```python
import torch

def _softmax(x, axis=-1):
    return torch.softmax(x, dim=axis)
def _gelu(x):
    return torch.nn.functional.gelu(x, approximate="tanh")
def _silu(x):
    return torch.nn.functional.silu(x)
def _sigmoid(x):
    return torch.sigmoid(x)
def _layernorm(x, axis=-1, eps=1e-5):
    m = x.mean(dim=axis, keepdim=True)
    v = x.var(dim=axis, keepdim=True, unbiased=False)
    return (x - m) / torch.sqrt(v + eps)
def _scatter_add(tgt, idx, src, axis=0):
    return tgt.clone().index_add_(axis, idx, src)
def _segment_sum(src, seg, n):
    out = torch.zeros((n,) + src.shape[1:], dtype=src.dtype)
    return out.index_add_(0, seg, src)
def _pad(x, pw):
    flat = tuple(v for pair in reversed(pw) for v in pair)
    return torch.nn.functional.pad(x, flat)

kernel_name = 'standalone__hybrid_graph_tf_graphgps__graph'

def setup_inputs():

    _w = (lambda a: (lambda t: t.to(torch.bfloat16) if t.is_floating_point() else t)(torch.as_tensor(a)))
    N, deg, D = 10000, 16, 256
    E = N * deg
    src = (lambda lo, hi, *s: torch.randint(lo, hi, s))(0, N, E).to(torch.int64)
    dst = (lambda lo, hi, *s: torch.randint(lo, hi, s))(0, N, E).to(torch.int64)
    deg_cnt = torch.bincount(dst, minlength=N).to(float) + 1.0
    sc = 1.0 / float(D) ** 0.5
    return {
        "x": _w((lambda *s: torch.randn(*s, dtype=torch.bfloat16) * 0.05)(N, D)),
        "src": _w(src),
        "dst": _w(dst),
        "deg_inv": _w((1.0 / deg_cnt).to(float)),
        "w_msg": _w((lambda *s: torch.randn(*s, dtype=torch.bfloat16) * 0.2)(D, D) * sc),
        "wq": _w((lambda *s: torch.randn(*s, dtype=torch.bfloat16) * 1.6)(D, D) * sc),
        "wk": _w((lambda *s: torch.randn(*s, dtype=torch.bfloat16) * 1.6)(D, D) * sc),
        "wv": _w((lambda *s: torch.randn(*s, dtype=torch.bfloat16) * 0.2)(D, D) * sc),
        "w_out": _w((lambda *s: torch.randn(*s, dtype=torch.bfloat16) * 0.2)(D, D) * sc),
    }

def reference(x, src, dst, deg_inv, w_msg, wq, wk, wv, w_out):
    N, D = x.shape[0], x.shape[1]
    h = _layernorm(x, axis=-1)
    m_e = torch.einsum('nd,de->ne', h, w_msg)
    h_local = _segment_sum(m_e[src], dst, N) * deg_inv[:, None]
    q = torch.einsum('nd,de->ne', h, wq)
    k = torch.einsum('nd,de->ne', h, wk)
    v = torch.einsum('nd,de->ne', h, wv)
    logits = torch.einsum('id,jd->ij', q, k) / (float(D) ** 0.5)
    attn = _softmax(logits, axis=-1)
    h_global = torch.einsum('ij,jd->id', attn, v)
    y = torch.einsum('nd,de->ne', h_local + h_global, w_out)
    return x + y
```

```asm
; @launch kernel=k1_kernel grid=(249,1,1) block=(512,1,1) lds=163840
; @launch kernel=k2_kernel grid=(256,1,1) block=(256,1,1) lds=163840
.amdgcn_target "amdgcn-amd-amdhsa--gfx950"
.text
.globl k1_kernel
.p2align 8
.type k1_kernel,@function
k1_kernel:
s_getpc_b64 s[56:57]
s_load_dwordx16 s[16:31], s[0:1], 0
s_load_dwordx8 s[32:39], s[0:1], 64
s_cmp_ge_u32 s2, 249
s_cbranch_scc1 L1_end
v_lshrrev_b32 v1, 6, v0
v_and_b32 v2, 63, v0
s_lshr_b32 s3, s2, 3
v_readfirstlane_b32 s60, v1
s_mul_i32 s5, s3, 8
s_add_u32 s5, s5, s60
s_and_b32 s56, s56, 0xffffff00
s_mov_b32 s58, L2_end-k1_kernel
s_mov_b32 s59, 0x00020000
s_and_b32 s6, s5, 15
s_lshl_b32 s6, s6, 13
v_lshlrev_b32 v10, 7, v2
buffer_load_dword v255, v10, s[56:59], s6 offen
v_and_b32 v3, 15, v2
v_lshrrev_b32 v4, 4, v2
s_and_b32 s62, s3, 7
s_sub_u32 s4, s2, 40
s_cmp_lt_u32 s2, 40
s_cbranch_scc1 L1_notq
s_mov_b32 s61, 0
v_lshlrev_b32 v16, 4, v2
s_mul_i32 s63, s60, 6144
s_mul_i32 s6, s4, 24576
s_mul_i32 s7, s60, 3072
s_add_u32 s64, s6, s7
s_add_u32 s65, s64, 4096
s_lshl_b32 s7, s60, 6
v_lshrrev_b32 v5, 2, v2
v_and_b32 v6, 3, v2
v_lshrrev_b32 v7, 5, v2
v_lshlrev_b32 v7, 1, v7
v_xor_b32 v6, v6, v7
v_lshl_add_u32 v5, v5, 9, s7
v_lshl_add_u32 v17, v6, 4, v5
v_add_u32 v18, 0x1c00, v17
s_xor_b32 s6, s62, 0
s_lshl_b32 s66, s6, 14
s_xor_b32 s6, s62, 1
s_lshl_b32 s67, s6, 14
s_xor_b32 s6, s62, 2
s_lshl_b32 s68, s6, 14
s_xor_b32 s6, s62, 3
s_lshl_b32 s69, s6, 14
s_xor_b32 s6, s62, 4
s_lshl_b32 s70, s6, 14
s_xor_b32 s6, s62, 5
s_lshl_b32 s71, s6, 14
s_xor_b32 s6, s62, 6
s_lshl_b32 s72, s6, 14
s_xor_b32 s6, s62, 7
s_lshl_b32 s73, s6, 14
s_waitcnt lgkmcnt(0)
s_add_u32 s40, s16, 0x0
s_addc_u32 s41, s17, 0
s_mov_b32 s42, 0x4e2000
s_mov_b32 s43, 0x00020000
s_add_u32 s44, s26, 0x0
s_addc_u32 s45, s27, 0
s_mov_b32 s46, 0x20000
s_mov_b32 s47, 0x00020000
buffer_load_dwordx4 v[40:43], v16, s[40:43], s64 offen offset:0
buffer_load_dwordx4 v[44:47], v16, s[40:43], s64 offen offset:1024
buffer_load_dwordx4 v[48:51], v16, s[40:43], s64 offen offset:2048
s_add_u32 m0, s63, 0x0
s_nop 0
buffer_load_dwordx4 v17, s[44:47], s66 offen offset:0 lds
buffer_load_dwordx4 v18, s[44:47], s66 offen offset:1024 lds
s_add_u32 m0, s63, 0x800
s_nop 0
buffer_load_dwordx4 v17, s[44:47], s67 offen offset:0 lds
buffer_load_dwordx4 v18, s[44:47], s67 offen offset:1024 lds
v_bfe_u32 v5, v2, 2, 3
v_xor_b32 v5, s62, v5
v_and_b32 v6, 3, v2
v_lshlrev_b32 v7, 10, v5
v_lshl_add_u32 v7, v6, 8, v7
v_add_u32 v7, 0xc000, v7
v_and_b32 v5, 1, v5
v_lshl_or_b32 v6, v5, 2, v6
v_lshrrev_b32 v5, 5, v2
s_mul_i32 s6, s60, 6
v_add3_u32 v8, v5, s6, 0
v_lshrrev_b32 v9, 4, v8
v_lshl_add_u32 v9, v9, 13, v7
v_and_b32 v8, 15, v8
v_xor_b32 v8, v8, v6
v_lshl_add_u32 v36, v8, 4, v9
v_add3_u32 v8, v5, s6, 2
v_lshrrev_b32 v9, 4, v8
v_lshl_add_u32 v9, v9, 13, v7
v_and_b32 v8, 15, v8
v_xor_b32 v8, v8, v6
v_lshl_add_u32 v37, v8, 4, v9
v_add3_u32 v8, v5, s6, 4
v_lshrrev_b32 v9, 4, v8
v_lshl_add_u32 v9, v9, 13, v7
v_and_b32 v8, 15, v8
v_xor_b32 v8, v8, v6
v_lshl_add_u32 v38, v8, 4, v9
v_xor_b32 v5, v3, v4
v_lshlrev_b32 v5, 4, v5
v_lshl_add_u32 v5, v4, 8, v5
v_add_u32 v31, 0xc000, v5
v_xor_b32 v32, 64, v31
v_lshrrev_b32 v5, 2, v3
v_and_b32 v6, 3, v3
v_and_b32 v7, 1, v4
v_lshlrev_b32 v7, 1, v7
v_lshl_add_u32 v8, v4, 3, v5
v_lshlrev_b32 v8, 6, v8
v_add_u32 v8, s63, v8
v_and_b32 v9, 1, v6
v_lshl_add_u32 v8, v9, 3, v8
v_lshrrev_b32 v6, 1, v6
v_xor_b32 v6, v6, v7
v_xor_b32 v9, 0, v6
v_lshl_add_u32 v25, v9, 4, v8
v_xor_b32 v9, 2, v6
v_lshl_add_u32 v26, v9, 4, v8
v_lshrrev_b32 v5, 3, v2
v_and_b32 v6, 7, v2
v_lshrrev_b32 v7, 1, v5
v_xor_b32 v6, v6, v7
v_and_b32 v7, 4, v5
v_add_u32 v5, v5, v7
s_mul_i32 s6, s60, 16384
v_lshl_add_u32 v5, v5, 9, s6
v_lshl_add_u32 v21, v6, 4, v5
v_xor_b32 v6, 4, v6
v_lshl_add_u32 v22, v6, 4, v5
v_add_u32 v22, 0x1c00, v22
s_lshr_b32 s7, s62, 1
s_xor_b32 s6, s7, 0
s_lshl_b32 s74, s6, 7
s_add_u32 s75, s74, 2048
s_xor_b32 s6, s7, 1
s_lshl_b32 s76, s6, 7
s_add_u32 s77, s76, 2048
s_xor_b32 s6, s7, 2
s_lshl_b32 s78, s6, 7
s_add_u32 s79, s78, 2048
s_xor_b32 s6, s7, 3
s_lshl_b32 s80, s6, 7
s_add_u32 s81, s80, 2048
s_and_b32 s6, s62, 1
s_lshl_b32 s6, s6, 2
v_lshrrev_b32 v5, 1, v3
v_xor_b32 v5, v5, v4
v_xor_b32 v5, s6, v5
v_lshl_add_u32 v6, v3, 7, s63
v_lshl_add_u32 v29, v5, 4, v6
v_xor_b32 v30, 64, v29
s_mul_i32 s6, s60, 1
s_xor_b32 s6, s6, s62
s_lshl_b32 s6, s6, 10
s_add_u32 s6, s6, 0x12000
v_lshrrev_b32 v5, 1, v4
v_and_b32 v6, 1, v4
v_lshl_add_u32 v5, v5, 8, s6
v_lshl_add_u32 v5, v6, 3, v5
v_lshl_add_u32 v33, v3, 4, v5
v_xor_b32 v34, 0x400, v33
v_add_u32 v35, 0x12000, v16
s_mul_i32 s6, s4, 24576
s_mul_i32 s7, s60, 1024
s_add_u32 s82, s6, s7
s_add_u32 s83, s82, 8192
s_add_u32 s84, s82, 16384
s_mov_b32 s86, 0x3db8aa3b
s_mov_b32 s87, 0x3db8aa3b
s_mov_b32 s88, 0x3727c5ac
s_mov_b32 s89, 0x3b800000
s_mov_b32 s90, 0xffff0000
s_add_u32 s48, s28, 0x0
s_addc_u32 s49, s29, 0
s_mov_b32 s50, 0x20000
s_mov_b32 s51, 0x00020000
s_add_u32 s52, s38, 0x0
s_addc_u32 s53, s39, 0
s_mov_b32 s54, 0x4e4000
s_mov_b32 s55, 0x00020000
s_add_u32 s56, s38, 0x6800000
s_addc_u32 s57, s39, 0
s_mov_b32 s58, 0x4e4000
s_mov_b32 s59, 0x00020000
s_waitcnt vmcnt(6)
v_lshlrev_b32 v76, 16, v40
v_and_b32 v77, s90, v40
v_lshlrev_b32 v78, 16, v41
v_and_b32 v79, s90, v41
v_lshlrev_b32 v80, 16, v42
v_and_b32 v81, s90, v42
v_lshlrev_b32 v82, 16, v43
v_and_b32 v83, s90, v43
v_pk_add_f32 v[100:101], v[76:77], v[78:79]
v_pk_mul_f32 v[102:103], v[76:77], v[76:77]
v_pk_add_f32 v[40:41], v[80:81], v[82:83]
v_pk_fma_f32 v[102:103], v[78:79], v[78:79], v[102:103]
v_pk_add_f32 v[100:101], v[100:101], v[40:41]
v_pk_fma_f32 v[102:103], v[80:81], v[80:81], v[102:103]
v_add_f32 v100, v100, v101
v_pk_fma_f32 v[102:103], v[82:83], v[82:83], v[102:103]
v_add_f32 v102, v102, v103
s_waitcnt vmcnt(5)
v_lshlrev_b32 v84, 16, v44
v_and_b32 v85, s90, v44
v_lshlrev_b32 v86, 16, v45
v_and_b32 v87, s90, v45
v_lshlrev_b32 v88, 16, v46
v_and_b32 v89, s90, v46
v_lshlrev_b32 v90, 16, v47
v_and_b32 v91, s90, v47
v_pk_add_f32 v[104:105], v[84:85], v[86:87]
v_pk_mul_f32 v[106:107], v[84:85], v[84:85]
v_pk_add_f32 v[44:45], v[88:89], v[90:91]
v_pk_fma_f32 v[106:107], v[86:87], v[86:87], v[106:107]
v_pk_add_f32 v[104:105], v[104:105], v[44:45]
v_pk_fma_f32 v[106:107], v[88:89], v[88:89], v[106:107]
v_add_f32 v104, v104, v105
v_pk_fma_f32 v[106:107], v[90:91], v[90:91], v[106:107]
v_add_f32 v106, v106, v107
s_waitcnt vmcnt(4)
v_lshlrev_b32 v92, 16, v48
v_and_b32 v93, s90, v48
v_lshlrev_b32 v94, 16, v49
v_and_b32 v95, s90, v49
v_lshlrev_b32 v96, 16, v50
v_and_b32 v97, s90, v50
v_lshlrev_b32 v98, 16, v51
v_and_b32 v99, s90, v51
v_pk_add_f32 v[108:109], v[92:93], v[94:95]
v_pk_mul_f32 v[110:111], v[92:93], v[92:93]
v_pk_add_f32 v[48:49], v[96:97], v[98:99]
v_pk_fma_f32 v[110:111], v[94:95], v[94:95], v[110:111]
v_pk_add_f32 v[108:109], v[108:109], v[48:49]
v_pk_fma_f32 v[110:111], v[96:97], v[96:97], v[110:111]
v_add_f32 v108, v108, v109
v_pk_fma_f32 v[110:111], v[98:99], v[98:99], v[110:111]
v_add_f32 v110, v110, v111
v_permlane16_swap_b32 v100, v102
v_permlane16_swap_b32 v104, v106
v_permlane16_swap_b32 v108, v110
v_add_f32 v100, v100, v102
v_add_f32 v104, v104, v106
v_add_f32 v108, v108, v110
v_add_f32_dpp v101, v100, v100 row_ror:8 row_mask:0xf bank_mask:0x3
v_add_f32_dpp v101, v104, v104 row_ror:8 row_mask:0xf bank_mask:0xc
v_add_f32_dpp v109, v108, v108 row_ror:8 row_mask:0xf bank_mask:0xf
s_nop 0
v_add_f32_dpp v102, v101, v101 row_half_mirror row_mask:0xf bank_mask:0x5
v_add_f32_dpp v102, v109, v109 row_half_mirror row_mask:0xf bank_mask:0xa
s_nop 1
v_add_f32_dpp v102, v102, v102 quad_perm:[1,0,3,2] row_mask:0xf bank_mask:0xf
s_nop 1
v_add_f32_dpp v102, v102, v102 quad_perm:[2,3,0,1] row_mask:0xf bank_mask:0xf
v_mov_b32 v103, v102
s_nop 1
v_permlane16_swap_b32 v103, v102
v_mul_f32 v103, s89, v103
v_mul_f32 v102, s89, v102
v_fma_f32 v102, -v103, v103, v102
v_cvt_pk_bf16_f32 v103, v103, v103
v_max_f32 v102, 0, v102
v_cvt_pk_bf16_f32 v102, v102, v102
v_and_b32 v102, s90, v102
v_add_f32 v102, s88, v102
v_cvt_pk_bf16_f32 v102, v102, v102
v_and_b32 v102, s90, v102
v_sqrt_f32 v102, v102
v_and_b32 v103, s90, v103
v_cvt_pk_bf16_f32 v102, v102, v102
v_and_b32 v102, s90, v102
v_rcp_f32 v102, v102
s_nop 0
v_mul_f32 v103, -v103, v102
s_nop 1
v_mov_b64_dpp v[100:101], v[102:103] row_newbcast:0 row_mask:0xf bank_mask:0xf
v_mov_b64_dpp v[104:105], v[102:103] row_newbcast:8 row_mask:0xf bank_mask:0xf
v_mov_b64_dpp v[108:109], v[102:103] row_newbcast:4 row_mask:0xf bank_mask:0xf
v_fma_f32 v76, v76, v100, v101
v_fma_f32 v77, v77, v100, v101
v_fma_f32 v78, v78, v100, v101
v_fma_f32 v79, v79, v100, v101
v_fma_f32 v80, v80, v100, v101
v_fma_f32 v81, v81, v100, v101
v_fma_f32 v82, v82, v100, v101
v_fma_f32 v83, v83, v100, v101
v_cvt_pk_bf16_f32 v40, v76, v77
v_cvt_pk_bf16_f32 v41, v78, v79
v_cvt_pk_bf16_f32 v42, v80, v81
v_cvt_pk_bf16_f32 v43, v82, v83
ds_write_b128 v36, v[40:43]
v_fma_f32 v84, v84, v104, v105
v_fma_f32 v85, v85, v104, v105
v_fma_f32 v86, v86, v104, v105
v_fma_f32 v87, v87, v104, v105
v_fma_f32 v88, v88, v104, v105
v_fma_f32 v89, v89, v104, v105
v_fma_f32 v90, v90, v104, v105
v_fma_f32 v91, v91, v104, v105
v_cvt_pk_bf16_f32 v44, v84, v85
v_cvt_pk_bf16_f32 v45, v86, v87
v_cvt_pk_bf16_f32 v46, v88, v89
v_cvt_pk_bf16_f32 v47, v90, v91
ds_write_b128 v37, v[44:47]
v_fma_f32 v92, v92, v108, v109
v_fma_f32 v93, v93, v108, v109
v_fma_f32 v94, v94, v108, v109
v_fma_f32 v95, v95, v108, v109
v_fma_f32 v96, v96, v108, v109
v_fma_f32 v97, v97, v108, v109
v_fma_f32 v98, v98, v108, v109
v_fma_f32 v99, v99, v108, v109
v_cvt_pk_bf16_f32 v48, v92, v93
v_cvt_pk_bf16_f32 v49, v94, v95
v_cvt_pk_bf16_f32 v50, v96, v97
v_cvt_pk_bf16_f32 v51, v98, v99
ds_write_b128 v38, v[48:51]
s_add_u32 m0, s63, 0x1000
s_nop 0
buffer_load_dwordx4 v17, s[44:47], s68 offen offset:0 lds
buffer_load_dwordx4 v18, s[44:47], s68 offen offset:1024 lds
s_waitcnt vmcnt(4)
ds_read_b64_tr_b16 v[100:101], v25 offset:0
ds_read_b64_tr_b16 v[102:103], v25 offset:256
ds_read_b64_tr_b16 v[104:105], v26 offset:0
ds_read_b64_tr_b16 v[106:107], v26 offset:256
s_waitcnt lgkmcnt(4)
s_barrier
ds_read_b128 v[124:127], v31 offset:0
ds_read_b128 v[128:131], v31 offset:8192
ds_read_b128 v[132:135], v31 offset:16384
ds_read_b128 v[136:139], v32 offset:1024
s_waitcnt vmcnt(2)
ds_read_b64_tr_b16 v[108:109], v25 offset:2048
ds_read_b64_tr_b16 v[110:111], v25 offset:2304
s_waitcnt lgkmcnt(5)
v_mfma_f32_16x16x32_bf16 v[52:55], v[100:103], v[124:127], 0
ds_read_b128 v[140:143], v32 offset:9216
s_waitcnt lgkmcnt(5)
v_mfma_f32_16x16x32_bf16 v[56:59], v[100:103], v[128:131], 0
ds_read_b128 v[144:147], v32 offset:17408
s_waitcnt lgkmcnt(5)
v_mfma_f32_16x16x32_bf16 v[60:63], v[100:103], v[132:135], 0
ds_read_b64_tr_b16 v[112:113], v26 offset:2048
ds_read_b64_tr_b16 v[114:115], v26 offset:2304
v_mfma_f32_16x16x32_bf16 v[64:67], v[104:107], v[124:127], 0
s_add_u32 m0, s63, 0x0
s_nop 0
buffer_load_dwordx4 v17, s[44:47], s69 offen offset:0 lds
buffer_load_dwordx4 v18, s[44:47], s69 offen offset:1024 lds
v_mfma_f32_16x16x32_bf16 v[68:71], v[104:107], v[128:131], 0
v_mfma_f32_16x16x32_bf16 v[72:75], v[104:107], v[132:135], 0
ds_read_b128 v[148:151], v31 offset:2048
s_waitcnt vmcnt(2)
ds_read_b64_tr_b16 v[116:117], v25 offset:4096
ds_read_b64_tr_b16 v[118:119], v25 offset:4352
s_waitcnt lgkmcnt(7)
v_mfma_f32_16x16x32_bf16 v[52:55], v[108:111], v[136:139], v[52:55]
ds_read_b128 v[152:155], v31 offset:10240
s_waitcnt lgkmcnt(7)
v_mfma_f32_16x16x32_bf16 v[56:59], v[108:111], v[140:143], v[56:59]
ds_read_b128 v[156:159], v31 offset:18432
s_waitcnt lgkmcnt(7)
v_mfma_f32_16x16x32_bf16 v[60:63], v[108:111], v[144:147], v[60:63]
ds_read_b64_tr_b16 v[120:121], v26 offset:4096
ds_read_b64_tr_b16 v[122:123], v26 offset:4352
s_waitcnt lgkmcnt(7)
v_mfma_f32_16x16x32_bf16 v[64:67], v[112:115], v[136:139], v[64:67]
s_add_u32 m0, s63, 0x800
s_nop 0
buffer_load_dwordx4 v17, s[44:47], s70 offen offset:0 lds
buffer_load_dwordx4 v18, s[44:47], s70 offen offset:1024 lds
v_mfma_f32_16x16x32_bf16 v[68:71], v[112:115], v[140:143], v[68:71]
v_mfma_f32_16x16x32_bf16 v[72:75], v[112:115], v[144:147], v[72:75]
ds_read_b128 v[160:163], v32 offset:3072
s_waitcnt vmcnt(2)
ds_read_b64_tr_b16 v[100:101], v25 offset:0
ds_read_b64_tr_b16 v[102:103], v25 offset:256
s_waitcnt lgkmcnt(7)
v_mfma_f32_16x16x32_bf16 v[52:55], v[116:119], v[148:151], v[52:55]
ds_read_b128 v[164:167], v32 offset:11264
s_waitcnt lgkmcnt(7)
v_mfma_f32_16x16x32_bf16 v[56:59], v[116:119], v[152:155], v[56:59]
ds_read_b128 v[168:171], v32 offset:19456
s_waitcnt lgkmcnt(7)
v_mfma_f32_16x16x32_bf16 v[60:63], v[116:119], v[156:159], v[60:63]
ds_read_b64_tr_b16 v[104:105], v26 offset:0
ds_read_b64_tr_b16 v[106:107], v26 offset:256
s_waitcnt lgkmcnt(7)
v_mfma_f32_16x16x32_bf16 v[64:67], v[120:123], v[148:151], v[64:67]
s_add_u32 m0, s63, 0x1000
s_nop 0
buffer_load_dwordx4 v17, s[44:47], s71 offen offset:0 lds
buffer_load_dwordx4 v18, s[44:47], s71 offen offset:1024 lds
v_mfma_f32_16x16x32_bf16 v[68:71], v[120:123], v[152:155], v[68:71]
v_mfma_f32_16x16x32_bf16 v[72:75], v[120:123], v[156:159], v[72:75]
ds_read_b128 v[124:127], v31 offset:4096
s_waitcnt vmcnt(2)
ds_read_b64_tr_b16 v[108:109], v25 offset:2048
ds_read_b64_tr_b16 v[110:111], v25 offset:2304
s_waitcnt lgkmcnt(7)
v_mfma_f32_16x16x32_bf16 v[52:55], v[100:103], v[160:163], v[52:55]
ds_read_b128 v[128:131], v31 offset:12288
s_waitcnt lgkmcnt(7)
v_mfma_f32_16x16x32_bf16 v[56:59], v[100:103], v[164:167], v[56:59]
ds_read_b128 v[132:135], v31 offset:20480
s_waitcnt lgkmcnt(7)
v_mfma_f32_16x16x32_bf16 v[60:63], v[100:103], v[168:171], v[60:63]
ds_read_b64_tr_b16 v[112:113], v26 offset:2048
ds_read_b64_tr_b16 v[114:115], v26 offset:2304
s_waitcnt lgkmcnt(7)
v_mfma_f32_16x16x32_bf16 v[64:67], v[104:107], v[160:163], v[64:67]
s_add_u32 m0, s63, 0x0
s_nop 0
buffer_load_dwordx4 v17, s[44:47], s72 offen offset:0 lds
buffer_load_dwordx4 v18, s[44:47], s72 offen offset:1024 lds
v_mfma_f32_16x16x32_bf16 v[68:71], v[104:107], v[164:167], v[68:71]
v_mfma_f32_16x16x32_bf16 v[72:75], v[104:107], v[168:171], v[72:75]
ds_read_b128 v[136:139], v32 offset:5120
s_waitcnt vmcnt(2)
ds_read_b64_tr_b16 v[116:117], v25 offset:4096
ds_read_b64_tr_b16 v[118:119], v25 offset:4352
s_waitcnt lgkmcnt(7)
v_mfma_f32_16x16x32_bf16 v[52:55], v[108:111], v[124:127], v[52:55]
ds_read_b128 v[140:143], v32 offset:13312
s_waitcnt lgkmcnt(7)
v_mfma_f32_16x16x32_bf16 v[56:59], v[108:111], v[128:131], v[56:59]
ds_read_b128 v[144:147], v32 offset:21504
s_waitcnt lgkmcnt(7)
v_mfma_f32_16x16x32_bf16 v[60:63], v[108:111], v[132:135], v[60:63]
ds_read_b64_tr_b16 v[120:121], v26 offset:4096
ds_read_b64_tr_b16 v[122:123], v26 offset:4352
s_waitcnt lgkmcnt(7)
v_mfma_f32_16x16x32_bf16 v[64:67], v[112:115], v[124:127], v[64:67]
s_add_u32 m0, s63, 0x800
s_nop 0
buffer_load_dwordx4 v17, s[44:47], s73 offen offset:0 lds
buffer_load_dwordx4 v18, s[44:47], s73 offen offset:1024 lds
v_mfma_f32_16x16x32_bf16 v[68:71], v[112:115], v[128:131], v[68:71]
v_mfma_f32_16x16x32_bf16 v[72:75], v[112:115], v[132:135], v[72:75]
ds_read_b128 v[148:151], v31 offset:6144
s_waitcnt vmcnt(2)
ds_read_b64_tr_b16 v[100:101], v25 offset:0
ds_read_b64_tr_b16 v[102:103], v25 offset:256
s_waitcnt lgkmcnt(7)
v_mfma_f32_16x16x32_bf16 v[52:55], v[116:119], v[136:139], v[52:55]
ds_read_b128 v[152:155], v31 offset:14336
s_waitcnt lgkmcnt(7)
v_mfma_f32_16x16x32_bf16 v[56:59], v[116:119], v[140:143], v[56:59]
ds_read_b128 v[156:159], v31 offset:22528
s_waitcnt lgkmcnt(7)
v_mfma_f32_16x16x32_bf16 v[60:63], v[116:119], v[144:147], v[60:63]
ds_read_b64_tr_b16 v[104:105], v26 offset:0
ds_read_b64_tr_b16 v[106:107], v26 offset:256
s_waitcnt lgkmcnt(7)
v_mfma_f32_16x16x32_bf16 v[64:67], v[120:123], v[136:139], v[64:67]
s_add_u32 m0, s63, 0x1000
s_nop 0
buffer_load_dwordx4 v21, s[48:51], s74 offen offset:0 lds
buffer_load_dwordx4 v22, s[48:51], s74 offen offset:1024 lds
v_mfma_f32_16x16x32_bf16 v[68:71], v[120:123], v[140:143], v[68:71]
v_mfma_f32_16x16x32_bf16 v[72:75], v[120:123], v[144:147], v[72:75]
ds_read_b128 v[160:163], v32 offset:7168
s_waitcnt vmcnt(2)
ds_read_b64_tr_b16 v[108:109], v25 offset:2048
ds_read_b64_tr_b16 v[110:111], v25 offset:2304
s_waitcnt lgkmcnt(7)
v_mfma_f32_16x16x32_bf16 v[52:55], v[100:103], v[148:151], v[52:55]
ds_read_b128 v[164:167], v32 offset:15360
s_waitcnt lgkmcnt(7)
v_mfma_f32_16x16x32_bf16 v[56:59], v[100:103], v[152:155], v[56:59]
ds_read_b128 v[168:171], v32 offset:23552
s_waitcnt lgkmcnt(7)
v_mfma_f32_16x16x32_bf16 v[60:63], v[100:103], v[156:159], v[60:63]
ds_read_b64_tr_b16 v[112:113], v26 offset:2048
ds_read_b64_tr_b16 v[114:115], v26 offset:2304
s_waitcnt lgkmcnt(7)
v_mfma_f32_16x16x32_bf16 v[64:67], v[104:107], v[148:151], v[64:67]
s_add_u32 m0, s63, 0x0
s_nop 0
buffer_load_dwordx4 v21, s[48:51], s75 offen offset:0 lds
buffer_load_dwordx4 v22, s[48:51], s75 offen offset:1024 lds
v_mfma_f32_16x16x32_bf16 v[68:71], v[104:107], v[152:155], v[68:71]
v_mfma_f32_16x16x32_bf16 v[72:75], v[104:107], v[156:159], v[72:75]
s_waitcnt lgkmcnt(4)
v_mfma_f32_16x16x32_bf16 v[52:55], v[108:111], v[160:163], v[52:55]
s_waitcnt lgkmcnt(3)
v_mfma_f32_16x16x32_bf16 v[56:59], v[108:111], v[164:167], v[56:59]
s_waitcnt lgkmcnt(2)
v_mfma_f32_16x16x32_bf16 v[60:63], v[108:111], v[168:171], v[60:63]
s_waitcnt lgkmcnt(0)
v_mfma_f32_16x16x32_bf16 v[64:67], v[112:115], v[160:163], v[64:67]
s_nop 1
v_cvt_pk_bf16_f32 v52, v52, v53
v_cvt_pk_bf16_f32 v53, v54, v55
ds_write_b64 v33, v[52:53] offset:0
s_add_u32 m0, s63, 0x800
s_nop 0
buffer_load_dwordx4 v21, s[48:51], s76 offen offset:0 lds
buffer_load_dwordx4 v22, s[48:51], s76 offen offset:1024 lds
v_mfma_f32_16x16x32_bf16 v[68:71], v[112:115], v[164:167], v[68:71]
v_cvt_pk_bf16_f32 v56, v56, v57
v_cvt_pk_bf16_f32 v57, v58, v59
ds_write_b64 v33, v[56:57] offset:8192
v_mfma_f32_16x16x32_bf16 v[72:75], v[112:115], v[168:171], v[72:75]
v_cvt_pk_bf16_f32 v60, v60, v61
v_cvt_pk_bf16_f32 v61, v62, v63
ds_write_b64 v33, v[60:61] offset:16384
v_cvt_pk_bf16_f32 v64, v64, v65
v_cvt_pk_bf16_f32 v65, v66, v67
ds_write_b64 v33, v[64:65] offset:512
v_cvt_pk_bf16_f32 v68, v68, v69
v_cvt_pk_bf16_f32 v69, v70, v71
ds_write_b64 v33, v[68:69] offset:8704
v_cvt_pk_bf16_f32 v72, v72, v73
v_cvt_pk_bf16_f32 v73, v74, v75
ds_write_b64 v33, v[72:73] offset:16896
s_waitcnt vmcnt(4)
ds_read_b128 v[116:119], v29 offset:4096
ds_read_b128 v[120:123], v30 offset:4096
s_waitcnt lgkmcnt(2)
s_barrier
ds_read_b128 v[124:127], v35 offset:0
ds_read_b128 v[128:131], v35 offset:8192
ds_read_b128 v[132:135], v35 offset:16384
ds_read_b128 v[136:139], v35 offset:1024
ds_read_b128 v[140:143], v35 offset:9216
ds_read_b128 v[144:147], v35 offset:17408
s_waitcnt vmcnt(2)
ds_read_b128 v[100:103], v29 offset:0
s_waitcnt lgkmcnt(6)
v_mfma_f32_16x16x32_bf16 v[76:79], v[116:119], v[124:127], 0
s_waitcnt lgkmcnt(5)
v_mfma_f32_16x16x32_bf16 v[84:87], v[116:119], v[128:131], 0
s_waitcnt lgkmcnt(4)
v_mfma_f32_16x16x32_bf16 v[92:95], v[116:119], v[132:135], 0
ds_read_b128 v[104:107], v30 offset:0
s_waitcnt lgkmcnt(4)
v_mfma_f32_16x16x32_bf16 v[76:79], v[120:123], v[136:139], v[76:79]
s_add_u32 m0, s63, 0x1000
s_nop 0
buffer_load_dwordx4 v21, s[48:51], s77 offen offset:0 lds
buffer_load_dwordx4 v22, s[48:51], s77 offen offset:1024 lds
s_waitcnt lgkmcnt(3)
v_mfma_f32_16x16x32_bf16 v[84:87], v[120:123], v[140:143], v[84:87]
s_waitcnt lgkmcnt(2)
v_mfma_f32_16x16x32_bf16 v[92:95], v[120:123], v[144:147], v[92:95]
ds_read_b128 v[148:151], v35 offset:2048
s_waitcnt vmcnt(2)
ds_read_b128 v[108:111], v29 offset:2048
s_waitcnt lgkmcnt(3)
v_mfma_f32_16x16x32_bf16 v[80:83], v[100:103], v[124:127], 0
ds_read_b128 v[152:155], v35 offset:10240
v_mfma_f32_16x16x32_bf16 v[88:91], v[100:103], v[128:131], 0
ds_read_b128 v[156:159], v35 offset:18432
v_mfma_f32_16x16x32_bf16 v[96:99], v[100:103], v[132:135], 0
ds_read_b128 v[160:163], v35 offset:3072
ds_read_b128 v[112:115], v30 offset:2048
s_waitcnt lgkmcnt(6)
v_mfma_f32_16x16x32_bf16 v[80:83], v[104:107], v[136:139], v[80:83]
ds_read_b128 v[164:167], v35 offset:11264
s_add_u32 m0, s63, 0x0
s_nop 0
buffer_load_dwordx4 v21, s[48:51], s78 offen offset:0 lds
buffer_load_dwordx4 v22, s[48:51], s78 offen offset:1024 lds
v_mfma_f32_16x16x32_bf16 v[88:91], v[104:107], v[140:143], v[88:91]
ds_read_b128 v[168:171], v35 offset:19456
v_mfma_f32_16x16x32_bf16 v[96:99], v[104:107], v[144:147], v[96:99]
s_waitcnt vmcnt(2)
ds_read_b128 v[116:119], v29 offset:4096
s_waitcnt lgkmcnt(7)
v_mfma_f32_16x16x32_bf16 v[76:79], v[108:111], v[148:151], v[76:79]
s_waitcnt lgkmcnt(6)
v_mfma_f32_16x16x32_bf16 v[84:87], v[108:111], v[152:155], v[84:87]
s_waitcnt lgkmcnt(5)
v_mfma_f32_16x16x32_bf16 v[92:95], v[108:111], v[156:159], v[92:95]
ds_read_b128 v[120:123], v30 offset:4096
s_waitcnt lgkmcnt(4)
v_mfma_f32_16x16x32_bf16 v[76:79], v[112:115], v[160:163], v[76:79]
s_add_u32 m0, s63, 0x800
s_nop 0
buffer_load_dwordx4 v21, s[48:51], s79 offen offset:0 lds
buffer_load_dwordx4 v22, s[48:51], s79 offen offset:1024 lds
s_waitcnt lgkmcnt(3)
v_mfma_f32_16x16x32_bf16 v[84:87], v[112:115], v[164:167], v[84:87]
s_waitcnt lgkmcnt(2)
v_mfma_f32_16x16x32_bf16 v[92:95], v[112:115], v[168:171], v[92:95]
ds_read_b128 v[124:127], v35 offset:4096
s_waitcnt vmcnt(2)
ds_read_b128 v[100:103], v29 offset:0
s_waitcnt lgkmcnt(3)
v_mfma_f32_16x16x32_bf16 v[80:83], v[116:119], v[148:151], v[80:83]
ds_read_b128 v[128:131], v35 offset:12288
v_mfma_f32_16x16x32_bf16 v[88:91], v[116:119], v[152:155], v[88:91]
ds_read_b128 v[132:135], v35 offset:20480
v_mfma_f32_16x16x32_bf16 v[96:99], v[116:119], v[156:159], v[96:99]
ds_read_b128 v[136:139], v35 offset:5120
ds_read_b128 v[104:107], v30 offset:0
s_waitcnt lgkmcnt(6)
v_mfma_f32_16x16x32_bf16 v[80:83], v[120:123], v[160:163], v[80:83]
ds_read_b128 v[140:143], v35 offset:13312
s_add_u32 m0, s63, 0x1000
s_nop 0
buffer_load_dwordx4 v21, s[48:51], s80 offen offset:0 lds
buffer_load_dwordx4 v22, s[48:51], s80 offen offset:1024 lds
v_mfma_f32_16x16x32_bf16 v[88:91], v[120:123], v[164:167], v[88:91]
ds_read_b128 v[144:147], v35 offset:21504
v_mfma_f32_16x16x32_bf16 v[96:99], v[120:123], v[168:171], v[96:99]
s_waitcnt vmcnt(2)
ds_read_b128 v[108:111], v29 offset:2048
s_waitcnt lgkmcnt(7)
v_mfma_f32_16x16x32_bf16 v[76:79], v[100:103], v[124:127], v[76:79]
s_waitcnt lgkmcnt(6)
v_mfma_f32_16x16x32_bf16 v[84:87], v[100:103], v[128:131], v[84:87]
s_waitcnt lgkmcnt(5)
v_mfma_f32_16x16x32_bf16 v[92:95], v[100:103], v[132:135], v[92:95]
ds_read_b128 v[112:115], v30 offset:2048
s_waitcnt lgkmcnt(4)
v_mfma_f32_16x16x32_bf16 v[76:79], v[104:107], v[136:139], v[76:79]
s_add_u32 m0, s63, 0x0
s_nop 0
buffer_load_dwordx4 v21, s[48:51], s81 offen offset:0 lds
buffer_load_dwordx4 v22, s[48:51], s81 offen offset:1024 lds
s_waitcnt lgkmcnt(3)
v_mfma_f32_16x16x32_bf16 v[84:87], v[104:107], v[140:143], v[84:87]
buffer_store_dwordx4 v[40:43], v16, s[56:59], s64 offen offset:0 sc1
buffer_store_dwordx4 v[44:47], v16, s[56:59], s64 offen offset:1024 sc1
s_waitcnt lgkmcnt(2)
v_mfma_f32_16x16x32_bf16 v[92:95], v[104:107], v[144:147], v[92:95]
ds_read_b128 v[148:151], v35 offset:6144
s_waitcnt vmcnt(4)
ds_read_b128 v[116:119], v29 offset:4096
s_waitcnt lgkmcnt(3)
v_mfma_f32_16x16x32_bf16 v[80:83], v[108:111], v[124:127], v[80:83]
ds_read_b128 v[152:155], v35 offset:14336
buffer_store_dwordx4 v[48:51], v16, s[56:59], s64 offen offset:2048 sc1
v_mfma_f32_16x16x32_bf16 v[88:91], v[108:111], v[128:131], v[88:91]
ds_read_b128 v[156:159], v35 offset:22528
v_mfma_f32_16x16x32_bf16 v[96:99], v[108:111], v[132:135], v[96:99]
ds_read_b128 v[160:163], v35 offset:7168
ds_read_b128 v[120:123], v30 offset:4096
s_waitcnt lgkmcnt(6)
v_mfma_f32_16x16x32_bf16 v[80:83], v[112:115], v[136:139], v[80:83]
ds_read_b128 v[164:167], v35 offset:15360
v_mfma_f32_16x16x32_bf16 v[88:91], v[112:115], v[140:143], v[88:91]
ds_read_b128 v[168:171], v35 offset:23552
v_mfma_f32_16x16x32_bf16 v[96:99], v[112:115], v[144:147], v[96:99]
s_waitcnt vmcnt(3)
ds_read_b128 v[100:103], v29 offset:0
s_waitcnt lgkmcnt(7)
v_mfma_f32_16x16x32_bf16 v[76:79], v[116:119], v[148:151], v[76:79]
s_waitcnt lgkmcnt(6)
v_mfma_f32_16x16x32_bf16 v[84:87], v[116:119], v[152:155], v[84:87]
s_waitcnt lgkmcnt(5)
v_mfma_f32_16x16x32_bf16 v[92:95], v[116:119], v[156:159], v[92:95]
ds_read_b128 v[104:107], v30 offset:0
s_waitcnt lgkmcnt(4)
v_mfma_f32_16x16x32_bf16 v[76:79], v[120:123], v[160:163], v[76:79]
s_waitcnt lgkmcnt(3)
v_mfma_f32_16x16x32_bf16 v[84:87], v[120:123], v[164:167], v[84:87]
s_waitcnt lgkmcnt(2)
v_mfma_f32_16x16x32_bf16 v[92:95], v[120:123], v[168:171], v[92:95]
s_waitcnt lgkmcnt(1)
v_mfma_f32_16x16x32_bf16 v[80:83], v[100:103], v[148:151], v[80:83]
v_mfma_f32_16x16x32_bf16 v[88:91], v[100:103], v[152:155], v[88:91]
v_mfma_f32_16x16x32_bf16 v[96:99], v[100:103], v[156:159], v[96:99]
s_waitcnt lgkmcnt(0)
v_mfma_f32_16x16x32_bf16 v[80:83], v[104:107], v[160:163], v[80:83]
v_mfma_f32_16x16x32_bf16 v[88:91], v[104:107], v[164:167], v[88:91]
v_mfma_f32_16x16x32_bf16 v[96:99], v[104:107], v[168:171], v[96:99]
v_mul_f32 v76, s86, v76
v_mul_f32 v77, s86, v77
v_mul_f32 v78, s86, v78
v_mul_f32 v79, s86, v79
s_nop 1
v_mul_f32 v80, s86, v80
v_mul_f32 v81, s86, v81
v_mul_f32 v82, s86, v82
v_mul_f32 v83, s86, v83
v_cvt_pk_bf16_f32 v76, v76, v77
v_cvt_pk_bf16_f32 v77, v78, v79
v_cvt_pk_bf16_f32 v78, v80, v81
v_cvt_pk_bf16_f32 v79, v82, v83
buffer_store_dwordx4 v[76:79], v16, s[52:55], s82 offen offset:0 sc1
v_mul_f32 v84, s86, v84
v_mul_f32 v85, s86, v85
v_mul_f32 v86, s86, v86
v_mul_f32 v87, s86, v87
v_mul_f32 v88, s86, v88
v_mul_f32 v89, s86, v89
v_mul_f32 v90, s86, v90
v_mul_f32 v91, s86, v91
v_cvt_pk_bf16_f32 v84, v84, v85
v_cvt_pk_bf16_f32 v85, v86, v87
v_cvt_pk_bf16_f32 v86, v88, v89
v_cvt_pk_bf16_f32 v87, v90, v91
buffer_store_dwordx4 v[84:87], v16, s[52:55], s83 offen offset:0 sc1
v_mul_f32 v92, s86, v92
v_mul_f32 v93, s86, v93
v_mul_f32 v94, s86, v94
v_mul_f32 v95, s86, v95
v_mul_f32 v96, s86, v96
v_mul_f32 v97, s86, v97
v_mul_f32 v98, s86, v98
v_mul_f32 v99, s86, v99
v_cvt_pk_bf16_f32 v92, v92, v93
v_cvt_pk_bf16_f32 v93, v94, v95
v_cvt_pk_bf16_f32 v94, v96, v97
v_cvt_pk_bf16_f32 v95, v98, v99
buffer_store_dwordx4 v[92:95], v16, s[52:55], s84 offen offset:0 sc1
s_branch L1_fin
L1_notq:
s_sub_u32 s4, s2, 32
s_cmp_lt_u32 s2, 32
s_cbranch_scc1 L1_edge
s_mov_b32 s61, 1
v_lshlrev_b32 v16, 4, v2
s_mul_i32 s63, s60, 6144
s_and_b32 s6, s4, 3
s_lshl_b32 s6, s6, 6
s_mul_i32 s7, s60, 8
s_add_u32 s6, s6, s7
v_lshrrev_b32 v5, 5, v2
v_and_b32 v6, 31, v2
v_lshlrev_b32 v6, 4, v6
s_cmp_ge_u32 s4, 4
s_cselect_b64 vcc, -1, 0
v_add3_u32 v7, v5, s6, 0
v_and_b32 v8, 0x80, v7
v_bfe_u32 v9, v7, 2, 1
v_lshl_or_b32 v8, v9, 6, v8
v_bfe_u32 v9, v7, 4, 1
v_lshl_or_b32 v8, v9, 5, v8
v_and_b32 v9, 3, v7
v_lshl_or_b32 v8, v9, 3, v8
v_bfe_u32 v9, v7, 5, 2
v_lshl_or_b32 v8, v9, 1, v8
v_bfe_u32 v9, v7, 3, 1
v_or_b32 v8, v9, v8
v_cndmask_b32 v8, v8, v7, vcc
v_lshl_add_u32 v40, v8, 9, v6
v_add3_u32 v7, v5, s6, 2
v_and_b32 v8, 0x80, v7
v_bfe_u32 v9, v7, 2, 1
v_lshl_or_b32 v8, v9, 6, v8
v_bfe_u32 v9, v7, 4, 1
v_lshl_or_b32 v8, v9, 5, v8
v_and_b32 v9, 3, v7
v_lshl_or_b32 v8, v9, 3, v8
v_bfe_u32 v9, v7, 5, 2
v_lshl_or_b32 v8, v9, 1, v8
v_bfe_u32 v9, v7, 3, 1
v_or_b32 v8, v9, v8
v_cndmask_b32 v8, v8, v7, vcc
v_lshl_add_u32 v44, v8, 9, v6
v_add3_u32 v7, v5, s6, 4
v_and_b32 v8, 0x80, v7
v_bfe_u32 v9, v7, 2, 1
v_lshl_or_b32 v8, v9, 6, v8
v_bfe_u32 v9, v7, 4, 1
v_lshl_or_b32 v8, v9, 5, v8
v_and_b32 v9, 3, v7
v_lshl_or_b32 v8, v9, 3, v8
v_bfe_u32 v9, v7, 5, 2
v_lshl_or_b32 v8, v9, 1, v8
v_bfe_u32 v9, v7, 3, 1
v_or_b32 v8, v9, v8
v_cndmask_b32 v8, v8, v7, vcc
v_lshl_add_u32 v48, v8, 9, v6
v_add3_u32 v7, v5, s6, 6
v_and_b32 v8, 0x80, v7
v_bfe_u32 v9, v7, 2, 1
v_lshl_or_b32 v8, v9, 6, v8
v_bfe_u32 v9, v7, 4, 1
v_lshl_or_b32 v8, v9, 5, v8
v_and_b32 v9, 3, v7
v_lshl_or_b32 v8, v9, 3, v8
v_bfe_u32 v9, v7, 5, 2
v_lshl_or_b32 v8, v9, 1, v8
v_bfe_u32 v9, v7, 3, 1
v_or_b32 v8, v9, v8
v_cndmask_b32 v8, v8, v7, vcc
v_lshl_add_u32 v52, v8, 9, v6
s_lshl_b32 s7, s60, 6
v_lshrrev_b32 v5, 2, v2
v_and_b32 v6, 3, v2
v_lshrrev_b32 v7, 5, v2
v_lshlrev_b32 v7, 1, v7
v_xor_b32 v6, v6, v7
v_lshl_add_u32 v5, v5, 9, s7
v_lshl_add_u32 v17, v6, 4, v5
v_add_u32 v18, 0x1c00, v17
s_xor_b32 s6, s62, 0
s_lshl_b32 s66, s6, 14
s_xor_b32 s6, s62, 1
s_lshl_b32 s67, s6, 14
s_xor_b32 s6, s62, 2
s_lshl_b32 s68, s6, 14
s_xor_b32 s6, s62, 3
s_lshl_b32 s69, s6, 14
s_xor_b32 s6, s62, 4
s_lshl_b32 s70, s6, 14
s_xor_b32 s6, s62, 5
s_lshl_b32 s71, s6, 14
s_xor_b32 s6, s62, 6
s_lshl_b32 s72, s6, 14
s_xor_b32 s6, s62, 7
s_lshl_b32 s73, s6, 14
s_waitcnt lgkmcnt(0)
s_cmp_ge_u32 s4, 4
s_cselect_b32 s6, s30, s24
s_cselect_b32 s7, s31, s25
s_add_u32 s40, s6, 0x0
s_addc_u32 s41, s7, 0
s_mov_b32 s42, 0x20000
s_mov_b32 s43, 0x00020000
s_add_u32 s44, s32, 0x0
s_addc_u32 s45, s33, 0
s_mov_b32 s46, 0x20000
s_mov_b32 s47, 0x00020000
buffer_load_dwordx4 v[40:43], v40, s[40:43], 0 offen
buffer_load_dwordx4 v[44:47], v44, s[40:43], 0 offen
buffer_load_dwordx4 v[48:51], v48, s[40:43], 0 offen
buffer_load_dwordx4 v[52:55], v52, s[40:43], 0 offen
s_add_u32 m0, s63, 0x0
s_nop 0
buffer_load_dwordx4 v17, s[44:47], s66 offen offset:0 lds
buffer_load_dwordx4 v18, s[44:47], s66 offen offset:1024 lds
s_add_u32 m0, s63, 0x800
s_nop 0
buffer_load_dwordx4 v17, s[44:47], s67 offen offset:0 lds
buffer_load_dwordx4 v18, s[44:47], s67 offen offset:1024 lds
v_bfe_u32 v5, v2, 2, 3
v_xor_b32 v5, s62, v5
v_and_b32 v6, 3, v2
v_lshlrev_b32 v7, 10, v5
v_lshl_add_u32 v7, v6, 8, v7
v_add_u32 v7, 0xc000, v7
v_and_b32 v5, 1, v5
v_lshl_or_b32 v6, v5, 2, v6
v_lshrrev_b32 v5, 5, v2
s_mul_i32 s6, s60, 8
v_add3_u32 v8, v5, s6, 0
v_lshrrev_b32 v9, 4, v8
v_lshl_add_u32 v9, v9, 13, v7
v_and_b32 v8, 15, v8
v_xor_b32 v8, v8, v6
v_lshl_add_u32 v36, v8, 4, v9
v_add3_u32 v8, v5, s6, 2
v_lshrrev_b32 v9, 4, v8
v_lshl_add_u32 v9, v9, 13, v7
v_and_b32 v8, 15, v8
v_xor_b32 v8, v8, v6
v_lshl_add_u32 v37, v8, 4, v9
v_add3_u32 v8, v5, s6, 4
v_lshrrev_b32 v9, 4, v8
v_lshl_add_u32 v9, v9, 13, v7
v_and_b32 v8, 15, v8
v_xor_b32 v8, v8, v6
v_lshl_add_u32 v38, v8, 4, v9
v_add3_u32 v8, v5, s6, 6
v_lshrrev_b32 v9, 4, v8
v_lshl_add_u32 v9, v9, 13, v7
v_and_b32 v8, 15, v8
v_xor_b32 v8, v8, v6
v_lshl_add_u32 v39, v8, 4, v9
v_xor_b32 v5, v3, v4
v_lshlrev_b32 v5, 4, v5
v_lshl_add_u32 v5, v4, 8, v5
v_add_u32 v31, 0xc000, v5
v_xor_b32 v32, 64, v31
v_lshrrev_b32 v5, 2, v3
v_and_b32 v6, 3, v3
v_and_b32 v7, 1, v4
v_lshlrev_b32 v7, 1, v7
v_lshl_add_u32 v8, v4, 3, v5
v_lshlrev_b32 v8, 6, v8
v_add_u32 v8, s63, v8
v_xor_b32 v6, v6, v7
v_xor_b32 v9, 0, v6
v_lshl_add_u32 v25, v9, 4, v8
v_add_u32 v26, 8, v25
s_lshr_b32 s6, s4, 2
s_lshl_b32 s6, s6, 17
s_and_b32 s7, s4, 3
s_lshl_b32 s7, s7, 12
s_add_u32 s6, s6, s7
s_mul_i32 s7, s60, 16384
s_add_u32 s82, s6, s7
s_add_u32 s83, s82, 16384
s_add_u32 s52, s38, 0x1000000
s_addc_u32 s53, s39, 0
s_mov_b32 s54, 0x40000
s_mov_b32 s55, 0x00020000
s_waitcnt vmcnt(7)
ds_write_b128 v36, v[40:43]
s_waitcnt vmcnt(6)
ds_write_b128 v37, v[44:47]
s_waitcnt vmcnt(5)
ds_write_b128 v38, v[48:51]
s_waitcnt vmcnt(4)
ds_write_b128 v39, v[52:55]
s_add_u32 m0, s63, 0x1000
s_nop 0
buffer_load_dwordx4 v17, s[44:47], s68 offen offset:0 lds
buffer_load_dwordx4 v18, s[44:47], s68 offen offset:1024 lds
s_waitcnt vmcnt(4)
ds_read_b64_tr_b16 v[88:89], v25 offset:0
ds_read_b64_tr_b16 v[90:91], v25 offset:256
ds_read_b64_tr_b16 v[92:93], v26 offset:0
ds_read_b64_tr_b16 v[94:95], v26 offset:256
s_waitcnt lgkmcnt(4)
s_barrier
ds_read_b128 v[112:115], v31 offset:0
ds_read_b128 v[116:119], v31 offset:8192
ds_read_b128 v[120:123], v31 offset:16384
ds_read_b128 v[124:127], v31 offset:24576
ds_read_b128 v[128:131], v32 offset:1024
s_waitcnt vmcnt(2)
ds_read_b64_tr_b16 v[96:97], v25 offset:2048
ds_read_b64_tr_b16 v[98:99], v25 offset:2304
s_waitcnt lgkmcnt(6)
v_mfma_f32_16x16x32_bf16 v[56:59], v[112:115], v[88:91], 0
ds_read_b128 v[132:135], v32 offset:9216
s_waitcnt lgkmcnt(6)
v_mfma_f32_16x16x32_bf16 v[60:63], v[116:119], v[88:91], 0
ds_read_b128 v[136:139], v32 offset:17408
s_waitcnt lgkmcnt(6)
v_mfma_f32_16x16x32_bf16 v[64:67], v[120:123], v[88:91], 0
ds_read_b128 v[140:143], v32 offset:25600
s_waitcnt lgkmcnt(6)
v_mfma_f32_16x16x32_bf16 v[68:71], v[124:127], v[88:91], 0
ds_read_b64_tr_b16 v[100:101], v26 offset:2048
ds_read_b64_tr_b16 v[102:103], v26 offset:2304
v_mfma_f32_16x16x32_bf16 v[72:75], v[112:115], v[92:95], 0
s_add_u32 m0, s63, 0x0
s_nop 0
buffer_load_dwordx4 v17, s[44:47], s69 offen offset:0 lds
buffer_load_dwordx4 v18, s[44:47], s69 offen offset:1024 lds
v_mfma_f32_16x16x32_bf16 v[76:79], v[116:119], v[92:95], 0
v_mfma_f32_16x16x32_bf16 v[80:83], v[120:123], v[92:95], 0
v_mfma_f32_16x16x32_bf16 v[84:87], v[124:127], v[92:95], 0
ds_read_b128 v[144:147], v31 offset:2048
s_waitcnt vmcnt(2)
ds_read_b64_tr_b16 v[104:105], v25 offset:4096
ds_read_b64_tr_b16 v[106:107], v25 offset:4352
s_waitcnt lgkmcnt(8)
v_mfma_f32_16x16x32_bf16 v[56:59], v[128:131], v[96:99], v[56:59]
ds_read_b128 v[148:151], v31 offset:10240
s_waitcnt lgkmcnt(8)
v_mfma_f32_16x16x32_bf16 v[60:63], v[132:135], v[96:99], v[60:63]
ds_read_b128 v[152:155], v31 offset:18432
s_waitcnt lgkmcnt(8)
v_mfma_f32_16x16x32_bf16 v[64:67], v[136:139], v[96:99], v[64:67]
ds_read_b128 v[156:159], v31 offset:26624
s_waitcnt lgkmcnt(8)
v_mfma_f32_16x16x32_bf16 v[68:71], v[140:143], v[96:99], v[68:71]
ds_read_b64_tr_b16 v[108:109], v26 offset:4096
ds_read_b64_tr_b16 v[110:111], v26 offset:4352
s_waitcnt lgkmcnt(8)
v_mfma_f32_16x16x32_bf16 v[72:75], v[128:131], v[100:103], v[72:75]
s_add_u32 m0, s63, 0x800
s_nop 0
buffer_load_dwordx4 v17, s[44:47], s70 offen offset:0 lds
buffer_load_dwordx4 v18, s[44:47], s70 offen offset:1024 lds
v_mfma_f32_16x16x32_bf16 v[76:79], v[132:135], v[100:103], v[76:79]
v_mfma_f32_16x16x32_bf16 v[80:83], v[136:139], v[100:103], v[80:83]
v_mfma_f32_16x16x32_bf16 v[84:87], v[140:143], v[100:103], v[84:87]
ds_read_b128 v[160:163], v32 offset:3072
s_waitcnt vmcnt(2)
ds_read_b64_tr_b16 v[88:89], v25 offset:0
ds_read_b64_tr_b16 v[90:91], v25 offset:256
s_waitcnt lgkmcnt(8)
v_mfma_f32_16x16x32_bf16 v[56:59], v[144:147], v[104:107], v[56:59]
ds_read_b128 v[164:167], v32 offset:11264
s_waitcnt lgkmcnt(8)
v_mfma_f32_16x16x32_bf16 v[60:63], v[148:151], v[104:107], v[60:63]
ds_read_b128 v[168:171], v32 offset:19456
s_waitcnt lgkmcnt(8)
v_mfma_f32_16x16x32_bf16 v[64:67], v[152:155], v[104:107], v[64:67]
ds_read_b128 v[172:175], v32 offset:27648
s_waitcnt lgkmcnt(8)
v_mfma_f32_16x16x32_bf16 v[68:71], v[156:159], v[104:107], v[68:71]
ds_read_b64_tr_b16 v[92:93], v26 offset:0
ds_read_b64_tr_b16 v[94:95], v26 offset:256
s_waitcnt lgkmcnt(8)
v_mfma_f32_16x16x32_bf16 v[72:75], v[144:147], v[108:111], v[72:75]
s_add_u32 m0, s63, 0x1000
s_nop 0
buffer_load_dwordx4 v17, s[44:47], s71 offen offset:0 lds
buffer_load_dwordx4 v18, s[44:47], s71 offen offset:1024 lds
v_mfma_f32_16x16x32_bf16 v[76:79], v[148:151], v[108:111], v[76:79]
v_mfma_f32_16x16x32_bf16 v[80:83], v[152:155], v[108:111], v[80:83]
v_mfma_f32_16x16x32_bf16 v[84:87], v[156:159], v[108:111], v[84:87]
ds_read_b128 v[112:115], v31 offset:4096
s_waitcnt vmcnt(2)
ds_read_b64_tr_b16 v[96:97], v25 offset:2048
ds_read_b64_tr_b16 v[98:99], v25 offset:2304
s_waitcnt lgkmcnt(8)
v_mfma_f32_16x16x32_bf16 v[56:59], v[160:163], v[88:91], v[56:59]
ds_read_b128 v[116:119], v31 offset:12288
s_waitcnt lgkmcnt(8)
v_mfma_f32_16x16x32_bf16 v[60:63], v[164:167], v[88:91], v[60:63]
ds_read_b128 v[120:123], v31 offset:20480
s_waitcnt lgkmcnt(8)
v_mfma_f32_16x16x32_bf16 v[64:67], v[168:171], v[88:91], v[64:67]
ds_read_b128 v[124:127], v31 offset:28672
s_waitcnt lgkmcnt(8)
v_mfma_f32_16x16x32_bf16 v[68:71], v[172:175], v[88:91], v[68:71]
ds_read_b64_tr_b16 v[100:101], v26 offset:2048
ds_read_b64_tr_b16 v[102:103], v26 offset:2304
s_waitcnt lgkmcnt(8)
v_mfma_f32_16x16x32_bf16 v[72:75], v[160:163], v[92:95], v[72:75]
s_add_u32 m0, s63, 0x0
s_nop 0
buffer_load_dwordx4 v17, s[44:47], s72 offen offset:0 lds
buffer_load_dwordx4 v18, s[44:47], s72 offen offset:1024 lds
v_mfma_f32_16x16x32_bf16 v[76:79], v[164:167], v[92:95], v[76:79]
v_mfma_f32_16x16x32_bf16 v[80:83], v[168:171], v[92:95], v[80:83]
v_mfma_f32_16x16x32_bf16 v[84:87], v[172:175], v[92:95], v[84:87]
ds_read_b128 v[128:131], v32 offset:5120
s_waitcnt vmcnt(2)
ds_read_b64_tr_b16 v[104:105], v25 offset:4096
ds_read_b64_tr_b16 v[106:107], v25 offset:4352
s_waitcnt lgkmcnt(8)
v_mfma_f32_16x16x32_bf16 v[56:59], v[112:115], v[96:99], v[56:59]
ds_read_b128 v[132:135], v32 offset:13312
s_waitcnt lgkmcnt(8)
v_mfma_f32_16x16x32_bf16 v[60:63], v[116:119], v[96:99], v[60:63]
ds_read_b128 v[136:139], v32 offset:21504
s_waitcnt lgkmcnt(8)
v_mfma_f32_16x16x32_bf16 v[64:67], v[120:123], v[96:99], v[64:67]
ds_read_b128 v[140:143], v32 offset:29696
s_waitcnt lgkmcnt(8)
v_mfma_f32_16x16x32_bf16 v[68:71], v[124:127], v[96:99], v[68:71]
ds_read_b64_tr_b16 v[108:109], v26 offset:4096
ds_read_b64_tr_b16 v[110:111], v26 offset:4352
s_waitcnt lgkmcnt(8)
v_mfma_f32_16x16x32_bf16 v[72:75], v[112:115], v[100:103], v[72:75]
s_add_u32 m0, s63, 0x800
s_nop 0
buffer_load_dwordx4 v17, s[44:47], s73 offen offset:0 lds
buffer_load_dwordx4 v18, s[44:47], s73 offen offset:1024 lds
v_mfma_f32_16x16x32_bf16 v[76:79], v[116:119], v[100:103], v[76:79]
v_mfma_f32_16x16x32_bf16 v[80:83], v[120:123], v[100:103], v[80:83]
v_mfma_f32_16x16x32_bf16 v[84:87], v[124:127], v[100:103], v[84:87]
ds_read_b128 v[144:147], v31 offset:6144
s_waitcnt vmcnt(2)
ds_read_b64_tr_b16 v[88:89], v25 offset:0
ds_read_b64_tr_b16 v[90:91], v25 offset:256
s_waitcnt lgkmcnt(8)
v_mfma_f32_16x16x32_bf16 v[56:59], v[128:131], v[104:107], v[56:59]
ds_read_b128 v[148:151], v31 offset:14336
s_waitcnt lgkmcnt(8)
v_mfma_f32_16x16x32_bf16 v[60:63], v[132:135], v[104:107], v[60:63]
ds_read_b128 v[152:155], v31 offset:22528
s_waitcnt lgkmcnt(8)
v_mfma_f32_16x16x32_bf16 v[64:67], v[136:139], v[104:107], v[64:67]
ds_read_b128 v[156:159], v31 offset:30720
s_waitcnt lgkmcnt(8)
v_mfma_f32_16x16x32_bf16 v[68:71], v[140:143], v[104:107], v[68:71]
ds_read_b64_tr_b16 v[92:93], v26 offset:0
ds_read_b64_tr_b16 v[94:95], v26 offset:256
s_waitcnt lgkmcnt(8)
v_mfma_f32_16x16x32_bf16 v[72:75], v[128:131], v[108:111], v[72:75]
v_mfma_f32_16x16x32_bf16 v[76:79], v[132:135], v[108:111], v[76:79]
v_mfma_f32_16x16x32_bf16 v[80:83], v[136:139], v[108:111], v[80:83]
v_mfma_f32_16x16x32_bf16 v[84:87], v[140:143], v[108:111], v[84:87]
ds_read_b128 v[160:163], v32 offset:7168
s_waitcnt vmcnt(0)
ds_read_b64_tr_b16 v[96:97], v25 offset:2048
ds_read_b64_tr_b16 v[98:99], v25 offset:2304
s_waitcnt lgkmcnt(8)
v_mfma_f32_16x16x32_bf16 v[56:59], v[144:147], v[88:91], v[56:59]
ds_read_b128 v[164:167], v32 offset:15360
s_waitcnt lgkmcnt(8)
v_mfma_f32_16x16x32_bf16 v[60:63], v[148:151], v[88:91], v[60:63]
ds_read_b128 v[168:171], v32 offset:23552
s_waitcnt lgkmcnt(8)
v_mfma_f32_16x16x32_bf16 v[64:67], v[152:155], v[88:91], v[64:67]
ds_read_b128 v[172:175], v32 offset:31744
s_waitcnt lgkmcnt(8)
v_mfma_f32_16x16x32_bf16 v[68:71], v[156:159], v[88:91], v[68:71]
ds_read_b64_tr_b16 v[100:101], v26 offset:2048
ds_read_b64_tr_b16 v[102:103], v26 offset:2304
s_waitcnt lgkmcnt(8)
v_mfma_f32_16x16x32_bf16 v[72:75], v[144:147], v[92:95], v[72:75]
v_mfma_f32_16x16x32_bf16 v[76:79], v[148:151], v[92:95], v[76:79]
v_mfma_f32_16x16x32_bf16 v[80:83], v[152:155], v[92:95], v[80:83]
v_mfma_f32_16x16x32_bf16 v[84:87], v[156:159], v[92:95], v[84:87]
s_waitcnt lgkmcnt(5)
v_mfma_f32_16x16x32_bf16 v[56:59], v[160:163], v[96:99], v[56:59]
s_waitcnt lgkmcnt(4)
v_mfma_f32_16x16x32_bf16 v[60:63], v[164:167], v[96:99], v[60:63]
s_waitcnt lgkmcnt(3)
v_mfma_f32_16x16x32_bf16 v[64:67], v[168:171], v[96:99], v[64:67]
s_waitcnt lgkmcnt(2)
v_mfma_f32_16x16x32_bf16 v[68:71], v[172:175], v[96:99], v[68:71]
s_waitcnt lgkmcnt(0)
v_mfma_f32_16x16x32_bf16 v[72:75], v[160:163], v[100:103], v[72:75]
v_cvt_pk_bf16_f32 v56, v56, v57
v_cvt_pk_bf16_f32 v57, v58, v59
v_cvt_pk_bf16_f32 v58, v60, v61
v_cvt_pk_bf16_f32 v59, v62, v63
buffer_store_dwordx4 v[56:59], v16, s[52:55], s82 offen offset:0 sc1
v_mfma_f32_16x16x32_bf16 v[76:79], v[164:167], v[100:103], v[76:79]
v_mfma_f32_16x16x32_bf16 v[80:83], v[168:171], v[100:103], v[80:83]
v_cvt_pk_bf16_f32 v64, v64, v65
v_cvt_pk_bf16_f32 v65, v66, v67
v_cvt_pk_bf16_f32 v66, v68, v69
v_cvt_pk_bf16_f32 v67, v70, v71
buffer_store_dwordx4 v[64:67], v16, s[52:55], s82 offen offset:2048 sc1
v_mfma_f32_16x16x32_bf16 v[84:87], v[172:175], v[100:103], v[84:87]
v_cvt_pk_bf16_f32 v72, v72, v73
v_cvt_pk_bf16_f32 v73, v74, v75
v_cvt_pk_bf16_f32 v74, v76, v77
v_cvt_pk_bf16_f32 v75, v78, v79
buffer_store_dwordx4 v[72:75], v16, s[52:55], s82 offen offset:1024 sc1
v_cvt_pk_bf16_f32 v80, v80, v81
v_cvt_pk_bf16_f32 v81, v82, v83
s_nop 0
v_cvt_pk_bf16_f32 v82, v84, v85
v_cvt_pk_bf16_f32 v83, v86, v87
buffer_store_dwordx4 v[80:83], v16, s[52:55], s82 offen offset:3072 sc1
s_branch L1_fin
L1_edge:
s_mov_b32 s61, 4
s_mov_b32 s4, s2
s_mul_i32 s6, s4, 20000
v_lshlrev_b32 v5, 4, v0
v_lshlrev_b32 v6, 2, v2
v_add_u32 v6, 0x10000, v6
v_mov_b32 v7, 0
ds_write_b32 v6, v7
s_mov_b32 s66, 0
s_mov_b32 s67, 8192
s_mov_b32 s68, 16384
s_waitcnt lgkmcnt(0)
s_add_u32 s40, s20, 0x0
s_addc_u32 s41, s21, 0
s_add_u32 s40, s40, s6
s_addc_u32 s41, s41, 0
s_mov_b32 s42, 0x4e20
s_mov_b32 s43, 0x00020000
s_add_u32 s44, s18, 0x0
s_addc_u32 s45, s19, 0
s_add_u32 s44, s44, s6
s_addc_u32 s45, s45, 0
s_mov_b32 s46, 0x4e20
s_mov_b32 s47, 0x00020000
buffer_load_dwordx4 v[16:19], v5, s[40:43], s66 offen
buffer_load_dwordx4 v[20:23], v5, s[40:43], s67 offen
buffer_load_dwordx4 v[24:27], v5, s[40:43], s68 offen
buffer_load_dwordx4 v[28:31], v5, s[44:47], s66 offen
buffer_load_dwordx4 v[32:35], v5, s[44:47], s67 offen
buffer_load_dwordx4 v[36:39], v5, s[44:47], s68 offen
s_add_u32 s48, s38, 0x8000000
s_addc_u32 s49, s39, 0
s_mov_b32 s50, 0x2800000
s_mov_b32 s51, 0x00020000
s_add_u32 s52, s38, 0x7800000
s_addc_u32 s53, s39, 0
s_mov_b32 s54, 0x2000
s_mov_b32 s55, 0x00020000
s_mov_b32 s9, 6679
s_mov_b32 s10, 4294967139
s_mov_b32 s11, 0x10000
v_mov_b32 v7, 1
v_cmp_gt_u32 vcc, 0xe2, v0
s_mov_b64 s[12:13], vcc
s_barrier
s_waitcnt vmcnt(5)
v_mul_u32_u24 v40, s9, v16
v_lshrrev_b32 v40, 20, v40
v_lshl_add_u32 v52, v40, 2, s11
ds_add_rtn_u32 v52, v52, v7
v_mad_i32_i24 v16, v40, s10, v16
v_mul_u32_u24 v41, s9, v17
v_lshrrev_b32 v41, 20, v41
v_lshl_add_u32 v53, v41, 2, s11
ds_add_rtn_u32 v53, v53, v7
v_mad_i32_i24 v17, v41, s10, v17
v_mul_u32_u24 v42, s9, v18
v_lshrrev_b32 v42, 20, v42
v_lshl_add_u32 v54, v42, 2, s11
ds_add_rtn_u32 v54, v54, v7
v_mad_i32_i24 v18, v42, s10, v18
v_mul_u32_u24 v43, s9, v19
v_lshrrev_b32 v43, 20, v43
v_lshl_add_u32 v55, v43, 2, s11
ds_add_rtn_u32 v55, v55, v7
v_mad_i32_i24 v19, v43, s10, v19
s_waitcnt vmcnt(4)
v_mul_u32_u24 v44, s9, v20
v_lshrrev_b32 v44, 20, v44
v_lshl_add_u32 v56, v44, 2, s11
ds_add_rtn_u32 v56, v56, v7
v_mad_i32_i24 v20, v44, s10, v20
v_mul_u32_u24 v45, s9, v21
v_lshrrev_b32 v45, 20, v45
v_lshl_add_u32 v57, v45, 2, s11
ds_add_rtn_u32 v57, v57, v7
v_mad_i32_i24 v21, v45, s10, v21
v_mul_u32_u24 v46, s9, v22
v_lshrrev_b32 v46, 20, v46
v_lshl_add_u32 v58, v46, 2, s11
ds_add_rtn_u32 v58, v58, v7
v_mad_i32_i24 v22, v46, s10, v22
v_mul_u32_u24 v47, s9, v23
v_lshrrev_b32 v47, 20, v47
v_lshl_add_u32 v59, v47, 2, s11
ds_add_rtn_u32 v59, v59, v7
v_mad_i32_i24 v23, v47, s10, v23
s_waitcnt vmcnt(3)
s_mov_b64 exec, s[12:13]
v_mul_u32_u24 v48, s9, v24
v_lshrrev_b32 v48, 20, v48
v_lshl_add_u32 v60, v48, 2, s11
ds_add_rtn_u32 v60, v60, v7
v_mad_i32_i24 v24, v48, s10, v24
v_mul_u32_u24 v49, s9, v25
v_lshrrev_b32 v49, 20, v49
v_lshl_add_u32 v61, v49, 2, s11
ds_add_rtn_u32 v61, v61, v7
v_mad_i32_i24 v25, v49, s10, v25
v_mul_u32_u24 v50, s9, v26
v_lshrrev_b32 v50, 20, v50
v_lshl_add_u32 v62, v50, 2, s11
ds_add_rtn_u32 v62, v62, v7
v_mad_i32_i24 v26, v50, s10, v26
v_mul_u32_u24 v51, s9, v27
v_lshrrev_b32 v51, 20, v51
v_lshl_add_u32 v63, v51, 2, s11
ds_add_rtn_u32 v63, v63, v7
v_mad_i32_i24 v27, v51, s10, v27
s_mov_b64 exec, -1
s_waitcnt vmcnt(2) lgkmcnt(4)
v_and_b32 v8, 0x7f, v52
v_lshl_or_b32 v28, v16, 18, v28
v_lshlrev_b32 v8, 2, v8
v_lshl_add_u32 v8, v40, 9, v8
ds_write_b32 v8, v28
v_and_b32 v8, 0x7f, v53
v_lshl_or_b32 v29, v17, 18, v29
v_lshlrev_b32 v8, 2, v8
v_lshl_add_u32 v8, v41, 9, v8
ds_write_b32 v8, v29
v_and_b32 v8, 0x7f, v54
v_lshl_or_b32 v30, v18, 18, v30
v_lshlrev_b32 v8, 2, v8
v_lshl_add_u32 v8, v42, 9, v8
ds_write_b32 v8, v30
v_and_b32 v8, 0x7f, v55
v_lshl_or_b32 v31, v19, 18, v31
v_lshlrev_b32 v8, 2, v8
v_lshl_add_u32 v8, v43, 9, v8
ds_write_b32 v8, v31
s_waitcnt vmcnt(1) lgkmcnt(4)
v_and_b32 v8, 0x7f, v56
v_lshl_or_b32 v32, v20, 18, v32
v_lshlrev_b32 v8, 2, v8
v_lshl_add_u32 v8, v44, 9, v8
ds_write_b32 v8, v32
v_and_b32 v8, 0x7f, v57
v_lshl_or_b32 v33, v21, 18, v33
v_lshlrev_b32 v8, 2, v8
v_lshl_add_u32 v8, v45, 9, v8
ds_write_b32 v8, v33
v_and_b32 v8, 0x7f, v58
v_lshl_or_b32 v34, v22, 18, v34
v_lshlrev_b32 v8, 2, v8
v_lshl_add_u32 v8, v46, 9, v8
ds_write_b32 v8, v34
v_and_b32 v8, 0x7f, v59
v_lshl_or_b32 v35, v23, 18, v35
v_lshlrev_b32 v8, 2, v8
v_lshl_add_u32 v8, v47, 9, v8
ds_write_b32 v8, v35
s_waitcnt vmcnt(0) lgkmcnt(8)
s_mov_b64 exec, s[12:13]
v_and_b32 v8, 0x7f, v60
v_lshl_or_b32 v36, v24, 18, v36
v_lshlrev_b32 v8, 2, v8
v_lshl_add_u32 v8, v48, 9, v8
ds_write_b32 v8, v36
v_and_b32 v8, 0x7f, v61
v_lshl_or_b32 v37, v25, 18, v37
v_lshlrev_b32 v8, 2, v8
v_lshl_add_u32 v8, v49, 9, v8
ds_write_b32 v8, v37
v_and_b32 v8, 0x7f, v62
v_lshl_or_b32 v38, v26, 18, v38
v_lshlrev_b32 v8, 2, v8
v_lshl_add_u32 v8, v50, 9, v8
ds_write_b32 v8, v38
v_and_b32 v8, 0x7f, v63
v_lshl_or_b32 v39, v27, 18, v39
v_lshlrev_b32 v8, 2, v8
v_lshl_add_u32 v8, v51, 9, v8
ds_write_b32 v8, v39
s_mov_b64 exec, -1
s_waitcnt lgkmcnt(0)
s_barrier
s_add_u32 s40, s38, 0x7c00000
s_addc_u32 s41, s39, 0
s_mov_b32 s42, 0x40000
s_mov_b32 s43, 0x00020000
v_lshlrev_b32 v13, 7, v2
v_mov_b32 v12, 0
s_mul_i32 s6, s4, 8192
s_cmp_eq_u32 s60, 1
s_cselect_b32 s6, s6, 0x7fff0000
buffer_store_dword v12, v13, s[40:43], s6 offen sc1
ds_read_b32 v8, v6
s_mul_i32 s6, s60, 4096
v_lshlrev_b32 v10, 4, v2
v_add_u32 v9, s6, v10
ds_read_b128 v[64:67], v9 offset:0
ds_read_b128 v[68:71], v9 offset:1024
ds_read_b128 v[72:75], v9 offset:2048
ds_read_b128 v[76:79], v9 offset:3072
v_lshrrev_b32 v11, 5, v2
v_mul_u32_u24 v11, 0x9fe00, v11
v_add_u32 v10, v10, v11
s_mul_i32 s6, s60, 5242880
s_mul_i32 s7, s4, 20480
s_add_u32 s6, s6, s7
v_lshlrev_b32 v9, 7, v2
s_lshl_b32 s8, s4, 2
s_cmp_eq_u32 s60, 0
s_cselect_b32 s8, s8, 0x7fff0000
s_waitcnt lgkmcnt(4)
buffer_store_dword v8, v9, s[52:55], s8 offen
v_cmp_lt_u32 vcc, 0x80, v8
s_cbranch_vccnz L1_eslow
s_waitcnt lgkmcnt(3)
buffer_store_dwordx4 v[64:67], v10, s[48:51], s6 offen
s_add_u32 s6, s6, 1310720
s_waitcnt lgkmcnt(2)
buffer_store_dwordx4 v[68:71], v10, s[48:51], s6 offen
s_add_u32 s6, s6, 1310720
s_waitcnt lgkmcnt(1)
buffer_store_dwordx4 v[72:75], v10, s[48:51], s6 offen
s_add_u32 s6, s6, 1310720
s_waitcnt lgkmcnt(0)
buffer_store_dwordx4 v[76:79], v10, s[48:51], s6 offen
s_add_u32 s6, s6, 1310720
s_branch L1_fin
L1_eslow:
s_mov_b32 s9, 655360
v_mul_u32_u24 v40, s9, v40
v_lshl_add_u32 v40, v52, 2, v40
v_mul_u32_u24 v41, s9, v41
v_lshl_add_u32 v41, v53, 2, v41
v_mul_u32_u24 v42, s9, v42
v_lshl_add_u32 v42, v54, 2, v42
v_mul_u32_u24 v43, s9, v43
v_lshl_add_u32 v43, v55, 2, v43
v_mul_u32_u24 v44, s9, v44
v_lshl_add_u32 v44, v56, 2, v44
v_mul_u32_u24 v45, s9, v45
v_lshl_add_u32 v45, v57, 2, v45
v_mul_u32_u24 v46, s9, v46
v_lshl_add_u32 v46, v58, 2, v46
v_mul_u32_u24 v47, s9, v47
v_lshl_add_u32 v47, v59, 2, v47
v_mul_u32_u24 v48, s9, v48
v_lshl_add_u32 v48, v60, 2, v48
v_mul_u32_u24 v49, s9, v49
v_lshl_add_u32 v49, v61, 2, v49
v_mul_u32_u24 v50, s9, v50
v_lshl_add_u32 v50, v62, 2, v50
v_mul_u32_u24 v51, s9, v51
v_lshl_add_u32 v51, v63, 2, v51
buffer_store_dword v28, v40, s[48:51], s7 offen
buffer_store_dword v29, v41, s[48:51], s7 offen
buffer_store_dword v30, v42, s[48:51], s7 offen
buffer_store_dword v31, v43, s[48:51], s7 offen
buffer_store_dword v32, v44, s[48:51], s7 offen
buffer_store_dword v33, v45, s[48:51], s7 offen
buffer_store_dword v34, v46, s[48:51], s7 offen
buffer_store_dword v35, v47, s[48:51], s7 offen
s_mov_b64 exec, s[12:13]
buffer_store_dword v36, v48, s[48:51], s7 offen
buffer_store_dword v37, v49, s[48:51], s7 offen
buffer_store_dword v38, v50, s[48:51], s7 offen
buffer_store_dword v39, v51, s[48:51], s7 offen
s_mov_b64 exec, -1
L1_fin:
L1_end:
s_endpgm
.globl k2_kernel
.p2align 8
.type k2_kernel,@function
k2_kernel:
s_load_dwordx2 s[4:5], s[0:1], 88
s_load_dwordx2 s[60:61], s[0:1], 0
s_load_dwordx2 s[52:53], s[0:1], 24
s_load_dwordx2 s[56:57], s[0:1], 72
s_and_b32 s35, s2, 7
s_lshr_b32 s37, s2, 3
s_cmp_ge_u32 s37, 30
s_cbranch_scc1 LE_start
s_mul_i32 s38, s37, 26
s_lshr_b32 s38, s38, 8
s_mul_i32 s39, s38, 10
s_sub_u32 s39, s37, s39
s_and_b32 s37, s35, 1
s_mul_i32 s37, s37, 3
s_add_u32 s37, s37, s38
s_lshr_b32 s38, s35, 1
s_mul_i32 s38, s38, 10
s_add_u32 s38, s38, s39
v_lshrrev_b32 v1, 6, v0
v_and_b32 v248, 63, v0
v_lshlrev_b32 v248, 4, v248
v_readfirstlane_b32 s34, v1
s_mov_b32 s50, 0xe1a06800
s_mov_b32 s51, 0x4e20ad04
s_mul_i32 s39, s37, 9
s_lshr_b64 s[50:51], s[50:51], s39
s_and_b32 s39, s50, 0x1ff
s_bfe_u32 s49, s50, 0x90009
s_sub_u32 s31, s49, s39
s_sub_u32 s31, s31, 5
s_lshl_b32 s39, s39, 14
s_lshl_b32 s49, s49, 14
s_add_u32 s28, s39, 0x4000
s_cmp_eq_u32 s37, 5
s_addc_u32 s31, s31, 0
s_cmp_eq_u32 s37, 5
s_cselect_b32 s28, s39, s28
s_cselect_b32 s39, 5111808, s39
s_cselect_b32 s49, 5128192, s49
s_cselect_b32 s33, 0xff800000, 0
s_mov_b32 s32, 0x5d800000
v_and_b32 v2, 63, v0
v_bfe_u32 v3, v2, 3, 2
v_bfe_u32 v4, v2, 2, 1
v_lshlrev_b32 v241, 12, v3
v_lshl_or_b32 v241, v4, 9, v241
v_lshl_or_b32 v241, v1, 7, v241
v_lshrrev_b32 v4, 5, v2
v_lshl_or_b32 v241, v4, 6, v241
v_and_b32 v3, 2, v3
v_and_b32 v4, 3, v2
v_xor_b32 v3, v3, v4
v_lshl_or_b32 v241, v3, 4, v241
s_cmp_eq_u32 s38, 39
s_cbranch_scc1 LT_disp
s_lshl_b32 s30, s34, 12
s_lshl_b32 s50, s34, 13
s_add_u32 s50, s50, 0x20000
s_mov_b32 m0, s30
s_mov_b32 s6, 0x92c51840
s_mov_b32 s7, 0xfb73ea6d
s_mul_i32 s3, s37, 12
s_min_u32 s3, s3, 56
s_lshr_b64 s[6:7], s[6:7], s3
s_bfe_u32 s29, s6, 0x40008
s_bfe_u32 s7, s6, 0x40004
s_and_b32 s6, s6, 15
s_cmp_lt_u32 s37, 4
s_cselect_b32 s29, s29, 16
s_mov_b32 s94, 0
s_mov_b32 s95, 0
s_lshr_b32 s3, s6, 2
s_cmp_eq_u32 s3, s34
s_cselect_b32 s94, s6, s94
s_cselect_b32 s95, 1, s95
s_lshr_b32 s3, s7, 2
s_cmp_eq_u32 s3, s34
s_cselect_b32 s94, s7, s94
s_cselect_b32 s95, 1, s95
s_lshr_b32 s3, s29, 2
s_cmp_eq_u32 s3, s34
s_cselect_b32 s94, s29, s94
s_cselect_b32 s95, 1, s95
s_and_b32 s94, s94, 3
s_lshl_b32 s3, s38, 17
s_lshl_b32 s51, s34, 7
s_add_u32 s3, s3, s51
s_lshl_b32 s6, s6, 13
s_add_u32 s6, s6, s3
s_lshl_b32 s7, s7, 13
s_add_u32 s7, s7, s3
s_lshl_b32 s29, s29, 13
s_add_u32 s29, s29, s3
s_mov_b64 s[96:97], 0
s_lshr_b32 s3, s6, 9
s_mul_i32 s3, s3, 6679
s_lshr_b32 s3, s3, 20
s_bitset1_b64 s[96:97], s3
s_lshr_b32 s3, s6, 9
s_add_u32 s3, s3, 15
s_mul_i32 s3, s3, 6679
s_lshr_b32 s3, s3, 20
s_bitset1_b64 s[96:97], s3
s_lshr_b32 s3, s7, 9
s_mul_i32 s3, s3, 6679
s_lshr_b32 s3, s3, 20
s_bitset1_b64 s[96:97], s3
s_lshr_b32 s3, s7, 9
s_add_u32 s3, s3, 15
s_mul_i32 s3, s3, 6679
s_lshr_b32 s3, s3, 20
s_bitset1_b64 s[96:97], s3
s_lshr_b32 s3, s29, 9
s_mul_i32 s3, s3, 6679
s_lshr_b32 s3, s3, 20
s_bitset1_b64 s[96:97], s3
s_lshr_b32 s3, s29, 9
s_add_u32 s3, s3, 15
s_mul_i32 s3, s3, 6679
s_lshr_b32 s3, s3, 20
s_bitset1_b64 s[96:97], s3
s_mul_i32 s3, s38, 6
s_add_u32 s3, s3, s37
s_cmp_eq_u32 s3, 233
s_cselect_b32 s3, 0, s37
s_cmp_lt_u32 s3, 4
s_cselect_b32 s29, s29, 0x70000000
s_lshl_b32 s51, s38, 5
s_lshl_b32 s3, s34, 3
s_add_u32 s51, s51, s3
s_add_u32 s51, s51, s37
s_mul_i32 s51, s51, 128
s_add_u32 s51, s51, 0x7c00000
s_waitcnt lgkmcnt(0)
s_add_u32 s12, s4, 0x6800000
s_addc_u32 s13, s5, 0
s_mov_b32 s14, 0x0
s_mov_b32 s15, 0x00020000
s_mov_b32 s14, s49
buffer_load_dwordx4 v241, s[12:15], s39 offen offset:0 lds
buffer_load_dwordx4 v241, s[12:15], s39 offen offset:1024 lds
buffer_load_dwordx4 v241, s[12:15], s39 offen offset:2048 lds
buffer_load_dwordx4 v241, s[12:15], s39 offen offset:3072 lds
s_add_u32 m0, s30, 0x4000
s_add_u32 s8, s4, 0x0
s_addc_u32 s9, s5, 0
s_mov_b32 s10, 0x4e4000
s_mov_b32 s11, 0x00020000
buffer_load_dwordx4 v241, s[12:15], s28 offen offset:0 lds
buffer_load_dwordx4 v241, s[12:15], s28 offen offset:1024 lds
s_mul_i32 s35, s37, 0x600000
s_add_u32 s20, s4, 0x2000000
s_addc_u32 s21, s5, 0
s_add_u32 s20, s20, s35
s_addc_u32 s21, s21, 0
s_mov_b32 s22, 0x4e4000
s_mov_b32 s23, 0x00020000
s_add_u32 s24, s4, 0x6000000
s_addc_u32 s25, s5, 0
s_mov_b32 s26, 0x139000
s_mov_b32 s27, 0x00020000
s_lshl_b32 s35, s38, 4
s_lshl_b32 s41, s34, 2
s_add_u32 s35, s35, s41
s_lshl_b32 s40, s35, 13
s_lshl_b32 s94, s94, 13
s_add_u32 s40, s40, s94
s_xor_b32 s41, s40, 8192
s_xor_b32 s42, s40, 16384
s_xor_b32 s43, s40, 24576
s_add_u32 s44, s40, 4096
s_add_u32 s45, s41, 4096
s_add_u32 s46, s42, 4096
s_add_u32 s47, s43, 4096
s_lshl_b32 s48, s35, 10
s_lshl_b32 s35, s37, 3
s_add_u32 s48, s48, s35
v_mov_b32 v232, 0
v_mov_b32 v233, 0
v_mov_b32 v234, 0
v_mov_b32 v235, 0
buffer_load_dwordx4 v[0:3], v248, s[8:11], s40 offen offset:0
buffer_load_dwordx4 v[32:35], v248, s[8:11], s41 offen offset:0
v_mfma_f32_32x32x16_bf16 a[0:15], v[232:235], v[232:235], 0
buffer_load_dwordx4 v[64:67], v248, s[8:11], s42 offen offset:0
buffer_load_dwordx4 v[96:99], v248, s[8:11], s43 offen offset:0
v_mfma_f32_32x32x16_bf16 a[16:31], v[232:235], v[232:235], 0
buffer_load_dwordx4 v[4:7], v248, s[8:11], s40 offen offset:1024
buffer_load_dwordx4 v[36:39], v248, s[8:11], s41 offen offset:1024
v_mfma_f32_32x32x16_bf16 a[32:47], v[232:235], v[232:235], 0
buffer_load_dwordx4 v[68:71], v248, s[8:11], s42 offen offset:1024
buffer_load_dwordx4 v[100:103], v248, s[8:11], s43 offen offset:1024
v_mfma_f32_32x32x16_bf16 a[48:63], v[232:235], v[232:235], 0
buffer_load_dwordx4 v[8:11], v248, s[8:11], s40 offen offset:2048
buffer_load_dwordx4 v[40:43], v248, s[8:11], s41 offen offset:2048
v_mfma_f32_32x32x16_bf16 a[64:79], v[232:235], v[232:235], 0
buffer_load_dwordx4 v[72:75], v248, s[8:11], s42 offen offset:2048
buffer_load_dwordx4 v[104:107], v248, s[8:11], s43 offen offset:2048
v_mfma_f32_32x32x16_bf16 a[80:95], v[232:235], v[232:235], 0
buffer_load_dwordx4 v[12:15], v248, s[8:11], s40 offen offset:3072
buffer_load_dwordx4 v[44:47], v248, s[8:11], s41 offen offset:3072
v_mfma_f32_32x32x16_bf16 a[96:111], v[232:235], v[232:235], 0
buffer_load_dwordx4 v[76:79], v248, s[8:11], s42 offen offset:3072
buffer_load_dwordx4 v[108:111], v248, s[8:11], s43 offen offset:3072
v_mfma_f32_32x32x16_bf16 a[112:127], v[232:235], v[232:235], 0
buffer_load_dwordx4 v[16:19], v248, s[8:11], s44 offen offset:0
buffer_load_dwordx4 v[48:51], v248, s[8:11], s45 offen offset:0
v_mfma_f32_32x32x16_bf16 a[128:143], v[232:235], v[232:235], 0
buffer_load_dwordx4 v[80:83], v248, s[8:11], s46 offen offset:0
buffer_load_dwordx4 v[112:115], v248, s[8:11], s47 offen offset:0
v_mfma_f32_32x32x16_bf16 a[144:159], v[232:235], v[232:235], 0
buffer_load_dwordx4 v[20:23], v248, s[8:11], s44 offen offset:1024
buffer_load_dwordx4 v[52:55], v248, s[8:11], s45 offen offset:1024
v_mfma_f32_32x32x16_bf16 a[160:175], v[232:235], v[232:235], 0
buffer_load_dwordx4 v[84:87], v248, s[8:11], s46 offen offset:1024
buffer_load_dwordx4 v[116:119], v248, s[8:11], s47 offen offset:1024
v_mfma_f32_32x32x16_bf16 a[176:191], v[232:235], v[232:235], 0
buffer_load_dwordx4 v[24:27], v248, s[8:11], s44 offen offset:2048
buffer_load_dwordx4 v[56:59], v248, s[8:11], s45 offen offset:2048
v_mfma_f32_32x32x16_bf16 a[192:207], v[232:235], v[232:235], 0
buffer_load_dwordx4 v[88:91], v248, s[8:11], s46 offen offset:2048
buffer_load_dwordx4 v[120:123], v248, s[8:11], s47 offen offset:2048
v_mfma_f32_32x32x16_bf16 a[208:223], v[232:235], v[232:235], 0
buffer_load_dwordx4 v[28:31], v248, s[8:11], s44 offen offset:3072
buffer_load_dwordx4 v[60:63], v248, s[8:11], s45 offen offset:3072
v_mfma_f32_32x32x16_bf16 a[224:239], v[232:235], v[232:235], 0
buffer_load_dwordx4 v[92:95], v248, s[8:11], s46 offen offset:3072
buffer_load_dwordx4 v[124:127], v248, s[8:11], s47 offen offset:3072
v_mfma_f32_32x32x16_bf16 a[240:255], v[232:235], v[232:235], 0
s_add_u32 s16, s4, 0x0
s_addc_u32 s17, s5, 0
s_mov_b32 s18, 0x10000000
s_mov_b32 s19, 0x00020000
s_add_u32 s8, s60, 0x0
s_addc_u32 s9, s61, 0
s_mov_b32 s10, 0x4e2000
s_mov_b32 s11, 0x00020000
s_mov_b32 s54, 0x4e20
s_mov_b32 s55, 0x00020000
s_mov_b32 s58, 0x4e2000
s_mov_b32 s59, 0x00020000
s_lshr_b32 s48, s40, 2
s_cmp_eq_u32 s95, 1
s_cselect_b32 s40, 0x70000000, s40
s_cselect_b32 s44, 0x70000000, s44
v_bfe_u32 v240, v248, 4, 3
v_lshlrev_b32 v240, 6, v240
v_bfe_u32 v242, v248, 7, 1
v_lshl_or_b32 v240, v242, 10, v240
v_bfe_u32 v242, v248, 8, 2
v_lshl_or_b32 v240, v242, 4, v240
v_bfe_u32 v242, v248, 6, 1
v_lshlrev_b32 v242, 5, v242
v_xor_b32 v240, v240, v242
v_and_b32 v249, 0x1c0, v248
v_bfe_u32 v242, v248, 9, 1
v_lshl_or_b32 v249, v242, 10, v249
v_bfe_u32 v242, v248, 8, 1
v_lshl_or_b32 v249, v242, 5, v249
v_bfe_u32 v242, v248, 4, 2
v_lshl_or_b32 v249, v242, 3, v249
v_xor_b32 v250, 32, v249
v_bfe_i32 v242, v248, 8, 1
v_and_b32 v192, s33, v242
v_and_b32 v193, s33, v242
v_and_b32 v194, s33, v242
v_and_b32 v195, s33, v242
s_waitcnt vmcnt(32)
s_barrier
ds_read_b128 v[208:211], v240 offset:0
ds_read_b128 v[212:215], v240 offset:2048
ds_read_b128 v[216:219], v240 offset:16384
ds_read_b128 v[220:223], v240 offset:512
s_waitcnt lgkmcnt(3)
s_waitcnt vmcnt(28)
v_mfma_f32_16x16x32_bf16 v[128:131], v[208:211], v[0:3], v[192:195]
v_mfma_f32_16x16x32_bf16 v[132:135], v[208:211], v[32:35], v[192:195]
buffer_load_dwordx4 v241, s[12:15], s28 offen offset:2048 lds
v_mfma_f32_16x16x32_bf16 v[136:139], v[208:211], v[64:67], v[192:195]
v_mfma_f32_16x16x32_bf16 v[140:143], v[208:211], v[96:99], v[192:195]
ds_read_b128 v[208:211], v240 offset:2560
s_waitcnt lgkmcnt(3)
buffer_load_dwordx4 v241, s[12:15], s28 offen offset:3072 lds
v_mfma_f32_16x16x32_bf16 v[144:147], v[212:215], v[0:3], v[192:195]
v_mfma_f32_16x16x32_bf16 v[148:151], v[212:215], v[32:35], v[192:195]
v_mfma_f32_16x16x32_bf16 v[152:155], v[212:215], v[64:67], v[192:195]
v_mfma_f32_16x16x32_bf16 v[156:159], v[212:215], v[96:99], v[192:195]
ds_read_b128 v[212:215], v240 offset:16896
s_waitcnt lgkmcnt(3)
v_mfma_f32_16x16x32_bf16 v[176:179], v[216:219], v[0:3], 0
v_mfma_f32_16x16x32_bf16 v[180:183], v[216:219], v[32:35], 0
v_mfma_f32_16x16x32_bf16 v[184:187], v[216:219], v[64:67], 0
v_mfma_f32_16x16x32_bf16 v[188:191], v[216:219], v[96:99], 0
ds_read_b128 v[216:219], v240 offset:4096
s_waitcnt lgkmcnt(3)
s_waitcnt vmcnt(26)
v_mfma_f32_16x16x32_bf16 v[128:131], v[220:223], v[4:7], v[128:131]
v_mfma_f32_16x16x32_bf16 v[132:135], v[220:223], v[36:39], v[132:135]
s_add_u32 s28, s28, 0x4000
s_add_u32 m0, s30, 0x8000
s_nop 0
v_mfma_f32_16x16x32_bf16 v[136:139], v[220:223], v[68:71], v[136:139]
v_mfma_f32_16x16x32_bf16 v[140:143], v[220:223], v[100:103], v[140:143]
ds_read_b128 v[220:223], v240 offset:6144
s_waitcnt lgkmcnt(3)
buffer_load_dwordx4 v241, s[12:15], s28 offen offset:0 lds
v_mfma_f32_16x16x32_bf16 v[144:147], v[208:211], v[4:7], v[144:147]
v_mfma_f32_16x16x32_bf16 v[148:151], v[208:211], v[36:39], v[148:151]
buffer_load_dwordx4 v241, s[12:15], s28 offen offset:1024 lds
v_mfma_f32_16x16x32_bf16 v[152:155], v[208:211], v[68:71], v[152:155]
v_mfma_f32_16x16x32_bf16 v[156:159], v[208:211], v[100:103], v[156:159]
ds_read_b128 v[208:211], v240 offset:20480
s_waitcnt lgkmcnt(3)
v_mfma_f32_16x16x32_bf16 v[176:179], v[212:215], v[4:7], v[176:179]
v_mfma_f32_16x16x32_bf16 v[180:183], v[212:215], v[36:39], v[180:183]
v_mfma_f32_16x16x32_bf16 v[184:187], v[212:215], v[68:71], v[184:187]
v_mfma_f32_16x16x32_bf16 v[188:191], v[212:215], v[100:103], v[188:191]
ds_read_b128 v[212:215], v240 offset:4608
s_waitcnt lgkmcnt(3)
s_waitcnt vmcnt(24)
v_mfma_f32_16x16x32_bf16 v[128:131], v[216:219], v[8:11], v[128:131]
v_mfma_f32_16x16x32_bf16 v[132:135], v[216:219], v[40:43], v[132:135]
buffer_load_dwordx4 v241, s[12:15], s28 offen offset:2048 lds
v_mfma_f32_16x16x32_bf16 v[136:139], v[216:219], v[72:75], v[136:139]
v_mfma_f32_16x16x32_bf16 v[140:143], v[216:219], v[104:107], v[140:143]
ds_read_b128 v[216:219], v240 offset:6656
s_waitcnt lgkmcnt(3)
buffer_load_dwordx4 v241, s[12:15], s28 offen offset:3072 lds
v_mfma_f32_16x16x32_bf16 v[144:147], v[220:223], v[8:11], v[144:147]
v_mfma_f32_16x16x32_bf16 v[148:151], v[220:223], v[40:43], v[148:151]
v_mfma_f32_16x16x32_bf16 v[152:155], v[220:223], v[72:75], v[152:155]
v_mfma_f32_16x16x32_bf16 v[156:159], v[220:223], v[104:107], v[156:159]
ds_read_b128 v[220:223], v240 offset:20992
s_waitcnt lgkmcnt(3)
v_mfma_f32_16x16x32_bf16 v[176:179], v[208:211], v[8:11], v[176:179]
v_mfma_f32_16x16x32_bf16 v[180:183], v[208:211], v[40:43], v[180:183]
v_mfma_f32_16x16x32_bf16 v[184:187], v[208:211], v[72:75], v[184:187]
v_mfma_f32_16x16x32_bf16 v[188:191], v[208:211], v[104:107], v[188:191]
ds_read_b128 v[208:211], v240 offset:8192
s_waitcnt lgkmcnt(3)
s_waitcnt vmcnt(22)
v_mfma_f32_16x16x32_bf16 v[128:131], v[212:215], v[12:15], v[128:131]
v_mfma_f32_16x16x32_bf16 v[132:135], v[212:215], v[44:47], v[132:135]
s_add_u32 s28, s28, 0x4000
s_add_u32 s30, s30, 0xc000
v_mfma_f32_16x16x32_bf16 v[136:139], v[212:215], v[76:79], v[136:139]
v_mfma_f32_16x16x32_bf16 v[140:143], v[212:215], v[108:111], v[140:143]
ds_read_b128 v[212:215], v240 offset:10240
s_waitcnt lgkmcnt(3)
v_mfma_f32_16x16x32_bf16 v[144:147], v[216:219], v[12:15], v[144:147]
v_mfma_f32_16x16x32_bf16 v[148:151], v[216:219], v[44:47], v[148:151]
v_mfma_f32_16x16x32_bf16 v[152:155], v[216:219], v[76:79], v[152:155]
v_mfma_f32_16x16x32_bf16 v[156:159], v[216:219], v[108:111], v[156:159]
ds_read_b128 v[216:219], v240 offset:24576
s_waitcnt lgkmcnt(3)
v_mfma_f32_16x16x32_bf16 v[176:179], v[220:223], v[12:15], v[176:179]
v_mfma_f32_16x16x32_bf16 v[180:183], v[220:223], v[44:47], v[180:183]
v_mfma_f32_16x16x32_bf16 v[184:187], v[220:223], v[76:79], v[184:187]
v_mfma_f32_16x16x32_bf16 v[188:191], v[220:223], v[108:111], v[188:191]
ds_read_b128 v[220:223], v240 offset:8704
s_waitcnt lgkmcnt(3)
s_waitcnt vmcnt(18)
v_mfma_f32_16x16x32_bf16 v[128:131], v[208:211], v[16:19], v[128:131]
v_mfma_f32_16x16x32_bf16 v[132:135], v[208:211], v[48:51], v[132:135]
v_mfma_f32_16x16x32_bf16 v[136:139], v[208:211], v[80:83], v[136:139]
v_mfma_f32_16x16x32_bf16 v[140:143], v[208:211], v[112:115], v[140:143]
ds_read_b128 v[208:211], v240 offset:10752
s_waitcnt lgkmcnt(3)
v_mfma_f32_16x16x32_bf16 v[144:147], v[212:215], v[16:19], v[144:147]
v_mfma_f32_16x16x32_bf16 v[148:151], v[212:215], v[48:51], v[148:151]
v_mfma_f32_16x16x32_bf16 v[152:155], v[212:215], v[80:83], v[152:155]
v_mfma_f32_16x16x32_bf16 v[156:159], v[212:215], v[112:115], v[156:159]
ds_read_b128 v[212:215], v240 offset:25088
s_waitcnt lgkmcnt(3)
v_mfma_f32_16x16x32_bf16 v[176:179], v[216:219], v[16:19], v[176:179]
v_mfma_f32_16x16x32_bf16 v[180:183], v[216:219], v[48:51], v[180:183]
v_mfma_f32_16x16x32_bf16 v[184:187], v[216:219], v[80:83], v[184:187]
v_mfma_f32_16x16x32_bf16 v[188:191], v[216:219], v[112:115], v[188:191]
ds_read_b128 v[216:219], v240 offset:12288
s_waitcnt lgkmcnt(3)
s_waitcnt vmcnt(14)
v_mfma_f32_16x16x32_bf16 v[128:131], v[220:223], v[20:23], v[128:131]
v_mfma_f32_16x16x32_bf16 v[132:135], v[220:223], v[52:55], v[132:135]
v_mfma_f32_16x16x32_bf16 v[136:139], v[220:223], v[84:87], v[136:139]
v_mfma_f32_16x16x32_bf16 v[140:143], v[220:223], v[116:119], v[140:143]
ds_read_b128 v[220:223], v240 offset:14336
s_waitcnt lgkmcnt(3)
v_mfma_f32_16x16x32_bf16 v[144:147], v[208:211], v[20:23], v[144:147]
v_mfma_f32_16x16x32_bf16 v[148:151], v[208:211], v[52:55], v[148:151]
v_mfma_f32_16x16x32_bf16 v[152:155], v[208:211], v[84:87], v[152:155]
v_mfma_f32_16x16x32_bf16 v[156:159], v[208:211], v[116:119], v[156:159]
ds_read_b128 v[208:211], v240 offset:28672
s_waitcnt lgkmcnt(3)
v_mfma_f32_16x16x32_bf16 v[176:179], v[212:215], v[20:23], v[176:179]
v_mfma_f32_16x16x32_bf16 v[180:183], v[212:215], v[52:55], v[180:183]
v_mfma_f32_16x16x32_bf16 v[184:187], v[212:215], v[84:87], v[184:187]
v_mfma_f32_16x16x32_bf16 v[188:191], v[212:215], v[116:119], v[188:191]
ds_read_b128 v[212:215], v240 offset:12800
s_waitcnt lgkmcnt(3)
s_waitcnt vmcnt(10)
v_mfma_f32_16x16x32_bf16 v[128:131], v[216:219], v[24:27], v[128:131]
v_mfma_f32_16x16x32_bf16 v[132:135], v[216:219], v[56:59], v[132:135]
v_mfma_f32_16x16x32_bf16 v[136:139], v[216:219], v[88:91], v[136:139]
v_mfma_f32_16x16x32_bf16 v[140:143], v[216:219], v[120:123], v[140:143]
ds_read_b128 v[216:219], v240 offset:14848
s_waitcnt lgkmcnt(3)
v_mfma_f32_16x16x32_bf16 v[144:147], v[220:223], v[24:27], v[144:147]
v_mfma_f32_16x16x32_bf16 v[148:151], v[220:223], v[56:59], v[148:151]
v_mfma_f32_16x16x32_bf16 v[152:155], v[220:223], v[88:91], v[152:155]
v_mfma_f32_16x16x32_bf16 v[156:159], v[220:223], v[120:123], v[156:159]
ds_read_b128 v[220:223], v240 offset:29184
s_waitcnt lgkmcnt(3)
v_mfma_f32_16x16x32_bf16 v[176:179], v[208:211], v[24:27], v[176:179]
v_mfma_f32_16x16x32_bf16 v[180:183], v[208:211], v[56:59], v[180:183]
v_mfma_f32_16x16x32_bf16 v[184:187], v[208:211], v[88:91], v[184:187]
v_mfma_f32_16x16x32_bf16 v[188:191], v[208:211], v[120:123], v[188:191]
s_waitcnt lgkmcnt(2)
s_waitcnt vmcnt(6)
v_mfma_f32_16x16x32_bf16 v[128:131], v[212:215], v[28:31], v[128:131]
v_mfma_f32_16x16x32_bf16 v[132:135], v[212:215], v[60:63], v[132:135]
v_mfma_f32_16x16x32_bf16 v[136:139], v[212:215], v[92:95], v[136:139]
v_mfma_f32_16x16x32_bf16 v[140:143], v[212:215], v[124:127], v[140:143]
s_waitcnt lgkmcnt(1)
v_mfma_f32_16x16x32_bf16 v[144:147], v[216:219], v[28:31], v[144:147]
v_mfma_f32_16x16x32_bf16 v[148:151], v[216:219], v[60:63], v[148:151]
v_mfma_f32_16x16x32_bf16 v[152:155], v[216:219], v[92:95], v[152:155]
v_mfma_f32_16x16x32_bf16 v[156:159], v[216:219], v[124:127], v[156:159]
s_waitcnt lgkmcnt(0)
v_mfma_f32_16x16x32_bf16 v[176:179], v[220:223], v[28:31], v[176:179]
v_mfma_f32_16x16x32_bf16 v[180:183], v[220:223], v[60:63], v[180:183]
v_mfma_f32_16x16x32_bf16 v[184:187], v[220:223], v[92:95], v[184:187]
v_mfma_f32_16x16x32_bf16 v[188:191], v[220:223], v[124:127], v[188:191]
v_max3_f32 v244, v128, v129, v130
v_max3_f32 v245, v132, v133, v134
v_max3_f32 v246, v136, v137, v138
v_max3_f32 v247, v140, v141, v142
v_max3_f32 v244, v244, v131, v144
v_max3_f32 v245, v245, v135, v148
v_max3_f32 v246, v246, v139, v152
v_max3_f32 v247, v247, v143, v156
v_max3_f32 v244, v244, v145, v146
v_max3_f32 v245, v245, v149, v150
v_max3_f32 v246, v246, v153, v154
v_max3_f32 v247, v247, v157, v158
v_max_f32 v244, v244, v147
v_max_f32 v245, v245, v151
v_max_f32 v246, v246, v155
v_max_f32 v247, v247, v159
v_mov_b32 v232, v244
v_mov_b32 v233, v245
v_mov_b32 v234, v246
v_mov_b32 v235, v247
v_permlane32_swap_b32 v244, v232
v_permlane32_swap_b32 v245, v233
v_permlane32_swap_b32 v246, v234
v_permlane32_swap_b32 v247, v235
v_max_f32 v244, v244, v232
v_max_f32 v245, v245, v233
v_max_f32 v246, v246, v234
v_max_f32 v247, v247, v235
v_mov_b32 v232, v244
v_mov_b32 v233, v245
v_mov_b32 v234, v246
v_mov_b32 v235, v247
v_permlane16_swap_b32 v244, v232
v_permlane16_swap_b32 v245, v233
v_permlane16_swap_b32 v246, v234
v_permlane16_swap_b32 v247, v235
v_max_f32 v244, v244, v232
v_max_f32 v245, v245, v233
v_max_f32 v246, v246, v234
v_max_f32 v247, v247, v235
v_ceil_f32 v244, v244
v_ceil_f32 v245, v245
v_ceil_f32 v246, v246
v_ceil_f32 v247, v247
v_sub_f32 v128, v128, v244
v_sub_f32 v129, v129, v244
v_sub_f32 v130, v130, v244
v_sub_f32 v131, v131, v244
v_exp_f32 v128, v128
v_exp_f32 v129, v129
v_exp_f32 v130, v130
v_exp_f32 v131, v131
v_sub_f32 v192, 0, v244
v_sub_f32 v193, 0, v244
v_sub_f32 v194, 0, v244
v_sub_f32 v195, 0, v244
v_sub_f32 v132, v132, v245
v_sub_f32 v133, v133, v245
v_sub_f32 v134, v134, v245
v_sub_f32 v135, v135, v245
v_exp_f32 v132, v132
v_exp_f32 v133, v133
v_exp_f32 v134, v134
v_exp_f32 v135, v135
v_sub_f32 v196, 0, v245
v_sub_f32 v197, 0, v245
v_sub_f32 v198, 0, v245
v_sub_f32 v199, 0, v245
v_sub_f32 v136, v136, v246
v_sub_f32 v137, v137, v246
v_sub_f32 v138, v138, v246
v_sub_f32 v139, v139, v246
v_exp_f32 v136, v136
v_exp_f32 v137, v137
v_exp_f32 v138, v138
v_exp_f32 v139, v139
v_sub_f32 v200, 0, v246
v_sub_f32 v201, 0, v246
v_sub_f32 v202, 0, v246
v_sub_f32 v203, 0, v246
v_sub_f32 v140, v140, v247
v_sub_f32 v141, v141, v247
v_sub_f32 v142, v142, v247
v_sub_f32 v143, v143, v247
v_exp_f32 v140, v140
v_exp_f32 v141, v141
v_exp_f32 v142, v142
v_exp_f32 v143, v143
v_sub_f32 v204, 0, v247
v_sub_f32 v205, 0, v247
v_sub_f32 v206, 0, v247
v_sub_f32 v207, 0, v247
s_waitcnt vmcnt(4)
s_barrier
ds_read_b64_tr_b16 v[208:209], v249 offset:0
ds_read_b64_tr_b16 v[210:211], v249 offset:2048
ds_read_b64_tr_b16 v[212:213], v250 offset:0
ds_read_b64_tr_b16 v[214:215], v250 offset:2048
ds_read_b64_tr_b16 v[216:217], v249 offset:512
ds_read_b64_tr_b16 v[218:219], v249 offset:2560
ds_read_b64_tr_b16 v[220:221], v250 offset:512
ds_read_b64_tr_b16 v[222:223], v250 offset:2560
v_sub_f32 v144, v144, v244
v_sub_f32 v145, v145, v244
v_sub_f32 v146, v146, v244
v_sub_f32 v147, v147, v244
v_exp_f32 v144, v144
v_exp_f32 v145, v145
v_exp_f32 v146, v146
v_exp_f32 v147, v147
v_sub_f32 v148, v148, v245
v_sub_f32 v149, v149, v245
v_sub_f32 v150, v150, v245
v_sub_f32 v151, v151, v245
v_exp_f32 v148, v148
v_exp_f32 v149, v149
v_exp_f32 v150, v150
v_exp_f32 v151, v151
v_sub_f32 v152, v152, v246
v_sub_f32 v153, v153, v246
v_sub_f32 v154, v154, v246
v_sub_f32 v155, v155, v246
v_exp_f32 v152, v152
v_exp_f32 v153, v153
v_exp_f32 v154, v154
v_exp_f32 v155, v155
v_sub_f32 v156, v156, v247
v_sub_f32 v157, v157, v247
v_sub_f32 v158, v158, v247
v_sub_f32 v159, v159, v247
v_exp_f32 v156, v156
v_exp_f32 v157, v157
v_exp_f32 v158, v158
v_exp_f32 v159, v159
v_cvt_pk_bf16_f32 v160, v128, v129
v_cvt_pk_bf16_f32 v161, v130, v131
v_cvt_pk_bf16_f32 v164, v132, v133
v_cvt_pk_bf16_f32 v165, v134, v135
v_cvt_pk_bf16_f32 v168, v136, v137
v_cvt_pk_bf16_f32 v169, v138, v139
v_cvt_pk_bf16_f32 v172, v140, v141
v_cvt_pk_bf16_f32 v173, v142, v143
v_cvt_pk_bf16_f32 v162, v144, v145
v_cvt_pk_bf16_f32 v163, v146, v147
v_cvt_pk_bf16_f32 v166, v148, v149
v_cvt_pk_bf16_f32 v167, v150, v151
v_cvt_pk_bf16_f32 v170, v152, v153
v_cvt_pk_bf16_f32 v171, v154, v155
v_cvt_pk_bf16_f32 v174, v156, v157
v_cvt_pk_bf16_f32 v175, v158, v159
v_add_f32 v224, v128, v129
v_add_f32 v225, v132, v133
v_add_f32 v226, v136, v137
v_add_f32 v227, v140, v141
v_add_f32 v228, v130, v131
v_add_f32 v229, v134, v135
v_add_f32 v230, v138, v139
v_add_f32 v231, v142, v143
v_add_f32 v224, v224, v144
v_add_f32 v225, v225, v148
v_add_f32 v226, v226, v152
v_add_f32 v227, v227, v156
v_add_f32 v228, v228, v145
v_add_f32 v229, v229, v149
v_add_f32 v230, v230, v153
v_add_f32 v231, v231, v157
v_add_f32 v224, v224, v146
v_add_f32 v225, v225, v150
v_add_f32 v226, v226, v154
v_add_f32 v227, v227, v158
v_add_f32 v228, v228, v147
v_add_f32 v229, v229, v151
v_add_f32 v230, v230, v155
v_add_f32 v231, v231, v159
v_add_f32 v224, v224, v228
v_add_f32 v225, v225, v229
v_add_f32 v226, v226, v230
v_add_f32 v227, v227, v231
v_sub_f32 v128, v176, v244
v_sub_f32 v129, v177, v244
v_sub_f32 v130, v178, v244
v_sub_f32 v131, v179, v244
v_sub_f32 v132, v180, v245
v_sub_f32 v133, v181, v245
v_sub_f32 v134, v182, v245
v_sub_f32 v135, v183, v245
v_sub_f32 v136, v184, v246
v_sub_f32 v137, v185, v246
v_sub_f32 v138, v186, v246
v_sub_f32 v139, v187, v246
v_sub_f32 v140, v188, v247
v_sub_f32 v141, v189, v247
v_sub_f32 v142, v190, v247
v_sub_f32 v143, v191, v247
s_nop 1
.p2align 6
L2_loop:
s_waitcnt lgkmcnt(6)
v_mfma_f32_16x16x32_bf16 a[0:3], v[160:163], v[208:211], a[0:3]
v_mfma_f32_16x16x32_bf16 a[4:7], v[164:167], v[208:211], a[4:7]
v_mfma_f32_16x16x32_bf16 a[8:11], v[168:171], v[208:211], a[8:11]
v_mfma_f32_16x16x32_bf16 a[12:15], v[172:175], v[208:211], a[12:15]
ds_read_b64_tr_b16 v[208:209], v249 offset:4096
s_waitcnt lgkmcnt(5)
v_mfma_f32_16x16x32_bf16 a[16:19], v[160:163], v[212:215], a[16:19]
ds_read_b64_tr_b16 v[210:211], v249 offset:6144
v_mfma_f32_16x16x32_bf16 a[20:23], v[164:167], v[212:215], a[20:23]
v_mfma_f32_16x16x32_bf16 a[24:27], v[168:171], v[212:215], a[24:27]
v_mfma_f32_16x16x32_bf16 a[28:31], v[172:175], v[212:215], a[28:31]
ds_read_b64_tr_b16 v[212:213], v250 offset:4096
s_waitcnt lgkmcnt(5)
v_mfma_f32_16x16x32_bf16 a[32:35], v[160:163], v[216:219], a[32:35]
ds_read_b64_tr_b16 v[214:215], v250 offset:6144
v_mfma_f32_16x16x32_bf16 a[36:39], v[164:167], v[216:219], a[36:39]
v_exp_f32 v232, v128
v_mfma_f32_16x16x32_bf16 a[40:43], v[168:171], v[216:219], a[40:43]
v_exp_f32 v233, v129
v_mfma_f32_16x16x32_bf16 a[44:47], v[172:175], v[216:219], a[44:47]
ds_read_b64_tr_b16 v[216:217], v249 offset:4608
s_waitcnt lgkmcnt(5)
v_mfma_f32_16x16x32_bf16 a[48:51], v[160:163], v[220:223], a[48:51]
ds_read_b64_tr_b16 v[218:219], v249 offset:6656
v_mfma_f32_16x16x32_bf16 a[52:55], v[164:167], v[220:223], a[52:55]
v_exp_f32 v234, v130
v_mfma_f32_16x16x32_bf16 a[56:59], v[168:171], v[220:223], a[56:59]
v_add_f32 v228, v224, v232
v_cvt_pk_bf16_f32 v176, v232, v233
v_mfma_f32_16x16x32_bf16 a[60:63], v[172:175], v[220:223], a[60:63]
ds_read_b64_tr_b16 v[220:221], v250 offset:4608
s_waitcnt lgkmcnt(5)
v_mfma_f32_16x16x32_bf16 a[64:67], v[160:163], v[208:211], a[64:67]
ds_read_b64_tr_b16 v[222:223], v250 offset:6656
v_mfma_f32_16x16x32_bf16 a[68:71], v[164:167], v[208:211], a[68:71]
v_exp_f32 v235, v131
v_mfma_f32_16x16x32_bf16 a[72:75], v[168:171], v[208:211], a[72:75]
v_add_f32 v228, v228, v233
v_add_f32 v228, v228, v234
v_mfma_f32_16x16x32_bf16 a[76:79], v[172:175], v[208:211], a[76:79]
ds_read_b128 v[208:211], v240 offset:18432
s_waitcnt lgkmcnt(5)
v_mfma_f32_16x16x32_bf16 a[80:83], v[160:163], v[212:215], a[80:83]
v_add_f32 v228, v228, v235
v_cvt_pk_bf16_f32 v177, v234, v235
v_mfma_f32_16x16x32_bf16 a[84:87], v[164:167], v[212:215], a[84:87]
v_exp_f32 v236, v132
v_mfma_f32_16x16x32_bf16 a[88:91], v[168:171], v[212:215], a[88:91]
v_exp_f32 v237, v133
v_mfma_f32_16x16x32_bf16 a[92:95], v[172:175], v[212:215], a[92:95]
ds_read_b128 v[212:215], v240 offset:18944
s_waitcnt lgkmcnt(4)
v_mfma_f32_16x16x32_bf16 a[96:99], v[160:163], v[216:219], a[96:99]
v_exp_f32 v238, v134
v_mfma_f32_16x16x32_bf16 a[100:103], v[164:167], v[216:219], a[100:103]
v_add_f32 v229, v225, v236
v_cvt_pk_bf16_f32 v180, v236, v237
v_mfma_f32_16x16x32_bf16 a[104:107], v[168:171], v[216:219], a[104:107]
v_exp_f32 v239, v135
v_mfma_f32_16x16x32_bf16 a[108:111], v[172:175], v[216:219], a[108:111]
ds_read_b128 v[216:219], v240 offset:22528
s_waitcnt lgkmcnt(3)
v_mfma_f32_16x16x32_bf16 a[112:115], v[160:163], v[220:223], a[112:115]
v_add_f32 v229, v229, v237
v_add_f32 v229, v229, v238
v_mfma_f32_16x16x32_bf16 a[116:119], v[164:167], v[220:223], a[116:119]
v_add_f32 v229, v229, v239
v_cvt_pk_bf16_f32 v181, v238, v239
v_mfma_f32_16x16x32_bf16 a[120:123], v[168:171], v[220:223], a[120:123]
v_exp_f32 v232, v136
v_mfma_f32_16x16x32_bf16 a[124:127], v[172:175], v[220:223], a[124:127]
ds_read_b128 v[220:223], v240 offset:23040
s_waitcnt lgkmcnt(3)
v_mfma_f32_16x16x32_bf16 v[144:147], v[208:211], v[0:3], v[192:195]
v_exp_f32 v233, v137
v_mfma_f32_16x16x32_bf16 v[148:151], v[208:211], v[32:35], v[196:199]
v_exp_f32 v234, v138
v_mfma_f32_16x16x32_bf16 v[152:155], v[208:211], v[64:67], v[200:203]
v_add_f32 v230, v226, v232
v_cvt_pk_bf16_f32 v184, v232, v233
v_mfma_f32_16x16x32_bf16 v[156:159], v[208:211], v[96:99], v[204:207]
ds_read_b128 v[208:211], v240 offset:26624
s_waitcnt lgkmcnt(3)
v_mfma_f32_16x16x32_bf16 v[144:147], v[212:215], v[4:7], v[144:147]
v_exp_f32 v235, v139
v_mfma_f32_16x16x32_bf16 v[148:151], v[212:215], v[36:39], v[148:151]
v_add_f32 v230, v230, v233
v_add_f32 v230, v230, v234
v_mfma_f32_16x16x32_bf16 v[152:155], v[212:215], v[68:71], v[152:155]
v_add_f32 v230, v230, v235
v_cvt_pk_bf16_f32 v185, v234, v235
v_mfma_f32_16x16x32_bf16 v[156:159], v[212:215], v[100:103], v[156:159]
ds_read_b128 v[212:215], v240 offset:27136
s_waitcnt lgkmcnt(3)
v_mfma_f32_16x16x32_bf16 v[144:147], v[216:219], v[8:11], v[144:147]
v_exp_f32 v236, v140
v_mfma_f32_16x16x32_bf16 v[148:151], v[216:219], v[40:43], v[148:151]
v_exp_f32 v237, v141
v_mfma_f32_16x16x32_bf16 v[152:155], v[216:219], v[72:75], v[152:155]
v_exp_f32 v238, v142
v_mfma_f32_16x16x32_bf16 v[156:159], v[216:219], v[104:107], v[156:159]
ds_read_b128 v[216:219], v240 offset:30720
s_waitcnt lgkmcnt(3)
v_mfma_f32_16x16x32_bf16 v[144:147], v[220:223], v[12:15], v[144:147]
v_add_f32 v231, v227, v236
v_cvt_pk_bf16_f32 v188, v236, v237
v_mfma_f32_16x16x32_bf16 v[148:151], v[220:223], v[44:47], v[148:151]
v_exp_f32 v239, v143
v_mfma_f32_16x16x32_bf16 v[152:155], v[220:223], v[76:79], v[152:155]
v_add_f32 v231, v231, v237
v_add_f32 v231, v231, v238
v_mfma_f32_16x16x32_bf16 v[156:159], v[220:223], v[108:111], v[156:159]
ds_read_b128 v[220:223], v240 offset:31232
s_waitcnt lgkmcnt(3)
v_mfma_f32_16x16x32_bf16 v[144:147], v[208:211], v[16:19], v[144:147]
v_add_f32 v231, v231, v239
v_cvt_pk_bf16_f32 v189, v238, v239
v_mfma_f32_16x16x32_bf16 v[148:151], v[208:211], v[48:51], v[148:151]
v_max3_f32 v242, v228, v229, v230
v_max_f32 v242, v242, v231
v_mfma_f32_16x16x32_bf16 v[152:155], v[208:211], v[80:83], v[152:155]
v_cmp_lt_f32 vcc, s32, v242
s_cbranch_vccnz L2_rare_site0
L2_ret0:
v_mfma_f32_16x16x32_bf16 v[156:159], v[208:211], v[112:115], v[156:159]
ds_read_b64_tr_b16 v[208:209], v249 offset:8192
s_waitcnt lgkmcnt(3)
v_mfma_f32_16x16x32_bf16 v[144:147], v[212:215], v[20:23], v[144:147]
ds_read_b64_tr_b16 v[210:211], v249 offset:10240
s_mov_b32 m0, s30
v_mfma_f32_16x16x32_bf16 v[148:151], v[212:215], v[52:55], v[148:151]
buffer_load_dwordx4 v241, s[12:15], s28 offen offset:0 lds
v_mfma_f32_16x16x32_bf16 v[152:155], v[212:215], v[84:87], v[152:155]
v_mfma_f32_16x16x32_bf16 v[156:159], v[212:215], v[116:119], v[156:159]
ds_read_b64_tr_b16 v[212:213], v250 offset:8192
s_waitcnt lgkmcnt(4)
v_mfma_f32_16x16x32_bf16 v[144:147], v[216:219], v[24:27], v[144:147]
ds_read_b64_tr_b16 v[214:215], v250 offset:10240
v_mfma_f32_16x16x32_bf16 v[148:151], v[216:219], v[56:59], v[148:151]
buffer_load_dwordx4 v241, s[12:15], s28 offen offset:1024 lds
v_mfma_f32_16x16x32_bf16 v[152:155], v[216:219], v[88:91], v[152:155]
v_mfma_f32_16x16x32_bf16 v[156:159], v[216:219], v[120:123], v[156:159]
ds_read_b64_tr_b16 v[216:217], v249 offset:8704
s_waitcnt lgkmcnt(5)
v_mfma_f32_16x16x32_bf16 v[144:147], v[220:223], v[28:31], v[144:147]
ds_read_b64_tr_b16 v[218:219], v249 offset:10752
v_mfma_f32_16x16x32_bf16 v[148:151], v[220:223], v[60:63], v[148:151]
buffer_load_dwordx4 v241, s[12:15], s28 offen offset:2048 lds
v_mfma_f32_16x16x32_bf16 v[152:155], v[220:223], v[92:95], v[152:155]
v_mfma_f32_16x16x32_bf16 v[156:159], v[220:223], v[124:127], v[156:159]
ds_read_b64_tr_b16 v[220:221], v250 offset:8704
s_waitcnt lgkmcnt(5)
v_mfma_f32_16x16x32_bf16 a[128:131], v[160:163], v[208:211], a[128:131]
ds_read_b64_tr_b16 v[222:223], v250 offset:10752
v_mfma_f32_16x16x32_bf16 a[132:135], v[164:167], v[208:211], a[132:135]
buffer_load_dwordx4 v241, s[12:15], s28 offen offset:3072 lds
v_mfma_f32_16x16x32_bf16 a[136:139], v[168:171], v[208:211], a[136:139]
v_mfma_f32_16x16x32_bf16 a[140:143], v[172:175], v[208:211], a[140:143]
ds_read_b64_tr_b16 v[208:209], v249 offset:12288
s_waitcnt lgkmcnt(5)
v_mfma_f32_16x16x32_bf16 a[144:147], v[160:163], v[212:215], a[144:147]
ds_read_b64_tr_b16 v[210:211], v249 offset:14336
v_mfma_f32_16x16x32_bf16 a[148:151], v[164:167], v[212:215], a[148:151]
v_mfma_f32_16x16x32_bf16 a[152:155], v[168:171], v[212:215], a[152:155]
v_add_u32 v240, 0x8000, v240
v_and_b32 v240, 0x1ffff, v240
v_mfma_f32_16x16x32_bf16 a[156:159], v[172:175], v[212:215], a[156:159]
ds_read_b64_tr_b16 v[212:213], v250 offset:12288
s_waitcnt lgkmcnt(5)
v_mfma_f32_16x16x32_bf16 a[160:163], v[160:163], v[216:219], a[160:163]
ds_read_b64_tr_b16 v[214:215], v250 offset:14336
v_mfma_f32_16x16x32_bf16 a[164:167], v[164:167], v[216:219], a[164:167]
v_exp_f32 v232, v144
v_mfma_f32_16x16x32_bf16 a[168:171], v[168:171], v[216:219], a[168:171]
v_exp_f32 v233, v145
v_mfma_f32_16x16x32_bf16 a[172:175], v[172:175], v[216:219], a[172:175]
ds_read_b64_tr_b16 v[216:217], v249 offset:12800
s_waitcnt lgkmcnt(5)
v_mfma_f32_16x16x32_bf16 a[176:179], v[160:163], v[220:223], a[176:179]
ds_read_b64_tr_b16 v[218:219], v249 offset:14848
v_mfma_f32_16x16x32_bf16 a[180:183], v[164:167], v[220:223], a[180:183]
v_exp_f32 v234, v146
v_mfma_f32_16x16x32_bf16 a[184:187], v[168:171], v[220:223], a[184:187]
v_add_f32 v224, v228, v232
v_cvt_pk_bf16_f32 v178, v232, v233
v_mfma_f32_16x16x32_bf16 a[188:191], v[172:175], v[220:223], a[188:191]
ds_read_b64_tr_b16 v[220:221], v250 offset:12800
s_waitcnt lgkmcnt(5)
v_mfma_f32_16x16x32_bf16 a[192:195], v[160:163], v[208:211], a[192:195]
ds_read_b64_tr_b16 v[222:223], v250 offset:14848
v_mfma_f32_16x16x32_bf16 a[196:199], v[164:167], v[208:211], a[196:199]
s_waitcnt vmcnt(4)
s_barrier
v_mfma_f32_16x16x32_bf16 a[200:203], v[168:171], v[208:211], a[200:203]
v_exp_f32 v235, v147
v_mfma_f32_16x16x32_bf16 a[204:207], v[172:175], v[208:211], a[204:207]
ds_read_b128 v[208:211], v240 offset:0
s_waitcnt lgkmcnt(5)
v_mfma_f32_16x16x32_bf16 a[208:211], v[160:163], v[212:215], a[208:211]
v_add_f32 v224, v224, v233
v_add_f32 v224, v224, v234
v_mfma_f32_16x16x32_bf16 a[212:215], v[164:167], v[212:215], a[212:215]
v_add_f32 v224, v224, v235
v_cvt_pk_bf16_f32 v179, v234, v235
v_mfma_f32_16x16x32_bf16 a[216:219], v[168:171], v[212:215], a[216:219]
v_exp_f32 v236, v148
v_mfma_f32_16x16x32_bf16 a[220:223], v[172:175], v[212:215], a[220:223]
ds_read_b128 v[212:215], v240 offset:512
s_waitcnt lgkmcnt(4)
v_mfma_f32_16x16x32_bf16 a[224:227], v[160:163], v[216:219], a[224:227]
v_exp_f32 v237, v149
v_mfma_f32_16x16x32_bf16 a[228:231], v[164:167], v[216:219], a[228:231]
v_exp_f32 v238, v150
v_mfma_f32_16x16x32_bf16 a[232:235], v[168:171], v[216:219], a[232:235]
v_add_f32 v225, v229, v236
v_cvt_pk_bf16_f32 v182, v236, v237
v_mfma_f32_16x16x32_bf16 a[236:239], v[172:175], v[216:219], a[236:239]
ds_read_b128 v[216:219], v240 offset:4096
s_waitcnt lgkmcnt(3)
v_mfma_f32_16x16x32_bf16 a[240:243], v[160:163], v[220:223], a[240:243]
v_exp_f32 v239, v151
v_mfma_f32_16x16x32_bf16 a[244:247], v[164:167], v[220:223], a[244:247]
v_add_f32 v225, v225, v237
v_add_f32 v225, v225, v238
v_mfma_f32_16x16x32_bf16 a[248:251], v[168:171], v[220:223], a[248:251]
v_add_f32 v225, v225, v239
v_cvt_pk_bf16_f32 v183, v238, v239
v_mfma_f32_16x16x32_bf16 a[252:255], v[172:175], v[220:223], a[252:255]
ds_read_b128 v[220:223], v240 offset:4608
s_waitcnt lgkmcnt(3)
v_mfma_f32_16x16x32_bf16 v[128:131], v[208:211], v[0:3], v[192:195]
v_exp_f32 v232, v152
v_mfma_f32_16x16x32_bf16 v[132:135], v[208:211], v[32:35], v[196:199]
v_exp_f32 v233, v153
v_mfma_f32_16x16x32_bf16 v[136:139], v[208:211], v[64:67], v[200:203]
v_exp_f32 v234, v154
v_mfma_f32_16x16x32_bf16 v[140:143], v[208:211], v[96:99], v[204:207]
ds_read_b128 v[208:211], v240 offset:8192
s_waitcnt lgkmcnt(3)
v_mfma_f32_16x16x32_bf16 v[128:131], v[212:215], v[4:7], v[128:131]
v_add_f32 v226, v230, v232
v_cvt_pk_bf16_f32 v186, v232, v233
v_mfma_f32_16x16x32_bf16 v[132:135], v[212:215], v[36:39], v[132:135]
v_exp_f32 v235, v155
v_mfma_f32_16x16x32_bf16 v[136:139], v[212:215], v[68:71], v[136:139]
v_add_f32 v226, v226, v233
v_add_f32 v226, v226, v234
v_mfma_f32_16x16x32_bf16 v[140:143], v[212:215], v[100:103], v[140:143]
ds_read_b128 v[212:215], v240 offset:8704
s_waitcnt lgkmcnt(3)
v_mfma_f32_16x16x32_bf16 v[128:131], v[216:219], v[8:11], v[128:131]
v_add_f32 v226, v226, v235
v_cvt_pk_bf16_f32 v187, v234, v235
v_mfma_f32_16x16x32_bf16 v[132:135], v[216:219], v[40:43], v[132:135]
v_exp_f32 v236, v156
v_mfma_f32_16x16x32_bf16 v[136:139], v[216:219], v[72:75], v[136:139]
v_exp_f32 v237, v157
v_mfma_f32_16x16x32_bf16 v[140:143], v[216:219], v[104:107], v[140:143]
ds_read_b128 v[216:219], v240 offset:12288
s_waitcnt lgkmcnt(3)
v_mfma_f32_16x16x32_bf16 v[128:131], v[220:223], v[12:15], v[128:131]
v_exp_f32 v238, v158
v_mfma_f32_16x16x32_bf16 v[132:135], v[220:223], v[44:47], v[132:135]
v_add_f32 v227, v231, v236
v_cvt_pk_bf16_f32 v190, v236, v237
v_mfma_f32_16x16x32_bf16 v[136:139], v[220:223], v[76:79], v[136:139]
v_exp_f32 v239, v159
v_mfma_f32_16x16x32_bf16 v[140:143], v[220:223], v[108:111], v[140:143]
ds_read_b128 v[220:223], v240 offset:12800
s_waitcnt lgkmcnt(3)
v_mfma_f32_16x16x32_bf16 v[128:131], v[208:211], v[16:19], v[128:131]
v_add_f32 v227, v227, v237
v_add_f32 v227, v227, v238
v_mfma_f32_16x16x32_bf16 v[132:135], v[208:211], v[48:51], v[132:135]
v_add_f32 v227, v227, v239
v_cvt_pk_bf16_f32 v191, v238, v239
v_mfma_f32_16x16x32_bf16 v[136:139], v[208:211], v[80:83], v[136:139]
v_max3_f32 v242, v224, v225, v226
v_max_f32 v242, v242, v227
v_mfma_f32_16x16x32_bf16 v[140:143], v[208:211], v[112:115], v[140:143]
ds_read_b64_tr_b16 v[208:209], v249 offset:16384
s_waitcnt lgkmcnt(3)
v_mfma_f32_16x16x32_bf16 v[128:131], v[212:215], v[20:23], v[128:131]
ds_read_b64_tr_b16 v[210:211], v249 offset:18432
v_cmp_lt_f32 vcc, s32, v242
v_mfma_f32_16x16x32_bf16 v[132:135], v[212:215], v[52:55], v[132:135]
s_cbranch_vccnz L2_rare_site1
L2_ret1:
v_mfma_f32_16x16x32_bf16 v[136:139], v[212:215], v[84:87], v[136:139]
v_mfma_f32_16x16x32_bf16 v[140:143], v[212:215], v[116:119], v[140:143]
ds_read_b64_tr_b16 v[212:213], v250 offset:16384
s_waitcnt lgkmcnt(4)
v_mfma_f32_16x16x32_bf16 v[128:131], v[216:219], v[24:27], v[128:131]
ds_read_b64_tr_b16 v[214:215], v250 offset:18432
v_mfma_f32_16x16x32_bf16 v[132:135], v[216:219], v[56:59], v[132:135]
v_mfma_f32_16x16x32_bf16 v[136:139], v[216:219], v[88:91], v[136:139]
s_sub_u32 s31, s31, 1
v_mfma_f32_16x16x32_bf16 v[140:143], v[216:219], v[120:123], v[140:143]
ds_read_b64_tr_b16 v[216:217], v249 offset:16896
s_waitcnt lgkmcnt(5)
v_mfma_f32_16x16x32_bf16 v[128:131], v[220:223], v[28:31], v[128:131]
ds_read_b64_tr_b16 v[218:219], v249 offset:18944
v_mfma_f32_16x16x32_bf16 v[132:135], v[220:223], v[60:63], v[132:135]
s_add_u32 s28, s28, 0x4000
s_add_u32 s30, s30, 0x4000
v_mfma_f32_16x16x32_bf16 v[136:139], v[220:223], v[92:95], v[136:139]
s_and_b32 s30, s30, 0x1ffff
s_cmp_eq_u32 s31, 0
v_mfma_f32_16x16x32_bf16 v[140:143], v[220:223], v[124:127], v[140:143]
ds_read_b64_tr_b16 v[220:221], v250 offset:16896
ds_read_b64_tr_b16 v[222:223], v250 offset:18944
s_cbranch_scc1 L2_tail_1
s_waitcnt lgkmcnt(6)
v_mfma_f32_16x16x32_bf16 a[0:3], v[176:179], v[208:211], a[0:3]
v_mfma_f32_16x16x32_bf16 a[4:7], v[180:183], v[208:211], a[4:7]
v_mfma_f32_16x16x32_bf16 a[8:11], v[184:187], v[208:211], a[8:11]
v_mfma_f32_16x16x32_bf16 a[12:15], v[188:191], v[208:211], a[12:15]
ds_read_b64_tr_b16 v[208:209], v249 offset:20480
s_waitcnt lgkmcnt(5)
v_mfma_f32_16x16x32_bf16 a[16:19], v[176:179], v[212:215], a[16:19]
ds_read_b64_tr_b16 v[210:211], v249 offset:22528
v_mfma_f32_16x16x32_bf16 a[20:23], v[180:183], v[212:215], a[20:23]
v_mfma_f32_16x16x32_bf16 a[24:27], v[184:187], v[212:215], a[24:27]
v_mfma_f32_16x16x32_bf16 a[28:31], v[188:191], v[212:215], a[28:31]
ds_read_b64_tr_b16 v[212:213], v250 offset:20480
s_waitcnt lgkmcnt(5)
v_mfma_f32_16x16x32_bf16 a[32:35], v[176:179], v[216:219], a[32:35]
ds_read_b64_tr_b16 v[214:215], v250 offset:22528
v_mfma_f32_16x16x32_bf16 a[36:39], v[180:183], v[216:219], a[36:39]
v_exp_f32 v232, v128
v_mfma_f32_16x16x32_bf16 a[40:43], v[184:187], v[216:219], a[40:43]
v_exp_f32 v233, v129
v_mfma_f32_16x16x32_bf16 a[44:47], v[188:191], v[216:219], a[44:47]
ds_read_b64_tr_b16 v[216:217], v249 offset:20992
s_waitcnt lgkmcnt(5)
v_mfma_f32_16x16x32_bf16 a[48:51], v[176:179], v[220:223], a[48:51]
ds_read_b64_tr_b16 v[218:219], v249 offset:23040
v_mfma_f32_16x16x32_bf16 a[52:55], v[180:183], v[220:223], a[52:55]
v_exp_f32 v234, v130
v_mfma_f32_16x16x32_bf16 a[56:59], v[184:187], v[220:223], a[56:59]
v_add_f32 v228, v224, v232
v_cvt_pk_bf16_f32 v160, v232, v233
v_mfma_f32_16x16x32_bf16 a[60:63], v[188:191], v[220:223], a[60:63]
ds_read_b64_tr_b16 v[220:221], v250 offset:20992
s_waitcnt lgkmcnt(5)
v_mfma_f32_16x16x32_bf16 a[64:67], v[176:179], v[208:211], a[64:67]
ds_read_b64_tr_b16 v[222:223], v250 offset:23040
v_mfma_f32_16x16x32_bf16 a[68:71], v[180:183], v[208:211], a[68:71]
v_exp_f32 v235, v131
v_mfma_f32_16x16x32_bf16 a[72:75], v[184:187], v[208:211], a[72:75]
v_add_f32 v228, v228, v233
v_add_f32 v228, v228, v234
v_mfma_f32_16x16x32_bf16 a[76:79], v[188:191], v[208:211], a[76:79]
ds_read_b128 v[208:211], v240 offset:2048
s_waitcnt lgkmcnt(5)
v_mfma_f32_16x16x32_bf16 a[80:83], v[176:179], v[212:215], a[80:83]
v_add_f32 v228, v228, v235
v_cvt_pk_bf16_f32 v161, v234, v235
v_mfma_f32_16x16x32_bf16 a[84:87], v[180:183], v[212:215], a[84:87]
v_exp_f32 v236, v132
v_mfma_f32_16x16x32_bf16 a[88:91], v[184:187], v[212:215], a[88:91]
v_exp_f32 v237, v133
v_mfma_f32_16x16x32_bf16 a[92:95], v[188:191], v[212:215], a[92:95]
ds_read_b128 v[212:215], v240 offset:2560
s_waitcnt lgkmcnt(4)
v_mfma_f32_16x16x32_bf16 a[96:99], v[176:179], v[216:219], a[96:99]
v_exp_f32 v238, v134
v_mfma_f32_16x16x32_bf16 a[100:103], v[180:183], v[216:219], a[100:103]
v_add_f32 v229, v225, v236
v_cvt_pk_bf16_f32 v164, v236, v237
v_mfma_f32_16x16x32_bf16 a[104:107], v[184:187], v[216:219], a[104:107]
v_exp_f32 v239, v135
v_mfma_f32_16x16x32_bf16 a[108:111], v[188:191], v[216:219], a[108:111]
ds_read_b128 v[216:219], v240 offset:6144
s_waitcnt lgkmcnt(3)
v_mfma_f32_16x16x32_bf16 a[112:115], v[176:179], v[220:223], a[112:115]
v_add_f32 v229, v229, v237
v_add_f32 v229, v229, v238
v_mfma_f32_16x16x32_bf16 a[116:119], v[180:183], v[220:223], a[116:119]
v_add_f32 v229, v229, v239
v_cvt_pk_bf16_f32 v165, v238, v239
v_mfma_f32_16x16x32_bf16 a[120:123], v[184:187], v[220:223], a[120:123]
v_exp_f32 v232, v136
v_mfma_f32_16x16x32_bf16 a[124:127], v[188:191], v[220:223], a[124:127]
ds_read_b128 v[220:223], v240 offset:6656
s_waitcnt lgkmcnt(3)
v_mfma_f32_16x16x32_bf16 v[144:147], v[208:211], v[0:3], v[192:195]
v_exp_f32 v233, v137
v_mfma_f32_16x16x32_bf16 v[148:151], v[208:211], v[32:35], v[196:199]
v_exp_f32 v234, v138
v_mfma_f32_16x16x32_bf16 v[152:155], v[208:211], v[64:67], v[200:203]
v_add_f32 v230, v226, v232
v_cvt_pk_bf16_f32 v168, v232, v233
v_mfma_f32_16x16x32_bf16 v[156:159], v[208:211], v[96:99], v[204:207]
ds_read_b128 v[208:211], v240 offset:10240
s_waitcnt lgkmcnt(3)
v_mfma_f32_16x16x32_bf16 v[144:147], v[212:215], v[4:7], v[144:147]
v_exp_f32 v235, v139
v_mfma_f32_16x16x32_bf16 v[148:151], v[212:215], v[36:39], v[148:151]
v_add_f32 v230, v230, v233
v_add_f32 v230, v230, v234
v_mfma_f32_16x16x32_bf16 v[152:155], v[212:215], v[68:71], v[152:155]
v_add_f32 v230, v230, v235
v_cvt_pk_bf16_f32 v169, v234, v235
v_mfma_f32_16x16x32_bf16 v[156:159], v[212:215], v[100:103], v[156:159]
ds_read_b128 v[212:215], v240 offset:10752
s_waitcnt lgkmcnt(3)
v_mfma_f32_16x16x32_bf16 v[144:147], v[216:219], v[8:11], v[144:147]
v_exp_f32 v236, v140
v_mfma_f32_16x16x32_bf16 v[148:151], v[216:219], v[40:43], v[148:151]
v_exp_f32 v237, v141
v_mfma_f32_16x16x32_bf16 v[152:155], v[216:219], v[72:75], v[152:155]
v_exp_f32 v238, v142
v_mfma_f32_16x16x32_bf16 v[156:159], v[216:219], v[104:107], v[156:159]
ds_read_b128 v[216:219], v240 offset:14336
s_waitcnt lgkmcnt(3)
v_mfma_f32_16x16x32_bf16 v[144:147], v[220:223], v[12:15], v[144:147]
v_add_f32 v231, v227, v236
v_cvt_pk_bf16_f32 v172, v236, v237
v_mfma_f32_16x16x32_bf16 v[148:151], v[220:223], v[44:47], v[148:151]
v_exp_f32 v239, v143
v_mfma_f32_16x16x32_bf16 v[152:155], v[220:223], v[76:79], v[152:155]
v_add_f32 v231, v231, v237
v_add_f32 v231, v231, v238
v_mfma_f32_16x16x32_bf16 v[156:159], v[220:223], v[108:111], v[156:159]
ds_read_b128 v[220:223], v240 offset:14848
s_waitcnt lgkmcnt(3)
v_mfma_f32_16x16x32_bf16 v[144:147], v[208:211], v[16:19], v[144:147]
v_add_f32 v231, v231, v239
v_cvt_pk_bf16_f32 v173, v238, v239
v_mfma_f32_16x16x32_bf16 v[148:151], v[208:211], v[48:51], v[148:151]
v_max3_f32 v242, v228, v229, v230
v_max_f32 v242, v242, v231
v_mfma_f32_16x16x32_bf16 v[152:155], v[208:211], v[80:83], v[152:155]
v_cmp_lt_f32 vcc, s32, v242
s_cbranch_vccnz L2_rare_site2
L2_ret2:
v_mfma_f32_16x16x32_bf16 v[156:159], v[208:211], v[112:115], v[156:159]
ds_read_b64_tr_b16 v[208:209], v249 offset:24576
s_waitcnt lgkmcnt(3)
v_mfma_f32_16x16x32_bf16 v[144:147], v[212:215], v[20:23], v[144:147]
ds_read_b64_tr_b16 v[210:211], v249 offset:26624
s_mov_b32 m0, s30
v_mfma_f32_16x16x32_bf16 v[148:151], v[212:215], v[52:55], v[148:151]
buffer_load_dwordx4 v241, s[12:15], s28 offen offset:0 lds
v_mfma_f32_16x16x32_bf16 v[152:155], v[212:215], v[84:87], v[152:155]
v_mfma_f32_16x16x32_bf16 v[156:159], v[212:215], v[116:119], v[156:159]
ds_read_b64_tr_b16 v[212:213], v250 offset:24576
s_waitcnt lgkmcnt(4)
v_mfma_f32_16x16x32_bf16 v[144:147], v[216:219], v[24:27], v[144:147]
ds_read_b64_tr_b16 v[214:215], v250 offset:26624
v_mfma_f32_16x16x32_bf16 v[148:151], v[216:219], v[56:59], v[148:151]
buffer_load_dwordx4 v241, s[12:15], s28 offen offset:1024 lds
v_mfma_f32_16x16x32_bf16 v[152:155], v[216:219], v[88:91], v[152:155]
v_mfma_f32_16x16x32_bf16 v[156:159], v[216:219], v[120:123], v[156:159]
ds_read_b64_tr_b16 v[216:217], v249 offset:25088
s_waitcnt lgkmcnt(5)
v_mfma_f32_16x16x32_bf16 v[144:147], v[220:223], v[28:31], v[144:147]
ds_read_b64_tr_b16 v[218:219], v249 offset:27136
v_mfma_f32_16x16x32_bf16 v[148:151], v[220:223], v[60:63], v[148:151]
buffer_load_dwordx4 v241, s[12:15], s28 offen offset:2048 lds
v_mfma_f32_16x16x32_bf16 v[152:155], v[220:223], v[92:95], v[152:155]
v_mfma_f32_16x16x32_bf16 v[156:159], v[220:223], v[124:127], v[156:159]
ds_read_b64_tr_b16 v[220:221], v250 offset:25088
s_waitcnt lgkmcnt(5)
v_mfma_f32_16x16x32_bf16 a[128:131], v[176:179], v[208:211], a[128:131]
ds_read_b64_tr_b16 v[222:223], v250 offset:27136
v_mfma_f32_16x16x32_bf16 a[132:135], v[180:183], v[208:211], a[132:135]
buffer_load_dwordx4 v241, s[12:15], s28 offen offset:3072 lds
v_mfma_f32_16x16x32_bf16 a[136:139], v[184:187], v[208:211], a[136:139]
v_mfma_f32_16x16x32_bf16 a[140:143], v[188:191], v[208:211], a[140:143]
ds_read_b64_tr_b16 v[208:209], v249 offset:28672
s_waitcnt lgkmcnt(5)
v_mfma_f32_16x16x32_bf16 a[144:147], v[176:179], v[212:215], a[144:147]
ds_read_b64_tr_b16 v[210:211], v249 offset:30720
v_mfma_f32_16x16x32_bf16 a[148:151], v[180:183], v[212:215], a[148:151]
v_mfma_f32_16x16x32_bf16 a[152:155], v[184:187], v[212:215], a[152:155]
v_mfma_f32_16x16x32_bf16 a[156:159], v[188:191], v[212:215], a[156:159]
ds_read_b64_tr_b16 v[212:213], v250 offset:28672
s_waitcnt lgkmcnt(5)
v_mfma_f32_16x16x32_bf16 a[160:163], v[176:179], v[216:219], a[160:163]
ds_read_b64_tr_b16 v[214:215], v250 offset:30720
v_mfma_f32_16x16x32_bf16 a[164:167], v[180:183], v[216:219], a[164:167]
v_exp_f32 v232, v144
v_mfma_f32_16x16x32_bf16 a[168:171], v[184:187], v[216:219], a[168:171]
v_exp_f32 v233, v145
v_mfma_f32_16x16x32_bf16 a[172:175], v[188:191], v[216:219], a[172:175]
ds_read_b64_tr_b16 v[216:217], v249 offset:29184
s_waitcnt lgkmcnt(5)
v_mfma_f32_16x16x32_bf16 a[176:179], v[176:179], v[220:223], a[176:179]
ds_read_b64_tr_b16 v[218:219], v249 offset:31232
v_mfma_f32_16x16x32_bf16 a[180:183], v[180:183], v[220:223], a[180:183]
v_exp_f32 v234, v146
v_mfma_f32_16x16x32_bf16 a[184:187], v[184:187], v[220:223], a[184:187]
v_add_f32 v224, v228, v232
v_cvt_pk_bf16_f32 v162, v232, v233
v_mfma_f32_16x16x32_bf16 a[188:191], v[188:191], v[220:223], a[188:191]
ds_read_b64_tr_b16 v[220:221], v250 offset:29184
s_waitcnt lgkmcnt(5)
v_mfma_f32_16x16x32_bf16 a[192:195], v[176:179], v[208:211], a[192:195]
ds_read_b64_tr_b16 v[222:223], v250 offset:31232
v_mfma_f32_16x16x32_bf16 a[196:199], v[180:183], v[208:211], a[196:199]
s_waitcnt vmcnt(4)
s_barrier
v_mfma_f32_16x16x32_bf16 a[200:203], v[184:187], v[208:211], a[200:203]
v_exp_f32 v235, v147
v_mfma_f32_16x16x32_bf16 a[204:207], v[188:191], v[208:211], a[204:207]
ds_read_b128 v[208:211], v240 offset:16384
s_waitcnt lgkmcnt(5)
v_mfma_f32_16x16x32_bf16 a[208:211], v[176:179], v[212:215], a[208:211]
v_add_u32 v249, 0x8000, v249
v_and_b32 v249, 0x1ffff, v249
v_mfma_f32_16x16x32_bf16 a[212:215], v[180:183], v[212:215], a[212:215]
v_xor_b32 v250, 32, v249
v_add_f32 v224, v224, v233
v_mfma_f32_16x16x32_bf16 a[216:219], v[184:187], v[212:215], a[216:219]
v_add_f32 v224, v224, v234
v_add_f32 v224, v224, v235
v_mfma_f32_16x16x32_bf16 a[220:223], v[188:191], v[212:215], a[220:223]
ds_read_b128 v[212:215], v240 offset:16896
s_waitcnt lgkmcnt(4)
v_mfma_f32_16x16x32_bf16 a[224:227], v[176:179], v[216:219], a[224:227]
v_cvt_pk_bf16_f32 v163, v234, v235
v_mfma_f32_16x16x32_bf16 a[228:231], v[180:183], v[216:219], a[228:231]
v_exp_f32 v236, v148
v_mfma_f32_16x16x32_bf16 a[232:235], v[184:187], v[216:219], a[232:235]
v_exp_f32 v237, v149
v_mfma_f32_16x16x32_bf16 a[236:239], v[188:191], v[216:219], a[236:239]
ds_read_b128 v[216:219], v240 offset:20480
s_waitcnt lgkmcnt(3)
v_mfma_f32_16x16x32_bf16 a[240:243], v[176:179], v[220:223], a[240:243]
v_exp_f32 v238, v150
v_mfma_f32_16x16x32_bf16 a[244:247], v[180:183], v[220:223], a[244:247]
v_add_f32 v225, v229, v236
v_cvt_pk_bf16_f32 v166, v236, v237
v_mfma_f32_16x16x32_bf16 a[248:251], v[184:187], v[220:223], a[248:251]
v_exp_f32 v239, v151
v_mfma_f32_16x16x32_bf16 a[252:255], v[188:191], v[220:223], a[252:255]
ds_read_b128 v[220:223], v240 offset:20992
s_waitcnt lgkmcnt(3)
v_mfma_f32_16x16x32_bf16 v[128:131], v[208:211], v[0:3], v[192:195]
v_add_f32 v225, v225, v237
v_add_f32 v225, v225, v238
v_mfma_f32_16x16x32_bf16 v[132:135], v[208:211], v[32:35], v[196:199]
v_add_f32 v225, v225, v239
v_cvt_pk_bf16_f32 v167, v238, v239
v_mfma_f32_16x16x32_bf16 v[136:139], v[208:211], v[64:67], v[200:203]
v_exp_f32 v232, v152
v_mfma_f32_16x16x32_bf16 v[140:143], v[208:211], v[96:99], v[204:207]
ds_read_b128 v[208:211], v240 offset:24576
s_waitcnt lgkmcnt(3)
v_mfma_f32_16x16x32_bf16 v[128:131], v[212:215], v[4:7], v[128:131]
v_exp_f32 v233, v153
v_mfma_f32_16x16x32_bf16 v[132:135], v[212:215], v[36:39], v[132:135]
v_exp_f32 v234, v154
v_mfma_f32_16x16x32_bf16 v[136:139], v[212:215], v[68:71], v[136:139]
v_add_f32 v226, v230, v232
v_cvt_pk_bf16_f32 v170, v232, v233
v_mfma_f32_16x16x32_bf16 v[140:143], v[212:215], v[100:103], v[140:143]
ds_read_b128 v[212:215], v240 offset:25088
s_waitcnt lgkmcnt(3)
v_mfma_f32_16x16x32_bf16 v[128:131], v[216:219], v[8:11], v[128:131]
v_exp_f32 v235, v155
v_mfma_f32_16x16x32_bf16 v[132:135], v[216:219], v[40:43], v[132:135]
v_add_f32 v226, v226, v233
v_add_f32 v226, v226, v234
v_mfma_f32_16x16x32_bf16 v[136:139], v[216:219], v[72:75], v[136:139]
v_add_f32 v226, v226, v235
v_cvt_pk_bf16_f32 v171, v234, v235
v_mfma_f32_16x16x32_bf16 v[140:143], v[216:219], v[104:107], v[140:143]
ds_read_b128 v[216:219], v240 offset:28672
s_waitcnt lgkmcnt(3)
v_mfma_f32_16x16x32_bf16 v[128:131], v[220:223], v[12:15], v[128:131]
v_exp_f32 v236, v156
v_mfma_f32_16x16x32_bf16 v[132:135], v[220:223], v[44:47], v[132:135]
v_exp_f32 v237, v157
v_mfma_f32_16x16x32_bf16 v[136:139], v[220:223], v[76:79], v[136:139]
v_exp_f32 v238, v158
v_mfma_f32_16x16x32_bf16 v[140:143], v[220:223], v[108:111], v[140:143]
ds_read_b128 v[220:223], v240 offset:29184
s_waitcnt lgkmcnt(3)
v_mfma_f32_16x16x32_bf16 v[128:131], v[208:211], v[16:19], v[128:131]
v_add_f32 v227, v231, v236
v_cvt_pk_bf16_f32 v174, v236, v237
v_mfma_f32_16x16x32_bf16 v[132:135], v[208:211], v[48:51], v[132:135]
v_exp_f32 v239, v159
v_mfma_f32_16x16x32_bf16 v[136:139], v[208:211], v[80:83], v[136:139]
v_add_f32 v227, v227, v237
v_add_f32 v227, v227, v238
v_mfma_f32_16x16x32_bf16 v[140:143], v[208:211], v[112:115], v[140:143]
ds_read_b64_tr_b16 v[208:209], v249 offset:0
s_waitcnt lgkmcnt(3)
v_mfma_f32_16x16x32_bf16 v[128:131], v[212:215], v[20:23], v[128:131]
ds_read_b64_tr_b16 v[210:211], v249 offset:2048
v_add_f32 v227, v227, v239
v_mfma_f32_16x16x32_bf16 v[132:135], v[212:215], v[52:55], v[132:135]
v_cvt_pk_bf16_f32 v175, v238, v239
v_max3_f32 v242, v224, v225, v226
v_mfma_f32_16x16x32_bf16 v[136:139], v[212:215], v[84:87], v[136:139]
v_max_f32 v242, v242, v227
v_cmp_lt_f32 vcc, s32, v242
v_mfma_f32_16x16x32_bf16 v[140:143], v[212:215], v[116:119], v[140:143]
ds_read_b64_tr_b16 v[212:213], v250 offset:0
s_waitcnt lgkmcnt(4)
v_mfma_f32_16x16x32_bf16 v[128:131], v[216:219], v[24:27], v[128:131]
ds_read_b64_tr_b16 v[214:215], v250 offset:2048
s_cbranch_vccnz L2_rare_site3
L2_ret3:
v_mfma_f32_16x16x32_bf16 v[132:135], v[216:219], v[56:59], v[132:135]
v_mfma_f32_16x16x32_bf16 v[136:139], v[216:219], v[88:91], v[136:139]
s_sub_u32 s31, s31, 1
v_mfma_f32_16x16x32_bf16 v[140:143], v[216:219], v[120:123], v[140:143]
ds_read_b64_tr_b16 v[216:217], v249 offset:512
s_waitcnt lgkmcnt(5)
v_mfma_f32_16x16x32_bf16 v[128:131], v[220:223], v[28:31], v[128:131]
ds_read_b64_tr_b16 v[218:219], v249 offset:2560
v_mfma_f32_16x16x32_bf16 v[132:135], v[220:223], v[60:63], v[132:135]
s_add_u32 s28, s28, 0x4000
s_add_u32 s30, s30, 0x4000
v_mfma_f32_16x16x32_bf16 v[136:139], v[220:223], v[92:95], v[136:139]
s_and_b32 s30, s30, 0x1ffff
s_cmp_eq_u32 s31, 0
v_mfma_f32_16x16x32_bf16 v[140:143], v[220:223], v[124:127], v[140:143]
ds_read_b64_tr_b16 v[220:221], v250 offset:512
ds_read_b64_tr_b16 v[222:223], v250 offset:2560
s_cbranch_scc0 L2_loop
L2_tail_0:
s_waitcnt lgkmcnt(6)
v_mfma_f32_16x16x32_bf16 a[0:3], v[160:163], v[208:211], a[0:3]
s_mov_b32 m0, s30
v_mfma_f32_16x16x32_bf16 a[4:7], v[164:167], v[208:211], a[4:7]
buffer_load_dwordx4 v241, s[12:15], s28 offen offset:0 lds
v_add_u32 v253, s50, v248
v_mfma_f32_16x16x32_bf16 a[8:11], v[168:171], v[208:211], a[8:11]
buffer_load_dwordx4 v241, s[12:15], s28 offen offset:1024 lds
v_mfma_f32_16x16x32_bf16 a[12:15], v[172:175], v[208:211], a[12:15]
ds_read_b128 v[208:211], v240 offset:18432
s_waitcnt lgkmcnt(5)
buffer_load_dwordx4 v241, s[12:15], s28 offen offset:2048 lds
v_mfma_f32_16x16x32_bf16 a[16:19], v[160:163], v[212:215], a[16:19]
buffer_load_dwordx4 v241, s[12:15], s28 offen offset:3072 lds
v_mfma_f32_16x16x32_bf16 a[20:23], v[164:167], v[212:215], a[20:23]
s_add_u32 s28, s28, 0x4000
s_add_u32 s30, s30, 0x4000
s_and_b32 s30, s30, 0x1ffff
v_mfma_f32_16x16x32_bf16 a[24:27], v[168:171], v[212:215], a[24:27]
s_mov_b32 m0, s30
v_mfma_f32_16x16x32_bf16 a[28:31], v[172:175], v[212:215], a[28:31]
ds_read_b128 v[212:215], v240 offset:18944
s_waitcnt lgkmcnt(4)
buffer_load_dwordx4 v241, s[12:15], s28 offen offset:0 lds
v_mfma_f32_16x16x32_bf16 a[32:35], v[160:163], v[216:219], a[32:35]
buffer_load_dwordx4 v241, s[12:15], s28 offen offset:1024 lds
v_mfma_f32_16x16x32_bf16 a[36:39], v[164:167], v[216:219], a[36:39]
buffer_load_dwordx4 v241, s[12:15], s28 offen offset:2048 lds
v_mfma_f32_16x16x32_bf16 a[40:43], v[168:171], v[216:219], a[40:43]
buffer_load_dwordx4 v241, s[12:15], s28 offen offset:3072 lds
v_mfma_f32_16x16x32_bf16 a[44:47], v[172:175], v[216:219], a[44:47]
ds_read_b128 v[216:219], v240 offset:22528
s_waitcnt lgkmcnt(3)
v_mfma_f32_16x16x32_bf16 a[48:51], v[160:163], v[220:223], a[48:51]
v_exp_f32 v232, v128
s_and_b32 s30, s30, 0x1c000
v_mfma_f32_16x16x32_bf16 a[52:55], v[164:167], v[220:223], a[52:55]
v_add_u32 v251, 0x8000, v240
v_and_b32 v251, 0x1ffff, v251
s_add_u32 s28, s30, 0x4000
v_mfma_f32_16x16x32_bf16 a[56:59], v[168:171], v[220:223], a[56:59]
v_add_u32 v252, 0x10000, v240
v_and_b32 v252, 0x1ffff, v252
s_and_b32 s28, s28, 0x1ffff
v_mfma_f32_16x16x32_bf16 a[60:63], v[172:175], v[220:223], a[60:63]
ds_read_b128 v[220:223], v240 offset:23040
s_waitcnt lgkmcnt(3)
s_add_u32 s30, s30, 0x8000
v_mfma_f32_16x16x32_bf16 v[144:147], v[208:211], v[0:3], v[192:195]
ds_write_b128 v253, v[160:163] offset:0
s_and_b32 s30, s30, 0x1ffff
s_mul_i32 s31, s34, 6144
v_mfma_f32_16x16x32_bf16 v[148:151], v[208:211], v[32:35], v[196:199]
ds_write_b128 v253, v[164:167] offset:1024
s_add_u32 s31, s31, s30
s_lshl_b32 s3, s34, 10
v_mfma_f32_16x16x32_bf16 v[152:155], v[208:211], v[64:67], v[200:203]
ds_write_b128 v253, v[168:171] offset:2048
s_add_u32 s28, s28, s3
s_add_u32 s3, s3, 24576
v_mfma_f32_16x16x32_bf16 v[156:159], v[208:211], v[96:99], v[204:207]
ds_read_b128 v[208:211], v240 offset:26624
s_waitcnt lgkmcnt(3)
ds_write_b128 v253, v[172:175] offset:3072
v_mfma_f32_16x16x32_bf16 v[144:147], v[212:215], v[4:7], v[144:147]
v_exp_f32 v233, v129
s_add_u32 s30, s30, s3
v_mfma_f32_16x16x32_bf16 v[148:151], v[212:215], v[36:39], v[148:151]
v_exp_f32 v234, v130
v_lshrrev_b32 v241, 4, v248
v_mfma_f32_16x16x32_bf16 v[152:155], v[212:215], v[68:71], v[152:155]
v_add_f32 v228, v224, v232
v_cvt_pk_bf16_f32 v176, v232, v233
v_and_b32 v241, 0x30, v241
v_mfma_f32_16x16x32_bf16 v[156:159], v[212:215], v[100:103], v[156:159]
ds_read_b128 v[212:215], v240 offset:27136
s_waitcnt lgkmcnt(3)
v_xor_b32 v241, v241, v248
v_mfma_f32_16x16x32_bf16 v[144:147], v[216:219], v[8:11], v[144:147]
v_exp_f32 v235, v131
v_mfma_f32_16x16x32_bf16 v[148:151], v[216:219], v[40:43], v[148:151]
v_add_f32 v228, v228, v233
v_add_f32 v228, v228, v234
v_mfma_f32_16x16x32_bf16 v[152:155], v[216:219], v[72:75], v[152:155]
v_add_f32 v228, v228, v235
v_cvt_pk_bf16_f32 v177, v234, v235
v_mfma_f32_16x16x32_bf16 v[156:159], v[216:219], v[104:107], v[156:159]
ds_read_b128 v[216:219], v240 offset:30720
s_waitcnt lgkmcnt(3)
v_mfma_f32_16x16x32_bf16 v[144:147], v[220:223], v[12:15], v[144:147]
v_exp_f32 v236, v132
v_mfma_f32_16x16x32_bf16 v[148:151], v[220:223], v[44:47], v[148:151]
v_exp_f32 v237, v133
v_mfma_f32_16x16x32_bf16 v[152:155], v[220:223], v[76:79], v[152:155]
v_exp_f32 v238, v134
v_mfma_f32_16x16x32_bf16 v[156:159], v[220:223], v[108:111], v[156:159]
ds_read_b128 v[220:223], v240 offset:31232
s_waitcnt lgkmcnt(3)
v_mfma_f32_16x16x32_bf16 v[144:147], v[208:211], v[16:19], v[144:147]
v_add_f32 v229, v225, v236
v_cvt_pk_bf16_f32 v180, v236, v237
v_and_b32 v243, 0x380, v248
v_mad_u32_u24 v241, v243, 3, v241
v_mfma_f32_16x16x32_bf16 v[148:151], v[208:211], v[48:51], v[148:151]
s_waitcnt vmcnt(8)
s_barrier
v_mfma_f32_16x16x32_bf16 v[152:155], v[208:211], v[80:83], v[152:155]
v_exp_f32 v239, v135
v_mfma_f32_16x16x32_bf16 v[156:159], v[208:211], v[112:115], v[156:159]
ds_read_b128 v[208:211], v251 offset:0
s_waitcnt lgkmcnt(3)
v_mfma_f32_16x16x32_bf16 v[144:147], v[212:215], v[20:23], v[144:147]
v_add_f32 v229, v229, v237
v_add_f32 v229, v229, v238
v_mfma_f32_16x16x32_bf16 v[148:151], v[212:215], v[52:55], v[148:151]
v_add_f32 v229, v229, v239
v_cvt_pk_bf16_f32 v181, v238, v239
v_mfma_f32_16x16x32_bf16 v[152:155], v[212:215], v[84:87], v[152:155]
v_exp_f32 v232, v136
v_mfma_f32_16x16x32_bf16 v[156:159], v[212:215], v[116:119], v[156:159]
ds_read_b128 v[212:215], v251 offset:512
s_waitcnt lgkmcnt(3)
v_mfma_f32_16x16x32_bf16 v[144:147], v[216:219], v[24:27], v[144:147]
v_exp_f32 v233, v137
v_mfma_f32_16x16x32_bf16 v[148:151], v[216:219], v[56:59], v[148:151]
v_exp_f32 v234, v138
v_mfma_f32_16x16x32_bf16 v[152:155], v[216:219], v[88:91], v[152:155]
v_add_f32 v230, v226, v232
v_cvt_pk_bf16_f32 v184, v232, v233
v_mfma_f32_16x16x32_bf16 v[156:159], v[216:219], v[120:123], v[156:159]
ds_read_b128 v[216:219], v251 offset:4096
s_waitcnt lgkmcnt(3)
v_mfma_f32_16x16x32_bf16 v[144:147], v[220:223], v[28:31], v[144:147]
v_exp_f32 v235, v139
v_mfma_f32_16x16x32_bf16 v[148:151], v[220:223], v[60:63], v[148:151]
v_add_f32 v230, v230, v233
v_add_f32 v230, v230, v234
v_mfma_f32_16x16x32_bf16 v[152:155], v[220:223], v[92:95], v[152:155]
v_add_f32 v230, v230, v235
v_cvt_pk_bf16_f32 v185, v234, v235
v_mfma_f32_16x16x32_bf16 v[156:159], v[220:223], v[124:127], v[156:159]
ds_read_b128 v[220:223], v251 offset:4608
s_waitcnt lgkmcnt(3)
v_exp_f32 v236, v140
v_exp_f32 v237, v141
v_exp_f32 v238, v142
v_add_f32 v231, v227, v236
v_cvt_pk_bf16_f32 v188, v236, v237
v_exp_f32 v239, v143
v_add_f32 v231, v231, v237
v_add_f32 v231, v231, v238
v_add_f32 v231, v231, v239
v_cvt_pk_bf16_f32 v189, v238, v239
v_max3_f32 v242, v228, v229, v230
v_max_f32 v242, v242, v231
v_cmp_lt_f32 vcc, s32, v242
s_cbranch_vccnz L2_rare_site4
L2_ret4:
v_mfma_f32_16x16x32_bf16 v[128:131], v[208:211], v[0:3], v[192:195]
s_add_u32 m0, s31, 0
v_mfma_f32_16x16x32_bf16 v[132:135], v[208:211], v[32:35], v[196:199]
v_exp_f32 v232, v144
v_mfma_f32_16x16x32_bf16 v[136:139], v[208:211], v[64:67], v[200:203]
v_exp_f32 v233, v145
v_mfma_f32_16x16x32_bf16 v[140:143], v[208:211], v[96:99], v[204:207]
ds_read_b128 v[208:211], v251 offset:8192
s_waitcnt lgkmcnt(3)
v_mfma_f32_16x16x32_bf16 v[128:131], v[212:215], v[4:7], v[128:131]
v_exp_f32 v234, v146
v_add_f32 v224, v228, v232
v_mfma_f32_16x16x32_bf16 v[132:135], v[212:215], v[36:39], v[132:135]
v_cvt_pk_bf16_f32 v178, v232, v233
v_exp_f32 v235, v147
v_mfma_f32_16x16x32_bf16 v[136:139], v[212:215], v[68:71], v[136:139]
v_add_f32 v224, v224, v233
v_add_f32 v224, v224, v234
v_add_f32 v224, v224, v235
v_mfma_f32_16x16x32_bf16 v[140:143], v[212:215], v[100:103], v[140:143]
ds_read_b128 v[212:215], v251 offset:8704
s_waitcnt lgkmcnt(3)
v_cvt_pk_bf16_f32 v179, v234, v235
v_mfma_f32_16x16x32_bf16 v[128:131], v[216:219], v[8:11], v[128:131]
v_exp_f32 v236, v148
v_mfma_f32_16x16x32_bf16 v[132:135], v[216:219], v[40:43], v[132:135]
v_exp_f32 v237, v149
v_mfma_f32_16x16x32_bf16 v[136:139], v[216:219], v[72:75], v[136:139]
v_exp_f32 v238, v150
v_add_f32 v225, v229, v236
v_mfma_f32_16x16x32_bf16 v[140:143], v[216:219], v[104:107], v[140:143]
ds_read_b128 v[216:219], v251 offset:12288
s_waitcnt lgkmcnt(3)
v_cvt_pk_bf16_f32 v182, v236, v237
v_mfma_f32_16x16x32_bf16 v[128:131], v[220:223], v[12:15], v[128:131]
v_exp_f32 v239, v151
v_add_f32 v225, v225, v237
v_mfma_f32_16x16x32_bf16 v[132:135], v[220:223], v[44:47], v[132:135]
v_add_f32 v225, v225, v238
v_add_f32 v225, v225, v239
v_cvt_pk_bf16_f32 v183, v238, v239
v_mfma_f32_16x16x32_bf16 v[136:139], v[220:223], v[76:79], v[136:139]
v_exp_f32 v232, v152
v_mfma_f32_16x16x32_bf16 v[140:143], v[220:223], v[108:111], v[140:143]
ds_read_b128 v[220:223], v251 offset:12800
s_waitcnt lgkmcnt(3)
v_mfma_f32_16x16x32_bf16 v[128:131], v[208:211], v[16:19], v[128:131]
v_exp_f32 v233, v153
v_mfma_f32_16x16x32_bf16 v[132:135], v[208:211], v[48:51], v[132:135]
v_exp_f32 v234, v154
v_add_f32 v226, v230, v232
v_mfma_f32_16x16x32_bf16 v[136:139], v[208:211], v[80:83], v[136:139]
v_cvt_pk_bf16_f32 v186, v232, v233
v_exp_f32 v235, v155
v_mfma_f32_16x16x32_bf16 v[140:143], v[208:211], v[112:115], v[140:143]
ds_read_b128 v[208:211], v251 offset:2048
s_waitcnt lgkmcnt(3)
v_add_f32 v226, v226, v233
v_mfma_f32_16x16x32_bf16 v[128:131], v[212:215], v[20:23], v[128:131]
v_add_f32 v226, v226, v234
v_add_f32 v226, v226, v235
v_cvt_pk_bf16_f32 v187, v234, v235
v_mfma_f32_16x16x32_bf16 v[132:135], v[212:215], v[52:55], v[132:135]
v_exp_f32 v236, v156
v_mfma_f32_16x16x32_bf16 v[136:139], v[212:215], v[84:87], v[136:139]
v_exp_f32 v237, v157
v_mfma_f32_16x16x32_bf16 v[140:143], v[212:215], v[116:119], v[140:143]
ds_read_b128 v[212:215], v251 offset:2560
s_waitcnt lgkmcnt(3)
v_mfma_f32_16x16x32_bf16 v[128:131], v[216:219], v[24:27], v[128:131]
v_exp_f32 v238, v158
v_add_f32 v227, v231, v236
v_mfma_f32_16x16x32_bf16 v[132:135], v[216:219], v[56:59], v[132:135]
v_cvt_pk_bf16_f32 v190, v236, v237
v_exp_f32 v239, v159
v_mfma_f32_16x16x32_bf16 v[136:139], v[216:219], v[88:91], v[136:139]
v_add_f32 v227, v227, v237
v_add_f32 v227, v227, v238
v_add_f32 v227, v227, v239
v_mfma_f32_16x16x32_bf16 v[140:143], v[216:219], v[120:123], v[140:143]
ds_read_b128 v[216:219], v251 offset:6144
s_waitcnt lgkmcnt(3)
v_cvt_pk_bf16_f32 v191, v238, v239
v_mfma_f32_16x16x32_bf16 v[128:131], v[220:223], v[28:31], v[128:131]
v_max3_f32 v242, v224, v225, v226
v_max_f32 v242, v242, v227
v_cmp_lt_f32 vcc, s32, v242
s_cbranch_vccnz L2_rare_site5
L2_ret5:
v_mfma_f32_16x16x32_bf16 v[132:135], v[220:223], v[60:63], v[132:135]
buffer_load_dwordx4 v241, s[8:11], s6 offen lds
s_add_u32 m0, s31, 2048
v_mfma_f32_16x16x32_bf16 v[136:139], v[220:223], v[92:95], v[136:139]
buffer_load_dwordx4 v241, s[8:11], s7 offen lds
s_add_u32 m0, s31, 4096
v_mfma_f32_16x16x32_bf16 v[140:143], v[220:223], v[124:127], v[140:143]
ds_read_b128 v[220:223], v251 offset:6656
s_waitcnt lgkmcnt(3)
v_mfma_f32_16x16x32_bf16 v[144:147], v[208:211], v[0:3], v[192:195]
ds_write_b128 v253, v[176:179] offset:4096
buffer_load_dwordx4 v241, s[8:11], s29 offen lds
s_add_u32 m0, s31, 1024
v_mfma_f32_16x16x32_bf16 v[148:151], v[208:211], v[32:35], v[196:199]
ds_write_b128 v253, v[180:183] offset:5120
v_exp_f32 v232, v128
v_mfma_f32_16x16x32_bf16 v[152:155], v[208:211], v[64:67], v[200:203]
ds_write_b128 v253, v[184:187] offset:6144
v_exp_f32 v233, v129
v_mfma_f32_16x16x32_bf16 v[156:159], v[208:211], v[96:99], v[204:207]
ds_read_b128 v[208:211], v251 offset:10240
s_waitcnt lgkmcnt(3)
ds_write_b128 v253, v[188:191] offset:7168
v_mfma_f32_16x16x32_bf16 v[144:147], v[212:215], v[4:7], v[144:147]
v_exp_f32 v234, v130
v_add_f32 v228, v224, v232
v_mfma_f32_16x16x32_bf16 v[148:151], v[212:215], v[36:39], v[148:151]
v_cvt_pk_bf16_f32 v160, v232, v233
v_exp_f32 v235, v131
v_mfma_f32_16x16x32_bf16 v[152:155], v[212:215], v[68:71], v[152:155]
v_add_f32 v228, v228, v233
v_add_f32 v228, v228, v234
v_add_f32 v228, v228, v235
v_mfma_f32_16x16x32_bf16 v[156:159], v[212:215], v[100:103], v[156:159]
ds_read_b128 v[212:215], v251 offset:10752
s_waitcnt lgkmcnt(3)
v_cvt_pk_bf16_f32 v161, v234, v235
v_mfma_f32_16x16x32_bf16 v[144:147], v[216:219], v[8:11], v[144:147]
v_exp_f32 v236, v132
v_xor_b32 v241, 0x1040, v241
v_mfma_f32_16x16x32_bf16 v[148:151], v[216:219], v[40:43], v[148:151]
v_exp_f32 v237, v133
v_mfma_f32_16x16x32_bf16 v[152:155], v[216:219], v[72:75], v[152:155]
v_exp_f32 v238, v134
v_add_f32 v229, v225, v236
v_mfma_f32_16x16x32_bf16 v[156:159], v[216:219], v[104:107], v[156:159]
ds_read_b128 v[216:219], v251 offset:14336
s_waitcnt lgkmcnt(3)
v_cvt_pk_bf16_f32 v164, v236, v237
v_mfma_f32_16x16x32_bf16 v[144:147], v[220:223], v[12:15], v[144:147]
v_exp_f32 v239, v135
v_add_f32 v229, v229, v237
v_mfma_f32_16x16x32_bf16 v[148:151], v[220:223], v[44:47], v[148:151]
v_add_f32 v229, v229, v238
v_add_f32 v229, v229, v239
v_cvt_pk_bf16_f32 v165, v238, v239
v_mfma_f32_16x16x32_bf16 v[152:155], v[220:223], v[76:79], v[152:155]
v_exp_f32 v232, v136
v_mfma_f32_16x16x32_bf16 v[156:159], v[220:223], v[108:111], v[156:159]
ds_read_b128 v[220:223], v251 offset:14848
s_waitcnt lgkmcnt(3)
v_mfma_f32_16x16x32_bf16 v[144:147], v[208:211], v[16:19], v[144:147]
v_exp_f32 v233, v137
v_mfma_f32_16x16x32_bf16 v[148:151], v[208:211], v[48:51], v[148:151]
s_waitcnt vmcnt(7)
s_barrier
v_mfma_f32_16x16x32_bf16 v[152:155], v[208:211], v[80:83], v[152:155]
v_exp_f32 v234, v138
v_add_f32 v230, v226, v232
v_mfma_f32_16x16x32_bf16 v[156:159], v[208:211], v[112:115], v[156:159]
ds_read_b128 v[208:211], v251 offset:16384
s_waitcnt lgkmcnt(3)
v_cvt_pk_bf16_f32 v168, v232, v233
v_mfma_f32_16x16x32_bf16 v[144:147], v[212:215], v[20:23], v[144:147]
v_exp_f32 v235, v139
v_add_f32 v230, v230, v233
v_mfma_f32_16x16x32_bf16 v[148:151], v[212:215], v[52:55], v[148:151]
v_add_f32 v230, v230, v234
v_add_f32 v230, v230, v235
v_cvt_pk_bf16_f32 v169, v234, v235
v_mfma_f32_16x16x32_bf16 v[152:155], v[212:215], v[84:87], v[152:155]
v_exp_f32 v236, v140
v_mfma_f32_16x16x32_bf16 v[156:159], v[212:215], v[116:119], v[156:159]
ds_read_b128 v[212:215], v251 offset:16896
s_waitcnt lgkmcnt(3)
v_mfma_f32_16x16x32_bf16 v[144:147], v[216:219], v[24:27], v[144:147]
v_exp_f32 v237, v141
v_mfma_f32_16x16x32_bf16 v[148:151], v[216:219], v[56:59], v[148:151]
v_exp_f32 v238, v142
v_add_f32 v231, v227, v236
v_mfma_f32_16x16x32_bf16 v[152:155], v[216:219], v[88:91], v[152:155]
v_cvt_pk_bf16_f32 v172, v236, v237
v_exp_f32 v239, v143
v_mfma_f32_16x16x32_bf16 v[156:159], v[216:219], v[120:123], v[156:159]
ds_read_b128 v[216:219], v251 offset:20480
s_waitcnt lgkmcnt(3)
v_add_f32 v231, v231, v237
v_mfma_f32_16x16x32_bf16 v[144:147], v[220:223], v[28:31], v[144:147]
v_add_f32 v231, v231, v238
v_add_f32 v231, v231, v239
v_cvt_pk_bf16_f32 v173, v238, v239
v_mfma_f32_16x16x32_bf16 v[148:151], v[220:223], v[60:63], v[148:151]
v_max3_f32 v242, v228, v229, v230
v_max_f32 v242, v242, v231
v_cmp_lt_f32 vcc, s32, v242
s_cbranch_vccnz L2_rare_site6
L2_ret6:
v_mfma_f32_16x16x32_bf16 v[152:155], v[220:223], v[92:95], v[152:155]
buffer_load_dwordx4 v241, s[8:11], s6 offen lds
s_add_u32 m0, s31, 3072
v_mfma_f32_16x16x32_bf16 v[156:159], v[220:223], v[124:127], v[156:159]
ds_read_b128 v[220:223], v251 offset:20992
s_waitcnt lgkmcnt(3)
v_mfma_f32_16x16x32_bf16 v[128:131], v[208:211], v[0:3], v[192:195]
buffer_load_dwordx4 v241, s[8:11], s7 offen lds
s_add_u32 m0, s31, 5120
v_mfma_f32_16x16x32_bf16 v[132:135], v[208:211], v[32:35], v[196:199]
v_exp_f32 v232, v144
v_mfma_f32_16x16x32_bf16 v[136:139], v[208:211], v[64:67], v[200:203]
v_exp_f32 v233, v145
v_mfma_f32_16x16x32_bf16 v[140:143], v[208:211], v[96:99], v[204:207]
ds_read_b128 v[208:211], v251 offset:24576
s_waitcnt lgkmcnt(3)
v_mfma_f32_16x16x32_bf16 v[128:131], v[212:215], v[4:7], v[128:131]
v_exp_f32 v234, v146
v_add_f32 v224, v228, v232
v_mfma_f32_16x16x32_bf16 v[132:135], v[212:215], v[36:39], v[132:135]
v_cvt_pk_bf16_f32 v162, v232, v233
v_exp_f32 v235, v147
v_mfma_f32_16x16x32_bf16 v[136:139], v[212:215], v[68:71], v[136:139]
v_add_f32 v224, v224, v233
v_add_f32 v224, v224, v234
v_add_f32 v224, v224, v235
v_mfma_f32_16x16x32_bf16 v[140:143], v[212:215], v[100:103], v[140:143]
ds_read_b128 v[212:215], v251 offset:25088
s_waitcnt lgkmcnt(3)
v_cvt_pk_bf16_f32 v163, v234, v235
v_mfma_f32_16x16x32_bf16 v[128:131], v[216:219], v[8:11], v[128:131]
v_exp_f32 v236, v148
v_mfma_f32_16x16x32_bf16 v[132:135], v[216:219], v[40:43], v[132:135]
v_exp_f32 v237, v149
v_mfma_f32_16x16x32_bf16 v[136:139], v[216:219], v[72:75], v[136:139]
v_exp_f32 v238, v150
v_add_f32 v225, v229, v236
v_mfma_f32_16x16x32_bf16 v[140:143], v[216:219], v[104:107], v[140:143]
ds_read_b128 v[216:219], v251 offset:28672
s_waitcnt lgkmcnt(3)
v_cvt_pk_bf16_f32 v166, v236, v237
v_mfma_f32_16x16x32_bf16 v[128:131], v[220:223], v[12:15], v[128:131]
v_exp_f32 v239, v151
v_add_f32 v225, v225, v237
v_mfma_f32_16x16x32_bf16 v[132:135], v[220:223], v[44:47], v[132:135]
v_add_f32 v225, v225, v238
v_add_f32 v225, v225, v239
v_cvt_pk_bf16_f32 v167, v238, v239
v_mfma_f32_16x16x32_bf16 v[136:139], v[220:223], v[76:79], v[136:139]
v_exp_f32 v232, v152
v_mfma_f32_16x16x32_bf16 v[140:143], v[220:223], v[108:111], v[140:143]
ds_read_b128 v[220:223], v251 offset:29184
s_waitcnt lgkmcnt(3)
v_mfma_f32_16x16x32_bf16 v[128:131], v[208:211], v[16:19], v[128:131]
v_exp_f32 v233, v153
v_mfma_f32_16x16x32_bf16 v[132:135], v[208:211], v[48:51], v[132:135]
v_exp_f32 v234, v154
v_add_f32 v226, v230, v232
v_mfma_f32_16x16x32_bf16 v[136:139], v[208:211], v[80:83], v[136:139]
v_cvt_pk_bf16_f32 v170, v232, v233
v_exp_f32 v235, v155
v_mfma_f32_16x16x32_bf16 v[140:143], v[208:211], v[112:115], v[140:143]
ds_read_b128 v[208:211], v251 offset:18432
s_waitcnt lgkmcnt(3)
v_add_f32 v226, v226, v233
v_mfma_f32_16x16x32_bf16 v[128:131], v[212:215], v[20:23], v[128:131]
v_add_f32 v226, v226, v234
v_add_f32 v226, v226, v235
v_cvt_pk_bf16_f32 v171, v234, v235
v_mfma_f32_16x16x32_bf16 v[132:135], v[212:215], v[52:55], v[132:135]
v_exp_f32 v236, v156
v_mfma_f32_16x16x32_bf16 v[136:139], v[212:215], v[84:87], v[136:139]
v_exp_f32 v237, v157
v_mfma_f32_16x16x32_bf16 v[140:143], v[212:215], v[116:119], v[140:143]
ds_read_b128 v[212:215], v251 offset:18944
s_waitcnt lgkmcnt(3)
v_mfma_f32_16x16x32_bf16 v[128:131], v[216:219], v[24:27], v[128:131]
v_exp_f32 v238, v158
v_add_f32 v227, v231, v236
v_mfma_f32_16x16x32_bf16 v[132:135], v[216:219], v[56:59], v[132:135]
v_cvt_pk_bf16_f32 v174, v236, v237
v_exp_f32 v239, v159
v_mfma_f32_16x16x32_bf16 v[136:139], v[216:219], v[88:91], v[136:139]
v_add_f32 v227, v227, v237
v_add_f32 v227, v227, v238
v_add_f32 v227, v227, v239
v_mfma_f32_16x16x32_bf16 v[140:143], v[216:219], v[120:123], v[140:143]
ds_read_b128 v[216:219], v251 offset:22528
s_waitcnt lgkmcnt(3)
v_cvt_pk_bf16_f32 v175, v238, v239
v_mfma_f32_16x16x32_bf16 v[128:131], v[220:223], v[28:31], v[128:131]
v_max3_f32 v242, v224, v225, v226
v_max_f32 v242, v242, v227
v_cmp_lt_f32 vcc, s32, v242
s_cbranch_vccnz L2_rare_site7
L2_ret7:
v_mfma_f32_16x16x32_bf16 v[132:135], v[220:223], v[60:63], v[132:135]
buffer_load_dwordx4 v241, s[8:11], s29 offen lds
v_mfma_f32_16x16x32_bf16 v[136:139], v[220:223], v[92:95], v[136:139]
v_mfma_f32_16x16x32_bf16 v[140:143], v[220:223], v[124:127], v[140:143]
ds_read_b128 v[220:223], v251 offset:23040
s_waitcnt lgkmcnt(3)
v_mfma_f32_16x16x32_bf16 v[144:147], v[208:211], v[0:3], v[192:195]
v_mfma_f32_16x16x32_bf16 v[148:151], v[208:211], v[32:35], v[196:199]
v_exp_f32 v232, v128
v_mfma_f32_16x16x32_bf16 v[152:155], v[208:211], v[64:67], v[200:203]
v_exp_f32 v233, v129
v_mfma_f32_16x16x32_bf16 v[156:159], v[208:211], v[96:99], v[204:207]
ds_read_b128 v[208:211], v251 offset:26624
s_waitcnt lgkmcnt(3)
v_mfma_f32_16x16x32_bf16 v[144:147], v[212:215], v[4:7], v[144:147]
v_exp_f32 v234, v130
v_add_f32 v228, v224, v232
v_mfma_f32_16x16x32_bf16 v[148:151], v[212:215], v[36:39], v[148:151]
v_cvt_pk_bf16_f32 v176, v232, v233
v_exp_f32 v235, v131
v_mfma_f32_16x16x32_bf16 v[152:155], v[212:215], v[68:71], v[152:155]
v_add_f32 v228, v228, v233
v_add_f32 v228, v228, v234
v_add_f32 v228, v228, v235
v_mfma_f32_16x16x32_bf16 v[156:159], v[212:215], v[100:103], v[156:159]
ds_read_b128 v[212:215], v251 offset:27136
s_waitcnt lgkmcnt(3)
v_cvt_pk_bf16_f32 v177, v234, v235
v_mfma_f32_16x16x32_bf16 v[144:147], v[216:219], v[8:11], v[144:147]
v_exp_f32 v236, v132
v_mfma_f32_16x16x32_bf16 v[148:151], v[216:219], v[40:43], v[148:151]
v_exp_f32 v237, v133
v_mfma_f32_16x16x32_bf16 v[152:155], v[216:219], v[72:75], v[152:155]
v_exp_f32 v238, v134
v_add_f32 v229, v225, v236
v_mfma_f32_16x16x32_bf16 v[156:159], v[216:219], v[104:107], v[156:159]
ds_read_b128 v[216:219], v251 offset:30720
s_waitcnt lgkmcnt(3)
v_cvt_pk_bf16_f32 v180, v236, v237
v_mfma_f32_16x16x32_bf16 v[144:147], v[220:223], v[12:15], v[144:147]
v_exp_f32 v239, v135
v_add_f32 v229, v229, v237
v_mfma_f32_16x16x32_bf16 v[148:151], v[220:223], v[44:47], v[148:151]
v_add_f32 v229, v229, v238
v_add_f32 v229, v229, v239
v_cvt_pk_bf16_f32 v181, v238, v239
v_mfma_f32_16x16x32_bf16 v[152:155], v[220:223], v[76:79], v[152:155]
v_exp_f32 v232, v136
v_mfma_f32_16x16x32_bf16 v[156:159], v[220:223], v[108:111], v[156:159]
ds_read_b128 v[220:223], v251 offset:31232
s_waitcnt lgkmcnt(3)
v_mfma_f32_16x16x32_bf16 v[144:147], v[208:211], v[16:19], v[144:147]
v_exp_f32 v233, v137
v_mfma_f32_16x16x32_bf16 v[148:151], v[208:211], v[48:51], v[148:151]
s_waitcnt vmcnt(6)
s_barrier
v_mfma_f32_16x16x32_bf16 v[152:155], v[208:211], v[80:83], v[152:155]
v_exp_f32 v234, v138
v_add_f32 v230, v226, v232
v_mfma_f32_16x16x32_bf16 v[156:159], v[208:211], v[112:115], v[156:159]
ds_read_b128 v[208:211], v252 offset:0
s_waitcnt lgkmcnt(3)
v_cvt_pk_bf16_f32 v184, v232, v233
v_mfma_f32_16x16x32_bf16 v[144:147], v[212:215], v[20:23], v[144:147]
v_exp_f32 v235, v139
v_add_f32 v230, v230, v233
v_mfma_f32_16x16x32_bf16 v[148:151], v[212:215], v[52:55], v[148:151]
v_add_f32 v230, v230, v234
v_add_f32 v230, v230, v235
v_cvt_pk_bf16_f32 v185, v234, v235
v_mfma_f32_16x16x32_bf16 v[152:155], v[212:215], v[84:87], v[152:155]
v_exp_f32 v236, v140
v_mfma_f32_16x16x32_bf16 v[156:159], v[212:215], v[116:119], v[156:159]
ds_read_b128 v[212:215], v252 offset:512
s_waitcnt lgkmcnt(3)
v_mfma_f32_16x16x32_bf16 v[144:147], v[216:219], v[24:27], v[144:147]
v_exp_f32 v237, v141
v_mfma_f32_16x16x32_bf16 v[148:151], v[216:219], v[56:59], v[148:151]
v_exp_f32 v238, v142
v_add_f32 v231, v227, v236
v_mfma_f32_16x16x32_bf16 v[152:155], v[216:219], v[88:91], v[152:155]
v_cvt_pk_bf16_f32 v188, v236, v237
v_exp_f32 v239, v143
v_mfma_f32_16x16x32_bf16 v[156:159], v[216:219], v[120:123], v[156:159]
ds_read_b128 v[216:219], v252 offset:4096
s_waitcnt lgkmcnt(3)
v_add_f32 v231, v231, v237
v_mfma_f32_16x16x32_bf16 v[144:147], v[220:223], v[28:31], v[144:147]
v_add_f32 v231, v231, v238
v_add_f32 v231, v231, v239
v_cvt_pk_bf16_f32 v189, v238, v239
v_mfma_f32_16x16x32_bf16 v[148:151], v[220:223], v[60:63], v[148:151]
v_max3_f32 v242, v228, v229, v230
v_max_f32 v242, v242, v231
v_cmp_lt_f32 vcc, s32, v242
s_cbranch_vccnz L2_rare_site8
L2_ret8:
v_mfma_f32_16x16x32_bf16 v[152:155], v[220:223], v[92:95], v[152:155]
v_mfma_f32_16x16x32_bf16 v[156:159], v[220:223], v[124:127], v[156:159]
ds_read_b128 v[220:223], v252 offset:4608
s_waitcnt lgkmcnt(3)
v_mfma_f32_16x16x32_bf16 v[128:131], v[208:211], v[0:3], v[192:195]
v_mfma_f32_16x16x32_bf16 v[132:135], v[208:211], v[32:35], v[196:199]
v_exp_f32 v232, v144
v_mfma_f32_16x16x32_bf16 v[136:139], v[208:211], v[64:67], v[200:203]
v_exp_f32 v233, v145
v_mfma_f32_16x16x32_bf16 v[140:143], v[208:211], v[96:99], v[204:207]
ds_read_b128 v[208:211], v252 offset:8192
s_waitcnt lgkmcnt(3)
v_mfma_f32_16x16x32_bf16 v[128:131], v[212:215], v[4:7], v[128:131]
v_exp_f32 v234, v146
v_add_f32 v224, v228, v232
v_mfma_f32_16x16x32_bf16 v[132:135], v[212:215], v[36:39], v[132:135]
v_cvt_pk_bf16_f32 v178, v232, v233
v_exp_f32 v235, v147
v_mfma_f32_16x16x32_bf16 v[136:139], v[212:215], v[68:71], v[136:139]
v_add_f32 v224, v224, v233
v_add_f32 v224, v224, v234
v_add_f32 v224, v224, v235
v_mfma_f32_16x16x32_bf16 v[140:143], v[212:215], v[100:103], v[140:143]
ds_read_b128 v[212:215], v252 offset:8704
s_waitcnt lgkmcnt(3)
v_cvt_pk_bf16_f32 v179, v234, v235
v_mfma_f32_16x16x32_bf16 v[128:131], v[216:219], v[8:11], v[128:131]
v_exp_f32 v236, v148
v_lshlrev_b32 v241, 3, v248
v_mfma_f32_16x16x32_bf16 v[132:135], v[216:219], v[40:43], v[132:135]
v_exp_f32 v237, v149
s_mov_b32 s3, 0x7c28000
v_mfma_f32_16x16x32_bf16 v[136:139], v[216:219], v[72:75], v[136:139]
v_exp_f32 v238, v150
v_add_f32 v225, v229, v236
v_mfma_f32_16x16x32_bf16 v[140:143], v[216:219], v[104:107], v[140:143]
ds_read_b128 v[216:219], v252 offset:12288
s_waitcnt lgkmcnt(3)
v_cvt_pk_bf16_f32 v182, v236, v237
v_mfma_f32_16x16x32_bf16 v[128:131], v[220:223], v[12:15], v[128:131]
v_exp_f32 v239, v151
v_add_f32 v225, v225, v237
v_mfma_f32_16x16x32_bf16 v[132:135], v[220:223], v[44:47], v[132:135]
v_add_f32 v225, v225, v238
v_add_f32 v225, v225, v239
v_cvt_pk_bf16_f32 v183, v238, v239
v_mfma_f32_16x16x32_bf16 v[136:139], v[220:223], v[76:79], v[136:139]
v_exp_f32 v232, v152
buffer_load_dword v241, v241, s[16:19], s3 offen sc1
v_mfma_f32_16x16x32_bf16 v[140:143], v[220:223], v[108:111], v[140:143]
ds_read_b128 v[220:223], v252 offset:12800
s_waitcnt lgkmcnt(3)
v_mfma_f32_16x16x32_bf16 v[128:131], v[208:211], v[16:19], v[128:131]
v_exp_f32 v233, v153
v_mfma_f32_16x16x32_bf16 v[132:135], v[208:211], v[48:51], v[132:135]
v_exp_f32 v234, v154
v_add_f32 v226, v230, v232
v_mfma_f32_16x16x32_bf16 v[136:139], v[208:211], v[80:83], v[136:139]
v_cvt_pk_bf16_f32 v186, v232, v233
v_exp_f32 v235, v155
v_mfma_f32_16x16x32_bf16 v[140:143], v[208:211], v[112:115], v[140:143]
ds_read_b128 v[208:211], v252 offset:2048
s_waitcnt lgkmcnt(3)
v_add_f32 v226, v226, v233
v_mfma_f32_16x16x32_bf16 v[128:131], v[212:215], v[20:23], v[128:131]
v_add_f32 v226, v226, v234
v_add_f32 v226, v226, v235
v_cvt_pk_bf16_f32 v187, v234, v235
v_mfma_f32_16x16x32_bf16 v[132:135], v[212:215], v[52:55], v[132:135]
v_exp_f32 v236, v156
v_mfma_f32_16x16x32_bf16 v[136:139], v[212:215], v[84:87], v[136:139]
v_exp_f32 v237, v157
v_mfma_f32_16x16x32_bf16 v[140:143], v[212:215], v[116:119], v[140:143]
ds_read_b128 v[212:215], v252 offset:2560
s_waitcnt lgkmcnt(3)
v_mfma_f32_16x16x32_bf16 v[128:131], v[216:219], v[24:27], v[128:131]
v_exp_f32 v238, v158
v_add_f32 v227, v231, v236
v_mfma_f32_16x16x32_bf16 v[132:135], v[216:219], v[56:59], v[132:135]
v_cvt_pk_bf16_f32 v190, v236, v237
v_exp_f32 v239, v159
v_mfma_f32_16x16x32_bf16 v[136:139], v[216:219], v[88:91], v[136:139]
v_add_f32 v227, v227, v237
v_add_f32 v227, v227, v238
v_add_f32 v227, v227, v239
v_mfma_f32_16x16x32_bf16 v[140:143], v[216:219], v[120:123], v[140:143]
ds_read_b128 v[216:219], v252 offset:6144
s_waitcnt lgkmcnt(3)
v_cvt_pk_bf16_f32 v191, v238, v239
v_mfma_f32_16x16x32_bf16 v[128:131], v[220:223], v[28:31], v[128:131]
v_max3_f32 v242, v224, v225, v226
v_max_f32 v242, v242, v227
v_cmp_lt_f32 vcc, s32, v242
s_cbranch_vccnz L2_rare_site9
L2_ret9:
v_mfma_f32_16x16x32_bf16 v[132:135], v[220:223], v[60:63], v[132:135]
v_mfma_f32_16x16x32_bf16 v[136:139], v[220:223], v[92:95], v[136:139]
v_mfma_f32_16x16x32_bf16 v[140:143], v[220:223], v[124:127], v[140:143]
ds_read_b128 v[220:223], v252 offset:6656
s_waitcnt lgkmcnt(3)
v_mfma_f32_16x16x32_bf16 v[144:147], v[208:211], v[0:3], v[192:195]
v_mfma_f32_16x16x32_bf16 v[148:151], v[208:211], v[32:35], v[196:199]
v_mfma_f32_16x16x32_bf16 v[152:155], v[208:211], v[64:67], v[200:203]
v_mfma_f32_16x16x32_bf16 v[156:159], v[208:211], v[96:99], v[204:207]
ds_read_b128 v[208:211], v252 offset:10240
s_waitcnt lgkmcnt(3)
v_mfma_f32_16x16x32_bf16 v[144:147], v[212:215], v[4:7], v[144:147]
v_exp_f32 v232, v128
v_mfma_f32_16x16x32_bf16 v[148:151], v[212:215], v[36:39], v[148:151]
v_exp_f32 v233, v129
v_mfma_f32_16x16x32_bf16 v[152:155], v[212:215], v[68:71], v[152:155]
v_exp_f32 v234, v130
v_add_f32 v228, v224, v232
v_mfma_f32_16x16x32_bf16 v[156:159], v[212:215], v[100:103], v[156:159]
ds_read_b128 v[212:215], v252 offset:10752
s_waitcnt lgkmcnt(3)
v_cvt_pk_bf16_f32 v0, v232, v233
v_mfma_f32_16x16x32_bf16 v[144:147], v[216:219], v[8:11], v[144:147]
v_exp_f32 v235, v131
v_add_f32 v228, v228, v233
v_mfma_f32_16x16x32_bf16 v[148:151], v[216:219], v[40:43], v[148:151]
ds_read_b128 v[4:7], v253 offset:0
v_add_f32 v228, v228, v234
v_add_f32 v228, v228, v235
v_mfma_f32_16x16x32_bf16 v[152:155], v[216:219], v[72:75], v[152:155]
ds_read_b128 v[36:39], v253 offset:1024
v_cvt_pk_bf16_f32 v1, v234, v235
v_mfma_f32_16x16x32_bf16 v[156:159], v[216:219], v[104:107], v[156:159]
ds_read_b128 v[216:219], v252 offset:14336
s_waitcnt lgkmcnt(3)
v_mfma_f32_16x16x32_bf16 v[144:147], v[220:223], v[12:15], v[144:147]
v_exp_f32 v236, v132
v_mfma_f32_16x16x32_bf16 v[148:151], v[220:223], v[44:47], v[148:151]
ds_read_b128 v[68:71], v253 offset:2048
ds_read_b128 v[8:11], v253 offset:4096
v_mfma_f32_16x16x32_bf16 v[152:155], v[220:223], v[76:79], v[152:155]
v_add_u32 v12, 0x8000, v249
v_and_b32 v12, 0x1ffff, v12
ds_read_b128 v[100:103], v253 offset:3072
ds_read_b128 v[40:43], v253 offset:5120
v_mfma_f32_16x16x32_bf16 v[156:159], v[220:223], v[108:111], v[156:159]
ds_read_b128 v[220:223], v252 offset:14848
s_waitcnt lgkmcnt(3)
v_add_u32 v14, 0x10000, v249
v_and_b32 v14, 0x1ffff, v14
v_mfma_f32_16x16x32_bf16 v[144:147], v[208:211], v[16:19], v[144:147]
v_xor_b32 v13, 32, v12
v_xor_b32 v15, 32, v14
v_mfma_f32_16x16x32_bf16 v[148:151], v[208:211], v[48:51], v[148:151]
ds_read_b128 v[72:75], v253 offset:6144
v_exp_f32 v237, v133
v_mfma_f32_16x16x32_bf16 v[152:155], v[208:211], v[80:83], v[152:155]
ds_read_b128 v[104:107], v253 offset:7168
v_exp_f32 v238, v134
v_mfma_f32_16x16x32_bf16 v[156:159], v[208:211], v[112:115], v[156:159]
ds_read_b64_tr_b16 v[208:209], v249 offset:16384
s_waitcnt lgkmcnt(3)
v_add_f32 v229, v225, v236
v_mfma_f32_16x16x32_bf16 v[144:147], v[212:215], v[20:23], v[144:147]
ds_read_b64_tr_b16 v[210:211], v249 offset:18432
v_cvt_pk_bf16_f32 v32, v236, v237
v_mfma_f32_16x16x32_bf16 v[148:151], v[212:215], v[52:55], v[148:151]
v_exp_f32 v239, v135
v_add_f32 v229, v229, v237
v_mfma_f32_16x16x32_bf16 v[152:155], v[212:215], v[84:87], v[152:155]
v_add_f32 v229, v229, v238
v_add_f32 v229, v229, v239
v_cvt_pk_bf16_f32 v33, v238, v239
v_mfma_f32_16x16x32_bf16 v[156:159], v[212:215], v[116:119], v[156:159]
ds_read_b64_tr_b16 v[212:213], v12 offset:0
s_waitcnt lgkmcnt(4)
v_mfma_f32_16x16x32_bf16 v[144:147], v[216:219], v[24:27], v[144:147]
ds_read_b64_tr_b16 v[214:215], v12 offset:2048
v_exp_f32 v232, v136
v_mfma_f32_16x16x32_bf16 v[148:151], v[216:219], v[56:59], v[148:151]
v_exp_f32 v233, v137
v_mfma_f32_16x16x32_bf16 v[152:155], v[216:219], v[88:91], v[152:155]
v_exp_f32 v234, v138
v_add_f32 v230, v226, v232
v_mfma_f32_16x16x32_bf16 v[156:159], v[216:219], v[120:123], v[156:159]
ds_read_b64_tr_b16 v[216:217], v12 offset:16384
s_waitcnt lgkmcnt(5)
v_cvt_pk_bf16_f32 v64, v232, v233
v_mfma_f32_16x16x32_bf16 v[144:147], v[220:223], v[28:31], v[144:147]
ds_read_b64_tr_b16 v[218:219], v12 offset:18432
v_exp_f32 v235, v139
v_mfma_f32_16x16x32_bf16 v[148:151], v[220:223], v[60:63], v[148:151]
v_add_f32 v230, v230, v233
v_add_f32 v230, v230, v234
v_add_f32 v230, v230, v235
v_mfma_f32_16x16x32_bf16 v[152:155], v[220:223], v[92:95], v[152:155]
v_cvt_pk_bf16_f32 v65, v234, v235
v_exp_f32 v236, v140
v_mfma_f32_16x16x32_bf16 v[156:159], v[220:223], v[124:127], v[156:159]
ds_read_b64_tr_b16 v[220:221], v250 offset:16384
s_waitcnt lgkmcnt(5)
v_exp_f32 v237, v141
v_exp_f32 v238, v142
v_add_f32 v231, v227, v236
v_cvt_pk_bf16_f32 v96, v236, v237
v_exp_f32 v239, v143
v_add_f32 v231, v231, v237
v_add_f32 v231, v231, v238
v_add_f32 v231, v231, v239
v_cvt_pk_bf16_f32 v97, v238, v239
v_max3_f32 v242, v228, v229, v230
v_max_f32 v242, v242, v231
v_cmp_lt_f32 vcc, s32, v242
s_cbranch_vccnz L2_rare_site10
L2_ret10:
v_mfma_f32_16x16x32_bf16 a[0:3], v[8:11], v[208:211], a[0:3]
ds_read_b64_tr_b16 v[222:223], v250 offset:18432
s_waitcnt vmcnt(0)
v_cmp_eq_u32_e64 s[38:39], 0, v241
v_mfma_f32_16x16x32_bf16 a[4:7], v[40:43], v[208:211], a[4:7]
v_exp_f32 v232, v144
v_mfma_f32_16x16x32_bf16 a[8:11], v[72:75], v[208:211], a[8:11]
v_exp_f32 v233, v145
v_mfma_f32_16x16x32_bf16 a[12:15], v[104:107], v[208:211], a[12:15]
ds_read_b64_tr_b16 v[208:209], v13 offset:0
s_waitcnt lgkmcnt(5)
v_mfma_f32_16x16x32_bf16 a[0:3], v[160:163], v[212:215], a[0:3]
ds_read_b64_tr_b16 v[210:211], v13 offset:2048
s_and_b64 s[38:39], s[38:39], s[96:97]
s_cbranch_scc1 LF_hl_0
LF_hlret_0:
v_mfma_f32_16x16x32_bf16 a[4:7], v[164:167], v[212:215], a[4:7]
v_exp_f32 v234, v146
v_lshrrev_b32 v241, 4, v248
v_mfma_f32_16x16x32_bf16 a[8:11], v[168:171], v[212:215], a[8:11]
v_add_f32 v224, v228, v232
v_cvt_pk_bf16_f32 v2, v232, v233
v_and_b32 v241, 0x30, v241
v_mfma_f32_16x16x32_bf16 a[12:15], v[172:175], v[212:215], a[12:15]
ds_read_b64_tr_b16 v[212:213], v13 offset:16384
s_waitcnt lgkmcnt(5)
v_xor_b32 v241, v241, v248
v_mfma_f32_16x16x32_bf16 a[0:3], v[176:179], v[216:219], a[0:3]
ds_read_b64_tr_b16 v[214:215], v13 offset:18432
v_and_b32 v243, 0x380, v248
v_mad_u32_u24 v241, v243, 3, v241
v_mfma_f32_16x16x32_bf16 a[4:7], v[180:183], v[216:219], a[4:7]
v_exp_f32 v235, v147
v_add_u32 v241, 0x7000000, v241
v_mfma_f32_16x16x32_bf16 a[8:11], v[184:187], v[216:219], a[8:11]
v_add_f32 v224, v224, v233
v_add_f32 v224, v224, v234
v_mfma_f32_16x16x32_bf16 a[12:15], v[188:191], v[216:219], a[12:15]
ds_read_b64_tr_b16 v[216:217], v249 offset:16896
s_waitcnt lgkmcnt(5)
v_mfma_f32_16x16x32_bf16 a[16:19], v[8:11], v[220:223], a[16:19]
ds_read_b64_tr_b16 v[218:219], v249 offset:18944
v_add_f32 v224, v224, v235
v_mfma_f32_16x16x32_bf16 a[20:23], v[40:43], v[220:223], a[20:23]
v_cvt_pk_bf16_f32 v3, v234, v235
s_add_u32 m0, s28, 0
v_mfma_f32_16x16x32_bf16 a[24:27], v[72:75], v[220:223], a[24:27]
v_exp_f32 v236, v148
v_mfma_f32_16x16x32_bf16 a[28:31], v[104:107], v[220:223], a[28:31]
ds_read_b64_tr_b16 v[220:221], v12 offset:512
s_waitcnt lgkmcnt(5)
v_mfma_f32_16x16x32_bf16 a[16:19], v[160:163], v[208:211], a[16:19]
ds_read_b64_tr_b16 v[222:223], v12 offset:2560
buffer_load_dwordx4 v241, s[16:19], s6 offen sc1 lds
s_add_u32 m0, s28, 8192
v_mfma_f32_16x16x32_bf16 a[20:23], v[164:167], v[208:211], a[20:23]
v_exp_f32 v237, v149
v_mfma_f32_16x16x32_bf16 a[24:27], v[168:171], v[208:211], a[24:27]
v_exp_f32 v238, v150
v_mfma_f32_16x16x32_bf16 a[28:31], v[172:175], v[208:211], a[28:31]
ds_read_b64_tr_b16 v[208:209], v12 offset:16896
s_waitcnt lgkmcnt(5)
v_mfma_f32_16x16x32_bf16 a[16:19], v[176:179], v[212:215], a[16:19]
ds_read_b64_tr_b16 v[210:211], v12 offset:18944
v_add_f32 v225, v229, v236
v_mfma_f32_16x16x32_bf16 a[20:23], v[180:183], v[212:215], a[20:23]
v_cvt_pk_bf16_f32 v34, v236, v237
buffer_load_dwordx4 v241, s[16:19], s7 offen sc1 lds
s_add_u32 m0, s30, 0
v_mfma_f32_16x16x32_bf16 a[24:27], v[184:187], v[212:215], a[24:27]
v_exp_f32 v239, v151
v_mfma_f32_16x16x32_bf16 a[28:31], v[188:191], v[212:215], a[28:31]
ds_read_b64_tr_b16 v[212:213], v250 offset:16896
s_waitcnt lgkmcnt(5)
v_mfma_f32_16x16x32_bf16 a[32:35], v[8:11], v[216:219], a[32:35]
ds_read_b64_tr_b16 v[214:215], v250 offset:18944
v_add_f32 v225, v225, v237
v_mfma_f32_16x16x32_bf16 a[36:39], v[40:43], v[216:219], a[36:39]
v_add_f32 v225, v225, v238
v_add_f32 v225, v225, v239
v_mfma_f32_16x16x32_bf16 a[40:43], v[72:75], v[216:219], a[40:43]
v_cvt_pk_bf16_f32 v35, v238, v239
buffer_load_dwordx4 v241, s[16:19], s29 offen sc1 lds
s_add_u32 m0, s28, 4096
v_mfma_f32_16x16x32_bf16 a[44:47], v[104:107], v[216:219], a[44:47]
ds_read_b64_tr_b16 v[216:217], v13 offset:512
s_waitcnt lgkmcnt(5)
v_xor_b32 v241, 0x1040, v241
v_mfma_f32_16x16x32_bf16 a[32:35], v[160:163], v[220:223], a[32:35]
ds_read_b64_tr_b16 v[218:219], v13 offset:2560
buffer_load_dwordx4 v241, s[16:19], s6 offen sc1 lds
s_add_u32 m0, s28, 12288
v_mfma_f32_16x16x32_bf16 a[36:39], v[164:167], v[220:223], a[36:39]
v_exp_f32 v232, v152
v_mfma_f32_16x16x32_bf16 a[40:43], v[168:171], v[220:223], a[40:43]
v_exp_f32 v233, v153
v_mfma_f32_16x16x32_bf16 a[44:47], v[172:175], v[220:223], a[44:47]
ds_read_b64_tr_b16 v[220:221], v13 offset:16896
s_waitcnt lgkmcnt(5)
v_mfma_f32_16x16x32_bf16 a[32:35], v[176:179], v[208:211], a[32:35]
ds_read_b64_tr_b16 v[222:223], v13 offset:18944
buffer_load_dwordx4 v241, s[16:19], s7 offen sc1 lds
s_add_u32 m0, s30, 4096
v_mfma_f32_16x16x32_bf16 a[36:39], v[180:183], v[208:211], a[36:39]
v_exp_f32 v234, v154
v_mfma_f32_16x16x32_bf16 a[40:43], v[184:187], v[208:211], a[40:43]
v_add_f32 v226, v230, v232
v_cvt_pk_bf16_f32 v66, v232, v233
v_mfma_f32_16x16x32_bf16 a[44:47], v[188:191], v[208:211], a[44:47]
ds_read_b64_tr_b16 v[208:209], v14 offset:0
s_waitcnt lgkmcnt(5)
v_mfma_f32_16x16x32_bf16 a[48:51], v[8:11], v[212:215], a[48:51]
ds_read_b64_tr_b16 v[210:211], v14 offset:2048
buffer_load_dwordx4 v241, s[16:19], s29 offen sc1 lds
v_mfma_f32_16x16x32_bf16 a[52:55], v[40:43], v[212:215], a[52:55]
v_exp_f32 v235, v155
v_mfma_f32_16x16x32_bf16 a[56:59], v[72:75], v[212:215], a[56:59]
v_add_f32 v226, v226, v233
v_add_f32 v226, v226, v234
v_mfma_f32_16x16x32_bf16 a[60:63], v[104:107], v[212:215], a[60:63]
ds_read_b64_tr_b16 v[212:213], v15 offset:0
s_waitcnt lgkmcnt(5)
v_mfma_f32_16x16x32_bf16 a[48:51], v[160:163], v[216:219], a[48:51]
ds_read_b64_tr_b16 v[214:215], v15 offset:2048
v_add_f32 v226, v226, v235
v_mfma_f32_16x16x32_bf16 a[52:55], v[164:167], v[216:219], a[52:55]
v_cvt_pk_bf16_f32 v67, v234, v235
v_mfma_f32_16x16x32_bf16 a[56:59], v[168:171], v[216:219], a[56:59]
v_exp_f32 v236, v156
v_mfma_f32_16x16x32_bf16 a[60:63], v[172:175], v[216:219], a[60:63]
ds_read_b64_tr_b16 v[216:217], v14 offset:512
s_waitcnt lgkmcnt(5)
v_mfma_f32_16x16x32_bf16 a[48:51], v[176:179], v[220:223], a[48:51]
ds_read_b64_tr_b16 v[218:219], v14 offset:2560
v_mfma_f32_16x16x32_bf16 a[52:55], v[180:183], v[220:223], a[52:55]
v_exp_f32 v237, v157
v_mfma_f32_16x16x32_bf16 a[56:59], v[184:187], v[220:223], a[56:59]
v_exp_f32 v238, v158
v_add_f32 v227, v231, v236
v_cvt_pk_bf16_f32 v98, v236, v237
v_exp_f32 v239, v159
v_add_f32 v227, v227, v237
v_add_f32 v227, v227, v238
v_add_f32 v227, v227, v239
v_cvt_pk_bf16_f32 v99, v238, v239
v_max3_f32 v242, v224, v225, v226
v_max_f32 v242, v242, v227
v_cmp_lt_f32 vcc, s32, v242
s_cbranch_vccnz L2_rare_site11
L2_ret11:
v_mfma_f32_16x16x32_bf16 a[60:63], v[188:191], v[220:223], a[60:63]
ds_read_b64_tr_b16 v[220:221], v15 offset:512
s_waitcnt lgkmcnt(5)
v_mfma_f32_16x16x32_bf16 a[0:3], v[0:3], v[208:211], a[0:3]
ds_read_b64_tr_b16 v[222:223], v15 offset:2560
v_bfe_u32 v242, v248, 8, 1
v_mul_u32_u24 v242, 48, v242
v_mfma_f32_16x16x32_bf16 a[4:7], v[32:35], v[208:211], a[4:7]
v_lshl_add_u32 v242, s37, 3, v242
v_and_b32 v243, 0xf0, v248
v_lshl_add_u32 v242, v243, 3, v242
v_mfma_f32_16x16x32_bf16 a[8:11], v[64:67], v[208:211], a[8:11]
v_mov_b32 v232, v224
v_mov_b32 v234, v225
v_mov_b32 v236, v226
v_mfma_f32_16x16x32_bf16 a[12:15], v[96:99], v[208:211], a[12:15]
ds_read_b64_tr_b16 v[208:209], v249 offset:4096
s_waitcnt lgkmcnt(5)
v_mov_b32 v238, v227
v_mfma_f32_16x16x32_bf16 a[16:19], v[0:3], v[212:215], a[16:19]
ds_read_b64_tr_b16 v[210:211], v249 offset:6144
v_permlane32_swap_b32 v224, v232
v_permlane32_swap_b32 v225, v234
v_mfma_f32_16x16x32_bf16 a[20:23], v[32:35], v[212:215], a[20:23]
v_permlane32_swap_b32 v226, v236
v_permlane32_swap_b32 v227, v238
v_add_f32 v224, v224, v232
v_mfma_f32_16x16x32_bf16 a[24:27], v[64:67], v[212:215], a[24:27]
v_add_f32 v225, v225, v234
v_add_f32 v226, v226, v236
v_add_f32 v227, v227, v238
v_mfma_f32_16x16x32_bf16 a[28:31], v[96:99], v[212:215], a[28:31]
ds_read_b64_tr_b16 v[212:213], v249 offset:20480
s_waitcnt lgkmcnt(5)
v_mov_b32 v232, v224
v_mfma_f32_16x16x32_bf16 a[32:35], v[0:3], v[216:219], a[32:35]
ds_read_b64_tr_b16 v[214:215], v249 offset:22528
v_mov_b32 v234, v225
v_mov_b32 v236, v226
v_mfma_f32_16x16x32_bf16 a[36:39], v[32:35], v[216:219], a[36:39]
v_mov_b32 v238, v227
v_permlane16_swap_b32 v224, v232
v_permlane16_swap_b32 v225, v234
v_mfma_f32_16x16x32_bf16 a[40:43], v[64:67], v[216:219], a[40:43]
v_permlane16_swap_b32 v226, v236
v_permlane16_swap_b32 v227, v238
v_add_f32 v233, v224, v232
v_mfma_f32_16x16x32_bf16 a[44:47], v[96:99], v[216:219], a[44:47]
ds_read_b64_tr_b16 v[216:217], v12 offset:4096
s_waitcnt lgkmcnt(5)
v_add_f32 v235, v225, v234
v_mfma_f32_16x16x32_bf16 a[48:51], v[0:3], v[220:223], a[48:51]
ds_read_b64_tr_b16 v[218:219], v12 offset:6144
v_add_f32 v237, v226, v236
v_add_f32 v239, v227, v238
v_mfma_f32_16x16x32_bf16 a[52:55], v[32:35], v[220:223], a[52:55]
v_mov_b32 v232, v244
v_mov_b32 v234, v245
v_mov_b32 v236, v246
v_mfma_f32_16x16x32_bf16 a[56:59], v[64:67], v[220:223], a[56:59]
v_mov_b32 v238, v247
v_mfma_f32_16x16x32_bf16 a[60:63], v[96:99], v[220:223], a[60:63]
ds_read_b64_tr_b16 v[220:221], v12 offset:20480
s_waitcnt lgkmcnt(5)
v_mfma_f32_16x16x32_bf16 a[64:67], v[4:7], v[208:211], a[64:67]
ds_read_b64_tr_b16 v[222:223], v12 offset:22528
v_mfma_f32_16x16x32_bf16 a[68:71], v[36:39], v[208:211], a[68:71]
s_mov_b32 exec_hi, 0
buffer_store_dwordx2 v[232:233], v242, s[24:27], s48 offen sc1
s_lshr_b32 s3, s41, 2
buffer_store_dwordx2 v[234:235], v242, s[24:27], s3 offen sc1
s_lshr_b32 s3, s42, 2
buffer_store_dwordx2 v[236:237], v242, s[24:27], s3 offen sc1
s_lshr_b32 s3, s43, 2
buffer_store_dwordx2 v[238:239], v242, s[24:27], s3 offen sc1
s_mov_b32 exec_hi, -1
v_mfma_f32_16x16x32_bf16 a[72:75], v[68:71], v[208:211], a[72:75]
v_accvgpr_read_b32 v128, a0
v_accvgpr_read_b32 v129, a1
v_accvgpr_read_b32 v130, a2
v_mfma_f32_16x16x32_bf16 a[76:79], v[100:103], v[208:211], a[76:79]
ds_read_b64_tr_b16 v[208:209], v14 offset:4096
s_waitcnt lgkmcnt(5)
v_accvgpr_read_b32 v131, a3
v_mfma_f32_16x16x32_bf16 a[64:67], v[8:11], v[212:215], a[64:67]
ds_read_b64_tr_b16 v[210:211], v14 offset:6144
v_cvt_pk_bf16_f32 v16, v128, v129
v_cvt_pk_bf16_f32 v17, v130, v131
v_mfma_f32_16x16x32_bf16 a[68:71], v[40:43], v[212:215], a[68:71]
v_accvgpr_read_b32 v136, a4
v_accvgpr_read_b32 v137, a5
v_accvgpr_read_b32 v138, a6
v_mfma_f32_16x16x32_bf16 a[72:75], v[72:75], v[212:215], a[72:75]
v_accvgpr_read_b32 v139, a7
v_cvt_pk_bf16_f32 v48, v136, v137
v_cvt_pk_bf16_f32 v49, v138, v139
v_mfma_f32_16x16x32_bf16 a[76:79], v[104:107], v[212:215], a[76:79]
ds_read_b64_tr_b16 v[212:213], v250 offset:4096
s_waitcnt lgkmcnt(5)
v_accvgpr_read_b32 v144, a8
v_mfma_f32_16x16x32_bf16 a[64:67], v[160:163], v[216:219], a[64:67]
ds_read_b64_tr_b16 v[214:215], v250 offset:6144
v_accvgpr_read_b32 v145, a9
v_accvgpr_read_b32 v146, a10
v_mfma_f32_16x16x32_bf16 a[68:71], v[164:167], v[216:219], a[68:71]
v_accvgpr_read_b32 v147, a11
v_cvt_pk_bf16_f32 v80, v144, v145
v_cvt_pk_bf16_f32 v81, v146, v147
v_mfma_f32_16x16x32_bf16 a[72:75], v[168:171], v[216:219], a[72:75]
v_accvgpr_read_b32 v152, a12
v_accvgpr_read_b32 v153, a13
v_accvgpr_read_b32 v154, a14
v_mfma_f32_16x16x32_bf16 a[76:79], v[172:175], v[216:219], a[76:79]
ds_read_b64_tr_b16 v[216:217], v250 offset:20480
s_waitcnt lgkmcnt(5)
v_accvgpr_read_b32 v155, a15
v_mfma_f32_16x16x32_bf16 a[64:67], v[176:179], v[220:223], a[64:67]
ds_read_b64_tr_b16 v[218:219], v250 offset:22528
v_cvt_pk_bf16_f32 v112, v152, v153
v_cvt_pk_bf16_f32 v113, v154, v155
v_mfma_f32_16x16x32_bf16 a[68:71], v[180:183], v[220:223], a[68:71]
v_accvgpr_read_b32 v132, a16
v_accvgpr_read_b32 v133, a17
v_accvgpr_read_b32 v134, a18
v_mfma_f32_16x16x32_bf16 a[72:75], v[184:187], v[220:223], a[72:75]
v_accvgpr_read_b32 v135, a19
v_cvt_pk_bf16_f32 v18, v132, v133
v_cvt_pk_bf16_f32 v19, v134, v135
v_mfma_f32_16x16x32_bf16 a[76:79], v[188:191], v[220:223], a[76:79]
ds_read_b64_tr_b16 v[220:221], v13 offset:4096
s_waitcnt lgkmcnt(5)
buffer_store_dwordx4 v[16:19], v248, s[20:23], s40 offen offset:0 sc1
v_mfma_f32_16x16x32_bf16 a[64:67], v[0:3], v[208:211], a[64:67]
ds_read_b64_tr_b16 v[222:223], v13 offset:6144
ds_write_b128 v253, v[16:19] offset:0
v_accvgpr_read_b32 v140, a20
v_mfma_f32_16x16x32_bf16 a[68:71], v[32:35], v[208:211], a[68:71]
v_accvgpr_read_b32 v141, a21
v_accvgpr_read_b32 v142, a22
v_accvgpr_read_b32 v143, a23
v_mfma_f32_16x16x32_bf16 a[72:75], v[64:67], v[208:211], a[72:75]
v_cvt_pk_bf16_f32 v50, v140, v141
v_cvt_pk_bf16_f32 v51, v142, v143
buffer_store_dwordx4 v[48:51], v248, s[20:23], s41 offen offset:0 sc1
v_mfma_f32_16x16x32_bf16 a[76:79], v[96:99], v[208:211], a[76:79]
ds_read_b64_tr_b16 v[208:209], v13 offset:20480
s_waitcnt lgkmcnt(5)
v_accvgpr_read_b32 v148, a24
v_mfma_f32_16x16x32_bf16 a[80:83], v[4:7], v[212:215], a[80:83]
ds_read_b64_tr_b16 v[210:211], v13 offset:22528
v_accvgpr_read_b32 v149, a25
v_accvgpr_read_b32 v150, a26
v_mfma_f32_16x16x32_bf16 a[84:87], v[36:39], v[212:215], a[84:87]
v_accvgpr_read_b32 v151, a27
v_cvt_pk_bf16_f32 v82, v148, v149
v_cvt_pk_bf16_f32 v83, v150, v151
v_mfma_f32_16x16x32_bf16 a[88:91], v[68:71], v[212:215], a[88:91]
buffer_store_dwordx4 v[80:83], v248, s[20:23], s42 offen offset:0 sc1
v_accvgpr_read_b32 v156, a28
v_accvgpr_read_b32 v157, a29
v_mfma_f32_16x16x32_bf16 a[92:95], v[100:103], v[212:215], a[92:95]
ds_read_b64_tr_b16 v[212:213], v15 offset:4096
s_waitcnt lgkmcnt(5)
v_accvgpr_read_b32 v158, a30
v_mfma_f32_16x16x32_bf16 a[80:83], v[8:11], v[216:219], a[80:83]
ds_read_b64_tr_b16 v[214:215], v15 offset:6144
v_accvgpr_read_b32 v159, a31
v_cvt_pk_bf16_f32 v114, v156, v157
v_mfma_f32_16x16x32_bf16 a[84:87], v[40:43], v[216:219], a[84:87]
v_cvt_pk_bf16_f32 v115, v158, v159
buffer_store_dwordx4 v[112:115], v248, s[20:23], s43 offen offset:0 sc1
v_accvgpr_read_b32 v128, a32
v_mfma_f32_16x16x32_bf16 a[88:91], v[72:75], v[216:219], a[88:91]
v_accvgpr_read_b32 v129, a33
v_accvgpr_read_b32 v130, a34
v_accvgpr_read_b32 v131, a35
v_mfma_f32_16x16x32_bf16 a[92:95], v[104:107], v[216:219], a[92:95]
ds_read_b64_tr_b16 v[216:217], v249 offset:4608
s_waitcnt lgkmcnt(5)
v_cvt_pk_bf16_f32 v20, v128, v129
v_mfma_f32_16x16x32_bf16 a[80:83], v[160:163], v[220:223], a[80:83]
ds_read_b64_tr_b16 v[218:219], v249 offset:6656
v_cvt_pk_bf16_f32 v21, v130, v131
v_accvgpr_read_b32 v136, a36
v_mfma_f32_16x16x32_bf16 a[84:87], v[164:167], v[220:223], a[84:87]
v_accvgpr_read_b32 v137, a37
v_accvgpr_read_b32 v138, a38
v_accvgpr_read_b32 v139, a39
v_mfma_f32_16x16x32_bf16 a[88:91], v[168:171], v[220:223], a[88:91]
v_cvt_pk_bf16_f32 v52, v136, v137
v_cvt_pk_bf16_f32 v53, v138, v139
v_accvgpr_read_b32 v144, a40
v_mfma_f32_16x16x32_bf16 a[92:95], v[172:175], v[220:223], a[92:95]
ds_read_b64_tr_b16 v[220:221], v249 offset:20992
s_waitcnt lgkmcnt(5)
v_accvgpr_read_b32 v145, a41
v_mfma_f32_16x16x32_bf16 a[80:83], v[176:179], v[208:211], a[80:83]
ds_read_b64_tr_b16 v[222:223], v249 offset:23040
v_accvgpr_read_b32 v146, a42
v_accvgpr_read_b32 v147, a43
v_mfma_f32_16x16x32_bf16 a[84:87], v[180:183], v[208:211], a[84:87]
v_cvt_pk_bf16_f32 v84, v144, v145
v_cvt_pk_bf16_f32 v85, v146, v147
v_accvgpr_read_b32 v152, a44
v_mfma_f32_16x16x32_bf16 a[88:91], v[184:187], v[208:211], a[88:91]
v_accvgpr_read_b32 v153, a45
v_accvgpr_read_b32 v154, a46
v_accvgpr_read_b32 v155, a47
v_mfma_f32_16x16x32_bf16 a[92:95], v[188:191], v[208:211], a[92:95]
ds_read_b64_tr_b16 v[208:209], v12 offset:4608
s_waitcnt lgkmcnt(5)
v_cvt_pk_bf16_f32 v116, v152, v153
v_mfma_f32_16x16x32_bf16 a[80:83], v[0:3], v[212:215], a[80:83]
ds_read_b64_tr_b16 v[210:211], v12 offset:6656
v_cvt_pk_bf16_f32 v117, v154, v155
v_accvgpr_read_b32 v132, a48
v_mfma_f32_16x16x32_bf16 a[84:87], v[32:35], v[212:215], a[84:87]
v_accvgpr_read_b32 v133, a49
v_accvgpr_read_b32 v134, a50
v_accvgpr_read_b32 v135, a51
v_mfma_f32_16x16x32_bf16 a[88:91], v[64:67], v[212:215], a[88:91]
v_cvt_pk_bf16_f32 v22, v132, v133
v_cvt_pk_bf16_f32 v23, v134, v135
buffer_store_dwordx4 v[20:23], v248, s[20:23], s40 offen offset:1024 sc1
v_mfma_f32_16x16x32_bf16 a[92:95], v[96:99], v[212:215], a[92:95]
ds_read_b64_tr_b16 v[212:213], v12 offset:20992
s_waitcnt lgkmcnt(5)
ds_write_b128 v253, v[20:23] offset:1024
v_mfma_f32_16x16x32_bf16 a[96:99], v[4:7], v[216:219], a[96:99]
ds_read_b64_tr_b16 v[214:215], v12 offset:23040
v_accvgpr_read_b32 v140, a52
v_accvgpr_read_b32 v141, a53
v_mfma_f32_16x16x32_bf16 a[100:103], v[36:39], v[216:219], a[100:103]
v_accvgpr_read_b32 v142, a54
v_accvgpr_read_b32 v143, a55
v_cvt_pk_bf16_f32 v54, v140, v141
v_mfma_f32_16x16x32_bf16 a[104:107], v[68:71], v[216:219], a[104:107]
v_cvt_pk_bf16_f32 v55, v142, v143
buffer_store_dwordx4 v[52:55], v248, s[20:23], s41 offen offset:1024 sc1
v_accvgpr_read_b32 v148, a56
v_mfma_f32_16x16x32_bf16 a[108:111], v[100:103], v[216:219], a[108:111]
ds_read_b64_tr_b16 v[216:217], v14 offset:4608
s_waitcnt lgkmcnt(5)
v_accvgpr_read_b32 v149, a57
v_mfma_f32_16x16x32_bf16 a[96:99], v[8:11], v[220:223], a[96:99]
ds_read_b64_tr_b16 v[218:219], v14 offset:6656
v_accvgpr_read_b32 v150, a58
v_accvgpr_read_b32 v151, a59
v_mfma_f32_16x16x32_bf16 a[100:103], v[40:43], v[220:223], a[100:103]
v_cvt_pk_bf16_f32 v86, v148, v149
v_cvt_pk_bf16_f32 v87, v150, v151
buffer_store_dwordx4 v[84:87], v248, s[20:23], s42 offen offset:1024 sc1
v_mfma_f32_16x16x32_bf16 a[104:107], v[72:75], v[220:223], a[104:107]
v_accvgpr_read_b32 v156, a60
v_accvgpr_read_b32 v157, a61
v_accvgpr_read_b32 v158, a62
v_mfma_f32_16x16x32_bf16 a[108:111], v[104:107], v[220:223], a[108:111]
ds_read_b64_tr_b16 v[220:221], v250 offset:4608
s_waitcnt lgkmcnt(5)
v_accvgpr_read_b32 v159, a63
v_mfma_f32_16x16x32_bf16 a[96:99], v[160:163], v[208:211], a[96:99]
ds_read_b64_tr_b16 v[222:223], v250 offset:6656
v_cvt_pk_bf16_f32 v118, v156, v157
v_cvt_pk_bf16_f32 v119, v158, v159
v_mfma_f32_16x16x32_bf16 a[100:103], v[164:167], v[208:211], a[100:103]
buffer_store_dwordx4 v[116:119], v248, s[20:23], s43 offen offset:1024 sc1
v_accvgpr_read_b32 v128, a64
v_accvgpr_read_b32 v129, a65
v_mfma_f32_16x16x32_bf16 a[104:107], v[168:171], v[208:211], a[104:107]
v_accvgpr_read_b32 v130, a66
v_accvgpr_read_b32 v131, a67
v_cvt_pk_bf16_f32 v24, v128, v129
v_mfma_f32_16x16x32_bf16 a[108:111], v[172:175], v[208:211], a[108:111]
ds_read_b64_tr_b16 v[208:209], v250 offset:20992
s_waitcnt lgkmcnt(5)
v_cvt_pk_bf16_f32 v25, v130, v131
v_mfma_f32_16x16x32_bf16 a[96:99], v[176:179], v[212:215], a[96:99]
ds_read_b64_tr_b16 v[210:211], v250 offset:23040
v_accvgpr_read_b32 v136, a68
v_accvgpr_read_b32 v137, a69
v_mfma_f32_16x16x32_bf16 a[100:103], v[180:183], v[212:215], a[100:103]
v_accvgpr_read_b32 v138, a70
v_accvgpr_read_b32 v139, a71
v_cvt_pk_bf16_f32 v56, v136, v137
v_mfma_f32_16x16x32_bf16 a[104:107], v[184:187], v[212:215], a[104:107]
v_cvt_pk_bf16_f32 v57, v138, v139
v_accvgpr_read_b32 v144, a72
v_accvgpr_read_b32 v145, a73
v_mfma_f32_16x16x32_bf16 a[108:111], v[188:191], v[212:215], a[108:111]
ds_read_b64_tr_b16 v[212:213], v13 offset:4608
s_waitcnt lgkmcnt(5)
v_accvgpr_read_b32 v146, a74
v_mfma_f32_16x16x32_bf16 a[96:99], v[0:3], v[216:219], a[96:99]
ds_read_b64_tr_b16 v[214:215], v13 offset:6656
v_accvgpr_read_b32 v147, a75
v_cvt_pk_bf16_f32 v88, v144, v145
v_mfma_f32_16x16x32_bf16 a[100:103], v[32:35], v[216:219], a[100:103]
v_cvt_pk_bf16_f32 v89, v146, v147
v_accvgpr_read_b32 v152, a76
v_accvgpr_read_b32 v153, a77
v_mfma_f32_16x16x32_bf16 a[104:107], v[64:67], v[216:219], a[104:107]
v_accvgpr_read_b32 v154, a78
v_accvgpr_read_b32 v155, a79
v_cvt_pk_bf16_f32 v120, v152, v153
v_mfma_f32_16x16x32_bf16 a[108:111], v[96:99], v[216:219], a[108:111]
ds_read_b64_tr_b16 v[216:217], v13 offset:20992
s_waitcnt lgkmcnt(5)
v_cvt_pk_bf16_f32 v121, v154, v155
v_mfma_f32_16x16x32_bf16 a[112:115], v[4:7], v[220:223], a[112:115]
ds_read_b64_tr_b16 v[218:219], v13 offset:23040
v_accvgpr_read_b32 v132, a80
v_accvgpr_read_b32 v133, a81
v_mfma_f32_16x16x32_bf16 a[116:119], v[36:39], v[220:223], a[116:119]
v_accvgpr_read_b32 v134, a82
v_accvgpr_read_b32 v135, a83
v_cvt_pk_bf16_f32 v26, v132, v133
v_mfma_f32_16x16x32_bf16 a[120:123], v[68:71], v[220:223], a[120:123]
v_cvt_pk_bf16_f32 v27, v134, v135
buffer_store_dwordx4 v[24:27], v248, s[20:23], s40 offen offset:2048 sc1
ds_write_b128 v253, v[24:27] offset:2048
v_mfma_f32_16x16x32_bf16 a[124:127], v[100:103], v[220:223], a[124:127]
ds_read_b64_tr_b16 v[220:221], v15 offset:4608
s_waitcnt lgkmcnt(5)
v_accvgpr_read_b32 v140, a84
v_mfma_f32_16x16x32_bf16 a[112:115], v[8:11], v[208:211], a[112:115]
ds_read_b64_tr_b16 v[222:223], v15 offset:6656
v_accvgpr_read_b32 v141, a85
v_accvgpr_read_b32 v142, a86
v_mfma_f32_16x16x32_bf16 a[116:119], v[40:43], v[208:211], a[116:119]
v_accvgpr_read_b32 v143, a87
v_cvt_pk_bf16_f32 v58, v140, v141
v_cvt_pk_bf16_f32 v59, v142, v143
v_mfma_f32_16x16x32_bf16 a[120:123], v[72:75], v[208:211], a[120:123]
buffer_store_dwordx4 v[56:59], v248, s[20:23], s41 offen offset:2048 sc1
v_accvgpr_read_b32 v148, a88
v_accvgpr_read_b32 v149, a89
v_mfma_f32_16x16x32_bf16 a[124:127], v[104:107], v[208:211], a[124:127]
ds_read_b64_tr_b16 v[208:209], v249 offset:8192
s_waitcnt lgkmcnt(5)
v_accvgpr_read_b32 v150, a90
v_mfma_f32_16x16x32_bf16 a[112:115], v[160:163], v[212:215], a[112:115]
ds_read_b64_tr_b16 v[210:211], v249 offset:10240
v_accvgpr_read_b32 v151, a91
v_cvt_pk_bf16_f32 v90, v148, v149
v_mfma_f32_16x16x32_bf16 a[116:119], v[164:167], v[212:215], a[116:119]
v_cvt_pk_bf16_f32 v91, v150, v151
buffer_store_dwordx4 v[88:91], v248, s[20:23], s42 offen offset:2048 sc1
v_accvgpr_read_b32 v156, a92
v_mfma_f32_16x16x32_bf16 a[120:123], v[168:171], v[212:215], a[120:123]
v_accvgpr_read_b32 v157, a93
v_accvgpr_read_b32 v158, a94
v_accvgpr_read_b32 v159, a95
v_mfma_f32_16x16x32_bf16 a[124:127], v[172:175], v[212:215], a[124:127]
ds_read_b64_tr_b16 v[212:213], v249 offset:24576
s_waitcnt lgkmcnt(5)
v_cvt_pk_bf16_f32 v122, v156, v157
v_mfma_f32_16x16x32_bf16 a[112:115], v[176:179], v[216:219], a[112:115]
ds_read_b64_tr_b16 v[214:215], v249 offset:26624
v_cvt_pk_bf16_f32 v123, v158, v159
buffer_store_dwordx4 v[120:123], v248, s[20:23], s43 offen offset:2048 sc1
v_mfma_f32_16x16x32_bf16 a[116:119], v[180:183], v[216:219], a[116:119]
v_accvgpr_read_b32 v128, a96
v_accvgpr_read_b32 v129, a97
v_mfma_f32_16x16x32_bf16 a[120:123], v[184:187], v[216:219], a[120:123]
v_accvgpr_read_b32 v130, a98
v_accvgpr_read_b32 v131, a99
v_mfma_f32_16x16x32_bf16 a[124:127], v[188:191], v[216:219], a[124:127]
ds_read_b64_tr_b16 v[216:217], v12 offset:8192
s_waitcnt lgkmcnt(5)
v_mfma_f32_16x16x32_bf16 a[112:115], v[0:3], v[220:223], a[112:115]
ds_read_b64_tr_b16 v[218:219], v12 offset:10240
v_cvt_pk_bf16_f32 v28, v128, v129
v_mfma_f32_16x16x32_bf16 a[116:119], v[32:35], v[220:223], a[116:119]
v_cvt_pk_bf16_f32 v29, v130, v131
v_accvgpr_read_b32 v136, a100
v_mfma_f32_16x16x32_bf16 a[120:123], v[64:67], v[220:223], a[120:123]
v_accvgpr_read_b32 v137, a101
v_accvgpr_read_b32 v138, a102
v_mfma_f32_16x16x32_bf16 a[124:127], v[96:99], v[220:223], a[124:127]
ds_read_b64_tr_b16 v[220:221], v12 offset:24576
s_waitcnt lgkmcnt(5)
v_mfma_f32_16x16x32_bf16 a[128:131], v[4:7], v[208:211], a[128:131]
ds_read_b64_tr_b16 v[222:223], v12 offset:26624
v_accvgpr_read_b32 v139, a103
v_mfma_f32_16x16x32_bf16 a[132:135], v[36:39], v[208:211], a[132:135]
v_cvt_pk_bf16_f32 v60, v136, v137
v_cvt_pk_bf16_f32 v61, v138, v139
v_mfma_f32_16x16x32_bf16 a[136:139], v[68:71], v[208:211], a[136:139]
v_accvgpr_read_b32 v144, a104
v_accvgpr_read_b32 v145, a105
v_mfma_f32_16x16x32_bf16 a[140:143], v[100:103], v[208:211], a[140:143]
ds_read_b64_tr_b16 v[208:209], v14 offset:8192
s_waitcnt lgkmcnt(5)
v_mfma_f32_16x16x32_bf16 a[128:131], v[8:11], v[212:215], a[128:131]
ds_read_b64_tr_b16 v[210:211], v14 offset:10240
v_accvgpr_read_b32 v146, a106
v_mfma_f32_16x16x32_bf16 a[132:135], v[40:43], v[212:215], a[132:135]
v_accvgpr_read_b32 v147, a107
v_cvt_pk_bf16_f32 v92, v144, v145
v_mfma_f32_16x16x32_bf16 a[136:139], v[72:75], v[212:215], a[136:139]
v_cvt_pk_bf16_f32 v93, v146, v147
v_accvgpr_read_b32 v152, a108
v_mfma_f32_16x16x32_bf16 a[140:143], v[104:107], v[212:215], a[140:143]
ds_read_b64_tr_b16 v[212:213], v250 offset:8192
s_waitcnt lgkmcnt(5)
v_mfma_f32_16x16x32_bf16 a[128:131], v[160:163], v[216:219], a[128:131]
ds_read_b64_tr_b16 v[214:215], v250 offset:10240
v_accvgpr_read_b32 v153, a109
v_mfma_f32_16x16x32_bf16 a[132:135], v[164:167], v[216:219], a[132:135]
v_accvgpr_read_b32 v154, a110
v_accvgpr_read_b32 v155, a111
v_mfma_f32_16x16x32_bf16 a[136:139], v[168:171], v[216:219], a[136:139]
v_cvt_pk_bf16_f32 v124, v152, v153
v_cvt_pk_bf16_f32 v125, v154, v155
v_mfma_f32_16x16x32_bf16 a[140:143], v[172:175], v[216:219], a[140:143]
ds_read_b64_tr_b16 v[216:217], v250 offset:24576
s_waitcnt lgkmcnt(5)
v_mfma_f32_16x16x32_bf16 a[128:131], v[176:179], v[220:223], a[128:131]
ds_read_b64_tr_b16 v[218:219], v250 offset:26624
v_accvgpr_read_b32 v132, a112
v_mfma_f32_16x16x32_bf16 a[132:135], v[180:183], v[220:223], a[132:135]
v_accvgpr_read_b32 v133, a113
v_accvgpr_read_b32 v134, a114
v_mfma_f32_16x16x32_bf16 a[136:139], v[184:187], v[220:223], a[136:139]
v_accvgpr_read_b32 v135, a115
v_cvt_pk_bf16_f32 v30, v132, v133
v_mfma_f32_16x16x32_bf16 a[140:143], v[188:191], v[220:223], a[140:143]
ds_read_b64_tr_b16 v[220:221], v13 offset:8192
s_waitcnt lgkmcnt(5)
v_mfma_f32_16x16x32_bf16 a[128:131], v[0:3], v[208:211], a[128:131]
ds_read_b64_tr_b16 v[222:223], v13 offset:10240
v_cvt_pk_bf16_f32 v31, v134, v135
v_mfma_f32_16x16x32_bf16 a[132:135], v[32:35], v[208:211], a[132:135]
buffer_store_dwordx4 v[28:31], v248, s[20:23], s40 offen offset:3072 sc1
ds_write_b128 v253, v[28:31] offset:3072
v_mfma_f32_16x16x32_bf16 a[136:139], v[64:67], v[208:211], a[136:139]
v_accvgpr_read_b32 v140, a116
v_accvgpr_read_b32 v141, a117
v_mfma_f32_16x16x32_bf16 a[140:143], v[96:99], v[208:211], a[140:143]
ds_read_b64_tr_b16 v[208:209], v13 offset:24576
s_waitcnt lgkmcnt(5)
v_mfma_f32_16x16x32_bf16 a[144:147], v[4:7], v[212:215], a[144:147]
ds_read_b64_tr_b16 v[210:211], v13 offset:26624
v_accvgpr_read_b32 v142, a118
v_mfma_f32_16x16x32_bf16 a[148:151], v[36:39], v[212:215], a[148:151]
v_accvgpr_read_b32 v143, a119
v_cvt_pk_bf16_f32 v62, v140, v141
v_mfma_f32_16x16x32_bf16 a[152:155], v[68:71], v[212:215], a[152:155]
v_cvt_pk_bf16_f32 v63, v142, v143
buffer_store_dwordx4 v[60:63], v248, s[20:23], s41 offen offset:3072 sc1
v_mfma_f32_16x16x32_bf16 a[156:159], v[100:103], v[212:215], a[156:159]
ds_read_b64_tr_b16 v[212:213], v15 offset:8192
s_waitcnt lgkmcnt(5)
v_mfma_f32_16x16x32_bf16 a[144:147], v[8:11], v[216:219], a[144:147]
ds_read_b64_tr_b16 v[214:215], v15 offset:10240
v_accvgpr_read_b32 v148, a120
v_mfma_f32_16x16x32_bf16 a[148:151], v[40:43], v[216:219], a[148:151]
v_accvgpr_read_b32 v149, a121
v_accvgpr_read_b32 v150, a122
v_mfma_f32_16x16x32_bf16 a[152:155], v[72:75], v[216:219], a[152:155]
v_accvgpr_read_b32 v151, a123
v_cvt_pk_bf16_f32 v94, v148, v149
v_mfma_f32_16x16x32_bf16 a[156:159], v[104:107], v[216:219], a[156:159]
ds_read_b64_tr_b16 v[216:217], v249 offset:8704
s_waitcnt lgkmcnt(5)
v_mfma_f32_16x16x32_bf16 a[144:147], v[160:163], v[220:223], a[144:147]
ds_read_b64_tr_b16 v[218:219], v249 offset:10752
v_cvt_pk_bf16_f32 v95, v150, v151
v_mfma_f32_16x16x32_bf16 a[148:151], v[164:167], v[220:223], a[148:151]
buffer_store_dwordx4 v[92:95], v248, s[20:23], s42 offen offset:3072 sc1
v_accvgpr_read_b32 v156, a124
v_mfma_f32_16x16x32_bf16 a[152:155], v[168:171], v[220:223], a[152:155]
v_accvgpr_read_b32 v157, a125
v_accvgpr_read_b32 v158, a126
v_mfma_f32_16x16x32_bf16 a[156:159], v[172:175], v[220:223], a[156:159]
ds_read_b64_tr_b16 v[220:221], v249 offset:25088
s_waitcnt lgkmcnt(5)
v_mfma_f32_16x16x32_bf16 a[144:147], v[176:179], v[208:211], a[144:147]
ds_read_b64_tr_b16 v[222:223], v249 offset:27136
v_accvgpr_read_b32 v159, a127
v_mfma_f32_16x16x32_bf16 a[148:151], v[180:183], v[208:211], a[148:151]
v_cvt_pk_bf16_f32 v126, v156, v157
v_cvt_pk_bf16_f32 v127, v158, v159
v_mfma_f32_16x16x32_bf16 a[152:155], v[184:187], v[208:211], a[152:155]
buffer_store_dwordx4 v[124:127], v248, s[20:23], s43 offen offset:3072 sc1
v_accvgpr_read_b32 v128, a128
v_mfma_f32_16x16x32_bf16 a[156:159], v[188:191], v[208:211], a[156:159]
ds_read_b64_tr_b16 v[208:209], v12 offset:8704
s_waitcnt lgkmcnt(5)
v_mfma_f32_16x16x32_bf16 a[144:147], v[0:3], v[212:215], a[144:147]
ds_read_b64_tr_b16 v[210:211], v12 offset:10752
v_accvgpr_read_b32 v129, a129
v_mfma_f32_16x16x32_bf16 a[148:151], v[32:35], v[212:215], a[148:151]
v_accvgpr_read_b32 v130, a130
v_accvgpr_read_b32 v131, a131
v_mfma_f32_16x16x32_bf16 a[152:155], v[64:67], v[212:215], a[152:155]
v_cvt_pk_bf16_f32 v16, v128, v129
v_cvt_pk_bf16_f32 v17, v130, v131
v_mfma_f32_16x16x32_bf16 a[156:159], v[96:99], v[212:215], a[156:159]
ds_read_b64_tr_b16 v[212:213], v12 offset:25088
s_waitcnt lgkmcnt(5)
v_mfma_f32_16x16x32_bf16 a[160:163], v[4:7], v[216:219], a[160:163]
ds_read_b64_tr_b16 v[214:215], v12 offset:27136
v_accvgpr_read_b32 v136, a132
v_mfma_f32_16x16x32_bf16 a[164:167], v[36:39], v[216:219], a[164:167]
v_accvgpr_read_b32 v137, a133
v_accvgpr_read_b32 v138, a134
v_mfma_f32_16x16x32_bf16 a[168:171], v[68:71], v[216:219], a[168:171]
v_accvgpr_read_b32 v139, a135
v_cvt_pk_bf16_f32 v48, v136, v137
v_mfma_f32_16x16x32_bf16 a[172:175], v[100:103], v[216:219], a[172:175]
ds_read_b64_tr_b16 v[216:217], v14 offset:8704
s_waitcnt lgkmcnt(5)
v_mfma_f32_16x16x32_bf16 a[160:163], v[8:11], v[220:223], a[160:163]
ds_read_b64_tr_b16 v[218:219], v14 offset:10752
v_cvt_pk_bf16_f32 v49, v138, v139
v_mfma_f32_16x16x32_bf16 a[164:167], v[40:43], v[220:223], a[164:167]
v_accvgpr_read_b32 v144, a136
v_accvgpr_read_b32 v145, a137
v_mfma_f32_16x16x32_bf16 a[168:171], v[72:75], v[220:223], a[168:171]
v_accvgpr_read_b32 v146, a138
v_accvgpr_read_b32 v147, a139
v_mfma_f32_16x16x32_bf16 a[172:175], v[104:107], v[220:223], a[172:175]
ds_read_b64_tr_b16 v[220:221], v250 offset:8704
s_waitcnt lgkmcnt(5)
v_mfma_f32_16x16x32_bf16 a[160:163], v[160:163], v[208:211], a[160:163]
ds_read_b64_tr_b16 v[222:223], v250 offset:10752
v_cvt_pk_bf16_f32 v80, v144, v145
v_mfma_f32_16x16x32_bf16 a[164:167], v[164:167], v[208:211], a[164:167]
v_cvt_pk_bf16_f32 v81, v146, v147
v_accvgpr_read_b32 v152, a140
v_mfma_f32_16x16x32_bf16 a[168:171], v[168:171], v[208:211], a[168:171]
v_accvgpr_read_b32 v153, a141
v_accvgpr_read_b32 v154, a142
v_mfma_f32_16x16x32_bf16 a[172:175], v[172:175], v[208:211], a[172:175]
ds_read_b64_tr_b16 v[208:209], v250 offset:25088
s_waitcnt lgkmcnt(5)
v_mfma_f32_16x16x32_bf16 a[160:163], v[176:179], v[212:215], a[160:163]
ds_read_b64_tr_b16 v[210:211], v250 offset:27136
v_accvgpr_read_b32 v155, a143
v_mfma_f32_16x16x32_bf16 a[164:167], v[180:183], v[212:215], a[164:167]
v_cvt_pk_bf16_f32 v112, v152, v153
v_cvt_pk_bf16_f32 v113, v154, v155
v_mfma_f32_16x16x32_bf16 a[168:171], v[184:187], v[212:215], a[168:171]
v_accvgpr_read_b32 v132, a144
v_accvgpr_read_b32 v133, a145
v_mfma_f32_16x16x32_bf16 a[172:175], v[188:191], v[212:215], a[172:175]
ds_read_b64_tr_b16 v[212:213], v13 offset:8704
s_waitcnt lgkmcnt(5)
v_mfma_f32_16x16x32_bf16 a[160:163], v[0:3], v[216:219], a[160:163]
ds_read_b64_tr_b16 v[214:215], v13 offset:10752
v_accvgpr_read_b32 v134, a146
v_mfma_f32_16x16x32_bf16 a[164:167], v[32:35], v[216:219], a[164:167]
v_accvgpr_read_b32 v135, a147
v_cvt_pk_bf16_f32 v18, v132, v133
v_mfma_f32_16x16x32_bf16 a[168:171], v[64:67], v[216:219], a[168:171]
v_cvt_pk_bf16_f32 v19, v134, v135
buffer_store_dwordx4 v[16:19], v248, s[20:23], s44 offen offset:0 sc1
v_mfma_f32_16x16x32_bf16 a[172:175], v[96:99], v[216:219], a[172:175]
ds_read_b64_tr_b16 v[216:217], v13 offset:25088
s_waitcnt lgkmcnt(5)
v_mfma_f32_16x16x32_bf16 a[176:179], v[4:7], v[220:223], a[176:179]
ds_read_b64_tr_b16 v[218:219], v13 offset:27136
ds_write_b128 v253, v[16:19] offset:4096
v_mfma_f32_16x16x32_bf16 a[180:183], v[36:39], v[220:223], a[180:183]
v_accvgpr_read_b32 v140, a148
v_accvgpr_read_b32 v141, a149
v_mfma_f32_16x16x32_bf16 a[184:187], v[68:71], v[220:223], a[184:187]
v_accvgpr_read_b32 v142, a150
v_accvgpr_read_b32 v143, a151
v_mfma_f32_16x16x32_bf16 a[188:191], v[100:103], v[220:223], a[188:191]
ds_read_b64_tr_b16 v[220:221], v15 offset:8704
s_waitcnt lgkmcnt(5)
v_mfma_f32_16x16x32_bf16 a[176:179], v[8:11], v[208:211], a[176:179]
ds_read_b64_tr_b16 v[222:223], v15 offset:10752
v_cvt_pk_bf16_f32 v50, v140, v141
v_mfma_f32_16x16x32_bf16 a[180:183], v[40:43], v[208:211], a[180:183]
v_cvt_pk_bf16_f32 v51, v142, v143
buffer_store_dwordx4 v[48:51], v248, s[20:23], s45 offen offset:0 sc1
v_mfma_f32_16x16x32_bf16 a[184:187], v[72:75], v[208:211], a[184:187]
v_accvgpr_read_b32 v148, a152
v_accvgpr_read_b32 v149, a153
v_mfma_f32_16x16x32_bf16 a[188:191], v[104:107], v[208:211], a[188:191]
ds_read_b64_tr_b16 v[208:209], v249 offset:12288
s_waitcnt lgkmcnt(5)
v_mfma_f32_16x16x32_bf16 a[176:179], v[160:163], v[212:215], a[176:179]
ds_read_b64_tr_b16 v[210:211], v249 offset:14336
v_accvgpr_read_b32 v150, a154
v_mfma_f32_16x16x32_bf16 a[180:183], v[164:167], v[212:215], a[180:183]
v_accvgpr_read_b32 v151, a155
v_cvt_pk_bf16_f32 v82, v148, v149
v_mfma_f32_16x16x32_bf16 a[184:187], v[168:171], v[212:215], a[184:187]
v_cvt_pk_bf16_f32 v83, v150, v151
buffer_store_dwordx4 v[80:83], v248, s[20:23], s46 offen offset:0 sc1
v_mfma_f32_16x16x32_bf16 a[188:191], v[172:175], v[212:215], a[188:191]
ds_read_b64_tr_b16 v[212:213], v249 offset:28672
s_waitcnt lgkmcnt(5)
v_mfma_f32_16x16x32_bf16 a[176:179], v[176:179], v[216:219], a[176:179]
ds_read_b64_tr_b16 v[214:215], v249 offset:30720
v_accvgpr_read_b32 v156, a156
v_mfma_f32_16x16x32_bf16 a[180:183], v[180:183], v[216:219], a[180:183]
v_accvgpr_read_b32 v157, a157
v_accvgpr_read_b32 v158, a158
v_mfma_f32_16x16x32_bf16 a[184:187], v[184:187], v[216:219], a[184:187]
v_accvgpr_read_b32 v159, a159
v_cvt_pk_bf16_f32 v114, v156, v157
v_mfma_f32_16x16x32_bf16 a[188:191], v[188:191], v[216:219], a[188:191]
ds_read_b64_tr_b16 v[216:217], v12 offset:12288
s_waitcnt lgkmcnt(5)
v_mfma_f32_16x16x32_bf16 a[176:179], v[0:3], v[220:223], a[176:179]
ds_read_b64_tr_b16 v[218:219], v12 offset:14336
v_cvt_pk_bf16_f32 v115, v158, v159
v_mfma_f32_16x16x32_bf16 a[180:183], v[32:35], v[220:223], a[180:183]
buffer_store_dwordx4 v[112:115], v248, s[20:23], s47 offen offset:0 sc1
v_accvgpr_read_b32 v128, a160
v_mfma_f32_16x16x32_bf16 a[184:187], v[64:67], v[220:223], a[184:187]
v_accvgpr_read_b32 v129, a161
v_accvgpr_read_b32 v130, a162
v_mfma_f32_16x16x32_bf16 a[188:191], v[96:99], v[220:223], a[188:191]
ds_read_b64_tr_b16 v[220:221], v12 offset:28672
s_waitcnt lgkmcnt(5)
v_mfma_f32_16x16x32_bf16 a[192:195], v[4:7], v[208:211], a[192:195]
ds_read_b64_tr_b16 v[222:223], v12 offset:30720
v_accvgpr_read_b32 v131, a163
v_mfma_f32_16x16x32_bf16 a[196:199], v[36:39], v[208:211], a[196:199]
v_cvt_pk_bf16_f32 v20, v128, v129
v_cvt_pk_bf16_f32 v21, v130, v131
v_mfma_f32_16x16x32_bf16 a[200:203], v[68:71], v[208:211], a[200:203]
v_accvgpr_read_b32 v136, a164
v_accvgpr_read_b32 v137, a165
v_mfma_f32_16x16x32_bf16 a[204:207], v[100:103], v[208:211], a[204:207]
ds_read_b64_tr_b16 v[208:209], v14 offset:12288
s_waitcnt lgkmcnt(5)
v_mfma_f32_16x16x32_bf16 a[192:195], v[8:11], v[212:215], a[192:195]
ds_read_b64_tr_b16 v[210:211], v14 offset:14336
v_accvgpr_read_b32 v138, a166
v_mfma_f32_16x16x32_bf16 a[196:199], v[40:43], v[212:215], a[196:199]
v_accvgpr_read_b32 v139, a167
v_cvt_pk_bf16_f32 v52, v136, v137
v_mfma_f32_16x16x32_bf16 a[200:203], v[72:75], v[212:215], a[200:203]
v_cvt_pk_bf16_f32 v53, v138, v139
v_accvgpr_read_b32 v144, a168
v_mfma_f32_16x16x32_bf16 a[204:207], v[104:107], v[212:215], a[204:207]
ds_read_b64_tr_b16 v[212:213], v250 offset:12288
s_waitcnt lgkmcnt(5)
v_mfma_f32_16x16x32_bf16 a[192:195], v[160:163], v[216:219], a[192:195]
ds_read_b64_tr_b16 v[214:215], v250 offset:14336
v_accvgpr_read_b32 v145, a169
v_mfma_f32_16x16x32_bf16 a[196:199], v[164:167], v[216:219], a[196:199]
v_accvgpr_read_b32 v146, a170
v_accvgpr_read_b32 v147, a171
v_mfma_f32_16x16x32_bf16 a[200:203], v[168:171], v[216:219], a[200:203]
v_cvt_pk_bf16_f32 v84, v144, v145
v_cvt_pk_bf16_f32 v85, v146, v147
v_mfma_f32_16x16x32_bf16 a[204:207], v[172:175], v[216:219], a[204:207]
ds_read_b64_tr_b16 v[216:217], v250 offset:28672
s_waitcnt lgkmcnt(5)
v_mfma_f32_16x16x32_bf16 a[192:195], v[176:179], v[220:223], a[192:195]
ds_read_b64_tr_b16 v[218:219], v250 offset:30720
v_accvgpr_read_b32 v152, a172
v_mfma_f32_16x16x32_bf16 a[196:199], v[180:183], v[220:223], a[196:199]
v_accvgpr_read_b32 v153, a173
v_accvgpr_read_b32 v154, a174
v_mfma_f32_16x16x32_bf16 a[200:203], v[184:187], v[220:223], a[200:203]
v_accvgpr_read_b32 v155, a175
v_cvt_pk_bf16_f32 v116, v152, v153
v_mfma_f32_16x16x32_bf16 a[204:207], v[188:191], v[220:223], a[204:207]
ds_read_b64_tr_b16 v[220:221], v13 offset:12288
s_waitcnt lgkmcnt(5)
v_mfma_f32_16x16x32_bf16 a[192:195], v[0:3], v[208:211], a[192:195]
ds_read_b64_tr_b16 v[222:223], v13 offset:14336
v_cvt_pk_bf16_f32 v117, v154, v155
v_mfma_f32_16x16x32_bf16 a[196:199], v[32:35], v[208:211], a[196:199]
v_accvgpr_read_b32 v132, a176
v_accvgpr_read_b32 v133, a177
v_mfma_f32_16x16x32_bf16 a[200:203], v[64:67], v[208:211], a[200:203]
v_accvgpr_read_b32 v134, a178
v_accvgpr_read_b32 v135, a179
v_mfma_f32_16x16x32_bf16 a[204:207], v[96:99], v[208:211], a[204:207]
ds_read_b64_tr_b16 v[208:209], v13 offset:28672
s_waitcnt lgkmcnt(5)
v_mfma_f32_16x16x32_bf16 a[208:211], v[4:7], v[212:215], a[208:211]
ds_read_b64_tr_b16 v[210:211], v13 offset:30720
v_cvt_pk_bf16_f32 v22, v132, v133
v_mfma_f32_16x16x32_bf16 a[212:215], v[36:39], v[212:215], a[212:215]
v_cvt_pk_bf16_f32 v23, v134, v135
buffer_store_dwordx4 v[20:23], v248, s[20:23], s44 offen offset:1024 sc1
v_mfma_f32_16x16x32_bf16 a[216:219], v[68:71], v[212:215], a[216:219]
ds_write_b128 v253, v[20:23] offset:5120
v_accvgpr_read_b32 v140, a180
v_mfma_f32_16x16x32_bf16 a[220:223], v[100:103], v[212:215], a[220:223]
ds_read_b64_tr_b16 v[212:213], v15 offset:12288
s_waitcnt lgkmcnt(5)
v_mfma_f32_16x16x32_bf16 a[208:211], v[8:11], v[216:219], a[208:211]
ds_read_b64_tr_b16 v[214:215], v15 offset:14336
v_accvgpr_read_b32 v141, a181
v_mfma_f32_16x16x32_bf16 a[212:215], v[40:43], v[216:219], a[212:215]
v_accvgpr_read_b32 v142, a182
v_accvgpr_read_b32 v143, a183
v_mfma_f32_16x16x32_bf16 a[216:219], v[72:75], v[216:219], a[216:219]
v_cvt_pk_bf16_f32 v54, v140, v141
v_cvt_pk_bf16_f32 v55, v142, v143
v_mfma_f32_16x16x32_bf16 a[220:223], v[104:107], v[216:219], a[220:223]
ds_read_b64_tr_b16 v[216:217], v249 offset:12800
s_waitcnt lgkmcnt(5)
v_mfma_f32_16x16x32_bf16 a[208:211], v[160:163], v[220:223], a[208:211]
ds_read_b64_tr_b16 v[218:219], v249 offset:14848
buffer_store_dwordx4 v[52:55], v248, s[20:23], s45 offen offset:1024 sc1
v_mfma_f32_16x16x32_bf16 a[212:215], v[164:167], v[220:223], a[212:215]
v_accvgpr_read_b32 v148, a184
v_accvgpr_read_b32 v149, a185
v_mfma_f32_16x16x32_bf16 a[216:219], v[168:171], v[220:223], a[216:219]
v_accvgpr_read_b32 v150, a186
v_accvgpr_read_b32 v151, a187
v_mfma_f32_16x16x32_bf16 a[220:223], v[172:175], v[220:223], a[220:223]
ds_read_b64_tr_b16 v[220:221], v249 offset:29184
s_waitcnt lgkmcnt(5)
v_mfma_f32_16x16x32_bf16 a[208:211], v[176:179], v[208:211], a[208:211]
ds_read_b64_tr_b16 v[222:223], v249 offset:31232
v_cvt_pk_bf16_f32 v86, v148, v149
v_mfma_f32_16x16x32_bf16 a[212:215], v[180:183], v[208:211], a[212:215]
v_cvt_pk_bf16_f32 v87, v150, v151
buffer_store_dwordx4 v[84:87], v248, s[20:23], s46 offen offset:1024 sc1
v_mfma_f32_16x16x32_bf16 a[216:219], v[184:187], v[208:211], a[216:219]
v_accvgpr_read_b32 v156, a188
v_accvgpr_read_b32 v157, a189
v_mfma_f32_16x16x32_bf16 a[220:223], v[188:191], v[208:211], a[220:223]
ds_read_b64_tr_b16 v[208:209], v12 offset:12800
s_waitcnt lgkmcnt(5)
v_mfma_f32_16x16x32_bf16 a[208:211], v[0:3], v[212:215], a[208:211]
ds_read_b64_tr_b16 v[210:211], v12 offset:14848
v_accvgpr_read_b32 v158, a190
v_mfma_f32_16x16x32_bf16 a[212:215], v[32:35], v[212:215], a[212:215]
v_accvgpr_read_b32 v159, a191
v_cvt_pk_bf16_f32 v118, v156, v157
v_mfma_f32_16x16x32_bf16 a[216:219], v[64:67], v[212:215], a[216:219]
v_cvt_pk_bf16_f32 v119, v158, v159
buffer_store_dwordx4 v[116:119], v248, s[20:23], s47 offen offset:1024 sc1
v_mfma_f32_16x16x32_bf16 a[220:223], v[96:99], v[212:215], a[220:223]
ds_read_b64_tr_b16 v[212:213], v12 offset:29184
s_waitcnt lgkmcnt(5)
v_mfma_f32_16x16x32_bf16 a[224:227], v[4:7], v[216:219], a[224:227]
ds_read_b64_tr_b16 v[214:215], v12 offset:31232
v_accvgpr_read_b32 v128, a192
v_mfma_f32_16x16x32_bf16 a[228:231], v[36:39], v[216:219], a[228:231]
v_accvgpr_read_b32 v129, a193
v_accvgpr_read_b32 v130, a194
v_mfma_f32_16x16x32_bf16 a[232:235], v[68:71], v[216:219], a[232:235]
v_accvgpr_read_b32 v131, a195
v_cvt_pk_bf16_f32 v24, v128, v129
v_mfma_f32_16x16x32_bf16 a[236:239], v[100:103], v[216:219], a[236:239]
ds_read_b64_tr_b16 v[216:217], v14 offset:12800
s_waitcnt lgkmcnt(5)
v_mfma_f32_16x16x32_bf16 a[224:227], v[8:11], v[220:223], a[224:227]
ds_read_b64_tr_b16 v[218:219], v14 offset:14848
v_cvt_pk_bf16_f32 v25, v130, v131
v_mfma_f32_16x16x32_bf16 a[228:231], v[40:43], v[220:223], a[228:231]
v_accvgpr_read_b32 v136, a196
v_accvgpr_read_b32 v137, a197
v_mfma_f32_16x16x32_bf16 a[232:235], v[72:75], v[220:223], a[232:235]
v_accvgpr_read_b32 v138, a198
v_accvgpr_read_b32 v139, a199
v_mfma_f32_16x16x32_bf16 a[236:239], v[104:107], v[220:223], a[236:239]
ds_read_b64_tr_b16 v[220:221], v250 offset:12800
s_waitcnt lgkmcnt(5)
v_mfma_f32_16x16x32_bf16 a[224:227], v[160:163], v[208:211], a[224:227]
ds_read_b64_tr_b16 v[222:223], v250 offset:14848
v_cvt_pk_bf16_f32 v56, v136, v137
v_mfma_f32_16x16x32_bf16 a[228:231], v[164:167], v[208:211], a[228:231]
v_cvt_pk_bf16_f32 v57, v138, v139
v_accvgpr_read_b32 v144, a200
v_mfma_f32_16x16x32_bf16 a[232:235], v[168:171], v[208:211], a[232:235]
v_accvgpr_read_b32 v145, a201
v_accvgpr_read_b32 v146, a202
v_mfma_f32_16x16x32_bf16 a[236:239], v[172:175], v[208:211], a[236:239]
ds_read_b64_tr_b16 v[208:209], v250 offset:29184
s_waitcnt lgkmcnt(5)
v_mfma_f32_16x16x32_bf16 a[224:227], v[176:179], v[212:215], a[224:227]
ds_read_b64_tr_b16 v[210:211], v250 offset:31232
v_accvgpr_read_b32 v147, a203
v_mfma_f32_16x16x32_bf16 a[228:231], v[180:183], v[212:215], a[228:231]
v_cvt_pk_bf16_f32 v88, v144, v145
v_cvt_pk_bf16_f32 v89, v146, v147
v_mfma_f32_16x16x32_bf16 a[232:235], v[184:187], v[212:215], a[232:235]
v_accvgpr_read_b32 v152, a204
v_accvgpr_read_b32 v153, a205
v_mfma_f32_16x16x32_bf16 a[236:239], v[188:191], v[212:215], a[236:239]
ds_read_b64_tr_b16 v[212:213], v13 offset:12800
s_waitcnt lgkmcnt(5)
v_mfma_f32_16x16x32_bf16 a[224:227], v[0:3], v[216:219], a[224:227]
ds_read_b64_tr_b16 v[214:215], v13 offset:14848
v_accvgpr_read_b32 v154, a206
v_mfma_f32_16x16x32_bf16 a[228:231], v[32:35], v[216:219], a[228:231]
v_accvgpr_read_b32 v155, a207
v_cvt_pk_bf16_f32 v120, v152, v153
v_mfma_f32_16x16x32_bf16 a[232:235], v[64:67], v[216:219], a[232:235]
v_cvt_pk_bf16_f32 v121, v154, v155
v_accvgpr_read_b32 v132, a208
v_mfma_f32_16x16x32_bf16 a[236:239], v[96:99], v[216:219], a[236:239]
ds_read_b64_tr_b16 v[216:217], v13 offset:29184
s_waitcnt lgkmcnt(5)
v_mfma_f32_16x16x32_bf16 a[240:243], v[4:7], v[220:223], a[240:243]
ds_read_b64_tr_b16 v[218:219], v13 offset:31232
v_accvgpr_read_b32 v133, a209
v_mfma_f32_16x16x32_bf16 a[244:247], v[36:39], v[220:223], a[244:247]
v_accvgpr_read_b32 v134, a210
v_accvgpr_read_b32 v135, a211
v_mfma_f32_16x16x32_bf16 a[248:251], v[68:71], v[220:223], a[248:251]
v_cvt_pk_bf16_f32 v26, v132, v133
v_cvt_pk_bf16_f32 v27, v134, v135
v_mfma_f32_16x16x32_bf16 a[252:255], v[100:103], v[220:223], a[252:255]
ds_read_b64_tr_b16 v[220:221], v15 offset:12800
s_waitcnt lgkmcnt(5)
v_mfma_f32_16x16x32_bf16 a[240:243], v[8:11], v[208:211], a[240:243]
ds_read_b64_tr_b16 v[222:223], v15 offset:14848
buffer_store_dwordx4 v[24:27], v248, s[20:23], s44 offen offset:2048 sc1
v_mfma_f32_16x16x32_bf16 a[244:247], v[40:43], v[208:211], a[244:247]
ds_write_b128 v253, v[24:27] offset:6144
v_accvgpr_read_b32 v140, a212
v_mfma_f32_16x16x32_bf16 a[248:251], v[72:75], v[208:211], a[248:251]
v_accvgpr_read_b32 v141, a213
v_accvgpr_read_b32 v142, a214
v_mfma_f32_16x16x32_bf16 a[252:255], v[104:107], v[208:211], a[252:255]
s_waitcnt lgkmcnt(4)
v_accvgpr_read_b32 v143, a215
v_mfma_f32_16x16x32_bf16 a[240:243], v[160:163], v[212:215], a[240:243]
v_cvt_pk_bf16_f32 v58, v140, v141
v_cvt_pk_bf16_f32 v59, v142, v143
v_mfma_f32_16x16x32_bf16 a[244:247], v[164:167], v[212:215], a[244:247]
buffer_store_dwordx4 v[56:59], v248, s[20:23], s45 offen offset:2048 sc1
v_accvgpr_read_b32 v148, a216
v_mfma_f32_16x16x32_bf16 a[248:251], v[168:171], v[212:215], a[248:251]
v_accvgpr_read_b32 v149, a217
v_accvgpr_read_b32 v150, a218
v_mfma_f32_16x16x32_bf16 a[252:255], v[172:175], v[212:215], a[252:255]
s_waitcnt lgkmcnt(2)
v_accvgpr_read_b32 v151, a219
v_mfma_f32_16x16x32_bf16 a[240:243], v[176:179], v[216:219], a[240:243]
v_cvt_pk_bf16_f32 v90, v148, v149
v_cvt_pk_bf16_f32 v91, v150, v151
v_mfma_f32_16x16x32_bf16 a[244:247], v[180:183], v[216:219], a[244:247]
buffer_store_dwordx4 v[88:91], v248, s[20:23], s46 offen offset:2048 sc1
v_accvgpr_read_b32 v156, a220
v_mfma_f32_16x16x32_bf16 a[248:251], v[184:187], v[216:219], a[248:251]
v_accvgpr_read_b32 v157, a221
v_accvgpr_read_b32 v158, a222
v_mfma_f32_16x16x32_bf16 a[252:255], v[188:191], v[216:219], a[252:255]
s_waitcnt lgkmcnt(0)
v_accvgpr_read_b32 v159, a223
v_mfma_f32_16x16x32_bf16 a[240:243], v[0:3], v[220:223], a[240:243]
v_cvt_pk_bf16_f32 v122, v156, v157
v_cvt_pk_bf16_f32 v123, v158, v159
v_mfma_f32_16x16x32_bf16 a[244:247], v[32:35], v[220:223], a[244:247]
buffer_store_dwordx4 v[120:123], v248, s[20:23], s47 offen offset:2048 sc1
v_accvgpr_read_b32 v128, a224
v_mfma_f32_16x16x32_bf16 a[248:251], v[64:67], v[220:223], a[248:251]
v_accvgpr_read_b32 v129, a225
v_accvgpr_read_b32 v130, a226
v_mfma_f32_16x16x32_bf16 a[252:255], v[96:99], v[220:223], a[252:255]
v_accvgpr_read_b32 v131, a227
v_cvt_pk_bf16_f32 v28, v128, v129
v_cvt_pk_bf16_f32 v29, v130, v131
v_accvgpr_read_b32 v136, a228
v_accvgpr_read_b32 v137, a229
v_accvgpr_read_b32 v138, a230
v_accvgpr_read_b32 v139, a231
v_cvt_pk_bf16_f32 v60, v136, v137
v_cvt_pk_bf16_f32 v61, v138, v139
v_accvgpr_read_b32 v144, a232
v_accvgpr_read_b32 v145, a233
v_accvgpr_read_b32 v146, a234
v_accvgpr_read_b32 v147, a235
v_cvt_pk_bf16_f32 v92, v144, v145
v_cvt_pk_bf16_f32 v93, v146, v147
v_accvgpr_read_b32 v152, a236
v_accvgpr_read_b32 v153, a237
v_accvgpr_read_b32 v154, a238
v_accvgpr_read_b32 v155, a239
v_cvt_pk_bf16_f32 v124, v152, v153
v_cvt_pk_bf16_f32 v125, v154, v155
v_accvgpr_read_b32 v132, a240
v_accvgpr_read_b32 v133, a241
v_accvgpr_read_b32 v134, a242
v_accvgpr_read_b32 v135, a243
v_cvt_pk_bf16_f32 v30, v132, v133
v_cvt_pk_bf16_f32 v31, v134, v135
buffer_store_dwordx4 v[28:31], v248, s[20:23], s44 offen offset:3072 sc1
ds_write_b128 v253, v[28:31] offset:7168
v_accvgpr_read_b32 v140, a244
v_accvgpr_read_b32 v141, a245
v_accvgpr_read_b32 v142, a246
v_accvgpr_read_b32 v143, a247
v_cvt_pk_bf16_f32 v62, v140, v141
v_cvt_pk_bf16_f32 v63, v142, v143
buffer_store_dwordx4 v[60:63], v248, s[20:23], s45 offen offset:3072 sc1
v_accvgpr_read_b32 v148, a248
v_accvgpr_read_b32 v149, a249
v_accvgpr_read_b32 v150, a250
v_accvgpr_read_b32 v151, a251
v_cvt_pk_bf16_f32 v94, v148, v149
v_cvt_pk_bf16_f32 v95, v150, v151
buffer_store_dwordx4 v[92:95], v248, s[20:23], s46 offen offset:3072 sc1
v_accvgpr_read_b32 v156, a252
v_accvgpr_read_b32 v157, a253
v_accvgpr_read_b32 v158, a254
v_accvgpr_read_b32 v159, a255
v_cvt_pk_bf16_f32 v126, v156, v157
v_cvt_pk_bf16_f32 v127, v158, v159
buffer_store_dwordx4 v[124:127], v248, s[20:23], s47 offen offset:3072 sc1
s_waitcnt vmcnt(36)
s_branch L2_F
L2_tail_1:
s_waitcnt lgkmcnt(6)
v_mfma_f32_16x16x32_bf16 a[0:3], v[176:179], v[208:211], a[0:3]
s_mov_b32 m0, s30
v_mfma_f32_16x16x32_bf16 a[4:7], v[180:183], v[208:211], a[4:7]
buffer_load_dwordx4 v241, s[12:15], s28 offen offset:0 lds
v_add_u32 v253, s50, v248
v_mfma_f32_16x16x32_bf16 a[8:11], v[184:187], v[208:211], a[8:11]
buffer_load_dwordx4 v241, s[12:15], s28 offen offset:1024 lds
v_mfma_f32_16x16x32_bf16 a[12:15], v[188:191], v[208:211], a[12:15]
ds_read_b128 v[208:211], v240 offset:2048
s_waitcnt lgkmcnt(5)
buffer_load_dwordx4 v241, s[12:15], s28 offen offset:2048 lds
v_mfma_f32_16x16x32_bf16 a[16:19], v[176:179], v[212:215], a[16:19]
buffer_load_dwordx4 v241, s[12:15], s28 offen offset:3072 lds
v_mfma_f32_16x16x32_bf16 a[20:23], v[180:183], v[212:215], a[20:23]
s_add_u32 s28, s28, 0x4000
s_add_u32 s30, s30, 0x4000
s_and_b32 s30, s30, 0x1ffff
v_mfma_f32_16x16x32_bf16 a[24:27], v[184:187], v[212:215], a[24:27]
s_mov_b32 m0, s30
v_mfma_f32_16x16x32_bf16 a[28:31], v[188:191], v[212:215], a[28:31]
ds_read_b128 v[212:215], v240 offset:2560
s_waitcnt lgkmcnt(4)
buffer_load_dwordx4 v241, s[12:15], s28 offen offset:0 lds
v_mfma_f32_16x16x32_bf16 a[32:35], v[176:179], v[216:219], a[32:35]
buffer_load_dwordx4 v241, s[12:15], s28 offen offset:1024 lds
v_mfma_f32_16x16x32_bf16 a[36:39], v[180:183], v[216:219], a[36:39]
buffer_load_dwordx4 v241, s[12:15], s28 offen offset:2048 lds
v_mfma_f32_16x16x32_bf16 a[40:43], v[184:187], v[216:219], a[40:43]
buffer_load_dwordx4 v241, s[12:15], s28 offen offset:3072 lds
v_mfma_f32_16x16x32_bf16 a[44:47], v[188:191], v[216:219], a[44:47]
ds_read_b128 v[216:219], v240 offset:6144
s_waitcnt lgkmcnt(3)
v_mfma_f32_16x16x32_bf16 a[48:51], v[176:179], v[220:223], a[48:51]
v_exp_f32 v232, v128
s_and_b32 s30, s30, 0x1c000
v_mfma_f32_16x16x32_bf16 a[52:55], v[180:183], v[220:223], a[52:55]
v_add_u32 v251, 0x8000, v240
v_and_b32 v251, 0x1ffff, v251
s_add_u32 s28, s30, 0xc000
v_mfma_f32_16x16x32_bf16 a[56:59], v[184:187], v[220:223], a[56:59]
v_exp_f32 v233, v129
s_and_b32 s28, s28, 0x1ffff
v_mfma_f32_16x16x32_bf16 a[60:63], v[188:191], v[220:223], a[60:63]
ds_read_b128 v[220:223], v240 offset:6656
s_waitcnt lgkmcnt(3)
s_add_u32 s30, s30, 0x4000
v_mfma_f32_16x16x32_bf16 v[144:147], v[208:211], v[0:3], v[192:195]
ds_write_b128 v253, v[176:179] offset:0
s_and_b32 s30, s30, 0x1ffff
s_mul_i32 s31, s34, 6144
v_mfma_f32_16x16x32_bf16 v[148:151], v[208:211], v[32:35], v[196:199]
ds_write_b128 v253, v[180:183] offset:1024
s_add_u32 s31, s31, s30
s_lshl_b32 s3, s34, 10
v_mfma_f32_16x16x32_bf16 v[152:155], v[208:211], v[64:67], v[200:203]
ds_write_b128 v253, v[184:187] offset:2048
s_add_u32 s28, s28, s3
s_add_u32 s3, s3, 24576
v_mfma_f32_16x16x32_bf16 v[156:159], v[208:211], v[96:99], v[204:207]
ds_read_b128 v[208:211], v240 offset:10240
s_waitcnt lgkmcnt(3)
ds_write_b128 v253, v[188:191] offset:3072
v_mfma_f32_16x16x32_bf16 v[144:147], v[212:215], v[4:7], v[144:147]
v_exp_f32 v234, v130
s_add_u32 s30, s30, s3
v_mfma_f32_16x16x32_bf16 v[148:151], v[212:215], v[36:39], v[148:151]
v_add_f32 v228, v224, v232
v_cvt_pk_bf16_f32 v160, v232, v233
v_lshrrev_b32 v241, 4, v248
v_mfma_f32_16x16x32_bf16 v[152:155], v[212:215], v[68:71], v[152:155]
v_exp_f32 v235, v131
v_and_b32 v241, 0x30, v241
v_mfma_f32_16x16x32_bf16 v[156:159], v[212:215], v[100:103], v[156:159]
ds_read_b128 v[212:215], v240 offset:10752
s_waitcnt lgkmcnt(3)
v_xor_b32 v241, v241, v248
v_mfma_f32_16x16x32_bf16 v[144:147], v[216:219], v[8:11], v[144:147]
v_add_f32 v228, v228, v233
v_add_f32 v228, v228, v234
v_mfma_f32_16x16x32_bf16 v[148:151], v[216:219], v[40:43], v[148:151]
v_add_f32 v228, v228, v235
v_cvt_pk_bf16_f32 v161, v234, v235
v_mfma_f32_16x16x32_bf16 v[152:155], v[216:219], v[72:75], v[152:155]
v_exp_f32 v236, v132
v_mfma_f32_16x16x32_bf16 v[156:159], v[216:219], v[104:107], v[156:159]
ds_read_b128 v[216:219], v240 offset:14336
s_waitcnt lgkmcnt(3)
v_mfma_f32_16x16x32_bf16 v[144:147], v[220:223], v[12:15], v[144:147]
v_exp_f32 v237, v133
v_mfma_f32_16x16x32_bf16 v[148:151], v[220:223], v[44:47], v[148:151]
v_exp_f32 v238, v134
v_mfma_f32_16x16x32_bf16 v[152:155], v[220:223], v[76:79], v[152:155]
v_add_f32 v229, v225, v236
v_cvt_pk_bf16_f32 v164, v236, v237
v_mfma_f32_16x16x32_bf16 v[156:159], v[220:223], v[108:111], v[156:159]
ds_read_b128 v[220:223], v240 offset:14848
s_waitcnt lgkmcnt(3)
v_mfma_f32_16x16x32_bf16 v[144:147], v[208:211], v[16:19], v[144:147]
v_exp_f32 v239, v135
v_and_b32 v243, 0x380, v248
v_mad_u32_u24 v241, v243, 3, v241
v_mfma_f32_16x16x32_bf16 v[148:151], v[208:211], v[48:51], v[148:151]
s_waitcnt vmcnt(8)
s_barrier
v_mfma_f32_16x16x32_bf16 v[152:155], v[208:211], v[80:83], v[152:155]
v_add_f32 v229, v229, v237
v_add_f32 v229, v229, v238
v_mfma_f32_16x16x32_bf16 v[156:159], v[208:211], v[112:115], v[156:159]
ds_read_b128 v[208:211], v240 offset:16384
s_waitcnt lgkmcnt(3)
v_mfma_f32_16x16x32_bf16 v[144:147], v[212:215], v[20:23], v[144:147]
v_add_f32 v229, v229, v239
v_cvt_pk_bf16_f32 v165, v238, v239
v_mfma_f32_16x16x32_bf16 v[148:151], v[212:215], v[52:55], v[148:151]
v_exp_f32 v232, v136
v_mfma_f32_16x16x32_bf16 v[152:155], v[212:215], v[84:87], v[152:155]
v_exp_f32 v233, v137
v_mfma_f32_16x16x32_bf16 v[156:159], v[212:215], v[116:119], v[156:159]
ds_read_b128 v[212:215], v240 offset:16896
s_waitcnt lgkmcnt(3)
v_mfma_f32_16x16x32_bf16 v[144:147], v[216:219], v[24:27], v[144:147]
v_exp_f32 v234, v138
v_mfma_f32_16x16x32_bf16 v[148:151], v[216:219], v[56:59], v[148:151]
v_add_f32 v230, v226, v232
v_cvt_pk_bf16_f32 v168, v232, v233
v_mfma_f32_16x16x32_bf16 v[152:155], v[216:219], v[88:91], v[152:155]
v_exp_f32 v235, v139
v_mfma_f32_16x16x32_bf16 v[156:159], v[216:219], v[120:123], v[156:159]
ds_read_b128 v[216:219], v240 offset:20480
s_waitcnt lgkmcnt(3)
v_mfma_f32_16x16x32_bf16 v[144:147], v[220:223], v[28:31], v[144:147]
v_add_f32 v230, v230, v233
v_add_f32 v230, v230, v234
v_mfma_f32_16x16x32_bf16 v[148:151], v[220:223], v[60:63], v[148:151]
v_add_f32 v230, v230, v235
v_cvt_pk_bf16_f32 v169, v234, v235
v_mfma_f32_16x16x32_bf16 v[152:155], v[220:223], v[92:95], v[152:155]
v_exp_f32 v236, v140
v_mfma_f32_16x16x32_bf16 v[156:159], v[220:223], v[124:127], v[156:159]
ds_read_b128 v[220:223], v240 offset:20992
s_waitcnt lgkmcnt(3)
v_exp_f32 v237, v141
v_exp_f32 v238, v142
v_add_f32 v231, v227, v236
v_cvt_pk_bf16_f32 v172, v236, v237
v_exp_f32 v239, v143
v_add_f32 v231, v231, v237
v_add_f32 v231, v231, v238
v_add_f32 v231, v231, v239
v_cvt_pk_bf16_f32 v173, v238, v239
v_max3_f32 v242, v228, v229, v230
v_max_f32 v242, v242, v231
v_cmp_lt_f32 vcc, s32, v242
s_cbranch_vccnz L2_rare_site12
L2_ret12:
v_mfma_f32_16x16x32_bf16 v[128:131], v[208:211], v[0:3], v[192:195]
s_add_u32 m0, s31, 0
v_mfma_f32_16x16x32_bf16 v[132:135], v[208:211], v[32:35], v[196:199]
v_exp_f32 v232, v144
v_mfma_f32_16x16x32_bf16 v[136:139], v[208:211], v[64:67], v[200:203]
v_exp_f32 v233, v145
v_mfma_f32_16x16x32_bf16 v[140:143], v[208:211], v[96:99], v[204:207]
ds_read_b128 v[208:211], v240 offset:24576
s_waitcnt lgkmcnt(3)
v_mfma_f32_16x16x32_bf16 v[128:131], v[212:215], v[4:7], v[128:131]
v_exp_f32 v234, v146
v_add_f32 v224, v228, v232
v_mfma_f32_16x16x32_bf16 v[132:135], v[212:215], v[36:39], v[132:135]
v_cvt_pk_bf16_f32 v162, v232, v233
v_exp_f32 v235, v147
v_mfma_f32_16x16x32_bf16 v[136:139], v[212:215], v[68:71], v[136:139]
v_add_f32 v224, v224, v233
v_add_f32 v224, v224, v234
v_add_f32 v224, v224, v235
v_mfma_f32_16x16x32_bf16 v[140:143], v[212:215], v[100:103], v[140:143]
ds_read_b128 v[212:215], v240 offset:25088
s_waitcnt lgkmcnt(3)
v_cvt_pk_bf16_f32 v163, v234, v235
v_mfma_f32_16x16x32_bf16 v[128:131], v[216:219], v[8:11], v[128:131]
v_exp_f32 v236, v148
v_mfma_f32_16x16x32_bf16 v[132:135], v[216:219], v[40:43], v[132:135]
v_exp_f32 v237, v149
v_mfma_f32_16x16x32_bf16 v[136:139], v[216:219], v[72:75], v[136:139]
v_exp_f32 v238, v150
v_add_f32 v225, v229, v236
v_mfma_f32_16x16x32_bf16 v[140:143], v[216:219], v[104:107], v[140:143]
ds_read_b128 v[216:219], v240 offset:28672
s_waitcnt lgkmcnt(3)
v_cvt_pk_bf16_f32 v166, v236, v237
v_mfma_f32_16x16x32_bf16 v[128:131], v[220:223], v[12:15], v[128:131]
v_exp_f32 v239, v151
v_add_f32 v225, v225, v237
v_mfma_f32_16x16x32_bf16 v[132:135], v[220:223], v[44:47], v[132:135]
v_add_f32 v225, v225, v238
v_add_f32 v225, v225, v239
v_cvt_pk_bf16_f32 v167, v238, v239
v_mfma_f32_16x16x32_bf16 v[136:139], v[220:223], v[76:79], v[136:139]
v_exp_f32 v232, v152
v_mfma_f32_16x16x32_bf16 v[140:143], v[220:223], v[108:111], v[140:143]
ds_read_b128 v[220:223], v240 offset:29184
s_waitcnt lgkmcnt(3)
v_mfma_f32_16x16x32_bf16 v[128:131], v[208:211], v[16:19], v[128:131]
v_exp_f32 v233, v153
v_mfma_f32_16x16x32_bf16 v[132:135], v[208:211], v[48:51], v[132:135]
v_exp_f32 v234, v154
v_add_f32 v226, v230, v232
v_mfma_f32_16x16x32_bf16 v[136:139], v[208:211], v[80:83], v[136:139]
v_cvt_pk_bf16_f32 v170, v232, v233
v_exp_f32 v235, v155
v_mfma_f32_16x16x32_bf16 v[140:143], v[208:211], v[112:115], v[140:143]
ds_read_b128 v[208:211], v240 offset:18432
s_waitcnt lgkmcnt(3)
v_add_f32 v226, v226, v233
v_mfma_f32_16x16x32_bf16 v[128:131], v[212:215], v[20:23], v[128:131]
v_add_f32 v226, v226, v234
v_add_f32 v226, v226, v235
v_cvt_pk_bf16_f32 v171, v234, v235
v_mfma_f32_16x16x32_bf16 v[132:135], v[212:215], v[52:55], v[132:135]
v_exp_f32 v236, v156
v_mfma_f32_16x16x32_bf16 v[136:139], v[212:215], v[84:87], v[136:139]
v_exp_f32 v237, v157
v_mfma_f32_16x16x32_bf16 v[140:143], v[212:215], v[116:119], v[140:143]
ds_read_b128 v[212:215], v240 offset:18944
s_waitcnt lgkmcnt(3)
v_mfma_f32_16x16x32_bf16 v[128:131], v[216:219], v[24:27], v[128:131]
v_exp_f32 v238, v158
v_add_f32 v227, v231, v236
v_mfma_f32_16x16x32_bf16 v[132:135], v[216:219], v[56:59], v[132:135]
v_cvt_pk_bf16_f32 v174, v236, v237
v_exp_f32 v239, v159
v_mfma_f32_16x16x32_bf16 v[136:139], v[216:219], v[88:91], v[136:139]
v_add_f32 v227, v227, v237
v_add_f32 v227, v227, v238
v_add_f32 v227, v227, v239
v_mfma_f32_16x16x32_bf16 v[140:143], v[216:219], v[120:123], v[140:143]
ds_read_b128 v[216:219], v240 offset:22528
s_waitcnt lgkmcnt(3)
v_cvt_pk_bf16_f32 v175, v238, v239
v_mfma_f32_16x16x32_bf16 v[128:131], v[220:223], v[28:31], v[128:131]
v_max3_f32 v242, v224, v225, v226
v_max_f32 v242, v242, v227
v_cmp_lt_f32 vcc, s32, v242
s_cbranch_vccnz L2_rare_site13
L2_ret13:
v_mfma_f32_16x16x32_bf16 v[132:135], v[220:223], v[60:63], v[132:135]
buffer_load_dwordx4 v241, s[8:11], s6 offen lds
s_add_u32 m0, s31, 2048
v_mfma_f32_16x16x32_bf16 v[136:139], v[220:223], v[92:95], v[136:139]
buffer_load_dwordx4 v241, s[8:11], s7 offen lds
s_add_u32 m0, s31, 4096
v_mfma_f32_16x16x32_bf16 v[140:143], v[220:223], v[124:127], v[140:143]
ds_read_b128 v[220:223], v240 offset:23040
s_waitcnt lgkmcnt(3)
v_mfma_f32_16x16x32_bf16 v[144:147], v[208:211], v[0:3], v[192:195]
ds_write_b128 v253, v[160:163] offset:4096
buffer_load_dwordx4 v241, s[8:11], s29 offen lds
s_add_u32 m0, s31, 1024
v_mfma_f32_16x16x32_bf16 v[148:151], v[208:211], v[32:35], v[196:199]
ds_write_b128 v253, v[164:167] offset:5120
v_exp_f32 v232, v128
v_mfma_f32_16x16x32_bf16 v[152:155], v[208:211], v[64:67], v[200:203]
ds_write_b128 v253, v[168:171] offset:6144
v_exp_f32 v233, v129
v_mfma_f32_16x16x32_bf16 v[156:159], v[208:211], v[96:99], v[204:207]
ds_read_b128 v[208:211], v240 offset:26624
s_waitcnt lgkmcnt(3)
ds_write_b128 v253, v[172:175] offset:7168
v_mfma_f32_16x16x32_bf16 v[144:147], v[212:215], v[4:7], v[144:147]
v_exp_f32 v234, v130
v_add_f32 v228, v224, v232
v_mfma_f32_16x16x32_bf16 v[148:151], v[212:215], v[36:39], v[148:151]
v_cvt_pk_bf16_f32 v176, v232, v233
v_exp_f32 v235, v131
v_mfma_f32_16x16x32_bf16 v[152:155], v[212:215], v[68:71], v[152:155]
v_add_f32 v228, v228, v233
v_add_f32 v228, v228, v234
v_add_f32 v228, v228, v235
v_mfma_f32_16x16x32_bf16 v[156:159], v[212:215], v[100:103], v[156:159]
ds_read_b128 v[212:215], v240 offset:27136
s_waitcnt lgkmcnt(3)
v_cvt_pk_bf16_f32 v177, v234, v235
v_mfma_f32_16x16x32_bf16 v[144:147], v[216:219], v[8:11], v[144:147]
v_exp_f32 v236, v132
v_xor_b32 v241, 0x1040, v241
v_mfma_f32_16x16x32_bf16 v[148:151], v[216:219], v[40:43], v[148:151]
v_exp_f32 v237, v133
v_mfma_f32_16x16x32_bf16 v[152:155], v[216:219], v[72:75], v[152:155]
v_exp_f32 v238, v134
v_add_f32 v229, v225, v236
v_mfma_f32_16x16x32_bf16 v[156:159], v[216:219], v[104:107], v[156:159]
ds_read_b128 v[216:219], v240 offset:30720
s_waitcnt lgkmcnt(3)
v_cvt_pk_bf16_f32 v180, v236, v237
v_mfma_f32_16x16x32_bf16 v[144:147], v[220:223], v[12:15], v[144:147]
v_exp_f32 v239, v135
v_add_f32 v229, v229, v237
v_mfma_f32_16x16x32_bf16 v[148:151], v[220:223], v[44:47], v[148:151]
v_add_f32 v229, v229, v238
v_add_f32 v229, v229, v239
v_cvt_pk_bf16_f32 v181, v238, v239
v_mfma_f32_16x16x32_bf16 v[152:155], v[220:223], v[76:79], v[152:155]
v_exp_f32 v232, v136
v_mfma_f32_16x16x32_bf16 v[156:159], v[220:223], v[108:111], v[156:159]
ds_read_b128 v[220:223], v240 offset:31232
s_waitcnt lgkmcnt(3)
v_mfma_f32_16x16x32_bf16 v[144:147], v[208:211], v[16:19], v[144:147]
v_exp_f32 v233, v137
v_mfma_f32_16x16x32_bf16 v[148:151], v[208:211], v[48:51], v[148:151]
s_waitcnt vmcnt(7)
s_barrier
v_mfma_f32_16x16x32_bf16 v[152:155], v[208:211], v[80:83], v[152:155]
v_exp_f32 v234, v138
v_add_f32 v230, v226, v232
v_mfma_f32_16x16x32_bf16 v[156:159], v[208:211], v[112:115], v[156:159]
ds_read_b128 v[208:211], v251 offset:0
s_waitcnt lgkmcnt(3)
v_cvt_pk_bf16_f32 v184, v232, v233
v_mfma_f32_16x16x32_bf16 v[144:147], v[212:215], v[20:23], v[144:147]
v_exp_f32 v235, v139
v_add_f32 v230, v230, v233
v_mfma_f32_16x16x32_bf16 v[148:151], v[212:215], v[52:55], v[148:151]
v_add_f32 v230, v230, v234
v_add_f32 v230, v230, v235
v_cvt_pk_bf16_f32 v185, v234, v235
v_mfma_f32_16x16x32_bf16 v[152:155], v[212:215], v[84:87], v[152:155]
v_exp_f32 v236, v140
v_mfma_f32_16x16x32_bf16 v[156:159], v[212:215], v[116:119], v[156:159]
ds_read_b128 v[212:215], v251 offset:512
s_waitcnt lgkmcnt(3)
v_mfma_f32_16x16x32_bf16 v[144:147], v[216:219], v[24:27], v[144:147]
v_exp_f32 v237, v141
v_mfma_f32_16x16x32_bf16 v[148:151], v[216:219], v[56:59], v[148:151]
v_exp_f32 v238, v142
v_add_f32 v231, v227, v236
v_mfma_f32_16x16x32_bf16 v[152:155], v[216:219], v[88:91], v[152:155]
v_cvt_pk_bf16_f32 v188, v236, v237
v_exp_f32 v239, v143
v_mfma_f32_16x16x32_bf16 v[156:159], v[216:219], v[120:123], v[156:159]
ds_read_b128 v[216:219], v251 offset:4096
s_waitcnt lgkmcnt(3)
v_add_f32 v231, v231, v237
v_mfma_f32_16x16x32_bf16 v[144:147], v[220:223], v[28:31], v[144:147]
v_add_f32 v231, v231, v238
v_add_f32 v231, v231, v239
v_cvt_pk_bf16_f32 v189, v238, v239
v_mfma_f32_16x16x32_bf16 v[148:151], v[220:223], v[60:63], v[148:151]
v_max3_f32 v242, v228, v229, v230
v_max_f32 v242, v242, v231
v_cmp_lt_f32 vcc, s32, v242
s_cbranch_vccnz L2_rare_site14
L2_ret14:
v_mfma_f32_16x16x32_bf16 v[152:155], v[220:223], v[92:95], v[152:155]
buffer_load_dwordx4 v241, s[8:11], s6 offen lds
s_add_u32 m0, s31, 3072
v_mfma_f32_16x16x32_bf16 v[156:159], v[220:223], v[124:127], v[156:159]
ds_read_b128 v[220:223], v251 offset:4608
s_waitcnt lgkmcnt(3)
v_mfma_f32_16x16x32_bf16 v[128:131], v[208:211], v[0:3], v[192:195]
buffer_load_dwordx4 v241, s[8:11], s7 offen lds
s_add_u32 m0, s31, 5120
v_mfma_f32_16x16x32_bf16 v[132:135], v[208:211], v[32:35], v[196:199]
v_exp_f32 v232, v144
v_mfma_f32_16x16x32_bf16 v[136:139], v[208:211], v[64:67], v[200:203]
v_exp_f32 v233, v145
v_mfma_f32_16x16x32_bf16 v[140:143], v[208:211], v[96:99], v[204:207]
ds_read_b128 v[208:211], v251 offset:8192
s_waitcnt lgkmcnt(3)
v_mfma_f32_16x16x32_bf16 v[128:131], v[212:215], v[4:7], v[128:131]
v_exp_f32 v234, v146
v_add_f32 v224, v228, v232
v_mfma_f32_16x16x32_bf16 v[132:135], v[212:215], v[36:39], v[132:135]
v_cvt_pk_bf16_f32 v178, v232, v233
v_exp_f32 v235, v147
v_mfma_f32_16x16x32_bf16 v[136:139], v[212:215], v[68:71], v[136:139]
v_add_f32 v224, v224, v233
v_add_f32 v224, v224, v234
v_add_f32 v224, v224, v235
v_mfma_f32_16x16x32_bf16 v[140:143], v[212:215], v[100:103], v[140:143]
ds_read_b128 v[212:215], v251 offset:8704
s_waitcnt lgkmcnt(3)
v_cvt_pk_bf16_f32 v179, v234, v235
v_mfma_f32_16x16x32_bf16 v[128:131], v[216:219], v[8:11], v[128:131]
v_exp_f32 v236, v148
v_mfma_f32_16x16x32_bf16 v[132:135], v[216:219], v[40:43], v[132:135]
v_exp_f32 v237, v149
v_mfma_f32_16x16x32_bf16 v[136:139], v[216:219], v[72:75], v[136:139]
v_exp_f32 v238, v150
v_add_f32 v225, v229, v236
v_mfma_f32_16x16x32_bf16 v[140:143], v[216:219], v[104:107], v[140:143]
ds_read_b128 v[216:219], v251 offset:12288
s_waitcnt lgkmcnt(3)
v_cvt_pk_bf16_f32 v182, v236, v237
v_mfma_f32_16x16x32_bf16 v[128:131], v[220:223], v[12:15], v[128:131]
v_exp_f32 v239, v151
v_add_f32 v225, v225, v237
v_mfma_f32_16x16x32_bf16 v[132:135], v[220:223], v[44:47], v[132:135]
v_add_f32 v225, v225, v238
v_add_f32 v225, v225, v239
v_cvt_pk_bf16_f32 v183, v238, v239
v_mfma_f32_16x16x32_bf16 v[136:139], v[220:223], v[76:79], v[136:139]
v_exp_f32 v232, v152
v_mfma_f32_16x16x32_bf16 v[140:143], v[220:223], v[108:111], v[140:143]
ds_read_b128 v[220:223], v251 offset:12800
s_waitcnt lgkmcnt(3)
v_mfma_f32_16x16x32_bf16 v[128:131], v[208:211], v[16:19], v[128:131]
v_exp_f32 v233, v153
v_mfma_f32_16x16x32_bf16 v[132:135], v[208:211], v[48:51], v[132:135]
v_exp_f32 v234, v154
v_add_f32 v226, v230, v232
v_mfma_f32_16x16x32_bf16 v[136:139], v[208:211], v[80:83], v[136:139]
v_cvt_pk_bf16_f32 v186, v232, v233
v_exp_f32 v235, v155
v_mfma_f32_16x16x32_bf16 v[140:143], v[208:211], v[112:115], v[140:143]
ds_read_b128 v[208:211], v251 offset:2048
s_waitcnt lgkmcnt(3)
v_add_f32 v226, v226, v233
v_mfma_f32_16x16x32_bf16 v[128:131], v[212:215], v[20:23], v[128:131]
v_add_f32 v226, v226, v234
v_add_f32 v226, v226, v235
v_cvt_pk_bf16_f32 v187, v234, v235
v_mfma_f32_16x16x32_bf16 v[132:135], v[212:215], v[52:55], v[132:135]
v_exp_f32 v236, v156
v_mfma_f32_16x16x32_bf16 v[136:139], v[212:215], v[84:87], v[136:139]
v_exp_f32 v237, v157
v_mfma_f32_16x16x32_bf16 v[140:143], v[212:215], v[116:119], v[140:143]
ds_read_b128 v[212:215], v251 offset:2560
s_waitcnt lgkmcnt(3)
v_mfma_f32_16x16x32_bf16 v[128:131], v[216:219], v[24:27], v[128:131]
v_exp_f32 v238, v158
v_add_f32 v227, v231, v236
v_mfma_f32_16x16x32_bf16 v[132:135], v[216:219], v[56:59], v[132:135]
v_cvt_pk_bf16_f32 v190, v236, v237
v_exp_f32 v239, v159
v_mfma_f32_16x16x32_bf16 v[136:139], v[216:219], v[88:91], v[136:139]
v_add_f32 v227, v227, v237
v_add_f32 v227, v227, v238
v_add_f32 v227, v227, v239
v_mfma_f32_16x16x32_bf16 v[140:143], v[216:219], v[120:123], v[140:143]
ds_read_b128 v[216:219], v251 offset:6144
s_waitcnt lgkmcnt(3)
v_cvt_pk_bf16_f32 v191, v238, v239
v_mfma_f32_16x16x32_bf16 v[128:131], v[220:223], v[28:31], v[128:131]
v_max3_f32 v242, v224, v225, v226
v_max_f32 v242, v242, v227
v_cmp_lt_f32 vcc, s32, v242
s_cbranch_vccnz L2_rare_site15
L2_ret15:
v_mfma_f32_16x16x32_bf16 v[132:135], v[220:223], v[60:63], v[132:135]
buffer_load_dwordx4 v241, s[8:11], s29 offen lds
v_mfma_f32_16x16x32_bf16 v[136:139], v[220:223], v[92:95], v[136:139]
v_mfma_f32_16x16x32_bf16 v[140:143], v[220:223], v[124:127], v[140:143]
ds_read_b128 v[220:223], v251 offset:6656
s_waitcnt lgkmcnt(3)
v_mfma_f32_16x16x32_bf16 v[144:147], v[208:211], v[0:3], v[192:195]
v_mfma_f32_16x16x32_bf16 v[148:151], v[208:211], v[32:35], v[196:199]
v_exp_f32 v232, v128
v_mfma_f32_16x16x32_bf16 v[152:155], v[208:211], v[64:67], v[200:203]
v_exp_f32 v233, v129
v_mfma_f32_16x16x32_bf16 v[156:159], v[208:211], v[96:99], v[204:207]
ds_read_b128 v[208:211], v251 offset:10240
s_waitcnt lgkmcnt(3)
v_mfma_f32_16x16x32_bf16 v[144:147], v[212:215], v[4:7], v[144:147]
v_exp_f32 v234, v130
v_add_f32 v228, v224, v232
v_mfma_f32_16x16x32_bf16 v[148:151], v[212:215], v[36:39], v[148:151]
v_cvt_pk_bf16_f32 v160, v232, v233
v_exp_f32 v235, v131
v_mfma_f32_16x16x32_bf16 v[152:155], v[212:215], v[68:71], v[152:155]
v_add_f32 v228, v228, v233
v_add_f32 v228, v228, v234
v_add_f32 v228, v228, v235
v_mfma_f32_16x16x32_bf16 v[156:159], v[212:215], v[100:103], v[156:159]
ds_read_b128 v[212:215], v251 offset:10752
s_waitcnt lgkmcnt(3)
v_cvt_pk_bf16_f32 v161, v234, v235
v_mfma_f32_16x16x32_bf16 v[144:147], v[216:219], v[8:11], v[144:147]
v_exp_f32 v236, v132
v_mfma_f32_16x16x32_bf16 v[148:151], v[216:219], v[40:43], v[148:151]
v_exp_f32 v237, v133
v_mfma_f32_16x16x32_bf16 v[152:155], v[216:219], v[72:75], v[152:155]
v_exp_f32 v238, v134
v_add_f32 v229, v225, v236
v_mfma_f32_16x16x32_bf16 v[156:159], v[216:219], v[104:107], v[156:159]
ds_read_b128 v[216:219], v251 offset:14336
s_waitcnt lgkmcnt(3)
v_cvt_pk_bf16_f32 v164, v236, v237
v_mfma_f32_16x16x32_bf16 v[144:147], v[220:223], v[12:15], v[144:147]
v_exp_f32 v239, v135
v_add_f32 v229, v229, v237
v_mfma_f32_16x16x32_bf16 v[148:151], v[220:223], v[44:47], v[148:151]
v_add_f32 v229, v229, v238
v_add_f32 v229, v229, v239
v_cvt_pk_bf16_f32 v165, v238, v239
v_mfma_f32_16x16x32_bf16 v[152:155], v[220:223], v[76:79], v[152:155]
v_exp_f32 v232, v136
v_mfma_f32_16x16x32_bf16 v[156:159], v[220:223], v[108:111], v[156:159]
ds_read_b128 v[220:223], v251 offset:14848
s_waitcnt lgkmcnt(3)
v_mfma_f32_16x16x32_bf16 v[144:147], v[208:211], v[16:19], v[144:147]
v_exp_f32 v233, v137
v_mfma_f32_16x16x32_bf16 v[148:151], v[208:211], v[48:51], v[148:151]
s_waitcnt vmcnt(6)
s_barrier
v_mfma_f32_16x16x32_bf16 v[152:155], v[208:211], v[80:83], v[152:155]
v_exp_f32 v234, v138
v_add_f32 v230, v226, v232
v_mfma_f32_16x16x32_bf16 v[156:159], v[208:211], v[112:115], v[156:159]
ds_read_b128 v[208:211], v251 offset:16384
s_waitcnt lgkmcnt(3)
v_cvt_pk_bf16_f32 v168, v232, v233
v_mfma_f32_16x16x32_bf16 v[144:147], v[212:215], v[20:23], v[144:147]
v_exp_f32 v235, v139
v_add_f32 v230, v230, v233
v_mfma_f32_16x16x32_bf16 v[148:151], v[212:215], v[52:55], v[148:151]
v_add_f32 v230, v230, v234
v_add_f32 v230, v230, v235
v_cvt_pk_bf16_f32 v169, v234, v235
v_mfma_f32_16x16x32_bf16 v[152:155], v[212:215], v[84:87], v[152:155]
v_exp_f32 v236, v140
v_mfma_f32_16x16x32_bf16 v[156:159], v[212:215], v[116:119], v[156:159]
ds_read_b128 v[212:215], v251 offset:16896
s_waitcnt lgkmcnt(3)
v_mfma_f32_16x16x32_bf16 v[144:147], v[216:219], v[24:27], v[144:147]
v_exp_f32 v237, v141
v_mfma_f32_16x16x32_bf16 v[148:151], v[216:219], v[56:59], v[148:151]
v_exp_f32 v238, v142
v_add_f32 v231, v227, v236
v_mfma_f32_16x16x32_bf16 v[152:155], v[216:219], v[88:91], v[152:155]
v_cvt_pk_bf16_f32 v172, v236, v237
v_exp_f32 v239, v143
v_mfma_f32_16x16x32_bf16 v[156:159], v[216:219], v[120:123], v[156:159]
ds_read_b128 v[216:219], v251 offset:20480
s_waitcnt lgkmcnt(3)
v_add_f32 v231, v231, v237
v_mfma_f32_16x16x32_bf16 v[144:147], v[220:223], v[28:31], v[144:147]
v_add_f32 v231, v231, v238
v_add_f32 v231, v231, v239
v_cvt_pk_bf16_f32 v173, v238, v239
v_mfma_f32_16x16x32_bf16 v[148:151], v[220:223], v[60:63], v[148:151]
v_max3_f32 v242, v228, v229, v230
v_max_f32 v242, v242, v231
v_cmp_lt_f32 vcc, s32, v242
s_cbranch_vccnz L2_rare_site16
L2_ret16:
v_mfma_f32_16x16x32_bf16 v[152:155], v[220:223], v[92:95], v[152:155]
v_mfma_f32_16x16x32_bf16 v[156:159], v[220:223], v[124:127], v[156:159]
ds_read_b128 v[220:223], v251 offset:20992
s_waitcnt lgkmcnt(3)
v_mfma_f32_16x16x32_bf16 v[128:131], v[208:211], v[0:3], v[192:195]
v_mfma_f32_16x16x32_bf16 v[132:135], v[208:211], v[32:35], v[196:199]
v_exp_f32 v232, v144
v_mfma_f32_16x16x32_bf16 v[136:139], v[208:211], v[64:67], v[200:203]
v_exp_f32 v233, v145
v_mfma_f32_16x16x32_bf16 v[140:143], v[208:211], v[96:99], v[204:207]
ds_read_b128 v[208:211], v251 offset:24576
s_waitcnt lgkmcnt(3)
v_mfma_f32_16x16x32_bf16 v[128:131], v[212:215], v[4:7], v[128:131]
v_exp_f32 v234, v146
v_add_f32 v224, v228, v232
v_mfma_f32_16x16x32_bf16 v[132:135], v[212:215], v[36:39], v[132:135]
v_cvt_pk_bf16_f32 v162, v232, v233
v_exp_f32 v235, v147
v_mfma_f32_16x16x32_bf16 v[136:139], v[212:215], v[68:71], v[136:139]
v_add_f32 v224, v224, v233
v_add_f32 v224, v224, v234
v_add_f32 v224, v224, v235
v_mfma_f32_16x16x32_bf16 v[140:143], v[212:215], v[100:103], v[140:143]
ds_read_b128 v[212:215], v251 offset:25088
s_waitcnt lgkmcnt(3)
v_cvt_pk_bf16_f32 v163, v234, v235
v_mfma_f32_16x16x32_bf16 v[128:131], v[216:219], v[8:11], v[128:131]
v_exp_f32 v236, v148
v_lshlrev_b32 v241, 3, v248
v_mfma_f32_16x16x32_bf16 v[132:135], v[216:219], v[40:43], v[132:135]
v_exp_f32 v237, v149
s_mov_b32 s3, 0x7c28000
v_mfma_f32_16x16x32_bf16 v[136:139], v[216:219], v[72:75], v[136:139]
v_exp_f32 v238, v150
v_add_f32 v225, v229, v236
v_mfma_f32_16x16x32_bf16 v[140:143], v[216:219], v[104:107], v[140:143]
ds_read_b128 v[216:219], v251 offset:28672
s_waitcnt lgkmcnt(3)
v_cvt_pk_bf16_f32 v166, v236, v237
v_mfma_f32_16x16x32_bf16 v[128:131], v[220:223], v[12:15], v[128:131]
v_exp_f32 v239, v151
v_add_f32 v225, v225, v237
v_mfma_f32_16x16x32_bf16 v[132:135], v[220:223], v[44:47], v[132:135]
v_add_f32 v225, v225, v238
v_add_f32 v225, v225, v239
v_cvt_pk_bf16_f32 v167, v238, v239
v_mfma_f32_16x16x32_bf16 v[136:139], v[220:223], v[76:79], v[136:139]
v_exp_f32 v232, v152
buffer_load_dword v241, v241, s[16:19], s3 offen sc1
v_mfma_f32_16x16x32_bf16 v[140:143], v[220:223], v[108:111], v[140:143]
ds_read_b128 v[220:223], v251 offset:29184
s_waitcnt lgkmcnt(3)
v_mfma_f32_16x16x32_bf16 v[128:131], v[208:211], v[16:19], v[128:131]
v_exp_f32 v233, v153
v_mfma_f32_16x16x32_bf16 v[132:135], v[208:211], v[48:51], v[132:135]
v_exp_f32 v234, v154
v_add_f32 v226, v230, v232
v_mfma_f32_16x16x32_bf16 v[136:139], v[208:211], v[80:83], v[136:139]
v_cvt_pk_bf16_f32 v170, v232, v233
v_exp_f32 v235, v155
v_mfma_f32_16x16x32_bf16 v[140:143], v[208:211], v[112:115], v[140:143]
ds_read_b128 v[208:211], v251 offset:18432
s_waitcnt lgkmcnt(3)
v_add_f32 v226, v226, v233
v_mfma_f32_16x16x32_bf16 v[128:131], v[212:215], v[20:23], v[128:131]
v_add_f32 v226, v226, v234
v_add_f32 v226, v226, v235
v_cvt_pk_bf16_f32 v171, v234, v235
v_mfma_f32_16x16x32_bf16 v[132:135], v[212:215], v[52:55], v[132:135]
v_exp_f32 v236, v156
v_mfma_f32_16x16x32_bf16 v[136:139], v[212:215], v[84:87], v[136:139]
v_exp_f32 v237, v157
v_mfma_f32_16x16x32_bf16 v[140:143], v[212:215], v[116:119], v[140:143]
ds_read_b128 v[212:215], v251 offset:18944
s_waitcnt lgkmcnt(3)
v_mfma_f32_16x16x32_bf16 v[128:131], v[216:219], v[24:27], v[128:131]
v_exp_f32 v238, v158
v_add_f32 v227, v231, v236
v_mfma_f32_16x16x32_bf16 v[132:135], v[216:219], v[56:59], v[132:135]
v_cvt_pk_bf16_f32 v174, v236, v237
v_exp_f32 v239, v159
v_mfma_f32_16x16x32_bf16 v[136:139], v[216:219], v[88:91], v[136:139]
v_add_f32 v227, v227, v237
v_add_f32 v227, v227, v238
v_add_f32 v227, v227, v239
v_mfma_f32_16x16x32_bf16 v[140:143], v[216:219], v[120:123], v[140:143]
ds_read_b128 v[216:219], v251 offset:22528
s_waitcnt lgkmcnt(3)
v_cvt_pk_bf16_f32 v175, v238, v239
v_mfma_f32_16x16x32_bf16 v[128:131], v[220:223], v[28:31], v[128:131]
v_max3_f32 v242, v224, v225, v226
v_max_f32 v242, v242, v227
v_cmp_lt_f32 vcc, s32, v242
s_cbranch_vccnz L2_rare_site17
L2_ret17:
v_mfma_f32_16x16x32_bf16 v[132:135], v[220:223], v[60:63], v[132:135]
v_mfma_f32_16x16x32_bf16 v[136:139], v[220:223], v[92:95], v[136:139]
v_mfma_f32_16x16x32_bf16 v[140:143], v[220:223], v[124:127], v[140:143]
ds_read_b128 v[220:223], v251 offset:23040
s_waitcnt lgkmcnt(3)
v_mfma_f32_16x16x32_bf16 v[144:147], v[208:211], v[0:3], v[192:195]
v_mfma_f32_16x16x32_bf16 v[148:151], v[208:211], v[32:35], v[196:199]
v_mfma_f32_16x16x32_bf16 v[152:155], v[208:211], v[64:67], v[200:203]
v_mfma_f32_16x16x32_bf16 v[156:159], v[208:211], v[96:99], v[204:207]
ds_read_b128 v[208:211], v251 offset:26624
s_waitcnt lgkmcnt(3)
v_mfma_f32_16x16x32_bf16 v[144:147], v[212:215], v[4:7], v[144:147]
v_exp_f32 v232, v128
v_mfma_f32_16x16x32_bf16 v[148:151], v[212:215], v[36:39], v[148:151]
v_exp_f32 v233, v129
v_mfma_f32_16x16x32_bf16 v[152:155], v[212:215], v[68:71], v[152:155]
v_exp_f32 v234, v130
v_add_f32 v228, v224, v232
v_mfma_f32_16x16x32_bf16 v[156:159], v[212:215], v[100:103], v[156:159]
ds_read_b128 v[212:215], v251 offset:27136
s_waitcnt lgkmcnt(3)
v_cvt_pk_bf16_f32 v0, v232, v233
v_mfma_f32_16x16x32_bf16 v[144:147], v[216:219], v[8:11], v[144:147]
v_exp_f32 v235, v131
v_add_f32 v228, v228, v233
v_mfma_f32_16x16x32_bf16 v[148:151], v[216:219], v[40:43], v[148:151]
ds_read_b128 v[4:7], v253 offset:0
v_add_f32 v228, v228, v234
v_add_f32 v228, v228, v235
v_mfma_f32_16x16x32_bf16 v[152:155], v[216:219], v[72:75], v[152:155]
ds_read_b128 v[36:39], v253 offset:1024
v_cvt_pk_bf16_f32 v1, v234, v235
v_mfma_f32_16x16x32_bf16 v[156:159], v[216:219], v[104:107], v[156:159]
ds_read_b128 v[216:219], v251 offset:30720
s_waitcnt lgkmcnt(3)
v_mfma_f32_16x16x32_bf16 v[144:147], v[220:223], v[12:15], v[144:147]
v_exp_f32 v236, v132
v_mfma_f32_16x16x32_bf16 v[148:151], v[220:223], v[44:47], v[148:151]
ds_read_b128 v[68:71], v253 offset:2048
ds_read_b128 v[8:11], v253 offset:4096
v_mfma_f32_16x16x32_bf16 v[152:155], v[220:223], v[76:79], v[152:155]
v_add_u32 v12, 0x8000, v249
v_and_b32 v12, 0x1ffff, v12
ds_read_b128 v[100:103], v253 offset:3072
ds_read_b128 v[40:43], v253 offset:5120
v_mfma_f32_16x16x32_bf16 v[156:159], v[220:223], v[108:111], v[156:159]
ds_read_b128 v[220:223], v251 offset:31232
s_waitcnt lgkmcnt(3)
v_add_u32 v14, 0x10000, v249
v_and_b32 v14, 0x1ffff, v14
v_mfma_f32_16x16x32_bf16 v[144:147], v[208:211], v[16:19], v[144:147]
v_xor_b32 v13, 32, v12
v_xor_b32 v15, 32, v14
v_mfma_f32_16x16x32_bf16 v[148:151], v[208:211], v[48:51], v[148:151]
ds_read_b128 v[72:75], v253 offset:6144
v_exp_f32 v237, v133
v_mfma_f32_16x16x32_bf16 v[152:155], v[208:211], v[80:83], v[152:155]
ds_read_b128 v[104:107], v253 offset:7168
v_exp_f32 v238, v134
v_mfma_f32_16x16x32_bf16 v[156:159], v[208:211], v[112:115], v[156:159]
ds_read_b64_tr_b16 v[208:209], v12 offset:0
s_waitcnt lgkmcnt(3)
v_add_f32 v229, v225, v236
v_mfma_f32_16x16x32_bf16 v[144:147], v[212:215], v[20:23], v[144:147]
ds_read_b64_tr_b16 v[210:211], v12 offset:2048
v_cvt_pk_bf16_f32 v32, v236, v237
v_mfma_f32_16x16x32_bf16 v[148:151], v[212:215], v[52:55], v[148:151]
v_exp_f32 v239, v135
v_add_f32 v229, v229, v237
v_mfma_f32_16x16x32_bf16 v[152:155], v[212:215], v[84:87], v[152:155]
v_add_f32 v229, v229, v238
v_add_f32 v229, v229, v239
v_cvt_pk_bf16_f32 v33, v238, v239
v_mfma_f32_16x16x32_bf16 v[156:159], v[212:215], v[116:119], v[156:159]
ds_read_b64_tr_b16 v[212:213], v12 offset:16384
s_waitcnt lgkmcnt(4)
v_mfma_f32_16x16x32_bf16 v[144:147], v[216:219], v[24:27], v[144:147]
ds_read_b64_tr_b16 v[214:215], v12 offset:18432
v_exp_f32 v232, v136
v_mfma_f32_16x16x32_bf16 v[148:151], v[216:219], v[56:59], v[148:151]
v_exp_f32 v233, v137
v_mfma_f32_16x16x32_bf16 v[152:155], v[216:219], v[88:91], v[152:155]
v_exp_f32 v234, v138
v_add_f32 v230, v226, v232
v_mfma_f32_16x16x32_bf16 v[156:159], v[216:219], v[120:123], v[156:159]
ds_read_b64_tr_b16 v[216:217], v14 offset:0
s_waitcnt lgkmcnt(5)
v_cvt_pk_bf16_f32 v64, v232, v233
v_mfma_f32_16x16x32_bf16 v[144:147], v[220:223], v[28:31], v[144:147]
ds_read_b64_tr_b16 v[218:219], v14 offset:2048
v_exp_f32 v235, v139
v_mfma_f32_16x16x32_bf16 v[148:151], v[220:223], v[60:63], v[148:151]
v_add_f32 v230, v230, v233
v_add_f32 v230, v230, v234
v_add_f32 v230, v230, v235
v_mfma_f32_16x16x32_bf16 v[152:155], v[220:223], v[92:95], v[152:155]
v_cvt_pk_bf16_f32 v65, v234, v235
v_exp_f32 v236, v140
v_mfma_f32_16x16x32_bf16 v[156:159], v[220:223], v[124:127], v[156:159]
ds_read_b64_tr_b16 v[220:221], v13 offset:0
s_waitcnt lgkmcnt(5)
v_exp_f32 v237, v141
v_exp_f32 v238, v142
v_add_f32 v231, v227, v236
v_cvt_pk_bf16_f32 v96, v236, v237
v_exp_f32 v239, v143
v_add_f32 v231, v231, v237
v_add_f32 v231, v231, v238
v_add_f32 v231, v231, v239
v_cvt_pk_bf16_f32 v97, v238, v239
v_max3_f32 v242, v228, v229, v230
v_max_f32 v242, v242, v231
v_cmp_lt_f32 vcc, s32, v242
s_cbranch_vccnz L2_rare_site18
L2_ret18:
v_mfma_f32_16x16x32_bf16 a[0:3], v[8:11], v[208:211], a[0:3]
ds_read_b64_tr_b16 v[222:223], v13 offset:2048
s_waitcnt vmcnt(0)
v_cmp_eq_u32_e64 s[38:39], 0, v241
v_mfma_f32_16x16x32_bf16 a[4:7], v[40:43], v[208:211], a[4:7]
v_exp_f32 v232, v144
v_mfma_f32_16x16x32_bf16 a[8:11], v[72:75], v[208:211], a[8:11]
v_exp_f32 v233, v145
v_mfma_f32_16x16x32_bf16 a[12:15], v[104:107], v[208:211], a[12:15]
ds_read_b64_tr_b16 v[208:209], v13 offset:16384
s_waitcnt lgkmcnt(5)
v_mfma_f32_16x16x32_bf16 a[0:3], v[176:179], v[212:215], a[0:3]
ds_read_b64_tr_b16 v[210:211], v13 offset:18432
s_and_b64 s[38:39], s[38:39], s[96:97]
s_cbranch_scc1 LF_hl_1
LF_hlret_1:
v_mfma_f32_16x16x32_bf16 a[4:7], v[180:183], v[212:215], a[4:7]
v_exp_f32 v234, v146
v_lshrrev_b32 v241, 4, v248
v_mfma_f32_16x16x32_bf16 a[8:11], v[184:187], v[212:215], a[8:11]
v_add_f32 v224, v228, v232
v_cvt_pk_bf16_f32 v2, v232, v233
v_and_b32 v241, 0x30, v241
v_mfma_f32_16x16x32_bf16 a[12:15], v[188:191], v[212:215], a[12:15]
ds_read_b64_tr_b16 v[212:213], v15 offset:0
s_waitcnt lgkmcnt(5)
v_xor_b32 v241, v241, v248
v_mfma_f32_16x16x32_bf16 a[0:3], v[160:163], v[216:219], a[0:3]
ds_read_b64_tr_b16 v[214:215], v15 offset:2048
v_and_b32 v243, 0x380, v248
v_mad_u32_u24 v241, v243, 3, v241
v_mfma_f32_16x16x32_bf16 a[4:7], v[164:167], v[216:219], a[4:7]
v_exp_f32 v235, v147
v_add_u32 v241, 0x7000000, v241
v_mfma_f32_16x16x32_bf16 a[8:11], v[168:171], v[216:219], a[8:11]
v_add_f32 v224, v224, v233
v_add_f32 v224, v224, v234
v_mfma_f32_16x16x32_bf16 a[12:15], v[172:175], v[216:219], a[12:15]
ds_read_b64_tr_b16 v[216:217], v12 offset:512
s_waitcnt lgkmcnt(5)
v_mfma_f32_16x16x32_bf16 a[16:19], v[8:11], v[220:223], a[16:19]
ds_read_b64_tr_b16 v[218:219], v12 offset:2560
v_add_f32 v224, v224, v235
v_mfma_f32_16x16x32_bf16 a[20:23], v[40:43], v[220:223], a[20:23]
v_cvt_pk_bf16_f32 v3, v234, v235
s_add_u32 m0, s28, 0
v_mfma_f32_16x16x32_bf16 a[24:27], v[72:75], v[220:223], a[24:27]
v_exp_f32 v236, v148
v_mfma_f32_16x16x32_bf16 a[28:31], v[104:107], v[220:223], a[28:31]
ds_read_b64_tr_b16 v[220:221], v12 offset:16896
s_waitcnt lgkmcnt(5)
v_mfma_f32_16x16x32_bf16 a[16:19], v[176:179], v[208:211], a[16:19]
ds_read_b64_tr_b16 v[222:223], v12 offset:18944
buffer_load_dwordx4 v241, s[16:19], s6 offen sc1 lds
s_add_u32 m0, s28, 8192
v_mfma_f32_16x16x32_bf16 a[20:23], v[180:183], v[208:211], a[20:23]
v_exp_f32 v237, v149
v_mfma_f32_16x16x32_bf16 a[24:27], v[184:187], v[208:211], a[24:27]
v_exp_f32 v238, v150
v_mfma_f32_16x16x32_bf16 a[28:31], v[188:191], v[208:211], a[28:31]
ds_read_b64_tr_b16 v[208:209], v14 offset:512
s_waitcnt lgkmcnt(5)
v_mfma_f32_16x16x32_bf16 a[16:19], v[160:163], v[212:215], a[16:19]
ds_read_b64_tr_b16 v[210:211], v14 offset:2560
v_add_f32 v225, v229, v236
v_mfma_f32_16x16x32_bf16 a[20:23], v[164:167], v[212:215], a[20:23]
v_cvt_pk_bf16_f32 v34, v236, v237
buffer_load_dwordx4 v241, s[16:19], s7 offen sc1 lds
s_add_u32 m0, s30, 0
v_mfma_f32_16x16x32_bf16 a[24:27], v[168:171], v[212:215], a[24:27]
v_exp_f32 v239, v151
v_mfma_f32_16x16x32_bf16 a[28:31], v[172:175], v[212:215], a[28:31]
ds_read_b64_tr_b16 v[212:213], v13 offset:512
s_waitcnt lgkmcnt(5)
v_mfma_f32_16x16x32_bf16 a[32:35], v[8:11], v[216:219], a[32:35]
ds_read_b64_tr_b16 v[214:215], v13 offset:2560
v_add_f32 v225, v225, v237
v_mfma_f32_16x16x32_bf16 a[36:39], v[40:43], v[216:219], a[36:39]
v_add_f32 v225, v225, v238
v_add_f32 v225, v225, v239
v_mfma_f32_16x16x32_bf16 a[40:43], v[72:75], v[216:219], a[40:43]
v_cvt_pk_bf16_f32 v35, v238, v239
buffer_load_dwordx4 v241, s[16:19], s29 offen sc1 lds
s_add_u32 m0, s28, 4096
v_mfma_f32_16x16x32_bf16 a[44:47], v[104:107], v[216:219], a[44:47]
ds_read_b64_tr_b16 v[216:217], v13 offset:16896
s_waitcnt lgkmcnt(5)
v_xor_b32 v241, 0x1040, v241
v_mfma_f32_16x16x32_bf16 a[32:35], v[176:179], v[220:223], a[32:35]
ds_read_b64_tr_b16 v[218:219], v13 offset:18944
buffer_load_dwordx4 v241, s[16:19], s6 offen sc1 lds
s_add_u32 m0, s28, 12288
v_mfma_f32_16x16x32_bf16 a[36:39], v[180:183], v[220:223], a[36:39]
v_exp_f32 v232, v152
v_mfma_f32_16x16x32_bf16 a[40:43], v[184:187], v[220:223], a[40:43]
v_exp_f32 v233, v153
v_mfma_f32_16x16x32_bf16 a[44:47], v[188:191], v[220:223], a[44:47]
ds_read_b64_tr_b16 v[220:221], v15 offset:512
s_waitcnt lgkmcnt(5)
v_mfma_f32_16x16x32_bf16 a[32:35], v[160:163], v[208:211], a[32:35]
ds_read_b64_tr_b16 v[222:223], v15 offset:2560
buffer_load_dwordx4 v241, s[16:19], s7 offen sc1 lds
s_add_u32 m0, s30, 4096
v_mfma_f32_16x16x32_bf16 a[36:39], v[164:167], v[208:211], a[36:39]
v_exp_f32 v234, v154
v_mfma_f32_16x16x32_bf16 a[40:43], v[168:171], v[208:211], a[40:43]
v_add_f32 v226, v230, v232
v_cvt_pk_bf16_f32 v66, v232, v233
v_mfma_f32_16x16x32_bf16 a[44:47], v[172:175], v[208:211], a[44:47]
ds_read_b64_tr_b16 v[208:209], v14 offset:16384
s_waitcnt lgkmcnt(5)
v_mfma_f32_16x16x32_bf16 a[48:51], v[8:11], v[212:215], a[48:51]
ds_read_b64_tr_b16 v[210:211], v14 offset:18432
buffer_load_dwordx4 v241, s[16:19], s29 offen sc1 lds
v_mfma_f32_16x16x32_bf16 a[52:55], v[40:43], v[212:215], a[52:55]
v_exp_f32 v235, v155
v_mfma_f32_16x16x32_bf16 a[56:59], v[72:75], v[212:215], a[56:59]
v_add_f32 v226, v226, v233
v_add_f32 v226, v226, v234
v_mfma_f32_16x16x32_bf16 a[60:63], v[104:107], v[212:215], a[60:63]
ds_read_b64_tr_b16 v[212:213], v15 offset:16384
s_waitcnt lgkmcnt(5)
v_mfma_f32_16x16x32_bf16 a[48:51], v[176:179], v[216:219], a[48:51]
ds_read_b64_tr_b16 v[214:215], v15 offset:18432
v_add_f32 v226, v226, v235
v_mfma_f32_16x16x32_bf16 a[52:55], v[180:183], v[216:219], a[52:55]
v_cvt_pk_bf16_f32 v67, v234, v235
v_mfma_f32_16x16x32_bf16 a[56:59], v[184:187], v[216:219], a[56:59]
v_exp_f32 v236, v156
v_mfma_f32_16x16x32_bf16 a[60:63], v[188:191], v[216:219], a[60:63]
ds_read_b64_tr_b16 v[216:217], v14 offset:16896
s_waitcnt lgkmcnt(5)
v_mfma_f32_16x16x32_bf16 a[48:51], v[160:163], v[220:223], a[48:51]
ds_read_b64_tr_b16 v[218:219], v14 offset:18944
v_mfma_f32_16x16x32_bf16 a[52:55], v[164:167], v[220:223], a[52:55]
v_exp_f32 v237, v157
v_mfma_f32_16x16x32_bf16 a[56:59], v[168:171], v[220:223], a[56:59]
v_exp_f32 v238, v158
v_add_f32 v227, v231, v236
v_cvt_pk_bf16_f32 v98, v236, v237
v_exp_f32 v239, v159
v_add_f32 v227, v227, v237
v_add_f32 v227, v227, v238
v_add_f32 v227, v227, v239
v_cvt_pk_bf16_f32 v99, v238, v239
v_max3_f32 v242, v224, v225, v226
v_max_f32 v242, v242, v227
v_cmp_lt_f32 vcc, s32, v242
s_cbranch_vccnz L2_rare_site19
L2_ret19:
v_mfma_f32_16x16x32_bf16 a[60:63], v[172:175], v[220:223], a[60:63]
ds_read_b64_tr_b16 v[220:221], v15 offset:16896
s_waitcnt lgkmcnt(5)
v_mfma_f32_16x16x32_bf16 a[0:3], v[0:3], v[208:211], a[0:3]
ds_read_b64_tr_b16 v[222:223], v15 offset:18944
v_bfe_u32 v242, v248, 8, 1
v_mul_u32_u24 v242, 48, v242
v_mfma_f32_16x16x32_bf16 a[4:7], v[32:35], v[208:211], a[4:7]
v_lshl_add_u32 v242, s37, 3, v242
v_and_b32 v243, 0xf0, v248
v_lshl_add_u32 v242, v243, 3, v242
v_mfma_f32_16x16x32_bf16 a[8:11], v[64:67], v[208:211], a[8:11]
v_mov_b32 v232, v224
v_mov_b32 v234, v225
v_mov_b32 v236, v226
v_mfma_f32_16x16x32_bf16 a[12:15], v[96:99], v[208:211], a[12:15]
ds_read_b64_tr_b16 v[208:209], v249 offset:20480
s_waitcnt lgkmcnt(5)
v_mov_b32 v238, v227
v_mfma_f32_16x16x32_bf16 a[16:19], v[0:3], v[212:215], a[16:19]
ds_read_b64_tr_b16 v[210:211], v249 offset:22528
v_permlane32_swap_b32 v224, v232
v_permlane32_swap_b32 v225, v234
v_mfma_f32_16x16x32_bf16 a[20:23], v[32:35], v[212:215], a[20:23]
v_permlane32_swap_b32 v226, v236
v_permlane32_swap_b32 v227, v238
v_add_f32 v224, v224, v232
v_mfma_f32_16x16x32_bf16 a[24:27], v[64:67], v[212:215], a[24:27]
v_add_f32 v225, v225, v234
v_add_f32 v226, v226, v236
v_add_f32 v227, v227, v238
v_mfma_f32_16x16x32_bf16 a[28:31], v[96:99], v[212:215], a[28:31]
ds_read_b64_tr_b16 v[212:213], v12 offset:4096
s_waitcnt lgkmcnt(5)
v_mov_b32 v232, v224
v_mfma_f32_16x16x32_bf16 a[32:35], v[0:3], v[216:219], a[32:35]
ds_read_b64_tr_b16 v[214:215], v12 offset:6144
v_mov_b32 v234, v225
v_mov_b32 v236, v226
v_mfma_f32_16x16x32_bf16 a[36:39], v[32:35], v[216:219], a[36:39]
v_mov_b32 v238, v227
v_permlane16_swap_b32 v224, v232
v_permlane16_swap_b32 v225, v234
v_mfma_f32_16x16x32_bf16 a[40:43], v[64:67], v[216:219], a[40:43]
v_permlane16_swap_b32 v226, v236
v_permlane16_swap_b32 v227, v238
v_add_f32 v233, v224, v232
v_mfma_f32_16x16x32_bf16 a[44:47], v[96:99], v[216:219], a[44:47]
ds_read_b64_tr_b16 v[216:217], v12 offset:20480
s_waitcnt lgkmcnt(5)
v_add_f32 v235, v225, v234
v_mfma_f32_16x16x32_bf16 a[48:51], v[0:3], v[220:223], a[48:51]
ds_read_b64_tr_b16 v[218:219], v12 offset:22528
v_add_f32 v237, v226, v236
v_add_f32 v239, v227, v238
v_mfma_f32_16x16x32_bf16 a[52:55], v[32:35], v[220:223], a[52:55]
v_mov_b32 v232, v244
v_mov_b32 v234, v245
v_mov_b32 v236, v246
v_mfma_f32_16x16x32_bf16 a[56:59], v[64:67], v[220:223], a[56:59]
v_mov_b32 v238, v247
v_mfma_f32_16x16x32_bf16 a[60:63], v[96:99], v[220:223], a[60:63]
ds_read_b64_tr_b16 v[220:221], v14 offset:4096
s_waitcnt lgkmcnt(5)
v_mfma_f32_16x16x32_bf16 a[64:67], v[4:7], v[208:211], a[64:67]
ds_read_b64_tr_b16 v[222:223], v14 offset:6144
v_mfma_f32_16x16x32_bf16 a[68:71], v[36:39], v[208:211], a[68:71]
s_mov_b32 exec_hi, 0
buffer_store_dwordx2 v[232:233], v242, s[24:27], s48 offen sc1
s_lshr_b32 s3, s41, 2
buffer_store_dwordx2 v[234:235], v242, s[24:27], s3 offen sc1
s_lshr_b32 s3, s42, 2
buffer_store_dwordx2 v[236:237], v242, s[24:27], s3 offen sc1
s_lshr_b32 s3, s43, 2
buffer_store_dwordx2 v[238:239], v242, s[24:27], s3 offen sc1
s_mov_b32 exec_hi, -1
v_mfma_f32_16x16x32_bf16 a[72:75], v[68:71], v[208:211], a[72:75]
v_accvgpr_read_b32 v128, a0
v_accvgpr_read_b32 v129, a1
v_accvgpr_read_b32 v130, a2
v_mfma_f32_16x16x32_bf16 a[76:79], v[100:103], v[208:211], a[76:79]
ds_read_b64_tr_b16 v[208:209], v14 offset:20480
s_waitcnt lgkmcnt(5)
v_accvgpr_read_b32 v131, a3
v_mfma_f32_16x16x32_bf16 a[64:67], v[8:11], v[212:215], a[64:67]
ds_read_b64_tr_b16 v[210:211], v14 offset:22528
v_cvt_pk_bf16_f32 v16, v128, v129
v_cvt_pk_bf16_f32 v17, v130, v131
v_mfma_f32_16x16x32_bf16 a[68:71], v[40:43], v[212:215], a[68:71]
v_accvgpr_read_b32 v136, a4
v_accvgpr_read_b32 v137, a5
v_accvgpr_read_b32 v138, a6
v_mfma_f32_16x16x32_bf16 a[72:75], v[72:75], v[212:215], a[72:75]
v_accvgpr_read_b32 v139, a7
v_cvt_pk_bf16_f32 v48, v136, v137
v_cvt_pk_bf16_f32 v49, v138, v139
v_mfma_f32_16x16x32_bf16 a[76:79], v[104:107], v[212:215], a[76:79]
ds_read_b64_tr_b16 v[212:213], v250 offset:20480
s_waitcnt lgkmcnt(5)
v_accvgpr_read_b32 v144, a8
v_mfma_f32_16x16x32_bf16 a[64:67], v[176:179], v[216:219], a[64:67]
ds_read_b64_tr_b16 v[214:215], v250 offset:22528
v_accvgpr_read_b32 v145, a9
v_accvgpr_read_b32 v146, a10
v_mfma_f32_16x16x32_bf16 a[68:71], v[180:183], v[216:219], a[68:71]
v_accvgpr_read_b32 v147, a11
v_cvt_pk_bf16_f32 v80, v144, v145
v_cvt_pk_bf16_f32 v81, v146, v147
v_mfma_f32_16x16x32_bf16 a[72:75], v[184:187], v[216:219], a[72:75]
v_accvgpr_read_b32 v152, a12
v_accvgpr_read_b32 v153, a13
v_accvgpr_read_b32 v154, a14
v_mfma_f32_16x16x32_bf16 a[76:79], v[188:191], v[216:219], a[76:79]
ds_read_b64_tr_b16 v[216:217], v13 offset:4096
s_waitcnt lgkmcnt(5)
v_accvgpr_read_b32 v155, a15
v_mfma_f32_16x16x32_bf16 a[64:67], v[160:163], v[220:223], a[64:67]
ds_read_b64_tr_b16 v[218:219], v13 offset:6144
v_cvt_pk_bf16_f32 v112, v152, v153
v_cvt_pk_bf16_f32 v113, v154, v155
v_mfma_f32_16x16x32_bf16 a[68:71], v[164:167], v[220:223], a[68:71]
v_accvgpr_read_b32 v132, a16
v_accvgpr_read_b32 v133, a17
v_accvgpr_read_b32 v134, a18
v_mfma_f32_16x16x32_bf16 a[72:75], v[168:171], v[220:223], a[72:75]
v_accvgpr_read_b32 v135, a19
v_cvt_pk_bf16_f32 v18, v132, v133
v_cvt_pk_bf16_f32 v19, v134, v135
v_mfma_f32_16x16x32_bf16 a[76:79], v[172:175], v[220:223], a[76:79]
ds_read_b64_tr_b16 v[220:221], v13 offset:20480
s_waitcnt lgkmcnt(5)
buffer_store_dwordx4 v[16:19], v248, s[20:23], s40 offen offset:0 sc1
v_mfma_f32_16x16x32_bf16 a[64:67], v[0:3], v[208:211], a[64:67]
ds_read_b64_tr_b16 v[222:223], v13 offset:22528
ds_write_b128 v253, v[16:19] offset:0
v_accvgpr_read_b32 v140, a20
v_mfma_f32_16x16x32_bf16 a[68:71], v[32:35], v[208:211], a[68:71]
v_accvgpr_read_b32 v141, a21
v_accvgpr_read_b32 v142, a22
v_accvgpr_read_b32 v143, a23
v_mfma_f32_16x16x32_bf16 a[72:75], v[64:67], v[208:211], a[72:75]
v_cvt_pk_bf16_f32 v50, v140, v141
v_cvt_pk_bf16_f32 v51, v142, v143
buffer_store_dwordx4 v[48:51], v248, s[20:23], s41 offen offset:0 sc1
v_mfma_f32_16x16x32_bf16 a[76:79], v[96:99], v[208:211], a[76:79]
ds_read_b64_tr_b16 v[208:209], v15 offset:4096
s_waitcnt lgkmcnt(5)
v_accvgpr_read_b32 v148, a24
v_mfma_f32_16x16x32_bf16 a[80:83], v[4:7], v[212:215], a[80:83]
ds_read_b64_tr_b16 v[210:211], v15 offset:6144
v_accvgpr_read_b32 v149, a25
v_accvgpr_read_b32 v150, a26
v_mfma_f32_16x16x32_bf16 a[84:87], v[36:39], v[212:215], a[84:87]
v_accvgpr_read_b32 v151, a27
v_cvt_pk_bf16_f32 v82, v148, v149
v_cvt_pk_bf16_f32 v83, v150, v151
v_mfma_f32_16x16x32_bf16 a[88:91], v[68:71], v[212:215], a[88:91]
buffer_store_dwordx4 v[80:83], v248, s[20:23], s42 offen offset:0 sc1
v_accvgpr_read_b32 v156, a28
v_accvgpr_read_b32 v157, a29
v_mfma_f32_16x16x32_bf16 a[92:95], v[100:103], v[212:215], a[92:95]
ds_read_b64_tr_b16 v[212:213], v15 offset:20480
s_waitcnt lgkmcnt(5)
v_accvgpr_read_b32 v158, a30
v_mfma_f32_16x16x32_bf16 a[80:83], v[8:11], v[216:219], a[80:83]
ds_read_b64_tr_b16 v[214:215], v15 offset:22528
v_accvgpr_read_b32 v159, a31
v_cvt_pk_bf16_f32 v114, v156, v157
v_mfma_f32_16x16x32_bf16 a[84:87], v[40:43], v[216:219], a[84:87]
v_cvt_pk_bf16_f32 v115, v158, v159
buffer_store_dwordx4 v[112:115], v248, s[20:23], s43 offen offset:0 sc1
v_accvgpr_read_b32 v128, a32
v_mfma_f32_16x16x32_bf16 a[88:91], v[72:75], v[216:219], a[88:91]
v_accvgpr_read_b32 v129, a33
v_accvgpr_read_b32 v130, a34
v_accvgpr_read_b32 v131, a35
v_mfma_f32_16x16x32_bf16 a[92:95], v[104:107], v[216:219], a[92:95]
ds_read_b64_tr_b16 v[216:217], v249 offset:20992
s_waitcnt lgkmcnt(5)
v_cvt_pk_bf16_f32 v20, v128, v129
v_mfma_f32_16x16x32_bf16 a[80:83], v[176:179], v[220:223], a[80:83]
ds_read_b64_tr_b16 v[218:219], v249 offset:23040
v_cvt_pk_bf16_f32 v21, v130, v131
v_accvgpr_read_b32 v136, a36
v_mfma_f32_16x16x32_bf16 a[84:87], v[180:183], v[220:223], a[84:87]
v_accvgpr_read_b32 v137, a37
v_accvgpr_read_b32 v138, a38
v_accvgpr_read_b32 v139, a39
v_mfma_f32_16x16x32_bf16 a[88:91], v[184:187], v[220:223], a[88:91]
v_cvt_pk_bf16_f32 v52, v136, v137
v_cvt_pk_bf16_f32 v53, v138, v139
v_accvgpr_read_b32 v144, a40
v_mfma_f32_16x16x32_bf16 a[92:95], v[188:191], v[220:223], a[92:95]
ds_read_b64_tr_b16 v[220:221], v12 offset:4608
s_waitcnt lgkmcnt(5)
v_accvgpr_read_b32 v145, a41
v_mfma_f32_16x16x32_bf16 a[80:83], v[160:163], v[208:211], a[80:83]
ds_read_b64_tr_b16 v[222:223], v12 offset:6656
v_accvgpr_read_b32 v146, a42
v_accvgpr_read_b32 v147, a43
v_mfma_f32_16x16x32_bf16 a[84:87], v[164:167], v[208:211], a[84:87]
v_cvt_pk_bf16_f32 v84, v144, v145
v_cvt_pk_bf16_f32 v85, v146, v147
v_accvgpr_read_b32 v152, a44
v_mfma_f32_16x16x32_bf16 a[88:91], v[168:171], v[208:211], a[88:91]
v_accvgpr_read_b32 v153, a45
v_accvgpr_read_b32 v154, a46
v_accvgpr_read_b32 v155, a47
v_mfma_f32_16x16x32_bf16 a[92:95], v[172:175], v[208:211], a[92:95]
ds_read_b64_tr_b16 v[208:209], v12 offset:20992
s_waitcnt lgkmcnt(5)
v_cvt_pk_bf16_f32 v116, v152, v153
v_mfma_f32_16x16x32_bf16 a[80:83], v[0:3], v[212:215], a[80:83]
ds_read_b64_tr_b16 v[210:211], v12 offset:23040
v_cvt_pk_bf16_f32 v117, v154, v155
v_accvgpr_read_b32 v132, a48
v_mfma_f32_16x16x32_bf16 a[84:87], v[32:35], v[212:215], a[84:87]
v_accvgpr_read_b32 v133, a49
v_accvgpr_read_b32 v134, a50
v_accvgpr_read_b32 v135, a51
v_mfma_f32_16x16x32_bf16 a[88:91], v[64:67], v[212:215], a[88:91]
v_cvt_pk_bf16_f32 v22, v132, v133
v_cvt_pk_bf16_f32 v23, v134, v135
buffer_store_dwordx4 v[20:23], v248, s[20:23], s40 offen offset:1024 sc1
v_mfma_f32_16x16x32_bf16 a[92:95], v[96:99], v[212:215], a[92:95]
ds_read_b64_tr_b16 v[212:213], v14 offset:4608
s_waitcnt lgkmcnt(5)
ds_write_b128 v253, v[20:23] offset:1024
v_mfma_f32_16x16x32_bf16 a[96:99], v[4:7], v[216:219], a[96:99]
ds_read_b64_tr_b16 v[214:215], v14 offset:6656
v_accvgpr_read_b32 v140, a52
v_accvgpr_read_b32 v141, a53
v_mfma_f32_16x16x32_bf16 a[100:103], v[36:39], v[216:219], a[100:103]
v_accvgpr_read_b32 v142, a54
v_accvgpr_read_b32 v143, a55
v_cvt_pk_bf16_f32 v54, v140, v141
v_mfma_f32_16x16x32_bf16 a[104:107], v[68:71], v[216:219], a[104:107]
v_cvt_pk_bf16_f32 v55, v142, v143
buffer_store_dwordx4 v[52:55], v248, s[20:23], s41 offen offset:1024 sc1
v_accvgpr_read_b32 v148, a56
v_mfma_f32_16x16x32_bf16 a[108:111], v[100:103], v[216:219], a[108:111]
ds_read_b64_tr_b16 v[216:217], v14 offset:20992
s_waitcnt lgkmcnt(5)
v_accvgpr_read_b32 v149, a57
v_mfma_f32_16x16x32_bf16 a[96:99], v[8:11], v[220:223], a[96:99]
ds_read_b64_tr_b16 v[218:219], v14 offset:23040
v_accvgpr_read_b32 v150, a58
v_accvgpr_read_b32 v151, a59
v_mfma_f32_16x16x32_bf16 a[100:103], v[40:43], v[220:223], a[100:103]
v_cvt_pk_bf16_f32 v86, v148, v149
v_cvt_pk_bf16_f32 v87, v150, v151
buffer_store_dwordx4 v[84:87], v248, s[20:23], s42 offen offset:1024 sc1
v_mfma_f32_16x16x32_bf16 a[104:107], v[72:75], v[220:223], a[104:107]
v_accvgpr_read_b32 v156, a60
v_accvgpr_read_b32 v157, a61
v_accvgpr_read_b32 v158, a62
v_mfma_f32_16x16x32_bf16 a[108:111], v[104:107], v[220:223], a[108:111]
ds_read_b64_tr_b16 v[220:221], v250 offset:20992
s_waitcnt lgkmcnt(5)
v_accvgpr_read_b32 v159, a63
v_mfma_f32_16x16x32_bf16 a[96:99], v[176:179], v[208:211], a[96:99]
ds_read_b64_tr_b16 v[222:223], v250 offset:23040
v_cvt_pk_bf16_f32 v118, v156, v157
v_cvt_pk_bf16_f32 v119, v158, v159
v_mfma_f32_16x16x32_bf16 a[100:103], v[180:183], v[208:211], a[100:103]
buffer_store_dwordx4 v[116:119], v248, s[20:23], s43 offen offset:1024 sc1
v_accvgpr_read_b32 v128, a64
v_accvgpr_read_b32 v129, a65
v_mfma_f32_16x16x32_bf16 a[104:107], v[184:187], v[208:211], a[104:107]
v_accvgpr_read_b32 v130, a66
v_accvgpr_read_b32 v131, a67
v_cvt_pk_bf16_f32 v24, v128, v129
v_mfma_f32_16x16x32_bf16 a[108:111], v[188:191], v[208:211], a[108:111]
ds_read_b64_tr_b16 v[208:209], v13 offset:4608
s_waitcnt lgkmcnt(5)
v_cvt_pk_bf16_f32 v25, v130, v131
v_mfma_f32_16x16x32_bf16 a[96:99], v[160:163], v[212:215], a[96:99]
ds_read_b64_tr_b16 v[210:211], v13 offset:6656
v_accvgpr_read_b32 v136, a68
v_accvgpr_read_b32 v137, a69
v_mfma_f32_16x16x32_bf16 a[100:103], v[164:167], v[212:215], a[100:103]
v_accvgpr_read_b32 v138, a70
v_accvgpr_read_b32 v139, a71
v_cvt_pk_bf16_f32 v56, v136, v137
v_mfma_f32_16x16x32_bf16 a[104:107], v[168:171], v[212:215], a[104:107]
v_cvt_pk_bf16_f32 v57, v138, v139
v_accvgpr_read_b32 v144, a72
v_accvgpr_read_b32 v145, a73
v_mfma_f32_16x16x32_bf16 a[108:111], v[172:175], v[212:215], a[108:111]
ds_read_b64_tr_b16 v[212:213], v13 offset:20992
s_waitcnt lgkmcnt(5)
v_accvgpr_read_b32 v146, a74
v_mfma_f32_16x16x32_bf16 a[96:99], v[0:3], v[216:219], a[96:99]
ds_read_b64_tr_b16 v[214:215], v13 offset:23040
v_accvgpr_read_b32 v147, a75
v_cvt_pk_bf16_f32 v88, v144, v145
v_mfma_f32_16x16x32_bf16 a[100:103], v[32:35], v[216:219], a[100:103]
v_cvt_pk_bf16_f32 v89, v146, v147
v_accvgpr_read_b32 v152, a76
v_accvgpr_read_b32 v153, a77
v_mfma_f32_16x16x32_bf16 a[104:107], v[64:67], v[216:219], a[104:107]
v_accvgpr_read_b32 v154, a78
v_accvgpr_read_b32 v155, a79
v_cvt_pk_bf16_f32 v120, v152, v153
v_mfma_f32_16x16x32_bf16 a[108:111], v[96:99], v[216:219], a[108:111]
ds_read_b64_tr_b16 v[216:217], v15 offset:4608
s_waitcnt lgkmcnt(5)
v_cvt_pk_bf16_f32 v121, v154, v155
v_mfma_f32_16x16x32_bf16 a[112:115], v[4:7], v[220:223], a[112:115]
ds_read_b64_tr_b16 v[218:219], v15 offset:6656
v_accvgpr_read_b32 v132, a80
v_accvgpr_read_b32 v133, a81
v_mfma_f32_16x16x32_bf16 a[116:119], v[36:39], v[220:223], a[116:119]
v_accvgpr_read_b32 v134, a82
v_accvgpr_read_b32 v135, a83
v_cvt_pk_bf16_f32 v26, v132, v133
v_mfma_f32_16x16x32_bf16 a[120:123], v[68:71], v[220:223], a[120:123]
v_cvt_pk_bf16_f32 v27, v134, v135
buffer_store_dwordx4 v[24:27], v248, s[20:23], s40 offen offset:2048 sc1
ds_write_b128 v253, v[24:27] offset:2048
v_mfma_f32_16x16x32_bf16 a[124:127], v[100:103], v[220:223], a[124:127]
ds_read_b64_tr_b16 v[220:221], v15 offset:20992
s_waitcnt lgkmcnt(5)
v_accvgpr_read_b32 v140, a84
v_mfma_f32_16x16x32_bf16 a[112:115], v[8:11], v[208:211], a[112:115]
ds_read_b64_tr_b16 v[222:223], v15 offset:23040
v_accvgpr_read_b32 v141, a85
v_accvgpr_read_b32 v142, a86
v_mfma_f32_16x16x32_bf16 a[116:119], v[40:43], v[208:211], a[116:119]
v_accvgpr_read_b32 v143, a87
v_cvt_pk_bf16_f32 v58, v140, v141
v_cvt_pk_bf16_f32 v59, v142, v143
v_mfma_f32_16x16x32_bf16 a[120:123], v[72:75], v[208:211], a[120:123]
buffer_store_dwordx4 v[56:59], v248, s[20:23], s41 offen offset:2048 sc1
v_accvgpr_read_b32 v148, a88
v_accvgpr_read_b32 v149, a89
v_mfma_f32_16x16x32_bf16 a[124:127], v[104:107], v[208:211], a[124:127]
ds_read_b64_tr_b16 v[208:209], v249 offset:24576
s_waitcnt lgkmcnt(5)
v_accvgpr_read_b32 v150, a90
v_mfma_f32_16x16x32_bf16 a[112:115], v[176:179], v[212:215], a[112:115]
ds_read_b64_tr_b16 v[210:211], v249 offset:26624
v_accvgpr_read_b32 v151, a91
v_cvt_pk_bf16_f32 v90, v148, v149
v_mfma_f32_16x16x32_bf16 a[116:119], v[180:183], v[212:215], a[116:119]
v_cvt_pk_bf16_f32 v91, v150, v151
buffer_store_dwordx4 v[88:91], v248, s[20:23], s42 offen offset:2048 sc1
v_accvgpr_read_b32 v156, a92
v_mfma_f32_16x16x32_bf16 a[120:123], v[184:187], v[212:215], a[120:123]
v_accvgpr_read_b32 v157, a93
v_accvgpr_read_b32 v158, a94
v_accvgpr_read_b32 v159, a95
v_mfma_f32_16x16x32_bf16 a[124:127], v[188:191], v[212:215], a[124:127]
ds_read_b64_tr_b16 v[212:213], v12 offset:8192
s_waitcnt lgkmcnt(5)
v_cvt_pk_bf16_f32 v122, v156, v157
v_mfma_f32_16x16x32_bf16 a[112:115], v[160:163], v[216:219], a[112:115]
ds_read_b64_tr_b16 v[214:215], v12 offset:10240
v_cvt_pk_bf16_f32 v123, v158, v159
buffer_store_dwordx4 v[120:123], v248, s[20:23], s43 offen offset:2048 sc1
v_mfma_f32_16x16x32_bf16 a[116:119], v[164:167], v[216:219], a[116:119]
v_accvgpr_read_b32 v128, a96
v_accvgpr_read_b32 v129, a97
v_mfma_f32_16x16x32_bf16 a[120:123], v[168:171], v[216:219], a[120:123]
v_accvgpr_read_b32 v130, a98
v_accvgpr_read_b32 v131, a99
v_mfma_f32_16x16x32_bf16 a[124:127], v[172:175], v[216:219], a[124:127]
ds_read_b64_tr_b16 v[216:217], v12 offset:24576
s_waitcnt lgkmcnt(5)
v_mfma_f32_16x16x32_bf16 a[112:115], v[0:3], v[220:223], a[112:115]
ds_read_b64_tr_b16 v[218:219], v12 offset:26624
v_cvt_pk_bf16_f32 v28, v128, v129
v_mfma_f32_16x16x32_bf16 a[116:119], v[32:35], v[220:223], a[116:119]
v_cvt_pk_bf16_f32 v29, v130, v131
v_accvgpr_read_b32 v136, a100
v_mfma_f32_16x16x32_bf16 a[120:123], v[64:67], v[220:223], a[120:123]
v_accvgpr_read_b32 v137, a101
v_accvgpr_read_b32 v138, a102
v_mfma_f32_16x16x32_bf16 a[124:127], v[96:99], v[220:223], a[124:127]
ds_read_b64_tr_b16 v[220:221], v14 offset:8192
s_waitcnt lgkmcnt(5)
v_mfma_f32_16x16x32_bf16 a[128:131], v[4:7], v[208:211], a[128:131]
ds_read_b64_tr_b16 v[222:223], v14 offset:10240
v_accvgpr_read_b32 v139, a103
v_mfma_f32_16x16x32_bf16 a[132:135], v[36:39], v[208:211], a[132:135]
v_cvt_pk_bf16_f32 v60, v136, v137
v_cvt_pk_bf16_f32 v61, v138, v139
v_mfma_f32_16x16x32_bf16 a[136:139], v[68:71], v[208:211], a[136:139]
v_accvgpr_read_b32 v144, a104
v_accvgpr_read_b32 v145, a105
v_mfma_f32_16x16x32_bf16 a[140:143], v[100:103], v[208:211], a[140:143]
ds_read_b64_tr_b16 v[208:209], v14 offset:24576
s_waitcnt lgkmcnt(5)
v_mfma_f32_16x16x32_bf16 a[128:131], v[8:11], v[212:215], a[128:131]
ds_read_b64_tr_b16 v[210:211], v14 offset:26624
v_accvgpr_read_b32 v146, a106
v_mfma_f32_16x16x32_bf16 a[132:135], v[40:43], v[212:215], a[132:135]
v_accvgpr_read_b32 v147, a107
v_cvt_pk_bf16_f32 v92, v144, v145
v_mfma_f32_16x16x32_bf16 a[136:139], v[72:75], v[212:215], a[136:139]
v_cvt_pk_bf16_f32 v93, v146, v147
v_accvgpr_read_b32 v152, a108
v_mfma_f32_16x16x32_bf16 a[140:143], v[104:107], v[212:215], a[140:143]
ds_read_b64_tr_b16 v[212:213], v250 offset:24576
s_waitcnt lgkmcnt(5)
v_mfma_f32_16x16x32_bf16 a[128:131], v[176:179], v[216:219], a[128:131]
ds_read_b64_tr_b16 v[214:215], v250 offset:26624
v_accvgpr_read_b32 v153, a109
v_mfma_f32_16x16x32_bf16 a[132:135], v[180:183], v[216:219], a[132:135]
v_accvgpr_read_b32 v154, a110
v_accvgpr_read_b32 v155, a111
v_mfma_f32_16x16x32_bf16 a[136:139], v[184:187], v[216:219], a[136:139]
v_cvt_pk_bf16_f32 v124, v152, v153
v_cvt_pk_bf16_f32 v125, v154, v155
v_mfma_f32_16x16x32_bf16 a[140:143], v[188:191], v[216:219], a[140:143]
ds_read_b64_tr_b16 v[216:217], v13 offset:8192
s_waitcnt lgkmcnt(5)
v_mfma_f32_16x16x32_bf16 a[128:131], v[160:163], v[220:223], a[128:131]
ds_read_b64_tr_b16 v[218:219], v13 offset:10240
v_accvgpr_read_b32 v132, a112
v_mfma_f32_16x16x32_bf16 a[132:135], v[164:167], v[220:223], a[132:135]
v_accvgpr_read_b32 v133, a113
v_accvgpr_read_b32 v134, a114
v_mfma_f32_16x16x32_bf16 a[136:139], v[168:171], v[220:223], a[136:139]
v_accvgpr_read_b32 v135, a115
v_cvt_pk_bf16_f32 v30, v132, v133
v_mfma_f32_16x16x32_bf16 a[140:143], v[172:175], v[220:223], a[140:143]
ds_read_b64_tr_b16 v[220:221], v13 offset:24576
s_waitcnt lgkmcnt(5)
v_mfma_f32_16x16x32_bf16 a[128:131], v[0:3], v[208:211], a[128:131]
ds_read_b64_tr_b16 v[222:223], v13 offset:26624
v_cvt_pk_bf16_f32 v31, v134, v135
v_mfma_f32_16x16x32_bf16 a[132:135], v[32:35], v[208:211], a[132:135]
buffer_store_dwordx4 v[28:31], v248, s[20:23], s40 offen offset:3072 sc1
ds_write_b128 v253, v[28:31] offset:3072
v_mfma_f32_16x16x32_bf16 a[136:139], v[64:67], v[208:211], a[136:139]
v_accvgpr_read_b32 v140, a116
v_accvgpr_read_b32 v141, a117
v_mfma_f32_16x16x32_bf16 a[140:143], v[96:99], v[208:211], a[140:143]
ds_read_b64_tr_b16 v[208:209], v15 offset:8192
s_waitcnt lgkmcnt(5)
v_mfma_f32_16x16x32_bf16 a[144:147], v[4:7], v[212:215], a[144:147]
ds_read_b64_tr_b16 v[210:211], v15 offset:10240
v_accvgpr_read_b32 v142, a118
v_mfma_f32_16x16x32_bf16 a[148:151], v[36:39], v[212:215], a[148:151]
v_accvgpr_read_b32 v143, a119
v_cvt_pk_bf16_f32 v62, v140, v141
v_mfma_f32_16x16x32_bf16 a[152:155], v[68:71], v[212:215], a[152:155]
v_cvt_pk_bf16_f32 v63, v142, v143
buffer_store_dwordx4 v[60:63], v248, s[20:23], s41 offen offset:3072 sc1
v_mfma_f32_16x16x32_bf16 a[156:159], v[100:103], v[212:215], a[156:159]
ds_read_b64_tr_b16 v[212:213], v15 offset:24576
s_waitcnt lgkmcnt(5)
v_mfma_f32_16x16x32_bf16 a[144:147], v[8:11], v[216:219], a[144:147]
ds_read_b64_tr_b16 v[214:215], v15 offset:26624
v_accvgpr_read_b32 v148, a120
v_mfma_f32_16x16x32_bf16 a[148:151], v[40:43], v[216:219], a[148:151]
v_accvgpr_read_b32 v149, a121
v_accvgpr_read_b32 v150, a122
v_mfma_f32_16x16x32_bf16 a[152:155], v[72:75], v[216:219], a[152:155]
v_accvgpr_read_b32 v151, a123
v_cvt_pk_bf16_f32 v94, v148, v149
v_mfma_f32_16x16x32_bf16 a[156:159], v[104:107], v[216:219], a[156:159]
ds_read_b64_tr_b16 v[216:217], v249 offset:25088
s_waitcnt lgkmcnt(5)
v_mfma_f32_16x16x32_bf16 a[144:147], v[176:179], v[220:223], a[144:147]
ds_read_b64_tr_b16 v[218:219], v249 offset:27136
v_cvt_pk_bf16_f32 v95, v150, v151
v_mfma_f32_16x16x32_bf16 a[148:151], v[180:183], v[220:223], a[148:151]
buffer_store_dwordx4 v[92:95], v248, s[20:23], s42 offen offset:3072 sc1
v_accvgpr_read_b32 v156, a124
v_mfma_f32_16x16x32_bf16 a[152:155], v[184:187], v[220:223], a[152:155]
v_accvgpr_read_b32 v157, a125
v_accvgpr_read_b32 v158, a126
v_mfma_f32_16x16x32_bf16 a[156:159], v[188:191], v[220:223], a[156:159]
ds_read_b64_tr_b16 v[220:221], v12 offset:8704
s_waitcnt lgkmcnt(5)
v_mfma_f32_16x16x32_bf16 a[144:147], v[160:163], v[208:211], a[144:147]
ds_read_b64_tr_b16 v[222:223], v12 offset:10752
v_accvgpr_read_b32 v159, a127
v_mfma_f32_16x16x32_bf16 a[148:151], v[164:167], v[208:211], a[148:151]
v_cvt_pk_bf16_f32 v126, v156, v157
v_cvt_pk_bf16_f32 v127, v158, v159
v_mfma_f32_16x16x32_bf16 a[152:155], v[168:171], v[208:211], a[152:155]
buffer_store_dwordx4 v[124:127], v248, s[20:23], s43 offen offset:3072 sc1
v_accvgpr_read_b32 v128, a128
v_mfma_f32_16x16x32_bf16 a[156:159], v[172:175], v[208:211], a[156:159]
ds_read_b64_tr_b16 v[208:209], v12 offset:25088
s_waitcnt lgkmcnt(5)
v_mfma_f32_16x16x32_bf16 a[144:147], v[0:3], v[212:215], a[144:147]
ds_read_b64_tr_b16 v[210:211], v12 offset:27136
v_accvgpr_read_b32 v129, a129
v_mfma_f32_16x16x32_bf16 a[148:151], v[32:35], v[212:215], a[148:151]
v_accvgpr_read_b32 v130, a130
v_accvgpr_read_b32 v131, a131
v_mfma_f32_16x16x32_bf16 a[152:155], v[64:67], v[212:215], a[152:155]
v_cvt_pk_bf16_f32 v16, v128, v129
v_cvt_pk_bf16_f32 v17, v130, v131
v_mfma_f32_16x16x32_bf16 a[156:159], v[96:99], v[212:215], a[156:159]
ds_read_b64_tr_b16 v[212:213], v14 offset:8704
s_waitcnt lgkmcnt(5)
v_mfma_f32_16x16x32_bf16 a[160:163], v[4:7], v[216:219], a[160:163]
ds_read_b64_tr_b16 v[214:215], v14 offset:10752
v_accvgpr_read_b32 v136, a132
v_mfma_f32_16x16x32_bf16 a[164:167], v[36:39], v[216:219], a[164:167]
v_accvgpr_read_b32 v137, a133
v_accvgpr_read_b32 v138, a134
v_mfma_f32_16x16x32_bf16 a[168:171], v[68:71], v[216:219], a[168:171]
v_accvgpr_read_b32 v139, a135
v_cvt_pk_bf16_f32 v48, v136, v137
v_mfma_f32_16x16x32_bf16 a[172:175], v[100:103], v[216:219], a[172:175]
ds_read_b64_tr_b16 v[216:217], v14 offset:25088
s_waitcnt lgkmcnt(5)
v_mfma_f32_16x16x32_bf16 a[160:163], v[8:11], v[220:223], a[160:163]
ds_read_b64_tr_b16 v[218:219], v14 offset:27136
v_cvt_pk_bf16_f32 v49, v138, v139
v_mfma_f32_16x16x32_bf16 a[164:167], v[40:43], v[220:223], a[164:167]
v_accvgpr_read_b32 v144, a136
v_accvgpr_read_b32 v145, a137
v_mfma_f32_16x16x32_bf16 a[168:171], v[72:75], v[220:223], a[168:171]
v_accvgpr_read_b32 v146, a138
v_accvgpr_read_b32 v147, a139
v_mfma_f32_16x16x32_bf16 a[172:175], v[104:107], v[220:223], a[172:175]
ds_read_b64_tr_b16 v[220:221], v250 offset:25088
s_waitcnt lgkmcnt(5)
v_mfma_f32_16x16x32_bf16 a[160:163], v[176:179], v[208:211], a[160:163]
ds_read_b64_tr_b16 v[222:223], v250 offset:27136
v_cvt_pk_bf16_f32 v80, v144, v145
v_mfma_f32_16x16x32_bf16 a[164:167], v[180:183], v[208:211], a[164:167]
v_cvt_pk_bf16_f32 v81, v146, v147
v_accvgpr_read_b32 v152, a140
v_mfma_f32_16x16x32_bf16 a[168:171], v[184:187], v[208:211], a[168:171]
v_accvgpr_read_b32 v153, a141
v_accvgpr_read_b32 v154, a142
v_mfma_f32_16x16x32_bf16 a[172:175], v[188:191], v[208:211], a[172:175]
ds_read_b64_tr_b16 v[208:209], v13 offset:8704
s_waitcnt lgkmcnt(5)
v_mfma_f32_16x16x32_bf16 a[160:163], v[160:163], v[212:215], a[160:163]
ds_read_b64_tr_b16 v[210:211], v13 offset:10752
v_accvgpr_read_b32 v155, a143
v_mfma_f32_16x16x32_bf16 a[164:167], v[164:167], v[212:215], a[164:167]
v_cvt_pk_bf16_f32 v112, v152, v153
v_cvt_pk_bf16_f32 v113, v154, v155
v_mfma_f32_16x16x32_bf16 a[168:171], v[168:171], v[212:215], a[168:171]
v_accvgpr_read_b32 v132, a144
v_accvgpr_read_b32 v133, a145
v_mfma_f32_16x16x32_bf16 a[172:175], v[172:175], v[212:215], a[172:175]
ds_read_b64_tr_b16 v[212:213], v13 offset:25088
s_waitcnt lgkmcnt(5)
v_mfma_f32_16x16x32_bf16 a[160:163], v[0:3], v[216:219], a[160:163]
ds_read_b64_tr_b16 v[214:215], v13 offset:27136
v_accvgpr_read_b32 v134, a146
v_mfma_f32_16x16x32_bf16 a[164:167], v[32:35], v[216:219], a[164:167]
v_accvgpr_read_b32 v135, a147
v_cvt_pk_bf16_f32 v18, v132, v133
v_mfma_f32_16x16x32_bf16 a[168:171], v[64:67], v[216:219], a[168:171]
v_cvt_pk_bf16_f32 v19, v134, v135
buffer_store_dwordx4 v[16:19], v248, s[20:23], s44 offen offset:0 sc1
v_mfma_f32_16x16x32_bf16 a[172:175], v[96:99], v[216:219], a[172:175]
ds_read_b64_tr_b16 v[216:217], v15 offset:8704
s_waitcnt lgkmcnt(5)
v_mfma_f32_16x16x32_bf16 a[176:179], v[4:7], v[220:223], a[176:179]
ds_read_b64_tr_b16 v[218:219], v15 offset:10752
ds_write_b128 v253, v[16:19] offset:4096
v_mfma_f32_16x16x32_bf16 a[180:183], v[36:39], v[220:223], a[180:183]
v_accvgpr_read_b32 v140, a148
v_accvgpr_read_b32 v141, a149
v_mfma_f32_16x16x32_bf16 a[184:187], v[68:71], v[220:223], a[184:187]
v_accvgpr_read_b32 v142, a150
v_accvgpr_read_b32 v143, a151
v_mfma_f32_16x16x32_bf16 a[188:191], v[100:103], v[220:223], a[188:191]
ds_read_b64_tr_b16 v[220:221], v15 offset:25088
s_waitcnt lgkmcnt(5)
v_mfma_f32_16x16x32_bf16 a[176:179], v[8:11], v[208:211], a[176:179]
ds_read_b64_tr_b16 v[222:223], v15 offset:27136
v_cvt_pk_bf16_f32 v50, v140, v141
v_mfma_f32_16x16x32_bf16 a[180:183], v[40:43], v[208:211], a[180:183]
v_cvt_pk_bf16_f32 v51, v142, v143
buffer_store_dwordx4 v[48:51], v248, s[20:23], s45 offen offset:0 sc1
v_mfma_f32_16x16x32_bf16 a[184:187], v[72:75], v[208:211], a[184:187]
v_accvgpr_read_b32 v148, a152
v_accvgpr_read_b32 v149, a153
v_mfma_f32_16x16x32_bf16 a[188:191], v[104:107], v[208:211], a[188:191]
ds_read_b64_tr_b16 v[208:209], v249 offset:28672
s_waitcnt lgkmcnt(5)
v_mfma_f32_16x16x32_bf16 a[176:179], v[176:179], v[212:215], a[176:179]
ds_read_b64_tr_b16 v[210:211], v249 offset:30720
v_accvgpr_read_b32 v150, a154
v_mfma_f32_16x16x32_bf16 a[180:183], v[180:183], v[212:215], a[180:183]
v_accvgpr_read_b32 v151, a155
v_cvt_pk_bf16_f32 v82, v148, v149
v_mfma_f32_16x16x32_bf16 a[184:187], v[184:187], v[212:215], a[184:187]
v_cvt_pk_bf16_f32 v83, v150, v151
buffer_store_dwordx4 v[80:83], v248, s[20:23], s46 offen offset:0 sc1
v_mfma_f32_16x16x32_bf16 a[188:191], v[188:191], v[212:215], a[188:191]
ds_read_b64_tr_b16 v[212:213], v12 offset:12288
s_waitcnt lgkmcnt(5)
v_mfma_f32_16x16x32_bf16 a[176:179], v[160:163], v[216:219], a[176:179]
ds_read_b64_tr_b16 v[214:215], v12 offset:14336
v_accvgpr_read_b32 v156, a156
v_mfma_f32_16x16x32_bf16 a[180:183], v[164:167], v[216:219], a[180:183]
v_accvgpr_read_b32 v157, a157
v_accvgpr_read_b32 v158, a158
v_mfma_f32_16x16x32_bf16 a[184:187], v[168:171], v[216:219], a[184:187]
v_accvgpr_read_b32 v159, a159
v_cvt_pk_bf16_f32 v114, v156, v157
v_mfma_f32_16x16x32_bf16 a[188:191], v[172:175], v[216:219], a[188:191]
ds_read_b64_tr_b16 v[216:217], v12 offset:28672
s_waitcnt lgkmcnt(5)
v_mfma_f32_16x16x32_bf16 a[176:179], v[0:3], v[220:223], a[176:179]
ds_read_b64_tr_b16 v[218:219], v12 offset:30720
v_cvt_pk_bf16_f32 v115, v158, v159
v_mfma_f32_16x16x32_bf16 a[180:183], v[32:35], v[220:223], a[180:183]
buffer_store_dwordx4 v[112:115], v248, s[20:23], s47 offen offset:0 sc1
v_accvgpr_read_b32 v128, a160
v_mfma_f32_16x16x32_bf16 a[184:187], v[64:67], v[220:223], a[184:187]
v_accvgpr_read_b32 v129, a161
v_accvgpr_read_b32 v130, a162
v_mfma_f32_16x16x32_bf16 a[188:191], v[96:99], v[220:223], a[188:191]
ds_read_b64_tr_b16 v[220:221], v14 offset:12288
s_waitcnt lgkmcnt(5)
v_mfma_f32_16x16x32_bf16 a[192:195], v[4:7], v[208:211], a[192:195]
ds_read_b64_tr_b16 v[222:223], v14 offset:14336
v_accvgpr_read_b32 v131, a163
v_mfma_f32_16x16x32_bf16 a[196:199], v[36:39], v[208:211], a[196:199]
v_cvt_pk_bf16_f32 v20, v128, v129
v_cvt_pk_bf16_f32 v21, v130, v131
v_mfma_f32_16x16x32_bf16 a[200:203], v[68:71], v[208:211], a[200:203]
v_accvgpr_read_b32 v136, a164
v_accvgpr_read_b32 v137, a165
v_mfma_f32_16x16x32_bf16 a[204:207], v[100:103], v[208:211], a[204:207]
ds_read_b64_tr_b16 v[208:209], v14 offset:28672
s_waitcnt lgkmcnt(5)
v_mfma_f32_16x16x32_bf16 a[192:195], v[8:11], v[212:215], a[192:195]
ds_read_b64_tr_b16 v[210:211], v14 offset:30720
v_accvgpr_read_b32 v138, a166
v_mfma_f32_16x16x32_bf16 a[196:199], v[40:43], v[212:215], a[196:199]
v_accvgpr_read_b32 v139, a167
v_cvt_pk_bf16_f32 v52, v136, v137
v_mfma_f32_16x16x32_bf16 a[200:203], v[72:75], v[212:215], a[200:203]
v_cvt_pk_bf16_f32 v53, v138, v139
v_accvgpr_read_b32 v144, a168
v_mfma_f32_16x16x32_bf16 a[204:207], v[104:107], v[212:215], a[204:207]
ds_read_b64_tr_b16 v[212:213], v250 offset:28672
s_waitcnt lgkmcnt(5)
v_mfma_f32_16x16x32_bf16 a[192:195], v[176:179], v[216:219], a[192:195]
ds_read_b64_tr_b16 v[214:215], v250 offset:30720
v_accvgpr_read_b32 v145, a169
v_mfma_f32_16x16x32_bf16 a[196:199], v[180:183], v[216:219], a[196:199]
v_accvgpr_read_b32 v146, a170
v_accvgpr_read_b32 v147, a171
v_mfma_f32_16x16x32_bf16 a[200:203], v[184:187], v[216:219], a[200:203]
v_cvt_pk_bf16_f32 v84, v144, v145
v_cvt_pk_bf16_f32 v85, v146, v147
v_mfma_f32_16x16x32_bf16 a[204:207], v[188:191], v[216:219], a[204:207]
ds_read_b64_tr_b16 v[216:217], v13 offset:12288
s_waitcnt lgkmcnt(5)
v_mfma_f32_16x16x32_bf16 a[192:195], v[160:163], v[220:223], a[192:195]
ds_read_b64_tr_b16 v[218:219], v13 offset:14336
v_accvgpr_read_b32 v152, a172
v_mfma_f32_16x16x32_bf16 a[196:199], v[164:167], v[220:223], a[196:199]
v_accvgpr_read_b32 v153, a173
v_accvgpr_read_b32 v154, a174
v_mfma_f32_16x16x32_bf16 a[200:203], v[168:171], v[220:223], a[200:203]
v_accvgpr_read_b32 v155, a175
v_cvt_pk_bf16_f32 v116, v152, v153
v_mfma_f32_16x16x32_bf16 a[204:207], v[172:175], v[220:223], a[204:207]
ds_read_b64_tr_b16 v[220:221], v13 offset:28672
s_waitcnt lgkmcnt(5)
v_mfma_f32_16x16x32_bf16 a[192:195], v[0:3], v[208:211], a[192:195]
ds_read_b64_tr_b16 v[222:223], v13 offset:30720
v_cvt_pk_bf16_f32 v117, v154, v155
v_mfma_f32_16x16x32_bf16 a[196:199], v[32:35], v[208:211], a[196:199]
v_accvgpr_read_b32 v132, a176
v_accvgpr_read_b32 v133, a177
v_mfma_f32_16x16x32_bf16 a[200:203], v[64:67], v[208:211], a[200:203]
v_accvgpr_read_b32 v134, a178
v_accvgpr_read_b32 v135, a179
v_mfma_f32_16x16x32_bf16 a[204:207], v[96:99], v[208:211], a[204:207]
ds_read_b64_tr_b16 v[208:209], v15 offset:12288
s_waitcnt lgkmcnt(5)
v_mfma_f32_16x16x32_bf16 a[208:211], v[4:7], v[212:215], a[208:211]
ds_read_b64_tr_b16 v[210:211], v15 offset:14336
v_cvt_pk_bf16_f32 v22, v132, v133
v_mfma_f32_16x16x32_bf16 a[212:215], v[36:39], v[212:215], a[212:215]
v_cvt_pk_bf16_f32 v23, v134, v135
buffer_store_dwordx4 v[20:23], v248, s[20:23], s44 offen offset:1024 sc1
v_mfma_f32_16x16x32_bf16 a[216:219], v[68:71], v[212:215], a[216:219]
ds_write_b128 v253, v[20:23] offset:5120
v_accvgpr_read_b32 v140, a180
v_mfma_f32_16x16x32_bf16 a[220:223], v[100:103], v[212:215], a[220:223]
ds_read_b64_tr_b16 v[212:213], v15 offset:28672
s_waitcnt lgkmcnt(5)
v_mfma_f32_16x16x32_bf16 a[208:211], v[8:11], v[216:219], a[208:211]
ds_read_b64_tr_b16 v[214:215], v15 offset:30720
v_accvgpr_read_b32 v141, a181
v_mfma_f32_16x16x32_bf16 a[212:215], v[40:43], v[216:219], a[212:215]
v_accvgpr_read_b32 v142, a182
v_accvgpr_read_b32 v143, a183
v_mfma_f32_16x16x32_bf16 a[216:219], v[72:75], v[216:219], a[216:219]
v_cvt_pk_bf16_f32 v54, v140, v141
v_cvt_pk_bf16_f32 v55, v142, v143
v_mfma_f32_16x16x32_bf16 a[220:223], v[104:107], v[216:219], a[220:223]
ds_read_b64_tr_b16 v[216:217], v249 offset:29184
s_waitcnt lgkmcnt(5)
v_mfma_f32_16x16x32_bf16 a[208:211], v[176:179], v[220:223], a[208:211]
ds_read_b64_tr_b16 v[218:219], v249 offset:31232
buffer_store_dwordx4 v[52:55], v248, s[20:23], s45 offen offset:1024 sc1
v_mfma_f32_16x16x32_bf16 a[212:215], v[180:183], v[220:223], a[212:215]
v_accvgpr_read_b32 v148, a184
v_accvgpr_read_b32 v149, a185
v_mfma_f32_16x16x32_bf16 a[216:219], v[184:187], v[220:223], a[216:219]
v_accvgpr_read_b32 v150, a186
v_accvgpr_read_b32 v151, a187
v_mfma_f32_16x16x32_bf16 a[220:223], v[188:191], v[220:223], a[220:223]
ds_read_b64_tr_b16 v[220:221], v12 offset:12800
s_waitcnt lgkmcnt(5)
v_mfma_f32_16x16x32_bf16 a[208:211], v[160:163], v[208:211], a[208:211]
ds_read_b64_tr_b16 v[222:223], v12 offset:14848
v_cvt_pk_bf16_f32 v86, v148, v149
v_mfma_f32_16x16x32_bf16 a[212:215], v[164:167], v[208:211], a[212:215]
v_cvt_pk_bf16_f32 v87, v150, v151
buffer_store_dwordx4 v[84:87], v248, s[20:23], s46 offen offset:1024 sc1
v_mfma_f32_16x16x32_bf16 a[216:219], v[168:171], v[208:211], a[216:219]
v_accvgpr_read_b32 v156, a188
v_accvgpr_read_b32 v157, a189
v_mfma_f32_16x16x32_bf16 a[220:223], v[172:175], v[208:211], a[220:223]
ds_read_b64_tr_b16 v[208:209], v12 offset:29184
s_waitcnt lgkmcnt(5)
v_mfma_f32_16x16x32_bf16 a[208:211], v[0:3], v[212:215], a[208:211]
ds_read_b64_tr_b16 v[210:211], v12 offset:31232
v_accvgpr_read_b32 v158, a190
v_mfma_f32_16x16x32_bf16 a[212:215], v[32:35], v[212:215], a[212:215]
v_accvgpr_read_b32 v159, a191
v_cvt_pk_bf16_f32 v118, v156, v157
v_mfma_f32_16x16x32_bf16 a[216:219], v[64:67], v[212:215], a[216:219]
v_cvt_pk_bf16_f32 v119, v158, v159
buffer_store_dwordx4 v[116:119], v248, s[20:23], s47 offen offset:1024 sc1
v_mfma_f32_16x16x32_bf16 a[220:223], v[96:99], v[212:215], a[220:223]
ds_read_b64_tr_b16 v[212:213], v14 offset:12800
s_waitcnt lgkmcnt(5)
v_mfma_f32_16x16x32_bf16 a[224:227], v[4:7], v[216:219], a[224:227]
ds_read_b64_tr_b16 v[214:215], v14 offset:14848
v_accvgpr_read_b32 v128, a192
v_mfma_f32_16x16x32_bf16 a[228:231], v[36:39], v[216:219], a[228:231]
v_accvgpr_read_b32 v129, a193
v_accvgpr_read_b32 v130, a194
v_mfma_f32_16x16x32_bf16 a[232:235], v[68:71], v[216:219], a[232:235]
v_accvgpr_read_b32 v131, a195
v_cvt_pk_bf16_f32 v24, v128, v129
v_mfma_f32_16x16x32_bf16 a[236:239], v[100:103], v[216:219], a[236:239]
ds_read_b64_tr_b16 v[216:217], v14 offset:29184
s_waitcnt lgkmcnt(5)
v_mfma_f32_16x16x32_bf16 a[224:227], v[8:11], v[220:223], a[224:227]
ds_read_b64_tr_b16 v[218:219], v14 offset:31232
v_cvt_pk_bf16_f32 v25, v130, v131
v_mfma_f32_16x16x32_bf16 a[228:231], v[40:43], v[220:223], a[228:231]
v_accvgpr_read_b32 v136, a196
v_accvgpr_read_b32 v137, a197
v_mfma_f32_16x16x32_bf16 a[232:235], v[72:75], v[220:223], a[232:235]
v_accvgpr_read_b32 v138, a198
v_accvgpr_read_b32 v139, a199
v_mfma_f32_16x16x32_bf16 a[236:239], v[104:107], v[220:223], a[236:239]
ds_read_b64_tr_b16 v[220:221], v250 offset:29184
s_waitcnt lgkmcnt(5)
v_mfma_f32_16x16x32_bf16 a[224:227], v[176:179], v[208:211], a[224:227]
ds_read_b64_tr_b16 v[222:223], v250 offset:31232
v_cvt_pk_bf16_f32 v56, v136, v137
v_mfma_f32_16x16x32_bf16 a[228:231], v[180:183], v[208:211], a[228:231]
v_cvt_pk_bf16_f32 v57, v138, v139
v_accvgpr_read_b32 v144, a200
v_mfma_f32_16x16x32_bf16 a[232:235], v[184:187], v[208:211], a[232:235]
v_accvgpr_read_b32 v145, a201
v_accvgpr_read_b32 v146, a202
v_mfma_f32_16x16x32_bf16 a[236:239], v[188:191], v[208:211], a[236:239]
ds_read_b64_tr_b16 v[208:209], v13 offset:12800
s_waitcnt lgkmcnt(5)
v_mfma_f32_16x16x32_bf16 a[224:227], v[160:163], v[212:215], a[224:227]
ds_read_b64_tr_b16 v[210:211], v13 offset:14848
v_accvgpr_read_b32 v147, a203
v_mfma_f32_16x16x32_bf16 a[228:231], v[164:167], v[212:215], a[228:231]
v_cvt_pk_bf16_f32 v88, v144, v145
v_cvt_pk_bf16_f32 v89, v146, v147
v_mfma_f32_16x16x32_bf16 a[232:235], v[168:171], v[212:215], a[232:235]
v_accvgpr_read_b32 v152, a204
v_accvgpr_read_b32 v153, a205
v_mfma_f32_16x16x32_bf16 a[236:239], v[172:175], v[212:215], a[236:239]
ds_read_b64_tr_b16 v[212:213], v13 offset:29184
s_waitcnt lgkmcnt(5)
v_mfma_f32_16x16x32_bf16 a[224:227], v[0:3], v[216:219], a[224:227]
ds_read_b64_tr_b16 v[214:215], v13 offset:31232
v_accvgpr_read_b32 v154, a206
v_mfma_f32_16x16x32_bf16 a[228:231], v[32:35], v[216:219], a[228:231]
v_accvgpr_read_b32 v155, a207
v_cvt_pk_bf16_f32 v120, v152, v153
v_mfma_f32_16x16x32_bf16 a[232:235], v[64:67], v[216:219], a[232:235]
v_cvt_pk_bf16_f32 v121, v154, v155
v_accvgpr_read_b32 v132, a208
v_mfma_f32_16x16x32_bf16 a[236:239], v[96:99], v[216:219], a[236:239]
ds_read_b64_tr_b16 v[216:217], v15 offset:12800
s_waitcnt lgkmcnt(5)
v_mfma_f32_16x16x32_bf16 a[240:243], v[4:7], v[220:223], a[240:243]
ds_read_b64_tr_b16 v[218:219], v15 offset:14848
v_accvgpr_read_b32 v133, a209
v_mfma_f32_16x16x32_bf16 a[244:247], v[36:39], v[220:223], a[244:247]
v_accvgpr_read_b32 v134, a210
v_accvgpr_read_b32 v135, a211
v_mfma_f32_16x16x32_bf16 a[248:251], v[68:71], v[220:223], a[248:251]
v_cvt_pk_bf16_f32 v26, v132, v133
v_cvt_pk_bf16_f32 v27, v134, v135
v_mfma_f32_16x16x32_bf16 a[252:255], v[100:103], v[220:223], a[252:255]
ds_read_b64_tr_b16 v[220:221], v15 offset:29184
s_waitcnt lgkmcnt(5)
v_mfma_f32_16x16x32_bf16 a[240:243], v[8:11], v[208:211], a[240:243]
ds_read_b64_tr_b16 v[222:223], v15 offset:31232
buffer_store_dwordx4 v[24:27], v248, s[20:23], s44 offen offset:2048 sc1
v_mfma_f32_16x16x32_bf16 a[244:247], v[40:43], v[208:211], a[244:247]
ds_write_b128 v253, v[24:27] offset:6144
v_accvgpr_read_b32 v140, a212
v_mfma_f32_16x16x32_bf16 a[248:251], v[72:75], v[208:211], a[248:251]
v_accvgpr_read_b32 v141, a213
v_accvgpr_read_b32 v142, a214
v_mfma_f32_16x16x32_bf16 a[252:255], v[104:107], v[208:211], a[252:255]
s_waitcnt lgkmcnt(4)
v_accvgpr_read_b32 v143, a215
v_mfma_f32_16x16x32_bf16 a[240:243], v[176:179], v[212:215], a[240:243]
v_cvt_pk_bf16_f32 v58, v140, v141
v_cvt_pk_bf16_f32 v59, v142, v143
v_mfma_f32_16x16x32_bf16 a[244:247], v[180:183], v[212:215], a[244:247]
buffer_store_dwordx4 v[56:59], v248, s[20:23], s45 offen offset:2048 sc1
v_accvgpr_read_b32 v148, a216
v_mfma_f32_16x16x32_bf16 a[248:251], v[184:187], v[212:215], a[248:251]
v_accvgpr_read_b32 v149, a217
v_accvgpr_read_b32 v150, a218
v_mfma_f32_16x16x32_bf16 a[252:255], v[188:191], v[212:215], a[252:255]
s_waitcnt lgkmcnt(2)
v_accvgpr_read_b32 v151, a219
v_mfma_f32_16x16x32_bf16 a[240:243], v[160:163], v[216:219], a[240:243]
v_cvt_pk_bf16_f32 v90, v148, v149
v_cvt_pk_bf16_f32 v91, v150, v151
v_mfma_f32_16x16x32_bf16 a[244:247], v[164:167], v[216:219], a[244:247]
buffer_store_dwordx4 v[88:91], v248, s[20:23], s46 offen offset:2048 sc1
v_accvgpr_read_b32 v156, a220
v_mfma_f32_16x16x32_bf16 a[248:251], v[168:171], v[216:219], a[248:251]
v_accvgpr_read_b32 v157, a221
v_accvgpr_read_b32 v158, a222
v_mfma_f32_16x16x32_bf16 a[252:255], v[172:175], v[216:219], a[252:255]
s_waitcnt lgkmcnt(0)
v_accvgpr_read_b32 v159, a223
v_mfma_f32_16x16x32_bf16 a[240:243], v[0:3], v[220:223], a[240:243]
v_cvt_pk_bf16_f32 v122, v156, v157
v_cvt_pk_bf16_f32 v123, v158, v159
v_mfma_f32_16x16x32_bf16 a[244:247], v[32:35], v[220:223], a[244:247]
buffer_store_dwordx4 v[120:123], v248, s[20:23], s47 offen offset:2048 sc1
v_accvgpr_read_b32 v128, a224
v_mfma_f32_16x16x32_bf16 a[248:251], v[64:67], v[220:223], a[248:251]
v_accvgpr_read_b32 v129, a225
v_accvgpr_read_b32 v130, a226
v_mfma_f32_16x16x32_bf16 a[252:255], v[96:99], v[220:223], a[252:255]
v_accvgpr_read_b32 v131, a227
v_cvt_pk_bf16_f32 v28, v128, v129
v_cvt_pk_bf16_f32 v29, v130, v131
v_accvgpr_read_b32 v136, a228
v_accvgpr_read_b32 v137, a229
v_accvgpr_read_b32 v138, a230
v_accvgpr_read_b32 v139, a231
v_cvt_pk_bf16_f32 v60, v136, v137
v_cvt_pk_bf16_f32 v61, v138, v139
v_accvgpr_read_b32 v144, a232
v_accvgpr_read_b32 v145, a233
v_accvgpr_read_b32 v146, a234
v_accvgpr_read_b32 v147, a235
v_cvt_pk_bf16_f32 v92, v144, v145
v_cvt_pk_bf16_f32 v93, v146, v147
v_accvgpr_read_b32 v152, a236
v_accvgpr_read_b32 v153, a237
v_accvgpr_read_b32 v154, a238
v_accvgpr_read_b32 v155, a239
v_cvt_pk_bf16_f32 v124, v152, v153
v_cvt_pk_bf16_f32 v125, v154, v155
v_accvgpr_read_b32 v132, a240
v_accvgpr_read_b32 v133, a241
v_accvgpr_read_b32 v134, a242
v_accvgpr_read_b32 v135, a243
v_cvt_pk_bf16_f32 v30, v132, v133
v_cvt_pk_bf16_f32 v31, v134, v135
buffer_store_dwordx4 v[28:31], v248, s[20:23], s44 offen offset:3072 sc1
ds_write_b128 v253, v[28:31] offset:7168
v_accvgpr_read_b32 v140, a244
v_accvgpr_read_b32 v141, a245
v_accvgpr_read_b32 v142, a246
v_accvgpr_read_b32 v143, a247
v_cvt_pk_bf16_f32 v62, v140, v141
v_cvt_pk_bf16_f32 v63, v142, v143
buffer_store_dwordx4 v[60:63], v248, s[20:23], s45 offen offset:3072 sc1
v_accvgpr_read_b32 v148, a248
v_accvgpr_read_b32 v149, a249
v_accvgpr_read_b32 v150, a250
v_accvgpr_read_b32 v151, a251
v_cvt_pk_bf16_f32 v94, v148, v149
v_cvt_pk_bf16_f32 v95, v150, v151
buffer_store_dwordx4 v[92:95], v248, s[20:23], s46 offen offset:3072 sc1
v_accvgpr_read_b32 v156, a252
v_accvgpr_read_b32 v157, a253
v_accvgpr_read_b32 v158, a254
v_accvgpr_read_b32 v159, a255
v_cvt_pk_bf16_f32 v126, v156, v157
v_cvt_pk_bf16_f32 v127, v158, v159
buffer_store_dwordx4 v[124:127], v248, s[20:23], s47 offen offset:3072 sc1
s_waitcnt vmcnt(36)
s_branch L2_F
L2_F:
s_lshl_b32 s3, s34, 15
s_add_u32 s3, s3, 0x1000000
v_add_u32 v240, s3, v248
v_add_u32 v241, 0x4000, v240
s_mov_b32 s32, 0x0
s_mov_b32 s33, 0x1000
s_mov_b32 s35, 0x2000
s_mov_b32 s36, 0x3000
s_mov_b32 s38, 0x20000
s_mov_b32 s39, 0x21000
s_mov_b32 s40, 0x22000
s_mov_b32 s41, 0x23000
s_lshr_b32 s42, s6, 13
s_lshr_b32 s43, s7, 13
s_lshr_b32 s44, s29, 13
v_mov_b32 v242, s42
v_mov_b32 v232, s43
v_cmp_lt_u32 vcc, 0xff, v248
v_mov_b32 v233, s44
s_nop 0
v_cndmask_b32 v242, v242, v232, vcc
v_cmp_lt_u32 vcc, 0x1ff, v248
v_and_b32 v235, 0xf0, v248
s_nop 0
v_cndmask_b32 v242, v242, v233, vcc
v_lshlrev_b32 v242, 11, v242
v_lshl_add_u32 v242, v235, 3, v242
v_lshrrev_b32 v79, 6, v242
buffer_load_ushort v79, v79, s[52:55], 0 offen
buffer_load_dwordx4 a[0:3], v240, s[16:19], s32 offen offset:0
buffer_load_dwordx4 a[4:7], v240, s[16:19], s32 offen offset:1024
buffer_load_dwordx4 a[8:11], v241, s[16:19], s32 offen offset:0
buffer_load_dwordx4 a[12:15], v241, s[16:19], s32 offen offset:1024
buffer_load_dwordx4 a[16:19], v240, s[16:19], s32 offen offset:2048
buffer_load_dwordx4 a[20:23], v240, s[16:19], s32 offen offset:3072
buffer_load_dwordx4 a[24:27], v241, s[16:19], s32 offen offset:2048
buffer_load_dwordx4 a[28:31], v241, s[16:19], s32 offen offset:3072
buffer_load_dwordx4 a[32:35], v240, s[16:19], s33 offen offset:0
buffer_load_dwordx4 a[36:39], v240, s[16:19], s33 offen offset:1024
buffer_load_dwordx4 a[40:43], v241, s[16:19], s33 offen offset:0
buffer_load_dwordx4 a[44:47], v241, s[16:19], s33 offen offset:1024
s_lshl_b32 s3, s37, 3
v_add3_u32 v242, v242, s3, 8
s_cmp_ge_u32 s29, 0x70000000
s_cselect_b32 s44, s43, s44
v_mov_b32 v46, s42
v_mov_b32 v232, s43
v_cmp_lt_u32 vcc, 0x7f, v248
v_mov_b32 v233, s44
s_nop 0
v_cndmask_b32 v46, v46, v232, vcc
v_cmp_lt_u32 vcc, 0xff, v248
v_bfe_u32 v232, v248, 4, 3
s_nop 0
v_cndmask_b32 v46, v46, v233, vcc
v_min_u32 v232, 5, v232
v_lshrrev_b32 v46, 2, v46
v_lshl_add_u32 v46, v46, 3, v232
v_lshlrev_b32 v46, 7, v46
v_add_u32 v46, 0x7c00000, v46
s_lshl_b32 s49, s34, 11
s_add_u32 s49, s49, 0x20000
s_bfe_u32 s3, s6, 0x2000f
s_lshl_b32 s3, s3, 13
s_add_u32 s3, s3, s49
v_add_u32 v76, s3, v248
s_bfe_u32 s3, s7, 0x2000f
s_lshl_b32 s3, s3, 13
s_add_u32 s3, s3, s49
v_add_u32 v77, s3, v248
s_bfe_u32 s3, s29, 0x2000f
s_lshl_b32 s3, s3, 13
s_add_u32 s3, s3, s49
v_add_u32 v78, s3, v248
s_add_u32 s3, s37, 1
s_sub_u32 s49, s3, 6
s_cselect_b32 s3, s3, s49
s_mul_i32 s3, s3, 0x600000
s_add_u32 s42, s3, 0x2000000
s_add_u32 s3, s37, 2
s_sub_u32 s49, s3, 6
s_cselect_b32 s3, s3, s49
s_mul_i32 s3, s3, 0x600000
s_add_u32 s43, s3, 0x2000000
s_add_u32 s3, s37, 3
s_sub_u32 s49, s3, 6
s_cselect_b32 s3, s3, s49
s_mul_i32 s3, s3, 0x600000
s_add_u32 s44, s3, 0x2000000
s_add_u32 s3, s37, 4
s_sub_u32 s49, s3, 6
s_cselect_b32 s3, s3, s49
s_mul_i32 s3, s3, 0x600000
s_add_u32 s45, s3, 0x2000000
s_add_u32 s3, s37, 5
s_sub_u32 s49, s3, 6
s_cselect_b32 s3, s3, s49
s_mul_i32 s3, s3, 0x600000
s_add_u32 s46, s3, 0x2000000
s_add_u32 s3, s37, 6
s_sub_u32 s49, s3, 6
s_cselect_b32 s3, s3, s49
s_mul_i32 s3, s3, 0x600000
s_add_u32 s47, s3, 0x2000000
s_mul_i32 s3, s34, 1920
v_add_u32 v47, s3, v248
v_lshrrev_b32 v44, 4, v248
v_and_b32 v44, 0x30, v44
v_xor_b32 v44, v44, v248
v_and_b32 v232, 0x380, v248
v_mad_u32_u24 v44, v232, 3, v44
v_xor_b32 v45, 0x1040, v44
v_bfe_u32 v232, v248, 5, 3
v_lshrrev_b32 v234, 8, v248
v_xor_b32 v232, v232, v234
v_bfe_u32 v233, v248, 4, 3
v_lshlrev_b32 v233, 7, v233
v_lshl_or_b32 v232, v232, 4, v233
v_bfe_u32 v233, v248, 7, 1
s_lshl_b32 s49, s34, 10
s_sub_u32 s3, s28, s49
v_lshl_add_u32 v74, v233, 12, v232
v_add_u32 v72, s3, v74
s_sub_u32 s3, s30, s49
v_add_u32 v74, s3, v74
v_xor_b32 v73, 64, v72
v_xor_b32 v75, 64, v74
v_lshl_add_u32 v245, v233, 10, v232
v_add_u32 v245, s31, v245
v_xor_b32 v246, 64, v245
v_add_u32 v247, s31, v248
s_add_u32 s3, s3, 0xa000
s_and_b32 s3, s3, 0x1ffff
v_add_u32 v252, s3, v248
s_lshl_b32 s49, s34, 11
v_add_u32 v251, s49, v252
s_add_u32 s3, s3, s49
s_add_u32 s3, s3, 24576
v_lshl_add_u32 v249, v248, 1, s3
v_lshl_add_u32 v250, v235, 1, s3
v_lshrrev_b32 v232, 4, v235
v_lshlrev_b32 v234, 2, v234
v_sub_u32 v232, v232, v234
v_and_b32 v233, 1, v232
v_lshlrev_b32 v233, 4, v233
v_mov_b32 v234, 0xffff
v_lshlrev_b32 v233, v233, v234
v_lshrrev_b32 v232, 1, v232
v_cmp_eq_u32 vcc, 0, v232
s_nop 1
v_cndmask_b32 v156, 0, v233, vcc
v_cmp_eq_u32 vcc, 1, v232
s_nop 1
v_cndmask_b32 v157, 0, v233, vcc
s_mov_b32 s100, 0x10000
s_mov_b32 s101, 0xffff0000
s_waitcnt lgkmcnt(0)
s_barrier
ds_read_b128 v[208:211], v72 offset:0
ds_read_b128 v[212:215], v72 offset:8192
ds_read_b128 v[216:219], v74 offset:0
ds_read_b128 v[220:223], v73 offset:0
ds_read_b128 v[224:227], v73 offset:8192
ds_read_b128 v[104:107], v245 offset:0
ds_read_b128 v[108:111], v246 offset:0
ds_read_b128 v[152:155], v245 offset:2048
s_waitcnt vmcnt(13)
v_mov_b32 v43, 1
s_mov_b64 exec, 1
buffer_store_dword v43, off, s[16:19], s51 sc1
s_mov_b64 exec, -1
s_waitcnt vmcnt(13)
v_lshlrev_b32 v79, 16, v79
ds_write_b32 v249, v79 offset:28
ds_read_b32 v253, v250 offset:28
ds_read_b32 v254, v250 offset:540
ds_read_b32 v255, v250 offset:1052
s_waitcnt vmcnt(12)
buffer_load_dwordx4 a[48:51], v240, s[16:19], s33 offen offset:2048
s_waitcnt vmcnt(12)
buffer_load_dwordx4 a[52:55], v240, s[16:19], s33 offen offset:3072
s_waitcnt vmcnt(12)
buffer_load_dwordx4 a[56:59], v241, s[16:19], s33 offen offset:2048
s_waitcnt vmcnt(12)
s_waitcnt lgkmcnt(11)
v_mfma_f32_16x16x32_bf16 v[160:163], a[0:3], v[208:211], 0
ds_read_b128 v[228:231], v75 offset:0
buffer_load_dwordx4 a[60:63], v241, s[16:19], s33 offen offset:3072
v_mfma_f32_16x16x32_bf16 v[164:167], a[4:7], v[208:211], 0
v_mfma_f32_16x16x32_bf16 v[168:171], a[8:11], v[208:211], 0
v_mfma_f32_16x16x32_bf16 v[172:175], a[12:15], v[208:211], 0
s_waitcnt vmcnt(12)
s_waitcnt lgkmcnt(11)
v_mfma_f32_16x16x32_bf16 v[176:179], a[0:3], v[212:215], 0
ds_read_b128 v[208:211], v72 offset:1024
buffer_load_dwordx4 a[64:67], v240, s[16:19], s35 offen offset:0
v_mfma_f32_16x16x32_bf16 v[180:183], a[4:7], v[212:215], 0
v_mfma_f32_16x16x32_bf16 v[184:187], a[8:11], v[212:215], 0
v_mfma_f32_16x16x32_bf16 v[188:191], a[12:15], v[212:215], 0
s_waitcnt vmcnt(12)
s_waitcnt lgkmcnt(11)
v_mfma_f32_16x16x32_bf16 v[192:195], a[0:3], v[216:219], 0
ds_read_b128 v[212:215], v72 offset:9216
buffer_load_dwordx4 a[68:71], v240, s[16:19], s35 offen offset:1024
v_mfma_f32_16x16x32_bf16 v[196:199], a[4:7], v[216:219], 0
v_mfma_f32_16x16x32_bf16 v[200:203], a[8:11], v[216:219], 0
v_mfma_f32_16x16x32_bf16 v[204:207], a[12:15], v[216:219], 0
s_waitcnt vmcnt(12)
buffer_load_dwordx4 a[72:75], v241, s[16:19], s35 offen offset:0
s_waitcnt vmcnt(12)
s_waitcnt lgkmcnt(11)
v_mfma_f32_16x16x32_bf16 v[160:163], a[16:19], v[220:223], v[160:163]
ds_read_b128 v[216:219], v74 offset:1024
buffer_load_dwordx4 a[76:79], v241, s[16:19], s35 offen offset:1024
v_mfma_f32_16x16x32_bf16 v[164:167], a[20:23], v[220:223], v[164:167]
v_mfma_f32_16x16x32_bf16 v[168:171], a[24:27], v[220:223], v[168:171]
v_mfma_f32_16x16x32_bf16 v[172:175], a[28:31], v[220:223], v[172:175]
s_waitcnt vmcnt(12)
s_waitcnt lgkmcnt(11)
v_mfma_f32_16x16x32_bf16 v[176:179], a[16:19], v[224:227], v[176:179]
ds_read_b128 v[220:223], v73 offset:1024
buffer_load_dwordx4 a[80:83], v240, s[16:19], s35 offen offset:2048
v_mfma_f32_16x16x32_bf16 v[180:183], a[20:23], v[224:227], v[180:183]
v_mfma_f32_16x16x32_bf16 v[184:187], a[24:27], v[224:227], v[184:187]
v_mfma_f32_16x16x32_bf16 v[188:191], a[28:31], v[224:227], v[188:191]
s_waitcnt vmcnt(12)
s_waitcnt lgkmcnt(4)
v_mfma_f32_16x16x32_bf16 v[192:195], a[16:19], v[228:231], v[192:195]
ds_read_b128 v[224:227], v73 offset:9216
buffer_load_dwordx4 a[84:87], v240, s[16:19], s35 offen offset:3072
v_mfma_f32_16x16x32_bf16 v[196:199], a[20:23], v[228:231], v[196:199]
v_mfma_f32_16x16x32_bf16 v[200:203], a[24:27], v[228:231], v[200:203]
v_mfma_f32_16x16x32_bf16 v[204:207], a[28:31], v[228:231], v[204:207]
s_waitcnt vmcnt(12)
buffer_load_dwordx4 a[88:91], v241, s[16:19], s35 offen offset:2048
s_waitcnt vmcnt(12)
s_waitcnt lgkmcnt(4)
v_mfma_f32_16x16x32_bf16 v[160:163], a[32:35], v[208:211], v[160:163]
ds_read_b128 v[228:231], v75 offset:1024
buffer_load_dwordx4 a[92:95], v241, s[16:19], s35 offen offset:3072
v_mfma_f32_16x16x32_bf16 v[164:167], a[36:39], v[208:211], v[164:167]
v_mfma_f32_16x16x32_bf16 v[168:171], a[40:43], v[208:211], v[168:171]
v_mfma_f32_16x16x32_bf16 v[172:175], a[44:47], v[208:211], v[172:175]
s_waitcnt lgkmcnt(4)
v_mfma_f32_16x16x32_bf16 v[176:179], a[32:35], v[212:215], v[176:179]
ds_read_b128 v[208:211], v72 offset:2048
v_mfma_f32_16x16x32_bf16 v[180:183], a[36:39], v[212:215], v[180:183]
v_mfma_f32_16x16x32_bf16 v[184:187], a[40:43], v[212:215], v[184:187]
v_mfma_f32_16x16x32_bf16 v[188:191], a[44:47], v[212:215], v[188:191]
s_waitcnt vmcnt(11)
s_waitcnt lgkmcnt(4)
v_mfma_f32_16x16x32_bf16 v[192:195], a[32:35], v[216:219], v[192:195]
ds_read_b128 v[212:215], v72 offset:10240
buffer_load_dwordx4 a[96:99], v240, s[16:19], s36 offen offset:0
v_mfma_f32_16x16x32_bf16 v[196:199], a[36:39], v[216:219], v[196:199]
v_mfma_f32_16x16x32_bf16 v[200:203], a[40:43], v[216:219], v[200:203]
v_mfma_f32_16x16x32_bf16 v[204:207], a[44:47], v[216:219], v[204:207]
s_waitcnt vmcnt(11)
buffer_load_dwordx4 a[100:103], v240, s[16:19], s36 offen offset:1024
s_waitcnt vmcnt(11)
buffer_load_dwordx4 a[104:107], v241, s[16:19], s36 offen offset:0
s_waitcnt vmcnt(11)
s_waitcnt lgkmcnt(4)
v_mfma_f32_16x16x32_bf16 v[160:163], a[48:51], v[220:223], v[160:163]
ds_read_b128 v[216:219], v74 offset:2048
buffer_load_dwordx4 a[108:111], v241, s[16:19], s36 offen offset:1024
v_mfma_f32_16x16x32_bf16 v[164:167], a[52:55], v[220:223], v[164:167]
v_mfma_f32_16x16x32_bf16 v[168:171], a[56:59], v[220:223], v[168:171]
v_mfma_f32_16x16x32_bf16 v[172:175], a[60:63], v[220:223], v[172:175]
s_waitcnt vmcnt(11)
s_waitcnt lgkmcnt(4)
v_mfma_f32_16x16x32_bf16 v[176:179], a[48:51], v[224:227], v[176:179]
ds_read_b128 v[220:223], v73 offset:2048
buffer_load_dwordx4 a[112:115], v240, s[16:19], s36 offen offset:2048
v_mfma_f32_16x16x32_bf16 v[180:183], a[52:55], v[224:227], v[180:183]
v_mfma_f32_16x16x32_bf16 v[184:187], a[56:59], v[224:227], v[184:187]
v_mfma_f32_16x16x32_bf16 v[188:191], a[60:63], v[224:227], v[188:191]
s_waitcnt vmcnt(11)
s_waitcnt lgkmcnt(4)
v_mfma_f32_16x16x32_bf16 v[192:195], a[48:51], v[228:231], v[192:195]
ds_read_b128 v[224:227], v73 offset:10240
buffer_load_dwordx4 a[116:119], v240, s[16:19], s36 offen offset:3072
v_mfma_f32_16x16x32_bf16 v[196:199], a[52:55], v[228:231], v[196:199]
v_mfma_f32_16x16x32_bf16 v[200:203], a[56:59], v[228:231], v[200:203]
v_mfma_f32_16x16x32_bf16 v[204:207], a[60:63], v[228:231], v[204:207]
s_waitcnt vmcnt(11)
buffer_load_dwordx4 a[120:123], v241, s[16:19], s36 offen offset:2048
s_waitcnt vmcnt(11)
s_waitcnt lgkmcnt(4)
v_mfma_f32_16x16x32_bf16 v[160:163], a[64:67], v[208:211], v[160:163]
ds_read_b128 v[228:231], v75 offset:2048
buffer_load_dwordx4 a[124:127], v241, s[16:19], s36 offen offset:3072
v_mfma_f32_16x16x32_bf16 v[164:167], a[68:71], v[208:211], v[164:167]
v_mfma_f32_16x16x32_bf16 v[168:171], a[72:75], v[208:211], v[168:171]
v_mfma_f32_16x16x32_bf16 v[172:175], a[76:79], v[208:211], v[172:175]
s_waitcnt vmcnt(11)
s_waitcnt lgkmcnt(4)
v_mfma_f32_16x16x32_bf16 v[176:179], a[64:67], v[212:215], v[176:179]
ds_read_b128 v[208:211], v72 offset:3072
buffer_load_dwordx4 a[128:131], v240, s[16:19], s38 offen offset:0
v_mfma_f32_16x16x32_bf16 v[180:183], a[68:71], v[212:215], v[180:183]
v_mfma_f32_16x16x32_bf16 v[184:187], a[72:75], v[212:215], v[184:187]
v_mfma_f32_16x16x32_bf16 v[188:191], a[76:79], v[212:215], v[188:191]
s_waitcnt vmcnt(11)
s_waitcnt lgkmcnt(4)
v_mfma_f32_16x16x32_bf16 v[192:195], a[64:67], v[216:219], v[192:195]
ds_read_b128 v[212:215], v72 offset:11264
buffer_load_dwordx4 a[132:135], v240, s[16:19], s38 offen offset:1024
v_mfma_f32_16x16x32_bf16 v[196:199], a[68:71], v[216:219], v[196:199]
v_mfma_f32_16x16x32_bf16 v[200:203], a[72:75], v[216:219], v[200:203]
v_mfma_f32_16x16x32_bf16 v[204:207], a[76:79], v[216:219], v[204:207]
s_waitcnt vmcnt(11)
buffer_load_dwordx4 a[136:139], v241, s[16:19], s38 offen offset:0
s_waitcnt vmcnt(11)
s_waitcnt lgkmcnt(4)
v_mfma_f32_16x16x32_bf16 v[160:163], a[80:83], v[220:223], v[160:163]
ds_read_b128 v[216:219], v74 offset:3072
buffer_load_dwordx4 a[140:143], v241, s[16:19], s38 offen offset:1024
v_mfma_f32_16x16x32_bf16 v[164:167], a[84:87], v[220:223], v[164:167]
v_mfma_f32_16x16x32_bf16 v[168:171], a[88:91], v[220:223], v[168:171]
v_mfma_f32_16x16x32_bf16 v[172:175], a[92:95], v[220:223], v[172:175]
s_waitcnt vmcnt(11)
s_waitcnt lgkmcnt(4)
v_mfma_f32_16x16x32_bf16 v[176:179], a[80:83], v[224:227], v[176:179]
ds_read_b128 v[220:223], v73 offset:3072
buffer_load_dwordx4 a[144:147], v240, s[16:19], s38 offen offset:2048
v_mfma_f32_16x16x32_bf16 v[180:183], a[84:87], v[224:227], v[180:183]
v_mfma_f32_16x16x32_bf16 v[184:187], a[88:91], v[224:227], v[184:187]
v_mfma_f32_16x16x32_bf16 v[188:191], a[92:95], v[224:227], v[188:191]
s_waitcnt vmcnt(11)
s_waitcnt lgkmcnt(4)
v_mfma_f32_16x16x32_bf16 v[192:195], a[80:83], v[228:231], v[192:195]
ds_read_b128 v[224:227], v73 offset:11264
buffer_load_dwordx4 a[148:151], v240, s[16:19], s38 offen offset:3072
v_mfma_f32_16x16x32_bf16 v[196:199], a[84:87], v[228:231], v[196:199]
v_mfma_f32_16x16x32_bf16 v[200:203], a[88:91], v[228:231], v[200:203]
v_mfma_f32_16x16x32_bf16 v[204:207], a[92:95], v[228:231], v[204:207]
s_waitcnt vmcnt(11)
buffer_load_dwordx4 a[152:155], v241, s[16:19], s38 offen offset:2048
s_waitcnt vmcnt(11)
s_waitcnt lgkmcnt(4)
v_mfma_f32_16x16x32_bf16 v[160:163], a[96:99], v[208:211], v[160:163]
ds_read_b128 v[228:231], v75 offset:3072
buffer_load_dwordx4 a[156:159], v241, s[16:19], s38 offen offset:3072
v_mfma_f32_16x16x32_bf16 v[164:167], a[100:103], v[208:211], v[164:167]
v_mfma_f32_16x16x32_bf16 v[168:171], a[104:107], v[208:211], v[168:171]
v_mfma_f32_16x16x32_bf16 v[172:175], a[108:111], v[208:211], v[172:175]
s_waitcnt vmcnt(11)
s_waitcnt lgkmcnt(4)
v_mfma_f32_16x16x32_bf16 v[176:179], a[96:99], v[212:215], v[176:179]
buffer_load_dwordx4 a[160:163], v240, s[16:19], s39 offen offset:0
v_mfma_f32_16x16x32_bf16 v[180:183], a[100:103], v[212:215], v[180:183]
v_mfma_f32_16x16x32_bf16 v[184:187], a[104:107], v[212:215], v[184:187]
v_mfma_f32_16x16x32_bf16 v[188:191], a[108:111], v[212:215], v[188:191]
s_waitcnt vmcnt(11)
s_waitcnt lgkmcnt(3)
v_mfma_f32_16x16x32_bf16 v[192:195], a[96:99], v[216:219], v[192:195]
buffer_load_dwordx4 a[164:167], v240, s[16:19], s39 offen offset:1024
v_mfma_f32_16x16x32_bf16 v[196:199], a[100:103], v[216:219], v[196:199]
v_mfma_f32_16x16x32_bf16 v[200:203], a[104:107], v[216:219], v[200:203]
v_mfma_f32_16x16x32_bf16 v[204:207], a[108:111], v[216:219], v[204:207]
s_waitcnt vmcnt(11)
buffer_load_dwordx4 a[168:171], v241, s[16:19], s39 offen offset:0
s_waitcnt vmcnt(11)
s_waitcnt lgkmcnt(2)
v_mfma_f32_16x16x32_bf16 v[160:163], a[112:115], v[220:223], v[160:163]
buffer_load_dwordx4 a[172:175], v241, s[16:19], s39 offen offset:1024
v_mfma_f32_16x16x32_bf16 v[164:167], a[116:119], v[220:223], v[164:167]
v_mfma_f32_16x16x32_bf16 v[168:171], a[120:123], v[220:223], v[168:171]
v_mfma_f32_16x16x32_bf16 v[172:175], a[124:127], v[220:223], v[172:175]
s_waitcnt vmcnt(11)
s_waitcnt lgkmcnt(1)
v_mfma_f32_16x16x32_bf16 v[176:179], a[112:115], v[224:227], v[176:179]
buffer_load_dword v43, v46, s[16:19], 0 offen sc1
v_mfma_f32_16x16x32_bf16 v[180:183], a[116:119], v[224:227], v[180:183]
v_lshlrev_b32 v234, 16, v104
v_and_b32 v235, s101, v104
v_mfma_f32_16x16x32_bf16 v[184:187], a[120:123], v[224:227], v[184:187]
v_fma_f32 v160, v160, v253, v234
v_fma_f32 v161, v161, v253, v235
v_mfma_f32_16x16x32_bf16 v[188:191], a[124:127], v[224:227], v[188:191]
v_lshlrev_b32 v236, 16, v105
v_and_b32 v237, s101, v105
s_waitcnt lgkmcnt(0)
v_mfma_f32_16x16x32_bf16 v[192:195], a[112:115], v[228:231], v[192:195]
v_fma_f32 v162, v162, v253, v236
v_fma_f32 v163, v163, v253, v237
v_mfma_f32_16x16x32_bf16 v[196:199], a[116:119], v[228:231], v[196:199]
v_lshlrev_b32 v238, 16, v106
v_and_b32 v239, s101, v106
v_mfma_f32_16x16x32_bf16 v[200:203], a[120:123], v[228:231], v[200:203]
v_fma_f32 v164, v164, v253, v238
v_fma_f32 v165, v165, v253, v239
v_mfma_f32_16x16x32_bf16 v[204:207], a[124:127], v[228:231], v[204:207]
v_lshlrev_b32 v232, 16, v107
v_and_b32 v233, s101, v107
v_fma_f32 v166, v166, v253, v232
v_fma_f32 v167, v167, v253, v233
ds_read_b128 v[104:107], v246 offset:2048
v_lshlrev_b32 v234, 16, v108
v_and_b32 v235, s101, v108
v_fma_f32 v168, v168, v253, v234
v_fma_f32 v169, v169, v253, v235
v_lshlrev_b32 v236, 16, v109
v_and_b32 v237, s101, v109
v_fma_f32 v170, v170, v253, v236
v_fma_f32 v171, v171, v253, v237
v_lshlrev_b32 v238, 16, v110
v_and_b32 v239, s101, v110
v_fma_f32 v172, v172, v253, v238
v_fma_f32 v173, v173, v253, v239
v_lshlrev_b32 v232, 16, v111
v_and_b32 v233, s101, v111
v_fma_f32 v174, v174, v253, v232
v_fma_f32 v175, v175, v253, v233
ds_read_b128 v[108:111], v245 offset:4096
s_waitcnt vmcnt(11)
buffer_load_dwordx4 a[176:179], v240, s[16:19], s39 offen offset:2048
v_lshlrev_b32 v234, 16, v152
v_and_b32 v235, s101, v152
v_fma_f32 v176, v176, v254, v234
v_fma_f32 v177, v177, v254, v235
v_lshlrev_b32 v236, 16, v153
v_and_b32 v237, s101, v153
v_fma_f32 v178, v178, v254, v236
v_fma_f32 v179, v179, v254, v237
v_lshlrev_b32 v238, 16, v154
v_and_b32 v239, s101, v154
v_fma_f32 v180, v180, v254, v238
v_fma_f32 v181, v181, v254, v239
v_lshlrev_b32 v232, 16, v155
v_and_b32 v233, s101, v155
v_fma_f32 v182, v182, v254, v232
v_fma_f32 v183, v183, v254, v233
ds_read_b128 v[152:155], v246 offset:4096
s_waitcnt lgkmcnt(2)
v_lshlrev_b32 v234, 16, v104
v_and_b32 v235, s101, v104
v_fma_f32 v184, v184, v254, v234
v_fma_f32 v185, v185, v254, v235
v_lshlrev_b32 v236, 16, v105
v_and_b32 v237, s101, v105
v_fma_f32 v186, v186, v254, v236
v_fma_f32 v187, v187, v254, v237
v_lshlrev_b32 v238, 16, v106
v_and_b32 v239, s101, v106
v_fma_f32 v188, v188, v254, v238
v_fma_f32 v189, v189, v254, v239
v_lshlrev_b32 v232, 16, v107
v_and_b32 v233, s101, v107
v_fma_f32 v190, v190, v254, v232
v_fma_f32 v191, v191, v254, v233
s_waitcnt vmcnt(11)
buffer_load_dwordx4 a[180:183], v240, s[16:19], s39 offen offset:3072
s_waitcnt lgkmcnt(1)
v_lshlrev_b32 v234, 16, v108
v_and_b32 v235, s101, v108
v_fma_f32 v192, v192, v255, v234
v_fma_f32 v193, v193, v255, v235
v_lshlrev_b32 v236, 16, v109
v_and_b32 v237, s101, v109
v_fma_f32 v194, v194, v255, v236
v_fma_f32 v195, v195, v255, v237
v_lshlrev_b32 v238, 16, v110
v_and_b32 v239, s101, v110
v_fma_f32 v196, v196, v255, v238
v_fma_f32 v197, v197, v255, v239
v_lshlrev_b32 v232, 16, v111
v_and_b32 v233, s101, v111
v_fma_f32 v198, v198, v255, v232
v_fma_f32 v199, v199, v255, v233
s_waitcnt lgkmcnt(0)
v_lshlrev_b32 v234, 16, v152
v_and_b32 v235, s101, v152
v_fma_f32 v200, v200, v255, v234
v_fma_f32 v201, v201, v255, v235
v_lshlrev_b32 v236, 16, v153
v_and_b32 v237, s101, v153
v_fma_f32 v202, v202, v255, v236
v_fma_f32 v203, v203, v255, v237
v_lshlrev_b32 v238, 16, v154
v_and_b32 v239, s101, v154
v_fma_f32 v204, v204, v255, v238
v_fma_f32 v205, v205, v255, v239
v_lshlrev_b32 v232, 16, v155
v_and_b32 v233, s101, v155
v_fma_f32 v206, v206, v255, v232
v_fma_f32 v207, v207, v255, v233
s_waitcnt vmcnt(11)
buffer_load_dwordx4 a[184:187], v241, s[16:19], s39 offen offset:2048
s_waitcnt vmcnt(11)
buffer_load_dwordx4 a[188:191], v241, s[16:19], s39 offen offset:3072
s_waitcnt vmcnt(11)
buffer_load_dwordx4 a[192:195], v240, s[16:19], s40 offen offset:0
s_waitcnt vmcnt(11)
buffer_load_dwordx4 a[196:199], v240, s[16:19], s40 offen offset:1024
s_waitcnt vmcnt(11)
buffer_load_dwordx4 a[200:203], v241, s[16:19], s40 offen offset:0
s_waitcnt vmcnt(11)
buffer_load_dwordx4 a[204:207], v241, s[16:19], s40 offen offset:1024
s_waitcnt vmcnt(11)
buffer_load_dwordx4 a[208:211], v240, s[16:19], s40 offen offset:2048
s_waitcnt vmcnt(11)
buffer_load_dwordx4 a[212:215], v240, s[16:19], s40 offen offset:3072
s_waitcnt vmcnt(11)
s_waitcnt vmcnt(10)
v_cmp_eq_u32 vcc, 0, v43
s_nop 1
s_cbranch_vccnz LF_spin
LF_go:
buffer_load_dwordx4 v[128:131], v242, s[24:27], 0 offen offset:0 sc1
buffer_load_dwordx4 v[132:135], v242, s[24:27], 0 offen offset:16 sc1
s_waitcnt vmcnt(11)
buffer_load_dwordx4 v[136:139], v242, s[24:27], 0 offen offset:32 sc1
s_waitcnt vmcnt(11)
s_waitcnt vmcnt(10)
s_add_u32 s49, s6, s42
buffer_load_dwordx4 v[24:27], v47, s[16:19], s49 offen offset:0 sc1
s_add_u32 s3, s6, s43
buffer_load_dwordx4 v[28:31], v47, s[16:19], s3 offen offset:0 sc1
s_waitcnt vmcnt(11)
buffer_load_dwordx4 a[216:219], v241, s[16:19], s40 offen offset:2048
s_waitcnt vmcnt(11)
s_waitcnt vmcnt(10)
s_add_u32 s49, s6, s44
buffer_load_dwordx4 v[32:35], v47, s[16:19], s49 offen offset:0 sc1
s_add_u32 s3, s6, s45
buffer_load_dwordx4 v[36:39], v47, s[16:19], s3 offen offset:0 sc1
s_waitcnt vmcnt(11)
buffer_load_dwordx4 a[220:223], v241, s[16:19], s40 offen offset:3072
s_waitcnt vmcnt(11)
s_add_u32 s49, s6, s46
buffer_load_dwordx4 v[48:51], v47, s[16:19], s49 offen offset:0 sc1
ds_read_b128 v[52:55], v76 offset:0
s_waitcnt vmcnt(11)
buffer_load_dwordx4 a[224:227], v240, s[16:19], s41 offen offset:0
s_waitcnt vmcnt(11)
s_waitcnt vmcnt(10)
s_add_u32 s49, s6, s42
buffer_load_dwordx4 v[56:59], v47, s[16:19], s49 offen offset:1024 sc1
s_add_u32 s3, s6, s43
buffer_load_dwordx4 v[60:63], v47, s[16:19], s3 offen offset:1024 sc1
s_waitcnt vmcnt(11)
buffer_load_dwordx4 a[228:231], v240, s[16:19], s41 offen offset:1024
s_waitcnt vmcnt(11)
v_max3_f32 v232, v128, v130, v132
v_max3_f32 v233, v134, v136, v138
v_max_f32 v232, v232, v233
v_subrev_f32 v232, 0x42fe0000, v232
v_sub_f32 v128, v128, v232
v_sub_f32 v130, v130, v232
v_sub_f32 v132, v132, v232
v_sub_f32 v134, v134, v232
v_sub_f32 v136, v136, v232
v_sub_f32 v138, v138, v232
v_cvt_u32_f32 v128, v128
v_cvt_u32_f32 v130, v130
v_cvt_u32_f32 v132, v132
v_cvt_u32_f32 v134, v134
v_cvt_u32_f32 v136, v136
v_cvt_u32_f32 v138, v138
v_lshlrev_b32 v234, 23, v128
v_lshlrev_b32 v235, 23, v130
v_lshlrev_b32 v236, 23, v132
v_lshlrev_b32 v237, 23, v134
v_lshlrev_b32 v238, 23, v136
v_lshlrev_b32 v239, 23, v138
v_mul_f32 v232, v234, v129
v_fmac_f32 v232, v235, v131
v_fmac_f32 v232, v236, v133
v_fmac_f32 v232, v237, v135
v_fmac_f32 v232, v238, v137
v_fmac_f32 v232, v239, v139
v_rcp_f32 v150, v232
v_mul_u32_u24 v144, 0x800080, v128
v_mul_u32_u24 v145, 0x800080, v130
v_mul_u32_u24 v146, 0x800080, v132
v_mul_u32_u24 v147, 0x800080, v134
v_mul_u32_u24 v148, 0x800080, v136
v_mul_u32_u24 v149, 0x800080, v138
ds_write_b128 v249, v[144:147]
ds_write_b96 v249, v[148:150] offset:16
ds_read_b128 v[144:147], v250 offset:0
ds_read_b128 v[148:151], v250 offset:16
s_waitcnt lgkmcnt(0)
v_and_b32 v0, v144, v156
v_and_b32 v1, v144, v157
v_and_b32 v2, v145, v156
v_and_b32 v3, v145, v157
v_and_b32 v4, v146, v156
v_and_b32 v5, v146, v157
v_and_b32 v6, v147, v156
v_and_b32 v7, v147, v157
v_and_b32 v8, v148, v156
v_and_b32 v9, v148, v157
v_and_b32 v10, v149, v156
v_and_b32 v11, v149, v157
v_mov_b32 v40, v150
ds_read_b128 v[144:147], v250 offset:512
ds_read_b128 v[148:151], v250 offset:528
s_waitcnt vmcnt(9)
v_swap_b32 v26, v28
v_swap_b32 v27, v29
s_nop 1
v_mfma_f32_16x16x32_bf16 v[128:131], v[24:27], v[0:3], 0
s_add_u32 s49, s6, s44
buffer_load_dwordx4 v[64:67], v47, s[16:19], s49 offen offset:1024 sc1
v_mfma_f32_16x16x32_bf16 v[132:135], v[28:31], v[0:3], 0
s_add_u32 s3, s6, s45
buffer_load_dwordx4 v[68:71], v47, s[16:19], s3 offen offset:1024 sc1
buffer_load_dwordx4 a[232:235], v241, s[16:19], s41 offen offset:0
s_waitcnt lgkmcnt(0)
v_and_b32 v12, v144, v156
v_and_b32 v13, v144, v157
v_and_b32 v14, v145, v156
v_and_b32 v15, v145, v157
v_and_b32 v16, v146, v156
v_and_b32 v17, v146, v157
v_and_b32 v18, v147, v156
v_and_b32 v19, v147, v157
v_and_b32 v20, v148, v156
v_and_b32 v21, v148, v157
v_and_b32 v22, v149, v156
v_and_b32 v23, v149, v157
v_mov_b32 v41, v150
ds_read_b128 v[144:147], v250 offset:1024
ds_read_b128 v[148:151], v250 offset:1040
s_waitcnt vmcnt(11)
s_add_u32 s49, s6, s46
buffer_load_dwordx4 v[80:83], v47, s[16:19], s49 offen offset:1024 sc1
ds_read_b128 v[84:87], v76 offset:1024
s_waitcnt vmcnt(10)
v_swap_b32 v34, v36
v_swap_b32 v35, v37
s_nop 1
v_mfma_f32_16x16x32_bf16 v[128:131], v[32:35], v[4:7], v[128:131]
buffer_load_dwordx4 a[236:239], v241, s[16:19], s41 offen offset:1024
v_mfma_f32_16x16x32_bf16 v[132:135], v[36:39], v[4:7], v[132:135]
s_waitcnt vmcnt(10)
s_add_u32 s49, s7, s42
buffer_load_dwordx4 v[88:91], v47, s[16:19], s49 offen offset:0 sc1
s_add_u32 s3, s7, s43
buffer_load_dwordx4 v[92:95], v47, s[16:19], s3 offen offset:0 sc1
s_waitcnt vmcnt(11)
v_swap_b32 v50, v52
v_swap_b32 v51, v53
s_nop 1
v_mfma_f32_16x16x32_bf16 v[128:131], v[48:51], v[8:11], v[128:131]
buffer_load_dwordx4 a[240:243], v240, s[16:19], s41 offen offset:2048
v_mfma_f32_16x16x32_bf16 v[132:135], v[52:55], v[8:11], v[132:135]
s_waitcnt vmcnt(11)
s_nop 4
v_mul_f32 v128, v128, v40
v_mul_f32 v129, v129, v40
v_mul_f32 v130, v130, v40
v_mul_f32 v131, v131, v40
v_mul_f32 v132, v132, v40
v_mul_f32 v133, v133, v40
v_mul_f32 v134, v134, v40
v_mul_f32 v135, v135, v40
v_cvt_pk_bf16_f32 v128, v128, v129
v_cvt_pk_bf16_f32 v129, v130, v131
v_cvt_pk_bf16_f32 v130, v132, v133
v_cvt_pk_bf16_f32 v131, v134, v135
ds_write_b128 v251, v[128:131] offset:0
s_waitcnt vmcnt(9)
v_swap_b32 v58, v60
v_swap_b32 v59, v61
s_nop 1
v_mfma_f32_16x16x32_bf16 v[136:139], v[56:59], v[0:3], 0
s_add_u32 s49, s7, s44
buffer_load_dwordx4 v[96:99], v47, s[16:19], s49 offen offset:0 sc1
v_mfma_f32_16x16x32_bf16 v[140:143], v[60:63], v[0:3], 0
s_add_u32 s3, s7, s45
buffer_load_dwordx4 v[100:103], v47, s[16:19], s3 offen offset:0 sc1
buffer_load_dwordx4 a[244:247], v240, s[16:19], s41 offen offset:3072
s_waitcnt vmcnt(11)
s_add_u32 s49, s7, s46
buffer_load_dwordx4 v[112:115], v47, s[16:19], s49 offen offset:0 sc1
ds_read_b128 v[116:119], v77 offset:0
s_waitcnt vmcnt(10)
v_swap_b32 v66, v68
v_swap_b32 v67, v69
s_nop 1
v_mfma_f32_16x16x32_bf16 v[136:139], v[64:67], v[4:7], v[136:139]
buffer_load_dwordx4 a[248:251], v241, s[16:19], s41 offen offset:2048
v_mfma_f32_16x16x32_bf16 v[140:143], v[68:71], v[4:7], v[140:143]
s_waitcnt vmcnt(10)
s_add_u32 s49, s7, s42
buffer_load_dwordx4 v[120:123], v47, s[16:19], s49 offen offset:1024 sc1
s_add_u32 s3, s7, s43
buffer_load_dwordx4 v[124:127], v47, s[16:19], s3 offen offset:1024 sc1
s_waitcnt vmcnt(11)
s_waitcnt lgkmcnt(2)
v_swap_b32 v82, v84
v_swap_b32 v83, v85
s_nop 1
v_mfma_f32_16x16x32_bf16 v[136:139], v[80:83], v[8:11], v[136:139]
buffer_load_dwordx4 a[252:255], v241, s[16:19], s41 offen offset:3072
v_mfma_f32_16x16x32_bf16 v[140:143], v[84:87], v[8:11], v[140:143]
s_waitcnt vmcnt(11)
s_nop 4
v_mul_f32 v136, v136, v40
v_mul_f32 v137, v137, v40
v_mul_f32 v138, v138, v40
v_mul_f32 v139, v139, v40
v_mul_f32 v140, v140, v40
v_mul_f32 v141, v141, v40
v_mul_f32 v142, v142, v40
v_mul_f32 v143, v143, v40
v_cvt_pk_bf16_f32 v136, v136, v137
v_cvt_pk_bf16_f32 v137, v138, v139
v_cvt_pk_bf16_f32 v138, v140, v141
v_cvt_pk_bf16_f32 v139, v142, v143
ds_write_b128 v251, v[136:139] offset:1024
s_waitcnt lgkmcnt(0)
s_barrier
ds_read_b128 v[208:211], v252 offset:0
ds_read_b128 v[212:215], v252 offset:1024
ds_read_b128 v[216:219], v252 offset:2048
ds_read_b128 v[220:223], v252 offset:3072
ds_read_b128 v[224:227], v252 offset:4096
s_waitcnt vmcnt(9)
s_waitcnt lgkmcnt(4)
v_mfma_f32_16x16x32_bf16 v[160:163], a[128:131], v[208:211], v[160:163]
ds_read_b128 v[228:231], v252 offset:5120
v_swap_b32 v90, v92
v_mfma_f32_16x16x32_bf16 v[164:167], a[132:135], v[208:211], v[164:167]
v_swap_b32 v91, v93
s_nop 1
v_mfma_f32_16x16x32_bf16 v[128:131], v[88:91], v[12:15], 0
s_add_u32 s49, s7, s44
buffer_load_dwordx4 v[24:27], v47, s[16:19], s49 offen offset:1024 sc1
v_mfma_f32_16x16x32_bf16 v[132:135], v[92:95], v[12:15], 0
s_add_u32 s3, s7, s45
buffer_load_dwordx4 v[28:31], v47, s[16:19], s3 offen offset:1024 sc1
v_mfma_f32_16x16x32_bf16 v[168:171], a[136:139], v[208:211], v[168:171]
s_add_u32 s49, s7, s46
buffer_load_dwordx4 v[32:35], v47, s[16:19], s49 offen offset:1024 sc1
v_mfma_f32_16x16x32_bf16 v[172:175], a[140:143], v[208:211], v[172:175]
ds_read_b128 v[36:39], v77 offset:1024
v_and_b32 v0, v144, v156
s_waitcnt lgkmcnt(5)
v_mfma_f32_16x16x32_bf16 v[160:163], a[144:147], v[212:215], v[160:163]
ds_read_b128 v[208:211], v252 offset:6144
v_and_b32 v1, v144, v157
v_and_b32 v2, v145, v156
v_mfma_f32_16x16x32_bf16 v[164:167], a[148:151], v[212:215], v[164:167]
v_and_b32 v3, v145, v157
v_and_b32 v4, v146, v156
v_mfma_f32_16x16x32_bf16 v[168:171], a[152:155], v[212:215], v[168:171]
v_and_b32 v5, v146, v157
v_and_b32 v6, v147, v156
v_mfma_f32_16x16x32_bf16 v[172:175], a[156:159], v[212:215], v[172:175]
v_and_b32 v7, v147, v157
v_and_b32 v8, v148, v156
s_waitcnt lgkmcnt(5)
v_mfma_f32_16x16x32_bf16 v[160:163], a[160:163], v[216:219], v[160:163]
ds_read_b128 v[212:215], v252 offset:7168
v_and_b32 v9, v148, v157
v_and_b32 v10, v149, v156
v_mfma_f32_16x16x32_bf16 v[164:167], a[164:167], v[216:219], v[164:167]
v_and_b32 v11, v149, v157
v_mov_b32 v42, v150
v_mfma_f32_16x16x32_bf16 v[168:171], a[168:171], v[216:219], v[168:171]
v_mfma_f32_16x16x32_bf16 v[172:175], a[172:175], v[216:219], v[172:175]
s_waitcnt vmcnt(11)
s_waitcnt lgkmcnt(5)
v_mfma_f32_16x16x32_bf16 v[160:163], a[176:179], v[220:223], v[160:163]
v_mfma_f32_16x16x32_bf16 v[164:167], a[180:183], v[220:223], v[164:167]
v_mfma_f32_16x16x32_bf16 v[168:171], a[184:187], v[220:223], v[168:171]
v_mfma_f32_16x16x32_bf16 v[172:175], a[188:191], v[220:223], v[172:175]
s_waitcnt vmcnt(9)
s_waitcnt lgkmcnt(4)
v_mfma_f32_16x16x32_bf16 v[160:163], a[192:195], v[224:227], v[160:163]
v_swap_b32 v98, v100
v_mfma_f32_16x16x32_bf16 v[164:167], a[196:199], v[224:227], v[164:167]
v_swap_b32 v99, v101
s_nop 1
v_mfma_f32_16x16x32_bf16 v[128:131], v[96:99], v[16:19], v[128:131]
s_add_u32 s49, s29, s42
buffer_load_dwordx4 v[48:51], v47, s[16:19], s49 offen offset:0 sc1
v_mfma_f32_16x16x32_bf16 v[132:135], v[100:103], v[16:19], v[132:135]
s_add_u32 s3, s29, s43
buffer_load_dwordx4 v[52:55], v47, s[16:19], s3 offen offset:0 sc1
v_mfma_f32_16x16x32_bf16 v[168:171], a[200:203], v[224:227], v[168:171]
v_mfma_f32_16x16x32_bf16 v[172:175], a[204:207], v[224:227], v[172:175]
s_waitcnt lgkmcnt(3)
v_mfma_f32_16x16x32_bf16 v[160:163], a[208:211], v[228:231], v[160:163]
v_mfma_f32_16x16x32_bf16 v[164:167], a[212:215], v[228:231], v[164:167]
v_mfma_f32_16x16x32_bf16 v[168:171], a[216:219], v[228:231], v[168:171]
v_mfma_f32_16x16x32_bf16 v[172:175], a[220:223], v[228:231], v[172:175]
s_waitcnt vmcnt(10)
s_waitcnt lgkmcnt(1)
v_mfma_f32_16x16x32_bf16 v[160:163], a[224:227], v[208:211], v[160:163]
s_add_u32 s49, s29, s44
buffer_load_dwordx4 v[56:59], v47, s[16:19], s49 offen offset:0 sc1
v_mfma_f32_16x16x32_bf16 v[164:167], a[228:231], v[208:211], v[164:167]
s_add_u32 s3, s29, s45
buffer_load_dwordx4 v[60:63], v47, s[16:19], s3 offen offset:0 sc1
v_mfma_f32_16x16x32_bf16 v[168:171], a[232:235], v[208:211], v[168:171]
v_mfma_f32_16x16x32_bf16 v[172:175], a[236:239], v[208:211], v[172:175]
s_waitcnt vmcnt(11)
v_swap_b32 v114, v116
v_swap_b32 v115, v117
s_nop 1
v_mfma_f32_16x16x32_bf16 v[128:131], v[112:115], v[20:23], v[128:131]
v_mfma_f32_16x16x32_bf16 v[132:135], v[116:119], v[20:23], v[132:135]
s_waitcnt vmcnt(10)
s_add_u32 s49, s29, s46
buffer_load_dwordx4 v[64:67], v47, s[16:19], s49 offen offset:0 sc1
s_add_u32 s3, s29, s47
s_cmp_lt_u32 s37, 4
s_cbranch_scc1 LF_o0
buffer_load_dwordx4 v[68:71], v47, s[16:19], s3 offen offset:0 sc1
ds_read_b128 v[152:155], v78 offset:0
s_branch LF_j0
LF_o0:
s_mov_b32 s3, 0x70000000
buffer_load_dwordx4 v[152:155], v47, s[16:19], s3 offen offset:0 sc1
ds_read_b128 v[68:71], v78 offset:0
LF_j0:
v_mul_f32 v128, v128, v41
v_mul_f32 v129, v129, v41
v_mul_f32 v130, v130, v41
v_mul_f32 v131, v131, v41
v_mul_f32 v132, v132, v41
v_mul_f32 v133, v133, v41
v_mul_f32 v134, v134, v41
v_mul_f32 v135, v135, v41
v_cvt_pk_bf16_f32 v128, v128, v129
v_cvt_pk_bf16_f32 v129, v130, v131
v_cvt_pk_bf16_f32 v130, v132, v133
v_cvt_pk_bf16_f32 v131, v134, v135
ds_write_b128 v251, v[128:131] offset:8192
s_waitcnt vmcnt(10)
v_swap_b32 v122, v124
v_swap_b32 v123, v125
s_nop 1
v_mfma_f32_16x16x32_bf16 v[136:139], v[120:123], v[12:15], 0
s_add_u32 s49, s29, s42
buffer_load_dwordx4 v[80:83], v47, s[16:19], s49 offen offset:1024 sc1
v_mfma_f32_16x16x32_bf16 v[140:143], v[124:127], v[12:15], 0
s_add_u32 s3, s29, s43
buffer_load_dwordx4 v[84:87], v47, s[16:19], s3 offen offset:1024 sc1
s_waitcnt vmcnt(11)
s_waitcnt lgkmcnt(2)
v_mfma_f32_16x16x32_bf16 v[160:163], a[240:243], v[212:215], v[160:163]
v_mfma_f32_16x16x32_bf16 v[164:167], a[244:247], v[212:215], v[164:167]
v_mfma_f32_16x16x32_bf16 v[168:171], a[248:251], v[212:215], v[168:171]
v_mfma_f32_16x16x32_bf16 v[172:175], a[252:255], v[212:215], v[172:175]
s_waitcnt vmcnt(9)
v_swap_b32 v26, v28
v_swap_b32 v27, v29
s_nop 1
v_mfma_f32_16x16x32_bf16 v[136:139], v[24:27], v[16:19], v[136:139]
s_add_u32 s49, s29, s44
buffer_load_dwordx4 v[88:91], v47, s[16:19], s49 offen offset:1024 sc1
v_mfma_f32_16x16x32_bf16 v[140:143], v[28:31], v[16:19], v[140:143]
s_add_u32 s3, s29, s45
buffer_load_dwordx4 v[92:95], v47, s[16:19], s3 offen offset:1024 sc1
v_cvt_pk_bf16_f32 v160, v160, v161
v_cvt_pk_bf16_f32 v161, v162, v163
v_cvt_pk_bf16_f32 v162, v164, v165
v_cvt_pk_bf16_f32 v163, v166, v167
ds_write_b128 v245, v[160:163] offset:0
v_cvt_pk_bf16_f32 v168, v168, v169
v_cvt_pk_bf16_f32 v169, v170, v171
v_cvt_pk_bf16_f32 v170, v172, v173
v_cvt_pk_bf16_f32 v171, v174, v175
ds_write_b128 v246, v[168:171] offset:0
ds_read_b128 v[164:167], v247 offset:0
ds_read_b128 v[172:175], v247 offset:1024
s_waitcnt vmcnt(10)
v_swap_b32 v34, v36
v_swap_b32 v35, v37
s_nop 1
v_mfma_f32_16x16x32_bf16 v[136:139], v[32:35], v[20:23], v[136:139]
s_add_u32 s49, s29, s46
buffer_load_dwordx4 v[96:99], v47, s[16:19], s49 offen offset:1024 sc1
v_mfma_f32_16x16x32_bf16 v[140:143], v[36:39], v[20:23], v[140:143]
s_add_u32 s3, s29, s47
s_cmp_lt_u32 s37, 4
s_cbranch_scc1 LF_o1
buffer_load_dwordx4 v[100:103], v47, s[16:19], s3 offen offset:1024 sc1
ds_read_b128 v[152:155], v78 offset:1024
s_branch LF_j1
LF_o1:
s_mov_b32 s3, 0x70000000
buffer_load_dwordx4 v[152:155], v47, s[16:19], s3 offen offset:1024 sc1
ds_read_b128 v[100:103], v78 offset:1024
LF_j1:
s_waitcnt lgkmcnt(2)
buffer_store_dwordx4 v[164:167], v44, s[56:59], s6 offen
s_waitcnt lgkmcnt(1)
buffer_store_dwordx4 v[172:175], v45, s[56:59], s6 offen
v_mul_f32 v136, v136, v41
v_mul_f32 v137, v137, v41
v_mul_f32 v138, v138, v41
v_mul_f32 v139, v139, v41
v_mul_f32 v140, v140, v41
v_mul_f32 v141, v141, v41
v_mul_f32 v142, v142, v41
v_mul_f32 v143, v143, v41
v_cvt_pk_bf16_f32 v136, v136, v137
v_cvt_pk_bf16_f32 v137, v138, v139
v_cvt_pk_bf16_f32 v138, v140, v141
v_cvt_pk_bf16_f32 v139, v142, v143
ds_write_b128 v251, v[136:139] offset:9216
s_waitcnt lgkmcnt(0)
s_barrier
ds_read_b128 v[216:219], v252 offset:8192
ds_read_b128 v[220:223], v252 offset:9216
ds_read_b128 v[224:227], v252 offset:10240
ds_read_b128 v[228:231], v252 offset:11264
ds_read_b128 v[208:211], v252 offset:12288
s_waitcnt vmcnt(12)
s_waitcnt lgkmcnt(4)
v_mfma_f32_16x16x32_bf16 v[176:179], a[128:131], v[216:219], v[176:179]
ds_read_b128 v[212:215], v252 offset:13312
v_swap_b32 v50, v52
v_mfma_f32_16x16x32_bf16 v[180:183], a[132:135], v[216:219], v[180:183]
v_swap_b32 v51, v53
s_nop 1
v_mfma_f32_16x16x32_bf16 v[128:131], v[48:51], v[0:3], 0
v_mfma_f32_16x16x32_bf16 v[132:135], v[52:55], v[0:3], 0
v_mfma_f32_16x16x32_bf16 v[184:187], a[136:139], v[216:219], v[184:187]
v_mfma_f32_16x16x32_bf16 v[188:191], a[140:143], v[216:219], v[188:191]
s_waitcnt lgkmcnt(4)
v_mfma_f32_16x16x32_bf16 v[176:179], a[144:147], v[220:223], v[176:179]
ds_read_b128 v[216:219], v252 offset:14336
v_mfma_f32_16x16x32_bf16 v[180:183], a[148:151], v[220:223], v[180:183]
v_mfma_f32_16x16x32_bf16 v[184:187], a[152:155], v[220:223], v[184:187]
v_mfma_f32_16x16x32_bf16 v[188:191], a[156:159], v[220:223], v[188:191]
s_waitcnt vmcnt(10)
s_waitcnt lgkmcnt(4)
v_mfma_f32_16x16x32_bf16 v[176:179], a[160:163], v[224:227], v[176:179]
v_swap_b32 v58, v60
v_mfma_f32_16x16x32_bf16 v[180:183], a[164:167], v[224:227], v[180:183]
v_swap_b32 v59, v61
s_nop 1
v_mfma_f32_16x16x32_bf16 v[128:131], v[56:59], v[4:7], v[128:131]
v_mfma_f32_16x16x32_bf16 v[132:135], v[60:63], v[4:7], v[132:135]
v_mfma_f32_16x16x32_bf16 v[184:187], a[168:171], v[224:227], v[184:187]
v_mfma_f32_16x16x32_bf16 v[188:191], a[172:175], v[224:227], v[188:191]
s_waitcnt lgkmcnt(3)
v_mfma_f32_16x16x32_bf16 v[176:179], a[176:179], v[228:231], v[176:179]
v_mfma_f32_16x16x32_bf16 v[180:183], a[180:183], v[228:231], v[180:183]
v_mfma_f32_16x16x32_bf16 v[184:187], a[184:187], v[228:231], v[184:187]
v_mfma_f32_16x16x32_bf16 v[188:191], a[188:191], v[228:231], v[188:191]
s_waitcnt vmcnt(8)
s_waitcnt lgkmcnt(2)
v_mfma_f32_16x16x32_bf16 v[176:179], a[192:195], v[208:211], v[176:179]
v_swap_b32 v66, v68
v_mfma_f32_16x16x32_bf16 v[180:183], a[196:199], v[208:211], v[180:183]
v_swap_b32 v67, v69
s_nop 1
v_mfma_f32_16x16x32_bf16 v[128:131], v[64:67], v[8:11], v[128:131]
v_mfma_f32_16x16x32_bf16 v[132:135], v[68:71], v[8:11], v[132:135]
v_mfma_f32_16x16x32_bf16 v[184:187], a[200:203], v[208:211], v[184:187]
v_mfma_f32_16x16x32_bf16 v[188:191], a[204:207], v[208:211], v[188:191]
s_waitcnt lgkmcnt(1)
v_mfma_f32_16x16x32_bf16 v[176:179], a[208:211], v[212:215], v[176:179]
v_mfma_f32_16x16x32_bf16 v[180:183], a[212:215], v[212:215], v[180:183]
v_mfma_f32_16x16x32_bf16 v[184:187], a[216:219], v[212:215], v[184:187]
v_mfma_f32_16x16x32_bf16 v[188:191], a[220:223], v[212:215], v[188:191]
s_waitcnt lgkmcnt(0)
v_mfma_f32_16x16x32_bf16 v[176:179], a[224:227], v[216:219], v[176:179]
v_mul_f32 v128, v128, v42
v_mul_f32 v129, v129, v42
v_mfma_f32_16x16x32_bf16 v[180:183], a[228:231], v[216:219], v[180:183]
v_mul_f32 v130, v130, v42
v_mul_f32 v131, v131, v42
v_mfma_f32_16x16x32_bf16 v[184:187], a[232:235], v[216:219], v[184:187]
v_mul_f32 v132, v132, v42
v_mul_f32 v133, v133, v42
v_mfma_f32_16x16x32_bf16 v[188:191], a[236:239], v[216:219], v[188:191]
v_mul_f32 v134, v134, v42
v_mul_f32 v135, v135, v42
v_cvt_pk_bf16_f32 v128, v128, v129
v_cvt_pk_bf16_f32 v129, v130, v131
v_cvt_pk_bf16_f32 v130, v132, v133
v_cvt_pk_bf16_f32 v131, v134, v135
ds_write_b128 v251, v[128:131] offset:16384
s_waitcnt lgkmcnt(0)
s_barrier
ds_read_b128 v[220:223], v252 offset:15360
ds_read_b128 v[224:227], v252 offset:16384
ds_read_b128 v[228:231], v252 offset:18432
ds_read_b128 v[208:211], v252 offset:20480
ds_read_b128 v[212:215], v252 offset:22528
s_waitcnt vmcnt(6)
s_waitcnt lgkmcnt(4)
v_mfma_f32_16x16x32_bf16 v[176:179], a[240:243], v[220:223], v[176:179]
v_swap_b32 v82, v84
v_mfma_f32_16x16x32_bf16 v[180:183], a[244:247], v[220:223], v[180:183]
v_swap_b32 v83, v85
s_nop 1
v_mfma_f32_16x16x32_bf16 v[136:139], v[80:83], v[0:3], 0
v_mfma_f32_16x16x32_bf16 v[140:143], v[84:87], v[0:3], 0
v_mfma_f32_16x16x32_bf16 v[184:187], a[248:251], v[220:223], v[184:187]
v_mfma_f32_16x16x32_bf16 v[188:191], a[252:255], v[220:223], v[188:191]
s_waitcnt lgkmcnt(3)
v_mfma_f32_16x16x32_bf16 v[192:195], a[128:131], v[224:227], v[192:195]
v_mfma_f32_16x16x32_bf16 v[196:199], a[132:135], v[224:227], v[196:199]
v_mfma_f32_16x16x32_bf16 v[200:203], a[136:139], v[224:227], v[200:203]
v_mfma_f32_16x16x32_bf16 v[204:207], a[140:143], v[224:227], v[204:207]
s_waitcnt vmcnt(4)
s_waitcnt lgkmcnt(2)
v_mfma_f32_16x16x32_bf16 v[192:195], a[160:163], v[228:231], v[192:195]
v_swap_b32 v90, v92
v_mfma_f32_16x16x32_bf16 v[196:199], a[164:167], v[228:231], v[196:199]
v_swap_b32 v91, v93
s_nop 1
v_mfma_f32_16x16x32_bf16 v[136:139], v[88:91], v[4:7], v[136:139]
v_cvt_pk_bf16_f32 v176, v176, v177
v_cvt_pk_bf16_f32 v177, v178, v179
v_mfma_f32_16x16x32_bf16 v[140:143], v[92:95], v[4:7], v[140:143]
v_cvt_pk_bf16_f32 v178, v180, v181
v_cvt_pk_bf16_f32 v179, v182, v183
v_mfma_f32_16x16x32_bf16 v[200:203], a[168:171], v[228:231], v[200:203]
ds_write_b128 v245, v[176:179] offset:2048
v_cvt_pk_bf16_f32 v184, v184, v185
v_mfma_f32_16x16x32_bf16 v[204:207], a[172:175], v[228:231], v[204:207]
v_cvt_pk_bf16_f32 v185, v186, v187
v_cvt_pk_bf16_f32 v186, v188, v189
s_waitcnt lgkmcnt(2)
v_mfma_f32_16x16x32_bf16 v[192:195], a[192:195], v[208:211], v[192:195]
v_cvt_pk_bf16_f32 v187, v190, v191
ds_write_b128 v246, v[184:187] offset:2048
v_mfma_f32_16x16x32_bf16 v[196:199], a[196:199], v[208:211], v[196:199]
ds_read_b128 v[180:183], v247 offset:2048
ds_read_b128 v[188:191], v247 offset:3072
v_mfma_f32_16x16x32_bf16 v[200:203], a[200:203], v[208:211], v[200:203]
v_mfma_f32_16x16x32_bf16 v[204:207], a[204:207], v[208:211], v[204:207]
s_waitcnt vmcnt(2)
s_waitcnt lgkmcnt(4)
v_mfma_f32_16x16x32_bf16 v[192:195], a[224:227], v[212:215], v[192:195]
v_swap_b32 v98, v100
v_mfma_f32_16x16x32_bf16 v[196:199], a[228:231], v[212:215], v[196:199]
v_swap_b32 v99, v101
s_nop 1
v_mfma_f32_16x16x32_bf16 v[136:139], v[96:99], v[8:11], v[136:139]
s_waitcnt lgkmcnt(1)
buffer_store_dwordx4 v[180:183], v44, s[56:59], s7 offen
v_mfma_f32_16x16x32_bf16 v[140:143], v[100:103], v[8:11], v[140:143]
s_waitcnt lgkmcnt(0)
buffer_store_dwordx4 v[188:191], v45, s[56:59], s7 offen
v_mfma_f32_16x16x32_bf16 v[200:203], a[232:235], v[212:215], v[200:203]
v_mfma_f32_16x16x32_bf16 v[204:207], a[236:239], v[212:215], v[204:207]
s_nop 0
v_mul_f32 v136, v136, v42
v_mul_f32 v137, v137, v42
v_mul_f32 v138, v138, v42
v_mul_f32 v139, v139, v42
v_mul_f32 v140, v140, v42
v_mul_f32 v141, v141, v42
v_mul_f32 v142, v142, v42
v_mul_f32 v143, v143, v42
v_cvt_pk_bf16_f32 v136, v136, v137
v_cvt_pk_bf16_f32 v137, v138, v139
v_cvt_pk_bf16_f32 v138, v140, v141
v_cvt_pk_bf16_f32 v139, v142, v143
ds_write_b128 v251, v[136:139] offset:17408
s_waitcnt lgkmcnt(0)
s_barrier
ds_read_b128 v[216:219], v252 offset:17408
ds_read_b128 v[220:223], v252 offset:19456
ds_read_b128 v[224:227], v252 offset:21504
ds_read_b128 v[228:231], v252 offset:23552
s_waitcnt lgkmcnt(3)
v_mfma_f32_16x16x32_bf16 v[192:195], a[144:147], v[216:219], v[192:195]
v_mfma_f32_16x16x32_bf16 v[196:199], a[148:151], v[216:219], v[196:199]
v_mfma_f32_16x16x32_bf16 v[200:203], a[152:155], v[216:219], v[200:203]
v_mfma_f32_16x16x32_bf16 v[204:207], a[156:159], v[216:219], v[204:207]
s_waitcnt lgkmcnt(2)
v_mfma_f32_16x16x32_bf16 v[192:195], a[176:179], v[220:223], v[192:195]
v_mfma_f32_16x16x32_bf16 v[196:199], a[180:183], v[220:223], v[196:199]
v_mfma_f32_16x16x32_bf16 v[200:203], a[184:187], v[220:223], v[200:203]
v_mfma_f32_16x16x32_bf16 v[204:207], a[188:191], v[220:223], v[204:207]
s_waitcnt lgkmcnt(1)
v_mfma_f32_16x16x32_bf16 v[192:195], a[208:211], v[224:227], v[192:195]
v_mfma_f32_16x16x32_bf16 v[196:199], a[212:215], v[224:227], v[196:199]
v_mfma_f32_16x16x32_bf16 v[200:203], a[216:219], v[224:227], v[200:203]
v_mfma_f32_16x16x32_bf16 v[204:207], a[220:223], v[224:227], v[204:207]
s_waitcnt lgkmcnt(0)
v_mfma_f32_16x16x32_bf16 v[192:195], a[240:243], v[228:231], v[192:195]
v_mfma_f32_16x16x32_bf16 v[196:199], a[244:247], v[228:231], v[196:199]
v_mfma_f32_16x16x32_bf16 v[200:203], a[248:251], v[228:231], v[200:203]
v_mfma_f32_16x16x32_bf16 v[204:207], a[252:255], v[228:231], v[204:207]
s_nop 4
v_cvt_pk_bf16_f32 v192, v192, v193
v_cvt_pk_bf16_f32 v193, v194, v195
v_cvt_pk_bf16_f32 v194, v196, v197
v_cvt_pk_bf16_f32 v195, v198, v199
ds_write_b128 v245, v[192:195] offset:4096
v_cvt_pk_bf16_f32 v200, v200, v201
v_cvt_pk_bf16_f32 v201, v202, v203
v_cvt_pk_bf16_f32 v202, v204, v205
v_cvt_pk_bf16_f32 v203, v206, v207
ds_write_b128 v246, v[200:203] offset:4096
ds_read_b128 v[196:199], v247 offset:4096
ds_read_b128 v[204:207], v247 offset:5120
s_waitcnt lgkmcnt(1)
buffer_store_dwordx4 v[196:199], v44, s[56:59], s29 offen
s_waitcnt lgkmcnt(0)
buffer_store_dwordx4 v[204:207], v45, s[56:59], s29 offen
s_branch L2_fin
LF_spin:
buffer_load_dword v43, v46, s[16:19], 0 offen sc1
s_sub_u32 s100, s100, 1
s_waitcnt vmcnt(0)
s_cbranch_scc1 LF_go
v_cmp_eq_u32 vcc, 0, v43
s_nop 1
s_cbranch_vccnz LF_spin
s_branch LF_go
L2_Fend:
L2_rare_site0:
s_mov_b32 s36, 0
s_branch L2_rare_0_0
L2_rare_0_0:
s_nop 15
s_nop 15
s_waitcnt lgkmcnt(0)
v_log_f32 v243, v224
v_max3_f32 v232, v128, v129, v130
v_max3_f32 v232, v232, v131, v243
v_mov_b32 v243, v232
s_nop 1
v_permlane32_swap_b32 v232, v243
s_nop 1
v_max_f32 v232, v232, v243
v_mov_b32 v243, v232
s_nop 1
v_permlane16_swap_b32 v232, v243
s_nop 1
v_max_f32 v232, v232, v243
v_ceil_f32 v232, v232
v_max_f32 v232, 0, v232
v_sub_f32 v243, 0, v232
v_exp_f32 v236, v243
s_nop 1
v_mul_f32 v224, v224, v236
v_add_f32 v244, v244, v232
v_sub_f32 v192, v192, v232
v_sub_f32 v128, v128, v232
v_sub_f32 v144, v144, v232
v_sub_f32 v193, v193, v232
v_sub_f32 v129, v129, v232
v_sub_f32 v145, v145, v232
v_sub_f32 v194, v194, v232
v_sub_f32 v130, v130, v232
v_sub_f32 v146, v146, v232
v_sub_f32 v195, v195, v232
v_sub_f32 v131, v131, v232
v_sub_f32 v147, v147, v232
v_lshlrev_b32 v242, 16, v160
v_and_b32 v243, 0xffff0000, v160
v_mul_f32 v242, v242, v236
v_mul_f32 v243, v243, v236
v_cvt_pk_bf16_f32 v160, v242, v243
v_lshlrev_b32 v242, 16, v161
v_and_b32 v243, 0xffff0000, v161
v_mul_f32 v242, v242, v236
v_mul_f32 v243, v243, v236
v_cvt_pk_bf16_f32 v161, v242, v243
v_lshlrev_b32 v242, 16, v162
v_and_b32 v243, 0xffff0000, v162
v_mul_f32 v242, v242, v236
v_mul_f32 v243, v243, v236
v_cvt_pk_bf16_f32 v162, v242, v243
v_lshlrev_b32 v242, 16, v163
v_and_b32 v243, 0xffff0000, v163
v_mul_f32 v242, v242, v236
v_mul_f32 v243, v243, v236
v_cvt_pk_bf16_f32 v163, v242, v243
v_log_f32 v243, v225
v_max3_f32 v233, v132, v133, v134
v_max3_f32 v233, v233, v135, v243
v_mov_b32 v243, v233
s_nop 1
v_permlane32_swap_b32 v233, v243
s_nop 1
v_max_f32 v233, v233, v243
v_mov_b32 v243, v233
s_nop 1
v_permlane16_swap_b32 v233, v243
s_nop 1
v_max_f32 v233, v233, v243
v_ceil_f32 v233, v233
v_max_f32 v233, 0, v233
v_sub_f32 v243, 0, v233
v_exp_f32 v237, v243
s_nop 1
v_mul_f32 v225, v225, v237
v_add_f32 v245, v245, v233
v_sub_f32 v196, v196, v233
v_sub_f32 v132, v132, v233
v_sub_f32 v148, v148, v233
v_sub_f32 v197, v197, v233
v_sub_f32 v133, v133, v233
v_sub_f32 v149, v149, v233
v_sub_f32 v198, v198, v233
v_sub_f32 v134, v134, v233
v_sub_f32 v150, v150, v233
v_sub_f32 v199, v199, v233
v_sub_f32 v135, v135, v233
v_sub_f32 v151, v151, v233
v_lshlrev_b32 v242, 16, v164
v_and_b32 v243, 0xffff0000, v164
v_mul_f32 v242, v242, v237
v_mul_f32 v243, v243, v237
v_cvt_pk_bf16_f32 v164, v242, v243
v_lshlrev_b32 v242, 16, v165
v_and_b32 v243, 0xffff0000, v165
v_mul_f32 v242, v242, v237
v_mul_f32 v243, v243, v237
v_cvt_pk_bf16_f32 v165, v242, v243
v_lshlrev_b32 v242, 16, v166
v_and_b32 v243, 0xffff0000, v166
v_mul_f32 v242, v242, v237
v_mul_f32 v243, v243, v237
v_cvt_pk_bf16_f32 v166, v242, v243
v_lshlrev_b32 v242, 16, v167
v_and_b32 v243, 0xffff0000, v167
v_mul_f32 v242, v242, v237
v_mul_f32 v243, v243, v237
v_cvt_pk_bf16_f32 v167, v242, v243
v_log_f32 v243, v226
v_max3_f32 v234, v136, v137, v138
v_max3_f32 v234, v234, v139, v243
v_mov_b32 v243, v234
s_nop 1
v_permlane32_swap_b32 v234, v243
s_nop 1
v_max_f32 v234, v234, v243
v_mov_b32 v243, v234
s_nop 1
v_permlane16_swap_b32 v234, v243
s_nop 1
v_max_f32 v234, v234, v243
v_ceil_f32 v234, v234
v_max_f32 v234, 0, v234
v_sub_f32 v243, 0, v234
v_exp_f32 v238, v243
s_nop 1
v_mul_f32 v226, v226, v238
v_add_f32 v246, v246, v234
v_sub_f32 v200, v200, v234
v_sub_f32 v136, v136, v234
v_sub_f32 v152, v152, v234
v_sub_f32 v201, v201, v234
v_sub_f32 v137, v137, v234
v_sub_f32 v153, v153, v234
v_sub_f32 v202, v202, v234
v_sub_f32 v138, v138, v234
v_sub_f32 v154, v154, v234
v_sub_f32 v203, v203, v234
v_sub_f32 v139, v139, v234
v_sub_f32 v155, v155, v234
v_lshlrev_b32 v242, 16, v168
v_and_b32 v243, 0xffff0000, v168
v_mul_f32 v242, v242, v238
v_mul_f32 v243, v243, v238
v_cvt_pk_bf16_f32 v168, v242, v243
v_lshlrev_b32 v242, 16, v169
v_and_b32 v243, 0xffff0000, v169
v_mul_f32 v242, v242, v238
v_mul_f32 v243, v243, v238
v_cvt_pk_bf16_f32 v169, v242, v243
v_lshlrev_b32 v242, 16, v170
v_and_b32 v243, 0xffff0000, v170
v_mul_f32 v242, v242, v238
v_mul_f32 v243, v243, v238
v_cvt_pk_bf16_f32 v170, v242, v243
v_lshlrev_b32 v242, 16, v171
v_and_b32 v243, 0xffff0000, v171
v_mul_f32 v242, v242, v238
v_mul_f32 v243, v243, v238
v_cvt_pk_bf16_f32 v171, v242, v243
v_log_f32 v243, v227
v_max3_f32 v235, v140, v141, v142
v_max3_f32 v235, v235, v143, v243
v_mov_b32 v243, v235
s_nop 1
v_permlane32_swap_b32 v235, v243
s_nop 1
v_max_f32 v235, v235, v243
v_mov_b32 v243, v235
s_nop 1
v_permlane16_swap_b32 v235, v243
s_nop 1
v_max_f32 v235, v235, v243
v_ceil_f32 v235, v235
v_max_f32 v235, 0, v235
v_sub_f32 v243, 0, v235
v_exp_f32 v239, v243
s_nop 1
v_mul_f32 v227, v227, v239
v_add_f32 v247, v247, v235
v_sub_f32 v204, v204, v235
v_sub_f32 v140, v140, v235
v_sub_f32 v156, v156, v235
v_sub_f32 v205, v205, v235
v_sub_f32 v141, v141, v235
v_sub_f32 v157, v157, v235
v_sub_f32 v206, v206, v235
v_sub_f32 v142, v142, v235
v_sub_f32 v158, v158, v235
v_sub_f32 v207, v207, v235
v_sub_f32 v143, v143, v235
v_sub_f32 v159, v159, v235
v_lshlrev_b32 v242, 16, v172
v_and_b32 v243, 0xffff0000, v172
v_mul_f32 v242, v242, v239
v_mul_f32 v243, v243, v239
v_cvt_pk_bf16_f32 v172, v242, v243
v_lshlrev_b32 v242, 16, v173
v_and_b32 v243, 0xffff0000, v173
v_mul_f32 v242, v242, v239
v_mul_f32 v243, v243, v239
v_cvt_pk_bf16_f32 v173, v242, v243
v_lshlrev_b32 v242, 16, v174
v_and_b32 v243, 0xffff0000, v174
v_mul_f32 v242, v242, v239
v_mul_f32 v243, v243, v239
v_cvt_pk_bf16_f32 v174, v242, v243
v_lshlrev_b32 v242, 16, v175
v_and_b32 v243, 0xffff0000, v175
v_mul_f32 v242, v242, v239
v_mul_f32 v243, v243, v239
v_cvt_pk_bf16_f32 v175, v242, v243
v_exp_f32 v232, v128
v_exp_f32 v233, v129
v_exp_f32 v234, v130
v_exp_f32 v235, v131
s_nop 1
v_add_f32 v228, v224, v232
v_add_f32 v228, v228, v233
v_add_f32 v228, v228, v234
v_add_f32 v228, v228, v235
v_cvt_pk_bf16_f32 v176, v232, v233
v_cvt_pk_bf16_f32 v177, v234, v235
v_exp_f32 v232, v132
v_exp_f32 v233, v133
v_exp_f32 v234, v134
v_exp_f32 v235, v135
s_nop 1
v_add_f32 v229, v225, v232
v_add_f32 v229, v229, v233
v_add_f32 v229, v229, v234
v_add_f32 v229, v229, v235
v_cvt_pk_bf16_f32 v180, v232, v233
v_cvt_pk_bf16_f32 v181, v234, v235
v_exp_f32 v232, v136
v_exp_f32 v233, v137
v_exp_f32 v234, v138
v_exp_f32 v235, v139
s_nop 1
v_add_f32 v230, v226, v232
v_add_f32 v230, v230, v233
v_add_f32 v230, v230, v234
v_add_f32 v230, v230, v235
v_cvt_pk_bf16_f32 v184, v232, v233
v_cvt_pk_bf16_f32 v185, v234, v235
v_exp_f32 v232, v140
v_exp_f32 v233, v141
v_exp_f32 v234, v142
v_exp_f32 v235, v143
s_nop 1
v_add_f32 v231, v227, v232
v_add_f32 v231, v231, v233
v_add_f32 v231, v231, v234
v_add_f32 v231, v231, v235
v_cvt_pk_bf16_f32 v188, v232, v233
v_cvt_pk_bf16_f32 v189, v234, v235
s_branch L2_rare_common
L2_rare_site1:
s_mov_b32 s36, 1
s_branch L2_rare_0_1
L2_rare_0_1:
s_nop 15
s_nop 15
s_waitcnt lgkmcnt(0)
v_log_f32 v243, v228
v_max3_f32 v232, v144, v145, v146
v_max3_f32 v232, v232, v147, v243
v_mov_b32 v243, v232
s_nop 1
v_permlane32_swap_b32 v232, v243
s_nop 1
v_max_f32 v232, v232, v243
v_mov_b32 v243, v232
s_nop 1
v_permlane16_swap_b32 v232, v243
s_nop 1
v_max_f32 v232, v232, v243
v_ceil_f32 v232, v232
v_max_f32 v232, 0, v232
v_sub_f32 v243, 0, v232
v_exp_f32 v236, v243
s_nop 1
v_mul_f32 v228, v228, v236
v_add_f32 v244, v244, v232
v_sub_f32 v192, v192, v232
v_sub_f32 v128, v128, v232
v_sub_f32 v144, v144, v232
v_sub_f32 v193, v193, v232
v_sub_f32 v129, v129, v232
v_sub_f32 v145, v145, v232
v_sub_f32 v194, v194, v232
v_sub_f32 v130, v130, v232
v_sub_f32 v146, v146, v232
v_sub_f32 v195, v195, v232
v_sub_f32 v131, v131, v232
v_sub_f32 v147, v147, v232
v_lshlrev_b32 v242, 16, v160
v_and_b32 v243, 0xffff0000, v160
v_mul_f32 v242, v242, v236
v_mul_f32 v243, v243, v236
v_cvt_pk_bf16_f32 v160, v242, v243
v_lshlrev_b32 v242, 16, v161
v_and_b32 v243, 0xffff0000, v161
v_mul_f32 v242, v242, v236
v_mul_f32 v243, v243, v236
v_cvt_pk_bf16_f32 v161, v242, v243
v_lshlrev_b32 v242, 16, v162
v_and_b32 v243, 0xffff0000, v162
v_mul_f32 v242, v242, v236
v_mul_f32 v243, v243, v236
v_cvt_pk_bf16_f32 v162, v242, v243
v_lshlrev_b32 v242, 16, v163
v_and_b32 v243, 0xffff0000, v163
v_mul_f32 v242, v242, v236
v_mul_f32 v243, v243, v236
v_cvt_pk_bf16_f32 v163, v242, v243
v_lshlrev_b32 v242, 16, v176
v_and_b32 v243, 0xffff0000, v176
v_mul_f32 v242, v242, v236
v_mul_f32 v243, v243, v236
v_cvt_pk_bf16_f32 v176, v242, v243
v_lshlrev_b32 v242, 16, v177
v_and_b32 v243, 0xffff0000, v177
v_mul_f32 v242, v242, v236
v_mul_f32 v243, v243, v236
v_cvt_pk_bf16_f32 v177, v242, v243
v_log_f32 v243, v229
v_max3_f32 v233, v148, v149, v150
v_max3_f32 v233, v233, v151, v243
v_mov_b32 v243, v233
s_nop 1
v_permlane32_swap_b32 v233, v243
s_nop 1
v_max_f32 v233, v233, v243
v_mov_b32 v243, v233
s_nop 1
v_permlane16_swap_b32 v233, v243
s_nop 1
v_max_f32 v233, v233, v243
v_ceil_f32 v233, v233
v_max_f32 v233, 0, v233
v_sub_f32 v243, 0, v233
v_exp_f32 v237, v243
s_nop 1
v_mul_f32 v229, v229, v237
v_add_f32 v245, v245, v233
v_sub_f32 v196, v196, v233
v_sub_f32 v132, v132, v233
v_sub_f32 v148, v148, v233
v_sub_f32 v197, v197, v233
v_sub_f32 v133, v133, v233
v_sub_f32 v149, v149, v233
v_sub_f32 v198, v198, v233
v_sub_f32 v134, v134, v233
v_sub_f32 v150, v150, v233
v_sub_f32 v199, v199, v233
v_sub_f32 v135, v135, v233
v_sub_f32 v151, v151, v233
v_lshlrev_b32 v242, 16, v164
v_and_b32 v243, 0xffff0000, v164
v_mul_f32 v242, v242, v237
v_mul_f32 v243, v243, v237
v_cvt_pk_bf16_f32 v164, v242, v243
v_lshlrev_b32 v242, 16, v165
v_and_b32 v243, 0xffff0000, v165
v_mul_f32 v242, v242, v237
v_mul_f32 v243, v243, v237
v_cvt_pk_bf16_f32 v165, v242, v243
v_lshlrev_b32 v242, 16, v166
v_and_b32 v243, 0xffff0000, v166
v_mul_f32 v242, v242, v237
v_mul_f32 v243, v243, v237
v_cvt_pk_bf16_f32 v166, v242, v243
v_lshlrev_b32 v242, 16, v167
v_and_b32 v243, 0xffff0000, v167
v_mul_f32 v242, v242, v237
v_mul_f32 v243, v243, v237
v_cvt_pk_bf16_f32 v167, v242, v243
v_lshlrev_b32 v242, 16, v180
v_and_b32 v243, 0xffff0000, v180
v_mul_f32 v242, v242, v237
v_mul_f32 v243, v243, v237
v_cvt_pk_bf16_f32 v180, v242, v243
v_lshlrev_b32 v242, 16, v181
v_and_b32 v243, 0xffff0000, v181
v_mul_f32 v242, v242, v237
v_mul_f32 v243, v243, v237
v_cvt_pk_bf16_f32 v181, v242, v243
v_log_f32 v243, v230
v_max3_f32 v234, v152, v153, v154
v_max3_f32 v234, v234, v155, v243
v_mov_b32 v243, v234
s_nop 1
v_permlane32_swap_b32 v234, v243
s_nop 1
v_max_f32 v234, v234, v243
v_mov_b32 v243, v234
s_nop 1
v_permlane16_swap_b32 v234, v243
s_nop 1
v_max_f32 v234, v234, v243
v_ceil_f32 v234, v234
v_max_f32 v234, 0, v234
v_sub_f32 v243, 0, v234
v_exp_f32 v238, v243
s_nop 1
v_mul_f32 v230, v230, v238
v_add_f32 v246, v246, v234
v_sub_f32 v200, v200, v234
v_sub_f32 v136, v136, v234
v_sub_f32 v152, v152, v234
v_sub_f32 v201, v201, v234
v_sub_f32 v137, v137, v234
v_sub_f32 v153, v153, v234
v_sub_f32 v202, v202, v234
v_sub_f32 v138, v138, v234
v_sub_f32 v154, v154, v234
v_sub_f32 v203, v203, v234
v_sub_f32 v139, v139, v234
v_sub_f32 v155, v155, v234
v_lshlrev_b32 v242, 16, v168
v_and_b32 v243, 0xffff0000, v168
v_mul_f32 v242, v242, v238
v_mul_f32 v243, v243, v238
v_cvt_pk_bf16_f32 v168, v242, v243
v_lshlrev_b32 v242, 16, v169
v_and_b32 v243, 0xffff0000, v169
v_mul_f32 v242, v242, v238
v_mul_f32 v243, v243, v238
v_cvt_pk_bf16_f32 v169, v242, v243
v_lshlrev_b32 v242, 16, v170
v_and_b32 v243, 0xffff0000, v170
v_mul_f32 v242, v242, v238
v_mul_f32 v243, v243, v238
v_cvt_pk_bf16_f32 v170, v242, v243
v_lshlrev_b32 v242, 16, v171
v_and_b32 v243, 0xffff0000, v171
v_mul_f32 v242, v242, v238
v_mul_f32 v243, v243, v238
v_cvt_pk_bf16_f32 v171, v242, v243
v_lshlrev_b32 v242, 16, v184
v_and_b32 v243, 0xffff0000, v184
v_mul_f32 v242, v242, v238
v_mul_f32 v243, v243, v238
v_cvt_pk_bf16_f32 v184, v242, v243
v_lshlrev_b32 v242, 16, v185
v_and_b32 v243, 0xffff0000, v185
v_mul_f32 v242, v242, v238
v_mul_f32 v243, v243, v238
v_cvt_pk_bf16_f32 v185, v242, v243
v_log_f32 v243, v231
v_max3_f32 v235, v156, v157, v158
v_max3_f32 v235, v235, v159, v243
v_mov_b32 v243, v235
s_nop 1
v_permlane32_swap_b32 v235, v243
s_nop 1
v_max_f32 v235, v235, v243
v_mov_b32 v243, v235
s_nop 1
v_permlane16_swap_b32 v235, v243
s_nop 1
v_max_f32 v235, v235, v243
v_ceil_f32 v235, v235
v_max_f32 v235, 0, v235
v_sub_f32 v243, 0, v235
v_exp_f32 v239, v243
s_nop 1
v_mul_f32 v231, v231, v239
v_add_f32 v247, v247, v235
v_sub_f32 v204, v204, v235
v_sub_f32 v140, v140, v235
v_sub_f32 v156, v156, v235
v_sub_f32 v205, v205, v235
v_sub_f32 v141, v141, v235
v_sub_f32 v157, v157, v235
v_sub_f32 v206, v206, v235
v_sub_f32 v142, v142, v235
v_sub_f32 v158, v158, v235
v_sub_f32 v207, v207, v235
v_sub_f32 v143, v143, v235
v_sub_f32 v159, v159, v235
v_lshlrev_b32 v242, 16, v172
v_and_b32 v243, 0xffff0000, v172
v_mul_f32 v242, v242, v239
v_mul_f32 v243, v243, v239
v_cvt_pk_bf16_f32 v172, v242, v243
v_lshlrev_b32 v242, 16, v173
v_and_b32 v243, 0xffff0000, v173
v_mul_f32 v242, v242, v239
v_mul_f32 v243, v243, v239
v_cvt_pk_bf16_f32 v173, v242, v243
v_lshlrev_b32 v242, 16, v174
v_and_b32 v243, 0xffff0000, v174
v_mul_f32 v242, v242, v239
v_mul_f32 v243, v243, v239
v_cvt_pk_bf16_f32 v174, v242, v243
v_lshlrev_b32 v242, 16, v175
v_and_b32 v243, 0xffff0000, v175
v_mul_f32 v242, v242, v239
v_mul_f32 v243, v243, v239
v_cvt_pk_bf16_f32 v175, v242, v243
v_lshlrev_b32 v242, 16, v188
v_and_b32 v243, 0xffff0000, v188
v_mul_f32 v242, v242, v239
v_mul_f32 v243, v243, v239
v_cvt_pk_bf16_f32 v188, v242, v243
v_lshlrev_b32 v242, 16, v189
v_and_b32 v243, 0xffff0000, v189
v_mul_f32 v242, v242, v239
v_mul_f32 v243, v243, v239
v_cvt_pk_bf16_f32 v189, v242, v243
v_exp_f32 v232, v144
v_exp_f32 v233, v145
v_exp_f32 v234, v146
v_exp_f32 v235, v147
s_nop 1
v_add_f32 v224, v228, v232
v_add_f32 v224, v224, v233
v_add_f32 v224, v224, v234
v_add_f32 v224, v224, v235
v_cvt_pk_bf16_f32 v178, v232, v233
v_cvt_pk_bf16_f32 v179, v234, v235
v_exp_f32 v232, v148
v_exp_f32 v233, v149
v_exp_f32 v234, v150
v_exp_f32 v235, v151
s_nop 1
v_add_f32 v225, v229, v232
v_add_f32 v225, v225, v233
v_add_f32 v225, v225, v234
v_add_f32 v225, v225, v235
v_cvt_pk_bf16_f32 v182, v232, v233
v_cvt_pk_bf16_f32 v183, v234, v235
v_exp_f32 v232, v152
v_exp_f32 v233, v153
v_exp_f32 v234, v154
v_exp_f32 v235, v155
s_nop 1
v_add_f32 v226, v230, v232
v_add_f32 v226, v226, v233
v_add_f32 v226, v226, v234
v_add_f32 v226, v226, v235
v_cvt_pk_bf16_f32 v186, v232, v233
v_cvt_pk_bf16_f32 v187, v234, v235
v_exp_f32 v232, v156
v_exp_f32 v233, v157
v_exp_f32 v234, v158
v_exp_f32 v235, v159
s_nop 1
v_add_f32 v227, v231, v232
v_add_f32 v227, v227, v233
v_add_f32 v227, v227, v234
v_add_f32 v227, v227, v235
v_cvt_pk_bf16_f32 v190, v232, v233
v_cvt_pk_bf16_f32 v191, v234, v235
s_branch L2_rare_common
L2_rare_site2:
s_mov_b32 s36, 2
s_branch L2_rare_1_0
L2_rare_1_0:
s_nop 15
s_nop 15
s_waitcnt lgkmcnt(0)
v_log_f32 v243, v224
v_max3_f32 v232, v128, v129, v130
v_max3_f32 v232, v232, v131, v243
v_mov_b32 v243, v232
s_nop 1
v_permlane32_swap_b32 v232, v243
s_nop 1
v_max_f32 v232, v232, v243
v_mov_b32 v243, v232
s_nop 1
v_permlane16_swap_b32 v232, v243
s_nop 1
v_max_f32 v232, v232, v243
v_ceil_f32 v232, v232
v_max_f32 v232, 0, v232
v_sub_f32 v243, 0, v232
v_exp_f32 v236, v243
s_nop 1
v_mul_f32 v224, v224, v236
v_add_f32 v244, v244, v232
v_sub_f32 v192, v192, v232
v_sub_f32 v128, v128, v232
v_sub_f32 v144, v144, v232
v_sub_f32 v193, v193, v232
v_sub_f32 v129, v129, v232
v_sub_f32 v145, v145, v232
v_sub_f32 v194, v194, v232
v_sub_f32 v130, v130, v232
v_sub_f32 v146, v146, v232
v_sub_f32 v195, v195, v232
v_sub_f32 v131, v131, v232
v_sub_f32 v147, v147, v232
v_lshlrev_b32 v242, 16, v176
v_and_b32 v243, 0xffff0000, v176
v_mul_f32 v242, v242, v236
v_mul_f32 v243, v243, v236
v_cvt_pk_bf16_f32 v176, v242, v243
v_lshlrev_b32 v242, 16, v177
v_and_b32 v243, 0xffff0000, v177
v_mul_f32 v242, v242, v236
v_mul_f32 v243, v243, v236
v_cvt_pk_bf16_f32 v177, v242, v243
v_lshlrev_b32 v242, 16, v178
v_and_b32 v243, 0xffff0000, v178
v_mul_f32 v242, v242, v236
v_mul_f32 v243, v243, v236
v_cvt_pk_bf16_f32 v178, v242, v243
v_lshlrev_b32 v242, 16, v179
v_and_b32 v243, 0xffff0000, v179
v_mul_f32 v242, v242, v236
v_mul_f32 v243, v243, v236
v_cvt_pk_bf16_f32 v179, v242, v243
v_log_f32 v243, v225
v_max3_f32 v233, v132, v133, v134
v_max3_f32 v233, v233, v135, v243
v_mov_b32 v243, v233
s_nop 1
v_permlane32_swap_b32 v233, v243
s_nop 1
v_max_f32 v233, v233, v243
v_mov_b32 v243, v233
s_nop 1
v_permlane16_swap_b32 v233, v243
s_nop 1
v_max_f32 v233, v233, v243
v_ceil_f32 v233, v233
v_max_f32 v233, 0, v233
v_sub_f32 v243, 0, v233
v_exp_f32 v237, v243
s_nop 1
v_mul_f32 v225, v225, v237
v_add_f32 v245, v245, v233
v_sub_f32 v196, v196, v233
v_sub_f32 v132, v132, v233
v_sub_f32 v148, v148, v233
v_sub_f32 v197, v197, v233
v_sub_f32 v133, v133, v233
v_sub_f32 v149, v149, v233
v_sub_f32 v198, v198, v233
v_sub_f32 v134, v134, v233
v_sub_f32 v150, v150, v233
v_sub_f32 v199, v199, v233
v_sub_f32 v135, v135, v233
v_sub_f32 v151, v151, v233
v_lshlrev_b32 v242, 16, v180
v_and_b32 v243, 0xffff0000, v180
v_mul_f32 v242, v242, v237
v_mul_f32 v243, v243, v237
v_cvt_pk_bf16_f32 v180, v242, v243
v_lshlrev_b32 v242, 16, v181
v_and_b32 v243, 0xffff0000, v181
v_mul_f32 v242, v242, v237
v_mul_f32 v243, v243, v237
v_cvt_pk_bf16_f32 v181, v242, v243
v_lshlrev_b32 v242, 16, v182
v_and_b32 v243, 0xffff0000, v182
v_mul_f32 v242, v242, v237
v_mul_f32 v243, v243, v237
v_cvt_pk_bf16_f32 v182, v242, v243
v_lshlrev_b32 v242, 16, v183
v_and_b32 v243, 0xffff0000, v183
v_mul_f32 v242, v242, v237
v_mul_f32 v243, v243, v237
v_cvt_pk_bf16_f32 v183, v242, v243
v_log_f32 v243, v226
v_max3_f32 v234, v136, v137, v138
v_max3_f32 v234, v234, v139, v243
v_mov_b32 v243, v234
s_nop 1
v_permlane32_swap_b32 v234, v243
s_nop 1
v_max_f32 v234, v234, v243
v_mov_b32 v243, v234
s_nop 1
v_permlane16_swap_b32 v234, v243
s_nop 1
v_max_f32 v234, v234, v243
v_ceil_f32 v234, v234
v_max_f32 v234, 0, v234
v_sub_f32 v243, 0, v234
v_exp_f32 v238, v243
s_nop 1
v_mul_f32 v226, v226, v238
v_add_f32 v246, v246, v234
v_sub_f32 v200, v200, v234
v_sub_f32 v136, v136, v234
v_sub_f32 v152, v152, v234
v_sub_f32 v201, v201, v234
v_sub_f32 v137, v137, v234
v_sub_f32 v153, v153, v234
v_sub_f32 v202, v202, v234
v_sub_f32 v138, v138, v234
v_sub_f32 v154, v154, v234
v_sub_f32 v203, v203, v234
v_sub_f32 v139, v139, v234
v_sub_f32 v155, v155, v234
v_lshlrev_b32 v242, 16, v184
v_and_b32 v243, 0xffff0000, v184
v_mul_f32 v242, v242, v238
v_mul_f32 v243, v243, v238
v_cvt_pk_bf16_f32 v184, v242, v243
v_lshlrev_b32 v242, 16, v185
v_and_b32 v243, 0xffff0000, v185
v_mul_f32 v242, v242, v238
v_mul_f32 v243, v243, v238
v_cvt_pk_bf16_f32 v185, v242, v243
v_lshlrev_b32 v242, 16, v186
v_and_b32 v243, 0xffff0000, v186
v_mul_f32 v242, v242, v238
v_mul_f32 v243, v243, v238
v_cvt_pk_bf16_f32 v186, v242, v243
v_lshlrev_b32 v242, 16, v187
v_and_b32 v243, 0xffff0000, v187
v_mul_f32 v242, v242, v238
v_mul_f32 v243, v243, v238
v_cvt_pk_bf16_f32 v187, v242, v243
v_log_f32 v243, v227
v_max3_f32 v235, v140, v141, v142
v_max3_f32 v235, v235, v143, v243
v_mov_b32 v243, v235
s_nop 1
v_permlane32_swap_b32 v235, v243
s_nop 1
v_max_f32 v235, v235, v243
v_mov_b32 v243, v235
s_nop 1
v_permlane16_swap_b32 v235, v243
s_nop 1
v_max_f32 v235, v235, v243
v_ceil_f32 v235, v235
v_max_f32 v235, 0, v235
v_sub_f32 v243, 0, v235
v_exp_f32 v239, v243
s_nop 1
v_mul_f32 v227, v227, v239
v_add_f32 v247, v247, v235
v_sub_f32 v204, v204, v235
v_sub_f32 v140, v140, v235
v_sub_f32 v156, v156, v235
v_sub_f32 v205, v205, v235
v_sub_f32 v141, v141, v235
v_sub_f32 v157, v157, v235
v_sub_f32 v206, v206, v235
v_sub_f32 v142, v142, v235
v_sub_f32 v158, v158, v235
v_sub_f32 v207, v207, v235
v_sub_f32 v143, v143, v235
v_sub_f32 v159, v159, v235
v_lshlrev_b32 v242, 16, v188
v_and_b32 v243, 0xffff0000, v188
v_mul_f32 v242, v242, v239
v_mul_f32 v243, v243, v239
v_cvt_pk_bf16_f32 v188, v242, v243
v_lshlrev_b32 v242, 16, v189
v_and_b32 v243, 0xffff0000, v189
v_mul_f32 v242, v242, v239
v_mul_f32 v243, v243, v239
v_cvt_pk_bf16_f32 v189, v242, v243
v_lshlrev_b32 v242, 16, v190
v_and_b32 v243, 0xffff0000, v190
v_mul_f32 v242, v242, v239
v_mul_f32 v243, v243, v239
v_cvt_pk_bf16_f32 v190, v242, v243
v_lshlrev_b32 v242, 16, v191
v_and_b32 v243, 0xffff0000, v191
v_mul_f32 v242, v242, v239
v_mul_f32 v243, v243, v239
v_cvt_pk_bf16_f32 v191, v242, v243
v_exp_f32 v232, v128
v_exp_f32 v233, v129
v_exp_f32 v234, v130
v_exp_f32 v235, v131
s_nop 1
v_add_f32 v228, v224, v232
v_add_f32 v228, v228, v233
v_add_f32 v228, v228, v234
v_add_f32 v228, v228, v235
v_cvt_pk_bf16_f32 v160, v232, v233
v_cvt_pk_bf16_f32 v161, v234, v235
v_exp_f32 v232, v132
v_exp_f32 v233, v133
v_exp_f32 v234, v134
v_exp_f32 v235, v135
s_nop 1
v_add_f32 v229, v225, v232
v_add_f32 v229, v229, v233
v_add_f32 v229, v229, v234
v_add_f32 v229, v229, v235
v_cvt_pk_bf16_f32 v164, v232, v233
v_cvt_pk_bf16_f32 v165, v234, v235
v_exp_f32 v232, v136
v_exp_f32 v233, v137
v_exp_f32 v234, v138
v_exp_f32 v235, v139
s_nop 1
v_add_f32 v230, v226, v232
v_add_f32 v230, v230, v233
v_add_f32 v230, v230, v234
v_add_f32 v230, v230, v235
v_cvt_pk_bf16_f32 v168, v232, v233
v_cvt_pk_bf16_f32 v169, v234, v235
v_exp_f32 v232, v140
v_exp_f32 v233, v141
v_exp_f32 v234, v142
v_exp_f32 v235, v143
s_nop 1
v_add_f32 v231, v227, v232
v_add_f32 v231, v231, v233
v_add_f32 v231, v231, v234
v_add_f32 v231, v231, v235
v_cvt_pk_bf16_f32 v172, v232, v233
v_cvt_pk_bf16_f32 v173, v234, v235
s_branch L2_rare_common
L2_rare_site3:
s_mov_b32 s36, 3
s_branch L2_rare_1_1
L2_rare_1_1:
s_nop 15
s_nop 15
s_waitcnt lgkmcnt(0)
v_log_f32 v243, v228
v_max3_f32 v232, v144, v145, v146
v_max3_f32 v232, v232, v147, v243
v_mov_b32 v243, v232
s_nop 1
v_permlane32_swap_b32 v232, v243
s_nop 1
v_max_f32 v232, v232, v243
v_mov_b32 v243, v232
s_nop 1
v_permlane16_swap_b32 v232, v243
s_nop 1
v_max_f32 v232, v232, v243
v_ceil_f32 v232, v232
v_max_f32 v232, 0, v232
v_sub_f32 v243, 0, v232
v_exp_f32 v236, v243
s_nop 1
v_mul_f32 v228, v228, v236
v_add_f32 v244, v244, v232
v_sub_f32 v192, v192, v232
v_sub_f32 v128, v128, v232
v_sub_f32 v144, v144, v232
v_sub_f32 v193, v193, v232
v_sub_f32 v129, v129, v232
v_sub_f32 v145, v145, v232
v_sub_f32 v194, v194, v232
v_sub_f32 v130, v130, v232
v_sub_f32 v146, v146, v232
v_sub_f32 v195, v195, v232
v_sub_f32 v131, v131, v232
v_sub_f32 v147, v147, v232
v_lshlrev_b32 v242, 16, v176
v_and_b32 v243, 0xffff0000, v176
v_mul_f32 v242, v242, v236
v_mul_f32 v243, v243, v236
v_cvt_pk_bf16_f32 v176, v242, v243
v_lshlrev_b32 v242, 16, v177
v_and_b32 v243, 0xffff0000, v177
v_mul_f32 v242, v242, v236
v_mul_f32 v243, v243, v236
v_cvt_pk_bf16_f32 v177, v242, v243
v_lshlrev_b32 v242, 16, v178
v_and_b32 v243, 0xffff0000, v178
v_mul_f32 v242, v242, v236
v_mul_f32 v243, v243, v236
v_cvt_pk_bf16_f32 v178, v242, v243
v_lshlrev_b32 v242, 16, v179
v_and_b32 v243, 0xffff0000, v179
v_mul_f32 v242, v242, v236
v_mul_f32 v243, v243, v236
v_cvt_pk_bf16_f32 v179, v242, v243
v_lshlrev_b32 v242, 16, v160
v_and_b32 v243, 0xffff0000, v160
v_mul_f32 v242, v242, v236
v_mul_f32 v243, v243, v236
v_cvt_pk_bf16_f32 v160, v242, v243
v_lshlrev_b32 v242, 16, v161
v_and_b32 v243, 0xffff0000, v161
v_mul_f32 v242, v242, v236
v_mul_f32 v243, v243, v236
v_cvt_pk_bf16_f32 v161, v242, v243
v_log_f32 v243, v229
v_max3_f32 v233, v148, v149, v150
v_max3_f32 v233, v233, v151, v243
v_mov_b32 v243, v233
s_nop 1
v_permlane32_swap_b32 v233, v243
s_nop 1
v_max_f32 v233, v233, v243
v_mov_b32 v243, v233
s_nop 1
v_permlane16_swap_b32 v233, v243
s_nop 1
v_max_f32 v233, v233, v243
v_ceil_f32 v233, v233
v_max_f32 v233, 0, v233
v_sub_f32 v243, 0, v233
v_exp_f32 v237, v243
s_nop 1
v_mul_f32 v229, v229, v237
v_add_f32 v245, v245, v233
v_sub_f32 v196, v196, v233
v_sub_f32 v132, v132, v233
v_sub_f32 v148, v148, v233
v_sub_f32 v197, v197, v233
v_sub_f32 v133, v133, v233
v_sub_f32 v149, v149, v233
v_sub_f32 v198, v198, v233
v_sub_f32 v134, v134, v233
v_sub_f32 v150, v150, v233
v_sub_f32 v199, v199, v233
v_sub_f32 v135, v135, v233
v_sub_f32 v151, v151, v233
v_lshlrev_b32 v242, 16, v180
v_and_b32 v243, 0xffff0000, v180
v_mul_f32 v242, v242, v237
v_mul_f32 v243, v243, v237
v_cvt_pk_bf16_f32 v180, v242, v243
v_lshlrev_b32 v242, 16, v181
v_and_b32 v243, 0xffff0000, v181
v_mul_f32 v242, v242, v237
v_mul_f32 v243, v243, v237
v_cvt_pk_bf16_f32 v181, v242, v243
v_lshlrev_b32 v242, 16, v182
v_and_b32 v243, 0xffff0000, v182
v_mul_f32 v242, v242, v237
v_mul_f32 v243, v243, v237
v_cvt_pk_bf16_f32 v182, v242, v243
v_lshlrev_b32 v242, 16, v183
v_and_b32 v243, 0xffff0000, v183
v_mul_f32 v242, v242, v237
v_mul_f32 v243, v243, v237
v_cvt_pk_bf16_f32 v183, v242, v243
v_lshlrev_b32 v242, 16, v164
v_and_b32 v243, 0xffff0000, v164
v_mul_f32 v242, v242, v237
v_mul_f32 v243, v243, v237
v_cvt_pk_bf16_f32 v164, v242, v243
v_lshlrev_b32 v242, 16, v165
v_and_b32 v243, 0xffff0000, v165
v_mul_f32 v242, v242, v237
v_mul_f32 v243, v243, v237
v_cvt_pk_bf16_f32 v165, v242, v243
v_log_f32 v243, v230
v_max3_f32 v234, v152, v153, v154
v_max3_f32 v234, v234, v155, v243
v_mov_b32 v243, v234
s_nop 1
v_permlane32_swap_b32 v234, v243
s_nop 1
v_max_f32 v234, v234, v243
v_mov_b32 v243, v234
s_nop 1
v_permlane16_swap_b32 v234, v243
s_nop 1
v_max_f32 v234, v234, v243
v_ceil_f32 v234, v234
v_max_f32 v234, 0, v234
v_sub_f32 v243, 0, v234
v_exp_f32 v238, v243
s_nop 1
v_mul_f32 v230, v230, v238
v_add_f32 v246, v246, v234
v_sub_f32 v200, v200, v234
v_sub_f32 v136, v136, v234
v_sub_f32 v152, v152, v234
v_sub_f32 v201, v201, v234
v_sub_f32 v137, v137, v234
v_sub_f32 v153, v153, v234
v_sub_f32 v202, v202, v234
v_sub_f32 v138, v138, v234
v_sub_f32 v154, v154, v234
v_sub_f32 v203, v203, v234
v_sub_f32 v139, v139, v234
v_sub_f32 v155, v155, v234
v_lshlrev_b32 v242, 16, v184
v_and_b32 v243, 0xffff0000, v184
v_mul_f32 v242, v242, v238
v_mul_f32 v243, v243, v238
v_cvt_pk_bf16_f32 v184, v242, v243
v_lshlrev_b32 v242, 16, v185
v_and_b32 v243, 0xffff0000, v185
v_mul_f32 v242, v242, v238
v_mul_f32 v243, v243, v238
v_cvt_pk_bf16_f32 v185, v242, v243
v_lshlrev_b32 v242, 16, v186
v_and_b32 v243, 0xffff0000, v186
v_mul_f32 v242, v242, v238
v_mul_f32 v243, v243, v238
v_cvt_pk_bf16_f32 v186, v242, v243
v_lshlrev_b32 v242, 16, v187
v_and_b32 v243, 0xffff0000, v187
v_mul_f32 v242, v242, v238
v_mul_f32 v243, v243, v238
v_cvt_pk_bf16_f32 v187, v242, v243
v_lshlrev_b32 v242, 16, v168
v_and_b32 v243, 0xffff0000, v168
v_mul_f32 v242, v242, v238
v_mul_f32 v243, v243, v238
v_cvt_pk_bf16_f32 v168, v242, v243
v_lshlrev_b32 v242, 16, v169
v_and_b32 v243, 0xffff0000, v169
v_mul_f32 v242, v242, v238
v_mul_f32 v243, v243, v238
v_cvt_pk_bf16_f32 v169, v242, v243
v_log_f32 v243, v231
v_max3_f32 v235, v156, v157, v158
v_max3_f32 v235, v235, v159, v243
v_mov_b32 v243, v235
s_nop 1
v_permlane32_swap_b32 v235, v243
s_nop 1
v_max_f32 v235, v235, v243
v_mov_b32 v243, v235
s_nop 1
v_permlane16_swap_b32 v235, v243
s_nop 1
v_max_f32 v235, v235, v243
v_ceil_f32 v235, v235
v_max_f32 v235, 0, v235
v_sub_f32 v243, 0, v235
v_exp_f32 v239, v243
s_nop 1
v_mul_f32 v231, v231, v239
v_add_f32 v247, v247, v235
v_sub_f32 v204, v204, v235
v_sub_f32 v140, v140, v235
v_sub_f32 v156, v156, v235
v_sub_f32 v205, v205, v235
v_sub_f32 v141, v141, v235
v_sub_f32 v157, v157, v235
v_sub_f32 v206, v206, v235
v_sub_f32 v142, v142, v235
v_sub_f32 v158, v158, v235
v_sub_f32 v207, v207, v235
v_sub_f32 v143, v143, v235
v_sub_f32 v159, v159, v235
v_lshlrev_b32 v242, 16, v188
v_and_b32 v243, 0xffff0000, v188
v_mul_f32 v242, v242, v239
v_mul_f32 v243, v243, v239
v_cvt_pk_bf16_f32 v188, v242, v243
v_lshlrev_b32 v242, 16, v189
v_and_b32 v243, 0xffff0000, v189
v_mul_f32 v242, v242, v239
v_mul_f32 v243, v243, v239
v_cvt_pk_bf16_f32 v189, v242, v243
v_lshlrev_b32 v242, 16, v190
v_and_b32 v243, 0xffff0000, v190
v_mul_f32 v242, v242, v239
v_mul_f32 v243, v243, v239
v_cvt_pk_bf16_f32 v190, v242, v243
v_lshlrev_b32 v242, 16, v191
v_and_b32 v243, 0xffff0000, v191
v_mul_f32 v242, v242, v239
v_mul_f32 v243, v243, v239
v_cvt_pk_bf16_f32 v191, v242, v243
v_lshlrev_b32 v242, 16, v172
v_and_b32 v243, 0xffff0000, v172
v_mul_f32 v242, v242, v239
v_mul_f32 v243, v243, v239
v_cvt_pk_bf16_f32 v172, v242, v243
v_lshlrev_b32 v242, 16, v173
v_and_b32 v243, 0xffff0000, v173
v_mul_f32 v242, v242, v239
v_mul_f32 v243, v243, v239
v_cvt_pk_bf16_f32 v173, v242, v243
v_exp_f32 v232, v144
v_exp_f32 v233, v145
v_exp_f32 v234, v146
v_exp_f32 v235, v147
s_nop 1
v_add_f32 v224, v228, v232
v_add_f32 v224, v224, v233
v_add_f32 v224, v224, v234
v_add_f32 v224, v224, v235
v_cvt_pk_bf16_f32 v162, v232, v233
v_cvt_pk_bf16_f32 v163, v234, v235
v_exp_f32 v232, v148
v_exp_f32 v233, v149
v_exp_f32 v234, v150
v_exp_f32 v235, v151
s_nop 1
v_add_f32 v225, v229, v232
v_add_f32 v225, v225, v233
v_add_f32 v225, v225, v234
v_add_f32 v225, v225, v235
v_cvt_pk_bf16_f32 v166, v232, v233
v_cvt_pk_bf16_f32 v167, v234, v235
v_exp_f32 v232, v152
v_exp_f32 v233, v153
v_exp_f32 v234, v154
v_exp_f32 v235, v155
s_nop 1
v_add_f32 v226, v230, v232
v_add_f32 v226, v226, v233
v_add_f32 v226, v226, v234
v_add_f32 v226, v226, v235
v_cvt_pk_bf16_f32 v170, v232, v233
v_cvt_pk_bf16_f32 v171, v234, v235
v_exp_f32 v232, v156
v_exp_f32 v233, v157
v_exp_f32 v234, v158
v_exp_f32 v235, v159
s_nop 1
v_add_f32 v227, v231, v232
v_add_f32 v227, v227, v233
v_add_f32 v227, v227, v234
v_add_f32 v227, v227, v235
v_cvt_pk_bf16_f32 v174, v232, v233
v_cvt_pk_bf16_f32 v175, v234, v235
s_branch L2_rare_common
L2_rare_site4:
s_mov_b32 s36, 4
s_branch L2_rare_t0_0_0
L2_rare_t0_0_0:
s_nop 15
s_nop 15
s_waitcnt lgkmcnt(0)
v_log_f32 v243, v224
v_max3_f32 v232, v128, v129, v130
v_max3_f32 v232, v232, v131, v243
v_mov_b32 v243, v232
s_nop 1
v_permlane32_swap_b32 v232, v243
s_nop 1
v_max_f32 v232, v232, v243
v_mov_b32 v243, v232
s_nop 1
v_permlane16_swap_b32 v232, v243
s_nop 1
v_max_f32 v232, v232, v243
v_ceil_f32 v232, v232
v_max_f32 v232, 0, v232
v_sub_f32 v243, 0, v232
v_exp_f32 v236, v243
s_nop 1
v_mul_f32 v224, v224, v236
v_add_f32 v244, v244, v232
v_sub_f32 v192, v192, v232
v_sub_f32 v128, v128, v232
v_sub_f32 v144, v144, v232
v_sub_f32 v193, v193, v232
v_sub_f32 v129, v129, v232
v_sub_f32 v145, v145, v232
v_sub_f32 v194, v194, v232
v_sub_f32 v130, v130, v232
v_sub_f32 v146, v146, v232
v_sub_f32 v195, v195, v232
v_sub_f32 v131, v131, v232
v_sub_f32 v147, v147, v232
ds_read_b64 v[254:255], v253 offset:0
s_waitcnt lgkmcnt(0)
v_lshlrev_b32 v242, 16, v254
v_and_b32 v243, 0xffff0000, v254
v_mul_f32 v242, v242, v236
v_mul_f32 v243, v243, v236
v_cvt_pk_bf16_f32 v254, v242, v243
v_lshlrev_b32 v242, 16, v255
v_and_b32 v243, 0xffff0000, v255
v_mul_f32 v242, v242, v236
v_mul_f32 v243, v243, v236
v_cvt_pk_bf16_f32 v255, v242, v243
ds_write_b64 v253, v[254:255] offset:0
s_waitcnt lgkmcnt(0)
ds_read_b64 v[254:255], v253 offset:8
s_waitcnt lgkmcnt(0)
v_lshlrev_b32 v242, 16, v254
v_and_b32 v243, 0xffff0000, v254
v_mul_f32 v242, v242, v236
v_mul_f32 v243, v243, v236
v_cvt_pk_bf16_f32 v254, v242, v243
v_lshlrev_b32 v242, 16, v255
v_and_b32 v243, 0xffff0000, v255
v_mul_f32 v242, v242, v236
v_mul_f32 v243, v243, v236
v_cvt_pk_bf16_f32 v255, v242, v243
ds_write_b64 v253, v[254:255] offset:8
s_waitcnt lgkmcnt(0)
v_log_f32 v243, v225
v_max3_f32 v233, v132, v133, v134
v_max3_f32 v233, v233, v135, v243
v_mov_b32 v243, v233
s_nop 1
v_permlane32_swap_b32 v233, v243
s_nop 1
v_max_f32 v233, v233, v243
v_mov_b32 v243, v233
s_nop 1
v_permlane16_swap_b32 v233, v243
s_nop 1
v_max_f32 v233, v233, v243
v_ceil_f32 v233, v233
v_max_f32 v233, 0, v233
v_sub_f32 v243, 0, v233
v_exp_f32 v237, v243
s_nop 1
v_mul_f32 v225, v225, v237
v_add_f32 v245, v245, v233
v_sub_f32 v196, v196, v233
v_sub_f32 v132, v132, v233
v_sub_f32 v148, v148, v233
v_sub_f32 v197, v197, v233
v_sub_f32 v133, v133, v233
v_sub_f32 v149, v149, v233
v_sub_f32 v198, v198, v233
v_sub_f32 v134, v134, v233
v_sub_f32 v150, v150, v233
v_sub_f32 v199, v199, v233
v_sub_f32 v135, v135, v233
v_sub_f32 v151, v151, v233
ds_read_b64 v[254:255], v253 offset:1024
s_waitcnt lgkmcnt(0)
v_lshlrev_b32 v242, 16, v254
v_and_b32 v243, 0xffff0000, v254
v_mul_f32 v242, v242, v237
v_mul_f32 v243, v243, v237
v_cvt_pk_bf16_f32 v254, v242, v243
v_lshlrev_b32 v242, 16, v255
v_and_b32 v243, 0xffff0000, v255
v_mul_f32 v242, v242, v237
v_mul_f32 v243, v243, v237
v_cvt_pk_bf16_f32 v255, v242, v243
ds_write_b64 v253, v[254:255] offset:1024
s_waitcnt lgkmcnt(0)
ds_read_b64 v[254:255], v253 offset:1032
s_waitcnt lgkmcnt(0)
v_lshlrev_b32 v242, 16, v254
v_and_b32 v243, 0xffff0000, v254
v_mul_f32 v242, v242, v237
v_mul_f32 v243, v243, v237
v_cvt_pk_bf16_f32 v254, v242, v243
v_lshlrev_b32 v242, 16, v255
v_and_b32 v243, 0xffff0000, v255
v_mul_f32 v242, v242, v237
v_mul_f32 v243, v243, v237
v_cvt_pk_bf16_f32 v255, v242, v243
ds_write_b64 v253, v[254:255] offset:1032
s_waitcnt lgkmcnt(0)
v_log_f32 v243, v226
v_max3_f32 v234, v136, v137, v138
v_max3_f32 v234, v234, v139, v243
v_mov_b32 v243, v234
s_nop 1
v_permlane32_swap_b32 v234, v243
s_nop 1
v_max_f32 v234, v234, v243
v_mov_b32 v243, v234
s_nop 1
v_permlane16_swap_b32 v234, v243
s_nop 1
v_max_f32 v234, v234, v243
v_ceil_f32 v234, v234
v_max_f32 v234, 0, v234
v_sub_f32 v243, 0, v234
v_exp_f32 v238, v243
s_nop 1
v_mul_f32 v226, v226, v238
v_add_f32 v246, v246, v234
v_sub_f32 v200, v200, v234
v_sub_f32 v136, v136, v234
v_sub_f32 v152, v152, v234
v_sub_f32 v201, v201, v234
v_sub_f32 v137, v137, v234
v_sub_f32 v153, v153, v234
v_sub_f32 v202, v202, v234
v_sub_f32 v138, v138, v234
v_sub_f32 v154, v154, v234
v_sub_f32 v203, v203, v234
v_sub_f32 v139, v139, v234
v_sub_f32 v155, v155, v234
ds_read_b64 v[254:255], v253 offset:2048
s_waitcnt lgkmcnt(0)
v_lshlrev_b32 v242, 16, v254
v_and_b32 v243, 0xffff0000, v254
v_mul_f32 v242, v242, v238
v_mul_f32 v243, v243, v238
v_cvt_pk_bf16_f32 v254, v242, v243
v_lshlrev_b32 v242, 16, v255
v_and_b32 v243, 0xffff0000, v255
v_mul_f32 v242, v242, v238
v_mul_f32 v243, v243, v238
v_cvt_pk_bf16_f32 v255, v242, v243
ds_write_b64 v253, v[254:255] offset:2048
s_waitcnt lgkmcnt(0)
ds_read_b64 v[254:255], v253 offset:2056
s_waitcnt lgkmcnt(0)
v_lshlrev_b32 v242, 16, v254
v_and_b32 v243, 0xffff0000, v254
v_mul_f32 v242, v242, v238
v_mul_f32 v243, v243, v238
v_cvt_pk_bf16_f32 v254, v242, v243
v_lshlrev_b32 v242, 16, v255
v_and_b32 v243, 0xffff0000, v255
v_mul_f32 v242, v242, v238
v_mul_f32 v243, v243, v238
v_cvt_pk_bf16_f32 v255, v242, v243
ds_write_b64 v253, v[254:255] offset:2056
s_waitcnt lgkmcnt(0)
v_log_f32 v243, v227
v_max3_f32 v235, v140, v141, v142
v_max3_f32 v235, v235, v143, v243
v_mov_b32 v243, v235
s_nop 1
v_permlane32_swap_b32 v235, v243
s_nop 1
v_max_f32 v235, v235, v243
v_mov_b32 v243, v235
s_nop 1
v_permlane16_swap_b32 v235, v243
s_nop 1
v_max_f32 v235, v235, v243
v_ceil_f32 v235, v235
v_max_f32 v235, 0, v235
v_sub_f32 v243, 0, v235
v_exp_f32 v239, v243
s_nop 1
v_mul_f32 v227, v227, v239
v_add_f32 v247, v247, v235
v_sub_f32 v204, v204, v235
v_sub_f32 v140, v140, v235
v_sub_f32 v156, v156, v235
v_sub_f32 v205, v205, v235
v_sub_f32 v141, v141, v235
v_sub_f32 v157, v157, v235
v_sub_f32 v206, v206, v235
v_sub_f32 v142, v142, v235
v_sub_f32 v158, v158, v235
v_sub_f32 v207, v207, v235
v_sub_f32 v143, v143, v235
v_sub_f32 v159, v159, v235
ds_read_b64 v[254:255], v253 offset:3072
s_waitcnt lgkmcnt(0)
v_lshlrev_b32 v242, 16, v254
v_and_b32 v243, 0xffff0000, v254
v_mul_f32 v242, v242, v239
v_mul_f32 v243, v243, v239
v_cvt_pk_bf16_f32 v254, v242, v243
v_lshlrev_b32 v242, 16, v255
v_and_b32 v243, 0xffff0000, v255
v_mul_f32 v242, v242, v239
v_mul_f32 v243, v243, v239
v_cvt_pk_bf16_f32 v255, v242, v243
ds_write_b64 v253, v[254:255] offset:3072
s_waitcnt lgkmcnt(0)
ds_read_b64 v[254:255], v253 offset:3080
s_waitcnt lgkmcnt(0)
v_lshlrev_b32 v242, 16, v254
v_and_b32 v243, 0xffff0000, v254
v_mul_f32 v242, v242, v239
v_mul_f32 v243, v243, v239
v_cvt_pk_bf16_f32 v254, v242, v243
v_lshlrev_b32 v242, 16, v255
v_and_b32 v243, 0xffff0000, v255
v_mul_f32 v242, v242, v239
v_mul_f32 v243, v243, v239
v_cvt_pk_bf16_f32 v255, v242, v243
ds_write_b64 v253, v[254:255] offset:3080
s_waitcnt lgkmcnt(0)
v_exp_f32 v232, v128
v_exp_f32 v233, v129
v_exp_f32 v234, v130
v_exp_f32 v235, v131
s_nop 1
v_add_f32 v228, v224, v232
v_add_f32 v228, v228, v233
v_add_f32 v228, v228, v234
v_add_f32 v228, v228, v235
v_cvt_pk_bf16_f32 v176, v232, v233
v_cvt_pk_bf16_f32 v177, v234, v235
v_exp_f32 v232, v132
v_exp_f32 v233, v133
v_exp_f32 v234, v134
v_exp_f32 v235, v135
s_nop 1
v_add_f32 v229, v225, v232
v_add_f32 v229, v229, v233
v_add_f32 v229, v229, v234
v_add_f32 v229, v229, v235
v_cvt_pk_bf16_f32 v180, v232, v233
v_cvt_pk_bf16_f32 v181, v234, v235
v_exp_f32 v232, v136
v_exp_f32 v233, v137
v_exp_f32 v234, v138
v_exp_f32 v235, v139
s_nop 1
v_add_f32 v230, v226, v232
v_add_f32 v230, v230, v233
v_add_f32 v230, v230, v234
v_add_f32 v230, v230, v235
v_cvt_pk_bf16_f32 v184, v232, v233
v_cvt_pk_bf16_f32 v185, v234, v235
v_exp_f32 v232, v140
v_exp_f32 v233, v141
v_exp_f32 v234, v142
v_exp_f32 v235, v143
s_nop 1
v_add_f32 v231, v227, v232
v_add_f32 v231, v231, v233
v_add_f32 v231, v231, v234
v_add_f32 v231, v231, v235
v_cvt_pk_bf16_f32 v188, v232, v233
v_cvt_pk_bf16_f32 v189, v234, v235
s_branch L2_rare_common
L2_rare_site5:
s_mov_b32 s36, 5
s_branch L2_rare_t0_1_1
L2_rare_t0_1_1:
s_nop 15
s_nop 15
s_waitcnt lgkmcnt(0)
v_log_f32 v243, v228
v_max3_f32 v232, v144, v145, v146
v_max3_f32 v232, v232, v147, v243
v_mov_b32 v243, v232
s_nop 1
v_permlane32_swap_b32 v232, v243
s_nop 1
v_max_f32 v232, v232, v243
v_mov_b32 v243, v232
s_nop 1
v_permlane16_swap_b32 v232, v243
s_nop 1
v_max_f32 v232, v232, v243
v_ceil_f32 v232, v232
v_max_f32 v232, 0, v232
v_sub_f32 v243, 0, v232
v_exp_f32 v236, v243
s_nop 1
v_mul_f32 v228, v228, v236
v_add_f32 v244, v244, v232
v_sub_f32 v192, v192, v232
v_sub_f32 v128, v128, v232
v_sub_f32 v144, v144, v232
v_sub_f32 v193, v193, v232
v_sub_f32 v129, v129, v232
v_sub_f32 v145, v145, v232
v_sub_f32 v194, v194, v232
v_sub_f32 v130, v130, v232
v_sub_f32 v146, v146, v232
v_sub_f32 v195, v195, v232
v_sub_f32 v131, v131, v232
v_sub_f32 v147, v147, v232
v_lshlrev_b32 v242, 16, v176
v_and_b32 v243, 0xffff0000, v176
v_mul_f32 v242, v242, v236
v_mul_f32 v243, v243, v236
v_cvt_pk_bf16_f32 v176, v242, v243
v_lshlrev_b32 v242, 16, v177
v_and_b32 v243, 0xffff0000, v177
v_mul_f32 v242, v242, v236
v_mul_f32 v243, v243, v236
v_cvt_pk_bf16_f32 v177, v242, v243
ds_read_b64 v[254:255], v253 offset:0
s_waitcnt lgkmcnt(0)
v_lshlrev_b32 v242, 16, v254
v_and_b32 v243, 0xffff0000, v254
v_mul_f32 v242, v242, v236
v_mul_f32 v243, v243, v236
v_cvt_pk_bf16_f32 v254, v242, v243
v_lshlrev_b32 v242, 16, v255
v_and_b32 v243, 0xffff0000, v255
v_mul_f32 v242, v242, v236
v_mul_f32 v243, v243, v236
v_cvt_pk_bf16_f32 v255, v242, v243
ds_write_b64 v253, v[254:255] offset:0
s_waitcnt lgkmcnt(0)
ds_read_b64 v[254:255], v253 offset:8
s_waitcnt lgkmcnt(0)
v_lshlrev_b32 v242, 16, v254
v_and_b32 v243, 0xffff0000, v254
v_mul_f32 v242, v242, v236
v_mul_f32 v243, v243, v236
v_cvt_pk_bf16_f32 v254, v242, v243
v_lshlrev_b32 v242, 16, v255
v_and_b32 v243, 0xffff0000, v255
v_mul_f32 v242, v242, v236
v_mul_f32 v243, v243, v236
v_cvt_pk_bf16_f32 v255, v242, v243
ds_write_b64 v253, v[254:255] offset:8
s_waitcnt lgkmcnt(0)
v_log_f32 v243, v229
v_max3_f32 v233, v148, v149, v150
v_max3_f32 v233, v233, v151, v243
v_mov_b32 v243, v233
s_nop 1
v_permlane32_swap_b32 v233, v243
s_nop 1
v_max_f32 v233, v233, v243
v_mov_b32 v243, v233
s_nop 1
v_permlane16_swap_b32 v233, v243
s_nop 1
v_max_f32 v233, v233, v243
v_ceil_f32 v233, v233
v_max_f32 v233, 0, v233
v_sub_f32 v243, 0, v233
v_exp_f32 v237, v243
s_nop 1
v_mul_f32 v229, v229, v237
v_add_f32 v245, v245, v233
v_sub_f32 v196, v196, v233
v_sub_f32 v132, v132, v233
v_sub_f32 v148, v148, v233
v_sub_f32 v197, v197, v233
v_sub_f32 v133, v133, v233
v_sub_f32 v149, v149, v233
v_sub_f32 v198, v198, v233
v_sub_f32 v134, v134, v233
v_sub_f32 v150, v150, v233
v_sub_f32 v199, v199, v233
v_sub_f32 v135, v135, v233
v_sub_f32 v151, v151, v233
v_lshlrev_b32 v242, 16, v180
v_and_b32 v243, 0xffff0000, v180
v_mul_f32 v242, v242, v237
v_mul_f32 v243, v243, v237
v_cvt_pk_bf16_f32 v180, v242, v243
v_lshlrev_b32 v242, 16, v181
v_and_b32 v243, 0xffff0000, v181
v_mul_f32 v242, v242, v237
v_mul_f32 v243, v243, v237
v_cvt_pk_bf16_f32 v181, v242, v243
ds_read_b64 v[254:255], v253 offset:1024
s_waitcnt lgkmcnt(0)
v_lshlrev_b32 v242, 16, v254
v_and_b32 v243, 0xffff0000, v254
v_mul_f32 v242, v242, v237
v_mul_f32 v243, v243, v237
v_cvt_pk_bf16_f32 v254, v242, v243
v_lshlrev_b32 v242, 16, v255
v_and_b32 v243, 0xffff0000, v255
v_mul_f32 v242, v242, v237
v_mul_f32 v243, v243, v237
v_cvt_pk_bf16_f32 v255, v242, v243
ds_write_b64 v253, v[254:255] offset:1024
s_waitcnt lgkmcnt(0)
ds_read_b64 v[254:255], v253 offset:1032
s_waitcnt lgkmcnt(0)
v_lshlrev_b32 v242, 16, v254
v_and_b32 v243, 0xffff0000, v254
v_mul_f32 v242, v242, v237
v_mul_f32 v243, v243, v237
v_cvt_pk_bf16_f32 v254, v242, v243
v_lshlrev_b32 v242, 16, v255
v_and_b32 v243, 0xffff0000, v255
v_mul_f32 v242, v242, v237
v_mul_f32 v243, v243, v237
v_cvt_pk_bf16_f32 v255, v242, v243
ds_write_b64 v253, v[254:255] offset:1032
s_waitcnt lgkmcnt(0)
v_log_f32 v243, v230
v_max3_f32 v234, v152, v153, v154
v_max3_f32 v234, v234, v155, v243
v_mov_b32 v243, v234
s_nop 1
v_permlane32_swap_b32 v234, v243
s_nop 1
v_max_f32 v234, v234, v243
v_mov_b32 v243, v234
s_nop 1
v_permlane16_swap_b32 v234, v243
s_nop 1
v_max_f32 v234, v234, v243
v_ceil_f32 v234, v234
v_max_f32 v234, 0, v234
v_sub_f32 v243, 0, v234
v_exp_f32 v238, v243
s_nop 1
v_mul_f32 v230, v230, v238
v_add_f32 v246, v246, v234
v_sub_f32 v200, v200, v234
v_sub_f32 v136, v136, v234
v_sub_f32 v152, v152, v234
v_sub_f32 v201, v201, v234
v_sub_f32 v137, v137, v234
v_sub_f32 v153, v153, v234
v_sub_f32 v202, v202, v234
v_sub_f32 v138, v138, v234
v_sub_f32 v154, v154, v234
v_sub_f32 v203, v203, v234
v_sub_f32 v139, v139, v234
v_sub_f32 v155, v155, v234
v_lshlrev_b32 v242, 16, v184
v_and_b32 v243, 0xffff0000, v184
v_mul_f32 v242, v242, v238
v_mul_f32 v243, v243, v238
v_cvt_pk_bf16_f32 v184, v242, v243
v_lshlrev_b32 v242, 16, v185
v_and_b32 v243, 0xffff0000, v185
v_mul_f32 v242, v242, v238
v_mul_f32 v243, v243, v238
v_cvt_pk_bf16_f32 v185, v242, v243
ds_read_b64 v[254:255], v253 offset:2048
s_waitcnt lgkmcnt(0)
v_lshlrev_b32 v242, 16, v254
v_and_b32 v243, 0xffff0000, v254
v_mul_f32 v242, v242, v238
v_mul_f32 v243, v243, v238
v_cvt_pk_bf16_f32 v254, v242, v243
v_lshlrev_b32 v242, 16, v255
v_and_b32 v243, 0xffff0000, v255
v_mul_f32 v242, v242, v238
v_mul_f32 v243, v243, v238
v_cvt_pk_bf16_f32 v255, v242, v243
ds_write_b64 v253, v[254:255] offset:2048
s_waitcnt lgkmcnt(0)
ds_read_b64 v[254:255], v253 offset:2056
s_waitcnt lgkmcnt(0)
v_lshlrev_b32 v242, 16, v254
v_and_b32 v243, 0xffff0000, v254
v_mul_f32 v242, v242, v238
v_mul_f32 v243, v243, v238
v_cvt_pk_bf16_f32 v254, v242, v243
v_lshlrev_b32 v242, 16, v255
v_and_b32 v243, 0xffff0000, v255
v_mul_f32 v242, v242, v238
v_mul_f32 v243, v243, v238
v_cvt_pk_bf16_f32 v255, v242, v243
ds_write_b64 v253, v[254:255] offset:2056
s_waitcnt lgkmcnt(0)
v_log_f32 v243, v231
v_max3_f32 v235, v156, v157, v158
v_max3_f32 v235, v235, v159, v243
v_mov_b32 v243, v235
s_nop 1
v_permlane32_swap_b32 v235, v243
s_nop 1
v_max_f32 v235, v235, v243
v_mov_b32 v243, v235
s_nop 1
v_permlane16_swap_b32 v235, v243
s_nop 1
v_max_f32 v235, v235, v243
v_ceil_f32 v235, v235
v_max_f32 v235, 0, v235
v_sub_f32 v243, 0, v235
v_exp_f32 v239, v243
s_nop 1
v_mul_f32 v231, v231, v239
v_add_f32 v247, v247, v235
v_sub_f32 v204, v204, v235
v_sub_f32 v140, v140, v235
v_sub_f32 v156, v156, v235
v_sub_f32 v205, v205, v235
v_sub_f32 v141, v141, v235
v_sub_f32 v157, v157, v235
v_sub_f32 v206, v206, v235
v_sub_f32 v142, v142, v235
v_sub_f32 v158, v158, v235
v_sub_f32 v207, v207, v235
v_sub_f32 v143, v143, v235
v_sub_f32 v159, v159, v235
v_lshlrev_b32 v242, 16, v188
v_and_b32 v243, 0xffff0000, v188
v_mul_f32 v242, v242, v239
v_mul_f32 v243, v243, v239
v_cvt_pk_bf16_f32 v188, v242, v243
v_lshlrev_b32 v242, 16, v189
v_and_b32 v243, 0xffff0000, v189
v_mul_f32 v242, v242, v239
v_mul_f32 v243, v243, v239
v_cvt_pk_bf16_f32 v189, v242, v243
ds_read_b64 v[254:255], v253 offset:3072
s_waitcnt lgkmcnt(0)
v_lshlrev_b32 v242, 16, v254
v_and_b32 v243, 0xffff0000, v254
v_mul_f32 v242, v242, v239
v_mul_f32 v243, v243, v239
v_cvt_pk_bf16_f32 v254, v242, v243
v_lshlrev_b32 v242, 16, v255
v_and_b32 v243, 0xffff0000, v255
v_mul_f32 v242, v242, v239
v_mul_f32 v243, v243, v239
v_cvt_pk_bf16_f32 v255, v242, v243
ds_write_b64 v253, v[254:255] offset:3072
s_waitcnt lgkmcnt(0)
ds_read_b64 v[254:255], v253 offset:3080
s_waitcnt lgkmcnt(0)
v_lshlrev_b32 v242, 16, v254
v_and_b32 v243, 0xffff0000, v254
v_mul_f32 v242, v242, v239
v_mul_f32 v243, v243, v239
v_cvt_pk_bf16_f32 v254, v242, v243
v_lshlrev_b32 v242, 16, v255
v_and_b32 v243, 0xffff0000, v255
v_mul_f32 v242, v242, v239
v_mul_f32 v243, v243, v239
v_cvt_pk_bf16_f32 v255, v242, v243
ds_write_b64 v253, v[254:255] offset:3080
s_waitcnt lgkmcnt(0)
v_exp_f32 v232, v144
v_exp_f32 v233, v145
v_exp_f32 v234, v146
v_exp_f32 v235, v147
s_nop 1
v_add_f32 v224, v228, v232
v_add_f32 v224, v224, v233
v_add_f32 v224, v224, v234
v_add_f32 v224, v224, v235
v_cvt_pk_bf16_f32 v178, v232, v233
v_cvt_pk_bf16_f32 v179, v234, v235
v_exp_f32 v232, v148
v_exp_f32 v233, v149
v_exp_f32 v234, v150
v_exp_f32 v235, v151
s_nop 1
v_add_f32 v225, v229, v232
v_add_f32 v225, v225, v233
v_add_f32 v225, v225, v234
v_add_f32 v225, v225, v235
v_cvt_pk_bf16_f32 v182, v232, v233
v_cvt_pk_bf16_f32 v183, v234, v235
v_exp_f32 v232, v152
v_exp_f32 v233, v153
v_exp_f32 v234, v154
v_exp_f32 v235, v155
s_nop 1
v_add_f32 v226, v230, v232
v_add_f32 v226, v226, v233
v_add_f32 v226, v226, v234
v_add_f32 v226, v226, v235
v_cvt_pk_bf16_f32 v186, v232, v233
v_cvt_pk_bf16_f32 v187, v234, v235
v_exp_f32 v232, v156
v_exp_f32 v233, v157
v_exp_f32 v234, v158
v_exp_f32 v235, v159
s_nop 1
v_add_f32 v227, v231, v232
v_add_f32 v227, v227, v233
v_add_f32 v227, v227, v234
v_add_f32 v227, v227, v235
v_cvt_pk_bf16_f32 v190, v232, v233
v_cvt_pk_bf16_f32 v191, v234, v235
s_branch L2_rare_common
L2_rare_site6:
s_mov_b32 s36, 6
s_branch L2_rare_t0_2_0
L2_rare_t0_2_0:
s_nop 15
s_nop 15
s_waitcnt lgkmcnt(0)
v_log_f32 v243, v224
v_max3_f32 v232, v128, v129, v130
v_max3_f32 v232, v232, v131, v243
v_mov_b32 v243, v232
s_nop 1
v_permlane32_swap_b32 v232, v243
s_nop 1
v_max_f32 v232, v232, v243
v_mov_b32 v243, v232
s_nop 1
v_permlane16_swap_b32 v232, v243
s_nop 1
v_max_f32 v232, v232, v243
v_ceil_f32 v232, v232
v_max_f32 v232, 0, v232
v_sub_f32 v243, 0, v232
v_exp_f32 v236, v243
s_nop 1
v_mul_f32 v224, v224, v236
v_add_f32 v244, v244, v232
v_sub_f32 v192, v192, v232
v_sub_f32 v128, v128, v232
v_sub_f32 v144, v144, v232
v_sub_f32 v193, v193, v232
v_sub_f32 v129, v129, v232
v_sub_f32 v145, v145, v232
v_sub_f32 v194, v194, v232
v_sub_f32 v130, v130, v232
v_sub_f32 v146, v146, v232
v_sub_f32 v195, v195, v232
v_sub_f32 v131, v131, v232
v_sub_f32 v147, v147, v232
ds_read_b64 v[254:255], v253 offset:0
s_waitcnt lgkmcnt(0)
v_lshlrev_b32 v242, 16, v254
v_and_b32 v243, 0xffff0000, v254
v_mul_f32 v242, v242, v236
v_mul_f32 v243, v243, v236
v_cvt_pk_bf16_f32 v254, v242, v243
v_lshlrev_b32 v242, 16, v255
v_and_b32 v243, 0xffff0000, v255
v_mul_f32 v242, v242, v236
v_mul_f32 v243, v243, v236
v_cvt_pk_bf16_f32 v255, v242, v243
ds_write_b64 v253, v[254:255] offset:0
s_waitcnt lgkmcnt(0)
ds_read_b64 v[254:255], v253 offset:8
s_waitcnt lgkmcnt(0)
v_lshlrev_b32 v242, 16, v254
v_and_b32 v243, 0xffff0000, v254
v_mul_f32 v242, v242, v236
v_mul_f32 v243, v243, v236
v_cvt_pk_bf16_f32 v254, v242, v243
v_lshlrev_b32 v242, 16, v255
v_and_b32 v243, 0xffff0000, v255
v_mul_f32 v242, v242, v236
v_mul_f32 v243, v243, v236
v_cvt_pk_bf16_f32 v255, v242, v243
ds_write_b64 v253, v[254:255] offset:8
s_waitcnt lgkmcnt(0)
ds_read_b64 v[254:255], v253 offset:4096
s_waitcnt lgkmcnt(0)
v_lshlrev_b32 v242, 16, v254
v_and_b32 v243, 0xffff0000, v254
v_mul_f32 v242, v242, v236
v_mul_f32 v243, v243, v236
v_cvt_pk_bf16_f32 v254, v242, v243
v_lshlrev_b32 v242, 16, v255
v_and_b32 v243, 0xffff0000, v255
v_mul_f32 v242, v242, v236
v_mul_f32 v243, v243, v236
v_cvt_pk_bf16_f32 v255, v242, v243
ds_write_b64 v253, v[254:255] offset:4096
s_waitcnt lgkmcnt(0)
ds_read_b64 v[254:255], v253 offset:4104
s_waitcnt lgkmcnt(0)
v_lshlrev_b32 v242, 16, v254
v_and_b32 v243, 0xffff0000, v254
v_mul_f32 v242, v242, v236
v_mul_f32 v243, v243, v236
v_cvt_pk_bf16_f32 v254, v242, v243
v_lshlrev_b32 v242, 16, v255
v_and_b32 v243, 0xffff0000, v255
v_mul_f32 v242, v242, v236
v_mul_f32 v243, v243, v236
v_cvt_pk_bf16_f32 v255, v242, v243
ds_write_b64 v253, v[254:255] offset:4104
s_waitcnt lgkmcnt(0)
v_log_f32 v243, v225
v_max3_f32 v233, v132, v133, v134
v_max3_f32 v233, v233, v135, v243
v_mov_b32 v243, v233
s_nop 1
v_permlane32_swap_b32 v233, v243
s_nop 1
v_max_f32 v233, v233, v243
v_mov_b32 v243, v233
s_nop 1
v_permlane16_swap_b32 v233, v243
s_nop 1
v_max_f32 v233, v233, v243
v_ceil_f32 v233, v233
v_max_f32 v233, 0, v233
v_sub_f32 v243, 0, v233
v_exp_f32 v237, v243
s_nop 1
v_mul_f32 v225, v225, v237
v_add_f32 v245, v245, v233
v_sub_f32 v196, v196, v233
v_sub_f32 v132, v132, v233
v_sub_f32 v148, v148, v233
v_sub_f32 v197, v197, v233
v_sub_f32 v133, v133, v233
v_sub_f32 v149, v149, v233
v_sub_f32 v198, v198, v233
v_sub_f32 v134, v134, v233
v_sub_f32 v150, v150, v233
v_sub_f32 v199, v199, v233
v_sub_f32 v135, v135, v233
v_sub_f32 v151, v151, v233
ds_read_b64 v[254:255], v253 offset:1024
s_waitcnt lgkmcnt(0)
v_lshlrev_b32 v242, 16, v254
v_and_b32 v243, 0xffff0000, v254
v_mul_f32 v242, v242, v237
v_mul_f32 v243, v243, v237
v_cvt_pk_bf16_f32 v254, v242, v243
v_lshlrev_b32 v242, 16, v255
v_and_b32 v243, 0xffff0000, v255
v_mul_f32 v242, v242, v237
v_mul_f32 v243, v243, v237
v_cvt_pk_bf16_f32 v255, v242, v243
ds_write_b64 v253, v[254:255] offset:1024
s_waitcnt lgkmcnt(0)
ds_read_b64 v[254:255], v253 offset:1032
s_waitcnt lgkmcnt(0)
v_lshlrev_b32 v242, 16, v254
v_and_b32 v243, 0xffff0000, v254
v_mul_f32 v242, v242, v237
v_mul_f32 v243, v243, v237
v_cvt_pk_bf16_f32 v254, v242, v243
v_lshlrev_b32 v242, 16, v255
v_and_b32 v243, 0xffff0000, v255
v_mul_f32 v242, v242, v237
v_mul_f32 v243, v243, v237
v_cvt_pk_bf16_f32 v255, v242, v243
ds_write_b64 v253, v[254:255] offset:1032
s_waitcnt lgkmcnt(0)
ds_read_b64 v[254:255], v253 offset:5120
s_waitcnt lgkmcnt(0)
v_lshlrev_b32 v242, 16, v254
v_and_b32 v243, 0xffff0000, v254
v_mul_f32 v242, v242, v237
v_mul_f32 v243, v243, v237
v_cvt_pk_bf16_f32 v254, v242, v243
v_lshlrev_b32 v242, 16, v255
v_and_b32 v243, 0xffff0000, v255
v_mul_f32 v242, v242, v237
v_mul_f32 v243, v243, v237
v_cvt_pk_bf16_f32 v255, v242, v243
ds_write_b64 v253, v[254:255] offset:5120
s_waitcnt lgkmcnt(0)
ds_read_b64 v[254:255], v253 offset:5128
s_waitcnt lgkmcnt(0)
v_lshlrev_b32 v242, 16, v254
v_and_b32 v243, 0xffff0000, v254
v_mul_f32 v242, v242, v237
v_mul_f32 v243, v243, v237
v_cvt_pk_bf16_f32 v254, v242, v243
v_lshlrev_b32 v242, 16, v255
v_and_b32 v243, 0xffff0000, v255
v_mul_f32 v242, v242, v237
v_mul_f32 v243, v243, v237
v_cvt_pk_bf16_f32 v255, v242, v243
ds_write_b64 v253, v[254:255] offset:5128
s_waitcnt lgkmcnt(0)
v_log_f32 v243, v226
v_max3_f32 v234, v136, v137, v138
v_max3_f32 v234, v234, v139, v243
v_mov_b32 v243, v234
s_nop 1
v_permlane32_swap_b32 v234, v243
s_nop 1
v_max_f32 v234, v234, v243
v_mov_b32 v243, v234
s_nop 1
v_permlane16_swap_b32 v234, v243
s_nop 1
v_max_f32 v234, v234, v243
v_ceil_f32 v234, v234
v_max_f32 v234, 0, v234
v_sub_f32 v243, 0, v234
v_exp_f32 v238, v243
s_nop 1
v_mul_f32 v226, v226, v238
v_add_f32 v246, v246, v234
v_sub_f32 v200, v200, v234
v_sub_f32 v136, v136, v234
v_sub_f32 v152, v152, v234
v_sub_f32 v201, v201, v234
v_sub_f32 v137, v137, v234
v_sub_f32 v153, v153, v234
v_sub_f32 v202, v202, v234
v_sub_f32 v138, v138, v234
v_sub_f32 v154, v154, v234
v_sub_f32 v203, v203, v234
v_sub_f32 v139, v139, v234
v_sub_f32 v155, v155, v234
ds_read_b64 v[254:255], v253 offset:2048
s_waitcnt lgkmcnt(0)
v_lshlrev_b32 v242, 16, v254
v_and_b32 v243, 0xffff0000, v254
v_mul_f32 v242, v242, v238
v_mul_f32 v243, v243, v238
v_cvt_pk_bf16_f32 v254, v242, v243
v_lshlrev_b32 v242, 16, v255
v_and_b32 v243, 0xffff0000, v255
v_mul_f32 v242, v242, v238
v_mul_f32 v243, v243, v238
v_cvt_pk_bf16_f32 v255, v242, v243
ds_write_b64 v253, v[254:255] offset:2048
s_waitcnt lgkmcnt(0)
ds_read_b64 v[254:255], v253 offset:2056
s_waitcnt lgkmcnt(0)
v_lshlrev_b32 v242, 16, v254
v_and_b32 v243, 0xffff0000, v254
v_mul_f32 v242, v242, v238
v_mul_f32 v243, v243, v238
v_cvt_pk_bf16_f32 v254, v242, v243
v_lshlrev_b32 v242, 16, v255
v_and_b32 v243, 0xffff0000, v255
v_mul_f32 v242, v242, v238
v_mul_f32 v243, v243, v238
v_cvt_pk_bf16_f32 v255, v242, v243
ds_write_b64 v253, v[254:255] offset:2056
s_waitcnt lgkmcnt(0)
ds_read_b64 v[254:255], v253 offset:6144
s_waitcnt lgkmcnt(0)
v_lshlrev_b32 v242, 16, v254
v_and_b32 v243, 0xffff0000, v254
v_mul_f32 v242, v242, v238
v_mul_f32 v243, v243, v238
v_cvt_pk_bf16_f32 v254, v242, v243
v_lshlrev_b32 v242, 16, v255
v_and_b32 v243, 0xffff0000, v255
v_mul_f32 v242, v242, v238
v_mul_f32 v243, v243, v238
v_cvt_pk_bf16_f32 v255, v242, v243
ds_write_b64 v253, v[254:255] offset:6144
s_waitcnt lgkmcnt(0)
ds_read_b64 v[254:255], v253 offset:6152
s_waitcnt lgkmcnt(0)
v_lshlrev_b32 v242, 16, v254
v_and_b32 v243, 0xffff0000, v254
v_mul_f32 v242, v242, v238
v_mul_f32 v243, v243, v238
v_cvt_pk_bf16_f32 v254, v242, v243
v_lshlrev_b32 v242, 16, v255
v_and_b32 v243, 0xffff0000, v255
v_mul_f32 v242, v242, v238
v_mul_f32 v243, v243, v238
v_cvt_pk_bf16_f32 v255, v242, v243
ds_write_b64 v253, v[254:255] offset:6152
s_waitcnt lgkmcnt(0)
v_log_f32 v243, v227
v_max3_f32 v235, v140, v141, v142
v_max3_f32 v235, v235, v143, v243
v_mov_b32 v243, v235
s_nop 1
v_permlane32_swap_b32 v235, v243
s_nop 1
v_max_f32 v235, v235, v243
v_mov_b32 v243, v235
s_nop 1
v_permlane16_swap_b32 v235, v243
s_nop 1
v_max_f32 v235, v235, v243
v_ceil_f32 v235, v235
v_max_f32 v235, 0, v235
v_sub_f32 v243, 0, v235
v_exp_f32 v239, v243
s_nop 1
v_mul_f32 v227, v227, v239
v_add_f32 v247, v247, v235
v_sub_f32 v204, v204, v235
v_sub_f32 v140, v140, v235
v_sub_f32 v156, v156, v235
v_sub_f32 v205, v205, v235
v_sub_f32 v141, v141, v235
v_sub_f32 v157, v157, v235
v_sub_f32 v206, v206, v235
v_sub_f32 v142, v142, v235
v_sub_f32 v158, v158, v235
v_sub_f32 v207, v207, v235
v_sub_f32 v143, v143, v235
v_sub_f32 v159, v159, v235
ds_read_b64 v[254:255], v253 offset:3072
s_waitcnt lgkmcnt(0)
v_lshlrev_b32 v242, 16, v254
v_and_b32 v243, 0xffff0000, v254
v_mul_f32 v242, v242, v239
v_mul_f32 v243, v243, v239
v_cvt_pk_bf16_f32 v254, v242, v243
v_lshlrev_b32 v242, 16, v255
v_and_b32 v243, 0xffff0000, v255
v_mul_f32 v242, v242, v239
v_mul_f32 v243, v243, v239
v_cvt_pk_bf16_f32 v255, v242, v243
ds_write_b64 v253, v[254:255] offset:3072
s_waitcnt lgkmcnt(0)
ds_read_b64 v[254:255], v253 offset:3080
s_waitcnt lgkmcnt(0)
v_lshlrev_b32 v242, 16, v254
v_and_b32 v243, 0xffff0000, v254
v_mul_f32 v242, v242, v239
v_mul_f32 v243, v243, v239
v_cvt_pk_bf16_f32 v254, v242, v243
v_lshlrev_b32 v242, 16, v255
v_and_b32 v243, 0xffff0000, v255
v_mul_f32 v242, v242, v239
v_mul_f32 v243, v243, v239
v_cvt_pk_bf16_f32 v255, v242, v243
ds_write_b64 v253, v[254:255] offset:3080
s_waitcnt lgkmcnt(0)
ds_read_b64 v[254:255], v253 offset:7168
s_waitcnt lgkmcnt(0)
v_lshlrev_b32 v242, 16, v254
v_and_b32 v243, 0xffff0000, v254
v_mul_f32 v242, v242, v239
v_mul_f32 v243, v243, v239
v_cvt_pk_bf16_f32 v254, v242, v243
v_lshlrev_b32 v242, 16, v255
v_and_b32 v243, 0xffff0000, v255
v_mul_f32 v242, v242, v239
v_mul_f32 v243, v243, v239
v_cvt_pk_bf16_f32 v255, v242, v243
ds_write_b64 v253, v[254:255] offset:7168
s_waitcnt lgkmcnt(0)
ds_read_b64 v[254:255], v253 offset:7176
s_waitcnt lgkmcnt(0)
v_lshlrev_b32 v242, 16, v254
v_and_b32 v243, 0xffff0000, v254
v_mul_f32 v242, v242, v239
v_mul_f32 v243, v243, v239
v_cvt_pk_bf16_f32 v254, v242, v243
v_lshlrev_b32 v242, 16, v255
v_and_b32 v243, 0xffff0000, v255
v_mul_f32 v242, v242, v239
v_mul_f32 v243, v243, v239
v_cvt_pk_bf16_f32 v255, v242, v243
ds_write_b64 v253, v[254:255] offset:7176
s_waitcnt lgkmcnt(0)
v_exp_f32 v232, v128
v_exp_f32 v233, v129
v_exp_f32 v234, v130
v_exp_f32 v235, v131
s_nop 1
v_add_f32 v228, v224, v232
v_add_f32 v228, v228, v233
v_add_f32 v228, v228, v234
v_add_f32 v228, v228, v235
v_cvt_pk_bf16_f32 v160, v232, v233
v_cvt_pk_bf16_f32 v161, v234, v235
v_exp_f32 v232, v132
v_exp_f32 v233, v133
v_exp_f32 v234, v134
v_exp_f32 v235, v135
s_nop 1
v_add_f32 v229, v225, v232
v_add_f32 v229, v229, v233
v_add_f32 v229, v229, v234
v_add_f32 v229, v229, v235
v_cvt_pk_bf16_f32 v164, v232, v233
v_cvt_pk_bf16_f32 v165, v234, v235
v_exp_f32 v232, v136
v_exp_f32 v233, v137
v_exp_f32 v234, v138
v_exp_f32 v235, v139
s_nop 1
v_add_f32 v230, v226, v232
v_add_f32 v230, v230, v233
v_add_f32 v230, v230, v234
v_add_f32 v230, v230, v235
v_cvt_pk_bf16_f32 v168, v232, v233
v_cvt_pk_bf16_f32 v169, v234, v235
v_exp_f32 v232, v140
v_exp_f32 v233, v141
v_exp_f32 v234, v142
v_exp_f32 v235, v143
s_nop 1
v_add_f32 v231, v227, v232
v_add_f32 v231, v231, v233
v_add_f32 v231, v231, v234
v_add_f32 v231, v231, v235
v_cvt_pk_bf16_f32 v172, v232, v233
v_cvt_pk_bf16_f32 v173, v234, v235
s_branch L2_rare_common
L2_rare_site7:
s_mov_b32 s36, 7
s_branch L2_rare_t0_3_1
L2_rare_t0_3_1:
s_nop 15
s_nop 15
s_waitcnt lgkmcnt(0)
v_log_f32 v243, v228
v_max3_f32 v232, v144, v145, v146
v_max3_f32 v232, v232, v147, v243
v_mov_b32 v243, v232
s_nop 1
v_permlane32_swap_b32 v232, v243
s_nop 1
v_max_f32 v232, v232, v243
v_mov_b32 v243, v232
s_nop 1
v_permlane16_swap_b32 v232, v243
s_nop 1
v_max_f32 v232, v232, v243
v_ceil_f32 v232, v232
v_max_f32 v232, 0, v232
v_sub_f32 v243, 0, v232
v_exp_f32 v236, v243
s_nop 1
v_mul_f32 v228, v228, v236
v_add_f32 v244, v244, v232
v_sub_f32 v192, v192, v232
v_sub_f32 v128, v128, v232
v_sub_f32 v144, v144, v232
v_sub_f32 v193, v193, v232
v_sub_f32 v129, v129, v232
v_sub_f32 v145, v145, v232
v_sub_f32 v194, v194, v232
v_sub_f32 v130, v130, v232
v_sub_f32 v146, v146, v232
v_sub_f32 v195, v195, v232
v_sub_f32 v131, v131, v232
v_sub_f32 v147, v147, v232
v_lshlrev_b32 v242, 16, v160
v_and_b32 v243, 0xffff0000, v160
v_mul_f32 v242, v242, v236
v_mul_f32 v243, v243, v236
v_cvt_pk_bf16_f32 v160, v242, v243
v_lshlrev_b32 v242, 16, v161
v_and_b32 v243, 0xffff0000, v161
v_mul_f32 v242, v242, v236
v_mul_f32 v243, v243, v236
v_cvt_pk_bf16_f32 v161, v242, v243
ds_read_b64 v[254:255], v253 offset:0
s_waitcnt lgkmcnt(0)
v_lshlrev_b32 v242, 16, v254
v_and_b32 v243, 0xffff0000, v254
v_mul_f32 v242, v242, v236
v_mul_f32 v243, v243, v236
v_cvt_pk_bf16_f32 v254, v242, v243
v_lshlrev_b32 v242, 16, v255
v_and_b32 v243, 0xffff0000, v255
v_mul_f32 v242, v242, v236
v_mul_f32 v243, v243, v236
v_cvt_pk_bf16_f32 v255, v242, v243
ds_write_b64 v253, v[254:255] offset:0
s_waitcnt lgkmcnt(0)
ds_read_b64 v[254:255], v253 offset:8
s_waitcnt lgkmcnt(0)
v_lshlrev_b32 v242, 16, v254
v_and_b32 v243, 0xffff0000, v254
v_mul_f32 v242, v242, v236
v_mul_f32 v243, v243, v236
v_cvt_pk_bf16_f32 v254, v242, v243
v_lshlrev_b32 v242, 16, v255
v_and_b32 v243, 0xffff0000, v255
v_mul_f32 v242, v242, v236
v_mul_f32 v243, v243, v236
v_cvt_pk_bf16_f32 v255, v242, v243
ds_write_b64 v253, v[254:255] offset:8
s_waitcnt lgkmcnt(0)
ds_read_b64 v[254:255], v253 offset:4096
s_waitcnt lgkmcnt(0)
v_lshlrev_b32 v242, 16, v254
v_and_b32 v243, 0xffff0000, v254
v_mul_f32 v242, v242, v236
v_mul_f32 v243, v243, v236
v_cvt_pk_bf16_f32 v254, v242, v243
v_lshlrev_b32 v242, 16, v255
v_and_b32 v243, 0xffff0000, v255
v_mul_f32 v242, v242, v236
v_mul_f32 v243, v243, v236
v_cvt_pk_bf16_f32 v255, v242, v243
ds_write_b64 v253, v[254:255] offset:4096
s_waitcnt lgkmcnt(0)
ds_read_b64 v[254:255], v253 offset:4104
s_waitcnt lgkmcnt(0)
v_lshlrev_b32 v242, 16, v254
v_and_b32 v243, 0xffff0000, v254
v_mul_f32 v242, v242, v236
v_mul_f32 v243, v243, v236
v_cvt_pk_bf16_f32 v254, v242, v243
v_lshlrev_b32 v242, 16, v255
v_and_b32 v243, 0xffff0000, v255
v_mul_f32 v242, v242, v236
v_mul_f32 v243, v243, v236
v_cvt_pk_bf16_f32 v255, v242, v243
ds_write_b64 v253, v[254:255] offset:4104
s_waitcnt lgkmcnt(0)
v_log_f32 v243, v229
v_max3_f32 v233, v148, v149, v150
v_max3_f32 v233, v233, v151, v243
v_mov_b32 v243, v233
s_nop 1
v_permlane32_swap_b32 v233, v243
s_nop 1
v_max_f32 v233, v233, v243
v_mov_b32 v243, v233
s_nop 1
v_permlane16_swap_b32 v233, v243
s_nop 1
v_max_f32 v233, v233, v243
v_ceil_f32 v233, v233
v_max_f32 v233, 0, v233
v_sub_f32 v243, 0, v233
v_exp_f32 v237, v243
s_nop 1
v_mul_f32 v229, v229, v237
v_add_f32 v245, v245, v233
v_sub_f32 v196, v196, v233
v_sub_f32 v132, v132, v233
v_sub_f32 v148, v148, v233
v_sub_f32 v197, v197, v233
v_sub_f32 v133, v133, v233
v_sub_f32 v149, v149, v233
v_sub_f32 v198, v198, v233
v_sub_f32 v134, v134, v233
v_sub_f32 v150, v150, v233
v_sub_f32 v199, v199, v233
v_sub_f32 v135, v135, v233
v_sub_f32 v151, v151, v233
v_lshlrev_b32 v242, 16, v164
v_and_b32 v243, 0xffff0000, v164
v_mul_f32 v242, v242, v237
v_mul_f32 v243, v243, v237
v_cvt_pk_bf16_f32 v164, v242, v243
v_lshlrev_b32 v242, 16, v165
v_and_b32 v243, 0xffff0000, v165
v_mul_f32 v242, v242, v237
v_mul_f32 v243, v243, v237
v_cvt_pk_bf16_f32 v165, v242, v243
ds_read_b64 v[254:255], v253 offset:1024
s_waitcnt lgkmcnt(0)
v_lshlrev_b32 v242, 16, v254
v_and_b32 v243, 0xffff0000, v254
v_mul_f32 v242, v242, v237
v_mul_f32 v243, v243, v237
v_cvt_pk_bf16_f32 v254, v242, v243
v_lshlrev_b32 v242, 16, v255
v_and_b32 v243, 0xffff0000, v255
v_mul_f32 v242, v242, v237
v_mul_f32 v243, v243, v237
v_cvt_pk_bf16_f32 v255, v242, v243
ds_write_b64 v253, v[254:255] offset:1024
s_waitcnt lgkmcnt(0)
ds_read_b64 v[254:255], v253 offset:1032
s_waitcnt lgkmcnt(0)
v_lshlrev_b32 v242, 16, v254
v_and_b32 v243, 0xffff0000, v254
v_mul_f32 v242, v242, v237
v_mul_f32 v243, v243, v237
v_cvt_pk_bf16_f32 v254, v242, v243
v_lshlrev_b32 v242, 16, v255
v_and_b32 v243, 0xffff0000, v255
v_mul_f32 v242, v242, v237
v_mul_f32 v243, v243, v237
v_cvt_pk_bf16_f32 v255, v242, v243
ds_write_b64 v253, v[254:255] offset:1032
s_waitcnt lgkmcnt(0)
ds_read_b64 v[254:255], v253 offset:5120
s_waitcnt lgkmcnt(0)
v_lshlrev_b32 v242, 16, v254
v_and_b32 v243, 0xffff0000, v254
v_mul_f32 v242, v242, v237
v_mul_f32 v243, v243, v237
v_cvt_pk_bf16_f32 v254, v242, v243
v_lshlrev_b32 v242, 16, v255
v_and_b32 v243, 0xffff0000, v255
v_mul_f32 v242, v242, v237
v_mul_f32 v243, v243, v237
v_cvt_pk_bf16_f32 v255, v242, v243
ds_write_b64 v253, v[254:255] offset:5120
s_waitcnt lgkmcnt(0)
ds_read_b64 v[254:255], v253 offset:5128
s_waitcnt lgkmcnt(0)
v_lshlrev_b32 v242, 16, v254
v_and_b32 v243, 0xffff0000, v254
v_mul_f32 v242, v242, v237
v_mul_f32 v243, v243, v237
v_cvt_pk_bf16_f32 v254, v242, v243
v_lshlrev_b32 v242, 16, v255
v_and_b32 v243, 0xffff0000, v255
v_mul_f32 v242, v242, v237
v_mul_f32 v243, v243, v237
v_cvt_pk_bf16_f32 v255, v242, v243
ds_write_b64 v253, v[254:255] offset:5128
s_waitcnt lgkmcnt(0)
v_log_f32 v243, v230
v_max3_f32 v234, v152, v153, v154
v_max3_f32 v234, v234, v155, v243
v_mov_b32 v243, v234
s_nop 1
v_permlane32_swap_b32 v234, v243
s_nop 1
v_max_f32 v234, v234, v243
v_mov_b32 v243, v234
s_nop 1
v_permlane16_swap_b32 v234, v243
s_nop 1
v_max_f32 v234, v234, v243
v_ceil_f32 v234, v234
v_max_f32 v234, 0, v234
v_sub_f32 v243, 0, v234
v_exp_f32 v238, v243
s_nop 1
v_mul_f32 v230, v230, v238
v_add_f32 v246, v246, v234
v_sub_f32 v200, v200, v234
v_sub_f32 v136, v136, v234
v_sub_f32 v152, v152, v234
v_sub_f32 v201, v201, v234
v_sub_f32 v137, v137, v234
v_sub_f32 v153, v153, v234
v_sub_f32 v202, v202, v234
v_sub_f32 v138, v138, v234
v_sub_f32 v154, v154, v234
v_sub_f32 v203, v203, v234
v_sub_f32 v139, v139, v234
v_sub_f32 v155, v155, v234
v_lshlrev_b32 v242, 16, v168
v_and_b32 v243, 0xffff0000, v168
v_mul_f32 v242, v242, v238
v_mul_f32 v243, v243, v238
v_cvt_pk_bf16_f32 v168, v242, v243
v_lshlrev_b32 v242, 16, v169
v_and_b32 v243, 0xffff0000, v169
v_mul_f32 v242, v242, v238
v_mul_f32 v243, v243, v238
v_cvt_pk_bf16_f32 v169, v242, v243
ds_read_b64 v[254:255], v253 offset:2048
s_waitcnt lgkmcnt(0)
v_lshlrev_b32 v242, 16, v254
v_and_b32 v243, 0xffff0000, v254
v_mul_f32 v242, v242, v238
v_mul_f32 v243, v243, v238
v_cvt_pk_bf16_f32 v254, v242, v243
v_lshlrev_b32 v242, 16, v255
v_and_b32 v243, 0xffff0000, v255
v_mul_f32 v242, v242, v238
v_mul_f32 v243, v243, v238
v_cvt_pk_bf16_f32 v255, v242, v243
ds_write_b64 v253, v[254:255] offset:2048
s_waitcnt lgkmcnt(0)
ds_read_b64 v[254:255], v253 offset:2056
s_waitcnt lgkmcnt(0)
v_lshlrev_b32 v242, 16, v254
v_and_b32 v243, 0xffff0000, v254
v_mul_f32 v242, v242, v238
v_mul_f32 v243, v243, v238
v_cvt_pk_bf16_f32 v254, v242, v243
v_lshlrev_b32 v242, 16, v255
v_and_b32 v243, 0xffff0000, v255
v_mul_f32 v242, v242, v238
v_mul_f32 v243, v243, v238
v_cvt_pk_bf16_f32 v255, v242, v243
ds_write_b64 v253, v[254:255] offset:2056
s_waitcnt lgkmcnt(0)
ds_read_b64 v[254:255], v253 offset:6144
s_waitcnt lgkmcnt(0)
v_lshlrev_b32 v242, 16, v254
v_and_b32 v243, 0xffff0000, v254
v_mul_f32 v242, v242, v238
v_mul_f32 v243, v243, v238
v_cvt_pk_bf16_f32 v254, v242, v243
v_lshlrev_b32 v242, 16, v255
v_and_b32 v243, 0xffff0000, v255
v_mul_f32 v242, v242, v238
v_mul_f32 v243, v243, v238
v_cvt_pk_bf16_f32 v255, v242, v243
ds_write_b64 v253, v[254:255] offset:6144
s_waitcnt lgkmcnt(0)
ds_read_b64 v[254:255], v253 offset:6152
s_waitcnt lgkmcnt(0)
v_lshlrev_b32 v242, 16, v254
v_and_b32 v243, 0xffff0000, v254
v_mul_f32 v242, v242, v238
v_mul_f32 v243, v243, v238
v_cvt_pk_bf16_f32 v254, v242, v243
v_lshlrev_b32 v242, 16, v255
v_and_b32 v243, 0xffff0000, v255
v_mul_f32 v242, v242, v238
v_mul_f32 v243, v243, v238
v_cvt_pk_bf16_f32 v255, v242, v243
ds_write_b64 v253, v[254:255] offset:6152
s_waitcnt lgkmcnt(0)
v_log_f32 v243, v231
v_max3_f32 v235, v156, v157, v158
v_max3_f32 v235, v235, v159, v243
v_mov_b32 v243, v235
s_nop 1
v_permlane32_swap_b32 v235, v243
s_nop 1
v_max_f32 v235, v235, v243
v_mov_b32 v243, v235
s_nop 1
v_permlane16_swap_b32 v235, v243
s_nop 1
v_max_f32 v235, v235, v243
v_ceil_f32 v235, v235
v_max_f32 v235, 0, v235
v_sub_f32 v243, 0, v235
v_exp_f32 v239, v243
s_nop 1
v_mul_f32 v231, v231, v239
v_add_f32 v247, v247, v235
v_sub_f32 v204, v204, v235
v_sub_f32 v140, v140, v235
v_sub_f32 v156, v156, v235
v_sub_f32 v205, v205, v235
v_sub_f32 v141, v141, v235
v_sub_f32 v157, v157, v235
v_sub_f32 v206, v206, v235
v_sub_f32 v142, v142, v235
v_sub_f32 v158, v158, v235
v_sub_f32 v207, v207, v235
v_sub_f32 v143, v143, v235
v_sub_f32 v159, v159, v235
v_lshlrev_b32 v242, 16, v172
v_and_b32 v243, 0xffff0000, v172
v_mul_f32 v242, v242, v239
v_mul_f32 v243, v243, v239
v_cvt_pk_bf16_f32 v172, v242, v243
v_lshlrev_b32 v242, 16, v173
v_and_b32 v243, 0xffff0000, v173
v_mul_f32 v242, v242, v239
v_mul_f32 v243, v243, v239
v_cvt_pk_bf16_f32 v173, v242, v243
ds_read_b64 v[254:255], v253 offset:3072
s_waitcnt lgkmcnt(0)
v_lshlrev_b32 v242, 16, v254
v_and_b32 v243, 0xffff0000, v254
v_mul_f32 v242, v242, v239
v_mul_f32 v243, v243, v239
v_cvt_pk_bf16_f32 v254, v242, v243
v_lshlrev_b32 v242, 16, v255
v_and_b32 v243, 0xffff0000, v255
v_mul_f32 v242, v242, v239
v_mul_f32 v243, v243, v239
v_cvt_pk_bf16_f32 v255, v242, v243
ds_write_b64 v253, v[254:255] offset:3072
s_waitcnt lgkmcnt(0)
ds_read_b64 v[254:255], v253 offset:3080
s_waitcnt lgkmcnt(0)
v_lshlrev_b32 v242, 16, v254
v_and_b32 v243, 0xffff0000, v254
v_mul_f32 v242, v242, v239
v_mul_f32 v243, v243, v239
v_cvt_pk_bf16_f32 v254, v242, v243
v_lshlrev_b32 v242, 16, v255
v_and_b32 v243, 0xffff0000, v255
v_mul_f32 v242, v242, v239
v_mul_f32 v243, v243, v239
v_cvt_pk_bf16_f32 v255, v242, v243
ds_write_b64 v253, v[254:255] offset:3080
s_waitcnt lgkmcnt(0)
ds_read_b64 v[254:255], v253 offset:7168
s_waitcnt lgkmcnt(0)
v_lshlrev_b32 v242, 16, v254
v_and_b32 v243, 0xffff0000, v254
v_mul_f32 v242, v242, v239
v_mul_f32 v243, v243, v239
v_cvt_pk_bf16_f32 v254, v242, v243
v_lshlrev_b32 v242, 16, v255
v_and_b32 v243, 0xffff0000, v255
v_mul_f32 v242, v242, v239
v_mul_f32 v243, v243, v239
v_cvt_pk_bf16_f32 v255, v242, v243
ds_write_b64 v253, v[254:255] offset:7168
s_waitcnt lgkmcnt(0)
ds_read_b64 v[254:255], v253 offset:7176
s_waitcnt lgkmcnt(0)
v_lshlrev_b32 v242, 16, v254
v_and_b32 v243, 0xffff0000, v254
v_mul_f32 v242, v242, v239
v_mul_f32 v243, v243, v239
v_cvt_pk_bf16_f32 v254, v242, v243
v_lshlrev_b32 v242, 16, v255
v_and_b32 v243, 0xffff0000, v255
v_mul_f32 v242, v242, v239
v_mul_f32 v243, v243, v239
v_cvt_pk_bf16_f32 v255, v242, v243
ds_write_b64 v253, v[254:255] offset:7176
s_waitcnt lgkmcnt(0)
v_exp_f32 v232, v144
v_exp_f32 v233, v145
v_exp_f32 v234, v146
v_exp_f32 v235, v147
s_nop 1
v_add_f32 v224, v228, v232
v_add_f32 v224, v224, v233
v_add_f32 v224, v224, v234
v_add_f32 v224, v224, v235
v_cvt_pk_bf16_f32 v162, v232, v233
v_cvt_pk_bf16_f32 v163, v234, v235
v_exp_f32 v232, v148
v_exp_f32 v233, v149
v_exp_f32 v234, v150
v_exp_f32 v235, v151
s_nop 1
v_add_f32 v225, v229, v232
v_add_f32 v225, v225, v233
v_add_f32 v225, v225, v234
v_add_f32 v225, v225, v235
v_cvt_pk_bf16_f32 v166, v232, v233
v_cvt_pk_bf16_f32 v167, v234, v235
v_exp_f32 v232, v152
v_exp_f32 v233, v153
v_exp_f32 v234, v154
v_exp_f32 v235, v155
s_nop 1
v_add_f32 v226, v230, v232
v_add_f32 v226, v226, v233
v_add_f32 v226, v226, v234
v_add_f32 v226, v226, v235
v_cvt_pk_bf16_f32 v170, v232, v233
v_cvt_pk_bf16_f32 v171, v234, v235
v_exp_f32 v232, v156
v_exp_f32 v233, v157
v_exp_f32 v234, v158
v_exp_f32 v235, v159
s_nop 1
v_add_f32 v227, v231, v232
v_add_f32 v227, v227, v233
v_add_f32 v227, v227, v234
v_add_f32 v227, v227, v235
v_cvt_pk_bf16_f32 v174, v232, v233
v_cvt_pk_bf16_f32 v175, v234, v235
s_branch L2_rare_common
L2_rare_site8:
s_mov_b32 s36, 8
s_branch L2_rare_t0_4_0
L2_rare_t0_4_0:
s_nop 15
s_nop 15
s_waitcnt lgkmcnt(0)
v_log_f32 v243, v224
v_max3_f32 v232, v128, v129, v130
v_max3_f32 v232, v232, v131, v243
v_mov_b32 v243, v232
s_nop 1
v_permlane32_swap_b32 v232, v243
s_nop 1
v_max_f32 v232, v232, v243
v_mov_b32 v243, v232
s_nop 1
v_permlane16_swap_b32 v232, v243
s_nop 1
v_max_f32 v232, v232, v243
v_ceil_f32 v232, v232
v_max_f32 v232, 0, v232
v_sub_f32 v243, 0, v232
v_exp_f32 v236, v243
s_nop 1
v_mul_f32 v224, v224, v236
v_add_f32 v244, v244, v232
v_sub_f32 v192, v192, v232
v_sub_f32 v128, v128, v232
v_sub_f32 v144, v144, v232
v_sub_f32 v193, v193, v232
v_sub_f32 v129, v129, v232
v_sub_f32 v145, v145, v232
v_sub_f32 v194, v194, v232
v_sub_f32 v130, v130, v232
v_sub_f32 v146, v146, v232
v_sub_f32 v195, v195, v232
v_sub_f32 v131, v131, v232
v_sub_f32 v147, v147, v232
v_lshlrev_b32 v242, 16, v160
v_and_b32 v243, 0xffff0000, v160
v_mul_f32 v242, v242, v236
v_mul_f32 v243, v243, v236
v_cvt_pk_bf16_f32 v160, v242, v243
v_lshlrev_b32 v242, 16, v161
v_and_b32 v243, 0xffff0000, v161
v_mul_f32 v242, v242, v236
v_mul_f32 v243, v243, v236
v_cvt_pk_bf16_f32 v161, v242, v243
v_lshlrev_b32 v242, 16, v162
v_and_b32 v243, 0xffff0000, v162
v_mul_f32 v242, v242, v236
v_mul_f32 v243, v243, v236
v_cvt_pk_bf16_f32 v162, v242, v243
v_lshlrev_b32 v242, 16, v163
v_and_b32 v243, 0xffff0000, v163
v_mul_f32 v242, v242, v236
v_mul_f32 v243, v243, v236
v_cvt_pk_bf16_f32 v163, v242, v243
ds_read_b64 v[254:255], v253 offset:0
s_waitcnt lgkmcnt(0)
v_lshlrev_b32 v242, 16, v254
v_and_b32 v243, 0xffff0000, v254
v_mul_f32 v242, v242, v236
v_mul_f32 v243, v243, v236
v_cvt_pk_bf16_f32 v254, v242, v243
v_lshlrev_b32 v242, 16, v255
v_and_b32 v243, 0xffff0000, v255
v_mul_f32 v242, v242, v236
v_mul_f32 v243, v243, v236
v_cvt_pk_bf16_f32 v255, v242, v243
ds_write_b64 v253, v[254:255] offset:0
s_waitcnt lgkmcnt(0)
ds_read_b64 v[254:255], v253 offset:8
s_waitcnt lgkmcnt(0)
v_lshlrev_b32 v242, 16, v254
v_and_b32 v243, 0xffff0000, v254
v_mul_f32 v242, v242, v236
v_mul_f32 v243, v243, v236
v_cvt_pk_bf16_f32 v254, v242, v243
v_lshlrev_b32 v242, 16, v255
v_and_b32 v243, 0xffff0000, v255
v_mul_f32 v242, v242, v236
v_mul_f32 v243, v243, v236
v_cvt_pk_bf16_f32 v255, v242, v243
ds_write_b64 v253, v[254:255] offset:8
s_waitcnt lgkmcnt(0)
ds_read_b64 v[254:255], v253 offset:4096
s_waitcnt lgkmcnt(0)
v_lshlrev_b32 v242, 16, v254
v_and_b32 v243, 0xffff0000, v254
v_mul_f32 v242, v242, v236
v_mul_f32 v243, v243, v236
v_cvt_pk_bf16_f32 v254, v242, v243
v_lshlrev_b32 v242, 16, v255
v_and_b32 v243, 0xffff0000, v255
v_mul_f32 v242, v242, v236
v_mul_f32 v243, v243, v236
v_cvt_pk_bf16_f32 v255, v242, v243
ds_write_b64 v253, v[254:255] offset:4096
s_waitcnt lgkmcnt(0)
ds_read_b64 v[254:255], v253 offset:4104
s_waitcnt lgkmcnt(0)
v_lshlrev_b32 v242, 16, v254
v_and_b32 v243, 0xffff0000, v254
v_mul_f32 v242, v242, v236
v_mul_f32 v243, v243, v236
v_cvt_pk_bf16_f32 v254, v242, v243
v_lshlrev_b32 v242, 16, v255
v_and_b32 v243, 0xffff0000, v255
v_mul_f32 v242, v242, v236
v_mul_f32 v243, v243, v236
v_cvt_pk_bf16_f32 v255, v242, v243
ds_write_b64 v253, v[254:255] offset:4104
s_waitcnt lgkmcnt(0)
v_log_f32 v243, v225
v_max3_f32 v233, v132, v133, v134
v_max3_f32 v233, v233, v135, v243
v_mov_b32 v243, v233
s_nop 1
v_permlane32_swap_b32 v233, v243
s_nop 1
v_max_f32 v233, v233, v243
v_mov_b32 v243, v233
s_nop 1
v_permlane16_swap_b32 v233, v243
s_nop 1
v_max_f32 v233, v233, v243
v_ceil_f32 v233, v233
v_max_f32 v233, 0, v233
v_sub_f32 v243, 0, v233
v_exp_f32 v237, v243
s_nop 1
v_mul_f32 v225, v225, v237
v_add_f32 v245, v245, v233
v_sub_f32 v196, v196, v233
v_sub_f32 v132, v132, v233
v_sub_f32 v148, v148, v233
v_sub_f32 v197, v197, v233
v_sub_f32 v133, v133, v233
v_sub_f32 v149, v149, v233
v_sub_f32 v198, v198, v233
v_sub_f32 v134, v134, v233
v_sub_f32 v150, v150, v233
v_sub_f32 v199, v199, v233
v_sub_f32 v135, v135, v233
v_sub_f32 v151, v151, v233
v_lshlrev_b32 v242, 16, v164
v_and_b32 v243, 0xffff0000, v164
v_mul_f32 v242, v242, v237
v_mul_f32 v243, v243, v237
v_cvt_pk_bf16_f32 v164, v242, v243
v_lshlrev_b32 v242, 16, v165
v_and_b32 v243, 0xffff0000, v165
v_mul_f32 v242, v242, v237
v_mul_f32 v243, v243, v237
v_cvt_pk_bf16_f32 v165, v242, v243
v_lshlrev_b32 v242, 16, v166
v_and_b32 v243, 0xffff0000, v166
v_mul_f32 v242, v242, v237
v_mul_f32 v243, v243, v237
v_cvt_pk_bf16_f32 v166, v242, v243
v_lshlrev_b32 v242, 16, v167
v_and_b32 v243, 0xffff0000, v167
v_mul_f32 v242, v242, v237
v_mul_f32 v243, v243, v237
v_cvt_pk_bf16_f32 v167, v242, v243
ds_read_b64 v[254:255], v253 offset:1024
s_waitcnt lgkmcnt(0)
v_lshlrev_b32 v242, 16, v254
v_and_b32 v243, 0xffff0000, v254
v_mul_f32 v242, v242, v237
v_mul_f32 v243, v243, v237
v_cvt_pk_bf16_f32 v254, v242, v243
v_lshlrev_b32 v242, 16, v255
v_and_b32 v243, 0xffff0000, v255
v_mul_f32 v242, v242, v237
v_mul_f32 v243, v243, v237
v_cvt_pk_bf16_f32 v255, v242, v243
ds_write_b64 v253, v[254:255] offset:1024
s_waitcnt lgkmcnt(0)
ds_read_b64 v[254:255], v253 offset:1032
s_waitcnt lgkmcnt(0)
v_lshlrev_b32 v242, 16, v254
v_and_b32 v243, 0xffff0000, v254
v_mul_f32 v242, v242, v237
v_mul_f32 v243, v243, v237
v_cvt_pk_bf16_f32 v254, v242, v243
v_lshlrev_b32 v242, 16, v255
v_and_b32 v243, 0xffff0000, v255
v_mul_f32 v242, v242, v237
v_mul_f32 v243, v243, v237
v_cvt_pk_bf16_f32 v255, v242, v243
ds_write_b64 v253, v[254:255] offset:1032
s_waitcnt lgkmcnt(0)
ds_read_b64 v[254:255], v253 offset:5120
s_waitcnt lgkmcnt(0)
v_lshlrev_b32 v242, 16, v254
v_and_b32 v243, 0xffff0000, v254
v_mul_f32 v242, v242, v237
v_mul_f32 v243, v243, v237
v_cvt_pk_bf16_f32 v254, v242, v243
v_lshlrev_b32 v242, 16, v255
v_and_b32 v243, 0xffff0000, v255
v_mul_f32 v242, v242, v237
v_mul_f32 v243, v243, v237
v_cvt_pk_bf16_f32 v255, v242, v243
ds_write_b64 v253, v[254:255] offset:5120
s_waitcnt lgkmcnt(0)
ds_read_b64 v[254:255], v253 offset:5128
s_waitcnt lgkmcnt(0)
v_lshlrev_b32 v242, 16, v254
v_and_b32 v243, 0xffff0000, v254
v_mul_f32 v242, v242, v237
v_mul_f32 v243, v243, v237
v_cvt_pk_bf16_f32 v254, v242, v243
v_lshlrev_b32 v242, 16, v255
v_and_b32 v243, 0xffff0000, v255
v_mul_f32 v242, v242, v237
v_mul_f32 v243, v243, v237
v_cvt_pk_bf16_f32 v255, v242, v243
ds_write_b64 v253, v[254:255] offset:5128
s_waitcnt lgkmcnt(0)
v_log_f32 v243, v226
v_max3_f32 v234, v136, v137, v138
v_max3_f32 v234, v234, v139, v243
v_mov_b32 v243, v234
s_nop 1
v_permlane32_swap_b32 v234, v243
s_nop 1
v_max_f32 v234, v234, v243
v_mov_b32 v243, v234
s_nop 1
v_permlane16_swap_b32 v234, v243
s_nop 1
v_max_f32 v234, v234, v243
v_ceil_f32 v234, v234
v_max_f32 v234, 0, v234
v_sub_f32 v243, 0, v234
v_exp_f32 v238, v243
s_nop 1
v_mul_f32 v226, v226, v238
v_add_f32 v246, v246, v234
v_sub_f32 v200, v200, v234
v_sub_f32 v136, v136, v234
v_sub_f32 v152, v152, v234
v_sub_f32 v201, v201, v234
v_sub_f32 v137, v137, v234
v_sub_f32 v153, v153, v234
v_sub_f32 v202, v202, v234
v_sub_f32 v138, v138, v234
v_sub_f32 v154, v154, v234
v_sub_f32 v203, v203, v234
v_sub_f32 v139, v139, v234
v_sub_f32 v155, v155, v234
v_lshlrev_b32 v242, 16, v168
v_and_b32 v243, 0xffff0000, v168
v_mul_f32 v242, v242, v238
v_mul_f32 v243, v243, v238
v_cvt_pk_bf16_f32 v168, v242, v243
v_lshlrev_b32 v242, 16, v169
v_and_b32 v243, 0xffff0000, v169
v_mul_f32 v242, v242, v238
v_mul_f32 v243, v243, v238
v_cvt_pk_bf16_f32 v169, v242, v243
v_lshlrev_b32 v242, 16, v170
v_and_b32 v243, 0xffff0000, v170
v_mul_f32 v242, v242, v238
v_mul_f32 v243, v243, v238
v_cvt_pk_bf16_f32 v170, v242, v243
v_lshlrev_b32 v242, 16, v171
v_and_b32 v243, 0xffff0000, v171
v_mul_f32 v242, v242, v238
v_mul_f32 v243, v243, v238
v_cvt_pk_bf16_f32 v171, v242, v243
ds_read_b64 v[254:255], v253 offset:2048
s_waitcnt lgkmcnt(0)
v_lshlrev_b32 v242, 16, v254
v_and_b32 v243, 0xffff0000, v254
v_mul_f32 v242, v242, v238
v_mul_f32 v243, v243, v238
v_cvt_pk_bf16_f32 v254, v242, v243
v_lshlrev_b32 v242, 16, v255
v_and_b32 v243, 0xffff0000, v255
v_mul_f32 v242, v242, v238
v_mul_f32 v243, v243, v238
v_cvt_pk_bf16_f32 v255, v242, v243
ds_write_b64 v253, v[254:255] offset:2048
s_waitcnt lgkmcnt(0)
ds_read_b64 v[254:255], v253 offset:2056
s_waitcnt lgkmcnt(0)
v_lshlrev_b32 v242, 16, v254
v_and_b32 v243, 0xffff0000, v254
v_mul_f32 v242, v242, v238
v_mul_f32 v243, v243, v238
v_cvt_pk_bf16_f32 v254, v242, v243
v_lshlrev_b32 v242, 16, v255
v_and_b32 v243, 0xffff0000, v255
v_mul_f32 v242, v242, v238
v_mul_f32 v243, v243, v238
v_cvt_pk_bf16_f32 v255, v242, v243
ds_write_b64 v253, v[254:255] offset:2056
s_waitcnt lgkmcnt(0)
ds_read_b64 v[254:255], v253 offset:6144
s_waitcnt lgkmcnt(0)
v_lshlrev_b32 v242, 16, v254
v_and_b32 v243, 0xffff0000, v254
v_mul_f32 v242, v242, v238
v_mul_f32 v243, v243, v238
v_cvt_pk_bf16_f32 v254, v242, v243
v_lshlrev_b32 v242, 16, v255
v_and_b32 v243, 0xffff0000, v255
v_mul_f32 v242, v242, v238
v_mul_f32 v243, v243, v238
v_cvt_pk_bf16_f32 v255, v242, v243
ds_write_b64 v253, v[254:255] offset:6144
s_waitcnt lgkmcnt(0)
ds_read_b64 v[254:255], v253 offset:6152
s_waitcnt lgkmcnt(0)
v_lshlrev_b32 v242, 16, v254
v_and_b32 v243, 0xffff0000, v254
v_mul_f32 v242, v242, v238
v_mul_f32 v243, v243, v238
v_cvt_pk_bf16_f32 v254, v242, v243
v_lshlrev_b32 v242, 16, v255
v_and_b32 v243, 0xffff0000, v255
v_mul_f32 v242, v242, v238
v_mul_f32 v243, v243, v238
v_cvt_pk_bf16_f32 v255, v242, v243
ds_write_b64 v253, v[254:255] offset:6152
s_waitcnt lgkmcnt(0)
v_log_f32 v243, v227
v_max3_f32 v235, v140, v141, v142
v_max3_f32 v235, v235, v143, v243
v_mov_b32 v243, v235
s_nop 1
v_permlane32_swap_b32 v235, v243
s_nop 1
v_max_f32 v235, v235, v243
v_mov_b32 v243, v235
s_nop 1
v_permlane16_swap_b32 v235, v243
s_nop 1
v_max_f32 v235, v235, v243
v_ceil_f32 v235, v235
v_max_f32 v235, 0, v235
v_sub_f32 v243, 0, v235
v_exp_f32 v239, v243
s_nop 1
v_mul_f32 v227, v227, v239
v_add_f32 v247, v247, v235
v_sub_f32 v204, v204, v235
v_sub_f32 v140, v140, v235
v_sub_f32 v156, v156, v235
v_sub_f32 v205, v205, v235
v_sub_f32 v141, v141, v235
v_sub_f32 v157, v157, v235
v_sub_f32 v206, v206, v235
v_sub_f32 v142, v142, v235
v_sub_f32 v158, v158, v235
v_sub_f32 v207, v207, v235
v_sub_f32 v143, v143, v235
v_sub_f32 v159, v159, v235
v_lshlrev_b32 v242, 16, v172
v_and_b32 v243, 0xffff0000, v172
v_mul_f32 v242, v242, v239
v_mul_f32 v243, v243, v239
v_cvt_pk_bf16_f32 v172, v242, v243
v_lshlrev_b32 v242, 16, v173
v_and_b32 v243, 0xffff0000, v173
v_mul_f32 v242, v242, v239
v_mul_f32 v243, v243, v239
v_cvt_pk_bf16_f32 v173, v242, v243
v_lshlrev_b32 v242, 16, v174
v_and_b32 v243, 0xffff0000, v174
v_mul_f32 v242, v242, v239
v_mul_f32 v243, v243, v239
v_cvt_pk_bf16_f32 v174, v242, v243
v_lshlrev_b32 v242, 16, v175
v_and_b32 v243, 0xffff0000, v175
v_mul_f32 v242, v242, v239
v_mul_f32 v243, v243, v239
v_cvt_pk_bf16_f32 v175, v242, v243
ds_read_b64 v[254:255], v253 offset:3072
s_waitcnt lgkmcnt(0)
v_lshlrev_b32 v242, 16, v254
v_and_b32 v243, 0xffff0000, v254
v_mul_f32 v242, v242, v239
v_mul_f32 v243, v243, v239
v_cvt_pk_bf16_f32 v254, v242, v243
v_lshlrev_b32 v242, 16, v255
v_and_b32 v243, 0xffff0000, v255
v_mul_f32 v242, v242, v239
v_mul_f32 v243, v243, v239
v_cvt_pk_bf16_f32 v255, v242, v243
ds_write_b64 v253, v[254:255] offset:3072
s_waitcnt lgkmcnt(0)
ds_read_b64 v[254:255], v253 offset:3080
s_waitcnt lgkmcnt(0)
v_lshlrev_b32 v242, 16, v254
v_and_b32 v243, 0xffff0000, v254
v_mul_f32 v242, v242, v239
v_mul_f32 v243, v243, v239
v_cvt_pk_bf16_f32 v254, v242, v243
v_lshlrev_b32 v242, 16, v255
v_and_b32 v243, 0xffff0000, v255
v_mul_f32 v242, v242, v239
v_mul_f32 v243, v243, v239
v_cvt_pk_bf16_f32 v255, v242, v243
ds_write_b64 v253, v[254:255] offset:3080
s_waitcnt lgkmcnt(0)
ds_read_b64 v[254:255], v253 offset:7168
s_waitcnt lgkmcnt(0)
v_lshlrev_b32 v242, 16, v254
v_and_b32 v243, 0xffff0000, v254
v_mul_f32 v242, v242, v239
v_mul_f32 v243, v243, v239
v_cvt_pk_bf16_f32 v254, v242, v243
v_lshlrev_b32 v242, 16, v255
v_and_b32 v243, 0xffff0000, v255
v_mul_f32 v242, v242, v239
v_mul_f32 v243, v243, v239
v_cvt_pk_bf16_f32 v255, v242, v243
ds_write_b64 v253, v[254:255] offset:7168
s_waitcnt lgkmcnt(0)
ds_read_b64 v[254:255], v253 offset:7176
s_waitcnt lgkmcnt(0)
v_lshlrev_b32 v242, 16, v254
v_and_b32 v243, 0xffff0000, v254
v_mul_f32 v242, v242, v239
v_mul_f32 v243, v243, v239
v_cvt_pk_bf16_f32 v254, v242, v243
v_lshlrev_b32 v242, 16, v255
v_and_b32 v243, 0xffff0000, v255
v_mul_f32 v242, v242, v239
v_mul_f32 v243, v243, v239
v_cvt_pk_bf16_f32 v255, v242, v243
ds_write_b64 v253, v[254:255] offset:7176
s_waitcnt lgkmcnt(0)
v_exp_f32 v232, v128
v_exp_f32 v233, v129
v_exp_f32 v234, v130
v_exp_f32 v235, v131
s_nop 1
v_add_f32 v228, v224, v232
v_add_f32 v228, v228, v233
v_add_f32 v228, v228, v234
v_add_f32 v228, v228, v235
v_cvt_pk_bf16_f32 v176, v232, v233
v_cvt_pk_bf16_f32 v177, v234, v235
v_exp_f32 v232, v132
v_exp_f32 v233, v133
v_exp_f32 v234, v134
v_exp_f32 v235, v135
s_nop 1
v_add_f32 v229, v225, v232
v_add_f32 v229, v229, v233
v_add_f32 v229, v229, v234
v_add_f32 v229, v229, v235
v_cvt_pk_bf16_f32 v180, v232, v233
v_cvt_pk_bf16_f32 v181, v234, v235
v_exp_f32 v232, v136
v_exp_f32 v233, v137
v_exp_f32 v234, v138
v_exp_f32 v235, v139
s_nop 1
v_add_f32 v230, v226, v232
v_add_f32 v230, v230, v233
v_add_f32 v230, v230, v234
v_add_f32 v230, v230, v235
v_cvt_pk_bf16_f32 v184, v232, v233
v_cvt_pk_bf16_f32 v185, v234, v235
v_exp_f32 v232, v140
v_exp_f32 v233, v141
v_exp_f32 v234, v142
v_exp_f32 v235, v143
s_nop 1
v_add_f32 v231, v227, v232
v_add_f32 v231, v231, v233
v_add_f32 v231, v231, v234
v_add_f32 v231, v231, v235
v_cvt_pk_bf16_f32 v188, v232, v233
v_cvt_pk_bf16_f32 v189, v234, v235
s_branch L2_rare_common
L2_rare_site9:
s_mov_b32 s36, 9
s_branch L2_rare_t0_5_1
L2_rare_t0_5_1:
s_nop 15
s_nop 15
s_waitcnt lgkmcnt(0)
v_log_f32 v243, v228
v_max3_f32 v232, v144, v145, v146
v_max3_f32 v232, v232, v147, v243
v_mov_b32 v243, v232
s_nop 1
v_permlane32_swap_b32 v232, v243
s_nop 1
v_max_f32 v232, v232, v243
v_mov_b32 v243, v232
s_nop 1
v_permlane16_swap_b32 v232, v243
s_nop 1
v_max_f32 v232, v232, v243
v_ceil_f32 v232, v232
v_max_f32 v232, 0, v232
v_sub_f32 v243, 0, v232
v_exp_f32 v236, v243
s_nop 1
v_mul_f32 v228, v228, v236
v_add_f32 v244, v244, v232
v_sub_f32 v192, v192, v232
v_sub_f32 v128, v128, v232
v_sub_f32 v144, v144, v232
v_sub_f32 v193, v193, v232
v_sub_f32 v129, v129, v232
v_sub_f32 v145, v145, v232
v_sub_f32 v194, v194, v232
v_sub_f32 v130, v130, v232
v_sub_f32 v146, v146, v232
v_sub_f32 v195, v195, v232
v_sub_f32 v131, v131, v232
v_sub_f32 v147, v147, v232
v_lshlrev_b32 v242, 16, v160
v_and_b32 v243, 0xffff0000, v160
v_mul_f32 v242, v242, v236
v_mul_f32 v243, v243, v236
v_cvt_pk_bf16_f32 v160, v242, v243
v_lshlrev_b32 v242, 16, v161
v_and_b32 v243, 0xffff0000, v161
v_mul_f32 v242, v242, v236
v_mul_f32 v243, v243, v236
v_cvt_pk_bf16_f32 v161, v242, v243
v_lshlrev_b32 v242, 16, v162
v_and_b32 v243, 0xffff0000, v162
v_mul_f32 v242, v242, v236
v_mul_f32 v243, v243, v236
v_cvt_pk_bf16_f32 v162, v242, v243
v_lshlrev_b32 v242, 16, v163
v_and_b32 v243, 0xffff0000, v163
v_mul_f32 v242, v242, v236
v_mul_f32 v243, v243, v236
v_cvt_pk_bf16_f32 v163, v242, v243
v_lshlrev_b32 v242, 16, v176
v_and_b32 v243, 0xffff0000, v176
v_mul_f32 v242, v242, v236
v_mul_f32 v243, v243, v236
v_cvt_pk_bf16_f32 v176, v242, v243
v_lshlrev_b32 v242, 16, v177
v_and_b32 v243, 0xffff0000, v177
v_mul_f32 v242, v242, v236
v_mul_f32 v243, v243, v236
v_cvt_pk_bf16_f32 v177, v242, v243
ds_read_b64 v[254:255], v253 offset:0
s_waitcnt lgkmcnt(0)
v_lshlrev_b32 v242, 16, v254
v_and_b32 v243, 0xffff0000, v254
v_mul_f32 v242, v242, v236
v_mul_f32 v243, v243, v236
v_cvt_pk_bf16_f32 v254, v242, v243
v_lshlrev_b32 v242, 16, v255
v_and_b32 v243, 0xffff0000, v255
v_mul_f32 v242, v242, v236
v_mul_f32 v243, v243, v236
v_cvt_pk_bf16_f32 v255, v242, v243
ds_write_b64 v253, v[254:255] offset:0
s_waitcnt lgkmcnt(0)
ds_read_b64 v[254:255], v253 offset:8
s_waitcnt lgkmcnt(0)
v_lshlrev_b32 v242, 16, v254
v_and_b32 v243, 0xffff0000, v254
v_mul_f32 v242, v242, v236
v_mul_f32 v243, v243, v236
v_cvt_pk_bf16_f32 v254, v242, v243
v_lshlrev_b32 v242, 16, v255
v_and_b32 v243, 0xffff0000, v255
v_mul_f32 v242, v242, v236
v_mul_f32 v243, v243, v236
v_cvt_pk_bf16_f32 v255, v242, v243
ds_write_b64 v253, v[254:255] offset:8
s_waitcnt lgkmcnt(0)
ds_read_b64 v[254:255], v253 offset:4096
s_waitcnt lgkmcnt(0)
v_lshlrev_b32 v242, 16, v254
v_and_b32 v243, 0xffff0000, v254
v_mul_f32 v242, v242, v236
v_mul_f32 v243, v243, v236
v_cvt_pk_bf16_f32 v254, v242, v243
v_lshlrev_b32 v242, 16, v255
v_and_b32 v243, 0xffff0000, v255
v_mul_f32 v242, v242, v236
v_mul_f32 v243, v243, v236
v_cvt_pk_bf16_f32 v255, v242, v243
ds_write_b64 v253, v[254:255] offset:4096
s_waitcnt lgkmcnt(0)
ds_read_b64 v[254:255], v253 offset:4104
s_waitcnt lgkmcnt(0)
v_lshlrev_b32 v242, 16, v254
v_and_b32 v243, 0xffff0000, v254
v_mul_f32 v242, v242, v236
v_mul_f32 v243, v243, v236
v_cvt_pk_bf16_f32 v254, v242, v243
v_lshlrev_b32 v242, 16, v255
v_and_b32 v243, 0xffff0000, v255
v_mul_f32 v242, v242, v236
v_mul_f32 v243, v243, v236
v_cvt_pk_bf16_f32 v255, v242, v243
ds_write_b64 v253, v[254:255] offset:4104
s_waitcnt lgkmcnt(0)
v_log_f32 v243, v229
v_max3_f32 v233, v148, v149, v150
v_max3_f32 v233, v233, v151, v243
v_mov_b32 v243, v233
s_nop 1
v_permlane32_swap_b32 v233, v243
s_nop 1
v_max_f32 v233, v233, v243
v_mov_b32 v243, v233
s_nop 1
v_permlane16_swap_b32 v233, v243
s_nop 1
v_max_f32 v233, v233, v243
v_ceil_f32 v233, v233
v_max_f32 v233, 0, v233
v_sub_f32 v243, 0, v233
v_exp_f32 v237, v243
s_nop 1
v_mul_f32 v229, v229, v237
v_add_f32 v245, v245, v233
v_sub_f32 v196, v196, v233
v_sub_f32 v132, v132, v233
v_sub_f32 v148, v148, v233
v_sub_f32 v197, v197, v233
v_sub_f32 v133, v133, v233
v_sub_f32 v149, v149, v233
v_sub_f32 v198, v198, v233
v_sub_f32 v134, v134, v233
v_sub_f32 v150, v150, v233
v_sub_f32 v199, v199, v233
v_sub_f32 v135, v135, v233
v_sub_f32 v151, v151, v233
v_lshlrev_b32 v242, 16, v164
v_and_b32 v243, 0xffff0000, v164
v_mul_f32 v242, v242, v237
v_mul_f32 v243, v243, v237
v_cvt_pk_bf16_f32 v164, v242, v243
v_lshlrev_b32 v242, 16, v165
v_and_b32 v243, 0xffff0000, v165
v_mul_f32 v242, v242, v237
v_mul_f32 v243, v243, v237
v_cvt_pk_bf16_f32 v165, v242, v243
v_lshlrev_b32 v242, 16, v166
v_and_b32 v243, 0xffff0000, v166
v_mul_f32 v242, v242, v237
v_mul_f32 v243, v243, v237
v_cvt_pk_bf16_f32 v166, v242, v243
v_lshlrev_b32 v242, 16, v167
v_and_b32 v243, 0xffff0000, v167
v_mul_f32 v242, v242, v237
v_mul_f32 v243, v243, v237
v_cvt_pk_bf16_f32 v167, v242, v243
v_lshlrev_b32 v242, 16, v180
v_and_b32 v243, 0xffff0000, v180
v_mul_f32 v242, v242, v237
v_mul_f32 v243, v243, v237
v_cvt_pk_bf16_f32 v180, v242, v243
v_lshlrev_b32 v242, 16, v181
v_and_b32 v243, 0xffff0000, v181
v_mul_f32 v242, v242, v237
v_mul_f32 v243, v243, v237
v_cvt_pk_bf16_f32 v181, v242, v243
ds_read_b64 v[254:255], v253 offset:1024
s_waitcnt lgkmcnt(0)
v_lshlrev_b32 v242, 16, v254
v_and_b32 v243, 0xffff0000, v254
v_mul_f32 v242, v242, v237
v_mul_f32 v243, v243, v237
v_cvt_pk_bf16_f32 v254, v242, v243
v_lshlrev_b32 v242, 16, v255
v_and_b32 v243, 0xffff0000, v255
v_mul_f32 v242, v242, v237
v_mul_f32 v243, v243, v237
v_cvt_pk_bf16_f32 v255, v242, v243
ds_write_b64 v253, v[254:255] offset:1024
s_waitcnt lgkmcnt(0)
ds_read_b64 v[254:255], v253 offset:1032
s_waitcnt lgkmcnt(0)
v_lshlrev_b32 v242, 16, v254
v_and_b32 v243, 0xffff0000, v254
v_mul_f32 v242, v242, v237
v_mul_f32 v243, v243, v237
v_cvt_pk_bf16_f32 v254, v242, v243
v_lshlrev_b32 v242, 16, v255
v_and_b32 v243, 0xffff0000, v255
v_mul_f32 v242, v242, v237
v_mul_f32 v243, v243, v237
v_cvt_pk_bf16_f32 v255, v242, v243
ds_write_b64 v253, v[254:255] offset:1032
s_waitcnt lgkmcnt(0)
ds_read_b64 v[254:255], v253 offset:5120
s_waitcnt lgkmcnt(0)
v_lshlrev_b32 v242, 16, v254
v_and_b32 v243, 0xffff0000, v254
v_mul_f32 v242, v242, v237
v_mul_f32 v243, v243, v237
v_cvt_pk_bf16_f32 v254, v242, v243
v_lshlrev_b32 v242, 16, v255
v_and_b32 v243, 0xffff0000, v255
v_mul_f32 v242, v242, v237
v_mul_f32 v243, v243, v237
v_cvt_pk_bf16_f32 v255, v242, v243
ds_write_b64 v253, v[254:255] offset:5120
s_waitcnt lgkmcnt(0)
ds_read_b64 v[254:255], v253 offset:5128
s_waitcnt lgkmcnt(0)
v_lshlrev_b32 v242, 16, v254
v_and_b32 v243, 0xffff0000, v254
v_mul_f32 v242, v242, v237
v_mul_f32 v243, v243, v237
v_cvt_pk_bf16_f32 v254, v242, v243
v_lshlrev_b32 v242, 16, v255
v_and_b32 v243, 0xffff0000, v255
v_mul_f32 v242, v242, v237
v_mul_f32 v243, v243, v237
v_cvt_pk_bf16_f32 v255, v242, v243
ds_write_b64 v253, v[254:255] offset:5128
s_waitcnt lgkmcnt(0)
v_log_f32 v243, v230
v_max3_f32 v234, v152, v153, v154
v_max3_f32 v234, v234, v155, v243
v_mov_b32 v243, v234
s_nop 1
v_permlane32_swap_b32 v234, v243
s_nop 1
v_max_f32 v234, v234, v243
v_mov_b32 v243, v234
s_nop 1
v_permlane16_swap_b32 v234, v243
s_nop 1
v_max_f32 v234, v234, v243
v_ceil_f32 v234, v234
v_max_f32 v234, 0, v234
v_sub_f32 v243, 0, v234
v_exp_f32 v238, v243
s_nop 1
v_mul_f32 v230, v230, v238
v_add_f32 v246, v246, v234
v_sub_f32 v200, v200, v234
v_sub_f32 v136, v136, v234
v_sub_f32 v152, v152, v234
v_sub_f32 v201, v201, v234
v_sub_f32 v137, v137, v234
v_sub_f32 v153, v153, v234
v_sub_f32 v202, v202, v234
v_sub_f32 v138, v138, v234
v_sub_f32 v154, v154, v234
v_sub_f32 v203, v203, v234
v_sub_f32 v139, v139, v234
v_sub_f32 v155, v155, v234
v_lshlrev_b32 v242, 16, v168
v_and_b32 v243, 0xffff0000, v168
v_mul_f32 v242, v242, v238
v_mul_f32 v243, v243, v238
v_cvt_pk_bf16_f32 v168, v242, v243
v_lshlrev_b32 v242, 16, v169
v_and_b32 v243, 0xffff0000, v169
v_mul_f32 v242, v242, v238
v_mul_f32 v243, v243, v238
v_cvt_pk_bf16_f32 v169, v242, v243
v_lshlrev_b32 v242, 16, v170
v_and_b32 v243, 0xffff0000, v170
v_mul_f32 v242, v242, v238
v_mul_f32 v243, v243, v238
v_cvt_pk_bf16_f32 v170, v242, v243
v_lshlrev_b32 v242, 16, v171
v_and_b32 v243, 0xffff0000, v171
v_mul_f32 v242, v242, v238
v_mul_f32 v243, v243, v238
v_cvt_pk_bf16_f32 v171, v242, v243
v_lshlrev_b32 v242, 16, v184
v_and_b32 v243, 0xffff0000, v184
v_mul_f32 v242, v242, v238
v_mul_f32 v243, v243, v238
v_cvt_pk_bf16_f32 v184, v242, v243
v_lshlrev_b32 v242, 16, v185
v_and_b32 v243, 0xffff0000, v185
v_mul_f32 v242, v242, v238
v_mul_f32 v243, v243, v238
v_cvt_pk_bf16_f32 v185, v242, v243
ds_read_b64 v[254:255], v253 offset:2048
s_waitcnt lgkmcnt(0)
v_lshlrev_b32 v242, 16, v254
v_and_b32 v243, 0xffff0000, v254
v_mul_f32 v242, v242, v238
v_mul_f32 v243, v243, v238
v_cvt_pk_bf16_f32 v254, v242, v243
v_lshlrev_b32 v242, 16, v255
v_and_b32 v243, 0xffff0000, v255
v_mul_f32 v242, v242, v238
v_mul_f32 v243, v243, v238
v_cvt_pk_bf16_f32 v255, v242, v243
ds_write_b64 v253, v[254:255] offset:2048
s_waitcnt lgkmcnt(0)
ds_read_b64 v[254:255], v253 offset:2056
s_waitcnt lgkmcnt(0)
v_lshlrev_b32 v242, 16, v254
v_and_b32 v243, 0xffff0000, v254
v_mul_f32 v242, v242, v238
v_mul_f32 v243, v243, v238
v_cvt_pk_bf16_f32 v254, v242, v243
v_lshlrev_b32 v242, 16, v255
v_and_b32 v243, 0xffff0000, v255
v_mul_f32 v242, v242, v238
v_mul_f32 v243, v243, v238
v_cvt_pk_bf16_f32 v255, v242, v243
ds_write_b64 v253, v[254:255] offset:2056
s_waitcnt lgkmcnt(0)
ds_read_b64 v[254:255], v253 offset:6144
s_waitcnt lgkmcnt(0)
v_lshlrev_b32 v242, 16, v254
v_and_b32 v243, 0xffff0000, v254
v_mul_f32 v242, v242, v238
v_mul_f32 v243, v243, v238
v_cvt_pk_bf16_f32 v254, v242, v243
v_lshlrev_b32 v242, 16, v255
v_and_b32 v243, 0xffff0000, v255
v_mul_f32 v242, v242, v238
v_mul_f32 v243, v243, v238
v_cvt_pk_bf16_f32 v255, v242, v243
ds_write_b64 v253, v[254:255] offset:6144
s_waitcnt lgkmcnt(0)
ds_read_b64 v[254:255], v253 offset:6152
s_waitcnt lgkmcnt(0)
v_lshlrev_b32 v242, 16, v254
v_and_b32 v243, 0xffff0000, v254
v_mul_f32 v242, v242, v238
v_mul_f32 v243, v243, v238
v_cvt_pk_bf16_f32 v254, v242, v243
v_lshlrev_b32 v242, 16, v255
v_and_b32 v243, 0xffff0000, v255
v_mul_f32 v242, v242, v238
v_mul_f32 v243, v243, v238
v_cvt_pk_bf16_f32 v255, v242, v243
ds_write_b64 v253, v[254:255] offset:6152
s_waitcnt lgkmcnt(0)
v_log_f32 v243, v231
v_max3_f32 v235, v156, v157, v158
v_max3_f32 v235, v235, v159, v243
v_mov_b32 v243, v235
s_nop 1
v_permlane32_swap_b32 v235, v243
s_nop 1
v_max_f32 v235, v235, v243
v_mov_b32 v243, v235
s_nop 1
v_permlane16_swap_b32 v235, v243
s_nop 1
v_max_f32 v235, v235, v243
v_ceil_f32 v235, v235
v_max_f32 v235, 0, v235
v_sub_f32 v243, 0, v235
v_exp_f32 v239, v243
s_nop 1
v_mul_f32 v231, v231, v239
v_add_f32 v247, v247, v235
v_sub_f32 v204, v204, v235
v_sub_f32 v140, v140, v235
v_sub_f32 v156, v156, v235
v_sub_f32 v205, v205, v235
v_sub_f32 v141, v141, v235
v_sub_f32 v157, v157, v235
v_sub_f32 v206, v206, v235
v_sub_f32 v142, v142, v235
v_sub_f32 v158, v158, v235
v_sub_f32 v207, v207, v235
v_sub_f32 v143, v143, v235
v_sub_f32 v159, v159, v235
v_lshlrev_b32 v242, 16, v172
v_and_b32 v243, 0xffff0000, v172
v_mul_f32 v242, v242, v239
v_mul_f32 v243, v243, v239
v_cvt_pk_bf16_f32 v172, v242, v243
v_lshlrev_b32 v242, 16, v173
v_and_b32 v243, 0xffff0000, v173
v_mul_f32 v242, v242, v239
v_mul_f32 v243, v243, v239
v_cvt_pk_bf16_f32 v173, v242, v243
v_lshlrev_b32 v242, 16, v174
v_and_b32 v243, 0xffff0000, v174
v_mul_f32 v242, v242, v239
v_mul_f32 v243, v243, v239
v_cvt_pk_bf16_f32 v174, v242, v243
v_lshlrev_b32 v242, 16, v175
v_and_b32 v243, 0xffff0000, v175
v_mul_f32 v242, v242, v239
v_mul_f32 v243, v243, v239
v_cvt_pk_bf16_f32 v175, v242, v243
v_lshlrev_b32 v242, 16, v188
v_and_b32 v243, 0xffff0000, v188
v_mul_f32 v242, v242, v239
v_mul_f32 v243, v243, v239
v_cvt_pk_bf16_f32 v188, v242, v243
v_lshlrev_b32 v242, 16, v189
v_and_b32 v243, 0xffff0000, v189
v_mul_f32 v242, v242, v239
v_mul_f32 v243, v243, v239
v_cvt_pk_bf16_f32 v189, v242, v243
ds_read_b64 v[254:255], v253 offset:3072
s_waitcnt lgkmcnt(0)
v_lshlrev_b32 v242, 16, v254
v_and_b32 v243, 0xffff0000, v254
v_mul_f32 v242, v242, v239
v_mul_f32 v243, v243, v239
v_cvt_pk_bf16_f32 v254, v242, v243
v_lshlrev_b32 v242, 16, v255
v_and_b32 v243, 0xffff0000, v255
v_mul_f32 v242, v242, v239
v_mul_f32 v243, v243, v239
v_cvt_pk_bf16_f32 v255, v242, v243
ds_write_b64 v253, v[254:255] offset:3072
s_waitcnt lgkmcnt(0)
ds_read_b64 v[254:255], v253 offset:3080
s_waitcnt lgkmcnt(0)
v_lshlrev_b32 v242, 16, v254
v_and_b32 v243, 0xffff0000, v254
v_mul_f32 v242, v242, v239
v_mul_f32 v243, v243, v239
v_cvt_pk_bf16_f32 v254, v242, v243
v_lshlrev_b32 v242, 16, v255
v_and_b32 v243, 0xffff0000, v255
v_mul_f32 v242, v242, v239
v_mul_f32 v243, v243, v239
v_cvt_pk_bf16_f32 v255, v242, v243
ds_write_b64 v253, v[254:255] offset:3080
s_waitcnt lgkmcnt(0)
ds_read_b64 v[254:255], v253 offset:7168
s_waitcnt lgkmcnt(0)
v_lshlrev_b32 v242, 16, v254
v_and_b32 v243, 0xffff0000, v254
v_mul_f32 v242, v242, v239
v_mul_f32 v243, v243, v239
v_cvt_pk_bf16_f32 v254, v242, v243
v_lshlrev_b32 v242, 16, v255
v_and_b32 v243, 0xffff0000, v255
v_mul_f32 v242, v242, v239
v_mul_f32 v243, v243, v239
v_cvt_pk_bf16_f32 v255, v242, v243
ds_write_b64 v253, v[254:255] offset:7168
s_waitcnt lgkmcnt(0)
ds_read_b64 v[254:255], v253 offset:7176
s_waitcnt lgkmcnt(0)
v_lshlrev_b32 v242, 16, v254
v_and_b32 v243, 0xffff0000, v254
v_mul_f32 v242, v242, v239
v_mul_f32 v243, v243, v239
v_cvt_pk_bf16_f32 v254, v242, v243
v_lshlrev_b32 v242, 16, v255
v_and_b32 v243, 0xffff0000, v255
v_mul_f32 v242, v242, v239
v_mul_f32 v243, v243, v239
v_cvt_pk_bf16_f32 v255, v242, v243
ds_write_b64 v253, v[254:255] offset:7176
s_waitcnt lgkmcnt(0)
v_exp_f32 v232, v144
v_exp_f32 v233, v145
v_exp_f32 v234, v146
v_exp_f32 v235, v147
s_nop 1
v_add_f32 v224, v228, v232
v_add_f32 v224, v224, v233
v_add_f32 v224, v224, v234
v_add_f32 v224, v224, v235
v_cvt_pk_bf16_f32 v178, v232, v233
v_cvt_pk_bf16_f32 v179, v234, v235
v_exp_f32 v232, v148
v_exp_f32 v233, v149
v_exp_f32 v234, v150
v_exp_f32 v235, v151
s_nop 1
v_add_f32 v225, v229, v232
v_add_f32 v225, v225, v233
v_add_f32 v225, v225, v234
v_add_f32 v225, v225, v235
v_cvt_pk_bf16_f32 v182, v232, v233
v_cvt_pk_bf16_f32 v183, v234, v235
v_exp_f32 v232, v152
v_exp_f32 v233, v153
v_exp_f32 v234, v154
v_exp_f32 v235, v155
s_nop 1
v_add_f32 v226, v230, v232
v_add_f32 v226, v226, v233
v_add_f32 v226, v226, v234
v_add_f32 v226, v226, v235
v_cvt_pk_bf16_f32 v186, v232, v233
v_cvt_pk_bf16_f32 v187, v234, v235
v_exp_f32 v232, v156
v_exp_f32 v233, v157
v_exp_f32 v234, v158
v_exp_f32 v235, v159
s_nop 1
v_add_f32 v227, v231, v232
v_add_f32 v227, v227, v233
v_add_f32 v227, v227, v234
v_add_f32 v227, v227, v235
v_cvt_pk_bf16_f32 v190, v232, v233
v_cvt_pk_bf16_f32 v191, v234, v235
s_branch L2_rare_common
L2_rare_site10:
s_mov_b32 s36, 10
s_branch L2_rare_t0_6_0
L2_rare_t0_6_0:
s_nop 15
s_nop 15
s_waitcnt lgkmcnt(0)
v_log_f32 v243, v224
v_max3_f32 v232, v128, v129, v130
v_max3_f32 v232, v232, v131, v243
v_mov_b32 v243, v232
s_nop 1
v_permlane32_swap_b32 v232, v243
s_nop 1
v_max_f32 v232, v232, v243
v_mov_b32 v243, v232
s_nop 1
v_permlane16_swap_b32 v232, v243
s_nop 1
v_max_f32 v232, v232, v243
v_ceil_f32 v232, v232
v_max_f32 v232, 0, v232
v_sub_f32 v243, 0, v232
v_exp_f32 v236, v243
s_nop 1
v_mul_f32 v224, v224, v236
v_add_f32 v244, v244, v232
v_sub_f32 v192, v192, v232
v_sub_f32 v128, v128, v232
v_sub_f32 v144, v144, v232
v_sub_f32 v193, v193, v232
v_sub_f32 v129, v129, v232
v_sub_f32 v145, v145, v232
v_sub_f32 v194, v194, v232
v_sub_f32 v130, v130, v232
v_sub_f32 v146, v146, v232
v_sub_f32 v195, v195, v232
v_sub_f32 v131, v131, v232
v_sub_f32 v147, v147, v232
v_lshlrev_b32 v242, 16, v4
v_and_b32 v243, 0xffff0000, v4
v_mul_f32 v242, v242, v236
v_mul_f32 v243, v243, v236
v_cvt_pk_bf16_f32 v4, v242, v243
v_lshlrev_b32 v242, 16, v5
v_and_b32 v243, 0xffff0000, v5
v_mul_f32 v242, v242, v236
v_mul_f32 v243, v243, v236
v_cvt_pk_bf16_f32 v5, v242, v243
v_lshlrev_b32 v242, 16, v6
v_and_b32 v243, 0xffff0000, v6
v_mul_f32 v242, v242, v236
v_mul_f32 v243, v243, v236
v_cvt_pk_bf16_f32 v6, v242, v243
v_lshlrev_b32 v242, 16, v7
v_and_b32 v243, 0xffff0000, v7
v_mul_f32 v242, v242, v236
v_mul_f32 v243, v243, v236
v_cvt_pk_bf16_f32 v7, v242, v243
v_lshlrev_b32 v242, 16, v8
v_and_b32 v243, 0xffff0000, v8
v_mul_f32 v242, v242, v236
v_mul_f32 v243, v243, v236
v_cvt_pk_bf16_f32 v8, v242, v243
v_lshlrev_b32 v242, 16, v9
v_and_b32 v243, 0xffff0000, v9
v_mul_f32 v242, v242, v236
v_mul_f32 v243, v243, v236
v_cvt_pk_bf16_f32 v9, v242, v243
v_lshlrev_b32 v242, 16, v10
v_and_b32 v243, 0xffff0000, v10
v_mul_f32 v242, v242, v236
v_mul_f32 v243, v243, v236
v_cvt_pk_bf16_f32 v10, v242, v243
v_lshlrev_b32 v242, 16, v11
v_and_b32 v243, 0xffff0000, v11
v_mul_f32 v242, v242, v236
v_mul_f32 v243, v243, v236
v_cvt_pk_bf16_f32 v11, v242, v243
v_lshlrev_b32 v242, 16, v160
v_and_b32 v243, 0xffff0000, v160
v_mul_f32 v242, v242, v236
v_mul_f32 v243, v243, v236
v_cvt_pk_bf16_f32 v160, v242, v243
v_lshlrev_b32 v242, 16, v161
v_and_b32 v243, 0xffff0000, v161
v_mul_f32 v242, v242, v236
v_mul_f32 v243, v243, v236
v_cvt_pk_bf16_f32 v161, v242, v243
v_lshlrev_b32 v242, 16, v162
v_and_b32 v243, 0xffff0000, v162
v_mul_f32 v242, v242, v236
v_mul_f32 v243, v243, v236
v_cvt_pk_bf16_f32 v162, v242, v243
v_lshlrev_b32 v242, 16, v163
v_and_b32 v243, 0xffff0000, v163
v_mul_f32 v242, v242, v236
v_mul_f32 v243, v243, v236
v_cvt_pk_bf16_f32 v163, v242, v243
v_lshlrev_b32 v242, 16, v176
v_and_b32 v243, 0xffff0000, v176
v_mul_f32 v242, v242, v236
v_mul_f32 v243, v243, v236
v_cvt_pk_bf16_f32 v176, v242, v243
v_lshlrev_b32 v242, 16, v177
v_and_b32 v243, 0xffff0000, v177
v_mul_f32 v242, v242, v236
v_mul_f32 v243, v243, v236
v_cvt_pk_bf16_f32 v177, v242, v243
v_lshlrev_b32 v242, 16, v178
v_and_b32 v243, 0xffff0000, v178
v_mul_f32 v242, v242, v236
v_mul_f32 v243, v243, v236
v_cvt_pk_bf16_f32 v178, v242, v243
v_lshlrev_b32 v242, 16, v179
v_and_b32 v243, 0xffff0000, v179
v_mul_f32 v242, v242, v236
v_mul_f32 v243, v243, v236
v_cvt_pk_bf16_f32 v179, v242, v243
v_log_f32 v243, v225
v_max3_f32 v233, v132, v133, v134
v_max3_f32 v233, v233, v135, v243
v_mov_b32 v243, v233
s_nop 1
v_permlane32_swap_b32 v233, v243
s_nop 1
v_max_f32 v233, v233, v243
v_mov_b32 v243, v233
s_nop 1
v_permlane16_swap_b32 v233, v243
s_nop 1
v_max_f32 v233, v233, v243
v_ceil_f32 v233, v233
v_max_f32 v233, 0, v233
v_sub_f32 v243, 0, v233
v_exp_f32 v237, v243
s_nop 1
v_mul_f32 v225, v225, v237
v_add_f32 v245, v245, v233
v_sub_f32 v196, v196, v233
v_sub_f32 v132, v132, v233
v_sub_f32 v148, v148, v233
v_sub_f32 v197, v197, v233
v_sub_f32 v133, v133, v233
v_sub_f32 v149, v149, v233
v_sub_f32 v198, v198, v233
v_sub_f32 v134, v134, v233
v_sub_f32 v150, v150, v233
v_sub_f32 v199, v199, v233
v_sub_f32 v135, v135, v233
v_sub_f32 v151, v151, v233
v_lshlrev_b32 v242, 16, v36
v_and_b32 v243, 0xffff0000, v36
v_mul_f32 v242, v242, v237
v_mul_f32 v243, v243, v237
v_cvt_pk_bf16_f32 v36, v242, v243
v_lshlrev_b32 v242, 16, v37
v_and_b32 v243, 0xffff0000, v37
v_mul_f32 v242, v242, v237
v_mul_f32 v243, v243, v237
v_cvt_pk_bf16_f32 v37, v242, v243
v_lshlrev_b32 v242, 16, v38
v_and_b32 v243, 0xffff0000, v38
v_mul_f32 v242, v242, v237
v_mul_f32 v243, v243, v237
v_cvt_pk_bf16_f32 v38, v242, v243
v_lshlrev_b32 v242, 16, v39
v_and_b32 v243, 0xffff0000, v39
v_mul_f32 v242, v242, v237
v_mul_f32 v243, v243, v237
v_cvt_pk_bf16_f32 v39, v242, v243
v_lshlrev_b32 v242, 16, v40
v_and_b32 v243, 0xffff0000, v40
v_mul_f32 v242, v242, v237
v_mul_f32 v243, v243, v237
v_cvt_pk_bf16_f32 v40, v242, v243
v_lshlrev_b32 v242, 16, v41
v_and_b32 v243, 0xffff0000, v41
v_mul_f32 v242, v242, v237
v_mul_f32 v243, v243, v237
v_cvt_pk_bf16_f32 v41, v242, v243
v_lshlrev_b32 v242, 16, v42
v_and_b32 v243, 0xffff0000, v42
v_mul_f32 v242, v242, v237
v_mul_f32 v243, v243, v237
v_cvt_pk_bf16_f32 v42, v242, v243
v_lshlrev_b32 v242, 16, v43
v_and_b32 v243, 0xffff0000, v43
v_mul_f32 v242, v242, v237
v_mul_f32 v243, v243, v237
v_cvt_pk_bf16_f32 v43, v242, v243
v_lshlrev_b32 v242, 16, v164
v_and_b32 v243, 0xffff0000, v164
v_mul_f32 v242, v242, v237
v_mul_f32 v243, v243, v237
v_cvt_pk_bf16_f32 v164, v242, v243
v_lshlrev_b32 v242, 16, v165
v_and_b32 v243, 0xffff0000, v165
v_mul_f32 v242, v242, v237
v_mul_f32 v243, v243, v237
v_cvt_pk_bf16_f32 v165, v242, v243
v_lshlrev_b32 v242, 16, v166
v_and_b32 v243, 0xffff0000, v166
v_mul_f32 v242, v242, v237
v_mul_f32 v243, v243, v237
v_cvt_pk_bf16_f32 v166, v242, v243
v_lshlrev_b32 v242, 16, v167
v_and_b32 v243, 0xffff0000, v167
v_mul_f32 v242, v242, v237
v_mul_f32 v243, v243, v237
v_cvt_pk_bf16_f32 v167, v242, v243
v_lshlrev_b32 v242, 16, v180
v_and_b32 v243, 0xffff0000, v180
v_mul_f32 v242, v242, v237
v_mul_f32 v243, v243, v237
v_cvt_pk_bf16_f32 v180, v242, v243
v_lshlrev_b32 v242, 16, v181
v_and_b32 v243, 0xffff0000, v181
v_mul_f32 v242, v242, v237
v_mul_f32 v243, v243, v237
v_cvt_pk_bf16_f32 v181, v242, v243
v_lshlrev_b32 v242, 16, v182
v_and_b32 v243, 0xffff0000, v182
v_mul_f32 v242, v242, v237
v_mul_f32 v243, v243, v237
v_cvt_pk_bf16_f32 v182, v242, v243
v_lshlrev_b32 v242, 16, v183
v_and_b32 v243, 0xffff0000, v183
v_mul_f32 v242, v242, v237
v_mul_f32 v243, v243, v237
v_cvt_pk_bf16_f32 v183, v242, v243
v_log_f32 v243, v226
v_max3_f32 v234, v136, v137, v138
v_max3_f32 v234, v234, v139, v243
v_mov_b32 v243, v234
s_nop 1
v_permlane32_swap_b32 v234, v243
s_nop 1
v_max_f32 v234, v234, v243
v_mov_b32 v243, v234
s_nop 1
v_permlane16_swap_b32 v234, v243
s_nop 1
v_max_f32 v234, v234, v243
v_ceil_f32 v234, v234
v_max_f32 v234, 0, v234
v_sub_f32 v243, 0, v234
v_exp_f32 v238, v243
s_nop 1
v_mul_f32 v226, v226, v238
v_add_f32 v246, v246, v234
v_sub_f32 v200, v200, v234
v_sub_f32 v136, v136, v234
v_sub_f32 v152, v152, v234
v_sub_f32 v201, v201, v234
v_sub_f32 v137, v137, v234
v_sub_f32 v153, v153, v234
v_sub_f32 v202, v202, v234
v_sub_f32 v138, v138, v234
v_sub_f32 v154, v154, v234
v_sub_f32 v203, v203, v234
v_sub_f32 v139, v139, v234
v_sub_f32 v155, v155, v234
v_lshlrev_b32 v242, 16, v68
v_and_b32 v243, 0xffff0000, v68
v_mul_f32 v242, v242, v238
v_mul_f32 v243, v243, v238
v_cvt_pk_bf16_f32 v68, v242, v243
v_lshlrev_b32 v242, 16, v69
v_and_b32 v243, 0xffff0000, v69
v_mul_f32 v242, v242, v238
v_mul_f32 v243, v243, v238
v_cvt_pk_bf16_f32 v69, v242, v243
v_lshlrev_b32 v242, 16, v70
v_and_b32 v243, 0xffff0000, v70
v_mul_f32 v242, v242, v238
v_mul_f32 v243, v243, v238
v_cvt_pk_bf16_f32 v70, v242, v243
v_lshlrev_b32 v242, 16, v71
v_and_b32 v243, 0xffff0000, v71
v_mul_f32 v242, v242, v238
v_mul_f32 v243, v243, v238
v_cvt_pk_bf16_f32 v71, v242, v243
v_lshlrev_b32 v242, 16, v72
v_and_b32 v243, 0xffff0000, v72
v_mul_f32 v242, v242, v238
v_mul_f32 v243, v243, v238
v_cvt_pk_bf16_f32 v72, v242, v243
v_lshlrev_b32 v242, 16, v73
v_and_b32 v243, 0xffff0000, v73
v_mul_f32 v242, v242, v238
v_mul_f32 v243, v243, v238
v_cvt_pk_bf16_f32 v73, v242, v243
v_lshlrev_b32 v242, 16, v74
v_and_b32 v243, 0xffff0000, v74
v_mul_f32 v242, v242, v238
v_mul_f32 v243, v243, v238
v_cvt_pk_bf16_f32 v74, v242, v243
v_lshlrev_b32 v242, 16, v75
v_and_b32 v243, 0xffff0000, v75
v_mul_f32 v242, v242, v238
v_mul_f32 v243, v243, v238
v_cvt_pk_bf16_f32 v75, v242, v243
v_lshlrev_b32 v242, 16, v168
v_and_b32 v243, 0xffff0000, v168
v_mul_f32 v242, v242, v238
v_mul_f32 v243, v243, v238
v_cvt_pk_bf16_f32 v168, v242, v243
v_lshlrev_b32 v242, 16, v169
v_and_b32 v243, 0xffff0000, v169
v_mul_f32 v242, v242, v238
v_mul_f32 v243, v243, v238
v_cvt_pk_bf16_f32 v169, v242, v243
v_lshlrev_b32 v242, 16, v170
v_and_b32 v243, 0xffff0000, v170
v_mul_f32 v242, v242, v238
v_mul_f32 v243, v243, v238
v_cvt_pk_bf16_f32 v170, v242, v243
v_lshlrev_b32 v242, 16, v171
v_and_b32 v243, 0xffff0000, v171
v_mul_f32 v242, v242, v238
v_mul_f32 v243, v243, v238
v_cvt_pk_bf16_f32 v171, v242, v243
v_lshlrev_b32 v242, 16, v184
v_and_b32 v243, 0xffff0000, v184
v_mul_f32 v242, v242, v238
v_mul_f32 v243, v243, v238
v_cvt_pk_bf16_f32 v184, v242, v243
v_lshlrev_b32 v242, 16, v185
v_and_b32 v243, 0xffff0000, v185
v_mul_f32 v242, v242, v238
v_mul_f32 v243, v243, v238
v_cvt_pk_bf16_f32 v185, v242, v243
v_lshlrev_b32 v242, 16, v186
v_and_b32 v243, 0xffff0000, v186
v_mul_f32 v242, v242, v238
v_mul_f32 v243, v243, v238
v_cvt_pk_bf16_f32 v186, v242, v243
v_lshlrev_b32 v242, 16, v187
v_and_b32 v243, 0xffff0000, v187
v_mul_f32 v242, v242, v238
v_mul_f32 v243, v243, v238
v_cvt_pk_bf16_f32 v187, v242, v243
v_log_f32 v243, v227
v_max3_f32 v235, v140, v141, v142
v_max3_f32 v235, v235, v143, v243
v_mov_b32 v243, v235
s_nop 1
v_permlane32_swap_b32 v235, v243
s_nop 1
v_max_f32 v235, v235, v243
v_mov_b32 v243, v235
s_nop 1
v_permlane16_swap_b32 v235, v243
s_nop 1
v_max_f32 v235, v235, v243
v_ceil_f32 v235, v235
v_max_f32 v235, 0, v235
v_sub_f32 v243, 0, v235
v_exp_f32 v239, v243
s_nop 1
v_mul_f32 v227, v227, v239
v_add_f32 v247, v247, v235
v_sub_f32 v204, v204, v235
v_sub_f32 v140, v140, v235
v_sub_f32 v156, v156, v235
v_sub_f32 v205, v205, v235
v_sub_f32 v141, v141, v235
v_sub_f32 v157, v157, v235
v_sub_f32 v206, v206, v235
v_sub_f32 v142, v142, v235
v_sub_f32 v158, v158, v235
v_sub_f32 v207, v207, v235
v_sub_f32 v143, v143, v235
v_sub_f32 v159, v159, v235
v_lshlrev_b32 v242, 16, v100
v_and_b32 v243, 0xffff0000, v100
v_mul_f32 v242, v242, v239
v_mul_f32 v243, v243, v239
v_cvt_pk_bf16_f32 v100, v242, v243
v_lshlrev_b32 v242, 16, v101
v_and_b32 v243, 0xffff0000, v101
v_mul_f32 v242, v242, v239
v_mul_f32 v243, v243, v239
v_cvt_pk_bf16_f32 v101, v242, v243
v_lshlrev_b32 v242, 16, v102
v_and_b32 v243, 0xffff0000, v102
v_mul_f32 v242, v242, v239
v_mul_f32 v243, v243, v239
v_cvt_pk_bf16_f32 v102, v242, v243
v_lshlrev_b32 v242, 16, v103
v_and_b32 v243, 0xffff0000, v103
v_mul_f32 v242, v242, v239
v_mul_f32 v243, v243, v239
v_cvt_pk_bf16_f32 v103, v242, v243
v_lshlrev_b32 v242, 16, v104
v_and_b32 v243, 0xffff0000, v104
v_mul_f32 v242, v242, v239
v_mul_f32 v243, v243, v239
v_cvt_pk_bf16_f32 v104, v242, v243
v_lshlrev_b32 v242, 16, v105
v_and_b32 v243, 0xffff0000, v105
v_mul_f32 v242, v242, v239
v_mul_f32 v243, v243, v239
v_cvt_pk_bf16_f32 v105, v242, v243
v_lshlrev_b32 v242, 16, v106
v_and_b32 v243, 0xffff0000, v106
v_mul_f32 v242, v242, v239
v_mul_f32 v243, v243, v239
v_cvt_pk_bf16_f32 v106, v242, v243
v_lshlrev_b32 v242, 16, v107
v_and_b32 v243, 0xffff0000, v107
v_mul_f32 v242, v242, v239
v_mul_f32 v243, v243, v239
v_cvt_pk_bf16_f32 v107, v242, v243
v_lshlrev_b32 v242, 16, v172
v_and_b32 v243, 0xffff0000, v172
v_mul_f32 v242, v242, v239
v_mul_f32 v243, v243, v239
v_cvt_pk_bf16_f32 v172, v242, v243
v_lshlrev_b32 v242, 16, v173
v_and_b32 v243, 0xffff0000, v173
v_mul_f32 v242, v242, v239
v_mul_f32 v243, v243, v239
v_cvt_pk_bf16_f32 v173, v242, v243
v_lshlrev_b32 v242, 16, v174
v_and_b32 v243, 0xffff0000, v174
v_mul_f32 v242, v242, v239
v_mul_f32 v243, v243, v239
v_cvt_pk_bf16_f32 v174, v242, v243
v_lshlrev_b32 v242, 16, v175
v_and_b32 v243, 0xffff0000, v175
v_mul_f32 v242, v242, v239
v_mul_f32 v243, v243, v239
v_cvt_pk_bf16_f32 v175, v242, v243
v_lshlrev_b32 v242, 16, v188
v_and_b32 v243, 0xffff0000, v188
v_mul_f32 v242, v242, v239
v_mul_f32 v243, v243, v239
v_cvt_pk_bf16_f32 v188, v242, v243
v_lshlrev_b32 v242, 16, v189
v_and_b32 v243, 0xffff0000, v189
v_mul_f32 v242, v242, v239
v_mul_f32 v243, v243, v239
v_cvt_pk_bf16_f32 v189, v242, v243
v_lshlrev_b32 v242, 16, v190
v_and_b32 v243, 0xffff0000, v190
v_mul_f32 v242, v242, v239
v_mul_f32 v243, v243, v239
v_cvt_pk_bf16_f32 v190, v242, v243
v_lshlrev_b32 v242, 16, v191
v_and_b32 v243, 0xffff0000, v191
v_mul_f32 v242, v242, v239
v_mul_f32 v243, v243, v239
v_cvt_pk_bf16_f32 v191, v242, v243
v_exp_f32 v232, v128
v_exp_f32 v233, v129
v_exp_f32 v234, v130
v_exp_f32 v235, v131
s_nop 1
v_add_f32 v228, v224, v232
v_add_f32 v228, v228, v233
v_add_f32 v228, v228, v234
v_add_f32 v228, v228, v235
v_cvt_pk_bf16_f32 v0, v232, v233
v_cvt_pk_bf16_f32 v1, v234, v235
v_exp_f32 v232, v132
v_exp_f32 v233, v133
v_exp_f32 v234, v134
v_exp_f32 v235, v135
s_nop 1
v_add_f32 v229, v225, v232
v_add_f32 v229, v229, v233
v_add_f32 v229, v229, v234
v_add_f32 v229, v229, v235
v_cvt_pk_bf16_f32 v32, v232, v233
v_cvt_pk_bf16_f32 v33, v234, v235
v_exp_f32 v232, v136
v_exp_f32 v233, v137
v_exp_f32 v234, v138
v_exp_f32 v235, v139
s_nop 1
v_add_f32 v230, v226, v232
v_add_f32 v230, v230, v233
v_add_f32 v230, v230, v234
v_add_f32 v230, v230, v235
v_cvt_pk_bf16_f32 v64, v232, v233
v_cvt_pk_bf16_f32 v65, v234, v235
v_exp_f32 v232, v140
v_exp_f32 v233, v141
v_exp_f32 v234, v142
v_exp_f32 v235, v143
s_nop 1
v_add_f32 v231, v227, v232
v_add_f32 v231, v231, v233
v_add_f32 v231, v231, v234
v_add_f32 v231, v231, v235
v_cvt_pk_bf16_f32 v96, v232, v233
v_cvt_pk_bf16_f32 v97, v234, v235
s_branch L2_rare_common
L2_rare_site11:
s_mov_b32 s36, 11
s_branch L2_rare_t0_7_1
L2_rare_t0_7_1:
s_nop 15
s_nop 15
s_waitcnt lgkmcnt(0)
v_log_f32 v243, v228
v_max3_f32 v232, v144, v145, v146
v_max3_f32 v232, v232, v147, v243
v_mov_b32 v243, v232
s_nop 1
v_permlane32_swap_b32 v232, v243
s_nop 1
v_max_f32 v232, v232, v243
v_mov_b32 v243, v232
s_nop 1
v_permlane16_swap_b32 v232, v243
s_nop 1
v_max_f32 v232, v232, v243
v_ceil_f32 v232, v232
v_max_f32 v232, 0, v232
v_sub_f32 v243, 0, v232
v_exp_f32 v236, v243
s_nop 1
v_mul_f32 v228, v228, v236
v_add_f32 v244, v244, v232
v_sub_f32 v192, v192, v232
v_sub_f32 v128, v128, v232
v_sub_f32 v144, v144, v232
v_sub_f32 v193, v193, v232
v_sub_f32 v129, v129, v232
v_sub_f32 v145, v145, v232
v_sub_f32 v194, v194, v232
v_sub_f32 v130, v130, v232
v_sub_f32 v146, v146, v232
v_sub_f32 v195, v195, v232
v_sub_f32 v131, v131, v232
v_sub_f32 v147, v147, v232
v_lshlrev_b32 v242, 16, v4
v_and_b32 v243, 0xffff0000, v4
v_mul_f32 v242, v242, v236
v_mul_f32 v243, v243, v236
v_cvt_pk_bf16_f32 v4, v242, v243
v_lshlrev_b32 v242, 16, v5
v_and_b32 v243, 0xffff0000, v5
v_mul_f32 v242, v242, v236
v_mul_f32 v243, v243, v236
v_cvt_pk_bf16_f32 v5, v242, v243
v_lshlrev_b32 v242, 16, v6
v_and_b32 v243, 0xffff0000, v6
v_mul_f32 v242, v242, v236
v_mul_f32 v243, v243, v236
v_cvt_pk_bf16_f32 v6, v242, v243
v_lshlrev_b32 v242, 16, v7
v_and_b32 v243, 0xffff0000, v7
v_mul_f32 v242, v242, v236
v_mul_f32 v243, v243, v236
v_cvt_pk_bf16_f32 v7, v242, v243
v_lshlrev_b32 v242, 16, v8
v_and_b32 v243, 0xffff0000, v8
v_mul_f32 v242, v242, v236
v_mul_f32 v243, v243, v236
v_cvt_pk_bf16_f32 v8, v242, v243
v_lshlrev_b32 v242, 16, v9
v_and_b32 v243, 0xffff0000, v9
v_mul_f32 v242, v242, v236
v_mul_f32 v243, v243, v236
v_cvt_pk_bf16_f32 v9, v242, v243
v_lshlrev_b32 v242, 16, v10
v_and_b32 v243, 0xffff0000, v10
v_mul_f32 v242, v242, v236
v_mul_f32 v243, v243, v236
v_cvt_pk_bf16_f32 v10, v242, v243
v_lshlrev_b32 v242, 16, v11
v_and_b32 v243, 0xffff0000, v11
v_mul_f32 v242, v242, v236
v_mul_f32 v243, v243, v236
v_cvt_pk_bf16_f32 v11, v242, v243
v_lshlrev_b32 v242, 16, v160
v_and_b32 v243, 0xffff0000, v160
v_mul_f32 v242, v242, v236
v_mul_f32 v243, v243, v236
v_cvt_pk_bf16_f32 v160, v242, v243
v_lshlrev_b32 v242, 16, v161
v_and_b32 v243, 0xffff0000, v161
v_mul_f32 v242, v242, v236
v_mul_f32 v243, v243, v236
v_cvt_pk_bf16_f32 v161, v242, v243
v_lshlrev_b32 v242, 16, v162
v_and_b32 v243, 0xffff0000, v162
v_mul_f32 v242, v242, v236
v_mul_f32 v243, v243, v236
v_cvt_pk_bf16_f32 v162, v242, v243
v_lshlrev_b32 v242, 16, v163
v_and_b32 v243, 0xffff0000, v163
v_mul_f32 v242, v242, v236
v_mul_f32 v243, v243, v236
v_cvt_pk_bf16_f32 v163, v242, v243
v_lshlrev_b32 v242, 16, v176
v_and_b32 v243, 0xffff0000, v176
v_mul_f32 v242, v242, v236
v_mul_f32 v243, v243, v236
v_cvt_pk_bf16_f32 v176, v242, v243
v_lshlrev_b32 v242, 16, v177
v_and_b32 v243, 0xffff0000, v177
v_mul_f32 v242, v242, v236
v_mul_f32 v243, v243, v236
v_cvt_pk_bf16_f32 v177, v242, v243
v_lshlrev_b32 v242, 16, v178
v_and_b32 v243, 0xffff0000, v178
v_mul_f32 v242, v242, v236
v_mul_f32 v243, v243, v236
v_cvt_pk_bf16_f32 v178, v242, v243
v_lshlrev_b32 v242, 16, v179
v_and_b32 v243, 0xffff0000, v179
v_mul_f32 v242, v242, v236
v_mul_f32 v243, v243, v236
v_cvt_pk_bf16_f32 v179, v242, v243
v_lshlrev_b32 v242, 16, v0
v_and_b32 v243, 0xffff0000, v0
v_mul_f32 v242, v242, v236
v_mul_f32 v243, v243, v236
v_cvt_pk_bf16_f32 v0, v242, v243
v_lshlrev_b32 v242, 16, v1
v_and_b32 v243, 0xffff0000, v1
v_mul_f32 v242, v242, v236
v_mul_f32 v243, v243, v236
v_cvt_pk_bf16_f32 v1, v242, v243
v_log_f32 v243, v229
v_max3_f32 v233, v148, v149, v150
v_max3_f32 v233, v233, v151, v243
v_mov_b32 v243, v233
s_nop 1
v_permlane32_swap_b32 v233, v243
s_nop 1
v_max_f32 v233, v233, v243
v_mov_b32 v243, v233
s_nop 1
v_permlane16_swap_b32 v233, v243
s_nop 1
v_max_f32 v233, v233, v243
v_ceil_f32 v233, v233
v_max_f32 v233, 0, v233
v_sub_f32 v243, 0, v233
v_exp_f32 v237, v243
s_nop 1
v_mul_f32 v229, v229, v237
v_add_f32 v245, v245, v233
v_sub_f32 v196, v196, v233
v_sub_f32 v132, v132, v233
v_sub_f32 v148, v148, v233
v_sub_f32 v197, v197, v233
v_sub_f32 v133, v133, v233
v_sub_f32 v149, v149, v233
v_sub_f32 v198, v198, v233
v_sub_f32 v134, v134, v233
v_sub_f32 v150, v150, v233
v_sub_f32 v199, v199, v233
v_sub_f32 v135, v135, v233
v_sub_f32 v151, v151, v233
v_lshlrev_b32 v242, 16, v36
v_and_b32 v243, 0xffff0000, v36
v_mul_f32 v242, v242, v237
v_mul_f32 v243, v243, v237
v_cvt_pk_bf16_f32 v36, v242, v243
v_lshlrev_b32 v242, 16, v37
v_and_b32 v243, 0xffff0000, v37
v_mul_f32 v242, v242, v237
v_mul_f32 v243, v243, v237
v_cvt_pk_bf16_f32 v37, v242, v243
v_lshlrev_b32 v242, 16, v38
v_and_b32 v243, 0xffff0000, v38
v_mul_f32 v242, v242, v237
v_mul_f32 v243, v243, v237
v_cvt_pk_bf16_f32 v38, v242, v243
v_lshlrev_b32 v242, 16, v39
v_and_b32 v243, 0xffff0000, v39
v_mul_f32 v242, v242, v237
v_mul_f32 v243, v243, v237
v_cvt_pk_bf16_f32 v39, v242, v243
v_lshlrev_b32 v242, 16, v40
v_and_b32 v243, 0xffff0000, v40
v_mul_f32 v242, v242, v237
v_mul_f32 v243, v243, v237
v_cvt_pk_bf16_f32 v40, v242, v243
v_lshlrev_b32 v242, 16, v41
v_and_b32 v243, 0xffff0000, v41
v_mul_f32 v242, v242, v237
v_mul_f32 v243, v243, v237
v_cvt_pk_bf16_f32 v41, v242, v243
v_lshlrev_b32 v242, 16, v42
v_and_b32 v243, 0xffff0000, v42
v_mul_f32 v242, v242, v237
v_mul_f32 v243, v243, v237
v_cvt_pk_bf16_f32 v42, v242, v243
v_lshlrev_b32 v242, 16, v43
v_and_b32 v243, 0xffff0000, v43
v_mul_f32 v242, v242, v237
v_mul_f32 v243, v243, v237
v_cvt_pk_bf16_f32 v43, v242, v243
v_lshlrev_b32 v242, 16, v164
v_and_b32 v243, 0xffff0000, v164
v_mul_f32 v242, v242, v237
v_mul_f32 v243, v243, v237
v_cvt_pk_bf16_f32 v164, v242, v243
v_lshlrev_b32 v242, 16, v165
v_and_b32 v243, 0xffff0000, v165
v_mul_f32 v242, v242, v237
v_mul_f32 v243, v243, v237
v_cvt_pk_bf16_f32 v165, v242, v243
v_lshlrev_b32 v242, 16, v166
v_and_b32 v243, 0xffff0000, v166
v_mul_f32 v242, v242, v237
v_mul_f32 v243, v243, v237
v_cvt_pk_bf16_f32 v166, v242, v243
v_lshlrev_b32 v242, 16, v167
v_and_b32 v243, 0xffff0000, v167
v_mul_f32 v242, v242, v237
v_mul_f32 v243, v243, v237
v_cvt_pk_bf16_f32 v167, v242, v243
v_lshlrev_b32 v242, 16, v180
v_and_b32 v243, 0xffff0000, v180
v_mul_f32 v242, v242, v237
v_mul_f32 v243, v243, v237
v_cvt_pk_bf16_f32 v180, v242, v243
v_lshlrev_b32 v242, 16, v181
v_and_b32 v243, 0xffff0000, v181
v_mul_f32 v242, v242, v237
v_mul_f32 v243, v243, v237
v_cvt_pk_bf16_f32 v181, v242, v243
v_lshlrev_b32 v242, 16, v182
v_and_b32 v243, 0xffff0000, v182
v_mul_f32 v242, v242, v237
v_mul_f32 v243, v243, v237
v_cvt_pk_bf16_f32 v182, v242, v243
v_lshlrev_b32 v242, 16, v183
v_and_b32 v243, 0xffff0000, v183
v_mul_f32 v242, v242, v237
v_mul_f32 v243, v243, v237
v_cvt_pk_bf16_f32 v183, v242, v243
v_lshlrev_b32 v242, 16, v32
v_and_b32 v243, 0xffff0000, v32
v_mul_f32 v242, v242, v237
v_mul_f32 v243, v243, v237
v_cvt_pk_bf16_f32 v32, v242, v243
v_lshlrev_b32 v242, 16, v33
v_and_b32 v243, 0xffff0000, v33
v_mul_f32 v242, v242, v237
v_mul_f32 v243, v243, v237
v_cvt_pk_bf16_f32 v33, v242, v243
v_log_f32 v243, v230
v_max3_f32 v234, v152, v153, v154
v_max3_f32 v234, v234, v155, v243
v_mov_b32 v243, v234
s_nop 1
v_permlane32_swap_b32 v234, v243
s_nop 1
v_max_f32 v234, v234, v243
v_mov_b32 v243, v234
s_nop 1
v_permlane16_swap_b32 v234, v243
s_nop 1
v_max_f32 v234, v234, v243
v_ceil_f32 v234, v234
v_max_f32 v234, 0, v234
v_sub_f32 v243, 0, v234
v_exp_f32 v238, v243
s_nop 1
v_mul_f32 v230, v230, v238
v_add_f32 v246, v246, v234
v_sub_f32 v200, v200, v234
v_sub_f32 v136, v136, v234
v_sub_f32 v152, v152, v234
v_sub_f32 v201, v201, v234
v_sub_f32 v137, v137, v234
v_sub_f32 v153, v153, v234
v_sub_f32 v202, v202, v234
v_sub_f32 v138, v138, v234
v_sub_f32 v154, v154, v234
v_sub_f32 v203, v203, v234
v_sub_f32 v139, v139, v234
v_sub_f32 v155, v155, v234
v_lshlrev_b32 v242, 16, v68
v_and_b32 v243, 0xffff0000, v68
v_mul_f32 v242, v242, v238
v_mul_f32 v243, v243, v238
v_cvt_pk_bf16_f32 v68, v242, v243
v_lshlrev_b32 v242, 16, v69
v_and_b32 v243, 0xffff0000, v69
v_mul_f32 v242, v242, v238
v_mul_f32 v243, v243, v238
v_cvt_pk_bf16_f32 v69, v242, v243
v_lshlrev_b32 v242, 16, v70
v_and_b32 v243, 0xffff0000, v70
v_mul_f32 v242, v242, v238
v_mul_f32 v243, v243, v238
v_cvt_pk_bf16_f32 v70, v242, v243
v_lshlrev_b32 v242, 16, v71
v_and_b32 v243, 0xffff0000, v71
v_mul_f32 v242, v242, v238
v_mul_f32 v243, v243, v238
v_cvt_pk_bf16_f32 v71, v242, v243
v_lshlrev_b32 v242, 16, v72
v_and_b32 v243, 0xffff0000, v72
v_mul_f32 v242, v242, v238
v_mul_f32 v243, v243, v238
v_cvt_pk_bf16_f32 v72, v242, v243
v_lshlrev_b32 v242, 16, v73
v_and_b32 v243, 0xffff0000, v73
v_mul_f32 v242, v242, v238
v_mul_f32 v243, v243, v238
v_cvt_pk_bf16_f32 v73, v242, v243
v_lshlrev_b32 v242, 16, v74
v_and_b32 v243, 0xffff0000, v74
v_mul_f32 v242, v242, v238
v_mul_f32 v243, v243, v238
v_cvt_pk_bf16_f32 v74, v242, v243
v_lshlrev_b32 v242, 16, v75
v_and_b32 v243, 0xffff0000, v75
v_mul_f32 v242, v242, v238
v_mul_f32 v243, v243, v238
v_cvt_pk_bf16_f32 v75, v242, v243
v_lshlrev_b32 v242, 16, v168
v_and_b32 v243, 0xffff0000, v168
v_mul_f32 v242, v242, v238
v_mul_f32 v243, v243, v238
v_cvt_pk_bf16_f32 v168, v242, v243
v_lshlrev_b32 v242, 16, v169
v_and_b32 v243, 0xffff0000, v169
v_mul_f32 v242, v242, v238
v_mul_f32 v243, v243, v238
v_cvt_pk_bf16_f32 v169, v242, v243
v_lshlrev_b32 v242, 16, v170
v_and_b32 v243, 0xffff0000, v170
v_mul_f32 v242, v242, v238
v_mul_f32 v243, v243, v238
v_cvt_pk_bf16_f32 v170, v242, v243
v_lshlrev_b32 v242, 16, v171
v_and_b32 v243, 0xffff0000, v171
v_mul_f32 v242, v242, v238
v_mul_f32 v243, v243, v238
v_cvt_pk_bf16_f32 v171, v242, v243
v_lshlrev_b32 v242, 16, v184
v_and_b32 v243, 0xffff0000, v184
v_mul_f32 v242, v242, v238
v_mul_f32 v243, v243, v238
v_cvt_pk_bf16_f32 v184, v242, v243
v_lshlrev_b32 v242, 16, v185
v_and_b32 v243, 0xffff0000, v185
v_mul_f32 v242, v242, v238
v_mul_f32 v243, v243, v238
v_cvt_pk_bf16_f32 v185, v242, v243
v_lshlrev_b32 v242, 16, v186
v_and_b32 v243, 0xffff0000, v186
v_mul_f32 v242, v242, v238
v_mul_f32 v243, v243, v238
v_cvt_pk_bf16_f32 v186, v242, v243
v_lshlrev_b32 v242, 16, v187
v_and_b32 v243, 0xffff0000, v187
v_mul_f32 v242, v242, v238
v_mul_f32 v243, v243, v238
v_cvt_pk_bf16_f32 v187, v242, v243
v_lshlrev_b32 v242, 16, v64
v_and_b32 v243, 0xffff0000, v64
v_mul_f32 v242, v242, v238
v_mul_f32 v243, v243, v238
v_cvt_pk_bf16_f32 v64, v242, v243
v_lshlrev_b32 v242, 16, v65
v_and_b32 v243, 0xffff0000, v65
v_mul_f32 v242, v242, v238
v_mul_f32 v243, v243, v238
v_cvt_pk_bf16_f32 v65, v242, v243
v_log_f32 v243, v231
v_max3_f32 v235, v156, v157, v158
v_max3_f32 v235, v235, v159, v243
v_mov_b32 v243, v235
s_nop 1
v_permlane32_swap_b32 v235, v243
s_nop 1
v_max_f32 v235, v235, v243
v_mov_b32 v243, v235
s_nop 1
v_permlane16_swap_b32 v235, v243
s_nop 1
v_max_f32 v235, v235, v243
v_ceil_f32 v235, v235
v_max_f32 v235, 0, v235
v_sub_f32 v243, 0, v235
v_exp_f32 v239, v243
s_nop 1
v_mul_f32 v231, v231, v239
v_add_f32 v247, v247, v235
v_sub_f32 v204, v204, v235
v_sub_f32 v140, v140, v235
v_sub_f32 v156, v156, v235
v_sub_f32 v205, v205, v235
v_sub_f32 v141, v141, v235
v_sub_f32 v157, v157, v235
v_sub_f32 v206, v206, v235
v_sub_f32 v142, v142, v235
v_sub_f32 v158, v158, v235
v_sub_f32 v207, v207, v235
v_sub_f32 v143, v143, v235
v_sub_f32 v159, v159, v235
v_lshlrev_b32 v242, 16, v100
v_and_b32 v243, 0xffff0000, v100
v_mul_f32 v242, v242, v239
v_mul_f32 v243, v243, v239
v_cvt_pk_bf16_f32 v100, v242, v243
v_lshlrev_b32 v242, 16, v101
v_and_b32 v243, 0xffff0000, v101
v_mul_f32 v242, v242, v239
v_mul_f32 v243, v243, v239
v_cvt_pk_bf16_f32 v101, v242, v243
v_lshlrev_b32 v242, 16, v102
v_and_b32 v243, 0xffff0000, v102
v_mul_f32 v242, v242, v239
v_mul_f32 v243, v243, v239
v_cvt_pk_bf16_f32 v102, v242, v243
v_lshlrev_b32 v242, 16, v103
v_and_b32 v243, 0xffff0000, v103
v_mul_f32 v242, v242, v239
v_mul_f32 v243, v243, v239
v_cvt_pk_bf16_f32 v103, v242, v243
v_lshlrev_b32 v242, 16, v104
v_and_b32 v243, 0xffff0000, v104
v_mul_f32 v242, v242, v239
v_mul_f32 v243, v243, v239
v_cvt_pk_bf16_f32 v104, v242, v243
v_lshlrev_b32 v242, 16, v105
v_and_b32 v243, 0xffff0000, v105
v_mul_f32 v242, v242, v239
v_mul_f32 v243, v243, v239
v_cvt_pk_bf16_f32 v105, v242, v243
v_lshlrev_b32 v242, 16, v106
v_and_b32 v243, 0xffff0000, v106
v_mul_f32 v242, v242, v239
v_mul_f32 v243, v243, v239
v_cvt_pk_bf16_f32 v106, v242, v243
v_lshlrev_b32 v242, 16, v107
v_and_b32 v243, 0xffff0000, v107
v_mul_f32 v242, v242, v239
v_mul_f32 v243, v243, v239
v_cvt_pk_bf16_f32 v107, v242, v243
v_lshlrev_b32 v242, 16, v172
v_and_b32 v243, 0xffff0000, v172
v_mul_f32 v242, v242, v239
v_mul_f32 v243, v243, v239
v_cvt_pk_bf16_f32 v172, v242, v243
v_lshlrev_b32 v242, 16, v173
v_and_b32 v243, 0xffff0000, v173
v_mul_f32 v242, v242, v239
v_mul_f32 v243, v243, v239
v_cvt_pk_bf16_f32 v173, v242, v243
v_lshlrev_b32 v242, 16, v174
v_and_b32 v243, 0xffff0000, v174
v_mul_f32 v242, v242, v239
v_mul_f32 v243, v243, v239
v_cvt_pk_bf16_f32 v174, v242, v243
v_lshlrev_b32 v242, 16, v175
v_and_b32 v243, 0xffff0000, v175
v_mul_f32 v242, v242, v239
v_mul_f32 v243, v243, v239
v_cvt_pk_bf16_f32 v175, v242, v243
v_lshlrev_b32 v242, 16, v188
v_and_b32 v243, 0xffff0000, v188
v_mul_f32 v242, v242, v239
v_mul_f32 v243, v243, v239
v_cvt_pk_bf16_f32 v188, v242, v243
v_lshlrev_b32 v242, 16, v189
v_and_b32 v243, 0xffff0000, v189
v_mul_f32 v242, v242, v239
v_mul_f32 v243, v243, v239
v_cvt_pk_bf16_f32 v189, v242, v243
v_lshlrev_b32 v242, 16, v190
v_and_b32 v243, 0xffff0000, v190
v_mul_f32 v242, v242, v239
v_mul_f32 v243, v243, v239
v_cvt_pk_bf16_f32 v190, v242, v243
v_lshlrev_b32 v242, 16, v191
v_and_b32 v243, 0xffff0000, v191
v_mul_f32 v242, v242, v239
v_mul_f32 v243, v243, v239
v_cvt_pk_bf16_f32 v191, v242, v243
v_lshlrev_b32 v242, 16, v96
v_and_b32 v243, 0xffff0000, v96
v_mul_f32 v242, v242, v239
v_mul_f32 v243, v243, v239
v_cvt_pk_bf16_f32 v96, v242, v243
v_lshlrev_b32 v242, 16, v97
v_and_b32 v243, 0xffff0000, v97
v_mul_f32 v242, v242, v239
v_mul_f32 v243, v243, v239
v_cvt_pk_bf16_f32 v97, v242, v243
v_exp_f32 v232, v144
v_exp_f32 v233, v145
v_exp_f32 v234, v146
v_exp_f32 v235, v147
s_nop 1
v_add_f32 v224, v228, v232
v_add_f32 v224, v224, v233
v_add_f32 v224, v224, v234
v_add_f32 v224, v224, v235
v_cvt_pk_bf16_f32 v2, v232, v233
v_cvt_pk_bf16_f32 v3, v234, v235
v_exp_f32 v232, v148
v_exp_f32 v233, v149
v_exp_f32 v234, v150
v_exp_f32 v235, v151
s_nop 1
v_add_f32 v225, v229, v232
v_add_f32 v225, v225, v233
v_add_f32 v225, v225, v234
v_add_f32 v225, v225, v235
v_cvt_pk_bf16_f32 v34, v232, v233
v_cvt_pk_bf16_f32 v35, v234, v235
v_exp_f32 v232, v152
v_exp_f32 v233, v153
v_exp_f32 v234, v154
v_exp_f32 v235, v155
s_nop 1
v_add_f32 v226, v230, v232
v_add_f32 v226, v226, v233
v_add_f32 v226, v226, v234
v_add_f32 v226, v226, v235
v_cvt_pk_bf16_f32 v66, v232, v233
v_cvt_pk_bf16_f32 v67, v234, v235
v_exp_f32 v232, v156
v_exp_f32 v233, v157
v_exp_f32 v234, v158
v_exp_f32 v235, v159
s_nop 1
v_add_f32 v227, v231, v232
v_add_f32 v227, v227, v233
v_add_f32 v227, v227, v234
v_add_f32 v227, v227, v235
v_cvt_pk_bf16_f32 v98, v232, v233
v_cvt_pk_bf16_f32 v99, v234, v235
s_branch L2_rare_common
LF_hl_0:
s_mov_b32 s100, 0x10000
s_mov_b32 s3, 0x7c28000
LF_hl2_0:
v_lshlrev_b32 v241, 3, v248
buffer_load_dword v241, v241, s[16:19], s3 offen sc1
s_sub_u32 s100, s100, 1
s_waitcnt vmcnt(0)
s_cbranch_scc1 LF_hlret_0
v_cmp_eq_u32_e64 s[38:39], 0, v241
s_and_b64 s[38:39], s[38:39], s[96:97]
s_cbranch_scc1 LF_hl2_0
s_branch LF_hlret_0
L2_rare_site12:
s_mov_b32 s36, 12
s_branch L2_rare_t1_0_0
L2_rare_t1_0_0:
s_nop 15
s_nop 15
s_waitcnt lgkmcnt(0)
v_log_f32 v243, v224
v_max3_f32 v232, v128, v129, v130
v_max3_f32 v232, v232, v131, v243
v_mov_b32 v243, v232
s_nop 1
v_permlane32_swap_b32 v232, v243
s_nop 1
v_max_f32 v232, v232, v243
v_mov_b32 v243, v232
s_nop 1
v_permlane16_swap_b32 v232, v243
s_nop 1
v_max_f32 v232, v232, v243
v_ceil_f32 v232, v232
v_max_f32 v232, 0, v232
v_sub_f32 v243, 0, v232
v_exp_f32 v236, v243
s_nop 1
v_mul_f32 v224, v224, v236
v_add_f32 v244, v244, v232
v_sub_f32 v192, v192, v232
v_sub_f32 v128, v128, v232
v_sub_f32 v144, v144, v232
v_sub_f32 v193, v193, v232
v_sub_f32 v129, v129, v232
v_sub_f32 v145, v145, v232
v_sub_f32 v194, v194, v232
v_sub_f32 v130, v130, v232
v_sub_f32 v146, v146, v232
v_sub_f32 v195, v195, v232
v_sub_f32 v131, v131, v232
v_sub_f32 v147, v147, v232
ds_read_b64 v[254:255], v253 offset:0
s_waitcnt lgkmcnt(0)
v_lshlrev_b32 v242, 16, v254
v_and_b32 v243, 0xffff0000, v254
v_mul_f32 v242, v242, v236
v_mul_f32 v243, v243, v236
v_cvt_pk_bf16_f32 v254, v242, v243
v_lshlrev_b32 v242, 16, v255
v_and_b32 v243, 0xffff0000, v255
v_mul_f32 v242, v242, v236
v_mul_f32 v243, v243, v236
v_cvt_pk_bf16_f32 v255, v242, v243
ds_write_b64 v253, v[254:255] offset:0
s_waitcnt lgkmcnt(0)
ds_read_b64 v[254:255], v253 offset:8
s_waitcnt lgkmcnt(0)
v_lshlrev_b32 v242, 16, v254
v_and_b32 v243, 0xffff0000, v254
v_mul_f32 v242, v242, v236
v_mul_f32 v243, v243, v236
v_cvt_pk_bf16_f32 v254, v242, v243
v_lshlrev_b32 v242, 16, v255
v_and_b32 v243, 0xffff0000, v255
v_mul_f32 v242, v242, v236
v_mul_f32 v243, v243, v236
v_cvt_pk_bf16_f32 v255, v242, v243
ds_write_b64 v253, v[254:255] offset:8
s_waitcnt lgkmcnt(0)
v_log_f32 v243, v225
v_max3_f32 v233, v132, v133, v134
v_max3_f32 v233, v233, v135, v243
v_mov_b32 v243, v233
s_nop 1
v_permlane32_swap_b32 v233, v243
s_nop 1
v_max_f32 v233, v233, v243
v_mov_b32 v243, v233
s_nop 1
v_permlane16_swap_b32 v233, v243
s_nop 1
v_max_f32 v233, v233, v243
v_ceil_f32 v233, v233
v_max_f32 v233, 0, v233
v_sub_f32 v243, 0, v233
v_exp_f32 v237, v243
s_nop 1
v_mul_f32 v225, v225, v237
v_add_f32 v245, v245, v233
v_sub_f32 v196, v196, v233
v_sub_f32 v132, v132, v233
v_sub_f32 v148, v148, v233
v_sub_f32 v197, v197, v233
v_sub_f32 v133, v133, v233
v_sub_f32 v149, v149, v233
v_sub_f32 v198, v198, v233
v_sub_f32 v134, v134, v233
v_sub_f32 v150, v150, v233
v_sub_f32 v199, v199, v233
v_sub_f32 v135, v135, v233
v_sub_f32 v151, v151, v233
ds_read_b64 v[254:255], v253 offset:1024
s_waitcnt lgkmcnt(0)
v_lshlrev_b32 v242, 16, v254
v_and_b32 v243, 0xffff0000, v254
v_mul_f32 v242, v242, v237
v_mul_f32 v243, v243, v237
v_cvt_pk_bf16_f32 v254, v242, v243
v_lshlrev_b32 v242, 16, v255
v_and_b32 v243, 0xffff0000, v255
v_mul_f32 v242, v242, v237
v_mul_f32 v243, v243, v237
v_cvt_pk_bf16_f32 v255, v242, v243
ds_write_b64 v253, v[254:255] offset:1024
s_waitcnt lgkmcnt(0)
ds_read_b64 v[254:255], v253 offset:1032
s_waitcnt lgkmcnt(0)
v_lshlrev_b32 v242, 16, v254
v_and_b32 v243, 0xffff0000, v254
v_mul_f32 v242, v242, v237
v_mul_f32 v243, v243, v237
v_cvt_pk_bf16_f32 v254, v242, v243
v_lshlrev_b32 v242, 16, v255
v_and_b32 v243, 0xffff0000, v255
v_mul_f32 v242, v242, v237
v_mul_f32 v243, v243, v237
v_cvt_pk_bf16_f32 v255, v242, v243
ds_write_b64 v253, v[254:255] offset:1032
s_waitcnt lgkmcnt(0)
v_log_f32 v243, v226
v_max3_f32 v234, v136, v137, v138
v_max3_f32 v234, v234, v139, v243
v_mov_b32 v243, v234
s_nop 1
v_permlane32_swap_b32 v234, v243
s_nop 1
v_max_f32 v234, v234, v243
v_mov_b32 v243, v234
s_nop 1
v_permlane16_swap_b32 v234, v243
s_nop 1
v_max_f32 v234, v234, v243
v_ceil_f32 v234, v234
v_max_f32 v234, 0, v234
v_sub_f32 v243, 0, v234
v_exp_f32 v238, v243
s_nop 1
v_mul_f32 v226, v226, v238
v_add_f32 v246, v246, v234
v_sub_f32 v200, v200, v234
v_sub_f32 v136, v136, v234
v_sub_f32 v152, v152, v234
v_sub_f32 v201, v201, v234
v_sub_f32 v137, v137, v234
v_sub_f32 v153, v153, v234
v_sub_f32 v202, v202, v234
v_sub_f32 v138, v138, v234
v_sub_f32 v154, v154, v234
v_sub_f32 v203, v203, v234
v_sub_f32 v139, v139, v234
v_sub_f32 v155, v155, v234
ds_read_b64 v[254:255], v253 offset:2048
s_waitcnt lgkmcnt(0)
v_lshlrev_b32 v242, 16, v254
v_and_b32 v243, 0xffff0000, v254
v_mul_f32 v242, v242, v238
v_mul_f32 v243, v243, v238
v_cvt_pk_bf16_f32 v254, v242, v243
v_lshlrev_b32 v242, 16, v255
v_and_b32 v243, 0xffff0000, v255
v_mul_f32 v242, v242, v238
v_mul_f32 v243, v243, v238
v_cvt_pk_bf16_f32 v255, v242, v243
ds_write_b64 v253, v[254:255] offset:2048
s_waitcnt lgkmcnt(0)
ds_read_b64 v[254:255], v253 offset:2056
s_waitcnt lgkmcnt(0)
v_lshlrev_b32 v242, 16, v254
v_and_b32 v243, 0xffff0000, v254
v_mul_f32 v242, v242, v238
v_mul_f32 v243, v243, v238
v_cvt_pk_bf16_f32 v254, v242, v243
v_lshlrev_b32 v242, 16, v255
v_and_b32 v243, 0xffff0000, v255
v_mul_f32 v242, v242, v238
v_mul_f32 v243, v243, v238
v_cvt_pk_bf16_f32 v255, v242, v243
ds_write_b64 v253, v[254:255] offset:2056
s_waitcnt lgkmcnt(0)
v_log_f32 v243, v227
v_max3_f32 v235, v140, v141, v142
v_max3_f32 v235, v235, v143, v243
v_mov_b32 v243, v235
s_nop 1
v_permlane32_swap_b32 v235, v243
s_nop 1
v_max_f32 v235, v235, v243
v_mov_b32 v243, v235
s_nop 1
v_permlane16_swap_b32 v235, v243
s_nop 1
v_max_f32 v235, v235, v243
v_ceil_f32 v235, v235
v_max_f32 v235, 0, v235
v_sub_f32 v243, 0, v235
v_exp_f32 v239, v243
s_nop 1
v_mul_f32 v227, v227, v239
v_add_f32 v247, v247, v235
v_sub_f32 v204, v204, v235
v_sub_f32 v140, v140, v235
v_sub_f32 v156, v156, v235
v_sub_f32 v205, v205, v235
v_sub_f32 v141, v141, v235
v_sub_f32 v157, v157, v235
v_sub_f32 v206, v206, v235
v_sub_f32 v142, v142, v235
v_sub_f32 v158, v158, v235
v_sub_f32 v207, v207, v235
v_sub_f32 v143, v143, v235
v_sub_f32 v159, v159, v235
ds_read_b64 v[254:255], v253 offset:3072
s_waitcnt lgkmcnt(0)
v_lshlrev_b32 v242, 16, v254
v_and_b32 v243, 0xffff0000, v254
v_mul_f32 v242, v242, v239
v_mul_f32 v243, v243, v239
v_cvt_pk_bf16_f32 v254, v242, v243
v_lshlrev_b32 v242, 16, v255
v_and_b32 v243, 0xffff0000, v255
v_mul_f32 v242, v242, v239
v_mul_f32 v243, v243, v239
v_cvt_pk_bf16_f32 v255, v242, v243
ds_write_b64 v253, v[254:255] offset:3072
s_waitcnt lgkmcnt(0)
ds_read_b64 v[254:255], v253 offset:3080
s_waitcnt lgkmcnt(0)
v_lshlrev_b32 v242, 16, v254
v_and_b32 v243, 0xffff0000, v254
v_mul_f32 v242, v242, v239
v_mul_f32 v243, v243, v239
v_cvt_pk_bf16_f32 v254, v242, v243
v_lshlrev_b32 v242, 16, v255
v_and_b32 v243, 0xffff0000, v255
v_mul_f32 v242, v242, v239
v_mul_f32 v243, v243, v239
v_cvt_pk_bf16_f32 v255, v242, v243
ds_write_b64 v253, v[254:255] offset:3080
s_waitcnt lgkmcnt(0)
v_exp_f32 v232, v128
v_exp_f32 v233, v129
v_exp_f32 v234, v130
v_exp_f32 v235, v131
s_nop 1
v_add_f32 v228, v224, v232
v_add_f32 v228, v228, v233
v_add_f32 v228, v228, v234
v_add_f32 v228, v228, v235
v_cvt_pk_bf16_f32 v160, v232, v233
v_cvt_pk_bf16_f32 v161, v234, v235
v_exp_f32 v232, v132
v_exp_f32 v233, v133
v_exp_f32 v234, v134
v_exp_f32 v235, v135
s_nop 1
v_add_f32 v229, v225, v232
v_add_f32 v229, v229, v233
v_add_f32 v229, v229, v234
v_add_f32 v229, v229, v235
v_cvt_pk_bf16_f32 v164, v232, v233
v_cvt_pk_bf16_f32 v165, v234, v235
v_exp_f32 v232, v136
v_exp_f32 v233, v137
v_exp_f32 v234, v138
v_exp_f32 v235, v139
s_nop 1
v_add_f32 v230, v226, v232
v_add_f32 v230, v230, v233
v_add_f32 v230, v230, v234
v_add_f32 v230, v230, v235
v_cvt_pk_bf16_f32 v168, v232, v233
v_cvt_pk_bf16_f32 v169, v234, v235
v_exp_f32 v232, v140
v_exp_f32 v233, v141
v_exp_f32 v234, v142
v_exp_f32 v235, v143
s_nop 1
v_add_f32 v231, v227, v232
v_add_f32 v231, v231, v233
v_add_f32 v231, v231, v234
v_add_f32 v231, v231, v235
v_cvt_pk_bf16_f32 v172, v232, v233
v_cvt_pk_bf16_f32 v173, v234, v235
s_branch L2_rare_common
L2_rare_site13:
s_mov_b32 s36, 13
s_branch L2_rare_t1_1_1
L2_rare_t1_1_1:
s_nop 15
s_nop 15
s_waitcnt lgkmcnt(0)
v_log_f32 v243, v228
v_max3_f32 v232, v144, v145, v146
v_max3_f32 v232, v232, v147, v243
v_mov_b32 v243, v232
s_nop 1
v_permlane32_swap_b32 v232, v243
s_nop 1
v_max_f32 v232, v232, v243
v_mov_b32 v243, v232
s_nop 1
v_permlane16_swap_b32 v232, v243
s_nop 1
v_max_f32 v232, v232, v243
v_ceil_f32 v232, v232
v_max_f32 v232, 0, v232
v_sub_f32 v243, 0, v232
v_exp_f32 v236, v243
s_nop 1
v_mul_f32 v228, v228, v236
v_add_f32 v244, v244, v232
v_sub_f32 v192, v192, v232
v_sub_f32 v128, v128, v232
v_sub_f32 v144, v144, v232
v_sub_f32 v193, v193, v232
v_sub_f32 v129, v129, v232
v_sub_f32 v145, v145, v232
v_sub_f32 v194, v194, v232
v_sub_f32 v130, v130, v232
v_sub_f32 v146, v146, v232
v_sub_f32 v195, v195, v232
v_sub_f32 v131, v131, v232
v_sub_f32 v147, v147, v232
v_lshlrev_b32 v242, 16, v160
v_and_b32 v243, 0xffff0000, v160
v_mul_f32 v242, v242, v236
v_mul_f32 v243, v243, v236
v_cvt_pk_bf16_f32 v160, v242, v243
v_lshlrev_b32 v242, 16, v161
v_and_b32 v243, 0xffff0000, v161
v_mul_f32 v242, v242, v236
v_mul_f32 v243, v243, v236
v_cvt_pk_bf16_f32 v161, v242, v243
ds_read_b64 v[254:255], v253 offset:0
s_waitcnt lgkmcnt(0)
v_lshlrev_b32 v242, 16, v254
v_and_b32 v243, 0xffff0000, v254
v_mul_f32 v242, v242, v236
v_mul_f32 v243, v243, v236
v_cvt_pk_bf16_f32 v254, v242, v243
v_lshlrev_b32 v242, 16, v255
v_and_b32 v243, 0xffff0000, v255
v_mul_f32 v242, v242, v236
v_mul_f32 v243, v243, v236
v_cvt_pk_bf16_f32 v255, v242, v243
ds_write_b64 v253, v[254:255] offset:0
s_waitcnt lgkmcnt(0)
ds_read_b64 v[254:255], v253 offset:8
s_waitcnt lgkmcnt(0)
v_lshlrev_b32 v242, 16, v254
v_and_b32 v243, 0xffff0000, v254
v_mul_f32 v242, v242, v236
v_mul_f32 v243, v243, v236
v_cvt_pk_bf16_f32 v254, v242, v243
v_lshlrev_b32 v242, 16, v255
v_and_b32 v243, 0xffff0000, v255
v_mul_f32 v242, v242, v236
v_mul_f32 v243, v243, v236
v_cvt_pk_bf16_f32 v255, v242, v243
ds_write_b64 v253, v[254:255] offset:8
s_waitcnt lgkmcnt(0)
v_log_f32 v243, v229
v_max3_f32 v233, v148, v149, v150
v_max3_f32 v233, v233, v151, v243
v_mov_b32 v243, v233
s_nop 1
v_permlane32_swap_b32 v233, v243
s_nop 1
v_max_f32 v233, v233, v243
v_mov_b32 v243, v233
s_nop 1
v_permlane16_swap_b32 v233, v243
s_nop 1
v_max_f32 v233, v233, v243
v_ceil_f32 v233, v233
v_max_f32 v233, 0, v233
v_sub_f32 v243, 0, v233
v_exp_f32 v237, v243
s_nop 1
v_mul_f32 v229, v229, v237
v_add_f32 v245, v245, v233
v_sub_f32 v196, v196, v233
v_sub_f32 v132, v132, v233
v_sub_f32 v148, v148, v233
v_sub_f32 v197, v197, v233
v_sub_f32 v133, v133, v233
v_sub_f32 v149, v149, v233
v_sub_f32 v198, v198, v233
v_sub_f32 v134, v134, v233
v_sub_f32 v150, v150, v233
v_sub_f32 v199, v199, v233
v_sub_f32 v135, v135, v233
v_sub_f32 v151, v151, v233
v_lshlrev_b32 v242, 16, v164
v_and_b32 v243, 0xffff0000, v164
v_mul_f32 v242, v242, v237
v_mul_f32 v243, v243, v237
v_cvt_pk_bf16_f32 v164, v242, v243
v_lshlrev_b32 v242, 16, v165
v_and_b32 v243, 0xffff0000, v165
v_mul_f32 v242, v242, v237
v_mul_f32 v243, v243, v237
v_cvt_pk_bf16_f32 v165, v242, v243
ds_read_b64 v[254:255], v253 offset:1024
s_waitcnt lgkmcnt(0)
v_lshlrev_b32 v242, 16, v254
v_and_b32 v243, 0xffff0000, v254
v_mul_f32 v242, v242, v237
v_mul_f32 v243, v243, v237
v_cvt_pk_bf16_f32 v254, v242, v243
v_lshlrev_b32 v242, 16, v255
v_and_b32 v243, 0xffff0000, v255
v_mul_f32 v242, v242, v237
v_mul_f32 v243, v243, v237
v_cvt_pk_bf16_f32 v255, v242, v243
ds_write_b64 v253, v[254:255] offset:1024
s_waitcnt lgkmcnt(0)
ds_read_b64 v[254:255], v253 offset:1032
s_waitcnt lgkmcnt(0)
v_lshlrev_b32 v242, 16, v254
v_and_b32 v243, 0xffff0000, v254
v_mul_f32 v242, v242, v237
v_mul_f32 v243, v243, v237
v_cvt_pk_bf16_f32 v254, v242, v243
v_lshlrev_b32 v242, 16, v255
v_and_b32 v243, 0xffff0000, v255
v_mul_f32 v242, v242, v237
v_mul_f32 v243, v243, v237
v_cvt_pk_bf16_f32 v255, v242, v243
ds_write_b64 v253, v[254:255] offset:1032
s_waitcnt lgkmcnt(0)
v_log_f32 v243, v230
v_max3_f32 v234, v152, v153, v154
v_max3_f32 v234, v234, v155, v243
v_mov_b32 v243, v234
s_nop 1
v_permlane32_swap_b32 v234, v243
s_nop 1
v_max_f32 v234, v234, v243
v_mov_b32 v243, v234
s_nop 1
v_permlane16_swap_b32 v234, v243
s_nop 1
v_max_f32 v234, v234, v243
v_ceil_f32 v234, v234
v_max_f32 v234, 0, v234
v_sub_f32 v243, 0, v234
v_exp_f32 v238, v243
s_nop 1
v_mul_f32 v230, v230, v238
v_add_f32 v246, v246, v234
v_sub_f32 v200, v200, v234
v_sub_f32 v136, v136, v234
v_sub_f32 v152, v152, v234
v_sub_f32 v201, v201, v234
v_sub_f32 v137, v137, v234
v_sub_f32 v153, v153, v234
v_sub_f32 v202, v202, v234
v_sub_f32 v138, v138, v234
v_sub_f32 v154, v154, v234
v_sub_f32 v203, v203, v234
v_sub_f32 v139, v139, v234
v_sub_f32 v155, v155, v234
v_lshlrev_b32 v242, 16, v168
v_and_b32 v243, 0xffff0000, v168
v_mul_f32 v242, v242, v238
v_mul_f32 v243, v243, v238
v_cvt_pk_bf16_f32 v168, v242, v243
v_lshlrev_b32 v242, 16, v169
v_and_b32 v243, 0xffff0000, v169
v_mul_f32 v242, v242, v238
v_mul_f32 v243, v243, v238
v_cvt_pk_bf16_f32 v169, v242, v243
ds_read_b64 v[254:255], v253 offset:2048
s_waitcnt lgkmcnt(0)
v_lshlrev_b32 v242, 16, v254
v_and_b32 v243, 0xffff0000, v254
v_mul_f32 v242, v242, v238
v_mul_f32 v243, v243, v238
v_cvt_pk_bf16_f32 v254, v242, v243
v_lshlrev_b32 v242, 16, v255
v_and_b32 v243, 0xffff0000, v255
v_mul_f32 v242, v242, v238
v_mul_f32 v243, v243, v238
v_cvt_pk_bf16_f32 v255, v242, v243
ds_write_b64 v253, v[254:255] offset:2048
s_waitcnt lgkmcnt(0)
ds_read_b64 v[254:255], v253 offset:2056
s_waitcnt lgkmcnt(0)
v_lshlrev_b32 v242, 16, v254
v_and_b32 v243, 0xffff0000, v254
v_mul_f32 v242, v242, v238
v_mul_f32 v243, v243, v238
v_cvt_pk_bf16_f32 v254, v242, v243
v_lshlrev_b32 v242, 16, v255
v_and_b32 v243, 0xffff0000, v255
v_mul_f32 v242, v242, v238
v_mul_f32 v243, v243, v238
v_cvt_pk_bf16_f32 v255, v242, v243
ds_write_b64 v253, v[254:255] offset:2056
s_waitcnt lgkmcnt(0)
v_log_f32 v243, v231
v_max3_f32 v235, v156, v157, v158
v_max3_f32 v235, v235, v159, v243
v_mov_b32 v243, v235
s_nop 1
v_permlane32_swap_b32 v235, v243
s_nop 1
v_max_f32 v235, v235, v243
v_mov_b32 v243, v235
s_nop 1
v_permlane16_swap_b32 v235, v243
s_nop 1
v_max_f32 v235, v235, v243
v_ceil_f32 v235, v235
v_max_f32 v235, 0, v235
v_sub_f32 v243, 0, v235
v_exp_f32 v239, v243
s_nop 1
v_mul_f32 v231, v231, v239
v_add_f32 v247, v247, v235
v_sub_f32 v204, v204, v235
v_sub_f32 v140, v140, v235
v_sub_f32 v156, v156, v235
v_sub_f32 v205, v205, v235
v_sub_f32 v141, v141, v235
v_sub_f32 v157, v157, v235
v_sub_f32 v206, v206, v235
v_sub_f32 v142, v142, v235
v_sub_f32 v158, v158, v235
v_sub_f32 v207, v207, v235
v_sub_f32 v143, v143, v235
v_sub_f32 v159, v159, v235
v_lshlrev_b32 v242, 16, v172
v_and_b32 v243, 0xffff0000, v172
v_mul_f32 v242, v242, v239
v_mul_f32 v243, v243, v239
v_cvt_pk_bf16_f32 v172, v242, v243
v_lshlrev_b32 v242, 16, v173
v_and_b32 v243, 0xffff0000, v173
v_mul_f32 v242, v242, v239
v_mul_f32 v243, v243, v239
v_cvt_pk_bf16_f32 v173, v242, v243
ds_read_b64 v[254:255], v253 offset:3072
s_waitcnt lgkmcnt(0)
v_lshlrev_b32 v242, 16, v254
v_and_b32 v243, 0xffff0000, v254
v_mul_f32 v242, v242, v239
v_mul_f32 v243, v243, v239
v_cvt_pk_bf16_f32 v254, v242, v243
v_lshlrev_b32 v242, 16, v255
v_and_b32 v243, 0xffff0000, v255
v_mul_f32 v242, v242, v239
v_mul_f32 v243, v243, v239
v_cvt_pk_bf16_f32 v255, v242, v243
ds_write_b64 v253, v[254:255] offset:3072
s_waitcnt lgkmcnt(0)
ds_read_b64 v[254:255], v253 offset:3080
s_waitcnt lgkmcnt(0)
v_lshlrev_b32 v242, 16, v254
v_and_b32 v243, 0xffff0000, v254
v_mul_f32 v242, v242, v239
v_mul_f32 v243, v243, v239
v_cvt_pk_bf16_f32 v254, v242, v243
v_lshlrev_b32 v242, 16, v255
v_and_b32 v243, 0xffff0000, v255
v_mul_f32 v242, v242, v239
v_mul_f32 v243, v243, v239
v_cvt_pk_bf16_f32 v255, v242, v243
ds_write_b64 v253, v[254:255] offset:3080
s_waitcnt lgkmcnt(0)
v_exp_f32 v232, v144
v_exp_f32 v233, v145
v_exp_f32 v234, v146
v_exp_f32 v235, v147
s_nop 1
v_add_f32 v224, v228, v232
v_add_f32 v224, v224, v233
v_add_f32 v224, v224, v234
v_add_f32 v224, v224, v235
v_cvt_pk_bf16_f32 v162, v232, v233
v_cvt_pk_bf16_f32 v163, v234, v235
v_exp_f32 v232, v148
v_exp_f32 v233, v149
v_exp_f32 v234, v150
v_exp_f32 v235, v151
s_nop 1
v_add_f32 v225, v229, v232
v_add_f32 v225, v225, v233
v_add_f32 v225, v225, v234
v_add_f32 v225, v225, v235
v_cvt_pk_bf16_f32 v166, v232, v233
v_cvt_pk_bf16_f32 v167, v234, v235
v_exp_f32 v232, v152
v_exp_f32 v233, v153
v_exp_f32 v234, v154
v_exp_f32 v235, v155
s_nop 1
v_add_f32 v226, v230, v232
v_add_f32 v226, v226, v233
v_add_f32 v226, v226, v234
v_add_f32 v226, v226, v235
v_cvt_pk_bf16_f32 v170, v232, v233
v_cvt_pk_bf16_f32 v171, v234, v235
v_exp_f32 v232, v156
v_exp_f32 v233, v157
v_exp_f32 v234, v158
v_exp_f32 v235, v159
s_nop 1
v_add_f32 v227, v231, v232
v_add_f32 v227, v227, v233
v_add_f32 v227, v227, v234
v_add_f32 v227, v227, v235
v_cvt_pk_bf16_f32 v174, v232, v233
v_cvt_pk_bf16_f32 v175, v234, v235
s_branch L2_rare_common
L2_rare_site14:
s_mov_b32 s36, 14
s_branch L2_rare_t1_2_0
L2_rare_t1_2_0:
s_nop 15
s_nop 15
s_waitcnt lgkmcnt(0)
v_log_f32 v243, v224
v_max3_f32 v232, v128, v129, v130
v_max3_f32 v232, v232, v131, v243
v_mov_b32 v243, v232
s_nop 1
v_permlane32_swap_b32 v232, v243
s_nop 1
v_max_f32 v232, v232, v243
v_mov_b32 v243, v232
s_nop 1
v_permlane16_swap_b32 v232, v243
s_nop 1
v_max_f32 v232, v232, v243
v_ceil_f32 v232, v232
v_max_f32 v232, 0, v232
v_sub_f32 v243, 0, v232
v_exp_f32 v236, v243
s_nop 1
v_mul_f32 v224, v224, v236
v_add_f32 v244, v244, v232
v_sub_f32 v192, v192, v232
v_sub_f32 v128, v128, v232
v_sub_f32 v144, v144, v232
v_sub_f32 v193, v193, v232
v_sub_f32 v129, v129, v232
v_sub_f32 v145, v145, v232
v_sub_f32 v194, v194, v232
v_sub_f32 v130, v130, v232
v_sub_f32 v146, v146, v232
v_sub_f32 v195, v195, v232
v_sub_f32 v131, v131, v232
v_sub_f32 v147, v147, v232
ds_read_b64 v[254:255], v253 offset:0
s_waitcnt lgkmcnt(0)
v_lshlrev_b32 v242, 16, v254
v_and_b32 v243, 0xffff0000, v254
v_mul_f32 v242, v242, v236
v_mul_f32 v243, v243, v236
v_cvt_pk_bf16_f32 v254, v242, v243
v_lshlrev_b32 v242, 16, v255
v_and_b32 v243, 0xffff0000, v255
v_mul_f32 v242, v242, v236
v_mul_f32 v243, v243, v236
v_cvt_pk_bf16_f32 v255, v242, v243
ds_write_b64 v253, v[254:255] offset:0
s_waitcnt lgkmcnt(0)
ds_read_b64 v[254:255], v253 offset:8
s_waitcnt lgkmcnt(0)
v_lshlrev_b32 v242, 16, v254
v_and_b32 v243, 0xffff0000, v254
v_mul_f32 v242, v242, v236
v_mul_f32 v243, v243, v236
v_cvt_pk_bf16_f32 v254, v242, v243
v_lshlrev_b32 v242, 16, v255
v_and_b32 v243, 0xffff0000, v255
v_mul_f32 v242, v242, v236
v_mul_f32 v243, v243, v236
v_cvt_pk_bf16_f32 v255, v242, v243
ds_write_b64 v253, v[254:255] offset:8
s_waitcnt lgkmcnt(0)
ds_read_b64 v[254:255], v253 offset:4096
s_waitcnt lgkmcnt(0)
v_lshlrev_b32 v242, 16, v254
v_and_b32 v243, 0xffff0000, v254
v_mul_f32 v242, v242, v236
v_mul_f32 v243, v243, v236
v_cvt_pk_bf16_f32 v254, v242, v243
v_lshlrev_b32 v242, 16, v255
v_and_b32 v243, 0xffff0000, v255
v_mul_f32 v242, v242, v236
v_mul_f32 v243, v243, v236
v_cvt_pk_bf16_f32 v255, v242, v243
ds_write_b64 v253, v[254:255] offset:4096
s_waitcnt lgkmcnt(0)
ds_read_b64 v[254:255], v253 offset:4104
s_waitcnt lgkmcnt(0)
v_lshlrev_b32 v242, 16, v254
v_and_b32 v243, 0xffff0000, v254
v_mul_f32 v242, v242, v236
v_mul_f32 v243, v243, v236
v_cvt_pk_bf16_f32 v254, v242, v243
v_lshlrev_b32 v242, 16, v255
v_and_b32 v243, 0xffff0000, v255
v_mul_f32 v242, v242, v236
v_mul_f32 v243, v243, v236
v_cvt_pk_bf16_f32 v255, v242, v243
ds_write_b64 v253, v[254:255] offset:4104
s_waitcnt lgkmcnt(0)
v_log_f32 v243, v225
v_max3_f32 v233, v132, v133, v134
v_max3_f32 v233, v233, v135, v243
v_mov_b32 v243, v233
s_nop 1
v_permlane32_swap_b32 v233, v243
s_nop 1
v_max_f32 v233, v233, v243
v_mov_b32 v243, v233
s_nop 1
v_permlane16_swap_b32 v233, v243
s_nop 1
v_max_f32 v233, v233, v243
v_ceil_f32 v233, v233
v_max_f32 v233, 0, v233
v_sub_f32 v243, 0, v233
v_exp_f32 v237, v243
s_nop 1
v_mul_f32 v225, v225, v237
v_add_f32 v245, v245, v233
v_sub_f32 v196, v196, v233
v_sub_f32 v132, v132, v233
v_sub_f32 v148, v148, v233
v_sub_f32 v197, v197, v233
v_sub_f32 v133, v133, v233
v_sub_f32 v149, v149, v233
v_sub_f32 v198, v198, v233
v_sub_f32 v134, v134, v233
v_sub_f32 v150, v150, v233
v_sub_f32 v199, v199, v233
v_sub_f32 v135, v135, v233
v_sub_f32 v151, v151, v233
ds_read_b64 v[254:255], v253 offset:1024
s_waitcnt lgkmcnt(0)
v_lshlrev_b32 v242, 16, v254
v_and_b32 v243, 0xffff0000, v254
v_mul_f32 v242, v242, v237
v_mul_f32 v243, v243, v237
v_cvt_pk_bf16_f32 v254, v242, v243
v_lshlrev_b32 v242, 16, v255
v_and_b32 v243, 0xffff0000, v255
v_mul_f32 v242, v242, v237
v_mul_f32 v243, v243, v237
v_cvt_pk_bf16_f32 v255, v242, v243
ds_write_b64 v253, v[254:255] offset:1024
s_waitcnt lgkmcnt(0)
ds_read_b64 v[254:255], v253 offset:1032
s_waitcnt lgkmcnt(0)
v_lshlrev_b32 v242, 16, v254
v_and_b32 v243, 0xffff0000, v254
v_mul_f32 v242, v242, v237
v_mul_f32 v243, v243, v237
v_cvt_pk_bf16_f32 v254, v242, v243
v_lshlrev_b32 v242, 16, v255
v_and_b32 v243, 0xffff0000, v255
v_mul_f32 v242, v242, v237
v_mul_f32 v243, v243, v237
v_cvt_pk_bf16_f32 v255, v242, v243
ds_write_b64 v253, v[254:255] offset:1032
s_waitcnt lgkmcnt(0)
ds_read_b64 v[254:255], v253 offset:5120
s_waitcnt lgkmcnt(0)
v_lshlrev_b32 v242, 16, v254
v_and_b32 v243, 0xffff0000, v254
v_mul_f32 v242, v242, v237
v_mul_f32 v243, v243, v237
v_cvt_pk_bf16_f32 v254, v242, v243
v_lshlrev_b32 v242, 16, v255
v_and_b32 v243, 0xffff0000, v255
v_mul_f32 v242, v242, v237
v_mul_f32 v243, v243, v237
v_cvt_pk_bf16_f32 v255, v242, v243
ds_write_b64 v253, v[254:255] offset:5120
s_waitcnt lgkmcnt(0)
ds_read_b64 v[254:255], v253 offset:5128
s_waitcnt lgkmcnt(0)
v_lshlrev_b32 v242, 16, v254
v_and_b32 v243, 0xffff0000, v254
v_mul_f32 v242, v242, v237
v_mul_f32 v243, v243, v237
v_cvt_pk_bf16_f32 v254, v242, v243
v_lshlrev_b32 v242, 16, v255
v_and_b32 v243, 0xffff0000, v255
v_mul_f32 v242, v242, v237
v_mul_f32 v243, v243, v237
v_cvt_pk_bf16_f32 v255, v242, v243
ds_write_b64 v253, v[254:255] offset:5128
s_waitcnt lgkmcnt(0)
v_log_f32 v243, v226
v_max3_f32 v234, v136, v137, v138
v_max3_f32 v234, v234, v139, v243
v_mov_b32 v243, v234
s_nop 1
v_permlane32_swap_b32 v234, v243
s_nop 1
v_max_f32 v234, v234, v243
v_mov_b32 v243, v234
s_nop 1
v_permlane16_swap_b32 v234, v243
s_nop 1
v_max_f32 v234, v234, v243
v_ceil_f32 v234, v234
v_max_f32 v234, 0, v234
v_sub_f32 v243, 0, v234
v_exp_f32 v238, v243
s_nop 1
v_mul_f32 v226, v226, v238
v_add_f32 v246, v246, v234
v_sub_f32 v200, v200, v234
v_sub_f32 v136, v136, v234
v_sub_f32 v152, v152, v234
v_sub_f32 v201, v201, v234
v_sub_f32 v137, v137, v234
v_sub_f32 v153, v153, v234
v_sub_f32 v202, v202, v234
v_sub_f32 v138, v138, v234
v_sub_f32 v154, v154, v234
v_sub_f32 v203, v203, v234
v_sub_f32 v139, v139, v234
v_sub_f32 v155, v155, v234
ds_read_b64 v[254:255], v253 offset:2048
s_waitcnt lgkmcnt(0)
v_lshlrev_b32 v242, 16, v254
v_and_b32 v243, 0xffff0000, v254
v_mul_f32 v242, v242, v238
v_mul_f32 v243, v243, v238
v_cvt_pk_bf16_f32 v254, v242, v243
v_lshlrev_b32 v242, 16, v255
v_and_b32 v243, 0xffff0000, v255
v_mul_f32 v242, v242, v238
v_mul_f32 v243, v243, v238
v_cvt_pk_bf16_f32 v255, v242, v243
ds_write_b64 v253, v[254:255] offset:2048
s_waitcnt lgkmcnt(0)
ds_read_b64 v[254:255], v253 offset:2056
s_waitcnt lgkmcnt(0)
v_lshlrev_b32 v242, 16, v254
v_and_b32 v243, 0xffff0000, v254
v_mul_f32 v242, v242, v238
v_mul_f32 v243, v243, v238
v_cvt_pk_bf16_f32 v254, v242, v243
v_lshlrev_b32 v242, 16, v255
v_and_b32 v243, 0xffff0000, v255
v_mul_f32 v242, v242, v238
v_mul_f32 v243, v243, v238
v_cvt_pk_bf16_f32 v255, v242, v243
ds_write_b64 v253, v[254:255] offset:2056
s_waitcnt lgkmcnt(0)
ds_read_b64 v[254:255], v253 offset:6144
s_waitcnt lgkmcnt(0)
v_lshlrev_b32 v242, 16, v254
v_and_b32 v243, 0xffff0000, v254
v_mul_f32 v242, v242, v238
v_mul_f32 v243, v243, v238
v_cvt_pk_bf16_f32 v254, v242, v243
v_lshlrev_b32 v242, 16, v255
v_and_b32 v243, 0xffff0000, v255
v_mul_f32 v242, v242, v238
v_mul_f32 v243, v243, v238
v_cvt_pk_bf16_f32 v255, v242, v243
ds_write_b64 v253, v[254:255] offset:6144
s_waitcnt lgkmcnt(0)
ds_read_b64 v[254:255], v253 offset:6152
s_waitcnt lgkmcnt(0)
v_lshlrev_b32 v242, 16, v254
v_and_b32 v243, 0xffff0000, v254
v_mul_f32 v242, v242, v238
v_mul_f32 v243, v243, v238
v_cvt_pk_bf16_f32 v254, v242, v243
v_lshlrev_b32 v242, 16, v255
v_and_b32 v243, 0xffff0000, v255
v_mul_f32 v242, v242, v238
v_mul_f32 v243, v243, v238
v_cvt_pk_bf16_f32 v255, v242, v243
ds_write_b64 v253, v[254:255] offset:6152
s_waitcnt lgkmcnt(0)
v_log_f32 v243, v227
v_max3_f32 v235, v140, v141, v142
v_max3_f32 v235, v235, v143, v243
v_mov_b32 v243, v235
s_nop 1
v_permlane32_swap_b32 v235, v243
s_nop 1
v_max_f32 v235, v235, v243
v_mov_b32 v243, v235
s_nop 1
v_permlane16_swap_b32 v235, v243
s_nop 1
v_max_f32 v235, v235, v243
v_ceil_f32 v235, v235
v_max_f32 v235, 0, v235
v_sub_f32 v243, 0, v235
v_exp_f32 v239, v243
s_nop 1
v_mul_f32 v227, v227, v239
v_add_f32 v247, v247, v235
v_sub_f32 v204, v204, v235
v_sub_f32 v140, v140, v235
v_sub_f32 v156, v156, v235
v_sub_f32 v205, v205, v235
v_sub_f32 v141, v141, v235
v_sub_f32 v157, v157, v235
v_sub_f32 v206, v206, v235
v_sub_f32 v142, v142, v235
v_sub_f32 v158, v158, v235
v_sub_f32 v207, v207, v235
v_sub_f32 v143, v143, v235
v_sub_f32 v159, v159, v235
ds_read_b64 v[254:255], v253 offset:3072
s_waitcnt lgkmcnt(0)
v_lshlrev_b32 v242, 16, v254
v_and_b32 v243, 0xffff0000, v254
v_mul_f32 v242, v242, v239
v_mul_f32 v243, v243, v239
v_cvt_pk_bf16_f32 v254, v242, v243
v_lshlrev_b32 v242, 16, v255
v_and_b32 v243, 0xffff0000, v255
v_mul_f32 v242, v242, v239
v_mul_f32 v243, v243, v239
v_cvt_pk_bf16_f32 v255, v242, v243
ds_write_b64 v253, v[254:255] offset:3072
s_waitcnt lgkmcnt(0)
ds_read_b64 v[254:255], v253 offset:3080
s_waitcnt lgkmcnt(0)
v_lshlrev_b32 v242, 16, v254
v_and_b32 v243, 0xffff0000, v254
v_mul_f32 v242, v242, v239
v_mul_f32 v243, v243, v239
v_cvt_pk_bf16_f32 v254, v242, v243
v_lshlrev_b32 v242, 16, v255
v_and_b32 v243, 0xffff0000, v255
v_mul_f32 v242, v242, v239
v_mul_f32 v243, v243, v239
v_cvt_pk_bf16_f32 v255, v242, v243
ds_write_b64 v253, v[254:255] offset:3080
s_waitcnt lgkmcnt(0)
ds_read_b64 v[254:255], v253 offset:7168
s_waitcnt lgkmcnt(0)
v_lshlrev_b32 v242, 16, v254
v_and_b32 v243, 0xffff0000, v254
v_mul_f32 v242, v242, v239
v_mul_f32 v243, v243, v239
v_cvt_pk_bf16_f32 v254, v242, v243
v_lshlrev_b32 v242, 16, v255
v_and_b32 v243, 0xffff0000, v255
v_mul_f32 v242, v242, v239
v_mul_f32 v243, v243, v239
v_cvt_pk_bf16_f32 v255, v242, v243
ds_write_b64 v253, v[254:255] offset:7168
s_waitcnt lgkmcnt(0)
ds_read_b64 v[254:255], v253 offset:7176
s_waitcnt lgkmcnt(0)
v_lshlrev_b32 v242, 16, v254
v_and_b32 v243, 0xffff0000, v254
v_mul_f32 v242, v242, v239
v_mul_f32 v243, v243, v239
v_cvt_pk_bf16_f32 v254, v242, v243
v_lshlrev_b32 v242, 16, v255
v_and_b32 v243, 0xffff0000, v255
v_mul_f32 v242, v242, v239
v_mul_f32 v243, v243, v239
v_cvt_pk_bf16_f32 v255, v242, v243
ds_write_b64 v253, v[254:255] offset:7176
s_waitcnt lgkmcnt(0)
v_exp_f32 v232, v128
v_exp_f32 v233, v129
v_exp_f32 v234, v130
v_exp_f32 v235, v131
s_nop 1
v_add_f32 v228, v224, v232
v_add_f32 v228, v228, v233
v_add_f32 v228, v228, v234
v_add_f32 v228, v228, v235
v_cvt_pk_bf16_f32 v176, v232, v233
v_cvt_pk_bf16_f32 v177, v234, v235
v_exp_f32 v232, v132
v_exp_f32 v233, v133
v_exp_f32 v234, v134
v_exp_f32 v235, v135
s_nop 1
v_add_f32 v229, v225, v232
v_add_f32 v229, v229, v233
v_add_f32 v229, v229, v234
v_add_f32 v229, v229, v235
v_cvt_pk_bf16_f32 v180, v232, v233
v_cvt_pk_bf16_f32 v181, v234, v235
v_exp_f32 v232, v136
v_exp_f32 v233, v137
v_exp_f32 v234, v138
v_exp_f32 v235, v139
s_nop 1
v_add_f32 v230, v226, v232
v_add_f32 v230, v230, v233
v_add_f32 v230, v230, v234
v_add_f32 v230, v230, v235
v_cvt_pk_bf16_f32 v184, v232, v233
v_cvt_pk_bf16_f32 v185, v234, v235
v_exp_f32 v232, v140
v_exp_f32 v233, v141
v_exp_f32 v234, v142
v_exp_f32 v235, v143
s_nop 1
v_add_f32 v231, v227, v232
v_add_f32 v231, v231, v233
v_add_f32 v231, v231, v234
v_add_f32 v231, v231, v235
v_cvt_pk_bf16_f32 v188, v232, v233
v_cvt_pk_bf16_f32 v189, v234, v235
s_branch L2_rare_common
L2_rare_site15:
s_mov_b32 s36, 15
s_branch L2_rare_t1_3_1
L2_rare_t1_3_1:
s_nop 15
s_nop 15
s_waitcnt lgkmcnt(0)
v_log_f32 v243, v228
v_max3_f32 v232, v144, v145, v146
v_max3_f32 v232, v232, v147, v243
v_mov_b32 v243, v232
s_nop 1
v_permlane32_swap_b32 v232, v243
s_nop 1
v_max_f32 v232, v232, v243
v_mov_b32 v243, v232
s_nop 1
v_permlane16_swap_b32 v232, v243
s_nop 1
v_max_f32 v232, v232, v243
v_ceil_f32 v232, v232
v_max_f32 v232, 0, v232
v_sub_f32 v243, 0, v232
v_exp_f32 v236, v243
s_nop 1
v_mul_f32 v228, v228, v236
v_add_f32 v244, v244, v232
v_sub_f32 v192, v192, v232
v_sub_f32 v128, v128, v232
v_sub_f32 v144, v144, v232
v_sub_f32 v193, v193, v232
v_sub_f32 v129, v129, v232
v_sub_f32 v145, v145, v232
v_sub_f32 v194, v194, v232
v_sub_f32 v130, v130, v232
v_sub_f32 v146, v146, v232
v_sub_f32 v195, v195, v232
v_sub_f32 v131, v131, v232
v_sub_f32 v147, v147, v232
v_lshlrev_b32 v242, 16, v176
v_and_b32 v243, 0xffff0000, v176
v_mul_f32 v242, v242, v236
v_mul_f32 v243, v243, v236
v_cvt_pk_bf16_f32 v176, v242, v243
v_lshlrev_b32 v242, 16, v177
v_and_b32 v243, 0xffff0000, v177
v_mul_f32 v242, v242, v236
v_mul_f32 v243, v243, v236
v_cvt_pk_bf16_f32 v177, v242, v243
ds_read_b64 v[254:255], v253 offset:0
s_waitcnt lgkmcnt(0)
v_lshlrev_b32 v242, 16, v254
v_and_b32 v243, 0xffff0000, v254
v_mul_f32 v242, v242, v236
v_mul_f32 v243, v243, v236
v_cvt_pk_bf16_f32 v254, v242, v243
v_lshlrev_b32 v242, 16, v255
v_and_b32 v243, 0xffff0000, v255
v_mul_f32 v242, v242, v236
v_mul_f32 v243, v243, v236
v_cvt_pk_bf16_f32 v255, v242, v243
ds_write_b64 v253, v[254:255] offset:0
s_waitcnt lgkmcnt(0)
ds_read_b64 v[254:255], v253 offset:8
s_waitcnt lgkmcnt(0)
v_lshlrev_b32 v242, 16, v254
v_and_b32 v243, 0xffff0000, v254
v_mul_f32 v242, v242, v236
v_mul_f32 v243, v243, v236
v_cvt_pk_bf16_f32 v254, v242, v243
v_lshlrev_b32 v242, 16, v255
v_and_b32 v243, 0xffff0000, v255
v_mul_f32 v242, v242, v236
v_mul_f32 v243, v243, v236
v_cvt_pk_bf16_f32 v255, v242, v243
ds_write_b64 v253, v[254:255] offset:8
s_waitcnt lgkmcnt(0)
ds_read_b64 v[254:255], v253 offset:4096
s_waitcnt lgkmcnt(0)
v_lshlrev_b32 v242, 16, v254
v_and_b32 v243, 0xffff0000, v254
v_mul_f32 v242, v242, v236
v_mul_f32 v243, v243, v236
v_cvt_pk_bf16_f32 v254, v242, v243
v_lshlrev_b32 v242, 16, v255
v_and_b32 v243, 0xffff0000, v255
v_mul_f32 v242, v242, v236
v_mul_f32 v243, v243, v236
v_cvt_pk_bf16_f32 v255, v242, v243
ds_write_b64 v253, v[254:255] offset:4096
s_waitcnt lgkmcnt(0)
ds_read_b64 v[254:255], v253 offset:4104
s_waitcnt lgkmcnt(0)
v_lshlrev_b32 v242, 16, v254
v_and_b32 v243, 0xffff0000, v254
v_mul_f32 v242, v242, v236
v_mul_f32 v243, v243, v236
v_cvt_pk_bf16_f32 v254, v242, v243
v_lshlrev_b32 v242, 16, v255
v_and_b32 v243, 0xffff0000, v255
v_mul_f32 v242, v242, v236
v_mul_f32 v243, v243, v236
v_cvt_pk_bf16_f32 v255, v242, v243
ds_write_b64 v253, v[254:255] offset:4104
s_waitcnt lgkmcnt(0)
v_log_f32 v243, v229
v_max3_f32 v233, v148, v149, v150
v_max3_f32 v233, v233, v151, v243
v_mov_b32 v243, v233
s_nop 1
v_permlane32_swap_b32 v233, v243
s_nop 1
v_max_f32 v233, v233, v243
v_mov_b32 v243, v233
s_nop 1
v_permlane16_swap_b32 v233, v243
s_nop 1
v_max_f32 v233, v233, v243
v_ceil_f32 v233, v233
v_max_f32 v233, 0, v233
v_sub_f32 v243, 0, v233
v_exp_f32 v237, v243
s_nop 1
v_mul_f32 v229, v229, v237
v_add_f32 v245, v245, v233
v_sub_f32 v196, v196, v233
v_sub_f32 v132, v132, v233
v_sub_f32 v148, v148, v233
v_sub_f32 v197, v197, v233
v_sub_f32 v133, v133, v233
v_sub_f32 v149, v149, v233
v_sub_f32 v198, v198, v233
v_sub_f32 v134, v134, v233
v_sub_f32 v150, v150, v233
v_sub_f32 v199, v199, v233
v_sub_f32 v135, v135, v233
v_sub_f32 v151, v151, v233
v_lshlrev_b32 v242, 16, v180
v_and_b32 v243, 0xffff0000, v180
v_mul_f32 v242, v242, v237
v_mul_f32 v243, v243, v237
v_cvt_pk_bf16_f32 v180, v242, v243
v_lshlrev_b32 v242, 16, v181
v_and_b32 v243, 0xffff0000, v181
v_mul_f32 v242, v242, v237
v_mul_f32 v243, v243, v237
v_cvt_pk_bf16_f32 v181, v242, v243
ds_read_b64 v[254:255], v253 offset:1024
s_waitcnt lgkmcnt(0)
v_lshlrev_b32 v242, 16, v254
v_and_b32 v243, 0xffff0000, v254
v_mul_f32 v242, v242, v237
v_mul_f32 v243, v243, v237
v_cvt_pk_bf16_f32 v254, v242, v243
v_lshlrev_b32 v242, 16, v255
v_and_b32 v243, 0xffff0000, v255
v_mul_f32 v242, v242, v237
v_mul_f32 v243, v243, v237
v_cvt_pk_bf16_f32 v255, v242, v243
ds_write_b64 v253, v[254:255] offset:1024
s_waitcnt lgkmcnt(0)
ds_read_b64 v[254:255], v253 offset:1032
s_waitcnt lgkmcnt(0)
v_lshlrev_b32 v242, 16, v254
v_and_b32 v243, 0xffff0000, v254
v_mul_f32 v242, v242, v237
v_mul_f32 v243, v243, v237
v_cvt_pk_bf16_f32 v254, v242, v243
v_lshlrev_b32 v242, 16, v255
v_and_b32 v243, 0xffff0000, v255
v_mul_f32 v242, v242, v237
v_mul_f32 v243, v243, v237
v_cvt_pk_bf16_f32 v255, v242, v243
ds_write_b64 v253, v[254:255] offset:1032
s_waitcnt lgkmcnt(0)
ds_read_b64 v[254:255], v253 offset:5120
s_waitcnt lgkmcnt(0)
v_lshlrev_b32 v242, 16, v254
v_and_b32 v243, 0xffff0000, v254
v_mul_f32 v242, v242, v237
v_mul_f32 v243, v243, v237
v_cvt_pk_bf16_f32 v254, v242, v243
v_lshlrev_b32 v242, 16, v255
v_and_b32 v243, 0xffff0000, v255
v_mul_f32 v242, v242, v237
v_mul_f32 v243, v243, v237
v_cvt_pk_bf16_f32 v255, v242, v243
ds_write_b64 v253, v[254:255] offset:5120
s_waitcnt lgkmcnt(0)
ds_read_b64 v[254:255], v253 offset:5128
s_waitcnt lgkmcnt(0)
v_lshlrev_b32 v242, 16, v254
v_and_b32 v243, 0xffff0000, v254
v_mul_f32 v242, v242, v237
v_mul_f32 v243, v243, v237
v_cvt_pk_bf16_f32 v254, v242, v243
v_lshlrev_b32 v242, 16, v255
v_and_b32 v243, 0xffff0000, v255
v_mul_f32 v242, v242, v237
v_mul_f32 v243, v243, v237
v_cvt_pk_bf16_f32 v255, v242, v243
ds_write_b64 v253, v[254:255] offset:5128
s_waitcnt lgkmcnt(0)
v_log_f32 v243, v230
v_max3_f32 v234, v152, v153, v154
v_max3_f32 v234, v234, v155, v243
v_mov_b32 v243, v234
s_nop 1
v_permlane32_swap_b32 v234, v243
s_nop 1
v_max_f32 v234, v234, v243
v_mov_b32 v243, v234
s_nop 1
v_permlane16_swap_b32 v234, v243
s_nop 1
v_max_f32 v234, v234, v243
v_ceil_f32 v234, v234
v_max_f32 v234, 0, v234
v_sub_f32 v243, 0, v234
v_exp_f32 v238, v243
s_nop 1
v_mul_f32 v230, v230, v238
v_add_f32 v246, v246, v234
v_sub_f32 v200, v200, v234
v_sub_f32 v136, v136, v234
v_sub_f32 v152, v152, v234
v_sub_f32 v201, v201, v234
v_sub_f32 v137, v137, v234
v_sub_f32 v153, v153, v234
v_sub_f32 v202, v202, v234
v_sub_f32 v138, v138, v234
v_sub_f32 v154, v154, v234
v_sub_f32 v203, v203, v234
v_sub_f32 v139, v139, v234
v_sub_f32 v155, v155, v234
v_lshlrev_b32 v242, 16, v184
v_and_b32 v243, 0xffff0000, v184
v_mul_f32 v242, v242, v238
v_mul_f32 v243, v243, v238
v_cvt_pk_bf16_f32 v184, v242, v243
v_lshlrev_b32 v242, 16, v185
v_and_b32 v243, 0xffff0000, v185
v_mul_f32 v242, v242, v238
v_mul_f32 v243, v243, v238
v_cvt_pk_bf16_f32 v185, v242, v243
ds_read_b64 v[254:255], v253 offset:2048
s_waitcnt lgkmcnt(0)
v_lshlrev_b32 v242, 16, v254
v_and_b32 v243, 0xffff0000, v254
v_mul_f32 v242, v242, v238
v_mul_f32 v243, v243, v238
v_cvt_pk_bf16_f32 v254, v242, v243
v_lshlrev_b32 v242, 16, v255
v_and_b32 v243, 0xffff0000, v255
v_mul_f32 v242, v242, v238
v_mul_f32 v243, v243, v238
v_cvt_pk_bf16_f32 v255, v242, v243
ds_write_b64 v253, v[254:255] offset:2048
s_waitcnt lgkmcnt(0)
ds_read_b64 v[254:255], v253 offset:2056
s_waitcnt lgkmcnt(0)
v_lshlrev_b32 v242, 16, v254
v_and_b32 v243, 0xffff0000, v254
v_mul_f32 v242, v242, v238
v_mul_f32 v243, v243, v238
v_cvt_pk_bf16_f32 v254, v242, v243
v_lshlrev_b32 v242, 16, v255
v_and_b32 v243, 0xffff0000, v255
v_mul_f32 v242, v242, v238
v_mul_f32 v243, v243, v238
v_cvt_pk_bf16_f32 v255, v242, v243
ds_write_b64 v253, v[254:255] offset:2056
s_waitcnt lgkmcnt(0)
ds_read_b64 v[254:255], v253 offset:6144
s_waitcnt lgkmcnt(0)
v_lshlrev_b32 v242, 16, v254
v_and_b32 v243, 0xffff0000, v254
v_mul_f32 v242, v242, v238
v_mul_f32 v243, v243, v238
v_cvt_pk_bf16_f32 v254, v242, v243
v_lshlrev_b32 v242, 16, v255
v_and_b32 v243, 0xffff0000, v255
v_mul_f32 v242, v242, v238
v_mul_f32 v243, v243, v238
v_cvt_pk_bf16_f32 v255, v242, v243
ds_write_b64 v253, v[254:255] offset:6144
s_waitcnt lgkmcnt(0)
ds_read_b64 v[254:255], v253 offset:6152
s_waitcnt lgkmcnt(0)
v_lshlrev_b32 v242, 16, v254
v_and_b32 v243, 0xffff0000, v254
v_mul_f32 v242, v242, v238
v_mul_f32 v243, v243, v238
v_cvt_pk_bf16_f32 v254, v242, v243
v_lshlrev_b32 v242, 16, v255
v_and_b32 v243, 0xffff0000, v255
v_mul_f32 v242, v242, v238
v_mul_f32 v243, v243, v238
v_cvt_pk_bf16_f32 v255, v242, v243
ds_write_b64 v253, v[254:255] offset:6152
s_waitcnt lgkmcnt(0)
v_log_f32 v243, v231
v_max3_f32 v235, v156, v157, v158
v_max3_f32 v235, v235, v159, v243
v_mov_b32 v243, v235
s_nop 1
v_permlane32_swap_b32 v235, v243
s_nop 1
v_max_f32 v235, v235, v243
v_mov_b32 v243, v235
s_nop 1
v_permlane16_swap_b32 v235, v243
s_nop 1
v_max_f32 v235, v235, v243
v_ceil_f32 v235, v235
v_max_f32 v235, 0, v235
v_sub_f32 v243, 0, v235
v_exp_f32 v239, v243
s_nop 1
v_mul_f32 v231, v231, v239
v_add_f32 v247, v247, v235
v_sub_f32 v204, v204, v235
v_sub_f32 v140, v140, v235
v_sub_f32 v156, v156, v235
v_sub_f32 v205, v205, v235
v_sub_f32 v141, v141, v235
v_sub_f32 v157, v157, v235
v_sub_f32 v206, v206, v235
v_sub_f32 v142, v142, v235
v_sub_f32 v158, v158, v235
v_sub_f32 v207, v207, v235
v_sub_f32 v143, v143, v235
v_sub_f32 v159, v159, v235
v_lshlrev_b32 v242, 16, v188
v_and_b32 v243, 0xffff0000, v188
v_mul_f32 v242, v242, v239
v_mul_f32 v243, v243, v239
v_cvt_pk_bf16_f32 v188, v242, v243
v_lshlrev_b32 v242, 16, v189
v_and_b32 v243, 0xffff0000, v189
v_mul_f32 v242, v242, v239
v_mul_f32 v243, v243, v239
v_cvt_pk_bf16_f32 v189, v242, v243
ds_read_b64 v[254:255], v253 offset:3072
s_waitcnt lgkmcnt(0)
v_lshlrev_b32 v242, 16, v254
v_and_b32 v243, 0xffff0000, v254
v_mul_f32 v242, v242, v239
v_mul_f32 v243, v243, v239
v_cvt_pk_bf16_f32 v254, v242, v243
v_lshlrev_b32 v242, 16, v255
v_and_b32 v243, 0xffff0000, v255
v_mul_f32 v242, v242, v239
v_mul_f32 v243, v243, v239
v_cvt_pk_bf16_f32 v255, v242, v243
ds_write_b64 v253, v[254:255] offset:3072
s_waitcnt lgkmcnt(0)
ds_read_b64 v[254:255], v253 offset:3080
s_waitcnt lgkmcnt(0)
v_lshlrev_b32 v242, 16, v254
v_and_b32 v243, 0xffff0000, v254
v_mul_f32 v242, v242, v239
v_mul_f32 v243, v243, v239
v_cvt_pk_bf16_f32 v254, v242, v243
v_lshlrev_b32 v242, 16, v255
v_and_b32 v243, 0xffff0000, v255
v_mul_f32 v242, v242, v239
v_mul_f32 v243, v243, v239
v_cvt_pk_bf16_f32 v255, v242, v243
ds_write_b64 v253, v[254:255] offset:3080
s_waitcnt lgkmcnt(0)
ds_read_b64 v[254:255], v253 offset:7168
s_waitcnt lgkmcnt(0)
v_lshlrev_b32 v242, 16, v254
v_and_b32 v243, 0xffff0000, v254
v_mul_f32 v242, v242, v239
v_mul_f32 v243, v243, v239
v_cvt_pk_bf16_f32 v254, v242, v243
v_lshlrev_b32 v242, 16, v255
v_and_b32 v243, 0xffff0000, v255
v_mul_f32 v242, v242, v239
v_mul_f32 v243, v243, v239
v_cvt_pk_bf16_f32 v255, v242, v243
ds_write_b64 v253, v[254:255] offset:7168
s_waitcnt lgkmcnt(0)
ds_read_b64 v[254:255], v253 offset:7176
s_waitcnt lgkmcnt(0)
v_lshlrev_b32 v242, 16, v254
v_and_b32 v243, 0xffff0000, v254
v_mul_f32 v242, v242, v239
v_mul_f32 v243, v243, v239
v_cvt_pk_bf16_f32 v254, v242, v243
v_lshlrev_b32 v242, 16, v255
v_and_b32 v243, 0xffff0000, v255
v_mul_f32 v242, v242, v239
v_mul_f32 v243, v243, v239
v_cvt_pk_bf16_f32 v255, v242, v243
ds_write_b64 v253, v[254:255] offset:7176
s_waitcnt lgkmcnt(0)
v_exp_f32 v232, v144
v_exp_f32 v233, v145
v_exp_f32 v234, v146
v_exp_f32 v235, v147
s_nop 1
v_add_f32 v224, v228, v232
v_add_f32 v224, v224, v233
v_add_f32 v224, v224, v234
v_add_f32 v224, v224, v235
v_cvt_pk_bf16_f32 v178, v232, v233
v_cvt_pk_bf16_f32 v179, v234, v235
v_exp_f32 v232, v148
v_exp_f32 v233, v149
v_exp_f32 v234, v150
v_exp_f32 v235, v151
s_nop 1
v_add_f32 v225, v229, v232
v_add_f32 v225, v225, v233
v_add_f32 v225, v225, v234
v_add_f32 v225, v225, v235
v_cvt_pk_bf16_f32 v182, v232, v233
v_cvt_pk_bf16_f32 v183, v234, v235
v_exp_f32 v232, v152
v_exp_f32 v233, v153
v_exp_f32 v234, v154
v_exp_f32 v235, v155
s_nop 1
v_add_f32 v226, v230, v232
v_add_f32 v226, v226, v233
v_add_f32 v226, v226, v234
v_add_f32 v226, v226, v235
v_cvt_pk_bf16_f32 v186, v232, v233
v_cvt_pk_bf16_f32 v187, v234, v235
v_exp_f32 v232, v156
v_exp_f32 v233, v157
v_exp_f32 v234, v158
v_exp_f32 v235, v159
s_nop 1
v_add_f32 v227, v231, v232
v_add_f32 v227, v227, v233
v_add_f32 v227, v227, v234
v_add_f32 v227, v227, v235
v_cvt_pk_bf16_f32 v190, v232, v233
v_cvt_pk_bf16_f32 v191, v234, v235
s_branch L2_rare_common
L2_rare_site16:
s_mov_b32 s36, 16
s_branch L2_rare_t1_4_0
L2_rare_t1_4_0:
s_nop 15
s_nop 15
s_waitcnt lgkmcnt(0)
v_log_f32 v243, v224
v_max3_f32 v232, v128, v129, v130
v_max3_f32 v232, v232, v131, v243
v_mov_b32 v243, v232
s_nop 1
v_permlane32_swap_b32 v232, v243
s_nop 1
v_max_f32 v232, v232, v243
v_mov_b32 v243, v232
s_nop 1
v_permlane16_swap_b32 v232, v243
s_nop 1
v_max_f32 v232, v232, v243
v_ceil_f32 v232, v232
v_max_f32 v232, 0, v232
v_sub_f32 v243, 0, v232
v_exp_f32 v236, v243
s_nop 1
v_mul_f32 v224, v224, v236
v_add_f32 v244, v244, v232
v_sub_f32 v192, v192, v232
v_sub_f32 v128, v128, v232
v_sub_f32 v144, v144, v232
v_sub_f32 v193, v193, v232
v_sub_f32 v129, v129, v232
v_sub_f32 v145, v145, v232
v_sub_f32 v194, v194, v232
v_sub_f32 v130, v130, v232
v_sub_f32 v146, v146, v232
v_sub_f32 v195, v195, v232
v_sub_f32 v131, v131, v232
v_sub_f32 v147, v147, v232
v_lshlrev_b32 v242, 16, v176
v_and_b32 v243, 0xffff0000, v176
v_mul_f32 v242, v242, v236
v_mul_f32 v243, v243, v236
v_cvt_pk_bf16_f32 v176, v242, v243
v_lshlrev_b32 v242, 16, v177
v_and_b32 v243, 0xffff0000, v177
v_mul_f32 v242, v242, v236
v_mul_f32 v243, v243, v236
v_cvt_pk_bf16_f32 v177, v242, v243
v_lshlrev_b32 v242, 16, v178
v_and_b32 v243, 0xffff0000, v178
v_mul_f32 v242, v242, v236
v_mul_f32 v243, v243, v236
v_cvt_pk_bf16_f32 v178, v242, v243
v_lshlrev_b32 v242, 16, v179
v_and_b32 v243, 0xffff0000, v179
v_mul_f32 v242, v242, v236
v_mul_f32 v243, v243, v236
v_cvt_pk_bf16_f32 v179, v242, v243
ds_read_b64 v[254:255], v253 offset:0
s_waitcnt lgkmcnt(0)
v_lshlrev_b32 v242, 16, v254
v_and_b32 v243, 0xffff0000, v254
v_mul_f32 v242, v242, v236
v_mul_f32 v243, v243, v236
v_cvt_pk_bf16_f32 v254, v242, v243
v_lshlrev_b32 v242, 16, v255
v_and_b32 v243, 0xffff0000, v255
v_mul_f32 v242, v242, v236
v_mul_f32 v243, v243, v236
v_cvt_pk_bf16_f32 v255, v242, v243
ds_write_b64 v253, v[254:255] offset:0
s_waitcnt lgkmcnt(0)
ds_read_b64 v[254:255], v253 offset:8
s_waitcnt lgkmcnt(0)
v_lshlrev_b32 v242, 16, v254
v_and_b32 v243, 0xffff0000, v254
v_mul_f32 v242, v242, v236
v_mul_f32 v243, v243, v236
v_cvt_pk_bf16_f32 v254, v242, v243
v_lshlrev_b32 v242, 16, v255
v_and_b32 v243, 0xffff0000, v255
v_mul_f32 v242, v242, v236
v_mul_f32 v243, v243, v236
v_cvt_pk_bf16_f32 v255, v242, v243
ds_write_b64 v253, v[254:255] offset:8
s_waitcnt lgkmcnt(0)
ds_read_b64 v[254:255], v253 offset:4096
s_waitcnt lgkmcnt(0)
v_lshlrev_b32 v242, 16, v254
v_and_b32 v243, 0xffff0000, v254
v_mul_f32 v242, v242, v236
v_mul_f32 v243, v243, v236
v_cvt_pk_bf16_f32 v254, v242, v243
v_lshlrev_b32 v242, 16, v255
v_and_b32 v243, 0xffff0000, v255
v_mul_f32 v242, v242, v236
v_mul_f32 v243, v243, v236
v_cvt_pk_bf16_f32 v255, v242, v243
ds_write_b64 v253, v[254:255] offset:4096
s_waitcnt lgkmcnt(0)
ds_read_b64 v[254:255], v253 offset:4104
s_waitcnt lgkmcnt(0)
v_lshlrev_b32 v242, 16, v254
v_and_b32 v243, 0xffff0000, v254
v_mul_f32 v242, v242, v236
v_mul_f32 v243, v243, v236
v_cvt_pk_bf16_f32 v254, v242, v243
v_lshlrev_b32 v242, 16, v255
v_and_b32 v243, 0xffff0000, v255
v_mul_f32 v242, v242, v236
v_mul_f32 v243, v243, v236
v_cvt_pk_bf16_f32 v255, v242, v243
ds_write_b64 v253, v[254:255] offset:4104
s_waitcnt lgkmcnt(0)
v_log_f32 v243, v225
v_max3_f32 v233, v132, v133, v134
v_max3_f32 v233, v233, v135, v243
v_mov_b32 v243, v233
s_nop 1
v_permlane32_swap_b32 v233, v243
s_nop 1
v_max_f32 v233, v233, v243
v_mov_b32 v243, v233
s_nop 1
v_permlane16_swap_b32 v233, v243
s_nop 1
v_max_f32 v233, v233, v243
v_ceil_f32 v233, v233
v_max_f32 v233, 0, v233
v_sub_f32 v243, 0, v233
v_exp_f32 v237, v243
s_nop 1
v_mul_f32 v225, v225, v237
v_add_f32 v245, v245, v233
v_sub_f32 v196, v196, v233
v_sub_f32 v132, v132, v233
v_sub_f32 v148, v148, v233
v_sub_f32 v197, v197, v233
v_sub_f32 v133, v133, v233
v_sub_f32 v149, v149, v233
v_sub_f32 v198, v198, v233
v_sub_f32 v134, v134, v233
v_sub_f32 v150, v150, v233
v_sub_f32 v199, v199, v233
v_sub_f32 v135, v135, v233
v_sub_f32 v151, v151, v233
v_lshlrev_b32 v242, 16, v180
v_and_b32 v243, 0xffff0000, v180
v_mul_f32 v242, v242, v237
v_mul_f32 v243, v243, v237
v_cvt_pk_bf16_f32 v180, v242, v243
v_lshlrev_b32 v242, 16, v181
v_and_b32 v243, 0xffff0000, v181
v_mul_f32 v242, v242, v237
v_mul_f32 v243, v243, v237
v_cvt_pk_bf16_f32 v181, v242, v243
v_lshlrev_b32 v242, 16, v182
v_and_b32 v243, 0xffff0000, v182
v_mul_f32 v242, v242, v237
v_mul_f32 v243, v243, v237
v_cvt_pk_bf16_f32 v182, v242, v243
v_lshlrev_b32 v242, 16, v183
v_and_b32 v243, 0xffff0000, v183
v_mul_f32 v242, v242, v237
v_mul_f32 v243, v243, v237
v_cvt_pk_bf16_f32 v183, v242, v243
ds_read_b64 v[254:255], v253 offset:1024
s_waitcnt lgkmcnt(0)
v_lshlrev_b32 v242, 16, v254
v_and_b32 v243, 0xffff0000, v254
v_mul_f32 v242, v242, v237
v_mul_f32 v243, v243, v237
v_cvt_pk_bf16_f32 v254, v242, v243
v_lshlrev_b32 v242, 16, v255
v_and_b32 v243, 0xffff0000, v255
v_mul_f32 v242, v242, v237
v_mul_f32 v243, v243, v237
v_cvt_pk_bf16_f32 v255, v242, v243
ds_write_b64 v253, v[254:255] offset:1024
s_waitcnt lgkmcnt(0)
ds_read_b64 v[254:255], v253 offset:1032
s_waitcnt lgkmcnt(0)
v_lshlrev_b32 v242, 16, v254
v_and_b32 v243, 0xffff0000, v254
v_mul_f32 v242, v242, v237
v_mul_f32 v243, v243, v237
v_cvt_pk_bf16_f32 v254, v242, v243
v_lshlrev_b32 v242, 16, v255
v_and_b32 v243, 0xffff0000, v255
v_mul_f32 v242, v242, v237
v_mul_f32 v243, v243, v237
v_cvt_pk_bf16_f32 v255, v242, v243
ds_write_b64 v253, v[254:255] offset:1032
s_waitcnt lgkmcnt(0)
ds_read_b64 v[254:255], v253 offset:5120
s_waitcnt lgkmcnt(0)
v_lshlrev_b32 v242, 16, v254
v_and_b32 v243, 0xffff0000, v254
v_mul_f32 v242, v242, v237
v_mul_f32 v243, v243, v237
v_cvt_pk_bf16_f32 v254, v242, v243
v_lshlrev_b32 v242, 16, v255
v_and_b32 v243, 0xffff0000, v255
v_mul_f32 v242, v242, v237
v_mul_f32 v243, v243, v237
v_cvt_pk_bf16_f32 v255, v242, v243
ds_write_b64 v253, v[254:255] offset:5120
s_waitcnt lgkmcnt(0)
ds_read_b64 v[254:255], v253 offset:5128
s_waitcnt lgkmcnt(0)
v_lshlrev_b32 v242, 16, v254
v_and_b32 v243, 0xffff0000, v254
v_mul_f32 v242, v242, v237
v_mul_f32 v243, v243, v237
v_cvt_pk_bf16_f32 v254, v242, v243
v_lshlrev_b32 v242, 16, v255
v_and_b32 v243, 0xffff0000, v255
v_mul_f32 v242, v242, v237
v_mul_f32 v243, v243, v237
v_cvt_pk_bf16_f32 v255, v242, v243
ds_write_b64 v253, v[254:255] offset:5128
s_waitcnt lgkmcnt(0)
v_log_f32 v243, v226
v_max3_f32 v234, v136, v137, v138
v_max3_f32 v234, v234, v139, v243
v_mov_b32 v243, v234
s_nop 1
v_permlane32_swap_b32 v234, v243
s_nop 1
v_max_f32 v234, v234, v243
v_mov_b32 v243, v234
s_nop 1
v_permlane16_swap_b32 v234, v243
s_nop 1
v_max_f32 v234, v234, v243
v_ceil_f32 v234, v234
v_max_f32 v234, 0, v234
v_sub_f32 v243, 0, v234
v_exp_f32 v238, v243
s_nop 1
v_mul_f32 v226, v226, v238
v_add_f32 v246, v246, v234
v_sub_f32 v200, v200, v234
v_sub_f32 v136, v136, v234
v_sub_f32 v152, v152, v234
v_sub_f32 v201, v201, v234
v_sub_f32 v137, v137, v234
v_sub_f32 v153, v153, v234
v_sub_f32 v202, v202, v234
v_sub_f32 v138, v138, v234
v_sub_f32 v154, v154, v234
v_sub_f32 v203, v203, v234
v_sub_f32 v139, v139, v234
v_sub_f32 v155, v155, v234
v_lshlrev_b32 v242, 16, v184
v_and_b32 v243, 0xffff0000, v184
v_mul_f32 v242, v242, v238
v_mul_f32 v243, v243, v238
v_cvt_pk_bf16_f32 v184, v242, v243
v_lshlrev_b32 v242, 16, v185
v_and_b32 v243, 0xffff0000, v185
v_mul_f32 v242, v242, v238
v_mul_f32 v243, v243, v238
v_cvt_pk_bf16_f32 v185, v242, v243
v_lshlrev_b32 v242, 16, v186
v_and_b32 v243, 0xffff0000, v186
v_mul_f32 v242, v242, v238
v_mul_f32 v243, v243, v238
v_cvt_pk_bf16_f32 v186, v242, v243
v_lshlrev_b32 v242, 16, v187
v_and_b32 v243, 0xffff0000, v187
v_mul_f32 v242, v242, v238
v_mul_f32 v243, v243, v238
v_cvt_pk_bf16_f32 v187, v242, v243
ds_read_b64 v[254:255], v253 offset:2048
s_waitcnt lgkmcnt(0)
v_lshlrev_b32 v242, 16, v254
v_and_b32 v243, 0xffff0000, v254
v_mul_f32 v242, v242, v238
v_mul_f32 v243, v243, v238
v_cvt_pk_bf16_f32 v254, v242, v243
v_lshlrev_b32 v242, 16, v255
v_and_b32 v243, 0xffff0000, v255
v_mul_f32 v242, v242, v238
v_mul_f32 v243, v243, v238
v_cvt_pk_bf16_f32 v255, v242, v243
ds_write_b64 v253, v[254:255] offset:2048
s_waitcnt lgkmcnt(0)
ds_read_b64 v[254:255], v253 offset:2056
s_waitcnt lgkmcnt(0)
v_lshlrev_b32 v242, 16, v254
v_and_b32 v243, 0xffff0000, v254
v_mul_f32 v242, v242, v238
v_mul_f32 v243, v243, v238
v_cvt_pk_bf16_f32 v254, v242, v243
v_lshlrev_b32 v242, 16, v255
v_and_b32 v243, 0xffff0000, v255
v_mul_f32 v242, v242, v238
v_mul_f32 v243, v243, v238
v_cvt_pk_bf16_f32 v255, v242, v243
ds_write_b64 v253, v[254:255] offset:2056
s_waitcnt lgkmcnt(0)
ds_read_b64 v[254:255], v253 offset:6144
s_waitcnt lgkmcnt(0)
v_lshlrev_b32 v242, 16, v254
v_and_b32 v243, 0xffff0000, v254
v_mul_f32 v242, v242, v238
v_mul_f32 v243, v243, v238
v_cvt_pk_bf16_f32 v254, v242, v243
v_lshlrev_b32 v242, 16, v255
v_and_b32 v243, 0xffff0000, v255
v_mul_f32 v242, v242, v238
v_mul_f32 v243, v243, v238
v_cvt_pk_bf16_f32 v255, v242, v243
ds_write_b64 v253, v[254:255] offset:6144
s_waitcnt lgkmcnt(0)
ds_read_b64 v[254:255], v253 offset:6152
s_waitcnt lgkmcnt(0)
v_lshlrev_b32 v242, 16, v254
v_and_b32 v243, 0xffff0000, v254
v_mul_f32 v242, v242, v238
v_mul_f32 v243, v243, v238
v_cvt_pk_bf16_f32 v254, v242, v243
v_lshlrev_b32 v242, 16, v255
v_and_b32 v243, 0xffff0000, v255
v_mul_f32 v242, v242, v238
v_mul_f32 v243, v243, v238
v_cvt_pk_bf16_f32 v255, v242, v243
ds_write_b64 v253, v[254:255] offset:6152
s_waitcnt lgkmcnt(0)
v_log_f32 v243, v227
v_max3_f32 v235, v140, v141, v142
v_max3_f32 v235, v235, v143, v243
v_mov_b32 v243, v235
s_nop 1
v_permlane32_swap_b32 v235, v243
s_nop 1
v_max_f32 v235, v235, v243
v_mov_b32 v243, v235
s_nop 1
v_permlane16_swap_b32 v235, v243
s_nop 1
v_max_f32 v235, v235, v243
v_ceil_f32 v235, v235
v_max_f32 v235, 0, v235
v_sub_f32 v243, 0, v235
v_exp_f32 v239, v243
s_nop 1
v_mul_f32 v227, v227, v239
v_add_f32 v247, v247, v235
v_sub_f32 v204, v204, v235
v_sub_f32 v140, v140, v235
v_sub_f32 v156, v156, v235
v_sub_f32 v205, v205, v235
v_sub_f32 v141, v141, v235
v_sub_f32 v157, v157, v235
v_sub_f32 v206, v206, v235
v_sub_f32 v142, v142, v235
v_sub_f32 v158, v158, v235
v_sub_f32 v207, v207, v235
v_sub_f32 v143, v143, v235
v_sub_f32 v159, v159, v235
v_lshlrev_b32 v242, 16, v188
v_and_b32 v243, 0xffff0000, v188
v_mul_f32 v242, v242, v239
v_mul_f32 v243, v243, v239
v_cvt_pk_bf16_f32 v188, v242, v243
v_lshlrev_b32 v242, 16, v189
v_and_b32 v243, 0xffff0000, v189
v_mul_f32 v242, v242, v239
v_mul_f32 v243, v243, v239
v_cvt_pk_bf16_f32 v189, v242, v243
v_lshlrev_b32 v242, 16, v190
v_and_b32 v243, 0xffff0000, v190
v_mul_f32 v242, v242, v239
v_mul_f32 v243, v243, v239
v_cvt_pk_bf16_f32 v190, v242, v243
v_lshlrev_b32 v242, 16, v191
v_and_b32 v243, 0xffff0000, v191
v_mul_f32 v242, v242, v239
v_mul_f32 v243, v243, v239
v_cvt_pk_bf16_f32 v191, v242, v243
ds_read_b64 v[254:255], v253 offset:3072
s_waitcnt lgkmcnt(0)
v_lshlrev_b32 v242, 16, v254
v_and_b32 v243, 0xffff0000, v254
v_mul_f32 v242, v242, v239
v_mul_f32 v243, v243, v239
v_cvt_pk_bf16_f32 v254, v242, v243
v_lshlrev_b32 v242, 16, v255
v_and_b32 v243, 0xffff0000, v255
v_mul_f32 v242, v242, v239
v_mul_f32 v243, v243, v239
v_cvt_pk_bf16_f32 v255, v242, v243
ds_write_b64 v253, v[254:255] offset:3072
s_waitcnt lgkmcnt(0)
ds_read_b64 v[254:255], v253 offset:3080
s_waitcnt lgkmcnt(0)
v_lshlrev_b32 v242, 16, v254
v_and_b32 v243, 0xffff0000, v254
v_mul_f32 v242, v242, v239
v_mul_f32 v243, v243, v239
v_cvt_pk_bf16_f32 v254, v242, v243
v_lshlrev_b32 v242, 16, v255
v_and_b32 v243, 0xffff0000, v255
v_mul_f32 v242, v242, v239
v_mul_f32 v243, v243, v239
v_cvt_pk_bf16_f32 v255, v242, v243
ds_write_b64 v253, v[254:255] offset:3080
s_waitcnt lgkmcnt(0)
ds_read_b64 v[254:255], v253 offset:7168
s_waitcnt lgkmcnt(0)
v_lshlrev_b32 v242, 16, v254
v_and_b32 v243, 0xffff0000, v254
v_mul_f32 v242, v242, v239
v_mul_f32 v243, v243, v239
v_cvt_pk_bf16_f32 v254, v242, v243
v_lshlrev_b32 v242, 16, v255
v_and_b32 v243, 0xffff0000, v255
v_mul_f32 v242, v242, v239
v_mul_f32 v243, v243, v239
v_cvt_pk_bf16_f32 v255, v242, v243
ds_write_b64 v253, v[254:255] offset:7168
s_waitcnt lgkmcnt(0)
ds_read_b64 v[254:255], v253 offset:7176
s_waitcnt lgkmcnt(0)
v_lshlrev_b32 v242, 16, v254
v_and_b32 v243, 0xffff0000, v254
v_mul_f32 v242, v242, v239
v_mul_f32 v243, v243, v239
v_cvt_pk_bf16_f32 v254, v242, v243
v_lshlrev_b32 v242, 16, v255
v_and_b32 v243, 0xffff0000, v255
v_mul_f32 v242, v242, v239
v_mul_f32 v243, v243, v239
v_cvt_pk_bf16_f32 v255, v242, v243
ds_write_b64 v253, v[254:255] offset:7176
s_waitcnt lgkmcnt(0)
v_exp_f32 v232, v128
v_exp_f32 v233, v129
v_exp_f32 v234, v130
v_exp_f32 v235, v131
s_nop 1
v_add_f32 v228, v224, v232
v_add_f32 v228, v228, v233
v_add_f32 v228, v228, v234
v_add_f32 v228, v228, v235
v_cvt_pk_bf16_f32 v160, v232, v233
v_cvt_pk_bf16_f32 v161, v234, v235
v_exp_f32 v232, v132
v_exp_f32 v233, v133
v_exp_f32 v234, v134
v_exp_f32 v235, v135
s_nop 1
v_add_f32 v229, v225, v232
v_add_f32 v229, v229, v233
v_add_f32 v229, v229, v234
v_add_f32 v229, v229, v235
v_cvt_pk_bf16_f32 v164, v232, v233
v_cvt_pk_bf16_f32 v165, v234, v235
v_exp_f32 v232, v136
v_exp_f32 v233, v137
v_exp_f32 v234, v138
v_exp_f32 v235, v139
s_nop 1
v_add_f32 v230, v226, v232
v_add_f32 v230, v230, v233
v_add_f32 v230, v230, v234
v_add_f32 v230, v230, v235
v_cvt_pk_bf16_f32 v168, v232, v233
v_cvt_pk_bf16_f32 v169, v234, v235
v_exp_f32 v232, v140
v_exp_f32 v233, v141
v_exp_f32 v234, v142
v_exp_f32 v235, v143
s_nop 1
v_add_f32 v231, v227, v232
v_add_f32 v231, v231, v233
v_add_f32 v231, v231, v234
v_add_f32 v231, v231, v235
v_cvt_pk_bf16_f32 v172, v232, v233
v_cvt_pk_bf16_f32 v173, v234, v235
s_branch L2_rare_common
L2_rare_site17:
s_mov_b32 s36, 17
s_branch L2_rare_t1_5_1
L2_rare_t1_5_1:
s_nop 15
s_nop 15
s_waitcnt lgkmcnt(0)
v_log_f32 v243, v228
v_max3_f32 v232, v144, v145, v146
v_max3_f32 v232, v232, v147, v243
v_mov_b32 v243, v232
s_nop 1
v_permlane32_swap_b32 v232, v243
s_nop 1
v_max_f32 v232, v232, v243
v_mov_b32 v243, v232
s_nop 1
v_permlane16_swap_b32 v232, v243
s_nop 1
v_max_f32 v232, v232, v243
v_ceil_f32 v232, v232
v_max_f32 v232, 0, v232
v_sub_f32 v243, 0, v232
v_exp_f32 v236, v243
s_nop 1
v_mul_f32 v228, v228, v236
v_add_f32 v244, v244, v232
v_sub_f32 v192, v192, v232
v_sub_f32 v128, v128, v232
v_sub_f32 v144, v144, v232
v_sub_f32 v193, v193, v232
v_sub_f32 v129, v129, v232
v_sub_f32 v145, v145, v232
v_sub_f32 v194, v194, v232
v_sub_f32 v130, v130, v232
v_sub_f32 v146, v146, v232
v_sub_f32 v195, v195, v232
v_sub_f32 v131, v131, v232
v_sub_f32 v147, v147, v232
v_lshlrev_b32 v242, 16, v176
v_and_b32 v243, 0xffff0000, v176
v_mul_f32 v242, v242, v236
v_mul_f32 v243, v243, v236
v_cvt_pk_bf16_f32 v176, v242, v243
v_lshlrev_b32 v242, 16, v177
v_and_b32 v243, 0xffff0000, v177
v_mul_f32 v242, v242, v236
v_mul_f32 v243, v243, v236
v_cvt_pk_bf16_f32 v177, v242, v243
v_lshlrev_b32 v242, 16, v178
v_and_b32 v243, 0xffff0000, v178
v_mul_f32 v242, v242, v236
v_mul_f32 v243, v243, v236
v_cvt_pk_bf16_f32 v178, v242, v243
v_lshlrev_b32 v242, 16, v179
v_and_b32 v243, 0xffff0000, v179
v_mul_f32 v242, v242, v236
v_mul_f32 v243, v243, v236
v_cvt_pk_bf16_f32 v179, v242, v243
v_lshlrev_b32 v242, 16, v160
v_and_b32 v243, 0xffff0000, v160
v_mul_f32 v242, v242, v236
v_mul_f32 v243, v243, v236
v_cvt_pk_bf16_f32 v160, v242, v243
v_lshlrev_b32 v242, 16, v161
v_and_b32 v243, 0xffff0000, v161
v_mul_f32 v242, v242, v236
v_mul_f32 v243, v243, v236
v_cvt_pk_bf16_f32 v161, v242, v243
ds_read_b64 v[254:255], v253 offset:0
s_waitcnt lgkmcnt(0)
v_lshlrev_b32 v242, 16, v254
v_and_b32 v243, 0xffff0000, v254
v_mul_f32 v242, v242, v236
v_mul_f32 v243, v243, v236
v_cvt_pk_bf16_f32 v254, v242, v243
v_lshlrev_b32 v242, 16, v255
v_and_b32 v243, 0xffff0000, v255
v_mul_f32 v242, v242, v236
v_mul_f32 v243, v243, v236
v_cvt_pk_bf16_f32 v255, v242, v243
ds_write_b64 v253, v[254:255] offset:0
s_waitcnt lgkmcnt(0)
ds_read_b64 v[254:255], v253 offset:8
s_waitcnt lgkmcnt(0)
v_lshlrev_b32 v242, 16, v254
v_and_b32 v243, 0xffff0000, v254
v_mul_f32 v242, v242, v236
v_mul_f32 v243, v243, v236
v_cvt_pk_bf16_f32 v254, v242, v243
v_lshlrev_b32 v242, 16, v255
v_and_b32 v243, 0xffff0000, v255
v_mul_f32 v242, v242, v236
v_mul_f32 v243, v243, v236
v_cvt_pk_bf16_f32 v255, v242, v243
ds_write_b64 v253, v[254:255] offset:8
s_waitcnt lgkmcnt(0)
ds_read_b64 v[254:255], v253 offset:4096
s_waitcnt lgkmcnt(0)
v_lshlrev_b32 v242, 16, v254
v_and_b32 v243, 0xffff0000, v254
v_mul_f32 v242, v242, v236
v_mul_f32 v243, v243, v236
v_cvt_pk_bf16_f32 v254, v242, v243
v_lshlrev_b32 v242, 16, v255
v_and_b32 v243, 0xffff0000, v255
v_mul_f32 v242, v242, v236
v_mul_f32 v243, v243, v236
v_cvt_pk_bf16_f32 v255, v242, v243
ds_write_b64 v253, v[254:255] offset:4096
s_waitcnt lgkmcnt(0)
ds_read_b64 v[254:255], v253 offset:4104
s_waitcnt lgkmcnt(0)
v_lshlrev_b32 v242, 16, v254
v_and_b32 v243, 0xffff0000, v254
v_mul_f32 v242, v242, v236
v_mul_f32 v243, v243, v236
v_cvt_pk_bf16_f32 v254, v242, v243
v_lshlrev_b32 v242, 16, v255
v_and_b32 v243, 0xffff0000, v255
v_mul_f32 v242, v242, v236
v_mul_f32 v243, v243, v236
v_cvt_pk_bf16_f32 v255, v242, v243
ds_write_b64 v253, v[254:255] offset:4104
s_waitcnt lgkmcnt(0)
v_log_f32 v243, v229
v_max3_f32 v233, v148, v149, v150
v_max3_f32 v233, v233, v151, v243
v_mov_b32 v243, v233
s_nop 1
v_permlane32_swap_b32 v233, v243
s_nop 1
v_max_f32 v233, v233, v243
v_mov_b32 v243, v233
s_nop 1
v_permlane16_swap_b32 v233, v243
s_nop 1
v_max_f32 v233, v233, v243
v_ceil_f32 v233, v233
v_max_f32 v233, 0, v233
v_sub_f32 v243, 0, v233
v_exp_f32 v237, v243
s_nop 1
v_mul_f32 v229, v229, v237
v_add_f32 v245, v245, v233
v_sub_f32 v196, v196, v233
v_sub_f32 v132, v132, v233
v_sub_f32 v148, v148, v233
v_sub_f32 v197, v197, v233
v_sub_f32 v133, v133, v233
v_sub_f32 v149, v149, v233
v_sub_f32 v198, v198, v233
v_sub_f32 v134, v134, v233
v_sub_f32 v150, v150, v233
v_sub_f32 v199, v199, v233
v_sub_f32 v135, v135, v233
v_sub_f32 v151, v151, v233
v_lshlrev_b32 v242, 16, v180
v_and_b32 v243, 0xffff0000, v180
v_mul_f32 v242, v242, v237
v_mul_f32 v243, v243, v237
v_cvt_pk_bf16_f32 v180, v242, v243
v_lshlrev_b32 v242, 16, v181
v_and_b32 v243, 0xffff0000, v181
v_mul_f32 v242, v242, v237
v_mul_f32 v243, v243, v237
v_cvt_pk_bf16_f32 v181, v242, v243
v_lshlrev_b32 v242, 16, v182
v_and_b32 v243, 0xffff0000, v182
v_mul_f32 v242, v242, v237
v_mul_f32 v243, v243, v237
v_cvt_pk_bf16_f32 v182, v242, v243
v_lshlrev_b32 v242, 16, v183
v_and_b32 v243, 0xffff0000, v183
v_mul_f32 v242, v242, v237
v_mul_f32 v243, v243, v237
v_cvt_pk_bf16_f32 v183, v242, v243
v_lshlrev_b32 v242, 16, v164
v_and_b32 v243, 0xffff0000, v164
v_mul_f32 v242, v242, v237
v_mul_f32 v243, v243, v237
v_cvt_pk_bf16_f32 v164, v242, v243
v_lshlrev_b32 v242, 16, v165
v_and_b32 v243, 0xffff0000, v165
v_mul_f32 v242, v242, v237
v_mul_f32 v243, v243, v237
v_cvt_pk_bf16_f32 v165, v242, v243
ds_read_b64 v[254:255], v253 offset:1024
s_waitcnt lgkmcnt(0)
v_lshlrev_b32 v242, 16, v254
v_and_b32 v243, 0xffff0000, v254
v_mul_f32 v242, v242, v237
v_mul_f32 v243, v243, v237
v_cvt_pk_bf16_f32 v254, v242, v243
v_lshlrev_b32 v242, 16, v255
v_and_b32 v243, 0xffff0000, v255
v_mul_f32 v242, v242, v237
v_mul_f32 v243, v243, v237
v_cvt_pk_bf16_f32 v255, v242, v243
ds_write_b64 v253, v[254:255] offset:1024
s_waitcnt lgkmcnt(0)
ds_read_b64 v[254:255], v253 offset:1032
s_waitcnt lgkmcnt(0)
v_lshlrev_b32 v242, 16, v254
v_and_b32 v243, 0xffff0000, v254
v_mul_f32 v242, v242, v237
v_mul_f32 v243, v243, v237
v_cvt_pk_bf16_f32 v254, v242, v243
v_lshlrev_b32 v242, 16, v255
v_and_b32 v243, 0xffff0000, v255
v_mul_f32 v242, v242, v237
v_mul_f32 v243, v243, v237
v_cvt_pk_bf16_f32 v255, v242, v243
ds_write_b64 v253, v[254:255] offset:1032
s_waitcnt lgkmcnt(0)
ds_read_b64 v[254:255], v253 offset:5120
s_waitcnt lgkmcnt(0)
v_lshlrev_b32 v242, 16, v254
v_and_b32 v243, 0xffff0000, v254
v_mul_f32 v242, v242, v237
v_mul_f32 v243, v243, v237
v_cvt_pk_bf16_f32 v254, v242, v243
v_lshlrev_b32 v242, 16, v255
v_and_b32 v243, 0xffff0000, v255
v_mul_f32 v242, v242, v237
v_mul_f32 v243, v243, v237
v_cvt_pk_bf16_f32 v255, v242, v243
ds_write_b64 v253, v[254:255] offset:5120
s_waitcnt lgkmcnt(0)
ds_read_b64 v[254:255], v253 offset:5128
s_waitcnt lgkmcnt(0)
v_lshlrev_b32 v242, 16, v254
v_and_b32 v243, 0xffff0000, v254
v_mul_f32 v242, v242, v237
v_mul_f32 v243, v243, v237
v_cvt_pk_bf16_f32 v254, v242, v243
v_lshlrev_b32 v242, 16, v255
v_and_b32 v243, 0xffff0000, v255
v_mul_f32 v242, v242, v237
v_mul_f32 v243, v243, v237
v_cvt_pk_bf16_f32 v255, v242, v243
ds_write_b64 v253, v[254:255] offset:5128
s_waitcnt lgkmcnt(0)
v_log_f32 v243, v230
v_max3_f32 v234, v152, v153, v154
v_max3_f32 v234, v234, v155, v243
v_mov_b32 v243, v234
s_nop 1
v_permlane32_swap_b32 v234, v243
s_nop 1
v_max_f32 v234, v234, v243
v_mov_b32 v243, v234
s_nop 1
v_permlane16_swap_b32 v234, v243
s_nop 1
v_max_f32 v234, v234, v243
v_ceil_f32 v234, v234
v_max_f32 v234, 0, v234
v_sub_f32 v243, 0, v234
v_exp_f32 v238, v243
s_nop 1
v_mul_f32 v230, v230, v238
v_add_f32 v246, v246, v234
v_sub_f32 v200, v200, v234
v_sub_f32 v136, v136, v234
v_sub_f32 v152, v152, v234
v_sub_f32 v201, v201, v234
v_sub_f32 v137, v137, v234
v_sub_f32 v153, v153, v234
v_sub_f32 v202, v202, v234
v_sub_f32 v138, v138, v234
v_sub_f32 v154, v154, v234
v_sub_f32 v203, v203, v234
v_sub_f32 v139, v139, v234
v_sub_f32 v155, v155, v234
v_lshlrev_b32 v242, 16, v184
v_and_b32 v243, 0xffff0000, v184
v_mul_f32 v242, v242, v238
v_mul_f32 v243, v243, v238
v_cvt_pk_bf16_f32 v184, v242, v243
v_lshlrev_b32 v242, 16, v185
v_and_b32 v243, 0xffff0000, v185
v_mul_f32 v242, v242, v238
v_mul_f32 v243, v243, v238
v_cvt_pk_bf16_f32 v185, v242, v243
v_lshlrev_b32 v242, 16, v186
v_and_b32 v243, 0xffff0000, v186
v_mul_f32 v242, v242, v238
v_mul_f32 v243, v243, v238
v_cvt_pk_bf16_f32 v186, v242, v243
v_lshlrev_b32 v242, 16, v187
v_and_b32 v243, 0xffff0000, v187
v_mul_f32 v242, v242, v238
v_mul_f32 v243, v243, v238
v_cvt_pk_bf16_f32 v187, v242, v243
v_lshlrev_b32 v242, 16, v168
v_and_b32 v243, 0xffff0000, v168
v_mul_f32 v242, v242, v238
v_mul_f32 v243, v243, v238
v_cvt_pk_bf16_f32 v168, v242, v243
v_lshlrev_b32 v242, 16, v169
v_and_b32 v243, 0xffff0000, v169
v_mul_f32 v242, v242, v238
v_mul_f32 v243, v243, v238
v_cvt_pk_bf16_f32 v169, v242, v243
ds_read_b64 v[254:255], v253 offset:2048
s_waitcnt lgkmcnt(0)
v_lshlrev_b32 v242, 16, v254
v_and_b32 v243, 0xffff0000, v254
v_mul_f32 v242, v242, v238
v_mul_f32 v243, v243, v238
v_cvt_pk_bf16_f32 v254, v242, v243
v_lshlrev_b32 v242, 16, v255
v_and_b32 v243, 0xffff0000, v255
v_mul_f32 v242, v242, v238
v_mul_f32 v243, v243, v238
v_cvt_pk_bf16_f32 v255, v242, v243
ds_write_b64 v253, v[254:255] offset:2048
s_waitcnt lgkmcnt(0)
ds_read_b64 v[254:255], v253 offset:2056
s_waitcnt lgkmcnt(0)
v_lshlrev_b32 v242, 16, v254
v_and_b32 v243, 0xffff0000, v254
v_mul_f32 v242, v242, v238
v_mul_f32 v243, v243, v238
v_cvt_pk_bf16_f32 v254, v242, v243
v_lshlrev_b32 v242, 16, v255
v_and_b32 v243, 0xffff0000, v255
v_mul_f32 v242, v242, v238
v_mul_f32 v243, v243, v238
v_cvt_pk_bf16_f32 v255, v242, v243
ds_write_b64 v253, v[254:255] offset:2056
s_waitcnt lgkmcnt(0)
ds_read_b64 v[254:255], v253 offset:6144
s_waitcnt lgkmcnt(0)
v_lshlrev_b32 v242, 16, v254
v_and_b32 v243, 0xffff0000, v254
v_mul_f32 v242, v242, v238
v_mul_f32 v243, v243, v238
v_cvt_pk_bf16_f32 v254, v242, v243
v_lshlrev_b32 v242, 16, v255
v_and_b32 v243, 0xffff0000, v255
v_mul_f32 v242, v242, v238
v_mul_f32 v243, v243, v238
v_cvt_pk_bf16_f32 v255, v242, v243
ds_write_b64 v253, v[254:255] offset:6144
s_waitcnt lgkmcnt(0)
ds_read_b64 v[254:255], v253 offset:6152
s_waitcnt lgkmcnt(0)
v_lshlrev_b32 v242, 16, v254
v_and_b32 v243, 0xffff0000, v254
v_mul_f32 v242, v242, v238
v_mul_f32 v243, v243, v238
v_cvt_pk_bf16_f32 v254, v242, v243
v_lshlrev_b32 v242, 16, v255
v_and_b32 v243, 0xffff0000, v255
v_mul_f32 v242, v242, v238
v_mul_f32 v243, v243, v238
v_cvt_pk_bf16_f32 v255, v242, v243
ds_write_b64 v253, v[254:255] offset:6152
s_waitcnt lgkmcnt(0)
v_log_f32 v243, v231
v_max3_f32 v235, v156, v157, v158
v_max3_f32 v235, v235, v159, v243
v_mov_b32 v243, v235
s_nop 1
v_permlane32_swap_b32 v235, v243
s_nop 1
v_max_f32 v235, v235, v243
v_mov_b32 v243, v235
s_nop 1
v_permlane16_swap_b32 v235, v243
s_nop 1
v_max_f32 v235, v235, v243
v_ceil_f32 v235, v235
v_max_f32 v235, 0, v235
v_sub_f32 v243, 0, v235
v_exp_f32 v239, v243
s_nop 1
v_mul_f32 v231, v231, v239
v_add_f32 v247, v247, v235
v_sub_f32 v204, v204, v235
v_sub_f32 v140, v140, v235
v_sub_f32 v156, v156, v235
v_sub_f32 v205, v205, v235
v_sub_f32 v141, v141, v235
v_sub_f32 v157, v157, v235
v_sub_f32 v206, v206, v235
v_sub_f32 v142, v142, v235
v_sub_f32 v158, v158, v235
v_sub_f32 v207, v207, v235
v_sub_f32 v143, v143, v235
v_sub_f32 v159, v159, v235
v_lshlrev_b32 v242, 16, v188
v_and_b32 v243, 0xffff0000, v188
v_mul_f32 v242, v242, v239
v_mul_f32 v243, v243, v239
v_cvt_pk_bf16_f32 v188, v242, v243
v_lshlrev_b32 v242, 16, v189
v_and_b32 v243, 0xffff0000, v189
v_mul_f32 v242, v242, v239
v_mul_f32 v243, v243, v239
v_cvt_pk_bf16_f32 v189, v242, v243
v_lshlrev_b32 v242, 16, v190
v_and_b32 v243, 0xffff0000, v190
v_mul_f32 v242, v242, v239
v_mul_f32 v243, v243, v239
v_cvt_pk_bf16_f32 v190, v242, v243
v_lshlrev_b32 v242, 16, v191
v_and_b32 v243, 0xffff0000, v191
v_mul_f32 v242, v242, v239
v_mul_f32 v243, v243, v239
v_cvt_pk_bf16_f32 v191, v242, v243
v_lshlrev_b32 v242, 16, v172
v_and_b32 v243, 0xffff0000, v172
v_mul_f32 v242, v242, v239
v_mul_f32 v243, v243, v239
v_cvt_pk_bf16_f32 v172, v242, v243
v_lshlrev_b32 v242, 16, v173
v_and_b32 v243, 0xffff0000, v173
v_mul_f32 v242, v242, v239
v_mul_f32 v243, v243, v239
v_cvt_pk_bf16_f32 v173, v242, v243
ds_read_b64 v[254:255], v253 offset:3072
s_waitcnt lgkmcnt(0)
v_lshlrev_b32 v242, 16, v254
v_and_b32 v243, 0xffff0000, v254
v_mul_f32 v242, v242, v239
v_mul_f32 v243, v243, v239
v_cvt_pk_bf16_f32 v254, v242, v243
v_lshlrev_b32 v242, 16, v255
v_and_b32 v243, 0xffff0000, v255
v_mul_f32 v242, v242, v239
v_mul_f32 v243, v243, v239
v_cvt_pk_bf16_f32 v255, v242, v243
ds_write_b64 v253, v[254:255] offset:3072
s_waitcnt lgkmcnt(0)
ds_read_b64 v[254:255], v253 offset:3080
s_waitcnt lgkmcnt(0)
v_lshlrev_b32 v242, 16, v254
v_and_b32 v243, 0xffff0000, v254
v_mul_f32 v242, v242, v239
v_mul_f32 v243, v243, v239
v_cvt_pk_bf16_f32 v254, v242, v243
v_lshlrev_b32 v242, 16, v255
v_and_b32 v243, 0xffff0000, v255
v_mul_f32 v242, v242, v239
v_mul_f32 v243, v243, v239
v_cvt_pk_bf16_f32 v255, v242, v243
ds_write_b64 v253, v[254:255] offset:3080
s_waitcnt lgkmcnt(0)
ds_read_b64 v[254:255], v253 offset:7168
s_waitcnt lgkmcnt(0)
v_lshlrev_b32 v242, 16, v254
v_and_b32 v243, 0xffff0000, v254
v_mul_f32 v242, v242, v239
v_mul_f32 v243, v243, v239
v_cvt_pk_bf16_f32 v254, v242, v243
v_lshlrev_b32 v242, 16, v255
v_and_b32 v243, 0xffff0000, v255
v_mul_f32 v242, v242, v239
v_mul_f32 v243, v243, v239
v_cvt_pk_bf16_f32 v255, v242, v243
ds_write_b64 v253, v[254:255] offset:7168
s_waitcnt lgkmcnt(0)
ds_read_b64 v[254:255], v253 offset:7176
s_waitcnt lgkmcnt(0)
v_lshlrev_b32 v242, 16, v254
v_and_b32 v243, 0xffff0000, v254
v_mul_f32 v242, v242, v239
v_mul_f32 v243, v243, v239
v_cvt_pk_bf16_f32 v254, v242, v243
v_lshlrev_b32 v242, 16, v255
v_and_b32 v243, 0xffff0000, v255
v_mul_f32 v242, v242, v239
v_mul_f32 v243, v243, v239
v_cvt_pk_bf16_f32 v255, v242, v243
ds_write_b64 v253, v[254:255] offset:7176
s_waitcnt lgkmcnt(0)
v_exp_f32 v232, v144
v_exp_f32 v233, v145
v_exp_f32 v234, v146
v_exp_f32 v235, v147
s_nop 1
v_add_f32 v224, v228, v232
v_add_f32 v224, v224, v233
v_add_f32 v224, v224, v234
v_add_f32 v224, v224, v235
v_cvt_pk_bf16_f32 v162, v232, v233
v_cvt_pk_bf16_f32 v163, v234, v235
v_exp_f32 v232, v148
v_exp_f32 v233, v149
v_exp_f32 v234, v150
v_exp_f32 v235, v151
s_nop 1
v_add_f32 v225, v229, v232
v_add_f32 v225, v225, v233
v_add_f32 v225, v225, v234
v_add_f32 v225, v225, v235
v_cvt_pk_bf16_f32 v166, v232, v233
v_cvt_pk_bf16_f32 v167, v234, v235
v_exp_f32 v232, v152
v_exp_f32 v233, v153
v_exp_f32 v234, v154
v_exp_f32 v235, v155
s_nop 1
v_add_f32 v226, v230, v232
v_add_f32 v226, v226, v233
v_add_f32 v226, v226, v234
v_add_f32 v226, v226, v235
v_cvt_pk_bf16_f32 v170, v232, v233
v_cvt_pk_bf16_f32 v171, v234, v235
v_exp_f32 v232, v156
v_exp_f32 v233, v157
v_exp_f32 v234, v158
v_exp_f32 v235, v159
s_nop 1
v_add_f32 v227, v231, v232
v_add_f32 v227, v227, v233
v_add_f32 v227, v227, v234
v_add_f32 v227, v227, v235
v_cvt_pk_bf16_f32 v174, v232, v233
v_cvt_pk_bf16_f32 v175, v234, v235
s_branch L2_rare_common
L2_rare_site18:
s_mov_b32 s36, 18
s_branch L2_rare_t1_6_0
L2_rare_t1_6_0:
s_nop 15
s_nop 15
s_waitcnt lgkmcnt(0)
v_log_f32 v243, v224
v_max3_f32 v232, v128, v129, v130
v_max3_f32 v232, v232, v131, v243
v_mov_b32 v243, v232
s_nop 1
v_permlane32_swap_b32 v232, v243
s_nop 1
v_max_f32 v232, v232, v243
v_mov_b32 v243, v232
s_nop 1
v_permlane16_swap_b32 v232, v243
s_nop 1
v_max_f32 v232, v232, v243
v_ceil_f32 v232, v232
v_max_f32 v232, 0, v232
v_sub_f32 v243, 0, v232
v_exp_f32 v236, v243
s_nop 1
v_mul_f32 v224, v224, v236
v_add_f32 v244, v244, v232
v_sub_f32 v192, v192, v232
v_sub_f32 v128, v128, v232
v_sub_f32 v144, v144, v232
v_sub_f32 v193, v193, v232
v_sub_f32 v129, v129, v232
v_sub_f32 v145, v145, v232
v_sub_f32 v194, v194, v232
v_sub_f32 v130, v130, v232
v_sub_f32 v146, v146, v232
v_sub_f32 v195, v195, v232
v_sub_f32 v131, v131, v232
v_sub_f32 v147, v147, v232
v_lshlrev_b32 v242, 16, v4
v_and_b32 v243, 0xffff0000, v4
v_mul_f32 v242, v242, v236
v_mul_f32 v243, v243, v236
v_cvt_pk_bf16_f32 v4, v242, v243
v_lshlrev_b32 v242, 16, v5
v_and_b32 v243, 0xffff0000, v5
v_mul_f32 v242, v242, v236
v_mul_f32 v243, v243, v236
v_cvt_pk_bf16_f32 v5, v242, v243
v_lshlrev_b32 v242, 16, v6
v_and_b32 v243, 0xffff0000, v6
v_mul_f32 v242, v242, v236
v_mul_f32 v243, v243, v236
v_cvt_pk_bf16_f32 v6, v242, v243
v_lshlrev_b32 v242, 16, v7
v_and_b32 v243, 0xffff0000, v7
v_mul_f32 v242, v242, v236
v_mul_f32 v243, v243, v236
v_cvt_pk_bf16_f32 v7, v242, v243
v_lshlrev_b32 v242, 16, v8
v_and_b32 v243, 0xffff0000, v8
v_mul_f32 v242, v242, v236
v_mul_f32 v243, v243, v236
v_cvt_pk_bf16_f32 v8, v242, v243
v_lshlrev_b32 v242, 16, v9
v_and_b32 v243, 0xffff0000, v9
v_mul_f32 v242, v242, v236
v_mul_f32 v243, v243, v236
v_cvt_pk_bf16_f32 v9, v242, v243
v_lshlrev_b32 v242, 16, v10
v_and_b32 v243, 0xffff0000, v10
v_mul_f32 v242, v242, v236
v_mul_f32 v243, v243, v236
v_cvt_pk_bf16_f32 v10, v242, v243
v_lshlrev_b32 v242, 16, v11
v_and_b32 v243, 0xffff0000, v11
v_mul_f32 v242, v242, v236
v_mul_f32 v243, v243, v236
v_cvt_pk_bf16_f32 v11, v242, v243
v_lshlrev_b32 v242, 16, v176
v_and_b32 v243, 0xffff0000, v176
v_mul_f32 v242, v242, v236
v_mul_f32 v243, v243, v236
v_cvt_pk_bf16_f32 v176, v242, v243
v_lshlrev_b32 v242, 16, v177
v_and_b32 v243, 0xffff0000, v177
v_mul_f32 v242, v242, v236
v_mul_f32 v243, v243, v236
v_cvt_pk_bf16_f32 v177, v242, v243
v_lshlrev_b32 v242, 16, v178
v_and_b32 v243, 0xffff0000, v178
v_mul_f32 v242, v242, v236
v_mul_f32 v243, v243, v236
v_cvt_pk_bf16_f32 v178, v242, v243
v_lshlrev_b32 v242, 16, v179
v_and_b32 v243, 0xffff0000, v179
v_mul_f32 v242, v242, v236
v_mul_f32 v243, v243, v236
v_cvt_pk_bf16_f32 v179, v242, v243
v_lshlrev_b32 v242, 16, v160
v_and_b32 v243, 0xffff0000, v160
v_mul_f32 v242, v242, v236
v_mul_f32 v243, v243, v236
v_cvt_pk_bf16_f32 v160, v242, v243
v_lshlrev_b32 v242, 16, v161
v_and_b32 v243, 0xffff0000, v161
v_mul_f32 v242, v242, v236
v_mul_f32 v243, v243, v236
v_cvt_pk_bf16_f32 v161, v242, v243
v_lshlrev_b32 v242, 16, v162
v_and_b32 v243, 0xffff0000, v162
v_mul_f32 v242, v242, v236
v_mul_f32 v243, v243, v236
v_cvt_pk_bf16_f32 v162, v242, v243
v_lshlrev_b32 v242, 16, v163
v_and_b32 v243, 0xffff0000, v163
v_mul_f32 v242, v242, v236
v_mul_f32 v243, v243, v236
v_cvt_pk_bf16_f32 v163, v242, v243
v_log_f32 v243, v225
v_max3_f32 v233, v132, v133, v134
v_max3_f32 v233, v233, v135, v243
v_mov_b32 v243, v233
s_nop 1
v_permlane32_swap_b32 v233, v243
s_nop 1
v_max_f32 v233, v233, v243
v_mov_b32 v243, v233
s_nop 1
v_permlane16_swap_b32 v233, v243
s_nop 1
v_max_f32 v233, v233, v243
v_ceil_f32 v233, v233
v_max_f32 v233, 0, v233
v_sub_f32 v243, 0, v233
v_exp_f32 v237, v243
s_nop 1
v_mul_f32 v225, v225, v237
v_add_f32 v245, v245, v233
v_sub_f32 v196, v196, v233
v_sub_f32 v132, v132, v233
v_sub_f32 v148, v148, v233
v_sub_f32 v197, v197, v233
v_sub_f32 v133, v133, v233
v_sub_f32 v149, v149, v233
v_sub_f32 v198, v198, v233
v_sub_f32 v134, v134, v233
v_sub_f32 v150, v150, v233
v_sub_f32 v199, v199, v233
v_sub_f32 v135, v135, v233
v_sub_f32 v151, v151, v233
v_lshlrev_b32 v242, 16, v36
v_and_b32 v243, 0xffff0000, v36
v_mul_f32 v242, v242, v237
v_mul_f32 v243, v243, v237
v_cvt_pk_bf16_f32 v36, v242, v243
v_lshlrev_b32 v242, 16, v37
v_and_b32 v243, 0xffff0000, v37
v_mul_f32 v242, v242, v237
v_mul_f32 v243, v243, v237
v_cvt_pk_bf16_f32 v37, v242, v243
v_lshlrev_b32 v242, 16, v38
v_and_b32 v243, 0xffff0000, v38
v_mul_f32 v242, v242, v237
v_mul_f32 v243, v243, v237
v_cvt_pk_bf16_f32 v38, v242, v243
v_lshlrev_b32 v242, 16, v39
v_and_b32 v243, 0xffff0000, v39
v_mul_f32 v242, v242, v237
v_mul_f32 v243, v243, v237
v_cvt_pk_bf16_f32 v39, v242, v243
v_lshlrev_b32 v242, 16, v40
v_and_b32 v243, 0xffff0000, v40
v_mul_f32 v242, v242, v237
v_mul_f32 v243, v243, v237
v_cvt_pk_bf16_f32 v40, v242, v243
v_lshlrev_b32 v242, 16, v41
v_and_b32 v243, 0xffff0000, v41
v_mul_f32 v242, v242, v237
v_mul_f32 v243, v243, v237
v_cvt_pk_bf16_f32 v41, v242, v243
v_lshlrev_b32 v242, 16, v42
v_and_b32 v243, 0xffff0000, v42
v_mul_f32 v242, v242, v237
v_mul_f32 v243, v243, v237
v_cvt_pk_bf16_f32 v42, v242, v243
v_lshlrev_b32 v242, 16, v43
v_and_b32 v243, 0xffff0000, v43
v_mul_f32 v242, v242, v237
v_mul_f32 v243, v243, v237
v_cvt_pk_bf16_f32 v43, v242, v243
v_lshlrev_b32 v242, 16, v180
v_and_b32 v243, 0xffff0000, v180
v_mul_f32 v242, v242, v237
v_mul_f32 v243, v243, v237
v_cvt_pk_bf16_f32 v180, v242, v243
v_lshlrev_b32 v242, 16, v181
v_and_b32 v243, 0xffff0000, v181
v_mul_f32 v242, v242, v237
v_mul_f32 v243, v243, v237
v_cvt_pk_bf16_f32 v181, v242, v243
v_lshlrev_b32 v242, 16, v182
v_and_b32 v243, 0xffff0000, v182
v_mul_f32 v242, v242, v237
v_mul_f32 v243, v243, v237
v_cvt_pk_bf16_f32 v182, v242, v243
v_lshlrev_b32 v242, 16, v183
v_and_b32 v243, 0xffff0000, v183
v_mul_f32 v242, v242, v237
v_mul_f32 v243, v243, v237
v_cvt_pk_bf16_f32 v183, v242, v243
v_lshlrev_b32 v242, 16, v164
v_and_b32 v243, 0xffff0000, v164
v_mul_f32 v242, v242, v237
v_mul_f32 v243, v243, v237
v_cvt_pk_bf16_f32 v164, v242, v243
v_lshlrev_b32 v242, 16, v165
v_and_b32 v243, 0xffff0000, v165
v_mul_f32 v242, v242, v237
v_mul_f32 v243, v243, v237
v_cvt_pk_bf16_f32 v165, v242, v243
v_lshlrev_b32 v242, 16, v166
v_and_b32 v243, 0xffff0000, v166
v_mul_f32 v242, v242, v237
v_mul_f32 v243, v243, v237
v_cvt_pk_bf16_f32 v166, v242, v243
v_lshlrev_b32 v242, 16, v167
v_and_b32 v243, 0xffff0000, v167
v_mul_f32 v242, v242, v237
v_mul_f32 v243, v243, v237
v_cvt_pk_bf16_f32 v167, v242, v243
v_log_f32 v243, v226
v_max3_f32 v234, v136, v137, v138
v_max3_f32 v234, v234, v139, v243
v_mov_b32 v243, v234
s_nop 1
v_permlane32_swap_b32 v234, v243
s_nop 1
v_max_f32 v234, v234, v243
v_mov_b32 v243, v234
s_nop 1
v_permlane16_swap_b32 v234, v243
s_nop 1
v_max_f32 v234, v234, v243
v_ceil_f32 v234, v234
v_max_f32 v234, 0, v234
v_sub_f32 v243, 0, v234
v_exp_f32 v238, v243
s_nop 1
v_mul_f32 v226, v226, v238
v_add_f32 v246, v246, v234
v_sub_f32 v200, v200, v234
v_sub_f32 v136, v136, v234
v_sub_f32 v152, v152, v234
v_sub_f32 v201, v201, v234
v_sub_f32 v137, v137, v234
v_sub_f32 v153, v153, v234
v_sub_f32 v202, v202, v234
v_sub_f32 v138, v138, v234
v_sub_f32 v154, v154, v234
v_sub_f32 v203, v203, v234
v_sub_f32 v139, v139, v234
v_sub_f32 v155, v155, v234
v_lshlrev_b32 v242, 16, v68
v_and_b32 v243, 0xffff0000, v68
v_mul_f32 v242, v242, v238
v_mul_f32 v243, v243, v238
v_cvt_pk_bf16_f32 v68, v242, v243
v_lshlrev_b32 v242, 16, v69
v_and_b32 v243, 0xffff0000, v69
v_mul_f32 v242, v242, v238
v_mul_f32 v243, v243, v238
v_cvt_pk_bf16_f32 v69, v242, v243
v_lshlrev_b32 v242, 16, v70
v_and_b32 v243, 0xffff0000, v70
v_mul_f32 v242, v242, v238
v_mul_f32 v243, v243, v238
v_cvt_pk_bf16_f32 v70, v242, v243
v_lshlrev_b32 v242, 16, v71
v_and_b32 v243, 0xffff0000, v71
v_mul_f32 v242, v242, v238
v_mul_f32 v243, v243, v238
v_cvt_pk_bf16_f32 v71, v242, v243
v_lshlrev_b32 v242, 16, v72
v_and_b32 v243, 0xffff0000, v72
v_mul_f32 v242, v242, v238
v_mul_f32 v243, v243, v238
v_cvt_pk_bf16_f32 v72, v242, v243
v_lshlrev_b32 v242, 16, v73
v_and_b32 v243, 0xffff0000, v73
v_mul_f32 v242, v242, v238
v_mul_f32 v243, v243, v238
v_cvt_pk_bf16_f32 v73, v242, v243
v_lshlrev_b32 v242, 16, v74
v_and_b32 v243, 0xffff0000, v74
v_mul_f32 v242, v242, v238
v_mul_f32 v243, v243, v238
v_cvt_pk_bf16_f32 v74, v242, v243
v_lshlrev_b32 v242, 16, v75
v_and_b32 v243, 0xffff0000, v75
v_mul_f32 v242, v242, v238
v_mul_f32 v243, v243, v238
v_cvt_pk_bf16_f32 v75, v242, v243
v_lshlrev_b32 v242, 16, v184
v_and_b32 v243, 0xffff0000, v184
v_mul_f32 v242, v242, v238
v_mul_f32 v243, v243, v238
v_cvt_pk_bf16_f32 v184, v242, v243
v_lshlrev_b32 v242, 16, v185
v_and_b32 v243, 0xffff0000, v185
v_mul_f32 v242, v242, v238
v_mul_f32 v243, v243, v238
v_cvt_pk_bf16_f32 v185, v242, v243
v_lshlrev_b32 v242, 16, v186
v_and_b32 v243, 0xffff0000, v186
v_mul_f32 v242, v242, v238
v_mul_f32 v243, v243, v238
v_cvt_pk_bf16_f32 v186, v242, v243
v_lshlrev_b32 v242, 16, v187
v_and_b32 v243, 0xffff0000, v187
v_mul_f32 v242, v242, v238
v_mul_f32 v243, v243, v238
v_cvt_pk_bf16_f32 v187, v242, v243
v_lshlrev_b32 v242, 16, v168
v_and_b32 v243, 0xffff0000, v168
v_mul_f32 v242, v242, v238
v_mul_f32 v243, v243, v238
v_cvt_pk_bf16_f32 v168, v242, v243
v_lshlrev_b32 v242, 16, v169
v_and_b32 v243, 0xffff0000, v169
v_mul_f32 v242, v242, v238
v_mul_f32 v243, v243, v238
v_cvt_pk_bf16_f32 v169, v242, v243
v_lshlrev_b32 v242, 16, v170
v_and_b32 v243, 0xffff0000, v170
v_mul_f32 v242, v242, v238
v_mul_f32 v243, v243, v238
v_cvt_pk_bf16_f32 v170, v242, v243
v_lshlrev_b32 v242, 16, v171
v_and_b32 v243, 0xffff0000, v171
v_mul_f32 v242, v242, v238
v_mul_f32 v243, v243, v238
v_cvt_pk_bf16_f32 v171, v242, v243
v_log_f32 v243, v227
v_max3_f32 v235, v140, v141, v142
v_max3_f32 v235, v235, v143, v243
v_mov_b32 v243, v235
s_nop 1
v_permlane32_swap_b32 v235, v243
s_nop 1
v_max_f32 v235, v235, v243
v_mov_b32 v243, v235
s_nop 1
v_permlane16_swap_b32 v235, v243
s_nop 1
v_max_f32 v235, v235, v243
v_ceil_f32 v235, v235
v_max_f32 v235, 0, v235
v_sub_f32 v243, 0, v235
v_exp_f32 v239, v243
s_nop 1
v_mul_f32 v227, v227, v239
v_add_f32 v247, v247, v235
v_sub_f32 v204, v204, v235
v_sub_f32 v140, v140, v235
v_sub_f32 v156, v156, v235
v_sub_f32 v205, v205, v235
v_sub_f32 v141, v141, v235
v_sub_f32 v157, v157, v235
v_sub_f32 v206, v206, v235
v_sub_f32 v142, v142, v235
v_sub_f32 v158, v158, v235
v_sub_f32 v207, v207, v235
v_sub_f32 v143, v143, v235
v_sub_f32 v159, v159, v235
v_lshlrev_b32 v242, 16, v100
v_and_b32 v243, 0xffff0000, v100
v_mul_f32 v242, v242, v239
v_mul_f32 v243, v243, v239
v_cvt_pk_bf16_f32 v100, v242, v243
v_lshlrev_b32 v242, 16, v101
v_and_b32 v243, 0xffff0000, v101
v_mul_f32 v242, v242, v239
v_mul_f32 v243, v243, v239
v_cvt_pk_bf16_f32 v101, v242, v243
v_lshlrev_b32 v242, 16, v102
v_and_b32 v243, 0xffff0000, v102
v_mul_f32 v242, v242, v239
v_mul_f32 v243, v243, v239
v_cvt_pk_bf16_f32 v102, v242, v243
v_lshlrev_b32 v242, 16, v103
v_and_b32 v243, 0xffff0000, v103
v_mul_f32 v242, v242, v239
v_mul_f32 v243, v243, v239
v_cvt_pk_bf16_f32 v103, v242, v243
v_lshlrev_b32 v242, 16, v104
v_and_b32 v243, 0xffff0000, v104
v_mul_f32 v242, v242, v239
v_mul_f32 v243, v243, v239
v_cvt_pk_bf16_f32 v104, v242, v243
v_lshlrev_b32 v242, 16, v105
v_and_b32 v243, 0xffff0000, v105
v_mul_f32 v242, v242, v239
v_mul_f32 v243, v243, v239
v_cvt_pk_bf16_f32 v105, v242, v243
v_lshlrev_b32 v242, 16, v106
v_and_b32 v243, 0xffff0000, v106
v_mul_f32 v242, v242, v239
v_mul_f32 v243, v243, v239
v_cvt_pk_bf16_f32 v106, v242, v243
v_lshlrev_b32 v242, 16, v107
v_and_b32 v243, 0xffff0000, v107
v_mul_f32 v242, v242, v239
v_mul_f32 v243, v243, v239
v_cvt_pk_bf16_f32 v107, v242, v243
v_lshlrev_b32 v242, 16, v188
v_and_b32 v243, 0xffff0000, v188
v_mul_f32 v242, v242, v239
v_mul_f32 v243, v243, v239
v_cvt_pk_bf16_f32 v188, v242, v243
v_lshlrev_b32 v242, 16, v189
v_and_b32 v243, 0xffff0000, v189
v_mul_f32 v242, v242, v239
v_mul_f32 v243, v243, v239
v_cvt_pk_bf16_f32 v189, v242, v243
v_lshlrev_b32 v242, 16, v190
v_and_b32 v243, 0xffff0000, v190
v_mul_f32 v242, v242, v239
v_mul_f32 v243, v243, v239
v_cvt_pk_bf16_f32 v190, v242, v243
v_lshlrev_b32 v242, 16, v191
v_and_b32 v243, 0xffff0000, v191
v_mul_f32 v242, v242, v239
v_mul_f32 v243, v243, v239
v_cvt_pk_bf16_f32 v191, v242, v243
v_lshlrev_b32 v242, 16, v172
v_and_b32 v243, 0xffff0000, v172
v_mul_f32 v242, v242, v239
v_mul_f32 v243, v243, v239
v_cvt_pk_bf16_f32 v172, v242, v243
v_lshlrev_b32 v242, 16, v173
v_and_b32 v243, 0xffff0000, v173
v_mul_f32 v242, v242, v239
v_mul_f32 v243, v243, v239
v_cvt_pk_bf16_f32 v173, v242, v243
v_lshlrev_b32 v242, 16, v174
v_and_b32 v243, 0xffff0000, v174
v_mul_f32 v242, v242, v239
v_mul_f32 v243, v243, v239
v_cvt_pk_bf16_f32 v174, v242, v243
v_lshlrev_b32 v242, 16, v175
v_and_b32 v243, 0xffff0000, v175
v_mul_f32 v242, v242, v239
v_mul_f32 v243, v243, v239
v_cvt_pk_bf16_f32 v175, v242, v243
v_exp_f32 v232, v128
v_exp_f32 v233, v129
v_exp_f32 v234, v130
v_exp_f32 v235, v131
s_nop 1
v_add_f32 v228, v224, v232
v_add_f32 v228, v228, v233
v_add_f32 v228, v228, v234
v_add_f32 v228, v228, v235
v_cvt_pk_bf16_f32 v0, v232, v233
v_cvt_pk_bf16_f32 v1, v234, v235
v_exp_f32 v232, v132
v_exp_f32 v233, v133
v_exp_f32 v234, v134
v_exp_f32 v235, v135
s_nop 1
v_add_f32 v229, v225, v232
v_add_f32 v229, v229, v233
v_add_f32 v229, v229, v234
v_add_f32 v229, v229, v235
v_cvt_pk_bf16_f32 v32, v232, v233
v_cvt_pk_bf16_f32 v33, v234, v235
v_exp_f32 v232, v136
v_exp_f32 v233, v137
v_exp_f32 v234, v138
v_exp_f32 v235, v139
s_nop 1
v_add_f32 v230, v226, v232
v_add_f32 v230, v230, v233
v_add_f32 v230, v230, v234
v_add_f32 v230, v230, v235
v_cvt_pk_bf16_f32 v64, v232, v233
v_cvt_pk_bf16_f32 v65, v234, v235
v_exp_f32 v232, v140
v_exp_f32 v233, v141
v_exp_f32 v234, v142
v_exp_f32 v235, v143
s_nop 1
v_add_f32 v231, v227, v232
v_add_f32 v231, v231, v233
v_add_f32 v231, v231, v234
v_add_f32 v231, v231, v235
v_cvt_pk_bf16_f32 v96, v232, v233
v_cvt_pk_bf16_f32 v97, v234, v235
s_branch L2_rare_common
L2_rare_site19:
s_mov_b32 s36, 19
s_branch L2_rare_t1_7_1
L2_rare_t1_7_1:
s_nop 15
s_nop 15
s_waitcnt lgkmcnt(0)
v_log_f32 v243, v228
v_max3_f32 v232, v144, v145, v146
v_max3_f32 v232, v232, v147, v243
v_mov_b32 v243, v232
s_nop 1
v_permlane32_swap_b32 v232, v243
s_nop 1
v_max_f32 v232, v232, v243
v_mov_b32 v243, v232
s_nop 1
v_permlane16_swap_b32 v232, v243
s_nop 1
v_max_f32 v232, v232, v243
v_ceil_f32 v232, v232
v_max_f32 v232, 0, v232
v_sub_f32 v243, 0, v232
v_exp_f32 v236, v243
s_nop 1
v_mul_f32 v228, v228, v236
v_add_f32 v244, v244, v232
v_sub_f32 v192, v192, v232
v_sub_f32 v128, v128, v232
v_sub_f32 v144, v144, v232
v_sub_f32 v193, v193, v232
v_sub_f32 v129, v129, v232
v_sub_f32 v145, v145, v232
v_sub_f32 v194, v194, v232
v_sub_f32 v130, v130, v232
v_sub_f32 v146, v146, v232
v_sub_f32 v195, v195, v232
v_sub_f32 v131, v131, v232
v_sub_f32 v147, v147, v232
v_lshlrev_b32 v242, 16, v4
v_and_b32 v243, 0xffff0000, v4
v_mul_f32 v242, v242, v236
v_mul_f32 v243, v243, v236
v_cvt_pk_bf16_f32 v4, v242, v243
v_lshlrev_b32 v242, 16, v5
v_and_b32 v243, 0xffff0000, v5
v_mul_f32 v242, v242, v236
v_mul_f32 v243, v243, v236
v_cvt_pk_bf16_f32 v5, v242, v243
v_lshlrev_b32 v242, 16, v6
v_and_b32 v243, 0xffff0000, v6
v_mul_f32 v242, v242, v236
v_mul_f32 v243, v243, v236
v_cvt_pk_bf16_f32 v6, v242, v243
v_lshlrev_b32 v242, 16, v7
v_and_b32 v243, 0xffff0000, v7
v_mul_f32 v242, v242, v236
v_mul_f32 v243, v243, v236
v_cvt_pk_bf16_f32 v7, v242, v243
v_lshlrev_b32 v242, 16, v8
v_and_b32 v243, 0xffff0000, v8
v_mul_f32 v242, v242, v236
v_mul_f32 v243, v243, v236
v_cvt_pk_bf16_f32 v8, v242, v243
v_lshlrev_b32 v242, 16, v9
v_and_b32 v243, 0xffff0000, v9
v_mul_f32 v242, v242, v236
v_mul_f32 v243, v243, v236
v_cvt_pk_bf16_f32 v9, v242, v243
v_lshlrev_b32 v242, 16, v10
v_and_b32 v243, 0xffff0000, v10
v_mul_f32 v242, v242, v236
v_mul_f32 v243, v243, v236
v_cvt_pk_bf16_f32 v10, v242, v243
v_lshlrev_b32 v242, 16, v11
v_and_b32 v243, 0xffff0000, v11
v_mul_f32 v242, v242, v236
v_mul_f32 v243, v243, v236
v_cvt_pk_bf16_f32 v11, v242, v243
v_lshlrev_b32 v242, 16, v176
v_and_b32 v243, 0xffff0000, v176
v_mul_f32 v242, v242, v236
v_mul_f32 v243, v243, v236
v_cvt_pk_bf16_f32 v176, v242, v243
v_lshlrev_b32 v242, 16, v177
v_and_b32 v243, 0xffff0000, v177
v_mul_f32 v242, v242, v236
v_mul_f32 v243, v243, v236
v_cvt_pk_bf16_f32 v177, v242, v243
v_lshlrev_b32 v242, 16, v178
v_and_b32 v243, 0xffff0000, v178
v_mul_f32 v242, v242, v236
v_mul_f32 v243, v243, v236
v_cvt_pk_bf16_f32 v178, v242, v243
v_lshlrev_b32 v242, 16, v179
v_and_b32 v243, 0xffff0000, v179
v_mul_f32 v242, v242, v236
v_mul_f32 v243, v243, v236
v_cvt_pk_bf16_f32 v179, v242, v243
v_lshlrev_b32 v242, 16, v160
v_and_b32 v243, 0xffff0000, v160
v_mul_f32 v242, v242, v236
v_mul_f32 v243, v243, v236
v_cvt_pk_bf16_f32 v160, v242, v243
v_lshlrev_b32 v242, 16, v161
v_and_b32 v243, 0xffff0000, v161
v_mul_f32 v242, v242, v236
v_mul_f32 v243, v243, v236
v_cvt_pk_bf16_f32 v161, v242, v243
v_lshlrev_b32 v242, 16, v162
v_and_b32 v243, 0xffff0000, v162
v_mul_f32 v242, v242, v236
v_mul_f32 v243, v243, v236
v_cvt_pk_bf16_f32 v162, v242, v243
v_lshlrev_b32 v242, 16, v163
v_and_b32 v243, 0xffff0000, v163
v_mul_f32 v242, v242, v236
v_mul_f32 v243, v243, v236
v_cvt_pk_bf16_f32 v163, v242, v243
v_lshlrev_b32 v242, 16, v0
v_and_b32 v243, 0xffff0000, v0
v_mul_f32 v242, v242, v236
v_mul_f32 v243, v243, v236
v_cvt_pk_bf16_f32 v0, v242, v243
v_lshlrev_b32 v242, 16, v1
v_and_b32 v243, 0xffff0000, v1
v_mul_f32 v242, v242, v236
v_mul_f32 v243, v243, v236
v_cvt_pk_bf16_f32 v1, v242, v243
v_log_f32 v243, v229
v_max3_f32 v233, v148, v149, v150
v_max3_f32 v233, v233, v151, v243
v_mov_b32 v243, v233
s_nop 1
v_permlane32_swap_b32 v233, v243
s_nop 1
v_max_f32 v233, v233, v243
v_mov_b32 v243, v233
s_nop 1
v_permlane16_swap_b32 v233, v243
s_nop 1
v_max_f32 v233, v233, v243
v_ceil_f32 v233, v233
v_max_f32 v233, 0, v233
v_sub_f32 v243, 0, v233
v_exp_f32 v237, v243
s_nop 1
v_mul_f32 v229, v229, v237
v_add_f32 v245, v245, v233
v_sub_f32 v196, v196, v233
v_sub_f32 v132, v132, v233
v_sub_f32 v148, v148, v233
v_sub_f32 v197, v197, v233
v_sub_f32 v133, v133, v233
v_sub_f32 v149, v149, v233
v_sub_f32 v198, v198, v233
v_sub_f32 v134, v134, v233
v_sub_f32 v150, v150, v233
v_sub_f32 v199, v199, v233
v_sub_f32 v135, v135, v233
v_sub_f32 v151, v151, v233
v_lshlrev_b32 v242, 16, v36
v_and_b32 v243, 0xffff0000, v36
v_mul_f32 v242, v242, v237
v_mul_f32 v243, v243, v237
v_cvt_pk_bf16_f32 v36, v242, v243
v_lshlrev_b32 v242, 16, v37
v_and_b32 v243, 0xffff0000, v37
v_mul_f32 v242, v242, v237
v_mul_f32 v243, v243, v237
v_cvt_pk_bf16_f32 v37, v242, v243
v_lshlrev_b32 v242, 16, v38
v_and_b32 v243, 0xffff0000, v38
v_mul_f32 v242, v242, v237
v_mul_f32 v243, v243, v237
v_cvt_pk_bf16_f32 v38, v242, v243
v_lshlrev_b32 v242, 16, v39
v_and_b32 v243, 0xffff0000, v39
v_mul_f32 v242, v242, v237
v_mul_f32 v243, v243, v237
v_cvt_pk_bf16_f32 v39, v242, v243
v_lshlrev_b32 v242, 16, v40
v_and_b32 v243, 0xffff0000, v40
v_mul_f32 v242, v242, v237
v_mul_f32 v243, v243, v237
v_cvt_pk_bf16_f32 v40, v242, v243
v_lshlrev_b32 v242, 16, v41
v_and_b32 v243, 0xffff0000, v41
v_mul_f32 v242, v242, v237
v_mul_f32 v243, v243, v237
v_cvt_pk_bf16_f32 v41, v242, v243
v_lshlrev_b32 v242, 16, v42
v_and_b32 v243, 0xffff0000, v42
v_mul_f32 v242, v242, v237
v_mul_f32 v243, v243, v237
v_cvt_pk_bf16_f32 v42, v242, v243
v_lshlrev_b32 v242, 16, v43
v_and_b32 v243, 0xffff0000, v43
v_mul_f32 v242, v242, v237
v_mul_f32 v243, v243, v237
v_cvt_pk_bf16_f32 v43, v242, v243
v_lshlrev_b32 v242, 16, v180
v_and_b32 v243, 0xffff0000, v180
v_mul_f32 v242, v242, v237
v_mul_f32 v243, v243, v237
v_cvt_pk_bf16_f32 v180, v242, v243
v_lshlrev_b32 v242, 16, v181
v_and_b32 v243, 0xffff0000, v181
v_mul_f32 v242, v242, v237
v_mul_f32 v243, v243, v237
v_cvt_pk_bf16_f32 v181, v242, v243
v_lshlrev_b32 v242, 16, v182
v_and_b32 v243, 0xffff0000, v182
v_mul_f32 v242, v242, v237
v_mul_f32 v243, v243, v237
v_cvt_pk_bf16_f32 v182, v242, v243
v_lshlrev_b32 v242, 16, v183
v_and_b32 v243, 0xffff0000, v183
v_mul_f32 v242, v242, v237
v_mul_f32 v243, v243, v237
v_cvt_pk_bf16_f32 v183, v242, v243
v_lshlrev_b32 v242, 16, v164
v_and_b32 v243, 0xffff0000, v164
v_mul_f32 v242, v242, v237
v_mul_f32 v243, v243, v237
v_cvt_pk_bf16_f32 v164, v242, v243
v_lshlrev_b32 v242, 16, v165
v_and_b32 v243, 0xffff0000, v165
v_mul_f32 v242, v242, v237
v_mul_f32 v243, v243, v237
v_cvt_pk_bf16_f32 v165, v242, v243
v_lshlrev_b32 v242, 16, v166
v_and_b32 v243, 0xffff0000, v166
v_mul_f32 v242, v242, v237
v_mul_f32 v243, v243, v237
v_cvt_pk_bf16_f32 v166, v242, v243
v_lshlrev_b32 v242, 16, v167
v_and_b32 v243, 0xffff0000, v167
v_mul_f32 v242, v242, v237
v_mul_f32 v243, v243, v237
v_cvt_pk_bf16_f32 v167, v242, v243
v_lshlrev_b32 v242, 16, v32
v_and_b32 v243, 0xffff0000, v32
v_mul_f32 v242, v242, v237
v_mul_f32 v243, v243, v237
v_cvt_pk_bf16_f32 v32, v242, v243
v_lshlrev_b32 v242, 16, v33
v_and_b32 v243, 0xffff0000, v33
v_mul_f32 v242, v242, v237
v_mul_f32 v243, v243, v237
v_cvt_pk_bf16_f32 v33, v242, v243
v_log_f32 v243, v230
v_max3_f32 v234, v152, v153, v154
v_max3_f32 v234, v234, v155, v243
v_mov_b32 v243, v234
s_nop 1
v_permlane32_swap_b32 v234, v243
s_nop 1
v_max_f32 v234, v234, v243
v_mov_b32 v243, v234
s_nop 1
v_permlane16_swap_b32 v234, v243
s_nop 1
v_max_f32 v234, v234, v243
v_ceil_f32 v234, v234
v_max_f32 v234, 0, v234
v_sub_f32 v243, 0, v234
v_exp_f32 v238, v243
s_nop 1
v_mul_f32 v230, v230, v238
v_add_f32 v246, v246, v234
v_sub_f32 v200, v200, v234
v_sub_f32 v136, v136, v234
v_sub_f32 v152, v152, v234
v_sub_f32 v201, v201, v234
v_sub_f32 v137, v137, v234
v_sub_f32 v153, v153, v234
v_sub_f32 v202, v202, v234
v_sub_f32 v138, v138, v234
v_sub_f32 v154, v154, v234
v_sub_f32 v203, v203, v234
v_sub_f32 v139, v139, v234
v_sub_f32 v155, v155, v234
v_lshlrev_b32 v242, 16, v68
v_and_b32 v243, 0xffff0000, v68
v_mul_f32 v242, v242, v238
v_mul_f32 v243, v243, v238
v_cvt_pk_bf16_f32 v68, v242, v243
v_lshlrev_b32 v242, 16, v69
v_and_b32 v243, 0xffff0000, v69
v_mul_f32 v242, v242, v238
v_mul_f32 v243, v243, v238
v_cvt_pk_bf16_f32 v69, v242, v243
v_lshlrev_b32 v242, 16, v70
v_and_b32 v243, 0xffff0000, v70
v_mul_f32 v242, v242, v238
v_mul_f32 v243, v243, v238
v_cvt_pk_bf16_f32 v70, v242, v243
v_lshlrev_b32 v242, 16, v71
v_and_b32 v243, 0xffff0000, v71
v_mul_f32 v242, v242, v238
v_mul_f32 v243, v243, v238
v_cvt_pk_bf16_f32 v71, v242, v243
v_lshlrev_b32 v242, 16, v72
v_and_b32 v243, 0xffff0000, v72
v_mul_f32 v242, v242, v238
v_mul_f32 v243, v243, v238
v_cvt_pk_bf16_f32 v72, v242, v243
v_lshlrev_b32 v242, 16, v73
v_and_b32 v243, 0xffff0000, v73
v_mul_f32 v242, v242, v238
v_mul_f32 v243, v243, v238
v_cvt_pk_bf16_f32 v73, v242, v243
v_lshlrev_b32 v242, 16, v74
v_and_b32 v243, 0xffff0000, v74
v_mul_f32 v242, v242, v238
v_mul_f32 v243, v243, v238
v_cvt_pk_bf16_f32 v74, v242, v243
v_lshlrev_b32 v242, 16, v75
v_and_b32 v243, 0xffff0000, v75
v_mul_f32 v242, v242, v238
v_mul_f32 v243, v243, v238
v_cvt_pk_bf16_f32 v75, v242, v243
v_lshlrev_b32 v242, 16, v184
v_and_b32 v243, 0xffff0000, v184
v_mul_f32 v242, v242, v238
v_mul_f32 v243, v243, v238
v_cvt_pk_bf16_f32 v184, v242, v243
v_lshlrev_b32 v242, 16, v185
v_and_b32 v243, 0xffff0000, v185
v_mul_f32 v242, v242, v238
v_mul_f32 v243, v243, v238
v_cvt_pk_bf16_f32 v185, v242, v243
v_lshlrev_b32 v242, 16, v186
v_and_b32 v243, 0xffff0000, v186
v_mul_f32 v242, v242, v238
v_mul_f32 v243, v243, v238
v_cvt_pk_bf16_f32 v186, v242, v243
v_lshlrev_b32 v242, 16, v187
v_and_b32 v243, 0xffff0000, v187
v_mul_f32 v242, v242, v238
v_mul_f32 v243, v243, v238
v_cvt_pk_bf16_f32 v187, v242, v243
v_lshlrev_b32 v242, 16, v168
v_and_b32 v243, 0xffff0000, v168
v_mul_f32 v242, v242, v238
v_mul_f32 v243, v243, v238
v_cvt_pk_bf16_f32 v168, v242, v243
v_lshlrev_b32 v242, 16, v169
v_and_b32 v243, 0xffff0000, v169
v_mul_f32 v242, v242, v238
v_mul_f32 v243, v243, v238
v_cvt_pk_bf16_f32 v169, v242, v243
v_lshlrev_b32 v242, 16, v170
v_and_b32 v243, 0xffff0000, v170
v_mul_f32 v242, v242, v238
v_mul_f32 v243, v243, v238
v_cvt_pk_bf16_f32 v170, v242, v243
v_lshlrev_b32 v242, 16, v171
v_and_b32 v243, 0xffff0000, v171
v_mul_f32 v242, v242, v238
v_mul_f32 v243, v243, v238
v_cvt_pk_bf16_f32 v171, v242, v243
v_lshlrev_b32 v242, 16, v64
v_and_b32 v243, 0xffff0000, v64
v_mul_f32 v242, v242, v238
v_mul_f32 v243, v243, v238
v_cvt_pk_bf16_f32 v64, v242, v243
v_lshlrev_b32 v242, 16, v65
v_and_b32 v243, 0xffff0000, v65
v_mul_f32 v242, v242, v238
v_mul_f32 v243, v243, v238
v_cvt_pk_bf16_f32 v65, v242, v243
v_log_f32 v243, v231
v_max3_f32 v235, v156, v157, v158
v_max3_f32 v235, v235, v159, v243
v_mov_b32 v243, v235
s_nop 1
v_permlane32_swap_b32 v235, v243
s_nop 1
v_max_f32 v235, v235, v243
v_mov_b32 v243, v235
s_nop 1
v_permlane16_swap_b32 v235, v243
s_nop 1
v_max_f32 v235, v235, v243
v_ceil_f32 v235, v235
v_max_f32 v235, 0, v235
v_sub_f32 v243, 0, v235
v_exp_f32 v239, v243
s_nop 1
v_mul_f32 v231, v231, v239
v_add_f32 v247, v247, v235
v_sub_f32 v204, v204, v235
v_sub_f32 v140, v140, v235
v_sub_f32 v156, v156, v235
v_sub_f32 v205, v205, v235
v_sub_f32 v141, v141, v235
v_sub_f32 v157, v157, v235
v_sub_f32 v206, v206, v235
v_sub_f32 v142, v142, v235
v_sub_f32 v158, v158, v235
v_sub_f32 v207, v207, v235
v_sub_f32 v143, v143, v235
v_sub_f32 v159, v159, v235
v_lshlrev_b32 v242, 16, v100
v_and_b32 v243, 0xffff0000, v100
v_mul_f32 v242, v242, v239
v_mul_f32 v243, v243, v239
v_cvt_pk_bf16_f32 v100, v242, v243
v_lshlrev_b32 v242, 16, v101
v_and_b32 v243, 0xffff0000, v101
v_mul_f32 v242, v242, v239
v_mul_f32 v243, v243, v239
v_cvt_pk_bf16_f32 v101, v242, v243
v_lshlrev_b32 v242, 16, v102
v_and_b32 v243, 0xffff0000, v102
v_mul_f32 v242, v242, v239
v_mul_f32 v243, v243, v239
v_cvt_pk_bf16_f32 v102, v242, v243
v_lshlrev_b32 v242, 16, v103
v_and_b32 v243, 0xffff0000, v103
v_mul_f32 v242, v242, v239
v_mul_f32 v243, v243, v239
v_cvt_pk_bf16_f32 v103, v242, v243
v_lshlrev_b32 v242, 16, v104
v_and_b32 v243, 0xffff0000, v104
v_mul_f32 v242, v242, v239
v_mul_f32 v243, v243, v239
v_cvt_pk_bf16_f32 v104, v242, v243
v_lshlrev_b32 v242, 16, v105
v_and_b32 v243, 0xffff0000, v105
v_mul_f32 v242, v242, v239
v_mul_f32 v243, v243, v239
v_cvt_pk_bf16_f32 v105, v242, v243
v_lshlrev_b32 v242, 16, v106
v_and_b32 v243, 0xffff0000, v106
v_mul_f32 v242, v242, v239
v_mul_f32 v243, v243, v239
v_cvt_pk_bf16_f32 v106, v242, v243
v_lshlrev_b32 v242, 16, v107
v_and_b32 v243, 0xffff0000, v107
v_mul_f32 v242, v242, v239
v_mul_f32 v243, v243, v239
v_cvt_pk_bf16_f32 v107, v242, v243
v_lshlrev_b32 v242, 16, v188
v_and_b32 v243, 0xffff0000, v188
v_mul_f32 v242, v242, v239
v_mul_f32 v243, v243, v239
v_cvt_pk_bf16_f32 v188, v242, v243
v_lshlrev_b32 v242, 16, v189
v_and_b32 v243, 0xffff0000, v189
v_mul_f32 v242, v242, v239
v_mul_f32 v243, v243, v239
v_cvt_pk_bf16_f32 v189, v242, v243
v_lshlrev_b32 v242, 16, v190
v_and_b32 v243, 0xffff0000, v190
v_mul_f32 v242, v242, v239
v_mul_f32 v243, v243, v239
v_cvt_pk_bf16_f32 v190, v242, v243
v_lshlrev_b32 v242, 16, v191
v_and_b32 v243, 0xffff0000, v191
v_mul_f32 v242, v242, v239
v_mul_f32 v243, v243, v239
v_cvt_pk_bf16_f32 v191, v242, v243
v_lshlrev_b32 v242, 16, v172
v_and_b32 v243, 0xffff0000, v172
v_mul_f32 v242, v242, v239
v_mul_f32 v243, v243, v239
v_cvt_pk_bf16_f32 v172, v242, v243
v_lshlrev_b32 v242, 16, v173
v_and_b32 v243, 0xffff0000, v173
v_mul_f32 v242, v242, v239
v_mul_f32 v243, v243, v239
v_cvt_pk_bf16_f32 v173, v242, v243
v_lshlrev_b32 v242, 16, v174
v_and_b32 v243, 0xffff0000, v174
v_mul_f32 v242, v242, v239
v_mul_f32 v243, v243, v239
v_cvt_pk_bf16_f32 v174, v242, v243
v_lshlrev_b32 v242, 16, v175
v_and_b32 v243, 0xffff0000, v175
v_mul_f32 v242, v242, v239
v_mul_f32 v243, v243, v239
v_cvt_pk_bf16_f32 v175, v242, v243
v_lshlrev_b32 v242, 16, v96
v_and_b32 v243, 0xffff0000, v96
v_mul_f32 v242, v242, v239
v_mul_f32 v243, v243, v239
v_cvt_pk_bf16_f32 v96, v242, v243
v_lshlrev_b32 v242, 16, v97
v_and_b32 v243, 0xffff0000, v97
v_mul_f32 v242, v242, v239
v_mul_f32 v243, v243, v239
v_cvt_pk_bf16_f32 v97, v242, v243
v_exp_f32 v232, v144
v_exp_f32 v233, v145
v_exp_f32 v234, v146
v_exp_f32 v235, v147
s_nop 1
v_add_f32 v224, v228, v232
v_add_f32 v224, v224, v233
v_add_f32 v224, v224, v234
v_add_f32 v224, v224, v235
v_cvt_pk_bf16_f32 v2, v232, v233
v_cvt_pk_bf16_f32 v3, v234, v235
v_exp_f32 v232, v148
v_exp_f32 v233, v149
v_exp_f32 v234, v150
v_exp_f32 v235, v151
s_nop 1
v_add_f32 v225, v229, v232
v_add_f32 v225, v225, v233
v_add_f32 v225, v225, v234
v_add_f32 v225, v225, v235
v_cvt_pk_bf16_f32 v34, v232, v233
v_cvt_pk_bf16_f32 v35, v234, v235
v_exp_f32 v232, v152
v_exp_f32 v233, v153
v_exp_f32 v234, v154
v_exp_f32 v235, v155
s_nop 1
v_add_f32 v226, v230, v232
v_add_f32 v226, v226, v233
v_add_f32 v226, v226, v234
v_add_f32 v226, v226, v235
v_cvt_pk_bf16_f32 v66, v232, v233
v_cvt_pk_bf16_f32 v67, v234, v235
v_exp_f32 v232, v156
v_exp_f32 v233, v157
v_exp_f32 v234, v158
v_exp_f32 v235, v159
s_nop 1
v_add_f32 v227, v231, v232
v_add_f32 v227, v227, v233
v_add_f32 v227, v227, v234
v_add_f32 v227, v227, v235
v_cvt_pk_bf16_f32 v98, v232, v233
v_cvt_pk_bf16_f32 v99, v234, v235
s_branch L2_rare_common
LF_hl_1:
s_mov_b32 s100, 0x10000
s_mov_b32 s3, 0x7c28000
LF_hl2_1:
v_lshlrev_b32 v241, 3, v248
buffer_load_dword v241, v241, s[16:19], s3 offen sc1
s_sub_u32 s100, s100, 1
s_waitcnt vmcnt(0)
s_cbranch_scc1 LF_hlret_1
v_cmp_eq_u32_e64 s[38:39], 0, v241
s_and_b64 s[38:39], s[38:39], s[96:97]
s_cbranch_scc1 LF_hl2_1
s_branch LF_hlret_1
L2_rare_common:
v_lshrrev_b32 v232, 4, v248
v_and_b32 v232, 0x30, v232
ds_bpermute_b32 v242, v232, v236 offset:0
ds_bpermute_b32 v243, v232, v236 offset:4
ds_bpermute_b32 v254, v232, v236 offset:8
ds_bpermute_b32 v255, v232, v236 offset:12
s_waitcnt lgkmcnt(0)
v_accvgpr_read_b32 v232, a0
v_accvgpr_read_b32 v233, a1
v_accvgpr_read_b32 v234, a2
v_accvgpr_read_b32 v235, a3
v_mul_f32 v232, v232, v242
v_mul_f32 v233, v233, v243
v_mul_f32 v234, v234, v254
v_mul_f32 v235, v235, v255
v_accvgpr_write_b32 a0, v232
v_accvgpr_write_b32 a1, v233
v_accvgpr_write_b32 a2, v234
v_accvgpr_write_b32 a3, v235
v_accvgpr_read_b32 v232, a16
v_accvgpr_read_b32 v233, a17
v_accvgpr_read_b32 v234, a18
v_accvgpr_read_b32 v235, a19
v_mul_f32 v232, v232, v242
v_mul_f32 v233, v233, v243
v_mul_f32 v234, v234, v254
v_mul_f32 v235, v235, v255
v_accvgpr_write_b32 a16, v232
v_accvgpr_write_b32 a17, v233
v_accvgpr_write_b32 a18, v234
v_accvgpr_write_b32 a19, v235
v_accvgpr_read_b32 v232, a32
v_accvgpr_read_b32 v233, a33
v_accvgpr_read_b32 v234, a34
v_accvgpr_read_b32 v235, a35
v_mul_f32 v232, v232, v242
v_mul_f32 v233, v233, v243
v_mul_f32 v234, v234, v254
v_mul_f32 v235, v235, v255
v_accvgpr_write_b32 a32, v232
v_accvgpr_write_b32 a33, v233
v_accvgpr_write_b32 a34, v234
v_accvgpr_write_b32 a35, v235
v_accvgpr_read_b32 v232, a48
v_accvgpr_read_b32 v233, a49
v_accvgpr_read_b32 v234, a50
v_accvgpr_read_b32 v235, a51
v_mul_f32 v232, v232, v242
v_mul_f32 v233, v233, v243
v_mul_f32 v234, v234, v254
v_mul_f32 v235, v235, v255
v_accvgpr_write_b32 a48, v232
v_accvgpr_write_b32 a49, v233
v_accvgpr_write_b32 a50, v234
v_accvgpr_write_b32 a51, v235
v_accvgpr_read_b32 v232, a64
v_accvgpr_read_b32 v233, a65
v_accvgpr_read_b32 v234, a66
v_accvgpr_read_b32 v235, a67
v_mul_f32 v232, v232, v242
v_mul_f32 v233, v233, v243
v_mul_f32 v234, v234, v254
v_mul_f32 v235, v235, v255
v_accvgpr_write_b32 a64, v232
v_accvgpr_write_b32 a65, v233
v_accvgpr_write_b32 a66, v234
v_accvgpr_write_b32 a67, v235
v_accvgpr_read_b32 v232, a80
v_accvgpr_read_b32 v233, a81
v_accvgpr_read_b32 v234, a82
v_accvgpr_read_b32 v235, a83
v_mul_f32 v232, v232, v242
v_mul_f32 v233, v233, v243
v_mul_f32 v234, v234, v254
v_mul_f32 v235, v235, v255
v_accvgpr_write_b32 a80, v232
v_accvgpr_write_b32 a81, v233
v_accvgpr_write_b32 a82, v234
v_accvgpr_write_b32 a83, v235
v_accvgpr_read_b32 v232, a96
v_accvgpr_read_b32 v233, a97
v_accvgpr_read_b32 v234, a98
v_accvgpr_read_b32 v235, a99
v_mul_f32 v232, v232, v242
v_mul_f32 v233, v233, v243
v_mul_f32 v234, v234, v254
v_mul_f32 v235, v235, v255
v_accvgpr_write_b32 a96, v232
v_accvgpr_write_b32 a97, v233
v_accvgpr_write_b32 a98, v234
v_accvgpr_write_b32 a99, v235
v_accvgpr_read_b32 v232, a112
v_accvgpr_read_b32 v233, a113
v_accvgpr_read_b32 v234, a114
v_accvgpr_read_b32 v235, a115
v_mul_f32 v232, v232, v242
v_mul_f32 v233, v233, v243
v_mul_f32 v234, v234, v254
v_mul_f32 v235, v235, v255
v_accvgpr_write_b32 a112, v232
v_accvgpr_write_b32 a113, v233
v_accvgpr_write_b32 a114, v234
v_accvgpr_write_b32 a115, v235
v_accvgpr_read_b32 v232, a128
v_accvgpr_read_b32 v233, a129
v_accvgpr_read_b32 v234, a130
v_accvgpr_read_b32 v235, a131
v_mul_f32 v232, v232, v242
v_mul_f32 v233, v233, v243
v_mul_f32 v234, v234, v254
v_mul_f32 v235, v235, v255
v_accvgpr_write_b32 a128, v232
v_accvgpr_write_b32 a129, v233
v_accvgpr_write_b32 a130, v234
v_accvgpr_write_b32 a131, v235
v_accvgpr_read_b32 v232, a144
v_accvgpr_read_b32 v233, a145
v_accvgpr_read_b32 v234, a146
v_accvgpr_read_b32 v235, a147
v_mul_f32 v232, v232, v242
v_mul_f32 v233, v233, v243
v_mul_f32 v234, v234, v254
v_mul_f32 v235, v235, v255
v_accvgpr_write_b32 a144, v232
v_accvgpr_write_b32 a145, v233
v_accvgpr_write_b32 a146, v234
v_accvgpr_write_b32 a147, v235
v_accvgpr_read_b32 v232, a160
v_accvgpr_read_b32 v233, a161
v_accvgpr_read_b32 v234, a162
v_accvgpr_read_b32 v235, a163
v_mul_f32 v232, v232, v242
v_mul_f32 v233, v233, v243
v_mul_f32 v234, v234, v254
v_mul_f32 v235, v235, v255
v_accvgpr_write_b32 a160, v232
v_accvgpr_write_b32 a161, v233
v_accvgpr_write_b32 a162, v234
v_accvgpr_write_b32 a163, v235
v_accvgpr_read_b32 v232, a176
v_accvgpr_read_b32 v233, a177
v_accvgpr_read_b32 v234, a178
v_accvgpr_read_b32 v235, a179
v_mul_f32 v232, v232, v242
v_mul_f32 v233, v233, v243
v_mul_f32 v234, v234, v254
v_mul_f32 v235, v235, v255
v_accvgpr_write_b32 a176, v232
v_accvgpr_write_b32 a177, v233
v_accvgpr_write_b32 a178, v234
v_accvgpr_write_b32 a179, v235
v_accvgpr_read_b32 v232, a192
v_accvgpr_read_b32 v233, a193
v_accvgpr_read_b32 v234, a194
v_accvgpr_read_b32 v235, a195
v_mul_f32 v232, v232, v242
v_mul_f32 v233, v233, v243
v_mul_f32 v234, v234, v254
v_mul_f32 v235, v235, v255
v_accvgpr_write_b32 a192, v232
v_accvgpr_write_b32 a193, v233
v_accvgpr_write_b32 a194, v234
v_accvgpr_write_b32 a195, v235
v_accvgpr_read_b32 v232, a208
v_accvgpr_read_b32 v233, a209
v_accvgpr_read_b32 v234, a210
v_accvgpr_read_b32 v235, a211
v_mul_f32 v232, v232, v242
v_mul_f32 v233, v233, v243
v_mul_f32 v234, v234, v254
v_mul_f32 v235, v235, v255
v_accvgpr_write_b32 a208, v232
v_accvgpr_write_b32 a209, v233
v_accvgpr_write_b32 a210, v234
v_accvgpr_write_b32 a211, v235
v_accvgpr_read_b32 v232, a224
v_accvgpr_read_b32 v233, a225
v_accvgpr_read_b32 v234, a226
v_accvgpr_read_b32 v235, a227
v_mul_f32 v232, v232, v242
v_mul_f32 v233, v233, v243
v_mul_f32 v234, v234, v254
v_mul_f32 v235, v235, v255
v_accvgpr_write_b32 a224, v232
v_accvgpr_write_b32 a225, v233
v_accvgpr_write_b32 a226, v234
v_accvgpr_write_b32 a227, v235
v_accvgpr_read_b32 v232, a240
v_accvgpr_read_b32 v233, a241
v_accvgpr_read_b32 v234, a242
v_accvgpr_read_b32 v235, a243
v_mul_f32 v232, v232, v242
v_mul_f32 v233, v233, v243
v_mul_f32 v234, v234, v254
v_mul_f32 v235, v235, v255
v_accvgpr_write_b32 a240, v232
v_accvgpr_write_b32 a241, v233
v_accvgpr_write_b32 a242, v234
v_accvgpr_write_b32 a243, v235
v_lshrrev_b32 v232, 4, v248
v_and_b32 v232, 0x30, v232
ds_bpermute_b32 v242, v232, v237 offset:0
ds_bpermute_b32 v243, v232, v237 offset:4
ds_bpermute_b32 v254, v232, v237 offset:8
ds_bpermute_b32 v255, v232, v237 offset:12
s_waitcnt lgkmcnt(0)
v_accvgpr_read_b32 v232, a4
v_accvgpr_read_b32 v233, a5
v_accvgpr_read_b32 v234, a6
v_accvgpr_read_b32 v235, a7
v_mul_f32 v232, v232, v242
v_mul_f32 v233, v233, v243
v_mul_f32 v234, v234, v254
v_mul_f32 v235, v235, v255
v_accvgpr_write_b32 a4, v232
v_accvgpr_write_b32 a5, v233
v_accvgpr_write_b32 a6, v234
v_accvgpr_write_b32 a7, v235
v_accvgpr_read_b32 v232, a20
v_accvgpr_read_b32 v233, a21
v_accvgpr_read_b32 v234, a22
v_accvgpr_read_b32 v235, a23
v_mul_f32 v232, v232, v242
v_mul_f32 v233, v233, v243
v_mul_f32 v234, v234, v254
v_mul_f32 v235, v235, v255
v_accvgpr_write_b32 a20, v232
v_accvgpr_write_b32 a21, v233
v_accvgpr_write_b32 a22, v234
v_accvgpr_write_b32 a23, v235
v_accvgpr_read_b32 v232, a36
v_accvgpr_read_b32 v233, a37
v_accvgpr_read_b32 v234, a38
v_accvgpr_read_b32 v235, a39
v_mul_f32 v232, v232, v242
v_mul_f32 v233, v233, v243
v_mul_f32 v234, v234, v254
v_mul_f32 v235, v235, v255
v_accvgpr_write_b32 a36, v232
v_accvgpr_write_b32 a37, v233
v_accvgpr_write_b32 a38, v234
v_accvgpr_write_b32 a39, v235
v_accvgpr_read_b32 v232, a52
v_accvgpr_read_b32 v233, a53
v_accvgpr_read_b32 v234, a54
v_accvgpr_read_b32 v235, a55
v_mul_f32 v232, v232, v242
v_mul_f32 v233, v233, v243
v_mul_f32 v234, v234, v254
v_mul_f32 v235, v235, v255
v_accvgpr_write_b32 a52, v232
v_accvgpr_write_b32 a53, v233
v_accvgpr_write_b32 a54, v234
v_accvgpr_write_b32 a55, v235
v_accvgpr_read_b32 v232, a68
v_accvgpr_read_b32 v233, a69
v_accvgpr_read_b32 v234, a70
v_accvgpr_read_b32 v235, a71
v_mul_f32 v232, v232, v242
v_mul_f32 v233, v233, v243
v_mul_f32 v234, v234, v254
v_mul_f32 v235, v235, v255
v_accvgpr_write_b32 a68, v232
v_accvgpr_write_b32 a69, v233
v_accvgpr_write_b32 a70, v234
v_accvgpr_write_b32 a71, v235
v_accvgpr_read_b32 v232, a84
v_accvgpr_read_b32 v233, a85
v_accvgpr_read_b32 v234, a86
v_accvgpr_read_b32 v235, a87
v_mul_f32 v232, v232, v242
v_mul_f32 v233, v233, v243
v_mul_f32 v234, v234, v254
v_mul_f32 v235, v235, v255
v_accvgpr_write_b32 a84, v232
v_accvgpr_write_b32 a85, v233
v_accvgpr_write_b32 a86, v234
v_accvgpr_write_b32 a87, v235
v_accvgpr_read_b32 v232, a100
v_accvgpr_read_b32 v233, a101
v_accvgpr_read_b32 v234, a102
v_accvgpr_read_b32 v235, a103
v_mul_f32 v232, v232, v242
v_mul_f32 v233, v233, v243
v_mul_f32 v234, v234, v254
v_mul_f32 v235, v235, v255
v_accvgpr_write_b32 a100, v232
v_accvgpr_write_b32 a101, v233
v_accvgpr_write_b32 a102, v234
v_accvgpr_write_b32 a103, v235
v_accvgpr_read_b32 v232, a116
v_accvgpr_read_b32 v233, a117
v_accvgpr_read_b32 v234, a118
v_accvgpr_read_b32 v235, a119
v_mul_f32 v232, v232, v242
v_mul_f32 v233, v233, v243
v_mul_f32 v234, v234, v254
v_mul_f32 v235, v235, v255
v_accvgpr_write_b32 a116, v232
v_accvgpr_write_b32 a117, v233
v_accvgpr_write_b32 a118, v234
v_accvgpr_write_b32 a119, v235
v_accvgpr_read_b32 v232, a132
v_accvgpr_read_b32 v233, a133
v_accvgpr_read_b32 v234, a134
v_accvgpr_read_b32 v235, a135
v_mul_f32 v232, v232, v242
v_mul_f32 v233, v233, v243
v_mul_f32 v234, v234, v254
v_mul_f32 v235, v235, v255
v_accvgpr_write_b32 a132, v232
v_accvgpr_write_b32 a133, v233
v_accvgpr_write_b32 a134, v234
v_accvgpr_write_b32 a135, v235
v_accvgpr_read_b32 v232, a148
v_accvgpr_read_b32 v233, a149
v_accvgpr_read_b32 v234, a150
v_accvgpr_read_b32 v235, a151
v_mul_f32 v232, v232, v242
v_mul_f32 v233, v233, v243
v_mul_f32 v234, v234, v254
v_mul_f32 v235, v235, v255
v_accvgpr_write_b32 a148, v232
v_accvgpr_write_b32 a149, v233
v_accvgpr_write_b32 a150, v234
v_accvgpr_write_b32 a151, v235
v_accvgpr_read_b32 v232, a164
v_accvgpr_read_b32 v233, a165
v_accvgpr_read_b32 v234, a166
v_accvgpr_read_b32 v235, a167
v_mul_f32 v232, v232, v242
v_mul_f32 v233, v233, v243
v_mul_f32 v234, v234, v254
v_mul_f32 v235, v235, v255
v_accvgpr_write_b32 a164, v232
v_accvgpr_write_b32 a165, v233
v_accvgpr_write_b32 a166, v234
v_accvgpr_write_b32 a167, v235
v_accvgpr_read_b32 v232, a180
v_accvgpr_read_b32 v233, a181
v_accvgpr_read_b32 v234, a182
v_accvgpr_read_b32 v235, a183
v_mul_f32 v232, v232, v242
v_mul_f32 v233, v233, v243
v_mul_f32 v234, v234, v254
v_mul_f32 v235, v235, v255
v_accvgpr_write_b32 a180, v232
v_accvgpr_write_b32 a181, v233
v_accvgpr_write_b32 a182, v234
v_accvgpr_write_b32 a183, v235
v_accvgpr_read_b32 v232, a196
v_accvgpr_read_b32 v233, a197
v_accvgpr_read_b32 v234, a198
v_accvgpr_read_b32 v235, a199
v_mul_f32 v232, v232, v242
v_mul_f32 v233, v233, v243
v_mul_f32 v234, v234, v254
v_mul_f32 v235, v235, v255
v_accvgpr_write_b32 a196, v232
v_accvgpr_write_b32 a197, v233
v_accvgpr_write_b32 a198, v234
v_accvgpr_write_b32 a199, v235
v_accvgpr_read_b32 v232, a212
v_accvgpr_read_b32 v233, a213
v_accvgpr_read_b32 v234, a214
v_accvgpr_read_b32 v235, a215
v_mul_f32 v232, v232, v242
v_mul_f32 v233, v233, v243
v_mul_f32 v234, v234, v254
v_mul_f32 v235, v235, v255
v_accvgpr_write_b32 a212, v232
v_accvgpr_write_b32 a213, v233
v_accvgpr_write_b32 a214, v234
v_accvgpr_write_b32 a215, v235
v_accvgpr_read_b32 v232, a228
v_accvgpr_read_b32 v233, a229
v_accvgpr_read_b32 v234, a230
v_accvgpr_read_b32 v235, a231
v_mul_f32 v232, v232, v242
v_mul_f32 v233, v233, v243
v_mul_f32 v234, v234, v254
v_mul_f32 v235, v235, v255
v_accvgpr_write_b32 a228, v232
v_accvgpr_write_b32 a229, v233
v_accvgpr_write_b32 a230, v234
v_accvgpr_write_b32 a231, v235
v_accvgpr_read_b32 v232, a244
v_accvgpr_read_b32 v233, a245
v_accvgpr_read_b32 v234, a246
v_accvgpr_read_b32 v235, a247
v_mul_f32 v232, v232, v242
v_mul_f32 v233, v233, v243
v_mul_f32 v234, v234, v254
v_mul_f32 v235, v235, v255
v_accvgpr_write_b32 a244, v232
v_accvgpr_write_b32 a245, v233
v_accvgpr_write_b32 a246, v234
v_accvgpr_write_b32 a247, v235
v_lshrrev_b32 v232, 4, v248
v_and_b32 v232, 0x30, v232
ds_bpermute_b32 v242, v232, v238 offset:0
ds_bpermute_b32 v243, v232, v238 offset:4
ds_bpermute_b32 v254, v232, v238 offset:8
ds_bpermute_b32 v255, v232, v238 offset:12
s_waitcnt lgkmcnt(0)
v_accvgpr_read_b32 v232, a8
v_accvgpr_read_b32 v233, a9
v_accvgpr_read_b32 v234, a10
v_accvgpr_read_b32 v235, a11
v_mul_f32 v232, v232, v242
v_mul_f32 v233, v233, v243
v_mul_f32 v234, v234, v254
v_mul_f32 v235, v235, v255
v_accvgpr_write_b32 a8, v232
v_accvgpr_write_b32 a9, v233
v_accvgpr_write_b32 a10, v234
v_accvgpr_write_b32 a11, v235
v_accvgpr_read_b32 v232, a24
v_accvgpr_read_b32 v233, a25
v_accvgpr_read_b32 v234, a26
v_accvgpr_read_b32 v235, a27
v_mul_f32 v232, v232, v242
v_mul_f32 v233, v233, v243
v_mul_f32 v234, v234, v254
v_mul_f32 v235, v235, v255
v_accvgpr_write_b32 a24, v232
v_accvgpr_write_b32 a25, v233
v_accvgpr_write_b32 a26, v234
v_accvgpr_write_b32 a27, v235
v_accvgpr_read_b32 v232, a40
v_accvgpr_read_b32 v233, a41
v_accvgpr_read_b32 v234, a42
v_accvgpr_read_b32 v235, a43
v_mul_f32 v232, v232, v242
v_mul_f32 v233, v233, v243
v_mul_f32 v234, v234, v254
v_mul_f32 v235, v235, v255
v_accvgpr_write_b32 a40, v232
v_accvgpr_write_b32 a41, v233
v_accvgpr_write_b32 a42, v234
v_accvgpr_write_b32 a43, v235
v_accvgpr_read_b32 v232, a56
v_accvgpr_read_b32 v233, a57
v_accvgpr_read_b32 v234, a58
v_accvgpr_read_b32 v235, a59
v_mul_f32 v232, v232, v242
v_mul_f32 v233, v233, v243
v_mul_f32 v234, v234, v254
v_mul_f32 v235, v235, v255
v_accvgpr_write_b32 a56, v232
v_accvgpr_write_b32 a57, v233
v_accvgpr_write_b32 a58, v234
v_accvgpr_write_b32 a59, v235
v_accvgpr_read_b32 v232, a72
v_accvgpr_read_b32 v233, a73
v_accvgpr_read_b32 v234, a74
v_accvgpr_read_b32 v235, a75
v_mul_f32 v232, v232, v242
v_mul_f32 v233, v233, v243
v_mul_f32 v234, v234, v254
v_mul_f32 v235, v235, v255
v_accvgpr_write_b32 a72, v232
v_accvgpr_write_b32 a73, v233
v_accvgpr_write_b32 a74, v234
v_accvgpr_write_b32 a75, v235
v_accvgpr_read_b32 v232, a88
v_accvgpr_read_b32 v233, a89
v_accvgpr_read_b32 v234, a90
v_accvgpr_read_b32 v235, a91
v_mul_f32 v232, v232, v242
v_mul_f32 v233, v233, v243
v_mul_f32 v234, v234, v254
v_mul_f32 v235, v235, v255
v_accvgpr_write_b32 a88, v232
v_accvgpr_write_b32 a89, v233
v_accvgpr_write_b32 a90, v234
v_accvgpr_write_b32 a91, v235
v_accvgpr_read_b32 v232, a104
v_accvgpr_read_b32 v233, a105
v_accvgpr_read_b32 v234, a106
v_accvgpr_read_b32 v235, a107
v_mul_f32 v232, v232, v242
v_mul_f32 v233, v233, v243
v_mul_f32 v234, v234, v254
v_mul_f32 v235, v235, v255
v_accvgpr_write_b32 a104, v232
v_accvgpr_write_b32 a105, v233
v_accvgpr_write_b32 a106, v234
v_accvgpr_write_b32 a107, v235
v_accvgpr_read_b32 v232, a120
v_accvgpr_read_b32 v233, a121
v_accvgpr_read_b32 v234, a122
v_accvgpr_read_b32 v235, a123
v_mul_f32 v232, v232, v242
v_mul_f32 v233, v233, v243
v_mul_f32 v234, v234, v254
v_mul_f32 v235, v235, v255
v_accvgpr_write_b32 a120, v232
v_accvgpr_write_b32 a121, v233
v_accvgpr_write_b32 a122, v234
v_accvgpr_write_b32 a123, v235
v_accvgpr_read_b32 v232, a136
v_accvgpr_read_b32 v233, a137
v_accvgpr_read_b32 v234, a138
v_accvgpr_read_b32 v235, a139
v_mul_f32 v232, v232, v242
v_mul_f32 v233, v233, v243
v_mul_f32 v234, v234, v254
v_mul_f32 v235, v235, v255
v_accvgpr_write_b32 a136, v232
v_accvgpr_write_b32 a137, v233
v_accvgpr_write_b32 a138, v234
v_accvgpr_write_b32 a139, v235
v_accvgpr_read_b32 v232, a152
v_accvgpr_read_b32 v233, a153
v_accvgpr_read_b32 v234, a154
v_accvgpr_read_b32 v235, a155
v_mul_f32 v232, v232, v242
v_mul_f32 v233, v233, v243
v_mul_f32 v234, v234, v254
v_mul_f32 v235, v235, v255
v_accvgpr_write_b32 a152, v232
v_accvgpr_write_b32 a153, v233
v_accvgpr_write_b32 a154, v234
v_accvgpr_write_b32 a155, v235
v_accvgpr_read_b32 v232, a168
v_accvgpr_read_b32 v233, a169
v_accvgpr_read_b32 v234, a170
v_accvgpr_read_b32 v235, a171
v_mul_f32 v232, v232, v242
v_mul_f32 v233, v233, v243
v_mul_f32 v234, v234, v254
v_mul_f32 v235, v235, v255
v_accvgpr_write_b32 a168, v232
v_accvgpr_write_b32 a169, v233
v_accvgpr_write_b32 a170, v234
v_accvgpr_write_b32 a171, v235
v_accvgpr_read_b32 v232, a184
v_accvgpr_read_b32 v233, a185
v_accvgpr_read_b32 v234, a186
v_accvgpr_read_b32 v235, a187
v_mul_f32 v232, v232, v242
v_mul_f32 v233, v233, v243
v_mul_f32 v234, v234, v254
v_mul_f32 v235, v235, v255
v_accvgpr_write_b32 a184, v232
v_accvgpr_write_b32 a185, v233
v_accvgpr_write_b32 a186, v234
v_accvgpr_write_b32 a187, v235
v_accvgpr_read_b32 v232, a200
v_accvgpr_read_b32 v233, a201
v_accvgpr_read_b32 v234, a202
v_accvgpr_read_b32 v235, a203
v_mul_f32 v232, v232, v242
v_mul_f32 v233, v233, v243
v_mul_f32 v234, v234, v254
v_mul_f32 v235, v235, v255
v_accvgpr_write_b32 a200, v232
v_accvgpr_write_b32 a201, v233
v_accvgpr_write_b32 a202, v234
v_accvgpr_write_b32 a203, v235
v_accvgpr_read_b32 v232, a216
v_accvgpr_read_b32 v233, a217
v_accvgpr_read_b32 v234, a218
v_accvgpr_read_b32 v235, a219
v_mul_f32 v232, v232, v242
v_mul_f32 v233, v233, v243
v_mul_f32 v234, v234, v254
v_mul_f32 v235, v235, v255
v_accvgpr_write_b32 a216, v232
v_accvgpr_write_b32 a217, v233
v_accvgpr_write_b32 a218, v234
v_accvgpr_write_b32 a219, v235
v_accvgpr_read_b32 v232, a232
v_accvgpr_read_b32 v233, a233
v_accvgpr_read_b32 v234, a234
v_accvgpr_read_b32 v235, a235
v_mul_f32 v232, v232, v242
v_mul_f32 v233, v233, v243
v_mul_f32 v234, v234, v254
v_mul_f32 v235, v235, v255
v_accvgpr_write_b32 a232, v232
v_accvgpr_write_b32 a233, v233
v_accvgpr_write_b32 a234, v234
v_accvgpr_write_b32 a235, v235
v_accvgpr_read_b32 v232, a248
v_accvgpr_read_b32 v233, a249
v_accvgpr_read_b32 v234, a250
v_accvgpr_read_b32 v235, a251
v_mul_f32 v232, v232, v242
v_mul_f32 v233, v233, v243
v_mul_f32 v234, v234, v254
v_mul_f32 v235, v235, v255
v_accvgpr_write_b32 a248, v232
v_accvgpr_write_b32 a249, v233
v_accvgpr_write_b32 a250, v234
v_accvgpr_write_b32 a251, v235
v_lshrrev_b32 v232, 4, v248
v_and_b32 v232, 0x30, v232
ds_bpermute_b32 v242, v232, v239 offset:0
ds_bpermute_b32 v243, v232, v239 offset:4
ds_bpermute_b32 v254, v232, v239 offset:8
ds_bpermute_b32 v255, v232, v239 offset:12
s_waitcnt lgkmcnt(0)
v_accvgpr_read_b32 v232, a12
v_accvgpr_read_b32 v233, a13
v_accvgpr_read_b32 v234, a14
v_accvgpr_read_b32 v235, a15
v_mul_f32 v232, v232, v242
v_mul_f32 v233, v233, v243
v_mul_f32 v234, v234, v254
v_mul_f32 v235, v235, v255
v_accvgpr_write_b32 a12, v232
v_accvgpr_write_b32 a13, v233
v_accvgpr_write_b32 a14, v234
v_accvgpr_write_b32 a15, v235
v_accvgpr_read_b32 v232, a28
v_accvgpr_read_b32 v233, a29
v_accvgpr_read_b32 v234, a30
v_accvgpr_read_b32 v235, a31
v_mul_f32 v232, v232, v242
v_mul_f32 v233, v233, v243
v_mul_f32 v234, v234, v254
v_mul_f32 v235, v235, v255
v_accvgpr_write_b32 a28, v232
v_accvgpr_write_b32 a29, v233
v_accvgpr_write_b32 a30, v234
v_accvgpr_write_b32 a31, v235
v_accvgpr_read_b32 v232, a44
v_accvgpr_read_b32 v233, a45
v_accvgpr_read_b32 v234, a46
v_accvgpr_read_b32 v235, a47
v_mul_f32 v232, v232, v242
v_mul_f32 v233, v233, v243
v_mul_f32 v234, v234, v254
v_mul_f32 v235, v235, v255
v_accvgpr_write_b32 a44, v232
v_accvgpr_write_b32 a45, v233
v_accvgpr_write_b32 a46, v234
v_accvgpr_write_b32 a47, v235
v_accvgpr_read_b32 v232, a60
v_accvgpr_read_b32 v233, a61
v_accvgpr_read_b32 v234, a62
v_accvgpr_read_b32 v235, a63
v_mul_f32 v232, v232, v242
v_mul_f32 v233, v233, v243
v_mul_f32 v234, v234, v254
v_mul_f32 v235, v235, v255
v_accvgpr_write_b32 a60, v232
v_accvgpr_write_b32 a61, v233
v_accvgpr_write_b32 a62, v234
v_accvgpr_write_b32 a63, v235
v_accvgpr_read_b32 v232, a76
v_accvgpr_read_b32 v233, a77
v_accvgpr_read_b32 v234, a78
v_accvgpr_read_b32 v235, a79
v_mul_f32 v232, v232, v242
v_mul_f32 v233, v233, v243
v_mul_f32 v234, v234, v254
v_mul_f32 v235, v235, v255
v_accvgpr_write_b32 a76, v232
v_accvgpr_write_b32 a77, v233
v_accvgpr_write_b32 a78, v234
v_accvgpr_write_b32 a79, v235
v_accvgpr_read_b32 v232, a92
v_accvgpr_read_b32 v233, a93
v_accvgpr_read_b32 v234, a94
v_accvgpr_read_b32 v235, a95
v_mul_f32 v232, v232, v242
v_mul_f32 v233, v233, v243
v_mul_f32 v234, v234, v254
v_mul_f32 v235, v235, v255
v_accvgpr_write_b32 a92, v232
v_accvgpr_write_b32 a93, v233
v_accvgpr_write_b32 a94, v234
v_accvgpr_write_b32 a95, v235
v_accvgpr_read_b32 v232, a108
v_accvgpr_read_b32 v233, a109
v_accvgpr_read_b32 v234, a110
v_accvgpr_read_b32 v235, a111
v_mul_f32 v232, v232, v242
v_mul_f32 v233, v233, v243
v_mul_f32 v234, v234, v254
v_mul_f32 v235, v235, v255
v_accvgpr_write_b32 a108, v232
v_accvgpr_write_b32 a109, v233
v_accvgpr_write_b32 a110, v234
v_accvgpr_write_b32 a111, v235
v_accvgpr_read_b32 v232, a124
v_accvgpr_read_b32 v233, a125
v_accvgpr_read_b32 v234, a126
v_accvgpr_read_b32 v235, a127
v_mul_f32 v232, v232, v242
v_mul_f32 v233, v233, v243
v_mul_f32 v234, v234, v254
v_mul_f32 v235, v235, v255
v_accvgpr_write_b32 a124, v232
v_accvgpr_write_b32 a125, v233
v_accvgpr_write_b32 a126, v234
v_accvgpr_write_b32 a127, v235
v_accvgpr_read_b32 v232, a140
v_accvgpr_read_b32 v233, a141
v_accvgpr_read_b32 v234, a142
v_accvgpr_read_b32 v235, a143
v_mul_f32 v232, v232, v242
v_mul_f32 v233, v233, v243
v_mul_f32 v234, v234, v254
v_mul_f32 v235, v235, v255
v_accvgpr_write_b32 a140, v232
v_accvgpr_write_b32 a141, v233
v_accvgpr_write_b32 a142, v234
v_accvgpr_write_b32 a143, v235
v_accvgpr_read_b32 v232, a156
v_accvgpr_read_b32 v233, a157
v_accvgpr_read_b32 v234, a158
v_accvgpr_read_b32 v235, a159
v_mul_f32 v232, v232, v242
v_mul_f32 v233, v233, v243
v_mul_f32 v234, v234, v254
v_mul_f32 v235, v235, v255
v_accvgpr_write_b32 a156, v232
v_accvgpr_write_b32 a157, v233
v_accvgpr_write_b32 a158, v234
v_accvgpr_write_b32 a159, v235
v_accvgpr_read_b32 v232, a172
v_accvgpr_read_b32 v233, a173
v_accvgpr_read_b32 v234, a174
v_accvgpr_read_b32 v235, a175
v_mul_f32 v232, v232, v242
v_mul_f32 v233, v233, v243
v_mul_f32 v234, v234, v254
v_mul_f32 v235, v235, v255
v_accvgpr_write_b32 a172, v232
v_accvgpr_write_b32 a173, v233
v_accvgpr_write_b32 a174, v234
v_accvgpr_write_b32 a175, v235
v_accvgpr_read_b32 v232, a188
v_accvgpr_read_b32 v233, a189
v_accvgpr_read_b32 v234, a190
v_accvgpr_read_b32 v235, a191
v_mul_f32 v232, v232, v242
v_mul_f32 v233, v233, v243
v_mul_f32 v234, v234, v254
v_mul_f32 v235, v235, v255
v_accvgpr_write_b32 a188, v232
v_accvgpr_write_b32 a189, v233
v_accvgpr_write_b32 a190, v234
v_accvgpr_write_b32 a191, v235
v_accvgpr_read_b32 v232, a204
v_accvgpr_read_b32 v233, a205
v_accvgpr_read_b32 v234, a206
v_accvgpr_read_b32 v235, a207
v_mul_f32 v232, v232, v242
v_mul_f32 v233, v233, v243
v_mul_f32 v234, v234, v254
v_mul_f32 v235, v235, v255
v_accvgpr_write_b32 a204, v232
v_accvgpr_write_b32 a205, v233
v_accvgpr_write_b32 a206, v234
v_accvgpr_write_b32 a207, v235
v_accvgpr_read_b32 v232, a220
v_accvgpr_read_b32 v233, a221
v_accvgpr_read_b32 v234, a222
v_accvgpr_read_b32 v235, a223
v_mul_f32 v232, v232, v242
v_mul_f32 v233, v233, v243
v_mul_f32 v234, v234, v254
v_mul_f32 v235, v235, v255
v_accvgpr_write_b32 a220, v232
v_accvgpr_write_b32 a221, v233
v_accvgpr_write_b32 a222, v234
v_accvgpr_write_b32 a223, v235
v_accvgpr_read_b32 v232, a236
v_accvgpr_read_b32 v233, a237
v_accvgpr_read_b32 v234, a238
v_accvgpr_read_b32 v235, a239
v_mul_f32 v232, v232, v242
v_mul_f32 v233, v233, v243
v_mul_f32 v234, v234, v254
v_mul_f32 v235, v235, v255
v_accvgpr_write_b32 a236, v232
v_accvgpr_write_b32 a237, v233
v_accvgpr_write_b32 a238, v234
v_accvgpr_write_b32 a239, v235
v_accvgpr_read_b32 v232, a252
v_accvgpr_read_b32 v233, a253
v_accvgpr_read_b32 v234, a254
v_accvgpr_read_b32 v235, a255
v_mul_f32 v232, v232, v242
v_mul_f32 v233, v233, v243
v_mul_f32 v234, v234, v254
v_mul_f32 v235, v235, v255
v_accvgpr_write_b32 a252, v232
v_accvgpr_write_b32 a253, v233
v_accvgpr_write_b32 a254, v234
v_accvgpr_write_b32 a255, v235
s_nop 3
s_cmp_eq_u32 s36, 0
s_cbranch_scc1 L2_ret0
s_cmp_eq_u32 s36, 1
s_cbranch_scc1 L2_ret1
s_cmp_eq_u32 s36, 2
s_cbranch_scc1 L2_ret2
s_cmp_eq_u32 s36, 3
s_cbranch_scc1 L2_ret3
s_cmp_eq_u32 s36, 4
s_cbranch_scc1 L2_ret4
s_cmp_eq_u32 s36, 5
s_cbranch_scc1 L2_ret5
s_cmp_eq_u32 s36, 6
s_cbranch_scc1 L2_ret6
s_cmp_eq_u32 s36, 7
s_cbranch_scc1 L2_ret7
s_cmp_eq_u32 s36, 8
s_cbranch_scc1 L2_ret8
s_cmp_eq_u32 s36, 9
s_cbranch_scc1 L2_ret9
s_cmp_eq_u32 s36, 10
s_cbranch_scc1 L2_ret10
s_cmp_eq_u32 s36, 11
s_cbranch_scc1 L2_ret11
s_cmp_eq_u32 s36, 12
s_cbranch_scc1 L2_ret12
s_cmp_eq_u32 s36, 13
s_cbranch_scc1 L2_ret13
s_cmp_eq_u32 s36, 14
s_cbranch_scc1 L2_ret14
s_cmp_eq_u32 s36, 15
s_cbranch_scc1 L2_ret15
s_cmp_eq_u32 s36, 16
s_cbranch_scc1 L2_ret16
s_cmp_eq_u32 s36, 17
s_cbranch_scc1 L2_ret17
s_cmp_eq_u32 s36, 18
s_cbranch_scc1 L2_ret18
s_branch L2_ret19
LT_disp:
s_cmp_eq_u32 s34, 0
s_cbranch_scc1 LT_start
s_mov_b32 s41, s34
s_mul_i32 s40, s34, 6
s_add_u32 s40, s40, s37
s_add_u32 s40, s40, 42
s_cmp_lt_u32 s40, 64
s_cbranch_scc1 LE_common
s_branch L2_end
LT_start:
s_waitcnt lgkmcnt(0)
s_add_u32 s12, s4, 0x6800000
s_addc_u32 s13, s5, 0
s_mov_b32 s14, 0x0
s_mov_b32 s15, 0x00020000
s_mov_b32 s14, s49
s_add_u32 s8, s4, 0x0
s_addc_u32 s9, s5, 0
s_mov_b32 s10, 0x4e4000
s_mov_b32 s11, 0x00020000
s_mov_b32 s40, 5111808
s_mov_b32 s44, 5115904
buffer_load_dwordx4 v[0:3], v248, s[8:11], s40 offen offset:0
buffer_load_dwordx4 v[4:7], v248, s[8:11], s40 offen offset:1024
buffer_load_dwordx4 v[8:11], v248, s[8:11], s40 offen offset:2048
buffer_load_dwordx4 v[12:15], v248, s[8:11], s40 offen offset:3072
buffer_load_dwordx4 v[16:19], v248, s[8:11], s44 offen offset:0
buffer_load_dwordx4 v[20:23], v248, s[8:11], s44 offen offset:1024
buffer_load_dwordx4 v[24:27], v248, s[8:11], s44 offen offset:2048
buffer_load_dwordx4 v[28:31], v248, s[8:11], s44 offen offset:3072
s_mov_b32 s53, 0
s_add_u32 m0, s53, 90112
s_add_u32 s54, s39, 0
buffer_load_dwordx4 v241, s[12:15], s54 offen offset:0 lds
buffer_load_dwordx4 v241, s[12:15], s54 offen offset:1024 lds
buffer_load_dwordx4 v241, s[12:15], s54 offen offset:2048 lds
buffer_load_dwordx4 v241, s[12:15], s54 offen offset:3072 lds
s_add_u32 m0, s53, 94208
s_add_u32 s54, s39, 128
buffer_load_dwordx4 v241, s[12:15], s54 offen offset:0 lds
buffer_load_dwordx4 v241, s[12:15], s54 offen offset:1024 lds
buffer_load_dwordx4 v241, s[12:15], s54 offen offset:2048 lds
buffer_load_dwordx4 v241, s[12:15], s54 offen offset:3072 lds
s_add_u32 m0, s53, 98304
s_add_u32 s54, s39, 256
buffer_load_dwordx4 v241, s[12:15], s54 offen offset:0 lds
buffer_load_dwordx4 v241, s[12:15], s54 offen offset:1024 lds
buffer_load_dwordx4 v241, s[12:15], s54 offen offset:2048 lds
buffer_load_dwordx4 v241, s[12:15], s54 offen offset:3072 lds
s_add_u32 m0, s53, 102400
s_add_u32 s54, s39, 384
buffer_load_dwordx4 v241, s[12:15], s54 offen offset:0 lds
buffer_load_dwordx4 v241, s[12:15], s54 offen offset:1024 lds
buffer_load_dwordx4 v241, s[12:15], s54 offen offset:2048 lds
buffer_load_dwordx4 v241, s[12:15], s54 offen offset:3072 lds
s_add_u32 s53, s53, 0x4000
s_and_b32 s53, s53, 0xffff
s_add_u32 m0, s53, 90112
s_add_u32 s54, s28, 0
buffer_load_dwordx4 v241, s[12:15], s54 offen offset:0 lds
buffer_load_dwordx4 v241, s[12:15], s54 offen offset:1024 lds
buffer_load_dwordx4 v241, s[12:15], s54 offen offset:2048 lds
buffer_load_dwordx4 v241, s[12:15], s54 offen offset:3072 lds
s_add_u32 m0, s53, 94208
s_add_u32 s54, s28, 128
buffer_load_dwordx4 v241, s[12:15], s54 offen offset:0 lds
buffer_load_dwordx4 v241, s[12:15], s54 offen offset:1024 lds
buffer_load_dwordx4 v241, s[12:15], s54 offen offset:2048 lds
buffer_load_dwordx4 v241, s[12:15], s54 offen offset:3072 lds
s_add_u32 m0, s53, 98304
s_add_u32 s54, s28, 256
buffer_load_dwordx4 v241, s[12:15], s54 offen offset:0 lds
buffer_load_dwordx4 v241, s[12:15], s54 offen offset:1024 lds
buffer_load_dwordx4 v241, s[12:15], s54 offen offset:2048 lds
buffer_load_dwordx4 v241, s[12:15], s54 offen offset:3072 lds
s_add_u32 m0, s53, 102400
s_add_u32 s54, s28, 384
buffer_load_dwordx4 v241, s[12:15], s54 offen offset:0 lds
buffer_load_dwordx4 v241, s[12:15], s54 offen offset:1024 lds
buffer_load_dwordx4 v241, s[12:15], s54 offen offset:2048 lds
buffer_load_dwordx4 v241, s[12:15], s54 offen offset:3072 lds
s_add_u32 s53, s53, 0x4000
s_and_b32 s53, s53, 0xffff
s_add_u32 s28, s28, 0x4000
s_add_u32 m0, s53, 90112
s_add_u32 s54, s28, 0
buffer_load_dwordx4 v241, s[12:15], s54 offen offset:0 lds
buffer_load_dwordx4 v241, s[12:15], s54 offen offset:1024 lds
buffer_load_dwordx4 v241, s[12:15], s54 offen offset:2048 lds
buffer_load_dwordx4 v241, s[12:15], s54 offen offset:3072 lds
s_add_u32 m0, s53, 94208
s_add_u32 s54, s28, 128
buffer_load_dwordx4 v241, s[12:15], s54 offen offset:0 lds
buffer_load_dwordx4 v241, s[12:15], s54 offen offset:1024 lds
buffer_load_dwordx4 v241, s[12:15], s54 offen offset:2048 lds
buffer_load_dwordx4 v241, s[12:15], s54 offen offset:3072 lds
s_add_u32 m0, s53, 98304
s_add_u32 s54, s28, 256
buffer_load_dwordx4 v241, s[12:15], s54 offen offset:0 lds
buffer_load_dwordx4 v241, s[12:15], s54 offen offset:1024 lds
buffer_load_dwordx4 v241, s[12:15], s54 offen offset:2048 lds
buffer_load_dwordx4 v241, s[12:15], s54 offen offset:3072 lds
s_add_u32 m0, s53, 102400
s_add_u32 s54, s28, 384
buffer_load_dwordx4 v241, s[12:15], s54 offen offset:0 lds
buffer_load_dwordx4 v241, s[12:15], s54 offen offset:1024 lds
buffer_load_dwordx4 v241, s[12:15], s54 offen offset:2048 lds
buffer_load_dwordx4 v241, s[12:15], s54 offen offset:3072 lds
s_add_u32 s53, s53, 0x4000
s_and_b32 s53, s53, 0xffff
s_add_u32 s28, s28, 0x4000
s_mul_i32 s35, s37, 0x600000
s_add_u32 s20, s4, 0x2000000
s_addc_u32 s21, s5, 0
s_add_u32 s20, s20, s35
s_addc_u32 s21, s21, 0
s_mov_b32 s22, 0x4e4000
s_mov_b32 s23, 0x00020000
s_add_u32 s24, s4, 0x6000000
s_addc_u32 s25, s5, 0
s_mov_b32 s26, 0x139000
s_mov_b32 s27, 0x00020000
s_lshl_b32 s48, s37, 3
s_add_u32 s48, s48, 638976
s_mov_b32 s48, 1277952
v_bfe_u32 v240, v248, 4, 3
v_lshlrev_b32 v240, 6, v240
v_bfe_u32 v242, v248, 7, 1
v_lshl_or_b32 v240, v242, 10, v240
v_bfe_u32 v242, v248, 8, 2
v_lshl_or_b32 v240, v242, 4, v240
v_bfe_u32 v242, v248, 6, 1
v_lshlrev_b32 v242, 5, v242
v_xor_b32 v240, v240, v242
v_and_b32 v249, 0x1c0, v248
v_bfe_u32 v242, v248, 9, 1
v_lshl_or_b32 v249, v242, 10, v249
v_bfe_u32 v242, v248, 8, 1
v_lshl_or_b32 v249, v242, 5, v249
v_bfe_u32 v242, v248, 4, 2
v_lshl_or_b32 v249, v242, 3, v249
v_xor_b32 v250, 32, v249
v_bfe_i32 v242, v248, 8, 1
v_and_b32 v192, s33, v242
v_and_b32 v193, s33, v242
v_and_b32 v194, s33, v242
v_and_b32 v195, s33, v242
s_add_u32 s51, s31, 5
s_mov_b32 s52, 90112
v_mov_b32 v172, 0xff800000
v_mov_b32 v173, 0
v_accvgpr_write_b32 a0, 0
v_accvgpr_write_b32 a1, 0
v_accvgpr_write_b32 a2, 0
v_accvgpr_write_b32 a3, 0
v_accvgpr_write_b32 a4, 0
v_accvgpr_write_b32 a5, 0
v_accvgpr_write_b32 a6, 0
v_accvgpr_write_b32 a7, 0
v_accvgpr_write_b32 a8, 0
v_accvgpr_write_b32 a9, 0
v_accvgpr_write_b32 a10, 0
v_accvgpr_write_b32 a11, 0
v_accvgpr_write_b32 a12, 0
v_accvgpr_write_b32 a13, 0
v_accvgpr_write_b32 a14, 0
v_accvgpr_write_b32 a15, 0
v_accvgpr_write_b32 a16, 0
v_accvgpr_write_b32 a17, 0
v_accvgpr_write_b32 a18, 0
v_accvgpr_write_b32 a19, 0
v_accvgpr_write_b32 a20, 0
v_accvgpr_write_b32 a21, 0
v_accvgpr_write_b32 a22, 0
v_accvgpr_write_b32 a23, 0
v_accvgpr_write_b32 a24, 0
v_accvgpr_write_b32 a25, 0
v_accvgpr_write_b32 a26, 0
v_accvgpr_write_b32 a27, 0
v_accvgpr_write_b32 a28, 0
v_accvgpr_write_b32 a29, 0
v_accvgpr_write_b32 a30, 0
v_accvgpr_write_b32 a31, 0
v_accvgpr_write_b32 a32, 0
v_accvgpr_write_b32 a33, 0
v_accvgpr_write_b32 a34, 0
v_accvgpr_write_b32 a35, 0
v_accvgpr_write_b32 a36, 0
v_accvgpr_write_b32 a37, 0
v_accvgpr_write_b32 a38, 0
v_accvgpr_write_b32 a39, 0
v_accvgpr_write_b32 a40, 0
v_accvgpr_write_b32 a41, 0
v_accvgpr_write_b32 a42, 0
v_accvgpr_write_b32 a43, 0
v_accvgpr_write_b32 a44, 0
v_accvgpr_write_b32 a45, 0
v_accvgpr_write_b32 a46, 0
v_accvgpr_write_b32 a47, 0
v_accvgpr_write_b32 a48, 0
v_accvgpr_write_b32 a49, 0
v_accvgpr_write_b32 a50, 0
v_accvgpr_write_b32 a51, 0
v_accvgpr_write_b32 a52, 0
v_accvgpr_write_b32 a53, 0
v_accvgpr_write_b32 a54, 0
v_accvgpr_write_b32 a55, 0
v_accvgpr_write_b32 a56, 0
v_accvgpr_write_b32 a57, 0
v_accvgpr_write_b32 a58, 0
v_accvgpr_write_b32 a59, 0
v_accvgpr_write_b32 a60, 0
v_accvgpr_write_b32 a61, 0
v_accvgpr_write_b32 a62, 0
v_accvgpr_write_b32 a63, 0
LT_loop:
s_add_u32 m0, s53, 90112
s_add_u32 s54, s28, 0
buffer_load_dwordx4 v241, s[12:15], s54 offen offset:0 lds
buffer_load_dwordx4 v241, s[12:15], s54 offen offset:1024 lds
buffer_load_dwordx4 v241, s[12:15], s54 offen offset:2048 lds
buffer_load_dwordx4 v241, s[12:15], s54 offen offset:3072 lds
s_add_u32 m0, s53, 94208
s_add_u32 s54, s28, 128
buffer_load_dwordx4 v241, s[12:15], s54 offen offset:0 lds
buffer_load_dwordx4 v241, s[12:15], s54 offen offset:1024 lds
buffer_load_dwordx4 v241, s[12:15], s54 offen offset:2048 lds
buffer_load_dwordx4 v241, s[12:15], s54 offen offset:3072 lds
s_add_u32 m0, s53, 98304
s_add_u32 s54, s28, 256
buffer_load_dwordx4 v241, s[12:15], s54 offen offset:0 lds
buffer_load_dwordx4 v241, s[12:15], s54 offen offset:1024 lds
buffer_load_dwordx4 v241, s[12:15], s54 offen offset:2048 lds
buffer_load_dwordx4 v241, s[12:15], s54 offen offset:3072 lds
s_add_u32 m0, s53, 102400
s_add_u32 s54, s28, 384
buffer_load_dwordx4 v241, s[12:15], s54 offen offset:0 lds
buffer_load_dwordx4 v241, s[12:15], s54 offen offset:1024 lds
buffer_load_dwordx4 v241, s[12:15], s54 offen offset:2048 lds
buffer_load_dwordx4 v241, s[12:15], s54 offen offset:3072 lds
s_add_u32 s53, s53, 0x4000
s_and_b32 s53, s53, 0xffff
s_add_u32 s28, s28, 0x4000
v_add_u32 v177, s52, v240
v_add_u32 v178, s52, v249
v_add_u32 v179, s52, v250
s_add_u32 s52, s52, 0x4000
s_cmp_eq_u32 s52, 155648
s_cselect_b32 s52, 90112, s52
s_waitcnt vmcnt(48)
ds_read_b128 v[32:35], v177 offset:0
ds_read_b128 v[64:67], v177 offset:2048
ds_read_b128 v[36:39], v177 offset:512
ds_read_b128 v[68:71], v177 offset:2560
ds_read_b128 v[40:43], v177 offset:4096
ds_read_b128 v[72:75], v177 offset:6144
ds_read_b128 v[44:47], v177 offset:4608
ds_read_b128 v[76:79], v177 offset:6656
ds_read_b128 v[48:51], v177 offset:8192
ds_read_b128 v[80:83], v177 offset:10240
ds_read_b128 v[52:55], v177 offset:8704
ds_read_b128 v[84:87], v177 offset:10752
ds_read_b128 v[56:59], v177 offset:12288
ds_read_b128 v[88:91], v177 offset:14336
ds_read_b128 v[60:63], v177 offset:12800
ds_read_b128 v[92:95], v177 offset:14848
s_waitcnt lgkmcnt(14)
v_mfma_f32_16x16x32_bf16 v[160:163], v[32:35], v[0:3], v[192:195]
v_mfma_f32_16x16x32_bf16 v[164:167], v[64:67], v[0:3], v[192:195]
s_waitcnt lgkmcnt(12)
v_mfma_f32_16x16x32_bf16 v[160:163], v[36:39], v[4:7], v[160:163]
v_mfma_f32_16x16x32_bf16 v[164:167], v[68:71], v[4:7], v[164:167]
s_waitcnt lgkmcnt(10)
v_mfma_f32_16x16x32_bf16 v[160:163], v[40:43], v[8:11], v[160:163]
v_mfma_f32_16x16x32_bf16 v[164:167], v[72:75], v[8:11], v[164:167]
s_waitcnt lgkmcnt(8)
v_mfma_f32_16x16x32_bf16 v[160:163], v[44:47], v[12:15], v[160:163]
v_mfma_f32_16x16x32_bf16 v[164:167], v[76:79], v[12:15], v[164:167]
s_waitcnt lgkmcnt(6)
v_mfma_f32_16x16x32_bf16 v[160:163], v[48:51], v[16:19], v[160:163]
v_mfma_f32_16x16x32_bf16 v[164:167], v[80:83], v[16:19], v[164:167]
s_waitcnt lgkmcnt(4)
v_mfma_f32_16x16x32_bf16 v[160:163], v[52:55], v[20:23], v[160:163]
v_mfma_f32_16x16x32_bf16 v[164:167], v[84:87], v[20:23], v[164:167]
s_waitcnt lgkmcnt(2)
v_mfma_f32_16x16x32_bf16 v[160:163], v[56:59], v[24:27], v[160:163]
v_mfma_f32_16x16x32_bf16 v[164:167], v[88:91], v[24:27], v[164:167]
s_waitcnt lgkmcnt(0)
v_mfma_f32_16x16x32_bf16 v[160:163], v[60:63], v[28:31], v[160:163]
v_mfma_f32_16x16x32_bf16 v[164:167], v[92:95], v[28:31], v[164:167]
ds_read_b64_tr_b16 v[96:97], v178 offset:0
ds_read_b64_tr_b16 v[98:99], v178 offset:2048
ds_read_b64_tr_b16 v[100:101], v179 offset:0
ds_read_b64_tr_b16 v[102:103], v179 offset:2048
ds_read_b64_tr_b16 v[104:105], v178 offset:512
ds_read_b64_tr_b16 v[106:107], v178 offset:2560
ds_read_b64_tr_b16 v[108:109], v179 offset:512
ds_read_b64_tr_b16 v[110:111], v179 offset:2560
ds_read_b64_tr_b16 v[112:113], v178 offset:4096
ds_read_b64_tr_b16 v[114:115], v178 offset:6144
ds_read_b64_tr_b16 v[116:117], v179 offset:4096
ds_read_b64_tr_b16 v[118:119], v179 offset:6144
ds_read_b64_tr_b16 v[120:121], v178 offset:4608
ds_read_b64_tr_b16 v[122:123], v178 offset:6656
ds_read_b64_tr_b16 v[124:125], v179 offset:4608
ds_read_b64_tr_b16 v[126:127], v179 offset:6656
ds_read_b64_tr_b16 v[128:129], v178 offset:8192
ds_read_b64_tr_b16 v[130:131], v178 offset:10240
ds_read_b64_tr_b16 v[132:133], v179 offset:8192
ds_read_b64_tr_b16 v[134:135], v179 offset:10240
ds_read_b64_tr_b16 v[136:137], v178 offset:8704
ds_read_b64_tr_b16 v[138:139], v178 offset:10752
ds_read_b64_tr_b16 v[140:141], v179 offset:8704
ds_read_b64_tr_b16 v[142:143], v179 offset:10752
ds_read_b64_tr_b16 v[144:145], v178 offset:12288
ds_read_b64_tr_b16 v[146:147], v178 offset:14336
ds_read_b64_tr_b16 v[148:149], v179 offset:12288
ds_read_b64_tr_b16 v[150:151], v179 offset:14336
ds_read_b64_tr_b16 v[152:153], v178 offset:12800
ds_read_b64_tr_b16 v[154:155], v178 offset:14848
ds_read_b64_tr_b16 v[156:157], v179 offset:12800
ds_read_b64_tr_b16 v[158:159], v179 offset:14848
v_mov_b32 v192, 0
v_mov_b32 v193, 0
v_mov_b32 v194, 0
v_mov_b32 v195, 0
s_nop 7
v_max3_f32 v175, v160, v161, v162
v_max3_f32 v175, v175, v163, v164
v_max3_f32 v175, v175, v165, v166
v_max3_f32 v175, v175, v167, v172
v_mov_b32 v176, v175
s_nop 1
v_permlane32_swap_b32 v175, v176
s_nop 1
v_max_f32 v175, v175, v176
v_mov_b32 v176, v175
s_nop 1
v_permlane16_swap_b32 v175, v176
s_nop 1
v_max_f32 v175, v175, v176
v_ceil_f32 v175, v175
v_sub_f32 v174, v172, v175
v_exp_f32 v174, v174
v_mov_b32 v172, v175
v_sub_f32 v160, v160, v172
v_sub_f32 v161, v161, v172
v_sub_f32 v162, v162, v172
v_sub_f32 v163, v163, v172
v_sub_f32 v164, v164, v172
v_sub_f32 v165, v165, v172
v_sub_f32 v166, v166, v172
v_sub_f32 v167, v167, v172
v_exp_f32 v160, v160
v_exp_f32 v161, v161
v_exp_f32 v162, v162
v_exp_f32 v163, v163
v_exp_f32 v164, v164
v_exp_f32 v165, v165
v_exp_f32 v166, v166
v_exp_f32 v167, v167
v_mul_f32 v173, v173, v174
v_cvt_pk_bf16_f32 v168, v160, v161
v_cvt_pk_bf16_f32 v169, v162, v163
v_cvt_pk_bf16_f32 v170, v164, v165
v_cvt_pk_bf16_f32 v171, v166, v167
v_cmp_neq_f32 vcc, 1.0, v174
v_add_f32 v173, v173, v160
v_add_f32 v173, v173, v161
v_add_f32 v173, v173, v162
v_add_f32 v173, v173, v163
v_add_f32 v173, v173, v164
v_add_f32 v173, v173, v165
v_add_f32 v173, v173, v166
v_add_f32 v173, v173, v167
s_cbranch_vccz LT_nors
v_lshrrev_b32 v176, 4, v248
v_and_b32 v176, 0x30, v176
ds_bpermute_b32 v188, v176, v174 offset:0
ds_bpermute_b32 v189, v176, v174 offset:4
ds_bpermute_b32 v190, v176, v174 offset:8
ds_bpermute_b32 v191, v176, v174 offset:12
s_waitcnt lgkmcnt(0)
v_accvgpr_read_b32 v180, a0
v_accvgpr_read_b32 v181, a1
v_accvgpr_read_b32 v182, a2
v_accvgpr_read_b32 v183, a3
v_accvgpr_read_b32 v184, a4
v_accvgpr_read_b32 v185, a5
v_accvgpr_read_b32 v186, a6
v_accvgpr_read_b32 v187, a7
v_mul_f32 v180, v180, v188
v_mul_f32 v181, v181, v189
v_mul_f32 v182, v182, v190
v_mul_f32 v183, v183, v191
v_mul_f32 v184, v184, v188
v_mul_f32 v185, v185, v189
v_mul_f32 v186, v186, v190
v_mul_f32 v187, v187, v191
v_accvgpr_write_b32 a0, v180
v_accvgpr_write_b32 a1, v181
v_accvgpr_write_b32 a2, v182
v_accvgpr_write_b32 a3, v183
v_accvgpr_write_b32 a4, v184
v_accvgpr_write_b32 a5, v185
v_accvgpr_write_b32 a6, v186
v_accvgpr_write_b32 a7, v187
v_accvgpr_read_b32 v180, a8
v_accvgpr_read_b32 v181, a9
v_accvgpr_read_b32 v182, a10
v_accvgpr_read_b32 v183, a11
v_accvgpr_read_b32 v184, a12
v_accvgpr_read_b32 v185, a13
v_accvgpr_read_b32 v186, a14
v_accvgpr_read_b32 v187, a15
v_mul_f32 v180, v180, v188
v_mul_f32 v181, v181, v189
v_mul_f32 v182, v182, v190
v_mul_f32 v183, v183, v191
v_mul_f32 v184, v184, v188
v_mul_f32 v185, v185, v189
v_mul_f32 v186, v186, v190
v_mul_f32 v187, v187, v191
v_accvgpr_write_b32 a8, v180
v_accvgpr_write_b32 a9, v181
v_accvgpr_write_b32 a10, v182
v_accvgpr_write_b32 a11, v183
v_accvgpr_write_b32 a12, v184
v_accvgpr_write_b32 a13, v185
v_accvgpr_write_b32 a14, v186
v_accvgpr_write_b32 a15, v187
v_accvgpr_read_b32 v180, a16
v_accvgpr_read_b32 v181, a17
v_accvgpr_read_b32 v182, a18
v_accvgpr_read_b32 v183, a19
v_accvgpr_read_b32 v184, a20
v_accvgpr_read_b32 v185, a21
v_accvgpr_read_b32 v186, a22
v_accvgpr_read_b32 v187, a23
v_mul_f32 v180, v180, v188
v_mul_f32 v181, v181, v189
v_mul_f32 v182, v182, v190
v_mul_f32 v183, v183, v191
v_mul_f32 v184, v184, v188
v_mul_f32 v185, v185, v189
v_mul_f32 v186, v186, v190
v_mul_f32 v187, v187, v191
v_accvgpr_write_b32 a16, v180
v_accvgpr_write_b32 a17, v181
v_accvgpr_write_b32 a18, v182
v_accvgpr_write_b32 a19, v183
v_accvgpr_write_b32 a20, v184
v_accvgpr_write_b32 a21, v185
v_accvgpr_write_b32 a22, v186
v_accvgpr_write_b32 a23, v187
v_accvgpr_read_b32 v180, a24
v_accvgpr_read_b32 v181, a25
v_accvgpr_read_b32 v182, a26
v_accvgpr_read_b32 v183, a27
v_accvgpr_read_b32 v184, a28
v_accvgpr_read_b32 v185, a29
v_accvgpr_read_b32 v186, a30
v_accvgpr_read_b32 v187, a31
v_mul_f32 v180, v180, v188
v_mul_f32 v181, v181, v189
v_mul_f32 v182, v182, v190
v_mul_f32 v183, v183, v191
v_mul_f32 v184, v184, v188
v_mul_f32 v185, v185, v189
v_mul_f32 v186, v186, v190
v_mul_f32 v187, v187, v191
v_accvgpr_write_b32 a24, v180
v_accvgpr_write_b32 a25, v181
v_accvgpr_write_b32 a26, v182
v_accvgpr_write_b32 a27, v183
v_accvgpr_write_b32 a28, v184
v_accvgpr_write_b32 a29, v185
v_accvgpr_write_b32 a30, v186
v_accvgpr_write_b32 a31, v187
v_accvgpr_read_b32 v180, a32
v_accvgpr_read_b32 v181, a33
v_accvgpr_read_b32 v182, a34
v_accvgpr_read_b32 v183, a35
v_accvgpr_read_b32 v184, a36
v_accvgpr_read_b32 v185, a37
v_accvgpr_read_b32 v186, a38
v_accvgpr_read_b32 v187, a39
v_mul_f32 v180, v180, v188
v_mul_f32 v181, v181, v189
v_mul_f32 v182, v182, v190
v_mul_f32 v183, v183, v191
v_mul_f32 v184, v184, v188
v_mul_f32 v185, v185, v189
v_mul_f32 v186, v186, v190
v_mul_f32 v187, v187, v191
v_accvgpr_write_b32 a32, v180
v_accvgpr_write_b32 a33, v181
v_accvgpr_write_b32 a34, v182
v_accvgpr_write_b32 a35, v183
v_accvgpr_write_b32 a36, v184
v_accvgpr_write_b32 a37, v185
v_accvgpr_write_b32 a38, v186
v_accvgpr_write_b32 a39, v187
v_accvgpr_read_b32 v180, a40
v_accvgpr_read_b32 v181, a41
v_accvgpr_read_b32 v182, a42
v_accvgpr_read_b32 v183, a43
v_accvgpr_read_b32 v184, a44
v_accvgpr_read_b32 v185, a45
v_accvgpr_read_b32 v186, a46
v_accvgpr_read_b32 v187, a47
v_mul_f32 v180, v180, v188
v_mul_f32 v181, v181, v189
v_mul_f32 v182, v182, v190
v_mul_f32 v183, v183, v191
v_mul_f32 v184, v184, v188
v_mul_f32 v185, v185, v189
v_mul_f32 v186, v186, v190
v_mul_f32 v187, v187, v191
v_accvgpr_write_b32 a40, v180
v_accvgpr_write_b32 a41, v181
v_accvgpr_write_b32 a42, v182
v_accvgpr_write_b32 a43, v183
v_accvgpr_write_b32 a44, v184
v_accvgpr_write_b32 a45, v185
v_accvgpr_write_b32 a46, v186
v_accvgpr_write_b32 a47, v187
v_accvgpr_read_b32 v180, a48
v_accvgpr_read_b32 v181, a49
v_accvgpr_read_b32 v182, a50
v_accvgpr_read_b32 v183, a51
v_accvgpr_read_b32 v184, a52
v_accvgpr_read_b32 v185, a53
v_accvgpr_read_b32 v186, a54
v_accvgpr_read_b32 v187, a55
v_mul_f32 v180, v180, v188
v_mul_f32 v181, v181, v189
v_mul_f32 v182, v182, v190
v_mul_f32 v183, v183, v191
v_mul_f32 v184, v184, v188
v_mul_f32 v185, v185, v189
v_mul_f32 v186, v186, v190
v_mul_f32 v187, v187, v191
v_accvgpr_write_b32 a48, v180
v_accvgpr_write_b32 a49, v181
v_accvgpr_write_b32 a50, v182
v_accvgpr_write_b32 a51, v183
v_accvgpr_write_b32 a52, v184
v_accvgpr_write_b32 a53, v185
v_accvgpr_write_b32 a54, v186
v_accvgpr_write_b32 a55, v187
v_accvgpr_read_b32 v180, a56
v_accvgpr_read_b32 v181, a57
v_accvgpr_read_b32 v182, a58
v_accvgpr_read_b32 v183, a59
v_accvgpr_read_b32 v184, a60
v_accvgpr_read_b32 v185, a61
v_accvgpr_read_b32 v186, a62
v_accvgpr_read_b32 v187, a63
v_mul_f32 v180, v180, v188
v_mul_f32 v181, v181, v189
v_mul_f32 v182, v182, v190
v_mul_f32 v183, v183, v191
v_mul_f32 v184, v184, v188
v_mul_f32 v185, v185, v189
v_mul_f32 v186, v186, v190
v_mul_f32 v187, v187, v191
v_accvgpr_write_b32 a56, v180
v_accvgpr_write_b32 a57, v181
v_accvgpr_write_b32 a58, v182
v_accvgpr_write_b32 a59, v183
v_accvgpr_write_b32 a60, v184
v_accvgpr_write_b32 a61, v185
v_accvgpr_write_b32 a62, v186
v_accvgpr_write_b32 a63, v187
LT_nors:
s_waitcnt lgkmcnt(0)
s_nop 1
v_mfma_f32_16x16x32_bf16 a[0:3], v[168:171], v[96:99], a[0:3]
v_mfma_f32_16x16x32_bf16 a[4:7], v[168:171], v[100:103], a[4:7]
v_mfma_f32_16x16x32_bf16 a[8:11], v[168:171], v[104:107], a[8:11]
v_mfma_f32_16x16x32_bf16 a[12:15], v[168:171], v[108:111], a[12:15]
v_mfma_f32_16x16x32_bf16 a[16:19], v[168:171], v[112:115], a[16:19]
v_mfma_f32_16x16x32_bf16 a[20:23], v[168:171], v[116:119], a[20:23]
v_mfma_f32_16x16x32_bf16 a[24:27], v[168:171], v[120:123], a[24:27]
v_mfma_f32_16x16x32_bf16 a[28:31], v[168:171], v[124:127], a[28:31]
v_mfma_f32_16x16x32_bf16 a[32:35], v[168:171], v[128:131], a[32:35]
v_mfma_f32_16x16x32_bf16 a[36:39], v[168:171], v[132:135], a[36:39]
v_mfma_f32_16x16x32_bf16 a[40:43], v[168:171], v[136:139], a[40:43]
v_mfma_f32_16x16x32_bf16 a[44:47], v[168:171], v[140:143], a[44:47]
v_mfma_f32_16x16x32_bf16 a[48:51], v[168:171], v[144:147], a[48:51]
v_mfma_f32_16x16x32_bf16 a[52:55], v[168:171], v[148:151], a[52:55]
v_mfma_f32_16x16x32_bf16 a[56:59], v[168:171], v[152:155], a[56:59]
v_mfma_f32_16x16x32_bf16 a[60:63], v[168:171], v[156:159], a[60:63]
s_sub_u32 s51, s51, 1
s_cmp_lg_u32 s51, 0
s_cbranch_scc1 LT_loop
s_nop 15
v_accvgpr_read_b32 v180, a0
v_accvgpr_read_b32 v181, a1
v_accvgpr_read_b32 v182, a2
v_accvgpr_read_b32 v183, a3
v_accvgpr_read_b32 v184, a4
v_accvgpr_read_b32 v185, a5
v_accvgpr_read_b32 v186, a6
v_accvgpr_read_b32 v187, a7
v_cvt_pk_bf16_f32 v32, v180, v181
v_cvt_pk_bf16_f32 v33, v182, v183
v_cvt_pk_bf16_f32 v34, v184, v185
v_cvt_pk_bf16_f32 v35, v186, v187
buffer_store_dwordx4 v[32:35], v248, s[20:23], s40 offen offset:0 sc1
v_accvgpr_read_b32 v180, a8
v_accvgpr_read_b32 v181, a9
v_accvgpr_read_b32 v182, a10
v_accvgpr_read_b32 v183, a11
v_accvgpr_read_b32 v184, a12
v_accvgpr_read_b32 v185, a13
v_accvgpr_read_b32 v186, a14
v_accvgpr_read_b32 v187, a15
v_cvt_pk_bf16_f32 v36, v180, v181
v_cvt_pk_bf16_f32 v37, v182, v183
v_cvt_pk_bf16_f32 v38, v184, v185
v_cvt_pk_bf16_f32 v39, v186, v187
buffer_store_dwordx4 v[36:39], v248, s[20:23], s40 offen offset:1024 sc1
v_accvgpr_read_b32 v180, a16
v_accvgpr_read_b32 v181, a17
v_accvgpr_read_b32 v182, a18
v_accvgpr_read_b32 v183, a19
v_accvgpr_read_b32 v184, a20
v_accvgpr_read_b32 v185, a21
v_accvgpr_read_b32 v186, a22
v_accvgpr_read_b32 v187, a23
v_cvt_pk_bf16_f32 v40, v180, v181
v_cvt_pk_bf16_f32 v41, v182, v183
v_cvt_pk_bf16_f32 v42, v184, v185
v_cvt_pk_bf16_f32 v43, v186, v187
buffer_store_dwordx4 v[40:43], v248, s[20:23], s40 offen offset:2048 sc1
v_accvgpr_read_b32 v180, a24
v_accvgpr_read_b32 v181, a25
v_accvgpr_read_b32 v182, a26
v_accvgpr_read_b32 v183, a27
v_accvgpr_read_b32 v184, a28
v_accvgpr_read_b32 v185, a29
v_accvgpr_read_b32 v186, a30
v_accvgpr_read_b32 v187, a31
v_cvt_pk_bf16_f32 v44, v180, v181
v_cvt_pk_bf16_f32 v45, v182, v183
v_cvt_pk_bf16_f32 v46, v184, v185
v_cvt_pk_bf16_f32 v47, v186, v187
buffer_store_dwordx4 v[44:47], v248, s[20:23], s40 offen offset:3072 sc1
v_accvgpr_read_b32 v180, a32
v_accvgpr_read_b32 v181, a33
v_accvgpr_read_b32 v182, a34
v_accvgpr_read_b32 v183, a35
v_accvgpr_read_b32 v184, a36
v_accvgpr_read_b32 v185, a37
v_accvgpr_read_b32 v186, a38
v_accvgpr_read_b32 v187, a39
v_cvt_pk_bf16_f32 v48, v180, v181
v_cvt_pk_bf16_f32 v49, v182, v183
v_cvt_pk_bf16_f32 v50, v184, v185
v_cvt_pk_bf16_f32 v51, v186, v187
buffer_store_dwordx4 v[48:51], v248, s[20:23], s44 offen offset:0 sc1
v_accvgpr_read_b32 v180, a40
v_accvgpr_read_b32 v181, a41
v_accvgpr_read_b32 v182, a42
v_accvgpr_read_b32 v183, a43
v_accvgpr_read_b32 v184, a44
v_accvgpr_read_b32 v185, a45
v_accvgpr_read_b32 v186, a46
v_accvgpr_read_b32 v187, a47
v_cvt_pk_bf16_f32 v52, v180, v181
v_cvt_pk_bf16_f32 v53, v182, v183
v_cvt_pk_bf16_f32 v54, v184, v185
v_cvt_pk_bf16_f32 v55, v186, v187
buffer_store_dwordx4 v[52:55], v248, s[20:23], s44 offen offset:1024 sc1
v_accvgpr_read_b32 v180, a48
v_accvgpr_read_b32 v181, a49
v_accvgpr_read_b32 v182, a50
v_accvgpr_read_b32 v183, a51
v_accvgpr_read_b32 v184, a52
v_accvgpr_read_b32 v185, a53
v_accvgpr_read_b32 v186, a54
v_accvgpr_read_b32 v187, a55
v_cvt_pk_bf16_f32 v56, v180, v181
v_cvt_pk_bf16_f32 v57, v182, v183
v_cvt_pk_bf16_f32 v58, v184, v185
v_cvt_pk_bf16_f32 v59, v186, v187
buffer_store_dwordx4 v[56:59], v248, s[20:23], s44 offen offset:2048 sc1
v_accvgpr_read_b32 v180, a56
v_accvgpr_read_b32 v181, a57
v_accvgpr_read_b32 v182, a58
v_accvgpr_read_b32 v183, a59
v_accvgpr_read_b32 v184, a60
v_accvgpr_read_b32 v185, a61
v_accvgpr_read_b32 v186, a62
v_accvgpr_read_b32 v187, a63
v_cvt_pk_bf16_f32 v60, v180, v181
v_cvt_pk_bf16_f32 v61, v182, v183
v_cvt_pk_bf16_f32 v62, v184, v185
v_cvt_pk_bf16_f32 v63, v186, v187
buffer_store_dwordx4 v[60:63], v248, s[20:23], s44 offen offset:3072 sc1
v_mov_b32 v176, v173
s_nop 1
v_permlane32_swap_b32 v173, v176
s_nop 1
v_add_f32 v173, v173, v176
v_mov_b32 v176, v173
s_nop 1
v_permlane16_swap_b32 v173, v176
s_nop 1
v_add_f32 v173, v173, v176
v_lshlrev_b32 v175, 2, v248
s_mov_b64 exec, 0xffff
s_mov_b64 exec, -1
v_bfe_u32 v175, v248, 8, 1
v_mul_u32_u24 v175, 48, v175
v_lshl_add_u32 v175, s37, 3, v175
v_and_b32 v176, 0xf0, v248
v_lshl_add_u32 v175, v176, 3, v175
s_mov_b32 exec_hi, 0
buffer_store_dwordx2 v[172:173], v175, s[24:27], s48 offen sc1
s_add_u32 s16, s4, 0x7c00000
s_addc_u32 s17, s5, 0
s_mov_b32 s18, 0x40000
s_mov_b32 s19, 0x00020000
s_add_u32 s48, s37, 1248
s_mul_i32 s48, s48, 128
s_waitcnt vmcnt(0)
v_mov_b32 v175, 1
s_mov_b64 exec, 1
buffer_store_dword v175, off, s[16:19], s48 sc1
s_mov_b64 exec, -1
s_branch L2_fin
LE_start:
s_cmp_ge_u32 s37, 32
s_cbranch_scc1 L2_end
v_lshrrev_b32 v1, 6, v0
s_sub_u32 s37, s37, 30
s_lshl_b32 s35, s35, 1
v_readfirstlane_b32 s41, v1
s_add_u32 s35, s35, s37
s_mul_i32 s35, s35, 3
s_add_u32 s40, s35, s41
s_cmp_ge_u32 s41, 3
s_cbranch_scc1 L2_end
LE_common:
v_and_b32 v1, 63, v0
s_mov_b32 s42, 0
s_mov_b32 s49, 512
v_lshrrev_b32 v33, 1, v1
v_and_b32 v34, 1, v1
v_mul_u32_u24 v6, 0x5000, v33
v_lshl_add_u32 v6, v34, 4, v6
v_lshlrev_b32 v33, 2, v33
s_mul_i32 s50, s40, 655360
s_mul_i32 s48, s40, 128
s_waitcnt lgkmcnt(0)
s_add_u32 s8, s4, 0x7800000
s_addc_u32 s9, s5, 0
s_mov_b32 s10, 0x2000
s_mov_b32 s11, 0x00020000
s_add_u32 s12, s4, 0x8000000
s_addc_u32 s13, s5, 0
s_mov_b32 s14, 0x2800000
s_mov_b32 s15, 0x00020000
buffer_load_dword v4, v33, s[8:11], s48 offen
buffer_load_dwordx4 v[192:195], v6, s[12:15], s50 offen offset:0
buffer_load_dwordx4 v[196:199], v6, s[12:15], s50 offen offset:32
buffer_load_dwordx4 v[200:203], v6, s[12:15], s50 offen offset:64
buffer_load_dwordx4 v[204:207], v6, s[12:15], s50 offen offset:96
buffer_load_dwordx4 v[208:211], v6, s[12:15], s50 offen offset:128
buffer_load_dwordx4 v[212:215], v6, s[12:15], s50 offen offset:160
buffer_load_dwordx4 v[216:219], v6, s[12:15], s50 offen offset:192
buffer_load_dwordx4 v[220:223], v6, s[12:15], s50 offen offset:224
buffer_load_dwordx4 v[224:227], v6, s[12:15], s50 offen offset:256
buffer_load_dwordx4 v[228:231], v6, s[12:15], s50 offen offset:288
buffer_load_dwordx4 v[232:235], v6, s[12:15], s50 offen offset:320
buffer_load_dwordx4 v[236:239], v6, s[12:15], s50 offen offset:352
buffer_load_dwordx4 v[240:243], v6, s[12:15], s50 offen offset:384
buffer_load_dwordx4 v[244:247], v6, s[12:15], s50 offen offset:416
buffer_load_dwordx4 v[248:251], v6, s[12:15], s50 offen offset:448
buffer_load_dwordx4 v[252:255], v6, s[12:15], s50 offen offset:480
s_add_u32 s16, s4, 0x6800000
s_addc_u32 s17, s5, 0
s_mov_b32 s18, 0x4e2000
s_mov_b32 s19, 0x00020000
s_add_u32 s20, s4, 0x7000000
s_addc_u32 s21, s5, 0
s_mov_b32 s22, 0x4e2000
s_mov_b32 s23, 0x00020000
v_lshlrev_b32 v5, 2, v34
v_and_b32 v2, 15, v1
v_lshrrev_b32 v3, 4, v1
v_mov_b32 v16, 1
v_mov_b32 v17, 4
v_and_b32 v33, 1, v2
v_lshlrev_b32 v33, 4, v33
v_lshlrev_b32 v33, v33, v16
v_mul_u32_u24 v33, 0x3f80, v33
v_lshrrev_b32 v34, 1, v2
v_cmp_eq_u32 vcc, 0, v34
s_nop 1
v_cndmask_b32 v40, 0, v33, vcc
v_cmp_eq_u32 vcc, 1, v34
s_nop 1
v_cndmask_b32 v41, 0, v33, vcc
v_cmp_eq_u32 vcc, 2, v34
s_nop 1
v_cndmask_b32 v42, 0, v33, vcc
v_cmp_eq_u32 vcc, 3, v34
s_nop 1
v_cndmask_b32 v43, 0, v33, vcc
v_cmp_eq_u32 vcc, 4, v34
s_nop 1
v_cndmask_b32 v44, 0, v33, vcc
v_cmp_eq_u32 vcc, 5, v34
s_nop 1
v_cndmask_b32 v45, 0, v33, vcc
v_cmp_eq_u32 vcc, 6, v34
s_nop 1
v_cndmask_b32 v46, 0, v33, vcc
v_cmp_eq_u32 vcc, 7, v34
s_nop 1
v_cndmask_b32 v47, 0, v33, vcc
v_lshlrev_b32 v39, 5, v2
v_lshl_add_u32 v39, v3, 3, v39
v_lshlrev_b32 v2, 4, v2
s_mul_i32 s48, s41, 21504
s_add_u32 s48, s48, 4096
v_mov_b32 v36, s48
v_lshl_add_u32 v38, v3, 2, v36
s_lshl_b32 s36, s41, 10
v_mov_b32 v7, s36
v_lshlrev_b32 v35, 4, v1
v_add_u32 v68, s48, v35
v_add_u32 v35, s36, v35
v_lshlrev_b32 v33, 2, v1
v_mov_b32 v72, 0xffff
v_mov_b32 v73, 0xffff
v_mov_b32 v74, 0xffff
v_mov_b32 v75, 0xffff
v_cmp_gt_u32 vcc, 157, v33
v_mov_b32 v48, 0
s_nop 0
v_cndmask_b32 v18, 0, v16, vcc
v_cmp_gt_u32 vcc, 156, v33
v_mov_b32 v49, 0
s_nop 0
v_cndmask_b32 v19, 0, v16, vcc
v_cmp_gt_u32 vcc, 155, v33
v_mov_b32 v50, 0
s_nop 0
v_cndmask_b32 v20, 0, v16, vcc
v_cmp_gt_u32 vcc, 154, v33
v_mov_b32 v51, 0
s_nop 0
v_cndmask_b32 v21, 0, v16, vcc
LE_pass:
ds_write_b128 v35, v[48:51]
ds_write_b128 v68, v[72:75] offset:0
ds_write_b128 v68, v[72:75] offset:1024
ds_write_b128 v68, v[72:75] offset:2048
ds_write_b128 v68, v[72:75] offset:3072
ds_write_b128 v68, v[72:75] offset:4096
ds_write_b128 v68, v[72:75] offset:5120
ds_write_b128 v68, v[72:75] offset:6144
ds_write_b128 v68, v[72:75] offset:7168
ds_write_b128 v68, v[72:75] offset:8192
ds_write_b128 v68, v[72:75] offset:9216
ds_write_b128 v68, v[72:75] offset:10240
ds_write_b128 v68, v[72:75] offset:11264
ds_write_b128 v68, v[72:75] offset:12288
ds_write_b128 v68, v[72:75] offset:13312
ds_write_b128 v68, v[72:75] offset:14336
ds_write_b128 v68, v[72:75] offset:15360
ds_write_b128 v68, v[72:75] offset:16384
ds_write_b128 v68, v[72:75] offset:17408
ds_write_b128 v68, v[72:75] offset:18432
ds_write_b128 v68, v[72:75] offset:19456
v_lshl_add_u32 v32, v1, 2, v36
ds_write_b32 v32, v48 offset:20480
s_waitcnt vmcnt(16)
v_sub_u32 v32, v4, v5
s_waitcnt vmcnt(15)
v_cmpx_lt_i32 vcc, 0, v32
s_cbranch_execz LE_c
v_mad_u32_u16 v128, v192, 1, v7 op_sel:[1,0,0,0]
ds_add_u32 v128, v16
v_cmpx_lt_i32 vcc, 1, v32
v_mad_u32_u16 v129, v193, 1, v7 op_sel:[1,0,0,0]
ds_add_u32 v129, v16
v_cmpx_lt_i32 vcc, 2, v32
v_mad_u32_u16 v130, v194, 1, v7 op_sel:[1,0,0,0]
ds_add_u32 v130, v16
v_cmpx_lt_i32 vcc, 3, v32
v_mad_u32_u16 v131, v195, 1, v7 op_sel:[1,0,0,0]
ds_add_u32 v131, v16
s_waitcnt vmcnt(14)
v_cmpx_lt_i32 vcc, 8, v32
s_cbranch_execz LE_c
v_mad_u32_u16 v132, v196, 1, v7 op_sel:[1,0,0,0]
ds_add_u32 v132, v16
v_cmpx_lt_i32 vcc, 9, v32
v_mad_u32_u16 v133, v197, 1, v7 op_sel:[1,0,0,0]
ds_add_u32 v133, v16
v_cmpx_lt_i32 vcc, 10, v32
v_mad_u32_u16 v134, v198, 1, v7 op_sel:[1,0,0,0]
ds_add_u32 v134, v16
v_cmpx_lt_i32 vcc, 11, v32
v_mad_u32_u16 v135, v199, 1, v7 op_sel:[1,0,0,0]
ds_add_u32 v135, v16
s_waitcnt vmcnt(13)
v_cmpx_lt_i32 vcc, 16, v32
s_cbranch_execz LE_c
v_mad_u32_u16 v136, v200, 1, v7 op_sel:[1,0,0,0]
ds_add_u32 v136, v16
v_cmpx_lt_i32 vcc, 17, v32
v_mad_u32_u16 v137, v201, 1, v7 op_sel:[1,0,0,0]
ds_add_u32 v137, v16
v_cmpx_lt_i32 vcc, 18, v32
v_mad_u32_u16 v138, v202, 1, v7 op_sel:[1,0,0,0]
ds_add_u32 v138, v16
v_cmpx_lt_i32 vcc, 19, v32
v_mad_u32_u16 v139, v203, 1, v7 op_sel:[1,0,0,0]
ds_add_u32 v139, v16
s_waitcnt vmcnt(12)
v_cmpx_lt_i32 vcc, 24, v32
s_cbranch_execz LE_c
v_mad_u32_u16 v140, v204, 1, v7 op_sel:[1,0,0,0]
ds_add_u32 v140, v16
v_cmpx_lt_i32 vcc, 25, v32
v_mad_u32_u16 v141, v205, 1, v7 op_sel:[1,0,0,0]
ds_add_u32 v141, v16
v_cmpx_lt_i32 vcc, 26, v32
v_mad_u32_u16 v142, v206, 1, v7 op_sel:[1,0,0,0]
ds_add_u32 v142, v16
v_cmpx_lt_i32 vcc, 27, v32
v_mad_u32_u16 v143, v207, 1, v7 op_sel:[1,0,0,0]
ds_add_u32 v143, v16
s_waitcnt vmcnt(11)
v_cmpx_lt_i32 vcc, 32, v32
s_cbranch_execz LE_c
v_mad_u32_u16 v144, v208, 1, v7 op_sel:[1,0,0,0]
ds_add_u32 v144, v16
v_cmpx_lt_i32 vcc, 33, v32
v_mad_u32_u16 v145, v209, 1, v7 op_sel:[1,0,0,0]
ds_add_u32 v145, v16
v_cmpx_lt_i32 vcc, 34, v32
v_mad_u32_u16 v146, v210, 1, v7 op_sel:[1,0,0,0]
ds_add_u32 v146, v16
v_cmpx_lt_i32 vcc, 35, v32
v_mad_u32_u16 v147, v211, 1, v7 op_sel:[1,0,0,0]
ds_add_u32 v147, v16
s_waitcnt vmcnt(10)
v_cmpx_lt_i32 vcc, 40, v32
s_cbranch_execz LE_c
v_mad_u32_u16 v148, v212, 1, v7 op_sel:[1,0,0,0]
ds_add_u32 v148, v16
v_cmpx_lt_i32 vcc, 41, v32
v_mad_u32_u16 v149, v213, 1, v7 op_sel:[1,0,0,0]
ds_add_u32 v149, v16
v_cmpx_lt_i32 vcc, 42, v32
v_mad_u32_u16 v150, v214, 1, v7 op_sel:[1,0,0,0]
ds_add_u32 v150, v16
v_cmpx_lt_i32 vcc, 43, v32
v_mad_u32_u16 v151, v215, 1, v7 op_sel:[1,0,0,0]
ds_add_u32 v151, v16
s_waitcnt vmcnt(9)
v_cmpx_lt_i32 vcc, 48, v32
s_cbranch_execz LE_c
v_mad_u32_u16 v152, v216, 1, v7 op_sel:[1,0,0,0]
ds_add_u32 v152, v16
v_cmpx_lt_i32 vcc, 49, v32
v_mad_u32_u16 v153, v217, 1, v7 op_sel:[1,0,0,0]
ds_add_u32 v153, v16
v_cmpx_lt_i32 vcc, 50, v32
v_mad_u32_u16 v154, v218, 1, v7 op_sel:[1,0,0,0]
ds_add_u32 v154, v16
v_cmpx_lt_i32 vcc, 51, v32
v_mad_u32_u16 v155, v219, 1, v7 op_sel:[1,0,0,0]
ds_add_u32 v155, v16
s_waitcnt vmcnt(8)
v_cmpx_lt_i32 vcc, 56, v32
s_cbranch_execz LE_c
v_mad_u32_u16 v156, v220, 1, v7 op_sel:[1,0,0,0]
ds_add_u32 v156, v16
v_cmpx_lt_i32 vcc, 57, v32
v_mad_u32_u16 v157, v221, 1, v7 op_sel:[1,0,0,0]
ds_add_u32 v157, v16
v_cmpx_lt_i32 vcc, 58, v32
v_mad_u32_u16 v158, v222, 1, v7 op_sel:[1,0,0,0]
ds_add_u32 v158, v16
v_cmpx_lt_i32 vcc, 59, v32
v_mad_u32_u16 v159, v223, 1, v7 op_sel:[1,0,0,0]
ds_add_u32 v159, v16
s_waitcnt vmcnt(7)
v_cmpx_lt_i32 vcc, 64, v32
s_cbranch_execz LE_c
v_mad_u32_u16 v160, v224, 1, v7 op_sel:[1,0,0,0]
ds_add_u32 v160, v16
v_cmpx_lt_i32 vcc, 65, v32
v_mad_u32_u16 v161, v225, 1, v7 op_sel:[1,0,0,0]
ds_add_u32 v161, v16
v_cmpx_lt_i32 vcc, 66, v32
v_mad_u32_u16 v162, v226, 1, v7 op_sel:[1,0,0,0]
ds_add_u32 v162, v16
v_cmpx_lt_i32 vcc, 67, v32
v_mad_u32_u16 v163, v227, 1, v7 op_sel:[1,0,0,0]
ds_add_u32 v163, v16
s_waitcnt vmcnt(6)
v_cmpx_lt_i32 vcc, 72, v32
s_cbranch_execz LE_c
v_mad_u32_u16 v164, v228, 1, v7 op_sel:[1,0,0,0]
ds_add_u32 v164, v16
v_cmpx_lt_i32 vcc, 73, v32
v_mad_u32_u16 v165, v229, 1, v7 op_sel:[1,0,0,0]
ds_add_u32 v165, v16
v_cmpx_lt_i32 vcc, 74, v32
v_mad_u32_u16 v166, v230, 1, v7 op_sel:[1,0,0,0]
ds_add_u32 v166, v16
v_cmpx_lt_i32 vcc, 75, v32
v_mad_u32_u16 v167, v231, 1, v7 op_sel:[1,0,0,0]
ds_add_u32 v167, v16
s_waitcnt vmcnt(5)
v_cmpx_lt_i32 vcc, 80, v32
s_cbranch_execz LE_c
v_mad_u32_u16 v168, v232, 1, v7 op_sel:[1,0,0,0]
ds_add_u32 v168, v16
v_cmpx_lt_i32 vcc, 81, v32
v_mad_u32_u16 v169, v233, 1, v7 op_sel:[1,0,0,0]
ds_add_u32 v169, v16
v_cmpx_lt_i32 vcc, 82, v32
v_mad_u32_u16 v170, v234, 1, v7 op_sel:[1,0,0,0]
ds_add_u32 v170, v16
v_cmpx_lt_i32 vcc, 83, v32
v_mad_u32_u16 v171, v235, 1, v7 op_sel:[1,0,0,0]
ds_add_u32 v171, v16
s_waitcnt vmcnt(4)
v_cmpx_lt_i32 vcc, 88, v32
s_cbranch_execz LE_c
v_mad_u32_u16 v172, v236, 1, v7 op_sel:[1,0,0,0]
ds_add_u32 v172, v16
v_cmpx_lt_i32 vcc, 89, v32
v_mad_u32_u16 v173, v237, 1, v7 op_sel:[1,0,0,0]
ds_add_u32 v173, v16
v_cmpx_lt_i32 vcc, 90, v32
v_mad_u32_u16 v174, v238, 1, v7 op_sel:[1,0,0,0]
ds_add_u32 v174, v16
v_cmpx_lt_i32 vcc, 91, v32
v_mad_u32_u16 v175, v239, 1, v7 op_sel:[1,0,0,0]
ds_add_u32 v175, v16
s_waitcnt vmcnt(3)
v_cmpx_lt_i32 vcc, 96, v32
s_cbranch_execz LE_c
v_mad_u32_u16 v176, v240, 1, v7 op_sel:[1,0,0,0]
ds_add_u32 v176, v16
v_cmpx_lt_i32 vcc, 97, v32
v_mad_u32_u16 v177, v241, 1, v7 op_sel:[1,0,0,0]
ds_add_u32 v177, v16
v_cmpx_lt_i32 vcc, 98, v32
v_mad_u32_u16 v178, v242, 1, v7 op_sel:[1,0,0,0]
ds_add_u32 v178, v16
v_cmpx_lt_i32 vcc, 99, v32
v_mad_u32_u16 v179, v243, 1, v7 op_sel:[1,0,0,0]
ds_add_u32 v179, v16
s_waitcnt vmcnt(2)
v_cmpx_lt_i32 vcc, 104, v32
s_cbranch_execz LE_c
v_mad_u32_u16 v180, v244, 1, v7 op_sel:[1,0,0,0]
ds_add_u32 v180, v16
v_cmpx_lt_i32 vcc, 105, v32
v_mad_u32_u16 v181, v245, 1, v7 op_sel:[1,0,0,0]
ds_add_u32 v181, v16
v_cmpx_lt_i32 vcc, 106, v32
v_mad_u32_u16 v182, v246, 1, v7 op_sel:[1,0,0,0]
ds_add_u32 v182, v16
v_cmpx_lt_i32 vcc, 107, v32
v_mad_u32_u16 v183, v247, 1, v7 op_sel:[1,0,0,0]
ds_add_u32 v183, v16
s_waitcnt vmcnt(1)
v_cmpx_lt_i32 vcc, 112, v32
s_cbranch_execz LE_c
v_mad_u32_u16 v184, v248, 1, v7 op_sel:[1,0,0,0]
ds_add_u32 v184, v16
v_cmpx_lt_i32 vcc, 113, v32
v_mad_u32_u16 v185, v249, 1, v7 op_sel:[1,0,0,0]
ds_add_u32 v185, v16
v_cmpx_lt_i32 vcc, 114, v32
v_mad_u32_u16 v186, v250, 1, v7 op_sel:[1,0,0,0]
ds_add_u32 v186, v16
v_cmpx_lt_i32 vcc, 115, v32
v_mad_u32_u16 v187, v251, 1, v7 op_sel:[1,0,0,0]
ds_add_u32 v187, v16
s_waitcnt vmcnt(0)
v_cmpx_lt_i32 vcc, 120, v32
s_cbranch_execz LE_c
v_mad_u32_u16 v188, v252, 1, v7 op_sel:[1,0,0,0]
ds_add_u32 v188, v16
v_cmpx_lt_i32 vcc, 121, v32
v_mad_u32_u16 v189, v253, 1, v7 op_sel:[1,0,0,0]
ds_add_u32 v189, v16
v_cmpx_lt_i32 vcc, 122, v32
v_mad_u32_u16 v190, v254, 1, v7 op_sel:[1,0,0,0]
ds_add_u32 v190, v16
v_cmpx_lt_i32 vcc, 123, v32
v_mad_u32_u16 v191, v255, 1, v7 op_sel:[1,0,0,0]
ds_add_u32 v191, v16
LE_c:
s_mov_b64 exec, -1
ds_read_b128 v[24:27], v35
s_waitcnt lgkmcnt(0)
v_add_u32 v24, 3, v24
v_lshrrev_b32 v24, 2, v24
v_max_u32 v24, v24, v18
v_add_u32 v25, 3, v25
v_lshrrev_b32 v25, 2, v25
v_max_u32 v25, v25, v19
v_add_u32 v26, 3, v26
v_lshrrev_b32 v26, 2, v26
v_max_u32 v26, v26, v20
v_add_u32 v27, 3, v27
v_lshrrev_b32 v27, 2, v27
v_max_u32 v27, v27, v21
v_add_u32 v33, v24, v25
v_add3_u32 v33, v33, v26, v27
v_mov_b32 v64, v33
s_nop 1
v_add_u32_dpp v64, v64, v64 row_shr:1 row_mask:0xf bank_mask:0xf
s_nop 1
v_add_u32_dpp v64, v64, v64 row_shr:2 row_mask:0xf bank_mask:0xf
s_nop 1
v_add_u32_dpp v64, v64, v64 row_shr:4 row_mask:0xf bank_mask:0xf
s_nop 1
v_add_u32_dpp v64, v64, v64 row_shr:8 row_mask:0xf bank_mask:0xf
s_nop 1
v_add_u32_dpp v64, v64, v64 row_bcast:15 row_mask:0xa bank_mask:0xf
s_nop 1
v_add_u32_dpp v64, v64, v64 row_bcast:31 row_mask:0xc bank_mask:0xf
s_nop 1
v_readlane_b32 s44, v64, 63
v_sub_u32 v28, v64, v33
v_add_u32 v29, v28, v24
v_add_u32 v30, v29, v25
v_add_u32 v31, v30, v26
v_add3_u32 v33, v28, v24, -1
v_lshlrev_b32 v34, v33, v18
v_lshrrev_b32 v33, 5, v33
v_lshl_add_u32 v33, v33, 2, v36
ds_or_b32 v33, v34 offset:20480
v_lshl_add_u32 v28, v28, 4, v36
v_add3_u32 v33, v29, v25, -1
v_lshlrev_b32 v34, v33, v19
v_lshrrev_b32 v33, 5, v33
v_lshl_add_u32 v33, v33, 2, v36
ds_or_b32 v33, v34 offset:20480
v_lshl_add_u32 v29, v29, 4, v36
v_add3_u32 v33, v30, v26, -1
v_lshlrev_b32 v34, v33, v20
v_lshrrev_b32 v33, 5, v33
v_lshl_add_u32 v33, v33, 2, v36
ds_or_b32 v33, v34 offset:20480
v_lshl_add_u32 v30, v30, 4, v36
v_add3_u32 v33, v31, v27, -1
v_lshlrev_b32 v34, v33, v21
v_lshrrev_b32 v33, 5, v33
v_lshl_add_u32 v33, v33, 2, v36
ds_or_b32 v33, v34 offset:20480
v_lshl_add_u32 v31, v31, 4, v36
ds_write_b128 v35, v[28:31]
s_add_u32 s44, s44, 31
s_lshr_b32 s44, s44, 5
v_cmpx_lt_i32 vcc, 0, v32
s_cbranch_execz LE_p
ds_add_rtn_u32 v128, v128, v17
v_cmpx_lt_i32 vcc, 1, v32
ds_add_rtn_u32 v129, v129, v17
v_cmpx_lt_i32 vcc, 2, v32
ds_add_rtn_u32 v130, v130, v17
v_cmpx_lt_i32 vcc, 3, v32
ds_add_rtn_u32 v131, v131, v17
v_cmpx_lt_i32 vcc, 8, v32
s_cbranch_execz LE_p
ds_add_rtn_u32 v132, v132, v17
v_cmpx_lt_i32 vcc, 9, v32
ds_add_rtn_u32 v133, v133, v17
v_cmpx_lt_i32 vcc, 10, v32
ds_add_rtn_u32 v134, v134, v17
v_cmpx_lt_i32 vcc, 11, v32
ds_add_rtn_u32 v135, v135, v17
v_cmpx_lt_i32 vcc, 16, v32
s_cbranch_execz LE_p
ds_add_rtn_u32 v136, v136, v17
v_cmpx_lt_i32 vcc, 17, v32
ds_add_rtn_u32 v137, v137, v17
v_cmpx_lt_i32 vcc, 18, v32
ds_add_rtn_u32 v138, v138, v17
v_cmpx_lt_i32 vcc, 19, v32
ds_add_rtn_u32 v139, v139, v17
v_cmpx_lt_i32 vcc, 24, v32
s_cbranch_execz LE_p
ds_add_rtn_u32 v140, v140, v17
v_cmpx_lt_i32 vcc, 25, v32
ds_add_rtn_u32 v141, v141, v17
v_cmpx_lt_i32 vcc, 26, v32
ds_add_rtn_u32 v142, v142, v17
v_cmpx_lt_i32 vcc, 27, v32
ds_add_rtn_u32 v143, v143, v17
v_cmpx_lt_i32 vcc, 32, v32
s_cbranch_execz LE_p
ds_add_rtn_u32 v144, v144, v17
v_cmpx_lt_i32 vcc, 33, v32
ds_add_rtn_u32 v145, v145, v17
v_cmpx_lt_i32 vcc, 34, v32
ds_add_rtn_u32 v146, v146, v17
v_cmpx_lt_i32 vcc, 35, v32
ds_add_rtn_u32 v147, v147, v17
v_cmpx_lt_i32 vcc, 40, v32
s_cbranch_execz LE_p
ds_add_rtn_u32 v148, v148, v17
v_cmpx_lt_i32 vcc, 41, v32
ds_add_rtn_u32 v149, v149, v17
v_cmpx_lt_i32 vcc, 42, v32
ds_add_rtn_u32 v150, v150, v17
v_cmpx_lt_i32 vcc, 43, v32
ds_add_rtn_u32 v151, v151, v17
v_cmpx_lt_i32 vcc, 48, v32
s_cbranch_execz LE_p
ds_add_rtn_u32 v152, v152, v17
v_cmpx_lt_i32 vcc, 49, v32
ds_add_rtn_u32 v153, v153, v17
v_cmpx_lt_i32 vcc, 50, v32
ds_add_rtn_u32 v154, v154, v17
v_cmpx_lt_i32 vcc, 51, v32
ds_add_rtn_u32 v155, v155, v17
v_cmpx_lt_i32 vcc, 56, v32
s_cbranch_execz LE_p
ds_add_rtn_u32 v156, v156, v17
v_cmpx_lt_i32 vcc, 57, v32
ds_add_rtn_u32 v157, v157, v17
v_cmpx_lt_i32 vcc, 58, v32
ds_add_rtn_u32 v158, v158, v17
v_cmpx_lt_i32 vcc, 59, v32
ds_add_rtn_u32 v159, v159, v17
v_cmpx_lt_i32 vcc, 64, v32
s_cbranch_execz LE_p
ds_add_rtn_u32 v160, v160, v17
v_cmpx_lt_i32 vcc, 65, v32
ds_add_rtn_u32 v161, v161, v17
v_cmpx_lt_i32 vcc, 66, v32
ds_add_rtn_u32 v162, v162, v17
v_cmpx_lt_i32 vcc, 67, v32
ds_add_rtn_u32 v163, v163, v17
v_cmpx_lt_i32 vcc, 72, v32
s_cbranch_execz LE_p
ds_add_rtn_u32 v164, v164, v17
v_cmpx_lt_i32 vcc, 73, v32
ds_add_rtn_u32 v165, v165, v17
v_cmpx_lt_i32 vcc, 74, v32
ds_add_rtn_u32 v166, v166, v17
v_cmpx_lt_i32 vcc, 75, v32
ds_add_rtn_u32 v167, v167, v17
v_cmpx_lt_i32 vcc, 80, v32
s_cbranch_execz LE_p
ds_add_rtn_u32 v168, v168, v17
v_cmpx_lt_i32 vcc, 81, v32
ds_add_rtn_u32 v169, v169, v17
v_cmpx_lt_i32 vcc, 82, v32
ds_add_rtn_u32 v170, v170, v17
v_cmpx_lt_i32 vcc, 83, v32
ds_add_rtn_u32 v171, v171, v17
v_cmpx_lt_i32 vcc, 88, v32
s_cbranch_execz LE_p
ds_add_rtn_u32 v172, v172, v17
v_cmpx_lt_i32 vcc, 89, v32
ds_add_rtn_u32 v173, v173, v17
v_cmpx_lt_i32 vcc, 90, v32
ds_add_rtn_u32 v174, v174, v17
v_cmpx_lt_i32 vcc, 91, v32
ds_add_rtn_u32 v175, v175, v17
v_cmpx_lt_i32 vcc, 96, v32
s_cbranch_execz LE_p
ds_add_rtn_u32 v176, v176, v17
v_cmpx_lt_i32 vcc, 97, v32
ds_add_rtn_u32 v177, v177, v17
v_cmpx_lt_i32 vcc, 98, v32
ds_add_rtn_u32 v178, v178, v17
v_cmpx_lt_i32 vcc, 99, v32
ds_add_rtn_u32 v179, v179, v17
v_cmpx_lt_i32 vcc, 104, v32
s_cbranch_execz LE_p
ds_add_rtn_u32 v180, v180, v17
v_cmpx_lt_i32 vcc, 105, v32
ds_add_rtn_u32 v181, v181, v17
v_cmpx_lt_i32 vcc, 106, v32
ds_add_rtn_u32 v182, v182, v17
v_cmpx_lt_i32 vcc, 107, v32
ds_add_rtn_u32 v183, v183, v17
v_cmpx_lt_i32 vcc, 112, v32
s_cbranch_execz LE_p
ds_add_rtn_u32 v184, v184, v17
v_cmpx_lt_i32 vcc, 113, v32
ds_add_rtn_u32 v185, v185, v17
v_cmpx_lt_i32 vcc, 114, v32
ds_add_rtn_u32 v186, v186, v17
v_cmpx_lt_i32 vcc, 115, v32
ds_add_rtn_u32 v187, v187, v17
v_cmpx_lt_i32 vcc, 120, v32
s_cbranch_execz LE_p
ds_add_rtn_u32 v188, v188, v17
v_cmpx_lt_i32 vcc, 121, v32
ds_add_rtn_u32 v189, v189, v17
v_cmpx_lt_i32 vcc, 122, v32
ds_add_rtn_u32 v190, v190, v17
v_cmpx_lt_i32 vcc, 123, v32
ds_add_rtn_u32 v191, v191, v17
LE_p:
s_mov_b64 exec, -1
v_lshl_add_u32 v33, v1, 2, v36
ds_read_b32 v37, v33 offset:20480
s_waitcnt lgkmcnt(0)
v_cmpx_lt_i32 vcc, 0, v32
s_cbranch_execz LE_w
ds_write_b32 v128, v192
v_cmpx_lt_i32 vcc, 1, v32
ds_write_b32 v129, v193
v_cmpx_lt_i32 vcc, 2, v32
ds_write_b32 v130, v194
v_cmpx_lt_i32 vcc, 3, v32
ds_write_b32 v131, v195
v_cmpx_lt_i32 vcc, 8, v32
s_cbranch_execz LE_w
ds_write_b32 v132, v196
v_cmpx_lt_i32 vcc, 9, v32
ds_write_b32 v133, v197
v_cmpx_lt_i32 vcc, 10, v32
ds_write_b32 v134, v198
v_cmpx_lt_i32 vcc, 11, v32
ds_write_b32 v135, v199
v_cmpx_lt_i32 vcc, 16, v32
s_cbranch_execz LE_w
ds_write_b32 v136, v200
v_cmpx_lt_i32 vcc, 17, v32
ds_write_b32 v137, v201
v_cmpx_lt_i32 vcc, 18, v32
ds_write_b32 v138, v202
v_cmpx_lt_i32 vcc, 19, v32
ds_write_b32 v139, v203
v_cmpx_lt_i32 vcc, 24, v32
s_cbranch_execz LE_w
ds_write_b32 v140, v204
v_cmpx_lt_i32 vcc, 25, v32
ds_write_b32 v141, v205
v_cmpx_lt_i32 vcc, 26, v32
ds_write_b32 v142, v206
v_cmpx_lt_i32 vcc, 27, v32
ds_write_b32 v143, v207
v_cmpx_lt_i32 vcc, 32, v32
s_cbranch_execz LE_w
ds_write_b32 v144, v208
v_cmpx_lt_i32 vcc, 33, v32
ds_write_b32 v145, v209
v_cmpx_lt_i32 vcc, 34, v32
ds_write_b32 v146, v210
v_cmpx_lt_i32 vcc, 35, v32
ds_write_b32 v147, v211
v_cmpx_lt_i32 vcc, 40, v32
s_cbranch_execz LE_w
ds_write_b32 v148, v212
v_cmpx_lt_i32 vcc, 41, v32
ds_write_b32 v149, v213
v_cmpx_lt_i32 vcc, 42, v32
ds_write_b32 v150, v214
v_cmpx_lt_i32 vcc, 43, v32
ds_write_b32 v151, v215
v_cmpx_lt_i32 vcc, 48, v32
s_cbranch_execz LE_w
ds_write_b32 v152, v216
v_cmpx_lt_i32 vcc, 49, v32
ds_write_b32 v153, v217
v_cmpx_lt_i32 vcc, 50, v32
ds_write_b32 v154, v218
v_cmpx_lt_i32 vcc, 51, v32
ds_write_b32 v155, v219
v_cmpx_lt_i32 vcc, 56, v32
s_cbranch_execz LE_w
ds_write_b32 v156, v220
v_cmpx_lt_i32 vcc, 57, v32
ds_write_b32 v157, v221
v_cmpx_lt_i32 vcc, 58, v32
ds_write_b32 v158, v222
v_cmpx_lt_i32 vcc, 59, v32
ds_write_b32 v159, v223
v_cmpx_lt_i32 vcc, 64, v32
s_cbranch_execz LE_w
ds_write_b32 v160, v224
v_cmpx_lt_i32 vcc, 65, v32
ds_write_b32 v161, v225
v_cmpx_lt_i32 vcc, 66, v32
ds_write_b32 v162, v226
v_cmpx_lt_i32 vcc, 67, v32
ds_write_b32 v163, v227
v_cmpx_lt_i32 vcc, 72, v32
s_cbranch_execz LE_w
ds_write_b32 v164, v228
v_cmpx_lt_i32 vcc, 73, v32
ds_write_b32 v165, v229
v_cmpx_lt_i32 vcc, 74, v32
ds_write_b32 v166, v230
v_cmpx_lt_i32 vcc, 75, v32
ds_write_b32 v167, v231
v_cmpx_lt_i32 vcc, 80, v32
s_cbranch_execz LE_w
ds_write_b32 v168, v232
v_cmpx_lt_i32 vcc, 81, v32
ds_write_b32 v169, v233
v_cmpx_lt_i32 vcc, 82, v32
ds_write_b32 v170, v234
v_cmpx_lt_i32 vcc, 83, v32
ds_write_b32 v171, v235
v_cmpx_lt_i32 vcc, 88, v32
s_cbranch_execz LE_w
ds_write_b32 v172, v236
v_cmpx_lt_i32 vcc, 89, v32
ds_write_b32 v173, v237
v_cmpx_lt_i32 vcc, 90, v32
ds_write_b32 v174, v238
v_cmpx_lt_i32 vcc, 91, v32
ds_write_b32 v175, v239
v_cmpx_lt_i32 vcc, 96, v32
s_cbranch_execz LE_w
ds_write_b32 v176, v240
v_cmpx_lt_i32 vcc, 97, v32
ds_write_b32 v177, v241
v_cmpx_lt_i32 vcc, 98, v32
ds_write_b32 v178, v242
v_cmpx_lt_i32 vcc, 99, v32
ds_write_b32 v179, v243
v_cmpx_lt_i32 vcc, 104, v32
s_cbranch_execz LE_w
ds_write_b32 v180, v244
v_cmpx_lt_i32 vcc, 105, v32
ds_write_b32 v181, v245
v_cmpx_lt_i32 vcc, 106, v32
ds_write_b32 v182, v246
v_cmpx_lt_i32 vcc, 107, v32
ds_write_b32 v183, v247
v_cmpx_lt_i32 vcc, 112, v32
s_cbranch_execz LE_w
ds_write_b32 v184, v248
v_cmpx_lt_i32 vcc, 113, v32
ds_write_b32 v185, v249
v_cmpx_lt_i32 vcc, 114, v32
ds_write_b32 v186, v250
v_cmpx_lt_i32 vcc, 115, v32
ds_write_b32 v187, v251
v_cmpx_lt_i32 vcc, 120, v32
s_cbranch_execz LE_w
ds_write_b32 v188, v252
v_cmpx_lt_i32 vcc, 121, v32
ds_write_b32 v189, v253
v_cmpx_lt_i32 vcc, 122, v32
ds_write_b32 v190, v254
v_cmpx_lt_i32 vcc, 123, v32
ds_write_b32 v191, v255
LE_w:
s_mov_b64 exec, -1
v_mov_b32 v34, v38
ds_read2_b32 v[52:53], v34 offset0:0 offset1:4
ds_read2_b32 v[54:55], v34 offset0:8 offset1:12
s_waitcnt lgkmcnt(0)
ds_read2_b32 v[56:57], v34 offset0:16 offset1:20
ds_read2_b32 v[58:59], v34 offset0:24 offset1:28
v_mad_u32_u16 v60, v52, s49, v2
v_mad_u32_u16 v61, v53, s49, v2
v_mad_u32_u16 v62, v54, s49, v2
v_mad_u32_u16 v63, v55, s49, v2
buffer_load_dwordx4 a[0:3], v60, s[16:19], 0 offen
buffer_load_dwordx4 a[4:7], v60, s[16:19], 0 offen offset:256
buffer_load_dwordx4 a[8:11], v61, s[16:19], 0 offen
buffer_load_dwordx4 a[12:15], v61, s[16:19], 0 offen offset:256
buffer_load_dwordx4 a[16:19], v62, s[16:19], 0 offen
buffer_load_dwordx4 a[20:23], v62, s[16:19], 0 offen offset:256
buffer_load_dwordx4 a[24:27], v63, s[16:19], 0 offen
buffer_load_dwordx4 a[28:31], v63, s[16:19], 0 offen offset:256
s_waitcnt lgkmcnt(0)
ds_read2_b32 v[52:53], v34 offset0:32 offset1:36
ds_read2_b32 v[54:55], v34 offset0:40 offset1:44
v_mad_u32_u16 v60, v56, s49, v2
v_mad_u32_u16 v61, v57, s49, v2
v_mad_u32_u16 v62, v58, s49, v2
v_mad_u32_u16 v63, v59, s49, v2
buffer_load_dwordx4 a[32:35], v60, s[16:19], 0 offen
buffer_load_dwordx4 a[36:39], v60, s[16:19], 0 offen offset:256
buffer_load_dwordx4 a[40:43], v61, s[16:19], 0 offen
buffer_load_dwordx4 a[44:47], v61, s[16:19], 0 offen offset:256
buffer_load_dwordx4 a[48:51], v62, s[16:19], 0 offen
buffer_load_dwordx4 a[52:55], v62, s[16:19], 0 offen offset:256
buffer_load_dwordx4 a[56:59], v63, s[16:19], 0 offen
buffer_load_dwordx4 a[60:63], v63, s[16:19], 0 offen offset:256
s_waitcnt lgkmcnt(0)
ds_read2_b32 v[56:57], v34 offset0:48 offset1:52
ds_read2_b32 v[58:59], v34 offset0:56 offset1:60
v_mad_u32_u16 v60, v52, s49, v2
v_mad_u32_u16 v61, v53, s49, v2
v_mad_u32_u16 v62, v54, s49, v2
v_mad_u32_u16 v63, v55, s49, v2
buffer_load_dwordx4 a[64:67], v60, s[16:19], 0 offen
buffer_load_dwordx4 a[68:71], v60, s[16:19], 0 offen offset:256
buffer_load_dwordx4 a[72:75], v61, s[16:19], 0 offen
buffer_load_dwordx4 a[76:79], v61, s[16:19], 0 offen offset:256
buffer_load_dwordx4 a[80:83], v62, s[16:19], 0 offen
buffer_load_dwordx4 a[84:87], v62, s[16:19], 0 offen offset:256
buffer_load_dwordx4 a[88:91], v63, s[16:19], 0 offen
buffer_load_dwordx4 a[92:95], v63, s[16:19], 0 offen offset:256
s_waitcnt lgkmcnt(0)
ds_read2_b32 v[52:53], v34 offset0:64 offset1:68
ds_read2_b32 v[54:55], v34 offset0:72 offset1:76
v_mad_u32_u16 v60, v56, s49, v2
v_mad_u32_u16 v61, v57, s49, v2
v_mad_u32_u16 v62, v58, s49, v2
v_mad_u32_u16 v63, v59, s49, v2
buffer_load_dwordx4 a[96:99], v60, s[16:19], 0 offen
buffer_load_dwordx4 a[100:103], v60, s[16:19], 0 offen offset:256
buffer_load_dwordx4 a[104:107], v61, s[16:19], 0 offen
buffer_load_dwordx4 a[108:111], v61, s[16:19], 0 offen offset:256
buffer_load_dwordx4 a[112:115], v62, s[16:19], 0 offen
buffer_load_dwordx4 a[116:119], v62, s[16:19], 0 offen offset:256
buffer_load_dwordx4 a[120:123], v63, s[16:19], 0 offen
buffer_load_dwordx4 a[124:127], v63, s[16:19], 0 offen offset:256
s_waitcnt lgkmcnt(0)
ds_read2_b32 v[56:57], v34 offset0:80 offset1:84
ds_read2_b32 v[58:59], v34 offset0:88 offset1:92
v_mad_u32_u16 v60, v52, s49, v2
v_mad_u32_u16 v61, v53, s49, v2
v_mad_u32_u16 v62, v54, s49, v2
v_mad_u32_u16 v63, v55, s49, v2
buffer_load_dwordx4 a[128:131], v60, s[16:19], 0 offen
buffer_load_dwordx4 a[132:135], v60, s[16:19], 0 offen offset:256
buffer_load_dwordx4 a[136:139], v61, s[16:19], 0 offen
buffer_load_dwordx4 a[140:143], v61, s[16:19], 0 offen offset:256
buffer_load_dwordx4 a[144:147], v62, s[16:19], 0 offen
buffer_load_dwordx4 a[148:151], v62, s[16:19], 0 offen offset:256
buffer_load_dwordx4 a[152:155], v63, s[16:19], 0 offen
buffer_load_dwordx4 a[156:159], v63, s[16:19], 0 offen offset:256
s_waitcnt lgkmcnt(0)
ds_read2_b32 v[52:53], v34 offset0:96 offset1:100
ds_read2_b32 v[54:55], v34 offset0:104 offset1:108
v_mad_u32_u16 v60, v56, s49, v2
v_mad_u32_u16 v61, v57, s49, v2
v_mad_u32_u16 v62, v58, s49, v2
v_mad_u32_u16 v63, v59, s49, v2
buffer_load_dwordx4 a[160:163], v60, s[16:19], 0 offen
buffer_load_dwordx4 a[164:167], v60, s[16:19], 0 offen offset:256
buffer_load_dwordx4 a[168:171], v61, s[16:19], 0 offen
buffer_load_dwordx4 a[172:175], v61, s[16:19], 0 offen offset:256
buffer_load_dwordx4 a[176:179], v62, s[16:19], 0 offen
buffer_load_dwordx4 a[180:183], v62, s[16:19], 0 offen offset:256
buffer_load_dwordx4 a[184:187], v63, s[16:19], 0 offen
buffer_load_dwordx4 a[188:191], v63, s[16:19], 0 offen offset:256
s_waitcnt lgkmcnt(0)
ds_read2_b32 v[56:57], v34 offset0:112 offset1:116
ds_read2_b32 v[58:59], v34 offset0:120 offset1:124
v_mad_u32_u16 v60, v52, s49, v2
v_mad_u32_u16 v61, v53, s49, v2
v_mad_u32_u16 v62, v54, s49, v2
v_mad_u32_u16 v63, v55, s49, v2
buffer_load_dwordx4 a[192:195], v60, s[16:19], 0 offen
buffer_load_dwordx4 a[196:199], v60, s[16:19], 0 offen offset:256
buffer_load_dwordx4 a[200:203], v61, s[16:19], 0 offen
buffer_load_dwordx4 a[204:207], v61, s[16:19], 0 offen offset:256
buffer_load_dwordx4 a[208:211], v62, s[16:19], 0 offen
buffer_load_dwordx4 a[212:215], v62, s[16:19], 0 offen offset:256
buffer_load_dwordx4 a[216:219], v63, s[16:19], 0 offen
buffer_load_dwordx4 a[220:223], v63, s[16:19], 0 offen offset:256
s_waitcnt lgkmcnt(0)
ds_read2_b32 v[52:53], v34 offset0:128 offset1:132
ds_read2_b32 v[54:55], v34 offset0:136 offset1:140
v_mad_u32_u16 v60, v56, s49, v2
v_mad_u32_u16 v61, v57, s49, v2
v_mad_u32_u16 v62, v58, s49, v2
v_mad_u32_u16 v63, v59, s49, v2
buffer_load_dwordx4 a[224:227], v60, s[16:19], 0 offen
buffer_load_dwordx4 a[228:231], v60, s[16:19], 0 offen offset:256
buffer_load_dwordx4 a[232:235], v61, s[16:19], 0 offen
buffer_load_dwordx4 a[236:239], v61, s[16:19], 0 offen offset:256
buffer_load_dwordx4 a[240:243], v62, s[16:19], 0 offen
buffer_load_dwordx4 a[244:247], v62, s[16:19], 0 offen offset:256
buffer_load_dwordx4 a[248:251], v63, s[16:19], 0 offen
buffer_load_dwordx4 a[252:255], v63, s[16:19], 0 offen offset:256
v_add_u32 v34, 512, v34
s_mov_b32 s45, 0
s_mul_i32 s47, s40, 80384
LE_loop:
v_readlane_b32 s46, v37, s45
s_add_u32 s45, s45, 1
s_waitcnt vmcnt(56)
v_mfma_f32_16x16x32_bf16 v[48:51], a[0:3], v[40:43], v[48:51]
v_mfma_f32_16x16x32_bf16 v[48:51], a[4:7], v[44:47], v[48:51]
s_bitcmp1_b32 s46, 0
s_cbranch_scc0 LE_nf0
s_cmp_eq_u32 s42, 0
s_cbranch_scc1 LE_fl0
buffer_load_dwordx2 v[66:67], v39, s[20:23], s47 offen sc1
s_waitcnt vmcnt(0)
v_lshlrev_b32 v64, 16, v66
v_and_b32 v65, 0xffff0000, v66
v_add_f32 v48, v48, v64
v_add_f32 v49, v49, v65
v_lshlrev_b32 v64, 16, v67
v_and_b32 v65, 0xffff0000, v67
v_add_f32 v50, v50, v64
v_add_f32 v51, v51, v65
LE_fl0:
s_nop 3
v_cvt_pk_bf16_f32 v64, v48, v49
v_cvt_pk_bf16_f32 v65, v50, v51
v_mov_b32 v48, 0
v_mov_b32 v49, 0
v_mov_b32 v50, 0
v_mov_b32 v51, 0
buffer_store_dwordx2 v[64:65], v39, s[20:23], s47 offen sc1
s_add_u32 s47, s47, 512
LE_nf0:
v_mfma_f32_16x16x32_bf16 v[48:51], a[8:11], v[40:43], v[48:51]
v_mfma_f32_16x16x32_bf16 v[48:51], a[12:15], v[44:47], v[48:51]
s_bitcmp1_b32 s46, 1
s_cbranch_scc0 LE_nf1
s_cmp_eq_u32 s42, 0
s_cbranch_scc1 LE_fl1
buffer_load_dwordx2 v[66:67], v39, s[20:23], s47 offen sc1
s_waitcnt vmcnt(0)
v_lshlrev_b32 v64, 16, v66
v_and_b32 v65, 0xffff0000, v66
v_add_f32 v48, v48, v64
v_add_f32 v49, v49, v65
v_lshlrev_b32 v64, 16, v67
v_and_b32 v65, 0xffff0000, v67
v_add_f32 v50, v50, v64
v_add_f32 v51, v51, v65
LE_fl1:
s_nop 3
v_cvt_pk_bf16_f32 v64, v48, v49
v_cvt_pk_bf16_f32 v65, v50, v51
v_mov_b32 v48, 0
v_mov_b32 v49, 0
v_mov_b32 v50, 0
v_mov_b32 v51, 0
buffer_store_dwordx2 v[64:65], v39, s[20:23], s47 offen sc1
s_add_u32 s47, s47, 512
LE_nf1:
v_mfma_f32_16x16x32_bf16 v[48:51], a[16:19], v[40:43], v[48:51]
v_mfma_f32_16x16x32_bf16 v[48:51], a[20:23], v[44:47], v[48:51]
s_bitcmp1_b32 s46, 2
s_cbranch_scc0 LE_nf2
s_cmp_eq_u32 s42, 0
s_cbranch_scc1 LE_fl2
buffer_load_dwordx2 v[66:67], v39, s[20:23], s47 offen sc1
s_waitcnt vmcnt(0)
v_lshlrev_b32 v64, 16, v66
v_and_b32 v65, 0xffff0000, v66
v_add_f32 v48, v48, v64
v_add_f32 v49, v49, v65
v_lshlrev_b32 v64, 16, v67
v_and_b32 v65, 0xffff0000, v67
v_add_f32 v50, v50, v64
v_add_f32 v51, v51, v65
LE_fl2:
s_nop 3
v_cvt_pk_bf16_f32 v64, v48, v49
v_cvt_pk_bf16_f32 v65, v50, v51
v_mov_b32 v48, 0
v_mov_b32 v49, 0
v_mov_b32 v50, 0
v_mov_b32 v51, 0
buffer_store_dwordx2 v[64:65], v39, s[20:23], s47 offen sc1
s_add_u32 s47, s47, 512
LE_nf2:
v_mfma_f32_16x16x32_bf16 v[48:51], a[24:27], v[40:43], v[48:51]
v_mfma_f32_16x16x32_bf16 v[48:51], a[28:31], v[44:47], v[48:51]
s_bitcmp1_b32 s46, 3
s_cbranch_scc0 LE_nf3
s_cmp_eq_u32 s42, 0
s_cbranch_scc1 LE_fl3
buffer_load_dwordx2 v[66:67], v39, s[20:23], s47 offen sc1
s_waitcnt vmcnt(0)
v_lshlrev_b32 v64, 16, v66
v_and_b32 v65, 0xffff0000, v66
v_add_f32 v48, v48, v64
v_add_f32 v49, v49, v65
v_lshlrev_b32 v64, 16, v67
v_and_b32 v65, 0xffff0000, v67
v_add_f32 v50, v50, v64
v_add_f32 v51, v51, v65
LE_fl3:
s_nop 3
v_cvt_pk_bf16_f32 v64, v48, v49
v_cvt_pk_bf16_f32 v65, v50, v51
v_mov_b32 v48, 0
v_mov_b32 v49, 0
v_mov_b32 v50, 0
v_mov_b32 v51, 0
buffer_store_dwordx2 v[64:65], v39, s[20:23], s47 offen sc1
s_add_u32 s47, s47, 512
LE_nf3:
s_waitcnt lgkmcnt(0)
ds_read2_b32 v[56:57], v34 offset0:16 offset1:20
ds_read2_b32 v[58:59], v34 offset0:24 offset1:28
v_mad_u32_u16 v60, v52, s49, v2
v_mad_u32_u16 v61, v53, s49, v2
v_mad_u32_u16 v62, v54, s49, v2
v_mad_u32_u16 v63, v55, s49, v2
buffer_load_dwordx4 a[0:3], v60, s[16:19], 0 offen
buffer_load_dwordx4 a[4:7], v60, s[16:19], 0 offen offset:256
buffer_load_dwordx4 a[8:11], v61, s[16:19], 0 offen
buffer_load_dwordx4 a[12:15], v61, s[16:19], 0 offen offset:256
buffer_load_dwordx4 a[16:19], v62, s[16:19], 0 offen
buffer_load_dwordx4 a[20:23], v62, s[16:19], 0 offen offset:256
buffer_load_dwordx4 a[24:27], v63, s[16:19], 0 offen
buffer_load_dwordx4 a[28:31], v63, s[16:19], 0 offen offset:256
s_waitcnt vmcnt(56)
v_mfma_f32_16x16x32_bf16 v[48:51], a[32:35], v[40:43], v[48:51]
v_mfma_f32_16x16x32_bf16 v[48:51], a[36:39], v[44:47], v[48:51]
s_bitcmp1_b32 s46, 4
s_cbranch_scc0 LE_nf4
s_cmp_eq_u32 s42, 0
s_cbranch_scc1 LE_fl4
buffer_load_dwordx2 v[66:67], v39, s[20:23], s47 offen sc1
s_waitcnt vmcnt(0)
v_lshlrev_b32 v64, 16, v66
v_and_b32 v65, 0xffff0000, v66
v_add_f32 v48, v48, v64
v_add_f32 v49, v49, v65
v_lshlrev_b32 v64, 16, v67
v_and_b32 v65, 0xffff0000, v67
v_add_f32 v50, v50, v64
v_add_f32 v51, v51, v65
LE_fl4:
s_nop 3
v_cvt_pk_bf16_f32 v64, v48, v49
v_cvt_pk_bf16_f32 v65, v50, v51
v_mov_b32 v48, 0
v_mov_b32 v49, 0
v_mov_b32 v50, 0
v_mov_b32 v51, 0
buffer_store_dwordx2 v[64:65], v39, s[20:23], s47 offen sc1
s_add_u32 s47, s47, 512
LE_nf4:
v_mfma_f32_16x16x32_bf16 v[48:51], a[40:43], v[40:43], v[48:51]
v_mfma_f32_16x16x32_bf16 v[48:51], a[44:47], v[44:47], v[48:51]
s_bitcmp1_b32 s46, 5
s_cbranch_scc0 LE_nf5
s_cmp_eq_u32 s42, 0
s_cbranch_scc1 LE_fl5
buffer_load_dwordx2 v[66:67], v39, s[20:23], s47 offen sc1
s_waitcnt vmcnt(0)
v_lshlrev_b32 v64, 16, v66
v_and_b32 v65, 0xffff0000, v66
v_add_f32 v48, v48, v64
v_add_f32 v49, v49, v65
v_lshlrev_b32 v64, 16, v67
v_and_b32 v65, 0xffff0000, v67
v_add_f32 v50, v50, v64
v_add_f32 v51, v51, v65
LE_fl5:
s_nop 3
v_cvt_pk_bf16_f32 v64, v48, v49
v_cvt_pk_bf16_f32 v65, v50, v51
v_mov_b32 v48, 0
v_mov_b32 v49, 0
v_mov_b32 v50, 0
v_mov_b32 v51, 0
buffer_store_dwordx2 v[64:65], v39, s[20:23], s47 offen sc1
s_add_u32 s47, s47, 512
LE_nf5:
v_mfma_f32_16x16x32_bf16 v[48:51], a[48:51], v[40:43], v[48:51]
v_mfma_f32_16x16x32_bf16 v[48:51], a[52:55], v[44:47], v[48:51]
s_bitcmp1_b32 s46, 6
s_cbranch_scc0 LE_nf6
s_cmp_eq_u32 s42, 0
s_cbranch_scc1 LE_fl6
buffer_load_dwordx2 v[66:67], v39, s[20:23], s47 offen sc1
s_waitcnt vmcnt(0)
v_lshlrev_b32 v64, 16, v66
v_and_b32 v65, 0xffff0000, v66
v_add_f32 v48, v48, v64
v_add_f32 v49, v49, v65
v_lshlrev_b32 v64, 16, v67
v_and_b32 v65, 0xffff0000, v67
v_add_f32 v50, v50, v64
v_add_f32 v51, v51, v65
LE_fl6:
s_nop 3
v_cvt_pk_bf16_f32 v64, v48, v49
v_cvt_pk_bf16_f32 v65, v50, v51
v_mov_b32 v48, 0
v_mov_b32 v49, 0
v_mov_b32 v50, 0
v_mov_b32 v51, 0
buffer_store_dwordx2 v[64:65], v39, s[20:23], s47 offen sc1
s_add_u32 s47, s47, 512
LE_nf6:
v_mfma_f32_16x16x32_bf16 v[48:51], a[56:59], v[40:43], v[48:51]
v_mfma_f32_16x16x32_bf16 v[48:51], a[60:63], v[44:47], v[48:51]
s_bitcmp1_b32 s46, 7
s_cbranch_scc0 LE_nf7
s_cmp_eq_u32 s42, 0
s_cbranch_scc1 LE_fl7
buffer_load_dwordx2 v[66:67], v39, s[20:23], s47 offen sc1
s_waitcnt vmcnt(0)
v_lshlrev_b32 v64, 16, v66
v_and_b32 v65, 0xffff0000, v66
v_add_f32 v48, v48, v64
v_add_f32 v49, v49, v65
v_lshlrev_b32 v64, 16, v67
v_and_b32 v65, 0xffff0000, v67
v_add_f32 v50, v50, v64
v_add_f32 v51, v51, v65
LE_fl7:
s_nop 3
v_cvt_pk_bf16_f32 v64, v48, v49
v_cvt_pk_bf16_f32 v65, v50, v51
v_mov_b32 v48, 0
v_mov_b32 v49, 0
v_mov_b32 v50, 0
v_mov_b32 v51, 0
buffer_store_dwordx2 v[64:65], v39, s[20:23], s47 offen sc1
s_add_u32 s47, s47, 512
LE_nf7:
s_waitcnt lgkmcnt(0)
ds_read2_b32 v[52:53], v34 offset0:32 offset1:36
ds_read2_b32 v[54:55], v34 offset0:40 offset1:44
v_mad_u32_u16 v60, v56, s49, v2
v_mad_u32_u16 v61, v57, s49, v2
v_mad_u32_u16 v62, v58, s49, v2
v_mad_u32_u16 v63, v59, s49, v2
buffer_load_dwordx4 a[32:35], v60, s[16:19], 0 offen
buffer_load_dwordx4 a[36:39], v60, s[16:19], 0 offen offset:256
buffer_load_dwordx4 a[40:43], v61, s[16:19], 0 offen
buffer_load_dwordx4 a[44:47], v61, s[16:19], 0 offen offset:256
buffer_load_dwordx4 a[48:51], v62, s[16:19], 0 offen
buffer_load_dwordx4 a[52:55], v62, s[16:19], 0 offen offset:256
buffer_load_dwordx4 a[56:59], v63, s[16:19], 0 offen
buffer_load_dwordx4 a[60:63], v63, s[16:19], 0 offen offset:256
s_waitcnt vmcnt(56)
v_mfma_f32_16x16x32_bf16 v[48:51], a[64:67], v[40:43], v[48:51]
v_mfma_f32_16x16x32_bf16 v[48:51], a[68:71], v[44:47], v[48:51]
s_bitcmp1_b32 s46, 8
s_cbranch_scc0 LE_nf8
s_cmp_eq_u32 s42, 0
s_cbranch_scc1 LE_fl8
buffer_load_dwordx2 v[66:67], v39, s[20:23], s47 offen sc1
s_waitcnt vmcnt(0)
v_lshlrev_b32 v64, 16, v66
v_and_b32 v65, 0xffff0000, v66
v_add_f32 v48, v48, v64
v_add_f32 v49, v49, v65
v_lshlrev_b32 v64, 16, v67
v_and_b32 v65, 0xffff0000, v67
v_add_f32 v50, v50, v64
v_add_f32 v51, v51, v65
LE_fl8:
s_nop 3
v_cvt_pk_bf16_f32 v64, v48, v49
v_cvt_pk_bf16_f32 v65, v50, v51
v_mov_b32 v48, 0
v_mov_b32 v49, 0
v_mov_b32 v50, 0
v_mov_b32 v51, 0
buffer_store_dwordx2 v[64:65], v39, s[20:23], s47 offen sc1
s_add_u32 s47, s47, 512
LE_nf8:
v_mfma_f32_16x16x32_bf16 v[48:51], a[72:75], v[40:43], v[48:51]
v_mfma_f32_16x16x32_bf16 v[48:51], a[76:79], v[44:47], v[48:51]
s_bitcmp1_b32 s46, 9
s_cbranch_scc0 LE_nf9
s_cmp_eq_u32 s42, 0
s_cbranch_scc1 LE_fl9
buffer_load_dwordx2 v[66:67], v39, s[20:23], s47 offen sc1
s_waitcnt vmcnt(0)
v_lshlrev_b32 v64, 16, v66
v_and_b32 v65, 0xffff0000, v66
v_add_f32 v48, v48, v64
v_add_f32 v49, v49, v65
v_lshlrev_b32 v64, 16, v67
v_and_b32 v65, 0xffff0000, v67
v_add_f32 v50, v50, v64
v_add_f32 v51, v51, v65
LE_fl9:
s_nop 3
v_cvt_pk_bf16_f32 v64, v48, v49
v_cvt_pk_bf16_f32 v65, v50, v51
v_mov_b32 v48, 0
v_mov_b32 v49, 0
v_mov_b32 v50, 0
v_mov_b32 v51, 0
buffer_store_dwordx2 v[64:65], v39, s[20:23], s47 offen sc1
s_add_u32 s47, s47, 512
LE_nf9:
v_mfma_f32_16x16x32_bf16 v[48:51], a[80:83], v[40:43], v[48:51]
v_mfma_f32_16x16x32_bf16 v[48:51], a[84:87], v[44:47], v[48:51]
s_bitcmp1_b32 s46, 10
s_cbranch_scc0 LE_nf10
s_cmp_eq_u32 s42, 0
s_cbranch_scc1 LE_fl10
buffer_load_dwordx2 v[66:67], v39, s[20:23], s47 offen sc1
s_waitcnt vmcnt(0)
v_lshlrev_b32 v64, 16, v66
v_and_b32 v65, 0xffff0000, v66
v_add_f32 v48, v48, v64
v_add_f32 v49, v49, v65
v_lshlrev_b32 v64, 16, v67
v_and_b32 v65, 0xffff0000, v67
v_add_f32 v50, v50, v64
v_add_f32 v51, v51, v65
LE_fl10:
s_nop 3
v_cvt_pk_bf16_f32 v64, v48, v49
v_cvt_pk_bf16_f32 v65, v50, v51
v_mov_b32 v48, 0
v_mov_b32 v49, 0
v_mov_b32 v50, 0
v_mov_b32 v51, 0
buffer_store_dwordx2 v[64:65], v39, s[20:23], s47 offen sc1
s_add_u32 s47, s47, 512
LE_nf10:
v_mfma_f32_16x16x32_bf16 v[48:51], a[88:91], v[40:43], v[48:51]
v_mfma_f32_16x16x32_bf16 v[48:51], a[92:95], v[44:47], v[48:51]
s_bitcmp1_b32 s46, 11
s_cbranch_scc0 LE_nf11
s_cmp_eq_u32 s42, 0
s_cbranch_scc1 LE_fl11
buffer_load_dwordx2 v[66:67], v39, s[20:23], s47 offen sc1
s_waitcnt vmcnt(0)
v_lshlrev_b32 v64, 16, v66
v_and_b32 v65, 0xffff0000, v66
v_add_f32 v48, v48, v64
v_add_f32 v49, v49, v65
v_lshlrev_b32 v64, 16, v67
v_and_b32 v65, 0xffff0000, v67
v_add_f32 v50, v50, v64
v_add_f32 v51, v51, v65
LE_fl11:
s_nop 3
v_cvt_pk_bf16_f32 v64, v48, v49
v_cvt_pk_bf16_f32 v65, v50, v51
v_mov_b32 v48, 0
v_mov_b32 v49, 0
v_mov_b32 v50, 0
v_mov_b32 v51, 0
buffer_store_dwordx2 v[64:65], v39, s[20:23], s47 offen sc1
s_add_u32 s47, s47, 512
LE_nf11:
s_waitcnt lgkmcnt(0)
ds_read2_b32 v[56:57], v34 offset0:48 offset1:52
ds_read2_b32 v[58:59], v34 offset0:56 offset1:60
v_mad_u32_u16 v60, v52, s49, v2
v_mad_u32_u16 v61, v53, s49, v2
v_mad_u32_u16 v62, v54, s49, v2
v_mad_u32_u16 v63, v55, s49, v2
buffer_load_dwordx4 a[64:67], v60, s[16:19], 0 offen
buffer_load_dwordx4 a[68:71], v60, s[16:19], 0 offen offset:256
buffer_load_dwordx4 a[72:75], v61, s[16:19], 0 offen
buffer_load_dwordx4 a[76:79], v61, s[16:19], 0 offen offset:256
buffer_load_dwordx4 a[80:83], v62, s[16:19], 0 offen
buffer_load_dwordx4 a[84:87], v62, s[16:19], 0 offen offset:256
buffer_load_dwordx4 a[88:91], v63, s[16:19], 0 offen
buffer_load_dwordx4 a[92:95], v63, s[16:19], 0 offen offset:256
s_waitcnt vmcnt(56)
v_mfma_f32_16x16x32_bf16 v[48:51], a[96:99], v[40:43], v[48:51]
v_mfma_f32_16x16x32_bf16 v[48:51], a[100:103], v[44:47], v[48:51]
s_bitcmp1_b32 s46, 12
s_cbranch_scc0 LE_nf12
s_cmp_eq_u32 s42, 0
s_cbranch_scc1 LE_fl12
buffer_load_dwordx2 v[66:67], v39, s[20:23], s47 offen sc1
s_waitcnt vmcnt(0)
v_lshlrev_b32 v64, 16, v66
v_and_b32 v65, 0xffff0000, v66
v_add_f32 v48, v48, v64
v_add_f32 v49, v49, v65
v_lshlrev_b32 v64, 16, v67
v_and_b32 v65, 0xffff0000, v67
v_add_f32 v50, v50, v64
v_add_f32 v51, v51, v65
LE_fl12:
s_nop 3
v_cvt_pk_bf16_f32 v64, v48, v49
v_cvt_pk_bf16_f32 v65, v50, v51
v_mov_b32 v48, 0
v_mov_b32 v49, 0
v_mov_b32 v50, 0
v_mov_b32 v51, 0
buffer_store_dwordx2 v[64:65], v39, s[20:23], s47 offen sc1
s_add_u32 s47, s47, 512
LE_nf12:
v_mfma_f32_16x16x32_bf16 v[48:51], a[104:107], v[40:43], v[48:51]
v_mfma_f32_16x16x32_bf16 v[48:51], a[108:111], v[44:47], v[48:51]
s_bitcmp1_b32 s46, 13
s_cbranch_scc0 LE_nf13
s_cmp_eq_u32 s42, 0
s_cbranch_scc1 LE_fl13
buffer_load_dwordx2 v[66:67], v39, s[20:23], s47 offen sc1
s_waitcnt vmcnt(0)
v_lshlrev_b32 v64, 16, v66
v_and_b32 v65, 0xffff0000, v66
v_add_f32 v48, v48, v64
v_add_f32 v49, v49, v65
v_lshlrev_b32 v64, 16, v67
v_and_b32 v65, 0xffff0000, v67
v_add_f32 v50, v50, v64
v_add_f32 v51, v51, v65
LE_fl13:
s_nop 3
v_cvt_pk_bf16_f32 v64, v48, v49
v_cvt_pk_bf16_f32 v65, v50, v51
v_mov_b32 v48, 0
v_mov_b32 v49, 0
v_mov_b32 v50, 0
v_mov_b32 v51, 0
buffer_store_dwordx2 v[64:65], v39, s[20:23], s47 offen sc1
s_add_u32 s47, s47, 512
LE_nf13:
v_mfma_f32_16x16x32_bf16 v[48:51], a[112:115], v[40:43], v[48:51]
v_mfma_f32_16x16x32_bf16 v[48:51], a[116:119], v[44:47], v[48:51]
s_bitcmp1_b32 s46, 14
s_cbranch_scc0 LE_nf14
s_cmp_eq_u32 s42, 0
s_cbranch_scc1 LE_fl14
buffer_load_dwordx2 v[66:67], v39, s[20:23], s47 offen sc1
s_waitcnt vmcnt(0)
v_lshlrev_b32 v64, 16, v66
v_and_b32 v65, 0xffff0000, v66
v_add_f32 v48, v48, v64
v_add_f32 v49, v49, v65
v_lshlrev_b32 v64, 16, v67
v_and_b32 v65, 0xffff0000, v67
v_add_f32 v50, v50, v64
v_add_f32 v51, v51, v65
LE_fl14:
s_nop 3
v_cvt_pk_bf16_f32 v64, v48, v49
v_cvt_pk_bf16_f32 v65, v50, v51
v_mov_b32 v48, 0
v_mov_b32 v49, 0
v_mov_b32 v50, 0
v_mov_b32 v51, 0
buffer_store_dwordx2 v[64:65], v39, s[20:23], s47 offen sc1
s_add_u32 s47, s47, 512
LE_nf14:
v_mfma_f32_16x16x32_bf16 v[48:51], a[120:123], v[40:43], v[48:51]
v_mfma_f32_16x16x32_bf16 v[48:51], a[124:127], v[44:47], v[48:51]
s_bitcmp1_b32 s46, 15
s_cbranch_scc0 LE_nf15
s_cmp_eq_u32 s42, 0
s_cbranch_scc1 LE_fl15
buffer_load_dwordx2 v[66:67], v39, s[20:23], s47 offen sc1
s_waitcnt vmcnt(0)
v_lshlrev_b32 v64, 16, v66
v_and_b32 v65, 0xffff0000, v66
v_add_f32 v48, v48, v64
v_add_f32 v49, v49, v65
v_lshlrev_b32 v64, 16, v67
v_and_b32 v65, 0xffff0000, v67
v_add_f32 v50, v50, v64
v_add_f32 v51, v51, v65
LE_fl15:
s_nop 3
v_cvt_pk_bf16_f32 v64, v48, v49
v_cvt_pk_bf16_f32 v65, v50, v51
v_mov_b32 v48, 0
v_mov_b32 v49, 0
v_mov_b32 v50, 0
v_mov_b32 v51, 0
buffer_store_dwordx2 v[64:65], v39, s[20:23], s47 offen sc1
s_add_u32 s47, s47, 512
LE_nf15:
s_waitcnt lgkmcnt(0)
ds_read2_b32 v[52:53], v34 offset0:64 offset1:68
ds_read2_b32 v[54:55], v34 offset0:72 offset1:76
v_mad_u32_u16 v60, v56, s49, v2
v_mad_u32_u16 v61, v57, s49, v2
v_mad_u32_u16 v62, v58, s49, v2
v_mad_u32_u16 v63, v59, s49, v2
buffer_load_dwordx4 a[96:99], v60, s[16:19], 0 offen
buffer_load_dwordx4 a[100:103], v60, s[16:19], 0 offen offset:256
buffer_load_dwordx4 a[104:107], v61, s[16:19], 0 offen
buffer_load_dwordx4 a[108:111], v61, s[16:19], 0 offen offset:256
buffer_load_dwordx4 a[112:115], v62, s[16:19], 0 offen
buffer_load_dwordx4 a[116:119], v62, s[16:19], 0 offen offset:256
buffer_load_dwordx4 a[120:123], v63, s[16:19], 0 offen
buffer_load_dwordx4 a[124:127], v63, s[16:19], 0 offen offset:256
s_waitcnt vmcnt(56)
v_mfma_f32_16x16x32_bf16 v[48:51], a[128:131], v[40:43], v[48:51]
v_mfma_f32_16x16x32_bf16 v[48:51], a[132:135], v[44:47], v[48:51]
s_bitcmp1_b32 s46, 16
s_cbranch_scc0 LE_nf16
s_cmp_eq_u32 s42, 0
s_cbranch_scc1 LE_fl16
buffer_load_dwordx2 v[66:67], v39, s[20:23], s47 offen sc1
s_waitcnt vmcnt(0)
v_lshlrev_b32 v64, 16, v66
v_and_b32 v65, 0xffff0000, v66
v_add_f32 v48, v48, v64
v_add_f32 v49, v49, v65
v_lshlrev_b32 v64, 16, v67
v_and_b32 v65, 0xffff0000, v67
v_add_f32 v50, v50, v64
v_add_f32 v51, v51, v65
LE_fl16:
s_nop 3
v_cvt_pk_bf16_f32 v64, v48, v49
v_cvt_pk_bf16_f32 v65, v50, v51
v_mov_b32 v48, 0
v_mov_b32 v49, 0
v_mov_b32 v50, 0
v_mov_b32 v51, 0
buffer_store_dwordx2 v[64:65], v39, s[20:23], s47 offen sc1
s_add_u32 s47, s47, 512
LE_nf16:
v_mfma_f32_16x16x32_bf16 v[48:51], a[136:139], v[40:43], v[48:51]
v_mfma_f32_16x16x32_bf16 v[48:51], a[140:143], v[44:47], v[48:51]
s_bitcmp1_b32 s46, 17
s_cbranch_scc0 LE_nf17
s_cmp_eq_u32 s42, 0
s_cbranch_scc1 LE_fl17
buffer_load_dwordx2 v[66:67], v39, s[20:23], s47 offen sc1
s_waitcnt vmcnt(0)
v_lshlrev_b32 v64, 16, v66
v_and_b32 v65, 0xffff0000, v66
v_add_f32 v48, v48, v64
v_add_f32 v49, v49, v65
v_lshlrev_b32 v64, 16, v67
v_and_b32 v65, 0xffff0000, v67
v_add_f32 v50, v50, v64
v_add_f32 v51, v51, v65
LE_fl17:
s_nop 3
v_cvt_pk_bf16_f32 v64, v48, v49
v_cvt_pk_bf16_f32 v65, v50, v51
v_mov_b32 v48, 0
v_mov_b32 v49, 0
v_mov_b32 v50, 0
v_mov_b32 v51, 0
buffer_store_dwordx2 v[64:65], v39, s[20:23], s47 offen sc1
s_add_u32 s47, s47, 512
LE_nf17:
v_mfma_f32_16x16x32_bf16 v[48:51], a[144:147], v[40:43], v[48:51]
v_mfma_f32_16x16x32_bf16 v[48:51], a[148:151], v[44:47], v[48:51]
s_bitcmp1_b32 s46, 18
s_cbranch_scc0 LE_nf18
s_cmp_eq_u32 s42, 0
s_cbranch_scc1 LE_fl18
buffer_load_dwordx2 v[66:67], v39, s[20:23], s47 offen sc1
s_waitcnt vmcnt(0)
v_lshlrev_b32 v64, 16, v66
v_and_b32 v65, 0xffff0000, v66
v_add_f32 v48, v48, v64
v_add_f32 v49, v49, v65
v_lshlrev_b32 v64, 16, v67
v_and_b32 v65, 0xffff0000, v67
v_add_f32 v50, v50, v64
v_add_f32 v51, v51, v65
LE_fl18:
s_nop 3
v_cvt_pk_bf16_f32 v64, v48, v49
v_cvt_pk_bf16_f32 v65, v50, v51
v_mov_b32 v48, 0
v_mov_b32 v49, 0
v_mov_b32 v50, 0
v_mov_b32 v51, 0
buffer_store_dwordx2 v[64:65], v39, s[20:23], s47 offen sc1
s_add_u32 s47, s47, 512
LE_nf18:
v_mfma_f32_16x16x32_bf16 v[48:51], a[152:155], v[40:43], v[48:51]
v_mfma_f32_16x16x32_bf16 v[48:51], a[156:159], v[44:47], v[48:51]
s_bitcmp1_b32 s46, 19
s_cbranch_scc0 LE_nf19
s_cmp_eq_u32 s42, 0
s_cbranch_scc1 LE_fl19
buffer_load_dwordx2 v[66:67], v39, s[20:23], s47 offen sc1
s_waitcnt vmcnt(0)
v_lshlrev_b32 v64, 16, v66
v_and_b32 v65, 0xffff0000, v66
v_add_f32 v48, v48, v64
v_add_f32 v49, v49, v65
v_lshlrev_b32 v64, 16, v67
v_and_b32 v65, 0xffff0000, v67
v_add_f32 v50, v50, v64
v_add_f32 v51, v51, v65
LE_fl19:
s_nop 3
v_cvt_pk_bf16_f32 v64, v48, v49
v_cvt_pk_bf16_f32 v65, v50, v51
v_mov_b32 v48, 0
v_mov_b32 v49, 0
v_mov_b32 v50, 0
v_mov_b32 v51, 0
buffer_store_dwordx2 v[64:65], v39, s[20:23], s47 offen sc1
s_add_u32 s47, s47, 512
LE_nf19:
s_waitcnt lgkmcnt(0)
ds_read2_b32 v[56:57], v34 offset0:80 offset1:84
ds_read2_b32 v[58:59], v34 offset0:88 offset1:92
v_mad_u32_u16 v60, v52, s49, v2
v_mad_u32_u16 v61, v53, s49, v2
v_mad_u32_u16 v62, v54, s49, v2
v_mad_u32_u16 v63, v55, s49, v2
buffer_load_dwordx4 a[128:131], v60, s[16:19], 0 offen
buffer_load_dwordx4 a[132:135], v60, s[16:19], 0 offen offset:256
buffer_load_dwordx4 a[136:139], v61, s[16:19], 0 offen
buffer_load_dwordx4 a[140:143], v61, s[16:19], 0 offen offset:256
buffer_load_dwordx4 a[144:147], v62, s[16:19], 0 offen
buffer_load_dwordx4 a[148:151], v62, s[16:19], 0 offen offset:256
buffer_load_dwordx4 a[152:155], v63, s[16:19], 0 offen
buffer_load_dwordx4 a[156:159], v63, s[16:19], 0 offen offset:256
s_waitcnt vmcnt(56)
v_mfma_f32_16x16x32_bf16 v[48:51], a[160:163], v[40:43], v[48:51]
v_mfma_f32_16x16x32_bf16 v[48:51], a[164:167], v[44:47], v[48:51]
s_bitcmp1_b32 s46, 20
s_cbranch_scc0 LE_nf20
s_cmp_eq_u32 s42, 0
s_cbranch_scc1 LE_fl20
buffer_load_dwordx2 v[66:67], v39, s[20:23], s47 offen sc1
s_waitcnt vmcnt(0)
v_lshlrev_b32 v64, 16, v66
v_and_b32 v65, 0xffff0000, v66
v_add_f32 v48, v48, v64
v_add_f32 v49, v49, v65
v_lshlrev_b32 v64, 16, v67
v_and_b32 v65, 0xffff0000, v67
v_add_f32 v50, v50, v64
v_add_f32 v51, v51, v65
LE_fl20:
s_nop 3
v_cvt_pk_bf16_f32 v64, v48, v49
v_cvt_pk_bf16_f32 v65, v50, v51
v_mov_b32 v48, 0
v_mov_b32 v49, 0
v_mov_b32 v50, 0
v_mov_b32 v51, 0
buffer_store_dwordx2 v[64:65], v39, s[20:23], s47 offen sc1
s_add_u32 s47, s47, 512
LE_nf20:
v_mfma_f32_16x16x32_bf16 v[48:51], a[168:171], v[40:43], v[48:51]
v_mfma_f32_16x16x32_bf16 v[48:51], a[172:175], v[44:47], v[48:51]
s_bitcmp1_b32 s46, 21
s_cbranch_scc0 LE_nf21
s_cmp_eq_u32 s42, 0
s_cbranch_scc1 LE_fl21
buffer_load_dwordx2 v[66:67], v39, s[20:23], s47 offen sc1
s_waitcnt vmcnt(0)
v_lshlrev_b32 v64, 16, v66
v_and_b32 v65, 0xffff0000, v66
v_add_f32 v48, v48, v64
v_add_f32 v49, v49, v65
v_lshlrev_b32 v64, 16, v67
v_and_b32 v65, 0xffff0000, v67
v_add_f32 v50, v50, v64
v_add_f32 v51, v51, v65
LE_fl21:
s_nop 3
v_cvt_pk_bf16_f32 v64, v48, v49
v_cvt_pk_bf16_f32 v65, v50, v51
v_mov_b32 v48, 0
v_mov_b32 v49, 0
v_mov_b32 v50, 0
v_mov_b32 v51, 0
buffer_store_dwordx2 v[64:65], v39, s[20:23], s47 offen sc1
s_add_u32 s47, s47, 512
LE_nf21:
v_mfma_f32_16x16x32_bf16 v[48:51], a[176:179], v[40:43], v[48:51]
v_mfma_f32_16x16x32_bf16 v[48:51], a[180:183], v[44:47], v[48:51]
s_bitcmp1_b32 s46, 22
s_cbranch_scc0 LE_nf22
s_cmp_eq_u32 s42, 0
s_cbranch_scc1 LE_fl22
buffer_load_dwordx2 v[66:67], v39, s[20:23], s47 offen sc1
s_waitcnt vmcnt(0)
v_lshlrev_b32 v64, 16, v66
v_and_b32 v65, 0xffff0000, v66
v_add_f32 v48, v48, v64
v_add_f32 v49, v49, v65
v_lshlrev_b32 v64, 16, v67
v_and_b32 v65, 0xffff0000, v67
v_add_f32 v50, v50, v64
v_add_f32 v51, v51, v65
LE_fl22:
s_nop 3
v_cvt_pk_bf16_f32 v64, v48, v49
v_cvt_pk_bf16_f32 v65, v50, v51
v_mov_b32 v48, 0
v_mov_b32 v49, 0
v_mov_b32 v50, 0
v_mov_b32 v51, 0
buffer_store_dwordx2 v[64:65], v39, s[20:23], s47 offen sc1
s_add_u32 s47, s47, 512
LE_nf22:
v_mfma_f32_16x16x32_bf16 v[48:51], a[184:187], v[40:43], v[48:51]
v_mfma_f32_16x16x32_bf16 v[48:51], a[188:191], v[44:47], v[48:51]
s_bitcmp1_b32 s46, 23
s_cbranch_scc0 LE_nf23
s_cmp_eq_u32 s42, 0
s_cbranch_scc1 LE_fl23
buffer_load_dwordx2 v[66:67], v39, s[20:23], s47 offen sc1
s_waitcnt vmcnt(0)
v_lshlrev_b32 v64, 16, v66
v_and_b32 v65, 0xffff0000, v66
v_add_f32 v48, v48, v64
v_add_f32 v49, v49, v65
v_lshlrev_b32 v64, 16, v67
v_and_b32 v65, 0xffff0000, v67
v_add_f32 v50, v50, v64
v_add_f32 v51, v51, v65
LE_fl23:
s_nop 3
v_cvt_pk_bf16_f32 v64, v48, v49
v_cvt_pk_bf16_f32 v65, v50, v51
v_mov_b32 v48, 0
v_mov_b32 v49, 0
v_mov_b32 v50, 0
v_mov_b32 v51, 0
buffer_store_dwordx2 v[64:65], v39, s[20:23], s47 offen sc1
s_add_u32 s47, s47, 512
LE_nf23:
s_waitcnt lgkmcnt(0)
ds_read2_b32 v[52:53], v34 offset0:96 offset1:100
ds_read2_b32 v[54:55], v34 offset0:104 offset1:108
v_mad_u32_u16 v60, v56, s49, v2
v_mad_u32_u16 v61, v57, s49, v2
v_mad_u32_u16 v62, v58, s49, v2
v_mad_u32_u16 v63, v59, s49, v2
buffer_load_dwordx4 a[160:163], v60, s[16:19], 0 offen
buffer_load_dwordx4 a[164:167], v60, s[16:19], 0 offen offset:256
buffer_load_dwordx4 a[168:171], v61, s[16:19], 0 offen
buffer_load_dwordx4 a[172:175], v61, s[16:19], 0 offen offset:256
buffer_load_dwordx4 a[176:179], v62, s[16:19], 0 offen
buffer_load_dwordx4 a[180:183], v62, s[16:19], 0 offen offset:256
buffer_load_dwordx4 a[184:187], v63, s[16:19], 0 offen
buffer_load_dwordx4 a[188:191], v63, s[16:19], 0 offen offset:256
s_waitcnt vmcnt(56)
v_mfma_f32_16x16x32_bf16 v[48:51], a[192:195], v[40:43], v[48:51]
v_mfma_f32_16x16x32_bf16 v[48:51], a[196:199], v[44:47], v[48:51]
s_bitcmp1_b32 s46, 24
s_cbranch_scc0 LE_nf24
s_cmp_eq_u32 s42, 0
s_cbranch_scc1 LE_fl24
buffer_load_dwordx2 v[66:67], v39, s[20:23], s47 offen sc1
s_waitcnt vmcnt(0)
v_lshlrev_b32 v64, 16, v66
v_and_b32 v65, 0xffff0000, v66
v_add_f32 v48, v48, v64
v_add_f32 v49, v49, v65
v_lshlrev_b32 v64, 16, v67
v_and_b32 v65, 0xffff0000, v67
v_add_f32 v50, v50, v64
v_add_f32 v51, v51, v65
LE_fl24:
s_nop 3
v_cvt_pk_bf16_f32 v64, v48, v49
v_cvt_pk_bf16_f32 v65, v50, v51
v_mov_b32 v48, 0
v_mov_b32 v49, 0
v_mov_b32 v50, 0
v_mov_b32 v51, 0
buffer_store_dwordx2 v[64:65], v39, s[20:23], s47 offen sc1
s_add_u32 s47, s47, 512
LE_nf24:
v_mfma_f32_16x16x32_bf16 v[48:51], a[200:203], v[40:43], v[48:51]
v_mfma_f32_16x16x32_bf16 v[48:51], a[204:207], v[44:47], v[48:51]
s_bitcmp1_b32 s46, 25
s_cbranch_scc0 LE_nf25
s_cmp_eq_u32 s42, 0
s_cbranch_scc1 LE_fl25
buffer_load_dwordx2 v[66:67], v39, s[20:23], s47 offen sc1
s_waitcnt vmcnt(0)
v_lshlrev_b32 v64, 16, v66
v_and_b32 v65, 0xffff0000, v66
v_add_f32 v48, v48, v64
v_add_f32 v49, v49, v65
v_lshlrev_b32 v64, 16, v67
v_and_b32 v65, 0xffff0000, v67
v_add_f32 v50, v50, v64
v_add_f32 v51, v51, v65
LE_fl25:
s_nop 3
v_cvt_pk_bf16_f32 v64, v48, v49
v_cvt_pk_bf16_f32 v65, v50, v51
v_mov_b32 v48, 0
v_mov_b32 v49, 0
v_mov_b32 v50, 0
v_mov_b32 v51, 0
buffer_store_dwordx2 v[64:65], v39, s[20:23], s47 offen sc1
s_add_u32 s47, s47, 512
LE_nf25:
v_mfma_f32_16x16x32_bf16 v[48:51], a[208:211], v[40:43], v[48:51]
v_mfma_f32_16x16x32_bf16 v[48:51], a[212:215], v[44:47], v[48:51]
s_bitcmp1_b32 s46, 26
s_cbranch_scc0 LE_nf26
s_cmp_eq_u32 s42, 0
s_cbranch_scc1 LE_fl26
buffer_load_dwordx2 v[66:67], v39, s[20:23], s47 offen sc1
s_waitcnt vmcnt(0)
v_lshlrev_b32 v64, 16, v66
v_and_b32 v65, 0xffff0000, v66
v_add_f32 v48, v48, v64
v_add_f32 v49, v49, v65
v_lshlrev_b32 v64, 16, v67
v_and_b32 v65, 0xffff0000, v67
v_add_f32 v50, v50, v64
v_add_f32 v51, v51, v65
LE_fl26:
s_nop 3
v_cvt_pk_bf16_f32 v64, v48, v49
v_cvt_pk_bf16_f32 v65, v50, v51
v_mov_b32 v48, 0
v_mov_b32 v49, 0
v_mov_b32 v50, 0
v_mov_b32 v51, 0
buffer_store_dwordx2 v[64:65], v39, s[20:23], s47 offen sc1
s_add_u32 s47, s47, 512
LE_nf26:
v_mfma_f32_16x16x32_bf16 v[48:51], a[216:219], v[40:43], v[48:51]
v_mfma_f32_16x16x32_bf16 v[48:51], a[220:223], v[44:47], v[48:51]
s_bitcmp1_b32 s46, 27
s_cbranch_scc0 LE_nf27
s_cmp_eq_u32 s42, 0
s_cbranch_scc1 LE_fl27
buffer_load_dwordx2 v[66:67], v39, s[20:23], s47 offen sc1
s_waitcnt vmcnt(0)
v_lshlrev_b32 v64, 16, v66
v_and_b32 v65, 0xffff0000, v66
v_add_f32 v48, v48, v64
v_add_f32 v49, v49, v65
v_lshlrev_b32 v64, 16, v67
v_and_b32 v65, 0xffff0000, v67
v_add_f32 v50, v50, v64
v_add_f32 v51, v51, v65
LE_fl27:
s_nop 3
v_cvt_pk_bf16_f32 v64, v48, v49
v_cvt_pk_bf16_f32 v65, v50, v51
v_mov_b32 v48, 0
v_mov_b32 v49, 0
v_mov_b32 v50, 0
v_mov_b32 v51, 0
buffer_store_dwordx2 v[64:65], v39, s[20:23], s47 offen sc1
s_add_u32 s47, s47, 512
LE_nf27:
s_waitcnt lgkmcnt(0)
ds_read2_b32 v[56:57], v34 offset0:112 offset1:116
ds_read2_b32 v[58:59], v34 offset0:120 offset1:124
v_mad_u32_u16 v60, v52, s49, v2
v_mad_u32_u16 v61, v53, s49, v2
v_mad_u32_u16 v62, v54, s49, v2
v_mad_u32_u16 v63, v55, s49, v2
buffer_load_dwordx4 a[192:195], v60, s[16:19], 0 offen
buffer_load_dwordx4 a[196:199], v60, s[16:19], 0 offen offset:256
buffer_load_dwordx4 a[200:203], v61, s[16:19], 0 offen
buffer_load_dwordx4 a[204:207], v61, s[16:19], 0 offen offset:256
buffer_load_dwordx4 a[208:211], v62, s[16:19], 0 offen
buffer_load_dwordx4 a[212:215], v62, s[16:19], 0 offen offset:256
buffer_load_dwordx4 a[216:219], v63, s[16:19], 0 offen
buffer_load_dwordx4 a[220:223], v63, s[16:19], 0 offen offset:256
s_waitcnt vmcnt(56)
v_mfma_f32_16x16x32_bf16 v[48:51], a[224:227], v[40:43], v[48:51]
v_mfma_f32_16x16x32_bf16 v[48:51], a[228:231], v[44:47], v[48:51]
s_bitcmp1_b32 s46, 28
s_cbranch_scc0 LE_nf28
s_cmp_eq_u32 s42, 0
s_cbranch_scc1 LE_fl28
buffer_load_dwordx2 v[66:67], v39, s[20:23], s47 offen sc1
s_waitcnt vmcnt(0)
v_lshlrev_b32 v64, 16, v66
v_and_b32 v65, 0xffff0000, v66
v_add_f32 v48, v48, v64
v_add_f32 v49, v49, v65
v_lshlrev_b32 v64, 16, v67
v_and_b32 v65, 0xffff0000, v67
v_add_f32 v50, v50, v64
v_add_f32 v51, v51, v65
LE_fl28:
s_nop 3
v_cvt_pk_bf16_f32 v64, v48, v49
v_cvt_pk_bf16_f32 v65, v50, v51
v_mov_b32 v48, 0
v_mov_b32 v49, 0
v_mov_b32 v50, 0
v_mov_b32 v51, 0
buffer_store_dwordx2 v[64:65], v39, s[20:23], s47 offen sc1
s_add_u32 s47, s47, 512
LE_nf28:
v_mfma_f32_16x16x32_bf16 v[48:51], a[232:235], v[40:43], v[48:51]
v_mfma_f32_16x16x32_bf16 v[48:51], a[236:239], v[44:47], v[48:51]
s_bitcmp1_b32 s46, 29
s_cbranch_scc0 LE_nf29
s_cmp_eq_u32 s42, 0
s_cbranch_scc1 LE_fl29
buffer_load_dwordx2 v[66:67], v39, s[20:23], s47 offen sc1
s_waitcnt vmcnt(0)
v_lshlrev_b32 v64, 16, v66
v_and_b32 v65, 0xffff0000, v66
v_add_f32 v48, v48, v64
v_add_f32 v49, v49, v65
v_lshlrev_b32 v64, 16, v67
v_and_b32 v65, 0xffff0000, v67
v_add_f32 v50, v50, v64
v_add_f32 v51, v51, v65
LE_fl29:
s_nop 3
v_cvt_pk_bf16_f32 v64, v48, v49
v_cvt_pk_bf16_f32 v65, v50, v51
v_mov_b32 v48, 0
v_mov_b32 v49, 0
v_mov_b32 v50, 0
v_mov_b32 v51, 0
buffer_store_dwordx2 v[64:65], v39, s[20:23], s47 offen sc1
s_add_u32 s47, s47, 512
LE_nf29:
v_mfma_f32_16x16x32_bf16 v[48:51], a[240:243], v[40:43], v[48:51]
v_mfma_f32_16x16x32_bf16 v[48:51], a[244:247], v[44:47], v[48:51]
s_bitcmp1_b32 s46, 30
s_cbranch_scc0 LE_nf30
s_cmp_eq_u32 s42, 0
s_cbranch_scc1 LE_fl30
buffer_load_dwordx2 v[66:67], v39, s[20:23], s47 offen sc1
s_waitcnt vmcnt(0)
v_lshlrev_b32 v64, 16, v66
v_and_b32 v65, 0xffff0000, v66
v_add_f32 v48, v48, v64
v_add_f32 v49, v49, v65
v_lshlrev_b32 v64, 16, v67
v_and_b32 v65, 0xffff0000, v67
v_add_f32 v50, v50, v64
v_add_f32 v51, v51, v65
LE_fl30:
s_nop 3
v_cvt_pk_bf16_f32 v64, v48, v49
v_cvt_pk_bf16_f32 v65, v50, v51
v_mov_b32 v48, 0
v_mov_b32 v49, 0
v_mov_b32 v50, 0
v_mov_b32 v51, 0
buffer_store_dwordx2 v[64:65], v39, s[20:23], s47 offen sc1
s_add_u32 s47, s47, 512
LE_nf30:
v_mfma_f32_16x16x32_bf16 v[48:51], a[248:251], v[40:43], v[48:51]
v_mfma_f32_16x16x32_bf16 v[48:51], a[252:255], v[44:47], v[48:51]
s_bitcmp1_b32 s46, 31
s_cbranch_scc0 LE_nf31
s_cmp_eq_u32 s42, 0
s_cbranch_scc1 LE_fl31
buffer_load_dwordx2 v[66:67], v39, s[20:23], s47 offen sc1
s_waitcnt vmcnt(0)
v_lshlrev_b32 v64, 16, v66
v_and_b32 v65, 0xffff0000, v66
v_add_f32 v48, v48, v64
v_add_f32 v49, v49, v65
v_lshlrev_b32 v64, 16, v67
v_and_b32 v65, 0xffff0000, v67
v_add_f32 v50, v50, v64
v_add_f32 v51, v51, v65
LE_fl31:
s_nop 3
v_cvt_pk_bf16_f32 v64, v48, v49
v_cvt_pk_bf16_f32 v65, v50, v51
v_mov_b32 v48, 0
v_mov_b32 v49, 0
v_mov_b32 v50, 0
v_mov_b32 v51, 0
buffer_store_dwordx2 v[64:65], v39, s[20:23], s47 offen sc1
s_add_u32 s47, s47, 512
LE_nf31:
s_waitcnt lgkmcnt(0)
ds_read2_b32 v[52:53], v34 offset0:128 offset1:132
ds_read2_b32 v[54:55], v34 offset0:136 offset1:140
v_mad_u32_u16 v60, v56, s49, v2
v_mad_u32_u16 v61, v57, s49, v2
v_mad_u32_u16 v62, v58, s49, v2
v_mad_u32_u16 v63, v59, s49, v2
buffer_load_dwordx4 a[224:227], v60, s[16:19], 0 offen
buffer_load_dwordx4 a[228:231], v60, s[16:19], 0 offen offset:256
buffer_load_dwordx4 a[232:235], v61, s[16:19], 0 offen
buffer_load_dwordx4 a[236:239], v61, s[16:19], 0 offen offset:256
buffer_load_dwordx4 a[240:243], v62, s[16:19], 0 offen
buffer_load_dwordx4 a[244:247], v62, s[16:19], 0 offen offset:256
buffer_load_dwordx4 a[248:251], v63, s[16:19], 0 offen
buffer_load_dwordx4 a[252:255], v63, s[16:19], 0 offen offset:256
v_add_u32 v34, 512, v34
s_cmp_lt_u32 s45, s44
s_cbranch_scc1 LE_loop
s_add_u32 s42, s42, 1
s_mul_i32 s43, s42, 128
v_cmp_lt_u32 vcc, s43, v4
s_cbranch_vccz LE_done
s_cmp_ge_u32 s42, 40
s_cbranch_scc1 LE_done
s_waitcnt vmcnt(0) lgkmcnt(0)
s_add_u32 s50, s50, 512
v_add_u32 v5, 0x80, v5
buffer_load_dwordx4 v[192:195], v6, s[12:15], s50 offen offset:0
buffer_load_dwordx4 v[196:199], v6, s[12:15], s50 offen offset:32
buffer_load_dwordx4 v[200:203], v6, s[12:15], s50 offen offset:64
buffer_load_dwordx4 v[204:207], v6, s[12:15], s50 offen offset:96
buffer_load_dwordx4 v[208:211], v6, s[12:15], s50 offen offset:128
buffer_load_dwordx4 v[212:215], v6, s[12:15], s50 offen offset:160
buffer_load_dwordx4 v[216:219], v6, s[12:15], s50 offen offset:192
buffer_load_dwordx4 v[220:223], v6, s[12:15], s50 offen offset:224
buffer_load_dwordx4 v[224:227], v6, s[12:15], s50 offen offset:256
buffer_load_dwordx4 v[228:231], v6, s[12:15], s50 offen offset:288
buffer_load_dwordx4 v[232:235], v6, s[12:15], s50 offen offset:320
buffer_load_dwordx4 v[236:239], v6, s[12:15], s50 offen offset:352
buffer_load_dwordx4 v[240:243], v6, s[12:15], s50 offen offset:384
buffer_load_dwordx4 v[244:247], v6, s[12:15], s50 offen offset:416
buffer_load_dwordx4 v[248:251], v6, s[12:15], s50 offen offset:448
buffer_load_dwordx4 v[252:255], v6, s[12:15], s50 offen offset:480
s_branch LE_pass
LE_done:
s_add_u32 s24, s4, 0x7c00000
s_addc_u32 s25, s5, 0
s_mov_b32 s26, 0x40000
s_mov_b32 s27, 0x00020000
s_add_u32 s48, s40, 1280
s_mul_i32 s48, s48, 128
s_waitcnt vmcnt(0)
v_mov_b32 v33, 1
s_mov_b64 exec, 1
buffer_store_dword v33, off, s[24:27], s48 sc1
s_mov_b64 exec, -1
s_branch L2_end
L2_fin:
L2_end:
s_endpgm
.section .rodata,"a"
.p2align 6
.amdhsa_kernel k1_kernel
  .amdhsa_next_free_vgpr 256
  .amdhsa_next_free_sgpr 102
  .amdhsa_accum_offset 256
  .amdhsa_group_segment_fixed_size 0
  .amdhsa_kernarg_size 96
  .amdhsa_user_sgpr_count 2
  .amdhsa_user_sgpr_kernarg_segment_ptr 1
  .amdhsa_system_sgpr_workgroup_id_x 1
.end_amdhsa_kernel
.p2align 6
.amdhsa_kernel k2_kernel
  .amdhsa_next_free_vgpr 512
  .amdhsa_next_free_sgpr 102
  .amdhsa_accum_offset 256
  .amdhsa_group_segment_fixed_size 0
  .amdhsa_kernarg_size 96
  .amdhsa_user_sgpr_count 2
  .amdhsa_user_sgpr_kernarg_segment_ptr 1
  .amdhsa_system_sgpr_workgroup_id_x 1
.end_amdhsa_kernel
```

```asm
; @launch grid=(256,1,1) block=(256,1,1) lds=163840
.amdgcn_target "amdgcn-amd-amdhsa--gfx950"
.text
.globl standalone__hybrid_graph_tf_graphgps__graph_kernel
.p2align 8
.type standalone__hybrid_graph_tf_graphgps__graph_kernel,@function
standalone__hybrid_graph_tf_graphgps__graph_kernel:
s_getpc_b64 s[56:57]
s_load_dwordx16 s[16:31], s[0:1], 0
s_load_dwordx8 s[32:39], s[0:1], 64
s_cmp_ge_u32 s2, 256
s_cbranch_scc1 L2_end
v_lshrrev_b32 v1, 6, v0
v_and_b32 v2, 63, v0
s_lshr_b32 s3, s2, 3
s_add_u32 s3, s3, 30
s_and_b32 s3, s3, 31
v_readfirstlane_b32 s60, v1
s_lshl_b32 s5, s3, 2
s_add_u32 s5, s5, s60
s_and_b32 s56, s56, 0xffffff00
s_mov_b32 s58, L2_end-standalone__hybrid_graph_tf_graphgps__graph_kernel
s_mov_b32 s59, 0x00020000
s_and_b32 s6, s5, 15
s_lshl_b32 s6, s6, 13
v_lshlrev_b32 v10, 7, v2
buffer_load_dword v255, v10, s[56:59], s6 offen
v_and_b32 v3, 15, v2
v_lshrrev_b32 v4, 4, v2
s_and_b32 s62, s3, 7
s_mov_b64 s[14:15], 0
s_and_b32 s8, s2, 7
s_cmp_ge_u32 s3, 30
s_cbranch_scc1 LM_edge
s_mul_i32 s12, s3, 26
s_lshr_b32 s12, s12, 8
s_mul_i32 s9, s12, 10
s_sub_u32 s9, s3, s9
s_and_b32 s13, s8, 1
s_mul_i32 s13, s13, 3
s_add_u32 s13, s13, s12
s_lshr_b32 s12, s8, 1
s_mul_i32 s12, s12, 10
s_add_u32 s12, s12, s9
s_mul_i32 s91, s12, 6
s_add_u32 s91, s91, s13
s_mov_b32 s61, 0
s_cmp_eq_u32 s12, 39
s_cbranch_scc1 LM_light
s_mul_i32 s14, s13, 3
s_min_u32 s14, s14, 14
s_lshl_b32 s9, s12, 4
s_add_u32 s14, s14, s9
s_lshl_b32 s14, s14, 13
s_cmp_eq_u32 s91, 233
s_cselect_b32 s9, 0, s13
s_cmp_lt_u32 s9, 4
s_cselect_b32 s15, 3, 2
s_lshl_b32 s15, s15, 13
s_add_u32 s15, s15, s14
v_lshlrev_b32 v16, 4, v2
s_mul_i32 s63, s60, 12288
s_mov_b32 s6, s14
s_mul_i32 s7, s60, 6144
s_add_u32 s64, s6, s7
s_add_u32 s65, s64, 4096
s_lshl_b32 s7, s60, 7
v_lshrrev_b32 v5, 3, v2
v_and_b32 v6, 7, v2
v_and_b32 v7, 2, v5
v_xor_b32 v6, v6, v7
v_lshl_add_u32 v5, v5, 9, s7
v_lshl_add_u32 v17, v6, 4, v5
v_xor_b32 v6, 4, v6
v_lshl_add_u32 v18, v6, 4, v5
v_add_u32 v18, 0xc00, v18
v_add_u32 v19, 0x1800, v17
v_add_u32 v20, 0x1800, v18
s_xor_b32 s6, s62, 0
s_lshl_b32 s66, s6, 14
s_xor_b32 s6, s62, 1
s_lshl_b32 s67, s6, 14
s_xor_b32 s6, s62, 2
s_lshl_b32 s68, s6, 14
s_xor_b32 s6, s62, 3
s_lshl_b32 s69, s6, 14
s_xor_b32 s6, s62, 4
s_lshl_b32 s70, s6, 14
s_xor_b32 s6, s62, 5
s_lshl_b32 s71, s6, 14
s_xor_b32 s6, s62, 6
s_lshl_b32 s72, s6, 14
s_xor_b32 s6, s62, 7
s_lshl_b32 s73, s6, 14
s_waitcnt lgkmcnt(0)
s_add_u32 s40, s16, 0x0
s_addc_u32 s41, s17, 0
s_mov_b32 s42, s15
s_mov_b32 s43, 0x00020000
s_add_u32 s44, s26, 0x0
s_addc_u32 s45, s27, 0
s_mov_b32 s46, 0x20000
s_mov_b32 s47, 0x00020000
buffer_load_dwordx4 v[44:47], v16, s[40:43], s64 offen offset:0
buffer_load_dwordx4 v[48:51], v16, s[40:43], s64 offen offset:1024
buffer_load_dwordx4 v[52:55], v16, s[40:43], s64 offen offset:2048
buffer_load_dwordx4 v[56:59], v16, s[40:43], s64 offen offset:3072
buffer_load_dwordx4 v[60:63], v16, s[40:43], s65 offen offset:0
buffer_load_dwordx4 v[64:67], v16, s[40:43], s65 offen offset:1024
s_add_u32 m0, s63, 0x0
s_nop 0
buffer_load_dwordx4 v17, s[44:47], s66 offen offset:0 lds
buffer_load_dwordx4 v18, s[44:47], s66 offen offset:1024 lds
buffer_load_dwordx4 v19, s[44:47], s66 offen offset:2048 lds
buffer_load_dwordx4 v20, s[44:47], s66 offen offset:3072 lds
s_add_u32 m0, s63, 0x1000
s_nop 0
buffer_load_dwordx4 v17, s[44:47], s67 offen offset:0 lds
buffer_load_dwordx4 v18, s[44:47], s67 offen offset:1024 lds
buffer_load_dwordx4 v19, s[44:47], s67 offen offset:2048 lds
buffer_load_dwordx4 v20, s[44:47], s67 offen offset:3072 lds
s_mov_b32 s98, 0x7c3ff80
s_load_dwordx2 s[98:99], s[38:39], s98
v_bfe_u32 v5, v2, 2, 3
v_xor_b32 v5, s62, v5
v_and_b32 v6, 3, v2
v_lshlrev_b32 v7, 10, v5
v_lshl_add_u32 v7, v6, 8, v7
v_add_u32 v7, 0xc000, v7
v_and_b32 v5, 1, v5
v_lshl_or_b32 v6, v5, 2, v6
v_lshrrev_b32 v5, 5, v2
s_mul_i32 s6, s60, 12
v_add3_u32 v8, v5, s6, 0
v_lshrrev_b32 v9, 4, v8
v_lshl_add_u32 v9, v9, 13, v7
v_and_b32 v8, 15, v8
v_xor_b32 v8, v8, v6
v_lshl_add_u32 v36, v8, 4, v9
v_add3_u32 v8, v5, s6, 2
v_lshrrev_b32 v9, 4, v8
v_lshl_add_u32 v9, v9, 13, v7
v_and_b32 v8, 15, v8
v_xor_b32 v8, v8, v6
v_lshl_add_u32 v37, v8, 4, v9
v_add3_u32 v8, v5, s6, 4
v_lshrrev_b32 v9, 4, v8
v_lshl_add_u32 v9, v9, 13, v7
v_and_b32 v8, 15, v8
v_xor_b32 v8, v8, v6
v_lshl_add_u32 v38, v8, 4, v9
v_add3_u32 v8, v5, s6, 6
v_lshrrev_b32 v9, 4, v8
v_lshl_add_u32 v9, v9, 13, v7
v_and_b32 v8, 15, v8
v_xor_b32 v8, v8, v6
v_lshl_add_u32 v39, v8, 4, v9
v_add3_u32 v8, v5, s6, 8
v_lshrrev_b32 v9, 4, v8
v_lshl_add_u32 v9, v9, 13, v7
v_and_b32 v8, 15, v8
v_xor_b32 v8, v8, v6
v_lshl_add_u32 v40, v8, 4, v9
v_add3_u32 v8, v5, s6, 10
v_lshrrev_b32 v9, 4, v8
v_lshl_add_u32 v9, v9, 13, v7
v_and_b32 v8, 15, v8
v_xor_b32 v8, v8, v6
v_lshl_add_u32 v41, v8, 4, v9
v_xor_b32 v5, v3, v4
v_lshlrev_b32 v5, 4, v5
v_lshl_add_u32 v5, v4, 8, v5
v_add_u32 v31, 0xc000, v5
v_xor_b32 v32, 64, v31
v_lshrrev_b32 v5, 2, v3
v_and_b32 v6, 3, v3
v_and_b32 v7, 1, v4
v_lshlrev_b32 v7, 2, v7
v_and_b32 v8, 2, v5
v_or_b32 v7, v7, v8
v_lshl_add_u32 v8, v4, 3, v5
v_lshlrev_b32 v8, 7, v8
v_add_u32 v8, s63, v8
v_and_b32 v9, 1, v6
v_lshl_add_u32 v8, v9, 3, v8
v_lshrrev_b32 v6, 1, v6
v_xor_b32 v6, v6, v7
v_xor_b32 v9, 0, v6
v_lshl_add_u32 v25, v9, 4, v8
v_xor_b32 v9, 2, v6
v_lshl_add_u32 v26, v9, 4, v8
v_xor_b32 v9, 4, v6
v_lshl_add_u32 v27, v9, 4, v8
v_xor_b32 v9, 6, v6
v_lshl_add_u32 v28, v9, 4, v8
v_lshrrev_b32 v5, 3, v2
v_and_b32 v6, 7, v2
v_lshrrev_b32 v7, 1, v5
v_xor_b32 v6, v6, v7
v_and_b32 v7, 4, v5
v_add_u32 v5, v5, v7
s_mul_i32 s6, s60, 32768
v_lshl_add_u32 v5, v5, 9, s6
v_lshl_add_u32 v21, v6, 4, v5
v_xor_b32 v6, 4, v6
v_lshl_add_u32 v22, v6, 4, v5
v_add_u32 v22, 0x1c00, v22
v_mov_b32 v23, v21
v_mov_b32 v24, v22
s_lshr_b32 s7, s62, 1
s_xor_b32 s6, s7, 0
s_lshl_b32 s74, s6, 7
s_add_u32 s75, s74, 16384
s_xor_b32 s6, s7, 1
s_lshl_b32 s76, s6, 7
s_add_u32 s77, s76, 16384
s_xor_b32 s6, s7, 2
s_lshl_b32 s78, s6, 7
s_add_u32 s79, s78, 16384
s_xor_b32 s6, s7, 3
s_lshl_b32 s80, s6, 7
s_add_u32 s81, s80, 16384
s_and_b32 s6, s62, 1
s_lshl_b32 s6, s6, 2
v_lshrrev_b32 v5, 1, v3
v_xor_b32 v5, v5, v4
v_xor_b32 v5, s6, v5
v_lshl_add_u32 v6, v3, 7, s63
v_lshl_add_u32 v29, v5, 4, v6
v_xor_b32 v30, 64, v29
s_mul_i32 s6, s60, 2
s_xor_b32 s6, s6, s62
s_lshl_b32 s6, s6, 10
s_add_u32 s6, s6, 0x12000
v_lshrrev_b32 v5, 1, v4
v_and_b32 v6, 1, v4
v_lshl_add_u32 v5, v5, 8, s6
v_lshl_add_u32 v5, v6, 3, v5
v_lshl_add_u32 v33, v3, 4, v5
v_xor_b32 v34, 0x400, v33
v_add_u32 v35, 0x12000, v16
s_mov_b32 s6, s14
s_mul_i32 s7, s60, 2048
s_add_u32 s82, s6, s7
s_add_u32 s83, s82, 8192
s_add_u32 s84, s82, 16384
s_mov_b32 s86, 0x3db8aa3b
s_mov_b32 s87, 0x3db8aa3b
s_mov_b32 s88, 0x3727c5ac
s_mov_b32 s89, 0x3b800000
s_mov_b32 s90, 0xffff0000
s_add_u32 s48, s28, 0x0
s_addc_u32 s49, s29, 0
s_mov_b32 s50, 0x20000
s_mov_b32 s51, 0x00020000
s_add_u32 s52, s38, 0x0
s_addc_u32 s53, s39, 0
s_mov_b32 s54, s15
s_mov_b32 s55, 0x00020000
s_add_u32 s56, s38, 0x6800000
s_addc_u32 s57, s39, 0
s_mov_b32 s58, s15
s_mov_b32 s59, 0x00020000
s_waitcnt vmcnt(13)
v_lshlrev_b32 v116, 16, v44
v_and_b32 v117, s90, v44
v_lshlrev_b32 v118, 16, v45
v_and_b32 v119, s90, v45
v_lshlrev_b32 v120, 16, v46
v_and_b32 v121, s90, v46
v_lshlrev_b32 v122, 16, v47
v_and_b32 v123, s90, v47
v_pk_add_f32 v[164:165], v[116:117], v[118:119]
v_pk_mul_f32 v[166:167], v[116:117], v[116:117]
v_pk_add_f32 v[44:45], v[120:121], v[122:123]
v_pk_fma_f32 v[166:167], v[118:119], v[118:119], v[166:167]
v_pk_add_f32 v[164:165], v[164:165], v[44:45]
v_pk_fma_f32 v[166:167], v[120:121], v[120:121], v[166:167]
v_add_f32 v164, v164, v165
v_pk_fma_f32 v[166:167], v[122:123], v[122:123], v[166:167]
v_add_f32 v166, v166, v167
s_waitcnt vmcnt(12)
v_lshlrev_b32 v124, 16, v48
v_and_b32 v125, s90, v48
v_lshlrev_b32 v126, 16, v49
v_and_b32 v127, s90, v49
v_lshlrev_b32 v128, 16, v50
v_and_b32 v129, s90, v50
v_lshlrev_b32 v130, 16, v51
v_and_b32 v131, s90, v51
v_pk_add_f32 v[168:169], v[124:125], v[126:127]
v_pk_mul_f32 v[170:171], v[124:125], v[124:125]
v_pk_add_f32 v[48:49], v[128:129], v[130:131]
v_pk_fma_f32 v[170:171], v[126:127], v[126:127], v[170:171]
v_pk_add_f32 v[168:169], v[168:169], v[48:49]
v_pk_fma_f32 v[170:171], v[128:129], v[128:129], v[170:171]
v_add_f32 v168, v168, v169
v_pk_fma_f32 v[170:171], v[130:131], v[130:131], v[170:171]
v_add_f32 v170, v170, v171
s_waitcnt vmcnt(11)
v_lshlrev_b32 v132, 16, v52
v_and_b32 v133, s90, v52
v_lshlrev_b32 v134, 16, v53
v_and_b32 v135, s90, v53
v_lshlrev_b32 v136, 16, v54
v_and_b32 v137, s90, v54
v_lshlrev_b32 v138, 16, v55
v_and_b32 v139, s90, v55
v_pk_add_f32 v[172:173], v[132:133], v[134:135]
v_pk_mul_f32 v[174:175], v[132:133], v[132:133]
v_pk_add_f32 v[52:53], v[136:137], v[138:139]
v_pk_fma_f32 v[174:175], v[134:135], v[134:135], v[174:175]
v_pk_add_f32 v[172:173], v[172:173], v[52:53]
v_pk_fma_f32 v[174:175], v[136:137], v[136:137], v[174:175]
v_add_f32 v172, v172, v173
v_pk_fma_f32 v[174:175], v[138:139], v[138:139], v[174:175]
v_add_f32 v174, v174, v175
s_waitcnt vmcnt(10)
v_lshlrev_b32 v140, 16, v56
v_and_b32 v141, s90, v56
v_lshlrev_b32 v142, 16, v57
v_and_b32 v143, s90, v57
v_lshlrev_b32 v144, 16, v58
v_and_b32 v145, s90, v58
v_lshlrev_b32 v146, 16, v59
v_and_b32 v147, s90, v59
v_pk_add_f32 v[176:177], v[140:141], v[142:143]
v_pk_mul_f32 v[178:179], v[140:141], v[140:141]
v_pk_add_f32 v[56:57], v[144:145], v[146:147]
v_pk_fma_f32 v[178:179], v[142:143], v[142:143], v[178:179]
v_pk_add_f32 v[176:177], v[176:177], v[56:57]
v_pk_fma_f32 v[178:179], v[144:145], v[144:145], v[178:179]
v_add_f32 v176, v176, v177
v_pk_fma_f32 v[178:179], v[146:147], v[146:147], v[178:179]
v_add_f32 v178, v178, v179
s_waitcnt vmcnt(9)
v_lshlrev_b32 v148, 16, v60
v_and_b32 v149, s90, v60
v_lshlrev_b32 v150, 16, v61
v_and_b32 v151, s90, v61
v_lshlrev_b32 v152, 16, v62
v_and_b32 v153, s90, v62
v_lshlrev_b32 v154, 16, v63
v_and_b32 v155, s90, v63
v_pk_add_f32 v[180:181], v[148:149], v[150:151]
v_pk_mul_f32 v[182:183], v[148:149], v[148:149]
v_pk_add_f32 v[60:61], v[152:153], v[154:155]
v_pk_fma_f32 v[182:183], v[150:151], v[150:151], v[182:183]
v_pk_add_f32 v[180:181], v[180:181], v[60:61]
v_pk_fma_f32 v[182:183], v[152:153], v[152:153], v[182:183]
v_add_f32 v180, v180, v181
v_pk_fma_f32 v[182:183], v[154:155], v[154:155], v[182:183]
v_add_f32 v182, v182, v183
s_waitcnt vmcnt(8)
v_lshlrev_b32 v156, 16, v64
v_and_b32 v157, s90, v64
v_lshlrev_b32 v158, 16, v65
v_and_b32 v159, s90, v65
v_lshlrev_b32 v160, 16, v66
v_and_b32 v161, s90, v66
v_lshlrev_b32 v162, 16, v67
v_and_b32 v163, s90, v67
v_pk_add_f32 v[184:185], v[156:157], v[158:159]
v_pk_mul_f32 v[186:187], v[156:157], v[156:157]
v_pk_add_f32 v[64:65], v[160:161], v[162:163]
v_pk_fma_f32 v[186:187], v[158:159], v[158:159], v[186:187]
v_pk_add_f32 v[184:185], v[184:185], v[64:65]
v_pk_fma_f32 v[186:187], v[160:161], v[160:161], v[186:187]
v_add_f32 v184, v184, v185
v_pk_fma_f32 v[186:187], v[162:163], v[162:163], v[186:187]
v_add_f32 v186, v186, v187
v_permlane16_swap_b32 v164, v166
v_permlane16_swap_b32 v168, v170
v_permlane16_swap_b32 v172, v174
v_permlane16_swap_b32 v176, v178
v_permlane16_swap_b32 v180, v182
v_permlane16_swap_b32 v184, v186
v_add_f32 v164, v164, v166
v_add_f32 v168, v168, v170
v_add_f32 v172, v172, v174
v_add_f32 v176, v176, v178
v_add_f32 v180, v180, v182
v_add_f32 v184, v184, v186
v_add_f32_dpp v165, v164, v164 row_ror:8 row_mask:0xf bank_mask:0x3
v_add_f32_dpp v165, v168, v168 row_ror:8 row_mask:0xf bank_mask:0xc
v_add_f32_dpp v173, v172, v172 row_ror:8 row_mask:0xf bank_mask:0x3
v_add_f32_dpp v173, v176, v176 row_ror:8 row_mask:0xf bank_mask:0xc
v_add_f32_dpp v181, v180, v180 row_ror:8 row_mask:0xf bank_mask:0x3
v_add_f32_dpp v181, v184, v184 row_ror:8 row_mask:0xf bank_mask:0xc
v_add_f32_dpp v166, v165, v165 row_half_mirror row_mask:0xf bank_mask:0x5
v_add_f32_dpp v166, v173, v173 row_half_mirror row_mask:0xf bank_mask:0xa
v_add_f32_dpp v182, v181, v181 row_half_mirror row_mask:0xf bank_mask:0xf
s_nop 0
v_add_f32_dpp v166, v166, v166 quad_perm:[1,0,3,2] row_mask:0xf bank_mask:0xf
v_add_f32_dpp v182, v182, v182 quad_perm:[1,0,3,2] row_mask:0xf bank_mask:0xf
s_nop 0
v_add_f32_dpp v166, v166, v166 quad_perm:[2,3,0,1] row_mask:0xf bank_mask:0xf
v_add_f32_dpp v182, v182, v182 quad_perm:[2,3,0,1] row_mask:0xf bank_mask:0xf
v_mov_b32 v167, v166
v_mov_b32 v183, v182
s_nop 0
v_permlane16_swap_b32 v167, v166
v_permlane16_swap_b32 v183, v182
v_mul_f32 v167, s89, v167
v_mul_f32 v183, s89, v183
v_mul_f32 v166, s89, v166
v_mul_f32 v182, s89, v182
v_fma_f32 v166, -v167, v167, v166
v_fma_f32 v182, -v183, v183, v182
v_cvt_pk_bf16_f32 v167, v167, v167
v_cvt_pk_bf16_f32 v183, v183, v183
v_max_f32 v166, 0, v166
v_max_f32 v182, 0, v182
v_cvt_pk_bf16_f32 v166, v166, v166
v_cvt_pk_bf16_f32 v182, v182, v182
v_and_b32 v166, s90, v166
v_and_b32 v182, s90, v182
v_add_f32 v166, s88, v166
v_add_f32 v182, s88, v182
v_cvt_pk_bf16_f32 v166, v166, v166
v_cvt_pk_bf16_f32 v182, v182, v182
v_and_b32 v166, s90, v166
v_and_b32 v182, s90, v182
v_sqrt_f32 v166, v166
v_sqrt_f32 v182, v182
v_and_b32 v167, s90, v167
v_and_b32 v183, s90, v183
v_cvt_pk_bf16_f32 v166, v166, v166
v_cvt_pk_bf16_f32 v182, v182, v182
v_and_b32 v166, s90, v166
v_and_b32 v182, s90, v182
v_rcp_f32 v166, v166
v_rcp_f32 v182, v182
v_mul_f32 v167, -v167, v166
v_mul_f32 v183, -v183, v182
s_nop 0
v_mov_b64_dpp v[164:165], v[166:167] row_newbcast:0 row_mask:0xf bank_mask:0xf
v_mov_b64_dpp v[168:169], v[166:167] row_newbcast:8 row_mask:0xf bank_mask:0xf
v_mov_b64_dpp v[172:173], v[166:167] row_newbcast:4 row_mask:0xf bank_mask:0xf
v_mov_b64_dpp v[176:177], v[166:167] row_newbcast:12 row_mask:0xf bank_mask:0xf
v_mov_b64_dpp v[180:181], v[182:183] row_newbcast:0 row_mask:0xf bank_mask:0xf
v_mov_b64_dpp v[184:185], v[182:183] row_newbcast:8 row_mask:0xf bank_mask:0xf
v_fma_f32 v116, v116, v164, v165
v_fma_f32 v117, v117, v164, v165
v_fma_f32 v118, v118, v164, v165
v_fma_f32 v119, v119, v164, v165
v_fma_f32 v120, v120, v164, v165
v_fma_f32 v121, v121, v164, v165
v_fma_f32 v122, v122, v164, v165
v_fma_f32 v123, v123, v164, v165
v_cvt_pk_bf16_f32 v44, v116, v117
v_cvt_pk_bf16_f32 v45, v118, v119
v_cvt_pk_bf16_f32 v46, v120, v121
v_cvt_pk_bf16_f32 v47, v122, v123
ds_write_b128 v36, v[44:47]
v_fma_f32 v124, v124, v168, v169
v_fma_f32 v125, v125, v168, v169
v_fma_f32 v126, v126, v168, v169
v_fma_f32 v127, v127, v168, v169
v_fma_f32 v128, v128, v168, v169
v_fma_f32 v129, v129, v168, v169
v_fma_f32 v130, v130, v168, v169
v_fma_f32 v131, v131, v168, v169
v_cvt_pk_bf16_f32 v48, v124, v125
v_cvt_pk_bf16_f32 v49, v126, v127
v_cvt_pk_bf16_f32 v50, v128, v129
v_cvt_pk_bf16_f32 v51, v130, v131
ds_write_b128 v37, v[48:51]
v_fma_f32 v132, v132, v172, v173
v_fma_f32 v133, v133, v172, v173
v_fma_f32 v134, v134, v172, v173
v_fma_f32 v135, v135, v172, v173
v_fma_f32 v136, v136, v172, v173
v_fma_f32 v137, v137, v172, v173
v_fma_f32 v138, v138, v172, v173
v_fma_f32 v139, v139, v172, v173
v_cvt_pk_bf16_f32 v52, v132, v133
v_cvt_pk_bf16_f32 v53, v134, v135
v_cvt_pk_bf16_f32 v54, v136, v137
v_cvt_pk_bf16_f32 v55, v138, v139
ds_write_b128 v38, v[52:55]
v_fma_f32 v140, v140, v176, v177
v_fma_f32 v141, v141, v176, v177
v_fma_f32 v142, v142, v176, v177
v_fma_f32 v143, v143, v176, v177
v_fma_f32 v144, v144, v176, v177
v_fma_f32 v145, v145, v176, v177
v_fma_f32 v146, v146, v176, v177
v_fma_f32 v147, v147, v176, v177
v_cvt_pk_bf16_f32 v56, v140, v141
v_cvt_pk_bf16_f32 v57, v142, v143
v_cvt_pk_bf16_f32 v58, v144, v145
v_cvt_pk_bf16_f32 v59, v146, v147
ds_write_b128 v39, v[56:59]
v_fma_f32 v148, v148, v180, v181
v_fma_f32 v149, v149, v180, v181
v_fma_f32 v150, v150, v180, v181
v_fma_f32 v151, v151, v180, v181
v_fma_f32 v152, v152, v180, v181
v_fma_f32 v153, v153, v180, v181
v_fma_f32 v154, v154, v180, v181
v_fma_f32 v155, v155, v180, v181
v_cvt_pk_bf16_f32 v60, v148, v149
v_cvt_pk_bf16_f32 v61, v150, v151
v_cvt_pk_bf16_f32 v62, v152, v153
v_cvt_pk_bf16_f32 v63, v154, v155
ds_write_b128 v40, v[60:63]
v_fma_f32 v156, v156, v184, v185
v_fma_f32 v157, v157, v184, v185
v_fma_f32 v158, v158, v184, v185
v_fma_f32 v159, v159, v184, v185
v_fma_f32 v160, v160, v184, v185
v_fma_f32 v161, v161, v184, v185
v_fma_f32 v162, v162, v184, v185
v_fma_f32 v163, v163, v184, v185
v_cvt_pk_bf16_f32 v64, v156, v157
v_cvt_pk_bf16_f32 v65, v158, v159
v_cvt_pk_bf16_f32 v66, v160, v161
v_cvt_pk_bf16_f32 v67, v162, v163
ds_write_b128 v41, v[64:67]
s_add_u32 m0, s63, 0x2000
s_nop 0
buffer_load_dwordx4 v17, s[44:47], s68 offen offset:0 lds
buffer_load_dwordx4 v18, s[44:47], s68 offen offset:1024 lds
buffer_load_dwordx4 v19, s[44:47], s68 offen offset:2048 lds
buffer_load_dwordx4 v20, s[44:47], s68 offen offset:3072 lds
s_waitcnt vmcnt(8)
ds_read_b64_tr_b16 v[164:165], v25 offset:0
ds_read_b64_tr_b16 v[166:167], v25 offset:512
ds_read_b64_tr_b16 v[168:169], v26 offset:0
ds_read_b64_tr_b16 v[170:171], v26 offset:512
ds_read_b64_tr_b16 v[172:173], v27 offset:0
ds_read_b64_tr_b16 v[174:175], v27 offset:512
s_waitcnt lgkmcnt(6)
s_barrier
ds_read_b128 v[204:207], v31 offset:0
ds_read_b128 v[208:211], v31 offset:8192
ds_read_b128 v[212:215], v31 offset:16384
s_waitcnt lgkmcnt(2)
v_mfma_f32_16x16x32_bf16 v[68:71], v[164:167], v[204:207], 0
s_waitcnt lgkmcnt(1)
v_mfma_f32_16x16x32_bf16 v[72:75], v[164:167], v[208:211], 0
s_waitcnt lgkmcnt(0)
v_mfma_f32_16x16x32_bf16 v[76:79], v[164:167], v[212:215], 0
ds_read_b64_tr_b16 v[176:177], v28 offset:0
ds_read_b64_tr_b16 v[178:179], v28 offset:512
v_mfma_f32_16x16x32_bf16 v[80:83], v[168:171], v[204:207], 0
v_mfma_f32_16x16x32_bf16 v[84:87], v[168:171], v[208:211], 0
v_mfma_f32_16x16x32_bf16 v[88:91], v[168:171], v[212:215], 0
ds_read_b128 v[216:219], v32 offset:1024
s_waitcnt vmcnt(4)
ds_read_b64_tr_b16 v[180:181], v25 offset:4096
ds_read_b64_tr_b16 v[182:183], v25 offset:4608
v_mfma_f32_16x16x32_bf16 v[92:95], v[172:175], v[204:207], 0
ds_read_b128 v[220:223], v32 offset:9216
v_mfma_f32_16x16x32_bf16 v[96:99], v[172:175], v[208:211], 0
ds_read_b128 v[224:227], v32 offset:17408
v_mfma_f32_16x16x32_bf16 v[100:103], v[172:175], v[212:215], 0
ds_read_b64_tr_b16 v[184:185], v26 offset:4096
ds_read_b64_tr_b16 v[186:187], v26 offset:4608
s_waitcnt lgkmcnt(7)
v_mfma_f32_16x16x32_bf16 v[104:107], v[176:179], v[204:207], 0
s_add_u32 m0, s63, 0x0
s_nop 0
buffer_load_dwordx4 v17, s[44:47], s69 offen offset:0 lds
buffer_load_dwordx4 v18, s[44:47], s69 offen offset:1024 lds
buffer_load_dwordx4 v19, s[44:47], s69 offen offset:2048 lds
buffer_load_dwordx4 v20, s[44:47], s69 offen offset:3072 lds
v_mfma_f32_16x16x32_bf16 v[108:111], v[176:179], v[208:211], 0
v_mfma_f32_16x16x32_bf16 v[112:115], v[176:179], v[212:215], 0
ds_read_b64_tr_b16 v[188:189], v27 offset:4096
ds_read_b64_tr_b16 v[190:191], v27 offset:4608
s_waitcnt lgkmcnt(6)
v_mfma_f32_16x16x32_bf16 v[68:71], v[180:183], v[216:219], v[68:71]
s_waitcnt lgkmcnt(5)
v_mfma_f32_16x16x32_bf16 v[72:75], v[180:183], v[220:223], v[72:75]
s_waitcnt lgkmcnt(4)
v_mfma_f32_16x16x32_bf16 v[76:79], v[180:183], v[224:227], v[76:79]
ds_read_b64_tr_b16 v[192:193], v28 offset:4096
ds_read_b64_tr_b16 v[194:195], v28 offset:4608
s_waitcnt lgkmcnt(4)
v_mfma_f32_16x16x32_bf16 v[80:83], v[184:187], v[216:219], v[80:83]
v_mfma_f32_16x16x32_bf16 v[84:87], v[184:187], v[220:223], v[84:87]
v_mfma_f32_16x16x32_bf16 v[88:91], v[184:187], v[224:227], v[88:91]
ds_read_b128 v[228:231], v31 offset:2048
s_waitcnt vmcnt(4)
ds_read_b64_tr_b16 v[196:197], v25 offset:8192
ds_read_b64_tr_b16 v[198:199], v25 offset:8704
s_waitcnt lgkmcnt(5)
v_mfma_f32_16x16x32_bf16 v[92:95], v[188:191], v[216:219], v[92:95]
ds_read_b128 v[232:235], v31 offset:10240
v_mfma_f32_16x16x32_bf16 v[96:99], v[188:191], v[220:223], v[96:99]
ds_read_b128 v[236:239], v31 offset:18432
v_mfma_f32_16x16x32_bf16 v[100:103], v[188:191], v[224:227], v[100:103]
ds_read_b64_tr_b16 v[200:201], v26 offset:8192
ds_read_b64_tr_b16 v[202:203], v26 offset:8704
s_waitcnt lgkmcnt(7)
v_mfma_f32_16x16x32_bf16 v[104:107], v[192:195], v[216:219], v[104:107]
s_add_u32 m0, s63, 0x1000
s_nop 0
buffer_load_dwordx4 v17, s[44:47], s70 offen offset:0 lds
buffer_load_dwordx4 v18, s[44:47], s70 offen offset:1024 lds
buffer_load_dwordx4 v19, s[44:47], s70 offen offset:2048 lds
buffer_load_dwordx4 v20, s[44:47], s70 offen offset:3072 lds
v_mfma_f32_16x16x32_bf16 v[108:111], v[192:195], v[220:223], v[108:111]
v_mfma_f32_16x16x32_bf16 v[112:115], v[192:195], v[224:227], v[112:115]
ds_read_b64_tr_b16 v[164:165], v27 offset:8192
ds_read_b64_tr_b16 v[166:167], v27 offset:8704
s_waitcnt lgkmcnt(6)
v_mfma_f32_16x16x32_bf16 v[68:71], v[196:199], v[228:231], v[68:71]
s_waitcnt lgkmcnt(5)
v_mfma_f32_16x16x32_bf16 v[72:75], v[196:199], v[232:235], v[72:75]
s_waitcnt lgkmcnt(4)
v_mfma_f32_16x16x32_bf16 v[76:79], v[196:199], v[236:239], v[76:79]
ds_read_b64_tr_b16 v[168:169], v28 offset:8192
ds_read_b64_tr_b16 v[170:171], v28 offset:8704
s_waitcnt lgkmcnt(4)
v_mfma_f32_16x16x32_bf16 v[80:83], v[200:203], v[228:231], v[80:83]
v_mfma_f32_16x16x32_bf16 v[84:87], v[200:203], v[232:235], v[84:87]
v_mfma_f32_16x16x32_bf16 v[88:91], v[200:203], v[236:239], v[88:91]
ds_read_b128 v[204:207], v32 offset:3072
s_waitcnt vmcnt(4)
ds_read_b64_tr_b16 v[172:173], v25 offset:0
ds_read_b64_tr_b16 v[174:175], v25 offset:512
s_waitcnt lgkmcnt(5)
v_mfma_f32_16x16x32_bf16 v[92:95], v[164:167], v[228:231], v[92:95]
ds_read_b128 v[208:211], v32 offset:11264
v_mfma_f32_16x16x32_bf16 v[96:99], v[164:167], v[232:235], v[96:99]
ds_read_b128 v[212:215], v32 offset:19456
v_mfma_f32_16x16x32_bf16 v[100:103], v[164:167], v[236:239], v[100:103]
ds_read_b64_tr_b16 v[176:177], v26 offset:0
ds_read_b64_tr_b16 v[178:179], v26 offset:512
s_waitcnt lgkmcnt(7)
v_mfma_f32_16x16x32_bf16 v[104:107], v[168:171], v[228:231], v[104:107]
s_add_u32 m0, s63, 0x2000
s_nop 0
buffer_load_dwordx4 v17, s[44:47], s71 offen offset:0 lds
buffer_load_dwordx4 v18, s[44:47], s71 offen offset:1024 lds
buffer_load_dwordx4 v19, s[44:47], s71 offen offset:2048 lds
buffer_load_dwordx4 v20, s[44:47], s71 offen offset:3072 lds
v_mfma_f32_16x16x32_bf16 v[108:111], v[168:171], v[232:235], v[108:111]
v_mfma_f32_16x16x32_bf16 v[112:115], v[168:171], v[236:239], v[112:115]
ds_read_b64_tr_b16 v[180:181], v27 offset:0
ds_read_b64_tr_b16 v[182:183], v27 offset:512
s_waitcnt lgkmcnt(6)
v_mfma_f32_16x16x32_bf16 v[68:71], v[172:175], v[204:207], v[68:71]
s_waitcnt lgkmcnt(5)
v_mfma_f32_16x16x32_bf16 v[72:75], v[172:175], v[208:211], v[72:75]
s_waitcnt lgkmcnt(4)
v_mfma_f32_16x16x32_bf16 v[76:79], v[172:175], v[212:215], v[76:79]
ds_read_b64_tr_b16 v[184:185], v28 offset:0
ds_read_b64_tr_b16 v[186:187], v28 offset:512
s_waitcnt lgkmcnt(4)
v_mfma_f32_16x16x32_bf16 v[80:83], v[176:179], v[204:207], v[80:83]
v_mfma_f32_16x16x32_bf16 v[84:87], v[176:179], v[208:211], v[84:87]
v_mfma_f32_16x16x32_bf16 v[88:91], v[176:179], v[212:215], v[88:91]
ds_read_b128 v[216:219], v31 offset:4096
s_waitcnt vmcnt(4)
ds_read_b64_tr_b16 v[188:189], v25 offset:4096
ds_read_b64_tr_b16 v[190:191], v25 offset:4608
s_waitcnt lgkmcnt(5)
v_mfma_f32_16x16x32_bf16 v[92:95], v[180:183], v[204:207], v[92:95]
ds_read_b128 v[220:223], v31 offset:12288
v_mfma_f32_16x16x32_bf16 v[96:99], v[180:183], v[208:211], v[96:99]
ds_read_b128 v[224:227], v31 offset:20480
v_mfma_f32_16x16x32_bf16 v[100:103], v[180:183], v[212:215], v[100:103]
ds_read_b64_tr_b16 v[192:193], v26 offset:4096
ds_read_b64_tr_b16 v[194:195], v26 offset:4608
s_waitcnt lgkmcnt(7)
v_mfma_f32_16x16x32_bf16 v[104:107], v[184:187], v[204:207], v[104:107]
s_add_u32 m0, s63, 0x0
s_nop 0
buffer_load_dwordx4 v17, s[44:47], s72 offen offset:0 lds
buffer_load_dwordx4 v18, s[44:47], s72 offen offset:1024 lds
buffer_load_dwordx4 v19, s[44:47], s72 offen offset:2048 lds
buffer_load_dwordx4 v20, s[44:47], s72 offen offset:3072 lds
v_mfma_f32_16x16x32_bf16 v[108:111], v[184:187], v[208:211], v[108:111]
v_mfma_f32_16x16x32_bf16 v[112:115], v[184:187], v[212:215], v[112:115]
ds_read_b64_tr_b16 v[196:197], v27 offset:4096
ds_read_b64_tr_b16 v[198:199], v27 offset:4608
s_waitcnt lgkmcnt(6)
v_mfma_f32_16x16x32_bf16 v[68:71], v[188:191], v[216:219], v[68:71]
s_waitcnt lgkmcnt(5)
v_mfma_f32_16x16x32_bf16 v[72:75], v[188:191], v[220:223], v[72:75]
s_waitcnt lgkmcnt(4)
v_mfma_f32_16x16x32_bf16 v[76:79], v[188:191], v[224:227], v[76:79]
ds_read_b64_tr_b16 v[200:201], v28 offset:4096
ds_read_b64_tr_b16 v[202:203], v28 offset:4608
s_waitcnt lgkmcnt(4)
v_mfma_f32_16x16x32_bf16 v[80:83], v[192:195], v[216:219], v[80:83]
v_mfma_f32_16x16x32_bf16 v[84:87], v[192:195], v[220:223], v[84:87]
v_mfma_f32_16x16x32_bf16 v[88:91], v[192:195], v[224:227], v[88:91]
ds_read_b128 v[228:231], v32 offset:5120
s_waitcnt vmcnt(4)
ds_read_b64_tr_b16 v[164:165], v25 offset:8192
ds_read_b64_tr_b16 v[166:167], v25 offset:8704
s_waitcnt lgkmcnt(5)
v_mfma_f32_16x16x32_bf16 v[92:95], v[196:199], v[216:219], v[92:95]
ds_read_b128 v[232:235], v32 offset:13312
v_mfma_f32_16x16x32_bf16 v[96:99], v[196:199], v[220:223], v[96:99]
ds_read_b128 v[236:239], v32 offset:21504
v_mfma_f32_16x16x32_bf16 v[100:103], v[196:199], v[224:227], v[100:103]
ds_read_b64_tr_b16 v[168:169], v26 offset:8192
ds_read_b64_tr_b16 v[170:171], v26 offset:8704
s_waitcnt lgkmcnt(7)
v_mfma_f32_16x16x32_bf16 v[104:107], v[200:203], v[216:219], v[104:107]
s_add_u32 m0, s63, 0x1000
s_nop 0
buffer_load_dwordx4 v17, s[44:47], s73 offen offset:0 lds
buffer_load_dwordx4 v18, s[44:47], s73 offen offset:1024 lds
buffer_load_dwordx4 v19, s[44:47], s73 offen offset:2048 lds
buffer_load_dwordx4 v20, s[44:47], s73 offen offset:3072 lds
v_mfma_f32_16x16x32_bf16 v[108:111], v[200:203], v[220:223], v[108:111]
v_mfma_f32_16x16x32_bf16 v[112:115], v[200:203], v[224:227], v[112:115]
ds_read_b64_tr_b16 v[172:173], v27 offset:8192
ds_read_b64_tr_b16 v[174:175], v27 offset:8704
s_waitcnt lgkmcnt(6)
v_mfma_f32_16x16x32_bf16 v[68:71], v[164:167], v[228:231], v[68:71]
s_waitcnt lgkmcnt(5)
v_mfma_f32_16x16x32_bf16 v[72:75], v[164:167], v[232:235], v[72:75]
s_waitcnt lgkmcnt(4)
v_mfma_f32_16x16x32_bf16 v[76:79], v[164:167], v[236:239], v[76:79]
ds_read_b64_tr_b16 v[176:177], v28 offset:8192
ds_read_b64_tr_b16 v[178:179], v28 offset:8704
s_waitcnt lgkmcnt(4)
v_mfma_f32_16x16x32_bf16 v[80:83], v[168:171], v[228:231], v[80:83]
v_mfma_f32_16x16x32_bf16 v[84:87], v[168:171], v[232:235], v[84:87]
v_mfma_f32_16x16x32_bf16 v[88:91], v[168:171], v[236:239], v[88:91]
ds_read_b128 v[204:207], v31 offset:6144
s_waitcnt vmcnt(4)
ds_read_b64_tr_b16 v[180:181], v25 offset:0
ds_read_b64_tr_b16 v[182:183], v25 offset:512
s_waitcnt lgkmcnt(5)
v_mfma_f32_16x16x32_bf16 v[92:95], v[172:175], v[228:231], v[92:95]
ds_read_b128 v[208:211], v31 offset:14336
v_mfma_f32_16x16x32_bf16 v[96:99], v[172:175], v[232:235], v[96:99]
ds_read_b128 v[212:215], v31 offset:22528
v_mfma_f32_16x16x32_bf16 v[100:103], v[172:175], v[236:239], v[100:103]
ds_read_b64_tr_b16 v[184:185], v26 offset:0
ds_read_b64_tr_b16 v[186:187], v26 offset:512
s_waitcnt lgkmcnt(7)
v_mfma_f32_16x16x32_bf16 v[104:107], v[176:179], v[228:231], v[104:107]
s_add_u32 m0, s63, 0x2000
s_nop 0
buffer_load_dwordx4 v21, s[48:51], s74 offen offset:0 lds
buffer_load_dwordx4 v22, s[48:51], s74 offen offset:1024 lds
buffer_load_dwordx4 v23, s[48:51], s74 offen offset:2048 lds
buffer_load_dwordx4 v24, s[48:51], s74 offen offset:3072 lds
v_mfma_f32_16x16x32_bf16 v[108:111], v[176:179], v[232:235], v[108:111]
v_mfma_f32_16x16x32_bf16 v[112:115], v[176:179], v[236:239], v[112:115]
ds_read_b64_tr_b16 v[188:189], v27 offset:0
ds_read_b64_tr_b16 v[190:191], v27 offset:512
s_waitcnt lgkmcnt(6)
v_mfma_f32_16x16x32_bf16 v[68:71], v[180:183], v[204:207], v[68:71]
s_waitcnt lgkmcnt(5)
v_mfma_f32_16x16x32_bf16 v[72:75], v[180:183], v[208:211], v[72:75]
s_waitcnt lgkmcnt(4)
v_mfma_f32_16x16x32_bf16 v[76:79], v[180:183], v[212:215], v[76:79]
ds_read_b64_tr_b16 v[192:193], v28 offset:0
ds_read_b64_tr_b16 v[194:195], v28 offset:512
s_waitcnt lgkmcnt(4)
v_mfma_f32_16x16x32_bf16 v[80:83], v[184:187], v[204:207], v[80:83]
v_mfma_f32_16x16x32_bf16 v[84:87], v[184:187], v[208:211], v[84:87]
v_mfma_f32_16x16x32_bf16 v[88:91], v[184:187], v[212:215], v[88:91]
ds_read_b128 v[216:219], v32 offset:7168
s_waitcnt vmcnt(4)
ds_read_b64_tr_b16 v[196:197], v25 offset:4096
ds_read_b64_tr_b16 v[198:199], v25 offset:4608
s_waitcnt lgkmcnt(5)
v_mfma_f32_16x16x32_bf16 v[92:95], v[188:191], v[204:207], v[92:95]
ds_read_b128 v[220:223], v32 offset:15360
v_mfma_f32_16x16x32_bf16 v[96:99], v[188:191], v[208:211], v[96:99]
ds_read_b128 v[224:227], v32 offset:23552
v_mfma_f32_16x16x32_bf16 v[100:103], v[188:191], v[212:215], v[100:103]
ds_read_b64_tr_b16 v[200:201], v26 offset:4096
ds_read_b64_tr_b16 v[202:203], v26 offset:4608
s_waitcnt lgkmcnt(7)
v_mfma_f32_16x16x32_bf16 v[104:107], v[192:195], v[204:207], v[104:107]
s_add_u32 m0, s63, 0x0
s_nop 0
buffer_load_dwordx4 v21, s[48:51], s75 offen offset:0 lds
buffer_load_dwordx4 v22, s[48:51], s75 offen offset:1024 lds
buffer_load_dwordx4 v23, s[48:51], s75 offen offset:2048 lds
buffer_load_dwordx4 v24, s[48:51], s75 offen offset:3072 lds
v_mfma_f32_16x16x32_bf16 v[108:111], v[192:195], v[208:211], v[108:111]
v_mfma_f32_16x16x32_bf16 v[112:115], v[192:195], v[212:215], v[112:115]
ds_read_b64_tr_b16 v[164:165], v27 offset:4096
ds_read_b64_tr_b16 v[166:167], v27 offset:4608
s_waitcnt lgkmcnt(6)
v_mfma_f32_16x16x32_bf16 v[68:71], v[196:199], v[216:219], v[68:71]
s_waitcnt lgkmcnt(5)
v_mfma_f32_16x16x32_bf16 v[72:75], v[196:199], v[220:223], v[72:75]
s_waitcnt lgkmcnt(4)
v_mfma_f32_16x16x32_bf16 v[76:79], v[196:199], v[224:227], v[76:79]
ds_read_b64_tr_b16 v[168:169], v28 offset:4096
ds_read_b64_tr_b16 v[170:171], v28 offset:4608
s_waitcnt lgkmcnt(4)
v_mfma_f32_16x16x32_bf16 v[80:83], v[200:203], v[216:219], v[80:83]
v_cvt_pk_bf16_f32 v68, v68, v69
v_cvt_pk_bf16_f32 v69, v70, v71
ds_write_b64 v33, v[68:69] offset:0
v_mfma_f32_16x16x32_bf16 v[84:87], v[200:203], v[220:223], v[84:87]
v_cvt_pk_bf16_f32 v72, v72, v73
v_cvt_pk_bf16_f32 v73, v74, v75
ds_write_b64 v33, v[72:73] offset:8192
v_mfma_f32_16x16x32_bf16 v[88:91], v[200:203], v[224:227], v[88:91]
v_cvt_pk_bf16_f32 v76, v76, v77
v_cvt_pk_bf16_f32 v77, v78, v79
ds_write_b64 v33, v[76:77] offset:16384
s_waitcnt lgkmcnt(5)
v_mfma_f32_16x16x32_bf16 v[92:95], v[164:167], v[216:219], v[92:95]
v_cvt_pk_bf16_f32 v80, v80, v81
v_cvt_pk_bf16_f32 v81, v82, v83
ds_write_b64 v33, v[80:81] offset:512
v_mfma_f32_16x16x32_bf16 v[96:99], v[164:167], v[220:223], v[96:99]
v_cvt_pk_bf16_f32 v84, v84, v85
v_cvt_pk_bf16_f32 v85, v86, v87
ds_write_b64 v33, v[84:85] offset:8704
v_mfma_f32_16x16x32_bf16 v[100:103], v[164:167], v[224:227], v[100:103]
v_cvt_pk_bf16_f32 v88, v88, v89
v_cvt_pk_bf16_f32 v89, v90, v91
ds_write_b64 v33, v[88:89] offset:16896
s_waitcnt lgkmcnt(6)
v_mfma_f32_16x16x32_bf16 v[104:107], v[168:171], v[216:219], v[104:107]
v_cvt_pk_bf16_f32 v92, v92, v93
v_cvt_pk_bf16_f32 v93, v94, v95
ds_write_b64 v34, v[92:93] offset:0
s_add_u32 m0, s63, 0x1000
s_nop 0
buffer_load_dwordx4 v21, s[48:51], s76 offen offset:0 lds
buffer_load_dwordx4 v22, s[48:51], s76 offen offset:1024 lds
buffer_load_dwordx4 v23, s[48:51], s76 offen offset:2048 lds
buffer_load_dwordx4 v24, s[48:51], s76 offen offset:3072 lds
v_mfma_f32_16x16x32_bf16 v[108:111], v[168:171], v[220:223], v[108:111]
v_cvt_pk_bf16_f32 v96, v96, v97
v_cvt_pk_bf16_f32 v97, v98, v99
ds_write_b64 v34, v[96:97] offset:8192
v_mfma_f32_16x16x32_bf16 v[112:115], v[168:171], v[224:227], v[112:115]
v_cvt_pk_bf16_f32 v100, v100, v101
v_cvt_pk_bf16_f32 v101, v102, v103
ds_write_b64 v34, v[100:101] offset:16384
v_cvt_pk_bf16_f32 v104, v104, v105
v_cvt_pk_bf16_f32 v105, v106, v107
ds_write_b64 v34, v[104:105] offset:512
v_cvt_pk_bf16_f32 v108, v108, v109
v_cvt_pk_bf16_f32 v109, v110, v111
ds_write_b64 v34, v[108:109] offset:8704
v_cvt_pk_bf16_f32 v112, v112, v113
v_cvt_pk_bf16_f32 v113, v114, v115
ds_write_b64 v34, v[112:113] offset:16896
s_waitcnt vmcnt(8)
ds_read_b128 v[172:175], v29 offset:8192
ds_read_b128 v[176:179], v30 offset:8192
ds_read_b128 v[180:183], v29 offset:10240
s_waitcnt lgkmcnt(3)
s_barrier
ds_read_b128 v[228:231], v35 offset:0
ds_read_b128 v[232:235], v35 offset:8192
ds_read_b128 v[236:239], v35 offset:16384
ds_read_b128 v[204:207], v35 offset:1024
ds_read_b128 v[208:211], v35 offset:9216
ds_read_b128 v[212:215], v35 offset:17408
s_waitcnt lgkmcnt(5)
v_mfma_f32_16x16x32_bf16 v[116:119], v[172:175], v[228:231], 0
s_waitcnt lgkmcnt(4)
v_mfma_f32_16x16x32_bf16 v[132:135], v[172:175], v[232:235], 0
s_waitcnt lgkmcnt(3)
v_mfma_f32_16x16x32_bf16 v[148:151], v[172:175], v[236:239], 0
ds_read_b128 v[184:187], v30 offset:10240
s_waitcnt lgkmcnt(3)
v_mfma_f32_16x16x32_bf16 v[116:119], v[176:179], v[204:207], v[116:119]
s_waitcnt lgkmcnt(2)
v_mfma_f32_16x16x32_bf16 v[132:135], v[176:179], v[208:211], v[132:135]
s_waitcnt lgkmcnt(1)
v_mfma_f32_16x16x32_bf16 v[148:151], v[176:179], v[212:215], v[148:151]
s_waitcnt vmcnt(4)
ds_read_b128 v[188:191], v29 offset:0
v_mfma_f32_16x16x32_bf16 v[120:123], v[180:183], v[228:231], 0
v_mfma_f32_16x16x32_bf16 v[136:139], v[180:183], v[232:235], 0
v_mfma_f32_16x16x32_bf16 v[152:155], v[180:183], v[236:239], 0
ds_read_b128 v[192:195], v30 offset:0
s_waitcnt lgkmcnt(2)
v_mfma_f32_16x16x32_bf16 v[120:123], v[184:187], v[204:207], v[120:123]
s_add_u32 m0, s63, 0x2000
s_nop 0
buffer_load_dwordx4 v21, s[48:51], s77 offen offset:0 lds
buffer_load_dwordx4 v22, s[48:51], s77 offen offset:1024 lds
buffer_load_dwordx4 v23, s[48:51], s77 offen offset:2048 lds
buffer_load_dwordx4 v24, s[48:51], s77 offen offset:3072 lds
v_mfma_f32_16x16x32_bf16 v[136:139], v[184:187], v[208:211], v[136:139]
v_mfma_f32_16x16x32_bf16 v[152:155], v[184:187], v[212:215], v[152:155]
ds_read_b128 v[196:199], v29 offset:2048
s_waitcnt lgkmcnt(2)
v_mfma_f32_16x16x32_bf16 v[124:127], v[188:191], v[228:231], 0
v_mfma_f32_16x16x32_bf16 v[140:143], v[188:191], v[232:235], 0
v_mfma_f32_16x16x32_bf16 v[156:159], v[188:191], v[236:239], 0
ds_read_b128 v[200:203], v30 offset:2048
s_waitcnt lgkmcnt(2)
v_mfma_f32_16x16x32_bf16 v[124:127], v[192:195], v[204:207], v[124:127]
v_mfma_f32_16x16x32_bf16 v[140:143], v[192:195], v[208:211], v[140:143]
v_mfma_f32_16x16x32_bf16 v[156:159], v[192:195], v[212:215], v[156:159]
ds_read_b128 v[216:219], v35 offset:2048
s_waitcnt vmcnt(4)
ds_read_b128 v[164:167], v29 offset:4096
s_waitcnt lgkmcnt(3)
v_mfma_f32_16x16x32_bf16 v[128:131], v[196:199], v[228:231], 0
ds_read_b128 v[220:223], v35 offset:10240
v_mfma_f32_16x16x32_bf16 v[144:147], v[196:199], v[232:235], 0
ds_read_b128 v[224:227], v35 offset:18432
v_mfma_f32_16x16x32_bf16 v[160:163], v[196:199], v[236:239], 0
ds_read_b128 v[228:231], v35 offset:3072
ds_read_b128 v[168:171], v30 offset:4096
s_waitcnt lgkmcnt(6)
v_mfma_f32_16x16x32_bf16 v[128:131], v[200:203], v[204:207], v[128:131]
ds_read_b128 v[232:235], v35 offset:11264
s_add_u32 m0, s63, 0x0
s_nop 0
buffer_load_dwordx4 v21, s[48:51], s78 offen offset:0 lds
buffer_load_dwordx4 v22, s[48:51], s78 offen offset:1024 lds
buffer_load_dwordx4 v23, s[48:51], s78 offen offset:2048 lds
buffer_load_dwordx4 v24, s[48:51], s78 offen offset:3072 lds
v_mfma_f32_16x16x32_bf16 v[144:147], v[200:203], v[208:211], v[144:147]
ds_read_b128 v[236:239], v35 offset:19456
v_mfma_f32_16x16x32_bf16 v[160:163], v[200:203], v[212:215], v[160:163]
ds_read_b128 v[172:175], v29 offset:6144
s_waitcnt lgkmcnt(7)
v_mfma_f32_16x16x32_bf16 v[116:119], v[164:167], v[216:219], v[116:119]
s_waitcnt lgkmcnt(6)
v_mfma_f32_16x16x32_bf16 v[132:135], v[164:167], v[220:223], v[132:135]
s_waitcnt lgkmcnt(5)
v_mfma_f32_16x16x32_bf16 v[148:151], v[164:167], v[224:227], v[148:151]
ds_read_b128 v[176:179], v30 offset:6144
s_waitcnt lgkmcnt(4)
v_mfma_f32_16x16x32_bf16 v[116:119], v[168:171], v[228:231], v[116:119]
s_waitcnt lgkmcnt(3)
v_mfma_f32_16x16x32_bf16 v[132:135], v[168:171], v[232:235], v[132:135]
s_waitcnt lgkmcnt(2)
v_mfma_f32_16x16x32_bf16 v[148:151], v[168:171], v[236:239], v[148:151]
s_waitcnt vmcnt(4)
ds_read_b128 v[180:183], v29 offset:8192
s_waitcnt lgkmcnt(2)
v_mfma_f32_16x16x32_bf16 v[120:123], v[172:175], v[216:219], v[120:123]
v_mfma_f32_16x16x32_bf16 v[136:139], v[172:175], v[220:223], v[136:139]
v_mfma_f32_16x16x32_bf16 v[152:155], v[172:175], v[224:227], v[152:155]
ds_read_b128 v[184:187], v30 offset:8192
s_waitcnt lgkmcnt(2)
v_mfma_f32_16x16x32_bf16 v[120:123], v[176:179], v[228:231], v[120:123]
s_add_u32 m0, s63, 0x1000
s_nop 0
buffer_load_dwordx4 v21, s[48:51], s79 offen offset:0 lds
buffer_load_dwordx4 v22, s[48:51], s79 offen offset:1024 lds
buffer_load_dwordx4 v23, s[48:51], s79 offen offset:2048 lds
buffer_load_dwordx4 v24, s[48:51], s79 offen offset:3072 lds
v_mfma_f32_16x16x32_bf16 v[136:139], v[176:179], v[232:235], v[136:139]
v_mfma_f32_16x16x32_bf16 v[152:155], v[176:179], v[236:239], v[152:155]
ds_read_b128 v[188:191], v29 offset:10240
s_waitcnt lgkmcnt(2)
v_mfma_f32_16x16x32_bf16 v[124:127], v[180:183], v[216:219], v[124:127]
v_mfma_f32_16x16x32_bf16 v[140:143], v[180:183], v[220:223], v[140:143]
v_mfma_f32_16x16x32_bf16 v[156:159], v[180:183], v[224:227], v[156:159]
ds_read_b128 v[192:195], v30 offset:10240
s_waitcnt lgkmcnt(2)
v_mfma_f32_16x16x32_bf16 v[124:127], v[184:187], v[228:231], v[124:127]
v_mfma_f32_16x16x32_bf16 v[140:143], v[184:187], v[232:235], v[140:143]
v_mfma_f32_16x16x32_bf16 v[156:159], v[184:187], v[236:239], v[156:159]
ds_read_b128 v[204:207], v35 offset:4096
s_waitcnt vmcnt(4)
ds_read_b128 v[196:199], v29 offset:0
s_waitcnt lgkmcnt(3)
v_mfma_f32_16x16x32_bf16 v[128:131], v[188:191], v[216:219], v[128:131]
ds_read_b128 v[208:211], v35 offset:12288
v_mfma_f32_16x16x32_bf16 v[144:147], v[188:191], v[220:223], v[144:147]
ds_read_b128 v[212:215], v35 offset:20480
v_mfma_f32_16x16x32_bf16 v[160:163], v[188:191], v[224:227], v[160:163]
ds_read_b128 v[216:219], v35 offset:5120
ds_read_b128 v[200:203], v30 offset:0
s_waitcnt lgkmcnt(6)
v_mfma_f32_16x16x32_bf16 v[128:131], v[192:195], v[228:231], v[128:131]
ds_read_b128 v[220:223], v35 offset:13312
s_add_u32 m0, s63, 0x2000
s_nop 0
buffer_load_dwordx4 v21, s[48:51], s80 offen offset:0 lds
buffer_load_dwordx4 v22, s[48:51], s80 offen offset:1024 lds
buffer_load_dwordx4 v23, s[48:51], s80 offen offset:2048 lds
buffer_load_dwordx4 v24, s[48:51], s80 offen offset:3072 lds
v_mfma_f32_16x16x32_bf16 v[144:147], v[192:195], v[232:235], v[144:147]
ds_read_b128 v[224:227], v35 offset:21504
v_mfma_f32_16x16x32_bf16 v[160:163], v[192:195], v[236:239], v[160:163]
ds_read_b128 v[164:167], v29 offset:2048
s_waitcnt lgkmcnt(7)
v_mfma_f32_16x16x32_bf16 v[116:119], v[196:199], v[204:207], v[116:119]
s_waitcnt lgkmcnt(6)
v_mfma_f32_16x16x32_bf16 v[132:135], v[196:199], v[208:211], v[132:135]
s_waitcnt lgkmcnt(5)
v_mfma_f32_16x16x32_bf16 v[148:151], v[196:199], v[212:215], v[148:151]
ds_read_b128 v[168:171], v30 offset:2048
s_waitcnt lgkmcnt(4)
v_mfma_f32_16x16x32_bf16 v[116:119], v[200:203], v[216:219], v[116:119]
s_waitcnt lgkmcnt(3)
v_mfma_f32_16x16x32_bf16 v[132:135], v[200:203], v[220:223], v[132:135]
s_waitcnt lgkmcnt(2)
v_mfma_f32_16x16x32_bf16 v[148:151], v[200:203], v[224:227], v[148:151]
s_waitcnt vmcnt(4)
ds_read_b128 v[172:175], v29 offset:4096
s_waitcnt lgkmcnt(2)
v_mfma_f32_16x16x32_bf16 v[120:123], v[164:167], v[204:207], v[120:123]
v_mfma_f32_16x16x32_bf16 v[136:139], v[164:167], v[208:211], v[136:139]
v_mfma_f32_16x16x32_bf16 v[152:155], v[164:167], v[212:215], v[152:155]
ds_read_b128 v[176:179], v30 offset:4096
s_waitcnt lgkmcnt(2)
v_mfma_f32_16x16x32_bf16 v[120:123], v[168:171], v[216:219], v[120:123]
s_add_u32 m0, s63, 0x0
s_nop 0
buffer_load_dwordx4 v21, s[48:51], s81 offen offset:0 lds
buffer_load_dwordx4 v22, s[48:51], s81 offen offset:1024 lds
buffer_load_dwordx4 v23, s[48:51], s81 offen offset:2048 lds
buffer_load_dwordx4 v24, s[48:51], s81 offen offset:3072 lds
v_mfma_f32_16x16x32_bf16 v[136:139], v[168:171], v[220:223], v[136:139]
buffer_store_dwordx4 v[44:47], v16, s[56:59], s64 offen offset:0 sc1
buffer_store_dwordx4 v[48:51], v16, s[56:59], s64 offen offset:1024 sc1
v_mfma_f32_16x16x32_bf16 v[152:155], v[168:171], v[224:227], v[152:155]
ds_read_b128 v[180:183], v29 offset:6144
buffer_store_dwordx4 v[52:55], v16, s[56:59], s64 offen offset:2048 sc1
s_waitcnt lgkmcnt(2)
v_mfma_f32_16x16x32_bf16 v[124:127], v[172:175], v[204:207], v[124:127]
buffer_store_dwordx4 v[56:59], v16, s[56:59], s64 offen offset:3072 sc1
buffer_store_dwordx4 v[60:63], v16, s[56:59], s65 offen offset:0 sc1
v_mfma_f32_16x16x32_bf16 v[140:143], v[172:175], v[208:211], v[140:143]
buffer_store_dwordx4 v[64:67], v16, s[56:59], s65 offen offset:1024 sc1
v_mfma_f32_16x16x32_bf16 v[156:159], v[172:175], v[212:215], v[156:159]
ds_read_b128 v[184:187], v30 offset:6144
s_waitcnt lgkmcnt(2)
v_mfma_f32_16x16x32_bf16 v[124:127], v[176:179], v[216:219], v[124:127]
v_mfma_f32_16x16x32_bf16 v[140:143], v[176:179], v[220:223], v[140:143]
v_mfma_f32_16x16x32_bf16 v[156:159], v[176:179], v[224:227], v[156:159]
ds_read_b128 v[228:231], v35 offset:6144
s_waitcnt vmcnt(10)
ds_read_b128 v[188:191], v29 offset:8192
s_waitcnt lgkmcnt(3)
v_mfma_f32_16x16x32_bf16 v[128:131], v[180:183], v[204:207], v[128:131]
ds_read_b128 v[232:235], v35 offset:14336
v_mfma_f32_16x16x32_bf16 v[144:147], v[180:183], v[208:211], v[144:147]
ds_read_b128 v[236:239], v35 offset:22528
v_mfma_f32_16x16x32_bf16 v[160:163], v[180:183], v[212:215], v[160:163]
ds_read_b128 v[204:207], v35 offset:7168
ds_read_b128 v[192:195], v30 offset:8192
s_waitcnt lgkmcnt(6)
v_mfma_f32_16x16x32_bf16 v[128:131], v[184:187], v[216:219], v[128:131]
ds_read_b128 v[208:211], v35 offset:15360
v_mfma_f32_16x16x32_bf16 v[144:147], v[184:187], v[220:223], v[144:147]
ds_read_b128 v[212:215], v35 offset:23552
v_mfma_f32_16x16x32_bf16 v[160:163], v[184:187], v[224:227], v[160:163]
ds_read_b128 v[196:199], v29 offset:10240
s_waitcnt lgkmcnt(7)
v_mfma_f32_16x16x32_bf16 v[116:119], v[188:191], v[228:231], v[116:119]
s_waitcnt lgkmcnt(6)
v_mfma_f32_16x16x32_bf16 v[132:135], v[188:191], v[232:235], v[132:135]
s_waitcnt lgkmcnt(5)
v_mfma_f32_16x16x32_bf16 v[148:151], v[188:191], v[236:239], v[148:151]
ds_read_b128 v[200:203], v30 offset:10240
s_waitcnt lgkmcnt(4)
v_mfma_f32_16x16x32_bf16 v[116:119], v[192:195], v[204:207], v[116:119]
s_waitcnt lgkmcnt(3)
v_mfma_f32_16x16x32_bf16 v[132:135], v[192:195], v[208:211], v[132:135]
s_waitcnt lgkmcnt(2)
v_mfma_f32_16x16x32_bf16 v[148:151], v[192:195], v[212:215], v[148:151]
s_waitcnt vmcnt(6)
ds_read_b128 v[164:167], v29 offset:0
s_waitcnt lgkmcnt(2)
v_mfma_f32_16x16x32_bf16 v[120:123], v[196:199], v[228:231], v[120:123]
v_mfma_f32_16x16x32_bf16 v[136:139], v[196:199], v[232:235], v[136:139]
v_mfma_f32_16x16x32_bf16 v[152:155], v[196:199], v[236:239], v[152:155]
ds_read_b128 v[168:171], v30 offset:0
s_waitcnt lgkmcnt(2)
v_mfma_f32_16x16x32_bf16 v[120:123], v[200:203], v[204:207], v[120:123]
v_mfma_f32_16x16x32_bf16 v[136:139], v[200:203], v[208:211], v[136:139]
v_mfma_f32_16x16x32_bf16 v[152:155], v[200:203], v[212:215], v[152:155]
ds_read_b128 v[172:175], v29 offset:2048
s_waitcnt lgkmcnt(2)
v_mfma_f32_16x16x32_bf16 v[124:127], v[164:167], v[228:231], v[124:127]
v_mul_f32 v116, s86, v116
v_mul_f32 v117, s86, v117
v_mul_f32 v118, s86, v118
v_mul_f32 v119, s86, v119
v_mul_f32 v120, s86, v120
v_mul_f32 v121, s86, v121
v_mul_f32 v122, s86, v122
v_mul_f32 v123, s86, v123
v_cvt_pk_bf16_f32 v116, v116, v117
v_cvt_pk_bf16_f32 v117, v118, v119
v_cvt_pk_bf16_f32 v118, v120, v121
v_cvt_pk_bf16_f32 v119, v122, v123
buffer_store_dwordx4 v[116:119], v16, s[52:55], s82 offen offset:0 sc1
v_mfma_f32_16x16x32_bf16 v[140:143], v[164:167], v[232:235], v[140:143]
v_mul_f32 v132, s86, v132
v_mul_f32 v133, s86, v133
v_mul_f32 v134, s86, v134
v_mul_f32 v135, s86, v135
v_mul_f32 v136, s86, v136
v_mul_f32 v137, s86, v137
v_mul_f32 v138, s86, v138
v_mul_f32 v139, s86, v139
v_cvt_pk_bf16_f32 v132, v132, v133
v_cvt_pk_bf16_f32 v133, v134, v135
v_cvt_pk_bf16_f32 v134, v136, v137
v_cvt_pk_bf16_f32 v135, v138, v139
buffer_store_dwordx4 v[132:135], v16, s[52:55], s83 offen offset:0 sc1
v_mfma_f32_16x16x32_bf16 v[156:159], v[164:167], v[236:239], v[156:159]
ds_read_b128 v[176:179], v30 offset:2048
v_mul_f32 v148, s86, v148
v_mul_f32 v149, s86, v149
v_mul_f32 v150, s86, v150
v_mul_f32 v151, s86, v151
v_mul_f32 v152, s86, v152
v_mul_f32 v153, s86, v153
v_mul_f32 v154, s86, v154
v_mul_f32 v155, s86, v155
v_cvt_pk_bf16_f32 v148, v148, v149
v_cvt_pk_bf16_f32 v149, v150, v151
v_cvt_pk_bf16_f32 v150, v152, v153
v_cvt_pk_bf16_f32 v151, v154, v155
buffer_store_dwordx4 v[148:151], v16, s[52:55], s84 offen offset:0 sc1
s_waitcnt lgkmcnt(2)
v_mfma_f32_16x16x32_bf16 v[124:127], v[168:171], v[204:207], v[124:127]
v_mfma_f32_16x16x32_bf16 v[140:143], v[168:171], v[208:211], v[140:143]
v_mfma_f32_16x16x32_bf16 v[156:159], v[168:171], v[212:215], v[156:159]
s_waitcnt lgkmcnt(1)
v_mfma_f32_16x16x32_bf16 v[128:131], v[172:175], v[228:231], v[128:131]
v_mfma_f32_16x16x32_bf16 v[144:147], v[172:175], v[232:235], v[144:147]
v_mfma_f32_16x16x32_bf16 v[160:163], v[172:175], v[236:239], v[160:163]
s_waitcnt lgkmcnt(0)
v_mfma_f32_16x16x32_bf16 v[128:131], v[176:179], v[204:207], v[128:131]
v_mfma_f32_16x16x32_bf16 v[144:147], v[176:179], v[208:211], v[144:147]
v_mfma_f32_16x16x32_bf16 v[160:163], v[176:179], v[212:215], v[160:163]
v_mul_f32 v124, s86, v124
v_mul_f32 v125, s86, v125
v_mul_f32 v126, s86, v126
v_mul_f32 v127, s86, v127
s_nop 1
v_mul_f32 v128, s86, v128
v_mul_f32 v129, s86, v129
v_mul_f32 v130, s86, v130
v_mul_f32 v131, s86, v131
v_cvt_pk_bf16_f32 v124, v124, v125
v_cvt_pk_bf16_f32 v125, v126, v127
v_cvt_pk_bf16_f32 v126, v128, v129
v_cvt_pk_bf16_f32 v127, v130, v131
buffer_store_dwordx4 v[124:127], v16, s[52:55], s82 offen offset:1024 sc1
v_mul_f32 v140, s86, v140
v_mul_f32 v141, s86, v141
v_mul_f32 v142, s86, v142
v_mul_f32 v143, s86, v143
v_mul_f32 v144, s86, v144
v_mul_f32 v145, s86, v145
v_mul_f32 v146, s86, v146
v_mul_f32 v147, s86, v147
v_cvt_pk_bf16_f32 v140, v140, v141
v_cvt_pk_bf16_f32 v141, v142, v143
v_cvt_pk_bf16_f32 v142, v144, v145
v_cvt_pk_bf16_f32 v143, v146, v147
buffer_store_dwordx4 v[140:143], v16, s[52:55], s83 offen offset:1024 sc1
v_mul_f32 v156, s86, v156
v_mul_f32 v157, s86, v157
v_mul_f32 v158, s86, v158
v_mul_f32 v159, s86, v159
v_mul_f32 v160, s86, v160
v_mul_f32 v161, s86, v161
v_mul_f32 v162, s86, v162
v_mul_f32 v163, s86, v163
v_cvt_pk_bf16_f32 v156, v156, v157
v_cvt_pk_bf16_f32 v157, v158, v159
v_cvt_pk_bf16_f32 v158, v160, v161
v_cvt_pk_bf16_f32 v159, v162, v163
buffer_store_dwordx4 v[156:159], v16, s[52:55], s84 offen offset:1024 sc1
L1_fin:
s_add_u32 s91, s91, 1344
s_waitcnt lgkmcnt(0)
s_add_u32 s98, s98, 0x7f4a7c15
s_addc_u32 s99, s99, 0x9e3779b9
LM_pub:
s_add_u32 s40, s38, 0x7c00000
s_addc_u32 s41, s39, 0
s_mov_b32 s42, 0x40000
s_mov_b32 s43, 0x00020000
s_lshl_b32 s6, s91, 7
s_cmp_eq_u32 s60, 0
s_cselect_b32 s6, s6, 0x70000000
s_waitcnt vmcnt(0) lgkmcnt(0)
s_barrier
v_mov_b32 v6, s98
v_mov_b32 v7, s99
s_mov_b64 exec, 1
buffer_store_dwordx2 v[6:7], off, s[40:43], s6 sc1
s_mov_b64 exec, -1
s_cmp_eq_u32 s61, 0
s_cbranch_scc1 L2_entry
s_mov_b32 s61, 0
s_sub_u32 s4, s91, 1584
s_add_u32 s91, s4, 1600
v_lshlrev_b32 v16, 4, v2
s_mul_i32 s63, s60, 12288
s_and_b32 s6, s4, 3
s_lshl_b32 s6, s6, 6
s_mul_i32 s7, s60, 16
s_add_u32 s6, s6, s7
v_lshrrev_b32 v5, 5, v2
v_and_b32 v6, 31, v2
v_lshlrev_b32 v6, 4, v6
s_cmp_ge_u32 s4, 4
s_cselect_b64 vcc, -1, 0
v_add3_u32 v7, v5, s6, 0
v_and_b32 v8, 0x80, v7
v_bfe_u32 v9, v7, 2, 1
v_lshl_or_b32 v8, v9, 6, v8
v_bfe_u32 v9, v7, 4, 1
v_lshl_or_b32 v8, v9, 5, v8
v_and_b32 v9, 3, v7
v_lshl_or_b32 v8, v9, 3, v8
v_bfe_u32 v9, v7, 5, 2
v_lshl_or_b32 v8, v9, 1, v8
v_bfe_u32 v9, v7, 3, 1
v_or_b32 v8, v9, v8
v_cndmask_b32 v8, v8, v7, vcc
v_lshl_add_u32 v44, v8, 9, v6
v_add3_u32 v7, v5, s6, 2
v_and_b32 v8, 0x80, v7
v_bfe_u32 v9, v7, 2, 1
v_lshl_or_b32 v8, v9, 6, v8
v_bfe_u32 v9, v7, 4, 1
v_lshl_or_b32 v8, v9, 5, v8
v_and_b32 v9, 3, v7
v_lshl_or_b32 v8, v9, 3, v8
v_bfe_u32 v9, v7, 5, 2
v_lshl_or_b32 v8, v9, 1, v8
v_bfe_u32 v9, v7, 3, 1
v_or_b32 v8, v9, v8
v_cndmask_b32 v8, v8, v7, vcc
v_lshl_add_u32 v48, v8, 9, v6
v_add3_u32 v7, v5, s6, 4
v_and_b32 v8, 0x80, v7
v_bfe_u32 v9, v7, 2, 1
v_lshl_or_b32 v8, v9, 6, v8
v_bfe_u32 v9, v7, 4, 1
v_lshl_or_b32 v8, v9, 5, v8
v_and_b32 v9, 3, v7
v_lshl_or_b32 v8, v9, 3, v8
v_bfe_u32 v9, v7, 5, 2
v_lshl_or_b32 v8, v9, 1, v8
v_bfe_u32 v9, v7, 3, 1
v_or_b32 v8, v9, v8
v_cndmask_b32 v8, v8, v7, vcc
v_lshl_add_u32 v52, v8, 9, v6
v_add3_u32 v7, v5, s6, 6
v_and_b32 v8, 0x80, v7
v_bfe_u32 v9, v7, 2, 1
v_lshl_or_b32 v8, v9, 6, v8
v_bfe_u32 v9, v7, 4, 1
v_lshl_or_b32 v8, v9, 5, v8
v_and_b32 v9, 3, v7
v_lshl_or_b32 v8, v9, 3, v8
v_bfe_u32 v9, v7, 5, 2
v_lshl_or_b32 v8, v9, 1, v8
v_bfe_u32 v9, v7, 3, 1
v_or_b32 v8, v9, v8
v_cndmask_b32 v8, v8, v7, vcc
v_lshl_add_u32 v56, v8, 9, v6
v_add3_u32 v7, v5, s6, 8
v_and_b32 v8, 0x80, v7
v_bfe_u32 v9, v7, 2, 1
v_lshl_or_b32 v8, v9, 6, v8
v_bfe_u32 v9, v7, 4, 1
v_lshl_or_b32 v8, v9, 5, v8
v_and_b32 v9, 3, v7
v_lshl_or_b32 v8, v9, 3, v8
v_bfe_u32 v9, v7, 5, 2
v_lshl_or_b32 v8, v9, 1, v8
v_bfe_u32 v9, v7, 3, 1
v_or_b32 v8, v9, v8
v_cndmask_b32 v8, v8, v7, vcc
v_lshl_add_u32 v60, v8, 9, v6
v_add3_u32 v7, v5, s6, 10
v_and_b32 v8, 0x80, v7
v_bfe_u32 v9, v7, 2, 1
v_lshl_or_b32 v8, v9, 6, v8
v_bfe_u32 v9, v7, 4, 1
v_lshl_or_b32 v8, v9, 5, v8
v_and_b32 v9, 3, v7
v_lshl_or_b32 v8, v9, 3, v8
v_bfe_u32 v9, v7, 5, 2
v_lshl_or_b32 v8, v9, 1, v8
v_bfe_u32 v9, v7, 3, 1
v_or_b32 v8, v9, v8
v_cndmask_b32 v8, v8, v7, vcc
v_lshl_add_u32 v64, v8, 9, v6
v_add3_u32 v7, v5, s6, 12
v_and_b32 v8, 0x80, v7
v_bfe_u32 v9, v7, 2, 1
v_lshl_or_b32 v8, v9, 6, v8
v_bfe_u32 v9, v7, 4, 1
v_lshl_or_b32 v8, v9, 5, v8
v_and_b32 v9, 3, v7
v_lshl_or_b32 v8, v9, 3, v8
v_bfe_u32 v9, v7, 5, 2
v_lshl_or_b32 v8, v9, 1, v8
v_bfe_u32 v9, v7, 3, 1
v_or_b32 v8, v9, v8
v_cndmask_b32 v8, v8, v7, vcc
v_lshl_add_u32 v68, v8, 9, v6
v_add3_u32 v7, v5, s6, 14
v_and_b32 v8, 0x80, v7
v_bfe_u32 v9, v7, 2, 1
v_lshl_or_b32 v8, v9, 6, v8
v_bfe_u32 v9, v7, 4, 1
v_lshl_or_b32 v8, v9, 5, v8
v_and_b32 v9, 3, v7
v_lshl_or_b32 v8, v9, 3, v8
v_bfe_u32 v9, v7, 5, 2
v_lshl_or_b32 v8, v9, 1, v8
v_bfe_u32 v9, v7, 3, 1
v_or_b32 v8, v9, v8
v_cndmask_b32 v8, v8, v7, vcc
v_lshl_add_u32 v72, v8, 9, v6
s_lshl_b32 s7, s60, 7
v_lshrrev_b32 v5, 3, v2
v_and_b32 v6, 7, v2
v_and_b32 v7, 2, v5
v_xor_b32 v6, v6, v7
v_lshl_add_u32 v5, v5, 9, s7
v_lshl_add_u32 v17, v6, 4, v5
v_xor_b32 v6, 4, v6
v_lshl_add_u32 v18, v6, 4, v5
v_add_u32 v18, 0xc00, v18
v_add_u32 v19, 0x1800, v17
v_add_u32 v20, 0x1800, v18
s_xor_b32 s6, s62, 0
s_lshl_b32 s66, s6, 14
s_xor_b32 s6, s62, 1
s_lshl_b32 s67, s6, 14
s_xor_b32 s6, s62, 2
s_lshl_b32 s68, s6, 14
s_xor_b32 s6, s62, 3
s_lshl_b32 s69, s6, 14
s_xor_b32 s6, s62, 4
s_lshl_b32 s70, s6, 14
s_xor_b32 s6, s62, 5
s_lshl_b32 s71, s6, 14
s_xor_b32 s6, s62, 6
s_lshl_b32 s72, s6, 14
s_xor_b32 s6, s62, 7
s_lshl_b32 s73, s6, 14
s_waitcnt lgkmcnt(0)
s_cmp_ge_u32 s4, 4
s_cselect_b32 s6, s30, s24
s_cselect_b32 s7, s31, s25
s_add_u32 s40, s6, 0x0
s_addc_u32 s41, s7, 0
s_mov_b32 s42, 0x20000
s_mov_b32 s43, 0x00020000
s_add_u32 s44, s32, 0x0
s_addc_u32 s45, s33, 0
s_mov_b32 s46, 0x20000
s_mov_b32 s47, 0x00020000
buffer_load_dwordx4 v[44:47], v44, s[40:43], 0 offen
buffer_load_dwordx4 v[48:51], v48, s[40:43], 0 offen
buffer_load_dwordx4 v[52:55], v52, s[40:43], 0 offen
buffer_load_dwordx4 v[56:59], v56, s[40:43], 0 offen
buffer_load_dwordx4 v[60:63], v60, s[40:43], 0 offen
buffer_load_dwordx4 v[64:67], v64, s[40:43], 0 offen
buffer_load_dwordx4 v[68:71], v68, s[40:43], 0 offen
buffer_load_dwordx4 v[72:75], v72, s[40:43], 0 offen
s_add_u32 m0, s63, 0x0
s_nop 0
buffer_load_dwordx4 v17, s[44:47], s66 offen offset:0 lds
buffer_load_dwordx4 v18, s[44:47], s66 offen offset:1024 lds
buffer_load_dwordx4 v19, s[44:47], s66 offen offset:2048 lds
buffer_load_dwordx4 v20, s[44:47], s66 offen offset:3072 lds
s_add_u32 m0, s63, 0x1000
s_nop 0
buffer_load_dwordx4 v17, s[44:47], s67 offen offset:0 lds
buffer_load_dwordx4 v18, s[44:47], s67 offen offset:1024 lds
buffer_load_dwordx4 v19, s[44:47], s67 offen offset:2048 lds
buffer_load_dwordx4 v20, s[44:47], s67 offen offset:3072 lds
v_bfe_u32 v5, v2, 2, 3
v_xor_b32 v5, s62, v5
v_and_b32 v6, 3, v2
v_lshlrev_b32 v7, 10, v5
v_lshl_add_u32 v7, v6, 8, v7
v_add_u32 v7, 0xc000, v7
v_and_b32 v5, 1, v5
v_lshl_or_b32 v6, v5, 2, v6
v_lshrrev_b32 v5, 5, v2
s_mul_i32 s6, s60, 16
v_add3_u32 v8, v5, s6, 0
v_lshrrev_b32 v9, 4, v8
v_lshl_add_u32 v9, v9, 13, v7
v_and_b32 v8, 15, v8
v_xor_b32 v8, v8, v6
v_lshl_add_u32 v36, v8, 4, v9
v_add3_u32 v8, v5, s6, 2
v_lshrrev_b32 v9, 4, v8
v_lshl_add_u32 v9, v9, 13, v7
v_and_b32 v8, 15, v8
v_xor_b32 v8, v8, v6
v_lshl_add_u32 v37, v8, 4, v9
v_add3_u32 v8, v5, s6, 4
v_lshrrev_b32 v9, 4, v8
v_lshl_add_u32 v9, v9, 13, v7
v_and_b32 v8, 15, v8
v_xor_b32 v8, v8, v6
v_lshl_add_u32 v38, v8, 4, v9
v_add3_u32 v8, v5, s6, 6
v_lshrrev_b32 v9, 4, v8
v_lshl_add_u32 v9, v9, 13, v7
v_and_b32 v8, 15, v8
v_xor_b32 v8, v8, v6
v_lshl_add_u32 v39, v8, 4, v9
v_add3_u32 v8, v5, s6, 8
v_lshrrev_b32 v9, 4, v8
v_lshl_add_u32 v9, v9, 13, v7
v_and_b32 v8, 15, v8
v_xor_b32 v8, v8, v6
v_lshl_add_u32 v40, v8, 4, v9
v_add3_u32 v8, v5, s6, 10
v_lshrrev_b32 v9, 4, v8
v_lshl_add_u32 v9, v9, 13, v7
v_and_b32 v8, 15, v8
v_xor_b32 v8, v8, v6
v_lshl_add_u32 v41, v8, 4, v9
v_add3_u32 v8, v5, s6, 12
v_lshrrev_b32 v9, 4, v8
v_lshl_add_u32 v9, v9, 13, v7
v_and_b32 v8, 15, v8
v_xor_b32 v8, v8, v6
v_lshl_add_u32 v42, v8, 4, v9
v_add3_u32 v8, v5, s6, 14
v_lshrrev_b32 v9, 4, v8
v_lshl_add_u32 v9, v9, 13, v7
v_and_b32 v8, 15, v8
v_xor_b32 v8, v8, v6
v_lshl_add_u32 v43, v8, 4, v9
v_xor_b32 v5, v3, v4
v_lshlrev_b32 v5, 4, v5
v_lshl_add_u32 v5, v4, 8, v5
v_add_u32 v31, 0xc000, v5
v_xor_b32 v32, 64, v31
v_lshrrev_b32 v5, 2, v3
v_and_b32 v6, 3, v3
v_and_b32 v7, 1, v4
v_lshlrev_b32 v7, 2, v7
v_and_b32 v8, 2, v5
v_or_b32 v7, v7, v8
v_lshl_add_u32 v8, v4, 3, v5
v_lshlrev_b32 v8, 7, v8
v_add_u32 v8, s63, v8
v_xor_b32 v6, v6, v7
v_xor_b32 v9, 0, v6
v_lshl_add_u32 v25, v9, 4, v8
v_add_u32 v26, 8, v25
v_xor_b32 v9, 4, v6
v_lshl_add_u32 v27, v9, 4, v8
v_add_u32 v28, 8, v27
s_lshr_b32 s6, s4, 2
s_lshl_b32 s6, s6, 17
s_and_b32 s7, s4, 3
s_lshl_b32 s7, s7, 12
s_add_u32 s6, s6, s7
s_mul_i32 s7, s60, 32768
s_add_u32 s82, s6, s7
s_add_u32 s83, s82, 16384
s_add_u32 s52, s38, 0x1000000
s_addc_u32 s53, s39, 0
s_mov_b32 s54, 0x40000
s_mov_b32 s55, 0x00020000
s_waitcnt vmcnt(15)
ds_write_b128 v36, v[44:47]
s_waitcnt vmcnt(14)
ds_write_b128 v37, v[48:51]
s_waitcnt vmcnt(13)
ds_write_b128 v38, v[52:55]
s_waitcnt vmcnt(12)
ds_write_b128 v39, v[56:59]
s_waitcnt vmcnt(11)
ds_write_b128 v40, v[60:63]
s_waitcnt vmcnt(10)
ds_write_b128 v41, v[64:67]
s_waitcnt vmcnt(9)
ds_write_b128 v42, v[68:71]
s_waitcnt vmcnt(8)
ds_write_b128 v43, v[72:75]
s_add_u32 m0, s63, 0x2000
s_nop 0
buffer_load_dwordx4 v17, s[44:47], s68 offen offset:0 lds
buffer_load_dwordx4 v18, s[44:47], s68 offen offset:1024 lds
buffer_load_dwordx4 v19, s[44:47], s68 offen offset:2048 lds
buffer_load_dwordx4 v20, s[44:47], s68 offen offset:3072 lds
s_waitcnt vmcnt(8)
ds_read_b64_tr_b16 v[140:141], v25 offset:0
ds_read_b64_tr_b16 v[142:143], v25 offset:512
ds_read_b64_tr_b16 v[144:145], v26 offset:0
ds_read_b64_tr_b16 v[146:147], v26 offset:512
ds_read_b64_tr_b16 v[148:149], v27 offset:0
ds_read_b64_tr_b16 v[150:151], v27 offset:512
s_waitcnt lgkmcnt(6)
s_barrier
ds_read_b128 v[180:183], v31 offset:0
ds_read_b128 v[184:187], v31 offset:8192
ds_read_b128 v[188:191], v31 offset:16384
ds_read_b128 v[192:195], v31 offset:24576
s_waitcnt lgkmcnt(3)
v_mfma_f32_16x16x32_bf16 v[76:79], v[180:183], v[140:143], 0
s_waitcnt lgkmcnt(2)
v_mfma_f32_16x16x32_bf16 v[80:83], v[184:187], v[140:143], 0
s_waitcnt lgkmcnt(1)
v_mfma_f32_16x16x32_bf16 v[84:87], v[188:191], v[140:143], 0
s_waitcnt lgkmcnt(0)
v_mfma_f32_16x16x32_bf16 v[88:91], v[192:195], v[140:143], 0
ds_read_b64_tr_b16 v[152:153], v28 offset:0
ds_read_b64_tr_b16 v[154:155], v28 offset:512
v_mfma_f32_16x16x32_bf16 v[92:95], v[180:183], v[144:147], 0
v_mfma_f32_16x16x32_bf16 v[96:99], v[184:187], v[144:147], 0
v_mfma_f32_16x16x32_bf16 v[100:103], v[188:191], v[144:147], 0
v_mfma_f32_16x16x32_bf16 v[104:107], v[192:195], v[144:147], 0
ds_read_b128 v[196:199], v32 offset:1024
s_waitcnt vmcnt(4)
ds_read_b64_tr_b16 v[156:157], v25 offset:4096
ds_read_b64_tr_b16 v[158:159], v25 offset:4608
v_mfma_f32_16x16x32_bf16 v[108:111], v[180:183], v[148:151], 0
ds_read_b128 v[200:203], v32 offset:9216
v_mfma_f32_16x16x32_bf16 v[112:115], v[184:187], v[148:151], 0
ds_read_b128 v[204:207], v32 offset:17408
v_mfma_f32_16x16x32_bf16 v[116:119], v[188:191], v[148:151], 0
ds_read_b128 v[208:211], v32 offset:25600
v_mfma_f32_16x16x32_bf16 v[120:123], v[192:195], v[148:151], 0
ds_read_b64_tr_b16 v[160:161], v26 offset:4096
ds_read_b64_tr_b16 v[162:163], v26 offset:4608
s_waitcnt lgkmcnt(8)
v_mfma_f32_16x16x32_bf16 v[124:127], v[180:183], v[152:155], 0
s_add_u32 m0, s63, 0x0
s_nop 0
buffer_load_dwordx4 v17, s[44:47], s69 offen offset:0 lds
buffer_load_dwordx4 v18, s[44:47], s69 offen offset:1024 lds
buffer_load_dwordx4 v19, s[44:47], s69 offen offset:2048 lds
buffer_load_dwordx4 v20, s[44:47], s69 offen offset:3072 lds
v_mfma_f32_16x16x32_bf16 v[128:131], v[184:187], v[152:155], 0
v_mfma_f32_16x16x32_bf16 v[132:135], v[188:191], v[152:155], 0
v_mfma_f32_16x16x32_bf16 v[136:139], v[192:195], v[152:155], 0
ds_read_b64_tr_b16 v[164:165], v27 offset:4096
ds_read_b64_tr_b16 v[166:167], v27 offset:4608
s_waitcnt lgkmcnt(7)
v_mfma_f32_16x16x32_bf16 v[76:79], v[196:199], v[156:159], v[76:79]
s_waitcnt lgkmcnt(6)
v_mfma_f32_16x16x32_bf16 v[80:83], v[200:203], v[156:159], v[80:83]
s_waitcnt lgkmcnt(5)
v_mfma_f32_16x16x32_bf16 v[84:87], v[204:207], v[156:159], v[84:87]
s_waitcnt lgkmcnt(4)
v_mfma_f32_16x16x32_bf16 v[88:91], v[208:211], v[156:159], v[88:91]
ds_read_b64_tr_b16 v[168:169], v28 offset:4096
ds_read_b64_tr_b16 v[170:171], v28 offset:4608
s_waitcnt lgkmcnt(4)
v_mfma_f32_16x16x32_bf16 v[92:95], v[196:199], v[160:163], v[92:95]
v_mfma_f32_16x16x32_bf16 v[96:99], v[200:203], v[160:163], v[96:99]
v_mfma_f32_16x16x32_bf16 v[100:103], v[204:207], v[160:163], v[100:103]
v_mfma_f32_16x16x32_bf16 v[104:107], v[208:211], v[160:163], v[104:107]
ds_read_b128 v[212:215], v31 offset:2048
s_waitcnt vmcnt(4)
ds_read_b64_tr_b16 v[172:173], v25 offset:8192
ds_read_b64_tr_b16 v[174:175], v25 offset:8704
s_waitcnt lgkmcnt(5)
v_mfma_f32_16x16x32_bf16 v[108:111], v[196:199], v[164:167], v[108:111]
ds_read_b128 v[216:219], v31 offset:10240
v_mfma_f32_16x16x32_bf16 v[112:115], v[200:203], v[164:167], v[112:115]
ds_read_b128 v[220:223], v31 offset:18432
v_mfma_f32_16x16x32_bf16 v[116:119], v[204:207], v[164:167], v[116:119]
ds_read_b128 v[224:227], v31 offset:26624
v_mfma_f32_16x16x32_bf16 v[120:123], v[208:211], v[164:167], v[120:123]
ds_read_b64_tr_b16 v[176:177], v26 offset:8192
ds_read_b64_tr_b16 v[178:179], v26 offset:8704
s_waitcnt lgkmcnt(8)
v_mfma_f32_16x16x32_bf16 v[124:127], v[196:199], v[168:171], v[124:127]
s_add_u32 m0, s63, 0x1000
s_nop 0
buffer_load_dwordx4 v17, s[44:47], s70 offen offset:0 lds
buffer_load_dwordx4 v18, s[44:47], s70 offen offset:1024 lds
buffer_load_dwordx4 v19, s[44:47], s70 offen offset:2048 lds
buffer_load_dwordx4 v20, s[44:47], s70 offen offset:3072 lds
v_mfma_f32_16x16x32_bf16 v[128:131], v[200:203], v[168:171], v[128:131]
v_mfma_f32_16x16x32_bf16 v[132:135], v[204:207], v[168:171], v[132:135]
v_mfma_f32_16x16x32_bf16 v[136:139], v[208:211], v[168:171], v[136:139]
ds_read_b64_tr_b16 v[140:141], v27 offset:8192
ds_read_b64_tr_b16 v[142:143], v27 offset:8704
s_waitcnt lgkmcnt(7)
v_mfma_f32_16x16x32_bf16 v[76:79], v[212:215], v[172:175], v[76:79]
s_waitcnt lgkmcnt(6)
v_mfma_f32_16x16x32_bf16 v[80:83], v[216:219], v[172:175], v[80:83]
s_waitcnt lgkmcnt(5)
v_mfma_f32_16x16x32_bf16 v[84:87], v[220:223], v[172:175], v[84:87]
s_waitcnt lgkmcnt(4)
v_mfma_f32_16x16x32_bf16 v[88:91], v[224:227], v[172:175], v[88:91]
ds_read_b64_tr_b16 v[144:145], v28 offset:8192
ds_read_b64_tr_b16 v[146:147], v28 offset:8704
s_waitcnt lgkmcnt(4)
v_mfma_f32_16x16x32_bf16 v[92:95], v[212:215], v[176:179], v[92:95]
v_mfma_f32_16x16x32_bf16 v[96:99], v[216:219], v[176:179], v[96:99]
v_mfma_f32_16x16x32_bf16 v[100:103], v[220:223], v[176:179], v[100:103]
v_mfma_f32_16x16x32_bf16 v[104:107], v[224:227], v[176:179], v[104:107]
ds_read_b128 v[180:183], v32 offset:3072
s_waitcnt vmcnt(4)
ds_read_b64_tr_b16 v[148:149], v25 offset:0
ds_read_b64_tr_b16 v[150:151], v25 offset:512
s_waitcnt lgkmcnt(5)
v_mfma_f32_16x16x32_bf16 v[108:111], v[212:215], v[140:143], v[108:111]
ds_read_b128 v[184:187], v32 offset:11264
v_mfma_f32_16x16x32_bf16 v[112:115], v[216:219], v[140:143], v[112:115]
ds_read_b128 v[188:191], v32 offset:19456
v_mfma_f32_16x16x32_bf16 v[116:119], v[220:223], v[140:143], v[116:119]
ds_read_b128 v[192:195], v32 offset:27648
v_mfma_f32_16x16x32_bf16 v[120:123], v[224:227], v[140:143], v[120:123]
ds_read_b64_tr_b16 v[152:153], v26 offset:0
ds_read_b64_tr_b16 v[154:155], v26 offset:512
s_waitcnt lgkmcnt(8)
v_mfma_f32_16x16x32_bf16 v[124:127], v[212:215], v[144:147], v[124:127]
s_add_u32 m0, s63, 0x2000
s_nop 0
buffer_load_dwordx4 v17, s[44:47], s71 offen offset:0 lds
buffer_load_dwordx4 v18, s[44:47], s71 offen offset:1024 lds
buffer_load_dwordx4 v19, s[44:47], s71 offen offset:2048 lds
buffer_load_dwordx4 v20, s[44:47], s71 offen offset:3072 lds
v_mfma_f32_16x16x32_bf16 v[128:131], v[216:219], v[144:147], v[128:131]
v_mfma_f32_16x16x32_bf16 v[132:135], v[220:223], v[144:147], v[132:135]
v_mfma_f32_16x16x32_bf16 v[136:139], v[224:227], v[144:147], v[136:139]
ds_read_b64_tr_b16 v[156:157], v27 offset:0
ds_read_b64_tr_b16 v[158:159], v27 offset:512
s_waitcnt lgkmcnt(7)
v_mfma_f32_16x16x32_bf16 v[76:79], v[180:183], v[148:151], v[76:79]
s_waitcnt lgkmcnt(6)
v_mfma_f32_16x16x32_bf16 v[80:83], v[184:187], v[148:151], v[80:83]
s_waitcnt lgkmcnt(5)
v_mfma_f32_16x16x32_bf16 v[84:87], v[188:191], v[148:151], v[84:87]
s_waitcnt lgkmcnt(4)
v_mfma_f32_16x16x32_bf16 v[88:91], v[192:195], v[148:151], v[88:91]
ds_read_b64_tr_b16 v[160:161], v28 offset:0
ds_read_b64_tr_b16 v[162:163], v28 offset:512
s_waitcnt lgkmcnt(4)
v_mfma_f32_16x16x32_bf16 v[92:95], v[180:183], v[152:155], v[92:95]
v_mfma_f32_16x16x32_bf16 v[96:99], v[184:187], v[152:155], v[96:99]
v_mfma_f32_16x16x32_bf16 v[100:103], v[188:191], v[152:155], v[100:103]
v_mfma_f32_16x16x32_bf16 v[104:107], v[192:195], v[152:155], v[104:107]
ds_read_b128 v[196:199], v31 offset:4096
s_waitcnt vmcnt(4)
ds_read_b64_tr_b16 v[164:165], v25 offset:4096
ds_read_b64_tr_b16 v[166:167], v25 offset:4608
s_waitcnt lgkmcnt(5)
v_mfma_f32_16x16x32_bf16 v[108:111], v[180:183], v[156:159], v[108:111]
ds_read_b128 v[200:203], v31 offset:12288
v_mfma_f32_16x16x32_bf16 v[112:115], v[184:187], v[156:159], v[112:115]
ds_read_b128 v[204:207], v31 offset:20480
v_mfma_f32_16x16x32_bf16 v[116:119], v[188:191], v[156:159], v[116:119]
ds_read_b128 v[208:211], v31 offset:28672
v_mfma_f32_16x16x32_bf16 v[120:123], v[192:195], v[156:159], v[120:123]
ds_read_b64_tr_b16 v[168:169], v26 offset:4096
ds_read_b64_tr_b16 v[170:171], v26 offset:4608
s_waitcnt lgkmcnt(8)
v_mfma_f32_16x16x32_bf16 v[124:127], v[180:183], v[160:163], v[124:127]
s_add_u32 m0, s63, 0x0
s_nop 0
buffer_load_dwordx4 v17, s[44:47], s72 offen offset:0 lds
buffer_load_dwordx4 v18, s[44:47], s72 offen offset:1024 lds
buffer_load_dwordx4 v19, s[44:47], s72 offen offset:2048 lds
buffer_load_dwordx4 v20, s[44:47], s72 offen offset:3072 lds
v_mfma_f32_16x16x32_bf16 v[128:131], v[184:187], v[160:163], v[128:131]
v_mfma_f32_16x16x32_bf16 v[132:135], v[188:191], v[160:163], v[132:135]
v_mfma_f32_16x16x32_bf16 v[136:139], v[192:195], v[160:163], v[136:139]
ds_read_b64_tr_b16 v[172:173], v27 offset:4096
ds_read_b64_tr_b16 v[174:175], v27 offset:4608
s_waitcnt lgkmcnt(7)
v_mfma_f32_16x16x32_bf16 v[76:79], v[196:199], v[164:167], v[76:79]
s_waitcnt lgkmcnt(6)
v_mfma_f32_16x16x32_bf16 v[80:83], v[200:203], v[164:167], v[80:83]
s_waitcnt lgkmcnt(5)
v_mfma_f32_16x16x32_bf16 v[84:87], v[204:207], v[164:167], v[84:87]
s_waitcnt lgkmcnt(4)
v_mfma_f32_16x16x32_bf16 v[88:91], v[208:211], v[164:167], v[88:91]
ds_read_b64_tr_b16 v[176:177], v28 offset:4096
ds_read_b64_tr_b16 v[178:179], v28 offset:4608
s_waitcnt lgkmcnt(4)
v_mfma_f32_16x16x32_bf16 v[92:95], v[196:199], v[168:171], v[92:95]
v_mfma_f32_16x16x32_bf16 v[96:99], v[200:203], v[168:171], v[96:99]
v_mfma_f32_16x16x32_bf16 v[100:103], v[204:207], v[168:171], v[100:103]
v_mfma_f32_16x16x32_bf16 v[104:107], v[208:211], v[168:171], v[104:107]
ds_read_b128 v[212:215], v32 offset:5120
s_waitcnt vmcnt(4)
ds_read_b64_tr_b16 v[140:141], v25 offset:8192
ds_read_b64_tr_b16 v[142:143], v25 offset:8704
s_waitcnt lgkmcnt(5)
v_mfma_f32_16x16x32_bf16 v[108:111], v[196:199], v[172:175], v[108:111]
ds_read_b128 v[216:219], v32 offset:13312
v_mfma_f32_16x16x32_bf16 v[112:115], v[200:203], v[172:175], v[112:115]
ds_read_b128 v[220:223], v32 offset:21504
v_mfma_f32_16x16x32_bf16 v[116:119], v[204:207], v[172:175], v[116:119]
ds_read_b128 v[224:227], v32 offset:29696
v_mfma_f32_16x16x32_bf16 v[120:123], v[208:211], v[172:175], v[120:123]
ds_read_b64_tr_b16 v[144:145], v26 offset:8192
ds_read_b64_tr_b16 v[146:147], v26 offset:8704
s_waitcnt lgkmcnt(8)
v_mfma_f32_16x16x32_bf16 v[124:127], v[196:199], v[176:179], v[124:127]
s_add_u32 m0, s63, 0x1000
s_nop 0
buffer_load_dwordx4 v17, s[44:47], s73 offen offset:0 lds
buffer_load_dwordx4 v18, s[44:47], s73 offen offset:1024 lds
buffer_load_dwordx4 v19, s[44:47], s73 offen offset:2048 lds
buffer_load_dwordx4 v20, s[44:47], s73 offen offset:3072 lds
v_mfma_f32_16x16x32_bf16 v[128:131], v[200:203], v[176:179], v[128:131]
v_mfma_f32_16x16x32_bf16 v[132:135], v[204:207], v[176:179], v[132:135]
v_mfma_f32_16x16x32_bf16 v[136:139], v[208:211], v[176:179], v[136:139]
ds_read_b64_tr_b16 v[148:149], v27 offset:8192
ds_read_b64_tr_b16 v[150:151], v27 offset:8704
s_waitcnt lgkmcnt(7)
v_mfma_f32_16x16x32_bf16 v[76:79], v[212:215], v[140:143], v[76:79]
s_waitcnt lgkmcnt(6)
v_mfma_f32_16x16x32_bf16 v[80:83], v[216:219], v[140:143], v[80:83]
s_waitcnt lgkmcnt(5)
v_mfma_f32_16x16x32_bf16 v[84:87], v[220:223], v[140:143], v[84:87]
s_waitcnt lgkmcnt(4)
v_mfma_f32_16x16x32_bf16 v[88:91], v[224:227], v[140:143], v[88:91]
ds_read_b64_tr_b16 v[152:153], v28 offset:8192
ds_read_b64_tr_b16 v[154:155], v28 offset:8704
s_waitcnt lgkmcnt(4)
v_mfma_f32_16x16x32_bf16 v[92:95], v[212:215], v[144:147], v[92:95]
v_mfma_f32_16x16x32_bf16 v[96:99], v[216:219], v[144:147], v[96:99]
v_mfma_f32_16x16x32_bf16 v[100:103], v[220:223], v[144:147], v[100:103]
v_mfma_f32_16x16x32_bf16 v[104:107], v[224:227], v[144:147], v[104:107]
ds_read_b128 v[180:183], v31 offset:6144
s_waitcnt vmcnt(4)
ds_read_b64_tr_b16 v[156:157], v25 offset:0
ds_read_b64_tr_b16 v[158:159], v25 offset:512
s_waitcnt lgkmcnt(5)
v_mfma_f32_16x16x32_bf16 v[108:111], v[212:215], v[148:151], v[108:111]
ds_read_b128 v[184:187], v31 offset:14336
v_mfma_f32_16x16x32_bf16 v[112:115], v[216:219], v[148:151], v[112:115]
ds_read_b128 v[188:191], v31 offset:22528
v_mfma_f32_16x16x32_bf16 v[116:119], v[220:223], v[148:151], v[116:119]
ds_read_b128 v[192:195], v31 offset:30720
v_mfma_f32_16x16x32_bf16 v[120:123], v[224:227], v[148:151], v[120:123]
ds_read_b64_tr_b16 v[160:161], v26 offset:0
ds_read_b64_tr_b16 v[162:163], v26 offset:512
s_waitcnt lgkmcnt(8)
v_mfma_f32_16x16x32_bf16 v[124:127], v[212:215], v[152:155], v[124:127]
v_mfma_f32_16x16x32_bf16 v[128:131], v[216:219], v[152:155], v[128:131]
v_mfma_f32_16x16x32_bf16 v[132:135], v[220:223], v[152:155], v[132:135]
v_mfma_f32_16x16x32_bf16 v[136:139], v[224:227], v[152:155], v[136:139]
ds_read_b64_tr_b16 v[164:165], v27 offset:0
ds_read_b64_tr_b16 v[166:167], v27 offset:512
s_waitcnt lgkmcnt(7)
v_mfma_f32_16x16x32_bf16 v[76:79], v[180:183], v[156:159], v[76:79]
s_waitcnt lgkmcnt(6)
v_mfma_f32_16x16x32_bf16 v[80:83], v[184:187], v[156:159], v[80:83]
s_waitcnt lgkmcnt(5)
v_mfma_f32_16x16x32_bf16 v[84:87], v[188:191], v[156:159], v[84:87]
s_waitcnt lgkmcnt(4)
v_mfma_f32_16x16x32_bf16 v[88:91], v[192:195], v[156:159], v[88:91]
ds_read_b64_tr_b16 v[168:169], v28 offset:0
ds_read_b64_tr_b16 v[170:171], v28 offset:512
s_waitcnt lgkmcnt(4)
v_mfma_f32_16x16x32_bf16 v[92:95], v[180:183], v[160:163], v[92:95]
v_mfma_f32_16x16x32_bf16 v[96:99], v[184:187], v[160:163], v[96:99]
v_mfma_f32_16x16x32_bf16 v[100:103], v[188:191], v[160:163], v[100:103]
v_mfma_f32_16x16x32_bf16 v[104:107], v[192:195], v[160:163], v[104:107]
ds_read_b128 v[196:199], v32 offset:7168
s_waitcnt vmcnt(0)
ds_read_b64_tr_b16 v[172:173], v25 offset:4096
ds_read_b64_tr_b16 v[174:175], v25 offset:4608
s_waitcnt lgkmcnt(5)
v_mfma_f32_16x16x32_bf16 v[108:111], v[180:183], v[164:167], v[108:111]
ds_read_b128 v[200:203], v32 offset:15360
v_mfma_f32_16x16x32_bf16 v[112:115], v[184:187], v[164:167], v[112:115]
ds_read_b128 v[204:207], v32 offset:23552
v_mfma_f32_16x16x32_bf16 v[116:119], v[188:191], v[164:167], v[116:119]
ds_read_b128 v[208:211], v32 offset:31744
v_mfma_f32_16x16x32_bf16 v[120:123], v[192:195], v[164:167], v[120:123]
ds_read_b64_tr_b16 v[176:177], v26 offset:4096
ds_read_b64_tr_b16 v[178:179], v26 offset:4608
s_waitcnt lgkmcnt(8)
v_mfma_f32_16x16x32_bf16 v[124:127], v[180:183], v[168:171], v[124:127]
v_mfma_f32_16x16x32_bf16 v[128:131], v[184:187], v[168:171], v[128:131]
v_mfma_f32_16x16x32_bf16 v[132:135], v[188:191], v[168:171], v[132:135]
v_mfma_f32_16x16x32_bf16 v[136:139], v[192:195], v[168:171], v[136:139]
ds_read_b64_tr_b16 v[140:141], v27 offset:4096
ds_read_b64_tr_b16 v[142:143], v27 offset:4608
s_waitcnt lgkmcnt(7)
v_mfma_f32_16x16x32_bf16 v[76:79], v[196:199], v[172:175], v[76:79]
s_waitcnt lgkmcnt(6)
v_mfma_f32_16x16x32_bf16 v[80:83], v[200:203], v[172:175], v[80:83]
s_waitcnt lgkmcnt(5)
v_mfma_f32_16x16x32_bf16 v[84:87], v[204:207], v[172:175], v[84:87]
s_waitcnt lgkmcnt(4)
v_mfma_f32_16x16x32_bf16 v[88:91], v[208:211], v[172:175], v[88:91]
ds_read_b64_tr_b16 v[144:145], v28 offset:4096
ds_read_b64_tr_b16 v[146:147], v28 offset:4608
s_waitcnt lgkmcnt(4)
v_mfma_f32_16x16x32_bf16 v[92:95], v[196:199], v[176:179], v[92:95]
v_cvt_pk_bf16_f32 v76, v76, v77
v_cvt_pk_bf16_f32 v77, v78, v79
v_cvt_pk_bf16_f32 v78, v80, v81
v_cvt_pk_bf16_f32 v79, v82, v83
buffer_store_dwordx4 v[76:79], v16, s[52:55], s82 offen offset:0 sc1
v_mfma_f32_16x16x32_bf16 v[96:99], v[200:203], v[176:179], v[96:99]
v_mfma_f32_16x16x32_bf16 v[100:103], v[204:207], v[176:179], v[100:103]
v_cvt_pk_bf16_f32 v84, v84, v85
v_cvt_pk_bf16_f32 v85, v86, v87
v_cvt_pk_bf16_f32 v86, v88, v89
v_cvt_pk_bf16_f32 v87, v90, v91
buffer_store_dwordx4 v[84:87], v16, s[52:55], s82 offen offset:2048 sc1
v_mfma_f32_16x16x32_bf16 v[104:107], v[208:211], v[176:179], v[104:107]
s_waitcnt lgkmcnt(2)
v_mfma_f32_16x16x32_bf16 v[108:111], v[196:199], v[140:143], v[108:111]
v_cvt_pk_bf16_f32 v92, v92, v93
v_cvt_pk_bf16_f32 v93, v94, v95
v_cvt_pk_bf16_f32 v94, v96, v97
v_cvt_pk_bf16_f32 v95, v98, v99
buffer_store_dwordx4 v[92:95], v16, s[52:55], s82 offen offset:1024 sc1
v_mfma_f32_16x16x32_bf16 v[112:115], v[200:203], v[140:143], v[112:115]
v_mfma_f32_16x16x32_bf16 v[116:119], v[204:207], v[140:143], v[116:119]
v_cvt_pk_bf16_f32 v100, v100, v101
v_cvt_pk_bf16_f32 v101, v102, v103
v_cvt_pk_bf16_f32 v102, v104, v105
v_cvt_pk_bf16_f32 v103, v106, v107
buffer_store_dwordx4 v[100:103], v16, s[52:55], s82 offen offset:3072 sc1
v_mfma_f32_16x16x32_bf16 v[120:123], v[208:211], v[140:143], v[120:123]
s_waitcnt lgkmcnt(0)
v_mfma_f32_16x16x32_bf16 v[124:127], v[196:199], v[144:147], v[124:127]
v_cvt_pk_bf16_f32 v108, v108, v109
v_cvt_pk_bf16_f32 v109, v110, v111
v_cvt_pk_bf16_f32 v110, v112, v113
v_cvt_pk_bf16_f32 v111, v114, v115
buffer_store_dwordx4 v[108:111], v16, s[52:55], s83 offen offset:0 sc1
v_mfma_f32_16x16x32_bf16 v[128:131], v[200:203], v[144:147], v[128:131]
v_mfma_f32_16x16x32_bf16 v[132:135], v[204:207], v[144:147], v[132:135]
v_cvt_pk_bf16_f32 v116, v116, v117
v_cvt_pk_bf16_f32 v117, v118, v119
v_cvt_pk_bf16_f32 v118, v120, v121
v_cvt_pk_bf16_f32 v119, v122, v123
buffer_store_dwordx4 v[116:119], v16, s[52:55], s83 offen offset:2048 sc1
v_mfma_f32_16x16x32_bf16 v[136:139], v[208:211], v[144:147], v[136:139]
v_cvt_pk_bf16_f32 v124, v124, v125
v_cvt_pk_bf16_f32 v125, v126, v127
v_cvt_pk_bf16_f32 v126, v128, v129
v_cvt_pk_bf16_f32 v127, v130, v131
buffer_store_dwordx4 v[124:127], v16, s[52:55], s83 offen offset:1024 sc1
v_cvt_pk_bf16_f32 v132, v132, v133
v_cvt_pk_bf16_f32 v133, v134, v135
s_nop 0
v_cvt_pk_bf16_f32 v134, v136, v137
v_cvt_pk_bf16_f32 v135, v138, v139
buffer_store_dwordx4 v[132:135], v16, s[52:55], s83 offen offset:3072 sc1
s_branch LM_pub
LM_light:
s_waitcnt lgkmcnt(0)
s_mov_b32 s98, 0x7c3ff80
s_load_dwordx2 s[98:99], s[38:39], s98
s_branch L1_fin
LM_edge:
s_sub_u32 s4, s3, 30
s_lshl_b32 s8, s8, 1
s_add_u32 s4, s4, s8
s_add_u32 s91, s4, 240
s_cmp_lt_u32 s4, 8
s_cselect_b32 s61, 1, 0
s_and_b32 s6, s5, 7
s_lshl_b32 s6, s6, 14
v_lshlrev_b32 v10, 7, v2
s_waitcnt lgkmcnt(0)
s_add_u32 s40, s26, 0x0
s_addc_u32 s41, s27, 0
s_mov_b32 s42, 0x20000
s_mov_b32 s43, 0x00020000
s_add_u32 s44, s28, 0x0
s_addc_u32 s45, s29, 0
s_mov_b32 s46, 0x20000
s_mov_b32 s47, 0x00020000
s_add_u32 s7, s6, 0
buffer_load_dword v250, v10, s[40:43], s7 offen
s_add_u32 s7, s6, 8192
buffer_load_dword v251, v10, s[40:43], s7 offen
s_add_u32 s7, s6, 0
buffer_load_dword v252, v10, s[44:47], s7 offen
s_add_u32 s7, s6, 8192
buffer_load_dword v253, v10, s[44:47], s7 offen
s_mul_i32 s6, s4, 40000
v_lshlrev_b32 v5, 4, v0
v_lshlrev_b32 v6, 2, v2
v_add_u32 v6, 0x10000, v6
v_mov_b32 v7, 0
ds_write_b32 v6, v7
s_mov_b32 s66, 0
s_mov_b32 s67, 4096
s_mov_b32 s68, 8192
s_mov_b32 s69, 12288
s_mov_b32 s70, 16384
s_mov_b32 s71, 20480
s_mov_b32 s72, 24576
s_mov_b32 s73, 28672
s_mov_b32 s74, 32768
s_mov_b32 s75, 36864
s_waitcnt lgkmcnt(0)
s_add_u32 s40, s20, 0x0
s_addc_u32 s41, s21, 0
s_add_u32 s40, s40, s6
s_addc_u32 s41, s41, 0
s_mov_b32 s42, 0x9c40
s_mov_b32 s43, 0x00020000
s_add_u32 s44, s18, 0x0
s_addc_u32 s45, s19, 0
s_add_u32 s44, s44, s6
s_addc_u32 s45, s45, 0
s_mov_b32 s46, 0x9c40
s_mov_b32 s47, 0x00020000
buffer_load_dwordx4 v[16:19], v5, s[40:43], s66 offen
buffer_load_dwordx4 v[20:23], v5, s[40:43], s67 offen
buffer_load_dwordx4 v[24:27], v5, s[40:43], s68 offen
buffer_load_dwordx4 v[28:31], v5, s[40:43], s69 offen
buffer_load_dwordx4 v[32:35], v5, s[40:43], s70 offen
buffer_load_dwordx4 v[36:39], v5, s[40:43], s71 offen
buffer_load_dwordx4 v[40:43], v5, s[40:43], s72 offen
buffer_load_dwordx4 v[44:47], v5, s[40:43], s73 offen
buffer_load_dwordx4 v[48:51], v5, s[40:43], s74 offen
buffer_load_dwordx4 v[52:55], v5, s[40:43], s75 offen
buffer_load_dwordx4 v[56:59], v5, s[44:47], s66 offen
buffer_load_dwordx4 v[60:63], v5, s[44:47], s67 offen
buffer_load_dwordx4 v[64:67], v5, s[44:47], s68 offen
buffer_load_dwordx4 v[68:71], v5, s[44:47], s69 offen
buffer_load_dwordx4 v[72:75], v5, s[44:47], s70 offen
buffer_load_dwordx4 v[76:79], v5, s[44:47], s71 offen
buffer_load_dwordx4 v[80:83], v5, s[44:47], s72 offen
buffer_load_dwordx4 v[84:87], v5, s[44:47], s73 offen
buffer_load_dwordx4 v[88:91], v5, s[44:47], s74 offen
buffer_load_dwordx4 v[92:95], v5, s[44:47], s75 offen
s_mov_b32 s98, 0x7c3ff80
s_load_dwordx2 s[98:99], s[38:39], s98
s_add_u32 s48, s38, 0x8000000
s_addc_u32 s49, s39, 0
s_mov_b32 s50, 0x2800000
s_mov_b32 s51, 0x00020000
s_add_u32 s52, s38, 0x7800000
s_addc_u32 s53, s39, 0
s_mov_b32 s54, 0x1000
s_mov_b32 s55, 0x00020000
s_mov_b32 s9, 6679
s_mov_b32 s10, 4294967139
s_mov_b32 s11, 0x10000
v_mov_b32 v7, 1
v_cmp_gt_u32 vcc, 0xc4, v0
s_mov_b64 s[12:13], vcc
s_barrier
s_waitcnt vmcnt(19)
v_mul_u32_u24 v96, s9, v16
v_lshrrev_b32 v96, 20, v96
v_lshl_add_u32 v136, v96, 2, s11
ds_add_rtn_u32 v136, v136, v7
v_mad_i32_i24 v16, v96, s10, v16
v_mul_u32_u24 v97, s9, v17
v_lshrrev_b32 v97, 20, v97
v_lshl_add_u32 v137, v97, 2, s11
ds_add_rtn_u32 v137, v137, v7
v_mad_i32_i24 v17, v97, s10, v17
v_mul_u32_u24 v98, s9, v18
v_lshrrev_b32 v98, 20, v98
v_lshl_add_u32 v138, v98, 2, s11
ds_add_rtn_u32 v138, v138, v7
v_mad_i32_i24 v18, v98, s10, v18
v_mul_u32_u24 v99, s9, v19
v_lshrrev_b32 v99, 20, v99
v_lshl_add_u32 v139, v99, 2, s11
ds_add_rtn_u32 v139, v139, v7
v_mad_i32_i24 v19, v99, s10, v19
s_waitcnt vmcnt(18)
v_mul_u32_u24 v100, s9, v20
v_lshrrev_b32 v100, 20, v100
v_lshl_add_u32 v140, v100, 2, s11
ds_add_rtn_u32 v140, v140, v7
v_mad_i32_i24 v20, v100, s10, v20
v_mul_u32_u24 v101, s9, v21
v_lshrrev_b32 v101, 20, v101
v_lshl_add_u32 v141, v101, 2, s11
ds_add_rtn_u32 v141, v141, v7
v_mad_i32_i24 v21, v101, s10, v21
v_mul_u32_u24 v102, s9, v22
v_lshrrev_b32 v102, 20, v102
v_lshl_add_u32 v142, v102, 2, s11
ds_add_rtn_u32 v142, v142, v7
v_mad_i32_i24 v22, v102, s10, v22
v_mul_u32_u24 v103, s9, v23
v_lshrrev_b32 v103, 20, v103
v_lshl_add_u32 v143, v103, 2, s11
ds_add_rtn_u32 v143, v143, v7
v_mad_i32_i24 v23, v103, s10, v23
s_waitcnt vmcnt(17)
v_mul_u32_u24 v104, s9, v24
v_lshrrev_b32 v104, 20, v104
v_lshl_add_u32 v144, v104, 2, s11
ds_add_rtn_u32 v144, v144, v7
v_mad_i32_i24 v24, v104, s10, v24
v_mul_u32_u24 v105, s9, v25
v_lshrrev_b32 v105, 20, v105
v_lshl_add_u32 v145, v105, 2, s11
ds_add_rtn_u32 v145, v145, v7
v_mad_i32_i24 v25, v105, s10, v25
v_mul_u32_u24 v106, s9, v26
v_lshrrev_b32 v106, 20, v106
v_lshl_add_u32 v146, v106, 2, s11
ds_add_rtn_u32 v146, v146, v7
v_mad_i32_i24 v26, v106, s10, v26
v_mul_u32_u24 v107, s9, v27
v_lshrrev_b32 v107, 20, v107
v_lshl_add_u32 v147, v107, 2, s11
ds_add_rtn_u32 v147, v147, v7
v_mad_i32_i24 v27, v107, s10, v27
s_waitcnt vmcnt(16)
v_mul_u32_u24 v108, s9, v28
v_lshrrev_b32 v108, 20, v108
v_lshl_add_u32 v148, v108, 2, s11
ds_add_rtn_u32 v148, v148, v7
v_mad_i32_i24 v28, v108, s10, v28
v_mul_u32_u24 v109, s9, v29
v_lshrrev_b32 v109, 20, v109
v_lshl_add_u32 v149, v109, 2, s11
ds_add_rtn_u32 v149, v149, v7
v_mad_i32_i24 v29, v109, s10, v29
v_mul_u32_u24 v110, s9, v30
v_lshrrev_b32 v110, 20, v110
v_lshl_add_u32 v150, v110, 2, s11
ds_add_rtn_u32 v150, v150, v7
v_mad_i32_i24 v30, v110, s10, v30
v_mul_u32_u24 v111, s9, v31
v_lshrrev_b32 v111, 20, v111
v_lshl_add_u32 v151, v111, 2, s11
ds_add_rtn_u32 v151, v151, v7
v_mad_i32_i24 v31, v111, s10, v31
s_waitcnt vmcnt(15)
v_mul_u32_u24 v112, s9, v32
v_lshrrev_b32 v112, 20, v112
v_lshl_add_u32 v152, v112, 2, s11
ds_add_rtn_u32 v152, v152, v7
v_mad_i32_i24 v32, v112, s10, v32
v_mul_u32_u24 v113, s9, v33
v_lshrrev_b32 v113, 20, v113
v_lshl_add_u32 v153, v113, 2, s11
ds_add_rtn_u32 v153, v153, v7
v_mad_i32_i24 v33, v113, s10, v33
v_mul_u32_u24 v114, s9, v34
v_lshrrev_b32 v114, 20, v114
v_lshl_add_u32 v154, v114, 2, s11
ds_add_rtn_u32 v154, v154, v7
v_mad_i32_i24 v34, v114, s10, v34
v_mul_u32_u24 v115, s9, v35
v_lshrrev_b32 v115, 20, v115
v_lshl_add_u32 v155, v115, 2, s11
ds_add_rtn_u32 v155, v155, v7
v_mad_i32_i24 v35, v115, s10, v35
s_waitcnt vmcnt(14)
v_mul_u32_u24 v116, s9, v36
v_lshrrev_b32 v116, 20, v116
v_lshl_add_u32 v156, v116, 2, s11
ds_add_rtn_u32 v156, v156, v7
v_mad_i32_i24 v36, v116, s10, v36
v_mul_u32_u24 v117, s9, v37
v_lshrrev_b32 v117, 20, v117
v_lshl_add_u32 v157, v117, 2, s11
ds_add_rtn_u32 v157, v157, v7
v_mad_i32_i24 v37, v117, s10, v37
v_mul_u32_u24 v118, s9, v38
v_lshrrev_b32 v118, 20, v118
v_lshl_add_u32 v158, v118, 2, s11
ds_add_rtn_u32 v158, v158, v7
v_mad_i32_i24 v38, v118, s10, v38
v_mul_u32_u24 v119, s9, v39
v_lshrrev_b32 v119, 20, v119
v_lshl_add_u32 v159, v119, 2, s11
ds_add_rtn_u32 v159, v159, v7
v_mad_i32_i24 v39, v119, s10, v39
s_waitcnt vmcnt(13)
v_mul_u32_u24 v120, s9, v40
v_lshrrev_b32 v120, 20, v120
v_lshl_add_u32 v160, v120, 2, s11
ds_add_rtn_u32 v160, v160, v7
v_mad_i32_i24 v40, v120, s10, v40
v_mul_u32_u24 v121, s9, v41
v_lshrrev_b32 v121, 20, v121
v_lshl_add_u32 v161, v121, 2, s11
ds_add_rtn_u32 v161, v161, v7
v_mad_i32_i24 v41, v121, s10, v41
v_mul_u32_u24 v122, s9, v42
v_lshrrev_b32 v122, 20, v122
v_lshl_add_u32 v162, v122, 2, s11
ds_add_rtn_u32 v162, v162, v7
v_mad_i32_i24 v42, v122, s10, v42
v_mul_u32_u24 v123, s9, v43
v_lshrrev_b32 v123, 20, v123
v_lshl_add_u32 v163, v123, 2, s11
ds_add_rtn_u32 v163, v163, v7
v_mad_i32_i24 v43, v123, s10, v43
s_waitcnt vmcnt(12)
v_mul_u32_u24 v124, s9, v44
v_lshrrev_b32 v124, 20, v124
v_lshl_add_u32 v164, v124, 2, s11
ds_add_rtn_u32 v164, v164, v7
v_mad_i32_i24 v44, v124, s10, v44
v_mul_u32_u24 v125, s9, v45
v_lshrrev_b32 v125, 20, v125
v_lshl_add_u32 v165, v125, 2, s11
ds_add_rtn_u32 v165, v165, v7
v_mad_i32_i24 v45, v125, s10, v45
v_mul_u32_u24 v126, s9, v46
v_lshrrev_b32 v126, 20, v126
v_lshl_add_u32 v166, v126, 2, s11
ds_add_rtn_u32 v166, v166, v7
v_mad_i32_i24 v46, v126, s10, v46
v_mul_u32_u24 v127, s9, v47
v_lshrrev_b32 v127, 20, v127
v_lshl_add_u32 v167, v127, 2, s11
ds_add_rtn_u32 v167, v167, v7
v_mad_i32_i24 v47, v127, s10, v47
s_waitcnt vmcnt(11)
v_mul_u32_u24 v128, s9, v48
v_lshrrev_b32 v128, 20, v128
v_lshl_add_u32 v168, v128, 2, s11
ds_add_rtn_u32 v168, v168, v7
v_mad_i32_i24 v48, v128, s10, v48
v_mul_u32_u24 v129, s9, v49
v_lshrrev_b32 v129, 20, v129
v_lshl_add_u32 v169, v129, 2, s11
ds_add_rtn_u32 v169, v169, v7
v_mad_i32_i24 v49, v129, s10, v49
v_mul_u32_u24 v130, s9, v50
v_lshrrev_b32 v130, 20, v130
v_lshl_add_u32 v170, v130, 2, s11
ds_add_rtn_u32 v170, v170, v7
v_mad_i32_i24 v50, v130, s10, v50
v_mul_u32_u24 v131, s9, v51
v_lshrrev_b32 v131, 20, v131
v_lshl_add_u32 v171, v131, 2, s11
ds_add_rtn_u32 v171, v171, v7
v_mad_i32_i24 v51, v131, s10, v51
s_waitcnt vmcnt(10)
s_mov_b64 exec, s[12:13]
v_mul_u32_u24 v132, s9, v52
v_lshrrev_b32 v132, 20, v132
v_lshl_add_u32 v172, v132, 2, s11
ds_add_rtn_u32 v172, v172, v7
v_mad_i32_i24 v52, v132, s10, v52
v_mul_u32_u24 v133, s9, v53
v_lshrrev_b32 v133, 20, v133
v_lshl_add_u32 v173, v133, 2, s11
ds_add_rtn_u32 v173, v173, v7
v_mad_i32_i24 v53, v133, s10, v53
v_mul_u32_u24 v134, s9, v54
v_lshrrev_b32 v134, 20, v134
v_lshl_add_u32 v174, v134, 2, s11
ds_add_rtn_u32 v174, v174, v7
v_mad_i32_i24 v54, v134, s10, v54
v_mul_u32_u24 v135, s9, v55
v_lshrrev_b32 v135, 20, v135
v_lshl_add_u32 v175, v135, 2, s11
ds_add_rtn_u32 v175, v175, v7
v_mad_i32_i24 v55, v135, s10, v55
s_mov_b64 exec, -1
s_waitcnt vmcnt(9) lgkmcnt(15)
v_and_b32 v8, 0xff, v136
v_lshl_or_b32 v56, v16, 18, v56
v_lshlrev_b32 v8, 2, v8
v_lshl_add_u32 v8, v96, 10, v8
ds_write_b32 v8, v56
v_and_b32 v8, 0xff, v137
v_lshl_or_b32 v57, v17, 18, v57
v_lshlrev_b32 v8, 2, v8
v_lshl_add_u32 v8, v97, 10, v8
ds_write_b32 v8, v57
v_and_b32 v8, 0xff, v138
v_lshl_or_b32 v58, v18, 18, v58
v_lshlrev_b32 v8, 2, v8
v_lshl_add_u32 v8, v98, 10, v8
ds_write_b32 v8, v58
v_and_b32 v8, 0xff, v139
v_lshl_or_b32 v59, v19, 18, v59
v_lshlrev_b32 v8, 2, v8
v_lshl_add_u32 v8, v99, 10, v8
ds_write_b32 v8, v59
s_waitcnt vmcnt(8) lgkmcnt(15)
v_and_b32 v8, 0xff, v140
v_lshl_or_b32 v60, v20, 18, v60
v_lshlrev_b32 v8, 2, v8
v_lshl_add_u32 v8, v100, 10, v8
ds_write_b32 v8, v60
v_and_b32 v8, 0xff, v141
v_lshl_or_b32 v61, v21, 18, v61
v_lshlrev_b32 v8, 2, v8
v_lshl_add_u32 v8, v101, 10, v8
ds_write_b32 v8, v61
v_and_b32 v8, 0xff, v142
v_lshl_or_b32 v62, v22, 18, v62
v_lshlrev_b32 v8, 2, v8
v_lshl_add_u32 v8, v102, 10, v8
ds_write_b32 v8, v62
v_and_b32 v8, 0xff, v143
v_lshl_or_b32 v63, v23, 18, v63
v_lshlrev_b32 v8, 2, v8
v_lshl_add_u32 v8, v103, 10, v8
ds_write_b32 v8, v63
s_waitcnt vmcnt(7) lgkmcnt(15)
v_and_b32 v8, 0xff, v144
v_lshl_or_b32 v64, v24, 18, v64
v_lshlrev_b32 v8, 2, v8
v_lshl_add_u32 v8, v104, 10, v8
ds_write_b32 v8, v64
v_and_b32 v8, 0xff, v145
v_lshl_or_b32 v65, v25, 18, v65
v_lshlrev_b32 v8, 2, v8
v_lshl_add_u32 v8, v105, 10, v8
ds_write_b32 v8, v65
v_and_b32 v8, 0xff, v146
v_lshl_or_b32 v66, v26, 18, v66
v_lshlrev_b32 v8, 2, v8
v_lshl_add_u32 v8, v106, 10, v8
ds_write_b32 v8, v66
v_and_b32 v8, 0xff, v147
v_lshl_or_b32 v67, v27, 18, v67
v_lshlrev_b32 v8, 2, v8
v_lshl_add_u32 v8, v107, 10, v8
ds_write_b32 v8, v67
s_waitcnt vmcnt(6) lgkmcnt(15)
v_and_b32 v8, 0xff, v148
v_lshl_or_b32 v68, v28, 18, v68
v_lshlrev_b32 v8, 2, v8
v_lshl_add_u32 v8, v108, 10, v8
ds_write_b32 v8, v68
v_and_b32 v8, 0xff, v149
v_lshl_or_b32 v69, v29, 18, v69
v_lshlrev_b32 v8, 2, v8
v_lshl_add_u32 v8, v109, 10, v8
ds_write_b32 v8, v69
v_and_b32 v8, 0xff, v150
v_lshl_or_b32 v70, v30, 18, v70
v_lshlrev_b32 v8, 2, v8
v_lshl_add_u32 v8, v110, 10, v8
ds_write_b32 v8, v70
v_and_b32 v8, 0xff, v151
v_lshl_or_b32 v71, v31, 18, v71
v_lshlrev_b32 v8, 2, v8
v_lshl_add_u32 v8, v111, 10, v8
ds_write_b32 v8, v71
s_waitcnt vmcnt(5) lgkmcnt(15)
v_and_b32 v8, 0xff, v152
v_lshl_or_b32 v72, v32, 18, v72
v_lshlrev_b32 v8, 2, v8
v_lshl_add_u32 v8, v112, 10, v8
ds_write_b32 v8, v72
v_and_b32 v8, 0xff, v153
v_lshl_or_b32 v73, v33, 18, v73
v_lshlrev_b32 v8, 2, v8
v_lshl_add_u32 v8, v113, 10, v8
ds_write_b32 v8, v73
v_and_b32 v8, 0xff, v154
v_lshl_or_b32 v74, v34, 18, v74
v_lshlrev_b32 v8, 2, v8
v_lshl_add_u32 v8, v114, 10, v8
ds_write_b32 v8, v74
v_and_b32 v8, 0xff, v155
v_lshl_or_b32 v75, v35, 18, v75
v_lshlrev_b32 v8, 2, v8
v_lshl_add_u32 v8, v115, 10, v8
ds_write_b32 v8, v75
s_waitcnt vmcnt(4) lgkmcnt(15)
v_and_b32 v8, 0xff, v156
v_lshl_or_b32 v76, v36, 18, v76
v_lshlrev_b32 v8, 2, v8
v_lshl_add_u32 v8, v116, 10, v8
ds_write_b32 v8, v76
v_and_b32 v8, 0xff, v157
v_lshl_or_b32 v77, v37, 18, v77
v_lshlrev_b32 v8, 2, v8
v_lshl_add_u32 v8, v117, 10, v8
ds_write_b32 v8, v77
v_and_b32 v8, 0xff, v158
v_lshl_or_b32 v78, v38, 18, v78
v_lshlrev_b32 v8, 2, v8
v_lshl_add_u32 v8, v118, 10, v8
ds_write_b32 v8, v78
v_and_b32 v8, 0xff, v159
v_lshl_or_b32 v79, v39, 18, v79
v_lshlrev_b32 v8, 2, v8
v_lshl_add_u32 v8, v119, 10, v8
ds_write_b32 v8, v79
s_waitcnt vmcnt(3) lgkmcnt(15)
v_and_b32 v8, 0xff, v160
v_lshl_or_b32 v80, v40, 18, v80
v_lshlrev_b32 v8, 2, v8
v_lshl_add_u32 v8, v120, 10, v8
ds_write_b32 v8, v80
v_and_b32 v8, 0xff, v161
v_lshl_or_b32 v81, v41, 18, v81
v_lshlrev_b32 v8, 2, v8
v_lshl_add_u32 v8, v121, 10, v8
ds_write_b32 v8, v81
v_and_b32 v8, 0xff, v162
v_lshl_or_b32 v82, v42, 18, v82
v_lshlrev_b32 v8, 2, v8
v_lshl_add_u32 v8, v122, 10, v8
ds_write_b32 v8, v82
v_and_b32 v8, 0xff, v163
v_lshl_or_b32 v83, v43, 18, v83
v_lshlrev_b32 v8, 2, v8
v_lshl_add_u32 v8, v123, 10, v8
ds_write_b32 v8, v83
s_waitcnt vmcnt(2) lgkmcnt(15)
v_and_b32 v8, 0xff, v164
v_lshl_or_b32 v84, v44, 18, v84
v_lshlrev_b32 v8, 2, v8
v_lshl_add_u32 v8, v124, 10, v8
ds_write_b32 v8, v84
v_and_b32 v8, 0xff, v165
v_lshl_or_b32 v85, v45, 18, v85
v_lshlrev_b32 v8, 2, v8
v_lshl_add_u32 v8, v125, 10, v8
ds_write_b32 v8, v85
v_and_b32 v8, 0xff, v166
v_lshl_or_b32 v86, v46, 18, v86
v_lshlrev_b32 v8, 2, v8
v_lshl_add_u32 v8, v126, 10, v8
ds_write_b32 v8, v86
v_and_b32 v8, 0xff, v167
v_lshl_or_b32 v87, v47, 18, v87
v_lshlrev_b32 v8, 2, v8
v_lshl_add_u32 v8, v127, 10, v8
ds_write_b32 v8, v87
s_waitcnt vmcnt(1) lgkmcnt(15)
v_and_b32 v8, 0xff, v168
v_lshl_or_b32 v88, v48, 18, v88
v_lshlrev_b32 v8, 2, v8
v_lshl_add_u32 v8, v128, 10, v8
ds_write_b32 v8, v88
v_and_b32 v8, 0xff, v169
v_lshl_or_b32 v89, v49, 18, v89
v_lshlrev_b32 v8, 2, v8
v_lshl_add_u32 v8, v129, 10, v8
ds_write_b32 v8, v89
v_and_b32 v8, 0xff, v170
v_lshl_or_b32 v90, v50, 18, v90
v_lshlrev_b32 v8, 2, v8
v_lshl_add_u32 v8, v130, 10, v8
ds_write_b32 v8, v90
v_and_b32 v8, 0xff, v171
v_lshl_or_b32 v91, v51, 18, v91
v_lshlrev_b32 v8, 2, v8
v_lshl_add_u32 v8, v131, 10, v8
ds_write_b32 v8, v91
s_waitcnt vmcnt(0) lgkmcnt(15)
s_mov_b64 exec, s[12:13]
v_and_b32 v8, 0xff, v172
v_lshl_or_b32 v92, v52, 18, v92
v_lshlrev_b32 v8, 2, v8
v_lshl_add_u32 v8, v132, 10, v8
ds_write_b32 v8, v92
v_and_b32 v8, 0xff, v173
v_lshl_or_b32 v93, v53, 18, v93
v_lshlrev_b32 v8, 2, v8
v_lshl_add_u32 v8, v133, 10, v8
ds_write_b32 v8, v93
v_and_b32 v8, 0xff, v174
v_lshl_or_b32 v94, v54, 18, v94
v_lshlrev_b32 v8, 2, v8
v_lshl_add_u32 v8, v134, 10, v8
ds_write_b32 v8, v94
v_and_b32 v8, 0xff, v175
v_lshl_or_b32 v95, v55, 18, v95
v_lshlrev_b32 v8, 2, v8
v_lshl_add_u32 v8, v135, 10, v8
ds_write_b32 v8, v95
s_mov_b64 exec, -1
s_waitcnt lgkmcnt(0)
s_barrier
ds_read_b32 v8, v6
s_mul_i32 s6, s60, 16384
v_lshlrev_b32 v10, 4, v2
v_add_u32 v9, s6, v10
ds_read_b128 v[176:179], v9 offset:0
ds_read_b128 v[180:183], v9 offset:1024
ds_read_b128 v[184:187], v9 offset:2048
ds_read_b128 v[188:191], v9 offset:3072
ds_read_b128 v[192:195], v9 offset:4096
ds_read_b128 v[196:199], v9 offset:5120
ds_read_b128 v[200:203], v9 offset:6144
ds_read_b128 v[204:207], v9 offset:7168
ds_read_b128 v[208:211], v9 offset:8192
ds_read_b128 v[212:215], v9 offset:9216
ds_read_b128 v[216:219], v9 offset:10240
ds_read_b128 v[220:223], v9 offset:11264
ds_read_b128 v[224:227], v9 offset:12288
ds_read_b128 v[228:231], v9 offset:13312
ds_read_b128 v[232:235], v9 offset:14336
ds_read_b128 v[236:239], v9 offset:15360
s_mul_i32 s6, s60, 10485760
s_mul_i32 s7, s4, 40960
s_add_u32 s6, s6, s7
v_lshlrev_b32 v9, 6, v2
s_lshl_b32 s8, s4, 2
s_cmp_eq_u32 s60, 0
s_cselect_b32 s8, s8, 0x7fff0000
s_waitcnt lgkmcnt(15)
buffer_store_dword v8, v9, s[52:55], s8 offen sc1
v_cmp_lt_u32 vcc, 0x100, v8
s_cbranch_vccnz L1_eslow
s_waitcnt lgkmcnt(15)
buffer_store_dwordx4 v[176:179], v10, s[48:51], s6 offen sc1
s_add_u32 s6, s6, 655360
s_waitcnt lgkmcnt(14)
buffer_store_dwordx4 v[180:183], v10, s[48:51], s6 offen sc1
s_add_u32 s6, s6, 655360
s_waitcnt lgkmcnt(13)
buffer_store_dwordx4 v[184:187], v10, s[48:51], s6 offen sc1
s_add_u32 s6, s6, 655360
s_waitcnt lgkmcnt(12)
buffer_store_dwordx4 v[188:191], v10, s[48:51], s6 offen sc1
s_add_u32 s6, s6, 655360
s_waitcnt lgkmcnt(11)
buffer_store_dwordx4 v[192:195], v10, s[48:51], s6 offen sc1
s_add_u32 s6, s6, 655360
s_waitcnt lgkmcnt(10)
buffer_store_dwordx4 v[196:199], v10, s[48:51], s6 offen sc1
s_add_u32 s6, s6, 655360
s_waitcnt lgkmcnt(9)
buffer_store_dwordx4 v[200:203], v10, s[48:51], s6 offen sc1
s_add_u32 s6, s6, 655360
s_waitcnt lgkmcnt(8)
buffer_store_dwordx4 v[204:207], v10, s[48:51], s6 offen sc1
s_add_u32 s6, s6, 655360
s_waitcnt lgkmcnt(7)
buffer_store_dwordx4 v[208:211], v10, s[48:51], s6 offen sc1
s_add_u32 s6, s6, 655360
s_waitcnt lgkmcnt(6)
buffer_store_dwordx4 v[212:215], v10, s[48:51], s6 offen sc1
s_add_u32 s6, s6, 655360
s_waitcnt lgkmcnt(5)
buffer_store_dwordx4 v[216:219], v10, s[48:51], s6 offen sc1
s_add_u32 s6, s6, 655360
s_waitcnt lgkmcnt(4)
buffer_store_dwordx4 v[220:223], v10, s[48:51], s6 offen sc1
s_add_u32 s6, s6, 655360
s_waitcnt lgkmcnt(3)
buffer_store_dwordx4 v[224:227], v10, s[48:51], s6 offen sc1
s_add_u32 s6, s6, 655360
s_waitcnt lgkmcnt(2)
buffer_store_dwordx4 v[228:231], v10, s[48:51], s6 offen sc1
s_add_u32 s6, s6, 655360
s_waitcnt lgkmcnt(1)
buffer_store_dwordx4 v[232:235], v10, s[48:51], s6 offen sc1
s_add_u32 s6, s6, 655360
s_waitcnt lgkmcnt(0)
buffer_store_dwordx4 v[236:239], v10, s[48:51], s6 offen sc1
s_add_u32 s6, s6, 655360
s_branch L1_fin
L1_eslow:
s_mov_b32 s9, 655360
v_mul_u32_u24 v96, s9, v96
v_lshl_add_u32 v96, v136, 2, v96
v_mul_u32_u24 v97, s9, v97
v_lshl_add_u32 v97, v137, 2, v97
v_mul_u32_u24 v98, s9, v98
v_lshl_add_u32 v98, v138, 2, v98
v_mul_u32_u24 v99, s9, v99
v_lshl_add_u32 v99, v139, 2, v99
v_mul_u32_u24 v100, s9, v100
v_lshl_add_u32 v100, v140, 2, v100
v_mul_u32_u24 v101, s9, v101
v_lshl_add_u32 v101, v141, 2, v101
v_mul_u32_u24 v102, s9, v102
v_lshl_add_u32 v102, v142, 2, v102
v_mul_u32_u24 v103, s9, v103
v_lshl_add_u32 v103, v143, 2, v103
v_mul_u32_u24 v104, s9, v104
v_lshl_add_u32 v104, v144, 2, v104
v_mul_u32_u24 v105, s9, v105
v_lshl_add_u32 v105, v145, 2, v105
v_mul_u32_u24 v106, s9, v106
v_lshl_add_u32 v106, v146, 2, v106
v_mul_u32_u24 v107, s9, v107
v_lshl_add_u32 v107, v147, 2, v107
v_mul_u32_u24 v108, s9, v108
v_lshl_add_u32 v108, v148, 2, v108
v_mul_u32_u24 v109, s9, v109
v_lshl_add_u32 v109, v149, 2, v109
v_mul_u32_u24 v110, s9, v110
v_lshl_add_u32 v110, v150, 2, v110
v_mul_u32_u24 v111, s9, v111
v_lshl_add_u32 v111, v151, 2, v111
v_mul_u32_u24 v112, s9, v112
v_lshl_add_u32 v112, v152, 2, v112
v_mul_u32_u24 v113, s9, v113
v_lshl_add_u32 v113, v153, 2, v113
v_mul_u32_u24 v114, s9, v114
v_lshl_add_u32 v114, v154, 2, v114
v_mul_u32_u24 v115, s9, v115
v_lshl_add_u32 v115, v155, 2, v115
v_mul_u32_u24 v116, s9, v116
v_lshl_add_u32 v116, v156, 2, v116
v_mul_u32_u24 v117, s9, v117
v_lshl_add_u32 v117, v157, 2, v117
v_mul_u32_u24 v118, s9, v118
v_lshl_add_u32 v118, v158, 2, v118
v_mul_u32_u24 v119, s9, v119
v_lshl_add_u32 v119, v159, 2, v119
v_mul_u32_u24 v120, s9, v120
v_lshl_add_u32 v120, v160, 2, v120
v_mul_u32_u24 v121, s9, v121
v_lshl_add_u32 v121, v161, 2, v121
v_mul_u32_u24 v122, s9, v122
v_lshl_add_u32 v122, v162, 2, v122
v_mul_u32_u24 v123, s9, v123
v_lshl_add_u32 v123, v163, 2, v123
v_mul_u32_u24 v124, s9, v124
v_lshl_add_u32 v124, v164, 2, v124
v_mul_u32_u24 v125, s9, v125
v_lshl_add_u32 v125, v165, 2, v125
v_mul_u32_u24 v126, s9, v126
v_lshl_add_u32 v126, v166, 2, v126
v_mul_u32_u24 v127, s9, v127
v_lshl_add_u32 v127, v167, 2, v127
v_mul_u32_u24 v128, s9, v128
v_lshl_add_u32 v128, v168, 2, v128
v_mul_u32_u24 v129, s9, v129
v_lshl_add_u32 v129, v169, 2, v129
v_mul_u32_u24 v130, s9, v130
v_lshl_add_u32 v130, v170, 2, v130
v_mul_u32_u24 v131, s9, v131
v_lshl_add_u32 v131, v171, 2, v131
v_mul_u32_u24 v132, s9, v132
v_lshl_add_u32 v132, v172, 2, v132
v_mul_u32_u24 v133, s9, v133
v_lshl_add_u32 v133, v173, 2, v133
v_mul_u32_u24 v134, s9, v134
v_lshl_add_u32 v134, v174, 2, v134
v_mul_u32_u24 v135, s9, v135
v_lshl_add_u32 v135, v175, 2, v135
buffer_store_dword v56, v96, s[48:51], s7 offen sc1
buffer_store_dword v57, v97, s[48:51], s7 offen sc1
buffer_store_dword v58, v98, s[48:51], s7 offen sc1
buffer_store_dword v59, v99, s[48:51], s7 offen sc1
buffer_store_dword v60, v100, s[48:51], s7 offen sc1
buffer_store_dword v61, v101, s[48:51], s7 offen sc1
buffer_store_dword v62, v102, s[48:51], s7 offen sc1
buffer_store_dword v63, v103, s[48:51], s7 offen sc1
buffer_store_dword v64, v104, s[48:51], s7 offen sc1
buffer_store_dword v65, v105, s[48:51], s7 offen sc1
buffer_store_dword v66, v106, s[48:51], s7 offen sc1
buffer_store_dword v67, v107, s[48:51], s7 offen sc1
buffer_store_dword v68, v108, s[48:51], s7 offen sc1
buffer_store_dword v69, v109, s[48:51], s7 offen sc1
buffer_store_dword v70, v110, s[48:51], s7 offen sc1
buffer_store_dword v71, v111, s[48:51], s7 offen sc1
buffer_store_dword v72, v112, s[48:51], s7 offen sc1
buffer_store_dword v73, v113, s[48:51], s7 offen sc1
buffer_store_dword v74, v114, s[48:51], s7 offen sc1
buffer_store_dword v75, v115, s[48:51], s7 offen sc1
buffer_store_dword v76, v116, s[48:51], s7 offen sc1
buffer_store_dword v77, v117, s[48:51], s7 offen sc1
buffer_store_dword v78, v118, s[48:51], s7 offen sc1
buffer_store_dword v79, v119, s[48:51], s7 offen sc1
buffer_store_dword v80, v120, s[48:51], s7 offen sc1
buffer_store_dword v81, v121, s[48:51], s7 offen sc1
buffer_store_dword v82, v122, s[48:51], s7 offen sc1
buffer_store_dword v83, v123, s[48:51], s7 offen sc1
buffer_store_dword v84, v124, s[48:51], s7 offen sc1
buffer_store_dword v85, v125, s[48:51], s7 offen sc1
buffer_store_dword v86, v126, s[48:51], s7 offen sc1
buffer_store_dword v87, v127, s[48:51], s7 offen sc1
buffer_store_dword v88, v128, s[48:51], s7 offen sc1
buffer_store_dword v89, v129, s[48:51], s7 offen sc1
buffer_store_dword v90, v130, s[48:51], s7 offen sc1
buffer_store_dword v91, v131, s[48:51], s7 offen sc1
s_mov_b64 exec, s[12:13]
buffer_store_dword v92, v132, s[48:51], s7 offen sc1
buffer_store_dword v93, v133, s[48:51], s7 offen sc1
buffer_store_dword v94, v134, s[48:51], s7 offen sc1
buffer_store_dword v95, v135, s[48:51], s7 offen sc1
s_mov_b64 exec, -1
s_branch L1_fin
L2_entry:
s_load_dwordx2 s[4:5], s[0:1], 88
s_load_dwordx2 s[60:61], s[0:1], 0
s_load_dwordx2 s[52:53], s[0:1], 24
s_load_dwordx2 s[56:57], s[0:1], 72
s_and_b32 s35, s2, 7
s_lshr_b32 s37, s2, 3
s_add_u32 s37, s37, 30
s_and_b32 s37, s37, 31
s_cmp_ge_u32 s37, 30
s_cbranch_scc1 LE_start
s_mul_i32 s38, s37, 26
s_lshr_b32 s38, s38, 8
s_mul_i32 s39, s38, 10
s_sub_u32 s39, s37, s39
s_and_b32 s37, s35, 1
s_mul_i32 s37, s37, 3
s_add_u32 s37, s37, s38
s_lshr_b32 s38, s35, 1
s_mul_i32 s38, s38, 10
s_add_u32 s38, s38, s39
v_lshrrev_b32 v1, 6, v0
v_and_b32 v248, 63, v0
v_lshlrev_b32 v248, 4, v248
v_readfirstlane_b32 s34, v1
s_mov_b32 s50, 0xe1a06800
s_mov_b32 s51, 0x4e20ad04
s_mul_i32 s39, s37, 9
s_lshr_b64 s[50:51], s[50:51], s39
s_and_b32 s39, s50, 0x1ff
s_bfe_u32 s49, s50, 0x90009
s_sub_u32 s31, s49, s39
s_sub_u32 s31, s31, 5
s_lshl_b32 s39, s39, 14
s_lshl_b32 s49, s49, 14
s_add_u32 s28, s39, 0x4000
s_cmp_eq_u32 s37, 5
s_addc_u32 s31, s31, 0
s_cmp_eq_u32 s37, 5
s_cselect_b32 s28, s39, s28
s_cselect_b32 s39, 5111808, s39
s_cselect_b32 s49, 5120000, s49
s_cselect_b32 s33, 0xff800000, 0
s_mov_b32 s32, 0x5d800000
v_and_b32 v2, 63, v0
v_bfe_u32 v3, v2, 3, 2
v_bfe_u32 v4, v2, 2, 1
v_lshlrev_b32 v241, 12, v3
v_lshl_or_b32 v241, v4, 9, v241
v_lshl_or_b32 v241, v1, 7, v241
v_lshrrev_b32 v4, 5, v2
v_lshl_or_b32 v241, v4, 6, v241
v_and_b32 v3, 2, v3
v_and_b32 v4, 3, v2
v_xor_b32 v3, v3, v4
v_lshl_or_b32 v241, v3, 4, v241
s_cmp_eq_u32 s38, 39
s_cbranch_scc1 LT_disp
s_cmp_lt_u32 s37, 3
s_cselect_b32 s101, 1, -1
s_cselect_b32 s39, 0, 103
s_cselect_b32 s3, 0, 3
s_sub_u32 s3, s37, s3
s_mul_i32 s3, s3, 104
s_add_u32 s39, s39, s3
s_cmp_eq_u32 s37, 5
s_addc_u32 s39, s39, 0
s_lshl_b32 s101, s101, 14
s_lshl_b32 s39, s39, 14
s_add_u32 s28, s39, s101
s_mov_b32 s49, 5120000
s_mov_b32 s31, 40
s_mov_b32 s100, 3
s_lshl_b32 s30, s34, 12
s_lshl_b32 s50, s34, 13
s_add_u32 s50, s50, 0x20000
s_mov_b32 m0, s30
s_mov_b32 s6, 0x92c51840
s_mov_b32 s7, 0xfb73ea6d
s_mul_i32 s3, s37, 12
s_min_u32 s3, s3, 56
s_lshr_b64 s[6:7], s[6:7], s3
s_bfe_u32 s29, s6, 0x40008
s_bfe_u32 s7, s6, 0x40004
s_and_b32 s6, s6, 15
s_cmp_lt_u32 s37, 4
s_cselect_b32 s29, s29, 16
s_mov_b32 s94, 0
s_mov_b32 s95, 0
s_lshr_b32 s3, s6, 2
s_cmp_eq_u32 s3, s34
s_cselect_b32 s94, s6, s94
s_cselect_b32 s95, 1, s95
s_lshr_b32 s3, s7, 2
s_cmp_eq_u32 s3, s34
s_cselect_b32 s94, s7, s94
s_cselect_b32 s95, 1, s95
s_lshr_b32 s3, s29, 2
s_cmp_eq_u32 s3, s34
s_cselect_b32 s94, s29, s94
s_cselect_b32 s95, 1, s95
s_and_b32 s94, s94, 3
s_lshl_b32 s3, s38, 17
s_lshl_b32 s51, s34, 7
s_add_u32 s3, s3, s51
s_lshl_b32 s6, s6, 13
s_add_u32 s6, s6, s3
s_lshl_b32 s7, s7, 13
s_add_u32 s7, s7, s3
s_lshl_b32 s29, s29, 13
s_add_u32 s29, s29, s3
s_mov_b64 s[96:97], 0
s_lshr_b32 s3, s6, 9
s_mul_i32 s3, s3, 6679
s_lshr_b32 s3, s3, 20
s_bitset1_b64 s[96:97], s3
s_lshr_b32 s3, s6, 9
s_add_u32 s3, s3, 15
s_mul_i32 s3, s3, 6679
s_lshr_b32 s3, s3, 20
s_bitset1_b64 s[96:97], s3
s_lshr_b32 s3, s7, 9
s_mul_i32 s3, s3, 6679
s_lshr_b32 s3, s3, 20
s_bitset1_b64 s[96:97], s3
s_lshr_b32 s3, s7, 9
s_add_u32 s3, s3, 15
s_mul_i32 s3, s3, 6679
s_lshr_b32 s3, s3, 20
s_bitset1_b64 s[96:97], s3
s_lshr_b32 s3, s29, 9
s_mul_i32 s3, s3, 6679
s_lshr_b32 s3, s3, 20
s_bitset1_b64 s[96:97], s3
s_lshr_b32 s3, s29, 9
s_add_u32 s3, s3, 15
s_mul_i32 s3, s3, 6679
s_lshr_b32 s3, s3, 20
s_bitset1_b64 s[96:97], s3
s_mul_i32 s3, s38, 6
s_add_u32 s3, s3, s37
s_cmp_eq_u32 s3, 233
s_cselect_b32 s3, 0, s37
s_cmp_lt_u32 s3, 4
s_cselect_b32 s29, s29, 0x70000000
s_lshl_b32 s51, s38, 5
s_lshl_b32 s3, s34, 3
s_add_u32 s51, s51, s3
s_add_u32 s51, s51, s37
s_mul_i32 s51, s51, 128
s_add_u32 s51, s51, 0x7c00000
s_lshr_b32 s40, s39, 17
s_min_u32 s40, s40, 38
s_lshr_b32 s41, s28, 17
s_add_u32 s3, s28, s101
s_lshr_b32 s3, s3, 17
v_mov_b32 v5, s38
v_mov_b32 v6, s40
v_cmp_lt_u32 vcc, 0x7f, v248
s_nop 1
v_cndmask_b32 v5, v5, v6, vcc
v_mov_b32 v6, s41
v_cmp_lt_u32 vcc, 0xff, v248
s_nop 1
v_cndmask_b32 v5, v5, v6, vcc
v_mov_b32 v6, s3
v_cmp_lt_u32 vcc, 0x17f, v248
s_nop 1
v_cndmask_b32 v5, v5, v6, vcc
v_bfe_u32 v6, v248, 4, 3
v_min_u32 v6, 5, v6
v_mad_u32_u24 v5, v5, 6, v6
v_lshlrev_b32 v5, 7, v5
v_add_u32 v5, 0x7c2a000, v5
s_mul_i32 s3, s101, 54
s_add_u32 s3, s3, s39
s_min_u32 s41, s3, s39
s_max_u32 s3, s3, s39
s_lshr_b32 s41, s41, 17
s_min_u32 s40, s40, s41
s_mul_i32 s40, s40, 6
s_lshr_b32 s3, s3, 17
s_min_u32 s3, s3, 38
s_mul_i32 s3, s3, 6
s_add_u32 s3, s3, 5
v_lshrrev_b32 v251, 4, v248
v_add_u32 v251, s40, v251
v_min_u32 v251, s3, v251
v_lshlrev_b32 v251, 7, v251
v_add_u32 v251, 0x7c2a000, v251
s_waitcnt lgkmcnt(0)
s_add_u32 s12, s4, 0x6800000
s_addc_u32 s13, s5, 0
s_mov_b32 s14, 0x0
s_mov_b32 s15, 0x00020000
s_mov_b32 s14, s49
s_add_u32 s8, s4, 0x0
s_addc_u32 s9, s5, 0
s_mov_b32 s10, 0x4e4000
s_mov_b32 s11, 0x00020000
s_mul_i32 s35, s37, 0x600000
s_add_u32 s20, s4, 0x2000000
s_addc_u32 s21, s5, 0
s_add_u32 s20, s20, s35
s_addc_u32 s21, s21, 0
s_mov_b32 s22, 0x4e4000
s_mov_b32 s23, 0x00020000
s_add_u32 s24, s4, 0x6000000
s_addc_u32 s25, s5, 0
s_mov_b32 s26, 0x139000
s_mov_b32 s27, 0x00020000
s_lshl_b32 s35, s38, 4
s_lshl_b32 s41, s34, 2
s_add_u32 s35, s35, s41
s_lshl_b32 s40, s35, 13
s_lshl_b32 s94, s94, 13
s_add_u32 s40, s40, s94
s_xor_b32 s41, s40, 8192
s_xor_b32 s42, s40, 16384
s_xor_b32 s43, s40, 24576
s_add_u32 s44, s40, 4096
s_add_u32 s45, s41, 4096
s_add_u32 s46, s42, 4096
s_add_u32 s47, s43, 4096
s_lshl_b32 s48, s35, 10
s_lshl_b32 s35, s37, 3
s_add_u32 s48, s48, s35
v_mov_b32 v232, 0
v_mov_b32 v233, 0
v_mov_b32 v234, 0
v_mov_b32 v235, 0
v_bfe_u32 v240, v248, 4, 3
v_lshlrev_b32 v240, 6, v240
v_bfe_u32 v242, v248, 7, 1
v_lshl_or_b32 v240, v242, 10, v240
v_bfe_u32 v242, v248, 8, 2
v_lshl_or_b32 v240, v242, 4, v240
v_bfe_u32 v242, v248, 6, 1
v_lshlrev_b32 v242, 5, v242
v_xor_b32 v240, v240, v242
v_and_b32 v249, 0x1c0, v248
v_bfe_u32 v242, v248, 9, 1
v_lshl_or_b32 v249, v242, 10, v249
v_bfe_u32 v242, v248, 8, 1
v_lshl_or_b32 v249, v242, 5, v249
v_bfe_u32 v242, v248, 4, 2
v_lshl_or_b32 v249, v242, 3, v249
v_xor_b32 v250, 32, v249
v_bfe_i32 v242, v248, 8, 1
v_and_b32 v192, s33, v242
v_and_b32 v193, s33, v242
v_and_b32 v194, s33, v242
v_and_b32 v195, s33, v242
v_mfma_f32_32x32x16_bf16 a[0:15], v[232:235], v[232:235], 0
v_mfma_f32_32x32x16_bf16 a[16:31], v[232:235], v[232:235], 0
v_mfma_f32_32x32x16_bf16 a[32:47], v[232:235], v[232:235], 0
v_mfma_f32_32x32x16_bf16 a[48:63], v[232:235], v[232:235], 0
v_mfma_f32_32x32x16_bf16 a[64:79], v[232:235], v[232:235], 0
v_mfma_f32_32x32x16_bf16 a[80:95], v[232:235], v[232:235], 0
v_mfma_f32_32x32x16_bf16 a[96:111], v[232:235], v[232:235], 0
v_mfma_f32_32x32x16_bf16 a[112:127], v[232:235], v[232:235], 0
v_mfma_f32_32x32x16_bf16 a[128:143], v[232:235], v[232:235], 0
v_mfma_f32_32x32x16_bf16 a[144:159], v[232:235], v[232:235], 0
v_mfma_f32_32x32x16_bf16 a[160:175], v[232:235], v[232:235], 0
v_mfma_f32_32x32x16_bf16 a[176:191], v[232:235], v[232:235], 0
v_mfma_f32_32x32x16_bf16 a[192:207], v[232:235], v[232:235], 0
v_mfma_f32_32x32x16_bf16 a[208:223], v[232:235], v[232:235], 0
v_mfma_f32_32x32x16_bf16 a[224:239], v[232:235], v[232:235], 0
v_mfma_f32_32x32x16_bf16 a[240:255], v[232:235], v[232:235], 0
s_add_u32 s16, s4, 0x0
s_addc_u32 s17, s5, 0
s_mov_b32 s18, 0x10000000
s_mov_b32 s19, 0x00020000
s_mov_b32 s3, 0x10000
LM_pa:
buffer_load_dwordx2 v[6:7], v5, s[16:19], 0 offen sc1
s_sub_u32 s3, s3, 1
s_waitcnt vmcnt(0)
s_cbranch_scc1 LM_pa_go
v_cmp_ne_u64 vcc, s[98:99], v[6:7]
s_nop 1
s_cbranch_vccnz LM_pa
LM_pa_go:
buffer_load_dwordx4 v241, s[12:15], s39 offen offset:0 sc1 lds
buffer_load_dwordx4 v241, s[12:15], s39 offen offset:1024 sc1 lds
buffer_load_dwordx4 v241, s[12:15], s39 offen offset:2048 sc1 lds
buffer_load_dwordx4 v241, s[12:15], s39 offen offset:3072 sc1 lds
s_add_u32 m0, s30, 0x4000
s_nop 0
buffer_load_dwordx4 v241, s[12:15], s28 offen offset:0 sc1 lds
buffer_load_dwordx4 v241, s[12:15], s28 offen offset:1024 sc1 lds
buffer_load_dwordx4 v[0:3], v248, s[8:11], s40 offen offset:0 sc1
buffer_load_dwordx4 v[32:35], v248, s[8:11], s41 offen offset:0 sc1
buffer_load_dwordx4 v[64:67], v248, s[8:11], s42 offen offset:0 sc1
buffer_load_dwordx4 v[96:99], v248, s[8:11], s43 offen offset:0 sc1
buffer_load_dwordx4 v[4:7], v248, s[8:11], s40 offen offset:1024 sc1
buffer_load_dwordx4 v[36:39], v248, s[8:11], s41 offen offset:1024 sc1
buffer_load_dwordx4 v[68:71], v248, s[8:11], s42 offen offset:1024 sc1
buffer_load_dwordx4 v[100:103], v248, s[8:11], s43 offen offset:1024 sc1
buffer_load_dwordx4 v[8:11], v248, s[8:11], s40 offen offset:2048 sc1
buffer_load_dwordx4 v[40:43], v248, s[8:11], s41 offen offset:2048 sc1
buffer_load_dwordx4 v[72:75], v248, s[8:11], s42 offen offset:2048 sc1
buffer_load_dwordx4 v[104:107], v248, s[8:11], s43 offen offset:2048 sc1
buffer_load_dwordx4 v[12:15], v248, s[8:11], s40 offen offset:3072 sc1
buffer_load_dwordx4 v[44:47], v248, s[8:11], s41 offen offset:3072 sc1
buffer_load_dwordx4 v[76:79], v248, s[8:11], s42 offen offset:3072 sc1
buffer_load_dwordx4 v[108:111], v248, s[8:11], s43 offen offset:3072 sc1
buffer_load_dwordx4 v[16:19], v248, s[8:11], s44 offen offset:0 sc1
buffer_load_dwordx4 v[48:51], v248, s[8:11], s45 offen offset:0 sc1
buffer_load_dwordx4 v[80:83], v248, s[8:11], s46 offen offset:0 sc1
buffer_load_dwordx4 v[112:115], v248, s[8:11], s47 offen offset:0 sc1
buffer_load_dwordx2 v[252:253], v251, s[16:19], 0 offen sc1
s_waitcnt vmcnt(21)
s_barrier
ds_read_b128 v[208:211], v240 offset:0
ds_read_b128 v[212:215], v240 offset:2048
ds_read_b128 v[216:219], v240 offset:16384
ds_read_b128 v[220:223], v240 offset:512
s_waitcnt lgkmcnt(3)
s_waitcnt vmcnt(17)
v_mfma_f32_16x16x32_bf16 v[128:131], v[208:211], v[0:3], v[192:195]
buffer_load_dwordx4 v[20:23], v248, s[8:11], s44 offen offset:1024 sc1
v_mfma_f32_16x16x32_bf16 v[132:135], v[208:211], v[32:35], v[192:195]
v_mfma_f32_16x16x32_bf16 v[136:139], v[208:211], v[64:67], v[192:195]
v_mfma_f32_16x16x32_bf16 v[140:143], v[208:211], v[96:99], v[192:195]
ds_read_b128 v[208:211], v240 offset:2560
s_waitcnt lgkmcnt(3)
buffer_load_dwordx4 v[52:55], v248, s[8:11], s45 offen offset:1024 sc1
v_mfma_f32_16x16x32_bf16 v[144:147], v[212:215], v[0:3], v[192:195]
v_mfma_f32_16x16x32_bf16 v[148:151], v[212:215], v[32:35], v[192:195]
v_mfma_f32_16x16x32_bf16 v[152:155], v[212:215], v[64:67], v[192:195]
buffer_load_dwordx4 v[84:87], v248, s[8:11], s46 offen offset:1024 sc1
v_mfma_f32_16x16x32_bf16 v[156:159], v[212:215], v[96:99], v[192:195]
ds_read_b128 v[212:215], v240 offset:16896
s_waitcnt lgkmcnt(3)
v_mfma_f32_16x16x32_bf16 v[176:179], v[216:219], v[0:3], 0
v_mfma_f32_16x16x32_bf16 v[180:183], v[216:219], v[32:35], 0
buffer_load_dwordx4 v[116:119], v248, s[8:11], s47 offen offset:1024 sc1
v_mfma_f32_16x16x32_bf16 v[184:187], v[216:219], v[64:67], 0
v_mfma_f32_16x16x32_bf16 v[188:191], v[216:219], v[96:99], 0
ds_read_b128 v[216:219], v240 offset:4096
s_waitcnt lgkmcnt(3)
s_waitcnt vmcnt(17)
v_mfma_f32_16x16x32_bf16 v[128:131], v[220:223], v[4:7], v[128:131]
buffer_load_dwordx4 v[24:27], v248, s[8:11], s44 offen offset:2048 sc1
v_mfma_f32_16x16x32_bf16 v[132:135], v[220:223], v[36:39], v[132:135]
v_mfma_f32_16x16x32_bf16 v[136:139], v[220:223], v[68:71], v[136:139]
v_mfma_f32_16x16x32_bf16 v[140:143], v[220:223], v[100:103], v[140:143]
ds_read_b128 v[220:223], v240 offset:6144
s_waitcnt lgkmcnt(3)
buffer_load_dwordx4 v[56:59], v248, s[8:11], s45 offen offset:2048 sc1
v_mfma_f32_16x16x32_bf16 v[144:147], v[208:211], v[4:7], v[144:147]
v_mfma_f32_16x16x32_bf16 v[148:151], v[208:211], v[36:39], v[148:151]
v_mfma_f32_16x16x32_bf16 v[152:155], v[208:211], v[68:71], v[152:155]
buffer_load_dwordx4 v[88:91], v248, s[8:11], s46 offen offset:2048 sc1
v_mfma_f32_16x16x32_bf16 v[156:159], v[208:211], v[100:103], v[156:159]
ds_read_b128 v[208:211], v240 offset:20480
s_waitcnt lgkmcnt(3)
v_mfma_f32_16x16x32_bf16 v[176:179], v[212:215], v[4:7], v[176:179]
v_mfma_f32_16x16x32_bf16 v[180:183], v[212:215], v[36:39], v[180:183]
buffer_load_dwordx4 v[120:123], v248, s[8:11], s47 offen offset:2048 sc1
v_mfma_f32_16x16x32_bf16 v[184:187], v[212:215], v[68:71], v[184:187]
v_mfma_f32_16x16x32_bf16 v[188:191], v[212:215], v[100:103], v[188:191]
ds_read_b128 v[212:215], v240 offset:4608
s_waitcnt lgkmcnt(3)
s_waitcnt vmcnt(17)
v_mfma_f32_16x16x32_bf16 v[128:131], v[216:219], v[8:11], v[128:131]
buffer_load_dwordx4 v[28:31], v248, s[8:11], s44 offen offset:3072 sc1
v_mfma_f32_16x16x32_bf16 v[132:135], v[216:219], v[40:43], v[132:135]
v_mfma_f32_16x16x32_bf16 v[136:139], v[216:219], v[72:75], v[136:139]
v_mfma_f32_16x16x32_bf16 v[140:143], v[216:219], v[104:107], v[140:143]
ds_read_b128 v[216:219], v240 offset:6656
s_waitcnt lgkmcnt(3)
buffer_load_dwordx4 v[60:63], v248, s[8:11], s45 offen offset:3072 sc1
v_mfma_f32_16x16x32_bf16 v[144:147], v[220:223], v[8:11], v[144:147]
v_mfma_f32_16x16x32_bf16 v[148:151], v[220:223], v[40:43], v[148:151]
v_mfma_f32_16x16x32_bf16 v[152:155], v[220:223], v[72:75], v[152:155]
buffer_load_dwordx4 v[92:95], v248, s[8:11], s46 offen offset:3072 sc1
v_mfma_f32_16x16x32_bf16 v[156:159], v[220:223], v[104:107], v[156:159]
ds_read_b128 v[220:223], v240 offset:20992
s_waitcnt lgkmcnt(3)
v_mfma_f32_16x16x32_bf16 v[176:179], v[208:211], v[8:11], v[176:179]
v_mfma_f32_16x16x32_bf16 v[180:183], v[208:211], v[40:43], v[180:183]
buffer_load_dwordx4 v[124:127], v248, s[8:11], s47 offen offset:3072 sc1
v_mfma_f32_16x16x32_bf16 v[184:187], v[208:211], v[72:75], v[184:187]
v_mfma_f32_16x16x32_bf16 v[188:191], v[208:211], v[104:107], v[188:191]
ds_read_b128 v[208:211], v240 offset:8192
s_waitcnt lgkmcnt(3)
s_waitcnt vmcnt(17)
v_mfma_f32_16x16x32_bf16 v[128:131], v[212:215], v[12:15], v[128:131]
s_add_u32 s16, s4, 0x0
s_addc_u32 s17, s5, 0
s_mov_b32 s18, 0x10000000
v_mfma_f32_16x16x32_bf16 v[132:135], v[212:215], v[44:47], v[132:135]
buffer_load_dwordx4 v241, s[12:15], s28 offen offset:2048 sc1 lds
s_mov_b32 s19, 0x00020000
s_add_u32 s8, s60, 0x0
v_mfma_f32_16x16x32_bf16 v[136:139], v[212:215], v[76:79], v[136:139]
s_addc_u32 s9, s61, 0
s_mov_b32 s10, 0x4e2000
s_mov_b32 s11, 0x00020000
v_mfma_f32_16x16x32_bf16 v[140:143], v[212:215], v[108:111], v[140:143]
ds_read_b128 v[212:215], v240 offset:10240
s_waitcnt lgkmcnt(3)
buffer_load_dwordx4 v241, s[12:15], s28 offen offset:3072 sc1 lds
v_mfma_f32_16x16x32_bf16 v[144:147], v[216:219], v[12:15], v[144:147]
s_mov_b32 s54, 0x4e20
s_mov_b32 s55, 0x00020000
s_mov_b32 s58, 0x4e2000
v_mfma_f32_16x16x32_bf16 v[148:151], v[216:219], v[44:47], v[148:151]
s_mov_b32 s59, 0x00020000
s_lshr_b32 s48, s40, 2
s_cmp_eq_u32 s95, 1
v_mfma_f32_16x16x32_bf16 v[152:155], v[216:219], v[76:79], v[152:155]
s_cselect_b32 s40, 0x70000000, s40
s_cselect_b32 s44, 0x70000000, s44
s_cmp_lt_u32 s37, 3
v_mfma_f32_16x16x32_bf16 v[156:159], v[216:219], v[108:111], v[156:159]
ds_read_b128 v[216:219], v240 offset:24576
s_waitcnt lgkmcnt(3)
s_cselect_b32 s3, 0, 3
v_mfma_f32_16x16x32_bf16 v[176:179], v[220:223], v[12:15], v[176:179]
s_sub_u32 s3, s37, s3
s_cmp_eq_u32 s3, 2
s_cselect_b32 s39, 6, 6
v_mfma_f32_16x16x32_bf16 v[180:183], v[220:223], v[44:47], v[180:183]
s_cselect_b32 s35, 5, 4
s_lshl_b32 s49, s38, 2
s_add_u32 s49, s49, s3
v_mfma_f32_16x16x32_bf16 v[184:187], v[220:223], v[76:79], v[184:187]
s_lshl_b32 s49, s49, 10
s_add_u32 s49, s49, 0x7c00300
v_mfma_f32_16x16x32_bf16 v[188:191], v[220:223], v[108:111], v[188:191]
ds_read_b128 v[220:223], v240 offset:8704
s_waitcnt lgkmcnt(3)
s_waitcnt vmcnt(15)
v_mfma_f32_16x16x32_bf16 v[128:131], v[208:211], v[16:19], v[128:131]
v_mfma_f32_16x16x32_bf16 v[132:135], v[208:211], v[48:51], v[132:135]
s_add_u32 s28, s28, s101
s_add_u32 m0, s30, 0x8000
s_nop 0
v_mfma_f32_16x16x32_bf16 v[136:139], v[208:211], v[80:83], v[136:139]
v_mfma_f32_16x16x32_bf16 v[140:143], v[208:211], v[112:115], v[140:143]
ds_read_b128 v[208:211], v240 offset:10752
s_waitcnt lgkmcnt(3)
buffer_load_dwordx4 v241, s[12:15], s28 offen offset:0 sc1 lds
v_mfma_f32_16x16x32_bf16 v[144:147], v[212:215], v[16:19], v[144:147]
v_mfma_f32_16x16x32_bf16 v[148:151], v[212:215], v[48:51], v[148:151]
buffer_load_dwordx4 v241, s[12:15], s28 offen offset:1024 sc1 lds
v_mfma_f32_16x16x32_bf16 v[152:155], v[212:215], v[80:83], v[152:155]
v_mfma_f32_16x16x32_bf16 v[156:159], v[212:215], v[112:115], v[156:159]
ds_read_b128 v[212:215], v240 offset:25088
s_waitcnt lgkmcnt(3)
v_mfma_f32_16x16x32_bf16 v[176:179], v[216:219], v[16:19], v[176:179]
v_mfma_f32_16x16x32_bf16 v[180:183], v[216:219], v[48:51], v[180:183]
v_mfma_f32_16x16x32_bf16 v[184:187], v[216:219], v[80:83], v[184:187]
v_mfma_f32_16x16x32_bf16 v[188:191], v[216:219], v[112:115], v[188:191]
ds_read_b128 v[216:219], v240 offset:12288
s_waitcnt lgkmcnt(3)
s_waitcnt vmcnt(12)
v_mfma_f32_16x16x32_bf16 v[128:131], v[220:223], v[20:23], v[128:131]
v_mfma_f32_16x16x32_bf16 v[132:135], v[220:223], v[52:55], v[132:135]
buffer_load_dwordx4 v241, s[12:15], s28 offen offset:2048 sc1 lds
v_mfma_f32_16x16x32_bf16 v[136:139], v[220:223], v[84:87], v[136:139]
v_mfma_f32_16x16x32_bf16 v[140:143], v[220:223], v[116:119], v[140:143]
ds_read_b128 v[220:223], v240 offset:14336
s_waitcnt lgkmcnt(3)
buffer_load_dwordx4 v241, s[12:15], s28 offen offset:3072 sc1 lds
v_mfma_f32_16x16x32_bf16 v[144:147], v[208:211], v[20:23], v[144:147]
v_mfma_f32_16x16x32_bf16 v[148:151], v[208:211], v[52:55], v[148:151]
v_mfma_f32_16x16x32_bf16 v[152:155], v[208:211], v[84:87], v[152:155]
v_mfma_f32_16x16x32_bf16 v[156:159], v[208:211], v[116:119], v[156:159]
ds_read_b128 v[208:211], v240 offset:28672
s_waitcnt lgkmcnt(3)
v_mfma_f32_16x16x32_bf16 v[176:179], v[212:215], v[20:23], v[176:179]
v_mfma_f32_16x16x32_bf16 v[180:183], v[212:215], v[52:55], v[180:183]
v_mfma_f32_16x16x32_bf16 v[184:187], v[212:215], v[84:87], v[184:187]
v_mfma_f32_16x16x32_bf16 v[188:191], v[212:215], v[116:119], v[188:191]
ds_read_b128 v[212:215], v240 offset:12800
s_waitcnt lgkmcnt(3)
s_waitcnt vmcnt(10)
v_mfma_f32_16x16x32_bf16 v[128:131], v[216:219], v[24:27], v[128:131]
v_mfma_f32_16x16x32_bf16 v[132:135], v[216:219], v[56:59], v[132:135]
s_add_u32 s28, s28, s101
s_add_u32 s30, s30, 0xc000
v_mfma_f32_16x16x32_bf16 v[136:139], v[216:219], v[88:91], v[136:139]
v_mfma_f32_16x16x32_bf16 v[140:143], v[216:219], v[120:123], v[140:143]
ds_read_b128 v[216:219], v240 offset:14848
s_waitcnt lgkmcnt(3)
v_mfma_f32_16x16x32_bf16 v[144:147], v[220:223], v[24:27], v[144:147]
v_mfma_f32_16x16x32_bf16 v[148:151], v[220:223], v[56:59], v[148:151]
v_mfma_f32_16x16x32_bf16 v[152:155], v[220:223], v[88:91], v[152:155]
v_mfma_f32_16x16x32_bf16 v[156:159], v[220:223], v[120:123], v[156:159]
ds_read_b128 v[220:223], v240 offset:29184
s_waitcnt lgkmcnt(3)
v_mfma_f32_16x16x32_bf16 v[176:179], v[208:211], v[24:27], v[176:179]
v_mfma_f32_16x16x32_bf16 v[180:183], v[208:211], v[56:59], v[180:183]
v_mfma_f32_16x16x32_bf16 v[184:187], v[208:211], v[88:91], v[184:187]
v_mfma_f32_16x16x32_bf16 v[188:191], v[208:211], v[120:123], v[188:191]
s_waitcnt lgkmcnt(2)
s_waitcnt vmcnt(6)
v_mfma_f32_16x16x32_bf16 v[128:131], v[212:215], v[28:31], v[128:131]
v_mfma_f32_16x16x32_bf16 v[132:135], v[212:215], v[60:63], v[132:135]
v_mfma_f32_16x16x32_bf16 v[136:139], v[212:215], v[92:95], v[136:139]
v_mfma_f32_16x16x32_bf16 v[140:143], v[212:215], v[124:127], v[140:143]
s_waitcnt lgkmcnt(1)
v_mfma_f32_16x16x32_bf16 v[144:147], v[216:219], v[28:31], v[144:147]
v_mfma_f32_16x16x32_bf16 v[148:151], v[216:219], v[60:63], v[148:151]
v_mfma_f32_16x16x32_bf16 v[152:155], v[216:219], v[92:95], v[152:155]
v_mfma_f32_16x16x32_bf16 v[156:159], v[216:219], v[124:127], v[156:159]
s_waitcnt lgkmcnt(0)
v_mfma_f32_16x16x32_bf16 v[176:179], v[220:223], v[28:31], v[176:179]
v_mfma_f32_16x16x32_bf16 v[180:183], v[220:223], v[60:63], v[180:183]
v_mfma_f32_16x16x32_bf16 v[184:187], v[220:223], v[92:95], v[184:187]
v_mfma_f32_16x16x32_bf16 v[188:191], v[220:223], v[124:127], v[188:191]
v_max3_f32 v244, v128, v129, v130
v_max3_f32 v245, v132, v133, v134
v_max3_f32 v246, v136, v137, v138
v_max3_f32 v247, v140, v141, v142
v_max3_f32 v244, v244, v131, v144
v_max3_f32 v245, v245, v135, v148
v_max3_f32 v246, v246, v139, v152
v_max3_f32 v247, v247, v143, v156
v_max3_f32 v244, v244, v145, v146
v_max3_f32 v245, v245, v149, v150
v_max3_f32 v246, v246, v153, v154
v_max3_f32 v247, v247, v157, v158
v_max_f32 v244, v244, v147
v_max_f32 v245, v245, v151
v_max_f32 v246, v246, v155
v_max_f32 v247, v247, v159
v_mov_b32 v232, v244
v_mov_b32 v233, v245
v_mov_b32 v234, v246
v_mov_b32 v235, v247
v_permlane32_swap_b32 v244, v232
v_permlane32_swap_b32 v245, v233
v_permlane32_swap_b32 v246, v234
v_permlane32_swap_b32 v247, v235
v_max_f32 v244, v244, v232
v_max_f32 v245, v245, v233
v_max_f32 v246, v246, v234
v_max_f32 v247, v247, v235
v_mov_b32 v232, v244
v_mov_b32 v233, v245
v_mov_b32 v234, v246
v_mov_b32 v235, v247
v_permlane16_swap_b32 v244, v232
v_permlane16_swap_b32 v245, v233
v_permlane16_swap_b32 v246, v234
v_permlane16_swap_b32 v247, v235
v_max_f32 v244, v244, v232
v_max_f32 v245, v245, v233
v_max_f32 v246, v246, v234
v_max_f32 v247, v247, v235
v_ceil_f32 v244, v244
v_ceil_f32 v245, v245
v_ceil_f32 v246, v246
v_ceil_f32 v247, v247
v_sub_f32 v128, v128, v244
v_sub_f32 v129, v129, v244
v_sub_f32 v130, v130, v244
v_sub_f32 v131, v131, v244
v_exp_f32 v128, v128
v_exp_f32 v129, v129
v_exp_f32 v130, v130
v_exp_f32 v131, v131
v_sub_f32 v192, 0, v244
v_sub_f32 v193, 0, v244
v_sub_f32 v194, 0, v244
v_sub_f32 v195, 0, v244
v_sub_f32 v132, v132, v245
v_sub_f32 v133, v133, v245
v_sub_f32 v134, v134, v245
v_sub_f32 v135, v135, v245
v_exp_f32 v132, v132
v_exp_f32 v133, v133
v_exp_f32 v134, v134
v_exp_f32 v135, v135
v_sub_f32 v196, 0, v245
v_sub_f32 v197, 0, v245
v_sub_f32 v198, 0, v245
v_sub_f32 v199, 0, v245
v_sub_f32 v136, v136, v246
v_sub_f32 v137, v137, v246
v_sub_f32 v138, v138, v246
v_sub_f32 v139, v139, v246
v_exp_f32 v136, v136
v_exp_f32 v137, v137
v_exp_f32 v138, v138
v_exp_f32 v139, v139
v_sub_f32 v200, 0, v246
v_sub_f32 v201, 0, v246
v_sub_f32 v202, 0, v246
v_sub_f32 v203, 0, v246
v_sub_f32 v140, v140, v247
v_sub_f32 v141, v141, v247
v_sub_f32 v142, v142, v247
v_sub_f32 v143, v143, v247
v_exp_f32 v140, v140
v_exp_f32 v141, v141
v_exp_f32 v142, v142
v_exp_f32 v143, v143
v_sub_f32 v204, 0, v247
v_sub_f32 v205, 0, v247
v_sub_f32 v206, 0, v247
v_sub_f32 v207, 0, v247
s_waitcnt vmcnt(4)
s_barrier
ds_read_b64_tr_b16 v[208:209], v249 offset:0
ds_read_b64_tr_b16 v[210:211], v249 offset:2048
ds_read_b64_tr_b16 v[212:213], v250 offset:0
ds_read_b64_tr_b16 v[214:215], v250 offset:2048
ds_read_b64_tr_b16 v[216:217], v249 offset:512
ds_read_b64_tr_b16 v[218:219], v249 offset:2560
ds_read_b64_tr_b16 v[220:221], v250 offset:512
ds_read_b64_tr_b16 v[222:223], v250 offset:2560
v_sub_f32 v144, v144, v244
v_sub_f32 v145, v145, v244
v_sub_f32 v146, v146, v244
v_sub_f32 v147, v147, v244
v_exp_f32 v144, v144
v_exp_f32 v145, v145
v_exp_f32 v146, v146
v_exp_f32 v147, v147
v_sub_f32 v148, v148, v245
v_sub_f32 v149, v149, v245
v_sub_f32 v150, v150, v245
v_sub_f32 v151, v151, v245
v_exp_f32 v148, v148
v_exp_f32 v149, v149
v_exp_f32 v150, v150
v_exp_f32 v151, v151
v_sub_f32 v152, v152, v246
v_sub_f32 v153, v153, v246
v_sub_f32 v154, v154, v246
v_sub_f32 v155, v155, v246
v_exp_f32 v152, v152
v_exp_f32 v153, v153
v_exp_f32 v154, v154
v_exp_f32 v155, v155
v_sub_f32 v156, v156, v247
v_sub_f32 v157, v157, v247
v_sub_f32 v158, v158, v247
v_sub_f32 v159, v159, v247
v_exp_f32 v156, v156
v_exp_f32 v157, v157
v_exp_f32 v158, v158
v_exp_f32 v159, v159
v_cvt_pk_bf16_f32 v160, v128, v129
v_cvt_pk_bf16_f32 v161, v130, v131
v_cvt_pk_bf16_f32 v164, v132, v133
v_cvt_pk_bf16_f32 v165, v134, v135
v_cvt_pk_bf16_f32 v168, v136, v137
v_cvt_pk_bf16_f32 v169, v138, v139
v_cvt_pk_bf16_f32 v172, v140, v141
v_cvt_pk_bf16_f32 v173, v142, v143
v_cvt_pk_bf16_f32 v162, v144, v145
v_cvt_pk_bf16_f32 v163, v146, v147
v_cvt_pk_bf16_f32 v166, v148, v149
v_cvt_pk_bf16_f32 v167, v150, v151
v_cvt_pk_bf16_f32 v170, v152, v153
v_cvt_pk_bf16_f32 v171, v154, v155
v_cvt_pk_bf16_f32 v174, v156, v157
v_cvt_pk_bf16_f32 v175, v158, v159
v_add_f32 v224, v128, v129
v_add_f32 v225, v132, v133
v_add_f32 v226, v136, v137
v_add_f32 v227, v140, v141
v_add_f32 v228, v130, v131
v_add_f32 v229, v134, v135
v_add_f32 v230, v138, v139
v_add_f32 v231, v142, v143
v_add_f32 v224, v224, v144
v_add_f32 v225, v225, v148
v_add_f32 v226, v226, v152
v_add_f32 v227, v227, v156
v_add_f32 v228, v228, v145
v_add_f32 v229, v229, v149
v_add_f32 v230, v230, v153
v_add_f32 v231, v231, v157
v_add_f32 v224, v224, v146
v_add_f32 v225, v225, v150
v_add_f32 v226, v226, v154
v_add_f32 v227, v227, v158
v_add_f32 v228, v228, v147
v_add_f32 v229, v229, v151
v_add_f32 v230, v230, v155
v_add_f32 v231, v231, v159
v_add_f32 v224, v224, v228
v_add_f32 v225, v225, v229
v_add_f32 v226, v226, v230
v_add_f32 v227, v227, v231
v_sub_f32 v128, v176, v244
v_sub_f32 v129, v177, v244
v_sub_f32 v130, v178, v244
v_sub_f32 v131, v179, v244
v_sub_f32 v132, v180, v245
v_sub_f32 v133, v181, v245
v_sub_f32 v134, v182, v245
v_sub_f32 v135, v183, v245
v_sub_f32 v136, v184, v246
v_sub_f32 v137, v185, v246
v_sub_f32 v138, v186, v246
v_sub_f32 v139, v187, v246
v_sub_f32 v140, v188, v247
v_sub_f32 v141, v189, v247
v_sub_f32 v142, v190, v247
v_sub_f32 v143, v191, v247
v_cmp_ne_u64 vcc, s[98:99], v[252:253]
s_nop 1
s_cbranch_vccnz LM_pb
LM_pb_ret:
s_nop 1
.p2align 6
L2_loop:
s_waitcnt lgkmcnt(6)
v_mfma_f32_16x16x32_bf16 a[0:3], v[160:163], v[208:211], a[0:3]
v_mfma_f32_16x16x32_bf16 a[4:7], v[164:167], v[208:211], a[4:7]
v_mfma_f32_16x16x32_bf16 a[8:11], v[168:171], v[208:211], a[8:11]
v_mfma_f32_16x16x32_bf16 a[12:15], v[172:175], v[208:211], a[12:15]
ds_read_b64_tr_b16 v[208:209], v249 offset:4096
s_waitcnt lgkmcnt(5)
v_mfma_f32_16x16x32_bf16 a[16:19], v[160:163], v[212:215], a[16:19]
ds_read_b64_tr_b16 v[210:211], v249 offset:6144
v_mfma_f32_16x16x32_bf16 a[20:23], v[164:167], v[212:215], a[20:23]
v_mfma_f32_16x16x32_bf16 a[24:27], v[168:171], v[212:215], a[24:27]
v_mfma_f32_16x16x32_bf16 a[28:31], v[172:175], v[212:215], a[28:31]
ds_read_b64_tr_b16 v[212:213], v250 offset:4096
s_waitcnt lgkmcnt(5)
v_mfma_f32_16x16x32_bf16 a[32:35], v[160:163], v[216:219], a[32:35]
ds_read_b64_tr_b16 v[214:215], v250 offset:6144
v_mfma_f32_16x16x32_bf16 a[36:39], v[164:167], v[216:219], a[36:39]
v_exp_f32 v232, v128
v_mfma_f32_16x16x32_bf16 a[40:43], v[168:171], v[216:219], a[40:43]
v_exp_f32 v233, v129
v_mfma_f32_16x16x32_bf16 a[44:47], v[172:175], v[216:219], a[44:47]
ds_read_b64_tr_b16 v[216:217], v249 offset:4608
s_waitcnt lgkmcnt(5)
v_mfma_f32_16x16x32_bf16 a[48:51], v[160:163], v[220:223], a[48:51]
ds_read_b64_tr_b16 v[218:219], v249 offset:6656
v_mfma_f32_16x16x32_bf16 a[52:55], v[164:167], v[220:223], a[52:55]
v_exp_f32 v234, v130
v_mfma_f32_16x16x32_bf16 a[56:59], v[168:171], v[220:223], a[56:59]
v_add_f32 v228, v224, v232
v_cvt_pk_bf16_f32 v176, v232, v233
v_mfma_f32_16x16x32_bf16 a[60:63], v[172:175], v[220:223], a[60:63]
ds_read_b64_tr_b16 v[220:221], v250 offset:4608
s_waitcnt lgkmcnt(5)
v_mfma_f32_16x16x32_bf16 a[64:67], v[160:163], v[208:211], a[64:67]
ds_read_b64_tr_b16 v[222:223], v250 offset:6656
v_mfma_f32_16x16x32_bf16 a[68:71], v[164:167], v[208:211], a[68:71]
v_exp_f32 v235, v131
v_mfma_f32_16x16x32_bf16 a[72:75], v[168:171], v[208:211], a[72:75]
v_add_f32 v228, v228, v233
v_add_f32 v228, v228, v234
v_mfma_f32_16x16x32_bf16 a[76:79], v[172:175], v[208:211], a[76:79]
ds_read_b128 v[208:211], v240 offset:18432
s_waitcnt lgkmcnt(5)
v_mfma_f32_16x16x32_bf16 a[80:83], v[160:163], v[212:215], a[80:83]
v_add_f32 v228, v228, v235
v_cvt_pk_bf16_f32 v177, v234, v235
v_mfma_f32_16x16x32_bf16 a[84:87], v[164:167], v[212:215], a[84:87]
v_exp_f32 v236, v132
v_mfma_f32_16x16x32_bf16 a[88:91], v[168:171], v[212:215], a[88:91]
v_exp_f32 v237, v133
v_mfma_f32_16x16x32_bf16 a[92:95], v[172:175], v[212:215], a[92:95]
ds_read_b128 v[212:215], v240 offset:18944
s_waitcnt lgkmcnt(4)
v_mfma_f32_16x16x32_bf16 a[96:99], v[160:163], v[216:219], a[96:99]
v_exp_f32 v238, v134
v_mfma_f32_16x16x32_bf16 a[100:103], v[164:167], v[216:219], a[100:103]
v_add_f32 v229, v225, v236
v_cvt_pk_bf16_f32 v180, v236, v237
v_mfma_f32_16x16x32_bf16 a[104:107], v[168:171], v[216:219], a[104:107]
v_exp_f32 v239, v135
v_mfma_f32_16x16x32_bf16 a[108:111], v[172:175], v[216:219], a[108:111]
ds_read_b128 v[216:219], v240 offset:22528
s_waitcnt lgkmcnt(3)
v_mfma_f32_16x16x32_bf16 a[112:115], v[160:163], v[220:223], a[112:115]
v_add_f32 v229, v229, v237
v_add_f32 v229, v229, v238
v_mfma_f32_16x16x32_bf16 a[116:119], v[164:167], v[220:223], a[116:119]
v_add_f32 v229, v229, v239
v_cvt_pk_bf16_f32 v181, v238, v239
v_mfma_f32_16x16x32_bf16 a[120:123], v[168:171], v[220:223], a[120:123]
v_exp_f32 v232, v136
v_mfma_f32_16x16x32_bf16 a[124:127], v[172:175], v[220:223], a[124:127]
ds_read_b128 v[220:223], v240 offset:23040
s_waitcnt lgkmcnt(3)
v_mfma_f32_16x16x32_bf16 v[144:147], v[208:211], v[0:3], v[192:195]
v_exp_f32 v233, v137
v_mfma_f32_16x16x32_bf16 v[148:151], v[208:211], v[32:35], v[196:199]
v_exp_f32 v234, v138
v_mfma_f32_16x16x32_bf16 v[152:155], v[208:211], v[64:67], v[200:203]
v_add_f32 v230, v226, v232
v_cvt_pk_bf16_f32 v184, v232, v233
v_mfma_f32_16x16x32_bf16 v[156:159], v[208:211], v[96:99], v[204:207]
ds_read_b128 v[208:211], v240 offset:26624
s_waitcnt lgkmcnt(3)
v_mfma_f32_16x16x32_bf16 v[144:147], v[212:215], v[4:7], v[144:147]
v_exp_f32 v235, v139
v_mfma_f32_16x16x32_bf16 v[148:151], v[212:215], v[36:39], v[148:151]
v_add_f32 v230, v230, v233
v_add_f32 v230, v230, v234
v_mfma_f32_16x16x32_bf16 v[152:155], v[212:215], v[68:71], v[152:155]
v_add_f32 v230, v230, v235
v_cvt_pk_bf16_f32 v185, v234, v235
v_mfma_f32_16x16x32_bf16 v[156:159], v[212:215], v[100:103], v[156:159]
ds_read_b128 v[212:215], v240 offset:27136
s_waitcnt lgkmcnt(3)
v_mfma_f32_16x16x32_bf16 v[144:147], v[216:219], v[8:11], v[144:147]
v_exp_f32 v236, v140
v_mfma_f32_16x16x32_bf16 v[148:151], v[216:219], v[40:43], v[148:151]
v_exp_f32 v237, v141
v_mfma_f32_16x16x32_bf16 v[152:155], v[216:219], v[72:75], v[152:155]
v_exp_f32 v238, v142
v_mfma_f32_16x16x32_bf16 v[156:159], v[216:219], v[104:107], v[156:159]
ds_read_b128 v[216:219], v240 offset:30720
s_waitcnt lgkmcnt(3)
v_mfma_f32_16x16x32_bf16 v[144:147], v[220:223], v[12:15], v[144:147]
v_add_f32 v231, v227, v236
v_cvt_pk_bf16_f32 v188, v236, v237
v_mfma_f32_16x16x32_bf16 v[148:151], v[220:223], v[44:47], v[148:151]
v_exp_f32 v239, v143
v_mfma_f32_16x16x32_bf16 v[152:155], v[220:223], v[76:79], v[152:155]
v_add_f32 v231, v231, v237
v_add_f32 v231, v231, v238
v_mfma_f32_16x16x32_bf16 v[156:159], v[220:223], v[108:111], v[156:159]
ds_read_b128 v[220:223], v240 offset:31232
s_waitcnt lgkmcnt(3)
v_mfma_f32_16x16x32_bf16 v[144:147], v[208:211], v[16:19], v[144:147]
v_add_f32 v231, v231, v239
v_cvt_pk_bf16_f32 v189, v238, v239
v_mfma_f32_16x16x32_bf16 v[148:151], v[208:211], v[48:51], v[148:151]
v_max3_f32 v242, v228, v229, v230
v_max_f32 v242, v242, v231
v_mfma_f32_16x16x32_bf16 v[152:155], v[208:211], v[80:83], v[152:155]
v_cmp_lt_f32 vcc, s32, v242
s_cbranch_vccnz L2_rare_site0
L2_ret0:
v_mfma_f32_16x16x32_bf16 v[156:159], v[208:211], v[112:115], v[156:159]
ds_read_b64_tr_b16 v[208:209], v249 offset:8192
s_waitcnt lgkmcnt(3)
v_mfma_f32_16x16x32_bf16 v[144:147], v[212:215], v[20:23], v[144:147]
ds_read_b64_tr_b16 v[210:211], v249 offset:10240
s_mov_b32 m0, s30
v_mfma_f32_16x16x32_bf16 v[148:151], v[212:215], v[52:55], v[148:151]
buffer_load_dwordx4 v241, s[12:15], s28 offen offset:0 sc1 lds
v_mfma_f32_16x16x32_bf16 v[152:155], v[212:215], v[84:87], v[152:155]
v_mfma_f32_16x16x32_bf16 v[156:159], v[212:215], v[116:119], v[156:159]
ds_read_b64_tr_b16 v[212:213], v250 offset:8192
s_waitcnt lgkmcnt(4)
v_mfma_f32_16x16x32_bf16 v[144:147], v[216:219], v[24:27], v[144:147]
ds_read_b64_tr_b16 v[214:215], v250 offset:10240
v_mfma_f32_16x16x32_bf16 v[148:151], v[216:219], v[56:59], v[148:151]
buffer_load_dwordx4 v241, s[12:15], s28 offen offset:1024 sc1 lds
v_mfma_f32_16x16x32_bf16 v[152:155], v[216:219], v[88:91], v[152:155]
v_mfma_f32_16x16x32_bf16 v[156:159], v[216:219], v[120:123], v[156:159]
ds_read_b64_tr_b16 v[216:217], v249 offset:8704
s_waitcnt lgkmcnt(5)
v_mfma_f32_16x16x32_bf16 v[144:147], v[220:223], v[28:31], v[144:147]
ds_read_b64_tr_b16 v[218:219], v249 offset:10752
v_mfma_f32_16x16x32_bf16 v[148:151], v[220:223], v[60:63], v[148:151]
buffer_load_dwordx4 v241, s[12:15], s28 offen offset:2048 sc1 lds
v_mfma_f32_16x16x32_bf16 v[152:155], v[220:223], v[92:95], v[152:155]
v_mfma_f32_16x16x32_bf16 v[156:159], v[220:223], v[124:127], v[156:159]
ds_read_b64_tr_b16 v[220:221], v250 offset:8704
s_waitcnt lgkmcnt(5)
v_mfma_f32_16x16x32_bf16 a[128:131], v[160:163], v[208:211], a[128:131]
ds_read_b64_tr_b16 v[222:223], v250 offset:10752
v_mfma_f32_16x16x32_bf16 a[132:135], v[164:167], v[208:211], a[132:135]
buffer_load_dwordx4 v241, s[12:15], s28 offen offset:3072 sc1 lds
v_mfma_f32_16x16x32_bf16 a[136:139], v[168:171], v[208:211], a[136:139]
v_mfma_f32_16x16x32_bf16 a[140:143], v[172:175], v[208:211], a[140:143]
ds_read_b64_tr_b16 v[208:209], v249 offset:12288
s_waitcnt lgkmcnt(5)
v_mfma_f32_16x16x32_bf16 a[144:147], v[160:163], v[212:215], a[144:147]
ds_read_b64_tr_b16 v[210:211], v249 offset:14336
v_mfma_f32_16x16x32_bf16 a[148:151], v[164:167], v[212:215], a[148:151]
v_mfma_f32_16x16x32_bf16 a[152:155], v[168:171], v[212:215], a[152:155]
v_add_u32 v240, 0x8000, v240
v_and_b32 v240, 0x1ffff, v240
v_mfma_f32_16x16x32_bf16 a[156:159], v[172:175], v[212:215], a[156:159]
ds_read_b64_tr_b16 v[212:213], v250 offset:12288
s_waitcnt lgkmcnt(5)
v_mfma_f32_16x16x32_bf16 a[160:163], v[160:163], v[216:219], a[160:163]
ds_read_b64_tr_b16 v[214:215], v250 offset:14336
v_mfma_f32_16x16x32_bf16 a[164:167], v[164:167], v[216:219], a[164:167]
v_exp_f32 v232, v144
v_mfma_f32_16x16x32_bf16 a[168:171], v[168:171], v[216:219], a[168:171]
v_exp_f32 v233, v145
v_mfma_f32_16x16x32_bf16 a[172:175], v[172:175], v[216:219], a[172:175]
ds_read_b64_tr_b16 v[216:217], v249 offset:12800
s_waitcnt lgkmcnt(5)
v_mfma_f32_16x16x32_bf16 a[176:179], v[160:163], v[220:223], a[176:179]
ds_read_b64_tr_b16 v[218:219], v249 offset:14848
v_mfma_f32_16x16x32_bf16 a[180:183], v[164:167], v[220:223], a[180:183]
v_exp_f32 v234, v146
v_mfma_f32_16x16x32_bf16 a[184:187], v[168:171], v[220:223], a[184:187]
v_add_f32 v224, v228, v232
v_cvt_pk_bf16_f32 v178, v232, v233
v_mfma_f32_16x16x32_bf16 a[188:191], v[172:175], v[220:223], a[188:191]
ds_read_b64_tr_b16 v[220:221], v250 offset:12800
s_waitcnt lgkmcnt(5)
v_mfma_f32_16x16x32_bf16 a[192:195], v[160:163], v[208:211], a[192:195]
ds_read_b64_tr_b16 v[222:223], v250 offset:14848
v_mfma_f32_16x16x32_bf16 a[196:199], v[164:167], v[208:211], a[196:199]
s_waitcnt vmcnt(4)
s_barrier
v_mfma_f32_16x16x32_bf16 a[200:203], v[168:171], v[208:211], a[200:203]
v_exp_f32 v235, v147
v_mfma_f32_16x16x32_bf16 a[204:207], v[172:175], v[208:211], a[204:207]
ds_read_b128 v[208:211], v240 offset:0
s_waitcnt lgkmcnt(5)
v_mfma_f32_16x16x32_bf16 a[208:211], v[160:163], v[212:215], a[208:211]
v_add_f32 v224, v224, v233
v_add_f32 v224, v224, v234
v_mfma_f32_16x16x32_bf16 a[212:215], v[164:167], v[212:215], a[212:215]
v_add_f32 v224, v224, v235
v_cvt_pk_bf16_f32 v179, v234, v235
v_mfma_f32_16x16x32_bf16 a[216:219], v[168:171], v[212:215], a[216:219]
v_exp_f32 v236, v148
v_mfma_f32_16x16x32_bf16 a[220:223], v[172:175], v[212:215], a[220:223]
ds_read_b128 v[212:215], v240 offset:512
s_waitcnt lgkmcnt(4)
v_mfma_f32_16x16x32_bf16 a[224:227], v[160:163], v[216:219], a[224:227]
v_exp_f32 v237, v149
v_mfma_f32_16x16x32_bf16 a[228:231], v[164:167], v[216:219], a[228:231]
v_exp_f32 v238, v150
v_mfma_f32_16x16x32_bf16 a[232:235], v[168:171], v[216:219], a[232:235]
v_add_f32 v225, v229, v236
v_cvt_pk_bf16_f32 v182, v236, v237
v_mfma_f32_16x16x32_bf16 a[236:239], v[172:175], v[216:219], a[236:239]
ds_read_b128 v[216:219], v240 offset:4096
s_waitcnt lgkmcnt(3)
v_mfma_f32_16x16x32_bf16 a[240:243], v[160:163], v[220:223], a[240:243]
v_exp_f32 v239, v151
v_mfma_f32_16x16x32_bf16 a[244:247], v[164:167], v[220:223], a[244:247]
v_add_f32 v225, v225, v237
v_add_f32 v225, v225, v238
v_mfma_f32_16x16x32_bf16 a[248:251], v[168:171], v[220:223], a[248:251]
v_add_f32 v225, v225, v239
v_cvt_pk_bf16_f32 v183, v238, v239
v_mfma_f32_16x16x32_bf16 a[252:255], v[172:175], v[220:223], a[252:255]
ds_read_b128 v[220:223], v240 offset:4608
s_waitcnt lgkmcnt(3)
v_mfma_f32_16x16x32_bf16 v[128:131], v[208:211], v[0:3], v[192:195]
v_exp_f32 v232, v152
v_mfma_f32_16x16x32_bf16 v[132:135], v[208:211], v[32:35], v[196:199]
v_exp_f32 v233, v153
v_mfma_f32_16x16x32_bf16 v[136:139], v[208:211], v[64:67], v[200:203]
v_exp_f32 v234, v154
v_mfma_f32_16x16x32_bf16 v[140:143], v[208:211], v[96:99], v[204:207]
ds_read_b128 v[208:211], v240 offset:8192
s_waitcnt lgkmcnt(3)
v_mfma_f32_16x16x32_bf16 v[128:131], v[212:215], v[4:7], v[128:131]
v_add_f32 v226, v230, v232
v_cvt_pk_bf16_f32 v186, v232, v233
v_mfma_f32_16x16x32_bf16 v[132:135], v[212:215], v[36:39], v[132:135]
v_exp_f32 v235, v155
v_mfma_f32_16x16x32_bf16 v[136:139], v[212:215], v[68:71], v[136:139]
v_add_f32 v226, v226, v233
v_add_f32 v226, v226, v234
v_mfma_f32_16x16x32_bf16 v[140:143], v[212:215], v[100:103], v[140:143]
ds_read_b128 v[212:215], v240 offset:8704
s_waitcnt lgkmcnt(3)
v_mfma_f32_16x16x32_bf16 v[128:131], v[216:219], v[8:11], v[128:131]
v_add_f32 v226, v226, v235
v_cvt_pk_bf16_f32 v187, v234, v235
v_mfma_f32_16x16x32_bf16 v[132:135], v[216:219], v[40:43], v[132:135]
v_exp_f32 v236, v156
v_mfma_f32_16x16x32_bf16 v[136:139], v[216:219], v[72:75], v[136:139]
v_exp_f32 v237, v157
v_mfma_f32_16x16x32_bf16 v[140:143], v[216:219], v[104:107], v[140:143]
ds_read_b128 v[216:219], v240 offset:12288
s_waitcnt lgkmcnt(3)
v_mfma_f32_16x16x32_bf16 v[128:131], v[220:223], v[12:15], v[128:131]
v_exp_f32 v238, v158
v_mfma_f32_16x16x32_bf16 v[132:135], v[220:223], v[44:47], v[132:135]
v_add_f32 v227, v231, v236
v_cvt_pk_bf16_f32 v190, v236, v237
v_mfma_f32_16x16x32_bf16 v[136:139], v[220:223], v[76:79], v[136:139]
v_exp_f32 v239, v159
v_mfma_f32_16x16x32_bf16 v[140:143], v[220:223], v[108:111], v[140:143]
ds_read_b128 v[220:223], v240 offset:12800
s_waitcnt lgkmcnt(3)
v_mfma_f32_16x16x32_bf16 v[128:131], v[208:211], v[16:19], v[128:131]
v_add_f32 v227, v227, v237
v_add_f32 v227, v227, v238
v_mfma_f32_16x16x32_bf16 v[132:135], v[208:211], v[48:51], v[132:135]
v_add_f32 v227, v227, v239
v_cvt_pk_bf16_f32 v191, v238, v239
v_mfma_f32_16x16x32_bf16 v[136:139], v[208:211], v[80:83], v[136:139]
v_max3_f32 v242, v224, v225, v226
v_max_f32 v242, v242, v227
v_mfma_f32_16x16x32_bf16 v[140:143], v[208:211], v[112:115], v[140:143]
ds_read_b64_tr_b16 v[208:209], v249 offset:16384
s_waitcnt lgkmcnt(3)
v_mfma_f32_16x16x32_bf16 v[128:131], v[212:215], v[20:23], v[128:131]
ds_read_b64_tr_b16 v[210:211], v249 offset:18432
v_cmp_lt_f32 vcc, s32, v242
v_mfma_f32_16x16x32_bf16 v[132:135], v[212:215], v[52:55], v[132:135]
s_cbranch_vccnz L2_rare_site1
L2_ret1:
v_mfma_f32_16x16x32_bf16 v[136:139], v[212:215], v[84:87], v[136:139]
v_mfma_f32_16x16x32_bf16 v[140:143], v[212:215], v[116:119], v[140:143]
ds_read_b64_tr_b16 v[212:213], v250 offset:16384
s_waitcnt lgkmcnt(4)
v_mfma_f32_16x16x32_bf16 v[128:131], v[216:219], v[24:27], v[128:131]
ds_read_b64_tr_b16 v[214:215], v250 offset:18432
v_mfma_f32_16x16x32_bf16 v[132:135], v[216:219], v[56:59], v[132:135]
v_mfma_f32_16x16x32_bf16 v[136:139], v[216:219], v[88:91], v[136:139]
s_sub_u32 s31, s31, 1
v_mfma_f32_16x16x32_bf16 v[140:143], v[216:219], v[120:123], v[140:143]
ds_read_b64_tr_b16 v[216:217], v249 offset:16896
s_waitcnt lgkmcnt(5)
v_mfma_f32_16x16x32_bf16 v[128:131], v[220:223], v[28:31], v[128:131]
ds_read_b64_tr_b16 v[218:219], v249 offset:18944
v_mfma_f32_16x16x32_bf16 v[132:135], v[220:223], v[60:63], v[132:135]
s_add_u32 s28, s28, s101
s_add_u32 s30, s30, 0x4000
v_mfma_f32_16x16x32_bf16 v[136:139], v[220:223], v[92:95], v[136:139]
s_and_b32 s30, s30, 0x1ffff
s_cmp_eq_u32 s31, 0
v_mfma_f32_16x16x32_bf16 v[140:143], v[220:223], v[124:127], v[140:143]
ds_read_b64_tr_b16 v[220:221], v250 offset:16896
ds_read_b64_tr_b16 v[222:223], v250 offset:18944
s_cbranch_scc1 L2_x1
L2_loop1:
s_waitcnt lgkmcnt(6)
v_mfma_f32_16x16x32_bf16 a[0:3], v[176:179], v[208:211], a[0:3]
v_mfma_f32_16x16x32_bf16 a[4:7], v[180:183], v[208:211], a[4:7]
v_mfma_f32_16x16x32_bf16 a[8:11], v[184:187], v[208:211], a[8:11]
v_mfma_f32_16x16x32_bf16 a[12:15], v[188:191], v[208:211], a[12:15]
ds_read_b64_tr_b16 v[208:209], v249 offset:20480
s_waitcnt lgkmcnt(5)
v_mfma_f32_16x16x32_bf16 a[16:19], v[176:179], v[212:215], a[16:19]
ds_read_b64_tr_b16 v[210:211], v249 offset:22528
v_mfma_f32_16x16x32_bf16 a[20:23], v[180:183], v[212:215], a[20:23]
v_mfma_f32_16x16x32_bf16 a[24:27], v[184:187], v[212:215], a[24:27]
v_mfma_f32_16x16x32_bf16 a[28:31], v[188:191], v[212:215], a[28:31]
ds_read_b64_tr_b16 v[212:213], v250 offset:20480
s_waitcnt lgkmcnt(5)
v_mfma_f32_16x16x32_bf16 a[32:35], v[176:179], v[216:219], a[32:35]
ds_read_b64_tr_b16 v[214:215], v250 offset:22528
v_mfma_f32_16x16x32_bf16 a[36:39], v[180:183], v[216:219], a[36:39]
v_exp_f32 v232, v128
v_mfma_f32_16x16x32_bf16 a[40:43], v[184:187], v[216:219], a[40:43]
v_exp_f32 v233, v129
v_mfma_f32_16x16x32_bf16 a[44:47], v[188:191], v[216:219], a[44:47]
ds_read_b64_tr_b16 v[216:217], v249 offset:20992
s_waitcnt lgkmcnt(5)
v_mfma_f32_16x16x32_bf16 a[48:51], v[176:179], v[220:223], a[48:51]
ds_read_b64_tr_b16 v[218:219], v249 offset:23040
v_mfma_f32_16x16x32_bf16 a[52:55], v[180:183], v[220:223], a[52:55]
v_exp_f32 v234, v130
v_mfma_f32_16x16x32_bf16 a[56:59], v[184:187], v[220:223], a[56:59]
v_add_f32 v228, v224, v232
v_cvt_pk_bf16_f32 v160, v232, v233
v_mfma_f32_16x16x32_bf16 a[60:63], v[188:191], v[220:223], a[60:63]
ds_read_b64_tr_b16 v[220:221], v250 offset:20992
s_waitcnt lgkmcnt(5)
v_mfma_f32_16x16x32_bf16 a[64:67], v[176:179], v[208:211], a[64:67]
ds_read_b64_tr_b16 v[222:223], v250 offset:23040
v_mfma_f32_16x16x32_bf16 a[68:71], v[180:183], v[208:211], a[68:71]
v_exp_f32 v235, v131
v_mfma_f32_16x16x32_bf16 a[72:75], v[184:187], v[208:211], a[72:75]
v_add_f32 v228, v228, v233
v_add_f32 v228, v228, v234
v_mfma_f32_16x16x32_bf16 a[76:79], v[188:191], v[208:211], a[76:79]
ds_read_b128 v[208:211], v240 offset:2048
s_waitcnt lgkmcnt(5)
v_mfma_f32_16x16x32_bf16 a[80:83], v[176:179], v[212:215], a[80:83]
v_add_f32 v228, v228, v235
v_cvt_pk_bf16_f32 v161, v234, v235
v_mfma_f32_16x16x32_bf16 a[84:87], v[180:183], v[212:215], a[84:87]
v_exp_f32 v236, v132
v_mfma_f32_16x16x32_bf16 a[88:91], v[184:187], v[212:215], a[88:91]
v_exp_f32 v237, v133
v_mfma_f32_16x16x32_bf16 a[92:95], v[188:191], v[212:215], a[92:95]
ds_read_b128 v[212:215], v240 offset:2560
s_waitcnt lgkmcnt(4)
v_mfma_f32_16x16x32_bf16 a[96:99], v[176:179], v[216:219], a[96:99]
v_exp_f32 v238, v134
v_mfma_f32_16x16x32_bf16 a[100:103], v[180:183], v[216:219], a[100:103]
v_add_f32 v229, v225, v236
v_cvt_pk_bf16_f32 v164, v236, v237
v_mfma_f32_16x16x32_bf16 a[104:107], v[184:187], v[216:219], a[104:107]
v_exp_f32 v239, v135
v_mfma_f32_16x16x32_bf16 a[108:111], v[188:191], v[216:219], a[108:111]
ds_read_b128 v[216:219], v240 offset:6144
s_waitcnt lgkmcnt(3)
v_mfma_f32_16x16x32_bf16 a[112:115], v[176:179], v[220:223], a[112:115]
v_add_f32 v229, v229, v237
v_add_f32 v229, v229, v238
v_mfma_f32_16x16x32_bf16 a[116:119], v[180:183], v[220:223], a[116:119]
v_add_f32 v229, v229, v239
v_cvt_pk_bf16_f32 v165, v238, v239
v_mfma_f32_16x16x32_bf16 a[120:123], v[184:187], v[220:223], a[120:123]
v_exp_f32 v232, v136
v_mfma_f32_16x16x32_bf16 a[124:127], v[188:191], v[220:223], a[124:127]
ds_read_b128 v[220:223], v240 offset:6656
s_waitcnt lgkmcnt(3)
v_mfma_f32_16x16x32_bf16 v[144:147], v[208:211], v[0:3], v[192:195]
v_exp_f32 v233, v137
v_mfma_f32_16x16x32_bf16 v[148:151], v[208:211], v[32:35], v[196:199]
v_exp_f32 v234, v138
v_mfma_f32_16x16x32_bf16 v[152:155], v[208:211], v[64:67], v[200:203]
v_add_f32 v230, v226, v232
v_cvt_pk_bf16_f32 v168, v232, v233
v_mfma_f32_16x16x32_bf16 v[156:159], v[208:211], v[96:99], v[204:207]
ds_read_b128 v[208:211], v240 offset:10240
s_waitcnt lgkmcnt(3)
v_mfma_f32_16x16x32_bf16 v[144:147], v[212:215], v[4:7], v[144:147]
v_exp_f32 v235, v139
v_mfma_f32_16x16x32_bf16 v[148:151], v[212:215], v[36:39], v[148:151]
v_add_f32 v230, v230, v233
v_add_f32 v230, v230, v234
v_mfma_f32_16x16x32_bf16 v[152:155], v[212:215], v[68:71], v[152:155]
v_add_f32 v230, v230, v235
v_cvt_pk_bf16_f32 v169, v234, v235
v_mfma_f32_16x16x32_bf16 v[156:159], v[212:215], v[100:103], v[156:159]
ds_read_b128 v[212:215], v240 offset:10752
s_waitcnt lgkmcnt(3)
v_mfma_f32_16x16x32_bf16 v[144:147], v[216:219], v[8:11], v[144:147]
v_exp_f32 v236, v140
v_mfma_f32_16x16x32_bf16 v[148:151], v[216:219], v[40:43], v[148:151]
v_exp_f32 v237, v141
v_mfma_f32_16x16x32_bf16 v[152:155], v[216:219], v[72:75], v[152:155]
v_exp_f32 v238, v142
v_mfma_f32_16x16x32_bf16 v[156:159], v[216:219], v[104:107], v[156:159]
ds_read_b128 v[216:219], v240 offset:14336
s_waitcnt lgkmcnt(3)
v_mfma_f32_16x16x32_bf16 v[144:147], v[220:223], v[12:15], v[144:147]
v_add_f32 v231, v227, v236
v_cvt_pk_bf16_f32 v172, v236, v237
v_mfma_f32_16x16x32_bf16 v[148:151], v[220:223], v[44:47], v[148:151]
v_exp_f32 v239, v143
v_mfma_f32_16x16x32_bf16 v[152:155], v[220:223], v[76:79], v[152:155]
v_add_f32 v231, v231, v237
v_add_f32 v231, v231, v238
v_mfma_f32_16x16x32_bf16 v[156:159], v[220:223], v[108:111], v[156:159]
ds_read_b128 v[220:223], v240 offset:14848
s_waitcnt lgkmcnt(3)
v_mfma_f32_16x16x32_bf16 v[144:147], v[208:211], v[16:19], v[144:147]
v_add_f32 v231, v231, v239
v_cvt_pk_bf16_f32 v173, v238, v239
v_mfma_f32_16x16x32_bf16 v[148:151], v[208:211], v[48:51], v[148:151]
v_max3_f32 v242, v228, v229, v230
v_max_f32 v242, v242, v231
v_mfma_f32_16x16x32_bf16 v[152:155], v[208:211], v[80:83], v[152:155]
v_cmp_lt_f32 vcc, s32, v242
s_cbranch_vccnz L2_rare_site2
L2_ret2:
v_mfma_f32_16x16x32_bf16 v[156:159], v[208:211], v[112:115], v[156:159]
ds_read_b64_tr_b16 v[208:209], v249 offset:24576
s_waitcnt lgkmcnt(3)
v_mfma_f32_16x16x32_bf16 v[144:147], v[212:215], v[20:23], v[144:147]
ds_read_b64_tr_b16 v[210:211], v249 offset:26624
s_mov_b32 m0, s30
v_mfma_f32_16x16x32_bf16 v[148:151], v[212:215], v[52:55], v[148:151]
buffer_load_dwordx4 v241, s[12:15], s28 offen offset:0 sc1 lds
v_mfma_f32_16x16x32_bf16 v[152:155], v[212:215], v[84:87], v[152:155]
v_mfma_f32_16x16x32_bf16 v[156:159], v[212:215], v[116:119], v[156:159]
ds_read_b64_tr_b16 v[212:213], v250 offset:24576
s_waitcnt lgkmcnt(4)
v_mfma_f32_16x16x32_bf16 v[144:147], v[216:219], v[24:27], v[144:147]
ds_read_b64_tr_b16 v[214:215], v250 offset:26624
v_mfma_f32_16x16x32_bf16 v[148:151], v[216:219], v[56:59], v[148:151]
buffer_load_dwordx4 v241, s[12:15], s28 offen offset:1024 sc1 lds
v_mfma_f32_16x16x32_bf16 v[152:155], v[216:219], v[88:91], v[152:155]
v_mfma_f32_16x16x32_bf16 v[156:159], v[216:219], v[120:123], v[156:159]
ds_read_b64_tr_b16 v[216:217], v249 offset:25088
s_waitcnt lgkmcnt(5)
v_mfma_f32_16x16x32_bf16 v[144:147], v[220:223], v[28:31], v[144:147]
ds_read_b64_tr_b16 v[218:219], v249 offset:27136
v_mfma_f32_16x16x32_bf16 v[148:151], v[220:223], v[60:63], v[148:151]
buffer_load_dwordx4 v241, s[12:15], s28 offen offset:2048 sc1 lds
v_mfma_f32_16x16x32_bf16 v[152:155], v[220:223], v[92:95], v[152:155]
v_mfma_f32_16x16x32_bf16 v[156:159], v[220:223], v[124:127], v[156:159]
ds_read_b64_tr_b16 v[220:221], v250 offset:25088
s_waitcnt lgkmcnt(5)
v_mfma_f32_16x16x32_bf16 a[128:131], v[176:179], v[208:211], a[128:131]
ds_read_b64_tr_b16 v[222:223], v250 offset:27136
v_mfma_f32_16x16x32_bf16 a[132:135], v[180:183], v[208:211], a[132:135]
buffer_load_dwordx4 v241, s[12:15], s28 offen offset:3072 sc1 lds
v_mfma_f32_16x16x32_bf16 a[136:139], v[184:187], v[208:211], a[136:139]
v_mfma_f32_16x16x32_bf16 a[140:143], v[188:191], v[208:211], a[140:143]
ds_read_b64_tr_b16 v[208:209], v249 offset:28672
s_waitcnt lgkmcnt(5)
v_mfma_f32_16x16x32_bf16 a[144:147], v[176:179], v[212:215], a[144:147]
ds_read_b64_tr_b16 v[210:211], v249 offset:30720
v_mfma_f32_16x16x32_bf16 a[148:151], v[180:183], v[212:215], a[148:151]
v_mfma_f32_16x16x32_bf16 a[152:155], v[184:187], v[212:215], a[152:155]
v_mfma_f32_16x16x32_bf16 a[156:159], v[188:191], v[212:215], a[156:159]
ds_read_b64_tr_b16 v[212:213], v250 offset:28672
s_waitcnt lgkmcnt(5)
v_mfma_f32_16x16x32_bf16 a[160:163], v[176:179], v[216:219], a[160:163]
ds_read_b64_tr_b16 v[214:215], v250 offset:30720
v_mfma_f32_16x16x32_bf16 a[164:167], v[180:183], v[216:219], a[164:167]
v_exp_f32 v232, v144
v_mfma_f32_16x16x32_bf16 a[168:171], v[184:187], v[216:219], a[168:171]
v_exp_f32 v233, v145
v_mfma_f32_16x16x32_bf16 a[172:175], v[188:191], v[216:219], a[172:175]
ds_read_b64_tr_b16 v[216:217], v249 offset:29184
s_waitcnt lgkmcnt(5)
v_mfma_f32_16x16x32_bf16 a[176:179], v[176:179], v[220:223], a[176:179]
ds_read_b64_tr_b16 v[218:219], v249 offset:31232
v_mfma_f32_16x16x32_bf16 a[180:183], v[180:183], v[220:223], a[180:183]
v_exp_f32 v234, v146
v_mfma_f32_16x16x32_bf16 a[184:187], v[184:187], v[220:223], a[184:187]
v_add_f32 v224, v228, v232
v_cvt_pk_bf16_f32 v162, v232, v233
v_mfma_f32_16x16x32_bf16 a[188:191], v[188:191], v[220:223], a[188:191]
ds_read_b64_tr_b16 v[220:221], v250 offset:29184
s_waitcnt lgkmcnt(5)
v_mfma_f32_16x16x32_bf16 a[192:195], v[176:179], v[208:211], a[192:195]
ds_read_b64_tr_b16 v[222:223], v250 offset:31232
v_mfma_f32_16x16x32_bf16 a[196:199], v[180:183], v[208:211], a[196:199]
s_waitcnt vmcnt(4)
s_barrier
v_mfma_f32_16x16x32_bf16 a[200:203], v[184:187], v[208:211], a[200:203]
v_exp_f32 v235, v147
v_mfma_f32_16x16x32_bf16 a[204:207], v[188:191], v[208:211], a[204:207]
ds_read_b128 v[208:211], v240 offset:16384
s_waitcnt lgkmcnt(5)
v_mfma_f32_16x16x32_bf16 a[208:211], v[176:179], v[212:215], a[208:211]
v_add_u32 v249, 0x8000, v249
v_and_b32 v249, 0x1ffff, v249
v_mfma_f32_16x16x32_bf16 a[212:215], v[180:183], v[212:215], a[212:215]
v_xor_b32 v250, 32, v249
v_add_f32 v224, v224, v233
v_mfma_f32_16x16x32_bf16 a[216:219], v[184:187], v[212:215], a[216:219]
v_add_f32 v224, v224, v234
v_add_f32 v224, v224, v235
v_mfma_f32_16x16x32_bf16 a[220:223], v[188:191], v[212:215], a[220:223]
ds_read_b128 v[212:215], v240 offset:16896
s_waitcnt lgkmcnt(4)
v_mfma_f32_16x16x32_bf16 a[224:227], v[176:179], v[216:219], a[224:227]
v_cvt_pk_bf16_f32 v163, v234, v235
v_mfma_f32_16x16x32_bf16 a[228:231], v[180:183], v[216:219], a[228:231]
v_exp_f32 v236, v148
v_mfma_f32_16x16x32_bf16 a[232:235], v[184:187], v[216:219], a[232:235]
v_exp_f32 v237, v149
v_mfma_f32_16x16x32_bf16 a[236:239], v[188:191], v[216:219], a[236:239]
ds_read_b128 v[216:219], v240 offset:20480
s_waitcnt lgkmcnt(3)
v_mfma_f32_16x16x32_bf16 a[240:243], v[176:179], v[220:223], a[240:243]
v_exp_f32 v238, v150
v_mfma_f32_16x16x32_bf16 a[244:247], v[180:183], v[220:223], a[244:247]
v_add_f32 v225, v229, v236
v_cvt_pk_bf16_f32 v166, v236, v237
v_mfma_f32_16x16x32_bf16 a[248:251], v[184:187], v[220:223], a[248:251]
v_exp_f32 v239, v151
v_mfma_f32_16x16x32_bf16 a[252:255], v[188:191], v[220:223], a[252:255]
ds_read_b128 v[220:223], v240 offset:20992
s_waitcnt lgkmcnt(3)
v_mfma_f32_16x16x32_bf16 v[128:131], v[208:211], v[0:3], v[192:195]
v_add_f32 v225, v225, v237
v_add_f32 v225, v225, v238
v_mfma_f32_16x16x32_bf16 v[132:135], v[208:211], v[32:35], v[196:199]
v_add_f32 v225, v225, v239
v_cvt_pk_bf16_f32 v167, v238, v239
v_mfma_f32_16x16x32_bf16 v[136:139], v[208:211], v[64:67], v[200:203]
v_exp_f32 v232, v152
v_mfma_f32_16x16x32_bf16 v[140:143], v[208:211], v[96:99], v[204:207]
ds_read_b128 v[208:211], v240 offset:24576
s_waitcnt lgkmcnt(3)
v_mfma_f32_16x16x32_bf16 v[128:131], v[212:215], v[4:7], v[128:131]
v_exp_f32 v233, v153
v_mfma_f32_16x16x32_bf16 v[132:135], v[212:215], v[36:39], v[132:135]
v_exp_f32 v234, v154
v_mfma_f32_16x16x32_bf16 v[136:139], v[212:215], v[68:71], v[136:139]
v_add_f32 v226, v230, v232
v_cvt_pk_bf16_f32 v170, v232, v233
v_mfma_f32_16x16x32_bf16 v[140:143], v[212:215], v[100:103], v[140:143]
ds_read_b128 v[212:215], v240 offset:25088
s_waitcnt lgkmcnt(3)
v_mfma_f32_16x16x32_bf16 v[128:131], v[216:219], v[8:11], v[128:131]
v_exp_f32 v235, v155
v_mfma_f32_16x16x32_bf16 v[132:135], v[216:219], v[40:43], v[132:135]
v_add_f32 v226, v226, v233
v_add_f32 v226, v226, v234
v_mfma_f32_16x16x32_bf16 v[136:139], v[216:219], v[72:75], v[136:139]
v_add_f32 v226, v226, v235
v_cvt_pk_bf16_f32 v171, v234, v235
v_mfma_f32_16x16x32_bf16 v[140:143], v[216:219], v[104:107], v[140:143]
ds_read_b128 v[216:219], v240 offset:28672
s_waitcnt lgkmcnt(3)
v_mfma_f32_16x16x32_bf16 v[128:131], v[220:223], v[12:15], v[128:131]
v_exp_f32 v236, v156
v_mfma_f32_16x16x32_bf16 v[132:135], v[220:223], v[44:47], v[132:135]
v_exp_f32 v237, v157
v_mfma_f32_16x16x32_bf16 v[136:139], v[220:223], v[76:79], v[136:139]
v_exp_f32 v238, v158
v_mfma_f32_16x16x32_bf16 v[140:143], v[220:223], v[108:111], v[140:143]
ds_read_b128 v[220:223], v240 offset:29184
s_waitcnt lgkmcnt(3)
v_mfma_f32_16x16x32_bf16 v[128:131], v[208:211], v[16:19], v[128:131]
v_add_f32 v227, v231, v236
v_cvt_pk_bf16_f32 v174, v236, v237
v_mfma_f32_16x16x32_bf16 v[132:135], v[208:211], v[48:51], v[132:135]
v_exp_f32 v239, v159
v_mfma_f32_16x16x32_bf16 v[136:139], v[208:211], v[80:83], v[136:139]
v_add_f32 v227, v227, v237
v_add_f32 v227, v227, v238
v_mfma_f32_16x16x32_bf16 v[140:143], v[208:211], v[112:115], v[140:143]
ds_read_b64_tr_b16 v[208:209], v249 offset:0
s_waitcnt lgkmcnt(3)
v_mfma_f32_16x16x32_bf16 v[128:131], v[212:215], v[20:23], v[128:131]
ds_read_b64_tr_b16 v[210:211], v249 offset:2048
v_add_f32 v227, v227, v239
v_mfma_f32_16x16x32_bf16 v[132:135], v[212:215], v[52:55], v[132:135]
v_cvt_pk_bf16_f32 v175, v238, v239
v_max3_f32 v242, v224, v225, v226
v_mfma_f32_16x16x32_bf16 v[136:139], v[212:215], v[84:87], v[136:139]
v_max_f32 v242, v242, v227
v_cmp_lt_f32 vcc, s32, v242
v_mfma_f32_16x16x32_bf16 v[140:143], v[212:215], v[116:119], v[140:143]
ds_read_b64_tr_b16 v[212:213], v250 offset:0
s_waitcnt lgkmcnt(4)
v_mfma_f32_16x16x32_bf16 v[128:131], v[216:219], v[24:27], v[128:131]
ds_read_b64_tr_b16 v[214:215], v250 offset:2048
s_cbranch_vccnz L2_rare_site3
L2_ret3:
v_mfma_f32_16x16x32_bf16 v[132:135], v[216:219], v[56:59], v[132:135]
v_mfma_f32_16x16x32_bf16 v[136:139], v[216:219], v[88:91], v[136:139]
s_sub_u32 s31, s31, 1
v_mfma_f32_16x16x32_bf16 v[140:143], v[216:219], v[120:123], v[140:143]
ds_read_b64_tr_b16 v[216:217], v249 offset:512
s_waitcnt lgkmcnt(5)
v_mfma_f32_16x16x32_bf16 v[128:131], v[220:223], v[28:31], v[128:131]
ds_read_b64_tr_b16 v[218:219], v249 offset:2560
v_mfma_f32_16x16x32_bf16 v[132:135], v[220:223], v[60:63], v[132:135]
s_add_u32 s28, s28, s101
s_add_u32 s30, s30, 0x4000
v_mfma_f32_16x16x32_bf16 v[136:139], v[220:223], v[92:95], v[136:139]
s_and_b32 s30, s30, 0x1ffff
s_cmp_eq_u32 s31, 0
v_mfma_f32_16x16x32_bf16 v[140:143], v[220:223], v[124:127], v[140:143]
ds_read_b64_tr_b16 v[220:221], v250 offset:512
ds_read_b64_tr_b16 v[222:223], v250 offset:2560
s_cbranch_scc0 L2_loop
s_cmp_eq_u32 s100, 0
s_cbranch_scc1 L2_tail_0
s_mov_b32 s3, 0
s_branch L2_ev
L2_x1:
s_cmp_eq_u32 s100, 0
s_cbranch_scc1 L2_tail_1
s_mov_b32 s3, 1
L2_ev:
s_sub_u32 s100, s100, 1
s_mov_b32 s31, 1
v_mov_b32 v251, 0x20000
s_cmp_eq_u32 s100, 0
s_cbranch_scc1 L2_ev3
s_cmp_lg_u32 s34, 0
s_cbranch_scc1 L2_evr
s_cmp_eq_u32 s100, 1
s_cbranch_scc1 L2_ev2
v_mov_b32 v252, s98
v_mov_b32 v253, s99
s_mov_b64 exec, 1
buffer_atomic_swap_x2 v[252:253], off, s[16:19], s49 sc0 sc1
s_mov_b64 exec, -1
s_branch L2_evr
L2_ev2:
s_mov_b64 exec, 1
ds_write_b64 v251, v[252:253]
s_mov_b64 exec, -1
s_branch L2_evr
L2_ev3:
ds_read_b64 v[252:253], v251
s_waitcnt lgkmcnt(0)
v_cmp_eq_u64 vcc, s[98:99], v[252:253]
s_nop 1
s_cmp_eq_u64 vcc, 0
s_cselect_b32 s31, s39, s35
L2_evr:
s_cmp_eq_u32 s3, 0
s_cbranch_scc1 L2_loop
s_branch L2_loop1
L2_tail_0:
s_waitcnt lgkmcnt(6)
v_mfma_f32_16x16x32_bf16 a[0:3], v[160:163], v[208:211], a[0:3]
s_mov_b32 m0, s30
v_mfma_f32_16x16x32_bf16 a[4:7], v[164:167], v[208:211], a[4:7]
buffer_load_dwordx4 v241, s[12:15], s28 offen offset:0 sc1 lds
v_add_u32 v253, s50, v248
v_mfma_f32_16x16x32_bf16 a[8:11], v[168:171], v[208:211], a[8:11]
buffer_load_dwordx4 v241, s[12:15], s28 offen offset:1024 sc1 lds
v_mfma_f32_16x16x32_bf16 a[12:15], v[172:175], v[208:211], a[12:15]
ds_read_b128 v[208:211], v240 offset:18432
s_waitcnt lgkmcnt(5)
buffer_load_dwordx4 v241, s[12:15], s28 offen offset:2048 sc1 lds
v_mfma_f32_16x16x32_bf16 a[16:19], v[160:163], v[212:215], a[16:19]
buffer_load_dwordx4 v241, s[12:15], s28 offen offset:3072 sc1 lds
v_mfma_f32_16x16x32_bf16 a[20:23], v[164:167], v[212:215], a[20:23]
s_add_u32 s28, s28, s101
s_add_u32 s30, s30, 0x4000
s_and_b32 s30, s30, 0x1ffff
v_mfma_f32_16x16x32_bf16 a[24:27], v[168:171], v[212:215], a[24:27]
s_mov_b32 m0, s30
v_mfma_f32_16x16x32_bf16 a[28:31], v[172:175], v[212:215], a[28:31]
ds_read_b128 v[212:215], v240 offset:18944
s_waitcnt lgkmcnt(4)
buffer_load_dwordx4 v241, s[12:15], s28 offen offset:0 sc1 lds
v_mfma_f32_16x16x32_bf16 a[32:35], v[160:163], v[216:219], a[32:35]
buffer_load_dwordx4 v241, s[12:15], s28 offen offset:1024 sc1 lds
v_mfma_f32_16x16x32_bf16 a[36:39], v[164:167], v[216:219], a[36:39]
buffer_load_dwordx4 v241, s[12:15], s28 offen offset:2048 sc1 lds
v_mfma_f32_16x16x32_bf16 a[40:43], v[168:171], v[216:219], a[40:43]
buffer_load_dwordx4 v241, s[12:15], s28 offen offset:3072 sc1 lds
v_mfma_f32_16x16x32_bf16 a[44:47], v[172:175], v[216:219], a[44:47]
ds_read_b128 v[216:219], v240 offset:22528
s_waitcnt lgkmcnt(3)
v_mfma_f32_16x16x32_bf16 a[48:51], v[160:163], v[220:223], a[48:51]
v_exp_f32 v232, v128
s_and_b32 s30, s30, 0x1c000
v_mfma_f32_16x16x32_bf16 a[52:55], v[164:167], v[220:223], a[52:55]
v_add_u32 v251, 0x8000, v240
v_and_b32 v251, 0x1ffff, v251
s_add_u32 s28, s30, 0x4000
v_mfma_f32_16x16x32_bf16 a[56:59], v[168:171], v[220:223], a[56:59]
v_add_u32 v252, 0x10000, v240
v_and_b32 v252, 0x1ffff, v252
s_and_b32 s28, s28, 0x1ffff
v_mfma_f32_16x16x32_bf16 a[60:63], v[172:175], v[220:223], a[60:63]
ds_read_b128 v[220:223], v240 offset:23040
s_waitcnt lgkmcnt(3)
s_add_u32 s30, s30, 0x8000
v_mfma_f32_16x16x32_bf16 v[144:147], v[208:211], v[0:3], v[192:195]
ds_write_b128 v253, v[160:163] offset:0
s_and_b32 s30, s30, 0x1ffff
s_mul_i32 s31, s34, 6144
v_mfma_f32_16x16x32_bf16 v[148:151], v[208:211], v[32:35], v[196:199]
ds_write_b128 v253, v[164:167] offset:1024
s_add_u32 s31, s31, s30
s_lshl_b32 s3, s34, 10
v_mfma_f32_16x16x32_bf16 v[152:155], v[208:211], v[64:67], v[200:203]
ds_write_b128 v253, v[168:171] offset:2048
s_add_u32 s28, s28, s3
s_add_u32 s3, s3, 24576
v_mfma_f32_16x16x32_bf16 v[156:159], v[208:211], v[96:99], v[204:207]
ds_read_b128 v[208:211], v240 offset:26624
s_waitcnt lgkmcnt(3)
ds_write_b128 v253, v[172:175] offset:3072
v_mfma_f32_16x16x32_bf16 v[144:147], v[212:215], v[4:7], v[144:147]
v_exp_f32 v233, v129
s_add_u32 s30, s30, s3
v_mfma_f32_16x16x32_bf16 v[148:151], v[212:215], v[36:39], v[148:151]
v_exp_f32 v234, v130
v_lshrrev_b32 v241, 4, v248
v_mfma_f32_16x16x32_bf16 v[152:155], v[212:215], v[68:71], v[152:155]
v_add_f32 v228, v224, v232
v_cvt_pk_bf16_f32 v176, v232, v233
v_and_b32 v241, 0x30, v241
v_mfma_f32_16x16x32_bf16 v[156:159], v[212:215], v[100:103], v[156:159]
ds_read_b128 v[212:215], v240 offset:27136
s_waitcnt lgkmcnt(3)
v_xor_b32 v241, v241, v248
v_mfma_f32_16x16x32_bf16 v[144:147], v[216:219], v[8:11], v[144:147]
v_exp_f32 v235, v131
v_mfma_f32_16x16x32_bf16 v[148:151], v[216:219], v[40:43], v[148:151]
v_add_f32 v228, v228, v233
v_add_f32 v228, v228, v234
v_mfma_f32_16x16x32_bf16 v[152:155], v[216:219], v[72:75], v[152:155]
v_add_f32 v228, v228, v235
v_cvt_pk_bf16_f32 v177, v234, v235
v_mfma_f32_16x16x32_bf16 v[156:159], v[216:219], v[104:107], v[156:159]
ds_read_b128 v[216:219], v240 offset:30720
s_waitcnt lgkmcnt(3)
v_mfma_f32_16x16x32_bf16 v[144:147], v[220:223], v[12:15], v[144:147]
v_exp_f32 v236, v132
v_mfma_f32_16x16x32_bf16 v[148:151], v[220:223], v[44:47], v[148:151]
v_exp_f32 v237, v133
v_mfma_f32_16x16x32_bf16 v[152:155], v[220:223], v[76:79], v[152:155]
v_exp_f32 v238, v134
v_mfma_f32_16x16x32_bf16 v[156:159], v[220:223], v[108:111], v[156:159]
ds_read_b128 v[220:223], v240 offset:31232
s_waitcnt lgkmcnt(3)
v_mfma_f32_16x16x32_bf16 v[144:147], v[208:211], v[16:19], v[144:147]
v_add_f32 v229, v225, v236
v_cvt_pk_bf16_f32 v180, v236, v237
v_and_b32 v243, 0x380, v248
v_mad_u32_u24 v241, v243, 3, v241
v_mfma_f32_16x16x32_bf16 v[148:151], v[208:211], v[48:51], v[148:151]
s_waitcnt vmcnt(8)
s_barrier
v_mfma_f32_16x16x32_bf16 v[152:155], v[208:211], v[80:83], v[152:155]
v_exp_f32 v239, v135
v_mfma_f32_16x16x32_bf16 v[156:159], v[208:211], v[112:115], v[156:159]
ds_read_b128 v[208:211], v251 offset:0
s_waitcnt lgkmcnt(3)
v_mfma_f32_16x16x32_bf16 v[144:147], v[212:215], v[20:23], v[144:147]
v_add_f32 v229, v229, v237
v_add_f32 v229, v229, v238
v_mfma_f32_16x16x32_bf16 v[148:151], v[212:215], v[52:55], v[148:151]
v_add_f32 v229, v229, v239
v_cvt_pk_bf16_f32 v181, v238, v239
v_mfma_f32_16x16x32_bf16 v[152:155], v[212:215], v[84:87], v[152:155]
v_exp_f32 v232, v136
v_mfma_f32_16x16x32_bf16 v[156:159], v[212:215], v[116:119], v[156:159]
ds_read_b128 v[212:215], v251 offset:512
s_waitcnt lgkmcnt(3)
v_mfma_f32_16x16x32_bf16 v[144:147], v[216:219], v[24:27], v[144:147]
v_exp_f32 v233, v137
v_mfma_f32_16x16x32_bf16 v[148:151], v[216:219], v[56:59], v[148:151]
v_exp_f32 v234, v138
v_mfma_f32_16x16x32_bf16 v[152:155], v[216:219], v[88:91], v[152:155]
v_add_f32 v230, v226, v232
v_cvt_pk_bf16_f32 v184, v232, v233
v_mfma_f32_16x16x32_bf16 v[156:159], v[216:219], v[120:123], v[156:159]
ds_read_b128 v[216:219], v251 offset:4096
s_waitcnt lgkmcnt(3)
v_mfma_f32_16x16x32_bf16 v[144:147], v[220:223], v[28:31], v[144:147]
v_exp_f32 v235, v139
v_mfma_f32_16x16x32_bf16 v[148:151], v[220:223], v[60:63], v[148:151]
v_add_f32 v230, v230, v233
v_add_f32 v230, v230, v234
v_mfma_f32_16x16x32_bf16 v[152:155], v[220:223], v[92:95], v[152:155]
v_add_f32 v230, v230, v235
v_cvt_pk_bf16_f32 v185, v234, v235
v_mfma_f32_16x16x32_bf16 v[156:159], v[220:223], v[124:127], v[156:159]
ds_read_b128 v[220:223], v251 offset:4608
s_waitcnt lgkmcnt(3)
v_exp_f32 v236, v140
v_exp_f32 v237, v141
v_exp_f32 v238, v142
v_add_f32 v231, v227, v236
v_cvt_pk_bf16_f32 v188, v236, v237
v_exp_f32 v239, v143
v_add_f32 v231, v231, v237
v_add_f32 v231, v231, v238
v_add_f32 v231, v231, v239
v_cvt_pk_bf16_f32 v189, v238, v239
v_max3_f32 v242, v228, v229, v230
v_max_f32 v242, v242, v231
v_cmp_lt_f32 vcc, s32, v242
s_cbranch_vccnz L2_rare_site4
L2_ret4:
v_mfma_f32_16x16x32_bf16 v[128:131], v[208:211], v[0:3], v[192:195]
s_add_u32 m0, s31, 0
v_mfma_f32_16x16x32_bf16 v[132:135], v[208:211], v[32:35], v[196:199]
v_exp_f32 v232, v144
v_mfma_f32_16x16x32_bf16 v[136:139], v[208:211], v[64:67], v[200:203]
v_exp_f32 v233, v145
v_mfma_f32_16x16x32_bf16 v[140:143], v[208:211], v[96:99], v[204:207]
ds_read_b128 v[208:211], v251 offset:8192
s_waitcnt lgkmcnt(3)
v_mfma_f32_16x16x32_bf16 v[128:131], v[212:215], v[4:7], v[128:131]
v_exp_f32 v234, v146
v_add_f32 v224, v228, v232
v_mfma_f32_16x16x32_bf16 v[132:135], v[212:215], v[36:39], v[132:135]
v_cvt_pk_bf16_f32 v178, v232, v233
v_exp_f32 v235, v147
v_mfma_f32_16x16x32_bf16 v[136:139], v[212:215], v[68:71], v[136:139]
v_add_f32 v224, v224, v233
v_add_f32 v224, v224, v234
v_add_f32 v224, v224, v235
v_mfma_f32_16x16x32_bf16 v[140:143], v[212:215], v[100:103], v[140:143]
ds_read_b128 v[212:215], v251 offset:8704
s_waitcnt lgkmcnt(3)
v_cvt_pk_bf16_f32 v179, v234, v235
v_mfma_f32_16x16x32_bf16 v[128:131], v[216:219], v[8:11], v[128:131]
v_exp_f32 v236, v148
v_mfma_f32_16x16x32_bf16 v[132:135], v[216:219], v[40:43], v[132:135]
v_exp_f32 v237, v149
v_mfma_f32_16x16x32_bf16 v[136:139], v[216:219], v[72:75], v[136:139]
v_exp_f32 v238, v150
v_add_f32 v225, v229, v236
v_mfma_f32_16x16x32_bf16 v[140:143], v[216:219], v[104:107], v[140:143]
ds_read_b128 v[216:219], v251 offset:12288
s_waitcnt lgkmcnt(3)
v_cvt_pk_bf16_f32 v182, v236, v237
v_mfma_f32_16x16x32_bf16 v[128:131], v[220:223], v[12:15], v[128:131]
v_exp_f32 v239, v151
v_add_f32 v225, v225, v237
v_mfma_f32_16x16x32_bf16 v[132:135], v[220:223], v[44:47], v[132:135]
v_add_f32 v225, v225, v238
v_add_f32 v225, v225, v239
v_cvt_pk_bf16_f32 v183, v238, v239
v_mfma_f32_16x16x32_bf16 v[136:139], v[220:223], v[76:79], v[136:139]
v_exp_f32 v232, v152
v_mfma_f32_16x16x32_bf16 v[140:143], v[220:223], v[108:111], v[140:143]
ds_read_b128 v[220:223], v251 offset:12800
s_waitcnt lgkmcnt(3)
v_mfma_f32_16x16x32_bf16 v[128:131], v[208:211], v[16:19], v[128:131]
v_exp_f32 v233, v153
v_mfma_f32_16x16x32_bf16 v[132:135], v[208:211], v[48:51], v[132:135]
v_exp_f32 v234, v154
v_add_f32 v226, v230, v232
v_mfma_f32_16x16x32_bf16 v[136:139], v[208:211], v[80:83], v[136:139]
v_cvt_pk_bf16_f32 v186, v232, v233
v_exp_f32 v235, v155
v_mfma_f32_16x16x32_bf16 v[140:143], v[208:211], v[112:115], v[140:143]
ds_read_b128 v[208:211], v251 offset:2048
s_waitcnt lgkmcnt(3)
v_add_f32 v226, v226, v233
v_mfma_f32_16x16x32_bf16 v[128:131], v[212:215], v[20:23], v[128:131]
v_add_f32 v226, v226, v234
v_add_f32 v226, v226, v235
v_cvt_pk_bf16_f32 v187, v234, v235
v_mfma_f32_16x16x32_bf16 v[132:135], v[212:215], v[52:55], v[132:135]
v_exp_f32 v236, v156
v_mfma_f32_16x16x32_bf16 v[136:139], v[212:215], v[84:87], v[136:139]
v_exp_f32 v237, v157
v_mfma_f32_16x16x32_bf16 v[140:143], v[212:215], v[116:119], v[140:143]
ds_read_b128 v[212:215], v251 offset:2560
s_waitcnt lgkmcnt(3)
v_mfma_f32_16x16x32_bf16 v[128:131], v[216:219], v[24:27], v[128:131]
v_exp_f32 v238, v158
v_add_f32 v227, v231, v236
v_mfma_f32_16x16x32_bf16 v[132:135], v[216:219], v[56:59], v[132:135]
v_cvt_pk_bf16_f32 v190, v236, v237
v_exp_f32 v239, v159
v_mfma_f32_16x16x32_bf16 v[136:139], v[216:219], v[88:91], v[136:139]
v_add_f32 v227, v227, v237
v_add_f32 v227, v227, v238
v_add_f32 v227, v227, v239
v_mfma_f32_16x16x32_bf16 v[140:143], v[216:219], v[120:123], v[140:143]
ds_read_b128 v[216:219], v251 offset:6144
s_waitcnt lgkmcnt(3)
v_cvt_pk_bf16_f32 v191, v238, v239
v_mfma_f32_16x16x32_bf16 v[128:131], v[220:223], v[28:31], v[128:131]
v_max3_f32 v242, v224, v225, v226
v_max_f32 v242, v242, v227
v_cmp_lt_f32 vcc, s32, v242
s_cbranch_vccnz L2_rare_site5
L2_ret5:
v_mfma_f32_16x16x32_bf16 v[132:135], v[220:223], v[60:63], v[132:135]
buffer_load_dwordx4 v241, s[8:11], s6 offen lds
s_add_u32 m0, s31, 2048
v_mfma_f32_16x16x32_bf16 v[136:139], v[220:223], v[92:95], v[136:139]
buffer_load_dwordx4 v241, s[8:11], s7 offen lds
s_add_u32 m0, s31, 4096
v_mfma_f32_16x16x32_bf16 v[140:143], v[220:223], v[124:127], v[140:143]
ds_read_b128 v[220:223], v251 offset:6656
s_waitcnt lgkmcnt(3)
v_mfma_f32_16x16x32_bf16 v[144:147], v[208:211], v[0:3], v[192:195]
ds_write_b128 v253, v[176:179] offset:4096
buffer_load_dwordx4 v241, s[8:11], s29 offen lds
s_add_u32 m0, s31, 1024
v_mfma_f32_16x16x32_bf16 v[148:151], v[208:211], v[32:35], v[196:199]
ds_write_b128 v253, v[180:183] offset:5120
v_exp_f32 v232, v128
v_mfma_f32_16x16x32_bf16 v[152:155], v[208:211], v[64:67], v[200:203]
ds_write_b128 v253, v[184:187] offset:6144
v_exp_f32 v233, v129
v_mfma_f32_16x16x32_bf16 v[156:159], v[208:211], v[96:99], v[204:207]
ds_read_b128 v[208:211], v251 offset:10240
s_waitcnt lgkmcnt(3)
ds_write_b128 v253, v[188:191] offset:7168
v_mfma_f32_16x16x32_bf16 v[144:147], v[212:215], v[4:7], v[144:147]
v_exp_f32 v234, v130
v_add_f32 v228, v224, v232
v_mfma_f32_16x16x32_bf16 v[148:151], v[212:215], v[36:39], v[148:151]
v_cvt_pk_bf16_f32 v160, v232, v233
v_exp_f32 v235, v131
v_mfma_f32_16x16x32_bf16 v[152:155], v[212:215], v[68:71], v[152:155]
v_add_f32 v228, v228, v233
v_add_f32 v228, v228, v234
v_add_f32 v228, v228, v235
v_mfma_f32_16x16x32_bf16 v[156:159], v[212:215], v[100:103], v[156:159]
ds_read_b128 v[212:215], v251 offset:10752
s_waitcnt lgkmcnt(3)
v_cvt_pk_bf16_f32 v161, v234, v235
v_mfma_f32_16x16x32_bf16 v[144:147], v[216:219], v[8:11], v[144:147]
v_exp_f32 v236, v132
v_xor_b32 v241, 0x1040, v241
v_mfma_f32_16x16x32_bf16 v[148:151], v[216:219], v[40:43], v[148:151]
v_exp_f32 v237, v133
v_mfma_f32_16x16x32_bf16 v[152:155], v[216:219], v[72:75], v[152:155]
v_exp_f32 v238, v134
v_add_f32 v229, v225, v236
v_mfma_f32_16x16x32_bf16 v[156:159], v[216:219], v[104:107], v[156:159]
ds_read_b128 v[216:219], v251 offset:14336
s_waitcnt lgkmcnt(3)
v_cvt_pk_bf16_f32 v164, v236, v237
v_mfma_f32_16x16x32_bf16 v[144:147], v[220:223], v[12:15], v[144:147]
v_exp_f32 v239, v135
v_add_f32 v229, v229, v237
v_mfma_f32_16x16x32_bf16 v[148:151], v[220:223], v[44:47], v[148:151]
v_add_f32 v229, v229, v238
v_add_f32 v229, v229, v239
v_cvt_pk_bf16_f32 v165, v238, v239
v_mfma_f32_16x16x32_bf16 v[152:155], v[220:223], v[76:79], v[152:155]
v_exp_f32 v232, v136
v_mfma_f32_16x16x32_bf16 v[156:159], v[220:223], v[108:111], v[156:159]
ds_read_b128 v[220:223], v251 offset:14848
s_waitcnt lgkmcnt(3)
v_mfma_f32_16x16x32_bf16 v[144:147], v[208:211], v[16:19], v[144:147]
v_exp_f32 v233, v137
v_mfma_f32_16x16x32_bf16 v[148:151], v[208:211], v[48:51], v[148:151]
s_waitcnt vmcnt(7)
s_barrier
v_mfma_f32_16x16x32_bf16 v[152:155], v[208:211], v[80:83], v[152:155]
v_exp_f32 v234, v138
v_add_f32 v230, v226, v232
v_mfma_f32_16x16x32_bf16 v[156:159], v[208:211], v[112:115], v[156:159]
ds_read_b128 v[208:211], v251 offset:16384
s_waitcnt lgkmcnt(3)
v_cvt_pk_bf16_f32 v168, v232, v233
v_mfma_f32_16x16x32_bf16 v[144:147], v[212:215], v[20:23], v[144:147]
v_exp_f32 v235, v139
v_add_f32 v230, v230, v233
v_mfma_f32_16x16x32_bf16 v[148:151], v[212:215], v[52:55], v[148:151]
v_add_f32 v230, v230, v234
v_add_f32 v230, v230, v235
v_cvt_pk_bf16_f32 v169, v234, v235
v_mfma_f32_16x16x32_bf16 v[152:155], v[212:215], v[84:87], v[152:155]
v_exp_f32 v236, v140
v_mfma_f32_16x16x32_bf16 v[156:159], v[212:215], v[116:119], v[156:159]
ds_read_b128 v[212:215], v251 offset:16896
s_waitcnt lgkmcnt(3)
v_mfma_f32_16x16x32_bf16 v[144:147], v[216:219], v[24:27], v[144:147]
v_exp_f32 v237, v141
v_mfma_f32_16x16x32_bf16 v[148:151], v[216:219], v[56:59], v[148:151]
v_exp_f32 v238, v142
v_add_f32 v231, v227, v236
v_mfma_f32_16x16x32_bf16 v[152:155], v[216:219], v[88:91], v[152:155]
v_cvt_pk_bf16_f32 v172, v236, v237
v_exp_f32 v239, v143
v_mfma_f32_16x16x32_bf16 v[156:159], v[216:219], v[120:123], v[156:159]
ds_read_b128 v[216:219], v251 offset:20480
s_waitcnt lgkmcnt(3)
v_add_f32 v231, v231, v237
v_mfma_f32_16x16x32_bf16 v[144:147], v[220:223], v[28:31], v[144:147]
v_add_f32 v231, v231, v238
v_add_f32 v231, v231, v239
v_cvt_pk_bf16_f32 v173, v238, v239
v_mfma_f32_16x16x32_bf16 v[148:151], v[220:223], v[60:63], v[148:151]
v_max3_f32 v242, v228, v229, v230
v_max_f32 v242, v242, v231
v_cmp_lt_f32 vcc, s32, v242
s_cbranch_vccnz L2_rare_site6
L2_ret6:
v_mfma_f32_16x16x32_bf16 v[152:155], v[220:223], v[92:95], v[152:155]
buffer_load_dwordx4 v241, s[8:11], s6 offen lds
s_add_u32 m0, s31, 3072
v_mfma_f32_16x16x32_bf16 v[156:159], v[220:223], v[124:127], v[156:159]
ds_read_b128 v[220:223], v251 offset:20992
s_waitcnt lgkmcnt(3)
v_mfma_f32_16x16x32_bf16 v[128:131], v[208:211], v[0:3], v[192:195]
buffer_load_dwordx4 v241, s[8:11], s7 offen lds
s_add_u32 m0, s31, 5120
v_mfma_f32_16x16x32_bf16 v[132:135], v[208:211], v[32:35], v[196:199]
v_exp_f32 v232, v144
v_mfma_f32_16x16x32_bf16 v[136:139], v[208:211], v[64:67], v[200:203]
v_exp_f32 v233, v145
v_mfma_f32_16x16x32_bf16 v[140:143], v[208:211], v[96:99], v[204:207]
ds_read_b128 v[208:211], v251 offset:24576
s_waitcnt lgkmcnt(3)
v_mfma_f32_16x16x32_bf16 v[128:131], v[212:215], v[4:7], v[128:131]
v_exp_f32 v234, v146
v_add_f32 v224, v228, v232
v_mfma_f32_16x16x32_bf16 v[132:135], v[212:215], v[36:39], v[132:135]
v_cvt_pk_bf16_f32 v162, v232, v233
v_exp_f32 v235, v147
v_mfma_f32_16x16x32_bf16 v[136:139], v[212:215], v[68:71], v[136:139]
v_add_f32 v224, v224, v233
v_add_f32 v224, v224, v234
v_add_f32 v224, v224, v235
v_mfma_f32_16x16x32_bf16 v[140:143], v[212:215], v[100:103], v[140:143]
ds_read_b128 v[212:215], v251 offset:25088
s_waitcnt lgkmcnt(3)
v_cvt_pk_bf16_f32 v163, v234, v235
v_mfma_f32_16x16x32_bf16 v[128:131], v[216:219], v[8:11], v[128:131]
v_exp_f32 v236, v148
v_mfma_f32_16x16x32_bf16 v[132:135], v[216:219], v[40:43], v[132:135]
v_exp_f32 v237, v149
v_mfma_f32_16x16x32_bf16 v[136:139], v[216:219], v[72:75], v[136:139]
v_exp_f32 v238, v150
v_add_f32 v225, v229, v236
v_mfma_f32_16x16x32_bf16 v[140:143], v[216:219], v[104:107], v[140:143]
ds_read_b128 v[216:219], v251 offset:28672
s_waitcnt lgkmcnt(3)
v_cvt_pk_bf16_f32 v166, v236, v237
v_mfma_f32_16x16x32_bf16 v[128:131], v[220:223], v[12:15], v[128:131]
v_exp_f32 v239, v151
v_add_f32 v225, v225, v237
v_mfma_f32_16x16x32_bf16 v[132:135], v[220:223], v[44:47], v[132:135]
v_add_f32 v225, v225, v238
v_add_f32 v225, v225, v239
v_cvt_pk_bf16_f32 v167, v238, v239
v_mfma_f32_16x16x32_bf16 v[136:139], v[220:223], v[76:79], v[136:139]
v_exp_f32 v232, v152
v_mfma_f32_16x16x32_bf16 v[140:143], v[220:223], v[108:111], v[140:143]
ds_read_b128 v[220:223], v251 offset:29184
s_waitcnt lgkmcnt(3)
v_mfma_f32_16x16x32_bf16 v[128:131], v[208:211], v[16:19], v[128:131]
v_exp_f32 v233, v153
v_mfma_f32_16x16x32_bf16 v[132:135], v[208:211], v[48:51], v[132:135]
v_exp_f32 v234, v154
v_add_f32 v226, v230, v232
v_mfma_f32_16x16x32_bf16 v[136:139], v[208:211], v[80:83], v[136:139]
v_cvt_pk_bf16_f32 v170, v232, v233
v_exp_f32 v235, v155
v_mfma_f32_16x16x32_bf16 v[140:143], v[208:211], v[112:115], v[140:143]
ds_read_b128 v[208:211], v251 offset:18432
s_waitcnt lgkmcnt(3)
v_add_f32 v226, v226, v233
v_mfma_f32_16x16x32_bf16 v[128:131], v[212:215], v[20:23], v[128:131]
v_add_f32 v226, v226, v234
v_add_f32 v226, v226, v235
v_cvt_pk_bf16_f32 v171, v234, v235
v_mfma_f32_16x16x32_bf16 v[132:135], v[212:215], v[52:55], v[132:135]
v_exp_f32 v236, v156
v_mfma_f32_16x16x32_bf16 v[136:139], v[212:215], v[84:87], v[136:139]
v_exp_f32 v237, v157
v_mfma_f32_16x16x32_bf16 v[140:143], v[212:215], v[116:119], v[140:143]
ds_read_b128 v[212:215], v251 offset:18944
s_waitcnt lgkmcnt(3)
v_mfma_f32_16x16x32_bf16 v[128:131], v[216:219], v[24:27], v[128:131]
v_exp_f32 v238, v158
v_add_f32 v227, v231, v236
v_mfma_f32_16x16x32_bf16 v[132:135], v[216:219], v[56:59], v[132:135]
v_cvt_pk_bf16_f32 v174, v236, v237
v_exp_f32 v239, v159
v_mfma_f32_16x16x32_bf16 v[136:139], v[216:219], v[88:91], v[136:139]
v_add_f32 v227, v227, v237
v_add_f32 v227, v227, v238
v_add_f32 v227, v227, v239
v_mfma_f32_16x16x32_bf16 v[140:143], v[216:219], v[120:123], v[140:143]
ds_read_b128 v[216:219], v251 offset:22528
s_waitcnt lgkmcnt(3)
v_cvt_pk_bf16_f32 v175, v238, v239
v_mfma_f32_16x16x32_bf16 v[128:131], v[220:223], v[28:31], v[128:131]
v_max3_f32 v242, v224, v225, v226
v_max_f32 v242, v242, v227
v_cmp_lt_f32 vcc, s32, v242
s_cbranch_vccnz L2_rare_site7
L2_ret7:
v_mfma_f32_16x16x32_bf16 v[132:135], v[220:223], v[60:63], v[132:135]
buffer_load_dwordx4 v241, s[8:11], s29 offen lds
v_mfma_f32_16x16x32_bf16 v[136:139], v[220:223], v[92:95], v[136:139]
v_mfma_f32_16x16x32_bf16 v[140:143], v[220:223], v[124:127], v[140:143]
ds_read_b128 v[220:223], v251 offset:23040
s_waitcnt lgkmcnt(3)
v_mfma_f32_16x16x32_bf16 v[144:147], v[208:211], v[0:3], v[192:195]
v_mfma_f32_16x16x32_bf16 v[148:151], v[208:211], v[32:35], v[196:199]
v_exp_f32 v232, v128
v_mfma_f32_16x16x32_bf16 v[152:155], v[208:211], v[64:67], v[200:203]
v_exp_f32 v233, v129
v_mfma_f32_16x16x32_bf16 v[156:159], v[208:211], v[96:99], v[204:207]
ds_read_b128 v[208:211], v251 offset:26624
s_waitcnt lgkmcnt(3)
v_mfma_f32_16x16x32_bf16 v[144:147], v[212:215], v[4:7], v[144:147]
v_exp_f32 v234, v130
v_add_f32 v228, v224, v232
v_mfma_f32_16x16x32_bf16 v[148:151], v[212:215], v[36:39], v[148:151]
v_cvt_pk_bf16_f32 v176, v232, v233
v_exp_f32 v235, v131
v_mfma_f32_16x16x32_bf16 v[152:155], v[212:215], v[68:71], v[152:155]
v_add_f32 v228, v228, v233
v_add_f32 v228, v228, v234
v_add_f32 v228, v228, v235
v_mfma_f32_16x16x32_bf16 v[156:159], v[212:215], v[100:103], v[156:159]
ds_read_b128 v[212:215], v251 offset:27136
s_waitcnt lgkmcnt(3)
v_cvt_pk_bf16_f32 v177, v234, v235
v_mfma_f32_16x16x32_bf16 v[144:147], v[216:219], v[8:11], v[144:147]
v_exp_f32 v236, v132
v_mfma_f32_16x16x32_bf16 v[148:151], v[216:219], v[40:43], v[148:151]
v_exp_f32 v237, v133
v_mfma_f32_16x16x32_bf16 v[152:155], v[216:219], v[72:75], v[152:155]
v_exp_f32 v238, v134
v_add_f32 v229, v225, v236
v_mfma_f32_16x16x32_bf16 v[156:159], v[216:219], v[104:107], v[156:159]
ds_read_b128 v[216:219], v251 offset:30720
s_waitcnt lgkmcnt(3)
v_cvt_pk_bf16_f32 v180, v236, v237
v_mfma_f32_16x16x32_bf16 v[144:147], v[220:223], v[12:15], v[144:147]
v_exp_f32 v239, v135
v_add_f32 v229, v229, v237
v_mfma_f32_16x16x32_bf16 v[148:151], v[220:223], v[44:47], v[148:151]
v_add_f32 v229, v229, v238
v_add_f32 v229, v229, v239
v_cvt_pk_bf16_f32 v181, v238, v239
v_mfma_f32_16x16x32_bf16 v[152:155], v[220:223], v[76:79], v[152:155]
v_exp_f32 v232, v136
v_mfma_f32_16x16x32_bf16 v[156:159], v[220:223], v[108:111], v[156:159]
ds_read_b128 v[220:223], v251 offset:31232
s_waitcnt lgkmcnt(3)
v_mfma_f32_16x16x32_bf16 v[144:147], v[208:211], v[16:19], v[144:147]
v_exp_f32 v233, v137
v_mfma_f32_16x16x32_bf16 v[148:151], v[208:211], v[48:51], v[148:151]
s_waitcnt vmcnt(6)
s_barrier
v_mfma_f32_16x16x32_bf16 v[152:155], v[208:211], v[80:83], v[152:155]
v_exp_f32 v234, v138
v_add_f32 v230, v226, v232
v_mfma_f32_16x16x32_bf16 v[156:159], v[208:211], v[112:115], v[156:159]
ds_read_b128 v[208:211], v252 offset:0
s_waitcnt lgkmcnt(3)
v_cvt_pk_bf16_f32 v184, v232, v233
v_mfma_f32_16x16x32_bf16 v[144:147], v[212:215], v[20:23], v[144:147]
v_exp_f32 v235, v139
v_add_f32 v230, v230, v233
v_mfma_f32_16x16x32_bf16 v[148:151], v[212:215], v[52:55], v[148:151]
v_add_f32 v230, v230, v234
v_add_f32 v230, v230, v235
v_cvt_pk_bf16_f32 v185, v234, v235
v_mfma_f32_16x16x32_bf16 v[152:155], v[212:215], v[84:87], v[152:155]
v_exp_f32 v236, v140
v_mfma_f32_16x16x32_bf16 v[156:159], v[212:215], v[116:119], v[156:159]
ds_read_b128 v[212:215], v252 offset:512
s_waitcnt lgkmcnt(3)
v_mfma_f32_16x16x32_bf16 v[144:147], v[216:219], v[24:27], v[144:147]
v_exp_f32 v237, v141
v_mfma_f32_16x16x32_bf16 v[148:151], v[216:219], v[56:59], v[148:151]
v_exp_f32 v238, v142
v_add_f32 v231, v227, v236
v_mfma_f32_16x16x32_bf16 v[152:155], v[216:219], v[88:91], v[152:155]
v_cvt_pk_bf16_f32 v188, v236, v237
v_exp_f32 v239, v143
v_mfma_f32_16x16x32_bf16 v[156:159], v[216:219], v[120:123], v[156:159]
ds_read_b128 v[216:219], v252 offset:4096
s_waitcnt lgkmcnt(3)
v_add_f32 v231, v231, v237
v_mfma_f32_16x16x32_bf16 v[144:147], v[220:223], v[28:31], v[144:147]
v_add_f32 v231, v231, v238
v_add_f32 v231, v231, v239
v_cvt_pk_bf16_f32 v189, v238, v239
v_mfma_f32_16x16x32_bf16 v[148:151], v[220:223], v[60:63], v[148:151]
v_max3_f32 v242, v228, v229, v230
v_max_f32 v242, v242, v231
v_cmp_lt_f32 vcc, s32, v242
s_cbranch_vccnz L2_rare_site8
L2_ret8:
v_mfma_f32_16x16x32_bf16 v[152:155], v[220:223], v[92:95], v[152:155]
v_mfma_f32_16x16x32_bf16 v[156:159], v[220:223], v[124:127], v[156:159]
ds_read_b128 v[220:223], v252 offset:4608
s_waitcnt lgkmcnt(3)
v_mfma_f32_16x16x32_bf16 v[128:131], v[208:211], v[0:3], v[192:195]
v_mfma_f32_16x16x32_bf16 v[132:135], v[208:211], v[32:35], v[196:199]
v_exp_f32 v232, v144
v_mfma_f32_16x16x32_bf16 v[136:139], v[208:211], v[64:67], v[200:203]
v_exp_f32 v233, v145
v_mfma_f32_16x16x32_bf16 v[140:143], v[208:211], v[96:99], v[204:207]
ds_read_b128 v[208:211], v252 offset:8192
s_waitcnt lgkmcnt(3)
v_mfma_f32_16x16x32_bf16 v[128:131], v[212:215], v[4:7], v[128:131]
v_exp_f32 v234, v146
v_add_f32 v224, v228, v232
v_mfma_f32_16x16x32_bf16 v[132:135], v[212:215], v[36:39], v[132:135]
v_cvt_pk_bf16_f32 v178, v232, v233
v_exp_f32 v235, v147
v_mfma_f32_16x16x32_bf16 v[136:139], v[212:215], v[68:71], v[136:139]
v_add_f32 v224, v224, v233
v_add_f32 v224, v224, v234
v_add_f32 v224, v224, v235
v_mfma_f32_16x16x32_bf16 v[140:143], v[212:215], v[100:103], v[140:143]
ds_read_b128 v[212:215], v252 offset:8704
s_waitcnt lgkmcnt(3)
v_cvt_pk_bf16_f32 v179, v234, v235
v_mfma_f32_16x16x32_bf16 v[128:131], v[216:219], v[8:11], v[128:131]
v_exp_f32 v236, v148
v_lshlrev_b32 v241, 3, v248
v_mfma_f32_16x16x32_bf16 v[132:135], v[216:219], v[40:43], v[132:135]
v_exp_f32 v237, v149
s_mov_b32 s3, 0x7c28000
v_mfma_f32_16x16x32_bf16 v[136:139], v[216:219], v[72:75], v[136:139]
v_exp_f32 v238, v150
v_add_f32 v225, v229, v236
v_mfma_f32_16x16x32_bf16 v[140:143], v[216:219], v[104:107], v[140:143]
ds_read_b128 v[216:219], v252 offset:12288
s_waitcnt lgkmcnt(3)
v_cvt_pk_bf16_f32 v182, v236, v237
v_mfma_f32_16x16x32_bf16 v[128:131], v[220:223], v[12:15], v[128:131]
v_exp_f32 v239, v151
v_add_f32 v225, v225, v237
v_mfma_f32_16x16x32_bf16 v[132:135], v[220:223], v[44:47], v[132:135]
v_add_f32 v225, v225, v238
v_add_f32 v225, v225, v239
v_cvt_pk_bf16_f32 v183, v238, v239
v_mfma_f32_16x16x32_bf16 v[136:139], v[220:223], v[76:79], v[136:139]
v_exp_f32 v232, v152
buffer_load_dwordx2 v[240:241], v241, s[16:19], s3 offen sc1
v_mfma_f32_16x16x32_bf16 v[140:143], v[220:223], v[108:111], v[140:143]
ds_read_b128 v[220:223], v252 offset:12800
s_waitcnt lgkmcnt(3)
v_mfma_f32_16x16x32_bf16 v[128:131], v[208:211], v[16:19], v[128:131]
v_exp_f32 v233, v153
v_mfma_f32_16x16x32_bf16 v[132:135], v[208:211], v[48:51], v[132:135]
v_exp_f32 v234, v154
v_add_f32 v226, v230, v232
v_mfma_f32_16x16x32_bf16 v[136:139], v[208:211], v[80:83], v[136:139]
v_cvt_pk_bf16_f32 v186, v232, v233
v_exp_f32 v235, v155
v_mfma_f32_16x16x32_bf16 v[140:143], v[208:211], v[112:115], v[140:143]
ds_read_b128 v[208:211], v252 offset:2048
s_waitcnt lgkmcnt(3)
v_add_f32 v226, v226, v233
v_mfma_f32_16x16x32_bf16 v[128:131], v[212:215], v[20:23], v[128:131]
v_add_f32 v226, v226, v234
v_add_f32 v226, v226, v235
v_cvt_pk_bf16_f32 v187, v234, v235
v_mfma_f32_16x16x32_bf16 v[132:135], v[212:215], v[52:55], v[132:135]
v_exp_f32 v236, v156
v_mfma_f32_16x16x32_bf16 v[136:139], v[212:215], v[84:87], v[136:139]
v_exp_f32 v237, v157
v_mfma_f32_16x16x32_bf16 v[140:143], v[212:215], v[116:119], v[140:143]
ds_read_b128 v[212:215], v252 offset:2560
s_waitcnt lgkmcnt(3)
v_mfma_f32_16x16x32_bf16 v[128:131], v[216:219], v[24:27], v[128:131]
v_exp_f32 v238, v158
v_add_f32 v227, v231, v236
v_mfma_f32_16x16x32_bf16 v[132:135], v[216:219], v[56:59], v[132:135]
v_cvt_pk_bf16_f32 v190, v236, v237
v_exp_f32 v239, v159
v_mfma_f32_16x16x32_bf16 v[136:139], v[216:219], v[88:91], v[136:139]
v_add_f32 v227, v227, v237
v_add_f32 v227, v227, v238
v_add_f32 v227, v227, v239
v_mfma_f32_16x16x32_bf16 v[140:143], v[216:219], v[120:123], v[140:143]
ds_read_b128 v[216:219], v252 offset:6144
s_waitcnt lgkmcnt(3)
v_cvt_pk_bf16_f32 v191, v238, v239
v_mfma_f32_16x16x32_bf16 v[128:131], v[220:223], v[28:31], v[128:131]
v_max3_f32 v242, v224, v225, v226
v_max_f32 v242, v242, v227
v_cmp_lt_f32 vcc, s32, v242
s_cbranch_vccnz L2_rare_site9
L2_ret9:
v_mfma_f32_16x16x32_bf16 v[132:135], v[220:223], v[60:63], v[132:135]
v_mfma_f32_16x16x32_bf16 v[136:139], v[220:223], v[92:95], v[136:139]
v_mfma_f32_16x16x32_bf16 v[140:143], v[220:223], v[124:127], v[140:143]
ds_read_b128 v[220:223], v252 offset:6656
s_waitcnt lgkmcnt(3)
v_mfma_f32_16x16x32_bf16 v[144:147], v[208:211], v[0:3], v[192:195]
v_mfma_f32_16x16x32_bf16 v[148:151], v[208:211], v[32:35], v[196:199]
v_mfma_f32_16x16x32_bf16 v[152:155], v[208:211], v[64:67], v[200:203]
v_mfma_f32_16x16x32_bf16 v[156:159], v[208:211], v[96:99], v[204:207]
ds_read_b128 v[208:211], v252 offset:10240
s_waitcnt lgkmcnt(3)
v_mfma_f32_16x16x32_bf16 v[144:147], v[212:215], v[4:7], v[144:147]
v_exp_f32 v232, v128
v_mfma_f32_16x16x32_bf16 v[148:151], v[212:215], v[36:39], v[148:151]
v_exp_f32 v233, v129
v_mfma_f32_16x16x32_bf16 v[152:155], v[212:215], v[68:71], v[152:155]
v_exp_f32 v234, v130
v_add_f32 v228, v224, v232
v_mfma_f32_16x16x32_bf16 v[156:159], v[212:215], v[100:103], v[156:159]
ds_read_b128 v[212:215], v252 offset:10752
s_waitcnt lgkmcnt(3)
v_cvt_pk_bf16_f32 v0, v232, v233
v_mfma_f32_16x16x32_bf16 v[144:147], v[216:219], v[8:11], v[144:147]
v_exp_f32 v235, v131
v_add_f32 v228, v228, v233
v_mfma_f32_16x16x32_bf16 v[148:151], v[216:219], v[40:43], v[148:151]
ds_read_b128 v[4:7], v253 offset:0
v_add_f32 v228, v228, v234
v_add_f32 v228, v228, v235
v_mfma_f32_16x16x32_bf16 v[152:155], v[216:219], v[72:75], v[152:155]
ds_read_b128 v[36:39], v253 offset:1024
v_cvt_pk_bf16_f32 v1, v234, v235
v_mfma_f32_16x16x32_bf16 v[156:159], v[216:219], v[104:107], v[156:159]
ds_read_b128 v[216:219], v252 offset:14336
s_waitcnt lgkmcnt(3)
v_mfma_f32_16x16x32_bf16 v[144:147], v[220:223], v[12:15], v[144:147]
v_exp_f32 v236, v132
v_mfma_f32_16x16x32_bf16 v[148:151], v[220:223], v[44:47], v[148:151]
ds_read_b128 v[68:71], v253 offset:2048
ds_read_b128 v[8:11], v253 offset:4096
v_mfma_f32_16x16x32_bf16 v[152:155], v[220:223], v[76:79], v[152:155]
v_add_u32 v12, 0x8000, v249
v_and_b32 v12, 0x1ffff, v12
ds_read_b128 v[100:103], v253 offset:3072
ds_read_b128 v[40:43], v253 offset:5120
v_mfma_f32_16x16x32_bf16 v[156:159], v[220:223], v[108:111], v[156:159]
ds_read_b128 v[220:223], v252 offset:14848
s_waitcnt lgkmcnt(3)
v_add_u32 v14, 0x10000, v249
v_and_b32 v14, 0x1ffff, v14
v_mfma_f32_16x16x32_bf16 v[144:147], v[208:211], v[16:19], v[144:147]
v_xor_b32 v13, 32, v12
v_xor_b32 v15, 32, v14
v_mfma_f32_16x16x32_bf16 v[148:151], v[208:211], v[48:51], v[148:151]
ds_read_b128 v[72:75], v253 offset:6144
v_exp_f32 v237, v133
v_mfma_f32_16x16x32_bf16 v[152:155], v[208:211], v[80:83], v[152:155]
ds_read_b128 v[104:107], v253 offset:7168
v_exp_f32 v238, v134
v_mfma_f32_16x16x32_bf16 v[156:159], v[208:211], v[112:115], v[156:159]
ds_read_b64_tr_b16 v[208:209], v249 offset:16384
s_waitcnt lgkmcnt(3)
v_add_f32 v229, v225, v236
v_mfma_f32_16x16x32_bf16 v[144:147], v[212:215], v[20:23], v[144:147]
ds_read_b64_tr_b16 v[210:211], v249 offset:18432
v_cvt_pk_bf16_f32 v32, v236, v237
v_mfma_f32_16x16x32_bf16 v[148:151], v[212:215], v[52:55], v[148:151]
v_exp_f32 v239, v135
v_add_f32 v229, v229, v237
v_mfma_f32_16x16x32_bf16 v[152:155], v[212:215], v[84:87], v[152:155]
v_add_f32 v229, v229, v238
v_add_f32 v229, v229, v239
v_cvt_pk_bf16_f32 v33, v238, v239
v_mfma_f32_16x16x32_bf16 v[156:159], v[212:215], v[116:119], v[156:159]
ds_read_b64_tr_b16 v[212:213], v12 offset:0
s_waitcnt lgkmcnt(4)
v_mfma_f32_16x16x32_bf16 v[144:147], v[216:219], v[24:27], v[144:147]
ds_read_b64_tr_b16 v[214:215], v12 offset:2048
v_exp_f32 v232, v136
v_mfma_f32_16x16x32_bf16 v[148:151], v[216:219], v[56:59], v[148:151]
v_exp_f32 v233, v137
v_mfma_f32_16x16x32_bf16 v[152:155], v[216:219], v[88:91], v[152:155]
v_exp_f32 v234, v138
v_add_f32 v230, v226, v232
v_mfma_f32_16x16x32_bf16 v[156:159], v[216:219], v[120:123], v[156:159]
ds_read_b64_tr_b16 v[216:217], v12 offset:16384
s_waitcnt lgkmcnt(5)
v_cvt_pk_bf16_f32 v64, v232, v233
v_mfma_f32_16x16x32_bf16 v[144:147], v[220:223], v[28:31], v[144:147]
ds_read_b64_tr_b16 v[218:219], v12 offset:18432
v_exp_f32 v235, v139
v_mfma_f32_16x16x32_bf16 v[148:151], v[220:223], v[60:63], v[148:151]
v_add_f32 v230, v230, v233
v_add_f32 v230, v230, v234
v_add_f32 v230, v230, v235
v_mfma_f32_16x16x32_bf16 v[152:155], v[220:223], v[92:95], v[152:155]
v_cvt_pk_bf16_f32 v65, v234, v235
v_exp_f32 v236, v140
v_mfma_f32_16x16x32_bf16 v[156:159], v[220:223], v[124:127], v[156:159]
ds_read_b64_tr_b16 v[220:221], v250 offset:16384
s_waitcnt lgkmcnt(5)
v_exp_f32 v237, v141
v_exp_f32 v238, v142
v_add_f32 v231, v227, v236
v_cvt_pk_bf16_f32 v96, v236, v237
v_exp_f32 v239, v143
v_add_f32 v231, v231, v237
v_add_f32 v231, v231, v238
v_add_f32 v231, v231, v239
v_cvt_pk_bf16_f32 v97, v238, v239
v_max3_f32 v242, v228, v229, v230
v_max_f32 v242, v242, v231
v_cmp_lt_f32 vcc, s32, v242
s_cbranch_vccnz L2_rare_site10
L2_ret10:
v_mfma_f32_16x16x32_bf16 a[0:3], v[8:11], v[208:211], a[0:3]
ds_read_b64_tr_b16 v[222:223], v250 offset:18432
s_waitcnt vmcnt(0)
v_cmp_ne_u64_e64 s[38:39], s[98:99], v[240:241]
v_mfma_f32_16x16x32_bf16 a[4:7], v[40:43], v[208:211], a[4:7]
v_exp_f32 v232, v144
v_mfma_f32_16x16x32_bf16 a[8:11], v[72:75], v[208:211], a[8:11]
v_exp_f32 v233, v145
v_mfma_f32_16x16x32_bf16 a[12:15], v[104:107], v[208:211], a[12:15]
ds_read_b64_tr_b16 v[208:209], v13 offset:0
s_waitcnt lgkmcnt(5)
v_mfma_f32_16x16x32_bf16 a[0:3], v[160:163], v[212:215], a[0:3]
ds_read_b64_tr_b16 v[210:211], v13 offset:2048
s_and_b64 s[38:39], s[38:39], s[96:97]
s_cbranch_scc1 LF_hl_0
LF_hlret_0:
v_mfma_f32_16x16x32_bf16 a[4:7], v[164:167], v[212:215], a[4:7]
v_exp_f32 v234, v146
v_lshrrev_b32 v241, 4, v248
v_mfma_f32_16x16x32_bf16 a[8:11], v[168:171], v[212:215], a[8:11]
v_add_f32 v224, v228, v232
v_cvt_pk_bf16_f32 v2, v232, v233
v_and_b32 v241, 0x30, v241
v_mfma_f32_16x16x32_bf16 a[12:15], v[172:175], v[212:215], a[12:15]
ds_read_b64_tr_b16 v[212:213], v13 offset:16384
s_waitcnt lgkmcnt(5)
v_xor_b32 v241, v241, v248
v_mfma_f32_16x16x32_bf16 a[0:3], v[176:179], v[216:219], a[0:3]
ds_read_b64_tr_b16 v[214:215], v13 offset:18432
v_and_b32 v243, 0x380, v248
v_mad_u32_u24 v241, v243, 3, v241
v_mfma_f32_16x16x32_bf16 a[4:7], v[180:183], v[216:219], a[4:7]
v_exp_f32 v235, v147
v_add_u32 v241, 0x7000000, v241
v_mfma_f32_16x16x32_bf16 a[8:11], v[184:187], v[216:219], a[8:11]
v_add_f32 v224, v224, v233
v_add_f32 v224, v224, v234
v_and_b32 v110, 0x70, v248
v_mfma_f32_16x16x32_bf16 a[12:15], v[188:191], v[216:219], a[12:15]
ds_read_b64_tr_b16 v[216:217], v249 offset:16896
s_waitcnt lgkmcnt(5)
v_lshlrev_b32 v110, 3, v110
v_mfma_f32_16x16x32_bf16 a[16:19], v[8:11], v[220:223], a[16:19]
ds_read_b64_tr_b16 v[218:219], v249 offset:18944
v_add_f32 v224, v224, v235
v_add_u32 v110, 0x7c32000, v110
v_mfma_f32_16x16x32_bf16 a[20:23], v[40:43], v[220:223], a[20:23]
v_cvt_pk_bf16_f32 v3, v234, v235
buffer_load_dwordx2 v[108:109], v110, s[16:19], 0 offen sc1
v_mfma_f32_16x16x32_bf16 a[24:27], v[72:75], v[220:223], a[24:27]
v_exp_f32 v236, v148
v_mfma_f32_16x16x32_bf16 a[28:31], v[104:107], v[220:223], a[28:31]
ds_read_b64_tr_b16 v[220:221], v12 offset:512
s_waitcnt lgkmcnt(5)
v_mfma_f32_16x16x32_bf16 a[16:19], v[160:163], v[208:211], a[16:19]
ds_read_b64_tr_b16 v[222:223], v12 offset:2560
s_add_u32 m0, s28, 0
v_mfma_f32_16x16x32_bf16 a[20:23], v[164:167], v[208:211], a[20:23]
v_exp_f32 v237, v149
v_mfma_f32_16x16x32_bf16 a[24:27], v[168:171], v[208:211], a[24:27]
v_exp_f32 v238, v150
v_mfma_f32_16x16x32_bf16 a[28:31], v[172:175], v[208:211], a[28:31]
ds_read_b64_tr_b16 v[208:209], v12 offset:16896
s_waitcnt lgkmcnt(5)
v_mfma_f32_16x16x32_bf16 a[16:19], v[176:179], v[212:215], a[16:19]
ds_read_b64_tr_b16 v[210:211], v12 offset:18944
v_add_f32 v225, v229, v236
v_mfma_f32_16x16x32_bf16 a[20:23], v[180:183], v[212:215], a[20:23]
v_cvt_pk_bf16_f32 v34, v236, v237
buffer_load_dwordx4 v241, s[16:19], s6 offen sc1 lds
s_add_u32 m0, s28, 8192
v_mfma_f32_16x16x32_bf16 a[24:27], v[184:187], v[212:215], a[24:27]
v_exp_f32 v239, v151
v_mfma_f32_16x16x32_bf16 a[28:31], v[188:191], v[212:215], a[28:31]
ds_read_b64_tr_b16 v[212:213], v250 offset:16896
s_waitcnt lgkmcnt(5)
v_mfma_f32_16x16x32_bf16 a[32:35], v[8:11], v[216:219], a[32:35]
ds_read_b64_tr_b16 v[214:215], v250 offset:18944
v_add_f32 v225, v225, v237
v_mfma_f32_16x16x32_bf16 a[36:39], v[40:43], v[216:219], a[36:39]
v_add_f32 v225, v225, v238
v_add_f32 v225, v225, v239
v_mfma_f32_16x16x32_bf16 a[40:43], v[72:75], v[216:219], a[40:43]
v_cvt_pk_bf16_f32 v35, v238, v239
buffer_load_dwordx4 v241, s[16:19], s7 offen sc1 lds
s_add_u32 m0, s30, 0
v_mfma_f32_16x16x32_bf16 a[44:47], v[104:107], v[216:219], a[44:47]
ds_read_b64_tr_b16 v[216:217], v13 offset:512
s_waitcnt lgkmcnt(5)
v_mfma_f32_16x16x32_bf16 a[32:35], v[160:163], v[220:223], a[32:35]
ds_read_b64_tr_b16 v[218:219], v13 offset:2560
buffer_load_dwordx4 v241, s[16:19], s29 offen sc1 lds
s_add_u32 m0, s28, 4096
v_mfma_f32_16x16x32_bf16 a[36:39], v[164:167], v[220:223], a[36:39]
v_exp_f32 v232, v152
v_xor_b32 v241, 0x1040, v241
v_mfma_f32_16x16x32_bf16 a[40:43], v[168:171], v[220:223], a[40:43]
v_exp_f32 v233, v153
v_mfma_f32_16x16x32_bf16 a[44:47], v[172:175], v[220:223], a[44:47]
ds_read_b64_tr_b16 v[220:221], v13 offset:16896
s_waitcnt lgkmcnt(5)
v_mfma_f32_16x16x32_bf16 a[32:35], v[176:179], v[208:211], a[32:35]
ds_read_b64_tr_b16 v[222:223], v13 offset:18944
buffer_load_dwordx4 v241, s[16:19], s6 offen sc1 lds
s_add_u32 m0, s28, 12288
v_mfma_f32_16x16x32_bf16 a[36:39], v[180:183], v[208:211], a[36:39]
v_exp_f32 v234, v154
v_mfma_f32_16x16x32_bf16 a[40:43], v[184:187], v[208:211], a[40:43]
v_add_f32 v226, v230, v232
v_cvt_pk_bf16_f32 v66, v232, v233
v_mfma_f32_16x16x32_bf16 a[44:47], v[188:191], v[208:211], a[44:47]
ds_read_b64_tr_b16 v[208:209], v14 offset:0
s_waitcnt lgkmcnt(5)
v_mfma_f32_16x16x32_bf16 a[48:51], v[8:11], v[212:215], a[48:51]
ds_read_b64_tr_b16 v[210:211], v14 offset:2048
buffer_load_dwordx4 v241, s[16:19], s7 offen sc1 lds
s_add_u32 m0, s30, 4096
v_mfma_f32_16x16x32_bf16 a[52:55], v[40:43], v[212:215], a[52:55]
v_exp_f32 v235, v155
v_mfma_f32_16x16x32_bf16 a[56:59], v[72:75], v[212:215], a[56:59]
v_add_f32 v226, v226, v233
v_add_f32 v226, v226, v234
v_mfma_f32_16x16x32_bf16 a[60:63], v[104:107], v[212:215], a[60:63]
ds_read_b64_tr_b16 v[212:213], v15 offset:0
s_waitcnt lgkmcnt(5)
v_mfma_f32_16x16x32_bf16 a[48:51], v[160:163], v[216:219], a[48:51]
ds_read_b64_tr_b16 v[214:215], v15 offset:2048
v_add_f32 v226, v226, v235
v_mfma_f32_16x16x32_bf16 a[52:55], v[164:167], v[216:219], a[52:55]
v_cvt_pk_bf16_f32 v67, v234, v235
buffer_load_dwordx4 v241, s[16:19], s29 offen sc1 lds
v_mfma_f32_16x16x32_bf16 a[56:59], v[168:171], v[216:219], a[56:59]
v_exp_f32 v236, v156
v_mfma_f32_16x16x32_bf16 a[60:63], v[172:175], v[216:219], a[60:63]
ds_read_b64_tr_b16 v[216:217], v14 offset:512
s_waitcnt lgkmcnt(5)
v_mfma_f32_16x16x32_bf16 a[48:51], v[176:179], v[220:223], a[48:51]
ds_read_b64_tr_b16 v[218:219], v14 offset:2560
v_mfma_f32_16x16x32_bf16 a[52:55], v[180:183], v[220:223], a[52:55]
v_exp_f32 v237, v157
v_mfma_f32_16x16x32_bf16 a[56:59], v[184:187], v[220:223], a[56:59]
v_exp_f32 v238, v158
v_add_f32 v227, v231, v236
v_cvt_pk_bf16_f32 v98, v236, v237
v_exp_f32 v239, v159
v_add_f32 v227, v227, v237
v_add_f32 v227, v227, v238
v_add_f32 v227, v227, v239
v_cvt_pk_bf16_f32 v99, v238, v239
v_max3_f32 v242, v224, v225, v226
v_max_f32 v242, v242, v227
v_cmp_lt_f32 vcc, s32, v242
s_cbranch_vccnz L2_rare_site11
L2_ret11:
v_mfma_f32_16x16x32_bf16 a[60:63], v[188:191], v[220:223], a[60:63]
ds_read_b64_tr_b16 v[220:221], v15 offset:512
s_waitcnt lgkmcnt(5)
v_mfma_f32_16x16x32_bf16 a[0:3], v[0:3], v[208:211], a[0:3]
ds_read_b64_tr_b16 v[222:223], v15 offset:2560
v_bfe_u32 v242, v248, 8, 1
v_mul_u32_u24 v242, 48, v242
v_mfma_f32_16x16x32_bf16 a[4:7], v[32:35], v[208:211], a[4:7]
v_lshl_add_u32 v242, s37, 3, v242
v_and_b32 v243, 0xf0, v248
v_lshl_add_u32 v242, v243, 3, v242
v_mfma_f32_16x16x32_bf16 a[8:11], v[64:67], v[208:211], a[8:11]
v_mov_b32 v232, v224
v_mov_b32 v234, v225
v_mov_b32 v236, v226
v_mfma_f32_16x16x32_bf16 a[12:15], v[96:99], v[208:211], a[12:15]
ds_read_b64_tr_b16 v[208:209], v249 offset:4096
s_waitcnt lgkmcnt(5)
v_mov_b32 v238, v227
v_mfma_f32_16x16x32_bf16 a[16:19], v[0:3], v[212:215], a[16:19]
ds_read_b64_tr_b16 v[210:211], v249 offset:6144
v_permlane32_swap_b32 v224, v232
v_permlane32_swap_b32 v225, v234
v_mfma_f32_16x16x32_bf16 a[20:23], v[32:35], v[212:215], a[20:23]
v_permlane32_swap_b32 v226, v236
v_permlane32_swap_b32 v227, v238
v_add_f32 v224, v224, v232
v_mfma_f32_16x16x32_bf16 a[24:27], v[64:67], v[212:215], a[24:27]
v_add_f32 v225, v225, v234
v_add_f32 v226, v226, v236
v_add_f32 v227, v227, v238
v_mfma_f32_16x16x32_bf16 a[28:31], v[96:99], v[212:215], a[28:31]
ds_read_b64_tr_b16 v[212:213], v249 offset:20480
s_waitcnt lgkmcnt(5)
v_mov_b32 v232, v224
v_mfma_f32_16x16x32_bf16 a[32:35], v[0:3], v[216:219], a[32:35]
ds_read_b64_tr_b16 v[214:215], v249 offset:22528
v_mov_b32 v234, v225
v_mov_b32 v236, v226
v_mfma_f32_16x16x32_bf16 a[36:39], v[32:35], v[216:219], a[36:39]
v_mov_b32 v238, v227
v_permlane16_swap_b32 v224, v232
v_permlane16_swap_b32 v225, v234
v_mfma_f32_16x16x32_bf16 a[40:43], v[64:67], v[216:219], a[40:43]
v_permlane16_swap_b32 v226, v236
v_permlane16_swap_b32 v227, v238
v_add_f32 v233, v224, v232
v_mfma_f32_16x16x32_bf16 a[44:47], v[96:99], v[216:219], a[44:47]
ds_read_b64_tr_b16 v[216:217], v12 offset:4096
s_waitcnt lgkmcnt(5)
v_add_f32 v235, v225, v234
v_mfma_f32_16x16x32_bf16 a[48:51], v[0:3], v[220:223], a[48:51]
ds_read_b64_tr_b16 v[218:219], v12 offset:6144
v_add_f32 v237, v226, v236
v_add_f32 v239, v227, v238
v_mfma_f32_16x16x32_bf16 a[52:55], v[32:35], v[220:223], a[52:55]
v_mov_b32 v232, v244
v_mov_b32 v234, v245
v_mov_b32 v236, v246
v_mfma_f32_16x16x32_bf16 a[56:59], v[64:67], v[220:223], a[56:59]
v_mov_b32 v238, v247
v_mfma_f32_16x16x32_bf16 a[60:63], v[96:99], v[220:223], a[60:63]
ds_read_b64_tr_b16 v[220:221], v12 offset:20480
s_waitcnt lgkmcnt(5)
v_mfma_f32_16x16x32_bf16 a[64:67], v[4:7], v[208:211], a[64:67]
ds_read_b64_tr_b16 v[222:223], v12 offset:22528
v_mfma_f32_16x16x32_bf16 a[68:71], v[36:39], v[208:211], a[68:71]
s_mov_b32 exec_hi, 0
buffer_store_dwordx2 v[232:233], v242, s[24:27], s48 offen sc1
s_lshr_b32 s3, s41, 2
buffer_store_dwordx2 v[234:235], v242, s[24:27], s3 offen sc1
s_lshr_b32 s3, s42, 2
buffer_store_dwordx2 v[236:237], v242, s[24:27], s3 offen sc1
s_lshr_b32 s3, s43, 2
buffer_store_dwordx2 v[238:239], v242, s[24:27], s3 offen sc1
s_mov_b32 exec_hi, -1
v_mfma_f32_16x16x32_bf16 a[72:75], v[68:71], v[208:211], a[72:75]
v_accvgpr_read_b32 v128, a0
v_accvgpr_read_b32 v129, a1
v_accvgpr_read_b32 v130, a2
v_mfma_f32_16x16x32_bf16 a[76:79], v[100:103], v[208:211], a[76:79]
ds_read_b64_tr_b16 v[208:209], v14 offset:4096
s_waitcnt lgkmcnt(5)
v_accvgpr_read_b32 v131, a3
v_mfma_f32_16x16x32_bf16 a[64:67], v[8:11], v[212:215], a[64:67]
ds_read_b64_tr_b16 v[210:211], v14 offset:6144
v_cvt_pk_bf16_f32 v16, v128, v129
v_cvt_pk_bf16_f32 v17, v130, v131
v_mfma_f32_16x16x32_bf16 a[68:71], v[40:43], v[212:215], a[68:71]
v_accvgpr_read_b32 v136, a4
v_accvgpr_read_b32 v137, a5
v_accvgpr_read_b32 v138, a6
v_mfma_f32_16x16x32_bf16 a[72:75], v[72:75], v[212:215], a[72:75]
v_accvgpr_read_b32 v139, a7
v_cvt_pk_bf16_f32 v48, v136, v137
v_cvt_pk_bf16_f32 v49, v138, v139
v_mfma_f32_16x16x32_bf16 a[76:79], v[104:107], v[212:215], a[76:79]
ds_read_b64_tr_b16 v[212:213], v250 offset:4096
s_waitcnt lgkmcnt(5)
v_accvgpr_read_b32 v144, a8
v_mfma_f32_16x16x32_bf16 a[64:67], v[160:163], v[216:219], a[64:67]
ds_read_b64_tr_b16 v[214:215], v250 offset:6144
v_accvgpr_read_b32 v145, a9
v_accvgpr_read_b32 v146, a10
v_mfma_f32_16x16x32_bf16 a[68:71], v[164:167], v[216:219], a[68:71]
v_accvgpr_read_b32 v147, a11
v_cvt_pk_bf16_f32 v80, v144, v145
v_cvt_pk_bf16_f32 v81, v146, v147
v_mfma_f32_16x16x32_bf16 a[72:75], v[168:171], v[216:219], a[72:75]
v_accvgpr_read_b32 v152, a12
v_accvgpr_read_b32 v153, a13
v_accvgpr_read_b32 v154, a14
v_mfma_f32_16x16x32_bf16 a[76:79], v[172:175], v[216:219], a[76:79]
ds_read_b64_tr_b16 v[216:217], v250 offset:20480
s_waitcnt lgkmcnt(5)
v_accvgpr_read_b32 v155, a15
v_mfma_f32_16x16x32_bf16 a[64:67], v[176:179], v[220:223], a[64:67]
ds_read_b64_tr_b16 v[218:219], v250 offset:22528
v_cvt_pk_bf16_f32 v112, v152, v153
v_cvt_pk_bf16_f32 v113, v154, v155
v_mfma_f32_16x16x32_bf16 a[68:71], v[180:183], v[220:223], a[68:71]
v_accvgpr_read_b32 v132, a16
v_accvgpr_read_b32 v133, a17
v_accvgpr_read_b32 v134, a18
v_mfma_f32_16x16x32_bf16 a[72:75], v[184:187], v[220:223], a[72:75]
v_accvgpr_read_b32 v135, a19
v_cvt_pk_bf16_f32 v18, v132, v133
v_cvt_pk_bf16_f32 v19, v134, v135
v_mfma_f32_16x16x32_bf16 a[76:79], v[188:191], v[220:223], a[76:79]
ds_read_b64_tr_b16 v[220:221], v13 offset:4096
s_waitcnt lgkmcnt(5)
buffer_store_dwordx4 v[16:19], v248, s[20:23], s40 offen offset:0 sc1
v_mfma_f32_16x16x32_bf16 a[64:67], v[0:3], v[208:211], a[64:67]
ds_read_b64_tr_b16 v[222:223], v13 offset:6144
ds_write_b128 v253, v[16:19] offset:0
v_accvgpr_read_b32 v140, a20
v_mfma_f32_16x16x32_bf16 a[68:71], v[32:35], v[208:211], a[68:71]
v_accvgpr_read_b32 v141, a21
v_accvgpr_read_b32 v142, a22
v_accvgpr_read_b32 v143, a23
v_mfma_f32_16x16x32_bf16 a[72:75], v[64:67], v[208:211], a[72:75]
v_cvt_pk_bf16_f32 v50, v140, v141
v_cvt_pk_bf16_f32 v51, v142, v143
buffer_store_dwordx4 v[48:51], v248, s[20:23], s41 offen offset:0 sc1
v_mfma_f32_16x16x32_bf16 a[76:79], v[96:99], v[208:211], a[76:79]
ds_read_b64_tr_b16 v[208:209], v13 offset:20480
s_waitcnt lgkmcnt(5)
v_accvgpr_read_b32 v148, a24
v_mfma_f32_16x16x32_bf16 a[80:83], v[4:7], v[212:215], a[80:83]
ds_read_b64_tr_b16 v[210:211], v13 offset:22528
v_accvgpr_read_b32 v149, a25
v_accvgpr_read_b32 v150, a26
v_mfma_f32_16x16x32_bf16 a[84:87], v[36:39], v[212:215], a[84:87]
v_accvgpr_read_b32 v151, a27
v_cvt_pk_bf16_f32 v82, v148, v149
v_cvt_pk_bf16_f32 v83, v150, v151
v_mfma_f32_16x16x32_bf16 a[88:91], v[68:71], v[212:215], a[88:91]
buffer_store_dwordx4 v[80:83], v248, s[20:23], s42 offen offset:0 sc1
v_accvgpr_read_b32 v156, a28
v_accvgpr_read_b32 v157, a29
v_mfma_f32_16x16x32_bf16 a[92:95], v[100:103], v[212:215], a[92:95]
ds_read_b64_tr_b16 v[212:213], v15 offset:4096
s_waitcnt lgkmcnt(5)
v_accvgpr_read_b32 v158, a30
v_mfma_f32_16x16x32_bf16 a[80:83], v[8:11], v[216:219], a[80:83]
ds_read_b64_tr_b16 v[214:215], v15 offset:6144
v_accvgpr_read_b32 v159, a31
v_cvt_pk_bf16_f32 v114, v156, v157
v_mfma_f32_16x16x32_bf16 a[84:87], v[40:43], v[216:219], a[84:87]
v_cvt_pk_bf16_f32 v115, v158, v159
buffer_store_dwordx4 v[112:115], v248, s[20:23], s43 offen offset:0 sc1
v_accvgpr_read_b32 v128, a32
v_mfma_f32_16x16x32_bf16 a[88:91], v[72:75], v[216:219], a[88:91]
v_accvgpr_read_b32 v129, a33
v_accvgpr_read_b32 v130, a34
v_accvgpr_read_b32 v131, a35
v_mfma_f32_16x16x32_bf16 a[92:95], v[104:107], v[216:219], a[92:95]
ds_read_b64_tr_b16 v[216:217], v249 offset:4608
s_waitcnt lgkmcnt(5)
v_cvt_pk_bf16_f32 v20, v128, v129
v_mfma_f32_16x16x32_bf16 a[80:83], v[160:163], v[220:223], a[80:83]
ds_read_b64_tr_b16 v[218:219], v249 offset:6656
v_cvt_pk_bf16_f32 v21, v130, v131
v_accvgpr_read_b32 v136, a36
v_mfma_f32_16x16x32_bf16 a[84:87], v[164:167], v[220:223], a[84:87]
v_accvgpr_read_b32 v137, a37
v_accvgpr_read_b32 v138, a38
v_accvgpr_read_b32 v139, a39
v_mfma_f32_16x16x32_bf16 a[88:91], v[168:171], v[220:223], a[88:91]
v_cvt_pk_bf16_f32 v52, v136, v137
v_cvt_pk_bf16_f32 v53, v138, v139
v_accvgpr_read_b32 v144, a40
v_mfma_f32_16x16x32_bf16 a[92:95], v[172:175], v[220:223], a[92:95]
ds_read_b64_tr_b16 v[220:221], v249 offset:20992
s_waitcnt lgkmcnt(5)
v_accvgpr_read_b32 v145, a41
v_mfma_f32_16x16x32_bf16 a[80:83], v[176:179], v[208:211], a[80:83]
ds_read_b64_tr_b16 v[222:223], v249 offset:23040
v_accvgpr_read_b32 v146, a42
v_accvgpr_read_b32 v147, a43
v_mfma_f32_16x16x32_bf16 a[84:87], v[180:183], v[208:211], a[84:87]
v_cvt_pk_bf16_f32 v84, v144, v145
v_cvt_pk_bf16_f32 v85, v146, v147
v_accvgpr_read_b32 v152, a44
v_mfma_f32_16x16x32_bf16 a[88:91], v[184:187], v[208:211], a[88:91]
v_accvgpr_read_b32 v153, a45
v_accvgpr_read_b32 v154, a46
v_accvgpr_read_b32 v155, a47
v_mfma_f32_16x16x32_bf16 a[92:95], v[188:191], v[208:211], a[92:95]
ds_read_b64_tr_b16 v[208:209], v12 offset:4608
s_waitcnt lgkmcnt(5)
v_cvt_pk_bf16_f32 v116, v152, v153
v_mfma_f32_16x16x32_bf16 a[80:83], v[0:3], v[212:215], a[80:83]
ds_read_b64_tr_b16 v[210:211], v12 offset:6656
v_cvt_pk_bf16_f32 v117, v154, v155
v_accvgpr_read_b32 v132, a48
v_mfma_f32_16x16x32_bf16 a[84:87], v[32:35], v[212:215], a[84:87]
v_accvgpr_read_b32 v133, a49
v_accvgpr_read_b32 v134, a50
v_accvgpr_read_b32 v135, a51
v_mfma_f32_16x16x32_bf16 a[88:91], v[64:67], v[212:215], a[88:91]
v_cvt_pk_bf16_f32 v22, v132, v133
v_cvt_pk_bf16_f32 v23, v134, v135
buffer_store_dwordx4 v[20:23], v248, s[20:23], s40 offen offset:1024 sc1
v_mfma_f32_16x16x32_bf16 a[92:95], v[96:99], v[212:215], a[92:95]
ds_read_b64_tr_b16 v[212:213], v12 offset:20992
s_waitcnt lgkmcnt(5)
ds_write_b128 v253, v[20:23] offset:1024
v_mfma_f32_16x16x32_bf16 a[96:99], v[4:7], v[216:219], a[96:99]
ds_read_b64_tr_b16 v[214:215], v12 offset:23040
v_accvgpr_read_b32 v140, a52
v_accvgpr_read_b32 v141, a53
v_mfma_f32_16x16x32_bf16 a[100:103], v[36:39], v[216:219], a[100:103]
v_accvgpr_read_b32 v142, a54
v_accvgpr_read_b32 v143, a55
v_cvt_pk_bf16_f32 v54, v140, v141
v_mfma_f32_16x16x32_bf16 a[104:107], v[68:71], v[216:219], a[104:107]
v_cvt_pk_bf16_f32 v55, v142, v143
buffer_store_dwordx4 v[52:55], v248, s[20:23], s41 offen offset:1024 sc1
v_accvgpr_read_b32 v148, a56
v_mfma_f32_16x16x32_bf16 a[108:111], v[100:103], v[216:219], a[108:111]
ds_read_b64_tr_b16 v[216:217], v14 offset:4608
s_waitcnt lgkmcnt(5)
v_accvgpr_read_b32 v149, a57
v_mfma_f32_16x16x32_bf16 a[96:99], v[8:11], v[220:223], a[96:99]
ds_read_b64_tr_b16 v[218:219], v14 offset:6656
v_accvgpr_read_b32 v150, a58
v_accvgpr_read_b32 v151, a59
v_mfma_f32_16x16x32_bf16 a[100:103], v[40:43], v[220:223], a[100:103]
v_cvt_pk_bf16_f32 v86, v148, v149
v_cvt_pk_bf16_f32 v87, v150, v151
buffer_store_dwordx4 v[84:87], v248, s[20:23], s42 offen offset:1024 sc1
v_mfma_f32_16x16x32_bf16 a[104:107], v[72:75], v[220:223], a[104:107]
v_accvgpr_read_b32 v156, a60
v_accvgpr_read_b32 v157, a61
v_accvgpr_read_b32 v158, a62
v_mfma_f32_16x16x32_bf16 a[108:111], v[104:107], v[220:223], a[108:111]
ds_read_b64_tr_b16 v[220:221], v250 offset:4608
s_waitcnt lgkmcnt(5)
v_accvgpr_read_b32 v159, a63
v_mfma_f32_16x16x32_bf16 a[96:99], v[160:163], v[208:211], a[96:99]
ds_read_b64_tr_b16 v[222:223], v250 offset:6656
v_cvt_pk_bf16_f32 v118, v156, v157
v_cvt_pk_bf16_f32 v119, v158, v159
v_mfma_f32_16x16x32_bf16 a[100:103], v[164:167], v[208:211], a[100:103]
buffer_store_dwordx4 v[116:119], v248, s[20:23], s43 offen offset:1024 sc1
v_accvgpr_read_b32 v128, a64
v_accvgpr_read_b32 v129, a65
v_mfma_f32_16x16x32_bf16 a[104:107], v[168:171], v[208:211], a[104:107]
v_accvgpr_read_b32 v130, a66
v_accvgpr_read_b32 v131, a67
v_cvt_pk_bf16_f32 v24, v128, v129
v_mfma_f32_16x16x32_bf16 a[108:111], v[172:175], v[208:211], a[108:111]
ds_read_b64_tr_b16 v[208:209], v250 offset:20992
s_waitcnt lgkmcnt(5)
v_cvt_pk_bf16_f32 v25, v130, v131
v_mfma_f32_16x16x32_bf16 a[96:99], v[176:179], v[212:215], a[96:99]
ds_read_b64_tr_b16 v[210:211], v250 offset:23040
v_accvgpr_read_b32 v136, a68
v_accvgpr_read_b32 v137, a69
v_mfma_f32_16x16x32_bf16 a[100:103], v[180:183], v[212:215], a[100:103]
v_accvgpr_read_b32 v138, a70
v_accvgpr_read_b32 v139, a71
v_cvt_pk_bf16_f32 v56, v136, v137
v_mfma_f32_16x16x32_bf16 a[104:107], v[184:187], v[212:215], a[104:107]
v_cvt_pk_bf16_f32 v57, v138, v139
v_accvgpr_read_b32 v144, a72
v_accvgpr_read_b32 v145, a73
v_mfma_f32_16x16x32_bf16 a[108:111], v[188:191], v[212:215], a[108:111]
ds_read_b64_tr_b16 v[212:213], v13 offset:4608
s_waitcnt lgkmcnt(5)
v_accvgpr_read_b32 v146, a74
v_mfma_f32_16x16x32_bf16 a[96:99], v[0:3], v[216:219], a[96:99]
ds_read_b64_tr_b16 v[214:215], v13 offset:6656
v_accvgpr_read_b32 v147, a75
v_cvt_pk_bf16_f32 v88, v144, v145
v_mfma_f32_16x16x32_bf16 a[100:103], v[32:35], v[216:219], a[100:103]
v_cvt_pk_bf16_f32 v89, v146, v147
v_accvgpr_read_b32 v152, a76
v_accvgpr_read_b32 v153, a77
v_mfma_f32_16x16x32_bf16 a[104:107], v[64:67], v[216:219], a[104:107]
v_accvgpr_read_b32 v154, a78
v_accvgpr_read_b32 v155, a79
v_cvt_pk_bf16_f32 v120, v152, v153
v_mfma_f32_16x16x32_bf16 a[108:111], v[96:99], v[216:219], a[108:111]
ds_read_b64_tr_b16 v[216:217], v13 offset:20992
s_waitcnt lgkmcnt(5)
v_cvt_pk_bf16_f32 v121, v154, v155
v_mfma_f32_16x16x32_bf16 a[112:115], v[4:7], v[220:223], a[112:115]
ds_read_b64_tr_b16 v[218:219], v13 offset:23040
v_accvgpr_read_b32 v132, a80
v_accvgpr_read_b32 v133, a81
v_mfma_f32_16x16x32_bf16 a[116:119], v[36:39], v[220:223], a[116:119]
v_accvgpr_read_b32 v134, a82
v_accvgpr_read_b32 v135, a83
v_cvt_pk_bf16_f32 v26, v132, v133
v_mfma_f32_16x16x32_bf16 a[120:123], v[68:71], v[220:223], a[120:123]
v_cvt_pk_bf16_f32 v27, v134, v135
buffer_store_dwordx4 v[24:27], v248, s[20:23], s40 offen offset:2048 sc1
ds_write_b128 v253, v[24:27] offset:2048
v_mfma_f32_16x16x32_bf16 a[124:127], v[100:103], v[220:223], a[124:127]
ds_read_b64_tr_b16 v[220:221], v15 offset:4608
s_waitcnt lgkmcnt(5)
v_accvgpr_read_b32 v140, a84
v_mfma_f32_16x16x32_bf16 a[112:115], v[8:11], v[208:211], a[112:115]
ds_read_b64_tr_b16 v[222:223], v15 offset:6656
v_accvgpr_read_b32 v141, a85
v_accvgpr_read_b32 v142, a86
v_mfma_f32_16x16x32_bf16 a[116:119], v[40:43], v[208:211], a[116:119]
v_accvgpr_read_b32 v143, a87
v_cvt_pk_bf16_f32 v58, v140, v141
v_cvt_pk_bf16_f32 v59, v142, v143
v_mfma_f32_16x16x32_bf16 a[120:123], v[72:75], v[208:211], a[120:123]
buffer_store_dwordx4 v[56:59], v248, s[20:23], s41 offen offset:2048 sc1
v_accvgpr_read_b32 v148, a88
v_accvgpr_read_b32 v149, a89
v_mfma_f32_16x16x32_bf16 a[124:127], v[104:107], v[208:211], a[124:127]
ds_read_b64_tr_b16 v[208:209], v249 offset:8192
s_waitcnt lgkmcnt(5)
v_accvgpr_read_b32 v150, a90
v_mfma_f32_16x16x32_bf16 a[112:115], v[160:163], v[212:215], a[112:115]
ds_read_b64_tr_b16 v[210:211], v249 offset:10240
v_accvgpr_read_b32 v151, a91
v_cvt_pk_bf16_f32 v90, v148, v149
v_mfma_f32_16x16x32_bf16 a[116:119], v[164:167], v[212:215], a[116:119]
v_cvt_pk_bf16_f32 v91, v150, v151
buffer_store_dwordx4 v[88:91], v248, s[20:23], s42 offen offset:2048 sc1
v_accvgpr_read_b32 v156, a92
v_mfma_f32_16x16x32_bf16 a[120:123], v[168:171], v[212:215], a[120:123]
v_accvgpr_read_b32 v157, a93
v_accvgpr_read_b32 v158, a94
v_accvgpr_read_b32 v159, a95
v_mfma_f32_16x16x32_bf16 a[124:127], v[172:175], v[212:215], a[124:127]
ds_read_b64_tr_b16 v[212:213], v249 offset:24576
s_waitcnt lgkmcnt(5)
v_cvt_pk_bf16_f32 v122, v156, v157
v_mfma_f32_16x16x32_bf16 a[112:115], v[176:179], v[216:219], a[112:115]
ds_read_b64_tr_b16 v[214:215], v249 offset:26624
v_cvt_pk_bf16_f32 v123, v158, v159
buffer_store_dwordx4 v[120:123], v248, s[20:23], s43 offen offset:2048 sc1
v_mfma_f32_16x16x32_bf16 a[116:119], v[180:183], v[216:219], a[116:119]
v_accvgpr_read_b32 v128, a96
v_accvgpr_read_b32 v129, a97
v_mfma_f32_16x16x32_bf16 a[120:123], v[184:187], v[216:219], a[120:123]
v_accvgpr_read_b32 v130, a98
v_accvgpr_read_b32 v131, a99
v_mfma_f32_16x16x32_bf16 a[124:127], v[188:191], v[216:219], a[124:127]
ds_read_b64_tr_b16 v[216:217], v12 offset:8192
s_waitcnt lgkmcnt(5)
v_mfma_f32_16x16x32_bf16 a[112:115], v[0:3], v[220:223], a[112:115]
ds_read_b64_tr_b16 v[218:219], v12 offset:10240
v_cvt_pk_bf16_f32 v28, v128, v129
v_mfma_f32_16x16x32_bf16 a[116:119], v[32:35], v[220:223], a[116:119]
v_cvt_pk_bf16_f32 v29, v130, v131
v_accvgpr_read_b32 v136, a100
v_mfma_f32_16x16x32_bf16 a[120:123], v[64:67], v[220:223], a[120:123]
v_accvgpr_read_b32 v137, a101
v_accvgpr_read_b32 v138, a102
v_mfma_f32_16x16x32_bf16 a[124:127], v[96:99], v[220:223], a[124:127]
ds_read_b64_tr_b16 v[220:221], v12 offset:24576
s_waitcnt lgkmcnt(5)
v_mfma_f32_16x16x32_bf16 a[128:131], v[4:7], v[208:211], a[128:131]
ds_read_b64_tr_b16 v[222:223], v12 offset:26624
v_accvgpr_read_b32 v139, a103
v_mfma_f32_16x16x32_bf16 a[132:135], v[36:39], v[208:211], a[132:135]
v_cvt_pk_bf16_f32 v60, v136, v137
v_cvt_pk_bf16_f32 v61, v138, v139
v_mfma_f32_16x16x32_bf16 a[136:139], v[68:71], v[208:211], a[136:139]
v_accvgpr_read_b32 v144, a104
v_accvgpr_read_b32 v145, a105
v_mfma_f32_16x16x32_bf16 a[140:143], v[100:103], v[208:211], a[140:143]
ds_read_b64_tr_b16 v[208:209], v14 offset:8192
s_waitcnt lgkmcnt(5)
v_mfma_f32_16x16x32_bf16 a[128:131], v[8:11], v[212:215], a[128:131]
ds_read_b64_tr_b16 v[210:211], v14 offset:10240
v_accvgpr_read_b32 v146, a106
v_mfma_f32_16x16x32_bf16 a[132:135], v[40:43], v[212:215], a[132:135]
v_accvgpr_read_b32 v147, a107
v_cvt_pk_bf16_f32 v92, v144, v145
v_mfma_f32_16x16x32_bf16 a[136:139], v[72:75], v[212:215], a[136:139]
v_cvt_pk_bf16_f32 v93, v146, v147
v_accvgpr_read_b32 v152, a108
v_mfma_f32_16x16x32_bf16 a[140:143], v[104:107], v[212:215], a[140:143]
ds_read_b64_tr_b16 v[212:213], v250 offset:8192
s_waitcnt lgkmcnt(5)
v_mfma_f32_16x16x32_bf16 a[128:131], v[160:163], v[216:219], a[128:131]
ds_read_b64_tr_b16 v[214:215], v250 offset:10240
v_accvgpr_read_b32 v153, a109
v_mfma_f32_16x16x32_bf16 a[132:135], v[164:167], v[216:219], a[132:135]
v_accvgpr_read_b32 v154, a110
v_accvgpr_read_b32 v155, a111
v_mfma_f32_16x16x32_bf16 a[136:139], v[168:171], v[216:219], a[136:139]
v_cvt_pk_bf16_f32 v124, v152, v153
v_cvt_pk_bf16_f32 v125, v154, v155
v_mfma_f32_16x16x32_bf16 a[140:143], v[172:175], v[216:219], a[140:143]
ds_read_b64_tr_b16 v[216:217], v250 offset:24576
s_waitcnt lgkmcnt(5)
v_mfma_f32_16x16x32_bf16 a[128:131], v[176:179], v[220:223], a[128:131]
ds_read_b64_tr_b16 v[218:219], v250 offset:26624
v_accvgpr_read_b32 v132, a112
v_mfma_f32_16x16x32_bf16 a[132:135], v[180:183], v[220:223], a[132:135]
v_accvgpr_read_b32 v133, a113
v_accvgpr_read_b32 v134, a114
v_mfma_f32_16x16x32_bf16 a[136:139], v[184:187], v[220:223], a[136:139]
v_accvgpr_read_b32 v135, a115
v_cvt_pk_bf16_f32 v30, v132, v133
v_mfma_f32_16x16x32_bf16 a[140:143], v[188:191], v[220:223], a[140:143]
ds_read_b64_tr_b16 v[220:221], v13 offset:8192
s_waitcnt lgkmcnt(5)
v_mfma_f32_16x16x32_bf16 a[128:131], v[0:3], v[208:211], a[128:131]
ds_read_b64_tr_b16 v[222:223], v13 offset:10240
v_cvt_pk_bf16_f32 v31, v134, v135
v_mfma_f32_16x16x32_bf16 a[132:135], v[32:35], v[208:211], a[132:135]
buffer_store_dwordx4 v[28:31], v248, s[20:23], s40 offen offset:3072 sc1
ds_write_b128 v253, v[28:31] offset:3072
v_mfma_f32_16x16x32_bf16 a[136:139], v[64:67], v[208:211], a[136:139]
v_accvgpr_read_b32 v140, a116
v_accvgpr_read_b32 v141, a117
v_mfma_f32_16x16x32_bf16 a[140:143], v[96:99], v[208:211], a[140:143]
ds_read_b64_tr_b16 v[208:209], v13 offset:24576
s_waitcnt lgkmcnt(5)
v_mfma_f32_16x16x32_bf16 a[144:147], v[4:7], v[212:215], a[144:147]
ds_read_b64_tr_b16 v[210:211], v13 offset:26624
v_accvgpr_read_b32 v142, a118
v_mfma_f32_16x16x32_bf16 a[148:151], v[36:39], v[212:215], a[148:151]
v_accvgpr_read_b32 v143, a119
v_cvt_pk_bf16_f32 v62, v140, v141
v_mfma_f32_16x16x32_bf16 a[152:155], v[68:71], v[212:215], a[152:155]
v_cvt_pk_bf16_f32 v63, v142, v143
buffer_store_dwordx4 v[60:63], v248, s[20:23], s41 offen offset:3072 sc1
v_mfma_f32_16x16x32_bf16 a[156:159], v[100:103], v[212:215], a[156:159]
ds_read_b64_tr_b16 v[212:213], v15 offset:8192
s_waitcnt lgkmcnt(5)
v_mfma_f32_16x16x32_bf16 a[144:147], v[8:11], v[216:219], a[144:147]
ds_read_b64_tr_b16 v[214:215], v15 offset:10240
v_accvgpr_read_b32 v148, a120
v_mfma_f32_16x16x32_bf16 a[148:151], v[40:43], v[216:219], a[148:151]
v_accvgpr_read_b32 v149, a121
v_accvgpr_read_b32 v150, a122
v_mfma_f32_16x16x32_bf16 a[152:155], v[72:75], v[216:219], a[152:155]
v_accvgpr_read_b32 v151, a123
v_cvt_pk_bf16_f32 v94, v148, v149
v_mfma_f32_16x16x32_bf16 a[156:159], v[104:107], v[216:219], a[156:159]
ds_read_b64_tr_b16 v[216:217], v249 offset:8704
s_waitcnt lgkmcnt(5)
v_mfma_f32_16x16x32_bf16 a[144:147], v[160:163], v[220:223], a[144:147]
ds_read_b64_tr_b16 v[218:219], v249 offset:10752
v_cvt_pk_bf16_f32 v95, v150, v151
v_mfma_f32_16x16x32_bf16 a[148:151], v[164:167], v[220:223], a[148:151]
buffer_store_dwordx4 v[92:95], v248, s[20:23], s42 offen offset:3072 sc1
v_accvgpr_read_b32 v156, a124
v_mfma_f32_16x16x32_bf16 a[152:155], v[168:171], v[220:223], a[152:155]
v_accvgpr_read_b32 v157, a125
v_accvgpr_read_b32 v158, a126
v_mfma_f32_16x16x32_bf16 a[156:159], v[172:175], v[220:223], a[156:159]
ds_read_b64_tr_b16 v[220:221], v249 offset:25088
s_waitcnt lgkmcnt(5)
v_mfma_f32_16x16x32_bf16 a[144:147], v[176:179], v[208:211], a[144:147]
ds_read_b64_tr_b16 v[222:223], v249 offset:27136
v_accvgpr_read_b32 v159, a127
v_mfma_f32_16x16x32_bf16 a[148:151], v[180:183], v[208:211], a[148:151]
v_cvt_pk_bf16_f32 v126, v156, v157
v_cvt_pk_bf16_f32 v127, v158, v159
v_mfma_f32_16x16x32_bf16 a[152:155], v[184:187], v[208:211], a[152:155]
buffer_store_dwordx4 v[124:127], v248, s[20:23], s43 offen offset:3072 sc1
v_accvgpr_read_b32 v128, a128
v_mfma_f32_16x16x32_bf16 a[156:159], v[188:191], v[208:211], a[156:159]
ds_read_b64_tr_b16 v[208:209], v12 offset:8704
s_waitcnt lgkmcnt(5)
v_mfma_f32_16x16x32_bf16 a[144:147], v[0:3], v[212:215], a[144:147]
ds_read_b64_tr_b16 v[210:211], v12 offset:10752
v_accvgpr_read_b32 v129, a129
v_mfma_f32_16x16x32_bf16 a[148:151], v[32:35], v[212:215], a[148:151]
v_accvgpr_read_b32 v130, a130
v_accvgpr_read_b32 v131, a131
v_mfma_f32_16x16x32_bf16 a[152:155], v[64:67], v[212:215], a[152:155]
v_cvt_pk_bf16_f32 v16, v128, v129
v_cvt_pk_bf16_f32 v17, v130, v131
v_mfma_f32_16x16x32_bf16 a[156:159], v[96:99], v[212:215], a[156:159]
ds_read_b64_tr_b16 v[212:213], v12 offset:25088
s_waitcnt lgkmcnt(5)
v_mfma_f32_16x16x32_bf16 a[160:163], v[4:7], v[216:219], a[160:163]
ds_read_b64_tr_b16 v[214:215], v12 offset:27136
v_accvgpr_read_b32 v136, a132
v_mfma_f32_16x16x32_bf16 a[164:167], v[36:39], v[216:219], a[164:167]
v_accvgpr_read_b32 v137, a133
v_accvgpr_read_b32 v138, a134
v_mfma_f32_16x16x32_bf16 a[168:171], v[68:71], v[216:219], a[168:171]
v_accvgpr_read_b32 v139, a135
v_cvt_pk_bf16_f32 v48, v136, v137
v_mfma_f32_16x16x32_bf16 a[172:175], v[100:103], v[216:219], a[172:175]
ds_read_b64_tr_b16 v[216:217], v14 offset:8704
s_waitcnt lgkmcnt(5)
v_mfma_f32_16x16x32_bf16 a[160:163], v[8:11], v[220:223], a[160:163]
ds_read_b64_tr_b16 v[218:219], v14 offset:10752
v_cvt_pk_bf16_f32 v49, v138, v139
v_mfma_f32_16x16x32_bf16 a[164:167], v[40:43], v[220:223], a[164:167]
v_accvgpr_read_b32 v144, a136
v_accvgpr_read_b32 v145, a137
v_mfma_f32_16x16x32_bf16 a[168:171], v[72:75], v[220:223], a[168:171]
v_accvgpr_read_b32 v146, a138
v_accvgpr_read_b32 v147, a139
v_mfma_f32_16x16x32_bf16 a[172:175], v[104:107], v[220:223], a[172:175]
ds_read_b64_tr_b16 v[220:221], v250 offset:8704
s_waitcnt lgkmcnt(5)
v_mfma_f32_16x16x32_bf16 a[160:163], v[160:163], v[208:211], a[160:163]
ds_read_b64_tr_b16 v[222:223], v250 offset:10752
v_cvt_pk_bf16_f32 v80, v144, v145
v_mfma_f32_16x16x32_bf16 a[164:167], v[164:167], v[208:211], a[164:167]
v_cvt_pk_bf16_f32 v81, v146, v147
v_accvgpr_read_b32 v152, a140
v_mfma_f32_16x16x32_bf16 a[168:171], v[168:171], v[208:211], a[168:171]
v_accvgpr_read_b32 v153, a141
v_accvgpr_read_b32 v154, a142
v_mfma_f32_16x16x32_bf16 a[172:175], v[172:175], v[208:211], a[172:175]
ds_read_b64_tr_b16 v[208:209], v250 offset:25088
s_waitcnt lgkmcnt(5)
v_mfma_f32_16x16x32_bf16 a[160:163], v[176:179], v[212:215], a[160:163]
ds_read_b64_tr_b16 v[210:211], v250 offset:27136
v_accvgpr_read_b32 v155, a143
v_mfma_f32_16x16x32_bf16 a[164:167], v[180:183], v[212:215], a[164:167]
v_cvt_pk_bf16_f32 v112, v152, v153
v_cvt_pk_bf16_f32 v113, v154, v155
v_mfma_f32_16x16x32_bf16 a[168:171], v[184:187], v[212:215], a[168:171]
v_accvgpr_read_b32 v132, a144
v_accvgpr_read_b32 v133, a145
v_mfma_f32_16x16x32_bf16 a[172:175], v[188:191], v[212:215], a[172:175]
ds_read_b64_tr_b16 v[212:213], v13 offset:8704
s_waitcnt lgkmcnt(5)
v_mfma_f32_16x16x32_bf16 a[160:163], v[0:3], v[216:219], a[160:163]
ds_read_b64_tr_b16 v[214:215], v13 offset:10752
v_accvgpr_read_b32 v134, a146
v_mfma_f32_16x16x32_bf16 a[164:167], v[32:35], v[216:219], a[164:167]
v_accvgpr_read_b32 v135, a147
v_cvt_pk_bf16_f32 v18, v132, v133
v_mfma_f32_16x16x32_bf16 a[168:171], v[64:67], v[216:219], a[168:171]
v_cvt_pk_bf16_f32 v19, v134, v135
buffer_store_dwordx4 v[16:19], v248, s[20:23], s44 offen offset:0 sc1
v_mfma_f32_16x16x32_bf16 a[172:175], v[96:99], v[216:219], a[172:175]
ds_read_b64_tr_b16 v[216:217], v13 offset:25088
s_waitcnt lgkmcnt(5)
v_mfma_f32_16x16x32_bf16 a[176:179], v[4:7], v[220:223], a[176:179]
ds_read_b64_tr_b16 v[218:219], v13 offset:27136
ds_write_b128 v253, v[16:19] offset:4096
v_mfma_f32_16x16x32_bf16 a[180:183], v[36:39], v[220:223], a[180:183]
v_accvgpr_read_b32 v140, a148
v_accvgpr_read_b32 v141, a149
v_mfma_f32_16x16x32_bf16 a[184:187], v[68:71], v[220:223], a[184:187]
v_accvgpr_read_b32 v142, a150
v_accvgpr_read_b32 v143, a151
v_mfma_f32_16x16x32_bf16 a[188:191], v[100:103], v[220:223], a[188:191]
ds_read_b64_tr_b16 v[220:221], v15 offset:8704
s_waitcnt lgkmcnt(5)
v_mfma_f32_16x16x32_bf16 a[176:179], v[8:11], v[208:211], a[176:179]
ds_read_b64_tr_b16 v[222:223], v15 offset:10752
v_cvt_pk_bf16_f32 v50, v140, v141
v_mfma_f32_16x16x32_bf16 a[180:183], v[40:43], v[208:211], a[180:183]
v_cvt_pk_bf16_f32 v51, v142, v143
buffer_store_dwordx4 v[48:51], v248, s[20:23], s45 offen offset:0 sc1
v_mfma_f32_16x16x32_bf16 a[184:187], v[72:75], v[208:211], a[184:187]
v_accvgpr_read_b32 v148, a152
v_accvgpr_read_b32 v149, a153
v_mfma_f32_16x16x32_bf16 a[188:191], v[104:107], v[208:211], a[188:191]
ds_read_b64_tr_b16 v[208:209], v249 offset:12288
s_waitcnt lgkmcnt(5)
v_mfma_f32_16x16x32_bf16 a[176:179], v[160:163], v[212:215], a[176:179]
ds_read_b64_tr_b16 v[210:211], v249 offset:14336
v_accvgpr_read_b32 v150, a154
v_mfma_f32_16x16x32_bf16 a[180:183], v[164:167], v[212:215], a[180:183]
v_accvgpr_read_b32 v151, a155
v_cvt_pk_bf16_f32 v82, v148, v149
v_mfma_f32_16x16x32_bf16 a[184:187], v[168:171], v[212:215], a[184:187]
v_cvt_pk_bf16_f32 v83, v150, v151
buffer_store_dwordx4 v[80:83], v248, s[20:23], s46 offen offset:0 sc1
v_mfma_f32_16x16x32_bf16 a[188:191], v[172:175], v[212:215], a[188:191]
ds_read_b64_tr_b16 v[212:213], v249 offset:28672
s_waitcnt lgkmcnt(5)
v_mfma_f32_16x16x32_bf16 a[176:179], v[176:179], v[216:219], a[176:179]
ds_read_b64_tr_b16 v[214:215], v249 offset:30720
v_accvgpr_read_b32 v156, a156
v_mfma_f32_16x16x32_bf16 a[180:183], v[180:183], v[216:219], a[180:183]
v_accvgpr_read_b32 v157, a157
v_accvgpr_read_b32 v158, a158
v_mfma_f32_16x16x32_bf16 a[184:187], v[184:187], v[216:219], a[184:187]
v_accvgpr_read_b32 v159, a159
v_cvt_pk_bf16_f32 v114, v156, v157
v_mfma_f32_16x16x32_bf16 a[188:191], v[188:191], v[216:219], a[188:191]
ds_read_b64_tr_b16 v[216:217], v12 offset:12288
s_waitcnt lgkmcnt(5)
v_mfma_f32_16x16x32_bf16 a[176:179], v[0:3], v[220:223], a[176:179]
ds_read_b64_tr_b16 v[218:219], v12 offset:14336
v_cvt_pk_bf16_f32 v115, v158, v159
v_mfma_f32_16x16x32_bf16 a[180:183], v[32:35], v[220:223], a[180:183]
buffer_store_dwordx4 v[112:115], v248, s[20:23], s47 offen offset:0 sc1
v_accvgpr_read_b32 v128, a160
v_mfma_f32_16x16x32_bf16 a[184:187], v[64:67], v[220:223], a[184:187]
v_accvgpr_read_b32 v129, a161
v_accvgpr_read_b32 v130, a162
v_mfma_f32_16x16x32_bf16 a[188:191], v[96:99], v[220:223], a[188:191]
ds_read_b64_tr_b16 v[220:221], v12 offset:28672
s_waitcnt lgkmcnt(5)
v_mfma_f32_16x16x32_bf16 a[192:195], v[4:7], v[208:211], a[192:195]
ds_read_b64_tr_b16 v[222:223], v12 offset:30720
v_accvgpr_read_b32 v131, a163
v_mfma_f32_16x16x32_bf16 a[196:199], v[36:39], v[208:211], a[196:199]
v_cvt_pk_bf16_f32 v20, v128, v129
v_cvt_pk_bf16_f32 v21, v130, v131
v_mfma_f32_16x16x32_bf16 a[200:203], v[68:71], v[208:211], a[200:203]
v_accvgpr_read_b32 v136, a164
v_accvgpr_read_b32 v137, a165
v_mfma_f32_16x16x32_bf16 a[204:207], v[100:103], v[208:211], a[204:207]
ds_read_b64_tr_b16 v[208:209], v14 offset:12288
s_waitcnt lgkmcnt(5)
v_mfma_f32_16x16x32_bf16 a[192:195], v[8:11], v[212:215], a[192:195]
ds_read_b64_tr_b16 v[210:211], v14 offset:14336
v_accvgpr_read_b32 v138, a166
v_mfma_f32_16x16x32_bf16 a[196:199], v[40:43], v[212:215], a[196:199]
v_accvgpr_read_b32 v139, a167
v_cvt_pk_bf16_f32 v52, v136, v137
v_mfma_f32_16x16x32_bf16 a[200:203], v[72:75], v[212:215], a[200:203]
v_cvt_pk_bf16_f32 v53, v138, v139
v_accvgpr_read_b32 v144, a168
v_mfma_f32_16x16x32_bf16 a[204:207], v[104:107], v[212:215], a[204:207]
ds_read_b64_tr_b16 v[212:213], v250 offset:12288
s_waitcnt lgkmcnt(5)
v_mfma_f32_16x16x32_bf16 a[192:195], v[160:163], v[216:219], a[192:195]
ds_read_b64_tr_b16 v[214:215], v250 offset:14336
v_accvgpr_read_b32 v145, a169
v_mfma_f32_16x16x32_bf16 a[196:199], v[164:167], v[216:219], a[196:199]
v_accvgpr_read_b32 v146, a170
v_accvgpr_read_b32 v147, a171
v_mfma_f32_16x16x32_bf16 a[200:203], v[168:171], v[216:219], a[200:203]
v_cvt_pk_bf16_f32 v84, v144, v145
v_cvt_pk_bf16_f32 v85, v146, v147
v_mfma_f32_16x16x32_bf16 a[204:207], v[172:175], v[216:219], a[204:207]
ds_read_b64_tr_b16 v[216:217], v250 offset:28672
s_waitcnt lgkmcnt(5)
v_mfma_f32_16x16x32_bf16 a[192:195], v[176:179], v[220:223], a[192:195]
ds_read_b64_tr_b16 v[218:219], v250 offset:30720
v_accvgpr_read_b32 v152, a172
v_mfma_f32_16x16x32_bf16 a[196:199], v[180:183], v[220:223], a[196:199]
v_accvgpr_read_b32 v153, a173
v_accvgpr_read_b32 v154, a174
v_mfma_f32_16x16x32_bf16 a[200:203], v[184:187], v[220:223], a[200:203]
v_accvgpr_read_b32 v155, a175
v_cvt_pk_bf16_f32 v116, v152, v153
v_mfma_f32_16x16x32_bf16 a[204:207], v[188:191], v[220:223], a[204:207]
ds_read_b64_tr_b16 v[220:221], v13 offset:12288
s_waitcnt lgkmcnt(5)
v_mfma_f32_16x16x32_bf16 a[192:195], v[0:3], v[208:211], a[192:195]
ds_read_b64_tr_b16 v[222:223], v13 offset:14336
v_cvt_pk_bf16_f32 v117, v154, v155
v_mfma_f32_16x16x32_bf16 a[196:199], v[32:35], v[208:211], a[196:199]
v_accvgpr_read_b32 v132, a176
v_accvgpr_read_b32 v133, a177
v_mfma_f32_16x16x32_bf16 a[200:203], v[64:67], v[208:211], a[200:203]
v_accvgpr_read_b32 v134, a178
v_accvgpr_read_b32 v135, a179
v_mfma_f32_16x16x32_bf16 a[204:207], v[96:99], v[208:211], a[204:207]
ds_read_b64_tr_b16 v[208:209], v13 offset:28672
s_waitcnt lgkmcnt(5)
v_mfma_f32_16x16x32_bf16 a[208:211], v[4:7], v[212:215], a[208:211]
ds_read_b64_tr_b16 v[210:211], v13 offset:30720
v_cvt_pk_bf16_f32 v22, v132, v133
v_mfma_f32_16x16x32_bf16 a[212:215], v[36:39], v[212:215], a[212:215]
v_cvt_pk_bf16_f32 v23, v134, v135
buffer_store_dwordx4 v[20:23], v248, s[20:23], s44 offen offset:1024 sc1
v_mfma_f32_16x16x32_bf16 a[216:219], v[68:71], v[212:215], a[216:219]
ds_write_b128 v253, v[20:23] offset:5120
v_accvgpr_read_b32 v140, a180
v_mfma_f32_16x16x32_bf16 a[220:223], v[100:103], v[212:215], a[220:223]
ds_read_b64_tr_b16 v[212:213], v15 offset:12288
s_waitcnt lgkmcnt(5)
v_mfma_f32_16x16x32_bf16 a[208:211], v[8:11], v[216:219], a[208:211]
ds_read_b64_tr_b16 v[214:215], v15 offset:14336
v_accvgpr_read_b32 v141, a181
v_mfma_f32_16x16x32_bf16 a[212:215], v[40:43], v[216:219], a[212:215]
v_accvgpr_read_b32 v142, a182
v_accvgpr_read_b32 v143, a183
v_mfma_f32_16x16x32_bf16 a[216:219], v[72:75], v[216:219], a[216:219]
v_cvt_pk_bf16_f32 v54, v140, v141
v_cvt_pk_bf16_f32 v55, v142, v143
v_mfma_f32_16x16x32_bf16 a[220:223], v[104:107], v[216:219], a[220:223]
ds_read_b64_tr_b16 v[216:217], v249 offset:12800
s_waitcnt lgkmcnt(5)
v_mfma_f32_16x16x32_bf16 a[208:211], v[160:163], v[220:223], a[208:211]
ds_read_b64_tr_b16 v[218:219], v249 offset:14848
buffer_store_dwordx4 v[52:55], v248, s[20:23], s45 offen offset:1024 sc1
v_mfma_f32_16x16x32_bf16 a[212:215], v[164:167], v[220:223], a[212:215]
v_accvgpr_read_b32 v148, a184
v_accvgpr_read_b32 v149, a185
v_mfma_f32_16x16x32_bf16 a[216:219], v[168:171], v[220:223], a[216:219]
v_accvgpr_read_b32 v150, a186
v_accvgpr_read_b32 v151, a187
v_mfma_f32_16x16x32_bf16 a[220:223], v[172:175], v[220:223], a[220:223]
ds_read_b64_tr_b16 v[220:221], v249 offset:29184
s_waitcnt lgkmcnt(5)
v_mfma_f32_16x16x32_bf16 a[208:211], v[176:179], v[208:211], a[208:211]
ds_read_b64_tr_b16 v[222:223], v249 offset:31232
v_cvt_pk_bf16_f32 v86, v148, v149
v_mfma_f32_16x16x32_bf16 a[212:215], v[180:183], v[208:211], a[212:215]
v_cvt_pk_bf16_f32 v87, v150, v151
buffer_store_dwordx4 v[84:87], v248, s[20:23], s46 offen offset:1024 sc1
v_mfma_f32_16x16x32_bf16 a[216:219], v[184:187], v[208:211], a[216:219]
v_accvgpr_read_b32 v156, a188
v_accvgpr_read_b32 v157, a189
v_mfma_f32_16x16x32_bf16 a[220:223], v[188:191], v[208:211], a[220:223]
ds_read_b64_tr_b16 v[208:209], v12 offset:12800
s_waitcnt lgkmcnt(5)
v_mfma_f32_16x16x32_bf16 a[208:211], v[0:3], v[212:215], a[208:211]
ds_read_b64_tr_b16 v[210:211], v12 offset:14848
v_accvgpr_read_b32 v158, a190
v_mfma_f32_16x16x32_bf16 a[212:215], v[32:35], v[212:215], a[212:215]
v_accvgpr_read_b32 v159, a191
v_cvt_pk_bf16_f32 v118, v156, v157
v_mfma_f32_16x16x32_bf16 a[216:219], v[64:67], v[212:215], a[216:219]
v_cvt_pk_bf16_f32 v119, v158, v159
buffer_store_dwordx4 v[116:119], v248, s[20:23], s47 offen offset:1024 sc1
v_mfma_f32_16x16x32_bf16 a[220:223], v[96:99], v[212:215], a[220:223]
ds_read_b64_tr_b16 v[212:213], v12 offset:29184
s_waitcnt lgkmcnt(5)
v_mfma_f32_16x16x32_bf16 a[224:227], v[4:7], v[216:219], a[224:227]
ds_read_b64_tr_b16 v[214:215], v12 offset:31232
v_accvgpr_read_b32 v128, a192
v_mfma_f32_16x16x32_bf16 a[228:231], v[36:39], v[216:219], a[228:231]
v_accvgpr_read_b32 v129, a193
v_accvgpr_read_b32 v130, a194
v_mfma_f32_16x16x32_bf16 a[232:235], v[68:71], v[216:219], a[232:235]
v_accvgpr_read_b32 v131, a195
v_cvt_pk_bf16_f32 v24, v128, v129
v_mfma_f32_16x16x32_bf16 a[236:239], v[100:103], v[216:219], a[236:239]
ds_read_b64_tr_b16 v[216:217], v14 offset:12800
s_waitcnt lgkmcnt(5)
v_mfma_f32_16x16x32_bf16 a[224:227], v[8:11], v[220:223], a[224:227]
ds_read_b64_tr_b16 v[218:219], v14 offset:14848
v_cvt_pk_bf16_f32 v25, v130, v131
v_mfma_f32_16x16x32_bf16 a[228:231], v[40:43], v[220:223], a[228:231]
v_accvgpr_read_b32 v136, a196
v_accvgpr_read_b32 v137, a197
v_mfma_f32_16x16x32_bf16 a[232:235], v[72:75], v[220:223], a[232:235]
v_accvgpr_read_b32 v138, a198
v_accvgpr_read_b32 v139, a199
v_mfma_f32_16x16x32_bf16 a[236:239], v[104:107], v[220:223], a[236:239]
ds_read_b64_tr_b16 v[220:221], v250 offset:12800
s_waitcnt lgkmcnt(5)
v_mfma_f32_16x16x32_bf16 a[224:227], v[160:163], v[208:211], a[224:227]
ds_read_b64_tr_b16 v[222:223], v250 offset:14848
v_cvt_pk_bf16_f32 v56, v136, v137
v_mfma_f32_16x16x32_bf16 a[228:231], v[164:167], v[208:211], a[228:231]
v_cvt_pk_bf16_f32 v57, v138, v139
v_accvgpr_read_b32 v144, a200
v_mfma_f32_16x16x32_bf16 a[232:235], v[168:171], v[208:211], a[232:235]
v_accvgpr_read_b32 v145, a201
v_accvgpr_read_b32 v146, a202
v_mfma_f32_16x16x32_bf16 a[236:239], v[172:175], v[208:211], a[236:239]
ds_read_b64_tr_b16 v[208:209], v250 offset:29184
s_waitcnt lgkmcnt(5)
v_mfma_f32_16x16x32_bf16 a[224:227], v[176:179], v[212:215], a[224:227]
ds_read_b64_tr_b16 v[210:211], v250 offset:31232
v_accvgpr_read_b32 v147, a203
v_mfma_f32_16x16x32_bf16 a[228:231], v[180:183], v[212:215], a[228:231]
v_cvt_pk_bf16_f32 v88, v144, v145
v_cvt_pk_bf16_f32 v89, v146, v147
v_mfma_f32_16x16x32_bf16 a[232:235], v[184:187], v[212:215], a[232:235]
v_accvgpr_read_b32 v152, a204
v_accvgpr_read_b32 v153, a205
v_mfma_f32_16x16x32_bf16 a[236:239], v[188:191], v[212:215], a[236:239]
ds_read_b64_tr_b16 v[212:213], v13 offset:12800
s_waitcnt lgkmcnt(5)
v_mfma_f32_16x16x32_bf16 a[224:227], v[0:3], v[216:219], a[224:227]
ds_read_b64_tr_b16 v[214:215], v13 offset:14848
v_accvgpr_read_b32 v154, a206
v_mfma_f32_16x16x32_bf16 a[228:231], v[32:35], v[216:219], a[228:231]
v_accvgpr_read_b32 v155, a207
v_cvt_pk_bf16_f32 v120, v152, v153
v_mfma_f32_16x16x32_bf16 a[232:235], v[64:67], v[216:219], a[232:235]
v_cvt_pk_bf16_f32 v121, v154, v155
v_accvgpr_read_b32 v132, a208
v_mfma_f32_16x16x32_bf16 a[236:239], v[96:99], v[216:219], a[236:239]
ds_read_b64_tr_b16 v[216:217], v13 offset:29184
s_waitcnt lgkmcnt(5)
v_mfma_f32_16x16x32_bf16 a[240:243], v[4:7], v[220:223], a[240:243]
ds_read_b64_tr_b16 v[218:219], v13 offset:31232
v_accvgpr_read_b32 v133, a209
v_mfma_f32_16x16x32_bf16 a[244:247], v[36:39], v[220:223], a[244:247]
v_accvgpr_read_b32 v134, a210
v_accvgpr_read_b32 v135, a211
v_mfma_f32_16x16x32_bf16 a[248:251], v[68:71], v[220:223], a[248:251]
v_cvt_pk_bf16_f32 v26, v132, v133
v_cvt_pk_bf16_f32 v27, v134, v135
v_mfma_f32_16x16x32_bf16 a[252:255], v[100:103], v[220:223], a[252:255]
ds_read_b64_tr_b16 v[220:221], v15 offset:12800
s_waitcnt lgkmcnt(5)
v_mfma_f32_16x16x32_bf16 a[240:243], v[8:11], v[208:211], a[240:243]
ds_read_b64_tr_b16 v[222:223], v15 offset:14848
buffer_store_dwordx4 v[24:27], v248, s[20:23], s44 offen offset:2048 sc1
v_mfma_f32_16x16x32_bf16 a[244:247], v[40:43], v[208:211], a[244:247]
ds_write_b128 v253, v[24:27] offset:6144
v_accvgpr_read_b32 v140, a212
v_mfma_f32_16x16x32_bf16 a[248:251], v[72:75], v[208:211], a[248:251]
v_accvgpr_read_b32 v141, a213
v_accvgpr_read_b32 v142, a214
v_mfma_f32_16x16x32_bf16 a[252:255], v[104:107], v[208:211], a[252:255]
s_waitcnt lgkmcnt(4)
v_accvgpr_read_b32 v143, a215
v_mfma_f32_16x16x32_bf16 a[240:243], v[160:163], v[212:215], a[240:243]
v_cvt_pk_bf16_f32 v58, v140, v141
v_cvt_pk_bf16_f32 v59, v142, v143
v_mfma_f32_16x16x32_bf16 a[244:247], v[164:167], v[212:215], a[244:247]
buffer_store_dwordx4 v[56:59], v248, s[20:23], s45 offen offset:2048 sc1
v_accvgpr_read_b32 v148, a216
v_mfma_f32_16x16x32_bf16 a[248:251], v[168:171], v[212:215], a[248:251]
v_accvgpr_read_b32 v149, a217
v_accvgpr_read_b32 v150, a218
v_mfma_f32_16x16x32_bf16 a[252:255], v[172:175], v[212:215], a[252:255]
s_waitcnt lgkmcnt(2)
v_accvgpr_read_b32 v151, a219
v_mfma_f32_16x16x32_bf16 a[240:243], v[176:179], v[216:219], a[240:243]
v_cvt_pk_bf16_f32 v90, v148, v149
v_cvt_pk_bf16_f32 v91, v150, v151
v_mfma_f32_16x16x32_bf16 a[244:247], v[180:183], v[216:219], a[244:247]
buffer_store_dwordx4 v[88:91], v248, s[20:23], s46 offen offset:2048 sc1
v_accvgpr_read_b32 v156, a220
v_mfma_f32_16x16x32_bf16 a[248:251], v[184:187], v[216:219], a[248:251]
v_accvgpr_read_b32 v157, a221
v_accvgpr_read_b32 v158, a222
v_mfma_f32_16x16x32_bf16 a[252:255], v[188:191], v[216:219], a[252:255]
s_waitcnt lgkmcnt(0)
v_accvgpr_read_b32 v159, a223
v_mfma_f32_16x16x32_bf16 a[240:243], v[0:3], v[220:223], a[240:243]
v_cvt_pk_bf16_f32 v122, v156, v157
v_cvt_pk_bf16_f32 v123, v158, v159
v_mfma_f32_16x16x32_bf16 a[244:247], v[32:35], v[220:223], a[244:247]
buffer_store_dwordx4 v[120:123], v248, s[20:23], s47 offen offset:2048 sc1
v_accvgpr_read_b32 v128, a224
v_mfma_f32_16x16x32_bf16 a[248:251], v[64:67], v[220:223], a[248:251]
v_accvgpr_read_b32 v129, a225
v_accvgpr_read_b32 v130, a226
v_mfma_f32_16x16x32_bf16 a[252:255], v[96:99], v[220:223], a[252:255]
v_accvgpr_read_b32 v131, a227
v_cvt_pk_bf16_f32 v28, v128, v129
v_cvt_pk_bf16_f32 v29, v130, v131
v_accvgpr_read_b32 v136, a228
v_accvgpr_read_b32 v137, a229
v_accvgpr_read_b32 v138, a230
v_accvgpr_read_b32 v139, a231
v_cvt_pk_bf16_f32 v60, v136, v137
v_cvt_pk_bf16_f32 v61, v138, v139
v_accvgpr_read_b32 v144, a232
v_accvgpr_read_b32 v145, a233
v_accvgpr_read_b32 v146, a234
v_accvgpr_read_b32 v147, a235
v_cvt_pk_bf16_f32 v92, v144, v145
v_cvt_pk_bf16_f32 v93, v146, v147
v_accvgpr_read_b32 v152, a236
v_accvgpr_read_b32 v153, a237
v_accvgpr_read_b32 v154, a238
v_accvgpr_read_b32 v155, a239
v_cvt_pk_bf16_f32 v124, v152, v153
v_cvt_pk_bf16_f32 v125, v154, v155
v_accvgpr_read_b32 v132, a240
v_accvgpr_read_b32 v133, a241
v_accvgpr_read_b32 v134, a242
v_accvgpr_read_b32 v135, a243
v_cvt_pk_bf16_f32 v30, v132, v133
v_cvt_pk_bf16_f32 v31, v134, v135
buffer_store_dwordx4 v[28:31], v248, s[20:23], s44 offen offset:3072 sc1
ds_write_b128 v253, v[28:31] offset:7168
v_accvgpr_read_b32 v140, a244
v_accvgpr_read_b32 v141, a245
v_accvgpr_read_b32 v142, a246
v_accvgpr_read_b32 v143, a247
v_cvt_pk_bf16_f32 v62, v140, v141
v_cvt_pk_bf16_f32 v63, v142, v143
buffer_store_dwordx4 v[60:63], v248, s[20:23], s45 offen offset:3072 sc1
v_accvgpr_read_b32 v148, a248
v_accvgpr_read_b32 v149, a249
v_accvgpr_read_b32 v150, a250
v_accvgpr_read_b32 v151, a251
v_cvt_pk_bf16_f32 v94, v148, v149
v_cvt_pk_bf16_f32 v95, v150, v151
buffer_store_dwordx4 v[92:95], v248, s[20:23], s46 offen offset:3072 sc1
v_accvgpr_read_b32 v156, a252
v_accvgpr_read_b32 v157, a253
v_accvgpr_read_b32 v158, a254
v_accvgpr_read_b32 v159, a255
v_cvt_pk_bf16_f32 v126, v156, v157
v_cvt_pk_bf16_f32 v127, v158, v159
buffer_store_dwordx4 v[124:127], v248, s[20:23], s47 offen offset:3072 sc1
s_waitcnt vmcnt(36)
s_branch L2_F
L2_tail_1:
s_waitcnt lgkmcnt(6)
v_mfma_f32_16x16x32_bf16 a[0:3], v[176:179], v[208:211], a[0:3]
s_mov_b32 m0, s30
v_mfma_f32_16x16x32_bf16 a[4:7], v[180:183], v[208:211], a[4:7]
buffer_load_dwordx4 v241, s[12:15], s28 offen offset:0 sc1 lds
v_add_u32 v253, s50, v248
v_mfma_f32_16x16x32_bf16 a[8:11], v[184:187], v[208:211], a[8:11]
buffer_load_dwordx4 v241, s[12:15], s28 offen offset:1024 sc1 lds
v_mfma_f32_16x16x32_bf16 a[12:15], v[188:191], v[208:211], a[12:15]
ds_read_b128 v[208:211], v240 offset:2048
s_waitcnt lgkmcnt(5)
buffer_load_dwordx4 v241, s[12:15], s28 offen offset:2048 sc1 lds
v_mfma_f32_16x16x32_bf16 a[16:19], v[176:179], v[212:215], a[16:19]
buffer_load_dwordx4 v241, s[12:15], s28 offen offset:3072 sc1 lds
v_mfma_f32_16x16x32_bf16 a[20:23], v[180:183], v[212:215], a[20:23]
s_add_u32 s28, s28, s101
s_add_u32 s30, s30, 0x4000
s_and_b32 s30, s30, 0x1ffff
v_mfma_f32_16x16x32_bf16 a[24:27], v[184:187], v[212:215], a[24:27]
s_mov_b32 m0, s30
v_mfma_f32_16x16x32_bf16 a[28:31], v[188:191], v[212:215], a[28:31]
ds_read_b128 v[212:215], v240 offset:2560
s_waitcnt lgkmcnt(4)
buffer_load_dwordx4 v241, s[12:15], s28 offen offset:0 sc1 lds
v_mfma_f32_16x16x32_bf16 a[32:35], v[176:179], v[216:219], a[32:35]
buffer_load_dwordx4 v241, s[12:15], s28 offen offset:1024 sc1 lds
v_mfma_f32_16x16x32_bf16 a[36:39], v[180:183], v[216:219], a[36:39]
buffer_load_dwordx4 v241, s[12:15], s28 offen offset:2048 sc1 lds
v_mfma_f32_16x16x32_bf16 a[40:43], v[184:187], v[216:219], a[40:43]
buffer_load_dwordx4 v241, s[12:15], s28 offen offset:3072 sc1 lds
v_mfma_f32_16x16x32_bf16 a[44:47], v[188:191], v[216:219], a[44:47]
ds_read_b128 v[216:219], v240 offset:6144
s_waitcnt lgkmcnt(3)
v_mfma_f32_16x16x32_bf16 a[48:51], v[176:179], v[220:223], a[48:51]
v_exp_f32 v232, v128
s_and_b32 s30, s30, 0x1c000
v_mfma_f32_16x16x32_bf16 a[52:55], v[180:183], v[220:223], a[52:55]
v_add_u32 v251, 0x8000, v240
v_and_b32 v251, 0x1ffff, v251
s_add_u32 s28, s30, 0xc000
v_mfma_f32_16x16x32_bf16 a[56:59], v[184:187], v[220:223], a[56:59]
v_exp_f32 v233, v129
s_and_b32 s28, s28, 0x1ffff
v_mfma_f32_16x16x32_bf16 a[60:63], v[188:191], v[220:223], a[60:63]
ds_read_b128 v[220:223], v240 offset:6656
s_waitcnt lgkmcnt(3)
s_add_u32 s30, s30, 0x4000
v_mfma_f32_16x16x32_bf16 v[144:147], v[208:211], v[0:3], v[192:195]
ds_write_b128 v253, v[176:179] offset:0
s_and_b32 s30, s30, 0x1ffff
s_mul_i32 s31, s34, 6144
v_mfma_f32_16x16x32_bf16 v[148:151], v[208:211], v[32:35], v[196:199]
ds_write_b128 v253, v[180:183] offset:1024
s_add_u32 s31, s31, s30
s_lshl_b32 s3, s34, 10
v_mfma_f32_16x16x32_bf16 v[152:155], v[208:211], v[64:67], v[200:203]
ds_write_b128 v253, v[184:187] offset:2048
s_add_u32 s28, s28, s3
s_add_u32 s3, s3, 24576
v_mfma_f32_16x16x32_bf16 v[156:159], v[208:211], v[96:99], v[204:207]
ds_read_b128 v[208:211], v240 offset:10240
s_waitcnt lgkmcnt(3)
ds_write_b128 v253, v[188:191] offset:3072
v_mfma_f32_16x16x32_bf16 v[144:147], v[212:215], v[4:7], v[144:147]
v_exp_f32 v234, v130
s_add_u32 s30, s30, s3
v_mfma_f32_16x16x32_bf16 v[148:151], v[212:215], v[36:39], v[148:151]
v_add_f32 v228, v224, v232
v_cvt_pk_bf16_f32 v160, v232, v233
v_lshrrev_b32 v241, 4, v248
v_mfma_f32_16x16x32_bf16 v[152:155], v[212:215], v[68:71], v[152:155]
v_exp_f32 v235, v131
v_and_b32 v241, 0x30, v241
v_mfma_f32_16x16x32_bf16 v[156:159], v[212:215], v[100:103], v[156:159]
ds_read_b128 v[212:215], v240 offset:10752
s_waitcnt lgkmcnt(3)
v_xor_b32 v241, v241, v248
v_mfma_f32_16x16x32_bf16 v[144:147], v[216:219], v[8:11], v[144:147]
v_add_f32 v228, v228, v233
v_add_f32 v228, v228, v234
v_mfma_f32_16x16x32_bf16 v[148:151], v[216:219], v[40:43], v[148:151]
v_add_f32 v228, v228, v235
v_cvt_pk_bf16_f32 v161, v234, v235
v_mfma_f32_16x16x32_bf16 v[152:155], v[216:219], v[72:75], v[152:155]
v_exp_f32 v236, v132
v_mfma_f32_16x16x32_bf16 v[156:159], v[216:219], v[104:107], v[156:159]
ds_read_b128 v[216:219], v240 offset:14336
s_waitcnt lgkmcnt(3)
v_mfma_f32_16x16x32_bf16 v[144:147], v[220:223], v[12:15], v[144:147]
v_exp_f32 v237, v133
v_mfma_f32_16x16x32_bf16 v[148:151], v[220:223], v[44:47], v[148:151]
v_exp_f32 v238, v134
v_mfma_f32_16x16x32_bf16 v[152:155], v[220:223], v[76:79], v[152:155]
v_add_f32 v229, v225, v236
v_cvt_pk_bf16_f32 v164, v236, v237
v_mfma_f32_16x16x32_bf16 v[156:159], v[220:223], v[108:111], v[156:159]
ds_read_b128 v[220:223], v240 offset:14848
s_waitcnt lgkmcnt(3)
v_mfma_f32_16x16x32_bf16 v[144:147], v[208:211], v[16:19], v[144:147]
v_exp_f32 v239, v135
v_and_b32 v243, 0x380, v248
v_mad_u32_u24 v241, v243, 3, v241
v_mfma_f32_16x16x32_bf16 v[148:151], v[208:211], v[48:51], v[148:151]
s_waitcnt vmcnt(8)
s_barrier
v_mfma_f32_16x16x32_bf16 v[152:155], v[208:211], v[80:83], v[152:155]
v_add_f32 v229, v229, v237
v_add_f32 v229, v229, v238
v_mfma_f32_16x16x32_bf16 v[156:159], v[208:211], v[112:115], v[156:159]
ds_read_b128 v[208:211], v240 offset:16384
s_waitcnt lgkmcnt(3)
v_mfma_f32_16x16x32_bf16 v[144:147], v[212:215], v[20:23], v[144:147]
v_add_f32 v229, v229, v239
v_cvt_pk_bf16_f32 v165, v238, v239
v_mfma_f32_16x16x32_bf16 v[148:151], v[212:215], v[52:55], v[148:151]
v_exp_f32 v232, v136
v_mfma_f32_16x16x32_bf16 v[152:155], v[212:215], v[84:87], v[152:155]
v_exp_f32 v233, v137
v_mfma_f32_16x16x32_bf16 v[156:159], v[212:215], v[116:119], v[156:159]
ds_read_b128 v[212:215], v240 offset:16896
s_waitcnt lgkmcnt(3)
v_mfma_f32_16x16x32_bf16 v[144:147], v[216:219], v[24:27], v[144:147]
v_exp_f32 v234, v138
v_mfma_f32_16x16x32_bf16 v[148:151], v[216:219], v[56:59], v[148:151]
v_add_f32 v230, v226, v232
v_cvt_pk_bf16_f32 v168, v232, v233
v_mfma_f32_16x16x32_bf16 v[152:155], v[216:219], v[88:91], v[152:155]
v_exp_f32 v235, v139
v_mfma_f32_16x16x32_bf16 v[156:159], v[216:219], v[120:123], v[156:159]
ds_read_b128 v[216:219], v240 offset:20480
s_waitcnt lgkmcnt(3)
v_mfma_f32_16x16x32_bf16 v[144:147], v[220:223], v[28:31], v[144:147]
v_add_f32 v230, v230, v233
v_add_f32 v230, v230, v234
v_mfma_f32_16x16x32_bf16 v[148:151], v[220:223], v[60:63], v[148:151]
v_add_f32 v230, v230, v235
v_cvt_pk_bf16_f32 v169, v234, v235
v_mfma_f32_16x16x32_bf16 v[152:155], v[220:223], v[92:95], v[152:155]
v_exp_f32 v236, v140
v_mfma_f32_16x16x32_bf16 v[156:159], v[220:223], v[124:127], v[156:159]
ds_read_b128 v[220:223], v240 offset:20992
s_waitcnt lgkmcnt(3)
v_exp_f32 v237, v141
v_exp_f32 v238, v142
v_add_f32 v231, v227, v236
v_cvt_pk_bf16_f32 v172, v236, v237
v_exp_f32 v239, v143
v_add_f32 v231, v231, v237
v_add_f32 v231, v231, v238
v_add_f32 v231, v231, v239
v_cvt_pk_bf16_f32 v173, v238, v239
v_max3_f32 v242, v228, v229, v230
v_max_f32 v242, v242, v231
v_cmp_lt_f32 vcc, s32, v242
s_cbranch_vccnz L2_rare_site12
L2_ret12:
v_mfma_f32_16x16x32_bf16 v[128:131], v[208:211], v[0:3], v[192:195]
s_add_u32 m0, s31, 0
v_mfma_f32_16x16x32_bf16 v[132:135], v[208:211], v[32:35], v[196:199]
v_exp_f32 v232, v144
v_mfma_f32_16x16x32_bf16 v[136:139], v[208:211], v[64:67], v[200:203]
v_exp_f32 v233, v145
v_mfma_f32_16x16x32_bf16 v[140:143], v[208:211], v[96:99], v[204:207]
ds_read_b128 v[208:211], v240 offset:24576
s_waitcnt lgkmcnt(3)
v_mfma_f32_16x16x32_bf16 v[128:131], v[212:215], v[4:7], v[128:131]
v_exp_f32 v234, v146
v_add_f32 v224, v228, v232
v_mfma_f32_16x16x32_bf16 v[132:135], v[212:215], v[36:39], v[132:135]
v_cvt_pk_bf16_f32 v162, v232, v233
v_exp_f32 v235, v147
v_mfma_f32_16x16x32_bf16 v[136:139], v[212:215], v[68:71], v[136:139]
v_add_f32 v224, v224, v233
v_add_f32 v224, v224, v234
v_add_f32 v224, v224, v235
v_mfma_f32_16x16x32_bf16 v[140:143], v[212:215], v[100:103], v[140:143]
ds_read_b128 v[212:215], v240 offset:25088
s_waitcnt lgkmcnt(3)
v_cvt_pk_bf16_f32 v163, v234, v235
v_mfma_f32_16x16x32_bf16 v[128:131], v[216:219], v[8:11], v[128:131]
v_exp_f32 v236, v148
v_mfma_f32_16x16x32_bf16 v[132:135], v[216:219], v[40:43], v[132:135]
v_exp_f32 v237, v149
v_mfma_f32_16x16x32_bf16 v[136:139], v[216:219], v[72:75], v[136:139]
v_exp_f32 v238, v150
v_add_f32 v225, v229, v236
v_mfma_f32_16x16x32_bf16 v[140:143], v[216:219], v[104:107], v[140:143]
ds_read_b128 v[216:219], v240 offset:28672
s_waitcnt lgkmcnt(3)
v_cvt_pk_bf16_f32 v166, v236, v237
v_mfma_f32_16x16x32_bf16 v[128:131], v[220:223], v[12:15], v[128:131]
v_exp_f32 v239, v151
v_add_f32 v225, v225, v237
v_mfma_f32_16x16x32_bf16 v[132:135], v[220:223], v[44:47], v[132:135]
v_add_f32 v225, v225, v238
v_add_f32 v225, v225, v239
v_cvt_pk_bf16_f32 v167, v238, v239
v_mfma_f32_16x16x32_bf16 v[136:139], v[220:223], v[76:79], v[136:139]
v_exp_f32 v232, v152
v_mfma_f32_16x16x32_bf16 v[140:143], v[220:223], v[108:111], v[140:143]
ds_read_b128 v[220:223], v240 offset:29184
s_waitcnt lgkmcnt(3)
v_mfma_f32_16x16x32_bf16 v[128:131], v[208:211], v[16:19], v[128:131]
v_exp_f32 v233, v153
v_mfma_f32_16x16x32_bf16 v[132:135], v[208:211], v[48:51], v[132:135]
v_exp_f32 v234, v154
v_add_f32 v226, v230, v232
v_mfma_f32_16x16x32_bf16 v[136:139], v[208:211], v[80:83], v[136:139]
v_cvt_pk_bf16_f32 v170, v232, v233
v_exp_f32 v235, v155
v_mfma_f32_16x16x32_bf16 v[140:143], v[208:211], v[112:115], v[140:143]
ds_read_b128 v[208:211], v240 offset:18432
s_waitcnt lgkmcnt(3)
v_add_f32 v226, v226, v233
v_mfma_f32_16x16x32_bf16 v[128:131], v[212:215], v[20:23], v[128:131]
v_add_f32 v226, v226, v234
v_add_f32 v226, v226, v235
v_cvt_pk_bf16_f32 v171, v234, v235
v_mfma_f32_16x16x32_bf16 v[132:135], v[212:215], v[52:55], v[132:135]
v_exp_f32 v236, v156
v_mfma_f32_16x16x32_bf16 v[136:139], v[212:215], v[84:87], v[136:139]
v_exp_f32 v237, v157
v_mfma_f32_16x16x32_bf16 v[140:143], v[212:215], v[116:119], v[140:143]
ds_read_b128 v[212:215], v240 offset:18944
s_waitcnt lgkmcnt(3)
v_mfma_f32_16x16x32_bf16 v[128:131], v[216:219], v[24:27], v[128:131]
v_exp_f32 v238, v158
v_add_f32 v227, v231, v236
v_mfma_f32_16x16x32_bf16 v[132:135], v[216:219], v[56:59], v[132:135]
v_cvt_pk_bf16_f32 v174, v236, v237
v_exp_f32 v239, v159
v_mfma_f32_16x16x32_bf16 v[136:139], v[216:219], v[88:91], v[136:139]
v_add_f32 v227, v227, v237
v_add_f32 v227, v227, v238
v_add_f32 v227, v227, v239
v_mfma_f32_16x16x32_bf16 v[140:143], v[216:219], v[120:123], v[140:143]
ds_read_b128 v[216:219], v240 offset:22528
s_waitcnt lgkmcnt(3)
v_cvt_pk_bf16_f32 v175, v238, v239
v_mfma_f32_16x16x32_bf16 v[128:131], v[220:223], v[28:31], v[128:131]
v_max3_f32 v242, v224, v225, v226
v_max_f32 v242, v242, v227
v_cmp_lt_f32 vcc, s32, v242
s_cbranch_vccnz L2_rare_site13
L2_ret13:
v_mfma_f32_16x16x32_bf16 v[132:135], v[220:223], v[60:63], v[132:135]
buffer_load_dwordx4 v241, s[8:11], s6 offen lds
s_add_u32 m0, s31, 2048
v_mfma_f32_16x16x32_bf16 v[136:139], v[220:223], v[92:95], v[136:139]
buffer_load_dwordx4 v241, s[8:11], s7 offen lds
s_add_u32 m0, s31, 4096
v_mfma_f32_16x16x32_bf16 v[140:143], v[220:223], v[124:127], v[140:143]
ds_read_b128 v[220:223], v240 offset:23040
s_waitcnt lgkmcnt(3)
v_mfma_f32_16x16x32_bf16 v[144:147], v[208:211], v[0:3], v[192:195]
ds_write_b128 v253, v[160:163] offset:4096
buffer_load_dwordx4 v241, s[8:11], s29 offen lds
s_add_u32 m0, s31, 1024
v_mfma_f32_16x16x32_bf16 v[148:151], v[208:211], v[32:35], v[196:199]
ds_write_b128 v253, v[164:167] offset:5120
v_exp_f32 v232, v128
v_mfma_f32_16x16x32_bf16 v[152:155], v[208:211], v[64:67], v[200:203]
ds_write_b128 v253, v[168:171] offset:6144
v_exp_f32 v233, v129
v_mfma_f32_16x16x32_bf16 v[156:159], v[208:211], v[96:99], v[204:207]
ds_read_b128 v[208:211], v240 offset:26624
s_waitcnt lgkmcnt(3)
ds_write_b128 v253, v[172:175] offset:7168
v_mfma_f32_16x16x32_bf16 v[144:147], v[212:215], v[4:7], v[144:147]
v_exp_f32 v234, v130
v_add_f32 v228, v224, v232
v_mfma_f32_16x16x32_bf16 v[148:151], v[212:215], v[36:39], v[148:151]
v_cvt_pk_bf16_f32 v176, v232, v233
v_exp_f32 v235, v131
v_mfma_f32_16x16x32_bf16 v[152:155], v[212:215], v[68:71], v[152:155]
v_add_f32 v228, v228, v233
v_add_f32 v228, v228, v234
v_add_f32 v228, v228, v235
v_mfma_f32_16x16x32_bf16 v[156:159], v[212:215], v[100:103], v[156:159]
ds_read_b128 v[212:215], v240 offset:27136
s_waitcnt lgkmcnt(3)
v_cvt_pk_bf16_f32 v177, v234, v235
v_mfma_f32_16x16x32_bf16 v[144:147], v[216:219], v[8:11], v[144:147]
v_exp_f32 v236, v132
v_xor_b32 v241, 0x1040, v241
v_mfma_f32_16x16x32_bf16 v[148:151], v[216:219], v[40:43], v[148:151]
v_exp_f32 v237, v133
v_mfma_f32_16x16x32_bf16 v[152:155], v[216:219], v[72:75], v[152:155]
v_exp_f32 v238, v134
v_add_f32 v229, v225, v236
v_mfma_f32_16x16x32_bf16 v[156:159], v[216:219], v[104:107], v[156:159]
ds_read_b128 v[216:219], v240 offset:30720
s_waitcnt lgkmcnt(3)
v_cvt_pk_bf16_f32 v180, v236, v237
v_mfma_f32_16x16x32_bf16 v[144:147], v[220:223], v[12:15], v[144:147]
v_exp_f32 v239, v135
v_add_f32 v229, v229, v237
v_mfma_f32_16x16x32_bf16 v[148:151], v[220:223], v[44:47], v[148:151]
v_add_f32 v229, v229, v238
v_add_f32 v229, v229, v239
v_cvt_pk_bf16_f32 v181, v238, v239
v_mfma_f32_16x16x32_bf16 v[152:155], v[220:223], v[76:79], v[152:155]
v_exp_f32 v232, v136
v_mfma_f32_16x16x32_bf16 v[156:159], v[220:223], v[108:111], v[156:159]
ds_read_b128 v[220:223], v240 offset:31232
s_waitcnt lgkmcnt(3)
v_mfma_f32_16x16x32_bf16 v[144:147], v[208:211], v[16:19], v[144:147]
v_exp_f32 v233, v137
v_mfma_f32_16x16x32_bf16 v[148:151], v[208:211], v[48:51], v[148:151]
s_waitcnt vmcnt(7)
s_barrier
v_mfma_f32_16x16x32_bf16 v[152:155], v[208:211], v[80:83], v[152:155]
v_exp_f32 v234, v138
v_add_f32 v230, v226, v232
v_mfma_f32_16x16x32_bf16 v[156:159], v[208:211], v[112:115], v[156:159]
ds_read_b128 v[208:211], v251 offset:0
s_waitcnt lgkmcnt(3)
v_cvt_pk_bf16_f32 v184, v232, v233
v_mfma_f32_16x16x32_bf16 v[144:147], v[212:215], v[20:23], v[144:147]
v_exp_f32 v235, v139
v_add_f32 v230, v230, v233
v_mfma_f32_16x16x32_bf16 v[148:151], v[212:215], v[52:55], v[148:151]
v_add_f32 v230, v230, v234
v_add_f32 v230, v230, v235
v_cvt_pk_bf16_f32 v185, v234, v235
v_mfma_f32_16x16x32_bf16 v[152:155], v[212:215], v[84:87], v[152:155]
v_exp_f32 v236, v140
v_mfma_f32_16x16x32_bf16 v[156:159], v[212:215], v[116:119], v[156:159]
ds_read_b128 v[212:215], v251 offset:512
s_waitcnt lgkmcnt(3)
v_mfma_f32_16x16x32_bf16 v[144:147], v[216:219], v[24:27], v[144:147]
v_exp_f32 v237, v141
v_mfma_f32_16x16x32_bf16 v[148:151], v[216:219], v[56:59], v[148:151]
v_exp_f32 v238, v142
v_add_f32 v231, v227, v236
v_mfma_f32_16x16x32_bf16 v[152:155], v[216:219], v[88:91], v[152:155]
v_cvt_pk_bf16_f32 v188, v236, v237
v_exp_f32 v239, v143
v_mfma_f32_16x16x32_bf16 v[156:159], v[216:219], v[120:123], v[156:159]
ds_read_b128 v[216:219], v251 offset:4096
s_waitcnt lgkmcnt(3)
v_add_f32 v231, v231, v237
v_mfma_f32_16x16x32_bf16 v[144:147], v[220:223], v[28:31], v[144:147]
v_add_f32 v231, v231, v238
v_add_f32 v231, v231, v239
v_cvt_pk_bf16_f32 v189, v238, v239
v_mfma_f32_16x16x32_bf16 v[148:151], v[220:223], v[60:63], v[148:151]
v_max3_f32 v242, v228, v229, v230
v_max_f32 v242, v242, v231
v_cmp_lt_f32 vcc, s32, v242
s_cbranch_vccnz L2_rare_site14
L2_ret14:
v_mfma_f32_16x16x32_bf16 v[152:155], v[220:223], v[92:95], v[152:155]
buffer_load_dwordx4 v241, s[8:11], s6 offen lds
s_add_u32 m0, s31, 3072
v_mfma_f32_16x16x32_bf16 v[156:159], v[220:223], v[124:127], v[156:159]
ds_read_b128 v[220:223], v251 offset:4608
s_waitcnt lgkmcnt(3)
v_mfma_f32_16x16x32_bf16 v[128:131], v[208:211], v[0:3], v[192:195]
buffer_load_dwordx4 v241, s[8:11], s7 offen lds
s_add_u32 m0, s31, 5120
v_mfma_f32_16x16x32_bf16 v[132:135], v[208:211], v[32:35], v[196:199]
v_exp_f32 v232, v144
v_mfma_f32_16x16x32_bf16 v[136:139], v[208:211], v[64:67], v[200:203]
v_exp_f32 v233, v145
v_mfma_f32_16x16x32_bf16 v[140:143], v[208:211], v[96:99], v[204:207]
ds_read_b128 v[208:211], v251 offset:8192
s_waitcnt lgkmcnt(3)
v_mfma_f32_16x16x32_bf16 v[128:131], v[212:215], v[4:7], v[128:131]
v_exp_f32 v234, v146
v_add_f32 v224, v228, v232
v_mfma_f32_16x16x32_bf16 v[132:135], v[212:215], v[36:39], v[132:135]
v_cvt_pk_bf16_f32 v178, v232, v233
v_exp_f32 v235, v147
v_mfma_f32_16x16x32_bf16 v[136:139], v[212:215], v[68:71], v[136:139]
v_add_f32 v224, v224, v233
v_add_f32 v224, v224, v234
v_add_f32 v224, v224, v235
v_mfma_f32_16x16x32_bf16 v[140:143], v[212:215], v[100:103], v[140:143]
ds_read_b128 v[212:215], v251 offset:8704
s_waitcnt lgkmcnt(3)
v_cvt_pk_bf16_f32 v179, v234, v235
v_mfma_f32_16x16x32_bf16 v[128:131], v[216:219], v[8:11], v[128:131]
v_exp_f32 v236, v148
v_mfma_f32_16x16x32_bf16 v[132:135], v[216:219], v[40:43], v[132:135]
v_exp_f32 v237, v149
v_mfma_f32_16x16x32_bf16 v[136:139], v[216:219], v[72:75], v[136:139]
v_exp_f32 v238, v150
v_add_f32 v225, v229, v236
v_mfma_f32_16x16x32_bf16 v[140:143], v[216:219], v[104:107], v[140:143]
ds_read_b128 v[216:219], v251 offset:12288
s_waitcnt lgkmcnt(3)
v_cvt_pk_bf16_f32 v182, v236, v237
v_mfma_f32_16x16x32_bf16 v[128:131], v[220:223], v[12:15], v[128:131]
v_exp_f32 v239, v151
v_add_f32 v225, v225, v237
v_mfma_f32_16x16x32_bf16 v[132:135], v[220:223], v[44:47], v[132:135]
v_add_f32 v225, v225, v238
v_add_f32 v225, v225, v239
v_cvt_pk_bf16_f32 v183, v238, v239
v_mfma_f32_16x16x32_bf16 v[136:139], v[220:223], v[76:79], v[136:139]
v_exp_f32 v232, v152
v_mfma_f32_16x16x32_bf16 v[140:143], v[220:223], v[108:111], v[140:143]
ds_read_b128 v[220:223], v251 offset:12800
s_waitcnt lgkmcnt(3)
v_mfma_f32_16x16x32_bf16 v[128:131], v[208:211], v[16:19], v[128:131]
v_exp_f32 v233, v153
v_mfma_f32_16x16x32_bf16 v[132:135], v[208:211], v[48:51], v[132:135]
v_exp_f32 v234, v154
v_add_f32 v226, v230, v232
v_mfma_f32_16x16x32_bf16 v[136:139], v[208:211], v[80:83], v[136:139]
v_cvt_pk_bf16_f32 v186, v232, v233
v_exp_f32 v235, v155
v_mfma_f32_16x16x32_bf16 v[140:143], v[208:211], v[112:115], v[140:143]
ds_read_b128 v[208:211], v251 offset:2048
s_waitcnt lgkmcnt(3)
v_add_f32 v226, v226, v233
v_mfma_f32_16x16x32_bf16 v[128:131], v[212:215], v[20:23], v[128:131]
v_add_f32 v226, v226, v234
v_add_f32 v226, v226, v235
v_cvt_pk_bf16_f32 v187, v234, v235
v_mfma_f32_16x16x32_bf16 v[132:135], v[212:215], v[52:55], v[132:135]
v_exp_f32 v236, v156
v_mfma_f32_16x16x32_bf16 v[136:139], v[212:215], v[84:87], v[136:139]
v_exp_f32 v237, v157
v_mfma_f32_16x16x32_bf16 v[140:143], v[212:215], v[116:119], v[140:143]
ds_read_b128 v[212:215], v251 offset:2560
s_waitcnt lgkmcnt(3)
v_mfma_f32_16x16x32_bf16 v[128:131], v[216:219], v[24:27], v[128:131]
v_exp_f32 v238, v158
v_add_f32 v227, v231, v236
v_mfma_f32_16x16x32_bf16 v[132:135], v[216:219], v[56:59], v[132:135]
v_cvt_pk_bf16_f32 v190, v236, v237
v_exp_f32 v239, v159
v_mfma_f32_16x16x32_bf16 v[136:139], v[216:219], v[88:91], v[136:139]
v_add_f32 v227, v227, v237
v_add_f32 v227, v227, v238
v_add_f32 v227, v227, v239
v_mfma_f32_16x16x32_bf16 v[140:143], v[216:219], v[120:123], v[140:143]
ds_read_b128 v[216:219], v251 offset:6144
s_waitcnt lgkmcnt(3)
v_cvt_pk_bf16_f32 v191, v238, v239
v_mfma_f32_16x16x32_bf16 v[128:131], v[220:223], v[28:31], v[128:131]
v_max3_f32 v242, v224, v225, v226
v_max_f32 v242, v242, v227
v_cmp_lt_f32 vcc, s32, v242
s_cbranch_vccnz L2_rare_site15
L2_ret15:
v_mfma_f32_16x16x32_bf16 v[132:135], v[220:223], v[60:63], v[132:135]
buffer_load_dwordx4 v241, s[8:11], s29 offen lds
v_mfma_f32_16x16x32_bf16 v[136:139], v[220:223], v[92:95], v[136:139]
v_mfma_f32_16x16x32_bf16 v[140:143], v[220:223], v[124:127], v[140:143]
ds_read_b128 v[220:223], v251 offset:6656
s_waitcnt lgkmcnt(3)
v_mfma_f32_16x16x32_bf16 v[144:147], v[208:211], v[0:3], v[192:195]
v_mfma_f32_16x16x32_bf16 v[148:151], v[208:211], v[32:35], v[196:199]
v_exp_f32 v232, v128
v_mfma_f32_16x16x32_bf16 v[152:155], v[208:211], v[64:67], v[200:203]
v_exp_f32 v233, v129
v_mfma_f32_16x16x32_bf16 v[156:159], v[208:211], v[96:99], v[204:207]
ds_read_b128 v[208:211], v251 offset:10240
s_waitcnt lgkmcnt(3)
v_mfma_f32_16x16x32_bf16 v[144:147], v[212:215], v[4:7], v[144:147]
v_exp_f32 v234, v130
v_add_f32 v228, v224, v232
v_mfma_f32_16x16x32_bf16 v[148:151], v[212:215], v[36:39], v[148:151]
v_cvt_pk_bf16_f32 v160, v232, v233
v_exp_f32 v235, v131
v_mfma_f32_16x16x32_bf16 v[152:155], v[212:215], v[68:71], v[152:155]
v_add_f32 v228, v228, v233
v_add_f32 v228, v228, v234
v_add_f32 v228, v228, v235
v_mfma_f32_16x16x32_bf16 v[156:159], v[212:215], v[100:103], v[156:159]
ds_read_b128 v[212:215], v251 offset:10752
s_waitcnt lgkmcnt(3)
v_cvt_pk_bf16_f32 v161, v234, v235
v_mfma_f32_16x16x32_bf16 v[144:147], v[216:219], v[8:11], v[144:147]
v_exp_f32 v236, v132
v_mfma_f32_16x16x32_bf16 v[148:151], v[216:219], v[40:43], v[148:151]
v_exp_f32 v237, v133
v_mfma_f32_16x16x32_bf16 v[152:155], v[216:219], v[72:75], v[152:155]
v_exp_f32 v238, v134
v_add_f32 v229, v225, v236
v_mfma_f32_16x16x32_bf16 v[156:159], v[216:219], v[104:107], v[156:159]
ds_read_b128 v[216:219], v251 offset:14336
s_waitcnt lgkmcnt(3)
v_cvt_pk_bf16_f32 v164, v236, v237
v_mfma_f32_16x16x32_bf16 v[144:147], v[220:223], v[12:15], v[144:147]
v_exp_f32 v239, v135
v_add_f32 v229, v229, v237
v_mfma_f32_16x16x32_bf16 v[148:151], v[220:223], v[44:47], v[148:151]
v_add_f32 v229, v229, v238
v_add_f32 v229, v229, v239
v_cvt_pk_bf16_f32 v165, v238, v239
v_mfma_f32_16x16x32_bf16 v[152:155], v[220:223], v[76:79], v[152:155]
v_exp_f32 v232, v136
v_mfma_f32_16x16x32_bf16 v[156:159], v[220:223], v[108:111], v[156:159]
ds_read_b128 v[220:223], v251 offset:14848
s_waitcnt lgkmcnt(3)
v_mfma_f32_16x16x32_bf16 v[144:147], v[208:211], v[16:19], v[144:147]
v_exp_f32 v233, v137
v_mfma_f32_16x16x32_bf16 v[148:151], v[208:211], v[48:51], v[148:151]
s_waitcnt vmcnt(6)
s_barrier
v_mfma_f32_16x16x32_bf16 v[152:155], v[208:211], v[80:83], v[152:155]
v_exp_f32 v234, v138
v_add_f32 v230, v226, v232
v_mfma_f32_16x16x32_bf16 v[156:159], v[208:211], v[112:115], v[156:159]
ds_read_b128 v[208:211], v251 offset:16384
s_waitcnt lgkmcnt(3)
v_cvt_pk_bf16_f32 v168, v232, v233
v_mfma_f32_16x16x32_bf16 v[144:147], v[212:215], v[20:23], v[144:147]
v_exp_f32 v235, v139
v_add_f32 v230, v230, v233
v_mfma_f32_16x16x32_bf16 v[148:151], v[212:215], v[52:55], v[148:151]
v_add_f32 v230, v230, v234
v_add_f32 v230, v230, v235
v_cvt_pk_bf16_f32 v169, v234, v235
v_mfma_f32_16x16x32_bf16 v[152:155], v[212:215], v[84:87], v[152:155]
v_exp_f32 v236, v140
v_mfma_f32_16x16x32_bf16 v[156:159], v[212:215], v[116:119], v[156:159]
ds_read_b128 v[212:215], v251 offset:16896
s_waitcnt lgkmcnt(3)
v_mfma_f32_16x16x32_bf16 v[144:147], v[216:219], v[24:27], v[144:147]
v_exp_f32 v237, v141
v_mfma_f32_16x16x32_bf16 v[148:151], v[216:219], v[56:59], v[148:151]
v_exp_f32 v238, v142
v_add_f32 v231, v227, v236
v_mfma_f32_16x16x32_bf16 v[152:155], v[216:219], v[88:91], v[152:155]
v_cvt_pk_bf16_f32 v172, v236, v237
v_exp_f32 v239, v143
v_mfma_f32_16x16x32_bf16 v[156:159], v[216:219], v[120:123], v[156:159]
ds_read_b128 v[216:219], v251 offset:20480
s_waitcnt lgkmcnt(3)
v_add_f32 v231, v231, v237
v_mfma_f32_16x16x32_bf16 v[144:147], v[220:223], v[28:31], v[144:147]
v_add_f32 v231, v231, v238
v_add_f32 v231, v231, v239
v_cvt_pk_bf16_f32 v173, v238, v239
v_mfma_f32_16x16x32_bf16 v[148:151], v[220:223], v[60:63], v[148:151]
v_max3_f32 v242, v228, v229, v230
v_max_f32 v242, v242, v231
v_cmp_lt_f32 vcc, s32, v242
s_cbranch_vccnz L2_rare_site16
L2_ret16:
v_mfma_f32_16x16x32_bf16 v[152:155], v[220:223], v[92:95], v[152:155]
v_mfma_f32_16x16x32_bf16 v[156:159], v[220:223], v[124:127], v[156:159]
ds_read_b128 v[220:223], v251 offset:20992
s_waitcnt lgkmcnt(3)
v_mfma_f32_16x16x32_bf16 v[128:131], v[208:211], v[0:3], v[192:195]
v_mfma_f32_16x16x32_bf16 v[132:135], v[208:211], v[32:35], v[196:199]
v_exp_f32 v232, v144
v_mfma_f32_16x16x32_bf16 v[136:139], v[208:211], v[64:67], v[200:203]
v_exp_f32 v233, v145
v_mfma_f32_16x16x32_bf16 v[140:143], v[208:211], v[96:99], v[204:207]
ds_read_b128 v[208:211], v251 offset:24576
s_waitcnt lgkmcnt(3)
v_mfma_f32_16x16x32_bf16 v[128:131], v[212:215], v[4:7], v[128:131]
v_exp_f32 v234, v146
v_add_f32 v224, v228, v232
v_mfma_f32_16x16x32_bf16 v[132:135], v[212:215], v[36:39], v[132:135]
v_cvt_pk_bf16_f32 v162, v232, v233
v_exp_f32 v235, v147
v_mfma_f32_16x16x32_bf16 v[136:139], v[212:215], v[68:71], v[136:139]
v_add_f32 v224, v224, v233
v_add_f32 v224, v224, v234
v_add_f32 v224, v224, v235
v_mfma_f32_16x16x32_bf16 v[140:143], v[212:215], v[100:103], v[140:143]
ds_read_b128 v[212:215], v251 offset:25088
s_waitcnt lgkmcnt(3)
v_cvt_pk_bf16_f32 v163, v234, v235
v_mfma_f32_16x16x32_bf16 v[128:131], v[216:219], v[8:11], v[128:131]
v_exp_f32 v236, v148
v_lshlrev_b32 v241, 3, v248
v_mfma_f32_16x16x32_bf16 v[132:135], v[216:219], v[40:43], v[132:135]
v_exp_f32 v237, v149
s_mov_b32 s3, 0x7c28000
v_mfma_f32_16x16x32_bf16 v[136:139], v[216:219], v[72:75], v[136:139]
v_exp_f32 v238, v150
v_add_f32 v225, v229, v236
v_mfma_f32_16x16x32_bf16 v[140:143], v[216:219], v[104:107], v[140:143]
ds_read_b128 v[216:219], v251 offset:28672
s_waitcnt lgkmcnt(3)
v_cvt_pk_bf16_f32 v166, v236, v237
v_mfma_f32_16x16x32_bf16 v[128:131], v[220:223], v[12:15], v[128:131]
v_exp_f32 v239, v151
v_add_f32 v225, v225, v237
v_mfma_f32_16x16x32_bf16 v[132:135], v[220:223], v[44:47], v[132:135]
v_add_f32 v225, v225, v238
v_add_f32 v225, v225, v239
v_cvt_pk_bf16_f32 v167, v238, v239
v_mfma_f32_16x16x32_bf16 v[136:139], v[220:223], v[76:79], v[136:139]
v_exp_f32 v232, v152
buffer_load_dwordx2 v[240:241], v241, s[16:19], s3 offen sc1
v_mfma_f32_16x16x32_bf16 v[140:143], v[220:223], v[108:111], v[140:143]
ds_read_b128 v[220:223], v251 offset:29184
s_waitcnt lgkmcnt(3)
v_mfma_f32_16x16x32_bf16 v[128:131], v[208:211], v[16:19], v[128:131]
v_exp_f32 v233, v153
v_mfma_f32_16x16x32_bf16 v[132:135], v[208:211], v[48:51], v[132:135]
v_exp_f32 v234, v154
v_add_f32 v226, v230, v232
v_mfma_f32_16x16x32_bf16 v[136:139], v[208:211], v[80:83], v[136:139]
v_cvt_pk_bf16_f32 v170, v232, v233
v_exp_f32 v235, v155
v_mfma_f32_16x16x32_bf16 v[140:143], v[208:211], v[112:115], v[140:143]
ds_read_b128 v[208:211], v251 offset:18432
s_waitcnt lgkmcnt(3)
v_add_f32 v226, v226, v233
v_mfma_f32_16x16x32_bf16 v[128:131], v[212:215], v[20:23], v[128:131]
v_add_f32 v226, v226, v234
v_add_f32 v226, v226, v235
v_cvt_pk_bf16_f32 v171, v234, v235
v_mfma_f32_16x16x32_bf16 v[132:135], v[212:215], v[52:55], v[132:135]
v_exp_f32 v236, v156
v_mfma_f32_16x16x32_bf16 v[136:139], v[212:215], v[84:87], v[136:139]
v_exp_f32 v237, v157
v_mfma_f32_16x16x32_bf16 v[140:143], v[212:215], v[116:119], v[140:143]
ds_read_b128 v[212:215], v251 offset:18944
s_waitcnt lgkmcnt(3)
v_mfma_f32_16x16x32_bf16 v[128:131], v[216:219], v[24:27], v[128:131]
v_exp_f32 v238, v158
v_add_f32 v227, v231, v236
v_mfma_f32_16x16x32_bf16 v[132:135], v[216:219], v[56:59], v[132:135]
v_cvt_pk_bf16_f32 v174, v236, v237
v_exp_f32 v239, v159
v_mfma_f32_16x16x32_bf16 v[136:139], v[216:219], v[88:91], v[136:139]
v_add_f32 v227, v227, v237
v_add_f32 v227, v227, v238
v_add_f32 v227, v227, v239
v_mfma_f32_16x16x32_bf16 v[140:143], v[216:219], v[120:123], v[140:143]
ds_read_b128 v[216:219], v251 offset:22528
s_waitcnt lgkmcnt(3)
v_cvt_pk_bf16_f32 v175, v238, v239
v_mfma_f32_16x16x32_bf16 v[128:131], v[220:223], v[28:31], v[128:131]
v_max3_f32 v242, v224, v225, v226
v_max_f32 v242, v242, v227
v_cmp_lt_f32 vcc, s32, v242
s_cbranch_vccnz L2_rare_site17
L2_ret17:
v_mfma_f32_16x16x32_bf16 v[132:135], v[220:223], v[60:63], v[132:135]
v_mfma_f32_16x16x32_bf16 v[136:139], v[220:223], v[92:95], v[136:139]
v_mfma_f32_16x16x32_bf16 v[140:143], v[220:223], v[124:127], v[140:143]
ds_read_b128 v[220:223], v251 offset:23040
s_waitcnt lgkmcnt(3)
v_mfma_f32_16x16x32_bf16 v[144:147], v[208:211], v[0:3], v[192:195]
v_mfma_f32_16x16x32_bf16 v[148:151], v[208:211], v[32:35], v[196:199]
v_mfma_f32_16x16x32_bf16 v[152:155], v[208:211], v[64:67], v[200:203]
v_mfma_f32_16x16x32_bf16 v[156:159], v[208:211], v[96:99], v[204:207]
ds_read_b128 v[208:211], v251 offset:26624
s_waitcnt lgkmcnt(3)
v_mfma_f32_16x16x32_bf16 v[144:147], v[212:215], v[4:7], v[144:147]
v_exp_f32 v232, v128
v_mfma_f32_16x16x32_bf16 v[148:151], v[212:215], v[36:39], v[148:151]
v_exp_f32 v233, v129
v_mfma_f32_16x16x32_bf16 v[152:155], v[212:215], v[68:71], v[152:155]
v_exp_f32 v234, v130
v_add_f32 v228, v224, v232
v_mfma_f32_16x16x32_bf16 v[156:159], v[212:215], v[100:103], v[156:159]
ds_read_b128 v[212:215], v251 offset:27136
s_waitcnt lgkmcnt(3)
v_cvt_pk_bf16_f32 v0, v232, v233
v_mfma_f32_16x16x32_bf16 v[144:147], v[216:219], v[8:11], v[144:147]
v_exp_f32 v235, v131
v_add_f32 v228, v228, v233
v_mfma_f32_16x16x32_bf16 v[148:151], v[216:219], v[40:43], v[148:151]
ds_read_b128 v[4:7], v253 offset:0
v_add_f32 v228, v228, v234
v_add_f32 v228, v228, v235
v_mfma_f32_16x16x32_bf16 v[152:155], v[216:219], v[72:75], v[152:155]
ds_read_b128 v[36:39], v253 offset:1024
v_cvt_pk_bf16_f32 v1, v234, v235
v_mfma_f32_16x16x32_bf16 v[156:159], v[216:219], v[104:107], v[156:159]
ds_read_b128 v[216:219], v251 offset:30720
s_waitcnt lgkmcnt(3)
v_mfma_f32_16x16x32_bf16 v[144:147], v[220:223], v[12:15], v[144:147]
v_exp_f32 v236, v132
v_mfma_f32_16x16x32_bf16 v[148:151], v[220:223], v[44:47], v[148:151]
ds_read_b128 v[68:71], v253 offset:2048
ds_read_b128 v[8:11], v253 offset:4096
v_mfma_f32_16x16x32_bf16 v[152:155], v[220:223], v[76:79], v[152:155]
v_add_u32 v12, 0x8000, v249
v_and_b32 v12, 0x1ffff, v12
ds_read_b128 v[100:103], v253 offset:3072
ds_read_b128 v[40:43], v253 offset:5120
v_mfma_f32_16x16x32_bf16 v[156:159], v[220:223], v[108:111], v[156:159]
ds_read_b128 v[220:223], v251 offset:31232
s_waitcnt lgkmcnt(3)
v_add_u32 v14, 0x10000, v249
v_and_b32 v14, 0x1ffff, v14
v_mfma_f32_16x16x32_bf16 v[144:147], v[208:211], v[16:19], v[144:147]
v_xor_b32 v13, 32, v12
v_xor_b32 v15, 32, v14
v_mfma_f32_16x16x32_bf16 v[148:151], v[208:211], v[48:51], v[148:151]
ds_read_b128 v[72:75], v253 offset:6144
v_exp_f32 v237, v133
v_mfma_f32_16x16x32_bf16 v[152:155], v[208:211], v[80:83], v[152:155]
ds_read_b128 v[104:107], v253 offset:7168
v_exp_f32 v238, v134
v_mfma_f32_16x16x32_bf16 v[156:159], v[208:211], v[112:115], v[156:159]
ds_read_b64_tr_b16 v[208:209], v12 offset:0
s_waitcnt lgkmcnt(3)
v_add_f32 v229, v225, v236
v_mfma_f32_16x16x32_bf16 v[144:147], v[212:215], v[20:23], v[144:147]
ds_read_b64_tr_b16 v[210:211], v12 offset:2048
v_cvt_pk_bf16_f32 v32, v236, v237
v_mfma_f32_16x16x32_bf16 v[148:151], v[212:215], v[52:55], v[148:151]
v_exp_f32 v239, v135
v_add_f32 v229, v229, v237
v_mfma_f32_16x16x32_bf16 v[152:155], v[212:215], v[84:87], v[152:155]
v_add_f32 v229, v229, v238
v_add_f32 v229, v229, v239
v_cvt_pk_bf16_f32 v33, v238, v239
v_mfma_f32_16x16x32_bf16 v[156:159], v[212:215], v[116:119], v[156:159]
ds_read_b64_tr_b16 v[212:213], v12 offset:16384
s_waitcnt lgkmcnt(4)
v_mfma_f32_16x16x32_bf16 v[144:147], v[216:219], v[24:27], v[144:147]
ds_read_b64_tr_b16 v[214:215], v12 offset:18432
v_exp_f32 v232, v136
v_mfma_f32_16x16x32_bf16 v[148:151], v[216:219], v[56:59], v[148:151]
v_exp_f32 v233, v137
v_mfma_f32_16x16x32_bf16 v[152:155], v[216:219], v[88:91], v[152:155]
v_exp_f32 v234, v138
v_add_f32 v230, v226, v232
v_mfma_f32_16x16x32_bf16 v[156:159], v[216:219], v[120:123], v[156:159]
ds_read_b64_tr_b16 v[216:217], v14 offset:0
s_waitcnt lgkmcnt(5)
v_cvt_pk_bf16_f32 v64, v232, v233
v_mfma_f32_16x16x32_bf16 v[144:147], v[220:223], v[28:31], v[144:147]
ds_read_b64_tr_b16 v[218:219], v14 offset:2048
v_exp_f32 v235, v139
v_mfma_f32_16x16x32_bf16 v[148:151], v[220:223], v[60:63], v[148:151]
v_add_f32 v230, v230, v233
v_add_f32 v230, v230, v234
v_add_f32 v230, v230, v235
v_mfma_f32_16x16x32_bf16 v[152:155], v[220:223], v[92:95], v[152:155]
v_cvt_pk_bf16_f32 v65, v234, v235
v_exp_f32 v236, v140
v_mfma_f32_16x16x32_bf16 v[156:159], v[220:223], v[124:127], v[156:159]
ds_read_b64_tr_b16 v[220:221], v13 offset:0
s_waitcnt lgkmcnt(5)
v_exp_f32 v237, v141
v_exp_f32 v238, v142
v_add_f32 v231, v227, v236
v_cvt_pk_bf16_f32 v96, v236, v237
v_exp_f32 v239, v143
v_add_f32 v231, v231, v237
v_add_f32 v231, v231, v238
v_add_f32 v231, v231, v239
v_cvt_pk_bf16_f32 v97, v238, v239
v_max3_f32 v242, v228, v229, v230
v_max_f32 v242, v242, v231
v_cmp_lt_f32 vcc, s32, v242
s_cbranch_vccnz L2_rare_site18
L2_ret18:
v_mfma_f32_16x16x32_bf16 a[0:3], v[8:11], v[208:211], a[0:3]
ds_read_b64_tr_b16 v[222:223], v13 offset:2048
s_waitcnt vmcnt(0)
v_cmp_ne_u64_e64 s[38:39], s[98:99], v[240:241]
v_mfma_f32_16x16x32_bf16 a[4:7], v[40:43], v[208:211], a[4:7]
v_exp_f32 v232, v144
v_mfma_f32_16x16x32_bf16 a[8:11], v[72:75], v[208:211], a[8:11]
v_exp_f32 v233, v145
v_mfma_f32_16x16x32_bf16 a[12:15], v[104:107], v[208:211], a[12:15]
ds_read_b64_tr_b16 v[208:209], v13 offset:16384
s_waitcnt lgkmcnt(5)
v_mfma_f32_16x16x32_bf16 a[0:3], v[176:179], v[212:215], a[0:3]
ds_read_b64_tr_b16 v[210:211], v13 offset:18432
s_and_b64 s[38:39], s[38:39], s[96:97]
s_cbranch_scc1 LF_hl_1
LF_hlret_1:
v_mfma_f32_16x16x32_bf16 a[4:7], v[180:183], v[212:215], a[4:7]
v_exp_f32 v234, v146
v_lshrrev_b32 v241, 4, v248
v_mfma_f32_16x16x32_bf16 a[8:11], v[184:187], v[212:215], a[8:11]
v_add_f32 v224, v228, v232
v_cvt_pk_bf16_f32 v2, v232, v233
v_and_b32 v241, 0x30, v241
v_mfma_f32_16x16x32_bf16 a[12:15], v[188:191], v[212:215], a[12:15]
ds_read_b64_tr_b16 v[212:213], v15 offset:0
s_waitcnt lgkmcnt(5)
v_xor_b32 v241, v241, v248
v_mfma_f32_16x16x32_bf16 a[0:3], v[160:163], v[216:219], a[0:3]
ds_read_b64_tr_b16 v[214:215], v15 offset:2048
v_and_b32 v243, 0x380, v248
v_mad_u32_u24 v241, v243, 3, v241
v_mfma_f32_16x16x32_bf16 a[4:7], v[164:167], v[216:219], a[4:7]
v_exp_f32 v235, v147
v_add_u32 v241, 0x7000000, v241
v_mfma_f32_16x16x32_bf16 a[8:11], v[168:171], v[216:219], a[8:11]
v_add_f32 v224, v224, v233
v_add_f32 v224, v224, v234
v_and_b32 v110, 0x70, v248
v_mfma_f32_16x16x32_bf16 a[12:15], v[172:175], v[216:219], a[12:15]
ds_read_b64_tr_b16 v[216:217], v12 offset:512
s_waitcnt lgkmcnt(5)
v_lshlrev_b32 v110, 3, v110
v_mfma_f32_16x16x32_bf16 a[16:19], v[8:11], v[220:223], a[16:19]
ds_read_b64_tr_b16 v[218:219], v12 offset:2560
v_add_f32 v224, v224, v235
v_add_u32 v110, 0x7c32000, v110
v_mfma_f32_16x16x32_bf16 a[20:23], v[40:43], v[220:223], a[20:23]
v_cvt_pk_bf16_f32 v3, v234, v235
buffer_load_dwordx2 v[108:109], v110, s[16:19], 0 offen sc1
v_mfma_f32_16x16x32_bf16 a[24:27], v[72:75], v[220:223], a[24:27]
v_exp_f32 v236, v148
v_mfma_f32_16x16x32_bf16 a[28:31], v[104:107], v[220:223], a[28:31]
ds_read_b64_tr_b16 v[220:221], v12 offset:16896
s_waitcnt lgkmcnt(5)
v_mfma_f32_16x16x32_bf16 a[16:19], v[176:179], v[208:211], a[16:19]
ds_read_b64_tr_b16 v[222:223], v12 offset:18944
s_add_u32 m0, s28, 0
v_mfma_f32_16x16x32_bf16 a[20:23], v[180:183], v[208:211], a[20:23]
v_exp_f32 v237, v149
v_mfma_f32_16x16x32_bf16 a[24:27], v[184:187], v[208:211], a[24:27]
v_exp_f32 v238, v150
v_mfma_f32_16x16x32_bf16 a[28:31], v[188:191], v[208:211], a[28:31]
ds_read_b64_tr_b16 v[208:209], v14 offset:512
s_waitcnt lgkmcnt(5)
v_mfma_f32_16x16x32_bf16 a[16:19], v[160:163], v[212:215], a[16:19]
ds_read_b64_tr_b16 v[210:211], v14 offset:2560
v_add_f32 v225, v229, v236
v_mfma_f32_16x16x32_bf16 a[20:23], v[164:167], v[212:215], a[20:23]
v_cvt_pk_bf16_f32 v34, v236, v237
buffer_load_dwordx4 v241, s[16:19], s6 offen sc1 lds
s_add_u32 m0, s28, 8192
v_mfma_f32_16x16x32_bf16 a[24:27], v[168:171], v[212:215], a[24:27]
v_exp_f32 v239, v151
v_mfma_f32_16x16x32_bf16 a[28:31], v[172:175], v[212:215], a[28:31]
ds_read_b64_tr_b16 v[212:213], v13 offset:512
s_waitcnt lgkmcnt(5)
v_mfma_f32_16x16x32_bf16 a[32:35], v[8:11], v[216:219], a[32:35]
ds_read_b64_tr_b16 v[214:215], v13 offset:2560
v_add_f32 v225, v225, v237
v_mfma_f32_16x16x32_bf16 a[36:39], v[40:43], v[216:219], a[36:39]
v_add_f32 v225, v225, v238
v_add_f32 v225, v225, v239
v_mfma_f32_16x16x32_bf16 a[40:43], v[72:75], v[216:219], a[40:43]
v_cvt_pk_bf16_f32 v35, v238, v239
buffer_load_dwordx4 v241, s[16:19], s7 offen sc1 lds
s_add_u32 m0, s30, 0
v_mfma_f32_16x16x32_bf16 a[44:47], v[104:107], v[216:219], a[44:47]
ds_read_b64_tr_b16 v[216:217], v13 offset:16896
s_waitcnt lgkmcnt(5)
v_mfma_f32_16x16x32_bf16 a[32:35], v[176:179], v[220:223], a[32:35]
ds_read_b64_tr_b16 v[218:219], v13 offset:18944
buffer_load_dwordx4 v241, s[16:19], s29 offen sc1 lds
s_add_u32 m0, s28, 4096
v_mfma_f32_16x16x32_bf16 a[36:39], v[180:183], v[220:223], a[36:39]
v_exp_f32 v232, v152
v_xor_b32 v241, 0x1040, v241
v_mfma_f32_16x16x32_bf16 a[40:43], v[184:187], v[220:223], a[40:43]
v_exp_f32 v233, v153
v_mfma_f32_16x16x32_bf16 a[44:47], v[188:191], v[220:223], a[44:47]
ds_read_b64_tr_b16 v[220:221], v15 offset:512
s_waitcnt lgkmcnt(5)
v_mfma_f32_16x16x32_bf16 a[32:35], v[160:163], v[208:211], a[32:35]
ds_read_b64_tr_b16 v[222:223], v15 offset:2560
buffer_load_dwordx4 v241, s[16:19], s6 offen sc1 lds
s_add_u32 m0, s28, 12288
v_mfma_f32_16x16x32_bf16 a[36:39], v[164:167], v[208:211], a[36:39]
v_exp_f32 v234, v154
v_mfma_f32_16x16x32_bf16 a[40:43], v[168:171], v[208:211], a[40:43]
v_add_f32 v226, v230, v232
v_cvt_pk_bf16_f32 v66, v232, v233
v_mfma_f32_16x16x32_bf16 a[44:47], v[172:175], v[208:211], a[44:47]
ds_read_b64_tr_b16 v[208:209], v14 offset:16384
s_waitcnt lgkmcnt(5)
v_mfma_f32_16x16x32_bf16 a[48:51], v[8:11], v[212:215], a[48:51]
ds_read_b64_tr_b16 v[210:211], v14 offset:18432
buffer_load_dwordx4 v241, s[16:19], s7 offen sc1 lds
s_add_u32 m0, s30, 4096
v_mfma_f32_16x16x32_bf16 a[52:55], v[40:43], v[212:215], a[52:55]
v_exp_f32 v235, v155
v_mfma_f32_16x16x32_bf16 a[56:59], v[72:75], v[212:215], a[56:59]
v_add_f32 v226, v226, v233
v_add_f32 v226, v226, v234
v_mfma_f32_16x16x32_bf16 a[60:63], v[104:107], v[212:215], a[60:63]
ds_read_b64_tr_b16 v[212:213], v15 offset:16384
s_waitcnt lgkmcnt(5)
v_mfma_f32_16x16x32_bf16 a[48:51], v[176:179], v[216:219], a[48:51]
ds_read_b64_tr_b16 v[214:215], v15 offset:18432
v_add_f32 v226, v226, v235
v_mfma_f32_16x16x32_bf16 a[52:55], v[180:183], v[216:219], a[52:55]
v_cvt_pk_bf16_f32 v67, v234, v235
buffer_load_dwordx4 v241, s[16:19], s29 offen sc1 lds
v_mfma_f32_16x16x32_bf16 a[56:59], v[184:187], v[216:219], a[56:59]
v_exp_f32 v236, v156
v_mfma_f32_16x16x32_bf16 a[60:63], v[188:191], v[216:219], a[60:63]
ds_read_b64_tr_b16 v[216:217], v14 offset:16896
s_waitcnt lgkmcnt(5)
v_mfma_f32_16x16x32_bf16 a[48:51], v[160:163], v[220:223], a[48:51]
ds_read_b64_tr_b16 v[218:219], v14 offset:18944
v_mfma_f32_16x16x32_bf16 a[52:55], v[164:167], v[220:223], a[52:55]
v_exp_f32 v237, v157
v_mfma_f32_16x16x32_bf16 a[56:59], v[168:171], v[220:223], a[56:59]
v_exp_f32 v238, v158
v_add_f32 v227, v231, v236
v_cvt_pk_bf16_f32 v98, v236, v237
v_exp_f32 v239, v159
v_add_f32 v227, v227, v237
v_add_f32 v227, v227, v238
v_add_f32 v227, v227, v239
v_cvt_pk_bf16_f32 v99, v238, v239
v_max3_f32 v242, v224, v225, v226
v_max_f32 v242, v242, v227
v_cmp_lt_f32 vcc, s32, v242
s_cbranch_vccnz L2_rare_site19
L2_ret19:
v_mfma_f32_16x16x32_bf16 a[60:63], v[172:175], v[220:223], a[60:63]
ds_read_b64_tr_b16 v[220:221], v15 offset:16896
s_waitcnt lgkmcnt(5)
v_mfma_f32_16x16x32_bf16 a[0:3], v[0:3], v[208:211], a[0:3]
ds_read_b64_tr_b16 v[222:223], v15 offset:18944
v_bfe_u32 v242, v248, 8, 1
v_mul_u32_u24 v242, 48, v242
v_mfma_f32_16x16x32_bf16 a[4:7], v[32:35], v[208:211], a[4:7]
v_lshl_add_u32 v242, s37, 3, v242
v_and_b32 v243, 0xf0, v248
v_lshl_add_u32 v242, v243, 3, v242
v_mfma_f32_16x16x32_bf16 a[8:11], v[64:67], v[208:211], a[8:11]
v_mov_b32 v232, v224
v_mov_b32 v234, v225
v_mov_b32 v236, v226
v_mfma_f32_16x16x32_bf16 a[12:15], v[96:99], v[208:211], a[12:15]
ds_read_b64_tr_b16 v[208:209], v249 offset:20480
s_waitcnt lgkmcnt(5)
v_mov_b32 v238, v227
v_mfma_f32_16x16x32_bf16 a[16:19], v[0:3], v[212:215], a[16:19]
ds_read_b64_tr_b16 v[210:211], v249 offset:22528
v_permlane32_swap_b32 v224, v232
v_permlane32_swap_b32 v225, v234
v_mfma_f32_16x16x32_bf16 a[20:23], v[32:35], v[212:215], a[20:23]
v_permlane32_swap_b32 v226, v236
v_permlane32_swap_b32 v227, v238
v_add_f32 v224, v224, v232
v_mfma_f32_16x16x32_bf16 a[24:27], v[64:67], v[212:215], a[24:27]
v_add_f32 v225, v225, v234
v_add_f32 v226, v226, v236
v_add_f32 v227, v227, v238
v_mfma_f32_16x16x32_bf16 a[28:31], v[96:99], v[212:215], a[28:31]
ds_read_b64_tr_b16 v[212:213], v12 offset:4096
s_waitcnt lgkmcnt(5)
v_mov_b32 v232, v224
v_mfma_f32_16x16x32_bf16 a[32:35], v[0:3], v[216:219], a[32:35]
ds_read_b64_tr_b16 v[214:215], v12 offset:6144
v_mov_b32 v234, v225
v_mov_b32 v236, v226
v_mfma_f32_16x16x32_bf16 a[36:39], v[32:35], v[216:219], a[36:39]
v_mov_b32 v238, v227
v_permlane16_swap_b32 v224, v232
v_permlane16_swap_b32 v225, v234
v_mfma_f32_16x16x32_bf16 a[40:43], v[64:67], v[216:219], a[40:43]
v_permlane16_swap_b32 v226, v236
v_permlane16_swap_b32 v227, v238
v_add_f32 v233, v224, v232
v_mfma_f32_16x16x32_bf16 a[44:47], v[96:99], v[216:219], a[44:47]
ds_read_b64_tr_b16 v[216:217], v12 offset:20480
s_waitcnt lgkmcnt(5)
v_add_f32 v235, v225, v234
v_mfma_f32_16x16x32_bf16 a[48:51], v[0:3], v[220:223], a[48:51]
ds_read_b64_tr_b16 v[218:219], v12 offset:22528
v_add_f32 v237, v226, v236
v_add_f32 v239, v227, v238
v_mfma_f32_16x16x32_bf16 a[52:55], v[32:35], v[220:223], a[52:55]
v_mov_b32 v232, v244
v_mov_b32 v234, v245
v_mov_b32 v236, v246
v_mfma_f32_16x16x32_bf16 a[56:59], v[64:67], v[220:223], a[56:59]
v_mov_b32 v238, v247
v_mfma_f32_16x16x32_bf16 a[60:63], v[96:99], v[220:223], a[60:63]
ds_read_b64_tr_b16 v[220:221], v14 offset:4096
s_waitcnt lgkmcnt(5)
v_mfma_f32_16x16x32_bf16 a[64:67], v[4:7], v[208:211], a[64:67]
ds_read_b64_tr_b16 v[222:223], v14 offset:6144
v_mfma_f32_16x16x32_bf16 a[68:71], v[36:39], v[208:211], a[68:71]
s_mov_b32 exec_hi, 0
buffer_store_dwordx2 v[232:233], v242, s[24:27], s48 offen sc1
s_lshr_b32 s3, s41, 2
buffer_store_dwordx2 v[234:235], v242, s[24:27], s3 offen sc1
s_lshr_b32 s3, s42, 2
buffer_store_dwordx2 v[236:237], v242, s[24:27], s3 offen sc1
s_lshr_b32 s3, s43, 2
buffer_store_dwordx2 v[238:239], v242, s[24:27], s3 offen sc1
s_mov_b32 exec_hi, -1
v_mfma_f32_16x16x32_bf16 a[72:75], v[68:71], v[208:211], a[72:75]
v_accvgpr_read_b32 v128, a0
v_accvgpr_read_b32 v129, a1
v_accvgpr_read_b32 v130, a2
v_mfma_f32_16x16x32_bf16 a[76:79], v[100:103], v[208:211], a[76:79]
ds_read_b64_tr_b16 v[208:209], v14 offset:20480
s_waitcnt lgkmcnt(5)
v_accvgpr_read_b32 v131, a3
v_mfma_f32_16x16x32_bf16 a[64:67], v[8:11], v[212:215], a[64:67]
ds_read_b64_tr_b16 v[210:211], v14 offset:22528
v_cvt_pk_bf16_f32 v16, v128, v129
v_cvt_pk_bf16_f32 v17, v130, v131
v_mfma_f32_16x16x32_bf16 a[68:71], v[40:43], v[212:215], a[68:71]
v_accvgpr_read_b32 v136, a4
v_accvgpr_read_b32 v137, a5
v_accvgpr_read_b32 v138, a6
v_mfma_f32_16x16x32_bf16 a[72:75], v[72:75], v[212:215], a[72:75]
v_accvgpr_read_b32 v139, a7
v_cvt_pk_bf16_f32 v48, v136, v137
v_cvt_pk_bf16_f32 v49, v138, v139
v_mfma_f32_16x16x32_bf16 a[76:79], v[104:107], v[212:215], a[76:79]
ds_read_b64_tr_b16 v[212:213], v250 offset:20480
s_waitcnt lgkmcnt(5)
v_accvgpr_read_b32 v144, a8
v_mfma_f32_16x16x32_bf16 a[64:67], v[176:179], v[216:219], a[64:67]
ds_read_b64_tr_b16 v[214:215], v250 offset:22528
v_accvgpr_read_b32 v145, a9
v_accvgpr_read_b32 v146, a10
v_mfma_f32_16x16x32_bf16 a[68:71], v[180:183], v[216:219], a[68:71]
v_accvgpr_read_b32 v147, a11
v_cvt_pk_bf16_f32 v80, v144, v145
v_cvt_pk_bf16_f32 v81, v146, v147
v_mfma_f32_16x16x32_bf16 a[72:75], v[184:187], v[216:219], a[72:75]
v_accvgpr_read_b32 v152, a12
v_accvgpr_read_b32 v153, a13
v_accvgpr_read_b32 v154, a14
v_mfma_f32_16x16x32_bf16 a[76:79], v[188:191], v[216:219], a[76:79]
ds_read_b64_tr_b16 v[216:217], v13 offset:4096
s_waitcnt lgkmcnt(5)
v_accvgpr_read_b32 v155, a15
v_mfma_f32_16x16x32_bf16 a[64:67], v[160:163], v[220:223], a[64:67]
ds_read_b64_tr_b16 v[218:219], v13 offset:6144
v_cvt_pk_bf16_f32 v112, v152, v153
v_cvt_pk_bf16_f32 v113, v154, v155
v_mfma_f32_16x16x32_bf16 a[68:71], v[164:167], v[220:223], a[68:71]
v_accvgpr_read_b32 v132, a16
v_accvgpr_read_b32 v133, a17
v_accvgpr_read_b32 v134, a18
v_mfma_f32_16x16x32_bf16 a[72:75], v[168:171], v[220:223], a[72:75]
v_accvgpr_read_b32 v135, a19
v_cvt_pk_bf16_f32 v18, v132, v133
v_cvt_pk_bf16_f32 v19, v134, v135
v_mfma_f32_16x16x32_bf16 a[76:79], v[172:175], v[220:223], a[76:79]
ds_read_b64_tr_b16 v[220:221], v13 offset:20480
s_waitcnt lgkmcnt(5)
buffer_store_dwordx4 v[16:19], v248, s[20:23], s40 offen offset:0 sc1
v_mfma_f32_16x16x32_bf16 a[64:67], v[0:3], v[208:211], a[64:67]
ds_read_b64_tr_b16 v[222:223], v13 offset:22528
ds_write_b128 v253, v[16:19] offset:0
v_accvgpr_read_b32 v140, a20
v_mfma_f32_16x16x32_bf16 a[68:71], v[32:35], v[208:211], a[68:71]
v_accvgpr_read_b32 v141, a21
v_accvgpr_read_b32 v142, a22
v_accvgpr_read_b32 v143, a23
v_mfma_f32_16x16x32_bf16 a[72:75], v[64:67], v[208:211], a[72:75]
v_cvt_pk_bf16_f32 v50, v140, v141
v_cvt_pk_bf16_f32 v51, v142, v143
buffer_store_dwordx4 v[48:51], v248, s[20:23], s41 offen offset:0 sc1
v_mfma_f32_16x16x32_bf16 a[76:79], v[96:99], v[208:211], a[76:79]
ds_read_b64_tr_b16 v[208:209], v15 offset:4096
s_waitcnt lgkmcnt(5)
v_accvgpr_read_b32 v148, a24
v_mfma_f32_16x16x32_bf16 a[80:83], v[4:7], v[212:215], a[80:83]
ds_read_b64_tr_b16 v[210:211], v15 offset:6144
v_accvgpr_read_b32 v149, a25
v_accvgpr_read_b32 v150, a26
v_mfma_f32_16x16x32_bf16 a[84:87], v[36:39], v[212:215], a[84:87]
v_accvgpr_read_b32 v151, a27
v_cvt_pk_bf16_f32 v82, v148, v149
v_cvt_pk_bf16_f32 v83, v150, v151
v_mfma_f32_16x16x32_bf16 a[88:91], v[68:71], v[212:215], a[88:91]
buffer_store_dwordx4 v[80:83], v248, s[20:23], s42 offen offset:0 sc1
v_accvgpr_read_b32 v156, a28
v_accvgpr_read_b32 v157, a29
v_mfma_f32_16x16x32_bf16 a[92:95], v[100:103], v[212:215], a[92:95]
ds_read_b64_tr_b16 v[212:213], v15 offset:20480
s_waitcnt lgkmcnt(5)
v_accvgpr_read_b32 v158, a30
v_mfma_f32_16x16x32_bf16 a[80:83], v[8:11], v[216:219], a[80:83]
ds_read_b64_tr_b16 v[214:215], v15 offset:22528
v_accvgpr_read_b32 v159, a31
v_cvt_pk_bf16_f32 v114, v156, v157
v_mfma_f32_16x16x32_bf16 a[84:87], v[40:43], v[216:219], a[84:87]
v_cvt_pk_bf16_f32 v115, v158, v159
buffer_store_dwordx4 v[112:115], v248, s[20:23], s43 offen offset:0 sc1
v_accvgpr_read_b32 v128, a32
v_mfma_f32_16x16x32_bf16 a[88:91], v[72:75], v[216:219], a[88:91]
v_accvgpr_read_b32 v129, a33
v_accvgpr_read_b32 v130, a34
v_accvgpr_read_b32 v131, a35
v_mfma_f32_16x16x32_bf16 a[92:95], v[104:107], v[216:219], a[92:95]
ds_read_b64_tr_b16 v[216:217], v249 offset:20992
s_waitcnt lgkmcnt(5)
v_cvt_pk_bf16_f32 v20, v128, v129
v_mfma_f32_16x16x32_bf16 a[80:83], v[176:179], v[220:223], a[80:83]
ds_read_b64_tr_b16 v[218:219], v249 offset:23040
v_cvt_pk_bf16_f32 v21, v130, v131
v_accvgpr_read_b32 v136, a36
v_mfma_f32_16x16x32_bf16 a[84:87], v[180:183], v[220:223], a[84:87]
v_accvgpr_read_b32 v137, a37
v_accvgpr_read_b32 v138, a38
v_accvgpr_read_b32 v139, a39
v_mfma_f32_16x16x32_bf16 a[88:91], v[184:187], v[220:223], a[88:91]
v_cvt_pk_bf16_f32 v52, v136, v137
v_cvt_pk_bf16_f32 v53, v138, v139
v_accvgpr_read_b32 v144, a40
v_mfma_f32_16x16x32_bf16 a[92:95], v[188:191], v[220:223], a[92:95]
ds_read_b64_tr_b16 v[220:221], v12 offset:4608
s_waitcnt lgkmcnt(5)
v_accvgpr_read_b32 v145, a41
v_mfma_f32_16x16x32_bf16 a[80:83], v[160:163], v[208:211], a[80:83]
ds_read_b64_tr_b16 v[222:223], v12 offset:6656
v_accvgpr_read_b32 v146, a42
v_accvgpr_read_b32 v147, a43
v_mfma_f32_16x16x32_bf16 a[84:87], v[164:167], v[208:211], a[84:87]
v_cvt_pk_bf16_f32 v84, v144, v145
v_cvt_pk_bf16_f32 v85, v146, v147
v_accvgpr_read_b32 v152, a44
v_mfma_f32_16x16x32_bf16 a[88:91], v[168:171], v[208:211], a[88:91]
v_accvgpr_read_b32 v153, a45
v_accvgpr_read_b32 v154, a46
v_accvgpr_read_b32 v155, a47
v_mfma_f32_16x16x32_bf16 a[92:95], v[172:175], v[208:211], a[92:95]
ds_read_b64_tr_b16 v[208:209], v12 offset:20992
s_waitcnt lgkmcnt(5)
v_cvt_pk_bf16_f32 v116, v152, v153
v_mfma_f32_16x16x32_bf16 a[80:83], v[0:3], v[212:215], a[80:83]
ds_read_b64_tr_b16 v[210:211], v12 offset:23040
v_cvt_pk_bf16_f32 v117, v154, v155
v_accvgpr_read_b32 v132, a48
v_mfma_f32_16x16x32_bf16 a[84:87], v[32:35], v[212:215], a[84:87]
v_accvgpr_read_b32 v133, a49
v_accvgpr_read_b32 v134, a50
v_accvgpr_read_b32 v135, a51
v_mfma_f32_16x16x32_bf16 a[88:91], v[64:67], v[212:215], a[88:91]
v_cvt_pk_bf16_f32 v22, v132, v133
v_cvt_pk_bf16_f32 v23, v134, v135
buffer_store_dwordx4 v[20:23], v248, s[20:23], s40 offen offset:1024 sc1
v_mfma_f32_16x16x32_bf16 a[92:95], v[96:99], v[212:215], a[92:95]
ds_read_b64_tr_b16 v[212:213], v14 offset:4608
s_waitcnt lgkmcnt(5)
ds_write_b128 v253, v[20:23] offset:1024
v_mfma_f32_16x16x32_bf16 a[96:99], v[4:7], v[216:219], a[96:99]
ds_read_b64_tr_b16 v[214:215], v14 offset:6656
v_accvgpr_read_b32 v140, a52
v_accvgpr_read_b32 v141, a53
v_mfma_f32_16x16x32_bf16 a[100:103], v[36:39], v[216:219], a[100:103]
v_accvgpr_read_b32 v142, a54
v_accvgpr_read_b32 v143, a55
v_cvt_pk_bf16_f32 v54, v140, v141
v_mfma_f32_16x16x32_bf16 a[104:107], v[68:71], v[216:219], a[104:107]
v_cvt_pk_bf16_f32 v55, v142, v143
buffer_store_dwordx4 v[52:55], v248, s[20:23], s41 offen offset:1024 sc1
v_accvgpr_read_b32 v148, a56
v_mfma_f32_16x16x32_bf16 a[108:111], v[100:103], v[216:219], a[108:111]
ds_read_b64_tr_b16 v[216:217], v14 offset:20992
s_waitcnt lgkmcnt(5)
v_accvgpr_read_b32 v149, a57
v_mfma_f32_16x16x32_bf16 a[96:99], v[8:11], v[220:223], a[96:99]
ds_read_b64_tr_b16 v[218:219], v14 offset:23040
v_accvgpr_read_b32 v150, a58
v_accvgpr_read_b32 v151, a59
v_mfma_f32_16x16x32_bf16 a[100:103], v[40:43], v[220:223], a[100:103]
v_cvt_pk_bf16_f32 v86, v148, v149
v_cvt_pk_bf16_f32 v87, v150, v151
buffer_store_dwordx4 v[84:87], v248, s[20:23], s42 offen offset:1024 sc1
v_mfma_f32_16x16x32_bf16 a[104:107], v[72:75], v[220:223], a[104:107]
v_accvgpr_read_b32 v156, a60
v_accvgpr_read_b32 v157, a61
v_accvgpr_read_b32 v158, a62
v_mfma_f32_16x16x32_bf16 a[108:111], v[104:107], v[220:223], a[108:111]
ds_read_b64_tr_b16 v[220:221], v250 offset:20992
s_waitcnt lgkmcnt(5)
v_accvgpr_read_b32 v159, a63
v_mfma_f32_16x16x32_bf16 a[96:99], v[176:179], v[208:211], a[96:99]
ds_read_b64_tr_b16 v[222:223], v250 offset:23040
v_cvt_pk_bf16_f32 v118, v156, v157
v_cvt_pk_bf16_f32 v119, v158, v159
v_mfma_f32_16x16x32_bf16 a[100:103], v[180:183], v[208:211], a[100:103]
buffer_store_dwordx4 v[116:119], v248, s[20:23], s43 offen offset:1024 sc1
v_accvgpr_read_b32 v128, a64
v_accvgpr_read_b32 v129, a65
v_mfma_f32_16x16x32_bf16 a[104:107], v[184:187], v[208:211], a[104:107]
v_accvgpr_read_b32 v130, a66
v_accvgpr_read_b32 v131, a67
v_cvt_pk_bf16_f32 v24, v128, v129
v_mfma_f32_16x16x32_bf16 a[108:111], v[188:191], v[208:211], a[108:111]
ds_read_b64_tr_b16 v[208:209], v13 offset:4608
s_waitcnt lgkmcnt(5)
v_cvt_pk_bf16_f32 v25, v130, v131
v_mfma_f32_16x16x32_bf16 a[96:99], v[160:163], v[212:215], a[96:99]
ds_read_b64_tr_b16 v[210:211], v13 offset:6656
v_accvgpr_read_b32 v136, a68
v_accvgpr_read_b32 v137, a69
v_mfma_f32_16x16x32_bf16 a[100:103], v[164:167], v[212:215], a[100:103]
v_accvgpr_read_b32 v138, a70
v_accvgpr_read_b32 v139, a71
v_cvt_pk_bf16_f32 v56, v136, v137
v_mfma_f32_16x16x32_bf16 a[104:107], v[168:171], v[212:215], a[104:107]
v_cvt_pk_bf16_f32 v57, v138, v139
v_accvgpr_read_b32 v144, a72
v_accvgpr_read_b32 v145, a73
v_mfma_f32_16x16x32_bf16 a[108:111], v[172:175], v[212:215], a[108:111]
ds_read_b64_tr_b16 v[212:213], v13 offset:20992
s_waitcnt lgkmcnt(5)
v_accvgpr_read_b32 v146, a74
v_mfma_f32_16x16x32_bf16 a[96:99], v[0:3], v[216:219], a[96:99]
ds_read_b64_tr_b16 v[214:215], v13 offset:23040
v_accvgpr_read_b32 v147, a75
v_cvt_pk_bf16_f32 v88, v144, v145
v_mfma_f32_16x16x32_bf16 a[100:103], v[32:35], v[216:219], a[100:103]
v_cvt_pk_bf16_f32 v89, v146, v147
v_accvgpr_read_b32 v152, a76
v_accvgpr_read_b32 v153, a77
v_mfma_f32_16x16x32_bf16 a[104:107], v[64:67], v[216:219], a[104:107]
v_accvgpr_read_b32 v154, a78
v_accvgpr_read_b32 v155, a79
v_cvt_pk_bf16_f32 v120, v152, v153
v_mfma_f32_16x16x32_bf16 a[108:111], v[96:99], v[216:219], a[108:111]
ds_read_b64_tr_b16 v[216:217], v15 offset:4608
s_waitcnt lgkmcnt(5)
v_cvt_pk_bf16_f32 v121, v154, v155
v_mfma_f32_16x16x32_bf16 a[112:115], v[4:7], v[220:223], a[112:115]
ds_read_b64_tr_b16 v[218:219], v15 offset:6656
v_accvgpr_read_b32 v132, a80
v_accvgpr_read_b32 v133, a81
v_mfma_f32_16x16x32_bf16 a[116:119], v[36:39], v[220:223], a[116:119]
v_accvgpr_read_b32 v134, a82
v_accvgpr_read_b32 v135, a83
v_cvt_pk_bf16_f32 v26, v132, v133
v_mfma_f32_16x16x32_bf16 a[120:123], v[68:71], v[220:223], a[120:123]
v_cvt_pk_bf16_f32 v27, v134, v135
buffer_store_dwordx4 v[24:27], v248, s[20:23], s40 offen offset:2048 sc1
ds_write_b128 v253, v[24:27] offset:2048
v_mfma_f32_16x16x32_bf16 a[124:127], v[100:103], v[220:223], a[124:127]
ds_read_b64_tr_b16 v[220:221], v15 offset:20992
s_waitcnt lgkmcnt(5)
v_accvgpr_read_b32 v140, a84
v_mfma_f32_16x16x32_bf16 a[112:115], v[8:11], v[208:211], a[112:115]
ds_read_b64_tr_b16 v[222:223], v15 offset:23040
v_accvgpr_read_b32 v141, a85
v_accvgpr_read_b32 v142, a86
v_mfma_f32_16x16x32_bf16 a[116:119], v[40:43], v[208:211], a[116:119]
v_accvgpr_read_b32 v143, a87
v_cvt_pk_bf16_f32 v58, v140, v141
v_cvt_pk_bf16_f32 v59, v142, v143
v_mfma_f32_16x16x32_bf16 a[120:123], v[72:75], v[208:211], a[120:123]
buffer_store_dwordx4 v[56:59], v248, s[20:23], s41 offen offset:2048 sc1
v_accvgpr_read_b32 v148, a88
v_accvgpr_read_b32 v149, a89
v_mfma_f32_16x16x32_bf16 a[124:127], v[104:107], v[208:211], a[124:127]
ds_read_b64_tr_b16 v[208:209], v249 offset:24576
s_waitcnt lgkmcnt(5)
v_accvgpr_read_b32 v150, a90
v_mfma_f32_16x16x32_bf16 a[112:115], v[176:179], v[212:215], a[112:115]
ds_read_b64_tr_b16 v[210:211], v249 offset:26624
v_accvgpr_read_b32 v151, a91
v_cvt_pk_bf16_f32 v90, v148, v149
v_mfma_f32_16x16x32_bf16 a[116:119], v[180:183], v[212:215], a[116:119]
v_cvt_pk_bf16_f32 v91, v150, v151
buffer_store_dwordx4 v[88:91], v248, s[20:23], s42 offen offset:2048 sc1
v_accvgpr_read_b32 v156, a92
v_mfma_f32_16x16x32_bf16 a[120:123], v[184:187], v[212:215], a[120:123]
v_accvgpr_read_b32 v157, a93
v_accvgpr_read_b32 v158, a94
v_accvgpr_read_b32 v159, a95
v_mfma_f32_16x16x32_bf16 a[124:127], v[188:191], v[212:215], a[124:127]
ds_read_b64_tr_b16 v[212:213], v12 offset:8192
s_waitcnt lgkmcnt(5)
v_cvt_pk_bf16_f32 v122, v156, v157
v_mfma_f32_16x16x32_bf16 a[112:115], v[160:163], v[216:219], a[112:115]
ds_read_b64_tr_b16 v[214:215], v12 offset:10240
v_cvt_pk_bf16_f32 v123, v158, v159
buffer_store_dwordx4 v[120:123], v248, s[20:23], s43 offen offset:2048 sc1
v_mfma_f32_16x16x32_bf16 a[116:119], v[164:167], v[216:219], a[116:119]
v_accvgpr_read_b32 v128, a96
v_accvgpr_read_b32 v129, a97
v_mfma_f32_16x16x32_bf16 a[120:123], v[168:171], v[216:219], a[120:123]
v_accvgpr_read_b32 v130, a98
v_accvgpr_read_b32 v131, a99
v_mfma_f32_16x16x32_bf16 a[124:127], v[172:175], v[216:219], a[124:127]
ds_read_b64_tr_b16 v[216:217], v12 offset:24576
s_waitcnt lgkmcnt(5)
v_mfma_f32_16x16x32_bf16 a[112:115], v[0:3], v[220:223], a[112:115]
ds_read_b64_tr_b16 v[218:219], v12 offset:26624
v_cvt_pk_bf16_f32 v28, v128, v129
v_mfma_f32_16x16x32_bf16 a[116:119], v[32:35], v[220:223], a[116:119]
v_cvt_pk_bf16_f32 v29, v130, v131
v_accvgpr_read_b32 v136, a100
v_mfma_f32_16x16x32_bf16 a[120:123], v[64:67], v[220:223], a[120:123]
v_accvgpr_read_b32 v137, a101
v_accvgpr_read_b32 v138, a102
v_mfma_f32_16x16x32_bf16 a[124:127], v[96:99], v[220:223], a[124:127]
ds_read_b64_tr_b16 v[220:221], v14 offset:8192
s_waitcnt lgkmcnt(5)
v_mfma_f32_16x16x32_bf16 a[128:131], v[4:7], v[208:211], a[128:131]
ds_read_b64_tr_b16 v[222:223], v14 offset:10240
v_accvgpr_read_b32 v139, a103
v_mfma_f32_16x16x32_bf16 a[132:135], v[36:39], v[208:211], a[132:135]
v_cvt_pk_bf16_f32 v60, v136, v137
v_cvt_pk_bf16_f32 v61, v138, v139
v_mfma_f32_16x16x32_bf16 a[136:139], v[68:71], v[208:211], a[136:139]
v_accvgpr_read_b32 v144, a104
v_accvgpr_read_b32 v145, a105
v_mfma_f32_16x16x32_bf16 a[140:143], v[100:103], v[208:211], a[140:143]
ds_read_b64_tr_b16 v[208:209], v14 offset:24576
s_waitcnt lgkmcnt(5)
v_mfma_f32_16x16x32_bf16 a[128:131], v[8:11], v[212:215], a[128:131]
ds_read_b64_tr_b16 v[210:211], v14 offset:26624
v_accvgpr_read_b32 v146, a106
v_mfma_f32_16x16x32_bf16 a[132:135], v[40:43], v[212:215], a[132:135]
v_accvgpr_read_b32 v147, a107
v_cvt_pk_bf16_f32 v92, v144, v145
v_mfma_f32_16x16x32_bf16 a[136:139], v[72:75], v[212:215], a[136:139]
v_cvt_pk_bf16_f32 v93, v146, v147
v_accvgpr_read_b32 v152, a108
v_mfma_f32_16x16x32_bf16 a[140:143], v[104:107], v[212:215], a[140:143]
ds_read_b64_tr_b16 v[212:213], v250 offset:24576
s_waitcnt lgkmcnt(5)
v_mfma_f32_16x16x32_bf16 a[128:131], v[176:179], v[216:219], a[128:131]
ds_read_b64_tr_b16 v[214:215], v250 offset:26624
v_accvgpr_read_b32 v153, a109
v_mfma_f32_16x16x32_bf16 a[132:135], v[180:183], v[216:219], a[132:135]
v_accvgpr_read_b32 v154, a110
v_accvgpr_read_b32 v155, a111
v_mfma_f32_16x16x32_bf16 a[136:139], v[184:187], v[216:219], a[136:139]
v_cvt_pk_bf16_f32 v124, v152, v153
v_cvt_pk_bf16_f32 v125, v154, v155
v_mfma_f32_16x16x32_bf16 a[140:143], v[188:191], v[216:219], a[140:143]
ds_read_b64_tr_b16 v[216:217], v13 offset:8192
s_waitcnt lgkmcnt(5)
v_mfma_f32_16x16x32_bf16 a[128:131], v[160:163], v[220:223], a[128:131]
ds_read_b64_tr_b16 v[218:219], v13 offset:10240
v_accvgpr_read_b32 v132, a112
v_mfma_f32_16x16x32_bf16 a[132:135], v[164:167], v[220:223], a[132:135]
v_accvgpr_read_b32 v133, a113
v_accvgpr_read_b32 v134, a114
v_mfma_f32_16x16x32_bf16 a[136:139], v[168:171], v[220:223], a[136:139]
v_accvgpr_read_b32 v135, a115
v_cvt_pk_bf16_f32 v30, v132, v133
v_mfma_f32_16x16x32_bf16 a[140:143], v[172:175], v[220:223], a[140:143]
ds_read_b64_tr_b16 v[220:221], v13 offset:24576
s_waitcnt lgkmcnt(5)
v_mfma_f32_16x16x32_bf16 a[128:131], v[0:3], v[208:211], a[128:131]
ds_read_b64_tr_b16 v[222:223], v13 offset:26624
v_cvt_pk_bf16_f32 v31, v134, v135
v_mfma_f32_16x16x32_bf16 a[132:135], v[32:35], v[208:211], a[132:135]
buffer_store_dwordx4 v[28:31], v248, s[20:23], s40 offen offset:3072 sc1
ds_write_b128 v253, v[28:31] offset:3072
v_mfma_f32_16x16x32_bf16 a[136:139], v[64:67], v[208:211], a[136:139]
v_accvgpr_read_b32 v140, a116
v_accvgpr_read_b32 v141, a117
v_mfma_f32_16x16x32_bf16 a[140:143], v[96:99], v[208:211], a[140:143]
ds_read_b64_tr_b16 v[208:209], v15 offset:8192
s_waitcnt lgkmcnt(5)
v_mfma_f32_16x16x32_bf16 a[144:147], v[4:7], v[212:215], a[144:147]
ds_read_b64_tr_b16 v[210:211], v15 offset:10240
v_accvgpr_read_b32 v142, a118
v_mfma_f32_16x16x32_bf16 a[148:151], v[36:39], v[212:215], a[148:151]
v_accvgpr_read_b32 v143, a119
v_cvt_pk_bf16_f32 v62, v140, v141
v_mfma_f32_16x16x32_bf16 a[152:155], v[68:71], v[212:215], a[152:155]
v_cvt_pk_bf16_f32 v63, v142, v143
buffer_store_dwordx4 v[60:63], v248, s[20:23], s41 offen offset:3072 sc1
v_mfma_f32_16x16x32_bf16 a[156:159], v[100:103], v[212:215], a[156:159]
ds_read_b64_tr_b16 v[212:213], v15 offset:24576
s_waitcnt lgkmcnt(5)
v_mfma_f32_16x16x32_bf16 a[144:147], v[8:11], v[216:219], a[144:147]
ds_read_b64_tr_b16 v[214:215], v15 offset:26624
v_accvgpr_read_b32 v148, a120
v_mfma_f32_16x16x32_bf16 a[148:151], v[40:43], v[216:219], a[148:151]
v_accvgpr_read_b32 v149, a121
v_accvgpr_read_b32 v150, a122
v_mfma_f32_16x16x32_bf16 a[152:155], v[72:75], v[216:219], a[152:155]
v_accvgpr_read_b32 v151, a123
v_cvt_pk_bf16_f32 v94, v148, v149
v_mfma_f32_16x16x32_bf16 a[156:159], v[104:107], v[216:219], a[156:159]
ds_read_b64_tr_b16 v[216:217], v249 offset:25088
s_waitcnt lgkmcnt(5)
v_mfma_f32_16x16x32_bf16 a[144:147], v[176:179], v[220:223], a[144:147]
ds_read_b64_tr_b16 v[218:219], v249 offset:27136
v_cvt_pk_bf16_f32 v95, v150, v151
v_mfma_f32_16x16x32_bf16 a[148:151], v[180:183], v[220:223], a[148:151]
buffer_store_dwordx4 v[92:95], v248, s[20:23], s42 offen offset:3072 sc1
v_accvgpr_read_b32 v156, a124
v_mfma_f32_16x16x32_bf16 a[152:155], v[184:187], v[220:223], a[152:155]
v_accvgpr_read_b32 v157, a125
v_accvgpr_read_b32 v158, a126
v_mfma_f32_16x16x32_bf16 a[156:159], v[188:191], v[220:223], a[156:159]
ds_read_b64_tr_b16 v[220:221], v12 offset:8704
s_waitcnt lgkmcnt(5)
v_mfma_f32_16x16x32_bf16 a[144:147], v[160:163], v[208:211], a[144:147]
ds_read_b64_tr_b16 v[222:223], v12 offset:10752
v_accvgpr_read_b32 v159, a127
v_mfma_f32_16x16x32_bf16 a[148:151], v[164:167], v[208:211], a[148:151]
v_cvt_pk_bf16_f32 v126, v156, v157
v_cvt_pk_bf16_f32 v127, v158, v159
v_mfma_f32_16x16x32_bf16 a[152:155], v[168:171], v[208:211], a[152:155]
buffer_store_dwordx4 v[124:127], v248, s[20:23], s43 offen offset:3072 sc1
v_accvgpr_read_b32 v128, a128
v_mfma_f32_16x16x32_bf16 a[156:159], v[172:175], v[208:211], a[156:159]
ds_read_b64_tr_b16 v[208:209], v12 offset:25088
s_waitcnt lgkmcnt(5)
v_mfma_f32_16x16x32_bf16 a[144:147], v[0:3], v[212:215], a[144:147]
ds_read_b64_tr_b16 v[210:211], v12 offset:27136
v_accvgpr_read_b32 v129, a129
v_mfma_f32_16x16x32_bf16 a[148:151], v[32:35], v[212:215], a[148:151]
v_accvgpr_read_b32 v130, a130
v_accvgpr_read_b32 v131, a131
v_mfma_f32_16x16x32_bf16 a[152:155], v[64:67], v[212:215], a[152:155]
v_cvt_pk_bf16_f32 v16, v128, v129
v_cvt_pk_bf16_f32 v17, v130, v131
v_mfma_f32_16x16x32_bf16 a[156:159], v[96:99], v[212:215], a[156:159]
ds_read_b64_tr_b16 v[212:213], v14 offset:8704
s_waitcnt lgkmcnt(5)
v_mfma_f32_16x16x32_bf16 a[160:163], v[4:7], v[216:219], a[160:163]
ds_read_b64_tr_b16 v[214:215], v14 offset:10752
v_accvgpr_read_b32 v136, a132
v_mfma_f32_16x16x32_bf16 a[164:167], v[36:39], v[216:219], a[164:167]
v_accvgpr_read_b32 v137, a133
v_accvgpr_read_b32 v138, a134
v_mfma_f32_16x16x32_bf16 a[168:171], v[68:71], v[216:219], a[168:171]
v_accvgpr_read_b32 v139, a135
v_cvt_pk_bf16_f32 v48, v136, v137
v_mfma_f32_16x16x32_bf16 a[172:175], v[100:103], v[216:219], a[172:175]
ds_read_b64_tr_b16 v[216:217], v14 offset:25088
s_waitcnt lgkmcnt(5)
v_mfma_f32_16x16x32_bf16 a[160:163], v[8:11], v[220:223], a[160:163]
ds_read_b64_tr_b16 v[218:219], v14 offset:27136
v_cvt_pk_bf16_f32 v49, v138, v139
v_mfma_f32_16x16x32_bf16 a[164:167], v[40:43], v[220:223], a[164:167]
v_accvgpr_read_b32 v144, a136
v_accvgpr_read_b32 v145, a137
v_mfma_f32_16x16x32_bf16 a[168:171], v[72:75], v[220:223], a[168:171]
v_accvgpr_read_b32 v146, a138
v_accvgpr_read_b32 v147, a139
v_mfma_f32_16x16x32_bf16 a[172:175], v[104:107], v[220:223], a[172:175]
ds_read_b64_tr_b16 v[220:221], v250 offset:25088
s_waitcnt lgkmcnt(5)
v_mfma_f32_16x16x32_bf16 a[160:163], v[176:179], v[208:211], a[160:163]
ds_read_b64_tr_b16 v[222:223], v250 offset:27136
v_cvt_pk_bf16_f32 v80, v144, v145
v_mfma_f32_16x16x32_bf16 a[164:167], v[180:183], v[208:211], a[164:167]
v_cvt_pk_bf16_f32 v81, v146, v147
v_accvgpr_read_b32 v152, a140
v_mfma_f32_16x16x32_bf16 a[168:171], v[184:187], v[208:211], a[168:171]
v_accvgpr_read_b32 v153, a141
v_accvgpr_read_b32 v154, a142
v_mfma_f32_16x16x32_bf16 a[172:175], v[188:191], v[208:211], a[172:175]
ds_read_b64_tr_b16 v[208:209], v13 offset:8704
s_waitcnt lgkmcnt(5)
v_mfma_f32_16x16x32_bf16 a[160:163], v[160:163], v[212:215], a[160:163]
ds_read_b64_tr_b16 v[210:211], v13 offset:10752
v_accvgpr_read_b32 v155, a143
v_mfma_f32_16x16x32_bf16 a[164:167], v[164:167], v[212:215], a[164:167]
v_cvt_pk_bf16_f32 v112, v152, v153
v_cvt_pk_bf16_f32 v113, v154, v155
v_mfma_f32_16x16x32_bf16 a[168:171], v[168:171], v[212:215], a[168:171]
v_accvgpr_read_b32 v132, a144
v_accvgpr_read_b32 v133, a145
v_mfma_f32_16x16x32_bf16 a[172:175], v[172:175], v[212:215], a[172:175]
ds_read_b64_tr_b16 v[212:213], v13 offset:25088
s_waitcnt lgkmcnt(5)
v_mfma_f32_16x16x32_bf16 a[160:163], v[0:3], v[216:219], a[160:163]
ds_read_b64_tr_b16 v[214:215], v13 offset:27136
v_accvgpr_read_b32 v134, a146
v_mfma_f32_16x16x32_bf16 a[164:167], v[32:35], v[216:219], a[164:167]
v_accvgpr_read_b32 v135, a147
v_cvt_pk_bf16_f32 v18, v132, v133
v_mfma_f32_16x16x32_bf16 a[168:171], v[64:67], v[216:219], a[168:171]
v_cvt_pk_bf16_f32 v19, v134, v135
buffer_store_dwordx4 v[16:19], v248, s[20:23], s44 offen offset:0 sc1
v_mfma_f32_16x16x32_bf16 a[172:175], v[96:99], v[216:219], a[172:175]
ds_read_b64_tr_b16 v[216:217], v15 offset:8704
s_waitcnt lgkmcnt(5)
v_mfma_f32_16x16x32_bf16 a[176:179], v[4:7], v[220:223], a[176:179]
ds_read_b64_tr_b16 v[218:219], v15 offset:10752
ds_write_b128 v253, v[16:19] offset:4096
v_mfma_f32_16x16x32_bf16 a[180:183], v[36:39], v[220:223], a[180:183]
v_accvgpr_read_b32 v140, a148
v_accvgpr_read_b32 v141, a149
v_mfma_f32_16x16x32_bf16 a[184:187], v[68:71], v[220:223], a[184:187]
v_accvgpr_read_b32 v142, a150
v_accvgpr_read_b32 v143, a151
v_mfma_f32_16x16x32_bf16 a[188:191], v[100:103], v[220:223], a[188:191]
ds_read_b64_tr_b16 v[220:221], v15 offset:25088
s_waitcnt lgkmcnt(5)
v_mfma_f32_16x16x32_bf16 a[176:179], v[8:11], v[208:211], a[176:179]
ds_read_b64_tr_b16 v[222:223], v15 offset:27136
v_cvt_pk_bf16_f32 v50, v140, v141
v_mfma_f32_16x16x32_bf16 a[180:183], v[40:43], v[208:211], a[180:183]
v_cvt_pk_bf16_f32 v51, v142, v143
buffer_store_dwordx4 v[48:51], v248, s[20:23], s45 offen offset:0 sc1
v_mfma_f32_16x16x32_bf16 a[184:187], v[72:75], v[208:211], a[184:187]
v_accvgpr_read_b32 v148, a152
v_accvgpr_read_b32 v149, a153
v_mfma_f32_16x16x32_bf16 a[188:191], v[104:107], v[208:211], a[188:191]
ds_read_b64_tr_b16 v[208:209], v249 offset:28672
s_waitcnt lgkmcnt(5)
v_mfma_f32_16x16x32_bf16 a[176:179], v[176:179], v[212:215], a[176:179]
ds_read_b64_tr_b16 v[210:211], v249 offset:30720
v_accvgpr_read_b32 v150, a154
v_mfma_f32_16x16x32_bf16 a[180:183], v[180:183], v[212:215], a[180:183]
v_accvgpr_read_b32 v151, a155
v_cvt_pk_bf16_f32 v82, v148, v149
v_mfma_f32_16x16x32_bf16 a[184:187], v[184:187], v[212:215], a[184:187]
v_cvt_pk_bf16_f32 v83, v150, v151
buffer_store_dwordx4 v[80:83], v248, s[20:23], s46 offen offset:0 sc1
v_mfma_f32_16x16x32_bf16 a[188:191], v[188:191], v[212:215], a[188:191]
ds_read_b64_tr_b16 v[212:213], v12 offset:12288
s_waitcnt lgkmcnt(5)
v_mfma_f32_16x16x32_bf16 a[176:179], v[160:163], v[216:219], a[176:179]
ds_read_b64_tr_b16 v[214:215], v12 offset:14336
v_accvgpr_read_b32 v156, a156
v_mfma_f32_16x16x32_bf16 a[180:183], v[164:167], v[216:219], a[180:183]
v_accvgpr_read_b32 v157, a157
v_accvgpr_read_b32 v158, a158
v_mfma_f32_16x16x32_bf16 a[184:187], v[168:171], v[216:219], a[184:187]
v_accvgpr_read_b32 v159, a159
v_cvt_pk_bf16_f32 v114, v156, v157
v_mfma_f32_16x16x32_bf16 a[188:191], v[172:175], v[216:219], a[188:191]
ds_read_b64_tr_b16 v[216:217], v12 offset:28672
s_waitcnt lgkmcnt(5)
v_mfma_f32_16x16x32_bf16 a[176:179], v[0:3], v[220:223], a[176:179]
ds_read_b64_tr_b16 v[218:219], v12 offset:30720
v_cvt_pk_bf16_f32 v115, v158, v159
v_mfma_f32_16x16x32_bf16 a[180:183], v[32:35], v[220:223], a[180:183]
buffer_store_dwordx4 v[112:115], v248, s[20:23], s47 offen offset:0 sc1
v_accvgpr_read_b32 v128, a160
v_mfma_f32_16x16x32_bf16 a[184:187], v[64:67], v[220:223], a[184:187]
v_accvgpr_read_b32 v129, a161
v_accvgpr_read_b32 v130, a162
v_mfma_f32_16x16x32_bf16 a[188:191], v[96:99], v[220:223], a[188:191]
ds_read_b64_tr_b16 v[220:221], v14 offset:12288
s_waitcnt lgkmcnt(5)
v_mfma_f32_16x16x32_bf16 a[192:195], v[4:7], v[208:211], a[192:195]
ds_read_b64_tr_b16 v[222:223], v14 offset:14336
v_accvgpr_read_b32 v131, a163
v_mfma_f32_16x16x32_bf16 a[196:199], v[36:39], v[208:211], a[196:199]
v_cvt_pk_bf16_f32 v20, v128, v129
v_cvt_pk_bf16_f32 v21, v130, v131
v_mfma_f32_16x16x32_bf16 a[200:203], v[68:71], v[208:211], a[200:203]
v_accvgpr_read_b32 v136, a164
v_accvgpr_read_b32 v137, a165
v_mfma_f32_16x16x32_bf16 a[204:207], v[100:103], v[208:211], a[204:207]
ds_read_b64_tr_b16 v[208:209], v14 offset:28672
s_waitcnt lgkmcnt(5)
v_mfma_f32_16x16x32_bf16 a[192:195], v[8:11], v[212:215], a[192:195]
ds_read_b64_tr_b16 v[210:211], v14 offset:30720
v_accvgpr_read_b32 v138, a166
v_mfma_f32_16x16x32_bf16 a[196:199], v[40:43], v[212:215], a[196:199]
v_accvgpr_read_b32 v139, a167
v_cvt_pk_bf16_f32 v52, v136, v137
v_mfma_f32_16x16x32_bf16 a[200:203], v[72:75], v[212:215], a[200:203]
v_cvt_pk_bf16_f32 v53, v138, v139
v_accvgpr_read_b32 v144, a168
v_mfma_f32_16x16x32_bf16 a[204:207], v[104:107], v[212:215], a[204:207]
ds_read_b64_tr_b16 v[212:213], v250 offset:28672
s_waitcnt lgkmcnt(5)
v_mfma_f32_16x16x32_bf16 a[192:195], v[176:179], v[216:219], a[192:195]
ds_read_b64_tr_b16 v[214:215], v250 offset:30720
v_accvgpr_read_b32 v145, a169
v_mfma_f32_16x16x32_bf16 a[196:199], v[180:183], v[216:219], a[196:199]
v_accvgpr_read_b32 v146, a170
v_accvgpr_read_b32 v147, a171
v_mfma_f32_16x16x32_bf16 a[200:203], v[184:187], v[216:219], a[200:203]
v_cvt_pk_bf16_f32 v84, v144, v145
v_cvt_pk_bf16_f32 v85, v146, v147
v_mfma_f32_16x16x32_bf16 a[204:207], v[188:191], v[216:219], a[204:207]
ds_read_b64_tr_b16 v[216:217], v13 offset:12288
s_waitcnt lgkmcnt(5)
v_mfma_f32_16x16x32_bf16 a[192:195], v[160:163], v[220:223], a[192:195]
ds_read_b64_tr_b16 v[218:219], v13 offset:14336
v_accvgpr_read_b32 v152, a172
v_mfma_f32_16x16x32_bf16 a[196:199], v[164:167], v[220:223], a[196:199]
v_accvgpr_read_b32 v153, a173
v_accvgpr_read_b32 v154, a174
v_mfma_f32_16x16x32_bf16 a[200:203], v[168:171], v[220:223], a[200:203]
v_accvgpr_read_b32 v155, a175
v_cvt_pk_bf16_f32 v116, v152, v153
v_mfma_f32_16x16x32_bf16 a[204:207], v[172:175], v[220:223], a[204:207]
ds_read_b64_tr_b16 v[220:221], v13 offset:28672
s_waitcnt lgkmcnt(5)
v_mfma_f32_16x16x32_bf16 a[192:195], v[0:3], v[208:211], a[192:195]
ds_read_b64_tr_b16 v[222:223], v13 offset:30720
v_cvt_pk_bf16_f32 v117, v154, v155
v_mfma_f32_16x16x32_bf16 a[196:199], v[32:35], v[208:211], a[196:199]
v_accvgpr_read_b32 v132, a176
v_accvgpr_read_b32 v133, a177
v_mfma_f32_16x16x32_bf16 a[200:203], v[64:67], v[208:211], a[200:203]
v_accvgpr_read_b32 v134, a178
v_accvgpr_read_b32 v135, a179
v_mfma_f32_16x16x32_bf16 a[204:207], v[96:99], v[208:211], a[204:207]
ds_read_b64_tr_b16 v[208:209], v15 offset:12288
s_waitcnt lgkmcnt(5)
v_mfma_f32_16x16x32_bf16 a[208:211], v[4:7], v[212:215], a[208:211]
ds_read_b64_tr_b16 v[210:211], v15 offset:14336
v_cvt_pk_bf16_f32 v22, v132, v133
v_mfma_f32_16x16x32_bf16 a[212:215], v[36:39], v[212:215], a[212:215]
v_cvt_pk_bf16_f32 v23, v134, v135
buffer_store_dwordx4 v[20:23], v248, s[20:23], s44 offen offset:1024 sc1
v_mfma_f32_16x16x32_bf16 a[216:219], v[68:71], v[212:215], a[216:219]
ds_write_b128 v253, v[20:23] offset:5120
v_accvgpr_read_b32 v140, a180
v_mfma_f32_16x16x32_bf16 a[220:223], v[100:103], v[212:215], a[220:223]
ds_read_b64_tr_b16 v[212:213], v15 offset:28672
s_waitcnt lgkmcnt(5)
v_mfma_f32_16x16x32_bf16 a[208:211], v[8:11], v[216:219], a[208:211]
ds_read_b64_tr_b16 v[214:215], v15 offset:30720
v_accvgpr_read_b32 v141, a181
v_mfma_f32_16x16x32_bf16 a[212:215], v[40:43], v[216:219], a[212:215]
v_accvgpr_read_b32 v142, a182
v_accvgpr_read_b32 v143, a183
v_mfma_f32_16x16x32_bf16 a[216:219], v[72:75], v[216:219], a[216:219]
v_cvt_pk_bf16_f32 v54, v140, v141
v_cvt_pk_bf16_f32 v55, v142, v143
v_mfma_f32_16x16x32_bf16 a[220:223], v[104:107], v[216:219], a[220:223]
ds_read_b64_tr_b16 v[216:217], v249 offset:29184
s_waitcnt lgkmcnt(5)
v_mfma_f32_16x16x32_bf16 a[208:211], v[176:179], v[220:223], a[208:211]
ds_read_b64_tr_b16 v[218:219], v249 offset:31232
buffer_store_dwordx4 v[52:55], v248, s[20:23], s45 offen offset:1024 sc1
v_mfma_f32_16x16x32_bf16 a[212:215], v[180:183], v[220:223], a[212:215]
v_accvgpr_read_b32 v148, a184
v_accvgpr_read_b32 v149, a185
v_mfma_f32_16x16x32_bf16 a[216:219], v[184:187], v[220:223], a[216:219]
v_accvgpr_read_b32 v150, a186
v_accvgpr_read_b32 v151, a187
v_mfma_f32_16x16x32_bf16 a[220:223], v[188:191], v[220:223], a[220:223]
ds_read_b64_tr_b16 v[220:221], v12 offset:12800
s_waitcnt lgkmcnt(5)
v_mfma_f32_16x16x32_bf16 a[208:211], v[160:163], v[208:211], a[208:211]
ds_read_b64_tr_b16 v[222:223], v12 offset:14848
v_cvt_pk_bf16_f32 v86, v148, v149
v_mfma_f32_16x16x32_bf16 a[212:215], v[164:167], v[208:211], a[212:215]
v_cvt_pk_bf16_f32 v87, v150, v151
buffer_store_dwordx4 v[84:87], v248, s[20:23], s46 offen offset:1024 sc1
v_mfma_f32_16x16x32_bf16 a[216:219], v[168:171], v[208:211], a[216:219]
v_accvgpr_read_b32 v156, a188
v_accvgpr_read_b32 v157, a189
v_mfma_f32_16x16x32_bf16 a[220:223], v[172:175], v[208:211], a[220:223]
ds_read_b64_tr_b16 v[208:209], v12 offset:29184
s_waitcnt lgkmcnt(5)
v_mfma_f32_16x16x32_bf16 a[208:211], v[0:3], v[212:215], a[208:211]
ds_read_b64_tr_b16 v[210:211], v12 offset:31232
v_accvgpr_read_b32 v158, a190
v_mfma_f32_16x16x32_bf16 a[212:215], v[32:35], v[212:215], a[212:215]
v_accvgpr_read_b32 v159, a191
v_cvt_pk_bf16_f32 v118, v156, v157
v_mfma_f32_16x16x32_bf16 a[216:219], v[64:67], v[212:215], a[216:219]
v_cvt_pk_bf16_f32 v119, v158, v159
buffer_store_dwordx4 v[116:119], v248, s[20:23], s47 offen offset:1024 sc1
v_mfma_f32_16x16x32_bf16 a[220:223], v[96:99], v[212:215], a[220:223]
ds_read_b64_tr_b16 v[212:213], v14 offset:12800
s_waitcnt lgkmcnt(5)
v_mfma_f32_16x16x32_bf16 a[224:227], v[4:7], v[216:219], a[224:227]
ds_read_b64_tr_b16 v[214:215], v14 offset:14848
v_accvgpr_read_b32 v128, a192
v_mfma_f32_16x16x32_bf16 a[228:231], v[36:39], v[216:219], a[228:231]
v_accvgpr_read_b32 v129, a193
v_accvgpr_read_b32 v130, a194
v_mfma_f32_16x16x32_bf16 a[232:235], v[68:71], v[216:219], a[232:235]
v_accvgpr_read_b32 v131, a195
v_cvt_pk_bf16_f32 v24, v128, v129
v_mfma_f32_16x16x32_bf16 a[236:239], v[100:103], v[216:219], a[236:239]
ds_read_b64_tr_b16 v[216:217], v14 offset:29184
s_waitcnt lgkmcnt(5)
v_mfma_f32_16x16x32_bf16 a[224:227], v[8:11], v[220:223], a[224:227]
ds_read_b64_tr_b16 v[218:219], v14 offset:31232
v_cvt_pk_bf16_f32 v25, v130, v131
v_mfma_f32_16x16x32_bf16 a[228:231], v[40:43], v[220:223], a[228:231]
v_accvgpr_read_b32 v136, a196
v_accvgpr_read_b32 v137, a197
v_mfma_f32_16x16x32_bf16 a[232:235], v[72:75], v[220:223], a[232:235]
v_accvgpr_read_b32 v138, a198
v_accvgpr_read_b32 v139, a199
v_mfma_f32_16x16x32_bf16 a[236:239], v[104:107], v[220:223], a[236:239]
ds_read_b64_tr_b16 v[220:221], v250 offset:29184
s_waitcnt lgkmcnt(5)
v_mfma_f32_16x16x32_bf16 a[224:227], v[176:179], v[208:211], a[224:227]
ds_read_b64_tr_b16 v[222:223], v250 offset:31232
v_cvt_pk_bf16_f32 v56, v136, v137
v_mfma_f32_16x16x32_bf16 a[228:231], v[180:183], v[208:211], a[228:231]
v_cvt_pk_bf16_f32 v57, v138, v139
v_accvgpr_read_b32 v144, a200
v_mfma_f32_16x16x32_bf16 a[232:235], v[184:187], v[208:211], a[232:235]
v_accvgpr_read_b32 v145, a201
v_accvgpr_read_b32 v146, a202
v_mfma_f32_16x16x32_bf16 a[236:239], v[188:191], v[208:211], a[236:239]
ds_read_b64_tr_b16 v[208:209], v13 offset:12800
s_waitcnt lgkmcnt(5)
v_mfma_f32_16x16x32_bf16 a[224:227], v[160:163], v[212:215], a[224:227]
ds_read_b64_tr_b16 v[210:211], v13 offset:14848
v_accvgpr_read_b32 v147, a203
v_mfma_f32_16x16x32_bf16 a[228:231], v[164:167], v[212:215], a[228:231]
v_cvt_pk_bf16_f32 v88, v144, v145
v_cvt_pk_bf16_f32 v89, v146, v147
v_mfma_f32_16x16x32_bf16 a[232:235], v[168:171], v[212:215], a[232:235]
v_accvgpr_read_b32 v152, a204
v_accvgpr_read_b32 v153, a205
v_mfma_f32_16x16x32_bf16 a[236:239], v[172:175], v[212:215], a[236:239]
ds_read_b64_tr_b16 v[212:213], v13 offset:29184
s_waitcnt lgkmcnt(5)
v_mfma_f32_16x16x32_bf16 a[224:227], v[0:3], v[216:219], a[224:227]
ds_read_b64_tr_b16 v[214:215], v13 offset:31232
v_accvgpr_read_b32 v154, a206
v_mfma_f32_16x16x32_bf16 a[228:231], v[32:35], v[216:219], a[228:231]
v_accvgpr_read_b32 v155, a207
v_cvt_pk_bf16_f32 v120, v152, v153
v_mfma_f32_16x16x32_bf16 a[232:235], v[64:67], v[216:219], a[232:235]
v_cvt_pk_bf16_f32 v121, v154, v155
v_accvgpr_read_b32 v132, a208
v_mfma_f32_16x16x32_bf16 a[236:239], v[96:99], v[216:219], a[236:239]
ds_read_b64_tr_b16 v[216:217], v15 offset:12800
s_waitcnt lgkmcnt(5)
v_mfma_f32_16x16x32_bf16 a[240:243], v[4:7], v[220:223], a[240:243]
ds_read_b64_tr_b16 v[218:219], v15 offset:14848
v_accvgpr_read_b32 v133, a209
v_mfma_f32_16x16x32_bf16 a[244:247], v[36:39], v[220:223], a[244:247]
v_accvgpr_read_b32 v134, a210
v_accvgpr_read_b32 v135, a211
v_mfma_f32_16x16x32_bf16 a[248:251], v[68:71], v[220:223], a[248:251]
v_cvt_pk_bf16_f32 v26, v132, v133
v_cvt_pk_bf16_f32 v27, v134, v135
v_mfma_f32_16x16x32_bf16 a[252:255], v[100:103], v[220:223], a[252:255]
ds_read_b64_tr_b16 v[220:221], v15 offset:29184
s_waitcnt lgkmcnt(5)
v_mfma_f32_16x16x32_bf16 a[240:243], v[8:11], v[208:211], a[240:243]
ds_read_b64_tr_b16 v[222:223], v15 offset:31232
buffer_store_dwordx4 v[24:27], v248, s[20:23], s44 offen offset:2048 sc1
v_mfma_f32_16x16x32_bf16 a[244:247], v[40:43], v[208:211], a[244:247]
ds_write_b128 v253, v[24:27] offset:6144
v_accvgpr_read_b32 v140, a212
v_mfma_f32_16x16x32_bf16 a[248:251], v[72:75], v[208:211], a[248:251]
v_accvgpr_read_b32 v141, a213
v_accvgpr_read_b32 v142, a214
v_mfma_f32_16x16x32_bf16 a[252:255], v[104:107], v[208:211], a[252:255]
s_waitcnt lgkmcnt(4)
v_accvgpr_read_b32 v143, a215
v_mfma_f32_16x16x32_bf16 a[240:243], v[176:179], v[212:215], a[240:243]
v_cvt_pk_bf16_f32 v58, v140, v141
v_cvt_pk_bf16_f32 v59, v142, v143
v_mfma_f32_16x16x32_bf16 a[244:247], v[180:183], v[212:215], a[244:247]
buffer_store_dwordx4 v[56:59], v248, s[20:23], s45 offen offset:2048 sc1
v_accvgpr_read_b32 v148, a216
v_mfma_f32_16x16x32_bf16 a[248:251], v[184:187], v[212:215], a[248:251]
v_accvgpr_read_b32 v149, a217
v_accvgpr_read_b32 v150, a218
v_mfma_f32_16x16x32_bf16 a[252:255], v[188:191], v[212:215], a[252:255]
s_waitcnt lgkmcnt(2)
v_accvgpr_read_b32 v151, a219
v_mfma_f32_16x16x32_bf16 a[240:243], v[160:163], v[216:219], a[240:243]
v_cvt_pk_bf16_f32 v90, v148, v149
v_cvt_pk_bf16_f32 v91, v150, v151
v_mfma_f32_16x16x32_bf16 a[244:247], v[164:167], v[216:219], a[244:247]
buffer_store_dwordx4 v[88:91], v248, s[20:23], s46 offen offset:2048 sc1
v_accvgpr_read_b32 v156, a220
v_mfma_f32_16x16x32_bf16 a[248:251], v[168:171], v[216:219], a[248:251]
v_accvgpr_read_b32 v157, a221
v_accvgpr_read_b32 v158, a222
v_mfma_f32_16x16x32_bf16 a[252:255], v[172:175], v[216:219], a[252:255]
s_waitcnt lgkmcnt(0)
v_accvgpr_read_b32 v159, a223
v_mfma_f32_16x16x32_bf16 a[240:243], v[0:3], v[220:223], a[240:243]
v_cvt_pk_bf16_f32 v122, v156, v157
v_cvt_pk_bf16_f32 v123, v158, v159
v_mfma_f32_16x16x32_bf16 a[244:247], v[32:35], v[220:223], a[244:247]
buffer_store_dwordx4 v[120:123], v248, s[20:23], s47 offen offset:2048 sc1
v_accvgpr_read_b32 v128, a224
v_mfma_f32_16x16x32_bf16 a[248:251], v[64:67], v[220:223], a[248:251]
v_accvgpr_read_b32 v129, a225
v_accvgpr_read_b32 v130, a226
v_mfma_f32_16x16x32_bf16 a[252:255], v[96:99], v[220:223], a[252:255]
v_accvgpr_read_b32 v131, a227
v_cvt_pk_bf16_f32 v28, v128, v129
v_cvt_pk_bf16_f32 v29, v130, v131
v_accvgpr_read_b32 v136, a228
v_accvgpr_read_b32 v137, a229
v_accvgpr_read_b32 v138, a230
v_accvgpr_read_b32 v139, a231
v_cvt_pk_bf16_f32 v60, v136, v137
v_cvt_pk_bf16_f32 v61, v138, v139
v_accvgpr_read_b32 v144, a232
v_accvgpr_read_b32 v145, a233
v_accvgpr_read_b32 v146, a234
v_accvgpr_read_b32 v147, a235
v_cvt_pk_bf16_f32 v92, v144, v145
v_cvt_pk_bf16_f32 v93, v146, v147
v_accvgpr_read_b32 v152, a236
v_accvgpr_read_b32 v153, a237
v_accvgpr_read_b32 v154, a238
v_accvgpr_read_b32 v155, a239
v_cvt_pk_bf16_f32 v124, v152, v153
v_cvt_pk_bf16_f32 v125, v154, v155
v_accvgpr_read_b32 v132, a240
v_accvgpr_read_b32 v133, a241
v_accvgpr_read_b32 v134, a242
v_accvgpr_read_b32 v135, a243
v_cvt_pk_bf16_f32 v30, v132, v133
v_cvt_pk_bf16_f32 v31, v134, v135
buffer_store_dwordx4 v[28:31], v248, s[20:23], s44 offen offset:3072 sc1
ds_write_b128 v253, v[28:31] offset:7168
v_accvgpr_read_b32 v140, a244
v_accvgpr_read_b32 v141, a245
v_accvgpr_read_b32 v142, a246
v_accvgpr_read_b32 v143, a247
v_cvt_pk_bf16_f32 v62, v140, v141
v_cvt_pk_bf16_f32 v63, v142, v143
buffer_store_dwordx4 v[60:63], v248, s[20:23], s45 offen offset:3072 sc1
v_accvgpr_read_b32 v148, a248
v_accvgpr_read_b32 v149, a249
v_accvgpr_read_b32 v150, a250
v_accvgpr_read_b32 v151, a251
v_cvt_pk_bf16_f32 v94, v148, v149
v_cvt_pk_bf16_f32 v95, v150, v151
buffer_store_dwordx4 v[92:95], v248, s[20:23], s46 offen offset:3072 sc1
v_accvgpr_read_b32 v156, a252
v_accvgpr_read_b32 v157, a253
v_accvgpr_read_b32 v158, a254
v_accvgpr_read_b32 v159, a255
v_cvt_pk_bf16_f32 v126, v156, v157
v_cvt_pk_bf16_f32 v127, v158, v159
buffer_store_dwordx4 v[124:127], v248, s[20:23], s47 offen offset:3072 sc1
s_waitcnt vmcnt(36)
s_branch L2_F
L2_F:
v_cmp_ne_u64 vcc, s[98:99], v[108:109]
s_lshl_b32 s3, s34, 15
s_add_u32 s3, s3, 0x1000000
s_cbranch_vccnz LF_wf
LF_wf_go:
v_add_u32 v240, s3, v248
v_add_u32 v241, 0x4000, v240
s_mov_b32 s32, 0x0
s_mov_b32 s33, 0x1000
s_mov_b32 s35, 0x2000
s_mov_b32 s36, 0x3000
s_mov_b32 s38, 0x20000
s_mov_b32 s39, 0x21000
s_mov_b32 s40, 0x22000
s_mov_b32 s41, 0x23000
s_lshr_b32 s42, s6, 13
s_lshr_b32 s43, s7, 13
s_lshr_b32 s44, s29, 13
v_mov_b32 v244, s42
v_mov_b32 v232, s43
v_cmp_lt_u32 vcc, 0xff, v248
v_mov_b32 v233, s44
s_nop 0
v_cndmask_b32 v244, v244, v232, vcc
v_cmp_lt_u32 vcc, 0x1ff, v248
v_and_b32 v235, 0xf0, v248
s_nop 0
v_cndmask_b32 v244, v244, v233, vcc
v_lshlrev_b32 v244, 11, v244
v_lshl_add_u32 v244, v235, 3, v244
v_lshrrev_b32 v79, 6, v244
buffer_load_ushort v79, v79, s[52:55], 0 offen
buffer_load_dwordx4 a[0:3], v240, s[16:19], s32 offen offset:0 sc1
buffer_load_dwordx4 a[4:7], v240, s[16:19], s32 offen offset:1024 sc1
buffer_load_dwordx4 a[8:11], v241, s[16:19], s32 offen offset:0 sc1
buffer_load_dwordx4 a[12:15], v241, s[16:19], s32 offen offset:1024 sc1
buffer_load_dwordx4 a[16:19], v240, s[16:19], s32 offen offset:2048 sc1
buffer_load_dwordx4 a[20:23], v240, s[16:19], s32 offen offset:3072 sc1
buffer_load_dwordx4 a[24:27], v241, s[16:19], s32 offen offset:2048 sc1
buffer_load_dwordx4 a[28:31], v241, s[16:19], s32 offen offset:3072 sc1
buffer_load_dwordx4 a[32:35], v240, s[16:19], s33 offen offset:0 sc1
buffer_load_dwordx4 a[36:39], v240, s[16:19], s33 offen offset:1024 sc1
buffer_load_dwordx4 a[40:43], v241, s[16:19], s33 offen offset:0 sc1
buffer_load_dwordx4 a[44:47], v241, s[16:19], s33 offen offset:1024 sc1
s_lshl_b32 s3, s37, 3
v_add3_u32 v244, v244, s3, 8
s_cmp_ge_u32 s29, 0x70000000
s_cselect_b32 s44, s43, s44
v_mov_b32 v46, s42
v_mov_b32 v232, s43
v_cmp_lt_u32 vcc, 0x7f, v248
v_mov_b32 v233, s44
s_nop 0
v_cndmask_b32 v46, v46, v232, vcc
v_cmp_lt_u32 vcc, 0xff, v248
v_bfe_u32 v232, v248, 4, 3
s_nop 0
v_cndmask_b32 v46, v46, v233, vcc
v_min_u32 v232, 5, v232
v_lshrrev_b32 v46, 2, v46
v_lshl_add_u32 v46, v46, 3, v232
v_lshlrev_b32 v46, 7, v46
v_add_u32 v46, 0x7c00000, v46
s_lshl_b32 s49, s34, 10
s_add_u32 s49, s49, 0x20000
s_bfe_u32 s3, s6, 0x2000f
s_lshl_b32 s3, s3, 13
s_add_u32 s3, s3, s49
v_add_u32 v76, s3, v248
s_bfe_u32 s3, s7, 0x2000f
s_lshl_b32 s3, s3, 13
s_add_u32 s3, s3, s49
v_add_u32 v77, s3, v248
s_bfe_u32 s3, s29, 0x2000f
s_lshl_b32 s3, s3, 13
s_add_u32 s3, s3, s49
v_add_u32 v78, s3, v248
s_add_u32 s3, s37, 1
s_sub_u32 s49, s3, 6
s_cselect_b32 s3, s3, s49
s_mul_i32 s3, s3, 0x600000
s_add_u32 s42, s3, 0x2000000
s_add_u32 s3, s37, 2
s_sub_u32 s49, s3, 6
s_cselect_b32 s3, s3, s49
s_mul_i32 s3, s3, 0x600000
s_add_u32 s43, s3, 0x2000000
s_add_u32 s3, s37, 3
s_sub_u32 s49, s3, 6
s_cselect_b32 s3, s3, s49
s_mul_i32 s3, s3, 0x600000
s_add_u32 s44, s3, 0x2000000
s_add_u32 s3, s37, 4
s_sub_u32 s49, s3, 6
s_cselect_b32 s3, s3, s49
s_mul_i32 s3, s3, 0x600000
s_add_u32 s45, s3, 0x2000000
s_add_u32 s3, s37, 5
s_sub_u32 s49, s3, 6
s_cselect_b32 s3, s3, s49
s_mul_i32 s3, s3, 0x600000
s_add_u32 s46, s3, 0x2000000
s_add_u32 s3, s37, 6
s_sub_u32 s49, s3, 6
s_cselect_b32 s3, s3, s49
s_mul_i32 s3, s3, 0x600000
s_add_u32 s47, s3, 0x2000000
s_mul_i32 s3, s34, 896
v_add_u32 v47, s3, v248
v_add_u32 v43, 0x1000, v47
v_lshrrev_b32 v44, 4, v248
v_and_b32 v44, 0x30, v44
v_xor_b32 v44, v44, v248
v_and_b32 v232, 0x380, v248
v_mad_u32_u24 v44, v232, 3, v44
v_xor_b32 v45, 0x1040, v44
v_bfe_u32 v232, v248, 5, 3
v_lshrrev_b32 v234, 8, v248
v_xor_b32 v232, v232, v234
v_bfe_u32 v233, v248, 4, 3
v_lshlrev_b32 v233, 7, v233
v_lshl_or_b32 v232, v232, 4, v233
v_bfe_u32 v233, v248, 7, 1
s_lshl_b32 s49, s34, 10
s_sub_u32 s3, s28, s49
v_lshl_add_u32 v74, v233, 12, v232
v_add_u32 v72, s3, v74
s_sub_u32 s3, s30, s49
v_add_u32 v74, s3, v74
v_xor_b32 v73, 64, v72
v_xor_b32 v75, 64, v74
v_lshl_add_u32 v245, v233, 10, v232
v_add_u32 v245, s31, v245
v_xor_b32 v246, 64, v245
v_add_u32 v247, s31, v248
s_add_u32 s3, s3, 0xa000
s_and_b32 s3, s3, 0x1ffff
v_add_u32 v252, s3, v248
v_add_u32 v251, s49, v252
s_lshl_b32 s49, s34, 11
s_add_u32 s3, s3, s49
s_add_u32 s3, s3, 24576
v_lshl_add_u32 v249, v248, 1, s3
v_lshl_add_u32 v250, v235, 1, s3
v_lshrrev_b32 v232, 4, v235
v_lshlrev_b32 v234, 2, v234
v_sub_u32 v232, v232, v234
v_and_b32 v233, 1, v232
v_lshlrev_b32 v233, 4, v233
v_mov_b32 v234, 0xffff
v_lshlrev_b32 v233, v233, v234
v_lshrrev_b32 v232, 1, v232
v_cmp_eq_u32 vcc, 0, v232
s_nop 1
v_cndmask_b32 v156, 0, v233, vcc
v_cmp_eq_u32 vcc, 1, v232
s_nop 1
v_cndmask_b32 v157, 0, v233, vcc
s_mov_b32 s95, 0xffff0000
s_waitcnt vmcnt(13)
v_mov_b32 v158, s98
v_mov_b32 v159, s99
s_mov_b64 exec, 1
buffer_store_dwordx2 v[158:159], off, s[16:19], s51 sc1
s_mov_b64 exec, -1
s_waitcnt lgkmcnt(0)
s_barrier
ds_read_b128 v[208:211], v72 offset:0
ds_read_b128 v[212:215], v72 offset:8192
ds_read_b128 v[216:219], v74 offset:0
ds_read_b128 v[220:223], v73 offset:0
ds_read_b128 v[224:227], v73 offset:8192
ds_read_b128 v[104:107], v245 offset:0
ds_read_b128 v[108:111], v246 offset:0
ds_read_b128 v[152:155], v245 offset:2048
s_waitcnt vmcnt(13)
v_lshlrev_b32 v79, 16, v79
ds_write_b32 v249, v79 offset:28
ds_read_b32 v253, v250 offset:28
ds_read_b32 v254, v250 offset:540
ds_read_b32 v255, v250 offset:1052
s_waitcnt vmcnt(12)
buffer_load_dwordx4 a[48:51], v240, s[16:19], s33 offen offset:2048 sc1
s_waitcnt vmcnt(12)
buffer_load_dwordx4 a[52:55], v240, s[16:19], s33 offen offset:3072 sc1
s_waitcnt vmcnt(12)
buffer_load_dwordx4 a[56:59], v241, s[16:19], s33 offen offset:2048 sc1
s_waitcnt vmcnt(12)
s_waitcnt lgkmcnt(11)
v_mfma_f32_16x16x32_bf16 v[160:163], a[0:3], v[208:211], 0
ds_read_b128 v[228:231], v75 offset:0
buffer_load_dwordx4 a[60:63], v241, s[16:19], s33 offen offset:3072 sc1
v_mfma_f32_16x16x32_bf16 v[164:167], a[4:7], v[208:211], 0
v_mfma_f32_16x16x32_bf16 v[168:171], a[8:11], v[208:211], 0
v_mfma_f32_16x16x32_bf16 v[172:175], a[12:15], v[208:211], 0
s_waitcnt vmcnt(12)
s_waitcnt lgkmcnt(11)
v_mfma_f32_16x16x32_bf16 v[176:179], a[0:3], v[212:215], 0
ds_read_b128 v[208:211], v72 offset:1024
buffer_load_dwordx4 a[64:67], v240, s[16:19], s35 offen offset:0 sc1
v_mfma_f32_16x16x32_bf16 v[180:183], a[4:7], v[212:215], 0
v_mfma_f32_16x16x32_bf16 v[184:187], a[8:11], v[212:215], 0
v_mfma_f32_16x16x32_bf16 v[188:191], a[12:15], v[212:215], 0
s_waitcnt vmcnt(12)
s_waitcnt lgkmcnt(11)
v_mfma_f32_16x16x32_bf16 v[192:195], a[0:3], v[216:219], 0
ds_read_b128 v[212:215], v72 offset:9216
buffer_load_dwordx4 a[68:71], v240, s[16:19], s35 offen offset:1024 sc1
v_mfma_f32_16x16x32_bf16 v[196:199], a[4:7], v[216:219], 0
v_mfma_f32_16x16x32_bf16 v[200:203], a[8:11], v[216:219], 0
v_mfma_f32_16x16x32_bf16 v[204:207], a[12:15], v[216:219], 0
s_waitcnt vmcnt(12)
buffer_load_dwordx4 a[72:75], v241, s[16:19], s35 offen offset:0 sc1
s_waitcnt vmcnt(12)
s_waitcnt lgkmcnt(11)
v_mfma_f32_16x16x32_bf16 v[160:163], a[16:19], v[220:223], v[160:163]
ds_read_b128 v[216:219], v74 offset:1024
buffer_load_dwordx4 a[76:79], v241, s[16:19], s35 offen offset:1024 sc1
v_mfma_f32_16x16x32_bf16 v[164:167], a[20:23], v[220:223], v[164:167]
v_mfma_f32_16x16x32_bf16 v[168:171], a[24:27], v[220:223], v[168:171]
v_mfma_f32_16x16x32_bf16 v[172:175], a[28:31], v[220:223], v[172:175]
s_waitcnt vmcnt(12)
s_waitcnt lgkmcnt(11)
v_mfma_f32_16x16x32_bf16 v[176:179], a[16:19], v[224:227], v[176:179]
ds_read_b128 v[220:223], v73 offset:1024
buffer_load_dwordx4 a[80:83], v240, s[16:19], s35 offen offset:2048 sc1
v_mfma_f32_16x16x32_bf16 v[180:183], a[20:23], v[224:227], v[180:183]
v_mfma_f32_16x16x32_bf16 v[184:187], a[24:27], v[224:227], v[184:187]
v_mfma_f32_16x16x32_bf16 v[188:191], a[28:31], v[224:227], v[188:191]
s_waitcnt vmcnt(12)
s_waitcnt lgkmcnt(4)
v_mfma_f32_16x16x32_bf16 v[192:195], a[16:19], v[228:231], v[192:195]
ds_read_b128 v[224:227], v73 offset:9216
buffer_load_dwordx4 a[84:87], v240, s[16:19], s35 offen offset:3072 sc1
v_mfma_f32_16x16x32_bf16 v[196:199], a[20:23], v[228:231], v[196:199]
v_mfma_f32_16x16x32_bf16 v[200:203], a[24:27], v[228:231], v[200:203]
v_mfma_f32_16x16x32_bf16 v[204:207], a[28:31], v[228:231], v[204:207]
s_waitcnt vmcnt(12)
buffer_load_dwordx4 a[88:91], v241, s[16:19], s35 offen offset:2048 sc1
s_waitcnt vmcnt(12)
s_waitcnt lgkmcnt(4)
v_mfma_f32_16x16x32_bf16 v[160:163], a[32:35], v[208:211], v[160:163]
ds_read_b128 v[228:231], v75 offset:1024
buffer_load_dwordx4 a[92:95], v241, s[16:19], s35 offen offset:3072 sc1
v_mfma_f32_16x16x32_bf16 v[164:167], a[36:39], v[208:211], v[164:167]
v_mfma_f32_16x16x32_bf16 v[168:171], a[40:43], v[208:211], v[168:171]
v_mfma_f32_16x16x32_bf16 v[172:175], a[44:47], v[208:211], v[172:175]
s_waitcnt lgkmcnt(4)
v_mfma_f32_16x16x32_bf16 v[176:179], a[32:35], v[212:215], v[176:179]
ds_read_b128 v[208:211], v72 offset:2048
v_mfma_f32_16x16x32_bf16 v[180:183], a[36:39], v[212:215], v[180:183]
v_mfma_f32_16x16x32_bf16 v[184:187], a[40:43], v[212:215], v[184:187]
v_mfma_f32_16x16x32_bf16 v[188:191], a[44:47], v[212:215], v[188:191]
s_waitcnt vmcnt(11)
s_waitcnt lgkmcnt(4)
v_mfma_f32_16x16x32_bf16 v[192:195], a[32:35], v[216:219], v[192:195]
ds_read_b128 v[212:215], v72 offset:10240
buffer_load_dwordx4 a[96:99], v240, s[16:19], s36 offen offset:0 sc1
v_mfma_f32_16x16x32_bf16 v[196:199], a[36:39], v[216:219], v[196:199]
v_mfma_f32_16x16x32_bf16 v[200:203], a[40:43], v[216:219], v[200:203]
v_mfma_f32_16x16x32_bf16 v[204:207], a[44:47], v[216:219], v[204:207]
s_waitcnt vmcnt(11)
buffer_load_dwordx4 a[100:103], v240, s[16:19], s36 offen offset:1024 sc1
s_waitcnt vmcnt(11)
buffer_load_dwordx4 a[104:107], v241, s[16:19], s36 offen offset:0 sc1
s_waitcnt vmcnt(11)
s_waitcnt lgkmcnt(4)
v_mfma_f32_16x16x32_bf16 v[160:163], a[48:51], v[220:223], v[160:163]
ds_read_b128 v[216:219], v74 offset:2048
buffer_load_dwordx4 a[108:111], v241, s[16:19], s36 offen offset:1024 sc1
v_mfma_f32_16x16x32_bf16 v[164:167], a[52:55], v[220:223], v[164:167]
v_mfma_f32_16x16x32_bf16 v[168:171], a[56:59], v[220:223], v[168:171]
v_mfma_f32_16x16x32_bf16 v[172:175], a[60:63], v[220:223], v[172:175]
s_waitcnt vmcnt(11)
s_waitcnt lgkmcnt(4)
v_mfma_f32_16x16x32_bf16 v[176:179], a[48:51], v[224:227], v[176:179]
ds_read_b128 v[220:223], v73 offset:2048
buffer_load_dwordx4 a[112:115], v240, s[16:19], s36 offen offset:2048 sc1
v_mfma_f32_16x16x32_bf16 v[180:183], a[52:55], v[224:227], v[180:183]
v_mfma_f32_16x16x32_bf16 v[184:187], a[56:59], v[224:227], v[184:187]
v_mfma_f32_16x16x32_bf16 v[188:191], a[60:63], v[224:227], v[188:191]
s_waitcnt vmcnt(11)
s_waitcnt lgkmcnt(4)
v_mfma_f32_16x16x32_bf16 v[192:195], a[48:51], v[228:231], v[192:195]
ds_read_b128 v[224:227], v73 offset:10240
buffer_load_dwordx4 a[116:119], v240, s[16:19], s36 offen offset:3072 sc1
v_mfma_f32_16x16x32_bf16 v[196:199], a[52:55], v[228:231], v[196:199]
v_mfma_f32_16x16x32_bf16 v[200:203], a[56:59], v[228:231], v[200:203]
v_mfma_f32_16x16x32_bf16 v[204:207], a[60:63], v[228:231], v[204:207]
s_waitcnt vmcnt(11)
buffer_load_dwordx4 a[120:123], v241, s[16:19], s36 offen offset:2048 sc1
s_waitcnt vmcnt(11)
s_waitcnt lgkmcnt(4)
v_mfma_f32_16x16x32_bf16 v[160:163], a[64:67], v[208:211], v[160:163]
ds_read_b128 v[228:231], v75 offset:2048
buffer_load_dwordx4 a[124:127], v241, s[16:19], s36 offen offset:3072 sc1
v_mfma_f32_16x16x32_bf16 v[164:167], a[68:71], v[208:211], v[164:167]
v_mfma_f32_16x16x32_bf16 v[168:171], a[72:75], v[208:211], v[168:171]
v_mfma_f32_16x16x32_bf16 v[172:175], a[76:79], v[208:211], v[172:175]
s_waitcnt vmcnt(11)
s_waitcnt lgkmcnt(4)
v_mfma_f32_16x16x32_bf16 v[176:179], a[64:67], v[212:215], v[176:179]
ds_read_b128 v[208:211], v72 offset:3072
buffer_load_dwordx4 a[128:131], v240, s[16:19], s38 offen offset:0 sc1
v_mfma_f32_16x16x32_bf16 v[180:183], a[68:71], v[212:215], v[180:183]
v_mfma_f32_16x16x32_bf16 v[184:187], a[72:75], v[212:215], v[184:187]
v_mfma_f32_16x16x32_bf16 v[188:191], a[76:79], v[212:215], v[188:191]
s_waitcnt vmcnt(11)
s_waitcnt lgkmcnt(4)
v_mfma_f32_16x16x32_bf16 v[192:195], a[64:67], v[216:219], v[192:195]
ds_read_b128 v[212:215], v72 offset:11264
buffer_load_dwordx4 a[132:135], v240, s[16:19], s38 offen offset:1024 sc1
v_mfma_f32_16x16x32_bf16 v[196:199], a[68:71], v[216:219], v[196:199]
v_mfma_f32_16x16x32_bf16 v[200:203], a[72:75], v[216:219], v[200:203]
v_mfma_f32_16x16x32_bf16 v[204:207], a[76:79], v[216:219], v[204:207]
s_waitcnt vmcnt(11)
buffer_load_dwordx4 a[136:139], v241, s[16:19], s38 offen offset:0 sc1
s_waitcnt vmcnt(11)
s_waitcnt lgkmcnt(4)
v_mfma_f32_16x16x32_bf16 v[160:163], a[80:83], v[220:223], v[160:163]
ds_read_b128 v[216:219], v74 offset:3072
buffer_load_dwordx4 a[140:143], v241, s[16:19], s38 offen offset:1024 sc1
v_mfma_f32_16x16x32_bf16 v[164:167], a[84:87], v[220:223], v[164:167]
v_mfma_f32_16x16x32_bf16 v[168:171], a[88:91], v[220:223], v[168:171]
v_mfma_f32_16x16x32_bf16 v[172:175], a[92:95], v[220:223], v[172:175]
s_waitcnt vmcnt(11)
s_waitcnt lgkmcnt(4)
v_mfma_f32_16x16x32_bf16 v[176:179], a[80:83], v[224:227], v[176:179]
ds_read_b128 v[220:223], v73 offset:3072
buffer_load_dwordx4 a[144:147], v240, s[16:19], s38 offen offset:2048 sc1
v_mfma_f32_16x16x32_bf16 v[180:183], a[84:87], v[224:227], v[180:183]
v_mfma_f32_16x16x32_bf16 v[184:187], a[88:91], v[224:227], v[184:187]
v_mfma_f32_16x16x32_bf16 v[188:191], a[92:95], v[224:227], v[188:191]
s_waitcnt vmcnt(11)
s_waitcnt lgkmcnt(4)
v_mfma_f32_16x16x32_bf16 v[192:195], a[80:83], v[228:231], v[192:195]
ds_read_b128 v[224:227], v73 offset:11264
buffer_load_dwordx4 a[148:151], v240, s[16:19], s38 offen offset:3072 sc1
v_mfma_f32_16x16x32_bf16 v[196:199], a[84:87], v[228:231], v[196:199]
v_mfma_f32_16x16x32_bf16 v[200:203], a[88:91], v[228:231], v[200:203]
v_mfma_f32_16x16x32_bf16 v[204:207], a[92:95], v[228:231], v[204:207]
s_waitcnt vmcnt(11)
buffer_load_dwordx4 a[152:155], v241, s[16:19], s38 offen offset:2048 sc1
s_waitcnt vmcnt(11)
s_waitcnt lgkmcnt(4)
v_mfma_f32_16x16x32_bf16 v[160:163], a[96:99], v[208:211], v[160:163]
ds_read_b128 v[228:231], v75 offset:3072
buffer_load_dwordx4 a[156:159], v241, s[16:19], s38 offen offset:3072 sc1
v_mfma_f32_16x16x32_bf16 v[164:167], a[100:103], v[208:211], v[164:167]
v_mfma_f32_16x16x32_bf16 v[168:171], a[104:107], v[208:211], v[168:171]
v_mfma_f32_16x16x32_bf16 v[172:175], a[108:111], v[208:211], v[172:175]
s_waitcnt vmcnt(11)
s_waitcnt lgkmcnt(4)
v_mfma_f32_16x16x32_bf16 v[176:179], a[96:99], v[212:215], v[176:179]
buffer_load_dwordx2 v[242:243], v46, s[16:19], 0 offen offset:0 sc1
v_mfma_f32_16x16x32_bf16 v[180:183], a[100:103], v[212:215], v[180:183]
v_mfma_f32_16x16x32_bf16 v[184:187], a[104:107], v[212:215], v[184:187]
v_mfma_f32_16x16x32_bf16 v[188:191], a[108:111], v[212:215], v[188:191]
s_waitcnt vmcnt(11)
s_waitcnt lgkmcnt(3)
v_mfma_f32_16x16x32_bf16 v[192:195], a[96:99], v[216:219], v[192:195]
buffer_load_dwordx4 a[160:163], v240, s[16:19], s39 offen offset:0 sc1
v_mfma_f32_16x16x32_bf16 v[196:199], a[100:103], v[216:219], v[196:199]
v_mfma_f32_16x16x32_bf16 v[200:203], a[104:107], v[216:219], v[200:203]
v_mfma_f32_16x16x32_bf16 v[204:207], a[108:111], v[216:219], v[204:207]
s_waitcnt vmcnt(11)
buffer_load_dwordx4 a[164:167], v240, s[16:19], s39 offen offset:1024 sc1
s_waitcnt vmcnt(11)
s_waitcnt lgkmcnt(2)
v_mfma_f32_16x16x32_bf16 v[160:163], a[112:115], v[220:223], v[160:163]
buffer_load_dwordx4 a[168:171], v241, s[16:19], s39 offen offset:0 sc1
v_mfma_f32_16x16x32_bf16 v[164:167], a[116:119], v[220:223], v[164:167]
v_mfma_f32_16x16x32_bf16 v[168:171], a[120:123], v[220:223], v[168:171]
v_mfma_f32_16x16x32_bf16 v[172:175], a[124:127], v[220:223], v[172:175]
s_waitcnt vmcnt(11)
s_waitcnt lgkmcnt(1)
v_mfma_f32_16x16x32_bf16 v[176:179], a[112:115], v[224:227], v[176:179]
buffer_load_dwordx4 a[172:175], v241, s[16:19], s39 offen offset:1024 sc1
v_mfma_f32_16x16x32_bf16 v[180:183], a[116:119], v[224:227], v[180:183]
v_lshlrev_b32 v234, 16, v104
v_and_b32 v235, s95, v104
v_mfma_f32_16x16x32_bf16 v[184:187], a[120:123], v[224:227], v[184:187]
v_fma_f32 v160, v160, v253, v234
v_fma_f32 v161, v161, v253, v235
v_mfma_f32_16x16x32_bf16 v[188:191], a[124:127], v[224:227], v[188:191]
v_lshlrev_b32 v236, 16, v105
v_and_b32 v237, s95, v105
s_waitcnt lgkmcnt(0)
v_mfma_f32_16x16x32_bf16 v[192:195], a[112:115], v[228:231], v[192:195]
v_fma_f32 v162, v162, v253, v236
v_fma_f32 v163, v163, v253, v237
v_mfma_f32_16x16x32_bf16 v[196:199], a[116:119], v[228:231], v[196:199]
v_lshlrev_b32 v238, 16, v106
v_and_b32 v239, s95, v106
v_mfma_f32_16x16x32_bf16 v[200:203], a[120:123], v[228:231], v[200:203]
v_fma_f32 v164, v164, v253, v238
v_fma_f32 v165, v165, v253, v239
v_mfma_f32_16x16x32_bf16 v[204:207], a[124:127], v[228:231], v[204:207]
v_lshlrev_b32 v232, 16, v107
v_and_b32 v233, s95, v107
v_fma_f32 v166, v166, v253, v232
v_fma_f32 v167, v167, v253, v233
ds_read_b128 v[104:107], v246 offset:2048
v_lshlrev_b32 v234, 16, v108
v_and_b32 v235, s95, v108
v_fma_f32 v168, v168, v253, v234
v_fma_f32 v169, v169, v253, v235
v_lshlrev_b32 v236, 16, v109
v_and_b32 v237, s95, v109
v_fma_f32 v170, v170, v253, v236
v_fma_f32 v171, v171, v253, v237
v_lshlrev_b32 v238, 16, v110
v_and_b32 v239, s95, v110
v_fma_f32 v172, v172, v253, v238
v_fma_f32 v173, v173, v253, v239
v_lshlrev_b32 v232, 16, v111
v_and_b32 v233, s95, v111
v_fma_f32 v174, v174, v253, v232
v_fma_f32 v175, v175, v253, v233
ds_read_b128 v[108:111], v245 offset:4096
s_waitcnt vmcnt(11)
buffer_load_dwordx4 a[176:179], v240, s[16:19], s39 offen offset:2048 sc1
v_lshlrev_b32 v234, 16, v152
v_and_b32 v235, s95, v152
v_fma_f32 v176, v176, v254, v234
v_fma_f32 v177, v177, v254, v235
v_lshlrev_b32 v236, 16, v153
v_and_b32 v237, s95, v153
v_fma_f32 v178, v178, v254, v236
v_fma_f32 v179, v179, v254, v237
v_lshlrev_b32 v238, 16, v154
v_and_b32 v239, s95, v154
v_fma_f32 v180, v180, v254, v238
v_fma_f32 v181, v181, v254, v239
v_lshlrev_b32 v232, 16, v155
v_and_b32 v233, s95, v155
v_fma_f32 v182, v182, v254, v232
v_fma_f32 v183, v183, v254, v233
ds_read_b128 v[152:155], v246 offset:4096
s_waitcnt lgkmcnt(2)
v_lshlrev_b32 v234, 16, v104
v_and_b32 v235, s95, v104
v_fma_f32 v184, v184, v254, v234
v_fma_f32 v185, v185, v254, v235
v_lshlrev_b32 v236, 16, v105
v_and_b32 v237, s95, v105
v_fma_f32 v186, v186, v254, v236
v_fma_f32 v187, v187, v254, v237
v_lshlrev_b32 v238, 16, v106
v_and_b32 v239, s95, v106
v_fma_f32 v188, v188, v254, v238
v_fma_f32 v189, v189, v254, v239
v_lshlrev_b32 v232, 16, v107
v_and_b32 v233, s95, v107
v_fma_f32 v190, v190, v254, v232
v_fma_f32 v191, v191, v254, v233
s_waitcnt vmcnt(11)
buffer_load_dwordx4 a[180:183], v240, s[16:19], s39 offen offset:3072 sc1
s_waitcnt lgkmcnt(1)
v_lshlrev_b32 v234, 16, v108
v_and_b32 v235, s95, v108
v_fma_f32 v192, v192, v255, v234
v_fma_f32 v193, v193, v255, v235
v_lshlrev_b32 v236, 16, v109
v_and_b32 v237, s95, v109
v_fma_f32 v194, v194, v255, v236
v_fma_f32 v195, v195, v255, v237
v_lshlrev_b32 v238, 16, v110
v_and_b32 v239, s95, v110
v_fma_f32 v196, v196, v255, v238
v_fma_f32 v197, v197, v255, v239
v_lshlrev_b32 v232, 16, v111
v_and_b32 v233, s95, v111
v_fma_f32 v198, v198, v255, v232
v_fma_f32 v199, v199, v255, v233
s_waitcnt lgkmcnt(0)
v_lshlrev_b32 v234, 16, v152
v_and_b32 v235, s95, v152
v_fma_f32 v200, v200, v255, v234
v_fma_f32 v201, v201, v255, v235
v_lshlrev_b32 v236, 16, v153
v_and_b32 v237, s95, v153
v_fma_f32 v202, v202, v255, v236
v_fma_f32 v203, v203, v255, v237
v_lshlrev_b32 v238, 16, v154
v_and_b32 v239, s95, v154
v_fma_f32 v204, v204, v255, v238
v_fma_f32 v205, v205, v255, v239
v_lshlrev_b32 v232, 16, v155
v_and_b32 v233, s95, v155
v_fma_f32 v206, v206, v255, v232
v_fma_f32 v207, v207, v255, v233
s_waitcnt vmcnt(11)
buffer_load_dwordx4 a[184:187], v241, s[16:19], s39 offen offset:2048 sc1
s_waitcnt vmcnt(11)
buffer_load_dwordx4 a[188:191], v241, s[16:19], s39 offen offset:3072 sc1
s_waitcnt vmcnt(11)
buffer_load_dwordx4 a[192:195], v240, s[16:19], s40 offen offset:0 sc1
s_waitcnt vmcnt(11)
buffer_load_dwordx4 a[196:199], v240, s[16:19], s40 offen offset:1024 sc1
s_waitcnt vmcnt(11)
s_waitcnt vmcnt(10)
v_cmp_ne_u64 vcc, s[98:99], v[242:243]
s_nop 1
s_cbranch_vccnz LF_spinQ
LF_goQ:
buffer_load_dwordx4 v[128:131], v244, s[24:27], 0 offen offset:0 sc1
buffer_load_dwordx4 v[132:135], v244, s[24:27], 0 offen offset:16 sc1
s_waitcnt vmcnt(11)
buffer_load_dwordx4 v[136:139], v244, s[24:27], 0 offen offset:32 sc1
s_waitcnt vmcnt(11)
s_waitcnt vmcnt(10)
s_add_u32 s49, s6, s42
buffer_load_dwordx4 v[48:51], v47, s[16:19], s49 offen sc1
s_add_u32 s3, s6, s43
buffer_load_dwordx4 v[52:55], v47, s[16:19], s3 offen sc1
s_waitcnt vmcnt(11)
buffer_load_dwordx4 a[200:203], v241, s[16:19], s40 offen offset:0 sc1
s_waitcnt vmcnt(11)
s_waitcnt vmcnt(10)
s_add_u32 s49, s6, s44
buffer_load_dwordx4 v[56:59], v47, s[16:19], s49 offen sc1
s_add_u32 s3, s6, s45
buffer_load_dwordx4 v[60:63], v47, s[16:19], s3 offen sc1
s_waitcnt vmcnt(11)
buffer_load_dwordx4 a[204:207], v241, s[16:19], s40 offen offset:1024 sc1
s_waitcnt vmcnt(11)
s_add_u32 s49, s6, s46
buffer_load_dwordx4 v[64:67], v47, s[16:19], s49 offen sc1
ds_read_b128 v[68:71], v76 offset:0
s_waitcnt vmcnt(11)
buffer_load_dwordx4 a[208:211], v240, s[16:19], s40 offen offset:2048 sc1
s_waitcnt vmcnt(11)
s_waitcnt vmcnt(10)
s_add_u32 s49, s7, s42
buffer_load_dwordx4 v[80:83], v47, s[16:19], s49 offen sc1
s_add_u32 s3, s7, s43
buffer_load_dwordx4 v[84:87], v47, s[16:19], s3 offen sc1
s_waitcnt vmcnt(11)
buffer_load_dwordx4 a[212:215], v240, s[16:19], s40 offen offset:3072 sc1
s_waitcnt vmcnt(11)
v_max3_f32 v232, v128, v130, v132
v_max3_f32 v233, v134, v136, v138
v_max_f32 v232, v232, v233
v_subrev_f32 v232, 0x42fe0000, v232
v_sub_f32 v128, v128, v232
v_sub_f32 v130, v130, v232
v_sub_f32 v132, v132, v232
v_sub_f32 v134, v134, v232
v_sub_f32 v136, v136, v232
v_sub_f32 v138, v138, v232
v_cvt_u32_f32 v128, v128
v_cvt_u32_f32 v130, v130
v_cvt_u32_f32 v132, v132
v_cvt_u32_f32 v134, v134
v_cvt_u32_f32 v136, v136
v_cvt_u32_f32 v138, v138
v_lshlrev_b32 v234, 23, v128
v_lshlrev_b32 v235, 23, v130
v_lshlrev_b32 v236, 23, v132
v_lshlrev_b32 v237, 23, v134
v_lshlrev_b32 v238, 23, v136
v_lshlrev_b32 v239, 23, v138
v_mul_f32 v232, v234, v129
v_fmac_f32 v232, v235, v131
v_fmac_f32 v232, v236, v133
v_fmac_f32 v232, v237, v135
v_fmac_f32 v232, v238, v137
v_fmac_f32 v232, v239, v139
v_rcp_f32 v150, v232
v_mul_u32_u24 v144, 0x800080, v128
v_mul_u32_u24 v145, 0x800080, v130
v_mul_u32_u24 v146, 0x800080, v132
v_mul_u32_u24 v147, 0x800080, v134
v_mul_u32_u24 v148, 0x800080, v136
v_mul_u32_u24 v149, 0x800080, v138
ds_write_b128 v249, v[144:147]
ds_write_b96 v249, v[148:150] offset:16
ds_read_b128 v[144:147], v250 offset:0
ds_read_b128 v[148:151], v250 offset:16
ds_read_b128 v[128:131], v250 offset:512
ds_read_b128 v[132:135], v250 offset:528
ds_read_b128 v[136:139], v250 offset:1024
ds_read_b128 v[140:143], v250 offset:1040
s_waitcnt lgkmcnt(4)
v_and_b32 v0, v144, v156
v_and_b32 v1, v144, v157
v_and_b32 v2, v145, v156
v_and_b32 v3, v145, v157
v_and_b32 v4, v146, v156
v_and_b32 v5, v146, v157
v_and_b32 v6, v147, v156
v_and_b32 v7, v147, v157
v_and_b32 v8, v148, v156
v_and_b32 v9, v148, v157
v_and_b32 v10, v149, v156
v_and_b32 v11, v149, v157
v_mov_b32 v40, v150
s_waitcnt lgkmcnt(2)
v_and_b32 v12, v128, v156
v_and_b32 v13, v128, v157
v_and_b32 v14, v129, v156
v_and_b32 v15, v129, v157
v_and_b32 v16, v130, v156
v_and_b32 v17, v130, v157
v_and_b32 v18, v131, v156
v_and_b32 v19, v131, v157
v_and_b32 v20, v132, v156
v_and_b32 v21, v132, v157
v_and_b32 v22, v133, v156
v_and_b32 v23, v133, v157
v_mov_b32 v41, v134
s_waitcnt lgkmcnt(0)
v_and_b32 v24, v136, v156
v_and_b32 v25, v136, v157
v_and_b32 v26, v137, v156
v_and_b32 v27, v137, v157
v_and_b32 v28, v138, v156
v_and_b32 v29, v138, v157
v_and_b32 v30, v139, v156
v_and_b32 v31, v139, v157
v_and_b32 v32, v140, v156
v_and_b32 v33, v140, v157
v_and_b32 v34, v141, v156
v_and_b32 v35, v141, v157
v_mov_b32 v42, v142
s_waitcnt vmcnt(9)
v_swap_b32 v50, v52
v_swap_b32 v51, v53
s_nop 1
v_mfma_f32_16x16x32_bf16 v[136:139], v[48:51], v[0:3], 0
s_add_u32 s49, s7, s44
buffer_load_dwordx4 v[88:91], v47, s[16:19], s49 offen sc1
v_mfma_f32_16x16x32_bf16 v[140:143], v[52:55], v[0:3], 0
s_add_u32 s3, s7, s45
buffer_load_dwordx4 v[92:95], v47, s[16:19], s3 offen sc1
buffer_load_dwordx4 a[216:219], v241, s[16:19], s40 offen offset:2048 sc1
s_waitcnt vmcnt(11)
s_add_u32 s49, s7, s46
buffer_load_dwordx4 v[96:99], v47, s[16:19], s49 offen sc1
ds_read_b128 v[100:103], v77 offset:0
s_waitcnt vmcnt(10)
v_swap_b32 v58, v60
v_swap_b32 v59, v61
s_nop 1
v_mfma_f32_16x16x32_bf16 v[136:139], v[56:59], v[4:7], v[136:139]
buffer_load_dwordx4 a[220:223], v241, s[16:19], s40 offen offset:3072 sc1
v_mfma_f32_16x16x32_bf16 v[140:143], v[60:63], v[4:7], v[140:143]
s_waitcnt vmcnt(10)
s_add_u32 s49, s29, s42
buffer_load_dwordx4 v[112:115], v47, s[16:19], s49 offen sc1
s_add_u32 s3, s29, s43
buffer_load_dwordx4 v[116:119], v47, s[16:19], s3 offen sc1
s_waitcnt vmcnt(11)
v_swap_b32 v66, v68
v_swap_b32 v67, v69
s_nop 1
v_mfma_f32_16x16x32_bf16 v[136:139], v[64:67], v[8:11], v[136:139]
buffer_load_dwordx4 a[224:227], v240, s[16:19], s41 offen offset:0 sc1
v_mfma_f32_16x16x32_bf16 v[140:143], v[68:71], v[8:11], v[140:143]
s_waitcnt vmcnt(11)
s_nop 4
v_mul_f32 v136, v136, v40
v_mul_f32 v137, v137, v40
v_mul_f32 v138, v138, v40
v_mul_f32 v139, v139, v40
v_mul_f32 v140, v140, v40
v_mul_f32 v141, v141, v40
v_mul_f32 v142, v142, v40
v_mul_f32 v143, v143, v40
v_cvt_pk_bf16_f32 v136, v136, v137
v_cvt_pk_bf16_f32 v137, v138, v139
v_cvt_pk_bf16_f32 v138, v140, v141
v_cvt_pk_bf16_f32 v139, v142, v143
ds_write_b128 v251, v[136:139] offset:0
s_waitcnt vmcnt(9)
v_swap_b32 v82, v84
v_swap_b32 v83, v85
s_nop 1
v_mfma_f32_16x16x32_bf16 v[128:131], v[80:83], v[12:15], 0
s_add_u32 s49, s29, s44
buffer_load_dwordx4 v[120:123], v47, s[16:19], s49 offen sc1
v_mfma_f32_16x16x32_bf16 v[132:135], v[84:87], v[12:15], 0
s_add_u32 s3, s29, s45
buffer_load_dwordx4 v[124:127], v47, s[16:19], s3 offen sc1
buffer_load_dwordx4 a[228:231], v240, s[16:19], s41 offen offset:1024 sc1
s_waitcnt vmcnt(11)
s_waitcnt vmcnt(9)
v_swap_b32 v90, v92
v_swap_b32 v91, v93
s_nop 1
v_mfma_f32_16x16x32_bf16 v[128:131], v[88:91], v[16:19], v[128:131]
s_add_u32 s49, s29, s46
buffer_load_dwordx4 v[48:51], v47, s[16:19], s49 offen sc1
v_mfma_f32_16x16x32_bf16 v[132:135], v[92:95], v[16:19], v[132:135]
s_add_u32 s3, s29, s47
s_cmp_lt_u32 s37, 4
s_cbranch_scc1 LF_o0
buffer_load_dwordx4 v[52:55], v47, s[16:19], s3 offen sc1
ds_read_b128 v[36:39], v78 offset:0
s_branch LF_j0
LF_o0:
s_mov_b32 s3, 0x70000000
buffer_load_dwordx4 v[36:39], v47, s[16:19], s3 offen sc1
ds_read_b128 v[52:55], v78 offset:0
LF_j0:
buffer_load_dwordx4 a[232:235], v241, s[16:19], s41 offen offset:0 sc1
s_waitcnt vmcnt(11)
s_waitcnt vmcnt(10)
s_waitcnt lgkmcnt(2)
v_swap_b32 v98, v100
v_swap_b32 v99, v101
s_nop 1
v_mfma_f32_16x16x32_bf16 v[128:131], v[96:99], v[20:23], v[128:131]
s_add_u32 s49, s6, s42
buffer_load_dwordx4 v[56:59], v43, s[16:19], s49 offen sc1
v_mfma_f32_16x16x32_bf16 v[132:135], v[100:103], v[20:23], v[132:135]
s_add_u32 s3, s6, s43
buffer_load_dwordx4 v[60:63], v43, s[16:19], s3 offen sc1
s_waitcnt vmcnt(11)
buffer_load_dwordx4 a[236:239], v241, s[16:19], s41 offen offset:1024 sc1
s_nop 0
v_mul_f32 v128, v128, v41
v_mul_f32 v129, v129, v41
v_mul_f32 v130, v130, v41
v_mul_f32 v131, v131, v41
v_mul_f32 v132, v132, v41
v_mul_f32 v133, v133, v41
v_mul_f32 v134, v134, v41
v_mul_f32 v135, v135, v41
v_cvt_pk_bf16_f32 v128, v128, v129
v_cvt_pk_bf16_f32 v129, v130, v131
v_cvt_pk_bf16_f32 v130, v132, v133
v_cvt_pk_bf16_f32 v131, v134, v135
ds_write_b128 v251, v[128:131] offset:8192
s_waitcnt vmcnt(10)
v_swap_b32 v114, v116
v_swap_b32 v115, v117
s_nop 1
v_mfma_f32_16x16x32_bf16 v[136:139], v[112:115], v[24:27], 0
s_add_u32 s49, s6, s44
buffer_load_dwordx4 v[64:67], v43, s[16:19], s49 offen sc1
v_mfma_f32_16x16x32_bf16 v[140:143], v[116:119], v[24:27], 0
s_add_u32 s3, s6, s45
buffer_load_dwordx4 v[68:71], v43, s[16:19], s3 offen sc1
s_waitcnt vmcnt(11)
buffer_load_dwordx4 a[240:243], v240, s[16:19], s41 offen offset:2048 sc1
s_waitcnt vmcnt(10)
v_swap_b32 v122, v124
v_swap_b32 v123, v125
s_nop 1
v_mfma_f32_16x16x32_bf16 v[136:139], v[120:123], v[28:31], v[136:139]
s_add_u32 s49, s6, s46
buffer_load_dwordx4 v[80:83], v43, s[16:19], s49 offen sc1
v_mfma_f32_16x16x32_bf16 v[140:143], v[124:127], v[28:31], v[140:143]
ds_read_b128 v[84:87], v76 offset:4096
buffer_load_dwordx4 a[244:247], v240, s[16:19], s41 offen offset:3072 sc1
s_waitcnt vmcnt(11)
s_waitcnt vmcnt(9)
s_waitcnt lgkmcnt(2)
v_swap_b32 v50, v52
v_swap_b32 v51, v53
s_nop 1
v_mfma_f32_16x16x32_bf16 v[136:139], v[48:51], v[32:35], v[136:139]
s_add_u32 s49, s7, s42
buffer_load_dwordx4 v[88:91], v43, s[16:19], s49 offen sc1
v_mfma_f32_16x16x32_bf16 v[140:143], v[52:55], v[32:35], v[140:143]
s_add_u32 s3, s7, s43
buffer_load_dwordx4 v[92:95], v43, s[16:19], s3 offen sc1
buffer_load_dwordx4 a[248:251], v241, s[16:19], s41 offen offset:2048 sc1
s_waitcnt vmcnt(11)
s_nop 0
v_mul_f32 v136, v136, v42
v_mul_f32 v137, v137, v42
v_mul_f32 v138, v138, v42
v_mul_f32 v139, v139, v42
v_mul_f32 v140, v140, v42
v_mul_f32 v141, v141, v42
v_mul_f32 v142, v142, v42
v_mul_f32 v143, v143, v42
v_cvt_pk_bf16_f32 v136, v136, v137
v_cvt_pk_bf16_f32 v137, v138, v139
v_cvt_pk_bf16_f32 v138, v140, v141
v_cvt_pk_bf16_f32 v139, v142, v143
ds_write_b128 v251, v[136:139] offset:16384
s_waitcnt lgkmcnt(0)
s_barrier
ds_read_b128 v[208:211], v252 offset:0
ds_read_b128 v[212:215], v252 offset:1024
ds_read_b128 v[216:219], v252 offset:2048
ds_read_b128 v[220:223], v252 offset:3072
ds_read_b128 v[224:227], v252 offset:8192
s_waitcnt vmcnt(9)
s_waitcnt lgkmcnt(4)
v_mfma_f32_16x16x32_bf16 v[160:163], a[128:131], v[208:211], v[160:163]
ds_read_b128 v[228:231], v252 offset:9216
v_swap_b32 v58, v60
v_mfma_f32_16x16x32_bf16 v[164:167], a[132:135], v[208:211], v[164:167]
v_swap_b32 v59, v61
s_nop 1
v_mfma_f32_16x16x32_bf16 v[128:131], v[56:59], v[0:3], 0
s_add_u32 s49, s7, s44
buffer_load_dwordx4 v[96:99], v43, s[16:19], s49 offen sc1
v_mfma_f32_16x16x32_bf16 v[132:135], v[60:63], v[0:3], 0
s_add_u32 s3, s7, s45
buffer_load_dwordx4 v[100:103], v43, s[16:19], s3 offen sc1
v_mfma_f32_16x16x32_bf16 v[168:171], a[136:139], v[208:211], v[168:171]
buffer_load_dwordx4 a[252:255], v241, s[16:19], s41 offen offset:3072 sc1
v_mfma_f32_16x16x32_bf16 v[172:175], a[140:143], v[208:211], v[172:175]
s_waitcnt lgkmcnt(4)
v_mfma_f32_16x16x32_bf16 v[160:163], a[144:147], v[212:215], v[160:163]
ds_read_b128 v[208:211], v252 offset:10240
v_mfma_f32_16x16x32_bf16 v[164:167], a[148:151], v[212:215], v[164:167]
v_mfma_f32_16x16x32_bf16 v[168:171], a[152:155], v[212:215], v[168:171]
v_mfma_f32_16x16x32_bf16 v[172:175], a[156:159], v[212:215], v[172:175]
s_waitcnt vmcnt(11)
s_waitcnt lgkmcnt(4)
v_mfma_f32_16x16x32_bf16 v[160:163], a[160:163], v[216:219], v[160:163]
ds_read_b128 v[212:215], v252 offset:11264
s_add_u32 s49, s7, s46
buffer_load_dwordx4 v[112:115], v43, s[16:19], s49 offen sc1
v_mfma_f32_16x16x32_bf16 v[164:167], a[164:167], v[216:219], v[164:167]
ds_read_b128 v[116:119], v77 offset:4096
v_mfma_f32_16x16x32_bf16 v[168:171], a[168:171], v[216:219], v[168:171]
v_mfma_f32_16x16x32_bf16 v[172:175], a[172:175], v[216:219], v[172:175]
s_waitcnt vmcnt(10)
s_waitcnt lgkmcnt(5)
v_mfma_f32_16x16x32_bf16 v[160:163], a[176:179], v[220:223], v[160:163]
ds_read_b128 v[216:219], v252 offset:16384
v_swap_b32 v66, v68
v_mfma_f32_16x16x32_bf16 v[164:167], a[180:183], v[220:223], v[164:167]
v_swap_b32 v67, v69
s_nop 1
v_mfma_f32_16x16x32_bf16 v[128:131], v[64:67], v[4:7], v[128:131]
s_add_u32 s49, s29, s42
buffer_load_dwordx4 v[120:123], v43, s[16:19], s49 offen sc1
v_mfma_f32_16x16x32_bf16 v[132:135], v[68:71], v[4:7], v[132:135]
s_add_u32 s3, s29, s43
buffer_load_dwordx4 v[124:127], v43, s[16:19], s3 offen sc1
v_mfma_f32_16x16x32_bf16 v[168:171], a[184:187], v[220:223], v[168:171]
v_mfma_f32_16x16x32_bf16 v[172:175], a[188:191], v[220:223], v[172:175]
s_waitcnt lgkmcnt(5)
v_mfma_f32_16x16x32_bf16 v[176:179], a[128:131], v[224:227], v[176:179]
ds_read_b128 v[220:223], v252 offset:17408
v_mfma_f32_16x16x32_bf16 v[180:183], a[132:135], v[224:227], v[180:183]
v_mfma_f32_16x16x32_bf16 v[184:187], a[136:139], v[224:227], v[184:187]
v_mfma_f32_16x16x32_bf16 v[188:191], a[140:143], v[224:227], v[188:191]
s_waitcnt vmcnt(11)
s_waitcnt lgkmcnt(5)
v_mfma_f32_16x16x32_bf16 v[176:179], a[144:147], v[228:231], v[176:179]
ds_read_b128 v[224:227], v252 offset:18432
v_mfma_f32_16x16x32_bf16 v[180:183], a[148:151], v[228:231], v[180:183]
v_mfma_f32_16x16x32_bf16 v[184:187], a[152:155], v[228:231], v[184:187]
v_mfma_f32_16x16x32_bf16 v[188:191], a[156:159], v[228:231], v[188:191]
s_waitcnt vmcnt(10)
s_waitcnt lgkmcnt(5)
v_mfma_f32_16x16x32_bf16 v[176:179], a[160:163], v[208:211], v[176:179]
v_swap_b32 v82, v84
v_mfma_f32_16x16x32_bf16 v[180:183], a[164:167], v[208:211], v[180:183]
v_swap_b32 v83, v85
s_nop 1
v_mfma_f32_16x16x32_bf16 v[128:131], v[80:83], v[8:11], v[128:131]
s_add_u32 s49, s29, s44
buffer_load_dwordx4 v[48:51], v43, s[16:19], s49 offen sc1
v_mfma_f32_16x16x32_bf16 v[132:135], v[84:87], v[8:11], v[132:135]
s_add_u32 s3, s29, s45
buffer_load_dwordx4 v[52:55], v43, s[16:19], s3 offen sc1
v_mfma_f32_16x16x32_bf16 v[184:187], a[168:171], v[208:211], v[184:187]
v_mfma_f32_16x16x32_bf16 v[188:191], a[172:175], v[208:211], v[188:191]
s_waitcnt lgkmcnt(4)
v_mfma_f32_16x16x32_bf16 v[176:179], a[176:179], v[212:215], v[176:179]
v_mfma_f32_16x16x32_bf16 v[180:183], a[180:183], v[212:215], v[180:183]
v_mfma_f32_16x16x32_bf16 v[184:187], a[184:187], v[212:215], v[184:187]
v_mfma_f32_16x16x32_bf16 v[188:191], a[188:191], v[212:215], v[188:191]
s_waitcnt vmcnt(11)
s_waitcnt lgkmcnt(2)
v_mfma_f32_16x16x32_bf16 v[192:195], a[128:131], v[216:219], v[192:195]
v_mul_f32 v128, v128, v40
v_mul_f32 v129, v129, v40
v_mfma_f32_16x16x32_bf16 v[196:199], a[132:135], v[216:219], v[196:199]
v_mul_f32 v130, v130, v40
v_mul_f32 v131, v131, v40
v_mfma_f32_16x16x32_bf16 v[200:203], a[136:139], v[216:219], v[200:203]
v_mul_f32 v132, v132, v40
v_mul_f32 v133, v133, v40
v_mfma_f32_16x16x32_bf16 v[204:207], a[140:143], v[216:219], v[204:207]
v_mul_f32 v134, v134, v40
v_mul_f32 v135, v135, v40
s_waitcnt lgkmcnt(1)
v_mfma_f32_16x16x32_bf16 v[192:195], a[144:147], v[220:223], v[192:195]
v_cvt_pk_bf16_f32 v128, v128, v129
v_cvt_pk_bf16_f32 v129, v130, v131
v_mfma_f32_16x16x32_bf16 v[196:199], a[148:151], v[220:223], v[196:199]
v_cvt_pk_bf16_f32 v130, v132, v133
v_cvt_pk_bf16_f32 v131, v134, v135
v_mfma_f32_16x16x32_bf16 v[200:203], a[152:155], v[220:223], v[200:203]
ds_write_b128 v251, v[128:131] offset:4096
v_mfma_f32_16x16x32_bf16 v[204:207], a[156:159], v[220:223], v[204:207]
s_waitcnt lgkmcnt(1)
v_mfma_f32_16x16x32_bf16 v[192:195], a[160:163], v[224:227], v[192:195]
v_mfma_f32_16x16x32_bf16 v[196:199], a[164:167], v[224:227], v[196:199]
v_mfma_f32_16x16x32_bf16 v[200:203], a[168:171], v[224:227], v[200:203]
v_mfma_f32_16x16x32_bf16 v[204:207], a[172:175], v[224:227], v[204:207]
s_waitcnt lgkmcnt(0)
s_barrier
ds_read_b128 v[228:231], v252 offset:4096
ds_read_b128 v[208:211], v252 offset:5120
ds_read_b128 v[212:215], v252 offset:6144
ds_read_b128 v[216:219], v252 offset:19456
ds_read_b128 v[220:223], v252 offset:7168
s_waitcnt vmcnt(9)
s_waitcnt lgkmcnt(4)
v_mfma_f32_16x16x32_bf16 v[160:163], a[192:195], v[228:231], v[160:163]
v_swap_b32 v90, v92
v_mfma_f32_16x16x32_bf16 v[164:167], a[196:199], v[228:231], v[164:167]
v_swap_b32 v91, v93
s_nop 1
v_mfma_f32_16x16x32_bf16 v[136:139], v[88:91], v[12:15], 0
s_add_u32 s49, s29, s46
buffer_load_dwordx4 v[56:59], v43, s[16:19], s49 offen sc1
v_mfma_f32_16x16x32_bf16 v[140:143], v[92:95], v[12:15], 0
s_add_u32 s3, s29, s47
s_cmp_lt_u32 s37, 4
s_cbranch_scc1 LF_o1
buffer_load_dwordx4 v[60:63], v43, s[16:19], s3 offen sc1
ds_read_b128 v[36:39], v78 offset:4096
s_branch LF_j1
LF_o1:
s_mov_b32 s3, 0x70000000
buffer_load_dwordx4 v[36:39], v43, s[16:19], s3 offen sc1
ds_read_b128 v[60:63], v78 offset:4096
LF_j1:
v_mfma_f32_16x16x32_bf16 v[168:171], a[200:203], v[228:231], v[168:171]
v_mfma_f32_16x16x32_bf16 v[172:175], a[204:207], v[228:231], v[172:175]
s_waitcnt lgkmcnt(4)
v_mfma_f32_16x16x32_bf16 v[160:163], a[208:211], v[208:211], v[160:163]
v_mfma_f32_16x16x32_bf16 v[164:167], a[212:215], v[208:211], v[164:167]
v_mfma_f32_16x16x32_bf16 v[168:171], a[216:219], v[208:211], v[168:171]
v_mfma_f32_16x16x32_bf16 v[172:175], a[220:223], v[208:211], v[172:175]
s_waitcnt vmcnt(10)
s_waitcnt lgkmcnt(3)
v_mfma_f32_16x16x32_bf16 v[160:163], a[224:227], v[212:215], v[160:163]
v_mfma_f32_16x16x32_bf16 v[164:167], a[228:231], v[212:215], v[164:167]
v_mfma_f32_16x16x32_bf16 v[168:171], a[232:235], v[212:215], v[168:171]
v_mfma_f32_16x16x32_bf16 v[172:175], a[236:239], v[212:215], v[172:175]
s_waitcnt vmcnt(8)
s_waitcnt lgkmcnt(2)
v_mfma_f32_16x16x32_bf16 v[192:195], a[176:179], v[216:219], v[192:195]
v_swap_b32 v98, v100
v_mfma_f32_16x16x32_bf16 v[196:199], a[180:183], v[216:219], v[196:199]
v_swap_b32 v99, v101
s_nop 1
v_mfma_f32_16x16x32_bf16 v[136:139], v[96:99], v[16:19], v[136:139]
v_mfma_f32_16x16x32_bf16 v[140:143], v[100:103], v[16:19], v[140:143]
v_mfma_f32_16x16x32_bf16 v[200:203], a[184:187], v[216:219], v[200:203]
v_mfma_f32_16x16x32_bf16 v[204:207], a[188:191], v[216:219], v[204:207]
s_waitcnt vmcnt(7)
s_waitcnt lgkmcnt(1)
v_mfma_f32_16x16x32_bf16 v[160:163], a[240:243], v[220:223], v[160:163]
v_mfma_f32_16x16x32_bf16 v[164:167], a[244:247], v[220:223], v[164:167]
v_mfma_f32_16x16x32_bf16 v[168:171], a[248:251], v[220:223], v[168:171]
v_mfma_f32_16x16x32_bf16 v[172:175], a[252:255], v[220:223], v[172:175]
s_waitcnt vmcnt(6)
v_swap_b32 v114, v116
v_swap_b32 v115, v117
s_nop 1
v_mfma_f32_16x16x32_bf16 v[136:139], v[112:115], v[20:23], v[136:139]
v_cvt_pk_bf16_f32 v160, v160, v161
v_cvt_pk_bf16_f32 v161, v162, v163
v_mfma_f32_16x16x32_bf16 v[140:143], v[116:119], v[20:23], v[140:143]
v_cvt_pk_bf16_f32 v162, v164, v165
v_cvt_pk_bf16_f32 v163, v166, v167
ds_write_b128 v245, v[160:163] offset:0
v_cvt_pk_bf16_f32 v168, v168, v169
v_cvt_pk_bf16_f32 v169, v170, v171
v_cvt_pk_bf16_f32 v170, v172, v173
v_cvt_pk_bf16_f32 v171, v174, v175
ds_write_b128 v246, v[168:171] offset:0
ds_read_b128 v[164:167], v247 offset:0
ds_read_b128 v[172:175], v247 offset:1024
v_mul_f32 v136, v136, v41
v_mul_f32 v137, v137, v41
v_mul_f32 v138, v138, v41
v_mul_f32 v139, v139, v41
v_mul_f32 v140, v140, v41
v_mul_f32 v141, v141, v41
v_mul_f32 v142, v142, v41
v_mul_f32 v143, v143, v41
v_cvt_pk_bf16_f32 v136, v136, v137
v_cvt_pk_bf16_f32 v137, v138, v139
v_cvt_pk_bf16_f32 v138, v140, v141
v_cvt_pk_bf16_f32 v139, v142, v143
ds_write_b128 v251, v[136:139] offset:12288
s_waitcnt lgkmcnt(0)
s_barrier
ds_read_b128 v[224:227], v252 offset:12288
ds_read_b128 v[228:231], v252 offset:13312
ds_read_b128 v[208:211], v252 offset:14336
ds_read_b128 v[212:215], v252 offset:15360
s_waitcnt vmcnt(4)
s_waitcnt lgkmcnt(3)
v_mfma_f32_16x16x32_bf16 v[176:179], a[192:195], v[224:227], v[176:179]
v_swap_b32 v122, v124
v_mfma_f32_16x16x32_bf16 v[180:183], a[196:199], v[224:227], v[180:183]
v_swap_b32 v123, v125
s_nop 1
v_mfma_f32_16x16x32_bf16 v[128:131], v[120:123], v[24:27], 0
buffer_store_dwordx4 v[164:167], v44, s[56:59], s6 offen sc1
v_mfma_f32_16x16x32_bf16 v[132:135], v[124:127], v[24:27], 0
buffer_store_dwordx4 v[172:175], v45, s[56:59], s6 offen sc1
v_mfma_f32_16x16x32_bf16 v[184:187], a[200:203], v[224:227], v[184:187]
v_mfma_f32_16x16x32_bf16 v[188:191], a[204:207], v[224:227], v[188:191]
s_waitcnt lgkmcnt(2)
v_mfma_f32_16x16x32_bf16 v[176:179], a[208:211], v[228:231], v[176:179]
v_mfma_f32_16x16x32_bf16 v[180:183], a[212:215], v[228:231], v[180:183]
v_mfma_f32_16x16x32_bf16 v[184:187], a[216:219], v[228:231], v[184:187]
v_mfma_f32_16x16x32_bf16 v[188:191], a[220:223], v[228:231], v[188:191]
s_waitcnt vmcnt(4)
s_waitcnt lgkmcnt(1)
v_mfma_f32_16x16x32_bf16 v[176:179], a[224:227], v[208:211], v[176:179]
v_swap_b32 v50, v52
v_mfma_f32_16x16x32_bf16 v[180:183], a[228:231], v[208:211], v[180:183]
v_swap_b32 v51, v53
s_nop 1
v_mfma_f32_16x16x32_bf16 v[128:131], v[48:51], v[28:31], v[128:131]
v_mfma_f32_16x16x32_bf16 v[132:135], v[52:55], v[28:31], v[132:135]
v_mfma_f32_16x16x32_bf16 v[184:187], a[232:235], v[208:211], v[184:187]
v_mfma_f32_16x16x32_bf16 v[188:191], a[236:239], v[208:211], v[188:191]
s_waitcnt lgkmcnt(0)
v_mfma_f32_16x16x32_bf16 v[176:179], a[240:243], v[212:215], v[176:179]
v_mfma_f32_16x16x32_bf16 v[180:183], a[244:247], v[212:215], v[180:183]
v_mfma_f32_16x16x32_bf16 v[184:187], a[248:251], v[212:215], v[184:187]
v_mfma_f32_16x16x32_bf16 v[188:191], a[252:255], v[212:215], v[188:191]
s_waitcnt vmcnt(2)
v_swap_b32 v58, v60
v_swap_b32 v59, v61
s_nop 1
v_mfma_f32_16x16x32_bf16 v[128:131], v[56:59], v[32:35], v[128:131]
v_cvt_pk_bf16_f32 v176, v176, v177
v_cvt_pk_bf16_f32 v177, v178, v179
v_mfma_f32_16x16x32_bf16 v[132:135], v[60:63], v[32:35], v[132:135]
v_cvt_pk_bf16_f32 v178, v180, v181
v_cvt_pk_bf16_f32 v179, v182, v183
ds_write_b128 v245, v[176:179] offset:2048
v_cvt_pk_bf16_f32 v184, v184, v185
v_cvt_pk_bf16_f32 v185, v186, v187
v_cvt_pk_bf16_f32 v186, v188, v189
v_cvt_pk_bf16_f32 v187, v190, v191
ds_write_b128 v246, v[184:187] offset:2048
ds_read_b128 v[180:183], v247 offset:2048
ds_read_b128 v[188:191], v247 offset:3072
v_mul_f32 v128, v128, v42
v_mul_f32 v129, v129, v42
v_mul_f32 v130, v130, v42
v_mul_f32 v131, v131, v42
v_mul_f32 v132, v132, v42
v_mul_f32 v133, v133, v42
v_mul_f32 v134, v134, v42
v_mul_f32 v135, v135, v42
v_cvt_pk_bf16_f32 v128, v128, v129
v_cvt_pk_bf16_f32 v129, v130, v131
v_cvt_pk_bf16_f32 v130, v132, v133
v_cvt_pk_bf16_f32 v131, v134, v135
ds_write_b128 v251, v[128:131] offset:20480
s_waitcnt lgkmcnt(0)
s_barrier
ds_read_b128 v[216:219], v252 offset:20480
ds_read_b128 v[220:223], v252 offset:21504
ds_read_b128 v[224:227], v252 offset:22528
ds_read_b128 v[228:231], v252 offset:23552
s_waitcnt lgkmcnt(3)
v_mfma_f32_16x16x32_bf16 v[192:195], a[192:195], v[216:219], v[192:195]
buffer_store_dwordx4 v[180:183], v44, s[56:59], s7 offen sc1
v_mfma_f32_16x16x32_bf16 v[196:199], a[196:199], v[216:219], v[196:199]
buffer_store_dwordx4 v[188:191], v45, s[56:59], s7 offen sc1
v_mfma_f32_16x16x32_bf16 v[200:203], a[200:203], v[216:219], v[200:203]
v_mfma_f32_16x16x32_bf16 v[204:207], a[204:207], v[216:219], v[204:207]
s_waitcnt lgkmcnt(2)
v_mfma_f32_16x16x32_bf16 v[192:195], a[208:211], v[220:223], v[192:195]
v_mfma_f32_16x16x32_bf16 v[196:199], a[212:215], v[220:223], v[196:199]
v_mfma_f32_16x16x32_bf16 v[200:203], a[216:219], v[220:223], v[200:203]
v_mfma_f32_16x16x32_bf16 v[204:207], a[220:223], v[220:223], v[204:207]
s_waitcnt lgkmcnt(1)
v_mfma_f32_16x16x32_bf16 v[192:195], a[224:227], v[224:227], v[192:195]
v_mfma_f32_16x16x32_bf16 v[196:199], a[228:231], v[224:227], v[196:199]
v_mfma_f32_16x16x32_bf16 v[200:203], a[232:235], v[224:227], v[200:203]
v_mfma_f32_16x16x32_bf16 v[204:207], a[236:239], v[224:227], v[204:207]
s_waitcnt lgkmcnt(0)
v_mfma_f32_16x16x32_bf16 v[192:195], a[240:243], v[228:231], v[192:195]
v_mfma_f32_16x16x32_bf16 v[196:199], a[244:247], v[228:231], v[196:199]
v_mfma_f32_16x16x32_bf16 v[200:203], a[248:251], v[228:231], v[200:203]
v_mfma_f32_16x16x32_bf16 v[204:207], a[252:255], v[228:231], v[204:207]
s_nop 4
v_cvt_pk_bf16_f32 v192, v192, v193
v_cvt_pk_bf16_f32 v193, v194, v195
v_cvt_pk_bf16_f32 v194, v196, v197
v_cvt_pk_bf16_f32 v195, v198, v199
ds_write_b128 v245, v[192:195] offset:4096
v_cvt_pk_bf16_f32 v200, v200, v201
v_cvt_pk_bf16_f32 v201, v202, v203
v_cvt_pk_bf16_f32 v202, v204, v205
v_cvt_pk_bf16_f32 v203, v206, v207
ds_write_b128 v246, v[200:203] offset:4096
ds_read_b128 v[196:199], v247 offset:4096
ds_read_b128 v[204:207], v247 offset:5120
s_waitcnt lgkmcnt(1)
buffer_store_dwordx4 v[196:199], v44, s[56:59], s29 offen sc1
s_waitcnt lgkmcnt(0)
buffer_store_dwordx4 v[204:207], v45, s[56:59], s29 offen sc1
s_branch L2_fin
LF_spinQ:
s_mov_b32 s94, 0x10000
LF_spin2Q:
buffer_load_dwordx2 v[242:243], v46, s[16:19], 0 offen offset:0 sc1
s_sub_u32 s94, s94, 1
s_waitcnt vmcnt(0)
s_cbranch_scc1 LF_spin2Q_go
v_cmp_ne_u64 vcc, s[98:99], v[242:243]
s_nop 1
s_cbranch_vccnz LF_spin2Q
LF_spin2Q_go:
s_branch LF_goQ
LF_wf:
s_mov_b32 s94, 0x10000
LF_wf2:
buffer_load_dwordx2 v[108:109], v110, s[16:19], 0 offen sc1
s_sub_u32 s94, s94, 1
s_waitcnt vmcnt(0)
s_cbranch_scc1 LF_wf2_go
v_cmp_ne_u64 vcc, s[98:99], v[108:109]
s_nop 1
s_cbranch_vccnz LF_wf2
LF_wf2_go:
s_branch LF_wf_go
LM_pb:
s_mov_b32 s3, 0x10000
LM_pb2:
buffer_load_dwordx2 v[252:253], v251, s[16:19], 0 offen sc1
s_sub_u32 s3, s3, 1
s_waitcnt vmcnt(0)
s_cbranch_scc1 LM_pb2_go
v_cmp_ne_u64 vcc, s[98:99], v[252:253]
s_nop 1
s_cbranch_vccnz LM_pb2
LM_pb2_go:
s_branch LM_pb_ret
L2_Fend:
L2_rare_site0:
s_mov_b32 s36, 0
s_branch L2_rare_0_0
L2_rare_0_0:
s_nop 15
s_nop 15
s_waitcnt lgkmcnt(0)
v_log_f32 v243, v224
v_max3_f32 v232, v128, v129, v130
v_max3_f32 v232, v232, v131, v243
v_mov_b32 v243, v232
s_nop 1
v_permlane32_swap_b32 v232, v243
s_nop 1
v_max_f32 v232, v232, v243
v_mov_b32 v243, v232
s_nop 1
v_permlane16_swap_b32 v232, v243
s_nop 1
v_max_f32 v232, v232, v243
v_ceil_f32 v232, v232
v_max_f32 v232, 0, v232
v_sub_f32 v243, 0, v232
v_exp_f32 v236, v243
s_nop 1
v_mul_f32 v224, v224, v236
v_add_f32 v244, v244, v232
v_sub_f32 v192, v192, v232
v_sub_f32 v128, v128, v232
v_sub_f32 v144, v144, v232
v_sub_f32 v193, v193, v232
v_sub_f32 v129, v129, v232
v_sub_f32 v145, v145, v232
v_sub_f32 v194, v194, v232
v_sub_f32 v130, v130, v232
v_sub_f32 v146, v146, v232
v_sub_f32 v195, v195, v232
v_sub_f32 v131, v131, v232
v_sub_f32 v147, v147, v232
v_lshlrev_b32 v242, 16, v160
v_and_b32 v243, 0xffff0000, v160
v_mul_f32 v242, v242, v236
v_mul_f32 v243, v243, v236
v_cvt_pk_bf16_f32 v160, v242, v243
v_lshlrev_b32 v242, 16, v161
v_and_b32 v243, 0xffff0000, v161
v_mul_f32 v242, v242, v236
v_mul_f32 v243, v243, v236
v_cvt_pk_bf16_f32 v161, v242, v243
v_lshlrev_b32 v242, 16, v162
v_and_b32 v243, 0xffff0000, v162
v_mul_f32 v242, v242, v236
v_mul_f32 v243, v243, v236
v_cvt_pk_bf16_f32 v162, v242, v243
v_lshlrev_b32 v242, 16, v163
v_and_b32 v243, 0xffff0000, v163
v_mul_f32 v242, v242, v236
v_mul_f32 v243, v243, v236
v_cvt_pk_bf16_f32 v163, v242, v243
v_log_f32 v243, v225
v_max3_f32 v233, v132, v133, v134
v_max3_f32 v233, v233, v135, v243
v_mov_b32 v243, v233
s_nop 1
v_permlane32_swap_b32 v233, v243
s_nop 1
v_max_f32 v233, v233, v243
v_mov_b32 v243, v233
s_nop 1
v_permlane16_swap_b32 v233, v243
s_nop 1
v_max_f32 v233, v233, v243
v_ceil_f32 v233, v233
v_max_f32 v233, 0, v233
v_sub_f32 v243, 0, v233
v_exp_f32 v237, v243
s_nop 1
v_mul_f32 v225, v225, v237
v_add_f32 v245, v245, v233
v_sub_f32 v196, v196, v233
v_sub_f32 v132, v132, v233
v_sub_f32 v148, v148, v233
v_sub_f32 v197, v197, v233
v_sub_f32 v133, v133, v233
v_sub_f32 v149, v149, v233
v_sub_f32 v198, v198, v233
v_sub_f32 v134, v134, v233
v_sub_f32 v150, v150, v233
v_sub_f32 v199, v199, v233
v_sub_f32 v135, v135, v233
v_sub_f32 v151, v151, v233
v_lshlrev_b32 v242, 16, v164
v_and_b32 v243, 0xffff0000, v164
v_mul_f32 v242, v242, v237
v_mul_f32 v243, v243, v237
v_cvt_pk_bf16_f32 v164, v242, v243
v_lshlrev_b32 v242, 16, v165
v_and_b32 v243, 0xffff0000, v165
v_mul_f32 v242, v242, v237
v_mul_f32 v243, v243, v237
v_cvt_pk_bf16_f32 v165, v242, v243
v_lshlrev_b32 v242, 16, v166
v_and_b32 v243, 0xffff0000, v166
v_mul_f32 v242, v242, v237
v_mul_f32 v243, v243, v237
v_cvt_pk_bf16_f32 v166, v242, v243
v_lshlrev_b32 v242, 16, v167
v_and_b32 v243, 0xffff0000, v167
v_mul_f32 v242, v242, v237
v_mul_f32 v243, v243, v237
v_cvt_pk_bf16_f32 v167, v242, v243
v_log_f32 v243, v226
v_max3_f32 v234, v136, v137, v138
v_max3_f32 v234, v234, v139, v243
v_mov_b32 v243, v234
s_nop 1
v_permlane32_swap_b32 v234, v243
s_nop 1
v_max_f32 v234, v234, v243
v_mov_b32 v243, v234
s_nop 1
v_permlane16_swap_b32 v234, v243
s_nop 1
v_max_f32 v234, v234, v243
v_ceil_f32 v234, v234
v_max_f32 v234, 0, v234
v_sub_f32 v243, 0, v234
v_exp_f32 v238, v243
s_nop 1
v_mul_f32 v226, v226, v238
v_add_f32 v246, v246, v234
v_sub_f32 v200, v200, v234
v_sub_f32 v136, v136, v234
v_sub_f32 v152, v152, v234
v_sub_f32 v201, v201, v234
v_sub_f32 v137, v137, v234
v_sub_f32 v153, v153, v234
v_sub_f32 v202, v202, v234
v_sub_f32 v138, v138, v234
v_sub_f32 v154, v154, v234
v_sub_f32 v203, v203, v234
v_sub_f32 v139, v139, v234
v_sub_f32 v155, v155, v234
v_lshlrev_b32 v242, 16, v168
v_and_b32 v243, 0xffff0000, v168
v_mul_f32 v242, v242, v238
v_mul_f32 v243, v243, v238
v_cvt_pk_bf16_f32 v168, v242, v243
v_lshlrev_b32 v242, 16, v169
v_and_b32 v243, 0xffff0000, v169
v_mul_f32 v242, v242, v238
v_mul_f32 v243, v243, v238
v_cvt_pk_bf16_f32 v169, v242, v243
v_lshlrev_b32 v242, 16, v170
v_and_b32 v243, 0xffff0000, v170
v_mul_f32 v242, v242, v238
v_mul_f32 v243, v243, v238
v_cvt_pk_bf16_f32 v170, v242, v243
v_lshlrev_b32 v242, 16, v171
v_and_b32 v243, 0xffff0000, v171
v_mul_f32 v242, v242, v238
v_mul_f32 v243, v243, v238
v_cvt_pk_bf16_f32 v171, v242, v243
v_log_f32 v243, v227
v_max3_f32 v235, v140, v141, v142
v_max3_f32 v235, v235, v143, v243
v_mov_b32 v243, v235
s_nop 1
v_permlane32_swap_b32 v235, v243
s_nop 1
v_max_f32 v235, v235, v243
v_mov_b32 v243, v235
s_nop 1
v_permlane16_swap_b32 v235, v243
s_nop 1
v_max_f32 v235, v235, v243
v_ceil_f32 v235, v235
v_max_f32 v235, 0, v235
v_sub_f32 v243, 0, v235
v_exp_f32 v239, v243
s_nop 1
v_mul_f32 v227, v227, v239
v_add_f32 v247, v247, v235
v_sub_f32 v204, v204, v235
v_sub_f32 v140, v140, v235
v_sub_f32 v156, v156, v235
v_sub_f32 v205, v205, v235
v_sub_f32 v141, v141, v235
v_sub_f32 v157, v157, v235
v_sub_f32 v206, v206, v235
v_sub_f32 v142, v142, v235
v_sub_f32 v158, v158, v235
v_sub_f32 v207, v207, v235
v_sub_f32 v143, v143, v235
v_sub_f32 v159, v159, v235
v_lshlrev_b32 v242, 16, v172
v_and_b32 v243, 0xffff0000, v172
v_mul_f32 v242, v242, v239
v_mul_f32 v243, v243, v239
v_cvt_pk_bf16_f32 v172, v242, v243
v_lshlrev_b32 v242, 16, v173
v_and_b32 v243, 0xffff0000, v173
v_mul_f32 v242, v242, v239
v_mul_f32 v243, v243, v239
v_cvt_pk_bf16_f32 v173, v242, v243
v_lshlrev_b32 v242, 16, v174
v_and_b32 v243, 0xffff0000, v174
v_mul_f32 v242, v242, v239
v_mul_f32 v243, v243, v239
v_cvt_pk_bf16_f32 v174, v242, v243
v_lshlrev_b32 v242, 16, v175
v_and_b32 v243, 0xffff0000, v175
v_mul_f32 v242, v242, v239
v_mul_f32 v243, v243, v239
v_cvt_pk_bf16_f32 v175, v242, v243
v_exp_f32 v232, v128
v_exp_f32 v233, v129
v_exp_f32 v234, v130
v_exp_f32 v235, v131
s_nop 1
v_add_f32 v228, v224, v232
v_add_f32 v228, v228, v233
v_add_f32 v228, v228, v234
v_add_f32 v228, v228, v235
v_cvt_pk_bf16_f32 v176, v232, v233
v_cvt_pk_bf16_f32 v177, v234, v235
v_exp_f32 v232, v132
v_exp_f32 v233, v133
v_exp_f32 v234, v134
v_exp_f32 v235, v135
s_nop 1
v_add_f32 v229, v225, v232
v_add_f32 v229, v229, v233
v_add_f32 v229, v229, v234
v_add_f32 v229, v229, v235
v_cvt_pk_bf16_f32 v180, v232, v233
v_cvt_pk_bf16_f32 v181, v234, v235
v_exp_f32 v232, v136
v_exp_f32 v233, v137
v_exp_f32 v234, v138
v_exp_f32 v235, v139
s_nop 1
v_add_f32 v230, v226, v232
v_add_f32 v230, v230, v233
v_add_f32 v230, v230, v234
v_add_f32 v230, v230, v235
v_cvt_pk_bf16_f32 v184, v232, v233
v_cvt_pk_bf16_f32 v185, v234, v235
v_exp_f32 v232, v140
v_exp_f32 v233, v141
v_exp_f32 v234, v142
v_exp_f32 v235, v143
s_nop 1
v_add_f32 v231, v227, v232
v_add_f32 v231, v231, v233
v_add_f32 v231, v231, v234
v_add_f32 v231, v231, v235
v_cvt_pk_bf16_f32 v188, v232, v233
v_cvt_pk_bf16_f32 v189, v234, v235
s_branch L2_rare_common
L2_rare_site1:
s_mov_b32 s36, 1
s_branch L2_rare_0_1
L2_rare_0_1:
s_nop 15
s_nop 15
s_waitcnt lgkmcnt(0)
v_log_f32 v243, v228
v_max3_f32 v232, v144, v145, v146
v_max3_f32 v232, v232, v147, v243
v_mov_b32 v243, v232
s_nop 1
v_permlane32_swap_b32 v232, v243
s_nop 1
v_max_f32 v232, v232, v243
v_mov_b32 v243, v232
s_nop 1
v_permlane16_swap_b32 v232, v243
s_nop 1
v_max_f32 v232, v232, v243
v_ceil_f32 v232, v232
v_max_f32 v232, 0, v232
v_sub_f32 v243, 0, v232
v_exp_f32 v236, v243
s_nop 1
v_mul_f32 v228, v228, v236
v_add_f32 v244, v244, v232
v_sub_f32 v192, v192, v232
v_sub_f32 v128, v128, v232
v_sub_f32 v144, v144, v232
v_sub_f32 v193, v193, v232
v_sub_f32 v129, v129, v232
v_sub_f32 v145, v145, v232
v_sub_f32 v194, v194, v232
v_sub_f32 v130, v130, v232
v_sub_f32 v146, v146, v232
v_sub_f32 v195, v195, v232
v_sub_f32 v131, v131, v232
v_sub_f32 v147, v147, v232
v_lshlrev_b32 v242, 16, v160
v_and_b32 v243, 0xffff0000, v160
v_mul_f32 v242, v242, v236
v_mul_f32 v243, v243, v236
v_cvt_pk_bf16_f32 v160, v242, v243
v_lshlrev_b32 v242, 16, v161
v_and_b32 v243, 0xffff0000, v161
v_mul_f32 v242, v242, v236
v_mul_f32 v243, v243, v236
v_cvt_pk_bf16_f32 v161, v242, v243
v_lshlrev_b32 v242, 16, v162
v_and_b32 v243, 0xffff0000, v162
v_mul_f32 v242, v242, v236
v_mul_f32 v243, v243, v236
v_cvt_pk_bf16_f32 v162, v242, v243
v_lshlrev_b32 v242, 16, v163
v_and_b32 v243, 0xffff0000, v163
v_mul_f32 v242, v242, v236
v_mul_f32 v243, v243, v236
v_cvt_pk_bf16_f32 v163, v242, v243
v_lshlrev_b32 v242, 16, v176
v_and_b32 v243, 0xffff0000, v176
v_mul_f32 v242, v242, v236
v_mul_f32 v243, v243, v236
v_cvt_pk_bf16_f32 v176, v242, v243
v_lshlrev_b32 v242, 16, v177
v_and_b32 v243, 0xffff0000, v177
v_mul_f32 v242, v242, v236
v_mul_f32 v243, v243, v236
v_cvt_pk_bf16_f32 v177, v242, v243
v_log_f32 v243, v229
v_max3_f32 v233, v148, v149, v150
v_max3_f32 v233, v233, v151, v243
v_mov_b32 v243, v233
s_nop 1
v_permlane32_swap_b32 v233, v243
s_nop 1
v_max_f32 v233, v233, v243
v_mov_b32 v243, v233
s_nop 1
v_permlane16_swap_b32 v233, v243
s_nop 1
v_max_f32 v233, v233, v243
v_ceil_f32 v233, v233
v_max_f32 v233, 0, v233
v_sub_f32 v243, 0, v233
v_exp_f32 v237, v243
s_nop 1
v_mul_f32 v229, v229, v237
v_add_f32 v245, v245, v233
v_sub_f32 v196, v196, v233
v_sub_f32 v132, v132, v233
v_sub_f32 v148, v148, v233
v_sub_f32 v197, v197, v233
v_sub_f32 v133, v133, v233
v_sub_f32 v149, v149, v233
v_sub_f32 v198, v198, v233
v_sub_f32 v134, v134, v233
v_sub_f32 v150, v150, v233
v_sub_f32 v199, v199, v233
v_sub_f32 v135, v135, v233
v_sub_f32 v151, v151, v233
v_lshlrev_b32 v242, 16, v164
v_and_b32 v243, 0xffff0000, v164
v_mul_f32 v242, v242, v237
v_mul_f32 v243, v243, v237
v_cvt_pk_bf16_f32 v164, v242, v243
v_lshlrev_b32 v242, 16, v165
v_and_b32 v243, 0xffff0000, v165
v_mul_f32 v242, v242, v237
v_mul_f32 v243, v243, v237
v_cvt_pk_bf16_f32 v165, v242, v243
v_lshlrev_b32 v242, 16, v166
v_and_b32 v243, 0xffff0000, v166
v_mul_f32 v242, v242, v237
v_mul_f32 v243, v243, v237
v_cvt_pk_bf16_f32 v166, v242, v243
v_lshlrev_b32 v242, 16, v167
v_and_b32 v243, 0xffff0000, v167
v_mul_f32 v242, v242, v237
v_mul_f32 v243, v243, v237
v_cvt_pk_bf16_f32 v167, v242, v243
v_lshlrev_b32 v242, 16, v180
v_and_b32 v243, 0xffff0000, v180
v_mul_f32 v242, v242, v237
v_mul_f32 v243, v243, v237
v_cvt_pk_bf16_f32 v180, v242, v243
v_lshlrev_b32 v242, 16, v181
v_and_b32 v243, 0xffff0000, v181
v_mul_f32 v242, v242, v237
v_mul_f32 v243, v243, v237
v_cvt_pk_bf16_f32 v181, v242, v243
v_log_f32 v243, v230
v_max3_f32 v234, v152, v153, v154
v_max3_f32 v234, v234, v155, v243
v_mov_b32 v243, v234
s_nop 1
v_permlane32_swap_b32 v234, v243
s_nop 1
v_max_f32 v234, v234, v243
v_mov_b32 v243, v234
s_nop 1
v_permlane16_swap_b32 v234, v243
s_nop 1
v_max_f32 v234, v234, v243
v_ceil_f32 v234, v234
v_max_f32 v234, 0, v234
v_sub_f32 v243, 0, v234
v_exp_f32 v238, v243
s_nop 1
v_mul_f32 v230, v230, v238
v_add_f32 v246, v246, v234
v_sub_f32 v200, v200, v234
v_sub_f32 v136, v136, v234
v_sub_f32 v152, v152, v234
v_sub_f32 v201, v201, v234
v_sub_f32 v137, v137, v234
v_sub_f32 v153, v153, v234
v_sub_f32 v202, v202, v234
v_sub_f32 v138, v138, v234
v_sub_f32 v154, v154, v234
v_sub_f32 v203, v203, v234
v_sub_f32 v139, v139, v234
v_sub_f32 v155, v155, v234
v_lshlrev_b32 v242, 16, v168
v_and_b32 v243, 0xffff0000, v168
v_mul_f32 v242, v242, v238
v_mul_f32 v243, v243, v238
v_cvt_pk_bf16_f32 v168, v242, v243
v_lshlrev_b32 v242, 16, v169
v_and_b32 v243, 0xffff0000, v169
v_mul_f32 v242, v242, v238
v_mul_f32 v243, v243, v238
v_cvt_pk_bf16_f32 v169, v242, v243
v_lshlrev_b32 v242, 16, v170
v_and_b32 v243, 0xffff0000, v170
v_mul_f32 v242, v242, v238
v_mul_f32 v243, v243, v238
v_cvt_pk_bf16_f32 v170, v242, v243
v_lshlrev_b32 v242, 16, v171
v_and_b32 v243, 0xffff0000, v171
v_mul_f32 v242, v242, v238
v_mul_f32 v243, v243, v238
v_cvt_pk_bf16_f32 v171, v242, v243
v_lshlrev_b32 v242, 16, v184
v_and_b32 v243, 0xffff0000, v184
v_mul_f32 v242, v242, v238
v_mul_f32 v243, v243, v238
v_cvt_pk_bf16_f32 v184, v242, v243
v_lshlrev_b32 v242, 16, v185
v_and_b32 v243, 0xffff0000, v185
v_mul_f32 v242, v242, v238
v_mul_f32 v243, v243, v238
v_cvt_pk_bf16_f32 v185, v242, v243
v_log_f32 v243, v231
v_max3_f32 v235, v156, v157, v158
v_max3_f32 v235, v235, v159, v243
v_mov_b32 v243, v235
s_nop 1
v_permlane32_swap_b32 v235, v243
s_nop 1
v_max_f32 v235, v235, v243
v_mov_b32 v243, v235
s_nop 1
v_permlane16_swap_b32 v235, v243
s_nop 1
v_max_f32 v235, v235, v243
v_ceil_f32 v235, v235
v_max_f32 v235, 0, v235
v_sub_f32 v243, 0, v235
v_exp_f32 v239, v243
s_nop 1
v_mul_f32 v231, v231, v239
v_add_f32 v247, v247, v235
v_sub_f32 v204, v204, v235
v_sub_f32 v140, v140, v235
v_sub_f32 v156, v156, v235
v_sub_f32 v205, v205, v235
v_sub_f32 v141, v141, v235
v_sub_f32 v157, v157, v235
v_sub_f32 v206, v206, v235
v_sub_f32 v142, v142, v235
v_sub_f32 v158, v158, v235
v_sub_f32 v207, v207, v235
v_sub_f32 v143, v143, v235
v_sub_f32 v159, v159, v235
v_lshlrev_b32 v242, 16, v172
v_and_b32 v243, 0xffff0000, v172
v_mul_f32 v242, v242, v239
v_mul_f32 v243, v243, v239
v_cvt_pk_bf16_f32 v172, v242, v243
v_lshlrev_b32 v242, 16, v173
v_and_b32 v243, 0xffff0000, v173
v_mul_f32 v242, v242, v239
v_mul_f32 v243, v243, v239
v_cvt_pk_bf16_f32 v173, v242, v243
v_lshlrev_b32 v242, 16, v174
v_and_b32 v243, 0xffff0000, v174
v_mul_f32 v242, v242, v239
v_mul_f32 v243, v243, v239
v_cvt_pk_bf16_f32 v174, v242, v243
v_lshlrev_b32 v242, 16, v175
v_and_b32 v243, 0xffff0000, v175
v_mul_f32 v242, v242, v239
v_mul_f32 v243, v243, v239
v_cvt_pk_bf16_f32 v175, v242, v243
v_lshlrev_b32 v242, 16, v188
v_and_b32 v243, 0xffff0000, v188
v_mul_f32 v242, v242, v239
v_mul_f32 v243, v243, v239
v_cvt_pk_bf16_f32 v188, v242, v243
v_lshlrev_b32 v242, 16, v189
v_and_b32 v243, 0xffff0000, v189
v_mul_f32 v242, v242, v239
v_mul_f32 v243, v243, v239
v_cvt_pk_bf16_f32 v189, v242, v243
v_exp_f32 v232, v144
v_exp_f32 v233, v145
v_exp_f32 v234, v146
v_exp_f32 v235, v147
s_nop 1
v_add_f32 v224, v228, v232
v_add_f32 v224, v224, v233
v_add_f32 v224, v224, v234
v_add_f32 v224, v224, v235
v_cvt_pk_bf16_f32 v178, v232, v233
v_cvt_pk_bf16_f32 v179, v234, v235
v_exp_f32 v232, v148
v_exp_f32 v233, v149
v_exp_f32 v234, v150
v_exp_f32 v235, v151
s_nop 1
v_add_f32 v225, v229, v232
v_add_f32 v225, v225, v233
v_add_f32 v225, v225, v234
v_add_f32 v225, v225, v235
v_cvt_pk_bf16_f32 v182, v232, v233
v_cvt_pk_bf16_f32 v183, v234, v235
v_exp_f32 v232, v152
v_exp_f32 v233, v153
v_exp_f32 v234, v154
v_exp_f32 v235, v155
s_nop 1
v_add_f32 v226, v230, v232
v_add_f32 v226, v226, v233
v_add_f32 v226, v226, v234
v_add_f32 v226, v226, v235
v_cvt_pk_bf16_f32 v186, v232, v233
v_cvt_pk_bf16_f32 v187, v234, v235
v_exp_f32 v232, v156
v_exp_f32 v233, v157
v_exp_f32 v234, v158
v_exp_f32 v235, v159
s_nop 1
v_add_f32 v227, v231, v232
v_add_f32 v227, v227, v233
v_add_f32 v227, v227, v234
v_add_f32 v227, v227, v235
v_cvt_pk_bf16_f32 v190, v232, v233
v_cvt_pk_bf16_f32 v191, v234, v235
s_branch L2_rare_common
L2_rare_site2:
s_mov_b32 s36, 2
s_branch L2_rare_1_0
L2_rare_1_0:
s_nop 15
s_nop 15
s_waitcnt lgkmcnt(0)
v_log_f32 v243, v224
v_max3_f32 v232, v128, v129, v130
v_max3_f32 v232, v232, v131, v243
v_mov_b32 v243, v232
s_nop 1
v_permlane32_swap_b32 v232, v243
s_nop 1
v_max_f32 v232, v232, v243
v_mov_b32 v243, v232
s_nop 1
v_permlane16_swap_b32 v232, v243
s_nop 1
v_max_f32 v232, v232, v243
v_ceil_f32 v232, v232
v_max_f32 v232, 0, v232
v_sub_f32 v243, 0, v232
v_exp_f32 v236, v243
s_nop 1
v_mul_f32 v224, v224, v236
v_add_f32 v244, v244, v232
v_sub_f32 v192, v192, v232
v_sub_f32 v128, v128, v232
v_sub_f32 v144, v144, v232
v_sub_f32 v193, v193, v232
v_sub_f32 v129, v129, v232
v_sub_f32 v145, v145, v232
v_sub_f32 v194, v194, v232
v_sub_f32 v130, v130, v232
v_sub_f32 v146, v146, v232
v_sub_f32 v195, v195, v232
v_sub_f32 v131, v131, v232
v_sub_f32 v147, v147, v232
v_lshlrev_b32 v242, 16, v176
v_and_b32 v243, 0xffff0000, v176
v_mul_f32 v242, v242, v236
v_mul_f32 v243, v243, v236
v_cvt_pk_bf16_f32 v176, v242, v243
v_lshlrev_b32 v242, 16, v177
v_and_b32 v243, 0xffff0000, v177
v_mul_f32 v242, v242, v236
v_mul_f32 v243, v243, v236
v_cvt_pk_bf16_f32 v177, v242, v243
v_lshlrev_b32 v242, 16, v178
v_and_b32 v243, 0xffff0000, v178
v_mul_f32 v242, v242, v236
v_mul_f32 v243, v243, v236
v_cvt_pk_bf16_f32 v178, v242, v243
v_lshlrev_b32 v242, 16, v179
v_and_b32 v243, 0xffff0000, v179
v_mul_f32 v242, v242, v236
v_mul_f32 v243, v243, v236
v_cvt_pk_bf16_f32 v179, v242, v243
v_log_f32 v243, v225
v_max3_f32 v233, v132, v133, v134
v_max3_f32 v233, v233, v135, v243
v_mov_b32 v243, v233
s_nop 1
v_permlane32_swap_b32 v233, v243
s_nop 1
v_max_f32 v233, v233, v243
v_mov_b32 v243, v233
s_nop 1
v_permlane16_swap_b32 v233, v243
s_nop 1
v_max_f32 v233, v233, v243
v_ceil_f32 v233, v233
v_max_f32 v233, 0, v233
v_sub_f32 v243, 0, v233
v_exp_f32 v237, v243
s_nop 1
v_mul_f32 v225, v225, v237
v_add_f32 v245, v245, v233
v_sub_f32 v196, v196, v233
v_sub_f32 v132, v132, v233
v_sub_f32 v148, v148, v233
v_sub_f32 v197, v197, v233
v_sub_f32 v133, v133, v233
v_sub_f32 v149, v149, v233
v_sub_f32 v198, v198, v233
v_sub_f32 v134, v134, v233
v_sub_f32 v150, v150, v233
v_sub_f32 v199, v199, v233
v_sub_f32 v135, v135, v233
v_sub_f32 v151, v151, v233
v_lshlrev_b32 v242, 16, v180
v_and_b32 v243, 0xffff0000, v180
v_mul_f32 v242, v242, v237
v_mul_f32 v243, v243, v237
v_cvt_pk_bf16_f32 v180, v242, v243
v_lshlrev_b32 v242, 16, v181
v_and_b32 v243, 0xffff0000, v181
v_mul_f32 v242, v242, v237
v_mul_f32 v243, v243, v237
v_cvt_pk_bf16_f32 v181, v242, v243
v_lshlrev_b32 v242, 16, v182
v_and_b32 v243, 0xffff0000, v182
v_mul_f32 v242, v242, v237
v_mul_f32 v243, v243, v237
v_cvt_pk_bf16_f32 v182, v242, v243
v_lshlrev_b32 v242, 16, v183
v_and_b32 v243, 0xffff0000, v183
v_mul_f32 v242, v242, v237
v_mul_f32 v243, v243, v237
v_cvt_pk_bf16_f32 v183, v242, v243
v_log_f32 v243, v226
v_max3_f32 v234, v136, v137, v138
v_max3_f32 v234, v234, v139, v243
v_mov_b32 v243, v234
s_nop 1
v_permlane32_swap_b32 v234, v243
s_nop 1
v_max_f32 v234, v234, v243
v_mov_b32 v243, v234
s_nop 1
v_permlane16_swap_b32 v234, v243
s_nop 1
v_max_f32 v234, v234, v243
v_ceil_f32 v234, v234
v_max_f32 v234, 0, v234
v_sub_f32 v243, 0, v234
v_exp_f32 v238, v243
s_nop 1
v_mul_f32 v226, v226, v238
v_add_f32 v246, v246, v234
v_sub_f32 v200, v200, v234
v_sub_f32 v136, v136, v234
v_sub_f32 v152, v152, v234
v_sub_f32 v201, v201, v234
v_sub_f32 v137, v137, v234
v_sub_f32 v153, v153, v234
v_sub_f32 v202, v202, v234
v_sub_f32 v138, v138, v234
v_sub_f32 v154, v154, v234
v_sub_f32 v203, v203, v234
v_sub_f32 v139, v139, v234
v_sub_f32 v155, v155, v234
v_lshlrev_b32 v242, 16, v184
v_and_b32 v243, 0xffff0000, v184
v_mul_f32 v242, v242, v238
v_mul_f32 v243, v243, v238
v_cvt_pk_bf16_f32 v184, v242, v243
v_lshlrev_b32 v242, 16, v185
v_and_b32 v243, 0xffff0000, v185
v_mul_f32 v242, v242, v238
v_mul_f32 v243, v243, v238
v_cvt_pk_bf16_f32 v185, v242, v243
v_lshlrev_b32 v242, 16, v186
v_and_b32 v243, 0xffff0000, v186
v_mul_f32 v242, v242, v238
v_mul_f32 v243, v243, v238
v_cvt_pk_bf16_f32 v186, v242, v243
v_lshlrev_b32 v242, 16, v187
v_and_b32 v243, 0xffff0000, v187
v_mul_f32 v242, v242, v238
v_mul_f32 v243, v243, v238
v_cvt_pk_bf16_f32 v187, v242, v243
v_log_f32 v243, v227
v_max3_f32 v235, v140, v141, v142
v_max3_f32 v235, v235, v143, v243
v_mov_b32 v243, v235
s_nop 1
v_permlane32_swap_b32 v235, v243
s_nop 1
v_max_f32 v235, v235, v243
v_mov_b32 v243, v235
s_nop 1
v_permlane16_swap_b32 v235, v243
s_nop 1
v_max_f32 v235, v235, v243
v_ceil_f32 v235, v235
v_max_f32 v235, 0, v235
v_sub_f32 v243, 0, v235
v_exp_f32 v239, v243
s_nop 1
v_mul_f32 v227, v227, v239
v_add_f32 v247, v247, v235
v_sub_f32 v204, v204, v235
v_sub_f32 v140, v140, v235
v_sub_f32 v156, v156, v235
v_sub_f32 v205, v205, v235
v_sub_f32 v141, v141, v235
v_sub_f32 v157, v157, v235
v_sub_f32 v206, v206, v235
v_sub_f32 v142, v142, v235
v_sub_f32 v158, v158, v235
v_sub_f32 v207, v207, v235
v_sub_f32 v143, v143, v235
v_sub_f32 v159, v159, v235
v_lshlrev_b32 v242, 16, v188
v_and_b32 v243, 0xffff0000, v188
v_mul_f32 v242, v242, v239
v_mul_f32 v243, v243, v239
v_cvt_pk_bf16_f32 v188, v242, v243
v_lshlrev_b32 v242, 16, v189
v_and_b32 v243, 0xffff0000, v189
v_mul_f32 v242, v242, v239
v_mul_f32 v243, v243, v239
v_cvt_pk_bf16_f32 v189, v242, v243
v_lshlrev_b32 v242, 16, v190
v_and_b32 v243, 0xffff0000, v190
v_mul_f32 v242, v242, v239
v_mul_f32 v243, v243, v239
v_cvt_pk_bf16_f32 v190, v242, v243
v_lshlrev_b32 v242, 16, v191
v_and_b32 v243, 0xffff0000, v191
v_mul_f32 v242, v242, v239
v_mul_f32 v243, v243, v239
v_cvt_pk_bf16_f32 v191, v242, v243
v_exp_f32 v232, v128
v_exp_f32 v233, v129
v_exp_f32 v234, v130
v_exp_f32 v235, v131
s_nop 1
v_add_f32 v228, v224, v232
v_add_f32 v228, v228, v233
v_add_f32 v228, v228, v234
v_add_f32 v228, v228, v235
v_cvt_pk_bf16_f32 v160, v232, v233
v_cvt_pk_bf16_f32 v161, v234, v235
v_exp_f32 v232, v132
v_exp_f32 v233, v133
v_exp_f32 v234, v134
v_exp_f32 v235, v135
s_nop 1
v_add_f32 v229, v225, v232
v_add_f32 v229, v229, v233
v_add_f32 v229, v229, v234
v_add_f32 v229, v229, v235
v_cvt_pk_bf16_f32 v164, v232, v233
v_cvt_pk_bf16_f32 v165, v234, v235
v_exp_f32 v232, v136
v_exp_f32 v233, v137
v_exp_f32 v234, v138
v_exp_f32 v235, v139
s_nop 1
v_add_f32 v230, v226, v232
v_add_f32 v230, v230, v233
v_add_f32 v230, v230, v234
v_add_f32 v230, v230, v235
v_cvt_pk_bf16_f32 v168, v232, v233
v_cvt_pk_bf16_f32 v169, v234, v235
v_exp_f32 v232, v140
v_exp_f32 v233, v141
v_exp_f32 v234, v142
v_exp_f32 v235, v143
s_nop 1
v_add_f32 v231, v227, v232
v_add_f32 v231, v231, v233
v_add_f32 v231, v231, v234
v_add_f32 v231, v231, v235
v_cvt_pk_bf16_f32 v172, v232, v233
v_cvt_pk_bf16_f32 v173, v234, v235
s_branch L2_rare_common
L2_rare_site3:
s_mov_b32 s36, 3
s_branch L2_rare_1_1
L2_rare_1_1:
s_nop 15
s_nop 15
s_waitcnt lgkmcnt(0)
v_log_f32 v243, v228
v_max3_f32 v232, v144, v145, v146
v_max3_f32 v232, v232, v147, v243
v_mov_b32 v243, v232
s_nop 1
v_permlane32_swap_b32 v232, v243
s_nop 1
v_max_f32 v232, v232, v243
v_mov_b32 v243, v232
s_nop 1
v_permlane16_swap_b32 v232, v243
s_nop 1
v_max_f32 v232, v232, v243
v_ceil_f32 v232, v232
v_max_f32 v232, 0, v232
v_sub_f32 v243, 0, v232
v_exp_f32 v236, v243
s_nop 1
v_mul_f32 v228, v228, v236
v_add_f32 v244, v244, v232
v_sub_f32 v192, v192, v232
v_sub_f32 v128, v128, v232
v_sub_f32 v144, v144, v232
v_sub_f32 v193, v193, v232
v_sub_f32 v129, v129, v232
v_sub_f32 v145, v145, v232
v_sub_f32 v194, v194, v232
v_sub_f32 v130, v130, v232
v_sub_f32 v146, v146, v232
v_sub_f32 v195, v195, v232
v_sub_f32 v131, v131, v232
v_sub_f32 v147, v147, v232
v_lshlrev_b32 v242, 16, v176
v_and_b32 v243, 0xffff0000, v176
v_mul_f32 v242, v242, v236
v_mul_f32 v243, v243, v236
v_cvt_pk_bf16_f32 v176, v242, v243
v_lshlrev_b32 v242, 16, v177
v_and_b32 v243, 0xffff0000, v177
v_mul_f32 v242, v242, v236
v_mul_f32 v243, v243, v236
v_cvt_pk_bf16_f32 v177, v242, v243
v_lshlrev_b32 v242, 16, v178
v_and_b32 v243, 0xffff0000, v178
v_mul_f32 v242, v242, v236
v_mul_f32 v243, v243, v236
v_cvt_pk_bf16_f32 v178, v242, v243
v_lshlrev_b32 v242, 16, v179
v_and_b32 v243, 0xffff0000, v179
v_mul_f32 v242, v242, v236
v_mul_f32 v243, v243, v236
v_cvt_pk_bf16_f32 v179, v242, v243
v_lshlrev_b32 v242, 16, v160
v_and_b32 v243, 0xffff0000, v160
v_mul_f32 v242, v242, v236
v_mul_f32 v243, v243, v236
v_cvt_pk_bf16_f32 v160, v242, v243
v_lshlrev_b32 v242, 16, v161
v_and_b32 v243, 0xffff0000, v161
v_mul_f32 v242, v242, v236
v_mul_f32 v243, v243, v236
v_cvt_pk_bf16_f32 v161, v242, v243
v_log_f32 v243, v229
v_max3_f32 v233, v148, v149, v150
v_max3_f32 v233, v233, v151, v243
v_mov_b32 v243, v233
s_nop 1
v_permlane32_swap_b32 v233, v243
s_nop 1
v_max_f32 v233, v233, v243
v_mov_b32 v243, v233
s_nop 1
v_permlane16_swap_b32 v233, v243
s_nop 1
v_max_f32 v233, v233, v243
v_ceil_f32 v233, v233
v_max_f32 v233, 0, v233
v_sub_f32 v243, 0, v233
v_exp_f32 v237, v243
s_nop 1
v_mul_f32 v229, v229, v237
v_add_f32 v245, v245, v233
v_sub_f32 v196, v196, v233
v_sub_f32 v132, v132, v233
v_sub_f32 v148, v148, v233
v_sub_f32 v197, v197, v233
v_sub_f32 v133, v133, v233
v_sub_f32 v149, v149, v233
v_sub_f32 v198, v198, v233
v_sub_f32 v134, v134, v233
v_sub_f32 v150, v150, v233
v_sub_f32 v199, v199, v233
v_sub_f32 v135, v135, v233
v_sub_f32 v151, v151, v233
v_lshlrev_b32 v242, 16, v180
v_and_b32 v243, 0xffff0000, v180
v_mul_f32 v242, v242, v237
v_mul_f32 v243, v243, v237
v_cvt_pk_bf16_f32 v180, v242, v243
v_lshlrev_b32 v242, 16, v181
v_and_b32 v243, 0xffff0000, v181
v_mul_f32 v242, v242, v237
v_mul_f32 v243, v243, v237
v_cvt_pk_bf16_f32 v181, v242, v243
v_lshlrev_b32 v242, 16, v182
v_and_b32 v243, 0xffff0000, v182
v_mul_f32 v242, v242, v237
v_mul_f32 v243, v243, v237
v_cvt_pk_bf16_f32 v182, v242, v243
v_lshlrev_b32 v242, 16, v183
v_and_b32 v243, 0xffff0000, v183
v_mul_f32 v242, v242, v237
v_mul_f32 v243, v243, v237
v_cvt_pk_bf16_f32 v183, v242, v243
v_lshlrev_b32 v242, 16, v164
v_and_b32 v243, 0xffff0000, v164
v_mul_f32 v242, v242, v237
v_mul_f32 v243, v243, v237
v_cvt_pk_bf16_f32 v164, v242, v243
v_lshlrev_b32 v242, 16, v165
v_and_b32 v243, 0xffff0000, v165
v_mul_f32 v242, v242, v237
v_mul_f32 v243, v243, v237
v_cvt_pk_bf16_f32 v165, v242, v243
v_log_f32 v243, v230
v_max3_f32 v234, v152, v153, v154
v_max3_f32 v234, v234, v155, v243
v_mov_b32 v243, v234
s_nop 1
v_permlane32_swap_b32 v234, v243
s_nop 1
v_max_f32 v234, v234, v243
v_mov_b32 v243, v234
s_nop 1
v_permlane16_swap_b32 v234, v243
s_nop 1
v_max_f32 v234, v234, v243
v_ceil_f32 v234, v234
v_max_f32 v234, 0, v234
v_sub_f32 v243, 0, v234
v_exp_f32 v238, v243
s_nop 1
v_mul_f32 v230, v230, v238
v_add_f32 v246, v246, v234
v_sub_f32 v200, v200, v234
v_sub_f32 v136, v136, v234
v_sub_f32 v152, v152, v234
v_sub_f32 v201, v201, v234
v_sub_f32 v137, v137, v234
v_sub_f32 v153, v153, v234
v_sub_f32 v202, v202, v234
v_sub_f32 v138, v138, v234
v_sub_f32 v154, v154, v234
v_sub_f32 v203, v203, v234
v_sub_f32 v139, v139, v234
v_sub_f32 v155, v155, v234
v_lshlrev_b32 v242, 16, v184
v_and_b32 v243, 0xffff0000, v184
v_mul_f32 v242, v242, v238
v_mul_f32 v243, v243, v238
v_cvt_pk_bf16_f32 v184, v242, v243
v_lshlrev_b32 v242, 16, v185
v_and_b32 v243, 0xffff0000, v185
v_mul_f32 v242, v242, v238
v_mul_f32 v243, v243, v238
v_cvt_pk_bf16_f32 v185, v242, v243
v_lshlrev_b32 v242, 16, v186
v_and_b32 v243, 0xffff0000, v186
v_mul_f32 v242, v242, v238
v_mul_f32 v243, v243, v238
v_cvt_pk_bf16_f32 v186, v242, v243
v_lshlrev_b32 v242, 16, v187
v_and_b32 v243, 0xffff0000, v187
v_mul_f32 v242, v242, v238
v_mul_f32 v243, v243, v238
v_cvt_pk_bf16_f32 v187, v242, v243
v_lshlrev_b32 v242, 16, v168
v_and_b32 v243, 0xffff0000, v168
v_mul_f32 v242, v242, v238
v_mul_f32 v243, v243, v238
v_cvt_pk_bf16_f32 v168, v242, v243
v_lshlrev_b32 v242, 16, v169
v_and_b32 v243, 0xffff0000, v169
v_mul_f32 v242, v242, v238
v_mul_f32 v243, v243, v238
v_cvt_pk_bf16_f32 v169, v242, v243
v_log_f32 v243, v231
v_max3_f32 v235, v156, v157, v158
v_max3_f32 v235, v235, v159, v243
v_mov_b32 v243, v235
s_nop 1
v_permlane32_swap_b32 v235, v243
s_nop 1
v_max_f32 v235, v235, v243
v_mov_b32 v243, v235
s_nop 1
v_permlane16_swap_b32 v235, v243
s_nop 1
v_max_f32 v235, v235, v243
v_ceil_f32 v235, v235
v_max_f32 v235, 0, v235
v_sub_f32 v243, 0, v235
v_exp_f32 v239, v243
s_nop 1
v_mul_f32 v231, v231, v239
v_add_f32 v247, v247, v235
v_sub_f32 v204, v204, v235
v_sub_f32 v140, v140, v235
v_sub_f32 v156, v156, v235
v_sub_f32 v205, v205, v235
v_sub_f32 v141, v141, v235
v_sub_f32 v157, v157, v235
v_sub_f32 v206, v206, v235
v_sub_f32 v142, v142, v235
v_sub_f32 v158, v158, v235
v_sub_f32 v207, v207, v235
v_sub_f32 v143, v143, v235
v_sub_f32 v159, v159, v235
v_lshlrev_b32 v242, 16, v188
v_and_b32 v243, 0xffff0000, v188
v_mul_f32 v242, v242, v239
v_mul_f32 v243, v243, v239
v_cvt_pk_bf16_f32 v188, v242, v243
v_lshlrev_b32 v242, 16, v189
v_and_b32 v243, 0xffff0000, v189
v_mul_f32 v242, v242, v239
v_mul_f32 v243, v243, v239
v_cvt_pk_bf16_f32 v189, v242, v243
v_lshlrev_b32 v242, 16, v190
v_and_b32 v243, 0xffff0000, v190
v_mul_f32 v242, v242, v239
v_mul_f32 v243, v243, v239
v_cvt_pk_bf16_f32 v190, v242, v243
v_lshlrev_b32 v242, 16, v191
v_and_b32 v243, 0xffff0000, v191
v_mul_f32 v242, v242, v239
v_mul_f32 v243, v243, v239
v_cvt_pk_bf16_f32 v191, v242, v243
v_lshlrev_b32 v242, 16, v172
v_and_b32 v243, 0xffff0000, v172
v_mul_f32 v242, v242, v239
v_mul_f32 v243, v243, v239
v_cvt_pk_bf16_f32 v172, v242, v243
v_lshlrev_b32 v242, 16, v173
v_and_b32 v243, 0xffff0000, v173
v_mul_f32 v242, v242, v239
v_mul_f32 v243, v243, v239
v_cvt_pk_bf16_f32 v173, v242, v243
v_exp_f32 v232, v144
v_exp_f32 v233, v145
v_exp_f32 v234, v146
v_exp_f32 v235, v147
s_nop 1
v_add_f32 v224, v228, v232
v_add_f32 v224, v224, v233
v_add_f32 v224, v224, v234
v_add_f32 v224, v224, v235
v_cvt_pk_bf16_f32 v162, v232, v233
v_cvt_pk_bf16_f32 v163, v234, v235
v_exp_f32 v232, v148
v_exp_f32 v233, v149
v_exp_f32 v234, v150
v_exp_f32 v235, v151
s_nop 1
v_add_f32 v225, v229, v232
v_add_f32 v225, v225, v233
v_add_f32 v225, v225, v234
v_add_f32 v225, v225, v235
v_cvt_pk_bf16_f32 v166, v232, v233
v_cvt_pk_bf16_f32 v167, v234, v235
v_exp_f32 v232, v152
v_exp_f32 v233, v153
v_exp_f32 v234, v154
v_exp_f32 v235, v155
s_nop 1
v_add_f32 v226, v230, v232
v_add_f32 v226, v226, v233
v_add_f32 v226, v226, v234
v_add_f32 v226, v226, v235
v_cvt_pk_bf16_f32 v170, v232, v233
v_cvt_pk_bf16_f32 v171, v234, v235
v_exp_f32 v232, v156
v_exp_f32 v233, v157
v_exp_f32 v234, v158
v_exp_f32 v235, v159
s_nop 1
v_add_f32 v227, v231, v232
v_add_f32 v227, v227, v233
v_add_f32 v227, v227, v234
v_add_f32 v227, v227, v235
v_cvt_pk_bf16_f32 v174, v232, v233
v_cvt_pk_bf16_f32 v175, v234, v235
s_branch L2_rare_common
L2_rare_site4:
s_mov_b32 s36, 4
s_branch L2_rare_t0_0_0
L2_rare_t0_0_0:
s_nop 15
s_nop 15
s_waitcnt lgkmcnt(0)
v_log_f32 v243, v224
v_max3_f32 v232, v128, v129, v130
v_max3_f32 v232, v232, v131, v243
v_mov_b32 v243, v232
s_nop 1
v_permlane32_swap_b32 v232, v243
s_nop 1
v_max_f32 v232, v232, v243
v_mov_b32 v243, v232
s_nop 1
v_permlane16_swap_b32 v232, v243
s_nop 1
v_max_f32 v232, v232, v243
v_ceil_f32 v232, v232
v_max_f32 v232, 0, v232
v_sub_f32 v243, 0, v232
v_exp_f32 v236, v243
s_nop 1
v_mul_f32 v224, v224, v236
v_add_f32 v244, v244, v232
v_sub_f32 v192, v192, v232
v_sub_f32 v128, v128, v232
v_sub_f32 v144, v144, v232
v_sub_f32 v193, v193, v232
v_sub_f32 v129, v129, v232
v_sub_f32 v145, v145, v232
v_sub_f32 v194, v194, v232
v_sub_f32 v130, v130, v232
v_sub_f32 v146, v146, v232
v_sub_f32 v195, v195, v232
v_sub_f32 v131, v131, v232
v_sub_f32 v147, v147, v232
ds_read_b64 v[254:255], v253 offset:0
s_waitcnt lgkmcnt(0)
v_lshlrev_b32 v242, 16, v254
v_and_b32 v243, 0xffff0000, v254
v_mul_f32 v242, v242, v236
v_mul_f32 v243, v243, v236
v_cvt_pk_bf16_f32 v254, v242, v243
v_lshlrev_b32 v242, 16, v255
v_and_b32 v243, 0xffff0000, v255
v_mul_f32 v242, v242, v236
v_mul_f32 v243, v243, v236
v_cvt_pk_bf16_f32 v255, v242, v243
ds_write_b64 v253, v[254:255] offset:0
s_waitcnt lgkmcnt(0)
ds_read_b64 v[254:255], v253 offset:8
s_waitcnt lgkmcnt(0)
v_lshlrev_b32 v242, 16, v254
v_and_b32 v243, 0xffff0000, v254
v_mul_f32 v242, v242, v236
v_mul_f32 v243, v243, v236
v_cvt_pk_bf16_f32 v254, v242, v243
v_lshlrev_b32 v242, 16, v255
v_and_b32 v243, 0xffff0000, v255
v_mul_f32 v242, v242, v236
v_mul_f32 v243, v243, v236
v_cvt_pk_bf16_f32 v255, v242, v243
ds_write_b64 v253, v[254:255] offset:8
s_waitcnt lgkmcnt(0)
v_log_f32 v243, v225
v_max3_f32 v233, v132, v133, v134
v_max3_f32 v233, v233, v135, v243
v_mov_b32 v243, v233
s_nop 1
v_permlane32_swap_b32 v233, v243
s_nop 1
v_max_f32 v233, v233, v243
v_mov_b32 v243, v233
s_nop 1
v_permlane16_swap_b32 v233, v243
s_nop 1
v_max_f32 v233, v233, v243
v_ceil_f32 v233, v233
v_max_f32 v233, 0, v233
v_sub_f32 v243, 0, v233
v_exp_f32 v237, v243
s_nop 1
v_mul_f32 v225, v225, v237
v_add_f32 v245, v245, v233
v_sub_f32 v196, v196, v233
v_sub_f32 v132, v132, v233
v_sub_f32 v148, v148, v233
v_sub_f32 v197, v197, v233
v_sub_f32 v133, v133, v233
v_sub_f32 v149, v149, v233
v_sub_f32 v198, v198, v233
v_sub_f32 v134, v134, v233
v_sub_f32 v150, v150, v233
v_sub_f32 v199, v199, v233
v_sub_f32 v135, v135, v233
v_sub_f32 v151, v151, v233
ds_read_b64 v[254:255], v253 offset:1024
s_waitcnt lgkmcnt(0)
v_lshlrev_b32 v242, 16, v254
v_and_b32 v243, 0xffff0000, v254
v_mul_f32 v242, v242, v237
v_mul_f32 v243, v243, v237
v_cvt_pk_bf16_f32 v254, v242, v243
v_lshlrev_b32 v242, 16, v255
v_and_b32 v243, 0xffff0000, v255
v_mul_f32 v242, v242, v237
v_mul_f32 v243, v243, v237
v_cvt_pk_bf16_f32 v255, v242, v243
ds_write_b64 v253, v[254:255] offset:1024
s_waitcnt lgkmcnt(0)
ds_read_b64 v[254:255], v253 offset:1032
s_waitcnt lgkmcnt(0)
v_lshlrev_b32 v242, 16, v254
v_and_b32 v243, 0xffff0000, v254
v_mul_f32 v242, v242, v237
v_mul_f32 v243, v243, v237
v_cvt_pk_bf16_f32 v254, v242, v243
v_lshlrev_b32 v242, 16, v255
v_and_b32 v243, 0xffff0000, v255
v_mul_f32 v242, v242, v237
v_mul_f32 v243, v243, v237
v_cvt_pk_bf16_f32 v255, v242, v243
ds_write_b64 v253, v[254:255] offset:1032
s_waitcnt lgkmcnt(0)
v_log_f32 v243, v226
v_max3_f32 v234, v136, v137, v138
v_max3_f32 v234, v234, v139, v243
v_mov_b32 v243, v234
s_nop 1
v_permlane32_swap_b32 v234, v243
s_nop 1
v_max_f32 v234, v234, v243
v_mov_b32 v243, v234
s_nop 1
v_permlane16_swap_b32 v234, v243
s_nop 1
v_max_f32 v234, v234, v243
v_ceil_f32 v234, v234
v_max_f32 v234, 0, v234
v_sub_f32 v243, 0, v234
v_exp_f32 v238, v243
s_nop 1
v_mul_f32 v226, v226, v238
v_add_f32 v246, v246, v234
v_sub_f32 v200, v200, v234
v_sub_f32 v136, v136, v234
v_sub_f32 v152, v152, v234
v_sub_f32 v201, v201, v234
v_sub_f32 v137, v137, v234
v_sub_f32 v153, v153, v234
v_sub_f32 v202, v202, v234
v_sub_f32 v138, v138, v234
v_sub_f32 v154, v154, v234
v_sub_f32 v203, v203, v234
v_sub_f32 v139, v139, v234
v_sub_f32 v155, v155, v234
ds_read_b64 v[254:255], v253 offset:2048
s_waitcnt lgkmcnt(0)
v_lshlrev_b32 v242, 16, v254
v_and_b32 v243, 0xffff0000, v254
v_mul_f32 v242, v242, v238
v_mul_f32 v243, v243, v238
v_cvt_pk_bf16_f32 v254, v242, v243
v_lshlrev_b32 v242, 16, v255
v_and_b32 v243, 0xffff0000, v255
v_mul_f32 v242, v242, v238
v_mul_f32 v243, v243, v238
v_cvt_pk_bf16_f32 v255, v242, v243
ds_write_b64 v253, v[254:255] offset:2048
s_waitcnt lgkmcnt(0)
ds_read_b64 v[254:255], v253 offset:2056
s_waitcnt lgkmcnt(0)
v_lshlrev_b32 v242, 16, v254
v_and_b32 v243, 0xffff0000, v254
v_mul_f32 v242, v242, v238
v_mul_f32 v243, v243, v238
v_cvt_pk_bf16_f32 v254, v242, v243
v_lshlrev_b32 v242, 16, v255
v_and_b32 v243, 0xffff0000, v255
v_mul_f32 v242, v242, v238
v_mul_f32 v243, v243, v238
v_cvt_pk_bf16_f32 v255, v242, v243
ds_write_b64 v253, v[254:255] offset:2056
s_waitcnt lgkmcnt(0)
v_log_f32 v243, v227
v_max3_f32 v235, v140, v141, v142
v_max3_f32 v235, v235, v143, v243
v_mov_b32 v243, v235
s_nop 1
v_permlane32_swap_b32 v235, v243
s_nop 1
v_max_f32 v235, v235, v243
v_mov_b32 v243, v235
s_nop 1
v_permlane16_swap_b32 v235, v243
s_nop 1
v_max_f32 v235, v235, v243
v_ceil_f32 v235, v235
v_max_f32 v235, 0, v235
v_sub_f32 v243, 0, v235
v_exp_f32 v239, v243
s_nop 1
v_mul_f32 v227, v227, v239
v_add_f32 v247, v247, v235
v_sub_f32 v204, v204, v235
v_sub_f32 v140, v140, v235
v_sub_f32 v156, v156, v235
v_sub_f32 v205, v205, v235
v_sub_f32 v141, v141, v235
v_sub_f32 v157, v157, v235
v_sub_f32 v206, v206, v235
v_sub_f32 v142, v142, v235
v_sub_f32 v158, v158, v235
v_sub_f32 v207, v207, v235
v_sub_f32 v143, v143, v235
v_sub_f32 v159, v159, v235
ds_read_b64 v[254:255], v253 offset:3072
s_waitcnt lgkmcnt(0)
v_lshlrev_b32 v242, 16, v254
v_and_b32 v243, 0xffff0000, v254
v_mul_f32 v242, v242, v239
v_mul_f32 v243, v243, v239
v_cvt_pk_bf16_f32 v254, v242, v243
v_lshlrev_b32 v242, 16, v255
v_and_b32 v243, 0xffff0000, v255
v_mul_f32 v242, v242, v239
v_mul_f32 v243, v243, v239
v_cvt_pk_bf16_f32 v255, v242, v243
ds_write_b64 v253, v[254:255] offset:3072
s_waitcnt lgkmcnt(0)
ds_read_b64 v[254:255], v253 offset:3080
s_waitcnt lgkmcnt(0)
v_lshlrev_b32 v242, 16, v254
v_and_b32 v243, 0xffff0000, v254
v_mul_f32 v242, v242, v239
v_mul_f32 v243, v243, v239
v_cvt_pk_bf16_f32 v254, v242, v243
v_lshlrev_b32 v242, 16, v255
v_and_b32 v243, 0xffff0000, v255
v_mul_f32 v242, v242, v239
v_mul_f32 v243, v243, v239
v_cvt_pk_bf16_f32 v255, v242, v243
ds_write_b64 v253, v[254:255] offset:3080
s_waitcnt lgkmcnt(0)
v_exp_f32 v232, v128
v_exp_f32 v233, v129
v_exp_f32 v234, v130
v_exp_f32 v235, v131
s_nop 1
v_add_f32 v228, v224, v232
v_add_f32 v228, v228, v233
v_add_f32 v228, v228, v234
v_add_f32 v228, v228, v235
v_cvt_pk_bf16_f32 v176, v232, v233
v_cvt_pk_bf16_f32 v177, v234, v235
v_exp_f32 v232, v132
v_exp_f32 v233, v133
v_exp_f32 v234, v134
v_exp_f32 v235, v135
s_nop 1
v_add_f32 v229, v225, v232
v_add_f32 v229, v229, v233
v_add_f32 v229, v229, v234
v_add_f32 v229, v229, v235
v_cvt_pk_bf16_f32 v180, v232, v233
v_cvt_pk_bf16_f32 v181, v234, v235
v_exp_f32 v232, v136
v_exp_f32 v233, v137
v_exp_f32 v234, v138
v_exp_f32 v235, v139
s_nop 1
v_add_f32 v230, v226, v232
v_add_f32 v230, v230, v233
v_add_f32 v230, v230, v234
v_add_f32 v230, v230, v235
v_cvt_pk_bf16_f32 v184, v232, v233
v_cvt_pk_bf16_f32 v185, v234, v235
v_exp_f32 v232, v140
v_exp_f32 v233, v141
v_exp_f32 v234, v142
v_exp_f32 v235, v143
s_nop 1
v_add_f32 v231, v227, v232
v_add_f32 v231, v231, v233
v_add_f32 v231, v231, v234
v_add_f32 v231, v231, v235
v_cvt_pk_bf16_f32 v188, v232, v233
v_cvt_pk_bf16_f32 v189, v234, v235
s_branch L2_rare_common
L2_rare_site5:
s_mov_b32 s36, 5
s_branch L2_rare_t0_1_1
L2_rare_t0_1_1:
s_nop 15
s_nop 15
s_waitcnt lgkmcnt(0)
v_log_f32 v243, v228
v_max3_f32 v232, v144, v145, v146
v_max3_f32 v232, v232, v147, v243
v_mov_b32 v243, v232
s_nop 1
v_permlane32_swap_b32 v232, v243
s_nop 1
v_max_f32 v232, v232, v243
v_mov_b32 v243, v232
s_nop 1
v_permlane16_swap_b32 v232, v243
s_nop 1
v_max_f32 v232, v232, v243
v_ceil_f32 v232, v232
v_max_f32 v232, 0, v232
v_sub_f32 v243, 0, v232
v_exp_f32 v236, v243
s_nop 1
v_mul_f32 v228, v228, v236
v_add_f32 v244, v244, v232
v_sub_f32 v192, v192, v232
v_sub_f32 v128, v128, v232
v_sub_f32 v144, v144, v232
v_sub_f32 v193, v193, v232
v_sub_f32 v129, v129, v232
v_sub_f32 v145, v145, v232
v_sub_f32 v194, v194, v232
v_sub_f32 v130, v130, v232
v_sub_f32 v146, v146, v232
v_sub_f32 v195, v195, v232
v_sub_f32 v131, v131, v232
v_sub_f32 v147, v147, v232
v_lshlrev_b32 v242, 16, v176
v_and_b32 v243, 0xffff0000, v176
v_mul_f32 v242, v242, v236
v_mul_f32 v243, v243, v236
v_cvt_pk_bf16_f32 v176, v242, v243
v_lshlrev_b32 v242, 16, v177
v_and_b32 v243, 0xffff0000, v177
v_mul_f32 v242, v242, v236
v_mul_f32 v243, v243, v236
v_cvt_pk_bf16_f32 v177, v242, v243
ds_read_b64 v[254:255], v253 offset:0
s_waitcnt lgkmcnt(0)
v_lshlrev_b32 v242, 16, v254
v_and_b32 v243, 0xffff0000, v254
v_mul_f32 v242, v242, v236
v_mul_f32 v243, v243, v236
v_cvt_pk_bf16_f32 v254, v242, v243
v_lshlrev_b32 v242, 16, v255
v_and_b32 v243, 0xffff0000, v255
v_mul_f32 v242, v242, v236
v_mul_f32 v243, v243, v236
v_cvt_pk_bf16_f32 v255, v242, v243
ds_write_b64 v253, v[254:255] offset:0
s_waitcnt lgkmcnt(0)
ds_read_b64 v[254:255], v253 offset:8
s_waitcnt lgkmcnt(0)
v_lshlrev_b32 v242, 16, v254
v_and_b32 v243, 0xffff0000, v254
v_mul_f32 v242, v242, v236
v_mul_f32 v243, v243, v236
v_cvt_pk_bf16_f32 v254, v242, v243
v_lshlrev_b32 v242, 16, v255
v_and_b32 v243, 0xffff0000, v255
v_mul_f32 v242, v242, v236
v_mul_f32 v243, v243, v236
v_cvt_pk_bf16_f32 v255, v242, v243
ds_write_b64 v253, v[254:255] offset:8
s_waitcnt lgkmcnt(0)
v_log_f32 v243, v229
v_max3_f32 v233, v148, v149, v150
v_max3_f32 v233, v233, v151, v243
v_mov_b32 v243, v233
s_nop 1
v_permlane32_swap_b32 v233, v243
s_nop 1
v_max_f32 v233, v233, v243
v_mov_b32 v243, v233
s_nop 1
v_permlane16_swap_b32 v233, v243
s_nop 1
v_max_f32 v233, v233, v243
v_ceil_f32 v233, v233
v_max_f32 v233, 0, v233
v_sub_f32 v243, 0, v233
v_exp_f32 v237, v243
s_nop 1
v_mul_f32 v229, v229, v237
v_add_f32 v245, v245, v233
v_sub_f32 v196, v196, v233
v_sub_f32 v132, v132, v233
v_sub_f32 v148, v148, v233
v_sub_f32 v197, v197, v233
v_sub_f32 v133, v133, v233
v_sub_f32 v149, v149, v233
v_sub_f32 v198, v198, v233
v_sub_f32 v134, v134, v233
v_sub_f32 v150, v150, v233
v_sub_f32 v199, v199, v233
v_sub_f32 v135, v135, v233
v_sub_f32 v151, v151, v233
v_lshlrev_b32 v242, 16, v180
v_and_b32 v243, 0xffff0000, v180
v_mul_f32 v242, v242, v237
v_mul_f32 v243, v243, v237
v_cvt_pk_bf16_f32 v180, v242, v243
v_lshlrev_b32 v242, 16, v181
v_and_b32 v243, 0xffff0000, v181
v_mul_f32 v242, v242, v237
v_mul_f32 v243, v243, v237
v_cvt_pk_bf16_f32 v181, v242, v243
ds_read_b64 v[254:255], v253 offset:1024
s_waitcnt lgkmcnt(0)
v_lshlrev_b32 v242, 16, v254
v_and_b32 v243, 0xffff0000, v254
v_mul_f32 v242, v242, v237
v_mul_f32 v243, v243, v237
v_cvt_pk_bf16_f32 v254, v242, v243
v_lshlrev_b32 v242, 16, v255
v_and_b32 v243, 0xffff0000, v255
v_mul_f32 v242, v242, v237
v_mul_f32 v243, v243, v237
v_cvt_pk_bf16_f32 v255, v242, v243
ds_write_b64 v253, v[254:255] offset:1024
s_waitcnt lgkmcnt(0)
ds_read_b64 v[254:255], v253 offset:1032
s_waitcnt lgkmcnt(0)
v_lshlrev_b32 v242, 16, v254
v_and_b32 v243, 0xffff0000, v254
v_mul_f32 v242, v242, v237
v_mul_f32 v243, v243, v237
v_cvt_pk_bf16_f32 v254, v242, v243
v_lshlrev_b32 v242, 16, v255
v_and_b32 v243, 0xffff0000, v255
v_mul_f32 v242, v242, v237
v_mul_f32 v243, v243, v237
v_cvt_pk_bf16_f32 v255, v242, v243
ds_write_b64 v253, v[254:255] offset:1032
s_waitcnt lgkmcnt(0)
v_log_f32 v243, v230
v_max3_f32 v234, v152, v153, v154
v_max3_f32 v234, v234, v155, v243
v_mov_b32 v243, v234
s_nop 1
v_permlane32_swap_b32 v234, v243
s_nop 1
v_max_f32 v234, v234, v243
v_mov_b32 v243, v234
s_nop 1
v_permlane16_swap_b32 v234, v243
s_nop 1
v_max_f32 v234, v234, v243
v_ceil_f32 v234, v234
v_max_f32 v234, 0, v234
v_sub_f32 v243, 0, v234
v_exp_f32 v238, v243
s_nop 1
v_mul_f32 v230, v230, v238
v_add_f32 v246, v246, v234
v_sub_f32 v200, v200, v234
v_sub_f32 v136, v136, v234
v_sub_f32 v152, v152, v234
v_sub_f32 v201, v201, v234
v_sub_f32 v137, v137, v234
v_sub_f32 v153, v153, v234
v_sub_f32 v202, v202, v234
v_sub_f32 v138, v138, v234
v_sub_f32 v154, v154, v234
v_sub_f32 v203, v203, v234
v_sub_f32 v139, v139, v234
v_sub_f32 v155, v155, v234
v_lshlrev_b32 v242, 16, v184
v_and_b32 v243, 0xffff0000, v184
v_mul_f32 v242, v242, v238
v_mul_f32 v243, v243, v238
v_cvt_pk_bf16_f32 v184, v242, v243
v_lshlrev_b32 v242, 16, v185
v_and_b32 v243, 0xffff0000, v185
v_mul_f32 v242, v242, v238
v_mul_f32 v243, v243, v238
v_cvt_pk_bf16_f32 v185, v242, v243
ds_read_b64 v[254:255], v253 offset:2048
s_waitcnt lgkmcnt(0)
v_lshlrev_b32 v242, 16, v254
v_and_b32 v243, 0xffff0000, v254
v_mul_f32 v242, v242, v238
v_mul_f32 v243, v243, v238
v_cvt_pk_bf16_f32 v254, v242, v243
v_lshlrev_b32 v242, 16, v255
v_and_b32 v243, 0xffff0000, v255
v_mul_f32 v242, v242, v238
v_mul_f32 v243, v243, v238
v_cvt_pk_bf16_f32 v255, v242, v243
ds_write_b64 v253, v[254:255] offset:2048
s_waitcnt lgkmcnt(0)
ds_read_b64 v[254:255], v253 offset:2056
s_waitcnt lgkmcnt(0)
v_lshlrev_b32 v242, 16, v254
v_and_b32 v243, 0xffff0000, v254
v_mul_f32 v242, v242, v238
v_mul_f32 v243, v243, v238
v_cvt_pk_bf16_f32 v254, v242, v243
v_lshlrev_b32 v242, 16, v255
v_and_b32 v243, 0xffff0000, v255
v_mul_f32 v242, v242, v238
v_mul_f32 v243, v243, v238
v_cvt_pk_bf16_f32 v255, v242, v243
ds_write_b64 v253, v[254:255] offset:2056
s_waitcnt lgkmcnt(0)
v_log_f32 v243, v231
v_max3_f32 v235, v156, v157, v158
v_max3_f32 v235, v235, v159, v243
v_mov_b32 v243, v235
s_nop 1
v_permlane32_swap_b32 v235, v243
s_nop 1
v_max_f32 v235, v235, v243
v_mov_b32 v243, v235
s_nop 1
v_permlane16_swap_b32 v235, v243
s_nop 1
v_max_f32 v235, v235, v243
v_ceil_f32 v235, v235
v_max_f32 v235, 0, v235
v_sub_f32 v243, 0, v235
v_exp_f32 v239, v243
s_nop 1
v_mul_f32 v231, v231, v239
v_add_f32 v247, v247, v235
v_sub_f32 v204, v204, v235
v_sub_f32 v140, v140, v235
v_sub_f32 v156, v156, v235
v_sub_f32 v205, v205, v235
v_sub_f32 v141, v141, v235
v_sub_f32 v157, v157, v235
v_sub_f32 v206, v206, v235
v_sub_f32 v142, v142, v235
v_sub_f32 v158, v158, v235
v_sub_f32 v207, v207, v235
v_sub_f32 v143, v143, v235
v_sub_f32 v159, v159, v235
v_lshlrev_b32 v242, 16, v188
v_and_b32 v243, 0xffff0000, v188
v_mul_f32 v242, v242, v239
v_mul_f32 v243, v243, v239
v_cvt_pk_bf16_f32 v188, v242, v243
v_lshlrev_b32 v242, 16, v189
v_and_b32 v243, 0xffff0000, v189
v_mul_f32 v242, v242, v239
v_mul_f32 v243, v243, v239
v_cvt_pk_bf16_f32 v189, v242, v243
ds_read_b64 v[254:255], v253 offset:3072
s_waitcnt lgkmcnt(0)
v_lshlrev_b32 v242, 16, v254
v_and_b32 v243, 0xffff0000, v254
v_mul_f32 v242, v242, v239
v_mul_f32 v243, v243, v239
v_cvt_pk_bf16_f32 v254, v242, v243
v_lshlrev_b32 v242, 16, v255
v_and_b32 v243, 0xffff0000, v255
v_mul_f32 v242, v242, v239
v_mul_f32 v243, v243, v239
v_cvt_pk_bf16_f32 v255, v242, v243
ds_write_b64 v253, v[254:255] offset:3072
s_waitcnt lgkmcnt(0)
ds_read_b64 v[254:255], v253 offset:3080
s_waitcnt lgkmcnt(0)
v_lshlrev_b32 v242, 16, v254
v_and_b32 v243, 0xffff0000, v254
v_mul_f32 v242, v242, v239
v_mul_f32 v243, v243, v239
v_cvt_pk_bf16_f32 v254, v242, v243
v_lshlrev_b32 v242, 16, v255
v_and_b32 v243, 0xffff0000, v255
v_mul_f32 v242, v242, v239
v_mul_f32 v243, v243, v239
v_cvt_pk_bf16_f32 v255, v242, v243
ds_write_b64 v253, v[254:255] offset:3080
s_waitcnt lgkmcnt(0)
v_exp_f32 v232, v144
v_exp_f32 v233, v145
v_exp_f32 v234, v146
v_exp_f32 v235, v147
s_nop 1
v_add_f32 v224, v228, v232
v_add_f32 v224, v224, v233
v_add_f32 v224, v224, v234
v_add_f32 v224, v224, v235
v_cvt_pk_bf16_f32 v178, v232, v233
v_cvt_pk_bf16_f32 v179, v234, v235
v_exp_f32 v232, v148
v_exp_f32 v233, v149
v_exp_f32 v234, v150
v_exp_f32 v235, v151
s_nop 1
v_add_f32 v225, v229, v232
v_add_f32 v225, v225, v233
v_add_f32 v225, v225, v234
v_add_f32 v225, v225, v235
v_cvt_pk_bf16_f32 v182, v232, v233
v_cvt_pk_bf16_f32 v183, v234, v235
v_exp_f32 v232, v152
v_exp_f32 v233, v153
v_exp_f32 v234, v154
v_exp_f32 v235, v155
s_nop 1
v_add_f32 v226, v230, v232
v_add_f32 v226, v226, v233
v_add_f32 v226, v226, v234
v_add_f32 v226, v226, v235
v_cvt_pk_bf16_f32 v186, v232, v233
v_cvt_pk_bf16_f32 v187, v234, v235
v_exp_f32 v232, v156
v_exp_f32 v233, v157
v_exp_f32 v234, v158
v_exp_f32 v235, v159
s_nop 1
v_add_f32 v227, v231, v232
v_add_f32 v227, v227, v233
v_add_f32 v227, v227, v234
v_add_f32 v227, v227, v235
v_cvt_pk_bf16_f32 v190, v232, v233
v_cvt_pk_bf16_f32 v191, v234, v235
s_branch L2_rare_common
L2_rare_site6:
s_mov_b32 s36, 6
s_branch L2_rare_t0_2_0
L2_rare_t0_2_0:
s_nop 15
s_nop 15
s_waitcnt lgkmcnt(0)
v_log_f32 v243, v224
v_max3_f32 v232, v128, v129, v130
v_max3_f32 v232, v232, v131, v243
v_mov_b32 v243, v232
s_nop 1
v_permlane32_swap_b32 v232, v243
s_nop 1
v_max_f32 v232, v232, v243
v_mov_b32 v243, v232
s_nop 1
v_permlane16_swap_b32 v232, v243
s_nop 1
v_max_f32 v232, v232, v243
v_ceil_f32 v232, v232
v_max_f32 v232, 0, v232
v_sub_f32 v243, 0, v232
v_exp_f32 v236, v243
s_nop 1
v_mul_f32 v224, v224, v236
v_add_f32 v244, v244, v232
v_sub_f32 v192, v192, v232
v_sub_f32 v128, v128, v232
v_sub_f32 v144, v144, v232
v_sub_f32 v193, v193, v232
v_sub_f32 v129, v129, v232
v_sub_f32 v145, v145, v232
v_sub_f32 v194, v194, v232
v_sub_f32 v130, v130, v232
v_sub_f32 v146, v146, v232
v_sub_f32 v195, v195, v232
v_sub_f32 v131, v131, v232
v_sub_f32 v147, v147, v232
ds_read_b64 v[254:255], v253 offset:0
s_waitcnt lgkmcnt(0)
v_lshlrev_b32 v242, 16, v254
v_and_b32 v243, 0xffff0000, v254
v_mul_f32 v242, v242, v236
v_mul_f32 v243, v243, v236
v_cvt_pk_bf16_f32 v254, v242, v243
v_lshlrev_b32 v242, 16, v255
v_and_b32 v243, 0xffff0000, v255
v_mul_f32 v242, v242, v236
v_mul_f32 v243, v243, v236
v_cvt_pk_bf16_f32 v255, v242, v243
ds_write_b64 v253, v[254:255] offset:0
s_waitcnt lgkmcnt(0)
ds_read_b64 v[254:255], v253 offset:8
s_waitcnt lgkmcnt(0)
v_lshlrev_b32 v242, 16, v254
v_and_b32 v243, 0xffff0000, v254
v_mul_f32 v242, v242, v236
v_mul_f32 v243, v243, v236
v_cvt_pk_bf16_f32 v254, v242, v243
v_lshlrev_b32 v242, 16, v255
v_and_b32 v243, 0xffff0000, v255
v_mul_f32 v242, v242, v236
v_mul_f32 v243, v243, v236
v_cvt_pk_bf16_f32 v255, v242, v243
ds_write_b64 v253, v[254:255] offset:8
s_waitcnt lgkmcnt(0)
ds_read_b64 v[254:255], v253 offset:4096
s_waitcnt lgkmcnt(0)
v_lshlrev_b32 v242, 16, v254
v_and_b32 v243, 0xffff0000, v254
v_mul_f32 v242, v242, v236
v_mul_f32 v243, v243, v236
v_cvt_pk_bf16_f32 v254, v242, v243
v_lshlrev_b32 v242, 16, v255
v_and_b32 v243, 0xffff0000, v255
v_mul_f32 v242, v242, v236
v_mul_f32 v243, v243, v236
v_cvt_pk_bf16_f32 v255, v242, v243
ds_write_b64 v253, v[254:255] offset:4096
s_waitcnt lgkmcnt(0)
ds_read_b64 v[254:255], v253 offset:4104
s_waitcnt lgkmcnt(0)
v_lshlrev_b32 v242, 16, v254
v_and_b32 v243, 0xffff0000, v254
v_mul_f32 v242, v242, v236
v_mul_f32 v243, v243, v236
v_cvt_pk_bf16_f32 v254, v242, v243
v_lshlrev_b32 v242, 16, v255
v_and_b32 v243, 0xffff0000, v255
v_mul_f32 v242, v242, v236
v_mul_f32 v243, v243, v236
v_cvt_pk_bf16_f32 v255, v242, v243
ds_write_b64 v253, v[254:255] offset:4104
s_waitcnt lgkmcnt(0)
v_log_f32 v243, v225
v_max3_f32 v233, v132, v133, v134
v_max3_f32 v233, v233, v135, v243
v_mov_b32 v243, v233
s_nop 1
v_permlane32_swap_b32 v233, v243
s_nop 1
v_max_f32 v233, v233, v243
v_mov_b32 v243, v233
s_nop 1
v_permlane16_swap_b32 v233, v243
s_nop 1
v_max_f32 v233, v233, v243
v_ceil_f32 v233, v233
v_max_f32 v233, 0, v233
v_sub_f32 v243, 0, v233
v_exp_f32 v237, v243
s_nop 1
v_mul_f32 v225, v225, v237
v_add_f32 v245, v245, v233
v_sub_f32 v196, v196, v233
v_sub_f32 v132, v132, v233
v_sub_f32 v148, v148, v233
v_sub_f32 v197, v197, v233
v_sub_f32 v133, v133, v233
v_sub_f32 v149, v149, v233
v_sub_f32 v198, v198, v233
v_sub_f32 v134, v134, v233
v_sub_f32 v150, v150, v233
v_sub_f32 v199, v199, v233
v_sub_f32 v135, v135, v233
v_sub_f32 v151, v151, v233
ds_read_b64 v[254:255], v253 offset:1024
s_waitcnt lgkmcnt(0)
v_lshlrev_b32 v242, 16, v254
v_and_b32 v243, 0xffff0000, v254
v_mul_f32 v242, v242, v237
v_mul_f32 v243, v243, v237
v_cvt_pk_bf16_f32 v254, v242, v243
v_lshlrev_b32 v242, 16, v255
v_and_b32 v243, 0xffff0000, v255
v_mul_f32 v242, v242, v237
v_mul_f32 v243, v243, v237
v_cvt_pk_bf16_f32 v255, v242, v243
ds_write_b64 v253, v[254:255] offset:1024
s_waitcnt lgkmcnt(0)
ds_read_b64 v[254:255], v253 offset:1032
s_waitcnt lgkmcnt(0)
v_lshlrev_b32 v242, 16, v254
v_and_b32 v243, 0xffff0000, v254
v_mul_f32 v242, v242, v237
v_mul_f32 v243, v243, v237
v_cvt_pk_bf16_f32 v254, v242, v243
v_lshlrev_b32 v242, 16, v255
v_and_b32 v243, 0xffff0000, v255
v_mul_f32 v242, v242, v237
v_mul_f32 v243, v243, v237
v_cvt_pk_bf16_f32 v255, v242, v243
ds_write_b64 v253, v[254:255] offset:1032
s_waitcnt lgkmcnt(0)
ds_read_b64 v[254:255], v253 offset:5120
s_waitcnt lgkmcnt(0)
v_lshlrev_b32 v242, 16, v254
v_and_b32 v243, 0xffff0000, v254
v_mul_f32 v242, v242, v237
v_mul_f32 v243, v243, v237
v_cvt_pk_bf16_f32 v254, v242, v243
v_lshlrev_b32 v242, 16, v255
v_and_b32 v243, 0xffff0000, v255
v_mul_f32 v242, v242, v237
v_mul_f32 v243, v243, v237
v_cvt_pk_bf16_f32 v255, v242, v243
ds_write_b64 v253, v[254:255] offset:5120
s_waitcnt lgkmcnt(0)
ds_read_b64 v[254:255], v253 offset:5128
s_waitcnt lgkmcnt(0)
v_lshlrev_b32 v242, 16, v254
v_and_b32 v243, 0xffff0000, v254
v_mul_f32 v242, v242, v237
v_mul_f32 v243, v243, v237
v_cvt_pk_bf16_f32 v254, v242, v243
v_lshlrev_b32 v242, 16, v255
v_and_b32 v243, 0xffff0000, v255
v_mul_f32 v242, v242, v237
v_mul_f32 v243, v243, v237
v_cvt_pk_bf16_f32 v255, v242, v243
ds_write_b64 v253, v[254:255] offset:5128
s_waitcnt lgkmcnt(0)
v_log_f32 v243, v226
v_max3_f32 v234, v136, v137, v138
v_max3_f32 v234, v234, v139, v243
v_mov_b32 v243, v234
s_nop 1
v_permlane32_swap_b32 v234, v243
s_nop 1
v_max_f32 v234, v234, v243
v_mov_b32 v243, v234
s_nop 1
v_permlane16_swap_b32 v234, v243
s_nop 1
v_max_f32 v234, v234, v243
v_ceil_f32 v234, v234
v_max_f32 v234, 0, v234
v_sub_f32 v243, 0, v234
v_exp_f32 v238, v243
s_nop 1
v_mul_f32 v226, v226, v238
v_add_f32 v246, v246, v234
v_sub_f32 v200, v200, v234
v_sub_f32 v136, v136, v234
v_sub_f32 v152, v152, v234
v_sub_f32 v201, v201, v234
v_sub_f32 v137, v137, v234
v_sub_f32 v153, v153, v234
v_sub_f32 v202, v202, v234
v_sub_f32 v138, v138, v234
v_sub_f32 v154, v154, v234
v_sub_f32 v203, v203, v234
v_sub_f32 v139, v139, v234
v_sub_f32 v155, v155, v234
ds_read_b64 v[254:255], v253 offset:2048
s_waitcnt lgkmcnt(0)
v_lshlrev_b32 v242, 16, v254
v_and_b32 v243, 0xffff0000, v254
v_mul_f32 v242, v242, v238
v_mul_f32 v243, v243, v238
v_cvt_pk_bf16_f32 v254, v242, v243
v_lshlrev_b32 v242, 16, v255
v_and_b32 v243, 0xffff0000, v255
v_mul_f32 v242, v242, v238
v_mul_f32 v243, v243, v238
v_cvt_pk_bf16_f32 v255, v242, v243
ds_write_b64 v253, v[254:255] offset:2048
s_waitcnt lgkmcnt(0)
ds_read_b64 v[254:255], v253 offset:2056
s_waitcnt lgkmcnt(0)
v_lshlrev_b32 v242, 16, v254
v_and_b32 v243, 0xffff0000, v254
v_mul_f32 v242, v242, v238
v_mul_f32 v243, v243, v238
v_cvt_pk_bf16_f32 v254, v242, v243
v_lshlrev_b32 v242, 16, v255
v_and_b32 v243, 0xffff0000, v255
v_mul_f32 v242, v242, v238
v_mul_f32 v243, v243, v238
v_cvt_pk_bf16_f32 v255, v242, v243
ds_write_b64 v253, v[254:255] offset:2056
s_waitcnt lgkmcnt(0)
ds_read_b64 v[254:255], v253 offset:6144
s_waitcnt lgkmcnt(0)
v_lshlrev_b32 v242, 16, v254
v_and_b32 v243, 0xffff0000, v254
v_mul_f32 v242, v242, v238
v_mul_f32 v243, v243, v238
v_cvt_pk_bf16_f32 v254, v242, v243
v_lshlrev_b32 v242, 16, v255
v_and_b32 v243, 0xffff0000, v255
v_mul_f32 v242, v242, v238
v_mul_f32 v243, v243, v238
v_cvt_pk_bf16_f32 v255, v242, v243
ds_write_b64 v253, v[254:255] offset:6144
s_waitcnt lgkmcnt(0)
ds_read_b64 v[254:255], v253 offset:6152
s_waitcnt lgkmcnt(0)
v_lshlrev_b32 v242, 16, v254
v_and_b32 v243, 0xffff0000, v254
v_mul_f32 v242, v242, v238
v_mul_f32 v243, v243, v238
v_cvt_pk_bf16_f32 v254, v242, v243
v_lshlrev_b32 v242, 16, v255
v_and_b32 v243, 0xffff0000, v255
v_mul_f32 v242, v242, v238
v_mul_f32 v243, v243, v238
v_cvt_pk_bf16_f32 v255, v242, v243
ds_write_b64 v253, v[254:255] offset:6152
s_waitcnt lgkmcnt(0)
v_log_f32 v243, v227
v_max3_f32 v235, v140, v141, v142
v_max3_f32 v235, v235, v143, v243
v_mov_b32 v243, v235
s_nop 1
v_permlane32_swap_b32 v235, v243
s_nop 1
v_max_f32 v235, v235, v243
v_mov_b32 v243, v235
s_nop 1
v_permlane16_swap_b32 v235, v243
s_nop 1
v_max_f32 v235, v235, v243
v_ceil_f32 v235, v235
v_max_f32 v235, 0, v235
v_sub_f32 v243, 0, v235
v_exp_f32 v239, v243
s_nop 1
v_mul_f32 v227, v227, v239
v_add_f32 v247, v247, v235
v_sub_f32 v204, v204, v235
v_sub_f32 v140, v140, v235
v_sub_f32 v156, v156, v235
v_sub_f32 v205, v205, v235
v_sub_f32 v141, v141, v235
v_sub_f32 v157, v157, v235
v_sub_f32 v206, v206, v235
v_sub_f32 v142, v142, v235
v_sub_f32 v158, v158, v235
v_sub_f32 v207, v207, v235
v_sub_f32 v143, v143, v235
v_sub_f32 v159, v159, v235
ds_read_b64 v[254:255], v253 offset:3072
s_waitcnt lgkmcnt(0)
v_lshlrev_b32 v242, 16, v254
v_and_b32 v243, 0xffff0000, v254
v_mul_f32 v242, v242, v239
v_mul_f32 v243, v243, v239
v_cvt_pk_bf16_f32 v254, v242, v243
v_lshlrev_b32 v242, 16, v255
v_and_b32 v243, 0xffff0000, v255
v_mul_f32 v242, v242, v239
v_mul_f32 v243, v243, v239
v_cvt_pk_bf16_f32 v255, v242, v243
ds_write_b64 v253, v[254:255] offset:3072
s_waitcnt lgkmcnt(0)
ds_read_b64 v[254:255], v253 offset:3080
s_waitcnt lgkmcnt(0)
v_lshlrev_b32 v242, 16, v254
v_and_b32 v243, 0xffff0000, v254
v_mul_f32 v242, v242, v239
v_mul_f32 v243, v243, v239
v_cvt_pk_bf16_f32 v254, v242, v243
v_lshlrev_b32 v242, 16, v255
v_and_b32 v243, 0xffff0000, v255
v_mul_f32 v242, v242, v239
v_mul_f32 v243, v243, v239
v_cvt_pk_bf16_f32 v255, v242, v243
ds_write_b64 v253, v[254:255] offset:3080
s_waitcnt lgkmcnt(0)
ds_read_b64 v[254:255], v253 offset:7168
s_waitcnt lgkmcnt(0)
v_lshlrev_b32 v242, 16, v254
v_and_b32 v243, 0xffff0000, v254
v_mul_f32 v242, v242, v239
v_mul_f32 v243, v243, v239
v_cvt_pk_bf16_f32 v254, v242, v243
v_lshlrev_b32 v242, 16, v255
v_and_b32 v243, 0xffff0000, v255
v_mul_f32 v242, v242, v239
v_mul_f32 v243, v243, v239
v_cvt_pk_bf16_f32 v255, v242, v243
ds_write_b64 v253, v[254:255] offset:7168
s_waitcnt lgkmcnt(0)
ds_read_b64 v[254:255], v253 offset:7176
s_waitcnt lgkmcnt(0)
v_lshlrev_b32 v242, 16, v254
v_and_b32 v243, 0xffff0000, v254
v_mul_f32 v242, v242, v239
v_mul_f32 v243, v243, v239
v_cvt_pk_bf16_f32 v254, v242, v243
v_lshlrev_b32 v242, 16, v255
v_and_b32 v243, 0xffff0000, v255
v_mul_f32 v242, v242, v239
v_mul_f32 v243, v243, v239
v_cvt_pk_bf16_f32 v255, v242, v243
ds_write_b64 v253, v[254:255] offset:7176
s_waitcnt lgkmcnt(0)
v_exp_f32 v232, v128
v_exp_f32 v233, v129
v_exp_f32 v234, v130
v_exp_f32 v235, v131
s_nop 1
v_add_f32 v228, v224, v232
v_add_f32 v228, v228, v233
v_add_f32 v228, v228, v234
v_add_f32 v228, v228, v235
v_cvt_pk_bf16_f32 v160, v232, v233
v_cvt_pk_bf16_f32 v161, v234, v235
v_exp_f32 v232, v132
v_exp_f32 v233, v133
v_exp_f32 v234, v134
v_exp_f32 v235, v135
s_nop 1
v_add_f32 v229, v225, v232
v_add_f32 v229, v229, v233
v_add_f32 v229, v229, v234
v_add_f32 v229, v229, v235
v_cvt_pk_bf16_f32 v164, v232, v233
v_cvt_pk_bf16_f32 v165, v234, v235
v_exp_f32 v232, v136
v_exp_f32 v233, v137
v_exp_f32 v234, v138
v_exp_f32 v235, v139
s_nop 1
v_add_f32 v230, v226, v232
v_add_f32 v230, v230, v233
v_add_f32 v230, v230, v234
v_add_f32 v230, v230, v235
v_cvt_pk_bf16_f32 v168, v232, v233
v_cvt_pk_bf16_f32 v169, v234, v235
v_exp_f32 v232, v140
v_exp_f32 v233, v141
v_exp_f32 v234, v142
v_exp_f32 v235, v143
s_nop 1
v_add_f32 v231, v227, v232
v_add_f32 v231, v231, v233
v_add_f32 v231, v231, v234
v_add_f32 v231, v231, v235
v_cvt_pk_bf16_f32 v172, v232, v233
v_cvt_pk_bf16_f32 v173, v234, v235
s_branch L2_rare_common
L2_rare_site7:
s_mov_b32 s36, 7
s_branch L2_rare_t0_3_1
L2_rare_t0_3_1:
s_nop 15
s_nop 15
s_waitcnt lgkmcnt(0)
v_log_f32 v243, v228
v_max3_f32 v232, v144, v145, v146
v_max3_f32 v232, v232, v147, v243
v_mov_b32 v243, v232
s_nop 1
v_permlane32_swap_b32 v232, v243
s_nop 1
v_max_f32 v232, v232, v243
v_mov_b32 v243, v232
s_nop 1
v_permlane16_swap_b32 v232, v243
s_nop 1
v_max_f32 v232, v232, v243
v_ceil_f32 v232, v232
v_max_f32 v232, 0, v232
v_sub_f32 v243, 0, v232
v_exp_f32 v236, v243
s_nop 1
v_mul_f32 v228, v228, v236
v_add_f32 v244, v244, v232
v_sub_f32 v192, v192, v232
v_sub_f32 v128, v128, v232
v_sub_f32 v144, v144, v232
v_sub_f32 v193, v193, v232
v_sub_f32 v129, v129, v232
v_sub_f32 v145, v145, v232
v_sub_f32 v194, v194, v232
v_sub_f32 v130, v130, v232
v_sub_f32 v146, v146, v232
v_sub_f32 v195, v195, v232
v_sub_f32 v131, v131, v232
v_sub_f32 v147, v147, v232
v_lshlrev_b32 v242, 16, v160
v_and_b32 v243, 0xffff0000, v160
v_mul_f32 v242, v242, v236
v_mul_f32 v243, v243, v236
v_cvt_pk_bf16_f32 v160, v242, v243
v_lshlrev_b32 v242, 16, v161
v_and_b32 v243, 0xffff0000, v161
v_mul_f32 v242, v242, v236
v_mul_f32 v243, v243, v236
v_cvt_pk_bf16_f32 v161, v242, v243
ds_read_b64 v[254:255], v253 offset:0
s_waitcnt lgkmcnt(0)
v_lshlrev_b32 v242, 16, v254
v_and_b32 v243, 0xffff0000, v254
v_mul_f32 v242, v242, v236
v_mul_f32 v243, v243, v236
v_cvt_pk_bf16_f32 v254, v242, v243
v_lshlrev_b32 v242, 16, v255
v_and_b32 v243, 0xffff0000, v255
v_mul_f32 v242, v242, v236
v_mul_f32 v243, v243, v236
v_cvt_pk_bf16_f32 v255, v242, v243
ds_write_b64 v253, v[254:255] offset:0
s_waitcnt lgkmcnt(0)
ds_read_b64 v[254:255], v253 offset:8
s_waitcnt lgkmcnt(0)
v_lshlrev_b32 v242, 16, v254
v_and_b32 v243, 0xffff0000, v254
v_mul_f32 v242, v242, v236
v_mul_f32 v243, v243, v236
v_cvt_pk_bf16_f32 v254, v242, v243
v_lshlrev_b32 v242, 16, v255
v_and_b32 v243, 0xffff0000, v255
v_mul_f32 v242, v242, v236
v_mul_f32 v243, v243, v236
v_cvt_pk_bf16_f32 v255, v242, v243
ds_write_b64 v253, v[254:255] offset:8
s_waitcnt lgkmcnt(0)
ds_read_b64 v[254:255], v253 offset:4096
s_waitcnt lgkmcnt(0)
v_lshlrev_b32 v242, 16, v254
v_and_b32 v243, 0xffff0000, v254
v_mul_f32 v242, v242, v236
v_mul_f32 v243, v243, v236
v_cvt_pk_bf16_f32 v254, v242, v243
v_lshlrev_b32 v242, 16, v255
v_and_b32 v243, 0xffff0000, v255
v_mul_f32 v242, v242, v236
v_mul_f32 v243, v243, v236
v_cvt_pk_bf16_f32 v255, v242, v243
ds_write_b64 v253, v[254:255] offset:4096
s_waitcnt lgkmcnt(0)
ds_read_b64 v[254:255], v253 offset:4104
s_waitcnt lgkmcnt(0)
v_lshlrev_b32 v242, 16, v254
v_and_b32 v243, 0xffff0000, v254
v_mul_f32 v242, v242, v236
v_mul_f32 v243, v243, v236
v_cvt_pk_bf16_f32 v254, v242, v243
v_lshlrev_b32 v242, 16, v255
v_and_b32 v243, 0xffff0000, v255
v_mul_f32 v242, v242, v236
v_mul_f32 v243, v243, v236
v_cvt_pk_bf16_f32 v255, v242, v243
ds_write_b64 v253, v[254:255] offset:4104
s_waitcnt lgkmcnt(0)
v_log_f32 v243, v229
v_max3_f32 v233, v148, v149, v150
v_max3_f32 v233, v233, v151, v243
v_mov_b32 v243, v233
s_nop 1
v_permlane32_swap_b32 v233, v243
s_nop 1
v_max_f32 v233, v233, v243
v_mov_b32 v243, v233
s_nop 1
v_permlane16_swap_b32 v233, v243
s_nop 1
v_max_f32 v233, v233, v243
v_ceil_f32 v233, v233
v_max_f32 v233, 0, v233
v_sub_f32 v243, 0, v233
v_exp_f32 v237, v243
s_nop 1
v_mul_f32 v229, v229, v237
v_add_f32 v245, v245, v233
v_sub_f32 v196, v196, v233
v_sub_f32 v132, v132, v233
v_sub_f32 v148, v148, v233
v_sub_f32 v197, v197, v233
v_sub_f32 v133, v133, v233
v_sub_f32 v149, v149, v233
v_sub_f32 v198, v198, v233
v_sub_f32 v134, v134, v233
v_sub_f32 v150, v150, v233
v_sub_f32 v199, v199, v233
v_sub_f32 v135, v135, v233
v_sub_f32 v151, v151, v233
v_lshlrev_b32 v242, 16, v164
v_and_b32 v243, 0xffff0000, v164
v_mul_f32 v242, v242, v237
v_mul_f32 v243, v243, v237
v_cvt_pk_bf16_f32 v164, v242, v243
v_lshlrev_b32 v242, 16, v165
v_and_b32 v243, 0xffff0000, v165
v_mul_f32 v242, v242, v237
v_mul_f32 v243, v243, v237
v_cvt_pk_bf16_f32 v165, v242, v243
ds_read_b64 v[254:255], v253 offset:1024
s_waitcnt lgkmcnt(0)
v_lshlrev_b32 v242, 16, v254
v_and_b32 v243, 0xffff0000, v254
v_mul_f32 v242, v242, v237
v_mul_f32 v243, v243, v237
v_cvt_pk_bf16_f32 v254, v242, v243
v_lshlrev_b32 v242, 16, v255
v_and_b32 v243, 0xffff0000, v255
v_mul_f32 v242, v242, v237
v_mul_f32 v243, v243, v237
v_cvt_pk_bf16_f32 v255, v242, v243
ds_write_b64 v253, v[254:255] offset:1024
s_waitcnt lgkmcnt(0)
ds_read_b64 v[254:255], v253 offset:1032
s_waitcnt lgkmcnt(0)
v_lshlrev_b32 v242, 16, v254
v_and_b32 v243, 0xffff0000, v254
v_mul_f32 v242, v242, v237
v_mul_f32 v243, v243, v237
v_cvt_pk_bf16_f32 v254, v242, v243
v_lshlrev_b32 v242, 16, v255
v_and_b32 v243, 0xffff0000, v255
v_mul_f32 v242, v242, v237
v_mul_f32 v243, v243, v237
v_cvt_pk_bf16_f32 v255, v242, v243
ds_write_b64 v253, v[254:255] offset:1032
s_waitcnt lgkmcnt(0)
ds_read_b64 v[254:255], v253 offset:5120
s_waitcnt lgkmcnt(0)
v_lshlrev_b32 v242, 16, v254
v_and_b32 v243, 0xffff0000, v254
v_mul_f32 v242, v242, v237
v_mul_f32 v243, v243, v237
v_cvt_pk_bf16_f32 v254, v242, v243
v_lshlrev_b32 v242, 16, v255
v_and_b32 v243, 0xffff0000, v255
v_mul_f32 v242, v242, v237
v_mul_f32 v243, v243, v237
v_cvt_pk_bf16_f32 v255, v242, v243
ds_write_b64 v253, v[254:255] offset:5120
s_waitcnt lgkmcnt(0)
ds_read_b64 v[254:255], v253 offset:5128
s_waitcnt lgkmcnt(0)
v_lshlrev_b32 v242, 16, v254
v_and_b32 v243, 0xffff0000, v254
v_mul_f32 v242, v242, v237
v_mul_f32 v243, v243, v237
v_cvt_pk_bf16_f32 v254, v242, v243
v_lshlrev_b32 v242, 16, v255
v_and_b32 v243, 0xffff0000, v255
v_mul_f32 v242, v242, v237
v_mul_f32 v243, v243, v237
v_cvt_pk_bf16_f32 v255, v242, v243
ds_write_b64 v253, v[254:255] offset:5128
s_waitcnt lgkmcnt(0)
v_log_f32 v243, v230
v_max3_f32 v234, v152, v153, v154
v_max3_f32 v234, v234, v155, v243
v_mov_b32 v243, v234
s_nop 1
v_permlane32_swap_b32 v234, v243
s_nop 1
v_max_f32 v234, v234, v243
v_mov_b32 v243, v234
s_nop 1
v_permlane16_swap_b32 v234, v243
s_nop 1
v_max_f32 v234, v234, v243
v_ceil_f32 v234, v234
v_max_f32 v234, 0, v234
v_sub_f32 v243, 0, v234
v_exp_f32 v238, v243
s_nop 1
v_mul_f32 v230, v230, v238
v_add_f32 v246, v246, v234
v_sub_f32 v200, v200, v234
v_sub_f32 v136, v136, v234
v_sub_f32 v152, v152, v234
v_sub_f32 v201, v201, v234
v_sub_f32 v137, v137, v234
v_sub_f32 v153, v153, v234
v_sub_f32 v202, v202, v234
v_sub_f32 v138, v138, v234
v_sub_f32 v154, v154, v234
v_sub_f32 v203, v203, v234
v_sub_f32 v139, v139, v234
v_sub_f32 v155, v155, v234
v_lshlrev_b32 v242, 16, v168
v_and_b32 v243, 0xffff0000, v168
v_mul_f32 v242, v242, v238
v_mul_f32 v243, v243, v238
v_cvt_pk_bf16_f32 v168, v242, v243
v_lshlrev_b32 v242, 16, v169
v_and_b32 v243, 0xffff0000, v169
v_mul_f32 v242, v242, v238
v_mul_f32 v243, v243, v238
v_cvt_pk_bf16_f32 v169, v242, v243
ds_read_b64 v[254:255], v253 offset:2048
s_waitcnt lgkmcnt(0)
v_lshlrev_b32 v242, 16, v254
v_and_b32 v243, 0xffff0000, v254
v_mul_f32 v242, v242, v238
v_mul_f32 v243, v243, v238
v_cvt_pk_bf16_f32 v254, v242, v243
v_lshlrev_b32 v242, 16, v255
v_and_b32 v243, 0xffff0000, v255
v_mul_f32 v242, v242, v238
v_mul_f32 v243, v243, v238
v_cvt_pk_bf16_f32 v255, v242, v243
ds_write_b64 v253, v[254:255] offset:2048
s_waitcnt lgkmcnt(0)
ds_read_b64 v[254:255], v253 offset:2056
s_waitcnt lgkmcnt(0)
v_lshlrev_b32 v242, 16, v254
v_and_b32 v243, 0xffff0000, v254
v_mul_f32 v242, v242, v238
v_mul_f32 v243, v243, v238
v_cvt_pk_bf16_f32 v254, v242, v243
v_lshlrev_b32 v242, 16, v255
v_and_b32 v243, 0xffff0000, v255
v_mul_f32 v242, v242, v238
v_mul_f32 v243, v243, v238
v_cvt_pk_bf16_f32 v255, v242, v243
ds_write_b64 v253, v[254:255] offset:2056
s_waitcnt lgkmcnt(0)
ds_read_b64 v[254:255], v253 offset:6144
s_waitcnt lgkmcnt(0)
v_lshlrev_b32 v242, 16, v254
v_and_b32 v243, 0xffff0000, v254
v_mul_f32 v242, v242, v238
v_mul_f32 v243, v243, v238
v_cvt_pk_bf16_f32 v254, v242, v243
v_lshlrev_b32 v242, 16, v255
v_and_b32 v243, 0xffff0000, v255
v_mul_f32 v242, v242, v238
v_mul_f32 v243, v243, v238
v_cvt_pk_bf16_f32 v255, v242, v243
ds_write_b64 v253, v[254:255] offset:6144
s_waitcnt lgkmcnt(0)
ds_read_b64 v[254:255], v253 offset:6152
s_waitcnt lgkmcnt(0)
v_lshlrev_b32 v242, 16, v254
v_and_b32 v243, 0xffff0000, v254
v_mul_f32 v242, v242, v238
v_mul_f32 v243, v243, v238
v_cvt_pk_bf16_f32 v254, v242, v243
v_lshlrev_b32 v242, 16, v255
v_and_b32 v243, 0xffff0000, v255
v_mul_f32 v242, v242, v238
v_mul_f32 v243, v243, v238
v_cvt_pk_bf16_f32 v255, v242, v243
ds_write_b64 v253, v[254:255] offset:6152
s_waitcnt lgkmcnt(0)
v_log_f32 v243, v231
v_max3_f32 v235, v156, v157, v158
v_max3_f32 v235, v235, v159, v243
v_mov_b32 v243, v235
s_nop 1
v_permlane32_swap_b32 v235, v243
s_nop 1
v_max_f32 v235, v235, v243
v_mov_b32 v243, v235
s_nop 1
v_permlane16_swap_b32 v235, v243
s_nop 1
v_max_f32 v235, v235, v243
v_ceil_f32 v235, v235
v_max_f32 v235, 0, v235
v_sub_f32 v243, 0, v235
v_exp_f32 v239, v243
s_nop 1
v_mul_f32 v231, v231, v239
v_add_f32 v247, v247, v235
v_sub_f32 v204, v204, v235
v_sub_f32 v140, v140, v235
v_sub_f32 v156, v156, v235
v_sub_f32 v205, v205, v235
v_sub_f32 v141, v141, v235
v_sub_f32 v157, v157, v235
v_sub_f32 v206, v206, v235
v_sub_f32 v142, v142, v235
v_sub_f32 v158, v158, v235
v_sub_f32 v207, v207, v235
v_sub_f32 v143, v143, v235
v_sub_f32 v159, v159, v235
v_lshlrev_b32 v242, 16, v172
v_and_b32 v243, 0xffff0000, v172
v_mul_f32 v242, v242, v239
v_mul_f32 v243, v243, v239
v_cvt_pk_bf16_f32 v172, v242, v243
v_lshlrev_b32 v242, 16, v173
v_and_b32 v243, 0xffff0000, v173
v_mul_f32 v242, v242, v239
v_mul_f32 v243, v243, v239
v_cvt_pk_bf16_f32 v173, v242, v243
ds_read_b64 v[254:255], v253 offset:3072
s_waitcnt lgkmcnt(0)
v_lshlrev_b32 v242, 16, v254
v_and_b32 v243, 0xffff0000, v254
v_mul_f32 v242, v242, v239
v_mul_f32 v243, v243, v239
v_cvt_pk_bf16_f32 v254, v242, v243
v_lshlrev_b32 v242, 16, v255
v_and_b32 v243, 0xffff0000, v255
v_mul_f32 v242, v242, v239
v_mul_f32 v243, v243, v239
v_cvt_pk_bf16_f32 v255, v242, v243
ds_write_b64 v253, v[254:255] offset:3072
s_waitcnt lgkmcnt(0)
ds_read_b64 v[254:255], v253 offset:3080
s_waitcnt lgkmcnt(0)
v_lshlrev_b32 v242, 16, v254
v_and_b32 v243, 0xffff0000, v254
v_mul_f32 v242, v242, v239
v_mul_f32 v243, v243, v239
v_cvt_pk_bf16_f32 v254, v242, v243
v_lshlrev_b32 v242, 16, v255
v_and_b32 v243, 0xffff0000, v255
v_mul_f32 v242, v242, v239
v_mul_f32 v243, v243, v239
v_cvt_pk_bf16_f32 v255, v242, v243
ds_write_b64 v253, v[254:255] offset:3080
s_waitcnt lgkmcnt(0)
ds_read_b64 v[254:255], v253 offset:7168
s_waitcnt lgkmcnt(0)
v_lshlrev_b32 v242, 16, v254
v_and_b32 v243, 0xffff0000, v254
v_mul_f32 v242, v242, v239
v_mul_f32 v243, v243, v239
v_cvt_pk_bf16_f32 v254, v242, v243
v_lshlrev_b32 v242, 16, v255
v_and_b32 v243, 0xffff0000, v255
v_mul_f32 v242, v242, v239
v_mul_f32 v243, v243, v239
v_cvt_pk_bf16_f32 v255, v242, v243
ds_write_b64 v253, v[254:255] offset:7168
s_waitcnt lgkmcnt(0)
ds_read_b64 v[254:255], v253 offset:7176
s_waitcnt lgkmcnt(0)
v_lshlrev_b32 v242, 16, v254
v_and_b32 v243, 0xffff0000, v254
v_mul_f32 v242, v242, v239
v_mul_f32 v243, v243, v239
v_cvt_pk_bf16_f32 v254, v242, v243
v_lshlrev_b32 v242, 16, v255
v_and_b32 v243, 0xffff0000, v255
v_mul_f32 v242, v242, v239
v_mul_f32 v243, v243, v239
v_cvt_pk_bf16_f32 v255, v242, v243
ds_write_b64 v253, v[254:255] offset:7176
s_waitcnt lgkmcnt(0)
v_exp_f32 v232, v144
v_exp_f32 v233, v145
v_exp_f32 v234, v146
v_exp_f32 v235, v147
s_nop 1
v_add_f32 v224, v228, v232
v_add_f32 v224, v224, v233
v_add_f32 v224, v224, v234
v_add_f32 v224, v224, v235
v_cvt_pk_bf16_f32 v162, v232, v233
v_cvt_pk_bf16_f32 v163, v234, v235
v_exp_f32 v232, v148
v_exp_f32 v233, v149
v_exp_f32 v234, v150
v_exp_f32 v235, v151
s_nop 1
v_add_f32 v225, v229, v232
v_add_f32 v225, v225, v233
v_add_f32 v225, v225, v234
v_add_f32 v225, v225, v235
v_cvt_pk_bf16_f32 v166, v232, v233
v_cvt_pk_bf16_f32 v167, v234, v235
v_exp_f32 v232, v152
v_exp_f32 v233, v153
v_exp_f32 v234, v154
v_exp_f32 v235, v155
s_nop 1
v_add_f32 v226, v230, v232
v_add_f32 v226, v226, v233
v_add_f32 v226, v226, v234
v_add_f32 v226, v226, v235
v_cvt_pk_bf16_f32 v170, v232, v233
v_cvt_pk_bf16_f32 v171, v234, v235
v_exp_f32 v232, v156
v_exp_f32 v233, v157
v_exp_f32 v234, v158
v_exp_f32 v235, v159
s_nop 1
v_add_f32 v227, v231, v232
v_add_f32 v227, v227, v233
v_add_f32 v227, v227, v234
v_add_f32 v227, v227, v235
v_cvt_pk_bf16_f32 v174, v232, v233
v_cvt_pk_bf16_f32 v175, v234, v235
s_branch L2_rare_common
L2_rare_site8:
s_mov_b32 s36, 8
s_branch L2_rare_t0_4_0
L2_rare_t0_4_0:
s_nop 15
s_nop 15
s_waitcnt lgkmcnt(0)
v_log_f32 v243, v224
v_max3_f32 v232, v128, v129, v130
v_max3_f32 v232, v232, v131, v243
v_mov_b32 v243, v232
s_nop 1
v_permlane32_swap_b32 v232, v243
s_nop 1
v_max_f32 v232, v232, v243
v_mov_b32 v243, v232
s_nop 1
v_permlane16_swap_b32 v232, v243
s_nop 1
v_max_f32 v232, v232, v243
v_ceil_f32 v232, v232
v_max_f32 v232, 0, v232
v_sub_f32 v243, 0, v232
v_exp_f32 v236, v243
s_nop 1
v_mul_f32 v224, v224, v236
v_add_f32 v244, v244, v232
v_sub_f32 v192, v192, v232
v_sub_f32 v128, v128, v232
v_sub_f32 v144, v144, v232
v_sub_f32 v193, v193, v232
v_sub_f32 v129, v129, v232
v_sub_f32 v145, v145, v232
v_sub_f32 v194, v194, v232
v_sub_f32 v130, v130, v232
v_sub_f32 v146, v146, v232
v_sub_f32 v195, v195, v232
v_sub_f32 v131, v131, v232
v_sub_f32 v147, v147, v232
v_lshlrev_b32 v242, 16, v160
v_and_b32 v243, 0xffff0000, v160
v_mul_f32 v242, v242, v236
v_mul_f32 v243, v243, v236
v_cvt_pk_bf16_f32 v160, v242, v243
v_lshlrev_b32 v242, 16, v161
v_and_b32 v243, 0xffff0000, v161
v_mul_f32 v242, v242, v236
v_mul_f32 v243, v243, v236
v_cvt_pk_bf16_f32 v161, v242, v243
v_lshlrev_b32 v242, 16, v162
v_and_b32 v243, 0xffff0000, v162
v_mul_f32 v242, v242, v236
v_mul_f32 v243, v243, v236
v_cvt_pk_bf16_f32 v162, v242, v243
v_lshlrev_b32 v242, 16, v163
v_and_b32 v243, 0xffff0000, v163
v_mul_f32 v242, v242, v236
v_mul_f32 v243, v243, v236
v_cvt_pk_bf16_f32 v163, v242, v243
ds_read_b64 v[254:255], v253 offset:0
s_waitcnt lgkmcnt(0)
v_lshlrev_b32 v242, 16, v254
v_and_b32 v243, 0xffff0000, v254
v_mul_f32 v242, v242, v236
v_mul_f32 v243, v243, v236
v_cvt_pk_bf16_f32 v254, v242, v243
v_lshlrev_b32 v242, 16, v255
v_and_b32 v243, 0xffff0000, v255
v_mul_f32 v242, v242, v236
v_mul_f32 v243, v243, v236
v_cvt_pk_bf16_f32 v255, v242, v243
ds_write_b64 v253, v[254:255] offset:0
s_waitcnt lgkmcnt(0)
ds_read_b64 v[254:255], v253 offset:8
s_waitcnt lgkmcnt(0)
v_lshlrev_b32 v242, 16, v254
v_and_b32 v243, 0xffff0000, v254
v_mul_f32 v242, v242, v236
v_mul_f32 v243, v243, v236
v_cvt_pk_bf16_f32 v254, v242, v243
v_lshlrev_b32 v242, 16, v255
v_and_b32 v243, 0xffff0000, v255
v_mul_f32 v242, v242, v236
v_mul_f32 v243, v243, v236
v_cvt_pk_bf16_f32 v255, v242, v243
ds_write_b64 v253, v[254:255] offset:8
s_waitcnt lgkmcnt(0)
ds_read_b64 v[254:255], v253 offset:4096
s_waitcnt lgkmcnt(0)
v_lshlrev_b32 v242, 16, v254
v_and_b32 v243, 0xffff0000, v254
v_mul_f32 v242, v242, v236
v_mul_f32 v243, v243, v236
v_cvt_pk_bf16_f32 v254, v242, v243
v_lshlrev_b32 v242, 16, v255
v_and_b32 v243, 0xffff0000, v255
v_mul_f32 v242, v242, v236
v_mul_f32 v243, v243, v236
v_cvt_pk_bf16_f32 v255, v242, v243
ds_write_b64 v253, v[254:255] offset:4096
s_waitcnt lgkmcnt(0)
ds_read_b64 v[254:255], v253 offset:4104
s_waitcnt lgkmcnt(0)
v_lshlrev_b32 v242, 16, v254
v_and_b32 v243, 0xffff0000, v254
v_mul_f32 v242, v242, v236
v_mul_f32 v243, v243, v236
v_cvt_pk_bf16_f32 v254, v242, v243
v_lshlrev_b32 v242, 16, v255
v_and_b32 v243, 0xffff0000, v255
v_mul_f32 v242, v242, v236
v_mul_f32 v243, v243, v236
v_cvt_pk_bf16_f32 v255, v242, v243
ds_write_b64 v253, v[254:255] offset:4104
s_waitcnt lgkmcnt(0)
v_log_f32 v243, v225
v_max3_f32 v233, v132, v133, v134
v_max3_f32 v233, v233, v135, v243
v_mov_b32 v243, v233
s_nop 1
v_permlane32_swap_b32 v233, v243
s_nop 1
v_max_f32 v233, v233, v243
v_mov_b32 v243, v233
s_nop 1
v_permlane16_swap_b32 v233, v243
s_nop 1
v_max_f32 v233, v233, v243
v_ceil_f32 v233, v233
v_max_f32 v233, 0, v233
v_sub_f32 v243, 0, v233
v_exp_f32 v237, v243
s_nop 1
v_mul_f32 v225, v225, v237
v_add_f32 v245, v245, v233
v_sub_f32 v196, v196, v233
v_sub_f32 v132, v132, v233
v_sub_f32 v148, v148, v233
v_sub_f32 v197, v197, v233
v_sub_f32 v133, v133, v233
v_sub_f32 v149, v149, v233
v_sub_f32 v198, v198, v233
v_sub_f32 v134, v134, v233
v_sub_f32 v150, v150, v233
v_sub_f32 v199, v199, v233
v_sub_f32 v135, v135, v233
v_sub_f32 v151, v151, v233
v_lshlrev_b32 v242, 16, v164
v_and_b32 v243, 0xffff0000, v164
v_mul_f32 v242, v242, v237
v_mul_f32 v243, v243, v237
v_cvt_pk_bf16_f32 v164, v242, v243
v_lshlrev_b32 v242, 16, v165
v_and_b32 v243, 0xffff0000, v165
v_mul_f32 v242, v242, v237
v_mul_f32 v243, v243, v237
v_cvt_pk_bf16_f32 v165, v242, v243
v_lshlrev_b32 v242, 16, v166
v_and_b32 v243, 0xffff0000, v166
v_mul_f32 v242, v242, v237
v_mul_f32 v243, v243, v237
v_cvt_pk_bf16_f32 v166, v242, v243
v_lshlrev_b32 v242, 16, v167
v_and_b32 v243, 0xffff0000, v167
v_mul_f32 v242, v242, v237
v_mul_f32 v243, v243, v237
v_cvt_pk_bf16_f32 v167, v242, v243
ds_read_b64 v[254:255], v253 offset:1024
s_waitcnt lgkmcnt(0)
v_lshlrev_b32 v242, 16, v254
v_and_b32 v243, 0xffff0000, v254
v_mul_f32 v242, v242, v237
v_mul_f32 v243, v243, v237
v_cvt_pk_bf16_f32 v254, v242, v243
v_lshlrev_b32 v242, 16, v255
v_and_b32 v243, 0xffff0000, v255
v_mul_f32 v242, v242, v237
v_mul_f32 v243, v243, v237
v_cvt_pk_bf16_f32 v255, v242, v243
ds_write_b64 v253, v[254:255] offset:1024
s_waitcnt lgkmcnt(0)
ds_read_b64 v[254:255], v253 offset:1032
s_waitcnt lgkmcnt(0)
v_lshlrev_b32 v242, 16, v254
v_and_b32 v243, 0xffff0000, v254
v_mul_f32 v242, v242, v237
v_mul_f32 v243, v243, v237
v_cvt_pk_bf16_f32 v254, v242, v243
v_lshlrev_b32 v242, 16, v255
v_and_b32 v243, 0xffff0000, v255
v_mul_f32 v242, v242, v237
v_mul_f32 v243, v243, v237
v_cvt_pk_bf16_f32 v255, v242, v243
ds_write_b64 v253, v[254:255] offset:1032
s_waitcnt lgkmcnt(0)
ds_read_b64 v[254:255], v253 offset:5120
s_waitcnt lgkmcnt(0)
v_lshlrev_b32 v242, 16, v254
v_and_b32 v243, 0xffff0000, v254
v_mul_f32 v242, v242, v237
v_mul_f32 v243, v243, v237
v_cvt_pk_bf16_f32 v254, v242, v243
v_lshlrev_b32 v242, 16, v255
v_and_b32 v243, 0xffff0000, v255
v_mul_f32 v242, v242, v237
v_mul_f32 v243, v243, v237
v_cvt_pk_bf16_f32 v255, v242, v243
ds_write_b64 v253, v[254:255] offset:5120
s_waitcnt lgkmcnt(0)
ds_read_b64 v[254:255], v253 offset:5128
s_waitcnt lgkmcnt(0)
v_lshlrev_b32 v242, 16, v254
v_and_b32 v243, 0xffff0000, v254
v_mul_f32 v242, v242, v237
v_mul_f32 v243, v243, v237
v_cvt_pk_bf16_f32 v254, v242, v243
v_lshlrev_b32 v242, 16, v255
v_and_b32 v243, 0xffff0000, v255
v_mul_f32 v242, v242, v237
v_mul_f32 v243, v243, v237
v_cvt_pk_bf16_f32 v255, v242, v243
ds_write_b64 v253, v[254:255] offset:5128
s_waitcnt lgkmcnt(0)
v_log_f32 v243, v226
v_max3_f32 v234, v136, v137, v138
v_max3_f32 v234, v234, v139, v243
v_mov_b32 v243, v234
s_nop 1
v_permlane32_swap_b32 v234, v243
s_nop 1
v_max_f32 v234, v234, v243
v_mov_b32 v243, v234
s_nop 1
v_permlane16_swap_b32 v234, v243
s_nop 1
v_max_f32 v234, v234, v243
v_ceil_f32 v234, v234
v_max_f32 v234, 0, v234
v_sub_f32 v243, 0, v234
v_exp_f32 v238, v243
s_nop 1
v_mul_f32 v226, v226, v238
v_add_f32 v246, v246, v234
v_sub_f32 v200, v200, v234
v_sub_f32 v136, v136, v234
v_sub_f32 v152, v152, v234
v_sub_f32 v201, v201, v234
v_sub_f32 v137, v137, v234
v_sub_f32 v153, v153, v234
v_sub_f32 v202, v202, v234
v_sub_f32 v138, v138, v234
v_sub_f32 v154, v154, v234
v_sub_f32 v203, v203, v234
v_sub_f32 v139, v139, v234
v_sub_f32 v155, v155, v234
v_lshlrev_b32 v242, 16, v168
v_and_b32 v243, 0xffff0000, v168
v_mul_f32 v242, v242, v238
v_mul_f32 v243, v243, v238
v_cvt_pk_bf16_f32 v168, v242, v243
v_lshlrev_b32 v242, 16, v169
v_and_b32 v243, 0xffff0000, v169
v_mul_f32 v242, v242, v238
v_mul_f32 v243, v243, v238
v_cvt_pk_bf16_f32 v169, v242, v243
v_lshlrev_b32 v242, 16, v170
v_and_b32 v243, 0xffff0000, v170
v_mul_f32 v242, v242, v238
v_mul_f32 v243, v243, v238
v_cvt_pk_bf16_f32 v170, v242, v243
v_lshlrev_b32 v242, 16, v171
v_and_b32 v243, 0xffff0000, v171
v_mul_f32 v242, v242, v238
v_mul_f32 v243, v243, v238
v_cvt_pk_bf16_f32 v171, v242, v243
ds_read_b64 v[254:255], v253 offset:2048
s_waitcnt lgkmcnt(0)
v_lshlrev_b32 v242, 16, v254
v_and_b32 v243, 0xffff0000, v254
v_mul_f32 v242, v242, v238
v_mul_f32 v243, v243, v238
v_cvt_pk_bf16_f32 v254, v242, v243
v_lshlrev_b32 v242, 16, v255
v_and_b32 v243, 0xffff0000, v255
v_mul_f32 v242, v242, v238
v_mul_f32 v243, v243, v238
v_cvt_pk_bf16_f32 v255, v242, v243
ds_write_b64 v253, v[254:255] offset:2048
s_waitcnt lgkmcnt(0)
ds_read_b64 v[254:255], v253 offset:2056
s_waitcnt lgkmcnt(0)
v_lshlrev_b32 v242, 16, v254
v_and_b32 v243, 0xffff0000, v254
v_mul_f32 v242, v242, v238
v_mul_f32 v243, v243, v238
v_cvt_pk_bf16_f32 v254, v242, v243
v_lshlrev_b32 v242, 16, v255
v_and_b32 v243, 0xffff0000, v255
v_mul_f32 v242, v242, v238
v_mul_f32 v243, v243, v238
v_cvt_pk_bf16_f32 v255, v242, v243
ds_write_b64 v253, v[254:255] offset:2056
s_waitcnt lgkmcnt(0)
ds_read_b64 v[254:255], v253 offset:6144
s_waitcnt lgkmcnt(0)
v_lshlrev_b32 v242, 16, v254
v_and_b32 v243, 0xffff0000, v254
v_mul_f32 v242, v242, v238
v_mul_f32 v243, v243, v238
v_cvt_pk_bf16_f32 v254, v242, v243
v_lshlrev_b32 v242, 16, v255
v_and_b32 v243, 0xffff0000, v255
v_mul_f32 v242, v242, v238
v_mul_f32 v243, v243, v238
v_cvt_pk_bf16_f32 v255, v242, v243
ds_write_b64 v253, v[254:255] offset:6144
s_waitcnt lgkmcnt(0)
ds_read_b64 v[254:255], v253 offset:6152
s_waitcnt lgkmcnt(0)
v_lshlrev_b32 v242, 16, v254
v_and_b32 v243, 0xffff0000, v254
v_mul_f32 v242, v242, v238
v_mul_f32 v243, v243, v238
v_cvt_pk_bf16_f32 v254, v242, v243
v_lshlrev_b32 v242, 16, v255
v_and_b32 v243, 0xffff0000, v255
v_mul_f32 v242, v242, v238
v_mul_f32 v243, v243, v238
v_cvt_pk_bf16_f32 v255, v242, v243
ds_write_b64 v253, v[254:255] offset:6152
s_waitcnt lgkmcnt(0)
v_log_f32 v243, v227
v_max3_f32 v235, v140, v141, v142
v_max3_f32 v235, v235, v143, v243
v_mov_b32 v243, v235
s_nop 1
v_permlane32_swap_b32 v235, v243
s_nop 1
v_max_f32 v235, v235, v243
v_mov_b32 v243, v235
s_nop 1
v_permlane16_swap_b32 v235, v243
s_nop 1
v_max_f32 v235, v235, v243
v_ceil_f32 v235, v235
v_max_f32 v235, 0, v235
v_sub_f32 v243, 0, v235
v_exp_f32 v239, v243
s_nop 1
v_mul_f32 v227, v227, v239
v_add_f32 v247, v247, v235
v_sub_f32 v204, v204, v235
v_sub_f32 v140, v140, v235
v_sub_f32 v156, v156, v235
v_sub_f32 v205, v205, v235
v_sub_f32 v141, v141, v235
v_sub_f32 v157, v157, v235
v_sub_f32 v206, v206, v235
v_sub_f32 v142, v142, v235
v_sub_f32 v158, v158, v235
v_sub_f32 v207, v207, v235
v_sub_f32 v143, v143, v235
v_sub_f32 v159, v159, v235
v_lshlrev_b32 v242, 16, v172
v_and_b32 v243, 0xffff0000, v172
v_mul_f32 v242, v242, v239
v_mul_f32 v243, v243, v239
v_cvt_pk_bf16_f32 v172, v242, v243
v_lshlrev_b32 v242, 16, v173
v_and_b32 v243, 0xffff0000, v173
v_mul_f32 v242, v242, v239
v_mul_f32 v243, v243, v239
v_cvt_pk_bf16_f32 v173, v242, v243
v_lshlrev_b32 v242, 16, v174
v_and_b32 v243, 0xffff0000, v174
v_mul_f32 v242, v242, v239
v_mul_f32 v243, v243, v239
v_cvt_pk_bf16_f32 v174, v242, v243
v_lshlrev_b32 v242, 16, v175
v_and_b32 v243, 0xffff0000, v175
v_mul_f32 v242, v242, v239
v_mul_f32 v243, v243, v239
v_cvt_pk_bf16_f32 v175, v242, v243
ds_read_b64 v[254:255], v253 offset:3072
s_waitcnt lgkmcnt(0)
v_lshlrev_b32 v242, 16, v254
v_and_b32 v243, 0xffff0000, v254
v_mul_f32 v242, v242, v239
v_mul_f32 v243, v243, v239
v_cvt_pk_bf16_f32 v254, v242, v243
v_lshlrev_b32 v242, 16, v255
v_and_b32 v243, 0xffff0000, v255
v_mul_f32 v242, v242, v239
v_mul_f32 v243, v243, v239
v_cvt_pk_bf16_f32 v255, v242, v243
ds_write_b64 v253, v[254:255] offset:3072
s_waitcnt lgkmcnt(0)
ds_read_b64 v[254:255], v253 offset:3080
s_waitcnt lgkmcnt(0)
v_lshlrev_b32 v242, 16, v254
v_and_b32 v243, 0xffff0000, v254
v_mul_f32 v242, v242, v239
v_mul_f32 v243, v243, v239
v_cvt_pk_bf16_f32 v254, v242, v243
v_lshlrev_b32 v242, 16, v255
v_and_b32 v243, 0xffff0000, v255
v_mul_f32 v242, v242, v239
v_mul_f32 v243, v243, v239
v_cvt_pk_bf16_f32 v255, v242, v243
ds_write_b64 v253, v[254:255] offset:3080
s_waitcnt lgkmcnt(0)
ds_read_b64 v[254:255], v253 offset:7168
s_waitcnt lgkmcnt(0)
v_lshlrev_b32 v242, 16, v254
v_and_b32 v243, 0xffff0000, v254
v_mul_f32 v242, v242, v239
v_mul_f32 v243, v243, v239
v_cvt_pk_bf16_f32 v254, v242, v243
v_lshlrev_b32 v242, 16, v255
v_and_b32 v243, 0xffff0000, v255
v_mul_f32 v242, v242, v239
v_mul_f32 v243, v243, v239
v_cvt_pk_bf16_f32 v255, v242, v243
ds_write_b64 v253, v[254:255] offset:7168
s_waitcnt lgkmcnt(0)
ds_read_b64 v[254:255], v253 offset:7176
s_waitcnt lgkmcnt(0)
v_lshlrev_b32 v242, 16, v254
v_and_b32 v243, 0xffff0000, v254
v_mul_f32 v242, v242, v239
v_mul_f32 v243, v243, v239
v_cvt_pk_bf16_f32 v254, v242, v243
v_lshlrev_b32 v242, 16, v255
v_and_b32 v243, 0xffff0000, v255
v_mul_f32 v242, v242, v239
v_mul_f32 v243, v243, v239
v_cvt_pk_bf16_f32 v255, v242, v243
ds_write_b64 v253, v[254:255] offset:7176
s_waitcnt lgkmcnt(0)
v_exp_f32 v232, v128
v_exp_f32 v233, v129
v_exp_f32 v234, v130
v_exp_f32 v235, v131
s_nop 1
v_add_f32 v228, v224, v232
v_add_f32 v228, v228, v233
v_add_f32 v228, v228, v234
v_add_f32 v228, v228, v235
v_cvt_pk_bf16_f32 v176, v232, v233
v_cvt_pk_bf16_f32 v177, v234, v235
v_exp_f32 v232, v132
v_exp_f32 v233, v133
v_exp_f32 v234, v134
v_exp_f32 v235, v135
s_nop 1
v_add_f32 v229, v225, v232
v_add_f32 v229, v229, v233
v_add_f32 v229, v229, v234
v_add_f32 v229, v229, v235
v_cvt_pk_bf16_f32 v180, v232, v233
v_cvt_pk_bf16_f32 v181, v234, v235
v_exp_f32 v232, v136
v_exp_f32 v233, v137
v_exp_f32 v234, v138
v_exp_f32 v235, v139
s_nop 1
v_add_f32 v230, v226, v232
v_add_f32 v230, v230, v233
v_add_f32 v230, v230, v234
v_add_f32 v230, v230, v235
v_cvt_pk_bf16_f32 v184, v232, v233
v_cvt_pk_bf16_f32 v185, v234, v235
v_exp_f32 v232, v140
v_exp_f32 v233, v141
v_exp_f32 v234, v142
v_exp_f32 v235, v143
s_nop 1
v_add_f32 v231, v227, v232
v_add_f32 v231, v231, v233
v_add_f32 v231, v231, v234
v_add_f32 v231, v231, v235
v_cvt_pk_bf16_f32 v188, v232, v233
v_cvt_pk_bf16_f32 v189, v234, v235
s_branch L2_rare_common
L2_rare_site9:
s_mov_b32 s36, 9
s_branch L2_rare_t0_5_1
L2_rare_t0_5_1:
s_nop 15
s_nop 15
s_waitcnt lgkmcnt(0)
v_log_f32 v243, v228
v_max3_f32 v232, v144, v145, v146
v_max3_f32 v232, v232, v147, v243
v_mov_b32 v243, v232
s_nop 1
v_permlane32_swap_b32 v232, v243
s_nop 1
v_max_f32 v232, v232, v243
v_mov_b32 v243, v232
s_nop 1
v_permlane16_swap_b32 v232, v243
s_nop 1
v_max_f32 v232, v232, v243
v_ceil_f32 v232, v232
v_max_f32 v232, 0, v232
v_sub_f32 v243, 0, v232
v_exp_f32 v236, v243
s_nop 1
v_mul_f32 v228, v228, v236
v_add_f32 v244, v244, v232
v_sub_f32 v192, v192, v232
v_sub_f32 v128, v128, v232
v_sub_f32 v144, v144, v232
v_sub_f32 v193, v193, v232
v_sub_f32 v129, v129, v232
v_sub_f32 v145, v145, v232
v_sub_f32 v194, v194, v232
v_sub_f32 v130, v130, v232
v_sub_f32 v146, v146, v232
v_sub_f32 v195, v195, v232
v_sub_f32 v131, v131, v232
v_sub_f32 v147, v147, v232
v_lshlrev_b32 v242, 16, v160
v_and_b32 v243, 0xffff0000, v160
v_mul_f32 v242, v242, v236
v_mul_f32 v243, v243, v236
v_cvt_pk_bf16_f32 v160, v242, v243
v_lshlrev_b32 v242, 16, v161
v_and_b32 v243, 0xffff0000, v161
v_mul_f32 v242, v242, v236
v_mul_f32 v243, v243, v236
v_cvt_pk_bf16_f32 v161, v242, v243
v_lshlrev_b32 v242, 16, v162
v_and_b32 v243, 0xffff0000, v162
v_mul_f32 v242, v242, v236
v_mul_f32 v243, v243, v236
v_cvt_pk_bf16_f32 v162, v242, v243
v_lshlrev_b32 v242, 16, v163
v_and_b32 v243, 0xffff0000, v163
v_mul_f32 v242, v242, v236
v_mul_f32 v243, v243, v236
v_cvt_pk_bf16_f32 v163, v242, v243
v_lshlrev_b32 v242, 16, v176
v_and_b32 v243, 0xffff0000, v176
v_mul_f32 v242, v242, v236
v_mul_f32 v243, v243, v236
v_cvt_pk_bf16_f32 v176, v242, v243
v_lshlrev_b32 v242, 16, v177
v_and_b32 v243, 0xffff0000, v177
v_mul_f32 v242, v242, v236
v_mul_f32 v243, v243, v236
v_cvt_pk_bf16_f32 v177, v242, v243
ds_read_b64 v[254:255], v253 offset:0
s_waitcnt lgkmcnt(0)
v_lshlrev_b32 v242, 16, v254
v_and_b32 v243, 0xffff0000, v254
v_mul_f32 v242, v242, v236
v_mul_f32 v243, v243, v236
v_cvt_pk_bf16_f32 v254, v242, v243
v_lshlrev_b32 v242, 16, v255
v_and_b32 v243, 0xffff0000, v255
v_mul_f32 v242, v242, v236
v_mul_f32 v243, v243, v236
v_cvt_pk_bf16_f32 v255, v242, v243
ds_write_b64 v253, v[254:255] offset:0
s_waitcnt lgkmcnt(0)
ds_read_b64 v[254:255], v253 offset:8
s_waitcnt lgkmcnt(0)
v_lshlrev_b32 v242, 16, v254
v_and_b32 v243, 0xffff0000, v254
v_mul_f32 v242, v242, v236
v_mul_f32 v243, v243, v236
v_cvt_pk_bf16_f32 v254, v242, v243
v_lshlrev_b32 v242, 16, v255
v_and_b32 v243, 0xffff0000, v255
v_mul_f32 v242, v242, v236
v_mul_f32 v243, v243, v236
v_cvt_pk_bf16_f32 v255, v242, v243
ds_write_b64 v253, v[254:255] offset:8
s_waitcnt lgkmcnt(0)
ds_read_b64 v[254:255], v253 offset:4096
s_waitcnt lgkmcnt(0)
v_lshlrev_b32 v242, 16, v254
v_and_b32 v243, 0xffff0000, v254
v_mul_f32 v242, v242, v236
v_mul_f32 v243, v243, v236
v_cvt_pk_bf16_f32 v254, v242, v243
v_lshlrev_b32 v242, 16, v255
v_and_b32 v243, 0xffff0000, v255
v_mul_f32 v242, v242, v236
v_mul_f32 v243, v243, v236
v_cvt_pk_bf16_f32 v255, v242, v243
ds_write_b64 v253, v[254:255] offset:4096
s_waitcnt lgkmcnt(0)
ds_read_b64 v[254:255], v253 offset:4104
s_waitcnt lgkmcnt(0)
v_lshlrev_b32 v242, 16, v254
v_and_b32 v243, 0xffff0000, v254
v_mul_f32 v242, v242, v236
v_mul_f32 v243, v243, v236
v_cvt_pk_bf16_f32 v254, v242, v243
v_lshlrev_b32 v242, 16, v255
v_and_b32 v243, 0xffff0000, v255
v_mul_f32 v242, v242, v236
v_mul_f32 v243, v243, v236
v_cvt_pk_bf16_f32 v255, v242, v243
ds_write_b64 v253, v[254:255] offset:4104
s_waitcnt lgkmcnt(0)
v_log_f32 v243, v229
v_max3_f32 v233, v148, v149, v150
v_max3_f32 v233, v233, v151, v243
v_mov_b32 v243, v233
s_nop 1
v_permlane32_swap_b32 v233, v243
s_nop 1
v_max_f32 v233, v233, v243
v_mov_b32 v243, v233
s_nop 1
v_permlane16_swap_b32 v233, v243
s_nop 1
v_max_f32 v233, v233, v243
v_ceil_f32 v233, v233
v_max_f32 v233, 0, v233
v_sub_f32 v243, 0, v233
v_exp_f32 v237, v243
s_nop 1
v_mul_f32 v229, v229, v237
v_add_f32 v245, v245, v233
v_sub_f32 v196, v196, v233
v_sub_f32 v132, v132, v233
v_sub_f32 v148, v148, v233
v_sub_f32 v197, v197, v233
v_sub_f32 v133, v133, v233
v_sub_f32 v149, v149, v233
v_sub_f32 v198, v198, v233
v_sub_f32 v134, v134, v233
v_sub_f32 v150, v150, v233
v_sub_f32 v199, v199, v233
v_sub_f32 v135, v135, v233
v_sub_f32 v151, v151, v233
v_lshlrev_b32 v242, 16, v164
v_and_b32 v243, 0xffff0000, v164
v_mul_f32 v242, v242, v237
v_mul_f32 v243, v243, v237
v_cvt_pk_bf16_f32 v164, v242, v243
v_lshlrev_b32 v242, 16, v165
v_and_b32 v243, 0xffff0000, v165
v_mul_f32 v242, v242, v237
v_mul_f32 v243, v243, v237
v_cvt_pk_bf16_f32 v165, v242, v243
v_lshlrev_b32 v242, 16, v166
v_and_b32 v243, 0xffff0000, v166
v_mul_f32 v242, v242, v237
v_mul_f32 v243, v243, v237
v_cvt_pk_bf16_f32 v166, v242, v243
v_lshlrev_b32 v242, 16, v167
v_and_b32 v243, 0xffff0000, v167
v_mul_f32 v242, v242, v237
v_mul_f32 v243, v243, v237
v_cvt_pk_bf16_f32 v167, v242, v243
v_lshlrev_b32 v242, 16, v180
v_and_b32 v243, 0xffff0000, v180
v_mul_f32 v242, v242, v237
v_mul_f32 v243, v243, v237
v_cvt_pk_bf16_f32 v180, v242, v243
v_lshlrev_b32 v242, 16, v181
v_and_b32 v243, 0xffff0000, v181
v_mul_f32 v242, v242, v237
v_mul_f32 v243, v243, v237
v_cvt_pk_bf16_f32 v181, v242, v243
ds_read_b64 v[254:255], v253 offset:1024
s_waitcnt lgkmcnt(0)
v_lshlrev_b32 v242, 16, v254
v_and_b32 v243, 0xffff0000, v254
v_mul_f32 v242, v242, v237
v_mul_f32 v243, v243, v237
v_cvt_pk_bf16_f32 v254, v242, v243
v_lshlrev_b32 v242, 16, v255
v_and_b32 v243, 0xffff0000, v255
v_mul_f32 v242, v242, v237
v_mul_f32 v243, v243, v237
v_cvt_pk_bf16_f32 v255, v242, v243
ds_write_b64 v253, v[254:255] offset:1024
s_waitcnt lgkmcnt(0)
ds_read_b64 v[254:255], v253 offset:1032
s_waitcnt lgkmcnt(0)
v_lshlrev_b32 v242, 16, v254
v_and_b32 v243, 0xffff0000, v254
v_mul_f32 v242, v242, v237
v_mul_f32 v243, v243, v237
v_cvt_pk_bf16_f32 v254, v242, v243
v_lshlrev_b32 v242, 16, v255
v_and_b32 v243, 0xffff0000, v255
v_mul_f32 v242, v242, v237
v_mul_f32 v243, v243, v237
v_cvt_pk_bf16_f32 v255, v242, v243
ds_write_b64 v253, v[254:255] offset:1032
s_waitcnt lgkmcnt(0)
ds_read_b64 v[254:255], v253 offset:5120
s_waitcnt lgkmcnt(0)
v_lshlrev_b32 v242, 16, v254
v_and_b32 v243, 0xffff0000, v254
v_mul_f32 v242, v242, v237
v_mul_f32 v243, v243, v237
v_cvt_pk_bf16_f32 v254, v242, v243
v_lshlrev_b32 v242, 16, v255
v_and_b32 v243, 0xffff0000, v255
v_mul_f32 v242, v242, v237
v_mul_f32 v243, v243, v237
v_cvt_pk_bf16_f32 v255, v242, v243
ds_write_b64 v253, v[254:255] offset:5120
s_waitcnt lgkmcnt(0)
ds_read_b64 v[254:255], v253 offset:5128
s_waitcnt lgkmcnt(0)
v_lshlrev_b32 v242, 16, v254
v_and_b32 v243, 0xffff0000, v254
v_mul_f32 v242, v242, v237
v_mul_f32 v243, v243, v237
v_cvt_pk_bf16_f32 v254, v242, v243
v_lshlrev_b32 v242, 16, v255
v_and_b32 v243, 0xffff0000, v255
v_mul_f32 v242, v242, v237
v_mul_f32 v243, v243, v237
v_cvt_pk_bf16_f32 v255, v242, v243
ds_write_b64 v253, v[254:255] offset:5128
s_waitcnt lgkmcnt(0)
v_log_f32 v243, v230
v_max3_f32 v234, v152, v153, v154
v_max3_f32 v234, v234, v155, v243
v_mov_b32 v243, v234
s_nop 1
v_permlane32_swap_b32 v234, v243
s_nop 1
v_max_f32 v234, v234, v243
v_mov_b32 v243, v234
s_nop 1
v_permlane16_swap_b32 v234, v243
s_nop 1
v_max_f32 v234, v234, v243
v_ceil_f32 v234, v234
v_max_f32 v234, 0, v234
v_sub_f32 v243, 0, v234
v_exp_f32 v238, v243
s_nop 1
v_mul_f32 v230, v230, v238
v_add_f32 v246, v246, v234
v_sub_f32 v200, v200, v234
v_sub_f32 v136, v136, v234
v_sub_f32 v152, v152, v234
v_sub_f32 v201, v201, v234
v_sub_f32 v137, v137, v234
v_sub_f32 v153, v153, v234
v_sub_f32 v202, v202, v234
v_sub_f32 v138, v138, v234
v_sub_f32 v154, v154, v234
v_sub_f32 v203, v203, v234
v_sub_f32 v139, v139, v234
v_sub_f32 v155, v155, v234
v_lshlrev_b32 v242, 16, v168
v_and_b32 v243, 0xffff0000, v168
v_mul_f32 v242, v242, v238
v_mul_f32 v243, v243, v238
v_cvt_pk_bf16_f32 v168, v242, v243
v_lshlrev_b32 v242, 16, v169
v_and_b32 v243, 0xffff0000, v169
v_mul_f32 v242, v242, v238
v_mul_f32 v243, v243, v238
v_cvt_pk_bf16_f32 v169, v242, v243
v_lshlrev_b32 v242, 16, v170
v_and_b32 v243, 0xffff0000, v170
v_mul_f32 v242, v242, v238
v_mul_f32 v243, v243, v238
v_cvt_pk_bf16_f32 v170, v242, v243
v_lshlrev_b32 v242, 16, v171
v_and_b32 v243, 0xffff0000, v171
v_mul_f32 v242, v242, v238
v_mul_f32 v243, v243, v238
v_cvt_pk_bf16_f32 v171, v242, v243
v_lshlrev_b32 v242, 16, v184
v_and_b32 v243, 0xffff0000, v184
v_mul_f32 v242, v242, v238
v_mul_f32 v243, v243, v238
v_cvt_pk_bf16_f32 v184, v242, v243
v_lshlrev_b32 v242, 16, v185
v_and_b32 v243, 0xffff0000, v185
v_mul_f32 v242, v242, v238
v_mul_f32 v243, v243, v238
v_cvt_pk_bf16_f32 v185, v242, v243
ds_read_b64 v[254:255], v253 offset:2048
s_waitcnt lgkmcnt(0)
v_lshlrev_b32 v242, 16, v254
v_and_b32 v243, 0xffff0000, v254
v_mul_f32 v242, v242, v238
v_mul_f32 v243, v243, v238
v_cvt_pk_bf16_f32 v254, v242, v243
v_lshlrev_b32 v242, 16, v255
v_and_b32 v243, 0xffff0000, v255
v_mul_f32 v242, v242, v238
v_mul_f32 v243, v243, v238
v_cvt_pk_bf16_f32 v255, v242, v243
ds_write_b64 v253, v[254:255] offset:2048
s_waitcnt lgkmcnt(0)
ds_read_b64 v[254:255], v253 offset:2056
s_waitcnt lgkmcnt(0)
v_lshlrev_b32 v242, 16, v254
v_and_b32 v243, 0xffff0000, v254
v_mul_f32 v242, v242, v238
v_mul_f32 v243, v243, v238
v_cvt_pk_bf16_f32 v254, v242, v243
v_lshlrev_b32 v242, 16, v255
v_and_b32 v243, 0xffff0000, v255
v_mul_f32 v242, v242, v238
v_mul_f32 v243, v243, v238
v_cvt_pk_bf16_f32 v255, v242, v243
ds_write_b64 v253, v[254:255] offset:2056
s_waitcnt lgkmcnt(0)
ds_read_b64 v[254:255], v253 offset:6144
s_waitcnt lgkmcnt(0)
v_lshlrev_b32 v242, 16, v254
v_and_b32 v243, 0xffff0000, v254
v_mul_f32 v242, v242, v238
v_mul_f32 v243, v243, v238
v_cvt_pk_bf16_f32 v254, v242, v243
v_lshlrev_b32 v242, 16, v255
v_and_b32 v243, 0xffff0000, v255
v_mul_f32 v242, v242, v238
v_mul_f32 v243, v243, v238
v_cvt_pk_bf16_f32 v255, v242, v243
ds_write_b64 v253, v[254:255] offset:6144
s_waitcnt lgkmcnt(0)
ds_read_b64 v[254:255], v253 offset:6152
s_waitcnt lgkmcnt(0)
v_lshlrev_b32 v242, 16, v254
v_and_b32 v243, 0xffff0000, v254
v_mul_f32 v242, v242, v238
v_mul_f32 v243, v243, v238
v_cvt_pk_bf16_f32 v254, v242, v243
v_lshlrev_b32 v242, 16, v255
v_and_b32 v243, 0xffff0000, v255
v_mul_f32 v242, v242, v238
v_mul_f32 v243, v243, v238
v_cvt_pk_bf16_f32 v255, v242, v243
ds_write_b64 v253, v[254:255] offset:6152
s_waitcnt lgkmcnt(0)
v_log_f32 v243, v231
v_max3_f32 v235, v156, v157, v158
v_max3_f32 v235, v235, v159, v243
v_mov_b32 v243, v235
s_nop 1
v_permlane32_swap_b32 v235, v243
s_nop 1
v_max_f32 v235, v235, v243
v_mov_b32 v243, v235
s_nop 1
v_permlane16_swap_b32 v235, v243
s_nop 1
v_max_f32 v235, v235, v243
v_ceil_f32 v235, v235
v_max_f32 v235, 0, v235
v_sub_f32 v243, 0, v235
v_exp_f32 v239, v243
s_nop 1
v_mul_f32 v231, v231, v239
v_add_f32 v247, v247, v235
v_sub_f32 v204, v204, v235
v_sub_f32 v140, v140, v235
v_sub_f32 v156, v156, v235
v_sub_f32 v205, v205, v235
v_sub_f32 v141, v141, v235
v_sub_f32 v157, v157, v235
v_sub_f32 v206, v206, v235
v_sub_f32 v142, v142, v235
v_sub_f32 v158, v158, v235
v_sub_f32 v207, v207, v235
v_sub_f32 v143, v143, v235
v_sub_f32 v159, v159, v235
v_lshlrev_b32 v242, 16, v172
v_and_b32 v243, 0xffff0000, v172
v_mul_f32 v242, v242, v239
v_mul_f32 v243, v243, v239
v_cvt_pk_bf16_f32 v172, v242, v243
v_lshlrev_b32 v242, 16, v173
v_and_b32 v243, 0xffff0000, v173
v_mul_f32 v242, v242, v239
v_mul_f32 v243, v243, v239
v_cvt_pk_bf16_f32 v173, v242, v243
v_lshlrev_b32 v242, 16, v174
v_and_b32 v243, 0xffff0000, v174
v_mul_f32 v242, v242, v239
v_mul_f32 v243, v243, v239
v_cvt_pk_bf16_f32 v174, v242, v243
v_lshlrev_b32 v242, 16, v175
v_and_b32 v243, 0xffff0000, v175
v_mul_f32 v242, v242, v239
v_mul_f32 v243, v243, v239
v_cvt_pk_bf16_f32 v175, v242, v243
v_lshlrev_b32 v242, 16, v188
v_and_b32 v243, 0xffff0000, v188
v_mul_f32 v242, v242, v239
v_mul_f32 v243, v243, v239
v_cvt_pk_bf16_f32 v188, v242, v243
v_lshlrev_b32 v242, 16, v189
v_and_b32 v243, 0xffff0000, v189
v_mul_f32 v242, v242, v239
v_mul_f32 v243, v243, v239
v_cvt_pk_bf16_f32 v189, v242, v243
ds_read_b64 v[254:255], v253 offset:3072
s_waitcnt lgkmcnt(0)
v_lshlrev_b32 v242, 16, v254
v_and_b32 v243, 0xffff0000, v254
v_mul_f32 v242, v242, v239
v_mul_f32 v243, v243, v239
v_cvt_pk_bf16_f32 v254, v242, v243
v_lshlrev_b32 v242, 16, v255
v_and_b32 v243, 0xffff0000, v255
v_mul_f32 v242, v242, v239
v_mul_f32 v243, v243, v239
v_cvt_pk_bf16_f32 v255, v242, v243
ds_write_b64 v253, v[254:255] offset:3072
s_waitcnt lgkmcnt(0)
ds_read_b64 v[254:255], v253 offset:3080
s_waitcnt lgkmcnt(0)
v_lshlrev_b32 v242, 16, v254
v_and_b32 v243, 0xffff0000, v254
v_mul_f32 v242, v242, v239
v_mul_f32 v243, v243, v239
v_cvt_pk_bf16_f32 v254, v242, v243
v_lshlrev_b32 v242, 16, v255
v_and_b32 v243, 0xffff0000, v255
v_mul_f32 v242, v242, v239
v_mul_f32 v243, v243, v239
v_cvt_pk_bf16_f32 v255, v242, v243
ds_write_b64 v253, v[254:255] offset:3080
s_waitcnt lgkmcnt(0)
ds_read_b64 v[254:255], v253 offset:7168
s_waitcnt lgkmcnt(0)
v_lshlrev_b32 v242, 16, v254
v_and_b32 v243, 0xffff0000, v254
v_mul_f32 v242, v242, v239
v_mul_f32 v243, v243, v239
v_cvt_pk_bf16_f32 v254, v242, v243
v_lshlrev_b32 v242, 16, v255
v_and_b32 v243, 0xffff0000, v255
v_mul_f32 v242, v242, v239
v_mul_f32 v243, v243, v239
v_cvt_pk_bf16_f32 v255, v242, v243
ds_write_b64 v253, v[254:255] offset:7168
s_waitcnt lgkmcnt(0)
ds_read_b64 v[254:255], v253 offset:7176
s_waitcnt lgkmcnt(0)
v_lshlrev_b32 v242, 16, v254
v_and_b32 v243, 0xffff0000, v254
v_mul_f32 v242, v242, v239
v_mul_f32 v243, v243, v239
v_cvt_pk_bf16_f32 v254, v242, v243
v_lshlrev_b32 v242, 16, v255
v_and_b32 v243, 0xffff0000, v255
v_mul_f32 v242, v242, v239
v_mul_f32 v243, v243, v239
v_cvt_pk_bf16_f32 v255, v242, v243
ds_write_b64 v253, v[254:255] offset:7176
s_waitcnt lgkmcnt(0)
v_exp_f32 v232, v144
v_exp_f32 v233, v145
v_exp_f32 v234, v146
v_exp_f32 v235, v147
s_nop 1
v_add_f32 v224, v228, v232
v_add_f32 v224, v224, v233
v_add_f32 v224, v224, v234
v_add_f32 v224, v224, v235
v_cvt_pk_bf16_f32 v178, v232, v233
v_cvt_pk_bf16_f32 v179, v234, v235
v_exp_f32 v232, v148
v_exp_f32 v233, v149
v_exp_f32 v234, v150
v_exp_f32 v235, v151
s_nop 1
v_add_f32 v225, v229, v232
v_add_f32 v225, v225, v233
v_add_f32 v225, v225, v234
v_add_f32 v225, v225, v235
v_cvt_pk_bf16_f32 v182, v232, v233
v_cvt_pk_bf16_f32 v183, v234, v235
v_exp_f32 v232, v152
v_exp_f32 v233, v153
v_exp_f32 v234, v154
v_exp_f32 v235, v155
s_nop 1
v_add_f32 v226, v230, v232
v_add_f32 v226, v226, v233
v_add_f32 v226, v226, v234
v_add_f32 v226, v226, v235
v_cvt_pk_bf16_f32 v186, v232, v233
v_cvt_pk_bf16_f32 v187, v234, v235
v_exp_f32 v232, v156
v_exp_f32 v233, v157
v_exp_f32 v234, v158
v_exp_f32 v235, v159
s_nop 1
v_add_f32 v227, v231, v232
v_add_f32 v227, v227, v233
v_add_f32 v227, v227, v234
v_add_f32 v227, v227, v235
v_cvt_pk_bf16_f32 v190, v232, v233
v_cvt_pk_bf16_f32 v191, v234, v235
s_branch L2_rare_common
L2_rare_site10:
s_mov_b32 s36, 10
s_branch L2_rare_t0_6_0
L2_rare_t0_6_0:
s_nop 15
s_nop 15
s_waitcnt lgkmcnt(0)
v_log_f32 v243, v224
v_max3_f32 v232, v128, v129, v130
v_max3_f32 v232, v232, v131, v243
v_mov_b32 v243, v232
s_nop 1
v_permlane32_swap_b32 v232, v243
s_nop 1
v_max_f32 v232, v232, v243
v_mov_b32 v243, v232
s_nop 1
v_permlane16_swap_b32 v232, v243
s_nop 1
v_max_f32 v232, v232, v243
v_ceil_f32 v232, v232
v_max_f32 v232, 0, v232
v_sub_f32 v243, 0, v232
v_exp_f32 v236, v243
s_nop 1
v_mul_f32 v224, v224, v236
v_add_f32 v244, v244, v232
v_sub_f32 v192, v192, v232
v_sub_f32 v128, v128, v232
v_sub_f32 v144, v144, v232
v_sub_f32 v193, v193, v232
v_sub_f32 v129, v129, v232
v_sub_f32 v145, v145, v232
v_sub_f32 v194, v194, v232
v_sub_f32 v130, v130, v232
v_sub_f32 v146, v146, v232
v_sub_f32 v195, v195, v232
v_sub_f32 v131, v131, v232
v_sub_f32 v147, v147, v232
v_lshlrev_b32 v242, 16, v4
v_and_b32 v243, 0xffff0000, v4
v_mul_f32 v242, v242, v236
v_mul_f32 v243, v243, v236
v_cvt_pk_bf16_f32 v4, v242, v243
v_lshlrev_b32 v242, 16, v5
v_and_b32 v243, 0xffff0000, v5
v_mul_f32 v242, v242, v236
v_mul_f32 v243, v243, v236
v_cvt_pk_bf16_f32 v5, v242, v243
v_lshlrev_b32 v242, 16, v6
v_and_b32 v243, 0xffff0000, v6
v_mul_f32 v242, v242, v236
v_mul_f32 v243, v243, v236
v_cvt_pk_bf16_f32 v6, v242, v243
v_lshlrev_b32 v242, 16, v7
v_and_b32 v243, 0xffff0000, v7
v_mul_f32 v242, v242, v236
v_mul_f32 v243, v243, v236
v_cvt_pk_bf16_f32 v7, v242, v243
v_lshlrev_b32 v242, 16, v8
v_and_b32 v243, 0xffff0000, v8
v_mul_f32 v242, v242, v236
v_mul_f32 v243, v243, v236
v_cvt_pk_bf16_f32 v8, v242, v243
v_lshlrev_b32 v242, 16, v9
v_and_b32 v243, 0xffff0000, v9
v_mul_f32 v242, v242, v236
v_mul_f32 v243, v243, v236
v_cvt_pk_bf16_f32 v9, v242, v243
v_lshlrev_b32 v242, 16, v10
v_and_b32 v243, 0xffff0000, v10
v_mul_f32 v242, v242, v236
v_mul_f32 v243, v243, v236
v_cvt_pk_bf16_f32 v10, v242, v243
v_lshlrev_b32 v242, 16, v11
v_and_b32 v243, 0xffff0000, v11
v_mul_f32 v242, v242, v236
v_mul_f32 v243, v243, v236
v_cvt_pk_bf16_f32 v11, v242, v243
v_lshlrev_b32 v242, 16, v160
v_and_b32 v243, 0xffff0000, v160
v_mul_f32 v242, v242, v236
v_mul_f32 v243, v243, v236
v_cvt_pk_bf16_f32 v160, v242, v243
v_lshlrev_b32 v242, 16, v161
v_and_b32 v243, 0xffff0000, v161
v_mul_f32 v242, v242, v236
v_mul_f32 v243, v243, v236
v_cvt_pk_bf16_f32 v161, v242, v243
v_lshlrev_b32 v242, 16, v162
v_and_b32 v243, 0xffff0000, v162
v_mul_f32 v242, v242, v236
v_mul_f32 v243, v243, v236
v_cvt_pk_bf16_f32 v162, v242, v243
v_lshlrev_b32 v242, 16, v163
v_and_b32 v243, 0xffff0000, v163
v_mul_f32 v242, v242, v236
v_mul_f32 v243, v243, v236
v_cvt_pk_bf16_f32 v163, v242, v243
v_lshlrev_b32 v242, 16, v176
v_and_b32 v243, 0xffff0000, v176
v_mul_f32 v242, v242, v236
v_mul_f32 v243, v243, v236
v_cvt_pk_bf16_f32 v176, v242, v243
v_lshlrev_b32 v242, 16, v177
v_and_b32 v243, 0xffff0000, v177
v_mul_f32 v242, v242, v236
v_mul_f32 v243, v243, v236
v_cvt_pk_bf16_f32 v177, v242, v243
v_lshlrev_b32 v242, 16, v178
v_and_b32 v243, 0xffff0000, v178
v_mul_f32 v242, v242, v236
v_mul_f32 v243, v243, v236
v_cvt_pk_bf16_f32 v178, v242, v243
v_lshlrev_b32 v242, 16, v179
v_and_b32 v243, 0xffff0000, v179
v_mul_f32 v242, v242, v236
v_mul_f32 v243, v243, v236
v_cvt_pk_bf16_f32 v179, v242, v243
v_log_f32 v243, v225
v_max3_f32 v233, v132, v133, v134
v_max3_f32 v233, v233, v135, v243
v_mov_b32 v243, v233
s_nop 1
v_permlane32_swap_b32 v233, v243
s_nop 1
v_max_f32 v233, v233, v243
v_mov_b32 v243, v233
s_nop 1
v_permlane16_swap_b32 v233, v243
s_nop 1
v_max_f32 v233, v233, v243
v_ceil_f32 v233, v233
v_max_f32 v233, 0, v233
v_sub_f32 v243, 0, v233
v_exp_f32 v237, v243
s_nop 1
v_mul_f32 v225, v225, v237
v_add_f32 v245, v245, v233
v_sub_f32 v196, v196, v233
v_sub_f32 v132, v132, v233
v_sub_f32 v148, v148, v233
v_sub_f32 v197, v197, v233
v_sub_f32 v133, v133, v233
v_sub_f32 v149, v149, v233
v_sub_f32 v198, v198, v233
v_sub_f32 v134, v134, v233
v_sub_f32 v150, v150, v233
v_sub_f32 v199, v199, v233
v_sub_f32 v135, v135, v233
v_sub_f32 v151, v151, v233
v_lshlrev_b32 v242, 16, v36
v_and_b32 v243, 0xffff0000, v36
v_mul_f32 v242, v242, v237
v_mul_f32 v243, v243, v237
v_cvt_pk_bf16_f32 v36, v242, v243
v_lshlrev_b32 v242, 16, v37
v_and_b32 v243, 0xffff0000, v37
v_mul_f32 v242, v242, v237
v_mul_f32 v243, v243, v237
v_cvt_pk_bf16_f32 v37, v242, v243
v_lshlrev_b32 v242, 16, v38
v_and_b32 v243, 0xffff0000, v38
v_mul_f32 v242, v242, v237
v_mul_f32 v243, v243, v237
v_cvt_pk_bf16_f32 v38, v242, v243
v_lshlrev_b32 v242, 16, v39
v_and_b32 v243, 0xffff0000, v39
v_mul_f32 v242, v242, v237
v_mul_f32 v243, v243, v237
v_cvt_pk_bf16_f32 v39, v242, v243
v_lshlrev_b32 v242, 16, v40
v_and_b32 v243, 0xffff0000, v40
v_mul_f32 v242, v242, v237
v_mul_f32 v243, v243, v237
v_cvt_pk_bf16_f32 v40, v242, v243
v_lshlrev_b32 v242, 16, v41
v_and_b32 v243, 0xffff0000, v41
v_mul_f32 v242, v242, v237
v_mul_f32 v243, v243, v237
v_cvt_pk_bf16_f32 v41, v242, v243
v_lshlrev_b32 v242, 16, v42
v_and_b32 v243, 0xffff0000, v42
v_mul_f32 v242, v242, v237
v_mul_f32 v243, v243, v237
v_cvt_pk_bf16_f32 v42, v242, v243
v_lshlrev_b32 v242, 16, v43
v_and_b32 v243, 0xffff0000, v43
v_mul_f32 v242, v242, v237
v_mul_f32 v243, v243, v237
v_cvt_pk_bf16_f32 v43, v242, v243
v_lshlrev_b32 v242, 16, v164
v_and_b32 v243, 0xffff0000, v164
v_mul_f32 v242, v242, v237
v_mul_f32 v243, v243, v237
v_cvt_pk_bf16_f32 v164, v242, v243
v_lshlrev_b32 v242, 16, v165
v_and_b32 v243, 0xffff0000, v165
v_mul_f32 v242, v242, v237
v_mul_f32 v243, v243, v237
v_cvt_pk_bf16_f32 v165, v242, v243
v_lshlrev_b32 v242, 16, v166
v_and_b32 v243, 0xffff0000, v166
v_mul_f32 v242, v242, v237
v_mul_f32 v243, v243, v237
v_cvt_pk_bf16_f32 v166, v242, v243
v_lshlrev_b32 v242, 16, v167
v_and_b32 v243, 0xffff0000, v167
v_mul_f32 v242, v242, v237
v_mul_f32 v243, v243, v237
v_cvt_pk_bf16_f32 v167, v242, v243
v_lshlrev_b32 v242, 16, v180
v_and_b32 v243, 0xffff0000, v180
v_mul_f32 v242, v242, v237
v_mul_f32 v243, v243, v237
v_cvt_pk_bf16_f32 v180, v242, v243
v_lshlrev_b32 v242, 16, v181
v_and_b32 v243, 0xffff0000, v181
v_mul_f32 v242, v242, v237
v_mul_f32 v243, v243, v237
v_cvt_pk_bf16_f32 v181, v242, v243
v_lshlrev_b32 v242, 16, v182
v_and_b32 v243, 0xffff0000, v182
v_mul_f32 v242, v242, v237
v_mul_f32 v243, v243, v237
v_cvt_pk_bf16_f32 v182, v242, v243
v_lshlrev_b32 v242, 16, v183
v_and_b32 v243, 0xffff0000, v183
v_mul_f32 v242, v242, v237
v_mul_f32 v243, v243, v237
v_cvt_pk_bf16_f32 v183, v242, v243
v_log_f32 v243, v226
v_max3_f32 v234, v136, v137, v138
v_max3_f32 v234, v234, v139, v243
v_mov_b32 v243, v234
s_nop 1
v_permlane32_swap_b32 v234, v243
s_nop 1
v_max_f32 v234, v234, v243
v_mov_b32 v243, v234
s_nop 1
v_permlane16_swap_b32 v234, v243
s_nop 1
v_max_f32 v234, v234, v243
v_ceil_f32 v234, v234
v_max_f32 v234, 0, v234
v_sub_f32 v243, 0, v234
v_exp_f32 v238, v243
s_nop 1
v_mul_f32 v226, v226, v238
v_add_f32 v246, v246, v234
v_sub_f32 v200, v200, v234
v_sub_f32 v136, v136, v234
v_sub_f32 v152, v152, v234
v_sub_f32 v201, v201, v234
v_sub_f32 v137, v137, v234
v_sub_f32 v153, v153, v234
v_sub_f32 v202, v202, v234
v_sub_f32 v138, v138, v234
v_sub_f32 v154, v154, v234
v_sub_f32 v203, v203, v234
v_sub_f32 v139, v139, v234
v_sub_f32 v155, v155, v234
v_lshlrev_b32 v242, 16, v68
v_and_b32 v243, 0xffff0000, v68
v_mul_f32 v242, v242, v238
v_mul_f32 v243, v243, v238
v_cvt_pk_bf16_f32 v68, v242, v243
v_lshlrev_b32 v242, 16, v69
v_and_b32 v243, 0xffff0000, v69
v_mul_f32 v242, v242, v238
v_mul_f32 v243, v243, v238
v_cvt_pk_bf16_f32 v69, v242, v243
v_lshlrev_b32 v242, 16, v70
v_and_b32 v243, 0xffff0000, v70
v_mul_f32 v242, v242, v238
v_mul_f32 v243, v243, v238
v_cvt_pk_bf16_f32 v70, v242, v243
v_lshlrev_b32 v242, 16, v71
v_and_b32 v243, 0xffff0000, v71
v_mul_f32 v242, v242, v238
v_mul_f32 v243, v243, v238
v_cvt_pk_bf16_f32 v71, v242, v243
v_lshlrev_b32 v242, 16, v72
v_and_b32 v243, 0xffff0000, v72
v_mul_f32 v242, v242, v238
v_mul_f32 v243, v243, v238
v_cvt_pk_bf16_f32 v72, v242, v243
v_lshlrev_b32 v242, 16, v73
v_and_b32 v243, 0xffff0000, v73
v_mul_f32 v242, v242, v238
v_mul_f32 v243, v243, v238
v_cvt_pk_bf16_f32 v73, v242, v243
v_lshlrev_b32 v242, 16, v74
v_and_b32 v243, 0xffff0000, v74
v_mul_f32 v242, v242, v238
v_mul_f32 v243, v243, v238
v_cvt_pk_bf16_f32 v74, v242, v243
v_lshlrev_b32 v242, 16, v75
v_and_b32 v243, 0xffff0000, v75
v_mul_f32 v242, v242, v238
v_mul_f32 v243, v243, v238
v_cvt_pk_bf16_f32 v75, v242, v243
v_lshlrev_b32 v242, 16, v168
v_and_b32 v243, 0xffff0000, v168
v_mul_f32 v242, v242, v238
v_mul_f32 v243, v243, v238
v_cvt_pk_bf16_f32 v168, v242, v243
v_lshlrev_b32 v242, 16, v169
v_and_b32 v243, 0xffff0000, v169
v_mul_f32 v242, v242, v238
v_mul_f32 v243, v243, v238
v_cvt_pk_bf16_f32 v169, v242, v243
v_lshlrev_b32 v242, 16, v170
v_and_b32 v243, 0xffff0000, v170
v_mul_f32 v242, v242, v238
v_mul_f32 v243, v243, v238
v_cvt_pk_bf16_f32 v170, v242, v243
v_lshlrev_b32 v242, 16, v171
v_and_b32 v243, 0xffff0000, v171
v_mul_f32 v242, v242, v238
v_mul_f32 v243, v243, v238
v_cvt_pk_bf16_f32 v171, v242, v243
v_lshlrev_b32 v242, 16, v184
v_and_b32 v243, 0xffff0000, v184
v_mul_f32 v242, v242, v238
v_mul_f32 v243, v243, v238
v_cvt_pk_bf16_f32 v184, v242, v243
v_lshlrev_b32 v242, 16, v185
v_and_b32 v243, 0xffff0000, v185
v_mul_f32 v242, v242, v238
v_mul_f32 v243, v243, v238
v_cvt_pk_bf16_f32 v185, v242, v243
v_lshlrev_b32 v242, 16, v186
v_and_b32 v243, 0xffff0000, v186
v_mul_f32 v242, v242, v238
v_mul_f32 v243, v243, v238
v_cvt_pk_bf16_f32 v186, v242, v243
v_lshlrev_b32 v242, 16, v187
v_and_b32 v243, 0xffff0000, v187
v_mul_f32 v242, v242, v238
v_mul_f32 v243, v243, v238
v_cvt_pk_bf16_f32 v187, v242, v243
v_log_f32 v243, v227
v_max3_f32 v235, v140, v141, v142
v_max3_f32 v235, v235, v143, v243
v_mov_b32 v243, v235
s_nop 1
v_permlane32_swap_b32 v235, v243
s_nop 1
v_max_f32 v235, v235, v243
v_mov_b32 v243, v235
s_nop 1
v_permlane16_swap_b32 v235, v243
s_nop 1
v_max_f32 v235, v235, v243
v_ceil_f32 v235, v235
v_max_f32 v235, 0, v235
v_sub_f32 v243, 0, v235
v_exp_f32 v239, v243
s_nop 1
v_mul_f32 v227, v227, v239
v_add_f32 v247, v247, v235
v_sub_f32 v204, v204, v235
v_sub_f32 v140, v140, v235
v_sub_f32 v156, v156, v235
v_sub_f32 v205, v205, v235
v_sub_f32 v141, v141, v235
v_sub_f32 v157, v157, v235
v_sub_f32 v206, v206, v235
v_sub_f32 v142, v142, v235
v_sub_f32 v158, v158, v235
v_sub_f32 v207, v207, v235
v_sub_f32 v143, v143, v235
v_sub_f32 v159, v159, v235
v_lshlrev_b32 v242, 16, v100
v_and_b32 v243, 0xffff0000, v100
v_mul_f32 v242, v242, v239
v_mul_f32 v243, v243, v239
v_cvt_pk_bf16_f32 v100, v242, v243
v_lshlrev_b32 v242, 16, v101
v_and_b32 v243, 0xffff0000, v101
v_mul_f32 v242, v242, v239
v_mul_f32 v243, v243, v239
v_cvt_pk_bf16_f32 v101, v242, v243
v_lshlrev_b32 v242, 16, v102
v_and_b32 v243, 0xffff0000, v102
v_mul_f32 v242, v242, v239
v_mul_f32 v243, v243, v239
v_cvt_pk_bf16_f32 v102, v242, v243
v_lshlrev_b32 v242, 16, v103
v_and_b32 v243, 0xffff0000, v103
v_mul_f32 v242, v242, v239
v_mul_f32 v243, v243, v239
v_cvt_pk_bf16_f32 v103, v242, v243
v_lshlrev_b32 v242, 16, v104
v_and_b32 v243, 0xffff0000, v104
v_mul_f32 v242, v242, v239
v_mul_f32 v243, v243, v239
v_cvt_pk_bf16_f32 v104, v242, v243
v_lshlrev_b32 v242, 16, v105
v_and_b32 v243, 0xffff0000, v105
v_mul_f32 v242, v242, v239
v_mul_f32 v243, v243, v239
v_cvt_pk_bf16_f32 v105, v242, v243
v_lshlrev_b32 v242, 16, v106
v_and_b32 v243, 0xffff0000, v106
v_mul_f32 v242, v242, v239
v_mul_f32 v243, v243, v239
v_cvt_pk_bf16_f32 v106, v242, v243
v_lshlrev_b32 v242, 16, v107
v_and_b32 v243, 0xffff0000, v107
v_mul_f32 v242, v242, v239
v_mul_f32 v243, v243, v239
v_cvt_pk_bf16_f32 v107, v242, v243
v_lshlrev_b32 v242, 16, v172
v_and_b32 v243, 0xffff0000, v172
v_mul_f32 v242, v242, v239
v_mul_f32 v243, v243, v239
v_cvt_pk_bf16_f32 v172, v242, v243
v_lshlrev_b32 v242, 16, v173
v_and_b32 v243, 0xffff0000, v173
v_mul_f32 v242, v242, v239
v_mul_f32 v243, v243, v239
v_cvt_pk_bf16_f32 v173, v242, v243
v_lshlrev_b32 v242, 16, v174
v_and_b32 v243, 0xffff0000, v174
v_mul_f32 v242, v242, v239
v_mul_f32 v243, v243, v239
v_cvt_pk_bf16_f32 v174, v242, v243
v_lshlrev_b32 v242, 16, v175
v_and_b32 v243, 0xffff0000, v175
v_mul_f32 v242, v242, v239
v_mul_f32 v243, v243, v239
v_cvt_pk_bf16_f32 v175, v242, v243
v_lshlrev_b32 v242, 16, v188
v_and_b32 v243, 0xffff0000, v188
v_mul_f32 v242, v242, v239
v_mul_f32 v243, v243, v239
v_cvt_pk_bf16_f32 v188, v242, v243
v_lshlrev_b32 v242, 16, v189
v_and_b32 v243, 0xffff0000, v189
v_mul_f32 v242, v242, v239
v_mul_f32 v243, v243, v239
v_cvt_pk_bf16_f32 v189, v242, v243
v_lshlrev_b32 v242, 16, v190
v_and_b32 v243, 0xffff0000, v190
v_mul_f32 v242, v242, v239
v_mul_f32 v243, v243, v239
v_cvt_pk_bf16_f32 v190, v242, v243
v_lshlrev_b32 v242, 16, v191
v_and_b32 v243, 0xffff0000, v191
v_mul_f32 v242, v242, v239
v_mul_f32 v243, v243, v239
v_cvt_pk_bf16_f32 v191, v242, v243
v_exp_f32 v232, v128
v_exp_f32 v233, v129
v_exp_f32 v234, v130
v_exp_f32 v235, v131
s_nop 1
v_add_f32 v228, v224, v232
v_add_f32 v228, v228, v233
v_add_f32 v228, v228, v234
v_add_f32 v228, v228, v235
v_cvt_pk_bf16_f32 v0, v232, v233
v_cvt_pk_bf16_f32 v1, v234, v235
v_exp_f32 v232, v132
v_exp_f32 v233, v133
v_exp_f32 v234, v134
v_exp_f32 v235, v135
s_nop 1
v_add_f32 v229, v225, v232
v_add_f32 v229, v229, v233
v_add_f32 v229, v229, v234
v_add_f32 v229, v229, v235
v_cvt_pk_bf16_f32 v32, v232, v233
v_cvt_pk_bf16_f32 v33, v234, v235
v_exp_f32 v232, v136
v_exp_f32 v233, v137
v_exp_f32 v234, v138
v_exp_f32 v235, v139
s_nop 1
v_add_f32 v230, v226, v232
v_add_f32 v230, v230, v233
v_add_f32 v230, v230, v234
v_add_f32 v230, v230, v235
v_cvt_pk_bf16_f32 v64, v232, v233
v_cvt_pk_bf16_f32 v65, v234, v235
v_exp_f32 v232, v140
v_exp_f32 v233, v141
v_exp_f32 v234, v142
v_exp_f32 v235, v143
s_nop 1
v_add_f32 v231, v227, v232
v_add_f32 v231, v231, v233
v_add_f32 v231, v231, v234
v_add_f32 v231, v231, v235
v_cvt_pk_bf16_f32 v96, v232, v233
v_cvt_pk_bf16_f32 v97, v234, v235
s_branch L2_rare_common
L2_rare_site11:
s_mov_b32 s36, 11
s_branch L2_rare_t0_7_1
L2_rare_t0_7_1:
s_nop 15
s_nop 15
s_waitcnt lgkmcnt(0)
v_log_f32 v243, v228
v_max3_f32 v232, v144, v145, v146
v_max3_f32 v232, v232, v147, v243
v_mov_b32 v243, v232
s_nop 1
v_permlane32_swap_b32 v232, v243
s_nop 1
v_max_f32 v232, v232, v243
v_mov_b32 v243, v232
s_nop 1
v_permlane16_swap_b32 v232, v243
s_nop 1
v_max_f32 v232, v232, v243
v_ceil_f32 v232, v232
v_max_f32 v232, 0, v232
v_sub_f32 v243, 0, v232
v_exp_f32 v236, v243
s_nop 1
v_mul_f32 v228, v228, v236
v_add_f32 v244, v244, v232
v_sub_f32 v192, v192, v232
v_sub_f32 v128, v128, v232
v_sub_f32 v144, v144, v232
v_sub_f32 v193, v193, v232
v_sub_f32 v129, v129, v232
v_sub_f32 v145, v145, v232
v_sub_f32 v194, v194, v232
v_sub_f32 v130, v130, v232
v_sub_f32 v146, v146, v232
v_sub_f32 v195, v195, v232
v_sub_f32 v131, v131, v232
v_sub_f32 v147, v147, v232
v_lshlrev_b32 v242, 16, v4
v_and_b32 v243, 0xffff0000, v4
v_mul_f32 v242, v242, v236
v_mul_f32 v243, v243, v236
v_cvt_pk_bf16_f32 v4, v242, v243
v_lshlrev_b32 v242, 16, v5
v_and_b32 v243, 0xffff0000, v5
v_mul_f32 v242, v242, v236
v_mul_f32 v243, v243, v236
v_cvt_pk_bf16_f32 v5, v242, v243
v_lshlrev_b32 v242, 16, v6
v_and_b32 v243, 0xffff0000, v6
v_mul_f32 v242, v242, v236
v_mul_f32 v243, v243, v236
v_cvt_pk_bf16_f32 v6, v242, v243
v_lshlrev_b32 v242, 16, v7
v_and_b32 v243, 0xffff0000, v7
v_mul_f32 v242, v242, v236
v_mul_f32 v243, v243, v236
v_cvt_pk_bf16_f32 v7, v242, v243
v_lshlrev_b32 v242, 16, v8
v_and_b32 v243, 0xffff0000, v8
v_mul_f32 v242, v242, v236
v_mul_f32 v243, v243, v236
v_cvt_pk_bf16_f32 v8, v242, v243
v_lshlrev_b32 v242, 16, v9
v_and_b32 v243, 0xffff0000, v9
v_mul_f32 v242, v242, v236
v_mul_f32 v243, v243, v236
v_cvt_pk_bf16_f32 v9, v242, v243
v_lshlrev_b32 v242, 16, v10
v_and_b32 v243, 0xffff0000, v10
v_mul_f32 v242, v242, v236
v_mul_f32 v243, v243, v236
v_cvt_pk_bf16_f32 v10, v242, v243
v_lshlrev_b32 v242, 16, v11
v_and_b32 v243, 0xffff0000, v11
v_mul_f32 v242, v242, v236
v_mul_f32 v243, v243, v236
v_cvt_pk_bf16_f32 v11, v242, v243
v_lshlrev_b32 v242, 16, v160
v_and_b32 v243, 0xffff0000, v160
v_mul_f32 v242, v242, v236
v_mul_f32 v243, v243, v236
v_cvt_pk_bf16_f32 v160, v242, v243
v_lshlrev_b32 v242, 16, v161
v_and_b32 v243, 0xffff0000, v161
v_mul_f32 v242, v242, v236
v_mul_f32 v243, v243, v236
v_cvt_pk_bf16_f32 v161, v242, v243
v_lshlrev_b32 v242, 16, v162
v_and_b32 v243, 0xffff0000, v162
v_mul_f32 v242, v242, v236
v_mul_f32 v243, v243, v236
v_cvt_pk_bf16_f32 v162, v242, v243
v_lshlrev_b32 v242, 16, v163
v_and_b32 v243, 0xffff0000, v163
v_mul_f32 v242, v242, v236
v_mul_f32 v243, v243, v236
v_cvt_pk_bf16_f32 v163, v242, v243
v_lshlrev_b32 v242, 16, v176
v_and_b32 v243, 0xffff0000, v176
v_mul_f32 v242, v242, v236
v_mul_f32 v243, v243, v236
v_cvt_pk_bf16_f32 v176, v242, v243
v_lshlrev_b32 v242, 16, v177
v_and_b32 v243, 0xffff0000, v177
v_mul_f32 v242, v242, v236
v_mul_f32 v243, v243, v236
v_cvt_pk_bf16_f32 v177, v242, v243
v_lshlrev_b32 v242, 16, v178
v_and_b32 v243, 0xffff0000, v178
v_mul_f32 v242, v242, v236
v_mul_f32 v243, v243, v236
v_cvt_pk_bf16_f32 v178, v242, v243
v_lshlrev_b32 v242, 16, v179
v_and_b32 v243, 0xffff0000, v179
v_mul_f32 v242, v242, v236
v_mul_f32 v243, v243, v236
v_cvt_pk_bf16_f32 v179, v242, v243
v_lshlrev_b32 v242, 16, v0
v_and_b32 v243, 0xffff0000, v0
v_mul_f32 v242, v242, v236
v_mul_f32 v243, v243, v236
v_cvt_pk_bf16_f32 v0, v242, v243
v_lshlrev_b32 v242, 16, v1
v_and_b32 v243, 0xffff0000, v1
v_mul_f32 v242, v242, v236
v_mul_f32 v243, v243, v236
v_cvt_pk_bf16_f32 v1, v242, v243
v_log_f32 v243, v229
v_max3_f32 v233, v148, v149, v150
v_max3_f32 v233, v233, v151, v243
v_mov_b32 v243, v233
s_nop 1
v_permlane32_swap_b32 v233, v243
s_nop 1
v_max_f32 v233, v233, v243
v_mov_b32 v243, v233
s_nop 1
v_permlane16_swap_b32 v233, v243
s_nop 1
v_max_f32 v233, v233, v243
v_ceil_f32 v233, v233
v_max_f32 v233, 0, v233
v_sub_f32 v243, 0, v233
v_exp_f32 v237, v243
s_nop 1
v_mul_f32 v229, v229, v237
v_add_f32 v245, v245, v233
v_sub_f32 v196, v196, v233
v_sub_f32 v132, v132, v233
v_sub_f32 v148, v148, v233
v_sub_f32 v197, v197, v233
v_sub_f32 v133, v133, v233
v_sub_f32 v149, v149, v233
v_sub_f32 v198, v198, v233
v_sub_f32 v134, v134, v233
v_sub_f32 v150, v150, v233
v_sub_f32 v199, v199, v233
v_sub_f32 v135, v135, v233
v_sub_f32 v151, v151, v233
v_lshlrev_b32 v242, 16, v36
v_and_b32 v243, 0xffff0000, v36
v_mul_f32 v242, v242, v237
v_mul_f32 v243, v243, v237
v_cvt_pk_bf16_f32 v36, v242, v243
v_lshlrev_b32 v242, 16, v37
v_and_b32 v243, 0xffff0000, v37
v_mul_f32 v242, v242, v237
v_mul_f32 v243, v243, v237
v_cvt_pk_bf16_f32 v37, v242, v243
v_lshlrev_b32 v242, 16, v38
v_and_b32 v243, 0xffff0000, v38
v_mul_f32 v242, v242, v237
v_mul_f32 v243, v243, v237
v_cvt_pk_bf16_f32 v38, v242, v243
v_lshlrev_b32 v242, 16, v39
v_and_b32 v243, 0xffff0000, v39
v_mul_f32 v242, v242, v237
v_mul_f32 v243, v243, v237
v_cvt_pk_bf16_f32 v39, v242, v243
v_lshlrev_b32 v242, 16, v40
v_and_b32 v243, 0xffff0000, v40
v_mul_f32 v242, v242, v237
v_mul_f32 v243, v243, v237
v_cvt_pk_bf16_f32 v40, v242, v243
v_lshlrev_b32 v242, 16, v41
v_and_b32 v243, 0xffff0000, v41
v_mul_f32 v242, v242, v237
v_mul_f32 v243, v243, v237
v_cvt_pk_bf16_f32 v41, v242, v243
v_lshlrev_b32 v242, 16, v42
v_and_b32 v243, 0xffff0000, v42
v_mul_f32 v242, v242, v237
v_mul_f32 v243, v243, v237
v_cvt_pk_bf16_f32 v42, v242, v243
v_lshlrev_b32 v242, 16, v43
v_and_b32 v243, 0xffff0000, v43
v_mul_f32 v242, v242, v237
v_mul_f32 v243, v243, v237
v_cvt_pk_bf16_f32 v43, v242, v243
v_lshlrev_b32 v242, 16, v164
v_and_b32 v243, 0xffff0000, v164
v_mul_f32 v242, v242, v237
v_mul_f32 v243, v243, v237
v_cvt_pk_bf16_f32 v164, v242, v243
v_lshlrev_b32 v242, 16, v165
v_and_b32 v243, 0xffff0000, v165
v_mul_f32 v242, v242, v237
v_mul_f32 v243, v243, v237
v_cvt_pk_bf16_f32 v165, v242, v243
v_lshlrev_b32 v242, 16, v166
v_and_b32 v243, 0xffff0000, v166
v_mul_f32 v242, v242, v237
v_mul_f32 v243, v243, v237
v_cvt_pk_bf16_f32 v166, v242, v243
v_lshlrev_b32 v242, 16, v167
v_and_b32 v243, 0xffff0000, v167
v_mul_f32 v242, v242, v237
v_mul_f32 v243, v243, v237
v_cvt_pk_bf16_f32 v167, v242, v243
v_lshlrev_b32 v242, 16, v180
v_and_b32 v243, 0xffff0000, v180
v_mul_f32 v242, v242, v237
v_mul_f32 v243, v243, v237
v_cvt_pk_bf16_f32 v180, v242, v243
v_lshlrev_b32 v242, 16, v181
v_and_b32 v243, 0xffff0000, v181
v_mul_f32 v242, v242, v237
v_mul_f32 v243, v243, v237
v_cvt_pk_bf16_f32 v181, v242, v243
v_lshlrev_b32 v242, 16, v182
v_and_b32 v243, 0xffff0000, v182
v_mul_f32 v242, v242, v237
v_mul_f32 v243, v243, v237
v_cvt_pk_bf16_f32 v182, v242, v243
v_lshlrev_b32 v242, 16, v183
v_and_b32 v243, 0xffff0000, v183
v_mul_f32 v242, v242, v237
v_mul_f32 v243, v243, v237
v_cvt_pk_bf16_f32 v183, v242, v243
v_lshlrev_b32 v242, 16, v32
v_and_b32 v243, 0xffff0000, v32
v_mul_f32 v242, v242, v237
v_mul_f32 v243, v243, v237
v_cvt_pk_bf16_f32 v32, v242, v243
v_lshlrev_b32 v242, 16, v33
v_and_b32 v243, 0xffff0000, v33
v_mul_f32 v242, v242, v237
v_mul_f32 v243, v243, v237
v_cvt_pk_bf16_f32 v33, v242, v243
v_log_f32 v243, v230
v_max3_f32 v234, v152, v153, v154
v_max3_f32 v234, v234, v155, v243
v_mov_b32 v243, v234
s_nop 1
v_permlane32_swap_b32 v234, v243
s_nop 1
v_max_f32 v234, v234, v243
v_mov_b32 v243, v234
s_nop 1
v_permlane16_swap_b32 v234, v243
s_nop 1
v_max_f32 v234, v234, v243
v_ceil_f32 v234, v234
v_max_f32 v234, 0, v234
v_sub_f32 v243, 0, v234
v_exp_f32 v238, v243
s_nop 1
v_mul_f32 v230, v230, v238
v_add_f32 v246, v246, v234
v_sub_f32 v200, v200, v234
v_sub_f32 v136, v136, v234
v_sub_f32 v152, v152, v234
v_sub_f32 v201, v201, v234
v_sub_f32 v137, v137, v234
v_sub_f32 v153, v153, v234
v_sub_f32 v202, v202, v234
v_sub_f32 v138, v138, v234
v_sub_f32 v154, v154, v234
v_sub_f32 v203, v203, v234
v_sub_f32 v139, v139, v234
v_sub_f32 v155, v155, v234
v_lshlrev_b32 v242, 16, v68
v_and_b32 v243, 0xffff0000, v68
v_mul_f32 v242, v242, v238
v_mul_f32 v243, v243, v238
v_cvt_pk_bf16_f32 v68, v242, v243
v_lshlrev_b32 v242, 16, v69
v_and_b32 v243, 0xffff0000, v69
v_mul_f32 v242, v242, v238
v_mul_f32 v243, v243, v238
v_cvt_pk_bf16_f32 v69, v242, v243
v_lshlrev_b32 v242, 16, v70
v_and_b32 v243, 0xffff0000, v70
v_mul_f32 v242, v242, v238
v_mul_f32 v243, v243, v238
v_cvt_pk_bf16_f32 v70, v242, v243
v_lshlrev_b32 v242, 16, v71
v_and_b32 v243, 0xffff0000, v71
v_mul_f32 v242, v242, v238
v_mul_f32 v243, v243, v238
v_cvt_pk_bf16_f32 v71, v242, v243
v_lshlrev_b32 v242, 16, v72
v_and_b32 v243, 0xffff0000, v72
v_mul_f32 v242, v242, v238
v_mul_f32 v243, v243, v238
v_cvt_pk_bf16_f32 v72, v242, v243
v_lshlrev_b32 v242, 16, v73
v_and_b32 v243, 0xffff0000, v73
v_mul_f32 v242, v242, v238
v_mul_f32 v243, v243, v238
v_cvt_pk_bf16_f32 v73, v242, v243
v_lshlrev_b32 v242, 16, v74
v_and_b32 v243, 0xffff0000, v74
v_mul_f32 v242, v242, v238
v_mul_f32 v243, v243, v238
v_cvt_pk_bf16_f32 v74, v242, v243
v_lshlrev_b32 v242, 16, v75
v_and_b32 v243, 0xffff0000, v75
v_mul_f32 v242, v242, v238
v_mul_f32 v243, v243, v238
v_cvt_pk_bf16_f32 v75, v242, v243
v_lshlrev_b32 v242, 16, v168
v_and_b32 v243, 0xffff0000, v168
v_mul_f32 v242, v242, v238
v_mul_f32 v243, v243, v238
v_cvt_pk_bf16_f32 v168, v242, v243
v_lshlrev_b32 v242, 16, v169
v_and_b32 v243, 0xffff0000, v169
v_mul_f32 v242, v242, v238
v_mul_f32 v243, v243, v238
v_cvt_pk_bf16_f32 v169, v242, v243
v_lshlrev_b32 v242, 16, v170
v_and_b32 v243, 0xffff0000, v170
v_mul_f32 v242, v242, v238
v_mul_f32 v243, v243, v238
v_cvt_pk_bf16_f32 v170, v242, v243
v_lshlrev_b32 v242, 16, v171
v_and_b32 v243, 0xffff0000, v171
v_mul_f32 v242, v242, v238
v_mul_f32 v243, v243, v238
v_cvt_pk_bf16_f32 v171, v242, v243
v_lshlrev_b32 v242, 16, v184
v_and_b32 v243, 0xffff0000, v184
v_mul_f32 v242, v242, v238
v_mul_f32 v243, v243, v238
v_cvt_pk_bf16_f32 v184, v242, v243
v_lshlrev_b32 v242, 16, v185
v_and_b32 v243, 0xffff0000, v185
v_mul_f32 v242, v242, v238
v_mul_f32 v243, v243, v238
v_cvt_pk_bf16_f32 v185, v242, v243
v_lshlrev_b32 v242, 16, v186
v_and_b32 v243, 0xffff0000, v186
v_mul_f32 v242, v242, v238
v_mul_f32 v243, v243, v238
v_cvt_pk_bf16_f32 v186, v242, v243
v_lshlrev_b32 v242, 16, v187
v_and_b32 v243, 0xffff0000, v187
v_mul_f32 v242, v242, v238
v_mul_f32 v243, v243, v238
v_cvt_pk_bf16_f32 v187, v242, v243
v_lshlrev_b32 v242, 16, v64
v_and_b32 v243, 0xffff0000, v64
v_mul_f32 v242, v242, v238
v_mul_f32 v243, v243, v238
v_cvt_pk_bf16_f32 v64, v242, v243
v_lshlrev_b32 v242, 16, v65
v_and_b32 v243, 0xffff0000, v65
v_mul_f32 v242, v242, v238
v_mul_f32 v243, v243, v238
v_cvt_pk_bf16_f32 v65, v242, v243
v_log_f32 v243, v231
v_max3_f32 v235, v156, v157, v158
v_max3_f32 v235, v235, v159, v243
v_mov_b32 v243, v235
s_nop 1
v_permlane32_swap_b32 v235, v243
s_nop 1
v_max_f32 v235, v235, v243
v_mov_b32 v243, v235
s_nop 1
v_permlane16_swap_b32 v235, v243
s_nop 1
v_max_f32 v235, v235, v243
v_ceil_f32 v235, v235
v_max_f32 v235, 0, v235
v_sub_f32 v243, 0, v235
v_exp_f32 v239, v243
s_nop 1
v_mul_f32 v231, v231, v239
v_add_f32 v247, v247, v235
v_sub_f32 v204, v204, v235
v_sub_f32 v140, v140, v235
v_sub_f32 v156, v156, v235
v_sub_f32 v205, v205, v235
v_sub_f32 v141, v141, v235
v_sub_f32 v157, v157, v235
v_sub_f32 v206, v206, v235
v_sub_f32 v142, v142, v235
v_sub_f32 v158, v158, v235
v_sub_f32 v207, v207, v235
v_sub_f32 v143, v143, v235
v_sub_f32 v159, v159, v235
v_lshlrev_b32 v242, 16, v100
v_and_b32 v243, 0xffff0000, v100
v_mul_f32 v242, v242, v239
v_mul_f32 v243, v243, v239
v_cvt_pk_bf16_f32 v100, v242, v243
v_lshlrev_b32 v242, 16, v101
v_and_b32 v243, 0xffff0000, v101
v_mul_f32 v242, v242, v239
v_mul_f32 v243, v243, v239
v_cvt_pk_bf16_f32 v101, v242, v243
v_lshlrev_b32 v242, 16, v102
v_and_b32 v243, 0xffff0000, v102
v_mul_f32 v242, v242, v239
v_mul_f32 v243, v243, v239
v_cvt_pk_bf16_f32 v102, v242, v243
v_lshlrev_b32 v242, 16, v103
v_and_b32 v243, 0xffff0000, v103
v_mul_f32 v242, v242, v239
v_mul_f32 v243, v243, v239
v_cvt_pk_bf16_f32 v103, v242, v243
v_lshlrev_b32 v242, 16, v104
v_and_b32 v243, 0xffff0000, v104
v_mul_f32 v242, v242, v239
v_mul_f32 v243, v243, v239
v_cvt_pk_bf16_f32 v104, v242, v243
v_lshlrev_b32 v242, 16, v105
v_and_b32 v243, 0xffff0000, v105
v_mul_f32 v242, v242, v239
v_mul_f32 v243, v243, v239
v_cvt_pk_bf16_f32 v105, v242, v243
v_lshlrev_b32 v242, 16, v106
v_and_b32 v243, 0xffff0000, v106
v_mul_f32 v242, v242, v239
v_mul_f32 v243, v243, v239
v_cvt_pk_bf16_f32 v106, v242, v243
v_lshlrev_b32 v242, 16, v107
v_and_b32 v243, 0xffff0000, v107
v_mul_f32 v242, v242, v239
v_mul_f32 v243, v243, v239
v_cvt_pk_bf16_f32 v107, v242, v243
v_lshlrev_b32 v242, 16, v172
v_and_b32 v243, 0xffff0000, v172
v_mul_f32 v242, v242, v239
v_mul_f32 v243, v243, v239
v_cvt_pk_bf16_f32 v172, v242, v243
v_lshlrev_b32 v242, 16, v173
v_and_b32 v243, 0xffff0000, v173
v_mul_f32 v242, v242, v239
v_mul_f32 v243, v243, v239
v_cvt_pk_bf16_f32 v173, v242, v243
v_lshlrev_b32 v242, 16, v174
v_and_b32 v243, 0xffff0000, v174
v_mul_f32 v242, v242, v239
v_mul_f32 v243, v243, v239
v_cvt_pk_bf16_f32 v174, v242, v243
v_lshlrev_b32 v242, 16, v175
v_and_b32 v243, 0xffff0000, v175
v_mul_f32 v242, v242, v239
v_mul_f32 v243, v243, v239
v_cvt_pk_bf16_f32 v175, v242, v243
v_lshlrev_b32 v242, 16, v188
v_and_b32 v243, 0xffff0000, v188
v_mul_f32 v242, v242, v239
v_mul_f32 v243, v243, v239
v_cvt_pk_bf16_f32 v188, v242, v243
v_lshlrev_b32 v242, 16, v189
v_and_b32 v243, 0xffff0000, v189
v_mul_f32 v242, v242, v239
v_mul_f32 v243, v243, v239
v_cvt_pk_bf16_f32 v189, v242, v243
v_lshlrev_b32 v242, 16, v190
v_and_b32 v243, 0xffff0000, v190
v_mul_f32 v242, v242, v239
v_mul_f32 v243, v243, v239
v_cvt_pk_bf16_f32 v190, v242, v243
v_lshlrev_b32 v242, 16, v191
v_and_b32 v243, 0xffff0000, v191
v_mul_f32 v242, v242, v239
v_mul_f32 v243, v243, v239
v_cvt_pk_bf16_f32 v191, v242, v243
v_lshlrev_b32 v242, 16, v96
v_and_b32 v243, 0xffff0000, v96
v_mul_f32 v242, v242, v239
v_mul_f32 v243, v243, v239
v_cvt_pk_bf16_f32 v96, v242, v243
v_lshlrev_b32 v242, 16, v97
v_and_b32 v243, 0xffff0000, v97
v_mul_f32 v242, v242, v239
v_mul_f32 v243, v243, v239
v_cvt_pk_bf16_f32 v97, v242, v243
v_exp_f32 v232, v144
v_exp_f32 v233, v145
v_exp_f32 v234, v146
v_exp_f32 v235, v147
s_nop 1
v_add_f32 v224, v228, v232
v_add_f32 v224, v224, v233
v_add_f32 v224, v224, v234
v_add_f32 v224, v224, v235
v_cvt_pk_bf16_f32 v2, v232, v233
v_cvt_pk_bf16_f32 v3, v234, v235
v_exp_f32 v232, v148
v_exp_f32 v233, v149
v_exp_f32 v234, v150
v_exp_f32 v235, v151
s_nop 1
v_add_f32 v225, v229, v232
v_add_f32 v225, v225, v233
v_add_f32 v225, v225, v234
v_add_f32 v225, v225, v235
v_cvt_pk_bf16_f32 v34, v232, v233
v_cvt_pk_bf16_f32 v35, v234, v235
v_exp_f32 v232, v152
v_exp_f32 v233, v153
v_exp_f32 v234, v154
v_exp_f32 v235, v155
s_nop 1
v_add_f32 v226, v230, v232
v_add_f32 v226, v226, v233
v_add_f32 v226, v226, v234
v_add_f32 v226, v226, v235
v_cvt_pk_bf16_f32 v66, v232, v233
v_cvt_pk_bf16_f32 v67, v234, v235
v_exp_f32 v232, v156
v_exp_f32 v233, v157
v_exp_f32 v234, v158
v_exp_f32 v235, v159
s_nop 1
v_add_f32 v227, v231, v232
v_add_f32 v227, v227, v233
v_add_f32 v227, v227, v234
v_add_f32 v227, v227, v235
v_cvt_pk_bf16_f32 v98, v232, v233
v_cvt_pk_bf16_f32 v99, v234, v235
s_branch L2_rare_common
LF_hl_0:
s_mov_b32 s94, 0x10000
s_mov_b32 s3, 0x7c28000
LF_hl2_0:
v_lshlrev_b32 v241, 3, v248
buffer_load_dwordx2 v[240:241], v241, s[16:19], s3 offen sc1
s_sub_u32 s94, s94, 1
s_waitcnt vmcnt(0)
s_cbranch_scc1 LF_hlret_0
v_cmp_ne_u64_e64 s[38:39], s[98:99], v[240:241]
s_and_b64 s[38:39], s[38:39], s[96:97]
s_cbranch_scc1 LF_hl2_0
s_branch LF_hlret_0
L2_rare_site12:
s_mov_b32 s36, 12
s_branch L2_rare_t1_0_0
L2_rare_t1_0_0:
s_nop 15
s_nop 15
s_waitcnt lgkmcnt(0)
v_log_f32 v243, v224
v_max3_f32 v232, v128, v129, v130
v_max3_f32 v232, v232, v131, v243
v_mov_b32 v243, v232
s_nop 1
v_permlane32_swap_b32 v232, v243
s_nop 1
v_max_f32 v232, v232, v243
v_mov_b32 v243, v232
s_nop 1
v_permlane16_swap_b32 v232, v243
s_nop 1
v_max_f32 v232, v232, v243
v_ceil_f32 v232, v232
v_max_f32 v232, 0, v232
v_sub_f32 v243, 0, v232
v_exp_f32 v236, v243
s_nop 1
v_mul_f32 v224, v224, v236
v_add_f32 v244, v244, v232
v_sub_f32 v192, v192, v232
v_sub_f32 v128, v128, v232
v_sub_f32 v144, v144, v232
v_sub_f32 v193, v193, v232
v_sub_f32 v129, v129, v232
v_sub_f32 v145, v145, v232
v_sub_f32 v194, v194, v232
v_sub_f32 v130, v130, v232
v_sub_f32 v146, v146, v232
v_sub_f32 v195, v195, v232
v_sub_f32 v131, v131, v232
v_sub_f32 v147, v147, v232
ds_read_b64 v[254:255], v253 offset:0
s_waitcnt lgkmcnt(0)
v_lshlrev_b32 v242, 16, v254
v_and_b32 v243, 0xffff0000, v254
v_mul_f32 v242, v242, v236
v_mul_f32 v243, v243, v236
v_cvt_pk_bf16_f32 v254, v242, v243
v_lshlrev_b32 v242, 16, v255
v_and_b32 v243, 0xffff0000, v255
v_mul_f32 v242, v242, v236
v_mul_f32 v243, v243, v236
v_cvt_pk_bf16_f32 v255, v242, v243
ds_write_b64 v253, v[254:255] offset:0
s_waitcnt lgkmcnt(0)
ds_read_b64 v[254:255], v253 offset:8
s_waitcnt lgkmcnt(0)
v_lshlrev_b32 v242, 16, v254
v_and_b32 v243, 0xffff0000, v254
v_mul_f32 v242, v242, v236
v_mul_f32 v243, v243, v236
v_cvt_pk_bf16_f32 v254, v242, v243
v_lshlrev_b32 v242, 16, v255
v_and_b32 v243, 0xffff0000, v255
v_mul_f32 v242, v242, v236
v_mul_f32 v243, v243, v236
v_cvt_pk_bf16_f32 v255, v242, v243
ds_write_b64 v253, v[254:255] offset:8
s_waitcnt lgkmcnt(0)
v_log_f32 v243, v225
v_max3_f32 v233, v132, v133, v134
v_max3_f32 v233, v233, v135, v243
v_mov_b32 v243, v233
s_nop 1
v_permlane32_swap_b32 v233, v243
s_nop 1
v_max_f32 v233, v233, v243
v_mov_b32 v243, v233
s_nop 1
v_permlane16_swap_b32 v233, v243
s_nop 1
v_max_f32 v233, v233, v243
v_ceil_f32 v233, v233
v_max_f32 v233, 0, v233
v_sub_f32 v243, 0, v233
v_exp_f32 v237, v243
s_nop 1
v_mul_f32 v225, v225, v237
v_add_f32 v245, v245, v233
v_sub_f32 v196, v196, v233
v_sub_f32 v132, v132, v233
v_sub_f32 v148, v148, v233
v_sub_f32 v197, v197, v233
v_sub_f32 v133, v133, v233
v_sub_f32 v149, v149, v233
v_sub_f32 v198, v198, v233
v_sub_f32 v134, v134, v233
v_sub_f32 v150, v150, v233
v_sub_f32 v199, v199, v233
v_sub_f32 v135, v135, v233
v_sub_f32 v151, v151, v233
ds_read_b64 v[254:255], v253 offset:1024
s_waitcnt lgkmcnt(0)
v_lshlrev_b32 v242, 16, v254
v_and_b32 v243, 0xffff0000, v254
v_mul_f32 v242, v242, v237
v_mul_f32 v243, v243, v237
v_cvt_pk_bf16_f32 v254, v242, v243
v_lshlrev_b32 v242, 16, v255
v_and_b32 v243, 0xffff0000, v255
v_mul_f32 v242, v242, v237
v_mul_f32 v243, v243, v237
v_cvt_pk_bf16_f32 v255, v242, v243
ds_write_b64 v253, v[254:255] offset:1024
s_waitcnt lgkmcnt(0)
ds_read_b64 v[254:255], v253 offset:1032
s_waitcnt lgkmcnt(0)
v_lshlrev_b32 v242, 16, v254
v_and_b32 v243, 0xffff0000, v254
v_mul_f32 v242, v242, v237
v_mul_f32 v243, v243, v237
v_cvt_pk_bf16_f32 v254, v242, v243
v_lshlrev_b32 v242, 16, v255
v_and_b32 v243, 0xffff0000, v255
v_mul_f32 v242, v242, v237
v_mul_f32 v243, v243, v237
v_cvt_pk_bf16_f32 v255, v242, v243
ds_write_b64 v253, v[254:255] offset:1032
s_waitcnt lgkmcnt(0)
v_log_f32 v243, v226
v_max3_f32 v234, v136, v137, v138
v_max3_f32 v234, v234, v139, v243
v_mov_b32 v243, v234
s_nop 1
v_permlane32_swap_b32 v234, v243
s_nop 1
v_max_f32 v234, v234, v243
v_mov_b32 v243, v234
s_nop 1
v_permlane16_swap_b32 v234, v243
s_nop 1
v_max_f32 v234, v234, v243
v_ceil_f32 v234, v234
v_max_f32 v234, 0, v234
v_sub_f32 v243, 0, v234
v_exp_f32 v238, v243
s_nop 1
v_mul_f32 v226, v226, v238
v_add_f32 v246, v246, v234
v_sub_f32 v200, v200, v234
v_sub_f32 v136, v136, v234
v_sub_f32 v152, v152, v234
v_sub_f32 v201, v201, v234
v_sub_f32 v137, v137, v234
v_sub_f32 v153, v153, v234
v_sub_f32 v202, v202, v234
v_sub_f32 v138, v138, v234
v_sub_f32 v154, v154, v234
v_sub_f32 v203, v203, v234
v_sub_f32 v139, v139, v234
v_sub_f32 v155, v155, v234
ds_read_b64 v[254:255], v253 offset:2048
s_waitcnt lgkmcnt(0)
v_lshlrev_b32 v242, 16, v254
v_and_b32 v243, 0xffff0000, v254
v_mul_f32 v242, v242, v238
v_mul_f32 v243, v243, v238
v_cvt_pk_bf16_f32 v254, v242, v243
v_lshlrev_b32 v242, 16, v255
v_and_b32 v243, 0xffff0000, v255
v_mul_f32 v242, v242, v238
v_mul_f32 v243, v243, v238
v_cvt_pk_bf16_f32 v255, v242, v243
ds_write_b64 v253, v[254:255] offset:2048
s_waitcnt lgkmcnt(0)
ds_read_b64 v[254:255], v253 offset:2056
s_waitcnt lgkmcnt(0)
v_lshlrev_b32 v242, 16, v254
v_and_b32 v243, 0xffff0000, v254
v_mul_f32 v242, v242, v238
v_mul_f32 v243, v243, v238
v_cvt_pk_bf16_f32 v254, v242, v243
v_lshlrev_b32 v242, 16, v255
v_and_b32 v243, 0xffff0000, v255
v_mul_f32 v242, v242, v238
v_mul_f32 v243, v243, v238
v_cvt_pk_bf16_f32 v255, v242, v243
ds_write_b64 v253, v[254:255] offset:2056
s_waitcnt lgkmcnt(0)
v_log_f32 v243, v227
v_max3_f32 v235, v140, v141, v142
v_max3_f32 v235, v235, v143, v243
v_mov_b32 v243, v235
s_nop 1
v_permlane32_swap_b32 v235, v243
s_nop 1
v_max_f32 v235, v235, v243
v_mov_b32 v243, v235
s_nop 1
v_permlane16_swap_b32 v235, v243
s_nop 1
v_max_f32 v235, v235, v243
v_ceil_f32 v235, v235
v_max_f32 v235, 0, v235
v_sub_f32 v243, 0, v235
v_exp_f32 v239, v243
s_nop 1
v_mul_f32 v227, v227, v239
v_add_f32 v247, v247, v235
v_sub_f32 v204, v204, v235
v_sub_f32 v140, v140, v235
v_sub_f32 v156, v156, v235
v_sub_f32 v205, v205, v235
v_sub_f32 v141, v141, v235
v_sub_f32 v157, v157, v235
v_sub_f32 v206, v206, v235
v_sub_f32 v142, v142, v235
v_sub_f32 v158, v158, v235
v_sub_f32 v207, v207, v235
v_sub_f32 v143, v143, v235
v_sub_f32 v159, v159, v235
ds_read_b64 v[254:255], v253 offset:3072
s_waitcnt lgkmcnt(0)
v_lshlrev_b32 v242, 16, v254
v_and_b32 v243, 0xffff0000, v254
v_mul_f32 v242, v242, v239
v_mul_f32 v243, v243, v239
v_cvt_pk_bf16_f32 v254, v242, v243
v_lshlrev_b32 v242, 16, v255
v_and_b32 v243, 0xffff0000, v255
v_mul_f32 v242, v242, v239
v_mul_f32 v243, v243, v239
v_cvt_pk_bf16_f32 v255, v242, v243
ds_write_b64 v253, v[254:255] offset:3072
s_waitcnt lgkmcnt(0)
ds_read_b64 v[254:255], v253 offset:3080
s_waitcnt lgkmcnt(0)
v_lshlrev_b32 v242, 16, v254
v_and_b32 v243, 0xffff0000, v254
v_mul_f32 v242, v242, v239
v_mul_f32 v243, v243, v239
v_cvt_pk_bf16_f32 v254, v242, v243
v_lshlrev_b32 v242, 16, v255
v_and_b32 v243, 0xffff0000, v255
v_mul_f32 v242, v242, v239
v_mul_f32 v243, v243, v239
v_cvt_pk_bf16_f32 v255, v242, v243
ds_write_b64 v253, v[254:255] offset:3080
s_waitcnt lgkmcnt(0)
v_exp_f32 v232, v128
v_exp_f32 v233, v129
v_exp_f32 v234, v130
v_exp_f32 v235, v131
s_nop 1
v_add_f32 v228, v224, v232
v_add_f32 v228, v228, v233
v_add_f32 v228, v228, v234
v_add_f32 v228, v228, v235
v_cvt_pk_bf16_f32 v160, v232, v233
v_cvt_pk_bf16_f32 v161, v234, v235
v_exp_f32 v232, v132
v_exp_f32 v233, v133
v_exp_f32 v234, v134
v_exp_f32 v235, v135
s_nop 1
v_add_f32 v229, v225, v232
v_add_f32 v229, v229, v233
v_add_f32 v229, v229, v234
v_add_f32 v229, v229, v235
v_cvt_pk_bf16_f32 v164, v232, v233
v_cvt_pk_bf16_f32 v165, v234, v235
v_exp_f32 v232, v136
v_exp_f32 v233, v137
v_exp_f32 v234, v138
v_exp_f32 v235, v139
s_nop 1
v_add_f32 v230, v226, v232
v_add_f32 v230, v230, v233
v_add_f32 v230, v230, v234
v_add_f32 v230, v230, v235
v_cvt_pk_bf16_f32 v168, v232, v233
v_cvt_pk_bf16_f32 v169, v234, v235
v_exp_f32 v232, v140
v_exp_f32 v233, v141
v_exp_f32 v234, v142
v_exp_f32 v235, v143
s_nop 1
v_add_f32 v231, v227, v232
v_add_f32 v231, v231, v233
v_add_f32 v231, v231, v234
v_add_f32 v231, v231, v235
v_cvt_pk_bf16_f32 v172, v232, v233
v_cvt_pk_bf16_f32 v173, v234, v235
s_branch L2_rare_common
L2_rare_site13:
s_mov_b32 s36, 13
s_branch L2_rare_t1_1_1
L2_rare_t1_1_1:
s_nop 15
s_nop 15
s_waitcnt lgkmcnt(0)
v_log_f32 v243, v228
v_max3_f32 v232, v144, v145, v146
v_max3_f32 v232, v232, v147, v243
v_mov_b32 v243, v232
s_nop 1
v_permlane32_swap_b32 v232, v243
s_nop 1
v_max_f32 v232, v232, v243
v_mov_b32 v243, v232
s_nop 1
v_permlane16_swap_b32 v232, v243
s_nop 1
v_max_f32 v232, v232, v243
v_ceil_f32 v232, v232
v_max_f32 v232, 0, v232
v_sub_f32 v243, 0, v232
v_exp_f32 v236, v243
s_nop 1
v_mul_f32 v228, v228, v236
v_add_f32 v244, v244, v232
v_sub_f32 v192, v192, v232
v_sub_f32 v128, v128, v232
v_sub_f32 v144, v144, v232
v_sub_f32 v193, v193, v232
v_sub_f32 v129, v129, v232
v_sub_f32 v145, v145, v232
v_sub_f32 v194, v194, v232
v_sub_f32 v130, v130, v232
v_sub_f32 v146, v146, v232
v_sub_f32 v195, v195, v232
v_sub_f32 v131, v131, v232
v_sub_f32 v147, v147, v232
v_lshlrev_b32 v242, 16, v160
v_and_b32 v243, 0xffff0000, v160
v_mul_f32 v242, v242, v236
v_mul_f32 v243, v243, v236
v_cvt_pk_bf16_f32 v160, v242, v243
v_lshlrev_b32 v242, 16, v161
v_and_b32 v243, 0xffff0000, v161
v_mul_f32 v242, v242, v236
v_mul_f32 v243, v243, v236
v_cvt_pk_bf16_f32 v161, v242, v243
ds_read_b64 v[254:255], v253 offset:0
s_waitcnt lgkmcnt(0)
v_lshlrev_b32 v242, 16, v254
v_and_b32 v243, 0xffff0000, v254
v_mul_f32 v242, v242, v236
v_mul_f32 v243, v243, v236
v_cvt_pk_bf16_f32 v254, v242, v243
v_lshlrev_b32 v242, 16, v255
v_and_b32 v243, 0xffff0000, v255
v_mul_f32 v242, v242, v236
v_mul_f32 v243, v243, v236
v_cvt_pk_bf16_f32 v255, v242, v243
ds_write_b64 v253, v[254:255] offset:0
s_waitcnt lgkmcnt(0)
ds_read_b64 v[254:255], v253 offset:8
s_waitcnt lgkmcnt(0)
v_lshlrev_b32 v242, 16, v254
v_and_b32 v243, 0xffff0000, v254
v_mul_f32 v242, v242, v236
v_mul_f32 v243, v243, v236
v_cvt_pk_bf16_f32 v254, v242, v243
v_lshlrev_b32 v242, 16, v255
v_and_b32 v243, 0xffff0000, v255
v_mul_f32 v242, v242, v236
v_mul_f32 v243, v243, v236
v_cvt_pk_bf16_f32 v255, v242, v243
ds_write_b64 v253, v[254:255] offset:8
s_waitcnt lgkmcnt(0)
v_log_f32 v243, v229
v_max3_f32 v233, v148, v149, v150
v_max3_f32 v233, v233, v151, v243
v_mov_b32 v243, v233
s_nop 1
v_permlane32_swap_b32 v233, v243
s_nop 1
v_max_f32 v233, v233, v243
v_mov_b32 v243, v233
s_nop 1
v_permlane16_swap_b32 v233, v243
s_nop 1
v_max_f32 v233, v233, v243
v_ceil_f32 v233, v233
v_max_f32 v233, 0, v233
v_sub_f32 v243, 0, v233
v_exp_f32 v237, v243
s_nop 1
v_mul_f32 v229, v229, v237
v_add_f32 v245, v245, v233
v_sub_f32 v196, v196, v233
v_sub_f32 v132, v132, v233
v_sub_f32 v148, v148, v233
v_sub_f32 v197, v197, v233
v_sub_f32 v133, v133, v233
v_sub_f32 v149, v149, v233
v_sub_f32 v198, v198, v233
v_sub_f32 v134, v134, v233
v_sub_f32 v150, v150, v233
v_sub_f32 v199, v199, v233
v_sub_f32 v135, v135, v233
v_sub_f32 v151, v151, v233
v_lshlrev_b32 v242, 16, v164
v_and_b32 v243, 0xffff0000, v164
v_mul_f32 v242, v242, v237
v_mul_f32 v243, v243, v237
v_cvt_pk_bf16_f32 v164, v242, v243
v_lshlrev_b32 v242, 16, v165
v_and_b32 v243, 0xffff0000, v165
v_mul_f32 v242, v242, v237
v_mul_f32 v243, v243, v237
v_cvt_pk_bf16_f32 v165, v242, v243
ds_read_b64 v[254:255], v253 offset:1024
s_waitcnt lgkmcnt(0)
v_lshlrev_b32 v242, 16, v254
v_and_b32 v243, 0xffff0000, v254
v_mul_f32 v242, v242, v237
v_mul_f32 v243, v243, v237
v_cvt_pk_bf16_f32 v254, v242, v243
v_lshlrev_b32 v242, 16, v255
v_and_b32 v243, 0xffff0000, v255
v_mul_f32 v242, v242, v237
v_mul_f32 v243, v243, v237
v_cvt_pk_bf16_f32 v255, v242, v243
ds_write_b64 v253, v[254:255] offset:1024
s_waitcnt lgkmcnt(0)
ds_read_b64 v[254:255], v253 offset:1032
s_waitcnt lgkmcnt(0)
v_lshlrev_b32 v242, 16, v254
v_and_b32 v243, 0xffff0000, v254
v_mul_f32 v242, v242, v237
v_mul_f32 v243, v243, v237
v_cvt_pk_bf16_f32 v254, v242, v243
v_lshlrev_b32 v242, 16, v255
v_and_b32 v243, 0xffff0000, v255
v_mul_f32 v242, v242, v237
v_mul_f32 v243, v243, v237
v_cvt_pk_bf16_f32 v255, v242, v243
ds_write_b64 v253, v[254:255] offset:1032
s_waitcnt lgkmcnt(0)
v_log_f32 v243, v230
v_max3_f32 v234, v152, v153, v154
v_max3_f32 v234, v234, v155, v243
v_mov_b32 v243, v234
s_nop 1
v_permlane32_swap_b32 v234, v243
s_nop 1
v_max_f32 v234, v234, v243
v_mov_b32 v243, v234
s_nop 1
v_permlane16_swap_b32 v234, v243
s_nop 1
v_max_f32 v234, v234, v243
v_ceil_f32 v234, v234
v_max_f32 v234, 0, v234
v_sub_f32 v243, 0, v234
v_exp_f32 v238, v243
s_nop 1
v_mul_f32 v230, v230, v238
v_add_f32 v246, v246, v234
v_sub_f32 v200, v200, v234
v_sub_f32 v136, v136, v234
v_sub_f32 v152, v152, v234
v_sub_f32 v201, v201, v234
v_sub_f32 v137, v137, v234
v_sub_f32 v153, v153, v234
v_sub_f32 v202, v202, v234
v_sub_f32 v138, v138, v234
v_sub_f32 v154, v154, v234
v_sub_f32 v203, v203, v234
v_sub_f32 v139, v139, v234
v_sub_f32 v155, v155, v234
v_lshlrev_b32 v242, 16, v168
v_and_b32 v243, 0xffff0000, v168
v_mul_f32 v242, v242, v238
v_mul_f32 v243, v243, v238
v_cvt_pk_bf16_f32 v168, v242, v243
v_lshlrev_b32 v242, 16, v169
v_and_b32 v243, 0xffff0000, v169
v_mul_f32 v242, v242, v238
v_mul_f32 v243, v243, v238
v_cvt_pk_bf16_f32 v169, v242, v243
ds_read_b64 v[254:255], v253 offset:2048
s_waitcnt lgkmcnt(0)
v_lshlrev_b32 v242, 16, v254
v_and_b32 v243, 0xffff0000, v254
v_mul_f32 v242, v242, v238
v_mul_f32 v243, v243, v238
v_cvt_pk_bf16_f32 v254, v242, v243
v_lshlrev_b32 v242, 16, v255
v_and_b32 v243, 0xffff0000, v255
v_mul_f32 v242, v242, v238
v_mul_f32 v243, v243, v238
v_cvt_pk_bf16_f32 v255, v242, v243
ds_write_b64 v253, v[254:255] offset:2048
s_waitcnt lgkmcnt(0)
ds_read_b64 v[254:255], v253 offset:2056
s_waitcnt lgkmcnt(0)
v_lshlrev_b32 v242, 16, v254
v_and_b32 v243, 0xffff0000, v254
v_mul_f32 v242, v242, v238
v_mul_f32 v243, v243, v238
v_cvt_pk_bf16_f32 v254, v242, v243
v_lshlrev_b32 v242, 16, v255
v_and_b32 v243, 0xffff0000, v255
v_mul_f32 v242, v242, v238
v_mul_f32 v243, v243, v238
v_cvt_pk_bf16_f32 v255, v242, v243
ds_write_b64 v253, v[254:255] offset:2056
s_waitcnt lgkmcnt(0)
v_log_f32 v243, v231
v_max3_f32 v235, v156, v157, v158
v_max3_f32 v235, v235, v159, v243
v_mov_b32 v243, v235
s_nop 1
v_permlane32_swap_b32 v235, v243
s_nop 1
v_max_f32 v235, v235, v243
v_mov_b32 v243, v235
s_nop 1
v_permlane16_swap_b32 v235, v243
s_nop 1
v_max_f32 v235, v235, v243
v_ceil_f32 v235, v235
v_max_f32 v235, 0, v235
v_sub_f32 v243, 0, v235
v_exp_f32 v239, v243
s_nop 1
v_mul_f32 v231, v231, v239
v_add_f32 v247, v247, v235
v_sub_f32 v204, v204, v235
v_sub_f32 v140, v140, v235
v_sub_f32 v156, v156, v235
v_sub_f32 v205, v205, v235
v_sub_f32 v141, v141, v235
v_sub_f32 v157, v157, v235
v_sub_f32 v206, v206, v235
v_sub_f32 v142, v142, v235
v_sub_f32 v158, v158, v235
v_sub_f32 v207, v207, v235
v_sub_f32 v143, v143, v235
v_sub_f32 v159, v159, v235
v_lshlrev_b32 v242, 16, v172
v_and_b32 v243, 0xffff0000, v172
v_mul_f32 v242, v242, v239
v_mul_f32 v243, v243, v239
v_cvt_pk_bf16_f32 v172, v242, v243
v_lshlrev_b32 v242, 16, v173
v_and_b32 v243, 0xffff0000, v173
v_mul_f32 v242, v242, v239
v_mul_f32 v243, v243, v239
v_cvt_pk_bf16_f32 v173, v242, v243
ds_read_b64 v[254:255], v253 offset:3072
s_waitcnt lgkmcnt(0)
v_lshlrev_b32 v242, 16, v254
v_and_b32 v243, 0xffff0000, v254
v_mul_f32 v242, v242, v239
v_mul_f32 v243, v243, v239
v_cvt_pk_bf16_f32 v254, v242, v243
v_lshlrev_b32 v242, 16, v255
v_and_b32 v243, 0xffff0000, v255
v_mul_f32 v242, v242, v239
v_mul_f32 v243, v243, v239
v_cvt_pk_bf16_f32 v255, v242, v243
ds_write_b64 v253, v[254:255] offset:3072
s_waitcnt lgkmcnt(0)
ds_read_b64 v[254:255], v253 offset:3080
s_waitcnt lgkmcnt(0)
v_lshlrev_b32 v242, 16, v254
v_and_b32 v243, 0xffff0000, v254
v_mul_f32 v242, v242, v239
v_mul_f32 v243, v243, v239
v_cvt_pk_bf16_f32 v254, v242, v243
v_lshlrev_b32 v242, 16, v255
v_and_b32 v243, 0xffff0000, v255
v_mul_f32 v242, v242, v239
v_mul_f32 v243, v243, v239
v_cvt_pk_bf16_f32 v255, v242, v243
ds_write_b64 v253, v[254:255] offset:3080
s_waitcnt lgkmcnt(0)
v_exp_f32 v232, v144
v_exp_f32 v233, v145
v_exp_f32 v234, v146
v_exp_f32 v235, v147
s_nop 1
v_add_f32 v224, v228, v232
v_add_f32 v224, v224, v233
v_add_f32 v224, v224, v234
v_add_f32 v224, v224, v235
v_cvt_pk_bf16_f32 v162, v232, v233
v_cvt_pk_bf16_f32 v163, v234, v235
v_exp_f32 v232, v148
v_exp_f32 v233, v149
v_exp_f32 v234, v150
v_exp_f32 v235, v151
s_nop 1
v_add_f32 v225, v229, v232
v_add_f32 v225, v225, v233
v_add_f32 v225, v225, v234
v_add_f32 v225, v225, v235
v_cvt_pk_bf16_f32 v166, v232, v233
v_cvt_pk_bf16_f32 v167, v234, v235
v_exp_f32 v232, v152
v_exp_f32 v233, v153
v_exp_f32 v234, v154
v_exp_f32 v235, v155
s_nop 1
v_add_f32 v226, v230, v232
v_add_f32 v226, v226, v233
v_add_f32 v226, v226, v234
v_add_f32 v226, v226, v235
v_cvt_pk_bf16_f32 v170, v232, v233
v_cvt_pk_bf16_f32 v171, v234, v235
v_exp_f32 v232, v156
v_exp_f32 v233, v157
v_exp_f32 v234, v158
v_exp_f32 v235, v159
s_nop 1
v_add_f32 v227, v231, v232
v_add_f32 v227, v227, v233
v_add_f32 v227, v227, v234
v_add_f32 v227, v227, v235
v_cvt_pk_bf16_f32 v174, v232, v233
v_cvt_pk_bf16_f32 v175, v234, v235
s_branch L2_rare_common
L2_rare_site14:
s_mov_b32 s36, 14
s_branch L2_rare_t1_2_0
L2_rare_t1_2_0:
s_nop 15
s_nop 15
s_waitcnt lgkmcnt(0)
v_log_f32 v243, v224
v_max3_f32 v232, v128, v129, v130
v_max3_f32 v232, v232, v131, v243
v_mov_b32 v243, v232
s_nop 1
v_permlane32_swap_b32 v232, v243
s_nop 1
v_max_f32 v232, v232, v243
v_mov_b32 v243, v232
s_nop 1
v_permlane16_swap_b32 v232, v243
s_nop 1
v_max_f32 v232, v232, v243
v_ceil_f32 v232, v232
v_max_f32 v232, 0, v232
v_sub_f32 v243, 0, v232
v_exp_f32 v236, v243
s_nop 1
v_mul_f32 v224, v224, v236
v_add_f32 v244, v244, v232
v_sub_f32 v192, v192, v232
v_sub_f32 v128, v128, v232
v_sub_f32 v144, v144, v232
v_sub_f32 v193, v193, v232
v_sub_f32 v129, v129, v232
v_sub_f32 v145, v145, v232
v_sub_f32 v194, v194, v232
v_sub_f32 v130, v130, v232
v_sub_f32 v146, v146, v232
v_sub_f32 v195, v195, v232
v_sub_f32 v131, v131, v232
v_sub_f32 v147, v147, v232
ds_read_b64 v[254:255], v253 offset:0
s_waitcnt lgkmcnt(0)
v_lshlrev_b32 v242, 16, v254
v_and_b32 v243, 0xffff0000, v254
v_mul_f32 v242, v242, v236
v_mul_f32 v243, v243, v236
v_cvt_pk_bf16_f32 v254, v242, v243
v_lshlrev_b32 v242, 16, v255
v_and_b32 v243, 0xffff0000, v255
v_mul_f32 v242, v242, v236
v_mul_f32 v243, v243, v236
v_cvt_pk_bf16_f32 v255, v242, v243
ds_write_b64 v253, v[254:255] offset:0
s_waitcnt lgkmcnt(0)
ds_read_b64 v[254:255], v253 offset:8
s_waitcnt lgkmcnt(0)
v_lshlrev_b32 v242, 16, v254
v_and_b32 v243, 0xffff0000, v254
v_mul_f32 v242, v242, v236
v_mul_f32 v243, v243, v236
v_cvt_pk_bf16_f32 v254, v242, v243
v_lshlrev_b32 v242, 16, v255
v_and_b32 v243, 0xffff0000, v255
v_mul_f32 v242, v242, v236
v_mul_f32 v243, v243, v236
v_cvt_pk_bf16_f32 v255, v242, v243
ds_write_b64 v253, v[254:255] offset:8
s_waitcnt lgkmcnt(0)
ds_read_b64 v[254:255], v253 offset:4096
s_waitcnt lgkmcnt(0)
v_lshlrev_b32 v242, 16, v254
v_and_b32 v243, 0xffff0000, v254
v_mul_f32 v242, v242, v236
v_mul_f32 v243, v243, v236
v_cvt_pk_bf16_f32 v254, v242, v243
v_lshlrev_b32 v242, 16, v255
v_and_b32 v243, 0xffff0000, v255
v_mul_f32 v242, v242, v236
v_mul_f32 v243, v243, v236
v_cvt_pk_bf16_f32 v255, v242, v243
ds_write_b64 v253, v[254:255] offset:4096
s_waitcnt lgkmcnt(0)
ds_read_b64 v[254:255], v253 offset:4104
s_waitcnt lgkmcnt(0)
v_lshlrev_b32 v242, 16, v254
v_and_b32 v243, 0xffff0000, v254
v_mul_f32 v242, v242, v236
v_mul_f32 v243, v243, v236
v_cvt_pk_bf16_f32 v254, v242, v243
v_lshlrev_b32 v242, 16, v255
v_and_b32 v243, 0xffff0000, v255
v_mul_f32 v242, v242, v236
v_mul_f32 v243, v243, v236
v_cvt_pk_bf16_f32 v255, v242, v243
ds_write_b64 v253, v[254:255] offset:4104
s_waitcnt lgkmcnt(0)
v_log_f32 v243, v225
v_max3_f32 v233, v132, v133, v134
v_max3_f32 v233, v233, v135, v243
v_mov_b32 v243, v233
s_nop 1
v_permlane32_swap_b32 v233, v243
s_nop 1
v_max_f32 v233, v233, v243
v_mov_b32 v243, v233
s_nop 1
v_permlane16_swap_b32 v233, v243
s_nop 1
v_max_f32 v233, v233, v243
v_ceil_f32 v233, v233
v_max_f32 v233, 0, v233
v_sub_f32 v243, 0, v233
v_exp_f32 v237, v243
s_nop 1
v_mul_f32 v225, v225, v237
v_add_f32 v245, v245, v233
v_sub_f32 v196, v196, v233
v_sub_f32 v132, v132, v233
v_sub_f32 v148, v148, v233
v_sub_f32 v197, v197, v233
v_sub_f32 v133, v133, v233
v_sub_f32 v149, v149, v233
v_sub_f32 v198, v198, v233
v_sub_f32 v134, v134, v233
v_sub_f32 v150, v150, v233
v_sub_f32 v199, v199, v233
v_sub_f32 v135, v135, v233
v_sub_f32 v151, v151, v233
ds_read_b64 v[254:255], v253 offset:1024
s_waitcnt lgkmcnt(0)
v_lshlrev_b32 v242, 16, v254
v_and_b32 v243, 0xffff0000, v254
v_mul_f32 v242, v242, v237
v_mul_f32 v243, v243, v237
v_cvt_pk_bf16_f32 v254, v242, v243
v_lshlrev_b32 v242, 16, v255
v_and_b32 v243, 0xffff0000, v255
v_mul_f32 v242, v242, v237
v_mul_f32 v243, v243, v237
v_cvt_pk_bf16_f32 v255, v242, v243
ds_write_b64 v253, v[254:255] offset:1024
s_waitcnt lgkmcnt(0)
ds_read_b64 v[254:255], v253 offset:1032
s_waitcnt lgkmcnt(0)
v_lshlrev_b32 v242, 16, v254
v_and_b32 v243, 0xffff0000, v254
v_mul_f32 v242, v242, v237
v_mul_f32 v243, v243, v237
v_cvt_pk_bf16_f32 v254, v242, v243
v_lshlrev_b32 v242, 16, v255
v_and_b32 v243, 0xffff0000, v255
v_mul_f32 v242, v242, v237
v_mul_f32 v243, v243, v237
v_cvt_pk_bf16_f32 v255, v242, v243
ds_write_b64 v253, v[254:255] offset:1032
s_waitcnt lgkmcnt(0)
ds_read_b64 v[254:255], v253 offset:5120
s_waitcnt lgkmcnt(0)
v_lshlrev_b32 v242, 16, v254
v_and_b32 v243, 0xffff0000, v254
v_mul_f32 v242, v242, v237
v_mul_f32 v243, v243, v237
v_cvt_pk_bf16_f32 v254, v242, v243
v_lshlrev_b32 v242, 16, v255
v_and_b32 v243, 0xffff0000, v255
v_mul_f32 v242, v242, v237
v_mul_f32 v243, v243, v237
v_cvt_pk_bf16_f32 v255, v242, v243
ds_write_b64 v253, v[254:255] offset:5120
s_waitcnt lgkmcnt(0)
ds_read_b64 v[254:255], v253 offset:5128
s_waitcnt lgkmcnt(0)
v_lshlrev_b32 v242, 16, v254
v_and_b32 v243, 0xffff0000, v254
v_mul_f32 v242, v242, v237
v_mul_f32 v243, v243, v237
v_cvt_pk_bf16_f32 v254, v242, v243
v_lshlrev_b32 v242, 16, v255
v_and_b32 v243, 0xffff0000, v255
v_mul_f32 v242, v242, v237
v_mul_f32 v243, v243, v237
v_cvt_pk_bf16_f32 v255, v242, v243
ds_write_b64 v253, v[254:255] offset:5128
s_waitcnt lgkmcnt(0)
v_log_f32 v243, v226
v_max3_f32 v234, v136, v137, v138
v_max3_f32 v234, v234, v139, v243
v_mov_b32 v243, v234
s_nop 1
v_permlane32_swap_b32 v234, v243
s_nop 1
v_max_f32 v234, v234, v243
v_mov_b32 v243, v234
s_nop 1
v_permlane16_swap_b32 v234, v243
s_nop 1
v_max_f32 v234, v234, v243
v_ceil_f32 v234, v234
v_max_f32 v234, 0, v234
v_sub_f32 v243, 0, v234
v_exp_f32 v238, v243
s_nop 1
v_mul_f32 v226, v226, v238
v_add_f32 v246, v246, v234
v_sub_f32 v200, v200, v234
v_sub_f32 v136, v136, v234
v_sub_f32 v152, v152, v234
v_sub_f32 v201, v201, v234
v_sub_f32 v137, v137, v234
v_sub_f32 v153, v153, v234
v_sub_f32 v202, v202, v234
v_sub_f32 v138, v138, v234
v_sub_f32 v154, v154, v234
v_sub_f32 v203, v203, v234
v_sub_f32 v139, v139, v234
v_sub_f32 v155, v155, v234
ds_read_b64 v[254:255], v253 offset:2048
s_waitcnt lgkmcnt(0)
v_lshlrev_b32 v242, 16, v254
v_and_b32 v243, 0xffff0000, v254
v_mul_f32 v242, v242, v238
v_mul_f32 v243, v243, v238
v_cvt_pk_bf16_f32 v254, v242, v243
v_lshlrev_b32 v242, 16, v255
v_and_b32 v243, 0xffff0000, v255
v_mul_f32 v242, v242, v238
v_mul_f32 v243, v243, v238
v_cvt_pk_bf16_f32 v255, v242, v243
ds_write_b64 v253, v[254:255] offset:2048
s_waitcnt lgkmcnt(0)
ds_read_b64 v[254:255], v253 offset:2056
s_waitcnt lgkmcnt(0)
v_lshlrev_b32 v242, 16, v254
v_and_b32 v243, 0xffff0000, v254
v_mul_f32 v242, v242, v238
v_mul_f32 v243, v243, v238
v_cvt_pk_bf16_f32 v254, v242, v243
v_lshlrev_b32 v242, 16, v255
v_and_b32 v243, 0xffff0000, v255
v_mul_f32 v242, v242, v238
v_mul_f32 v243, v243, v238
v_cvt_pk_bf16_f32 v255, v242, v243
ds_write_b64 v253, v[254:255] offset:2056
s_waitcnt lgkmcnt(0)
ds_read_b64 v[254:255], v253 offset:6144
s_waitcnt lgkmcnt(0)
v_lshlrev_b32 v242, 16, v254
v_and_b32 v243, 0xffff0000, v254
v_mul_f32 v242, v242, v238
v_mul_f32 v243, v243, v238
v_cvt_pk_bf16_f32 v254, v242, v243
v_lshlrev_b32 v242, 16, v255
v_and_b32 v243, 0xffff0000, v255
v_mul_f32 v242, v242, v238
v_mul_f32 v243, v243, v238
v_cvt_pk_bf16_f32 v255, v242, v243
ds_write_b64 v253, v[254:255] offset:6144
s_waitcnt lgkmcnt(0)
ds_read_b64 v[254:255], v253 offset:6152
s_waitcnt lgkmcnt(0)
v_lshlrev_b32 v242, 16, v254
v_and_b32 v243, 0xffff0000, v254
v_mul_f32 v242, v242, v238
v_mul_f32 v243, v243, v238
v_cvt_pk_bf16_f32 v254, v242, v243
v_lshlrev_b32 v242, 16, v255
v_and_b32 v243, 0xffff0000, v255
v_mul_f32 v242, v242, v238
v_mul_f32 v243, v243, v238
v_cvt_pk_bf16_f32 v255, v242, v243
ds_write_b64 v253, v[254:255] offset:6152
s_waitcnt lgkmcnt(0)
v_log_f32 v243, v227
v_max3_f32 v235, v140, v141, v142
v_max3_f32 v235, v235, v143, v243
v_mov_b32 v243, v235
s_nop 1
v_permlane32_swap_b32 v235, v243
s_nop 1
v_max_f32 v235, v235, v243
v_mov_b32 v243, v235
s_nop 1
v_permlane16_swap_b32 v235, v243
s_nop 1
v_max_f32 v235, v235, v243
v_ceil_f32 v235, v235
v_max_f32 v235, 0, v235
v_sub_f32 v243, 0, v235
v_exp_f32 v239, v243
s_nop 1
v_mul_f32 v227, v227, v239
v_add_f32 v247, v247, v235
v_sub_f32 v204, v204, v235
v_sub_f32 v140, v140, v235
v_sub_f32 v156, v156, v235
v_sub_f32 v205, v205, v235
v_sub_f32 v141, v141, v235
v_sub_f32 v157, v157, v235
v_sub_f32 v206, v206, v235
v_sub_f32 v142, v142, v235
v_sub_f32 v158, v158, v235
v_sub_f32 v207, v207, v235
v_sub_f32 v143, v143, v235
v_sub_f32 v159, v159, v235
ds_read_b64 v[254:255], v253 offset:3072
s_waitcnt lgkmcnt(0)
v_lshlrev_b32 v242, 16, v254
v_and_b32 v243, 0xffff0000, v254
v_mul_f32 v242, v242, v239
v_mul_f32 v243, v243, v239
v_cvt_pk_bf16_f32 v254, v242, v243
v_lshlrev_b32 v242, 16, v255
v_and_b32 v243, 0xffff0000, v255
v_mul_f32 v242, v242, v239
v_mul_f32 v243, v243, v239
v_cvt_pk_bf16_f32 v255, v242, v243
ds_write_b64 v253, v[254:255] offset:3072
s_waitcnt lgkmcnt(0)
ds_read_b64 v[254:255], v253 offset:3080
s_waitcnt lgkmcnt(0)
v_lshlrev_b32 v242, 16, v254
v_and_b32 v243, 0xffff0000, v254
v_mul_f32 v242, v242, v239
v_mul_f32 v243, v243, v239
v_cvt_pk_bf16_f32 v254, v242, v243
v_lshlrev_b32 v242, 16, v255
v_and_b32 v243, 0xffff0000, v255
v_mul_f32 v242, v242, v239
v_mul_f32 v243, v243, v239
v_cvt_pk_bf16_f32 v255, v242, v243
ds_write_b64 v253, v[254:255] offset:3080
s_waitcnt lgkmcnt(0)
ds_read_b64 v[254:255], v253 offset:7168
s_waitcnt lgkmcnt(0)
v_lshlrev_b32 v242, 16, v254
v_and_b32 v243, 0xffff0000, v254
v_mul_f32 v242, v242, v239
v_mul_f32 v243, v243, v239
v_cvt_pk_bf16_f32 v254, v242, v243
v_lshlrev_b32 v242, 16, v255
v_and_b32 v243, 0xffff0000, v255
v_mul_f32 v242, v242, v239
v_mul_f32 v243, v243, v239
v_cvt_pk_bf16_f32 v255, v242, v243
ds_write_b64 v253, v[254:255] offset:7168
s_waitcnt lgkmcnt(0)
ds_read_b64 v[254:255], v253 offset:7176
s_waitcnt lgkmcnt(0)
v_lshlrev_b32 v242, 16, v254
v_and_b32 v243, 0xffff0000, v254
v_mul_f32 v242, v242, v239
v_mul_f32 v243, v243, v239
v_cvt_pk_bf16_f32 v254, v242, v243
v_lshlrev_b32 v242, 16, v255
v_and_b32 v243, 0xffff0000, v255
v_mul_f32 v242, v242, v239
v_mul_f32 v243, v243, v239
v_cvt_pk_bf16_f32 v255, v242, v243
ds_write_b64 v253, v[254:255] offset:7176
s_waitcnt lgkmcnt(0)
v_exp_f32 v232, v128
v_exp_f32 v233, v129
v_exp_f32 v234, v130
v_exp_f32 v235, v131
s_nop 1
v_add_f32 v228, v224, v232
v_add_f32 v228, v228, v233
v_add_f32 v228, v228, v234
v_add_f32 v228, v228, v235
v_cvt_pk_bf16_f32 v176, v232, v233
v_cvt_pk_bf16_f32 v177, v234, v235
v_exp_f32 v232, v132
v_exp_f32 v233, v133
v_exp_f32 v234, v134
v_exp_f32 v235, v135
s_nop 1
v_add_f32 v229, v225, v232
v_add_f32 v229, v229, v233
v_add_f32 v229, v229, v234
v_add_f32 v229, v229, v235
v_cvt_pk_bf16_f32 v180, v232, v233
v_cvt_pk_bf16_f32 v181, v234, v235
v_exp_f32 v232, v136
v_exp_f32 v233, v137
v_exp_f32 v234, v138
v_exp_f32 v235, v139
s_nop 1
v_add_f32 v230, v226, v232
v_add_f32 v230, v230, v233
v_add_f32 v230, v230, v234
v_add_f32 v230, v230, v235
v_cvt_pk_bf16_f32 v184, v232, v233
v_cvt_pk_bf16_f32 v185, v234, v235
v_exp_f32 v232, v140
v_exp_f32 v233, v141
v_exp_f32 v234, v142
v_exp_f32 v235, v143
s_nop 1
v_add_f32 v231, v227, v232
v_add_f32 v231, v231, v233
v_add_f32 v231, v231, v234
v_add_f32 v231, v231, v235
v_cvt_pk_bf16_f32 v188, v232, v233
v_cvt_pk_bf16_f32 v189, v234, v235
s_branch L2_rare_common
L2_rare_site15:
s_mov_b32 s36, 15
s_branch L2_rare_t1_3_1
L2_rare_t1_3_1:
s_nop 15
s_nop 15
s_waitcnt lgkmcnt(0)
v_log_f32 v243, v228
v_max3_f32 v232, v144, v145, v146
v_max3_f32 v232, v232, v147, v243
v_mov_b32 v243, v232
s_nop 1
v_permlane32_swap_b32 v232, v243
s_nop 1
v_max_f32 v232, v232, v243
v_mov_b32 v243, v232
s_nop 1
v_permlane16_swap_b32 v232, v243
s_nop 1
v_max_f32 v232, v232, v243
v_ceil_f32 v232, v232
v_max_f32 v232, 0, v232
v_sub_f32 v243, 0, v232
v_exp_f32 v236, v243
s_nop 1
v_mul_f32 v228, v228, v236
v_add_f32 v244, v244, v232
v_sub_f32 v192, v192, v232
v_sub_f32 v128, v128, v232
v_sub_f32 v144, v144, v232
v_sub_f32 v193, v193, v232
v_sub_f32 v129, v129, v232
v_sub_f32 v145, v145, v232
v_sub_f32 v194, v194, v232
v_sub_f32 v130, v130, v232
v_sub_f32 v146, v146, v232
v_sub_f32 v195, v195, v232
v_sub_f32 v131, v131, v232
v_sub_f32 v147, v147, v232
v_lshlrev_b32 v242, 16, v176
v_and_b32 v243, 0xffff0000, v176
v_mul_f32 v242, v242, v236
v_mul_f32 v243, v243, v236
v_cvt_pk_bf16_f32 v176, v242, v243
v_lshlrev_b32 v242, 16, v177
v_and_b32 v243, 0xffff0000, v177
v_mul_f32 v242, v242, v236
v_mul_f32 v243, v243, v236
v_cvt_pk_bf16_f32 v177, v242, v243
ds_read_b64 v[254:255], v253 offset:0
s_waitcnt lgkmcnt(0)
v_lshlrev_b32 v242, 16, v254
v_and_b32 v243, 0xffff0000, v254
v_mul_f32 v242, v242, v236
v_mul_f32 v243, v243, v236
v_cvt_pk_bf16_f32 v254, v242, v243
v_lshlrev_b32 v242, 16, v255
v_and_b32 v243, 0xffff0000, v255
v_mul_f32 v242, v242, v236
v_mul_f32 v243, v243, v236
v_cvt_pk_bf16_f32 v255, v242, v243
ds_write_b64 v253, v[254:255] offset:0
s_waitcnt lgkmcnt(0)
ds_read_b64 v[254:255], v253 offset:8
s_waitcnt lgkmcnt(0)
v_lshlrev_b32 v242, 16, v254
v_and_b32 v243, 0xffff0000, v254
v_mul_f32 v242, v242, v236
v_mul_f32 v243, v243, v236
v_cvt_pk_bf16_f32 v254, v242, v243
v_lshlrev_b32 v242, 16, v255
v_and_b32 v243, 0xffff0000, v255
v_mul_f32 v242, v242, v236
v_mul_f32 v243, v243, v236
v_cvt_pk_bf16_f32 v255, v242, v243
ds_write_b64 v253, v[254:255] offset:8
s_waitcnt lgkmcnt(0)
ds_read_b64 v[254:255], v253 offset:4096
s_waitcnt lgkmcnt(0)
v_lshlrev_b32 v242, 16, v254
v_and_b32 v243, 0xffff0000, v254
v_mul_f32 v242, v242, v236
v_mul_f32 v243, v243, v236
v_cvt_pk_bf16_f32 v254, v242, v243
v_lshlrev_b32 v242, 16, v255
v_and_b32 v243, 0xffff0000, v255
v_mul_f32 v242, v242, v236
v_mul_f32 v243, v243, v236
v_cvt_pk_bf16_f32 v255, v242, v243
ds_write_b64 v253, v[254:255] offset:4096
s_waitcnt lgkmcnt(0)
ds_read_b64 v[254:255], v253 offset:4104
s_waitcnt lgkmcnt(0)
v_lshlrev_b32 v242, 16, v254
v_and_b32 v243, 0xffff0000, v254
v_mul_f32 v242, v242, v236
v_mul_f32 v243, v243, v236
v_cvt_pk_bf16_f32 v254, v242, v243
v_lshlrev_b32 v242, 16, v255
v_and_b32 v243, 0xffff0000, v255
v_mul_f32 v242, v242, v236
v_mul_f32 v243, v243, v236
v_cvt_pk_bf16_f32 v255, v242, v243
ds_write_b64 v253, v[254:255] offset:4104
s_waitcnt lgkmcnt(0)
v_log_f32 v243, v229
v_max3_f32 v233, v148, v149, v150
v_max3_f32 v233, v233, v151, v243
v_mov_b32 v243, v233
s_nop 1
v_permlane32_swap_b32 v233, v243
s_nop 1
v_max_f32 v233, v233, v243
v_mov_b32 v243, v233
s_nop 1
v_permlane16_swap_b32 v233, v243
s_nop 1
v_max_f32 v233, v233, v243
v_ceil_f32 v233, v233
v_max_f32 v233, 0, v233
v_sub_f32 v243, 0, v233
v_exp_f32 v237, v243
s_nop 1
v_mul_f32 v229, v229, v237
v_add_f32 v245, v245, v233
v_sub_f32 v196, v196, v233
v_sub_f32 v132, v132, v233
v_sub_f32 v148, v148, v233
v_sub_f32 v197, v197, v233
v_sub_f32 v133, v133, v233
v_sub_f32 v149, v149, v233
v_sub_f32 v198, v198, v233
v_sub_f32 v134, v134, v233
v_sub_f32 v150, v150, v233
v_sub_f32 v199, v199, v233
v_sub_f32 v135, v135, v233
v_sub_f32 v151, v151, v233
v_lshlrev_b32 v242, 16, v180
v_and_b32 v243, 0xffff0000, v180
v_mul_f32 v242, v242, v237
v_mul_f32 v243, v243, v237
v_cvt_pk_bf16_f32 v180, v242, v243
v_lshlrev_b32 v242, 16, v181
v_and_b32 v243, 0xffff0000, v181
v_mul_f32 v242, v242, v237
v_mul_f32 v243, v243, v237
v_cvt_pk_bf16_f32 v181, v242, v243
ds_read_b64 v[254:255], v253 offset:1024
s_waitcnt lgkmcnt(0)
v_lshlrev_b32 v242, 16, v254
v_and_b32 v243, 0xffff0000, v254
v_mul_f32 v242, v242, v237
v_mul_f32 v243, v243, v237
v_cvt_pk_bf16_f32 v254, v242, v243
v_lshlrev_b32 v242, 16, v255
v_and_b32 v243, 0xffff0000, v255
v_mul_f32 v242, v242, v237
v_mul_f32 v243, v243, v237
v_cvt_pk_bf16_f32 v255, v242, v243
ds_write_b64 v253, v[254:255] offset:1024
s_waitcnt lgkmcnt(0)
ds_read_b64 v[254:255], v253 offset:1032
s_waitcnt lgkmcnt(0)
v_lshlrev_b32 v242, 16, v254
v_and_b32 v243, 0xffff0000, v254
v_mul_f32 v242, v242, v237
v_mul_f32 v243, v243, v237
v_cvt_pk_bf16_f32 v254, v242, v243
v_lshlrev_b32 v242, 16, v255
v_and_b32 v243, 0xffff0000, v255
v_mul_f32 v242, v242, v237
v_mul_f32 v243, v243, v237
v_cvt_pk_bf16_f32 v255, v242, v243
ds_write_b64 v253, v[254:255] offset:1032
s_waitcnt lgkmcnt(0)
ds_read_b64 v[254:255], v253 offset:5120
s_waitcnt lgkmcnt(0)
v_lshlrev_b32 v242, 16, v254
v_and_b32 v243, 0xffff0000, v254
v_mul_f32 v242, v242, v237
v_mul_f32 v243, v243, v237
v_cvt_pk_bf16_f32 v254, v242, v243
v_lshlrev_b32 v242, 16, v255
v_and_b32 v243, 0xffff0000, v255
v_mul_f32 v242, v242, v237
v_mul_f32 v243, v243, v237
v_cvt_pk_bf16_f32 v255, v242, v243
ds_write_b64 v253, v[254:255] offset:5120
s_waitcnt lgkmcnt(0)
ds_read_b64 v[254:255], v253 offset:5128
s_waitcnt lgkmcnt(0)
v_lshlrev_b32 v242, 16, v254
v_and_b32 v243, 0xffff0000, v254
v_mul_f32 v242, v242, v237
v_mul_f32 v243, v243, v237
v_cvt_pk_bf16_f32 v254, v242, v243
v_lshlrev_b32 v242, 16, v255
v_and_b32 v243, 0xffff0000, v255
v_mul_f32 v242, v242, v237
v_mul_f32 v243, v243, v237
v_cvt_pk_bf16_f32 v255, v242, v243
ds_write_b64 v253, v[254:255] offset:5128
s_waitcnt lgkmcnt(0)
v_log_f32 v243, v230
v_max3_f32 v234, v152, v153, v154
v_max3_f32 v234, v234, v155, v243
v_mov_b32 v243, v234
s_nop 1
v_permlane32_swap_b32 v234, v243
s_nop 1
v_max_f32 v234, v234, v243
v_mov_b32 v243, v234
s_nop 1
v_permlane16_swap_b32 v234, v243
s_nop 1
v_max_f32 v234, v234, v243
v_ceil_f32 v234, v234
v_max_f32 v234, 0, v234
v_sub_f32 v243, 0, v234
v_exp_f32 v238, v243
s_nop 1
v_mul_f32 v230, v230, v238
v_add_f32 v246, v246, v234
v_sub_f32 v200, v200, v234
v_sub_f32 v136, v136, v234
v_sub_f32 v152, v152, v234
v_sub_f32 v201, v201, v234
v_sub_f32 v137, v137, v234
v_sub_f32 v153, v153, v234
v_sub_f32 v202, v202, v234
v_sub_f32 v138, v138, v234
v_sub_f32 v154, v154, v234
v_sub_f32 v203, v203, v234
v_sub_f32 v139, v139, v234
v_sub_f32 v155, v155, v234
v_lshlrev_b32 v242, 16, v184
v_and_b32 v243, 0xffff0000, v184
v_mul_f32 v242, v242, v238
v_mul_f32 v243, v243, v238
v_cvt_pk_bf16_f32 v184, v242, v243
v_lshlrev_b32 v242, 16, v185
v_and_b32 v243, 0xffff0000, v185
v_mul_f32 v242, v242, v238
v_mul_f32 v243, v243, v238
v_cvt_pk_bf16_f32 v185, v242, v243
ds_read_b64 v[254:255], v253 offset:2048
s_waitcnt lgkmcnt(0)
v_lshlrev_b32 v242, 16, v254
v_and_b32 v243, 0xffff0000, v254
v_mul_f32 v242, v242, v238
v_mul_f32 v243, v243, v238
v_cvt_pk_bf16_f32 v254, v242, v243
v_lshlrev_b32 v242, 16, v255
v_and_b32 v243, 0xffff0000, v255
v_mul_f32 v242, v242, v238
v_mul_f32 v243, v243, v238
v_cvt_pk_bf16_f32 v255, v242, v243
ds_write_b64 v253, v[254:255] offset:2048
s_waitcnt lgkmcnt(0)
ds_read_b64 v[254:255], v253 offset:2056
s_waitcnt lgkmcnt(0)
v_lshlrev_b32 v242, 16, v254
v_and_b32 v243, 0xffff0000, v254
v_mul_f32 v242, v242, v238
v_mul_f32 v243, v243, v238
v_cvt_pk_bf16_f32 v254, v242, v243
v_lshlrev_b32 v242, 16, v255
v_and_b32 v243, 0xffff0000, v255
v_mul_f32 v242, v242, v238
v_mul_f32 v243, v243, v238
v_cvt_pk_bf16_f32 v255, v242, v243
ds_write_b64 v253, v[254:255] offset:2056
s_waitcnt lgkmcnt(0)
ds_read_b64 v[254:255], v253 offset:6144
s_waitcnt lgkmcnt(0)
v_lshlrev_b32 v242, 16, v254
v_and_b32 v243, 0xffff0000, v254
v_mul_f32 v242, v242, v238
v_mul_f32 v243, v243, v238
v_cvt_pk_bf16_f32 v254, v242, v243
v_lshlrev_b32 v242, 16, v255
v_and_b32 v243, 0xffff0000, v255
v_mul_f32 v242, v242, v238
v_mul_f32 v243, v243, v238
v_cvt_pk_bf16_f32 v255, v242, v243
ds_write_b64 v253, v[254:255] offset:6144
s_waitcnt lgkmcnt(0)
ds_read_b64 v[254:255], v253 offset:6152
s_waitcnt lgkmcnt(0)
v_lshlrev_b32 v242, 16, v254
v_and_b32 v243, 0xffff0000, v254
v_mul_f32 v242, v242, v238
v_mul_f32 v243, v243, v238
v_cvt_pk_bf16_f32 v254, v242, v243
v_lshlrev_b32 v242, 16, v255
v_and_b32 v243, 0xffff0000, v255
v_mul_f32 v242, v242, v238
v_mul_f32 v243, v243, v238
v_cvt_pk_bf16_f32 v255, v242, v243
ds_write_b64 v253, v[254:255] offset:6152
s_waitcnt lgkmcnt(0)
v_log_f32 v243, v231
v_max3_f32 v235, v156, v157, v158
v_max3_f32 v235, v235, v159, v243
v_mov_b32 v243, v235
s_nop 1
v_permlane32_swap_b32 v235, v243
s_nop 1
v_max_f32 v235, v235, v243
v_mov_b32 v243, v235
s_nop 1
v_permlane16_swap_b32 v235, v243
s_nop 1
v_max_f32 v235, v235, v243
v_ceil_f32 v235, v235
v_max_f32 v235, 0, v235
v_sub_f32 v243, 0, v235
v_exp_f32 v239, v243
s_nop 1
v_mul_f32 v231, v231, v239
v_add_f32 v247, v247, v235
v_sub_f32 v204, v204, v235
v_sub_f32 v140, v140, v235
v_sub_f32 v156, v156, v235
v_sub_f32 v205, v205, v235
v_sub_f32 v141, v141, v235
v_sub_f32 v157, v157, v235
v_sub_f32 v206, v206, v235
v_sub_f32 v142, v142, v235
v_sub_f32 v158, v158, v235
v_sub_f32 v207, v207, v235
v_sub_f32 v143, v143, v235
v_sub_f32 v159, v159, v235
v_lshlrev_b32 v242, 16, v188
v_and_b32 v243, 0xffff0000, v188
v_mul_f32 v242, v242, v239
v_mul_f32 v243, v243, v239
v_cvt_pk_bf16_f32 v188, v242, v243
v_lshlrev_b32 v242, 16, v189
v_and_b32 v243, 0xffff0000, v189
v_mul_f32 v242, v242, v239
v_mul_f32 v243, v243, v239
v_cvt_pk_bf16_f32 v189, v242, v243
ds_read_b64 v[254:255], v253 offset:3072
s_waitcnt lgkmcnt(0)
v_lshlrev_b32 v242, 16, v254
v_and_b32 v243, 0xffff0000, v254
v_mul_f32 v242, v242, v239
v_mul_f32 v243, v243, v239
v_cvt_pk_bf16_f32 v254, v242, v243
v_lshlrev_b32 v242, 16, v255
v_and_b32 v243, 0xffff0000, v255
v_mul_f32 v242, v242, v239
v_mul_f32 v243, v243, v239
v_cvt_pk_bf16_f32 v255, v242, v243
ds_write_b64 v253, v[254:255] offset:3072
s_waitcnt lgkmcnt(0)
ds_read_b64 v[254:255], v253 offset:3080
s_waitcnt lgkmcnt(0)
v_lshlrev_b32 v242, 16, v254
v_and_b32 v243, 0xffff0000, v254
v_mul_f32 v242, v242, v239
v_mul_f32 v243, v243, v239
v_cvt_pk_bf16_f32 v254, v242, v243
v_lshlrev_b32 v242, 16, v255
v_and_b32 v243, 0xffff0000, v255
v_mul_f32 v242, v242, v239
v_mul_f32 v243, v243, v239
v_cvt_pk_bf16_f32 v255, v242, v243
ds_write_b64 v253, v[254:255] offset:3080
s_waitcnt lgkmcnt(0)
ds_read_b64 v[254:255], v253 offset:7168
s_waitcnt lgkmcnt(0)
v_lshlrev_b32 v242, 16, v254
v_and_b32 v243, 0xffff0000, v254
v_mul_f32 v242, v242, v239
v_mul_f32 v243, v243, v239
v_cvt_pk_bf16_f32 v254, v242, v243
v_lshlrev_b32 v242, 16, v255
v_and_b32 v243, 0xffff0000, v255
v_mul_f32 v242, v242, v239
v_mul_f32 v243, v243, v239
v_cvt_pk_bf16_f32 v255, v242, v243
ds_write_b64 v253, v[254:255] offset:7168
s_waitcnt lgkmcnt(0)
ds_read_b64 v[254:255], v253 offset:7176
s_waitcnt lgkmcnt(0)
v_lshlrev_b32 v242, 16, v254
v_and_b32 v243, 0xffff0000, v254
v_mul_f32 v242, v242, v239
v_mul_f32 v243, v243, v239
v_cvt_pk_bf16_f32 v254, v242, v243
v_lshlrev_b32 v242, 16, v255
v_and_b32 v243, 0xffff0000, v255
v_mul_f32 v242, v242, v239
v_mul_f32 v243, v243, v239
v_cvt_pk_bf16_f32 v255, v242, v243
ds_write_b64 v253, v[254:255] offset:7176
s_waitcnt lgkmcnt(0)
v_exp_f32 v232, v144
v_exp_f32 v233, v145
v_exp_f32 v234, v146
v_exp_f32 v235, v147
s_nop 1
v_add_f32 v224, v228, v232
v_add_f32 v224, v224, v233
v_add_f32 v224, v224, v234
v_add_f32 v224, v224, v235
v_cvt_pk_bf16_f32 v178, v232, v233
v_cvt_pk_bf16_f32 v179, v234, v235
v_exp_f32 v232, v148
v_exp_f32 v233, v149
v_exp_f32 v234, v150
v_exp_f32 v235, v151
s_nop 1
v_add_f32 v225, v229, v232
v_add_f32 v225, v225, v233
v_add_f32 v225, v225, v234
v_add_f32 v225, v225, v235
v_cvt_pk_bf16_f32 v182, v232, v233
v_cvt_pk_bf16_f32 v183, v234, v235
v_exp_f32 v232, v152
v_exp_f32 v233, v153
v_exp_f32 v234, v154
v_exp_f32 v235, v155
s_nop 1
v_add_f32 v226, v230, v232
v_add_f32 v226, v226, v233
v_add_f32 v226, v226, v234
v_add_f32 v226, v226, v235
v_cvt_pk_bf16_f32 v186, v232, v233
v_cvt_pk_bf16_f32 v187, v234, v235
v_exp_f32 v232, v156
v_exp_f32 v233, v157
v_exp_f32 v234, v158
v_exp_f32 v235, v159
s_nop 1
v_add_f32 v227, v231, v232
v_add_f32 v227, v227, v233
v_add_f32 v227, v227, v234
v_add_f32 v227, v227, v235
v_cvt_pk_bf16_f32 v190, v232, v233
v_cvt_pk_bf16_f32 v191, v234, v235
s_branch L2_rare_common
L2_rare_site16:
s_mov_b32 s36, 16
s_branch L2_rare_t1_4_0
L2_rare_t1_4_0:
s_nop 15
s_nop 15
s_waitcnt lgkmcnt(0)
v_log_f32 v243, v224
v_max3_f32 v232, v128, v129, v130
v_max3_f32 v232, v232, v131, v243
v_mov_b32 v243, v232
s_nop 1
v_permlane32_swap_b32 v232, v243
s_nop 1
v_max_f32 v232, v232, v243
v_mov_b32 v243, v232
s_nop 1
v_permlane16_swap_b32 v232, v243
s_nop 1
v_max_f32 v232, v232, v243
v_ceil_f32 v232, v232
v_max_f32 v232, 0, v232
v_sub_f32 v243, 0, v232
v_exp_f32 v236, v243
s_nop 1
v_mul_f32 v224, v224, v236
v_add_f32 v244, v244, v232
v_sub_f32 v192, v192, v232
v_sub_f32 v128, v128, v232
v_sub_f32 v144, v144, v232
v_sub_f32 v193, v193, v232
v_sub_f32 v129, v129, v232
v_sub_f32 v145, v145, v232
v_sub_f32 v194, v194, v232
v_sub_f32 v130, v130, v232
v_sub_f32 v146, v146, v232
v_sub_f32 v195, v195, v232
v_sub_f32 v131, v131, v232
v_sub_f32 v147, v147, v232
v_lshlrev_b32 v242, 16, v176
v_and_b32 v243, 0xffff0000, v176
v_mul_f32 v242, v242, v236
v_mul_f32 v243, v243, v236
v_cvt_pk_bf16_f32 v176, v242, v243
v_lshlrev_b32 v242, 16, v177
v_and_b32 v243, 0xffff0000, v177
v_mul_f32 v242, v242, v236
v_mul_f32 v243, v243, v236
v_cvt_pk_bf16_f32 v177, v242, v243
v_lshlrev_b32 v242, 16, v178
v_and_b32 v243, 0xffff0000, v178
v_mul_f32 v242, v242, v236
v_mul_f32 v243, v243, v236
v_cvt_pk_bf16_f32 v178, v242, v243
v_lshlrev_b32 v242, 16, v179
v_and_b32 v243, 0xffff0000, v179
v_mul_f32 v242, v242, v236
v_mul_f32 v243, v243, v236
v_cvt_pk_bf16_f32 v179, v242, v243
ds_read_b64 v[254:255], v253 offset:0
s_waitcnt lgkmcnt(0)
v_lshlrev_b32 v242, 16, v254
v_and_b32 v243, 0xffff0000, v254
v_mul_f32 v242, v242, v236
v_mul_f32 v243, v243, v236
v_cvt_pk_bf16_f32 v254, v242, v243
v_lshlrev_b32 v242, 16, v255
v_and_b32 v243, 0xffff0000, v255
v_mul_f32 v242, v242, v236
v_mul_f32 v243, v243, v236
v_cvt_pk_bf16_f32 v255, v242, v243
ds_write_b64 v253, v[254:255] offset:0
s_waitcnt lgkmcnt(0)
ds_read_b64 v[254:255], v253 offset:8
s_waitcnt lgkmcnt(0)
v_lshlrev_b32 v242, 16, v254
v_and_b32 v243, 0xffff0000, v254
v_mul_f32 v242, v242, v236
v_mul_f32 v243, v243, v236
v_cvt_pk_bf16_f32 v254, v242, v243
v_lshlrev_b32 v242, 16, v255
v_and_b32 v243, 0xffff0000, v255
v_mul_f32 v242, v242, v236
v_mul_f32 v243, v243, v236
v_cvt_pk_bf16_f32 v255, v242, v243
ds_write_b64 v253, v[254:255] offset:8
s_waitcnt lgkmcnt(0)
ds_read_b64 v[254:255], v253 offset:4096
s_waitcnt lgkmcnt(0)
v_lshlrev_b32 v242, 16, v254
v_and_b32 v243, 0xffff0000, v254
v_mul_f32 v242, v242, v236
v_mul_f32 v243, v243, v236
v_cvt_pk_bf16_f32 v254, v242, v243
v_lshlrev_b32 v242, 16, v255
v_and_b32 v243, 0xffff0000, v255
v_mul_f32 v242, v242, v236
v_mul_f32 v243, v243, v236
v_cvt_pk_bf16_f32 v255, v242, v243
ds_write_b64 v253, v[254:255] offset:4096
s_waitcnt lgkmcnt(0)
ds_read_b64 v[254:255], v253 offset:4104
s_waitcnt lgkmcnt(0)
v_lshlrev_b32 v242, 16, v254
v_and_b32 v243, 0xffff0000, v254
v_mul_f32 v242, v242, v236
v_mul_f32 v243, v243, v236
v_cvt_pk_bf16_f32 v254, v242, v243
v_lshlrev_b32 v242, 16, v255
v_and_b32 v243, 0xffff0000, v255
v_mul_f32 v242, v242, v236
v_mul_f32 v243, v243, v236
v_cvt_pk_bf16_f32 v255, v242, v243
ds_write_b64 v253, v[254:255] offset:4104
s_waitcnt lgkmcnt(0)
v_log_f32 v243, v225
v_max3_f32 v233, v132, v133, v134
v_max3_f32 v233, v233, v135, v243
v_mov_b32 v243, v233
s_nop 1
v_permlane32_swap_b32 v233, v243
s_nop 1
v_max_f32 v233, v233, v243
v_mov_b32 v243, v233
s_nop 1
v_permlane16_swap_b32 v233, v243
s_nop 1
v_max_f32 v233, v233, v243
v_ceil_f32 v233, v233
v_max_f32 v233, 0, v233
v_sub_f32 v243, 0, v233
v_exp_f32 v237, v243
s_nop 1
v_mul_f32 v225, v225, v237
v_add_f32 v245, v245, v233
v_sub_f32 v196, v196, v233
v_sub_f32 v132, v132, v233
v_sub_f32 v148, v148, v233
v_sub_f32 v197, v197, v233
v_sub_f32 v133, v133, v233
v_sub_f32 v149, v149, v233
v_sub_f32 v198, v198, v233
v_sub_f32 v134, v134, v233
v_sub_f32 v150, v150, v233
v_sub_f32 v199, v199, v233
v_sub_f32 v135, v135, v233
v_sub_f32 v151, v151, v233
v_lshlrev_b32 v242, 16, v180
v_and_b32 v243, 0xffff0000, v180
v_mul_f32 v242, v242, v237
v_mul_f32 v243, v243, v237
v_cvt_pk_bf16_f32 v180, v242, v243
v_lshlrev_b32 v242, 16, v181
v_and_b32 v243, 0xffff0000, v181
v_mul_f32 v242, v242, v237
v_mul_f32 v243, v243, v237
v_cvt_pk_bf16_f32 v181, v242, v243
v_lshlrev_b32 v242, 16, v182
v_and_b32 v243, 0xffff0000, v182
v_mul_f32 v242, v242, v237
v_mul_f32 v243, v243, v237
v_cvt_pk_bf16_f32 v182, v242, v243
v_lshlrev_b32 v242, 16, v183
v_and_b32 v243, 0xffff0000, v183
v_mul_f32 v242, v242, v237
v_mul_f32 v243, v243, v237
v_cvt_pk_bf16_f32 v183, v242, v243
ds_read_b64 v[254:255], v253 offset:1024
s_waitcnt lgkmcnt(0)
v_lshlrev_b32 v242, 16, v254
v_and_b32 v243, 0xffff0000, v254
v_mul_f32 v242, v242, v237
v_mul_f32 v243, v243, v237
v_cvt_pk_bf16_f32 v254, v242, v243
v_lshlrev_b32 v242, 16, v255
v_and_b32 v243, 0xffff0000, v255
v_mul_f32 v242, v242, v237
v_mul_f32 v243, v243, v237
v_cvt_pk_bf16_f32 v255, v242, v243
ds_write_b64 v253, v[254:255] offset:1024
s_waitcnt lgkmcnt(0)
ds_read_b64 v[254:255], v253 offset:1032
s_waitcnt lgkmcnt(0)
v_lshlrev_b32 v242, 16, v254
v_and_b32 v243, 0xffff0000, v254
v_mul_f32 v242, v242, v237
v_mul_f32 v243, v243, v237
v_cvt_pk_bf16_f32 v254, v242, v243
v_lshlrev_b32 v242, 16, v255
v_and_b32 v243, 0xffff0000, v255
v_mul_f32 v242, v242, v237
v_mul_f32 v243, v243, v237
v_cvt_pk_bf16_f32 v255, v242, v243
ds_write_b64 v253, v[254:255] offset:1032
s_waitcnt lgkmcnt(0)
ds_read_b64 v[254:255], v253 offset:5120
s_waitcnt lgkmcnt(0)
v_lshlrev_b32 v242, 16, v254
v_and_b32 v243, 0xffff0000, v254
v_mul_f32 v242, v242, v237
v_mul_f32 v243, v243, v237
v_cvt_pk_bf16_f32 v254, v242, v243
v_lshlrev_b32 v242, 16, v255
v_and_b32 v243, 0xffff0000, v255
v_mul_f32 v242, v242, v237
v_mul_f32 v243, v243, v237
v_cvt_pk_bf16_f32 v255, v242, v243
ds_write_b64 v253, v[254:255] offset:5120
s_waitcnt lgkmcnt(0)
ds_read_b64 v[254:255], v253 offset:5128
s_waitcnt lgkmcnt(0)
v_lshlrev_b32 v242, 16, v254
v_and_b32 v243, 0xffff0000, v254
v_mul_f32 v242, v242, v237
v_mul_f32 v243, v243, v237
v_cvt_pk_bf16_f32 v254, v242, v243
v_lshlrev_b32 v242, 16, v255
v_and_b32 v243, 0xffff0000, v255
v_mul_f32 v242, v242, v237
v_mul_f32 v243, v243, v237
v_cvt_pk_bf16_f32 v255, v242, v243
ds_write_b64 v253, v[254:255] offset:5128
s_waitcnt lgkmcnt(0)
v_log_f32 v243, v226
v_max3_f32 v234, v136, v137, v138
v_max3_f32 v234, v234, v139, v243
v_mov_b32 v243, v234
s_nop 1
v_permlane32_swap_b32 v234, v243
s_nop 1
v_max_f32 v234, v234, v243
v_mov_b32 v243, v234
s_nop 1
v_permlane16_swap_b32 v234, v243
s_nop 1
v_max_f32 v234, v234, v243
v_ceil_f32 v234, v234
v_max_f32 v234, 0, v234
v_sub_f32 v243, 0, v234
v_exp_f32 v238, v243
s_nop 1
v_mul_f32 v226, v226, v238
v_add_f32 v246, v246, v234
v_sub_f32 v200, v200, v234
v_sub_f32 v136, v136, v234
v_sub_f32 v152, v152, v234
v_sub_f32 v201, v201, v234
v_sub_f32 v137, v137, v234
v_sub_f32 v153, v153, v234
v_sub_f32 v202, v202, v234
v_sub_f32 v138, v138, v234
v_sub_f32 v154, v154, v234
v_sub_f32 v203, v203, v234
v_sub_f32 v139, v139, v234
v_sub_f32 v155, v155, v234
v_lshlrev_b32 v242, 16, v184
v_and_b32 v243, 0xffff0000, v184
v_mul_f32 v242, v242, v238
v_mul_f32 v243, v243, v238
v_cvt_pk_bf16_f32 v184, v242, v243
v_lshlrev_b32 v242, 16, v185
v_and_b32 v243, 0xffff0000, v185
v_mul_f32 v242, v242, v238
v_mul_f32 v243, v243, v238
v_cvt_pk_bf16_f32 v185, v242, v243
v_lshlrev_b32 v242, 16, v186
v_and_b32 v243, 0xffff0000, v186
v_mul_f32 v242, v242, v238
v_mul_f32 v243, v243, v238
v_cvt_pk_bf16_f32 v186, v242, v243
v_lshlrev_b32 v242, 16, v187
v_and_b32 v243, 0xffff0000, v187
v_mul_f32 v242, v242, v238
v_mul_f32 v243, v243, v238
v_cvt_pk_bf16_f32 v187, v242, v243
ds_read_b64 v[254:255], v253 offset:2048
s_waitcnt lgkmcnt(0)
v_lshlrev_b32 v242, 16, v254
v_and_b32 v243, 0xffff0000, v254
v_mul_f32 v242, v242, v238
v_mul_f32 v243, v243, v238
v_cvt_pk_bf16_f32 v254, v242, v243
v_lshlrev_b32 v242, 16, v255
v_and_b32 v243, 0xffff0000, v255
v_mul_f32 v242, v242, v238
v_mul_f32 v243, v243, v238
v_cvt_pk_bf16_f32 v255, v242, v243
ds_write_b64 v253, v[254:255] offset:2048
s_waitcnt lgkmcnt(0)
ds_read_b64 v[254:255], v253 offset:2056
s_waitcnt lgkmcnt(0)
v_lshlrev_b32 v242, 16, v254
v_and_b32 v243, 0xffff0000, v254
v_mul_f32 v242, v242, v238
v_mul_f32 v243, v243, v238
v_cvt_pk_bf16_f32 v254, v242, v243
v_lshlrev_b32 v242, 16, v255
v_and_b32 v243, 0xffff0000, v255
v_mul_f32 v242, v242, v238
v_mul_f32 v243, v243, v238
v_cvt_pk_bf16_f32 v255, v242, v243
ds_write_b64 v253, v[254:255] offset:2056
s_waitcnt lgkmcnt(0)
ds_read_b64 v[254:255], v253 offset:6144
s_waitcnt lgkmcnt(0)
v_lshlrev_b32 v242, 16, v254
v_and_b32 v243, 0xffff0000, v254
v_mul_f32 v242, v242, v238
v_mul_f32 v243, v243, v238
v_cvt_pk_bf16_f32 v254, v242, v243
v_lshlrev_b32 v242, 16, v255
v_and_b32 v243, 0xffff0000, v255
v_mul_f32 v242, v242, v238
v_mul_f32 v243, v243, v238
v_cvt_pk_bf16_f32 v255, v242, v243
ds_write_b64 v253, v[254:255] offset:6144
s_waitcnt lgkmcnt(0)
ds_read_b64 v[254:255], v253 offset:6152
s_waitcnt lgkmcnt(0)
v_lshlrev_b32 v242, 16, v254
v_and_b32 v243, 0xffff0000, v254
v_mul_f32 v242, v242, v238
v_mul_f32 v243, v243, v238
v_cvt_pk_bf16_f32 v254, v242, v243
v_lshlrev_b32 v242, 16, v255
v_and_b32 v243, 0xffff0000, v255
v_mul_f32 v242, v242, v238
v_mul_f32 v243, v243, v238
v_cvt_pk_bf16_f32 v255, v242, v243
ds_write_b64 v253, v[254:255] offset:6152
s_waitcnt lgkmcnt(0)
v_log_f32 v243, v227
v_max3_f32 v235, v140, v141, v142
v_max3_f32 v235, v235, v143, v243
v_mov_b32 v243, v235
s_nop 1
v_permlane32_swap_b32 v235, v243
s_nop 1
v_max_f32 v235, v235, v243
v_mov_b32 v243, v235
s_nop 1
v_permlane16_swap_b32 v235, v243
s_nop 1
v_max_f32 v235, v235, v243
v_ceil_f32 v235, v235
v_max_f32 v235, 0, v235
v_sub_f32 v243, 0, v235
v_exp_f32 v239, v243
s_nop 1
v_mul_f32 v227, v227, v239
v_add_f32 v247, v247, v235
v_sub_f32 v204, v204, v235
v_sub_f32 v140, v140, v235
v_sub_f32 v156, v156, v235
v_sub_f32 v205, v205, v235
v_sub_f32 v141, v141, v235
v_sub_f32 v157, v157, v235
v_sub_f32 v206, v206, v235
v_sub_f32 v142, v142, v235
v_sub_f32 v158, v158, v235
v_sub_f32 v207, v207, v235
v_sub_f32 v143, v143, v235
v_sub_f32 v159, v159, v235
v_lshlrev_b32 v242, 16, v188
v_and_b32 v243, 0xffff0000, v188
v_mul_f32 v242, v242, v239
v_mul_f32 v243, v243, v239
v_cvt_pk_bf16_f32 v188, v242, v243
v_lshlrev_b32 v242, 16, v189
v_and_b32 v243, 0xffff0000, v189
v_mul_f32 v242, v242, v239
v_mul_f32 v243, v243, v239
v_cvt_pk_bf16_f32 v189, v242, v243
v_lshlrev_b32 v242, 16, v190
v_and_b32 v243, 0xffff0000, v190
v_mul_f32 v242, v242, v239
v_mul_f32 v243, v243, v239
v_cvt_pk_bf16_f32 v190, v242, v243
v_lshlrev_b32 v242, 16, v191
v_and_b32 v243, 0xffff0000, v191
v_mul_f32 v242, v242, v239
v_mul_f32 v243, v243, v239
v_cvt_pk_bf16_f32 v191, v242, v243
ds_read_b64 v[254:255], v253 offset:3072
s_waitcnt lgkmcnt(0)
v_lshlrev_b32 v242, 16, v254
v_and_b32 v243, 0xffff0000, v254
v_mul_f32 v242, v242, v239
v_mul_f32 v243, v243, v239
v_cvt_pk_bf16_f32 v254, v242, v243
v_lshlrev_b32 v242, 16, v255
v_and_b32 v243, 0xffff0000, v255
v_mul_f32 v242, v242, v239
v_mul_f32 v243, v243, v239
v_cvt_pk_bf16_f32 v255, v242, v243
ds_write_b64 v253, v[254:255] offset:3072
s_waitcnt lgkmcnt(0)
ds_read_b64 v[254:255], v253 offset:3080
s_waitcnt lgkmcnt(0)
v_lshlrev_b32 v242, 16, v254
v_and_b32 v243, 0xffff0000, v254
v_mul_f32 v242, v242, v239
v_mul_f32 v243, v243, v239
v_cvt_pk_bf16_f32 v254, v242, v243
v_lshlrev_b32 v242, 16, v255
v_and_b32 v243, 0xffff0000, v255
v_mul_f32 v242, v242, v239
v_mul_f32 v243, v243, v239
v_cvt_pk_bf16_f32 v255, v242, v243
ds_write_b64 v253, v[254:255] offset:3080
s_waitcnt lgkmcnt(0)
ds_read_b64 v[254:255], v253 offset:7168
s_waitcnt lgkmcnt(0)
v_lshlrev_b32 v242, 16, v254
v_and_b32 v243, 0xffff0000, v254
v_mul_f32 v242, v242, v239
v_mul_f32 v243, v243, v239
v_cvt_pk_bf16_f32 v254, v242, v243
v_lshlrev_b32 v242, 16, v255
v_and_b32 v243, 0xffff0000, v255
v_mul_f32 v242, v242, v239
v_mul_f32 v243, v243, v239
v_cvt_pk_bf16_f32 v255, v242, v243
ds_write_b64 v253, v[254:255] offset:7168
s_waitcnt lgkmcnt(0)
ds_read_b64 v[254:255], v253 offset:7176
s_waitcnt lgkmcnt(0)
v_lshlrev_b32 v242, 16, v254
v_and_b32 v243, 0xffff0000, v254
v_mul_f32 v242, v242, v239
v_mul_f32 v243, v243, v239
v_cvt_pk_bf16_f32 v254, v242, v243
v_lshlrev_b32 v242, 16, v255
v_and_b32 v243, 0xffff0000, v255
v_mul_f32 v242, v242, v239
v_mul_f32 v243, v243, v239
v_cvt_pk_bf16_f32 v255, v242, v243
ds_write_b64 v253, v[254:255] offset:7176
s_waitcnt lgkmcnt(0)
v_exp_f32 v232, v128
v_exp_f32 v233, v129
v_exp_f32 v234, v130
v_exp_f32 v235, v131
s_nop 1
v_add_f32 v228, v224, v232
v_add_f32 v228, v228, v233
v_add_f32 v228, v228, v234
v_add_f32 v228, v228, v235
v_cvt_pk_bf16_f32 v160, v232, v233
v_cvt_pk_bf16_f32 v161, v234, v235
v_exp_f32 v232, v132
v_exp_f32 v233, v133
v_exp_f32 v234, v134
v_exp_f32 v235, v135
s_nop 1
v_add_f32 v229, v225, v232
v_add_f32 v229, v229, v233
v_add_f32 v229, v229, v234
v_add_f32 v229, v229, v235
v_cvt_pk_bf16_f32 v164, v232, v233
v_cvt_pk_bf16_f32 v165, v234, v235
v_exp_f32 v232, v136
v_exp_f32 v233, v137
v_exp_f32 v234, v138
v_exp_f32 v235, v139
s_nop 1
v_add_f32 v230, v226, v232
v_add_f32 v230, v230, v233
v_add_f32 v230, v230, v234
v_add_f32 v230, v230, v235
v_cvt_pk_bf16_f32 v168, v232, v233
v_cvt_pk_bf16_f32 v169, v234, v235
v_exp_f32 v232, v140
v_exp_f32 v233, v141
v_exp_f32 v234, v142
v_exp_f32 v235, v143
s_nop 1
v_add_f32 v231, v227, v232
v_add_f32 v231, v231, v233
v_add_f32 v231, v231, v234
v_add_f32 v231, v231, v235
v_cvt_pk_bf16_f32 v172, v232, v233
v_cvt_pk_bf16_f32 v173, v234, v235
s_branch L2_rare_common
L2_rare_site17:
s_mov_b32 s36, 17
s_branch L2_rare_t1_5_1
L2_rare_t1_5_1:
s_nop 15
s_nop 15
s_waitcnt lgkmcnt(0)
v_log_f32 v243, v228
v_max3_f32 v232, v144, v145, v146
v_max3_f32 v232, v232, v147, v243
v_mov_b32 v243, v232
s_nop 1
v_permlane32_swap_b32 v232, v243
s_nop 1
v_max_f32 v232, v232, v243
v_mov_b32 v243, v232
s_nop 1
v_permlane16_swap_b32 v232, v243
s_nop 1
v_max_f32 v232, v232, v243
v_ceil_f32 v232, v232
v_max_f32 v232, 0, v232
v_sub_f32 v243, 0, v232
v_exp_f32 v236, v243
s_nop 1
v_mul_f32 v228, v228, v236
v_add_f32 v244, v244, v232
v_sub_f32 v192, v192, v232
v_sub_f32 v128, v128, v232
v_sub_f32 v144, v144, v232
v_sub_f32 v193, v193, v232
v_sub_f32 v129, v129, v232
v_sub_f32 v145, v145, v232
v_sub_f32 v194, v194, v232
v_sub_f32 v130, v130, v232
v_sub_f32 v146, v146, v232
v_sub_f32 v195, v195, v232
v_sub_f32 v131, v131, v232
v_sub_f32 v147, v147, v232
v_lshlrev_b32 v242, 16, v176
v_and_b32 v243, 0xffff0000, v176
v_mul_f32 v242, v242, v236
v_mul_f32 v243, v243, v236
v_cvt_pk_bf16_f32 v176, v242, v243
v_lshlrev_b32 v242, 16, v177
v_and_b32 v243, 0xffff0000, v177
v_mul_f32 v242, v242, v236
v_mul_f32 v243, v243, v236
v_cvt_pk_bf16_f32 v177, v242, v243
v_lshlrev_b32 v242, 16, v178
v_and_b32 v243, 0xffff0000, v178
v_mul_f32 v242, v242, v236
v_mul_f32 v243, v243, v236
v_cvt_pk_bf16_f32 v178, v242, v243
v_lshlrev_b32 v242, 16, v179
v_and_b32 v243, 0xffff0000, v179
v_mul_f32 v242, v242, v236
v_mul_f32 v243, v243, v236
v_cvt_pk_bf16_f32 v179, v242, v243
v_lshlrev_b32 v242, 16, v160
v_and_b32 v243, 0xffff0000, v160
v_mul_f32 v242, v242, v236
v_mul_f32 v243, v243, v236
v_cvt_pk_bf16_f32 v160, v242, v243
v_lshlrev_b32 v242, 16, v161
v_and_b32 v243, 0xffff0000, v161
v_mul_f32 v242, v242, v236
v_mul_f32 v243, v243, v236
v_cvt_pk_bf16_f32 v161, v242, v243
ds_read_b64 v[254:255], v253 offset:0
s_waitcnt lgkmcnt(0)
v_lshlrev_b32 v242, 16, v254
v_and_b32 v243, 0xffff0000, v254
v_mul_f32 v242, v242, v236
v_mul_f32 v243, v243, v236
v_cvt_pk_bf16_f32 v254, v242, v243
v_lshlrev_b32 v242, 16, v255
v_and_b32 v243, 0xffff0000, v255
v_mul_f32 v242, v242, v236
v_mul_f32 v243, v243, v236
v_cvt_pk_bf16_f32 v255, v242, v243
ds_write_b64 v253, v[254:255] offset:0
s_waitcnt lgkmcnt(0)
ds_read_b64 v[254:255], v253 offset:8
s_waitcnt lgkmcnt(0)
v_lshlrev_b32 v242, 16, v254
v_and_b32 v243, 0xffff0000, v254
v_mul_f32 v242, v242, v236
v_mul_f32 v243, v243, v236
v_cvt_pk_bf16_f32 v254, v242, v243
v_lshlrev_b32 v242, 16, v255
v_and_b32 v243, 0xffff0000, v255
v_mul_f32 v242, v242, v236
v_mul_f32 v243, v243, v236
v_cvt_pk_bf16_f32 v255, v242, v243
ds_write_b64 v253, v[254:255] offset:8
s_waitcnt lgkmcnt(0)
ds_read_b64 v[254:255], v253 offset:4096
s_waitcnt lgkmcnt(0)
v_lshlrev_b32 v242, 16, v254
v_and_b32 v243, 0xffff0000, v254
v_mul_f32 v242, v242, v236
v_mul_f32 v243, v243, v236
v_cvt_pk_bf16_f32 v254, v242, v243
v_lshlrev_b32 v242, 16, v255
v_and_b32 v243, 0xffff0000, v255
v_mul_f32 v242, v242, v236
v_mul_f32 v243, v243, v236
v_cvt_pk_bf16_f32 v255, v242, v243
ds_write_b64 v253, v[254:255] offset:4096
s_waitcnt lgkmcnt(0)
ds_read_b64 v[254:255], v253 offset:4104
s_waitcnt lgkmcnt(0)
v_lshlrev_b32 v242, 16, v254
v_and_b32 v243, 0xffff0000, v254
v_mul_f32 v242, v242, v236
v_mul_f32 v243, v243, v236
v_cvt_pk_bf16_f32 v254, v242, v243
v_lshlrev_b32 v242, 16, v255
v_and_b32 v243, 0xffff0000, v255
v_mul_f32 v242, v242, v236
v_mul_f32 v243, v243, v236
v_cvt_pk_bf16_f32 v255, v242, v243
ds_write_b64 v253, v[254:255] offset:4104
s_waitcnt lgkmcnt(0)
v_log_f32 v243, v229
v_max3_f32 v233, v148, v149, v150
v_max3_f32 v233, v233, v151, v243
v_mov_b32 v243, v233
s_nop 1
v_permlane32_swap_b32 v233, v243
s_nop 1
v_max_f32 v233, v233, v243
v_mov_b32 v243, v233
s_nop 1
v_permlane16_swap_b32 v233, v243
s_nop 1
v_max_f32 v233, v233, v243
v_ceil_f32 v233, v233
v_max_f32 v233, 0, v233
v_sub_f32 v243, 0, v233
v_exp_f32 v237, v243
s_nop 1
v_mul_f32 v229, v229, v237
v_add_f32 v245, v245, v233
v_sub_f32 v196, v196, v233
v_sub_f32 v132, v132, v233
v_sub_f32 v148, v148, v233
v_sub_f32 v197, v197, v233
v_sub_f32 v133, v133, v233
v_sub_f32 v149, v149, v233
v_sub_f32 v198, v198, v233
v_sub_f32 v134, v134, v233
v_sub_f32 v150, v150, v233
v_sub_f32 v199, v199, v233
v_sub_f32 v135, v135, v233
v_sub_f32 v151, v151, v233
v_lshlrev_b32 v242, 16, v180
v_and_b32 v243, 0xffff0000, v180
v_mul_f32 v242, v242, v237
v_mul_f32 v243, v243, v237
v_cvt_pk_bf16_f32 v180, v242, v243
v_lshlrev_b32 v242, 16, v181
v_and_b32 v243, 0xffff0000, v181
v_mul_f32 v242, v242, v237
v_mul_f32 v243, v243, v237
v_cvt_pk_bf16_f32 v181, v242, v243
v_lshlrev_b32 v242, 16, v182
v_and_b32 v243, 0xffff0000, v182
v_mul_f32 v242, v242, v237
v_mul_f32 v243, v243, v237
v_cvt_pk_bf16_f32 v182, v242, v243
v_lshlrev_b32 v242, 16, v183
v_and_b32 v243, 0xffff0000, v183
v_mul_f32 v242, v242, v237
v_mul_f32 v243, v243, v237
v_cvt_pk_bf16_f32 v183, v242, v243
v_lshlrev_b32 v242, 16, v164
v_and_b32 v243, 0xffff0000, v164
v_mul_f32 v242, v242, v237
v_mul_f32 v243, v243, v237
v_cvt_pk_bf16_f32 v164, v242, v243
v_lshlrev_b32 v242, 16, v165
v_and_b32 v243, 0xffff0000, v165
v_mul_f32 v242, v242, v237
v_mul_f32 v243, v243, v237
v_cvt_pk_bf16_f32 v165, v242, v243
ds_read_b64 v[254:255], v253 offset:1024
s_waitcnt lgkmcnt(0)
v_lshlrev_b32 v242, 16, v254
v_and_b32 v243, 0xffff0000, v254
v_mul_f32 v242, v242, v237
v_mul_f32 v243, v243, v237
v_cvt_pk_bf16_f32 v254, v242, v243
v_lshlrev_b32 v242, 16, v255
v_and_b32 v243, 0xffff0000, v255
v_mul_f32 v242, v242, v237
v_mul_f32 v243, v243, v237
v_cvt_pk_bf16_f32 v255, v242, v243
ds_write_b64 v253, v[254:255] offset:1024
s_waitcnt lgkmcnt(0)
ds_read_b64 v[254:255], v253 offset:1032
s_waitcnt lgkmcnt(0)
v_lshlrev_b32 v242, 16, v254
v_and_b32 v243, 0xffff0000, v254
v_mul_f32 v242, v242, v237
v_mul_f32 v243, v243, v237
v_cvt_pk_bf16_f32 v254, v242, v243
v_lshlrev_b32 v242, 16, v255
v_and_b32 v243, 0xffff0000, v255
v_mul_f32 v242, v242, v237
v_mul_f32 v243, v243, v237
v_cvt_pk_bf16_f32 v255, v242, v243
ds_write_b64 v253, v[254:255] offset:1032
s_waitcnt lgkmcnt(0)
ds_read_b64 v[254:255], v253 offset:5120
s_waitcnt lgkmcnt(0)
v_lshlrev_b32 v242, 16, v254
v_and_b32 v243, 0xffff0000, v254
v_mul_f32 v242, v242, v237
v_mul_f32 v243, v243, v237
v_cvt_pk_bf16_f32 v254, v242, v243
v_lshlrev_b32 v242, 16, v255
v_and_b32 v243, 0xffff0000, v255
v_mul_f32 v242, v242, v237
v_mul_f32 v243, v243, v237
v_cvt_pk_bf16_f32 v255, v242, v243
ds_write_b64 v253, v[254:255] offset:5120
s_waitcnt lgkmcnt(0)
ds_read_b64 v[254:255], v253 offset:5128
s_waitcnt lgkmcnt(0)
v_lshlrev_b32 v242, 16, v254
v_and_b32 v243, 0xffff0000, v254
v_mul_f32 v242, v242, v237
v_mul_f32 v243, v243, v237
v_cvt_pk_bf16_f32 v254, v242, v243
v_lshlrev_b32 v242, 16, v255
v_and_b32 v243, 0xffff0000, v255
v_mul_f32 v242, v242, v237
v_mul_f32 v243, v243, v237
v_cvt_pk_bf16_f32 v255, v242, v243
ds_write_b64 v253, v[254:255] offset:5128
s_waitcnt lgkmcnt(0)
v_log_f32 v243, v230
v_max3_f32 v234, v152, v153, v154
v_max3_f32 v234, v234, v155, v243
v_mov_b32 v243, v234
s_nop 1
v_permlane32_swap_b32 v234, v243
s_nop 1
v_max_f32 v234, v234, v243
v_mov_b32 v243, v234
s_nop 1
v_permlane16_swap_b32 v234, v243
s_nop 1
v_max_f32 v234, v234, v243
v_ceil_f32 v234, v234
v_max_f32 v234, 0, v234
v_sub_f32 v243, 0, v234
v_exp_f32 v238, v243
s_nop 1
v_mul_f32 v230, v230, v238
v_add_f32 v246, v246, v234
v_sub_f32 v200, v200, v234
v_sub_f32 v136, v136, v234
v_sub_f32 v152, v152, v234
v_sub_f32 v201, v201, v234
v_sub_f32 v137, v137, v234
v_sub_f32 v153, v153, v234
v_sub_f32 v202, v202, v234
v_sub_f32 v138, v138, v234
v_sub_f32 v154, v154, v234
v_sub_f32 v203, v203, v234
v_sub_f32 v139, v139, v234
v_sub_f32 v155, v155, v234
v_lshlrev_b32 v242, 16, v184
v_and_b32 v243, 0xffff0000, v184
v_mul_f32 v242, v242, v238
v_mul_f32 v243, v243, v238
v_cvt_pk_bf16_f32 v184, v242, v243
v_lshlrev_b32 v242, 16, v185
v_and_b32 v243, 0xffff0000, v185
v_mul_f32 v242, v242, v238
v_mul_f32 v243, v243, v238
v_cvt_pk_bf16_f32 v185, v242, v243
v_lshlrev_b32 v242, 16, v186
v_and_b32 v243, 0xffff0000, v186
v_mul_f32 v242, v242, v238
v_mul_f32 v243, v243, v238
v_cvt_pk_bf16_f32 v186, v242, v243
v_lshlrev_b32 v242, 16, v187
v_and_b32 v243, 0xffff0000, v187
v_mul_f32 v242, v242, v238
v_mul_f32 v243, v243, v238
v_cvt_pk_bf16_f32 v187, v242, v243
v_lshlrev_b32 v242, 16, v168
v_and_b32 v243, 0xffff0000, v168
v_mul_f32 v242, v242, v238
v_mul_f32 v243, v243, v238
v_cvt_pk_bf16_f32 v168, v242, v243
v_lshlrev_b32 v242, 16, v169
v_and_b32 v243, 0xffff0000, v169
v_mul_f32 v242, v242, v238
v_mul_f32 v243, v243, v238
v_cvt_pk_bf16_f32 v169, v242, v243
ds_read_b64 v[254:255], v253 offset:2048
s_waitcnt lgkmcnt(0)
v_lshlrev_b32 v242, 16, v254
v_and_b32 v243, 0xffff0000, v254
v_mul_f32 v242, v242, v238
v_mul_f32 v243, v243, v238
v_cvt_pk_bf16_f32 v254, v242, v243
v_lshlrev_b32 v242, 16, v255
v_and_b32 v243, 0xffff0000, v255
v_mul_f32 v242, v242, v238
v_mul_f32 v243, v243, v238
v_cvt_pk_bf16_f32 v255, v242, v243
ds_write_b64 v253, v[254:255] offset:2048
s_waitcnt lgkmcnt(0)
ds_read_b64 v[254:255], v253 offset:2056
s_waitcnt lgkmcnt(0)
v_lshlrev_b32 v242, 16, v254
v_and_b32 v243, 0xffff0000, v254
v_mul_f32 v242, v242, v238
v_mul_f32 v243, v243, v238
v_cvt_pk_bf16_f32 v254, v242, v243
v_lshlrev_b32 v242, 16, v255
v_and_b32 v243, 0xffff0000, v255
v_mul_f32 v242, v242, v238
v_mul_f32 v243, v243, v238
v_cvt_pk_bf16_f32 v255, v242, v243
ds_write_b64 v253, v[254:255] offset:2056
s_waitcnt lgkmcnt(0)
ds_read_b64 v[254:255], v253 offset:6144
s_waitcnt lgkmcnt(0)
v_lshlrev_b32 v242, 16, v254
v_and_b32 v243, 0xffff0000, v254
v_mul_f32 v242, v242, v238
v_mul_f32 v243, v243, v238
v_cvt_pk_bf16_f32 v254, v242, v243
v_lshlrev_b32 v242, 16, v255
v_and_b32 v243, 0xffff0000, v255
v_mul_f32 v242, v242, v238
v_mul_f32 v243, v243, v238
v_cvt_pk_bf16_f32 v255, v242, v243
ds_write_b64 v253, v[254:255] offset:6144
s_waitcnt lgkmcnt(0)
ds_read_b64 v[254:255], v253 offset:6152
s_waitcnt lgkmcnt(0)
v_lshlrev_b32 v242, 16, v254
v_and_b32 v243, 0xffff0000, v254
v_mul_f32 v242, v242, v238
v_mul_f32 v243, v243, v238
v_cvt_pk_bf16_f32 v254, v242, v243
v_lshlrev_b32 v242, 16, v255
v_and_b32 v243, 0xffff0000, v255
v_mul_f32 v242, v242, v238
v_mul_f32 v243, v243, v238
v_cvt_pk_bf16_f32 v255, v242, v243
ds_write_b64 v253, v[254:255] offset:6152
s_waitcnt lgkmcnt(0)
v_log_f32 v243, v231
v_max3_f32 v235, v156, v157, v158
v_max3_f32 v235, v235, v159, v243
v_mov_b32 v243, v235
s_nop 1
v_permlane32_swap_b32 v235, v243
s_nop 1
v_max_f32 v235, v235, v243
v_mov_b32 v243, v235
s_nop 1
v_permlane16_swap_b32 v235, v243
s_nop 1
v_max_f32 v235, v235, v243
v_ceil_f32 v235, v235
v_max_f32 v235, 0, v235
v_sub_f32 v243, 0, v235
v_exp_f32 v239, v243
s_nop 1
v_mul_f32 v231, v231, v239
v_add_f32 v247, v247, v235
v_sub_f32 v204, v204, v235
v_sub_f32 v140, v140, v235
v_sub_f32 v156, v156, v235
v_sub_f32 v205, v205, v235
v_sub_f32 v141, v141, v235
v_sub_f32 v157, v157, v235
v_sub_f32 v206, v206, v235
v_sub_f32 v142, v142, v235
v_sub_f32 v158, v158, v235
v_sub_f32 v207, v207, v235
v_sub_f32 v143, v143, v235
v_sub_f32 v159, v159, v235
v_lshlrev_b32 v242, 16, v188
v_and_b32 v243, 0xffff0000, v188
v_mul_f32 v242, v242, v239
v_mul_f32 v243, v243, v239
v_cvt_pk_bf16_f32 v188, v242, v243
v_lshlrev_b32 v242, 16, v189
v_and_b32 v243, 0xffff0000, v189
v_mul_f32 v242, v242, v239
v_mul_f32 v243, v243, v239
v_cvt_pk_bf16_f32 v189, v242, v243
v_lshlrev_b32 v242, 16, v190
v_and_b32 v243, 0xffff0000, v190
v_mul_f32 v242, v242, v239
v_mul_f32 v243, v243, v239
v_cvt_pk_bf16_f32 v190, v242, v243
v_lshlrev_b32 v242, 16, v191
v_and_b32 v243, 0xffff0000, v191
v_mul_f32 v242, v242, v239
v_mul_f32 v243, v243, v239
v_cvt_pk_bf16_f32 v191, v242, v243
v_lshlrev_b32 v242, 16, v172
v_and_b32 v243, 0xffff0000, v172
v_mul_f32 v242, v242, v239
v_mul_f32 v243, v243, v239
v_cvt_pk_bf16_f32 v172, v242, v243
v_lshlrev_b32 v242, 16, v173
v_and_b32 v243, 0xffff0000, v173
v_mul_f32 v242, v242, v239
v_mul_f32 v243, v243, v239
v_cvt_pk_bf16_f32 v173, v242, v243
ds_read_b64 v[254:255], v253 offset:3072
s_waitcnt lgkmcnt(0)
v_lshlrev_b32 v242, 16, v254
v_and_b32 v243, 0xffff0000, v254
v_mul_f32 v242, v242, v239
v_mul_f32 v243, v243, v239
v_cvt_pk_bf16_f32 v254, v242, v243
v_lshlrev_b32 v242, 16, v255
v_and_b32 v243, 0xffff0000, v255
v_mul_f32 v242, v242, v239
v_mul_f32 v243, v243, v239
v_cvt_pk_bf16_f32 v255, v242, v243
ds_write_b64 v253, v[254:255] offset:3072
s_waitcnt lgkmcnt(0)
ds_read_b64 v[254:255], v253 offset:3080
s_waitcnt lgkmcnt(0)
v_lshlrev_b32 v242, 16, v254
v_and_b32 v243, 0xffff0000, v254
v_mul_f32 v242, v242, v239
v_mul_f32 v243, v243, v239
v_cvt_pk_bf16_f32 v254, v242, v243
v_lshlrev_b32 v242, 16, v255
v_and_b32 v243, 0xffff0000, v255
v_mul_f32 v242, v242, v239
v_mul_f32 v243, v243, v239
v_cvt_pk_bf16_f32 v255, v242, v243
ds_write_b64 v253, v[254:255] offset:3080
s_waitcnt lgkmcnt(0)
ds_read_b64 v[254:255], v253 offset:7168
s_waitcnt lgkmcnt(0)
v_lshlrev_b32 v242, 16, v254
v_and_b32 v243, 0xffff0000, v254
v_mul_f32 v242, v242, v239
v_mul_f32 v243, v243, v239
v_cvt_pk_bf16_f32 v254, v242, v243
v_lshlrev_b32 v242, 16, v255
v_and_b32 v243, 0xffff0000, v255
v_mul_f32 v242, v242, v239
v_mul_f32 v243, v243, v239
v_cvt_pk_bf16_f32 v255, v242, v243
ds_write_b64 v253, v[254:255] offset:7168
s_waitcnt lgkmcnt(0)
ds_read_b64 v[254:255], v253 offset:7176
s_waitcnt lgkmcnt(0)
v_lshlrev_b32 v242, 16, v254
v_and_b32 v243, 0xffff0000, v254
v_mul_f32 v242, v242, v239
v_mul_f32 v243, v243, v239
v_cvt_pk_bf16_f32 v254, v242, v243
v_lshlrev_b32 v242, 16, v255
v_and_b32 v243, 0xffff0000, v255
v_mul_f32 v242, v242, v239
v_mul_f32 v243, v243, v239
v_cvt_pk_bf16_f32 v255, v242, v243
ds_write_b64 v253, v[254:255] offset:7176
s_waitcnt lgkmcnt(0)
v_exp_f32 v232, v144
v_exp_f32 v233, v145
v_exp_f32 v234, v146
v_exp_f32 v235, v147
s_nop 1
v_add_f32 v224, v228, v232
v_add_f32 v224, v224, v233
v_add_f32 v224, v224, v234
v_add_f32 v224, v224, v235
v_cvt_pk_bf16_f32 v162, v232, v233
v_cvt_pk_bf16_f32 v163, v234, v235
v_exp_f32 v232, v148
v_exp_f32 v233, v149
v_exp_f32 v234, v150
v_exp_f32 v235, v151
s_nop 1
v_add_f32 v225, v229, v232
v_add_f32 v225, v225, v233
v_add_f32 v225, v225, v234
v_add_f32 v225, v225, v235
v_cvt_pk_bf16_f32 v166, v232, v233
v_cvt_pk_bf16_f32 v167, v234, v235
v_exp_f32 v232, v152
v_exp_f32 v233, v153
v_exp_f32 v234, v154
v_exp_f32 v235, v155
s_nop 1
v_add_f32 v226, v230, v232
v_add_f32 v226, v226, v233
v_add_f32 v226, v226, v234
v_add_f32 v226, v226, v235
v_cvt_pk_bf16_f32 v170, v232, v233
v_cvt_pk_bf16_f32 v171, v234, v235
v_exp_f32 v232, v156
v_exp_f32 v233, v157
v_exp_f32 v234, v158
v_exp_f32 v235, v159
s_nop 1
v_add_f32 v227, v231, v232
v_add_f32 v227, v227, v233
v_add_f32 v227, v227, v234
v_add_f32 v227, v227, v235
v_cvt_pk_bf16_f32 v174, v232, v233
v_cvt_pk_bf16_f32 v175, v234, v235
s_branch L2_rare_common
L2_rare_site18:
s_mov_b32 s36, 18
s_branch L2_rare_t1_6_0
L2_rare_t1_6_0:
s_nop 15
s_nop 15
s_waitcnt lgkmcnt(0)
v_log_f32 v243, v224
v_max3_f32 v232, v128, v129, v130
v_max3_f32 v232, v232, v131, v243
v_mov_b32 v243, v232
s_nop 1
v_permlane32_swap_b32 v232, v243
s_nop 1
v_max_f32 v232, v232, v243
v_mov_b32 v243, v232
s_nop 1
v_permlane16_swap_b32 v232, v243
s_nop 1
v_max_f32 v232, v232, v243
v_ceil_f32 v232, v232
v_max_f32 v232, 0, v232
v_sub_f32 v243, 0, v232
v_exp_f32 v236, v243
s_nop 1
v_mul_f32 v224, v224, v236
v_add_f32 v244, v244, v232
v_sub_f32 v192, v192, v232
v_sub_f32 v128, v128, v232
v_sub_f32 v144, v144, v232
v_sub_f32 v193, v193, v232
v_sub_f32 v129, v129, v232
v_sub_f32 v145, v145, v232
v_sub_f32 v194, v194, v232
v_sub_f32 v130, v130, v232
v_sub_f32 v146, v146, v232
v_sub_f32 v195, v195, v232
v_sub_f32 v131, v131, v232
v_sub_f32 v147, v147, v232
v_lshlrev_b32 v242, 16, v4
v_and_b32 v243, 0xffff0000, v4
v_mul_f32 v242, v242, v236
v_mul_f32 v243, v243, v236
v_cvt_pk_bf16_f32 v4, v242, v243
v_lshlrev_b32 v242, 16, v5
v_and_b32 v243, 0xffff0000, v5
v_mul_f32 v242, v242, v236
v_mul_f32 v243, v243, v236
v_cvt_pk_bf16_f32 v5, v242, v243
v_lshlrev_b32 v242, 16, v6
v_and_b32 v243, 0xffff0000, v6
v_mul_f32 v242, v242, v236
v_mul_f32 v243, v243, v236
v_cvt_pk_bf16_f32 v6, v242, v243
v_lshlrev_b32 v242, 16, v7
v_and_b32 v243, 0xffff0000, v7
v_mul_f32 v242, v242, v236
v_mul_f32 v243, v243, v236
v_cvt_pk_bf16_f32 v7, v242, v243
v_lshlrev_b32 v242, 16, v8
v_and_b32 v243, 0xffff0000, v8
v_mul_f32 v242, v242, v236
v_mul_f32 v243, v243, v236
v_cvt_pk_bf16_f32 v8, v242, v243
v_lshlrev_b32 v242, 16, v9
v_and_b32 v243, 0xffff0000, v9
v_mul_f32 v242, v242, v236
v_mul_f32 v243, v243, v236
v_cvt_pk_bf16_f32 v9, v242, v243
v_lshlrev_b32 v242, 16, v10
v_and_b32 v243, 0xffff0000, v10
v_mul_f32 v242, v242, v236
v_mul_f32 v243, v243, v236
v_cvt_pk_bf16_f32 v10, v242, v243
v_lshlrev_b32 v242, 16, v11
v_and_b32 v243, 0xffff0000, v11
v_mul_f32 v242, v242, v236
v_mul_f32 v243, v243, v236
v_cvt_pk_bf16_f32 v11, v242, v243
v_lshlrev_b32 v242, 16, v176
v_and_b32 v243, 0xffff0000, v176
v_mul_f32 v242, v242, v236
v_mul_f32 v243, v243, v236
v_cvt_pk_bf16_f32 v176, v242, v243
v_lshlrev_b32 v242, 16, v177
v_and_b32 v243, 0xffff0000, v177
v_mul_f32 v242, v242, v236
v_mul_f32 v243, v243, v236
v_cvt_pk_bf16_f32 v177, v242, v243
v_lshlrev_b32 v242, 16, v178
v_and_b32 v243, 0xffff0000, v178
v_mul_f32 v242, v242, v236
v_mul_f32 v243, v243, v236
v_cvt_pk_bf16_f32 v178, v242, v243
v_lshlrev_b32 v242, 16, v179
v_and_b32 v243, 0xffff0000, v179
v_mul_f32 v242, v242, v236
v_mul_f32 v243, v243, v236
v_cvt_pk_bf16_f32 v179, v242, v243
v_lshlrev_b32 v242, 16, v160
v_and_b32 v243, 0xffff0000, v160
v_mul_f32 v242, v242, v236
v_mul_f32 v243, v243, v236
v_cvt_pk_bf16_f32 v160, v242, v243
v_lshlrev_b32 v242, 16, v161
v_and_b32 v243, 0xffff0000, v161
v_mul_f32 v242, v242, v236
v_mul_f32 v243, v243, v236
v_cvt_pk_bf16_f32 v161, v242, v243
v_lshlrev_b32 v242, 16, v162
v_and_b32 v243, 0xffff0000, v162
v_mul_f32 v242, v242, v236
v_mul_f32 v243, v243, v236
v_cvt_pk_bf16_f32 v162, v242, v243
v_lshlrev_b32 v242, 16, v163
v_and_b32 v243, 0xffff0000, v163
v_mul_f32 v242, v242, v236
v_mul_f32 v243, v243, v236
v_cvt_pk_bf16_f32 v163, v242, v243
v_log_f32 v243, v225
v_max3_f32 v233, v132, v133, v134
v_max3_f32 v233, v233, v135, v243
v_mov_b32 v243, v233
s_nop 1
v_permlane32_swap_b32 v233, v243
s_nop 1
v_max_f32 v233, v233, v243
v_mov_b32 v243, v233
s_nop 1
v_permlane16_swap_b32 v233, v243
s_nop 1
v_max_f32 v233, v233, v243
v_ceil_f32 v233, v233
v_max_f32 v233, 0, v233
v_sub_f32 v243, 0, v233
v_exp_f32 v237, v243
s_nop 1
v_mul_f32 v225, v225, v237
v_add_f32 v245, v245, v233
v_sub_f32 v196, v196, v233
v_sub_f32 v132, v132, v233
v_sub_f32 v148, v148, v233
v_sub_f32 v197, v197, v233
v_sub_f32 v133, v133, v233
v_sub_f32 v149, v149, v233
v_sub_f32 v198, v198, v233
v_sub_f32 v134, v134, v233
v_sub_f32 v150, v150, v233
v_sub_f32 v199, v199, v233
v_sub_f32 v135, v135, v233
v_sub_f32 v151, v151, v233
v_lshlrev_b32 v242, 16, v36
v_and_b32 v243, 0xffff0000, v36
v_mul_f32 v242, v242, v237
v_mul_f32 v243, v243, v237
v_cvt_pk_bf16_f32 v36, v242, v243
v_lshlrev_b32 v242, 16, v37
v_and_b32 v243, 0xffff0000, v37
v_mul_f32 v242, v242, v237
v_mul_f32 v243, v243, v237
v_cvt_pk_bf16_f32 v37, v242, v243
v_lshlrev_b32 v242, 16, v38
v_and_b32 v243, 0xffff0000, v38
v_mul_f32 v242, v242, v237
v_mul_f32 v243, v243, v237
v_cvt_pk_bf16_f32 v38, v242, v243
v_lshlrev_b32 v242, 16, v39
v_and_b32 v243, 0xffff0000, v39
v_mul_f32 v242, v242, v237
v_mul_f32 v243, v243, v237
v_cvt_pk_bf16_f32 v39, v242, v243
v_lshlrev_b32 v242, 16, v40
v_and_b32 v243, 0xffff0000, v40
v_mul_f32 v242, v242, v237
v_mul_f32 v243, v243, v237
v_cvt_pk_bf16_f32 v40, v242, v243
v_lshlrev_b32 v242, 16, v41
v_and_b32 v243, 0xffff0000, v41
v_mul_f32 v242, v242, v237
v_mul_f32 v243, v243, v237
v_cvt_pk_bf16_f32 v41, v242, v243
v_lshlrev_b32 v242, 16, v42
v_and_b32 v243, 0xffff0000, v42
v_mul_f32 v242, v242, v237
v_mul_f32 v243, v243, v237
v_cvt_pk_bf16_f32 v42, v242, v243
v_lshlrev_b32 v242, 16, v43
v_and_b32 v243, 0xffff0000, v43
v_mul_f32 v242, v242, v237
v_mul_f32 v243, v243, v237
v_cvt_pk_bf16_f32 v43, v242, v243
v_lshlrev_b32 v242, 16, v180
v_and_b32 v243, 0xffff0000, v180
v_mul_f32 v242, v242, v237
v_mul_f32 v243, v243, v237
v_cvt_pk_bf16_f32 v180, v242, v243
v_lshlrev_b32 v242, 16, v181
v_and_b32 v243, 0xffff0000, v181
v_mul_f32 v242, v242, v237
v_mul_f32 v243, v243, v237
v_cvt_pk_bf16_f32 v181, v242, v243
v_lshlrev_b32 v242, 16, v182
v_and_b32 v243, 0xffff0000, v182
v_mul_f32 v242, v242, v237
v_mul_f32 v243, v243, v237
v_cvt_pk_bf16_f32 v182, v242, v243
v_lshlrev_b32 v242, 16, v183
v_and_b32 v243, 0xffff0000, v183
v_mul_f32 v242, v242, v237
v_mul_f32 v243, v243, v237
v_cvt_pk_bf16_f32 v183, v242, v243
v_lshlrev_b32 v242, 16, v164
v_and_b32 v243, 0xffff0000, v164
v_mul_f32 v242, v242, v237
v_mul_f32 v243, v243, v237
v_cvt_pk_bf16_f32 v164, v242, v243
v_lshlrev_b32 v242, 16, v165
v_and_b32 v243, 0xffff0000, v165
v_mul_f32 v242, v242, v237
v_mul_f32 v243, v243, v237
v_cvt_pk_bf16_f32 v165, v242, v243
v_lshlrev_b32 v242, 16, v166
v_and_b32 v243, 0xffff0000, v166
v_mul_f32 v242, v242, v237
v_mul_f32 v243, v243, v237
v_cvt_pk_bf16_f32 v166, v242, v243
v_lshlrev_b32 v242, 16, v167
v_and_b32 v243, 0xffff0000, v167
v_mul_f32 v242, v242, v237
v_mul_f32 v243, v243, v237
v_cvt_pk_bf16_f32 v167, v242, v243
v_log_f32 v243, v226
v_max3_f32 v234, v136, v137, v138
v_max3_f32 v234, v234, v139, v243
v_mov_b32 v243, v234
s_nop 1
v_permlane32_swap_b32 v234, v243
s_nop 1
v_max_f32 v234, v234, v243
v_mov_b32 v243, v234
s_nop 1
v_permlane16_swap_b32 v234, v243
s_nop 1
v_max_f32 v234, v234, v243
v_ceil_f32 v234, v234
v_max_f32 v234, 0, v234
v_sub_f32 v243, 0, v234
v_exp_f32 v238, v243
s_nop 1
v_mul_f32 v226, v226, v238
v_add_f32 v246, v246, v234
v_sub_f32 v200, v200, v234
v_sub_f32 v136, v136, v234
v_sub_f32 v152, v152, v234
v_sub_f32 v201, v201, v234
v_sub_f32 v137, v137, v234
v_sub_f32 v153, v153, v234
v_sub_f32 v202, v202, v234
v_sub_f32 v138, v138, v234
v_sub_f32 v154, v154, v234
v_sub_f32 v203, v203, v234
v_sub_f32 v139, v139, v234
v_sub_f32 v155, v155, v234
v_lshlrev_b32 v242, 16, v68
v_and_b32 v243, 0xffff0000, v68
v_mul_f32 v242, v242, v238
v_mul_f32 v243, v243, v238
v_cvt_pk_bf16_f32 v68, v242, v243
v_lshlrev_b32 v242, 16, v69
v_and_b32 v243, 0xffff0000, v69
v_mul_f32 v242, v242, v238
v_mul_f32 v243, v243, v238
v_cvt_pk_bf16_f32 v69, v242, v243
v_lshlrev_b32 v242, 16, v70
v_and_b32 v243, 0xffff0000, v70
v_mul_f32 v242, v242, v238
v_mul_f32 v243, v243, v238
v_cvt_pk_bf16_f32 v70, v242, v243
v_lshlrev_b32 v242, 16, v71
v_and_b32 v243, 0xffff0000, v71
v_mul_f32 v242, v242, v238
v_mul_f32 v243, v243, v238
v_cvt_pk_bf16_f32 v71, v242, v243
v_lshlrev_b32 v242, 16, v72
v_and_b32 v243, 0xffff0000, v72
v_mul_f32 v242, v242, v238
v_mul_f32 v243, v243, v238
v_cvt_pk_bf16_f32 v72, v242, v243
v_lshlrev_b32 v242, 16, v73
v_and_b32 v243, 0xffff0000, v73
v_mul_f32 v242, v242, v238
v_mul_f32 v243, v243, v238
v_cvt_pk_bf16_f32 v73, v242, v243
v_lshlrev_b32 v242, 16, v74
v_and_b32 v243, 0xffff0000, v74
v_mul_f32 v242, v242, v238
v_mul_f32 v243, v243, v238
v_cvt_pk_bf16_f32 v74, v242, v243
v_lshlrev_b32 v242, 16, v75
v_and_b32 v243, 0xffff0000, v75
v_mul_f32 v242, v242, v238
v_mul_f32 v243, v243, v238
v_cvt_pk_bf16_f32 v75, v242, v243
v_lshlrev_b32 v242, 16, v184
v_and_b32 v243, 0xffff0000, v184
v_mul_f32 v242, v242, v238
v_mul_f32 v243, v243, v238
v_cvt_pk_bf16_f32 v184, v242, v243
v_lshlrev_b32 v242, 16, v185
v_and_b32 v243, 0xffff0000, v185
v_mul_f32 v242, v242, v238
v_mul_f32 v243, v243, v238
v_cvt_pk_bf16_f32 v185, v242, v243
v_lshlrev_b32 v242, 16, v186
v_and_b32 v243, 0xffff0000, v186
v_mul_f32 v242, v242, v238
v_mul_f32 v243, v243, v238
v_cvt_pk_bf16_f32 v186, v242, v243
v_lshlrev_b32 v242, 16, v187
v_and_b32 v243, 0xffff0000, v187
v_mul_f32 v242, v242, v238
v_mul_f32 v243, v243, v238
v_cvt_pk_bf16_f32 v187, v242, v243
v_lshlrev_b32 v242, 16, v168
v_and_b32 v243, 0xffff0000, v168
v_mul_f32 v242, v242, v238
v_mul_f32 v243, v243, v238
v_cvt_pk_bf16_f32 v168, v242, v243
v_lshlrev_b32 v242, 16, v169
v_and_b32 v243, 0xffff0000, v169
v_mul_f32 v242, v242, v238
v_mul_f32 v243, v243, v238
v_cvt_pk_bf16_f32 v169, v242, v243
v_lshlrev_b32 v242, 16, v170
v_and_b32 v243, 0xffff0000, v170
v_mul_f32 v242, v242, v238
v_mul_f32 v243, v243, v238
v_cvt_pk_bf16_f32 v170, v242, v243
v_lshlrev_b32 v242, 16, v171
v_and_b32 v243, 0xffff0000, v171
v_mul_f32 v242, v242, v238
v_mul_f32 v243, v243, v238
v_cvt_pk_bf16_f32 v171, v242, v243
v_log_f32 v243, v227
v_max3_f32 v235, v140, v141, v142
v_max3_f32 v235, v235, v143, v243
v_mov_b32 v243, v235
s_nop 1
v_permlane32_swap_b32 v235, v243
s_nop 1
v_max_f32 v235, v235, v243
v_mov_b32 v243, v235
s_nop 1
v_permlane16_swap_b32 v235, v243
s_nop 1
v_max_f32 v235, v235, v243
v_ceil_f32 v235, v235
v_max_f32 v235, 0, v235
v_sub_f32 v243, 0, v235
v_exp_f32 v239, v243
s_nop 1
v_mul_f32 v227, v227, v239
v_add_f32 v247, v247, v235
v_sub_f32 v204, v204, v235
v_sub_f32 v140, v140, v235
v_sub_f32 v156, v156, v235
v_sub_f32 v205, v205, v235
v_sub_f32 v141, v141, v235
v_sub_f32 v157, v157, v235
v_sub_f32 v206, v206, v235
v_sub_f32 v142, v142, v235
v_sub_f32 v158, v158, v235
v_sub_f32 v207, v207, v235
v_sub_f32 v143, v143, v235
v_sub_f32 v159, v159, v235
v_lshlrev_b32 v242, 16, v100
v_and_b32 v243, 0xffff0000, v100
v_mul_f32 v242, v242, v239
v_mul_f32 v243, v243, v239
v_cvt_pk_bf16_f32 v100, v242, v243
v_lshlrev_b32 v242, 16, v101
v_and_b32 v243, 0xffff0000, v101
v_mul_f32 v242, v242, v239
v_mul_f32 v243, v243, v239
v_cvt_pk_bf16_f32 v101, v242, v243
v_lshlrev_b32 v242, 16, v102
v_and_b32 v243, 0xffff0000, v102
v_mul_f32 v242, v242, v239
v_mul_f32 v243, v243, v239
v_cvt_pk_bf16_f32 v102, v242, v243
v_lshlrev_b32 v242, 16, v103
v_and_b32 v243, 0xffff0000, v103
v_mul_f32 v242, v242, v239
v_mul_f32 v243, v243, v239
v_cvt_pk_bf16_f32 v103, v242, v243
v_lshlrev_b32 v242, 16, v104
v_and_b32 v243, 0xffff0000, v104
v_mul_f32 v242, v242, v239
v_mul_f32 v243, v243, v239
v_cvt_pk_bf16_f32 v104, v242, v243
v_lshlrev_b32 v242, 16, v105
v_and_b32 v243, 0xffff0000, v105
v_mul_f32 v242, v242, v239
v_mul_f32 v243, v243, v239
v_cvt_pk_bf16_f32 v105, v242, v243
v_lshlrev_b32 v242, 16, v106
v_and_b32 v243, 0xffff0000, v106
v_mul_f32 v242, v242, v239
v_mul_f32 v243, v243, v239
v_cvt_pk_bf16_f32 v106, v242, v243
v_lshlrev_b32 v242, 16, v107
v_and_b32 v243, 0xffff0000, v107
v_mul_f32 v242, v242, v239
v_mul_f32 v243, v243, v239
v_cvt_pk_bf16_f32 v107, v242, v243
v_lshlrev_b32 v242, 16, v188
v_and_b32 v243, 0xffff0000, v188
v_mul_f32 v242, v242, v239
v_mul_f32 v243, v243, v239
v_cvt_pk_bf16_f32 v188, v242, v243
v_lshlrev_b32 v242, 16, v189
v_and_b32 v243, 0xffff0000, v189
v_mul_f32 v242, v242, v239
v_mul_f32 v243, v243, v239
v_cvt_pk_bf16_f32 v189, v242, v243
v_lshlrev_b32 v242, 16, v190
v_and_b32 v243, 0xffff0000, v190
v_mul_f32 v242, v242, v239
v_mul_f32 v243, v243, v239
v_cvt_pk_bf16_f32 v190, v242, v243
v_lshlrev_b32 v242, 16, v191
v_and_b32 v243, 0xffff0000, v191
v_mul_f32 v242, v242, v239
v_mul_f32 v243, v243, v239
v_cvt_pk_bf16_f32 v191, v242, v243
v_lshlrev_b32 v242, 16, v172
v_and_b32 v243, 0xffff0000, v172
v_mul_f32 v242, v242, v239
v_mul_f32 v243, v243, v239
v_cvt_pk_bf16_f32 v172, v242, v243
v_lshlrev_b32 v242, 16, v173
v_and_b32 v243, 0xffff0000, v173
v_mul_f32 v242, v242, v239
v_mul_f32 v243, v243, v239
v_cvt_pk_bf16_f32 v173, v242, v243
v_lshlrev_b32 v242, 16, v174
v_and_b32 v243, 0xffff0000, v174
v_mul_f32 v242, v242, v239
v_mul_f32 v243, v243, v239
v_cvt_pk_bf16_f32 v174, v242, v243
v_lshlrev_b32 v242, 16, v175
v_and_b32 v243, 0xffff0000, v175
v_mul_f32 v242, v242, v239
v_mul_f32 v243, v243, v239
v_cvt_pk_bf16_f32 v175, v242, v243
v_exp_f32 v232, v128
v_exp_f32 v233, v129
v_exp_f32 v234, v130
v_exp_f32 v235, v131
s_nop 1
v_add_f32 v228, v224, v232
v_add_f32 v228, v228, v233
v_add_f32 v228, v228, v234
v_add_f32 v228, v228, v235
v_cvt_pk_bf16_f32 v0, v232, v233
v_cvt_pk_bf16_f32 v1, v234, v235
v_exp_f32 v232, v132
v_exp_f32 v233, v133
v_exp_f32 v234, v134
v_exp_f32 v235, v135
s_nop 1
v_add_f32 v229, v225, v232
v_add_f32 v229, v229, v233
v_add_f32 v229, v229, v234
v_add_f32 v229, v229, v235
v_cvt_pk_bf16_f32 v32, v232, v233
v_cvt_pk_bf16_f32 v33, v234, v235
v_exp_f32 v232, v136
v_exp_f32 v233, v137
v_exp_f32 v234, v138
v_exp_f32 v235, v139
s_nop 1
v_add_f32 v230, v226, v232
v_add_f32 v230, v230, v233
v_add_f32 v230, v230, v234
v_add_f32 v230, v230, v235
v_cvt_pk_bf16_f32 v64, v232, v233
v_cvt_pk_bf16_f32 v65, v234, v235
v_exp_f32 v232, v140
v_exp_f32 v233, v141
v_exp_f32 v234, v142
v_exp_f32 v235, v143
s_nop 1
v_add_f32 v231, v227, v232
v_add_f32 v231, v231, v233
v_add_f32 v231, v231, v234
v_add_f32 v231, v231, v235
v_cvt_pk_bf16_f32 v96, v232, v233
v_cvt_pk_bf16_f32 v97, v234, v235
s_branch L2_rare_common
L2_rare_site19:
s_mov_b32 s36, 19
s_branch L2_rare_t1_7_1
L2_rare_t1_7_1:
s_nop 15
s_nop 15
s_waitcnt lgkmcnt(0)
v_log_f32 v243, v228
v_max3_f32 v232, v144, v145, v146
v_max3_f32 v232, v232, v147, v243
v_mov_b32 v243, v232
s_nop 1
v_permlane32_swap_b32 v232, v243
s_nop 1
v_max_f32 v232, v232, v243
v_mov_b32 v243, v232
s_nop 1
v_permlane16_swap_b32 v232, v243
s_nop 1
v_max_f32 v232, v232, v243
v_ceil_f32 v232, v232
v_max_f32 v232, 0, v232
v_sub_f32 v243, 0, v232
v_exp_f32 v236, v243
s_nop 1
v_mul_f32 v228, v228, v236
v_add_f32 v244, v244, v232
v_sub_f32 v192, v192, v232
v_sub_f32 v128, v128, v232
v_sub_f32 v144, v144, v232
v_sub_f32 v193, v193, v232
v_sub_f32 v129, v129, v232
v_sub_f32 v145, v145, v232
v_sub_f32 v194, v194, v232
v_sub_f32 v130, v130, v232
v_sub_f32 v146, v146, v232
v_sub_f32 v195, v195, v232
v_sub_f32 v131, v131, v232
v_sub_f32 v147, v147, v232
v_lshlrev_b32 v242, 16, v4
v_and_b32 v243, 0xffff0000, v4
v_mul_f32 v242, v242, v236
v_mul_f32 v243, v243, v236
v_cvt_pk_bf16_f32 v4, v242, v243
v_lshlrev_b32 v242, 16, v5
v_and_b32 v243, 0xffff0000, v5
v_mul_f32 v242, v242, v236
v_mul_f32 v243, v243, v236
v_cvt_pk_bf16_f32 v5, v242, v243
v_lshlrev_b32 v242, 16, v6
v_and_b32 v243, 0xffff0000, v6
v_mul_f32 v242, v242, v236
v_mul_f32 v243, v243, v236
v_cvt_pk_bf16_f32 v6, v242, v243
v_lshlrev_b32 v242, 16, v7
v_and_b32 v243, 0xffff0000, v7
v_mul_f32 v242, v242, v236
v_mul_f32 v243, v243, v236
v_cvt_pk_bf16_f32 v7, v242, v243
v_lshlrev_b32 v242, 16, v8
v_and_b32 v243, 0xffff0000, v8
v_mul_f32 v242, v242, v236
v_mul_f32 v243, v243, v236
v_cvt_pk_bf16_f32 v8, v242, v243
v_lshlrev_b32 v242, 16, v9
v_and_b32 v243, 0xffff0000, v9
v_mul_f32 v242, v242, v236
v_mul_f32 v243, v243, v236
v_cvt_pk_bf16_f32 v9, v242, v243
v_lshlrev_b32 v242, 16, v10
v_and_b32 v243, 0xffff0000, v10
v_mul_f32 v242, v242, v236
v_mul_f32 v243, v243, v236
v_cvt_pk_bf16_f32 v10, v242, v243
v_lshlrev_b32 v242, 16, v11
v_and_b32 v243, 0xffff0000, v11
v_mul_f32 v242, v242, v236
v_mul_f32 v243, v243, v236
v_cvt_pk_bf16_f32 v11, v242, v243
v_lshlrev_b32 v242, 16, v176
v_and_b32 v243, 0xffff0000, v176
v_mul_f32 v242, v242, v236
v_mul_f32 v243, v243, v236
v_cvt_pk_bf16_f32 v176, v242, v243
v_lshlrev_b32 v242, 16, v177
v_and_b32 v243, 0xffff0000, v177
v_mul_f32 v242, v242, v236
v_mul_f32 v243, v243, v236
v_cvt_pk_bf16_f32 v177, v242, v243
v_lshlrev_b32 v242, 16, v178
v_and_b32 v243, 0xffff0000, v178
v_mul_f32 v242, v242, v236
v_mul_f32 v243, v243, v236
v_cvt_pk_bf16_f32 v178, v242, v243
v_lshlrev_b32 v242, 16, v179
v_and_b32 v243, 0xffff0000, v179
v_mul_f32 v242, v242, v236
v_mul_f32 v243, v243, v236
v_cvt_pk_bf16_f32 v179, v242, v243
v_lshlrev_b32 v242, 16, v160
v_and_b32 v243, 0xffff0000, v160
v_mul_f32 v242, v242, v236
v_mul_f32 v243, v243, v236
v_cvt_pk_bf16_f32 v160, v242, v243
v_lshlrev_b32 v242, 16, v161
v_and_b32 v243, 0xffff0000, v161
v_mul_f32 v242, v242, v236
v_mul_f32 v243, v243, v236
v_cvt_pk_bf16_f32 v161, v242, v243
v_lshlrev_b32 v242, 16, v162
v_and_b32 v243, 0xffff0000, v162
v_mul_f32 v242, v242, v236
v_mul_f32 v243, v243, v236
v_cvt_pk_bf16_f32 v162, v242, v243
v_lshlrev_b32 v242, 16, v163
v_and_b32 v243, 0xffff0000, v163
v_mul_f32 v242, v242, v236
v_mul_f32 v243, v243, v236
v_cvt_pk_bf16_f32 v163, v242, v243
v_lshlrev_b32 v242, 16, v0
v_and_b32 v243, 0xffff0000, v0
v_mul_f32 v242, v242, v236
v_mul_f32 v243, v243, v236
v_cvt_pk_bf16_f32 v0, v242, v243
v_lshlrev_b32 v242, 16, v1
v_and_b32 v243, 0xffff0000, v1
v_mul_f32 v242, v242, v236
v_mul_f32 v243, v243, v236
v_cvt_pk_bf16_f32 v1, v242, v243
v_log_f32 v243, v229
v_max3_f32 v233, v148, v149, v150
v_max3_f32 v233, v233, v151, v243
v_mov_b32 v243, v233
s_nop 1
v_permlane32_swap_b32 v233, v243
s_nop 1
v_max_f32 v233, v233, v243
v_mov_b32 v243, v233
s_nop 1
v_permlane16_swap_b32 v233, v243
s_nop 1
v_max_f32 v233, v233, v243
v_ceil_f32 v233, v233
v_max_f32 v233, 0, v233
v_sub_f32 v243, 0, v233
v_exp_f32 v237, v243
s_nop 1
v_mul_f32 v229, v229, v237
v_add_f32 v245, v245, v233
v_sub_f32 v196, v196, v233
v_sub_f32 v132, v132, v233
v_sub_f32 v148, v148, v233
v_sub_f32 v197, v197, v233
v_sub_f32 v133, v133, v233
v_sub_f32 v149, v149, v233
v_sub_f32 v198, v198, v233
v_sub_f32 v134, v134, v233
v_sub_f32 v150, v150, v233
v_sub_f32 v199, v199, v233
v_sub_f32 v135, v135, v233
v_sub_f32 v151, v151, v233
v_lshlrev_b32 v242, 16, v36
v_and_b32 v243, 0xffff0000, v36
v_mul_f32 v242, v242, v237
v_mul_f32 v243, v243, v237
v_cvt_pk_bf16_f32 v36, v242, v243
v_lshlrev_b32 v242, 16, v37
v_and_b32 v243, 0xffff0000, v37
v_mul_f32 v242, v242, v237
v_mul_f32 v243, v243, v237
v_cvt_pk_bf16_f32 v37, v242, v243
v_lshlrev_b32 v242, 16, v38
v_and_b32 v243, 0xffff0000, v38
v_mul_f32 v242, v242, v237
v_mul_f32 v243, v243, v237
v_cvt_pk_bf16_f32 v38, v242, v243
v_lshlrev_b32 v242, 16, v39
v_and_b32 v243, 0xffff0000, v39
v_mul_f32 v242, v242, v237
v_mul_f32 v243, v243, v237
v_cvt_pk_bf16_f32 v39, v242, v243
v_lshlrev_b32 v242, 16, v40
v_and_b32 v243, 0xffff0000, v40
v_mul_f32 v242, v242, v237
v_mul_f32 v243, v243, v237
v_cvt_pk_bf16_f32 v40, v242, v243
v_lshlrev_b32 v242, 16, v41
v_and_b32 v243, 0xffff0000, v41
v_mul_f32 v242, v242, v237
v_mul_f32 v243, v243, v237
v_cvt_pk_bf16_f32 v41, v242, v243
v_lshlrev_b32 v242, 16, v42
v_and_b32 v243, 0xffff0000, v42
v_mul_f32 v242, v242, v237
v_mul_f32 v243, v243, v237
v_cvt_pk_bf16_f32 v42, v242, v243
v_lshlrev_b32 v242, 16, v43
v_and_b32 v243, 0xffff0000, v43
v_mul_f32 v242, v242, v237
v_mul_f32 v243, v243, v237
v_cvt_pk_bf16_f32 v43, v242, v243
v_lshlrev_b32 v242, 16, v180
v_and_b32 v243, 0xffff0000, v180
v_mul_f32 v242, v242, v237
v_mul_f32 v243, v243, v237
v_cvt_pk_bf16_f32 v180, v242, v243
v_lshlrev_b32 v242, 16, v181
v_and_b32 v243, 0xffff0000, v181
v_mul_f32 v242, v242, v237
v_mul_f32 v243, v243, v237
v_cvt_pk_bf16_f32 v181, v242, v243
v_lshlrev_b32 v242, 16, v182
v_and_b32 v243, 0xffff0000, v182
v_mul_f32 v242, v242, v237
v_mul_f32 v243, v243, v237
v_cvt_pk_bf16_f32 v182, v242, v243
v_lshlrev_b32 v242, 16, v183
v_and_b32 v243, 0xffff0000, v183
v_mul_f32 v242, v242, v237
v_mul_f32 v243, v243, v237
v_cvt_pk_bf16_f32 v183, v242, v243
v_lshlrev_b32 v242, 16, v164
v_and_b32 v243, 0xffff0000, v164
v_mul_f32 v242, v242, v237
v_mul_f32 v243, v243, v237
v_cvt_pk_bf16_f32 v164, v242, v243
v_lshlrev_b32 v242, 16, v165
v_and_b32 v243, 0xffff0000, v165
v_mul_f32 v242, v242, v237
v_mul_f32 v243, v243, v237
v_cvt_pk_bf16_f32 v165, v242, v243
v_lshlrev_b32 v242, 16, v166
v_and_b32 v243, 0xffff0000, v166
v_mul_f32 v242, v242, v237
v_mul_f32 v243, v243, v237
v_cvt_pk_bf16_f32 v166, v242, v243
v_lshlrev_b32 v242, 16, v167
v_and_b32 v243, 0xffff0000, v167
v_mul_f32 v242, v242, v237
v_mul_f32 v243, v243, v237
v_cvt_pk_bf16_f32 v167, v242, v243
v_lshlrev_b32 v242, 16, v32
v_and_b32 v243, 0xffff0000, v32
v_mul_f32 v242, v242, v237
v_mul_f32 v243, v243, v237
v_cvt_pk_bf16_f32 v32, v242, v243
v_lshlrev_b32 v242, 16, v33
v_and_b32 v243, 0xffff0000, v33
v_mul_f32 v242, v242, v237
v_mul_f32 v243, v243, v237
v_cvt_pk_bf16_f32 v33, v242, v243
v_log_f32 v243, v230
v_max3_f32 v234, v152, v153, v154
v_max3_f32 v234, v234, v155, v243
v_mov_b32 v243, v234
s_nop 1
v_permlane32_swap_b32 v234, v243
s_nop 1
v_max_f32 v234, v234, v243
v_mov_b32 v243, v234
s_nop 1
v_permlane16_swap_b32 v234, v243
s_nop 1
v_max_f32 v234, v234, v243
v_ceil_f32 v234, v234
v_max_f32 v234, 0, v234
v_sub_f32 v243, 0, v234
v_exp_f32 v238, v243
s_nop 1
v_mul_f32 v230, v230, v238
v_add_f32 v246, v246, v234
v_sub_f32 v200, v200, v234
v_sub_f32 v136, v136, v234
v_sub_f32 v152, v152, v234
v_sub_f32 v201, v201, v234
v_sub_f32 v137, v137, v234
v_sub_f32 v153, v153, v234
v_sub_f32 v202, v202, v234
v_sub_f32 v138, v138, v234
v_sub_f32 v154, v154, v234
v_sub_f32 v203, v203, v234
v_sub_f32 v139, v139, v234
v_sub_f32 v155, v155, v234
v_lshlrev_b32 v242, 16, v68
v_and_b32 v243, 0xffff0000, v68
v_mul_f32 v242, v242, v238
v_mul_f32 v243, v243, v238
v_cvt_pk_bf16_f32 v68, v242, v243
v_lshlrev_b32 v242, 16, v69
v_and_b32 v243, 0xffff0000, v69
v_mul_f32 v242, v242, v238
v_mul_f32 v243, v243, v238
v_cvt_pk_bf16_f32 v69, v242, v243
v_lshlrev_b32 v242, 16, v70
v_and_b32 v243, 0xffff0000, v70
v_mul_f32 v242, v242, v238
v_mul_f32 v243, v243, v238
v_cvt_pk_bf16_f32 v70, v242, v243
v_lshlrev_b32 v242, 16, v71
v_and_b32 v243, 0xffff0000, v71
v_mul_f32 v242, v242, v238
v_mul_f32 v243, v243, v238
v_cvt_pk_bf16_f32 v71, v242, v243
v_lshlrev_b32 v242, 16, v72
v_and_b32 v243, 0xffff0000, v72
v_mul_f32 v242, v242, v238
v_mul_f32 v243, v243, v238
v_cvt_pk_bf16_f32 v72, v242, v243
v_lshlrev_b32 v242, 16, v73
v_and_b32 v243, 0xffff0000, v73
v_mul_f32 v242, v242, v238
v_mul_f32 v243, v243, v238
v_cvt_pk_bf16_f32 v73, v242, v243
v_lshlrev_b32 v242, 16, v74
v_and_b32 v243, 0xffff0000, v74
v_mul_f32 v242, v242, v238
v_mul_f32 v243, v243, v238
v_cvt_pk_bf16_f32 v74, v242, v243
v_lshlrev_b32 v242, 16, v75
v_and_b32 v243, 0xffff0000, v75
v_mul_f32 v242, v242, v238
v_mul_f32 v243, v243, v238
v_cvt_pk_bf16_f32 v75, v242, v243
v_lshlrev_b32 v242, 16, v184
v_and_b32 v243, 0xffff0000, v184
v_mul_f32 v242, v242, v238
v_mul_f32 v243, v243, v238
v_cvt_pk_bf16_f32 v184, v242, v243
v_lshlrev_b32 v242, 16, v185
v_and_b32 v243, 0xffff0000, v185
v_mul_f32 v242, v242, v238
v_mul_f32 v243, v243, v238
v_cvt_pk_bf16_f32 v185, v242, v243
v_lshlrev_b32 v242, 16, v186
v_and_b32 v243, 0xffff0000, v186
v_mul_f32 v242, v242, v238
v_mul_f32 v243, v243, v238
v_cvt_pk_bf16_f32 v186, v242, v243
v_lshlrev_b32 v242, 16, v187
v_and_b32 v243, 0xffff0000, v187
v_mul_f32 v242, v242, v238
v_mul_f32 v243, v243, v238
v_cvt_pk_bf16_f32 v187, v242, v243
v_lshlrev_b32 v242, 16, v168
v_and_b32 v243, 0xffff0000, v168
v_mul_f32 v242, v242, v238
v_mul_f32 v243, v243, v238
v_cvt_pk_bf16_f32 v168, v242, v243
v_lshlrev_b32 v242, 16, v169
v_and_b32 v243, 0xffff0000, v169
v_mul_f32 v242, v242, v238
v_mul_f32 v243, v243, v238
v_cvt_pk_bf16_f32 v169, v242, v243
v_lshlrev_b32 v242, 16, v170
v_and_b32 v243, 0xffff0000, v170
v_mul_f32 v242, v242, v238
v_mul_f32 v243, v243, v238
v_cvt_pk_bf16_f32 v170, v242, v243
v_lshlrev_b32 v242, 16, v171
v_and_b32 v243, 0xffff0000, v171
v_mul_f32 v242, v242, v238
v_mul_f32 v243, v243, v238
v_cvt_pk_bf16_f32 v171, v242, v243
v_lshlrev_b32 v242, 16, v64
v_and_b32 v243, 0xffff0000, v64
v_mul_f32 v242, v242, v238
v_mul_f32 v243, v243, v238
v_cvt_pk_bf16_f32 v64, v242, v243
v_lshlrev_b32 v242, 16, v65
v_and_b32 v243, 0xffff0000, v65
v_mul_f32 v242, v242, v238
v_mul_f32 v243, v243, v238
v_cvt_pk_bf16_f32 v65, v242, v243
v_log_f32 v243, v231
v_max3_f32 v235, v156, v157, v158
v_max3_f32 v235, v235, v159, v243
v_mov_b32 v243, v235
s_nop 1
v_permlane32_swap_b32 v235, v243
s_nop 1
v_max_f32 v235, v235, v243
v_mov_b32 v243, v235
s_nop 1
v_permlane16_swap_b32 v235, v243
s_nop 1
v_max_f32 v235, v235, v243
v_ceil_f32 v235, v235
v_max_f32 v235, 0, v235
v_sub_f32 v243, 0, v235
v_exp_f32 v239, v243
s_nop 1
v_mul_f32 v231, v231, v239
v_add_f32 v247, v247, v235
v_sub_f32 v204, v204, v235
v_sub_f32 v140, v140, v235
v_sub_f32 v156, v156, v235
v_sub_f32 v205, v205, v235
v_sub_f32 v141, v141, v235
v_sub_f32 v157, v157, v235
v_sub_f32 v206, v206, v235
v_sub_f32 v142, v142, v235
v_sub_f32 v158, v158, v235
v_sub_f32 v207, v207, v235
v_sub_f32 v143, v143, v235
v_sub_f32 v159, v159, v235
v_lshlrev_b32 v242, 16, v100
v_and_b32 v243, 0xffff0000, v100
v_mul_f32 v242, v242, v239
v_mul_f32 v243, v243, v239
v_cvt_pk_bf16_f32 v100, v242, v243
v_lshlrev_b32 v242, 16, v101
v_and_b32 v243, 0xffff0000, v101
v_mul_f32 v242, v242, v239
v_mul_f32 v243, v243, v239
v_cvt_pk_bf16_f32 v101, v242, v243
v_lshlrev_b32 v242, 16, v102
v_and_b32 v243, 0xffff0000, v102
v_mul_f32 v242, v242, v239
v_mul_f32 v243, v243, v239
v_cvt_pk_bf16_f32 v102, v242, v243
v_lshlrev_b32 v242, 16, v103
v_and_b32 v243, 0xffff0000, v103
v_mul_f32 v242, v242, v239
v_mul_f32 v243, v243, v239
v_cvt_pk_bf16_f32 v103, v242, v243
v_lshlrev_b32 v242, 16, v104
v_and_b32 v243, 0xffff0000, v104
v_mul_f32 v242, v242, v239
v_mul_f32 v243, v243, v239
v_cvt_pk_bf16_f32 v104, v242, v243
v_lshlrev_b32 v242, 16, v105
v_and_b32 v243, 0xffff0000, v105
v_mul_f32 v242, v242, v239
v_mul_f32 v243, v243, v239
v_cvt_pk_bf16_f32 v105, v242, v243
v_lshlrev_b32 v242, 16, v106
v_and_b32 v243, 0xffff0000, v106
v_mul_f32 v242, v242, v239
v_mul_f32 v243, v243, v239
v_cvt_pk_bf16_f32 v106, v242, v243
v_lshlrev_b32 v242, 16, v107
v_and_b32 v243, 0xffff0000, v107
v_mul_f32 v242, v242, v239
v_mul_f32 v243, v243, v239
v_cvt_pk_bf16_f32 v107, v242, v243
v_lshlrev_b32 v242, 16, v188
v_and_b32 v243, 0xffff0000, v188
v_mul_f32 v242, v242, v239
v_mul_f32 v243, v243, v239
v_cvt_pk_bf16_f32 v188, v242, v243
v_lshlrev_b32 v242, 16, v189
v_and_b32 v243, 0xffff0000, v189
v_mul_f32 v242, v242, v239
v_mul_f32 v243, v243, v239
v_cvt_pk_bf16_f32 v189, v242, v243
v_lshlrev_b32 v242, 16, v190
v_and_b32 v243, 0xffff0000, v190
v_mul_f32 v242, v242, v239
v_mul_f32 v243, v243, v239
v_cvt_pk_bf16_f32 v190, v242, v243
v_lshlrev_b32 v242, 16, v191
v_and_b32 v243, 0xffff0000, v191
v_mul_f32 v242, v242, v239
v_mul_f32 v243, v243, v239
v_cvt_pk_bf16_f32 v191, v242, v243
v_lshlrev_b32 v242, 16, v172
v_and_b32 v243, 0xffff0000, v172
v_mul_f32 v242, v242, v239
v_mul_f32 v243, v243, v239
v_cvt_pk_bf16_f32 v172, v242, v243
v_lshlrev_b32 v242, 16, v173
v_and_b32 v243, 0xffff0000, v173
v_mul_f32 v242, v242, v239
v_mul_f32 v243, v243, v239
v_cvt_pk_bf16_f32 v173, v242, v243
v_lshlrev_b32 v242, 16, v174
v_and_b32 v243, 0xffff0000, v174
v_mul_f32 v242, v242, v239
v_mul_f32 v243, v243, v239
v_cvt_pk_bf16_f32 v174, v242, v243
v_lshlrev_b32 v242, 16, v175
v_and_b32 v243, 0xffff0000, v175
v_mul_f32 v242, v242, v239
v_mul_f32 v243, v243, v239
v_cvt_pk_bf16_f32 v175, v242, v243
v_lshlrev_b32 v242, 16, v96
v_and_b32 v243, 0xffff0000, v96
v_mul_f32 v242, v242, v239
v_mul_f32 v243, v243, v239
v_cvt_pk_bf16_f32 v96, v242, v243
v_lshlrev_b32 v242, 16, v97
v_and_b32 v243, 0xffff0000, v97
v_mul_f32 v242, v242, v239
v_mul_f32 v243, v243, v239
v_cvt_pk_bf16_f32 v97, v242, v243
v_exp_f32 v232, v144
v_exp_f32 v233, v145
v_exp_f32 v234, v146
v_exp_f32 v235, v147
s_nop 1
v_add_f32 v224, v228, v232
v_add_f32 v224, v224, v233
v_add_f32 v224, v224, v234
v_add_f32 v224, v224, v235
v_cvt_pk_bf16_f32 v2, v232, v233
v_cvt_pk_bf16_f32 v3, v234, v235
v_exp_f32 v232, v148
v_exp_f32 v233, v149
v_exp_f32 v234, v150
v_exp_f32 v235, v151
s_nop 1
v_add_f32 v225, v229, v232
v_add_f32 v225, v225, v233
v_add_f32 v225, v225, v234
v_add_f32 v225, v225, v235
v_cvt_pk_bf16_f32 v34, v232, v233
v_cvt_pk_bf16_f32 v35, v234, v235
v_exp_f32 v232, v152
v_exp_f32 v233, v153
v_exp_f32 v234, v154
v_exp_f32 v235, v155
s_nop 1
v_add_f32 v226, v230, v232
v_add_f32 v226, v226, v233
v_add_f32 v226, v226, v234
v_add_f32 v226, v226, v235
v_cvt_pk_bf16_f32 v66, v232, v233
v_cvt_pk_bf16_f32 v67, v234, v235
v_exp_f32 v232, v156
v_exp_f32 v233, v157
v_exp_f32 v234, v158
v_exp_f32 v235, v159
s_nop 1
v_add_f32 v227, v231, v232
v_add_f32 v227, v227, v233
v_add_f32 v227, v227, v234
v_add_f32 v227, v227, v235
v_cvt_pk_bf16_f32 v98, v232, v233
v_cvt_pk_bf16_f32 v99, v234, v235
s_branch L2_rare_common
LF_hl_1:
s_mov_b32 s94, 0x10000
s_mov_b32 s3, 0x7c28000
LF_hl2_1:
v_lshlrev_b32 v241, 3, v248
buffer_load_dwordx2 v[240:241], v241, s[16:19], s3 offen sc1
s_sub_u32 s94, s94, 1
s_waitcnt vmcnt(0)
s_cbranch_scc1 LF_hlret_1
v_cmp_ne_u64_e64 s[38:39], s[98:99], v[240:241]
s_and_b64 s[38:39], s[38:39], s[96:97]
s_cbranch_scc1 LF_hl2_1
s_branch LF_hlret_1
L2_rare_common:
v_lshrrev_b32 v232, 4, v248
v_and_b32 v232, 0x30, v232
ds_bpermute_b32 v242, v232, v236 offset:0
ds_bpermute_b32 v243, v232, v236 offset:4
ds_bpermute_b32 v254, v232, v236 offset:8
ds_bpermute_b32 v255, v232, v236 offset:12
s_waitcnt lgkmcnt(0)
v_accvgpr_read_b32 v232, a0
v_accvgpr_read_b32 v233, a1
v_accvgpr_read_b32 v234, a2
v_accvgpr_read_b32 v235, a3
v_mul_f32 v232, v232, v242
v_mul_f32 v233, v233, v243
v_mul_f32 v234, v234, v254
v_mul_f32 v235, v235, v255
v_accvgpr_write_b32 a0, v232
v_accvgpr_write_b32 a1, v233
v_accvgpr_write_b32 a2, v234
v_accvgpr_write_b32 a3, v235
v_accvgpr_read_b32 v232, a16
v_accvgpr_read_b32 v233, a17
v_accvgpr_read_b32 v234, a18
v_accvgpr_read_b32 v235, a19
v_mul_f32 v232, v232, v242
v_mul_f32 v233, v233, v243
v_mul_f32 v234, v234, v254
v_mul_f32 v235, v235, v255
v_accvgpr_write_b32 a16, v232
v_accvgpr_write_b32 a17, v233
v_accvgpr_write_b32 a18, v234
v_accvgpr_write_b32 a19, v235
v_accvgpr_read_b32 v232, a32
v_accvgpr_read_b32 v233, a33
v_accvgpr_read_b32 v234, a34
v_accvgpr_read_b32 v235, a35
v_mul_f32 v232, v232, v242
v_mul_f32 v233, v233, v243
v_mul_f32 v234, v234, v254
v_mul_f32 v235, v235, v255
v_accvgpr_write_b32 a32, v232
v_accvgpr_write_b32 a33, v233
v_accvgpr_write_b32 a34, v234
v_accvgpr_write_b32 a35, v235
v_accvgpr_read_b32 v232, a48
v_accvgpr_read_b32 v233, a49
v_accvgpr_read_b32 v234, a50
v_accvgpr_read_b32 v235, a51
v_mul_f32 v232, v232, v242
v_mul_f32 v233, v233, v243
v_mul_f32 v234, v234, v254
v_mul_f32 v235, v235, v255
v_accvgpr_write_b32 a48, v232
v_accvgpr_write_b32 a49, v233
v_accvgpr_write_b32 a50, v234
v_accvgpr_write_b32 a51, v235
v_accvgpr_read_b32 v232, a64
v_accvgpr_read_b32 v233, a65
v_accvgpr_read_b32 v234, a66
v_accvgpr_read_b32 v235, a67
v_mul_f32 v232, v232, v242
v_mul_f32 v233, v233, v243
v_mul_f32 v234, v234, v254
v_mul_f32 v235, v235, v255
v_accvgpr_write_b32 a64, v232
v_accvgpr_write_b32 a65, v233
v_accvgpr_write_b32 a66, v234
v_accvgpr_write_b32 a67, v235
v_accvgpr_read_b32 v232, a80
v_accvgpr_read_b32 v233, a81
v_accvgpr_read_b32 v234, a82
v_accvgpr_read_b32 v235, a83
v_mul_f32 v232, v232, v242
v_mul_f32 v233, v233, v243
v_mul_f32 v234, v234, v254
v_mul_f32 v235, v235, v255
v_accvgpr_write_b32 a80, v232
v_accvgpr_write_b32 a81, v233
v_accvgpr_write_b32 a82, v234
v_accvgpr_write_b32 a83, v235
v_accvgpr_read_b32 v232, a96
v_accvgpr_read_b32 v233, a97
v_accvgpr_read_b32 v234, a98
v_accvgpr_read_b32 v235, a99
v_mul_f32 v232, v232, v242
v_mul_f32 v233, v233, v243
v_mul_f32 v234, v234, v254
v_mul_f32 v235, v235, v255
v_accvgpr_write_b32 a96, v232
v_accvgpr_write_b32 a97, v233
v_accvgpr_write_b32 a98, v234
v_accvgpr_write_b32 a99, v235
v_accvgpr_read_b32 v232, a112
v_accvgpr_read_b32 v233, a113
v_accvgpr_read_b32 v234, a114
v_accvgpr_read_b32 v235, a115
v_mul_f32 v232, v232, v242
v_mul_f32 v233, v233, v243
v_mul_f32 v234, v234, v254
v_mul_f32 v235, v235, v255
v_accvgpr_write_b32 a112, v232
v_accvgpr_write_b32 a113, v233
v_accvgpr_write_b32 a114, v234
v_accvgpr_write_b32 a115, v235
v_accvgpr_read_b32 v232, a128
v_accvgpr_read_b32 v233, a129
v_accvgpr_read_b32 v234, a130
v_accvgpr_read_b32 v235, a131
v_mul_f32 v232, v232, v242
v_mul_f32 v233, v233, v243
v_mul_f32 v234, v234, v254
v_mul_f32 v235, v235, v255
v_accvgpr_write_b32 a128, v232
v_accvgpr_write_b32 a129, v233
v_accvgpr_write_b32 a130, v234
v_accvgpr_write_b32 a131, v235
v_accvgpr_read_b32 v232, a144
v_accvgpr_read_b32 v233, a145
v_accvgpr_read_b32 v234, a146
v_accvgpr_read_b32 v235, a147
v_mul_f32 v232, v232, v242
v_mul_f32 v233, v233, v243
v_mul_f32 v234, v234, v254
v_mul_f32 v235, v235, v255
v_accvgpr_write_b32 a144, v232
v_accvgpr_write_b32 a145, v233
v_accvgpr_write_b32 a146, v234
v_accvgpr_write_b32 a147, v235
v_accvgpr_read_b32 v232, a160
v_accvgpr_read_b32 v233, a161
v_accvgpr_read_b32 v234, a162
v_accvgpr_read_b32 v235, a163
v_mul_f32 v232, v232, v242
v_mul_f32 v233, v233, v243
v_mul_f32 v234, v234, v254
v_mul_f32 v235, v235, v255
v_accvgpr_write_b32 a160, v232
v_accvgpr_write_b32 a161, v233
v_accvgpr_write_b32 a162, v234
v_accvgpr_write_b32 a163, v235
v_accvgpr_read_b32 v232, a176
v_accvgpr_read_b32 v233, a177
v_accvgpr_read_b32 v234, a178
v_accvgpr_read_b32 v235, a179
v_mul_f32 v232, v232, v242
v_mul_f32 v233, v233, v243
v_mul_f32 v234, v234, v254
v_mul_f32 v235, v235, v255
v_accvgpr_write_b32 a176, v232
v_accvgpr_write_b32 a177, v233
v_accvgpr_write_b32 a178, v234
v_accvgpr_write_b32 a179, v235
v_accvgpr_read_b32 v232, a192
v_accvgpr_read_b32 v233, a193
v_accvgpr_read_b32 v234, a194
v_accvgpr_read_b32 v235, a195
v_mul_f32 v232, v232, v242
v_mul_f32 v233, v233, v243
v_mul_f32 v234, v234, v254
v_mul_f32 v235, v235, v255
v_accvgpr_write_b32 a192, v232
v_accvgpr_write_b32 a193, v233
v_accvgpr_write_b32 a194, v234
v_accvgpr_write_b32 a195, v235
v_accvgpr_read_b32 v232, a208
v_accvgpr_read_b32 v233, a209
v_accvgpr_read_b32 v234, a210
v_accvgpr_read_b32 v235, a211
v_mul_f32 v232, v232, v242
v_mul_f32 v233, v233, v243
v_mul_f32 v234, v234, v254
v_mul_f32 v235, v235, v255
v_accvgpr_write_b32 a208, v232
v_accvgpr_write_b32 a209, v233
v_accvgpr_write_b32 a210, v234
v_accvgpr_write_b32 a211, v235
v_accvgpr_read_b32 v232, a224
v_accvgpr_read_b32 v233, a225
v_accvgpr_read_b32 v234, a226
v_accvgpr_read_b32 v235, a227
v_mul_f32 v232, v232, v242
v_mul_f32 v233, v233, v243
v_mul_f32 v234, v234, v254
v_mul_f32 v235, v235, v255
v_accvgpr_write_b32 a224, v232
v_accvgpr_write_b32 a225, v233
v_accvgpr_write_b32 a226, v234
v_accvgpr_write_b32 a227, v235
v_accvgpr_read_b32 v232, a240
v_accvgpr_read_b32 v233, a241
v_accvgpr_read_b32 v234, a242
v_accvgpr_read_b32 v235, a243
v_mul_f32 v232, v232, v242
v_mul_f32 v233, v233, v243
v_mul_f32 v234, v234, v254
v_mul_f32 v235, v235, v255
v_accvgpr_write_b32 a240, v232
v_accvgpr_write_b32 a241, v233
v_accvgpr_write_b32 a242, v234
v_accvgpr_write_b32 a243, v235
v_lshrrev_b32 v232, 4, v248
v_and_b32 v232, 0x30, v232
ds_bpermute_b32 v242, v232, v237 offset:0
ds_bpermute_b32 v243, v232, v237 offset:4
ds_bpermute_b32 v254, v232, v237 offset:8
ds_bpermute_b32 v255, v232, v237 offset:12
s_waitcnt lgkmcnt(0)
v_accvgpr_read_b32 v232, a4
v_accvgpr_read_b32 v233, a5
v_accvgpr_read_b32 v234, a6
v_accvgpr_read_b32 v235, a7
v_mul_f32 v232, v232, v242
v_mul_f32 v233, v233, v243
v_mul_f32 v234, v234, v254
v_mul_f32 v235, v235, v255
v_accvgpr_write_b32 a4, v232
v_accvgpr_write_b32 a5, v233
v_accvgpr_write_b32 a6, v234
v_accvgpr_write_b32 a7, v235
v_accvgpr_read_b32 v232, a20
v_accvgpr_read_b32 v233, a21
v_accvgpr_read_b32 v234, a22
v_accvgpr_read_b32 v235, a23
v_mul_f32 v232, v232, v242
v_mul_f32 v233, v233, v243
v_mul_f32 v234, v234, v254
v_mul_f32 v235, v235, v255
v_accvgpr_write_b32 a20, v232
v_accvgpr_write_b32 a21, v233
v_accvgpr_write_b32 a22, v234
v_accvgpr_write_b32 a23, v235
v_accvgpr_read_b32 v232, a36
v_accvgpr_read_b32 v233, a37
v_accvgpr_read_b32 v234, a38
v_accvgpr_read_b32 v235, a39
v_mul_f32 v232, v232, v242
v_mul_f32 v233, v233, v243
v_mul_f32 v234, v234, v254
v_mul_f32 v235, v235, v255
v_accvgpr_write_b32 a36, v232
v_accvgpr_write_b32 a37, v233
v_accvgpr_write_b32 a38, v234
v_accvgpr_write_b32 a39, v235
v_accvgpr_read_b32 v232, a52
v_accvgpr_read_b32 v233, a53
v_accvgpr_read_b32 v234, a54
v_accvgpr_read_b32 v235, a55
v_mul_f32 v232, v232, v242
v_mul_f32 v233, v233, v243
v_mul_f32 v234, v234, v254
v_mul_f32 v235, v235, v255
v_accvgpr_write_b32 a52, v232
v_accvgpr_write_b32 a53, v233
v_accvgpr_write_b32 a54, v234
v_accvgpr_write_b32 a55, v235
v_accvgpr_read_b32 v232, a68
v_accvgpr_read_b32 v233, a69
v_accvgpr_read_b32 v234, a70
v_accvgpr_read_b32 v235, a71
v_mul_f32 v232, v232, v242
v_mul_f32 v233, v233, v243
v_mul_f32 v234, v234, v254
v_mul_f32 v235, v235, v255
v_accvgpr_write_b32 a68, v232
v_accvgpr_write_b32 a69, v233
v_accvgpr_write_b32 a70, v234
v_accvgpr_write_b32 a71, v235
v_accvgpr_read_b32 v232, a84
v_accvgpr_read_b32 v233, a85
v_accvgpr_read_b32 v234, a86
v_accvgpr_read_b32 v235, a87
v_mul_f32 v232, v232, v242
v_mul_f32 v233, v233, v243
v_mul_f32 v234, v234, v254
v_mul_f32 v235, v235, v255
v_accvgpr_write_b32 a84, v232
v_accvgpr_write_b32 a85, v233
v_accvgpr_write_b32 a86, v234
v_accvgpr_write_b32 a87, v235
v_accvgpr_read_b32 v232, a100
v_accvgpr_read_b32 v233, a101
v_accvgpr_read_b32 v234, a102
v_accvgpr_read_b32 v235, a103
v_mul_f32 v232, v232, v242
v_mul_f32 v233, v233, v243
v_mul_f32 v234, v234, v254
v_mul_f32 v235, v235, v255
v_accvgpr_write_b32 a100, v232
v_accvgpr_write_b32 a101, v233
v_accvgpr_write_b32 a102, v234
v_accvgpr_write_b32 a103, v235
v_accvgpr_read_b32 v232, a116
v_accvgpr_read_b32 v233, a117
v_accvgpr_read_b32 v234, a118
v_accvgpr_read_b32 v235, a119
v_mul_f32 v232, v232, v242
v_mul_f32 v233, v233, v243
v_mul_f32 v234, v234, v254
v_mul_f32 v235, v235, v255
v_accvgpr_write_b32 a116, v232
v_accvgpr_write_b32 a117, v233
v_accvgpr_write_b32 a118, v234
v_accvgpr_write_b32 a119, v235
v_accvgpr_read_b32 v232, a132
v_accvgpr_read_b32 v233, a133
v_accvgpr_read_b32 v234, a134
v_accvgpr_read_b32 v235, a135
v_mul_f32 v232, v232, v242
v_mul_f32 v233, v233, v243
v_mul_f32 v234, v234, v254
v_mul_f32 v235, v235, v255
v_accvgpr_write_b32 a132, v232
v_accvgpr_write_b32 a133, v233
v_accvgpr_write_b32 a134, v234
v_accvgpr_write_b32 a135, v235
v_accvgpr_read_b32 v232, a148
v_accvgpr_read_b32 v233, a149
v_accvgpr_read_b32 v234, a150
v_accvgpr_read_b32 v235, a151
v_mul_f32 v232, v232, v242
v_mul_f32 v233, v233, v243
v_mul_f32 v234, v234, v254
v_mul_f32 v235, v235, v255
v_accvgpr_write_b32 a148, v232
v_accvgpr_write_b32 a149, v233
v_accvgpr_write_b32 a150, v234
v_accvgpr_write_b32 a151, v235
v_accvgpr_read_b32 v232, a164
v_accvgpr_read_b32 v233, a165
v_accvgpr_read_b32 v234, a166
v_accvgpr_read_b32 v235, a167
v_mul_f32 v232, v232, v242
v_mul_f32 v233, v233, v243
v_mul_f32 v234, v234, v254
v_mul_f32 v235, v235, v255
v_accvgpr_write_b32 a164, v232
v_accvgpr_write_b32 a165, v233
v_accvgpr_write_b32 a166, v234
v_accvgpr_write_b32 a167, v235
v_accvgpr_read_b32 v232, a180
v_accvgpr_read_b32 v233, a181
v_accvgpr_read_b32 v234, a182
v_accvgpr_read_b32 v235, a183
v_mul_f32 v232, v232, v242
v_mul_f32 v233, v233, v243
v_mul_f32 v234, v234, v254
v_mul_f32 v235, v235, v255
v_accvgpr_write_b32 a180, v232
v_accvgpr_write_b32 a181, v233
v_accvgpr_write_b32 a182, v234
v_accvgpr_write_b32 a183, v235
v_accvgpr_read_b32 v232, a196
v_accvgpr_read_b32 v233, a197
v_accvgpr_read_b32 v234, a198
v_accvgpr_read_b32 v235, a199
v_mul_f32 v232, v232, v242
v_mul_f32 v233, v233, v243
v_mul_f32 v234, v234, v254
v_mul_f32 v235, v235, v255
v_accvgpr_write_b32 a196, v232
v_accvgpr_write_b32 a197, v233
v_accvgpr_write_b32 a198, v234
v_accvgpr_write_b32 a199, v235
v_accvgpr_read_b32 v232, a212
v_accvgpr_read_b32 v233, a213
v_accvgpr_read_b32 v234, a214
v_accvgpr_read_b32 v235, a215
v_mul_f32 v232, v232, v242
v_mul_f32 v233, v233, v243
v_mul_f32 v234, v234, v254
v_mul_f32 v235, v235, v255
v_accvgpr_write_b32 a212, v232
v_accvgpr_write_b32 a213, v233
v_accvgpr_write_b32 a214, v234
v_accvgpr_write_b32 a215, v235
v_accvgpr_read_b32 v232, a228
v_accvgpr_read_b32 v233, a229
v_accvgpr_read_b32 v234, a230
v_accvgpr_read_b32 v235, a231
v_mul_f32 v232, v232, v242
v_mul_f32 v233, v233, v243
v_mul_f32 v234, v234, v254
v_mul_f32 v235, v235, v255
v_accvgpr_write_b32 a228, v232
v_accvgpr_write_b32 a229, v233
v_accvgpr_write_b32 a230, v234
v_accvgpr_write_b32 a231, v235
v_accvgpr_read_b32 v232, a244
v_accvgpr_read_b32 v233, a245
v_accvgpr_read_b32 v234, a246
v_accvgpr_read_b32 v235, a247
v_mul_f32 v232, v232, v242
v_mul_f32 v233, v233, v243
v_mul_f32 v234, v234, v254
v_mul_f32 v235, v235, v255
v_accvgpr_write_b32 a244, v232
v_accvgpr_write_b32 a245, v233
v_accvgpr_write_b32 a246, v234
v_accvgpr_write_b32 a247, v235
v_lshrrev_b32 v232, 4, v248
v_and_b32 v232, 0x30, v232
ds_bpermute_b32 v242, v232, v238 offset:0
ds_bpermute_b32 v243, v232, v238 offset:4
ds_bpermute_b32 v254, v232, v238 offset:8
ds_bpermute_b32 v255, v232, v238 offset:12
s_waitcnt lgkmcnt(0)
v_accvgpr_read_b32 v232, a8
v_accvgpr_read_b32 v233, a9
v_accvgpr_read_b32 v234, a10
v_accvgpr_read_b32 v235, a11
v_mul_f32 v232, v232, v242
v_mul_f32 v233, v233, v243
v_mul_f32 v234, v234, v254
v_mul_f32 v235, v235, v255
v_accvgpr_write_b32 a8, v232
v_accvgpr_write_b32 a9, v233
v_accvgpr_write_b32 a10, v234
v_accvgpr_write_b32 a11, v235
v_accvgpr_read_b32 v232, a24
v_accvgpr_read_b32 v233, a25
v_accvgpr_read_b32 v234, a26
v_accvgpr_read_b32 v235, a27
v_mul_f32 v232, v232, v242
v_mul_f32 v233, v233, v243
v_mul_f32 v234, v234, v254
v_mul_f32 v235, v235, v255
v_accvgpr_write_b32 a24, v232
v_accvgpr_write_b32 a25, v233
v_accvgpr_write_b32 a26, v234
v_accvgpr_write_b32 a27, v235
v_accvgpr_read_b32 v232, a40
v_accvgpr_read_b32 v233, a41
v_accvgpr_read_b32 v234, a42
v_accvgpr_read_b32 v235, a43
v_mul_f32 v232, v232, v242
v_mul_f32 v233, v233, v243
v_mul_f32 v234, v234, v254
v_mul_f32 v235, v235, v255
v_accvgpr_write_b32 a40, v232
v_accvgpr_write_b32 a41, v233
v_accvgpr_write_b32 a42, v234
v_accvgpr_write_b32 a43, v235
v_accvgpr_read_b32 v232, a56
v_accvgpr_read_b32 v233, a57
v_accvgpr_read_b32 v234, a58
v_accvgpr_read_b32 v235, a59
v_mul_f32 v232, v232, v242
v_mul_f32 v233, v233, v243
v_mul_f32 v234, v234, v254
v_mul_f32 v235, v235, v255
v_accvgpr_write_b32 a56, v232
v_accvgpr_write_b32 a57, v233
v_accvgpr_write_b32 a58, v234
v_accvgpr_write_b32 a59, v235
v_accvgpr_read_b32 v232, a72
v_accvgpr_read_b32 v233, a73
v_accvgpr_read_b32 v234, a74
v_accvgpr_read_b32 v235, a75
v_mul_f32 v232, v232, v242
v_mul_f32 v233, v233, v243
v_mul_f32 v234, v234, v254
v_mul_f32 v235, v235, v255
v_accvgpr_write_b32 a72, v232
v_accvgpr_write_b32 a73, v233
v_accvgpr_write_b32 a74, v234
v_accvgpr_write_b32 a75, v235
v_accvgpr_read_b32 v232, a88
v_accvgpr_read_b32 v233, a89
v_accvgpr_read_b32 v234, a90
v_accvgpr_read_b32 v235, a91
v_mul_f32 v232, v232, v242
v_mul_f32 v233, v233, v243
v_mul_f32 v234, v234, v254
v_mul_f32 v235, v235, v255
v_accvgpr_write_b32 a88, v232
v_accvgpr_write_b32 a89, v233
v_accvgpr_write_b32 a90, v234
v_accvgpr_write_b32 a91, v235
v_accvgpr_read_b32 v232, a104
v_accvgpr_read_b32 v233, a105
v_accvgpr_read_b32 v234, a106
v_accvgpr_read_b32 v235, a107
v_mul_f32 v232, v232, v242
v_mul_f32 v233, v233, v243
v_mul_f32 v234, v234, v254
v_mul_f32 v235, v235, v255
v_accvgpr_write_b32 a104, v232
v_accvgpr_write_b32 a105, v233
v_accvgpr_write_b32 a106, v234
v_accvgpr_write_b32 a107, v235
v_accvgpr_read_b32 v232, a120
v_accvgpr_read_b32 v233, a121
v_accvgpr_read_b32 v234, a122
v_accvgpr_read_b32 v235, a123
v_mul_f32 v232, v232, v242
v_mul_f32 v233, v233, v243
v_mul_f32 v234, v234, v254
v_mul_f32 v235, v235, v255
v_accvgpr_write_b32 a120, v232
v_accvgpr_write_b32 a121, v233
v_accvgpr_write_b32 a122, v234
v_accvgpr_write_b32 a123, v235
v_accvgpr_read_b32 v232, a136
v_accvgpr_read_b32 v233, a137
v_accvgpr_read_b32 v234, a138
v_accvgpr_read_b32 v235, a139
v_mul_f32 v232, v232, v242
v_mul_f32 v233, v233, v243
v_mul_f32 v234, v234, v254
v_mul_f32 v235, v235, v255
v_accvgpr_write_b32 a136, v232
v_accvgpr_write_b32 a137, v233
v_accvgpr_write_b32 a138, v234
v_accvgpr_write_b32 a139, v235
v_accvgpr_read_b32 v232, a152
v_accvgpr_read_b32 v233, a153
v_accvgpr_read_b32 v234, a154
v_accvgpr_read_b32 v235, a155
v_mul_f32 v232, v232, v242
v_mul_f32 v233, v233, v243
v_mul_f32 v234, v234, v254
v_mul_f32 v235, v235, v255
v_accvgpr_write_b32 a152, v232
v_accvgpr_write_b32 a153, v233
v_accvgpr_write_b32 a154, v234
v_accvgpr_write_b32 a155, v235
v_accvgpr_read_b32 v232, a168
v_accvgpr_read_b32 v233, a169
v_accvgpr_read_b32 v234, a170
v_accvgpr_read_b32 v235, a171
v_mul_f32 v232, v232, v242
v_mul_f32 v233, v233, v243
v_mul_f32 v234, v234, v254
v_mul_f32 v235, v235, v255
v_accvgpr_write_b32 a168, v232
v_accvgpr_write_b32 a169, v233
v_accvgpr_write_b32 a170, v234
v_accvgpr_write_b32 a171, v235
v_accvgpr_read_b32 v232, a184
v_accvgpr_read_b32 v233, a185
v_accvgpr_read_b32 v234, a186
v_accvgpr_read_b32 v235, a187
v_mul_f32 v232, v232, v242
v_mul_f32 v233, v233, v243
v_mul_f32 v234, v234, v254
v_mul_f32 v235, v235, v255
v_accvgpr_write_b32 a184, v232
v_accvgpr_write_b32 a185, v233
v_accvgpr_write_b32 a186, v234
v_accvgpr_write_b32 a187, v235
v_accvgpr_read_b32 v232, a200
v_accvgpr_read_b32 v233, a201
v_accvgpr_read_b32 v234, a202
v_accvgpr_read_b32 v235, a203
v_mul_f32 v232, v232, v242
v_mul_f32 v233, v233, v243
v_mul_f32 v234, v234, v254
v_mul_f32 v235, v235, v255
v_accvgpr_write_b32 a200, v232
v_accvgpr_write_b32 a201, v233
v_accvgpr_write_b32 a202, v234
v_accvgpr_write_b32 a203, v235
v_accvgpr_read_b32 v232, a216
v_accvgpr_read_b32 v233, a217
v_accvgpr_read_b32 v234, a218
v_accvgpr_read_b32 v235, a219
v_mul_f32 v232, v232, v242
v_mul_f32 v233, v233, v243
v_mul_f32 v234, v234, v254
v_mul_f32 v235, v235, v255
v_accvgpr_write_b32 a216, v232
v_accvgpr_write_b32 a217, v233
v_accvgpr_write_b32 a218, v234
v_accvgpr_write_b32 a219, v235
v_accvgpr_read_b32 v232, a232
v_accvgpr_read_b32 v233, a233
v_accvgpr_read_b32 v234, a234
v_accvgpr_read_b32 v235, a235
v_mul_f32 v232, v232, v242
v_mul_f32 v233, v233, v243
v_mul_f32 v234, v234, v254
v_mul_f32 v235, v235, v255
v_accvgpr_write_b32 a232, v232
v_accvgpr_write_b32 a233, v233
v_accvgpr_write_b32 a234, v234
v_accvgpr_write_b32 a235, v235
v_accvgpr_read_b32 v232, a248
v_accvgpr_read_b32 v233, a249
v_accvgpr_read_b32 v234, a250
v_accvgpr_read_b32 v235, a251
v_mul_f32 v232, v232, v242
v_mul_f32 v233, v233, v243
v_mul_f32 v234, v234, v254
v_mul_f32 v235, v235, v255
v_accvgpr_write_b32 a248, v232
v_accvgpr_write_b32 a249, v233
v_accvgpr_write_b32 a250, v234
v_accvgpr_write_b32 a251, v235
v_lshrrev_b32 v232, 4, v248
v_and_b32 v232, 0x30, v232
ds_bpermute_b32 v242, v232, v239 offset:0
ds_bpermute_b32 v243, v232, v239 offset:4
ds_bpermute_b32 v254, v232, v239 offset:8
ds_bpermute_b32 v255, v232, v239 offset:12
s_waitcnt lgkmcnt(0)
v_accvgpr_read_b32 v232, a12
v_accvgpr_read_b32 v233, a13
v_accvgpr_read_b32 v234, a14
v_accvgpr_read_b32 v235, a15
v_mul_f32 v232, v232, v242
v_mul_f32 v233, v233, v243
v_mul_f32 v234, v234, v254
v_mul_f32 v235, v235, v255
v_accvgpr_write_b32 a12, v232
v_accvgpr_write_b32 a13, v233
v_accvgpr_write_b32 a14, v234
v_accvgpr_write_b32 a15, v235
v_accvgpr_read_b32 v232, a28
v_accvgpr_read_b32 v233, a29
v_accvgpr_read_b32 v234, a30
v_accvgpr_read_b32 v235, a31
v_mul_f32 v232, v232, v242
v_mul_f32 v233, v233, v243
v_mul_f32 v234, v234, v254
v_mul_f32 v235, v235, v255
v_accvgpr_write_b32 a28, v232
v_accvgpr_write_b32 a29, v233
v_accvgpr_write_b32 a30, v234
v_accvgpr_write_b32 a31, v235
v_accvgpr_read_b32 v232, a44
v_accvgpr_read_b32 v233, a45
v_accvgpr_read_b32 v234, a46
v_accvgpr_read_b32 v235, a47
v_mul_f32 v232, v232, v242
v_mul_f32 v233, v233, v243
v_mul_f32 v234, v234, v254
v_mul_f32 v235, v235, v255
v_accvgpr_write_b32 a44, v232
v_accvgpr_write_b32 a45, v233
v_accvgpr_write_b32 a46, v234
v_accvgpr_write_b32 a47, v235
v_accvgpr_read_b32 v232, a60
v_accvgpr_read_b32 v233, a61
v_accvgpr_read_b32 v234, a62
v_accvgpr_read_b32 v235, a63
v_mul_f32 v232, v232, v242
v_mul_f32 v233, v233, v243
v_mul_f32 v234, v234, v254
v_mul_f32 v235, v235, v255
v_accvgpr_write_b32 a60, v232
v_accvgpr_write_b32 a61, v233
v_accvgpr_write_b32 a62, v234
v_accvgpr_write_b32 a63, v235
v_accvgpr_read_b32 v232, a76
v_accvgpr_read_b32 v233, a77
v_accvgpr_read_b32 v234, a78
v_accvgpr_read_b32 v235, a79
v_mul_f32 v232, v232, v242
v_mul_f32 v233, v233, v243
v_mul_f32 v234, v234, v254
v_mul_f32 v235, v235, v255
v_accvgpr_write_b32 a76, v232
v_accvgpr_write_b32 a77, v233
v_accvgpr_write_b32 a78, v234
v_accvgpr_write_b32 a79, v235
v_accvgpr_read_b32 v232, a92
v_accvgpr_read_b32 v233, a93
v_accvgpr_read_b32 v234, a94
v_accvgpr_read_b32 v235, a95
v_mul_f32 v232, v232, v242
v_mul_f32 v233, v233, v243
v_mul_f32 v234, v234, v254
v_mul_f32 v235, v235, v255
v_accvgpr_write_b32 a92, v232
v_accvgpr_write_b32 a93, v233
v_accvgpr_write_b32 a94, v234
v_accvgpr_write_b32 a95, v235
v_accvgpr_read_b32 v232, a108
v_accvgpr_read_b32 v233, a109
v_accvgpr_read_b32 v234, a110
v_accvgpr_read_b32 v235, a111
v_mul_f32 v232, v232, v242
v_mul_f32 v233, v233, v243
v_mul_f32 v234, v234, v254
v_mul_f32 v235, v235, v255
v_accvgpr_write_b32 a108, v232
v_accvgpr_write_b32 a109, v233
v_accvgpr_write_b32 a110, v234
v_accvgpr_write_b32 a111, v235
v_accvgpr_read_b32 v232, a124
v_accvgpr_read_b32 v233, a125
v_accvgpr_read_b32 v234, a126
v_accvgpr_read_b32 v235, a127
v_mul_f32 v232, v232, v242
v_mul_f32 v233, v233, v243
v_mul_f32 v234, v234, v254
v_mul_f32 v235, v235, v255
v_accvgpr_write_b32 a124, v232
v_accvgpr_write_b32 a125, v233
v_accvgpr_write_b32 a126, v234
v_accvgpr_write_b32 a127, v235
v_accvgpr_read_b32 v232, a140
v_accvgpr_read_b32 v233, a141
v_accvgpr_read_b32 v234, a142
v_accvgpr_read_b32 v235, a143
v_mul_f32 v232, v232, v242
v_mul_f32 v233, v233, v243
v_mul_f32 v234, v234, v254
v_mul_f32 v235, v235, v255
v_accvgpr_write_b32 a140, v232
v_accvgpr_write_b32 a141, v233
v_accvgpr_write_b32 a142, v234
v_accvgpr_write_b32 a143, v235
v_accvgpr_read_b32 v232, a156
v_accvgpr_read_b32 v233, a157
v_accvgpr_read_b32 v234, a158
v_accvgpr_read_b32 v235, a159
v_mul_f32 v232, v232, v242
v_mul_f32 v233, v233, v243
v_mul_f32 v234, v234, v254
v_mul_f32 v235, v235, v255
v_accvgpr_write_b32 a156, v232
v_accvgpr_write_b32 a157, v233
v_accvgpr_write_b32 a158, v234
v_accvgpr_write_b32 a159, v235
v_accvgpr_read_b32 v232, a172
v_accvgpr_read_b32 v233, a173
v_accvgpr_read_b32 v234, a174
v_accvgpr_read_b32 v235, a175
v_mul_f32 v232, v232, v242
v_mul_f32 v233, v233, v243
v_mul_f32 v234, v234, v254
v_mul_f32 v235, v235, v255
v_accvgpr_write_b32 a172, v232
v_accvgpr_write_b32 a173, v233
v_accvgpr_write_b32 a174, v234
v_accvgpr_write_b32 a175, v235
v_accvgpr_read_b32 v232, a188
v_accvgpr_read_b32 v233, a189
v_accvgpr_read_b32 v234, a190
v_accvgpr_read_b32 v235, a191
v_mul_f32 v232, v232, v242
v_mul_f32 v233, v233, v243
v_mul_f32 v234, v234, v254
v_mul_f32 v235, v235, v255
v_accvgpr_write_b32 a188, v232
v_accvgpr_write_b32 a189, v233
v_accvgpr_write_b32 a190, v234
v_accvgpr_write_b32 a191, v235
v_accvgpr_read_b32 v232, a204
v_accvgpr_read_b32 v233, a205
v_accvgpr_read_b32 v234, a206
v_accvgpr_read_b32 v235, a207
v_mul_f32 v232, v232, v242
v_mul_f32 v233, v233, v243
v_mul_f32 v234, v234, v254
v_mul_f32 v235, v235, v255
v_accvgpr_write_b32 a204, v232
v_accvgpr_write_b32 a205, v233
v_accvgpr_write_b32 a206, v234
v_accvgpr_write_b32 a207, v235
v_accvgpr_read_b32 v232, a220
v_accvgpr_read_b32 v233, a221
v_accvgpr_read_b32 v234, a222
v_accvgpr_read_b32 v235, a223
v_mul_f32 v232, v232, v242
v_mul_f32 v233, v233, v243
v_mul_f32 v234, v234, v254
v_mul_f32 v235, v235, v255
v_accvgpr_write_b32 a220, v232
v_accvgpr_write_b32 a221, v233
v_accvgpr_write_b32 a222, v234
v_accvgpr_write_b32 a223, v235
v_accvgpr_read_b32 v232, a236
v_accvgpr_read_b32 v233, a237
v_accvgpr_read_b32 v234, a238
v_accvgpr_read_b32 v235, a239
v_mul_f32 v232, v232, v242
v_mul_f32 v233, v233, v243
v_mul_f32 v234, v234, v254
v_mul_f32 v235, v235, v255
v_accvgpr_write_b32 a236, v232
v_accvgpr_write_b32 a237, v233
v_accvgpr_write_b32 a238, v234
v_accvgpr_write_b32 a239, v235
v_accvgpr_read_b32 v232, a252
v_accvgpr_read_b32 v233, a253
v_accvgpr_read_b32 v234, a254
v_accvgpr_read_b32 v235, a255
v_mul_f32 v232, v232, v242
v_mul_f32 v233, v233, v243
v_mul_f32 v234, v234, v254
v_mul_f32 v235, v235, v255
v_accvgpr_write_b32 a252, v232
v_accvgpr_write_b32 a253, v233
v_accvgpr_write_b32 a254, v234
v_accvgpr_write_b32 a255, v235
s_nop 3
s_cmp_eq_u32 s36, 0
s_cbranch_scc1 L2_ret0
s_cmp_eq_u32 s36, 1
s_cbranch_scc1 L2_ret1
s_cmp_eq_u32 s36, 2
s_cbranch_scc1 L2_ret2
s_cmp_eq_u32 s36, 3
s_cbranch_scc1 L2_ret3
s_cmp_eq_u32 s36, 4
s_cbranch_scc1 L2_ret4
s_cmp_eq_u32 s36, 5
s_cbranch_scc1 L2_ret5
s_cmp_eq_u32 s36, 6
s_cbranch_scc1 L2_ret6
s_cmp_eq_u32 s36, 7
s_cbranch_scc1 L2_ret7
s_cmp_eq_u32 s36, 8
s_cbranch_scc1 L2_ret8
s_cmp_eq_u32 s36, 9
s_cbranch_scc1 L2_ret9
s_cmp_eq_u32 s36, 10
s_cbranch_scc1 L2_ret10
s_cmp_eq_u32 s36, 11
s_cbranch_scc1 L2_ret11
s_cmp_eq_u32 s36, 12
s_cbranch_scc1 L2_ret12
s_cmp_eq_u32 s36, 13
s_cbranch_scc1 L2_ret13
s_cmp_eq_u32 s36, 14
s_cbranch_scc1 L2_ret14
s_cmp_eq_u32 s36, 15
s_cbranch_scc1 L2_ret15
s_cmp_eq_u32 s36, 16
s_cbranch_scc1 L2_ret16
s_cmp_eq_u32 s36, 17
s_cbranch_scc1 L2_ret17
s_cmp_eq_u32 s36, 18
s_cbranch_scc1 L2_ret18
s_branch L2_ret19
LT_disp:
s_cmp_eq_u32 s34, 0
s_cbranch_scc1 LT_start
s_mov_b32 s41, s34
s_mul_i32 s40, s34, 6
s_add_u32 s40, s40, s37
s_add_u32 s40, s40, 42
s_cmp_lt_u32 s40, 64
s_cbranch_scc1 LE_common
s_branch L2_end
LT_start:
s_waitcnt lgkmcnt(0)
s_add_u32 s12, s4, 0x7c2a000
s_addc_u32 s13, s5, 0
s_mov_b32 s14, 0x8000
s_mov_b32 s15, 0x00020000
v_and_b32 v8, 63, v0
v_lshlrev_b32 v8, 7, v8
s_mov_b32 s91, 8192
s_mov_b32 s90, 16384
s_mov_b32 s95, 24576
s_mov_b32 s94, 0x10000
LT_poll:
buffer_load_dwordx2 v[0:1], v8, s[12:15], 0 offen sc1
buffer_load_dwordx2 v[2:3], v8, s[12:15], s91 offen sc1
buffer_load_dwordx2 v[4:5], v8, s[12:15], s90 offen sc1
buffer_load_dwordx2 v[6:7], v8, s[12:15], s95 offen sc1
s_sub_u32 s94, s94, 1
s_waitcnt vmcnt(0)
s_cbranch_scc1 LT_poll_go
v_cmp_ne_u64 vcc, s[98:99], v[0:1]
s_nop 1
s_cbranch_vccnz LT_poll
v_cmp_ne_u64 vcc, s[98:99], v[2:3]
s_nop 1
s_cbranch_vccnz LT_poll
v_cmp_ne_u64 vcc, s[98:99], v[4:5]
s_nop 1
s_cbranch_vccnz LT_poll
v_cmp_ne_u64 vcc, s[98:99], v[6:7]
s_nop 1
s_cbranch_vccnz LT_poll
LT_poll_go:
s_add_u32 s12, s4, 0x6800000
s_addc_u32 s13, s5, 0
s_mov_b32 s14, 0x0
s_mov_b32 s15, 0x00020000
s_mov_b32 s14, s49
s_add_u32 s8, s4, 0x0
s_addc_u32 s9, s5, 0
s_mov_b32 s10, 0x4e4000
s_mov_b32 s11, 0x00020000
s_mov_b32 s40, 5111808
s_mov_b32 s44, 5115904
buffer_load_dwordx4 v[0:3], v248, s[8:11], s40 offen offset:0 sc1
buffer_load_dwordx4 v[4:7], v248, s[8:11], s40 offen offset:1024 sc1
buffer_load_dwordx4 v[8:11], v248, s[8:11], s40 offen offset:2048 sc1
buffer_load_dwordx4 v[12:15], v248, s[8:11], s40 offen offset:3072 sc1
buffer_load_dwordx4 v[16:19], v248, s[8:11], s44 offen offset:0 sc1
buffer_load_dwordx4 v[20:23], v248, s[8:11], s44 offen offset:1024 sc1
buffer_load_dwordx4 v[24:27], v248, s[8:11], s44 offen offset:2048 sc1
buffer_load_dwordx4 v[28:31], v248, s[8:11], s44 offen offset:3072 sc1
s_mov_b32 s53, 0
s_add_u32 m0, s53, 90112
s_add_u32 s54, s39, 0
buffer_load_dwordx4 v241, s[12:15], s54 offen offset:0 sc1 lds
buffer_load_dwordx4 v241, s[12:15], s54 offen offset:1024 sc1 lds
buffer_load_dwordx4 v241, s[12:15], s54 offen offset:2048 sc1 lds
buffer_load_dwordx4 v241, s[12:15], s54 offen offset:3072 sc1 lds
s_add_u32 m0, s53, 94208
s_add_u32 s54, s39, 128
buffer_load_dwordx4 v241, s[12:15], s54 offen offset:0 sc1 lds
buffer_load_dwordx4 v241, s[12:15], s54 offen offset:1024 sc1 lds
buffer_load_dwordx4 v241, s[12:15], s54 offen offset:2048 sc1 lds
buffer_load_dwordx4 v241, s[12:15], s54 offen offset:3072 sc1 lds
s_add_u32 m0, s53, 98304
s_add_u32 s54, s39, 256
buffer_load_dwordx4 v241, s[12:15], s54 offen offset:0 sc1 lds
buffer_load_dwordx4 v241, s[12:15], s54 offen offset:1024 sc1 lds
buffer_load_dwordx4 v241, s[12:15], s54 offen offset:2048 sc1 lds
buffer_load_dwordx4 v241, s[12:15], s54 offen offset:3072 sc1 lds
s_add_u32 m0, s53, 102400
s_add_u32 s54, s39, 384
buffer_load_dwordx4 v241, s[12:15], s54 offen offset:0 sc1 lds
buffer_load_dwordx4 v241, s[12:15], s54 offen offset:1024 sc1 lds
buffer_load_dwordx4 v241, s[12:15], s54 offen offset:2048 sc1 lds
buffer_load_dwordx4 v241, s[12:15], s54 offen offset:3072 sc1 lds
s_add_u32 s53, s53, 0x4000
s_and_b32 s53, s53, 0xffff
s_add_u32 m0, s53, 90112
s_add_u32 s54, s28, 0
buffer_load_dwordx4 v241, s[12:15], s54 offen offset:0 sc1 lds
buffer_load_dwordx4 v241, s[12:15], s54 offen offset:1024 sc1 lds
buffer_load_dwordx4 v241, s[12:15], s54 offen offset:2048 sc1 lds
buffer_load_dwordx4 v241, s[12:15], s54 offen offset:3072 sc1 lds
s_add_u32 m0, s53, 94208
s_add_u32 s54, s28, 128
buffer_load_dwordx4 v241, s[12:15], s54 offen offset:0 sc1 lds
buffer_load_dwordx4 v241, s[12:15], s54 offen offset:1024 sc1 lds
buffer_load_dwordx4 v241, s[12:15], s54 offen offset:2048 sc1 lds
buffer_load_dwordx4 v241, s[12:15], s54 offen offset:3072 sc1 lds
s_add_u32 m0, s53, 98304
s_add_u32 s54, s28, 256
buffer_load_dwordx4 v241, s[12:15], s54 offen offset:0 sc1 lds
buffer_load_dwordx4 v241, s[12:15], s54 offen offset:1024 sc1 lds
buffer_load_dwordx4 v241, s[12:15], s54 offen offset:2048 sc1 lds
buffer_load_dwordx4 v241, s[12:15], s54 offen offset:3072 sc1 lds
s_add_u32 m0, s53, 102400
s_add_u32 s54, s28, 384
buffer_load_dwordx4 v241, s[12:15], s54 offen offset:0 sc1 lds
buffer_load_dwordx4 v241, s[12:15], s54 offen offset:1024 sc1 lds
buffer_load_dwordx4 v241, s[12:15], s54 offen offset:2048 sc1 lds
buffer_load_dwordx4 v241, s[12:15], s54 offen offset:3072 sc1 lds
s_add_u32 s53, s53, 0x4000
s_and_b32 s53, s53, 0xffff
s_add_u32 s28, s28, 0x4000
s_add_u32 m0, s53, 90112
s_add_u32 s54, s28, 0
buffer_load_dwordx4 v241, s[12:15], s54 offen offset:0 sc1 lds
buffer_load_dwordx4 v241, s[12:15], s54 offen offset:1024 sc1 lds
buffer_load_dwordx4 v241, s[12:15], s54 offen offset:2048 sc1 lds
buffer_load_dwordx4 v241, s[12:15], s54 offen offset:3072 sc1 lds
s_add_u32 m0, s53, 94208
s_add_u32 s54, s28, 128
buffer_load_dwordx4 v241, s[12:15], s54 offen offset:0 sc1 lds
buffer_load_dwordx4 v241, s[12:15], s54 offen offset:1024 sc1 lds
buffer_load_dwordx4 v241, s[12:15], s54 offen offset:2048 sc1 lds
buffer_load_dwordx4 v241, s[12:15], s54 offen offset:3072 sc1 lds
s_add_u32 m0, s53, 98304
s_add_u32 s54, s28, 256
buffer_load_dwordx4 v241, s[12:15], s54 offen offset:0 sc1 lds
buffer_load_dwordx4 v241, s[12:15], s54 offen offset:1024 sc1 lds
buffer_load_dwordx4 v241, s[12:15], s54 offen offset:2048 sc1 lds
buffer_load_dwordx4 v241, s[12:15], s54 offen offset:3072 sc1 lds
s_add_u32 m0, s53, 102400
s_add_u32 s54, s28, 384
buffer_load_dwordx4 v241, s[12:15], s54 offen offset:0 sc1 lds
buffer_load_dwordx4 v241, s[12:15], s54 offen offset:1024 sc1 lds
buffer_load_dwordx4 v241, s[12:15], s54 offen offset:2048 sc1 lds
buffer_load_dwordx4 v241, s[12:15], s54 offen offset:3072 sc1 lds
s_add_u32 s53, s53, 0x4000
s_and_b32 s53, s53, 0xffff
s_add_u32 s28, s28, 0x4000
s_mul_i32 s35, s37, 0x600000
s_add_u32 s20, s4, 0x2000000
s_addc_u32 s21, s5, 0
s_add_u32 s20, s20, s35
s_addc_u32 s21, s21, 0
s_mov_b32 s22, 0x4e4000
s_mov_b32 s23, 0x00020000
s_add_u32 s24, s4, 0x6000000
s_addc_u32 s25, s5, 0
s_mov_b32 s26, 0x139000
s_mov_b32 s27, 0x00020000
s_lshl_b32 s48, s37, 3
s_add_u32 s48, s48, 638976
s_mov_b32 s48, 1277952
v_bfe_u32 v240, v248, 4, 3
v_lshlrev_b32 v240, 6, v240
v_bfe_u32 v242, v248, 7, 1
v_lshl_or_b32 v240, v242, 10, v240
v_bfe_u32 v242, v248, 8, 2
v_lshl_or_b32 v240, v242, 4, v240
v_bfe_u32 v242, v248, 6, 1
v_lshlrev_b32 v242, 5, v242
v_xor_b32 v240, v240, v242
v_and_b32 v249, 0x1c0, v248
v_bfe_u32 v242, v248, 9, 1
v_lshl_or_b32 v249, v242, 10, v249
v_bfe_u32 v242, v248, 8, 1
v_lshl_or_b32 v249, v242, 5, v249
v_bfe_u32 v242, v248, 4, 2
v_lshl_or_b32 v249, v242, 3, v249
v_xor_b32 v250, 32, v249
v_bfe_i32 v242, v248, 8, 1
v_and_b32 v192, s33, v242
v_and_b32 v193, s33, v242
v_and_b32 v194, s33, v242
v_and_b32 v195, s33, v242
s_add_u32 s51, s31, 5
s_mov_b32 s52, 90112
v_mov_b32 v172, 0xff800000
v_mov_b32 v173, 0
v_accvgpr_write_b32 a0, 0
v_accvgpr_write_b32 a1, 0
v_accvgpr_write_b32 a2, 0
v_accvgpr_write_b32 a3, 0
v_accvgpr_write_b32 a4, 0
v_accvgpr_write_b32 a5, 0
v_accvgpr_write_b32 a6, 0
v_accvgpr_write_b32 a7, 0
v_accvgpr_write_b32 a8, 0
v_accvgpr_write_b32 a9, 0
v_accvgpr_write_b32 a10, 0
v_accvgpr_write_b32 a11, 0
v_accvgpr_write_b32 a12, 0
v_accvgpr_write_b32 a13, 0
v_accvgpr_write_b32 a14, 0
v_accvgpr_write_b32 a15, 0
v_accvgpr_write_b32 a16, 0
v_accvgpr_write_b32 a17, 0
v_accvgpr_write_b32 a18, 0
v_accvgpr_write_b32 a19, 0
v_accvgpr_write_b32 a20, 0
v_accvgpr_write_b32 a21, 0
v_accvgpr_write_b32 a22, 0
v_accvgpr_write_b32 a23, 0
v_accvgpr_write_b32 a24, 0
v_accvgpr_write_b32 a25, 0
v_accvgpr_write_b32 a26, 0
v_accvgpr_write_b32 a27, 0
v_accvgpr_write_b32 a28, 0
v_accvgpr_write_b32 a29, 0
v_accvgpr_write_b32 a30, 0
v_accvgpr_write_b32 a31, 0
v_accvgpr_write_b32 a32, 0
v_accvgpr_write_b32 a33, 0
v_accvgpr_write_b32 a34, 0
v_accvgpr_write_b32 a35, 0
v_accvgpr_write_b32 a36, 0
v_accvgpr_write_b32 a37, 0
v_accvgpr_write_b32 a38, 0
v_accvgpr_write_b32 a39, 0
v_accvgpr_write_b32 a40, 0
v_accvgpr_write_b32 a41, 0
v_accvgpr_write_b32 a42, 0
v_accvgpr_write_b32 a43, 0
v_accvgpr_write_b32 a44, 0
v_accvgpr_write_b32 a45, 0
v_accvgpr_write_b32 a46, 0
v_accvgpr_write_b32 a47, 0
v_accvgpr_write_b32 a48, 0
v_accvgpr_write_b32 a49, 0
v_accvgpr_write_b32 a50, 0
v_accvgpr_write_b32 a51, 0
v_accvgpr_write_b32 a52, 0
v_accvgpr_write_b32 a53, 0
v_accvgpr_write_b32 a54, 0
v_accvgpr_write_b32 a55, 0
v_accvgpr_write_b32 a56, 0
v_accvgpr_write_b32 a57, 0
v_accvgpr_write_b32 a58, 0
v_accvgpr_write_b32 a59, 0
v_accvgpr_write_b32 a60, 0
v_accvgpr_write_b32 a61, 0
v_accvgpr_write_b32 a62, 0
v_accvgpr_write_b32 a63, 0
LT_loop:
s_add_u32 m0, s53, 90112
s_add_u32 s54, s28, 0
buffer_load_dwordx4 v241, s[12:15], s54 offen offset:0 sc1 lds
buffer_load_dwordx4 v241, s[12:15], s54 offen offset:1024 sc1 lds
buffer_load_dwordx4 v241, s[12:15], s54 offen offset:2048 sc1 lds
buffer_load_dwordx4 v241, s[12:15], s54 offen offset:3072 sc1 lds
s_add_u32 m0, s53, 94208
s_add_u32 s54, s28, 128
buffer_load_dwordx4 v241, s[12:15], s54 offen offset:0 sc1 lds
buffer_load_dwordx4 v241, s[12:15], s54 offen offset:1024 sc1 lds
buffer_load_dwordx4 v241, s[12:15], s54 offen offset:2048 sc1 lds
buffer_load_dwordx4 v241, s[12:15], s54 offen offset:3072 sc1 lds
s_add_u32 m0, s53, 98304
s_add_u32 s54, s28, 256
buffer_load_dwordx4 v241, s[12:15], s54 offen offset:0 sc1 lds
buffer_load_dwordx4 v241, s[12:15], s54 offen offset:1024 sc1 lds
buffer_load_dwordx4 v241, s[12:15], s54 offen offset:2048 sc1 lds
buffer_load_dwordx4 v241, s[12:15], s54 offen offset:3072 sc1 lds
s_add_u32 m0, s53, 102400
s_add_u32 s54, s28, 384
buffer_load_dwordx4 v241, s[12:15], s54 offen offset:0 sc1 lds
buffer_load_dwordx4 v241, s[12:15], s54 offen offset:1024 sc1 lds
buffer_load_dwordx4 v241, s[12:15], s54 offen offset:2048 sc1 lds
buffer_load_dwordx4 v241, s[12:15], s54 offen offset:3072 sc1 lds
s_add_u32 s53, s53, 0x4000
s_and_b32 s53, s53, 0xffff
s_add_u32 s28, s28, 0x4000
v_add_u32 v177, s52, v240
v_add_u32 v178, s52, v249
v_add_u32 v179, s52, v250
s_add_u32 s52, s52, 0x4000
s_cmp_eq_u32 s52, 155648
s_cselect_b32 s52, 90112, s52
s_waitcnt vmcnt(48)
ds_read_b128 v[32:35], v177 offset:0
ds_read_b128 v[64:67], v177 offset:2048
ds_read_b128 v[36:39], v177 offset:512
ds_read_b128 v[68:71], v177 offset:2560
ds_read_b128 v[40:43], v177 offset:4096
ds_read_b128 v[72:75], v177 offset:6144
ds_read_b128 v[44:47], v177 offset:4608
ds_read_b128 v[76:79], v177 offset:6656
ds_read_b128 v[48:51], v177 offset:8192
ds_read_b128 v[80:83], v177 offset:10240
ds_read_b128 v[52:55], v177 offset:8704
ds_read_b128 v[84:87], v177 offset:10752
ds_read_b128 v[56:59], v177 offset:12288
ds_read_b128 v[88:91], v177 offset:14336
ds_read_b128 v[60:63], v177 offset:12800
ds_read_b128 v[92:95], v177 offset:14848
s_waitcnt lgkmcnt(14)
v_mfma_f32_16x16x32_bf16 v[160:163], v[32:35], v[0:3], v[192:195]
v_mfma_f32_16x16x32_bf16 v[164:167], v[64:67], v[0:3], v[192:195]
s_waitcnt lgkmcnt(12)
v_mfma_f32_16x16x32_bf16 v[160:163], v[36:39], v[4:7], v[160:163]
v_mfma_f32_16x16x32_bf16 v[164:167], v[68:71], v[4:7], v[164:167]
s_waitcnt lgkmcnt(10)
v_mfma_f32_16x16x32_bf16 v[160:163], v[40:43], v[8:11], v[160:163]
v_mfma_f32_16x16x32_bf16 v[164:167], v[72:75], v[8:11], v[164:167]
s_waitcnt lgkmcnt(8)
v_mfma_f32_16x16x32_bf16 v[160:163], v[44:47], v[12:15], v[160:163]
v_mfma_f32_16x16x32_bf16 v[164:167], v[76:79], v[12:15], v[164:167]
s_waitcnt lgkmcnt(6)
v_mfma_f32_16x16x32_bf16 v[160:163], v[48:51], v[16:19], v[160:163]
v_mfma_f32_16x16x32_bf16 v[164:167], v[80:83], v[16:19], v[164:167]
s_waitcnt lgkmcnt(4)
v_mfma_f32_16x16x32_bf16 v[160:163], v[52:55], v[20:23], v[160:163]
v_mfma_f32_16x16x32_bf16 v[164:167], v[84:87], v[20:23], v[164:167]
s_waitcnt lgkmcnt(2)
v_mfma_f32_16x16x32_bf16 v[160:163], v[56:59], v[24:27], v[160:163]
v_mfma_f32_16x16x32_bf16 v[164:167], v[88:91], v[24:27], v[164:167]
s_waitcnt lgkmcnt(0)
v_mfma_f32_16x16x32_bf16 v[160:163], v[60:63], v[28:31], v[160:163]
v_mfma_f32_16x16x32_bf16 v[164:167], v[92:95], v[28:31], v[164:167]
ds_read_b64_tr_b16 v[96:97], v178 offset:0
ds_read_b64_tr_b16 v[98:99], v178 offset:2048
ds_read_b64_tr_b16 v[100:101], v179 offset:0
ds_read_b64_tr_b16 v[102:103], v179 offset:2048
ds_read_b64_tr_b16 v[104:105], v178 offset:512
ds_read_b64_tr_b16 v[106:107], v178 offset:2560
ds_read_b64_tr_b16 v[108:109], v179 offset:512
ds_read_b64_tr_b16 v[110:111], v179 offset:2560
ds_read_b64_tr_b16 v[112:113], v178 offset:4096
ds_read_b64_tr_b16 v[114:115], v178 offset:6144
ds_read_b64_tr_b16 v[116:117], v179 offset:4096
ds_read_b64_tr_b16 v[118:119], v179 offset:6144
ds_read_b64_tr_b16 v[120:121], v178 offset:4608
ds_read_b64_tr_b16 v[122:123], v178 offset:6656
ds_read_b64_tr_b16 v[124:125], v179 offset:4608
ds_read_b64_tr_b16 v[126:127], v179 offset:6656
ds_read_b64_tr_b16 v[128:129], v178 offset:8192
ds_read_b64_tr_b16 v[130:131], v178 offset:10240
ds_read_b64_tr_b16 v[132:133], v179 offset:8192
ds_read_b64_tr_b16 v[134:135], v179 offset:10240
ds_read_b64_tr_b16 v[136:137], v178 offset:8704
ds_read_b64_tr_b16 v[138:139], v178 offset:10752
ds_read_b64_tr_b16 v[140:141], v179 offset:8704
ds_read_b64_tr_b16 v[142:143], v179 offset:10752
ds_read_b64_tr_b16 v[144:145], v178 offset:12288
ds_read_b64_tr_b16 v[146:147], v178 offset:14336
ds_read_b64_tr_b16 v[148:149], v179 offset:12288
ds_read_b64_tr_b16 v[150:151], v179 offset:14336
ds_read_b64_tr_b16 v[152:153], v178 offset:12800
ds_read_b64_tr_b16 v[154:155], v178 offset:14848
ds_read_b64_tr_b16 v[156:157], v179 offset:12800
ds_read_b64_tr_b16 v[158:159], v179 offset:14848
v_mov_b32 v192, 0
v_mov_b32 v193, 0
v_mov_b32 v194, 0
v_mov_b32 v195, 0
s_nop 7
v_max3_f32 v175, v160, v161, v162
v_max3_f32 v175, v175, v163, v164
v_max3_f32 v175, v175, v165, v166
v_max3_f32 v175, v175, v167, v172
v_mov_b32 v176, v175
s_nop 1
v_permlane32_swap_b32 v175, v176
s_nop 1
v_max_f32 v175, v175, v176
v_mov_b32 v176, v175
s_nop 1
v_permlane16_swap_b32 v175, v176
s_nop 1
v_max_f32 v175, v175, v176
v_ceil_f32 v175, v175
v_sub_f32 v174, v172, v175
v_exp_f32 v174, v174
v_mov_b32 v172, v175
v_sub_f32 v160, v160, v172
v_sub_f32 v161, v161, v172
v_sub_f32 v162, v162, v172
v_sub_f32 v163, v163, v172
v_sub_f32 v164, v164, v172
v_sub_f32 v165, v165, v172
v_sub_f32 v166, v166, v172
v_sub_f32 v167, v167, v172
v_exp_f32 v160, v160
v_exp_f32 v161, v161
v_exp_f32 v162, v162
v_exp_f32 v163, v163
v_exp_f32 v164, v164
v_exp_f32 v165, v165
v_exp_f32 v166, v166
v_exp_f32 v167, v167
v_mul_f32 v173, v173, v174
v_cvt_pk_bf16_f32 v168, v160, v161
v_cvt_pk_bf16_f32 v169, v162, v163
v_cvt_pk_bf16_f32 v170, v164, v165
v_cvt_pk_bf16_f32 v171, v166, v167
v_cmp_neq_f32 vcc, 1.0, v174
v_add_f32 v173, v173, v160
v_add_f32 v173, v173, v161
v_add_f32 v173, v173, v162
v_add_f32 v173, v173, v163
v_add_f32 v173, v173, v164
v_add_f32 v173, v173, v165
v_add_f32 v173, v173, v166
v_add_f32 v173, v173, v167
s_cbranch_vccz LT_nors
v_lshrrev_b32 v176, 4, v248
v_and_b32 v176, 0x30, v176
ds_bpermute_b32 v188, v176, v174 offset:0
ds_bpermute_b32 v189, v176, v174 offset:4
ds_bpermute_b32 v190, v176, v174 offset:8
ds_bpermute_b32 v191, v176, v174 offset:12
s_waitcnt lgkmcnt(0)
v_accvgpr_read_b32 v180, a0
v_accvgpr_read_b32 v181, a1
v_accvgpr_read_b32 v182, a2
v_accvgpr_read_b32 v183, a3
v_accvgpr_read_b32 v184, a4
v_accvgpr_read_b32 v185, a5
v_accvgpr_read_b32 v186, a6
v_accvgpr_read_b32 v187, a7
v_mul_f32 v180, v180, v188
v_mul_f32 v181, v181, v189
v_mul_f32 v182, v182, v190
v_mul_f32 v183, v183, v191
v_mul_f32 v184, v184, v188
v_mul_f32 v185, v185, v189
v_mul_f32 v186, v186, v190
v_mul_f32 v187, v187, v191
v_accvgpr_write_b32 a0, v180
v_accvgpr_write_b32 a1, v181
v_accvgpr_write_b32 a2, v182
v_accvgpr_write_b32 a3, v183
v_accvgpr_write_b32 a4, v184
v_accvgpr_write_b32 a5, v185
v_accvgpr_write_b32 a6, v186
v_accvgpr_write_b32 a7, v187
v_accvgpr_read_b32 v180, a8
v_accvgpr_read_b32 v181, a9
v_accvgpr_read_b32 v182, a10
v_accvgpr_read_b32 v183, a11
v_accvgpr_read_b32 v184, a12
v_accvgpr_read_b32 v185, a13
v_accvgpr_read_b32 v186, a14
v_accvgpr_read_b32 v187, a15
v_mul_f32 v180, v180, v188
v_mul_f32 v181, v181, v189
v_mul_f32 v182, v182, v190
v_mul_f32 v183, v183, v191
v_mul_f32 v184, v184, v188
v_mul_f32 v185, v185, v189
v_mul_f32 v186, v186, v190
v_mul_f32 v187, v187, v191
v_accvgpr_write_b32 a8, v180
v_accvgpr_write_b32 a9, v181
v_accvgpr_write_b32 a10, v182
v_accvgpr_write_b32 a11, v183
v_accvgpr_write_b32 a12, v184
v_accvgpr_write_b32 a13, v185
v_accvgpr_write_b32 a14, v186
v_accvgpr_write_b32 a15, v187
v_accvgpr_read_b32 v180, a16
v_accvgpr_read_b32 v181, a17
v_accvgpr_read_b32 v182, a18
v_accvgpr_read_b32 v183, a19
v_accvgpr_read_b32 v184, a20
v_accvgpr_read_b32 v185, a21
v_accvgpr_read_b32 v186, a22
v_accvgpr_read_b32 v187, a23
v_mul_f32 v180, v180, v188
v_mul_f32 v181, v181, v189
v_mul_f32 v182, v182, v190
v_mul_f32 v183, v183, v191
v_mul_f32 v184, v184, v188
v_mul_f32 v185, v185, v189
v_mul_f32 v186, v186, v190
v_mul_f32 v187, v187, v191
v_accvgpr_write_b32 a16, v180
v_accvgpr_write_b32 a17, v181
v_accvgpr_write_b32 a18, v182
v_accvgpr_write_b32 a19, v183
v_accvgpr_write_b32 a20, v184
v_accvgpr_write_b32 a21, v185
v_accvgpr_write_b32 a22, v186
v_accvgpr_write_b32 a23, v187
v_accvgpr_read_b32 v180, a24
v_accvgpr_read_b32 v181, a25
v_accvgpr_read_b32 v182, a26
v_accvgpr_read_b32 v183, a27
v_accvgpr_read_b32 v184, a28
v_accvgpr_read_b32 v185, a29
v_accvgpr_read_b32 v186, a30
v_accvgpr_read_b32 v187, a31
v_mul_f32 v180, v180, v188
v_mul_f32 v181, v181, v189
v_mul_f32 v182, v182, v190
v_mul_f32 v183, v183, v191
v_mul_f32 v184, v184, v188
v_mul_f32 v185, v185, v189
v_mul_f32 v186, v186, v190
v_mul_f32 v187, v187, v191
v_accvgpr_write_b32 a24, v180
v_accvgpr_write_b32 a25, v181
v_accvgpr_write_b32 a26, v182
v_accvgpr_write_b32 a27, v183
v_accvgpr_write_b32 a28, v184
v_accvgpr_write_b32 a29, v185
v_accvgpr_write_b32 a30, v186
v_accvgpr_write_b32 a31, v187
v_accvgpr_read_b32 v180, a32
v_accvgpr_read_b32 v181, a33
v_accvgpr_read_b32 v182, a34
v_accvgpr_read_b32 v183, a35
v_accvgpr_read_b32 v184, a36
v_accvgpr_read_b32 v185, a37
v_accvgpr_read_b32 v186, a38
v_accvgpr_read_b32 v187, a39
v_mul_f32 v180, v180, v188
v_mul_f32 v181, v181, v189
v_mul_f32 v182, v182, v190
v_mul_f32 v183, v183, v191
v_mul_f32 v184, v184, v188
v_mul_f32 v185, v185, v189
v_mul_f32 v186, v186, v190
v_mul_f32 v187, v187, v191
v_accvgpr_write_b32 a32, v180
v_accvgpr_write_b32 a33, v181
v_accvgpr_write_b32 a34, v182
v_accvgpr_write_b32 a35, v183
v_accvgpr_write_b32 a36, v184
v_accvgpr_write_b32 a37, v185
v_accvgpr_write_b32 a38, v186
v_accvgpr_write_b32 a39, v187
v_accvgpr_read_b32 v180, a40
v_accvgpr_read_b32 v181, a41
v_accvgpr_read_b32 v182, a42
v_accvgpr_read_b32 v183, a43
v_accvgpr_read_b32 v184, a44
v_accvgpr_read_b32 v185, a45
v_accvgpr_read_b32 v186, a46
v_accvgpr_read_b32 v187, a47
v_mul_f32 v180, v180, v188
v_mul_f32 v181, v181, v189
v_mul_f32 v182, v182, v190
v_mul_f32 v183, v183, v191
v_mul_f32 v184, v184, v188
v_mul_f32 v185, v185, v189
v_mul_f32 v186, v186, v190
v_mul_f32 v187, v187, v191
v_accvgpr_write_b32 a40, v180
v_accvgpr_write_b32 a41, v181
v_accvgpr_write_b32 a42, v182
v_accvgpr_write_b32 a43, v183
v_accvgpr_write_b32 a44, v184
v_accvgpr_write_b32 a45, v185
v_accvgpr_write_b32 a46, v186
v_accvgpr_write_b32 a47, v187
v_accvgpr_read_b32 v180, a48
v_accvgpr_read_b32 v181, a49
v_accvgpr_read_b32 v182, a50
v_accvgpr_read_b32 v183, a51
v_accvgpr_read_b32 v184, a52
v_accvgpr_read_b32 v185, a53
v_accvgpr_read_b32 v186, a54
v_accvgpr_read_b32 v187, a55
v_mul_f32 v180, v180, v188
v_mul_f32 v181, v181, v189
v_mul_f32 v182, v182, v190
v_mul_f32 v183, v183, v191
v_mul_f32 v184, v184, v188
v_mul_f32 v185, v185, v189
v_mul_f32 v186, v186, v190
v_mul_f32 v187, v187, v191
v_accvgpr_write_b32 a48, v180
v_accvgpr_write_b32 a49, v181
v_accvgpr_write_b32 a50, v182
v_accvgpr_write_b32 a51, v183
v_accvgpr_write_b32 a52, v184
v_accvgpr_write_b32 a53, v185
v_accvgpr_write_b32 a54, v186
v_accvgpr_write_b32 a55, v187
v_accvgpr_read_b32 v180, a56
v_accvgpr_read_b32 v181, a57
v_accvgpr_read_b32 v182, a58
v_accvgpr_read_b32 v183, a59
v_accvgpr_read_b32 v184, a60
v_accvgpr_read_b32 v185, a61
v_accvgpr_read_b32 v186, a62
v_accvgpr_read_b32 v187, a63
v_mul_f32 v180, v180, v188
v_mul_f32 v181, v181, v189
v_mul_f32 v182, v182, v190
v_mul_f32 v183, v183, v191
v_mul_f32 v184, v184, v188
v_mul_f32 v185, v185, v189
v_mul_f32 v186, v186, v190
v_mul_f32 v187, v187, v191
v_accvgpr_write_b32 a56, v180
v_accvgpr_write_b32 a57, v181
v_accvgpr_write_b32 a58, v182
v_accvgpr_write_b32 a59, v183
v_accvgpr_write_b32 a60, v184
v_accvgpr_write_b32 a61, v185
v_accvgpr_write_b32 a62, v186
v_accvgpr_write_b32 a63, v187
LT_nors:
s_waitcnt lgkmcnt(0)
s_nop 1
v_mfma_f32_16x16x32_bf16 a[0:3], v[168:171], v[96:99], a[0:3]
v_mfma_f32_16x16x32_bf16 a[4:7], v[168:171], v[100:103], a[4:7]
v_mfma_f32_16x16x32_bf16 a[8:11], v[168:171], v[104:107], a[8:11]
v_mfma_f32_16x16x32_bf16 a[12:15], v[168:171], v[108:111], a[12:15]
v_mfma_f32_16x16x32_bf16 a[16:19], v[168:171], v[112:115], a[16:19]
v_mfma_f32_16x16x32_bf16 a[20:23], v[168:171], v[116:119], a[20:23]
v_mfma_f32_16x16x32_bf16 a[24:27], v[168:171], v[120:123], a[24:27]
v_mfma_f32_16x16x32_bf16 a[28:31], v[168:171], v[124:127], a[28:31]
v_mfma_f32_16x16x32_bf16 a[32:35], v[168:171], v[128:131], a[32:35]
v_mfma_f32_16x16x32_bf16 a[36:39], v[168:171], v[132:135], a[36:39]
v_mfma_f32_16x16x32_bf16 a[40:43], v[168:171], v[136:139], a[40:43]
v_mfma_f32_16x16x32_bf16 a[44:47], v[168:171], v[140:143], a[44:47]
v_mfma_f32_16x16x32_bf16 a[48:51], v[168:171], v[144:147], a[48:51]
v_mfma_f32_16x16x32_bf16 a[52:55], v[168:171], v[148:151], a[52:55]
v_mfma_f32_16x16x32_bf16 a[56:59], v[168:171], v[152:155], a[56:59]
v_mfma_f32_16x16x32_bf16 a[60:63], v[168:171], v[156:159], a[60:63]
s_sub_u32 s51, s51, 1
s_cmp_lg_u32 s51, 0
s_cbranch_scc1 LT_loop
s_nop 15
v_accvgpr_read_b32 v180, a0
v_accvgpr_read_b32 v181, a1
v_accvgpr_read_b32 v182, a2
v_accvgpr_read_b32 v183, a3
v_accvgpr_read_b32 v184, a4
v_accvgpr_read_b32 v185, a5
v_accvgpr_read_b32 v186, a6
v_accvgpr_read_b32 v187, a7
v_cvt_pk_bf16_f32 v32, v180, v181
v_cvt_pk_bf16_f32 v33, v182, v183
v_cvt_pk_bf16_f32 v34, v184, v185
v_cvt_pk_bf16_f32 v35, v186, v187
buffer_store_dwordx4 v[32:35], v248, s[20:23], s40 offen offset:0 sc1
v_accvgpr_read_b32 v180, a8
v_accvgpr_read_b32 v181, a9
v_accvgpr_read_b32 v182, a10
v_accvgpr_read_b32 v183, a11
v_accvgpr_read_b32 v184, a12
v_accvgpr_read_b32 v185, a13
v_accvgpr_read_b32 v186, a14
v_accvgpr_read_b32 v187, a15
v_cvt_pk_bf16_f32 v36, v180, v181
v_cvt_pk_bf16_f32 v37, v182, v183
v_cvt_pk_bf16_f32 v38, v184, v185
v_cvt_pk_bf16_f32 v39, v186, v187
buffer_store_dwordx4 v[36:39], v248, s[20:23], s40 offen offset:1024 sc1
v_accvgpr_read_b32 v180, a16
v_accvgpr_read_b32 v181, a17
v_accvgpr_read_b32 v182, a18
v_accvgpr_read_b32 v183, a19
v_accvgpr_read_b32 v184, a20
v_accvgpr_read_b32 v185, a21
v_accvgpr_read_b32 v186, a22
v_accvgpr_read_b32 v187, a23
v_cvt_pk_bf16_f32 v40, v180, v181
v_cvt_pk_bf16_f32 v41, v182, v183
v_cvt_pk_bf16_f32 v42, v184, v185
v_cvt_pk_bf16_f32 v43, v186, v187
buffer_store_dwordx4 v[40:43], v248, s[20:23], s40 offen offset:2048 sc1
v_accvgpr_read_b32 v180, a24
v_accvgpr_read_b32 v181, a25
v_accvgpr_read_b32 v182, a26
v_accvgpr_read_b32 v183, a27
v_accvgpr_read_b32 v184, a28
v_accvgpr_read_b32 v185, a29
v_accvgpr_read_b32 v186, a30
v_accvgpr_read_b32 v187, a31
v_cvt_pk_bf16_f32 v44, v180, v181
v_cvt_pk_bf16_f32 v45, v182, v183
v_cvt_pk_bf16_f32 v46, v184, v185
v_cvt_pk_bf16_f32 v47, v186, v187
buffer_store_dwordx4 v[44:47], v248, s[20:23], s40 offen offset:3072 sc1
v_accvgpr_read_b32 v180, a32
v_accvgpr_read_b32 v181, a33
v_accvgpr_read_b32 v182, a34
v_accvgpr_read_b32 v183, a35
v_accvgpr_read_b32 v184, a36
v_accvgpr_read_b32 v185, a37
v_accvgpr_read_b32 v186, a38
v_accvgpr_read_b32 v187, a39
v_cvt_pk_bf16_f32 v48, v180, v181
v_cvt_pk_bf16_f32 v49, v182, v183
v_cvt_pk_bf16_f32 v50, v184, v185
v_cvt_pk_bf16_f32 v51, v186, v187
buffer_store_dwordx4 v[48:51], v248, s[20:23], s44 offen offset:0 sc1
v_accvgpr_read_b32 v180, a40
v_accvgpr_read_b32 v181, a41
v_accvgpr_read_b32 v182, a42
v_accvgpr_read_b32 v183, a43
v_accvgpr_read_b32 v184, a44
v_accvgpr_read_b32 v185, a45
v_accvgpr_read_b32 v186, a46
v_accvgpr_read_b32 v187, a47
v_cvt_pk_bf16_f32 v52, v180, v181
v_cvt_pk_bf16_f32 v53, v182, v183
v_cvt_pk_bf16_f32 v54, v184, v185
v_cvt_pk_bf16_f32 v55, v186, v187
buffer_store_dwordx4 v[52:55], v248, s[20:23], s44 offen offset:1024 sc1
v_accvgpr_read_b32 v180, a48
v_accvgpr_read_b32 v181, a49
v_accvgpr_read_b32 v182, a50
v_accvgpr_read_b32 v183, a51
v_accvgpr_read_b32 v184, a52
v_accvgpr_read_b32 v185, a53
v_accvgpr_read_b32 v186, a54
v_accvgpr_read_b32 v187, a55
v_cvt_pk_bf16_f32 v56, v180, v181
v_cvt_pk_bf16_f32 v57, v182, v183
v_cvt_pk_bf16_f32 v58, v184, v185
v_cvt_pk_bf16_f32 v59, v186, v187
buffer_store_dwordx4 v[56:59], v248, s[20:23], s44 offen offset:2048 sc1
v_accvgpr_read_b32 v180, a56
v_accvgpr_read_b32 v181, a57
v_accvgpr_read_b32 v182, a58
v_accvgpr_read_b32 v183, a59
v_accvgpr_read_b32 v184, a60
v_accvgpr_read_b32 v185, a61
v_accvgpr_read_b32 v186, a62
v_accvgpr_read_b32 v187, a63
v_cvt_pk_bf16_f32 v60, v180, v181
v_cvt_pk_bf16_f32 v61, v182, v183
v_cvt_pk_bf16_f32 v62, v184, v185
v_cvt_pk_bf16_f32 v63, v186, v187
buffer_store_dwordx4 v[60:63], v248, s[20:23], s44 offen offset:3072 sc1
v_mov_b32 v176, v173
s_nop 1
v_permlane32_swap_b32 v173, v176
s_nop 1
v_add_f32 v173, v173, v176
v_mov_b32 v176, v173
s_nop 1
v_permlane16_swap_b32 v173, v176
s_nop 1
v_add_f32 v173, v173, v176
v_lshlrev_b32 v175, 2, v248
s_mov_b64 exec, 0xffff
s_mov_b64 exec, -1
v_bfe_u32 v175, v248, 8, 1
v_mul_u32_u24 v175, 48, v175
v_lshl_add_u32 v175, s37, 3, v175
v_and_b32 v176, 0xf0, v248
v_lshl_add_u32 v175, v176, 3, v175
s_mov_b32 exec_hi, 0
buffer_store_dwordx2 v[172:173], v175, s[24:27], s48 offen sc1
s_add_u32 s16, s4, 0x7c00000
s_addc_u32 s17, s5, 0
s_mov_b32 s18, 0x40000
s_mov_b32 s19, 0x00020000
s_add_u32 s48, s37, 1248
s_mul_i32 s48, s48, 128
s_waitcnt vmcnt(0)
v_mov_b32 v176, s98
v_mov_b32 v177, s99
s_mov_b64 exec, 1
buffer_store_dwordx2 v[176:177], off, s[16:19], s48 sc1
buffer_store_dwordx2 v[176:177], off, s[16:19], s48 offset:8 sc1
s_mov_b64 exec, -1
s_branch L2_fin
LE_start:
s_cmp_ge_u32 s37, 32
s_cbranch_scc1 L2_end
v_lshrrev_b32 v1, 6, v0
s_sub_u32 s37, s37, 30
s_lshl_b32 s35, s35, 1
v_readfirstlane_b32 s41, v1
s_add_u32 s35, s35, s37
s_mul_i32 s35, s35, 3
s_add_u32 s40, s35, s41
s_cmp_ge_u32 s41, 3
s_cbranch_scc1 L2_end
LE_common:
v_and_b32 v1, 63, v0
s_mov_b32 s42, 0
s_mov_b32 s49, 512
v_lshrrev_b32 v33, 2, v1
v_and_b32 v34, 3, v1
v_mul_u32_u24 v6, 0xa000, v33
v_lshl_add_u32 v6, v34, 4, v6
v_lshlrev_b32 v33, 2, v33
s_mul_i32 s50, s40, 655360
s_mul_i32 s48, s40, 64
s_waitcnt lgkmcnt(0)
s_add_u32 s8, s4, 0x7c2a000
s_addc_u32 s9, s5, 0
s_mov_b32 s10, 0x8000
s_mov_b32 s11, 0x00020000
v_and_b32 v200, 63, v0
v_lshlrev_b32 v200, 7, v200
s_mov_b32 s91, 8192
s_mov_b32 s90, 16384
s_mov_b32 s95, 24576
s_mov_b32 s94, 0x10000
LE_poll:
buffer_load_dwordx2 v[192:193], v200, s[8:11], 0 offen sc1
buffer_load_dwordx2 v[194:195], v200, s[8:11], s91 offen sc1
buffer_load_dwordx2 v[196:197], v200, s[8:11], s90 offen sc1
buffer_load_dwordx2 v[198:199], v200, s[8:11], s95 offen sc1
s_sub_u32 s94, s94, 1
s_waitcnt vmcnt(0)
s_cbranch_scc1 LE_poll_go
v_cmp_ne_u64 vcc, s[98:99], v[192:193]
s_nop 1
s_cbranch_vccnz LE_poll
v_cmp_ne_u64 vcc, s[98:99], v[194:195]
s_nop 1
s_cbranch_vccnz LE_poll
v_cmp_ne_u64 vcc, s[98:99], v[196:197]
s_nop 1
s_cbranch_vccnz LE_poll
v_cmp_ne_u64 vcc, s[98:99], v[198:199]
s_nop 1
s_cbranch_vccnz LE_poll
LE_poll_go:
s_cmp_lg_u32 s40, 0
s_cbranch_scc1 LE_nobump
s_mov_b32 s90, 89984
s_mov_b32 s10, 90112
v_mov_b32 v192, s98
v_mov_b32 v193, s99
s_mov_b64 exec, 1
buffer_store_dwordx2 v[192:193], off, s[8:11], s90 sc1
s_mov_b64 exec, -1
LE_nobump:
s_add_u32 s8, s4, 0x7800000
s_addc_u32 s9, s5, 0
s_mov_b32 s10, 0x1000
s_mov_b32 s11, 0x00020000
s_add_u32 s12, s4, 0x8000000
s_addc_u32 s13, s5, 0
s_mov_b32 s14, 0x2800000
s_mov_b32 s15, 0x00020000
buffer_load_dword v4, v33, s[8:11], s48 offen sc1
buffer_load_dwordx4 v[192:195], v6, s[12:15], s50 offen offset:0 sc1
buffer_load_dwordx4 v[196:199], v6, s[12:15], s50 offen offset:64 sc1
buffer_load_dwordx4 v[200:203], v6, s[12:15], s50 offen offset:128 sc1
buffer_load_dwordx4 v[204:207], v6, s[12:15], s50 offen offset:192 sc1
buffer_load_dwordx4 v[208:211], v6, s[12:15], s50 offen offset:256 sc1
buffer_load_dwordx4 v[212:215], v6, s[12:15], s50 offen offset:320 sc1
buffer_load_dwordx4 v[216:219], v6, s[12:15], s50 offen offset:384 sc1
buffer_load_dwordx4 v[220:223], v6, s[12:15], s50 offen offset:448 sc1
buffer_load_dwordx4 v[224:227], v6, s[12:15], s50 offen offset:512 sc1
buffer_load_dwordx4 v[228:231], v6, s[12:15], s50 offen offset:576 sc1
buffer_load_dwordx4 v[232:235], v6, s[12:15], s50 offen offset:640 sc1
buffer_load_dwordx4 v[236:239], v6, s[12:15], s50 offen offset:704 sc1
buffer_load_dwordx4 v[240:243], v6, s[12:15], s50 offen offset:768 sc1
buffer_load_dwordx4 v[244:247], v6, s[12:15], s50 offen offset:832 sc1
buffer_load_dwordx4 v[248:251], v6, s[12:15], s50 offen offset:896 sc1
buffer_load_dwordx4 v[252:255], v6, s[12:15], s50 offen offset:960 sc1
s_add_u32 s16, s4, 0x6800000
s_addc_u32 s17, s5, 0
s_mov_b32 s18, 0x4e2000
s_mov_b32 s19, 0x00020000
s_add_u32 s20, s4, 0x7000000
s_addc_u32 s21, s5, 0
s_mov_b32 s22, 0x4e2000
s_mov_b32 s23, 0x00020000
v_lshlrev_b32 v5, 2, v34
v_and_b32 v2, 15, v1
v_lshrrev_b32 v3, 4, v1
v_mov_b32 v16, 1
v_mov_b32 v17, 4
v_and_b32 v33, 1, v2
v_lshlrev_b32 v33, 4, v33
v_lshlrev_b32 v33, v33, v16
v_mul_u32_u24 v33, 0x3f80, v33
v_lshrrev_b32 v34, 1, v2
v_cmp_eq_u32 vcc, 0, v34
s_nop 1
v_cndmask_b32 v40, 0, v33, vcc
v_cmp_eq_u32 vcc, 1, v34
s_nop 1
v_cndmask_b32 v41, 0, v33, vcc
v_cmp_eq_u32 vcc, 2, v34
s_nop 1
v_cndmask_b32 v42, 0, v33, vcc
v_cmp_eq_u32 vcc, 3, v34
s_nop 1
v_cndmask_b32 v43, 0, v33, vcc
v_cmp_eq_u32 vcc, 4, v34
s_nop 1
v_cndmask_b32 v44, 0, v33, vcc
v_cmp_eq_u32 vcc, 5, v34
s_nop 1
v_cndmask_b32 v45, 0, v33, vcc
v_cmp_eq_u32 vcc, 6, v34
s_nop 1
v_cndmask_b32 v46, 0, v33, vcc
v_cmp_eq_u32 vcc, 7, v34
s_nop 1
v_cndmask_b32 v47, 0, v33, vcc
v_lshlrev_b32 v39, 5, v2
v_lshl_add_u32 v39, v3, 3, v39
v_lshlrev_b32 v2, 4, v2
s_mul_i32 s48, s41, 21504
s_add_u32 s48, s48, 4096
v_mov_b32 v36, s48
v_lshl_add_u32 v38, v3, 2, v36
s_lshl_b32 s36, s41, 10
v_mov_b32 v7, s36
v_lshlrev_b32 v35, 4, v1
v_add_u32 v68, s48, v35
v_add_u32 v35, s36, v35
v_lshlrev_b32 v33, 2, v1
v_mov_b32 v72, 0xffff
v_mov_b32 v73, 0xffff
v_mov_b32 v74, 0xffff
v_mov_b32 v75, 0xffff
v_cmp_gt_u32 vcc, 157, v33
v_mov_b32 v48, 0
s_nop 0
v_cndmask_b32 v18, 0, v16, vcc
v_cmp_gt_u32 vcc, 156, v33
v_mov_b32 v49, 0
s_nop 0
v_cndmask_b32 v19, 0, v16, vcc
v_cmp_gt_u32 vcc, 155, v33
v_mov_b32 v50, 0
s_nop 0
v_cndmask_b32 v20, 0, v16, vcc
v_cmp_gt_u32 vcc, 154, v33
v_mov_b32 v51, 0
s_nop 0
v_cndmask_b32 v21, 0, v16, vcc
LE_pass:
ds_write_b128 v35, v[48:51]
ds_write_b128 v68, v[72:75] offset:0
ds_write_b128 v68, v[72:75] offset:1024
ds_write_b128 v68, v[72:75] offset:2048
ds_write_b128 v68, v[72:75] offset:3072
ds_write_b128 v68, v[72:75] offset:4096
ds_write_b128 v68, v[72:75] offset:5120
ds_write_b128 v68, v[72:75] offset:6144
ds_write_b128 v68, v[72:75] offset:7168
ds_write_b128 v68, v[72:75] offset:8192
ds_write_b128 v68, v[72:75] offset:9216
ds_write_b128 v68, v[72:75] offset:10240
ds_write_b128 v68, v[72:75] offset:11264
ds_write_b128 v68, v[72:75] offset:12288
ds_write_b128 v68, v[72:75] offset:13312
ds_write_b128 v68, v[72:75] offset:14336
ds_write_b128 v68, v[72:75] offset:15360
ds_write_b128 v68, v[72:75] offset:16384
ds_write_b128 v68, v[72:75] offset:17408
ds_write_b128 v68, v[72:75] offset:18432
ds_write_b128 v68, v[72:75] offset:19456
v_lshl_add_u32 v32, v1, 2, v36
ds_write_b32 v32, v48 offset:20480
s_waitcnt vmcnt(16)
v_sub_u32 v32, v4, v5
s_waitcnt vmcnt(15)
v_cmpx_lt_i32 vcc, 0, v32
s_cbranch_execz LE_c
v_mad_u32_u16 v128, v192, 1, v7 op_sel:[1,0,0,0]
ds_add_u32 v128, v16
v_cmpx_lt_i32 vcc, 1, v32
v_mad_u32_u16 v129, v193, 1, v7 op_sel:[1,0,0,0]
ds_add_u32 v129, v16
v_cmpx_lt_i32 vcc, 2, v32
v_mad_u32_u16 v130, v194, 1, v7 op_sel:[1,0,0,0]
ds_add_u32 v130, v16
v_cmpx_lt_i32 vcc, 3, v32
v_mad_u32_u16 v131, v195, 1, v7 op_sel:[1,0,0,0]
ds_add_u32 v131, v16
s_waitcnt vmcnt(14)
v_cmpx_lt_i32 vcc, 16, v32
s_cbranch_execz LE_c
v_mad_u32_u16 v132, v196, 1, v7 op_sel:[1,0,0,0]
ds_add_u32 v132, v16
v_cmpx_lt_i32 vcc, 17, v32
v_mad_u32_u16 v133, v197, 1, v7 op_sel:[1,0,0,0]
ds_add_u32 v133, v16
v_cmpx_lt_i32 vcc, 18, v32
v_mad_u32_u16 v134, v198, 1, v7 op_sel:[1,0,0,0]
ds_add_u32 v134, v16
v_cmpx_lt_i32 vcc, 19, v32
v_mad_u32_u16 v135, v199, 1, v7 op_sel:[1,0,0,0]
ds_add_u32 v135, v16
s_waitcnt vmcnt(13)
v_cmpx_lt_i32 vcc, 32, v32
s_cbranch_execz LE_c
v_mad_u32_u16 v136, v200, 1, v7 op_sel:[1,0,0,0]
ds_add_u32 v136, v16
v_cmpx_lt_i32 vcc, 33, v32
v_mad_u32_u16 v137, v201, 1, v7 op_sel:[1,0,0,0]
ds_add_u32 v137, v16
v_cmpx_lt_i32 vcc, 34, v32
v_mad_u32_u16 v138, v202, 1, v7 op_sel:[1,0,0,0]
ds_add_u32 v138, v16
v_cmpx_lt_i32 vcc, 35, v32
v_mad_u32_u16 v139, v203, 1, v7 op_sel:[1,0,0,0]
ds_add_u32 v139, v16
s_waitcnt vmcnt(12)
v_cmpx_lt_i32 vcc, 48, v32
s_cbranch_execz LE_c
v_mad_u32_u16 v140, v204, 1, v7 op_sel:[1,0,0,0]
ds_add_u32 v140, v16
v_cmpx_lt_i32 vcc, 49, v32
v_mad_u32_u16 v141, v205, 1, v7 op_sel:[1,0,0,0]
ds_add_u32 v141, v16
v_cmpx_lt_i32 vcc, 50, v32
v_mad_u32_u16 v142, v206, 1, v7 op_sel:[1,0,0,0]
ds_add_u32 v142, v16
v_cmpx_lt_i32 vcc, 51, v32
v_mad_u32_u16 v143, v207, 1, v7 op_sel:[1,0,0,0]
ds_add_u32 v143, v16
s_waitcnt vmcnt(11)
v_cmpx_lt_i32 vcc, 64, v32
s_cbranch_execz LE_c
v_mad_u32_u16 v144, v208, 1, v7 op_sel:[1,0,0,0]
ds_add_u32 v144, v16
v_cmpx_lt_i32 vcc, 65, v32
v_mad_u32_u16 v145, v209, 1, v7 op_sel:[1,0,0,0]
ds_add_u32 v145, v16
v_cmpx_lt_i32 vcc, 66, v32
v_mad_u32_u16 v146, v210, 1, v7 op_sel:[1,0,0,0]
ds_add_u32 v146, v16
v_cmpx_lt_i32 vcc, 67, v32
v_mad_u32_u16 v147, v211, 1, v7 op_sel:[1,0,0,0]
ds_add_u32 v147, v16
s_waitcnt vmcnt(10)
v_cmpx_lt_i32 vcc, 80, v32
s_cbranch_execz LE_c
v_mad_u32_u16 v148, v212, 1, v7 op_sel:[1,0,0,0]
ds_add_u32 v148, v16
v_cmpx_lt_i32 vcc, 81, v32
v_mad_u32_u16 v149, v213, 1, v7 op_sel:[1,0,0,0]
ds_add_u32 v149, v16
v_cmpx_lt_i32 vcc, 82, v32
v_mad_u32_u16 v150, v214, 1, v7 op_sel:[1,0,0,0]
ds_add_u32 v150, v16
v_cmpx_lt_i32 vcc, 83, v32
v_mad_u32_u16 v151, v215, 1, v7 op_sel:[1,0,0,0]
ds_add_u32 v151, v16
s_waitcnt vmcnt(9)
v_cmpx_lt_i32 vcc, 96, v32
s_cbranch_execz LE_c
v_mad_u32_u16 v152, v216, 1, v7 op_sel:[1,0,0,0]
ds_add_u32 v152, v16
v_cmpx_lt_i32 vcc, 97, v32
v_mad_u32_u16 v153, v217, 1, v7 op_sel:[1,0,0,0]
ds_add_u32 v153, v16
v_cmpx_lt_i32 vcc, 98, v32
v_mad_u32_u16 v154, v218, 1, v7 op_sel:[1,0,0,0]
ds_add_u32 v154, v16
v_cmpx_lt_i32 vcc, 99, v32
v_mad_u32_u16 v155, v219, 1, v7 op_sel:[1,0,0,0]
ds_add_u32 v155, v16
s_waitcnt vmcnt(8)
v_cmpx_lt_i32 vcc, 112, v32
s_cbranch_execz LE_c
v_mad_u32_u16 v156, v220, 1, v7 op_sel:[1,0,0,0]
ds_add_u32 v156, v16
v_cmpx_lt_i32 vcc, 113, v32
v_mad_u32_u16 v157, v221, 1, v7 op_sel:[1,0,0,0]
ds_add_u32 v157, v16
v_cmpx_lt_i32 vcc, 114, v32
v_mad_u32_u16 v158, v222, 1, v7 op_sel:[1,0,0,0]
ds_add_u32 v158, v16
v_cmpx_lt_i32 vcc, 115, v32
v_mad_u32_u16 v159, v223, 1, v7 op_sel:[1,0,0,0]
ds_add_u32 v159, v16
s_waitcnt vmcnt(7)
v_cmpx_lt_i32 vcc, 128, v32
s_cbranch_execz LE_c
v_mad_u32_u16 v160, v224, 1, v7 op_sel:[1,0,0,0]
ds_add_u32 v160, v16
v_cmpx_lt_i32 vcc, 129, v32
v_mad_u32_u16 v161, v225, 1, v7 op_sel:[1,0,0,0]
ds_add_u32 v161, v16
v_cmpx_lt_i32 vcc, 130, v32
v_mad_u32_u16 v162, v226, 1, v7 op_sel:[1,0,0,0]
ds_add_u32 v162, v16
v_cmpx_lt_i32 vcc, 131, v32
v_mad_u32_u16 v163, v227, 1, v7 op_sel:[1,0,0,0]
ds_add_u32 v163, v16
s_waitcnt vmcnt(6)
v_cmpx_lt_i32 vcc, 144, v32
s_cbranch_execz LE_c
v_mad_u32_u16 v164, v228, 1, v7 op_sel:[1,0,0,0]
ds_add_u32 v164, v16
v_cmpx_lt_i32 vcc, 145, v32
v_mad_u32_u16 v165, v229, 1, v7 op_sel:[1,0,0,0]
ds_add_u32 v165, v16
v_cmpx_lt_i32 vcc, 146, v32
v_mad_u32_u16 v166, v230, 1, v7 op_sel:[1,0,0,0]
ds_add_u32 v166, v16
v_cmpx_lt_i32 vcc, 147, v32
v_mad_u32_u16 v167, v231, 1, v7 op_sel:[1,0,0,0]
ds_add_u32 v167, v16
s_waitcnt vmcnt(5)
v_cmpx_lt_i32 vcc, 160, v32
s_cbranch_execz LE_c
v_mad_u32_u16 v168, v232, 1, v7 op_sel:[1,0,0,0]
ds_add_u32 v168, v16
v_cmpx_lt_i32 vcc, 161, v32
v_mad_u32_u16 v169, v233, 1, v7 op_sel:[1,0,0,0]
ds_add_u32 v169, v16
v_cmpx_lt_i32 vcc, 162, v32
v_mad_u32_u16 v170, v234, 1, v7 op_sel:[1,0,0,0]
ds_add_u32 v170, v16
v_cmpx_lt_i32 vcc, 163, v32
v_mad_u32_u16 v171, v235, 1, v7 op_sel:[1,0,0,0]
ds_add_u32 v171, v16
s_waitcnt vmcnt(4)
v_cmpx_lt_i32 vcc, 176, v32
s_cbranch_execz LE_c
v_mad_u32_u16 v172, v236, 1, v7 op_sel:[1,0,0,0]
ds_add_u32 v172, v16
v_cmpx_lt_i32 vcc, 177, v32
v_mad_u32_u16 v173, v237, 1, v7 op_sel:[1,0,0,0]
ds_add_u32 v173, v16
v_cmpx_lt_i32 vcc, 178, v32
v_mad_u32_u16 v174, v238, 1, v7 op_sel:[1,0,0,0]
ds_add_u32 v174, v16
v_cmpx_lt_i32 vcc, 179, v32
v_mad_u32_u16 v175, v239, 1, v7 op_sel:[1,0,0,0]
ds_add_u32 v175, v16
s_waitcnt vmcnt(3)
v_cmpx_lt_i32 vcc, 192, v32
s_cbranch_execz LE_c
v_mad_u32_u16 v176, v240, 1, v7 op_sel:[1,0,0,0]
ds_add_u32 v176, v16
v_cmpx_lt_i32 vcc, 193, v32
v_mad_u32_u16 v177, v241, 1, v7 op_sel:[1,0,0,0]
ds_add_u32 v177, v16
v_cmpx_lt_i32 vcc, 194, v32
v_mad_u32_u16 v178, v242, 1, v7 op_sel:[1,0,0,0]
ds_add_u32 v178, v16
v_cmpx_lt_i32 vcc, 195, v32
v_mad_u32_u16 v179, v243, 1, v7 op_sel:[1,0,0,0]
ds_add_u32 v179, v16
s_waitcnt vmcnt(2)
v_cmpx_lt_i32 vcc, 208, v32
s_cbranch_execz LE_c
v_mad_u32_u16 v180, v244, 1, v7 op_sel:[1,0,0,0]
ds_add_u32 v180, v16
v_cmpx_lt_i32 vcc, 209, v32
v_mad_u32_u16 v181, v245, 1, v7 op_sel:[1,0,0,0]
ds_add_u32 v181, v16
v_cmpx_lt_i32 vcc, 210, v32
v_mad_u32_u16 v182, v246, 1, v7 op_sel:[1,0,0,0]
ds_add_u32 v182, v16
v_cmpx_lt_i32 vcc, 211, v32
v_mad_u32_u16 v183, v247, 1, v7 op_sel:[1,0,0,0]
ds_add_u32 v183, v16
s_waitcnt vmcnt(1)
v_cmpx_lt_i32 vcc, 224, v32
s_cbranch_execz LE_c
v_mad_u32_u16 v184, v248, 1, v7 op_sel:[1,0,0,0]
ds_add_u32 v184, v16
v_cmpx_lt_i32 vcc, 225, v32
v_mad_u32_u16 v185, v249, 1, v7 op_sel:[1,0,0,0]
ds_add_u32 v185, v16
v_cmpx_lt_i32 vcc, 226, v32
v_mad_u32_u16 v186, v250, 1, v7 op_sel:[1,0,0,0]
ds_add_u32 v186, v16
v_cmpx_lt_i32 vcc, 227, v32
v_mad_u32_u16 v187, v251, 1, v7 op_sel:[1,0,0,0]
ds_add_u32 v187, v16
s_waitcnt vmcnt(0)
v_cmpx_lt_i32 vcc, 240, v32
s_cbranch_execz LE_c
v_mad_u32_u16 v188, v252, 1, v7 op_sel:[1,0,0,0]
ds_add_u32 v188, v16
v_cmpx_lt_i32 vcc, 241, v32
v_mad_u32_u16 v189, v253, 1, v7 op_sel:[1,0,0,0]
ds_add_u32 v189, v16
v_cmpx_lt_i32 vcc, 242, v32
v_mad_u32_u16 v190, v254, 1, v7 op_sel:[1,0,0,0]
ds_add_u32 v190, v16
v_cmpx_lt_i32 vcc, 243, v32
v_mad_u32_u16 v191, v255, 1, v7 op_sel:[1,0,0,0]
ds_add_u32 v191, v16
LE_c:
s_mov_b64 exec, -1
ds_read_b128 v[24:27], v35
s_waitcnt lgkmcnt(0)
v_add_u32 v24, 3, v24
v_lshrrev_b32 v24, 2, v24
v_max_u32 v24, v24, v18
v_add_u32 v25, 3, v25
v_lshrrev_b32 v25, 2, v25
v_max_u32 v25, v25, v19
v_add_u32 v26, 3, v26
v_lshrrev_b32 v26, 2, v26
v_max_u32 v26, v26, v20
v_add_u32 v27, 3, v27
v_lshrrev_b32 v27, 2, v27
v_max_u32 v27, v27, v21
v_add_u32 v33, v24, v25
v_add3_u32 v33, v33, v26, v27
v_mov_b32 v64, v33
s_nop 1
v_add_u32_dpp v64, v64, v64 row_shr:1 row_mask:0xf bank_mask:0xf
s_nop 1
v_add_u32_dpp v64, v64, v64 row_shr:2 row_mask:0xf bank_mask:0xf
s_nop 1
v_add_u32_dpp v64, v64, v64 row_shr:4 row_mask:0xf bank_mask:0xf
s_nop 1
v_add_u32_dpp v64, v64, v64 row_shr:8 row_mask:0xf bank_mask:0xf
s_nop 1
v_add_u32_dpp v64, v64, v64 row_bcast:15 row_mask:0xa bank_mask:0xf
s_nop 1
v_add_u32_dpp v64, v64, v64 row_bcast:31 row_mask:0xc bank_mask:0xf
s_nop 1
v_readlane_b32 s44, v64, 63
v_sub_u32 v28, v64, v33
v_add_u32 v29, v28, v24
v_add_u32 v30, v29, v25
v_add_u32 v31, v30, v26
v_add3_u32 v33, v28, v24, -1
v_lshlrev_b32 v34, v33, v18
v_lshrrev_b32 v33, 5, v33
v_lshl_add_u32 v33, v33, 2, v36
ds_or_b32 v33, v34 offset:20480
v_lshl_add_u32 v28, v28, 4, v36
v_add3_u32 v33, v29, v25, -1
v_lshlrev_b32 v34, v33, v19
v_lshrrev_b32 v33, 5, v33
v_lshl_add_u32 v33, v33, 2, v36
ds_or_b32 v33, v34 offset:20480
v_lshl_add_u32 v29, v29, 4, v36
v_add3_u32 v33, v30, v26, -1
v_lshlrev_b32 v34, v33, v20
v_lshrrev_b32 v33, 5, v33
v_lshl_add_u32 v33, v33, 2, v36
ds_or_b32 v33, v34 offset:20480
v_lshl_add_u32 v30, v30, 4, v36
v_add3_u32 v33, v31, v27, -1
v_lshlrev_b32 v34, v33, v21
v_lshrrev_b32 v33, 5, v33
v_lshl_add_u32 v33, v33, 2, v36
ds_or_b32 v33, v34 offset:20480
v_lshl_add_u32 v31, v31, 4, v36
ds_write_b128 v35, v[28:31]
s_add_u32 s44, s44, 31
s_lshr_b32 s44, s44, 5
v_cmpx_lt_i32 vcc, 0, v32
s_cbranch_execz LE_p
ds_add_rtn_u32 v128, v128, v17
v_cmpx_lt_i32 vcc, 1, v32
ds_add_rtn_u32 v129, v129, v17
v_cmpx_lt_i32 vcc, 2, v32
ds_add_rtn_u32 v130, v130, v17
v_cmpx_lt_i32 vcc, 3, v32
ds_add_rtn_u32 v131, v131, v17
v_cmpx_lt_i32 vcc, 16, v32
s_cbranch_execz LE_p
ds_add_rtn_u32 v132, v132, v17
v_cmpx_lt_i32 vcc, 17, v32
ds_add_rtn_u32 v133, v133, v17
v_cmpx_lt_i32 vcc, 18, v32
ds_add_rtn_u32 v134, v134, v17
v_cmpx_lt_i32 vcc, 19, v32
ds_add_rtn_u32 v135, v135, v17
v_cmpx_lt_i32 vcc, 32, v32
s_cbranch_execz LE_p
ds_add_rtn_u32 v136, v136, v17
v_cmpx_lt_i32 vcc, 33, v32
ds_add_rtn_u32 v137, v137, v17
v_cmpx_lt_i32 vcc, 34, v32
ds_add_rtn_u32 v138, v138, v17
v_cmpx_lt_i32 vcc, 35, v32
ds_add_rtn_u32 v139, v139, v17
v_cmpx_lt_i32 vcc, 48, v32
s_cbranch_execz LE_p
ds_add_rtn_u32 v140, v140, v17
v_cmpx_lt_i32 vcc, 49, v32
ds_add_rtn_u32 v141, v141, v17
v_cmpx_lt_i32 vcc, 50, v32
ds_add_rtn_u32 v142, v142, v17
v_cmpx_lt_i32 vcc, 51, v32
ds_add_rtn_u32 v143, v143, v17
v_cmpx_lt_i32 vcc, 64, v32
s_cbranch_execz LE_p
ds_add_rtn_u32 v144, v144, v17
v_cmpx_lt_i32 vcc, 65, v32
ds_add_rtn_u32 v145, v145, v17
v_cmpx_lt_i32 vcc, 66, v32
ds_add_rtn_u32 v146, v146, v17
v_cmpx_lt_i32 vcc, 67, v32
ds_add_rtn_u32 v147, v147, v17
v_cmpx_lt_i32 vcc, 80, v32
s_cbranch_execz LE_p
ds_add_rtn_u32 v148, v148, v17
v_cmpx_lt_i32 vcc, 81, v32
ds_add_rtn_u32 v149, v149, v17
v_cmpx_lt_i32 vcc, 82, v32
ds_add_rtn_u32 v150, v150, v17
v_cmpx_lt_i32 vcc, 83, v32
ds_add_rtn_u32 v151, v151, v17
v_cmpx_lt_i32 vcc, 96, v32
s_cbranch_execz LE_p
ds_add_rtn_u32 v152, v152, v17
v_cmpx_lt_i32 vcc, 97, v32
ds_add_rtn_u32 v153, v153, v17
v_cmpx_lt_i32 vcc, 98, v32
ds_add_rtn_u32 v154, v154, v17
v_cmpx_lt_i32 vcc, 99, v32
ds_add_rtn_u32 v155, v155, v17
v_cmpx_lt_i32 vcc, 112, v32
s_cbranch_execz LE_p
ds_add_rtn_u32 v156, v156, v17
v_cmpx_lt_i32 vcc, 113, v32
ds_add_rtn_u32 v157, v157, v17
v_cmpx_lt_i32 vcc, 114, v32
ds_add_rtn_u32 v158, v158, v17
v_cmpx_lt_i32 vcc, 115, v32
ds_add_rtn_u32 v159, v159, v17
v_cmpx_lt_i32 vcc, 128, v32
s_cbranch_execz LE_p
ds_add_rtn_u32 v160, v160, v17
v_cmpx_lt_i32 vcc, 129, v32
ds_add_rtn_u32 v161, v161, v17
v_cmpx_lt_i32 vcc, 130, v32
ds_add_rtn_u32 v162, v162, v17
v_cmpx_lt_i32 vcc, 131, v32
ds_add_rtn_u32 v163, v163, v17
v_cmpx_lt_i32 vcc, 144, v32
s_cbranch_execz LE_p
ds_add_rtn_u32 v164, v164, v17
v_cmpx_lt_i32 vcc, 145, v32
ds_add_rtn_u32 v165, v165, v17
v_cmpx_lt_i32 vcc, 146, v32
ds_add_rtn_u32 v166, v166, v17
v_cmpx_lt_i32 vcc, 147, v32
ds_add_rtn_u32 v167, v167, v17
v_cmpx_lt_i32 vcc, 160, v32
s_cbranch_execz LE_p
ds_add_rtn_u32 v168, v168, v17
v_cmpx_lt_i32 vcc, 161, v32
ds_add_rtn_u32 v169, v169, v17
v_cmpx_lt_i32 vcc, 162, v32
ds_add_rtn_u32 v170, v170, v17
v_cmpx_lt_i32 vcc, 163, v32
ds_add_rtn_u32 v171, v171, v17
v_cmpx_lt_i32 vcc, 176, v32
s_cbranch_execz LE_p
ds_add_rtn_u32 v172, v172, v17
v_cmpx_lt_i32 vcc, 177, v32
ds_add_rtn_u32 v173, v173, v17
v_cmpx_lt_i32 vcc, 178, v32
ds_add_rtn_u32 v174, v174, v17
v_cmpx_lt_i32 vcc, 179, v32
ds_add_rtn_u32 v175, v175, v17
v_cmpx_lt_i32 vcc, 192, v32
s_cbranch_execz LE_p
ds_add_rtn_u32 v176, v176, v17
v_cmpx_lt_i32 vcc, 193, v32
ds_add_rtn_u32 v177, v177, v17
v_cmpx_lt_i32 vcc, 194, v32
ds_add_rtn_u32 v178, v178, v17
v_cmpx_lt_i32 vcc, 195, v32
ds_add_rtn_u32 v179, v179, v17
v_cmpx_lt_i32 vcc, 208, v32
s_cbranch_execz LE_p
ds_add_rtn_u32 v180, v180, v17
v_cmpx_lt_i32 vcc, 209, v32
ds_add_rtn_u32 v181, v181, v17
v_cmpx_lt_i32 vcc, 210, v32
ds_add_rtn_u32 v182, v182, v17
v_cmpx_lt_i32 vcc, 211, v32
ds_add_rtn_u32 v183, v183, v17
v_cmpx_lt_i32 vcc, 224, v32
s_cbranch_execz LE_p
ds_add_rtn_u32 v184, v184, v17
v_cmpx_lt_i32 vcc, 225, v32
ds_add_rtn_u32 v185, v185, v17
v_cmpx_lt_i32 vcc, 226, v32
ds_add_rtn_u32 v186, v186, v17
v_cmpx_lt_i32 vcc, 227, v32
ds_add_rtn_u32 v187, v187, v17
v_cmpx_lt_i32 vcc, 240, v32
s_cbranch_execz LE_p
ds_add_rtn_u32 v188, v188, v17
v_cmpx_lt_i32 vcc, 241, v32
ds_add_rtn_u32 v189, v189, v17
v_cmpx_lt_i32 vcc, 242, v32
ds_add_rtn_u32 v190, v190, v17
v_cmpx_lt_i32 vcc, 243, v32
ds_add_rtn_u32 v191, v191, v17
LE_p:
s_mov_b64 exec, -1
v_lshl_add_u32 v33, v1, 2, v36
ds_read_b32 v37, v33 offset:20480
s_waitcnt lgkmcnt(0)
v_cmpx_lt_i32 vcc, 0, v32
s_cbranch_execz LE_w
ds_write_b32 v128, v192
v_cmpx_lt_i32 vcc, 1, v32
ds_write_b32 v129, v193
v_cmpx_lt_i32 vcc, 2, v32
ds_write_b32 v130, v194
v_cmpx_lt_i32 vcc, 3, v32
ds_write_b32 v131, v195
v_cmpx_lt_i32 vcc, 16, v32
s_cbranch_execz LE_w
ds_write_b32 v132, v196
v_cmpx_lt_i32 vcc, 17, v32
ds_write_b32 v133, v197
v_cmpx_lt_i32 vcc, 18, v32
ds_write_b32 v134, v198
v_cmpx_lt_i32 vcc, 19, v32
ds_write_b32 v135, v199
v_cmpx_lt_i32 vcc, 32, v32
s_cbranch_execz LE_w
ds_write_b32 v136, v200
v_cmpx_lt_i32 vcc, 33, v32
ds_write_b32 v137, v201
v_cmpx_lt_i32 vcc, 34, v32
ds_write_b32 v138, v202
v_cmpx_lt_i32 vcc, 35, v32
ds_write_b32 v139, v203
v_cmpx_lt_i32 vcc, 48, v32
s_cbranch_execz LE_w
ds_write_b32 v140, v204
v_cmpx_lt_i32 vcc, 49, v32
ds_write_b32 v141, v205
v_cmpx_lt_i32 vcc, 50, v32
ds_write_b32 v142, v206
v_cmpx_lt_i32 vcc, 51, v32
ds_write_b32 v143, v207
v_cmpx_lt_i32 vcc, 64, v32
s_cbranch_execz LE_w
ds_write_b32 v144, v208
v_cmpx_lt_i32 vcc, 65, v32
ds_write_b32 v145, v209
v_cmpx_lt_i32 vcc, 66, v32
ds_write_b32 v146, v210
v_cmpx_lt_i32 vcc, 67, v32
ds_write_b32 v147, v211
v_cmpx_lt_i32 vcc, 80, v32
s_cbranch_execz LE_w
ds_write_b32 v148, v212
v_cmpx_lt_i32 vcc, 81, v32
ds_write_b32 v149, v213
v_cmpx_lt_i32 vcc, 82, v32
ds_write_b32 v150, v214
v_cmpx_lt_i32 vcc, 83, v32
ds_write_b32 v151, v215
v_cmpx_lt_i32 vcc, 96, v32
s_cbranch_execz LE_w
ds_write_b32 v152, v216
v_cmpx_lt_i32 vcc, 97, v32
ds_write_b32 v153, v217
v_cmpx_lt_i32 vcc, 98, v32
ds_write_b32 v154, v218
v_cmpx_lt_i32 vcc, 99, v32
ds_write_b32 v155, v219
v_cmpx_lt_i32 vcc, 112, v32
s_cbranch_execz LE_w
ds_write_b32 v156, v220
v_cmpx_lt_i32 vcc, 113, v32
ds_write_b32 v157, v221
v_cmpx_lt_i32 vcc, 114, v32
ds_write_b32 v158, v222
v_cmpx_lt_i32 vcc, 115, v32
ds_write_b32 v159, v223
v_cmpx_lt_i32 vcc, 128, v32
s_cbranch_execz LE_w
ds_write_b32 v160, v224
v_cmpx_lt_i32 vcc, 129, v32
ds_write_b32 v161, v225
v_cmpx_lt_i32 vcc, 130, v32
ds_write_b32 v162, v226
v_cmpx_lt_i32 vcc, 131, v32
ds_write_b32 v163, v227
v_cmpx_lt_i32 vcc, 144, v32
s_cbranch_execz LE_w
ds_write_b32 v164, v228
v_cmpx_lt_i32 vcc, 145, v32
ds_write_b32 v165, v229
v_cmpx_lt_i32 vcc, 146, v32
ds_write_b32 v166, v230
v_cmpx_lt_i32 vcc, 147, v32
ds_write_b32 v167, v231
v_cmpx_lt_i32 vcc, 160, v32
s_cbranch_execz LE_w
ds_write_b32 v168, v232
v_cmpx_lt_i32 vcc, 161, v32
ds_write_b32 v169, v233
v_cmpx_lt_i32 vcc, 162, v32
ds_write_b32 v170, v234
v_cmpx_lt_i32 vcc, 163, v32
ds_write_b32 v171, v235
v_cmpx_lt_i32 vcc, 176, v32
s_cbranch_execz LE_w
ds_write_b32 v172, v236
v_cmpx_lt_i32 vcc, 177, v32
ds_write_b32 v173, v237
v_cmpx_lt_i32 vcc, 178, v32
ds_write_b32 v174, v238
v_cmpx_lt_i32 vcc, 179, v32
ds_write_b32 v175, v239
v_cmpx_lt_i32 vcc, 192, v32
s_cbranch_execz LE_w
ds_write_b32 v176, v240
v_cmpx_lt_i32 vcc, 193, v32
ds_write_b32 v177, v241
v_cmpx_lt_i32 vcc, 194, v32
ds_write_b32 v178, v242
v_cmpx_lt_i32 vcc, 195, v32
ds_write_b32 v179, v243
v_cmpx_lt_i32 vcc, 208, v32
s_cbranch_execz LE_w
ds_write_b32 v180, v244
v_cmpx_lt_i32 vcc, 209, v32
ds_write_b32 v181, v245
v_cmpx_lt_i32 vcc, 210, v32
ds_write_b32 v182, v246
v_cmpx_lt_i32 vcc, 211, v32
ds_write_b32 v183, v247
v_cmpx_lt_i32 vcc, 224, v32
s_cbranch_execz LE_w
ds_write_b32 v184, v248
v_cmpx_lt_i32 vcc, 225, v32
ds_write_b32 v185, v249
v_cmpx_lt_i32 vcc, 226, v32
ds_write_b32 v186, v250
v_cmpx_lt_i32 vcc, 227, v32
ds_write_b32 v187, v251
v_cmpx_lt_i32 vcc, 240, v32
s_cbranch_execz LE_w
ds_write_b32 v188, v252
v_cmpx_lt_i32 vcc, 241, v32
ds_write_b32 v189, v253
v_cmpx_lt_i32 vcc, 242, v32
ds_write_b32 v190, v254
v_cmpx_lt_i32 vcc, 243, v32
ds_write_b32 v191, v255
LE_w:
s_mov_b64 exec, -1
v_mov_b32 v34, v38
ds_read2_b32 v[52:53], v34 offset0:0 offset1:4
ds_read2_b32 v[54:55], v34 offset0:8 offset1:12
s_waitcnt lgkmcnt(0)
ds_read2_b32 v[56:57], v34 offset0:16 offset1:20
ds_read2_b32 v[58:59], v34 offset0:24 offset1:28
v_mad_u32_u16 v60, v52, s49, v2
v_mad_u32_u16 v61, v53, s49, v2
v_mad_u32_u16 v62, v54, s49, v2
v_mad_u32_u16 v63, v55, s49, v2
buffer_load_dwordx4 a[0:3], v60, s[16:19], 0 offen sc1
buffer_load_dwordx4 a[4:7], v60, s[16:19], 0 offen offset:256 sc1
buffer_load_dwordx4 a[8:11], v61, s[16:19], 0 offen sc1
buffer_load_dwordx4 a[12:15], v61, s[16:19], 0 offen offset:256 sc1
buffer_load_dwordx4 a[16:19], v62, s[16:19], 0 offen sc1
buffer_load_dwordx4 a[20:23], v62, s[16:19], 0 offen offset:256 sc1
buffer_load_dwordx4 a[24:27], v63, s[16:19], 0 offen sc1
buffer_load_dwordx4 a[28:31], v63, s[16:19], 0 offen offset:256 sc1
s_waitcnt lgkmcnt(0)
ds_read2_b32 v[52:53], v34 offset0:32 offset1:36
ds_read2_b32 v[54:55], v34 offset0:40 offset1:44
v_mad_u32_u16 v60, v56, s49, v2
v_mad_u32_u16 v61, v57, s49, v2
v_mad_u32_u16 v62, v58, s49, v2
v_mad_u32_u16 v63, v59, s49, v2
buffer_load_dwordx4 a[32:35], v60, s[16:19], 0 offen sc1
buffer_load_dwordx4 a[36:39], v60, s[16:19], 0 offen offset:256 sc1
buffer_load_dwordx4 a[40:43], v61, s[16:19], 0 offen sc1
buffer_load_dwordx4 a[44:47], v61, s[16:19], 0 offen offset:256 sc1
buffer_load_dwordx4 a[48:51], v62, s[16:19], 0 offen sc1
buffer_load_dwordx4 a[52:55], v62, s[16:19], 0 offen offset:256 sc1
buffer_load_dwordx4 a[56:59], v63, s[16:19], 0 offen sc1
buffer_load_dwordx4 a[60:63], v63, s[16:19], 0 offen offset:256 sc1
s_waitcnt lgkmcnt(0)
ds_read2_b32 v[56:57], v34 offset0:48 offset1:52
ds_read2_b32 v[58:59], v34 offset0:56 offset1:60
v_mad_u32_u16 v60, v52, s49, v2
v_mad_u32_u16 v61, v53, s49, v2
v_mad_u32_u16 v62, v54, s49, v2
v_mad_u32_u16 v63, v55, s49, v2
buffer_load_dwordx4 a[64:67], v60, s[16:19], 0 offen sc1
buffer_load_dwordx4 a[68:71], v60, s[16:19], 0 offen offset:256 sc1
buffer_load_dwordx4 a[72:75], v61, s[16:19], 0 offen sc1
buffer_load_dwordx4 a[76:79], v61, s[16:19], 0 offen offset:256 sc1
buffer_load_dwordx4 a[80:83], v62, s[16:19], 0 offen sc1
buffer_load_dwordx4 a[84:87], v62, s[16:19], 0 offen offset:256 sc1
buffer_load_dwordx4 a[88:91], v63, s[16:19], 0 offen sc1
buffer_load_dwordx4 a[92:95], v63, s[16:19], 0 offen offset:256 sc1
s_waitcnt lgkmcnt(0)
ds_read2_b32 v[52:53], v34 offset0:64 offset1:68
ds_read2_b32 v[54:55], v34 offset0:72 offset1:76
v_mad_u32_u16 v60, v56, s49, v2
v_mad_u32_u16 v61, v57, s49, v2
v_mad_u32_u16 v62, v58, s49, v2
v_mad_u32_u16 v63, v59, s49, v2
buffer_load_dwordx4 a[96:99], v60, s[16:19], 0 offen sc1
buffer_load_dwordx4 a[100:103], v60, s[16:19], 0 offen offset:256 sc1
buffer_load_dwordx4 a[104:107], v61, s[16:19], 0 offen sc1
buffer_load_dwordx4 a[108:111], v61, s[16:19], 0 offen offset:256 sc1
buffer_load_dwordx4 a[112:115], v62, s[16:19], 0 offen sc1
buffer_load_dwordx4 a[116:119], v62, s[16:19], 0 offen offset:256 sc1
buffer_load_dwordx4 a[120:123], v63, s[16:19], 0 offen sc1
buffer_load_dwordx4 a[124:127], v63, s[16:19], 0 offen offset:256 sc1
s_waitcnt lgkmcnt(0)
ds_read2_b32 v[56:57], v34 offset0:80 offset1:84
ds_read2_b32 v[58:59], v34 offset0:88 offset1:92
v_mad_u32_u16 v60, v52, s49, v2
v_mad_u32_u16 v61, v53, s49, v2
v_mad_u32_u16 v62, v54, s49, v2
v_mad_u32_u16 v63, v55, s49, v2
buffer_load_dwordx4 a[128:131], v60, s[16:19], 0 offen sc1
buffer_load_dwordx4 a[132:135], v60, s[16:19], 0 offen offset:256 sc1
buffer_load_dwordx4 a[136:139], v61, s[16:19], 0 offen sc1
buffer_load_dwordx4 a[140:143], v61, s[16:19], 0 offen offset:256 sc1
buffer_load_dwordx4 a[144:147], v62, s[16:19], 0 offen sc1
buffer_load_dwordx4 a[148:151], v62, s[16:19], 0 offen offset:256 sc1
buffer_load_dwordx4 a[152:155], v63, s[16:19], 0 offen sc1
buffer_load_dwordx4 a[156:159], v63, s[16:19], 0 offen offset:256 sc1
s_waitcnt lgkmcnt(0)
ds_read2_b32 v[52:53], v34 offset0:96 offset1:100
ds_read2_b32 v[54:55], v34 offset0:104 offset1:108
v_mad_u32_u16 v60, v56, s49, v2
v_mad_u32_u16 v61, v57, s49, v2
v_mad_u32_u16 v62, v58, s49, v2
v_mad_u32_u16 v63, v59, s49, v2
buffer_load_dwordx4 a[160:163], v60, s[16:19], 0 offen sc1
buffer_load_dwordx4 a[164:167], v60, s[16:19], 0 offen offset:256 sc1
buffer_load_dwordx4 a[168:171], v61, s[16:19], 0 offen sc1
buffer_load_dwordx4 a[172:175], v61, s[16:19], 0 offen offset:256 sc1
buffer_load_dwordx4 a[176:179], v62, s[16:19], 0 offen sc1
buffer_load_dwordx4 a[180:183], v62, s[16:19], 0 offen offset:256 sc1
buffer_load_dwordx4 a[184:187], v63, s[16:19], 0 offen sc1
buffer_load_dwordx4 a[188:191], v63, s[16:19], 0 offen offset:256 sc1
s_waitcnt lgkmcnt(0)
ds_read2_b32 v[56:57], v34 offset0:112 offset1:116
ds_read2_b32 v[58:59], v34 offset0:120 offset1:124
v_mad_u32_u16 v60, v52, s49, v2
v_mad_u32_u16 v61, v53, s49, v2
v_mad_u32_u16 v62, v54, s49, v2
v_mad_u32_u16 v63, v55, s49, v2
buffer_load_dwordx4 a[192:195], v60, s[16:19], 0 offen sc1
buffer_load_dwordx4 a[196:199], v60, s[16:19], 0 offen offset:256 sc1
buffer_load_dwordx4 a[200:203], v61, s[16:19], 0 offen sc1
buffer_load_dwordx4 a[204:207], v61, s[16:19], 0 offen offset:256 sc1
buffer_load_dwordx4 a[208:211], v62, s[16:19], 0 offen sc1
buffer_load_dwordx4 a[212:215], v62, s[16:19], 0 offen offset:256 sc1
buffer_load_dwordx4 a[216:219], v63, s[16:19], 0 offen sc1
buffer_load_dwordx4 a[220:223], v63, s[16:19], 0 offen offset:256 sc1
s_waitcnt lgkmcnt(0)
ds_read2_b32 v[52:53], v34 offset0:128 offset1:132
ds_read2_b32 v[54:55], v34 offset0:136 offset1:140
v_mad_u32_u16 v60, v56, s49, v2
v_mad_u32_u16 v61, v57, s49, v2
v_mad_u32_u16 v62, v58, s49, v2
v_mad_u32_u16 v63, v59, s49, v2
buffer_load_dwordx4 a[224:227], v60, s[16:19], 0 offen sc1
buffer_load_dwordx4 a[228:231], v60, s[16:19], 0 offen offset:256 sc1
buffer_load_dwordx4 a[232:235], v61, s[16:19], 0 offen sc1
buffer_load_dwordx4 a[236:239], v61, s[16:19], 0 offen offset:256 sc1
buffer_load_dwordx4 a[240:243], v62, s[16:19], 0 offen sc1
buffer_load_dwordx4 a[244:247], v62, s[16:19], 0 offen offset:256 sc1
buffer_load_dwordx4 a[248:251], v63, s[16:19], 0 offen sc1
buffer_load_dwordx4 a[252:255], v63, s[16:19], 0 offen offset:256 sc1
v_add_u32 v34, 512, v34
s_mov_b32 s45, 0
s_mul_i32 s47, s40, 80384
LE_loop:
v_readlane_b32 s46, v37, s45
s_add_u32 s45, s45, 1
s_waitcnt vmcnt(56)
v_mfma_f32_16x16x32_bf16 v[48:51], a[0:3], v[40:43], v[48:51]
v_mfma_f32_16x16x32_bf16 v[48:51], a[4:7], v[44:47], v[48:51]
s_bitcmp1_b32 s46, 0
s_cbranch_scc0 LE_nf0
s_cmp_eq_u32 s42, 0
s_cbranch_scc1 LE_fl0
buffer_load_dwordx2 v[66:67], v39, s[20:23], s47 offen sc1
s_waitcnt vmcnt(0)
v_lshlrev_b32 v64, 16, v66
v_and_b32 v65, 0xffff0000, v66
v_add_f32 v48, v48, v64
v_add_f32 v49, v49, v65
v_lshlrev_b32 v64, 16, v67
v_and_b32 v65, 0xffff0000, v67
v_add_f32 v50, v50, v64
v_add_f32 v51, v51, v65
LE_fl0:
s_nop 3
v_cvt_pk_bf16_f32 v64, v48, v49
v_cvt_pk_bf16_f32 v65, v50, v51
v_mov_b32 v48, 0
v_mov_b32 v49, 0
v_mov_b32 v50, 0
v_mov_b32 v51, 0
buffer_store_dwordx2 v[64:65], v39, s[20:23], s47 offen sc1
s_add_u32 s47, s47, 512
LE_nf0:
v_mfma_f32_16x16x32_bf16 v[48:51], a[8:11], v[40:43], v[48:51]
v_mfma_f32_16x16x32_bf16 v[48:51], a[12:15], v[44:47], v[48:51]
s_bitcmp1_b32 s46, 1
s_cbranch_scc0 LE_nf1
s_cmp_eq_u32 s42, 0
s_cbranch_scc1 LE_fl1
buffer_load_dwordx2 v[66:67], v39, s[20:23], s47 offen sc1
s_waitcnt vmcnt(0)
v_lshlrev_b32 v64, 16, v66
v_and_b32 v65, 0xffff0000, v66
v_add_f32 v48, v48, v64
v_add_f32 v49, v49, v65
v_lshlrev_b32 v64, 16, v67
v_and_b32 v65, 0xffff0000, v67
v_add_f32 v50, v50, v64
v_add_f32 v51, v51, v65
LE_fl1:
s_nop 3
v_cvt_pk_bf16_f32 v64, v48, v49
v_cvt_pk_bf16_f32 v65, v50, v51
v_mov_b32 v48, 0
v_mov_b32 v49, 0
v_mov_b32 v50, 0
v_mov_b32 v51, 0
buffer_store_dwordx2 v[64:65], v39, s[20:23], s47 offen sc1
s_add_u32 s47, s47, 512
LE_nf1:
v_mfma_f32_16x16x32_bf16 v[48:51], a[16:19], v[40:43], v[48:51]
v_mfma_f32_16x16x32_bf16 v[48:51], a[20:23], v[44:47], v[48:51]
s_bitcmp1_b32 s46, 2
s_cbranch_scc0 LE_nf2
s_cmp_eq_u32 s42, 0
s_cbranch_scc1 LE_fl2
buffer_load_dwordx2 v[66:67], v39, s[20:23], s47 offen sc1
s_waitcnt vmcnt(0)
v_lshlrev_b32 v64, 16, v66
v_and_b32 v65, 0xffff0000, v66
v_add_f32 v48, v48, v64
v_add_f32 v49, v49, v65
v_lshlrev_b32 v64, 16, v67
v_and_b32 v65, 0xffff0000, v67
v_add_f32 v50, v50, v64
v_add_f32 v51, v51, v65
LE_fl2:
s_nop 3
v_cvt_pk_bf16_f32 v64, v48, v49
v_cvt_pk_bf16_f32 v65, v50, v51
v_mov_b32 v48, 0
v_mov_b32 v49, 0
v_mov_b32 v50, 0
v_mov_b32 v51, 0
buffer_store_dwordx2 v[64:65], v39, s[20:23], s47 offen sc1
s_add_u32 s47, s47, 512
LE_nf2:
v_mfma_f32_16x16x32_bf16 v[48:51], a[24:27], v[40:43], v[48:51]
v_mfma_f32_16x16x32_bf16 v[48:51], a[28:31], v[44:47], v[48:51]
s_bitcmp1_b32 s46, 3
s_cbranch_scc0 LE_nf3
s_cmp_eq_u32 s42, 0
s_cbranch_scc1 LE_fl3
buffer_load_dwordx2 v[66:67], v39, s[20:23], s47 offen sc1
s_waitcnt vmcnt(0)
v_lshlrev_b32 v64, 16, v66
v_and_b32 v65, 0xffff0000, v66
v_add_f32 v48, v48, v64
v_add_f32 v49, v49, v65
v_lshlrev_b32 v64, 16, v67
v_and_b32 v65, 0xffff0000, v67
v_add_f32 v50, v50, v64
v_add_f32 v51, v51, v65
LE_fl3:
s_nop 3
v_cvt_pk_bf16_f32 v64, v48, v49
v_cvt_pk_bf16_f32 v65, v50, v51
v_mov_b32 v48, 0
v_mov_b32 v49, 0
v_mov_b32 v50, 0
v_mov_b32 v51, 0
buffer_store_dwordx2 v[64:65], v39, s[20:23], s47 offen sc1
s_add_u32 s47, s47, 512
LE_nf3:
s_waitcnt lgkmcnt(0)
ds_read2_b32 v[56:57], v34 offset0:16 offset1:20
ds_read2_b32 v[58:59], v34 offset0:24 offset1:28
v_mad_u32_u16 v60, v52, s49, v2
v_mad_u32_u16 v61, v53, s49, v2
v_mad_u32_u16 v62, v54, s49, v2
v_mad_u32_u16 v63, v55, s49, v2
buffer_load_dwordx4 a[0:3], v60, s[16:19], 0 offen sc1
buffer_load_dwordx4 a[4:7], v60, s[16:19], 0 offen offset:256 sc1
buffer_load_dwordx4 a[8:11], v61, s[16:19], 0 offen sc1
buffer_load_dwordx4 a[12:15], v61, s[16:19], 0 offen offset:256 sc1
buffer_load_dwordx4 a[16:19], v62, s[16:19], 0 offen sc1
buffer_load_dwordx4 a[20:23], v62, s[16:19], 0 offen offset:256 sc1
buffer_load_dwordx4 a[24:27], v63, s[16:19], 0 offen sc1
buffer_load_dwordx4 a[28:31], v63, s[16:19], 0 offen offset:256 sc1
s_waitcnt vmcnt(56)
v_mfma_f32_16x16x32_bf16 v[48:51], a[32:35], v[40:43], v[48:51]
v_mfma_f32_16x16x32_bf16 v[48:51], a[36:39], v[44:47], v[48:51]
s_bitcmp1_b32 s46, 4
s_cbranch_scc0 LE_nf4
s_cmp_eq_u32 s42, 0
s_cbranch_scc1 LE_fl4
buffer_load_dwordx2 v[66:67], v39, s[20:23], s47 offen sc1
s_waitcnt vmcnt(0)
v_lshlrev_b32 v64, 16, v66
v_and_b32 v65, 0xffff0000, v66
v_add_f32 v48, v48, v64
v_add_f32 v49, v49, v65
v_lshlrev_b32 v64, 16, v67
v_and_b32 v65, 0xffff0000, v67
v_add_f32 v50, v50, v64
v_add_f32 v51, v51, v65
LE_fl4:
s_nop 3
v_cvt_pk_bf16_f32 v64, v48, v49
v_cvt_pk_bf16_f32 v65, v50, v51
v_mov_b32 v48, 0
v_mov_b32 v49, 0
v_mov_b32 v50, 0
v_mov_b32 v51, 0
buffer_store_dwordx2 v[64:65], v39, s[20:23], s47 offen sc1
s_add_u32 s47, s47, 512
LE_nf4:
v_mfma_f32_16x16x32_bf16 v[48:51], a[40:43], v[40:43], v[48:51]
v_mfma_f32_16x16x32_bf16 v[48:51], a[44:47], v[44:47], v[48:51]
s_bitcmp1_b32 s46, 5
s_cbranch_scc0 LE_nf5
s_cmp_eq_u32 s42, 0
s_cbranch_scc1 LE_fl5
buffer_load_dwordx2 v[66:67], v39, s[20:23], s47 offen sc1
s_waitcnt vmcnt(0)
v_lshlrev_b32 v64, 16, v66
v_and_b32 v65, 0xffff0000, v66
v_add_f32 v48, v48, v64
v_add_f32 v49, v49, v65
v_lshlrev_b32 v64, 16, v67
v_and_b32 v65, 0xffff0000, v67
v_add_f32 v50, v50, v64
v_add_f32 v51, v51, v65
LE_fl5:
s_nop 3
v_cvt_pk_bf16_f32 v64, v48, v49
v_cvt_pk_bf16_f32 v65, v50, v51
v_mov_b32 v48, 0
v_mov_b32 v49, 0
v_mov_b32 v50, 0
v_mov_b32 v51, 0
buffer_store_dwordx2 v[64:65], v39, s[20:23], s47 offen sc1
s_add_u32 s47, s47, 512
LE_nf5:
v_mfma_f32_16x16x32_bf16 v[48:51], a[48:51], v[40:43], v[48:51]
v_mfma_f32_16x16x32_bf16 v[48:51], a[52:55], v[44:47], v[48:51]
s_bitcmp1_b32 s46, 6
s_cbranch_scc0 LE_nf6
s_cmp_eq_u32 s42, 0
s_cbranch_scc1 LE_fl6
buffer_load_dwordx2 v[66:67], v39, s[20:23], s47 offen sc1
s_waitcnt vmcnt(0)
v_lshlrev_b32 v64, 16, v66
v_and_b32 v65, 0xffff0000, v66
v_add_f32 v48, v48, v64
v_add_f32 v49, v49, v65
v_lshlrev_b32 v64, 16, v67
v_and_b32 v65, 0xffff0000, v67
v_add_f32 v50, v50, v64
v_add_f32 v51, v51, v65
LE_fl6:
s_nop 3
v_cvt_pk_bf16_f32 v64, v48, v49
v_cvt_pk_bf16_f32 v65, v50, v51
v_mov_b32 v48, 0
v_mov_b32 v49, 0
v_mov_b32 v50, 0
v_mov_b32 v51, 0
buffer_store_dwordx2 v[64:65], v39, s[20:23], s47 offen sc1
s_add_u32 s47, s47, 512
LE_nf6:
v_mfma_f32_16x16x32_bf16 v[48:51], a[56:59], v[40:43], v[48:51]
v_mfma_f32_16x16x32_bf16 v[48:51], a[60:63], v[44:47], v[48:51]
s_bitcmp1_b32 s46, 7
s_cbranch_scc0 LE_nf7
s_cmp_eq_u32 s42, 0
s_cbranch_scc1 LE_fl7
buffer_load_dwordx2 v[66:67], v39, s[20:23], s47 offen sc1
s_waitcnt vmcnt(0)
v_lshlrev_b32 v64, 16, v66
v_and_b32 v65, 0xffff0000, v66
v_add_f32 v48, v48, v64
v_add_f32 v49, v49, v65
v_lshlrev_b32 v64, 16, v67
v_and_b32 v65, 0xffff0000, v67
v_add_f32 v50, v50, v64
v_add_f32 v51, v51, v65
LE_fl7:
s_nop 3
v_cvt_pk_bf16_f32 v64, v48, v49
v_cvt_pk_bf16_f32 v65, v50, v51
v_mov_b32 v48, 0
v_mov_b32 v49, 0
v_mov_b32 v50, 0
v_mov_b32 v51, 0
buffer_store_dwordx2 v[64:65], v39, s[20:23], s47 offen sc1
s_add_u32 s47, s47, 512
LE_nf7:
s_waitcnt lgkmcnt(0)
ds_read2_b32 v[52:53], v34 offset0:32 offset1:36
ds_read2_b32 v[54:55], v34 offset0:40 offset1:44
v_mad_u32_u16 v60, v56, s49, v2
v_mad_u32_u16 v61, v57, s49, v2
v_mad_u32_u16 v62, v58, s49, v2
v_mad_u32_u16 v63, v59, s49, v2
buffer_load_dwordx4 a[32:35], v60, s[16:19], 0 offen sc1
buffer_load_dwordx4 a[36:39], v60, s[16:19], 0 offen offset:256 sc1
buffer_load_dwordx4 a[40:43], v61, s[16:19], 0 offen sc1
buffer_load_dwordx4 a[44:47], v61, s[16:19], 0 offen offset:256 sc1
buffer_load_dwordx4 a[48:51], v62, s[16:19], 0 offen sc1
buffer_load_dwordx4 a[52:55], v62, s[16:19], 0 offen offset:256 sc1
buffer_load_dwordx4 a[56:59], v63, s[16:19], 0 offen sc1
buffer_load_dwordx4 a[60:63], v63, s[16:19], 0 offen offset:256 sc1
s_waitcnt vmcnt(56)
v_mfma_f32_16x16x32_bf16 v[48:51], a[64:67], v[40:43], v[48:51]
v_mfma_f32_16x16x32_bf16 v[48:51], a[68:71], v[44:47], v[48:51]
s_bitcmp1_b32 s46, 8
s_cbranch_scc0 LE_nf8
s_cmp_eq_u32 s42, 0
s_cbranch_scc1 LE_fl8
buffer_load_dwordx2 v[66:67], v39, s[20:23], s47 offen sc1
s_waitcnt vmcnt(0)
v_lshlrev_b32 v64, 16, v66
v_and_b32 v65, 0xffff0000, v66
v_add_f32 v48, v48, v64
v_add_f32 v49, v49, v65
v_lshlrev_b32 v64, 16, v67
v_and_b32 v65, 0xffff0000, v67
v_add_f32 v50, v50, v64
v_add_f32 v51, v51, v65
LE_fl8:
s_nop 3
v_cvt_pk_bf16_f32 v64, v48, v49
v_cvt_pk_bf16_f32 v65, v50, v51
v_mov_b32 v48, 0
v_mov_b32 v49, 0
v_mov_b32 v50, 0
v_mov_b32 v51, 0
buffer_store_dwordx2 v[64:65], v39, s[20:23], s47 offen sc1
s_add_u32 s47, s47, 512
LE_nf8:
v_mfma_f32_16x16x32_bf16 v[48:51], a[72:75], v[40:43], v[48:51]
v_mfma_f32_16x16x32_bf16 v[48:51], a[76:79], v[44:47], v[48:51]
s_bitcmp1_b32 s46, 9
s_cbranch_scc0 LE_nf9
s_cmp_eq_u32 s42, 0
s_cbranch_scc1 LE_fl9
buffer_load_dwordx2 v[66:67], v39, s[20:23], s47 offen sc1
s_waitcnt vmcnt(0)
v_lshlrev_b32 v64, 16, v66
v_and_b32 v65, 0xffff0000, v66
v_add_f32 v48, v48, v64
v_add_f32 v49, v49, v65
v_lshlrev_b32 v64, 16, v67
v_and_b32 v65, 0xffff0000, v67
v_add_f32 v50, v50, v64
v_add_f32 v51, v51, v65
LE_fl9:
s_nop 3
v_cvt_pk_bf16_f32 v64, v48, v49
v_cvt_pk_bf16_f32 v65, v50, v51
v_mov_b32 v48, 0
v_mov_b32 v49, 0
v_mov_b32 v50, 0
v_mov_b32 v51, 0
buffer_store_dwordx2 v[64:65], v39, s[20:23], s47 offen sc1
s_add_u32 s47, s47, 512
LE_nf9:
v_mfma_f32_16x16x32_bf16 v[48:51], a[80:83], v[40:43], v[48:51]
v_mfma_f32_16x16x32_bf16 v[48:51], a[84:87], v[44:47], v[48:51]
s_bitcmp1_b32 s46, 10
s_cbranch_scc0 LE_nf10
s_cmp_eq_u32 s42, 0
s_cbranch_scc1 LE_fl10
buffer_load_dwordx2 v[66:67], v39, s[20:23], s47 offen sc1
s_waitcnt vmcnt(0)
v_lshlrev_b32 v64, 16, v66
v_and_b32 v65, 0xffff0000, v66
v_add_f32 v48, v48, v64
v_add_f32 v49, v49, v65
v_lshlrev_b32 v64, 16, v67
v_and_b32 v65, 0xffff0000, v67
v_add_f32 v50, v50, v64
v_add_f32 v51, v51, v65
LE_fl10:
s_nop 3
v_cvt_pk_bf16_f32 v64, v48, v49
v_cvt_pk_bf16_f32 v65, v50, v51
v_mov_b32 v48, 0
v_mov_b32 v49, 0
v_mov_b32 v50, 0
v_mov_b32 v51, 0
buffer_store_dwordx2 v[64:65], v39, s[20:23], s47 offen sc1
s_add_u32 s47, s47, 512
LE_nf10:
v_mfma_f32_16x16x32_bf16 v[48:51], a[88:91], v[40:43], v[48:51]
v_mfma_f32_16x16x32_bf16 v[48:51], a[92:95], v[44:47], v[48:51]
s_bitcmp1_b32 s46, 11
s_cbranch_scc0 LE_nf11
s_cmp_eq_u32 s42, 0
s_cbranch_scc1 LE_fl11
buffer_load_dwordx2 v[66:67], v39, s[20:23], s47 offen sc1
s_waitcnt vmcnt(0)
v_lshlrev_b32 v64, 16, v66
v_and_b32 v65, 0xffff0000, v66
v_add_f32 v48, v48, v64
v_add_f32 v49, v49, v65
v_lshlrev_b32 v64, 16, v67
v_and_b32 v65, 0xffff0000, v67
v_add_f32 v50, v50, v64
v_add_f32 v51, v51, v65
LE_fl11:
s_nop 3
v_cvt_pk_bf16_f32 v64, v48, v49
v_cvt_pk_bf16_f32 v65, v50, v51
v_mov_b32 v48, 0
v_mov_b32 v49, 0
v_mov_b32 v50, 0
v_mov_b32 v51, 0
buffer_store_dwordx2 v[64:65], v39, s[20:23], s47 offen sc1
s_add_u32 s47, s47, 512
LE_nf11:
s_waitcnt lgkmcnt(0)
ds_read2_b32 v[56:57], v34 offset0:48 offset1:52
ds_read2_b32 v[58:59], v34 offset0:56 offset1:60
v_mad_u32_u16 v60, v52, s49, v2
v_mad_u32_u16 v61, v53, s49, v2
v_mad_u32_u16 v62, v54, s49, v2
v_mad_u32_u16 v63, v55, s49, v2
buffer_load_dwordx4 a[64:67], v60, s[16:19], 0 offen sc1
buffer_load_dwordx4 a[68:71], v60, s[16:19], 0 offen offset:256 sc1
buffer_load_dwordx4 a[72:75], v61, s[16:19], 0 offen sc1
buffer_load_dwordx4 a[76:79], v61, s[16:19], 0 offen offset:256 sc1
buffer_load_dwordx4 a[80:83], v62, s[16:19], 0 offen sc1
buffer_load_dwordx4 a[84:87], v62, s[16:19], 0 offen offset:256 sc1
buffer_load_dwordx4 a[88:91], v63, s[16:19], 0 offen sc1
buffer_load_dwordx4 a[92:95], v63, s[16:19], 0 offen offset:256 sc1
s_waitcnt vmcnt(56)
v_mfma_f32_16x16x32_bf16 v[48:51], a[96:99], v[40:43], v[48:51]
v_mfma_f32_16x16x32_bf16 v[48:51], a[100:103], v[44:47], v[48:51]
s_bitcmp1_b32 s46, 12
s_cbranch_scc0 LE_nf12
s_cmp_eq_u32 s42, 0
s_cbranch_scc1 LE_fl12
buffer_load_dwordx2 v[66:67], v39, s[20:23], s47 offen sc1
s_waitcnt vmcnt(0)
v_lshlrev_b32 v64, 16, v66
v_and_b32 v65, 0xffff0000, v66
v_add_f32 v48, v48, v64
v_add_f32 v49, v49, v65
v_lshlrev_b32 v64, 16, v67
v_and_b32 v65, 0xffff0000, v67
v_add_f32 v50, v50, v64
v_add_f32 v51, v51, v65
LE_fl12:
s_nop 3
v_cvt_pk_bf16_f32 v64, v48, v49
v_cvt_pk_bf16_f32 v65, v50, v51
v_mov_b32 v48, 0
v_mov_b32 v49, 0
v_mov_b32 v50, 0
v_mov_b32 v51, 0
buffer_store_dwordx2 v[64:65], v39, s[20:23], s47 offen sc1
s_add_u32 s47, s47, 512
LE_nf12:
v_mfma_f32_16x16x32_bf16 v[48:51], a[104:107], v[40:43], v[48:51]
v_mfma_f32_16x16x32_bf16 v[48:51], a[108:111], v[44:47], v[48:51]
s_bitcmp1_b32 s46, 13
s_cbranch_scc0 LE_nf13
s_cmp_eq_u32 s42, 0
s_cbranch_scc1 LE_fl13
buffer_load_dwordx2 v[66:67], v39, s[20:23], s47 offen sc1
s_waitcnt vmcnt(0)
v_lshlrev_b32 v64, 16, v66
v_and_b32 v65, 0xffff0000, v66
v_add_f32 v48, v48, v64
v_add_f32 v49, v49, v65
v_lshlrev_b32 v64, 16, v67
v_and_b32 v65, 0xffff0000, v67
v_add_f32 v50, v50, v64
v_add_f32 v51, v51, v65
LE_fl13:
s_nop 3
v_cvt_pk_bf16_f32 v64, v48, v49
v_cvt_pk_bf16_f32 v65, v50, v51
v_mov_b32 v48, 0
v_mov_b32 v49, 0
v_mov_b32 v50, 0
v_mov_b32 v51, 0
buffer_store_dwordx2 v[64:65], v39, s[20:23], s47 offen sc1
s_add_u32 s47, s47, 512
LE_nf13:
v_mfma_f32_16x16x32_bf16 v[48:51], a[112:115], v[40:43], v[48:51]
v_mfma_f32_16x16x32_bf16 v[48:51], a[116:119], v[44:47], v[48:51]
s_bitcmp1_b32 s46, 14
s_cbranch_scc0 LE_nf14
s_cmp_eq_u32 s42, 0
s_cbranch_scc1 LE_fl14
buffer_load_dwordx2 v[66:67], v39, s[20:23], s47 offen sc1
s_waitcnt vmcnt(0)
v_lshlrev_b32 v64, 16, v66
v_and_b32 v65, 0xffff0000, v66
v_add_f32 v48, v48, v64
v_add_f32 v49, v49, v65
v_lshlrev_b32 v64, 16, v67
v_and_b32 v65, 0xffff0000, v67
v_add_f32 v50, v50, v64
v_add_f32 v51, v51, v65
LE_fl14:
s_nop 3
v_cvt_pk_bf16_f32 v64, v48, v49
v_cvt_pk_bf16_f32 v65, v50, v51
v_mov_b32 v48, 0
v_mov_b32 v49, 0
v_mov_b32 v50, 0
v_mov_b32 v51, 0
buffer_store_dwordx2 v[64:65], v39, s[20:23], s47 offen sc1
s_add_u32 s47, s47, 512
LE_nf14:
v_mfma_f32_16x16x32_bf16 v[48:51], a[120:123], v[40:43], v[48:51]
v_mfma_f32_16x16x32_bf16 v[48:51], a[124:127], v[44:47], v[48:51]
s_bitcmp1_b32 s46, 15
s_cbranch_scc0 LE_nf15
s_cmp_eq_u32 s42, 0
s_cbranch_scc1 LE_fl15
buffer_load_dwordx2 v[66:67], v39, s[20:23], s47 offen sc1
s_waitcnt vmcnt(0)
v_lshlrev_b32 v64, 16, v66
v_and_b32 v65, 0xffff0000, v66
v_add_f32 v48, v48, v64
v_add_f32 v49, v49, v65
v_lshlrev_b32 v64, 16, v67
v_and_b32 v65, 0xffff0000, v67
v_add_f32 v50, v50, v64
v_add_f32 v51, v51, v65
LE_fl15:
s_nop 3
v_cvt_pk_bf16_f32 v64, v48, v49
v_cvt_pk_bf16_f32 v65, v50, v51
v_mov_b32 v48, 0
v_mov_b32 v49, 0
v_mov_b32 v50, 0
v_mov_b32 v51, 0
buffer_store_dwordx2 v[64:65], v39, s[20:23], s47 offen sc1
s_add_u32 s47, s47, 512
LE_nf15:
s_waitcnt lgkmcnt(0)
ds_read2_b32 v[52:53], v34 offset0:64 offset1:68
ds_read2_b32 v[54:55], v34 offset0:72 offset1:76
v_mad_u32_u16 v60, v56, s49, v2
v_mad_u32_u16 v61, v57, s49, v2
v_mad_u32_u16 v62, v58, s49, v2
v_mad_u32_u16 v63, v59, s49, v2
buffer_load_dwordx4 a[96:99], v60, s[16:19], 0 offen sc1
buffer_load_dwordx4 a[100:103], v60, s[16:19], 0 offen offset:256 sc1
buffer_load_dwordx4 a[104:107], v61, s[16:19], 0 offen sc1
buffer_load_dwordx4 a[108:111], v61, s[16:19], 0 offen offset:256 sc1
buffer_load_dwordx4 a[112:115], v62, s[16:19], 0 offen sc1
buffer_load_dwordx4 a[116:119], v62, s[16:19], 0 offen offset:256 sc1
buffer_load_dwordx4 a[120:123], v63, s[16:19], 0 offen sc1
buffer_load_dwordx4 a[124:127], v63, s[16:19], 0 offen offset:256 sc1
s_waitcnt vmcnt(56)
v_mfma_f32_16x16x32_bf16 v[48:51], a[128:131], v[40:43], v[48:51]
v_mfma_f32_16x16x32_bf16 v[48:51], a[132:135], v[44:47], v[48:51]
s_bitcmp1_b32 s46, 16
s_cbranch_scc0 LE_nf16
s_cmp_eq_u32 s42, 0
s_cbranch_scc1 LE_fl16
buffer_load_dwordx2 v[66:67], v39, s[20:23], s47 offen sc1
s_waitcnt vmcnt(0)
v_lshlrev_b32 v64, 16, v66
v_and_b32 v65, 0xffff0000, v66
v_add_f32 v48, v48, v64
v_add_f32 v49, v49, v65
v_lshlrev_b32 v64, 16, v67
v_and_b32 v65, 0xffff0000, v67
v_add_f32 v50, v50, v64
v_add_f32 v51, v51, v65
LE_fl16:
s_nop 3
v_cvt_pk_bf16_f32 v64, v48, v49
v_cvt_pk_bf16_f32 v65, v50, v51
v_mov_b32 v48, 0
v_mov_b32 v49, 0
v_mov_b32 v50, 0
v_mov_b32 v51, 0
buffer_store_dwordx2 v[64:65], v39, s[20:23], s47 offen sc1
s_add_u32 s47, s47, 512
LE_nf16:
v_mfma_f32_16x16x32_bf16 v[48:51], a[136:139], v[40:43], v[48:51]
v_mfma_f32_16x16x32_bf16 v[48:51], a[140:143], v[44:47], v[48:51]
s_bitcmp1_b32 s46, 17
s_cbranch_scc0 LE_nf17
s_cmp_eq_u32 s42, 0
s_cbranch_scc1 LE_fl17
buffer_load_dwordx2 v[66:67], v39, s[20:23], s47 offen sc1
s_waitcnt vmcnt(0)
v_lshlrev_b32 v64, 16, v66
v_and_b32 v65, 0xffff0000, v66
v_add_f32 v48, v48, v64
v_add_f32 v49, v49, v65
v_lshlrev_b32 v64, 16, v67
v_and_b32 v65, 0xffff0000, v67
v_add_f32 v50, v50, v64
v_add_f32 v51, v51, v65
LE_fl17:
s_nop 3
v_cvt_pk_bf16_f32 v64, v48, v49
v_cvt_pk_bf16_f32 v65, v50, v51
v_mov_b32 v48, 0
v_mov_b32 v49, 0
v_mov_b32 v50, 0
v_mov_b32 v51, 0
buffer_store_dwordx2 v[64:65], v39, s[20:23], s47 offen sc1
s_add_u32 s47, s47, 512
LE_nf17:
v_mfma_f32_16x16x32_bf16 v[48:51], a[144:147], v[40:43], v[48:51]
v_mfma_f32_16x16x32_bf16 v[48:51], a[148:151], v[44:47], v[48:51]
s_bitcmp1_b32 s46, 18
s_cbranch_scc0 LE_nf18
s_cmp_eq_u32 s42, 0
s_cbranch_scc1 LE_fl18
buffer_load_dwordx2 v[66:67], v39, s[20:23], s47 offen sc1
s_waitcnt vmcnt(0)
v_lshlrev_b32 v64, 16, v66
v_and_b32 v65, 0xffff0000, v66
v_add_f32 v48, v48, v64
v_add_f32 v49, v49, v65
v_lshlrev_b32 v64, 16, v67
v_and_b32 v65, 0xffff0000, v67
v_add_f32 v50, v50, v64
v_add_f32 v51, v51, v65
LE_fl18:
s_nop 3
v_cvt_pk_bf16_f32 v64, v48, v49
v_cvt_pk_bf16_f32 v65, v50, v51
v_mov_b32 v48, 0
v_mov_b32 v49, 0
v_mov_b32 v50, 0
v_mov_b32 v51, 0
buffer_store_dwordx2 v[64:65], v39, s[20:23], s47 offen sc1
s_add_u32 s47, s47, 512
LE_nf18:
v_mfma_f32_16x16x32_bf16 v[48:51], a[152:155], v[40:43], v[48:51]
v_mfma_f32_16x16x32_bf16 v[48:51], a[156:159], v[44:47], v[48:51]
s_bitcmp1_b32 s46, 19
s_cbranch_scc0 LE_nf19
s_cmp_eq_u32 s42, 0
s_cbranch_scc1 LE_fl19
buffer_load_dwordx2 v[66:67], v39, s[20:23], s47 offen sc1
s_waitcnt vmcnt(0)
v_lshlrev_b32 v64, 16, v66
v_and_b32 v65, 0xffff0000, v66
v_add_f32 v48, v48, v64
v_add_f32 v49, v49, v65
v_lshlrev_b32 v64, 16, v67
v_and_b32 v65, 0xffff0000, v67
v_add_f32 v50, v50, v64
v_add_f32 v51, v51, v65
LE_fl19:
s_nop 3
v_cvt_pk_bf16_f32 v64, v48, v49
v_cvt_pk_bf16_f32 v65, v50, v51
v_mov_b32 v48, 0
v_mov_b32 v49, 0
v_mov_b32 v50, 0
v_mov_b32 v51, 0
buffer_store_dwordx2 v[64:65], v39, s[20:23], s47 offen sc1
s_add_u32 s47, s47, 512
LE_nf19:
s_waitcnt lgkmcnt(0)
ds_read2_b32 v[56:57], v34 offset0:80 offset1:84
ds_read2_b32 v[58:59], v34 offset0:88 offset1:92
v_mad_u32_u16 v60, v52, s49, v2
v_mad_u32_u16 v61, v53, s49, v2
v_mad_u32_u16 v62, v54, s49, v2
v_mad_u32_u16 v63, v55, s49, v2
buffer_load_dwordx4 a[128:131], v60, s[16:19], 0 offen sc1
buffer_load_dwordx4 a[132:135], v60, s[16:19], 0 offen offset:256 sc1
buffer_load_dwordx4 a[136:139], v61, s[16:19], 0 offen sc1
buffer_load_dwordx4 a[140:143], v61, s[16:19], 0 offen offset:256 sc1
buffer_load_dwordx4 a[144:147], v62, s[16:19], 0 offen sc1
buffer_load_dwordx4 a[148:151], v62, s[16:19], 0 offen offset:256 sc1
buffer_load_dwordx4 a[152:155], v63, s[16:19], 0 offen sc1
buffer_load_dwordx4 a[156:159], v63, s[16:19], 0 offen offset:256 sc1
s_waitcnt vmcnt(56)
v_mfma_f32_16x16x32_bf16 v[48:51], a[160:163], v[40:43], v[48:51]
v_mfma_f32_16x16x32_bf16 v[48:51], a[164:167], v[44:47], v[48:51]
s_bitcmp1_b32 s46, 20
s_cbranch_scc0 LE_nf20
s_cmp_eq_u32 s42, 0
s_cbranch_scc1 LE_fl20
buffer_load_dwordx2 v[66:67], v39, s[20:23], s47 offen sc1
s_waitcnt vmcnt(0)
v_lshlrev_b32 v64, 16, v66
v_and_b32 v65, 0xffff0000, v66
v_add_f32 v48, v48, v64
v_add_f32 v49, v49, v65
v_lshlrev_b32 v64, 16, v67
v_and_b32 v65, 0xffff0000, v67
v_add_f32 v50, v50, v64
v_add_f32 v51, v51, v65
LE_fl20:
s_nop 3
v_cvt_pk_bf16_f32 v64, v48, v49
v_cvt_pk_bf16_f32 v65, v50, v51
v_mov_b32 v48, 0
v_mov_b32 v49, 0
v_mov_b32 v50, 0
v_mov_b32 v51, 0
buffer_store_dwordx2 v[64:65], v39, s[20:23], s47 offen sc1
s_add_u32 s47, s47, 512
LE_nf20:
v_mfma_f32_16x16x32_bf16 v[48:51], a[168:171], v[40:43], v[48:51]
v_mfma_f32_16x16x32_bf16 v[48:51], a[172:175], v[44:47], v[48:51]
s_bitcmp1_b32 s46, 21
s_cbranch_scc0 LE_nf21
s_cmp_eq_u32 s42, 0
s_cbranch_scc1 LE_fl21
buffer_load_dwordx2 v[66:67], v39, s[20:23], s47 offen sc1
s_waitcnt vmcnt(0)
v_lshlrev_b32 v64, 16, v66
v_and_b32 v65, 0xffff0000, v66
v_add_f32 v48, v48, v64
v_add_f32 v49, v49, v65
v_lshlrev_b32 v64, 16, v67
v_and_b32 v65, 0xffff0000, v67
v_add_f32 v50, v50, v64
v_add_f32 v51, v51, v65
LE_fl21:
s_nop 3
v_cvt_pk_bf16_f32 v64, v48, v49
v_cvt_pk_bf16_f32 v65, v50, v51
v_mov_b32 v48, 0
v_mov_b32 v49, 0
v_mov_b32 v50, 0
v_mov_b32 v51, 0
buffer_store_dwordx2 v[64:65], v39, s[20:23], s47 offen sc1
s_add_u32 s47, s47, 512
LE_nf21:
v_mfma_f32_16x16x32_bf16 v[48:51], a[176:179], v[40:43], v[48:51]
v_mfma_f32_16x16x32_bf16 v[48:51], a[180:183], v[44:47], v[48:51]
s_bitcmp1_b32 s46, 22
s_cbranch_scc0 LE_nf22
s_cmp_eq_u32 s42, 0
s_cbranch_scc1 LE_fl22
buffer_load_dwordx2 v[66:67], v39, s[20:23], s47 offen sc1
s_waitcnt vmcnt(0)
v_lshlrev_b32 v64, 16, v66
v_and_b32 v65, 0xffff0000, v66
v_add_f32 v48, v48, v64
v_add_f32 v49, v49, v65
v_lshlrev_b32 v64, 16, v67
v_and_b32 v65, 0xffff0000, v67
v_add_f32 v50, v50, v64
v_add_f32 v51, v51, v65
LE_fl22:
s_nop 3
v_cvt_pk_bf16_f32 v64, v48, v49
v_cvt_pk_bf16_f32 v65, v50, v51
v_mov_b32 v48, 0
v_mov_b32 v49, 0
v_mov_b32 v50, 0
v_mov_b32 v51, 0
buffer_store_dwordx2 v[64:65], v39, s[20:23], s47 offen sc1
s_add_u32 s47, s47, 512
LE_nf22:
v_mfma_f32_16x16x32_bf16 v[48:51], a[184:187], v[40:43], v[48:51]
v_mfma_f32_16x16x32_bf16 v[48:51], a[188:191], v[44:47], v[48:51]
s_bitcmp1_b32 s46, 23
s_cbranch_scc0 LE_nf23
s_cmp_eq_u32 s42, 0
s_cbranch_scc1 LE_fl23
buffer_load_dwordx2 v[66:67], v39, s[20:23], s47 offen sc1
s_waitcnt vmcnt(0)
v_lshlrev_b32 v64, 16, v66
v_and_b32 v65, 0xffff0000, v66
v_add_f32 v48, v48, v64
v_add_f32 v49, v49, v65
v_lshlrev_b32 v64, 16, v67
v_and_b32 v65, 0xffff0000, v67
v_add_f32 v50, v50, v64
v_add_f32 v51, v51, v65
LE_fl23:
s_nop 3
v_cvt_pk_bf16_f32 v64, v48, v49
v_cvt_pk_bf16_f32 v65, v50, v51
v_mov_b32 v48, 0
v_mov_b32 v49, 0
v_mov_b32 v50, 0
v_mov_b32 v51, 0
buffer_store_dwordx2 v[64:65], v39, s[20:23], s47 offen sc1
s_add_u32 s47, s47, 512
LE_nf23:
s_waitcnt lgkmcnt(0)
ds_read2_b32 v[52:53], v34 offset0:96 offset1:100
ds_read2_b32 v[54:55], v34 offset0:104 offset1:108
v_mad_u32_u16 v60, v56, s49, v2
v_mad_u32_u16 v61, v57, s49, v2
v_mad_u32_u16 v62, v58, s49, v2
v_mad_u32_u16 v63, v59, s49, v2
buffer_load_dwordx4 a[160:163], v60, s[16:19], 0 offen sc1
buffer_load_dwordx4 a[164:167], v60, s[16:19], 0 offen offset:256 sc1
buffer_load_dwordx4 a[168:171], v61, s[16:19], 0 offen sc1
buffer_load_dwordx4 a[172:175], v61, s[16:19], 0 offen offset:256 sc1
buffer_load_dwordx4 a[176:179], v62, s[16:19], 0 offen sc1
buffer_load_dwordx4 a[180:183], v62, s[16:19], 0 offen offset:256 sc1
buffer_load_dwordx4 a[184:187], v63, s[16:19], 0 offen sc1
buffer_load_dwordx4 a[188:191], v63, s[16:19], 0 offen offset:256 sc1
s_waitcnt vmcnt(56)
v_mfma_f32_16x16x32_bf16 v[48:51], a[192:195], v[40:43], v[48:51]
v_mfma_f32_16x16x32_bf16 v[48:51], a[196:199], v[44:47], v[48:51]
s_bitcmp1_b32 s46, 24
s_cbranch_scc0 LE_nf24
s_cmp_eq_u32 s42, 0
s_cbranch_scc1 LE_fl24
buffer_load_dwordx2 v[66:67], v39, s[20:23], s47 offen sc1
s_waitcnt vmcnt(0)
v_lshlrev_b32 v64, 16, v66
v_and_b32 v65, 0xffff0000, v66
v_add_f32 v48, v48, v64
v_add_f32 v49, v49, v65
v_lshlrev_b32 v64, 16, v67
v_and_b32 v65, 0xffff0000, v67
v_add_f32 v50, v50, v64
v_add_f32 v51, v51, v65
LE_fl24:
s_nop 3
v_cvt_pk_bf16_f32 v64, v48, v49
v_cvt_pk_bf16_f32 v65, v50, v51
v_mov_b32 v48, 0
v_mov_b32 v49, 0
v_mov_b32 v50, 0
v_mov_b32 v51, 0
buffer_store_dwordx2 v[64:65], v39, s[20:23], s47 offen sc1
s_add_u32 s47, s47, 512
LE_nf24:
v_mfma_f32_16x16x32_bf16 v[48:51], a[200:203], v[40:43], v[48:51]
v_mfma_f32_16x16x32_bf16 v[48:51], a[204:207], v[44:47], v[48:51]
s_bitcmp1_b32 s46, 25
s_cbranch_scc0 LE_nf25
s_cmp_eq_u32 s42, 0
s_cbranch_scc1 LE_fl25
buffer_load_dwordx2 v[66:67], v39, s[20:23], s47 offen sc1
s_waitcnt vmcnt(0)
v_lshlrev_b32 v64, 16, v66
v_and_b32 v65, 0xffff0000, v66
v_add_f32 v48, v48, v64
v_add_f32 v49, v49, v65
v_lshlrev_b32 v64, 16, v67
v_and_b32 v65, 0xffff0000, v67
v_add_f32 v50, v50, v64
v_add_f32 v51, v51, v65
LE_fl25:
s_nop 3
v_cvt_pk_bf16_f32 v64, v48, v49
v_cvt_pk_bf16_f32 v65, v50, v51
v_mov_b32 v48, 0
v_mov_b32 v49, 0
v_mov_b32 v50, 0
v_mov_b32 v51, 0
buffer_store_dwordx2 v[64:65], v39, s[20:23], s47 offen sc1
s_add_u32 s47, s47, 512
LE_nf25:
v_mfma_f32_16x16x32_bf16 v[48:51], a[208:211], v[40:43], v[48:51]
v_mfma_f32_16x16x32_bf16 v[48:51], a[212:215], v[44:47], v[48:51]
s_bitcmp1_b32 s46, 26
s_cbranch_scc0 LE_nf26
s_cmp_eq_u32 s42, 0
s_cbranch_scc1 LE_fl26
buffer_load_dwordx2 v[66:67], v39, s[20:23], s47 offen sc1
s_waitcnt vmcnt(0)
v_lshlrev_b32 v64, 16, v66
v_and_b32 v65, 0xffff0000, v66
v_add_f32 v48, v48, v64
v_add_f32 v49, v49, v65
v_lshlrev_b32 v64, 16, v67
v_and_b32 v65, 0xffff0000, v67
v_add_f32 v50, v50, v64
v_add_f32 v51, v51, v65
LE_fl26:
s_nop 3
v_cvt_pk_bf16_f32 v64, v48, v49
v_cvt_pk_bf16_f32 v65, v50, v51
v_mov_b32 v48, 0
v_mov_b32 v49, 0
v_mov_b32 v50, 0
v_mov_b32 v51, 0
buffer_store_dwordx2 v[64:65], v39, s[20:23], s47 offen sc1
s_add_u32 s47, s47, 512
LE_nf26:
v_mfma_f32_16x16x32_bf16 v[48:51], a[216:219], v[40:43], v[48:51]
v_mfma_f32_16x16x32_bf16 v[48:51], a[220:223], v[44:47], v[48:51]
s_bitcmp1_b32 s46, 27
s_cbranch_scc0 LE_nf27
s_cmp_eq_u32 s42, 0
s_cbranch_scc1 LE_fl27
buffer_load_dwordx2 v[66:67], v39, s[20:23], s47 offen sc1
s_waitcnt vmcnt(0)
v_lshlrev_b32 v64, 16, v66
v_and_b32 v65, 0xffff0000, v66
v_add_f32 v48, v48, v64
v_add_f32 v49, v49, v65
v_lshlrev_b32 v64, 16, v67
v_and_b32 v65, 0xffff0000, v67
v_add_f32 v50, v50, v64
v_add_f32 v51, v51, v65
LE_fl27:
s_nop 3
v_cvt_pk_bf16_f32 v64, v48, v49
v_cvt_pk_bf16_f32 v65, v50, v51
v_mov_b32 v48, 0
v_mov_b32 v49, 0
v_mov_b32 v50, 0
v_mov_b32 v51, 0
buffer_store_dwordx2 v[64:65], v39, s[20:23], s47 offen sc1
s_add_u32 s47, s47, 512
LE_nf27:
s_waitcnt lgkmcnt(0)
ds_read2_b32 v[56:57], v34 offset0:112 offset1:116
ds_read2_b32 v[58:59], v34 offset0:120 offset1:124
v_mad_u32_u16 v60, v52, s49, v2
v_mad_u32_u16 v61, v53, s49, v2
v_mad_u32_u16 v62, v54, s49, v2
v_mad_u32_u16 v63, v55, s49, v2
buffer_load_dwordx4 a[192:195], v60, s[16:19], 0 offen sc1
buffer_load_dwordx4 a[196:199], v60, s[16:19], 0 offen offset:256 sc1
buffer_load_dwordx4 a[200:203], v61, s[16:19], 0 offen sc1
buffer_load_dwordx4 a[204:207], v61, s[16:19], 0 offen offset:256 sc1
buffer_load_dwordx4 a[208:211], v62, s[16:19], 0 offen sc1
buffer_load_dwordx4 a[212:215], v62, s[16:19], 0 offen offset:256 sc1
buffer_load_dwordx4 a[216:219], v63, s[16:19], 0 offen sc1
buffer_load_dwordx4 a[220:223], v63, s[16:19], 0 offen offset:256 sc1
s_waitcnt vmcnt(56)
v_mfma_f32_16x16x32_bf16 v[48:51], a[224:227], v[40:43], v[48:51]
v_mfma_f32_16x16x32_bf16 v[48:51], a[228:231], v[44:47], v[48:51]
s_bitcmp1_b32 s46, 28
s_cbranch_scc0 LE_nf28
s_cmp_eq_u32 s42, 0
s_cbranch_scc1 LE_fl28
buffer_load_dwordx2 v[66:67], v39, s[20:23], s47 offen sc1
s_waitcnt vmcnt(0)
v_lshlrev_b32 v64, 16, v66
v_and_b32 v65, 0xffff0000, v66
v_add_f32 v48, v48, v64
v_add_f32 v49, v49, v65
v_lshlrev_b32 v64, 16, v67
v_and_b32 v65, 0xffff0000, v67
v_add_f32 v50, v50, v64
v_add_f32 v51, v51, v65
LE_fl28:
s_nop 3
v_cvt_pk_bf16_f32 v64, v48, v49
v_cvt_pk_bf16_f32 v65, v50, v51
v_mov_b32 v48, 0
v_mov_b32 v49, 0
v_mov_b32 v50, 0
v_mov_b32 v51, 0
buffer_store_dwordx2 v[64:65], v39, s[20:23], s47 offen sc1
s_add_u32 s47, s47, 512
LE_nf28:
v_mfma_f32_16x16x32_bf16 v[48:51], a[232:235], v[40:43], v[48:51]
v_mfma_f32_16x16x32_bf16 v[48:51], a[236:239], v[44:47], v[48:51]
s_bitcmp1_b32 s46, 29
s_cbranch_scc0 LE_nf29
s_cmp_eq_u32 s42, 0
s_cbranch_scc1 LE_fl29
buffer_load_dwordx2 v[66:67], v39, s[20:23], s47 offen sc1
s_waitcnt vmcnt(0)
v_lshlrev_b32 v64, 16, v66
v_and_b32 v65, 0xffff0000, v66
v_add_f32 v48, v48, v64
v_add_f32 v49, v49, v65
v_lshlrev_b32 v64, 16, v67
v_and_b32 v65, 0xffff0000, v67
v_add_f32 v50, v50, v64
v_add_f32 v51, v51, v65
LE_fl29:
s_nop 3
v_cvt_pk_bf16_f32 v64, v48, v49
v_cvt_pk_bf16_f32 v65, v50, v51
v_mov_b32 v48, 0
v_mov_b32 v49, 0
v_mov_b32 v50, 0
v_mov_b32 v51, 0
buffer_store_dwordx2 v[64:65], v39, s[20:23], s47 offen sc1
s_add_u32 s47, s47, 512
LE_nf29:
v_mfma_f32_16x16x32_bf16 v[48:51], a[240:243], v[40:43], v[48:51]
v_mfma_f32_16x16x32_bf16 v[48:51], a[244:247], v[44:47], v[48:51]
s_bitcmp1_b32 s46, 30
s_cbranch_scc0 LE_nf30
s_cmp_eq_u32 s42, 0
s_cbranch_scc1 LE_fl30
buffer_load_dwordx2 v[66:67], v39, s[20:23], s47 offen sc1
s_waitcnt vmcnt(0)
v_lshlrev_b32 v64, 16, v66
v_and_b32 v65, 0xffff0000, v66
v_add_f32 v48, v48, v64
v_add_f32 v49, v49, v65
v_lshlrev_b32 v64, 16, v67
v_and_b32 v65, 0xffff0000, v67
v_add_f32 v50, v50, v64
v_add_f32 v51, v51, v65
LE_fl30:
s_nop 3
v_cvt_pk_bf16_f32 v64, v48, v49
v_cvt_pk_bf16_f32 v65, v50, v51
v_mov_b32 v48, 0
v_mov_b32 v49, 0
v_mov_b32 v50, 0
v_mov_b32 v51, 0
buffer_store_dwordx2 v[64:65], v39, s[20:23], s47 offen sc1
s_add_u32 s47, s47, 512
LE_nf30:
v_mfma_f32_16x16x32_bf16 v[48:51], a[248:251], v[40:43], v[48:51]
v_mfma_f32_16x16x32_bf16 v[48:51], a[252:255], v[44:47], v[48:51]
s_bitcmp1_b32 s46, 31
s_cbranch_scc0 LE_nf31
s_cmp_eq_u32 s42, 0
s_cbranch_scc1 LE_fl31
buffer_load_dwordx2 v[66:67], v39, s[20:23], s47 offen sc1
s_waitcnt vmcnt(0)
v_lshlrev_b32 v64, 16, v66
v_and_b32 v65, 0xffff0000, v66
v_add_f32 v48, v48, v64
v_add_f32 v49, v49, v65
v_lshlrev_b32 v64, 16, v67
v_and_b32 v65, 0xffff0000, v67
v_add_f32 v50, v50, v64
v_add_f32 v51, v51, v65
LE_fl31:
s_nop 3
v_cvt_pk_bf16_f32 v64, v48, v49
v_cvt_pk_bf16_f32 v65, v50, v51
v_mov_b32 v48, 0
v_mov_b32 v49, 0
v_mov_b32 v50, 0
v_mov_b32 v51, 0
buffer_store_dwordx2 v[64:65], v39, s[20:23], s47 offen sc1
s_add_u32 s47, s47, 512
LE_nf31:
s_waitcnt lgkmcnt(0)
ds_read2_b32 v[52:53], v34 offset0:128 offset1:132
ds_read2_b32 v[54:55], v34 offset0:136 offset1:140
v_mad_u32_u16 v60, v56, s49, v2
v_mad_u32_u16 v61, v57, s49, v2
v_mad_u32_u16 v62, v58, s49, v2
v_mad_u32_u16 v63, v59, s49, v2
buffer_load_dwordx4 a[224:227], v60, s[16:19], 0 offen sc1
buffer_load_dwordx4 a[228:231], v60, s[16:19], 0 offen offset:256 sc1
buffer_load_dwordx4 a[232:235], v61, s[16:19], 0 offen sc1
buffer_load_dwordx4 a[236:239], v61, s[16:19], 0 offen offset:256 sc1
buffer_load_dwordx4 a[240:243], v62, s[16:19], 0 offen sc1
buffer_load_dwordx4 a[244:247], v62, s[16:19], 0 offen offset:256 sc1
buffer_load_dwordx4 a[248:251], v63, s[16:19], 0 offen sc1
buffer_load_dwordx4 a[252:255], v63, s[16:19], 0 offen offset:256 sc1
v_add_u32 v34, 512, v34
s_cmp_lt_u32 s45, s44
s_cbranch_scc1 LE_loop
s_add_u32 s42, s42, 1
s_mul_i32 s43, s42, 256
v_cmp_lt_u32 vcc, s43, v4
s_cbranch_vccz LE_done
s_cmp_ge_u32 s42, 40
s_cbranch_scc1 LE_done
s_waitcnt vmcnt(0) lgkmcnt(0)
s_add_u32 s50, s50, 1024
v_add_u32 v5, 0x100, v5
buffer_load_dwordx4 v[192:195], v6, s[12:15], s50 offen offset:0 sc1
buffer_load_dwordx4 v[196:199], v6, s[12:15], s50 offen offset:64 sc1
buffer_load_dwordx4 v[200:203], v6, s[12:15], s50 offen offset:128 sc1
buffer_load_dwordx4 v[204:207], v6, s[12:15], s50 offen offset:192 sc1
buffer_load_dwordx4 v[208:211], v6, s[12:15], s50 offen offset:256 sc1
buffer_load_dwordx4 v[212:215], v6, s[12:15], s50 offen offset:320 sc1
buffer_load_dwordx4 v[216:219], v6, s[12:15], s50 offen offset:384 sc1
buffer_load_dwordx4 v[220:223], v6, s[12:15], s50 offen offset:448 sc1
buffer_load_dwordx4 v[224:227], v6, s[12:15], s50 offen offset:512 sc1
buffer_load_dwordx4 v[228:231], v6, s[12:15], s50 offen offset:576 sc1
buffer_load_dwordx4 v[232:235], v6, s[12:15], s50 offen offset:640 sc1
buffer_load_dwordx4 v[236:239], v6, s[12:15], s50 offen offset:704 sc1
buffer_load_dwordx4 v[240:243], v6, s[12:15], s50 offen offset:768 sc1
buffer_load_dwordx4 v[244:247], v6, s[12:15], s50 offen offset:832 sc1
buffer_load_dwordx4 v[248:251], v6, s[12:15], s50 offen offset:896 sc1
buffer_load_dwordx4 v[252:255], v6, s[12:15], s50 offen offset:960 sc1
s_branch LE_pass
LE_done:
s_add_u32 s24, s4, 0x7c00000
s_addc_u32 s25, s5, 0
s_mov_b32 s26, 0x40000
s_mov_b32 s27, 0x00020000
s_add_u32 s48, s40, 1280
s_mul_i32 s48, s48, 128
s_waitcnt vmcnt(0)
v_mov_b32 v32, s98
v_mov_b32 v33, s99
s_mov_b64 exec, 1
buffer_store_dwordx2 v[32:33], off, s[24:27], s48 sc1
s_mov_b64 exec, -1
s_branch L2_end
L2_fin:
L2_end:
s_endpgm
.section .rodata,"a"
.p2align 6
.amdhsa_kernel standalone__hybrid_graph_tf_graphgps__graph_kernel
  .amdhsa_next_free_vgpr 512
  .amdhsa_next_free_sgpr 102
  .amdhsa_accum_offset 256
  .amdhsa_group_segment_fixed_size 0
  .amdhsa_kernarg_size 96
  .amdhsa_user_sgpr_count 2
  .amdhsa_user_sgpr_kernarg_segment_ptr 1
  .amdhsa_system_sgpr_workgroup_id_x 1
.end_amdhsa_kernel
```

```asm
; @launch grid=(256,1,1) block=(256,1,1) lds=163840
.amdgcn_target "amdgcn-amd-amdhsa--gfx950"
.text
.globl standalone__hybrid_graph_tf_graphgps__graph_kernel
.p2align 8
.type standalone__hybrid_graph_tf_graphgps__graph_kernel,@function
standalone__hybrid_graph_tf_graphgps__graph_kernel:
s_getpc_b64 s[56:57]
s_load_dwordx16 s[16:31], s[0:1], 0
s_load_dwordx8 s[32:39], s[0:1], 64
s_cmp_ge_u32 s2, 256
s_cbranch_scc1 L2_end
v_lshrrev_b32 v1, 6, v0
v_and_b32 v2, 63, v0
s_lshr_b32 s3, s2, 3
s_add_u32 s3, s3, 30
s_and_b32 s3, s3, 31
v_readfirstlane_b32 s60, v1
s_lshl_b32 s5, s3, 2
s_add_u32 s5, s5, s60
s_and_b32 s56, s56, 0xffffff00
s_mov_b32 s58, L2_end-standalone__hybrid_graph_tf_graphgps__graph_kernel
s_mov_b32 s59, 0x00020000
s_and_b32 s6, s5, 15
s_lshl_b32 s6, s6, 13
v_lshlrev_b32 v10, 7, v2
buffer_load_dword v255, v10, s[56:59], s6 offen
v_and_b32 v3, 15, v2
v_lshrrev_b32 v4, 4, v2
s_and_b32 s62, s3, 7
s_mov_b64 s[14:15], 0
s_and_b32 s8, s2, 7
s_cmp_ge_u32 s3, 30
s_cbranch_scc1 LM_edge
s_mul_i32 s12, s3, 26
s_lshr_b32 s12, s12, 8
s_mul_i32 s9, s12, 10
s_sub_u32 s9, s3, s9
s_and_b32 s13, s8, 1
s_mul_i32 s13, s13, 3
s_add_u32 s13, s13, s12
s_lshr_b32 s12, s8, 1
s_mul_i32 s12, s12, 10
s_add_u32 s12, s12, s9
s_mul_i32 s91, s12, 6
s_add_u32 s91, s91, s13
s_mov_b32 s61, 0
s_cmp_eq_u32 s12, 39
s_cbranch_scc1 LM_light
s_mul_i32 s14, s13, 3
s_min_u32 s14, s14, 14
s_lshl_b32 s9, s12, 4
s_add_u32 s14, s14, s9
s_lshl_b32 s14, s14, 13
s_cmp_eq_u32 s91, 233
s_cselect_b32 s9, 0, s13
s_cmp_lt_u32 s9, 4
s_cselect_b32 s15, 3, 2
s_lshl_b32 s15, s15, 13
s_add_u32 s15, s15, s14
v_lshlrev_b32 v16, 4, v2
s_mul_i32 s63, s60, 12288
s_mov_b32 s6, s14
s_mul_i32 s7, s60, 6144
s_add_u32 s64, s6, s7
s_add_u32 s65, s64, 4096
s_lshl_b32 s7, s60, 7
v_lshrrev_b32 v5, 3, v2
v_and_b32 v6, 7, v2
v_and_b32 v7, 2, v5
v_xor_b32 v6, v6, v7
v_lshl_add_u32 v5, v5, 9, s7
v_lshl_add_u32 v17, v6, 4, v5
v_xor_b32 v6, 4, v6
v_lshl_add_u32 v18, v6, 4, v5
v_add_u32 v18, 0xc00, v18
v_add_u32 v19, 0x1800, v17
v_add_u32 v20, 0x1800, v18
s_xor_b32 s6, s62, 0
s_lshl_b32 s66, s6, 14
s_xor_b32 s6, s62, 1
s_lshl_b32 s67, s6, 14
s_xor_b32 s6, s62, 2
s_lshl_b32 s68, s6, 14
s_xor_b32 s6, s62, 3
s_lshl_b32 s69, s6, 14
s_xor_b32 s6, s62, 4
s_lshl_b32 s70, s6, 14
s_xor_b32 s6, s62, 5
s_lshl_b32 s71, s6, 14
s_xor_b32 s6, s62, 6
s_lshl_b32 s72, s6, 14
s_xor_b32 s6, s62, 7
s_lshl_b32 s73, s6, 14
s_waitcnt lgkmcnt(0)
s_add_u32 s40, s16, 0x0
s_addc_u32 s41, s17, 0
s_mov_b32 s42, s15
s_mov_b32 s43, 0x00020000
s_add_u32 s44, s26, 0x0
s_addc_u32 s45, s27, 0
s_mov_b32 s46, 0x20000
s_mov_b32 s47, 0x00020000
buffer_load_dwordx4 v[44:47], v16, s[40:43], s64 offen offset:0
buffer_load_dwordx4 v[48:51], v16, s[40:43], s64 offen offset:1024
buffer_load_dwordx4 v[52:55], v16, s[40:43], s64 offen offset:2048
buffer_load_dwordx4 v[56:59], v16, s[40:43], s64 offen offset:3072
buffer_load_dwordx4 v[60:63], v16, s[40:43], s65 offen offset:0
buffer_load_dwordx4 v[64:67], v16, s[40:43], s65 offen offset:1024
s_add_u32 m0, s63, 0x0
s_nop 0
buffer_load_dwordx4 v17, s[44:47], s66 offen offset:0 lds
buffer_load_dwordx4 v18, s[44:47], s66 offen offset:1024 lds
buffer_load_dwordx4 v19, s[44:47], s66 offen offset:2048 lds
buffer_load_dwordx4 v20, s[44:47], s66 offen offset:3072 lds
s_add_u32 m0, s63, 0x1000
s_nop 0
buffer_load_dwordx4 v17, s[44:47], s67 offen offset:0 lds
buffer_load_dwordx4 v18, s[44:47], s67 offen offset:1024 lds
buffer_load_dwordx4 v19, s[44:47], s67 offen offset:2048 lds
buffer_load_dwordx4 v20, s[44:47], s67 offen offset:3072 lds
s_mov_b32 s98, 0x7c3ff80
s_load_dwordx2 s[98:99], s[38:39], s98
v_bfe_u32 v5, v2, 2, 3
v_xor_b32 v5, s62, v5
v_and_b32 v6, 3, v2
v_lshlrev_b32 v7, 10, v5
v_lshl_add_u32 v7, v6, 8, v7
v_add_u32 v7, 0xc000, v7
v_and_b32 v5, 1, v5
v_lshl_or_b32 v6, v5, 2, v6
v_lshrrev_b32 v5, 5, v2
s_mul_i32 s6, s60, 12
v_add3_u32 v8, v5, s6, 0
v_lshrrev_b32 v9, 4, v8
v_lshl_add_u32 v9, v9, 13, v7
v_and_b32 v8, 15, v8
v_xor_b32 v8, v8, v6
v_lshl_add_u32 v36, v8, 4, v9
v_add3_u32 v8, v5, s6, 2
v_lshrrev_b32 v9, 4, v8
v_lshl_add_u32 v9, v9, 13, v7
v_and_b32 v8, 15, v8
v_xor_b32 v8, v8, v6
v_lshl_add_u32 v37, v8, 4, v9
v_add3_u32 v8, v5, s6, 4
v_lshrrev_b32 v9, 4, v8
v_lshl_add_u32 v9, v9, 13, v7
v_and_b32 v8, 15, v8
v_xor_b32 v8, v8, v6
v_lshl_add_u32 v38, v8, 4, v9
v_add3_u32 v8, v5, s6, 6
v_lshrrev_b32 v9, 4, v8
v_lshl_add_u32 v9, v9, 13, v7
v_and_b32 v8, 15, v8
v_xor_b32 v8, v8, v6
v_lshl_add_u32 v39, v8, 4, v9
v_add3_u32 v8, v5, s6, 8
v_lshrrev_b32 v9, 4, v8
v_lshl_add_u32 v9, v9, 13, v7
v_and_b32 v8, 15, v8
v_xor_b32 v8, v8, v6
v_lshl_add_u32 v40, v8, 4, v9
v_add3_u32 v8, v5, s6, 10
v_lshrrev_b32 v9, 4, v8
v_lshl_add_u32 v9, v9, 13, v7
v_and_b32 v8, 15, v8
v_xor_b32 v8, v8, v6
v_lshl_add_u32 v41, v8, 4, v9
v_xor_b32 v5, v3, v4
v_lshlrev_b32 v5, 4, v5
v_lshl_add_u32 v5, v4, 8, v5
v_add_u32 v31, 0xc000, v5
v_xor_b32 v32, 64, v31
v_lshrrev_b32 v5, 2, v3
v_and_b32 v6, 3, v3
v_and_b32 v7, 1, v4
v_lshlrev_b32 v7, 2, v7
v_and_b32 v8, 2, v5
v_or_b32 v7, v7, v8
v_lshl_add_u32 v8, v4, 3, v5
v_lshlrev_b32 v8, 7, v8
v_add_u32 v8, s63, v8
v_and_b32 v9, 1, v6
v_lshl_add_u32 v8, v9, 3, v8
v_lshrrev_b32 v6, 1, v6
v_xor_b32 v6, v6, v7
v_xor_b32 v9, 0, v6
v_lshl_add_u32 v25, v9, 4, v8
v_xor_b32 v9, 2, v6
v_lshl_add_u32 v26, v9, 4, v8
v_xor_b32 v9, 4, v6
v_lshl_add_u32 v27, v9, 4, v8
v_xor_b32 v9, 6, v6
v_lshl_add_u32 v28, v9, 4, v8
v_lshrrev_b32 v5, 3, v2
v_and_b32 v6, 7, v2
v_lshrrev_b32 v7, 1, v5
v_xor_b32 v6, v6, v7
v_and_b32 v7, 4, v5
v_add_u32 v5, v5, v7
s_mul_i32 s6, s60, 32768
v_lshl_add_u32 v5, v5, 9, s6
v_lshl_add_u32 v21, v6, 4, v5
v_xor_b32 v6, 4, v6
v_lshl_add_u32 v22, v6, 4, v5
v_add_u32 v22, 0x1c00, v22
v_mov_b32 v23, v21
v_mov_b32 v24, v22
s_lshr_b32 s7, s62, 1
s_xor_b32 s6, s7, 0
s_lshl_b32 s74, s6, 7
s_add_u32 s75, s74, 16384
s_xor_b32 s6, s7, 1
s_lshl_b32 s76, s6, 7
s_add_u32 s77, s76, 16384
s_xor_b32 s6, s7, 2
s_lshl_b32 s78, s6, 7
s_add_u32 s79, s78, 16384
s_xor_b32 s6, s7, 3
s_lshl_b32 s80, s6, 7
s_add_u32 s81, s80, 16384
s_and_b32 s6, s62, 1
s_lshl_b32 s6, s6, 2
v_lshrrev_b32 v5, 1, v3
v_xor_b32 v5, v5, v4
v_xor_b32 v5, s6, v5
v_lshl_add_u32 v6, v3, 7, s63
v_lshl_add_u32 v29, v5, 4, v6
v_xor_b32 v30, 64, v29
s_mul_i32 s6, s60, 2
s_xor_b32 s6, s6, s62
s_lshl_b32 s6, s6, 10
s_add_u32 s6, s6, 0x12000
v_lshrrev_b32 v5, 1, v4
v_and_b32 v6, 1, v4
v_lshl_add_u32 v5, v5, 8, s6
v_lshl_add_u32 v5, v6, 3, v5
v_lshl_add_u32 v33, v3, 4, v5
v_xor_b32 v34, 0x400, v33
v_add_u32 v35, 0x12000, v16
s_mov_b32 s6, s14
s_mul_i32 s7, s60, 2048
s_add_u32 s82, s6, s7
s_add_u32 s83, s82, 8192
s_add_u32 s84, s82, 16384
s_mov_b32 s86, 0x3db8aa3b
s_mov_b32 s87, 0x3db8aa3b
s_mov_b32 s88, 0x3727c5ac
s_mov_b32 s89, 0x3b800000
s_mov_b32 s90, 0xffff0000
s_add_u32 s48, s28, 0x0
s_addc_u32 s49, s29, 0
s_mov_b32 s50, 0x20000
s_mov_b32 s51, 0x00020000
s_add_u32 s52, s38, 0x0
s_addc_u32 s53, s39, 0
s_mov_b32 s54, s15
s_mov_b32 s55, 0x00020000
s_add_u32 s56, s38, 0x6800000
s_addc_u32 s57, s39, 0
s_mov_b32 s58, s15
s_mov_b32 s59, 0x00020000
s_waitcnt vmcnt(13)
v_lshlrev_b32 v116, 16, v44
v_and_b32 v117, s90, v44
v_lshlrev_b32 v118, 16, v45
v_and_b32 v119, s90, v45
v_lshlrev_b32 v120, 16, v46
v_and_b32 v121, s90, v46
v_lshlrev_b32 v122, 16, v47
v_and_b32 v123, s90, v47
v_pk_add_f32 v[164:165], v[116:117], v[118:119]
v_pk_mul_f32 v[166:167], v[116:117], v[116:117]
v_pk_add_f32 v[44:45], v[120:121], v[122:123]
v_pk_fma_f32 v[166:167], v[118:119], v[118:119], v[166:167]
v_pk_add_f32 v[164:165], v[164:165], v[44:45]
v_pk_fma_f32 v[166:167], v[120:121], v[120:121], v[166:167]
v_add_f32 v164, v164, v165
v_pk_fma_f32 v[166:167], v[122:123], v[122:123], v[166:167]
v_add_f32 v166, v166, v167
s_waitcnt vmcnt(12)
v_lshlrev_b32 v124, 16, v48
v_and_b32 v125, s90, v48
v_lshlrev_b32 v126, 16, v49
v_and_b32 v127, s90, v49
v_lshlrev_b32 v128, 16, v50
v_and_b32 v129, s90, v50
v_lshlrev_b32 v130, 16, v51
v_and_b32 v131, s90, v51
v_pk_add_f32 v[168:169], v[124:125], v[126:127]
v_pk_mul_f32 v[170:171], v[124:125], v[124:125]
v_pk_add_f32 v[48:49], v[128:129], v[130:131]
v_pk_fma_f32 v[170:171], v[126:127], v[126:127], v[170:171]
v_pk_add_f32 v[168:169], v[168:169], v[48:49]
v_pk_fma_f32 v[170:171], v[128:129], v[128:129], v[170:171]
v_add_f32 v168, v168, v169
v_pk_fma_f32 v[170:171], v[130:131], v[130:131], v[170:171]
v_add_f32 v170, v170, v171
s_waitcnt vmcnt(11)
v_lshlrev_b32 v132, 16, v52
v_and_b32 v133, s90, v52
v_lshlrev_b32 v134, 16, v53
v_and_b32 v135, s90, v53
v_lshlrev_b32 v136, 16, v54
v_and_b32 v137, s90, v54
v_lshlrev_b32 v138, 16, v55
v_and_b32 v139, s90, v55
v_pk_add_f32 v[172:173], v[132:133], v[134:135]
v_pk_mul_f32 v[174:175], v[132:133], v[132:133]
v_pk_add_f32 v[52:53], v[136:137], v[138:139]
v_pk_fma_f32 v[174:175], v[134:135], v[134:135], v[174:175]
v_pk_add_f32 v[172:173], v[172:173], v[52:53]
v_pk_fma_f32 v[174:175], v[136:137], v[136:137], v[174:175]
v_add_f32 v172, v172, v173
v_pk_fma_f32 v[174:175], v[138:139], v[138:139], v[174:175]
v_add_f32 v174, v174, v175
s_waitcnt vmcnt(10)
v_lshlrev_b32 v140, 16, v56
v_and_b32 v141, s90, v56
v_lshlrev_b32 v142, 16, v57
v_and_b32 v143, s90, v57
v_lshlrev_b32 v144, 16, v58
v_and_b32 v145, s90, v58
v_lshlrev_b32 v146, 16, v59
v_and_b32 v147, s90, v59
v_pk_add_f32 v[176:177], v[140:141], v[142:143]
v_pk_mul_f32 v[178:179], v[140:141], v[140:141]
v_pk_add_f32 v[56:57], v[144:145], v[146:147]
v_pk_fma_f32 v[178:179], v[142:143], v[142:143], v[178:179]
v_pk_add_f32 v[176:177], v[176:177], v[56:57]
v_pk_fma_f32 v[178:179], v[144:145], v[144:145], v[178:179]
v_add_f32 v176, v176, v177
v_pk_fma_f32 v[178:179], v[146:147], v[146:147], v[178:179]
v_add_f32 v178, v178, v179
s_waitcnt vmcnt(9)
v_lshlrev_b32 v148, 16, v60
v_and_b32 v149, s90, v60
v_lshlrev_b32 v150, 16, v61
v_and_b32 v151, s90, v61
v_lshlrev_b32 v152, 16, v62
v_and_b32 v153, s90, v62
v_lshlrev_b32 v154, 16, v63
v_and_b32 v155, s90, v63
v_pk_add_f32 v[180:181], v[148:149], v[150:151]
v_pk_mul_f32 v[182:183], v[148:149], v[148:149]
v_pk_add_f32 v[60:61], v[152:153], v[154:155]
v_pk_fma_f32 v[182:183], v[150:151], v[150:151], v[182:183]
v_pk_add_f32 v[180:181], v[180:181], v[60:61]
v_pk_fma_f32 v[182:183], v[152:153], v[152:153], v[182:183]
v_add_f32 v180, v180, v181
v_pk_fma_f32 v[182:183], v[154:155], v[154:155], v[182:183]
v_add_f32 v182, v182, v183
s_waitcnt vmcnt(8)
v_lshlrev_b32 v156, 16, v64
v_and_b32 v157, s90, v64
v_lshlrev_b32 v158, 16, v65
v_and_b32 v159, s90, v65
v_lshlrev_b32 v160, 16, v66
v_and_b32 v161, s90, v66
v_lshlrev_b32 v162, 16, v67
v_and_b32 v163, s90, v67
v_pk_add_f32 v[184:185], v[156:157], v[158:159]
v_pk_mul_f32 v[186:187], v[156:157], v[156:157]
v_pk_add_f32 v[64:65], v[160:161], v[162:163]
v_pk_fma_f32 v[186:187], v[158:159], v[158:159], v[186:187]
v_pk_add_f32 v[184:185], v[184:185], v[64:65]
v_pk_fma_f32 v[186:187], v[160:161], v[160:161], v[186:187]
v_add_f32 v184, v184, v185
v_pk_fma_f32 v[186:187], v[162:163], v[162:163], v[186:187]
v_add_f32 v186, v186, v187
v_permlane16_swap_b32 v164, v166
v_permlane16_swap_b32 v168, v170
v_permlane16_swap_b32 v172, v174
v_permlane16_swap_b32 v176, v178
v_permlane16_swap_b32 v180, v182
v_permlane16_swap_b32 v184, v186
v_add_f32 v164, v164, v166
v_add_f32 v168, v168, v170
v_add_f32 v172, v172, v174
v_add_f32 v176, v176, v178
v_add_f32 v180, v180, v182
v_add_f32 v184, v184, v186
v_add_f32_dpp v165, v164, v164 row_ror:8 row_mask:0xf bank_mask:0x3
v_add_f32_dpp v165, v168, v168 row_ror:8 row_mask:0xf bank_mask:0xc
v_add_f32_dpp v173, v172, v172 row_ror:8 row_mask:0xf bank_mask:0x3
v_add_f32_dpp v173, v176, v176 row_ror:8 row_mask:0xf bank_mask:0xc
v_add_f32_dpp v181, v180, v180 row_ror:8 row_mask:0xf bank_mask:0x3
v_add_f32_dpp v181, v184, v184 row_ror:8 row_mask:0xf bank_mask:0xc
v_add_f32_dpp v166, v165, v165 row_half_mirror row_mask:0xf bank_mask:0x5
v_add_f32_dpp v166, v173, v173 row_half_mirror row_mask:0xf bank_mask:0xa
v_add_f32_dpp v182, v181, v181 row_half_mirror row_mask:0xf bank_mask:0xf
s_nop 0
v_add_f32_dpp v166, v166, v166 quad_perm:[1,0,3,2] row_mask:0xf bank_mask:0xf
v_add_f32_dpp v182, v182, v182 quad_perm:[1,0,3,2] row_mask:0xf bank_mask:0xf
s_nop 0
v_add_f32_dpp v166, v166, v166 quad_perm:[2,3,0,1] row_mask:0xf bank_mask:0xf
v_add_f32_dpp v182, v182, v182 quad_perm:[2,3,0,1] row_mask:0xf bank_mask:0xf
v_mov_b32 v167, v166
v_mov_b32 v183, v182
s_nop 0
v_permlane16_swap_b32 v167, v166
v_permlane16_swap_b32 v183, v182
v_mul_f32 v167, s89, v167
v_mul_f32 v183, s89, v183
v_mul_f32 v166, s89, v166
v_mul_f32 v182, s89, v182
v_fma_f32 v166, -v167, v167, v166
v_fma_f32 v182, -v183, v183, v182
v_cvt_pk_bf16_f32 v167, v167, v167
v_cvt_pk_bf16_f32 v183, v183, v183
v_max_f32 v166, 0, v166
v_max_f32 v182, 0, v182
v_cvt_pk_bf16_f32 v166, v166, v166
v_cvt_pk_bf16_f32 v182, v182, v182
v_and_b32 v166, s90, v166
v_and_b32 v182, s90, v182
v_add_f32 v166, s88, v166
v_add_f32 v182, s88, v182
v_cvt_pk_bf16_f32 v166, v166, v166
v_cvt_pk_bf16_f32 v182, v182, v182
v_and_b32 v166, s90, v166
v_and_b32 v182, s90, v182
v_sqrt_f32 v166, v166
v_sqrt_f32 v182, v182
v_and_b32 v167, s90, v167
v_and_b32 v183, s90, v183
v_cvt_pk_bf16_f32 v166, v166, v166
v_cvt_pk_bf16_f32 v182, v182, v182
v_and_b32 v166, s90, v166
v_and_b32 v182, s90, v182
v_rcp_f32 v166, v166
v_rcp_f32 v182, v182
v_mul_f32 v167, -v167, v166
v_mul_f32 v183, -v183, v182
s_nop 0
v_mov_b64_dpp v[164:165], v[166:167] row_newbcast:0 row_mask:0xf bank_mask:0xf
v_mov_b64_dpp v[168:169], v[166:167] row_newbcast:8 row_mask:0xf bank_mask:0xf
v_mov_b64_dpp v[172:173], v[166:167] row_newbcast:4 row_mask:0xf bank_mask:0xf
v_mov_b64_dpp v[176:177], v[166:167] row_newbcast:12 row_mask:0xf bank_mask:0xf
v_mov_b64_dpp v[180:181], v[182:183] row_newbcast:0 row_mask:0xf bank_mask:0xf
v_mov_b64_dpp v[184:185], v[182:183] row_newbcast:8 row_mask:0xf bank_mask:0xf
v_fma_f32 v116, v116, v164, v165
v_fma_f32 v117, v117, v164, v165
v_fma_f32 v118, v118, v164, v165
v_fma_f32 v119, v119, v164, v165
v_fma_f32 v120, v120, v164, v165
v_fma_f32 v121, v121, v164, v165
v_fma_f32 v122, v122, v164, v165
v_fma_f32 v123, v123, v164, v165
v_cvt_pk_bf16_f32 v44, v116, v117
v_cvt_pk_bf16_f32 v45, v118, v119
v_cvt_pk_bf16_f32 v46, v120, v121
v_cvt_pk_bf16_f32 v47, v122, v123
ds_write_b128 v36, v[44:47]
v_fma_f32 v124, v124, v168, v169
v_fma_f32 v125, v125, v168, v169
v_fma_f32 v126, v126, v168, v169
v_fma_f32 v127, v127, v168, v169
v_fma_f32 v128, v128, v168, v169
v_fma_f32 v129, v129, v168, v169
v_fma_f32 v130, v130, v168, v169
v_fma_f32 v131, v131, v168, v169
v_cvt_pk_bf16_f32 v48, v124, v125
v_cvt_pk_bf16_f32 v49, v126, v127
v_cvt_pk_bf16_f32 v50, v128, v129
v_cvt_pk_bf16_f32 v51, v130, v131
ds_write_b128 v37, v[48:51]
v_fma_f32 v132, v132, v172, v173
v_fma_f32 v133, v133, v172, v173
v_fma_f32 v134, v134, v172, v173
v_fma_f32 v135, v135, v172, v173
v_fma_f32 v136, v136, v172, v173
v_fma_f32 v137, v137, v172, v173
v_fma_f32 v138, v138, v172, v173
v_fma_f32 v139, v139, v172, v173
v_cvt_pk_bf16_f32 v52, v132, v133
v_cvt_pk_bf16_f32 v53, v134, v135
v_cvt_pk_bf16_f32 v54, v136, v137
v_cvt_pk_bf16_f32 v55, v138, v139
ds_write_b128 v38, v[52:55]
v_fma_f32 v140, v140, v176, v177
v_fma_f32 v141, v141, v176, v177
v_fma_f32 v142, v142, v176, v177
v_fma_f32 v143, v143, v176, v177
v_fma_f32 v144, v144, v176, v177
v_fma_f32 v145, v145, v176, v177
v_fma_f32 v146, v146, v176, v177
v_fma_f32 v147, v147, v176, v177
v_cvt_pk_bf16_f32 v56, v140, v141
v_cvt_pk_bf16_f32 v57, v142, v143
v_cvt_pk_bf16_f32 v58, v144, v145
v_cvt_pk_bf16_f32 v59, v146, v147
ds_write_b128 v39, v[56:59]
v_fma_f32 v148, v148, v180, v181
v_fma_f32 v149, v149, v180, v181
v_fma_f32 v150, v150, v180, v181
v_fma_f32 v151, v151, v180, v181
v_fma_f32 v152, v152, v180, v181
v_fma_f32 v153, v153, v180, v181
v_fma_f32 v154, v154, v180, v181
v_fma_f32 v155, v155, v180, v181
v_cvt_pk_bf16_f32 v60, v148, v149
v_cvt_pk_bf16_f32 v61, v150, v151
v_cvt_pk_bf16_f32 v62, v152, v153
v_cvt_pk_bf16_f32 v63, v154, v155
ds_write_b128 v40, v[60:63]
v_fma_f32 v156, v156, v184, v185
v_fma_f32 v157, v157, v184, v185
v_fma_f32 v158, v158, v184, v185
v_fma_f32 v159, v159, v184, v185
v_fma_f32 v160, v160, v184, v185
v_fma_f32 v161, v161, v184, v185
v_fma_f32 v162, v162, v184, v185
v_fma_f32 v163, v163, v184, v185
v_cvt_pk_bf16_f32 v64, v156, v157
v_cvt_pk_bf16_f32 v65, v158, v159
v_cvt_pk_bf16_f32 v66, v160, v161
v_cvt_pk_bf16_f32 v67, v162, v163
ds_write_b128 v41, v[64:67]
s_add_u32 m0, s63, 0x2000
s_nop 0
buffer_load_dwordx4 v17, s[44:47], s68 offen offset:0 lds
buffer_load_dwordx4 v18, s[44:47], s68 offen offset:1024 lds
buffer_load_dwordx4 v19, s[44:47], s68 offen offset:2048 lds
buffer_load_dwordx4 v20, s[44:47], s68 offen offset:3072 lds
s_waitcnt vmcnt(8)
ds_read_b64_tr_b16 v[164:165], v25 offset:0
ds_read_b64_tr_b16 v[166:167], v25 offset:512
ds_read_b64_tr_b16 v[168:169], v26 offset:0
ds_read_b64_tr_b16 v[170:171], v26 offset:512
ds_read_b64_tr_b16 v[172:173], v27 offset:0
ds_read_b64_tr_b16 v[174:175], v27 offset:512
s_waitcnt lgkmcnt(6)
s_barrier
ds_read_b128 v[204:207], v31 offset:0
ds_read_b128 v[208:211], v31 offset:8192
ds_read_b128 v[212:215], v31 offset:16384
s_waitcnt lgkmcnt(2)
v_mfma_f32_16x16x32_bf16 v[68:71], v[164:167], v[204:207], 0
s_waitcnt lgkmcnt(1)
v_mfma_f32_16x16x32_bf16 v[72:75], v[164:167], v[208:211], 0
s_waitcnt lgkmcnt(0)
v_mfma_f32_16x16x32_bf16 v[76:79], v[164:167], v[212:215], 0
ds_read_b64_tr_b16 v[176:177], v28 offset:0
ds_read_b64_tr_b16 v[178:179], v28 offset:512
v_mfma_f32_16x16x32_bf16 v[80:83], v[168:171], v[204:207], 0
v_mfma_f32_16x16x32_bf16 v[84:87], v[168:171], v[208:211], 0
v_mfma_f32_16x16x32_bf16 v[88:91], v[168:171], v[212:215], 0
ds_read_b128 v[216:219], v32 offset:1024
s_waitcnt vmcnt(4)
ds_read_b64_tr_b16 v[180:181], v25 offset:4096
ds_read_b64_tr_b16 v[182:183], v25 offset:4608
v_mfma_f32_16x16x32_bf16 v[92:95], v[172:175], v[204:207], 0
ds_read_b128 v[220:223], v32 offset:9216
v_mfma_f32_16x16x32_bf16 v[96:99], v[172:175], v[208:211], 0
ds_read_b128 v[224:227], v32 offset:17408
v_mfma_f32_16x16x32_bf16 v[100:103], v[172:175], v[212:215], 0
ds_read_b64_tr_b16 v[184:185], v26 offset:4096
ds_read_b64_tr_b16 v[186:187], v26 offset:4608
s_waitcnt lgkmcnt(7)
v_mfma_f32_16x16x32_bf16 v[104:107], v[176:179], v[204:207], 0
s_add_u32 m0, s63, 0x0
s_nop 0
buffer_load_dwordx4 v17, s[44:47], s69 offen offset:0 lds
buffer_load_dwordx4 v18, s[44:47], s69 offen offset:1024 lds
buffer_load_dwordx4 v19, s[44:47], s69 offen offset:2048 lds
buffer_load_dwordx4 v20, s[44:47], s69 offen offset:3072 lds
v_mfma_f32_16x16x32_bf16 v[108:111], v[176:179], v[208:211], 0
v_mfma_f32_16x16x32_bf16 v[112:115], v[176:179], v[212:215], 0
ds_read_b64_tr_b16 v[188:189], v27 offset:4096
ds_read_b64_tr_b16 v[190:191], v27 offset:4608
s_waitcnt lgkmcnt(6)
v_mfma_f32_16x16x32_bf16 v[68:71], v[180:183], v[216:219], v[68:71]
s_waitcnt lgkmcnt(5)
v_mfma_f32_16x16x32_bf16 v[72:75], v[180:183], v[220:223], v[72:75]
s_waitcnt lgkmcnt(4)
v_mfma_f32_16x16x32_bf16 v[76:79], v[180:183], v[224:227], v[76:79]
ds_read_b64_tr_b16 v[192:193], v28 offset:4096
ds_read_b64_tr_b16 v[194:195], v28 offset:4608
s_waitcnt lgkmcnt(4)
v_mfma_f32_16x16x32_bf16 v[80:83], v[184:187], v[216:219], v[80:83]
v_mfma_f32_16x16x32_bf16 v[84:87], v[184:187], v[220:223], v[84:87]
v_mfma_f32_16x16x32_bf16 v[88:91], v[184:187], v[224:227], v[88:91]
ds_read_b128 v[228:231], v31 offset:2048
s_waitcnt vmcnt(4)
ds_read_b64_tr_b16 v[196:197], v25 offset:8192
ds_read_b64_tr_b16 v[198:199], v25 offset:8704
s_waitcnt lgkmcnt(5)
v_mfma_f32_16x16x32_bf16 v[92:95], v[188:191], v[216:219], v[92:95]
ds_read_b128 v[232:235], v31 offset:10240
v_mfma_f32_16x16x32_bf16 v[96:99], v[188:191], v[220:223], v[96:99]
ds_read_b128 v[236:239], v31 offset:18432
v_mfma_f32_16x16x32_bf16 v[100:103], v[188:191], v[224:227], v[100:103]
ds_read_b64_tr_b16 v[200:201], v26 offset:8192
ds_read_b64_tr_b16 v[202:203], v26 offset:8704
s_waitcnt lgkmcnt(7)
v_mfma_f32_16x16x32_bf16 v[104:107], v[192:195], v[216:219], v[104:107]
s_add_u32 m0, s63, 0x1000
s_nop 0
buffer_load_dwordx4 v17, s[44:47], s70 offen offset:0 lds
buffer_load_dwordx4 v18, s[44:47], s70 offen offset:1024 lds
buffer_load_dwordx4 v19, s[44:47], s70 offen offset:2048 lds
buffer_load_dwordx4 v20, s[44:47], s70 offen offset:3072 lds
v_mfma_f32_16x16x32_bf16 v[108:111], v[192:195], v[220:223], v[108:111]
v_mfma_f32_16x16x32_bf16 v[112:115], v[192:195], v[224:227], v[112:115]
ds_read_b64_tr_b16 v[164:165], v27 offset:8192
ds_read_b64_tr_b16 v[166:167], v27 offset:8704
s_waitcnt lgkmcnt(6)
v_mfma_f32_16x16x32_bf16 v[68:71], v[196:199], v[228:231], v[68:71]
s_waitcnt lgkmcnt(5)
v_mfma_f32_16x16x32_bf16 v[72:75], v[196:199], v[232:235], v[72:75]
s_waitcnt lgkmcnt(4)
v_mfma_f32_16x16x32_bf16 v[76:79], v[196:199], v[236:239], v[76:79]
ds_read_b64_tr_b16 v[168:169], v28 offset:8192
ds_read_b64_tr_b16 v[170:171], v28 offset:8704
s_waitcnt lgkmcnt(4)
v_mfma_f32_16x16x32_bf16 v[80:83], v[200:203], v[228:231], v[80:83]
v_mfma_f32_16x16x32_bf16 v[84:87], v[200:203], v[232:235], v[84:87]
v_mfma_f32_16x16x32_bf16 v[88:91], v[200:203], v[236:239], v[88:91]
ds_read_b128 v[204:207], v32 offset:3072
s_waitcnt vmcnt(4)
ds_read_b64_tr_b16 v[172:173], v25 offset:0
ds_read_b64_tr_b16 v[174:175], v25 offset:512
s_waitcnt lgkmcnt(5)
v_mfma_f32_16x16x32_bf16 v[92:95], v[164:167], v[228:231], v[92:95]
ds_read_b128 v[208:211], v32 offset:11264
v_mfma_f32_16x16x32_bf16 v[96:99], v[164:167], v[232:235], v[96:99]
ds_read_b128 v[212:215], v32 offset:19456
v_mfma_f32_16x16x32_bf16 v[100:103], v[164:167], v[236:239], v[100:103]
ds_read_b64_tr_b16 v[176:177], v26 offset:0
ds_read_b64_tr_b16 v[178:179], v26 offset:512
s_waitcnt lgkmcnt(7)
v_mfma_f32_16x16x32_bf16 v[104:107], v[168:171], v[228:231], v[104:107]
s_add_u32 m0, s63, 0x2000
s_nop 0
buffer_load_dwordx4 v17, s[44:47], s71 offen offset:0 lds
buffer_load_dwordx4 v18, s[44:47], s71 offen offset:1024 lds
buffer_load_dwordx4 v19, s[44:47], s71 offen offset:2048 lds
buffer_load_dwordx4 v20, s[44:47], s71 offen offset:3072 lds
v_mfma_f32_16x16x32_bf16 v[108:111], v[168:171], v[232:235], v[108:111]
v_mfma_f32_16x16x32_bf16 v[112:115], v[168:171], v[236:239], v[112:115]
ds_read_b64_tr_b16 v[180:181], v27 offset:0
ds_read_b64_tr_b16 v[182:183], v27 offset:512
s_waitcnt lgkmcnt(6)
v_mfma_f32_16x16x32_bf16 v[68:71], v[172:175], v[204:207], v[68:71]
s_waitcnt lgkmcnt(5)
v_mfma_f32_16x16x32_bf16 v[72:75], v[172:175], v[208:211], v[72:75]
s_waitcnt lgkmcnt(4)
v_mfma_f32_16x16x32_bf16 v[76:79], v[172:175], v[212:215], v[76:79]
ds_read_b64_tr_b16 v[184:185], v28 offset:0
ds_read_b64_tr_b16 v[186:187], v28 offset:512
s_waitcnt lgkmcnt(4)
v_mfma_f32_16x16x32_bf16 v[80:83], v[176:179], v[204:207], v[80:83]
v_mfma_f32_16x16x32_bf16 v[84:87], v[176:179], v[208:211], v[84:87]
v_mfma_f32_16x16x32_bf16 v[88:91], v[176:179], v[212:215], v[88:91]
ds_read_b128 v[216:219], v31 offset:4096
s_waitcnt vmcnt(4)
ds_read_b64_tr_b16 v[188:189], v25 offset:4096
ds_read_b64_tr_b16 v[190:191], v25 offset:4608
s_waitcnt lgkmcnt(5)
v_mfma_f32_16x16x32_bf16 v[92:95], v[180:183], v[204:207], v[92:95]
ds_read_b128 v[220:223], v31 offset:12288
v_mfma_f32_16x16x32_bf16 v[96:99], v[180:183], v[208:211], v[96:99]
ds_read_b128 v[224:227], v31 offset:20480
v_mfma_f32_16x16x32_bf16 v[100:103], v[180:183], v[212:215], v[100:103]
ds_read_b64_tr_b16 v[192:193], v26 offset:4096
ds_read_b64_tr_b16 v[194:195], v26 offset:4608
s_waitcnt lgkmcnt(7)
v_mfma_f32_16x16x32_bf16 v[104:107], v[184:187], v[204:207], v[104:107]
s_add_u32 m0, s63, 0x0
s_nop 0
buffer_load_dwordx4 v17, s[44:47], s72 offen offset:0 lds
buffer_load_dwordx4 v18, s[44:47], s72 offen offset:1024 lds
buffer_load_dwordx4 v19, s[44:47], s72 offen offset:2048 lds
buffer_load_dwordx4 v20, s[44:47], s72 offen offset:3072 lds
v_mfma_f32_16x16x32_bf16 v[108:111], v[184:187], v[208:211], v[108:111]
v_mfma_f32_16x16x32_bf16 v[112:115], v[184:187], v[212:215], v[112:115]
ds_read_b64_tr_b16 v[196:197], v27 offset:4096
ds_read_b64_tr_b16 v[198:199], v27 offset:4608
s_waitcnt lgkmcnt(6)
v_mfma_f32_16x16x32_bf16 v[68:71], v[188:191], v[216:219], v[68:71]
s_waitcnt lgkmcnt(5)
v_mfma_f32_16x16x32_bf16 v[72:75], v[188:191], v[220:223], v[72:75]
s_waitcnt lgkmcnt(4)
v_mfma_f32_16x16x32_bf16 v[76:79], v[188:191], v[224:227], v[76:79]
ds_read_b64_tr_b16 v[200:201], v28 offset:4096
ds_read_b64_tr_b16 v[202:203], v28 offset:4608
s_waitcnt lgkmcnt(4)
v_mfma_f32_16x16x32_bf16 v[80:83], v[192:195], v[216:219], v[80:83]
v_mfma_f32_16x16x32_bf16 v[84:87], v[192:195], v[220:223], v[84:87]
v_mfma_f32_16x16x32_bf16 v[88:91], v[192:195], v[224:227], v[88:91]
ds_read_b128 v[228:231], v32 offset:5120
s_waitcnt vmcnt(4)
ds_read_b64_tr_b16 v[164:165], v25 offset:8192
ds_read_b64_tr_b16 v[166:167], v25 offset:8704
s_waitcnt lgkmcnt(5)
v_mfma_f32_16x16x32_bf16 v[92:95], v[196:199], v[216:219], v[92:95]
ds_read_b128 v[232:235], v32 offset:13312
v_mfma_f32_16x16x32_bf16 v[96:99], v[196:199], v[220:223], v[96:99]
ds_read_b128 v[236:239], v32 offset:21504
v_mfma_f32_16x16x32_bf16 v[100:103], v[196:199], v[224:227], v[100:103]
ds_read_b64_tr_b16 v[168:169], v26 offset:8192
ds_read_b64_tr_b16 v[170:171], v26 offset:8704
s_waitcnt lgkmcnt(7)
v_mfma_f32_16x16x32_bf16 v[104:107], v[200:203], v[216:219], v[104:107]
s_add_u32 m0, s63, 0x1000
s_nop 0
buffer_load_dwordx4 v17, s[44:47], s73 offen offset:0 lds
buffer_load_dwordx4 v18, s[44:47], s73 offen offset:1024 lds
buffer_load_dwordx4 v19, s[44:47], s73 offen offset:2048 lds
buffer_load_dwordx4 v20, s[44:47], s73 offen offset:3072 lds
v_mfma_f32_16x16x32_bf16 v[108:111], v[200:203], v[220:223], v[108:111]
v_mfma_f32_16x16x32_bf16 v[112:115], v[200:203], v[224:227], v[112:115]
ds_read_b64_tr_b16 v[172:173], v27 offset:8192
ds_read_b64_tr_b16 v[174:175], v27 offset:8704
s_waitcnt lgkmcnt(6)
v_mfma_f32_16x16x32_bf16 v[68:71], v[164:167], v[228:231], v[68:71]
s_waitcnt lgkmcnt(5)
v_mfma_f32_16x16x32_bf16 v[72:75], v[164:167], v[232:235], v[72:75]
s_waitcnt lgkmcnt(4)
v_mfma_f32_16x16x32_bf16 v[76:79], v[164:167], v[236:239], v[76:79]
ds_read_b64_tr_b16 v[176:177], v28 offset:8192
ds_read_b64_tr_b16 v[178:179], v28 offset:8704
s_waitcnt lgkmcnt(4)
v_mfma_f32_16x16x32_bf16 v[80:83], v[168:171], v[228:231], v[80:83]
v_mfma_f32_16x16x32_bf16 v[84:87], v[168:171], v[232:235], v[84:87]
v_mfma_f32_16x16x32_bf16 v[88:91], v[168:171], v[236:239], v[88:91]
ds_read_b128 v[204:207], v31 offset:6144
s_waitcnt vmcnt(4)
ds_read_b64_tr_b16 v[180:181], v25 offset:0
ds_read_b64_tr_b16 v[182:183], v25 offset:512
s_waitcnt lgkmcnt(5)
v_mfma_f32_16x16x32_bf16 v[92:95], v[172:175], v[228:231], v[92:95]
ds_read_b128 v[208:211], v31 offset:14336
v_mfma_f32_16x16x32_bf16 v[96:99], v[172:175], v[232:235], v[96:99]
ds_read_b128 v[212:215], v31 offset:22528
v_mfma_f32_16x16x32_bf16 v[100:103], v[172:175], v[236:239], v[100:103]
ds_read_b64_tr_b16 v[184:185], v26 offset:0
ds_read_b64_tr_b16 v[186:187], v26 offset:512
s_waitcnt lgkmcnt(7)
v_mfma_f32_16x16x32_bf16 v[104:107], v[176:179], v[228:231], v[104:107]
s_add_u32 m0, s63, 0x2000
s_nop 0
buffer_load_dwordx4 v21, s[48:51], s74 offen offset:0 lds
buffer_load_dwordx4 v22, s[48:51], s74 offen offset:1024 lds
buffer_load_dwordx4 v23, s[48:51], s74 offen offset:2048 lds
buffer_load_dwordx4 v24, s[48:51], s74 offen offset:3072 lds
v_mfma_f32_16x16x32_bf16 v[108:111], v[176:179], v[232:235], v[108:111]
v_mfma_f32_16x16x32_bf16 v[112:115], v[176:179], v[236:239], v[112:115]
ds_read_b64_tr_b16 v[188:189], v27 offset:0
ds_read_b64_tr_b16 v[190:191], v27 offset:512
s_waitcnt lgkmcnt(6)
v_mfma_f32_16x16x32_bf16 v[68:71], v[180:183], v[204:207], v[68:71]
s_waitcnt lgkmcnt(5)
v_mfma_f32_16x16x32_bf16 v[72:75], v[180:183], v[208:211], v[72:75]
s_waitcnt lgkmcnt(4)
v_mfma_f32_16x16x32_bf16 v[76:79], v[180:183], v[212:215], v[76:79]
ds_read_b64_tr_b16 v[192:193], v28 offset:0
ds_read_b64_tr_b16 v[194:195], v28 offset:512
s_waitcnt lgkmcnt(4)
v_mfma_f32_16x16x32_bf16 v[80:83], v[184:187], v[204:207], v[80:83]
v_mfma_f32_16x16x32_bf16 v[84:87], v[184:187], v[208:211], v[84:87]
v_mfma_f32_16x16x32_bf16 v[88:91], v[184:187], v[212:215], v[88:91]
ds_read_b128 v[216:219], v32 offset:7168
s_waitcnt vmcnt(4)
ds_read_b64_tr_b16 v[196:197], v25 offset:4096
ds_read_b64_tr_b16 v[198:199], v25 offset:4608
s_waitcnt lgkmcnt(5)
v_mfma_f32_16x16x32_bf16 v[92:95], v[188:191], v[204:207], v[92:95]
ds_read_b128 v[220:223], v32 offset:15360
v_mfma_f32_16x16x32_bf16 v[96:99], v[188:191], v[208:211], v[96:99]
ds_read_b128 v[224:227], v32 offset:23552
v_mfma_f32_16x16x32_bf16 v[100:103], v[188:191], v[212:215], v[100:103]
ds_read_b64_tr_b16 v[200:201], v26 offset:4096
ds_read_b64_tr_b16 v[202:203], v26 offset:4608
s_waitcnt lgkmcnt(7)
v_mfma_f32_16x16x32_bf16 v[104:107], v[192:195], v[204:207], v[104:107]
s_add_u32 m0, s63, 0x0
s_nop 0
buffer_load_dwordx4 v21, s[48:51], s75 offen offset:0 lds
buffer_load_dwordx4 v22, s[48:51], s75 offen offset:1024 lds
buffer_load_dwordx4 v23, s[48:51], s75 offen offset:2048 lds
buffer_load_dwordx4 v24, s[48:51], s75 offen offset:3072 lds
v_mfma_f32_16x16x32_bf16 v[108:111], v[192:195], v[208:211], v[108:111]
v_mfma_f32_16x16x32_bf16 v[112:115], v[192:195], v[212:215], v[112:115]
ds_read_b64_tr_b16 v[164:165], v27 offset:4096
ds_read_b64_tr_b16 v[166:167], v27 offset:4608
s_waitcnt lgkmcnt(6)
v_mfma_f32_16x16x32_bf16 v[68:71], v[196:199], v[216:219], v[68:71]
s_waitcnt lgkmcnt(5)
v_mfma_f32_16x16x32_bf16 v[72:75], v[196:199], v[220:223], v[72:75]
s_waitcnt lgkmcnt(4)
v_mfma_f32_16x16x32_bf16 v[76:79], v[196:199], v[224:227], v[76:79]
ds_read_b64_tr_b16 v[168:169], v28 offset:4096
ds_read_b64_tr_b16 v[170:171], v28 offset:4608
s_waitcnt lgkmcnt(4)
v_mfma_f32_16x16x32_bf16 v[80:83], v[200:203], v[216:219], v[80:83]
v_cvt_pk_bf16_f32 v68, v68, v69
v_cvt_pk_bf16_f32 v69, v70, v71
ds_write_b64 v33, v[68:69] offset:0
v_mfma_f32_16x16x32_bf16 v[84:87], v[200:203], v[220:223], v[84:87]
v_cvt_pk_bf16_f32 v72, v72, v73
v_cvt_pk_bf16_f32 v73, v74, v75
ds_write_b64 v33, v[72:73] offset:8192
v_mfma_f32_16x16x32_bf16 v[88:91], v[200:203], v[224:227], v[88:91]
v_cvt_pk_bf16_f32 v76, v76, v77
v_cvt_pk_bf16_f32 v77, v78, v79
ds_write_b64 v33, v[76:77] offset:16384
s_waitcnt lgkmcnt(5)
v_mfma_f32_16x16x32_bf16 v[92:95], v[164:167], v[216:219], v[92:95]
v_cvt_pk_bf16_f32 v80, v80, v81
v_cvt_pk_bf16_f32 v81, v82, v83
ds_write_b64 v33, v[80:81] offset:512
v_mfma_f32_16x16x32_bf16 v[96:99], v[164:167], v[220:223], v[96:99]
v_cvt_pk_bf16_f32 v84, v84, v85
v_cvt_pk_bf16_f32 v85, v86, v87
ds_write_b64 v33, v[84:85] offset:8704
v_mfma_f32_16x16x32_bf16 v[100:103], v[164:167], v[224:227], v[100:103]
v_cvt_pk_bf16_f32 v88, v88, v89
v_cvt_pk_bf16_f32 v89, v90, v91
ds_write_b64 v33, v[88:89] offset:16896
s_waitcnt lgkmcnt(6)
v_mfma_f32_16x16x32_bf16 v[104:107], v[168:171], v[216:219], v[104:107]
v_cvt_pk_bf16_f32 v92, v92, v93
v_cvt_pk_bf16_f32 v93, v94, v95
ds_write_b64 v34, v[92:93] offset:0
s_add_u32 m0, s63, 0x1000
s_nop 0
buffer_load_dwordx4 v21, s[48:51], s76 offen offset:0 lds
buffer_load_dwordx4 v22, s[48:51], s76 offen offset:1024 lds
buffer_load_dwordx4 v23, s[48:51], s76 offen offset:2048 lds
buffer_load_dwordx4 v24, s[48:51], s76 offen offset:3072 lds
v_mfma_f32_16x16x32_bf16 v[108:111], v[168:171], v[220:223], v[108:111]
v_cvt_pk_bf16_f32 v96, v96, v97
v_cvt_pk_bf16_f32 v97, v98, v99
ds_write_b64 v34, v[96:97] offset:8192
v_mfma_f32_16x16x32_bf16 v[112:115], v[168:171], v[224:227], v[112:115]
v_cvt_pk_bf16_f32 v100, v100, v101
v_cvt_pk_bf16_f32 v101, v102, v103
ds_write_b64 v34, v[100:101] offset:16384
v_cvt_pk_bf16_f32 v104, v104, v105
v_cvt_pk_bf16_f32 v105, v106, v107
ds_write_b64 v34, v[104:105] offset:512
v_cvt_pk_bf16_f32 v108, v108, v109
v_cvt_pk_bf16_f32 v109, v110, v111
ds_write_b64 v34, v[108:109] offset:8704
v_cvt_pk_bf16_f32 v112, v112, v113
v_cvt_pk_bf16_f32 v113, v114, v115
ds_write_b64 v34, v[112:113] offset:16896
s_waitcnt vmcnt(8)
ds_read_b128 v[172:175], v29 offset:8192
ds_read_b128 v[176:179], v30 offset:8192
ds_read_b128 v[180:183], v29 offset:10240
s_waitcnt lgkmcnt(3)
s_barrier
ds_read_b128 v[228:231], v35 offset:0
ds_read_b128 v[232:235], v35 offset:8192
ds_read_b128 v[236:239], v35 offset:16384
ds_read_b128 v[204:207], v35 offset:1024
ds_read_b128 v[208:211], v35 offset:9216
ds_read_b128 v[212:215], v35 offset:17408
s_waitcnt lgkmcnt(5)
v_mfma_f32_16x16x32_bf16 v[116:119], v[172:175], v[228:231], 0
s_waitcnt lgkmcnt(4)
v_mfma_f32_16x16x32_bf16 v[132:135], v[172:175], v[232:235], 0
s_waitcnt lgkmcnt(3)
v_mfma_f32_16x16x32_bf16 v[148:151], v[172:175], v[236:239], 0
ds_read_b128 v[184:187], v30 offset:10240
s_waitcnt lgkmcnt(3)
v_mfma_f32_16x16x32_bf16 v[116:119], v[176:179], v[204:207], v[116:119]
s_waitcnt lgkmcnt(2)
v_mfma_f32_16x16x32_bf16 v[132:135], v[176:179], v[208:211], v[132:135]
s_waitcnt lgkmcnt(1)
v_mfma_f32_16x16x32_bf16 v[148:151], v[176:179], v[212:215], v[148:151]
s_waitcnt vmcnt(4)
ds_read_b128 v[188:191], v29 offset:0
v_mfma_f32_16x16x32_bf16 v[120:123], v[180:183], v[228:231], 0
v_mfma_f32_16x16x32_bf16 v[136:139], v[180:183], v[232:235], 0
v_mfma_f32_16x16x32_bf16 v[152:155], v[180:183], v[236:239], 0
ds_read_b128 v[192:195], v30 offset:0
s_waitcnt lgkmcnt(2)
v_mfma_f32_16x16x32_bf16 v[120:123], v[184:187], v[204:207], v[120:123]
s_add_u32 m0, s63, 0x2000
s_nop 0
buffer_load_dwordx4 v21, s[48:51], s77 offen offset:0 lds
buffer_load_dwordx4 v22, s[48:51], s77 offen offset:1024 lds
buffer_load_dwordx4 v23, s[48:51], s77 offen offset:2048 lds
buffer_load_dwordx4 v24, s[48:51], s77 offen offset:3072 lds
v_mfma_f32_16x16x32_bf16 v[136:139], v[184:187], v[208:211], v[136:139]
v_mfma_f32_16x16x32_bf16 v[152:155], v[184:187], v[212:215], v[152:155]
ds_read_b128 v[196:199], v29 offset:2048
s_waitcnt lgkmcnt(2)
v_mfma_f32_16x16x32_bf16 v[124:127], v[188:191], v[228:231], 0
v_mfma_f32_16x16x32_bf16 v[140:143], v[188:191], v[232:235], 0
v_mfma_f32_16x16x32_bf16 v[156:159], v[188:191], v[236:239], 0
ds_read_b128 v[200:203], v30 offset:2048
s_waitcnt lgkmcnt(2)
v_mfma_f32_16x16x32_bf16 v[124:127], v[192:195], v[204:207], v[124:127]
v_mfma_f32_16x16x32_bf16 v[140:143], v[192:195], v[208:211], v[140:143]
v_mfma_f32_16x16x32_bf16 v[156:159], v[192:195], v[212:215], v[156:159]
ds_read_b128 v[216:219], v35 offset:2048
s_waitcnt vmcnt(4)
ds_read_b128 v[164:167], v29 offset:4096
s_waitcnt lgkmcnt(3)
v_mfma_f32_16x16x32_bf16 v[128:131], v[196:199], v[228:231], 0
ds_read_b128 v[220:223], v35 offset:10240
v_mfma_f32_16x16x32_bf16 v[144:147], v[196:199], v[232:235], 0
ds_read_b128 v[224:227], v35 offset:18432
v_mfma_f32_16x16x32_bf16 v[160:163], v[196:199], v[236:239], 0
ds_read_b128 v[228:231], v35 offset:3072
ds_read_b128 v[168:171], v30 offset:4096
s_waitcnt lgkmcnt(6)
v_mfma_f32_16x16x32_bf16 v[128:131], v[200:203], v[204:207], v[128:131]
ds_read_b128 v[232:235], v35 offset:11264
s_add_u32 m0, s63, 0x0
s_nop 0
buffer_load_dwordx4 v21, s[48:51], s78 offen offset:0 lds
buffer_load_dwordx4 v22, s[48:51], s78 offen offset:1024 lds
buffer_load_dwordx4 v23, s[48:51], s78 offen offset:2048 lds
buffer_load_dwordx4 v24, s[48:51], s78 offen offset:3072 lds
v_mfma_f32_16x16x32_bf16 v[144:147], v[200:203], v[208:211], v[144:147]
ds_read_b128 v[236:239], v35 offset:19456
v_mfma_f32_16x16x32_bf16 v[160:163], v[200:203], v[212:215], v[160:163]
ds_read_b128 v[172:175], v29 offset:6144
s_waitcnt lgkmcnt(7)
v_mfma_f32_16x16x32_bf16 v[116:119], v[164:167], v[216:219], v[116:119]
s_waitcnt lgkmcnt(6)
v_mfma_f32_16x16x32_bf16 v[132:135], v[164:167], v[220:223], v[132:135]
s_waitcnt lgkmcnt(5)
v_mfma_f32_16x16x32_bf16 v[148:151], v[164:167], v[224:227], v[148:151]
ds_read_b128 v[176:179], v30 offset:6144
s_waitcnt lgkmcnt(4)
v_mfma_f32_16x16x32_bf16 v[116:119], v[168:171], v[228:231], v[116:119]
s_waitcnt lgkmcnt(3)
v_mfma_f32_16x16x32_bf16 v[132:135], v[168:171], v[232:235], v[132:135]
s_waitcnt lgkmcnt(2)
v_mfma_f32_16x16x32_bf16 v[148:151], v[168:171], v[236:239], v[148:151]
s_waitcnt vmcnt(4)
ds_read_b128 v[180:183], v29 offset:8192
s_waitcnt lgkmcnt(2)
v_mfma_f32_16x16x32_bf16 v[120:123], v[172:175], v[216:219], v[120:123]
v_mfma_f32_16x16x32_bf16 v[136:139], v[172:175], v[220:223], v[136:139]
v_mfma_f32_16x16x32_bf16 v[152:155], v[172:175], v[224:227], v[152:155]
ds_read_b128 v[184:187], v30 offset:8192
s_waitcnt lgkmcnt(2)
v_mfma_f32_16x16x32_bf16 v[120:123], v[176:179], v[228:231], v[120:123]
s_add_u32 m0, s63, 0x1000
s_nop 0
buffer_load_dwordx4 v21, s[48:51], s79 offen offset:0 lds
buffer_load_dwordx4 v22, s[48:51], s79 offen offset:1024 lds
buffer_load_dwordx4 v23, s[48:51], s79 offen offset:2048 lds
buffer_load_dwordx4 v24, s[48:51], s79 offen offset:3072 lds
v_mfma_f32_16x16x32_bf16 v[136:139], v[176:179], v[232:235], v[136:139]
v_mfma_f32_16x16x32_bf16 v[152:155], v[176:179], v[236:239], v[152:155]
ds_read_b128 v[188:191], v29 offset:10240
s_waitcnt lgkmcnt(2)
v_mfma_f32_16x16x32_bf16 v[124:127], v[180:183], v[216:219], v[124:127]
v_mfma_f32_16x16x32_bf16 v[140:143], v[180:183], v[220:223], v[140:143]
v_mfma_f32_16x16x32_bf16 v[156:159], v[180:183], v[224:227], v[156:159]
ds_read_b128 v[192:195], v30 offset:10240
s_waitcnt lgkmcnt(2)
v_mfma_f32_16x16x32_bf16 v[124:127], v[184:187], v[228:231], v[124:127]
v_mfma_f32_16x16x32_bf16 v[140:143], v[184:187], v[232:235], v[140:143]
v_mfma_f32_16x16x32_bf16 v[156:159], v[184:187], v[236:239], v[156:159]
ds_read_b128 v[204:207], v35 offset:4096
s_waitcnt vmcnt(4)
ds_read_b128 v[196:199], v29 offset:0
s_waitcnt lgkmcnt(3)
v_mfma_f32_16x16x32_bf16 v[128:131], v[188:191], v[216:219], v[128:131]
ds_read_b128 v[208:211], v35 offset:12288
v_mfma_f32_16x16x32_bf16 v[144:147], v[188:191], v[220:223], v[144:147]
ds_read_b128 v[212:215], v35 offset:20480
v_mfma_f32_16x16x32_bf16 v[160:163], v[188:191], v[224:227], v[160:163]
ds_read_b128 v[216:219], v35 offset:5120
ds_read_b128 v[200:203], v30 offset:0
s_waitcnt lgkmcnt(6)
v_mfma_f32_16x16x32_bf16 v[128:131], v[192:195], v[228:231], v[128:131]
ds_read_b128 v[220:223], v35 offset:13312
s_add_u32 m0, s63, 0x2000
s_nop 0
buffer_load_dwordx4 v21, s[48:51], s80 offen offset:0 lds
buffer_load_dwordx4 v22, s[48:51], s80 offen offset:1024 lds
buffer_load_dwordx4 v23, s[48:51], s80 offen offset:2048 lds
buffer_load_dwordx4 v24, s[48:51], s80 offen offset:3072 lds
v_mfma_f32_16x16x32_bf16 v[144:147], v[192:195], v[232:235], v[144:147]
ds_read_b128 v[224:227], v35 offset:21504
v_mfma_f32_16x16x32_bf16 v[160:163], v[192:195], v[236:239], v[160:163]
ds_read_b128 v[164:167], v29 offset:2048
s_waitcnt lgkmcnt(7)
v_mfma_f32_16x16x32_bf16 v[116:119], v[196:199], v[204:207], v[116:119]
s_waitcnt lgkmcnt(6)
v_mfma_f32_16x16x32_bf16 v[132:135], v[196:199], v[208:211], v[132:135]
s_waitcnt lgkmcnt(5)
v_mfma_f32_16x16x32_bf16 v[148:151], v[196:199], v[212:215], v[148:151]
ds_read_b128 v[168:171], v30 offset:2048
s_waitcnt lgkmcnt(4)
v_mfma_f32_16x16x32_bf16 v[116:119], v[200:203], v[216:219], v[116:119]
s_waitcnt lgkmcnt(3)
v_mfma_f32_16x16x32_bf16 v[132:135], v[200:203], v[220:223], v[132:135]
s_waitcnt lgkmcnt(2)
v_mfma_f32_16x16x32_bf16 v[148:151], v[200:203], v[224:227], v[148:151]
s_waitcnt vmcnt(4)
ds_read_b128 v[172:175], v29 offset:4096
s_waitcnt lgkmcnt(2)
v_mfma_f32_16x16x32_bf16 v[120:123], v[164:167], v[204:207], v[120:123]
v_mfma_f32_16x16x32_bf16 v[136:139], v[164:167], v[208:211], v[136:139]
v_mfma_f32_16x16x32_bf16 v[152:155], v[164:167], v[212:215], v[152:155]
ds_read_b128 v[176:179], v30 offset:4096
s_waitcnt lgkmcnt(2)
v_mfma_f32_16x16x32_bf16 v[120:123], v[168:171], v[216:219], v[120:123]
s_add_u32 m0, s63, 0x0
s_nop 0
buffer_load_dwordx4 v21, s[48:51], s81 offen offset:0 lds
buffer_load_dwordx4 v22, s[48:51], s81 offen offset:1024 lds
buffer_load_dwordx4 v23, s[48:51], s81 offen offset:2048 lds
buffer_load_dwordx4 v24, s[48:51], s81 offen offset:3072 lds
v_mfma_f32_16x16x32_bf16 v[136:139], v[168:171], v[220:223], v[136:139]
buffer_store_dwordx4 v[44:47], v16, s[56:59], s64 offen offset:0 sc1
buffer_store_dwordx4 v[48:51], v16, s[56:59], s64 offen offset:1024 sc1
v_mfma_f32_16x16x32_bf16 v[152:155], v[168:171], v[224:227], v[152:155]
ds_read_b128 v[180:183], v29 offset:6144
buffer_store_dwordx4 v[52:55], v16, s[56:59], s64 offen offset:2048 sc1
s_waitcnt lgkmcnt(2)
v_mfma_f32_16x16x32_bf16 v[124:127], v[172:175], v[204:207], v[124:127]
buffer_store_dwordx4 v[56:59], v16, s[56:59], s64 offen offset:3072 sc1
buffer_store_dwordx4 v[60:63], v16, s[56:59], s65 offen offset:0 sc1
v_mfma_f32_16x16x32_bf16 v[140:143], v[172:175], v[208:211], v[140:143]
buffer_store_dwordx4 v[64:67], v16, s[56:59], s65 offen offset:1024 sc1
v_mfma_f32_16x16x32_bf16 v[156:159], v[172:175], v[212:215], v[156:159]
ds_read_b128 v[184:187], v30 offset:6144
s_waitcnt lgkmcnt(2)
v_mfma_f32_16x16x32_bf16 v[124:127], v[176:179], v[216:219], v[124:127]
v_mfma_f32_16x16x32_bf16 v[140:143], v[176:179], v[220:223], v[140:143]
v_mfma_f32_16x16x32_bf16 v[156:159], v[176:179], v[224:227], v[156:159]
ds_read_b128 v[228:231], v35 offset:6144
s_waitcnt vmcnt(10)
ds_read_b128 v[188:191], v29 offset:8192
s_waitcnt lgkmcnt(3)
v_mfma_f32_16x16x32_bf16 v[128:131], v[180:183], v[204:207], v[128:131]
ds_read_b128 v[232:235], v35 offset:14336
v_mfma_f32_16x16x32_bf16 v[144:147], v[180:183], v[208:211], v[144:147]
ds_read_b128 v[236:239], v35 offset:22528
v_mfma_f32_16x16x32_bf16 v[160:163], v[180:183], v[212:215], v[160:163]
ds_read_b128 v[204:207], v35 offset:7168
ds_read_b128 v[192:195], v30 offset:8192
s_waitcnt lgkmcnt(6)
v_mfma_f32_16x16x32_bf16 v[128:131], v[184:187], v[216:219], v[128:131]
ds_read_b128 v[208:211], v35 offset:15360
v_mfma_f32_16x16x32_bf16 v[144:147], v[184:187], v[220:223], v[144:147]
ds_read_b128 v[212:215], v35 offset:23552
v_mfma_f32_16x16x32_bf16 v[160:163], v[184:187], v[224:227], v[160:163]
ds_read_b128 v[196:199], v29 offset:10240
s_waitcnt lgkmcnt(7)
v_mfma_f32_16x16x32_bf16 v[116:119], v[188:191], v[228:231], v[116:119]
s_waitcnt lgkmcnt(6)
v_mfma_f32_16x16x32_bf16 v[132:135], v[188:191], v[232:235], v[132:135]
s_waitcnt lgkmcnt(5)
v_mfma_f32_16x16x32_bf16 v[148:151], v[188:191], v[236:239], v[148:151]
ds_read_b128 v[200:203], v30 offset:10240
s_waitcnt lgkmcnt(4)
v_mfma_f32_16x16x32_bf16 v[116:119], v[192:195], v[204:207], v[116:119]
s_waitcnt lgkmcnt(3)
v_mfma_f32_16x16x32_bf16 v[132:135], v[192:195], v[208:211], v[132:135]
s_waitcnt lgkmcnt(2)
v_mfma_f32_16x16x32_bf16 v[148:151], v[192:195], v[212:215], v[148:151]
s_waitcnt vmcnt(6)
ds_read_b128 v[164:167], v29 offset:0
s_waitcnt lgkmcnt(2)
v_mfma_f32_16x16x32_bf16 v[120:123], v[196:199], v[228:231], v[120:123]
v_mfma_f32_16x16x32_bf16 v[136:139], v[196:199], v[232:235], v[136:139]
v_mfma_f32_16x16x32_bf16 v[152:155], v[196:199], v[236:239], v[152:155]
ds_read_b128 v[168:171], v30 offset:0
s_waitcnt lgkmcnt(2)
v_mfma_f32_16x16x32_bf16 v[120:123], v[200:203], v[204:207], v[120:123]
v_mfma_f32_16x16x32_bf16 v[136:139], v[200:203], v[208:211], v[136:139]
v_mfma_f32_16x16x32_bf16 v[152:155], v[200:203], v[212:215], v[152:155]
ds_read_b128 v[172:175], v29 offset:2048
s_waitcnt lgkmcnt(2)
v_mfma_f32_16x16x32_bf16 v[124:127], v[164:167], v[228:231], v[124:127]
v_mul_f32 v116, s86, v116
v_mul_f32 v117, s86, v117
v_mul_f32 v118, s86, v118
v_mul_f32 v119, s86, v119
v_mul_f32 v120, s86, v120
v_mul_f32 v121, s86, v121
v_mul_f32 v122, s86, v122
v_mul_f32 v123, s86, v123
v_cvt_pk_bf16_f32 v116, v116, v117
v_cvt_pk_bf16_f32 v117, v118, v119
v_cvt_pk_bf16_f32 v118, v120, v121
v_cvt_pk_bf16_f32 v119, v122, v123
buffer_store_dwordx4 v[116:119], v16, s[52:55], s82 offen offset:0 sc1
v_mfma_f32_16x16x32_bf16 v[140:143], v[164:167], v[232:235], v[140:143]
v_mul_f32 v132, s86, v132
v_mul_f32 v133, s86, v133
v_mul_f32 v134, s86, v134
v_mul_f32 v135, s86, v135
v_mul_f32 v136, s86, v136
v_mul_f32 v137, s86, v137
v_mul_f32 v138, s86, v138
v_mul_f32 v139, s86, v139
v_cvt_pk_bf16_f32 v132, v132, v133
v_cvt_pk_bf16_f32 v133, v134, v135
v_cvt_pk_bf16_f32 v134, v136, v137
v_cvt_pk_bf16_f32 v135, v138, v139
buffer_store_dwordx4 v[132:135], v16, s[52:55], s83 offen offset:0 sc1
v_mfma_f32_16x16x32_bf16 v[156:159], v[164:167], v[236:239], v[156:159]
ds_read_b128 v[176:179], v30 offset:2048
v_mul_f32 v148, s86, v148
v_mul_f32 v149, s86, v149
v_mul_f32 v150, s86, v150
v_mul_f32 v151, s86, v151
v_mul_f32 v152, s86, v152
v_mul_f32 v153, s86, v153
v_mul_f32 v154, s86, v154
v_mul_f32 v155, s86, v155
v_cvt_pk_bf16_f32 v148, v148, v149
v_cvt_pk_bf16_f32 v149, v150, v151
v_cvt_pk_bf16_f32 v150, v152, v153
v_cvt_pk_bf16_f32 v151, v154, v155
buffer_store_dwordx4 v[148:151], v16, s[52:55], s84 offen offset:0 sc1
s_waitcnt lgkmcnt(2)
v_mfma_f32_16x16x32_bf16 v[124:127], v[168:171], v[204:207], v[124:127]
v_mfma_f32_16x16x32_bf16 v[140:143], v[168:171], v[208:211], v[140:143]
v_mfma_f32_16x16x32_bf16 v[156:159], v[168:171], v[212:215], v[156:159]
s_waitcnt lgkmcnt(1)
v_mfma_f32_16x16x32_bf16 v[128:131], v[172:175], v[228:231], v[128:131]
v_mfma_f32_16x16x32_bf16 v[144:147], v[172:175], v[232:235], v[144:147]
v_mfma_f32_16x16x32_bf16 v[160:163], v[172:175], v[236:239], v[160:163]
s_waitcnt lgkmcnt(0)
v_mfma_f32_16x16x32_bf16 v[128:131], v[176:179], v[204:207], v[128:131]
v_mfma_f32_16x16x32_bf16 v[144:147], v[176:179], v[208:211], v[144:147]
v_mfma_f32_16x16x32_bf16 v[160:163], v[176:179], v[212:215], v[160:163]
v_mul_f32 v124, s86, v124
v_mul_f32 v125, s86, v125
v_mul_f32 v126, s86, v126
v_mul_f32 v127, s86, v127
s_nop 1
v_mul_f32 v128, s86, v128
v_mul_f32 v129, s86, v129
v_mul_f32 v130, s86, v130
v_mul_f32 v131, s86, v131
v_cvt_pk_bf16_f32 v124, v124, v125
v_cvt_pk_bf16_f32 v125, v126, v127
v_cvt_pk_bf16_f32 v126, v128, v129
v_cvt_pk_bf16_f32 v127, v130, v131
buffer_store_dwordx4 v[124:127], v16, s[52:55], s82 offen offset:1024 sc1
v_mul_f32 v140, s86, v140
v_mul_f32 v141, s86, v141
v_mul_f32 v142, s86, v142
v_mul_f32 v143, s86, v143
v_mul_f32 v144, s86, v144
v_mul_f32 v145, s86, v145
v_mul_f32 v146, s86, v146
v_mul_f32 v147, s86, v147
v_cvt_pk_bf16_f32 v140, v140, v141
v_cvt_pk_bf16_f32 v141, v142, v143
v_cvt_pk_bf16_f32 v142, v144, v145
v_cvt_pk_bf16_f32 v143, v146, v147
buffer_store_dwordx4 v[140:143], v16, s[52:55], s83 offen offset:1024 sc1
v_mul_f32 v156, s86, v156
v_mul_f32 v157, s86, v157
v_mul_f32 v158, s86, v158
v_mul_f32 v159, s86, v159
v_mul_f32 v160, s86, v160
v_mul_f32 v161, s86, v161
v_mul_f32 v162, s86, v162
v_mul_f32 v163, s86, v163
v_cvt_pk_bf16_f32 v156, v156, v157
v_cvt_pk_bf16_f32 v157, v158, v159
v_cvt_pk_bf16_f32 v158, v160, v161
v_cvt_pk_bf16_f32 v159, v162, v163
buffer_store_dwordx4 v[156:159], v16, s[52:55], s84 offen offset:1024 sc1
L1_fin:
s_add_u32 s91, s91, 1344
s_waitcnt lgkmcnt(0)
s_add_u32 s98, s98, 0x7f4a7c15
s_addc_u32 s99, s99, 0x9e3779b9
LM_pub:
s_add_u32 s40, s38, 0x7c00000
s_addc_u32 s41, s39, 0
s_mov_b32 s42, 0x40000
s_mov_b32 s43, 0x00020000
s_lshl_b32 s6, s91, 7
s_cmp_eq_u32 s60, 0
s_cselect_b32 s6, s6, 0x70000000
s_waitcnt vmcnt(0) lgkmcnt(0)
s_barrier
v_mov_b32 v6, s98
v_mov_b32 v7, s99
s_mov_b64 exec, 1
buffer_store_dwordx2 v[6:7], off, s[40:43], s6 sc1
s_mov_b64 exec, -1
s_cmp_eq_u32 s61, 0
s_cbranch_scc1 L2_entry
s_mov_b32 s61, 0
s_sub_u32 s4, s91, 1584
s_add_u32 s91, s4, 1600
v_lshlrev_b32 v16, 4, v2
s_mul_i32 s63, s60, 12288
s_and_b32 s6, s4, 3
s_lshl_b32 s6, s6, 6
s_mul_i32 s7, s60, 16
s_add_u32 s6, s6, s7
v_lshrrev_b32 v5, 5, v2
v_and_b32 v6, 31, v2
v_lshlrev_b32 v6, 4, v6
s_cmp_ge_u32 s4, 4
s_cselect_b64 vcc, -1, 0
v_add3_u32 v7, v5, s6, 0
v_and_b32 v8, 0x80, v7
v_bfe_u32 v9, v7, 2, 1
v_lshl_or_b32 v8, v9, 6, v8
v_bfe_u32 v9, v7, 4, 1
v_lshl_or_b32 v8, v9, 5, v8
v_and_b32 v9, 3, v7
v_lshl_or_b32 v8, v9, 3, v8
v_bfe_u32 v9, v7, 5, 2
v_lshl_or_b32 v8, v9, 1, v8
v_bfe_u32 v9, v7, 3, 1
v_or_b32 v8, v9, v8
v_cndmask_b32 v8, v8, v7, vcc
v_lshl_add_u32 v44, v8, 9, v6
v_add3_u32 v7, v5, s6, 2
v_and_b32 v8, 0x80, v7
v_bfe_u32 v9, v7, 2, 1
v_lshl_or_b32 v8, v9, 6, v8
v_bfe_u32 v9, v7, 4, 1
v_lshl_or_b32 v8, v9, 5, v8
v_and_b32 v9, 3, v7
v_lshl_or_b32 v8, v9, 3, v8
v_bfe_u32 v9, v7, 5, 2
v_lshl_or_b32 v8, v9, 1, v8
v_bfe_u32 v9, v7, 3, 1
v_or_b32 v8, v9, v8
v_cndmask_b32 v8, v8, v7, vcc
v_lshl_add_u32 v48, v8, 9, v6
v_add3_u32 v7, v5, s6, 4
v_and_b32 v8, 0x80, v7
v_bfe_u32 v9, v7, 2, 1
v_lshl_or_b32 v8, v9, 6, v8
v_bfe_u32 v9, v7, 4, 1
v_lshl_or_b32 v8, v9, 5, v8
v_and_b32 v9, 3, v7
v_lshl_or_b32 v8, v9, 3, v8
v_bfe_u32 v9, v7, 5, 2
v_lshl_or_b32 v8, v9, 1, v8
v_bfe_u32 v9, v7, 3, 1
v_or_b32 v8, v9, v8
v_cndmask_b32 v8, v8, v7, vcc
v_lshl_add_u32 v52, v8, 9, v6
v_add3_u32 v7, v5, s6, 6
v_and_b32 v8, 0x80, v7
v_bfe_u32 v9, v7, 2, 1
v_lshl_or_b32 v8, v9, 6, v8
v_bfe_u32 v9, v7, 4, 1
v_lshl_or_b32 v8, v9, 5, v8
v_and_b32 v9, 3, v7
v_lshl_or_b32 v8, v9, 3, v8
v_bfe_u32 v9, v7, 5, 2
v_lshl_or_b32 v8, v9, 1, v8
v_bfe_u32 v9, v7, 3, 1
v_or_b32 v8, v9, v8
v_cndmask_b32 v8, v8, v7, vcc
v_lshl_add_u32 v56, v8, 9, v6
v_add3_u32 v7, v5, s6, 8
v_and_b32 v8, 0x80, v7
v_bfe_u32 v9, v7, 2, 1
v_lshl_or_b32 v8, v9, 6, v8
v_bfe_u32 v9, v7, 4, 1
v_lshl_or_b32 v8, v9, 5, v8
v_and_b32 v9, 3, v7
v_lshl_or_b32 v8, v9, 3, v8
v_bfe_u32 v9, v7, 5, 2
v_lshl_or_b32 v8, v9, 1, v8
v_bfe_u32 v9, v7, 3, 1
v_or_b32 v8, v9, v8
v_cndmask_b32 v8, v8, v7, vcc
v_lshl_add_u32 v60, v8, 9, v6
v_add3_u32 v7, v5, s6, 10
v_and_b32 v8, 0x80, v7
v_bfe_u32 v9, v7, 2, 1
v_lshl_or_b32 v8, v9, 6, v8
v_bfe_u32 v9, v7, 4, 1
v_lshl_or_b32 v8, v9, 5, v8
v_and_b32 v9, 3, v7
v_lshl_or_b32 v8, v9, 3, v8
v_bfe_u32 v9, v7, 5, 2
v_lshl_or_b32 v8, v9, 1, v8
v_bfe_u32 v9, v7, 3, 1
v_or_b32 v8, v9, v8
v_cndmask_b32 v8, v8, v7, vcc
v_lshl_add_u32 v64, v8, 9, v6
v_add3_u32 v7, v5, s6, 12
v_and_b32 v8, 0x80, v7
v_bfe_u32 v9, v7, 2, 1
v_lshl_or_b32 v8, v9, 6, v8
v_bfe_u32 v9, v7, 4, 1
v_lshl_or_b32 v8, v9, 5, v8
v_and_b32 v9, 3, v7
v_lshl_or_b32 v8, v9, 3, v8
v_bfe_u32 v9, v7, 5, 2
v_lshl_or_b32 v8, v9, 1, v8
v_bfe_u32 v9, v7, 3, 1
v_or_b32 v8, v9, v8
v_cndmask_b32 v8, v8, v7, vcc
v_lshl_add_u32 v68, v8, 9, v6
v_add3_u32 v7, v5, s6, 14
v_and_b32 v8, 0x80, v7
v_bfe_u32 v9, v7, 2, 1
v_lshl_or_b32 v8, v9, 6, v8
v_bfe_u32 v9, v7, 4, 1
v_lshl_or_b32 v8, v9, 5, v8
v_and_b32 v9, 3, v7
v_lshl_or_b32 v8, v9, 3, v8
v_bfe_u32 v9, v7, 5, 2
v_lshl_or_b32 v8, v9, 1, v8
v_bfe_u32 v9, v7, 3, 1
v_or_b32 v8, v9, v8
v_cndmask_b32 v8, v8, v7, vcc
v_lshl_add_u32 v72, v8, 9, v6
s_lshl_b32 s7, s60, 7
v_lshrrev_b32 v5, 3, v2
v_and_b32 v6, 7, v2
v_and_b32 v7, 2, v5
v_xor_b32 v6, v6, v7
v_lshl_add_u32 v5, v5, 9, s7
v_lshl_add_u32 v17, v6, 4, v5
v_xor_b32 v6, 4, v6
v_lshl_add_u32 v18, v6, 4, v5
v_add_u32 v18, 0xc00, v18
v_add_u32 v19, 0x1800, v17
v_add_u32 v20, 0x1800, v18
s_xor_b32 s6, s62, 0
s_lshl_b32 s66, s6, 14
s_xor_b32 s6, s62, 1
s_lshl_b32 s67, s6, 14
s_xor_b32 s6, s62, 2
s_lshl_b32 s68, s6, 14
s_xor_b32 s6, s62, 3
s_lshl_b32 s69, s6, 14
s_xor_b32 s6, s62, 4
s_lshl_b32 s70, s6, 14
s_xor_b32 s6, s62, 5
s_lshl_b32 s71, s6, 14
s_xor_b32 s6, s62, 6
s_lshl_b32 s72, s6, 14
s_xor_b32 s6, s62, 7
s_lshl_b32 s73, s6, 14
s_waitcnt lgkmcnt(0)
s_cmp_ge_u32 s4, 4
s_cselect_b32 s6, s30, s24
s_cselect_b32 s7, s31, s25
s_add_u32 s40, s6, 0x0
s_addc_u32 s41, s7, 0
s_mov_b32 s42, 0x20000
s_mov_b32 s43, 0x00020000
s_add_u32 s44, s32, 0x0
s_addc_u32 s45, s33, 0
s_mov_b32 s46, 0x20000
s_mov_b32 s47, 0x00020000
buffer_load_dwordx4 v[44:47], v44, s[40:43], 0 offen
buffer_load_dwordx4 v[48:51], v48, s[40:43], 0 offen
buffer_load_dwordx4 v[52:55], v52, s[40:43], 0 offen
buffer_load_dwordx4 v[56:59], v56, s[40:43], 0 offen
buffer_load_dwordx4 v[60:63], v60, s[40:43], 0 offen
buffer_load_dwordx4 v[64:67], v64, s[40:43], 0 offen
buffer_load_dwordx4 v[68:71], v68, s[40:43], 0 offen
buffer_load_dwordx4 v[72:75], v72, s[40:43], 0 offen
s_add_u32 m0, s63, 0x0
s_nop 0
buffer_load_dwordx4 v17, s[44:47], s66 offen offset:0 lds
buffer_load_dwordx4 v18, s[44:47], s66 offen offset:1024 lds
buffer_load_dwordx4 v19, s[44:47], s66 offen offset:2048 lds
buffer_load_dwordx4 v20, s[44:47], s66 offen offset:3072 lds
s_add_u32 m0, s63, 0x1000
s_nop 0
buffer_load_dwordx4 v17, s[44:47], s67 offen offset:0 lds
buffer_load_dwordx4 v18, s[44:47], s67 offen offset:1024 lds
buffer_load_dwordx4 v19, s[44:47], s67 offen offset:2048 lds
buffer_load_dwordx4 v20, s[44:47], s67 offen offset:3072 lds
v_bfe_u32 v5, v2, 2, 3
v_xor_b32 v5, s62, v5
v_and_b32 v6, 3, v2
v_lshlrev_b32 v7, 10, v5
v_lshl_add_u32 v7, v6, 8, v7
v_add_u32 v7, 0xc000, v7
v_and_b32 v5, 1, v5
v_lshl_or_b32 v6, v5, 2, v6
v_lshrrev_b32 v5, 5, v2
s_mul_i32 s6, s60, 16
v_add3_u32 v8, v5, s6, 0
v_lshrrev_b32 v9, 4, v8
v_lshl_add_u32 v9, v9, 13, v7
v_and_b32 v8, 15, v8
v_xor_b32 v8, v8, v6
v_lshl_add_u32 v36, v8, 4, v9
v_add3_u32 v8, v5, s6, 2
v_lshrrev_b32 v9, 4, v8
v_lshl_add_u32 v9, v9, 13, v7
v_and_b32 v8, 15, v8
v_xor_b32 v8, v8, v6
v_lshl_add_u32 v37, v8, 4, v9
v_add3_u32 v8, v5, s6, 4
v_lshrrev_b32 v9, 4, v8
v_lshl_add_u32 v9, v9, 13, v7
v_and_b32 v8, 15, v8
v_xor_b32 v8, v8, v6
v_lshl_add_u32 v38, v8, 4, v9
v_add3_u32 v8, v5, s6, 6
v_lshrrev_b32 v9, 4, v8
v_lshl_add_u32 v9, v9, 13, v7
v_and_b32 v8, 15, v8
v_xor_b32 v8, v8, v6
v_lshl_add_u32 v39, v8, 4, v9
v_add3_u32 v8, v5, s6, 8
v_lshrrev_b32 v9, 4, v8
v_lshl_add_u32 v9, v9, 13, v7
v_and_b32 v8, 15, v8
v_xor_b32 v8, v8, v6
v_lshl_add_u32 v40, v8, 4, v9
v_add3_u32 v8, v5, s6, 10
v_lshrrev_b32 v9, 4, v8
v_lshl_add_u32 v9, v9, 13, v7
v_and_b32 v8, 15, v8
v_xor_b32 v8, v8, v6
v_lshl_add_u32 v41, v8, 4, v9
v_add3_u32 v8, v5, s6, 12
v_lshrrev_b32 v9, 4, v8
v_lshl_add_u32 v9, v9, 13, v7
v_and_b32 v8, 15, v8
v_xor_b32 v8, v8, v6
v_lshl_add_u32 v42, v8, 4, v9
v_add3_u32 v8, v5, s6, 14
v_lshrrev_b32 v9, 4, v8
v_lshl_add_u32 v9, v9, 13, v7
v_and_b32 v8, 15, v8
v_xor_b32 v8, v8, v6
v_lshl_add_u32 v43, v8, 4, v9
v_xor_b32 v5, v3, v4
v_lshlrev_b32 v5, 4, v5
v_lshl_add_u32 v5, v4, 8, v5
v_add_u32 v31, 0xc000, v5
v_xor_b32 v32, 64, v31
v_lshrrev_b32 v5, 2, v3
v_and_b32 v6, 3, v3
v_and_b32 v7, 1, v4
v_lshlrev_b32 v7, 2, v7
v_and_b32 v8, 2, v5
v_or_b32 v7, v7, v8
v_lshl_add_u32 v8, v4, 3, v5
v_lshlrev_b32 v8, 7, v8
v_add_u32 v8, s63, v8
v_xor_b32 v6, v6, v7
v_xor_b32 v9, 0, v6
v_lshl_add_u32 v25, v9, 4, v8
v_add_u32 v26, 8, v25
v_xor_b32 v9, 4, v6
v_lshl_add_u32 v27, v9, 4, v8
v_add_u32 v28, 8, v27
s_lshr_b32 s6, s4, 2
s_lshl_b32 s6, s6, 17
s_and_b32 s7, s4, 3
s_lshl_b32 s7, s7, 12
s_add_u32 s6, s6, s7
s_mul_i32 s7, s60, 32768
s_add_u32 s82, s6, s7
s_add_u32 s83, s82, 16384
s_add_u32 s52, s38, 0x1000000
s_addc_u32 s53, s39, 0
s_mov_b32 s54, 0x40000
s_mov_b32 s55, 0x00020000
s_waitcnt vmcnt(15)
ds_write_b128 v36, v[44:47]
s_waitcnt vmcnt(14)
ds_write_b128 v37, v[48:51]
s_waitcnt vmcnt(13)
ds_write_b128 v38, v[52:55]
s_waitcnt vmcnt(12)
ds_write_b128 v39, v[56:59]
s_waitcnt vmcnt(11)
ds_write_b128 v40, v[60:63]
s_waitcnt vmcnt(10)
ds_write_b128 v41, v[64:67]
s_waitcnt vmcnt(9)
ds_write_b128 v42, v[68:71]
s_waitcnt vmcnt(8)
ds_write_b128 v43, v[72:75]
s_add_u32 m0, s63, 0x2000
s_nop 0
buffer_load_dwordx4 v17, s[44:47], s68 offen offset:0 lds
buffer_load_dwordx4 v18, s[44:47], s68 offen offset:1024 lds
buffer_load_dwordx4 v19, s[44:47], s68 offen offset:2048 lds
buffer_load_dwordx4 v20, s[44:47], s68 offen offset:3072 lds
s_waitcnt vmcnt(8)
ds_read_b64_tr_b16 v[140:141], v25 offset:0
ds_read_b64_tr_b16 v[142:143], v25 offset:512
ds_read_b64_tr_b16 v[144:145], v26 offset:0
ds_read_b64_tr_b16 v[146:147], v26 offset:512
ds_read_b64_tr_b16 v[148:149], v27 offset:0
ds_read_b64_tr_b16 v[150:151], v27 offset:512
s_waitcnt lgkmcnt(6)
s_barrier
ds_read_b128 v[180:183], v31 offset:0
ds_read_b128 v[184:187], v31 offset:8192
ds_read_b128 v[188:191], v31 offset:16384
ds_read_b128 v[192:195], v31 offset:24576
s_waitcnt lgkmcnt(3)
v_mfma_f32_16x16x32_bf16 v[76:79], v[180:183], v[140:143], 0
s_waitcnt lgkmcnt(2)
v_mfma_f32_16x16x32_bf16 v[80:83], v[184:187], v[140:143], 0
s_waitcnt lgkmcnt(1)
v_mfma_f32_16x16x32_bf16 v[84:87], v[188:191], v[140:143], 0
s_waitcnt lgkmcnt(0)
v_mfma_f32_16x16x32_bf16 v[88:91], v[192:195], v[140:143], 0
ds_read_b64_tr_b16 v[152:153], v28 offset:0
ds_read_b64_tr_b16 v[154:155], v28 offset:512
v_mfma_f32_16x16x32_bf16 v[92:95], v[180:183], v[144:147], 0
v_mfma_f32_16x16x32_bf16 v[96:99], v[184:187], v[144:147], 0
v_mfma_f32_16x16x32_bf16 v[100:103], v[188:191], v[144:147], 0
v_mfma_f32_16x16x32_bf16 v[104:107], v[192:195], v[144:147], 0
ds_read_b128 v[196:199], v32 offset:1024
s_waitcnt vmcnt(4)
ds_read_b64_tr_b16 v[156:157], v25 offset:4096
ds_read_b64_tr_b16 v[158:159], v25 offset:4608
v_mfma_f32_16x16x32_bf16 v[108:111], v[180:183], v[148:151], 0
ds_read_b128 v[200:203], v32 offset:9216
v_mfma_f32_16x16x32_bf16 v[112:115], v[184:187], v[148:151], 0
ds_read_b128 v[204:207], v32 offset:17408
v_mfma_f32_16x16x32_bf16 v[116:119], v[188:191], v[148:151], 0
ds_read_b128 v[208:211], v32 offset:25600
v_mfma_f32_16x16x32_bf16 v[120:123], v[192:195], v[148:151], 0
ds_read_b64_tr_b16 v[160:161], v26 offset:4096
ds_read_b64_tr_b16 v[162:163], v26 offset:4608
s_waitcnt lgkmcnt(8)
v_mfma_f32_16x16x32_bf16 v[124:127], v[180:183], v[152:155], 0
s_add_u32 m0, s63, 0x0
s_nop 0
buffer_load_dwordx4 v17, s[44:47], s69 offen offset:0 lds
buffer_load_dwordx4 v18, s[44:47], s69 offen offset:1024 lds
buffer_load_dwordx4 v19, s[44:47], s69 offen offset:2048 lds
buffer_load_dwordx4 v20, s[44:47], s69 offen offset:3072 lds
v_mfma_f32_16x16x32_bf16 v[128:131], v[184:187], v[152:155], 0
v_mfma_f32_16x16x32_bf16 v[132:135], v[188:191], v[152:155], 0
v_mfma_f32_16x16x32_bf16 v[136:139], v[192:195], v[152:155], 0
ds_read_b64_tr_b16 v[164:165], v27 offset:4096
ds_read_b64_tr_b16 v[166:167], v27 offset:4608
s_waitcnt lgkmcnt(7)
v_mfma_f32_16x16x32_bf16 v[76:79], v[196:199], v[156:159], v[76:79]
s_waitcnt lgkmcnt(6)
v_mfma_f32_16x16x32_bf16 v[80:83], v[200:203], v[156:159], v[80:83]
s_waitcnt lgkmcnt(5)
v_mfma_f32_16x16x32_bf16 v[84:87], v[204:207], v[156:159], v[84:87]
s_waitcnt lgkmcnt(4)
v_mfma_f32_16x16x32_bf16 v[88:91], v[208:211], v[156:159], v[88:91]
ds_read_b64_tr_b16 v[168:169], v28 offset:4096
ds_read_b64_tr_b16 v[170:171], v28 offset:4608
s_waitcnt lgkmcnt(4)
v_mfma_f32_16x16x32_bf16 v[92:95], v[196:199], v[160:163], v[92:95]
v_mfma_f32_16x16x32_bf16 v[96:99], v[200:203], v[160:163], v[96:99]
v_mfma_f32_16x16x32_bf16 v[100:103], v[204:207], v[160:163], v[100:103]
v_mfma_f32_16x16x32_bf16 v[104:107], v[208:211], v[160:163], v[104:107]
ds_read_b128 v[212:215], v31 offset:2048
s_waitcnt vmcnt(4)
ds_read_b64_tr_b16 v[172:173], v25 offset:8192
ds_read_b64_tr_b16 v[174:175], v25 offset:8704
s_waitcnt lgkmcnt(5)
v_mfma_f32_16x16x32_bf16 v[108:111], v[196:199], v[164:167], v[108:111]
ds_read_b128 v[216:219], v31 offset:10240
v_mfma_f32_16x16x32_bf16 v[112:115], v[200:203], v[164:167], v[112:115]
ds_read_b128 v[220:223], v31 offset:18432
v_mfma_f32_16x16x32_bf16 v[116:119], v[204:207], v[164:167], v[116:119]
ds_read_b128 v[224:227], v31 offset:26624
v_mfma_f32_16x16x32_bf16 v[120:123], v[208:211], v[164:167], v[120:123]
ds_read_b64_tr_b16 v[176:177], v26 offset:8192
ds_read_b64_tr_b16 v[178:179], v26 offset:8704
s_waitcnt lgkmcnt(8)
v_mfma_f32_16x16x32_bf16 v[124:127], v[196:199], v[168:171], v[124:127]
s_add_u32 m0, s63, 0x1000
s_nop 0
buffer_load_dwordx4 v17, s[44:47], s70 offen offset:0 lds
buffer_load_dwordx4 v18, s[44:47], s70 offen offset:1024 lds
buffer_load_dwordx4 v19, s[44:47], s70 offen offset:2048 lds
buffer_load_dwordx4 v20, s[44:47], s70 offen offset:3072 lds
v_mfma_f32_16x16x32_bf16 v[128:131], v[200:203], v[168:171], v[128:131]
v_mfma_f32_16x16x32_bf16 v[132:135], v[204:207], v[168:171], v[132:135]
v_mfma_f32_16x16x32_bf16 v[136:139], v[208:211], v[168:171], v[136:139]
ds_read_b64_tr_b16 v[140:141], v27 offset:8192
ds_read_b64_tr_b16 v[142:143], v27 offset:8704
s_waitcnt lgkmcnt(7)
v_mfma_f32_16x16x32_bf16 v[76:79], v[212:215], v[172:175], v[76:79]
s_waitcnt lgkmcnt(6)
v_mfma_f32_16x16x32_bf16 v[80:83], v[216:219], v[172:175], v[80:83]
s_waitcnt lgkmcnt(5)
v_mfma_f32_16x16x32_bf16 v[84:87], v[220:223], v[172:175], v[84:87]
s_waitcnt lgkmcnt(4)
v_mfma_f32_16x16x32_bf16 v[88:91], v[224:227], v[172:175], v[88:91]
ds_read_b64_tr_b16 v[144:145], v28 offset:8192
ds_read_b64_tr_b16 v[146:147], v28 offset:8704
s_waitcnt lgkmcnt(4)
v_mfma_f32_16x16x32_bf16 v[92:95], v[212:215], v[176:179], v[92:95]
v_mfma_f32_16x16x32_bf16 v[96:99], v[216:219], v[176:179], v[96:99]
v_mfma_f32_16x16x32_bf16 v[100:103], v[220:223], v[176:179], v[100:103]
v_mfma_f32_16x16x32_bf16 v[104:107], v[224:227], v[176:179], v[104:107]
ds_read_b128 v[180:183], v32 offset:3072
s_waitcnt vmcnt(4)
ds_read_b64_tr_b16 v[148:149], v25 offset:0
ds_read_b64_tr_b16 v[150:151], v25 offset:512
s_waitcnt lgkmcnt(5)
v_mfma_f32_16x16x32_bf16 v[108:111], v[212:215], v[140:143], v[108:111]
ds_read_b128 v[184:187], v32 offset:11264
v_mfma_f32_16x16x32_bf16 v[112:115], v[216:219], v[140:143], v[112:115]
ds_read_b128 v[188:191], v32 offset:19456
v_mfma_f32_16x16x32_bf16 v[116:119], v[220:223], v[140:143], v[116:119]
ds_read_b128 v[192:195], v32 offset:27648
v_mfma_f32_16x16x32_bf16 v[120:123], v[224:227], v[140:143], v[120:123]
ds_read_b64_tr_b16 v[152:153], v26 offset:0
ds_read_b64_tr_b16 v[154:155], v26 offset:512
s_waitcnt lgkmcnt(8)
v_mfma_f32_16x16x32_bf16 v[124:127], v[212:215], v[144:147], v[124:127]
s_add_u32 m0, s63, 0x2000
s_nop 0
buffer_load_dwordx4 v17, s[44:47], s71 offen offset:0 lds
buffer_load_dwordx4 v18, s[44:47], s71 offen offset:1024 lds
buffer_load_dwordx4 v19, s[44:47], s71 offen offset:2048 lds
buffer_load_dwordx4 v20, s[44:47], s71 offen offset:3072 lds
v_mfma_f32_16x16x32_bf16 v[128:131], v[216:219], v[144:147], v[128:131]
v_mfma_f32_16x16x32_bf16 v[132:135], v[220:223], v[144:147], v[132:135]
v_mfma_f32_16x16x32_bf16 v[136:139], v[224:227], v[144:147], v[136:139]
ds_read_b64_tr_b16 v[156:157], v27 offset:0
ds_read_b64_tr_b16 v[158:159], v27 offset:512
s_waitcnt lgkmcnt(7)
v_mfma_f32_16x16x32_bf16 v[76:79], v[180:183], v[148:151], v[76:79]
s_waitcnt lgkmcnt(6)
v_mfma_f32_16x16x32_bf16 v[80:83], v[184:187], v[148:151], v[80:83]
s_waitcnt lgkmcnt(5)
v_mfma_f32_16x16x32_bf16 v[84:87], v[188:191], v[148:151], v[84:87]
s_waitcnt lgkmcnt(4)
v_mfma_f32_16x16x32_bf16 v[88:91], v[192:195], v[148:151], v[88:91]
ds_read_b64_tr_b16 v[160:161], v28 offset:0
ds_read_b64_tr_b16 v[162:163], v28 offset:512
s_waitcnt lgkmcnt(4)
v_mfma_f32_16x16x32_bf16 v[92:95], v[180:183], v[152:155], v[92:95]
v_mfma_f32_16x16x32_bf16 v[96:99], v[184:187], v[152:155], v[96:99]
v_mfma_f32_16x16x32_bf16 v[100:103], v[188:191], v[152:155], v[100:103]
v_mfma_f32_16x16x32_bf16 v[104:107], v[192:195], v[152:155], v[104:107]
ds_read_b128 v[196:199], v31 offset:4096
s_waitcnt vmcnt(4)
ds_read_b64_tr_b16 v[164:165], v25 offset:4096
ds_read_b64_tr_b16 v[166:167], v25 offset:4608
s_waitcnt lgkmcnt(5)
v_mfma_f32_16x16x32_bf16 v[108:111], v[180:183], v[156:159], v[108:111]
ds_read_b128 v[200:203], v31 offset:12288
v_mfma_f32_16x16x32_bf16 v[112:115], v[184:187], v[156:159], v[112:115]
ds_read_b128 v[204:207], v31 offset:20480
v_mfma_f32_16x16x32_bf16 v[116:119], v[188:191], v[156:159], v[116:119]
ds_read_b128 v[208:211], v31 offset:28672
v_mfma_f32_16x16x32_bf16 v[120:123], v[192:195], v[156:159], v[120:123]
ds_read_b64_tr_b16 v[168:169], v26 offset:4096
ds_read_b64_tr_b16 v[170:171], v26 offset:4608
s_waitcnt lgkmcnt(8)
v_mfma_f32_16x16x32_bf16 v[124:127], v[180:183], v[160:163], v[124:127]
s_add_u32 m0, s63, 0x0
s_nop 0
buffer_load_dwordx4 v17, s[44:47], s72 offen offset:0 lds
buffer_load_dwordx4 v18, s[44:47], s72 offen offset:1024 lds
buffer_load_dwordx4 v19, s[44:47], s72 offen offset:2048 lds
buffer_load_dwordx4 v20, s[44:47], s72 offen offset:3072 lds
v_mfma_f32_16x16x32_bf16 v[128:131], v[184:187], v[160:163], v[128:131]
v_mfma_f32_16x16x32_bf16 v[132:135], v[188:191], v[160:163], v[132:135]
v_mfma_f32_16x16x32_bf16 v[136:139], v[192:195], v[160:163], v[136:139]
ds_read_b64_tr_b16 v[172:173], v27 offset:4096
ds_read_b64_tr_b16 v[174:175], v27 offset:4608
s_waitcnt lgkmcnt(7)
v_mfma_f32_16x16x32_bf16 v[76:79], v[196:199], v[164:167], v[76:79]
s_waitcnt lgkmcnt(6)
v_mfma_f32_16x16x32_bf16 v[80:83], v[200:203], v[164:167], v[80:83]
s_waitcnt lgkmcnt(5)
v_mfma_f32_16x16x32_bf16 v[84:87], v[204:207], v[164:167], v[84:87]
s_waitcnt lgkmcnt(4)
v_mfma_f32_16x16x32_bf16 v[88:91], v[208:211], v[164:167], v[88:91]
ds_read_b64_tr_b16 v[176:177], v28 offset:4096
ds_read_b64_tr_b16 v[178:179], v28 offset:4608
s_waitcnt lgkmcnt(4)
v_mfma_f32_16x16x32_bf16 v[92:95], v[196:199], v[168:171], v[92:95]
v_mfma_f32_16x16x32_bf16 v[96:99], v[200:203], v[168:171], v[96:99]
v_mfma_f32_16x16x32_bf16 v[100:103], v[204:207], v[168:171], v[100:103]
v_mfma_f32_16x16x32_bf16 v[104:107], v[208:211], v[168:171], v[104:107]
ds_read_b128 v[212:215], v32 offset:5120
s_waitcnt vmcnt(4)
ds_read_b64_tr_b16 v[140:141], v25 offset:8192
ds_read_b64_tr_b16 v[142:143], v25 offset:8704
s_waitcnt lgkmcnt(5)
v_mfma_f32_16x16x32_bf16 v[108:111], v[196:199], v[172:175], v[108:111]
ds_read_b128 v[216:219], v32 offset:13312
v_mfma_f32_16x16x32_bf16 v[112:115], v[200:203], v[172:175], v[112:115]
ds_read_b128 v[220:223], v32 offset:21504
v_mfma_f32_16x16x32_bf16 v[116:119], v[204:207], v[172:175], v[116:119]
ds_read_b128 v[224:227], v32 offset:29696
v_mfma_f32_16x16x32_bf16 v[120:123], v[208:211], v[172:175], v[120:123]
ds_read_b64_tr_b16 v[144:145], v26 offset:8192
ds_read_b64_tr_b16 v[146:147], v26 offset:8704
s_waitcnt lgkmcnt(8)
v_mfma_f32_16x16x32_bf16 v[124:127], v[196:199], v[176:179], v[124:127]
s_add_u32 m0, s63, 0x1000
s_nop 0
buffer_load_dwordx4 v17, s[44:47], s73 offen offset:0 lds
buffer_load_dwordx4 v18, s[44:47], s73 offen offset:1024 lds
buffer_load_dwordx4 v19, s[44:47], s73 offen offset:2048 lds
buffer_load_dwordx4 v20, s[44:47], s73 offen offset:3072 lds
v_mfma_f32_16x16x32_bf16 v[128:131], v[200:203], v[176:179], v[128:131]
v_mfma_f32_16x16x32_bf16 v[132:135], v[204:207], v[176:179], v[132:135]
v_mfma_f32_16x16x32_bf16 v[136:139], v[208:211], v[176:179], v[136:139]
ds_read_b64_tr_b16 v[148:149], v27 offset:8192
ds_read_b64_tr_b16 v[150:151], v27 offset:8704
s_waitcnt lgkmcnt(7)
v_mfma_f32_16x16x32_bf16 v[76:79], v[212:215], v[140:143], v[76:79]
s_waitcnt lgkmcnt(6)
v_mfma_f32_16x16x32_bf16 v[80:83], v[216:219], v[140:143], v[80:83]
s_waitcnt lgkmcnt(5)
v_mfma_f32_16x16x32_bf16 v[84:87], v[220:223], v[140:143], v[84:87]
s_waitcnt lgkmcnt(4)
v_mfma_f32_16x16x32_bf16 v[88:91], v[224:227], v[140:143], v[88:91]
ds_read_b64_tr_b16 v[152:153], v28 offset:8192
ds_read_b64_tr_b16 v[154:155], v28 offset:8704
s_waitcnt lgkmcnt(4)
v_mfma_f32_16x16x32_bf16 v[92:95], v[212:215], v[144:147], v[92:95]
v_mfma_f32_16x16x32_bf16 v[96:99], v[216:219], v[144:147], v[96:99]
v_mfma_f32_16x16x32_bf16 v[100:103], v[220:223], v[144:147], v[100:103]
v_mfma_f32_16x16x32_bf16 v[104:107], v[224:227], v[144:147], v[104:107]
ds_read_b128 v[180:183], v31 offset:6144
s_waitcnt vmcnt(4)
ds_read_b64_tr_b16 v[156:157], v25 offset:0
ds_read_b64_tr_b16 v[158:159], v25 offset:512
s_waitcnt lgkmcnt(5)
v_mfma_f32_16x16x32_bf16 v[108:111], v[212:215], v[148:151], v[108:111]
ds_read_b128 v[184:187], v31 offset:14336
v_mfma_f32_16x16x32_bf16 v[112:115], v[216:219], v[148:151], v[112:115]
ds_read_b128 v[188:191], v31 offset:22528
v_mfma_f32_16x16x32_bf16 v[116:119], v[220:223], v[148:151], v[116:119]
ds_read_b128 v[192:195], v31 offset:30720
v_mfma_f32_16x16x32_bf16 v[120:123], v[224:227], v[148:151], v[120:123]
ds_read_b64_tr_b16 v[160:161], v26 offset:0
ds_read_b64_tr_b16 v[162:163], v26 offset:512
s_waitcnt lgkmcnt(8)
v_mfma_f32_16x16x32_bf16 v[124:127], v[212:215], v[152:155], v[124:127]
v_mfma_f32_16x16x32_bf16 v[128:131], v[216:219], v[152:155], v[128:131]
v_mfma_f32_16x16x32_bf16 v[132:135], v[220:223], v[152:155], v[132:135]
v_mfma_f32_16x16x32_bf16 v[136:139], v[224:227], v[152:155], v[136:139]
ds_read_b64_tr_b16 v[164:165], v27 offset:0
ds_read_b64_tr_b16 v[166:167], v27 offset:512
s_waitcnt lgkmcnt(7)
v_mfma_f32_16x16x32_bf16 v[76:79], v[180:183], v[156:159], v[76:79]
s_waitcnt lgkmcnt(6)
v_mfma_f32_16x16x32_bf16 v[80:83], v[184:187], v[156:159], v[80:83]
s_waitcnt lgkmcnt(5)
v_mfma_f32_16x16x32_bf16 v[84:87], v[188:191], v[156:159], v[84:87]
s_waitcnt lgkmcnt(4)
v_mfma_f32_16x16x32_bf16 v[88:91], v[192:195], v[156:159], v[88:91]
ds_read_b64_tr_b16 v[168:169], v28 offset:0
ds_read_b64_tr_b16 v[170:171], v28 offset:512
s_waitcnt lgkmcnt(4)
v_mfma_f32_16x16x32_bf16 v[92:95], v[180:183], v[160:163], v[92:95]
v_mfma_f32_16x16x32_bf16 v[96:99], v[184:187], v[160:163], v[96:99]
v_mfma_f32_16x16x32_bf16 v[100:103], v[188:191], v[160:163], v[100:103]
v_mfma_f32_16x16x32_bf16 v[104:107], v[192:195], v[160:163], v[104:107]
ds_read_b128 v[196:199], v32 offset:7168
s_waitcnt vmcnt(0)
ds_read_b64_tr_b16 v[172:173], v25 offset:4096
ds_read_b64_tr_b16 v[174:175], v25 offset:4608
s_waitcnt lgkmcnt(5)
v_mfma_f32_16x16x32_bf16 v[108:111], v[180:183], v[164:167], v[108:111]
ds_read_b128 v[200:203], v32 offset:15360
v_mfma_f32_16x16x32_bf16 v[112:115], v[184:187], v[164:167], v[112:115]
ds_read_b128 v[204:207], v32 offset:23552
v_mfma_f32_16x16x32_bf16 v[116:119], v[188:191], v[164:167], v[116:119]
ds_read_b128 v[208:211], v32 offset:31744
v_mfma_f32_16x16x32_bf16 v[120:123], v[192:195], v[164:167], v[120:123]
ds_read_b64_tr_b16 v[176:177], v26 offset:4096
ds_read_b64_tr_b16 v[178:179], v26 offset:4608
s_waitcnt lgkmcnt(8)
v_mfma_f32_16x16x32_bf16 v[124:127], v[180:183], v[168:171], v[124:127]
v_mfma_f32_16x16x32_bf16 v[128:131], v[184:187], v[168:171], v[128:131]
v_mfma_f32_16x16x32_bf16 v[132:135], v[188:191], v[168:171], v[132:135]
v_mfma_f32_16x16x32_bf16 v[136:139], v[192:195], v[168:171], v[136:139]
ds_read_b64_tr_b16 v[140:141], v27 offset:4096
ds_read_b64_tr_b16 v[142:143], v27 offset:4608
s_waitcnt lgkmcnt(7)
v_mfma_f32_16x16x32_bf16 v[76:79], v[196:199], v[172:175], v[76:79]
s_waitcnt lgkmcnt(6)
v_mfma_f32_16x16x32_bf16 v[80:83], v[200:203], v[172:175], v[80:83]
s_waitcnt lgkmcnt(5)
v_mfma_f32_16x16x32_bf16 v[84:87], v[204:207], v[172:175], v[84:87]
s_waitcnt lgkmcnt(4)
v_mfma_f32_16x16x32_bf16 v[88:91], v[208:211], v[172:175], v[88:91]
ds_read_b64_tr_b16 v[144:145], v28 offset:4096
ds_read_b64_tr_b16 v[146:147], v28 offset:4608
s_waitcnt lgkmcnt(4)
v_mfma_f32_16x16x32_bf16 v[92:95], v[196:199], v[176:179], v[92:95]
v_cvt_pk_bf16_f32 v76, v76, v77
v_cvt_pk_bf16_f32 v77, v78, v79
v_cvt_pk_bf16_f32 v78, v80, v81
v_cvt_pk_bf16_f32 v79, v82, v83
buffer_store_dwordx4 v[76:79], v16, s[52:55], s82 offen offset:0 sc1
v_mfma_f32_16x16x32_bf16 v[96:99], v[200:203], v[176:179], v[96:99]
v_mfma_f32_16x16x32_bf16 v[100:103], v[204:207], v[176:179], v[100:103]
v_cvt_pk_bf16_f32 v84, v84, v85
v_cvt_pk_bf16_f32 v85, v86, v87
v_cvt_pk_bf16_f32 v86, v88, v89
v_cvt_pk_bf16_f32 v87, v90, v91
buffer_store_dwordx4 v[84:87], v16, s[52:55], s82 offen offset:2048 sc1
v_mfma_f32_16x16x32_bf16 v[104:107], v[208:211], v[176:179], v[104:107]
s_waitcnt lgkmcnt(2)
v_mfma_f32_16x16x32_bf16 v[108:111], v[196:199], v[140:143], v[108:111]
v_cvt_pk_bf16_f32 v92, v92, v93
v_cvt_pk_bf16_f32 v93, v94, v95
v_cvt_pk_bf16_f32 v94, v96, v97
v_cvt_pk_bf16_f32 v95, v98, v99
buffer_store_dwordx4 v[92:95], v16, s[52:55], s82 offen offset:1024 sc1
v_mfma_f32_16x16x32_bf16 v[112:115], v[200:203], v[140:143], v[112:115]
v_mfma_f32_16x16x32_bf16 v[116:119], v[204:207], v[140:143], v[116:119]
v_cvt_pk_bf16_f32 v100, v100, v101
v_cvt_pk_bf16_f32 v101, v102, v103
v_cvt_pk_bf16_f32 v102, v104, v105
v_cvt_pk_bf16_f32 v103, v106, v107
buffer_store_dwordx4 v[100:103], v16, s[52:55], s82 offen offset:3072 sc1
v_mfma_f32_16x16x32_bf16 v[120:123], v[208:211], v[140:143], v[120:123]
s_waitcnt lgkmcnt(0)
v_mfma_f32_16x16x32_bf16 v[124:127], v[196:199], v[144:147], v[124:127]
v_cvt_pk_bf16_f32 v108, v108, v109
v_cvt_pk_bf16_f32 v109, v110, v111
v_cvt_pk_bf16_f32 v110, v112, v113
v_cvt_pk_bf16_f32 v111, v114, v115
buffer_store_dwordx4 v[108:111], v16, s[52:55], s83 offen offset:0 sc1
v_mfma_f32_16x16x32_bf16 v[128:131], v[200:203], v[144:147], v[128:131]
v_mfma_f32_16x16x32_bf16 v[132:135], v[204:207], v[144:147], v[132:135]
v_cvt_pk_bf16_f32 v116, v116, v117
v_cvt_pk_bf16_f32 v117, v118, v119
v_cvt_pk_bf16_f32 v118, v120, v121
v_cvt_pk_bf16_f32 v119, v122, v123
buffer_store_dwordx4 v[116:119], v16, s[52:55], s83 offen offset:2048 sc1
v_mfma_f32_16x16x32_bf16 v[136:139], v[208:211], v[144:147], v[136:139]
v_cvt_pk_bf16_f32 v124, v124, v125
v_cvt_pk_bf16_f32 v125, v126, v127
v_cvt_pk_bf16_f32 v126, v128, v129
v_cvt_pk_bf16_f32 v127, v130, v131
buffer_store_dwordx4 v[124:127], v16, s[52:55], s83 offen offset:1024 sc1
v_cvt_pk_bf16_f32 v132, v132, v133
v_cvt_pk_bf16_f32 v133, v134, v135
s_nop 0
v_cvt_pk_bf16_f32 v134, v136, v137
v_cvt_pk_bf16_f32 v135, v138, v139
buffer_store_dwordx4 v[132:135], v16, s[52:55], s83 offen offset:3072 sc1
s_branch LM_pub
LM_light:
s_waitcnt lgkmcnt(0)
s_mov_b32 s98, 0x7c3ff80
s_load_dwordx2 s[98:99], s[38:39], s98
s_branch L1_fin
LM_edge:
s_sub_u32 s4, s3, 30
s_lshl_b32 s8, s8, 1
s_add_u32 s4, s4, s8
s_add_u32 s91, s4, 240
s_cmp_lt_u32 s4, 8
s_cselect_b32 s61, 1, 0
s_and_b32 s6, s5, 7
s_lshl_b32 s6, s6, 14
v_lshlrev_b32 v10, 7, v2
s_waitcnt lgkmcnt(0)
s_add_u32 s40, s26, 0x0
s_addc_u32 s41, s27, 0
s_mov_b32 s42, 0x20000
s_mov_b32 s43, 0x00020000
s_add_u32 s44, s28, 0x0
s_addc_u32 s45, s29, 0
s_mov_b32 s46, 0x20000
s_mov_b32 s47, 0x00020000
s_add_u32 s7, s6, 0
buffer_load_dword v250, v10, s[40:43], s7 offen
s_add_u32 s7, s6, 8192
buffer_load_dword v251, v10, s[40:43], s7 offen
s_add_u32 s7, s6, 0
buffer_load_dword v252, v10, s[44:47], s7 offen
s_add_u32 s7, s6, 8192
buffer_load_dword v253, v10, s[44:47], s7 offen
s_mul_i32 s6, s4, 40000
v_lshlrev_b32 v5, 4, v0
v_lshlrev_b32 v6, 2, v2
v_add_u32 v6, 0x10000, v6
v_mov_b32 v7, 0
ds_write_b32 v6, v7
s_mov_b32 s66, 0
s_mov_b32 s67, 4096
s_mov_b32 s68, 8192
s_mov_b32 s69, 12288
s_mov_b32 s70, 16384
s_mov_b32 s71, 20480
s_mov_b32 s72, 24576
s_mov_b32 s73, 28672
s_mov_b32 s74, 32768
s_mov_b32 s75, 36864
s_waitcnt lgkmcnt(0)
s_add_u32 s40, s20, 0x0
s_addc_u32 s41, s21, 0
s_add_u32 s40, s40, s6
s_addc_u32 s41, s41, 0
s_mov_b32 s42, 0x9c40
s_mov_b32 s43, 0x00020000
s_add_u32 s44, s18, 0x0
s_addc_u32 s45, s19, 0
s_add_u32 s44, s44, s6
s_addc_u32 s45, s45, 0
s_mov_b32 s46, 0x9c40
s_mov_b32 s47, 0x00020000
buffer_load_dwordx4 v[16:19], v5, s[40:43], s66 offen
buffer_load_dwordx4 v[20:23], v5, s[40:43], s67 offen
buffer_load_dwordx4 v[24:27], v5, s[40:43], s68 offen
buffer_load_dwordx4 v[28:31], v5, s[40:43], s69 offen
buffer_load_dwordx4 v[32:35], v5, s[40:43], s70 offen
buffer_load_dwordx4 v[36:39], v5, s[40:43], s71 offen
buffer_load_dwordx4 v[40:43], v5, s[40:43], s72 offen
buffer_load_dwordx4 v[44:47], v5, s[40:43], s73 offen
buffer_load_dwordx4 v[48:51], v5, s[40:43], s74 offen
buffer_load_dwordx4 v[52:55], v5, s[40:43], s75 offen
buffer_load_dwordx4 v[56:59], v5, s[44:47], s66 offen
buffer_load_dwordx4 v[60:63], v5, s[44:47], s67 offen
buffer_load_dwordx4 v[64:67], v5, s[44:47], s68 offen
buffer_load_dwordx4 v[68:71], v5, s[44:47], s69 offen
buffer_load_dwordx4 v[72:75], v5, s[44:47], s70 offen
buffer_load_dwordx4 v[76:79], v5, s[44:47], s71 offen
buffer_load_dwordx4 v[80:83], v5, s[44:47], s72 offen
buffer_load_dwordx4 v[84:87], v5, s[44:47], s73 offen
buffer_load_dwordx4 v[88:91], v5, s[44:47], s74 offen
buffer_load_dwordx4 v[92:95], v5, s[44:47], s75 offen
s_mov_b32 s98, 0x7c3ff80
s_load_dwordx2 s[98:99], s[38:39], s98
s_add_u32 s48, s38, 0x8000000
s_addc_u32 s49, s39, 0
s_mov_b32 s50, 0x2800000
s_mov_b32 s51, 0x00020000
s_add_u32 s52, s38, 0x7800000
s_addc_u32 s53, s39, 0
s_mov_b32 s54, 0x1000
s_mov_b32 s55, 0x00020000
v_mov_b32 v240, 6809
v_mov_b32 v241, 0x0
v_mov_b32 v242, 6205
v_mov_b32 v243, 0x220f50
v_mov_b32 v244, 7437
v_mov_b32 v245, 0xff904e58
s_mov_b32 s11, 0x10000
v_mov_b32 v7, 1
v_cmp_gt_u32 vcc, 0xc4, v0
s_mov_b64 s[12:13], vcc
s_barrier
s_waitcnt vmcnt(19)
v_cmp_le_u32 vcc, 3696, v16
s_nop 1
v_cndmask_b32 v96, v240, v242, vcc
v_cndmask_b32 v136, v241, v243, vcc
v_cmp_le_u32 vcc, 7752, v16
s_nop 1
v_cndmask_b32 v96, v96, v244, vcc
v_cndmask_b32 v136, v136, v245, vcc
v_mad_u32_u24 v96, v96, v16, v136
v_lshrrev_b32 v96, 20, v96
v_lshl_add_u32 v136, v96, 2, s11
ds_add_rtn_u32 v136, v136, v7
v_cmp_le_u32 vcc, 3696, v17
s_nop 1
v_cndmask_b32 v97, v240, v242, vcc
v_cndmask_b32 v137, v241, v243, vcc
v_cmp_le_u32 vcc, 7752, v17
s_nop 1
v_cndmask_b32 v97, v97, v244, vcc
v_cndmask_b32 v137, v137, v245, vcc
v_mad_u32_u24 v97, v97, v17, v137
v_lshrrev_b32 v97, 20, v97
v_lshl_add_u32 v137, v97, 2, s11
ds_add_rtn_u32 v137, v137, v7
v_cmp_le_u32 vcc, 3696, v18
s_nop 1
v_cndmask_b32 v98, v240, v242, vcc
v_cndmask_b32 v138, v241, v243, vcc
v_cmp_le_u32 vcc, 7752, v18
s_nop 1
v_cndmask_b32 v98, v98, v244, vcc
v_cndmask_b32 v138, v138, v245, vcc
v_mad_u32_u24 v98, v98, v18, v138
v_lshrrev_b32 v98, 20, v98
v_lshl_add_u32 v138, v98, 2, s11
ds_add_rtn_u32 v138, v138, v7
v_cmp_le_u32 vcc, 3696, v19
s_nop 1
v_cndmask_b32 v99, v240, v242, vcc
v_cndmask_b32 v139, v241, v243, vcc
v_cmp_le_u32 vcc, 7752, v19
s_nop 1
v_cndmask_b32 v99, v99, v244, vcc
v_cndmask_b32 v139, v139, v245, vcc
v_mad_u32_u24 v99, v99, v19, v139
v_lshrrev_b32 v99, 20, v99
v_lshl_add_u32 v139, v99, 2, s11
ds_add_rtn_u32 v139, v139, v7
s_waitcnt vmcnt(18)
v_cmp_le_u32 vcc, 3696, v20
s_nop 1
v_cndmask_b32 v100, v240, v242, vcc
v_cndmask_b32 v140, v241, v243, vcc
v_cmp_le_u32 vcc, 7752, v20
s_nop 1
v_cndmask_b32 v100, v100, v244, vcc
v_cndmask_b32 v140, v140, v245, vcc
v_mad_u32_u24 v100, v100, v20, v140
v_lshrrev_b32 v100, 20, v100
v_lshl_add_u32 v140, v100, 2, s11
ds_add_rtn_u32 v140, v140, v7
v_cmp_le_u32 vcc, 3696, v21
s_nop 1
v_cndmask_b32 v101, v240, v242, vcc
v_cndmask_b32 v141, v241, v243, vcc
v_cmp_le_u32 vcc, 7752, v21
s_nop 1
v_cndmask_b32 v101, v101, v244, vcc
v_cndmask_b32 v141, v141, v245, vcc
v_mad_u32_u24 v101, v101, v21, v141
v_lshrrev_b32 v101, 20, v101
v_lshl_add_u32 v141, v101, 2, s11
ds_add_rtn_u32 v141, v141, v7
v_cmp_le_u32 vcc, 3696, v22
s_nop 1
v_cndmask_b32 v102, v240, v242, vcc
v_cndmask_b32 v142, v241, v243, vcc
v_cmp_le_u32 vcc, 7752, v22
s_nop 1
v_cndmask_b32 v102, v102, v244, vcc
v_cndmask_b32 v142, v142, v245, vcc
v_mad_u32_u24 v102, v102, v22, v142
v_lshrrev_b32 v102, 20, v102
v_lshl_add_u32 v142, v102, 2, s11
ds_add_rtn_u32 v142, v142, v7
v_cmp_le_u32 vcc, 3696, v23
s_nop 1
v_cndmask_b32 v103, v240, v242, vcc
v_cndmask_b32 v143, v241, v243, vcc
v_cmp_le_u32 vcc, 7752, v23
s_nop 1
v_cndmask_b32 v103, v103, v244, vcc
v_cndmask_b32 v143, v143, v245, vcc
v_mad_u32_u24 v103, v103, v23, v143
v_lshrrev_b32 v103, 20, v103
v_lshl_add_u32 v143, v103, 2, s11
ds_add_rtn_u32 v143, v143, v7
s_waitcnt vmcnt(17)
v_cmp_le_u32 vcc, 3696, v24
s_nop 1
v_cndmask_b32 v104, v240, v242, vcc
v_cndmask_b32 v144, v241, v243, vcc
v_cmp_le_u32 vcc, 7752, v24
s_nop 1
v_cndmask_b32 v104, v104, v244, vcc
v_cndmask_b32 v144, v144, v245, vcc
v_mad_u32_u24 v104, v104, v24, v144
v_lshrrev_b32 v104, 20, v104
v_lshl_add_u32 v144, v104, 2, s11
ds_add_rtn_u32 v144, v144, v7
v_cmp_le_u32 vcc, 3696, v25
s_nop 1
v_cndmask_b32 v105, v240, v242, vcc
v_cndmask_b32 v145, v241, v243, vcc
v_cmp_le_u32 vcc, 7752, v25
s_nop 1
v_cndmask_b32 v105, v105, v244, vcc
v_cndmask_b32 v145, v145, v245, vcc
v_mad_u32_u24 v105, v105, v25, v145
v_lshrrev_b32 v105, 20, v105
v_lshl_add_u32 v145, v105, 2, s11
ds_add_rtn_u32 v145, v145, v7
v_cmp_le_u32 vcc, 3696, v26
s_nop 1
v_cndmask_b32 v106, v240, v242, vcc
v_cndmask_b32 v146, v241, v243, vcc
v_cmp_le_u32 vcc, 7752, v26
s_nop 1
v_cndmask_b32 v106, v106, v244, vcc
v_cndmask_b32 v146, v146, v245, vcc
v_mad_u32_u24 v106, v106, v26, v146
v_lshrrev_b32 v106, 20, v106
v_lshl_add_u32 v146, v106, 2, s11
ds_add_rtn_u32 v146, v146, v7
v_cmp_le_u32 vcc, 3696, v27
s_nop 1
v_cndmask_b32 v107, v240, v242, vcc
v_cndmask_b32 v147, v241, v243, vcc
v_cmp_le_u32 vcc, 7752, v27
s_nop 1
v_cndmask_b32 v107, v107, v244, vcc
v_cndmask_b32 v147, v147, v245, vcc
v_mad_u32_u24 v107, v107, v27, v147
v_lshrrev_b32 v107, 20, v107
v_lshl_add_u32 v147, v107, 2, s11
ds_add_rtn_u32 v147, v147, v7
s_waitcnt vmcnt(16)
v_cmp_le_u32 vcc, 3696, v28
s_nop 1
v_cndmask_b32 v108, v240, v242, vcc
v_cndmask_b32 v148, v241, v243, vcc
v_cmp_le_u32 vcc, 7752, v28
s_nop 1
v_cndmask_b32 v108, v108, v244, vcc
v_cndmask_b32 v148, v148, v245, vcc
v_mad_u32_u24 v108, v108, v28, v148
v_lshrrev_b32 v108, 20, v108
v_lshl_add_u32 v148, v108, 2, s11
ds_add_rtn_u32 v148, v148, v7
v_cmp_le_u32 vcc, 3696, v29
s_nop 1
v_cndmask_b32 v109, v240, v242, vcc
v_cndmask_b32 v149, v241, v243, vcc
v_cmp_le_u32 vcc, 7752, v29
s_nop 1
v_cndmask_b32 v109, v109, v244, vcc
v_cndmask_b32 v149, v149, v245, vcc
v_mad_u32_u24 v109, v109, v29, v149
v_lshrrev_b32 v109, 20, v109
v_lshl_add_u32 v149, v109, 2, s11
ds_add_rtn_u32 v149, v149, v7
v_cmp_le_u32 vcc, 3696, v30
s_nop 1
v_cndmask_b32 v110, v240, v242, vcc
v_cndmask_b32 v150, v241, v243, vcc
v_cmp_le_u32 vcc, 7752, v30
s_nop 1
v_cndmask_b32 v110, v110, v244, vcc
v_cndmask_b32 v150, v150, v245, vcc
v_mad_u32_u24 v110, v110, v30, v150
v_lshrrev_b32 v110, 20, v110
v_lshl_add_u32 v150, v110, 2, s11
ds_add_rtn_u32 v150, v150, v7
v_cmp_le_u32 vcc, 3696, v31
s_nop 1
v_cndmask_b32 v111, v240, v242, vcc
v_cndmask_b32 v151, v241, v243, vcc
v_cmp_le_u32 vcc, 7752, v31
s_nop 1
v_cndmask_b32 v111, v111, v244, vcc
v_cndmask_b32 v151, v151, v245, vcc
v_mad_u32_u24 v111, v111, v31, v151
v_lshrrev_b32 v111, 20, v111
v_lshl_add_u32 v151, v111, 2, s11
ds_add_rtn_u32 v151, v151, v7
s_waitcnt vmcnt(15)
v_cmp_le_u32 vcc, 3696, v32
s_nop 1
v_cndmask_b32 v112, v240, v242, vcc
v_cndmask_b32 v152, v241, v243, vcc
v_cmp_le_u32 vcc, 7752, v32
s_nop 1
v_cndmask_b32 v112, v112, v244, vcc
v_cndmask_b32 v152, v152, v245, vcc
v_mad_u32_u24 v112, v112, v32, v152
v_lshrrev_b32 v112, 20, v112
v_lshl_add_u32 v152, v112, 2, s11
ds_add_rtn_u32 v152, v152, v7
v_cmp_le_u32 vcc, 3696, v33
s_nop 1
v_cndmask_b32 v113, v240, v242, vcc
v_cndmask_b32 v153, v241, v243, vcc
v_cmp_le_u32 vcc, 7752, v33
s_nop 1
v_cndmask_b32 v113, v113, v244, vcc
v_cndmask_b32 v153, v153, v245, vcc
v_mad_u32_u24 v113, v113, v33, v153
v_lshrrev_b32 v113, 20, v113
v_lshl_add_u32 v153, v113, 2, s11
ds_add_rtn_u32 v153, v153, v7
v_cmp_le_u32 vcc, 3696, v34
s_nop 1
v_cndmask_b32 v114, v240, v242, vcc
v_cndmask_b32 v154, v241, v243, vcc
v_cmp_le_u32 vcc, 7752, v34
s_nop 1
v_cndmask_b32 v114, v114, v244, vcc
v_cndmask_b32 v154, v154, v245, vcc
v_mad_u32_u24 v114, v114, v34, v154
v_lshrrev_b32 v114, 20, v114
v_lshl_add_u32 v154, v114, 2, s11
ds_add_rtn_u32 v154, v154, v7
v_cmp_le_u32 vcc, 3696, v35
s_nop 1
v_cndmask_b32 v115, v240, v242, vcc
v_cndmask_b32 v155, v241, v243, vcc
v_cmp_le_u32 vcc, 7752, v35
s_nop 1
v_cndmask_b32 v115, v115, v244, vcc
v_cndmask_b32 v155, v155, v245, vcc
v_mad_u32_u24 v115, v115, v35, v155
v_lshrrev_b32 v115, 20, v115
v_lshl_add_u32 v155, v115, 2, s11
ds_add_rtn_u32 v155, v155, v7
s_waitcnt vmcnt(14)
v_cmp_le_u32 vcc, 3696, v36
s_nop 1
v_cndmask_b32 v116, v240, v242, vcc
v_cndmask_b32 v156, v241, v243, vcc
v_cmp_le_u32 vcc, 7752, v36
s_nop 1
v_cndmask_b32 v116, v116, v244, vcc
v_cndmask_b32 v156, v156, v245, vcc
v_mad_u32_u24 v116, v116, v36, v156
v_lshrrev_b32 v116, 20, v116
v_lshl_add_u32 v156, v116, 2, s11
ds_add_rtn_u32 v156, v156, v7
v_cmp_le_u32 vcc, 3696, v37
s_nop 1
v_cndmask_b32 v117, v240, v242, vcc
v_cndmask_b32 v157, v241, v243, vcc
v_cmp_le_u32 vcc, 7752, v37
s_nop 1
v_cndmask_b32 v117, v117, v244, vcc
v_cndmask_b32 v157, v157, v245, vcc
v_mad_u32_u24 v117, v117, v37, v157
v_lshrrev_b32 v117, 20, v117
v_lshl_add_u32 v157, v117, 2, s11
ds_add_rtn_u32 v157, v157, v7
v_cmp_le_u32 vcc, 3696, v38
s_nop 1
v_cndmask_b32 v118, v240, v242, vcc
v_cndmask_b32 v158, v241, v243, vcc
v_cmp_le_u32 vcc, 7752, v38
s_nop 1
v_cndmask_b32 v118, v118, v244, vcc
v_cndmask_b32 v158, v158, v245, vcc
v_mad_u32_u24 v118, v118, v38, v158
v_lshrrev_b32 v118, 20, v118
v_lshl_add_u32 v158, v118, 2, s11
ds_add_rtn_u32 v158, v158, v7
v_cmp_le_u32 vcc, 3696, v39
s_nop 1
v_cndmask_b32 v119, v240, v242, vcc
v_cndmask_b32 v159, v241, v243, vcc
v_cmp_le_u32 vcc, 7752, v39
s_nop 1
v_cndmask_b32 v119, v119, v244, vcc
v_cndmask_b32 v159, v159, v245, vcc
v_mad_u32_u24 v119, v119, v39, v159
v_lshrrev_b32 v119, 20, v119
v_lshl_add_u32 v159, v119, 2, s11
ds_add_rtn_u32 v159, v159, v7
s_waitcnt vmcnt(13)
v_cmp_le_u32 vcc, 3696, v40
s_nop 1
v_cndmask_b32 v120, v240, v242, vcc
v_cndmask_b32 v160, v241, v243, vcc
v_cmp_le_u32 vcc, 7752, v40
s_nop 1
v_cndmask_b32 v120, v120, v244, vcc
v_cndmask_b32 v160, v160, v245, vcc
v_mad_u32_u24 v120, v120, v40, v160
v_lshrrev_b32 v120, 20, v120
v_lshl_add_u32 v160, v120, 2, s11
ds_add_rtn_u32 v160, v160, v7
v_cmp_le_u32 vcc, 3696, v41
s_nop 1
v_cndmask_b32 v121, v240, v242, vcc
v_cndmask_b32 v161, v241, v243, vcc
v_cmp_le_u32 vcc, 7752, v41
s_nop 1
v_cndmask_b32 v121, v121, v244, vcc
v_cndmask_b32 v161, v161, v245, vcc
v_mad_u32_u24 v121, v121, v41, v161
v_lshrrev_b32 v121, 20, v121
v_lshl_add_u32 v161, v121, 2, s11
ds_add_rtn_u32 v161, v161, v7
v_cmp_le_u32 vcc, 3696, v42
s_nop 1
v_cndmask_b32 v122, v240, v242, vcc
v_cndmask_b32 v162, v241, v243, vcc
v_cmp_le_u32 vcc, 7752, v42
s_nop 1
v_cndmask_b32 v122, v122, v244, vcc
v_cndmask_b32 v162, v162, v245, vcc
v_mad_u32_u24 v122, v122, v42, v162
v_lshrrev_b32 v122, 20, v122
v_lshl_add_u32 v162, v122, 2, s11
ds_add_rtn_u32 v162, v162, v7
v_cmp_le_u32 vcc, 3696, v43
s_nop 1
v_cndmask_b32 v123, v240, v242, vcc
v_cndmask_b32 v163, v241, v243, vcc
v_cmp_le_u32 vcc, 7752, v43
s_nop 1
v_cndmask_b32 v123, v123, v244, vcc
v_cndmask_b32 v163, v163, v245, vcc
v_mad_u32_u24 v123, v123, v43, v163
v_lshrrev_b32 v123, 20, v123
v_lshl_add_u32 v163, v123, 2, s11
ds_add_rtn_u32 v163, v163, v7
s_waitcnt vmcnt(12)
v_cmp_le_u32 vcc, 3696, v44
s_nop 1
v_cndmask_b32 v124, v240, v242, vcc
v_cndmask_b32 v164, v241, v243, vcc
v_cmp_le_u32 vcc, 7752, v44
s_nop 1
v_cndmask_b32 v124, v124, v244, vcc
v_cndmask_b32 v164, v164, v245, vcc
v_mad_u32_u24 v124, v124, v44, v164
v_lshrrev_b32 v124, 20, v124
v_lshl_add_u32 v164, v124, 2, s11
ds_add_rtn_u32 v164, v164, v7
v_cmp_le_u32 vcc, 3696, v45
s_nop 1
v_cndmask_b32 v125, v240, v242, vcc
v_cndmask_b32 v165, v241, v243, vcc
v_cmp_le_u32 vcc, 7752, v45
s_nop 1
v_cndmask_b32 v125, v125, v244, vcc
v_cndmask_b32 v165, v165, v245, vcc
v_mad_u32_u24 v125, v125, v45, v165
v_lshrrev_b32 v125, 20, v125
v_lshl_add_u32 v165, v125, 2, s11
ds_add_rtn_u32 v165, v165, v7
v_cmp_le_u32 vcc, 3696, v46
s_nop 1
v_cndmask_b32 v126, v240, v242, vcc
v_cndmask_b32 v166, v241, v243, vcc
v_cmp_le_u32 vcc, 7752, v46
s_nop 1
v_cndmask_b32 v126, v126, v244, vcc
v_cndmask_b32 v166, v166, v245, vcc
v_mad_u32_u24 v126, v126, v46, v166
v_lshrrev_b32 v126, 20, v126
v_lshl_add_u32 v166, v126, 2, s11
ds_add_rtn_u32 v166, v166, v7
v_cmp_le_u32 vcc, 3696, v47
s_nop 1
v_cndmask_b32 v127, v240, v242, vcc
v_cndmask_b32 v167, v241, v243, vcc
v_cmp_le_u32 vcc, 7752, v47
s_nop 1
v_cndmask_b32 v127, v127, v244, vcc
v_cndmask_b32 v167, v167, v245, vcc
v_mad_u32_u24 v127, v127, v47, v167
v_lshrrev_b32 v127, 20, v127
v_lshl_add_u32 v167, v127, 2, s11
ds_add_rtn_u32 v167, v167, v7
s_waitcnt vmcnt(11)
v_cmp_le_u32 vcc, 3696, v48
s_nop 1
v_cndmask_b32 v128, v240, v242, vcc
v_cndmask_b32 v168, v241, v243, vcc
v_cmp_le_u32 vcc, 7752, v48
s_nop 1
v_cndmask_b32 v128, v128, v244, vcc
v_cndmask_b32 v168, v168, v245, vcc
v_mad_u32_u24 v128, v128, v48, v168
v_lshrrev_b32 v128, 20, v128
v_lshl_add_u32 v168, v128, 2, s11
ds_add_rtn_u32 v168, v168, v7
v_cmp_le_u32 vcc, 3696, v49
s_nop 1
v_cndmask_b32 v129, v240, v242, vcc
v_cndmask_b32 v169, v241, v243, vcc
v_cmp_le_u32 vcc, 7752, v49
s_nop 1
v_cndmask_b32 v129, v129, v244, vcc
v_cndmask_b32 v169, v169, v245, vcc
v_mad_u32_u24 v129, v129, v49, v169
v_lshrrev_b32 v129, 20, v129
v_lshl_add_u32 v169, v129, 2, s11
ds_add_rtn_u32 v169, v169, v7
v_cmp_le_u32 vcc, 3696, v50
s_nop 1
v_cndmask_b32 v130, v240, v242, vcc
v_cndmask_b32 v170, v241, v243, vcc
v_cmp_le_u32 vcc, 7752, v50
s_nop 1
v_cndmask_b32 v130, v130, v244, vcc
v_cndmask_b32 v170, v170, v245, vcc
v_mad_u32_u24 v130, v130, v50, v170
v_lshrrev_b32 v130, 20, v130
v_lshl_add_u32 v170, v130, 2, s11
ds_add_rtn_u32 v170, v170, v7
v_cmp_le_u32 vcc, 3696, v51
s_nop 1
v_cndmask_b32 v131, v240, v242, vcc
v_cndmask_b32 v171, v241, v243, vcc
v_cmp_le_u32 vcc, 7752, v51
s_nop 1
v_cndmask_b32 v131, v131, v244, vcc
v_cndmask_b32 v171, v171, v245, vcc
v_mad_u32_u24 v131, v131, v51, v171
v_lshrrev_b32 v131, 20, v131
v_lshl_add_u32 v171, v131, 2, s11
ds_add_rtn_u32 v171, v171, v7
s_waitcnt vmcnt(10)
s_mov_b64 exec, s[12:13]
v_cmp_le_u32 vcc, 3696, v52
s_nop 1
v_cndmask_b32 v132, v240, v242, vcc
v_cndmask_b32 v172, v241, v243, vcc
v_cmp_le_u32 vcc, 7752, v52
s_nop 1
v_cndmask_b32 v132, v132, v244, vcc
v_cndmask_b32 v172, v172, v245, vcc
v_mad_u32_u24 v132, v132, v52, v172
v_lshrrev_b32 v132, 20, v132
v_lshl_add_u32 v172, v132, 2, s11
ds_add_rtn_u32 v172, v172, v7
v_cmp_le_u32 vcc, 3696, v53
s_nop 1
v_cndmask_b32 v133, v240, v242, vcc
v_cndmask_b32 v173, v241, v243, vcc
v_cmp_le_u32 vcc, 7752, v53
s_nop 1
v_cndmask_b32 v133, v133, v244, vcc
v_cndmask_b32 v173, v173, v245, vcc
v_mad_u32_u24 v133, v133, v53, v173
v_lshrrev_b32 v133, 20, v133
v_lshl_add_u32 v173, v133, 2, s11
ds_add_rtn_u32 v173, v173, v7
v_cmp_le_u32 vcc, 3696, v54
s_nop 1
v_cndmask_b32 v134, v240, v242, vcc
v_cndmask_b32 v174, v241, v243, vcc
v_cmp_le_u32 vcc, 7752, v54
s_nop 1
v_cndmask_b32 v134, v134, v244, vcc
v_cndmask_b32 v174, v174, v245, vcc
v_mad_u32_u24 v134, v134, v54, v174
v_lshrrev_b32 v134, 20, v134
v_lshl_add_u32 v174, v134, 2, s11
ds_add_rtn_u32 v174, v174, v7
v_cmp_le_u32 vcc, 3696, v55
s_nop 1
v_cndmask_b32 v135, v240, v242, vcc
v_cndmask_b32 v175, v241, v243, vcc
v_cmp_le_u32 vcc, 7752, v55
s_nop 1
v_cndmask_b32 v135, v135, v244, vcc
v_cndmask_b32 v175, v175, v245, vcc
v_mad_u32_u24 v135, v135, v55, v175
v_lshrrev_b32 v135, 20, v135
v_lshl_add_u32 v175, v135, 2, s11
ds_add_rtn_u32 v175, v175, v7
s_mov_b64 exec, -1
s_waitcnt vmcnt(9) lgkmcnt(15)
v_and_b32 v8, 0xff, v136
v_lshl_or_b32 v56, v16, 18, v56
v_lshlrev_b32 v8, 2, v8
v_lshl_add_u32 v8, v96, 10, v8
ds_write_b32 v8, v56
v_and_b32 v8, 0xff, v137
v_lshl_or_b32 v57, v17, 18, v57
v_lshlrev_b32 v8, 2, v8
v_lshl_add_u32 v8, v97, 10, v8
ds_write_b32 v8, v57
v_and_b32 v8, 0xff, v138
v_lshl_or_b32 v58, v18, 18, v58
v_lshlrev_b32 v8, 2, v8
v_lshl_add_u32 v8, v98, 10, v8
ds_write_b32 v8, v58
v_and_b32 v8, 0xff, v139
v_lshl_or_b32 v59, v19, 18, v59
v_lshlrev_b32 v8, 2, v8
v_lshl_add_u32 v8, v99, 10, v8
ds_write_b32 v8, v59
s_waitcnt vmcnt(8) lgkmcnt(15)
v_and_b32 v8, 0xff, v140
v_lshl_or_b32 v60, v20, 18, v60
v_lshlrev_b32 v8, 2, v8
v_lshl_add_u32 v8, v100, 10, v8
ds_write_b32 v8, v60
v_and_b32 v8, 0xff, v141
v_lshl_or_b32 v61, v21, 18, v61
v_lshlrev_b32 v8, 2, v8
v_lshl_add_u32 v8, v101, 10, v8
ds_write_b32 v8, v61
v_and_b32 v8, 0xff, v142
v_lshl_or_b32 v62, v22, 18, v62
v_lshlrev_b32 v8, 2, v8
v_lshl_add_u32 v8, v102, 10, v8
ds_write_b32 v8, v62
v_and_b32 v8, 0xff, v143
v_lshl_or_b32 v63, v23, 18, v63
v_lshlrev_b32 v8, 2, v8
v_lshl_add_u32 v8, v103, 10, v8
ds_write_b32 v8, v63
s_waitcnt vmcnt(7) lgkmcnt(15)
v_and_b32 v8, 0xff, v144
v_lshl_or_b32 v64, v24, 18, v64
v_lshlrev_b32 v8, 2, v8
v_lshl_add_u32 v8, v104, 10, v8
ds_write_b32 v8, v64
v_and_b32 v8, 0xff, v145
v_lshl_or_b32 v65, v25, 18, v65
v_lshlrev_b32 v8, 2, v8
v_lshl_add_u32 v8, v105, 10, v8
ds_write_b32 v8, v65
v_and_b32 v8, 0xff, v146
v_lshl_or_b32 v66, v26, 18, v66
v_lshlrev_b32 v8, 2, v8
v_lshl_add_u32 v8, v106, 10, v8
ds_write_b32 v8, v66
v_and_b32 v8, 0xff, v147
v_lshl_or_b32 v67, v27, 18, v67
v_lshlrev_b32 v8, 2, v8
v_lshl_add_u32 v8, v107, 10, v8
ds_write_b32 v8, v67
s_waitcnt vmcnt(6) lgkmcnt(15)
v_and_b32 v8, 0xff, v148
v_lshl_or_b32 v68, v28, 18, v68
v_lshlrev_b32 v8, 2, v8
v_lshl_add_u32 v8, v108, 10, v8
ds_write_b32 v8, v68
v_and_b32 v8, 0xff, v149
v_lshl_or_b32 v69, v29, 18, v69
v_lshlrev_b32 v8, 2, v8
v_lshl_add_u32 v8, v109, 10, v8
ds_write_b32 v8, v69
v_and_b32 v8, 0xff, v150
v_lshl_or_b32 v70, v30, 18, v70
v_lshlrev_b32 v8, 2, v8
v_lshl_add_u32 v8, v110, 10, v8
ds_write_b32 v8, v70
v_and_b32 v8, 0xff, v151
v_lshl_or_b32 v71, v31, 18, v71
v_lshlrev_b32 v8, 2, v8
v_lshl_add_u32 v8, v111, 10, v8
ds_write_b32 v8, v71
s_waitcnt vmcnt(5) lgkmcnt(15)
v_and_b32 v8, 0xff, v152
v_lshl_or_b32 v72, v32, 18, v72
v_lshlrev_b32 v8, 2, v8
v_lshl_add_u32 v8, v112, 10, v8
ds_write_b32 v8, v72
v_and_b32 v8, 0xff, v153
v_lshl_or_b32 v73, v33, 18, v73
v_lshlrev_b32 v8, 2, v8
v_lshl_add_u32 v8, v113, 10, v8
ds_write_b32 v8, v73
v_and_b32 v8, 0xff, v154
v_lshl_or_b32 v74, v34, 18, v74
v_lshlrev_b32 v8, 2, v8
v_lshl_add_u32 v8, v114, 10, v8
ds_write_b32 v8, v74
v_and_b32 v8, 0xff, v155
v_lshl_or_b32 v75, v35, 18, v75
v_lshlrev_b32 v8, 2, v8
v_lshl_add_u32 v8, v115, 10, v8
ds_write_b32 v8, v75
s_waitcnt vmcnt(4) lgkmcnt(15)
v_and_b32 v8, 0xff, v156
v_lshl_or_b32 v76, v36, 18, v76
v_lshlrev_b32 v8, 2, v8
v_lshl_add_u32 v8, v116, 10, v8
ds_write_b32 v8, v76
v_and_b32 v8, 0xff, v157
v_lshl_or_b32 v77, v37, 18, v77
v_lshlrev_b32 v8, 2, v8
v_lshl_add_u32 v8, v117, 10, v8
ds_write_b32 v8, v77
v_and_b32 v8, 0xff, v158
v_lshl_or_b32 v78, v38, 18, v78
v_lshlrev_b32 v8, 2, v8
v_lshl_add_u32 v8, v118, 10, v8
ds_write_b32 v8, v78
v_and_b32 v8, 0xff, v159
v_lshl_or_b32 v79, v39, 18, v79
v_lshlrev_b32 v8, 2, v8
v_lshl_add_u32 v8, v119, 10, v8
ds_write_b32 v8, v79
s_waitcnt vmcnt(3) lgkmcnt(15)
v_and_b32 v8, 0xff, v160
v_lshl_or_b32 v80, v40, 18, v80
v_lshlrev_b32 v8, 2, v8
v_lshl_add_u32 v8, v120, 10, v8
ds_write_b32 v8, v80
v_and_b32 v8, 0xff, v161
v_lshl_or_b32 v81, v41, 18, v81
v_lshlrev_b32 v8, 2, v8
v_lshl_add_u32 v8, v121, 10, v8
ds_write_b32 v8, v81
v_and_b32 v8, 0xff, v162
v_lshl_or_b32 v82, v42, 18, v82
v_lshlrev_b32 v8, 2, v8
v_lshl_add_u32 v8, v122, 10, v8
ds_write_b32 v8, v82
v_and_b32 v8, 0xff, v163
v_lshl_or_b32 v83, v43, 18, v83
v_lshlrev_b32 v8, 2, v8
v_lshl_add_u32 v8, v123, 10, v8
ds_write_b32 v8, v83
s_waitcnt vmcnt(2) lgkmcnt(15)
v_and_b32 v8, 0xff, v164
v_lshl_or_b32 v84, v44, 18, v84
v_lshlrev_b32 v8, 2, v8
v_lshl_add_u32 v8, v124, 10, v8
ds_write_b32 v8, v84
v_and_b32 v8, 0xff, v165
v_lshl_or_b32 v85, v45, 18, v85
v_lshlrev_b32 v8, 2, v8
v_lshl_add_u32 v8, v125, 10, v8
ds_write_b32 v8, v85
v_and_b32 v8, 0xff, v166
v_lshl_or_b32 v86, v46, 18, v86
v_lshlrev_b32 v8, 2, v8
v_lshl_add_u32 v8, v126, 10, v8
ds_write_b32 v8, v86
v_and_b32 v8, 0xff, v167
v_lshl_or_b32 v87, v47, 18, v87
v_lshlrev_b32 v8, 2, v8
v_lshl_add_u32 v8, v127, 10, v8
ds_write_b32 v8, v87
s_waitcnt vmcnt(1) lgkmcnt(15)
v_and_b32 v8, 0xff, v168
v_lshl_or_b32 v88, v48, 18, v88
v_lshlrev_b32 v8, 2, v8
v_lshl_add_u32 v8, v128, 10, v8
ds_write_b32 v8, v88
v_and_b32 v8, 0xff, v169
v_lshl_or_b32 v89, v49, 18, v89
v_lshlrev_b32 v8, 2, v8
v_lshl_add_u32 v8, v129, 10, v8
ds_write_b32 v8, v89
v_and_b32 v8, 0xff, v170
v_lshl_or_b32 v90, v50, 18, v90
v_lshlrev_b32 v8, 2, v8
v_lshl_add_u32 v8, v130, 10, v8
ds_write_b32 v8, v90
v_and_b32 v8, 0xff, v171
v_lshl_or_b32 v91, v51, 18, v91
v_lshlrev_b32 v8, 2, v8
v_lshl_add_u32 v8, v131, 10, v8
ds_write_b32 v8, v91
s_waitcnt vmcnt(0) lgkmcnt(15)
s_mov_b64 exec, s[12:13]
v_and_b32 v8, 0xff, v172
v_lshl_or_b32 v92, v52, 18, v92
v_lshlrev_b32 v8, 2, v8
v_lshl_add_u32 v8, v132, 10, v8
ds_write_b32 v8, v92
v_and_b32 v8, 0xff, v173
v_lshl_or_b32 v93, v53, 18, v93
v_lshlrev_b32 v8, 2, v8
v_lshl_add_u32 v8, v133, 10, v8
ds_write_b32 v8, v93
v_and_b32 v8, 0xff, v174
v_lshl_or_b32 v94, v54, 18, v94
v_lshlrev_b32 v8, 2, v8
v_lshl_add_u32 v8, v134, 10, v8
ds_write_b32 v8, v94
v_and_b32 v8, 0xff, v175
v_lshl_or_b32 v95, v55, 18, v95
v_lshlrev_b32 v8, 2, v8
v_lshl_add_u32 v8, v135, 10, v8
ds_write_b32 v8, v95
s_mov_b64 exec, -1
s_waitcnt lgkmcnt(0)
s_barrier
ds_read_b32 v8, v6
s_mul_i32 s6, s60, 16384
v_lshlrev_b32 v10, 4, v2
v_add_u32 v9, s6, v10
ds_read_b128 v[176:179], v9 offset:0
ds_read_b128 v[180:183], v9 offset:1024
ds_read_b128 v[184:187], v9 offset:2048
ds_read_b128 v[188:191], v9 offset:3072
ds_read_b128 v[192:195], v9 offset:4096
ds_read_b128 v[196:199], v9 offset:5120
ds_read_b128 v[200:203], v9 offset:6144
ds_read_b128 v[204:207], v9 offset:7168
ds_read_b128 v[208:211], v9 offset:8192
ds_read_b128 v[212:215], v9 offset:9216
ds_read_b128 v[216:219], v9 offset:10240
ds_read_b128 v[220:223], v9 offset:11264
ds_read_b128 v[224:227], v9 offset:12288
ds_read_b128 v[228:231], v9 offset:13312
ds_read_b128 v[232:235], v9 offset:14336
ds_read_b128 v[236:239], v9 offset:15360
s_mul_i32 s6, s60, 10485760
s_mul_i32 s7, s4, 40960
s_add_u32 s6, s6, s7
v_lshlrev_b32 v9, 6, v2
s_lshl_b32 s8, s4, 2
s_cmp_eq_u32 s60, 0
s_cselect_b32 s8, s8, 0x7fff0000
s_waitcnt lgkmcnt(15)
buffer_store_dword v8, v9, s[52:55], s8 offen sc1
v_cmp_lt_u32 vcc, 0x100, v8
s_cbranch_vccnz L1_eslow
s_waitcnt lgkmcnt(15)
buffer_store_dwordx4 v[176:179], v10, s[48:51], s6 offen sc1
s_add_u32 s6, s6, 655360
s_waitcnt lgkmcnt(14)
buffer_store_dwordx4 v[180:183], v10, s[48:51], s6 offen sc1
s_add_u32 s6, s6, 655360
s_waitcnt lgkmcnt(13)
buffer_store_dwordx4 v[184:187], v10, s[48:51], s6 offen sc1
s_add_u32 s6, s6, 655360
s_waitcnt lgkmcnt(12)
buffer_store_dwordx4 v[188:191], v10, s[48:51], s6 offen sc1
s_add_u32 s6, s6, 655360
s_waitcnt lgkmcnt(11)
buffer_store_dwordx4 v[192:195], v10, s[48:51], s6 offen sc1
s_add_u32 s6, s6, 655360
s_waitcnt lgkmcnt(10)
buffer_store_dwordx4 v[196:199], v10, s[48:51], s6 offen sc1
s_add_u32 s6, s6, 655360
s_waitcnt lgkmcnt(9)
buffer_store_dwordx4 v[200:203], v10, s[48:51], s6 offen sc1
s_add_u32 s6, s6, 655360
s_waitcnt lgkmcnt(8)
buffer_store_dwordx4 v[204:207], v10, s[48:51], s6 offen sc1
s_add_u32 s6, s6, 655360
s_waitcnt lgkmcnt(7)
buffer_store_dwordx4 v[208:211], v10, s[48:51], s6 offen sc1
s_add_u32 s6, s6, 655360
s_waitcnt lgkmcnt(6)
buffer_store_dwordx4 v[212:215], v10, s[48:51], s6 offen sc1
s_add_u32 s6, s6, 655360
s_waitcnt lgkmcnt(5)
buffer_store_dwordx4 v[216:219], v10, s[48:51], s6 offen sc1
s_add_u32 s6, s6, 655360
s_waitcnt lgkmcnt(4)
buffer_store_dwordx4 v[220:223], v10, s[48:51], s6 offen sc1
s_add_u32 s6, s6, 655360
s_waitcnt lgkmcnt(3)
buffer_store_dwordx4 v[224:227], v10, s[48:51], s6 offen sc1
s_add_u32 s6, s6, 655360
s_waitcnt lgkmcnt(2)
buffer_store_dwordx4 v[228:231], v10, s[48:51], s6 offen sc1
s_add_u32 s6, s6, 655360
s_waitcnt lgkmcnt(1)
buffer_store_dwordx4 v[232:235], v10, s[48:51], s6 offen sc1
s_add_u32 s6, s6, 655360
s_waitcnt lgkmcnt(0)
buffer_store_dwordx4 v[236:239], v10, s[48:51], s6 offen sc1
s_add_u32 s6, s6, 655360
s_branch L1_fin
L1_eslow:
s_mov_b32 s9, 655360
v_mul_u32_u24 v96, s9, v96
v_lshl_add_u32 v96, v136, 2, v96
v_mul_u32_u24 v97, s9, v97
v_lshl_add_u32 v97, v137, 2, v97
v_mul_u32_u24 v98, s9, v98
v_lshl_add_u32 v98, v138, 2, v98
v_mul_u32_u24 v99, s9, v99
v_lshl_add_u32 v99, v139, 2, v99
v_mul_u32_u24 v100, s9, v100
v_lshl_add_u32 v100, v140, 2, v100
v_mul_u32_u24 v101, s9, v101
v_lshl_add_u32 v101, v141, 2, v101
v_mul_u32_u24 v102, s9, v102
v_lshl_add_u32 v102, v142, 2, v102
v_mul_u32_u24 v103, s9, v103
v_lshl_add_u32 v103, v143, 2, v103
v_mul_u32_u24 v104, s9, v104
v_lshl_add_u32 v104, v144, 2, v104
v_mul_u32_u24 v105, s9, v105
v_lshl_add_u32 v105, v145, 2, v105
v_mul_u32_u24 v106, s9, v106
v_lshl_add_u32 v106, v146, 2, v106
v_mul_u32_u24 v107, s9, v107
v_lshl_add_u32 v107, v147, 2, v107
v_mul_u32_u24 v108, s9, v108
v_lshl_add_u32 v108, v148, 2, v108
v_mul_u32_u24 v109, s9, v109
v_lshl_add_u32 v109, v149, 2, v109
v_mul_u32_u24 v110, s9, v110
v_lshl_add_u32 v110, v150, 2, v110
v_mul_u32_u24 v111, s9, v111
v_lshl_add_u32 v111, v151, 2, v111
v_mul_u32_u24 v112, s9, v112
v_lshl_add_u32 v112, v152, 2, v112
v_mul_u32_u24 v113, s9, v113
v_lshl_add_u32 v113, v153, 2, v113
v_mul_u32_u24 v114, s9, v114
v_lshl_add_u32 v114, v154, 2, v114
v_mul_u32_u24 v115, s9, v115
v_lshl_add_u32 v115, v155, 2, v115
v_mul_u32_u24 v116, s9, v116
v_lshl_add_u32 v116, v156, 2, v116
v_mul_u32_u24 v117, s9, v117
v_lshl_add_u32 v117, v157, 2, v117
v_mul_u32_u24 v118, s9, v118
v_lshl_add_u32 v118, v158, 2, v118
v_mul_u32_u24 v119, s9, v119
v_lshl_add_u32 v119, v159, 2, v119
v_mul_u32_u24 v120, s9, v120
v_lshl_add_u32 v120, v160, 2, v120
v_mul_u32_u24 v121, s9, v121
v_lshl_add_u32 v121, v161, 2, v121
v_mul_u32_u24 v122, s9, v122
v_lshl_add_u32 v122, v162, 2, v122
v_mul_u32_u24 v123, s9, v123
v_lshl_add_u32 v123, v163, 2, v123
v_mul_u32_u24 v124, s9, v124
v_lshl_add_u32 v124, v164, 2, v124
v_mul_u32_u24 v125, s9, v125
v_lshl_add_u32 v125, v165, 2, v125
v_mul_u32_u24 v126, s9, v126
v_lshl_add_u32 v126, v166, 2, v126
v_mul_u32_u24 v127, s9, v127
v_lshl_add_u32 v127, v167, 2, v127
v_mul_u32_u24 v128, s9, v128
v_lshl_add_u32 v128, v168, 2, v128
v_mul_u32_u24 v129, s9, v129
v_lshl_add_u32 v129, v169, 2, v129
v_mul_u32_u24 v130, s9, v130
v_lshl_add_u32 v130, v170, 2, v130
v_mul_u32_u24 v131, s9, v131
v_lshl_add_u32 v131, v171, 2, v131
v_mul_u32_u24 v132, s9, v132
v_lshl_add_u32 v132, v172, 2, v132
v_mul_u32_u24 v133, s9, v133
v_lshl_add_u32 v133, v173, 2, v133
v_mul_u32_u24 v134, s9, v134
v_lshl_add_u32 v134, v174, 2, v134
v_mul_u32_u24 v135, s9, v135
v_lshl_add_u32 v135, v175, 2, v135
buffer_store_dword v56, v96, s[48:51], s7 offen sc1
buffer_store_dword v57, v97, s[48:51], s7 offen sc1
buffer_store_dword v58, v98, s[48:51], s7 offen sc1
buffer_store_dword v59, v99, s[48:51], s7 offen sc1
buffer_store_dword v60, v100, s[48:51], s7 offen sc1
buffer_store_dword v61, v101, s[48:51], s7 offen sc1
buffer_store_dword v62, v102, s[48:51], s7 offen sc1
buffer_store_dword v63, v103, s[48:51], s7 offen sc1
buffer_store_dword v64, v104, s[48:51], s7 offen sc1
buffer_store_dword v65, v105, s[48:51], s7 offen sc1
buffer_store_dword v66, v106, s[48:51], s7 offen sc1
buffer_store_dword v67, v107, s[48:51], s7 offen sc1
buffer_store_dword v68, v108, s[48:51], s7 offen sc1
buffer_store_dword v69, v109, s[48:51], s7 offen sc1
buffer_store_dword v70, v110, s[48:51], s7 offen sc1
buffer_store_dword v71, v111, s[48:51], s7 offen sc1
buffer_store_dword v72, v112, s[48:51], s7 offen sc1
buffer_store_dword v73, v113, s[48:51], s7 offen sc1
buffer_store_dword v74, v114, s[48:51], s7 offen sc1
buffer_store_dword v75, v115, s[48:51], s7 offen sc1
buffer_store_dword v76, v116, s[48:51], s7 offen sc1
buffer_store_dword v77, v117, s[48:51], s7 offen sc1
buffer_store_dword v78, v118, s[48:51], s7 offen sc1
buffer_store_dword v79, v119, s[48:51], s7 offen sc1
buffer_store_dword v80, v120, s[48:51], s7 offen sc1
buffer_store_dword v81, v121, s[48:51], s7 offen sc1
buffer_store_dword v82, v122, s[48:51], s7 offen sc1
buffer_store_dword v83, v123, s[48:51], s7 offen sc1
buffer_store_dword v84, v124, s[48:51], s7 offen sc1
buffer_store_dword v85, v125, s[48:51], s7 offen sc1
buffer_store_dword v86, v126, s[48:51], s7 offen sc1
buffer_store_dword v87, v127, s[48:51], s7 offen sc1
buffer_store_dword v88, v128, s[48:51], s7 offen sc1
buffer_store_dword v89, v129, s[48:51], s7 offen sc1
buffer_store_dword v90, v130, s[48:51], s7 offen sc1
buffer_store_dword v91, v131, s[48:51], s7 offen sc1
s_mov_b64 exec, s[12:13]
buffer_store_dword v92, v132, s[48:51], s7 offen sc1
buffer_store_dword v93, v133, s[48:51], s7 offen sc1
buffer_store_dword v94, v134, s[48:51], s7 offen sc1
buffer_store_dword v95, v135, s[48:51], s7 offen sc1
s_mov_b64 exec, -1
s_branch L1_fin
L2_entry:
s_load_dwordx2 s[4:5], s[0:1], 88
s_load_dwordx2 s[60:61], s[0:1], 0
s_load_dwordx2 s[52:53], s[0:1], 24
s_load_dwordx2 s[56:57], s[0:1], 72
s_and_b32 s35, s2, 7
s_lshr_b32 s37, s2, 3
s_add_u32 s37, s37, 30
s_and_b32 s37, s37, 31
s_cmp_ge_u32 s37, 30
s_cbranch_scc1 LE_start
s_mul_i32 s38, s37, 26
s_lshr_b32 s38, s38, 8
s_mul_i32 s39, s38, 10
s_sub_u32 s39, s37, s39
s_and_b32 s37, s35, 1
s_mul_i32 s37, s37, 3
s_add_u32 s37, s37, s38
s_lshr_b32 s38, s35, 1
s_mul_i32 s38, s38, 10
s_add_u32 s38, s38, s39
v_lshrrev_b32 v1, 6, v0
v_and_b32 v248, 63, v0
v_lshlrev_b32 v248, 4, v248
v_readfirstlane_b32 s34, v1
s_mov_b32 s50, 0xe1a06800
s_mov_b32 s51, 0x4e20ad04
s_mul_i32 s39, s37, 9
s_lshr_b64 s[50:51], s[50:51], s39
s_and_b32 s39, s50, 0x1ff
s_bfe_u32 s49, s50, 0x90009
s_sub_u32 s31, s49, s39
s_sub_u32 s31, s31, 5
s_lshl_b32 s39, s39, 14
s_lshl_b32 s49, s49, 14
s_add_u32 s28, s39, 0x4000
s_cmp_eq_u32 s37, 5
s_addc_u32 s31, s31, 0
s_cmp_eq_u32 s37, 5
s_cselect_b32 s28, s39, s28
s_cselect_b32 s39, 5111808, s39
s_cselect_b32 s49, 5120000, s49
s_cselect_b32 s33, 0xff800000, 0
s_mov_b32 s32, 0x5d800000
v_and_b32 v2, 63, v0
v_bfe_u32 v3, v2, 3, 2
v_bfe_u32 v4, v2, 2, 1
v_lshlrev_b32 v241, 12, v3
v_lshl_or_b32 v241, v4, 9, v241
v_lshl_or_b32 v241, v1, 7, v241
v_lshrrev_b32 v4, 5, v2
v_lshl_or_b32 v241, v4, 6, v241
v_and_b32 v3, 2, v3
v_and_b32 v4, 3, v2
v_xor_b32 v3, v3, v4
v_lshl_or_b32 v241, v3, 4, v241
s_cmp_eq_u32 s38, 39
s_cbranch_scc1 LT_disp
s_cmp_lt_u32 s37, 3
s_cselect_b32 s101, 1, -1
s_cselect_b32 s39, 0, 103
s_cselect_b32 s3, 0, 3
s_sub_u32 s3, s37, s3
s_mul_i32 s3, s3, 104
s_add_u32 s39, s39, s3
s_cmp_eq_u32 s37, 5
s_addc_u32 s39, s39, 0
s_lshl_b32 s101, s101, 14
s_lshl_b32 s39, s39, 14
s_add_u32 s28, s39, s101
s_mov_b32 s49, 5120000
s_mov_b32 s31, 40
s_mov_b32 s100, 3
s_lshl_b32 s30, s34, 12
s_lshl_b32 s50, s34, 13
s_add_u32 s50, s50, 0x20000
s_mov_b32 m0, s30
s_mov_b32 s6, 0x92c51840
s_mov_b32 s7, 0xfb73ea6d
s_mul_i32 s3, s37, 12
s_min_u32 s3, s3, 56
s_lshr_b64 s[6:7], s[6:7], s3
s_bfe_u32 s29, s6, 0x40008
s_bfe_u32 s7, s6, 0x40004
s_and_b32 s6, s6, 15
s_cmp_lt_u32 s37, 4
s_cselect_b32 s29, s29, 16
s_mov_b32 s94, 0
s_mov_b32 s95, 0
s_lshr_b32 s3, s6, 2
s_cmp_eq_u32 s3, s34
s_cselect_b32 s94, s6, s94
s_cselect_b32 s95, 1, s95
s_lshr_b32 s3, s7, 2
s_cmp_eq_u32 s3, s34
s_cselect_b32 s94, s7, s94
s_cselect_b32 s95, 1, s95
s_lshr_b32 s3, s29, 2
s_cmp_eq_u32 s3, s34
s_cselect_b32 s94, s29, s94
s_cselect_b32 s95, 1, s95
s_and_b32 s94, s94, 3
s_lshl_b32 s3, s38, 17
s_lshl_b32 s51, s34, 7
s_add_u32 s3, s3, s51
s_lshl_b32 s6, s6, 13
s_add_u32 s6, s6, s3
s_lshl_b32 s7, s7, 13
s_add_u32 s7, s7, s3
s_lshl_b32 s29, s29, 13
s_add_u32 s29, s29, s3
s_mov_b64 s[96:97], 0
s_lshr_b32 s3, s6, 9
s_mul_i32 s40, s3, 6809
s_mov_b32 s41, s40
s_mul_i32 s40, s3, 6205
s_add_u32 s40, s40, 0x220f50
s_cmp_lt_u32 s3, 3696
s_cselect_b32 s41, s41, s40
s_mul_i32 s40, s3, 7437
s_add_u32 s40, s40, 0xff904e58
s_cmp_lt_u32 s3, 7752
s_cselect_b32 s41, s41, s40
s_lshr_b32 s3, s41, 20
s_bitset1_b64 s[96:97], s3
s_lshr_b32 s3, s6, 9
s_add_u32 s3, s3, 15
s_mul_i32 s40, s3, 6809
s_mov_b32 s41, s40
s_mul_i32 s40, s3, 6205
s_add_u32 s40, s40, 0x220f50
s_cmp_lt_u32 s3, 3696
s_cselect_b32 s41, s41, s40
s_mul_i32 s40, s3, 7437
s_add_u32 s40, s40, 0xff904e58
s_cmp_lt_u32 s3, 7752
s_cselect_b32 s41, s41, s40
s_lshr_b32 s3, s41, 20
s_bitset1_b64 s[96:97], s3
s_lshr_b32 s3, s7, 9
s_mul_i32 s40, s3, 6809
s_mov_b32 s41, s40
s_mul_i32 s40, s3, 6205
s_add_u32 s40, s40, 0x220f50
s_cmp_lt_u32 s3, 3696
s_cselect_b32 s41, s41, s40
s_mul_i32 s40, s3, 7437
s_add_u32 s40, s40, 0xff904e58
s_cmp_lt_u32 s3, 7752
s_cselect_b32 s41, s41, s40
s_lshr_b32 s3, s41, 20
s_bitset1_b64 s[96:97], s3
s_lshr_b32 s3, s7, 9
s_add_u32 s3, s3, 15
s_mul_i32 s40, s3, 6809
s_mov_b32 s41, s40
s_mul_i32 s40, s3, 6205
s_add_u32 s40, s40, 0x220f50
s_cmp_lt_u32 s3, 3696
s_cselect_b32 s41, s41, s40
s_mul_i32 s40, s3, 7437
s_add_u32 s40, s40, 0xff904e58
s_cmp_lt_u32 s3, 7752
s_cselect_b32 s41, s41, s40
s_lshr_b32 s3, s41, 20
s_bitset1_b64 s[96:97], s3
s_lshr_b32 s3, s29, 9
s_mul_i32 s40, s3, 6809
s_mov_b32 s41, s40
s_mul_i32 s40, s3, 6205
s_add_u32 s40, s40, 0x220f50
s_cmp_lt_u32 s3, 3696
s_cselect_b32 s41, s41, s40
s_mul_i32 s40, s3, 7437
s_add_u32 s40, s40, 0xff904e58
s_cmp_lt_u32 s3, 7752
s_cselect_b32 s41, s41, s40
s_lshr_b32 s3, s41, 20
s_bitset1_b64 s[96:97], s3
s_lshr_b32 s3, s29, 9
s_add_u32 s3, s3, 15
s_mul_i32 s40, s3, 6809
s_mov_b32 s41, s40
s_mul_i32 s40, s3, 6205
s_add_u32 s40, s40, 0x220f50
s_cmp_lt_u32 s3, 3696
s_cselect_b32 s41, s41, s40
s_mul_i32 s40, s3, 7437
s_add_u32 s40, s40, 0xff904e58
s_cmp_lt_u32 s3, 7752
s_cselect_b32 s41, s41, s40
s_lshr_b32 s3, s41, 20
s_bitset1_b64 s[96:97], s3
s_mul_i32 s3, s38, 6
s_add_u32 s3, s3, s37
s_cmp_eq_u32 s3, 233
s_cselect_b32 s3, 0, s37
s_cmp_lt_u32 s3, 4
s_cselect_b32 s29, s29, 0x70000000
s_lshl_b32 s51, s38, 5
s_lshl_b32 s3, s34, 3
s_add_u32 s51, s51, s3
s_add_u32 s51, s51, s37
s_mul_i32 s51, s51, 128
s_add_u32 s51, s51, 0x7c00000
s_lshr_b32 s40, s39, 17
s_min_u32 s40, s40, 38
s_lshr_b32 s41, s28, 17
s_add_u32 s3, s28, s101
s_lshr_b32 s3, s3, 17
v_mov_b32 v5, s38
v_mov_b32 v6, s40
v_cmp_lt_u32 vcc, 0x7f, v248
s_nop 1
v_cndmask_b32 v5, v5, v6, vcc
v_mov_b32 v6, s41
v_cmp_lt_u32 vcc, 0xff, v248
s_nop 1
v_cndmask_b32 v5, v5, v6, vcc
v_mov_b32 v6, s3
v_cmp_lt_u32 vcc, 0x17f, v248
s_nop 1
v_cndmask_b32 v5, v5, v6, vcc
v_bfe_u32 v6, v248, 4, 3
v_min_u32 v6, 5, v6
v_mad_u32_u24 v5, v5, 6, v6
v_lshlrev_b32 v5, 7, v5
v_add_u32 v5, 0x7c2a000, v5
s_mul_i32 s3, s101, 54
s_add_u32 s3, s3, s39
s_min_u32 s41, s3, s39
s_max_u32 s3, s3, s39
s_lshr_b32 s41, s41, 17
s_min_u32 s40, s40, s41
s_mul_i32 s40, s40, 6
s_lshr_b32 s3, s3, 17
s_min_u32 s3, s3, 38
s_mul_i32 s3, s3, 6
s_add_u32 s3, s3, 5
v_lshrrev_b32 v251, 4, v248
v_add_u32 v251, s40, v251
v_min_u32 v251, s3, v251
v_lshlrev_b32 v251, 7, v251
v_add_u32 v251, 0x7c2a000, v251
s_waitcnt lgkmcnt(0)
s_add_u32 s12, s4, 0x6800000
s_addc_u32 s13, s5, 0
s_mov_b32 s14, 0x0
s_mov_b32 s15, 0x00020000
s_mov_b32 s14, s49
s_add_u32 s8, s4, 0x0
s_addc_u32 s9, s5, 0
s_mov_b32 s10, 0x4e4000
s_mov_b32 s11, 0x00020000
s_mul_i32 s35, s37, 0x600000
s_add_u32 s20, s4, 0x2000000
s_addc_u32 s21, s5, 0
s_add_u32 s20, s20, s35
s_addc_u32 s21, s21, 0
s_mov_b32 s22, 0x4e4000
s_mov_b32 s23, 0x00020000
s_add_u32 s24, s4, 0x6000000
s_addc_u32 s25, s5, 0
s_mov_b32 s26, 0x139000
s_mov_b32 s27, 0x00020000
s_lshl_b32 s35, s38, 4
s_lshl_b32 s41, s34, 2
s_add_u32 s35, s35, s41
s_lshl_b32 s40, s35, 13
s_lshl_b32 s94, s94, 13
s_add_u32 s40, s40, s94
s_xor_b32 s41, s40, 8192
s_xor_b32 s42, s40, 16384
s_xor_b32 s43, s40, 24576
s_add_u32 s44, s40, 4096
s_add_u32 s45, s41, 4096
s_add_u32 s46, s42, 4096
s_add_u32 s47, s43, 4096
s_lshl_b32 s48, s35, 10
s_lshl_b32 s35, s37, 3
s_add_u32 s48, s48, s35
v_mov_b32 v232, 0
v_mov_b32 v233, 0
v_mov_b32 v234, 0
v_mov_b32 v235, 0
v_bfe_u32 v240, v248, 4, 3
v_lshlrev_b32 v240, 6, v240
v_bfe_u32 v242, v248, 7, 1
v_lshl_or_b32 v240, v242, 10, v240
v_bfe_u32 v242, v248, 8, 2
v_lshl_or_b32 v240, v242, 4, v240
v_bfe_u32 v242, v248, 6, 1
v_lshlrev_b32 v242, 5, v242
v_xor_b32 v240, v240, v242
v_and_b32 v249, 0x1c0, v248
v_bfe_u32 v242, v248, 9, 1
v_lshl_or_b32 v249, v242, 10, v249
v_bfe_u32 v242, v248, 8, 1
v_lshl_or_b32 v249, v242, 5, v249
v_bfe_u32 v242, v248, 4, 2
v_lshl_or_b32 v249, v242, 3, v249
v_xor_b32 v250, 32, v249
v_bfe_i32 v242, v248, 8, 1
v_and_b32 v192, s33, v242
v_and_b32 v193, s33, v242
v_and_b32 v194, s33, v242
v_and_b32 v195, s33, v242
v_mfma_f32_32x32x16_bf16 a[0:15], v[232:235], v[232:235], 0
v_mfma_f32_32x32x16_bf16 a[16:31], v[232:235], v[232:235], 0
v_mfma_f32_32x32x16_bf16 a[32:47], v[232:235], v[232:235], 0
v_mfma_f32_32x32x16_bf16 a[48:63], v[232:235], v[232:235], 0
v_mfma_f32_32x32x16_bf16 a[64:79], v[232:235], v[232:235], 0
v_mfma_f32_32x32x16_bf16 a[80:95], v[232:235], v[232:235], 0
v_mfma_f32_32x32x16_bf16 a[96:111], v[232:235], v[232:235], 0
v_mfma_f32_32x32x16_bf16 a[112:127], v[232:235], v[232:235], 0
v_mfma_f32_32x32x16_bf16 a[128:143], v[232:235], v[232:235], 0
v_mfma_f32_32x32x16_bf16 a[144:159], v[232:235], v[232:235], 0
v_mfma_f32_32x32x16_bf16 a[160:175], v[232:235], v[232:235], 0
v_mfma_f32_32x32x16_bf16 a[176:191], v[232:235], v[232:235], 0
v_mfma_f32_32x32x16_bf16 a[192:207], v[232:235], v[232:235], 0
v_mfma_f32_32x32x16_bf16 a[208:223], v[232:235], v[232:235], 0
v_mfma_f32_32x32x16_bf16 a[224:239], v[232:235], v[232:235], 0
v_mfma_f32_32x32x16_bf16 a[240:255], v[232:235], v[232:235], 0
s_add_u32 s16, s4, 0x0
s_addc_u32 s17, s5, 0
s_mov_b32 s18, 0x10000000
s_mov_b32 s19, 0x00020000
s_mov_b32 s3, 0x10000
LM_pa:
buffer_load_dwordx2 v[6:7], v5, s[16:19], 0 offen sc1
s_sub_u32 s3, s3, 1
s_waitcnt vmcnt(0)
s_cbranch_scc1 LM_pa_go
v_cmp_ne_u64 vcc, s[98:99], v[6:7]
s_nop 1
s_cbranch_vccnz LM_pa
LM_pa_go:
buffer_load_dwordx4 v241, s[12:15], s39 offen offset:0 sc1 lds
buffer_load_dwordx4 v241, s[12:15], s39 offen offset:1024 sc1 lds
buffer_load_dwordx4 v241, s[12:15], s39 offen offset:2048 sc1 lds
buffer_load_dwordx4 v241, s[12:15], s39 offen offset:3072 sc1 lds
s_add_u32 m0, s30, 0x4000
s_nop 0
buffer_load_dwordx4 v241, s[12:15], s28 offen offset:0 sc1 lds
buffer_load_dwordx4 v241, s[12:15], s28 offen offset:1024 sc1 lds
buffer_load_dwordx4 v[0:3], v248, s[8:11], s40 offen offset:0 sc1
buffer_load_dwordx4 v[32:35], v248, s[8:11], s41 offen offset:0 sc1
buffer_load_dwordx4 v[64:67], v248, s[8:11], s42 offen offset:0 sc1
buffer_load_dwordx4 v[96:99], v248, s[8:11], s43 offen offset:0 sc1
buffer_load_dwordx4 v[4:7], v248, s[8:11], s40 offen offset:1024 sc1
buffer_load_dwordx4 v[36:39], v248, s[8:11], s41 offen offset:1024 sc1
buffer_load_dwordx4 v[68:71], v248, s[8:11], s42 offen offset:1024 sc1
buffer_load_dwordx4 v[100:103], v248, s[8:11], s43 offen offset:1024 sc1
buffer_load_dwordx4 v[8:11], v248, s[8:11], s40 offen offset:2048 sc1
buffer_load_dwordx4 v[40:43], v248, s[8:11], s41 offen offset:2048 sc1
buffer_load_dwordx4 v[72:75], v248, s[8:11], s42 offen offset:2048 sc1
buffer_load_dwordx4 v[104:107], v248, s[8:11], s43 offen offset:2048 sc1
buffer_load_dwordx4 v[12:15], v248, s[8:11], s40 offen offset:3072 sc1
buffer_load_dwordx4 v[44:47], v248, s[8:11], s41 offen offset:3072 sc1
buffer_load_dwordx4 v[76:79], v248, s[8:11], s42 offen offset:3072 sc1
buffer_load_dwordx4 v[108:111], v248, s[8:11], s43 offen offset:3072 sc1
buffer_load_dwordx4 v[16:19], v248, s[8:11], s44 offen offset:0 sc1
buffer_load_dwordx4 v[48:51], v248, s[8:11], s45 offen offset:0 sc1
buffer_load_dwordx4 v[80:83], v248, s[8:11], s46 offen offset:0 sc1
buffer_load_dwordx4 v[112:115], v248, s[8:11], s47 offen offset:0 sc1
buffer_load_dwordx2 v[252:253], v251, s[16:19], 0 offen sc1
s_waitcnt vmcnt(21)
s_barrier
ds_read_b128 v[208:211], v240 offset:0
ds_read_b128 v[212:215], v240 offset:2048
ds_read_b128 v[216:219], v240 offset:16384
ds_read_b128 v[220:223], v240 offset:512
s_waitcnt lgkmcnt(3)
s_waitcnt vmcnt(17)
v_mfma_f32_16x16x32_bf16 v[128:131], v[208:211], v[0:3], v[192:195]
buffer_load_dwordx4 v[20:23], v248, s[8:11], s44 offen offset:1024 sc1
v_mfma_f32_16x16x32_bf16 v[132:135], v[208:211], v[32:35], v[192:195]
v_mfma_f32_16x16x32_bf16 v[136:139], v[208:211], v[64:67], v[192:195]
v_mfma_f32_16x16x32_bf16 v[140:143], v[208:211], v[96:99], v[192:195]
ds_read_b128 v[208:211], v240 offset:2560
s_waitcnt lgkmcnt(3)
buffer_load_dwordx4 v[52:55], v248, s[8:11], s45 offen offset:1024 sc1
v_mfma_f32_16x16x32_bf16 v[144:147], v[212:215], v[0:3], v[192:195]
v_mfma_f32_16x16x32_bf16 v[148:151], v[212:215], v[32:35], v[192:195]
v_mfma_f32_16x16x32_bf16 v[152:155], v[212:215], v[64:67], v[192:195]
buffer_load_dwordx4 v[84:87], v248, s[8:11], s46 offen offset:1024 sc1
v_mfma_f32_16x16x32_bf16 v[156:159], v[212:215], v[96:99], v[192:195]
ds_read_b128 v[212:215], v240 offset:16896
s_waitcnt lgkmcnt(3)
v_mfma_f32_16x16x32_bf16 v[176:179], v[216:219], v[0:3], 0
v_mfma_f32_16x16x32_bf16 v[180:183], v[216:219], v[32:35], 0
buffer_load_dwordx4 v[116:119], v248, s[8:11], s47 offen offset:1024 sc1
v_mfma_f32_16x16x32_bf16 v[184:187], v[216:219], v[64:67], 0
v_mfma_f32_16x16x32_bf16 v[188:191], v[216:219], v[96:99], 0
ds_read_b128 v[216:219], v240 offset:4096
s_waitcnt lgkmcnt(3)
s_waitcnt vmcnt(17)
v_mfma_f32_16x16x32_bf16 v[128:131], v[220:223], v[4:7], v[128:131]
buffer_load_dwordx4 v[24:27], v248, s[8:11], s44 offen offset:2048 sc1
v_mfma_f32_16x16x32_bf16 v[132:135], v[220:223], v[36:39], v[132:135]
v_mfma_f32_16x16x32_bf16 v[136:139], v[220:223], v[68:71], v[136:139]
v_mfma_f32_16x16x32_bf16 v[140:143], v[220:223], v[100:103], v[140:143]
ds_read_b128 v[220:223], v240 offset:6144
s_waitcnt lgkmcnt(3)
buffer_load_dwordx4 v[56:59], v248, s[8:11], s45 offen offset:2048 sc1
v_mfma_f32_16x16x32_bf16 v[144:147], v[208:211], v[4:7], v[144:147]
v_mfma_f32_16x16x32_bf16 v[148:151], v[208:211], v[36:39], v[148:151]
v_mfma_f32_16x16x32_bf16 v[152:155], v[208:211], v[68:71], v[152:155]
buffer_load_dwordx4 v[88:91], v248, s[8:11], s46 offen offset:2048 sc1
v_mfma_f32_16x16x32_bf16 v[156:159], v[208:211], v[100:103], v[156:159]
ds_read_b128 v[208:211], v240 offset:20480
s_waitcnt lgkmcnt(3)
v_mfma_f32_16x16x32_bf16 v[176:179], v[212:215], v[4:7], v[176:179]
v_mfma_f32_16x16x32_bf16 v[180:183], v[212:215], v[36:39], v[180:183]
buffer_load_dwordx4 v[120:123], v248, s[8:11], s47 offen offset:2048 sc1
v_mfma_f32_16x16x32_bf16 v[184:187], v[212:215], v[68:71], v[184:187]
v_mfma_f32_16x16x32_bf16 v[188:191], v[212:215], v[100:103], v[188:191]
ds_read_b128 v[212:215], v240 offset:4608
s_waitcnt lgkmcnt(3)
s_waitcnt vmcnt(17)
v_mfma_f32_16x16x32_bf16 v[128:131], v[216:219], v[8:11], v[128:131]
buffer_load_dwordx4 v[28:31], v248, s[8:11], s44 offen offset:3072 sc1
v_mfma_f32_16x16x32_bf16 v[132:135], v[216:219], v[40:43], v[132:135]
v_mfma_f32_16x16x32_bf16 v[136:139], v[216:219], v[72:75], v[136:139]
v_mfma_f32_16x16x32_bf16 v[140:143], v[216:219], v[104:107], v[140:143]
ds_read_b128 v[216:219], v240 offset:6656
s_waitcnt lgkmcnt(3)
buffer_load_dwordx4 v[60:63], v248, s[8:11], s45 offen offset:3072 sc1
v_mfma_f32_16x16x32_bf16 v[144:147], v[220:223], v[8:11], v[144:147]
v_mfma_f32_16x16x32_bf16 v[148:151], v[220:223], v[40:43], v[148:151]
v_mfma_f32_16x16x32_bf16 v[152:155], v[220:223], v[72:75], v[152:155]
buffer_load_dwordx4 v[92:95], v248, s[8:11], s46 offen offset:3072 sc1
v_mfma_f32_16x16x32_bf16 v[156:159], v[220:223], v[104:107], v[156:159]
ds_read_b128 v[220:223], v240 offset:20992
s_waitcnt lgkmcnt(3)
v_mfma_f32_16x16x32_bf16 v[176:179], v[208:211], v[8:11], v[176:179]
v_mfma_f32_16x16x32_bf16 v[180:183], v[208:211], v[40:43], v[180:183]
buffer_load_dwordx4 v[124:127], v248, s[8:11], s47 offen offset:3072 sc1
v_mfma_f32_16x16x32_bf16 v[184:187], v[208:211], v[72:75], v[184:187]
v_mfma_f32_16x16x32_bf16 v[188:191], v[208:211], v[104:107], v[188:191]
ds_read_b128 v[208:211], v240 offset:8192
s_waitcnt lgkmcnt(3)
s_waitcnt vmcnt(17)
v_mfma_f32_16x16x32_bf16 v[128:131], v[212:215], v[12:15], v[128:131]
s_add_u32 s16, s4, 0x0
s_addc_u32 s17, s5, 0
s_mov_b32 s18, 0x10000000
v_mfma_f32_16x16x32_bf16 v[132:135], v[212:215], v[44:47], v[132:135]
buffer_load_dwordx4 v241, s[12:15], s28 offen offset:2048 sc1 lds
s_mov_b32 s19, 0x00020000
s_add_u32 s8, s60, 0x0
v_mfma_f32_16x16x32_bf16 v[136:139], v[212:215], v[76:79], v[136:139]
s_addc_u32 s9, s61, 0
s_mov_b32 s10, 0x4e2000
s_mov_b32 s11, 0x00020000
v_mfma_f32_16x16x32_bf16 v[140:143], v[212:215], v[108:111], v[140:143]
ds_read_b128 v[212:215], v240 offset:10240
s_waitcnt lgkmcnt(3)
buffer_load_dwordx4 v241, s[12:15], s28 offen offset:3072 sc1 lds
v_mfma_f32_16x16x32_bf16 v[144:147], v[216:219], v[12:15], v[144:147]
s_mov_b32 s54, 0x4e20
s_mov_b32 s55, 0x00020000
s_mov_b32 s58, 0x4e2000
v_mfma_f32_16x16x32_bf16 v[148:151], v[216:219], v[44:47], v[148:151]
s_mov_b32 s59, 0x00020000
s_lshr_b32 s48, s40, 2
s_cmp_eq_u32 s95, 1
v_mfma_f32_16x16x32_bf16 v[152:155], v[216:219], v[76:79], v[152:155]
s_cselect_b32 s40, 0x70000000, s40
s_cselect_b32 s44, 0x70000000, s44
s_cmp_lt_u32 s37, 3
v_mfma_f32_16x16x32_bf16 v[156:159], v[216:219], v[108:111], v[156:159]
ds_read_b128 v[216:219], v240 offset:24576
s_waitcnt lgkmcnt(3)
s_cselect_b32 s3, 0, 3
v_mfma_f32_16x16x32_bf16 v[176:179], v[220:223], v[12:15], v[176:179]
s_sub_u32 s3, s37, s3
s_cmp_eq_u32 s3, 2
s_cselect_b32 s39, 6, 6
v_mfma_f32_16x16x32_bf16 v[180:183], v[220:223], v[44:47], v[180:183]
s_cselect_b32 s35, 5, 4
s_lshl_b32 s49, s38, 2
s_add_u32 s49, s49, s3
v_mfma_f32_16x16x32_bf16 v[184:187], v[220:223], v[76:79], v[184:187]
s_lshl_b32 s49, s49, 10
s_add_u32 s49, s49, 0x7c00300
v_mfma_f32_16x16x32_bf16 v[188:191], v[220:223], v[108:111], v[188:191]
ds_read_b128 v[220:223], v240 offset:8704
s_waitcnt lgkmcnt(3)
s_waitcnt vmcnt(15)
v_mfma_f32_16x16x32_bf16 v[128:131], v[208:211], v[16:19], v[128:131]
v_mfma_f32_16x16x32_bf16 v[132:135], v[208:211], v[48:51], v[132:135]
s_add_u32 s28, s28, s101
s_add_u32 m0, s30, 0x8000
s_nop 0
v_mfma_f32_16x16x32_bf16 v[136:139], v[208:211], v[80:83], v[136:139]
v_mfma_f32_16x16x32_bf16 v[140:143], v[208:211], v[112:115], v[140:143]
ds_read_b128 v[208:211], v240 offset:10752
s_waitcnt lgkmcnt(3)
buffer_load_dwordx4 v241, s[12:15], s28 offen offset:0 sc1 lds
v_mfma_f32_16x16x32_bf16 v[144:147], v[212:215], v[16:19], v[144:147]
v_mfma_f32_16x16x32_bf16 v[148:151], v[212:215], v[48:51], v[148:151]
buffer_load_dwordx4 v241, s[12:15], s28 offen offset:1024 sc1 lds
v_mfma_f32_16x16x32_bf16 v[152:155], v[212:215], v[80:83], v[152:155]
v_mfma_f32_16x16x32_bf16 v[156:159], v[212:215], v[112:115], v[156:159]
ds_read_b128 v[212:215], v240 offset:25088
s_waitcnt lgkmcnt(3)
v_mfma_f32_16x16x32_bf16 v[176:179], v[216:219], v[16:19], v[176:179]
v_mfma_f32_16x16x32_bf16 v[180:183], v[216:219], v[48:51], v[180:183]
v_mfma_f32_16x16x32_bf16 v[184:187], v[216:219], v[80:83], v[184:187]
v_mfma_f32_16x16x32_bf16 v[188:191], v[216:219], v[112:115], v[188:191]
ds_read_b128 v[216:219], v240 offset:12288
s_waitcnt lgkmcnt(3)
s_waitcnt vmcnt(12)
v_mfma_f32_16x16x32_bf16 v[128:131], v[220:223], v[20:23], v[128:131]
v_mfma_f32_16x16x32_bf16 v[132:135], v[220:223], v[52:55], v[132:135]
buffer_load_dwordx4 v241, s[12:15], s28 offen offset:2048 sc1 lds
v_mfma_f32_16x16x32_bf16 v[136:139], v[220:223], v[84:87], v[136:139]
v_mfma_f32_16x16x32_bf16 v[140:143], v[220:223], v[116:119], v[140:143]
ds_read_b128 v[220:223], v240 offset:14336
s_waitcnt lgkmcnt(3)
buffer_load_dwordx4 v241, s[12:15], s28 offen offset:3072 sc1 lds
v_mfma_f32_16x16x32_bf16 v[144:147], v[208:211], v[20:23], v[144:147]
v_mfma_f32_16x16x32_bf16 v[148:151], v[208:211], v[52:55], v[148:151]
v_mfma_f32_16x16x32_bf16 v[152:155], v[208:211], v[84:87], v[152:155]
v_mfma_f32_16x16x32_bf16 v[156:159], v[208:211], v[116:119], v[156:159]
ds_read_b128 v[208:211], v240 offset:28672
s_waitcnt lgkmcnt(3)
v_mfma_f32_16x16x32_bf16 v[176:179], v[212:215], v[20:23], v[176:179]
v_mfma_f32_16x16x32_bf16 v[180:183], v[212:215], v[52:55], v[180:183]
v_mfma_f32_16x16x32_bf16 v[184:187], v[212:215], v[84:87], v[184:187]
v_mfma_f32_16x16x32_bf16 v[188:191], v[212:215], v[116:119], v[188:191]
ds_read_b128 v[212:215], v240 offset:12800
s_waitcnt lgkmcnt(3)
s_waitcnt vmcnt(10)
v_mfma_f32_16x16x32_bf16 v[128:131], v[216:219], v[24:27], v[128:131]
v_mfma_f32_16x16x32_bf16 v[132:135], v[216:219], v[56:59], v[132:135]
s_add_u32 s28, s28, s101
s_add_u32 s30, s30, 0xc000
v_mfma_f32_16x16x32_bf16 v[136:139], v[216:219], v[88:91], v[136:139]
v_mfma_f32_16x16x32_bf16 v[140:143], v[216:219], v[120:123], v[140:143]
ds_read_b128 v[216:219], v240 offset:14848
s_waitcnt lgkmcnt(3)
v_mfma_f32_16x16x32_bf16 v[144:147], v[220:223], v[24:27], v[144:147]
v_mfma_f32_16x16x32_bf16 v[148:151], v[220:223], v[56:59], v[148:151]
v_mfma_f32_16x16x32_bf16 v[152:155], v[220:223], v[88:91], v[152:155]
v_mfma_f32_16x16x32_bf16 v[156:159], v[220:223], v[120:123], v[156:159]
ds_read_b128 v[220:223], v240 offset:29184
s_waitcnt lgkmcnt(3)
v_mfma_f32_16x16x32_bf16 v[176:179], v[208:211], v[24:27], v[176:179]
v_mfma_f32_16x16x32_bf16 v[180:183], v[208:211], v[56:59], v[180:183]
v_mfma_f32_16x16x32_bf16 v[184:187], v[208:211], v[88:91], v[184:187]
v_mfma_f32_16x16x32_bf16 v[188:191], v[208:211], v[120:123], v[188:191]
s_waitcnt lgkmcnt(2)
s_waitcnt vmcnt(6)
v_mfma_f32_16x16x32_bf16 v[128:131], v[212:215], v[28:31], v[128:131]
v_mfma_f32_16x16x32_bf16 v[132:135], v[212:215], v[60:63], v[132:135]
v_mfma_f32_16x16x32_bf16 v[136:139], v[212:215], v[92:95], v[136:139]
v_mfma_f32_16x16x32_bf16 v[140:143], v[212:215], v[124:127], v[140:143]
s_waitcnt lgkmcnt(1)
v_mfma_f32_16x16x32_bf16 v[144:147], v[216:219], v[28:31], v[144:147]
v_mfma_f32_16x16x32_bf16 v[148:151], v[216:219], v[60:63], v[148:151]
v_mfma_f32_16x16x32_bf16 v[152:155], v[216:219], v[92:95], v[152:155]
v_mfma_f32_16x16x32_bf16 v[156:159], v[216:219], v[124:127], v[156:159]
s_waitcnt lgkmcnt(0)
v_mfma_f32_16x16x32_bf16 v[176:179], v[220:223], v[28:31], v[176:179]
v_mfma_f32_16x16x32_bf16 v[180:183], v[220:223], v[60:63], v[180:183]
v_mfma_f32_16x16x32_bf16 v[184:187], v[220:223], v[92:95], v[184:187]
v_mfma_f32_16x16x32_bf16 v[188:191], v[220:223], v[124:127], v[188:191]
v_max3_f32 v244, v128, v129, v130
v_max3_f32 v245, v132, v133, v134
v_max3_f32 v246, v136, v137, v138
v_max3_f32 v247, v140, v141, v142
v_max3_f32 v244, v244, v131, v144
v_max3_f32 v245, v245, v135, v148
v_max3_f32 v246, v246, v139, v152
v_max3_f32 v247, v247, v143, v156
v_max3_f32 v244, v244, v145, v146
v_max3_f32 v245, v245, v149, v150
v_max3_f32 v246, v246, v153, v154
v_max3_f32 v247, v247, v157, v158
v_max_f32 v244, v244, v147
v_max_f32 v245, v245, v151
v_max_f32 v246, v246, v155
v_max_f32 v247, v247, v159
v_mov_b32 v232, v244
v_mov_b32 v233, v245
v_mov_b32 v234, v246
v_mov_b32 v235, v247
v_permlane32_swap_b32 v244, v232
v_permlane32_swap_b32 v245, v233
v_permlane32_swap_b32 v246, v234
v_permlane32_swap_b32 v247, v235
v_max_f32 v244, v244, v232
v_max_f32 v245, v245, v233
v_max_f32 v246, v246, v234
v_max_f32 v247, v247, v235
v_mov_b32 v232, v244
v_mov_b32 v233, v245
v_mov_b32 v234, v246
v_mov_b32 v235, v247
v_permlane16_swap_b32 v244, v232
v_permlane16_swap_b32 v245, v233
v_permlane16_swap_b32 v246, v234
v_permlane16_swap_b32 v247, v235
v_max_f32 v244, v244, v232
v_max_f32 v245, v245, v233
v_max_f32 v246, v246, v234
v_max_f32 v247, v247, v235
v_ceil_f32 v244, v244
v_ceil_f32 v245, v245
v_ceil_f32 v246, v246
v_ceil_f32 v247, v247
v_sub_f32 v128, v128, v244
v_sub_f32 v129, v129, v244
v_sub_f32 v130, v130, v244
v_sub_f32 v131, v131, v244
v_exp_f32 v128, v128
v_exp_f32 v129, v129
v_exp_f32 v130, v130
v_exp_f32 v131, v131
v_sub_f32 v192, 0, v244
v_sub_f32 v193, 0, v244
v_sub_f32 v194, 0, v244
v_sub_f32 v195, 0, v244
v_sub_f32 v132, v132, v245
v_sub_f32 v133, v133, v245
v_sub_f32 v134, v134, v245
v_sub_f32 v135, v135, v245
v_exp_f32 v132, v132
v_exp_f32 v133, v133
v_exp_f32 v134, v134
v_exp_f32 v135, v135
v_sub_f32 v196, 0, v245
v_sub_f32 v197, 0, v245
v_sub_f32 v198, 0, v245
v_sub_f32 v199, 0, v245
v_sub_f32 v136, v136, v246
v_sub_f32 v137, v137, v246
v_sub_f32 v138, v138, v246
v_sub_f32 v139, v139, v246
v_exp_f32 v136, v136
v_exp_f32 v137, v137
v_exp_f32 v138, v138
v_exp_f32 v139, v139
v_sub_f32 v200, 0, v246
v_sub_f32 v201, 0, v246
v_sub_f32 v202, 0, v246
v_sub_f32 v203, 0, v246
v_sub_f32 v140, v140, v247
v_sub_f32 v141, v141, v247
v_sub_f32 v142, v142, v247
v_sub_f32 v143, v143, v247
v_exp_f32 v140, v140
v_exp_f32 v141, v141
v_exp_f32 v142, v142
v_exp_f32 v143, v143
v_sub_f32 v204, 0, v247
v_sub_f32 v205, 0, v247
v_sub_f32 v206, 0, v247
v_sub_f32 v207, 0, v247
s_waitcnt vmcnt(4)
s_barrier
ds_read_b64_tr_b16 v[208:209], v249 offset:0
ds_read_b64_tr_b16 v[210:211], v249 offset:2048
ds_read_b64_tr_b16 v[212:213], v250 offset:0
ds_read_b64_tr_b16 v[214:215], v250 offset:2048
ds_read_b64_tr_b16 v[216:217], v249 offset:512
ds_read_b64_tr_b16 v[218:219], v249 offset:2560
ds_read_b64_tr_b16 v[220:221], v250 offset:512
ds_read_b64_tr_b16 v[222:223], v250 offset:2560
v_sub_f32 v144, v144, v244
v_sub_f32 v145, v145, v244
v_sub_f32 v146, v146, v244
v_sub_f32 v147, v147, v244
v_exp_f32 v144, v144
v_exp_f32 v145, v145
v_exp_f32 v146, v146
v_exp_f32 v147, v147
v_sub_f32 v148, v148, v245
v_sub_f32 v149, v149, v245
v_sub_f32 v150, v150, v245
v_sub_f32 v151, v151, v245
v_exp_f32 v148, v148
v_exp_f32 v149, v149
v_exp_f32 v150, v150
v_exp_f32 v151, v151
v_sub_f32 v152, v152, v246
v_sub_f32 v153, v153, v246
v_sub_f32 v154, v154, v246
v_sub_f32 v155, v155, v246
v_exp_f32 v152, v152
v_exp_f32 v153, v153
v_exp_f32 v154, v154
v_exp_f32 v155, v155
v_sub_f32 v156, v156, v247
v_sub_f32 v157, v157, v247
v_sub_f32 v158, v158, v247
v_sub_f32 v159, v159, v247
v_exp_f32 v156, v156
v_exp_f32 v157, v157
v_exp_f32 v158, v158
v_exp_f32 v159, v159
v_cvt_pk_bf16_f32 v160, v128, v129
v_cvt_pk_bf16_f32 v161, v130, v131
v_cvt_pk_bf16_f32 v164, v132, v133
v_cvt_pk_bf16_f32 v165, v134, v135
v_cvt_pk_bf16_f32 v168, v136, v137
v_cvt_pk_bf16_f32 v169, v138, v139
v_cvt_pk_bf16_f32 v172, v140, v141
v_cvt_pk_bf16_f32 v173, v142, v143
v_cvt_pk_bf16_f32 v162, v144, v145
v_cvt_pk_bf16_f32 v163, v146, v147
v_cvt_pk_bf16_f32 v166, v148, v149
v_cvt_pk_bf16_f32 v167, v150, v151
v_cvt_pk_bf16_f32 v170, v152, v153
v_cvt_pk_bf16_f32 v171, v154, v155
v_cvt_pk_bf16_f32 v174, v156, v157
v_cvt_pk_bf16_f32 v175, v158, v159
v_add_f32 v224, v128, v129
v_add_f32 v225, v132, v133
v_add_f32 v226, v136, v137
v_add_f32 v227, v140, v141
v_add_f32 v228, v130, v131
v_add_f32 v229, v134, v135
v_add_f32 v230, v138, v139
v_add_f32 v231, v142, v143
v_add_f32 v224, v224, v144
v_add_f32 v225, v225, v148
v_add_f32 v226, v226, v152
v_add_f32 v227, v227, v156
v_add_f32 v228, v228, v145
v_add_f32 v229, v229, v149
v_add_f32 v230, v230, v153
v_add_f32 v231, v231, v157
v_add_f32 v224, v224, v146
v_add_f32 v225, v225, v150
v_add_f32 v226, v226, v154
v_add_f32 v227, v227, v158
v_add_f32 v228, v228, v147
v_add_f32 v229, v229, v151
v_add_f32 v230, v230, v155
v_add_f32 v231, v231, v159
v_add_f32 v224, v224, v228
v_add_f32 v225, v225, v229
v_add_f32 v226, v226, v230
v_add_f32 v227, v227, v231
v_sub_f32 v128, v176, v244
v_sub_f32 v129, v177, v244
v_sub_f32 v130, v178, v244
v_sub_f32 v131, v179, v244
v_sub_f32 v132, v180, v245
v_sub_f32 v133, v181, v245
v_sub_f32 v134, v182, v245
v_sub_f32 v135, v183, v245
v_sub_f32 v136, v184, v246
v_sub_f32 v137, v185, v246
v_sub_f32 v138, v186, v246
v_sub_f32 v139, v187, v246
v_sub_f32 v140, v188, v247
v_sub_f32 v141, v189, v247
v_sub_f32 v142, v190, v247
v_sub_f32 v143, v191, v247
v_cmp_ne_u64 vcc, s[98:99], v[252:253]
s_nop 1
s_cbranch_vccnz LM_pb
LM_pb_ret:
s_nop 1
.p2align 6
L2_loop:
s_waitcnt lgkmcnt(6)
v_mfma_f32_16x16x32_bf16 a[0:3], v[160:163], v[208:211], a[0:3]
v_mfma_f32_16x16x32_bf16 a[4:7], v[164:167], v[208:211], a[4:7]
v_mfma_f32_16x16x32_bf16 a[8:11], v[168:171], v[208:211], a[8:11]
v_mfma_f32_16x16x32_bf16 a[12:15], v[172:175], v[208:211], a[12:15]
ds_read_b64_tr_b16 v[208:209], v249 offset:4096
s_waitcnt lgkmcnt(5)
v_mfma_f32_16x16x32_bf16 a[16:19], v[160:163], v[212:215], a[16:19]
ds_read_b64_tr_b16 v[210:211], v249 offset:6144
v_mfma_f32_16x16x32_bf16 a[20:23], v[164:167], v[212:215], a[20:23]
v_mfma_f32_16x16x32_bf16 a[24:27], v[168:171], v[212:215], a[24:27]
v_mfma_f32_16x16x32_bf16 a[28:31], v[172:175], v[212:215], a[28:31]
ds_read_b64_tr_b16 v[212:213], v250 offset:4096
s_waitcnt lgkmcnt(5)
v_mfma_f32_16x16x32_bf16 a[32:35], v[160:163], v[216:219], a[32:35]
ds_read_b64_tr_b16 v[214:215], v250 offset:6144
v_mfma_f32_16x16x32_bf16 a[36:39], v[164:167], v[216:219], a[36:39]
v_exp_f32 v232, v128
v_mfma_f32_16x16x32_bf16 a[40:43], v[168:171], v[216:219], a[40:43]
v_exp_f32 v233, v129
v_mfma_f32_16x16x32_bf16 a[44:47], v[172:175], v[216:219], a[44:47]
ds_read_b64_tr_b16 v[216:217], v249 offset:4608
s_waitcnt lgkmcnt(5)
v_mfma_f32_16x16x32_bf16 a[48:51], v[160:163], v[220:223], a[48:51]
ds_read_b64_tr_b16 v[218:219], v249 offset:6656
v_mfma_f32_16x16x32_bf16 a[52:55], v[164:167], v[220:223], a[52:55]
v_exp_f32 v234, v130
v_mfma_f32_16x16x32_bf16 a[56:59], v[168:171], v[220:223], a[56:59]
v_add_f32 v228, v224, v232
v_cvt_pk_bf16_f32 v176, v232, v233
v_mfma_f32_16x16x32_bf16 a[60:63], v[172:175], v[220:223], a[60:63]
ds_read_b64_tr_b16 v[220:221], v250 offset:4608
s_waitcnt lgkmcnt(5)
v_mfma_f32_16x16x32_bf16 a[64:67], v[160:163], v[208:211], a[64:67]
ds_read_b64_tr_b16 v[222:223], v250 offset:6656
v_mfma_f32_16x16x32_bf16 a[68:71], v[164:167], v[208:211], a[68:71]
v_exp_f32 v235, v131
v_mfma_f32_16x16x32_bf16 a[72:75], v[168:171], v[208:211], a[72:75]
v_add_f32 v228, v228, v233
v_add_f32 v228, v228, v234
v_mfma_f32_16x16x32_bf16 a[76:79], v[172:175], v[208:211], a[76:79]
ds_read_b128 v[208:211], v240 offset:18432
s_waitcnt lgkmcnt(5)
v_mfma_f32_16x16x32_bf16 a[80:83], v[160:163], v[212:215], a[80:83]
v_add_f32 v228, v228, v235
v_cvt_pk_bf16_f32 v177, v234, v235
v_mfma_f32_16x16x32_bf16 a[84:87], v[164:167], v[212:215], a[84:87]
v_exp_f32 v236, v132
v_mfma_f32_16x16x32_bf16 a[88:91], v[168:171], v[212:215], a[88:91]
v_exp_f32 v237, v133
v_mfma_f32_16x16x32_bf16 a[92:95], v[172:175], v[212:215], a[92:95]
ds_read_b128 v[212:215], v240 offset:18944
s_waitcnt lgkmcnt(4)
v_mfma_f32_16x16x32_bf16 a[96:99], v[160:163], v[216:219], a[96:99]
v_exp_f32 v238, v134
v_mfma_f32_16x16x32_bf16 a[100:103], v[164:167], v[216:219], a[100:103]
v_add_f32 v229, v225, v236
v_cvt_pk_bf16_f32 v180, v236, v237
v_mfma_f32_16x16x32_bf16 a[104:107], v[168:171], v[216:219], a[104:107]
v_exp_f32 v239, v135
v_mfma_f32_16x16x32_bf16 a[108:111], v[172:175], v[216:219], a[108:111]
ds_read_b128 v[216:219], v240 offset:22528
s_waitcnt lgkmcnt(3)
v_mfma_f32_16x16x32_bf16 a[112:115], v[160:163], v[220:223], a[112:115]
v_add_f32 v229, v229, v237
v_add_f32 v229, v229, v238
v_mfma_f32_16x16x32_bf16 a[116:119], v[164:167], v[220:223], a[116:119]
v_add_f32 v229, v229, v239
v_cvt_pk_bf16_f32 v181, v238, v239
v_mfma_f32_16x16x32_bf16 a[120:123], v[168:171], v[220:223], a[120:123]
v_exp_f32 v232, v136
v_mfma_f32_16x16x32_bf16 a[124:127], v[172:175], v[220:223], a[124:127]
ds_read_b128 v[220:223], v240 offset:23040
s_waitcnt lgkmcnt(3)
v_mfma_f32_16x16x32_bf16 v[144:147], v[208:211], v[0:3], v[192:195]
v_exp_f32 v233, v137
v_mfma_f32_16x16x32_bf16 v[148:151], v[208:211], v[32:35], v[196:199]
v_exp_f32 v234, v138
v_mfma_f32_16x16x32_bf16 v[152:155], v[208:211], v[64:67], v[200:203]
v_add_f32 v230, v226, v232
v_cvt_pk_bf16_f32 v184, v232, v233
v_mfma_f32_16x16x32_bf16 v[156:159], v[208:211], v[96:99], v[204:207]
ds_read_b128 v[208:211], v240 offset:26624
s_waitcnt lgkmcnt(3)
v_mfma_f32_16x16x32_bf16 v[144:147], v[212:215], v[4:7], v[144:147]
v_exp_f32 v235, v139
v_mfma_f32_16x16x32_bf16 v[148:151], v[212:215], v[36:39], v[148:151]
v_add_f32 v230, v230, v233
v_add_f32 v230, v230, v234
v_mfma_f32_16x16x32_bf16 v[152:155], v[212:215], v[68:71], v[152:155]
v_add_f32 v230, v230, v235
v_cvt_pk_bf16_f32 v185, v234, v235
v_mfma_f32_16x16x32_bf16 v[156:159], v[212:215], v[100:103], v[156:159]
ds_read_b128 v[212:215], v240 offset:27136
s_waitcnt lgkmcnt(3)
v_mfma_f32_16x16x32_bf16 v[144:147], v[216:219], v[8:11], v[144:147]
v_exp_f32 v236, v140
v_mfma_f32_16x16x32_bf16 v[148:151], v[216:219], v[40:43], v[148:151]
v_exp_f32 v237, v141
v_mfma_f32_16x16x32_bf16 v[152:155], v[216:219], v[72:75], v[152:155]
v_exp_f32 v238, v142
v_mfma_f32_16x16x32_bf16 v[156:159], v[216:219], v[104:107], v[156:159]
ds_read_b128 v[216:219], v240 offset:30720
s_waitcnt lgkmcnt(3)
v_mfma_f32_16x16x32_bf16 v[144:147], v[220:223], v[12:15], v[144:147]
v_add_f32 v231, v227, v236
v_cvt_pk_bf16_f32 v188, v236, v237
v_mfma_f32_16x16x32_bf16 v[148:151], v[220:223], v[44:47], v[148:151]
v_exp_f32 v239, v143
v_mfma_f32_16x16x32_bf16 v[152:155], v[220:223], v[76:79], v[152:155]
v_add_f32 v231, v231, v237
v_add_f32 v231, v231, v238
v_mfma_f32_16x16x32_bf16 v[156:159], v[220:223], v[108:111], v[156:159]
ds_read_b128 v[220:223], v240 offset:31232
s_waitcnt lgkmcnt(3)
v_mfma_f32_16x16x32_bf16 v[144:147], v[208:211], v[16:19], v[144:147]
v_add_f32 v231, v231, v239
v_cvt_pk_bf16_f32 v189, v238, v239
v_mfma_f32_16x16x32_bf16 v[148:151], v[208:211], v[48:51], v[148:151]
v_max3_f32 v242, v228, v229, v230
v_mfma_f32_16x16x32_bf16 v[152:155], v[208:211], v[80:83], v[152:155]
v_max_f32 v242, v242, v231
v_mfma_f32_16x16x32_bf16 v[156:159], v[208:211], v[112:115], v[156:159]
ds_read_b64_tr_b16 v[208:209], v249 offset:8192
s_waitcnt lgkmcnt(3)
v_mfma_f32_16x16x32_bf16 v[144:147], v[212:215], v[20:23], v[144:147]
ds_read_b64_tr_b16 v[210:211], v249 offset:10240
s_mov_b32 m0, s30
v_mfma_f32_16x16x32_bf16 v[148:151], v[212:215], v[52:55], v[148:151]
buffer_load_dwordx4 v241, s[12:15], s28 offen offset:0 sc1 lds
v_cmp_lt_f32 vcc, s32, v242
v_mfma_f32_16x16x32_bf16 v[152:155], v[212:215], v[84:87], v[152:155]
v_mfma_f32_16x16x32_bf16 v[156:159], v[212:215], v[116:119], v[156:159]
ds_read_b64_tr_b16 v[212:213], v250 offset:8192
s_waitcnt lgkmcnt(4)
v_mfma_f32_16x16x32_bf16 v[144:147], v[216:219], v[24:27], v[144:147]
ds_read_b64_tr_b16 v[214:215], v250 offset:10240
s_cbranch_vccnz L2_rare_site0
L2_ret0:
v_mfma_f32_16x16x32_bf16 v[148:151], v[216:219], v[56:59], v[148:151]
buffer_load_dwordx4 v241, s[12:15], s28 offen offset:1024 sc1 lds
v_mfma_f32_16x16x32_bf16 v[152:155], v[216:219], v[88:91], v[152:155]
v_mfma_f32_16x16x32_bf16 v[156:159], v[216:219], v[120:123], v[156:159]
ds_read_b64_tr_b16 v[216:217], v249 offset:8704
s_waitcnt lgkmcnt(5)
v_mfma_f32_16x16x32_bf16 v[144:147], v[220:223], v[28:31], v[144:147]
ds_read_b64_tr_b16 v[218:219], v249 offset:10752
v_mfma_f32_16x16x32_bf16 v[148:151], v[220:223], v[60:63], v[148:151]
buffer_load_dwordx4 v241, s[12:15], s28 offen offset:2048 sc1 lds
v_mfma_f32_16x16x32_bf16 v[152:155], v[220:223], v[92:95], v[152:155]
v_mfma_f32_16x16x32_bf16 v[156:159], v[220:223], v[124:127], v[156:159]
ds_read_b64_tr_b16 v[220:221], v250 offset:8704
s_waitcnt lgkmcnt(5)
v_mfma_f32_16x16x32_bf16 a[128:131], v[160:163], v[208:211], a[128:131]
ds_read_b64_tr_b16 v[222:223], v250 offset:10752
v_mfma_f32_16x16x32_bf16 a[132:135], v[164:167], v[208:211], a[132:135]
buffer_load_dwordx4 v241, s[12:15], s28 offen offset:3072 sc1 lds
v_mfma_f32_16x16x32_bf16 a[136:139], v[168:171], v[208:211], a[136:139]
v_mfma_f32_16x16x32_bf16 a[140:143], v[172:175], v[208:211], a[140:143]
ds_read_b64_tr_b16 v[208:209], v249 offset:12288
s_waitcnt lgkmcnt(5)
v_mfma_f32_16x16x32_bf16 a[144:147], v[160:163], v[212:215], a[144:147]
ds_read_b64_tr_b16 v[210:211], v249 offset:14336
v_mfma_f32_16x16x32_bf16 a[148:151], v[164:167], v[212:215], a[148:151]
v_mfma_f32_16x16x32_bf16 a[152:155], v[168:171], v[212:215], a[152:155]
v_add_u32 v240, 0x8000, v240
v_and_b32 v240, 0x1ffff, v240
v_mfma_f32_16x16x32_bf16 a[156:159], v[172:175], v[212:215], a[156:159]
ds_read_b64_tr_b16 v[212:213], v250 offset:12288
s_waitcnt lgkmcnt(5)
v_mfma_f32_16x16x32_bf16 a[160:163], v[160:163], v[216:219], a[160:163]
ds_read_b64_tr_b16 v[214:215], v250 offset:14336
v_mfma_f32_16x16x32_bf16 a[164:167], v[164:167], v[216:219], a[164:167]
v_exp_f32 v232, v144
v_mfma_f32_16x16x32_bf16 a[168:171], v[168:171], v[216:219], a[168:171]
v_exp_f32 v233, v145
v_mfma_f32_16x16x32_bf16 a[172:175], v[172:175], v[216:219], a[172:175]
ds_read_b64_tr_b16 v[216:217], v249 offset:12800
s_waitcnt lgkmcnt(5)
v_mfma_f32_16x16x32_bf16 a[176:179], v[160:163], v[220:223], a[176:179]
ds_read_b64_tr_b16 v[218:219], v249 offset:14848
v_mfma_f32_16x16x32_bf16 a[180:183], v[164:167], v[220:223], a[180:183]
v_exp_f32 v234, v146
v_mfma_f32_16x16x32_bf16 a[184:187], v[168:171], v[220:223], a[184:187]
v_add_f32 v224, v228, v232
v_cvt_pk_bf16_f32 v178, v232, v233
v_mfma_f32_16x16x32_bf16 a[188:191], v[172:175], v[220:223], a[188:191]
ds_read_b64_tr_b16 v[220:221], v250 offset:12800
s_waitcnt lgkmcnt(5)
v_mfma_f32_16x16x32_bf16 a[192:195], v[160:163], v[208:211], a[192:195]
ds_read_b64_tr_b16 v[222:223], v250 offset:14848
v_mfma_f32_16x16x32_bf16 a[196:199], v[164:167], v[208:211], a[196:199]
s_waitcnt vmcnt(4)
s_barrier
v_mfma_f32_16x16x32_bf16 a[200:203], v[168:171], v[208:211], a[200:203]
v_exp_f32 v235, v147
v_mfma_f32_16x16x32_bf16 a[204:207], v[172:175], v[208:211], a[204:207]
ds_read_b128 v[208:211], v240 offset:0
s_waitcnt lgkmcnt(5)
v_mfma_f32_16x16x32_bf16 a[208:211], v[160:163], v[212:215], a[208:211]
v_add_f32 v224, v224, v233
v_add_f32 v224, v224, v234
v_mfma_f32_16x16x32_bf16 a[212:215], v[164:167], v[212:215], a[212:215]
v_add_f32 v224, v224, v235
v_cvt_pk_bf16_f32 v179, v234, v235
v_mfma_f32_16x16x32_bf16 a[216:219], v[168:171], v[212:215], a[216:219]
v_exp_f32 v236, v148
v_mfma_f32_16x16x32_bf16 a[220:223], v[172:175], v[212:215], a[220:223]
ds_read_b128 v[212:215], v240 offset:512
s_waitcnt lgkmcnt(4)
v_mfma_f32_16x16x32_bf16 a[224:227], v[160:163], v[216:219], a[224:227]
v_exp_f32 v237, v149
v_mfma_f32_16x16x32_bf16 a[228:231], v[164:167], v[216:219], a[228:231]
v_exp_f32 v238, v150
v_mfma_f32_16x16x32_bf16 a[232:235], v[168:171], v[216:219], a[232:235]
v_add_f32 v225, v229, v236
v_cvt_pk_bf16_f32 v182, v236, v237
v_mfma_f32_16x16x32_bf16 a[236:239], v[172:175], v[216:219], a[236:239]
ds_read_b128 v[216:219], v240 offset:4096
s_waitcnt lgkmcnt(3)
v_mfma_f32_16x16x32_bf16 a[240:243], v[160:163], v[220:223], a[240:243]
v_exp_f32 v239, v151
v_mfma_f32_16x16x32_bf16 a[244:247], v[164:167], v[220:223], a[244:247]
v_add_f32 v225, v225, v237
v_add_f32 v225, v225, v238
v_mfma_f32_16x16x32_bf16 a[248:251], v[168:171], v[220:223], a[248:251]
v_add_f32 v225, v225, v239
v_cvt_pk_bf16_f32 v183, v238, v239
v_mfma_f32_16x16x32_bf16 a[252:255], v[172:175], v[220:223], a[252:255]
ds_read_b128 v[220:223], v240 offset:4608
s_waitcnt lgkmcnt(3)
v_mfma_f32_16x16x32_bf16 v[128:131], v[208:211], v[0:3], v[192:195]
v_exp_f32 v232, v152
v_mfma_f32_16x16x32_bf16 v[132:135], v[208:211], v[32:35], v[196:199]
v_exp_f32 v233, v153
v_mfma_f32_16x16x32_bf16 v[136:139], v[208:211], v[64:67], v[200:203]
v_exp_f32 v234, v154
v_mfma_f32_16x16x32_bf16 v[140:143], v[208:211], v[96:99], v[204:207]
ds_read_b128 v[208:211], v240 offset:8192
s_waitcnt lgkmcnt(3)
v_mfma_f32_16x16x32_bf16 v[128:131], v[212:215], v[4:7], v[128:131]
v_add_f32 v226, v230, v232
v_cvt_pk_bf16_f32 v186, v232, v233
v_mfma_f32_16x16x32_bf16 v[132:135], v[212:215], v[36:39], v[132:135]
v_exp_f32 v235, v155
v_mfma_f32_16x16x32_bf16 v[136:139], v[212:215], v[68:71], v[136:139]
v_add_f32 v226, v226, v233
v_add_f32 v226, v226, v234
v_mfma_f32_16x16x32_bf16 v[140:143], v[212:215], v[100:103], v[140:143]
ds_read_b128 v[212:215], v240 offset:8704
s_waitcnt lgkmcnt(3)
v_mfma_f32_16x16x32_bf16 v[128:131], v[216:219], v[8:11], v[128:131]
v_add_f32 v226, v226, v235
v_cvt_pk_bf16_f32 v187, v234, v235
v_mfma_f32_16x16x32_bf16 v[132:135], v[216:219], v[40:43], v[132:135]
v_exp_f32 v236, v156
v_mfma_f32_16x16x32_bf16 v[136:139], v[216:219], v[72:75], v[136:139]
v_exp_f32 v237, v157
v_mfma_f32_16x16x32_bf16 v[140:143], v[216:219], v[104:107], v[140:143]
ds_read_b128 v[216:219], v240 offset:12288
s_waitcnt lgkmcnt(3)
v_mfma_f32_16x16x32_bf16 v[128:131], v[220:223], v[12:15], v[128:131]
v_exp_f32 v238, v158
v_mfma_f32_16x16x32_bf16 v[132:135], v[220:223], v[44:47], v[132:135]
v_add_f32 v227, v231, v236
v_cvt_pk_bf16_f32 v190, v236, v237
v_mfma_f32_16x16x32_bf16 v[136:139], v[220:223], v[76:79], v[136:139]
v_exp_f32 v239, v159
v_mfma_f32_16x16x32_bf16 v[140:143], v[220:223], v[108:111], v[140:143]
ds_read_b128 v[220:223], v240 offset:12800
s_waitcnt lgkmcnt(3)
v_mfma_f32_16x16x32_bf16 v[128:131], v[208:211], v[16:19], v[128:131]
v_add_f32 v227, v227, v237
v_add_f32 v227, v227, v238
v_mfma_f32_16x16x32_bf16 v[132:135], v[208:211], v[48:51], v[132:135]
v_add_f32 v227, v227, v239
v_cvt_pk_bf16_f32 v191, v238, v239
v_mfma_f32_16x16x32_bf16 v[136:139], v[208:211], v[80:83], v[136:139]
v_max3_f32 v242, v224, v225, v226
v_mfma_f32_16x16x32_bf16 v[140:143], v[208:211], v[112:115], v[140:143]
ds_read_b64_tr_b16 v[208:209], v249 offset:16384
s_waitcnt lgkmcnt(3)
v_mfma_f32_16x16x32_bf16 v[128:131], v[212:215], v[20:23], v[128:131]
ds_read_b64_tr_b16 v[210:211], v249 offset:18432
v_max_f32 v242, v242, v227
v_mfma_f32_16x16x32_bf16 v[132:135], v[212:215], v[52:55], v[132:135]
v_cmp_lt_f32 vcc, s32, v242
v_mfma_f32_16x16x32_bf16 v[136:139], v[212:215], v[84:87], v[136:139]
v_mfma_f32_16x16x32_bf16 v[140:143], v[212:215], v[116:119], v[140:143]
ds_read_b64_tr_b16 v[212:213], v250 offset:16384
s_waitcnt lgkmcnt(4)
v_mfma_f32_16x16x32_bf16 v[128:131], v[216:219], v[24:27], v[128:131]
ds_read_b64_tr_b16 v[214:215], v250 offset:18432
s_cbranch_vccnz L2_rare_site1
L2_ret1:
v_mfma_f32_16x16x32_bf16 v[132:135], v[216:219], v[56:59], v[132:135]
v_mfma_f32_16x16x32_bf16 v[136:139], v[216:219], v[88:91], v[136:139]
s_sub_u32 s31, s31, 1
v_mfma_f32_16x16x32_bf16 v[140:143], v[216:219], v[120:123], v[140:143]
ds_read_b64_tr_b16 v[216:217], v249 offset:16896
s_waitcnt lgkmcnt(5)
v_mfma_f32_16x16x32_bf16 v[128:131], v[220:223], v[28:31], v[128:131]
ds_read_b64_tr_b16 v[218:219], v249 offset:18944
v_mfma_f32_16x16x32_bf16 v[132:135], v[220:223], v[60:63], v[132:135]
s_add_u32 s28, s28, s101
s_add_u32 s30, s30, 0x4000
v_mfma_f32_16x16x32_bf16 v[136:139], v[220:223], v[92:95], v[136:139]
s_and_b32 s30, s30, 0x1ffff
s_cmp_eq_u32 s31, 0
v_mfma_f32_16x16x32_bf16 v[140:143], v[220:223], v[124:127], v[140:143]
ds_read_b64_tr_b16 v[220:221], v250 offset:16896
ds_read_b64_tr_b16 v[222:223], v250 offset:18944
s_cbranch_scc1 L2_x1
L2_loop1:
s_waitcnt lgkmcnt(6)
v_mfma_f32_16x16x32_bf16 a[0:3], v[176:179], v[208:211], a[0:3]
v_mfma_f32_16x16x32_bf16 a[4:7], v[180:183], v[208:211], a[4:7]
v_mfma_f32_16x16x32_bf16 a[8:11], v[184:187], v[208:211], a[8:11]
v_mfma_f32_16x16x32_bf16 a[12:15], v[188:191], v[208:211], a[12:15]
ds_read_b64_tr_b16 v[208:209], v249 offset:20480
s_waitcnt lgkmcnt(5)
v_mfma_f32_16x16x32_bf16 a[16:19], v[176:179], v[212:215], a[16:19]
ds_read_b64_tr_b16 v[210:211], v249 offset:22528
v_mfma_f32_16x16x32_bf16 a[20:23], v[180:183], v[212:215], a[20:23]
v_mfma_f32_16x16x32_bf16 a[24:27], v[184:187], v[212:215], a[24:27]
v_mfma_f32_16x16x32_bf16 a[28:31], v[188:191], v[212:215], a[28:31]
ds_read_b64_tr_b16 v[212:213], v250 offset:20480
s_waitcnt lgkmcnt(5)
v_mfma_f32_16x16x32_bf16 a[32:35], v[176:179], v[216:219], a[32:35]
ds_read_b64_tr_b16 v[214:215], v250 offset:22528
v_mfma_f32_16x16x32_bf16 a[36:39], v[180:183], v[216:219], a[36:39]
v_exp_f32 v232, v128
v_mfma_f32_16x16x32_bf16 a[40:43], v[184:187], v[216:219], a[40:43]
v_exp_f32 v233, v129
v_mfma_f32_16x16x32_bf16 a[44:47], v[188:191], v[216:219], a[44:47]
ds_read_b64_tr_b16 v[216:217], v249 offset:20992
s_waitcnt lgkmcnt(5)
v_mfma_f32_16x16x32_bf16 a[48:51], v[176:179], v[220:223], a[48:51]
ds_read_b64_tr_b16 v[218:219], v249 offset:23040
v_mfma_f32_16x16x32_bf16 a[52:55], v[180:183], v[220:223], a[52:55]
v_exp_f32 v234, v130
v_mfma_f32_16x16x32_bf16 a[56:59], v[184:187], v[220:223], a[56:59]
v_add_f32 v228, v224, v232
v_cvt_pk_bf16_f32 v160, v232, v233
v_mfma_f32_16x16x32_bf16 a[60:63], v[188:191], v[220:223], a[60:63]
ds_read_b64_tr_b16 v[220:221], v250 offset:20992
s_waitcnt lgkmcnt(5)
v_mfma_f32_16x16x32_bf16 a[64:67], v[176:179], v[208:211], a[64:67]
ds_read_b64_tr_b16 v[222:223], v250 offset:23040
v_mfma_f32_16x16x32_bf16 a[68:71], v[180:183], v[208:211], a[68:71]
v_exp_f32 v235, v131
v_mfma_f32_16x16x32_bf16 a[72:75], v[184:187], v[208:211], a[72:75]
v_add_f32 v228, v228, v233
v_add_f32 v228, v228, v234
v_mfma_f32_16x16x32_bf16 a[76:79], v[188:191], v[208:211], a[76:79]
ds_read_b128 v[208:211], v240 offset:2048
s_waitcnt lgkmcnt(5)
v_mfma_f32_16x16x32_bf16 a[80:83], v[176:179], v[212:215], a[80:83]
v_add_f32 v228, v228, v235
v_cvt_pk_bf16_f32 v161, v234, v235
v_mfma_f32_16x16x32_bf16 a[84:87], v[180:183], v[212:215], a[84:87]
v_exp_f32 v236, v132
v_mfma_f32_16x16x32_bf16 a[88:91], v[184:187], v[212:215], a[88:91]
v_exp_f32 v237, v133
v_mfma_f32_16x16x32_bf16 a[92:95], v[188:191], v[212:215], a[92:95]
ds_read_b128 v[212:215], v240 offset:2560
s_waitcnt lgkmcnt(4)
v_mfma_f32_16x16x32_bf16 a[96:99], v[176:179], v[216:219], a[96:99]
v_exp_f32 v238, v134
v_mfma_f32_16x16x32_bf16 a[100:103], v[180:183], v[216:219], a[100:103]
v_add_f32 v229, v225, v236
v_cvt_pk_bf16_f32 v164, v236, v237
v_mfma_f32_16x16x32_bf16 a[104:107], v[184:187], v[216:219], a[104:107]
v_exp_f32 v239, v135
v_mfma_f32_16x16x32_bf16 a[108:111], v[188:191], v[216:219], a[108:111]
ds_read_b128 v[216:219], v240 offset:6144
s_waitcnt lgkmcnt(3)
v_mfma_f32_16x16x32_bf16 a[112:115], v[176:179], v[220:223], a[112:115]
v_add_f32 v229, v229, v237
v_add_f32 v229, v229, v238
v_mfma_f32_16x16x32_bf16 a[116:119], v[180:183], v[220:223], a[116:119]
v_add_f32 v229, v229, v239
v_cvt_pk_bf16_f32 v165, v238, v239
v_mfma_f32_16x16x32_bf16 a[120:123], v[184:187], v[220:223], a[120:123]
v_exp_f32 v232, v136
v_mfma_f32_16x16x32_bf16 a[124:127], v[188:191], v[220:223], a[124:127]
ds_read_b128 v[220:223], v240 offset:6656
s_waitcnt lgkmcnt(3)
v_mfma_f32_16x16x32_bf16 v[144:147], v[208:211], v[0:3], v[192:195]
v_exp_f32 v233, v137
v_mfma_f32_16x16x32_bf16 v[148:151], v[208:211], v[32:35], v[196:199]
v_exp_f32 v234, v138
v_mfma_f32_16x16x32_bf16 v[152:155], v[208:211], v[64:67], v[200:203]
v_add_f32 v230, v226, v232
v_cvt_pk_bf16_f32 v168, v232, v233
v_mfma_f32_16x16x32_bf16 v[156:159], v[208:211], v[96:99], v[204:207]
ds_read_b128 v[208:211], v240 offset:10240
s_waitcnt lgkmcnt(3)
v_mfma_f32_16x16x32_bf16 v[144:147], v[212:215], v[4:7], v[144:147]
v_exp_f32 v235, v139
v_mfma_f32_16x16x32_bf16 v[148:151], v[212:215], v[36:39], v[148:151]
v_add_f32 v230, v230, v233
v_add_f32 v230, v230, v234
v_mfma_f32_16x16x32_bf16 v[152:155], v[212:215], v[68:71], v[152:155]
v_add_f32 v230, v230, v235
v_cvt_pk_bf16_f32 v169, v234, v235
v_mfma_f32_16x16x32_bf16 v[156:159], v[212:215], v[100:103], v[156:159]
ds_read_b128 v[212:215], v240 offset:10752
s_waitcnt lgkmcnt(3)
v_mfma_f32_16x16x32_bf16 v[144:147], v[216:219], v[8:11], v[144:147]
v_exp_f32 v236, v140
v_mfma_f32_16x16x32_bf16 v[148:151], v[216:219], v[40:43], v[148:151]
v_exp_f32 v237, v141
v_mfma_f32_16x16x32_bf16 v[152:155], v[216:219], v[72:75], v[152:155]
v_exp_f32 v238, v142
v_mfma_f32_16x16x32_bf16 v[156:159], v[216:219], v[104:107], v[156:159]
ds_read_b128 v[216:219], v240 offset:14336
s_waitcnt lgkmcnt(3)
v_mfma_f32_16x16x32_bf16 v[144:147], v[220:223], v[12:15], v[144:147]
v_add_f32 v231, v227, v236
v_cvt_pk_bf16_f32 v172, v236, v237
v_mfma_f32_16x16x32_bf16 v[148:151], v[220:223], v[44:47], v[148:151]
v_exp_f32 v239, v143
v_mfma_f32_16x16x32_bf16 v[152:155], v[220:223], v[76:79], v[152:155]
v_add_f32 v231, v231, v237
v_add_f32 v231, v231, v238
v_mfma_f32_16x16x32_bf16 v[156:159], v[220:223], v[108:111], v[156:159]
ds_read_b128 v[220:223], v240 offset:14848
s_waitcnt lgkmcnt(3)
v_mfma_f32_16x16x32_bf16 v[144:147], v[208:211], v[16:19], v[144:147]
v_add_f32 v231, v231, v239
v_cvt_pk_bf16_f32 v173, v238, v239
v_mfma_f32_16x16x32_bf16 v[148:151], v[208:211], v[48:51], v[148:151]
v_max3_f32 v242, v228, v229, v230
v_mfma_f32_16x16x32_bf16 v[152:155], v[208:211], v[80:83], v[152:155]
v_max_f32 v242, v242, v231
v_mfma_f32_16x16x32_bf16 v[156:159], v[208:211], v[112:115], v[156:159]
ds_read_b64_tr_b16 v[208:209], v249 offset:24576
s_waitcnt lgkmcnt(3)
v_mfma_f32_16x16x32_bf16 v[144:147], v[212:215], v[20:23], v[144:147]
ds_read_b64_tr_b16 v[210:211], v249 offset:26624
s_mov_b32 m0, s30
v_mfma_f32_16x16x32_bf16 v[148:151], v[212:215], v[52:55], v[148:151]
buffer_load_dwordx4 v241, s[12:15], s28 offen offset:0 sc1 lds
v_cmp_lt_f32 vcc, s32, v242
v_mfma_f32_16x16x32_bf16 v[152:155], v[212:215], v[84:87], v[152:155]
v_mfma_f32_16x16x32_bf16 v[156:159], v[212:215], v[116:119], v[156:159]
ds_read_b64_tr_b16 v[212:213], v250 offset:24576
s_waitcnt lgkmcnt(4)
v_mfma_f32_16x16x32_bf16 v[144:147], v[216:219], v[24:27], v[144:147]
ds_read_b64_tr_b16 v[214:215], v250 offset:26624
s_cbranch_vccnz L2_rare_site2
L2_ret2:
v_mfma_f32_16x16x32_bf16 v[148:151], v[216:219], v[56:59], v[148:151]
buffer_load_dwordx4 v241, s[12:15], s28 offen offset:1024 sc1 lds
v_mfma_f32_16x16x32_bf16 v[152:155], v[216:219], v[88:91], v[152:155]
v_mfma_f32_16x16x32_bf16 v[156:159], v[216:219], v[120:123], v[156:159]
ds_read_b64_tr_b16 v[216:217], v249 offset:25088
s_waitcnt lgkmcnt(5)
v_mfma_f32_16x16x32_bf16 v[144:147], v[220:223], v[28:31], v[144:147]
ds_read_b64_tr_b16 v[218:219], v249 offset:27136
v_mfma_f32_16x16x32_bf16 v[148:151], v[220:223], v[60:63], v[148:151]
buffer_load_dwordx4 v241, s[12:15], s28 offen offset:2048 sc1 lds
v_mfma_f32_16x16x32_bf16 v[152:155], v[220:223], v[92:95], v[152:155]
v_mfma_f32_16x16x32_bf16 v[156:159], v[220:223], v[124:127], v[156:159]
ds_read_b64_tr_b16 v[220:221], v250 offset:25088
s_waitcnt lgkmcnt(5)
v_mfma_f32_16x16x32_bf16 a[128:131], v[176:179], v[208:211], a[128:131]
ds_read_b64_tr_b16 v[222:223], v250 offset:27136
v_mfma_f32_16x16x32_bf16 a[132:135], v[180:183], v[208:211], a[132:135]
buffer_load_dwordx4 v241, s[12:15], s28 offen offset:3072 sc1 lds
v_mfma_f32_16x16x32_bf16 a[136:139], v[184:187], v[208:211], a[136:139]
v_mfma_f32_16x16x32_bf16 a[140:143], v[188:191], v[208:211], a[140:143]
ds_read_b64_tr_b16 v[208:209], v249 offset:28672
s_waitcnt lgkmcnt(5)
v_mfma_f32_16x16x32_bf16 a[144:147], v[176:179], v[212:215], a[144:147]
ds_read_b64_tr_b16 v[210:211], v249 offset:30720
v_mfma_f32_16x16x32_bf16 a[148:151], v[180:183], v[212:215], a[148:151]
v_mfma_f32_16x16x32_bf16 a[152:155], v[184:187], v[212:215], a[152:155]
v_mfma_f32_16x16x32_bf16 a[156:159], v[188:191], v[212:215], a[156:159]
ds_read_b64_tr_b16 v[212:213], v250 offset:28672
s_waitcnt lgkmcnt(5)
v_mfma_f32_16x16x32_bf16 a[160:163], v[176:179], v[216:219], a[160:163]
ds_read_b64_tr_b16 v[214:215], v250 offset:30720
v_mfma_f32_16x16x32_bf16 a[164:167], v[180:183], v[216:219], a[164:167]
v_exp_f32 v232, v144
v_mfma_f32_16x16x32_bf16 a[168:171], v[184:187], v[216:219], a[168:171]
v_exp_f32 v233, v145
v_mfma_f32_16x16x32_bf16 a[172:175], v[188:191], v[216:219], a[172:175]
ds_read_b64_tr_b16 v[216:217], v249 offset:29184
s_waitcnt lgkmcnt(5)
v_mfma_f32_16x16x32_bf16 a[176:179], v[176:179], v[220:223], a[176:179]
ds_read_b64_tr_b16 v[218:219], v249 offset:31232
v_mfma_f32_16x16x32_bf16 a[180:183], v[180:183], v[220:223], a[180:183]
v_exp_f32 v234, v146
v_mfma_f32_16x16x32_bf16 a[184:187], v[184:187], v[220:223], a[184:187]
v_add_f32 v224, v228, v232
v_cvt_pk_bf16_f32 v162, v232, v233
v_mfma_f32_16x16x32_bf16 a[188:191], v[188:191], v[220:223], a[188:191]
ds_read_b64_tr_b16 v[220:221], v250 offset:29184
s_waitcnt lgkmcnt(5)
v_mfma_f32_16x16x32_bf16 a[192:195], v[176:179], v[208:211], a[192:195]
ds_read_b64_tr_b16 v[222:223], v250 offset:31232
v_mfma_f32_16x16x32_bf16 a[196:199], v[180:183], v[208:211], a[196:199]
s_waitcnt vmcnt(4)
s_barrier
v_mfma_f32_16x16x32_bf16 a[200:203], v[184:187], v[208:211], a[200:203]
v_exp_f32 v235, v147
v_mfma_f32_16x16x32_bf16 a[204:207], v[188:191], v[208:211], a[204:207]
ds_read_b128 v[208:211], v240 offset:16384
s_waitcnt lgkmcnt(5)
v_mfma_f32_16x16x32_bf16 a[208:211], v[176:179], v[212:215], a[208:211]
v_add_u32 v249, 0x8000, v249
v_and_b32 v249, 0x1ffff, v249
v_mfma_f32_16x16x32_bf16 a[212:215], v[180:183], v[212:215], a[212:215]
v_xor_b32 v250, 32, v249
v_add_f32 v224, v224, v233
v_mfma_f32_16x16x32_bf16 a[216:219], v[184:187], v[212:215], a[216:219]
v_add_f32 v224, v224, v234
v_add_f32 v224, v224, v235
v_mfma_f32_16x16x32_bf16 a[220:223], v[188:191], v[212:215], a[220:223]
ds_read_b128 v[212:215], v240 offset:16896
s_waitcnt lgkmcnt(4)
v_mfma_f32_16x16x32_bf16 a[224:227], v[176:179], v[216:219], a[224:227]
v_cvt_pk_bf16_f32 v163, v234, v235
v_mfma_f32_16x16x32_bf16 a[228:231], v[180:183], v[216:219], a[228:231]
v_exp_f32 v236, v148
v_mfma_f32_16x16x32_bf16 a[232:235], v[184:187], v[216:219], a[232:235]
v_exp_f32 v237, v149
v_mfma_f32_16x16x32_bf16 a[236:239], v[188:191], v[216:219], a[236:239]
ds_read_b128 v[216:219], v240 offset:20480
s_waitcnt lgkmcnt(3)
v_mfma_f32_16x16x32_bf16 a[240:243], v[176:179], v[220:223], a[240:243]
v_exp_f32 v238, v150
v_mfma_f32_16x16x32_bf16 a[244:247], v[180:183], v[220:223], a[244:247]
v_add_f32 v225, v229, v236
v_cvt_pk_bf16_f32 v166, v236, v237
v_mfma_f32_16x16x32_bf16 a[248:251], v[184:187], v[220:223], a[248:251]
v_exp_f32 v239, v151
v_mfma_f32_16x16x32_bf16 a[252:255], v[188:191], v[220:223], a[252:255]
ds_read_b128 v[220:223], v240 offset:20992
s_waitcnt lgkmcnt(3)
v_mfma_f32_16x16x32_bf16 v[128:131], v[208:211], v[0:3], v[192:195]
v_add_f32 v225, v225, v237
v_add_f32 v225, v225, v238
v_mfma_f32_16x16x32_bf16 v[132:135], v[208:211], v[32:35], v[196:199]
v_add_f32 v225, v225, v239
v_cvt_pk_bf16_f32 v167, v238, v239
v_mfma_f32_16x16x32_bf16 v[136:139], v[208:211], v[64:67], v[200:203]
v_exp_f32 v232, v152
v_mfma_f32_16x16x32_bf16 v[140:143], v[208:211], v[96:99], v[204:207]
ds_read_b128 v[208:211], v240 offset:24576
s_waitcnt lgkmcnt(3)
v_mfma_f32_16x16x32_bf16 v[128:131], v[212:215], v[4:7], v[128:131]
v_exp_f32 v233, v153
v_mfma_f32_16x16x32_bf16 v[132:135], v[212:215], v[36:39], v[132:135]
v_exp_f32 v234, v154
v_mfma_f32_16x16x32_bf16 v[136:139], v[212:215], v[68:71], v[136:139]
v_add_f32 v226, v230, v232
v_cvt_pk_bf16_f32 v170, v232, v233
v_mfma_f32_16x16x32_bf16 v[140:143], v[212:215], v[100:103], v[140:143]
ds_read_b128 v[212:215], v240 offset:25088
s_waitcnt lgkmcnt(3)
v_mfma_f32_16x16x32_bf16 v[128:131], v[216:219], v[8:11], v[128:131]
v_exp_f32 v235, v155
v_mfma_f32_16x16x32_bf16 v[132:135], v[216:219], v[40:43], v[132:135]
v_add_f32 v226, v226, v233
v_add_f32 v226, v226, v234
v_mfma_f32_16x16x32_bf16 v[136:139], v[216:219], v[72:75], v[136:139]
v_add_f32 v226, v226, v235
v_cvt_pk_bf16_f32 v171, v234, v235
v_mfma_f32_16x16x32_bf16 v[140:143], v[216:219], v[104:107], v[140:143]
ds_read_b128 v[216:219], v240 offset:28672
s_waitcnt lgkmcnt(3)
v_mfma_f32_16x16x32_bf16 v[128:131], v[220:223], v[12:15], v[128:131]
v_exp_f32 v236, v156
v_mfma_f32_16x16x32_bf16 v[132:135], v[220:223], v[44:47], v[132:135]
v_exp_f32 v237, v157
v_mfma_f32_16x16x32_bf16 v[136:139], v[220:223], v[76:79], v[136:139]
v_exp_f32 v238, v158
v_mfma_f32_16x16x32_bf16 v[140:143], v[220:223], v[108:111], v[140:143]
ds_read_b128 v[220:223], v240 offset:29184
s_waitcnt lgkmcnt(3)
v_mfma_f32_16x16x32_bf16 v[128:131], v[208:211], v[16:19], v[128:131]
v_add_f32 v227, v231, v236
v_cvt_pk_bf16_f32 v174, v236, v237
v_mfma_f32_16x16x32_bf16 v[132:135], v[208:211], v[48:51], v[132:135]
v_exp_f32 v239, v159
v_mfma_f32_16x16x32_bf16 v[136:139], v[208:211], v[80:83], v[136:139]
v_add_f32 v227, v227, v237
v_add_f32 v227, v227, v238
v_mfma_f32_16x16x32_bf16 v[140:143], v[208:211], v[112:115], v[140:143]
ds_read_b64_tr_b16 v[208:209], v249 offset:0
s_waitcnt lgkmcnt(3)
v_mfma_f32_16x16x32_bf16 v[128:131], v[212:215], v[20:23], v[128:131]
ds_read_b64_tr_b16 v[210:211], v249 offset:2048
v_add_f32 v227, v227, v239
v_mfma_f32_16x16x32_bf16 v[132:135], v[212:215], v[52:55], v[132:135]
v_cvt_pk_bf16_f32 v175, v238, v239
v_max3_f32 v242, v224, v225, v226
v_mfma_f32_16x16x32_bf16 v[136:139], v[212:215], v[84:87], v[136:139]
v_max_f32 v242, v242, v227
v_mfma_f32_16x16x32_bf16 v[140:143], v[212:215], v[116:119], v[140:143]
ds_read_b64_tr_b16 v[212:213], v250 offset:0
s_waitcnt lgkmcnt(4)
v_mfma_f32_16x16x32_bf16 v[128:131], v[216:219], v[24:27], v[128:131]
ds_read_b64_tr_b16 v[214:215], v250 offset:2048
v_cmp_lt_f32 vcc, s32, v242
v_mfma_f32_16x16x32_bf16 v[132:135], v[216:219], v[56:59], v[132:135]
v_mfma_f32_16x16x32_bf16 v[136:139], v[216:219], v[88:91], v[136:139]
s_sub_u32 s31, s31, 1
v_mfma_f32_16x16x32_bf16 v[140:143], v[216:219], v[120:123], v[140:143]
ds_read_b64_tr_b16 v[216:217], v249 offset:512
s_waitcnt lgkmcnt(5)
v_mfma_f32_16x16x32_bf16 v[128:131], v[220:223], v[28:31], v[128:131]
ds_read_b64_tr_b16 v[218:219], v249 offset:2560
s_cbranch_vccnz L2_rare_site3
L2_ret3:
v_mfma_f32_16x16x32_bf16 v[132:135], v[220:223], v[60:63], v[132:135]
s_add_u32 s28, s28, s101
s_add_u32 s30, s30, 0x4000
v_mfma_f32_16x16x32_bf16 v[136:139], v[220:223], v[92:95], v[136:139]
s_and_b32 s30, s30, 0x1ffff
s_cmp_eq_u32 s31, 0
v_mfma_f32_16x16x32_bf16 v[140:143], v[220:223], v[124:127], v[140:143]
ds_read_b64_tr_b16 v[220:221], v250 offset:512
ds_read_b64_tr_b16 v[222:223], v250 offset:2560
s_cbranch_scc0 L2_loop
s_cmp_eq_u32 s100, 0
s_cbranch_scc1 L2_tail_0
s_mov_b32 s3, 0
s_branch L2_ev
L2_x1:
s_cmp_eq_u32 s100, 0
s_cbranch_scc1 L2_tail_1
s_mov_b32 s3, 1
L2_ev:
s_sub_u32 s100, s100, 1
s_mov_b32 s31, 1
v_mov_b32 v251, 0x20000
s_cmp_eq_u32 s100, 0
s_cbranch_scc1 L2_ev3
s_cmp_lg_u32 s34, 0
s_cbranch_scc1 L2_evr
s_cmp_eq_u32 s100, 1
s_cbranch_scc1 L2_ev2
v_mov_b32 v252, s98
v_mov_b32 v253, s99
s_mov_b64 exec, 1
buffer_atomic_swap_x2 v[252:253], off, s[16:19], s49 sc0 sc1
s_mov_b64 exec, -1
s_branch L2_evr
L2_ev2:
s_mov_b64 exec, 1
ds_write_b64 v251, v[252:253]
s_mov_b64 exec, -1
s_branch L2_evr
L2_ev3:
ds_read_b64 v[252:253], v251
s_waitcnt lgkmcnt(0)
v_cmp_eq_u64 vcc, s[98:99], v[252:253]
s_nop 1
s_cmp_eq_u64 vcc, 0
s_cselect_b32 s31, s39, s35
L2_evr:
s_cmp_eq_u32 s3, 0
s_cbranch_scc1 L2_loop
s_branch L2_loop1
L2_tail_0:
s_waitcnt lgkmcnt(6)
v_mfma_f32_16x16x32_bf16 a[0:3], v[160:163], v[208:211], a[0:3]
s_mov_b32 m0, s30
v_mfma_f32_16x16x32_bf16 a[4:7], v[164:167], v[208:211], a[4:7]
buffer_load_dwordx4 v241, s[12:15], s28 offen offset:0 sc1 lds
v_add_u32 v253, s50, v248
v_mfma_f32_16x16x32_bf16 a[8:11], v[168:171], v[208:211], a[8:11]
buffer_load_dwordx4 v241, s[12:15], s28 offen offset:1024 sc1 lds
v_mfma_f32_16x16x32_bf16 a[12:15], v[172:175], v[208:211], a[12:15]
ds_read_b128 v[208:211], v240 offset:18432
s_waitcnt lgkmcnt(5)
buffer_load_dwordx4 v241, s[12:15], s28 offen offset:2048 sc1 lds
v_mfma_f32_16x16x32_bf16 a[16:19], v[160:163], v[212:215], a[16:19]
buffer_load_dwordx4 v241, s[12:15], s28 offen offset:3072 sc1 lds
v_mfma_f32_16x16x32_bf16 a[20:23], v[164:167], v[212:215], a[20:23]
s_add_u32 s28, s28, s101
s_add_u32 s30, s30, 0x4000
s_and_b32 s30, s30, 0x1ffff
v_mfma_f32_16x16x32_bf16 a[24:27], v[168:171], v[212:215], a[24:27]
s_mov_b32 m0, s30
v_mfma_f32_16x16x32_bf16 a[28:31], v[172:175], v[212:215], a[28:31]
ds_read_b128 v[212:215], v240 offset:18944
s_waitcnt lgkmcnt(4)
buffer_load_dwordx4 v241, s[12:15], s28 offen offset:0 sc1 lds
v_mfma_f32_16x16x32_bf16 a[32:35], v[160:163], v[216:219], a[32:35]
buffer_load_dwordx4 v241, s[12:15], s28 offen offset:1024 sc1 lds
v_mfma_f32_16x16x32_bf16 a[36:39], v[164:167], v[216:219], a[36:39]
buffer_load_dwordx4 v241, s[12:15], s28 offen offset:2048 sc1 lds
v_mfma_f32_16x16x32_bf16 a[40:43], v[168:171], v[216:219], a[40:43]
buffer_load_dwordx4 v241, s[12:15], s28 offen offset:3072 sc1 lds
v_mfma_f32_16x16x32_bf16 a[44:47], v[172:175], v[216:219], a[44:47]
ds_read_b128 v[216:219], v240 offset:22528
s_waitcnt lgkmcnt(3)
v_mfma_f32_16x16x32_bf16 a[48:51], v[160:163], v[220:223], a[48:51]
v_exp_f32 v232, v128
s_and_b32 s30, s30, 0x1c000
v_mfma_f32_16x16x32_bf16 a[52:55], v[164:167], v[220:223], a[52:55]
v_add_u32 v251, 0x8000, v240
v_and_b32 v251, 0x1ffff, v251
s_add_u32 s28, s30, 0x4000
v_mfma_f32_16x16x32_bf16 a[56:59], v[168:171], v[220:223], a[56:59]
v_add_u32 v252, 0x10000, v240
v_and_b32 v252, 0x1ffff, v252
s_and_b32 s28, s28, 0x1ffff
v_mfma_f32_16x16x32_bf16 a[60:63], v[172:175], v[220:223], a[60:63]
ds_read_b128 v[220:223], v240 offset:23040
s_waitcnt lgkmcnt(3)
s_add_u32 s30, s30, 0x8000
v_mfma_f32_16x16x32_bf16 v[144:147], v[208:211], v[0:3], v[192:195]
ds_write_b128 v253, v[160:163] offset:0
s_and_b32 s30, s30, 0x1ffff
s_mul_i32 s31, s34, 6144
v_mfma_f32_16x16x32_bf16 v[148:151], v[208:211], v[32:35], v[196:199]
ds_write_b128 v253, v[164:167] offset:1024
s_add_u32 s31, s31, s30
s_lshl_b32 s3, s34, 10
v_mfma_f32_16x16x32_bf16 v[152:155], v[208:211], v[64:67], v[200:203]
ds_write_b128 v253, v[168:171] offset:2048
s_add_u32 s28, s28, s3
s_add_u32 s3, s3, 24576
v_mfma_f32_16x16x32_bf16 v[156:159], v[208:211], v[96:99], v[204:207]
ds_read_b128 v[208:211], v240 offset:26624
s_waitcnt lgkmcnt(3)
ds_write_b128 v253, v[172:175] offset:3072
v_mfma_f32_16x16x32_bf16 v[144:147], v[212:215], v[4:7], v[144:147]
v_exp_f32 v233, v129
s_add_u32 s30, s30, s3
v_mfma_f32_16x16x32_bf16 v[148:151], v[212:215], v[36:39], v[148:151]
v_exp_f32 v234, v130
v_lshrrev_b32 v241, 4, v248
v_mfma_f32_16x16x32_bf16 v[152:155], v[212:215], v[68:71], v[152:155]
v_add_f32 v228, v224, v232
v_cvt_pk_bf16_f32 v176, v232, v233
v_and_b32 v241, 0x30, v241
v_mfma_f32_16x16x32_bf16 v[156:159], v[212:215], v[100:103], v[156:159]
ds_read_b128 v[212:215], v240 offset:27136
s_waitcnt lgkmcnt(3)
v_xor_b32 v241, v241, v248
v_mfma_f32_16x16x32_bf16 v[144:147], v[216:219], v[8:11], v[144:147]
v_exp_f32 v235, v131
v_mfma_f32_16x16x32_bf16 v[148:151], v[216:219], v[40:43], v[148:151]
v_add_f32 v228, v228, v233
v_add_f32 v228, v228, v234
v_mfma_f32_16x16x32_bf16 v[152:155], v[216:219], v[72:75], v[152:155]
v_add_f32 v228, v228, v235
v_cvt_pk_bf16_f32 v177, v234, v235
v_mfma_f32_16x16x32_bf16 v[156:159], v[216:219], v[104:107], v[156:159]
ds_read_b128 v[216:219], v240 offset:30720
s_waitcnt lgkmcnt(3)
v_mfma_f32_16x16x32_bf16 v[144:147], v[220:223], v[12:15], v[144:147]
v_exp_f32 v236, v132
v_mfma_f32_16x16x32_bf16 v[148:151], v[220:223], v[44:47], v[148:151]
v_exp_f32 v237, v133
v_mfma_f32_16x16x32_bf16 v[152:155], v[220:223], v[76:79], v[152:155]
v_exp_f32 v238, v134
v_mfma_f32_16x16x32_bf16 v[156:159], v[220:223], v[108:111], v[156:159]
ds_read_b128 v[220:223], v240 offset:31232
s_waitcnt lgkmcnt(3)
v_mfma_f32_16x16x32_bf16 v[144:147], v[208:211], v[16:19], v[144:147]
v_add_f32 v229, v225, v236
v_cvt_pk_bf16_f32 v180, v236, v237
v_and_b32 v243, 0x380, v248
v_mad_u32_u24 v241, v243, 3, v241
v_mfma_f32_16x16x32_bf16 v[148:151], v[208:211], v[48:51], v[148:151]
s_waitcnt vmcnt(8)
s_barrier
v_mfma_f32_16x16x32_bf16 v[152:155], v[208:211], v[80:83], v[152:155]
v_exp_f32 v239, v135
v_mfma_f32_16x16x32_bf16 v[156:159], v[208:211], v[112:115], v[156:159]
ds_read_b128 v[208:211], v251 offset:0
s_waitcnt lgkmcnt(3)
v_mfma_f32_16x16x32_bf16 v[144:147], v[212:215], v[20:23], v[144:147]
v_add_f32 v229, v229, v237
v_add_f32 v229, v229, v238
v_mfma_f32_16x16x32_bf16 v[148:151], v[212:215], v[52:55], v[148:151]
v_add_f32 v229, v229, v239
v_cvt_pk_bf16_f32 v181, v238, v239
v_mfma_f32_16x16x32_bf16 v[152:155], v[212:215], v[84:87], v[152:155]
v_exp_f32 v232, v136
v_mfma_f32_16x16x32_bf16 v[156:159], v[212:215], v[116:119], v[156:159]
ds_read_b128 v[212:215], v251 offset:512
s_waitcnt lgkmcnt(3)
v_mfma_f32_16x16x32_bf16 v[144:147], v[216:219], v[24:27], v[144:147]
v_exp_f32 v233, v137
v_mfma_f32_16x16x32_bf16 v[148:151], v[216:219], v[56:59], v[148:151]
v_exp_f32 v234, v138
v_mfma_f32_16x16x32_bf16 v[152:155], v[216:219], v[88:91], v[152:155]
v_add_f32 v230, v226, v232
v_cvt_pk_bf16_f32 v184, v232, v233
v_mfma_f32_16x16x32_bf16 v[156:159], v[216:219], v[120:123], v[156:159]
ds_read_b128 v[216:219], v251 offset:4096
s_waitcnt lgkmcnt(3)
v_mfma_f32_16x16x32_bf16 v[144:147], v[220:223], v[28:31], v[144:147]
v_exp_f32 v235, v139
v_mfma_f32_16x16x32_bf16 v[148:151], v[220:223], v[60:63], v[148:151]
v_add_f32 v230, v230, v233
v_add_f32 v230, v230, v234
v_mfma_f32_16x16x32_bf16 v[152:155], v[220:223], v[92:95], v[152:155]
v_add_f32 v230, v230, v235
v_cvt_pk_bf16_f32 v185, v234, v235
v_mfma_f32_16x16x32_bf16 v[156:159], v[220:223], v[124:127], v[156:159]
ds_read_b128 v[220:223], v251 offset:4608
s_waitcnt lgkmcnt(3)
v_exp_f32 v236, v140
v_exp_f32 v237, v141
v_exp_f32 v238, v142
v_add_f32 v231, v227, v236
v_cvt_pk_bf16_f32 v188, v236, v237
v_exp_f32 v239, v143
v_add_f32 v231, v231, v237
v_add_f32 v231, v231, v238
v_add_f32 v231, v231, v239
v_cvt_pk_bf16_f32 v189, v238, v239
v_max3_f32 v242, v228, v229, v230
v_max_f32 v242, v242, v231
v_cmp_lt_f32 vcc, s32, v242
s_cbranch_vccnz L2_rare_site4
L2_ret4:
v_mfma_f32_16x16x32_bf16 v[128:131], v[208:211], v[0:3], v[192:195]
s_add_u32 m0, s31, 0
v_mfma_f32_16x16x32_bf16 v[132:135], v[208:211], v[32:35], v[196:199]
v_exp_f32 v232, v144
v_mfma_f32_16x16x32_bf16 v[136:139], v[208:211], v[64:67], v[200:203]
v_exp_f32 v233, v145
v_mfma_f32_16x16x32_bf16 v[140:143], v[208:211], v[96:99], v[204:207]
ds_read_b128 v[208:211], v251 offset:8192
s_waitcnt lgkmcnt(3)
v_mfma_f32_16x16x32_bf16 v[128:131], v[212:215], v[4:7], v[128:131]
v_exp_f32 v234, v146
v_add_f32 v224, v228, v232
v_mfma_f32_16x16x32_bf16 v[132:135], v[212:215], v[36:39], v[132:135]
v_cvt_pk_bf16_f32 v178, v232, v233
v_exp_f32 v235, v147
v_mfma_f32_16x16x32_bf16 v[136:139], v[212:215], v[68:71], v[136:139]
v_add_f32 v224, v224, v233
v_add_f32 v224, v224, v234
v_add_f32 v224, v224, v235
v_mfma_f32_16x16x32_bf16 v[140:143], v[212:215], v[100:103], v[140:143]
ds_read_b128 v[212:215], v251 offset:8704
s_waitcnt lgkmcnt(3)
v_cvt_pk_bf16_f32 v179, v234, v235
v_mfma_f32_16x16x32_bf16 v[128:131], v[216:219], v[8:11], v[128:131]
v_exp_f32 v236, v148
v_mfma_f32_16x16x32_bf16 v[132:135], v[216:219], v[40:43], v[132:135]
v_exp_f32 v237, v149
v_mfma_f32_16x16x32_bf16 v[136:139], v[216:219], v[72:75], v[136:139]
v_exp_f32 v238, v150
v_add_f32 v225, v229, v236
v_mfma_f32_16x16x32_bf16 v[140:143], v[216:219], v[104:107], v[140:143]
ds_read_b128 v[216:219], v251 offset:12288
s_waitcnt lgkmcnt(3)
v_cvt_pk_bf16_f32 v182, v236, v237
v_mfma_f32_16x16x32_bf16 v[128:131], v[220:223], v[12:15], v[128:131]
v_exp_f32 v239, v151
v_add_f32 v225, v225, v237
v_mfma_f32_16x16x32_bf16 v[132:135], v[220:223], v[44:47], v[132:135]
v_add_f32 v225, v225, v238
v_add_f32 v225, v225, v239
v_cvt_pk_bf16_f32 v183, v238, v239
v_mfma_f32_16x16x32_bf16 v[136:139], v[220:223], v[76:79], v[136:139]
v_exp_f32 v232, v152
v_mfma_f32_16x16x32_bf16 v[140:143], v[220:223], v[108:111], v[140:143]
ds_read_b128 v[220:223], v251 offset:12800
s_waitcnt lgkmcnt(3)
v_mfma_f32_16x16x32_bf16 v[128:131], v[208:211], v[16:19], v[128:131]
v_exp_f32 v233, v153
v_mfma_f32_16x16x32_bf16 v[132:135], v[208:211], v[48:51], v[132:135]
v_exp_f32 v234, v154
v_add_f32 v226, v230, v232
v_mfma_f32_16x16x32_bf16 v[136:139], v[208:211], v[80:83], v[136:139]
v_cvt_pk_bf16_f32 v186, v232, v233
v_exp_f32 v235, v155
v_mfma_f32_16x16x32_bf16 v[140:143], v[208:211], v[112:115], v[140:143]
ds_read_b128 v[208:211], v251 offset:2048
s_waitcnt lgkmcnt(3)
v_add_f32 v226, v226, v233
v_mfma_f32_16x16x32_bf16 v[128:131], v[212:215], v[20:23], v[128:131]
v_add_f32 v226, v226, v234
v_add_f32 v226, v226, v235
v_cvt_pk_bf16_f32 v187, v234, v235
v_mfma_f32_16x16x32_bf16 v[132:135], v[212:215], v[52:55], v[132:135]
v_exp_f32 v236, v156
v_mfma_f32_16x16x32_bf16 v[136:139], v[212:215], v[84:87], v[136:139]
v_exp_f32 v237, v157
v_mfma_f32_16x16x32_bf16 v[140:143], v[212:215], v[116:119], v[140:143]
ds_read_b128 v[212:215], v251 offset:2560
s_waitcnt lgkmcnt(3)
v_mfma_f32_16x16x32_bf16 v[128:131], v[216:219], v[24:27], v[128:131]
v_exp_f32 v238, v158
v_add_f32 v227, v231, v236
v_mfma_f32_16x16x32_bf16 v[132:135], v[216:219], v[56:59], v[132:135]
v_cvt_pk_bf16_f32 v190, v236, v237
v_exp_f32 v239, v159
v_mfma_f32_16x16x32_bf16 v[136:139], v[216:219], v[88:91], v[136:139]
v_add_f32 v227, v227, v237
v_add_f32 v227, v227, v238
v_add_f32 v227, v227, v239
v_mfma_f32_16x16x32_bf16 v[140:143], v[216:219], v[120:123], v[140:143]
ds_read_b128 v[216:219], v251 offset:6144
s_waitcnt lgkmcnt(3)
v_cvt_pk_bf16_f32 v191, v238, v239
v_mfma_f32_16x16x32_bf16 v[128:131], v[220:223], v[28:31], v[128:131]
v_max3_f32 v242, v224, v225, v226
v_max_f32 v242, v242, v227
v_cmp_lt_f32 vcc, s32, v242
s_cbranch_vccnz L2_rare_site5
L2_ret5:
v_mfma_f32_16x16x32_bf16 v[132:135], v[220:223], v[60:63], v[132:135]
buffer_load_dwordx4 v241, s[8:11], s6 offen lds
s_add_u32 m0, s31, 2048
v_mfma_f32_16x16x32_bf16 v[136:139], v[220:223], v[92:95], v[136:139]
buffer_load_dwordx4 v241, s[8:11], s7 offen lds
s_add_u32 m0, s31, 4096
v_mfma_f32_16x16x32_bf16 v[140:143], v[220:223], v[124:127], v[140:143]
ds_read_b128 v[220:223], v251 offset:6656
s_waitcnt lgkmcnt(3)
v_mfma_f32_16x16x32_bf16 v[144:147], v[208:211], v[0:3], v[192:195]
ds_write_b128 v253, v[176:179] offset:4096
buffer_load_dwordx4 v241, s[8:11], s29 offen lds
s_add_u32 m0, s31, 1024
v_mfma_f32_16x16x32_bf16 v[148:151], v[208:211], v[32:35], v[196:199]
ds_write_b128 v253, v[180:183] offset:5120
v_exp_f32 v232, v128
v_mfma_f32_16x16x32_bf16 v[152:155], v[208:211], v[64:67], v[200:203]
ds_write_b128 v253, v[184:187] offset:6144
v_exp_f32 v233, v129
v_mfma_f32_16x16x32_bf16 v[156:159], v[208:211], v[96:99], v[204:207]
ds_read_b128 v[208:211], v251 offset:10240
s_waitcnt lgkmcnt(3)
ds_write_b128 v253, v[188:191] offset:7168
v_mfma_f32_16x16x32_bf16 v[144:147], v[212:215], v[4:7], v[144:147]
v_exp_f32 v234, v130
v_add_f32 v228, v224, v232
v_mfma_f32_16x16x32_bf16 v[148:151], v[212:215], v[36:39], v[148:151]
v_cvt_pk_bf16_f32 v160, v232, v233
v_exp_f32 v235, v131
v_mfma_f32_16x16x32_bf16 v[152:155], v[212:215], v[68:71], v[152:155]
v_add_f32 v228, v228, v233
v_add_f32 v228, v228, v234
v_add_f32 v228, v228, v235
v_mfma_f32_16x16x32_bf16 v[156:159], v[212:215], v[100:103], v[156:159]
ds_read_b128 v[212:215], v251 offset:10752
s_waitcnt lgkmcnt(3)
v_cvt_pk_bf16_f32 v161, v234, v235
v_mfma_f32_16x16x32_bf16 v[144:147], v[216:219], v[8:11], v[144:147]
v_exp_f32 v236, v132
v_xor_b32 v241, 0x1040, v241
v_mfma_f32_16x16x32_bf16 v[148:151], v[216:219], v[40:43], v[148:151]
v_exp_f32 v237, v133
v_mfma_f32_16x16x32_bf16 v[152:155], v[216:219], v[72:75], v[152:155]
v_exp_f32 v238, v134
v_add_f32 v229, v225, v236
v_mfma_f32_16x16x32_bf16 v[156:159], v[216:219], v[104:107], v[156:159]
ds_read_b128 v[216:219], v251 offset:14336
s_waitcnt lgkmcnt(3)
v_cvt_pk_bf16_f32 v164, v236, v237
v_mfma_f32_16x16x32_bf16 v[144:147], v[220:223], v[12:15], v[144:147]
v_exp_f32 v239, v135
v_add_f32 v229, v229, v237
v_mfma_f32_16x16x32_bf16 v[148:151], v[220:223], v[44:47], v[148:151]
v_add_f32 v229, v229, v238
v_add_f32 v229, v229, v239
v_cvt_pk_bf16_f32 v165, v238, v239
v_mfma_f32_16x16x32_bf16 v[152:155], v[220:223], v[76:79], v[152:155]
v_exp_f32 v232, v136
v_mfma_f32_16x16x32_bf16 v[156:159], v[220:223], v[108:111], v[156:159]
ds_read_b128 v[220:223], v251 offset:14848
s_waitcnt lgkmcnt(3)
v_mfma_f32_16x16x32_bf16 v[144:147], v[208:211], v[16:19], v[144:147]
v_exp_f32 v233, v137
v_mfma_f32_16x16x32_bf16 v[148:151], v[208:211], v[48:51], v[148:151]
s_waitcnt vmcnt(7)
s_barrier
v_mfma_f32_16x16x32_bf16 v[152:155], v[208:211], v[80:83], v[152:155]
v_exp_f32 v234, v138
v_add_f32 v230, v226, v232
v_mfma_f32_16x16x32_bf16 v[156:159], v[208:211], v[112:115], v[156:159]
ds_read_b128 v[208:211], v251 offset:16384
s_waitcnt lgkmcnt(3)
v_cvt_pk_bf16_f32 v168, v232, v233
v_mfma_f32_16x16x32_bf16 v[144:147], v[212:215], v[20:23], v[144:147]
v_exp_f32 v235, v139
v_add_f32 v230, v230, v233
v_mfma_f32_16x16x32_bf16 v[148:151], v[212:215], v[52:55], v[148:151]
v_add_f32 v230, v230, v234
v_add_f32 v230, v230, v235
v_cvt_pk_bf16_f32 v169, v234, v235
v_mfma_f32_16x16x32_bf16 v[152:155], v[212:215], v[84:87], v[152:155]
v_exp_f32 v236, v140
v_mfma_f32_16x16x32_bf16 v[156:159], v[212:215], v[116:119], v[156:159]
ds_read_b128 v[212:215], v251 offset:16896
s_waitcnt lgkmcnt(3)
v_mfma_f32_16x16x32_bf16 v[144:147], v[216:219], v[24:27], v[144:147]
v_exp_f32 v237, v141
v_mfma_f32_16x16x32_bf16 v[148:151], v[216:219], v[56:59], v[148:151]
v_exp_f32 v238, v142
v_add_f32 v231, v227, v236
v_mfma_f32_16x16x32_bf16 v[152:155], v[216:219], v[88:91], v[152:155]
v_cvt_pk_bf16_f32 v172, v236, v237
v_exp_f32 v239, v143
v_mfma_f32_16x16x32_bf16 v[156:159], v[216:219], v[120:123], v[156:159]
ds_read_b128 v[216:219], v251 offset:20480
s_waitcnt lgkmcnt(3)
v_add_f32 v231, v231, v237
v_mfma_f32_16x16x32_bf16 v[144:147], v[220:223], v[28:31], v[144:147]
v_add_f32 v231, v231, v238
v_add_f32 v231, v231, v239
v_cvt_pk_bf16_f32 v173, v238, v239
v_mfma_f32_16x16x32_bf16 v[148:151], v[220:223], v[60:63], v[148:151]
v_max3_f32 v242, v228, v229, v230
v_max_f32 v242, v242, v231
v_cmp_lt_f32 vcc, s32, v242
s_cbranch_vccnz L2_rare_site6
L2_ret6:
v_mfma_f32_16x16x32_bf16 v[152:155], v[220:223], v[92:95], v[152:155]
buffer_load_dwordx4 v241, s[8:11], s6 offen lds
s_add_u32 m0, s31, 3072
v_mfma_f32_16x16x32_bf16 v[156:159], v[220:223], v[124:127], v[156:159]
ds_read_b128 v[220:223], v251 offset:20992
s_waitcnt lgkmcnt(3)
v_mfma_f32_16x16x32_bf16 v[128:131], v[208:211], v[0:3], v[192:195]
buffer_load_dwordx4 v241, s[8:11], s7 offen lds
s_add_u32 m0, s31, 5120
v_mfma_f32_16x16x32_bf16 v[132:135], v[208:211], v[32:35], v[196:199]
v_exp_f32 v232, v144
v_mfma_f32_16x16x32_bf16 v[136:139], v[208:211], v[64:67], v[200:203]
v_exp_f32 v233, v145
v_mfma_f32_16x16x32_bf16 v[140:143], v[208:211], v[96:99], v[204:207]
ds_read_b128 v[208:211], v251 offset:24576
s_waitcnt lgkmcnt(3)
v_mfma_f32_16x16x32_bf16 v[128:131], v[212:215], v[4:7], v[128:131]
v_exp_f32 v234, v146
v_add_f32 v224, v228, v232
v_mfma_f32_16x16x32_bf16 v[132:135], v[212:215], v[36:39], v[132:135]
v_cvt_pk_bf16_f32 v162, v232, v233
v_exp_f32 v235, v147
v_mfma_f32_16x16x32_bf16 v[136:139], v[212:215], v[68:71], v[136:139]
v_add_f32 v224, v224, v233
v_add_f32 v224, v224, v234
v_add_f32 v224, v224, v235
v_mfma_f32_16x16x32_bf16 v[140:143], v[212:215], v[100:103], v[140:143]
ds_read_b128 v[212:215], v251 offset:25088
s_waitcnt lgkmcnt(3)
v_cvt_pk_bf16_f32 v163, v234, v235
v_mfma_f32_16x16x32_bf16 v[128:131], v[216:219], v[8:11], v[128:131]
v_exp_f32 v236, v148
v_mfma_f32_16x16x32_bf16 v[132:135], v[216:219], v[40:43], v[132:135]
v_exp_f32 v237, v149
v_mfma_f32_16x16x32_bf16 v[136:139], v[216:219], v[72:75], v[136:139]
v_exp_f32 v238, v150
v_add_f32 v225, v229, v236
v_mfma_f32_16x16x32_bf16 v[140:143], v[216:219], v[104:107], v[140:143]
ds_read_b128 v[216:219], v251 offset:28672
s_waitcnt lgkmcnt(3)
v_cvt_pk_bf16_f32 v166, v236, v237
v_mfma_f32_16x16x32_bf16 v[128:131], v[220:223], v[12:15], v[128:131]
v_exp_f32 v239, v151
v_add_f32 v225, v225, v237
v_mfma_f32_16x16x32_bf16 v[132:135], v[220:223], v[44:47], v[132:135]
v_add_f32 v225, v225, v238
v_add_f32 v225, v225, v239
v_cvt_pk_bf16_f32 v167, v238, v239
v_mfma_f32_16x16x32_bf16 v[136:139], v[220:223], v[76:79], v[136:139]
v_exp_f32 v232, v152
v_mfma_f32_16x16x32_bf16 v[140:143], v[220:223], v[108:111], v[140:143]
ds_read_b128 v[220:223], v251 offset:29184
s_waitcnt lgkmcnt(3)
v_mfma_f32_16x16x32_bf16 v[128:131], v[208:211], v[16:19], v[128:131]
v_exp_f32 v233, v153
v_mfma_f32_16x16x32_bf16 v[132:135], v[208:211], v[48:51], v[132:135]
v_exp_f32 v234, v154
v_add_f32 v226, v230, v232
v_mfma_f32_16x16x32_bf16 v[136:139], v[208:211], v[80:83], v[136:139]
v_cvt_pk_bf16_f32 v170, v232, v233
v_exp_f32 v235, v155
v_mfma_f32_16x16x32_bf16 v[140:143], v[208:211], v[112:115], v[140:143]
ds_read_b128 v[208:211], v251 offset:18432
s_waitcnt lgkmcnt(3)
v_add_f32 v226, v226, v233
v_mfma_f32_16x16x32_bf16 v[128:131], v[212:215], v[20:23], v[128:131]
v_add_f32 v226, v226, v234
v_add_f32 v226, v226, v235
v_cvt_pk_bf16_f32 v171, v234, v235
v_mfma_f32_16x16x32_bf16 v[132:135], v[212:215], v[52:55], v[132:135]
v_exp_f32 v236, v156
v_mfma_f32_16x16x32_bf16 v[136:139], v[212:215], v[84:87], v[136:139]
v_exp_f32 v237, v157
v_mfma_f32_16x16x32_bf16 v[140:143], v[212:215], v[116:119], v[140:143]
ds_read_b128 v[212:215], v251 offset:18944
s_waitcnt lgkmcnt(3)
v_mfma_f32_16x16x32_bf16 v[128:131], v[216:219], v[24:27], v[128:131]
v_exp_f32 v238, v158
v_add_f32 v227, v231, v236
v_mfma_f32_16x16x32_bf16 v[132:135], v[216:219], v[56:59], v[132:135]
v_cvt_pk_bf16_f32 v174, v236, v237
v_exp_f32 v239, v159
v_mfma_f32_16x16x32_bf16 v[136:139], v[216:219], v[88:91], v[136:139]
v_add_f32 v227, v227, v237
v_add_f32 v227, v227, v238
v_add_f32 v227, v227, v239
v_mfma_f32_16x16x32_bf16 v[140:143], v[216:219], v[120:123], v[140:143]
ds_read_b128 v[216:219], v251 offset:22528
s_waitcnt lgkmcnt(3)
v_cvt_pk_bf16_f32 v175, v238, v239
v_mfma_f32_16x16x32_bf16 v[128:131], v[220:223], v[28:31], v[128:131]
v_max3_f32 v242, v224, v225, v226
v_max_f32 v242, v242, v227
v_cmp_lt_f32 vcc, s32, v242
s_cbranch_vccnz L2_rare_site7
L2_ret7:
v_mfma_f32_16x16x32_bf16 v[132:135], v[220:223], v[60:63], v[132:135]
buffer_load_dwordx4 v241, s[8:11], s29 offen lds
v_mfma_f32_16x16x32_bf16 v[136:139], v[220:223], v[92:95], v[136:139]
v_mfma_f32_16x16x32_bf16 v[140:143], v[220:223], v[124:127], v[140:143]
ds_read_b128 v[220:223], v251 offset:23040
s_waitcnt lgkmcnt(3)
v_mfma_f32_16x16x32_bf16 v[144:147], v[208:211], v[0:3], v[192:195]
v_mfma_f32_16x16x32_bf16 v[148:151], v[208:211], v[32:35], v[196:199]
v_exp_f32 v232, v128
v_lshlrev_b32 v241, 3, v248
v_mfma_f32_16x16x32_bf16 v[152:155], v[208:211], v[64:67], v[200:203]
v_exp_f32 v233, v129
s_mov_b32 s3, 0x7c28000
v_mfma_f32_16x16x32_bf16 v[156:159], v[208:211], v[96:99], v[204:207]
ds_read_b128 v[208:211], v251 offset:26624
s_waitcnt lgkmcnt(3)
buffer_load_dwordx2 v[240:241], v241, s[16:19], s3 offen sc1
v_mfma_f32_16x16x32_bf16 v[144:147], v[212:215], v[4:7], v[144:147]
v_exp_f32 v234, v130
v_add_f32 v228, v224, v232
v_mfma_f32_16x16x32_bf16 v[148:151], v[212:215], v[36:39], v[148:151]
v_cvt_pk_bf16_f32 v176, v232, v233
v_exp_f32 v235, v131
v_mfma_f32_16x16x32_bf16 v[152:155], v[212:215], v[68:71], v[152:155]
v_add_f32 v228, v228, v233
v_add_f32 v228, v228, v234
v_add_f32 v228, v228, v235
v_mfma_f32_16x16x32_bf16 v[156:159], v[212:215], v[100:103], v[156:159]
ds_read_b128 v[212:215], v251 offset:27136
s_waitcnt lgkmcnt(3)
v_cvt_pk_bf16_f32 v177, v234, v235
v_mfma_f32_16x16x32_bf16 v[144:147], v[216:219], v[8:11], v[144:147]
v_exp_f32 v236, v132
v_mfma_f32_16x16x32_bf16 v[148:151], v[216:219], v[40:43], v[148:151]
v_exp_f32 v237, v133
v_mfma_f32_16x16x32_bf16 v[152:155], v[216:219], v[72:75], v[152:155]
v_exp_f32 v238, v134
v_add_f32 v229, v225, v236
v_mfma_f32_16x16x32_bf16 v[156:159], v[216:219], v[104:107], v[156:159]
ds_read_b128 v[216:219], v251 offset:30720
s_waitcnt lgkmcnt(3)
v_cvt_pk_bf16_f32 v180, v236, v237
v_mfma_f32_16x16x32_bf16 v[144:147], v[220:223], v[12:15], v[144:147]
v_exp_f32 v239, v135
v_add_f32 v229, v229, v237
v_mfma_f32_16x16x32_bf16 v[148:151], v[220:223], v[44:47], v[148:151]
v_add_f32 v229, v229, v238
v_add_f32 v229, v229, v239
v_cvt_pk_bf16_f32 v181, v238, v239
v_mfma_f32_16x16x32_bf16 v[152:155], v[220:223], v[76:79], v[152:155]
v_exp_f32 v232, v136
v_mfma_f32_16x16x32_bf16 v[156:159], v[220:223], v[108:111], v[156:159]
ds_read_b128 v[220:223], v251 offset:31232
s_waitcnt lgkmcnt(3)
v_mfma_f32_16x16x32_bf16 v[144:147], v[208:211], v[16:19], v[144:147]
v_exp_f32 v233, v137
v_mfma_f32_16x16x32_bf16 v[148:151], v[208:211], v[48:51], v[148:151]
s_waitcnt vmcnt(7)
s_barrier
v_mfma_f32_16x16x32_bf16 v[152:155], v[208:211], v[80:83], v[152:155]
v_exp_f32 v234, v138
v_add_f32 v230, v226, v232
v_mfma_f32_16x16x32_bf16 v[156:159], v[208:211], v[112:115], v[156:159]
ds_read_b128 v[208:211], v252 offset:0
s_waitcnt lgkmcnt(3)
v_cvt_pk_bf16_f32 v184, v232, v233
v_mfma_f32_16x16x32_bf16 v[144:147], v[212:215], v[20:23], v[144:147]
v_exp_f32 v235, v139
v_add_f32 v230, v230, v233
v_mfma_f32_16x16x32_bf16 v[148:151], v[212:215], v[52:55], v[148:151]
v_add_f32 v230, v230, v234
v_add_f32 v230, v230, v235
v_cvt_pk_bf16_f32 v185, v234, v235
v_mfma_f32_16x16x32_bf16 v[152:155], v[212:215], v[84:87], v[152:155]
v_exp_f32 v236, v140
v_mfma_f32_16x16x32_bf16 v[156:159], v[212:215], v[116:119], v[156:159]
ds_read_b128 v[212:215], v252 offset:512
s_waitcnt lgkmcnt(3)
v_mfma_f32_16x16x32_bf16 v[144:147], v[216:219], v[24:27], v[144:147]
v_exp_f32 v237, v141
v_mfma_f32_16x16x32_bf16 v[148:151], v[216:219], v[56:59], v[148:151]
v_exp_f32 v238, v142
v_add_f32 v231, v227, v236
v_mfma_f32_16x16x32_bf16 v[152:155], v[216:219], v[88:91], v[152:155]
v_cvt_pk_bf16_f32 v188, v236, v237
v_exp_f32 v239, v143
v_mfma_f32_16x16x32_bf16 v[156:159], v[216:219], v[120:123], v[156:159]
ds_read_b128 v[216:219], v252 offset:4096
s_waitcnt lgkmcnt(3)
v_add_f32 v231, v231, v237
v_mfma_f32_16x16x32_bf16 v[144:147], v[220:223], v[28:31], v[144:147]
v_add_f32 v231, v231, v238
v_add_f32 v231, v231, v239
v_cvt_pk_bf16_f32 v189, v238, v239
v_mfma_f32_16x16x32_bf16 v[148:151], v[220:223], v[60:63], v[148:151]
v_max3_f32 v242, v228, v229, v230
v_max_f32 v242, v242, v231
v_cmp_lt_f32 vcc, s32, v242
s_cbranch_vccnz L2_rare_site8
L2_ret8:
v_mfma_f32_16x16x32_bf16 v[152:155], v[220:223], v[92:95], v[152:155]
v_mfma_f32_16x16x32_bf16 v[156:159], v[220:223], v[124:127], v[156:159]
ds_read_b128 v[220:223], v252 offset:4608
s_waitcnt lgkmcnt(3)
v_mfma_f32_16x16x32_bf16 v[128:131], v[208:211], v[0:3], v[192:195]
v_mfma_f32_16x16x32_bf16 v[132:135], v[208:211], v[32:35], v[196:199]
v_exp_f32 v232, v144
v_mfma_f32_16x16x32_bf16 v[136:139], v[208:211], v[64:67], v[200:203]
v_exp_f32 v233, v145
v_mfma_f32_16x16x32_bf16 v[140:143], v[208:211], v[96:99], v[204:207]
ds_read_b128 v[208:211], v252 offset:8192
s_waitcnt lgkmcnt(3)
v_mfma_f32_16x16x32_bf16 v[128:131], v[212:215], v[4:7], v[128:131]
v_exp_f32 v234, v146
v_add_f32 v224, v228, v232
v_mfma_f32_16x16x32_bf16 v[132:135], v[212:215], v[36:39], v[132:135]
v_cvt_pk_bf16_f32 v178, v232, v233
v_exp_f32 v235, v147
v_mfma_f32_16x16x32_bf16 v[136:139], v[212:215], v[68:71], v[136:139]
v_add_f32 v224, v224, v233
v_add_f32 v224, v224, v234
v_add_f32 v224, v224, v235
v_mfma_f32_16x16x32_bf16 v[140:143], v[212:215], v[100:103], v[140:143]
ds_read_b128 v[212:215], v252 offset:8704
s_waitcnt lgkmcnt(3)
v_cvt_pk_bf16_f32 v179, v234, v235
v_mfma_f32_16x16x32_bf16 v[128:131], v[216:219], v[8:11], v[128:131]
v_exp_f32 v236, v148
v_mfma_f32_16x16x32_bf16 v[132:135], v[216:219], v[40:43], v[132:135]
v_exp_f32 v237, v149
v_mfma_f32_16x16x32_bf16 v[136:139], v[216:219], v[72:75], v[136:139]
v_exp_f32 v238, v150
v_add_f32 v225, v229, v236
v_mfma_f32_16x16x32_bf16 v[140:143], v[216:219], v[104:107], v[140:143]
ds_read_b128 v[216:219], v252 offset:12288
s_waitcnt lgkmcnt(3)
v_cvt_pk_bf16_f32 v182, v236, v237
v_mfma_f32_16x16x32_bf16 v[128:131], v[220:223], v[12:15], v[128:131]
v_exp_f32 v239, v151
v_add_f32 v225, v225, v237
v_mfma_f32_16x16x32_bf16 v[132:135], v[220:223], v[44:47], v[132:135]
v_add_f32 v225, v225, v238
v_add_f32 v225, v225, v239
v_cvt_pk_bf16_f32 v183, v238, v239
v_mfma_f32_16x16x32_bf16 v[136:139], v[220:223], v[76:79], v[136:139]
v_exp_f32 v232, v152
v_mfma_f32_16x16x32_bf16 v[140:143], v[220:223], v[108:111], v[140:143]
ds_read_b128 v[220:223], v252 offset:12800
s_waitcnt lgkmcnt(3)
v_mfma_f32_16x16x32_bf16 v[128:131], v[208:211], v[16:19], v[128:131]
v_exp_f32 v233, v153
v_mfma_f32_16x16x32_bf16 v[132:135], v[208:211], v[48:51], v[132:135]
v_exp_f32 v234, v154
v_add_f32 v226, v230, v232
v_mfma_f32_16x16x32_bf16 v[136:139], v[208:211], v[80:83], v[136:139]
v_cvt_pk_bf16_f32 v186, v232, v233
v_exp_f32 v235, v155
v_mfma_f32_16x16x32_bf16 v[140:143], v[208:211], v[112:115], v[140:143]
ds_read_b128 v[208:211], v252 offset:2048
s_waitcnt lgkmcnt(3)
v_add_f32 v226, v226, v233
v_mfma_f32_16x16x32_bf16 v[128:131], v[212:215], v[20:23], v[128:131]
v_add_f32 v226, v226, v234
v_add_f32 v226, v226, v235
v_cvt_pk_bf16_f32 v187, v234, v235
v_mfma_f32_16x16x32_bf16 v[132:135], v[212:215], v[52:55], v[132:135]
v_exp_f32 v236, v156
v_mfma_f32_16x16x32_bf16 v[136:139], v[212:215], v[84:87], v[136:139]
v_exp_f32 v237, v157
v_mfma_f32_16x16x32_bf16 v[140:143], v[212:215], v[116:119], v[140:143]
ds_read_b128 v[212:215], v252 offset:2560
s_waitcnt lgkmcnt(3)
v_mfma_f32_16x16x32_bf16 v[128:131], v[216:219], v[24:27], v[128:131]
v_exp_f32 v238, v158
v_add_f32 v227, v231, v236
v_mfma_f32_16x16x32_bf16 v[132:135], v[216:219], v[56:59], v[132:135]
v_cvt_pk_bf16_f32 v190, v236, v237
v_exp_f32 v239, v159
v_mfma_f32_16x16x32_bf16 v[136:139], v[216:219], v[88:91], v[136:139]
v_add_f32 v227, v227, v237
v_add_f32 v227, v227, v238
v_add_f32 v227, v227, v239
v_mfma_f32_16x16x32_bf16 v[140:143], v[216:219], v[120:123], v[140:143]
ds_read_b128 v[216:219], v252 offset:6144
s_waitcnt lgkmcnt(3)
v_cvt_pk_bf16_f32 v191, v238, v239
v_mfma_f32_16x16x32_bf16 v[128:131], v[220:223], v[28:31], v[128:131]
v_max3_f32 v242, v224, v225, v226
v_max_f32 v242, v242, v227
v_cmp_lt_f32 vcc, s32, v242
s_cbranch_vccnz L2_rare_site9
L2_ret9:
v_mfma_f32_16x16x32_bf16 v[132:135], v[220:223], v[60:63], v[132:135]
v_mfma_f32_16x16x32_bf16 v[136:139], v[220:223], v[92:95], v[136:139]
v_mfma_f32_16x16x32_bf16 v[140:143], v[220:223], v[124:127], v[140:143]
ds_read_b128 v[220:223], v252 offset:6656
s_waitcnt lgkmcnt(3)
v_mfma_f32_16x16x32_bf16 v[144:147], v[208:211], v[0:3], v[192:195]
v_mfma_f32_16x16x32_bf16 v[148:151], v[208:211], v[32:35], v[196:199]
v_mfma_f32_16x16x32_bf16 v[152:155], v[208:211], v[64:67], v[200:203]
v_mfma_f32_16x16x32_bf16 v[156:159], v[208:211], v[96:99], v[204:207]
ds_read_b128 v[208:211], v252 offset:10240
s_waitcnt lgkmcnt(3)
v_mfma_f32_16x16x32_bf16 v[144:147], v[212:215], v[4:7], v[144:147]
v_exp_f32 v232, v128
v_mfma_f32_16x16x32_bf16 v[148:151], v[212:215], v[36:39], v[148:151]
v_exp_f32 v233, v129
v_mfma_f32_16x16x32_bf16 v[152:155], v[212:215], v[68:71], v[152:155]
v_exp_f32 v234, v130
v_add_f32 v228, v224, v232
v_mfma_f32_16x16x32_bf16 v[156:159], v[212:215], v[100:103], v[156:159]
ds_read_b128 v[212:215], v252 offset:10752
s_waitcnt lgkmcnt(3)
v_cvt_pk_bf16_f32 v0, v232, v233
v_mfma_f32_16x16x32_bf16 v[144:147], v[216:219], v[8:11], v[144:147]
v_exp_f32 v235, v131
v_add_f32 v228, v228, v233
v_mfma_f32_16x16x32_bf16 v[148:151], v[216:219], v[40:43], v[148:151]
ds_read_b128 v[4:7], v253 offset:0
v_add_f32 v228, v228, v234
v_add_f32 v228, v228, v235
v_mfma_f32_16x16x32_bf16 v[152:155], v[216:219], v[72:75], v[152:155]
ds_read_b128 v[36:39], v253 offset:1024
v_cvt_pk_bf16_f32 v1, v234, v235
v_mfma_f32_16x16x32_bf16 v[156:159], v[216:219], v[104:107], v[156:159]
ds_read_b128 v[216:219], v252 offset:14336
s_waitcnt lgkmcnt(3)
v_mfma_f32_16x16x32_bf16 v[144:147], v[220:223], v[12:15], v[144:147]
v_exp_f32 v236, v132
v_mfma_f32_16x16x32_bf16 v[148:151], v[220:223], v[44:47], v[148:151]
ds_read_b128 v[68:71], v253 offset:2048
ds_read_b128 v[8:11], v253 offset:4096
v_mfma_f32_16x16x32_bf16 v[152:155], v[220:223], v[76:79], v[152:155]
v_add_u32 v12, 0x8000, v249
v_and_b32 v12, 0x1ffff, v12
ds_read_b128 v[100:103], v253 offset:3072
ds_read_b128 v[40:43], v253 offset:5120
v_mfma_f32_16x16x32_bf16 v[156:159], v[220:223], v[108:111], v[156:159]
ds_read_b128 v[220:223], v252 offset:14848
s_waitcnt lgkmcnt(3)
v_add_u32 v14, 0x10000, v249
v_and_b32 v14, 0x1ffff, v14
v_mfma_f32_16x16x32_bf16 v[144:147], v[208:211], v[16:19], v[144:147]
v_xor_b32 v13, 32, v12
v_xor_b32 v15, 32, v14
v_mfma_f32_16x16x32_bf16 v[148:151], v[208:211], v[48:51], v[148:151]
ds_read_b128 v[72:75], v253 offset:6144
v_exp_f32 v237, v133
v_mfma_f32_16x16x32_bf16 v[152:155], v[208:211], v[80:83], v[152:155]
ds_read_b128 v[104:107], v253 offset:7168
v_exp_f32 v238, v134
v_mfma_f32_16x16x32_bf16 v[156:159], v[208:211], v[112:115], v[156:159]
ds_read_b64_tr_b16 v[208:209], v249 offset:16384
s_waitcnt lgkmcnt(3)
v_add_f32 v229, v225, v236
v_mfma_f32_16x16x32_bf16 v[144:147], v[212:215], v[20:23], v[144:147]
ds_read_b64_tr_b16 v[210:211], v249 offset:18432
v_cvt_pk_bf16_f32 v32, v236, v237
v_mfma_f32_16x16x32_bf16 v[148:151], v[212:215], v[52:55], v[148:151]
v_exp_f32 v239, v135
v_add_f32 v229, v229, v237
v_mfma_f32_16x16x32_bf16 v[152:155], v[212:215], v[84:87], v[152:155]
v_add_f32 v229, v229, v238
v_add_f32 v229, v229, v239
v_cvt_pk_bf16_f32 v33, v238, v239
v_mfma_f32_16x16x32_bf16 v[156:159], v[212:215], v[116:119], v[156:159]
ds_read_b64_tr_b16 v[212:213], v12 offset:0
s_waitcnt lgkmcnt(4)
v_mfma_f32_16x16x32_bf16 v[144:147], v[216:219], v[24:27], v[144:147]
ds_read_b64_tr_b16 v[214:215], v12 offset:2048
v_exp_f32 v232, v136
v_mfma_f32_16x16x32_bf16 v[148:151], v[216:219], v[56:59], v[148:151]
v_exp_f32 v233, v137
v_mfma_f32_16x16x32_bf16 v[152:155], v[216:219], v[88:91], v[152:155]
v_exp_f32 v234, v138
v_add_f32 v230, v226, v232
v_mfma_f32_16x16x32_bf16 v[156:159], v[216:219], v[120:123], v[156:159]
ds_read_b64_tr_b16 v[216:217], v12 offset:16384
s_waitcnt lgkmcnt(5)
v_cvt_pk_bf16_f32 v64, v232, v233
v_mfma_f32_16x16x32_bf16 v[144:147], v[220:223], v[28:31], v[144:147]
ds_read_b64_tr_b16 v[218:219], v12 offset:18432
v_exp_f32 v235, v139
v_mfma_f32_16x16x32_bf16 v[148:151], v[220:223], v[60:63], v[148:151]
v_add_f32 v230, v230, v233
v_add_f32 v230, v230, v234
v_add_f32 v230, v230, v235
v_mfma_f32_16x16x32_bf16 v[152:155], v[220:223], v[92:95], v[152:155]
v_cvt_pk_bf16_f32 v65, v234, v235
v_exp_f32 v236, v140
v_mfma_f32_16x16x32_bf16 v[156:159], v[220:223], v[124:127], v[156:159]
ds_read_b64_tr_b16 v[220:221], v250 offset:16384
s_waitcnt lgkmcnt(5)
v_exp_f32 v237, v141
v_exp_f32 v238, v142
v_add_f32 v231, v227, v236
v_cvt_pk_bf16_f32 v96, v236, v237
v_exp_f32 v239, v143
v_add_f32 v231, v231, v237
v_add_f32 v231, v231, v238
v_add_f32 v231, v231, v239
v_cvt_pk_bf16_f32 v97, v238, v239
v_max3_f32 v242, v228, v229, v230
v_max_f32 v242, v242, v231
v_cmp_lt_f32 vcc, s32, v242
s_cbranch_vccnz L2_rare_site10
L2_ret10:
v_mfma_f32_16x16x32_bf16 a[0:3], v[8:11], v[208:211], a[0:3]
ds_read_b64_tr_b16 v[222:223], v250 offset:18432
s_waitcnt vmcnt(0)
v_cmp_ne_u64_e64 s[38:39], s[98:99], v[240:241]
v_mfma_f32_16x16x32_bf16 a[4:7], v[40:43], v[208:211], a[4:7]
v_exp_f32 v232, v144
v_mfma_f32_16x16x32_bf16 a[8:11], v[72:75], v[208:211], a[8:11]
v_exp_f32 v233, v145
v_mfma_f32_16x16x32_bf16 a[12:15], v[104:107], v[208:211], a[12:15]
ds_read_b64_tr_b16 v[208:209], v13 offset:0
s_waitcnt lgkmcnt(5)
v_mfma_f32_16x16x32_bf16 a[0:3], v[160:163], v[212:215], a[0:3]
ds_read_b64_tr_b16 v[210:211], v13 offset:2048
s_and_b64 s[38:39], s[38:39], s[96:97]
s_cbranch_scc1 LF_hl_0
LF_hlret_0:
v_mfma_f32_16x16x32_bf16 a[4:7], v[164:167], v[212:215], a[4:7]
v_exp_f32 v234, v146
v_lshrrev_b32 v241, 4, v248
v_mfma_f32_16x16x32_bf16 a[8:11], v[168:171], v[212:215], a[8:11]
v_add_f32 v224, v228, v232
v_cvt_pk_bf16_f32 v2, v232, v233
v_and_b32 v241, 0x30, v241
v_mfma_f32_16x16x32_bf16 a[12:15], v[172:175], v[212:215], a[12:15]
ds_read_b64_tr_b16 v[212:213], v13 offset:16384
s_waitcnt lgkmcnt(5)
v_xor_b32 v241, v241, v248
v_mfma_f32_16x16x32_bf16 a[0:3], v[176:179], v[216:219], a[0:3]
ds_read_b64_tr_b16 v[214:215], v13 offset:18432
v_and_b32 v243, 0x380, v248
v_mad_u32_u24 v241, v243, 3, v241
v_mfma_f32_16x16x32_bf16 a[4:7], v[180:183], v[216:219], a[4:7]
v_exp_f32 v235, v147
v_add_u32 v241, 0x7000000, v241
v_mfma_f32_16x16x32_bf16 a[8:11], v[184:187], v[216:219], a[8:11]
v_add_f32 v224, v224, v233
v_add_f32 v224, v224, v234
v_and_b32 v110, 0x70, v248
v_mfma_f32_16x16x32_bf16 a[12:15], v[188:191], v[216:219], a[12:15]
ds_read_b64_tr_b16 v[216:217], v249 offset:16896
s_waitcnt lgkmcnt(5)
v_lshlrev_b32 v110, 3, v110
v_mfma_f32_16x16x32_bf16 a[16:19], v[8:11], v[220:223], a[16:19]
ds_read_b64_tr_b16 v[218:219], v249 offset:18944
v_add_f32 v224, v224, v235
v_add_u32 v110, 0x7c32000, v110
v_mfma_f32_16x16x32_bf16 a[20:23], v[40:43], v[220:223], a[20:23]
v_cvt_pk_bf16_f32 v3, v234, v235
buffer_load_dwordx2 v[108:109], v110, s[16:19], 0 offen sc1
v_mfma_f32_16x16x32_bf16 a[24:27], v[72:75], v[220:223], a[24:27]
v_exp_f32 v236, v148
v_mfma_f32_16x16x32_bf16 a[28:31], v[104:107], v[220:223], a[28:31]
ds_read_b64_tr_b16 v[220:221], v12 offset:512
s_waitcnt lgkmcnt(5)
v_mfma_f32_16x16x32_bf16 a[16:19], v[160:163], v[208:211], a[16:19]
ds_read_b64_tr_b16 v[222:223], v12 offset:2560
s_add_u32 m0, s28, 0
v_mfma_f32_16x16x32_bf16 a[20:23], v[164:167], v[208:211], a[20:23]
v_exp_f32 v237, v149
v_mfma_f32_16x16x32_bf16 a[24:27], v[168:171], v[208:211], a[24:27]
v_exp_f32 v238, v150
v_mfma_f32_16x16x32_bf16 a[28:31], v[172:175], v[208:211], a[28:31]
ds_read_b64_tr_b16 v[208:209], v12 offset:16896
s_waitcnt lgkmcnt(5)
v_mfma_f32_16x16x32_bf16 a[16:19], v[176:179], v[212:215], a[16:19]
ds_read_b64_tr_b16 v[210:211], v12 offset:18944
v_add_f32 v225, v229, v236
v_mfma_f32_16x16x32_bf16 a[20:23], v[180:183], v[212:215], a[20:23]
v_cvt_pk_bf16_f32 v34, v236, v237
buffer_load_dwordx4 v241, s[16:19], s6 offen sc1 lds
s_add_u32 m0, s28, 8192
v_mfma_f32_16x16x32_bf16 a[24:27], v[184:187], v[212:215], a[24:27]
v_exp_f32 v239, v151
v_mfma_f32_16x16x32_bf16 a[28:31], v[188:191], v[212:215], a[28:31]
ds_read_b64_tr_b16 v[212:213], v250 offset:16896
s_waitcnt lgkmcnt(5)
v_mfma_f32_16x16x32_bf16 a[32:35], v[8:11], v[216:219], a[32:35]
ds_read_b64_tr_b16 v[214:215], v250 offset:18944
v_add_f32 v225, v225, v237
v_mfma_f32_16x16x32_bf16 a[36:39], v[40:43], v[216:219], a[36:39]
v_add_f32 v225, v225, v238
v_add_f32 v225, v225, v239
v_mfma_f32_16x16x32_bf16 a[40:43], v[72:75], v[216:219], a[40:43]
v_cvt_pk_bf16_f32 v35, v238, v239
buffer_load_dwordx4 v241, s[16:19], s7 offen sc1 lds
s_add_u32 m0, s30, 0
v_mfma_f32_16x16x32_bf16 a[44:47], v[104:107], v[216:219], a[44:47]
ds_read_b64_tr_b16 v[216:217], v13 offset:512
s_waitcnt lgkmcnt(5)
v_mfma_f32_16x16x32_bf16 a[32:35], v[160:163], v[220:223], a[32:35]
ds_read_b64_tr_b16 v[218:219], v13 offset:2560
buffer_load_dwordx4 v241, s[16:19], s29 offen sc1 lds
s_add_u32 m0, s28, 4096
v_mfma_f32_16x16x32_bf16 a[36:39], v[164:167], v[220:223], a[36:39]
v_exp_f32 v232, v152
v_xor_b32 v241, 0x1040, v241
v_mfma_f32_16x16x32_bf16 a[40:43], v[168:171], v[220:223], a[40:43]
v_exp_f32 v233, v153
v_mfma_f32_16x16x32_bf16 a[44:47], v[172:175], v[220:223], a[44:47]
ds_read_b64_tr_b16 v[220:221], v13 offset:16896
s_waitcnt lgkmcnt(5)
v_mfma_f32_16x16x32_bf16 a[32:35], v[176:179], v[208:211], a[32:35]
ds_read_b64_tr_b16 v[222:223], v13 offset:18944
buffer_load_dwordx4 v241, s[16:19], s6 offen sc1 lds
s_add_u32 m0, s28, 12288
v_mfma_f32_16x16x32_bf16 a[36:39], v[180:183], v[208:211], a[36:39]
v_exp_f32 v234, v154
v_mfma_f32_16x16x32_bf16 a[40:43], v[184:187], v[208:211], a[40:43]
v_add_f32 v226, v230, v232
v_cvt_pk_bf16_f32 v66, v232, v233
v_mfma_f32_16x16x32_bf16 a[44:47], v[188:191], v[208:211], a[44:47]
ds_read_b64_tr_b16 v[208:209], v14 offset:0
s_waitcnt lgkmcnt(5)
v_mfma_f32_16x16x32_bf16 a[48:51], v[8:11], v[212:215], a[48:51]
ds_read_b64_tr_b16 v[210:211], v14 offset:2048
buffer_load_dwordx4 v241, s[16:19], s7 offen sc1 lds
s_add_u32 m0, s30, 4096
v_mfma_f32_16x16x32_bf16 a[52:55], v[40:43], v[212:215], a[52:55]
v_exp_f32 v235, v155
v_mfma_f32_16x16x32_bf16 a[56:59], v[72:75], v[212:215], a[56:59]
v_add_f32 v226, v226, v233
v_add_f32 v226, v226, v234
v_mfma_f32_16x16x32_bf16 a[60:63], v[104:107], v[212:215], a[60:63]
ds_read_b64_tr_b16 v[212:213], v15 offset:0
s_waitcnt lgkmcnt(5)
v_mfma_f32_16x16x32_bf16 a[48:51], v[160:163], v[216:219], a[48:51]
ds_read_b64_tr_b16 v[214:215], v15 offset:2048
v_add_f32 v226, v226, v235
v_mfma_f32_16x16x32_bf16 a[52:55], v[164:167], v[216:219], a[52:55]
v_cvt_pk_bf16_f32 v67, v234, v235
buffer_load_dwordx4 v241, s[16:19], s29 offen sc1 lds
v_mfma_f32_16x16x32_bf16 a[56:59], v[168:171], v[216:219], a[56:59]
v_exp_f32 v236, v156
v_mfma_f32_16x16x32_bf16 a[60:63], v[172:175], v[216:219], a[60:63]
ds_read_b64_tr_b16 v[216:217], v14 offset:512
s_waitcnt lgkmcnt(5)
v_mfma_f32_16x16x32_bf16 a[48:51], v[176:179], v[220:223], a[48:51]
ds_read_b64_tr_b16 v[218:219], v14 offset:2560
v_mfma_f32_16x16x32_bf16 a[52:55], v[180:183], v[220:223], a[52:55]
v_exp_f32 v237, v157
v_mfma_f32_16x16x32_bf16 a[56:59], v[184:187], v[220:223], a[56:59]
v_exp_f32 v238, v158
v_add_f32 v227, v231, v236
v_cvt_pk_bf16_f32 v98, v236, v237
v_exp_f32 v239, v159
v_add_f32 v227, v227, v237
v_add_f32 v227, v227, v238
v_add_f32 v227, v227, v239
v_cvt_pk_bf16_f32 v99, v238, v239
v_max3_f32 v242, v224, v225, v226
v_max_f32 v242, v242, v227
v_cmp_lt_f32 vcc, s32, v242
s_cbranch_vccnz L2_rare_site11
L2_ret11:
v_mfma_f32_16x16x32_bf16 a[60:63], v[188:191], v[220:223], a[60:63]
ds_read_b64_tr_b16 v[220:221], v15 offset:512
s_waitcnt lgkmcnt(5)
v_mfma_f32_16x16x32_bf16 a[0:3], v[0:3], v[208:211], a[0:3]
ds_read_b64_tr_b16 v[222:223], v15 offset:2560
v_bfe_u32 v242, v248, 8, 1
v_mul_u32_u24 v242, 48, v242
v_mfma_f32_16x16x32_bf16 a[4:7], v[32:35], v[208:211], a[4:7]
v_lshl_add_u32 v242, s37, 3, v242
v_and_b32 v243, 0xf0, v248
v_lshl_add_u32 v242, v243, 3, v242
v_mfma_f32_16x16x32_bf16 a[8:11], v[64:67], v[208:211], a[8:11]
v_mov_b32 v232, v224
v_mov_b32 v234, v225
v_mov_b32 v236, v226
v_mfma_f32_16x16x32_bf16 a[12:15], v[96:99], v[208:211], a[12:15]
ds_read_b64_tr_b16 v[208:209], v249 offset:4096
s_waitcnt lgkmcnt(5)
v_mov_b32 v238, v227
v_mfma_f32_16x16x32_bf16 a[16:19], v[0:3], v[212:215], a[16:19]
ds_read_b64_tr_b16 v[210:211], v249 offset:6144
v_permlane32_swap_b32 v224, v232
v_permlane32_swap_b32 v225, v234
v_mfma_f32_16x16x32_bf16 a[20:23], v[32:35], v[212:215], a[20:23]
v_permlane32_swap_b32 v226, v236
v_permlane32_swap_b32 v227, v238
v_add_f32 v224, v224, v232
v_mfma_f32_16x16x32_bf16 a[24:27], v[64:67], v[212:215], a[24:27]
v_add_f32 v225, v225, v234
v_add_f32 v226, v226, v236
v_add_f32 v227, v227, v238
v_mfma_f32_16x16x32_bf16 a[28:31], v[96:99], v[212:215], a[28:31]
ds_read_b64_tr_b16 v[212:213], v249 offset:20480
s_waitcnt lgkmcnt(5)
v_mov_b32 v232, v224
v_mfma_f32_16x16x32_bf16 a[32:35], v[0:3], v[216:219], a[32:35]
ds_read_b64_tr_b16 v[214:215], v249 offset:22528
v_mov_b32 v234, v225
v_mov_b32 v236, v226
v_mfma_f32_16x16x32_bf16 a[36:39], v[32:35], v[216:219], a[36:39]
v_mov_b32 v238, v227
v_permlane16_swap_b32 v224, v232
v_permlane16_swap_b32 v225, v234
v_mfma_f32_16x16x32_bf16 a[40:43], v[64:67], v[216:219], a[40:43]
v_permlane16_swap_b32 v226, v236
v_permlane16_swap_b32 v227, v238
v_add_f32 v233, v224, v232
v_mfma_f32_16x16x32_bf16 a[44:47], v[96:99], v[216:219], a[44:47]
ds_read_b64_tr_b16 v[216:217], v12 offset:4096
s_waitcnt lgkmcnt(5)
v_add_f32 v235, v225, v234
v_mfma_f32_16x16x32_bf16 a[48:51], v[0:3], v[220:223], a[48:51]
ds_read_b64_tr_b16 v[218:219], v12 offset:6144
v_add_f32 v237, v226, v236
v_add_f32 v239, v227, v238
v_mfma_f32_16x16x32_bf16 a[52:55], v[32:35], v[220:223], a[52:55]
v_mov_b32 v232, v244
v_mov_b32 v234, v245
v_mov_b32 v236, v246
v_mfma_f32_16x16x32_bf16 a[56:59], v[64:67], v[220:223], a[56:59]
v_mov_b32 v238, v247
v_mfma_f32_16x16x32_bf16 a[60:63], v[96:99], v[220:223], a[60:63]
ds_read_b64_tr_b16 v[220:221], v12 offset:20480
s_waitcnt lgkmcnt(5)
v_mfma_f32_16x16x32_bf16 a[64:67], v[4:7], v[208:211], a[64:67]
ds_read_b64_tr_b16 v[222:223], v12 offset:22528
v_mfma_f32_16x16x32_bf16 a[68:71], v[36:39], v[208:211], a[68:71]
s_mov_b32 exec_hi, 0
buffer_store_dwordx2 v[232:233], v242, s[24:27], s48 offen sc1
s_lshr_b32 s3, s41, 2
buffer_store_dwordx2 v[234:235], v242, s[24:27], s3 offen sc1
s_lshr_b32 s3, s42, 2
buffer_store_dwordx2 v[236:237], v242, s[24:27], s3 offen sc1
s_lshr_b32 s3, s43, 2
buffer_store_dwordx2 v[238:239], v242, s[24:27], s3 offen sc1
s_mov_b32 exec_hi, -1
v_mfma_f32_16x16x32_bf16 a[72:75], v[68:71], v[208:211], a[72:75]
v_accvgpr_read_b32 v128, a0
v_accvgpr_read_b32 v129, a1
v_accvgpr_read_b32 v130, a2
v_mfma_f32_16x16x32_bf16 a[76:79], v[100:103], v[208:211], a[76:79]
ds_read_b64_tr_b16 v[208:209], v14 offset:4096
s_waitcnt lgkmcnt(5)
v_accvgpr_read_b32 v131, a3
v_mfma_f32_16x16x32_bf16 a[64:67], v[8:11], v[212:215], a[64:67]
ds_read_b64_tr_b16 v[210:211], v14 offset:6144
v_cvt_pk_bf16_f32 v16, v128, v129
v_cvt_pk_bf16_f32 v17, v130, v131
v_mfma_f32_16x16x32_bf16 a[68:71], v[40:43], v[212:215], a[68:71]
v_accvgpr_read_b32 v136, a4
v_accvgpr_read_b32 v137, a5
v_accvgpr_read_b32 v138, a6
v_mfma_f32_16x16x32_bf16 a[72:75], v[72:75], v[212:215], a[72:75]
v_accvgpr_read_b32 v139, a7
v_cvt_pk_bf16_f32 v48, v136, v137
v_cvt_pk_bf16_f32 v49, v138, v139
v_mfma_f32_16x16x32_bf16 a[76:79], v[104:107], v[212:215], a[76:79]
ds_read_b64_tr_b16 v[212:213], v250 offset:4096
s_waitcnt lgkmcnt(5)
v_accvgpr_read_b32 v144, a8
v_mfma_f32_16x16x32_bf16 a[64:67], v[160:163], v[216:219], a[64:67]
ds_read_b64_tr_b16 v[214:215], v250 offset:6144
v_accvgpr_read_b32 v145, a9
v_accvgpr_read_b32 v146, a10
v_mfma_f32_16x16x32_bf16 a[68:71], v[164:167], v[216:219], a[68:71]
v_accvgpr_read_b32 v147, a11
v_cvt_pk_bf16_f32 v80, v144, v145
v_cvt_pk_bf16_f32 v81, v146, v147
v_mfma_f32_16x16x32_bf16 a[72:75], v[168:171], v[216:219], a[72:75]
v_accvgpr_read_b32 v152, a12
v_accvgpr_read_b32 v153, a13
v_accvgpr_read_b32 v154, a14
v_mfma_f32_16x16x32_bf16 a[76:79], v[172:175], v[216:219], a[76:79]
ds_read_b64_tr_b16 v[216:217], v250 offset:20480
s_waitcnt lgkmcnt(5)
v_accvgpr_read_b32 v155, a15
v_mfma_f32_16x16x32_bf16 a[64:67], v[176:179], v[220:223], a[64:67]
ds_read_b64_tr_b16 v[218:219], v250 offset:22528
v_cvt_pk_bf16_f32 v112, v152, v153
v_cvt_pk_bf16_f32 v113, v154, v155
v_mfma_f32_16x16x32_bf16 a[68:71], v[180:183], v[220:223], a[68:71]
v_accvgpr_read_b32 v132, a16
v_accvgpr_read_b32 v133, a17
v_accvgpr_read_b32 v134, a18
v_mfma_f32_16x16x32_bf16 a[72:75], v[184:187], v[220:223], a[72:75]
v_accvgpr_read_b32 v135, a19
v_cvt_pk_bf16_f32 v18, v132, v133
v_cvt_pk_bf16_f32 v19, v134, v135
v_mfma_f32_16x16x32_bf16 a[76:79], v[188:191], v[220:223], a[76:79]
ds_read_b64_tr_b16 v[220:221], v13 offset:4096
s_waitcnt lgkmcnt(5)
buffer_store_dwordx4 v[16:19], v248, s[20:23], s40 offen offset:0 sc1
v_mfma_f32_16x16x32_bf16 a[64:67], v[0:3], v[208:211], a[64:67]
ds_read_b64_tr_b16 v[222:223], v13 offset:6144
ds_write_b128 v253, v[16:19] offset:0
v_accvgpr_read_b32 v140, a20
v_mfma_f32_16x16x32_bf16 a[68:71], v[32:35], v[208:211], a[68:71]
v_accvgpr_read_b32 v141, a21
v_accvgpr_read_b32 v142, a22
v_accvgpr_read_b32 v143, a23
v_mfma_f32_16x16x32_bf16 a[72:75], v[64:67], v[208:211], a[72:75]
v_cvt_pk_bf16_f32 v50, v140, v141
v_cvt_pk_bf16_f32 v51, v142, v143
buffer_store_dwordx4 v[48:51], v248, s[20:23], s41 offen offset:0 sc1
v_mfma_f32_16x16x32_bf16 a[76:79], v[96:99], v[208:211], a[76:79]
ds_read_b64_tr_b16 v[208:209], v13 offset:20480
s_waitcnt lgkmcnt(5)
v_accvgpr_read_b32 v148, a24
v_mfma_f32_16x16x32_bf16 a[80:83], v[4:7], v[212:215], a[80:83]
ds_read_b64_tr_b16 v[210:211], v13 offset:22528
v_accvgpr_read_b32 v149, a25
v_accvgpr_read_b32 v150, a26
v_mfma_f32_16x16x32_bf16 a[84:87], v[36:39], v[212:215], a[84:87]
v_accvgpr_read_b32 v151, a27
v_cvt_pk_bf16_f32 v82, v148, v149
v_cvt_pk_bf16_f32 v83, v150, v151
v_mfma_f32_16x16x32_bf16 a[88:91], v[68:71], v[212:215], a[88:91]
buffer_store_dwordx4 v[80:83], v248, s[20:23], s42 offen offset:0 sc1
v_accvgpr_read_b32 v156, a28
v_accvgpr_read_b32 v157, a29
v_mfma_f32_16x16x32_bf16 a[92:95], v[100:103], v[212:215], a[92:95]
ds_read_b64_tr_b16 v[212:213], v15 offset:4096
s_waitcnt lgkmcnt(5)
v_accvgpr_read_b32 v158, a30
v_mfma_f32_16x16x32_bf16 a[80:83], v[8:11], v[216:219], a[80:83]
ds_read_b64_tr_b16 v[214:215], v15 offset:6144
v_accvgpr_read_b32 v159, a31
v_cvt_pk_bf16_f32 v114, v156, v157
v_mfma_f32_16x16x32_bf16 a[84:87], v[40:43], v[216:219], a[84:87]
v_cvt_pk_bf16_f32 v115, v158, v159
buffer_store_dwordx4 v[112:115], v248, s[20:23], s43 offen offset:0 sc1
v_accvgpr_read_b32 v128, a32
v_mfma_f32_16x16x32_bf16 a[88:91], v[72:75], v[216:219], a[88:91]
v_accvgpr_read_b32 v129, a33
v_accvgpr_read_b32 v130, a34
v_accvgpr_read_b32 v131, a35
v_mfma_f32_16x16x32_bf16 a[92:95], v[104:107], v[216:219], a[92:95]
ds_read_b64_tr_b16 v[216:217], v249 offset:4608
s_waitcnt lgkmcnt(5)
v_cvt_pk_bf16_f32 v20, v128, v129
v_mfma_f32_16x16x32_bf16 a[80:83], v[160:163], v[220:223], a[80:83]
ds_read_b64_tr_b16 v[218:219], v249 offset:6656
v_cvt_pk_bf16_f32 v21, v130, v131
v_accvgpr_read_b32 v136, a36
v_mfma_f32_16x16x32_bf16 a[84:87], v[164:167], v[220:223], a[84:87]
v_accvgpr_read_b32 v137, a37
v_accvgpr_read_b32 v138, a38
v_accvgpr_read_b32 v139, a39
v_mfma_f32_16x16x32_bf16 a[88:91], v[168:171], v[220:223], a[88:91]
v_cvt_pk_bf16_f32 v52, v136, v137
v_cvt_pk_bf16_f32 v53, v138, v139
v_accvgpr_read_b32 v144, a40
v_mfma_f32_16x16x32_bf16 a[92:95], v[172:175], v[220:223], a[92:95]
ds_read_b64_tr_b16 v[220:221], v249 offset:20992
s_waitcnt lgkmcnt(5)
v_accvgpr_read_b32 v145, a41
v_mfma_f32_16x16x32_bf16 a[80:83], v[176:179], v[208:211], a[80:83]
ds_read_b64_tr_b16 v[222:223], v249 offset:23040
v_accvgpr_read_b32 v146, a42
v_accvgpr_read_b32 v147, a43
v_mfma_f32_16x16x32_bf16 a[84:87], v[180:183], v[208:211], a[84:87]
v_cvt_pk_bf16_f32 v84, v144, v145
v_cvt_pk_bf16_f32 v85, v146, v147
v_accvgpr_read_b32 v152, a44
v_mfma_f32_16x16x32_bf16 a[88:91], v[184:187], v[208:211], a[88:91]
v_accvgpr_read_b32 v153, a45
v_accvgpr_read_b32 v154, a46
v_accvgpr_read_b32 v155, a47
v_mfma_f32_16x16x32_bf16 a[92:95], v[188:191], v[208:211], a[92:95]
ds_read_b64_tr_b16 v[208:209], v12 offset:4608
s_waitcnt lgkmcnt(5)
v_cvt_pk_bf16_f32 v116, v152, v153
v_mfma_f32_16x16x32_bf16 a[80:83], v[0:3], v[212:215], a[80:83]
ds_read_b64_tr_b16 v[210:211], v12 offset:6656
v_cvt_pk_bf16_f32 v117, v154, v155
v_accvgpr_read_b32 v132, a48
v_mfma_f32_16x16x32_bf16 a[84:87], v[32:35], v[212:215], a[84:87]
v_accvgpr_read_b32 v133, a49
v_accvgpr_read_b32 v134, a50
v_accvgpr_read_b32 v135, a51
v_mfma_f32_16x16x32_bf16 a[88:91], v[64:67], v[212:215], a[88:91]
v_cvt_pk_bf16_f32 v22, v132, v133
v_cvt_pk_bf16_f32 v23, v134, v135
buffer_store_dwordx4 v[20:23], v248, s[20:23], s40 offen offset:1024 sc1
v_mfma_f32_16x16x32_bf16 a[92:95], v[96:99], v[212:215], a[92:95]
ds_read_b64_tr_b16 v[212:213], v12 offset:20992
s_waitcnt lgkmcnt(5)
ds_write_b128 v253, v[20:23] offset:1024
v_mfma_f32_16x16x32_bf16 a[96:99], v[4:7], v[216:219], a[96:99]
ds_read_b64_tr_b16 v[214:215], v12 offset:23040
v_accvgpr_read_b32 v140, a52
v_accvgpr_read_b32 v141, a53
v_mfma_f32_16x16x32_bf16 a[100:103], v[36:39], v[216:219], a[100:103]
v_accvgpr_read_b32 v142, a54
v_accvgpr_read_b32 v143, a55
v_cvt_pk_bf16_f32 v54, v140, v141
v_mfma_f32_16x16x32_bf16 a[104:107], v[68:71], v[216:219], a[104:107]
v_cvt_pk_bf16_f32 v55, v142, v143
buffer_store_dwordx4 v[52:55], v248, s[20:23], s41 offen offset:1024 sc1
v_accvgpr_read_b32 v148, a56
v_mfma_f32_16x16x32_bf16 a[108:111], v[100:103], v[216:219], a[108:111]
ds_read_b64_tr_b16 v[216:217], v14 offset:4608
s_waitcnt lgkmcnt(5)
v_accvgpr_read_b32 v149, a57
v_mfma_f32_16x16x32_bf16 a[96:99], v[8:11], v[220:223], a[96:99]
ds_read_b64_tr_b16 v[218:219], v14 offset:6656
v_accvgpr_read_b32 v150, a58
v_accvgpr_read_b32 v151, a59
v_mfma_f32_16x16x32_bf16 a[100:103], v[40:43], v[220:223], a[100:103]
v_cvt_pk_bf16_f32 v86, v148, v149
v_cvt_pk_bf16_f32 v87, v150, v151
buffer_store_dwordx4 v[84:87], v248, s[20:23], s42 offen offset:1024 sc1
v_mfma_f32_16x16x32_bf16 a[104:107], v[72:75], v[220:223], a[104:107]
v_accvgpr_read_b32 v156, a60
v_accvgpr_read_b32 v157, a61
v_accvgpr_read_b32 v158, a62
v_mfma_f32_16x16x32_bf16 a[108:111], v[104:107], v[220:223], a[108:111]
ds_read_b64_tr_b16 v[220:221], v250 offset:4608
s_waitcnt lgkmcnt(5)
v_accvgpr_read_b32 v159, a63
v_mfma_f32_16x16x32_bf16 a[96:99], v[160:163], v[208:211], a[96:99]
ds_read_b64_tr_b16 v[222:223], v250 offset:6656
v_cvt_pk_bf16_f32 v118, v156, v157
v_cvt_pk_bf16_f32 v119, v158, v159
v_mfma_f32_16x16x32_bf16 a[100:103], v[164:167], v[208:211], a[100:103]
buffer_store_dwordx4 v[116:119], v248, s[20:23], s43 offen offset:1024 sc1
v_accvgpr_read_b32 v128, a64
v_accvgpr_read_b32 v129, a65
v_mfma_f32_16x16x32_bf16 a[104:107], v[168:171], v[208:211], a[104:107]
v_accvgpr_read_b32 v130, a66
v_accvgpr_read_b32 v131, a67
v_cvt_pk_bf16_f32 v24, v128, v129
v_mfma_f32_16x16x32_bf16 a[108:111], v[172:175], v[208:211], a[108:111]
ds_read_b64_tr_b16 v[208:209], v250 offset:20992
s_waitcnt lgkmcnt(5)
v_cvt_pk_bf16_f32 v25, v130, v131
v_mfma_f32_16x16x32_bf16 a[96:99], v[176:179], v[212:215], a[96:99]
ds_read_b64_tr_b16 v[210:211], v250 offset:23040
v_accvgpr_read_b32 v136, a68
v_accvgpr_read_b32 v137, a69
v_mfma_f32_16x16x32_bf16 a[100:103], v[180:183], v[212:215], a[100:103]
v_accvgpr_read_b32 v138, a70
v_accvgpr_read_b32 v139, a71
v_cvt_pk_bf16_f32 v56, v136, v137
v_mfma_f32_16x16x32_bf16 a[104:107], v[184:187], v[212:215], a[104:107]
v_cvt_pk_bf16_f32 v57, v138, v139
v_accvgpr_read_b32 v144, a72
v_accvgpr_read_b32 v145, a73
v_mfma_f32_16x16x32_bf16 a[108:111], v[188:191], v[212:215], a[108:111]
ds_read_b64_tr_b16 v[212:213], v13 offset:4608
s_waitcnt lgkmcnt(5)
v_accvgpr_read_b32 v146, a74
v_mfma_f32_16x16x32_bf16 a[96:99], v[0:3], v[216:219], a[96:99]
ds_read_b64_tr_b16 v[214:215], v13 offset:6656
v_accvgpr_read_b32 v147, a75
v_cvt_pk_bf16_f32 v88, v144, v145
v_mfma_f32_16x16x32_bf16 a[100:103], v[32:35], v[216:219], a[100:103]
v_cvt_pk_bf16_f32 v89, v146, v147
v_accvgpr_read_b32 v152, a76
v_accvgpr_read_b32 v153, a77
v_mfma_f32_16x16x32_bf16 a[104:107], v[64:67], v[216:219], a[104:107]
v_accvgpr_read_b32 v154, a78
v_accvgpr_read_b32 v155, a79
v_cvt_pk_bf16_f32 v120, v152, v153
v_mfma_f32_16x16x32_bf16 a[108:111], v[96:99], v[216:219], a[108:111]
ds_read_b64_tr_b16 v[216:217], v13 offset:20992
s_waitcnt lgkmcnt(5)
v_cvt_pk_bf16_f32 v121, v154, v155
v_mfma_f32_16x16x32_bf16 a[112:115], v[4:7], v[220:223], a[112:115]
ds_read_b64_tr_b16 v[218:219], v13 offset:23040
v_accvgpr_read_b32 v132, a80
v_accvgpr_read_b32 v133, a81
v_mfma_f32_16x16x32_bf16 a[116:119], v[36:39], v[220:223], a[116:119]
v_accvgpr_read_b32 v134, a82
v_accvgpr_read_b32 v135, a83
v_cvt_pk_bf16_f32 v26, v132, v133
v_mfma_f32_16x16x32_bf16 a[120:123], v[68:71], v[220:223], a[120:123]
v_cvt_pk_bf16_f32 v27, v134, v135
buffer_store_dwordx4 v[24:27], v248, s[20:23], s40 offen offset:2048 sc1
ds_write_b128 v253, v[24:27] offset:2048
v_mfma_f32_16x16x32_bf16 a[124:127], v[100:103], v[220:223], a[124:127]
ds_read_b64_tr_b16 v[220:221], v15 offset:4608
s_waitcnt lgkmcnt(5)
v_accvgpr_read_b32 v140, a84
v_mfma_f32_16x16x32_bf16 a[112:115], v[8:11], v[208:211], a[112:115]
ds_read_b64_tr_b16 v[222:223], v15 offset:6656
v_accvgpr_read_b32 v141, a85
v_accvgpr_read_b32 v142, a86
v_mfma_f32_16x16x32_bf16 a[116:119], v[40:43], v[208:211], a[116:119]
v_accvgpr_read_b32 v143, a87
v_cvt_pk_bf16_f32 v58, v140, v141
v_cvt_pk_bf16_f32 v59, v142, v143
v_mfma_f32_16x16x32_bf16 a[120:123], v[72:75], v[208:211], a[120:123]
buffer_store_dwordx4 v[56:59], v248, s[20:23], s41 offen offset:2048 sc1
v_accvgpr_read_b32 v148, a88
v_accvgpr_read_b32 v149, a89
v_mfma_f32_16x16x32_bf16 a[124:127], v[104:107], v[208:211], a[124:127]
ds_read_b64_tr_b16 v[208:209], v249 offset:8192
s_waitcnt lgkmcnt(5)
v_accvgpr_read_b32 v150, a90
v_mfma_f32_16x16x32_bf16 a[112:115], v[160:163], v[212:215], a[112:115]
ds_read_b64_tr_b16 v[210:211], v249 offset:10240
v_accvgpr_read_b32 v151, a91
v_cvt_pk_bf16_f32 v90, v148, v149
v_mfma_f32_16x16x32_bf16 a[116:119], v[164:167], v[212:215], a[116:119]
v_cvt_pk_bf16_f32 v91, v150, v151
buffer_store_dwordx4 v[88:91], v248, s[20:23], s42 offen offset:2048 sc1
v_accvgpr_read_b32 v156, a92
v_mfma_f32_16x16x32_bf16 a[120:123], v[168:171], v[212:215], a[120:123]
v_accvgpr_read_b32 v157, a93
v_accvgpr_read_b32 v158, a94
v_accvgpr_read_b32 v159, a95
v_mfma_f32_16x16x32_bf16 a[124:127], v[172:175], v[212:215], a[124:127]
ds_read_b64_tr_b16 v[212:213], v249 offset:24576
s_waitcnt lgkmcnt(5)
v_cvt_pk_bf16_f32 v122, v156, v157
v_mfma_f32_16x16x32_bf16 a[112:115], v[176:179], v[216:219], a[112:115]
ds_read_b64_tr_b16 v[214:215], v249 offset:26624
v_cvt_pk_bf16_f32 v123, v158, v159
buffer_store_dwordx4 v[120:123], v248, s[20:23], s43 offen offset:2048 sc1
v_mfma_f32_16x16x32_bf16 a[116:119], v[180:183], v[216:219], a[116:119]
v_accvgpr_read_b32 v128, a96
v_accvgpr_read_b32 v129, a97
v_mfma_f32_16x16x32_bf16 a[120:123], v[184:187], v[216:219], a[120:123]
v_accvgpr_read_b32 v130, a98
v_accvgpr_read_b32 v131, a99
v_mfma_f32_16x16x32_bf16 a[124:127], v[188:191], v[216:219], a[124:127]
ds_read_b64_tr_b16 v[216:217], v12 offset:8192
s_waitcnt lgkmcnt(5)
v_mfma_f32_16x16x32_bf16 a[112:115], v[0:3], v[220:223], a[112:115]
ds_read_b64_tr_b16 v[218:219], v12 offset:10240
v_cvt_pk_bf16_f32 v28, v128, v129
v_mfma_f32_16x16x32_bf16 a[116:119], v[32:35], v[220:223], a[116:119]
v_cvt_pk_bf16_f32 v29, v130, v131
v_accvgpr_read_b32 v136, a100
v_mfma_f32_16x16x32_bf16 a[120:123], v[64:67], v[220:223], a[120:123]
v_accvgpr_read_b32 v137, a101
v_accvgpr_read_b32 v138, a102
v_mfma_f32_16x16x32_bf16 a[124:127], v[96:99], v[220:223], a[124:127]
ds_read_b64_tr_b16 v[220:221], v12 offset:24576
s_waitcnt lgkmcnt(5)
v_mfma_f32_16x16x32_bf16 a[128:131], v[4:7], v[208:211], a[128:131]
ds_read_b64_tr_b16 v[222:223], v12 offset:26624
v_accvgpr_read_b32 v139, a103
v_mfma_f32_16x16x32_bf16 a[132:135], v[36:39], v[208:211], a[132:135]
v_cvt_pk_bf16_f32 v60, v136, v137
v_cvt_pk_bf16_f32 v61, v138, v139
v_mfma_f32_16x16x32_bf16 a[136:139], v[68:71], v[208:211], a[136:139]
v_accvgpr_read_b32 v144, a104
v_accvgpr_read_b32 v145, a105
v_mfma_f32_16x16x32_bf16 a[140:143], v[100:103], v[208:211], a[140:143]
ds_read_b64_tr_b16 v[208:209], v14 offset:8192
s_waitcnt lgkmcnt(5)
v_mfma_f32_16x16x32_bf16 a[128:131], v[8:11], v[212:215], a[128:131]
ds_read_b64_tr_b16 v[210:211], v14 offset:10240
v_accvgpr_read_b32 v146, a106
v_mfma_f32_16x16x32_bf16 a[132:135], v[40:43], v[212:215], a[132:135]
v_accvgpr_read_b32 v147, a107
v_cvt_pk_bf16_f32 v92, v144, v145
v_mfma_f32_16x16x32_bf16 a[136:139], v[72:75], v[212:215], a[136:139]
v_cvt_pk_bf16_f32 v93, v146, v147
v_accvgpr_read_b32 v152, a108
v_mfma_f32_16x16x32_bf16 a[140:143], v[104:107], v[212:215], a[140:143]
ds_read_b64_tr_b16 v[212:213], v250 offset:8192
s_waitcnt lgkmcnt(5)
v_mfma_f32_16x16x32_bf16 a[128:131], v[160:163], v[216:219], a[128:131]
ds_read_b64_tr_b16 v[214:215], v250 offset:10240
v_accvgpr_read_b32 v153, a109
v_mfma_f32_16x16x32_bf16 a[132:135], v[164:167], v[216:219], a[132:135]
v_accvgpr_read_b32 v154, a110
v_accvgpr_read_b32 v155, a111
v_mfma_f32_16x16x32_bf16 a[136:139], v[168:171], v[216:219], a[136:139]
v_cvt_pk_bf16_f32 v124, v152, v153
v_cvt_pk_bf16_f32 v125, v154, v155
v_mfma_f32_16x16x32_bf16 a[140:143], v[172:175], v[216:219], a[140:143]
ds_read_b64_tr_b16 v[216:217], v250 offset:24576
s_waitcnt lgkmcnt(5)
v_mfma_f32_16x16x32_bf16 a[128:131], v[176:179], v[220:223], a[128:131]
ds_read_b64_tr_b16 v[218:219], v250 offset:26624
v_accvgpr_read_b32 v132, a112
v_mfma_f32_16x16x32_bf16 a[132:135], v[180:183], v[220:223], a[132:135]
v_accvgpr_read_b32 v133, a113
v_accvgpr_read_b32 v134, a114
v_mfma_f32_16x16x32_bf16 a[136:139], v[184:187], v[220:223], a[136:139]
v_accvgpr_read_b32 v135, a115
v_cvt_pk_bf16_f32 v30, v132, v133
v_mfma_f32_16x16x32_bf16 a[140:143], v[188:191], v[220:223], a[140:143]
ds_read_b64_tr_b16 v[220:221], v13 offset:8192
s_waitcnt lgkmcnt(5)
v_mfma_f32_16x16x32_bf16 a[128:131], v[0:3], v[208:211], a[128:131]
ds_read_b64_tr_b16 v[222:223], v13 offset:10240
v_cvt_pk_bf16_f32 v31, v134, v135
v_mfma_f32_16x16x32_bf16 a[132:135], v[32:35], v[208:211], a[132:135]
buffer_store_dwordx4 v[28:31], v248, s[20:23], s40 offen offset:3072 sc1
ds_write_b128 v253, v[28:31] offset:3072
v_mfma_f32_16x16x32_bf16 a[136:139], v[64:67], v[208:211], a[136:139]
v_accvgpr_read_b32 v140, a116
v_accvgpr_read_b32 v141, a117
v_mfma_f32_16x16x32_bf16 a[140:143], v[96:99], v[208:211], a[140:143]
ds_read_b64_tr_b16 v[208:209], v13 offset:24576
s_waitcnt lgkmcnt(5)
v_mfma_f32_16x16x32_bf16 a[144:147], v[4:7], v[212:215], a[144:147]
ds_read_b64_tr_b16 v[210:211], v13 offset:26624
v_accvgpr_read_b32 v142, a118
v_mfma_f32_16x16x32_bf16 a[148:151], v[36:39], v[212:215], a[148:151]
v_accvgpr_read_b32 v143, a119
v_cvt_pk_bf16_f32 v62, v140, v141
v_mfma_f32_16x16x32_bf16 a[152:155], v[68:71], v[212:215], a[152:155]
v_cvt_pk_bf16_f32 v63, v142, v143
buffer_store_dwordx4 v[60:63], v248, s[20:23], s41 offen offset:3072 sc1
v_mfma_f32_16x16x32_bf16 a[156:159], v[100:103], v[212:215], a[156:159]
ds_read_b64_tr_b16 v[212:213], v15 offset:8192
s_waitcnt lgkmcnt(5)
v_mfma_f32_16x16x32_bf16 a[144:147], v[8:11], v[216:219], a[144:147]
ds_read_b64_tr_b16 v[214:215], v15 offset:10240
v_accvgpr_read_b32 v148, a120
v_mfma_f32_16x16x32_bf16 a[148:151], v[40:43], v[216:219], a[148:151]
v_accvgpr_read_b32 v149, a121
v_accvgpr_read_b32 v150, a122
v_mfma_f32_16x16x32_bf16 a[152:155], v[72:75], v[216:219], a[152:155]
v_accvgpr_read_b32 v151, a123
v_cvt_pk_bf16_f32 v94, v148, v149
v_mfma_f32_16x16x32_bf16 a[156:159], v[104:107], v[216:219], a[156:159]
ds_read_b64_tr_b16 v[216:217], v249 offset:8704
s_waitcnt lgkmcnt(5)
v_mfma_f32_16x16x32_bf16 a[144:147], v[160:163], v[220:223], a[144:147]
ds_read_b64_tr_b16 v[218:219], v249 offset:10752
v_cvt_pk_bf16_f32 v95, v150, v151
v_mfma_f32_16x16x32_bf16 a[148:151], v[164:167], v[220:223], a[148:151]
buffer_store_dwordx4 v[92:95], v248, s[20:23], s42 offen offset:3072 sc1
v_accvgpr_read_b32 v156, a124
v_mfma_f32_16x16x32_bf16 a[152:155], v[168:171], v[220:223], a[152:155]
v_accvgpr_read_b32 v157, a125
v_accvgpr_read_b32 v158, a126
v_mfma_f32_16x16x32_bf16 a[156:159], v[172:175], v[220:223], a[156:159]
ds_read_b64_tr_b16 v[220:221], v249 offset:25088
s_waitcnt lgkmcnt(5)
v_mfma_f32_16x16x32_bf16 a[144:147], v[176:179], v[208:211], a[144:147]
ds_read_b64_tr_b16 v[222:223], v249 offset:27136
v_accvgpr_read_b32 v159, a127
v_mfma_f32_16x16x32_bf16 a[148:151], v[180:183], v[208:211], a[148:151]
v_cvt_pk_bf16_f32 v126, v156, v157
v_cvt_pk_bf16_f32 v127, v158, v159
v_mfma_f32_16x16x32_bf16 a[152:155], v[184:187], v[208:211], a[152:155]
buffer_store_dwordx4 v[124:127], v248, s[20:23], s43 offen offset:3072 sc1
v_accvgpr_read_b32 v128, a128
v_mfma_f32_16x16x32_bf16 a[156:159], v[188:191], v[208:211], a[156:159]
ds_read_b64_tr_b16 v[208:209], v12 offset:8704
s_waitcnt lgkmcnt(5)
v_mfma_f32_16x16x32_bf16 a[144:147], v[0:3], v[212:215], a[144:147]
ds_read_b64_tr_b16 v[210:211], v12 offset:10752
v_accvgpr_read_b32 v129, a129
v_mfma_f32_16x16x32_bf16 a[148:151], v[32:35], v[212:215], a[148:151]
v_accvgpr_read_b32 v130, a130
v_accvgpr_read_b32 v131, a131
v_mfma_f32_16x16x32_bf16 a[152:155], v[64:67], v[212:215], a[152:155]
v_cvt_pk_bf16_f32 v16, v128, v129
v_cvt_pk_bf16_f32 v17, v130, v131
v_mfma_f32_16x16x32_bf16 a[156:159], v[96:99], v[212:215], a[156:159]
ds_read_b64_tr_b16 v[212:213], v12 offset:25088
s_waitcnt lgkmcnt(5)
v_mfma_f32_16x16x32_bf16 a[160:163], v[4:7], v[216:219], a[160:163]
ds_read_b64_tr_b16 v[214:215], v12 offset:27136
v_accvgpr_read_b32 v136, a132
v_mfma_f32_16x16x32_bf16 a[164:167], v[36:39], v[216:219], a[164:167]
v_accvgpr_read_b32 v137, a133
v_accvgpr_read_b32 v138, a134
v_mfma_f32_16x16x32_bf16 a[168:171], v[68:71], v[216:219], a[168:171]
v_accvgpr_read_b32 v139, a135
v_cvt_pk_bf16_f32 v48, v136, v137
v_mfma_f32_16x16x32_bf16 a[172:175], v[100:103], v[216:219], a[172:175]
ds_read_b64_tr_b16 v[216:217], v14 offset:8704
s_waitcnt lgkmcnt(5)
v_mfma_f32_16x16x32_bf16 a[160:163], v[8:11], v[220:223], a[160:163]
ds_read_b64_tr_b16 v[218:219], v14 offset:10752
v_cvt_pk_bf16_f32 v49, v138, v139
v_mfma_f32_16x16x32_bf16 a[164:167], v[40:43], v[220:223], a[164:167]
v_accvgpr_read_b32 v144, a136
v_accvgpr_read_b32 v145, a137
v_mfma_f32_16x16x32_bf16 a[168:171], v[72:75], v[220:223], a[168:171]
v_accvgpr_read_b32 v146, a138
v_accvgpr_read_b32 v147, a139
v_mfma_f32_16x16x32_bf16 a[172:175], v[104:107], v[220:223], a[172:175]
ds_read_b64_tr_b16 v[220:221], v250 offset:8704
s_waitcnt lgkmcnt(5)
v_mfma_f32_16x16x32_bf16 a[160:163], v[160:163], v[208:211], a[160:163]
ds_read_b64_tr_b16 v[222:223], v250 offset:10752
v_cvt_pk_bf16_f32 v80, v144, v145
v_mfma_f32_16x16x32_bf16 a[164:167], v[164:167], v[208:211], a[164:167]
v_cvt_pk_bf16_f32 v81, v146, v147
v_accvgpr_read_b32 v152, a140
v_mfma_f32_16x16x32_bf16 a[168:171], v[168:171], v[208:211], a[168:171]
v_accvgpr_read_b32 v153, a141
v_accvgpr_read_b32 v154, a142
v_mfma_f32_16x16x32_bf16 a[172:175], v[172:175], v[208:211], a[172:175]
ds_read_b64_tr_b16 v[208:209], v250 offset:25088
s_waitcnt lgkmcnt(5)
v_mfma_f32_16x16x32_bf16 a[160:163], v[176:179], v[212:215], a[160:163]
ds_read_b64_tr_b16 v[210:211], v250 offset:27136
v_accvgpr_read_b32 v155, a143
v_mfma_f32_16x16x32_bf16 a[164:167], v[180:183], v[212:215], a[164:167]
v_cvt_pk_bf16_f32 v112, v152, v153
v_cvt_pk_bf16_f32 v113, v154, v155
v_mfma_f32_16x16x32_bf16 a[168:171], v[184:187], v[212:215], a[168:171]
v_accvgpr_read_b32 v132, a144
v_accvgpr_read_b32 v133, a145
v_mfma_f32_16x16x32_bf16 a[172:175], v[188:191], v[212:215], a[172:175]
ds_read_b64_tr_b16 v[212:213], v13 offset:8704
s_waitcnt lgkmcnt(5)
v_mfma_f32_16x16x32_bf16 a[160:163], v[0:3], v[216:219], a[160:163]
ds_read_b64_tr_b16 v[214:215], v13 offset:10752
v_accvgpr_read_b32 v134, a146
v_mfma_f32_16x16x32_bf16 a[164:167], v[32:35], v[216:219], a[164:167]
v_accvgpr_read_b32 v135, a147
v_cvt_pk_bf16_f32 v18, v132, v133
v_mfma_f32_16x16x32_bf16 a[168:171], v[64:67], v[216:219], a[168:171]
v_cvt_pk_bf16_f32 v19, v134, v135
buffer_store_dwordx4 v[16:19], v248, s[20:23], s44 offen offset:0 sc1
v_mfma_f32_16x16x32_bf16 a[172:175], v[96:99], v[216:219], a[172:175]
ds_read_b64_tr_b16 v[216:217], v13 offset:25088
s_waitcnt lgkmcnt(5)
v_mfma_f32_16x16x32_bf16 a[176:179], v[4:7], v[220:223], a[176:179]
ds_read_b64_tr_b16 v[218:219], v13 offset:27136
ds_write_b128 v253, v[16:19] offset:4096
v_mfma_f32_16x16x32_bf16 a[180:183], v[36:39], v[220:223], a[180:183]
v_accvgpr_read_b32 v140, a148
v_accvgpr_read_b32 v141, a149
v_mfma_f32_16x16x32_bf16 a[184:187], v[68:71], v[220:223], a[184:187]
v_accvgpr_read_b32 v142, a150
v_accvgpr_read_b32 v143, a151
v_mfma_f32_16x16x32_bf16 a[188:191], v[100:103], v[220:223], a[188:191]
ds_read_b64_tr_b16 v[220:221], v15 offset:8704
s_waitcnt lgkmcnt(5)
v_mfma_f32_16x16x32_bf16 a[176:179], v[8:11], v[208:211], a[176:179]
ds_read_b64_tr_b16 v[222:223], v15 offset:10752
v_cvt_pk_bf16_f32 v50, v140, v141
v_mfma_f32_16x16x32_bf16 a[180:183], v[40:43], v[208:211], a[180:183]
v_cvt_pk_bf16_f32 v51, v142, v143
buffer_store_dwordx4 v[48:51], v248, s[20:23], s45 offen offset:0 sc1
v_mfma_f32_16x16x32_bf16 a[184:187], v[72:75], v[208:211], a[184:187]
v_accvgpr_read_b32 v148, a152
v_accvgpr_read_b32 v149, a153
v_mfma_f32_16x16x32_bf16 a[188:191], v[104:107], v[208:211], a[188:191]
ds_read_b64_tr_b16 v[208:209], v249 offset:12288
s_waitcnt lgkmcnt(5)
v_mfma_f32_16x16x32_bf16 a[176:179], v[160:163], v[212:215], a[176:179]
ds_read_b64_tr_b16 v[210:211], v249 offset:14336
v_accvgpr_read_b32 v150, a154
v_mfma_f32_16x16x32_bf16 a[180:183], v[164:167], v[212:215], a[180:183]
v_accvgpr_read_b32 v151, a155
v_cvt_pk_bf16_f32 v82, v148, v149
v_mfma_f32_16x16x32_bf16 a[184:187], v[168:171], v[212:215], a[184:187]
v_cvt_pk_bf16_f32 v83, v150, v151
buffer_store_dwordx4 v[80:83], v248, s[20:23], s46 offen offset:0 sc1
v_mfma_f32_16x16x32_bf16 a[188:191], v[172:175], v[212:215], a[188:191]
ds_read_b64_tr_b16 v[212:213], v249 offset:28672
s_waitcnt lgkmcnt(5)
v_mfma_f32_16x16x32_bf16 a[176:179], v[176:179], v[216:219], a[176:179]
ds_read_b64_tr_b16 v[214:215], v249 offset:30720
v_accvgpr_read_b32 v156, a156
v_mfma_f32_16x16x32_bf16 a[180:183], v[180:183], v[216:219], a[180:183]
v_accvgpr_read_b32 v157, a157
v_accvgpr_read_b32 v158, a158
v_mfma_f32_16x16x32_bf16 a[184:187], v[184:187], v[216:219], a[184:187]
v_accvgpr_read_b32 v159, a159
v_cvt_pk_bf16_f32 v114, v156, v157
v_mfma_f32_16x16x32_bf16 a[188:191], v[188:191], v[216:219], a[188:191]
ds_read_b64_tr_b16 v[216:217], v12 offset:12288
s_waitcnt lgkmcnt(5)
v_mfma_f32_16x16x32_bf16 a[176:179], v[0:3], v[220:223], a[176:179]
ds_read_b64_tr_b16 v[218:219], v12 offset:14336
v_cvt_pk_bf16_f32 v115, v158, v159
v_mfma_f32_16x16x32_bf16 a[180:183], v[32:35], v[220:223], a[180:183]
buffer_store_dwordx4 v[112:115], v248, s[20:23], s47 offen offset:0 sc1
v_accvgpr_read_b32 v128, a160
v_mfma_f32_16x16x32_bf16 a[184:187], v[64:67], v[220:223], a[184:187]
v_accvgpr_read_b32 v129, a161
v_accvgpr_read_b32 v130, a162
v_mfma_f32_16x16x32_bf16 a[188:191], v[96:99], v[220:223], a[188:191]
ds_read_b64_tr_b16 v[220:221], v12 offset:28672
s_waitcnt lgkmcnt(5)
v_mfma_f32_16x16x32_bf16 a[192:195], v[4:7], v[208:211], a[192:195]
ds_read_b64_tr_b16 v[222:223], v12 offset:30720
v_accvgpr_read_b32 v131, a163
v_mfma_f32_16x16x32_bf16 a[196:199], v[36:39], v[208:211], a[196:199]
v_cvt_pk_bf16_f32 v20, v128, v129
v_cvt_pk_bf16_f32 v21, v130, v131
v_mfma_f32_16x16x32_bf16 a[200:203], v[68:71], v[208:211], a[200:203]
v_accvgpr_read_b32 v136, a164
v_accvgpr_read_b32 v137, a165
v_mfma_f32_16x16x32_bf16 a[204:207], v[100:103], v[208:211], a[204:207]
ds_read_b64_tr_b16 v[208:209], v14 offset:12288
s_waitcnt lgkmcnt(5)
v_mfma_f32_16x16x32_bf16 a[192:195], v[8:11], v[212:215], a[192:195]
ds_read_b64_tr_b16 v[210:211], v14 offset:14336
v_accvgpr_read_b32 v138, a166
v_mfma_f32_16x16x32_bf16 a[196:199], v[40:43], v[212:215], a[196:199]
v_accvgpr_read_b32 v139, a167
v_cvt_pk_bf16_f32 v52, v136, v137
v_mfma_f32_16x16x32_bf16 a[200:203], v[72:75], v[212:215], a[200:203]
v_cvt_pk_bf16_f32 v53, v138, v139
v_accvgpr_read_b32 v144, a168
v_mfma_f32_16x16x32_bf16 a[204:207], v[104:107], v[212:215], a[204:207]
ds_read_b64_tr_b16 v[212:213], v250 offset:12288
s_waitcnt lgkmcnt(5)
v_mfma_f32_16x16x32_bf16 a[192:195], v[160:163], v[216:219], a[192:195]
ds_read_b64_tr_b16 v[214:215], v250 offset:14336
v_accvgpr_read_b32 v145, a169
v_mfma_f32_16x16x32_bf16 a[196:199], v[164:167], v[216:219], a[196:199]
v_accvgpr_read_b32 v146, a170
v_accvgpr_read_b32 v147, a171
v_mfma_f32_16x16x32_bf16 a[200:203], v[168:171], v[216:219], a[200:203]
v_cvt_pk_bf16_f32 v84, v144, v145
v_cvt_pk_bf16_f32 v85, v146, v147
v_mfma_f32_16x16x32_bf16 a[204:207], v[172:175], v[216:219], a[204:207]
ds_read_b64_tr_b16 v[216:217], v250 offset:28672
s_waitcnt lgkmcnt(5)
v_mfma_f32_16x16x32_bf16 a[192:195], v[176:179], v[220:223], a[192:195]
ds_read_b64_tr_b16 v[218:219], v250 offset:30720
v_accvgpr_read_b32 v152, a172
v_mfma_f32_16x16x32_bf16 a[196:199], v[180:183], v[220:223], a[196:199]
v_accvgpr_read_b32 v153, a173
v_accvgpr_read_b32 v154, a174
v_mfma_f32_16x16x32_bf16 a[200:203], v[184:187], v[220:223], a[200:203]
v_accvgpr_read_b32 v155, a175
v_cvt_pk_bf16_f32 v116, v152, v153
v_mfma_f32_16x16x32_bf16 a[204:207], v[188:191], v[220:223], a[204:207]
ds_read_b64_tr_b16 v[220:221], v13 offset:12288
s_waitcnt lgkmcnt(5)
v_mfma_f32_16x16x32_bf16 a[192:195], v[0:3], v[208:211], a[192:195]
ds_read_b64_tr_b16 v[222:223], v13 offset:14336
v_cvt_pk_bf16_f32 v117, v154, v155
v_mfma_f32_16x16x32_bf16 a[196:199], v[32:35], v[208:211], a[196:199]
v_accvgpr_read_b32 v132, a176
v_accvgpr_read_b32 v133, a177
v_mfma_f32_16x16x32_bf16 a[200:203], v[64:67], v[208:211], a[200:203]
v_accvgpr_read_b32 v134, a178
v_accvgpr_read_b32 v135, a179
v_mfma_f32_16x16x32_bf16 a[204:207], v[96:99], v[208:211], a[204:207]
ds_read_b64_tr_b16 v[208:209], v13 offset:28672
s_waitcnt lgkmcnt(5)
v_mfma_f32_16x16x32_bf16 a[208:211], v[4:7], v[212:215], a[208:211]
ds_read_b64_tr_b16 v[210:211], v13 offset:30720
v_cvt_pk_bf16_f32 v22, v132, v133
v_mfma_f32_16x16x32_bf16 a[212:215], v[36:39], v[212:215], a[212:215]
v_cvt_pk_bf16_f32 v23, v134, v135
buffer_store_dwordx4 v[20:23], v248, s[20:23], s44 offen offset:1024 sc1
v_mfma_f32_16x16x32_bf16 a[216:219], v[68:71], v[212:215], a[216:219]
ds_write_b128 v253, v[20:23] offset:5120
v_accvgpr_read_b32 v140, a180
v_mfma_f32_16x16x32_bf16 a[220:223], v[100:103], v[212:215], a[220:223]
ds_read_b64_tr_b16 v[212:213], v15 offset:12288
s_waitcnt lgkmcnt(5)
v_mfma_f32_16x16x32_bf16 a[208:211], v[8:11], v[216:219], a[208:211]
ds_read_b64_tr_b16 v[214:215], v15 offset:14336
v_accvgpr_read_b32 v141, a181
v_mfma_f32_16x16x32_bf16 a[212:215], v[40:43], v[216:219], a[212:215]
v_accvgpr_read_b32 v142, a182
v_accvgpr_read_b32 v143, a183
v_mfma_f32_16x16x32_bf16 a[216:219], v[72:75], v[216:219], a[216:219]
v_cvt_pk_bf16_f32 v54, v140, v141
v_cvt_pk_bf16_f32 v55, v142, v143
v_mfma_f32_16x16x32_bf16 a[220:223], v[104:107], v[216:219], a[220:223]
ds_read_b64_tr_b16 v[216:217], v249 offset:12800
s_waitcnt lgkmcnt(5)
v_mfma_f32_16x16x32_bf16 a[208:211], v[160:163], v[220:223], a[208:211]
ds_read_b64_tr_b16 v[218:219], v249 offset:14848
buffer_store_dwordx4 v[52:55], v248, s[20:23], s45 offen offset:1024 sc1
v_mfma_f32_16x16x32_bf16 a[212:215], v[164:167], v[220:223], a[212:215]
v_accvgpr_read_b32 v148, a184
v_accvgpr_read_b32 v149, a185
v_mfma_f32_16x16x32_bf16 a[216:219], v[168:171], v[220:223], a[216:219]
v_accvgpr_read_b32 v150, a186
v_accvgpr_read_b32 v151, a187
v_mfma_f32_16x16x32_bf16 a[220:223], v[172:175], v[220:223], a[220:223]
ds_read_b64_tr_b16 v[220:221], v249 offset:29184
s_waitcnt lgkmcnt(5)
v_mfma_f32_16x16x32_bf16 a[208:211], v[176:179], v[208:211], a[208:211]
ds_read_b64_tr_b16 v[222:223], v249 offset:31232
v_cvt_pk_bf16_f32 v86, v148, v149
v_mfma_f32_16x16x32_bf16 a[212:215], v[180:183], v[208:211], a[212:215]
v_cvt_pk_bf16_f32 v87, v150, v151
buffer_store_dwordx4 v[84:87], v248, s[20:23], s46 offen offset:1024 sc1
v_mfma_f32_16x16x32_bf16 a[216:219], v[184:187], v[208:211], a[216:219]
v_accvgpr_read_b32 v156, a188
v_accvgpr_read_b32 v157, a189
v_mfma_f32_16x16x32_bf16 a[220:223], v[188:191], v[208:211], a[220:223]
ds_read_b64_tr_b16 v[208:209], v12 offset:12800
s_waitcnt lgkmcnt(5)
v_mfma_f32_16x16x32_bf16 a[208:211], v[0:3], v[212:215], a[208:211]
ds_read_b64_tr_b16 v[210:211], v12 offset:14848
v_accvgpr_read_b32 v158, a190
v_mfma_f32_16x16x32_bf16 a[212:215], v[32:35], v[212:215], a[212:215]
v_accvgpr_read_b32 v159, a191
v_cvt_pk_bf16_f32 v118, v156, v157
v_mfma_f32_16x16x32_bf16 a[216:219], v[64:67], v[212:215], a[216:219]
v_cvt_pk_bf16_f32 v119, v158, v159
buffer_store_dwordx4 v[116:119], v248, s[20:23], s47 offen offset:1024 sc1
v_mfma_f32_16x16x32_bf16 a[220:223], v[96:99], v[212:215], a[220:223]
ds_read_b64_tr_b16 v[212:213], v12 offset:29184
s_waitcnt lgkmcnt(5)
v_mfma_f32_16x16x32_bf16 a[224:227], v[4:7], v[216:219], a[224:227]
ds_read_b64_tr_b16 v[214:215], v12 offset:31232
v_accvgpr_read_b32 v128, a192
v_mfma_f32_16x16x32_bf16 a[228:231], v[36:39], v[216:219], a[228:231]
v_accvgpr_read_b32 v129, a193
v_accvgpr_read_b32 v130, a194
v_mfma_f32_16x16x32_bf16 a[232:235], v[68:71], v[216:219], a[232:235]
v_accvgpr_read_b32 v131, a195
v_cvt_pk_bf16_f32 v24, v128, v129
v_mfma_f32_16x16x32_bf16 a[236:239], v[100:103], v[216:219], a[236:239]
ds_read_b64_tr_b16 v[216:217], v14 offset:12800
s_waitcnt lgkmcnt(5)
v_mfma_f32_16x16x32_bf16 a[224:227], v[8:11], v[220:223], a[224:227]
ds_read_b64_tr_b16 v[218:219], v14 offset:14848
v_cvt_pk_bf16_f32 v25, v130, v131
v_mfma_f32_16x16x32_bf16 a[228:231], v[40:43], v[220:223], a[228:231]
v_accvgpr_read_b32 v136, a196
v_accvgpr_read_b32 v137, a197
v_mfma_f32_16x16x32_bf16 a[232:235], v[72:75], v[220:223], a[232:235]
v_accvgpr_read_b32 v138, a198
v_accvgpr_read_b32 v139, a199
v_mfma_f32_16x16x32_bf16 a[236:239], v[104:107], v[220:223], a[236:239]
ds_read_b64_tr_b16 v[220:221], v250 offset:12800
s_waitcnt lgkmcnt(5)
v_mfma_f32_16x16x32_bf16 a[224:227], v[160:163], v[208:211], a[224:227]
ds_read_b64_tr_b16 v[222:223], v250 offset:14848
v_cvt_pk_bf16_f32 v56, v136, v137
v_mfma_f32_16x16x32_bf16 a[228:231], v[164:167], v[208:211], a[228:231]
v_cvt_pk_bf16_f32 v57, v138, v139
v_accvgpr_read_b32 v144, a200
v_mfma_f32_16x16x32_bf16 a[232:235], v[168:171], v[208:211], a[232:235]
v_accvgpr_read_b32 v145, a201
v_accvgpr_read_b32 v146, a202
v_mfma_f32_16x16x32_bf16 a[236:239], v[172:175], v[208:211], a[236:239]
ds_read_b64_tr_b16 v[208:209], v250 offset:29184
s_waitcnt lgkmcnt(5)
v_mfma_f32_16x16x32_bf16 a[224:227], v[176:179], v[212:215], a[224:227]
ds_read_b64_tr_b16 v[210:211], v250 offset:31232
v_accvgpr_read_b32 v147, a203
v_mfma_f32_16x16x32_bf16 a[228:231], v[180:183], v[212:215], a[228:231]
v_cvt_pk_bf16_f32 v88, v144, v145
v_cvt_pk_bf16_f32 v89, v146, v147
v_mfma_f32_16x16x32_bf16 a[232:235], v[184:187], v[212:215], a[232:235]
v_accvgpr_read_b32 v152, a204
v_accvgpr_read_b32 v153, a205
v_mfma_f32_16x16x32_bf16 a[236:239], v[188:191], v[212:215], a[236:239]
ds_read_b64_tr_b16 v[212:213], v13 offset:12800
s_waitcnt lgkmcnt(5)
v_mfma_f32_16x16x32_bf16 a[224:227], v[0:3], v[216:219], a[224:227]
ds_read_b64_tr_b16 v[214:215], v13 offset:14848
v_accvgpr_read_b32 v154, a206
v_mfma_f32_16x16x32_bf16 a[228:231], v[32:35], v[216:219], a[228:231]
v_accvgpr_read_b32 v155, a207
v_cvt_pk_bf16_f32 v120, v152, v153
v_mfma_f32_16x16x32_bf16 a[232:235], v[64:67], v[216:219], a[232:235]
v_cvt_pk_bf16_f32 v121, v154, v155
v_accvgpr_read_b32 v132, a208
v_mfma_f32_16x16x32_bf16 a[236:239], v[96:99], v[216:219], a[236:239]
ds_read_b64_tr_b16 v[216:217], v13 offset:29184
s_waitcnt lgkmcnt(5)
v_mfma_f32_16x16x32_bf16 a[240:243], v[4:7], v[220:223], a[240:243]
ds_read_b64_tr_b16 v[218:219], v13 offset:31232
v_accvgpr_read_b32 v133, a209
v_mfma_f32_16x16x32_bf16 a[244:247], v[36:39], v[220:223], a[244:247]
v_accvgpr_read_b32 v134, a210
v_accvgpr_read_b32 v135, a211
v_mfma_f32_16x16x32_bf16 a[248:251], v[68:71], v[220:223], a[248:251]
v_cvt_pk_bf16_f32 v26, v132, v133
v_cvt_pk_bf16_f32 v27, v134, v135
v_mfma_f32_16x16x32_bf16 a[252:255], v[100:103], v[220:223], a[252:255]
ds_read_b64_tr_b16 v[220:221], v15 offset:12800
s_waitcnt lgkmcnt(5)
v_mfma_f32_16x16x32_bf16 a[240:243], v[8:11], v[208:211], a[240:243]
ds_read_b64_tr_b16 v[222:223], v15 offset:14848
buffer_store_dwordx4 v[24:27], v248, s[20:23], s44 offen offset:2048 sc1
v_mfma_f32_16x16x32_bf16 a[244:247], v[40:43], v[208:211], a[244:247]
ds_write_b128 v253, v[24:27] offset:6144
v_accvgpr_read_b32 v140, a212
v_mfma_f32_16x16x32_bf16 a[248:251], v[72:75], v[208:211], a[248:251]
v_accvgpr_read_b32 v141, a213
v_accvgpr_read_b32 v142, a214
v_mfma_f32_16x16x32_bf16 a[252:255], v[104:107], v[208:211], a[252:255]
s_waitcnt lgkmcnt(4)
v_accvgpr_read_b32 v143, a215
v_mfma_f32_16x16x32_bf16 a[240:243], v[160:163], v[212:215], a[240:243]
v_cvt_pk_bf16_f32 v58, v140, v141
v_cvt_pk_bf16_f32 v59, v142, v143
v_mfma_f32_16x16x32_bf16 a[244:247], v[164:167], v[212:215], a[244:247]
buffer_store_dwordx4 v[56:59], v248, s[20:23], s45 offen offset:2048 sc1
v_accvgpr_read_b32 v148, a216
v_mfma_f32_16x16x32_bf16 a[248:251], v[168:171], v[212:215], a[248:251]
v_accvgpr_read_b32 v149, a217
v_accvgpr_read_b32 v150, a218
v_mfma_f32_16x16x32_bf16 a[252:255], v[172:175], v[212:215], a[252:255]
s_waitcnt lgkmcnt(2)
v_accvgpr_read_b32 v151, a219
v_mfma_f32_16x16x32_bf16 a[240:243], v[176:179], v[216:219], a[240:243]
v_cvt_pk_bf16_f32 v90, v148, v149
v_cvt_pk_bf16_f32 v91, v150, v151
v_mfma_f32_16x16x32_bf16 a[244:247], v[180:183], v[216:219], a[244:247]
buffer_store_dwordx4 v[88:91], v248, s[20:23], s46 offen offset:2048 sc1
v_accvgpr_read_b32 v156, a220
v_mfma_f32_16x16x32_bf16 a[248:251], v[184:187], v[216:219], a[248:251]
v_accvgpr_read_b32 v157, a221
v_accvgpr_read_b32 v158, a222
v_mfma_f32_16x16x32_bf16 a[252:255], v[188:191], v[216:219], a[252:255]
s_waitcnt lgkmcnt(0)
v_accvgpr_read_b32 v159, a223
v_mfma_f32_16x16x32_bf16 a[240:243], v[0:3], v[220:223], a[240:243]
v_cvt_pk_bf16_f32 v122, v156, v157
v_cvt_pk_bf16_f32 v123, v158, v159
v_mfma_f32_16x16x32_bf16 a[244:247], v[32:35], v[220:223], a[244:247]
buffer_store_dwordx4 v[120:123], v248, s[20:23], s47 offen offset:2048 sc1
v_accvgpr_read_b32 v128, a224
v_mfma_f32_16x16x32_bf16 a[248:251], v[64:67], v[220:223], a[248:251]
v_accvgpr_read_b32 v129, a225
v_accvgpr_read_b32 v130, a226
v_mfma_f32_16x16x32_bf16 a[252:255], v[96:99], v[220:223], a[252:255]
v_accvgpr_read_b32 v131, a227
v_cvt_pk_bf16_f32 v28, v128, v129
v_cvt_pk_bf16_f32 v29, v130, v131
v_accvgpr_read_b32 v136, a228
v_accvgpr_read_b32 v137, a229
v_accvgpr_read_b32 v138, a230
v_accvgpr_read_b32 v139, a231
v_cvt_pk_bf16_f32 v60, v136, v137
v_cvt_pk_bf16_f32 v61, v138, v139
v_accvgpr_read_b32 v144, a232
v_accvgpr_read_b32 v145, a233
v_accvgpr_read_b32 v146, a234
v_accvgpr_read_b32 v147, a235
v_cvt_pk_bf16_f32 v92, v144, v145
v_cvt_pk_bf16_f32 v93, v146, v147
v_accvgpr_read_b32 v152, a236
v_accvgpr_read_b32 v153, a237
v_accvgpr_read_b32 v154, a238
v_accvgpr_read_b32 v155, a239
v_cvt_pk_bf16_f32 v124, v152, v153
v_cvt_pk_bf16_f32 v125, v154, v155
v_accvgpr_read_b32 v132, a240
v_accvgpr_read_b32 v133, a241
v_accvgpr_read_b32 v134, a242
v_accvgpr_read_b32 v135, a243
v_cvt_pk_bf16_f32 v30, v132, v133
v_cvt_pk_bf16_f32 v31, v134, v135
buffer_store_dwordx4 v[28:31], v248, s[20:23], s44 offen offset:3072 sc1
ds_write_b128 v253, v[28:31] offset:7168
v_accvgpr_read_b32 v140, a244
v_accvgpr_read_b32 v141, a245
v_accvgpr_read_b32 v142, a246
v_accvgpr_read_b32 v143, a247
v_cvt_pk_bf16_f32 v62, v140, v141
v_cvt_pk_bf16_f32 v63, v142, v143
buffer_store_dwordx4 v[60:63], v248, s[20:23], s45 offen offset:3072 sc1
v_accvgpr_read_b32 v148, a248
v_accvgpr_read_b32 v149, a249
v_accvgpr_read_b32 v150, a250
v_accvgpr_read_b32 v151, a251
v_cvt_pk_bf16_f32 v94, v148, v149
v_cvt_pk_bf16_f32 v95, v150, v151
buffer_store_dwordx4 v[92:95], v248, s[20:23], s46 offen offset:3072 sc1
v_accvgpr_read_b32 v156, a252
v_accvgpr_read_b32 v157, a253
v_accvgpr_read_b32 v158, a254
v_accvgpr_read_b32 v159, a255
v_cvt_pk_bf16_f32 v126, v156, v157
v_cvt_pk_bf16_f32 v127, v158, v159
buffer_store_dwordx4 v[124:127], v248, s[20:23], s47 offen offset:3072 sc1
s_waitcnt vmcnt(36)
s_branch L2_F
L2_tail_1:
s_waitcnt lgkmcnt(6)
v_mfma_f32_16x16x32_bf16 a[0:3], v[176:179], v[208:211], a[0:3]
s_mov_b32 m0, s30
v_mfma_f32_16x16x32_bf16 a[4:7], v[180:183], v[208:211], a[4:7]
buffer_load_dwordx4 v241, s[12:15], s28 offen offset:0 sc1 lds
v_add_u32 v253, s50, v248
v_mfma_f32_16x16x32_bf16 a[8:11], v[184:187], v[208:211], a[8:11]
buffer_load_dwordx4 v241, s[12:15], s28 offen offset:1024 sc1 lds
v_mfma_f32_16x16x32_bf16 a[12:15], v[188:191], v[208:211], a[12:15]
ds_read_b128 v[208:211], v240 offset:2048
s_waitcnt lgkmcnt(5)
buffer_load_dwordx4 v241, s[12:15], s28 offen offset:2048 sc1 lds
v_mfma_f32_16x16x32_bf16 a[16:19], v[176:179], v[212:215], a[16:19]
buffer_load_dwordx4 v241, s[12:15], s28 offen offset:3072 sc1 lds
v_mfma_f32_16x16x32_bf16 a[20:23], v[180:183], v[212:215], a[20:23]
s_add_u32 s28, s28, s101
s_add_u32 s30, s30, 0x4000
s_and_b32 s30, s30, 0x1ffff
v_mfma_f32_16x16x32_bf16 a[24:27], v[184:187], v[212:215], a[24:27]
s_mov_b32 m0, s30
v_mfma_f32_16x16x32_bf16 a[28:31], v[188:191], v[212:215], a[28:31]
ds_read_b128 v[212:215], v240 offset:2560
s_waitcnt lgkmcnt(4)
buffer_load_dwordx4 v241, s[12:15], s28 offen offset:0 sc1 lds
v_mfma_f32_16x16x32_bf16 a[32:35], v[176:179], v[216:219], a[32:35]
buffer_load_dwordx4 v241, s[12:15], s28 offen offset:1024 sc1 lds
v_mfma_f32_16x16x32_bf16 a[36:39], v[180:183], v[216:219], a[36:39]
buffer_load_dwordx4 v241, s[12:15], s28 offen offset:2048 sc1 lds
v_mfma_f32_16x16x32_bf16 a[40:43], v[184:187], v[216:219], a[40:43]
buffer_load_dwordx4 v241, s[12:15], s28 offen offset:3072 sc1 lds
v_mfma_f32_16x16x32_bf16 a[44:47], v[188:191], v[216:219], a[44:47]
ds_read_b128 v[216:219], v240 offset:6144
s_waitcnt lgkmcnt(3)
v_mfma_f32_16x16x32_bf16 a[48:51], v[176:179], v[220:223], a[48:51]
v_exp_f32 v232, v128
s_and_b32 s30, s30, 0x1c000
v_mfma_f32_16x16x32_bf16 a[52:55], v[180:183], v[220:223], a[52:55]
v_add_u32 v251, 0x8000, v240
v_and_b32 v251, 0x1ffff, v251
s_add_u32 s28, s30, 0xc000
v_mfma_f32_16x16x32_bf16 a[56:59], v[184:187], v[220:223], a[56:59]
v_exp_f32 v233, v129
s_and_b32 s28, s28, 0x1ffff
v_mfma_f32_16x16x32_bf16 a[60:63], v[188:191], v[220:223], a[60:63]
ds_read_b128 v[220:223], v240 offset:6656
s_waitcnt lgkmcnt(3)
s_add_u32 s30, s30, 0x4000
v_mfma_f32_16x16x32_bf16 v[144:147], v[208:211], v[0:3], v[192:195]
ds_write_b128 v253, v[176:179] offset:0
s_and_b32 s30, s30, 0x1ffff
s_mul_i32 s31, s34, 6144
v_mfma_f32_16x16x32_bf16 v[148:151], v[208:211], v[32:35], v[196:199]
ds_write_b128 v253, v[180:183] offset:1024
s_add_u32 s31, s31, s30
s_lshl_b32 s3, s34, 10
v_mfma_f32_16x16x32_bf16 v[152:155], v[208:211], v[64:67], v[200:203]
ds_write_b128 v253, v[184:187] offset:2048
s_add_u32 s28, s28, s3
s_add_u32 s3, s3, 24576
v_mfma_f32_16x16x32_bf16 v[156:159], v[208:211], v[96:99], v[204:207]
ds_read_b128 v[208:211], v240 offset:10240
s_waitcnt lgkmcnt(3)
ds_write_b128 v253, v[188:191] offset:3072
v_mfma_f32_16x16x32_bf16 v[144:147], v[212:215], v[4:7], v[144:147]
v_exp_f32 v234, v130
s_add_u32 s30, s30, s3
v_mfma_f32_16x16x32_bf16 v[148:151], v[212:215], v[36:39], v[148:151]
v_add_f32 v228, v224, v232
v_cvt_pk_bf16_f32 v160, v232, v233
v_lshrrev_b32 v241, 4, v248
v_mfma_f32_16x16x32_bf16 v[152:155], v[212:215], v[68:71], v[152:155]
v_exp_f32 v235, v131
v_and_b32 v241, 0x30, v241
v_mfma_f32_16x16x32_bf16 v[156:159], v[212:215], v[100:103], v[156:159]
ds_read_b128 v[212:215], v240 offset:10752
s_waitcnt lgkmcnt(3)
v_xor_b32 v241, v241, v248
v_mfma_f32_16x16x32_bf16 v[144:147], v[216:219], v[8:11], v[144:147]
v_add_f32 v228, v228, v233
v_add_f32 v228, v228, v234
v_mfma_f32_16x16x32_bf16 v[148:151], v[216:219], v[40:43], v[148:151]
v_add_f32 v228, v228, v235
v_cvt_pk_bf16_f32 v161, v234, v235
v_mfma_f32_16x16x32_bf16 v[152:155], v[216:219], v[72:75], v[152:155]
v_exp_f32 v236, v132
v_mfma_f32_16x16x32_bf16 v[156:159], v[216:219], v[104:107], v[156:159]
ds_read_b128 v[216:219], v240 offset:14336
s_waitcnt lgkmcnt(3)
v_mfma_f32_16x16x32_bf16 v[144:147], v[220:223], v[12:15], v[144:147]
v_exp_f32 v237, v133
v_mfma_f32_16x16x32_bf16 v[148:151], v[220:223], v[44:47], v[148:151]
v_exp_f32 v238, v134
v_mfma_f32_16x16x32_bf16 v[152:155], v[220:223], v[76:79], v[152:155]
v_add_f32 v229, v225, v236
v_cvt_pk_bf16_f32 v164, v236, v237
v_mfma_f32_16x16x32_bf16 v[156:159], v[220:223], v[108:111], v[156:159]
ds_read_b128 v[220:223], v240 offset:14848
s_waitcnt lgkmcnt(3)
v_mfma_f32_16x16x32_bf16 v[144:147], v[208:211], v[16:19], v[144:147]
v_exp_f32 v239, v135
v_and_b32 v243, 0x380, v248
v_mad_u32_u24 v241, v243, 3, v241
v_mfma_f32_16x16x32_bf16 v[148:151], v[208:211], v[48:51], v[148:151]
s_waitcnt vmcnt(8)
s_barrier
v_mfma_f32_16x16x32_bf16 v[152:155], v[208:211], v[80:83], v[152:155]
v_add_f32 v229, v229, v237
v_add_f32 v229, v229, v238
v_mfma_f32_16x16x32_bf16 v[156:159], v[208:211], v[112:115], v[156:159]
ds_read_b128 v[208:211], v240 offset:16384
s_waitcnt lgkmcnt(3)
v_mfma_f32_16x16x32_bf16 v[144:147], v[212:215], v[20:23], v[144:147]
v_add_f32 v229, v229, v239
v_cvt_pk_bf16_f32 v165, v238, v239
v_mfma_f32_16x16x32_bf16 v[148:151], v[212:215], v[52:55], v[148:151]
v_exp_f32 v232, v136
v_mfma_f32_16x16x32_bf16 v[152:155], v[212:215], v[84:87], v[152:155]
v_exp_f32 v233, v137
v_mfma_f32_16x16x32_bf16 v[156:159], v[212:215], v[116:119], v[156:159]
ds_read_b128 v[212:215], v240 offset:16896
s_waitcnt lgkmcnt(3)
v_mfma_f32_16x16x32_bf16 v[144:147], v[216:219], v[24:27], v[144:147]
v_exp_f32 v234, v138
v_mfma_f32_16x16x32_bf16 v[148:151], v[216:219], v[56:59], v[148:151]
v_add_f32 v230, v226, v232
v_cvt_pk_bf16_f32 v168, v232, v233
v_mfma_f32_16x16x32_bf16 v[152:155], v[216:219], v[88:91], v[152:155]
v_exp_f32 v235, v139
v_mfma_f32_16x16x32_bf16 v[156:159], v[216:219], v[120:123], v[156:159]
ds_read_b128 v[216:219], v240 offset:20480
s_waitcnt lgkmcnt(3)
v_mfma_f32_16x16x32_bf16 v[144:147], v[220:223], v[28:31], v[144:147]
v_add_f32 v230, v230, v233
v_add_f32 v230, v230, v234
v_mfma_f32_16x16x32_bf16 v[148:151], v[220:223], v[60:63], v[148:151]
v_add_f32 v230, v230, v235
v_cvt_pk_bf16_f32 v169, v234, v235
v_mfma_f32_16x16x32_bf16 v[152:155], v[220:223], v[92:95], v[152:155]
v_exp_f32 v236, v140
v_mfma_f32_16x16x32_bf16 v[156:159], v[220:223], v[124:127], v[156:159]
ds_read_b128 v[220:223], v240 offset:20992
s_waitcnt lgkmcnt(3)
v_exp_f32 v237, v141
v_exp_f32 v238, v142
v_add_f32 v231, v227, v236
v_cvt_pk_bf16_f32 v172, v236, v237
v_exp_f32 v239, v143
v_add_f32 v231, v231, v237
v_add_f32 v231, v231, v238
v_add_f32 v231, v231, v239
v_cvt_pk_bf16_f32 v173, v238, v239
v_max3_f32 v242, v228, v229, v230
v_max_f32 v242, v242, v231
v_cmp_lt_f32 vcc, s32, v242
s_cbranch_vccnz L2_rare_site12
L2_ret12:
v_mfma_f32_16x16x32_bf16 v[128:131], v[208:211], v[0:3], v[192:195]
s_add_u32 m0, s31, 0
v_mfma_f32_16x16x32_bf16 v[132:135], v[208:211], v[32:35], v[196:199]
v_exp_f32 v232, v144
v_mfma_f32_16x16x32_bf16 v[136:139], v[208:211], v[64:67], v[200:203]
v_exp_f32 v233, v145
v_mfma_f32_16x16x32_bf16 v[140:143], v[208:211], v[96:99], v[204:207]
ds_read_b128 v[208:211], v240 offset:24576
s_waitcnt lgkmcnt(3)
v_mfma_f32_16x16x32_bf16 v[128:131], v[212:215], v[4:7], v[128:131]
v_exp_f32 v234, v146
v_add_f32 v224, v228, v232
v_mfma_f32_16x16x32_bf16 v[132:135], v[212:215], v[36:39], v[132:135]
v_cvt_pk_bf16_f32 v162, v232, v233
v_exp_f32 v235, v147
v_mfma_f32_16x16x32_bf16 v[136:139], v[212:215], v[68:71], v[136:139]
v_add_f32 v224, v224, v233
v_add_f32 v224, v224, v234
v_add_f32 v224, v224, v235
v_mfma_f32_16x16x32_bf16 v[140:143], v[212:215], v[100:103], v[140:143]
ds_read_b128 v[212:215], v240 offset:25088
s_waitcnt lgkmcnt(3)
v_cvt_pk_bf16_f32 v163, v234, v235
v_mfma_f32_16x16x32_bf16 v[128:131], v[216:219], v[8:11], v[128:131]
v_exp_f32 v236, v148
v_mfma_f32_16x16x32_bf16 v[132:135], v[216:219], v[40:43], v[132:135]
v_exp_f32 v237, v149
v_mfma_f32_16x16x32_bf16 v[136:139], v[216:219], v[72:75], v[136:139]
v_exp_f32 v238, v150
v_add_f32 v225, v229, v236
v_mfma_f32_16x16x32_bf16 v[140:143], v[216:219], v[104:107], v[140:143]
ds_read_b128 v[216:219], v240 offset:28672
s_waitcnt lgkmcnt(3)
v_cvt_pk_bf16_f32 v166, v236, v237
v_mfma_f32_16x16x32_bf16 v[128:131], v[220:223], v[12:15], v[128:131]
v_exp_f32 v239, v151
v_add_f32 v225, v225, v237
v_mfma_f32_16x16x32_bf16 v[132:135], v[220:223], v[44:47], v[132:135]
v_add_f32 v225, v225, v238
v_add_f32 v225, v225, v239
v_cvt_pk_bf16_f32 v167, v238, v239
v_mfma_f32_16x16x32_bf16 v[136:139], v[220:223], v[76:79], v[136:139]
v_exp_f32 v232, v152
v_mfma_f32_16x16x32_bf16 v[140:143], v[220:223], v[108:111], v[140:143]
ds_read_b128 v[220:223], v240 offset:29184
s_waitcnt lgkmcnt(3)
v_mfma_f32_16x16x32_bf16 v[128:131], v[208:211], v[16:19], v[128:131]
v_exp_f32 v233, v153
v_mfma_f32_16x16x32_bf16 v[132:135], v[208:211], v[48:51], v[132:135]
v_exp_f32 v234, v154
v_add_f32 v226, v230, v232
v_mfma_f32_16x16x32_bf16 v[136:139], v[208:211], v[80:83], v[136:139]
v_cvt_pk_bf16_f32 v170, v232, v233
v_exp_f32 v235, v155
v_mfma_f32_16x16x32_bf16 v[140:143], v[208:211], v[112:115], v[140:143]
ds_read_b128 v[208:211], v240 offset:18432
s_waitcnt lgkmcnt(3)
v_add_f32 v226, v226, v233
v_mfma_f32_16x16x32_bf16 v[128:131], v[212:215], v[20:23], v[128:131]
v_add_f32 v226, v226, v234
v_add_f32 v226, v226, v235
v_cvt_pk_bf16_f32 v171, v234, v235
v_mfma_f32_16x16x32_bf16 v[132:135], v[212:215], v[52:55], v[132:135]
v_exp_f32 v236, v156
v_mfma_f32_16x16x32_bf16 v[136:139], v[212:215], v[84:87], v[136:139]
v_exp_f32 v237, v157
v_mfma_f32_16x16x32_bf16 v[140:143], v[212:215], v[116:119], v[140:143]
ds_read_b128 v[212:215], v240 offset:18944
s_waitcnt lgkmcnt(3)
v_mfma_f32_16x16x32_bf16 v[128:131], v[216:219], v[24:27], v[128:131]
v_exp_f32 v238, v158
v_add_f32 v227, v231, v236
v_mfma_f32_16x16x32_bf16 v[132:135], v[216:219], v[56:59], v[132:135]
v_cvt_pk_bf16_f32 v174, v236, v237
v_exp_f32 v239, v159
v_mfma_f32_16x16x32_bf16 v[136:139], v[216:219], v[88:91], v[136:139]
v_add_f32 v227, v227, v237
v_add_f32 v227, v227, v238
v_add_f32 v227, v227, v239
v_mfma_f32_16x16x32_bf16 v[140:143], v[216:219], v[120:123], v[140:143]
ds_read_b128 v[216:219], v240 offset:22528
s_waitcnt lgkmcnt(3)
v_cvt_pk_bf16_f32 v175, v238, v239
v_mfma_f32_16x16x32_bf16 v[128:131], v[220:223], v[28:31], v[128:131]
v_max3_f32 v242, v224, v225, v226
v_max_f32 v242, v242, v227
v_cmp_lt_f32 vcc, s32, v242
s_cbranch_vccnz L2_rare_site13
L2_ret13:
v_mfma_f32_16x16x32_bf16 v[132:135], v[220:223], v[60:63], v[132:135]
buffer_load_dwordx4 v241, s[8:11], s6 offen lds
s_add_u32 m0, s31, 2048
v_mfma_f32_16x16x32_bf16 v[136:139], v[220:223], v[92:95], v[136:139]
buffer_load_dwordx4 v241, s[8:11], s7 offen lds
s_add_u32 m0, s31, 4096
v_mfma_f32_16x16x32_bf16 v[140:143], v[220:223], v[124:127], v[140:143]
ds_read_b128 v[220:223], v240 offset:23040
s_waitcnt lgkmcnt(3)
v_mfma_f32_16x16x32_bf16 v[144:147], v[208:211], v[0:3], v[192:195]
ds_write_b128 v253, v[160:163] offset:4096
buffer_load_dwordx4 v241, s[8:11], s29 offen lds
s_add_u32 m0, s31, 1024
v_mfma_f32_16x16x32_bf16 v[148:151], v[208:211], v[32:35], v[196:199]
ds_write_b128 v253, v[164:167] offset:5120
v_exp_f32 v232, v128
v_mfma_f32_16x16x32_bf16 v[152:155], v[208:211], v[64:67], v[200:203]
ds_write_b128 v253, v[168:171] offset:6144
v_exp_f32 v233, v129
v_mfma_f32_16x16x32_bf16 v[156:159], v[208:211], v[96:99], v[204:207]
ds_read_b128 v[208:211], v240 offset:26624
s_waitcnt lgkmcnt(3)
ds_write_b128 v253, v[172:175] offset:7168
v_mfma_f32_16x16x32_bf16 v[144:147], v[212:215], v[4:7], v[144:147]
v_exp_f32 v234, v130
v_add_f32 v228, v224, v232
v_mfma_f32_16x16x32_bf16 v[148:151], v[212:215], v[36:39], v[148:151]
v_cvt_pk_bf16_f32 v176, v232, v233
v_exp_f32 v235, v131
v_mfma_f32_16x16x32_bf16 v[152:155], v[212:215], v[68:71], v[152:155]
v_add_f32 v228, v228, v233
v_add_f32 v228, v228, v234
v_add_f32 v228, v228, v235
v_mfma_f32_16x16x32_bf16 v[156:159], v[212:215], v[100:103], v[156:159]
ds_read_b128 v[212:215], v240 offset:27136
s_waitcnt lgkmcnt(3)
v_cvt_pk_bf16_f32 v177, v234, v235
v_mfma_f32_16x16x32_bf16 v[144:147], v[216:219], v[8:11], v[144:147]
v_exp_f32 v236, v132
v_xor_b32 v241, 0x1040, v241
v_mfma_f32_16x16x32_bf16 v[148:151], v[216:219], v[40:43], v[148:151]
v_exp_f32 v237, v133
v_mfma_f32_16x16x32_bf16 v[152:155], v[216:219], v[72:75], v[152:155]
v_exp_f32 v238, v134
v_add_f32 v229, v225, v236
v_mfma_f32_16x16x32_bf16 v[156:159], v[216:219], v[104:107], v[156:159]
ds_read_b128 v[216:219], v240 offset:30720
s_waitcnt lgkmcnt(3)
v_cvt_pk_bf16_f32 v180, v236, v237
v_mfma_f32_16x16x32_bf16 v[144:147], v[220:223], v[12:15], v[144:147]
v_exp_f32 v239, v135
v_add_f32 v229, v229, v237
v_mfma_f32_16x16x32_bf16 v[148:151], v[220:223], v[44:47], v[148:151]
v_add_f32 v229, v229, v238
v_add_f32 v229, v229, v239
v_cvt_pk_bf16_f32 v181, v238, v239
v_mfma_f32_16x16x32_bf16 v[152:155], v[220:223], v[76:79], v[152:155]
v_exp_f32 v232, v136
v_mfma_f32_16x16x32_bf16 v[156:159], v[220:223], v[108:111], v[156:159]
ds_read_b128 v[220:223], v240 offset:31232
s_waitcnt lgkmcnt(3)
v_mfma_f32_16x16x32_bf16 v[144:147], v[208:211], v[16:19], v[144:147]
v_exp_f32 v233, v137
v_mfma_f32_16x16x32_bf16 v[148:151], v[208:211], v[48:51], v[148:151]
s_waitcnt vmcnt(7)
s_barrier
v_mfma_f32_16x16x32_bf16 v[152:155], v[208:211], v[80:83], v[152:155]
v_exp_f32 v234, v138
v_add_f32 v230, v226, v232
v_mfma_f32_16x16x32_bf16 v[156:159], v[208:211], v[112:115], v[156:159]
ds_read_b128 v[208:211], v251 offset:0
s_waitcnt lgkmcnt(3)
v_cvt_pk_bf16_f32 v184, v232, v233
v_mfma_f32_16x16x32_bf16 v[144:147], v[212:215], v[20:23], v[144:147]
v_exp_f32 v235, v139
v_add_f32 v230, v230, v233
v_mfma_f32_16x16x32_bf16 v[148:151], v[212:215], v[52:55], v[148:151]
v_add_f32 v230, v230, v234
v_add_f32 v230, v230, v235
v_cvt_pk_bf16_f32 v185, v234, v235
v_mfma_f32_16x16x32_bf16 v[152:155], v[212:215], v[84:87], v[152:155]
v_exp_f32 v236, v140
v_mfma_f32_16x16x32_bf16 v[156:159], v[212:215], v[116:119], v[156:159]
ds_read_b128 v[212:215], v251 offset:512
s_waitcnt lgkmcnt(3)
v_mfma_f32_16x16x32_bf16 v[144:147], v[216:219], v[24:27], v[144:147]
v_exp_f32 v237, v141
v_mfma_f32_16x16x32_bf16 v[148:151], v[216:219], v[56:59], v[148:151]
v_exp_f32 v238, v142
v_add_f32 v231, v227, v236
v_mfma_f32_16x16x32_bf16 v[152:155], v[216:219], v[88:91], v[152:155]
v_cvt_pk_bf16_f32 v188, v236, v237
v_exp_f32 v239, v143
v_mfma_f32_16x16x32_bf16 v[156:159], v[216:219], v[120:123], v[156:159]
ds_read_b128 v[216:219], v251 offset:4096
s_waitcnt lgkmcnt(3)
v_add_f32 v231, v231, v237
v_mfma_f32_16x16x32_bf16 v[144:147], v[220:223], v[28:31], v[144:147]
v_add_f32 v231, v231, v238
v_add_f32 v231, v231, v239
v_cvt_pk_bf16_f32 v189, v238, v239
v_mfma_f32_16x16x32_bf16 v[148:151], v[220:223], v[60:63], v[148:151]
v_max3_f32 v242, v228, v229, v230
v_max_f32 v242, v242, v231
v_cmp_lt_f32 vcc, s32, v242
s_cbranch_vccnz L2_rare_site14
L2_ret14:
v_mfma_f32_16x16x32_bf16 v[152:155], v[220:223], v[92:95], v[152:155]
buffer_load_dwordx4 v241, s[8:11], s6 offen lds
s_add_u32 m0, s31, 3072
v_mfma_f32_16x16x32_bf16 v[156:159], v[220:223], v[124:127], v[156:159]
ds_read_b128 v[220:223], v251 offset:4608
s_waitcnt lgkmcnt(3)
v_mfma_f32_16x16x32_bf16 v[128:131], v[208:211], v[0:3], v[192:195]
buffer_load_dwordx4 v241, s[8:11], s7 offen lds
s_add_u32 m0, s31, 5120
v_mfma_f32_16x16x32_bf16 v[132:135], v[208:211], v[32:35], v[196:199]
v_exp_f32 v232, v144
v_mfma_f32_16x16x32_bf16 v[136:139], v[208:211], v[64:67], v[200:203]
v_exp_f32 v233, v145
v_mfma_f32_16x16x32_bf16 v[140:143], v[208:211], v[96:99], v[204:207]
ds_read_b128 v[208:211], v251 offset:8192
s_waitcnt lgkmcnt(3)
v_mfma_f32_16x16x32_bf16 v[128:131], v[212:215], v[4:7], v[128:131]
v_exp_f32 v234, v146
v_add_f32 v224, v228, v232
v_mfma_f32_16x16x32_bf16 v[132:135], v[212:215], v[36:39], v[132:135]
v_cvt_pk_bf16_f32 v178, v232, v233
v_exp_f32 v235, v147
v_mfma_f32_16x16x32_bf16 v[136:139], v[212:215], v[68:71], v[136:139]
v_add_f32 v224, v224, v233
v_add_f32 v224, v224, v234
v_add_f32 v224, v224, v235
v_mfma_f32_16x16x32_bf16 v[140:143], v[212:215], v[100:103], v[140:143]
ds_read_b128 v[212:215], v251 offset:8704
s_waitcnt lgkmcnt(3)
v_cvt_pk_bf16_f32 v179, v234, v235
v_mfma_f32_16x16x32_bf16 v[128:131], v[216:219], v[8:11], v[128:131]
v_exp_f32 v236, v148
v_mfma_f32_16x16x32_bf16 v[132:135], v[216:219], v[40:43], v[132:135]
v_exp_f32 v237, v149
v_mfma_f32_16x16x32_bf16 v[136:139], v[216:219], v[72:75], v[136:139]
v_exp_f32 v238, v150
v_add_f32 v225, v229, v236
v_mfma_f32_16x16x32_bf16 v[140:143], v[216:219], v[104:107], v[140:143]
ds_read_b128 v[216:219], v251 offset:12288
s_waitcnt lgkmcnt(3)
v_cvt_pk_bf16_f32 v182, v236, v237
v_mfma_f32_16x16x32_bf16 v[128:131], v[220:223], v[12:15], v[128:131]
v_exp_f32 v239, v151
v_add_f32 v225, v225, v237
v_mfma_f32_16x16x32_bf16 v[132:135], v[220:223], v[44:47], v[132:135]
v_add_f32 v225, v225, v238
v_add_f32 v225, v225, v239
v_cvt_pk_bf16_f32 v183, v238, v239
v_mfma_f32_16x16x32_bf16 v[136:139], v[220:223], v[76:79], v[136:139]
v_exp_f32 v232, v152
v_mfma_f32_16x16x32_bf16 v[140:143], v[220:223], v[108:111], v[140:143]
ds_read_b128 v[220:223], v251 offset:12800
s_waitcnt lgkmcnt(3)
v_mfma_f32_16x16x32_bf16 v[128:131], v[208:211], v[16:19], v[128:131]
v_exp_f32 v233, v153
v_mfma_f32_16x16x32_bf16 v[132:135], v[208:211], v[48:51], v[132:135]
v_exp_f32 v234, v154
v_add_f32 v226, v230, v232
v_mfma_f32_16x16x32_bf16 v[136:139], v[208:211], v[80:83], v[136:139]
v_cvt_pk_bf16_f32 v186, v232, v233
v_exp_f32 v235, v155
v_mfma_f32_16x16x32_bf16 v[140:143], v[208:211], v[112:115], v[140:143]
ds_read_b128 v[208:211], v251 offset:2048
s_waitcnt lgkmcnt(3)
v_add_f32 v226, v226, v233
v_mfma_f32_16x16x32_bf16 v[128:131], v[212:215], v[20:23], v[128:131]
v_add_f32 v226, v226, v234
v_add_f32 v226, v226, v235
v_cvt_pk_bf16_f32 v187, v234, v235
v_mfma_f32_16x16x32_bf16 v[132:135], v[212:215], v[52:55], v[132:135]
v_exp_f32 v236, v156
v_mfma_f32_16x16x32_bf16 v[136:139], v[212:215], v[84:87], v[136:139]
v_exp_f32 v237, v157
v_mfma_f32_16x16x32_bf16 v[140:143], v[212:215], v[116:119], v[140:143]
ds_read_b128 v[212:215], v251 offset:2560
s_waitcnt lgkmcnt(3)
v_mfma_f32_16x16x32_bf16 v[128:131], v[216:219], v[24:27], v[128:131]
v_exp_f32 v238, v158
v_add_f32 v227, v231, v236
v_mfma_f32_16x16x32_bf16 v[132:135], v[216:219], v[56:59], v[132:135]
v_cvt_pk_bf16_f32 v190, v236, v237
v_exp_f32 v239, v159
v_mfma_f32_16x16x32_bf16 v[136:139], v[216:219], v[88:91], v[136:139]
v_add_f32 v227, v227, v237
v_add_f32 v227, v227, v238
v_add_f32 v227, v227, v239
v_mfma_f32_16x16x32_bf16 v[140:143], v[216:219], v[120:123], v[140:143]
ds_read_b128 v[216:219], v251 offset:6144
s_waitcnt lgkmcnt(3)
v_cvt_pk_bf16_f32 v191, v238, v239
v_mfma_f32_16x16x32_bf16 v[128:131], v[220:223], v[28:31], v[128:131]
v_max3_f32 v242, v224, v225, v226
v_max_f32 v242, v242, v227
v_cmp_lt_f32 vcc, s32, v242
s_cbranch_vccnz L2_rare_site15
L2_ret15:
v_mfma_f32_16x16x32_bf16 v[132:135], v[220:223], v[60:63], v[132:135]
buffer_load_dwordx4 v241, s[8:11], s29 offen lds
v_mfma_f32_16x16x32_bf16 v[136:139], v[220:223], v[92:95], v[136:139]
v_mfma_f32_16x16x32_bf16 v[140:143], v[220:223], v[124:127], v[140:143]
ds_read_b128 v[220:223], v251 offset:6656
s_waitcnt lgkmcnt(3)
v_mfma_f32_16x16x32_bf16 v[144:147], v[208:211], v[0:3], v[192:195]
v_mfma_f32_16x16x32_bf16 v[148:151], v[208:211], v[32:35], v[196:199]
v_exp_f32 v232, v128
v_lshlrev_b32 v241, 3, v248
v_mfma_f32_16x16x32_bf16 v[152:155], v[208:211], v[64:67], v[200:203]
v_exp_f32 v233, v129
s_mov_b32 s3, 0x7c28000
v_mfma_f32_16x16x32_bf16 v[156:159], v[208:211], v[96:99], v[204:207]
ds_read_b128 v[208:211], v251 offset:10240
s_waitcnt lgkmcnt(3)
buffer_load_dwordx2 v[240:241], v241, s[16:19], s3 offen sc1
v_mfma_f32_16x16x32_bf16 v[144:147], v[212:215], v[4:7], v[144:147]
v_exp_f32 v234, v130
v_add_f32 v228, v224, v232
v_mfma_f32_16x16x32_bf16 v[148:151], v[212:215], v[36:39], v[148:151]
v_cvt_pk_bf16_f32 v160, v232, v233
v_exp_f32 v235, v131
v_mfma_f32_16x16x32_bf16 v[152:155], v[212:215], v[68:71], v[152:155]
v_add_f32 v228, v228, v233
v_add_f32 v228, v228, v234
v_add_f32 v228, v228, v235
v_mfma_f32_16x16x32_bf16 v[156:159], v[212:215], v[100:103], v[156:159]
ds_read_b128 v[212:215], v251 offset:10752
s_waitcnt lgkmcnt(3)
v_cvt_pk_bf16_f32 v161, v234, v235
v_mfma_f32_16x16x32_bf16 v[144:147], v[216:219], v[8:11], v[144:147]
v_exp_f32 v236, v132
v_mfma_f32_16x16x32_bf16 v[148:151], v[216:219], v[40:43], v[148:151]
v_exp_f32 v237, v133
v_mfma_f32_16x16x32_bf16 v[152:155], v[216:219], v[72:75], v[152:155]
v_exp_f32 v238, v134
v_add_f32 v229, v225, v236
v_mfma_f32_16x16x32_bf16 v[156:159], v[216:219], v[104:107], v[156:159]
ds_read_b128 v[216:219], v251 offset:14336
s_waitcnt lgkmcnt(3)
v_cvt_pk_bf16_f32 v164, v236, v237
v_mfma_f32_16x16x32_bf16 v[144:147], v[220:223], v[12:15], v[144:147]
v_exp_f32 v239, v135
v_add_f32 v229, v229, v237
v_mfma_f32_16x16x32_bf16 v[148:151], v[220:223], v[44:47], v[148:151]
v_add_f32 v229, v229, v238
v_add_f32 v229, v229, v239
v_cvt_pk_bf16_f32 v165, v238, v239
v_mfma_f32_16x16x32_bf16 v[152:155], v[220:223], v[76:79], v[152:155]
v_exp_f32 v232, v136
v_mfma_f32_16x16x32_bf16 v[156:159], v[220:223], v[108:111], v[156:159]
ds_read_b128 v[220:223], v251 offset:14848
s_waitcnt lgkmcnt(3)
v_mfma_f32_16x16x32_bf16 v[144:147], v[208:211], v[16:19], v[144:147]
v_exp_f32 v233, v137
v_mfma_f32_16x16x32_bf16 v[148:151], v[208:211], v[48:51], v[148:151]
s_waitcnt vmcnt(7)
s_barrier
v_mfma_f32_16x16x32_bf16 v[152:155], v[208:211], v[80:83], v[152:155]
v_exp_f32 v234, v138
v_add_f32 v230, v226, v232
v_mfma_f32_16x16x32_bf16 v[156:159], v[208:211], v[112:115], v[156:159]
ds_read_b128 v[208:211], v251 offset:16384
s_waitcnt lgkmcnt(3)
v_cvt_pk_bf16_f32 v168, v232, v233
v_mfma_f32_16x16x32_bf16 v[144:147], v[212:215], v[20:23], v[144:147]
v_exp_f32 v235, v139
v_add_f32 v230, v230, v233
v_mfma_f32_16x16x32_bf16 v[148:151], v[212:215], v[52:55], v[148:151]
v_add_f32 v230, v230, v234
v_add_f32 v230, v230, v235
v_cvt_pk_bf16_f32 v169, v234, v235
v_mfma_f32_16x16x32_bf16 v[152:155], v[212:215], v[84:87], v[152:155]
v_exp_f32 v236, v140
v_mfma_f32_16x16x32_bf16 v[156:159], v[212:215], v[116:119], v[156:159]
ds_read_b128 v[212:215], v251 offset:16896
s_waitcnt lgkmcnt(3)
v_mfma_f32_16x16x32_bf16 v[144:147], v[216:219], v[24:27], v[144:147]
v_exp_f32 v237, v141
v_mfma_f32_16x16x32_bf16 v[148:151], v[216:219], v[56:59], v[148:151]
v_exp_f32 v238, v142
v_add_f32 v231, v227, v236
v_mfma_f32_16x16x32_bf16 v[152:155], v[216:219], v[88:91], v[152:155]
v_cvt_pk_bf16_f32 v172, v236, v237
v_exp_f32 v239, v143
v_mfma_f32_16x16x32_bf16 v[156:159], v[216:219], v[120:123], v[156:159]
ds_read_b128 v[216:219], v251 offset:20480
s_waitcnt lgkmcnt(3)
v_add_f32 v231, v231, v237
v_mfma_f32_16x16x32_bf16 v[144:147], v[220:223], v[28:31], v[144:147]
v_add_f32 v231, v231, v238
v_add_f32 v231, v231, v239
v_cvt_pk_bf16_f32 v173, v238, v239
v_mfma_f32_16x16x32_bf16 v[148:151], v[220:223], v[60:63], v[148:151]
v_max3_f32 v242, v228, v229, v230
v_max_f32 v242, v242, v231
v_cmp_lt_f32 vcc, s32, v242
s_cbranch_vccnz L2_rare_site16
L2_ret16:
v_mfma_f32_16x16x32_bf16 v[152:155], v[220:223], v[92:95], v[152:155]
v_mfma_f32_16x16x32_bf16 v[156:159], v[220:223], v[124:127], v[156:159]
ds_read_b128 v[220:223], v251 offset:20992
s_waitcnt lgkmcnt(3)
v_mfma_f32_16x16x32_bf16 v[128:131], v[208:211], v[0:3], v[192:195]
v_mfma_f32_16x16x32_bf16 v[132:135], v[208:211], v[32:35], v[196:199]
v_exp_f32 v232, v144
v_mfma_f32_16x16x32_bf16 v[136:139], v[208:211], v[64:67], v[200:203]
v_exp_f32 v233, v145
v_mfma_f32_16x16x32_bf16 v[140:143], v[208:211], v[96:99], v[204:207]
ds_read_b128 v[208:211], v251 offset:24576
s_waitcnt lgkmcnt(3)
v_mfma_f32_16x16x32_bf16 v[128:131], v[212:215], v[4:7], v[128:131]
v_exp_f32 v234, v146
v_add_f32 v224, v228, v232
v_mfma_f32_16x16x32_bf16 v[132:135], v[212:215], v[36:39], v[132:135]
v_cvt_pk_bf16_f32 v162, v232, v233
v_exp_f32 v235, v147
v_mfma_f32_16x16x32_bf16 v[136:139], v[212:215], v[68:71], v[136:139]
v_add_f32 v224, v224, v233
v_add_f32 v224, v224, v234
v_add_f32 v224, v224, v235
v_mfma_f32_16x16x32_bf16 v[140:143], v[212:215], v[100:103], v[140:143]
ds_read_b128 v[212:215], v251 offset:25088
s_waitcnt lgkmcnt(3)
v_cvt_pk_bf16_f32 v163, v234, v235
v_mfma_f32_16x16x32_bf16 v[128:131], v[216:219], v[8:11], v[128:131]
v_exp_f32 v236, v148
v_mfma_f32_16x16x32_bf16 v[132:135], v[216:219], v[40:43], v[132:135]
v_exp_f32 v237, v149
v_mfma_f32_16x16x32_bf16 v[136:139], v[216:219], v[72:75], v[136:139]
v_exp_f32 v238, v150
v_add_f32 v225, v229, v236
v_mfma_f32_16x16x32_bf16 v[140:143], v[216:219], v[104:107], v[140:143]
ds_read_b128 v[216:219], v251 offset:28672
s_waitcnt lgkmcnt(3)
v_cvt_pk_bf16_f32 v166, v236, v237
v_mfma_f32_16x16x32_bf16 v[128:131], v[220:223], v[12:15], v[128:131]
v_exp_f32 v239, v151
v_add_f32 v225, v225, v237
v_mfma_f32_16x16x32_bf16 v[132:135], v[220:223], v[44:47], v[132:135]
v_add_f32 v225, v225, v238
v_add_f32 v225, v225, v239
v_cvt_pk_bf16_f32 v167, v238, v239
v_mfma_f32_16x16x32_bf16 v[136:139], v[220:223], v[76:79], v[136:139]
v_exp_f32 v232, v152
v_mfma_f32_16x16x32_bf16 v[140:143], v[220:223], v[108:111], v[140:143]
ds_read_b128 v[220:223], v251 offset:29184
s_waitcnt lgkmcnt(3)
v_mfma_f32_16x16x32_bf16 v[128:131], v[208:211], v[16:19], v[128:131]
v_exp_f32 v233, v153
v_mfma_f32_16x16x32_bf16 v[132:135], v[208:211], v[48:51], v[132:135]
v_exp_f32 v234, v154
v_add_f32 v226, v230, v232
v_mfma_f32_16x16x32_bf16 v[136:139], v[208:211], v[80:83], v[136:139]
v_cvt_pk_bf16_f32 v170, v232, v233
v_exp_f32 v235, v155
v_mfma_f32_16x16x32_bf16 v[140:143], v[208:211], v[112:115], v[140:143]
ds_read_b128 v[208:211], v251 offset:18432
s_waitcnt lgkmcnt(3)
v_add_f32 v226, v226, v233
v_mfma_f32_16x16x32_bf16 v[128:131], v[212:215], v[20:23], v[128:131]
v_add_f32 v226, v226, v234
v_add_f32 v226, v226, v235
v_cvt_pk_bf16_f32 v171, v234, v235
v_mfma_f32_16x16x32_bf16 v[132:135], v[212:215], v[52:55], v[132:135]
v_exp_f32 v236, v156
v_mfma_f32_16x16x32_bf16 v[136:139], v[212:215], v[84:87], v[136:139]
v_exp_f32 v237, v157
v_mfma_f32_16x16x32_bf16 v[140:143], v[212:215], v[116:119], v[140:143]
ds_read_b128 v[212:215], v251 offset:18944
s_waitcnt lgkmcnt(3)
v_mfma_f32_16x16x32_bf16 v[128:131], v[216:219], v[24:27], v[128:131]
v_exp_f32 v238, v158
v_add_f32 v227, v231, v236
v_mfma_f32_16x16x32_bf16 v[132:135], v[216:219], v[56:59], v[132:135]
v_cvt_pk_bf16_f32 v174, v236, v237
v_exp_f32 v239, v159
v_mfma_f32_16x16x32_bf16 v[136:139], v[216:219], v[88:91], v[136:139]
v_add_f32 v227, v227, v237
v_add_f32 v227, v227, v238
v_add_f32 v227, v227, v239
v_mfma_f32_16x16x32_bf16 v[140:143], v[216:219], v[120:123], v[140:143]
ds_read_b128 v[216:219], v251 offset:22528
s_waitcnt lgkmcnt(3)
v_cvt_pk_bf16_f32 v175, v238, v239
v_mfma_f32_16x16x32_bf16 v[128:131], v[220:223], v[28:31], v[128:131]
v_max3_f32 v242, v224, v225, v226
v_max_f32 v242, v242, v227
v_cmp_lt_f32 vcc, s32, v242
s_cbranch_vccnz L2_rare_site17
L2_ret17:
v_mfma_f32_16x16x32_bf16 v[132:135], v[220:223], v[60:63], v[132:135]
v_mfma_f32_16x16x32_bf16 v[136:139], v[220:223], v[92:95], v[136:139]
v_mfma_f32_16x16x32_bf16 v[140:143], v[220:223], v[124:127], v[140:143]
ds_read_b128 v[220:223], v251 offset:23040
s_waitcnt lgkmcnt(3)
v_mfma_f32_16x16x32_bf16 v[144:147], v[208:211], v[0:3], v[192:195]
v_mfma_f32_16x16x32_bf16 v[148:151], v[208:211], v[32:35], v[196:199]
v_mfma_f32_16x16x32_bf16 v[152:155], v[208:211], v[64:67], v[200:203]
v_mfma_f32_16x16x32_bf16 v[156:159], v[208:211], v[96:99], v[204:207]
ds_read_b128 v[208:211], v251 offset:26624
s_waitcnt lgkmcnt(3)
v_mfma_f32_16x16x32_bf16 v[144:147], v[212:215], v[4:7], v[144:147]
v_exp_f32 v232, v128
v_mfma_f32_16x16x32_bf16 v[148:151], v[212:215], v[36:39], v[148:151]
v_exp_f32 v233, v129
v_mfma_f32_16x16x32_bf16 v[152:155], v[212:215], v[68:71], v[152:155]
v_exp_f32 v234, v130
v_add_f32 v228, v224, v232
v_mfma_f32_16x16x32_bf16 v[156:159], v[212:215], v[100:103], v[156:159]
ds_read_b128 v[212:215], v251 offset:27136
s_waitcnt lgkmcnt(3)
v_cvt_pk_bf16_f32 v0, v232, v233
v_mfma_f32_16x16x32_bf16 v[144:147], v[216:219], v[8:11], v[144:147]
v_exp_f32 v235, v131
v_add_f32 v228, v228, v233
v_mfma_f32_16x16x32_bf16 v[148:151], v[216:219], v[40:43], v[148:151]
ds_read_b128 v[4:7], v253 offset:0
v_add_f32 v228, v228, v234
v_add_f32 v228, v228, v235
v_mfma_f32_16x16x32_bf16 v[152:155], v[216:219], v[72:75], v[152:155]
ds_read_b128 v[36:39], v253 offset:1024
v_cvt_pk_bf16_f32 v1, v234, v235
v_mfma_f32_16x16x32_bf16 v[156:159], v[216:219], v[104:107], v[156:159]
ds_read_b128 v[216:219], v251 offset:30720
s_waitcnt lgkmcnt(3)
v_mfma_f32_16x16x32_bf16 v[144:147], v[220:223], v[12:15], v[144:147]
v_exp_f32 v236, v132
v_mfma_f32_16x16x32_bf16 v[148:151], v[220:223], v[44:47], v[148:151]
ds_read_b128 v[68:71], v253 offset:2048
ds_read_b128 v[8:11], v253 offset:4096
v_mfma_f32_16x16x32_bf16 v[152:155], v[220:223], v[76:79], v[152:155]
v_add_u32 v12, 0x8000, v249
v_and_b32 v12, 0x1ffff, v12
ds_read_b128 v[100:103], v253 offset:3072
ds_read_b128 v[40:43], v253 offset:5120
v_mfma_f32_16x16x32_bf16 v[156:159], v[220:223], v[108:111], v[156:159]
ds_read_b128 v[220:223], v251 offset:31232
s_waitcnt lgkmcnt(3)
v_add_u32 v14, 0x10000, v249
v_and_b32 v14, 0x1ffff, v14
v_mfma_f32_16x16x32_bf16 v[144:147], v[208:211], v[16:19], v[144:147]
v_xor_b32 v13, 32, v12
v_xor_b32 v15, 32, v14
v_mfma_f32_16x16x32_bf16 v[148:151], v[208:211], v[48:51], v[148:151]
ds_read_b128 v[72:75], v253 offset:6144
v_exp_f32 v237, v133
v_mfma_f32_16x16x32_bf16 v[152:155], v[208:211], v[80:83], v[152:155]
ds_read_b128 v[104:107], v253 offset:7168
v_exp_f32 v238, v134
v_mfma_f32_16x16x32_bf16 v[156:159], v[208:211], v[112:115], v[156:159]
ds_read_b64_tr_b16 v[208:209], v12 offset:0
s_waitcnt lgkmcnt(3)
v_add_f32 v229, v225, v236
v_mfma_f32_16x16x32_bf16 v[144:147], v[212:215], v[20:23], v[144:147]
ds_read_b64_tr_b16 v[210:211], v12 offset:2048
v_cvt_pk_bf16_f32 v32, v236, v237
v_mfma_f32_16x16x32_bf16 v[148:151], v[212:215], v[52:55], v[148:151]
v_exp_f32 v239, v135
v_add_f32 v229, v229, v237
v_mfma_f32_16x16x32_bf16 v[152:155], v[212:215], v[84:87], v[152:155]
v_add_f32 v229, v229, v238
v_add_f32 v229, v229, v239
v_cvt_pk_bf16_f32 v33, v238, v239
v_mfma_f32_16x16x32_bf16 v[156:159], v[212:215], v[116:119], v[156:159]
ds_read_b64_tr_b16 v[212:213], v12 offset:16384
s_waitcnt lgkmcnt(4)
v_mfma_f32_16x16x32_bf16 v[144:147], v[216:219], v[24:27], v[144:147]
ds_read_b64_tr_b16 v[214:215], v12 offset:18432
v_exp_f32 v232, v136
v_mfma_f32_16x16x32_bf16 v[148:151], v[216:219], v[56:59], v[148:151]
v_exp_f32 v233, v137
v_mfma_f32_16x16x32_bf16 v[152:155], v[216:219], v[88:91], v[152:155]
v_exp_f32 v234, v138
v_add_f32 v230, v226, v232
v_mfma_f32_16x16x32_bf16 v[156:159], v[216:219], v[120:123], v[156:159]
ds_read_b64_tr_b16 v[216:217], v14 offset:0
s_waitcnt lgkmcnt(5)
v_cvt_pk_bf16_f32 v64, v232, v233
v_mfma_f32_16x16x32_bf16 v[144:147], v[220:223], v[28:31], v[144:147]
ds_read_b64_tr_b16 v[218:219], v14 offset:2048
v_exp_f32 v235, v139
v_mfma_f32_16x16x32_bf16 v[148:151], v[220:223], v[60:63], v[148:151]
v_add_f32 v230, v230, v233
v_add_f32 v230, v230, v234
v_add_f32 v230, v230, v235
v_mfma_f32_16x16x32_bf16 v[152:155], v[220:223], v[92:95], v[152:155]
v_cvt_pk_bf16_f32 v65, v234, v235
v_exp_f32 v236, v140
v_mfma_f32_16x16x32_bf16 v[156:159], v[220:223], v[124:127], v[156:159]
ds_read_b64_tr_b16 v[220:221], v13 offset:0
s_waitcnt lgkmcnt(5)
v_exp_f32 v237, v141
v_exp_f32 v238, v142
v_add_f32 v231, v227, v236
v_cvt_pk_bf16_f32 v96, v236, v237
v_exp_f32 v239, v143
v_add_f32 v231, v231, v237
v_add_f32 v231, v231, v238
v_add_f32 v231, v231, v239
v_cvt_pk_bf16_f32 v97, v238, v239
v_max3_f32 v242, v228, v229, v230
v_max_f32 v242, v242, v231
v_cmp_lt_f32 vcc, s32, v242
s_cbranch_vccnz L2_rare_site18
L2_ret18:
v_mfma_f32_16x16x32_bf16 a[0:3], v[8:11], v[208:211], a[0:3]
ds_read_b64_tr_b16 v[222:223], v13 offset:2048
s_waitcnt vmcnt(0)
v_cmp_ne_u64_e64 s[38:39], s[98:99], v[240:241]
v_mfma_f32_16x16x32_bf16 a[4:7], v[40:43], v[208:211], a[4:7]
v_exp_f32 v232, v144
v_mfma_f32_16x16x32_bf16 a[8:11], v[72:75], v[208:211], a[8:11]
v_exp_f32 v233, v145
v_mfma_f32_16x16x32_bf16 a[12:15], v[104:107], v[208:211], a[12:15]
ds_read_b64_tr_b16 v[208:209], v13 offset:16384
s_waitcnt lgkmcnt(5)
v_mfma_f32_16x16x32_bf16 a[0:3], v[176:179], v[212:215], a[0:3]
ds_read_b64_tr_b16 v[210:211], v13 offset:18432
s_and_b64 s[38:39], s[38:39], s[96:97]
s_cbranch_scc1 LF_hl_1
LF_hlret_1:
v_mfma_f32_16x16x32_bf16 a[4:7], v[180:183], v[212:215], a[4:7]
v_exp_f32 v234, v146
v_lshrrev_b32 v241, 4, v248
v_mfma_f32_16x16x32_bf16 a[8:11], v[184:187], v[212:215], a[8:11]
v_add_f32 v224, v228, v232
v_cvt_pk_bf16_f32 v2, v232, v233
v_and_b32 v241, 0x30, v241
v_mfma_f32_16x16x32_bf16 a[12:15], v[188:191], v[212:215], a[12:15]
ds_read_b64_tr_b16 v[212:213], v15 offset:0
s_waitcnt lgkmcnt(5)
v_xor_b32 v241, v241, v248
v_mfma_f32_16x16x32_bf16 a[0:3], v[160:163], v[216:219], a[0:3]
ds_read_b64_tr_b16 v[214:215], v15 offset:2048
v_and_b32 v243, 0x380, v248
v_mad_u32_u24 v241, v243, 3, v241
v_mfma_f32_16x16x32_bf16 a[4:7], v[164:167], v[216:219], a[4:7]
v_exp_f32 v235, v147
v_add_u32 v241, 0x7000000, v241
v_mfma_f32_16x16x32_bf16 a[8:11], v[168:171], v[216:219], a[8:11]
v_add_f32 v224, v224, v233
v_add_f32 v224, v224, v234
v_and_b32 v110, 0x70, v248
v_mfma_f32_16x16x32_bf16 a[12:15], v[172:175], v[216:219], a[12:15]
ds_read_b64_tr_b16 v[216:217], v12 offset:512
s_waitcnt lgkmcnt(5)
v_lshlrev_b32 v110, 3, v110
v_mfma_f32_16x16x32_bf16 a[16:19], v[8:11], v[220:223], a[16:19]
ds_read_b64_tr_b16 v[218:219], v12 offset:2560
v_add_f32 v224, v224, v235
v_add_u32 v110, 0x7c32000, v110
v_mfma_f32_16x16x32_bf16 a[20:23], v[40:43], v[220:223], a[20:23]
v_cvt_pk_bf16_f32 v3, v234, v235
buffer_load_dwordx2 v[108:109], v110, s[16:19], 0 offen sc1
v_mfma_f32_16x16x32_bf16 a[24:27], v[72:75], v[220:223], a[24:27]
v_exp_f32 v236, v148
v_mfma_f32_16x16x32_bf16 a[28:31], v[104:107], v[220:223], a[28:31]
ds_read_b64_tr_b16 v[220:221], v12 offset:16896
s_waitcnt lgkmcnt(5)
v_mfma_f32_16x16x32_bf16 a[16:19], v[176:179], v[208:211], a[16:19]
ds_read_b64_tr_b16 v[222:223], v12 offset:18944
s_add_u32 m0, s28, 0
v_mfma_f32_16x16x32_bf16 a[20:23], v[180:183], v[208:211], a[20:23]
v_exp_f32 v237, v149
v_mfma_f32_16x16x32_bf16 a[24:27], v[184:187], v[208:211], a[24:27]
v_exp_f32 v238, v150
v_mfma_f32_16x16x32_bf16 a[28:31], v[188:191], v[208:211], a[28:31]
ds_read_b64_tr_b16 v[208:209], v14 offset:512
s_waitcnt lgkmcnt(5)
v_mfma_f32_16x16x32_bf16 a[16:19], v[160:163], v[212:215], a[16:19]
ds_read_b64_tr_b16 v[210:211], v14 offset:2560
v_add_f32 v225, v229, v236
v_mfma_f32_16x16x32_bf16 a[20:23], v[164:167], v[212:215], a[20:23]
v_cvt_pk_bf16_f32 v34, v236, v237
buffer_load_dwordx4 v241, s[16:19], s6 offen sc1 lds
s_add_u32 m0, s28, 8192
v_mfma_f32_16x16x32_bf16 a[24:27], v[168:171], v[212:215], a[24:27]
v_exp_f32 v239, v151
v_mfma_f32_16x16x32_bf16 a[28:31], v[172:175], v[212:215], a[28:31]
ds_read_b64_tr_b16 v[212:213], v13 offset:512
s_waitcnt lgkmcnt(5)
v_mfma_f32_16x16x32_bf16 a[32:35], v[8:11], v[216:219], a[32:35]
ds_read_b64_tr_b16 v[214:215], v13 offset:2560
v_add_f32 v225, v225, v237
v_mfma_f32_16x16x32_bf16 a[36:39], v[40:43], v[216:219], a[36:39]
v_add_f32 v225, v225, v238
v_add_f32 v225, v225, v239
v_mfma_f32_16x16x32_bf16 a[40:43], v[72:75], v[216:219], a[40:43]
v_cvt_pk_bf16_f32 v35, v238, v239
buffer_load_dwordx4 v241, s[16:19], s7 offen sc1 lds
s_add_u32 m0, s30, 0
v_mfma_f32_16x16x32_bf16 a[44:47], v[104:107], v[216:219], a[44:47]
ds_read_b64_tr_b16 v[216:217], v13 offset:16896
s_waitcnt lgkmcnt(5)
v_mfma_f32_16x16x32_bf16 a[32:35], v[176:179], v[220:223], a[32:35]
ds_read_b64_tr_b16 v[218:219], v13 offset:18944
buffer_load_dwordx4 v241, s[16:19], s29 offen sc1 lds
s_add_u32 m0, s28, 4096
v_mfma_f32_16x16x32_bf16 a[36:39], v[180:183], v[220:223], a[36:39]
v_exp_f32 v232, v152
v_xor_b32 v241, 0x1040, v241
v_mfma_f32_16x16x32_bf16 a[40:43], v[184:187], v[220:223], a[40:43]
v_exp_f32 v233, v153
v_mfma_f32_16x16x32_bf16 a[44:47], v[188:191], v[220:223], a[44:47]
ds_read_b64_tr_b16 v[220:221], v15 offset:512
s_waitcnt lgkmcnt(5)
v_mfma_f32_16x16x32_bf16 a[32:35], v[160:163], v[208:211], a[32:35]
ds_read_b64_tr_b16 v[222:223], v15 offset:2560
buffer_load_dwordx4 v241, s[16:19], s6 offen sc1 lds
s_add_u32 m0, s28, 12288
v_mfma_f32_16x16x32_bf16 a[36:39], v[164:167], v[208:211], a[36:39]
v_exp_f32 v234, v154
v_mfma_f32_16x16x32_bf16 a[40:43], v[168:171], v[208:211], a[40:43]
v_add_f32 v226, v230, v232
v_cvt_pk_bf16_f32 v66, v232, v233
v_mfma_f32_16x16x32_bf16 a[44:47], v[172:175], v[208:211], a[44:47]
ds_read_b64_tr_b16 v[208:209], v14 offset:16384
s_waitcnt lgkmcnt(5)
v_mfma_f32_16x16x32_bf16 a[48:51], v[8:11], v[212:215], a[48:51]
ds_read_b64_tr_b16 v[210:211], v14 offset:18432
buffer_load_dwordx4 v241, s[16:19], s7 offen sc1 lds
s_add_u32 m0, s30, 4096
v_mfma_f32_16x16x32_bf16 a[52:55], v[40:43], v[212:215], a[52:55]
v_exp_f32 v235, v155
v_mfma_f32_16x16x32_bf16 a[56:59], v[72:75], v[212:215], a[56:59]
v_add_f32 v226, v226, v233
v_add_f32 v226, v226, v234
v_mfma_f32_16x16x32_bf16 a[60:63], v[104:107], v[212:215], a[60:63]
ds_read_b64_tr_b16 v[212:213], v15 offset:16384
s_waitcnt lgkmcnt(5)
v_mfma_f32_16x16x32_bf16 a[48:51], v[176:179], v[216:219], a[48:51]
ds_read_b64_tr_b16 v[214:215], v15 offset:18432
v_add_f32 v226, v226, v235
v_mfma_f32_16x16x32_bf16 a[52:55], v[180:183], v[216:219], a[52:55]
v_cvt_pk_bf16_f32 v67, v234, v235
buffer_load_dwordx4 v241, s[16:19], s29 offen sc1 lds
v_mfma_f32_16x16x32_bf16 a[56:59], v[184:187], v[216:219], a[56:59]
v_exp_f32 v236, v156
v_mfma_f32_16x16x32_bf16 a[60:63], v[188:191], v[216:219], a[60:63]
ds_read_b64_tr_b16 v[216:217], v14 offset:16896
s_waitcnt lgkmcnt(5)
v_mfma_f32_16x16x32_bf16 a[48:51], v[160:163], v[220:223], a[48:51]
ds_read_b64_tr_b16 v[218:219], v14 offset:18944
v_mfma_f32_16x16x32_bf16 a[52:55], v[164:167], v[220:223], a[52:55]
v_exp_f32 v237, v157
v_mfma_f32_16x16x32_bf16 a[56:59], v[168:171], v[220:223], a[56:59]
v_exp_f32 v238, v158
v_add_f32 v227, v231, v236
v_cvt_pk_bf16_f32 v98, v236, v237
v_exp_f32 v239, v159
v_add_f32 v227, v227, v237
v_add_f32 v227, v227, v238
v_add_f32 v227, v227, v239
v_cvt_pk_bf16_f32 v99, v238, v239
v_max3_f32 v242, v224, v225, v226
v_max_f32 v242, v242, v227
v_cmp_lt_f32 vcc, s32, v242
s_cbranch_vccnz L2_rare_site19
L2_ret19:
v_mfma_f32_16x16x32_bf16 a[60:63], v[172:175], v[220:223], a[60:63]
ds_read_b64_tr_b16 v[220:221], v15 offset:16896
s_waitcnt lgkmcnt(5)
v_mfma_f32_16x16x32_bf16 a[0:3], v[0:3], v[208:211], a[0:3]
ds_read_b64_tr_b16 v[222:223], v15 offset:18944
v_bfe_u32 v242, v248, 8, 1
v_mul_u32_u24 v242, 48, v242
v_mfma_f32_16x16x32_bf16 a[4:7], v[32:35], v[208:211], a[4:7]
v_lshl_add_u32 v242, s37, 3, v242
v_and_b32 v243, 0xf0, v248
v_lshl_add_u32 v242, v243, 3, v242
v_mfma_f32_16x16x32_bf16 a[8:11], v[64:67], v[208:211], a[8:11]
v_mov_b32 v232, v224
v_mov_b32 v234, v225
v_mov_b32 v236, v226
v_mfma_f32_16x16x32_bf16 a[12:15], v[96:99], v[208:211], a[12:15]
ds_read_b64_tr_b16 v[208:209], v249 offset:20480
s_waitcnt lgkmcnt(5)
v_mov_b32 v238, v227
v_mfma_f32_16x16x32_bf16 a[16:19], v[0:3], v[212:215], a[16:19]
ds_read_b64_tr_b16 v[210:211], v249 offset:22528
v_permlane32_swap_b32 v224, v232
v_permlane32_swap_b32 v225, v234
v_mfma_f32_16x16x32_bf16 a[20:23], v[32:35], v[212:215], a[20:23]
v_permlane32_swap_b32 v226, v236
v_permlane32_swap_b32 v227, v238
v_add_f32 v224, v224, v232
v_mfma_f32_16x16x32_bf16 a[24:27], v[64:67], v[212:215], a[24:27]
v_add_f32 v225, v225, v234
v_add_f32 v226, v226, v236
v_add_f32 v227, v227, v238
v_mfma_f32_16x16x32_bf16 a[28:31], v[96:99], v[212:215], a[28:31]
ds_read_b64_tr_b16 v[212:213], v12 offset:4096
s_waitcnt lgkmcnt(5)
v_mov_b32 v232, v224
v_mfma_f32_16x16x32_bf16 a[32:35], v[0:3], v[216:219], a[32:35]
ds_read_b64_tr_b16 v[214:215], v12 offset:6144
v_mov_b32 v234, v225
v_mov_b32 v236, v226
v_mfma_f32_16x16x32_bf16 a[36:39], v[32:35], v[216:219], a[36:39]
v_mov_b32 v238, v227
v_permlane16_swap_b32 v224, v232
v_permlane16_swap_b32 v225, v234
v_mfma_f32_16x16x32_bf16 a[40:43], v[64:67], v[216:219], a[40:43]
v_permlane16_swap_b32 v226, v236
v_permlane16_swap_b32 v227, v238
v_add_f32 v233, v224, v232
v_mfma_f32_16x16x32_bf16 a[44:47], v[96:99], v[216:219], a[44:47]
ds_read_b64_tr_b16 v[216:217], v12 offset:20480
s_waitcnt lgkmcnt(5)
v_add_f32 v235, v225, v234
v_mfma_f32_16x16x32_bf16 a[48:51], v[0:3], v[220:223], a[48:51]
ds_read_b64_tr_b16 v[218:219], v12 offset:22528
v_add_f32 v237, v226, v236
v_add_f32 v239, v227, v238
v_mfma_f32_16x16x32_bf16 a[52:55], v[32:35], v[220:223], a[52:55]
v_mov_b32 v232, v244
v_mov_b32 v234, v245
v_mov_b32 v236, v246
v_mfma_f32_16x16x32_bf16 a[56:59], v[64:67], v[220:223], a[56:59]
v_mov_b32 v238, v247
v_mfma_f32_16x16x32_bf16 a[60:63], v[96:99], v[220:223], a[60:63]
ds_read_b64_tr_b16 v[220:221], v14 offset:4096
s_waitcnt lgkmcnt(5)
v_mfma_f32_16x16x32_bf16 a[64:67], v[4:7], v[208:211], a[64:67]
ds_read_b64_tr_b16 v[222:223], v14 offset:6144
v_mfma_f32_16x16x32_bf16 a[68:71], v[36:39], v[208:211], a[68:71]
s_mov_b32 exec_hi, 0
buffer_store_dwordx2 v[232:233], v242, s[24:27], s48 offen sc1
s_lshr_b32 s3, s41, 2
buffer_store_dwordx2 v[234:235], v242, s[24:27], s3 offen sc1
s_lshr_b32 s3, s42, 2
buffer_store_dwordx2 v[236:237], v242, s[24:27], s3 offen sc1
s_lshr_b32 s3, s43, 2
buffer_store_dwordx2 v[238:239], v242, s[24:27], s3 offen sc1
s_mov_b32 exec_hi, -1
v_mfma_f32_16x16x32_bf16 a[72:75], v[68:71], v[208:211], a[72:75]
v_accvgpr_read_b32 v128, a0
v_accvgpr_read_b32 v129, a1
v_accvgpr_read_b32 v130, a2
v_mfma_f32_16x16x32_bf16 a[76:79], v[100:103], v[208:211], a[76:79]
ds_read_b64_tr_b16 v[208:209], v14 offset:20480
s_waitcnt lgkmcnt(5)
v_accvgpr_read_b32 v131, a3
v_mfma_f32_16x16x32_bf16 a[64:67], v[8:11], v[212:215], a[64:67]
ds_read_b64_tr_b16 v[210:211], v14 offset:22528
v_cvt_pk_bf16_f32 v16, v128, v129
v_cvt_pk_bf16_f32 v17, v130, v131
v_mfma_f32_16x16x32_bf16 a[68:71], v[40:43], v[212:215], a[68:71]
v_accvgpr_read_b32 v136, a4
v_accvgpr_read_b32 v137, a5
v_accvgpr_read_b32 v138, a6
v_mfma_f32_16x16x32_bf16 a[72:75], v[72:75], v[212:215], a[72:75]
v_accvgpr_read_b32 v139, a7
v_cvt_pk_bf16_f32 v48, v136, v137
v_cvt_pk_bf16_f32 v49, v138, v139
v_mfma_f32_16x16x32_bf16 a[76:79], v[104:107], v[212:215], a[76:79]
ds_read_b64_tr_b16 v[212:213], v250 offset:20480
s_waitcnt lgkmcnt(5)
v_accvgpr_read_b32 v144, a8
v_mfma_f32_16x16x32_bf16 a[64:67], v[176:179], v[216:219], a[64:67]
ds_read_b64_tr_b16 v[214:215], v250 offset:22528
v_accvgpr_read_b32 v145, a9
v_accvgpr_read_b32 v146, a10
v_mfma_f32_16x16x32_bf16 a[68:71], v[180:183], v[216:219], a[68:71]
v_accvgpr_read_b32 v147, a11
v_cvt_pk_bf16_f32 v80, v144, v145
v_cvt_pk_bf16_f32 v81, v146, v147
v_mfma_f32_16x16x32_bf16 a[72:75], v[184:187], v[216:219], a[72:75]
v_accvgpr_read_b32 v152, a12
v_accvgpr_read_b32 v153, a13
v_accvgpr_read_b32 v154, a14
v_mfma_f32_16x16x32_bf16 a[76:79], v[188:191], v[216:219], a[76:79]
ds_read_b64_tr_b16 v[216:217], v13 offset:4096
s_waitcnt lgkmcnt(5)
v_accvgpr_read_b32 v155, a15
v_mfma_f32_16x16x32_bf16 a[64:67], v[160:163], v[220:223], a[64:67]
ds_read_b64_tr_b16 v[218:219], v13 offset:6144
v_cvt_pk_bf16_f32 v112, v152, v153
v_cvt_pk_bf16_f32 v113, v154, v155
v_mfma_f32_16x16x32_bf16 a[68:71], v[164:167], v[220:223], a[68:71]
v_accvgpr_read_b32 v132, a16
v_accvgpr_read_b32 v133, a17
v_accvgpr_read_b32 v134, a18
v_mfma_f32_16x16x32_bf16 a[72:75], v[168:171], v[220:223], a[72:75]
v_accvgpr_read_b32 v135, a19
v_cvt_pk_bf16_f32 v18, v132, v133
v_cvt_pk_bf16_f32 v19, v134, v135
v_mfma_f32_16x16x32_bf16 a[76:79], v[172:175], v[220:223], a[76:79]
ds_read_b64_tr_b16 v[220:221], v13 offset:20480
s_waitcnt lgkmcnt(5)
buffer_store_dwordx4 v[16:19], v248, s[20:23], s40 offen offset:0 sc1
v_mfma_f32_16x16x32_bf16 a[64:67], v[0:3], v[208:211], a[64:67]
ds_read_b64_tr_b16 v[222:223], v13 offset:22528
ds_write_b128 v253, v[16:19] offset:0
v_accvgpr_read_b32 v140, a20
v_mfma_f32_16x16x32_bf16 a[68:71], v[32:35], v[208:211], a[68:71]
v_accvgpr_read_b32 v141, a21
v_accvgpr_read_b32 v142, a22
v_accvgpr_read_b32 v143, a23
v_mfma_f32_16x16x32_bf16 a[72:75], v[64:67], v[208:211], a[72:75]
v_cvt_pk_bf16_f32 v50, v140, v141
v_cvt_pk_bf16_f32 v51, v142, v143
buffer_store_dwordx4 v[48:51], v248, s[20:23], s41 offen offset:0 sc1
v_mfma_f32_16x16x32_bf16 a[76:79], v[96:99], v[208:211], a[76:79]
ds_read_b64_tr_b16 v[208:209], v15 offset:4096
s_waitcnt lgkmcnt(5)
v_accvgpr_read_b32 v148, a24
v_mfma_f32_16x16x32_bf16 a[80:83], v[4:7], v[212:215], a[80:83]
ds_read_b64_tr_b16 v[210:211], v15 offset:6144
v_accvgpr_read_b32 v149, a25
v_accvgpr_read_b32 v150, a26
v_mfma_f32_16x16x32_bf16 a[84:87], v[36:39], v[212:215], a[84:87]
v_accvgpr_read_b32 v151, a27
v_cvt_pk_bf16_f32 v82, v148, v149
v_cvt_pk_bf16_f32 v83, v150, v151
v_mfma_f32_16x16x32_bf16 a[88:91], v[68:71], v[212:215], a[88:91]
buffer_store_dwordx4 v[80:83], v248, s[20:23], s42 offen offset:0 sc1
v_accvgpr_read_b32 v156, a28
v_accvgpr_read_b32 v157, a29
v_mfma_f32_16x16x32_bf16 a[92:95], v[100:103], v[212:215], a[92:95]
ds_read_b64_tr_b16 v[212:213], v15 offset:20480
s_waitcnt lgkmcnt(5)
v_accvgpr_read_b32 v158, a30
v_mfma_f32_16x16x32_bf16 a[80:83], v[8:11], v[216:219], a[80:83]
ds_read_b64_tr_b16 v[214:215], v15 offset:22528
v_accvgpr_read_b32 v159, a31
v_cvt_pk_bf16_f32 v114, v156, v157
v_mfma_f32_16x16x32_bf16 a[84:87], v[40:43], v[216:219], a[84:87]
v_cvt_pk_bf16_f32 v115, v158, v159
buffer_store_dwordx4 v[112:115], v248, s[20:23], s43 offen offset:0 sc1
v_accvgpr_read_b32 v128, a32
v_mfma_f32_16x16x32_bf16 a[88:91], v[72:75], v[216:219], a[88:91]
v_accvgpr_read_b32 v129, a33
v_accvgpr_read_b32 v130, a34
v_accvgpr_read_b32 v131, a35
v_mfma_f32_16x16x32_bf16 a[92:95], v[104:107], v[216:219], a[92:95]
ds_read_b64_tr_b16 v[216:217], v249 offset:20992
s_waitcnt lgkmcnt(5)
v_cvt_pk_bf16_f32 v20, v128, v129
v_mfma_f32_16x16x32_bf16 a[80:83], v[176:179], v[220:223], a[80:83]
ds_read_b64_tr_b16 v[218:219], v249 offset:23040
v_cvt_pk_bf16_f32 v21, v130, v131
v_accvgpr_read_b32 v136, a36
v_mfma_f32_16x16x32_bf16 a[84:87], v[180:183], v[220:223], a[84:87]
v_accvgpr_read_b32 v137, a37
v_accvgpr_read_b32 v138, a38
v_accvgpr_read_b32 v139, a39
v_mfma_f32_16x16x32_bf16 a[88:91], v[184:187], v[220:223], a[88:91]
v_cvt_pk_bf16_f32 v52, v136, v137
v_cvt_pk_bf16_f32 v53, v138, v139
v_accvgpr_read_b32 v144, a40
v_mfma_f32_16x16x32_bf16 a[92:95], v[188:191], v[220:223], a[92:95]
ds_read_b64_tr_b16 v[220:221], v12 offset:4608
s_waitcnt lgkmcnt(5)
v_accvgpr_read_b32 v145, a41
v_mfma_f32_16x16x32_bf16 a[80:83], v[160:163], v[208:211], a[80:83]
ds_read_b64_tr_b16 v[222:223], v12 offset:6656
v_accvgpr_read_b32 v146, a42
v_accvgpr_read_b32 v147, a43
v_mfma_f32_16x16x32_bf16 a[84:87], v[164:167], v[208:211], a[84:87]
v_cvt_pk_bf16_f32 v84, v144, v145
v_cvt_pk_bf16_f32 v85, v146, v147
v_accvgpr_read_b32 v152, a44
v_mfma_f32_16x16x32_bf16 a[88:91], v[168:171], v[208:211], a[88:91]
v_accvgpr_read_b32 v153, a45
v_accvgpr_read_b32 v154, a46
v_accvgpr_read_b32 v155, a47
v_mfma_f32_16x16x32_bf16 a[92:95], v[172:175], v[208:211], a[92:95]
ds_read_b64_tr_b16 v[208:209], v12 offset:20992
s_waitcnt lgkmcnt(5)
v_cvt_pk_bf16_f32 v116, v152, v153
v_mfma_f32_16x16x32_bf16 a[80:83], v[0:3], v[212:215], a[80:83]
ds_read_b64_tr_b16 v[210:211], v12 offset:23040
v_cvt_pk_bf16_f32 v117, v154, v155
v_accvgpr_read_b32 v132, a48
v_mfma_f32_16x16x32_bf16 a[84:87], v[32:35], v[212:215], a[84:87]
v_accvgpr_read_b32 v133, a49
v_accvgpr_read_b32 v134, a50
v_accvgpr_read_b32 v135, a51
v_mfma_f32_16x16x32_bf16 a[88:91], v[64:67], v[212:215], a[88:91]
v_cvt_pk_bf16_f32 v22, v132, v133
v_cvt_pk_bf16_f32 v23, v134, v135
buffer_store_dwordx4 v[20:23], v248, s[20:23], s40 offen offset:1024 sc1
v_mfma_f32_16x16x32_bf16 a[92:95], v[96:99], v[212:215], a[92:95]
ds_read_b64_tr_b16 v[212:213], v14 offset:4608
s_waitcnt lgkmcnt(5)
ds_write_b128 v253, v[20:23] offset:1024
v_mfma_f32_16x16x32_bf16 a[96:99], v[4:7], v[216:219], a[96:99]
ds_read_b64_tr_b16 v[214:215], v14 offset:6656
v_accvgpr_read_b32 v140, a52
v_accvgpr_read_b32 v141, a53
v_mfma_f32_16x16x32_bf16 a[100:103], v[36:39], v[216:219], a[100:103]
v_accvgpr_read_b32 v142, a54
v_accvgpr_read_b32 v143, a55
v_cvt_pk_bf16_f32 v54, v140, v141
v_mfma_f32_16x16x32_bf16 a[104:107], v[68:71], v[216:219], a[104:107]
v_cvt_pk_bf16_f32 v55, v142, v143
buffer_store_dwordx4 v[52:55], v248, s[20:23], s41 offen offset:1024 sc1
v_accvgpr_read_b32 v148, a56
v_mfma_f32_16x16x32_bf16 a[108:111], v[100:103], v[216:219], a[108:111]
ds_read_b64_tr_b16 v[216:217], v14 offset:20992
s_waitcnt lgkmcnt(5)
v_accvgpr_read_b32 v149, a57
v_mfma_f32_16x16x32_bf16 a[96:99], v[8:11], v[220:223], a[96:99]
ds_read_b64_tr_b16 v[218:219], v14 offset:23040
v_accvgpr_read_b32 v150, a58
v_accvgpr_read_b32 v151, a59
v_mfma_f32_16x16x32_bf16 a[100:103], v[40:43], v[220:223], a[100:103]
v_cvt_pk_bf16_f32 v86, v148, v149
v_cvt_pk_bf16_f32 v87, v150, v151
buffer_store_dwordx4 v[84:87], v248, s[20:23], s42 offen offset:1024 sc1
v_mfma_f32_16x16x32_bf16 a[104:107], v[72:75], v[220:223], a[104:107]
v_accvgpr_read_b32 v156, a60
v_accvgpr_read_b32 v157, a61
v_accvgpr_read_b32 v158, a62
v_mfma_f32_16x16x32_bf16 a[108:111], v[104:107], v[220:223], a[108:111]
ds_read_b64_tr_b16 v[220:221], v250 offset:20992
s_waitcnt lgkmcnt(5)
v_accvgpr_read_b32 v159, a63
v_mfma_f32_16x16x32_bf16 a[96:99], v[176:179], v[208:211], a[96:99]
ds_read_b64_tr_b16 v[222:223], v250 offset:23040
v_cvt_pk_bf16_f32 v118, v156, v157
v_cvt_pk_bf16_f32 v119, v158, v159
v_mfma_f32_16x16x32_bf16 a[100:103], v[180:183], v[208:211], a[100:103]
buffer_store_dwordx4 v[116:119], v248, s[20:23], s43 offen offset:1024 sc1
v_accvgpr_read_b32 v128, a64
v_accvgpr_read_b32 v129, a65
v_mfma_f32_16x16x32_bf16 a[104:107], v[184:187], v[208:211], a[104:107]
v_accvgpr_read_b32 v130, a66
v_accvgpr_read_b32 v131, a67
v_cvt_pk_bf16_f32 v24, v128, v129
v_mfma_f32_16x16x32_bf16 a[108:111], v[188:191], v[208:211], a[108:111]
ds_read_b64_tr_b16 v[208:209], v13 offset:4608
s_waitcnt lgkmcnt(5)
v_cvt_pk_bf16_f32 v25, v130, v131
v_mfma_f32_16x16x32_bf16 a[96:99], v[160:163], v[212:215], a[96:99]
ds_read_b64_tr_b16 v[210:211], v13 offset:6656
v_accvgpr_read_b32 v136, a68
v_accvgpr_read_b32 v137, a69
v_mfma_f32_16x16x32_bf16 a[100:103], v[164:167], v[212:215], a[100:103]
v_accvgpr_read_b32 v138, a70
v_accvgpr_read_b32 v139, a71
v_cvt_pk_bf16_f32 v56, v136, v137
v_mfma_f32_16x16x32_bf16 a[104:107], v[168:171], v[212:215], a[104:107]
v_cvt_pk_bf16_f32 v57, v138, v139
v_accvgpr_read_b32 v144, a72
v_accvgpr_read_b32 v145, a73
v_mfma_f32_16x16x32_bf16 a[108:111], v[172:175], v[212:215], a[108:111]
ds_read_b64_tr_b16 v[212:213], v13 offset:20992
s_waitcnt lgkmcnt(5)
v_accvgpr_read_b32 v146, a74
v_mfma_f32_16x16x32_bf16 a[96:99], v[0:3], v[216:219], a[96:99]
ds_read_b64_tr_b16 v[214:215], v13 offset:23040
v_accvgpr_read_b32 v147, a75
v_cvt_pk_bf16_f32 v88, v144, v145
v_mfma_f32_16x16x32_bf16 a[100:103], v[32:35], v[216:219], a[100:103]
v_cvt_pk_bf16_f32 v89, v146, v147
v_accvgpr_read_b32 v152, a76
v_accvgpr_read_b32 v153, a77
v_mfma_f32_16x16x32_bf16 a[104:107], v[64:67], v[216:219], a[104:107]
v_accvgpr_read_b32 v154, a78
v_accvgpr_read_b32 v155, a79
v_cvt_pk_bf16_f32 v120, v152, v153
v_mfma_f32_16x16x32_bf16 a[108:111], v[96:99], v[216:219], a[108:111]
ds_read_b64_tr_b16 v[216:217], v15 offset:4608
s_waitcnt lgkmcnt(5)
v_cvt_pk_bf16_f32 v121, v154, v155
v_mfma_f32_16x16x32_bf16 a[112:115], v[4:7], v[220:223], a[112:115]
ds_read_b64_tr_b16 v[218:219], v15 offset:6656
v_accvgpr_read_b32 v132, a80
v_accvgpr_read_b32 v133, a81
v_mfma_f32_16x16x32_bf16 a[116:119], v[36:39], v[220:223], a[116:119]
v_accvgpr_read_b32 v134, a82
v_accvgpr_read_b32 v135, a83
v_cvt_pk_bf16_f32 v26, v132, v133
v_mfma_f32_16x16x32_bf16 a[120:123], v[68:71], v[220:223], a[120:123]
v_cvt_pk_bf16_f32 v27, v134, v135
buffer_store_dwordx4 v[24:27], v248, s[20:23], s40 offen offset:2048 sc1
ds_write_b128 v253, v[24:27] offset:2048
v_mfma_f32_16x16x32_bf16 a[124:127], v[100:103], v[220:223], a[124:127]
ds_read_b64_tr_b16 v[220:221], v15 offset:20992
s_waitcnt lgkmcnt(5)
v_accvgpr_read_b32 v140, a84
v_mfma_f32_16x16x32_bf16 a[112:115], v[8:11], v[208:211], a[112:115]
ds_read_b64_tr_b16 v[222:223], v15 offset:23040
v_accvgpr_read_b32 v141, a85
v_accvgpr_read_b32 v142, a86
v_mfma_f32_16x16x32_bf16 a[116:119], v[40:43], v[208:211], a[116:119]
v_accvgpr_read_b32 v143, a87
v_cvt_pk_bf16_f32 v58, v140, v141
v_cvt_pk_bf16_f32 v59, v142, v143
v_mfma_f32_16x16x32_bf16 a[120:123], v[72:75], v[208:211], a[120:123]
buffer_store_dwordx4 v[56:59], v248, s[20:23], s41 offen offset:2048 sc1
v_accvgpr_read_b32 v148, a88
v_accvgpr_read_b32 v149, a89
v_mfma_f32_16x16x32_bf16 a[124:127], v[104:107], v[208:211], a[124:127]
ds_read_b64_tr_b16 v[208:209], v249 offset:24576
s_waitcnt lgkmcnt(5)
v_accvgpr_read_b32 v150, a90
v_mfma_f32_16x16x32_bf16 a[112:115], v[176:179], v[212:215], a[112:115]
ds_read_b64_tr_b16 v[210:211], v249 offset:26624
v_accvgpr_read_b32 v151, a91
v_cvt_pk_bf16_f32 v90, v148, v149
v_mfma_f32_16x16x32_bf16 a[116:119], v[180:183], v[212:215], a[116:119]
v_cvt_pk_bf16_f32 v91, v150, v151
buffer_store_dwordx4 v[88:91], v248, s[20:23], s42 offen offset:2048 sc1
v_accvgpr_read_b32 v156, a92
v_mfma_f32_16x16x32_bf16 a[120:123], v[184:187], v[212:215], a[120:123]
v_accvgpr_read_b32 v157, a93
v_accvgpr_read_b32 v158, a94
v_accvgpr_read_b32 v159, a95
v_mfma_f32_16x16x32_bf16 a[124:127], v[188:191], v[212:215], a[124:127]
ds_read_b64_tr_b16 v[212:213], v12 offset:8192
s_waitcnt lgkmcnt(5)
v_cvt_pk_bf16_f32 v122, v156, v157
v_mfma_f32_16x16x32_bf16 a[112:115], v[160:163], v[216:219], a[112:115]
ds_read_b64_tr_b16 v[214:215], v12 offset:10240
v_cvt_pk_bf16_f32 v123, v158, v159
buffer_store_dwordx4 v[120:123], v248, s[20:23], s43 offen offset:2048 sc1
v_mfma_f32_16x16x32_bf16 a[116:119], v[164:167], v[216:219], a[116:119]
v_accvgpr_read_b32 v128, a96
v_accvgpr_read_b32 v129, a97
v_mfma_f32_16x16x32_bf16 a[120:123], v[168:171], v[216:219], a[120:123]
v_accvgpr_read_b32 v130, a98
v_accvgpr_read_b32 v131, a99
v_mfma_f32_16x16x32_bf16 a[124:127], v[172:175], v[216:219], a[124:127]
ds_read_b64_tr_b16 v[216:217], v12 offset:24576
s_waitcnt lgkmcnt(5)
v_mfma_f32_16x16x32_bf16 a[112:115], v[0:3], v[220:223], a[112:115]
ds_read_b64_tr_b16 v[218:219], v12 offset:26624
v_cvt_pk_bf16_f32 v28, v128, v129
v_mfma_f32_16x16x32_bf16 a[116:119], v[32:35], v[220:223], a[116:119]
v_cvt_pk_bf16_f32 v29, v130, v131
v_accvgpr_read_b32 v136, a100
v_mfma_f32_16x16x32_bf16 a[120:123], v[64:67], v[220:223], a[120:123]
v_accvgpr_read_b32 v137, a101
v_accvgpr_read_b32 v138, a102
v_mfma_f32_16x16x32_bf16 a[124:127], v[96:99], v[220:223], a[124:127]
ds_read_b64_tr_b16 v[220:221], v14 offset:8192
s_waitcnt lgkmcnt(5)
v_mfma_f32_16x16x32_bf16 a[128:131], v[4:7], v[208:211], a[128:131]
ds_read_b64_tr_b16 v[222:223], v14 offset:10240
v_accvgpr_read_b32 v139, a103
v_mfma_f32_16x16x32_bf16 a[132:135], v[36:39], v[208:211], a[132:135]
v_cvt_pk_bf16_f32 v60, v136, v137
v_cvt_pk_bf16_f32 v61, v138, v139
v_mfma_f32_16x16x32_bf16 a[136:139], v[68:71], v[208:211], a[136:139]
v_accvgpr_read_b32 v144, a104
v_accvgpr_read_b32 v145, a105
v_mfma_f32_16x16x32_bf16 a[140:143], v[100:103], v[208:211], a[140:143]
ds_read_b64_tr_b16 v[208:209], v14 offset:24576
s_waitcnt lgkmcnt(5)
v_mfma_f32_16x16x32_bf16 a[128:131], v[8:11], v[212:215], a[128:131]
ds_read_b64_tr_b16 v[210:211], v14 offset:26624
v_accvgpr_read_b32 v146, a106
v_mfma_f32_16x16x32_bf16 a[132:135], v[40:43], v[212:215], a[132:135]
v_accvgpr_read_b32 v147, a107
v_cvt_pk_bf16_f32 v92, v144, v145
v_mfma_f32_16x16x32_bf16 a[136:139], v[72:75], v[212:215], a[136:139]
v_cvt_pk_bf16_f32 v93, v146, v147
v_accvgpr_read_b32 v152, a108
v_mfma_f32_16x16x32_bf16 a[140:143], v[104:107], v[212:215], a[140:143]
ds_read_b64_tr_b16 v[212:213], v250 offset:24576
s_waitcnt lgkmcnt(5)
v_mfma_f32_16x16x32_bf16 a[128:131], v[176:179], v[216:219], a[128:131]
ds_read_b64_tr_b16 v[214:215], v250 offset:26624
v_accvgpr_read_b32 v153, a109
v_mfma_f32_16x16x32_bf16 a[132:135], v[180:183], v[216:219], a[132:135]
v_accvgpr_read_b32 v154, a110
v_accvgpr_read_b32 v155, a111
v_mfma_f32_16x16x32_bf16 a[136:139], v[184:187], v[216:219], a[136:139]
v_cvt_pk_bf16_f32 v124, v152, v153
v_cvt_pk_bf16_f32 v125, v154, v155
v_mfma_f32_16x16x32_bf16 a[140:143], v[188:191], v[216:219], a[140:143]
ds_read_b64_tr_b16 v[216:217], v13 offset:8192
s_waitcnt lgkmcnt(5)
v_mfma_f32_16x16x32_bf16 a[128:131], v[160:163], v[220:223], a[128:131]
ds_read_b64_tr_b16 v[218:219], v13 offset:10240
v_accvgpr_read_b32 v132, a112
v_mfma_f32_16x16x32_bf16 a[132:135], v[164:167], v[220:223], a[132:135]
v_accvgpr_read_b32 v133, a113
v_accvgpr_read_b32 v134, a114
v_mfma_f32_16x16x32_bf16 a[136:139], v[168:171], v[220:223], a[136:139]
v_accvgpr_read_b32 v135, a115
v_cvt_pk_bf16_f32 v30, v132, v133
v_mfma_f32_16x16x32_bf16 a[140:143], v[172:175], v[220:223], a[140:143]
ds_read_b64_tr_b16 v[220:221], v13 offset:24576
s_waitcnt lgkmcnt(5)
v_mfma_f32_16x16x32_bf16 a[128:131], v[0:3], v[208:211], a[128:131]
ds_read_b64_tr_b16 v[222:223], v13 offset:26624
v_cvt_pk_bf16_f32 v31, v134, v135
v_mfma_f32_16x16x32_bf16 a[132:135], v[32:35], v[208:211], a[132:135]
buffer_store_dwordx4 v[28:31], v248, s[20:23], s40 offen offset:3072 sc1
ds_write_b128 v253, v[28:31] offset:3072
v_mfma_f32_16x16x32_bf16 a[136:139], v[64:67], v[208:211], a[136:139]
v_accvgpr_read_b32 v140, a116
v_accvgpr_read_b32 v141, a117
v_mfma_f32_16x16x32_bf16 a[140:143], v[96:99], v[208:211], a[140:143]
ds_read_b64_tr_b16 v[208:209], v15 offset:8192
s_waitcnt lgkmcnt(5)
v_mfma_f32_16x16x32_bf16 a[144:147], v[4:7], v[212:215], a[144:147]
ds_read_b64_tr_b16 v[210:211], v15 offset:10240
v_accvgpr_read_b32 v142, a118
v_mfma_f32_16x16x32_bf16 a[148:151], v[36:39], v[212:215], a[148:151]
v_accvgpr_read_b32 v143, a119
v_cvt_pk_bf16_f32 v62, v140, v141
v_mfma_f32_16x16x32_bf16 a[152:155], v[68:71], v[212:215], a[152:155]
v_cvt_pk_bf16_f32 v63, v142, v143
buffer_store_dwordx4 v[60:63], v248, s[20:23], s41 offen offset:3072 sc1
v_mfma_f32_16x16x32_bf16 a[156:159], v[100:103], v[212:215], a[156:159]
ds_read_b64_tr_b16 v[212:213], v15 offset:24576
s_waitcnt lgkmcnt(5)
v_mfma_f32_16x16x32_bf16 a[144:147], v[8:11], v[216:219], a[144:147]
ds_read_b64_tr_b16 v[214:215], v15 offset:26624
v_accvgpr_read_b32 v148, a120
v_mfma_f32_16x16x32_bf16 a[148:151], v[40:43], v[216:219], a[148:151]
v_accvgpr_read_b32 v149, a121
v_accvgpr_read_b32 v150, a122
v_mfma_f32_16x16x32_bf16 a[152:155], v[72:75], v[216:219], a[152:155]
v_accvgpr_read_b32 v151, a123
v_cvt_pk_bf16_f32 v94, v148, v149
v_mfma_f32_16x16x32_bf16 a[156:159], v[104:107], v[216:219], a[156:159]
ds_read_b64_tr_b16 v[216:217], v249 offset:25088
s_waitcnt lgkmcnt(5)
v_mfma_f32_16x16x32_bf16 a[144:147], v[176:179], v[220:223], a[144:147]
ds_read_b64_tr_b16 v[218:219], v249 offset:27136
v_cvt_pk_bf16_f32 v95, v150, v151
v_mfma_f32_16x16x32_bf16 a[148:151], v[180:183], v[220:223], a[148:151]
buffer_store_dwordx4 v[92:95], v248, s[20:23], s42 offen offset:3072 sc1
v_accvgpr_read_b32 v156, a124
v_mfma_f32_16x16x32_bf16 a[152:155], v[184:187], v[220:223], a[152:155]
v_accvgpr_read_b32 v157, a125
v_accvgpr_read_b32 v158, a126
v_mfma_f32_16x16x32_bf16 a[156:159], v[188:191], v[220:223], a[156:159]
ds_read_b64_tr_b16 v[220:221], v12 offset:8704
s_waitcnt lgkmcnt(5)
v_mfma_f32_16x16x32_bf16 a[144:147], v[160:163], v[208:211], a[144:147]
ds_read_b64_tr_b16 v[222:223], v12 offset:10752
v_accvgpr_read_b32 v159, a127
v_mfma_f32_16x16x32_bf16 a[148:151], v[164:167], v[208:211], a[148:151]
v_cvt_pk_bf16_f32 v126, v156, v157
v_cvt_pk_bf16_f32 v127, v158, v159
v_mfma_f32_16x16x32_bf16 a[152:155], v[168:171], v[208:211], a[152:155]
buffer_store_dwordx4 v[124:127], v248, s[20:23], s43 offen offset:3072 sc1
v_accvgpr_read_b32 v128, a128
v_mfma_f32_16x16x32_bf16 a[156:159], v[172:175], v[208:211], a[156:159]
ds_read_b64_tr_b16 v[208:209], v12 offset:25088
s_waitcnt lgkmcnt(5)
v_mfma_f32_16x16x32_bf16 a[144:147], v[0:3], v[212:215], a[144:147]
ds_read_b64_tr_b16 v[210:211], v12 offset:27136
v_accvgpr_read_b32 v129, a129
v_mfma_f32_16x16x32_bf16 a[148:151], v[32:35], v[212:215], a[148:151]
v_accvgpr_read_b32 v130, a130
v_accvgpr_read_b32 v131, a131
v_mfma_f32_16x16x32_bf16 a[152:155], v[64:67], v[212:215], a[152:155]
v_cvt_pk_bf16_f32 v16, v128, v129
v_cvt_pk_bf16_f32 v17, v130, v131
v_mfma_f32_16x16x32_bf16 a[156:159], v[96:99], v[212:215], a[156:159]
ds_read_b64_tr_b16 v[212:213], v14 offset:8704
s_waitcnt lgkmcnt(5)
v_mfma_f32_16x16x32_bf16 a[160:163], v[4:7], v[216:219], a[160:163]
ds_read_b64_tr_b16 v[214:215], v14 offset:10752
v_accvgpr_read_b32 v136, a132
v_mfma_f32_16x16x32_bf16 a[164:167], v[36:39], v[216:219], a[164:167]
v_accvgpr_read_b32 v137, a133
v_accvgpr_read_b32 v138, a134
v_mfma_f32_16x16x32_bf16 a[168:171], v[68:71], v[216:219], a[168:171]
v_accvgpr_read_b32 v139, a135
v_cvt_pk_bf16_f32 v48, v136, v137
v_mfma_f32_16x16x32_bf16 a[172:175], v[100:103], v[216:219], a[172:175]
ds_read_b64_tr_b16 v[216:217], v14 offset:25088
s_waitcnt lgkmcnt(5)
v_mfma_f32_16x16x32_bf16 a[160:163], v[8:11], v[220:223], a[160:163]
ds_read_b64_tr_b16 v[218:219], v14 offset:27136
v_cvt_pk_bf16_f32 v49, v138, v139
v_mfma_f32_16x16x32_bf16 a[164:167], v[40:43], v[220:223], a[164:167]
v_accvgpr_read_b32 v144, a136
v_accvgpr_read_b32 v145, a137
v_mfma_f32_16x16x32_bf16 a[168:171], v[72:75], v[220:223], a[168:171]
v_accvgpr_read_b32 v146, a138
v_accvgpr_read_b32 v147, a139
v_mfma_f32_16x16x32_bf16 a[172:175], v[104:107], v[220:223], a[172:175]
ds_read_b64_tr_b16 v[220:221], v250 offset:25088
s_waitcnt lgkmcnt(5)
v_mfma_f32_16x16x32_bf16 a[160:163], v[176:179], v[208:211], a[160:163]
ds_read_b64_tr_b16 v[222:223], v250 offset:27136
v_cvt_pk_bf16_f32 v80, v144, v145
v_mfma_f32_16x16x32_bf16 a[164:167], v[180:183], v[208:211], a[164:167]
v_cvt_pk_bf16_f32 v81, v146, v147
v_accvgpr_read_b32 v152, a140
v_mfma_f32_16x16x32_bf16 a[168:171], v[184:187], v[208:211], a[168:171]
v_accvgpr_read_b32 v153, a141
v_accvgpr_read_b32 v154, a142
v_mfma_f32_16x16x32_bf16 a[172:175], v[188:191], v[208:211], a[172:175]
ds_read_b64_tr_b16 v[208:209], v13 offset:8704
s_waitcnt lgkmcnt(5)
v_mfma_f32_16x16x32_bf16 a[160:163], v[160:163], v[212:215], a[160:163]
ds_read_b64_tr_b16 v[210:211], v13 offset:10752
v_accvgpr_read_b32 v155, a143
v_mfma_f32_16x16x32_bf16 a[164:167], v[164:167], v[212:215], a[164:167]
v_cvt_pk_bf16_f32 v112, v152, v153
v_cvt_pk_bf16_f32 v113, v154, v155
v_mfma_f32_16x16x32_bf16 a[168:171], v[168:171], v[212:215], a[168:171]
v_accvgpr_read_b32 v132, a144
v_accvgpr_read_b32 v133, a145
v_mfma_f32_16x16x32_bf16 a[172:175], v[172:175], v[212:215], a[172:175]
ds_read_b64_tr_b16 v[212:213], v13 offset:25088
s_waitcnt lgkmcnt(5)
v_mfma_f32_16x16x32_bf16 a[160:163], v[0:3], v[216:219], a[160:163]
ds_read_b64_tr_b16 v[214:215], v13 offset:27136
v_accvgpr_read_b32 v134, a146
v_mfma_f32_16x16x32_bf16 a[164:167], v[32:35], v[216:219], a[164:167]
v_accvgpr_read_b32 v135, a147
v_cvt_pk_bf16_f32 v18, v132, v133
v_mfma_f32_16x16x32_bf16 a[168:171], v[64:67], v[216:219], a[168:171]
v_cvt_pk_bf16_f32 v19, v134, v135
buffer_store_dwordx4 v[16:19], v248, s[20:23], s44 offen offset:0 sc1
v_mfma_f32_16x16x32_bf16 a[172:175], v[96:99], v[216:219], a[172:175]
ds_read_b64_tr_b16 v[216:217], v15 offset:8704
s_waitcnt lgkmcnt(5)
v_mfma_f32_16x16x32_bf16 a[176:179], v[4:7], v[220:223], a[176:179]
ds_read_b64_tr_b16 v[218:219], v15 offset:10752
ds_write_b128 v253, v[16:19] offset:4096
v_mfma_f32_16x16x32_bf16 a[180:183], v[36:39], v[220:223], a[180:183]
v_accvgpr_read_b32 v140, a148
v_accvgpr_read_b32 v141, a149
v_mfma_f32_16x16x32_bf16 a[184:187], v[68:71], v[220:223], a[184:187]
v_accvgpr_read_b32 v142, a150
v_accvgpr_read_b32 v143, a151
v_mfma_f32_16x16x32_bf16 a[188:191], v[100:103], v[220:223], a[188:191]
ds_read_b64_tr_b16 v[220:221], v15 offset:25088
s_waitcnt lgkmcnt(5)
v_mfma_f32_16x16x32_bf16 a[176:179], v[8:11], v[208:211], a[176:179]
ds_read_b64_tr_b16 v[222:223], v15 offset:27136
v_cvt_pk_bf16_f32 v50, v140, v141
v_mfma_f32_16x16x32_bf16 a[180:183], v[40:43], v[208:211], a[180:183]
v_cvt_pk_bf16_f32 v51, v142, v143
buffer_store_dwordx4 v[48:51], v248, s[20:23], s45 offen offset:0 sc1
v_mfma_f32_16x16x32_bf16 a[184:187], v[72:75], v[208:211], a[184:187]
v_accvgpr_read_b32 v148, a152
v_accvgpr_read_b32 v149, a153
v_mfma_f32_16x16x32_bf16 a[188:191], v[104:107], v[208:211], a[188:191]
ds_read_b64_tr_b16 v[208:209], v249 offset:28672
s_waitcnt lgkmcnt(5)
v_mfma_f32_16x16x32_bf16 a[176:179], v[176:179], v[212:215], a[176:179]
ds_read_b64_tr_b16 v[210:211], v249 offset:30720
v_accvgpr_read_b32 v150, a154
v_mfma_f32_16x16x32_bf16 a[180:183], v[180:183], v[212:215], a[180:183]
v_accvgpr_read_b32 v151, a155
v_cvt_pk_bf16_f32 v82, v148, v149
v_mfma_f32_16x16x32_bf16 a[184:187], v[184:187], v[212:215], a[184:187]
v_cvt_pk_bf16_f32 v83, v150, v151
buffer_store_dwordx4 v[80:83], v248, s[20:23], s46 offen offset:0 sc1
v_mfma_f32_16x16x32_bf16 a[188:191], v[188:191], v[212:215], a[188:191]
ds_read_b64_tr_b16 v[212:213], v12 offset:12288
s_waitcnt lgkmcnt(5)
v_mfma_f32_16x16x32_bf16 a[176:179], v[160:163], v[216:219], a[176:179]
ds_read_b64_tr_b16 v[214:215], v12 offset:14336
v_accvgpr_read_b32 v156, a156
v_mfma_f32_16x16x32_bf16 a[180:183], v[164:167], v[216:219], a[180:183]
v_accvgpr_read_b32 v157, a157
v_accvgpr_read_b32 v158, a158
v_mfma_f32_16x16x32_bf16 a[184:187], v[168:171], v[216:219], a[184:187]
v_accvgpr_read_b32 v159, a159
v_cvt_pk_bf16_f32 v114, v156, v157
v_mfma_f32_16x16x32_bf16 a[188:191], v[172:175], v[216:219], a[188:191]
ds_read_b64_tr_b16 v[216:217], v12 offset:28672
s_waitcnt lgkmcnt(5)
v_mfma_f32_16x16x32_bf16 a[176:179], v[0:3], v[220:223], a[176:179]
ds_read_b64_tr_b16 v[218:219], v12 offset:30720
v_cvt_pk_bf16_f32 v115, v158, v159
v_mfma_f32_16x16x32_bf16 a[180:183], v[32:35], v[220:223], a[180:183]
buffer_store_dwordx4 v[112:115], v248, s[20:23], s47 offen offset:0 sc1
v_accvgpr_read_b32 v128, a160
v_mfma_f32_16x16x32_bf16 a[184:187], v[64:67], v[220:223], a[184:187]
v_accvgpr_read_b32 v129, a161
v_accvgpr_read_b32 v130, a162
v_mfma_f32_16x16x32_bf16 a[188:191], v[96:99], v[220:223], a[188:191]
ds_read_b64_tr_b16 v[220:221], v14 offset:12288
s_waitcnt lgkmcnt(5)
v_mfma_f32_16x16x32_bf16 a[192:195], v[4:7], v[208:211], a[192:195]
ds_read_b64_tr_b16 v[222:223], v14 offset:14336
v_accvgpr_read_b32 v131, a163
v_mfma_f32_16x16x32_bf16 a[196:199], v[36:39], v[208:211], a[196:199]
v_cvt_pk_bf16_f32 v20, v128, v129
v_cvt_pk_bf16_f32 v21, v130, v131
v_mfma_f32_16x16x32_bf16 a[200:203], v[68:71], v[208:211], a[200:203]
v_accvgpr_read_b32 v136, a164
v_accvgpr_read_b32 v137, a165
v_mfma_f32_16x16x32_bf16 a[204:207], v[100:103], v[208:211], a[204:207]
ds_read_b64_tr_b16 v[208:209], v14 offset:28672
s_waitcnt lgkmcnt(5)
v_mfma_f32_16x16x32_bf16 a[192:195], v[8:11], v[212:215], a[192:195]
ds_read_b64_tr_b16 v[210:211], v14 offset:30720
v_accvgpr_read_b32 v138, a166
v_mfma_f32_16x16x32_bf16 a[196:199], v[40:43], v[212:215], a[196:199]
v_accvgpr_read_b32 v139, a167
v_cvt_pk_bf16_f32 v52, v136, v137
v_mfma_f32_16x16x32_bf16 a[200:203], v[72:75], v[212:215], a[200:203]
v_cvt_pk_bf16_f32 v53, v138, v139
v_accvgpr_read_b32 v144, a168
v_mfma_f32_16x16x32_bf16 a[204:207], v[104:107], v[212:215], a[204:207]
ds_read_b64_tr_b16 v[212:213], v250 offset:28672
s_waitcnt lgkmcnt(5)
v_mfma_f32_16x16x32_bf16 a[192:195], v[176:179], v[216:219], a[192:195]
ds_read_b64_tr_b16 v[214:215], v250 offset:30720
v_accvgpr_read_b32 v145, a169
v_mfma_f32_16x16x32_bf16 a[196:199], v[180:183], v[216:219], a[196:199]
v_accvgpr_read_b32 v146, a170
v_accvgpr_read_b32 v147, a171
v_mfma_f32_16x16x32_bf16 a[200:203], v[184:187], v[216:219], a[200:203]
v_cvt_pk_bf16_f32 v84, v144, v145
v_cvt_pk_bf16_f32 v85, v146, v147
v_mfma_f32_16x16x32_bf16 a[204:207], v[188:191], v[216:219], a[204:207]
ds_read_b64_tr_b16 v[216:217], v13 offset:12288
s_waitcnt lgkmcnt(5)
v_mfma_f32_16x16x32_bf16 a[192:195], v[160:163], v[220:223], a[192:195]
ds_read_b64_tr_b16 v[218:219], v13 offset:14336
v_accvgpr_read_b32 v152, a172
v_mfma_f32_16x16x32_bf16 a[196:199], v[164:167], v[220:223], a[196:199]
v_accvgpr_read_b32 v153, a173
v_accvgpr_read_b32 v154, a174
v_mfma_f32_16x16x32_bf16 a[200:203], v[168:171], v[220:223], a[200:203]
v_accvgpr_read_b32 v155, a175
v_cvt_pk_bf16_f32 v116, v152, v153
v_mfma_f32_16x16x32_bf16 a[204:207], v[172:175], v[220:223], a[204:207]
ds_read_b64_tr_b16 v[220:221], v13 offset:28672
s_waitcnt lgkmcnt(5)
v_mfma_f32_16x16x32_bf16 a[192:195], v[0:3], v[208:211], a[192:195]
ds_read_b64_tr_b16 v[222:223], v13 offset:30720
v_cvt_pk_bf16_f32 v117, v154, v155
v_mfma_f32_16x16x32_bf16 a[196:199], v[32:35], v[208:211], a[196:199]
v_accvgpr_read_b32 v132, a176
v_accvgpr_read_b32 v133, a177
v_mfma_f32_16x16x32_bf16 a[200:203], v[64:67], v[208:211], a[200:203]
v_accvgpr_read_b32 v134, a178
v_accvgpr_read_b32 v135, a179
v_mfma_f32_16x16x32_bf16 a[204:207], v[96:99], v[208:211], a[204:207]
ds_read_b64_tr_b16 v[208:209], v15 offset:12288
s_waitcnt lgkmcnt(5)
v_mfma_f32_16x16x32_bf16 a[208:211], v[4:7], v[212:215], a[208:211]
ds_read_b64_tr_b16 v[210:211], v15 offset:14336
v_cvt_pk_bf16_f32 v22, v132, v133
v_mfma_f32_16x16x32_bf16 a[212:215], v[36:39], v[212:215], a[212:215]
v_cvt_pk_bf16_f32 v23, v134, v135
buffer_store_dwordx4 v[20:23], v248, s[20:23], s44 offen offset:1024 sc1
v_mfma_f32_16x16x32_bf16 a[216:219], v[68:71], v[212:215], a[216:219]
ds_write_b128 v253, v[20:23] offset:5120
v_accvgpr_read_b32 v140, a180
v_mfma_f32_16x16x32_bf16 a[220:223], v[100:103], v[212:215], a[220:223]
ds_read_b64_tr_b16 v[212:213], v15 offset:28672
s_waitcnt lgkmcnt(5)
v_mfma_f32_16x16x32_bf16 a[208:211], v[8:11], v[216:219], a[208:211]
ds_read_b64_tr_b16 v[214:215], v15 offset:30720
v_accvgpr_read_b32 v141, a181
v_mfma_f32_16x16x32_bf16 a[212:215], v[40:43], v[216:219], a[212:215]
v_accvgpr_read_b32 v142, a182
v_accvgpr_read_b32 v143, a183
v_mfma_f32_16x16x32_bf16 a[216:219], v[72:75], v[216:219], a[216:219]
v_cvt_pk_bf16_f32 v54, v140, v141
v_cvt_pk_bf16_f32 v55, v142, v143
v_mfma_f32_16x16x32_bf16 a[220:223], v[104:107], v[216:219], a[220:223]
ds_read_b64_tr_b16 v[216:217], v249 offset:29184
s_waitcnt lgkmcnt(5)
v_mfma_f32_16x16x32_bf16 a[208:211], v[176:179], v[220:223], a[208:211]
ds_read_b64_tr_b16 v[218:219], v249 offset:31232
buffer_store_dwordx4 v[52:55], v248, s[20:23], s45 offen offset:1024 sc1
v_mfma_f32_16x16x32_bf16 a[212:215], v[180:183], v[220:223], a[212:215]
v_accvgpr_read_b32 v148, a184
v_accvgpr_read_b32 v149, a185
v_mfma_f32_16x16x32_bf16 a[216:219], v[184:187], v[220:223], a[216:219]
v_accvgpr_read_b32 v150, a186
v_accvgpr_read_b32 v151, a187
v_mfma_f32_16x16x32_bf16 a[220:223], v[188:191], v[220:223], a[220:223]
ds_read_b64_tr_b16 v[220:221], v12 offset:12800
s_waitcnt lgkmcnt(5)
v_mfma_f32_16x16x32_bf16 a[208:211], v[160:163], v[208:211], a[208:211]
ds_read_b64_tr_b16 v[222:223], v12 offset:14848
v_cvt_pk_bf16_f32 v86, v148, v149
v_mfma_f32_16x16x32_bf16 a[212:215], v[164:167], v[208:211], a[212:215]
v_cvt_pk_bf16_f32 v87, v150, v151
buffer_store_dwordx4 v[84:87], v248, s[20:23], s46 offen offset:1024 sc1
v_mfma_f32_16x16x32_bf16 a[216:219], v[168:171], v[208:211], a[216:219]
v_accvgpr_read_b32 v156, a188
v_accvgpr_read_b32 v157, a189
v_mfma_f32_16x16x32_bf16 a[220:223], v[172:175], v[208:211], a[220:223]
ds_read_b64_tr_b16 v[208:209], v12 offset:29184
s_waitcnt lgkmcnt(5)
v_mfma_f32_16x16x32_bf16 a[208:211], v[0:3], v[212:215], a[208:211]
ds_read_b64_tr_b16 v[210:211], v12 offset:31232
v_accvgpr_read_b32 v158, a190
v_mfma_f32_16x16x32_bf16 a[212:215], v[32:35], v[212:215], a[212:215]
v_accvgpr_read_b32 v159, a191
v_cvt_pk_bf16_f32 v118, v156, v157
v_mfma_f32_16x16x32_bf16 a[216:219], v[64:67], v[212:215], a[216:219]
v_cvt_pk_bf16_f32 v119, v158, v159
buffer_store_dwordx4 v[116:119], v248, s[20:23], s47 offen offset:1024 sc1
v_mfma_f32_16x16x32_bf16 a[220:223], v[96:99], v[212:215], a[220:223]
ds_read_b64_tr_b16 v[212:213], v14 offset:12800
s_waitcnt lgkmcnt(5)
v_mfma_f32_16x16x32_bf16 a[224:227], v[4:7], v[216:219], a[224:227]
ds_read_b64_tr_b16 v[214:215], v14 offset:14848
v_accvgpr_read_b32 v128, a192
v_mfma_f32_16x16x32_bf16 a[228:231], v[36:39], v[216:219], a[228:231]
v_accvgpr_read_b32 v129, a193
v_accvgpr_read_b32 v130, a194
v_mfma_f32_16x16x32_bf16 a[232:235], v[68:71], v[216:219], a[232:235]
v_accvgpr_read_b32 v131, a195
v_cvt_pk_bf16_f32 v24, v128, v129
v_mfma_f32_16x16x32_bf16 a[236:239], v[100:103], v[216:219], a[236:239]
ds_read_b64_tr_b16 v[216:217], v14 offset:29184
s_waitcnt lgkmcnt(5)
v_mfma_f32_16x16x32_bf16 a[224:227], v[8:11], v[220:223], a[224:227]
ds_read_b64_tr_b16 v[218:219], v14 offset:31232
v_cvt_pk_bf16_f32 v25, v130, v131
v_mfma_f32_16x16x32_bf16 a[228:231], v[40:43], v[220:223], a[228:231]
v_accvgpr_read_b32 v136, a196
v_accvgpr_read_b32 v137, a197
v_mfma_f32_16x16x32_bf16 a[232:235], v[72:75], v[220:223], a[232:235]
v_accvgpr_read_b32 v138, a198
v_accvgpr_read_b32 v139, a199
v_mfma_f32_16x16x32_bf16 a[236:239], v[104:107], v[220:223], a[236:239]
ds_read_b64_tr_b16 v[220:221], v250 offset:29184
s_waitcnt lgkmcnt(5)
v_mfma_f32_16x16x32_bf16 a[224:227], v[176:179], v[208:211], a[224:227]
ds_read_b64_tr_b16 v[222:223], v250 offset:31232
v_cvt_pk_bf16_f32 v56, v136, v137
v_mfma_f32_16x16x32_bf16 a[228:231], v[180:183], v[208:211], a[228:231]
v_cvt_pk_bf16_f32 v57, v138, v139
v_accvgpr_read_b32 v144, a200
v_mfma_f32_16x16x32_bf16 a[232:235], v[184:187], v[208:211], a[232:235]
v_accvgpr_read_b32 v145, a201
v_accvgpr_read_b32 v146, a202
v_mfma_f32_16x16x32_bf16 a[236:239], v[188:191], v[208:211], a[236:239]
ds_read_b64_tr_b16 v[208:209], v13 offset:12800
s_waitcnt lgkmcnt(5)
v_mfma_f32_16x16x32_bf16 a[224:227], v[160:163], v[212:215], a[224:227]
ds_read_b64_tr_b16 v[210:211], v13 offset:14848
v_accvgpr_read_b32 v147, a203
v_mfma_f32_16x16x32_bf16 a[228:231], v[164:167], v[212:215], a[228:231]
v_cvt_pk_bf16_f32 v88, v144, v145
v_cvt_pk_bf16_f32 v89, v146, v147
v_mfma_f32_16x16x32_bf16 a[232:235], v[168:171], v[212:215], a[232:235]
v_accvgpr_read_b32 v152, a204
v_accvgpr_read_b32 v153, a205
v_mfma_f32_16x16x32_bf16 a[236:239], v[172:175], v[212:215], a[236:239]
ds_read_b64_tr_b16 v[212:213], v13 offset:29184
s_waitcnt lgkmcnt(5)
v_mfma_f32_16x16x32_bf16 a[224:227], v[0:3], v[216:219], a[224:227]
ds_read_b64_tr_b16 v[214:215], v13 offset:31232
v_accvgpr_read_b32 v154, a206
v_mfma_f32_16x16x32_bf16 a[228:231], v[32:35], v[216:219], a[228:231]
v_accvgpr_read_b32 v155, a207
v_cvt_pk_bf16_f32 v120, v152, v153
v_mfma_f32_16x16x32_bf16 a[232:235], v[64:67], v[216:219], a[232:235]
v_cvt_pk_bf16_f32 v121, v154, v155
v_accvgpr_read_b32 v132, a208
v_mfma_f32_16x16x32_bf16 a[236:239], v[96:99], v[216:219], a[236:239]
ds_read_b64_tr_b16 v[216:217], v15 offset:12800
s_waitcnt lgkmcnt(5)
v_mfma_f32_16x16x32_bf16 a[240:243], v[4:7], v[220:223], a[240:243]
ds_read_b64_tr_b16 v[218:219], v15 offset:14848
v_accvgpr_read_b32 v133, a209
v_mfma_f32_16x16x32_bf16 a[244:247], v[36:39], v[220:223], a[244:247]
v_accvgpr_read_b32 v134, a210
v_accvgpr_read_b32 v135, a211
v_mfma_f32_16x16x32_bf16 a[248:251], v[68:71], v[220:223], a[248:251]
v_cvt_pk_bf16_f32 v26, v132, v133
v_cvt_pk_bf16_f32 v27, v134, v135
v_mfma_f32_16x16x32_bf16 a[252:255], v[100:103], v[220:223], a[252:255]
ds_read_b64_tr_b16 v[220:221], v15 offset:29184
s_waitcnt lgkmcnt(5)
v_mfma_f32_16x16x32_bf16 a[240:243], v[8:11], v[208:211], a[240:243]
ds_read_b64_tr_b16 v[222:223], v15 offset:31232
buffer_store_dwordx4 v[24:27], v248, s[20:23], s44 offen offset:2048 sc1
v_mfma_f32_16x16x32_bf16 a[244:247], v[40:43], v[208:211], a[244:247]
ds_write_b128 v253, v[24:27] offset:6144
v_accvgpr_read_b32 v140, a212
v_mfma_f32_16x16x32_bf16 a[248:251], v[72:75], v[208:211], a[248:251]
v_accvgpr_read_b32 v141, a213
v_accvgpr_read_b32 v142, a214
v_mfma_f32_16x16x32_bf16 a[252:255], v[104:107], v[208:211], a[252:255]
s_waitcnt lgkmcnt(4)
v_accvgpr_read_b32 v143, a215
v_mfma_f32_16x16x32_bf16 a[240:243], v[176:179], v[212:215], a[240:243]
v_cvt_pk_bf16_f32 v58, v140, v141
v_cvt_pk_bf16_f32 v59, v142, v143
v_mfma_f32_16x16x32_bf16 a[244:247], v[180:183], v[212:215], a[244:247]
buffer_store_dwordx4 v[56:59], v248, s[20:23], s45 offen offset:2048 sc1
v_accvgpr_read_b32 v148, a216
v_mfma_f32_16x16x32_bf16 a[248:251], v[184:187], v[212:215], a[248:251]
v_accvgpr_read_b32 v149, a217
v_accvgpr_read_b32 v150, a218
v_mfma_f32_16x16x32_bf16 a[252:255], v[188:191], v[212:215], a[252:255]
s_waitcnt lgkmcnt(2)
v_accvgpr_read_b32 v151, a219
v_mfma_f32_16x16x32_bf16 a[240:243], v[160:163], v[216:219], a[240:243]
v_cvt_pk_bf16_f32 v90, v148, v149
v_cvt_pk_bf16_f32 v91, v150, v151
v_mfma_f32_16x16x32_bf16 a[244:247], v[164:167], v[216:219], a[244:247]
buffer_store_dwordx4 v[88:91], v248, s[20:23], s46 offen offset:2048 sc1
v_accvgpr_read_b32 v156, a220
v_mfma_f32_16x16x32_bf16 a[248:251], v[168:171], v[216:219], a[248:251]
v_accvgpr_read_b32 v157, a221
v_accvgpr_read_b32 v158, a222
v_mfma_f32_16x16x32_bf16 a[252:255], v[172:175], v[216:219], a[252:255]
s_waitcnt lgkmcnt(0)
v_accvgpr_read_b32 v159, a223
v_mfma_f32_16x16x32_bf16 a[240:243], v[0:3], v[220:223], a[240:243]
v_cvt_pk_bf16_f32 v122, v156, v157
v_cvt_pk_bf16_f32 v123, v158, v159
v_mfma_f32_16x16x32_bf16 a[244:247], v[32:35], v[220:223], a[244:247]
buffer_store_dwordx4 v[120:123], v248, s[20:23], s47 offen offset:2048 sc1
v_accvgpr_read_b32 v128, a224
v_mfma_f32_16x16x32_bf16 a[248:251], v[64:67], v[220:223], a[248:251]
v_accvgpr_read_b32 v129, a225
v_accvgpr_read_b32 v130, a226
v_mfma_f32_16x16x32_bf16 a[252:255], v[96:99], v[220:223], a[252:255]
v_accvgpr_read_b32 v131, a227
v_cvt_pk_bf16_f32 v28, v128, v129
v_cvt_pk_bf16_f32 v29, v130, v131
v_accvgpr_read_b32 v136, a228
v_accvgpr_read_b32 v137, a229
v_accvgpr_read_b32 v138, a230
v_accvgpr_read_b32 v139, a231
v_cvt_pk_bf16_f32 v60, v136, v137
v_cvt_pk_bf16_f32 v61, v138, v139
v_accvgpr_read_b32 v144, a232
v_accvgpr_read_b32 v145, a233
v_accvgpr_read_b32 v146, a234
v_accvgpr_read_b32 v147, a235
v_cvt_pk_bf16_f32 v92, v144, v145
v_cvt_pk_bf16_f32 v93, v146, v147
v_accvgpr_read_b32 v152, a236
v_accvgpr_read_b32 v153, a237
v_accvgpr_read_b32 v154, a238
v_accvgpr_read_b32 v155, a239
v_cvt_pk_bf16_f32 v124, v152, v153
v_cvt_pk_bf16_f32 v125, v154, v155
v_accvgpr_read_b32 v132, a240
v_accvgpr_read_b32 v133, a241
v_accvgpr_read_b32 v134, a242
v_accvgpr_read_b32 v135, a243
v_cvt_pk_bf16_f32 v30, v132, v133
v_cvt_pk_bf16_f32 v31, v134, v135
buffer_store_dwordx4 v[28:31], v248, s[20:23], s44 offen offset:3072 sc1
ds_write_b128 v253, v[28:31] offset:7168
v_accvgpr_read_b32 v140, a244
v_accvgpr_read_b32 v141, a245
v_accvgpr_read_b32 v142, a246
v_accvgpr_read_b32 v143, a247
v_cvt_pk_bf16_f32 v62, v140, v141
v_cvt_pk_bf16_f32 v63, v142, v143
buffer_store_dwordx4 v[60:63], v248, s[20:23], s45 offen offset:3072 sc1
v_accvgpr_read_b32 v148, a248
v_accvgpr_read_b32 v149, a249
v_accvgpr_read_b32 v150, a250
v_accvgpr_read_b32 v151, a251
v_cvt_pk_bf16_f32 v94, v148, v149
v_cvt_pk_bf16_f32 v95, v150, v151
buffer_store_dwordx4 v[92:95], v248, s[20:23], s46 offen offset:3072 sc1
v_accvgpr_read_b32 v156, a252
v_accvgpr_read_b32 v157, a253
v_accvgpr_read_b32 v158, a254
v_accvgpr_read_b32 v159, a255
v_cvt_pk_bf16_f32 v126, v156, v157
v_cvt_pk_bf16_f32 v127, v158, v159
buffer_store_dwordx4 v[124:127], v248, s[20:23], s47 offen offset:3072 sc1
s_waitcnt vmcnt(36)
s_branch L2_F
L2_F:
v_cmp_ne_u64 vcc, s[98:99], v[108:109]
s_lshl_b32 s3, s34, 15
s_add_u32 s3, s3, 0x1000000
s_cbranch_vccnz LF_wf
LF_wf_go:
v_add_u32 v240, s3, v248
v_add_u32 v241, 0x4000, v240
s_mov_b32 s32, 0x0
s_mov_b32 s33, 0x1000
s_mov_b32 s35, 0x2000
s_mov_b32 s36, 0x3000
s_mov_b32 s38, 0x20000
s_mov_b32 s39, 0x21000
s_mov_b32 s40, 0x22000
s_mov_b32 s41, 0x23000
s_lshr_b32 s42, s6, 13
s_lshr_b32 s43, s7, 13
s_lshr_b32 s44, s29, 13
v_mov_b32 v244, s42
v_mov_b32 v232, s43
v_cmp_lt_u32 vcc, 0xff, v248
v_mov_b32 v233, s44
s_nop 0
v_cndmask_b32 v244, v244, v232, vcc
v_cmp_lt_u32 vcc, 0x1ff, v248
v_and_b32 v235, 0xf0, v248
s_nop 0
v_cndmask_b32 v244, v244, v233, vcc
v_lshlrev_b32 v244, 11, v244
v_lshl_add_u32 v244, v235, 3, v244
v_lshrrev_b32 v79, 6, v244
buffer_load_ushort v79, v79, s[52:55], 0 offen
buffer_load_dwordx4 a[0:3], v240, s[16:19], s32 offen offset:0 sc1
buffer_load_dwordx4 a[4:7], v240, s[16:19], s32 offen offset:1024 sc1
buffer_load_dwordx4 a[8:11], v241, s[16:19], s32 offen offset:0 sc1
buffer_load_dwordx4 a[12:15], v241, s[16:19], s32 offen offset:1024 sc1
buffer_load_dwordx4 a[16:19], v240, s[16:19], s32 offen offset:2048 sc1
buffer_load_dwordx4 a[20:23], v240, s[16:19], s32 offen offset:3072 sc1
buffer_load_dwordx4 a[24:27], v241, s[16:19], s32 offen offset:2048 sc1
buffer_load_dwordx4 a[28:31], v241, s[16:19], s32 offen offset:3072 sc1
buffer_load_dwordx4 a[32:35], v240, s[16:19], s33 offen offset:0 sc1
buffer_load_dwordx4 a[36:39], v240, s[16:19], s33 offen offset:1024 sc1
buffer_load_dwordx4 a[40:43], v241, s[16:19], s33 offen offset:0 sc1
buffer_load_dwordx4 a[44:47], v241, s[16:19], s33 offen offset:1024 sc1
s_lshl_b32 s3, s37, 3
v_add3_u32 v244, v244, s3, 8
s_cmp_ge_u32 s29, 0x70000000
s_cselect_b32 s44, s43, s44
v_mov_b32 v46, s42
v_mov_b32 v232, s43
v_cmp_lt_u32 vcc, 0x7f, v248
v_mov_b32 v233, s44
s_nop 0
v_cndmask_b32 v46, v46, v232, vcc
v_cmp_lt_u32 vcc, 0xff, v248
v_bfe_u32 v232, v248, 4, 3
s_nop 0
v_cndmask_b32 v46, v46, v233, vcc
v_min_u32 v232, 5, v232
v_lshrrev_b32 v46, 2, v46
v_lshl_add_u32 v46, v46, 3, v232
v_lshlrev_b32 v46, 7, v46
v_add_u32 v46, 0x7c00000, v46
s_lshl_b32 s49, s34, 10
s_add_u32 s49, s49, 0x20000
s_bfe_u32 s3, s6, 0x2000f
s_lshl_b32 s3, s3, 13
s_add_u32 s3, s3, s49
v_add_u32 v76, s3, v248
s_bfe_u32 s3, s7, 0x2000f
s_lshl_b32 s3, s3, 13
s_add_u32 s3, s3, s49
v_add_u32 v77, s3, v248
s_bfe_u32 s3, s29, 0x2000f
s_lshl_b32 s3, s3, 13
s_add_u32 s3, s3, s49
v_add_u32 v78, s3, v248
s_add_u32 s3, s37, 1
s_sub_u32 s49, s3, 6
s_cselect_b32 s3, s3, s49
s_mul_i32 s3, s3, 0x600000
s_add_u32 s42, s3, 0x2000000
s_add_u32 s3, s37, 2
s_sub_u32 s49, s3, 6
s_cselect_b32 s3, s3, s49
s_mul_i32 s3, s3, 0x600000
s_add_u32 s43, s3, 0x2000000
s_add_u32 s3, s37, 3
s_sub_u32 s49, s3, 6
s_cselect_b32 s3, s3, s49
s_mul_i32 s3, s3, 0x600000
s_add_u32 s44, s3, 0x2000000
s_add_u32 s3, s37, 4
s_sub_u32 s49, s3, 6
s_cselect_b32 s3, s3, s49
s_mul_i32 s3, s3, 0x600000
s_add_u32 s45, s3, 0x2000000
s_add_u32 s3, s37, 5
s_sub_u32 s49, s3, 6
s_cselect_b32 s3, s3, s49
s_mul_i32 s3, s3, 0x600000
s_add_u32 s46, s3, 0x2000000
s_add_u32 s3, s37, 6
s_sub_u32 s49, s3, 6
s_cselect_b32 s3, s3, s49
s_mul_i32 s3, s3, 0x600000
s_add_u32 s47, s3, 0x2000000
s_mul_i32 s3, s34, 896
v_add_u32 v47, s3, v248
v_add_u32 v43, 0x1000, v47
v_lshrrev_b32 v44, 4, v248
v_and_b32 v44, 0x30, v44
v_xor_b32 v44, v44, v248
v_and_b32 v232, 0x380, v248
v_mad_u32_u24 v44, v232, 3, v44
v_xor_b32 v45, 0x1040, v44
v_bfe_u32 v232, v248, 5, 3
v_lshrrev_b32 v234, 8, v248
v_xor_b32 v232, v232, v234
v_bfe_u32 v233, v248, 4, 3
v_lshlrev_b32 v233, 7, v233
v_lshl_or_b32 v232, v232, 4, v233
v_bfe_u32 v233, v248, 7, 1
s_lshl_b32 s49, s34, 10
s_sub_u32 s3, s28, s49
v_lshl_add_u32 v74, v233, 12, v232
v_add_u32 v72, s3, v74
s_sub_u32 s3, s30, s49
v_add_u32 v74, s3, v74
v_xor_b32 v73, 64, v72
v_xor_b32 v75, 64, v74
v_lshl_add_u32 v245, v233, 10, v232
v_add_u32 v245, s31, v245
v_xor_b32 v246, 64, v245
v_add_u32 v247, s31, v248
s_add_u32 s3, s3, 0xa000
s_and_b32 s3, s3, 0x1ffff
v_add_u32 v252, s3, v248
v_add_u32 v251, s49, v252
s_lshl_b32 s49, s34, 11
s_add_u32 s3, s3, s49
s_add_u32 s3, s3, 24576
v_lshl_add_u32 v249, v248, 1, s3
v_lshl_add_u32 v250, v235, 1, s3
v_lshrrev_b32 v232, 4, v235
v_lshlrev_b32 v234, 2, v234
v_sub_u32 v232, v232, v234
v_and_b32 v233, 1, v232
v_lshlrev_b32 v233, 4, v233
v_mov_b32 v234, 0xffff
v_lshlrev_b32 v233, v233, v234
v_lshrrev_b32 v232, 1, v232
v_cmp_eq_u32 vcc, 0, v232
s_nop 1
v_cndmask_b32 v156, 0, v233, vcc
v_cmp_eq_u32 vcc, 1, v232
s_nop 1
v_cndmask_b32 v157, 0, v233, vcc
s_mov_b32 s95, 0xffff0000
s_waitcnt vmcnt(13)
v_mov_b32 v158, s98
v_mov_b32 v159, s99
s_mov_b64 exec, 1
buffer_store_dwordx2 v[158:159], off, s[16:19], s51 sc1
s_mov_b64 exec, -1
s_waitcnt lgkmcnt(0)
s_barrier
ds_read_b128 v[208:211], v72 offset:0
ds_read_b128 v[212:215], v72 offset:8192
ds_read_b128 v[216:219], v74 offset:0
ds_read_b128 v[220:223], v73 offset:0
ds_read_b128 v[224:227], v73 offset:8192
ds_read_b128 v[104:107], v245 offset:0
ds_read_b128 v[108:111], v246 offset:0
ds_read_b128 v[152:155], v245 offset:2048
s_waitcnt vmcnt(13)
v_lshlrev_b32 v79, 16, v79
ds_write_b32 v249, v79 offset:28
ds_read_b32 v253, v250 offset:28
ds_read_b32 v254, v250 offset:540
ds_read_b32 v255, v250 offset:1052
s_waitcnt vmcnt(12)
buffer_load_dwordx4 a[48:51], v240, s[16:19], s33 offen offset:2048 sc1
s_waitcnt vmcnt(12)
buffer_load_dwordx4 a[52:55], v240, s[16:19], s33 offen offset:3072 sc1
s_waitcnt vmcnt(12)
buffer_load_dwordx4 a[56:59], v241, s[16:19], s33 offen offset:2048 sc1
s_waitcnt vmcnt(12)
s_waitcnt lgkmcnt(11)
v_mfma_f32_16x16x32_bf16 v[160:163], a[0:3], v[208:211], 0
ds_read_b128 v[228:231], v75 offset:0
buffer_load_dwordx4 a[60:63], v241, s[16:19], s33 offen offset:3072 sc1
v_mfma_f32_16x16x32_bf16 v[164:167], a[4:7], v[208:211], 0
v_mfma_f32_16x16x32_bf16 v[168:171], a[8:11], v[208:211], 0
v_mfma_f32_16x16x32_bf16 v[172:175], a[12:15], v[208:211], 0
s_waitcnt vmcnt(12)
s_waitcnt lgkmcnt(11)
v_mfma_f32_16x16x32_bf16 v[176:179], a[0:3], v[212:215], 0
ds_read_b128 v[208:211], v72 offset:1024
buffer_load_dwordx4 a[64:67], v240, s[16:19], s35 offen offset:0 sc1
v_mfma_f32_16x16x32_bf16 v[180:183], a[4:7], v[212:215], 0
v_mfma_f32_16x16x32_bf16 v[184:187], a[8:11], v[212:215], 0
v_mfma_f32_16x16x32_bf16 v[188:191], a[12:15], v[212:215], 0
s_waitcnt vmcnt(12)
s_waitcnt lgkmcnt(11)
v_mfma_f32_16x16x32_bf16 v[192:195], a[0:3], v[216:219], 0
ds_read_b128 v[212:215], v72 offset:9216
buffer_load_dwordx4 a[68:71], v240, s[16:19], s35 offen offset:1024 sc1
v_mfma_f32_16x16x32_bf16 v[196:199], a[4:7], v[216:219], 0
v_mfma_f32_16x16x32_bf16 v[200:203], a[8:11], v[216:219], 0
v_mfma_f32_16x16x32_bf16 v[204:207], a[12:15], v[216:219], 0
s_waitcnt vmcnt(12)
buffer_load_dwordx4 a[72:75], v241, s[16:19], s35 offen offset:0 sc1
s_waitcnt vmcnt(12)
s_waitcnt lgkmcnt(11)
v_mfma_f32_16x16x32_bf16 v[160:163], a[16:19], v[220:223], v[160:163]
ds_read_b128 v[216:219], v74 offset:1024
buffer_load_dwordx4 a[76:79], v241, s[16:19], s35 offen offset:1024 sc1
v_mfma_f32_16x16x32_bf16 v[164:167], a[20:23], v[220:223], v[164:167]
v_mfma_f32_16x16x32_bf16 v[168:171], a[24:27], v[220:223], v[168:171]
v_mfma_f32_16x16x32_bf16 v[172:175], a[28:31], v[220:223], v[172:175]
s_waitcnt vmcnt(12)
s_waitcnt lgkmcnt(11)
v_mfma_f32_16x16x32_bf16 v[176:179], a[16:19], v[224:227], v[176:179]
ds_read_b128 v[220:223], v73 offset:1024
buffer_load_dwordx4 a[80:83], v240, s[16:19], s35 offen offset:2048 sc1
v_mfma_f32_16x16x32_bf16 v[180:183], a[20:23], v[224:227], v[180:183]
v_mfma_f32_16x16x32_bf16 v[184:187], a[24:27], v[224:227], v[184:187]
v_mfma_f32_16x16x32_bf16 v[188:191], a[28:31], v[224:227], v[188:191]
s_waitcnt vmcnt(12)
s_waitcnt lgkmcnt(4)
v_mfma_f32_16x16x32_bf16 v[192:195], a[16:19], v[228:231], v[192:195]
ds_read_b128 v[224:227], v73 offset:9216
buffer_load_dwordx4 a[84:87], v240, s[16:19], s35 offen offset:3072 sc1
v_mfma_f32_16x16x32_bf16 v[196:199], a[20:23], v[228:231], v[196:199]
v_mfma_f32_16x16x32_bf16 v[200:203], a[24:27], v[228:231], v[200:203]
v_mfma_f32_16x16x32_bf16 v[204:207], a[28:31], v[228:231], v[204:207]
s_waitcnt vmcnt(12)
buffer_load_dwordx4 a[88:91], v241, s[16:19], s35 offen offset:2048 sc1
s_waitcnt vmcnt(12)
s_waitcnt lgkmcnt(4)
v_mfma_f32_16x16x32_bf16 v[160:163], a[32:35], v[208:211], v[160:163]
ds_read_b128 v[228:231], v75 offset:1024
buffer_load_dwordx4 a[92:95], v241, s[16:19], s35 offen offset:3072 sc1
v_mfma_f32_16x16x32_bf16 v[164:167], a[36:39], v[208:211], v[164:167]
v_mfma_f32_16x16x32_bf16 v[168:171], a[40:43], v[208:211], v[168:171]
v_mfma_f32_16x16x32_bf16 v[172:175], a[44:47], v[208:211], v[172:175]
s_waitcnt lgkmcnt(4)
v_mfma_f32_16x16x32_bf16 v[176:179], a[32:35], v[212:215], v[176:179]
ds_read_b128 v[208:211], v72 offset:2048
v_mfma_f32_16x16x32_bf16 v[180:183], a[36:39], v[212:215], v[180:183]
v_mfma_f32_16x16x32_bf16 v[184:187], a[40:43], v[212:215], v[184:187]
v_mfma_f32_16x16x32_bf16 v[188:191], a[44:47], v[212:215], v[188:191]
s_waitcnt vmcnt(11)
s_waitcnt lgkmcnt(4)
v_mfma_f32_16x16x32_bf16 v[192:195], a[32:35], v[216:219], v[192:195]
ds_read_b128 v[212:215], v72 offset:10240
buffer_load_dwordx4 a[96:99], v240, s[16:19], s36 offen offset:0 sc1
v_mfma_f32_16x16x32_bf16 v[196:199], a[36:39], v[216:219], v[196:199]
v_mfma_f32_16x16x32_bf16 v[200:203], a[40:43], v[216:219], v[200:203]
v_mfma_f32_16x16x32_bf16 v[204:207], a[44:47], v[216:219], v[204:207]
s_waitcnt vmcnt(11)
buffer_load_dwordx4 a[100:103], v240, s[16:19], s36 offen offset:1024 sc1
s_waitcnt vmcnt(11)
buffer_load_dwordx4 a[104:107], v241, s[16:19], s36 offen offset:0 sc1
s_waitcnt vmcnt(11)
s_waitcnt lgkmcnt(4)
v_mfma_f32_16x16x32_bf16 v[160:163], a[48:51], v[220:223], v[160:163]
ds_read_b128 v[216:219], v74 offset:2048
buffer_load_dwordx4 a[108:111], v241, s[16:19], s36 offen offset:1024 sc1
v_mfma_f32_16x16x32_bf16 v[164:167], a[52:55], v[220:223], v[164:167]
v_mfma_f32_16x16x32_bf16 v[168:171], a[56:59], v[220:223], v[168:171]
v_mfma_f32_16x16x32_bf16 v[172:175], a[60:63], v[220:223], v[172:175]
s_waitcnt vmcnt(11)
s_waitcnt lgkmcnt(4)
v_mfma_f32_16x16x32_bf16 v[176:179], a[48:51], v[224:227], v[176:179]
ds_read_b128 v[220:223], v73 offset:2048
buffer_load_dwordx4 a[112:115], v240, s[16:19], s36 offen offset:2048 sc1
v_mfma_f32_16x16x32_bf16 v[180:183], a[52:55], v[224:227], v[180:183]
v_mfma_f32_16x16x32_bf16 v[184:187], a[56:59], v[224:227], v[184:187]
v_mfma_f32_16x16x32_bf16 v[188:191], a[60:63], v[224:227], v[188:191]
s_waitcnt vmcnt(11)
s_waitcnt lgkmcnt(4)
v_mfma_f32_16x16x32_bf16 v[192:195], a[48:51], v[228:231], v[192:195]
ds_read_b128 v[224:227], v73 offset:10240
buffer_load_dwordx4 a[116:119], v240, s[16:19], s36 offen offset:3072 sc1
v_mfma_f32_16x16x32_bf16 v[196:199], a[52:55], v[228:231], v[196:199]
v_mfma_f32_16x16x32_bf16 v[200:203], a[56:59], v[228:231], v[200:203]
v_mfma_f32_16x16x32_bf16 v[204:207], a[60:63], v[228:231], v[204:207]
s_waitcnt vmcnt(11)
buffer_load_dwordx4 a[120:123], v241, s[16:19], s36 offen offset:2048 sc1
s_waitcnt vmcnt(11)
s_waitcnt lgkmcnt(4)
v_mfma_f32_16x16x32_bf16 v[160:163], a[64:67], v[208:211], v[160:163]
ds_read_b128 v[228:231], v75 offset:2048
buffer_load_dwordx4 a[124:127], v241, s[16:19], s36 offen offset:3072 sc1
v_mfma_f32_16x16x32_bf16 v[164:167], a[68:71], v[208:211], v[164:167]
v_mfma_f32_16x16x32_bf16 v[168:171], a[72:75], v[208:211], v[168:171]
v_mfma_f32_16x16x32_bf16 v[172:175], a[76:79], v[208:211], v[172:175]
s_waitcnt vmcnt(11)
s_waitcnt lgkmcnt(4)
v_mfma_f32_16x16x32_bf16 v[176:179], a[64:67], v[212:215], v[176:179]
ds_read_b128 v[208:211], v72 offset:3072
buffer_load_dwordx4 a[128:131], v240, s[16:19], s38 offen offset:0 sc1
v_mfma_f32_16x16x32_bf16 v[180:183], a[68:71], v[212:215], v[180:183]
v_mfma_f32_16x16x32_bf16 v[184:187], a[72:75], v[212:215], v[184:187]
v_mfma_f32_16x16x32_bf16 v[188:191], a[76:79], v[212:215], v[188:191]
s_waitcnt vmcnt(11)
s_waitcnt lgkmcnt(4)
v_mfma_f32_16x16x32_bf16 v[192:195], a[64:67], v[216:219], v[192:195]
ds_read_b128 v[212:215], v72 offset:11264
buffer_load_dwordx4 a[132:135], v240, s[16:19], s38 offen offset:1024 sc1
v_mfma_f32_16x16x32_bf16 v[196:199], a[68:71], v[216:219], v[196:199]
v_mfma_f32_16x16x32_bf16 v[200:203], a[72:75], v[216:219], v[200:203]
v_mfma_f32_16x16x32_bf16 v[204:207], a[76:79], v[216:219], v[204:207]
s_waitcnt vmcnt(11)
buffer_load_dwordx4 a[136:139], v241, s[16:19], s38 offen offset:0 sc1
s_waitcnt vmcnt(11)
s_waitcnt lgkmcnt(4)
v_mfma_f32_16x16x32_bf16 v[160:163], a[80:83], v[220:223], v[160:163]
ds_read_b128 v[216:219], v74 offset:3072
buffer_load_dwordx4 a[140:143], v241, s[16:19], s38 offen offset:1024 sc1
v_mfma_f32_16x16x32_bf16 v[164:167], a[84:87], v[220:223], v[164:167]
v_mfma_f32_16x16x32_bf16 v[168:171], a[88:91], v[220:223], v[168:171]
v_mfma_f32_16x16x32_bf16 v[172:175], a[92:95], v[220:223], v[172:175]
s_waitcnt vmcnt(11)
s_waitcnt lgkmcnt(4)
v_mfma_f32_16x16x32_bf16 v[176:179], a[80:83], v[224:227], v[176:179]
ds_read_b128 v[220:223], v73 offset:3072
buffer_load_dwordx4 a[144:147], v240, s[16:19], s38 offen offset:2048 sc1
v_mfma_f32_16x16x32_bf16 v[180:183], a[84:87], v[224:227], v[180:183]
v_mfma_f32_16x16x32_bf16 v[184:187], a[88:91], v[224:227], v[184:187]
v_mfma_f32_16x16x32_bf16 v[188:191], a[92:95], v[224:227], v[188:191]
s_waitcnt vmcnt(11)
s_waitcnt lgkmcnt(4)
v_mfma_f32_16x16x32_bf16 v[192:195], a[80:83], v[228:231], v[192:195]
ds_read_b128 v[224:227], v73 offset:11264
buffer_load_dwordx4 a[148:151], v240, s[16:19], s38 offen offset:3072 sc1
v_mfma_f32_16x16x32_bf16 v[196:199], a[84:87], v[228:231], v[196:199]
v_mfma_f32_16x16x32_bf16 v[200:203], a[88:91], v[228:231], v[200:203]
v_mfma_f32_16x16x32_bf16 v[204:207], a[92:95], v[228:231], v[204:207]
s_waitcnt vmcnt(11)
buffer_load_dwordx4 a[152:155], v241, s[16:19], s38 offen offset:2048 sc1
s_waitcnt vmcnt(11)
s_waitcnt lgkmcnt(4)
v_mfma_f32_16x16x32_bf16 v[160:163], a[96:99], v[208:211], v[160:163]
ds_read_b128 v[228:231], v75 offset:3072
buffer_load_dwordx4 a[156:159], v241, s[16:19], s38 offen offset:3072 sc1
v_mfma_f32_16x16x32_bf16 v[164:167], a[100:103], v[208:211], v[164:167]
v_mfma_f32_16x16x32_bf16 v[168:171], a[104:107], v[208:211], v[168:171]
v_mfma_f32_16x16x32_bf16 v[172:175], a[108:111], v[208:211], v[172:175]
s_waitcnt vmcnt(11)
s_waitcnt lgkmcnt(4)
v_mfma_f32_16x16x32_bf16 v[176:179], a[96:99], v[212:215], v[176:179]
buffer_load_dwordx4 a[160:163], v240, s[16:19], s39 offen offset:0 sc1
v_mfma_f32_16x16x32_bf16 v[180:183], a[100:103], v[212:215], v[180:183]
v_mfma_f32_16x16x32_bf16 v[184:187], a[104:107], v[212:215], v[184:187]
v_mfma_f32_16x16x32_bf16 v[188:191], a[108:111], v[212:215], v[188:191]
s_waitcnt vmcnt(11)
s_waitcnt lgkmcnt(3)
v_mfma_f32_16x16x32_bf16 v[192:195], a[96:99], v[216:219], v[192:195]
buffer_load_dwordx4 a[164:167], v240, s[16:19], s39 offen offset:1024 sc1
v_mfma_f32_16x16x32_bf16 v[196:199], a[100:103], v[216:219], v[196:199]
v_mfma_f32_16x16x32_bf16 v[200:203], a[104:107], v[216:219], v[200:203]
v_mfma_f32_16x16x32_bf16 v[204:207], a[108:111], v[216:219], v[204:207]
s_waitcnt vmcnt(11)
buffer_load_dwordx4 a[168:171], v241, s[16:19], s39 offen offset:0 sc1
s_waitcnt vmcnt(11)
s_waitcnt lgkmcnt(2)
v_mfma_f32_16x16x32_bf16 v[160:163], a[112:115], v[220:223], v[160:163]
buffer_load_dwordx4 a[172:175], v241, s[16:19], s39 offen offset:1024 sc1
v_mfma_f32_16x16x32_bf16 v[164:167], a[116:119], v[220:223], v[164:167]
v_mfma_f32_16x16x32_bf16 v[168:171], a[120:123], v[220:223], v[168:171]
v_mfma_f32_16x16x32_bf16 v[172:175], a[124:127], v[220:223], v[172:175]
s_waitcnt vmcnt(11)
s_waitcnt lgkmcnt(1)
v_mfma_f32_16x16x32_bf16 v[176:179], a[112:115], v[224:227], v[176:179]
buffer_load_dwordx2 v[242:243], v46, s[16:19], 0 offen offset:0 sc1
v_mfma_f32_16x16x32_bf16 v[180:183], a[116:119], v[224:227], v[180:183]
v_lshlrev_b32 v234, 16, v104
v_and_b32 v235, s95, v104
v_mfma_f32_16x16x32_bf16 v[184:187], a[120:123], v[224:227], v[184:187]
v_fma_f32 v160, v160, v253, v234
v_fma_f32 v161, v161, v253, v235
v_mfma_f32_16x16x32_bf16 v[188:191], a[124:127], v[224:227], v[188:191]
v_lshlrev_b32 v236, 16, v105
v_and_b32 v237, s95, v105
s_waitcnt lgkmcnt(0)
v_mfma_f32_16x16x32_bf16 v[192:195], a[112:115], v[228:231], v[192:195]
v_fma_f32 v162, v162, v253, v236
v_fma_f32 v163, v163, v253, v237
v_mfma_f32_16x16x32_bf16 v[196:199], a[116:119], v[228:231], v[196:199]
v_lshlrev_b32 v238, 16, v106
v_and_b32 v239, s95, v106
v_mfma_f32_16x16x32_bf16 v[200:203], a[120:123], v[228:231], v[200:203]
v_fma_f32 v164, v164, v253, v238
v_fma_f32 v165, v165, v253, v239
v_mfma_f32_16x16x32_bf16 v[204:207], a[124:127], v[228:231], v[204:207]
v_lshlrev_b32 v232, 16, v107
v_and_b32 v233, s95, v107
v_fma_f32 v166, v166, v253, v232
v_fma_f32 v167, v167, v253, v233
ds_read_b128 v[104:107], v246 offset:2048
v_lshlrev_b32 v234, 16, v108
v_and_b32 v235, s95, v108
v_fma_f32 v168, v168, v253, v234
v_fma_f32 v169, v169, v253, v235
v_lshlrev_b32 v236, 16, v109
v_and_b32 v237, s95, v109
v_fma_f32 v170, v170, v253, v236
v_fma_f32 v171, v171, v253, v237
v_lshlrev_b32 v238, 16, v110
v_and_b32 v239, s95, v110
v_fma_f32 v172, v172, v253, v238
v_fma_f32 v173, v173, v253, v239
v_lshlrev_b32 v232, 16, v111
v_and_b32 v233, s95, v111
v_fma_f32 v174, v174, v253, v232
v_fma_f32 v175, v175, v253, v233
ds_read_b128 v[108:111], v245 offset:4096
s_waitcnt vmcnt(11)
buffer_load_dwordx4 a[176:179], v240, s[16:19], s39 offen offset:2048 sc1
v_lshlrev_b32 v234, 16, v152
v_and_b32 v235, s95, v152
v_fma_f32 v176, v176, v254, v234
v_fma_f32 v177, v177, v254, v235
v_lshlrev_b32 v236, 16, v153
v_and_b32 v237, s95, v153
v_fma_f32 v178, v178, v254, v236
v_fma_f32 v179, v179, v254, v237
v_lshlrev_b32 v238, 16, v154
v_and_b32 v239, s95, v154
v_fma_f32 v180, v180, v254, v238
v_fma_f32 v181, v181, v254, v239
v_lshlrev_b32 v232, 16, v155
v_and_b32 v233, s95, v155
v_fma_f32 v182, v182, v254, v232
v_fma_f32 v183, v183, v254, v233
ds_read_b128 v[152:155], v246 offset:4096
s_waitcnt lgkmcnt(2)
v_lshlrev_b32 v234, 16, v104
v_and_b32 v235, s95, v104
v_fma_f32 v184, v184, v254, v234
v_fma_f32 v185, v185, v254, v235
v_lshlrev_b32 v236, 16, v105
v_and_b32 v237, s95, v105
v_fma_f32 v186, v186, v254, v236
v_fma_f32 v187, v187, v254, v237
v_lshlrev_b32 v238, 16, v106
v_and_b32 v239, s95, v106
v_fma_f32 v188, v188, v254, v238
v_fma_f32 v189, v189, v254, v239
v_lshlrev_b32 v232, 16, v107
v_and_b32 v233, s95, v107
v_fma_f32 v190, v190, v254, v232
v_fma_f32 v191, v191, v254, v233
s_waitcnt vmcnt(11)
buffer_load_dwordx4 a[180:183], v240, s[16:19], s39 offen offset:3072 sc1
s_waitcnt lgkmcnt(1)
v_lshlrev_b32 v234, 16, v108
v_and_b32 v235, s95, v108
v_fma_f32 v192, v192, v255, v234
v_fma_f32 v193, v193, v255, v235
v_lshlrev_b32 v236, 16, v109
v_and_b32 v237, s95, v109
v_fma_f32 v194, v194, v255, v236
v_fma_f32 v195, v195, v255, v237
v_lshlrev_b32 v238, 16, v110
v_and_b32 v239, s95, v110
v_fma_f32 v196, v196, v255, v238
v_fma_f32 v197, v197, v255, v239
v_lshlrev_b32 v232, 16, v111
v_and_b32 v233, s95, v111
v_fma_f32 v198, v198, v255, v232
v_fma_f32 v199, v199, v255, v233
s_waitcnt lgkmcnt(0)
v_lshlrev_b32 v234, 16, v152
v_and_b32 v235, s95, v152
v_fma_f32 v200, v200, v255, v234
v_fma_f32 v201, v201, v255, v235
v_lshlrev_b32 v236, 16, v153
v_and_b32 v237, s95, v153
v_fma_f32 v202, v202, v255, v236
v_fma_f32 v203, v203, v255, v237
v_lshlrev_b32 v238, 16, v154
v_and_b32 v239, s95, v154
v_fma_f32 v204, v204, v255, v238
v_fma_f32 v205, v205, v255, v239
v_lshlrev_b32 v232, 16, v155
v_and_b32 v233, s95, v155
v_fma_f32 v206, v206, v255, v232
v_fma_f32 v207, v207, v255, v233
s_waitcnt vmcnt(11)
buffer_load_dwordx4 a[184:187], v241, s[16:19], s39 offen offset:2048 sc1
s_waitcnt vmcnt(11)
buffer_load_dwordx4 a[188:191], v241, s[16:19], s39 offen offset:3072 sc1
s_waitcnt vmcnt(11)
buffer_load_dwordx4 a[192:195], v240, s[16:19], s40 offen offset:0 sc1
s_waitcnt vmcnt(11)
buffer_load_dwordx4 a[196:199], v240, s[16:19], s40 offen offset:1024 sc1
s_waitcnt vmcnt(11)
buffer_load_dwordx4 a[200:203], v241, s[16:19], s40 offen offset:0 sc1
s_waitcnt vmcnt(11)
buffer_load_dwordx4 a[204:207], v241, s[16:19], s40 offen offset:1024 sc1
s_waitcnt vmcnt(11)
buffer_load_dwordx4 a[208:211], v240, s[16:19], s40 offen offset:2048 sc1
s_waitcnt vmcnt(11)
buffer_load_dwordx4 a[212:215], v240, s[16:19], s40 offen offset:3072 sc1
s_waitcnt vmcnt(11)
s_waitcnt vmcnt(10)
v_cmp_ne_u64 vcc, s[98:99], v[242:243]
s_nop 1
s_cbranch_vccnz LF_spinQ
LF_goQ:
buffer_load_dwordx4 v[128:131], v244, s[24:27], 0 offen offset:0 sc1
buffer_load_dwordx4 v[132:135], v244, s[24:27], 0 offen offset:16 sc1
s_waitcnt vmcnt(11)
buffer_load_dwordx4 v[136:139], v244, s[24:27], 0 offen offset:32 sc1
s_waitcnt vmcnt(11)
s_waitcnt vmcnt(10)
s_add_u32 s49, s6, s42
buffer_load_dwordx4 v[48:51], v47, s[16:19], s49 offen sc1
s_add_u32 s3, s6, s43
buffer_load_dwordx4 v[52:55], v47, s[16:19], s3 offen sc1
s_waitcnt vmcnt(11)
buffer_load_dwordx4 a[216:219], v241, s[16:19], s40 offen offset:2048 sc1
s_waitcnt vmcnt(11)
s_waitcnt vmcnt(10)
s_add_u32 s49, s6, s44
buffer_load_dwordx4 v[56:59], v47, s[16:19], s49 offen sc1
s_add_u32 s3, s6, s45
buffer_load_dwordx4 v[60:63], v47, s[16:19], s3 offen sc1
s_waitcnt vmcnt(11)
buffer_load_dwordx4 a[220:223], v241, s[16:19], s40 offen offset:3072 sc1
s_waitcnt vmcnt(11)
s_add_u32 s49, s6, s46
buffer_load_dwordx4 v[64:67], v47, s[16:19], s49 offen sc1
ds_read_b128 v[68:71], v76 offset:0
s_waitcnt vmcnt(11)
buffer_load_dwordx4 a[224:227], v240, s[16:19], s41 offen offset:0 sc1
s_waitcnt vmcnt(11)
s_waitcnt vmcnt(10)
s_add_u32 s49, s6, s42
buffer_load_dwordx4 v[80:83], v43, s[16:19], s49 offen sc1
s_add_u32 s3, s6, s43
buffer_load_dwordx4 v[84:87], v43, s[16:19], s3 offen sc1
s_waitcnt vmcnt(11)
buffer_load_dwordx4 a[228:231], v240, s[16:19], s41 offen offset:1024 sc1
s_waitcnt vmcnt(11)
v_max3_f32 v232, v128, v130, v132
v_max3_f32 v233, v134, v136, v138
v_max_f32 v232, v232, v233
v_subrev_f32 v232, 0x42fe0000, v232
v_sub_f32 v128, v128, v232
v_sub_f32 v130, v130, v232
v_sub_f32 v132, v132, v232
v_sub_f32 v134, v134, v232
v_sub_f32 v136, v136, v232
v_sub_f32 v138, v138, v232
v_cvt_u32_f32 v128, v128
v_cvt_u32_f32 v130, v130
v_cvt_u32_f32 v132, v132
v_cvt_u32_f32 v134, v134
v_cvt_u32_f32 v136, v136
v_cvt_u32_f32 v138, v138
v_lshlrev_b32 v234, 23, v128
v_lshlrev_b32 v235, 23, v130
v_lshlrev_b32 v236, 23, v132
v_lshlrev_b32 v237, 23, v134
v_lshlrev_b32 v238, 23, v136
v_lshlrev_b32 v239, 23, v138
v_mul_f32 v232, v234, v129
v_fmac_f32 v232, v235, v131
v_fmac_f32 v232, v236, v133
v_fmac_f32 v232, v237, v135
v_fmac_f32 v232, v238, v137
v_fmac_f32 v232, v239, v139
v_rcp_f32 v150, v232
v_mul_u32_u24 v144, 0x800080, v128
v_mul_u32_u24 v145, 0x800080, v130
v_mul_u32_u24 v146, 0x800080, v132
v_mul_u32_u24 v147, 0x800080, v134
v_mul_u32_u24 v148, 0x800080, v136
v_mul_u32_u24 v149, 0x800080, v138
ds_write_b128 v249, v[144:147]
ds_write_b96 v249, v[148:150] offset:16
ds_read_b128 v[144:147], v250 offset:0
ds_read_b128 v[148:151], v250 offset:16
ds_read_b128 v[128:131], v250 offset:512
ds_read_b128 v[132:135], v250 offset:528
ds_read_b128 v[136:139], v250 offset:1024
ds_read_b128 v[140:143], v250 offset:1040
s_waitcnt lgkmcnt(4)
v_and_b32 v0, v144, v156
v_and_b32 v1, v144, v157
v_and_b32 v2, v145, v156
v_and_b32 v3, v145, v157
v_and_b32 v4, v146, v156
v_and_b32 v5, v146, v157
v_and_b32 v6, v147, v156
v_and_b32 v7, v147, v157
v_and_b32 v8, v148, v156
v_and_b32 v9, v148, v157
v_and_b32 v10, v149, v156
v_and_b32 v11, v149, v157
v_mov_b32 v40, v150
s_waitcnt lgkmcnt(2)
v_and_b32 v12, v128, v156
v_and_b32 v13, v128, v157
v_and_b32 v14, v129, v156
v_and_b32 v15, v129, v157
v_and_b32 v16, v130, v156
v_and_b32 v17, v130, v157
v_and_b32 v18, v131, v156
v_and_b32 v19, v131, v157
v_and_b32 v20, v132, v156
v_and_b32 v21, v132, v157
v_and_b32 v22, v133, v156
v_and_b32 v23, v133, v157
v_mov_b32 v41, v134
s_waitcnt lgkmcnt(0)
v_and_b32 v24, v136, v156
v_and_b32 v25, v136, v157
v_and_b32 v26, v137, v156
v_and_b32 v27, v137, v157
v_and_b32 v28, v138, v156
v_and_b32 v29, v138, v157
v_and_b32 v30, v139, v156
v_and_b32 v31, v139, v157
v_and_b32 v32, v140, v156
v_and_b32 v33, v140, v157
v_and_b32 v34, v141, v156
v_and_b32 v35, v141, v157
v_mov_b32 v42, v142
s_waitcnt vmcnt(9)
v_swap_b32 v50, v52
v_swap_b32 v51, v53
s_nop 1
v_mfma_f32_16x16x32_bf16 v[136:139], v[48:51], v[0:3], 0
s_add_u32 s49, s6, s44
buffer_load_dwordx4 v[88:91], v43, s[16:19], s49 offen sc1
v_mfma_f32_16x16x32_bf16 v[140:143], v[52:55], v[0:3], 0
s_add_u32 s3, s6, s45
buffer_load_dwordx4 v[92:95], v43, s[16:19], s3 offen sc1
buffer_load_dwordx4 a[232:235], v241, s[16:19], s41 offen offset:0 sc1
s_waitcnt vmcnt(11)
s_add_u32 s49, s6, s46
buffer_load_dwordx4 v[96:99], v43, s[16:19], s49 offen sc1
ds_read_b128 v[100:103], v76 offset:4096
s_waitcnt vmcnt(10)
v_swap_b32 v58, v60
v_swap_b32 v59, v61
s_nop 1
v_mfma_f32_16x16x32_bf16 v[136:139], v[56:59], v[4:7], v[136:139]
buffer_load_dwordx4 a[236:239], v241, s[16:19], s41 offen offset:1024 sc1
v_mfma_f32_16x16x32_bf16 v[140:143], v[60:63], v[4:7], v[140:143]
s_waitcnt vmcnt(10)
s_add_u32 s49, s7, s42
buffer_load_dwordx4 v[112:115], v47, s[16:19], s49 offen sc1
s_add_u32 s3, s7, s43
buffer_load_dwordx4 v[116:119], v47, s[16:19], s3 offen sc1
s_waitcnt vmcnt(11)
v_swap_b32 v66, v68
v_swap_b32 v67, v69
s_nop 1
v_mfma_f32_16x16x32_bf16 v[136:139], v[64:67], v[8:11], v[136:139]
buffer_load_dwordx4 a[240:243], v240, s[16:19], s41 offen offset:2048 sc1
v_mfma_f32_16x16x32_bf16 v[140:143], v[68:71], v[8:11], v[140:143]
s_waitcnt vmcnt(11)
s_nop 4
v_mul_f32 v136, v136, v40
v_mul_f32 v137, v137, v40
v_mul_f32 v138, v138, v40
v_mul_f32 v139, v139, v40
v_mul_f32 v140, v140, v40
v_mul_f32 v141, v141, v40
v_mul_f32 v142, v142, v40
v_mul_f32 v143, v143, v40
v_cvt_pk_bf16_f32 v136, v136, v137
v_cvt_pk_bf16_f32 v137, v138, v139
v_cvt_pk_bf16_f32 v138, v140, v141
v_cvt_pk_bf16_f32 v139, v142, v143
ds_write_b128 v251, v[136:139] offset:0
s_waitcnt vmcnt(9)
v_swap_b32 v82, v84
v_swap_b32 v83, v85
s_nop 1
v_mfma_f32_16x16x32_bf16 v[128:131], v[80:83], v[0:3], 0
s_add_u32 s49, s7, s44
buffer_load_dwordx4 v[120:123], v47, s[16:19], s49 offen sc1
v_mfma_f32_16x16x32_bf16 v[132:135], v[84:87], v[0:3], 0
s_add_u32 s3, s7, s45
buffer_load_dwordx4 v[124:127], v47, s[16:19], s3 offen sc1
buffer_load_dwordx4 a[244:247], v240, s[16:19], s41 offen offset:3072 sc1
s_waitcnt vmcnt(11)
s_add_u32 s49, s7, s46
buffer_load_dwordx4 v[48:51], v47, s[16:19], s49 offen sc1
ds_read_b128 v[52:55], v77 offset:0
s_waitcnt vmcnt(10)
v_swap_b32 v90, v92
v_swap_b32 v91, v93
s_nop 1
v_mfma_f32_16x16x32_bf16 v[128:131], v[88:91], v[4:7], v[128:131]
buffer_load_dwordx4 a[248:251], v241, s[16:19], s41 offen offset:2048 sc1
v_mfma_f32_16x16x32_bf16 v[132:135], v[92:95], v[4:7], v[132:135]
s_waitcnt vmcnt(10)
s_add_u32 s49, s7, s42
buffer_load_dwordx4 v[56:59], v43, s[16:19], s49 offen sc1
s_add_u32 s3, s7, s43
buffer_load_dwordx4 v[60:63], v43, s[16:19], s3 offen sc1
s_waitcnt vmcnt(11)
s_waitcnt lgkmcnt(2)
v_swap_b32 v98, v100
v_swap_b32 v99, v101
s_nop 1
v_mfma_f32_16x16x32_bf16 v[128:131], v[96:99], v[8:11], v[128:131]
buffer_load_dwordx4 a[252:255], v241, s[16:19], s41 offen offset:3072 sc1
v_mfma_f32_16x16x32_bf16 v[132:135], v[100:103], v[8:11], v[132:135]
s_waitcnt vmcnt(11)
s_nop 4
v_mul_f32 v128, v128, v40
v_mul_f32 v129, v129, v40
v_mul_f32 v130, v130, v40
v_mul_f32 v131, v131, v40
v_mul_f32 v132, v132, v40
v_mul_f32 v133, v133, v40
v_mul_f32 v134, v134, v40
v_mul_f32 v135, v135, v40
v_cvt_pk_bf16_f32 v128, v128, v129
v_cvt_pk_bf16_f32 v129, v130, v131
v_cvt_pk_bf16_f32 v130, v132, v133
v_cvt_pk_bf16_f32 v131, v134, v135
ds_write_b128 v251, v[128:131] offset:4096
s_waitcnt lgkmcnt(0)
s_barrier
ds_read_b128 v[208:211], v252 offset:0
ds_read_b128 v[212:215], v252 offset:1024
ds_read_b128 v[216:219], v252 offset:2048
ds_read_b128 v[220:223], v252 offset:3072
ds_read_b128 v[224:227], v252 offset:4096
s_waitcnt vmcnt(9)
s_waitcnt lgkmcnt(4)
v_mfma_f32_16x16x32_bf16 v[160:163], a[128:131], v[208:211], v[160:163]
ds_read_b128 v[228:231], v252 offset:5120
v_swap_b32 v114, v116
v_mfma_f32_16x16x32_bf16 v[164:167], a[132:135], v[208:211], v[164:167]
v_swap_b32 v115, v117
s_nop 1
v_mfma_f32_16x16x32_bf16 v[136:139], v[112:115], v[12:15], 0
s_add_u32 s49, s7, s44
buffer_load_dwordx4 v[64:67], v43, s[16:19], s49 offen sc1
v_mfma_f32_16x16x32_bf16 v[140:143], v[116:119], v[12:15], 0
s_add_u32 s3, s7, s45
buffer_load_dwordx4 v[68:71], v43, s[16:19], s3 offen sc1
v_mfma_f32_16x16x32_bf16 v[168:171], a[136:139], v[208:211], v[168:171]
s_add_u32 s49, s7, s46
buffer_load_dwordx4 v[80:83], v43, s[16:19], s49 offen sc1
v_mfma_f32_16x16x32_bf16 v[172:175], a[140:143], v[208:211], v[172:175]
ds_read_b128 v[84:87], v77 offset:4096
s_waitcnt lgkmcnt(5)
v_mfma_f32_16x16x32_bf16 v[160:163], a[144:147], v[212:215], v[160:163]
ds_read_b128 v[208:211], v252 offset:6144
v_mfma_f32_16x16x32_bf16 v[164:167], a[148:151], v[212:215], v[164:167]
v_mfma_f32_16x16x32_bf16 v[168:171], a[152:155], v[212:215], v[168:171]
v_mfma_f32_16x16x32_bf16 v[172:175], a[156:159], v[212:215], v[172:175]
s_waitcnt vmcnt(11)
s_waitcnt lgkmcnt(5)
v_mfma_f32_16x16x32_bf16 v[160:163], a[160:163], v[216:219], v[160:163]
ds_read_b128 v[212:215], v252 offset:7168
v_mfma_f32_16x16x32_bf16 v[164:167], a[164:167], v[216:219], v[164:167]
v_mfma_f32_16x16x32_bf16 v[168:171], a[168:171], v[216:219], v[168:171]
v_mfma_f32_16x16x32_bf16 v[172:175], a[172:175], v[216:219], v[172:175]
s_waitcnt vmcnt(9)
s_waitcnt lgkmcnt(5)
v_mfma_f32_16x16x32_bf16 v[160:163], a[176:179], v[220:223], v[160:163]
v_swap_b32 v122, v124
v_mfma_f32_16x16x32_bf16 v[164:167], a[180:183], v[220:223], v[164:167]
v_swap_b32 v123, v125
s_nop 1
v_mfma_f32_16x16x32_bf16 v[136:139], v[120:123], v[16:19], v[136:139]
s_add_u32 s49, s29, s42
buffer_load_dwordx4 v[88:91], v47, s[16:19], s49 offen sc1
v_mfma_f32_16x16x32_bf16 v[140:143], v[124:127], v[16:19], v[140:143]
s_add_u32 s3, s29, s43
buffer_load_dwordx4 v[92:95], v47, s[16:19], s3 offen sc1
v_mfma_f32_16x16x32_bf16 v[168:171], a[184:187], v[220:223], v[168:171]
v_mfma_f32_16x16x32_bf16 v[172:175], a[188:191], v[220:223], v[172:175]
s_waitcnt lgkmcnt(4)
v_mfma_f32_16x16x32_bf16 v[160:163], a[192:195], v[224:227], v[160:163]
v_mfma_f32_16x16x32_bf16 v[164:167], a[196:199], v[224:227], v[164:167]
v_mfma_f32_16x16x32_bf16 v[168:171], a[200:203], v[224:227], v[168:171]
v_mfma_f32_16x16x32_bf16 v[172:175], a[204:207], v[224:227], v[172:175]
s_waitcnt vmcnt(10)
s_waitcnt lgkmcnt(3)
v_mfma_f32_16x16x32_bf16 v[160:163], a[208:211], v[228:231], v[160:163]
s_add_u32 s49, s29, s44
buffer_load_dwordx4 v[96:99], v47, s[16:19], s49 offen sc1
v_mfma_f32_16x16x32_bf16 v[164:167], a[212:215], v[228:231], v[164:167]
s_add_u32 s3, s29, s45
buffer_load_dwordx4 v[100:103], v47, s[16:19], s3 offen sc1
v_mfma_f32_16x16x32_bf16 v[168:171], a[216:219], v[228:231], v[168:171]
v_mfma_f32_16x16x32_bf16 v[172:175], a[220:223], v[228:231], v[172:175]
s_waitcnt vmcnt(11)
s_waitcnt lgkmcnt(1)
v_mfma_f32_16x16x32_bf16 v[160:163], a[224:227], v[208:211], v[160:163]
v_swap_b32 v50, v52
v_mfma_f32_16x16x32_bf16 v[164:167], a[228:231], v[208:211], v[164:167]
v_swap_b32 v51, v53
s_nop 1
v_mfma_f32_16x16x32_bf16 v[136:139], v[48:51], v[20:23], v[136:139]
v_mfma_f32_16x16x32_bf16 v[140:143], v[52:55], v[20:23], v[140:143]
v_mfma_f32_16x16x32_bf16 v[168:171], a[232:235], v[208:211], v[168:171]
v_mfma_f32_16x16x32_bf16 v[172:175], a[236:239], v[208:211], v[172:175]
s_waitcnt vmcnt(10)
s_add_u32 s49, s29, s46
buffer_load_dwordx4 v[112:115], v47, s[16:19], s49 offen sc1
s_add_u32 s3, s29, s47
s_cmp_lt_u32 s37, 4
s_cbranch_scc1 LF_o0
buffer_load_dwordx4 v[116:119], v47, s[16:19], s3 offen sc1
ds_read_b128 v[36:39], v78 offset:0
s_branch LF_j0
LF_o0:
s_mov_b32 s3, 0x70000000
buffer_load_dwordx4 v[36:39], v47, s[16:19], s3 offen sc1
ds_read_b128 v[116:119], v78 offset:0
LF_j0:
v_mul_f32 v136, v136, v41
v_mul_f32 v137, v137, v41
v_mul_f32 v138, v138, v41
v_mul_f32 v139, v139, v41
v_mul_f32 v140, v140, v41
v_mul_f32 v141, v141, v41
v_mul_f32 v142, v142, v41
v_mul_f32 v143, v143, v41
v_cvt_pk_bf16_f32 v136, v136, v137
v_cvt_pk_bf16_f32 v137, v138, v139
v_cvt_pk_bf16_f32 v138, v140, v141
v_cvt_pk_bf16_f32 v139, v142, v143
ds_write_b128 v251, v[136:139] offset:8192
s_waitcnt vmcnt(10)
v_swap_b32 v58, v60
v_swap_b32 v59, v61
s_nop 1
v_mfma_f32_16x16x32_bf16 v[128:131], v[56:59], v[12:15], 0
s_add_u32 s49, s29, s42
buffer_load_dwordx4 v[120:123], v43, s[16:19], s49 offen sc1
v_mfma_f32_16x16x32_bf16 v[132:135], v[60:63], v[12:15], 0
s_add_u32 s3, s29, s43
buffer_load_dwordx4 v[124:127], v43, s[16:19], s3 offen sc1
s_waitcnt vmcnt(11)
s_waitcnt lgkmcnt(2)
v_mfma_f32_16x16x32_bf16 v[160:163], a[240:243], v[212:215], v[160:163]
v_mfma_f32_16x16x32_bf16 v[164:167], a[244:247], v[212:215], v[164:167]
v_mfma_f32_16x16x32_bf16 v[168:171], a[248:251], v[212:215], v[168:171]
v_mfma_f32_16x16x32_bf16 v[172:175], a[252:255], v[212:215], v[172:175]
s_waitcnt vmcnt(9)
v_swap_b32 v66, v68
v_swap_b32 v67, v69
s_nop 1
v_mfma_f32_16x16x32_bf16 v[128:131], v[64:67], v[16:19], v[128:131]
s_add_u32 s49, s29, s44
buffer_load_dwordx4 v[48:51], v43, s[16:19], s49 offen sc1
v_mfma_f32_16x16x32_bf16 v[132:135], v[68:71], v[16:19], v[132:135]
s_add_u32 s3, s29, s45
buffer_load_dwordx4 v[52:55], v43, s[16:19], s3 offen sc1
v_cvt_pk_bf16_f32 v160, v160, v161
v_cvt_pk_bf16_f32 v161, v162, v163
v_cvt_pk_bf16_f32 v162, v164, v165
v_cvt_pk_bf16_f32 v163, v166, v167
ds_write_b128 v245, v[160:163] offset:0
v_cvt_pk_bf16_f32 v168, v168, v169
v_cvt_pk_bf16_f32 v169, v170, v171
v_cvt_pk_bf16_f32 v170, v172, v173
v_cvt_pk_bf16_f32 v171, v174, v175
ds_write_b128 v246, v[168:171] offset:0
ds_read_b128 v[164:167], v247 offset:0
ds_read_b128 v[172:175], v247 offset:1024
s_waitcnt vmcnt(10)
v_swap_b32 v82, v84
v_swap_b32 v83, v85
s_nop 1
v_mfma_f32_16x16x32_bf16 v[128:131], v[80:83], v[20:23], v[128:131]
s_add_u32 s49, s29, s46
buffer_load_dwordx4 v[56:59], v43, s[16:19], s49 offen sc1
v_mfma_f32_16x16x32_bf16 v[132:135], v[84:87], v[20:23], v[132:135]
s_add_u32 s3, s29, s47
s_cmp_lt_u32 s37, 4
s_cbranch_scc1 LF_o1
buffer_load_dwordx4 v[60:63], v43, s[16:19], s3 offen sc1
ds_read_b128 v[36:39], v78 offset:4096
s_branch LF_j1
LF_o1:
s_mov_b32 s3, 0x70000000
buffer_load_dwordx4 v[36:39], v43, s[16:19], s3 offen sc1
ds_read_b128 v[60:63], v78 offset:4096
LF_j1:
s_waitcnt lgkmcnt(2)
buffer_store_dwordx4 v[164:167], v44, s[56:59], s6 offen sc1
s_waitcnt lgkmcnt(1)
buffer_store_dwordx4 v[172:175], v45, s[56:59], s6 offen sc1
v_mul_f32 v128, v128, v41
v_mul_f32 v129, v129, v41
v_mul_f32 v130, v130, v41
v_mul_f32 v131, v131, v41
v_mul_f32 v132, v132, v41
v_mul_f32 v133, v133, v41
v_mul_f32 v134, v134, v41
v_mul_f32 v135, v135, v41
v_cvt_pk_bf16_f32 v128, v128, v129
v_cvt_pk_bf16_f32 v129, v130, v131
v_cvt_pk_bf16_f32 v130, v132, v133
v_cvt_pk_bf16_f32 v131, v134, v135
ds_write_b128 v251, v[128:131] offset:12288
s_waitcnt lgkmcnt(0)
s_barrier
ds_read_b128 v[216:219], v252 offset:8192
ds_read_b128 v[220:223], v252 offset:9216
ds_read_b128 v[224:227], v252 offset:10240
ds_read_b128 v[228:231], v252 offset:11264
ds_read_b128 v[208:211], v252 offset:12288
s_waitcnt vmcnt(12)
s_waitcnt lgkmcnt(4)
v_mfma_f32_16x16x32_bf16 v[176:179], a[128:131], v[216:219], v[176:179]
ds_read_b128 v[212:215], v252 offset:13312
v_swap_b32 v90, v92
v_mfma_f32_16x16x32_bf16 v[180:183], a[132:135], v[216:219], v[180:183]
v_swap_b32 v91, v93
s_nop 1
v_mfma_f32_16x16x32_bf16 v[136:139], v[88:91], v[24:27], 0
v_mfma_f32_16x16x32_bf16 v[140:143], v[92:95], v[24:27], 0
v_mfma_f32_16x16x32_bf16 v[184:187], a[136:139], v[216:219], v[184:187]
v_mfma_f32_16x16x32_bf16 v[188:191], a[140:143], v[216:219], v[188:191]
s_waitcnt lgkmcnt(4)
v_mfma_f32_16x16x32_bf16 v[176:179], a[144:147], v[220:223], v[176:179]
ds_read_b128 v[216:219], v252 offset:14336
v_mfma_f32_16x16x32_bf16 v[180:183], a[148:151], v[220:223], v[180:183]
v_mfma_f32_16x16x32_bf16 v[184:187], a[152:155], v[220:223], v[184:187]
v_mfma_f32_16x16x32_bf16 v[188:191], a[156:159], v[220:223], v[188:191]
s_waitcnt vmcnt(10)
s_waitcnt lgkmcnt(4)
v_mfma_f32_16x16x32_bf16 v[176:179], a[160:163], v[224:227], v[176:179]
v_swap_b32 v98, v100
v_mfma_f32_16x16x32_bf16 v[180:183], a[164:167], v[224:227], v[180:183]
v_swap_b32 v99, v101
s_nop 1
v_mfma_f32_16x16x32_bf16 v[136:139], v[96:99], v[28:31], v[136:139]
v_mfma_f32_16x16x32_bf16 v[140:143], v[100:103], v[28:31], v[140:143]
v_mfma_f32_16x16x32_bf16 v[184:187], a[168:171], v[224:227], v[184:187]
v_mfma_f32_16x16x32_bf16 v[188:191], a[172:175], v[224:227], v[188:191]
s_waitcnt lgkmcnt(3)
v_mfma_f32_16x16x32_bf16 v[176:179], a[176:179], v[228:231], v[176:179]
v_mfma_f32_16x16x32_bf16 v[180:183], a[180:183], v[228:231], v[180:183]
v_mfma_f32_16x16x32_bf16 v[184:187], a[184:187], v[228:231], v[184:187]
v_mfma_f32_16x16x32_bf16 v[188:191], a[188:191], v[228:231], v[188:191]
s_waitcnt vmcnt(8)
s_waitcnt lgkmcnt(2)
v_mfma_f32_16x16x32_bf16 v[176:179], a[192:195], v[208:211], v[176:179]
v_swap_b32 v114, v116
v_mfma_f32_16x16x32_bf16 v[180:183], a[196:199], v[208:211], v[180:183]
v_swap_b32 v115, v117
s_nop 1
v_mfma_f32_16x16x32_bf16 v[136:139], v[112:115], v[32:35], v[136:139]
v_mfma_f32_16x16x32_bf16 v[140:143], v[116:119], v[32:35], v[140:143]
v_mfma_f32_16x16x32_bf16 v[184:187], a[200:203], v[208:211], v[184:187]
v_mfma_f32_16x16x32_bf16 v[188:191], a[204:207], v[208:211], v[188:191]
s_waitcnt lgkmcnt(1)
v_mfma_f32_16x16x32_bf16 v[176:179], a[208:211], v[212:215], v[176:179]
v_mfma_f32_16x16x32_bf16 v[180:183], a[212:215], v[212:215], v[180:183]
v_mfma_f32_16x16x32_bf16 v[184:187], a[216:219], v[212:215], v[184:187]
v_mfma_f32_16x16x32_bf16 v[188:191], a[220:223], v[212:215], v[188:191]
s_waitcnt lgkmcnt(0)
v_mfma_f32_16x16x32_bf16 v[176:179], a[224:227], v[216:219], v[176:179]
v_mul_f32 v136, v136, v42
v_mul_f32 v137, v137, v42
v_mfma_f32_16x16x32_bf16 v[180:183], a[228:231], v[216:219], v[180:183]
v_mul_f32 v138, v138, v42
v_mul_f32 v139, v139, v42
v_mfma_f32_16x16x32_bf16 v[184:187], a[232:235], v[216:219], v[184:187]
v_mul_f32 v140, v140, v42
v_mul_f32 v141, v141, v42
v_mfma_f32_16x16x32_bf16 v[188:191], a[236:239], v[216:219], v[188:191]
v_mul_f32 v142, v142, v42
v_mul_f32 v143, v143, v42
v_cvt_pk_bf16_f32 v136, v136, v137
v_cvt_pk_bf16_f32 v137, v138, v139
v_cvt_pk_bf16_f32 v138, v140, v141
v_cvt_pk_bf16_f32 v139, v142, v143
ds_write_b128 v251, v[136:139] offset:16384
s_waitcnt lgkmcnt(0)
s_barrier
ds_read_b128 v[220:223], v252 offset:15360
ds_read_b128 v[224:227], v252 offset:16384
ds_read_b128 v[228:231], v252 offset:17408
ds_read_b128 v[208:211], v252 offset:18432
ds_read_b128 v[212:215], v252 offset:19456
s_waitcnt vmcnt(6)
s_waitcnt lgkmcnt(4)
v_mfma_f32_16x16x32_bf16 v[176:179], a[240:243], v[220:223], v[176:179]
v_swap_b32 v122, v124
v_mfma_f32_16x16x32_bf16 v[180:183], a[244:247], v[220:223], v[180:183]
v_swap_b32 v123, v125
s_nop 1
v_mfma_f32_16x16x32_bf16 v[128:131], v[120:123], v[24:27], 0
v_mfma_f32_16x16x32_bf16 v[132:135], v[124:127], v[24:27], 0
v_mfma_f32_16x16x32_bf16 v[184:187], a[248:251], v[220:223], v[184:187]
v_mfma_f32_16x16x32_bf16 v[188:191], a[252:255], v[220:223], v[188:191]
s_waitcnt lgkmcnt(3)
v_mfma_f32_16x16x32_bf16 v[192:195], a[128:131], v[224:227], v[192:195]
v_mfma_f32_16x16x32_bf16 v[196:199], a[132:135], v[224:227], v[196:199]
v_mfma_f32_16x16x32_bf16 v[200:203], a[136:139], v[224:227], v[200:203]
v_mfma_f32_16x16x32_bf16 v[204:207], a[140:143], v[224:227], v[204:207]
s_waitcnt vmcnt(4)
s_waitcnt lgkmcnt(2)
v_mfma_f32_16x16x32_bf16 v[192:195], a[144:147], v[228:231], v[192:195]
v_swap_b32 v50, v52
v_mfma_f32_16x16x32_bf16 v[196:199], a[148:151], v[228:231], v[196:199]
v_swap_b32 v51, v53
s_nop 1
v_mfma_f32_16x16x32_bf16 v[128:131], v[48:51], v[28:31], v[128:131]
v_cvt_pk_bf16_f32 v176, v176, v177
v_cvt_pk_bf16_f32 v177, v178, v179
v_mfma_f32_16x16x32_bf16 v[132:135], v[52:55], v[28:31], v[132:135]
v_cvt_pk_bf16_f32 v178, v180, v181
v_cvt_pk_bf16_f32 v179, v182, v183
v_mfma_f32_16x16x32_bf16 v[200:203], a[152:155], v[228:231], v[200:203]
ds_write_b128 v245, v[176:179] offset:2048
v_cvt_pk_bf16_f32 v184, v184, v185
v_mfma_f32_16x16x32_bf16 v[204:207], a[156:159], v[228:231], v[204:207]
v_cvt_pk_bf16_f32 v185, v186, v187
v_cvt_pk_bf16_f32 v186, v188, v189
s_waitcnt lgkmcnt(2)
v_mfma_f32_16x16x32_bf16 v[192:195], a[160:163], v[208:211], v[192:195]
v_cvt_pk_bf16_f32 v187, v190, v191
ds_write_b128 v246, v[184:187] offset:2048
v_mfma_f32_16x16x32_bf16 v[196:199], a[164:167], v[208:211], v[196:199]
ds_read_b128 v[180:183], v247 offset:2048
ds_read_b128 v[188:191], v247 offset:3072
v_mfma_f32_16x16x32_bf16 v[200:203], a[168:171], v[208:211], v[200:203]
v_mfma_f32_16x16x32_bf16 v[204:207], a[172:175], v[208:211], v[204:207]
s_waitcnt vmcnt(2)
s_waitcnt lgkmcnt(4)
v_mfma_f32_16x16x32_bf16 v[192:195], a[176:179], v[212:215], v[192:195]
v_swap_b32 v58, v60
v_mfma_f32_16x16x32_bf16 v[196:199], a[180:183], v[212:215], v[196:199]
v_swap_b32 v59, v61
s_nop 1
v_mfma_f32_16x16x32_bf16 v[128:131], v[56:59], v[32:35], v[128:131]
s_waitcnt lgkmcnt(1)
buffer_store_dwordx4 v[180:183], v44, s[56:59], s7 offen sc1
v_mfma_f32_16x16x32_bf16 v[132:135], v[60:63], v[32:35], v[132:135]
s_waitcnt lgkmcnt(0)
buffer_store_dwordx4 v[188:191], v45, s[56:59], s7 offen sc1
v_mfma_f32_16x16x32_bf16 v[200:203], a[184:187], v[212:215], v[200:203]
v_mfma_f32_16x16x32_bf16 v[204:207], a[188:191], v[212:215], v[204:207]
s_nop 0
v_mul_f32 v128, v128, v42
v_mul_f32 v129, v129, v42
v_mul_f32 v130, v130, v42
v_mul_f32 v131, v131, v42
v_mul_f32 v132, v132, v42
v_mul_f32 v133, v133, v42
v_mul_f32 v134, v134, v42
v_mul_f32 v135, v135, v42
v_cvt_pk_bf16_f32 v128, v128, v129
v_cvt_pk_bf16_f32 v129, v130, v131
v_cvt_pk_bf16_f32 v130, v132, v133
v_cvt_pk_bf16_f32 v131, v134, v135
ds_write_b128 v251, v[128:131] offset:20480
s_waitcnt lgkmcnt(0)
s_barrier
ds_read_b128 v[216:219], v252 offset:20480
ds_read_b128 v[220:223], v252 offset:21504
ds_read_b128 v[224:227], v252 offset:22528
ds_read_b128 v[228:231], v252 offset:23552
s_waitcnt lgkmcnt(3)
v_mfma_f32_16x16x32_bf16 v[192:195], a[192:195], v[216:219], v[192:195]
v_mfma_f32_16x16x32_bf16 v[196:199], a[196:199], v[216:219], v[196:199]
v_mfma_f32_16x16x32_bf16 v[200:203], a[200:203], v[216:219], v[200:203]
v_mfma_f32_16x16x32_bf16 v[204:207], a[204:207], v[216:219], v[204:207]
s_waitcnt lgkmcnt(2)
v_mfma_f32_16x16x32_bf16 v[192:195], a[208:211], v[220:223], v[192:195]
v_mfma_f32_16x16x32_bf16 v[196:199], a[212:215], v[220:223], v[196:199]
v_mfma_f32_16x16x32_bf16 v[200:203], a[216:219], v[220:223], v[200:203]
v_mfma_f32_16x16x32_bf16 v[204:207], a[220:223], v[220:223], v[204:207]
s_waitcnt lgkmcnt(1)
v_mfma_f32_16x16x32_bf16 v[192:195], a[224:227], v[224:227], v[192:195]
v_mfma_f32_16x16x32_bf16 v[196:199], a[228:231], v[224:227], v[196:199]
v_mfma_f32_16x16x32_bf16 v[200:203], a[232:235], v[224:227], v[200:203]
v_mfma_f32_16x16x32_bf16 v[204:207], a[236:239], v[224:227], v[204:207]
s_waitcnt lgkmcnt(0)
v_mfma_f32_16x16x32_bf16 v[192:195], a[240:243], v[228:231], v[192:195]
v_mfma_f32_16x16x32_bf16 v[196:199], a[244:247], v[228:231], v[196:199]
v_mfma_f32_16x16x32_bf16 v[200:203], a[248:251], v[228:231], v[200:203]
v_mfma_f32_16x16x32_bf16 v[204:207], a[252:255], v[228:231], v[204:207]
s_nop 4
v_cvt_pk_bf16_f32 v192, v192, v193
v_cvt_pk_bf16_f32 v193, v194, v195
v_cvt_pk_bf16_f32 v194, v196, v197
v_cvt_pk_bf16_f32 v195, v198, v199
ds_write_b128 v245, v[192:195] offset:4096
v_cvt_pk_bf16_f32 v200, v200, v201
v_cvt_pk_bf16_f32 v201, v202, v203
v_cvt_pk_bf16_f32 v202, v204, v205
v_cvt_pk_bf16_f32 v203, v206, v207
ds_write_b128 v246, v[200:203] offset:4096
ds_read_b128 v[196:199], v247 offset:4096
ds_read_b128 v[204:207], v247 offset:5120
s_waitcnt lgkmcnt(1)
buffer_store_dwordx4 v[196:199], v44, s[56:59], s29 offen sc1
s_waitcnt lgkmcnt(0)
buffer_store_dwordx4 v[204:207], v45, s[56:59], s29 offen sc1
s_branch L2_fin
LF_spinQ:
s_mov_b32 s94, 0x10000
LF_spin2Q:
buffer_load_dwordx2 v[242:243], v46, s[16:19], 0 offen offset:0 sc1
s_sub_u32 s94, s94, 1
s_waitcnt vmcnt(0)
s_cbranch_scc1 LF_spin2Q_go
v_cmp_ne_u64 vcc, s[98:99], v[242:243]
s_nop 1
s_cbranch_vccnz LF_spin2Q
LF_spin2Q_go:
s_branch LF_goQ
LF_wf:
s_mov_b32 s94, 0x10000
LF_wf2:
buffer_load_dwordx2 v[108:109], v110, s[16:19], 0 offen sc1
s_sub_u32 s94, s94, 1
s_waitcnt vmcnt(0)
s_cbranch_scc1 LF_wf2_go
v_cmp_ne_u64 vcc, s[98:99], v[108:109]
s_nop 1
s_cbranch_vccnz LF_wf2
LF_wf2_go:
s_branch LF_wf_go
LM_pb:
s_mov_b32 s3, 0x10000
LM_pb2:
buffer_load_dwordx2 v[252:253], v251, s[16:19], 0 offen sc1
s_sub_u32 s3, s3, 1
s_waitcnt vmcnt(0)
s_cbranch_scc1 LM_pb2_go
v_cmp_ne_u64 vcc, s[98:99], v[252:253]
s_nop 1
s_cbranch_vccnz LM_pb2
LM_pb2_go:
s_branch LM_pb_ret
L2_Fend:
L2_rare_site0:
s_mov_b32 s36, 0
s_branch L2_rare_0_0
L2_rare_0_0:
s_nop 15
s_nop 15
s_waitcnt lgkmcnt(0)
v_log_f32 v243, v224
v_max3_f32 v232, v128, v129, v130
v_max3_f32 v232, v232, v131, v243
v_mov_b32 v243, v232
s_nop 1
v_permlane32_swap_b32 v232, v243
s_nop 1
v_max_f32 v232, v232, v243
v_mov_b32 v243, v232
s_nop 1
v_permlane16_swap_b32 v232, v243
s_nop 1
v_max_f32 v232, v232, v243
v_ceil_f32 v232, v232
v_max_f32 v232, 0, v232
v_sub_f32 v243, 0, v232
v_exp_f32 v236, v243
s_nop 1
v_mul_f32 v224, v224, v236
v_add_f32 v244, v244, v232
v_sub_f32 v192, v192, v232
v_sub_f32 v128, v128, v232
v_sub_f32 v144, v144, v232
v_sub_f32 v193, v193, v232
v_sub_f32 v129, v129, v232
v_sub_f32 v145, v145, v232
v_sub_f32 v194, v194, v232
v_sub_f32 v130, v130, v232
v_sub_f32 v146, v146, v232
v_sub_f32 v195, v195, v232
v_sub_f32 v131, v131, v232
v_sub_f32 v147, v147, v232
v_lshlrev_b32 v242, 16, v160
v_and_b32 v243, 0xffff0000, v160
v_mul_f32 v242, v242, v236
v_mul_f32 v243, v243, v236
v_cvt_pk_bf16_f32 v160, v242, v243
v_lshlrev_b32 v242, 16, v161
v_and_b32 v243, 0xffff0000, v161
v_mul_f32 v242, v242, v236
v_mul_f32 v243, v243, v236
v_cvt_pk_bf16_f32 v161, v242, v243
v_lshlrev_b32 v242, 16, v162
v_and_b32 v243, 0xffff0000, v162
v_mul_f32 v242, v242, v236
v_mul_f32 v243, v243, v236
v_cvt_pk_bf16_f32 v162, v242, v243
v_lshlrev_b32 v242, 16, v163
v_and_b32 v243, 0xffff0000, v163
v_mul_f32 v242, v242, v236
v_mul_f32 v243, v243, v236
v_cvt_pk_bf16_f32 v163, v242, v243
v_log_f32 v243, v225
v_max3_f32 v233, v132, v133, v134
v_max3_f32 v233, v233, v135, v243
v_mov_b32 v243, v233
s_nop 1
v_permlane32_swap_b32 v233, v243
s_nop 1
v_max_f32 v233, v233, v243
v_mov_b32 v243, v233
s_nop 1
v_permlane16_swap_b32 v233, v243
s_nop 1
v_max_f32 v233, v233, v243
v_ceil_f32 v233, v233
v_max_f32 v233, 0, v233
v_sub_f32 v243, 0, v233
v_exp_f32 v237, v243
s_nop 1
v_mul_f32 v225, v225, v237
v_add_f32 v245, v245, v233
v_sub_f32 v196, v196, v233
v_sub_f32 v132, v132, v233
v_sub_f32 v148, v148, v233
v_sub_f32 v197, v197, v233
v_sub_f32 v133, v133, v233
v_sub_f32 v149, v149, v233
v_sub_f32 v198, v198, v233
v_sub_f32 v134, v134, v233
v_sub_f32 v150, v150, v233
v_sub_f32 v199, v199, v233
v_sub_f32 v135, v135, v233
v_sub_f32 v151, v151, v233
v_lshlrev_b32 v242, 16, v164
v_and_b32 v243, 0xffff0000, v164
v_mul_f32 v242, v242, v237
v_mul_f32 v243, v243, v237
v_cvt_pk_bf16_f32 v164, v242, v243
v_lshlrev_b32 v242, 16, v165
v_and_b32 v243, 0xffff0000, v165
v_mul_f32 v242, v242, v237
v_mul_f32 v243, v243, v237
v_cvt_pk_bf16_f32 v165, v242, v243
v_lshlrev_b32 v242, 16, v166
v_and_b32 v243, 0xffff0000, v166
v_mul_f32 v242, v242, v237
v_mul_f32 v243, v243, v237
v_cvt_pk_bf16_f32 v166, v242, v243
v_lshlrev_b32 v242, 16, v167
v_and_b32 v243, 0xffff0000, v167
v_mul_f32 v242, v242, v237
v_mul_f32 v243, v243, v237
v_cvt_pk_bf16_f32 v167, v242, v243
v_log_f32 v243, v226
v_max3_f32 v234, v136, v137, v138
v_max3_f32 v234, v234, v139, v243
v_mov_b32 v243, v234
s_nop 1
v_permlane32_swap_b32 v234, v243
s_nop 1
v_max_f32 v234, v234, v243
v_mov_b32 v243, v234
s_nop 1
v_permlane16_swap_b32 v234, v243
s_nop 1
v_max_f32 v234, v234, v243
v_ceil_f32 v234, v234
v_max_f32 v234, 0, v234
v_sub_f32 v243, 0, v234
v_exp_f32 v238, v243
s_nop 1
v_mul_f32 v226, v226, v238
v_add_f32 v246, v246, v234
v_sub_f32 v200, v200, v234
v_sub_f32 v136, v136, v234
v_sub_f32 v152, v152, v234
v_sub_f32 v201, v201, v234
v_sub_f32 v137, v137, v234
v_sub_f32 v153, v153, v234
v_sub_f32 v202, v202, v234
v_sub_f32 v138, v138, v234
v_sub_f32 v154, v154, v234
v_sub_f32 v203, v203, v234
v_sub_f32 v139, v139, v234
v_sub_f32 v155, v155, v234
v_lshlrev_b32 v242, 16, v168
v_and_b32 v243, 0xffff0000, v168
v_mul_f32 v242, v242, v238
v_mul_f32 v243, v243, v238
v_cvt_pk_bf16_f32 v168, v242, v243
v_lshlrev_b32 v242, 16, v169
v_and_b32 v243, 0xffff0000, v169
v_mul_f32 v242, v242, v238
v_mul_f32 v243, v243, v238
v_cvt_pk_bf16_f32 v169, v242, v243
v_lshlrev_b32 v242, 16, v170
v_and_b32 v243, 0xffff0000, v170
v_mul_f32 v242, v242, v238
v_mul_f32 v243, v243, v238
v_cvt_pk_bf16_f32 v170, v242, v243
v_lshlrev_b32 v242, 16, v171
v_and_b32 v243, 0xffff0000, v171
v_mul_f32 v242, v242, v238
v_mul_f32 v243, v243, v238
v_cvt_pk_bf16_f32 v171, v242, v243
v_log_f32 v243, v227
v_max3_f32 v235, v140, v141, v142
v_max3_f32 v235, v235, v143, v243
v_mov_b32 v243, v235
s_nop 1
v_permlane32_swap_b32 v235, v243
s_nop 1
v_max_f32 v235, v235, v243
v_mov_b32 v243, v235
s_nop 1
v_permlane16_swap_b32 v235, v243
s_nop 1
v_max_f32 v235, v235, v243
v_ceil_f32 v235, v235
v_max_f32 v235, 0, v235
v_sub_f32 v243, 0, v235
v_exp_f32 v239, v243
s_nop 1
v_mul_f32 v227, v227, v239
v_add_f32 v247, v247, v235
v_sub_f32 v204, v204, v235
v_sub_f32 v140, v140, v235
v_sub_f32 v156, v156, v235
v_sub_f32 v205, v205, v235
v_sub_f32 v141, v141, v235
v_sub_f32 v157, v157, v235
v_sub_f32 v206, v206, v235
v_sub_f32 v142, v142, v235
v_sub_f32 v158, v158, v235
v_sub_f32 v207, v207, v235
v_sub_f32 v143, v143, v235
v_sub_f32 v159, v159, v235
v_lshlrev_b32 v242, 16, v172
v_and_b32 v243, 0xffff0000, v172
v_mul_f32 v242, v242, v239
v_mul_f32 v243, v243, v239
v_cvt_pk_bf16_f32 v172, v242, v243
v_lshlrev_b32 v242, 16, v173
v_and_b32 v243, 0xffff0000, v173
v_mul_f32 v242, v242, v239
v_mul_f32 v243, v243, v239
v_cvt_pk_bf16_f32 v173, v242, v243
v_lshlrev_b32 v242, 16, v174
v_and_b32 v243, 0xffff0000, v174
v_mul_f32 v242, v242, v239
v_mul_f32 v243, v243, v239
v_cvt_pk_bf16_f32 v174, v242, v243
v_lshlrev_b32 v242, 16, v175
v_and_b32 v243, 0xffff0000, v175
v_mul_f32 v242, v242, v239
v_mul_f32 v243, v243, v239
v_cvt_pk_bf16_f32 v175, v242, v243
v_exp_f32 v232, v128
v_exp_f32 v233, v129
v_exp_f32 v234, v130
v_exp_f32 v235, v131
s_nop 1
v_add_f32 v228, v224, v232
v_add_f32 v228, v228, v233
v_add_f32 v228, v228, v234
v_add_f32 v228, v228, v235
v_cvt_pk_bf16_f32 v176, v232, v233
v_cvt_pk_bf16_f32 v177, v234, v235
v_exp_f32 v232, v132
v_exp_f32 v233, v133
v_exp_f32 v234, v134
v_exp_f32 v235, v135
s_nop 1
v_add_f32 v229, v225, v232
v_add_f32 v229, v229, v233
v_add_f32 v229, v229, v234
v_add_f32 v229, v229, v235
v_cvt_pk_bf16_f32 v180, v232, v233
v_cvt_pk_bf16_f32 v181, v234, v235
v_exp_f32 v232, v136
v_exp_f32 v233, v137
v_exp_f32 v234, v138
v_exp_f32 v235, v139
s_nop 1
v_add_f32 v230, v226, v232
v_add_f32 v230, v230, v233
v_add_f32 v230, v230, v234
v_add_f32 v230, v230, v235
v_cvt_pk_bf16_f32 v184, v232, v233
v_cvt_pk_bf16_f32 v185, v234, v235
v_exp_f32 v232, v140
v_exp_f32 v233, v141
v_exp_f32 v234, v142
v_exp_f32 v235, v143
s_nop 1
v_add_f32 v231, v227, v232
v_add_f32 v231, v231, v233
v_add_f32 v231, v231, v234
v_add_f32 v231, v231, v235
v_cvt_pk_bf16_f32 v188, v232, v233
v_cvt_pk_bf16_f32 v189, v234, v235
s_branch L2_rare_common
L2_rare_site1:
s_mov_b32 s36, 1
s_branch L2_rare_0_1
L2_rare_0_1:
s_nop 15
s_nop 15
s_waitcnt lgkmcnt(0)
v_log_f32 v243, v228
v_max3_f32 v232, v144, v145, v146
v_max3_f32 v232, v232, v147, v243
v_mov_b32 v243, v232
s_nop 1
v_permlane32_swap_b32 v232, v243
s_nop 1
v_max_f32 v232, v232, v243
v_mov_b32 v243, v232
s_nop 1
v_permlane16_swap_b32 v232, v243
s_nop 1
v_max_f32 v232, v232, v243
v_ceil_f32 v232, v232
v_max_f32 v232, 0, v232
v_sub_f32 v243, 0, v232
v_exp_f32 v236, v243
s_nop 1
v_mul_f32 v228, v228, v236
v_add_f32 v244, v244, v232
v_sub_f32 v192, v192, v232
v_sub_f32 v128, v128, v232
v_sub_f32 v144, v144, v232
v_sub_f32 v193, v193, v232
v_sub_f32 v129, v129, v232
v_sub_f32 v145, v145, v232
v_sub_f32 v194, v194, v232
v_sub_f32 v130, v130, v232
v_sub_f32 v146, v146, v232
v_sub_f32 v195, v195, v232
v_sub_f32 v131, v131, v232
v_sub_f32 v147, v147, v232
v_lshlrev_b32 v242, 16, v160
v_and_b32 v243, 0xffff0000, v160
v_mul_f32 v242, v242, v236
v_mul_f32 v243, v243, v236
v_cvt_pk_bf16_f32 v160, v242, v243
v_lshlrev_b32 v242, 16, v161
v_and_b32 v243, 0xffff0000, v161
v_mul_f32 v242, v242, v236
v_mul_f32 v243, v243, v236
v_cvt_pk_bf16_f32 v161, v242, v243
v_lshlrev_b32 v242, 16, v162
v_and_b32 v243, 0xffff0000, v162
v_mul_f32 v242, v242, v236
v_mul_f32 v243, v243, v236
v_cvt_pk_bf16_f32 v162, v242, v243
v_lshlrev_b32 v242, 16, v163
v_and_b32 v243, 0xffff0000, v163
v_mul_f32 v242, v242, v236
v_mul_f32 v243, v243, v236
v_cvt_pk_bf16_f32 v163, v242, v243
v_lshlrev_b32 v242, 16, v176
v_and_b32 v243, 0xffff0000, v176
v_mul_f32 v242, v242, v236
v_mul_f32 v243, v243, v236
v_cvt_pk_bf16_f32 v176, v242, v243
v_lshlrev_b32 v242, 16, v177
v_and_b32 v243, 0xffff0000, v177
v_mul_f32 v242, v242, v236
v_mul_f32 v243, v243, v236
v_cvt_pk_bf16_f32 v177, v242, v243
v_log_f32 v243, v229
v_max3_f32 v233, v148, v149, v150
v_max3_f32 v233, v233, v151, v243
v_mov_b32 v243, v233
s_nop 1
v_permlane32_swap_b32 v233, v243
s_nop 1
v_max_f32 v233, v233, v243
v_mov_b32 v243, v233
s_nop 1
v_permlane16_swap_b32 v233, v243
s_nop 1
v_max_f32 v233, v233, v243
v_ceil_f32 v233, v233
v_max_f32 v233, 0, v233
v_sub_f32 v243, 0, v233
v_exp_f32 v237, v243
s_nop 1
v_mul_f32 v229, v229, v237
v_add_f32 v245, v245, v233
v_sub_f32 v196, v196, v233
v_sub_f32 v132, v132, v233
v_sub_f32 v148, v148, v233
v_sub_f32 v197, v197, v233
v_sub_f32 v133, v133, v233
v_sub_f32 v149, v149, v233
v_sub_f32 v198, v198, v233
v_sub_f32 v134, v134, v233
v_sub_f32 v150, v150, v233
v_sub_f32 v199, v199, v233
v_sub_f32 v135, v135, v233
v_sub_f32 v151, v151, v233
v_lshlrev_b32 v242, 16, v164
v_and_b32 v243, 0xffff0000, v164
v_mul_f32 v242, v242, v237
v_mul_f32 v243, v243, v237
v_cvt_pk_bf16_f32 v164, v242, v243
v_lshlrev_b32 v242, 16, v165
v_and_b32 v243, 0xffff0000, v165
v_mul_f32 v242, v242, v237
v_mul_f32 v243, v243, v237
v_cvt_pk_bf16_f32 v165, v242, v243
v_lshlrev_b32 v242, 16, v166
v_and_b32 v243, 0xffff0000, v166
v_mul_f32 v242, v242, v237
v_mul_f32 v243, v243, v237
v_cvt_pk_bf16_f32 v166, v242, v243
v_lshlrev_b32 v242, 16, v167
v_and_b32 v243, 0xffff0000, v167
v_mul_f32 v242, v242, v237
v_mul_f32 v243, v243, v237
v_cvt_pk_bf16_f32 v167, v242, v243
v_lshlrev_b32 v242, 16, v180
v_and_b32 v243, 0xffff0000, v180
v_mul_f32 v242, v242, v237
v_mul_f32 v243, v243, v237
v_cvt_pk_bf16_f32 v180, v242, v243
v_lshlrev_b32 v242, 16, v181
v_and_b32 v243, 0xffff0000, v181
v_mul_f32 v242, v242, v237
v_mul_f32 v243, v243, v237
v_cvt_pk_bf16_f32 v181, v242, v243
v_log_f32 v243, v230
v_max3_f32 v234, v152, v153, v154
v_max3_f32 v234, v234, v155, v243
v_mov_b32 v243, v234
s_nop 1
v_permlane32_swap_b32 v234, v243
s_nop 1
v_max_f32 v234, v234, v243
v_mov_b32 v243, v234
s_nop 1
v_permlane16_swap_b32 v234, v243
s_nop 1
v_max_f32 v234, v234, v243
v_ceil_f32 v234, v234
v_max_f32 v234, 0, v234
v_sub_f32 v243, 0, v234
v_exp_f32 v238, v243
s_nop 1
v_mul_f32 v230, v230, v238
v_add_f32 v246, v246, v234
v_sub_f32 v200, v200, v234
v_sub_f32 v136, v136, v234
v_sub_f32 v152, v152, v234
v_sub_f32 v201, v201, v234
v_sub_f32 v137, v137, v234
v_sub_f32 v153, v153, v234
v_sub_f32 v202, v202, v234
v_sub_f32 v138, v138, v234
v_sub_f32 v154, v154, v234
v_sub_f32 v203, v203, v234
v_sub_f32 v139, v139, v234
v_sub_f32 v155, v155, v234
v_lshlrev_b32 v242, 16, v168
v_and_b32 v243, 0xffff0000, v168
v_mul_f32 v242, v242, v238
v_mul_f32 v243, v243, v238
v_cvt_pk_bf16_f32 v168, v242, v243
v_lshlrev_b32 v242, 16, v169
v_and_b32 v243, 0xffff0000, v169
v_mul_f32 v242, v242, v238
v_mul_f32 v243, v243, v238
v_cvt_pk_bf16_f32 v169, v242, v243
v_lshlrev_b32 v242, 16, v170
v_and_b32 v243, 0xffff0000, v170
v_mul_f32 v242, v242, v238
v_mul_f32 v243, v243, v238
v_cvt_pk_bf16_f32 v170, v242, v243
v_lshlrev_b32 v242, 16, v171
v_and_b32 v243, 0xffff0000, v171
v_mul_f32 v242, v242, v238
v_mul_f32 v243, v243, v238
v_cvt_pk_bf16_f32 v171, v242, v243
v_lshlrev_b32 v242, 16, v184
v_and_b32 v243, 0xffff0000, v184
v_mul_f32 v242, v242, v238
v_mul_f32 v243, v243, v238
v_cvt_pk_bf16_f32 v184, v242, v243
v_lshlrev_b32 v242, 16, v185
v_and_b32 v243, 0xffff0000, v185
v_mul_f32 v242, v242, v238
v_mul_f32 v243, v243, v238
v_cvt_pk_bf16_f32 v185, v242, v243
v_log_f32 v243, v231
v_max3_f32 v235, v156, v157, v158
v_max3_f32 v235, v235, v159, v243
v_mov_b32 v243, v235
s_nop 1
v_permlane32_swap_b32 v235, v243
s_nop 1
v_max_f32 v235, v235, v243
v_mov_b32 v243, v235
s_nop 1
v_permlane16_swap_b32 v235, v243
s_nop 1
v_max_f32 v235, v235, v243
v_ceil_f32 v235, v235
v_max_f32 v235, 0, v235
v_sub_f32 v243, 0, v235
v_exp_f32 v239, v243
s_nop 1
v_mul_f32 v231, v231, v239
v_add_f32 v247, v247, v235
v_sub_f32 v204, v204, v235
v_sub_f32 v140, v140, v235
v_sub_f32 v156, v156, v235
v_sub_f32 v205, v205, v235
v_sub_f32 v141, v141, v235
v_sub_f32 v157, v157, v235
v_sub_f32 v206, v206, v235
v_sub_f32 v142, v142, v235
v_sub_f32 v158, v158, v235
v_sub_f32 v207, v207, v235
v_sub_f32 v143, v143, v235
v_sub_f32 v159, v159, v235
v_lshlrev_b32 v242, 16, v172
v_and_b32 v243, 0xffff0000, v172
v_mul_f32 v242, v242, v239
v_mul_f32 v243, v243, v239
v_cvt_pk_bf16_f32 v172, v242, v243
v_lshlrev_b32 v242, 16, v173
v_and_b32 v243, 0xffff0000, v173
v_mul_f32 v242, v242, v239
v_mul_f32 v243, v243, v239
v_cvt_pk_bf16_f32 v173, v242, v243
v_lshlrev_b32 v242, 16, v174
v_and_b32 v243, 0xffff0000, v174
v_mul_f32 v242, v242, v239
v_mul_f32 v243, v243, v239
v_cvt_pk_bf16_f32 v174, v242, v243
v_lshlrev_b32 v242, 16, v175
v_and_b32 v243, 0xffff0000, v175
v_mul_f32 v242, v242, v239
v_mul_f32 v243, v243, v239
v_cvt_pk_bf16_f32 v175, v242, v243
v_lshlrev_b32 v242, 16, v188
v_and_b32 v243, 0xffff0000, v188
v_mul_f32 v242, v242, v239
v_mul_f32 v243, v243, v239
v_cvt_pk_bf16_f32 v188, v242, v243
v_lshlrev_b32 v242, 16, v189
v_and_b32 v243, 0xffff0000, v189
v_mul_f32 v242, v242, v239
v_mul_f32 v243, v243, v239
v_cvt_pk_bf16_f32 v189, v242, v243
v_exp_f32 v232, v144
v_exp_f32 v233, v145
v_exp_f32 v234, v146
v_exp_f32 v235, v147
s_nop 1
v_add_f32 v224, v228, v232
v_add_f32 v224, v224, v233
v_add_f32 v224, v224, v234
v_add_f32 v224, v224, v235
v_cvt_pk_bf16_f32 v178, v232, v233
v_cvt_pk_bf16_f32 v179, v234, v235
v_exp_f32 v232, v148
v_exp_f32 v233, v149
v_exp_f32 v234, v150
v_exp_f32 v235, v151
s_nop 1
v_add_f32 v225, v229, v232
v_add_f32 v225, v225, v233
v_add_f32 v225, v225, v234
v_add_f32 v225, v225, v235
v_cvt_pk_bf16_f32 v182, v232, v233
v_cvt_pk_bf16_f32 v183, v234, v235
v_exp_f32 v232, v152
v_exp_f32 v233, v153
v_exp_f32 v234, v154
v_exp_f32 v235, v155
s_nop 1
v_add_f32 v226, v230, v232
v_add_f32 v226, v226, v233
v_add_f32 v226, v226, v234
v_add_f32 v226, v226, v235
v_cvt_pk_bf16_f32 v186, v232, v233
v_cvt_pk_bf16_f32 v187, v234, v235
v_exp_f32 v232, v156
v_exp_f32 v233, v157
v_exp_f32 v234, v158
v_exp_f32 v235, v159
s_nop 1
v_add_f32 v227, v231, v232
v_add_f32 v227, v227, v233
v_add_f32 v227, v227, v234
v_add_f32 v227, v227, v235
v_cvt_pk_bf16_f32 v190, v232, v233
v_cvt_pk_bf16_f32 v191, v234, v235
s_branch L2_rare_common
L2_rare_site2:
s_mov_b32 s36, 2
s_branch L2_rare_1_0
L2_rare_1_0:
s_nop 15
s_nop 15
s_waitcnt lgkmcnt(0)
v_log_f32 v243, v224
v_max3_f32 v232, v128, v129, v130
v_max3_f32 v232, v232, v131, v243
v_mov_b32 v243, v232
s_nop 1
v_permlane32_swap_b32 v232, v243
s_nop 1
v_max_f32 v232, v232, v243
v_mov_b32 v243, v232
s_nop 1
v_permlane16_swap_b32 v232, v243
s_nop 1
v_max_f32 v232, v232, v243
v_ceil_f32 v232, v232
v_max_f32 v232, 0, v232
v_sub_f32 v243, 0, v232
v_exp_f32 v236, v243
s_nop 1
v_mul_f32 v224, v224, v236
v_add_f32 v244, v244, v232
v_sub_f32 v192, v192, v232
v_sub_f32 v128, v128, v232
v_sub_f32 v144, v144, v232
v_sub_f32 v193, v193, v232
v_sub_f32 v129, v129, v232
v_sub_f32 v145, v145, v232
v_sub_f32 v194, v194, v232
v_sub_f32 v130, v130, v232
v_sub_f32 v146, v146, v232
v_sub_f32 v195, v195, v232
v_sub_f32 v131, v131, v232
v_sub_f32 v147, v147, v232
v_lshlrev_b32 v242, 16, v176
v_and_b32 v243, 0xffff0000, v176
v_mul_f32 v242, v242, v236
v_mul_f32 v243, v243, v236
v_cvt_pk_bf16_f32 v176, v242, v243
v_lshlrev_b32 v242, 16, v177
v_and_b32 v243, 0xffff0000, v177
v_mul_f32 v242, v242, v236
v_mul_f32 v243, v243, v236
v_cvt_pk_bf16_f32 v177, v242, v243
v_lshlrev_b32 v242, 16, v178
v_and_b32 v243, 0xffff0000, v178
v_mul_f32 v242, v242, v236
v_mul_f32 v243, v243, v236
v_cvt_pk_bf16_f32 v178, v242, v243
v_lshlrev_b32 v242, 16, v179
v_and_b32 v243, 0xffff0000, v179
v_mul_f32 v242, v242, v236
v_mul_f32 v243, v243, v236
v_cvt_pk_bf16_f32 v179, v242, v243
v_log_f32 v243, v225
v_max3_f32 v233, v132, v133, v134
v_max3_f32 v233, v233, v135, v243
v_mov_b32 v243, v233
s_nop 1
v_permlane32_swap_b32 v233, v243
s_nop 1
v_max_f32 v233, v233, v243
v_mov_b32 v243, v233
s_nop 1
v_permlane16_swap_b32 v233, v243
s_nop 1
v_max_f32 v233, v233, v243
v_ceil_f32 v233, v233
v_max_f32 v233, 0, v233
v_sub_f32 v243, 0, v233
v_exp_f32 v237, v243
s_nop 1
v_mul_f32 v225, v225, v237
v_add_f32 v245, v245, v233
v_sub_f32 v196, v196, v233
v_sub_f32 v132, v132, v233
v_sub_f32 v148, v148, v233
v_sub_f32 v197, v197, v233
v_sub_f32 v133, v133, v233
v_sub_f32 v149, v149, v233
v_sub_f32 v198, v198, v233
v_sub_f32 v134, v134, v233
v_sub_f32 v150, v150, v233
v_sub_f32 v199, v199, v233
v_sub_f32 v135, v135, v233
v_sub_f32 v151, v151, v233
v_lshlrev_b32 v242, 16, v180
v_and_b32 v243, 0xffff0000, v180
v_mul_f32 v242, v242, v237
v_mul_f32 v243, v243, v237
v_cvt_pk_bf16_f32 v180, v242, v243
v_lshlrev_b32 v242, 16, v181
v_and_b32 v243, 0xffff0000, v181
v_mul_f32 v242, v242, v237
v_mul_f32 v243, v243, v237
v_cvt_pk_bf16_f32 v181, v242, v243
v_lshlrev_b32 v242, 16, v182
v_and_b32 v243, 0xffff0000, v182
v_mul_f32 v242, v242, v237
v_mul_f32 v243, v243, v237
v_cvt_pk_bf16_f32 v182, v242, v243
v_lshlrev_b32 v242, 16, v183
v_and_b32 v243, 0xffff0000, v183
v_mul_f32 v242, v242, v237
v_mul_f32 v243, v243, v237
v_cvt_pk_bf16_f32 v183, v242, v243
v_log_f32 v243, v226
v_max3_f32 v234, v136, v137, v138
v_max3_f32 v234, v234, v139, v243
v_mov_b32 v243, v234
s_nop 1
v_permlane32_swap_b32 v234, v243
s_nop 1
v_max_f32 v234, v234, v243
v_mov_b32 v243, v234
s_nop 1
v_permlane16_swap_b32 v234, v243
s_nop 1
v_max_f32 v234, v234, v243
v_ceil_f32 v234, v234
v_max_f32 v234, 0, v234
v_sub_f32 v243, 0, v234
v_exp_f32 v238, v243
s_nop 1
v_mul_f32 v226, v226, v238
v_add_f32 v246, v246, v234
v_sub_f32 v200, v200, v234
v_sub_f32 v136, v136, v234
v_sub_f32 v152, v152, v234
v_sub_f32 v201, v201, v234
v_sub_f32 v137, v137, v234
v_sub_f32 v153, v153, v234
v_sub_f32 v202, v202, v234
v_sub_f32 v138, v138, v234
v_sub_f32 v154, v154, v234
v_sub_f32 v203, v203, v234
v_sub_f32 v139, v139, v234
v_sub_f32 v155, v155, v234
v_lshlrev_b32 v242, 16, v184
v_and_b32 v243, 0xffff0000, v184
v_mul_f32 v242, v242, v238
v_mul_f32 v243, v243, v238
v_cvt_pk_bf16_f32 v184, v242, v243
v_lshlrev_b32 v242, 16, v185
v_and_b32 v243, 0xffff0000, v185
v_mul_f32 v242, v242, v238
v_mul_f32 v243, v243, v238
v_cvt_pk_bf16_f32 v185, v242, v243
v_lshlrev_b32 v242, 16, v186
v_and_b32 v243, 0xffff0000, v186
v_mul_f32 v242, v242, v238
v_mul_f32 v243, v243, v238
v_cvt_pk_bf16_f32 v186, v242, v243
v_lshlrev_b32 v242, 16, v187
v_and_b32 v243, 0xffff0000, v187
v_mul_f32 v242, v242, v238
v_mul_f32 v243, v243, v238
v_cvt_pk_bf16_f32 v187, v242, v243
v_log_f32 v243, v227
v_max3_f32 v235, v140, v141, v142
v_max3_f32 v235, v235, v143, v243
v_mov_b32 v243, v235
s_nop 1
v_permlane32_swap_b32 v235, v243
s_nop 1
v_max_f32 v235, v235, v243
v_mov_b32 v243, v235
s_nop 1
v_permlane16_swap_b32 v235, v243
s_nop 1
v_max_f32 v235, v235, v243
v_ceil_f32 v235, v235
v_max_f32 v235, 0, v235
v_sub_f32 v243, 0, v235
v_exp_f32 v239, v243
s_nop 1
v_mul_f32 v227, v227, v239
v_add_f32 v247, v247, v235
v_sub_f32 v204, v204, v235
v_sub_f32 v140, v140, v235
v_sub_f32 v156, v156, v235
v_sub_f32 v205, v205, v235
v_sub_f32 v141, v141, v235
v_sub_f32 v157, v157, v235
v_sub_f32 v206, v206, v235
v_sub_f32 v142, v142, v235
v_sub_f32 v158, v158, v235
v_sub_f32 v207, v207, v235
v_sub_f32 v143, v143, v235
v_sub_f32 v159, v159, v235
v_lshlrev_b32 v242, 16, v188
v_and_b32 v243, 0xffff0000, v188
v_mul_f32 v242, v242, v239
v_mul_f32 v243, v243, v239
v_cvt_pk_bf16_f32 v188, v242, v243
v_lshlrev_b32 v242, 16, v189
v_and_b32 v243, 0xffff0000, v189
v_mul_f32 v242, v242, v239
v_mul_f32 v243, v243, v239
v_cvt_pk_bf16_f32 v189, v242, v243
v_lshlrev_b32 v242, 16, v190
v_and_b32 v243, 0xffff0000, v190
v_mul_f32 v242, v242, v239
v_mul_f32 v243, v243, v239
v_cvt_pk_bf16_f32 v190, v242, v243
v_lshlrev_b32 v242, 16, v191
v_and_b32 v243, 0xffff0000, v191
v_mul_f32 v242, v242, v239
v_mul_f32 v243, v243, v239
v_cvt_pk_bf16_f32 v191, v242, v243
v_exp_f32 v232, v128
v_exp_f32 v233, v129
v_exp_f32 v234, v130
v_exp_f32 v235, v131
s_nop 1
v_add_f32 v228, v224, v232
v_add_f32 v228, v228, v233
v_add_f32 v228, v228, v234
v_add_f32 v228, v228, v235
v_cvt_pk_bf16_f32 v160, v232, v233
v_cvt_pk_bf16_f32 v161, v234, v235
v_exp_f32 v232, v132
v_exp_f32 v233, v133
v_exp_f32 v234, v134
v_exp_f32 v235, v135
s_nop 1
v_add_f32 v229, v225, v232
v_add_f32 v229, v229, v233
v_add_f32 v229, v229, v234
v_add_f32 v229, v229, v235
v_cvt_pk_bf16_f32 v164, v232, v233
v_cvt_pk_bf16_f32 v165, v234, v235
v_exp_f32 v232, v136
v_exp_f32 v233, v137
v_exp_f32 v234, v138
v_exp_f32 v235, v139
s_nop 1
v_add_f32 v230, v226, v232
v_add_f32 v230, v230, v233
v_add_f32 v230, v230, v234
v_add_f32 v230, v230, v235
v_cvt_pk_bf16_f32 v168, v232, v233
v_cvt_pk_bf16_f32 v169, v234, v235
v_exp_f32 v232, v140
v_exp_f32 v233, v141
v_exp_f32 v234, v142
v_exp_f32 v235, v143
s_nop 1
v_add_f32 v231, v227, v232
v_add_f32 v231, v231, v233
v_add_f32 v231, v231, v234
v_add_f32 v231, v231, v235
v_cvt_pk_bf16_f32 v172, v232, v233
v_cvt_pk_bf16_f32 v173, v234, v235
s_branch L2_rare_common
L2_rare_site3:
s_mov_b32 s36, 3
s_branch L2_rare_1_1
L2_rare_1_1:
s_nop 15
s_nop 15
s_waitcnt lgkmcnt(0)
v_log_f32 v243, v228
v_max3_f32 v232, v144, v145, v146
v_max3_f32 v232, v232, v147, v243
v_mov_b32 v243, v232
s_nop 1
v_permlane32_swap_b32 v232, v243
s_nop 1
v_max_f32 v232, v232, v243
v_mov_b32 v243, v232
s_nop 1
v_permlane16_swap_b32 v232, v243
s_nop 1
v_max_f32 v232, v232, v243
v_ceil_f32 v232, v232
v_max_f32 v232, 0, v232
v_sub_f32 v243, 0, v232
v_exp_f32 v236, v243
s_nop 1
v_mul_f32 v228, v228, v236
v_add_f32 v244, v244, v232
v_sub_f32 v192, v192, v232
v_sub_f32 v128, v128, v232
v_sub_f32 v144, v144, v232
v_sub_f32 v193, v193, v232
v_sub_f32 v129, v129, v232
v_sub_f32 v145, v145, v232
v_sub_f32 v194, v194, v232
v_sub_f32 v130, v130, v232
v_sub_f32 v146, v146, v232
v_sub_f32 v195, v195, v232
v_sub_f32 v131, v131, v232
v_sub_f32 v147, v147, v232
v_lshlrev_b32 v242, 16, v176
v_and_b32 v243, 0xffff0000, v176
v_mul_f32 v242, v242, v236
v_mul_f32 v243, v243, v236
v_cvt_pk_bf16_f32 v176, v242, v243
v_lshlrev_b32 v242, 16, v177
v_and_b32 v243, 0xffff0000, v177
v_mul_f32 v242, v242, v236
v_mul_f32 v243, v243, v236
v_cvt_pk_bf16_f32 v177, v242, v243
v_lshlrev_b32 v242, 16, v178
v_and_b32 v243, 0xffff0000, v178
v_mul_f32 v242, v242, v236
v_mul_f32 v243, v243, v236
v_cvt_pk_bf16_f32 v178, v242, v243
v_lshlrev_b32 v242, 16, v179
v_and_b32 v243, 0xffff0000, v179
v_mul_f32 v242, v242, v236
v_mul_f32 v243, v243, v236
v_cvt_pk_bf16_f32 v179, v242, v243
v_lshlrev_b32 v242, 16, v160
v_and_b32 v243, 0xffff0000, v160
v_mul_f32 v242, v242, v236
v_mul_f32 v243, v243, v236
v_cvt_pk_bf16_f32 v160, v242, v243
v_lshlrev_b32 v242, 16, v161
v_and_b32 v243, 0xffff0000, v161
v_mul_f32 v242, v242, v236
v_mul_f32 v243, v243, v236
v_cvt_pk_bf16_f32 v161, v242, v243
v_log_f32 v243, v229
v_max3_f32 v233, v148, v149, v150
v_max3_f32 v233, v233, v151, v243
v_mov_b32 v243, v233
s_nop 1
v_permlane32_swap_b32 v233, v243
s_nop 1
v_max_f32 v233, v233, v243
v_mov_b32 v243, v233
s_nop 1
v_permlane16_swap_b32 v233, v243
s_nop 1
v_max_f32 v233, v233, v243
v_ceil_f32 v233, v233
v_max_f32 v233, 0, v233
v_sub_f32 v243, 0, v233
v_exp_f32 v237, v243
s_nop 1
v_mul_f32 v229, v229, v237
v_add_f32 v245, v245, v233
v_sub_f32 v196, v196, v233
v_sub_f32 v132, v132, v233
v_sub_f32 v148, v148, v233
v_sub_f32 v197, v197, v233
v_sub_f32 v133, v133, v233
v_sub_f32 v149, v149, v233
v_sub_f32 v198, v198, v233
v_sub_f32 v134, v134, v233
v_sub_f32 v150, v150, v233
v_sub_f32 v199, v199, v233
v_sub_f32 v135, v135, v233
v_sub_f32 v151, v151, v233
v_lshlrev_b32 v242, 16, v180
v_and_b32 v243, 0xffff0000, v180
v_mul_f32 v242, v242, v237
v_mul_f32 v243, v243, v237
v_cvt_pk_bf16_f32 v180, v242, v243
v_lshlrev_b32 v242, 16, v181
v_and_b32 v243, 0xffff0000, v181
v_mul_f32 v242, v242, v237
v_mul_f32 v243, v243, v237
v_cvt_pk_bf16_f32 v181, v242, v243
v_lshlrev_b32 v242, 16, v182
v_and_b32 v243, 0xffff0000, v182
v_mul_f32 v242, v242, v237
v_mul_f32 v243, v243, v237
v_cvt_pk_bf16_f32 v182, v242, v243
v_lshlrev_b32 v242, 16, v183
v_and_b32 v243, 0xffff0000, v183
v_mul_f32 v242, v242, v237
v_mul_f32 v243, v243, v237
v_cvt_pk_bf16_f32 v183, v242, v243
v_lshlrev_b32 v242, 16, v164
v_and_b32 v243, 0xffff0000, v164
v_mul_f32 v242, v242, v237
v_mul_f32 v243, v243, v237
v_cvt_pk_bf16_f32 v164, v242, v243
v_lshlrev_b32 v242, 16, v165
v_and_b32 v243, 0xffff0000, v165
v_mul_f32 v242, v242, v237
v_mul_f32 v243, v243, v237
v_cvt_pk_bf16_f32 v165, v242, v243
v_log_f32 v243, v230
v_max3_f32 v234, v152, v153, v154
v_max3_f32 v234, v234, v155, v243
v_mov_b32 v243, v234
s_nop 1
v_permlane32_swap_b32 v234, v243
s_nop 1
v_max_f32 v234, v234, v243
v_mov_b32 v243, v234
s_nop 1
v_permlane16_swap_b32 v234, v243
s_nop 1
v_max_f32 v234, v234, v243
v_ceil_f32 v234, v234
v_max_f32 v234, 0, v234
v_sub_f32 v243, 0, v234
v_exp_f32 v238, v243
s_nop 1
v_mul_f32 v230, v230, v238
v_add_f32 v246, v246, v234
v_sub_f32 v200, v200, v234
v_sub_f32 v136, v136, v234
v_sub_f32 v152, v152, v234
v_sub_f32 v201, v201, v234
v_sub_f32 v137, v137, v234
v_sub_f32 v153, v153, v234
v_sub_f32 v202, v202, v234
v_sub_f32 v138, v138, v234
v_sub_f32 v154, v154, v234
v_sub_f32 v203, v203, v234
v_sub_f32 v139, v139, v234
v_sub_f32 v155, v155, v234
v_lshlrev_b32 v242, 16, v184
v_and_b32 v243, 0xffff0000, v184
v_mul_f32 v242, v242, v238
v_mul_f32 v243, v243, v238
v_cvt_pk_bf16_f32 v184, v242, v243
v_lshlrev_b32 v242, 16, v185
v_and_b32 v243, 0xffff0000, v185
v_mul_f32 v242, v242, v238
v_mul_f32 v243, v243, v238
v_cvt_pk_bf16_f32 v185, v242, v243
v_lshlrev_b32 v242, 16, v186
v_and_b32 v243, 0xffff0000, v186
v_mul_f32 v242, v242, v238
v_mul_f32 v243, v243, v238
v_cvt_pk_bf16_f32 v186, v242, v243
v_lshlrev_b32 v242, 16, v187
v_and_b32 v243, 0xffff0000, v187
v_mul_f32 v242, v242, v238
v_mul_f32 v243, v243, v238
v_cvt_pk_bf16_f32 v187, v242, v243
v_lshlrev_b32 v242, 16, v168
v_and_b32 v243, 0xffff0000, v168
v_mul_f32 v242, v242, v238
v_mul_f32 v243, v243, v238
v_cvt_pk_bf16_f32 v168, v242, v243
v_lshlrev_b32 v242, 16, v169
v_and_b32 v243, 0xffff0000, v169
v_mul_f32 v242, v242, v238
v_mul_f32 v243, v243, v238
v_cvt_pk_bf16_f32 v169, v242, v243
v_log_f32 v243, v231
v_max3_f32 v235, v156, v157, v158
v_max3_f32 v235, v235, v159, v243
v_mov_b32 v243, v235
s_nop 1
v_permlane32_swap_b32 v235, v243
s_nop 1
v_max_f32 v235, v235, v243
v_mov_b32 v243, v235
s_nop 1
v_permlane16_swap_b32 v235, v243
s_nop 1
v_max_f32 v235, v235, v243
v_ceil_f32 v235, v235
v_max_f32 v235, 0, v235
v_sub_f32 v243, 0, v235
v_exp_f32 v239, v243
s_nop 1
v_mul_f32 v231, v231, v239
v_add_f32 v247, v247, v235
v_sub_f32 v204, v204, v235
v_sub_f32 v140, v140, v235
v_sub_f32 v156, v156, v235
v_sub_f32 v205, v205, v235
v_sub_f32 v141, v141, v235
v_sub_f32 v157, v157, v235
v_sub_f32 v206, v206, v235
v_sub_f32 v142, v142, v235
v_sub_f32 v158, v158, v235
v_sub_f32 v207, v207, v235
v_sub_f32 v143, v143, v235
v_sub_f32 v159, v159, v235
v_lshlrev_b32 v242, 16, v188
v_and_b32 v243, 0xffff0000, v188
v_mul_f32 v242, v242, v239
v_mul_f32 v243, v243, v239
v_cvt_pk_bf16_f32 v188, v242, v243
v_lshlrev_b32 v242, 16, v189
v_and_b32 v243, 0xffff0000, v189
v_mul_f32 v242, v242, v239
v_mul_f32 v243, v243, v239
v_cvt_pk_bf16_f32 v189, v242, v243
v_lshlrev_b32 v242, 16, v190
v_and_b32 v243, 0xffff0000, v190
v_mul_f32 v242, v242, v239
v_mul_f32 v243, v243, v239
v_cvt_pk_bf16_f32 v190, v242, v243
v_lshlrev_b32 v242, 16, v191
v_and_b32 v243, 0xffff0000, v191
v_mul_f32 v242, v242, v239
v_mul_f32 v243, v243, v239
v_cvt_pk_bf16_f32 v191, v242, v243
v_lshlrev_b32 v242, 16, v172
v_and_b32 v243, 0xffff0000, v172
v_mul_f32 v242, v242, v239
v_mul_f32 v243, v243, v239
v_cvt_pk_bf16_f32 v172, v242, v243
v_lshlrev_b32 v242, 16, v173
v_and_b32 v243, 0xffff0000, v173
v_mul_f32 v242, v242, v239
v_mul_f32 v243, v243, v239
v_cvt_pk_bf16_f32 v173, v242, v243
v_exp_f32 v232, v144
v_exp_f32 v233, v145
v_exp_f32 v234, v146
v_exp_f32 v235, v147
s_nop 1
v_add_f32 v224, v228, v232
v_add_f32 v224, v224, v233
v_add_f32 v224, v224, v234
v_add_f32 v224, v224, v235
v_cvt_pk_bf16_f32 v162, v232, v233
v_cvt_pk_bf16_f32 v163, v234, v235
v_exp_f32 v232, v148
v_exp_f32 v233, v149
v_exp_f32 v234, v150
v_exp_f32 v235, v151
s_nop 1
v_add_f32 v225, v229, v232
v_add_f32 v225, v225, v233
v_add_f32 v225, v225, v234
v_add_f32 v225, v225, v235
v_cvt_pk_bf16_f32 v166, v232, v233
v_cvt_pk_bf16_f32 v167, v234, v235
v_exp_f32 v232, v152
v_exp_f32 v233, v153
v_exp_f32 v234, v154
v_exp_f32 v235, v155
s_nop 1
v_add_f32 v226, v230, v232
v_add_f32 v226, v226, v233
v_add_f32 v226, v226, v234
v_add_f32 v226, v226, v235
v_cvt_pk_bf16_f32 v170, v232, v233
v_cvt_pk_bf16_f32 v171, v234, v235
v_exp_f32 v232, v156
v_exp_f32 v233, v157
v_exp_f32 v234, v158
v_exp_f32 v235, v159
s_nop 1
v_add_f32 v227, v231, v232
v_add_f32 v227, v227, v233
v_add_f32 v227, v227, v234
v_add_f32 v227, v227, v235
v_cvt_pk_bf16_f32 v174, v232, v233
v_cvt_pk_bf16_f32 v175, v234, v235
s_branch L2_rare_common
L2_rare_site4:
s_mov_b32 s36, 4
s_branch L2_rare_t0_0_0
L2_rare_t0_0_0:
s_nop 15
s_nop 15
s_waitcnt lgkmcnt(0)
v_log_f32 v243, v224
v_max3_f32 v232, v128, v129, v130
v_max3_f32 v232, v232, v131, v243
v_mov_b32 v243, v232
s_nop 1
v_permlane32_swap_b32 v232, v243
s_nop 1
v_max_f32 v232, v232, v243
v_mov_b32 v243, v232
s_nop 1
v_permlane16_swap_b32 v232, v243
s_nop 1
v_max_f32 v232, v232, v243
v_ceil_f32 v232, v232
v_max_f32 v232, 0, v232
v_sub_f32 v243, 0, v232
v_exp_f32 v236, v243
s_nop 1
v_mul_f32 v224, v224, v236
v_add_f32 v244, v244, v232
v_sub_f32 v192, v192, v232
v_sub_f32 v128, v128, v232
v_sub_f32 v144, v144, v232
v_sub_f32 v193, v193, v232
v_sub_f32 v129, v129, v232
v_sub_f32 v145, v145, v232
v_sub_f32 v194, v194, v232
v_sub_f32 v130, v130, v232
v_sub_f32 v146, v146, v232
v_sub_f32 v195, v195, v232
v_sub_f32 v131, v131, v232
v_sub_f32 v147, v147, v232
ds_read_b64 v[254:255], v253 offset:0
s_waitcnt lgkmcnt(0)
v_lshlrev_b32 v242, 16, v254
v_and_b32 v243, 0xffff0000, v254
v_mul_f32 v242, v242, v236
v_mul_f32 v243, v243, v236
v_cvt_pk_bf16_f32 v254, v242, v243
v_lshlrev_b32 v242, 16, v255
v_and_b32 v243, 0xffff0000, v255
v_mul_f32 v242, v242, v236
v_mul_f32 v243, v243, v236
v_cvt_pk_bf16_f32 v255, v242, v243
ds_write_b64 v253, v[254:255] offset:0
s_waitcnt lgkmcnt(0)
ds_read_b64 v[254:255], v253 offset:8
s_waitcnt lgkmcnt(0)
v_lshlrev_b32 v242, 16, v254
v_and_b32 v243, 0xffff0000, v254
v_mul_f32 v242, v242, v236
v_mul_f32 v243, v243, v236
v_cvt_pk_bf16_f32 v254, v242, v243
v_lshlrev_b32 v242, 16, v255
v_and_b32 v243, 0xffff0000, v255
v_mul_f32 v242, v242, v236
v_mul_f32 v243, v243, v236
v_cvt_pk_bf16_f32 v255, v242, v243
ds_write_b64 v253, v[254:255] offset:8
s_waitcnt lgkmcnt(0)
v_log_f32 v243, v225
v_max3_f32 v233, v132, v133, v134
v_max3_f32 v233, v233, v135, v243
v_mov_b32 v243, v233
s_nop 1
v_permlane32_swap_b32 v233, v243
s_nop 1
v_max_f32 v233, v233, v243
v_mov_b32 v243, v233
s_nop 1
v_permlane16_swap_b32 v233, v243
s_nop 1
v_max_f32 v233, v233, v243
v_ceil_f32 v233, v233
v_max_f32 v233, 0, v233
v_sub_f32 v243, 0, v233
v_exp_f32 v237, v243
s_nop 1
v_mul_f32 v225, v225, v237
v_add_f32 v245, v245, v233
v_sub_f32 v196, v196, v233
v_sub_f32 v132, v132, v233
v_sub_f32 v148, v148, v233
v_sub_f32 v197, v197, v233
v_sub_f32 v133, v133, v233
v_sub_f32 v149, v149, v233
v_sub_f32 v198, v198, v233
v_sub_f32 v134, v134, v233
v_sub_f32 v150, v150, v233
v_sub_f32 v199, v199, v233
v_sub_f32 v135, v135, v233
v_sub_f32 v151, v151, v233
ds_read_b64 v[254:255], v253 offset:1024
s_waitcnt lgkmcnt(0)
v_lshlrev_b32 v242, 16, v254
v_and_b32 v243, 0xffff0000, v254
v_mul_f32 v242, v242, v237
v_mul_f32 v243, v243, v237
v_cvt_pk_bf16_f32 v254, v242, v243
v_lshlrev_b32 v242, 16, v255
v_and_b32 v243, 0xffff0000, v255
v_mul_f32 v242, v242, v237
v_mul_f32 v243, v243, v237
v_cvt_pk_bf16_f32 v255, v242, v243
ds_write_b64 v253, v[254:255] offset:1024
s_waitcnt lgkmcnt(0)
ds_read_b64 v[254:255], v253 offset:1032
s_waitcnt lgkmcnt(0)
v_lshlrev_b32 v242, 16, v254
v_and_b32 v243, 0xffff0000, v254
v_mul_f32 v242, v242, v237
v_mul_f32 v243, v243, v237
v_cvt_pk_bf16_f32 v254, v242, v243
v_lshlrev_b32 v242, 16, v255
v_and_b32 v243, 0xffff0000, v255
v_mul_f32 v242, v242, v237
v_mul_f32 v243, v243, v237
v_cvt_pk_bf16_f32 v255, v242, v243
ds_write_b64 v253, v[254:255] offset:1032
s_waitcnt lgkmcnt(0)
v_log_f32 v243, v226
v_max3_f32 v234, v136, v137, v138
v_max3_f32 v234, v234, v139, v243
v_mov_b32 v243, v234
s_nop 1
v_permlane32_swap_b32 v234, v243
s_nop 1
v_max_f32 v234, v234, v243
v_mov_b32 v243, v234
s_nop 1
v_permlane16_swap_b32 v234, v243
s_nop 1
v_max_f32 v234, v234, v243
v_ceil_f32 v234, v234
v_max_f32 v234, 0, v234
v_sub_f32 v243, 0, v234
v_exp_f32 v238, v243
s_nop 1
v_mul_f32 v226, v226, v238
v_add_f32 v246, v246, v234
v_sub_f32 v200, v200, v234
v_sub_f32 v136, v136, v234
v_sub_f32 v152, v152, v234
v_sub_f32 v201, v201, v234
v_sub_f32 v137, v137, v234
v_sub_f32 v153, v153, v234
v_sub_f32 v202, v202, v234
v_sub_f32 v138, v138, v234
v_sub_f32 v154, v154, v234
v_sub_f32 v203, v203, v234
v_sub_f32 v139, v139, v234
v_sub_f32 v155, v155, v234
ds_read_b64 v[254:255], v253 offset:2048
s_waitcnt lgkmcnt(0)
v_lshlrev_b32 v242, 16, v254
v_and_b32 v243, 0xffff0000, v254
v_mul_f32 v242, v242, v238
v_mul_f32 v243, v243, v238
v_cvt_pk_bf16_f32 v254, v242, v243
v_lshlrev_b32 v242, 16, v255
v_and_b32 v243, 0xffff0000, v255
v_mul_f32 v242, v242, v238
v_mul_f32 v243, v243, v238
v_cvt_pk_bf16_f32 v255, v242, v243
ds_write_b64 v253, v[254:255] offset:2048
s_waitcnt lgkmcnt(0)
ds_read_b64 v[254:255], v253 offset:2056
s_waitcnt lgkmcnt(0)
v_lshlrev_b32 v242, 16, v254
v_and_b32 v243, 0xffff0000, v254
v_mul_f32 v242, v242, v238
v_mul_f32 v243, v243, v238
v_cvt_pk_bf16_f32 v254, v242, v243
v_lshlrev_b32 v242, 16, v255
v_and_b32 v243, 0xffff0000, v255
v_mul_f32 v242, v242, v238
v_mul_f32 v243, v243, v238
v_cvt_pk_bf16_f32 v255, v242, v243
ds_write_b64 v253, v[254:255] offset:2056
s_waitcnt lgkmcnt(0)
v_log_f32 v243, v227
v_max3_f32 v235, v140, v141, v142
v_max3_f32 v235, v235, v143, v243
v_mov_b32 v243, v235
s_nop 1
v_permlane32_swap_b32 v235, v243
s_nop 1
v_max_f32 v235, v235, v243
v_mov_b32 v243, v235
s_nop 1
v_permlane16_swap_b32 v235, v243
s_nop 1
v_max_f32 v235, v235, v243
v_ceil_f32 v235, v235
v_max_f32 v235, 0, v235
v_sub_f32 v243, 0, v235
v_exp_f32 v239, v243
s_nop 1
v_mul_f32 v227, v227, v239
v_add_f32 v247, v247, v235
v_sub_f32 v204, v204, v235
v_sub_f32 v140, v140, v235
v_sub_f32 v156, v156, v235
v_sub_f32 v205, v205, v235
v_sub_f32 v141, v141, v235
v_sub_f32 v157, v157, v235
v_sub_f32 v206, v206, v235
v_sub_f32 v142, v142, v235
v_sub_f32 v158, v158, v235
v_sub_f32 v207, v207, v235
v_sub_f32 v143, v143, v235
v_sub_f32 v159, v159, v235
ds_read_b64 v[254:255], v253 offset:3072
s_waitcnt lgkmcnt(0)
v_lshlrev_b32 v242, 16, v254
v_and_b32 v243, 0xffff0000, v254
v_mul_f32 v242, v242, v239
v_mul_f32 v243, v243, v239
v_cvt_pk_bf16_f32 v254, v242, v243
v_lshlrev_b32 v242, 16, v255
v_and_b32 v243, 0xffff0000, v255
v_mul_f32 v242, v242, v239
v_mul_f32 v243, v243, v239
v_cvt_pk_bf16_f32 v255, v242, v243
ds_write_b64 v253, v[254:255] offset:3072
s_waitcnt lgkmcnt(0)
ds_read_b64 v[254:255], v253 offset:3080
s_waitcnt lgkmcnt(0)
v_lshlrev_b32 v242, 16, v254
v_and_b32 v243, 0xffff0000, v254
v_mul_f32 v242, v242, v239
v_mul_f32 v243, v243, v239
v_cvt_pk_bf16_f32 v254, v242, v243
v_lshlrev_b32 v242, 16, v255
v_and_b32 v243, 0xffff0000, v255
v_mul_f32 v242, v242, v239
v_mul_f32 v243, v243, v239
v_cvt_pk_bf16_f32 v255, v242, v243
ds_write_b64 v253, v[254:255] offset:3080
s_waitcnt lgkmcnt(0)
v_exp_f32 v232, v128
v_exp_f32 v233, v129
v_exp_f32 v234, v130
v_exp_f32 v235, v131
s_nop 1
v_add_f32 v228, v224, v232
v_add_f32 v228, v228, v233
v_add_f32 v228, v228, v234
v_add_f32 v228, v228, v235
v_cvt_pk_bf16_f32 v176, v232, v233
v_cvt_pk_bf16_f32 v177, v234, v235
v_exp_f32 v232, v132
v_exp_f32 v233, v133
v_exp_f32 v234, v134
v_exp_f32 v235, v135
s_nop 1
v_add_f32 v229, v225, v232
v_add_f32 v229, v229, v233
v_add_f32 v229, v229, v234
v_add_f32 v229, v229, v235
v_cvt_pk_bf16_f32 v180, v232, v233
v_cvt_pk_bf16_f32 v181, v234, v235
v_exp_f32 v232, v136
v_exp_f32 v233, v137
v_exp_f32 v234, v138
v_exp_f32 v235, v139
s_nop 1
v_add_f32 v230, v226, v232
v_add_f32 v230, v230, v233
v_add_f32 v230, v230, v234
v_add_f32 v230, v230, v235
v_cvt_pk_bf16_f32 v184, v232, v233
v_cvt_pk_bf16_f32 v185, v234, v235
v_exp_f32 v232, v140
v_exp_f32 v233, v141
v_exp_f32 v234, v142
v_exp_f32 v235, v143
s_nop 1
v_add_f32 v231, v227, v232
v_add_f32 v231, v231, v233
v_add_f32 v231, v231, v234
v_add_f32 v231, v231, v235
v_cvt_pk_bf16_f32 v188, v232, v233
v_cvt_pk_bf16_f32 v189, v234, v235
s_branch L2_rare_common
L2_rare_site5:
s_mov_b32 s36, 5
s_branch L2_rare_t0_1_1
L2_rare_t0_1_1:
s_nop 15
s_nop 15
s_waitcnt lgkmcnt(0)
v_log_f32 v243, v228
v_max3_f32 v232, v144, v145, v146
v_max3_f32 v232, v232, v147, v243
v_mov_b32 v243, v232
s_nop 1
v_permlane32_swap_b32 v232, v243
s_nop 1
v_max_f32 v232, v232, v243
v_mov_b32 v243, v232
s_nop 1
v_permlane16_swap_b32 v232, v243
s_nop 1
v_max_f32 v232, v232, v243
v_ceil_f32 v232, v232
v_max_f32 v232, 0, v232
v_sub_f32 v243, 0, v232
v_exp_f32 v236, v243
s_nop 1
v_mul_f32 v228, v228, v236
v_add_f32 v244, v244, v232
v_sub_f32 v192, v192, v232
v_sub_f32 v128, v128, v232
v_sub_f32 v144, v144, v232
v_sub_f32 v193, v193, v232
v_sub_f32 v129, v129, v232
v_sub_f32 v145, v145, v232
v_sub_f32 v194, v194, v232
v_sub_f32 v130, v130, v232
v_sub_f32 v146, v146, v232
v_sub_f32 v195, v195, v232
v_sub_f32 v131, v131, v232
v_sub_f32 v147, v147, v232
v_lshlrev_b32 v242, 16, v176
v_and_b32 v243, 0xffff0000, v176
v_mul_f32 v242, v242, v236
v_mul_f32 v243, v243, v236
v_cvt_pk_bf16_f32 v176, v242, v243
v_lshlrev_b32 v242, 16, v177
v_and_b32 v243, 0xffff0000, v177
v_mul_f32 v242, v242, v236
v_mul_f32 v243, v243, v236
v_cvt_pk_bf16_f32 v177, v242, v243
ds_read_b64 v[254:255], v253 offset:0
s_waitcnt lgkmcnt(0)
v_lshlrev_b32 v242, 16, v254
v_and_b32 v243, 0xffff0000, v254
v_mul_f32 v242, v242, v236
v_mul_f32 v243, v243, v236
v_cvt_pk_bf16_f32 v254, v242, v243
v_lshlrev_b32 v242, 16, v255
v_and_b32 v243, 0xffff0000, v255
v_mul_f32 v242, v242, v236
v_mul_f32 v243, v243, v236
v_cvt_pk_bf16_f32 v255, v242, v243
ds_write_b64 v253, v[254:255] offset:0
s_waitcnt lgkmcnt(0)
ds_read_b64 v[254:255], v253 offset:8
s_waitcnt lgkmcnt(0)
v_lshlrev_b32 v242, 16, v254
v_and_b32 v243, 0xffff0000, v254
v_mul_f32 v242, v242, v236
v_mul_f32 v243, v243, v236
v_cvt_pk_bf16_f32 v254, v242, v243
v_lshlrev_b32 v242, 16, v255
v_and_b32 v243, 0xffff0000, v255
v_mul_f32 v242, v242, v236
v_mul_f32 v243, v243, v236
v_cvt_pk_bf16_f32 v255, v242, v243
ds_write_b64 v253, v[254:255] offset:8
s_waitcnt lgkmcnt(0)
v_log_f32 v243, v229
v_max3_f32 v233, v148, v149, v150
v_max3_f32 v233, v233, v151, v243
v_mov_b32 v243, v233
s_nop 1
v_permlane32_swap_b32 v233, v243
s_nop 1
v_max_f32 v233, v233, v243
v_mov_b32 v243, v233
s_nop 1
v_permlane16_swap_b32 v233, v243
s_nop 1
v_max_f32 v233, v233, v243
v_ceil_f32 v233, v233
v_max_f32 v233, 0, v233
v_sub_f32 v243, 0, v233
v_exp_f32 v237, v243
s_nop 1
v_mul_f32 v229, v229, v237
v_add_f32 v245, v245, v233
v_sub_f32 v196, v196, v233
v_sub_f32 v132, v132, v233
v_sub_f32 v148, v148, v233
v_sub_f32 v197, v197, v233
v_sub_f32 v133, v133, v233
v_sub_f32 v149, v149, v233
v_sub_f32 v198, v198, v233
v_sub_f32 v134, v134, v233
v_sub_f32 v150, v150, v233
v_sub_f32 v199, v199, v233
v_sub_f32 v135, v135, v233
v_sub_f32 v151, v151, v233
v_lshlrev_b32 v242, 16, v180
v_and_b32 v243, 0xffff0000, v180
v_mul_f32 v242, v242, v237
v_mul_f32 v243, v243, v237
v_cvt_pk_bf16_f32 v180, v242, v243
v_lshlrev_b32 v242, 16, v181
v_and_b32 v243, 0xffff0000, v181
v_mul_f32 v242, v242, v237
v_mul_f32 v243, v243, v237
v_cvt_pk_bf16_f32 v181, v242, v243
ds_read_b64 v[254:255], v253 offset:1024
s_waitcnt lgkmcnt(0)
v_lshlrev_b32 v242, 16, v254
v_and_b32 v243, 0xffff0000, v254
v_mul_f32 v242, v242, v237
v_mul_f32 v243, v243, v237
v_cvt_pk_bf16_f32 v254, v242, v243
v_lshlrev_b32 v242, 16, v255
v_and_b32 v243, 0xffff0000, v255
v_mul_f32 v242, v242, v237
v_mul_f32 v243, v243, v237
v_cvt_pk_bf16_f32 v255, v242, v243
ds_write_b64 v253, v[254:255] offset:1024
s_waitcnt lgkmcnt(0)
ds_read_b64 v[254:255], v253 offset:1032
s_waitcnt lgkmcnt(0)
v_lshlrev_b32 v242, 16, v254
v_and_b32 v243, 0xffff0000, v254
v_mul_f32 v242, v242, v237
v_mul_f32 v243, v243, v237
v_cvt_pk_bf16_f32 v254, v242, v243
v_lshlrev_b32 v242, 16, v255
v_and_b32 v243, 0xffff0000, v255
v_mul_f32 v242, v242, v237
v_mul_f32 v243, v243, v237
v_cvt_pk_bf16_f32 v255, v242, v243
ds_write_b64 v253, v[254:255] offset:1032
s_waitcnt lgkmcnt(0)
v_log_f32 v243, v230
v_max3_f32 v234, v152, v153, v154
v_max3_f32 v234, v234, v155, v243
v_mov_b32 v243, v234
s_nop 1
v_permlane32_swap_b32 v234, v243
s_nop 1
v_max_f32 v234, v234, v243
v_mov_b32 v243, v234
s_nop 1
v_permlane16_swap_b32 v234, v243
s_nop 1
v_max_f32 v234, v234, v243
v_ceil_f32 v234, v234
v_max_f32 v234, 0, v234
v_sub_f32 v243, 0, v234
v_exp_f32 v238, v243
s_nop 1
v_mul_f32 v230, v230, v238
v_add_f32 v246, v246, v234
v_sub_f32 v200, v200, v234
v_sub_f32 v136, v136, v234
v_sub_f32 v152, v152, v234
v_sub_f32 v201, v201, v234
v_sub_f32 v137, v137, v234
v_sub_f32 v153, v153, v234
v_sub_f32 v202, v202, v234
v_sub_f32 v138, v138, v234
v_sub_f32 v154, v154, v234
v_sub_f32 v203, v203, v234
v_sub_f32 v139, v139, v234
v_sub_f32 v155, v155, v234
v_lshlrev_b32 v242, 16, v184
v_and_b32 v243, 0xffff0000, v184
v_mul_f32 v242, v242, v238
v_mul_f32 v243, v243, v238
v_cvt_pk_bf16_f32 v184, v242, v243
v_lshlrev_b32 v242, 16, v185
v_and_b32 v243, 0xffff0000, v185
v_mul_f32 v242, v242, v238
v_mul_f32 v243, v243, v238
v_cvt_pk_bf16_f32 v185, v242, v243
ds_read_b64 v[254:255], v253 offset:2048
s_waitcnt lgkmcnt(0)
v_lshlrev_b32 v242, 16, v254
v_and_b32 v243, 0xffff0000, v254
v_mul_f32 v242, v242, v238
v_mul_f32 v243, v243, v238
v_cvt_pk_bf16_f32 v254, v242, v243
v_lshlrev_b32 v242, 16, v255
v_and_b32 v243, 0xffff0000, v255
v_mul_f32 v242, v242, v238
v_mul_f32 v243, v243, v238
v_cvt_pk_bf16_f32 v255, v242, v243
ds_write_b64 v253, v[254:255] offset:2048
s_waitcnt lgkmcnt(0)
ds_read_b64 v[254:255], v253 offset:2056
s_waitcnt lgkmcnt(0)
v_lshlrev_b32 v242, 16, v254
v_and_b32 v243, 0xffff0000, v254
v_mul_f32 v242, v242, v238
v_mul_f32 v243, v243, v238
v_cvt_pk_bf16_f32 v254, v242, v243
v_lshlrev_b32 v242, 16, v255
v_and_b32 v243, 0xffff0000, v255
v_mul_f32 v242, v242, v238
v_mul_f32 v243, v243, v238
v_cvt_pk_bf16_f32 v255, v242, v243
ds_write_b64 v253, v[254:255] offset:2056
s_waitcnt lgkmcnt(0)
v_log_f32 v243, v231
v_max3_f32 v235, v156, v157, v158
v_max3_f32 v235, v235, v159, v243
v_mov_b32 v243, v235
s_nop 1
v_permlane32_swap_b32 v235, v243
s_nop 1
v_max_f32 v235, v235, v243
v_mov_b32 v243, v235
s_nop 1
v_permlane16_swap_b32 v235, v243
s_nop 1
v_max_f32 v235, v235, v243
v_ceil_f32 v235, v235
v_max_f32 v235, 0, v235
v_sub_f32 v243, 0, v235
v_exp_f32 v239, v243
s_nop 1
v_mul_f32 v231, v231, v239
v_add_f32 v247, v247, v235
v_sub_f32 v204, v204, v235
v_sub_f32 v140, v140, v235
v_sub_f32 v156, v156, v235
v_sub_f32 v205, v205, v235
v_sub_f32 v141, v141, v235
v_sub_f32 v157, v157, v235
v_sub_f32 v206, v206, v235
v_sub_f32 v142, v142, v235
v_sub_f32 v158, v158, v235
v_sub_f32 v207, v207, v235
v_sub_f32 v143, v143, v235
v_sub_f32 v159, v159, v235
v_lshlrev_b32 v242, 16, v188
v_and_b32 v243, 0xffff0000, v188
v_mul_f32 v242, v242, v239
v_mul_f32 v243, v243, v239
v_cvt_pk_bf16_f32 v188, v242, v243
v_lshlrev_b32 v242, 16, v189
v_and_b32 v243, 0xffff0000, v189
v_mul_f32 v242, v242, v239
v_mul_f32 v243, v243, v239
v_cvt_pk_bf16_f32 v189, v242, v243
ds_read_b64 v[254:255], v253 offset:3072
s_waitcnt lgkmcnt(0)
v_lshlrev_b32 v242, 16, v254
v_and_b32 v243, 0xffff0000, v254
v_mul_f32 v242, v242, v239
v_mul_f32 v243, v243, v239
v_cvt_pk_bf16_f32 v254, v242, v243
v_lshlrev_b32 v242, 16, v255
v_and_b32 v243, 0xffff0000, v255
v_mul_f32 v242, v242, v239
v_mul_f32 v243, v243, v239
v_cvt_pk_bf16_f32 v255, v242, v243
ds_write_b64 v253, v[254:255] offset:3072
s_waitcnt lgkmcnt(0)
ds_read_b64 v[254:255], v253 offset:3080
s_waitcnt lgkmcnt(0)
v_lshlrev_b32 v242, 16, v254
v_and_b32 v243, 0xffff0000, v254
v_mul_f32 v242, v242, v239
v_mul_f32 v243, v243, v239
v_cvt_pk_bf16_f32 v254, v242, v243
v_lshlrev_b32 v242, 16, v255
v_and_b32 v243, 0xffff0000, v255
v_mul_f32 v242, v242, v239
v_mul_f32 v243, v243, v239
v_cvt_pk_bf16_f32 v255, v242, v243
ds_write_b64 v253, v[254:255] offset:3080
s_waitcnt lgkmcnt(0)
v_exp_f32 v232, v144
v_exp_f32 v233, v145
v_exp_f32 v234, v146
v_exp_f32 v235, v147
s_nop 1
v_add_f32 v224, v228, v232
v_add_f32 v224, v224, v233
v_add_f32 v224, v224, v234
v_add_f32 v224, v224, v235
v_cvt_pk_bf16_f32 v178, v232, v233
v_cvt_pk_bf16_f32 v179, v234, v235
v_exp_f32 v232, v148
v_exp_f32 v233, v149
v_exp_f32 v234, v150
v_exp_f32 v235, v151
s_nop 1
v_add_f32 v225, v229, v232
v_add_f32 v225, v225, v233
v_add_f32 v225, v225, v234
v_add_f32 v225, v225, v235
v_cvt_pk_bf16_f32 v182, v232, v233
v_cvt_pk_bf16_f32 v183, v234, v235
v_exp_f32 v232, v152
v_exp_f32 v233, v153
v_exp_f32 v234, v154
v_exp_f32 v235, v155
s_nop 1
v_add_f32 v226, v230, v232
v_add_f32 v226, v226, v233
v_add_f32 v226, v226, v234
v_add_f32 v226, v226, v235
v_cvt_pk_bf16_f32 v186, v232, v233
v_cvt_pk_bf16_f32 v187, v234, v235
v_exp_f32 v232, v156
v_exp_f32 v233, v157
v_exp_f32 v234, v158
v_exp_f32 v235, v159
s_nop 1
v_add_f32 v227, v231, v232
v_add_f32 v227, v227, v233
v_add_f32 v227, v227, v234
v_add_f32 v227, v227, v235
v_cvt_pk_bf16_f32 v190, v232, v233
v_cvt_pk_bf16_f32 v191, v234, v235
s_branch L2_rare_common
L2_rare_site6:
s_mov_b32 s36, 6
s_branch L2_rare_t0_2_0
L2_rare_t0_2_0:
s_nop 15
s_nop 15
s_waitcnt lgkmcnt(0)
v_log_f32 v243, v224
v_max3_f32 v232, v128, v129, v130
v_max3_f32 v232, v232, v131, v243
v_mov_b32 v243, v232
s_nop 1
v_permlane32_swap_b32 v232, v243
s_nop 1
v_max_f32 v232, v232, v243
v_mov_b32 v243, v232
s_nop 1
v_permlane16_swap_b32 v232, v243
s_nop 1
v_max_f32 v232, v232, v243
v_ceil_f32 v232, v232
v_max_f32 v232, 0, v232
v_sub_f32 v243, 0, v232
v_exp_f32 v236, v243
s_nop 1
v_mul_f32 v224, v224, v236
v_add_f32 v244, v244, v232
v_sub_f32 v192, v192, v232
v_sub_f32 v128, v128, v232
v_sub_f32 v144, v144, v232
v_sub_f32 v193, v193, v232
v_sub_f32 v129, v129, v232
v_sub_f32 v145, v145, v232
v_sub_f32 v194, v194, v232
v_sub_f32 v130, v130, v232
v_sub_f32 v146, v146, v232
v_sub_f32 v195, v195, v232
v_sub_f32 v131, v131, v232
v_sub_f32 v147, v147, v232
ds_read_b64 v[254:255], v253 offset:0
s_waitcnt lgkmcnt(0)
v_lshlrev_b32 v242, 16, v254
v_and_b32 v243, 0xffff0000, v254
v_mul_f32 v242, v242, v236
v_mul_f32 v243, v243, v236
v_cvt_pk_bf16_f32 v254, v242, v243
v_lshlrev_b32 v242, 16, v255
v_and_b32 v243, 0xffff0000, v255
v_mul_f32 v242, v242, v236
v_mul_f32 v243, v243, v236
v_cvt_pk_bf16_f32 v255, v242, v243
ds_write_b64 v253, v[254:255] offset:0
s_waitcnt lgkmcnt(0)
ds_read_b64 v[254:255], v253 offset:8
s_waitcnt lgkmcnt(0)
v_lshlrev_b32 v242, 16, v254
v_and_b32 v243, 0xffff0000, v254
v_mul_f32 v242, v242, v236
v_mul_f32 v243, v243, v236
v_cvt_pk_bf16_f32 v254, v242, v243
v_lshlrev_b32 v242, 16, v255
v_and_b32 v243, 0xffff0000, v255
v_mul_f32 v242, v242, v236
v_mul_f32 v243, v243, v236
v_cvt_pk_bf16_f32 v255, v242, v243
ds_write_b64 v253, v[254:255] offset:8
s_waitcnt lgkmcnt(0)
ds_read_b64 v[254:255], v253 offset:4096
s_waitcnt lgkmcnt(0)
v_lshlrev_b32 v242, 16, v254
v_and_b32 v243, 0xffff0000, v254
v_mul_f32 v242, v242, v236
v_mul_f32 v243, v243, v236
v_cvt_pk_bf16_f32 v254, v242, v243
v_lshlrev_b32 v242, 16, v255
v_and_b32 v243, 0xffff0000, v255
v_mul_f32 v242, v242, v236
v_mul_f32 v243, v243, v236
v_cvt_pk_bf16_f32 v255, v242, v243
ds_write_b64 v253, v[254:255] offset:4096
s_waitcnt lgkmcnt(0)
ds_read_b64 v[254:255], v253 offset:4104
s_waitcnt lgkmcnt(0)
v_lshlrev_b32 v242, 16, v254
v_and_b32 v243, 0xffff0000, v254
v_mul_f32 v242, v242, v236
v_mul_f32 v243, v243, v236
v_cvt_pk_bf16_f32 v254, v242, v243
v_lshlrev_b32 v242, 16, v255
v_and_b32 v243, 0xffff0000, v255
v_mul_f32 v242, v242, v236
v_mul_f32 v243, v243, v236
v_cvt_pk_bf16_f32 v255, v242, v243
ds_write_b64 v253, v[254:255] offset:4104
s_waitcnt lgkmcnt(0)
v_log_f32 v243, v225
v_max3_f32 v233, v132, v133, v134
v_max3_f32 v233, v233, v135, v243
v_mov_b32 v243, v233
s_nop 1
v_permlane32_swap_b32 v233, v243
s_nop 1
v_max_f32 v233, v233, v243
v_mov_b32 v243, v233
s_nop 1
v_permlane16_swap_b32 v233, v243
s_nop 1
v_max_f32 v233, v233, v243
v_ceil_f32 v233, v233
v_max_f32 v233, 0, v233
v_sub_f32 v243, 0, v233
v_exp_f32 v237, v243
s_nop 1
v_mul_f32 v225, v225, v237
v_add_f32 v245, v245, v233
v_sub_f32 v196, v196, v233
v_sub_f32 v132, v132, v233
v_sub_f32 v148, v148, v233
v_sub_f32 v197, v197, v233
v_sub_f32 v133, v133, v233
v_sub_f32 v149, v149, v233
v_sub_f32 v198, v198, v233
v_sub_f32 v134, v134, v233
v_sub_f32 v150, v150, v233
v_sub_f32 v199, v199, v233
v_sub_f32 v135, v135, v233
v_sub_f32 v151, v151, v233
ds_read_b64 v[254:255], v253 offset:1024
s_waitcnt lgkmcnt(0)
v_lshlrev_b32 v242, 16, v254
v_and_b32 v243, 0xffff0000, v254
v_mul_f32 v242, v242, v237
v_mul_f32 v243, v243, v237
v_cvt_pk_bf16_f32 v254, v242, v243
v_lshlrev_b32 v242, 16, v255
v_and_b32 v243, 0xffff0000, v255
v_mul_f32 v242, v242, v237
v_mul_f32 v243, v243, v237
v_cvt_pk_bf16_f32 v255, v242, v243
ds_write_b64 v253, v[254:255] offset:1024
s_waitcnt lgkmcnt(0)
ds_read_b64 v[254:255], v253 offset:1032
s_waitcnt lgkmcnt(0)
v_lshlrev_b32 v242, 16, v254
v_and_b32 v243, 0xffff0000, v254
v_mul_f32 v242, v242, v237
v_mul_f32 v243, v243, v237
v_cvt_pk_bf16_f32 v254, v242, v243
v_lshlrev_b32 v242, 16, v255
v_and_b32 v243, 0xffff0000, v255
v_mul_f32 v242, v242, v237
v_mul_f32 v243, v243, v237
v_cvt_pk_bf16_f32 v255, v242, v243
ds_write_b64 v253, v[254:255] offset:1032
s_waitcnt lgkmcnt(0)
ds_read_b64 v[254:255], v253 offset:5120
s_waitcnt lgkmcnt(0)
v_lshlrev_b32 v242, 16, v254
v_and_b32 v243, 0xffff0000, v254
v_mul_f32 v242, v242, v237
v_mul_f32 v243, v243, v237
v_cvt_pk_bf16_f32 v254, v242, v243
v_lshlrev_b32 v242, 16, v255
v_and_b32 v243, 0xffff0000, v255
v_mul_f32 v242, v242, v237
v_mul_f32 v243, v243, v237
v_cvt_pk_bf16_f32 v255, v242, v243
ds_write_b64 v253, v[254:255] offset:5120
s_waitcnt lgkmcnt(0)
ds_read_b64 v[254:255], v253 offset:5128
s_waitcnt lgkmcnt(0)
v_lshlrev_b32 v242, 16, v254
v_and_b32 v243, 0xffff0000, v254
v_mul_f32 v242, v242, v237
v_mul_f32 v243, v243, v237
v_cvt_pk_bf16_f32 v254, v242, v243
v_lshlrev_b32 v242, 16, v255
v_and_b32 v243, 0xffff0000, v255
v_mul_f32 v242, v242, v237
v_mul_f32 v243, v243, v237
v_cvt_pk_bf16_f32 v255, v242, v243
ds_write_b64 v253, v[254:255] offset:5128
s_waitcnt lgkmcnt(0)
v_log_f32 v243, v226
v_max3_f32 v234, v136, v137, v138
v_max3_f32 v234, v234, v139, v243
v_mov_b32 v243, v234
s_nop 1
v_permlane32_swap_b32 v234, v243
s_nop 1
v_max_f32 v234, v234, v243
v_mov_b32 v243, v234
s_nop 1
v_permlane16_swap_b32 v234, v243
s_nop 1
v_max_f32 v234, v234, v243
v_ceil_f32 v234, v234
v_max_f32 v234, 0, v234
v_sub_f32 v243, 0, v234
v_exp_f32 v238, v243
s_nop 1
v_mul_f32 v226, v226, v238
v_add_f32 v246, v246, v234
v_sub_f32 v200, v200, v234
v_sub_f32 v136, v136, v234
v_sub_f32 v152, v152, v234
v_sub_f32 v201, v201, v234
v_sub_f32 v137, v137, v234
v_sub_f32 v153, v153, v234
v_sub_f32 v202, v202, v234
v_sub_f32 v138, v138, v234
v_sub_f32 v154, v154, v234
v_sub_f32 v203, v203, v234
v_sub_f32 v139, v139, v234
v_sub_f32 v155, v155, v234
ds_read_b64 v[254:255], v253 offset:2048
s_waitcnt lgkmcnt(0)
v_lshlrev_b32 v242, 16, v254
v_and_b32 v243, 0xffff0000, v254
v_mul_f32 v242, v242, v238
v_mul_f32 v243, v243, v238
v_cvt_pk_bf16_f32 v254, v242, v243
v_lshlrev_b32 v242, 16, v255
v_and_b32 v243, 0xffff0000, v255
v_mul_f32 v242, v242, v238
v_mul_f32 v243, v243, v238
v_cvt_pk_bf16_f32 v255, v242, v243
ds_write_b64 v253, v[254:255] offset:2048
s_waitcnt lgkmcnt(0)
ds_read_b64 v[254:255], v253 offset:2056
s_waitcnt lgkmcnt(0)
v_lshlrev_b32 v242, 16, v254
v_and_b32 v243, 0xffff0000, v254
v_mul_f32 v242, v242, v238
v_mul_f32 v243, v243, v238
v_cvt_pk_bf16_f32 v254, v242, v243
v_lshlrev_b32 v242, 16, v255
v_and_b32 v243, 0xffff0000, v255
v_mul_f32 v242, v242, v238
v_mul_f32 v243, v243, v238
v_cvt_pk_bf16_f32 v255, v242, v243
ds_write_b64 v253, v[254:255] offset:2056
s_waitcnt lgkmcnt(0)
ds_read_b64 v[254:255], v253 offset:6144
s_waitcnt lgkmcnt(0)
v_lshlrev_b32 v242, 16, v254
v_and_b32 v243, 0xffff0000, v254
v_mul_f32 v242, v242, v238
v_mul_f32 v243, v243, v238
v_cvt_pk_bf16_f32 v254, v242, v243
v_lshlrev_b32 v242, 16, v255
v_and_b32 v243, 0xffff0000, v255
v_mul_f32 v242, v242, v238
v_mul_f32 v243, v243, v238
v_cvt_pk_bf16_f32 v255, v242, v243
ds_write_b64 v253, v[254:255] offset:6144
s_waitcnt lgkmcnt(0)
ds_read_b64 v[254:255], v253 offset:6152
s_waitcnt lgkmcnt(0)
v_lshlrev_b32 v242, 16, v254
v_and_b32 v243, 0xffff0000, v254
v_mul_f32 v242, v242, v238
v_mul_f32 v243, v243, v238
v_cvt_pk_bf16_f32 v254, v242, v243
v_lshlrev_b32 v242, 16, v255
v_and_b32 v243, 0xffff0000, v255
v_mul_f32 v242, v242, v238
v_mul_f32 v243, v243, v238
v_cvt_pk_bf16_f32 v255, v242, v243
ds_write_b64 v253, v[254:255] offset:6152
s_waitcnt lgkmcnt(0)
v_log_f32 v243, v227
v_max3_f32 v235, v140, v141, v142
v_max3_f32 v235, v235, v143, v243
v_mov_b32 v243, v235
s_nop 1
v_permlane32_swap_b32 v235, v243
s_nop 1
v_max_f32 v235, v235, v243
v_mov_b32 v243, v235
s_nop 1
v_permlane16_swap_b32 v235, v243
s_nop 1
v_max_f32 v235, v235, v243
v_ceil_f32 v235, v235
v_max_f32 v235, 0, v235
v_sub_f32 v243, 0, v235
v_exp_f32 v239, v243
s_nop 1
v_mul_f32 v227, v227, v239
v_add_f32 v247, v247, v235
v_sub_f32 v204, v204, v235
v_sub_f32 v140, v140, v235
v_sub_f32 v156, v156, v235
v_sub_f32 v205, v205, v235
v_sub_f32 v141, v141, v235
v_sub_f32 v157, v157, v235
v_sub_f32 v206, v206, v235
v_sub_f32 v142, v142, v235
v_sub_f32 v158, v158, v235
v_sub_f32 v207, v207, v235
v_sub_f32 v143, v143, v235
v_sub_f32 v159, v159, v235
ds_read_b64 v[254:255], v253 offset:3072
s_waitcnt lgkmcnt(0)
v_lshlrev_b32 v242, 16, v254
v_and_b32 v243, 0xffff0000, v254
v_mul_f32 v242, v242, v239
v_mul_f32 v243, v243, v239
v_cvt_pk_bf16_f32 v254, v242, v243
v_lshlrev_b32 v242, 16, v255
v_and_b32 v243, 0xffff0000, v255
v_mul_f32 v242, v242, v239
v_mul_f32 v243, v243, v239
v_cvt_pk_bf16_f32 v255, v242, v243
ds_write_b64 v253, v[254:255] offset:3072
s_waitcnt lgkmcnt(0)
ds_read_b64 v[254:255], v253 offset:3080
s_waitcnt lgkmcnt(0)
v_lshlrev_b32 v242, 16, v254
v_and_b32 v243, 0xffff0000, v254
v_mul_f32 v242, v242, v239
v_mul_f32 v243, v243, v239
v_cvt_pk_bf16_f32 v254, v242, v243
v_lshlrev_b32 v242, 16, v255
v_and_b32 v243, 0xffff0000, v255
v_mul_f32 v242, v242, v239
v_mul_f32 v243, v243, v239
v_cvt_pk_bf16_f32 v255, v242, v243
ds_write_b64 v253, v[254:255] offset:3080
s_waitcnt lgkmcnt(0)
ds_read_b64 v[254:255], v253 offset:7168
s_waitcnt lgkmcnt(0)
v_lshlrev_b32 v242, 16, v254
v_and_b32 v243, 0xffff0000, v254
v_mul_f32 v242, v242, v239
v_mul_f32 v243, v243, v239
v_cvt_pk_bf16_f32 v254, v242, v243
v_lshlrev_b32 v242, 16, v255
v_and_b32 v243, 0xffff0000, v255
v_mul_f32 v242, v242, v239
v_mul_f32 v243, v243, v239
v_cvt_pk_bf16_f32 v255, v242, v243
ds_write_b64 v253, v[254:255] offset:7168
s_waitcnt lgkmcnt(0)
ds_read_b64 v[254:255], v253 offset:7176
s_waitcnt lgkmcnt(0)
v_lshlrev_b32 v242, 16, v254
v_and_b32 v243, 0xffff0000, v254
v_mul_f32 v242, v242, v239
v_mul_f32 v243, v243, v239
v_cvt_pk_bf16_f32 v254, v242, v243
v_lshlrev_b32 v242, 16, v255
v_and_b32 v243, 0xffff0000, v255
v_mul_f32 v242, v242, v239
v_mul_f32 v243, v243, v239
v_cvt_pk_bf16_f32 v255, v242, v243
ds_write_b64 v253, v[254:255] offset:7176
s_waitcnt lgkmcnt(0)
v_exp_f32 v232, v128
v_exp_f32 v233, v129
v_exp_f32 v234, v130
v_exp_f32 v235, v131
s_nop 1
v_add_f32 v228, v224, v232
v_add_f32 v228, v228, v233
v_add_f32 v228, v228, v234
v_add_f32 v228, v228, v235
v_cvt_pk_bf16_f32 v160, v232, v233
v_cvt_pk_bf16_f32 v161, v234, v235
v_exp_f32 v232, v132
v_exp_f32 v233, v133
v_exp_f32 v234, v134
v_exp_f32 v235, v135
s_nop 1
v_add_f32 v229, v225, v232
v_add_f32 v229, v229, v233
v_add_f32 v229, v229, v234
v_add_f32 v229, v229, v235
v_cvt_pk_bf16_f32 v164, v232, v233
v_cvt_pk_bf16_f32 v165, v234, v235
v_exp_f32 v232, v136
v_exp_f32 v233, v137
v_exp_f32 v234, v138
v_exp_f32 v235, v139
s_nop 1
v_add_f32 v230, v226, v232
v_add_f32 v230, v230, v233
v_add_f32 v230, v230, v234
v_add_f32 v230, v230, v235
v_cvt_pk_bf16_f32 v168, v232, v233
v_cvt_pk_bf16_f32 v169, v234, v235
v_exp_f32 v232, v140
v_exp_f32 v233, v141
v_exp_f32 v234, v142
v_exp_f32 v235, v143
s_nop 1
v_add_f32 v231, v227, v232
v_add_f32 v231, v231, v233
v_add_f32 v231, v231, v234
v_add_f32 v231, v231, v235
v_cvt_pk_bf16_f32 v172, v232, v233
v_cvt_pk_bf16_f32 v173, v234, v235
s_branch L2_rare_common
L2_rare_site7:
s_mov_b32 s36, 7
s_branch L2_rare_t0_3_1
L2_rare_t0_3_1:
s_nop 15
s_nop 15
s_waitcnt lgkmcnt(0)
v_log_f32 v243, v228
v_max3_f32 v232, v144, v145, v146
v_max3_f32 v232, v232, v147, v243
v_mov_b32 v243, v232
s_nop 1
v_permlane32_swap_b32 v232, v243
s_nop 1
v_max_f32 v232, v232, v243
v_mov_b32 v243, v232
s_nop 1
v_permlane16_swap_b32 v232, v243
s_nop 1
v_max_f32 v232, v232, v243
v_ceil_f32 v232, v232
v_max_f32 v232, 0, v232
v_sub_f32 v243, 0, v232
v_exp_f32 v236, v243
s_nop 1
v_mul_f32 v228, v228, v236
v_add_f32 v244, v244, v232
v_sub_f32 v192, v192, v232
v_sub_f32 v128, v128, v232
v_sub_f32 v144, v144, v232
v_sub_f32 v193, v193, v232
v_sub_f32 v129, v129, v232
v_sub_f32 v145, v145, v232
v_sub_f32 v194, v194, v232
v_sub_f32 v130, v130, v232
v_sub_f32 v146, v146, v232
v_sub_f32 v195, v195, v232
v_sub_f32 v131, v131, v232
v_sub_f32 v147, v147, v232
v_lshlrev_b32 v242, 16, v160
v_and_b32 v243, 0xffff0000, v160
v_mul_f32 v242, v242, v236
v_mul_f32 v243, v243, v236
v_cvt_pk_bf16_f32 v160, v242, v243
v_lshlrev_b32 v242, 16, v161
v_and_b32 v243, 0xffff0000, v161
v_mul_f32 v242, v242, v236
v_mul_f32 v243, v243, v236
v_cvt_pk_bf16_f32 v161, v242, v243
ds_read_b64 v[254:255], v253 offset:0
s_waitcnt lgkmcnt(0)
v_lshlrev_b32 v242, 16, v254
v_and_b32 v243, 0xffff0000, v254
v_mul_f32 v242, v242, v236
v_mul_f32 v243, v243, v236
v_cvt_pk_bf16_f32 v254, v242, v243
v_lshlrev_b32 v242, 16, v255
v_and_b32 v243, 0xffff0000, v255
v_mul_f32 v242, v242, v236
v_mul_f32 v243, v243, v236
v_cvt_pk_bf16_f32 v255, v242, v243
ds_write_b64 v253, v[254:255] offset:0
s_waitcnt lgkmcnt(0)
ds_read_b64 v[254:255], v253 offset:8
s_waitcnt lgkmcnt(0)
v_lshlrev_b32 v242, 16, v254
v_and_b32 v243, 0xffff0000, v254
v_mul_f32 v242, v242, v236
v_mul_f32 v243, v243, v236
v_cvt_pk_bf16_f32 v254, v242, v243
v_lshlrev_b32 v242, 16, v255
v_and_b32 v243, 0xffff0000, v255
v_mul_f32 v242, v242, v236
v_mul_f32 v243, v243, v236
v_cvt_pk_bf16_f32 v255, v242, v243
ds_write_b64 v253, v[254:255] offset:8
s_waitcnt lgkmcnt(0)
ds_read_b64 v[254:255], v253 offset:4096
s_waitcnt lgkmcnt(0)
v_lshlrev_b32 v242, 16, v254
v_and_b32 v243, 0xffff0000, v254
v_mul_f32 v242, v242, v236
v_mul_f32 v243, v243, v236
v_cvt_pk_bf16_f32 v254, v242, v243
v_lshlrev_b32 v242, 16, v255
v_and_b32 v243, 0xffff0000, v255
v_mul_f32 v242, v242, v236
v_mul_f32 v243, v243, v236
v_cvt_pk_bf16_f32 v255, v242, v243
ds_write_b64 v253, v[254:255] offset:4096
s_waitcnt lgkmcnt(0)
ds_read_b64 v[254:255], v253 offset:4104
s_waitcnt lgkmcnt(0)
v_lshlrev_b32 v242, 16, v254
v_and_b32 v243, 0xffff0000, v254
v_mul_f32 v242, v242, v236
v_mul_f32 v243, v243, v236
v_cvt_pk_bf16_f32 v254, v242, v243
v_lshlrev_b32 v242, 16, v255
v_and_b32 v243, 0xffff0000, v255
v_mul_f32 v242, v242, v236
v_mul_f32 v243, v243, v236
v_cvt_pk_bf16_f32 v255, v242, v243
ds_write_b64 v253, v[254:255] offset:4104
s_waitcnt lgkmcnt(0)
v_log_f32 v243, v229
v_max3_f32 v233, v148, v149, v150
v_max3_f32 v233, v233, v151, v243
v_mov_b32 v243, v233
s_nop 1
v_permlane32_swap_b32 v233, v243
s_nop 1
v_max_f32 v233, v233, v243
v_mov_b32 v243, v233
s_nop 1
v_permlane16_swap_b32 v233, v243
s_nop 1
v_max_f32 v233, v233, v243
v_ceil_f32 v233, v233
v_max_f32 v233, 0, v233
v_sub_f32 v243, 0, v233
v_exp_f32 v237, v243
s_nop 1
v_mul_f32 v229, v229, v237
v_add_f32 v245, v245, v233
v_sub_f32 v196, v196, v233
v_sub_f32 v132, v132, v233
v_sub_f32 v148, v148, v233
v_sub_f32 v197, v197, v233
v_sub_f32 v133, v133, v233
v_sub_f32 v149, v149, v233
v_sub_f32 v198, v198, v233
v_sub_f32 v134, v134, v233
v_sub_f32 v150, v150, v233
v_sub_f32 v199, v199, v233
v_sub_f32 v135, v135, v233
v_sub_f32 v151, v151, v233
v_lshlrev_b32 v242, 16, v164
v_and_b32 v243, 0xffff0000, v164
v_mul_f32 v242, v242, v237
v_mul_f32 v243, v243, v237
v_cvt_pk_bf16_f32 v164, v242, v243
v_lshlrev_b32 v242, 16, v165
v_and_b32 v243, 0xffff0000, v165
v_mul_f32 v242, v242, v237
v_mul_f32 v243, v243, v237
v_cvt_pk_bf16_f32 v165, v242, v243
ds_read_b64 v[254:255], v253 offset:1024
s_waitcnt lgkmcnt(0)
v_lshlrev_b32 v242, 16, v254
v_and_b32 v243, 0xffff0000, v254
v_mul_f32 v242, v242, v237
v_mul_f32 v243, v243, v237
v_cvt_pk_bf16_f32 v254, v242, v243
v_lshlrev_b32 v242, 16, v255
v_and_b32 v243, 0xffff0000, v255
v_mul_f32 v242, v242, v237
v_mul_f32 v243, v243, v237
v_cvt_pk_bf16_f32 v255, v242, v243
ds_write_b64 v253, v[254:255] offset:1024
s_waitcnt lgkmcnt(0)
ds_read_b64 v[254:255], v253 offset:1032
s_waitcnt lgkmcnt(0)
v_lshlrev_b32 v242, 16, v254
v_and_b32 v243, 0xffff0000, v254
v_mul_f32 v242, v242, v237
v_mul_f32 v243, v243, v237
v_cvt_pk_bf16_f32 v254, v242, v243
v_lshlrev_b32 v242, 16, v255
v_and_b32 v243, 0xffff0000, v255
v_mul_f32 v242, v242, v237
v_mul_f32 v243, v243, v237
v_cvt_pk_bf16_f32 v255, v242, v243
ds_write_b64 v253, v[254:255] offset:1032
s_waitcnt lgkmcnt(0)
ds_read_b64 v[254:255], v253 offset:5120
s_waitcnt lgkmcnt(0)
v_lshlrev_b32 v242, 16, v254
v_and_b32 v243, 0xffff0000, v254
v_mul_f32 v242, v242, v237
v_mul_f32 v243, v243, v237
v_cvt_pk_bf16_f32 v254, v242, v243
v_lshlrev_b32 v242, 16, v255
v_and_b32 v243, 0xffff0000, v255
v_mul_f32 v242, v242, v237
v_mul_f32 v243, v243, v237
v_cvt_pk_bf16_f32 v255, v242, v243
ds_write_b64 v253, v[254:255] offset:5120
s_waitcnt lgkmcnt(0)
ds_read_b64 v[254:255], v253 offset:5128
s_waitcnt lgkmcnt(0)
v_lshlrev_b32 v242, 16, v254
v_and_b32 v243, 0xffff0000, v254
v_mul_f32 v242, v242, v237
v_mul_f32 v243, v243, v237
v_cvt_pk_bf16_f32 v254, v242, v243
v_lshlrev_b32 v242, 16, v255
v_and_b32 v243, 0xffff0000, v255
v_mul_f32 v242, v242, v237
v_mul_f32 v243, v243, v237
v_cvt_pk_bf16_f32 v255, v242, v243
ds_write_b64 v253, v[254:255] offset:5128
s_waitcnt lgkmcnt(0)
v_log_f32 v243, v230
v_max3_f32 v234, v152, v153, v154
v_max3_f32 v234, v234, v155, v243
v_mov_b32 v243, v234
s_nop 1
v_permlane32_swap_b32 v234, v243
s_nop 1
v_max_f32 v234, v234, v243
v_mov_b32 v243, v234
s_nop 1
v_permlane16_swap_b32 v234, v243
s_nop 1
v_max_f32 v234, v234, v243
v_ceil_f32 v234, v234
v_max_f32 v234, 0, v234
v_sub_f32 v243, 0, v234
v_exp_f32 v238, v243
s_nop 1
v_mul_f32 v230, v230, v238
v_add_f32 v246, v246, v234
v_sub_f32 v200, v200, v234
v_sub_f32 v136, v136, v234
v_sub_f32 v152, v152, v234
v_sub_f32 v201, v201, v234
v_sub_f32 v137, v137, v234
v_sub_f32 v153, v153, v234
v_sub_f32 v202, v202, v234
v_sub_f32 v138, v138, v234
v_sub_f32 v154, v154, v234
v_sub_f32 v203, v203, v234
v_sub_f32 v139, v139, v234
v_sub_f32 v155, v155, v234
v_lshlrev_b32 v242, 16, v168
v_and_b32 v243, 0xffff0000, v168
v_mul_f32 v242, v242, v238
v_mul_f32 v243, v243, v238
v_cvt_pk_bf16_f32 v168, v242, v243
v_lshlrev_b32 v242, 16, v169
v_and_b32 v243, 0xffff0000, v169
v_mul_f32 v242, v242, v238
v_mul_f32 v243, v243, v238
v_cvt_pk_bf16_f32 v169, v242, v243
ds_read_b64 v[254:255], v253 offset:2048
s_waitcnt lgkmcnt(0)
v_lshlrev_b32 v242, 16, v254
v_and_b32 v243, 0xffff0000, v254
v_mul_f32 v242, v242, v238
v_mul_f32 v243, v243, v238
v_cvt_pk_bf16_f32 v254, v242, v243
v_lshlrev_b32 v242, 16, v255
v_and_b32 v243, 0xffff0000, v255
v_mul_f32 v242, v242, v238
v_mul_f32 v243, v243, v238
v_cvt_pk_bf16_f32 v255, v242, v243
ds_write_b64 v253, v[254:255] offset:2048
s_waitcnt lgkmcnt(0)
ds_read_b64 v[254:255], v253 offset:2056
s_waitcnt lgkmcnt(0)
v_lshlrev_b32 v242, 16, v254
v_and_b32 v243, 0xffff0000, v254
v_mul_f32 v242, v242, v238
v_mul_f32 v243, v243, v238
v_cvt_pk_bf16_f32 v254, v242, v243
v_lshlrev_b32 v242, 16, v255
v_and_b32 v243, 0xffff0000, v255
v_mul_f32 v242, v242, v238
v_mul_f32 v243, v243, v238
v_cvt_pk_bf16_f32 v255, v242, v243
ds_write_b64 v253, v[254:255] offset:2056
s_waitcnt lgkmcnt(0)
ds_read_b64 v[254:255], v253 offset:6144
s_waitcnt lgkmcnt(0)
v_lshlrev_b32 v242, 16, v254
v_and_b32 v243, 0xffff0000, v254
v_mul_f32 v242, v242, v238
v_mul_f32 v243, v243, v238
v_cvt_pk_bf16_f32 v254, v242, v243
v_lshlrev_b32 v242, 16, v255
v_and_b32 v243, 0xffff0000, v255
v_mul_f32 v242, v242, v238
v_mul_f32 v243, v243, v238
v_cvt_pk_bf16_f32 v255, v242, v243
ds_write_b64 v253, v[254:255] offset:6144
s_waitcnt lgkmcnt(0)
ds_read_b64 v[254:255], v253 offset:6152
s_waitcnt lgkmcnt(0)
v_lshlrev_b32 v242, 16, v254
v_and_b32 v243, 0xffff0000, v254
v_mul_f32 v242, v242, v238
v_mul_f32 v243, v243, v238
v_cvt_pk_bf16_f32 v254, v242, v243
v_lshlrev_b32 v242, 16, v255
v_and_b32 v243, 0xffff0000, v255
v_mul_f32 v242, v242, v238
v_mul_f32 v243, v243, v238
v_cvt_pk_bf16_f32 v255, v242, v243
ds_write_b64 v253, v[254:255] offset:6152
s_waitcnt lgkmcnt(0)
v_log_f32 v243, v231
v_max3_f32 v235, v156, v157, v158
v_max3_f32 v235, v235, v159, v243
v_mov_b32 v243, v235
s_nop 1
v_permlane32_swap_b32 v235, v243
s_nop 1
v_max_f32 v235, v235, v243
v_mov_b32 v243, v235
s_nop 1
v_permlane16_swap_b32 v235, v243
s_nop 1
v_max_f32 v235, v235, v243
v_ceil_f32 v235, v235
v_max_f32 v235, 0, v235
v_sub_f32 v243, 0, v235
v_exp_f32 v239, v243
s_nop 1
v_mul_f32 v231, v231, v239
v_add_f32 v247, v247, v235
v_sub_f32 v204, v204, v235
v_sub_f32 v140, v140, v235
v_sub_f32 v156, v156, v235
v_sub_f32 v205, v205, v235
v_sub_f32 v141, v141, v235
v_sub_f32 v157, v157, v235
v_sub_f32 v206, v206, v235
v_sub_f32 v142, v142, v235
v_sub_f32 v158, v158, v235
v_sub_f32 v207, v207, v235
v_sub_f32 v143, v143, v235
v_sub_f32 v159, v159, v235
v_lshlrev_b32 v242, 16, v172
v_and_b32 v243, 0xffff0000, v172
v_mul_f32 v242, v242, v239
v_mul_f32 v243, v243, v239
v_cvt_pk_bf16_f32 v172, v242, v243
v_lshlrev_b32 v242, 16, v173
v_and_b32 v243, 0xffff0000, v173
v_mul_f32 v242, v242, v239
v_mul_f32 v243, v243, v239
v_cvt_pk_bf16_f32 v173, v242, v243
ds_read_b64 v[254:255], v253 offset:3072
s_waitcnt lgkmcnt(0)
v_lshlrev_b32 v242, 16, v254
v_and_b32 v243, 0xffff0000, v254
v_mul_f32 v242, v242, v239
v_mul_f32 v243, v243, v239
v_cvt_pk_bf16_f32 v254, v242, v243
v_lshlrev_b32 v242, 16, v255
v_and_b32 v243, 0xffff0000, v255
v_mul_f32 v242, v242, v239
v_mul_f32 v243, v243, v239
v_cvt_pk_bf16_f32 v255, v242, v243
ds_write_b64 v253, v[254:255] offset:3072
s_waitcnt lgkmcnt(0)
ds_read_b64 v[254:255], v253 offset:3080
s_waitcnt lgkmcnt(0)
v_lshlrev_b32 v242, 16, v254
v_and_b32 v243, 0xffff0000, v254
v_mul_f32 v242, v242, v239
v_mul_f32 v243, v243, v239
v_cvt_pk_bf16_f32 v254, v242, v243
v_lshlrev_b32 v242, 16, v255
v_and_b32 v243, 0xffff0000, v255
v_mul_f32 v242, v242, v239
v_mul_f32 v243, v243, v239
v_cvt_pk_bf16_f32 v255, v242, v243
ds_write_b64 v253, v[254:255] offset:3080
s_waitcnt lgkmcnt(0)
ds_read_b64 v[254:255], v253 offset:7168
s_waitcnt lgkmcnt(0)
v_lshlrev_b32 v242, 16, v254
v_and_b32 v243, 0xffff0000, v254
v_mul_f32 v242, v242, v239
v_mul_f32 v243, v243, v239
v_cvt_pk_bf16_f32 v254, v242, v243
v_lshlrev_b32 v242, 16, v255
v_and_b32 v243, 0xffff0000, v255
v_mul_f32 v242, v242, v239
v_mul_f32 v243, v243, v239
v_cvt_pk_bf16_f32 v255, v242, v243
ds_write_b64 v253, v[254:255] offset:7168
s_waitcnt lgkmcnt(0)
ds_read_b64 v[254:255], v253 offset:7176
s_waitcnt lgkmcnt(0)
v_lshlrev_b32 v242, 16, v254
v_and_b32 v243, 0xffff0000, v254
v_mul_f32 v242, v242, v239
v_mul_f32 v243, v243, v239
v_cvt_pk_bf16_f32 v254, v242, v243
v_lshlrev_b32 v242, 16, v255
v_and_b32 v243, 0xffff0000, v255
v_mul_f32 v242, v242, v239
v_mul_f32 v243, v243, v239
v_cvt_pk_bf16_f32 v255, v242, v243
ds_write_b64 v253, v[254:255] offset:7176
s_waitcnt lgkmcnt(0)
v_exp_f32 v232, v144
v_exp_f32 v233, v145
v_exp_f32 v234, v146
v_exp_f32 v235, v147
s_nop 1
v_add_f32 v224, v228, v232
v_add_f32 v224, v224, v233
v_add_f32 v224, v224, v234
v_add_f32 v224, v224, v235
v_cvt_pk_bf16_f32 v162, v232, v233
v_cvt_pk_bf16_f32 v163, v234, v235
v_exp_f32 v232, v148
v_exp_f32 v233, v149
v_exp_f32 v234, v150
v_exp_f32 v235, v151
s_nop 1
v_add_f32 v225, v229, v232
v_add_f32 v225, v225, v233
v_add_f32 v225, v225, v234
v_add_f32 v225, v225, v235
v_cvt_pk_bf16_f32 v166, v232, v233
v_cvt_pk_bf16_f32 v167, v234, v235
v_exp_f32 v232, v152
v_exp_f32 v233, v153
v_exp_f32 v234, v154
v_exp_f32 v235, v155
s_nop 1
v_add_f32 v226, v230, v232
v_add_f32 v226, v226, v233
v_add_f32 v226, v226, v234
v_add_f32 v226, v226, v235
v_cvt_pk_bf16_f32 v170, v232, v233
v_cvt_pk_bf16_f32 v171, v234, v235
v_exp_f32 v232, v156
v_exp_f32 v233, v157
v_exp_f32 v234, v158
v_exp_f32 v235, v159
s_nop 1
v_add_f32 v227, v231, v232
v_add_f32 v227, v227, v233
v_add_f32 v227, v227, v234
v_add_f32 v227, v227, v235
v_cvt_pk_bf16_f32 v174, v232, v233
v_cvt_pk_bf16_f32 v175, v234, v235
s_branch L2_rare_common
L2_rare_site8:
s_mov_b32 s36, 8
s_branch L2_rare_t0_4_0
L2_rare_t0_4_0:
s_nop 15
s_nop 15
s_waitcnt lgkmcnt(0)
v_log_f32 v243, v224
v_max3_f32 v232, v128, v129, v130
v_max3_f32 v232, v232, v131, v243
v_mov_b32 v243, v232
s_nop 1
v_permlane32_swap_b32 v232, v243
s_nop 1
v_max_f32 v232, v232, v243
v_mov_b32 v243, v232
s_nop 1
v_permlane16_swap_b32 v232, v243
s_nop 1
v_max_f32 v232, v232, v243
v_ceil_f32 v232, v232
v_max_f32 v232, 0, v232
v_sub_f32 v243, 0, v232
v_exp_f32 v236, v243
s_nop 1
v_mul_f32 v224, v224, v236
v_add_f32 v244, v244, v232
v_sub_f32 v192, v192, v232
v_sub_f32 v128, v128, v232
v_sub_f32 v144, v144, v232
v_sub_f32 v193, v193, v232
v_sub_f32 v129, v129, v232
v_sub_f32 v145, v145, v232
v_sub_f32 v194, v194, v232
v_sub_f32 v130, v130, v232
v_sub_f32 v146, v146, v232
v_sub_f32 v195, v195, v232
v_sub_f32 v131, v131, v232
v_sub_f32 v147, v147, v232
v_lshlrev_b32 v242, 16, v160
v_and_b32 v243, 0xffff0000, v160
v_mul_f32 v242, v242, v236
v_mul_f32 v243, v243, v236
v_cvt_pk_bf16_f32 v160, v242, v243
v_lshlrev_b32 v242, 16, v161
v_and_b32 v243, 0xffff0000, v161
v_mul_f32 v242, v242, v236
v_mul_f32 v243, v243, v236
v_cvt_pk_bf16_f32 v161, v242, v243
v_lshlrev_b32 v242, 16, v162
v_and_b32 v243, 0xffff0000, v162
v_mul_f32 v242, v242, v236
v_mul_f32 v243, v243, v236
v_cvt_pk_bf16_f32 v162, v242, v243
v_lshlrev_b32 v242, 16, v163
v_and_b32 v243, 0xffff0000, v163
v_mul_f32 v242, v242, v236
v_mul_f32 v243, v243, v236
v_cvt_pk_bf16_f32 v163, v242, v243
ds_read_b64 v[254:255], v253 offset:0
s_waitcnt lgkmcnt(0)
v_lshlrev_b32 v242, 16, v254
v_and_b32 v243, 0xffff0000, v254
v_mul_f32 v242, v242, v236
v_mul_f32 v243, v243, v236
v_cvt_pk_bf16_f32 v254, v242, v243
v_lshlrev_b32 v242, 16, v255
v_and_b32 v243, 0xffff0000, v255
v_mul_f32 v242, v242, v236
v_mul_f32 v243, v243, v236
v_cvt_pk_bf16_f32 v255, v242, v243
ds_write_b64 v253, v[254:255] offset:0
s_waitcnt lgkmcnt(0)
ds_read_b64 v[254:255], v253 offset:8
s_waitcnt lgkmcnt(0)
v_lshlrev_b32 v242, 16, v254
v_and_b32 v243, 0xffff0000, v254
v_mul_f32 v242, v242, v236
v_mul_f32 v243, v243, v236
v_cvt_pk_bf16_f32 v254, v242, v243
v_lshlrev_b32 v242, 16, v255
v_and_b32 v243, 0xffff0000, v255
v_mul_f32 v242, v242, v236
v_mul_f32 v243, v243, v236
v_cvt_pk_bf16_f32 v255, v242, v243
ds_write_b64 v253, v[254:255] offset:8
s_waitcnt lgkmcnt(0)
ds_read_b64 v[254:255], v253 offset:4096
s_waitcnt lgkmcnt(0)
v_lshlrev_b32 v242, 16, v254
v_and_b32 v243, 0xffff0000, v254
v_mul_f32 v242, v242, v236
v_mul_f32 v243, v243, v236
v_cvt_pk_bf16_f32 v254, v242, v243
v_lshlrev_b32 v242, 16, v255
v_and_b32 v243, 0xffff0000, v255
v_mul_f32 v242, v242, v236
v_mul_f32 v243, v243, v236
v_cvt_pk_bf16_f32 v255, v242, v243
ds_write_b64 v253, v[254:255] offset:4096
s_waitcnt lgkmcnt(0)
ds_read_b64 v[254:255], v253 offset:4104
s_waitcnt lgkmcnt(0)
v_lshlrev_b32 v242, 16, v254
v_and_b32 v243, 0xffff0000, v254
v_mul_f32 v242, v242, v236
v_mul_f32 v243, v243, v236
v_cvt_pk_bf16_f32 v254, v242, v243
v_lshlrev_b32 v242, 16, v255
v_and_b32 v243, 0xffff0000, v255
v_mul_f32 v242, v242, v236
v_mul_f32 v243, v243, v236
v_cvt_pk_bf16_f32 v255, v242, v243
ds_write_b64 v253, v[254:255] offset:4104
s_waitcnt lgkmcnt(0)
v_log_f32 v243, v225
v_max3_f32 v233, v132, v133, v134
v_max3_f32 v233, v233, v135, v243
v_mov_b32 v243, v233
s_nop 1
v_permlane32_swap_b32 v233, v243
s_nop 1
v_max_f32 v233, v233, v243
v_mov_b32 v243, v233
s_nop 1
v_permlane16_swap_b32 v233, v243
s_nop 1
v_max_f32 v233, v233, v243
v_ceil_f32 v233, v233
v_max_f32 v233, 0, v233
v_sub_f32 v243, 0, v233
v_exp_f32 v237, v243
s_nop 1
v_mul_f32 v225, v225, v237
v_add_f32 v245, v245, v233
v_sub_f32 v196, v196, v233
v_sub_f32 v132, v132, v233
v_sub_f32 v148, v148, v233
v_sub_f32 v197, v197, v233
v_sub_f32 v133, v133, v233
v_sub_f32 v149, v149, v233
v_sub_f32 v198, v198, v233
v_sub_f32 v134, v134, v233
v_sub_f32 v150, v150, v233
v_sub_f32 v199, v199, v233
v_sub_f32 v135, v135, v233
v_sub_f32 v151, v151, v233
v_lshlrev_b32 v242, 16, v164
v_and_b32 v243, 0xffff0000, v164
v_mul_f32 v242, v242, v237
v_mul_f32 v243, v243, v237
v_cvt_pk_bf16_f32 v164, v242, v243
v_lshlrev_b32 v242, 16, v165
v_and_b32 v243, 0xffff0000, v165
v_mul_f32 v242, v242, v237
v_mul_f32 v243, v243, v237
v_cvt_pk_bf16_f32 v165, v242, v243
v_lshlrev_b32 v242, 16, v166
v_and_b32 v243, 0xffff0000, v166
v_mul_f32 v242, v242, v237
v_mul_f32 v243, v243, v237
v_cvt_pk_bf16_f32 v166, v242, v243
v_lshlrev_b32 v242, 16, v167
v_and_b32 v243, 0xffff0000, v167
v_mul_f32 v242, v242, v237
v_mul_f32 v243, v243, v237
v_cvt_pk_bf16_f32 v167, v242, v243
ds_read_b64 v[254:255], v253 offset:1024
s_waitcnt lgkmcnt(0)
v_lshlrev_b32 v242, 16, v254
v_and_b32 v243, 0xffff0000, v254
v_mul_f32 v242, v242, v237
v_mul_f32 v243, v243, v237
v_cvt_pk_bf16_f32 v254, v242, v243
v_lshlrev_b32 v242, 16, v255
v_and_b32 v243, 0xffff0000, v255
v_mul_f32 v242, v242, v237
v_mul_f32 v243, v243, v237
v_cvt_pk_bf16_f32 v255, v242, v243
ds_write_b64 v253, v[254:255] offset:1024
s_waitcnt lgkmcnt(0)
ds_read_b64 v[254:255], v253 offset:1032
s_waitcnt lgkmcnt(0)
v_lshlrev_b32 v242, 16, v254
v_and_b32 v243, 0xffff0000, v254
v_mul_f32 v242, v242, v237
v_mul_f32 v243, v243, v237
v_cvt_pk_bf16_f32 v254, v242, v243
v_lshlrev_b32 v242, 16, v255
v_and_b32 v243, 0xffff0000, v255
v_mul_f32 v242, v242, v237
v_mul_f32 v243, v243, v237
v_cvt_pk_bf16_f32 v255, v242, v243
ds_write_b64 v253, v[254:255] offset:1032
s_waitcnt lgkmcnt(0)
ds_read_b64 v[254:255], v253 offset:5120
s_waitcnt lgkmcnt(0)
v_lshlrev_b32 v242, 16, v254
v_and_b32 v243, 0xffff0000, v254
v_mul_f32 v242, v242, v237
v_mul_f32 v243, v243, v237
v_cvt_pk_bf16_f32 v254, v242, v243
v_lshlrev_b32 v242, 16, v255
v_and_b32 v243, 0xffff0000, v255
v_mul_f32 v242, v242, v237
v_mul_f32 v243, v243, v237
v_cvt_pk_bf16_f32 v255, v242, v243
ds_write_b64 v253, v[254:255] offset:5120
s_waitcnt lgkmcnt(0)
ds_read_b64 v[254:255], v253 offset:5128
s_waitcnt lgkmcnt(0)
v_lshlrev_b32 v242, 16, v254
v_and_b32 v243, 0xffff0000, v254
v_mul_f32 v242, v242, v237
v_mul_f32 v243, v243, v237
v_cvt_pk_bf16_f32 v254, v242, v243
v_lshlrev_b32 v242, 16, v255
v_and_b32 v243, 0xffff0000, v255
v_mul_f32 v242, v242, v237
v_mul_f32 v243, v243, v237
v_cvt_pk_bf16_f32 v255, v242, v243
ds_write_b64 v253, v[254:255] offset:5128
s_waitcnt lgkmcnt(0)
v_log_f32 v243, v226
v_max3_f32 v234, v136, v137, v138
v_max3_f32 v234, v234, v139, v243
v_mov_b32 v243, v234
s_nop 1
v_permlane32_swap_b32 v234, v243
s_nop 1
v_max_f32 v234, v234, v243
v_mov_b32 v243, v234
s_nop 1
v_permlane16_swap_b32 v234, v243
s_nop 1
v_max_f32 v234, v234, v243
v_ceil_f32 v234, v234
v_max_f32 v234, 0, v234
v_sub_f32 v243, 0, v234
v_exp_f32 v238, v243
s_nop 1
v_mul_f32 v226, v226, v238
v_add_f32 v246, v246, v234
v_sub_f32 v200, v200, v234
v_sub_f32 v136, v136, v234
v_sub_f32 v152, v152, v234
v_sub_f32 v201, v201, v234
v_sub_f32 v137, v137, v234
v_sub_f32 v153, v153, v234
v_sub_f32 v202, v202, v234
v_sub_f32 v138, v138, v234
v_sub_f32 v154, v154, v234
v_sub_f32 v203, v203, v234
v_sub_f32 v139, v139, v234
v_sub_f32 v155, v155, v234
v_lshlrev_b32 v242, 16, v168
v_and_b32 v243, 0xffff0000, v168
v_mul_f32 v242, v242, v238
v_mul_f32 v243, v243, v238
v_cvt_pk_bf16_f32 v168, v242, v243
v_lshlrev_b32 v242, 16, v169
v_and_b32 v243, 0xffff0000, v169
v_mul_f32 v242, v242, v238
v_mul_f32 v243, v243, v238
v_cvt_pk_bf16_f32 v169, v242, v243
v_lshlrev_b32 v242, 16, v170
v_and_b32 v243, 0xffff0000, v170
v_mul_f32 v242, v242, v238
v_mul_f32 v243, v243, v238
v_cvt_pk_bf16_f32 v170, v242, v243
v_lshlrev_b32 v242, 16, v171
v_and_b32 v243, 0xffff0000, v171
v_mul_f32 v242, v242, v238
v_mul_f32 v243, v243, v238
v_cvt_pk_bf16_f32 v171, v242, v243
ds_read_b64 v[254:255], v253 offset:2048
s_waitcnt lgkmcnt(0)
v_lshlrev_b32 v242, 16, v254
v_and_b32 v243, 0xffff0000, v254
v_mul_f32 v242, v242, v238
v_mul_f32 v243, v243, v238
v_cvt_pk_bf16_f32 v254, v242, v243
v_lshlrev_b32 v242, 16, v255
v_and_b32 v243, 0xffff0000, v255
v_mul_f32 v242, v242, v238
v_mul_f32 v243, v243, v238
v_cvt_pk_bf16_f32 v255, v242, v243
ds_write_b64 v253, v[254:255] offset:2048
s_waitcnt lgkmcnt(0)
ds_read_b64 v[254:255], v253 offset:2056
s_waitcnt lgkmcnt(0)
v_lshlrev_b32 v242, 16, v254
v_and_b32 v243, 0xffff0000, v254
v_mul_f32 v242, v242, v238
v_mul_f32 v243, v243, v238
v_cvt_pk_bf16_f32 v254, v242, v243
v_lshlrev_b32 v242, 16, v255
v_and_b32 v243, 0xffff0000, v255
v_mul_f32 v242, v242, v238
v_mul_f32 v243, v243, v238
v_cvt_pk_bf16_f32 v255, v242, v243
ds_write_b64 v253, v[254:255] offset:2056
s_waitcnt lgkmcnt(0)
ds_read_b64 v[254:255], v253 offset:6144
s_waitcnt lgkmcnt(0)
v_lshlrev_b32 v242, 16, v254
v_and_b32 v243, 0xffff0000, v254
v_mul_f32 v242, v242, v238
v_mul_f32 v243, v243, v238
v_cvt_pk_bf16_f32 v254, v242, v243
v_lshlrev_b32 v242, 16, v255
v_and_b32 v243, 0xffff0000, v255
v_mul_f32 v242, v242, v238
v_mul_f32 v243, v243, v238
v_cvt_pk_bf16_f32 v255, v242, v243
ds_write_b64 v253, v[254:255] offset:6144
s_waitcnt lgkmcnt(0)
ds_read_b64 v[254:255], v253 offset:6152
s_waitcnt lgkmcnt(0)
v_lshlrev_b32 v242, 16, v254
v_and_b32 v243, 0xffff0000, v254
v_mul_f32 v242, v242, v238
v_mul_f32 v243, v243, v238
v_cvt_pk_bf16_f32 v254, v242, v243
v_lshlrev_b32 v242, 16, v255
v_and_b32 v243, 0xffff0000, v255
v_mul_f32 v242, v242, v238
v_mul_f32 v243, v243, v238
v_cvt_pk_bf16_f32 v255, v242, v243
ds_write_b64 v253, v[254:255] offset:6152
s_waitcnt lgkmcnt(0)
v_log_f32 v243, v227
v_max3_f32 v235, v140, v141, v142
v_max3_f32 v235, v235, v143, v243
v_mov_b32 v243, v235
s_nop 1
v_permlane32_swap_b32 v235, v243
s_nop 1
v_max_f32 v235, v235, v243
v_mov_b32 v243, v235
s_nop 1
v_permlane16_swap_b32 v235, v243
s_nop 1
v_max_f32 v235, v235, v243
v_ceil_f32 v235, v235
v_max_f32 v235, 0, v235
v_sub_f32 v243, 0, v235
v_exp_f32 v239, v243
s_nop 1
v_mul_f32 v227, v227, v239
v_add_f32 v247, v247, v235
v_sub_f32 v204, v204, v235
v_sub_f32 v140, v140, v235
v_sub_f32 v156, v156, v235
v_sub_f32 v205, v205, v235
v_sub_f32 v141, v141, v235
v_sub_f32 v157, v157, v235
v_sub_f32 v206, v206, v235
v_sub_f32 v142, v142, v235
v_sub_f32 v158, v158, v235
v_sub_f32 v207, v207, v235
v_sub_f32 v143, v143, v235
v_sub_f32 v159, v159, v235
v_lshlrev_b32 v242, 16, v172
v_and_b32 v243, 0xffff0000, v172
v_mul_f32 v242, v242, v239
v_mul_f32 v243, v243, v239
v_cvt_pk_bf16_f32 v172, v242, v243
v_lshlrev_b32 v242, 16, v173
v_and_b32 v243, 0xffff0000, v173
v_mul_f32 v242, v242, v239
v_mul_f32 v243, v243, v239
v_cvt_pk_bf16_f32 v173, v242, v243
v_lshlrev_b32 v242, 16, v174
v_and_b32 v243, 0xffff0000, v174
v_mul_f32 v242, v242, v239
v_mul_f32 v243, v243, v239
v_cvt_pk_bf16_f32 v174, v242, v243
v_lshlrev_b32 v242, 16, v175
v_and_b32 v243, 0xffff0000, v175
v_mul_f32 v242, v242, v239
v_mul_f32 v243, v243, v239
v_cvt_pk_bf16_f32 v175, v242, v243
ds_read_b64 v[254:255], v253 offset:3072
s_waitcnt lgkmcnt(0)
v_lshlrev_b32 v242, 16, v254
v_and_b32 v243, 0xffff0000, v254
v_mul_f32 v242, v242, v239
v_mul_f32 v243, v243, v239
v_cvt_pk_bf16_f32 v254, v242, v243
v_lshlrev_b32 v242, 16, v255
v_and_b32 v243, 0xffff0000, v255
v_mul_f32 v242, v242, v239
v_mul_f32 v243, v243, v239
v_cvt_pk_bf16_f32 v255, v242, v243
ds_write_b64 v253, v[254:255] offset:3072
s_waitcnt lgkmcnt(0)
ds_read_b64 v[254:255], v253 offset:3080
s_waitcnt lgkmcnt(0)
v_lshlrev_b32 v242, 16, v254
v_and_b32 v243, 0xffff0000, v254
v_mul_f32 v242, v242, v239
v_mul_f32 v243, v243, v239
v_cvt_pk_bf16_f32 v254, v242, v243
v_lshlrev_b32 v242, 16, v255
v_and_b32 v243, 0xffff0000, v255
v_mul_f32 v242, v242, v239
v_mul_f32 v243, v243, v239
v_cvt_pk_bf16_f32 v255, v242, v243
ds_write_b64 v253, v[254:255] offset:3080
s_waitcnt lgkmcnt(0)
ds_read_b64 v[254:255], v253 offset:7168
s_waitcnt lgkmcnt(0)
v_lshlrev_b32 v242, 16, v254
v_and_b32 v243, 0xffff0000, v254
v_mul_f32 v242, v242, v239
v_mul_f32 v243, v243, v239
v_cvt_pk_bf16_f32 v254, v242, v243
v_lshlrev_b32 v242, 16, v255
v_and_b32 v243, 0xffff0000, v255
v_mul_f32 v242, v242, v239
v_mul_f32 v243, v243, v239
v_cvt_pk_bf16_f32 v255, v242, v243
ds_write_b64 v253, v[254:255] offset:7168
s_waitcnt lgkmcnt(0)
ds_read_b64 v[254:255], v253 offset:7176
s_waitcnt lgkmcnt(0)
v_lshlrev_b32 v242, 16, v254
v_and_b32 v243, 0xffff0000, v254
v_mul_f32 v242, v242, v239
v_mul_f32 v243, v243, v239
v_cvt_pk_bf16_f32 v254, v242, v243
v_lshlrev_b32 v242, 16, v255
v_and_b32 v243, 0xffff0000, v255
v_mul_f32 v242, v242, v239
v_mul_f32 v243, v243, v239
v_cvt_pk_bf16_f32 v255, v242, v243
ds_write_b64 v253, v[254:255] offset:7176
s_waitcnt lgkmcnt(0)
v_exp_f32 v232, v128
v_exp_f32 v233, v129
v_exp_f32 v234, v130
v_exp_f32 v235, v131
s_nop 1
v_add_f32 v228, v224, v232
v_add_f32 v228, v228, v233
v_add_f32 v228, v228, v234
v_add_f32 v228, v228, v235
v_cvt_pk_bf16_f32 v176, v232, v233
v_cvt_pk_bf16_f32 v177, v234, v235
v_exp_f32 v232, v132
v_exp_f32 v233, v133
v_exp_f32 v234, v134
v_exp_f32 v235, v135
s_nop 1
v_add_f32 v229, v225, v232
v_add_f32 v229, v229, v233
v_add_f32 v229, v229, v234
v_add_f32 v229, v229, v235
v_cvt_pk_bf16_f32 v180, v232, v233
v_cvt_pk_bf16_f32 v181, v234, v235
v_exp_f32 v232, v136
v_exp_f32 v233, v137
v_exp_f32 v234, v138
v_exp_f32 v235, v139
s_nop 1
v_add_f32 v230, v226, v232
v_add_f32 v230, v230, v233
v_add_f32 v230, v230, v234
v_add_f32 v230, v230, v235
v_cvt_pk_bf16_f32 v184, v232, v233
v_cvt_pk_bf16_f32 v185, v234, v235
v_exp_f32 v232, v140
v_exp_f32 v233, v141
v_exp_f32 v234, v142
v_exp_f32 v235, v143
s_nop 1
v_add_f32 v231, v227, v232
v_add_f32 v231, v231, v233
v_add_f32 v231, v231, v234
v_add_f32 v231, v231, v235
v_cvt_pk_bf16_f32 v188, v232, v233
v_cvt_pk_bf16_f32 v189, v234, v235
s_branch L2_rare_common
L2_rare_site9:
s_mov_b32 s36, 9
s_branch L2_rare_t0_5_1
L2_rare_t0_5_1:
s_nop 15
s_nop 15
s_waitcnt lgkmcnt(0)
v_log_f32 v243, v228
v_max3_f32 v232, v144, v145, v146
v_max3_f32 v232, v232, v147, v243
v_mov_b32 v243, v232
s_nop 1
v_permlane32_swap_b32 v232, v243
s_nop 1
v_max_f32 v232, v232, v243
v_mov_b32 v243, v232
s_nop 1
v_permlane16_swap_b32 v232, v243
s_nop 1
v_max_f32 v232, v232, v243
v_ceil_f32 v232, v232
v_max_f32 v232, 0, v232
v_sub_f32 v243, 0, v232
v_exp_f32 v236, v243
s_nop 1
v_mul_f32 v228, v228, v236
v_add_f32 v244, v244, v232
v_sub_f32 v192, v192, v232
v_sub_f32 v128, v128, v232
v_sub_f32 v144, v144, v232
v_sub_f32 v193, v193, v232
v_sub_f32 v129, v129, v232
v_sub_f32 v145, v145, v232
v_sub_f32 v194, v194, v232
v_sub_f32 v130, v130, v232
v_sub_f32 v146, v146, v232
v_sub_f32 v195, v195, v232
v_sub_f32 v131, v131, v232
v_sub_f32 v147, v147, v232
v_lshlrev_b32 v242, 16, v160
v_and_b32 v243, 0xffff0000, v160
v_mul_f32 v242, v242, v236
v_mul_f32 v243, v243, v236
v_cvt_pk_bf16_f32 v160, v242, v243
v_lshlrev_b32 v242, 16, v161
v_and_b32 v243, 0xffff0000, v161
v_mul_f32 v242, v242, v236
v_mul_f32 v243, v243, v236
v_cvt_pk_bf16_f32 v161, v242, v243
v_lshlrev_b32 v242, 16, v162
v_and_b32 v243, 0xffff0000, v162
v_mul_f32 v242, v242, v236
v_mul_f32 v243, v243, v236
v_cvt_pk_bf16_f32 v162, v242, v243
v_lshlrev_b32 v242, 16, v163
v_and_b32 v243, 0xffff0000, v163
v_mul_f32 v242, v242, v236
v_mul_f32 v243, v243, v236
v_cvt_pk_bf16_f32 v163, v242, v243
v_lshlrev_b32 v242, 16, v176
v_and_b32 v243, 0xffff0000, v176
v_mul_f32 v242, v242, v236
v_mul_f32 v243, v243, v236
v_cvt_pk_bf16_f32 v176, v242, v243
v_lshlrev_b32 v242, 16, v177
v_and_b32 v243, 0xffff0000, v177
v_mul_f32 v242, v242, v236
v_mul_f32 v243, v243, v236
v_cvt_pk_bf16_f32 v177, v242, v243
ds_read_b64 v[254:255], v253 offset:0
s_waitcnt lgkmcnt(0)
v_lshlrev_b32 v242, 16, v254
v_and_b32 v243, 0xffff0000, v254
v_mul_f32 v242, v242, v236
v_mul_f32 v243, v243, v236
v_cvt_pk_bf16_f32 v254, v242, v243
v_lshlrev_b32 v242, 16, v255
v_and_b32 v243, 0xffff0000, v255
v_mul_f32 v242, v242, v236
v_mul_f32 v243, v243, v236
v_cvt_pk_bf16_f32 v255, v242, v243
ds_write_b64 v253, v[254:255] offset:0
s_waitcnt lgkmcnt(0)
ds_read_b64 v[254:255], v253 offset:8
s_waitcnt lgkmcnt(0)
v_lshlrev_b32 v242, 16, v254
v_and_b32 v243, 0xffff0000, v254
v_mul_f32 v242, v242, v236
v_mul_f32 v243, v243, v236
v_cvt_pk_bf16_f32 v254, v242, v243
v_lshlrev_b32 v242, 16, v255
v_and_b32 v243, 0xffff0000, v255
v_mul_f32 v242, v242, v236
v_mul_f32 v243, v243, v236
v_cvt_pk_bf16_f32 v255, v242, v243
ds_write_b64 v253, v[254:255] offset:8
s_waitcnt lgkmcnt(0)
ds_read_b64 v[254:255], v253 offset:4096
s_waitcnt lgkmcnt(0)
v_lshlrev_b32 v242, 16, v254
v_and_b32 v243, 0xffff0000, v254
v_mul_f32 v242, v242, v236
v_mul_f32 v243, v243, v236
v_cvt_pk_bf16_f32 v254, v242, v243
v_lshlrev_b32 v242, 16, v255
v_and_b32 v243, 0xffff0000, v255
v_mul_f32 v242, v242, v236
v_mul_f32 v243, v243, v236
v_cvt_pk_bf16_f32 v255, v242, v243
ds_write_b64 v253, v[254:255] offset:4096
s_waitcnt lgkmcnt(0)
ds_read_b64 v[254:255], v253 offset:4104
s_waitcnt lgkmcnt(0)
v_lshlrev_b32 v242, 16, v254
v_and_b32 v243, 0xffff0000, v254
v_mul_f32 v242, v242, v236
v_mul_f32 v243, v243, v236
v_cvt_pk_bf16_f32 v254, v242, v243
v_lshlrev_b32 v242, 16, v255
v_and_b32 v243, 0xffff0000, v255
v_mul_f32 v242, v242, v236
v_mul_f32 v243, v243, v236
v_cvt_pk_bf16_f32 v255, v242, v243
ds_write_b64 v253, v[254:255] offset:4104
s_waitcnt lgkmcnt(0)
v_log_f32 v243, v229
v_max3_f32 v233, v148, v149, v150
v_max3_f32 v233, v233, v151, v243
v_mov_b32 v243, v233
s_nop 1
v_permlane32_swap_b32 v233, v243
s_nop 1
v_max_f32 v233, v233, v243
v_mov_b32 v243, v233
s_nop 1
v_permlane16_swap_b32 v233, v243
s_nop 1
v_max_f32 v233, v233, v243
v_ceil_f32 v233, v233
v_max_f32 v233, 0, v233
v_sub_f32 v243, 0, v233
v_exp_f32 v237, v243
s_nop 1
v_mul_f32 v229, v229, v237
v_add_f32 v245, v245, v233
v_sub_f32 v196, v196, v233
v_sub_f32 v132, v132, v233
v_sub_f32 v148, v148, v233
v_sub_f32 v197, v197, v233
v_sub_f32 v133, v133, v233
v_sub_f32 v149, v149, v233
v_sub_f32 v198, v198, v233
v_sub_f32 v134, v134, v233
v_sub_f32 v150, v150, v233
v_sub_f32 v199, v199, v233
v_sub_f32 v135, v135, v233
v_sub_f32 v151, v151, v233
v_lshlrev_b32 v242, 16, v164
v_and_b32 v243, 0xffff0000, v164
v_mul_f32 v242, v242, v237
v_mul_f32 v243, v243, v237
v_cvt_pk_bf16_f32 v164, v242, v243
v_lshlrev_b32 v242, 16, v165
v_and_b32 v243, 0xffff0000, v165
v_mul_f32 v242, v242, v237
v_mul_f32 v243, v243, v237
v_cvt_pk_bf16_f32 v165, v242, v243
v_lshlrev_b32 v242, 16, v166
v_and_b32 v243, 0xffff0000, v166
v_mul_f32 v242, v242, v237
v_mul_f32 v243, v243, v237
v_cvt_pk_bf16_f32 v166, v242, v243
v_lshlrev_b32 v242, 16, v167
v_and_b32 v243, 0xffff0000, v167
v_mul_f32 v242, v242, v237
v_mul_f32 v243, v243, v237
v_cvt_pk_bf16_f32 v167, v242, v243
v_lshlrev_b32 v242, 16, v180
v_and_b32 v243, 0xffff0000, v180
v_mul_f32 v242, v242, v237
v_mul_f32 v243, v243, v237
v_cvt_pk_bf16_f32 v180, v242, v243
v_lshlrev_b32 v242, 16, v181
v_and_b32 v243, 0xffff0000, v181
v_mul_f32 v242, v242, v237
v_mul_f32 v243, v243, v237
v_cvt_pk_bf16_f32 v181, v242, v243
ds_read_b64 v[254:255], v253 offset:1024
s_waitcnt lgkmcnt(0)
v_lshlrev_b32 v242, 16, v254
v_and_b32 v243, 0xffff0000, v254
v_mul_f32 v242, v242, v237
v_mul_f32 v243, v243, v237
v_cvt_pk_bf16_f32 v254, v242, v243
v_lshlrev_b32 v242, 16, v255
v_and_b32 v243, 0xffff0000, v255
v_mul_f32 v242, v242, v237
v_mul_f32 v243, v243, v237
v_cvt_pk_bf16_f32 v255, v242, v243
ds_write_b64 v253, v[254:255] offset:1024
s_waitcnt lgkmcnt(0)
ds_read_b64 v[254:255], v253 offset:1032
s_waitcnt lgkmcnt(0)
v_lshlrev_b32 v242, 16, v254
v_and_b32 v243, 0xffff0000, v254
v_mul_f32 v242, v242, v237
v_mul_f32 v243, v243, v237
v_cvt_pk_bf16_f32 v254, v242, v243
v_lshlrev_b32 v242, 16, v255
v_and_b32 v243, 0xffff0000, v255
v_mul_f32 v242, v242, v237
v_mul_f32 v243, v243, v237
v_cvt_pk_bf16_f32 v255, v242, v243
ds_write_b64 v253, v[254:255] offset:1032
s_waitcnt lgkmcnt(0)
ds_read_b64 v[254:255], v253 offset:5120
s_waitcnt lgkmcnt(0)
v_lshlrev_b32 v242, 16, v254
v_and_b32 v243, 0xffff0000, v254
v_mul_f32 v242, v242, v237
v_mul_f32 v243, v243, v237
v_cvt_pk_bf16_f32 v254, v242, v243
v_lshlrev_b32 v242, 16, v255
v_and_b32 v243, 0xffff0000, v255
v_mul_f32 v242, v242, v237
v_mul_f32 v243, v243, v237
v_cvt_pk_bf16_f32 v255, v242, v243
ds_write_b64 v253, v[254:255] offset:5120
s_waitcnt lgkmcnt(0)
ds_read_b64 v[254:255], v253 offset:5128
s_waitcnt lgkmcnt(0)
v_lshlrev_b32 v242, 16, v254
v_and_b32 v243, 0xffff0000, v254
v_mul_f32 v242, v242, v237
v_mul_f32 v243, v243, v237
v_cvt_pk_bf16_f32 v254, v242, v243
v_lshlrev_b32 v242, 16, v255
v_and_b32 v243, 0xffff0000, v255
v_mul_f32 v242, v242, v237
v_mul_f32 v243, v243, v237
v_cvt_pk_bf16_f32 v255, v242, v243
ds_write_b64 v253, v[254:255] offset:5128
s_waitcnt lgkmcnt(0)
v_log_f32 v243, v230
v_max3_f32 v234, v152, v153, v154
v_max3_f32 v234, v234, v155, v243
v_mov_b32 v243, v234
s_nop 1
v_permlane32_swap_b32 v234, v243
s_nop 1
v_max_f32 v234, v234, v243
v_mov_b32 v243, v234
s_nop 1
v_permlane16_swap_b32 v234, v243
s_nop 1
v_max_f32 v234, v234, v243
v_ceil_f32 v234, v234
v_max_f32 v234, 0, v234
v_sub_f32 v243, 0, v234
v_exp_f32 v238, v243
s_nop 1
v_mul_f32 v230, v230, v238
v_add_f32 v246, v246, v234
v_sub_f32 v200, v200, v234
v_sub_f32 v136, v136, v234
v_sub_f32 v152, v152, v234
v_sub_f32 v201, v201, v234
v_sub_f32 v137, v137, v234
v_sub_f32 v153, v153, v234
v_sub_f32 v202, v202, v234
v_sub_f32 v138, v138, v234
v_sub_f32 v154, v154, v234
v_sub_f32 v203, v203, v234
v_sub_f32 v139, v139, v234
v_sub_f32 v155, v155, v234
v_lshlrev_b32 v242, 16, v168
v_and_b32 v243, 0xffff0000, v168
v_mul_f32 v242, v242, v238
v_mul_f32 v243, v243, v238
v_cvt_pk_bf16_f32 v168, v242, v243
v_lshlrev_b32 v242, 16, v169
v_and_b32 v243, 0xffff0000, v169
v_mul_f32 v242, v242, v238
v_mul_f32 v243, v243, v238
v_cvt_pk_bf16_f32 v169, v242, v243
v_lshlrev_b32 v242, 16, v170
v_and_b32 v243, 0xffff0000, v170
v_mul_f32 v242, v242, v238
v_mul_f32 v243, v243, v238
v_cvt_pk_bf16_f32 v170, v242, v243
v_lshlrev_b32 v242, 16, v171
v_and_b32 v243, 0xffff0000, v171
v_mul_f32 v242, v242, v238
v_mul_f32 v243, v243, v238
v_cvt_pk_bf16_f32 v171, v242, v243
v_lshlrev_b32 v242, 16, v184
v_and_b32 v243, 0xffff0000, v184
v_mul_f32 v242, v242, v238
v_mul_f32 v243, v243, v238
v_cvt_pk_bf16_f32 v184, v242, v243
v_lshlrev_b32 v242, 16, v185
v_and_b32 v243, 0xffff0000, v185
v_mul_f32 v242, v242, v238
v_mul_f32 v243, v243, v238
v_cvt_pk_bf16_f32 v185, v242, v243
ds_read_b64 v[254:255], v253 offset:2048
s_waitcnt lgkmcnt(0)
v_lshlrev_b32 v242, 16, v254
v_and_b32 v243, 0xffff0000, v254
v_mul_f32 v242, v242, v238
v_mul_f32 v243, v243, v238
v_cvt_pk_bf16_f32 v254, v242, v243
v_lshlrev_b32 v242, 16, v255
v_and_b32 v243, 0xffff0000, v255
v_mul_f32 v242, v242, v238
v_mul_f32 v243, v243, v238
v_cvt_pk_bf16_f32 v255, v242, v243
ds_write_b64 v253, v[254:255] offset:2048
s_waitcnt lgkmcnt(0)
ds_read_b64 v[254:255], v253 offset:2056
s_waitcnt lgkmcnt(0)
v_lshlrev_b32 v242, 16, v254
v_and_b32 v243, 0xffff0000, v254
v_mul_f32 v242, v242, v238
v_mul_f32 v243, v243, v238
v_cvt_pk_bf16_f32 v254, v242, v243
v_lshlrev_b32 v242, 16, v255
v_and_b32 v243, 0xffff0000, v255
v_mul_f32 v242, v242, v238
v_mul_f32 v243, v243, v238
v_cvt_pk_bf16_f32 v255, v242, v243
ds_write_b64 v253, v[254:255] offset:2056
s_waitcnt lgkmcnt(0)
ds_read_b64 v[254:255], v253 offset:6144
s_waitcnt lgkmcnt(0)
v_lshlrev_b32 v242, 16, v254
v_and_b32 v243, 0xffff0000, v254
v_mul_f32 v242, v242, v238
v_mul_f32 v243, v243, v238
v_cvt_pk_bf16_f32 v254, v242, v243
v_lshlrev_b32 v242, 16, v255
v_and_b32 v243, 0xffff0000, v255
v_mul_f32 v242, v242, v238
v_mul_f32 v243, v243, v238
v_cvt_pk_bf16_f32 v255, v242, v243
ds_write_b64 v253, v[254:255] offset:6144
s_waitcnt lgkmcnt(0)
ds_read_b64 v[254:255], v253 offset:6152
s_waitcnt lgkmcnt(0)
v_lshlrev_b32 v242, 16, v254
v_and_b32 v243, 0xffff0000, v254
v_mul_f32 v242, v242, v238
v_mul_f32 v243, v243, v238
v_cvt_pk_bf16_f32 v254, v242, v243
v_lshlrev_b32 v242, 16, v255
v_and_b32 v243, 0xffff0000, v255
v_mul_f32 v242, v242, v238
v_mul_f32 v243, v243, v238
v_cvt_pk_bf16_f32 v255, v242, v243
ds_write_b64 v253, v[254:255] offset:6152
s_waitcnt lgkmcnt(0)
v_log_f32 v243, v231
v_max3_f32 v235, v156, v157, v158
v_max3_f32 v235, v235, v159, v243
v_mov_b32 v243, v235
s_nop 1
v_permlane32_swap_b32 v235, v243
s_nop 1
v_max_f32 v235, v235, v243
v_mov_b32 v243, v235
s_nop 1
v_permlane16_swap_b32 v235, v243
s_nop 1
v_max_f32 v235, v235, v243
v_ceil_f32 v235, v235
v_max_f32 v235, 0, v235
v_sub_f32 v243, 0, v235
v_exp_f32 v239, v243
s_nop 1
v_mul_f32 v231, v231, v239
v_add_f32 v247, v247, v235
v_sub_f32 v204, v204, v235
v_sub_f32 v140, v140, v235
v_sub_f32 v156, v156, v235
v_sub_f32 v205, v205, v235
v_sub_f32 v141, v141, v235
v_sub_f32 v157, v157, v235
v_sub_f32 v206, v206, v235
v_sub_f32 v142, v142, v235
v_sub_f32 v158, v158, v235
v_sub_f32 v207, v207, v235
v_sub_f32 v143, v143, v235
v_sub_f32 v159, v159, v235
v_lshlrev_b32 v242, 16, v172
v_and_b32 v243, 0xffff0000, v172
v_mul_f32 v242, v242, v239
v_mul_f32 v243, v243, v239
v_cvt_pk_bf16_f32 v172, v242, v243
v_lshlrev_b32 v242, 16, v173
v_and_b32 v243, 0xffff0000, v173
v_mul_f32 v242, v242, v239
v_mul_f32 v243, v243, v239
v_cvt_pk_bf16_f32 v173, v242, v243
v_lshlrev_b32 v242, 16, v174
v_and_b32 v243, 0xffff0000, v174
v_mul_f32 v242, v242, v239
v_mul_f32 v243, v243, v239
v_cvt_pk_bf16_f32 v174, v242, v243
v_lshlrev_b32 v242, 16, v175
v_and_b32 v243, 0xffff0000, v175
v_mul_f32 v242, v242, v239
v_mul_f32 v243, v243, v239
v_cvt_pk_bf16_f32 v175, v242, v243
v_lshlrev_b32 v242, 16, v188
v_and_b32 v243, 0xffff0000, v188
v_mul_f32 v242, v242, v239
v_mul_f32 v243, v243, v239
v_cvt_pk_bf16_f32 v188, v242, v243
v_lshlrev_b32 v242, 16, v189
v_and_b32 v243, 0xffff0000, v189
v_mul_f32 v242, v242, v239
v_mul_f32 v243, v243, v239
v_cvt_pk_bf16_f32 v189, v242, v243
ds_read_b64 v[254:255], v253 offset:3072
s_waitcnt lgkmcnt(0)
v_lshlrev_b32 v242, 16, v254
v_and_b32 v243, 0xffff0000, v254
v_mul_f32 v242, v242, v239
v_mul_f32 v243, v243, v239
v_cvt_pk_bf16_f32 v254, v242, v243
v_lshlrev_b32 v242, 16, v255
v_and_b32 v243, 0xffff0000, v255
v_mul_f32 v242, v242, v239
v_mul_f32 v243, v243, v239
v_cvt_pk_bf16_f32 v255, v242, v243
ds_write_b64 v253, v[254:255] offset:3072
s_waitcnt lgkmcnt(0)
ds_read_b64 v[254:255], v253 offset:3080
s_waitcnt lgkmcnt(0)
v_lshlrev_b32 v242, 16, v254
v_and_b32 v243, 0xffff0000, v254
v_mul_f32 v242, v242, v239
v_mul_f32 v243, v243, v239
v_cvt_pk_bf16_f32 v254, v242, v243
v_lshlrev_b32 v242, 16, v255
v_and_b32 v243, 0xffff0000, v255
v_mul_f32 v242, v242, v239
v_mul_f32 v243, v243, v239
v_cvt_pk_bf16_f32 v255, v242, v243
ds_write_b64 v253, v[254:255] offset:3080
s_waitcnt lgkmcnt(0)
ds_read_b64 v[254:255], v253 offset:7168
s_waitcnt lgkmcnt(0)
v_lshlrev_b32 v242, 16, v254
v_and_b32 v243, 0xffff0000, v254
v_mul_f32 v242, v242, v239
v_mul_f32 v243, v243, v239
v_cvt_pk_bf16_f32 v254, v242, v243
v_lshlrev_b32 v242, 16, v255
v_and_b32 v243, 0xffff0000, v255
v_mul_f32 v242, v242, v239
v_mul_f32 v243, v243, v239
v_cvt_pk_bf16_f32 v255, v242, v243
ds_write_b64 v253, v[254:255] offset:7168
s_waitcnt lgkmcnt(0)
ds_read_b64 v[254:255], v253 offset:7176
s_waitcnt lgkmcnt(0)
v_lshlrev_b32 v242, 16, v254
v_and_b32 v243, 0xffff0000, v254
v_mul_f32 v242, v242, v239
v_mul_f32 v243, v243, v239
v_cvt_pk_bf16_f32 v254, v242, v243
v_lshlrev_b32 v242, 16, v255
v_and_b32 v243, 0xffff0000, v255
v_mul_f32 v242, v242, v239
v_mul_f32 v243, v243, v239
v_cvt_pk_bf16_f32 v255, v242, v243
ds_write_b64 v253, v[254:255] offset:7176
s_waitcnt lgkmcnt(0)
v_exp_f32 v232, v144
v_exp_f32 v233, v145
v_exp_f32 v234, v146
v_exp_f32 v235, v147
s_nop 1
v_add_f32 v224, v228, v232
v_add_f32 v224, v224, v233
v_add_f32 v224, v224, v234
v_add_f32 v224, v224, v235
v_cvt_pk_bf16_f32 v178, v232, v233
v_cvt_pk_bf16_f32 v179, v234, v235
v_exp_f32 v232, v148
v_exp_f32 v233, v149
v_exp_f32 v234, v150
v_exp_f32 v235, v151
s_nop 1
v_add_f32 v225, v229, v232
v_add_f32 v225, v225, v233
v_add_f32 v225, v225, v234
v_add_f32 v225, v225, v235
v_cvt_pk_bf16_f32 v182, v232, v233
v_cvt_pk_bf16_f32 v183, v234, v235
v_exp_f32 v232, v152
v_exp_f32 v233, v153
v_exp_f32 v234, v154
v_exp_f32 v235, v155
s_nop 1
v_add_f32 v226, v230, v232
v_add_f32 v226, v226, v233
v_add_f32 v226, v226, v234
v_add_f32 v226, v226, v235
v_cvt_pk_bf16_f32 v186, v232, v233
v_cvt_pk_bf16_f32 v187, v234, v235
v_exp_f32 v232, v156
v_exp_f32 v233, v157
v_exp_f32 v234, v158
v_exp_f32 v235, v159
s_nop 1
v_add_f32 v227, v231, v232
v_add_f32 v227, v227, v233
v_add_f32 v227, v227, v234
v_add_f32 v227, v227, v235
v_cvt_pk_bf16_f32 v190, v232, v233
v_cvt_pk_bf16_f32 v191, v234, v235
s_branch L2_rare_common
L2_rare_site10:
s_mov_b32 s36, 10
s_branch L2_rare_t0_6_0
L2_rare_t0_6_0:
s_nop 15
s_nop 15
s_waitcnt lgkmcnt(0)
v_log_f32 v243, v224
v_max3_f32 v232, v128, v129, v130
v_max3_f32 v232, v232, v131, v243
v_mov_b32 v243, v232
s_nop 1
v_permlane32_swap_b32 v232, v243
s_nop 1
v_max_f32 v232, v232, v243
v_mov_b32 v243, v232
s_nop 1
v_permlane16_swap_b32 v232, v243
s_nop 1
v_max_f32 v232, v232, v243
v_ceil_f32 v232, v232
v_max_f32 v232, 0, v232
v_sub_f32 v243, 0, v232
v_exp_f32 v236, v243
s_nop 1
v_mul_f32 v224, v224, v236
v_add_f32 v244, v244, v232
v_sub_f32 v192, v192, v232
v_sub_f32 v128, v128, v232
v_sub_f32 v144, v144, v232
v_sub_f32 v193, v193, v232
v_sub_f32 v129, v129, v232
v_sub_f32 v145, v145, v232
v_sub_f32 v194, v194, v232
v_sub_f32 v130, v130, v232
v_sub_f32 v146, v146, v232
v_sub_f32 v195, v195, v232
v_sub_f32 v131, v131, v232
v_sub_f32 v147, v147, v232
v_lshlrev_b32 v242, 16, v4
v_and_b32 v243, 0xffff0000, v4
v_mul_f32 v242, v242, v236
v_mul_f32 v243, v243, v236
v_cvt_pk_bf16_f32 v4, v242, v243
v_lshlrev_b32 v242, 16, v5
v_and_b32 v243, 0xffff0000, v5
v_mul_f32 v242, v242, v236
v_mul_f32 v243, v243, v236
v_cvt_pk_bf16_f32 v5, v242, v243
v_lshlrev_b32 v242, 16, v6
v_and_b32 v243, 0xffff0000, v6
v_mul_f32 v242, v242, v236
v_mul_f32 v243, v243, v236
v_cvt_pk_bf16_f32 v6, v242, v243
v_lshlrev_b32 v242, 16, v7
v_and_b32 v243, 0xffff0000, v7
v_mul_f32 v242, v242, v236
v_mul_f32 v243, v243, v236
v_cvt_pk_bf16_f32 v7, v242, v243
v_lshlrev_b32 v242, 16, v8
v_and_b32 v243, 0xffff0000, v8
v_mul_f32 v242, v242, v236
v_mul_f32 v243, v243, v236
v_cvt_pk_bf16_f32 v8, v242, v243
v_lshlrev_b32 v242, 16, v9
v_and_b32 v243, 0xffff0000, v9
v_mul_f32 v242, v242, v236
v_mul_f32 v243, v243, v236
v_cvt_pk_bf16_f32 v9, v242, v243
v_lshlrev_b32 v242, 16, v10
v_and_b32 v243, 0xffff0000, v10
v_mul_f32 v242, v242, v236
v_mul_f32 v243, v243, v236
v_cvt_pk_bf16_f32 v10, v242, v243
v_lshlrev_b32 v242, 16, v11
v_and_b32 v243, 0xffff0000, v11
v_mul_f32 v242, v242, v236
v_mul_f32 v243, v243, v236
v_cvt_pk_bf16_f32 v11, v242, v243
v_lshlrev_b32 v242, 16, v160
v_and_b32 v243, 0xffff0000, v160
v_mul_f32 v242, v242, v236
v_mul_f32 v243, v243, v236
v_cvt_pk_bf16_f32 v160, v242, v243
v_lshlrev_b32 v242, 16, v161
v_and_b32 v243, 0xffff0000, v161
v_mul_f32 v242, v242, v236
v_mul_f32 v243, v243, v236
v_cvt_pk_bf16_f32 v161, v242, v243
v_lshlrev_b32 v242, 16, v162
v_and_b32 v243, 0xffff0000, v162
v_mul_f32 v242, v242, v236
v_mul_f32 v243, v243, v236
v_cvt_pk_bf16_f32 v162, v242, v243
v_lshlrev_b32 v242, 16, v163
v_and_b32 v243, 0xffff0000, v163
v_mul_f32 v242, v242, v236
v_mul_f32 v243, v243, v236
v_cvt_pk_bf16_f32 v163, v242, v243
v_lshlrev_b32 v242, 16, v176
v_and_b32 v243, 0xffff0000, v176
v_mul_f32 v242, v242, v236
v_mul_f32 v243, v243, v236
v_cvt_pk_bf16_f32 v176, v242, v243
v_lshlrev_b32 v242, 16, v177
v_and_b32 v243, 0xffff0000, v177
v_mul_f32 v242, v242, v236
v_mul_f32 v243, v243, v236
v_cvt_pk_bf16_f32 v177, v242, v243
v_lshlrev_b32 v242, 16, v178
v_and_b32 v243, 0xffff0000, v178
v_mul_f32 v242, v242, v236
v_mul_f32 v243, v243, v236
v_cvt_pk_bf16_f32 v178, v242, v243
v_lshlrev_b32 v242, 16, v179
v_and_b32 v243, 0xffff0000, v179
v_mul_f32 v242, v242, v236
v_mul_f32 v243, v243, v236
v_cvt_pk_bf16_f32 v179, v242, v243
v_log_f32 v243, v225
v_max3_f32 v233, v132, v133, v134
v_max3_f32 v233, v233, v135, v243
v_mov_b32 v243, v233
s_nop 1
v_permlane32_swap_b32 v233, v243
s_nop 1
v_max_f32 v233, v233, v243
v_mov_b32 v243, v233
s_nop 1
v_permlane16_swap_b32 v233, v243
s_nop 1
v_max_f32 v233, v233, v243
v_ceil_f32 v233, v233
v_max_f32 v233, 0, v233
v_sub_f32 v243, 0, v233
v_exp_f32 v237, v243
s_nop 1
v_mul_f32 v225, v225, v237
v_add_f32 v245, v245, v233
v_sub_f32 v196, v196, v233
v_sub_f32 v132, v132, v233
v_sub_f32 v148, v148, v233
v_sub_f32 v197, v197, v233
v_sub_f32 v133, v133, v233
v_sub_f32 v149, v149, v233
v_sub_f32 v198, v198, v233
v_sub_f32 v134, v134, v233
v_sub_f32 v150, v150, v233
v_sub_f32 v199, v199, v233
v_sub_f32 v135, v135, v233
v_sub_f32 v151, v151, v233
v_lshlrev_b32 v242, 16, v36
v_and_b32 v243, 0xffff0000, v36
v_mul_f32 v242, v242, v237
v_mul_f32 v243, v243, v237
v_cvt_pk_bf16_f32 v36, v242, v243
v_lshlrev_b32 v242, 16, v37
v_and_b32 v243, 0xffff0000, v37
v_mul_f32 v242, v242, v237
v_mul_f32 v243, v243, v237
v_cvt_pk_bf16_f32 v37, v242, v243
v_lshlrev_b32 v242, 16, v38
v_and_b32 v243, 0xffff0000, v38
v_mul_f32 v242, v242, v237
v_mul_f32 v243, v243, v237
v_cvt_pk_bf16_f32 v38, v242, v243
v_lshlrev_b32 v242, 16, v39
v_and_b32 v243, 0xffff0000, v39
v_mul_f32 v242, v242, v237
v_mul_f32 v243, v243, v237
v_cvt_pk_bf16_f32 v39, v242, v243
v_lshlrev_b32 v242, 16, v40
v_and_b32 v243, 0xffff0000, v40
v_mul_f32 v242, v242, v237
v_mul_f32 v243, v243, v237
v_cvt_pk_bf16_f32 v40, v242, v243
v_lshlrev_b32 v242, 16, v41
v_and_b32 v243, 0xffff0000, v41
v_mul_f32 v242, v242, v237
v_mul_f32 v243, v243, v237
v_cvt_pk_bf16_f32 v41, v242, v243
v_lshlrev_b32 v242, 16, v42
v_and_b32 v243, 0xffff0000, v42
v_mul_f32 v242, v242, v237
v_mul_f32 v243, v243, v237
v_cvt_pk_bf16_f32 v42, v242, v243
v_lshlrev_b32 v242, 16, v43
v_and_b32 v243, 0xffff0000, v43
v_mul_f32 v242, v242, v237
v_mul_f32 v243, v243, v237
v_cvt_pk_bf16_f32 v43, v242, v243
v_lshlrev_b32 v242, 16, v164
v_and_b32 v243, 0xffff0000, v164
v_mul_f32 v242, v242, v237
v_mul_f32 v243, v243, v237
v_cvt_pk_bf16_f32 v164, v242, v243
v_lshlrev_b32 v242, 16, v165
v_and_b32 v243, 0xffff0000, v165
v_mul_f32 v242, v242, v237
v_mul_f32 v243, v243, v237
v_cvt_pk_bf16_f32 v165, v242, v243
v_lshlrev_b32 v242, 16, v166
v_and_b32 v243, 0xffff0000, v166
v_mul_f32 v242, v242, v237
v_mul_f32 v243, v243, v237
v_cvt_pk_bf16_f32 v166, v242, v243
v_lshlrev_b32 v242, 16, v167
v_and_b32 v243, 0xffff0000, v167
v_mul_f32 v242, v242, v237
v_mul_f32 v243, v243, v237
v_cvt_pk_bf16_f32 v167, v242, v243
v_lshlrev_b32 v242, 16, v180
v_and_b32 v243, 0xffff0000, v180
v_mul_f32 v242, v242, v237
v_mul_f32 v243, v243, v237
v_cvt_pk_bf16_f32 v180, v242, v243
v_lshlrev_b32 v242, 16, v181
v_and_b32 v243, 0xffff0000, v181
v_mul_f32 v242, v242, v237
v_mul_f32 v243, v243, v237
v_cvt_pk_bf16_f32 v181, v242, v243
v_lshlrev_b32 v242, 16, v182
v_and_b32 v243, 0xffff0000, v182
v_mul_f32 v242, v242, v237
v_mul_f32 v243, v243, v237
v_cvt_pk_bf16_f32 v182, v242, v243
v_lshlrev_b32 v242, 16, v183
v_and_b32 v243, 0xffff0000, v183
v_mul_f32 v242, v242, v237
v_mul_f32 v243, v243, v237
v_cvt_pk_bf16_f32 v183, v242, v243
v_log_f32 v243, v226
v_max3_f32 v234, v136, v137, v138
v_max3_f32 v234, v234, v139, v243
v_mov_b32 v243, v234
s_nop 1
v_permlane32_swap_b32 v234, v243
s_nop 1
v_max_f32 v234, v234, v243
v_mov_b32 v243, v234
s_nop 1
v_permlane16_swap_b32 v234, v243
s_nop 1
v_max_f32 v234, v234, v243
v_ceil_f32 v234, v234
v_max_f32 v234, 0, v234
v_sub_f32 v243, 0, v234
v_exp_f32 v238, v243
s_nop 1
v_mul_f32 v226, v226, v238
v_add_f32 v246, v246, v234
v_sub_f32 v200, v200, v234
v_sub_f32 v136, v136, v234
v_sub_f32 v152, v152, v234
v_sub_f32 v201, v201, v234
v_sub_f32 v137, v137, v234
v_sub_f32 v153, v153, v234
v_sub_f32 v202, v202, v234
v_sub_f32 v138, v138, v234
v_sub_f32 v154, v154, v234
v_sub_f32 v203, v203, v234
v_sub_f32 v139, v139, v234
v_sub_f32 v155, v155, v234
v_lshlrev_b32 v242, 16, v68
v_and_b32 v243, 0xffff0000, v68
v_mul_f32 v242, v242, v238
v_mul_f32 v243, v243, v238
v_cvt_pk_bf16_f32 v68, v242, v243
v_lshlrev_b32 v242, 16, v69
v_and_b32 v243, 0xffff0000, v69
v_mul_f32 v242, v242, v238
v_mul_f32 v243, v243, v238
v_cvt_pk_bf16_f32 v69, v242, v243
v_lshlrev_b32 v242, 16, v70
v_and_b32 v243, 0xffff0000, v70
v_mul_f32 v242, v242, v238
v_mul_f32 v243, v243, v238
v_cvt_pk_bf16_f32 v70, v242, v243
v_lshlrev_b32 v242, 16, v71
v_and_b32 v243, 0xffff0000, v71
v_mul_f32 v242, v242, v238
v_mul_f32 v243, v243, v238
v_cvt_pk_bf16_f32 v71, v242, v243
v_lshlrev_b32 v242, 16, v72
v_and_b32 v243, 0xffff0000, v72
v_mul_f32 v242, v242, v238
v_mul_f32 v243, v243, v238
v_cvt_pk_bf16_f32 v72, v242, v243
v_lshlrev_b32 v242, 16, v73
v_and_b32 v243, 0xffff0000, v73
v_mul_f32 v242, v242, v238
v_mul_f32 v243, v243, v238
v_cvt_pk_bf16_f32 v73, v242, v243
v_lshlrev_b32 v242, 16, v74
v_and_b32 v243, 0xffff0000, v74
v_mul_f32 v242, v242, v238
v_mul_f32 v243, v243, v238
v_cvt_pk_bf16_f32 v74, v242, v243
v_lshlrev_b32 v242, 16, v75
v_and_b32 v243, 0xffff0000, v75
v_mul_f32 v242, v242, v238
v_mul_f32 v243, v243, v238
v_cvt_pk_bf16_f32 v75, v242, v243
v_lshlrev_b32 v242, 16, v168
v_and_b32 v243, 0xffff0000, v168
v_mul_f32 v242, v242, v238
v_mul_f32 v243, v243, v238
v_cvt_pk_bf16_f32 v168, v242, v243
v_lshlrev_b32 v242, 16, v169
v_and_b32 v243, 0xffff0000, v169
v_mul_f32 v242, v242, v238
v_mul_f32 v243, v243, v238
v_cvt_pk_bf16_f32 v169, v242, v243
v_lshlrev_b32 v242, 16, v170
v_and_b32 v243, 0xffff0000, v170
v_mul_f32 v242, v242, v238
v_mul_f32 v243, v243, v238
v_cvt_pk_bf16_f32 v170, v242, v243
v_lshlrev_b32 v242, 16, v171
v_and_b32 v243, 0xffff0000, v171
v_mul_f32 v242, v242, v238
v_mul_f32 v243, v243, v238
v_cvt_pk_bf16_f32 v171, v242, v243
v_lshlrev_b32 v242, 16, v184
v_and_b32 v243, 0xffff0000, v184
v_mul_f32 v242, v242, v238
v_mul_f32 v243, v243, v238
v_cvt_pk_bf16_f32 v184, v242, v243
v_lshlrev_b32 v242, 16, v185
v_and_b32 v243, 0xffff0000, v185
v_mul_f32 v242, v242, v238
v_mul_f32 v243, v243, v238
v_cvt_pk_bf16_f32 v185, v242, v243
v_lshlrev_b32 v242, 16, v186
v_and_b32 v243, 0xffff0000, v186
v_mul_f32 v242, v242, v238
v_mul_f32 v243, v243, v238
v_cvt_pk_bf16_f32 v186, v242, v243
v_lshlrev_b32 v242, 16, v187
v_and_b32 v243, 0xffff0000, v187
v_mul_f32 v242, v242, v238
v_mul_f32 v243, v243, v238
v_cvt_pk_bf16_f32 v187, v242, v243
v_log_f32 v243, v227
v_max3_f32 v235, v140, v141, v142
v_max3_f32 v235, v235, v143, v243
v_mov_b32 v243, v235
s_nop 1
v_permlane32_swap_b32 v235, v243
s_nop 1
v_max_f32 v235, v235, v243
v_mov_b32 v243, v235
s_nop 1
v_permlane16_swap_b32 v235, v243
s_nop 1
v_max_f32 v235, v235, v243
v_ceil_f32 v235, v235
v_max_f32 v235, 0, v235
v_sub_f32 v243, 0, v235
v_exp_f32 v239, v243
s_nop 1
v_mul_f32 v227, v227, v239
v_add_f32 v247, v247, v235
v_sub_f32 v204, v204, v235
v_sub_f32 v140, v140, v235
v_sub_f32 v156, v156, v235
v_sub_f32 v205, v205, v235
v_sub_f32 v141, v141, v235
v_sub_f32 v157, v157, v235
v_sub_f32 v206, v206, v235
v_sub_f32 v142, v142, v235
v_sub_f32 v158, v158, v235
v_sub_f32 v207, v207, v235
v_sub_f32 v143, v143, v235
v_sub_f32 v159, v159, v235
v_lshlrev_b32 v242, 16, v100
v_and_b32 v243, 0xffff0000, v100
v_mul_f32 v242, v242, v239
v_mul_f32 v243, v243, v239
v_cvt_pk_bf16_f32 v100, v242, v243
v_lshlrev_b32 v242, 16, v101
v_and_b32 v243, 0xffff0000, v101
v_mul_f32 v242, v242, v239
v_mul_f32 v243, v243, v239
v_cvt_pk_bf16_f32 v101, v242, v243
v_lshlrev_b32 v242, 16, v102
v_and_b32 v243, 0xffff0000, v102
v_mul_f32 v242, v242, v239
v_mul_f32 v243, v243, v239
v_cvt_pk_bf16_f32 v102, v242, v243
v_lshlrev_b32 v242, 16, v103
v_and_b32 v243, 0xffff0000, v103
v_mul_f32 v242, v242, v239
v_mul_f32 v243, v243, v239
v_cvt_pk_bf16_f32 v103, v242, v243
v_lshlrev_b32 v242, 16, v104
v_and_b32 v243, 0xffff0000, v104
v_mul_f32 v242, v242, v239
v_mul_f32 v243, v243, v239
v_cvt_pk_bf16_f32 v104, v242, v243
v_lshlrev_b32 v242, 16, v105
v_and_b32 v243, 0xffff0000, v105
v_mul_f32 v242, v242, v239
v_mul_f32 v243, v243, v239
v_cvt_pk_bf16_f32 v105, v242, v243
v_lshlrev_b32 v242, 16, v106
v_and_b32 v243, 0xffff0000, v106
v_mul_f32 v242, v242, v239
v_mul_f32 v243, v243, v239
v_cvt_pk_bf16_f32 v106, v242, v243
v_lshlrev_b32 v242, 16, v107
v_and_b32 v243, 0xffff0000, v107
v_mul_f32 v242, v242, v239
v_mul_f32 v243, v243, v239
v_cvt_pk_bf16_f32 v107, v242, v243
v_lshlrev_b32 v242, 16, v172
v_and_b32 v243, 0xffff0000, v172
v_mul_f32 v242, v242, v239
v_mul_f32 v243, v243, v239
v_cvt_pk_bf16_f32 v172, v242, v243
v_lshlrev_b32 v242, 16, v173
v_and_b32 v243, 0xffff0000, v173
v_mul_f32 v242, v242, v239
v_mul_f32 v243, v243, v239
v_cvt_pk_bf16_f32 v173, v242, v243
v_lshlrev_b32 v242, 16, v174
v_and_b32 v243, 0xffff0000, v174
v_mul_f32 v242, v242, v239
v_mul_f32 v243, v243, v239
v_cvt_pk_bf16_f32 v174, v242, v243
v_lshlrev_b32 v242, 16, v175
v_and_b32 v243, 0xffff0000, v175
v_mul_f32 v242, v242, v239
v_mul_f32 v243, v243, v239
v_cvt_pk_bf16_f32 v175, v242, v243
v_lshlrev_b32 v242, 16, v188
v_and_b32 v243, 0xffff0000, v188
v_mul_f32 v242, v242, v239
v_mul_f32 v243, v243, v239
v_cvt_pk_bf16_f32 v188, v242, v243
v_lshlrev_b32 v242, 16, v189
v_and_b32 v243, 0xffff0000, v189
v_mul_f32 v242, v242, v239
v_mul_f32 v243, v243, v239
v_cvt_pk_bf16_f32 v189, v242, v243
v_lshlrev_b32 v242, 16, v190
v_and_b32 v243, 0xffff0000, v190
v_mul_f32 v242, v242, v239
v_mul_f32 v243, v243, v239
v_cvt_pk_bf16_f32 v190, v242, v243
v_lshlrev_b32 v242, 16, v191
v_and_b32 v243, 0xffff0000, v191
v_mul_f32 v242, v242, v239
v_mul_f32 v243, v243, v239
v_cvt_pk_bf16_f32 v191, v242, v243
v_exp_f32 v232, v128
v_exp_f32 v233, v129
v_exp_f32 v234, v130
v_exp_f32 v235, v131
s_nop 1
v_add_f32 v228, v224, v232
v_add_f32 v228, v228, v233
v_add_f32 v228, v228, v234
v_add_f32 v228, v228, v235
v_cvt_pk_bf16_f32 v0, v232, v233
v_cvt_pk_bf16_f32 v1, v234, v235
v_exp_f32 v232, v132
v_exp_f32 v233, v133
v_exp_f32 v234, v134
v_exp_f32 v235, v135
s_nop 1
v_add_f32 v229, v225, v232
v_add_f32 v229, v229, v233
v_add_f32 v229, v229, v234
v_add_f32 v229, v229, v235
v_cvt_pk_bf16_f32 v32, v232, v233
v_cvt_pk_bf16_f32 v33, v234, v235
v_exp_f32 v232, v136
v_exp_f32 v233, v137
v_exp_f32 v234, v138
v_exp_f32 v235, v139
s_nop 1
v_add_f32 v230, v226, v232
v_add_f32 v230, v230, v233
v_add_f32 v230, v230, v234
v_add_f32 v230, v230, v235
v_cvt_pk_bf16_f32 v64, v232, v233
v_cvt_pk_bf16_f32 v65, v234, v235
v_exp_f32 v232, v140
v_exp_f32 v233, v141
v_exp_f32 v234, v142
v_exp_f32 v235, v143
s_nop 1
v_add_f32 v231, v227, v232
v_add_f32 v231, v231, v233
v_add_f32 v231, v231, v234
v_add_f32 v231, v231, v235
v_cvt_pk_bf16_f32 v96, v232, v233
v_cvt_pk_bf16_f32 v97, v234, v235
s_branch L2_rare_common
L2_rare_site11:
s_mov_b32 s36, 11
s_branch L2_rare_t0_7_1
L2_rare_t0_7_1:
s_nop 15
s_nop 15
s_waitcnt lgkmcnt(0)
v_log_f32 v243, v228
v_max3_f32 v232, v144, v145, v146
v_max3_f32 v232, v232, v147, v243
v_mov_b32 v243, v232
s_nop 1
v_permlane32_swap_b32 v232, v243
s_nop 1
v_max_f32 v232, v232, v243
v_mov_b32 v243, v232
s_nop 1
v_permlane16_swap_b32 v232, v243
s_nop 1
v_max_f32 v232, v232, v243
v_ceil_f32 v232, v232
v_max_f32 v232, 0, v232
v_sub_f32 v243, 0, v232
v_exp_f32 v236, v243
s_nop 1
v_mul_f32 v228, v228, v236
v_add_f32 v244, v244, v232
v_sub_f32 v192, v192, v232
v_sub_f32 v128, v128, v232
v_sub_f32 v144, v144, v232
v_sub_f32 v193, v193, v232
v_sub_f32 v129, v129, v232
v_sub_f32 v145, v145, v232
v_sub_f32 v194, v194, v232
v_sub_f32 v130, v130, v232
v_sub_f32 v146, v146, v232
v_sub_f32 v195, v195, v232
v_sub_f32 v131, v131, v232
v_sub_f32 v147, v147, v232
v_lshlrev_b32 v242, 16, v4
v_and_b32 v243, 0xffff0000, v4
v_mul_f32 v242, v242, v236
v_mul_f32 v243, v243, v236
v_cvt_pk_bf16_f32 v4, v242, v243
v_lshlrev_b32 v242, 16, v5
v_and_b32 v243, 0xffff0000, v5
v_mul_f32 v242, v242, v236
v_mul_f32 v243, v243, v236
v_cvt_pk_bf16_f32 v5, v242, v243
v_lshlrev_b32 v242, 16, v6
v_and_b32 v243, 0xffff0000, v6
v_mul_f32 v242, v242, v236
v_mul_f32 v243, v243, v236
v_cvt_pk_bf16_f32 v6, v242, v243
v_lshlrev_b32 v242, 16, v7
v_and_b32 v243, 0xffff0000, v7
v_mul_f32 v242, v242, v236
v_mul_f32 v243, v243, v236
v_cvt_pk_bf16_f32 v7, v242, v243
v_lshlrev_b32 v242, 16, v8
v_and_b32 v243, 0xffff0000, v8
v_mul_f32 v242, v242, v236
v_mul_f32 v243, v243, v236
v_cvt_pk_bf16_f32 v8, v242, v243
v_lshlrev_b32 v242, 16, v9
v_and_b32 v243, 0xffff0000, v9
v_mul_f32 v242, v242, v236
v_mul_f32 v243, v243, v236
v_cvt_pk_bf16_f32 v9, v242, v243
v_lshlrev_b32 v242, 16, v10
v_and_b32 v243, 0xffff0000, v10
v_mul_f32 v242, v242, v236
v_mul_f32 v243, v243, v236
v_cvt_pk_bf16_f32 v10, v242, v243
v_lshlrev_b32 v242, 16, v11
v_and_b32 v243, 0xffff0000, v11
v_mul_f32 v242, v242, v236
v_mul_f32 v243, v243, v236
v_cvt_pk_bf16_f32 v11, v242, v243
v_lshlrev_b32 v242, 16, v160
v_and_b32 v243, 0xffff0000, v160
v_mul_f32 v242, v242, v236
v_mul_f32 v243, v243, v236
v_cvt_pk_bf16_f32 v160, v242, v243
v_lshlrev_b32 v242, 16, v161
v_and_b32 v243, 0xffff0000, v161
v_mul_f32 v242, v242, v236
v_mul_f32 v243, v243, v236
v_cvt_pk_bf16_f32 v161, v242, v243
v_lshlrev_b32 v242, 16, v162
v_and_b32 v243, 0xffff0000, v162
v_mul_f32 v242, v242, v236
v_mul_f32 v243, v243, v236
v_cvt_pk_bf16_f32 v162, v242, v243
v_lshlrev_b32 v242, 16, v163
v_and_b32 v243, 0xffff0000, v163
v_mul_f32 v242, v242, v236
v_mul_f32 v243, v243, v236
v_cvt_pk_bf16_f32 v163, v242, v243
v_lshlrev_b32 v242, 16, v176
v_and_b32 v243, 0xffff0000, v176
v_mul_f32 v242, v242, v236
v_mul_f32 v243, v243, v236
v_cvt_pk_bf16_f32 v176, v242, v243
v_lshlrev_b32 v242, 16, v177
v_and_b32 v243, 0xffff0000, v177
v_mul_f32 v242, v242, v236
v_mul_f32 v243, v243, v236
v_cvt_pk_bf16_f32 v177, v242, v243
v_lshlrev_b32 v242, 16, v178
v_and_b32 v243, 0xffff0000, v178
v_mul_f32 v242, v242, v236
v_mul_f32 v243, v243, v236
v_cvt_pk_bf16_f32 v178, v242, v243
v_lshlrev_b32 v242, 16, v179
v_and_b32 v243, 0xffff0000, v179
v_mul_f32 v242, v242, v236
v_mul_f32 v243, v243, v236
v_cvt_pk_bf16_f32 v179, v242, v243
v_lshlrev_b32 v242, 16, v0
v_and_b32 v243, 0xffff0000, v0
v_mul_f32 v242, v242, v236
v_mul_f32 v243, v243, v236
v_cvt_pk_bf16_f32 v0, v242, v243
v_lshlrev_b32 v242, 16, v1
v_and_b32 v243, 0xffff0000, v1
v_mul_f32 v242, v242, v236
v_mul_f32 v243, v243, v236
v_cvt_pk_bf16_f32 v1, v242, v243
v_log_f32 v243, v229
v_max3_f32 v233, v148, v149, v150
v_max3_f32 v233, v233, v151, v243
v_mov_b32 v243, v233
s_nop 1
v_permlane32_swap_b32 v233, v243
s_nop 1
v_max_f32 v233, v233, v243
v_mov_b32 v243, v233
s_nop 1
v_permlane16_swap_b32 v233, v243
s_nop 1
v_max_f32 v233, v233, v243
v_ceil_f32 v233, v233
v_max_f32 v233, 0, v233
v_sub_f32 v243, 0, v233
v_exp_f32 v237, v243
s_nop 1
v_mul_f32 v229, v229, v237
v_add_f32 v245, v245, v233
v_sub_f32 v196, v196, v233
v_sub_f32 v132, v132, v233
v_sub_f32 v148, v148, v233
v_sub_f32 v197, v197, v233
v_sub_f32 v133, v133, v233
v_sub_f32 v149, v149, v233
v_sub_f32 v198, v198, v233
v_sub_f32 v134, v134, v233
v_sub_f32 v150, v150, v233
v_sub_f32 v199, v199, v233
v_sub_f32 v135, v135, v233
v_sub_f32 v151, v151, v233
v_lshlrev_b32 v242, 16, v36
v_and_b32 v243, 0xffff0000, v36
v_mul_f32 v242, v242, v237
v_mul_f32 v243, v243, v237
v_cvt_pk_bf16_f32 v36, v242, v243
v_lshlrev_b32 v242, 16, v37
v_and_b32 v243, 0xffff0000, v37
v_mul_f32 v242, v242, v237
v_mul_f32 v243, v243, v237
v_cvt_pk_bf16_f32 v37, v242, v243
v_lshlrev_b32 v242, 16, v38
v_and_b32 v243, 0xffff0000, v38
v_mul_f32 v242, v242, v237
v_mul_f32 v243, v243, v237
v_cvt_pk_bf16_f32 v38, v242, v243
v_lshlrev_b32 v242, 16, v39
v_and_b32 v243, 0xffff0000, v39
v_mul_f32 v242, v242, v237
v_mul_f32 v243, v243, v237
v_cvt_pk_bf16_f32 v39, v242, v243
v_lshlrev_b32 v242, 16, v40
v_and_b32 v243, 0xffff0000, v40
v_mul_f32 v242, v242, v237
v_mul_f32 v243, v243, v237
v_cvt_pk_bf16_f32 v40, v242, v243
v_lshlrev_b32 v242, 16, v41
v_and_b32 v243, 0xffff0000, v41
v_mul_f32 v242, v242, v237
v_mul_f32 v243, v243, v237
v_cvt_pk_bf16_f32 v41, v242, v243
v_lshlrev_b32 v242, 16, v42
v_and_b32 v243, 0xffff0000, v42
v_mul_f32 v242, v242, v237
v_mul_f32 v243, v243, v237
v_cvt_pk_bf16_f32 v42, v242, v243
v_lshlrev_b32 v242, 16, v43
v_and_b32 v243, 0xffff0000, v43
v_mul_f32 v242, v242, v237
v_mul_f32 v243, v243, v237
v_cvt_pk_bf16_f32 v43, v242, v243
v_lshlrev_b32 v242, 16, v164
v_and_b32 v243, 0xffff0000, v164
v_mul_f32 v242, v242, v237
v_mul_f32 v243, v243, v237
v_cvt_pk_bf16_f32 v164, v242, v243
v_lshlrev_b32 v242, 16, v165
v_and_b32 v243, 0xffff0000, v165
v_mul_f32 v242, v242, v237
v_mul_f32 v243, v243, v237
v_cvt_pk_bf16_f32 v165, v242, v243
v_lshlrev_b32 v242, 16, v166
v_and_b32 v243, 0xffff0000, v166
v_mul_f32 v242, v242, v237
v_mul_f32 v243, v243, v237
v_cvt_pk_bf16_f32 v166, v242, v243
v_lshlrev_b32 v242, 16, v167
v_and_b32 v243, 0xffff0000, v167
v_mul_f32 v242, v242, v237
v_mul_f32 v243, v243, v237
v_cvt_pk_bf16_f32 v167, v242, v243
v_lshlrev_b32 v242, 16, v180
v_and_b32 v243, 0xffff0000, v180
v_mul_f32 v242, v242, v237
v_mul_f32 v243, v243, v237
v_cvt_pk_bf16_f32 v180, v242, v243
v_lshlrev_b32 v242, 16, v181
v_and_b32 v243, 0xffff0000, v181
v_mul_f32 v242, v242, v237
v_mul_f32 v243, v243, v237
v_cvt_pk_bf16_f32 v181, v242, v243
v_lshlrev_b32 v242, 16, v182
v_and_b32 v243, 0xffff0000, v182
v_mul_f32 v242, v242, v237
v_mul_f32 v243, v243, v237
v_cvt_pk_bf16_f32 v182, v242, v243
v_lshlrev_b32 v242, 16, v183
v_and_b32 v243, 0xffff0000, v183
v_mul_f32 v242, v242, v237
v_mul_f32 v243, v243, v237
v_cvt_pk_bf16_f32 v183, v242, v243
v_lshlrev_b32 v242, 16, v32
v_and_b32 v243, 0xffff0000, v32
v_mul_f32 v242, v242, v237
v_mul_f32 v243, v243, v237
v_cvt_pk_bf16_f32 v32, v242, v243
v_lshlrev_b32 v242, 16, v33
v_and_b32 v243, 0xffff0000, v33
v_mul_f32 v242, v242, v237
v_mul_f32 v243, v243, v237
v_cvt_pk_bf16_f32 v33, v242, v243
v_log_f32 v243, v230
v_max3_f32 v234, v152, v153, v154
v_max3_f32 v234, v234, v155, v243
v_mov_b32 v243, v234
s_nop 1
v_permlane32_swap_b32 v234, v243
s_nop 1
v_max_f32 v234, v234, v243
v_mov_b32 v243, v234
s_nop 1
v_permlane16_swap_b32 v234, v243
s_nop 1
v_max_f32 v234, v234, v243
v_ceil_f32 v234, v234
v_max_f32 v234, 0, v234
v_sub_f32 v243, 0, v234
v_exp_f32 v238, v243
s_nop 1
v_mul_f32 v230, v230, v238
v_add_f32 v246, v246, v234
v_sub_f32 v200, v200, v234
v_sub_f32 v136, v136, v234
v_sub_f32 v152, v152, v234
v_sub_f32 v201, v201, v234
v_sub_f32 v137, v137, v234
v_sub_f32 v153, v153, v234
v_sub_f32 v202, v202, v234
v_sub_f32 v138, v138, v234
v_sub_f32 v154, v154, v234
v_sub_f32 v203, v203, v234
v_sub_f32 v139, v139, v234
v_sub_f32 v155, v155, v234
v_lshlrev_b32 v242, 16, v68
v_and_b32 v243, 0xffff0000, v68
v_mul_f32 v242, v242, v238
v_mul_f32 v243, v243, v238
v_cvt_pk_bf16_f32 v68, v242, v243
v_lshlrev_b32 v242, 16, v69
v_and_b32 v243, 0xffff0000, v69
v_mul_f32 v242, v242, v238
v_mul_f32 v243, v243, v238
v_cvt_pk_bf16_f32 v69, v242, v243
v_lshlrev_b32 v242, 16, v70
v_and_b32 v243, 0xffff0000, v70
v_mul_f32 v242, v242, v238
v_mul_f32 v243, v243, v238
v_cvt_pk_bf16_f32 v70, v242, v243
v_lshlrev_b32 v242, 16, v71
v_and_b32 v243, 0xffff0000, v71
v_mul_f32 v242, v242, v238
v_mul_f32 v243, v243, v238
v_cvt_pk_bf16_f32 v71, v242, v243
v_lshlrev_b32 v242, 16, v72
v_and_b32 v243, 0xffff0000, v72
v_mul_f32 v242, v242, v238
v_mul_f32 v243, v243, v238
v_cvt_pk_bf16_f32 v72, v242, v243
v_lshlrev_b32 v242, 16, v73
v_and_b32 v243, 0xffff0000, v73
v_mul_f32 v242, v242, v238
v_mul_f32 v243, v243, v238
v_cvt_pk_bf16_f32 v73, v242, v243
v_lshlrev_b32 v242, 16, v74
v_and_b32 v243, 0xffff0000, v74
v_mul_f32 v242, v242, v238
v_mul_f32 v243, v243, v238
v_cvt_pk_bf16_f32 v74, v242, v243
v_lshlrev_b32 v242, 16, v75
v_and_b32 v243, 0xffff0000, v75
v_mul_f32 v242, v242, v238
v_mul_f32 v243, v243, v238
v_cvt_pk_bf16_f32 v75, v242, v243
v_lshlrev_b32 v242, 16, v168
v_and_b32 v243, 0xffff0000, v168
v_mul_f32 v242, v242, v238
v_mul_f32 v243, v243, v238
v_cvt_pk_bf16_f32 v168, v242, v243
v_lshlrev_b32 v242, 16, v169
v_and_b32 v243, 0xffff0000, v169
v_mul_f32 v242, v242, v238
v_mul_f32 v243, v243, v238
v_cvt_pk_bf16_f32 v169, v242, v243
v_lshlrev_b32 v242, 16, v170
v_and_b32 v243, 0xffff0000, v170
v_mul_f32 v242, v242, v238
v_mul_f32 v243, v243, v238
v_cvt_pk_bf16_f32 v170, v242, v243
v_lshlrev_b32 v242, 16, v171
v_and_b32 v243, 0xffff0000, v171
v_mul_f32 v242, v242, v238
v_mul_f32 v243, v243, v238
v_cvt_pk_bf16_f32 v171, v242, v243
v_lshlrev_b32 v242, 16, v184
v_and_b32 v243, 0xffff0000, v184
v_mul_f32 v242, v242, v238
v_mul_f32 v243, v243, v238
v_cvt_pk_bf16_f32 v184, v242, v243
v_lshlrev_b32 v242, 16, v185
v_and_b32 v243, 0xffff0000, v185
v_mul_f32 v242, v242, v238
v_mul_f32 v243, v243, v238
v_cvt_pk_bf16_f32 v185, v242, v243
v_lshlrev_b32 v242, 16, v186
v_and_b32 v243, 0xffff0000, v186
v_mul_f32 v242, v242, v238
v_mul_f32 v243, v243, v238
v_cvt_pk_bf16_f32 v186, v242, v243
v_lshlrev_b32 v242, 16, v187
v_and_b32 v243, 0xffff0000, v187
v_mul_f32 v242, v242, v238
v_mul_f32 v243, v243, v238
v_cvt_pk_bf16_f32 v187, v242, v243
v_lshlrev_b32 v242, 16, v64
v_and_b32 v243, 0xffff0000, v64
v_mul_f32 v242, v242, v238
v_mul_f32 v243, v243, v238
v_cvt_pk_bf16_f32 v64, v242, v243
v_lshlrev_b32 v242, 16, v65
v_and_b32 v243, 0xffff0000, v65
v_mul_f32 v242, v242, v238
v_mul_f32 v243, v243, v238
v_cvt_pk_bf16_f32 v65, v242, v243
v_log_f32 v243, v231
v_max3_f32 v235, v156, v157, v158
v_max3_f32 v235, v235, v159, v243
v_mov_b32 v243, v235
s_nop 1
v_permlane32_swap_b32 v235, v243
s_nop 1
v_max_f32 v235, v235, v243
v_mov_b32 v243, v235
s_nop 1
v_permlane16_swap_b32 v235, v243
s_nop 1
v_max_f32 v235, v235, v243
v_ceil_f32 v235, v235
v_max_f32 v235, 0, v235
v_sub_f32 v243, 0, v235
v_exp_f32 v239, v243
s_nop 1
v_mul_f32 v231, v231, v239
v_add_f32 v247, v247, v235
v_sub_f32 v204, v204, v235
v_sub_f32 v140, v140, v235
v_sub_f32 v156, v156, v235
v_sub_f32 v205, v205, v235
v_sub_f32 v141, v141, v235
v_sub_f32 v157, v157, v235
v_sub_f32 v206, v206, v235
v_sub_f32 v142, v142, v235
v_sub_f32 v158, v158, v235
v_sub_f32 v207, v207, v235
v_sub_f32 v143, v143, v235
v_sub_f32 v159, v159, v235
v_lshlrev_b32 v242, 16, v100
v_and_b32 v243, 0xffff0000, v100
v_mul_f32 v242, v242, v239
v_mul_f32 v243, v243, v239
v_cvt_pk_bf16_f32 v100, v242, v243
v_lshlrev_b32 v242, 16, v101
v_and_b32 v243, 0xffff0000, v101
v_mul_f32 v242, v242, v239
v_mul_f32 v243, v243, v239
v_cvt_pk_bf16_f32 v101, v242, v243
v_lshlrev_b32 v242, 16, v102
v_and_b32 v243, 0xffff0000, v102
v_mul_f32 v242, v242, v239
v_mul_f32 v243, v243, v239
v_cvt_pk_bf16_f32 v102, v242, v243
v_lshlrev_b32 v242, 16, v103
v_and_b32 v243, 0xffff0000, v103
v_mul_f32 v242, v242, v239
v_mul_f32 v243, v243, v239
v_cvt_pk_bf16_f32 v103, v242, v243
v_lshlrev_b32 v242, 16, v104
v_and_b32 v243, 0xffff0000, v104
v_mul_f32 v242, v242, v239
v_mul_f32 v243, v243, v239
v_cvt_pk_bf16_f32 v104, v242, v243
v_lshlrev_b32 v242, 16, v105
v_and_b32 v243, 0xffff0000, v105
v_mul_f32 v242, v242, v239
v_mul_f32 v243, v243, v239
v_cvt_pk_bf16_f32 v105, v242, v243
v_lshlrev_b32 v242, 16, v106
v_and_b32 v243, 0xffff0000, v106
v_mul_f32 v242, v242, v239
v_mul_f32 v243, v243, v239
v_cvt_pk_bf16_f32 v106, v242, v243
v_lshlrev_b32 v242, 16, v107
v_and_b32 v243, 0xffff0000, v107
v_mul_f32 v242, v242, v239
v_mul_f32 v243, v243, v239
v_cvt_pk_bf16_f32 v107, v242, v243
v_lshlrev_b32 v242, 16, v172
v_and_b32 v243, 0xffff0000, v172
v_mul_f32 v242, v242, v239
v_mul_f32 v243, v243, v239
v_cvt_pk_bf16_f32 v172, v242, v243
v_lshlrev_b32 v242, 16, v173
v_and_b32 v243, 0xffff0000, v173
v_mul_f32 v242, v242, v239
v_mul_f32 v243, v243, v239
v_cvt_pk_bf16_f32 v173, v242, v243
v_lshlrev_b32 v242, 16, v174
v_and_b32 v243, 0xffff0000, v174
v_mul_f32 v242, v242, v239
v_mul_f32 v243, v243, v239
v_cvt_pk_bf16_f32 v174, v242, v243
v_lshlrev_b32 v242, 16, v175
v_and_b32 v243, 0xffff0000, v175
v_mul_f32 v242, v242, v239
v_mul_f32 v243, v243, v239
v_cvt_pk_bf16_f32 v175, v242, v243
v_lshlrev_b32 v242, 16, v188
v_and_b32 v243, 0xffff0000, v188
v_mul_f32 v242, v242, v239
v_mul_f32 v243, v243, v239
v_cvt_pk_bf16_f32 v188, v242, v243
v_lshlrev_b32 v242, 16, v189
v_and_b32 v243, 0xffff0000, v189
v_mul_f32 v242, v242, v239
v_mul_f32 v243, v243, v239
v_cvt_pk_bf16_f32 v189, v242, v243
v_lshlrev_b32 v242, 16, v190
v_and_b32 v243, 0xffff0000, v190
v_mul_f32 v242, v242, v239
v_mul_f32 v243, v243, v239
v_cvt_pk_bf16_f32 v190, v242, v243
v_lshlrev_b32 v242, 16, v191
v_and_b32 v243, 0xffff0000, v191
v_mul_f32 v242, v242, v239
v_mul_f32 v243, v243, v239
v_cvt_pk_bf16_f32 v191, v242, v243
v_lshlrev_b32 v242, 16, v96
v_and_b32 v243, 0xffff0000, v96
v_mul_f32 v242, v242, v239
v_mul_f32 v243, v243, v239
v_cvt_pk_bf16_f32 v96, v242, v243
v_lshlrev_b32 v242, 16, v97
v_and_b32 v243, 0xffff0000, v97
v_mul_f32 v242, v242, v239
v_mul_f32 v243, v243, v239
v_cvt_pk_bf16_f32 v97, v242, v243
v_exp_f32 v232, v144
v_exp_f32 v233, v145
v_exp_f32 v234, v146
v_exp_f32 v235, v147
s_nop 1
v_add_f32 v224, v228, v232
v_add_f32 v224, v224, v233
v_add_f32 v224, v224, v234
v_add_f32 v224, v224, v235
v_cvt_pk_bf16_f32 v2, v232, v233
v_cvt_pk_bf16_f32 v3, v234, v235
v_exp_f32 v232, v148
v_exp_f32 v233, v149
v_exp_f32 v234, v150
v_exp_f32 v235, v151
s_nop 1
v_add_f32 v225, v229, v232
v_add_f32 v225, v225, v233
v_add_f32 v225, v225, v234
v_add_f32 v225, v225, v235
v_cvt_pk_bf16_f32 v34, v232, v233
v_cvt_pk_bf16_f32 v35, v234, v235
v_exp_f32 v232, v152
v_exp_f32 v233, v153
v_exp_f32 v234, v154
v_exp_f32 v235, v155
s_nop 1
v_add_f32 v226, v230, v232
v_add_f32 v226, v226, v233
v_add_f32 v226, v226, v234
v_add_f32 v226, v226, v235
v_cvt_pk_bf16_f32 v66, v232, v233
v_cvt_pk_bf16_f32 v67, v234, v235
v_exp_f32 v232, v156
v_exp_f32 v233, v157
v_exp_f32 v234, v158
v_exp_f32 v235, v159
s_nop 1
v_add_f32 v227, v231, v232
v_add_f32 v227, v227, v233
v_add_f32 v227, v227, v234
v_add_f32 v227, v227, v235
v_cvt_pk_bf16_f32 v98, v232, v233
v_cvt_pk_bf16_f32 v99, v234, v235
s_branch L2_rare_common
LF_hl_0:
s_mov_b32 s94, 0x10000
s_mov_b32 s3, 0x7c28000
LF_hl2_0:
v_lshlrev_b32 v241, 3, v248
buffer_load_dwordx2 v[240:241], v241, s[16:19], s3 offen sc1
s_sub_u32 s94, s94, 1
s_waitcnt vmcnt(0)
s_cbranch_scc1 LF_hlret_0
v_cmp_ne_u64_e64 s[38:39], s[98:99], v[240:241]
s_and_b64 s[38:39], s[38:39], s[96:97]
s_cbranch_scc1 LF_hl2_0
s_branch LF_hlret_0
L2_rare_site12:
s_mov_b32 s36, 12
s_branch L2_rare_t1_0_0
L2_rare_t1_0_0:
s_nop 15
s_nop 15
s_waitcnt lgkmcnt(0)
v_log_f32 v243, v224
v_max3_f32 v232, v128, v129, v130
v_max3_f32 v232, v232, v131, v243
v_mov_b32 v243, v232
s_nop 1
v_permlane32_swap_b32 v232, v243
s_nop 1
v_max_f32 v232, v232, v243
v_mov_b32 v243, v232
s_nop 1
v_permlane16_swap_b32 v232, v243
s_nop 1
v_max_f32 v232, v232, v243
v_ceil_f32 v232, v232
v_max_f32 v232, 0, v232
v_sub_f32 v243, 0, v232
v_exp_f32 v236, v243
s_nop 1
v_mul_f32 v224, v224, v236
v_add_f32 v244, v244, v232
v_sub_f32 v192, v192, v232
v_sub_f32 v128, v128, v232
v_sub_f32 v144, v144, v232
v_sub_f32 v193, v193, v232
v_sub_f32 v129, v129, v232
v_sub_f32 v145, v145, v232
v_sub_f32 v194, v194, v232
v_sub_f32 v130, v130, v232
v_sub_f32 v146, v146, v232
v_sub_f32 v195, v195, v232
v_sub_f32 v131, v131, v232
v_sub_f32 v147, v147, v232
ds_read_b64 v[254:255], v253 offset:0
s_waitcnt lgkmcnt(0)
v_lshlrev_b32 v242, 16, v254
v_and_b32 v243, 0xffff0000, v254
v_mul_f32 v242, v242, v236
v_mul_f32 v243, v243, v236
v_cvt_pk_bf16_f32 v254, v242, v243
v_lshlrev_b32 v242, 16, v255
v_and_b32 v243, 0xffff0000, v255
v_mul_f32 v242, v242, v236
v_mul_f32 v243, v243, v236
v_cvt_pk_bf16_f32 v255, v242, v243
ds_write_b64 v253, v[254:255] offset:0
s_waitcnt lgkmcnt(0)
ds_read_b64 v[254:255], v253 offset:8
s_waitcnt lgkmcnt(0)
v_lshlrev_b32 v242, 16, v254
v_and_b32 v243, 0xffff0000, v254
v_mul_f32 v242, v242, v236
v_mul_f32 v243, v243, v236
v_cvt_pk_bf16_f32 v254, v242, v243
v_lshlrev_b32 v242, 16, v255
v_and_b32 v243, 0xffff0000, v255
v_mul_f32 v242, v242, v236
v_mul_f32 v243, v243, v236
v_cvt_pk_bf16_f32 v255, v242, v243
ds_write_b64 v253, v[254:255] offset:8
s_waitcnt lgkmcnt(0)
v_log_f32 v243, v225
v_max3_f32 v233, v132, v133, v134
v_max3_f32 v233, v233, v135, v243
v_mov_b32 v243, v233
s_nop 1
v_permlane32_swap_b32 v233, v243
s_nop 1
v_max_f32 v233, v233, v243
v_mov_b32 v243, v233
s_nop 1
v_permlane16_swap_b32 v233, v243
s_nop 1
v_max_f32 v233, v233, v243
v_ceil_f32 v233, v233
v_max_f32 v233, 0, v233
v_sub_f32 v243, 0, v233
v_exp_f32 v237, v243
s_nop 1
v_mul_f32 v225, v225, v237
v_add_f32 v245, v245, v233
v_sub_f32 v196, v196, v233
v_sub_f32 v132, v132, v233
v_sub_f32 v148, v148, v233
v_sub_f32 v197, v197, v233
v_sub_f32 v133, v133, v233
v_sub_f32 v149, v149, v233
v_sub_f32 v198, v198, v233
v_sub_f32 v134, v134, v233
v_sub_f32 v150, v150, v233
v_sub_f32 v199, v199, v233
v_sub_f32 v135, v135, v233
v_sub_f32 v151, v151, v233
ds_read_b64 v[254:255], v253 offset:1024
s_waitcnt lgkmcnt(0)
v_lshlrev_b32 v242, 16, v254
v_and_b32 v243, 0xffff0000, v254
v_mul_f32 v242, v242, v237
v_mul_f32 v243, v243, v237
v_cvt_pk_bf16_f32 v254, v242, v243
v_lshlrev_b32 v242, 16, v255
v_and_b32 v243, 0xffff0000, v255
v_mul_f32 v242, v242, v237
v_mul_f32 v243, v243, v237
v_cvt_pk_bf16_f32 v255, v242, v243
ds_write_b64 v253, v[254:255] offset:1024
s_waitcnt lgkmcnt(0)
ds_read_b64 v[254:255], v253 offset:1032
s_waitcnt lgkmcnt(0)
v_lshlrev_b32 v242, 16, v254
v_and_b32 v243, 0xffff0000, v254
v_mul_f32 v242, v242, v237
v_mul_f32 v243, v243, v237
v_cvt_pk_bf16_f32 v254, v242, v243
v_lshlrev_b32 v242, 16, v255
v_and_b32 v243, 0xffff0000, v255
v_mul_f32 v242, v242, v237
v_mul_f32 v243, v243, v237
v_cvt_pk_bf16_f32 v255, v242, v243
ds_write_b64 v253, v[254:255] offset:1032
s_waitcnt lgkmcnt(0)
v_log_f32 v243, v226
v_max3_f32 v234, v136, v137, v138
v_max3_f32 v234, v234, v139, v243
v_mov_b32 v243, v234
s_nop 1
v_permlane32_swap_b32 v234, v243
s_nop 1
v_max_f32 v234, v234, v243
v_mov_b32 v243, v234
s_nop 1
v_permlane16_swap_b32 v234, v243
s_nop 1
v_max_f32 v234, v234, v243
v_ceil_f32 v234, v234
v_max_f32 v234, 0, v234
v_sub_f32 v243, 0, v234
v_exp_f32 v238, v243
s_nop 1
v_mul_f32 v226, v226, v238
v_add_f32 v246, v246, v234
v_sub_f32 v200, v200, v234
v_sub_f32 v136, v136, v234
v_sub_f32 v152, v152, v234
v_sub_f32 v201, v201, v234
v_sub_f32 v137, v137, v234
v_sub_f32 v153, v153, v234
v_sub_f32 v202, v202, v234
v_sub_f32 v138, v138, v234
v_sub_f32 v154, v154, v234
v_sub_f32 v203, v203, v234
v_sub_f32 v139, v139, v234
v_sub_f32 v155, v155, v234
ds_read_b64 v[254:255], v253 offset:2048
s_waitcnt lgkmcnt(0)
v_lshlrev_b32 v242, 16, v254
v_and_b32 v243, 0xffff0000, v254
v_mul_f32 v242, v242, v238
v_mul_f32 v243, v243, v238
v_cvt_pk_bf16_f32 v254, v242, v243
v_lshlrev_b32 v242, 16, v255
v_and_b32 v243, 0xffff0000, v255
v_mul_f32 v242, v242, v238
v_mul_f32 v243, v243, v238
v_cvt_pk_bf16_f32 v255, v242, v243
ds_write_b64 v253, v[254:255] offset:2048
s_waitcnt lgkmcnt(0)
ds_read_b64 v[254:255], v253 offset:2056
s_waitcnt lgkmcnt(0)
v_lshlrev_b32 v242, 16, v254
v_and_b32 v243, 0xffff0000, v254
v_mul_f32 v242, v242, v238
v_mul_f32 v243, v243, v238
v_cvt_pk_bf16_f32 v254, v242, v243
v_lshlrev_b32 v242, 16, v255
v_and_b32 v243, 0xffff0000, v255
v_mul_f32 v242, v242, v238
v_mul_f32 v243, v243, v238
v_cvt_pk_bf16_f32 v255, v242, v243
ds_write_b64 v253, v[254:255] offset:2056
s_waitcnt lgkmcnt(0)
v_log_f32 v243, v227
v_max3_f32 v235, v140, v141, v142
v_max3_f32 v235, v235, v143, v243
v_mov_b32 v243, v235
s_nop 1
v_permlane32_swap_b32 v235, v243
s_nop 1
v_max_f32 v235, v235, v243
v_mov_b32 v243, v235
s_nop 1
v_permlane16_swap_b32 v235, v243
s_nop 1
v_max_f32 v235, v235, v243
v_ceil_f32 v235, v235
v_max_f32 v235, 0, v235
v_sub_f32 v243, 0, v235
v_exp_f32 v239, v243
s_nop 1
v_mul_f32 v227, v227, v239
v_add_f32 v247, v247, v235
v_sub_f32 v204, v204, v235
v_sub_f32 v140, v140, v235
v_sub_f32 v156, v156, v235
v_sub_f32 v205, v205, v235
v_sub_f32 v141, v141, v235
v_sub_f32 v157, v157, v235
v_sub_f32 v206, v206, v235
v_sub_f32 v142, v142, v235
v_sub_f32 v158, v158, v235
v_sub_f32 v207, v207, v235
v_sub_f32 v143, v143, v235
v_sub_f32 v159, v159, v235
ds_read_b64 v[254:255], v253 offset:3072
s_waitcnt lgkmcnt(0)
v_lshlrev_b32 v242, 16, v254
v_and_b32 v243, 0xffff0000, v254
v_mul_f32 v242, v242, v239
v_mul_f32 v243, v243, v239
v_cvt_pk_bf16_f32 v254, v242, v243
v_lshlrev_b32 v242, 16, v255
v_and_b32 v243, 0xffff0000, v255
v_mul_f32 v242, v242, v239
v_mul_f32 v243, v243, v239
v_cvt_pk_bf16_f32 v255, v242, v243
ds_write_b64 v253, v[254:255] offset:3072
s_waitcnt lgkmcnt(0)
ds_read_b64 v[254:255], v253 offset:3080
s_waitcnt lgkmcnt(0)
v_lshlrev_b32 v242, 16, v254
v_and_b32 v243, 0xffff0000, v254
v_mul_f32 v242, v242, v239
v_mul_f32 v243, v243, v239
v_cvt_pk_bf16_f32 v254, v242, v243
v_lshlrev_b32 v242, 16, v255
v_and_b32 v243, 0xffff0000, v255
v_mul_f32 v242, v242, v239
v_mul_f32 v243, v243, v239
v_cvt_pk_bf16_f32 v255, v242, v243
ds_write_b64 v253, v[254:255] offset:3080
s_waitcnt lgkmcnt(0)
v_exp_f32 v232, v128
v_exp_f32 v233, v129
v_exp_f32 v234, v130
v_exp_f32 v235, v131
s_nop 1
v_add_f32 v228, v224, v232
v_add_f32 v228, v228, v233
v_add_f32 v228, v228, v234
v_add_f32 v228, v228, v235
v_cvt_pk_bf16_f32 v160, v232, v233
v_cvt_pk_bf16_f32 v161, v234, v235
v_exp_f32 v232, v132
v_exp_f32 v233, v133
v_exp_f32 v234, v134
v_exp_f32 v235, v135
s_nop 1
v_add_f32 v229, v225, v232
v_add_f32 v229, v229, v233
v_add_f32 v229, v229, v234
v_add_f32 v229, v229, v235
v_cvt_pk_bf16_f32 v164, v232, v233
v_cvt_pk_bf16_f32 v165, v234, v235
v_exp_f32 v232, v136
v_exp_f32 v233, v137
v_exp_f32 v234, v138
v_exp_f32 v235, v139
s_nop 1
v_add_f32 v230, v226, v232
v_add_f32 v230, v230, v233
v_add_f32 v230, v230, v234
v_add_f32 v230, v230, v235
v_cvt_pk_bf16_f32 v168, v232, v233
v_cvt_pk_bf16_f32 v169, v234, v235
v_exp_f32 v232, v140
v_exp_f32 v233, v141
v_exp_f32 v234, v142
v_exp_f32 v235, v143
s_nop 1
v_add_f32 v231, v227, v232
v_add_f32 v231, v231, v233
v_add_f32 v231, v231, v234
v_add_f32 v231, v231, v235
v_cvt_pk_bf16_f32 v172, v232, v233
v_cvt_pk_bf16_f32 v173, v234, v235
s_branch L2_rare_common
L2_rare_site13:
s_mov_b32 s36, 13
s_branch L2_rare_t1_1_1
L2_rare_t1_1_1:
s_nop 15
s_nop 15
s_waitcnt lgkmcnt(0)
v_log_f32 v243, v228
v_max3_f32 v232, v144, v145, v146
v_max3_f32 v232, v232, v147, v243
v_mov_b32 v243, v232
s_nop 1
v_permlane32_swap_b32 v232, v243
s_nop 1
v_max_f32 v232, v232, v243
v_mov_b32 v243, v232
s_nop 1
v_permlane16_swap_b32 v232, v243
s_nop 1
v_max_f32 v232, v232, v243
v_ceil_f32 v232, v232
v_max_f32 v232, 0, v232
v_sub_f32 v243, 0, v232
v_exp_f32 v236, v243
s_nop 1
v_mul_f32 v228, v228, v236
v_add_f32 v244, v244, v232
v_sub_f32 v192, v192, v232
v_sub_f32 v128, v128, v232
v_sub_f32 v144, v144, v232
v_sub_f32 v193, v193, v232
v_sub_f32 v129, v129, v232
v_sub_f32 v145, v145, v232
v_sub_f32 v194, v194, v232
v_sub_f32 v130, v130, v232
v_sub_f32 v146, v146, v232
v_sub_f32 v195, v195, v232
v_sub_f32 v131, v131, v232
v_sub_f32 v147, v147, v232
v_lshlrev_b32 v242, 16, v160
v_and_b32 v243, 0xffff0000, v160
v_mul_f32 v242, v242, v236
v_mul_f32 v243, v243, v236
v_cvt_pk_bf16_f32 v160, v242, v243
v_lshlrev_b32 v242, 16, v161
v_and_b32 v243, 0xffff0000, v161
v_mul_f32 v242, v242, v236
v_mul_f32 v243, v243, v236
v_cvt_pk_bf16_f32 v161, v242, v243
ds_read_b64 v[254:255], v253 offset:0
s_waitcnt lgkmcnt(0)
v_lshlrev_b32 v242, 16, v254
v_and_b32 v243, 0xffff0000, v254
v_mul_f32 v242, v242, v236
v_mul_f32 v243, v243, v236
v_cvt_pk_bf16_f32 v254, v242, v243
v_lshlrev_b32 v242, 16, v255
v_and_b32 v243, 0xffff0000, v255
v_mul_f32 v242, v242, v236
v_mul_f32 v243, v243, v236
v_cvt_pk_bf16_f32 v255, v242, v243
ds_write_b64 v253, v[254:255] offset:0
s_waitcnt lgkmcnt(0)
ds_read_b64 v[254:255], v253 offset:8
s_waitcnt lgkmcnt(0)
v_lshlrev_b32 v242, 16, v254
v_and_b32 v243, 0xffff0000, v254
v_mul_f32 v242, v242, v236
v_mul_f32 v243, v243, v236
v_cvt_pk_bf16_f32 v254, v242, v243
v_lshlrev_b32 v242, 16, v255
v_and_b32 v243, 0xffff0000, v255
v_mul_f32 v242, v242, v236
v_mul_f32 v243, v243, v236
v_cvt_pk_bf16_f32 v255, v242, v243
ds_write_b64 v253, v[254:255] offset:8
s_waitcnt lgkmcnt(0)
v_log_f32 v243, v229
v_max3_f32 v233, v148, v149, v150
v_max3_f32 v233, v233, v151, v243
v_mov_b32 v243, v233
s_nop 1
v_permlane32_swap_b32 v233, v243
s_nop 1
v_max_f32 v233, v233, v243
v_mov_b32 v243, v233
s_nop 1
v_permlane16_swap_b32 v233, v243
s_nop 1
v_max_f32 v233, v233, v243
v_ceil_f32 v233, v233
v_max_f32 v233, 0, v233
v_sub_f32 v243, 0, v233
v_exp_f32 v237, v243
s_nop 1
v_mul_f32 v229, v229, v237
v_add_f32 v245, v245, v233
v_sub_f32 v196, v196, v233
v_sub_f32 v132, v132, v233
v_sub_f32 v148, v148, v233
v_sub_f32 v197, v197, v233
v_sub_f32 v133, v133, v233
v_sub_f32 v149, v149, v233
v_sub_f32 v198, v198, v233
v_sub_f32 v134, v134, v233
v_sub_f32 v150, v150, v233
v_sub_f32 v199, v199, v233
v_sub_f32 v135, v135, v233
v_sub_f32 v151, v151, v233
v_lshlrev_b32 v242, 16, v164
v_and_b32 v243, 0xffff0000, v164
v_mul_f32 v242, v242, v237
v_mul_f32 v243, v243, v237
v_cvt_pk_bf16_f32 v164, v242, v243
v_lshlrev_b32 v242, 16, v165
v_and_b32 v243, 0xffff0000, v165
v_mul_f32 v242, v242, v237
v_mul_f32 v243, v243, v237
v_cvt_pk_bf16_f32 v165, v242, v243
ds_read_b64 v[254:255], v253 offset:1024
s_waitcnt lgkmcnt(0)
v_lshlrev_b32 v242, 16, v254
v_and_b32 v243, 0xffff0000, v254
v_mul_f32 v242, v242, v237
v_mul_f32 v243, v243, v237
v_cvt_pk_bf16_f32 v254, v242, v243
v_lshlrev_b32 v242, 16, v255
v_and_b32 v243, 0xffff0000, v255
v_mul_f32 v242, v242, v237
v_mul_f32 v243, v243, v237
v_cvt_pk_bf16_f32 v255, v242, v243
ds_write_b64 v253, v[254:255] offset:1024
s_waitcnt lgkmcnt(0)
ds_read_b64 v[254:255], v253 offset:1032
s_waitcnt lgkmcnt(0)
v_lshlrev_b32 v242, 16, v254
v_and_b32 v243, 0xffff0000, v254
v_mul_f32 v242, v242, v237
v_mul_f32 v243, v243, v237
v_cvt_pk_bf16_f32 v254, v242, v243
v_lshlrev_b32 v242, 16, v255
v_and_b32 v243, 0xffff0000, v255
v_mul_f32 v242, v242, v237
v_mul_f32 v243, v243, v237
v_cvt_pk_bf16_f32 v255, v242, v243
ds_write_b64 v253, v[254:255] offset:1032
s_waitcnt lgkmcnt(0)
v_log_f32 v243, v230
v_max3_f32 v234, v152, v153, v154
v_max3_f32 v234, v234, v155, v243
v_mov_b32 v243, v234
s_nop 1
v_permlane32_swap_b32 v234, v243
s_nop 1
v_max_f32 v234, v234, v243
v_mov_b32 v243, v234
s_nop 1
v_permlane16_swap_b32 v234, v243
s_nop 1
v_max_f32 v234, v234, v243
v_ceil_f32 v234, v234
v_max_f32 v234, 0, v234
v_sub_f32 v243, 0, v234
v_exp_f32 v238, v243
s_nop 1
v_mul_f32 v230, v230, v238
v_add_f32 v246, v246, v234
v_sub_f32 v200, v200, v234
v_sub_f32 v136, v136, v234
v_sub_f32 v152, v152, v234
v_sub_f32 v201, v201, v234
v_sub_f32 v137, v137, v234
v_sub_f32 v153, v153, v234
v_sub_f32 v202, v202, v234
v_sub_f32 v138, v138, v234
v_sub_f32 v154, v154, v234
v_sub_f32 v203, v203, v234
v_sub_f32 v139, v139, v234
v_sub_f32 v155, v155, v234
v_lshlrev_b32 v242, 16, v168
v_and_b32 v243, 0xffff0000, v168
v_mul_f32 v242, v242, v238
v_mul_f32 v243, v243, v238
v_cvt_pk_bf16_f32 v168, v242, v243
v_lshlrev_b32 v242, 16, v169
v_and_b32 v243, 0xffff0000, v169
v_mul_f32 v242, v242, v238
v_mul_f32 v243, v243, v238
v_cvt_pk_bf16_f32 v169, v242, v243
ds_read_b64 v[254:255], v253 offset:2048
s_waitcnt lgkmcnt(0)
v_lshlrev_b32 v242, 16, v254
v_and_b32 v243, 0xffff0000, v254
v_mul_f32 v242, v242, v238
v_mul_f32 v243, v243, v238
v_cvt_pk_bf16_f32 v254, v242, v243
v_lshlrev_b32 v242, 16, v255
v_and_b32 v243, 0xffff0000, v255
v_mul_f32 v242, v242, v238
v_mul_f32 v243, v243, v238
v_cvt_pk_bf16_f32 v255, v242, v243
ds_write_b64 v253, v[254:255] offset:2048
s_waitcnt lgkmcnt(0)
ds_read_b64 v[254:255], v253 offset:2056
s_waitcnt lgkmcnt(0)
v_lshlrev_b32 v242, 16, v254
v_and_b32 v243, 0xffff0000, v254
v_mul_f32 v242, v242, v238
v_mul_f32 v243, v243, v238
v_cvt_pk_bf16_f32 v254, v242, v243
v_lshlrev_b32 v242, 16, v255
v_and_b32 v243, 0xffff0000, v255
v_mul_f32 v242, v242, v238
v_mul_f32 v243, v243, v238
v_cvt_pk_bf16_f32 v255, v242, v243
ds_write_b64 v253, v[254:255] offset:2056
s_waitcnt lgkmcnt(0)
v_log_f32 v243, v231
v_max3_f32 v235, v156, v157, v158
v_max3_f32 v235, v235, v159, v243
v_mov_b32 v243, v235
s_nop 1
v_permlane32_swap_b32 v235, v243
s_nop 1
v_max_f32 v235, v235, v243
v_mov_b32 v243, v235
s_nop 1
v_permlane16_swap_b32 v235, v243
s_nop 1
v_max_f32 v235, v235, v243
v_ceil_f32 v235, v235
v_max_f32 v235, 0, v235
v_sub_f32 v243, 0, v235
v_exp_f32 v239, v243
s_nop 1
v_mul_f32 v231, v231, v239
v_add_f32 v247, v247, v235
v_sub_f32 v204, v204, v235
v_sub_f32 v140, v140, v235
v_sub_f32 v156, v156, v235
v_sub_f32 v205, v205, v235
v_sub_f32 v141, v141, v235
v_sub_f32 v157, v157, v235
v_sub_f32 v206, v206, v235
v_sub_f32 v142, v142, v235
v_sub_f32 v158, v158, v235
v_sub_f32 v207, v207, v235
v_sub_f32 v143, v143, v235
v_sub_f32 v159, v159, v235
v_lshlrev_b32 v242, 16, v172
v_and_b32 v243, 0xffff0000, v172
v_mul_f32 v242, v242, v239
v_mul_f32 v243, v243, v239
v_cvt_pk_bf16_f32 v172, v242, v243
v_lshlrev_b32 v242, 16, v173
v_and_b32 v243, 0xffff0000, v173
v_mul_f32 v242, v242, v239
v_mul_f32 v243, v243, v239
v_cvt_pk_bf16_f32 v173, v242, v243
ds_read_b64 v[254:255], v253 offset:3072
s_waitcnt lgkmcnt(0)
v_lshlrev_b32 v242, 16, v254
v_and_b32 v243, 0xffff0000, v254
v_mul_f32 v242, v242, v239
v_mul_f32 v243, v243, v239
v_cvt_pk_bf16_f32 v254, v242, v243
v_lshlrev_b32 v242, 16, v255
v_and_b32 v243, 0xffff0000, v255
v_mul_f32 v242, v242, v239
v_mul_f32 v243, v243, v239
v_cvt_pk_bf16_f32 v255, v242, v243
ds_write_b64 v253, v[254:255] offset:3072
s_waitcnt lgkmcnt(0)
ds_read_b64 v[254:255], v253 offset:3080
s_waitcnt lgkmcnt(0)
v_lshlrev_b32 v242, 16, v254
v_and_b32 v243, 0xffff0000, v254
v_mul_f32 v242, v242, v239
v_mul_f32 v243, v243, v239
v_cvt_pk_bf16_f32 v254, v242, v243
v_lshlrev_b32 v242, 16, v255
v_and_b32 v243, 0xffff0000, v255
v_mul_f32 v242, v242, v239
v_mul_f32 v243, v243, v239
v_cvt_pk_bf16_f32 v255, v242, v243
ds_write_b64 v253, v[254:255] offset:3080
s_waitcnt lgkmcnt(0)
v_exp_f32 v232, v144
v_exp_f32 v233, v145
v_exp_f32 v234, v146
v_exp_f32 v235, v147
s_nop 1
v_add_f32 v224, v228, v232
v_add_f32 v224, v224, v233
v_add_f32 v224, v224, v234
v_add_f32 v224, v224, v235
v_cvt_pk_bf16_f32 v162, v232, v233
v_cvt_pk_bf16_f32 v163, v234, v235
v_exp_f32 v232, v148
v_exp_f32 v233, v149
v_exp_f32 v234, v150
v_exp_f32 v235, v151
s_nop 1
v_add_f32 v225, v229, v232
v_add_f32 v225, v225, v233
v_add_f32 v225, v225, v234
v_add_f32 v225, v225, v235
v_cvt_pk_bf16_f32 v166, v232, v233
v_cvt_pk_bf16_f32 v167, v234, v235
v_exp_f32 v232, v152
v_exp_f32 v233, v153
v_exp_f32 v234, v154
v_exp_f32 v235, v155
s_nop 1
v_add_f32 v226, v230, v232
v_add_f32 v226, v226, v233
v_add_f32 v226, v226, v234
v_add_f32 v226, v226, v235
v_cvt_pk_bf16_f32 v170, v232, v233
v_cvt_pk_bf16_f32 v171, v234, v235
v_exp_f32 v232, v156
v_exp_f32 v233, v157
v_exp_f32 v234, v158
v_exp_f32 v235, v159
s_nop 1
v_add_f32 v227, v231, v232
v_add_f32 v227, v227, v233
v_add_f32 v227, v227, v234
v_add_f32 v227, v227, v235
v_cvt_pk_bf16_f32 v174, v232, v233
v_cvt_pk_bf16_f32 v175, v234, v235
s_branch L2_rare_common
L2_rare_site14:
s_mov_b32 s36, 14
s_branch L2_rare_t1_2_0
L2_rare_t1_2_0:
s_nop 15
s_nop 15
s_waitcnt lgkmcnt(0)
v_log_f32 v243, v224
v_max3_f32 v232, v128, v129, v130
v_max3_f32 v232, v232, v131, v243
v_mov_b32 v243, v232
s_nop 1
v_permlane32_swap_b32 v232, v243
s_nop 1
v_max_f32 v232, v232, v243
v_mov_b32 v243, v232
s_nop 1
v_permlane16_swap_b32 v232, v243
s_nop 1
v_max_f32 v232, v232, v243
v_ceil_f32 v232, v232
v_max_f32 v232, 0, v232
v_sub_f32 v243, 0, v232
v_exp_f32 v236, v243
s_nop 1
v_mul_f32 v224, v224, v236
v_add_f32 v244, v244, v232
v_sub_f32 v192, v192, v232
v_sub_f32 v128, v128, v232
v_sub_f32 v144, v144, v232
v_sub_f32 v193, v193, v232
v_sub_f32 v129, v129, v232
v_sub_f32 v145, v145, v232
v_sub_f32 v194, v194, v232
v_sub_f32 v130, v130, v232
v_sub_f32 v146, v146, v232
v_sub_f32 v195, v195, v232
v_sub_f32 v131, v131, v232
v_sub_f32 v147, v147, v232
ds_read_b64 v[254:255], v253 offset:0
s_waitcnt lgkmcnt(0)
v_lshlrev_b32 v242, 16, v254
v_and_b32 v243, 0xffff0000, v254
v_mul_f32 v242, v242, v236
v_mul_f32 v243, v243, v236
v_cvt_pk_bf16_f32 v254, v242, v243
v_lshlrev_b32 v242, 16, v255
v_and_b32 v243, 0xffff0000, v255
v_mul_f32 v242, v242, v236
v_mul_f32 v243, v243, v236
v_cvt_pk_bf16_f32 v255, v242, v243
ds_write_b64 v253, v[254:255] offset:0
s_waitcnt lgkmcnt(0)
ds_read_b64 v[254:255], v253 offset:8
s_waitcnt lgkmcnt(0)
v_lshlrev_b32 v242, 16, v254
v_and_b32 v243, 0xffff0000, v254
v_mul_f32 v242, v242, v236
v_mul_f32 v243, v243, v236
v_cvt_pk_bf16_f32 v254, v242, v243
v_lshlrev_b32 v242, 16, v255
v_and_b32 v243, 0xffff0000, v255
v_mul_f32 v242, v242, v236
v_mul_f32 v243, v243, v236
v_cvt_pk_bf16_f32 v255, v242, v243
ds_write_b64 v253, v[254:255] offset:8
s_waitcnt lgkmcnt(0)
ds_read_b64 v[254:255], v253 offset:4096
s_waitcnt lgkmcnt(0)
v_lshlrev_b32 v242, 16, v254
v_and_b32 v243, 0xffff0000, v254
v_mul_f32 v242, v242, v236
v_mul_f32 v243, v243, v236
v_cvt_pk_bf16_f32 v254, v242, v243
v_lshlrev_b32 v242, 16, v255
v_and_b32 v243, 0xffff0000, v255
v_mul_f32 v242, v242, v236
v_mul_f32 v243, v243, v236
v_cvt_pk_bf16_f32 v255, v242, v243
ds_write_b64 v253, v[254:255] offset:4096
s_waitcnt lgkmcnt(0)
ds_read_b64 v[254:255], v253 offset:4104
s_waitcnt lgkmcnt(0)
v_lshlrev_b32 v242, 16, v254
v_and_b32 v243, 0xffff0000, v254
v_mul_f32 v242, v242, v236
v_mul_f32 v243, v243, v236
v_cvt_pk_bf16_f32 v254, v242, v243
v_lshlrev_b32 v242, 16, v255
v_and_b32 v243, 0xffff0000, v255
v_mul_f32 v242, v242, v236
v_mul_f32 v243, v243, v236
v_cvt_pk_bf16_f32 v255, v242, v243
ds_write_b64 v253, v[254:255] offset:4104
s_waitcnt lgkmcnt(0)
v_log_f32 v243, v225
v_max3_f32 v233, v132, v133, v134
v_max3_f32 v233, v233, v135, v243
v_mov_b32 v243, v233
s_nop 1
v_permlane32_swap_b32 v233, v243
s_nop 1
v_max_f32 v233, v233, v243
v_mov_b32 v243, v233
s_nop 1
v_permlane16_swap_b32 v233, v243
s_nop 1
v_max_f32 v233, v233, v243
v_ceil_f32 v233, v233
v_max_f32 v233, 0, v233
v_sub_f32 v243, 0, v233
v_exp_f32 v237, v243
s_nop 1
v_mul_f32 v225, v225, v237
v_add_f32 v245, v245, v233
v_sub_f32 v196, v196, v233
v_sub_f32 v132, v132, v233
v_sub_f32 v148, v148, v233
v_sub_f32 v197, v197, v233
v_sub_f32 v133, v133, v233
v_sub_f32 v149, v149, v233
v_sub_f32 v198, v198, v233
v_sub_f32 v134, v134, v233
v_sub_f32 v150, v150, v233
v_sub_f32 v199, v199, v233
v_sub_f32 v135, v135, v233
v_sub_f32 v151, v151, v233
ds_read_b64 v[254:255], v253 offset:1024
s_waitcnt lgkmcnt(0)
v_lshlrev_b32 v242, 16, v254
v_and_b32 v243, 0xffff0000, v254
v_mul_f32 v242, v242, v237
v_mul_f32 v243, v243, v237
v_cvt_pk_bf16_f32 v254, v242, v243
v_lshlrev_b32 v242, 16, v255
v_and_b32 v243, 0xffff0000, v255
v_mul_f32 v242, v242, v237
v_mul_f32 v243, v243, v237
v_cvt_pk_bf16_f32 v255, v242, v243
ds_write_b64 v253, v[254:255] offset:1024
s_waitcnt lgkmcnt(0)
ds_read_b64 v[254:255], v253 offset:1032
s_waitcnt lgkmcnt(0)
v_lshlrev_b32 v242, 16, v254
v_and_b32 v243, 0xffff0000, v254
v_mul_f32 v242, v242, v237
v_mul_f32 v243, v243, v237
v_cvt_pk_bf16_f32 v254, v242, v243
v_lshlrev_b32 v242, 16, v255
v_and_b32 v243, 0xffff0000, v255
v_mul_f32 v242, v242, v237
v_mul_f32 v243, v243, v237
v_cvt_pk_bf16_f32 v255, v242, v243
ds_write_b64 v253, v[254:255] offset:1032
s_waitcnt lgkmcnt(0)
ds_read_b64 v[254:255], v253 offset:5120
s_waitcnt lgkmcnt(0)
v_lshlrev_b32 v242, 16, v254
v_and_b32 v243, 0xffff0000, v254
v_mul_f32 v242, v242, v237
v_mul_f32 v243, v243, v237
v_cvt_pk_bf16_f32 v254, v242, v243
v_lshlrev_b32 v242, 16, v255
v_and_b32 v243, 0xffff0000, v255
v_mul_f32 v242, v242, v237
v_mul_f32 v243, v243, v237
v_cvt_pk_bf16_f32 v255, v242, v243
ds_write_b64 v253, v[254:255] offset:5120
s_waitcnt lgkmcnt(0)
ds_read_b64 v[254:255], v253 offset:5128
s_waitcnt lgkmcnt(0)
v_lshlrev_b32 v242, 16, v254
v_and_b32 v243, 0xffff0000, v254
v_mul_f32 v242, v242, v237
v_mul_f32 v243, v243, v237
v_cvt_pk_bf16_f32 v254, v242, v243
v_lshlrev_b32 v242, 16, v255
v_and_b32 v243, 0xffff0000, v255
v_mul_f32 v242, v242, v237
v_mul_f32 v243, v243, v237
v_cvt_pk_bf16_f32 v255, v242, v243
ds_write_b64 v253, v[254:255] offset:5128
s_waitcnt lgkmcnt(0)
v_log_f32 v243, v226
v_max3_f32 v234, v136, v137, v138
v_max3_f32 v234, v234, v139, v243
v_mov_b32 v243, v234
s_nop 1
v_permlane32_swap_b32 v234, v243
s_nop 1
v_max_f32 v234, v234, v243
v_mov_b32 v243, v234
s_nop 1
v_permlane16_swap_b32 v234, v243
s_nop 1
v_max_f32 v234, v234, v243
v_ceil_f32 v234, v234
v_max_f32 v234, 0, v234
v_sub_f32 v243, 0, v234
v_exp_f32 v238, v243
s_nop 1
v_mul_f32 v226, v226, v238
v_add_f32 v246, v246, v234
v_sub_f32 v200, v200, v234
v_sub_f32 v136, v136, v234
v_sub_f32 v152, v152, v234
v_sub_f32 v201, v201, v234
v_sub_f32 v137, v137, v234
v_sub_f32 v153, v153, v234
v_sub_f32 v202, v202, v234
v_sub_f32 v138, v138, v234
v_sub_f32 v154, v154, v234
v_sub_f32 v203, v203, v234
v_sub_f32 v139, v139, v234
v_sub_f32 v155, v155, v234
ds_read_b64 v[254:255], v253 offset:2048
s_waitcnt lgkmcnt(0)
v_lshlrev_b32 v242, 16, v254
v_and_b32 v243, 0xffff0000, v254
v_mul_f32 v242, v242, v238
v_mul_f32 v243, v243, v238
v_cvt_pk_bf16_f32 v254, v242, v243
v_lshlrev_b32 v242, 16, v255
v_and_b32 v243, 0xffff0000, v255
v_mul_f32 v242, v242, v238
v_mul_f32 v243, v243, v238
v_cvt_pk_bf16_f32 v255, v242, v243
ds_write_b64 v253, v[254:255] offset:2048
s_waitcnt lgkmcnt(0)
ds_read_b64 v[254:255], v253 offset:2056
s_waitcnt lgkmcnt(0)
v_lshlrev_b32 v242, 16, v254
v_and_b32 v243, 0xffff0000, v254
v_mul_f32 v242, v242, v238
v_mul_f32 v243, v243, v238
v_cvt_pk_bf16_f32 v254, v242, v243
v_lshlrev_b32 v242, 16, v255
v_and_b32 v243, 0xffff0000, v255
v_mul_f32 v242, v242, v238
v_mul_f32 v243, v243, v238
v_cvt_pk_bf16_f32 v255, v242, v243
ds_write_b64 v253, v[254:255] offset:2056
s_waitcnt lgkmcnt(0)
ds_read_b64 v[254:255], v253 offset:6144
s_waitcnt lgkmcnt(0)
v_lshlrev_b32 v242, 16, v254
v_and_b32 v243, 0xffff0000, v254
v_mul_f32 v242, v242, v238
v_mul_f32 v243, v243, v238
v_cvt_pk_bf16_f32 v254, v242, v243
v_lshlrev_b32 v242, 16, v255
v_and_b32 v243, 0xffff0000, v255
v_mul_f32 v242, v242, v238
v_mul_f32 v243, v243, v238
v_cvt_pk_bf16_f32 v255, v242, v243
ds_write_b64 v253, v[254:255] offset:6144
s_waitcnt lgkmcnt(0)
ds_read_b64 v[254:255], v253 offset:6152
s_waitcnt lgkmcnt(0)
v_lshlrev_b32 v242, 16, v254
v_and_b32 v243, 0xffff0000, v254
v_mul_f32 v242, v242, v238
v_mul_f32 v243, v243, v238
v_cvt_pk_bf16_f32 v254, v242, v243
v_lshlrev_b32 v242, 16, v255
v_and_b32 v243, 0xffff0000, v255
v_mul_f32 v242, v242, v238
v_mul_f32 v243, v243, v238
v_cvt_pk_bf16_f32 v255, v242, v243
ds_write_b64 v253, v[254:255] offset:6152
s_waitcnt lgkmcnt(0)
v_log_f32 v243, v227
v_max3_f32 v235, v140, v141, v142
v_max3_f32 v235, v235, v143, v243
v_mov_b32 v243, v235
s_nop 1
v_permlane32_swap_b32 v235, v243
s_nop 1
v_max_f32 v235, v235, v243
v_mov_b32 v243, v235
s_nop 1
v_permlane16_swap_b32 v235, v243
s_nop 1
v_max_f32 v235, v235, v243
v_ceil_f32 v235, v235
v_max_f32 v235, 0, v235
v_sub_f32 v243, 0, v235
v_exp_f32 v239, v243
s_nop 1
v_mul_f32 v227, v227, v239
v_add_f32 v247, v247, v235
v_sub_f32 v204, v204, v235
v_sub_f32 v140, v140, v235
v_sub_f32 v156, v156, v235
v_sub_f32 v205, v205, v235
v_sub_f32 v141, v141, v235
v_sub_f32 v157, v157, v235
v_sub_f32 v206, v206, v235
v_sub_f32 v142, v142, v235
v_sub_f32 v158, v158, v235
v_sub_f32 v207, v207, v235
v_sub_f32 v143, v143, v235
v_sub_f32 v159, v159, v235
ds_read_b64 v[254:255], v253 offset:3072
s_waitcnt lgkmcnt(0)
v_lshlrev_b32 v242, 16, v254
v_and_b32 v243, 0xffff0000, v254
v_mul_f32 v242, v242, v239
v_mul_f32 v243, v243, v239
v_cvt_pk_bf16_f32 v254, v242, v243
v_lshlrev_b32 v242, 16, v255
v_and_b32 v243, 0xffff0000, v255
v_mul_f32 v242, v242, v239
v_mul_f32 v243, v243, v239
v_cvt_pk_bf16_f32 v255, v242, v243
ds_write_b64 v253, v[254:255] offset:3072
s_waitcnt lgkmcnt(0)
ds_read_b64 v[254:255], v253 offset:3080
s_waitcnt lgkmcnt(0)
v_lshlrev_b32 v242, 16, v254
v_and_b32 v243, 0xffff0000, v254
v_mul_f32 v242, v242, v239
v_mul_f32 v243, v243, v239
v_cvt_pk_bf16_f32 v254, v242, v243
v_lshlrev_b32 v242, 16, v255
v_and_b32 v243, 0xffff0000, v255
v_mul_f32 v242, v242, v239
v_mul_f32 v243, v243, v239
v_cvt_pk_bf16_f32 v255, v242, v243
ds_write_b64 v253, v[254:255] offset:3080
s_waitcnt lgkmcnt(0)
ds_read_b64 v[254:255], v253 offset:7168
s_waitcnt lgkmcnt(0)
v_lshlrev_b32 v242, 16, v254
v_and_b32 v243, 0xffff0000, v254
v_mul_f32 v242, v242, v239
v_mul_f32 v243, v243, v239
v_cvt_pk_bf16_f32 v254, v242, v243
v_lshlrev_b32 v242, 16, v255
v_and_b32 v243, 0xffff0000, v255
v_mul_f32 v242, v242, v239
v_mul_f32 v243, v243, v239
v_cvt_pk_bf16_f32 v255, v242, v243
ds_write_b64 v253, v[254:255] offset:7168
s_waitcnt lgkmcnt(0)
ds_read_b64 v[254:255], v253 offset:7176
s_waitcnt lgkmcnt(0)
v_lshlrev_b32 v242, 16, v254
v_and_b32 v243, 0xffff0000, v254
v_mul_f32 v242, v242, v239
v_mul_f32 v243, v243, v239
v_cvt_pk_bf16_f32 v254, v242, v243
v_lshlrev_b32 v242, 16, v255
v_and_b32 v243, 0xffff0000, v255
v_mul_f32 v242, v242, v239
v_mul_f32 v243, v243, v239
v_cvt_pk_bf16_f32 v255, v242, v243
ds_write_b64 v253, v[254:255] offset:7176
s_waitcnt lgkmcnt(0)
v_exp_f32 v232, v128
v_exp_f32 v233, v129
v_exp_f32 v234, v130
v_exp_f32 v235, v131
s_nop 1
v_add_f32 v228, v224, v232
v_add_f32 v228, v228, v233
v_add_f32 v228, v228, v234
v_add_f32 v228, v228, v235
v_cvt_pk_bf16_f32 v176, v232, v233
v_cvt_pk_bf16_f32 v177, v234, v235
v_exp_f32 v232, v132
v_exp_f32 v233, v133
v_exp_f32 v234, v134
v_exp_f32 v235, v135
s_nop 1
v_add_f32 v229, v225, v232
v_add_f32 v229, v229, v233
v_add_f32 v229, v229, v234
v_add_f32 v229, v229, v235
v_cvt_pk_bf16_f32 v180, v232, v233
v_cvt_pk_bf16_f32 v181, v234, v235
v_exp_f32 v232, v136
v_exp_f32 v233, v137
v_exp_f32 v234, v138
v_exp_f32 v235, v139
s_nop 1
v_add_f32 v230, v226, v232
v_add_f32 v230, v230, v233
v_add_f32 v230, v230, v234
v_add_f32 v230, v230, v235
v_cvt_pk_bf16_f32 v184, v232, v233
v_cvt_pk_bf16_f32 v185, v234, v235
v_exp_f32 v232, v140
v_exp_f32 v233, v141
v_exp_f32 v234, v142
v_exp_f32 v235, v143
s_nop 1
v_add_f32 v231, v227, v232
v_add_f32 v231, v231, v233
v_add_f32 v231, v231, v234
v_add_f32 v231, v231, v235
v_cvt_pk_bf16_f32 v188, v232, v233
v_cvt_pk_bf16_f32 v189, v234, v235
s_branch L2_rare_common
L2_rare_site15:
s_mov_b32 s36, 15
s_branch L2_rare_t1_3_1
L2_rare_t1_3_1:
s_nop 15
s_nop 15
s_waitcnt lgkmcnt(0)
v_log_f32 v243, v228
v_max3_f32 v232, v144, v145, v146
v_max3_f32 v232, v232, v147, v243
v_mov_b32 v243, v232
s_nop 1
v_permlane32_swap_b32 v232, v243
s_nop 1
v_max_f32 v232, v232, v243
v_mov_b32 v243, v232
s_nop 1
v_permlane16_swap_b32 v232, v243
s_nop 1
v_max_f32 v232, v232, v243
v_ceil_f32 v232, v232
v_max_f32 v232, 0, v232
v_sub_f32 v243, 0, v232
v_exp_f32 v236, v243
s_nop 1
v_mul_f32 v228, v228, v236
v_add_f32 v244, v244, v232
v_sub_f32 v192, v192, v232
v_sub_f32 v128, v128, v232
v_sub_f32 v144, v144, v232
v_sub_f32 v193, v193, v232
v_sub_f32 v129, v129, v232
v_sub_f32 v145, v145, v232
v_sub_f32 v194, v194, v232
v_sub_f32 v130, v130, v232
v_sub_f32 v146, v146, v232
v_sub_f32 v195, v195, v232
v_sub_f32 v131, v131, v232
v_sub_f32 v147, v147, v232
v_lshlrev_b32 v242, 16, v176
v_and_b32 v243, 0xffff0000, v176
v_mul_f32 v242, v242, v236
v_mul_f32 v243, v243, v236
v_cvt_pk_bf16_f32 v176, v242, v243
v_lshlrev_b32 v242, 16, v177
v_and_b32 v243, 0xffff0000, v177
v_mul_f32 v242, v242, v236
v_mul_f32 v243, v243, v236
v_cvt_pk_bf16_f32 v177, v242, v243
ds_read_b64 v[254:255], v253 offset:0
s_waitcnt lgkmcnt(0)
v_lshlrev_b32 v242, 16, v254
v_and_b32 v243, 0xffff0000, v254
v_mul_f32 v242, v242, v236
v_mul_f32 v243, v243, v236
v_cvt_pk_bf16_f32 v254, v242, v243
v_lshlrev_b32 v242, 16, v255
v_and_b32 v243, 0xffff0000, v255
v_mul_f32 v242, v242, v236
v_mul_f32 v243, v243, v236
v_cvt_pk_bf16_f32 v255, v242, v243
ds_write_b64 v253, v[254:255] offset:0
s_waitcnt lgkmcnt(0)
ds_read_b64 v[254:255], v253 offset:8
s_waitcnt lgkmcnt(0)
v_lshlrev_b32 v242, 16, v254
v_and_b32 v243, 0xffff0000, v254
v_mul_f32 v242, v242, v236
v_mul_f32 v243, v243, v236
v_cvt_pk_bf16_f32 v254, v242, v243
v_lshlrev_b32 v242, 16, v255
v_and_b32 v243, 0xffff0000, v255
v_mul_f32 v242, v242, v236
v_mul_f32 v243, v243, v236
v_cvt_pk_bf16_f32 v255, v242, v243
ds_write_b64 v253, v[254:255] offset:8
s_waitcnt lgkmcnt(0)
ds_read_b64 v[254:255], v253 offset:4096
s_waitcnt lgkmcnt(0)
v_lshlrev_b32 v242, 16, v254
v_and_b32 v243, 0xffff0000, v254
v_mul_f32 v242, v242, v236
v_mul_f32 v243, v243, v236
v_cvt_pk_bf16_f32 v254, v242, v243
v_lshlrev_b32 v242, 16, v255
v_and_b32 v243, 0xffff0000, v255
v_mul_f32 v242, v242, v236
v_mul_f32 v243, v243, v236
v_cvt_pk_bf16_f32 v255, v242, v243
ds_write_b64 v253, v[254:255] offset:4096
s_waitcnt lgkmcnt(0)
ds_read_b64 v[254:255], v253 offset:4104
s_waitcnt lgkmcnt(0)
v_lshlrev_b32 v242, 16, v254
v_and_b32 v243, 0xffff0000, v254
v_mul_f32 v242, v242, v236
v_mul_f32 v243, v243, v236
v_cvt_pk_bf16_f32 v254, v242, v243
v_lshlrev_b32 v242, 16, v255
v_and_b32 v243, 0xffff0000, v255
v_mul_f32 v242, v242, v236
v_mul_f32 v243, v243, v236
v_cvt_pk_bf16_f32 v255, v242, v243
ds_write_b64 v253, v[254:255] offset:4104
s_waitcnt lgkmcnt(0)
v_log_f32 v243, v229
v_max3_f32 v233, v148, v149, v150
v_max3_f32 v233, v233, v151, v243
v_mov_b32 v243, v233
s_nop 1
v_permlane32_swap_b32 v233, v243
s_nop 1
v_max_f32 v233, v233, v243
v_mov_b32 v243, v233
s_nop 1
v_permlane16_swap_b32 v233, v243
s_nop 1
v_max_f32 v233, v233, v243
v_ceil_f32 v233, v233
v_max_f32 v233, 0, v233
v_sub_f32 v243, 0, v233
v_exp_f32 v237, v243
s_nop 1
v_mul_f32 v229, v229, v237
v_add_f32 v245, v245, v233
v_sub_f32 v196, v196, v233
v_sub_f32 v132, v132, v233
v_sub_f32 v148, v148, v233
v_sub_f32 v197, v197, v233
v_sub_f32 v133, v133, v233
v_sub_f32 v149, v149, v233
v_sub_f32 v198, v198, v233
v_sub_f32 v134, v134, v233
v_sub_f32 v150, v150, v233
v_sub_f32 v199, v199, v233
v_sub_f32 v135, v135, v233
v_sub_f32 v151, v151, v233
v_lshlrev_b32 v242, 16, v180
v_and_b32 v243, 0xffff0000, v180
v_mul_f32 v242, v242, v237
v_mul_f32 v243, v243, v237
v_cvt_pk_bf16_f32 v180, v242, v243
v_lshlrev_b32 v242, 16, v181
v_and_b32 v243, 0xffff0000, v181
v_mul_f32 v242, v242, v237
v_mul_f32 v243, v243, v237
v_cvt_pk_bf16_f32 v181, v242, v243
ds_read_b64 v[254:255], v253 offset:1024
s_waitcnt lgkmcnt(0)
v_lshlrev_b32 v242, 16, v254
v_and_b32 v243, 0xffff0000, v254
v_mul_f32 v242, v242, v237
v_mul_f32 v243, v243, v237
v_cvt_pk_bf16_f32 v254, v242, v243
v_lshlrev_b32 v242, 16, v255
v_and_b32 v243, 0xffff0000, v255
v_mul_f32 v242, v242, v237
v_mul_f32 v243, v243, v237
v_cvt_pk_bf16_f32 v255, v242, v243
ds_write_b64 v253, v[254:255] offset:1024
s_waitcnt lgkmcnt(0)
ds_read_b64 v[254:255], v253 offset:1032
s_waitcnt lgkmcnt(0)
v_lshlrev_b32 v242, 16, v254
v_and_b32 v243, 0xffff0000, v254
v_mul_f32 v242, v242, v237
v_mul_f32 v243, v243, v237
v_cvt_pk_bf16_f32 v254, v242, v243
v_lshlrev_b32 v242, 16, v255
v_and_b32 v243, 0xffff0000, v255
v_mul_f32 v242, v242, v237
v_mul_f32 v243, v243, v237
v_cvt_pk_bf16_f32 v255, v242, v243
ds_write_b64 v253, v[254:255] offset:1032
s_waitcnt lgkmcnt(0)
ds_read_b64 v[254:255], v253 offset:5120
s_waitcnt lgkmcnt(0)
v_lshlrev_b32 v242, 16, v254
v_and_b32 v243, 0xffff0000, v254
v_mul_f32 v242, v242, v237
v_mul_f32 v243, v243, v237
v_cvt_pk_bf16_f32 v254, v242, v243
v_lshlrev_b32 v242, 16, v255
v_and_b32 v243, 0xffff0000, v255
v_mul_f32 v242, v242, v237
v_mul_f32 v243, v243, v237
v_cvt_pk_bf16_f32 v255, v242, v243
ds_write_b64 v253, v[254:255] offset:5120
s_waitcnt lgkmcnt(0)
ds_read_b64 v[254:255], v253 offset:5128
s_waitcnt lgkmcnt(0)
v_lshlrev_b32 v242, 16, v254
v_and_b32 v243, 0xffff0000, v254
v_mul_f32 v242, v242, v237
v_mul_f32 v243, v243, v237
v_cvt_pk_bf16_f32 v254, v242, v243
v_lshlrev_b32 v242, 16, v255
v_and_b32 v243, 0xffff0000, v255
v_mul_f32 v242, v242, v237
v_mul_f32 v243, v243, v237
v_cvt_pk_bf16_f32 v255, v242, v243
ds_write_b64 v253, v[254:255] offset:5128
s_waitcnt lgkmcnt(0)
v_log_f32 v243, v230
v_max3_f32 v234, v152, v153, v154
v_max3_f32 v234, v234, v155, v243
v_mov_b32 v243, v234
s_nop 1
v_permlane32_swap_b32 v234, v243
s_nop 1
v_max_f32 v234, v234, v243
v_mov_b32 v243, v234
s_nop 1
v_permlane16_swap_b32 v234, v243
s_nop 1
v_max_f32 v234, v234, v243
v_ceil_f32 v234, v234
v_max_f32 v234, 0, v234
v_sub_f32 v243, 0, v234
v_exp_f32 v238, v243
s_nop 1
v_mul_f32 v230, v230, v238
v_add_f32 v246, v246, v234
v_sub_f32 v200, v200, v234
v_sub_f32 v136, v136, v234
v_sub_f32 v152, v152, v234
v_sub_f32 v201, v201, v234
v_sub_f32 v137, v137, v234
v_sub_f32 v153, v153, v234
v_sub_f32 v202, v202, v234
v_sub_f32 v138, v138, v234
v_sub_f32 v154, v154, v234
v_sub_f32 v203, v203, v234
v_sub_f32 v139, v139, v234
v_sub_f32 v155, v155, v234
v_lshlrev_b32 v242, 16, v184
v_and_b32 v243, 0xffff0000, v184
v_mul_f32 v242, v242, v238
v_mul_f32 v243, v243, v238
v_cvt_pk_bf16_f32 v184, v242, v243
v_lshlrev_b32 v242, 16, v185
v_and_b32 v243, 0xffff0000, v185
v_mul_f32 v242, v242, v238
v_mul_f32 v243, v243, v238
v_cvt_pk_bf16_f32 v185, v242, v243
ds_read_b64 v[254:255], v253 offset:2048
s_waitcnt lgkmcnt(0)
v_lshlrev_b32 v242, 16, v254
v_and_b32 v243, 0xffff0000, v254
v_mul_f32 v242, v242, v238
v_mul_f32 v243, v243, v238
v_cvt_pk_bf16_f32 v254, v242, v243
v_lshlrev_b32 v242, 16, v255
v_and_b32 v243, 0xffff0000, v255
v_mul_f32 v242, v242, v238
v_mul_f32 v243, v243, v238
v_cvt_pk_bf16_f32 v255, v242, v243
ds_write_b64 v253, v[254:255] offset:2048
s_waitcnt lgkmcnt(0)
ds_read_b64 v[254:255], v253 offset:2056
s_waitcnt lgkmcnt(0)
v_lshlrev_b32 v242, 16, v254
v_and_b32 v243, 0xffff0000, v254
v_mul_f32 v242, v242, v238
v_mul_f32 v243, v243, v238
v_cvt_pk_bf16_f32 v254, v242, v243
v_lshlrev_b32 v242, 16, v255
v_and_b32 v243, 0xffff0000, v255
v_mul_f32 v242, v242, v238
v_mul_f32 v243, v243, v238
v_cvt_pk_bf16_f32 v255, v242, v243
ds_write_b64 v253, v[254:255] offset:2056
s_waitcnt lgkmcnt(0)
ds_read_b64 v[254:255], v253 offset:6144
s_waitcnt lgkmcnt(0)
v_lshlrev_b32 v242, 16, v254
v_and_b32 v243, 0xffff0000, v254
v_mul_f32 v242, v242, v238
v_mul_f32 v243, v243, v238
v_cvt_pk_bf16_f32 v254, v242, v243
v_lshlrev_b32 v242, 16, v255
v_and_b32 v243, 0xffff0000, v255
v_mul_f32 v242, v242, v238
v_mul_f32 v243, v243, v238
v_cvt_pk_bf16_f32 v255, v242, v243
ds_write_b64 v253, v[254:255] offset:6144
s_waitcnt lgkmcnt(0)
ds_read_b64 v[254:255], v253 offset:6152
s_waitcnt lgkmcnt(0)
v_lshlrev_b32 v242, 16, v254
v_and_b32 v243, 0xffff0000, v254
v_mul_f32 v242, v242, v238
v_mul_f32 v243, v243, v238
v_cvt_pk_bf16_f32 v254, v242, v243
v_lshlrev_b32 v242, 16, v255
v_and_b32 v243, 0xffff0000, v255
v_mul_f32 v242, v242, v238
v_mul_f32 v243, v243, v238
v_cvt_pk_bf16_f32 v255, v242, v243
ds_write_b64 v253, v[254:255] offset:6152
s_waitcnt lgkmcnt(0)
v_log_f32 v243, v231
v_max3_f32 v235, v156, v157, v158
v_max3_f32 v235, v235, v159, v243
v_mov_b32 v243, v235
s_nop 1
v_permlane32_swap_b32 v235, v243
s_nop 1
v_max_f32 v235, v235, v243
v_mov_b32 v243, v235
s_nop 1
v_permlane16_swap_b32 v235, v243
s_nop 1
v_max_f32 v235, v235, v243
v_ceil_f32 v235, v235
v_max_f32 v235, 0, v235
v_sub_f32 v243, 0, v235
v_exp_f32 v239, v243
s_nop 1
v_mul_f32 v231, v231, v239
v_add_f32 v247, v247, v235
v_sub_f32 v204, v204, v235
v_sub_f32 v140, v140, v235
v_sub_f32 v156, v156, v235
v_sub_f32 v205, v205, v235
v_sub_f32 v141, v141, v235
v_sub_f32 v157, v157, v235
v_sub_f32 v206, v206, v235
v_sub_f32 v142, v142, v235
v_sub_f32 v158, v158, v235
v_sub_f32 v207, v207, v235
v_sub_f32 v143, v143, v235
v_sub_f32 v159, v159, v235
v_lshlrev_b32 v242, 16, v188
v_and_b32 v243, 0xffff0000, v188
v_mul_f32 v242, v242, v239
v_mul_f32 v243, v243, v239
v_cvt_pk_bf16_f32 v188, v242, v243
v_lshlrev_b32 v242, 16, v189
v_and_b32 v243, 0xffff0000, v189
v_mul_f32 v242, v242, v239
v_mul_f32 v243, v243, v239
v_cvt_pk_bf16_f32 v189, v242, v243
ds_read_b64 v[254:255], v253 offset:3072
s_waitcnt lgkmcnt(0)
v_lshlrev_b32 v242, 16, v254
v_and_b32 v243, 0xffff0000, v254
v_mul_f32 v242, v242, v239
v_mul_f32 v243, v243, v239
v_cvt_pk_bf16_f32 v254, v242, v243
v_lshlrev_b32 v242, 16, v255
v_and_b32 v243, 0xffff0000, v255
v_mul_f32 v242, v242, v239
v_mul_f32 v243, v243, v239
v_cvt_pk_bf16_f32 v255, v242, v243
ds_write_b64 v253, v[254:255] offset:3072
s_waitcnt lgkmcnt(0)
ds_read_b64 v[254:255], v253 offset:3080
s_waitcnt lgkmcnt(0)
v_lshlrev_b32 v242, 16, v254
v_and_b32 v243, 0xffff0000, v254
v_mul_f32 v242, v242, v239
v_mul_f32 v243, v243, v239
v_cvt_pk_bf16_f32 v254, v242, v243
v_lshlrev_b32 v242, 16, v255
v_and_b32 v243, 0xffff0000, v255
v_mul_f32 v242, v242, v239
v_mul_f32 v243, v243, v239
v_cvt_pk_bf16_f32 v255, v242, v243
ds_write_b64 v253, v[254:255] offset:3080
s_waitcnt lgkmcnt(0)
ds_read_b64 v[254:255], v253 offset:7168
s_waitcnt lgkmcnt(0)
v_lshlrev_b32 v242, 16, v254
v_and_b32 v243, 0xffff0000, v254
v_mul_f32 v242, v242, v239
v_mul_f32 v243, v243, v239
v_cvt_pk_bf16_f32 v254, v242, v243
v_lshlrev_b32 v242, 16, v255
v_and_b32 v243, 0xffff0000, v255
v_mul_f32 v242, v242, v239
v_mul_f32 v243, v243, v239
v_cvt_pk_bf16_f32 v255, v242, v243
ds_write_b64 v253, v[254:255] offset:7168
s_waitcnt lgkmcnt(0)
ds_read_b64 v[254:255], v253 offset:7176
s_waitcnt lgkmcnt(0)
v_lshlrev_b32 v242, 16, v254
v_and_b32 v243, 0xffff0000, v254
v_mul_f32 v242, v242, v239
v_mul_f32 v243, v243, v239
v_cvt_pk_bf16_f32 v254, v242, v243
v_lshlrev_b32 v242, 16, v255
v_and_b32 v243, 0xffff0000, v255
v_mul_f32 v242, v242, v239
v_mul_f32 v243, v243, v239
v_cvt_pk_bf16_f32 v255, v242, v243
ds_write_b64 v253, v[254:255] offset:7176
s_waitcnt lgkmcnt(0)
v_exp_f32 v232, v144
v_exp_f32 v233, v145
v_exp_f32 v234, v146
v_exp_f32 v235, v147
s_nop 1
v_add_f32 v224, v228, v232
v_add_f32 v224, v224, v233
v_add_f32 v224, v224, v234
v_add_f32 v224, v224, v235
v_cvt_pk_bf16_f32 v178, v232, v233
v_cvt_pk_bf16_f32 v179, v234, v235
v_exp_f32 v232, v148
v_exp_f32 v233, v149
v_exp_f32 v234, v150
v_exp_f32 v235, v151
s_nop 1
v_add_f32 v225, v229, v232
v_add_f32 v225, v225, v233
v_add_f32 v225, v225, v234
v_add_f32 v225, v225, v235
v_cvt_pk_bf16_f32 v182, v232, v233
v_cvt_pk_bf16_f32 v183, v234, v235
v_exp_f32 v232, v152
v_exp_f32 v233, v153
v_exp_f32 v234, v154
v_exp_f32 v235, v155
s_nop 1
v_add_f32 v226, v230, v232
v_add_f32 v226, v226, v233
v_add_f32 v226, v226, v234
v_add_f32 v226, v226, v235
v_cvt_pk_bf16_f32 v186, v232, v233
v_cvt_pk_bf16_f32 v187, v234, v235
v_exp_f32 v232, v156
v_exp_f32 v233, v157
v_exp_f32 v234, v158
v_exp_f32 v235, v159
s_nop 1
v_add_f32 v227, v231, v232
v_add_f32 v227, v227, v233
v_add_f32 v227, v227, v234
v_add_f32 v227, v227, v235
v_cvt_pk_bf16_f32 v190, v232, v233
v_cvt_pk_bf16_f32 v191, v234, v235
s_branch L2_rare_common
L2_rare_site16:
s_mov_b32 s36, 16
s_branch L2_rare_t1_4_0
L2_rare_t1_4_0:
s_nop 15
s_nop 15
s_waitcnt lgkmcnt(0)
v_log_f32 v243, v224
v_max3_f32 v232, v128, v129, v130
v_max3_f32 v232, v232, v131, v243
v_mov_b32 v243, v232
s_nop 1
v_permlane32_swap_b32 v232, v243
s_nop 1
v_max_f32 v232, v232, v243
v_mov_b32 v243, v232
s_nop 1
v_permlane16_swap_b32 v232, v243
s_nop 1
v_max_f32 v232, v232, v243
v_ceil_f32 v232, v232
v_max_f32 v232, 0, v232
v_sub_f32 v243, 0, v232
v_exp_f32 v236, v243
s_nop 1
v_mul_f32 v224, v224, v236
v_add_f32 v244, v244, v232
v_sub_f32 v192, v192, v232
v_sub_f32 v128, v128, v232
v_sub_f32 v144, v144, v232
v_sub_f32 v193, v193, v232
v_sub_f32 v129, v129, v232
v_sub_f32 v145, v145, v232
v_sub_f32 v194, v194, v232
v_sub_f32 v130, v130, v232
v_sub_f32 v146, v146, v232
v_sub_f32 v195, v195, v232
v_sub_f32 v131, v131, v232
v_sub_f32 v147, v147, v232
v_lshlrev_b32 v242, 16, v176
v_and_b32 v243, 0xffff0000, v176
v_mul_f32 v242, v242, v236
v_mul_f32 v243, v243, v236
v_cvt_pk_bf16_f32 v176, v242, v243
v_lshlrev_b32 v242, 16, v177
v_and_b32 v243, 0xffff0000, v177
v_mul_f32 v242, v242, v236
v_mul_f32 v243, v243, v236
v_cvt_pk_bf16_f32 v177, v242, v243
v_lshlrev_b32 v242, 16, v178
v_and_b32 v243, 0xffff0000, v178
v_mul_f32 v242, v242, v236
v_mul_f32 v243, v243, v236
v_cvt_pk_bf16_f32 v178, v242, v243
v_lshlrev_b32 v242, 16, v179
v_and_b32 v243, 0xffff0000, v179
v_mul_f32 v242, v242, v236
v_mul_f32 v243, v243, v236
v_cvt_pk_bf16_f32 v179, v242, v243
ds_read_b64 v[254:255], v253 offset:0
s_waitcnt lgkmcnt(0)
v_lshlrev_b32 v242, 16, v254
v_and_b32 v243, 0xffff0000, v254
v_mul_f32 v242, v242, v236
v_mul_f32 v243, v243, v236
v_cvt_pk_bf16_f32 v254, v242, v243
v_lshlrev_b32 v242, 16, v255
v_and_b32 v243, 0xffff0000, v255
v_mul_f32 v242, v242, v236
v_mul_f32 v243, v243, v236
v_cvt_pk_bf16_f32 v255, v242, v243
ds_write_b64 v253, v[254:255] offset:0
s_waitcnt lgkmcnt(0)
ds_read_b64 v[254:255], v253 offset:8
s_waitcnt lgkmcnt(0)
v_lshlrev_b32 v242, 16, v254
v_and_b32 v243, 0xffff0000, v254
v_mul_f32 v242, v242, v236
v_mul_f32 v243, v243, v236
v_cvt_pk_bf16_f32 v254, v242, v243
v_lshlrev_b32 v242, 16, v255
v_and_b32 v243, 0xffff0000, v255
v_mul_f32 v242, v242, v236
v_mul_f32 v243, v243, v236
v_cvt_pk_bf16_f32 v255, v242, v243
ds_write_b64 v253, v[254:255] offset:8
s_waitcnt lgkmcnt(0)
ds_read_b64 v[254:255], v253 offset:4096
s_waitcnt lgkmcnt(0)
v_lshlrev_b32 v242, 16, v254
v_and_b32 v243, 0xffff0000, v254
v_mul_f32 v242, v242, v236
v_mul_f32 v243, v243, v236
v_cvt_pk_bf16_f32 v254, v242, v243
v_lshlrev_b32 v242, 16, v255
v_and_b32 v243, 0xffff0000, v255
v_mul_f32 v242, v242, v236
v_mul_f32 v243, v243, v236
v_cvt_pk_bf16_f32 v255, v242, v243
ds_write_b64 v253, v[254:255] offset:4096
s_waitcnt lgkmcnt(0)
ds_read_b64 v[254:255], v253 offset:4104
s_waitcnt lgkmcnt(0)
v_lshlrev_b32 v242, 16, v254
v_and_b32 v243, 0xffff0000, v254
v_mul_f32 v242, v242, v236
v_mul_f32 v243, v243, v236
v_cvt_pk_bf16_f32 v254, v242, v243
v_lshlrev_b32 v242, 16, v255
v_and_b32 v243, 0xffff0000, v255
v_mul_f32 v242, v242, v236
v_mul_f32 v243, v243, v236
v_cvt_pk_bf16_f32 v255, v242, v243
ds_write_b64 v253, v[254:255] offset:4104
s_waitcnt lgkmcnt(0)
v_log_f32 v243, v225
v_max3_f32 v233, v132, v133, v134
v_max3_f32 v233, v233, v135, v243
v_mov_b32 v243, v233
s_nop 1
v_permlane32_swap_b32 v233, v243
s_nop 1
v_max_f32 v233, v233, v243
v_mov_b32 v243, v233
s_nop 1
v_permlane16_swap_b32 v233, v243
s_nop 1
v_max_f32 v233, v233, v243
v_ceil_f32 v233, v233
v_max_f32 v233, 0, v233
v_sub_f32 v243, 0, v233
v_exp_f32 v237, v243
s_nop 1
v_mul_f32 v225, v225, v237
v_add_f32 v245, v245, v233
v_sub_f32 v196, v196, v233
v_sub_f32 v132, v132, v233
v_sub_f32 v148, v148, v233
v_sub_f32 v197, v197, v233
v_sub_f32 v133, v133, v233
v_sub_f32 v149, v149, v233
v_sub_f32 v198, v198, v233
v_sub_f32 v134, v134, v233
v_sub_f32 v150, v150, v233
v_sub_f32 v199, v199, v233
v_sub_f32 v135, v135, v233
v_sub_f32 v151, v151, v233
v_lshlrev_b32 v242, 16, v180
v_and_b32 v243, 0xffff0000, v180
v_mul_f32 v242, v242, v237
v_mul_f32 v243, v243, v237
v_cvt_pk_bf16_f32 v180, v242, v243
v_lshlrev_b32 v242, 16, v181
v_and_b32 v243, 0xffff0000, v181
v_mul_f32 v242, v242, v237
v_mul_f32 v243, v243, v237
v_cvt_pk_bf16_f32 v181, v242, v243
v_lshlrev_b32 v242, 16, v182
v_and_b32 v243, 0xffff0000, v182
v_mul_f32 v242, v242, v237
v_mul_f32 v243, v243, v237
v_cvt_pk_bf16_f32 v182, v242, v243
v_lshlrev_b32 v242, 16, v183
v_and_b32 v243, 0xffff0000, v183
v_mul_f32 v242, v242, v237
v_mul_f32 v243, v243, v237
v_cvt_pk_bf16_f32 v183, v242, v243
ds_read_b64 v[254:255], v253 offset:1024
s_waitcnt lgkmcnt(0)
v_lshlrev_b32 v242, 16, v254
v_and_b32 v243, 0xffff0000, v254
v_mul_f32 v242, v242, v237
v_mul_f32 v243, v243, v237
v_cvt_pk_bf16_f32 v254, v242, v243
v_lshlrev_b32 v242, 16, v255
v_and_b32 v243, 0xffff0000, v255
v_mul_f32 v242, v242, v237
v_mul_f32 v243, v243, v237
v_cvt_pk_bf16_f32 v255, v242, v243
ds_write_b64 v253, v[254:255] offset:1024
s_waitcnt lgkmcnt(0)
ds_read_b64 v[254:255], v253 offset:1032
s_waitcnt lgkmcnt(0)
v_lshlrev_b32 v242, 16, v254
v_and_b32 v243, 0xffff0000, v254
v_mul_f32 v242, v242, v237
v_mul_f32 v243, v243, v237
v_cvt_pk_bf16_f32 v254, v242, v243
v_lshlrev_b32 v242, 16, v255
v_and_b32 v243, 0xffff0000, v255
v_mul_f32 v242, v242, v237
v_mul_f32 v243, v243, v237
v_cvt_pk_bf16_f32 v255, v242, v243
ds_write_b64 v253, v[254:255] offset:1032
s_waitcnt lgkmcnt(0)
ds_read_b64 v[254:255], v253 offset:5120
s_waitcnt lgkmcnt(0)
v_lshlrev_b32 v242, 16, v254
v_and_b32 v243, 0xffff0000, v254
v_mul_f32 v242, v242, v237
v_mul_f32 v243, v243, v237
v_cvt_pk_bf16_f32 v254, v242, v243
v_lshlrev_b32 v242, 16, v255
v_and_b32 v243, 0xffff0000, v255
v_mul_f32 v242, v242, v237
v_mul_f32 v243, v243, v237
v_cvt_pk_bf16_f32 v255, v242, v243
ds_write_b64 v253, v[254:255] offset:5120
s_waitcnt lgkmcnt(0)
ds_read_b64 v[254:255], v253 offset:5128
s_waitcnt lgkmcnt(0)
v_lshlrev_b32 v242, 16, v254
v_and_b32 v243, 0xffff0000, v254
v_mul_f32 v242, v242, v237
v_mul_f32 v243, v243, v237
v_cvt_pk_bf16_f32 v254, v242, v243
v_lshlrev_b32 v242, 16, v255
v_and_b32 v243, 0xffff0000, v255
v_mul_f32 v242, v242, v237
v_mul_f32 v243, v243, v237
v_cvt_pk_bf16_f32 v255, v242, v243
ds_write_b64 v253, v[254:255] offset:5128
s_waitcnt lgkmcnt(0)
v_log_f32 v243, v226
v_max3_f32 v234, v136, v137, v138
v_max3_f32 v234, v234, v139, v243
v_mov_b32 v243, v234
s_nop 1
v_permlane32_swap_b32 v234, v243
s_nop 1
v_max_f32 v234, v234, v243
v_mov_b32 v243, v234
s_nop 1
v_permlane16_swap_b32 v234, v243
s_nop 1
v_max_f32 v234, v234, v243
v_ceil_f32 v234, v234
v_max_f32 v234, 0, v234
v_sub_f32 v243, 0, v234
v_exp_f32 v238, v243
s_nop 1
v_mul_f32 v226, v226, v238
v_add_f32 v246, v246, v234
v_sub_f32 v200, v200, v234
v_sub_f32 v136, v136, v234
v_sub_f32 v152, v152, v234
v_sub_f32 v201, v201, v234
v_sub_f32 v137, v137, v234
v_sub_f32 v153, v153, v234
v_sub_f32 v202, v202, v234
v_sub_f32 v138, v138, v234
v_sub_f32 v154, v154, v234
v_sub_f32 v203, v203, v234
v_sub_f32 v139, v139, v234
v_sub_f32 v155, v155, v234
v_lshlrev_b32 v242, 16, v184
v_and_b32 v243, 0xffff0000, v184
v_mul_f32 v242, v242, v238
v_mul_f32 v243, v243, v238
v_cvt_pk_bf16_f32 v184, v242, v243
v_lshlrev_b32 v242, 16, v185
v_and_b32 v243, 0xffff0000, v185
v_mul_f32 v242, v242, v238
v_mul_f32 v243, v243, v238
v_cvt_pk_bf16_f32 v185, v242, v243
v_lshlrev_b32 v242, 16, v186
v_and_b32 v243, 0xffff0000, v186
v_mul_f32 v242, v242, v238
v_mul_f32 v243, v243, v238
v_cvt_pk_bf16_f32 v186, v242, v243
v_lshlrev_b32 v242, 16, v187
v_and_b32 v243, 0xffff0000, v187
v_mul_f32 v242, v242, v238
v_mul_f32 v243, v243, v238
v_cvt_pk_bf16_f32 v187, v242, v243
ds_read_b64 v[254:255], v253 offset:2048
s_waitcnt lgkmcnt(0)
v_lshlrev_b32 v242, 16, v254
v_and_b32 v243, 0xffff0000, v254
v_mul_f32 v242, v242, v238
v_mul_f32 v243, v243, v238
v_cvt_pk_bf16_f32 v254, v242, v243
v_lshlrev_b32 v242, 16, v255
v_and_b32 v243, 0xffff0000, v255
v_mul_f32 v242, v242, v238
v_mul_f32 v243, v243, v238
v_cvt_pk_bf16_f32 v255, v242, v243
ds_write_b64 v253, v[254:255] offset:2048
s_waitcnt lgkmcnt(0)
ds_read_b64 v[254:255], v253 offset:2056
s_waitcnt lgkmcnt(0)
v_lshlrev_b32 v242, 16, v254
v_and_b32 v243, 0xffff0000, v254
v_mul_f32 v242, v242, v238
v_mul_f32 v243, v243, v238
v_cvt_pk_bf16_f32 v254, v242, v243
v_lshlrev_b32 v242, 16, v255
v_and_b32 v243, 0xffff0000, v255
v_mul_f32 v242, v242, v238
v_mul_f32 v243, v243, v238
v_cvt_pk_bf16_f32 v255, v242, v243
ds_write_b64 v253, v[254:255] offset:2056
s_waitcnt lgkmcnt(0)
ds_read_b64 v[254:255], v253 offset:6144
s_waitcnt lgkmcnt(0)
v_lshlrev_b32 v242, 16, v254
v_and_b32 v243, 0xffff0000, v254
v_mul_f32 v242, v242, v238
v_mul_f32 v243, v243, v238
v_cvt_pk_bf16_f32 v254, v242, v243
v_lshlrev_b32 v242, 16, v255
v_and_b32 v243, 0xffff0000, v255
v_mul_f32 v242, v242, v238
v_mul_f32 v243, v243, v238
v_cvt_pk_bf16_f32 v255, v242, v243
ds_write_b64 v253, v[254:255] offset:6144
s_waitcnt lgkmcnt(0)
ds_read_b64 v[254:255], v253 offset:6152
s_waitcnt lgkmcnt(0)
v_lshlrev_b32 v242, 16, v254
v_and_b32 v243, 0xffff0000, v254
v_mul_f32 v242, v242, v238
v_mul_f32 v243, v243, v238
v_cvt_pk_bf16_f32 v254, v242, v243
v_lshlrev_b32 v242, 16, v255
v_and_b32 v243, 0xffff0000, v255
v_mul_f32 v242, v242, v238
v_mul_f32 v243, v243, v238
v_cvt_pk_bf16_f32 v255, v242, v243
ds_write_b64 v253, v[254:255] offset:6152
s_waitcnt lgkmcnt(0)
v_log_f32 v243, v227
v_max3_f32 v235, v140, v141, v142
v_max3_f32 v235, v235, v143, v243
v_mov_b32 v243, v235
s_nop 1
v_permlane32_swap_b32 v235, v243
s_nop 1
v_max_f32 v235, v235, v243
v_mov_b32 v243, v235
s_nop 1
v_permlane16_swap_b32 v235, v243
s_nop 1
v_max_f32 v235, v235, v243
v_ceil_f32 v235, v235
v_max_f32 v235, 0, v235
v_sub_f32 v243, 0, v235
v_exp_f32 v239, v243
s_nop 1
v_mul_f32 v227, v227, v239
v_add_f32 v247, v247, v235
v_sub_f32 v204, v204, v235
v_sub_f32 v140, v140, v235
v_sub_f32 v156, v156, v235
v_sub_f32 v205, v205, v235
v_sub_f32 v141, v141, v235
v_sub_f32 v157, v157, v235
v_sub_f32 v206, v206, v235
v_sub_f32 v142, v142, v235
v_sub_f32 v158, v158, v235
v_sub_f32 v207, v207, v235
v_sub_f32 v143, v143, v235
v_sub_f32 v159, v159, v235
v_lshlrev_b32 v242, 16, v188
v_and_b32 v243, 0xffff0000, v188
v_mul_f32 v242, v242, v239
v_mul_f32 v243, v243, v239
v_cvt_pk_bf16_f32 v188, v242, v243
v_lshlrev_b32 v242, 16, v189
v_and_b32 v243, 0xffff0000, v189
v_mul_f32 v242, v242, v239
v_mul_f32 v243, v243, v239
v_cvt_pk_bf16_f32 v189, v242, v243
v_lshlrev_b32 v242, 16, v190
v_and_b32 v243, 0xffff0000, v190
v_mul_f32 v242, v242, v239
v_mul_f32 v243, v243, v239
v_cvt_pk_bf16_f32 v190, v242, v243
v_lshlrev_b32 v242, 16, v191
v_and_b32 v243, 0xffff0000, v191
v_mul_f32 v242, v242, v239
v_mul_f32 v243, v243, v239
v_cvt_pk_bf16_f32 v191, v242, v243
ds_read_b64 v[254:255], v253 offset:3072
s_waitcnt lgkmcnt(0)
v_lshlrev_b32 v242, 16, v254
v_and_b32 v243, 0xffff0000, v254
v_mul_f32 v242, v242, v239
v_mul_f32 v243, v243, v239
v_cvt_pk_bf16_f32 v254, v242, v243
v_lshlrev_b32 v242, 16, v255
v_and_b32 v243, 0xffff0000, v255
v_mul_f32 v242, v242, v239
v_mul_f32 v243, v243, v239
v_cvt_pk_bf16_f32 v255, v242, v243
ds_write_b64 v253, v[254:255] offset:3072
s_waitcnt lgkmcnt(0)
ds_read_b64 v[254:255], v253 offset:3080
s_waitcnt lgkmcnt(0)
v_lshlrev_b32 v242, 16, v254
v_and_b32 v243, 0xffff0000, v254
v_mul_f32 v242, v242, v239
v_mul_f32 v243, v243, v239
v_cvt_pk_bf16_f32 v254, v242, v243
v_lshlrev_b32 v242, 16, v255
v_and_b32 v243, 0xffff0000, v255
v_mul_f32 v242, v242, v239
v_mul_f32 v243, v243, v239
v_cvt_pk_bf16_f32 v255, v242, v243
ds_write_b64 v253, v[254:255] offset:3080
s_waitcnt lgkmcnt(0)
ds_read_b64 v[254:255], v253 offset:7168
s_waitcnt lgkmcnt(0)
v_lshlrev_b32 v242, 16, v254
v_and_b32 v243, 0xffff0000, v254
v_mul_f32 v242, v242, v239
v_mul_f32 v243, v243, v239
v_cvt_pk_bf16_f32 v254, v242, v243
v_lshlrev_b32 v242, 16, v255
v_and_b32 v243, 0xffff0000, v255
v_mul_f32 v242, v242, v239
v_mul_f32 v243, v243, v239
v_cvt_pk_bf16_f32 v255, v242, v243
ds_write_b64 v253, v[254:255] offset:7168
s_waitcnt lgkmcnt(0)
ds_read_b64 v[254:255], v253 offset:7176
s_waitcnt lgkmcnt(0)
v_lshlrev_b32 v242, 16, v254
v_and_b32 v243, 0xffff0000, v254
v_mul_f32 v242, v242, v239
v_mul_f32 v243, v243, v239
v_cvt_pk_bf16_f32 v254, v242, v243
v_lshlrev_b32 v242, 16, v255
v_and_b32 v243, 0xffff0000, v255
v_mul_f32 v242, v242, v239
v_mul_f32 v243, v243, v239
v_cvt_pk_bf16_f32 v255, v242, v243
ds_write_b64 v253, v[254:255] offset:7176
s_waitcnt lgkmcnt(0)
v_exp_f32 v232, v128
v_exp_f32 v233, v129
v_exp_f32 v234, v130
v_exp_f32 v235, v131
s_nop 1
v_add_f32 v228, v224, v232
v_add_f32 v228, v228, v233
v_add_f32 v228, v228, v234
v_add_f32 v228, v228, v235
v_cvt_pk_bf16_f32 v160, v232, v233
v_cvt_pk_bf16_f32 v161, v234, v235
v_exp_f32 v232, v132
v_exp_f32 v233, v133
v_exp_f32 v234, v134
v_exp_f32 v235, v135
s_nop 1
v_add_f32 v229, v225, v232
v_add_f32 v229, v229, v233
v_add_f32 v229, v229, v234
v_add_f32 v229, v229, v235
v_cvt_pk_bf16_f32 v164, v232, v233
v_cvt_pk_bf16_f32 v165, v234, v235
v_exp_f32 v232, v136
v_exp_f32 v233, v137
v_exp_f32 v234, v138
v_exp_f32 v235, v139
s_nop 1
v_add_f32 v230, v226, v232
v_add_f32 v230, v230, v233
v_add_f32 v230, v230, v234
v_add_f32 v230, v230, v235
v_cvt_pk_bf16_f32 v168, v232, v233
v_cvt_pk_bf16_f32 v169, v234, v235
v_exp_f32 v232, v140
v_exp_f32 v233, v141
v_exp_f32 v234, v142
v_exp_f32 v235, v143
s_nop 1
v_add_f32 v231, v227, v232
v_add_f32 v231, v231, v233
v_add_f32 v231, v231, v234
v_add_f32 v231, v231, v235
v_cvt_pk_bf16_f32 v172, v232, v233
v_cvt_pk_bf16_f32 v173, v234, v235
s_branch L2_rare_common
L2_rare_site17:
s_mov_b32 s36, 17
s_branch L2_rare_t1_5_1
L2_rare_t1_5_1:
s_nop 15
s_nop 15
s_waitcnt lgkmcnt(0)
v_log_f32 v243, v228
v_max3_f32 v232, v144, v145, v146
v_max3_f32 v232, v232, v147, v243
v_mov_b32 v243, v232
s_nop 1
v_permlane32_swap_b32 v232, v243
s_nop 1
v_max_f32 v232, v232, v243
v_mov_b32 v243, v232
s_nop 1
v_permlane16_swap_b32 v232, v243
s_nop 1
v_max_f32 v232, v232, v243
v_ceil_f32 v232, v232
v_max_f32 v232, 0, v232
v_sub_f32 v243, 0, v232
v_exp_f32 v236, v243
s_nop 1
v_mul_f32 v228, v228, v236
v_add_f32 v244, v244, v232
v_sub_f32 v192, v192, v232
v_sub_f32 v128, v128, v232
v_sub_f32 v144, v144, v232
v_sub_f32 v193, v193, v232
v_sub_f32 v129, v129, v232
v_sub_f32 v145, v145, v232
v_sub_f32 v194, v194, v232
v_sub_f32 v130, v130, v232
v_sub_f32 v146, v146, v232
v_sub_f32 v195, v195, v232
v_sub_f32 v131, v131, v232
v_sub_f32 v147, v147, v232
v_lshlrev_b32 v242, 16, v176
v_and_b32 v243, 0xffff0000, v176
v_mul_f32 v242, v242, v236
v_mul_f32 v243, v243, v236
v_cvt_pk_bf16_f32 v176, v242, v243
v_lshlrev_b32 v242, 16, v177
v_and_b32 v243, 0xffff0000, v177
v_mul_f32 v242, v242, v236
v_mul_f32 v243, v243, v236
v_cvt_pk_bf16_f32 v177, v242, v243
v_lshlrev_b32 v242, 16, v178
v_and_b32 v243, 0xffff0000, v178
v_mul_f32 v242, v242, v236
v_mul_f32 v243, v243, v236
v_cvt_pk_bf16_f32 v178, v242, v243
v_lshlrev_b32 v242, 16, v179
v_and_b32 v243, 0xffff0000, v179
v_mul_f32 v242, v242, v236
v_mul_f32 v243, v243, v236
v_cvt_pk_bf16_f32 v179, v242, v243
v_lshlrev_b32 v242, 16, v160
v_and_b32 v243, 0xffff0000, v160
v_mul_f32 v242, v242, v236
v_mul_f32 v243, v243, v236
v_cvt_pk_bf16_f32 v160, v242, v243
v_lshlrev_b32 v242, 16, v161
v_and_b32 v243, 0xffff0000, v161
v_mul_f32 v242, v242, v236
v_mul_f32 v243, v243, v236
v_cvt_pk_bf16_f32 v161, v242, v243
ds_read_b64 v[254:255], v253 offset:0
s_waitcnt lgkmcnt(0)
v_lshlrev_b32 v242, 16, v254
v_and_b32 v243, 0xffff0000, v254
v_mul_f32 v242, v242, v236
v_mul_f32 v243, v243, v236
v_cvt_pk_bf16_f32 v254, v242, v243
v_lshlrev_b32 v242, 16, v255
v_and_b32 v243, 0xffff0000, v255
v_mul_f32 v242, v242, v236
v_mul_f32 v243, v243, v236
v_cvt_pk_bf16_f32 v255, v242, v243
ds_write_b64 v253, v[254:255] offset:0
s_waitcnt lgkmcnt(0)
ds_read_b64 v[254:255], v253 offset:8
s_waitcnt lgkmcnt(0)
v_lshlrev_b32 v242, 16, v254
v_and_b32 v243, 0xffff0000, v254
v_mul_f32 v242, v242, v236
v_mul_f32 v243, v243, v236
v_cvt_pk_bf16_f32 v254, v242, v243
v_lshlrev_b32 v242, 16, v255
v_and_b32 v243, 0xffff0000, v255
v_mul_f32 v242, v242, v236
v_mul_f32 v243, v243, v236
v_cvt_pk_bf16_f32 v255, v242, v243
ds_write_b64 v253, v[254:255] offset:8
s_waitcnt lgkmcnt(0)
ds_read_b64 v[254:255], v253 offset:4096
s_waitcnt lgkmcnt(0)
v_lshlrev_b32 v242, 16, v254
v_and_b32 v243, 0xffff0000, v254
v_mul_f32 v242, v242, v236
v_mul_f32 v243, v243, v236
v_cvt_pk_bf16_f32 v254, v242, v243
v_lshlrev_b32 v242, 16, v255
v_and_b32 v243, 0xffff0000, v255
v_mul_f32 v242, v242, v236
v_mul_f32 v243, v243, v236
v_cvt_pk_bf16_f32 v255, v242, v243
ds_write_b64 v253, v[254:255] offset:4096
s_waitcnt lgkmcnt(0)
ds_read_b64 v[254:255], v253 offset:4104
s_waitcnt lgkmcnt(0)
v_lshlrev_b32 v242, 16, v254
v_and_b32 v243, 0xffff0000, v254
v_mul_f32 v242, v242, v236
v_mul_f32 v243, v243, v236
v_cvt_pk_bf16_f32 v254, v242, v243
v_lshlrev_b32 v242, 16, v255
v_and_b32 v243, 0xffff0000, v255
v_mul_f32 v242, v242, v236
v_mul_f32 v243, v243, v236
v_cvt_pk_bf16_f32 v255, v242, v243
ds_write_b64 v253, v[254:255] offset:4104
s_waitcnt lgkmcnt(0)
v_log_f32 v243, v229
v_max3_f32 v233, v148, v149, v150
v_max3_f32 v233, v233, v151, v243
v_mov_b32 v243, v233
s_nop 1
v_permlane32_swap_b32 v233, v243
s_nop 1
v_max_f32 v233, v233, v243
v_mov_b32 v243, v233
s_nop 1
v_permlane16_swap_b32 v233, v243
s_nop 1
v_max_f32 v233, v233, v243
v_ceil_f32 v233, v233
v_max_f32 v233, 0, v233
v_sub_f32 v243, 0, v233
v_exp_f32 v237, v243
s_nop 1
v_mul_f32 v229, v229, v237
v_add_f32 v245, v245, v233
v_sub_f32 v196, v196, v233
v_sub_f32 v132, v132, v233
v_sub_f32 v148, v148, v233
v_sub_f32 v197, v197, v233
v_sub_f32 v133, v133, v233
v_sub_f32 v149, v149, v233
v_sub_f32 v198, v198, v233
v_sub_f32 v134, v134, v233
v_sub_f32 v150, v150, v233
v_sub_f32 v199, v199, v233
v_sub_f32 v135, v135, v233
v_sub_f32 v151, v151, v233
v_lshlrev_b32 v242, 16, v180
v_and_b32 v243, 0xffff0000, v180
v_mul_f32 v242, v242, v237
v_mul_f32 v243, v243, v237
v_cvt_pk_bf16_f32 v180, v242, v243
v_lshlrev_b32 v242, 16, v181
v_and_b32 v243, 0xffff0000, v181
v_mul_f32 v242, v242, v237
v_mul_f32 v243, v243, v237
v_cvt_pk_bf16_f32 v181, v242, v243
v_lshlrev_b32 v242, 16, v182
v_and_b32 v243, 0xffff0000, v182
v_mul_f32 v242, v242, v237
v_mul_f32 v243, v243, v237
v_cvt_pk_bf16_f32 v182, v242, v243
v_lshlrev_b32 v242, 16, v183
v_and_b32 v243, 0xffff0000, v183
v_mul_f32 v242, v242, v237
v_mul_f32 v243, v243, v237
v_cvt_pk_bf16_f32 v183, v242, v243
v_lshlrev_b32 v242, 16, v164
v_and_b32 v243, 0xffff0000, v164
v_mul_f32 v242, v242, v237
v_mul_f32 v243, v243, v237
v_cvt_pk_bf16_f32 v164, v242, v243
v_lshlrev_b32 v242, 16, v165
v_and_b32 v243, 0xffff0000, v165
v_mul_f32 v242, v242, v237
v_mul_f32 v243, v243, v237
v_cvt_pk_bf16_f32 v165, v242, v243
ds_read_b64 v[254:255], v253 offset:1024
s_waitcnt lgkmcnt(0)
v_lshlrev_b32 v242, 16, v254
v_and_b32 v243, 0xffff0000, v254
v_mul_f32 v242, v242, v237
v_mul_f32 v243, v243, v237
v_cvt_pk_bf16_f32 v254, v242, v243
v_lshlrev_b32 v242, 16, v255
v_and_b32 v243, 0xffff0000, v255
v_mul_f32 v242, v242, v237
v_mul_f32 v243, v243, v237
v_cvt_pk_bf16_f32 v255, v242, v243
ds_write_b64 v253, v[254:255] offset:1024
s_waitcnt lgkmcnt(0)
ds_read_b64 v[254:255], v253 offset:1032
s_waitcnt lgkmcnt(0)
v_lshlrev_b32 v242, 16, v254
v_and_b32 v243, 0xffff0000, v254
v_mul_f32 v242, v242, v237
v_mul_f32 v243, v243, v237
v_cvt_pk_bf16_f32 v254, v242, v243
v_lshlrev_b32 v242, 16, v255
v_and_b32 v243, 0xffff0000, v255
v_mul_f32 v242, v242, v237
v_mul_f32 v243, v243, v237
v_cvt_pk_bf16_f32 v255, v242, v243
ds_write_b64 v253, v[254:255] offset:1032
s_waitcnt lgkmcnt(0)
ds_read_b64 v[254:255], v253 offset:5120
s_waitcnt lgkmcnt(0)
v_lshlrev_b32 v242, 16, v254
v_and_b32 v243, 0xffff0000, v254
v_mul_f32 v242, v242, v237
v_mul_f32 v243, v243, v237
v_cvt_pk_bf16_f32 v254, v242, v243
v_lshlrev_b32 v242, 16, v255
v_and_b32 v243, 0xffff0000, v255
v_mul_f32 v242, v242, v237
v_mul_f32 v243, v243, v237
v_cvt_pk_bf16_f32 v255, v242, v243
ds_write_b64 v253, v[254:255] offset:5120
s_waitcnt lgkmcnt(0)
ds_read_b64 v[254:255], v253 offset:5128
s_waitcnt lgkmcnt(0)
v_lshlrev_b32 v242, 16, v254
v_and_b32 v243, 0xffff0000, v254
v_mul_f32 v242, v242, v237
v_mul_f32 v243, v243, v237
v_cvt_pk_bf16_f32 v254, v242, v243
v_lshlrev_b32 v242, 16, v255
v_and_b32 v243, 0xffff0000, v255
v_mul_f32 v242, v242, v237
v_mul_f32 v243, v243, v237
v_cvt_pk_bf16_f32 v255, v242, v243
ds_write_b64 v253, v[254:255] offset:5128
s_waitcnt lgkmcnt(0)
v_log_f32 v243, v230
v_max3_f32 v234, v152, v153, v154
v_max3_f32 v234, v234, v155, v243
v_mov_b32 v243, v234
s_nop 1
v_permlane32_swap_b32 v234, v243
s_nop 1
v_max_f32 v234, v234, v243
v_mov_b32 v243, v234
s_nop 1
v_permlane16_swap_b32 v234, v243
s_nop 1
v_max_f32 v234, v234, v243
v_ceil_f32 v234, v234
v_max_f32 v234, 0, v234
v_sub_f32 v243, 0, v234
v_exp_f32 v238, v243
s_nop 1
v_mul_f32 v230, v230, v238
v_add_f32 v246, v246, v234
v_sub_f32 v200, v200, v234
v_sub_f32 v136, v136, v234
v_sub_f32 v152, v152, v234
v_sub_f32 v201, v201, v234
v_sub_f32 v137, v137, v234
v_sub_f32 v153, v153, v234
v_sub_f32 v202, v202, v234
v_sub_f32 v138, v138, v234
v_sub_f32 v154, v154, v234
v_sub_f32 v203, v203, v234
v_sub_f32 v139, v139, v234
v_sub_f32 v155, v155, v234
v_lshlrev_b32 v242, 16, v184
v_and_b32 v243, 0xffff0000, v184
v_mul_f32 v242, v242, v238
v_mul_f32 v243, v243, v238
v_cvt_pk_bf16_f32 v184, v242, v243
v_lshlrev_b32 v242, 16, v185
v_and_b32 v243, 0xffff0000, v185
v_mul_f32 v242, v242, v238
v_mul_f32 v243, v243, v238
v_cvt_pk_bf16_f32 v185, v242, v243
v_lshlrev_b32 v242, 16, v186
v_and_b32 v243, 0xffff0000, v186
v_mul_f32 v242, v242, v238
v_mul_f32 v243, v243, v238
v_cvt_pk_bf16_f32 v186, v242, v243
v_lshlrev_b32 v242, 16, v187
v_and_b32 v243, 0xffff0000, v187
v_mul_f32 v242, v242, v238
v_mul_f32 v243, v243, v238
v_cvt_pk_bf16_f32 v187, v242, v243
v_lshlrev_b32 v242, 16, v168
v_and_b32 v243, 0xffff0000, v168
v_mul_f32 v242, v242, v238
v_mul_f32 v243, v243, v238
v_cvt_pk_bf16_f32 v168, v242, v243
v_lshlrev_b32 v242, 16, v169
v_and_b32 v243, 0xffff0000, v169
v_mul_f32 v242, v242, v238
v_mul_f32 v243, v243, v238
v_cvt_pk_bf16_f32 v169, v242, v243
ds_read_b64 v[254:255], v253 offset:2048
s_waitcnt lgkmcnt(0)
v_lshlrev_b32 v242, 16, v254
v_and_b32 v243, 0xffff0000, v254
v_mul_f32 v242, v242, v238
v_mul_f32 v243, v243, v238
v_cvt_pk_bf16_f32 v254, v242, v243
v_lshlrev_b32 v242, 16, v255
v_and_b32 v243, 0xffff0000, v255
v_mul_f32 v242, v242, v238
v_mul_f32 v243, v243, v238
v_cvt_pk_bf16_f32 v255, v242, v243
ds_write_b64 v253, v[254:255] offset:2048
s_waitcnt lgkmcnt(0)
ds_read_b64 v[254:255], v253 offset:2056
s_waitcnt lgkmcnt(0)
v_lshlrev_b32 v242, 16, v254
v_and_b32 v243, 0xffff0000, v254
v_mul_f32 v242, v242, v238
v_mul_f32 v243, v243, v238
v_cvt_pk_bf16_f32 v254, v242, v243
v_lshlrev_b32 v242, 16, v255
v_and_b32 v243, 0xffff0000, v255
v_mul_f32 v242, v242, v238
v_mul_f32 v243, v243, v238
v_cvt_pk_bf16_f32 v255, v242, v243
ds_write_b64 v253, v[254:255] offset:2056
s_waitcnt lgkmcnt(0)
ds_read_b64 v[254:255], v253 offset:6144
s_waitcnt lgkmcnt(0)
v_lshlrev_b32 v242, 16, v254
v_and_b32 v243, 0xffff0000, v254
v_mul_f32 v242, v242, v238
v_mul_f32 v243, v243, v238
v_cvt_pk_bf16_f32 v254, v242, v243
v_lshlrev_b32 v242, 16, v255
v_and_b32 v243, 0xffff0000, v255
v_mul_f32 v242, v242, v238
v_mul_f32 v243, v243, v238
v_cvt_pk_bf16_f32 v255, v242, v243
ds_write_b64 v253, v[254:255] offset:6144
s_waitcnt lgkmcnt(0)
ds_read_b64 v[254:255], v253 offset:6152
s_waitcnt lgkmcnt(0)
v_lshlrev_b32 v242, 16, v254
v_and_b32 v243, 0xffff0000, v254
v_mul_f32 v242, v242, v238
v_mul_f32 v243, v243, v238
v_cvt_pk_bf16_f32 v254, v242, v243
v_lshlrev_b32 v242, 16, v255
v_and_b32 v243, 0xffff0000, v255
v_mul_f32 v242, v242, v238
v_mul_f32 v243, v243, v238
v_cvt_pk_bf16_f32 v255, v242, v243
ds_write_b64 v253, v[254:255] offset:6152
s_waitcnt lgkmcnt(0)
v_log_f32 v243, v231
v_max3_f32 v235, v156, v157, v158
v_max3_f32 v235, v235, v159, v243
v_mov_b32 v243, v235
s_nop 1
v_permlane32_swap_b32 v235, v243
s_nop 1
v_max_f32 v235, v235, v243
v_mov_b32 v243, v235
s_nop 1
v_permlane16_swap_b32 v235, v243
s_nop 1
v_max_f32 v235, v235, v243
v_ceil_f32 v235, v235
v_max_f32 v235, 0, v235
v_sub_f32 v243, 0, v235
v_exp_f32 v239, v243
s_nop 1
v_mul_f32 v231, v231, v239
v_add_f32 v247, v247, v235
v_sub_f32 v204, v204, v235
v_sub_f32 v140, v140, v235
v_sub_f32 v156, v156, v235
v_sub_f32 v205, v205, v235
v_sub_f32 v141, v141, v235
v_sub_f32 v157, v157, v235
v_sub_f32 v206, v206, v235
v_sub_f32 v142, v142, v235
v_sub_f32 v158, v158, v235
v_sub_f32 v207, v207, v235
v_sub_f32 v143, v143, v235
v_sub_f32 v159, v159, v235
v_lshlrev_b32 v242, 16, v188
v_and_b32 v243, 0xffff0000, v188
v_mul_f32 v242, v242, v239
v_mul_f32 v243, v243, v239
v_cvt_pk_bf16_f32 v188, v242, v243
v_lshlrev_b32 v242, 16, v189
v_and_b32 v243, 0xffff0000, v189
v_mul_f32 v242, v242, v239
v_mul_f32 v243, v243, v239
v_cvt_pk_bf16_f32 v189, v242, v243
v_lshlrev_b32 v242, 16, v190
v_and_b32 v243, 0xffff0000, v190
v_mul_f32 v242, v242, v239
v_mul_f32 v243, v243, v239
v_cvt_pk_bf16_f32 v190, v242, v243
v_lshlrev_b32 v242, 16, v191
v_and_b32 v243, 0xffff0000, v191
v_mul_f32 v242, v242, v239
v_mul_f32 v243, v243, v239
v_cvt_pk_bf16_f32 v191, v242, v243
v_lshlrev_b32 v242, 16, v172
v_and_b32 v243, 0xffff0000, v172
v_mul_f32 v242, v242, v239
v_mul_f32 v243, v243, v239
v_cvt_pk_bf16_f32 v172, v242, v243
v_lshlrev_b32 v242, 16, v173
v_and_b32 v243, 0xffff0000, v173
v_mul_f32 v242, v242, v239
v_mul_f32 v243, v243, v239
v_cvt_pk_bf16_f32 v173, v242, v243
ds_read_b64 v[254:255], v253 offset:3072
s_waitcnt lgkmcnt(0)
v_lshlrev_b32 v242, 16, v254
v_and_b32 v243, 0xffff0000, v254
v_mul_f32 v242, v242, v239
v_mul_f32 v243, v243, v239
v_cvt_pk_bf16_f32 v254, v242, v243
v_lshlrev_b32 v242, 16, v255
v_and_b32 v243, 0xffff0000, v255
v_mul_f32 v242, v242, v239
v_mul_f32 v243, v243, v239
v_cvt_pk_bf16_f32 v255, v242, v243
ds_write_b64 v253, v[254:255] offset:3072
s_waitcnt lgkmcnt(0)
ds_read_b64 v[254:255], v253 offset:3080
s_waitcnt lgkmcnt(0)
v_lshlrev_b32 v242, 16, v254
v_and_b32 v243, 0xffff0000, v254
v_mul_f32 v242, v242, v239
v_mul_f32 v243, v243, v239
v_cvt_pk_bf16_f32 v254, v242, v243
v_lshlrev_b32 v242, 16, v255
v_and_b32 v243, 0xffff0000, v255
v_mul_f32 v242, v242, v239
v_mul_f32 v243, v243, v239
v_cvt_pk_bf16_f32 v255, v242, v243
ds_write_b64 v253, v[254:255] offset:3080
s_waitcnt lgkmcnt(0)
ds_read_b64 v[254:255], v253 offset:7168
s_waitcnt lgkmcnt(0)
v_lshlrev_b32 v242, 16, v254
v_and_b32 v243, 0xffff0000, v254
v_mul_f32 v242, v242, v239
v_mul_f32 v243, v243, v239
v_cvt_pk_bf16_f32 v254, v242, v243
v_lshlrev_b32 v242, 16, v255
v_and_b32 v243, 0xffff0000, v255
v_mul_f32 v242, v242, v239
v_mul_f32 v243, v243, v239
v_cvt_pk_bf16_f32 v255, v242, v243
ds_write_b64 v253, v[254:255] offset:7168
s_waitcnt lgkmcnt(0)
ds_read_b64 v[254:255], v253 offset:7176
s_waitcnt lgkmcnt(0)
v_lshlrev_b32 v242, 16, v254
v_and_b32 v243, 0xffff0000, v254
v_mul_f32 v242, v242, v239
v_mul_f32 v243, v243, v239
v_cvt_pk_bf16_f32 v254, v242, v243
v_lshlrev_b32 v242, 16, v255
v_and_b32 v243, 0xffff0000, v255
v_mul_f32 v242, v242, v239
v_mul_f32 v243, v243, v239
v_cvt_pk_bf16_f32 v255, v242, v243
ds_write_b64 v253, v[254:255] offset:7176
s_waitcnt lgkmcnt(0)
v_exp_f32 v232, v144
v_exp_f32 v233, v145
v_exp_f32 v234, v146
v_exp_f32 v235, v147
s_nop 1
v_add_f32 v224, v228, v232
v_add_f32 v224, v224, v233
v_add_f32 v224, v224, v234
v_add_f32 v224, v224, v235
v_cvt_pk_bf16_f32 v162, v232, v233
v_cvt_pk_bf16_f32 v163, v234, v235
v_exp_f32 v232, v148
v_exp_f32 v233, v149
v_exp_f32 v234, v150
v_exp_f32 v235, v151
s_nop 1
v_add_f32 v225, v229, v232
v_add_f32 v225, v225, v233
v_add_f32 v225, v225, v234
v_add_f32 v225, v225, v235
v_cvt_pk_bf16_f32 v166, v232, v233
v_cvt_pk_bf16_f32 v167, v234, v235
v_exp_f32 v232, v152
v_exp_f32 v233, v153
v_exp_f32 v234, v154
v_exp_f32 v235, v155
s_nop 1
v_add_f32 v226, v230, v232
v_add_f32 v226, v226, v233
v_add_f32 v226, v226, v234
v_add_f32 v226, v226, v235
v_cvt_pk_bf16_f32 v170, v232, v233
v_cvt_pk_bf16_f32 v171, v234, v235
v_exp_f32 v232, v156
v_exp_f32 v233, v157
v_exp_f32 v234, v158
v_exp_f32 v235, v159
s_nop 1
v_add_f32 v227, v231, v232
v_add_f32 v227, v227, v233
v_add_f32 v227, v227, v234
v_add_f32 v227, v227, v235
v_cvt_pk_bf16_f32 v174, v232, v233
v_cvt_pk_bf16_f32 v175, v234, v235
s_branch L2_rare_common
L2_rare_site18:
s_mov_b32 s36, 18
s_branch L2_rare_t1_6_0
L2_rare_t1_6_0:
s_nop 15
s_nop 15
s_waitcnt lgkmcnt(0)
v_log_f32 v243, v224
v_max3_f32 v232, v128, v129, v130
v_max3_f32 v232, v232, v131, v243
v_mov_b32 v243, v232
s_nop 1
v_permlane32_swap_b32 v232, v243
s_nop 1
v_max_f32 v232, v232, v243
v_mov_b32 v243, v232
s_nop 1
v_permlane16_swap_b32 v232, v243
s_nop 1
v_max_f32 v232, v232, v243
v_ceil_f32 v232, v232
v_max_f32 v232, 0, v232
v_sub_f32 v243, 0, v232
v_exp_f32 v236, v243
s_nop 1
v_mul_f32 v224, v224, v236
v_add_f32 v244, v244, v232
v_sub_f32 v192, v192, v232
v_sub_f32 v128, v128, v232
v_sub_f32 v144, v144, v232
v_sub_f32 v193, v193, v232
v_sub_f32 v129, v129, v232
v_sub_f32 v145, v145, v232
v_sub_f32 v194, v194, v232
v_sub_f32 v130, v130, v232
v_sub_f32 v146, v146, v232
v_sub_f32 v195, v195, v232
v_sub_f32 v131, v131, v232
v_sub_f32 v147, v147, v232
v_lshlrev_b32 v242, 16, v4
v_and_b32 v243, 0xffff0000, v4
v_mul_f32 v242, v242, v236
v_mul_f32 v243, v243, v236
v_cvt_pk_bf16_f32 v4, v242, v243
v_lshlrev_b32 v242, 16, v5
v_and_b32 v243, 0xffff0000, v5
v_mul_f32 v242, v242, v236
v_mul_f32 v243, v243, v236
v_cvt_pk_bf16_f32 v5, v242, v243
v_lshlrev_b32 v242, 16, v6
v_and_b32 v243, 0xffff0000, v6
v_mul_f32 v242, v242, v236
v_mul_f32 v243, v243, v236
v_cvt_pk_bf16_f32 v6, v242, v243
v_lshlrev_b32 v242, 16, v7
v_and_b32 v243, 0xffff0000, v7
v_mul_f32 v242, v242, v236
v_mul_f32 v243, v243, v236
v_cvt_pk_bf16_f32 v7, v242, v243
v_lshlrev_b32 v242, 16, v8
v_and_b32 v243, 0xffff0000, v8
v_mul_f32 v242, v242, v236
v_mul_f32 v243, v243, v236
v_cvt_pk_bf16_f32 v8, v242, v243
v_lshlrev_b32 v242, 16, v9
v_and_b32 v243, 0xffff0000, v9
v_mul_f32 v242, v242, v236
v_mul_f32 v243, v243, v236
v_cvt_pk_bf16_f32 v9, v242, v243
v_lshlrev_b32 v242, 16, v10
v_and_b32 v243, 0xffff0000, v10
v_mul_f32 v242, v242, v236
v_mul_f32 v243, v243, v236
v_cvt_pk_bf16_f32 v10, v242, v243
v_lshlrev_b32 v242, 16, v11
v_and_b32 v243, 0xffff0000, v11
v_mul_f32 v242, v242, v236
v_mul_f32 v243, v243, v236
v_cvt_pk_bf16_f32 v11, v242, v243
v_lshlrev_b32 v242, 16, v176
v_and_b32 v243, 0xffff0000, v176
v_mul_f32 v242, v242, v236
v_mul_f32 v243, v243, v236
v_cvt_pk_bf16_f32 v176, v242, v243
v_lshlrev_b32 v242, 16, v177
v_and_b32 v243, 0xffff0000, v177
v_mul_f32 v242, v242, v236
v_mul_f32 v243, v243, v236
v_cvt_pk_bf16_f32 v177, v242, v243
v_lshlrev_b32 v242, 16, v178
v_and_b32 v243, 0xffff0000, v178
v_mul_f32 v242, v242, v236
v_mul_f32 v243, v243, v236
v_cvt_pk_bf16_f32 v178, v242, v243
v_lshlrev_b32 v242, 16, v179
v_and_b32 v243, 0xffff0000, v179
v_mul_f32 v242, v242, v236
v_mul_f32 v243, v243, v236
v_cvt_pk_bf16_f32 v179, v242, v243
v_lshlrev_b32 v242, 16, v160
v_and_b32 v243, 0xffff0000, v160
v_mul_f32 v242, v242, v236
v_mul_f32 v243, v243, v236
v_cvt_pk_bf16_f32 v160, v242, v243
v_lshlrev_b32 v242, 16, v161
v_and_b32 v243, 0xffff0000, v161
v_mul_f32 v242, v242, v236
v_mul_f32 v243, v243, v236
v_cvt_pk_bf16_f32 v161, v242, v243
v_lshlrev_b32 v242, 16, v162
v_and_b32 v243, 0xffff0000, v162
v_mul_f32 v242, v242, v236
v_mul_f32 v243, v243, v236
v_cvt_pk_bf16_f32 v162, v242, v243
v_lshlrev_b32 v242, 16, v163
v_and_b32 v243, 0xffff0000, v163
v_mul_f32 v242, v242, v236
v_mul_f32 v243, v243, v236
v_cvt_pk_bf16_f32 v163, v242, v243
v_log_f32 v243, v225
v_max3_f32 v233, v132, v133, v134
v_max3_f32 v233, v233, v135, v243
v_mov_b32 v243, v233
s_nop 1
v_permlane32_swap_b32 v233, v243
s_nop 1
v_max_f32 v233, v233, v243
v_mov_b32 v243, v233
s_nop 1
v_permlane16_swap_b32 v233, v243
s_nop 1
v_max_f32 v233, v233, v243
v_ceil_f32 v233, v233
v_max_f32 v233, 0, v233
v_sub_f32 v243, 0, v233
v_exp_f32 v237, v243
s_nop 1
v_mul_f32 v225, v225, v237
v_add_f32 v245, v245, v233
v_sub_f32 v196, v196, v233
v_sub_f32 v132, v132, v233
v_sub_f32 v148, v148, v233
v_sub_f32 v197, v197, v233
v_sub_f32 v133, v133, v233
v_sub_f32 v149, v149, v233
v_sub_f32 v198, v198, v233
v_sub_f32 v134, v134, v233
v_sub_f32 v150, v150, v233
v_sub_f32 v199, v199, v233
v_sub_f32 v135, v135, v233
v_sub_f32 v151, v151, v233
v_lshlrev_b32 v242, 16, v36
v_and_b32 v243, 0xffff0000, v36
v_mul_f32 v242, v242, v237
v_mul_f32 v243, v243, v237
v_cvt_pk_bf16_f32 v36, v242, v243
v_lshlrev_b32 v242, 16, v37
v_and_b32 v243, 0xffff0000, v37
v_mul_f32 v242, v242, v237
v_mul_f32 v243, v243, v237
v_cvt_pk_bf16_f32 v37, v242, v243
v_lshlrev_b32 v242, 16, v38
v_and_b32 v243, 0xffff0000, v38
v_mul_f32 v242, v242, v237
v_mul_f32 v243, v243, v237
v_cvt_pk_bf16_f32 v38, v242, v243
v_lshlrev_b32 v242, 16, v39
v_and_b32 v243, 0xffff0000, v39
v_mul_f32 v242, v242, v237
v_mul_f32 v243, v243, v237
v_cvt_pk_bf16_f32 v39, v242, v243
v_lshlrev_b32 v242, 16, v40
v_and_b32 v243, 0xffff0000, v40
v_mul_f32 v242, v242, v237
v_mul_f32 v243, v243, v237
v_cvt_pk_bf16_f32 v40, v242, v243
v_lshlrev_b32 v242, 16, v41
v_and_b32 v243, 0xffff0000, v41
v_mul_f32 v242, v242, v237
v_mul_f32 v243, v243, v237
v_cvt_pk_bf16_f32 v41, v242, v243
v_lshlrev_b32 v242, 16, v42
v_and_b32 v243, 0xffff0000, v42
v_mul_f32 v242, v242, v237
v_mul_f32 v243, v243, v237
v_cvt_pk_bf16_f32 v42, v242, v243
v_lshlrev_b32 v242, 16, v43
v_and_b32 v243, 0xffff0000, v43
v_mul_f32 v242, v242, v237
v_mul_f32 v243, v243, v237
v_cvt_pk_bf16_f32 v43, v242, v243
v_lshlrev_b32 v242, 16, v180
v_and_b32 v243, 0xffff0000, v180
v_mul_f32 v242, v242, v237
v_mul_f32 v243, v243, v237
v_cvt_pk_bf16_f32 v180, v242, v243
v_lshlrev_b32 v242, 16, v181
v_and_b32 v243, 0xffff0000, v181
v_mul_f32 v242, v242, v237
v_mul_f32 v243, v243, v237
v_cvt_pk_bf16_f32 v181, v242, v243
v_lshlrev_b32 v242, 16, v182
v_and_b32 v243, 0xffff0000, v182
v_mul_f32 v242, v242, v237
v_mul_f32 v243, v243, v237
v_cvt_pk_bf16_f32 v182, v242, v243
v_lshlrev_b32 v242, 16, v183
v_and_b32 v243, 0xffff0000, v183
v_mul_f32 v242, v242, v237
v_mul_f32 v243, v243, v237
v_cvt_pk_bf16_f32 v183, v242, v243
v_lshlrev_b32 v242, 16, v164
v_and_b32 v243, 0xffff0000, v164
v_mul_f32 v242, v242, v237
v_mul_f32 v243, v243, v237
v_cvt_pk_bf16_f32 v164, v242, v243
v_lshlrev_b32 v242, 16, v165
v_and_b32 v243, 0xffff0000, v165
v_mul_f32 v242, v242, v237
v_mul_f32 v243, v243, v237
v_cvt_pk_bf16_f32 v165, v242, v243
v_lshlrev_b32 v242, 16, v166
v_and_b32 v243, 0xffff0000, v166
v_mul_f32 v242, v242, v237
v_mul_f32 v243, v243, v237
v_cvt_pk_bf16_f32 v166, v242, v243
v_lshlrev_b32 v242, 16, v167
v_and_b32 v243, 0xffff0000, v167
v_mul_f32 v242, v242, v237
v_mul_f32 v243, v243, v237
v_cvt_pk_bf16_f32 v167, v242, v243
v_log_f32 v243, v226
v_max3_f32 v234, v136, v137, v138
v_max3_f32 v234, v234, v139, v243
v_mov_b32 v243, v234
s_nop 1
v_permlane32_swap_b32 v234, v243
s_nop 1
v_max_f32 v234, v234, v243
v_mov_b32 v243, v234
s_nop 1
v_permlane16_swap_b32 v234, v243
s_nop 1
v_max_f32 v234, v234, v243
v_ceil_f32 v234, v234
v_max_f32 v234, 0, v234
v_sub_f32 v243, 0, v234
v_exp_f32 v238, v243
s_nop 1
v_mul_f32 v226, v226, v238
v_add_f32 v246, v246, v234
v_sub_f32 v200, v200, v234
v_sub_f32 v136, v136, v234
v_sub_f32 v152, v152, v234
v_sub_f32 v201, v201, v234
v_sub_f32 v137, v137, v234
v_sub_f32 v153, v153, v234
v_sub_f32 v202, v202, v234
v_sub_f32 v138, v138, v234
v_sub_f32 v154, v154, v234
v_sub_f32 v203, v203, v234
v_sub_f32 v139, v139, v234
v_sub_f32 v155, v155, v234
v_lshlrev_b32 v242, 16, v68
v_and_b32 v243, 0xffff0000, v68
v_mul_f32 v242, v242, v238
v_mul_f32 v243, v243, v238
v_cvt_pk_bf16_f32 v68, v242, v243
v_lshlrev_b32 v242, 16, v69
v_and_b32 v243, 0xffff0000, v69
v_mul_f32 v242, v242, v238
v_mul_f32 v243, v243, v238
v_cvt_pk_bf16_f32 v69, v242, v243
v_lshlrev_b32 v242, 16, v70
v_and_b32 v243, 0xffff0000, v70
v_mul_f32 v242, v242, v238
v_mul_f32 v243, v243, v238
v_cvt_pk_bf16_f32 v70, v242, v243
v_lshlrev_b32 v242, 16, v71
v_and_b32 v243, 0xffff0000, v71
v_mul_f32 v242, v242, v238
v_mul_f32 v243, v243, v238
v_cvt_pk_bf16_f32 v71, v242, v243
v_lshlrev_b32 v242, 16, v72
v_and_b32 v243, 0xffff0000, v72
v_mul_f32 v242, v242, v238
v_mul_f32 v243, v243, v238
v_cvt_pk_bf16_f32 v72, v242, v243
v_lshlrev_b32 v242, 16, v73
v_and_b32 v243, 0xffff0000, v73
v_mul_f32 v242, v242, v238
v_mul_f32 v243, v243, v238
v_cvt_pk_bf16_f32 v73, v242, v243
v_lshlrev_b32 v242, 16, v74
v_and_b32 v243, 0xffff0000, v74
v_mul_f32 v242, v242, v238
v_mul_f32 v243, v243, v238
v_cvt_pk_bf16_f32 v74, v242, v243
v_lshlrev_b32 v242, 16, v75
v_and_b32 v243, 0xffff0000, v75
v_mul_f32 v242, v242, v238
v_mul_f32 v243, v243, v238
v_cvt_pk_bf16_f32 v75, v242, v243
v_lshlrev_b32 v242, 16, v184
v_and_b32 v243, 0xffff0000, v184
v_mul_f32 v242, v242, v238
v_mul_f32 v243, v243, v238
v_cvt_pk_bf16_f32 v184, v242, v243
v_lshlrev_b32 v242, 16, v185
v_and_b32 v243, 0xffff0000, v185
v_mul_f32 v242, v242, v238
v_mul_f32 v243, v243, v238
v_cvt_pk_bf16_f32 v185, v242, v243
v_lshlrev_b32 v242, 16, v186
v_and_b32 v243, 0xffff0000, v186
v_mul_f32 v242, v242, v238
v_mul_f32 v243, v243, v238
v_cvt_pk_bf16_f32 v186, v242, v243
v_lshlrev_b32 v242, 16, v187
v_and_b32 v243, 0xffff0000, v187
v_mul_f32 v242, v242, v238
v_mul_f32 v243, v243, v238
v_cvt_pk_bf16_f32 v187, v242, v243
v_lshlrev_b32 v242, 16, v168
v_and_b32 v243, 0xffff0000, v168
v_mul_f32 v242, v242, v238
v_mul_f32 v243, v243, v238
v_cvt_pk_bf16_f32 v168, v242, v243
v_lshlrev_b32 v242, 16, v169
v_and_b32 v243, 0xffff0000, v169
v_mul_f32 v242, v242, v238
v_mul_f32 v243, v243, v238
v_cvt_pk_bf16_f32 v169, v242, v243
v_lshlrev_b32 v242, 16, v170
v_and_b32 v243, 0xffff0000, v170
v_mul_f32 v242, v242, v238
v_mul_f32 v243, v243, v238
v_cvt_pk_bf16_f32 v170, v242, v243
v_lshlrev_b32 v242, 16, v171
v_and_b32 v243, 0xffff0000, v171
v_mul_f32 v242, v242, v238
v_mul_f32 v243, v243, v238
v_cvt_pk_bf16_f32 v171, v242, v243
v_log_f32 v243, v227
v_max3_f32 v235, v140, v141, v142
v_max3_f32 v235, v235, v143, v243
v_mov_b32 v243, v235
s_nop 1
v_permlane32_swap_b32 v235, v243
s_nop 1
v_max_f32 v235, v235, v243
v_mov_b32 v243, v235
s_nop 1
v_permlane16_swap_b32 v235, v243
s_nop 1
v_max_f32 v235, v235, v243
v_ceil_f32 v235, v235
v_max_f32 v235, 0, v235
v_sub_f32 v243, 0, v235
v_exp_f32 v239, v243
s_nop 1
v_mul_f32 v227, v227, v239
v_add_f32 v247, v247, v235
v_sub_f32 v204, v204, v235
v_sub_f32 v140, v140, v235
v_sub_f32 v156, v156, v235
v_sub_f32 v205, v205, v235
v_sub_f32 v141, v141, v235
v_sub_f32 v157, v157, v235
v_sub_f32 v206, v206, v235
v_sub_f32 v142, v142, v235
v_sub_f32 v158, v158, v235
v_sub_f32 v207, v207, v235
v_sub_f32 v143, v143, v235
v_sub_f32 v159, v159, v235
v_lshlrev_b32 v242, 16, v100
v_and_b32 v243, 0xffff0000, v100
v_mul_f32 v242, v242, v239
v_mul_f32 v243, v243, v239
v_cvt_pk_bf16_f32 v100, v242, v243
v_lshlrev_b32 v242, 16, v101
v_and_b32 v243, 0xffff0000, v101
v_mul_f32 v242, v242, v239
v_mul_f32 v243, v243, v239
v_cvt_pk_bf16_f32 v101, v242, v243
v_lshlrev_b32 v242, 16, v102
v_and_b32 v243, 0xffff0000, v102
v_mul_f32 v242, v242, v239
v_mul_f32 v243, v243, v239
v_cvt_pk_bf16_f32 v102, v242, v243
v_lshlrev_b32 v242, 16, v103
v_and_b32 v243, 0xffff0000, v103
v_mul_f32 v242, v242, v239
v_mul_f32 v243, v243, v239
v_cvt_pk_bf16_f32 v103, v242, v243
v_lshlrev_b32 v242, 16, v104
v_and_b32 v243, 0xffff0000, v104
v_mul_f32 v242, v242, v239
v_mul_f32 v243, v243, v239
v_cvt_pk_bf16_f32 v104, v242, v243
v_lshlrev_b32 v242, 16, v105
v_and_b32 v243, 0xffff0000, v105
v_mul_f32 v242, v242, v239
v_mul_f32 v243, v243, v239
v_cvt_pk_bf16_f32 v105, v242, v243
v_lshlrev_b32 v242, 16, v106
v_and_b32 v243, 0xffff0000, v106
v_mul_f32 v242, v242, v239
v_mul_f32 v243, v243, v239
v_cvt_pk_bf16_f32 v106, v242, v243
v_lshlrev_b32 v242, 16, v107
v_and_b32 v243, 0xffff0000, v107
v_mul_f32 v242, v242, v239
v_mul_f32 v243, v243, v239
v_cvt_pk_bf16_f32 v107, v242, v243
v_lshlrev_b32 v242, 16, v188
v_and_b32 v243, 0xffff0000, v188
v_mul_f32 v242, v242, v239
v_mul_f32 v243, v243, v239
v_cvt_pk_bf16_f32 v188, v242, v243
v_lshlrev_b32 v242, 16, v189
v_and_b32 v243, 0xffff0000, v189
v_mul_f32 v242, v242, v239
v_mul_f32 v243, v243, v239
v_cvt_pk_bf16_f32 v189, v242, v243
v_lshlrev_b32 v242, 16, v190
v_and_b32 v243, 0xffff0000, v190
v_mul_f32 v242, v242, v239
v_mul_f32 v243, v243, v239
v_cvt_pk_bf16_f32 v190, v242, v243
v_lshlrev_b32 v242, 16, v191
v_and_b32 v243, 0xffff0000, v191
v_mul_f32 v242, v242, v239
v_mul_f32 v243, v243, v239
v_cvt_pk_bf16_f32 v191, v242, v243
v_lshlrev_b32 v242, 16, v172
v_and_b32 v243, 0xffff0000, v172
v_mul_f32 v242, v242, v239
v_mul_f32 v243, v243, v239
v_cvt_pk_bf16_f32 v172, v242, v243
v_lshlrev_b32 v242, 16, v173
v_and_b32 v243, 0xffff0000, v173
v_mul_f32 v242, v242, v239
v_mul_f32 v243, v243, v239
v_cvt_pk_bf16_f32 v173, v242, v243
v_lshlrev_b32 v242, 16, v174
v_and_b32 v243, 0xffff0000, v174
v_mul_f32 v242, v242, v239
v_mul_f32 v243, v243, v239
v_cvt_pk_bf16_f32 v174, v242, v243
v_lshlrev_b32 v242, 16, v175
v_and_b32 v243, 0xffff0000, v175
v_mul_f32 v242, v242, v239
v_mul_f32 v243, v243, v239
v_cvt_pk_bf16_f32 v175, v242, v243
v_exp_f32 v232, v128
v_exp_f32 v233, v129
v_exp_f32 v234, v130
v_exp_f32 v235, v131
s_nop 1
v_add_f32 v228, v224, v232
v_add_f32 v228, v228, v233
v_add_f32 v228, v228, v234
v_add_f32 v228, v228, v235
v_cvt_pk_bf16_f32 v0, v232, v233
v_cvt_pk_bf16_f32 v1, v234, v235
v_exp_f32 v232, v132
v_exp_f32 v233, v133
v_exp_f32 v234, v134
v_exp_f32 v235, v135
s_nop 1
v_add_f32 v229, v225, v232
v_add_f32 v229, v229, v233
v_add_f32 v229, v229, v234
v_add_f32 v229, v229, v235
v_cvt_pk_bf16_f32 v32, v232, v233
v_cvt_pk_bf16_f32 v33, v234, v235
v_exp_f32 v232, v136
v_exp_f32 v233, v137
v_exp_f32 v234, v138
v_exp_f32 v235, v139
s_nop 1
v_add_f32 v230, v226, v232
v_add_f32 v230, v230, v233
v_add_f32 v230, v230, v234
v_add_f32 v230, v230, v235
v_cvt_pk_bf16_f32 v64, v232, v233
v_cvt_pk_bf16_f32 v65, v234, v235
v_exp_f32 v232, v140
v_exp_f32 v233, v141
v_exp_f32 v234, v142
v_exp_f32 v235, v143
s_nop 1
v_add_f32 v231, v227, v232
v_add_f32 v231, v231, v233
v_add_f32 v231, v231, v234
v_add_f32 v231, v231, v235
v_cvt_pk_bf16_f32 v96, v232, v233
v_cvt_pk_bf16_f32 v97, v234, v235
s_branch L2_rare_common
L2_rare_site19:
s_mov_b32 s36, 19
s_branch L2_rare_t1_7_1
L2_rare_t1_7_1:
s_nop 15
s_nop 15
s_waitcnt lgkmcnt(0)
v_log_f32 v243, v228
v_max3_f32 v232, v144, v145, v146
v_max3_f32 v232, v232, v147, v243
v_mov_b32 v243, v232
s_nop 1
v_permlane32_swap_b32 v232, v243
s_nop 1
v_max_f32 v232, v232, v243
v_mov_b32 v243, v232
s_nop 1
v_permlane16_swap_b32 v232, v243
s_nop 1
v_max_f32 v232, v232, v243
v_ceil_f32 v232, v232
v_max_f32 v232, 0, v232
v_sub_f32 v243, 0, v232
v_exp_f32 v236, v243
s_nop 1
v_mul_f32 v228, v228, v236
v_add_f32 v244, v244, v232
v_sub_f32 v192, v192, v232
v_sub_f32 v128, v128, v232
v_sub_f32 v144, v144, v232
v_sub_f32 v193, v193, v232
v_sub_f32 v129, v129, v232
v_sub_f32 v145, v145, v232
v_sub_f32 v194, v194, v232
v_sub_f32 v130, v130, v232
v_sub_f32 v146, v146, v232
v_sub_f32 v195, v195, v232
v_sub_f32 v131, v131, v232
v_sub_f32 v147, v147, v232
v_lshlrev_b32 v242, 16, v4
v_and_b32 v243, 0xffff0000, v4
v_mul_f32 v242, v242, v236
v_mul_f32 v243, v243, v236
v_cvt_pk_bf16_f32 v4, v242, v243
v_lshlrev_b32 v242, 16, v5
v_and_b32 v243, 0xffff0000, v5
v_mul_f32 v242, v242, v236
v_mul_f32 v243, v243, v236
v_cvt_pk_bf16_f32 v5, v242, v243
v_lshlrev_b32 v242, 16, v6
v_and_b32 v243, 0xffff0000, v6
v_mul_f32 v242, v242, v236
v_mul_f32 v243, v243, v236
v_cvt_pk_bf16_f32 v6, v242, v243
v_lshlrev_b32 v242, 16, v7
v_and_b32 v243, 0xffff0000, v7
v_mul_f32 v242, v242, v236
v_mul_f32 v243, v243, v236
v_cvt_pk_bf16_f32 v7, v242, v243
v_lshlrev_b32 v242, 16, v8
v_and_b32 v243, 0xffff0000, v8
v_mul_f32 v242, v242, v236
v_mul_f32 v243, v243, v236
v_cvt_pk_bf16_f32 v8, v242, v243
v_lshlrev_b32 v242, 16, v9
v_and_b32 v243, 0xffff0000, v9
v_mul_f32 v242, v242, v236
v_mul_f32 v243, v243, v236
v_cvt_pk_bf16_f32 v9, v242, v243
v_lshlrev_b32 v242, 16, v10
v_and_b32 v243, 0xffff0000, v10
v_mul_f32 v242, v242, v236
v_mul_f32 v243, v243, v236
v_cvt_pk_bf16_f32 v10, v242, v243
v_lshlrev_b32 v242, 16, v11
v_and_b32 v243, 0xffff0000, v11
v_mul_f32 v242, v242, v236
v_mul_f32 v243, v243, v236
v_cvt_pk_bf16_f32 v11, v242, v243
v_lshlrev_b32 v242, 16, v176
v_and_b32 v243, 0xffff0000, v176
v_mul_f32 v242, v242, v236
v_mul_f32 v243, v243, v236
v_cvt_pk_bf16_f32 v176, v242, v243
v_lshlrev_b32 v242, 16, v177
v_and_b32 v243, 0xffff0000, v177
v_mul_f32 v242, v242, v236
v_mul_f32 v243, v243, v236
v_cvt_pk_bf16_f32 v177, v242, v243
v_lshlrev_b32 v242, 16, v178
v_and_b32 v243, 0xffff0000, v178
v_mul_f32 v242, v242, v236
v_mul_f32 v243, v243, v236
v_cvt_pk_bf16_f32 v178, v242, v243
v_lshlrev_b32 v242, 16, v179
v_and_b32 v243, 0xffff0000, v179
v_mul_f32 v242, v242, v236
v_mul_f32 v243, v243, v236
v_cvt_pk_bf16_f32 v179, v242, v243
v_lshlrev_b32 v242, 16, v160
v_and_b32 v243, 0xffff0000, v160
v_mul_f32 v242, v242, v236
v_mul_f32 v243, v243, v236
v_cvt_pk_bf16_f32 v160, v242, v243
v_lshlrev_b32 v242, 16, v161
v_and_b32 v243, 0xffff0000, v161
v_mul_f32 v242, v242, v236
v_mul_f32 v243, v243, v236
v_cvt_pk_bf16_f32 v161, v242, v243
v_lshlrev_b32 v242, 16, v162
v_and_b32 v243, 0xffff0000, v162
v_mul_f32 v242, v242, v236
v_mul_f32 v243, v243, v236
v_cvt_pk_bf16_f32 v162, v242, v243
v_lshlrev_b32 v242, 16, v163
v_and_b32 v243, 0xffff0000, v163
v_mul_f32 v242, v242, v236
v_mul_f32 v243, v243, v236
v_cvt_pk_bf16_f32 v163, v242, v243
v_lshlrev_b32 v242, 16, v0
v_and_b32 v243, 0xffff0000, v0
v_mul_f32 v242, v242, v236
v_mul_f32 v243, v243, v236
v_cvt_pk_bf16_f32 v0, v242, v243
v_lshlrev_b32 v242, 16, v1
v_and_b32 v243, 0xffff0000, v1
v_mul_f32 v242, v242, v236
v_mul_f32 v243, v243, v236
v_cvt_pk_bf16_f32 v1, v242, v243
v_log_f32 v243, v229
v_max3_f32 v233, v148, v149, v150
v_max3_f32 v233, v233, v151, v243
v_mov_b32 v243, v233
s_nop 1
v_permlane32_swap_b32 v233, v243
s_nop 1
v_max_f32 v233, v233, v243
v_mov_b32 v243, v233
s_nop 1
v_permlane16_swap_b32 v233, v243
s_nop 1
v_max_f32 v233, v233, v243
v_ceil_f32 v233, v233
v_max_f32 v233, 0, v233
v_sub_f32 v243, 0, v233
v_exp_f32 v237, v243
s_nop 1
v_mul_f32 v229, v229, v237
v_add_f32 v245, v245, v233
v_sub_f32 v196, v196, v233
v_sub_f32 v132, v132, v233
v_sub_f32 v148, v148, v233
v_sub_f32 v197, v197, v233
v_sub_f32 v133, v133, v233
v_sub_f32 v149, v149, v233
v_sub_f32 v198, v198, v233
v_sub_f32 v134, v134, v233
v_sub_f32 v150, v150, v233
v_sub_f32 v199, v199, v233
v_sub_f32 v135, v135, v233
v_sub_f32 v151, v151, v233
v_lshlrev_b32 v242, 16, v36
v_and_b32 v243, 0xffff0000, v36
v_mul_f32 v242, v242, v237
v_mul_f32 v243, v243, v237
v_cvt_pk_bf16_f32 v36, v242, v243
v_lshlrev_b32 v242, 16, v37
v_and_b32 v243, 0xffff0000, v37
v_mul_f32 v242, v242, v237
v_mul_f32 v243, v243, v237
v_cvt_pk_bf16_f32 v37, v242, v243
v_lshlrev_b32 v242, 16, v38
v_and_b32 v243, 0xffff0000, v38
v_mul_f32 v242, v242, v237
v_mul_f32 v243, v243, v237
v_cvt_pk_bf16_f32 v38, v242, v243
v_lshlrev_b32 v242, 16, v39
v_and_b32 v243, 0xffff0000, v39
v_mul_f32 v242, v242, v237
v_mul_f32 v243, v243, v237
v_cvt_pk_bf16_f32 v39, v242, v243
v_lshlrev_b32 v242, 16, v40
v_and_b32 v243, 0xffff0000, v40
v_mul_f32 v242, v242, v237
v_mul_f32 v243, v243, v237
v_cvt_pk_bf16_f32 v40, v242, v243
v_lshlrev_b32 v242, 16, v41
v_and_b32 v243, 0xffff0000, v41
v_mul_f32 v242, v242, v237
v_mul_f32 v243, v243, v237
v_cvt_pk_bf16_f32 v41, v242, v243
v_lshlrev_b32 v242, 16, v42
v_and_b32 v243, 0xffff0000, v42
v_mul_f32 v242, v242, v237
v_mul_f32 v243, v243, v237
v_cvt_pk_bf16_f32 v42, v242, v243
v_lshlrev_b32 v242, 16, v43
v_and_b32 v243, 0xffff0000, v43
v_mul_f32 v242, v242, v237
v_mul_f32 v243, v243, v237
v_cvt_pk_bf16_f32 v43, v242, v243
v_lshlrev_b32 v242, 16, v180
v_and_b32 v243, 0xffff0000, v180
v_mul_f32 v242, v242, v237
v_mul_f32 v243, v243, v237
v_cvt_pk_bf16_f32 v180, v242, v243
v_lshlrev_b32 v242, 16, v181
v_and_b32 v243, 0xffff0000, v181
v_mul_f32 v242, v242, v237
v_mul_f32 v243, v243, v237
v_cvt_pk_bf16_f32 v181, v242, v243
v_lshlrev_b32 v242, 16, v182
v_and_b32 v243, 0xffff0000, v182
v_mul_f32 v242, v242, v237
v_mul_f32 v243, v243, v237
v_cvt_pk_bf16_f32 v182, v242, v243
v_lshlrev_b32 v242, 16, v183
v_and_b32 v243, 0xffff0000, v183
v_mul_f32 v242, v242, v237
v_mul_f32 v243, v243, v237
v_cvt_pk_bf16_f32 v183, v242, v243
v_lshlrev_b32 v242, 16, v164
v_and_b32 v243, 0xffff0000, v164
v_mul_f32 v242, v242, v237
v_mul_f32 v243, v243, v237
v_cvt_pk_bf16_f32 v164, v242, v243
v_lshlrev_b32 v242, 16, v165
v_and_b32 v243, 0xffff0000, v165
v_mul_f32 v242, v242, v237
v_mul_f32 v243, v243, v237
v_cvt_pk_bf16_f32 v165, v242, v243
v_lshlrev_b32 v242, 16, v166
v_and_b32 v243, 0xffff0000, v166
v_mul_f32 v242, v242, v237
v_mul_f32 v243, v243, v237
v_cvt_pk_bf16_f32 v166, v242, v243
v_lshlrev_b32 v242, 16, v167
v_and_b32 v243, 0xffff0000, v167
v_mul_f32 v242, v242, v237
v_mul_f32 v243, v243, v237
v_cvt_pk_bf16_f32 v167, v242, v243
v_lshlrev_b32 v242, 16, v32
v_and_b32 v243, 0xffff0000, v32
v_mul_f32 v242, v242, v237
v_mul_f32 v243, v243, v237
v_cvt_pk_bf16_f32 v32, v242, v243
v_lshlrev_b32 v242, 16, v33
v_and_b32 v243, 0xffff0000, v33
v_mul_f32 v242, v242, v237
v_mul_f32 v243, v243, v237
v_cvt_pk_bf16_f32 v33, v242, v243
v_log_f32 v243, v230
v_max3_f32 v234, v152, v153, v154
v_max3_f32 v234, v234, v155, v243
v_mov_b32 v243, v234
s_nop 1
v_permlane32_swap_b32 v234, v243
s_nop 1
v_max_f32 v234, v234, v243
v_mov_b32 v243, v234
s_nop 1
v_permlane16_swap_b32 v234, v243
s_nop 1
v_max_f32 v234, v234, v243
v_ceil_f32 v234, v234
v_max_f32 v234, 0, v234
v_sub_f32 v243, 0, v234
v_exp_f32 v238, v243
s_nop 1
v_mul_f32 v230, v230, v238
v_add_f32 v246, v246, v234
v_sub_f32 v200, v200, v234
v_sub_f32 v136, v136, v234
v_sub_f32 v152, v152, v234
v_sub_f32 v201, v201, v234
v_sub_f32 v137, v137, v234
v_sub_f32 v153, v153, v234
v_sub_f32 v202, v202, v234
v_sub_f32 v138, v138, v234
v_sub_f32 v154, v154, v234
v_sub_f32 v203, v203, v234
v_sub_f32 v139, v139, v234
v_sub_f32 v155, v155, v234
v_lshlrev_b32 v242, 16, v68
v_and_b32 v243, 0xffff0000, v68
v_mul_f32 v242, v242, v238
v_mul_f32 v243, v243, v238
v_cvt_pk_bf16_f32 v68, v242, v243
v_lshlrev_b32 v242, 16, v69
v_and_b32 v243, 0xffff0000, v69
v_mul_f32 v242, v242, v238
v_mul_f32 v243, v243, v238
v_cvt_pk_bf16_f32 v69, v242, v243
v_lshlrev_b32 v242, 16, v70
v_and_b32 v243, 0xffff0000, v70
v_mul_f32 v242, v242, v238
v_mul_f32 v243, v243, v238
v_cvt_pk_bf16_f32 v70, v242, v243
v_lshlrev_b32 v242, 16, v71
v_and_b32 v243, 0xffff0000, v71
v_mul_f32 v242, v242, v238
v_mul_f32 v243, v243, v238
v_cvt_pk_bf16_f32 v71, v242, v243
v_lshlrev_b32 v242, 16, v72
v_and_b32 v243, 0xffff0000, v72
v_mul_f32 v242, v242, v238
v_mul_f32 v243, v243, v238
v_cvt_pk_bf16_f32 v72, v242, v243
v_lshlrev_b32 v242, 16, v73
v_and_b32 v243, 0xffff0000, v73
v_mul_f32 v242, v242, v238
v_mul_f32 v243, v243, v238
v_cvt_pk_bf16_f32 v73, v242, v243
v_lshlrev_b32 v242, 16, v74
v_and_b32 v243, 0xffff0000, v74
v_mul_f32 v242, v242, v238
v_mul_f32 v243, v243, v238
v_cvt_pk_bf16_f32 v74, v242, v243
v_lshlrev_b32 v242, 16, v75
v_and_b32 v243, 0xffff0000, v75
v_mul_f32 v242, v242, v238
v_mul_f32 v243, v243, v238
v_cvt_pk_bf16_f32 v75, v242, v243
v_lshlrev_b32 v242, 16, v184
v_and_b32 v243, 0xffff0000, v184
v_mul_f32 v242, v242, v238
v_mul_f32 v243, v243, v238
v_cvt_pk_bf16_f32 v184, v242, v243
v_lshlrev_b32 v242, 16, v185
v_and_b32 v243, 0xffff0000, v185
v_mul_f32 v242, v242, v238
v_mul_f32 v243, v243, v238
v_cvt_pk_bf16_f32 v185, v242, v243
v_lshlrev_b32 v242, 16, v186
v_and_b32 v243, 0xffff0000, v186
v_mul_f32 v242, v242, v238
v_mul_f32 v243, v243, v238
v_cvt_pk_bf16_f32 v186, v242, v243
v_lshlrev_b32 v242, 16, v187
v_and_b32 v243, 0xffff0000, v187
v_mul_f32 v242, v242, v238
v_mul_f32 v243, v243, v238
v_cvt_pk_bf16_f32 v187, v242, v243
v_lshlrev_b32 v242, 16, v168
v_and_b32 v243, 0xffff0000, v168
v_mul_f32 v242, v242, v238
v_mul_f32 v243, v243, v238
v_cvt_pk_bf16_f32 v168, v242, v243
v_lshlrev_b32 v242, 16, v169
v_and_b32 v243, 0xffff0000, v169
v_mul_f32 v242, v242, v238
v_mul_f32 v243, v243, v238
v_cvt_pk_bf16_f32 v169, v242, v243
v_lshlrev_b32 v242, 16, v170
v_and_b32 v243, 0xffff0000, v170
v_mul_f32 v242, v242, v238
v_mul_f32 v243, v243, v238
v_cvt_pk_bf16_f32 v170, v242, v243
v_lshlrev_b32 v242, 16, v171
v_and_b32 v243, 0xffff0000, v171
v_mul_f32 v242, v242, v238
v_mul_f32 v243, v243, v238
v_cvt_pk_bf16_f32 v171, v242, v243
v_lshlrev_b32 v242, 16, v64
v_and_b32 v243, 0xffff0000, v64
v_mul_f32 v242, v242, v238
v_mul_f32 v243, v243, v238
v_cvt_pk_bf16_f32 v64, v242, v243
v_lshlrev_b32 v242, 16, v65
v_and_b32 v243, 0xffff0000, v65
v_mul_f32 v242, v242, v238
v_mul_f32 v243, v243, v238
v_cvt_pk_bf16_f32 v65, v242, v243
v_log_f32 v243, v231
v_max3_f32 v235, v156, v157, v158
v_max3_f32 v235, v235, v159, v243
v_mov_b32 v243, v235
s_nop 1
v_permlane32_swap_b32 v235, v243
s_nop 1
v_max_f32 v235, v235, v243
v_mov_b32 v243, v235
s_nop 1
v_permlane16_swap_b32 v235, v243
s_nop 1
v_max_f32 v235, v235, v243
v_ceil_f32 v235, v235
v_max_f32 v235, 0, v235
v_sub_f32 v243, 0, v235
v_exp_f32 v239, v243
s_nop 1
v_mul_f32 v231, v231, v239
v_add_f32 v247, v247, v235
v_sub_f32 v204, v204, v235
v_sub_f32 v140, v140, v235
v_sub_f32 v156, v156, v235
v_sub_f32 v205, v205, v235
v_sub_f32 v141, v141, v235
v_sub_f32 v157, v157, v235
v_sub_f32 v206, v206, v235
v_sub_f32 v142, v142, v235
v_sub_f32 v158, v158, v235
v_sub_f32 v207, v207, v235
v_sub_f32 v143, v143, v235
v_sub_f32 v159, v159, v235
v_lshlrev_b32 v242, 16, v100
v_and_b32 v243, 0xffff0000, v100
v_mul_f32 v242, v242, v239
v_mul_f32 v243, v243, v239
v_cvt_pk_bf16_f32 v100, v242, v243
v_lshlrev_b32 v242, 16, v101
v_and_b32 v243, 0xffff0000, v101
v_mul_f32 v242, v242, v239
v_mul_f32 v243, v243, v239
v_cvt_pk_bf16_f32 v101, v242, v243
v_lshlrev_b32 v242, 16, v102
v_and_b32 v243, 0xffff0000, v102
v_mul_f32 v242, v242, v239
v_mul_f32 v243, v243, v239
v_cvt_pk_bf16_f32 v102, v242, v243
v_lshlrev_b32 v242, 16, v103
v_and_b32 v243, 0xffff0000, v103
v_mul_f32 v242, v242, v239
v_mul_f32 v243, v243, v239
v_cvt_pk_bf16_f32 v103, v242, v243
v_lshlrev_b32 v242, 16, v104
v_and_b32 v243, 0xffff0000, v104
v_mul_f32 v242, v242, v239
v_mul_f32 v243, v243, v239
v_cvt_pk_bf16_f32 v104, v242, v243
v_lshlrev_b32 v242, 16, v105
v_and_b32 v243, 0xffff0000, v105
v_mul_f32 v242, v242, v239
v_mul_f32 v243, v243, v239
v_cvt_pk_bf16_f32 v105, v242, v243
v_lshlrev_b32 v242, 16, v106
v_and_b32 v243, 0xffff0000, v106
v_mul_f32 v242, v242, v239
v_mul_f32 v243, v243, v239
v_cvt_pk_bf16_f32 v106, v242, v243
v_lshlrev_b32 v242, 16, v107
v_and_b32 v243, 0xffff0000, v107
v_mul_f32 v242, v242, v239
v_mul_f32 v243, v243, v239
v_cvt_pk_bf16_f32 v107, v242, v243
v_lshlrev_b32 v242, 16, v188
v_and_b32 v243, 0xffff0000, v188
v_mul_f32 v242, v242, v239
v_mul_f32 v243, v243, v239
v_cvt_pk_bf16_f32 v188, v242, v243
v_lshlrev_b32 v242, 16, v189
v_and_b32 v243, 0xffff0000, v189
v_mul_f32 v242, v242, v239
v_mul_f32 v243, v243, v239
v_cvt_pk_bf16_f32 v189, v242, v243
v_lshlrev_b32 v242, 16, v190
v_and_b32 v243, 0xffff0000, v190
v_mul_f32 v242, v242, v239
v_mul_f32 v243, v243, v239
v_cvt_pk_bf16_f32 v190, v242, v243
v_lshlrev_b32 v242, 16, v191
v_and_b32 v243, 0xffff0000, v191
v_mul_f32 v242, v242, v239
v_mul_f32 v243, v243, v239
v_cvt_pk_bf16_f32 v191, v242, v243
v_lshlrev_b32 v242, 16, v172
v_and_b32 v243, 0xffff0000, v172
v_mul_f32 v242, v242, v239
v_mul_f32 v243, v243, v239
v_cvt_pk_bf16_f32 v172, v242, v243
v_lshlrev_b32 v242, 16, v173
v_and_b32 v243, 0xffff0000, v173
v_mul_f32 v242, v242, v239
v_mul_f32 v243, v243, v239
v_cvt_pk_bf16_f32 v173, v242, v243
v_lshlrev_b32 v242, 16, v174
v_and_b32 v243, 0xffff0000, v174
v_mul_f32 v242, v242, v239
v_mul_f32 v243, v243, v239
v_cvt_pk_bf16_f32 v174, v242, v243
v_lshlrev_b32 v242, 16, v175
v_and_b32 v243, 0xffff0000, v175
v_mul_f32 v242, v242, v239
v_mul_f32 v243, v243, v239
v_cvt_pk_bf16_f32 v175, v242, v243
v_lshlrev_b32 v242, 16, v96
v_and_b32 v243, 0xffff0000, v96
v_mul_f32 v242, v242, v239
v_mul_f32 v243, v243, v239
v_cvt_pk_bf16_f32 v96, v242, v243
v_lshlrev_b32 v242, 16, v97
v_and_b32 v243, 0xffff0000, v97
v_mul_f32 v242, v242, v239
v_mul_f32 v243, v243, v239
v_cvt_pk_bf16_f32 v97, v242, v243
v_exp_f32 v232, v144
v_exp_f32 v233, v145
v_exp_f32 v234, v146
v_exp_f32 v235, v147
s_nop 1
v_add_f32 v224, v228, v232
v_add_f32 v224, v224, v233
v_add_f32 v224, v224, v234
v_add_f32 v224, v224, v235
v_cvt_pk_bf16_f32 v2, v232, v233
v_cvt_pk_bf16_f32 v3, v234, v235
v_exp_f32 v232, v148
v_exp_f32 v233, v149
v_exp_f32 v234, v150
v_exp_f32 v235, v151
s_nop 1
v_add_f32 v225, v229, v232
v_add_f32 v225, v225, v233
v_add_f32 v225, v225, v234
v_add_f32 v225, v225, v235
v_cvt_pk_bf16_f32 v34, v232, v233
v_cvt_pk_bf16_f32 v35, v234, v235
v_exp_f32 v232, v152
v_exp_f32 v233, v153
v_exp_f32 v234, v154
v_exp_f32 v235, v155
s_nop 1
v_add_f32 v226, v230, v232
v_add_f32 v226, v226, v233
v_add_f32 v226, v226, v234
v_add_f32 v226, v226, v235
v_cvt_pk_bf16_f32 v66, v232, v233
v_cvt_pk_bf16_f32 v67, v234, v235
v_exp_f32 v232, v156
v_exp_f32 v233, v157
v_exp_f32 v234, v158
v_exp_f32 v235, v159
s_nop 1
v_add_f32 v227, v231, v232
v_add_f32 v227, v227, v233
v_add_f32 v227, v227, v234
v_add_f32 v227, v227, v235
v_cvt_pk_bf16_f32 v98, v232, v233
v_cvt_pk_bf16_f32 v99, v234, v235
s_branch L2_rare_common
LF_hl_1:
s_mov_b32 s94, 0x10000
s_mov_b32 s3, 0x7c28000
LF_hl2_1:
v_lshlrev_b32 v241, 3, v248
buffer_load_dwordx2 v[240:241], v241, s[16:19], s3 offen sc1
s_sub_u32 s94, s94, 1
s_waitcnt vmcnt(0)
s_cbranch_scc1 LF_hlret_1
v_cmp_ne_u64_e64 s[38:39], s[98:99], v[240:241]
s_and_b64 s[38:39], s[38:39], s[96:97]
s_cbranch_scc1 LF_hl2_1
s_branch LF_hlret_1
L2_rare_common:
v_lshrrev_b32 v232, 4, v248
v_and_b32 v232, 0x30, v232
ds_bpermute_b32 v242, v232, v236 offset:0
ds_bpermute_b32 v243, v232, v236 offset:4
ds_bpermute_b32 v254, v232, v236 offset:8
ds_bpermute_b32 v255, v232, v236 offset:12
s_waitcnt lgkmcnt(0)
v_accvgpr_read_b32 v232, a0
v_accvgpr_read_b32 v233, a1
v_accvgpr_read_b32 v234, a2
v_accvgpr_read_b32 v235, a3
v_mul_f32 v232, v232, v242
v_mul_f32 v233, v233, v243
v_mul_f32 v234, v234, v254
v_mul_f32 v235, v235, v255
v_accvgpr_write_b32 a0, v232
v_accvgpr_write_b32 a1, v233
v_accvgpr_write_b32 a2, v234
v_accvgpr_write_b32 a3, v235
v_accvgpr_read_b32 v232, a16
v_accvgpr_read_b32 v233, a17
v_accvgpr_read_b32 v234, a18
v_accvgpr_read_b32 v235, a19
v_mul_f32 v232, v232, v242
v_mul_f32 v233, v233, v243
v_mul_f32 v234, v234, v254
v_mul_f32 v235, v235, v255
v_accvgpr_write_b32 a16, v232
v_accvgpr_write_b32 a17, v233
v_accvgpr_write_b32 a18, v234
v_accvgpr_write_b32 a19, v235
v_accvgpr_read_b32 v232, a32
v_accvgpr_read_b32 v233, a33
v_accvgpr_read_b32 v234, a34
v_accvgpr_read_b32 v235, a35
v_mul_f32 v232, v232, v242
v_mul_f32 v233, v233, v243
v_mul_f32 v234, v234, v254
v_mul_f32 v235, v235, v255
v_accvgpr_write_b32 a32, v232
v_accvgpr_write_b32 a33, v233
v_accvgpr_write_b32 a34, v234
v_accvgpr_write_b32 a35, v235
v_accvgpr_read_b32 v232, a48
v_accvgpr_read_b32 v233, a49
v_accvgpr_read_b32 v234, a50
v_accvgpr_read_b32 v235, a51
v_mul_f32 v232, v232, v242
v_mul_f32 v233, v233, v243
v_mul_f32 v234, v234, v254
v_mul_f32 v235, v235, v255
v_accvgpr_write_b32 a48, v232
v_accvgpr_write_b32 a49, v233
v_accvgpr_write_b32 a50, v234
v_accvgpr_write_b32 a51, v235
v_accvgpr_read_b32 v232, a64
v_accvgpr_read_b32 v233, a65
v_accvgpr_read_b32 v234, a66
v_accvgpr_read_b32 v235, a67
v_mul_f32 v232, v232, v242
v_mul_f32 v233, v233, v243
v_mul_f32 v234, v234, v254
v_mul_f32 v235, v235, v255
v_accvgpr_write_b32 a64, v232
v_accvgpr_write_b32 a65, v233
v_accvgpr_write_b32 a66, v234
v_accvgpr_write_b32 a67, v235
v_accvgpr_read_b32 v232, a80
v_accvgpr_read_b32 v233, a81
v_accvgpr_read_b32 v234, a82
v_accvgpr_read_b32 v235, a83
v_mul_f32 v232, v232, v242
v_mul_f32 v233, v233, v243
v_mul_f32 v234, v234, v254
v_mul_f32 v235, v235, v255
v_accvgpr_write_b32 a80, v232
v_accvgpr_write_b32 a81, v233
v_accvgpr_write_b32 a82, v234
v_accvgpr_write_b32 a83, v235
v_accvgpr_read_b32 v232, a96
v_accvgpr_read_b32 v233, a97
v_accvgpr_read_b32 v234, a98
v_accvgpr_read_b32 v235, a99
v_mul_f32 v232, v232, v242
v_mul_f32 v233, v233, v243
v_mul_f32 v234, v234, v254
v_mul_f32 v235, v235, v255
v_accvgpr_write_b32 a96, v232
v_accvgpr_write_b32 a97, v233
v_accvgpr_write_b32 a98, v234
v_accvgpr_write_b32 a99, v235
v_accvgpr_read_b32 v232, a112
v_accvgpr_read_b32 v233, a113
v_accvgpr_read_b32 v234, a114
v_accvgpr_read_b32 v235, a115
v_mul_f32 v232, v232, v242
v_mul_f32 v233, v233, v243
v_mul_f32 v234, v234, v254
v_mul_f32 v235, v235, v255
v_accvgpr_write_b32 a112, v232
v_accvgpr_write_b32 a113, v233
v_accvgpr_write_b32 a114, v234
v_accvgpr_write_b32 a115, v235
v_accvgpr_read_b32 v232, a128
v_accvgpr_read_b32 v233, a129
v_accvgpr_read_b32 v234, a130
v_accvgpr_read_b32 v235, a131
v_mul_f32 v232, v232, v242
v_mul_f32 v233, v233, v243
v_mul_f32 v234, v234, v254
v_mul_f32 v235, v235, v255
v_accvgpr_write_b32 a128, v232
v_accvgpr_write_b32 a129, v233
v_accvgpr_write_b32 a130, v234
v_accvgpr_write_b32 a131, v235
v_accvgpr_read_b32 v232, a144
v_accvgpr_read_b32 v233, a145
v_accvgpr_read_b32 v234, a146
v_accvgpr_read_b32 v235, a147
v_mul_f32 v232, v232, v242
v_mul_f32 v233, v233, v243
v_mul_f32 v234, v234, v254
v_mul_f32 v235, v235, v255
v_accvgpr_write_b32 a144, v232
v_accvgpr_write_b32 a145, v233
v_accvgpr_write_b32 a146, v234
v_accvgpr_write_b32 a147, v235
v_accvgpr_read_b32 v232, a160
v_accvgpr_read_b32 v233, a161
v_accvgpr_read_b32 v234, a162
v_accvgpr_read_b32 v235, a163
v_mul_f32 v232, v232, v242
v_mul_f32 v233, v233, v243
v_mul_f32 v234, v234, v254
v_mul_f32 v235, v235, v255
v_accvgpr_write_b32 a160, v232
v_accvgpr_write_b32 a161, v233
v_accvgpr_write_b32 a162, v234
v_accvgpr_write_b32 a163, v235
v_accvgpr_read_b32 v232, a176
v_accvgpr_read_b32 v233, a177
v_accvgpr_read_b32 v234, a178
v_accvgpr_read_b32 v235, a179
v_mul_f32 v232, v232, v242
v_mul_f32 v233, v233, v243
v_mul_f32 v234, v234, v254
v_mul_f32 v235, v235, v255
v_accvgpr_write_b32 a176, v232
v_accvgpr_write_b32 a177, v233
v_accvgpr_write_b32 a178, v234
v_accvgpr_write_b32 a179, v235
v_accvgpr_read_b32 v232, a192
v_accvgpr_read_b32 v233, a193
v_accvgpr_read_b32 v234, a194
v_accvgpr_read_b32 v235, a195
v_mul_f32 v232, v232, v242
v_mul_f32 v233, v233, v243
v_mul_f32 v234, v234, v254
v_mul_f32 v235, v235, v255
v_accvgpr_write_b32 a192, v232
v_accvgpr_write_b32 a193, v233
v_accvgpr_write_b32 a194, v234
v_accvgpr_write_b32 a195, v235
v_accvgpr_read_b32 v232, a208
v_accvgpr_read_b32 v233, a209
v_accvgpr_read_b32 v234, a210
v_accvgpr_read_b32 v235, a211
v_mul_f32 v232, v232, v242
v_mul_f32 v233, v233, v243
v_mul_f32 v234, v234, v254
v_mul_f32 v235, v235, v255
v_accvgpr_write_b32 a208, v232
v_accvgpr_write_b32 a209, v233
v_accvgpr_write_b32 a210, v234
v_accvgpr_write_b32 a211, v235
v_accvgpr_read_b32 v232, a224
v_accvgpr_read_b32 v233, a225
v_accvgpr_read_b32 v234, a226
v_accvgpr_read_b32 v235, a227
v_mul_f32 v232, v232, v242
v_mul_f32 v233, v233, v243
v_mul_f32 v234, v234, v254
v_mul_f32 v235, v235, v255
v_accvgpr_write_b32 a224, v232
v_accvgpr_write_b32 a225, v233
v_accvgpr_write_b32 a226, v234
v_accvgpr_write_b32 a227, v235
v_accvgpr_read_b32 v232, a240
v_accvgpr_read_b32 v233, a241
v_accvgpr_read_b32 v234, a242
v_accvgpr_read_b32 v235, a243
v_mul_f32 v232, v232, v242
v_mul_f32 v233, v233, v243
v_mul_f32 v234, v234, v254
v_mul_f32 v235, v235, v255
v_accvgpr_write_b32 a240, v232
v_accvgpr_write_b32 a241, v233
v_accvgpr_write_b32 a242, v234
v_accvgpr_write_b32 a243, v235
v_lshrrev_b32 v232, 4, v248
v_and_b32 v232, 0x30, v232
ds_bpermute_b32 v242, v232, v237 offset:0
ds_bpermute_b32 v243, v232, v237 offset:4
ds_bpermute_b32 v254, v232, v237 offset:8
ds_bpermute_b32 v255, v232, v237 offset:12
s_waitcnt lgkmcnt(0)
v_accvgpr_read_b32 v232, a4
v_accvgpr_read_b32 v233, a5
v_accvgpr_read_b32 v234, a6
v_accvgpr_read_b32 v235, a7
v_mul_f32 v232, v232, v242
v_mul_f32 v233, v233, v243
v_mul_f32 v234, v234, v254
v_mul_f32 v235, v235, v255
v_accvgpr_write_b32 a4, v232
v_accvgpr_write_b32 a5, v233
v_accvgpr_write_b32 a6, v234
v_accvgpr_write_b32 a7, v235
v_accvgpr_read_b32 v232, a20
v_accvgpr_read_b32 v233, a21
v_accvgpr_read_b32 v234, a22
v_accvgpr_read_b32 v235, a23
v_mul_f32 v232, v232, v242
v_mul_f32 v233, v233, v243
v_mul_f32 v234, v234, v254
v_mul_f32 v235, v235, v255
v_accvgpr_write_b32 a20, v232
v_accvgpr_write_b32 a21, v233
v_accvgpr_write_b32 a22, v234
v_accvgpr_write_b32 a23, v235
v_accvgpr_read_b32 v232, a36
v_accvgpr_read_b32 v233, a37
v_accvgpr_read_b32 v234, a38
v_accvgpr_read_b32 v235, a39
v_mul_f32 v232, v232, v242
v_mul_f32 v233, v233, v243
v_mul_f32 v234, v234, v254
v_mul_f32 v235, v235, v255
v_accvgpr_write_b32 a36, v232
v_accvgpr_write_b32 a37, v233
v_accvgpr_write_b32 a38, v234
v_accvgpr_write_b32 a39, v235
v_accvgpr_read_b32 v232, a52
v_accvgpr_read_b32 v233, a53
v_accvgpr_read_b32 v234, a54
v_accvgpr_read_b32 v235, a55
v_mul_f32 v232, v232, v242
v_mul_f32 v233, v233, v243
v_mul_f32 v234, v234, v254
v_mul_f32 v235, v235, v255
v_accvgpr_write_b32 a52, v232
v_accvgpr_write_b32 a53, v233
v_accvgpr_write_b32 a54, v234
v_accvgpr_write_b32 a55, v235
v_accvgpr_read_b32 v232, a68
v_accvgpr_read_b32 v233, a69
v_accvgpr_read_b32 v234, a70
v_accvgpr_read_b32 v235, a71
v_mul_f32 v232, v232, v242
v_mul_f32 v233, v233, v243
v_mul_f32 v234, v234, v254
v_mul_f32 v235, v235, v255
v_accvgpr_write_b32 a68, v232
v_accvgpr_write_b32 a69, v233
v_accvgpr_write_b32 a70, v234
v_accvgpr_write_b32 a71, v235
v_accvgpr_read_b32 v232, a84
v_accvgpr_read_b32 v233, a85
v_accvgpr_read_b32 v234, a86
v_accvgpr_read_b32 v235, a87
v_mul_f32 v232, v232, v242
v_mul_f32 v233, v233, v243
v_mul_f32 v234, v234, v254
v_mul_f32 v235, v235, v255
v_accvgpr_write_b32 a84, v232
v_accvgpr_write_b32 a85, v233
v_accvgpr_write_b32 a86, v234
v_accvgpr_write_b32 a87, v235
v_accvgpr_read_b32 v232, a100
v_accvgpr_read_b32 v233, a101
v_accvgpr_read_b32 v234, a102
v_accvgpr_read_b32 v235, a103
v_mul_f32 v232, v232, v242
v_mul_f32 v233, v233, v243
v_mul_f32 v234, v234, v254
v_mul_f32 v235, v235, v255
v_accvgpr_write_b32 a100, v232
v_accvgpr_write_b32 a101, v233
v_accvgpr_write_b32 a102, v234
v_accvgpr_write_b32 a103, v235
v_accvgpr_read_b32 v232, a116
v_accvgpr_read_b32 v233, a117
v_accvgpr_read_b32 v234, a118
v_accvgpr_read_b32 v235, a119
v_mul_f32 v232, v232, v242
v_mul_f32 v233, v233, v243
v_mul_f32 v234, v234, v254
v_mul_f32 v235, v235, v255
v_accvgpr_write_b32 a116, v232
v_accvgpr_write_b32 a117, v233
v_accvgpr_write_b32 a118, v234
v_accvgpr_write_b32 a119, v235
v_accvgpr_read_b32 v232, a132
v_accvgpr_read_b32 v233, a133
v_accvgpr_read_b32 v234, a134
v_accvgpr_read_b32 v235, a135
v_mul_f32 v232, v232, v242
v_mul_f32 v233, v233, v243
v_mul_f32 v234, v234, v254
v_mul_f32 v235, v235, v255
v_accvgpr_write_b32 a132, v232
v_accvgpr_write_b32 a133, v233
v_accvgpr_write_b32 a134, v234
v_accvgpr_write_b32 a135, v235
v_accvgpr_read_b32 v232, a148
v_accvgpr_read_b32 v233, a149
v_accvgpr_read_b32 v234, a150
v_accvgpr_read_b32 v235, a151
v_mul_f32 v232, v232, v242
v_mul_f32 v233, v233, v243
v_mul_f32 v234, v234, v254
v_mul_f32 v235, v235, v255
v_accvgpr_write_b32 a148, v232
v_accvgpr_write_b32 a149, v233
v_accvgpr_write_b32 a150, v234
v_accvgpr_write_b32 a151, v235
v_accvgpr_read_b32 v232, a164
v_accvgpr_read_b32 v233, a165
v_accvgpr_read_b32 v234, a166
v_accvgpr_read_b32 v235, a167
v_mul_f32 v232, v232, v242
v_mul_f32 v233, v233, v243
v_mul_f32 v234, v234, v254
v_mul_f32 v235, v235, v255
v_accvgpr_write_b32 a164, v232
v_accvgpr_write_b32 a165, v233
v_accvgpr_write_b32 a166, v234
v_accvgpr_write_b32 a167, v235
v_accvgpr_read_b32 v232, a180
v_accvgpr_read_b32 v233, a181
v_accvgpr_read_b32 v234, a182
v_accvgpr_read_b32 v235, a183
v_mul_f32 v232, v232, v242
v_mul_f32 v233, v233, v243
v_mul_f32 v234, v234, v254
v_mul_f32 v235, v235, v255
v_accvgpr_write_b32 a180, v232
v_accvgpr_write_b32 a181, v233
v_accvgpr_write_b32 a182, v234
v_accvgpr_write_b32 a183, v235
v_accvgpr_read_b32 v232, a196
v_accvgpr_read_b32 v233, a197
v_accvgpr_read_b32 v234, a198
v_accvgpr_read_b32 v235, a199
v_mul_f32 v232, v232, v242
v_mul_f32 v233, v233, v243
v_mul_f32 v234, v234, v254
v_mul_f32 v235, v235, v255
v_accvgpr_write_b32 a196, v232
v_accvgpr_write_b32 a197, v233
v_accvgpr_write_b32 a198, v234
v_accvgpr_write_b32 a199, v235
v_accvgpr_read_b32 v232, a212
v_accvgpr_read_b32 v233, a213
v_accvgpr_read_b32 v234, a214
v_accvgpr_read_b32 v235, a215
v_mul_f32 v232, v232, v242
v_mul_f32 v233, v233, v243
v_mul_f32 v234, v234, v254
v_mul_f32 v235, v235, v255
v_accvgpr_write_b32 a212, v232
v_accvgpr_write_b32 a213, v233
v_accvgpr_write_b32 a214, v234
v_accvgpr_write_b32 a215, v235
v_accvgpr_read_b32 v232, a228
v_accvgpr_read_b32 v233, a229
v_accvgpr_read_b32 v234, a230
v_accvgpr_read_b32 v235, a231
v_mul_f32 v232, v232, v242
v_mul_f32 v233, v233, v243
v_mul_f32 v234, v234, v254
v_mul_f32 v235, v235, v255
v_accvgpr_write_b32 a228, v232
v_accvgpr_write_b32 a229, v233
v_accvgpr_write_b32 a230, v234
v_accvgpr_write_b32 a231, v235
v_accvgpr_read_b32 v232, a244
v_accvgpr_read_b32 v233, a245
v_accvgpr_read_b32 v234, a246
v_accvgpr_read_b32 v235, a247
v_mul_f32 v232, v232, v242
v_mul_f32 v233, v233, v243
v_mul_f32 v234, v234, v254
v_mul_f32 v235, v235, v255
v_accvgpr_write_b32 a244, v232
v_accvgpr_write_b32 a245, v233
v_accvgpr_write_b32 a246, v234
v_accvgpr_write_b32 a247, v235
v_lshrrev_b32 v232, 4, v248
v_and_b32 v232, 0x30, v232
ds_bpermute_b32 v242, v232, v238 offset:0
ds_bpermute_b32 v243, v232, v238 offset:4
ds_bpermute_b32 v254, v232, v238 offset:8
ds_bpermute_b32 v255, v232, v238 offset:12
s_waitcnt lgkmcnt(0)
v_accvgpr_read_b32 v232, a8
v_accvgpr_read_b32 v233, a9
v_accvgpr_read_b32 v234, a10
v_accvgpr_read_b32 v235, a11
v_mul_f32 v232, v232, v242
v_mul_f32 v233, v233, v243
v_mul_f32 v234, v234, v254
v_mul_f32 v235, v235, v255
v_accvgpr_write_b32 a8, v232
v_accvgpr_write_b32 a9, v233
v_accvgpr_write_b32 a10, v234
v_accvgpr_write_b32 a11, v235
v_accvgpr_read_b32 v232, a24
v_accvgpr_read_b32 v233, a25
v_accvgpr_read_b32 v234, a26
v_accvgpr_read_b32 v235, a27
v_mul_f32 v232, v232, v242
v_mul_f32 v233, v233, v243
v_mul_f32 v234, v234, v254
v_mul_f32 v235, v235, v255
v_accvgpr_write_b32 a24, v232
v_accvgpr_write_b32 a25, v233
v_accvgpr_write_b32 a26, v234
v_accvgpr_write_b32 a27, v235
v_accvgpr_read_b32 v232, a40
v_accvgpr_read_b32 v233, a41
v_accvgpr_read_b32 v234, a42
v_accvgpr_read_b32 v235, a43
v_mul_f32 v232, v232, v242
v_mul_f32 v233, v233, v243
v_mul_f32 v234, v234, v254
v_mul_f32 v235, v235, v255
v_accvgpr_write_b32 a40, v232
v_accvgpr_write_b32 a41, v233
v_accvgpr_write_b32 a42, v234
v_accvgpr_write_b32 a43, v235
v_accvgpr_read_b32 v232, a56
v_accvgpr_read_b32 v233, a57
v_accvgpr_read_b32 v234, a58
v_accvgpr_read_b32 v235, a59
v_mul_f32 v232, v232, v242
v_mul_f32 v233, v233, v243
v_mul_f32 v234, v234, v254
v_mul_f32 v235, v235, v255
v_accvgpr_write_b32 a56, v232
v_accvgpr_write_b32 a57, v233
v_accvgpr_write_b32 a58, v234
v_accvgpr_write_b32 a59, v235
v_accvgpr_read_b32 v232, a72
v_accvgpr_read_b32 v233, a73
v_accvgpr_read_b32 v234, a74
v_accvgpr_read_b32 v235, a75
v_mul_f32 v232, v232, v242
v_mul_f32 v233, v233, v243
v_mul_f32 v234, v234, v254
v_mul_f32 v235, v235, v255
v_accvgpr_write_b32 a72, v232
v_accvgpr_write_b32 a73, v233
v_accvgpr_write_b32 a74, v234
v_accvgpr_write_b32 a75, v235
v_accvgpr_read_b32 v232, a88
v_accvgpr_read_b32 v233, a89
v_accvgpr_read_b32 v234, a90
v_accvgpr_read_b32 v235, a91
v_mul_f32 v232, v232, v242
v_mul_f32 v233, v233, v243
v_mul_f32 v234, v234, v254
v_mul_f32 v235, v235, v255
v_accvgpr_write_b32 a88, v232
v_accvgpr_write_b32 a89, v233
v_accvgpr_write_b32 a90, v234
v_accvgpr_write_b32 a91, v235
v_accvgpr_read_b32 v232, a104
v_accvgpr_read_b32 v233, a105
v_accvgpr_read_b32 v234, a106
v_accvgpr_read_b32 v235, a107
v_mul_f32 v232, v232, v242
v_mul_f32 v233, v233, v243
v_mul_f32 v234, v234, v254
v_mul_f32 v235, v235, v255
v_accvgpr_write_b32 a104, v232
v_accvgpr_write_b32 a105, v233
v_accvgpr_write_b32 a106, v234
v_accvgpr_write_b32 a107, v235
v_accvgpr_read_b32 v232, a120
v_accvgpr_read_b32 v233, a121
v_accvgpr_read_b32 v234, a122
v_accvgpr_read_b32 v235, a123
v_mul_f32 v232, v232, v242
v_mul_f32 v233, v233, v243
v_mul_f32 v234, v234, v254
v_mul_f32 v235, v235, v255
v_accvgpr_write_b32 a120, v232
v_accvgpr_write_b32 a121, v233
v_accvgpr_write_b32 a122, v234
v_accvgpr_write_b32 a123, v235
v_accvgpr_read_b32 v232, a136
v_accvgpr_read_b32 v233, a137
v_accvgpr_read_b32 v234, a138
v_accvgpr_read_b32 v235, a139
v_mul_f32 v232, v232, v242
v_mul_f32 v233, v233, v243
v_mul_f32 v234, v234, v254
v_mul_f32 v235, v235, v255
v_accvgpr_write_b32 a136, v232
v_accvgpr_write_b32 a137, v233
v_accvgpr_write_b32 a138, v234
v_accvgpr_write_b32 a139, v235
v_accvgpr_read_b32 v232, a152
v_accvgpr_read_b32 v233, a153
v_accvgpr_read_b32 v234, a154
v_accvgpr_read_b32 v235, a155
v_mul_f32 v232, v232, v242
v_mul_f32 v233, v233, v243
v_mul_f32 v234, v234, v254
v_mul_f32 v235, v235, v255
v_accvgpr_write_b32 a152, v232
v_accvgpr_write_b32 a153, v233
v_accvgpr_write_b32 a154, v234
v_accvgpr_write_b32 a155, v235
v_accvgpr_read_b32 v232, a168
v_accvgpr_read_b32 v233, a169
v_accvgpr_read_b32 v234, a170
v_accvgpr_read_b32 v235, a171
v_mul_f32 v232, v232, v242
v_mul_f32 v233, v233, v243
v_mul_f32 v234, v234, v254
v_mul_f32 v235, v235, v255
v_accvgpr_write_b32 a168, v232
v_accvgpr_write_b32 a169, v233
v_accvgpr_write_b32 a170, v234
v_accvgpr_write_b32 a171, v235
v_accvgpr_read_b32 v232, a184
v_accvgpr_read_b32 v233, a185
v_accvgpr_read_b32 v234, a186
v_accvgpr_read_b32 v235, a187
v_mul_f32 v232, v232, v242
v_mul_f32 v233, v233, v243
v_mul_f32 v234, v234, v254
v_mul_f32 v235, v235, v255
v_accvgpr_write_b32 a184, v232
v_accvgpr_write_b32 a185, v233
v_accvgpr_write_b32 a186, v234
v_accvgpr_write_b32 a187, v235
v_accvgpr_read_b32 v232, a200
v_accvgpr_read_b32 v233, a201
v_accvgpr_read_b32 v234, a202
v_accvgpr_read_b32 v235, a203
v_mul_f32 v232, v232, v242
v_mul_f32 v233, v233, v243
v_mul_f32 v234, v234, v254
v_mul_f32 v235, v235, v255
v_accvgpr_write_b32 a200, v232
v_accvgpr_write_b32 a201, v233
v_accvgpr_write_b32 a202, v234
v_accvgpr_write_b32 a203, v235
v_accvgpr_read_b32 v232, a216
v_accvgpr_read_b32 v233, a217
v_accvgpr_read_b32 v234, a218
v_accvgpr_read_b32 v235, a219
v_mul_f32 v232, v232, v242
v_mul_f32 v233, v233, v243
v_mul_f32 v234, v234, v254
v_mul_f32 v235, v235, v255
v_accvgpr_write_b32 a216, v232
v_accvgpr_write_b32 a217, v233
v_accvgpr_write_b32 a218, v234
v_accvgpr_write_b32 a219, v235
v_accvgpr_read_b32 v232, a232
v_accvgpr_read_b32 v233, a233
v_accvgpr_read_b32 v234, a234
v_accvgpr_read_b32 v235, a235
v_mul_f32 v232, v232, v242
v_mul_f32 v233, v233, v243
v_mul_f32 v234, v234, v254
v_mul_f32 v235, v235, v255
v_accvgpr_write_b32 a232, v232
v_accvgpr_write_b32 a233, v233
v_accvgpr_write_b32 a234, v234
v_accvgpr_write_b32 a235, v235
v_accvgpr_read_b32 v232, a248
v_accvgpr_read_b32 v233, a249
v_accvgpr_read_b32 v234, a250
v_accvgpr_read_b32 v235, a251
v_mul_f32 v232, v232, v242
v_mul_f32 v233, v233, v243
v_mul_f32 v234, v234, v254
v_mul_f32 v235, v235, v255
v_accvgpr_write_b32 a248, v232
v_accvgpr_write_b32 a249, v233
v_accvgpr_write_b32 a250, v234
v_accvgpr_write_b32 a251, v235
v_lshrrev_b32 v232, 4, v248
v_and_b32 v232, 0x30, v232
ds_bpermute_b32 v242, v232, v239 offset:0
ds_bpermute_b32 v243, v232, v239 offset:4
ds_bpermute_b32 v254, v232, v239 offset:8
ds_bpermute_b32 v255, v232, v239 offset:12
s_waitcnt lgkmcnt(0)
v_accvgpr_read_b32 v232, a12
v_accvgpr_read_b32 v233, a13
v_accvgpr_read_b32 v234, a14
v_accvgpr_read_b32 v235, a15
v_mul_f32 v232, v232, v242
v_mul_f32 v233, v233, v243
v_mul_f32 v234, v234, v254
v_mul_f32 v235, v235, v255
v_accvgpr_write_b32 a12, v232
v_accvgpr_write_b32 a13, v233
v_accvgpr_write_b32 a14, v234
v_accvgpr_write_b32 a15, v235
v_accvgpr_read_b32 v232, a28
v_accvgpr_read_b32 v233, a29
v_accvgpr_read_b32 v234, a30
v_accvgpr_read_b32 v235, a31
v_mul_f32 v232, v232, v242
v_mul_f32 v233, v233, v243
v_mul_f32 v234, v234, v254
v_mul_f32 v235, v235, v255
v_accvgpr_write_b32 a28, v232
v_accvgpr_write_b32 a29, v233
v_accvgpr_write_b32 a30, v234
v_accvgpr_write_b32 a31, v235
v_accvgpr_read_b32 v232, a44
v_accvgpr_read_b32 v233, a45
v_accvgpr_read_b32 v234, a46
v_accvgpr_read_b32 v235, a47
v_mul_f32 v232, v232, v242
v_mul_f32 v233, v233, v243
v_mul_f32 v234, v234, v254
v_mul_f32 v235, v235, v255
v_accvgpr_write_b32 a44, v232
v_accvgpr_write_b32 a45, v233
v_accvgpr_write_b32 a46, v234
v_accvgpr_write_b32 a47, v235
v_accvgpr_read_b32 v232, a60
v_accvgpr_read_b32 v233, a61
v_accvgpr_read_b32 v234, a62
v_accvgpr_read_b32 v235, a63
v_mul_f32 v232, v232, v242
v_mul_f32 v233, v233, v243
v_mul_f32 v234, v234, v254
v_mul_f32 v235, v235, v255
v_accvgpr_write_b32 a60, v232
v_accvgpr_write_b32 a61, v233
v_accvgpr_write_b32 a62, v234
v_accvgpr_write_b32 a63, v235
v_accvgpr_read_b32 v232, a76
v_accvgpr_read_b32 v233, a77
v_accvgpr_read_b32 v234, a78
v_accvgpr_read_b32 v235, a79
v_mul_f32 v232, v232, v242
v_mul_f32 v233, v233, v243
v_mul_f32 v234, v234, v254
v_mul_f32 v235, v235, v255
v_accvgpr_write_b32 a76, v232
v_accvgpr_write_b32 a77, v233
v_accvgpr_write_b32 a78, v234
v_accvgpr_write_b32 a79, v235
v_accvgpr_read_b32 v232, a92
v_accvgpr_read_b32 v233, a93
v_accvgpr_read_b32 v234, a94
v_accvgpr_read_b32 v235, a95
v_mul_f32 v232, v232, v242
v_mul_f32 v233, v233, v243
v_mul_f32 v234, v234, v254
v_mul_f32 v235, v235, v255
v_accvgpr_write_b32 a92, v232
v_accvgpr_write_b32 a93, v233
v_accvgpr_write_b32 a94, v234
v_accvgpr_write_b32 a95, v235
v_accvgpr_read_b32 v232, a108
v_accvgpr_read_b32 v233, a109
v_accvgpr_read_b32 v234, a110
v_accvgpr_read_b32 v235, a111
v_mul_f32 v232, v232, v242
v_mul_f32 v233, v233, v243
v_mul_f32 v234, v234, v254
v_mul_f32 v235, v235, v255
v_accvgpr_write_b32 a108, v232
v_accvgpr_write_b32 a109, v233
v_accvgpr_write_b32 a110, v234
v_accvgpr_write_b32 a111, v235
v_accvgpr_read_b32 v232, a124
v_accvgpr_read_b32 v233, a125
v_accvgpr_read_b32 v234, a126
v_accvgpr_read_b32 v235, a127
v_mul_f32 v232, v232, v242
v_mul_f32 v233, v233, v243
v_mul_f32 v234, v234, v254
v_mul_f32 v235, v235, v255
v_accvgpr_write_b32 a124, v232
v_accvgpr_write_b32 a125, v233
v_accvgpr_write_b32 a126, v234
v_accvgpr_write_b32 a127, v235
v_accvgpr_read_b32 v232, a140
v_accvgpr_read_b32 v233, a141
v_accvgpr_read_b32 v234, a142
v_accvgpr_read_b32 v235, a143
v_mul_f32 v232, v232, v242
v_mul_f32 v233, v233, v243
v_mul_f32 v234, v234, v254
v_mul_f32 v235, v235, v255
v_accvgpr_write_b32 a140, v232
v_accvgpr_write_b32 a141, v233
v_accvgpr_write_b32 a142, v234
v_accvgpr_write_b32 a143, v235
v_accvgpr_read_b32 v232, a156
v_accvgpr_read_b32 v233, a157
v_accvgpr_read_b32 v234, a158
v_accvgpr_read_b32 v235, a159
v_mul_f32 v232, v232, v242
v_mul_f32 v233, v233, v243
v_mul_f32 v234, v234, v254
v_mul_f32 v235, v235, v255
v_accvgpr_write_b32 a156, v232
v_accvgpr_write_b32 a157, v233
v_accvgpr_write_b32 a158, v234
v_accvgpr_write_b32 a159, v235
v_accvgpr_read_b32 v232, a172
v_accvgpr_read_b32 v233, a173
v_accvgpr_read_b32 v234, a174
v_accvgpr_read_b32 v235, a175
v_mul_f32 v232, v232, v242
v_mul_f32 v233, v233, v243
v_mul_f32 v234, v234, v254
v_mul_f32 v235, v235, v255
v_accvgpr_write_b32 a172, v232
v_accvgpr_write_b32 a173, v233
v_accvgpr_write_b32 a174, v234
v_accvgpr_write_b32 a175, v235
v_accvgpr_read_b32 v232, a188
v_accvgpr_read_b32 v233, a189
v_accvgpr_read_b32 v234, a190
v_accvgpr_read_b32 v235, a191
v_mul_f32 v232, v232, v242
v_mul_f32 v233, v233, v243
v_mul_f32 v234, v234, v254
v_mul_f32 v235, v235, v255
v_accvgpr_write_b32 a188, v232
v_accvgpr_write_b32 a189, v233
v_accvgpr_write_b32 a190, v234
v_accvgpr_write_b32 a191, v235
v_accvgpr_read_b32 v232, a204
v_accvgpr_read_b32 v233, a205
v_accvgpr_read_b32 v234, a206
v_accvgpr_read_b32 v235, a207
v_mul_f32 v232, v232, v242
v_mul_f32 v233, v233, v243
v_mul_f32 v234, v234, v254
v_mul_f32 v235, v235, v255
v_accvgpr_write_b32 a204, v232
v_accvgpr_write_b32 a205, v233
v_accvgpr_write_b32 a206, v234
v_accvgpr_write_b32 a207, v235
v_accvgpr_read_b32 v232, a220
v_accvgpr_read_b32 v233, a221
v_accvgpr_read_b32 v234, a222
v_accvgpr_read_b32 v235, a223
v_mul_f32 v232, v232, v242
v_mul_f32 v233, v233, v243
v_mul_f32 v234, v234, v254
v_mul_f32 v235, v235, v255
v_accvgpr_write_b32 a220, v232
v_accvgpr_write_b32 a221, v233
v_accvgpr_write_b32 a222, v234
v_accvgpr_write_b32 a223, v235
v_accvgpr_read_b32 v232, a236
v_accvgpr_read_b32 v233, a237
v_accvgpr_read_b32 v234, a238
v_accvgpr_read_b32 v235, a239
v_mul_f32 v232, v232, v242
v_mul_f32 v233, v233, v243
v_mul_f32 v234, v234, v254
v_mul_f32 v235, v235, v255
v_accvgpr_write_b32 a236, v232
v_accvgpr_write_b32 a237, v233
v_accvgpr_write_b32 a238, v234
v_accvgpr_write_b32 a239, v235
v_accvgpr_read_b32 v232, a252
v_accvgpr_read_b32 v233, a253
v_accvgpr_read_b32 v234, a254
v_accvgpr_read_b32 v235, a255
v_mul_f32 v232, v232, v242
v_mul_f32 v233, v233, v243
v_mul_f32 v234, v234, v254
v_mul_f32 v235, v235, v255
v_accvgpr_write_b32 a252, v232
v_accvgpr_write_b32 a253, v233
v_accvgpr_write_b32 a254, v234
v_accvgpr_write_b32 a255, v235
s_nop 3
s_cmp_eq_u32 s36, 0
s_cbranch_scc1 L2_ret0
s_cmp_eq_u32 s36, 1
s_cbranch_scc1 L2_ret1
s_cmp_eq_u32 s36, 2
s_cbranch_scc1 L2_ret2
s_cmp_eq_u32 s36, 3
s_cbranch_scc1 L2_ret3
s_cmp_eq_u32 s36, 4
s_cbranch_scc1 L2_ret4
s_cmp_eq_u32 s36, 5
s_cbranch_scc1 L2_ret5
s_cmp_eq_u32 s36, 6
s_cbranch_scc1 L2_ret6
s_cmp_eq_u32 s36, 7
s_cbranch_scc1 L2_ret7
s_cmp_eq_u32 s36, 8
s_cbranch_scc1 L2_ret8
s_cmp_eq_u32 s36, 9
s_cbranch_scc1 L2_ret9
s_cmp_eq_u32 s36, 10
s_cbranch_scc1 L2_ret10
s_cmp_eq_u32 s36, 11
s_cbranch_scc1 L2_ret11
s_cmp_eq_u32 s36, 12
s_cbranch_scc1 L2_ret12
s_cmp_eq_u32 s36, 13
s_cbranch_scc1 L2_ret13
s_cmp_eq_u32 s36, 14
s_cbranch_scc1 L2_ret14
s_cmp_eq_u32 s36, 15
s_cbranch_scc1 L2_ret15
s_cmp_eq_u32 s36, 16
s_cbranch_scc1 L2_ret16
s_cmp_eq_u32 s36, 17
s_cbranch_scc1 L2_ret17
s_cmp_eq_u32 s36, 18
s_cbranch_scc1 L2_ret18
s_branch L2_ret19
LT_disp:
s_cmp_eq_u32 s34, 0
s_cbranch_scc1 LT_start
s_mov_b32 s41, s34
s_mul_i32 s40, s34, 6
s_add_u32 s40, s40, s37
s_add_u32 s40, s40, 42
s_cmp_lt_u32 s40, 64
s_cbranch_scc1 LE_common
s_branch L2_end
LT_start:
s_waitcnt lgkmcnt(0)
s_add_u32 s12, s4, 0x7c2a000
s_addc_u32 s13, s5, 0
s_mov_b32 s14, 0x8000
s_mov_b32 s15, 0x00020000
v_and_b32 v8, 63, v0
v_lshlrev_b32 v8, 7, v8
s_mov_b32 s91, 8192
s_mov_b32 s90, 16384
s_mov_b32 s95, 24576
s_mov_b32 s94, 0x10000
LT_poll:
buffer_load_dwordx2 v[0:1], v8, s[12:15], 0 offen sc1
buffer_load_dwordx2 v[2:3], v8, s[12:15], s91 offen sc1
buffer_load_dwordx2 v[4:5], v8, s[12:15], s90 offen sc1
buffer_load_dwordx2 v[6:7], v8, s[12:15], s95 offen sc1
s_sub_u32 s94, s94, 1
s_waitcnt vmcnt(0)
s_cbranch_scc1 LT_poll_go
v_cmp_ne_u64 vcc, s[98:99], v[0:1]
s_nop 1
s_cbranch_vccnz LT_poll
v_cmp_ne_u64 vcc, s[98:99], v[2:3]
s_nop 1
s_cbranch_vccnz LT_poll
v_cmp_ne_u64 vcc, s[98:99], v[4:5]
s_nop 1
s_cbranch_vccnz LT_poll
v_cmp_ne_u64 vcc, s[98:99], v[6:7]
s_nop 1
s_cbranch_vccnz LT_poll
LT_poll_go:
s_add_u32 s12, s4, 0x6800000
s_addc_u32 s13, s5, 0
s_mov_b32 s14, 0x0
s_mov_b32 s15, 0x00020000
s_mov_b32 s14, s49
s_add_u32 s8, s4, 0x0
s_addc_u32 s9, s5, 0
s_mov_b32 s10, 0x4e4000
s_mov_b32 s11, 0x00020000
s_mov_b32 s40, 5111808
s_mov_b32 s44, 5115904
buffer_load_dwordx4 v[0:3], v248, s[8:11], s40 offen offset:0 sc1
buffer_load_dwordx4 v[4:7], v248, s[8:11], s40 offen offset:1024 sc1
buffer_load_dwordx4 v[8:11], v248, s[8:11], s40 offen offset:2048 sc1
buffer_load_dwordx4 v[12:15], v248, s[8:11], s40 offen offset:3072 sc1
buffer_load_dwordx4 v[16:19], v248, s[8:11], s44 offen offset:0 sc1
buffer_load_dwordx4 v[20:23], v248, s[8:11], s44 offen offset:1024 sc1
buffer_load_dwordx4 v[24:27], v248, s[8:11], s44 offen offset:2048 sc1
buffer_load_dwordx4 v[28:31], v248, s[8:11], s44 offen offset:3072 sc1
s_mov_b32 s53, 0
s_add_u32 m0, s53, 90112
s_add_u32 s54, s39, 0
buffer_load_dwordx4 v241, s[12:15], s54 offen offset:0 sc1 lds
buffer_load_dwordx4 v241, s[12:15], s54 offen offset:1024 sc1 lds
buffer_load_dwordx4 v241, s[12:15], s54 offen offset:2048 sc1 lds
buffer_load_dwordx4 v241, s[12:15], s54 offen offset:3072 sc1 lds
s_add_u32 m0, s53, 94208
s_add_u32 s54, s39, 128
buffer_load_dwordx4 v241, s[12:15], s54 offen offset:0 sc1 lds
buffer_load_dwordx4 v241, s[12:15], s54 offen offset:1024 sc1 lds
buffer_load_dwordx4 v241, s[12:15], s54 offen offset:2048 sc1 lds
buffer_load_dwordx4 v241, s[12:15], s54 offen offset:3072 sc1 lds
s_add_u32 m0, s53, 98304
s_add_u32 s54, s39, 256
buffer_load_dwordx4 v241, s[12:15], s54 offen offset:0 sc1 lds
buffer_load_dwordx4 v241, s[12:15], s54 offen offset:1024 sc1 lds
buffer_load_dwordx4 v241, s[12:15], s54 offen offset:2048 sc1 lds
buffer_load_dwordx4 v241, s[12:15], s54 offen offset:3072 sc1 lds
s_add_u32 m0, s53, 102400
s_add_u32 s54, s39, 384
buffer_load_dwordx4 v241, s[12:15], s54 offen offset:0 sc1 lds
buffer_load_dwordx4 v241, s[12:15], s54 offen offset:1024 sc1 lds
buffer_load_dwordx4 v241, s[12:15], s54 offen offset:2048 sc1 lds
buffer_load_dwordx4 v241, s[12:15], s54 offen offset:3072 sc1 lds
s_add_u32 s53, s53, 0x4000
s_and_b32 s53, s53, 0xffff
s_add_u32 m0, s53, 90112
s_add_u32 s54, s28, 0
buffer_load_dwordx4 v241, s[12:15], s54 offen offset:0 sc1 lds
buffer_load_dwordx4 v241, s[12:15], s54 offen offset:1024 sc1 lds
buffer_load_dwordx4 v241, s[12:15], s54 offen offset:2048 sc1 lds
buffer_load_dwordx4 v241, s[12:15], s54 offen offset:3072 sc1 lds
s_add_u32 m0, s53, 94208
s_add_u32 s54, s28, 128
buffer_load_dwordx4 v241, s[12:15], s54 offen offset:0 sc1 lds
buffer_load_dwordx4 v241, s[12:15], s54 offen offset:1024 sc1 lds
buffer_load_dwordx4 v241, s[12:15], s54 offen offset:2048 sc1 lds
buffer_load_dwordx4 v241, s[12:15], s54 offen offset:3072 sc1 lds
s_add_u32 m0, s53, 98304
s_add_u32 s54, s28, 256
buffer_load_dwordx4 v241, s[12:15], s54 offen offset:0 sc1 lds
buffer_load_dwordx4 v241, s[12:15], s54 offen offset:1024 sc1 lds
buffer_load_dwordx4 v241, s[12:15], s54 offen offset:2048 sc1 lds
buffer_load_dwordx4 v241, s[12:15], s54 offen offset:3072 sc1 lds
s_add_u32 m0, s53, 102400
s_add_u32 s54, s28, 384
buffer_load_dwordx4 v241, s[12:15], s54 offen offset:0 sc1 lds
buffer_load_dwordx4 v241, s[12:15], s54 offen offset:1024 sc1 lds
buffer_load_dwordx4 v241, s[12:15], s54 offen offset:2048 sc1 lds
buffer_load_dwordx4 v241, s[12:15], s54 offen offset:3072 sc1 lds
s_add_u32 s53, s53, 0x4000
s_and_b32 s53, s53, 0xffff
s_add_u32 s28, s28, 0x4000
s_add_u32 m0, s53, 90112
s_add_u32 s54, s28, 0
buffer_load_dwordx4 v241, s[12:15], s54 offen offset:0 sc1 lds
buffer_load_dwordx4 v241, s[12:15], s54 offen offset:1024 sc1 lds
buffer_load_dwordx4 v241, s[12:15], s54 offen offset:2048 sc1 lds
buffer_load_dwordx4 v241, s[12:15], s54 offen offset:3072 sc1 lds
s_add_u32 m0, s53, 94208
s_add_u32 s54, s28, 128
buffer_load_dwordx4 v241, s[12:15], s54 offen offset:0 sc1 lds
buffer_load_dwordx4 v241, s[12:15], s54 offen offset:1024 sc1 lds
buffer_load_dwordx4 v241, s[12:15], s54 offen offset:2048 sc1 lds
buffer_load_dwordx4 v241, s[12:15], s54 offen offset:3072 sc1 lds
s_add_u32 m0, s53, 98304
s_add_u32 s54, s28, 256
buffer_load_dwordx4 v241, s[12:15], s54 offen offset:0 sc1 lds
buffer_load_dwordx4 v241, s[12:15], s54 offen offset:1024 sc1 lds
buffer_load_dwordx4 v241, s[12:15], s54 offen offset:2048 sc1 lds
buffer_load_dwordx4 v241, s[12:15], s54 offen offset:3072 sc1 lds
s_add_u32 m0, s53, 102400
s_add_u32 s54, s28, 384
buffer_load_dwordx4 v241, s[12:15], s54 offen offset:0 sc1 lds
buffer_load_dwordx4 v241, s[12:15], s54 offen offset:1024 sc1 lds
buffer_load_dwordx4 v241, s[12:15], s54 offen offset:2048 sc1 lds
buffer_load_dwordx4 v241, s[12:15], s54 offen offset:3072 sc1 lds
s_add_u32 s53, s53, 0x4000
s_and_b32 s53, s53, 0xffff
s_add_u32 s28, s28, 0x4000
s_mul_i32 s35, s37, 0x600000
s_add_u32 s20, s4, 0x2000000
s_addc_u32 s21, s5, 0
s_add_u32 s20, s20, s35
s_addc_u32 s21, s21, 0
s_mov_b32 s22, 0x4e4000
s_mov_b32 s23, 0x00020000
s_add_u32 s24, s4, 0x6000000
s_addc_u32 s25, s5, 0
s_mov_b32 s26, 0x139000
s_mov_b32 s27, 0x00020000
s_lshl_b32 s48, s37, 3
s_add_u32 s48, s48, 638976
s_mov_b32 s48, 1277952
v_bfe_u32 v240, v248, 4, 3
v_lshlrev_b32 v240, 6, v240
v_bfe_u32 v242, v248, 7, 1
v_lshl_or_b32 v240, v242, 10, v240
v_bfe_u32 v242, v248, 8, 2
v_lshl_or_b32 v240, v242, 4, v240
v_bfe_u32 v242, v248, 6, 1
v_lshlrev_b32 v242, 5, v242
v_xor_b32 v240, v240, v242
v_and_b32 v249, 0x1c0, v248
v_bfe_u32 v242, v248, 9, 1
v_lshl_or_b32 v249, v242, 10, v249
v_bfe_u32 v242, v248, 8, 1
v_lshl_or_b32 v249, v242, 5, v249
v_bfe_u32 v242, v248, 4, 2
v_lshl_or_b32 v249, v242, 3, v249
v_xor_b32 v250, 32, v249
v_bfe_i32 v242, v248, 8, 1
v_and_b32 v192, s33, v242
v_and_b32 v193, s33, v242
v_and_b32 v194, s33, v242
v_and_b32 v195, s33, v242
s_add_u32 s51, s31, 5
s_mov_b32 s52, 90112
v_mov_b32 v172, 0xff800000
v_mov_b32 v173, 0
v_accvgpr_write_b32 a0, 0
v_accvgpr_write_b32 a1, 0
v_accvgpr_write_b32 a2, 0
v_accvgpr_write_b32 a3, 0
v_accvgpr_write_b32 a4, 0
v_accvgpr_write_b32 a5, 0
v_accvgpr_write_b32 a6, 0
v_accvgpr_write_b32 a7, 0
v_accvgpr_write_b32 a8, 0
v_accvgpr_write_b32 a9, 0
v_accvgpr_write_b32 a10, 0
v_accvgpr_write_b32 a11, 0
v_accvgpr_write_b32 a12, 0
v_accvgpr_write_b32 a13, 0
v_accvgpr_write_b32 a14, 0
v_accvgpr_write_b32 a15, 0
v_accvgpr_write_b32 a16, 0
v_accvgpr_write_b32 a17, 0
v_accvgpr_write_b32 a18, 0
v_accvgpr_write_b32 a19, 0
v_accvgpr_write_b32 a20, 0
v_accvgpr_write_b32 a21, 0
v_accvgpr_write_b32 a22, 0
v_accvgpr_write_b32 a23, 0
v_accvgpr_write_b32 a24, 0
v_accvgpr_write_b32 a25, 0
v_accvgpr_write_b32 a26, 0
v_accvgpr_write_b32 a27, 0
v_accvgpr_write_b32 a28, 0
v_accvgpr_write_b32 a29, 0
v_accvgpr_write_b32 a30, 0
v_accvgpr_write_b32 a31, 0
v_accvgpr_write_b32 a32, 0
v_accvgpr_write_b32 a33, 0
v_accvgpr_write_b32 a34, 0
v_accvgpr_write_b32 a35, 0
v_accvgpr_write_b32 a36, 0
v_accvgpr_write_b32 a37, 0
v_accvgpr_write_b32 a38, 0
v_accvgpr_write_b32 a39, 0
v_accvgpr_write_b32 a40, 0
v_accvgpr_write_b32 a41, 0
v_accvgpr_write_b32 a42, 0
v_accvgpr_write_b32 a43, 0
v_accvgpr_write_b32 a44, 0
v_accvgpr_write_b32 a45, 0
v_accvgpr_write_b32 a46, 0
v_accvgpr_write_b32 a47, 0
v_accvgpr_write_b32 a48, 0
v_accvgpr_write_b32 a49, 0
v_accvgpr_write_b32 a50, 0
v_accvgpr_write_b32 a51, 0
v_accvgpr_write_b32 a52, 0
v_accvgpr_write_b32 a53, 0
v_accvgpr_write_b32 a54, 0
v_accvgpr_write_b32 a55, 0
v_accvgpr_write_b32 a56, 0
v_accvgpr_write_b32 a57, 0
v_accvgpr_write_b32 a58, 0
v_accvgpr_write_b32 a59, 0
v_accvgpr_write_b32 a60, 0
v_accvgpr_write_b32 a61, 0
v_accvgpr_write_b32 a62, 0
v_accvgpr_write_b32 a63, 0
LT_loop:
s_add_u32 m0, s53, 90112
s_add_u32 s54, s28, 0
buffer_load_dwordx4 v241, s[12:15], s54 offen offset:0 sc1 lds
buffer_load_dwordx4 v241, s[12:15], s54 offen offset:1024 sc1 lds
buffer_load_dwordx4 v241, s[12:15], s54 offen offset:2048 sc1 lds
buffer_load_dwordx4 v241, s[12:15], s54 offen offset:3072 sc1 lds
s_add_u32 m0, s53, 94208
s_add_u32 s54, s28, 128
buffer_load_dwordx4 v241, s[12:15], s54 offen offset:0 sc1 lds
buffer_load_dwordx4 v241, s[12:15], s54 offen offset:1024 sc1 lds
buffer_load_dwordx4 v241, s[12:15], s54 offen offset:2048 sc1 lds
buffer_load_dwordx4 v241, s[12:15], s54 offen offset:3072 sc1 lds
s_add_u32 m0, s53, 98304
s_add_u32 s54, s28, 256
buffer_load_dwordx4 v241, s[12:15], s54 offen offset:0 sc1 lds
buffer_load_dwordx4 v241, s[12:15], s54 offen offset:1024 sc1 lds
buffer_load_dwordx4 v241, s[12:15], s54 offen offset:2048 sc1 lds
buffer_load_dwordx4 v241, s[12:15], s54 offen offset:3072 sc1 lds
s_add_u32 m0, s53, 102400
s_add_u32 s54, s28, 384
buffer_load_dwordx4 v241, s[12:15], s54 offen offset:0 sc1 lds
buffer_load_dwordx4 v241, s[12:15], s54 offen offset:1024 sc1 lds
buffer_load_dwordx4 v241, s[12:15], s54 offen offset:2048 sc1 lds
buffer_load_dwordx4 v241, s[12:15], s54 offen offset:3072 sc1 lds
s_add_u32 s53, s53, 0x4000
s_and_b32 s53, s53, 0xffff
s_add_u32 s28, s28, 0x4000
v_add_u32 v177, s52, v240
v_add_u32 v178, s52, v249
v_add_u32 v179, s52, v250
s_add_u32 s52, s52, 0x4000
s_cmp_eq_u32 s52, 155648
s_cselect_b32 s52, 90112, s52
s_waitcnt vmcnt(48)
ds_read_b128 v[32:35], v177 offset:0
ds_read_b128 v[64:67], v177 offset:2048
ds_read_b128 v[36:39], v177 offset:512
ds_read_b128 v[68:71], v177 offset:2560
ds_read_b128 v[40:43], v177 offset:4096
ds_read_b128 v[72:75], v177 offset:6144
ds_read_b128 v[44:47], v177 offset:4608
ds_read_b128 v[76:79], v177 offset:6656
ds_read_b128 v[48:51], v177 offset:8192
ds_read_b128 v[80:83], v177 offset:10240
ds_read_b128 v[52:55], v177 offset:8704
ds_read_b128 v[84:87], v177 offset:10752
ds_read_b128 v[56:59], v177 offset:12288
ds_read_b128 v[88:91], v177 offset:14336
ds_read_b128 v[60:63], v177 offset:12800
ds_read_b128 v[92:95], v177 offset:14848
s_waitcnt lgkmcnt(14)
v_mfma_f32_16x16x32_bf16 v[160:163], v[32:35], v[0:3], v[192:195]
v_mfma_f32_16x16x32_bf16 v[164:167], v[64:67], v[0:3], v[192:195]
s_waitcnt lgkmcnt(12)
v_mfma_f32_16x16x32_bf16 v[160:163], v[36:39], v[4:7], v[160:163]
v_mfma_f32_16x16x32_bf16 v[164:167], v[68:71], v[4:7], v[164:167]
s_waitcnt lgkmcnt(10)
v_mfma_f32_16x16x32_bf16 v[160:163], v[40:43], v[8:11], v[160:163]
v_mfma_f32_16x16x32_bf16 v[164:167], v[72:75], v[8:11], v[164:167]
s_waitcnt lgkmcnt(8)
v_mfma_f32_16x16x32_bf16 v[160:163], v[44:47], v[12:15], v[160:163]
v_mfma_f32_16x16x32_bf16 v[164:167], v[76:79], v[12:15], v[164:167]
s_waitcnt lgkmcnt(6)
v_mfma_f32_16x16x32_bf16 v[160:163], v[48:51], v[16:19], v[160:163]
v_mfma_f32_16x16x32_bf16 v[164:167], v[80:83], v[16:19], v[164:167]
s_waitcnt lgkmcnt(4)
v_mfma_f32_16x16x32_bf16 v[160:163], v[52:55], v[20:23], v[160:163]
v_mfma_f32_16x16x32_bf16 v[164:167], v[84:87], v[20:23], v[164:167]
s_waitcnt lgkmcnt(2)
v_mfma_f32_16x16x32_bf16 v[160:163], v[56:59], v[24:27], v[160:163]
v_mfma_f32_16x16x32_bf16 v[164:167], v[88:91], v[24:27], v[164:167]
s_waitcnt lgkmcnt(0)
v_mfma_f32_16x16x32_bf16 v[160:163], v[60:63], v[28:31], v[160:163]
v_mfma_f32_16x16x32_bf16 v[164:167], v[92:95], v[28:31], v[164:167]
ds_read_b64_tr_b16 v[96:97], v178 offset:0
ds_read_b64_tr_b16 v[98:99], v178 offset:2048
ds_read_b64_tr_b16 v[100:101], v179 offset:0
ds_read_b64_tr_b16 v[102:103], v179 offset:2048
ds_read_b64_tr_b16 v[104:105], v178 offset:512
ds_read_b64_tr_b16 v[106:107], v178 offset:2560
ds_read_b64_tr_b16 v[108:109], v179 offset:512
ds_read_b64_tr_b16 v[110:111], v179 offset:2560
ds_read_b64_tr_b16 v[112:113], v178 offset:4096
ds_read_b64_tr_b16 v[114:115], v178 offset:6144
ds_read_b64_tr_b16 v[116:117], v179 offset:4096
ds_read_b64_tr_b16 v[118:119], v179 offset:6144
ds_read_b64_tr_b16 v[120:121], v178 offset:4608
ds_read_b64_tr_b16 v[122:123], v178 offset:6656
ds_read_b64_tr_b16 v[124:125], v179 offset:4608
ds_read_b64_tr_b16 v[126:127], v179 offset:6656
ds_read_b64_tr_b16 v[128:129], v178 offset:8192
ds_read_b64_tr_b16 v[130:131], v178 offset:10240
ds_read_b64_tr_b16 v[132:133], v179 offset:8192
ds_read_b64_tr_b16 v[134:135], v179 offset:10240
ds_read_b64_tr_b16 v[136:137], v178 offset:8704
ds_read_b64_tr_b16 v[138:139], v178 offset:10752
ds_read_b64_tr_b16 v[140:141], v179 offset:8704
ds_read_b64_tr_b16 v[142:143], v179 offset:10752
ds_read_b64_tr_b16 v[144:145], v178 offset:12288
ds_read_b64_tr_b16 v[146:147], v178 offset:14336
ds_read_b64_tr_b16 v[148:149], v179 offset:12288
ds_read_b64_tr_b16 v[150:151], v179 offset:14336
ds_read_b64_tr_b16 v[152:153], v178 offset:12800
ds_read_b64_tr_b16 v[154:155], v178 offset:14848
ds_read_b64_tr_b16 v[156:157], v179 offset:12800
ds_read_b64_tr_b16 v[158:159], v179 offset:14848
v_mov_b32 v192, 0
v_mov_b32 v193, 0
v_mov_b32 v194, 0
v_mov_b32 v195, 0
s_nop 7
v_max3_f32 v175, v160, v161, v162
v_max3_f32 v175, v175, v163, v164
v_max3_f32 v175, v175, v165, v166
v_max3_f32 v175, v175, v167, v172
v_mov_b32 v176, v175
s_nop 1
v_permlane32_swap_b32 v175, v176
s_nop 1
v_max_f32 v175, v175, v176
v_mov_b32 v176, v175
s_nop 1
v_permlane16_swap_b32 v175, v176
s_nop 1
v_max_f32 v175, v175, v176
v_ceil_f32 v175, v175
v_sub_f32 v174, v172, v175
v_exp_f32 v174, v174
v_mov_b32 v172, v175
v_sub_f32 v160, v160, v172
v_sub_f32 v161, v161, v172
v_sub_f32 v162, v162, v172
v_sub_f32 v163, v163, v172
v_sub_f32 v164, v164, v172
v_sub_f32 v165, v165, v172
v_sub_f32 v166, v166, v172
v_sub_f32 v167, v167, v172
v_exp_f32 v160, v160
v_exp_f32 v161, v161
v_exp_f32 v162, v162
v_exp_f32 v163, v163
v_exp_f32 v164, v164
v_exp_f32 v165, v165
v_exp_f32 v166, v166
v_exp_f32 v167, v167
v_mul_f32 v173, v173, v174
v_cvt_pk_bf16_f32 v168, v160, v161
v_cvt_pk_bf16_f32 v169, v162, v163
v_cvt_pk_bf16_f32 v170, v164, v165
v_cvt_pk_bf16_f32 v171, v166, v167
v_cmp_neq_f32 vcc, 1.0, v174
v_add_f32 v173, v173, v160
v_add_f32 v173, v173, v161
v_add_f32 v173, v173, v162
v_add_f32 v173, v173, v163
v_add_f32 v173, v173, v164
v_add_f32 v173, v173, v165
v_add_f32 v173, v173, v166
v_add_f32 v173, v173, v167
s_cbranch_vccz LT_nors
v_lshrrev_b32 v176, 4, v248
v_and_b32 v176, 0x30, v176
ds_bpermute_b32 v188, v176, v174 offset:0
ds_bpermute_b32 v189, v176, v174 offset:4
ds_bpermute_b32 v190, v176, v174 offset:8
ds_bpermute_b32 v191, v176, v174 offset:12
s_waitcnt lgkmcnt(0)
v_accvgpr_read_b32 v180, a0
v_accvgpr_read_b32 v181, a1
v_accvgpr_read_b32 v182, a2
v_accvgpr_read_b32 v183, a3
v_accvgpr_read_b32 v184, a4
v_accvgpr_read_b32 v185, a5
v_accvgpr_read_b32 v186, a6
v_accvgpr_read_b32 v187, a7
v_mul_f32 v180, v180, v188
v_mul_f32 v181, v181, v189
v_mul_f32 v182, v182, v190
v_mul_f32 v183, v183, v191
v_mul_f32 v184, v184, v188
v_mul_f32 v185, v185, v189
v_mul_f32 v186, v186, v190
v_mul_f32 v187, v187, v191
v_accvgpr_write_b32 a0, v180
v_accvgpr_write_b32 a1, v181
v_accvgpr_write_b32 a2, v182
v_accvgpr_write_b32 a3, v183
v_accvgpr_write_b32 a4, v184
v_accvgpr_write_b32 a5, v185
v_accvgpr_write_b32 a6, v186
v_accvgpr_write_b32 a7, v187
v_accvgpr_read_b32 v180, a8
v_accvgpr_read_b32 v181, a9
v_accvgpr_read_b32 v182, a10
v_accvgpr_read_b32 v183, a11
v_accvgpr_read_b32 v184, a12
v_accvgpr_read_b32 v185, a13
v_accvgpr_read_b32 v186, a14
v_accvgpr_read_b32 v187, a15
v_mul_f32 v180, v180, v188
v_mul_f32 v181, v181, v189
v_mul_f32 v182, v182, v190
v_mul_f32 v183, v183, v191
v_mul_f32 v184, v184, v188
v_mul_f32 v185, v185, v189
v_mul_f32 v186, v186, v190
v_mul_f32 v187, v187, v191
v_accvgpr_write_b32 a8, v180
v_accvgpr_write_b32 a9, v181
v_accvgpr_write_b32 a10, v182
v_accvgpr_write_b32 a11, v183
v_accvgpr_write_b32 a12, v184
v_accvgpr_write_b32 a13, v185
v_accvgpr_write_b32 a14, v186
v_accvgpr_write_b32 a15, v187
v_accvgpr_read_b32 v180, a16
v_accvgpr_read_b32 v181, a17
v_accvgpr_read_b32 v182, a18
v_accvgpr_read_b32 v183, a19
v_accvgpr_read_b32 v184, a20
v_accvgpr_read_b32 v185, a21
v_accvgpr_read_b32 v186, a22
v_accvgpr_read_b32 v187, a23
v_mul_f32 v180, v180, v188
v_mul_f32 v181, v181, v189
v_mul_f32 v182, v182, v190
v_mul_f32 v183, v183, v191
v_mul_f32 v184, v184, v188
v_mul_f32 v185, v185, v189
v_mul_f32 v186, v186, v190
v_mul_f32 v187, v187, v191
v_accvgpr_write_b32 a16, v180
v_accvgpr_write_b32 a17, v181
v_accvgpr_write_b32 a18, v182
v_accvgpr_write_b32 a19, v183
v_accvgpr_write_b32 a20, v184
v_accvgpr_write_b32 a21, v185
v_accvgpr_write_b32 a22, v186
v_accvgpr_write_b32 a23, v187
v_accvgpr_read_b32 v180, a24
v_accvgpr_read_b32 v181, a25
v_accvgpr_read_b32 v182, a26
v_accvgpr_read_b32 v183, a27
v_accvgpr_read_b32 v184, a28
v_accvgpr_read_b32 v185, a29
v_accvgpr_read_b32 v186, a30
v_accvgpr_read_b32 v187, a31
v_mul_f32 v180, v180, v188
v_mul_f32 v181, v181, v189
v_mul_f32 v182, v182, v190
v_mul_f32 v183, v183, v191
v_mul_f32 v184, v184, v188
v_mul_f32 v185, v185, v189
v_mul_f32 v186, v186, v190
v_mul_f32 v187, v187, v191
v_accvgpr_write_b32 a24, v180
v_accvgpr_write_b32 a25, v181
v_accvgpr_write_b32 a26, v182
v_accvgpr_write_b32 a27, v183
v_accvgpr_write_b32 a28, v184
v_accvgpr_write_b32 a29, v185
v_accvgpr_write_b32 a30, v186
v_accvgpr_write_b32 a31, v187
v_accvgpr_read_b32 v180, a32
v_accvgpr_read_b32 v181, a33
v_accvgpr_read_b32 v182, a34
v_accvgpr_read_b32 v183, a35
v_accvgpr_read_b32 v184, a36
v_accvgpr_read_b32 v185, a37
v_accvgpr_read_b32 v186, a38
v_accvgpr_read_b32 v187, a39
v_mul_f32 v180, v180, v188
v_mul_f32 v181, v181, v189
v_mul_f32 v182, v182, v190
v_mul_f32 v183, v183, v191
v_mul_f32 v184, v184, v188
v_mul_f32 v185, v185, v189
v_mul_f32 v186, v186, v190
v_mul_f32 v187, v187, v191
v_accvgpr_write_b32 a32, v180
v_accvgpr_write_b32 a33, v181
v_accvgpr_write_b32 a34, v182
v_accvgpr_write_b32 a35, v183
v_accvgpr_write_b32 a36, v184
v_accvgpr_write_b32 a37, v185
v_accvgpr_write_b32 a38, v186
v_accvgpr_write_b32 a39, v187
v_accvgpr_read_b32 v180, a40
v_accvgpr_read_b32 v181, a41
v_accvgpr_read_b32 v182, a42
v_accvgpr_read_b32 v183, a43
v_accvgpr_read_b32 v184, a44
v_accvgpr_read_b32 v185, a45
v_accvgpr_read_b32 v186, a46
v_accvgpr_read_b32 v187, a47
v_mul_f32 v180, v180, v188
v_mul_f32 v181, v181, v189
v_mul_f32 v182, v182, v190
v_mul_f32 v183, v183, v191
v_mul_f32 v184, v184, v188
v_mul_f32 v185, v185, v189
v_mul_f32 v186, v186, v190
v_mul_f32 v187, v187, v191
v_accvgpr_write_b32 a40, v180
v_accvgpr_write_b32 a41, v181
v_accvgpr_write_b32 a42, v182
v_accvgpr_write_b32 a43, v183
v_accvgpr_write_b32 a44, v184
v_accvgpr_write_b32 a45, v185
v_accvgpr_write_b32 a46, v186
v_accvgpr_write_b32 a47, v187
v_accvgpr_read_b32 v180, a48
v_accvgpr_read_b32 v181, a49
v_accvgpr_read_b32 v182, a50
v_accvgpr_read_b32 v183, a51
v_accvgpr_read_b32 v184, a52
v_accvgpr_read_b32 v185, a53
v_accvgpr_read_b32 v186, a54
v_accvgpr_read_b32 v187, a55
v_mul_f32 v180, v180, v188
v_mul_f32 v181, v181, v189
v_mul_f32 v182, v182, v190
v_mul_f32 v183, v183, v191
v_mul_f32 v184, v184, v188
v_mul_f32 v185, v185, v189
v_mul_f32 v186, v186, v190
v_mul_f32 v187, v187, v191
v_accvgpr_write_b32 a48, v180
v_accvgpr_write_b32 a49, v181
v_accvgpr_write_b32 a50, v182
v_accvgpr_write_b32 a51, v183
v_accvgpr_write_b32 a52, v184
v_accvgpr_write_b32 a53, v185
v_accvgpr_write_b32 a54, v186
v_accvgpr_write_b32 a55, v187
v_accvgpr_read_b32 v180, a56
v_accvgpr_read_b32 v181, a57
v_accvgpr_read_b32 v182, a58
v_accvgpr_read_b32 v183, a59
v_accvgpr_read_b32 v184, a60
v_accvgpr_read_b32 v185, a61
v_accvgpr_read_b32 v186, a62
v_accvgpr_read_b32 v187, a63
v_mul_f32 v180, v180, v188
v_mul_f32 v181, v181, v189
v_mul_f32 v182, v182, v190
v_mul_f32 v183, v183, v191
v_mul_f32 v184, v184, v188
v_mul_f32 v185, v185, v189
v_mul_f32 v186, v186, v190
v_mul_f32 v187, v187, v191
v_accvgpr_write_b32 a56, v180
v_accvgpr_write_b32 a57, v181
v_accvgpr_write_b32 a58, v182
v_accvgpr_write_b32 a59, v183
v_accvgpr_write_b32 a60, v184
v_accvgpr_write_b32 a61, v185
v_accvgpr_write_b32 a62, v186
v_accvgpr_write_b32 a63, v187
LT_nors:
s_waitcnt lgkmcnt(0)
s_nop 1
v_mfma_f32_16x16x32_bf16 a[0:3], v[168:171], v[96:99], a[0:3]
v_mfma_f32_16x16x32_bf16 a[4:7], v[168:171], v[100:103], a[4:7]
v_mfma_f32_16x16x32_bf16 a[8:11], v[168:171], v[104:107], a[8:11]
v_mfma_f32_16x16x32_bf16 a[12:15], v[168:171], v[108:111], a[12:15]
v_mfma_f32_16x16x32_bf16 a[16:19], v[168:171], v[112:115], a[16:19]
v_mfma_f32_16x16x32_bf16 a[20:23], v[168:171], v[116:119], a[20:23]
v_mfma_f32_16x16x32_bf16 a[24:27], v[168:171], v[120:123], a[24:27]
v_mfma_f32_16x16x32_bf16 a[28:31], v[168:171], v[124:127], a[28:31]
v_mfma_f32_16x16x32_bf16 a[32:35], v[168:171], v[128:131], a[32:35]
v_mfma_f32_16x16x32_bf16 a[36:39], v[168:171], v[132:135], a[36:39]
v_mfma_f32_16x16x32_bf16 a[40:43], v[168:171], v[136:139], a[40:43]
v_mfma_f32_16x16x32_bf16 a[44:47], v[168:171], v[140:143], a[44:47]
v_mfma_f32_16x16x32_bf16 a[48:51], v[168:171], v[144:147], a[48:51]
v_mfma_f32_16x16x32_bf16 a[52:55], v[168:171], v[148:151], a[52:55]
v_mfma_f32_16x16x32_bf16 a[56:59], v[168:171], v[152:155], a[56:59]
v_mfma_f32_16x16x32_bf16 a[60:63], v[168:171], v[156:159], a[60:63]
s_sub_u32 s51, s51, 1
s_cmp_lg_u32 s51, 0
s_cbranch_scc1 LT_loop
s_nop 15
v_accvgpr_read_b32 v180, a0
v_accvgpr_read_b32 v181, a1
v_accvgpr_read_b32 v182, a2
v_accvgpr_read_b32 v183, a3
v_accvgpr_read_b32 v184, a4
v_accvgpr_read_b32 v185, a5
v_accvgpr_read_b32 v186, a6
v_accvgpr_read_b32 v187, a7
v_cvt_pk_bf16_f32 v32, v180, v181
v_cvt_pk_bf16_f32 v33, v182, v183
v_cvt_pk_bf16_f32 v34, v184, v185
v_cvt_pk_bf16_f32 v35, v186, v187
buffer_store_dwordx4 v[32:35], v248, s[20:23], s40 offen offset:0 sc1
v_accvgpr_read_b32 v180, a8
v_accvgpr_read_b32 v181, a9
v_accvgpr_read_b32 v182, a10
v_accvgpr_read_b32 v183, a11
v_accvgpr_read_b32 v184, a12
v_accvgpr_read_b32 v185, a13
v_accvgpr_read_b32 v186, a14
v_accvgpr_read_b32 v187, a15
v_cvt_pk_bf16_f32 v36, v180, v181
v_cvt_pk_bf16_f32 v37, v182, v183
v_cvt_pk_bf16_f32 v38, v184, v185
v_cvt_pk_bf16_f32 v39, v186, v187
buffer_store_dwordx4 v[36:39], v248, s[20:23], s40 offen offset:1024 sc1
v_accvgpr_read_b32 v180, a16
v_accvgpr_read_b32 v181, a17
v_accvgpr_read_b32 v182, a18
v_accvgpr_read_b32 v183, a19
v_accvgpr_read_b32 v184, a20
v_accvgpr_read_b32 v185, a21
v_accvgpr_read_b32 v186, a22
v_accvgpr_read_b32 v187, a23
v_cvt_pk_bf16_f32 v40, v180, v181
v_cvt_pk_bf16_f32 v41, v182, v183
v_cvt_pk_bf16_f32 v42, v184, v185
v_cvt_pk_bf16_f32 v43, v186, v187
buffer_store_dwordx4 v[40:43], v248, s[20:23], s40 offen offset:2048 sc1
v_accvgpr_read_b32 v180, a24
v_accvgpr_read_b32 v181, a25
v_accvgpr_read_b32 v182, a26
v_accvgpr_read_b32 v183, a27
v_accvgpr_read_b32 v184, a28
v_accvgpr_read_b32 v185, a29
v_accvgpr_read_b32 v186, a30
v_accvgpr_read_b32 v187, a31
v_cvt_pk_bf16_f32 v44, v180, v181
v_cvt_pk_bf16_f32 v45, v182, v183
v_cvt_pk_bf16_f32 v46, v184, v185
v_cvt_pk_bf16_f32 v47, v186, v187
buffer_store_dwordx4 v[44:47], v248, s[20:23], s40 offen offset:3072 sc1
v_accvgpr_read_b32 v180, a32
v_accvgpr_read_b32 v181, a33
v_accvgpr_read_b32 v182, a34
v_accvgpr_read_b32 v183, a35
v_accvgpr_read_b32 v184, a36
v_accvgpr_read_b32 v185, a37
v_accvgpr_read_b32 v186, a38
v_accvgpr_read_b32 v187, a39
v_cvt_pk_bf16_f32 v48, v180, v181
v_cvt_pk_bf16_f32 v49, v182, v183
v_cvt_pk_bf16_f32 v50, v184, v185
v_cvt_pk_bf16_f32 v51, v186, v187
buffer_store_dwordx4 v[48:51], v248, s[20:23], s44 offen offset:0 sc1
v_accvgpr_read_b32 v180, a40
v_accvgpr_read_b32 v181, a41
v_accvgpr_read_b32 v182, a42
v_accvgpr_read_b32 v183, a43
v_accvgpr_read_b32 v184, a44
v_accvgpr_read_b32 v185, a45
v_accvgpr_read_b32 v186, a46
v_accvgpr_read_b32 v187, a47
v_cvt_pk_bf16_f32 v52, v180, v181
v_cvt_pk_bf16_f32 v53, v182, v183
v_cvt_pk_bf16_f32 v54, v184, v185
v_cvt_pk_bf16_f32 v55, v186, v187
buffer_store_dwordx4 v[52:55], v248, s[20:23], s44 offen offset:1024 sc1
v_accvgpr_read_b32 v180, a48
v_accvgpr_read_b32 v181, a49
v_accvgpr_read_b32 v182, a50
v_accvgpr_read_b32 v183, a51
v_accvgpr_read_b32 v184, a52
v_accvgpr_read_b32 v185, a53
v_accvgpr_read_b32 v186, a54
v_accvgpr_read_b32 v187, a55
v_cvt_pk_bf16_f32 v56, v180, v181
v_cvt_pk_bf16_f32 v57, v182, v183
v_cvt_pk_bf16_f32 v58, v184, v185
v_cvt_pk_bf16_f32 v59, v186, v187
buffer_store_dwordx4 v[56:59], v248, s[20:23], s44 offen offset:2048 sc1
v_accvgpr_read_b32 v180, a56
v_accvgpr_read_b32 v181, a57
v_accvgpr_read_b32 v182, a58
v_accvgpr_read_b32 v183, a59
v_accvgpr_read_b32 v184, a60
v_accvgpr_read_b32 v185, a61
v_accvgpr_read_b32 v186, a62
v_accvgpr_read_b32 v187, a63
v_cvt_pk_bf16_f32 v60, v180, v181
v_cvt_pk_bf16_f32 v61, v182, v183
v_cvt_pk_bf16_f32 v62, v184, v185
v_cvt_pk_bf16_f32 v63, v186, v187
buffer_store_dwordx4 v[60:63], v248, s[20:23], s44 offen offset:3072 sc1
v_mov_b32 v176, v173
s_nop 1
v_permlane32_swap_b32 v173, v176
s_nop 1
v_add_f32 v173, v173, v176
v_mov_b32 v176, v173
s_nop 1
v_permlane16_swap_b32 v173, v176
s_nop 1
v_add_f32 v173, v173, v176
v_lshlrev_b32 v175, 2, v248
s_mov_b64 exec, 0xffff
s_mov_b64 exec, -1
v_bfe_u32 v175, v248, 8, 1
v_mul_u32_u24 v175, 48, v175
v_lshl_add_u32 v175, s37, 3, v175
v_and_b32 v176, 0xf0, v248
v_lshl_add_u32 v175, v176, 3, v175
s_mov_b32 exec_hi, 0
buffer_store_dwordx2 v[172:173], v175, s[24:27], s48 offen sc1
s_add_u32 s16, s4, 0x7c00000
s_addc_u32 s17, s5, 0
s_mov_b32 s18, 0x40000
s_mov_b32 s19, 0x00020000
s_add_u32 s48, s37, 1248
s_mul_i32 s48, s48, 128
s_waitcnt vmcnt(0)
v_mov_b32 v176, s98
v_mov_b32 v177, s99
s_mov_b64 exec, 1
buffer_store_dwordx2 v[176:177], off, s[16:19], s48 sc1
buffer_store_dwordx2 v[176:177], off, s[16:19], s48 offset:8 sc1
s_mov_b64 exec, -1
s_branch L2_fin
LE_start:
s_cmp_ge_u32 s37, 32
s_cbranch_scc1 L2_end
v_lshrrev_b32 v1, 6, v0
s_sub_u32 s37, s37, 30
s_lshl_b32 s35, s35, 1
v_readfirstlane_b32 s41, v1
s_add_u32 s35, s35, s37
s_mul_i32 s35, s35, 3
s_add_u32 s40, s35, s41
s_cmp_ge_u32 s41, 3
s_cbranch_scc1 L2_end
LE_common:
v_and_b32 v1, 63, v0
s_sub_u32 s36, s40, 0
s_mov_b32 s54, 154
s_mul_i32 s36, s36, 154
s_mov_b32 s55, s36
s_sub_u32 s36, s40, 24
s_cselect_b32 s54, s54, 169
s_mul_i32 s36, s36, 169
s_add_u32 s36, s36, 3696
s_cmp_lt_u32 s40, 24
s_cselect_b32 s55, s55, s36
s_sub_u32 s36, s40, 48
s_cselect_b32 s54, s54, 141
s_mul_i32 s36, s36, 141
s_add_u32 s36, s36, 7752
s_cmp_lt_u32 s40, 48
s_cselect_b32 s55, s55, s36
s_mov_b32 s42, 0
s_mov_b32 s49, 512
v_lshrrev_b32 v33, 2, v1
v_and_b32 v34, 3, v1
v_mul_u32_u24 v6, 0xa000, v33
v_lshl_add_u32 v6, v34, 4, v6
v_lshlrev_b32 v33, 2, v33
s_mul_i32 s50, s40, 655360
s_mul_i32 s48, s40, 64
s_waitcnt lgkmcnt(0)
s_add_u32 s8, s4, 0x7c2a000
s_addc_u32 s9, s5, 0
s_mov_b32 s10, 0x8000
s_mov_b32 s11, 0x00020000
v_and_b32 v200, 63, v0
v_lshlrev_b32 v200, 7, v200
s_mov_b32 s91, 8192
s_mov_b32 s90, 16384
s_mov_b32 s95, 24576
s_mov_b32 s94, 0x10000
LE_poll:
buffer_load_dwordx2 v[192:193], v200, s[8:11], 0 offen sc1
buffer_load_dwordx2 v[194:195], v200, s[8:11], s91 offen sc1
buffer_load_dwordx2 v[196:197], v200, s[8:11], s90 offen sc1
buffer_load_dwordx2 v[198:199], v200, s[8:11], s95 offen sc1
s_sub_u32 s94, s94, 1
s_waitcnt vmcnt(0)
s_cbranch_scc1 LE_poll_go
v_cmp_ne_u64 vcc, s[98:99], v[192:193]
s_nop 1
s_cbranch_vccnz LE_poll
v_cmp_ne_u64 vcc, s[98:99], v[194:195]
s_nop 1
s_cbranch_vccnz LE_poll
v_cmp_ne_u64 vcc, s[98:99], v[196:197]
s_nop 1
s_cbranch_vccnz LE_poll
v_cmp_ne_u64 vcc, s[98:99], v[198:199]
s_nop 1
s_cbranch_vccnz LE_poll
LE_poll_go:
s_cmp_lg_u32 s40, 0
s_cbranch_scc1 LE_nobump
s_mov_b32 s90, 89984
s_mov_b32 s10, 90112
v_mov_b32 v192, s98
v_mov_b32 v193, s99
s_mov_b64 exec, 1
buffer_store_dwordx2 v[192:193], off, s[8:11], s90 sc1
s_mov_b64 exec, -1
LE_nobump:
s_add_u32 s8, s4, 0x7800000
s_addc_u32 s9, s5, 0
s_mov_b32 s10, 0x1000
s_mov_b32 s11, 0x00020000
s_add_u32 s12, s4, 0x8000000
s_addc_u32 s13, s5, 0
s_mov_b32 s14, 0x2800000
s_mov_b32 s15, 0x00020000
buffer_load_dword v4, v33, s[8:11], s48 offen sc1
buffer_load_dwordx4 v[192:195], v6, s[12:15], s50 offen offset:0 sc1
buffer_load_dwordx4 v[196:199], v6, s[12:15], s50 offen offset:64 sc1
buffer_load_dwordx4 v[200:203], v6, s[12:15], s50 offen offset:128 sc1
buffer_load_dwordx4 v[204:207], v6, s[12:15], s50 offen offset:192 sc1
buffer_load_dwordx4 v[208:211], v6, s[12:15], s50 offen offset:256 sc1
buffer_load_dwordx4 v[212:215], v6, s[12:15], s50 offen offset:320 sc1
buffer_load_dwordx4 v[216:219], v6, s[12:15], s50 offen offset:384 sc1
buffer_load_dwordx4 v[220:223], v6, s[12:15], s50 offen offset:448 sc1
buffer_load_dwordx4 v[224:227], v6, s[12:15], s50 offen offset:512 sc1
buffer_load_dwordx4 v[228:231], v6, s[12:15], s50 offen offset:576 sc1
buffer_load_dwordx4 v[232:235], v6, s[12:15], s50 offen offset:640 sc1
buffer_load_dwordx4 v[236:239], v6, s[12:15], s50 offen offset:704 sc1
buffer_load_dwordx4 v[240:243], v6, s[12:15], s50 offen offset:768 sc1
buffer_load_dwordx4 v[244:247], v6, s[12:15], s50 offen offset:832 sc1
buffer_load_dwordx4 v[248:251], v6, s[12:15], s50 offen offset:896 sc1
buffer_load_dwordx4 v[252:255], v6, s[12:15], s50 offen offset:960 sc1
s_add_u32 s16, s4, 0x6800000
s_addc_u32 s17, s5, 0
s_mov_b32 s18, 0x4e2000
s_mov_b32 s19, 0x00020000
s_add_u32 s20, s4, 0x7000000
s_addc_u32 s21, s5, 0
s_mov_b32 s22, 0x4e2000
s_mov_b32 s23, 0x00020000
v_lshlrev_b32 v5, 2, v34
v_and_b32 v2, 15, v1
v_lshrrev_b32 v3, 4, v1
v_mov_b32 v16, 1
v_mov_b32 v17, 4
v_and_b32 v33, 1, v2
v_lshlrev_b32 v33, 4, v33
v_lshlrev_b32 v33, v33, v16
v_mul_u32_u24 v33, 0x3f80, v33
v_lshrrev_b32 v34, 1, v2
v_cmp_eq_u32 vcc, 0, v34
s_nop 1
v_cndmask_b32 v40, 0, v33, vcc
v_cmp_eq_u32 vcc, 1, v34
s_nop 1
v_cndmask_b32 v41, 0, v33, vcc
v_cmp_eq_u32 vcc, 2, v34
s_nop 1
v_cndmask_b32 v42, 0, v33, vcc
v_cmp_eq_u32 vcc, 3, v34
s_nop 1
v_cndmask_b32 v43, 0, v33, vcc
v_cmp_eq_u32 vcc, 4, v34
s_nop 1
v_cndmask_b32 v44, 0, v33, vcc
v_cmp_eq_u32 vcc, 5, v34
s_nop 1
v_cndmask_b32 v45, 0, v33, vcc
v_cmp_eq_u32 vcc, 6, v34
s_nop 1
v_cndmask_b32 v46, 0, v33, vcc
v_cmp_eq_u32 vcc, 7, v34
s_nop 1
v_cndmask_b32 v47, 0, v33, vcc
v_lshlrev_b32 v39, 5, v2
v_lshl_add_u32 v39, v3, 3, v39
v_lshlrev_b32 v2, 4, v2
s_mul_i32 s48, s41, 21504
s_add_u32 s48, s48, 4096
v_mov_b32 v36, s48
v_lshl_add_u32 v38, v3, 2, v36
s_lshl_b32 s36, s41, 10
s_lshl_b32 s35, s55, 2
s_sub_u32 s35, s36, s35
v_mov_b32 v7, s35
v_lshlrev_b32 v35, 4, v1
v_add_u32 v68, s48, v35
v_add_u32 v35, s36, v35
v_lshlrev_b32 v33, 2, v1
v_mov_b32 v72, 0xffff
v_mov_b32 v73, 0xffff
v_mov_b32 v74, 0xffff
v_mov_b32 v75, 0xffff
v_cmp_gt_u32 vcc, s54, v33
v_mov_b32 v48, 0
s_nop 0
v_cndmask_b32 v18, 0, v16, vcc
v_add_u32 v33, 1, v33
v_cmp_gt_u32 vcc, s54, v33
v_mov_b32 v49, 0
s_nop 0
v_cndmask_b32 v19, 0, v16, vcc
v_add_u32 v33, 1, v33
v_cmp_gt_u32 vcc, s54, v33
v_mov_b32 v50, 0
s_nop 0
v_cndmask_b32 v20, 0, v16, vcc
v_add_u32 v33, 1, v33
v_cmp_gt_u32 vcc, s54, v33
v_mov_b32 v51, 0
s_nop 0
v_cndmask_b32 v21, 0, v16, vcc
LE_pass:
ds_write_b128 v35, v[48:51]
ds_write_b128 v68, v[72:75] offset:0
ds_write_b128 v68, v[72:75] offset:1024
ds_write_b128 v68, v[72:75] offset:2048
ds_write_b128 v68, v[72:75] offset:3072
ds_write_b128 v68, v[72:75] offset:4096
ds_write_b128 v68, v[72:75] offset:5120
ds_write_b128 v68, v[72:75] offset:6144
ds_write_b128 v68, v[72:75] offset:7168
ds_write_b128 v68, v[72:75] offset:8192
ds_write_b128 v68, v[72:75] offset:9216
ds_write_b128 v68, v[72:75] offset:10240
ds_write_b128 v68, v[72:75] offset:11264
ds_write_b128 v68, v[72:75] offset:12288
ds_write_b128 v68, v[72:75] offset:13312
ds_write_b128 v68, v[72:75] offset:14336
ds_write_b128 v68, v[72:75] offset:15360
ds_write_b128 v68, v[72:75] offset:16384
ds_write_b128 v68, v[72:75] offset:17408
ds_write_b128 v68, v[72:75] offset:18432
ds_write_b128 v68, v[72:75] offset:19456
v_lshl_add_u32 v32, v1, 2, v36
ds_write_b32 v32, v48 offset:20480
s_waitcnt vmcnt(16)
v_sub_u32 v32, v4, v5
s_waitcnt vmcnt(15)
v_cmpx_lt_i32 vcc, 0, v32
s_cbranch_execz LE_c
v_mad_u32_u16 v128, v192, 1, v7 op_sel:[1,0,0,0]
ds_add_u32 v128, v16
v_cmpx_lt_i32 vcc, 1, v32
v_mad_u32_u16 v129, v193, 1, v7 op_sel:[1,0,0,0]
ds_add_u32 v129, v16
v_cmpx_lt_i32 vcc, 2, v32
v_mad_u32_u16 v130, v194, 1, v7 op_sel:[1,0,0,0]
ds_add_u32 v130, v16
v_cmpx_lt_i32 vcc, 3, v32
v_mad_u32_u16 v131, v195, 1, v7 op_sel:[1,0,0,0]
ds_add_u32 v131, v16
s_waitcnt vmcnt(14)
v_cmpx_lt_i32 vcc, 16, v32
s_cbranch_execz LE_c
v_mad_u32_u16 v132, v196, 1, v7 op_sel:[1,0,0,0]
ds_add_u32 v132, v16
v_cmpx_lt_i32 vcc, 17, v32
v_mad_u32_u16 v133, v197, 1, v7 op_sel:[1,0,0,0]
ds_add_u32 v133, v16
v_cmpx_lt_i32 vcc, 18, v32
v_mad_u32_u16 v134, v198, 1, v7 op_sel:[1,0,0,0]
ds_add_u32 v134, v16
v_cmpx_lt_i32 vcc, 19, v32
v_mad_u32_u16 v135, v199, 1, v7 op_sel:[1,0,0,0]
ds_add_u32 v135, v16
s_waitcnt vmcnt(13)
v_cmpx_lt_i32 vcc, 32, v32
s_cbranch_execz LE_c
v_mad_u32_u16 v136, v200, 1, v7 op_sel:[1,0,0,0]
ds_add_u32 v136, v16
v_cmpx_lt_i32 vcc, 33, v32
v_mad_u32_u16 v137, v201, 1, v7 op_sel:[1,0,0,0]
ds_add_u32 v137, v16
v_cmpx_lt_i32 vcc, 34, v32
v_mad_u32_u16 v138, v202, 1, v7 op_sel:[1,0,0,0]
ds_add_u32 v138, v16
v_cmpx_lt_i32 vcc, 35, v32
v_mad_u32_u16 v139, v203, 1, v7 op_sel:[1,0,0,0]
ds_add_u32 v139, v16
s_waitcnt vmcnt(12)
v_cmpx_lt_i32 vcc, 48, v32
s_cbranch_execz LE_c
v_mad_u32_u16 v140, v204, 1, v7 op_sel:[1,0,0,0]
ds_add_u32 v140, v16
v_cmpx_lt_i32 vcc, 49, v32
v_mad_u32_u16 v141, v205, 1, v7 op_sel:[1,0,0,0]
ds_add_u32 v141, v16
v_cmpx_lt_i32 vcc, 50, v32
v_mad_u32_u16 v142, v206, 1, v7 op_sel:[1,0,0,0]
ds_add_u32 v142, v16
v_cmpx_lt_i32 vcc, 51, v32
v_mad_u32_u16 v143, v207, 1, v7 op_sel:[1,0,0,0]
ds_add_u32 v143, v16
s_waitcnt vmcnt(11)
v_cmpx_lt_i32 vcc, 64, v32
s_cbranch_execz LE_c
v_mad_u32_u16 v144, v208, 1, v7 op_sel:[1,0,0,0]
ds_add_u32 v144, v16
v_cmpx_lt_i32 vcc, 65, v32
v_mad_u32_u16 v145, v209, 1, v7 op_sel:[1,0,0,0]
ds_add_u32 v145, v16
v_cmpx_lt_i32 vcc, 66, v32
v_mad_u32_u16 v146, v210, 1, v7 op_sel:[1,0,0,0]
ds_add_u32 v146, v16
v_cmpx_lt_i32 vcc, 67, v32
v_mad_u32_u16 v147, v211, 1, v7 op_sel:[1,0,0,0]
ds_add_u32 v147, v16
s_waitcnt vmcnt(10)
v_cmpx_lt_i32 vcc, 80, v32
s_cbranch_execz LE_c
v_mad_u32_u16 v148, v212, 1, v7 op_sel:[1,0,0,0]
ds_add_u32 v148, v16
v_cmpx_lt_i32 vcc, 81, v32
v_mad_u32_u16 v149, v213, 1, v7 op_sel:[1,0,0,0]
ds_add_u32 v149, v16
v_cmpx_lt_i32 vcc, 82, v32
v_mad_u32_u16 v150, v214, 1, v7 op_sel:[1,0,0,0]
ds_add_u32 v150, v16
v_cmpx_lt_i32 vcc, 83, v32
v_mad_u32_u16 v151, v215, 1, v7 op_sel:[1,0,0,0]
ds_add_u32 v151, v16
s_waitcnt vmcnt(9)
v_cmpx_lt_i32 vcc, 96, v32
s_cbranch_execz LE_c
v_mad_u32_u16 v152, v216, 1, v7 op_sel:[1,0,0,0]
ds_add_u32 v152, v16
v_cmpx_lt_i32 vcc, 97, v32
v_mad_u32_u16 v153, v217, 1, v7 op_sel:[1,0,0,0]
ds_add_u32 v153, v16
v_cmpx_lt_i32 vcc, 98, v32
v_mad_u32_u16 v154, v218, 1, v7 op_sel:[1,0,0,0]
ds_add_u32 v154, v16
v_cmpx_lt_i32 vcc, 99, v32
v_mad_u32_u16 v155, v219, 1, v7 op_sel:[1,0,0,0]
ds_add_u32 v155, v16
s_waitcnt vmcnt(8)
v_cmpx_lt_i32 vcc, 112, v32
s_cbranch_execz LE_c
v_mad_u32_u16 v156, v220, 1, v7 op_sel:[1,0,0,0]
ds_add_u32 v156, v16
v_cmpx_lt_i32 vcc, 113, v32
v_mad_u32_u16 v157, v221, 1, v7 op_sel:[1,0,0,0]
ds_add_u32 v157, v16
v_cmpx_lt_i32 vcc, 114, v32
v_mad_u32_u16 v158, v222, 1, v7 op_sel:[1,0,0,0]
ds_add_u32 v158, v16
v_cmpx_lt_i32 vcc, 115, v32
v_mad_u32_u16 v159, v223, 1, v7 op_sel:[1,0,0,0]
ds_add_u32 v159, v16
s_waitcnt vmcnt(7)
v_cmpx_lt_i32 vcc, 128, v32
s_cbranch_execz LE_c
v_mad_u32_u16 v160, v224, 1, v7 op_sel:[1,0,0,0]
ds_add_u32 v160, v16
v_cmpx_lt_i32 vcc, 129, v32
v_mad_u32_u16 v161, v225, 1, v7 op_sel:[1,0,0,0]
ds_add_u32 v161, v16
v_cmpx_lt_i32 vcc, 130, v32
v_mad_u32_u16 v162, v226, 1, v7 op_sel:[1,0,0,0]
ds_add_u32 v162, v16
v_cmpx_lt_i32 vcc, 131, v32
v_mad_u32_u16 v163, v227, 1, v7 op_sel:[1,0,0,0]
ds_add_u32 v163, v16
s_waitcnt vmcnt(6)
v_cmpx_lt_i32 vcc, 144, v32
s_cbranch_execz LE_c
v_mad_u32_u16 v164, v228, 1, v7 op_sel:[1,0,0,0]
ds_add_u32 v164, v16
v_cmpx_lt_i32 vcc, 145, v32
v_mad_u32_u16 v165, v229, 1, v7 op_sel:[1,0,0,0]
ds_add_u32 v165, v16
v_cmpx_lt_i32 vcc, 146, v32
v_mad_u32_u16 v166, v230, 1, v7 op_sel:[1,0,0,0]
ds_add_u32 v166, v16
v_cmpx_lt_i32 vcc, 147, v32
v_mad_u32_u16 v167, v231, 1, v7 op_sel:[1,0,0,0]
ds_add_u32 v167, v16
s_waitcnt vmcnt(5)
v_cmpx_lt_i32 vcc, 160, v32
s_cbranch_execz LE_c
v_mad_u32_u16 v168, v232, 1, v7 op_sel:[1,0,0,0]
ds_add_u32 v168, v16
v_cmpx_lt_i32 vcc, 161, v32
v_mad_u32_u16 v169, v233, 1, v7 op_sel:[1,0,0,0]
ds_add_u32 v169, v16
v_cmpx_lt_i32 vcc, 162, v32
v_mad_u32_u16 v170, v234, 1, v7 op_sel:[1,0,0,0]
ds_add_u32 v170, v16
v_cmpx_lt_i32 vcc, 163, v32
v_mad_u32_u16 v171, v235, 1, v7 op_sel:[1,0,0,0]
ds_add_u32 v171, v16
s_waitcnt vmcnt(4)
v_cmpx_lt_i32 vcc, 176, v32
s_cbranch_execz LE_c
v_mad_u32_u16 v172, v236, 1, v7 op_sel:[1,0,0,0]
ds_add_u32 v172, v16
v_cmpx_lt_i32 vcc, 177, v32
v_mad_u32_u16 v173, v237, 1, v7 op_sel:[1,0,0,0]
ds_add_u32 v173, v16
v_cmpx_lt_i32 vcc, 178, v32
v_mad_u32_u16 v174, v238, 1, v7 op_sel:[1,0,0,0]
ds_add_u32 v174, v16
v_cmpx_lt_i32 vcc, 179, v32
v_mad_u32_u16 v175, v239, 1, v7 op_sel:[1,0,0,0]
ds_add_u32 v175, v16
s_waitcnt vmcnt(3)
v_cmpx_lt_i32 vcc, 192, v32
s_cbranch_execz LE_c
v_mad_u32_u16 v176, v240, 1, v7 op_sel:[1,0,0,0]
ds_add_u32 v176, v16
v_cmpx_lt_i32 vcc, 193, v32
v_mad_u32_u16 v177, v241, 1, v7 op_sel:[1,0,0,0]
ds_add_u32 v177, v16
v_cmpx_lt_i32 vcc, 194, v32
v_mad_u32_u16 v178, v242, 1, v7 op_sel:[1,0,0,0]
ds_add_u32 v178, v16
v_cmpx_lt_i32 vcc, 195, v32
v_mad_u32_u16 v179, v243, 1, v7 op_sel:[1,0,0,0]
ds_add_u32 v179, v16
s_waitcnt vmcnt(2)
v_cmpx_lt_i32 vcc, 208, v32
s_cbranch_execz LE_c
v_mad_u32_u16 v180, v244, 1, v7 op_sel:[1,0,0,0]
ds_add_u32 v180, v16
v_cmpx_lt_i32 vcc, 209, v32
v_mad_u32_u16 v181, v245, 1, v7 op_sel:[1,0,0,0]
ds_add_u32 v181, v16
v_cmpx_lt_i32 vcc, 210, v32
v_mad_u32_u16 v182, v246, 1, v7 op_sel:[1,0,0,0]
ds_add_u32 v182, v16
v_cmpx_lt_i32 vcc, 211, v32
v_mad_u32_u16 v183, v247, 1, v7 op_sel:[1,0,0,0]
ds_add_u32 v183, v16
s_waitcnt vmcnt(1)
v_cmpx_lt_i32 vcc, 224, v32
s_cbranch_execz LE_c
v_mad_u32_u16 v184, v248, 1, v7 op_sel:[1,0,0,0]
ds_add_u32 v184, v16
v_cmpx_lt_i32 vcc, 225, v32
v_mad_u32_u16 v185, v249, 1, v7 op_sel:[1,0,0,0]
ds_add_u32 v185, v16
v_cmpx_lt_i32 vcc, 226, v32
v_mad_u32_u16 v186, v250, 1, v7 op_sel:[1,0,0,0]
ds_add_u32 v186, v16
v_cmpx_lt_i32 vcc, 227, v32
v_mad_u32_u16 v187, v251, 1, v7 op_sel:[1,0,0,0]
ds_add_u32 v187, v16
s_waitcnt vmcnt(0)
v_cmpx_lt_i32 vcc, 240, v32
s_cbranch_execz LE_c
v_mad_u32_u16 v188, v252, 1, v7 op_sel:[1,0,0,0]
ds_add_u32 v188, v16
v_cmpx_lt_i32 vcc, 241, v32
v_mad_u32_u16 v189, v253, 1, v7 op_sel:[1,0,0,0]
ds_add_u32 v189, v16
v_cmpx_lt_i32 vcc, 242, v32
v_mad_u32_u16 v190, v254, 1, v7 op_sel:[1,0,0,0]
ds_add_u32 v190, v16
v_cmpx_lt_i32 vcc, 243, v32
v_mad_u32_u16 v191, v255, 1, v7 op_sel:[1,0,0,0]
ds_add_u32 v191, v16
LE_c:
s_mov_b64 exec, -1
ds_read_b128 v[24:27], v35
s_waitcnt lgkmcnt(0)
v_add_u32 v24, 3, v24
v_lshrrev_b32 v24, 2, v24
v_max_u32 v24, v24, v18
v_add_u32 v25, 3, v25
v_lshrrev_b32 v25, 2, v25
v_max_u32 v25, v25, v19
v_add_u32 v26, 3, v26
v_lshrrev_b32 v26, 2, v26
v_max_u32 v26, v26, v20
v_add_u32 v27, 3, v27
v_lshrrev_b32 v27, 2, v27
v_max_u32 v27, v27, v21
v_add_u32 v33, v24, v25
v_add3_u32 v33, v33, v26, v27
v_mov_b32 v64, v33
s_nop 1
v_add_u32_dpp v64, v64, v64 row_shr:1 row_mask:0xf bank_mask:0xf
s_nop 1
v_add_u32_dpp v64, v64, v64 row_shr:2 row_mask:0xf bank_mask:0xf
s_nop 1
v_add_u32_dpp v64, v64, v64 row_shr:4 row_mask:0xf bank_mask:0xf
s_nop 1
v_add_u32_dpp v64, v64, v64 row_shr:8 row_mask:0xf bank_mask:0xf
s_nop 1
v_add_u32_dpp v64, v64, v64 row_bcast:15 row_mask:0xa bank_mask:0xf
s_nop 1
v_add_u32_dpp v64, v64, v64 row_bcast:31 row_mask:0xc bank_mask:0xf
s_nop 1
v_readlane_b32 s44, v64, 63
v_sub_u32 v28, v64, v33
v_add_u32 v29, v28, v24
v_add_u32 v30, v29, v25
v_add_u32 v31, v30, v26
v_add3_u32 v33, v28, v24, -1
v_lshlrev_b32 v34, v33, v18
v_lshrrev_b32 v33, 5, v33
v_lshl_add_u32 v33, v33, 2, v36
ds_or_b32 v33, v34 offset:20480
v_lshl_add_u32 v28, v28, 4, v36
v_add3_u32 v33, v29, v25, -1
v_lshlrev_b32 v34, v33, v19
v_lshrrev_b32 v33, 5, v33
v_lshl_add_u32 v33, v33, 2, v36
ds_or_b32 v33, v34 offset:20480
v_lshl_add_u32 v29, v29, 4, v36
v_add3_u32 v33, v30, v26, -1
v_lshlrev_b32 v34, v33, v20
v_lshrrev_b32 v33, 5, v33
v_lshl_add_u32 v33, v33, 2, v36
ds_or_b32 v33, v34 offset:20480
v_lshl_add_u32 v30, v30, 4, v36
v_add3_u32 v33, v31, v27, -1
v_lshlrev_b32 v34, v33, v21
v_lshrrev_b32 v33, 5, v33
v_lshl_add_u32 v33, v33, 2, v36
ds_or_b32 v33, v34 offset:20480
v_lshl_add_u32 v31, v31, 4, v36
ds_write_b128 v35, v[28:31]
s_add_u32 s44, s44, 31
s_lshr_b32 s44, s44, 5
v_cmpx_lt_i32 vcc, 0, v32
s_cbranch_execz LE_p
ds_add_rtn_u32 v128, v128, v17
v_cmpx_lt_i32 vcc, 1, v32
ds_add_rtn_u32 v129, v129, v17
v_cmpx_lt_i32 vcc, 2, v32
ds_add_rtn_u32 v130, v130, v17
v_cmpx_lt_i32 vcc, 3, v32
ds_add_rtn_u32 v131, v131, v17
v_cmpx_lt_i32 vcc, 16, v32
s_cbranch_execz LE_p
ds_add_rtn_u32 v132, v132, v17
v_cmpx_lt_i32 vcc, 17, v32
ds_add_rtn_u32 v133, v133, v17
v_cmpx_lt_i32 vcc, 18, v32
ds_add_rtn_u32 v134, v134, v17
v_cmpx_lt_i32 vcc, 19, v32
ds_add_rtn_u32 v135, v135, v17
v_cmpx_lt_i32 vcc, 32, v32
s_cbranch_execz LE_p
ds_add_rtn_u32 v136, v136, v17
v_cmpx_lt_i32 vcc, 33, v32
ds_add_rtn_u32 v137, v137, v17
v_cmpx_lt_i32 vcc, 34, v32
ds_add_rtn_u32 v138, v138, v17
v_cmpx_lt_i32 vcc, 35, v32
ds_add_rtn_u32 v139, v139, v17
v_cmpx_lt_i32 vcc, 48, v32
s_cbranch_execz LE_p
ds_add_rtn_u32 v140, v140, v17
v_cmpx_lt_i32 vcc, 49, v32
ds_add_rtn_u32 v141, v141, v17
v_cmpx_lt_i32 vcc, 50, v32
ds_add_rtn_u32 v142, v142, v17
v_cmpx_lt_i32 vcc, 51, v32
ds_add_rtn_u32 v143, v143, v17
v_cmpx_lt_i32 vcc, 64, v32
s_cbranch_execz LE_p
ds_add_rtn_u32 v144, v144, v17
v_cmpx_lt_i32 vcc, 65, v32
ds_add_rtn_u32 v145, v145, v17
v_cmpx_lt_i32 vcc, 66, v32
ds_add_rtn_u32 v146, v146, v17
v_cmpx_lt_i32 vcc, 67, v32
ds_add_rtn_u32 v147, v147, v17
v_cmpx_lt_i32 vcc, 80, v32
s_cbranch_execz LE_p
ds_add_rtn_u32 v148, v148, v17
v_cmpx_lt_i32 vcc, 81, v32
ds_add_rtn_u32 v149, v149, v17
v_cmpx_lt_i32 vcc, 82, v32
ds_add_rtn_u32 v150, v150, v17
v_cmpx_lt_i32 vcc, 83, v32
ds_add_rtn_u32 v151, v151, v17
v_cmpx_lt_i32 vcc, 96, v32
s_cbranch_execz LE_p
ds_add_rtn_u32 v152, v152, v17
v_cmpx_lt_i32 vcc, 97, v32
ds_add_rtn_u32 v153, v153, v17
v_cmpx_lt_i32 vcc, 98, v32
ds_add_rtn_u32 v154, v154, v17
v_cmpx_lt_i32 vcc, 99, v32
ds_add_rtn_u32 v155, v155, v17
v_cmpx_lt_i32 vcc, 112, v32
s_cbranch_execz LE_p
ds_add_rtn_u32 v156, v156, v17
v_cmpx_lt_i32 vcc, 113, v32
ds_add_rtn_u32 v157, v157, v17
v_cmpx_lt_i32 vcc, 114, v32
ds_add_rtn_u32 v158, v158, v17
v_cmpx_lt_i32 vcc, 115, v32
ds_add_rtn_u32 v159, v159, v17
v_cmpx_lt_i32 vcc, 128, v32
s_cbranch_execz LE_p
ds_add_rtn_u32 v160, v160, v17
v_cmpx_lt_i32 vcc, 129, v32
ds_add_rtn_u32 v161, v161, v17
v_cmpx_lt_i32 vcc, 130, v32
ds_add_rtn_u32 v162, v162, v17
v_cmpx_lt_i32 vcc, 131, v32
ds_add_rtn_u32 v163, v163, v17
v_cmpx_lt_i32 vcc, 144, v32
s_cbranch_execz LE_p
ds_add_rtn_u32 v164, v164, v17
v_cmpx_lt_i32 vcc, 145, v32
ds_add_rtn_u32 v165, v165, v17
v_cmpx_lt_i32 vcc, 146, v32
ds_add_rtn_u32 v166, v166, v17
v_cmpx_lt_i32 vcc, 147, v32
ds_add_rtn_u32 v167, v167, v17
v_cmpx_lt_i32 vcc, 160, v32
s_cbranch_execz LE_p
ds_add_rtn_u32 v168, v168, v17
v_cmpx_lt_i32 vcc, 161, v32
ds_add_rtn_u32 v169, v169, v17
v_cmpx_lt_i32 vcc, 162, v32
ds_add_rtn_u32 v170, v170, v17
v_cmpx_lt_i32 vcc, 163, v32
ds_add_rtn_u32 v171, v171, v17
v_cmpx_lt_i32 vcc, 176, v32
s_cbranch_execz LE_p
ds_add_rtn_u32 v172, v172, v17
v_cmpx_lt_i32 vcc, 177, v32
ds_add_rtn_u32 v173, v173, v17
v_cmpx_lt_i32 vcc, 178, v32
ds_add_rtn_u32 v174, v174, v17
v_cmpx_lt_i32 vcc, 179, v32
ds_add_rtn_u32 v175, v175, v17
v_cmpx_lt_i32 vcc, 192, v32
s_cbranch_execz LE_p
ds_add_rtn_u32 v176, v176, v17
v_cmpx_lt_i32 vcc, 193, v32
ds_add_rtn_u32 v177, v177, v17
v_cmpx_lt_i32 vcc, 194, v32
ds_add_rtn_u32 v178, v178, v17
v_cmpx_lt_i32 vcc, 195, v32
ds_add_rtn_u32 v179, v179, v17
v_cmpx_lt_i32 vcc, 208, v32
s_cbranch_execz LE_p
ds_add_rtn_u32 v180, v180, v17
v_cmpx_lt_i32 vcc, 209, v32
ds_add_rtn_u32 v181, v181, v17
v_cmpx_lt_i32 vcc, 210, v32
ds_add_rtn_u32 v182, v182, v17
v_cmpx_lt_i32 vcc, 211, v32
ds_add_rtn_u32 v183, v183, v17
v_cmpx_lt_i32 vcc, 224, v32
s_cbranch_execz LE_p
ds_add_rtn_u32 v184, v184, v17
v_cmpx_lt_i32 vcc, 225, v32
ds_add_rtn_u32 v185, v185, v17
v_cmpx_lt_i32 vcc, 226, v32
ds_add_rtn_u32 v186, v186, v17
v_cmpx_lt_i32 vcc, 227, v32
ds_add_rtn_u32 v187, v187, v17
v_cmpx_lt_i32 vcc, 240, v32
s_cbranch_execz LE_p
ds_add_rtn_u32 v188, v188, v17
v_cmpx_lt_i32 vcc, 241, v32
ds_add_rtn_u32 v189, v189, v17
v_cmpx_lt_i32 vcc, 242, v32
ds_add_rtn_u32 v190, v190, v17
v_cmpx_lt_i32 vcc, 243, v32
ds_add_rtn_u32 v191, v191, v17
LE_p:
s_mov_b64 exec, -1
v_lshl_add_u32 v33, v1, 2, v36
ds_read_b32 v37, v33 offset:20480
s_waitcnt lgkmcnt(0)
v_cmpx_lt_i32 vcc, 0, v32
s_cbranch_execz LE_w
ds_write_b32 v128, v192
v_cmpx_lt_i32 vcc, 1, v32
ds_write_b32 v129, v193
v_cmpx_lt_i32 vcc, 2, v32
ds_write_b32 v130, v194
v_cmpx_lt_i32 vcc, 3, v32
ds_write_b32 v131, v195
v_cmpx_lt_i32 vcc, 16, v32
s_cbranch_execz LE_w
ds_write_b32 v132, v196
v_cmpx_lt_i32 vcc, 17, v32
ds_write_b32 v133, v197
v_cmpx_lt_i32 vcc, 18, v32
ds_write_b32 v134, v198
v_cmpx_lt_i32 vcc, 19, v32
ds_write_b32 v135, v199
v_cmpx_lt_i32 vcc, 32, v32
s_cbranch_execz LE_w
ds_write_b32 v136, v200
v_cmpx_lt_i32 vcc, 33, v32
ds_write_b32 v137, v201
v_cmpx_lt_i32 vcc, 34, v32
ds_write_b32 v138, v202
v_cmpx_lt_i32 vcc, 35, v32
ds_write_b32 v139, v203
v_cmpx_lt_i32 vcc, 48, v32
s_cbranch_execz LE_w
ds_write_b32 v140, v204
v_cmpx_lt_i32 vcc, 49, v32
ds_write_b32 v141, v205
v_cmpx_lt_i32 vcc, 50, v32
ds_write_b32 v142, v206
v_cmpx_lt_i32 vcc, 51, v32
ds_write_b32 v143, v207
v_cmpx_lt_i32 vcc, 64, v32
s_cbranch_execz LE_w
ds_write_b32 v144, v208
v_cmpx_lt_i32 vcc, 65, v32
ds_write_b32 v145, v209
v_cmpx_lt_i32 vcc, 66, v32
ds_write_b32 v146, v210
v_cmpx_lt_i32 vcc, 67, v32
ds_write_b32 v147, v211
v_cmpx_lt_i32 vcc, 80, v32
s_cbranch_execz LE_w
ds_write_b32 v148, v212
v_cmpx_lt_i32 vcc, 81, v32
ds_write_b32 v149, v213
v_cmpx_lt_i32 vcc, 82, v32
ds_write_b32 v150, v214
v_cmpx_lt_i32 vcc, 83, v32
ds_write_b32 v151, v215
v_cmpx_lt_i32 vcc, 96, v32
s_cbranch_execz LE_w
ds_write_b32 v152, v216
v_cmpx_lt_i32 vcc, 97, v32
ds_write_b32 v153, v217
v_cmpx_lt_i32 vcc, 98, v32
ds_write_b32 v154, v218
v_cmpx_lt_i32 vcc, 99, v32
ds_write_b32 v155, v219
v_cmpx_lt_i32 vcc, 112, v32
s_cbranch_execz LE_w
ds_write_b32 v156, v220
v_cmpx_lt_i32 vcc, 113, v32
ds_write_b32 v157, v221
v_cmpx_lt_i32 vcc, 114, v32
ds_write_b32 v158, v222
v_cmpx_lt_i32 vcc, 115, v32
ds_write_b32 v159, v223
v_cmpx_lt_i32 vcc, 128, v32
s_cbranch_execz LE_w
ds_write_b32 v160, v224
v_cmpx_lt_i32 vcc, 129, v32
ds_write_b32 v161, v225
v_cmpx_lt_i32 vcc, 130, v32
ds_write_b32 v162, v226
v_cmpx_lt_i32 vcc, 131, v32
ds_write_b32 v163, v227
v_cmpx_lt_i32 vcc, 144, v32
s_cbranch_execz LE_w
ds_write_b32 v164, v228
v_cmpx_lt_i32 vcc, 145, v32
ds_write_b32 v165, v229
v_cmpx_lt_i32 vcc, 146, v32
ds_write_b32 v166, v230
v_cmpx_lt_i32 vcc, 147, v32
ds_write_b32 v167, v231
v_cmpx_lt_i32 vcc, 160, v32
s_cbranch_execz LE_w
ds_write_b32 v168, v232
v_cmpx_lt_i32 vcc, 161, v32
ds_write_b32 v169, v233
v_cmpx_lt_i32 vcc, 162, v32
ds_write_b32 v170, v234
v_cmpx_lt_i32 vcc, 163, v32
ds_write_b32 v171, v235
v_cmpx_lt_i32 vcc, 176, v32
s_cbranch_execz LE_w
ds_write_b32 v172, v236
v_cmpx_lt_i32 vcc, 177, v32
ds_write_b32 v173, v237
v_cmpx_lt_i32 vcc, 178, v32
ds_write_b32 v174, v238
v_cmpx_lt_i32 vcc, 179, v32
ds_write_b32 v175, v239
v_cmpx_lt_i32 vcc, 192, v32
s_cbranch_execz LE_w
ds_write_b32 v176, v240
v_cmpx_lt_i32 vcc, 193, v32
ds_write_b32 v177, v241
v_cmpx_lt_i32 vcc, 194, v32
ds_write_b32 v178, v242
v_cmpx_lt_i32 vcc, 195, v32
ds_write_b32 v179, v243
v_cmpx_lt_i32 vcc, 208, v32
s_cbranch_execz LE_w
ds_write_b32 v180, v244
v_cmpx_lt_i32 vcc, 209, v32
ds_write_b32 v181, v245
v_cmpx_lt_i32 vcc, 210, v32
ds_write_b32 v182, v246
v_cmpx_lt_i32 vcc, 211, v32
ds_write_b32 v183, v247
v_cmpx_lt_i32 vcc, 224, v32
s_cbranch_execz LE_w
ds_write_b32 v184, v248
v_cmpx_lt_i32 vcc, 225, v32
ds_write_b32 v185, v249
v_cmpx_lt_i32 vcc, 226, v32
ds_write_b32 v186, v250
v_cmpx_lt_i32 vcc, 227, v32
ds_write_b32 v187, v251
v_cmpx_lt_i32 vcc, 240, v32
s_cbranch_execz LE_w
ds_write_b32 v188, v252
v_cmpx_lt_i32 vcc, 241, v32
ds_write_b32 v189, v253
v_cmpx_lt_i32 vcc, 242, v32
ds_write_b32 v190, v254
v_cmpx_lt_i32 vcc, 243, v32
ds_write_b32 v191, v255
LE_w:
s_mov_b64 exec, -1
v_mov_b32 v34, v38
ds_read2_b32 v[52:53], v34 offset0:0 offset1:4
ds_read2_b32 v[54:55], v34 offset0:8 offset1:12
s_waitcnt lgkmcnt(0)
ds_read2_b32 v[56:57], v34 offset0:16 offset1:20
ds_read2_b32 v[58:59], v34 offset0:24 offset1:28
v_mad_u32_u16 v60, v52, s49, v2
v_mad_u32_u16 v61, v53, s49, v2
v_mad_u32_u16 v62, v54, s49, v2
v_mad_u32_u16 v63, v55, s49, v2
buffer_load_dwordx4 a[0:3], v60, s[16:19], 0 offen sc1
buffer_load_dwordx4 a[4:7], v60, s[16:19], 0 offen offset:256 sc1
buffer_load_dwordx4 a[8:11], v61, s[16:19], 0 offen sc1
buffer_load_dwordx4 a[12:15], v61, s[16:19], 0 offen offset:256 sc1
buffer_load_dwordx4 a[16:19], v62, s[16:19], 0 offen sc1
buffer_load_dwordx4 a[20:23], v62, s[16:19], 0 offen offset:256 sc1
buffer_load_dwordx4 a[24:27], v63, s[16:19], 0 offen sc1
buffer_load_dwordx4 a[28:31], v63, s[16:19], 0 offen offset:256 sc1
s_waitcnt lgkmcnt(0)
ds_read2_b32 v[52:53], v34 offset0:32 offset1:36
ds_read2_b32 v[54:55], v34 offset0:40 offset1:44
v_mad_u32_u16 v60, v56, s49, v2
v_mad_u32_u16 v61, v57, s49, v2
v_mad_u32_u16 v62, v58, s49, v2
v_mad_u32_u16 v63, v59, s49, v2
buffer_load_dwordx4 a[32:35], v60, s[16:19], 0 offen sc1
buffer_load_dwordx4 a[36:39], v60, s[16:19], 0 offen offset:256 sc1
buffer_load_dwordx4 a[40:43], v61, s[16:19], 0 offen sc1
buffer_load_dwordx4 a[44:47], v61, s[16:19], 0 offen offset:256 sc1
buffer_load_dwordx4 a[48:51], v62, s[16:19], 0 offen sc1
buffer_load_dwordx4 a[52:55], v62, s[16:19], 0 offen offset:256 sc1
buffer_load_dwordx4 a[56:59], v63, s[16:19], 0 offen sc1
buffer_load_dwordx4 a[60:63], v63, s[16:19], 0 offen offset:256 sc1
s_waitcnt lgkmcnt(0)
ds_read2_b32 v[56:57], v34 offset0:48 offset1:52
ds_read2_b32 v[58:59], v34 offset0:56 offset1:60
v_mad_u32_u16 v60, v52, s49, v2
v_mad_u32_u16 v61, v53, s49, v2
v_mad_u32_u16 v62, v54, s49, v2
v_mad_u32_u16 v63, v55, s49, v2
buffer_load_dwordx4 a[64:67], v60, s[16:19], 0 offen sc1
buffer_load_dwordx4 a[68:71], v60, s[16:19], 0 offen offset:256 sc1
buffer_load_dwordx4 a[72:75], v61, s[16:19], 0 offen sc1
buffer_load_dwordx4 a[76:79], v61, s[16:19], 0 offen offset:256 sc1
buffer_load_dwordx4 a[80:83], v62, s[16:19], 0 offen sc1
buffer_load_dwordx4 a[84:87], v62, s[16:19], 0 offen offset:256 sc1
buffer_load_dwordx4 a[88:91], v63, s[16:19], 0 offen sc1
buffer_load_dwordx4 a[92:95], v63, s[16:19], 0 offen offset:256 sc1
s_waitcnt lgkmcnt(0)
ds_read2_b32 v[52:53], v34 offset0:64 offset1:68
ds_read2_b32 v[54:55], v34 offset0:72 offset1:76
v_mad_u32_u16 v60, v56, s49, v2
v_mad_u32_u16 v61, v57, s49, v2
v_mad_u32_u16 v62, v58, s49, v2
v_mad_u32_u16 v63, v59, s49, v2
buffer_load_dwordx4 a[96:99], v60, s[16:19], 0 offen sc1
buffer_load_dwordx4 a[100:103], v60, s[16:19], 0 offen offset:256 sc1
buffer_load_dwordx4 a[104:107], v61, s[16:19], 0 offen sc1
buffer_load_dwordx4 a[108:111], v61, s[16:19], 0 offen offset:256 sc1
buffer_load_dwordx4 a[112:115], v62, s[16:19], 0 offen sc1
buffer_load_dwordx4 a[116:119], v62, s[16:19], 0 offen offset:256 sc1
buffer_load_dwordx4 a[120:123], v63, s[16:19], 0 offen sc1
buffer_load_dwordx4 a[124:127], v63, s[16:19], 0 offen offset:256 sc1
s_waitcnt lgkmcnt(0)
ds_read2_b32 v[56:57], v34 offset0:80 offset1:84
ds_read2_b32 v[58:59], v34 offset0:88 offset1:92
v_mad_u32_u16 v60, v52, s49, v2
v_mad_u32_u16 v61, v53, s49, v2
v_mad_u32_u16 v62, v54, s49, v2
v_mad_u32_u16 v63, v55, s49, v2
buffer_load_dwordx4 a[128:131], v60, s[16:19], 0 offen sc1
buffer_load_dwordx4 a[132:135], v60, s[16:19], 0 offen offset:256 sc1
buffer_load_dwordx4 a[136:139], v61, s[16:19], 0 offen sc1
buffer_load_dwordx4 a[140:143], v61, s[16:19], 0 offen offset:256 sc1
buffer_load_dwordx4 a[144:147], v62, s[16:19], 0 offen sc1
buffer_load_dwordx4 a[148:151], v62, s[16:19], 0 offen offset:256 sc1
buffer_load_dwordx4 a[152:155], v63, s[16:19], 0 offen sc1
buffer_load_dwordx4 a[156:159], v63, s[16:19], 0 offen offset:256 sc1
s_waitcnt lgkmcnt(0)
ds_read2_b32 v[52:53], v34 offset0:96 offset1:100
ds_read2_b32 v[54:55], v34 offset0:104 offset1:108
v_mad_u32_u16 v60, v56, s49, v2
v_mad_u32_u16 v61, v57, s49, v2
v_mad_u32_u16 v62, v58, s49, v2
v_mad_u32_u16 v63, v59, s49, v2
buffer_load_dwordx4 a[160:163], v60, s[16:19], 0 offen sc1
buffer_load_dwordx4 a[164:167], v60, s[16:19], 0 offen offset:256 sc1
buffer_load_dwordx4 a[168:171], v61, s[16:19], 0 offen sc1
buffer_load_dwordx4 a[172:175], v61, s[16:19], 0 offen offset:256 sc1
buffer_load_dwordx4 a[176:179], v62, s[16:19], 0 offen sc1
buffer_load_dwordx4 a[180:183], v62, s[16:19], 0 offen offset:256 sc1
buffer_load_dwordx4 a[184:187], v63, s[16:19], 0 offen sc1
buffer_load_dwordx4 a[188:191], v63, s[16:19], 0 offen offset:256 sc1
s_waitcnt lgkmcnt(0)
ds_read2_b32 v[56:57], v34 offset0:112 offset1:116
ds_read2_b32 v[58:59], v34 offset0:120 offset1:124
v_mad_u32_u16 v60, v52, s49, v2
v_mad_u32_u16 v61, v53, s49, v2
v_mad_u32_u16 v62, v54, s49, v2
v_mad_u32_u16 v63, v55, s49, v2
buffer_load_dwordx4 a[192:195], v60, s[16:19], 0 offen sc1
buffer_load_dwordx4 a[196:199], v60, s[16:19], 0 offen offset:256 sc1
buffer_load_dwordx4 a[200:203], v61, s[16:19], 0 offen sc1
buffer_load_dwordx4 a[204:207], v61, s[16:19], 0 offen offset:256 sc1
buffer_load_dwordx4 a[208:211], v62, s[16:19], 0 offen sc1
buffer_load_dwordx4 a[212:215], v62, s[16:19], 0 offen offset:256 sc1
buffer_load_dwordx4 a[216:219], v63, s[16:19], 0 offen sc1
buffer_load_dwordx4 a[220:223], v63, s[16:19], 0 offen offset:256 sc1
s_waitcnt lgkmcnt(0)
ds_read2_b32 v[52:53], v34 offset0:128 offset1:132
ds_read2_b32 v[54:55], v34 offset0:136 offset1:140
v_mad_u32_u16 v60, v56, s49, v2
v_mad_u32_u16 v61, v57, s49, v2
v_mad_u32_u16 v62, v58, s49, v2
v_mad_u32_u16 v63, v59, s49, v2
buffer_load_dwordx4 a[224:227], v60, s[16:19], 0 offen sc1
buffer_load_dwordx4 a[228:231], v60, s[16:19], 0 offen offset:256 sc1
buffer_load_dwordx4 a[232:235], v61, s[16:19], 0 offen sc1
buffer_load_dwordx4 a[236:239], v61, s[16:19], 0 offen offset:256 sc1
buffer_load_dwordx4 a[240:243], v62, s[16:19], 0 offen sc1
buffer_load_dwordx4 a[244:247], v62, s[16:19], 0 offen offset:256 sc1
buffer_load_dwordx4 a[248:251], v63, s[16:19], 0 offen sc1
buffer_load_dwordx4 a[252:255], v63, s[16:19], 0 offen offset:256 sc1
v_add_u32 v34, 512, v34
s_mov_b32 s45, 0
s_lshl_b32 s47, s55, 9
LE_loop:
v_readlane_b32 s46, v37, s45
s_add_u32 s45, s45, 1
s_waitcnt vmcnt(56)
v_mfma_f32_16x16x32_bf16 v[48:51], a[0:3], v[40:43], v[48:51]
v_mfma_f32_16x16x32_bf16 v[48:51], a[4:7], v[44:47], v[48:51]
s_bitcmp1_b32 s46, 0
s_cbranch_scc0 LE_nf0
s_cmp_eq_u32 s42, 0
s_cbranch_scc1 LE_fl0
buffer_load_dwordx2 v[66:67], v39, s[20:23], s47 offen sc1
s_waitcnt vmcnt(0)
v_lshlrev_b32 v64, 16, v66
v_and_b32 v65, 0xffff0000, v66
v_add_f32 v48, v48, v64
v_add_f32 v49, v49, v65
v_lshlrev_b32 v64, 16, v67
v_and_b32 v65, 0xffff0000, v67
v_add_f32 v50, v50, v64
v_add_f32 v51, v51, v65
LE_fl0:
s_nop 3
v_cvt_pk_bf16_f32 v64, v48, v49
v_cvt_pk_bf16_f32 v65, v50, v51
v_mov_b32 v48, 0
v_mov_b32 v49, 0
v_mov_b32 v50, 0
v_mov_b32 v51, 0
buffer_store_dwordx2 v[64:65], v39, s[20:23], s47 offen sc1
s_add_u32 s47, s47, 512
LE_nf0:
v_mfma_f32_16x16x32_bf16 v[48:51], a[8:11], v[40:43], v[48:51]
v_mfma_f32_16x16x32_bf16 v[48:51], a[12:15], v[44:47], v[48:51]
s_bitcmp1_b32 s46, 1
s_cbranch_scc0 LE_nf1
s_cmp_eq_u32 s42, 0
s_cbranch_scc1 LE_fl1
buffer_load_dwordx2 v[66:67], v39, s[20:23], s47 offen sc1
s_waitcnt vmcnt(0)
v_lshlrev_b32 v64, 16, v66
v_and_b32 v65, 0xffff0000, v66
v_add_f32 v48, v48, v64
v_add_f32 v49, v49, v65
v_lshlrev_b32 v64, 16, v67
v_and_b32 v65, 0xffff0000, v67
v_add_f32 v50, v50, v64
v_add_f32 v51, v51, v65
LE_fl1:
s_nop 3
v_cvt_pk_bf16_f32 v64, v48, v49
v_cvt_pk_bf16_f32 v65, v50, v51
v_mov_b32 v48, 0
v_mov_b32 v49, 0
v_mov_b32 v50, 0
v_mov_b32 v51, 0
buffer_store_dwordx2 v[64:65], v39, s[20:23], s47 offen sc1
s_add_u32 s47, s47, 512
LE_nf1:
v_mfma_f32_16x16x32_bf16 v[48:51], a[16:19], v[40:43], v[48:51]
v_mfma_f32_16x16x32_bf16 v[48:51], a[20:23], v[44:47], v[48:51]
s_bitcmp1_b32 s46, 2
s_cbranch_scc0 LE_nf2
s_cmp_eq_u32 s42, 0
s_cbranch_scc1 LE_fl2
buffer_load_dwordx2 v[66:67], v39, s[20:23], s47 offen sc1
s_waitcnt vmcnt(0)
v_lshlrev_b32 v64, 16, v66
v_and_b32 v65, 0xffff0000, v66
v_add_f32 v48, v48, v64
v_add_f32 v49, v49, v65
v_lshlrev_b32 v64, 16, v67
v_and_b32 v65, 0xffff0000, v67
v_add_f32 v50, v50, v64
v_add_f32 v51, v51, v65
LE_fl2:
s_nop 3
v_cvt_pk_bf16_f32 v64, v48, v49
v_cvt_pk_bf16_f32 v65, v50, v51
v_mov_b32 v48, 0
v_mov_b32 v49, 0
v_mov_b32 v50, 0
v_mov_b32 v51, 0
buffer_store_dwordx2 v[64:65], v39, s[20:23], s47 offen sc1
s_add_u32 s47, s47, 512
LE_nf2:
v_mfma_f32_16x16x32_bf16 v[48:51], a[24:27], v[40:43], v[48:51]
v_mfma_f32_16x16x32_bf16 v[48:51], a[28:31], v[44:47], v[48:51]
s_bitcmp1_b32 s46, 3
s_cbranch_scc0 LE_nf3
s_cmp_eq_u32 s42, 0
s_cbranch_scc1 LE_fl3
buffer_load_dwordx2 v[66:67], v39, s[20:23], s47 offen sc1
s_waitcnt vmcnt(0)
v_lshlrev_b32 v64, 16, v66
v_and_b32 v65, 0xffff0000, v66
v_add_f32 v48, v48, v64
v_add_f32 v49, v49, v65
v_lshlrev_b32 v64, 16, v67
v_and_b32 v65, 0xffff0000, v67
v_add_f32 v50, v50, v64
v_add_f32 v51, v51, v65
LE_fl3:
s_nop 3
v_cvt_pk_bf16_f32 v64, v48, v49
v_cvt_pk_bf16_f32 v65, v50, v51
v_mov_b32 v48, 0
v_mov_b32 v49, 0
v_mov_b32 v50, 0
v_mov_b32 v51, 0
buffer_store_dwordx2 v[64:65], v39, s[20:23], s47 offen sc1
s_add_u32 s47, s47, 512
LE_nf3:
s_waitcnt lgkmcnt(0)
ds_read2_b32 v[56:57], v34 offset0:16 offset1:20
ds_read2_b32 v[58:59], v34 offset0:24 offset1:28
v_mad_u32_u16 v60, v52, s49, v2
v_mad_u32_u16 v61, v53, s49, v2
v_mad_u32_u16 v62, v54, s49, v2
v_mad_u32_u16 v63, v55, s49, v2
buffer_load_dwordx4 a[0:3], v60, s[16:19], 0 offen sc1
buffer_load_dwordx4 a[4:7], v60, s[16:19], 0 offen offset:256 sc1
buffer_load_dwordx4 a[8:11], v61, s[16:19], 0 offen sc1
buffer_load_dwordx4 a[12:15], v61, s[16:19], 0 offen offset:256 sc1
buffer_load_dwordx4 a[16:19], v62, s[16:19], 0 offen sc1
buffer_load_dwordx4 a[20:23], v62, s[16:19], 0 offen offset:256 sc1
buffer_load_dwordx4 a[24:27], v63, s[16:19], 0 offen sc1
buffer_load_dwordx4 a[28:31], v63, s[16:19], 0 offen offset:256 sc1
s_waitcnt vmcnt(56)
v_mfma_f32_16x16x32_bf16 v[48:51], a[32:35], v[40:43], v[48:51]
v_mfma_f32_16x16x32_bf16 v[48:51], a[36:39], v[44:47], v[48:51]
s_bitcmp1_b32 s46, 4
s_cbranch_scc0 LE_nf4
s_cmp_eq_u32 s42, 0
s_cbranch_scc1 LE_fl4
buffer_load_dwordx2 v[66:67], v39, s[20:23], s47 offen sc1
s_waitcnt vmcnt(0)
v_lshlrev_b32 v64, 16, v66
v_and_b32 v65, 0xffff0000, v66
v_add_f32 v48, v48, v64
v_add_f32 v49, v49, v65
v_lshlrev_b32 v64, 16, v67
v_and_b32 v65, 0xffff0000, v67
v_add_f32 v50, v50, v64
v_add_f32 v51, v51, v65
LE_fl4:
s_nop 3
v_cvt_pk_bf16_f32 v64, v48, v49
v_cvt_pk_bf16_f32 v65, v50, v51
v_mov_b32 v48, 0
v_mov_b32 v49, 0
v_mov_b32 v50, 0
v_mov_b32 v51, 0
buffer_store_dwordx2 v[64:65], v39, s[20:23], s47 offen sc1
s_add_u32 s47, s47, 512
LE_nf4:
v_mfma_f32_16x16x32_bf16 v[48:51], a[40:43], v[40:43], v[48:51]
v_mfma_f32_16x16x32_bf16 v[48:51], a[44:47], v[44:47], v[48:51]
s_bitcmp1_b32 s46, 5
s_cbranch_scc0 LE_nf5
s_cmp_eq_u32 s42, 0
s_cbranch_scc1 LE_fl5
buffer_load_dwordx2 v[66:67], v39, s[20:23], s47 offen sc1
s_waitcnt vmcnt(0)
v_lshlrev_b32 v64, 16, v66
v_and_b32 v65, 0xffff0000, v66
v_add_f32 v48, v48, v64
v_add_f32 v49, v49, v65
v_lshlrev_b32 v64, 16, v67
v_and_b32 v65, 0xffff0000, v67
v_add_f32 v50, v50, v64
v_add_f32 v51, v51, v65
LE_fl5:
s_nop 3
v_cvt_pk_bf16_f32 v64, v48, v49
v_cvt_pk_bf16_f32 v65, v50, v51
v_mov_b32 v48, 0
v_mov_b32 v49, 0
v_mov_b32 v50, 0
v_mov_b32 v51, 0
buffer_store_dwordx2 v[64:65], v39, s[20:23], s47 offen sc1
s_add_u32 s47, s47, 512
LE_nf5:
v_mfma_f32_16x16x32_bf16 v[48:51], a[48:51], v[40:43], v[48:51]
v_mfma_f32_16x16x32_bf16 v[48:51], a[52:55], v[44:47], v[48:51]
s_bitcmp1_b32 s46, 6
s_cbranch_scc0 LE_nf6
s_cmp_eq_u32 s42, 0
s_cbranch_scc1 LE_fl6
buffer_load_dwordx2 v[66:67], v39, s[20:23], s47 offen sc1
s_waitcnt vmcnt(0)
v_lshlrev_b32 v64, 16, v66
v_and_b32 v65, 0xffff0000, v66
v_add_f32 v48, v48, v64
v_add_f32 v49, v49, v65
v_lshlrev_b32 v64, 16, v67
v_and_b32 v65, 0xffff0000, v67
v_add_f32 v50, v50, v64
v_add_f32 v51, v51, v65
LE_fl6:
s_nop 3
v_cvt_pk_bf16_f32 v64, v48, v49
v_cvt_pk_bf16_f32 v65, v50, v51
v_mov_b32 v48, 0
v_mov_b32 v49, 0
v_mov_b32 v50, 0
v_mov_b32 v51, 0
buffer_store_dwordx2 v[64:65], v39, s[20:23], s47 offen sc1
s_add_u32 s47, s47, 512
LE_nf6:
v_mfma_f32_16x16x32_bf16 v[48:51], a[56:59], v[40:43], v[48:51]
v_mfma_f32_16x16x32_bf16 v[48:51], a[60:63], v[44:47], v[48:51]
s_bitcmp1_b32 s46, 7
s_cbranch_scc0 LE_nf7
s_cmp_eq_u32 s42, 0
s_cbranch_scc1 LE_fl7
buffer_load_dwordx2 v[66:67], v39, s[20:23], s47 offen sc1
s_waitcnt vmcnt(0)
v_lshlrev_b32 v64, 16, v66
v_and_b32 v65, 0xffff0000, v66
v_add_f32 v48, v48, v64
v_add_f32 v49, v49, v65
v_lshlrev_b32 v64, 16, v67
v_and_b32 v65, 0xffff0000, v67
v_add_f32 v50, v50, v64
v_add_f32 v51, v51, v65
LE_fl7:
s_nop 3
v_cvt_pk_bf16_f32 v64, v48, v49
v_cvt_pk_bf16_f32 v65, v50, v51
v_mov_b32 v48, 0
v_mov_b32 v49, 0
v_mov_b32 v50, 0
v_mov_b32 v51, 0
buffer_store_dwordx2 v[64:65], v39, s[20:23], s47 offen sc1
s_add_u32 s47, s47, 512
LE_nf7:
s_waitcnt lgkmcnt(0)
ds_read2_b32 v[52:53], v34 offset0:32 offset1:36
ds_read2_b32 v[54:55], v34 offset0:40 offset1:44
v_mad_u32_u16 v60, v56, s49, v2
v_mad_u32_u16 v61, v57, s49, v2
v_mad_u32_u16 v62, v58, s49, v2
v_mad_u32_u16 v63, v59, s49, v2
buffer_load_dwordx4 a[32:35], v60, s[16:19], 0 offen sc1
buffer_load_dwordx4 a[36:39], v60, s[16:19], 0 offen offset:256 sc1
buffer_load_dwordx4 a[40:43], v61, s[16:19], 0 offen sc1
buffer_load_dwordx4 a[44:47], v61, s[16:19], 0 offen offset:256 sc1
buffer_load_dwordx4 a[48:51], v62, s[16:19], 0 offen sc1
buffer_load_dwordx4 a[52:55], v62, s[16:19], 0 offen offset:256 sc1
buffer_load_dwordx4 a[56:59], v63, s[16:19], 0 offen sc1
buffer_load_dwordx4 a[60:63], v63, s[16:19], 0 offen offset:256 sc1
s_waitcnt vmcnt(56)
v_mfma_f32_16x16x32_bf16 v[48:51], a[64:67], v[40:43], v[48:51]
v_mfma_f32_16x16x32_bf16 v[48:51], a[68:71], v[44:47], v[48:51]
s_bitcmp1_b32 s46, 8
s_cbranch_scc0 LE_nf8
s_cmp_eq_u32 s42, 0
s_cbranch_scc1 LE_fl8
buffer_load_dwordx2 v[66:67], v39, s[20:23], s47 offen sc1
s_waitcnt vmcnt(0)
v_lshlrev_b32 v64, 16, v66
v_and_b32 v65, 0xffff0000, v66
v_add_f32 v48, v48, v64
v_add_f32 v49, v49, v65
v_lshlrev_b32 v64, 16, v67
v_and_b32 v65, 0xffff0000, v67
v_add_f32 v50, v50, v64
v_add_f32 v51, v51, v65
LE_fl8:
s_nop 3
v_cvt_pk_bf16_f32 v64, v48, v49
v_cvt_pk_bf16_f32 v65, v50, v51
v_mov_b32 v48, 0
v_mov_b32 v49, 0
v_mov_b32 v50, 0
v_mov_b32 v51, 0
buffer_store_dwordx2 v[64:65], v39, s[20:23], s47 offen sc1
s_add_u32 s47, s47, 512
LE_nf8:
v_mfma_f32_16x16x32_bf16 v[48:51], a[72:75], v[40:43], v[48:51]
v_mfma_f32_16x16x32_bf16 v[48:51], a[76:79], v[44:47], v[48:51]
s_bitcmp1_b32 s46, 9
s_cbranch_scc0 LE_nf9
s_cmp_eq_u32 s42, 0
s_cbranch_scc1 LE_fl9
buffer_load_dwordx2 v[66:67], v39, s[20:23], s47 offen sc1
s_waitcnt vmcnt(0)
v_lshlrev_b32 v64, 16, v66
v_and_b32 v65, 0xffff0000, v66
v_add_f32 v48, v48, v64
v_add_f32 v49, v49, v65
v_lshlrev_b32 v64, 16, v67
v_and_b32 v65, 0xffff0000, v67
v_add_f32 v50, v50, v64
v_add_f32 v51, v51, v65
LE_fl9:
s_nop 3
v_cvt_pk_bf16_f32 v64, v48, v49
v_cvt_pk_bf16_f32 v65, v50, v51
v_mov_b32 v48, 0
v_mov_b32 v49, 0
v_mov_b32 v50, 0
v_mov_b32 v51, 0
buffer_store_dwordx2 v[64:65], v39, s[20:23], s47 offen sc1
s_add_u32 s47, s47, 512
LE_nf9:
v_mfma_f32_16x16x32_bf16 v[48:51], a[80:83], v[40:43], v[48:51]
v_mfma_f32_16x16x32_bf16 v[48:51], a[84:87], v[44:47], v[48:51]
s_bitcmp1_b32 s46, 10
s_cbranch_scc0 LE_nf10
s_cmp_eq_u32 s42, 0
s_cbranch_scc1 LE_fl10
buffer_load_dwordx2 v[66:67], v39, s[20:23], s47 offen sc1
s_waitcnt vmcnt(0)
v_lshlrev_b32 v64, 16, v66
v_and_b32 v65, 0xffff0000, v66
v_add_f32 v48, v48, v64
v_add_f32 v49, v49, v65
v_lshlrev_b32 v64, 16, v67
v_and_b32 v65, 0xffff0000, v67
v_add_f32 v50, v50, v64
v_add_f32 v51, v51, v65
LE_fl10:
s_nop 3
v_cvt_pk_bf16_f32 v64, v48, v49
v_cvt_pk_bf16_f32 v65, v50, v51
v_mov_b32 v48, 0
v_mov_b32 v49, 0
v_mov_b32 v50, 0
v_mov_b32 v51, 0
buffer_store_dwordx2 v[64:65], v39, s[20:23], s47 offen sc1
s_add_u32 s47, s47, 512
LE_nf10:
v_mfma_f32_16x16x32_bf16 v[48:51], a[88:91], v[40:43], v[48:51]
v_mfma_f32_16x16x32_bf16 v[48:51], a[92:95], v[44:47], v[48:51]
s_bitcmp1_b32 s46, 11
s_cbranch_scc0 LE_nf11
s_cmp_eq_u32 s42, 0
s_cbranch_scc1 LE_fl11
buffer_load_dwordx2 v[66:67], v39, s[20:23], s47 offen sc1
s_waitcnt vmcnt(0)
v_lshlrev_b32 v64, 16, v66
v_and_b32 v65, 0xffff0000, v66
v_add_f32 v48, v48, v64
v_add_f32 v49, v49, v65
v_lshlrev_b32 v64, 16, v67
v_and_b32 v65, 0xffff0000, v67
v_add_f32 v50, v50, v64
v_add_f32 v51, v51, v65
LE_fl11:
s_nop 3
v_cvt_pk_bf16_f32 v64, v48, v49
v_cvt_pk_bf16_f32 v65, v50, v51
v_mov_b32 v48, 0
v_mov_b32 v49, 0
v_mov_b32 v50, 0
v_mov_b32 v51, 0
buffer_store_dwordx2 v[64:65], v39, s[20:23], s47 offen sc1
s_add_u32 s47, s47, 512
LE_nf11:
s_waitcnt lgkmcnt(0)
ds_read2_b32 v[56:57], v34 offset0:48 offset1:52
ds_read2_b32 v[58:59], v34 offset0:56 offset1:60
v_mad_u32_u16 v60, v52, s49, v2
v_mad_u32_u16 v61, v53, s49, v2
v_mad_u32_u16 v62, v54, s49, v2
v_mad_u32_u16 v63, v55, s49, v2
buffer_load_dwordx4 a[64:67], v60, s[16:19], 0 offen sc1
buffer_load_dwordx4 a[68:71], v60, s[16:19], 0 offen offset:256 sc1
buffer_load_dwordx4 a[72:75], v61, s[16:19], 0 offen sc1
buffer_load_dwordx4 a[76:79], v61, s[16:19], 0 offen offset:256 sc1
buffer_load_dwordx4 a[80:83], v62, s[16:19], 0 offen sc1
buffer_load_dwordx4 a[84:87], v62, s[16:19], 0 offen offset:256 sc1
buffer_load_dwordx4 a[88:91], v63, s[16:19], 0 offen sc1
buffer_load_dwordx4 a[92:95], v63, s[16:19], 0 offen offset:256 sc1
s_waitcnt vmcnt(56)
v_mfma_f32_16x16x32_bf16 v[48:51], a[96:99], v[40:43], v[48:51]
v_mfma_f32_16x16x32_bf16 v[48:51], a[100:103], v[44:47], v[48:51]
s_bitcmp1_b32 s46, 12
s_cbranch_scc0 LE_nf12
s_cmp_eq_u32 s42, 0
s_cbranch_scc1 LE_fl12
buffer_load_dwordx2 v[66:67], v39, s[20:23], s47 offen sc1
s_waitcnt vmcnt(0)
v_lshlrev_b32 v64, 16, v66
v_and_b32 v65, 0xffff0000, v66
v_add_f32 v48, v48, v64
v_add_f32 v49, v49, v65
v_lshlrev_b32 v64, 16, v67
v_and_b32 v65, 0xffff0000, v67
v_add_f32 v50, v50, v64
v_add_f32 v51, v51, v65
LE_fl12:
s_nop 3
v_cvt_pk_bf16_f32 v64, v48, v49
v_cvt_pk_bf16_f32 v65, v50, v51
v_mov_b32 v48, 0
v_mov_b32 v49, 0
v_mov_b32 v50, 0
v_mov_b32 v51, 0
buffer_store_dwordx2 v[64:65], v39, s[20:23], s47 offen sc1
s_add_u32 s47, s47, 512
LE_nf12:
v_mfma_f32_16x16x32_bf16 v[48:51], a[104:107], v[40:43], v[48:51]
v_mfma_f32_16x16x32_bf16 v[48:51], a[108:111], v[44:47], v[48:51]
s_bitcmp1_b32 s46, 13
s_cbranch_scc0 LE_nf13
s_cmp_eq_u32 s42, 0
s_cbranch_scc1 LE_fl13
buffer_load_dwordx2 v[66:67], v39, s[20:23], s47 offen sc1
s_waitcnt vmcnt(0)
v_lshlrev_b32 v64, 16, v66
v_and_b32 v65, 0xffff0000, v66
v_add_f32 v48, v48, v64
v_add_f32 v49, v49, v65
v_lshlrev_b32 v64, 16, v67
v_and_b32 v65, 0xffff0000, v67
v_add_f32 v50, v50, v64
v_add_f32 v51, v51, v65
LE_fl13:
s_nop 3
v_cvt_pk_bf16_f32 v64, v48, v49
v_cvt_pk_bf16_f32 v65, v50, v51
v_mov_b32 v48, 0
v_mov_b32 v49, 0
v_mov_b32 v50, 0
v_mov_b32 v51, 0
buffer_store_dwordx2 v[64:65], v39, s[20:23], s47 offen sc1
s_add_u32 s47, s47, 512
LE_nf13:
v_mfma_f32_16x16x32_bf16 v[48:51], a[112:115], v[40:43], v[48:51]
v_mfma_f32_16x16x32_bf16 v[48:51], a[116:119], v[44:47], v[48:51]
s_bitcmp1_b32 s46, 14
s_cbranch_scc0 LE_nf14
s_cmp_eq_u32 s42, 0
s_cbranch_scc1 LE_fl14
buffer_load_dwordx2 v[66:67], v39, s[20:23], s47 offen sc1
s_waitcnt vmcnt(0)
v_lshlrev_b32 v64, 16, v66
v_and_b32 v65, 0xffff0000, v66
v_add_f32 v48, v48, v64
v_add_f32 v49, v49, v65
v_lshlrev_b32 v64, 16, v67
v_and_b32 v65, 0xffff0000, v67
v_add_f32 v50, v50, v64
v_add_f32 v51, v51, v65
LE_fl14:
s_nop 3
v_cvt_pk_bf16_f32 v64, v48, v49
v_cvt_pk_bf16_f32 v65, v50, v51
v_mov_b32 v48, 0
v_mov_b32 v49, 0
v_mov_b32 v50, 0
v_mov_b32 v51, 0
buffer_store_dwordx2 v[64:65], v39, s[20:23], s47 offen sc1
s_add_u32 s47, s47, 512
LE_nf14:
v_mfma_f32_16x16x32_bf16 v[48:51], a[120:123], v[40:43], v[48:51]
v_mfma_f32_16x16x32_bf16 v[48:51], a[124:127], v[44:47], v[48:51]
s_bitcmp1_b32 s46, 15
s_cbranch_scc0 LE_nf15
s_cmp_eq_u32 s42, 0
s_cbranch_scc1 LE_fl15
buffer_load_dwordx2 v[66:67], v39, s[20:23], s47 offen sc1
s_waitcnt vmcnt(0)
v_lshlrev_b32 v64, 16, v66
v_and_b32 v65, 0xffff0000, v66
v_add_f32 v48, v48, v64
v_add_f32 v49, v49, v65
v_lshlrev_b32 v64, 16, v67
v_and_b32 v65, 0xffff0000, v67
v_add_f32 v50, v50, v64
v_add_f32 v51, v51, v65
LE_fl15:
s_nop 3
v_cvt_pk_bf16_f32 v64, v48, v49
v_cvt_pk_bf16_f32 v65, v50, v51
v_mov_b32 v48, 0
v_mov_b32 v49, 0
v_mov_b32 v50, 0
v_mov_b32 v51, 0
buffer_store_dwordx2 v[64:65], v39, s[20:23], s47 offen sc1
s_add_u32 s47, s47, 512
LE_nf15:
s_waitcnt lgkmcnt(0)
ds_read2_b32 v[52:53], v34 offset0:64 offset1:68
ds_read2_b32 v[54:55], v34 offset0:72 offset1:76
v_mad_u32_u16 v60, v56, s49, v2
v_mad_u32_u16 v61, v57, s49, v2
v_mad_u32_u16 v62, v58, s49, v2
v_mad_u32_u16 v63, v59, s49, v2
buffer_load_dwordx4 a[96:99], v60, s[16:19], 0 offen sc1
buffer_load_dwordx4 a[100:103], v60, s[16:19], 0 offen offset:256 sc1
buffer_load_dwordx4 a[104:107], v61, s[16:19], 0 offen sc1
buffer_load_dwordx4 a[108:111], v61, s[16:19], 0 offen offset:256 sc1
buffer_load_dwordx4 a[112:115], v62, s[16:19], 0 offen sc1
buffer_load_dwordx4 a[116:119], v62, s[16:19], 0 offen offset:256 sc1
buffer_load_dwordx4 a[120:123], v63, s[16:19], 0 offen sc1
buffer_load_dwordx4 a[124:127], v63, s[16:19], 0 offen offset:256 sc1
s_waitcnt vmcnt(56)
v_mfma_f32_16x16x32_bf16 v[48:51], a[128:131], v[40:43], v[48:51]
v_mfma_f32_16x16x32_bf16 v[48:51], a[132:135], v[44:47], v[48:51]
s_bitcmp1_b32 s46, 16
s_cbranch_scc0 LE_nf16
s_cmp_eq_u32 s42, 0
s_cbranch_scc1 LE_fl16
buffer_load_dwordx2 v[66:67], v39, s[20:23], s47 offen sc1
s_waitcnt vmcnt(0)
v_lshlrev_b32 v64, 16, v66
v_and_b32 v65, 0xffff0000, v66
v_add_f32 v48, v48, v64
v_add_f32 v49, v49, v65
v_lshlrev_b32 v64, 16, v67
v_and_b32 v65, 0xffff0000, v67
v_add_f32 v50, v50, v64
v_add_f32 v51, v51, v65
LE_fl16:
s_nop 3
v_cvt_pk_bf16_f32 v64, v48, v49
v_cvt_pk_bf16_f32 v65, v50, v51
v_mov_b32 v48, 0
v_mov_b32 v49, 0
v_mov_b32 v50, 0
v_mov_b32 v51, 0
buffer_store_dwordx2 v[64:65], v39, s[20:23], s47 offen sc1
s_add_u32 s47, s47, 512
LE_nf16:
v_mfma_f32_16x16x32_bf16 v[48:51], a[136:139], v[40:43], v[48:51]
v_mfma_f32_16x16x32_bf16 v[48:51], a[140:143], v[44:47], v[48:51]
s_bitcmp1_b32 s46, 17
s_cbranch_scc0 LE_nf17
s_cmp_eq_u32 s42, 0
s_cbranch_scc1 LE_fl17
buffer_load_dwordx2 v[66:67], v39, s[20:23], s47 offen sc1
s_waitcnt vmcnt(0)
v_lshlrev_b32 v64, 16, v66
v_and_b32 v65, 0xffff0000, v66
v_add_f32 v48, v48, v64
v_add_f32 v49, v49, v65
v_lshlrev_b32 v64, 16, v67
v_and_b32 v65, 0xffff0000, v67
v_add_f32 v50, v50, v64
v_add_f32 v51, v51, v65
LE_fl17:
s_nop 3
v_cvt_pk_bf16_f32 v64, v48, v49
v_cvt_pk_bf16_f32 v65, v50, v51
v_mov_b32 v48, 0
v_mov_b32 v49, 0
v_mov_b32 v50, 0
v_mov_b32 v51, 0
buffer_store_dwordx2 v[64:65], v39, s[20:23], s47 offen sc1
s_add_u32 s47, s47, 512
LE_nf17:
v_mfma_f32_16x16x32_bf16 v[48:51], a[144:147], v[40:43], v[48:51]
v_mfma_f32_16x16x32_bf16 v[48:51], a[148:151], v[44:47], v[48:51]
s_bitcmp1_b32 s46, 18
s_cbranch_scc0 LE_nf18
s_cmp_eq_u32 s42, 0
s_cbranch_scc1 LE_fl18
buffer_load_dwordx2 v[66:67], v39, s[20:23], s47 offen sc1
s_waitcnt vmcnt(0)
v_lshlrev_b32 v64, 16, v66
v_and_b32 v65, 0xffff0000, v66
v_add_f32 v48, v48, v64
v_add_f32 v49, v49, v65
v_lshlrev_b32 v64, 16, v67
v_and_b32 v65, 0xffff0000, v67
v_add_f32 v50, v50, v64
v_add_f32 v51, v51, v65
LE_fl18:
s_nop 3
v_cvt_pk_bf16_f32 v64, v48, v49
v_cvt_pk_bf16_f32 v65, v50, v51
v_mov_b32 v48, 0
v_mov_b32 v49, 0
v_mov_b32 v50, 0
v_mov_b32 v51, 0
buffer_store_dwordx2 v[64:65], v39, s[20:23], s47 offen sc1
s_add_u32 s47, s47, 512
LE_nf18:
v_mfma_f32_16x16x32_bf16 v[48:51], a[152:155], v[40:43], v[48:51]
v_mfma_f32_16x16x32_bf16 v[48:51], a[156:159], v[44:47], v[48:51]
s_bitcmp1_b32 s46, 19
s_cbranch_scc0 LE_nf19
s_cmp_eq_u32 s42, 0
s_cbranch_scc1 LE_fl19
buffer_load_dwordx2 v[66:67], v39, s[20:23], s47 offen sc1
s_waitcnt vmcnt(0)
v_lshlrev_b32 v64, 16, v66
v_and_b32 v65, 0xffff0000, v66
v_add_f32 v48, v48, v64
v_add_f32 v49, v49, v65
v_lshlrev_b32 v64, 16, v67
v_and_b32 v65, 0xffff0000, v67
v_add_f32 v50, v50, v64
v_add_f32 v51, v51, v65
LE_fl19:
s_nop 3
v_cvt_pk_bf16_f32 v64, v48, v49
v_cvt_pk_bf16_f32 v65, v50, v51
v_mov_b32 v48, 0
v_mov_b32 v49, 0
v_mov_b32 v50, 0
v_mov_b32 v51, 0
buffer_store_dwordx2 v[64:65], v39, s[20:23], s47 offen sc1
s_add_u32 s47, s47, 512
LE_nf19:
s_waitcnt lgkmcnt(0)
ds_read2_b32 v[56:57], v34 offset0:80 offset1:84
ds_read2_b32 v[58:59], v34 offset0:88 offset1:92
v_mad_u32_u16 v60, v52, s49, v2
v_mad_u32_u16 v61, v53, s49, v2
v_mad_u32_u16 v62, v54, s49, v2
v_mad_u32_u16 v63, v55, s49, v2
buffer_load_dwordx4 a[128:131], v60, s[16:19], 0 offen sc1
buffer_load_dwordx4 a[132:135], v60, s[16:19], 0 offen offset:256 sc1
buffer_load_dwordx4 a[136:139], v61, s[16:19], 0 offen sc1
buffer_load_dwordx4 a[140:143], v61, s[16:19], 0 offen offset:256 sc1
buffer_load_dwordx4 a[144:147], v62, s[16:19], 0 offen sc1
buffer_load_dwordx4 a[148:151], v62, s[16:19], 0 offen offset:256 sc1
buffer_load_dwordx4 a[152:155], v63, s[16:19], 0 offen sc1
buffer_load_dwordx4 a[156:159], v63, s[16:19], 0 offen offset:256 sc1
s_waitcnt vmcnt(56)
v_mfma_f32_16x16x32_bf16 v[48:51], a[160:163], v[40:43], v[48:51]
v_mfma_f32_16x16x32_bf16 v[48:51], a[164:167], v[44:47], v[48:51]
s_bitcmp1_b32 s46, 20
s_cbranch_scc0 LE_nf20
s_cmp_eq_u32 s42, 0
s_cbranch_scc1 LE_fl20
buffer_load_dwordx2 v[66:67], v39, s[20:23], s47 offen sc1
s_waitcnt vmcnt(0)
v_lshlrev_b32 v64, 16, v66
v_and_b32 v65, 0xffff0000, v66
v_add_f32 v48, v48, v64
v_add_f32 v49, v49, v65
v_lshlrev_b32 v64, 16, v67
v_and_b32 v65, 0xffff0000, v67
v_add_f32 v50, v50, v64
v_add_f32 v51, v51, v65
LE_fl20:
s_nop 3
v_cvt_pk_bf16_f32 v64, v48, v49
v_cvt_pk_bf16_f32 v65, v50, v51
v_mov_b32 v48, 0
v_mov_b32 v49, 0
v_mov_b32 v50, 0
v_mov_b32 v51, 0
buffer_store_dwordx2 v[64:65], v39, s[20:23], s47 offen sc1
s_add_u32 s47, s47, 512
LE_nf20:
v_mfma_f32_16x16x32_bf16 v[48:51], a[168:171], v[40:43], v[48:51]
v_mfma_f32_16x16x32_bf16 v[48:51], a[172:175], v[44:47], v[48:51]
s_bitcmp1_b32 s46, 21
s_cbranch_scc0 LE_nf21
s_cmp_eq_u32 s42, 0
s_cbranch_scc1 LE_fl21
buffer_load_dwordx2 v[66:67], v39, s[20:23], s47 offen sc1
s_waitcnt vmcnt(0)
v_lshlrev_b32 v64, 16, v66
v_and_b32 v65, 0xffff0000, v66
v_add_f32 v48, v48, v64
v_add_f32 v49, v49, v65
v_lshlrev_b32 v64, 16, v67
v_and_b32 v65, 0xffff0000, v67
v_add_f32 v50, v50, v64
v_add_f32 v51, v51, v65
LE_fl21:
s_nop 3
v_cvt_pk_bf16_f32 v64, v48, v49
v_cvt_pk_bf16_f32 v65, v50, v51
v_mov_b32 v48, 0
v_mov_b32 v49, 0
v_mov_b32 v50, 0
v_mov_b32 v51, 0
buffer_store_dwordx2 v[64:65], v39, s[20:23], s47 offen sc1
s_add_u32 s47, s47, 512
LE_nf21:
v_mfma_f32_16x16x32_bf16 v[48:51], a[176:179], v[40:43], v[48:51]
v_mfma_f32_16x16x32_bf16 v[48:51], a[180:183], v[44:47], v[48:51]
s_bitcmp1_b32 s46, 22
s_cbranch_scc0 LE_nf22
s_cmp_eq_u32 s42, 0
s_cbranch_scc1 LE_fl22
buffer_load_dwordx2 v[66:67], v39, s[20:23], s47 offen sc1
s_waitcnt vmcnt(0)
v_lshlrev_b32 v64, 16, v66
v_and_b32 v65, 0xffff0000, v66
v_add_f32 v48, v48, v64
v_add_f32 v49, v49, v65
v_lshlrev_b32 v64, 16, v67
v_and_b32 v65, 0xffff0000, v67
v_add_f32 v50, v50, v64
v_add_f32 v51, v51, v65
LE_fl22:
s_nop 3
v_cvt_pk_bf16_f32 v64, v48, v49
v_cvt_pk_bf16_f32 v65, v50, v51
v_mov_b32 v48, 0
v_mov_b32 v49, 0
v_mov_b32 v50, 0
v_mov_b32 v51, 0
buffer_store_dwordx2 v[64:65], v39, s[20:23], s47 offen sc1
s_add_u32 s47, s47, 512
LE_nf22:
v_mfma_f32_16x16x32_bf16 v[48:51], a[184:187], v[40:43], v[48:51]
v_mfma_f32_16x16x32_bf16 v[48:51], a[188:191], v[44:47], v[48:51]
s_bitcmp1_b32 s46, 23
s_cbranch_scc0 LE_nf23
s_cmp_eq_u32 s42, 0
s_cbranch_scc1 LE_fl23
buffer_load_dwordx2 v[66:67], v39, s[20:23], s47 offen sc1
s_waitcnt vmcnt(0)
v_lshlrev_b32 v64, 16, v66
v_and_b32 v65, 0xffff0000, v66
v_add_f32 v48, v48, v64
v_add_f32 v49, v49, v65
v_lshlrev_b32 v64, 16, v67
v_and_b32 v65, 0xffff0000, v67
v_add_f32 v50, v50, v64
v_add_f32 v51, v51, v65
LE_fl23:
s_nop 3
v_cvt_pk_bf16_f32 v64, v48, v49
v_cvt_pk_bf16_f32 v65, v50, v51
v_mov_b32 v48, 0
v_mov_b32 v49, 0
v_mov_b32 v50, 0
v_mov_b32 v51, 0
buffer_store_dwordx2 v[64:65], v39, s[20:23], s47 offen sc1
s_add_u32 s47, s47, 512
LE_nf23:
s_waitcnt lgkmcnt(0)
ds_read2_b32 v[52:53], v34 offset0:96 offset1:100
ds_read2_b32 v[54:55], v34 offset0:104 offset1:108
v_mad_u32_u16 v60, v56, s49, v2
v_mad_u32_u16 v61, v57, s49, v2
v_mad_u32_u16 v62, v58, s49, v2
v_mad_u32_u16 v63, v59, s49, v2
buffer_load_dwordx4 a[160:163], v60, s[16:19], 0 offen sc1
buffer_load_dwordx4 a[164:167], v60, s[16:19], 0 offen offset:256 sc1
buffer_load_dwordx4 a[168:171], v61, s[16:19], 0 offen sc1
buffer_load_dwordx4 a[172:175], v61, s[16:19], 0 offen offset:256 sc1
buffer_load_dwordx4 a[176:179], v62, s[16:19], 0 offen sc1
buffer_load_dwordx4 a[180:183], v62, s[16:19], 0 offen offset:256 sc1
buffer_load_dwordx4 a[184:187], v63, s[16:19], 0 offen sc1
buffer_load_dwordx4 a[188:191], v63, s[16:19], 0 offen offset:256 sc1
s_waitcnt vmcnt(56)
v_mfma_f32_16x16x32_bf16 v[48:51], a[192:195], v[40:43], v[48:51]
v_mfma_f32_16x16x32_bf16 v[48:51], a[196:199], v[44:47], v[48:51]
s_bitcmp1_b32 s46, 24
s_cbranch_scc0 LE_nf24
s_cmp_eq_u32 s42, 0
s_cbranch_scc1 LE_fl24
buffer_load_dwordx2 v[66:67], v39, s[20:23], s47 offen sc1
s_waitcnt vmcnt(0)
v_lshlrev_b32 v64, 16, v66
v_and_b32 v65, 0xffff0000, v66
v_add_f32 v48, v48, v64
v_add_f32 v49, v49, v65
v_lshlrev_b32 v64, 16, v67
v_and_b32 v65, 0xffff0000, v67
v_add_f32 v50, v50, v64
v_add_f32 v51, v51, v65
LE_fl24:
s_nop 3
v_cvt_pk_bf16_f32 v64, v48, v49
v_cvt_pk_bf16_f32 v65, v50, v51
v_mov_b32 v48, 0
v_mov_b32 v49, 0
v_mov_b32 v50, 0
v_mov_b32 v51, 0
buffer_store_dwordx2 v[64:65], v39, s[20:23], s47 offen sc1
s_add_u32 s47, s47, 512
LE_nf24:
v_mfma_f32_16x16x32_bf16 v[48:51], a[200:203], v[40:43], v[48:51]
v_mfma_f32_16x16x32_bf16 v[48:51], a[204:207], v[44:47], v[48:51]
s_bitcmp1_b32 s46, 25
s_cbranch_scc0 LE_nf25
s_cmp_eq_u32 s42, 0
s_cbranch_scc1 LE_fl25
buffer_load_dwordx2 v[66:67], v39, s[20:23], s47 offen sc1
s_waitcnt vmcnt(0)
v_lshlrev_b32 v64, 16, v66
v_and_b32 v65, 0xffff0000, v66
v_add_f32 v48, v48, v64
v_add_f32 v49, v49, v65
v_lshlrev_b32 v64, 16, v67
v_and_b32 v65, 0xffff0000, v67
v_add_f32 v50, v50, v64
v_add_f32 v51, v51, v65
LE_fl25:
s_nop 3
v_cvt_pk_bf16_f32 v64, v48, v49
v_cvt_pk_bf16_f32 v65, v50, v51
v_mov_b32 v48, 0
v_mov_b32 v49, 0
v_mov_b32 v50, 0
v_mov_b32 v51, 0
buffer_store_dwordx2 v[64:65], v39, s[20:23], s47 offen sc1
s_add_u32 s47, s47, 512
LE_nf25:
v_mfma_f32_16x16x32_bf16 v[48:51], a[208:211], v[40:43], v[48:51]
v_mfma_f32_16x16x32_bf16 v[48:51], a[212:215], v[44:47], v[48:51]
s_bitcmp1_b32 s46, 26
s_cbranch_scc0 LE_nf26
s_cmp_eq_u32 s42, 0
s_cbranch_scc1 LE_fl26
buffer_load_dwordx2 v[66:67], v39, s[20:23], s47 offen sc1
s_waitcnt vmcnt(0)
v_lshlrev_b32 v64, 16, v66
v_and_b32 v65, 0xffff0000, v66
v_add_f32 v48, v48, v64
v_add_f32 v49, v49, v65
v_lshlrev_b32 v64, 16, v67
v_and_b32 v65, 0xffff0000, v67
v_add_f32 v50, v50, v64
v_add_f32 v51, v51, v65
LE_fl26:
s_nop 3
v_cvt_pk_bf16_f32 v64, v48, v49
v_cvt_pk_bf16_f32 v65, v50, v51
v_mov_b32 v48, 0
v_mov_b32 v49, 0
v_mov_b32 v50, 0
v_mov_b32 v51, 0
buffer_store_dwordx2 v[64:65], v39, s[20:23], s47 offen sc1
s_add_u32 s47, s47, 512
LE_nf26:
v_mfma_f32_16x16x32_bf16 v[48:51], a[216:219], v[40:43], v[48:51]
v_mfma_f32_16x16x32_bf16 v[48:51], a[220:223], v[44:47], v[48:51]
s_bitcmp1_b32 s46, 27
s_cbranch_scc0 LE_nf27
s_cmp_eq_u32 s42, 0
s_cbranch_scc1 LE_fl27
buffer_load_dwordx2 v[66:67], v39, s[20:23], s47 offen sc1
s_waitcnt vmcnt(0)
v_lshlrev_b32 v64, 16, v66
v_and_b32 v65, 0xffff0000, v66
v_add_f32 v48, v48, v64
v_add_f32 v49, v49, v65
v_lshlrev_b32 v64, 16, v67
v_and_b32 v65, 0xffff0000, v67
v_add_f32 v50, v50, v64
v_add_f32 v51, v51, v65
LE_fl27:
s_nop 3
v_cvt_pk_bf16_f32 v64, v48, v49
v_cvt_pk_bf16_f32 v65, v50, v51
v_mov_b32 v48, 0
v_mov_b32 v49, 0
v_mov_b32 v50, 0
v_mov_b32 v51, 0
buffer_store_dwordx2 v[64:65], v39, s[20:23], s47 offen sc1
s_add_u32 s47, s47, 512
LE_nf27:
s_waitcnt lgkmcnt(0)
ds_read2_b32 v[56:57], v34 offset0:112 offset1:116
ds_read2_b32 v[58:59], v34 offset0:120 offset1:124
v_mad_u32_u16 v60, v52, s49, v2
v_mad_u32_u16 v61, v53, s49, v2
v_mad_u32_u16 v62, v54, s49, v2
v_mad_u32_u16 v63, v55, s49, v2
buffer_load_dwordx4 a[192:195], v60, s[16:19], 0 offen sc1
buffer_load_dwordx4 a[196:199], v60, s[16:19], 0 offen offset:256 sc1
buffer_load_dwordx4 a[200:203], v61, s[16:19], 0 offen sc1
buffer_load_dwordx4 a[204:207], v61, s[16:19], 0 offen offset:256 sc1
buffer_load_dwordx4 a[208:211], v62, s[16:19], 0 offen sc1
buffer_load_dwordx4 a[212:215], v62, s[16:19], 0 offen offset:256 sc1
buffer_load_dwordx4 a[216:219], v63, s[16:19], 0 offen sc1
buffer_load_dwordx4 a[220:223], v63, s[16:19], 0 offen offset:256 sc1
s_waitcnt vmcnt(56)
v_mfma_f32_16x16x32_bf16 v[48:51], a[224:227], v[40:43], v[48:51]
v_mfma_f32_16x16x32_bf16 v[48:51], a[228:231], v[44:47], v[48:51]
s_bitcmp1_b32 s46, 28
s_cbranch_scc0 LE_nf28
s_cmp_eq_u32 s42, 0
s_cbranch_scc1 LE_fl28
buffer_load_dwordx2 v[66:67], v39, s[20:23], s47 offen sc1
s_waitcnt vmcnt(0)
v_lshlrev_b32 v64, 16, v66
v_and_b32 v65, 0xffff0000, v66
v_add_f32 v48, v48, v64
v_add_f32 v49, v49, v65
v_lshlrev_b32 v64, 16, v67
v_and_b32 v65, 0xffff0000, v67
v_add_f32 v50, v50, v64
v_add_f32 v51, v51, v65
LE_fl28:
s_nop 3
v_cvt_pk_bf16_f32 v64, v48, v49
v_cvt_pk_bf16_f32 v65, v50, v51
v_mov_b32 v48, 0
v_mov_b32 v49, 0
v_mov_b32 v50, 0
v_mov_b32 v51, 0
buffer_store_dwordx2 v[64:65], v39, s[20:23], s47 offen sc1
s_add_u32 s47, s47, 512
LE_nf28:
v_mfma_f32_16x16x32_bf16 v[48:51], a[232:235], v[40:43], v[48:51]
v_mfma_f32_16x16x32_bf16 v[48:51], a[236:239], v[44:47], v[48:51]
s_bitcmp1_b32 s46, 29
s_cbranch_scc0 LE_nf29
s_cmp_eq_u32 s42, 0
s_cbranch_scc1 LE_fl29
buffer_load_dwordx2 v[66:67], v39, s[20:23], s47 offen sc1
s_waitcnt vmcnt(0)
v_lshlrev_b32 v64, 16, v66
v_and_b32 v65, 0xffff0000, v66
v_add_f32 v48, v48, v64
v_add_f32 v49, v49, v65
v_lshlrev_b32 v64, 16, v67
v_and_b32 v65, 0xffff0000, v67
v_add_f32 v50, v50, v64
v_add_f32 v51, v51, v65
LE_fl29:
s_nop 3
v_cvt_pk_bf16_f32 v64, v48, v49
v_cvt_pk_bf16_f32 v65, v50, v51
v_mov_b32 v48, 0
v_mov_b32 v49, 0
v_mov_b32 v50, 0
v_mov_b32 v51, 0
buffer_store_dwordx2 v[64:65], v39, s[20:23], s47 offen sc1
s_add_u32 s47, s47, 512
LE_nf29:
v_mfma_f32_16x16x32_bf16 v[48:51], a[240:243], v[40:43], v[48:51]
v_mfma_f32_16x16x32_bf16 v[48:51], a[244:247], v[44:47], v[48:51]
s_bitcmp1_b32 s46, 30
s_cbranch_scc0 LE_nf30
s_cmp_eq_u32 s42, 0
s_cbranch_scc1 LE_fl30
buffer_load_dwordx2 v[66:67], v39, s[20:23], s47 offen sc1
s_waitcnt vmcnt(0)
v_lshlrev_b32 v64, 16, v66
v_and_b32 v65, 0xffff0000, v66
v_add_f32 v48, v48, v64
v_add_f32 v49, v49, v65
v_lshlrev_b32 v64, 16, v67
v_and_b32 v65, 0xffff0000, v67
v_add_f32 v50, v50, v64
v_add_f32 v51, v51, v65
LE_fl30:
s_nop 3
v_cvt_pk_bf16_f32 v64, v48, v49
v_cvt_pk_bf16_f32 v65, v50, v51
v_mov_b32 v48, 0
v_mov_b32 v49, 0
v_mov_b32 v50, 0
v_mov_b32 v51, 0
buffer_store_dwordx2 v[64:65], v39, s[20:23], s47 offen sc1
s_add_u32 s47, s47, 512
LE_nf30:
v_mfma_f32_16x16x32_bf16 v[48:51], a[248:251], v[40:43], v[48:51]
v_mfma_f32_16x16x32_bf16 v[48:51], a[252:255], v[44:47], v[48:51]
s_bitcmp1_b32 s46, 31
s_cbranch_scc0 LE_nf31
s_cmp_eq_u32 s42, 0
s_cbranch_scc1 LE_fl31
buffer_load_dwordx2 v[66:67], v39, s[20:23], s47 offen sc1
s_waitcnt vmcnt(0)
v_lshlrev_b32 v64, 16, v66
v_and_b32 v65, 0xffff0000, v66
v_add_f32 v48, v48, v64
v_add_f32 v49, v49, v65
v_lshlrev_b32 v64, 16, v67
v_and_b32 v65, 0xffff0000, v67
v_add_f32 v50, v50, v64
v_add_f32 v51, v51, v65
LE_fl31:
s_nop 3
v_cvt_pk_bf16_f32 v64, v48, v49
v_cvt_pk_bf16_f32 v65, v50, v51
v_mov_b32 v48, 0
v_mov_b32 v49, 0
v_mov_b32 v50, 0
v_mov_b32 v51, 0
buffer_store_dwordx2 v[64:65], v39, s[20:23], s47 offen sc1
s_add_u32 s47, s47, 512
LE_nf31:
s_waitcnt lgkmcnt(0)
ds_read2_b32 v[52:53], v34 offset0:128 offset1:132
ds_read2_b32 v[54:55], v34 offset0:136 offset1:140
v_mad_u32_u16 v60, v56, s49, v2
v_mad_u32_u16 v61, v57, s49, v2
v_mad_u32_u16 v62, v58, s49, v2
v_mad_u32_u16 v63, v59, s49, v2
buffer_load_dwordx4 a[224:227], v60, s[16:19], 0 offen sc1
buffer_load_dwordx4 a[228:231], v60, s[16:19], 0 offen offset:256 sc1
buffer_load_dwordx4 a[232:235], v61, s[16:19], 0 offen sc1
buffer_load_dwordx4 a[236:239], v61, s[16:19], 0 offen offset:256 sc1
buffer_load_dwordx4 a[240:243], v62, s[16:19], 0 offen sc1
buffer_load_dwordx4 a[244:247], v62, s[16:19], 0 offen offset:256 sc1
buffer_load_dwordx4 a[248:251], v63, s[16:19], 0 offen sc1
buffer_load_dwordx4 a[252:255], v63, s[16:19], 0 offen offset:256 sc1
v_add_u32 v34, 512, v34
s_cmp_lt_u32 s45, s44
s_cbranch_scc1 LE_loop
s_add_u32 s42, s42, 1
s_mul_i32 s43, s42, 256
v_cmp_lt_u32 vcc, s43, v4
s_cbranch_vccz LE_done
s_cmp_ge_u32 s42, 40
s_cbranch_scc1 LE_done
s_waitcnt vmcnt(0) lgkmcnt(0)
s_add_u32 s50, s50, 1024
v_add_u32 v5, 0x100, v5
buffer_load_dwordx4 v[192:195], v6, s[12:15], s50 offen offset:0 sc1
buffer_load_dwordx4 v[196:199], v6, s[12:15], s50 offen offset:64 sc1
buffer_load_dwordx4 v[200:203], v6, s[12:15], s50 offen offset:128 sc1
buffer_load_dwordx4 v[204:207], v6, s[12:15], s50 offen offset:192 sc1
buffer_load_dwordx4 v[208:211], v6, s[12:15], s50 offen offset:256 sc1
buffer_load_dwordx4 v[212:215], v6, s[12:15], s50 offen offset:320 sc1
buffer_load_dwordx4 v[216:219], v6, s[12:15], s50 offen offset:384 sc1
buffer_load_dwordx4 v[220:223], v6, s[12:15], s50 offen offset:448 sc1
buffer_load_dwordx4 v[224:227], v6, s[12:15], s50 offen offset:512 sc1
buffer_load_dwordx4 v[228:231], v6, s[12:15], s50 offen offset:576 sc1
buffer_load_dwordx4 v[232:235], v6, s[12:15], s50 offen offset:640 sc1
buffer_load_dwordx4 v[236:239], v6, s[12:15], s50 offen offset:704 sc1
buffer_load_dwordx4 v[240:243], v6, s[12:15], s50 offen offset:768 sc1
buffer_load_dwordx4 v[244:247], v6, s[12:15], s50 offen offset:832 sc1
buffer_load_dwordx4 v[248:251], v6, s[12:15], s50 offen offset:896 sc1
buffer_load_dwordx4 v[252:255], v6, s[12:15], s50 offen offset:960 sc1
s_branch LE_pass
LE_done:
s_add_u32 s24, s4, 0x7c00000
s_addc_u32 s25, s5, 0
s_mov_b32 s26, 0x40000
s_mov_b32 s27, 0x00020000
s_add_u32 s48, s40, 1280
s_mul_i32 s48, s48, 128
s_waitcnt vmcnt(0)
v_mov_b32 v32, s98
v_mov_b32 v33, s99
s_mov_b64 exec, 1
buffer_store_dwordx2 v[32:33], off, s[24:27], s48 sc1
s_mov_b64 exec, -1
s_branch L2_end
L2_fin:
L2_end:
s_endpgm
.section .rodata,"a"
.p2align 6
.amdhsa_kernel standalone__hybrid_graph_tf_graphgps__graph_kernel
  .amdhsa_next_free_vgpr 512
  .amdhsa_next_free_sgpr 102
  .amdhsa_accum_offset 256
  .amdhsa_group_segment_fixed_size 0
  .amdhsa_kernarg_size 96
  .amdhsa_user_sgpr_count 2
  .amdhsa_user_sgpr_kernarg_segment_ptr 1
  .amdhsa_system_sgpr_workgroup_id_x 1
.end_amdhsa_kernel
```

```asm
; @launch grid=(256,1,1) block=(256,1,1) lds=163840
.amdgcn_target "amdgcn-amd-amdhsa--gfx950"
.text
.globl standalone__hybrid_graph_tf_graphgps__graph_kernel
.p2align 8
.type standalone__hybrid_graph_tf_graphgps__graph_kernel,@function
standalone__hybrid_graph_tf_graphgps__graph_kernel:
s_getpc_b64 s[56:57]
s_load_dwordx16 s[16:31], s[0:1], 0
s_load_dwordx8 s[32:39], s[0:1], 64
s_cmp_ge_u32 s2, 256
s_cbranch_scc1 L2_end
v_lshrrev_b32 v1, 6, v0
v_and_b32 v2, 63, v0
s_lshr_b32 s3, s2, 3
s_add_u32 s3, s3, 30
s_and_b32 s3, s3, 31
v_readfirstlane_b32 s60, v1
s_lshl_b32 s5, s3, 2
s_add_u32 s5, s5, s60
s_and_b32 s56, s56, 0xffffff00
s_mov_b32 s58, L2_end-standalone__hybrid_graph_tf_graphgps__graph_kernel
s_mov_b32 s59, 0x00020000
s_and_b32 s6, s5, 15
s_lshl_b32 s6, s6, 13
v_lshlrev_b32 v10, 7, v2
buffer_load_dword v255, v10, s[56:59], s6 offen
v_and_b32 v3, 15, v2
v_lshrrev_b32 v4, 4, v2
s_and_b32 s62, s3, 7
s_mov_b64 s[14:15], 0
s_and_b32 s8, s2, 7
s_cmp_ge_u32 s3, 30
s_cbranch_scc1 LM_edge
s_mul_i32 s12, s3, 26
s_lshr_b32 s12, s12, 8
s_mul_i32 s9, s12, 10
s_sub_u32 s9, s3, s9
s_and_b32 s13, s8, 1
s_mul_i32 s13, s13, 3
s_add_u32 s13, s13, s12
s_lshr_b32 s12, s8, 1
s_mul_i32 s12, s12, 10
s_add_u32 s12, s12, s9
s_mul_i32 s91, s12, 6
s_add_u32 s91, s91, s13
s_mov_b32 s61, 0
s_cmp_eq_u32 s12, 39
s_cbranch_scc1 LM_light
s_mul_i32 s14, s13, 3
s_min_u32 s14, s14, 14
s_lshl_b32 s9, s12, 4
s_add_u32 s14, s14, s9
s_lshl_b32 s14, s14, 13
s_cmp_eq_u32 s91, 233
s_cselect_b32 s9, 0, s13
s_cmp_lt_u32 s9, 4
s_cselect_b32 s15, 3, 2
s_lshl_b32 s15, s15, 13
s_add_u32 s15, s15, s14
v_lshlrev_b32 v16, 4, v2
s_mul_i32 s63, s60, 12288
s_mov_b32 s6, s14
s_mul_i32 s7, s60, 6144
s_add_u32 s64, s6, s7
s_add_u32 s65, s64, 4096
s_lshl_b32 s7, s60, 7
v_lshrrev_b32 v5, 3, v2
v_and_b32 v6, 7, v2
v_and_b32 v7, 2, v5
v_xor_b32 v6, v6, v7
v_lshl_add_u32 v5, v5, 9, s7
v_lshl_add_u32 v17, v6, 4, v5
v_xor_b32 v6, 4, v6
v_lshl_add_u32 v18, v6, 4, v5
v_add_u32 v18, 0xc00, v18
v_add_u32 v19, 0x1800, v17
v_add_u32 v20, 0x1800, v18
s_xor_b32 s6, s62, 0
s_lshl_b32 s66, s6, 14
s_xor_b32 s6, s62, 1
s_lshl_b32 s67, s6, 14
s_xor_b32 s6, s62, 2
s_lshl_b32 s68, s6, 14
s_xor_b32 s6, s62, 3
s_lshl_b32 s69, s6, 14
s_xor_b32 s6, s62, 4
s_lshl_b32 s70, s6, 14
s_xor_b32 s6, s62, 5
s_lshl_b32 s71, s6, 14
s_xor_b32 s6, s62, 6
s_lshl_b32 s72, s6, 14
s_xor_b32 s6, s62, 7
s_lshl_b32 s73, s6, 14
s_waitcnt lgkmcnt(0)
s_add_u32 s40, s16, 0x0
s_addc_u32 s41, s17, 0
s_mov_b32 s42, s15
s_mov_b32 s43, 0x00020000
s_add_u32 s44, s26, 0x0
s_addc_u32 s45, s27, 0
s_mov_b32 s46, 0x20000
s_mov_b32 s47, 0x00020000
buffer_load_dwordx4 v[44:47], v16, s[40:43], s64 offen offset:0
buffer_load_dwordx4 v[48:51], v16, s[40:43], s64 offen offset:1024
buffer_load_dwordx4 v[52:55], v16, s[40:43], s64 offen offset:2048
buffer_load_dwordx4 v[56:59], v16, s[40:43], s64 offen offset:3072
buffer_load_dwordx4 v[60:63], v16, s[40:43], s65 offen offset:0
buffer_load_dwordx4 v[64:67], v16, s[40:43], s65 offen offset:1024
s_add_u32 m0, s63, 0x0
s_nop 0
buffer_load_dwordx4 v17, s[44:47], s66 offen offset:0 lds
buffer_load_dwordx4 v18, s[44:47], s66 offen offset:1024 lds
buffer_load_dwordx4 v19, s[44:47], s66 offen offset:2048 lds
buffer_load_dwordx4 v20, s[44:47], s66 offen offset:3072 lds
s_add_u32 m0, s63, 0x1000
s_nop 0
buffer_load_dwordx4 v17, s[44:47], s67 offen offset:0 lds
buffer_load_dwordx4 v18, s[44:47], s67 offen offset:1024 lds
buffer_load_dwordx4 v19, s[44:47], s67 offen offset:2048 lds
buffer_load_dwordx4 v20, s[44:47], s67 offen offset:3072 lds
s_mov_b32 s98, 0x7c3ff80
s_load_dwordx2 s[98:99], s[38:39], s98
v_bfe_u32 v5, v2, 2, 3
v_xor_b32 v5, s62, v5
v_and_b32 v6, 3, v2
v_lshlrev_b32 v7, 10, v5
v_lshl_add_u32 v7, v6, 8, v7
v_add_u32 v7, 0xc000, v7
v_and_b32 v5, 1, v5
v_lshl_or_b32 v6, v5, 2, v6
v_lshrrev_b32 v5, 5, v2
s_mul_i32 s6, s60, 12
v_add3_u32 v8, v5, s6, 0
v_lshrrev_b32 v9, 4, v8
v_lshl_add_u32 v9, v9, 13, v7
v_and_b32 v8, 15, v8
v_xor_b32 v8, v8, v6
v_lshl_add_u32 v36, v8, 4, v9
v_add3_u32 v8, v5, s6, 2
v_lshrrev_b32 v9, 4, v8
v_lshl_add_u32 v9, v9, 13, v7
v_and_b32 v8, 15, v8
v_xor_b32 v8, v8, v6
v_lshl_add_u32 v37, v8, 4, v9
v_add3_u32 v8, v5, s6, 4
v_lshrrev_b32 v9, 4, v8
v_lshl_add_u32 v9, v9, 13, v7
v_and_b32 v8, 15, v8
v_xor_b32 v8, v8, v6
v_lshl_add_u32 v38, v8, 4, v9
v_add3_u32 v8, v5, s6, 6
v_lshrrev_b32 v9, 4, v8
v_lshl_add_u32 v9, v9, 13, v7
v_and_b32 v8, 15, v8
v_xor_b32 v8, v8, v6
v_lshl_add_u32 v39, v8, 4, v9
v_add3_u32 v8, v5, s6, 8
v_lshrrev_b32 v9, 4, v8
v_lshl_add_u32 v9, v9, 13, v7
v_and_b32 v8, 15, v8
v_xor_b32 v8, v8, v6
v_lshl_add_u32 v40, v8, 4, v9
v_add3_u32 v8, v5, s6, 10
v_lshrrev_b32 v9, 4, v8
v_lshl_add_u32 v9, v9, 13, v7
v_and_b32 v8, 15, v8
v_xor_b32 v8, v8, v6
v_lshl_add_u32 v41, v8, 4, v9
v_xor_b32 v5, v3, v4
v_lshlrev_b32 v5, 4, v5
v_lshl_add_u32 v5, v4, 8, v5
v_add_u32 v31, 0xc000, v5
v_xor_b32 v32, 64, v31
v_lshrrev_b32 v5, 2, v3
v_and_b32 v6, 3, v3
v_and_b32 v7, 1, v4
v_lshlrev_b32 v7, 2, v7
v_and_b32 v8, 2, v5
v_or_b32 v7, v7, v8
v_lshl_add_u32 v8, v4, 3, v5
v_lshlrev_b32 v8, 7, v8
v_add_u32 v8, s63, v8
v_and_b32 v9, 1, v6
v_lshl_add_u32 v8, v9, 3, v8
v_lshrrev_b32 v6, 1, v6
v_xor_b32 v6, v6, v7
v_xor_b32 v9, 0, v6
v_lshl_add_u32 v25, v9, 4, v8
v_xor_b32 v9, 2, v6
v_lshl_add_u32 v26, v9, 4, v8
v_xor_b32 v9, 4, v6
v_lshl_add_u32 v27, v9, 4, v8
v_xor_b32 v9, 6, v6
v_lshl_add_u32 v28, v9, 4, v8
v_lshrrev_b32 v5, 3, v2
v_and_b32 v6, 7, v2
v_lshrrev_b32 v7, 1, v5
v_xor_b32 v6, v6, v7
v_and_b32 v7, 4, v5
v_add_u32 v5, v5, v7
s_mul_i32 s6, s60, 32768
v_lshl_add_u32 v5, v5, 9, s6
v_lshl_add_u32 v21, v6, 4, v5
v_xor_b32 v6, 4, v6
v_lshl_add_u32 v22, v6, 4, v5
v_add_u32 v22, 0x1c00, v22
v_mov_b32 v23, v21
v_mov_b32 v24, v22
s_lshr_b32 s7, s62, 1
s_xor_b32 s6, s7, 0
s_lshl_b32 s74, s6, 7
s_add_u32 s75, s74, 16384
s_xor_b32 s6, s7, 1
s_lshl_b32 s76, s6, 7
s_add_u32 s77, s76, 16384
s_xor_b32 s6, s7, 2
s_lshl_b32 s78, s6, 7
s_add_u32 s79, s78, 16384
s_xor_b32 s6, s7, 3
s_lshl_b32 s80, s6, 7
s_add_u32 s81, s80, 16384
s_and_b32 s6, s62, 1
s_lshl_b32 s6, s6, 2
v_lshrrev_b32 v5, 1, v3
v_xor_b32 v5, v5, v4
v_xor_b32 v5, s6, v5
v_lshl_add_u32 v6, v3, 7, s63
v_lshl_add_u32 v29, v5, 4, v6
v_xor_b32 v30, 64, v29
s_mul_i32 s6, s60, 2
s_xor_b32 s6, s6, s62
s_lshl_b32 s6, s6, 10
s_add_u32 s6, s6, 0x12000
v_lshrrev_b32 v5, 1, v4
v_and_b32 v6, 1, v4
v_lshl_add_u32 v5, v5, 8, s6
v_lshl_add_u32 v5, v6, 3, v5
v_lshl_add_u32 v33, v3, 4, v5
v_xor_b32 v34, 0x400, v33
v_add_u32 v35, 0x12000, v16
s_mov_b32 s6, s14
s_mul_i32 s7, s60, 2048
s_add_u32 s82, s6, s7
s_add_u32 s83, s82, 8192
s_add_u32 s84, s82, 16384
s_mov_b32 s86, 0x3db8aa3b
s_mov_b32 s87, 0x3db8aa3b
s_mov_b32 s88, 0x3727c5ac
s_mov_b32 s89, 0x3b800000
s_mov_b32 s90, 0xffff0000
s_add_u32 s48, s28, 0x0
s_addc_u32 s49, s29, 0
s_mov_b32 s50, 0x20000
s_mov_b32 s51, 0x00020000
s_add_u32 s52, s38, 0x0
s_addc_u32 s53, s39, 0
s_mov_b32 s54, s15
s_mov_b32 s55, 0x00020000
s_add_u32 s56, s38, 0x6800000
s_addc_u32 s57, s39, 0
s_mov_b32 s58, s15
s_mov_b32 s59, 0x00020000
s_waitcnt vmcnt(13)
v_lshlrev_b32 v116, 16, v44
v_and_b32 v117, s90, v44
v_lshlrev_b32 v118, 16, v45
v_and_b32 v119, s90, v45
v_lshlrev_b32 v120, 16, v46
v_and_b32 v121, s90, v46
v_lshlrev_b32 v122, 16, v47
v_and_b32 v123, s90, v47
v_pk_add_f32 v[164:165], v[116:117], v[118:119]
v_pk_mul_f32 v[166:167], v[116:117], v[116:117]
v_pk_add_f32 v[44:45], v[120:121], v[122:123]
v_pk_fma_f32 v[166:167], v[118:119], v[118:119], v[166:167]
v_pk_add_f32 v[164:165], v[164:165], v[44:45]
v_pk_fma_f32 v[166:167], v[120:121], v[120:121], v[166:167]
v_add_f32 v164, v164, v165
v_pk_fma_f32 v[166:167], v[122:123], v[122:123], v[166:167]
v_add_f32 v166, v166, v167
s_waitcnt vmcnt(12)
v_lshlrev_b32 v124, 16, v48
v_and_b32 v125, s90, v48
v_lshlrev_b32 v126, 16, v49
v_and_b32 v127, s90, v49
v_lshlrev_b32 v128, 16, v50
v_and_b32 v129, s90, v50
v_lshlrev_b32 v130, 16, v51
v_and_b32 v131, s90, v51
v_pk_add_f32 v[168:169], v[124:125], v[126:127]
v_pk_mul_f32 v[170:171], v[124:125], v[124:125]
v_pk_add_f32 v[48:49], v[128:129], v[130:131]
v_pk_fma_f32 v[170:171], v[126:127], v[126:127], v[170:171]
v_pk_add_f32 v[168:169], v[168:169], v[48:49]
v_pk_fma_f32 v[170:171], v[128:129], v[128:129], v[170:171]
v_add_f32 v168, v168, v169
v_pk_fma_f32 v[170:171], v[130:131], v[130:131], v[170:171]
v_add_f32 v170, v170, v171
s_waitcnt vmcnt(11)
v_lshlrev_b32 v132, 16, v52
v_and_b32 v133, s90, v52
v_lshlrev_b32 v134, 16, v53
v_and_b32 v135, s90, v53
v_lshlrev_b32 v136, 16, v54
v_and_b32 v137, s90, v54
v_lshlrev_b32 v138, 16, v55
v_and_b32 v139, s90, v55
v_pk_add_f32 v[172:173], v[132:133], v[134:135]
v_pk_mul_f32 v[174:175], v[132:133], v[132:133]
v_pk_add_f32 v[52:53], v[136:137], v[138:139]
v_pk_fma_f32 v[174:175], v[134:135], v[134:135], v[174:175]
v_pk_add_f32 v[172:173], v[172:173], v[52:53]
v_pk_fma_f32 v[174:175], v[136:137], v[136:137], v[174:175]
v_add_f32 v172, v172, v173
v_pk_fma_f32 v[174:175], v[138:139], v[138:139], v[174:175]
v_add_f32 v174, v174, v175
s_waitcnt vmcnt(10)
v_lshlrev_b32 v140, 16, v56
v_and_b32 v141, s90, v56
v_lshlrev_b32 v142, 16, v57
v_and_b32 v143, s90, v57
v_lshlrev_b32 v144, 16, v58
v_and_b32 v145, s90, v58
v_lshlrev_b32 v146, 16, v59
v_and_b32 v147, s90, v59
v_pk_add_f32 v[176:177], v[140:141], v[142:143]
v_pk_mul_f32 v[178:179], v[140:141], v[140:141]
v_pk_add_f32 v[56:57], v[144:145], v[146:147]
v_pk_fma_f32 v[178:179], v[142:143], v[142:143], v[178:179]
v_pk_add_f32 v[176:177], v[176:177], v[56:57]
v_pk_fma_f32 v[178:179], v[144:145], v[144:145], v[178:179]
v_add_f32 v176, v176, v177
v_pk_fma_f32 v[178:179], v[146:147], v[146:147], v[178:179]
v_add_f32 v178, v178, v179
s_waitcnt vmcnt(9)
v_lshlrev_b32 v148, 16, v60
v_and_b32 v149, s90, v60
v_lshlrev_b32 v150, 16, v61
v_and_b32 v151, s90, v61
v_lshlrev_b32 v152, 16, v62
v_and_b32 v153, s90, v62
v_lshlrev_b32 v154, 16, v63
v_and_b32 v155, s90, v63
v_pk_add_f32 v[180:181], v[148:149], v[150:151]
v_pk_mul_f32 v[182:183], v[148:149], v[148:149]
v_pk_add_f32 v[60:61], v[152:153], v[154:155]
v_pk_fma_f32 v[182:183], v[150:151], v[150:151], v[182:183]
v_pk_add_f32 v[180:181], v[180:181], v[60:61]
v_pk_fma_f32 v[182:183], v[152:153], v[152:153], v[182:183]
v_add_f32 v180, v180, v181
v_pk_fma_f32 v[182:183], v[154:155], v[154:155], v[182:183]
v_add_f32 v182, v182, v183
s_waitcnt vmcnt(8)
v_lshlrev_b32 v156, 16, v64
v_and_b32 v157, s90, v64
v_lshlrev_b32 v158, 16, v65
v_and_b32 v159, s90, v65
v_lshlrev_b32 v160, 16, v66
v_and_b32 v161, s90, v66
v_lshlrev_b32 v162, 16, v67
v_and_b32 v163, s90, v67
v_pk_add_f32 v[184:185], v[156:157], v[158:159]
v_pk_mul_f32 v[186:187], v[156:157], v[156:157]
v_pk_add_f32 v[64:65], v[160:161], v[162:163]
v_pk_fma_f32 v[186:187], v[158:159], v[158:159], v[186:187]
v_pk_add_f32 v[184:185], v[184:185], v[64:65]
v_pk_fma_f32 v[186:187], v[160:161], v[160:161], v[186:187]
v_add_f32 v184, v184, v185
v_pk_fma_f32 v[186:187], v[162:163], v[162:163], v[186:187]
v_add_f32 v186, v186, v187
v_permlane16_swap_b32 v164, v166
v_permlane16_swap_b32 v168, v170
v_permlane16_swap_b32 v172, v174
v_permlane16_swap_b32 v176, v178
v_permlane16_swap_b32 v180, v182
v_permlane16_swap_b32 v184, v186
v_add_f32 v164, v164, v166
v_add_f32 v168, v168, v170
v_add_f32 v172, v172, v174
v_add_f32 v176, v176, v178
v_add_f32 v180, v180, v182
v_add_f32 v184, v184, v186
v_add_f32_dpp v165, v164, v164 row_ror:8 row_mask:0xf bank_mask:0x3
v_add_f32_dpp v165, v168, v168 row_ror:8 row_mask:0xf bank_mask:0xc
v_add_f32_dpp v173, v172, v172 row_ror:8 row_mask:0xf bank_mask:0x3
v_add_f32_dpp v173, v176, v176 row_ror:8 row_mask:0xf bank_mask:0xc
v_add_f32_dpp v181, v180, v180 row_ror:8 row_mask:0xf bank_mask:0x3
v_add_f32_dpp v181, v184, v184 row_ror:8 row_mask:0xf bank_mask:0xc
v_add_f32_dpp v166, v165, v165 row_half_mirror row_mask:0xf bank_mask:0x5
v_add_f32_dpp v166, v173, v173 row_half_mirror row_mask:0xf bank_mask:0xa
v_add_f32_dpp v182, v181, v181 row_half_mirror row_mask:0xf bank_mask:0xf
s_nop 0
v_add_f32_dpp v166, v166, v166 quad_perm:[1,0,3,2] row_mask:0xf bank_mask:0xf
v_add_f32_dpp v182, v182, v182 quad_perm:[1,0,3,2] row_mask:0xf bank_mask:0xf
s_nop 0
v_add_f32_dpp v166, v166, v166 quad_perm:[2,3,0,1] row_mask:0xf bank_mask:0xf
v_add_f32_dpp v182, v182, v182 quad_perm:[2,3,0,1] row_mask:0xf bank_mask:0xf
v_mov_b32 v167, v166
v_mov_b32 v183, v182
s_nop 0
v_permlane16_swap_b32 v167, v166
v_permlane16_swap_b32 v183, v182
v_mul_f32 v167, s89, v167
v_mul_f32 v183, s89, v183
v_mul_f32 v166, s89, v166
v_mul_f32 v182, s89, v182
v_fma_f32 v166, -v167, v167, v166
v_fma_f32 v182, -v183, v183, v182
v_cvt_pk_bf16_f32 v167, v167, v167
v_cvt_pk_bf16_f32 v183, v183, v183
v_max_f32 v166, 0, v166
v_max_f32 v182, 0, v182
v_cvt_pk_bf16_f32 v166, v166, v166
v_cvt_pk_bf16_f32 v182, v182, v182
v_and_b32 v166, s90, v166
v_and_b32 v182, s90, v182
v_add_f32 v166, s88, v166
v_add_f32 v182, s88, v182
v_cvt_pk_bf16_f32 v166, v166, v166
v_cvt_pk_bf16_f32 v182, v182, v182
v_and_b32 v166, s90, v166
v_and_b32 v182, s90, v182
v_sqrt_f32 v166, v166
v_sqrt_f32 v182, v182
v_and_b32 v167, s90, v167
v_and_b32 v183, s90, v183
v_cvt_pk_bf16_f32 v166, v166, v166
v_cvt_pk_bf16_f32 v182, v182, v182
v_and_b32 v166, s90, v166
v_and_b32 v182, s90, v182
v_rcp_f32 v166, v166
v_rcp_f32 v182, v182
v_mul_f32 v167, -v167, v166
v_mul_f32 v183, -v183, v182
s_nop 0
v_mov_b64_dpp v[164:165], v[166:167] row_newbcast:0 row_mask:0xf bank_mask:0xf
v_mov_b64_dpp v[168:169], v[166:167] row_newbcast:8 row_mask:0xf bank_mask:0xf
v_mov_b64_dpp v[172:173], v[166:167] row_newbcast:4 row_mask:0xf bank_mask:0xf
v_mov_b64_dpp v[176:177], v[166:167] row_newbcast:12 row_mask:0xf bank_mask:0xf
v_mov_b64_dpp v[180:181], v[182:183] row_newbcast:0 row_mask:0xf bank_mask:0xf
v_mov_b64_dpp v[184:185], v[182:183] row_newbcast:8 row_mask:0xf bank_mask:0xf
v_fma_f32 v116, v116, v164, v165
v_fma_f32 v117, v117, v164, v165
v_fma_f32 v118, v118, v164, v165
v_fma_f32 v119, v119, v164, v165
v_fma_f32 v120, v120, v164, v165
v_fma_f32 v121, v121, v164, v165
v_fma_f32 v122, v122, v164, v165
v_fma_f32 v123, v123, v164, v165
v_cvt_pk_bf16_f32 v44, v116, v117
v_cvt_pk_bf16_f32 v45, v118, v119
v_cvt_pk_bf16_f32 v46, v120, v121
v_cvt_pk_bf16_f32 v47, v122, v123
ds_write_b128 v36, v[44:47]
v_fma_f32 v124, v124, v168, v169
v_fma_f32 v125, v125, v168, v169
v_fma_f32 v126, v126, v168, v169
v_fma_f32 v127, v127, v168, v169
v_fma_f32 v128, v128, v168, v169
v_fma_f32 v129, v129, v168, v169
v_fma_f32 v130, v130, v168, v169
v_fma_f32 v131, v131, v168, v169
v_cvt_pk_bf16_f32 v48, v124, v125
v_cvt_pk_bf16_f32 v49, v126, v127
v_cvt_pk_bf16_f32 v50, v128, v129
v_cvt_pk_bf16_f32 v51, v130, v131
ds_write_b128 v37, v[48:51]
v_fma_f32 v132, v132, v172, v173
v_fma_f32 v133, v133, v172, v173
v_fma_f32 v134, v134, v172, v173
v_fma_f32 v135, v135, v172, v173
v_fma_f32 v136, v136, v172, v173
v_fma_f32 v137, v137, v172, v173
v_fma_f32 v138, v138, v172, v173
v_fma_f32 v139, v139, v172, v173
v_cvt_pk_bf16_f32 v52, v132, v133
v_cvt_pk_bf16_f32 v53, v134, v135
v_cvt_pk_bf16_f32 v54, v136, v137
v_cvt_pk_bf16_f32 v55, v138, v139
ds_write_b128 v38, v[52:55]
v_fma_f32 v140, v140, v176, v177
v_fma_f32 v141, v141, v176, v177
v_fma_f32 v142, v142, v176, v177
v_fma_f32 v143, v143, v176, v177
v_fma_f32 v144, v144, v176, v177
v_fma_f32 v145, v145, v176, v177
v_fma_f32 v146, v146, v176, v177
v_fma_f32 v147, v147, v176, v177
v_cvt_pk_bf16_f32 v56, v140, v141
v_cvt_pk_bf16_f32 v57, v142, v143
v_cvt_pk_bf16_f32 v58, v144, v145
v_cvt_pk_bf16_f32 v59, v146, v147
ds_write_b128 v39, v[56:59]
v_fma_f32 v148, v148, v180, v181
v_fma_f32 v149, v149, v180, v181
v_fma_f32 v150, v150, v180, v181
v_fma_f32 v151, v151, v180, v181
v_fma_f32 v152, v152, v180, v181
v_fma_f32 v153, v153, v180, v181
v_fma_f32 v154, v154, v180, v181
v_fma_f32 v155, v155, v180, v181
v_cvt_pk_bf16_f32 v60, v148, v149
v_cvt_pk_bf16_f32 v61, v150, v151
v_cvt_pk_bf16_f32 v62, v152, v153
v_cvt_pk_bf16_f32 v63, v154, v155
ds_write_b128 v40, v[60:63]
v_fma_f32 v156, v156, v184, v185
v_fma_f32 v157, v157, v184, v185
v_fma_f32 v158, v158, v184, v185
v_fma_f32 v159, v159, v184, v185
v_fma_f32 v160, v160, v184, v185
v_fma_f32 v161, v161, v184, v185
v_fma_f32 v162, v162, v184, v185
v_fma_f32 v163, v163, v184, v185
v_cvt_pk_bf16_f32 v64, v156, v157
v_cvt_pk_bf16_f32 v65, v158, v159
v_cvt_pk_bf16_f32 v66, v160, v161
v_cvt_pk_bf16_f32 v67, v162, v163
ds_write_b128 v41, v[64:67]
s_add_u32 m0, s63, 0x2000
s_nop 0
buffer_load_dwordx4 v17, s[44:47], s68 offen offset:0 lds
buffer_load_dwordx4 v18, s[44:47], s68 offen offset:1024 lds
buffer_load_dwordx4 v19, s[44:47], s68 offen offset:2048 lds
buffer_load_dwordx4 v20, s[44:47], s68 offen offset:3072 lds
s_waitcnt vmcnt(8)
ds_read_b64_tr_b16 v[164:165], v25 offset:0
ds_read_b64_tr_b16 v[166:167], v25 offset:512
ds_read_b64_tr_b16 v[168:169], v26 offset:0
ds_read_b64_tr_b16 v[170:171], v26 offset:512
ds_read_b64_tr_b16 v[172:173], v27 offset:0
ds_read_b64_tr_b16 v[174:175], v27 offset:512
s_waitcnt lgkmcnt(6)
s_barrier
ds_read_b128 v[204:207], v31 offset:0
ds_read_b128 v[208:211], v31 offset:8192
ds_read_b128 v[212:215], v31 offset:16384
s_waitcnt lgkmcnt(2)
v_mfma_f32_16x16x32_bf16 v[68:71], v[164:167], v[204:207], 0
s_waitcnt lgkmcnt(1)
v_mfma_f32_16x16x32_bf16 v[72:75], v[164:167], v[208:211], 0
s_waitcnt lgkmcnt(0)
v_mfma_f32_16x16x32_bf16 v[76:79], v[164:167], v[212:215], 0
ds_read_b64_tr_b16 v[176:177], v28 offset:0
ds_read_b64_tr_b16 v[178:179], v28 offset:512
v_mfma_f32_16x16x32_bf16 v[80:83], v[168:171], v[204:207], 0
v_mfma_f32_16x16x32_bf16 v[84:87], v[168:171], v[208:211], 0
v_mfma_f32_16x16x32_bf16 v[88:91], v[168:171], v[212:215], 0
ds_read_b128 v[216:219], v32 offset:1024
s_waitcnt vmcnt(4)
ds_read_b64_tr_b16 v[180:181], v25 offset:4096
ds_read_b64_tr_b16 v[182:183], v25 offset:4608
v_mfma_f32_16x16x32_bf16 v[92:95], v[172:175], v[204:207], 0
ds_read_b128 v[220:223], v32 offset:9216
v_mfma_f32_16x16x32_bf16 v[96:99], v[172:175], v[208:211], 0
ds_read_b128 v[224:227], v32 offset:17408
v_mfma_f32_16x16x32_bf16 v[100:103], v[172:175], v[212:215], 0
ds_read_b64_tr_b16 v[184:185], v26 offset:4096
ds_read_b64_tr_b16 v[186:187], v26 offset:4608
s_waitcnt lgkmcnt(7)
v_mfma_f32_16x16x32_bf16 v[104:107], v[176:179], v[204:207], 0
s_add_u32 m0, s63, 0x0
s_nop 0
buffer_load_dwordx4 v17, s[44:47], s69 offen offset:0 lds
buffer_load_dwordx4 v18, s[44:47], s69 offen offset:1024 lds
buffer_load_dwordx4 v19, s[44:47], s69 offen offset:2048 lds
buffer_load_dwordx4 v20, s[44:47], s69 offen offset:3072 lds
v_mfma_f32_16x16x32_bf16 v[108:111], v[176:179], v[208:211], 0
v_mfma_f32_16x16x32_bf16 v[112:115], v[176:179], v[212:215], 0
ds_read_b64_tr_b16 v[188:189], v27 offset:4096
ds_read_b64_tr_b16 v[190:191], v27 offset:4608
s_waitcnt lgkmcnt(6)
v_mfma_f32_16x16x32_bf16 v[68:71], v[180:183], v[216:219], v[68:71]
s_waitcnt lgkmcnt(5)
v_mfma_f32_16x16x32_bf16 v[72:75], v[180:183], v[220:223], v[72:75]
s_waitcnt lgkmcnt(4)
v_mfma_f32_16x16x32_bf16 v[76:79], v[180:183], v[224:227], v[76:79]
ds_read_b64_tr_b16 v[192:193], v28 offset:4096
ds_read_b64_tr_b16 v[194:195], v28 offset:4608
s_waitcnt lgkmcnt(4)
v_mfma_f32_16x16x32_bf16 v[80:83], v[184:187], v[216:219], v[80:83]
v_mfma_f32_16x16x32_bf16 v[84:87], v[184:187], v[220:223], v[84:87]
v_mfma_f32_16x16x32_bf16 v[88:91], v[184:187], v[224:227], v[88:91]
ds_read_b128 v[228:231], v31 offset:2048
s_waitcnt vmcnt(4)
ds_read_b64_tr_b16 v[196:197], v25 offset:8192
ds_read_b64_tr_b16 v[198:199], v25 offset:8704
s_waitcnt lgkmcnt(5)
v_mfma_f32_16x16x32_bf16 v[92:95], v[188:191], v[216:219], v[92:95]
ds_read_b128 v[232:235], v31 offset:10240
v_mfma_f32_16x16x32_bf16 v[96:99], v[188:191], v[220:223], v[96:99]
ds_read_b128 v[236:239], v31 offset:18432
v_mfma_f32_16x16x32_bf16 v[100:103], v[188:191], v[224:227], v[100:103]
ds_read_b64_tr_b16 v[200:201], v26 offset:8192
ds_read_b64_tr_b16 v[202:203], v26 offset:8704
s_waitcnt lgkmcnt(7)
v_mfma_f32_16x16x32_bf16 v[104:107], v[192:195], v[216:219], v[104:107]
s_add_u32 m0, s63, 0x1000
s_nop 0
buffer_load_dwordx4 v17, s[44:47], s70 offen offset:0 lds
buffer_load_dwordx4 v18, s[44:47], s70 offen offset:1024 lds
buffer_load_dwordx4 v19, s[44:47], s70 offen offset:2048 lds
buffer_load_dwordx4 v20, s[44:47], s70 offen offset:3072 lds
v_mfma_f32_16x16x32_bf16 v[108:111], v[192:195], v[220:223], v[108:111]
v_mfma_f32_16x16x32_bf16 v[112:115], v[192:195], v[224:227], v[112:115]
ds_read_b64_tr_b16 v[164:165], v27 offset:8192
ds_read_b64_tr_b16 v[166:167], v27 offset:8704
s_waitcnt lgkmcnt(6)
v_mfma_f32_16x16x32_bf16 v[68:71], v[196:199], v[228:231], v[68:71]
s_waitcnt lgkmcnt(5)
v_mfma_f32_16x16x32_bf16 v[72:75], v[196:199], v[232:235], v[72:75]
s_waitcnt lgkmcnt(4)
v_mfma_f32_16x16x32_bf16 v[76:79], v[196:199], v[236:239], v[76:79]
ds_read_b64_tr_b16 v[168:169], v28 offset:8192
ds_read_b64_tr_b16 v[170:171], v28 offset:8704
s_waitcnt lgkmcnt(4)
v_mfma_f32_16x16x32_bf16 v[80:83], v[200:203], v[228:231], v[80:83]
v_mfma_f32_16x16x32_bf16 v[84:87], v[200:203], v[232:235], v[84:87]
v_mfma_f32_16x16x32_bf16 v[88:91], v[200:203], v[236:239], v[88:91]
ds_read_b128 v[204:207], v32 offset:3072
s_waitcnt vmcnt(4)
ds_read_b64_tr_b16 v[172:173], v25 offset:0
ds_read_b64_tr_b16 v[174:175], v25 offset:512
s_waitcnt lgkmcnt(5)
v_mfma_f32_16x16x32_bf16 v[92:95], v[164:167], v[228:231], v[92:95]
ds_read_b128 v[208:211], v32 offset:11264
v_mfma_f32_16x16x32_bf16 v[96:99], v[164:167], v[232:235], v[96:99]
ds_read_b128 v[212:215], v32 offset:19456
v_mfma_f32_16x16x32_bf16 v[100:103], v[164:167], v[236:239], v[100:103]
ds_read_b64_tr_b16 v[176:177], v26 offset:0
ds_read_b64_tr_b16 v[178:179], v26 offset:512
s_waitcnt lgkmcnt(7)
v_mfma_f32_16x16x32_bf16 v[104:107], v[168:171], v[228:231], v[104:107]
s_add_u32 m0, s63, 0x2000
s_nop 0
buffer_load_dwordx4 v17, s[44:47], s71 offen offset:0 lds
buffer_load_dwordx4 v18, s[44:47], s71 offen offset:1024 lds
buffer_load_dwordx4 v19, s[44:47], s71 offen offset:2048 lds
buffer_load_dwordx4 v20, s[44:47], s71 offen offset:3072 lds
v_mfma_f32_16x16x32_bf16 v[108:111], v[168:171], v[232:235], v[108:111]
v_mfma_f32_16x16x32_bf16 v[112:115], v[168:171], v[236:239], v[112:115]
ds_read_b64_tr_b16 v[180:181], v27 offset:0
ds_read_b64_tr_b16 v[182:183], v27 offset:512
s_waitcnt lgkmcnt(6)
v_mfma_f32_16x16x32_bf16 v[68:71], v[172:175], v[204:207], v[68:71]
s_waitcnt lgkmcnt(5)
v_mfma_f32_16x16x32_bf16 v[72:75], v[172:175], v[208:211], v[72:75]
s_waitcnt lgkmcnt(4)
v_mfma_f32_16x16x32_bf16 v[76:79], v[172:175], v[212:215], v[76:79]
ds_read_b64_tr_b16 v[184:185], v28 offset:0
ds_read_b64_tr_b16 v[186:187], v28 offset:512
s_waitcnt lgkmcnt(4)
v_mfma_f32_16x16x32_bf16 v[80:83], v[176:179], v[204:207], v[80:83]
v_mfma_f32_16x16x32_bf16 v[84:87], v[176:179], v[208:211], v[84:87]
v_mfma_f32_16x16x32_bf16 v[88:91], v[176:179], v[212:215], v[88:91]
ds_read_b128 v[216:219], v31 offset:4096
s_waitcnt vmcnt(4)
ds_read_b64_tr_b16 v[188:189], v25 offset:4096
ds_read_b64_tr_b16 v[190:191], v25 offset:4608
s_waitcnt lgkmcnt(5)
v_mfma_f32_16x16x32_bf16 v[92:95], v[180:183], v[204:207], v[92:95]
ds_read_b128 v[220:223], v31 offset:12288
v_mfma_f32_16x16x32_bf16 v[96:99], v[180:183], v[208:211], v[96:99]
ds_read_b128 v[224:227], v31 offset:20480
v_mfma_f32_16x16x32_bf16 v[100:103], v[180:183], v[212:215], v[100:103]
ds_read_b64_tr_b16 v[192:193], v26 offset:4096
ds_read_b64_tr_b16 v[194:195], v26 offset:4608
s_waitcnt lgkmcnt(7)
v_mfma_f32_16x16x32_bf16 v[104:107], v[184:187], v[204:207], v[104:107]
s_add_u32 m0, s63, 0x0
s_nop 0
buffer_load_dwordx4 v17, s[44:47], s72 offen offset:0 lds
buffer_load_dwordx4 v18, s[44:47], s72 offen offset:1024 lds
buffer_load_dwordx4 v19, s[44:47], s72 offen offset:2048 lds
buffer_load_dwordx4 v20, s[44:47], s72 offen offset:3072 lds
v_mfma_f32_16x16x32_bf16 v[108:111], v[184:187], v[208:211], v[108:111]
v_mfma_f32_16x16x32_bf16 v[112:115], v[184:187], v[212:215], v[112:115]
ds_read_b64_tr_b16 v[196:197], v27 offset:4096
ds_read_b64_tr_b16 v[198:199], v27 offset:4608
s_waitcnt lgkmcnt(6)
v_mfma_f32_16x16x32_bf16 v[68:71], v[188:191], v[216:219], v[68:71]
s_waitcnt lgkmcnt(5)
v_mfma_f32_16x16x32_bf16 v[72:75], v[188:191], v[220:223], v[72:75]
s_waitcnt lgkmcnt(4)
v_mfma_f32_16x16x32_bf16 v[76:79], v[188:191], v[224:227], v[76:79]
ds_read_b64_tr_b16 v[200:201], v28 offset:4096
ds_read_b64_tr_b16 v[202:203], v28 offset:4608
s_waitcnt lgkmcnt(4)
v_mfma_f32_16x16x32_bf16 v[80:83], v[192:195], v[216:219], v[80:83]
v_mfma_f32_16x16x32_bf16 v[84:87], v[192:195], v[220:223], v[84:87]
v_mfma_f32_16x16x32_bf16 v[88:91], v[192:195], v[224:227], v[88:91]
ds_read_b128 v[228:231], v32 offset:5120
s_waitcnt vmcnt(4)
ds_read_b64_tr_b16 v[164:165], v25 offset:8192
ds_read_b64_tr_b16 v[166:167], v25 offset:8704
s_waitcnt lgkmcnt(5)
v_mfma_f32_16x16x32_bf16 v[92:95], v[196:199], v[216:219], v[92:95]
ds_read_b128 v[232:235], v32 offset:13312
v_mfma_f32_16x16x32_bf16 v[96:99], v[196:199], v[220:223], v[96:99]
ds_read_b128 v[236:239], v32 offset:21504
v_mfma_f32_16x16x32_bf16 v[100:103], v[196:199], v[224:227], v[100:103]
ds_read_b64_tr_b16 v[168:169], v26 offset:8192
ds_read_b64_tr_b16 v[170:171], v26 offset:8704
s_waitcnt lgkmcnt(7)
v_mfma_f32_16x16x32_bf16 v[104:107], v[200:203], v[216:219], v[104:107]
s_add_u32 m0, s63, 0x1000
s_nop 0
buffer_load_dwordx4 v17, s[44:47], s73 offen offset:0 lds
buffer_load_dwordx4 v18, s[44:47], s73 offen offset:1024 lds
buffer_load_dwordx4 v19, s[44:47], s73 offen offset:2048 lds
buffer_load_dwordx4 v20, s[44:47], s73 offen offset:3072 lds
v_mfma_f32_16x16x32_bf16 v[108:111], v[200:203], v[220:223], v[108:111]
v_mfma_f32_16x16x32_bf16 v[112:115], v[200:203], v[224:227], v[112:115]
ds_read_b64_tr_b16 v[172:173], v27 offset:8192
ds_read_b64_tr_b16 v[174:175], v27 offset:8704
s_waitcnt lgkmcnt(6)
v_mfma_f32_16x16x32_bf16 v[68:71], v[164:167], v[228:231], v[68:71]
s_waitcnt lgkmcnt(5)
v_mfma_f32_16x16x32_bf16 v[72:75], v[164:167], v[232:235], v[72:75]
s_waitcnt lgkmcnt(4)
v_mfma_f32_16x16x32_bf16 v[76:79], v[164:167], v[236:239], v[76:79]
ds_read_b64_tr_b16 v[176:177], v28 offset:8192
ds_read_b64_tr_b16 v[178:179], v28 offset:8704
s_waitcnt lgkmcnt(4)
v_mfma_f32_16x16x32_bf16 v[80:83], v[168:171], v[228:231], v[80:83]
v_mfma_f32_16x16x32_bf16 v[84:87], v[168:171], v[232:235], v[84:87]
v_mfma_f32_16x16x32_bf16 v[88:91], v[168:171], v[236:239], v[88:91]
ds_read_b128 v[204:207], v31 offset:6144
s_waitcnt vmcnt(4)
ds_read_b64_tr_b16 v[180:181], v25 offset:0
ds_read_b64_tr_b16 v[182:183], v25 offset:512
s_waitcnt lgkmcnt(5)
v_mfma_f32_16x16x32_bf16 v[92:95], v[172:175], v[228:231], v[92:95]
ds_read_b128 v[208:211], v31 offset:14336
v_mfma_f32_16x16x32_bf16 v[96:99], v[172:175], v[232:235], v[96:99]
ds_read_b128 v[212:215], v31 offset:22528
v_mfma_f32_16x16x32_bf16 v[100:103], v[172:175], v[236:239], v[100:103]
ds_read_b64_tr_b16 v[184:185], v26 offset:0
ds_read_b64_tr_b16 v[186:187], v26 offset:512
s_waitcnt lgkmcnt(7)
v_mfma_f32_16x16x32_bf16 v[104:107], v[176:179], v[228:231], v[104:107]
s_add_u32 m0, s63, 0x2000
s_nop 0
buffer_load_dwordx4 v21, s[48:51], s74 offen offset:0 lds
buffer_load_dwordx4 v22, s[48:51], s74 offen offset:1024 lds
buffer_load_dwordx4 v23, s[48:51], s74 offen offset:2048 lds
buffer_load_dwordx4 v24, s[48:51], s74 offen offset:3072 lds
v_mfma_f32_16x16x32_bf16 v[108:111], v[176:179], v[232:235], v[108:111]
v_mfma_f32_16x16x32_bf16 v[112:115], v[176:179], v[236:239], v[112:115]
ds_read_b64_tr_b16 v[188:189], v27 offset:0
ds_read_b64_tr_b16 v[190:191], v27 offset:512
s_waitcnt lgkmcnt(6)
v_mfma_f32_16x16x32_bf16 v[68:71], v[180:183], v[204:207], v[68:71]
s_waitcnt lgkmcnt(5)
v_mfma_f32_16x16x32_bf16 v[72:75], v[180:183], v[208:211], v[72:75]
s_waitcnt lgkmcnt(4)
v_mfma_f32_16x16x32_bf16 v[76:79], v[180:183], v[212:215], v[76:79]
ds_read_b64_tr_b16 v[192:193], v28 offset:0
ds_read_b64_tr_b16 v[194:195], v28 offset:512
s_waitcnt lgkmcnt(4)
v_mfma_f32_16x16x32_bf16 v[80:83], v[184:187], v[204:207], v[80:83]
v_mfma_f32_16x16x32_bf16 v[84:87], v[184:187], v[208:211], v[84:87]
v_mfma_f32_16x16x32_bf16 v[88:91], v[184:187], v[212:215], v[88:91]
ds_read_b128 v[216:219], v32 offset:7168
s_waitcnt vmcnt(4)
ds_read_b64_tr_b16 v[196:197], v25 offset:4096
ds_read_b64_tr_b16 v[198:199], v25 offset:4608
s_waitcnt lgkmcnt(5)
v_mfma_f32_16x16x32_bf16 v[92:95], v[188:191], v[204:207], v[92:95]
ds_read_b128 v[220:223], v32 offset:15360
v_mfma_f32_16x16x32_bf16 v[96:99], v[188:191], v[208:211], v[96:99]
ds_read_b128 v[224:227], v32 offset:23552
v_mfma_f32_16x16x32_bf16 v[100:103], v[188:191], v[212:215], v[100:103]
ds_read_b64_tr_b16 v[200:201], v26 offset:4096
ds_read_b64_tr_b16 v[202:203], v26 offset:4608
s_waitcnt lgkmcnt(7)
v_mfma_f32_16x16x32_bf16 v[104:107], v[192:195], v[204:207], v[104:107]
s_add_u32 m0, s63, 0x0
s_nop 0
buffer_load_dwordx4 v21, s[48:51], s75 offen offset:0 lds
buffer_load_dwordx4 v22, s[48:51], s75 offen offset:1024 lds
buffer_load_dwordx4 v23, s[48:51], s75 offen offset:2048 lds
buffer_load_dwordx4 v24, s[48:51], s75 offen offset:3072 lds
v_mfma_f32_16x16x32_bf16 v[108:111], v[192:195], v[208:211], v[108:111]
v_mfma_f32_16x16x32_bf16 v[112:115], v[192:195], v[212:215], v[112:115]
ds_read_b64_tr_b16 v[164:165], v27 offset:4096
ds_read_b64_tr_b16 v[166:167], v27 offset:4608
s_waitcnt lgkmcnt(6)
v_mfma_f32_16x16x32_bf16 v[68:71], v[196:199], v[216:219], v[68:71]
s_waitcnt lgkmcnt(5)
v_mfma_f32_16x16x32_bf16 v[72:75], v[196:199], v[220:223], v[72:75]
s_waitcnt lgkmcnt(4)
v_mfma_f32_16x16x32_bf16 v[76:79], v[196:199], v[224:227], v[76:79]
ds_read_b64_tr_b16 v[168:169], v28 offset:4096
ds_read_b64_tr_b16 v[170:171], v28 offset:4608
s_waitcnt lgkmcnt(4)
v_mfma_f32_16x16x32_bf16 v[80:83], v[200:203], v[216:219], v[80:83]
v_cvt_pk_bf16_f32 v68, v68, v69
v_cvt_pk_bf16_f32 v69, v70, v71
ds_write_b64 v33, v[68:69] offset:0
v_mfma_f32_16x16x32_bf16 v[84:87], v[200:203], v[220:223], v[84:87]
v_cvt_pk_bf16_f32 v72, v72, v73
v_cvt_pk_bf16_f32 v73, v74, v75
ds_write_b64 v33, v[72:73] offset:8192
v_mfma_f32_16x16x32_bf16 v[88:91], v[200:203], v[224:227], v[88:91]
v_cvt_pk_bf16_f32 v76, v76, v77
v_cvt_pk_bf16_f32 v77, v78, v79
ds_write_b64 v33, v[76:77] offset:16384
s_waitcnt lgkmcnt(5)
v_mfma_f32_16x16x32_bf16 v[92:95], v[164:167], v[216:219], v[92:95]
v_cvt_pk_bf16_f32 v80, v80, v81
v_cvt_pk_bf16_f32 v81, v82, v83
ds_write_b64 v33, v[80:81] offset:512
v_mfma_f32_16x16x32_bf16 v[96:99], v[164:167], v[220:223], v[96:99]
v_cvt_pk_bf16_f32 v84, v84, v85
v_cvt_pk_bf16_f32 v85, v86, v87
ds_write_b64 v33, v[84:85] offset:8704
v_mfma_f32_16x16x32_bf16 v[100:103], v[164:167], v[224:227], v[100:103]
v_cvt_pk_bf16_f32 v88, v88, v89
v_cvt_pk_bf16_f32 v89, v90, v91
ds_write_b64 v33, v[88:89] offset:16896
s_waitcnt lgkmcnt(6)
v_mfma_f32_16x16x32_bf16 v[104:107], v[168:171], v[216:219], v[104:107]
v_cvt_pk_bf16_f32 v92, v92, v93
v_cvt_pk_bf16_f32 v93, v94, v95
ds_write_b64 v34, v[92:93] offset:0
s_add_u32 m0, s63, 0x1000
s_nop 0
buffer_load_dwordx4 v21, s[48:51], s76 offen offset:0 lds
buffer_load_dwordx4 v22, s[48:51], s76 offen offset:1024 lds
buffer_load_dwordx4 v23, s[48:51], s76 offen offset:2048 lds
buffer_load_dwordx4 v24, s[48:51], s76 offen offset:3072 lds
v_mfma_f32_16x16x32_bf16 v[108:111], v[168:171], v[220:223], v[108:111]
v_cvt_pk_bf16_f32 v96, v96, v97
v_cvt_pk_bf16_f32 v97, v98, v99
ds_write_b64 v34, v[96:97] offset:8192
v_mfma_f32_16x16x32_bf16 v[112:115], v[168:171], v[224:227], v[112:115]
v_cvt_pk_bf16_f32 v100, v100, v101
v_cvt_pk_bf16_f32 v101, v102, v103
ds_write_b64 v34, v[100:101] offset:16384
v_cvt_pk_bf16_f32 v104, v104, v105
v_cvt_pk_bf16_f32 v105, v106, v107
ds_write_b64 v34, v[104:105] offset:512
v_cvt_pk_bf16_f32 v108, v108, v109
v_cvt_pk_bf16_f32 v109, v110, v111
ds_write_b64 v34, v[108:109] offset:8704
v_cvt_pk_bf16_f32 v112, v112, v113
v_cvt_pk_bf16_f32 v113, v114, v115
ds_write_b64 v34, v[112:113] offset:16896
s_waitcnt vmcnt(8)
ds_read_b128 v[172:175], v29 offset:8192
ds_read_b128 v[176:179], v30 offset:8192
ds_read_b128 v[180:183], v29 offset:10240
s_waitcnt lgkmcnt(3)
s_barrier
ds_read_b128 v[228:231], v35 offset:0
ds_read_b128 v[232:235], v35 offset:8192
ds_read_b128 v[236:239], v35 offset:16384
ds_read_b128 v[204:207], v35 offset:1024
ds_read_b128 v[208:211], v35 offset:9216
ds_read_b128 v[212:215], v35 offset:17408
s_waitcnt lgkmcnt(5)
v_mfma_f32_16x16x32_bf16 v[116:119], v[172:175], v[228:231], 0
s_waitcnt lgkmcnt(4)
v_mfma_f32_16x16x32_bf16 v[132:135], v[172:175], v[232:235], 0
s_waitcnt lgkmcnt(3)
v_mfma_f32_16x16x32_bf16 v[148:151], v[172:175], v[236:239], 0
ds_read_b128 v[184:187], v30 offset:10240
s_waitcnt lgkmcnt(3)
v_mfma_f32_16x16x32_bf16 v[116:119], v[176:179], v[204:207], v[116:119]
s_waitcnt lgkmcnt(2)
v_mfma_f32_16x16x32_bf16 v[132:135], v[176:179], v[208:211], v[132:135]
s_waitcnt lgkmcnt(1)
v_mfma_f32_16x16x32_bf16 v[148:151], v[176:179], v[212:215], v[148:151]
s_waitcnt vmcnt(4)
ds_read_b128 v[188:191], v29 offset:0
v_mfma_f32_16x16x32_bf16 v[120:123], v[180:183], v[228:231], 0
v_mfma_f32_16x16x32_bf16 v[136:139], v[180:183], v[232:235], 0
v_mfma_f32_16x16x32_bf16 v[152:155], v[180:183], v[236:239], 0
ds_read_b128 v[192:195], v30 offset:0
s_waitcnt lgkmcnt(2)
v_mfma_f32_16x16x32_bf16 v[120:123], v[184:187], v[204:207], v[120:123]
s_add_u32 m0, s63, 0x2000
s_nop 0
buffer_load_dwordx4 v21, s[48:51], s77 offen offset:0 lds
buffer_load_dwordx4 v22, s[48:51], s77 offen offset:1024 lds
buffer_load_dwordx4 v23, s[48:51], s77 offen offset:2048 lds
buffer_load_dwordx4 v24, s[48:51], s77 offen offset:3072 lds
v_mfma_f32_16x16x32_bf16 v[136:139], v[184:187], v[208:211], v[136:139]
v_mfma_f32_16x16x32_bf16 v[152:155], v[184:187], v[212:215], v[152:155]
ds_read_b128 v[196:199], v29 offset:2048
s_waitcnt lgkmcnt(2)
v_mfma_f32_16x16x32_bf16 v[124:127], v[188:191], v[228:231], 0
v_mfma_f32_16x16x32_bf16 v[140:143], v[188:191], v[232:235], 0
v_mfma_f32_16x16x32_bf16 v[156:159], v[188:191], v[236:239], 0
ds_read_b128 v[200:203], v30 offset:2048
s_waitcnt lgkmcnt(2)
v_mfma_f32_16x16x32_bf16 v[124:127], v[192:195], v[204:207], v[124:127]
v_mfma_f32_16x16x32_bf16 v[140:143], v[192:195], v[208:211], v[140:143]
v_mfma_f32_16x16x32_bf16 v[156:159], v[192:195], v[212:215], v[156:159]
ds_read_b128 v[216:219], v35 offset:2048
s_waitcnt vmcnt(4)
ds_read_b128 v[164:167], v29 offset:4096
s_waitcnt lgkmcnt(3)
v_mfma_f32_16x16x32_bf16 v[128:131], v[196:199], v[228:231], 0
ds_read_b128 v[220:223], v35 offset:10240
v_mfma_f32_16x16x32_bf16 v[144:147], v[196:199], v[232:235], 0
ds_read_b128 v[224:227], v35 offset:18432
v_mfma_f32_16x16x32_bf16 v[160:163], v[196:199], v[236:239], 0
ds_read_b128 v[228:231], v35 offset:3072
ds_read_b128 v[168:171], v30 offset:4096
s_waitcnt lgkmcnt(6)
v_mfma_f32_16x16x32_bf16 v[128:131], v[200:203], v[204:207], v[128:131]
ds_read_b128 v[232:235], v35 offset:11264
s_add_u32 m0, s63, 0x0
s_nop 0
buffer_load_dwordx4 v21, s[48:51], s78 offen offset:0 lds
buffer_load_dwordx4 v22, s[48:51], s78 offen offset:1024 lds
buffer_load_dwordx4 v23, s[48:51], s78 offen offset:2048 lds
buffer_load_dwordx4 v24, s[48:51], s78 offen offset:3072 lds
v_mfma_f32_16x16x32_bf16 v[144:147], v[200:203], v[208:211], v[144:147]
ds_read_b128 v[236:239], v35 offset:19456
v_mfma_f32_16x16x32_bf16 v[160:163], v[200:203], v[212:215], v[160:163]
ds_read_b128 v[172:175], v29 offset:6144
s_waitcnt lgkmcnt(7)
v_mfma_f32_16x16x32_bf16 v[116:119], v[164:167], v[216:219], v[116:119]
s_waitcnt lgkmcnt(6)
v_mfma_f32_16x16x32_bf16 v[132:135], v[164:167], v[220:223], v[132:135]
s_waitcnt lgkmcnt(5)
v_mfma_f32_16x16x32_bf16 v[148:151], v[164:167], v[224:227], v[148:151]
ds_read_b128 v[176:179], v30 offset:6144
s_waitcnt lgkmcnt(4)
v_mfma_f32_16x16x32_bf16 v[116:119], v[168:171], v[228:231], v[116:119]
s_waitcnt lgkmcnt(3)
v_mfma_f32_16x16x32_bf16 v[132:135], v[168:171], v[232:235], v[132:135]
s_waitcnt lgkmcnt(2)
v_mfma_f32_16x16x32_bf16 v[148:151], v[168:171], v[236:239], v[148:151]
s_waitcnt vmcnt(4)
ds_read_b128 v[180:183], v29 offset:8192
s_waitcnt lgkmcnt(2)
v_mfma_f32_16x16x32_bf16 v[120:123], v[172:175], v[216:219], v[120:123]
v_mfma_f32_16x16x32_bf16 v[136:139], v[172:175], v[220:223], v[136:139]
v_mfma_f32_16x16x32_bf16 v[152:155], v[172:175], v[224:227], v[152:155]
ds_read_b128 v[184:187], v30 offset:8192
s_waitcnt lgkmcnt(2)
v_mfma_f32_16x16x32_bf16 v[120:123], v[176:179], v[228:231], v[120:123]
s_add_u32 m0, s63, 0x1000
s_nop 0
buffer_load_dwordx4 v21, s[48:51], s79 offen offset:0 lds
buffer_load_dwordx4 v22, s[48:51], s79 offen offset:1024 lds
buffer_load_dwordx4 v23, s[48:51], s79 offen offset:2048 lds
buffer_load_dwordx4 v24, s[48:51], s79 offen offset:3072 lds
v_mfma_f32_16x16x32_bf16 v[136:139], v[176:179], v[232:235], v[136:139]
v_mfma_f32_16x16x32_bf16 v[152:155], v[176:179], v[236:239], v[152:155]
ds_read_b128 v[188:191], v29 offset:10240
s_waitcnt lgkmcnt(2)
v_mfma_f32_16x16x32_bf16 v[124:127], v[180:183], v[216:219], v[124:127]
v_mfma_f32_16x16x32_bf16 v[140:143], v[180:183], v[220:223], v[140:143]
v_mfma_f32_16x16x32_bf16 v[156:159], v[180:183], v[224:227], v[156:159]
ds_read_b128 v[192:195], v30 offset:10240
s_waitcnt lgkmcnt(2)
v_mfma_f32_16x16x32_bf16 v[124:127], v[184:187], v[228:231], v[124:127]
v_mfma_f32_16x16x32_bf16 v[140:143], v[184:187], v[232:235], v[140:143]
v_mfma_f32_16x16x32_bf16 v[156:159], v[184:187], v[236:239], v[156:159]
ds_read_b128 v[204:207], v35 offset:4096
s_waitcnt vmcnt(4)
ds_read_b128 v[196:199], v29 offset:0
s_waitcnt lgkmcnt(3)
v_mfma_f32_16x16x32_bf16 v[128:131], v[188:191], v[216:219], v[128:131]
ds_read_b128 v[208:211], v35 offset:12288
v_mfma_f32_16x16x32_bf16 v[144:147], v[188:191], v[220:223], v[144:147]
ds_read_b128 v[212:215], v35 offset:20480
v_mfma_f32_16x16x32_bf16 v[160:163], v[188:191], v[224:227], v[160:163]
ds_read_b128 v[216:219], v35 offset:5120
ds_read_b128 v[200:203], v30 offset:0
s_waitcnt lgkmcnt(6)
v_mfma_f32_16x16x32_bf16 v[128:131], v[192:195], v[228:231], v[128:131]
ds_read_b128 v[220:223], v35 offset:13312
s_add_u32 m0, s63, 0x2000
s_nop 0
buffer_load_dwordx4 v21, s[48:51], s80 offen offset:0 lds
buffer_load_dwordx4 v22, s[48:51], s80 offen offset:1024 lds
buffer_load_dwordx4 v23, s[48:51], s80 offen offset:2048 lds
buffer_load_dwordx4 v24, s[48:51], s80 offen offset:3072 lds
v_mfma_f32_16x16x32_bf16 v[144:147], v[192:195], v[232:235], v[144:147]
ds_read_b128 v[224:227], v35 offset:21504
v_mfma_f32_16x16x32_bf16 v[160:163], v[192:195], v[236:239], v[160:163]
ds_read_b128 v[164:167], v29 offset:2048
s_waitcnt lgkmcnt(7)
v_mfma_f32_16x16x32_bf16 v[116:119], v[196:199], v[204:207], v[116:119]
s_waitcnt lgkmcnt(6)
v_mfma_f32_16x16x32_bf16 v[132:135], v[196:199], v[208:211], v[132:135]
s_waitcnt lgkmcnt(5)
v_mfma_f32_16x16x32_bf16 v[148:151], v[196:199], v[212:215], v[148:151]
ds_read_b128 v[168:171], v30 offset:2048
s_waitcnt lgkmcnt(4)
v_mfma_f32_16x16x32_bf16 v[116:119], v[200:203], v[216:219], v[116:119]
s_waitcnt lgkmcnt(3)
v_mfma_f32_16x16x32_bf16 v[132:135], v[200:203], v[220:223], v[132:135]
s_waitcnt lgkmcnt(2)
v_mfma_f32_16x16x32_bf16 v[148:151], v[200:203], v[224:227], v[148:151]
s_waitcnt vmcnt(4)
ds_read_b128 v[172:175], v29 offset:4096
s_waitcnt lgkmcnt(2)
v_mfma_f32_16x16x32_bf16 v[120:123], v[164:167], v[204:207], v[120:123]
v_mfma_f32_16x16x32_bf16 v[136:139], v[164:167], v[208:211], v[136:139]
v_mfma_f32_16x16x32_bf16 v[152:155], v[164:167], v[212:215], v[152:155]
ds_read_b128 v[176:179], v30 offset:4096
s_waitcnt lgkmcnt(2)
v_mfma_f32_16x16x32_bf16 v[120:123], v[168:171], v[216:219], v[120:123]
s_add_u32 m0, s63, 0x0
s_nop 0
buffer_load_dwordx4 v21, s[48:51], s81 offen offset:0 lds
buffer_load_dwordx4 v22, s[48:51], s81 offen offset:1024 lds
buffer_load_dwordx4 v23, s[48:51], s81 offen offset:2048 lds
buffer_load_dwordx4 v24, s[48:51], s81 offen offset:3072 lds
v_mfma_f32_16x16x32_bf16 v[136:139], v[168:171], v[220:223], v[136:139]
buffer_store_dwordx4 v[44:47], v16, s[56:59], s64 offen offset:0 sc1
buffer_store_dwordx4 v[48:51], v16, s[56:59], s64 offen offset:1024 sc1
v_mfma_f32_16x16x32_bf16 v[152:155], v[168:171], v[224:227], v[152:155]
ds_read_b128 v[180:183], v29 offset:6144
buffer_store_dwordx4 v[52:55], v16, s[56:59], s64 offen offset:2048 sc1
s_waitcnt lgkmcnt(2)
v_mfma_f32_16x16x32_bf16 v[124:127], v[172:175], v[204:207], v[124:127]
buffer_store_dwordx4 v[56:59], v16, s[56:59], s64 offen offset:3072 sc1
buffer_store_dwordx4 v[60:63], v16, s[56:59], s65 offen offset:0 sc1
v_mfma_f32_16x16x32_bf16 v[140:143], v[172:175], v[208:211], v[140:143]
buffer_store_dwordx4 v[64:67], v16, s[56:59], s65 offen offset:1024 sc1
v_mfma_f32_16x16x32_bf16 v[156:159], v[172:175], v[212:215], v[156:159]
ds_read_b128 v[184:187], v30 offset:6144
s_waitcnt lgkmcnt(2)
v_mfma_f32_16x16x32_bf16 v[124:127], v[176:179], v[216:219], v[124:127]
v_mfma_f32_16x16x32_bf16 v[140:143], v[176:179], v[220:223], v[140:143]
v_mfma_f32_16x16x32_bf16 v[156:159], v[176:179], v[224:227], v[156:159]
ds_read_b128 v[228:231], v35 offset:6144
s_waitcnt vmcnt(10)
ds_read_b128 v[188:191], v29 offset:8192
s_waitcnt lgkmcnt(3)
v_mfma_f32_16x16x32_bf16 v[128:131], v[180:183], v[204:207], v[128:131]
ds_read_b128 v[232:235], v35 offset:14336
v_mfma_f32_16x16x32_bf16 v[144:147], v[180:183], v[208:211], v[144:147]
ds_read_b128 v[236:239], v35 offset:22528
v_mfma_f32_16x16x32_bf16 v[160:163], v[180:183], v[212:215], v[160:163]
ds_read_b128 v[204:207], v35 offset:7168
ds_read_b128 v[192:195], v30 offset:8192
s_waitcnt lgkmcnt(6)
v_mfma_f32_16x16x32_bf16 v[128:131], v[184:187], v[216:219], v[128:131]
ds_read_b128 v[208:211], v35 offset:15360
v_mfma_f32_16x16x32_bf16 v[144:147], v[184:187], v[220:223], v[144:147]
ds_read_b128 v[212:215], v35 offset:23552
v_mfma_f32_16x16x32_bf16 v[160:163], v[184:187], v[224:227], v[160:163]
ds_read_b128 v[196:199], v29 offset:10240
s_waitcnt lgkmcnt(7)
v_mfma_f32_16x16x32_bf16 v[116:119], v[188:191], v[228:231], v[116:119]
s_waitcnt lgkmcnt(6)
v_mfma_f32_16x16x32_bf16 v[132:135], v[188:191], v[232:235], v[132:135]
s_waitcnt lgkmcnt(5)
v_mfma_f32_16x16x32_bf16 v[148:151], v[188:191], v[236:239], v[148:151]
ds_read_b128 v[200:203], v30 offset:10240
s_waitcnt lgkmcnt(4)
v_mfma_f32_16x16x32_bf16 v[116:119], v[192:195], v[204:207], v[116:119]
s_waitcnt lgkmcnt(3)
v_mfma_f32_16x16x32_bf16 v[132:135], v[192:195], v[208:211], v[132:135]
s_waitcnt lgkmcnt(2)
v_mfma_f32_16x16x32_bf16 v[148:151], v[192:195], v[212:215], v[148:151]
s_waitcnt vmcnt(6)
ds_read_b128 v[164:167], v29 offset:0
s_waitcnt lgkmcnt(2)
v_mfma_f32_16x16x32_bf16 v[120:123], v[196:199], v[228:231], v[120:123]
v_mfma_f32_16x16x32_bf16 v[136:139], v[196:199], v[232:235], v[136:139]
v_mfma_f32_16x16x32_bf16 v[152:155], v[196:199], v[236:239], v[152:155]
ds_read_b128 v[168:171], v30 offset:0
s_waitcnt lgkmcnt(2)
v_mfma_f32_16x16x32_bf16 v[120:123], v[200:203], v[204:207], v[120:123]
v_mfma_f32_16x16x32_bf16 v[136:139], v[200:203], v[208:211], v[136:139]
v_mfma_f32_16x16x32_bf16 v[152:155], v[200:203], v[212:215], v[152:155]
ds_read_b128 v[172:175], v29 offset:2048
s_waitcnt lgkmcnt(2)
v_mfma_f32_16x16x32_bf16 v[124:127], v[164:167], v[228:231], v[124:127]
v_mul_f32 v116, s86, v116
v_mul_f32 v117, s86, v117
v_mul_f32 v118, s86, v118
v_mul_f32 v119, s86, v119
v_mul_f32 v120, s86, v120
v_mul_f32 v121, s86, v121
v_mul_f32 v122, s86, v122
v_mul_f32 v123, s86, v123
v_cvt_pk_bf16_f32 v116, v116, v117
v_cvt_pk_bf16_f32 v117, v118, v119
v_cvt_pk_bf16_f32 v118, v120, v121
v_cvt_pk_bf16_f32 v119, v122, v123
buffer_store_dwordx4 v[116:119], v16, s[52:55], s82 offen offset:0 sc1
v_mfma_f32_16x16x32_bf16 v[140:143], v[164:167], v[232:235], v[140:143]
v_mul_f32 v132, s86, v132
v_mul_f32 v133, s86, v133
v_mul_f32 v134, s86, v134
v_mul_f32 v135, s86, v135
v_mul_f32 v136, s86, v136
v_mul_f32 v137, s86, v137
v_mul_f32 v138, s86, v138
v_mul_f32 v139, s86, v139
v_cvt_pk_bf16_f32 v132, v132, v133
v_cvt_pk_bf16_f32 v133, v134, v135
v_cvt_pk_bf16_f32 v134, v136, v137
v_cvt_pk_bf16_f32 v135, v138, v139
buffer_store_dwordx4 v[132:135], v16, s[52:55], s83 offen offset:0 sc1
v_mfma_f32_16x16x32_bf16 v[156:159], v[164:167], v[236:239], v[156:159]
ds_read_b128 v[176:179], v30 offset:2048
v_mul_f32 v148, s86, v148
v_mul_f32 v149, s86, v149
v_mul_f32 v150, s86, v150
v_mul_f32 v151, s86, v151
v_mul_f32 v152, s86, v152
v_mul_f32 v153, s86, v153
v_mul_f32 v154, s86, v154
v_mul_f32 v155, s86, v155
v_cvt_pk_bf16_f32 v148, v148, v149
v_cvt_pk_bf16_f32 v149, v150, v151
v_cvt_pk_bf16_f32 v150, v152, v153
v_cvt_pk_bf16_f32 v151, v154, v155
buffer_store_dwordx4 v[148:151], v16, s[52:55], s84 offen offset:0 sc1
s_waitcnt lgkmcnt(2)
v_mfma_f32_16x16x32_bf16 v[124:127], v[168:171], v[204:207], v[124:127]
v_mfma_f32_16x16x32_bf16 v[140:143], v[168:171], v[208:211], v[140:143]
v_mfma_f32_16x16x32_bf16 v[156:159], v[168:171], v[212:215], v[156:159]
s_waitcnt lgkmcnt(1)
v_mfma_f32_16x16x32_bf16 v[128:131], v[172:175], v[228:231], v[128:131]
v_mfma_f32_16x16x32_bf16 v[144:147], v[172:175], v[232:235], v[144:147]
v_mfma_f32_16x16x32_bf16 v[160:163], v[172:175], v[236:239], v[160:163]
s_waitcnt lgkmcnt(0)
v_mfma_f32_16x16x32_bf16 v[128:131], v[176:179], v[204:207], v[128:131]
v_mfma_f32_16x16x32_bf16 v[144:147], v[176:179], v[208:211], v[144:147]
v_mfma_f32_16x16x32_bf16 v[160:163], v[176:179], v[212:215], v[160:163]
v_mul_f32 v124, s86, v124
v_mul_f32 v125, s86, v125
v_mul_f32 v126, s86, v126
v_mul_f32 v127, s86, v127
s_nop 1
v_mul_f32 v128, s86, v128
v_mul_f32 v129, s86, v129
v_mul_f32 v130, s86, v130
v_mul_f32 v131, s86, v131
v_cvt_pk_bf16_f32 v124, v124, v125
v_cvt_pk_bf16_f32 v125, v126, v127
v_cvt_pk_bf16_f32 v126, v128, v129
v_cvt_pk_bf16_f32 v127, v130, v131
buffer_store_dwordx4 v[124:127], v16, s[52:55], s82 offen offset:1024 sc1
v_mul_f32 v140, s86, v140
v_mul_f32 v141, s86, v141
v_mul_f32 v142, s86, v142
v_mul_f32 v143, s86, v143
v_mul_f32 v144, s86, v144
v_mul_f32 v145, s86, v145
v_mul_f32 v146, s86, v146
v_mul_f32 v147, s86, v147
v_cvt_pk_bf16_f32 v140, v140, v141
v_cvt_pk_bf16_f32 v141, v142, v143
v_cvt_pk_bf16_f32 v142, v144, v145
v_cvt_pk_bf16_f32 v143, v146, v147
buffer_store_dwordx4 v[140:143], v16, s[52:55], s83 offen offset:1024 sc1
v_mul_f32 v156, s86, v156
v_mul_f32 v157, s86, v157
v_mul_f32 v158, s86, v158
v_mul_f32 v159, s86, v159
v_mul_f32 v160, s86, v160
v_mul_f32 v161, s86, v161
v_mul_f32 v162, s86, v162
v_mul_f32 v163, s86, v163
v_cvt_pk_bf16_f32 v156, v156, v157
v_cvt_pk_bf16_f32 v157, v158, v159
v_cvt_pk_bf16_f32 v158, v160, v161
v_cvt_pk_bf16_f32 v159, v162, v163
buffer_store_dwordx4 v[156:159], v16, s[52:55], s84 offen offset:1024 sc1
L1_fin:
s_add_u32 s91, s91, 1344
s_waitcnt lgkmcnt(0)
s_add_u32 s98, s98, 0x7f4a7c15
s_addc_u32 s99, s99, 0x9e3779b9
LM_pub:
s_add_u32 s40, s38, 0x7c00000
s_addc_u32 s41, s39, 0
s_mov_b32 s42, 0x40000
s_mov_b32 s43, 0x00020000
s_lshl_b32 s6, s91, 7
s_cmp_eq_u32 s60, 0
s_cselect_b32 s6, s6, 0x70000000
s_waitcnt vmcnt(0) lgkmcnt(0)
s_barrier
v_mov_b32 v6, s98
v_mov_b32 v7, s99
s_mov_b64 exec, 1
buffer_store_dwordx2 v[6:7], off, s[40:43], s6 sc1
s_mov_b64 exec, -1
s_cmp_eq_u32 s61, 0
s_cbranch_scc1 L2_entry
s_mov_b32 s61, 0
s_sub_u32 s4, s91, 1584
s_add_u32 s91, s4, 1600
v_lshlrev_b32 v16, 4, v2
s_mul_i32 s63, s60, 12288
s_and_b32 s6, s4, 3
s_lshl_b32 s6, s6, 6
s_mul_i32 s7, s60, 16
s_add_u32 s6, s6, s7
v_lshrrev_b32 v5, 5, v2
v_and_b32 v6, 31, v2
v_lshlrev_b32 v6, 4, v6
s_cmp_ge_u32 s4, 4
s_cselect_b64 vcc, -1, 0
v_add3_u32 v7, v5, s6, 0
v_and_b32 v8, 0x80, v7
v_bfe_u32 v9, v7, 2, 1
v_lshl_or_b32 v8, v9, 6, v8
v_bfe_u32 v9, v7, 4, 1
v_lshl_or_b32 v8, v9, 5, v8
v_and_b32 v9, 3, v7
v_lshl_or_b32 v8, v9, 3, v8
v_bfe_u32 v9, v7, 5, 2
v_lshl_or_b32 v8, v9, 1, v8
v_bfe_u32 v9, v7, 3, 1
v_or_b32 v8, v9, v8
v_cndmask_b32 v8, v8, v7, vcc
v_lshl_add_u32 v44, v8, 9, v6
v_add3_u32 v7, v5, s6, 2
v_and_b32 v8, 0x80, v7
v_bfe_u32 v9, v7, 2, 1
v_lshl_or_b32 v8, v9, 6, v8
v_bfe_u32 v9, v7, 4, 1
v_lshl_or_b32 v8, v9, 5, v8
v_and_b32 v9, 3, v7
v_lshl_or_b32 v8, v9, 3, v8
v_bfe_u32 v9, v7, 5, 2
v_lshl_or_b32 v8, v9, 1, v8
v_bfe_u32 v9, v7, 3, 1
v_or_b32 v8, v9, v8
v_cndmask_b32 v8, v8, v7, vcc
v_lshl_add_u32 v48, v8, 9, v6
v_add3_u32 v7, v5, s6, 4
v_and_b32 v8, 0x80, v7
v_bfe_u32 v9, v7, 2, 1
v_lshl_or_b32 v8, v9, 6, v8
v_bfe_u32 v9, v7, 4, 1
v_lshl_or_b32 v8, v9, 5, v8
v_and_b32 v9, 3, v7
v_lshl_or_b32 v8, v9, 3, v8
v_bfe_u32 v9, v7, 5, 2
v_lshl_or_b32 v8, v9, 1, v8
v_bfe_u32 v9, v7, 3, 1
v_or_b32 v8, v9, v8
v_cndmask_b32 v8, v8, v7, vcc
v_lshl_add_u32 v52, v8, 9, v6
v_add3_u32 v7, v5, s6, 6
v_and_b32 v8, 0x80, v7
v_bfe_u32 v9, v7, 2, 1
v_lshl_or_b32 v8, v9, 6, v8
v_bfe_u32 v9, v7, 4, 1
v_lshl_or_b32 v8, v9, 5, v8
v_and_b32 v9, 3, v7
v_lshl_or_b32 v8, v9, 3, v8
v_bfe_u32 v9, v7, 5, 2
v_lshl_or_b32 v8, v9, 1, v8
v_bfe_u32 v9, v7, 3, 1
v_or_b32 v8, v9, v8
v_cndmask_b32 v8, v8, v7, vcc
v_lshl_add_u32 v56, v8, 9, v6
v_add3_u32 v7, v5, s6, 8
v_and_b32 v8, 0x80, v7
v_bfe_u32 v9, v7, 2, 1
v_lshl_or_b32 v8, v9, 6, v8
v_bfe_u32 v9, v7, 4, 1
v_lshl_or_b32 v8, v9, 5, v8
v_and_b32 v9, 3, v7
v_lshl_or_b32 v8, v9, 3, v8
v_bfe_u32 v9, v7, 5, 2
v_lshl_or_b32 v8, v9, 1, v8
v_bfe_u32 v9, v7, 3, 1
v_or_b32 v8, v9, v8
v_cndmask_b32 v8, v8, v7, vcc
v_lshl_add_u32 v60, v8, 9, v6
v_add3_u32 v7, v5, s6, 10
v_and_b32 v8, 0x80, v7
v_bfe_u32 v9, v7, 2, 1
v_lshl_or_b32 v8, v9, 6, v8
v_bfe_u32 v9, v7, 4, 1
v_lshl_or_b32 v8, v9, 5, v8
v_and_b32 v9, 3, v7
v_lshl_or_b32 v8, v9, 3, v8
v_bfe_u32 v9, v7, 5, 2
v_lshl_or_b32 v8, v9, 1, v8
v_bfe_u32 v9, v7, 3, 1
v_or_b32 v8, v9, v8
v_cndmask_b32 v8, v8, v7, vcc
v_lshl_add_u32 v64, v8, 9, v6
v_add3_u32 v7, v5, s6, 12
v_and_b32 v8, 0x80, v7
v_bfe_u32 v9, v7, 2, 1
v_lshl_or_b32 v8, v9, 6, v8
v_bfe_u32 v9, v7, 4, 1
v_lshl_or_b32 v8, v9, 5, v8
v_and_b32 v9, 3, v7
v_lshl_or_b32 v8, v9, 3, v8
v_bfe_u32 v9, v7, 5, 2
v_lshl_or_b32 v8, v9, 1, v8
v_bfe_u32 v9, v7, 3, 1
v_or_b32 v8, v9, v8
v_cndmask_b32 v8, v8, v7, vcc
v_lshl_add_u32 v68, v8, 9, v6
v_add3_u32 v7, v5, s6, 14
v_and_b32 v8, 0x80, v7
v_bfe_u32 v9, v7, 2, 1
v_lshl_or_b32 v8, v9, 6, v8
v_bfe_u32 v9, v7, 4, 1
v_lshl_or_b32 v8, v9, 5, v8
v_and_b32 v9, 3, v7
v_lshl_or_b32 v8, v9, 3, v8
v_bfe_u32 v9, v7, 5, 2
v_lshl_or_b32 v8, v9, 1, v8
v_bfe_u32 v9, v7, 3, 1
v_or_b32 v8, v9, v8
v_cndmask_b32 v8, v8, v7, vcc
v_lshl_add_u32 v72, v8, 9, v6
s_lshl_b32 s7, s60, 7
v_lshrrev_b32 v5, 3, v2
v_and_b32 v6, 7, v2
v_and_b32 v7, 2, v5
v_xor_b32 v6, v6, v7
v_lshl_add_u32 v5, v5, 9, s7
v_lshl_add_u32 v17, v6, 4, v5
v_xor_b32 v6, 4, v6
v_lshl_add_u32 v18, v6, 4, v5
v_add_u32 v18, 0xc00, v18
v_add_u32 v19, 0x1800, v17
v_add_u32 v20, 0x1800, v18
s_xor_b32 s6, s62, 0
s_lshl_b32 s66, s6, 14
s_xor_b32 s6, s62, 1
s_lshl_b32 s67, s6, 14
s_xor_b32 s6, s62, 2
s_lshl_b32 s68, s6, 14
s_xor_b32 s6, s62, 3
s_lshl_b32 s69, s6, 14
s_xor_b32 s6, s62, 4
s_lshl_b32 s70, s6, 14
s_xor_b32 s6, s62, 5
s_lshl_b32 s71, s6, 14
s_xor_b32 s6, s62, 6
s_lshl_b32 s72, s6, 14
s_xor_b32 s6, s62, 7
s_lshl_b32 s73, s6, 14
s_waitcnt lgkmcnt(0)
s_cmp_ge_u32 s4, 4
s_cselect_b32 s6, s30, s24
s_cselect_b32 s7, s31, s25
s_add_u32 s40, s6, 0x0
s_addc_u32 s41, s7, 0
s_mov_b32 s42, 0x20000
s_mov_b32 s43, 0x00020000
s_add_u32 s44, s32, 0x0
s_addc_u32 s45, s33, 0
s_mov_b32 s46, 0x20000
s_mov_b32 s47, 0x00020000
buffer_load_dwordx4 v[44:47], v44, s[40:43], 0 offen
buffer_load_dwordx4 v[48:51], v48, s[40:43], 0 offen
buffer_load_dwordx4 v[52:55], v52, s[40:43], 0 offen
buffer_load_dwordx4 v[56:59], v56, s[40:43], 0 offen
buffer_load_dwordx4 v[60:63], v60, s[40:43], 0 offen
buffer_load_dwordx4 v[64:67], v64, s[40:43], 0 offen
buffer_load_dwordx4 v[68:71], v68, s[40:43], 0 offen
buffer_load_dwordx4 v[72:75], v72, s[40:43], 0 offen
s_add_u32 m0, s63, 0x0
s_nop 0
buffer_load_dwordx4 v17, s[44:47], s66 offen offset:0 lds
buffer_load_dwordx4 v18, s[44:47], s66 offen offset:1024 lds
buffer_load_dwordx4 v19, s[44:47], s66 offen offset:2048 lds
buffer_load_dwordx4 v20, s[44:47], s66 offen offset:3072 lds
s_add_u32 m0, s63, 0x1000
s_nop 0
buffer_load_dwordx4 v17, s[44:47], s67 offen offset:0 lds
buffer_load_dwordx4 v18, s[44:47], s67 offen offset:1024 lds
buffer_load_dwordx4 v19, s[44:47], s67 offen offset:2048 lds
buffer_load_dwordx4 v20, s[44:47], s67 offen offset:3072 lds
v_bfe_u32 v5, v2, 2, 3
v_xor_b32 v5, s62, v5
v_and_b32 v6, 3, v2
v_lshlrev_b32 v7, 10, v5
v_lshl_add_u32 v7, v6, 8, v7
v_add_u32 v7, 0xc000, v7
v_and_b32 v5, 1, v5
v_lshl_or_b32 v6, v5, 2, v6
v_lshrrev_b32 v5, 5, v2
s_mul_i32 s6, s60, 16
v_add3_u32 v8, v5, s6, 0
v_lshrrev_b32 v9, 4, v8
v_lshl_add_u32 v9, v9, 13, v7
v_and_b32 v8, 15, v8
v_xor_b32 v8, v8, v6
v_lshl_add_u32 v36, v8, 4, v9
v_add3_u32 v8, v5, s6, 2
v_lshrrev_b32 v9, 4, v8
v_lshl_add_u32 v9, v9, 13, v7
v_and_b32 v8, 15, v8
v_xor_b32 v8, v8, v6
v_lshl_add_u32 v37, v8, 4, v9
v_add3_u32 v8, v5, s6, 4
v_lshrrev_b32 v9, 4, v8
v_lshl_add_u32 v9, v9, 13, v7
v_and_b32 v8, 15, v8
v_xor_b32 v8, v8, v6
v_lshl_add_u32 v38, v8, 4, v9
v_add3_u32 v8, v5, s6, 6
v_lshrrev_b32 v9, 4, v8
v_lshl_add_u32 v9, v9, 13, v7
v_and_b32 v8, 15, v8
v_xor_b32 v8, v8, v6
v_lshl_add_u32 v39, v8, 4, v9
v_add3_u32 v8, v5, s6, 8
v_lshrrev_b32 v9, 4, v8
v_lshl_add_u32 v9, v9, 13, v7
v_and_b32 v8, 15, v8
v_xor_b32 v8, v8, v6
v_lshl_add_u32 v40, v8, 4, v9
v_add3_u32 v8, v5, s6, 10
v_lshrrev_b32 v9, 4, v8
v_lshl_add_u32 v9, v9, 13, v7
v_and_b32 v8, 15, v8
v_xor_b32 v8, v8, v6
v_lshl_add_u32 v41, v8, 4, v9
v_add3_u32 v8, v5, s6, 12
v_lshrrev_b32 v9, 4, v8
v_lshl_add_u32 v9, v9, 13, v7
v_and_b32 v8, 15, v8
v_xor_b32 v8, v8, v6
v_lshl_add_u32 v42, v8, 4, v9
v_add3_u32 v8, v5, s6, 14
v_lshrrev_b32 v9, 4, v8
v_lshl_add_u32 v9, v9, 13, v7
v_and_b32 v8, 15, v8
v_xor_b32 v8, v8, v6
v_lshl_add_u32 v43, v8, 4, v9
v_xor_b32 v5, v3, v4
v_lshlrev_b32 v5, 4, v5
v_lshl_add_u32 v5, v4, 8, v5
v_add_u32 v31, 0xc000, v5
v_xor_b32 v32, 64, v31
v_lshrrev_b32 v5, 2, v3
v_and_b32 v6, 3, v3
v_and_b32 v7, 1, v4
v_lshlrev_b32 v7, 2, v7
v_and_b32 v8, 2, v5
v_or_b32 v7, v7, v8
v_lshl_add_u32 v8, v4, 3, v5
v_lshlrev_b32 v8, 7, v8
v_add_u32 v8, s63, v8
v_xor_b32 v6, v6, v7
v_xor_b32 v9, 0, v6
v_lshl_add_u32 v25, v9, 4, v8
v_add_u32 v26, 8, v25
v_xor_b32 v9, 4, v6
v_lshl_add_u32 v27, v9, 4, v8
v_add_u32 v28, 8, v27
s_lshr_b32 s6, s4, 2
s_lshl_b32 s6, s6, 17
s_and_b32 s7, s4, 3
s_lshl_b32 s7, s7, 12
s_add_u32 s6, s6, s7
s_mul_i32 s7, s60, 32768
s_add_u32 s82, s6, s7
s_add_u32 s83, s82, 16384
s_add_u32 s52, s38, 0x1000000
s_addc_u32 s53, s39, 0
s_mov_b32 s54, 0x40000
s_mov_b32 s55, 0x00020000
s_waitcnt vmcnt(15)
ds_write_b128 v36, v[44:47]
s_waitcnt vmcnt(14)
ds_write_b128 v37, v[48:51]
s_waitcnt vmcnt(13)
ds_write_b128 v38, v[52:55]
s_waitcnt vmcnt(12)
ds_write_b128 v39, v[56:59]
s_waitcnt vmcnt(11)
ds_write_b128 v40, v[60:63]
s_waitcnt vmcnt(10)
ds_write_b128 v41, v[64:67]
s_waitcnt vmcnt(9)
ds_write_b128 v42, v[68:71]
s_waitcnt vmcnt(8)
ds_write_b128 v43, v[72:75]
s_add_u32 m0, s63, 0x2000
s_nop 0
buffer_load_dwordx4 v17, s[44:47], s68 offen offset:0 lds
buffer_load_dwordx4 v18, s[44:47], s68 offen offset:1024 lds
buffer_load_dwordx4 v19, s[44:47], s68 offen offset:2048 lds
buffer_load_dwordx4 v20, s[44:47], s68 offen offset:3072 lds
s_waitcnt vmcnt(8)
ds_read_b64_tr_b16 v[140:141], v25 offset:0
ds_read_b64_tr_b16 v[142:143], v25 offset:512
ds_read_b64_tr_b16 v[144:145], v26 offset:0
ds_read_b64_tr_b16 v[146:147], v26 offset:512
ds_read_b64_tr_b16 v[148:149], v27 offset:0
ds_read_b64_tr_b16 v[150:151], v27 offset:512
s_waitcnt lgkmcnt(6)
s_barrier
ds_read_b128 v[180:183], v31 offset:0
ds_read_b128 v[184:187], v31 offset:8192
ds_read_b128 v[188:191], v31 offset:16384
ds_read_b128 v[192:195], v31 offset:24576
s_waitcnt lgkmcnt(3)
v_mfma_f32_16x16x32_bf16 v[76:79], v[180:183], v[140:143], 0
s_waitcnt lgkmcnt(2)
v_mfma_f32_16x16x32_bf16 v[80:83], v[184:187], v[140:143], 0
s_waitcnt lgkmcnt(1)
v_mfma_f32_16x16x32_bf16 v[84:87], v[188:191], v[140:143], 0
s_waitcnt lgkmcnt(0)
v_mfma_f32_16x16x32_bf16 v[88:91], v[192:195], v[140:143], 0
ds_read_b64_tr_b16 v[152:153], v28 offset:0
ds_read_b64_tr_b16 v[154:155], v28 offset:512
v_mfma_f32_16x16x32_bf16 v[92:95], v[180:183], v[144:147], 0
v_mfma_f32_16x16x32_bf16 v[96:99], v[184:187], v[144:147], 0
v_mfma_f32_16x16x32_bf16 v[100:103], v[188:191], v[144:147], 0
v_mfma_f32_16x16x32_bf16 v[104:107], v[192:195], v[144:147], 0
ds_read_b128 v[196:199], v32 offset:1024
s_waitcnt vmcnt(4)
ds_read_b64_tr_b16 v[156:157], v25 offset:4096
ds_read_b64_tr_b16 v[158:159], v25 offset:4608
v_mfma_f32_16x16x32_bf16 v[108:111], v[180:183], v[148:151], 0
ds_read_b128 v[200:203], v32 offset:9216
v_mfma_f32_16x16x32_bf16 v[112:115], v[184:187], v[148:151], 0
ds_read_b128 v[204:207], v32 offset:17408
v_mfma_f32_16x16x32_bf16 v[116:119], v[188:191], v[148:151], 0
ds_read_b128 v[208:211], v32 offset:25600
v_mfma_f32_16x16x32_bf16 v[120:123], v[192:195], v[148:151], 0
ds_read_b64_tr_b16 v[160:161], v26 offset:4096
ds_read_b64_tr_b16 v[162:163], v26 offset:4608
s_waitcnt lgkmcnt(8)
v_mfma_f32_16x16x32_bf16 v[124:127], v[180:183], v[152:155], 0
s_add_u32 m0, s63, 0x0
s_nop 0
buffer_load_dwordx4 v17, s[44:47], s69 offen offset:0 lds
buffer_load_dwordx4 v18, s[44:47], s69 offen offset:1024 lds
buffer_load_dwordx4 v19, s[44:47], s69 offen offset:2048 lds
buffer_load_dwordx4 v20, s[44:47], s69 offen offset:3072 lds
v_mfma_f32_16x16x32_bf16 v[128:131], v[184:187], v[152:155], 0
v_mfma_f32_16x16x32_bf16 v[132:135], v[188:191], v[152:155], 0
v_mfma_f32_16x16x32_bf16 v[136:139], v[192:195], v[152:155], 0
ds_read_b64_tr_b16 v[164:165], v27 offset:4096
ds_read_b64_tr_b16 v[166:167], v27 offset:4608
s_waitcnt lgkmcnt(7)
v_mfma_f32_16x16x32_bf16 v[76:79], v[196:199], v[156:159], v[76:79]
s_waitcnt lgkmcnt(6)
v_mfma_f32_16x16x32_bf16 v[80:83], v[200:203], v[156:159], v[80:83]
s_waitcnt lgkmcnt(5)
v_mfma_f32_16x16x32_bf16 v[84:87], v[204:207], v[156:159], v[84:87]
s_waitcnt lgkmcnt(4)
v_mfma_f32_16x16x32_bf16 v[88:91], v[208:211], v[156:159], v[88:91]
ds_read_b64_tr_b16 v[168:169], v28 offset:4096
ds_read_b64_tr_b16 v[170:171], v28 offset:4608
s_waitcnt lgkmcnt(4)
v_mfma_f32_16x16x32_bf16 v[92:95], v[196:199], v[160:163], v[92:95]
v_mfma_f32_16x16x32_bf16 v[96:99], v[200:203], v[160:163], v[96:99]
v_mfma_f32_16x16x32_bf16 v[100:103], v[204:207], v[160:163], v[100:103]
v_mfma_f32_16x16x32_bf16 v[104:107], v[208:211], v[160:163], v[104:107]
ds_read_b128 v[212:215], v31 offset:2048
s_waitcnt vmcnt(4)
ds_read_b64_tr_b16 v[172:173], v25 offset:8192
ds_read_b64_tr_b16 v[174:175], v25 offset:8704
s_waitcnt lgkmcnt(5)
v_mfma_f32_16x16x32_bf16 v[108:111], v[196:199], v[164:167], v[108:111]
ds_read_b128 v[216:219], v31 offset:10240
v_mfma_f32_16x16x32_bf16 v[112:115], v[200:203], v[164:167], v[112:115]
ds_read_b128 v[220:223], v31 offset:18432
v_mfma_f32_16x16x32_bf16 v[116:119], v[204:207], v[164:167], v[116:119]
ds_read_b128 v[224:227], v31 offset:26624
v_mfma_f32_16x16x32_bf16 v[120:123], v[208:211], v[164:167], v[120:123]
ds_read_b64_tr_b16 v[176:177], v26 offset:8192
ds_read_b64_tr_b16 v[178:179], v26 offset:8704
s_waitcnt lgkmcnt(8)
v_mfma_f32_16x16x32_bf16 v[124:127], v[196:199], v[168:171], v[124:127]
s_add_u32 m0, s63, 0x1000
s_nop 0
buffer_load_dwordx4 v17, s[44:47], s70 offen offset:0 lds
buffer_load_dwordx4 v18, s[44:47], s70 offen offset:1024 lds
buffer_load_dwordx4 v19, s[44:47], s70 offen offset:2048 lds
buffer_load_dwordx4 v20, s[44:47], s70 offen offset:3072 lds
v_mfma_f32_16x16x32_bf16 v[128:131], v[200:203], v[168:171], v[128:131]
v_mfma_f32_16x16x32_bf16 v[132:135], v[204:207], v[168:171], v[132:135]
v_mfma_f32_16x16x32_bf16 v[136:139], v[208:211], v[168:171], v[136:139]
ds_read_b64_tr_b16 v[140:141], v27 offset:8192
ds_read_b64_tr_b16 v[142:143], v27 offset:8704
s_waitcnt lgkmcnt(7)
v_mfma_f32_16x16x32_bf16 v[76:79], v[212:215], v[172:175], v[76:79]
s_waitcnt lgkmcnt(6)
v_mfma_f32_16x16x32_bf16 v[80:83], v[216:219], v[172:175], v[80:83]
s_waitcnt lgkmcnt(5)
v_mfma_f32_16x16x32_bf16 v[84:87], v[220:223], v[172:175], v[84:87]
s_waitcnt lgkmcnt(4)
v_mfma_f32_16x16x32_bf16 v[88:91], v[224:227], v[172:175], v[88:91]
ds_read_b64_tr_b16 v[144:145], v28 offset:8192
ds_read_b64_tr_b16 v[146:147], v28 offset:8704
s_waitcnt lgkmcnt(4)
v_mfma_f32_16x16x32_bf16 v[92:95], v[212:215], v[176:179], v[92:95]
v_mfma_f32_16x16x32_bf16 v[96:99], v[216:219], v[176:179], v[96:99]
v_mfma_f32_16x16x32_bf16 v[100:103], v[220:223], v[176:179], v[100:103]
v_mfma_f32_16x16x32_bf16 v[104:107], v[224:227], v[176:179], v[104:107]
ds_read_b128 v[180:183], v32 offset:3072
s_waitcnt vmcnt(4)
ds_read_b64_tr_b16 v[148:149], v25 offset:0
ds_read_b64_tr_b16 v[150:151], v25 offset:512
s_waitcnt lgkmcnt(5)
v_mfma_f32_16x16x32_bf16 v[108:111], v[212:215], v[140:143], v[108:111]
ds_read_b128 v[184:187], v32 offset:11264
v_mfma_f32_16x16x32_bf16 v[112:115], v[216:219], v[140:143], v[112:115]
ds_read_b128 v[188:191], v32 offset:19456
v_mfma_f32_16x16x32_bf16 v[116:119], v[220:223], v[140:143], v[116:119]
ds_read_b128 v[192:195], v32 offset:27648
v_mfma_f32_16x16x32_bf16 v[120:123], v[224:227], v[140:143], v[120:123]
ds_read_b64_tr_b16 v[152:153], v26 offset:0
ds_read_b64_tr_b16 v[154:155], v26 offset:512
s_waitcnt lgkmcnt(8)
v_mfma_f32_16x16x32_bf16 v[124:127], v[212:215], v[144:147], v[124:127]
s_add_u32 m0, s63, 0x2000
s_nop 0
buffer_load_dwordx4 v17, s[44:47], s71 offen offset:0 lds
buffer_load_dwordx4 v18, s[44:47], s71 offen offset:1024 lds
buffer_load_dwordx4 v19, s[44:47], s71 offen offset:2048 lds
buffer_load_dwordx4 v20, s[44:47], s71 offen offset:3072 lds
v_mfma_f32_16x16x32_bf16 v[128:131], v[216:219], v[144:147], v[128:131]
v_mfma_f32_16x16x32_bf16 v[132:135], v[220:223], v[144:147], v[132:135]
v_mfma_f32_16x16x32_bf16 v[136:139], v[224:227], v[144:147], v[136:139]
ds_read_b64_tr_b16 v[156:157], v27 offset:0
ds_read_b64_tr_b16 v[158:159], v27 offset:512
s_waitcnt lgkmcnt(7)
v_mfma_f32_16x16x32_bf16 v[76:79], v[180:183], v[148:151], v[76:79]
s_waitcnt lgkmcnt(6)
v_mfma_f32_16x16x32_bf16 v[80:83], v[184:187], v[148:151], v[80:83]
s_waitcnt lgkmcnt(5)
v_mfma_f32_16x16x32_bf16 v[84:87], v[188:191], v[148:151], v[84:87]
s_waitcnt lgkmcnt(4)
v_mfma_f32_16x16x32_bf16 v[88:91], v[192:195], v[148:151], v[88:91]
ds_read_b64_tr_b16 v[160:161], v28 offset:0
ds_read_b64_tr_b16 v[162:163], v28 offset:512
s_waitcnt lgkmcnt(4)
v_mfma_f32_16x16x32_bf16 v[92:95], v[180:183], v[152:155], v[92:95]
v_mfma_f32_16x16x32_bf16 v[96:99], v[184:187], v[152:155], v[96:99]
v_mfma_f32_16x16x32_bf16 v[100:103], v[188:191], v[152:155], v[100:103]
v_mfma_f32_16x16x32_bf16 v[104:107], v[192:195], v[152:155], v[104:107]
ds_read_b128 v[196:199], v31 offset:4096
s_waitcnt vmcnt(4)
ds_read_b64_tr_b16 v[164:165], v25 offset:4096
ds_read_b64_tr_b16 v[166:167], v25 offset:4608
s_waitcnt lgkmcnt(5)
v_mfma_f32_16x16x32_bf16 v[108:111], v[180:183], v[156:159], v[108:111]
ds_read_b128 v[200:203], v31 offset:12288
v_mfma_f32_16x16x32_bf16 v[112:115], v[184:187], v[156:159], v[112:115]
ds_read_b128 v[204:207], v31 offset:20480
v_mfma_f32_16x16x32_bf16 v[116:119], v[188:191], v[156:159], v[116:119]
ds_read_b128 v[208:211], v31 offset:28672
v_mfma_f32_16x16x32_bf16 v[120:123], v[192:195], v[156:159], v[120:123]
ds_read_b64_tr_b16 v[168:169], v26 offset:4096
ds_read_b64_tr_b16 v[170:171], v26 offset:4608
s_waitcnt lgkmcnt(8)
v_mfma_f32_16x16x32_bf16 v[124:127], v[180:183], v[160:163], v[124:127]
s_add_u32 m0, s63, 0x0
s_nop 0
buffer_load_dwordx4 v17, s[44:47], s72 offen offset:0 lds
buffer_load_dwordx4 v18, s[44:47], s72 offen offset:1024 lds
buffer_load_dwordx4 v19, s[44:47], s72 offen offset:2048 lds
buffer_load_dwordx4 v20, s[44:47], s72 offen offset:3072 lds
v_mfma_f32_16x16x32_bf16 v[128:131], v[184:187], v[160:163], v[128:131]
v_mfma_f32_16x16x32_bf16 v[132:135], v[188:191], v[160:163], v[132:135]
v_mfma_f32_16x16x32_bf16 v[136:139], v[192:195], v[160:163], v[136:139]
ds_read_b64_tr_b16 v[172:173], v27 offset:4096
ds_read_b64_tr_b16 v[174:175], v27 offset:4608
s_waitcnt lgkmcnt(7)
v_mfma_f32_16x16x32_bf16 v[76:79], v[196:199], v[164:167], v[76:79]
s_waitcnt lgkmcnt(6)
v_mfma_f32_16x16x32_bf16 v[80:83], v[200:203], v[164:167], v[80:83]
s_waitcnt lgkmcnt(5)
v_mfma_f32_16x16x32_bf16 v[84:87], v[204:207], v[164:167], v[84:87]
s_waitcnt lgkmcnt(4)
v_mfma_f32_16x16x32_bf16 v[88:91], v[208:211], v[164:167], v[88:91]
ds_read_b64_tr_b16 v[176:177], v28 offset:4096
ds_read_b64_tr_b16 v[178:179], v28 offset:4608
s_waitcnt lgkmcnt(4)
v_mfma_f32_16x16x32_bf16 v[92:95], v[196:199], v[168:171], v[92:95]
v_mfma_f32_16x16x32_bf16 v[96:99], v[200:203], v[168:171], v[96:99]
v_mfma_f32_16x16x32_bf16 v[100:103], v[204:207], v[168:171], v[100:103]
v_mfma_f32_16x16x32_bf16 v[104:107], v[208:211], v[168:171], v[104:107]
ds_read_b128 v[212:215], v32 offset:5120
s_waitcnt vmcnt(4)
ds_read_b64_tr_b16 v[140:141], v25 offset:8192
ds_read_b64_tr_b16 v[142:143], v25 offset:8704
s_waitcnt lgkmcnt(5)
v_mfma_f32_16x16x32_bf16 v[108:111], v[196:199], v[172:175], v[108:111]
ds_read_b128 v[216:219], v32 offset:13312
v_mfma_f32_16x16x32_bf16 v[112:115], v[200:203], v[172:175], v[112:115]
ds_read_b128 v[220:223], v32 offset:21504
v_mfma_f32_16x16x32_bf16 v[116:119], v[204:207], v[172:175], v[116:119]
ds_read_b128 v[224:227], v32 offset:29696
v_mfma_f32_16x16x32_bf16 v[120:123], v[208:211], v[172:175], v[120:123]
ds_read_b64_tr_b16 v[144:145], v26 offset:8192
ds_read_b64_tr_b16 v[146:147], v26 offset:8704
s_waitcnt lgkmcnt(8)
v_mfma_f32_16x16x32_bf16 v[124:127], v[196:199], v[176:179], v[124:127]
s_add_u32 m0, s63, 0x1000
s_nop 0
buffer_load_dwordx4 v17, s[44:47], s73 offen offset:0 lds
buffer_load_dwordx4 v18, s[44:47], s73 offen offset:1024 lds
buffer_load_dwordx4 v19, s[44:47], s73 offen offset:2048 lds
buffer_load_dwordx4 v20, s[44:47], s73 offen offset:3072 lds
v_mfma_f32_16x16x32_bf16 v[128:131], v[200:203], v[176:179], v[128:131]
v_mfma_f32_16x16x32_bf16 v[132:135], v[204:207], v[176:179], v[132:135]
v_mfma_f32_16x16x32_bf16 v[136:139], v[208:211], v[176:179], v[136:139]
ds_read_b64_tr_b16 v[148:149], v27 offset:8192
ds_read_b64_tr_b16 v[150:151], v27 offset:8704
s_waitcnt lgkmcnt(7)
v_mfma_f32_16x16x32_bf16 v[76:79], v[212:215], v[140:143], v[76:79]
s_waitcnt lgkmcnt(6)
v_mfma_f32_16x16x32_bf16 v[80:83], v[216:219], v[140:143], v[80:83]
s_waitcnt lgkmcnt(5)
v_mfma_f32_16x16x32_bf16 v[84:87], v[220:223], v[140:143], v[84:87]
s_waitcnt lgkmcnt(4)
v_mfma_f32_16x16x32_bf16 v[88:91], v[224:227], v[140:143], v[88:91]
ds_read_b64_tr_b16 v[152:153], v28 offset:8192
ds_read_b64_tr_b16 v[154:155], v28 offset:8704
s_waitcnt lgkmcnt(4)
v_mfma_f32_16x16x32_bf16 v[92:95], v[212:215], v[144:147], v[92:95]
v_mfma_f32_16x16x32_bf16 v[96:99], v[216:219], v[144:147], v[96:99]
v_mfma_f32_16x16x32_bf16 v[100:103], v[220:223], v[144:147], v[100:103]
v_mfma_f32_16x16x32_bf16 v[104:107], v[224:227], v[144:147], v[104:107]
ds_read_b128 v[180:183], v31 offset:6144
s_waitcnt vmcnt(4)
ds_read_b64_tr_b16 v[156:157], v25 offset:0
ds_read_b64_tr_b16 v[158:159], v25 offset:512
s_waitcnt lgkmcnt(5)
v_mfma_f32_16x16x32_bf16 v[108:111], v[212:215], v[148:151], v[108:111]
ds_read_b128 v[184:187], v31 offset:14336
v_mfma_f32_16x16x32_bf16 v[112:115], v[216:219], v[148:151], v[112:115]
ds_read_b128 v[188:191], v31 offset:22528
v_mfma_f32_16x16x32_bf16 v[116:119], v[220:223], v[148:151], v[116:119]
ds_read_b128 v[192:195], v31 offset:30720
v_mfma_f32_16x16x32_bf16 v[120:123], v[224:227], v[148:151], v[120:123]
ds_read_b64_tr_b16 v[160:161], v26 offset:0
ds_read_b64_tr_b16 v[162:163], v26 offset:512
s_waitcnt lgkmcnt(8)
v_mfma_f32_16x16x32_bf16 v[124:127], v[212:215], v[152:155], v[124:127]
v_mfma_f32_16x16x32_bf16 v[128:131], v[216:219], v[152:155], v[128:131]
v_mfma_f32_16x16x32_bf16 v[132:135], v[220:223], v[152:155], v[132:135]
v_mfma_f32_16x16x32_bf16 v[136:139], v[224:227], v[152:155], v[136:139]
ds_read_b64_tr_b16 v[164:165], v27 offset:0
ds_read_b64_tr_b16 v[166:167], v27 offset:512
s_waitcnt lgkmcnt(7)
v_mfma_f32_16x16x32_bf16 v[76:79], v[180:183], v[156:159], v[76:79]
s_waitcnt lgkmcnt(6)
v_mfma_f32_16x16x32_bf16 v[80:83], v[184:187], v[156:159], v[80:83]
s_waitcnt lgkmcnt(5)
v_mfma_f32_16x16x32_bf16 v[84:87], v[188:191], v[156:159], v[84:87]
s_waitcnt lgkmcnt(4)
v_mfma_f32_16x16x32_bf16 v[88:91], v[192:195], v[156:159], v[88:91]
ds_read_b64_tr_b16 v[168:169], v28 offset:0
ds_read_b64_tr_b16 v[170:171], v28 offset:512
s_waitcnt lgkmcnt(4)
v_mfma_f32_16x16x32_bf16 v[92:95], v[180:183], v[160:163], v[92:95]
v_mfma_f32_16x16x32_bf16 v[96:99], v[184:187], v[160:163], v[96:99]
v_mfma_f32_16x16x32_bf16 v[100:103], v[188:191], v[160:163], v[100:103]
v_mfma_f32_16x16x32_bf16 v[104:107], v[192:195], v[160:163], v[104:107]
ds_read_b128 v[196:199], v32 offset:7168
s_waitcnt vmcnt(0)
ds_read_b64_tr_b16 v[172:173], v25 offset:4096
ds_read_b64_tr_b16 v[174:175], v25 offset:4608
s_waitcnt lgkmcnt(5)
v_mfma_f32_16x16x32_bf16 v[108:111], v[180:183], v[164:167], v[108:111]
ds_read_b128 v[200:203], v32 offset:15360
v_mfma_f32_16x16x32_bf16 v[112:115], v[184:187], v[164:167], v[112:115]
ds_read_b128 v[204:207], v32 offset:23552
v_mfma_f32_16x16x32_bf16 v[116:119], v[188:191], v[164:167], v[116:119]
ds_read_b128 v[208:211], v32 offset:31744
v_mfma_f32_16x16x32_bf16 v[120:123], v[192:195], v[164:167], v[120:123]
ds_read_b64_tr_b16 v[176:177], v26 offset:4096
ds_read_b64_tr_b16 v[178:179], v26 offset:4608
s_waitcnt lgkmcnt(8)
v_mfma_f32_16x16x32_bf16 v[124:127], v[180:183], v[168:171], v[124:127]
v_mfma_f32_16x16x32_bf16 v[128:131], v[184:187], v[168:171], v[128:131]
v_mfma_f32_16x16x32_bf16 v[132:135], v[188:191], v[168:171], v[132:135]
v_mfma_f32_16x16x32_bf16 v[136:139], v[192:195], v[168:171], v[136:139]
ds_read_b64_tr_b16 v[140:141], v27 offset:4096
ds_read_b64_tr_b16 v[142:143], v27 offset:4608
s_waitcnt lgkmcnt(7)
v_mfma_f32_16x16x32_bf16 v[76:79], v[196:199], v[172:175], v[76:79]
s_waitcnt lgkmcnt(6)
v_mfma_f32_16x16x32_bf16 v[80:83], v[200:203], v[172:175], v[80:83]
s_waitcnt lgkmcnt(5)
v_mfma_f32_16x16x32_bf16 v[84:87], v[204:207], v[172:175], v[84:87]
s_waitcnt lgkmcnt(4)
v_mfma_f32_16x16x32_bf16 v[88:91], v[208:211], v[172:175], v[88:91]
ds_read_b64_tr_b16 v[144:145], v28 offset:4096
ds_read_b64_tr_b16 v[146:147], v28 offset:4608
s_waitcnt lgkmcnt(4)
v_mfma_f32_16x16x32_bf16 v[92:95], v[196:199], v[176:179], v[92:95]
v_cvt_pk_bf16_f32 v76, v76, v77
v_cvt_pk_bf16_f32 v77, v78, v79
v_cvt_pk_bf16_f32 v78, v80, v81
v_cvt_pk_bf16_f32 v79, v82, v83
buffer_store_dwordx4 v[76:79], v16, s[52:55], s82 offen offset:0 sc1
v_mfma_f32_16x16x32_bf16 v[96:99], v[200:203], v[176:179], v[96:99]
v_mfma_f32_16x16x32_bf16 v[100:103], v[204:207], v[176:179], v[100:103]
v_cvt_pk_bf16_f32 v84, v84, v85
v_cvt_pk_bf16_f32 v85, v86, v87
v_cvt_pk_bf16_f32 v86, v88, v89
v_cvt_pk_bf16_f32 v87, v90, v91
buffer_store_dwordx4 v[84:87], v16, s[52:55], s82 offen offset:2048 sc1
v_mfma_f32_16x16x32_bf16 v[104:107], v[208:211], v[176:179], v[104:107]
s_waitcnt lgkmcnt(2)
v_mfma_f32_16x16x32_bf16 v[108:111], v[196:199], v[140:143], v[108:111]
v_cvt_pk_bf16_f32 v92, v92, v93
v_cvt_pk_bf16_f32 v93, v94, v95
v_cvt_pk_bf16_f32 v94, v96, v97
v_cvt_pk_bf16_f32 v95, v98, v99
buffer_store_dwordx4 v[92:95], v16, s[52:55], s82 offen offset:1024 sc1
v_mfma_f32_16x16x32_bf16 v[112:115], v[200:203], v[140:143], v[112:115]
v_mfma_f32_16x16x32_bf16 v[116:119], v[204:207], v[140:143], v[116:119]
v_cvt_pk_bf16_f32 v100, v100, v101
v_cvt_pk_bf16_f32 v101, v102, v103
v_cvt_pk_bf16_f32 v102, v104, v105
v_cvt_pk_bf16_f32 v103, v106, v107
buffer_store_dwordx4 v[100:103], v16, s[52:55], s82 offen offset:3072 sc1
v_mfma_f32_16x16x32_bf16 v[120:123], v[208:211], v[140:143], v[120:123]
s_waitcnt lgkmcnt(0)
v_mfma_f32_16x16x32_bf16 v[124:127], v[196:199], v[144:147], v[124:127]
v_cvt_pk_bf16_f32 v108, v108, v109
v_cvt_pk_bf16_f32 v109, v110, v111
v_cvt_pk_bf16_f32 v110, v112, v113
v_cvt_pk_bf16_f32 v111, v114, v115
buffer_store_dwordx4 v[108:111], v16, s[52:55], s83 offen offset:0 sc1
v_mfma_f32_16x16x32_bf16 v[128:131], v[200:203], v[144:147], v[128:131]
v_mfma_f32_16x16x32_bf16 v[132:135], v[204:207], v[144:147], v[132:135]
v_cvt_pk_bf16_f32 v116, v116, v117
v_cvt_pk_bf16_f32 v117, v118, v119
v_cvt_pk_bf16_f32 v118, v120, v121
v_cvt_pk_bf16_f32 v119, v122, v123
buffer_store_dwordx4 v[116:119], v16, s[52:55], s83 offen offset:2048 sc1
v_mfma_f32_16x16x32_bf16 v[136:139], v[208:211], v[144:147], v[136:139]
v_cvt_pk_bf16_f32 v124, v124, v125
v_cvt_pk_bf16_f32 v125, v126, v127
v_cvt_pk_bf16_f32 v126, v128, v129
v_cvt_pk_bf16_f32 v127, v130, v131
buffer_store_dwordx4 v[124:127], v16, s[52:55], s83 offen offset:1024 sc1
v_cvt_pk_bf16_f32 v132, v132, v133
v_cvt_pk_bf16_f32 v133, v134, v135
s_nop 0
v_cvt_pk_bf16_f32 v134, v136, v137
v_cvt_pk_bf16_f32 v135, v138, v139
buffer_store_dwordx4 v[132:135], v16, s[52:55], s83 offen offset:3072 sc1
s_branch LM_pub
LM_light:
s_waitcnt lgkmcnt(0)
s_mov_b32 s98, 0x7c3ff80
s_load_dwordx2 s[98:99], s[38:39], s98
s_branch L1_fin
LM_edge:
s_sub_u32 s4, s3, 30
s_lshl_b32 s8, s8, 1
s_add_u32 s4, s4, s8
s_add_u32 s91, s4, 240
s_cmp_lt_u32 s4, 8
s_cselect_b32 s61, 1, 0
s_and_b32 s6, s5, 7
s_lshl_b32 s6, s6, 14
v_lshlrev_b32 v10, 7, v2
s_waitcnt lgkmcnt(0)
s_add_u32 s40, s26, 0x0
s_addc_u32 s41, s27, 0
s_mov_b32 s42, 0x20000
s_mov_b32 s43, 0x00020000
s_add_u32 s44, s28, 0x0
s_addc_u32 s45, s29, 0
s_mov_b32 s46, 0x20000
s_mov_b32 s47, 0x00020000
s_add_u32 s7, s6, 0
buffer_load_dword v250, v10, s[40:43], s7 offen
s_add_u32 s7, s6, 8192
buffer_load_dword v251, v10, s[40:43], s7 offen
s_add_u32 s7, s6, 0
buffer_load_dword v252, v10, s[44:47], s7 offen
s_add_u32 s7, s6, 8192
buffer_load_dword v253, v10, s[44:47], s7 offen
s_mul_i32 s6, s4, 40000
v_lshlrev_b32 v5, 4, v0
v_lshlrev_b32 v6, 2, v2
v_add_u32 v6, 0x10000, v6
v_mov_b32 v7, 0
ds_write_b32 v6, v7
s_mov_b32 s66, 0
s_mov_b32 s67, 4096
s_mov_b32 s68, 8192
s_mov_b32 s69, 12288
s_mov_b32 s70, 16384
s_mov_b32 s71, 20480
s_mov_b32 s72, 24576
s_mov_b32 s73, 28672
s_mov_b32 s74, 32768
s_mov_b32 s75, 36864
s_waitcnt lgkmcnt(0)
s_add_u32 s40, s20, 0x0
s_addc_u32 s41, s21, 0
s_add_u32 s40, s40, s6
s_addc_u32 s41, s41, 0
s_mov_b32 s42, 0x9c40
s_mov_b32 s43, 0x00020000
s_add_u32 s44, s18, 0x0
s_addc_u32 s45, s19, 0
s_add_u32 s44, s44, s6
s_addc_u32 s45, s45, 0
s_mov_b32 s46, 0x9c40
s_mov_b32 s47, 0x00020000
buffer_load_dwordx4 v[16:19], v5, s[40:43], s66 offen
buffer_load_dwordx4 v[20:23], v5, s[40:43], s67 offen
buffer_load_dwordx4 v[24:27], v5, s[40:43], s68 offen
buffer_load_dwordx4 v[28:31], v5, s[40:43], s69 offen
buffer_load_dwordx4 v[32:35], v5, s[40:43], s70 offen
buffer_load_dwordx4 v[36:39], v5, s[40:43], s71 offen
buffer_load_dwordx4 v[40:43], v5, s[40:43], s72 offen
buffer_load_dwordx4 v[44:47], v5, s[40:43], s73 offen
buffer_load_dwordx4 v[48:51], v5, s[40:43], s74 offen
buffer_load_dwordx4 v[52:55], v5, s[40:43], s75 offen
buffer_load_dwordx4 v[56:59], v5, s[44:47], s66 offen
buffer_load_dwordx4 v[60:63], v5, s[44:47], s67 offen
buffer_load_dwordx4 v[64:67], v5, s[44:47], s68 offen
buffer_load_dwordx4 v[68:71], v5, s[44:47], s69 offen
buffer_load_dwordx4 v[72:75], v5, s[44:47], s70 offen
buffer_load_dwordx4 v[76:79], v5, s[44:47], s71 offen
buffer_load_dwordx4 v[80:83], v5, s[44:47], s72 offen
buffer_load_dwordx4 v[84:87], v5, s[44:47], s73 offen
buffer_load_dwordx4 v[88:91], v5, s[44:47], s74 offen
buffer_load_dwordx4 v[92:95], v5, s[44:47], s75 offen
s_mov_b32 s98, 0x7c3ff80
s_load_dwordx2 s[98:99], s[38:39], s98
s_add_u32 s48, s38, 0x8000000
s_addc_u32 s49, s39, 0
s_mov_b32 s50, 0x2800000
s_mov_b32 s51, 0x00020000
s_add_u32 s52, s38, 0x7800000
s_addc_u32 s53, s39, 0
s_mov_b32 s54, 0x1000
s_mov_b32 s55, 0x00020000
v_mov_b32 v240, 6809
v_mov_b32 v241, 0x0
v_mov_b32 v242, 6205
v_mov_b32 v243, 0x220f50
v_mov_b32 v244, 7437
v_mov_b32 v245, 0xff904e58
s_mov_b32 s11, 0x10000
v_mov_b32 v7, 1
v_cmp_gt_u32 vcc, 0xc4, v0
s_mov_b64 s[12:13], vcc
s_barrier
s_waitcnt vmcnt(19)
v_cmp_le_u32 vcc, 3696, v16
s_nop 1
v_cndmask_b32 v96, v240, v242, vcc
v_cndmask_b32 v136, v241, v243, vcc
v_cmp_le_u32 vcc, 7752, v16
s_nop 1
v_cndmask_b32 v96, v96, v244, vcc
v_cndmask_b32 v136, v136, v245, vcc
v_mad_u32_u24 v96, v96, v16, v136
v_lshrrev_b32 v96, 20, v96
v_lshl_add_u32 v136, v96, 2, s11
ds_add_rtn_u32 v136, v136, v7
v_cmp_le_u32 vcc, 3696, v17
s_nop 1
v_cndmask_b32 v97, v240, v242, vcc
v_cndmask_b32 v137, v241, v243, vcc
v_cmp_le_u32 vcc, 7752, v17
s_nop 1
v_cndmask_b32 v97, v97, v244, vcc
v_cndmask_b32 v137, v137, v245, vcc
v_mad_u32_u24 v97, v97, v17, v137
v_lshrrev_b32 v97, 20, v97
v_lshl_add_u32 v137, v97, 2, s11
ds_add_rtn_u32 v137, v137, v7
v_cmp_le_u32 vcc, 3696, v18
s_nop 1
v_cndmask_b32 v98, v240, v242, vcc
v_cndmask_b32 v138, v241, v243, vcc
v_cmp_le_u32 vcc, 7752, v18
s_nop 1
v_cndmask_b32 v98, v98, v244, vcc
v_cndmask_b32 v138, v138, v245, vcc
v_mad_u32_u24 v98, v98, v18, v138
v_lshrrev_b32 v98, 20, v98
v_lshl_add_u32 v138, v98, 2, s11
ds_add_rtn_u32 v138, v138, v7
v_cmp_le_u32 vcc, 3696, v19
s_nop 1
v_cndmask_b32 v99, v240, v242, vcc
v_cndmask_b32 v139, v241, v243, vcc
v_cmp_le_u32 vcc, 7752, v19
s_nop 1
v_cndmask_b32 v99, v99, v244, vcc
v_cndmask_b32 v139, v139, v245, vcc
v_mad_u32_u24 v99, v99, v19, v139
v_lshrrev_b32 v99, 20, v99
v_lshl_add_u32 v139, v99, 2, s11
ds_add_rtn_u32 v139, v139, v7
s_waitcnt vmcnt(18)
v_cmp_le_u32 vcc, 3696, v20
s_nop 1
v_cndmask_b32 v100, v240, v242, vcc
v_cndmask_b32 v140, v241, v243, vcc
v_cmp_le_u32 vcc, 7752, v20
s_nop 1
v_cndmask_b32 v100, v100, v244, vcc
v_cndmask_b32 v140, v140, v245, vcc
v_mad_u32_u24 v100, v100, v20, v140
v_lshrrev_b32 v100, 20, v100
v_lshl_add_u32 v140, v100, 2, s11
ds_add_rtn_u32 v140, v140, v7
v_cmp_le_u32 vcc, 3696, v21
s_nop 1
v_cndmask_b32 v101, v240, v242, vcc
v_cndmask_b32 v141, v241, v243, vcc
v_cmp_le_u32 vcc, 7752, v21
s_nop 1
v_cndmask_b32 v101, v101, v244, vcc
v_cndmask_b32 v141, v141, v245, vcc
v_mad_u32_u24 v101, v101, v21, v141
v_lshrrev_b32 v101, 20, v101
v_lshl_add_u32 v141, v101, 2, s11
ds_add_rtn_u32 v141, v141, v7
v_cmp_le_u32 vcc, 3696, v22
s_nop 1
v_cndmask_b32 v102, v240, v242, vcc
v_cndmask_b32 v142, v241, v243, vcc
v_cmp_le_u32 vcc, 7752, v22
s_nop 1
v_cndmask_b32 v102, v102, v244, vcc
v_cndmask_b32 v142, v142, v245, vcc
v_mad_u32_u24 v102, v102, v22, v142
v_lshrrev_b32 v102, 20, v102
v_lshl_add_u32 v142, v102, 2, s11
ds_add_rtn_u32 v142, v142, v7
v_cmp_le_u32 vcc, 3696, v23
s_nop 1
v_cndmask_b32 v103, v240, v242, vcc
v_cndmask_b32 v143, v241, v243, vcc
v_cmp_le_u32 vcc, 7752, v23
s_nop 1
v_cndmask_b32 v103, v103, v244, vcc
v_cndmask_b32 v143, v143, v245, vcc
v_mad_u32_u24 v103, v103, v23, v143
v_lshrrev_b32 v103, 20, v103
v_lshl_add_u32 v143, v103, 2, s11
ds_add_rtn_u32 v143, v143, v7
s_waitcnt vmcnt(17)
v_cmp_le_u32 vcc, 3696, v24
s_nop 1
v_cndmask_b32 v104, v240, v242, vcc
v_cndmask_b32 v144, v241, v243, vcc
v_cmp_le_u32 vcc, 7752, v24
s_nop 1
v_cndmask_b32 v104, v104, v244, vcc
v_cndmask_b32 v144, v144, v245, vcc
v_mad_u32_u24 v104, v104, v24, v144
v_lshrrev_b32 v104, 20, v104
v_lshl_add_u32 v144, v104, 2, s11
ds_add_rtn_u32 v144, v144, v7
v_cmp_le_u32 vcc, 3696, v25
s_nop 1
v_cndmask_b32 v105, v240, v242, vcc
v_cndmask_b32 v145, v241, v243, vcc
v_cmp_le_u32 vcc, 7752, v25
s_nop 1
v_cndmask_b32 v105, v105, v244, vcc
v_cndmask_b32 v145, v145, v245, vcc
v_mad_u32_u24 v105, v105, v25, v145
v_lshrrev_b32 v105, 20, v105
v_lshl_add_u32 v145, v105, 2, s11
ds_add_rtn_u32 v145, v145, v7
v_cmp_le_u32 vcc, 3696, v26
s_nop 1
v_cndmask_b32 v106, v240, v242, vcc
v_cndmask_b32 v146, v241, v243, vcc
v_cmp_le_u32 vcc, 7752, v26
s_nop 1
v_cndmask_b32 v106, v106, v244, vcc
v_cndmask_b32 v146, v146, v245, vcc
v_mad_u32_u24 v106, v106, v26, v146
v_lshrrev_b32 v106, 20, v106
v_lshl_add_u32 v146, v106, 2, s11
ds_add_rtn_u32 v146, v146, v7
v_cmp_le_u32 vcc, 3696, v27
s_nop 1
v_cndmask_b32 v107, v240, v242, vcc
v_cndmask_b32 v147, v241, v243, vcc
v_cmp_le_u32 vcc, 7752, v27
s_nop 1
v_cndmask_b32 v107, v107, v244, vcc
v_cndmask_b32 v147, v147, v245, vcc
v_mad_u32_u24 v107, v107, v27, v147
v_lshrrev_b32 v107, 20, v107
v_lshl_add_u32 v147, v107, 2, s11
ds_add_rtn_u32 v147, v147, v7
s_waitcnt vmcnt(16)
v_cmp_le_u32 vcc, 3696, v28
s_nop 1
v_cndmask_b32 v108, v240, v242, vcc
v_cndmask_b32 v148, v241, v243, vcc
v_cmp_le_u32 vcc, 7752, v28
s_nop 1
v_cndmask_b32 v108, v108, v244, vcc
v_cndmask_b32 v148, v148, v245, vcc
v_mad_u32_u24 v108, v108, v28, v148
v_lshrrev_b32 v108, 20, v108
v_lshl_add_u32 v148, v108, 2, s11
ds_add_rtn_u32 v148, v148, v7
v_cmp_le_u32 vcc, 3696, v29
s_nop 1
v_cndmask_b32 v109, v240, v242, vcc
v_cndmask_b32 v149, v241, v243, vcc
v_cmp_le_u32 vcc, 7752, v29
s_nop 1
v_cndmask_b32 v109, v109, v244, vcc
v_cndmask_b32 v149, v149, v245, vcc
v_mad_u32_u24 v109, v109, v29, v149
v_lshrrev_b32 v109, 20, v109
v_lshl_add_u32 v149, v109, 2, s11
ds_add_rtn_u32 v149, v149, v7
v_cmp_le_u32 vcc, 3696, v30
s_nop 1
v_cndmask_b32 v110, v240, v242, vcc
v_cndmask_b32 v150, v241, v243, vcc
v_cmp_le_u32 vcc, 7752, v30
s_nop 1
v_cndmask_b32 v110, v110, v244, vcc
v_cndmask_b32 v150, v150, v245, vcc
v_mad_u32_u24 v110, v110, v30, v150
v_lshrrev_b32 v110, 20, v110
v_lshl_add_u32 v150, v110, 2, s11
ds_add_rtn_u32 v150, v150, v7
v_cmp_le_u32 vcc, 3696, v31
s_nop 1
v_cndmask_b32 v111, v240, v242, vcc
v_cndmask_b32 v151, v241, v243, vcc
v_cmp_le_u32 vcc, 7752, v31
s_nop 1
v_cndmask_b32 v111, v111, v244, vcc
v_cndmask_b32 v151, v151, v245, vcc
v_mad_u32_u24 v111, v111, v31, v151
v_lshrrev_b32 v111, 20, v111
v_lshl_add_u32 v151, v111, 2, s11
ds_add_rtn_u32 v151, v151, v7
s_waitcnt vmcnt(15)
v_cmp_le_u32 vcc, 3696, v32
s_nop 1
v_cndmask_b32 v112, v240, v242, vcc
v_cndmask_b32 v152, v241, v243, vcc
v_cmp_le_u32 vcc, 7752, v32
s_nop 1
v_cndmask_b32 v112, v112, v244, vcc
v_cndmask_b32 v152, v152, v245, vcc
v_mad_u32_u24 v112, v112, v32, v152
v_lshrrev_b32 v112, 20, v112
v_lshl_add_u32 v152, v112, 2, s11
ds_add_rtn_u32 v152, v152, v7
v_cmp_le_u32 vcc, 3696, v33
s_nop 1
v_cndmask_b32 v113, v240, v242, vcc
v_cndmask_b32 v153, v241, v243, vcc
v_cmp_le_u32 vcc, 7752, v33
s_nop 1
v_cndmask_b32 v113, v113, v244, vcc
v_cndmask_b32 v153, v153, v245, vcc
v_mad_u32_u24 v113, v113, v33, v153
v_lshrrev_b32 v113, 20, v113
v_lshl_add_u32 v153, v113, 2, s11
ds_add_rtn_u32 v153, v153, v7
v_cmp_le_u32 vcc, 3696, v34
s_nop 1
v_cndmask_b32 v114, v240, v242, vcc
v_cndmask_b32 v154, v241, v243, vcc
v_cmp_le_u32 vcc, 7752, v34
s_nop 1
v_cndmask_b32 v114, v114, v244, vcc
v_cndmask_b32 v154, v154, v245, vcc
v_mad_u32_u24 v114, v114, v34, v154
v_lshrrev_b32 v114, 20, v114
v_lshl_add_u32 v154, v114, 2, s11
ds_add_rtn_u32 v154, v154, v7
v_cmp_le_u32 vcc, 3696, v35
s_nop 1
v_cndmask_b32 v115, v240, v242, vcc
v_cndmask_b32 v155, v241, v243, vcc
v_cmp_le_u32 vcc, 7752, v35
s_nop 1
v_cndmask_b32 v115, v115, v244, vcc
v_cndmask_b32 v155, v155, v245, vcc
v_mad_u32_u24 v115, v115, v35, v155
v_lshrrev_b32 v115, 20, v115
v_lshl_add_u32 v155, v115, 2, s11
ds_add_rtn_u32 v155, v155, v7
s_waitcnt vmcnt(14)
v_cmp_le_u32 vcc, 3696, v36
s_nop 1
v_cndmask_b32 v116, v240, v242, vcc
v_cndmask_b32 v156, v241, v243, vcc
v_cmp_le_u32 vcc, 7752, v36
s_nop 1
v_cndmask_b32 v116, v116, v244, vcc
v_cndmask_b32 v156, v156, v245, vcc
v_mad_u32_u24 v116, v116, v36, v156
v_lshrrev_b32 v116, 20, v116
v_lshl_add_u32 v156, v116, 2, s11
ds_add_rtn_u32 v156, v156, v7
v_cmp_le_u32 vcc, 3696, v37
s_nop 1
v_cndmask_b32 v117, v240, v242, vcc
v_cndmask_b32 v157, v241, v243, vcc
v_cmp_le_u32 vcc, 7752, v37
s_nop 1
v_cndmask_b32 v117, v117, v244, vcc
v_cndmask_b32 v157, v157, v245, vcc
v_mad_u32_u24 v117, v117, v37, v157
v_lshrrev_b32 v117, 20, v117
v_lshl_add_u32 v157, v117, 2, s11
ds_add_rtn_u32 v157, v157, v7
v_cmp_le_u32 vcc, 3696, v38
s_nop 1
v_cndmask_b32 v118, v240, v242, vcc
v_cndmask_b32 v158, v241, v243, vcc
v_cmp_le_u32 vcc, 7752, v38
s_nop 1
v_cndmask_b32 v118, v118, v244, vcc
v_cndmask_b32 v158, v158, v245, vcc
v_mad_u32_u24 v118, v118, v38, v158
v_lshrrev_b32 v118, 20, v118
v_lshl_add_u32 v158, v118, 2, s11
ds_add_rtn_u32 v158, v158, v7
v_cmp_le_u32 vcc, 3696, v39
s_nop 1
v_cndmask_b32 v119, v240, v242, vcc
v_cndmask_b32 v159, v241, v243, vcc
v_cmp_le_u32 vcc, 7752, v39
s_nop 1
v_cndmask_b32 v119, v119, v244, vcc
v_cndmask_b32 v159, v159, v245, vcc
v_mad_u32_u24 v119, v119, v39, v159
v_lshrrev_b32 v119, 20, v119
v_lshl_add_u32 v159, v119, 2, s11
ds_add_rtn_u32 v159, v159, v7
s_waitcnt vmcnt(13)
v_cmp_le_u32 vcc, 3696, v40
s_nop 1
v_cndmask_b32 v120, v240, v242, vcc
v_cndmask_b32 v160, v241, v243, vcc
v_cmp_le_u32 vcc, 7752, v40
s_nop 1
v_cndmask_b32 v120, v120, v244, vcc
v_cndmask_b32 v160, v160, v245, vcc
v_mad_u32_u24 v120, v120, v40, v160
v_lshrrev_b32 v120, 20, v120
v_lshl_add_u32 v160, v120, 2, s11
ds_add_rtn_u32 v160, v160, v7
v_cmp_le_u32 vcc, 3696, v41
s_nop 1
v_cndmask_b32 v121, v240, v242, vcc
v_cndmask_b32 v161, v241, v243, vcc
v_cmp_le_u32 vcc, 7752, v41
s_nop 1
v_cndmask_b32 v121, v121, v244, vcc
v_cndmask_b32 v161, v161, v245, vcc
v_mad_u32_u24 v121, v121, v41, v161
v_lshrrev_b32 v121, 20, v121
v_lshl_add_u32 v161, v121, 2, s11
ds_add_rtn_u32 v161, v161, v7
v_cmp_le_u32 vcc, 3696, v42
s_nop 1
v_cndmask_b32 v122, v240, v242, vcc
v_cndmask_b32 v162, v241, v243, vcc
v_cmp_le_u32 vcc, 7752, v42
s_nop 1
v_cndmask_b32 v122, v122, v244, vcc
v_cndmask_b32 v162, v162, v245, vcc
v_mad_u32_u24 v122, v122, v42, v162
v_lshrrev_b32 v122, 20, v122
v_lshl_add_u32 v162, v122, 2, s11
ds_add_rtn_u32 v162, v162, v7
v_cmp_le_u32 vcc, 3696, v43
s_nop 1
v_cndmask_b32 v123, v240, v242, vcc
v_cndmask_b32 v163, v241, v243, vcc
v_cmp_le_u32 vcc, 7752, v43
s_nop 1
v_cndmask_b32 v123, v123, v244, vcc
v_cndmask_b32 v163, v163, v245, vcc
v_mad_u32_u24 v123, v123, v43, v163
v_lshrrev_b32 v123, 20, v123
v_lshl_add_u32 v163, v123, 2, s11
ds_add_rtn_u32 v163, v163, v7
s_waitcnt vmcnt(12)
v_cmp_le_u32 vcc, 3696, v44
s_nop 1
v_cndmask_b32 v124, v240, v242, vcc
v_cndmask_b32 v164, v241, v243, vcc
v_cmp_le_u32 vcc, 7752, v44
s_nop 1
v_cndmask_b32 v124, v124, v244, vcc
v_cndmask_b32 v164, v164, v245, vcc
v_mad_u32_u24 v124, v124, v44, v164
v_lshrrev_b32 v124, 20, v124
v_lshl_add_u32 v164, v124, 2, s11
ds_add_rtn_u32 v164, v164, v7
v_cmp_le_u32 vcc, 3696, v45
s_nop 1
v_cndmask_b32 v125, v240, v242, vcc
v_cndmask_b32 v165, v241, v243, vcc
v_cmp_le_u32 vcc, 7752, v45
s_nop 1
v_cndmask_b32 v125, v125, v244, vcc
v_cndmask_b32 v165, v165, v245, vcc
v_mad_u32_u24 v125, v125, v45, v165
v_lshrrev_b32 v125, 20, v125
v_lshl_add_u32 v165, v125, 2, s11
ds_add_rtn_u32 v165, v165, v7
v_cmp_le_u32 vcc, 3696, v46
s_nop 1
v_cndmask_b32 v126, v240, v242, vcc
v_cndmask_b32 v166, v241, v243, vcc
v_cmp_le_u32 vcc, 7752, v46
s_nop 1
v_cndmask_b32 v126, v126, v244, vcc
v_cndmask_b32 v166, v166, v245, vcc
v_mad_u32_u24 v126, v126, v46, v166
v_lshrrev_b32 v126, 20, v126
v_lshl_add_u32 v166, v126, 2, s11
ds_add_rtn_u32 v166, v166, v7
v_cmp_le_u32 vcc, 3696, v47
s_nop 1
v_cndmask_b32 v127, v240, v242, vcc
v_cndmask_b32 v167, v241, v243, vcc
v_cmp_le_u32 vcc, 7752, v47
s_nop 1
v_cndmask_b32 v127, v127, v244, vcc
v_cndmask_b32 v167, v167, v245, vcc
v_mad_u32_u24 v127, v127, v47, v167
v_lshrrev_b32 v127, 20, v127
v_lshl_add_u32 v167, v127, 2, s11
ds_add_rtn_u32 v167, v167, v7
s_waitcnt vmcnt(11)
v_cmp_le_u32 vcc, 3696, v48
s_nop 1
v_cndmask_b32 v128, v240, v242, vcc
v_cndmask_b32 v168, v241, v243, vcc
v_cmp_le_u32 vcc, 7752, v48
s_nop 1
v_cndmask_b32 v128, v128, v244, vcc
v_cndmask_b32 v168, v168, v245, vcc
v_mad_u32_u24 v128, v128, v48, v168
v_lshrrev_b32 v128, 20, v128
v_lshl_add_u32 v168, v128, 2, s11
ds_add_rtn_u32 v168, v168, v7
v_cmp_le_u32 vcc, 3696, v49
s_nop 1
v_cndmask_b32 v129, v240, v242, vcc
v_cndmask_b32 v169, v241, v243, vcc
v_cmp_le_u32 vcc, 7752, v49
s_nop 1
v_cndmask_b32 v129, v129, v244, vcc
v_cndmask_b32 v169, v169, v245, vcc
v_mad_u32_u24 v129, v129, v49, v169
v_lshrrev_b32 v129, 20, v129
v_lshl_add_u32 v169, v129, 2, s11
ds_add_rtn_u32 v169, v169, v7
v_cmp_le_u32 vcc, 3696, v50
s_nop 1
v_cndmask_b32 v130, v240, v242, vcc
v_cndmask_b32 v170, v241, v243, vcc
v_cmp_le_u32 vcc, 7752, v50
s_nop 1
v_cndmask_b32 v130, v130, v244, vcc
v_cndmask_b32 v170, v170, v245, vcc
v_mad_u32_u24 v130, v130, v50, v170
v_lshrrev_b32 v130, 20, v130
v_lshl_add_u32 v170, v130, 2, s11
ds_add_rtn_u32 v170, v170, v7
v_cmp_le_u32 vcc, 3696, v51
s_nop 1
v_cndmask_b32 v131, v240, v242, vcc
v_cndmask_b32 v171, v241, v243, vcc
v_cmp_le_u32 vcc, 7752, v51
s_nop 1
v_cndmask_b32 v131, v131, v244, vcc
v_cndmask_b32 v171, v171, v245, vcc
v_mad_u32_u24 v131, v131, v51, v171
v_lshrrev_b32 v131, 20, v131
v_lshl_add_u32 v171, v131, 2, s11
ds_add_rtn_u32 v171, v171, v7
s_waitcnt vmcnt(10)
s_mov_b64 exec, s[12:13]
v_cmp_le_u32 vcc, 3696, v52
s_nop 1
v_cndmask_b32 v132, v240, v242, vcc
v_cndmask_b32 v172, v241, v243, vcc
v_cmp_le_u32 vcc, 7752, v52
s_nop 1
v_cndmask_b32 v132, v132, v244, vcc
v_cndmask_b32 v172, v172, v245, vcc
v_mad_u32_u24 v132, v132, v52, v172
v_lshrrev_b32 v132, 20, v132
v_lshl_add_u32 v172, v132, 2, s11
ds_add_rtn_u32 v172, v172, v7
v_cmp_le_u32 vcc, 3696, v53
s_nop 1
v_cndmask_b32 v133, v240, v242, vcc
v_cndmask_b32 v173, v241, v243, vcc
v_cmp_le_u32 vcc, 7752, v53
s_nop 1
v_cndmask_b32 v133, v133, v244, vcc
v_cndmask_b32 v173, v173, v245, vcc
v_mad_u32_u24 v133, v133, v53, v173
v_lshrrev_b32 v133, 20, v133
v_lshl_add_u32 v173, v133, 2, s11
ds_add_rtn_u32 v173, v173, v7
v_cmp_le_u32 vcc, 3696, v54
s_nop 1
v_cndmask_b32 v134, v240, v242, vcc
v_cndmask_b32 v174, v241, v243, vcc
v_cmp_le_u32 vcc, 7752, v54
s_nop 1
v_cndmask_b32 v134, v134, v244, vcc
v_cndmask_b32 v174, v174, v245, vcc
v_mad_u32_u24 v134, v134, v54, v174
v_lshrrev_b32 v134, 20, v134
v_lshl_add_u32 v174, v134, 2, s11
ds_add_rtn_u32 v174, v174, v7
v_cmp_le_u32 vcc, 3696, v55
s_nop 1
v_cndmask_b32 v135, v240, v242, vcc
v_cndmask_b32 v175, v241, v243, vcc
v_cmp_le_u32 vcc, 7752, v55
s_nop 1
v_cndmask_b32 v135, v135, v244, vcc
v_cndmask_b32 v175, v175, v245, vcc
v_mad_u32_u24 v135, v135, v55, v175
v_lshrrev_b32 v135, 20, v135
v_lshl_add_u32 v175, v135, 2, s11
ds_add_rtn_u32 v175, v175, v7
s_mov_b64 exec, -1
s_waitcnt vmcnt(9) lgkmcnt(15)
v_and_b32 v8, 0xff, v136
v_lshl_or_b32 v56, v16, 18, v56
v_lshlrev_b32 v8, 2, v8
v_lshl_add_u32 v8, v96, 10, v8
ds_write_b32 v8, v56
v_and_b32 v8, 0xff, v137
v_lshl_or_b32 v57, v17, 18, v57
v_lshlrev_b32 v8, 2, v8
v_lshl_add_u32 v8, v97, 10, v8
ds_write_b32 v8, v57
v_and_b32 v8, 0xff, v138
v_lshl_or_b32 v58, v18, 18, v58
v_lshlrev_b32 v8, 2, v8
v_lshl_add_u32 v8, v98, 10, v8
ds_write_b32 v8, v58
v_and_b32 v8, 0xff, v139
v_lshl_or_b32 v59, v19, 18, v59
v_lshlrev_b32 v8, 2, v8
v_lshl_add_u32 v8, v99, 10, v8
ds_write_b32 v8, v59
s_waitcnt vmcnt(8) lgkmcnt(15)
v_and_b32 v8, 0xff, v140
v_lshl_or_b32 v60, v20, 18, v60
v_lshlrev_b32 v8, 2, v8
v_lshl_add_u32 v8, v100, 10, v8
ds_write_b32 v8, v60
v_and_b32 v8, 0xff, v141
v_lshl_or_b32 v61, v21, 18, v61
v_lshlrev_b32 v8, 2, v8
v_lshl_add_u32 v8, v101, 10, v8
ds_write_b32 v8, v61
v_and_b32 v8, 0xff, v142
v_lshl_or_b32 v62, v22, 18, v62
v_lshlrev_b32 v8, 2, v8
v_lshl_add_u32 v8, v102, 10, v8
ds_write_b32 v8, v62
v_and_b32 v8, 0xff, v143
v_lshl_or_b32 v63, v23, 18, v63
v_lshlrev_b32 v8, 2, v8
v_lshl_add_u32 v8, v103, 10, v8
ds_write_b32 v8, v63
s_waitcnt vmcnt(7) lgkmcnt(15)
v_and_b32 v8, 0xff, v144
v_lshl_or_b32 v64, v24, 18, v64
v_lshlrev_b32 v8, 2, v8
v_lshl_add_u32 v8, v104, 10, v8
ds_write_b32 v8, v64
v_and_b32 v8, 0xff, v145
v_lshl_or_b32 v65, v25, 18, v65
v_lshlrev_b32 v8, 2, v8
v_lshl_add_u32 v8, v105, 10, v8
ds_write_b32 v8, v65
v_and_b32 v8, 0xff, v146
v_lshl_or_b32 v66, v26, 18, v66
v_lshlrev_b32 v8, 2, v8
v_lshl_add_u32 v8, v106, 10, v8
ds_write_b32 v8, v66
v_and_b32 v8, 0xff, v147
v_lshl_or_b32 v67, v27, 18, v67
v_lshlrev_b32 v8, 2, v8
v_lshl_add_u32 v8, v107, 10, v8
ds_write_b32 v8, v67
s_waitcnt vmcnt(6) lgkmcnt(15)
v_and_b32 v8, 0xff, v148
v_lshl_or_b32 v68, v28, 18, v68
v_lshlrev_b32 v8, 2, v8
v_lshl_add_u32 v8, v108, 10, v8
ds_write_b32 v8, v68
v_and_b32 v8, 0xff, v149
v_lshl_or_b32 v69, v29, 18, v69
v_lshlrev_b32 v8, 2, v8
v_lshl_add_u32 v8, v109, 10, v8
ds_write_b32 v8, v69
v_and_b32 v8, 0xff, v150
v_lshl_or_b32 v70, v30, 18, v70
v_lshlrev_b32 v8, 2, v8
v_lshl_add_u32 v8, v110, 10, v8
ds_write_b32 v8, v70
v_and_b32 v8, 0xff, v151
v_lshl_or_b32 v71, v31, 18, v71
v_lshlrev_b32 v8, 2, v8
v_lshl_add_u32 v8, v111, 10, v8
ds_write_b32 v8, v71
s_waitcnt vmcnt(5) lgkmcnt(15)
v_and_b32 v8, 0xff, v152
v_lshl_or_b32 v72, v32, 18, v72
v_lshlrev_b32 v8, 2, v8
v_lshl_add_u32 v8, v112, 10, v8
ds_write_b32 v8, v72
v_and_b32 v8, 0xff, v153
v_lshl_or_b32 v73, v33, 18, v73
v_lshlrev_b32 v8, 2, v8
v_lshl_add_u32 v8, v113, 10, v8
ds_write_b32 v8, v73
v_and_b32 v8, 0xff, v154
v_lshl_or_b32 v74, v34, 18, v74
v_lshlrev_b32 v8, 2, v8
v_lshl_add_u32 v8, v114, 10, v8
ds_write_b32 v8, v74
v_and_b32 v8, 0xff, v155
v_lshl_or_b32 v75, v35, 18, v75
v_lshlrev_b32 v8, 2, v8
v_lshl_add_u32 v8, v115, 10, v8
ds_write_b32 v8, v75
s_waitcnt vmcnt(4) lgkmcnt(15)
v_and_b32 v8, 0xff, v156
v_lshl_or_b32 v76, v36, 18, v76
v_lshlrev_b32 v8, 2, v8
v_lshl_add_u32 v8, v116, 10, v8
ds_write_b32 v8, v76
v_and_b32 v8, 0xff, v157
v_lshl_or_b32 v77, v37, 18, v77
v_lshlrev_b32 v8, 2, v8
v_lshl_add_u32 v8, v117, 10, v8
ds_write_b32 v8, v77
v_and_b32 v8, 0xff, v158
v_lshl_or_b32 v78, v38, 18, v78
v_lshlrev_b32 v8, 2, v8
v_lshl_add_u32 v8, v118, 10, v8
ds_write_b32 v8, v78
v_and_b32 v8, 0xff, v159
v_lshl_or_b32 v79, v39, 18, v79
v_lshlrev_b32 v8, 2, v8
v_lshl_add_u32 v8, v119, 10, v8
ds_write_b32 v8, v79
s_waitcnt vmcnt(3) lgkmcnt(15)
v_and_b32 v8, 0xff, v160
v_lshl_or_b32 v80, v40, 18, v80
v_lshlrev_b32 v8, 2, v8
v_lshl_add_u32 v8, v120, 10, v8
ds_write_b32 v8, v80
v_and_b32 v8, 0xff, v161
v_lshl_or_b32 v81, v41, 18, v81
v_lshlrev_b32 v8, 2, v8
v_lshl_add_u32 v8, v121, 10, v8
ds_write_b32 v8, v81
v_and_b32 v8, 0xff, v162
v_lshl_or_b32 v82, v42, 18, v82
v_lshlrev_b32 v8, 2, v8
v_lshl_add_u32 v8, v122, 10, v8
ds_write_b32 v8, v82
v_and_b32 v8, 0xff, v163
v_lshl_or_b32 v83, v43, 18, v83
v_lshlrev_b32 v8, 2, v8
v_lshl_add_u32 v8, v123, 10, v8
ds_write_b32 v8, v83
s_waitcnt vmcnt(2) lgkmcnt(15)
v_and_b32 v8, 0xff, v164
v_lshl_or_b32 v84, v44, 18, v84
v_lshlrev_b32 v8, 2, v8
v_lshl_add_u32 v8, v124, 10, v8
ds_write_b32 v8, v84
v_and_b32 v8, 0xff, v165
v_lshl_or_b32 v85, v45, 18, v85
v_lshlrev_b32 v8, 2, v8
v_lshl_add_u32 v8, v125, 10, v8
ds_write_b32 v8, v85
v_and_b32 v8, 0xff, v166
v_lshl_or_b32 v86, v46, 18, v86
v_lshlrev_b32 v8, 2, v8
v_lshl_add_u32 v8, v126, 10, v8
ds_write_b32 v8, v86
v_and_b32 v8, 0xff, v167
v_lshl_or_b32 v87, v47, 18, v87
v_lshlrev_b32 v8, 2, v8
v_lshl_add_u32 v8, v127, 10, v8
ds_write_b32 v8, v87
s_waitcnt vmcnt(1) lgkmcnt(15)
v_and_b32 v8, 0xff, v168
v_lshl_or_b32 v88, v48, 18, v88
v_lshlrev_b32 v8, 2, v8
v_lshl_add_u32 v8, v128, 10, v8
ds_write_b32 v8, v88
v_and_b32 v8, 0xff, v169
v_lshl_or_b32 v89, v49, 18, v89
v_lshlrev_b32 v8, 2, v8
v_lshl_add_u32 v8, v129, 10, v8
ds_write_b32 v8, v89
v_and_b32 v8, 0xff, v170
v_lshl_or_b32 v90, v50, 18, v90
v_lshlrev_b32 v8, 2, v8
v_lshl_add_u32 v8, v130, 10, v8
ds_write_b32 v8, v90
v_and_b32 v8, 0xff, v171
v_lshl_or_b32 v91, v51, 18, v91
v_lshlrev_b32 v8, 2, v8
v_lshl_add_u32 v8, v131, 10, v8
ds_write_b32 v8, v91
s_waitcnt vmcnt(0) lgkmcnt(15)
s_mov_b64 exec, s[12:13]
v_and_b32 v8, 0xff, v172
v_lshl_or_b32 v92, v52, 18, v92
v_lshlrev_b32 v8, 2, v8
v_lshl_add_u32 v8, v132, 10, v8
ds_write_b32 v8, v92
v_and_b32 v8, 0xff, v173
v_lshl_or_b32 v93, v53, 18, v93
v_lshlrev_b32 v8, 2, v8
v_lshl_add_u32 v8, v133, 10, v8
ds_write_b32 v8, v93
v_and_b32 v8, 0xff, v174
v_lshl_or_b32 v94, v54, 18, v94
v_lshlrev_b32 v8, 2, v8
v_lshl_add_u32 v8, v134, 10, v8
ds_write_b32 v8, v94
v_and_b32 v8, 0xff, v175
v_lshl_or_b32 v95, v55, 18, v95
v_lshlrev_b32 v8, 2, v8
v_lshl_add_u32 v8, v135, 10, v8
ds_write_b32 v8, v95
s_mov_b64 exec, -1
s_waitcnt lgkmcnt(0)
s_barrier
ds_read_b32 v8, v6
s_mul_i32 s6, s60, 16384
v_lshlrev_b32 v10, 4, v2
v_add_u32 v9, s6, v10
ds_read_b128 v[176:179], v9 offset:0
ds_read_b128 v[180:183], v9 offset:1024
ds_read_b128 v[184:187], v9 offset:2048
ds_read_b128 v[188:191], v9 offset:3072
ds_read_b128 v[192:195], v9 offset:4096
ds_read_b128 v[196:199], v9 offset:5120
ds_read_b128 v[200:203], v9 offset:6144
ds_read_b128 v[204:207], v9 offset:7168
ds_read_b128 v[208:211], v9 offset:8192
ds_read_b128 v[212:215], v9 offset:9216
ds_read_b128 v[216:219], v9 offset:10240
ds_read_b128 v[220:223], v9 offset:11264
ds_read_b128 v[224:227], v9 offset:12288
ds_read_b128 v[228:231], v9 offset:13312
ds_read_b128 v[232:235], v9 offset:14336
ds_read_b128 v[236:239], v9 offset:15360
s_mul_i32 s6, s60, 10485760
s_mul_i32 s7, s4, 40960
s_add_u32 s6, s6, s7
v_lshlrev_b32 v9, 6, v2
s_lshl_b32 s8, s4, 2
s_cmp_eq_u32 s60, 0
s_cselect_b32 s8, s8, 0x7fff0000
s_waitcnt lgkmcnt(15)
buffer_store_dword v8, v9, s[52:55], s8 offen sc1
v_cmp_lt_u32 vcc, 0x100, v8
s_cbranch_vccnz L1_eslow
s_waitcnt lgkmcnt(15)
buffer_store_dwordx4 v[176:179], v10, s[48:51], s6 offen sc1
s_add_u32 s6, s6, 655360
s_waitcnt lgkmcnt(14)
buffer_store_dwordx4 v[180:183], v10, s[48:51], s6 offen sc1
s_add_u32 s6, s6, 655360
s_waitcnt lgkmcnt(13)
buffer_store_dwordx4 v[184:187], v10, s[48:51], s6 offen sc1
s_add_u32 s6, s6, 655360
s_waitcnt lgkmcnt(12)
buffer_store_dwordx4 v[188:191], v10, s[48:51], s6 offen sc1
s_add_u32 s6, s6, 655360
s_waitcnt lgkmcnt(11)
buffer_store_dwordx4 v[192:195], v10, s[48:51], s6 offen sc1
s_add_u32 s6, s6, 655360
s_waitcnt lgkmcnt(10)
buffer_store_dwordx4 v[196:199], v10, s[48:51], s6 offen sc1
s_add_u32 s6, s6, 655360
s_waitcnt lgkmcnt(9)
buffer_store_dwordx4 v[200:203], v10, s[48:51], s6 offen sc1
s_add_u32 s6, s6, 655360
s_waitcnt lgkmcnt(8)
buffer_store_dwordx4 v[204:207], v10, s[48:51], s6 offen sc1
s_add_u32 s6, s6, 655360
s_waitcnt lgkmcnt(7)
buffer_store_dwordx4 v[208:211], v10, s[48:51], s6 offen sc1
s_add_u32 s6, s6, 655360
s_waitcnt lgkmcnt(6)
buffer_store_dwordx4 v[212:215], v10, s[48:51], s6 offen sc1
s_add_u32 s6, s6, 655360
s_waitcnt lgkmcnt(5)
buffer_store_dwordx4 v[216:219], v10, s[48:51], s6 offen sc1
s_add_u32 s6, s6, 655360
s_waitcnt lgkmcnt(4)
buffer_store_dwordx4 v[220:223], v10, s[48:51], s6 offen sc1
s_add_u32 s6, s6, 655360
s_waitcnt lgkmcnt(3)
buffer_store_dwordx4 v[224:227], v10, s[48:51], s6 offen sc1
s_add_u32 s6, s6, 655360
s_waitcnt lgkmcnt(2)
buffer_store_dwordx4 v[228:231], v10, s[48:51], s6 offen sc1
s_add_u32 s6, s6, 655360
s_waitcnt lgkmcnt(1)
buffer_store_dwordx4 v[232:235], v10, s[48:51], s6 offen sc1
s_add_u32 s6, s6, 655360
s_waitcnt lgkmcnt(0)
buffer_store_dwordx4 v[236:239], v10, s[48:51], s6 offen sc1
s_add_u32 s6, s6, 655360
s_branch L1_fin
L1_eslow:
s_mov_b32 s9, 655360
v_mul_u32_u24 v96, s9, v96
v_lshl_add_u32 v96, v136, 2, v96
v_mul_u32_u24 v97, s9, v97
v_lshl_add_u32 v97, v137, 2, v97
v_mul_u32_u24 v98, s9, v98
v_lshl_add_u32 v98, v138, 2, v98
v_mul_u32_u24 v99, s9, v99
v_lshl_add_u32 v99, v139, 2, v99
v_mul_u32_u24 v100, s9, v100
v_lshl_add_u32 v100, v140, 2, v100
v_mul_u32_u24 v101, s9, v101
v_lshl_add_u32 v101, v141, 2, v101
v_mul_u32_u24 v102, s9, v102
v_lshl_add_u32 v102, v142, 2, v102
v_mul_u32_u24 v103, s9, v103
v_lshl_add_u32 v103, v143, 2, v103
v_mul_u32_u24 v104, s9, v104
v_lshl_add_u32 v104, v144, 2, v104
v_mul_u32_u24 v105, s9, v105
v_lshl_add_u32 v105, v145, 2, v105
v_mul_u32_u24 v106, s9, v106
v_lshl_add_u32 v106, v146, 2, v106
v_mul_u32_u24 v107, s9, v107
v_lshl_add_u32 v107, v147, 2, v107
v_mul_u32_u24 v108, s9, v108
v_lshl_add_u32 v108, v148, 2, v108
v_mul_u32_u24 v109, s9, v109
v_lshl_add_u32 v109, v149, 2, v109
v_mul_u32_u24 v110, s9, v110
v_lshl_add_u32 v110, v150, 2, v110
v_mul_u32_u24 v111, s9, v111
v_lshl_add_u32 v111, v151, 2, v111
v_mul_u32_u24 v112, s9, v112
v_lshl_add_u32 v112, v152, 2, v112
v_mul_u32_u24 v113, s9, v113
v_lshl_add_u32 v113, v153, 2, v113
v_mul_u32_u24 v114, s9, v114
v_lshl_add_u32 v114, v154, 2, v114
v_mul_u32_u24 v115, s9, v115
v_lshl_add_u32 v115, v155, 2, v115
v_mul_u32_u24 v116, s9, v116
v_lshl_add_u32 v116, v156, 2, v116
v_mul_u32_u24 v117, s9, v117
v_lshl_add_u32 v117, v157, 2, v117
v_mul_u32_u24 v118, s9, v118
v_lshl_add_u32 v118, v158, 2, v118
v_mul_u32_u24 v119, s9, v119
v_lshl_add_u32 v119, v159, 2, v119
v_mul_u32_u24 v120, s9, v120
v_lshl_add_u32 v120, v160, 2, v120
v_mul_u32_u24 v121, s9, v121
v_lshl_add_u32 v121, v161, 2, v121
v_mul_u32_u24 v122, s9, v122
v_lshl_add_u32 v122, v162, 2, v122
v_mul_u32_u24 v123, s9, v123
v_lshl_add_u32 v123, v163, 2, v123
v_mul_u32_u24 v124, s9, v124
v_lshl_add_u32 v124, v164, 2, v124
v_mul_u32_u24 v125, s9, v125
v_lshl_add_u32 v125, v165, 2, v125
v_mul_u32_u24 v126, s9, v126
v_lshl_add_u32 v126, v166, 2, v126
v_mul_u32_u24 v127, s9, v127
v_lshl_add_u32 v127, v167, 2, v127
v_mul_u32_u24 v128, s9, v128
v_lshl_add_u32 v128, v168, 2, v128
v_mul_u32_u24 v129, s9, v129
v_lshl_add_u32 v129, v169, 2, v129
v_mul_u32_u24 v130, s9, v130
v_lshl_add_u32 v130, v170, 2, v130
v_mul_u32_u24 v131, s9, v131
v_lshl_add_u32 v131, v171, 2, v131
v_mul_u32_u24 v132, s9, v132
v_lshl_add_u32 v132, v172, 2, v132
v_mul_u32_u24 v133, s9, v133
v_lshl_add_u32 v133, v173, 2, v133
v_mul_u32_u24 v134, s9, v134
v_lshl_add_u32 v134, v174, 2, v134
v_mul_u32_u24 v135, s9, v135
v_lshl_add_u32 v135, v175, 2, v135
buffer_store_dword v56, v96, s[48:51], s7 offen sc1
buffer_store_dword v57, v97, s[48:51], s7 offen sc1
buffer_store_dword v58, v98, s[48:51], s7 offen sc1
buffer_store_dword v59, v99, s[48:51], s7 offen sc1
buffer_store_dword v60, v100, s[48:51], s7 offen sc1
buffer_store_dword v61, v101, s[48:51], s7 offen sc1
buffer_store_dword v62, v102, s[48:51], s7 offen sc1
buffer_store_dword v63, v103, s[48:51], s7 offen sc1
buffer_store_dword v64, v104, s[48:51], s7 offen sc1
buffer_store_dword v65, v105, s[48:51], s7 offen sc1
buffer_store_dword v66, v106, s[48:51], s7 offen sc1
buffer_store_dword v67, v107, s[48:51], s7 offen sc1
buffer_store_dword v68, v108, s[48:51], s7 offen sc1
buffer_store_dword v69, v109, s[48:51], s7 offen sc1
buffer_store_dword v70, v110, s[48:51], s7 offen sc1
buffer_store_dword v71, v111, s[48:51], s7 offen sc1
buffer_store_dword v72, v112, s[48:51], s7 offen sc1
buffer_store_dword v73, v113, s[48:51], s7 offen sc1
buffer_store_dword v74, v114, s[48:51], s7 offen sc1
buffer_store_dword v75, v115, s[48:51], s7 offen sc1
buffer_store_dword v76, v116, s[48:51], s7 offen sc1
buffer_store_dword v77, v117, s[48:51], s7 offen sc1
buffer_store_dword v78, v118, s[48:51], s7 offen sc1
buffer_store_dword v79, v119, s[48:51], s7 offen sc1
buffer_store_dword v80, v120, s[48:51], s7 offen sc1
buffer_store_dword v81, v121, s[48:51], s7 offen sc1
buffer_store_dword v82, v122, s[48:51], s7 offen sc1
buffer_store_dword v83, v123, s[48:51], s7 offen sc1
buffer_store_dword v84, v124, s[48:51], s7 offen sc1
buffer_store_dword v85, v125, s[48:51], s7 offen sc1
buffer_store_dword v86, v126, s[48:51], s7 offen sc1
buffer_store_dword v87, v127, s[48:51], s7 offen sc1
buffer_store_dword v88, v128, s[48:51], s7 offen sc1
buffer_store_dword v89, v129, s[48:51], s7 offen sc1
buffer_store_dword v90, v130, s[48:51], s7 offen sc1
buffer_store_dword v91, v131, s[48:51], s7 offen sc1
s_mov_b64 exec, s[12:13]
buffer_store_dword v92, v132, s[48:51], s7 offen sc1
buffer_store_dword v93, v133, s[48:51], s7 offen sc1
buffer_store_dword v94, v134, s[48:51], s7 offen sc1
buffer_store_dword v95, v135, s[48:51], s7 offen sc1
s_mov_b64 exec, -1
s_branch L1_fin
L2_entry:
s_load_dwordx2 s[4:5], s[0:1], 88
s_load_dwordx2 s[60:61], s[0:1], 0
s_load_dwordx2 s[52:53], s[0:1], 24
s_load_dwordx2 s[56:57], s[0:1], 72
s_and_b32 s35, s2, 7
s_lshr_b32 s37, s2, 3
s_add_u32 s37, s37, 30
s_and_b32 s37, s37, 31
s_cmp_ge_u32 s37, 30
s_cbranch_scc1 LE_start
s_mul_i32 s38, s37, 26
s_lshr_b32 s38, s38, 8
s_mul_i32 s39, s38, 10
s_sub_u32 s39, s37, s39
s_and_b32 s37, s35, 1
s_mul_i32 s37, s37, 3
s_add_u32 s37, s37, s38
s_lshr_b32 s38, s35, 1
s_mul_i32 s38, s38, 10
s_add_u32 s38, s38, s39
v_lshrrev_b32 v1, 6, v0
v_and_b32 v248, 63, v0
v_lshlrev_b32 v248, 4, v248
v_readfirstlane_b32 s34, v1
s_mov_b32 s50, 0xe1a06800
s_mov_b32 s51, 0x4e20ad04
s_mul_i32 s39, s37, 9
s_lshr_b64 s[50:51], s[50:51], s39
s_and_b32 s39, s50, 0x1ff
s_bfe_u32 s49, s50, 0x90009
s_sub_u32 s31, s49, s39
s_sub_u32 s31, s31, 5
s_lshl_b32 s39, s39, 14
s_lshl_b32 s49, s49, 14
s_add_u32 s28, s39, 0x4000
s_cmp_eq_u32 s37, 5
s_addc_u32 s31, s31, 0
s_cmp_eq_u32 s37, 5
s_cselect_b32 s28, s39, s28
s_cselect_b32 s39, 5111808, s39
s_cselect_b32 s49, 5120000, s49
s_cselect_b32 s33, 0xff800000, 0
s_mov_b32 s32, 0x5d800000
v_and_b32 v2, 63, v0
v_bfe_u32 v3, v2, 3, 2
v_bfe_u32 v4, v2, 2, 1
v_lshlrev_b32 v241, 12, v3
v_lshl_or_b32 v241, v4, 9, v241
v_lshl_or_b32 v241, v1, 7, v241
v_lshrrev_b32 v4, 5, v2
v_lshl_or_b32 v241, v4, 6, v241
v_and_b32 v3, 2, v3
v_and_b32 v4, 3, v2
v_xor_b32 v3, v3, v4
v_lshl_or_b32 v241, v3, 4, v241
s_cmp_eq_u32 s38, 39
s_cbranch_scc1 LT_disp
s_cmp_lt_u32 s37, 3
s_cselect_b32 s101, 1, -1
s_cselect_b32 s39, 0, 103
s_cselect_b32 s3, 0, 3
s_sub_u32 s3, s37, s3
s_mul_i32 s3, s3, 104
s_add_u32 s39, s39, s3
s_cmp_eq_u32 s37, 5
s_addc_u32 s39, s39, 0
s_lshl_b32 s101, s101, 14
s_lshl_b32 s39, s39, 14
s_add_u32 s28, s39, s101
s_mov_b32 s49, 5120000
s_mov_b32 s31, 40
s_mov_b32 s100, 3
s_lshl_b32 s30, s34, 12
s_lshl_b32 s50, s34, 13
s_add_u32 s50, s50, 0x20000
s_mov_b32 m0, s30
s_mov_b32 s6, 0x92c51840
s_mov_b32 s7, 0xfb73ea6d
s_mul_i32 s3, s37, 12
s_min_u32 s3, s3, 56
s_lshr_b64 s[6:7], s[6:7], s3
s_bfe_u32 s29, s6, 0x40008
s_bfe_u32 s7, s6, 0x40004
s_and_b32 s6, s6, 15
s_cmp_lt_u32 s37, 4
s_cselect_b32 s29, s29, 16
s_mov_b32 s94, 0
s_mov_b32 s95, 0
s_lshr_b32 s3, s6, 2
s_cmp_eq_u32 s3, s34
s_cselect_b32 s94, s6, s94
s_cselect_b32 s95, 1, s95
s_lshr_b32 s3, s7, 2
s_cmp_eq_u32 s3, s34
s_cselect_b32 s94, s7, s94
s_cselect_b32 s95, 1, s95
s_lshr_b32 s3, s29, 2
s_cmp_eq_u32 s3, s34
s_cselect_b32 s94, s29, s94
s_cselect_b32 s95, 1, s95
s_and_b32 s94, s94, 3
s_lshl_b32 s3, s38, 17
s_lshl_b32 s51, s34, 7
s_add_u32 s3, s3, s51
s_lshl_b32 s6, s6, 13
s_add_u32 s6, s6, s3
s_lshl_b32 s7, s7, 13
s_add_u32 s7, s7, s3
s_lshl_b32 s29, s29, 13
s_add_u32 s29, s29, s3
s_mov_b64 s[96:97], 0
s_lshr_b32 s3, s6, 9
s_mul_i32 s40, s3, 6809
s_mov_b32 s41, s40
s_mul_i32 s40, s3, 6205
s_add_u32 s40, s40, 0x220f50
s_cmp_lt_u32 s3, 3696
s_cselect_b32 s41, s41, s40
s_mul_i32 s40, s3, 7437
s_add_u32 s40, s40, 0xff904e58
s_cmp_lt_u32 s3, 7752
s_cselect_b32 s41, s41, s40
s_lshr_b32 s3, s41, 20
s_bitset1_b64 s[96:97], s3
s_lshr_b32 s3, s6, 9
s_add_u32 s3, s3, 15
s_mul_i32 s40, s3, 6809
s_mov_b32 s41, s40
s_mul_i32 s40, s3, 6205
s_add_u32 s40, s40, 0x220f50
s_cmp_lt_u32 s3, 3696
s_cselect_b32 s41, s41, s40
s_mul_i32 s40, s3, 7437
s_add_u32 s40, s40, 0xff904e58
s_cmp_lt_u32 s3, 7752
s_cselect_b32 s41, s41, s40
s_lshr_b32 s3, s41, 20
s_bitset1_b64 s[96:97], s3
s_lshr_b32 s3, s7, 9
s_mul_i32 s40, s3, 6809
s_mov_b32 s41, s40
s_mul_i32 s40, s3, 6205
s_add_u32 s40, s40, 0x220f50
s_cmp_lt_u32 s3, 3696
s_cselect_b32 s41, s41, s40
s_mul_i32 s40, s3, 7437
s_add_u32 s40, s40, 0xff904e58
s_cmp_lt_u32 s3, 7752
s_cselect_b32 s41, s41, s40
s_lshr_b32 s3, s41, 20
s_bitset1_b64 s[96:97], s3
s_lshr_b32 s3, s7, 9
s_add_u32 s3, s3, 15
s_mul_i32 s40, s3, 6809
s_mov_b32 s41, s40
s_mul_i32 s40, s3, 6205
s_add_u32 s40, s40, 0x220f50
s_cmp_lt_u32 s3, 3696
s_cselect_b32 s41, s41, s40
s_mul_i32 s40, s3, 7437
s_add_u32 s40, s40, 0xff904e58
s_cmp_lt_u32 s3, 7752
s_cselect_b32 s41, s41, s40
s_lshr_b32 s3, s41, 20
s_bitset1_b64 s[96:97], s3
s_lshr_b32 s3, s29, 9
s_mul_i32 s40, s3, 6809
s_mov_b32 s41, s40
s_mul_i32 s40, s3, 6205
s_add_u32 s40, s40, 0x220f50
s_cmp_lt_u32 s3, 3696
s_cselect_b32 s41, s41, s40
s_mul_i32 s40, s3, 7437
s_add_u32 s40, s40, 0xff904e58
s_cmp_lt_u32 s3, 7752
s_cselect_b32 s41, s41, s40
s_lshr_b32 s3, s41, 20
s_bitset1_b64 s[96:97], s3
s_lshr_b32 s3, s29, 9
s_add_u32 s3, s3, 15
s_mul_i32 s40, s3, 6809
s_mov_b32 s41, s40
s_mul_i32 s40, s3, 6205
s_add_u32 s40, s40, 0x220f50
s_cmp_lt_u32 s3, 3696
s_cselect_b32 s41, s41, s40
s_mul_i32 s40, s3, 7437
s_add_u32 s40, s40, 0xff904e58
s_cmp_lt_u32 s3, 7752
s_cselect_b32 s41, s41, s40
s_lshr_b32 s3, s41, 20
s_bitset1_b64 s[96:97], s3
s_mul_i32 s3, s38, 6
s_add_u32 s3, s3, s37
s_cmp_eq_u32 s3, 233
s_cselect_b32 s3, 0, s37
s_cmp_lt_u32 s3, 4
s_cselect_b32 s29, s29, 0x70000000
s_lshl_b32 s51, s38, 5
s_lshl_b32 s3, s34, 3
s_add_u32 s51, s51, s3
s_add_u32 s51, s51, s37
s_mul_i32 s51, s51, 128
s_add_u32 s51, s51, 0x7c00000
s_lshr_b32 s40, s39, 17
s_min_u32 s40, s40, 38
s_lshr_b32 s41, s28, 17
s_add_u32 s3, s28, s101
s_lshr_b32 s3, s3, 17
v_mov_b32 v5, s38
v_mov_b32 v6, s40
v_cmp_lt_u32 vcc, 0x7f, v248
s_nop 1
v_cndmask_b32 v5, v5, v6, vcc
v_mov_b32 v6, s41
v_cmp_lt_u32 vcc, 0xff, v248
s_nop 1
v_cndmask_b32 v5, v5, v6, vcc
v_mov_b32 v6, s3
v_cmp_lt_u32 vcc, 0x17f, v248
s_nop 1
v_cndmask_b32 v5, v5, v6, vcc
v_bfe_u32 v6, v248, 4, 3
v_min_u32 v6, 5, v6
v_mad_u32_u24 v5, v5, 6, v6
v_lshlrev_b32 v5, 7, v5
v_add_u32 v5, 0x7c2a000, v5
s_mul_i32 s3, s101, 54
s_add_u32 s3, s3, s39
s_min_u32 s41, s3, s39
s_max_u32 s3, s3, s39
s_lshr_b32 s41, s41, 17
s_min_u32 s40, s40, s41
s_mul_i32 s40, s40, 6
s_lshr_b32 s3, s3, 17
s_min_u32 s3, s3, 38
s_mul_i32 s3, s3, 6
s_add_u32 s3, s3, 5
v_lshrrev_b32 v251, 4, v248
v_add_u32 v251, s40, v251
v_min_u32 v251, s3, v251
v_lshlrev_b32 v251, 7, v251
v_add_u32 v251, 0x7c2a000, v251
s_waitcnt lgkmcnt(0)
s_add_u32 s12, s4, 0x6800000
s_addc_u32 s13, s5, 0
s_mov_b32 s14, 0x0
s_mov_b32 s15, 0x00020000
s_mov_b32 s14, s49
s_add_u32 s8, s4, 0x0
s_addc_u32 s9, s5, 0
s_mov_b32 s10, 0x4e4000
s_mov_b32 s11, 0x00020000
s_mul_i32 s35, s37, 0x600000
s_add_u32 s20, s4, 0x2000000
s_addc_u32 s21, s5, 0
s_add_u32 s20, s20, s35
s_addc_u32 s21, s21, 0
s_mov_b32 s22, 0x4e4000
s_mov_b32 s23, 0x00020000
s_add_u32 s24, s4, 0x6000000
s_addc_u32 s25, s5, 0
s_mov_b32 s26, 0x139000
s_mov_b32 s27, 0x00020000
s_lshl_b32 s35, s38, 4
s_lshl_b32 s41, s34, 2
s_add_u32 s35, s35, s41
s_lshl_b32 s40, s35, 13
s_lshl_b32 s94, s94, 13
s_add_u32 s40, s40, s94
s_xor_b32 s41, s40, 8192
s_xor_b32 s42, s40, 16384
s_xor_b32 s43, s40, 24576
s_add_u32 s44, s40, 4096
s_add_u32 s45, s41, 4096
s_add_u32 s46, s42, 4096
s_add_u32 s47, s43, 4096
s_lshl_b32 s48, s35, 10
s_lshl_b32 s35, s37, 3
s_add_u32 s48, s48, s35
v_mov_b32 v232, 0
v_mov_b32 v233, 0
v_mov_b32 v234, 0
v_mov_b32 v235, 0
v_bfe_u32 v240, v248, 4, 3
v_lshlrev_b32 v240, 6, v240
v_bfe_u32 v242, v248, 7, 1
v_lshl_or_b32 v240, v242, 10, v240
v_bfe_u32 v242, v248, 8, 2
v_lshl_or_b32 v240, v242, 4, v240
v_bfe_u32 v242, v248, 6, 1
v_lshlrev_b32 v242, 5, v242
v_xor_b32 v240, v240, v242
v_and_b32 v249, 0x1c0, v248
v_bfe_u32 v242, v248, 9, 1
v_lshl_or_b32 v249, v242, 10, v249
v_bfe_u32 v242, v248, 8, 1
v_lshl_or_b32 v249, v242, 5, v249
v_bfe_u32 v242, v248, 4, 2
v_lshl_or_b32 v249, v242, 3, v249
v_xor_b32 v250, 32, v249
v_bfe_i32 v242, v248, 8, 1
v_and_b32 v192, s33, v242
v_and_b32 v193, s33, v242
v_and_b32 v194, s33, v242
v_and_b32 v195, s33, v242
v_mfma_f32_32x32x16_bf16 a[0:15], v[232:235], v[232:235], 0
v_mfma_f32_32x32x16_bf16 a[16:31], v[232:235], v[232:235], 0
v_mfma_f32_32x32x16_bf16 a[32:47], v[232:235], v[232:235], 0
v_mfma_f32_32x32x16_bf16 a[48:63], v[232:235], v[232:235], 0
v_mfma_f32_32x32x16_bf16 a[64:79], v[232:235], v[232:235], 0
v_mfma_f32_32x32x16_bf16 a[80:95], v[232:235], v[232:235], 0
v_mfma_f32_32x32x16_bf16 a[96:111], v[232:235], v[232:235], 0
v_mfma_f32_32x32x16_bf16 a[112:127], v[232:235], v[232:235], 0
v_mfma_f32_32x32x16_bf16 a[128:143], v[232:235], v[232:235], 0
v_mfma_f32_32x32x16_bf16 a[144:159], v[232:235], v[232:235], 0
v_mfma_f32_32x32x16_bf16 a[160:175], v[232:235], v[232:235], 0
v_mfma_f32_32x32x16_bf16 a[176:191], v[232:235], v[232:235], 0
v_mfma_f32_32x32x16_bf16 a[192:207], v[232:235], v[232:235], 0
v_mfma_f32_32x32x16_bf16 a[208:223], v[232:235], v[232:235], 0
v_mfma_f32_32x32x16_bf16 a[224:239], v[232:235], v[232:235], 0
v_mfma_f32_32x32x16_bf16 a[240:255], v[232:235], v[232:235], 0
s_add_u32 s16, s4, 0x0
s_addc_u32 s17, s5, 0
s_mov_b32 s18, 0x10000000
s_mov_b32 s19, 0x00020000
s_mov_b32 s3, 0x10000
LM_pa:
buffer_load_dwordx2 v[6:7], v5, s[16:19], 0 offen sc1
s_sub_u32 s3, s3, 1
s_waitcnt vmcnt(0)
s_cbranch_scc1 LM_pa_go
v_cmp_ne_u64 vcc, s[98:99], v[6:7]
s_nop 1
s_cbranch_vccnz LM_pa
LM_pa_go:
buffer_load_dwordx4 v241, s[12:15], s39 offen offset:0 sc1 lds
buffer_load_dwordx4 v241, s[12:15], s39 offen offset:1024 sc1 lds
buffer_load_dwordx4 v241, s[12:15], s39 offen offset:2048 sc1 lds
buffer_load_dwordx4 v241, s[12:15], s39 offen offset:3072 sc1 lds
s_add_u32 m0, s30, 0x4000
s_nop 0
buffer_load_dwordx4 v241, s[12:15], s28 offen offset:0 sc1 lds
buffer_load_dwordx4 v241, s[12:15], s28 offen offset:1024 sc1 lds
buffer_load_dwordx4 v[0:3], v248, s[8:11], s40 offen offset:0 sc1
buffer_load_dwordx4 v[32:35], v248, s[8:11], s41 offen offset:0 sc1
buffer_load_dwordx4 v[64:67], v248, s[8:11], s42 offen offset:0 sc1
buffer_load_dwordx4 v[96:99], v248, s[8:11], s43 offen offset:0 sc1
buffer_load_dwordx4 v[4:7], v248, s[8:11], s40 offen offset:1024 sc1
buffer_load_dwordx4 v[36:39], v248, s[8:11], s41 offen offset:1024 sc1
buffer_load_dwordx4 v[68:71], v248, s[8:11], s42 offen offset:1024 sc1
buffer_load_dwordx4 v[100:103], v248, s[8:11], s43 offen offset:1024 sc1
buffer_load_dwordx4 v[8:11], v248, s[8:11], s40 offen offset:2048 sc1
buffer_load_dwordx4 v[40:43], v248, s[8:11], s41 offen offset:2048 sc1
buffer_load_dwordx4 v[72:75], v248, s[8:11], s42 offen offset:2048 sc1
buffer_load_dwordx4 v[104:107], v248, s[8:11], s43 offen offset:2048 sc1
buffer_load_dwordx4 v[12:15], v248, s[8:11], s40 offen offset:3072 sc1
buffer_load_dwordx4 v[44:47], v248, s[8:11], s41 offen offset:3072 sc1
buffer_load_dwordx4 v[76:79], v248, s[8:11], s42 offen offset:3072 sc1
buffer_load_dwordx4 v[108:111], v248, s[8:11], s43 offen offset:3072 sc1
buffer_load_dwordx4 v[16:19], v248, s[8:11], s44 offen offset:0 sc1
buffer_load_dwordx4 v[48:51], v248, s[8:11], s45 offen offset:0 sc1
buffer_load_dwordx4 v[80:83], v248, s[8:11], s46 offen offset:0 sc1
buffer_load_dwordx4 v[112:115], v248, s[8:11], s47 offen offset:0 sc1
buffer_load_dwordx2 v[252:253], v251, s[16:19], 0 offen sc1
s_waitcnt vmcnt(21)
s_barrier
ds_read_b128 v[208:211], v240 offset:0
ds_read_b128 v[212:215], v240 offset:2048
ds_read_b128 v[216:219], v240 offset:16384
ds_read_b128 v[220:223], v240 offset:512
s_waitcnt lgkmcnt(3)
s_waitcnt vmcnt(17)
v_mfma_f32_16x16x32_bf16 v[128:131], v[208:211], v[0:3], v[192:195]
buffer_load_dwordx4 v[20:23], v248, s[8:11], s44 offen offset:1024 sc1
v_mfma_f32_16x16x32_bf16 v[132:135], v[208:211], v[32:35], v[192:195]
v_mfma_f32_16x16x32_bf16 v[136:139], v[208:211], v[64:67], v[192:195]
v_mfma_f32_16x16x32_bf16 v[140:143], v[208:211], v[96:99], v[192:195]
ds_read_b128 v[208:211], v240 offset:2560
s_waitcnt lgkmcnt(3)
buffer_load_dwordx4 v[52:55], v248, s[8:11], s45 offen offset:1024 sc1
v_mfma_f32_16x16x32_bf16 v[144:147], v[212:215], v[0:3], v[192:195]
v_mfma_f32_16x16x32_bf16 v[148:151], v[212:215], v[32:35], v[192:195]
v_mfma_f32_16x16x32_bf16 v[152:155], v[212:215], v[64:67], v[192:195]
buffer_load_dwordx4 v[84:87], v248, s[8:11], s46 offen offset:1024 sc1
v_mfma_f32_16x16x32_bf16 v[156:159], v[212:215], v[96:99], v[192:195]
ds_read_b128 v[212:215], v240 offset:16896
s_waitcnt lgkmcnt(3)
v_mfma_f32_16x16x32_bf16 v[176:179], v[216:219], v[0:3], 0
v_mfma_f32_16x16x32_bf16 v[180:183], v[216:219], v[32:35], 0
buffer_load_dwordx4 v[116:119], v248, s[8:11], s47 offen offset:1024 sc1
v_mfma_f32_16x16x32_bf16 v[184:187], v[216:219], v[64:67], 0
v_mfma_f32_16x16x32_bf16 v[188:191], v[216:219], v[96:99], 0
ds_read_b128 v[216:219], v240 offset:4096
s_waitcnt lgkmcnt(3)
s_waitcnt vmcnt(17)
v_mfma_f32_16x16x32_bf16 v[128:131], v[220:223], v[4:7], v[128:131]
buffer_load_dwordx4 v[24:27], v248, s[8:11], s44 offen offset:2048 sc1
v_mfma_f32_16x16x32_bf16 v[132:135], v[220:223], v[36:39], v[132:135]
v_mfma_f32_16x16x32_bf16 v[136:139], v[220:223], v[68:71], v[136:139]
v_mfma_f32_16x16x32_bf16 v[140:143], v[220:223], v[100:103], v[140:143]
ds_read_b128 v[220:223], v240 offset:6144
s_waitcnt lgkmcnt(3)
buffer_load_dwordx4 v[56:59], v248, s[8:11], s45 offen offset:2048 sc1
v_mfma_f32_16x16x32_bf16 v[144:147], v[208:211], v[4:7], v[144:147]
v_mfma_f32_16x16x32_bf16 v[148:151], v[208:211], v[36:39], v[148:151]
v_mfma_f32_16x16x32_bf16 v[152:155], v[208:211], v[68:71], v[152:155]
buffer_load_dwordx4 v[88:91], v248, s[8:11], s46 offen offset:2048 sc1
v_mfma_f32_16x16x32_bf16 v[156:159], v[208:211], v[100:103], v[156:159]
ds_read_b128 v[208:211], v240 offset:20480
s_waitcnt lgkmcnt(3)
v_mfma_f32_16x16x32_bf16 v[176:179], v[212:215], v[4:7], v[176:179]
v_mfma_f32_16x16x32_bf16 v[180:183], v[212:215], v[36:39], v[180:183]
buffer_load_dwordx4 v[120:123], v248, s[8:11], s47 offen offset:2048 sc1
v_mfma_f32_16x16x32_bf16 v[184:187], v[212:215], v[68:71], v[184:187]
v_mfma_f32_16x16x32_bf16 v[188:191], v[212:215], v[100:103], v[188:191]
ds_read_b128 v[212:215], v240 offset:4608
s_waitcnt lgkmcnt(3)
s_waitcnt vmcnt(17)
v_mfma_f32_16x16x32_bf16 v[128:131], v[216:219], v[8:11], v[128:131]
buffer_load_dwordx4 v[28:31], v248, s[8:11], s44 offen offset:3072 sc1
v_mfma_f32_16x16x32_bf16 v[132:135], v[216:219], v[40:43], v[132:135]
v_mfma_f32_16x16x32_bf16 v[136:139], v[216:219], v[72:75], v[136:139]
v_mfma_f32_16x16x32_bf16 v[140:143], v[216:219], v[104:107], v[140:143]
ds_read_b128 v[216:219], v240 offset:6656
s_waitcnt lgkmcnt(3)
buffer_load_dwordx4 v[60:63], v248, s[8:11], s45 offen offset:3072 sc1
v_mfma_f32_16x16x32_bf16 v[144:147], v[220:223], v[8:11], v[144:147]
v_mfma_f32_16x16x32_bf16 v[148:151], v[220:223], v[40:43], v[148:151]
v_mfma_f32_16x16x32_bf16 v[152:155], v[220:223], v[72:75], v[152:155]
buffer_load_dwordx4 v[92:95], v248, s[8:11], s46 offen offset:3072 sc1
v_mfma_f32_16x16x32_bf16 v[156:159], v[220:223], v[104:107], v[156:159]
ds_read_b128 v[220:223], v240 offset:20992
s_waitcnt lgkmcnt(3)
v_mfma_f32_16x16x32_bf16 v[176:179], v[208:211], v[8:11], v[176:179]
v_mfma_f32_16x16x32_bf16 v[180:183], v[208:211], v[40:43], v[180:183]
buffer_load_dwordx4 v[124:127], v248, s[8:11], s47 offen offset:3072 sc1
v_mfma_f32_16x16x32_bf16 v[184:187], v[208:211], v[72:75], v[184:187]
v_mfma_f32_16x16x32_bf16 v[188:191], v[208:211], v[104:107], v[188:191]
ds_read_b128 v[208:211], v240 offset:8192
s_waitcnt lgkmcnt(3)
s_waitcnt vmcnt(17)
v_mfma_f32_16x16x32_bf16 v[128:131], v[212:215], v[12:15], v[128:131]
s_add_u32 s16, s4, 0x0
s_addc_u32 s17, s5, 0
s_mov_b32 s18, 0x10000000
v_mfma_f32_16x16x32_bf16 v[132:135], v[212:215], v[44:47], v[132:135]
buffer_load_dwordx4 v241, s[12:15], s28 offen offset:2048 sc1 lds
s_mov_b32 s19, 0x00020000
s_add_u32 s8, s60, 0x0
v_mfma_f32_16x16x32_bf16 v[136:139], v[212:215], v[76:79], v[136:139]
s_addc_u32 s9, s61, 0
s_mov_b32 s10, 0x4e2000
s_mov_b32 s11, 0x00020000
v_mfma_f32_16x16x32_bf16 v[140:143], v[212:215], v[108:111], v[140:143]
ds_read_b128 v[212:215], v240 offset:10240
s_waitcnt lgkmcnt(3)
buffer_load_dwordx4 v241, s[12:15], s28 offen offset:3072 sc1 lds
v_mfma_f32_16x16x32_bf16 v[144:147], v[216:219], v[12:15], v[144:147]
s_mov_b32 s54, 0x4e20
s_mov_b32 s55, 0x00020000
s_mov_b32 s58, 0x4e2000
v_mfma_f32_16x16x32_bf16 v[148:151], v[216:219], v[44:47], v[148:151]
s_mov_b32 s59, 0x00020000
s_lshr_b32 s48, s40, 2
s_cmp_eq_u32 s95, 1
v_mfma_f32_16x16x32_bf16 v[152:155], v[216:219], v[76:79], v[152:155]
s_cselect_b32 s40, 0x70000000, s40
s_cselect_b32 s44, 0x70000000, s44
s_cmp_lt_u32 s37, 3
v_mfma_f32_16x16x32_bf16 v[156:159], v[216:219], v[108:111], v[156:159]
ds_read_b128 v[216:219], v240 offset:24576
s_waitcnt lgkmcnt(3)
s_cselect_b32 s3, 0, 3
v_mfma_f32_16x16x32_bf16 v[176:179], v[220:223], v[12:15], v[176:179]
s_sub_u32 s3, s37, s3
s_cmp_eq_u32 s3, 2
s_cselect_b32 s39, 6, 6
v_mfma_f32_16x16x32_bf16 v[180:183], v[220:223], v[44:47], v[180:183]
s_cselect_b32 s35, 5, 4
s_lshl_b32 s49, s38, 2
s_add_u32 s49, s49, s3
v_mfma_f32_16x16x32_bf16 v[184:187], v[220:223], v[76:79], v[184:187]
s_lshl_b32 s49, s49, 10
s_add_u32 s49, s49, 0x7c00300
v_mfma_f32_16x16x32_bf16 v[188:191], v[220:223], v[108:111], v[188:191]
ds_read_b128 v[220:223], v240 offset:8704
s_waitcnt lgkmcnt(3)
s_waitcnt vmcnt(15)
v_mfma_f32_16x16x32_bf16 v[128:131], v[208:211], v[16:19], v[128:131]
v_mfma_f32_16x16x32_bf16 v[132:135], v[208:211], v[48:51], v[132:135]
s_add_u32 s28, s28, s101
s_add_u32 m0, s30, 0x8000
s_nop 0
v_mfma_f32_16x16x32_bf16 v[136:139], v[208:211], v[80:83], v[136:139]
v_mfma_f32_16x16x32_bf16 v[140:143], v[208:211], v[112:115], v[140:143]
ds_read_b128 v[208:211], v240 offset:10752
s_waitcnt lgkmcnt(3)
buffer_load_dwordx4 v241, s[12:15], s28 offen offset:0 sc1 lds
v_mfma_f32_16x16x32_bf16 v[144:147], v[212:215], v[16:19], v[144:147]
v_mfma_f32_16x16x32_bf16 v[148:151], v[212:215], v[48:51], v[148:151]
buffer_load_dwordx4 v241, s[12:15], s28 offen offset:1024 sc1 lds
v_mfma_f32_16x16x32_bf16 v[152:155], v[212:215], v[80:83], v[152:155]
v_mfma_f32_16x16x32_bf16 v[156:159], v[212:215], v[112:115], v[156:159]
ds_read_b128 v[212:215], v240 offset:25088
s_waitcnt lgkmcnt(3)
v_mfma_f32_16x16x32_bf16 v[176:179], v[216:219], v[16:19], v[176:179]
v_mfma_f32_16x16x32_bf16 v[180:183], v[216:219], v[48:51], v[180:183]
v_mfma_f32_16x16x32_bf16 v[184:187], v[216:219], v[80:83], v[184:187]
v_mfma_f32_16x16x32_bf16 v[188:191], v[216:219], v[112:115], v[188:191]
ds_read_b128 v[216:219], v240 offset:12288
s_waitcnt lgkmcnt(3)
s_waitcnt vmcnt(12)
v_mfma_f32_16x16x32_bf16 v[128:131], v[220:223], v[20:23], v[128:131]
v_mfma_f32_16x16x32_bf16 v[132:135], v[220:223], v[52:55], v[132:135]
buffer_load_dwordx4 v241, s[12:15], s28 offen offset:2048 sc1 lds
v_mfma_f32_16x16x32_bf16 v[136:139], v[220:223], v[84:87], v[136:139]
v_mfma_f32_16x16x32_bf16 v[140:143], v[220:223], v[116:119], v[140:143]
ds_read_b128 v[220:223], v240 offset:14336
s_waitcnt lgkmcnt(3)
buffer_load_dwordx4 v241, s[12:15], s28 offen offset:3072 sc1 lds
v_mfma_f32_16x16x32_bf16 v[144:147], v[208:211], v[20:23], v[144:147]
v_mfma_f32_16x16x32_bf16 v[148:151], v[208:211], v[52:55], v[148:151]
v_mfma_f32_16x16x32_bf16 v[152:155], v[208:211], v[84:87], v[152:155]
v_mfma_f32_16x16x32_bf16 v[156:159], v[208:211], v[116:119], v[156:159]
ds_read_b128 v[208:211], v240 offset:28672
s_waitcnt lgkmcnt(3)
v_mfma_f32_16x16x32_bf16 v[176:179], v[212:215], v[20:23], v[176:179]
v_mfma_f32_16x16x32_bf16 v[180:183], v[212:215], v[52:55], v[180:183]
v_mfma_f32_16x16x32_bf16 v[184:187], v[212:215], v[84:87], v[184:187]
v_mfma_f32_16x16x32_bf16 v[188:191], v[212:215], v[116:119], v[188:191]
ds_read_b128 v[212:215], v240 offset:12800
s_waitcnt lgkmcnt(3)
s_waitcnt vmcnt(10)
v_mfma_f32_16x16x32_bf16 v[128:131], v[216:219], v[24:27], v[128:131]
v_mfma_f32_16x16x32_bf16 v[132:135], v[216:219], v[56:59], v[132:135]
s_add_u32 s28, s28, s101
s_add_u32 s30, s30, 0xc000
v_mfma_f32_16x16x32_bf16 v[136:139], v[216:219], v[88:91], v[136:139]
v_mfma_f32_16x16x32_bf16 v[140:143], v[216:219], v[120:123], v[140:143]
ds_read_b128 v[216:219], v240 offset:14848
s_waitcnt lgkmcnt(3)
v_mfma_f32_16x16x32_bf16 v[144:147], v[220:223], v[24:27], v[144:147]
v_mfma_f32_16x16x32_bf16 v[148:151], v[220:223], v[56:59], v[148:151]
v_mfma_f32_16x16x32_bf16 v[152:155], v[220:223], v[88:91], v[152:155]
v_mfma_f32_16x16x32_bf16 v[156:159], v[220:223], v[120:123], v[156:159]
ds_read_b128 v[220:223], v240 offset:29184
s_waitcnt lgkmcnt(3)
v_mfma_f32_16x16x32_bf16 v[176:179], v[208:211], v[24:27], v[176:179]
v_mfma_f32_16x16x32_bf16 v[180:183], v[208:211], v[56:59], v[180:183]
v_mfma_f32_16x16x32_bf16 v[184:187], v[208:211], v[88:91], v[184:187]
v_mfma_f32_16x16x32_bf16 v[188:191], v[208:211], v[120:123], v[188:191]
s_waitcnt lgkmcnt(2)
s_waitcnt vmcnt(6)
v_mfma_f32_16x16x32_bf16 v[128:131], v[212:215], v[28:31], v[128:131]
v_mfma_f32_16x16x32_bf16 v[132:135], v[212:215], v[60:63], v[132:135]
v_mfma_f32_16x16x32_bf16 v[136:139], v[212:215], v[92:95], v[136:139]
v_mfma_f32_16x16x32_bf16 v[140:143], v[212:215], v[124:127], v[140:143]
s_waitcnt lgkmcnt(1)
v_mfma_f32_16x16x32_bf16 v[144:147], v[216:219], v[28:31], v[144:147]
v_mfma_f32_16x16x32_bf16 v[148:151], v[216:219], v[60:63], v[148:151]
v_mfma_f32_16x16x32_bf16 v[152:155], v[216:219], v[92:95], v[152:155]
v_mfma_f32_16x16x32_bf16 v[156:159], v[216:219], v[124:127], v[156:159]
s_waitcnt lgkmcnt(0)
v_mfma_f32_16x16x32_bf16 v[176:179], v[220:223], v[28:31], v[176:179]
v_mfma_f32_16x16x32_bf16 v[180:183], v[220:223], v[60:63], v[180:183]
v_mfma_f32_16x16x32_bf16 v[184:187], v[220:223], v[92:95], v[184:187]
v_mfma_f32_16x16x32_bf16 v[188:191], v[220:223], v[124:127], v[188:191]
v_max3_f32 v244, v128, v129, v130
v_max3_f32 v245, v132, v133, v134
v_max3_f32 v246, v136, v137, v138
v_max3_f32 v247, v140, v141, v142
v_max3_f32 v244, v244, v131, v144
v_max3_f32 v245, v245, v135, v148
v_max3_f32 v246, v246, v139, v152
v_max3_f32 v247, v247, v143, v156
v_max3_f32 v244, v244, v145, v146
v_max3_f32 v245, v245, v149, v150
v_max3_f32 v246, v246, v153, v154
v_max3_f32 v247, v247, v157, v158
v_max_f32 v244, v244, v147
v_max_f32 v245, v245, v151
v_max_f32 v246, v246, v155
v_max_f32 v247, v247, v159
v_mov_b32 v232, v244
v_mov_b32 v233, v245
v_mov_b32 v234, v246
v_mov_b32 v235, v247
v_permlane32_swap_b32 v244, v232
v_permlane32_swap_b32 v245, v233
v_permlane32_swap_b32 v246, v234
v_permlane32_swap_b32 v247, v235
v_max_f32 v244, v244, v232
v_max_f32 v245, v245, v233
v_max_f32 v246, v246, v234
v_max_f32 v247, v247, v235
v_mov_b32 v232, v244
v_mov_b32 v233, v245
v_mov_b32 v234, v246
v_mov_b32 v235, v247
v_permlane16_swap_b32 v244, v232
v_permlane16_swap_b32 v245, v233
v_permlane16_swap_b32 v246, v234
v_permlane16_swap_b32 v247, v235
v_max_f32 v244, v244, v232
v_max_f32 v245, v245, v233
v_max_f32 v246, v246, v234
v_max_f32 v247, v247, v235
v_ceil_f32 v244, v244
v_ceil_f32 v245, v245
v_ceil_f32 v246, v246
v_ceil_f32 v247, v247
v_sub_f32 v128, v128, v244
v_sub_f32 v129, v129, v244
v_sub_f32 v130, v130, v244
v_sub_f32 v131, v131, v244
v_exp_f32 v128, v128
v_exp_f32 v129, v129
v_exp_f32 v130, v130
v_exp_f32 v131, v131
v_sub_f32 v192, 0, v244
v_sub_f32 v193, 0, v244
v_sub_f32 v194, 0, v244
v_sub_f32 v195, 0, v244
v_sub_f32 v132, v132, v245
v_sub_f32 v133, v133, v245
v_sub_f32 v134, v134, v245
v_sub_f32 v135, v135, v245
v_exp_f32 v132, v132
v_exp_f32 v133, v133
v_exp_f32 v134, v134
v_exp_f32 v135, v135
v_sub_f32 v196, 0, v245
v_sub_f32 v197, 0, v245
v_sub_f32 v198, 0, v245
v_sub_f32 v199, 0, v245
v_sub_f32 v136, v136, v246
v_sub_f32 v137, v137, v246
v_sub_f32 v138, v138, v246
v_sub_f32 v139, v139, v246
v_exp_f32 v136, v136
v_exp_f32 v137, v137
v_exp_f32 v138, v138
v_exp_f32 v139, v139
v_sub_f32 v200, 0, v246
v_sub_f32 v201, 0, v246
v_sub_f32 v202, 0, v246
v_sub_f32 v203, 0, v246
v_sub_f32 v140, v140, v247
v_sub_f32 v141, v141, v247
v_sub_f32 v142, v142, v247
v_sub_f32 v143, v143, v247
v_exp_f32 v140, v140
v_exp_f32 v141, v141
v_exp_f32 v142, v142
v_exp_f32 v143, v143
v_sub_f32 v204, 0, v247
v_sub_f32 v205, 0, v247
v_sub_f32 v206, 0, v247
v_sub_f32 v207, 0, v247
s_waitcnt vmcnt(4)
s_barrier
ds_read_b64_tr_b16 v[208:209], v249 offset:0
ds_read_b64_tr_b16 v[210:211], v249 offset:2048
ds_read_b64_tr_b16 v[212:213], v250 offset:0
ds_read_b64_tr_b16 v[214:215], v250 offset:2048
ds_read_b64_tr_b16 v[216:217], v249 offset:512
ds_read_b64_tr_b16 v[218:219], v249 offset:2560
ds_read_b64_tr_b16 v[220:221], v250 offset:512
ds_read_b64_tr_b16 v[222:223], v250 offset:2560
v_sub_f32 v144, v144, v244
v_sub_f32 v145, v145, v244
v_sub_f32 v146, v146, v244
v_sub_f32 v147, v147, v244
v_exp_f32 v144, v144
v_exp_f32 v145, v145
v_exp_f32 v146, v146
v_exp_f32 v147, v147
v_sub_f32 v148, v148, v245
v_sub_f32 v149, v149, v245
v_sub_f32 v150, v150, v245
v_sub_f32 v151, v151, v245
v_exp_f32 v148, v148
v_exp_f32 v149, v149
v_exp_f32 v150, v150
v_exp_f32 v151, v151
v_sub_f32 v152, v152, v246
v_sub_f32 v153, v153, v246
v_sub_f32 v154, v154, v246
v_sub_f32 v155, v155, v246
v_exp_f32 v152, v152
v_exp_f32 v153, v153
v_exp_f32 v154, v154
v_exp_f32 v155, v155
v_sub_f32 v156, v156, v247
v_sub_f32 v157, v157, v247
v_sub_f32 v158, v158, v247
v_sub_f32 v159, v159, v247
v_exp_f32 v156, v156
v_exp_f32 v157, v157
v_exp_f32 v158, v158
v_exp_f32 v159, v159
v_cvt_pk_bf16_f32 v160, v128, v129
v_cvt_pk_bf16_f32 v161, v130, v131
v_cvt_pk_bf16_f32 v164, v132, v133
v_cvt_pk_bf16_f32 v165, v134, v135
v_cvt_pk_bf16_f32 v168, v136, v137
v_cvt_pk_bf16_f32 v169, v138, v139
v_cvt_pk_bf16_f32 v172, v140, v141
v_cvt_pk_bf16_f32 v173, v142, v143
v_cvt_pk_bf16_f32 v162, v144, v145
v_cvt_pk_bf16_f32 v163, v146, v147
v_cvt_pk_bf16_f32 v166, v148, v149
v_cvt_pk_bf16_f32 v167, v150, v151
v_cvt_pk_bf16_f32 v170, v152, v153
v_cvt_pk_bf16_f32 v171, v154, v155
v_cvt_pk_bf16_f32 v174, v156, v157
v_cvt_pk_bf16_f32 v175, v158, v159
v_add_f32 v224, v128, v129
v_add_f32 v225, v132, v133
v_add_f32 v226, v136, v137
v_add_f32 v227, v140, v141
v_add_f32 v228, v130, v131
v_add_f32 v229, v134, v135
v_add_f32 v230, v138, v139
v_add_f32 v231, v142, v143
v_add_f32 v224, v224, v144
v_add_f32 v225, v225, v148
v_add_f32 v226, v226, v152
v_add_f32 v227, v227, v156
v_add_f32 v228, v228, v145
v_add_f32 v229, v229, v149
v_add_f32 v230, v230, v153
v_add_f32 v231, v231, v157
v_add_f32 v224, v224, v146
v_add_f32 v225, v225, v150
v_add_f32 v226, v226, v154
v_add_f32 v227, v227, v158
v_add_f32 v228, v228, v147
v_add_f32 v229, v229, v151
v_add_f32 v230, v230, v155
v_add_f32 v231, v231, v159
v_add_f32 v224, v224, v228
v_add_f32 v225, v225, v229
v_add_f32 v226, v226, v230
v_add_f32 v227, v227, v231
v_sub_f32 v128, v176, v244
v_sub_f32 v129, v177, v244
v_sub_f32 v130, v178, v244
v_sub_f32 v131, v179, v244
v_sub_f32 v132, v180, v245
v_sub_f32 v133, v181, v245
v_sub_f32 v134, v182, v245
v_sub_f32 v135, v183, v245
v_sub_f32 v136, v184, v246
v_sub_f32 v137, v185, v246
v_sub_f32 v138, v186, v246
v_sub_f32 v139, v187, v246
v_sub_f32 v140, v188, v247
v_sub_f32 v141, v189, v247
v_sub_f32 v142, v190, v247
v_sub_f32 v143, v191, v247
v_cmp_ne_u64 vcc, s[98:99], v[252:253]
s_nop 1
s_cbranch_vccnz LM_pb
LM_pb_ret:
s_nop 1
.p2align 6
L2_loop:
s_waitcnt lgkmcnt(6)
v_mfma_f32_16x16x32_bf16 a[0:3], v[160:163], v[208:211], a[0:3]
v_mfma_f32_16x16x32_bf16 a[4:7], v[164:167], v[208:211], a[4:7]
v_mfma_f32_16x16x32_bf16 a[8:11], v[168:171], v[208:211], a[8:11]
v_mfma_f32_16x16x32_bf16 a[12:15], v[172:175], v[208:211], a[12:15]
ds_read_b64_tr_b16 v[208:209], v249 offset:4096
s_waitcnt lgkmcnt(5)
v_mfma_f32_16x16x32_bf16 a[16:19], v[160:163], v[212:215], a[16:19]
ds_read_b64_tr_b16 v[210:211], v249 offset:6144
v_mfma_f32_16x16x32_bf16 a[20:23], v[164:167], v[212:215], a[20:23]
v_mfma_f32_16x16x32_bf16 a[24:27], v[168:171], v[212:215], a[24:27]
v_mfma_f32_16x16x32_bf16 a[28:31], v[172:175], v[212:215], a[28:31]
ds_read_b64_tr_b16 v[212:213], v250 offset:4096
s_waitcnt lgkmcnt(5)
v_mfma_f32_16x16x32_bf16 a[32:35], v[160:163], v[216:219], a[32:35]
ds_read_b64_tr_b16 v[214:215], v250 offset:6144
v_mfma_f32_16x16x32_bf16 a[36:39], v[164:167], v[216:219], a[36:39]
v_exp_f32 v232, v128
v_mfma_f32_16x16x32_bf16 a[40:43], v[168:171], v[216:219], a[40:43]
v_exp_f32 v233, v129
v_mfma_f32_16x16x32_bf16 a[44:47], v[172:175], v[216:219], a[44:47]
ds_read_b64_tr_b16 v[216:217], v249 offset:4608
s_waitcnt lgkmcnt(5)
v_mfma_f32_16x16x32_bf16 a[48:51], v[160:163], v[220:223], a[48:51]
ds_read_b64_tr_b16 v[218:219], v249 offset:6656
v_mfma_f32_16x16x32_bf16 a[52:55], v[164:167], v[220:223], a[52:55]
v_exp_f32 v234, v130
v_mfma_f32_16x16x32_bf16 a[56:59], v[168:171], v[220:223], a[56:59]
v_add_f32 v228, v224, v232
v_cvt_pk_bf16_f32 v176, v232, v233
v_mfma_f32_16x16x32_bf16 a[60:63], v[172:175], v[220:223], a[60:63]
ds_read_b64_tr_b16 v[220:221], v250 offset:4608
s_waitcnt lgkmcnt(5)
v_mfma_f32_16x16x32_bf16 a[64:67], v[160:163], v[208:211], a[64:67]
ds_read_b64_tr_b16 v[222:223], v250 offset:6656
v_mfma_f32_16x16x32_bf16 a[68:71], v[164:167], v[208:211], a[68:71]
v_exp_f32 v235, v131
v_mfma_f32_16x16x32_bf16 a[72:75], v[168:171], v[208:211], a[72:75]
v_add_f32 v228, v228, v233
v_add_f32 v228, v228, v234
v_mfma_f32_16x16x32_bf16 a[76:79], v[172:175], v[208:211], a[76:79]
ds_read_b128 v[208:211], v240 offset:18432
s_waitcnt lgkmcnt(5)
v_mfma_f32_16x16x32_bf16 a[80:83], v[160:163], v[212:215], a[80:83]
v_add_f32 v228, v228, v235
v_cvt_pk_bf16_f32 v177, v234, v235
v_mfma_f32_16x16x32_bf16 a[84:87], v[164:167], v[212:215], a[84:87]
v_exp_f32 v236, v132
v_mfma_f32_16x16x32_bf16 a[88:91], v[168:171], v[212:215], a[88:91]
v_exp_f32 v237, v133
v_mfma_f32_16x16x32_bf16 a[92:95], v[172:175], v[212:215], a[92:95]
ds_read_b128 v[212:215], v240 offset:18944
s_waitcnt lgkmcnt(4)
v_mfma_f32_16x16x32_bf16 a[96:99], v[160:163], v[216:219], a[96:99]
v_exp_f32 v238, v134
v_mfma_f32_16x16x32_bf16 a[100:103], v[164:167], v[216:219], a[100:103]
v_add_f32 v229, v225, v236
v_cvt_pk_bf16_f32 v180, v236, v237
v_mfma_f32_16x16x32_bf16 a[104:107], v[168:171], v[216:219], a[104:107]
v_exp_f32 v239, v135
v_mfma_f32_16x16x32_bf16 a[108:111], v[172:175], v[216:219], a[108:111]
ds_read_b128 v[216:219], v240 offset:22528
s_waitcnt lgkmcnt(3)
v_mfma_f32_16x16x32_bf16 a[112:115], v[160:163], v[220:223], a[112:115]
v_add_f32 v229, v229, v237
v_add_f32 v229, v229, v238
v_mfma_f32_16x16x32_bf16 a[116:119], v[164:167], v[220:223], a[116:119]
v_add_f32 v229, v229, v239
v_cvt_pk_bf16_f32 v181, v238, v239
v_mfma_f32_16x16x32_bf16 a[120:123], v[168:171], v[220:223], a[120:123]
v_exp_f32 v232, v136
v_mfma_f32_16x16x32_bf16 a[124:127], v[172:175], v[220:223], a[124:127]
ds_read_b128 v[220:223], v240 offset:23040
s_waitcnt lgkmcnt(2)
v_mfma_f32_16x16x32_bf16 v[144:147], v[208:211], v[0:3], v[192:195]
v_exp_f32 v233, v137
v_mfma_f32_16x16x32_bf16 v[144:147], v[212:215], v[4:7], v[144:147]
v_exp_f32 v234, v138
v_mfma_f32_16x16x32_bf16 v[148:151], v[208:211], v[32:35], v[196:199]
v_add_f32 v230, v226, v232
v_cvt_pk_bf16_f32 v184, v232, v233
v_mfma_f32_16x16x32_bf16 v[148:151], v[212:215], v[36:39], v[148:151]
v_exp_f32 v235, v139
v_mfma_f32_16x16x32_bf16 v[152:155], v[208:211], v[64:67], v[200:203]
v_add_f32 v230, v230, v233
v_add_f32 v230, v230, v234
v_mfma_f32_16x16x32_bf16 v[152:155], v[212:215], v[68:71], v[152:155]
v_add_f32 v230, v230, v235
v_cvt_pk_bf16_f32 v185, v234, v235
v_mfma_f32_16x16x32_bf16 v[156:159], v[208:211], v[96:99], v[204:207]
ds_read_b128 v[208:211], v240 offset:26624
v_mfma_f32_16x16x32_bf16 v[156:159], v[212:215], v[100:103], v[156:159]
ds_read_b128 v[212:215], v240 offset:27136
s_waitcnt lgkmcnt(2)
v_mfma_f32_16x16x32_bf16 v[144:147], v[216:219], v[8:11], v[144:147]
v_exp_f32 v236, v140
v_mfma_f32_16x16x32_bf16 v[144:147], v[220:223], v[12:15], v[144:147]
v_exp_f32 v237, v141
v_mfma_f32_16x16x32_bf16 v[148:151], v[216:219], v[40:43], v[148:151]
v_exp_f32 v238, v142
v_mfma_f32_16x16x32_bf16 v[148:151], v[220:223], v[44:47], v[148:151]
v_add_f32 v231, v227, v236
v_cvt_pk_bf16_f32 v188, v236, v237
v_mfma_f32_16x16x32_bf16 v[152:155], v[216:219], v[72:75], v[152:155]
v_exp_f32 v239, v143
v_mfma_f32_16x16x32_bf16 v[152:155], v[220:223], v[76:79], v[152:155]
v_add_f32 v231, v231, v237
v_add_f32 v231, v231, v238
v_mfma_f32_16x16x32_bf16 v[156:159], v[216:219], v[104:107], v[156:159]
ds_read_b128 v[216:219], v240 offset:30720
v_add_f32 v231, v231, v239
v_mfma_f32_16x16x32_bf16 v[156:159], v[220:223], v[108:111], v[156:159]
ds_read_b128 v[220:223], v240 offset:31232
s_waitcnt lgkmcnt(2)
v_mfma_f32_16x16x32_bf16 v[144:147], v[208:211], v[16:19], v[144:147]
v_cvt_pk_bf16_f32 v189, v238, v239
v_max3_f32 v242, v228, v229, v230
v_mfma_f32_16x16x32_bf16 v[144:147], v[212:215], v[20:23], v[144:147]
v_max_f32 v242, v242, v231
v_mfma_f32_16x16x32_bf16 v[148:151], v[208:211], v[48:51], v[148:151]
v_cmp_lt_f32 vcc, s32, v242
v_mfma_f32_16x16x32_bf16 v[148:151], v[212:215], v[52:55], v[148:151]
v_mfma_f32_16x16x32_bf16 v[152:155], v[208:211], v[80:83], v[152:155]
s_mov_b32 m0, s30
v_mfma_f32_16x16x32_bf16 v[152:155], v[212:215], v[84:87], v[152:155]
buffer_load_dwordx4 v241, s[12:15], s28 offen offset:0 sc1 lds
s_cbranch_vccnz L2_rare_site0
L2_ret0:
v_mfma_f32_16x16x32_bf16 v[156:159], v[208:211], v[112:115], v[156:159]
ds_read_b64_tr_b16 v[208:209], v249 offset:8192
v_mfma_f32_16x16x32_bf16 v[156:159], v[212:215], v[116:119], v[156:159]
ds_read_b64_tr_b16 v[210:211], v249 offset:10240
ds_read_b64_tr_b16 v[212:213], v250 offset:8192
s_waitcnt lgkmcnt(3)
v_mfma_f32_16x16x32_bf16 v[144:147], v[216:219], v[24:27], v[144:147]
ds_read_b64_tr_b16 v[214:215], v250 offset:10240
v_mfma_f32_16x16x32_bf16 v[144:147], v[220:223], v[28:31], v[144:147]
buffer_load_dwordx4 v241, s[12:15], s28 offen offset:1024 sc1 lds
v_mfma_f32_16x16x32_bf16 v[148:151], v[216:219], v[56:59], v[148:151]
v_mfma_f32_16x16x32_bf16 v[148:151], v[220:223], v[60:63], v[148:151]
v_mfma_f32_16x16x32_bf16 v[152:155], v[216:219], v[88:91], v[152:155]
v_mfma_f32_16x16x32_bf16 v[152:155], v[220:223], v[92:95], v[152:155]
buffer_load_dwordx4 v241, s[12:15], s28 offen offset:2048 sc1 lds
v_mfma_f32_16x16x32_bf16 v[156:159], v[216:219], v[120:123], v[156:159]
ds_read_b64_tr_b16 v[216:217], v249 offset:8704
v_mfma_f32_16x16x32_bf16 v[156:159], v[220:223], v[124:127], v[156:159]
ds_read_b64_tr_b16 v[218:219], v249 offset:10752
ds_read_b64_tr_b16 v[220:221], v250 offset:8704
s_waitcnt lgkmcnt(5)
v_mfma_f32_16x16x32_bf16 a[128:131], v[160:163], v[208:211], a[128:131]
ds_read_b64_tr_b16 v[222:223], v250 offset:10752
v_mfma_f32_16x16x32_bf16 a[132:135], v[164:167], v[208:211], a[132:135]
buffer_load_dwordx4 v241, s[12:15], s28 offen offset:3072 sc1 lds
v_mfma_f32_16x16x32_bf16 a[136:139], v[168:171], v[208:211], a[136:139]
s_add_u32 s28, s28, s101
s_add_u32 s30, s30, 0x4000
v_mfma_f32_16x16x32_bf16 a[140:143], v[172:175], v[208:211], a[140:143]
ds_read_b64_tr_b16 v[208:209], v249 offset:12288
s_waitcnt lgkmcnt(5)
v_mfma_f32_16x16x32_bf16 a[144:147], v[160:163], v[212:215], a[144:147]
ds_read_b64_tr_b16 v[210:211], v249 offset:14336
s_and_b32 s30, s30, 0x1ffff
v_mfma_f32_16x16x32_bf16 a[148:151], v[164:167], v[212:215], a[148:151]
s_sub_u32 s31, s31, 1
v_mfma_f32_16x16x32_bf16 a[152:155], v[168:171], v[212:215], a[152:155]
v_add_u32 v240, 0x8000, v240
v_and_b32 v240, 0x1ffff, v240
v_mfma_f32_16x16x32_bf16 a[156:159], v[172:175], v[212:215], a[156:159]
ds_read_b64_tr_b16 v[212:213], v250 offset:12288
s_waitcnt lgkmcnt(5)
v_mfma_f32_16x16x32_bf16 a[160:163], v[160:163], v[216:219], a[160:163]
ds_read_b64_tr_b16 v[214:215], v250 offset:14336
v_mfma_f32_16x16x32_bf16 a[164:167], v[164:167], v[216:219], a[164:167]
v_exp_f32 v232, v144
v_mfma_f32_16x16x32_bf16 a[168:171], v[168:171], v[216:219], a[168:171]
v_exp_f32 v233, v145
v_mfma_f32_16x16x32_bf16 a[172:175], v[172:175], v[216:219], a[172:175]
ds_read_b64_tr_b16 v[216:217], v249 offset:12800
s_waitcnt lgkmcnt(5)
v_mfma_f32_16x16x32_bf16 a[176:179], v[160:163], v[220:223], a[176:179]
ds_read_b64_tr_b16 v[218:219], v249 offset:14848
v_mfma_f32_16x16x32_bf16 a[180:183], v[164:167], v[220:223], a[180:183]
v_exp_f32 v234, v146
v_mfma_f32_16x16x32_bf16 a[184:187], v[168:171], v[220:223], a[184:187]
v_add_f32 v224, v228, v232
v_cvt_pk_bf16_f32 v178, v232, v233
v_mfma_f32_16x16x32_bf16 a[188:191], v[172:175], v[220:223], a[188:191]
ds_read_b64_tr_b16 v[220:221], v250 offset:12800
s_waitcnt lgkmcnt(5)
v_mfma_f32_16x16x32_bf16 a[192:195], v[160:163], v[208:211], a[192:195]
ds_read_b64_tr_b16 v[222:223], v250 offset:14848
v_mfma_f32_16x16x32_bf16 a[196:199], v[164:167], v[208:211], a[196:199]
s_waitcnt vmcnt(4)
s_barrier
v_mfma_f32_16x16x32_bf16 a[200:203], v[168:171], v[208:211], a[200:203]
v_exp_f32 v235, v147
v_mfma_f32_16x16x32_bf16 a[204:207], v[172:175], v[208:211], a[204:207]
ds_read_b128 v[208:211], v240 offset:0
s_waitcnt lgkmcnt(5)
v_mfma_f32_16x16x32_bf16 a[208:211], v[160:163], v[212:215], a[208:211]
v_add_f32 v224, v224, v233
v_add_f32 v224, v224, v234
v_mfma_f32_16x16x32_bf16 a[212:215], v[164:167], v[212:215], a[212:215]
v_add_f32 v224, v224, v235
v_cvt_pk_bf16_f32 v179, v234, v235
v_mfma_f32_16x16x32_bf16 a[216:219], v[168:171], v[212:215], a[216:219]
v_exp_f32 v236, v148
v_mfma_f32_16x16x32_bf16 a[220:223], v[172:175], v[212:215], a[220:223]
ds_read_b128 v[212:215], v240 offset:512
s_waitcnt lgkmcnt(4)
v_mfma_f32_16x16x32_bf16 a[224:227], v[160:163], v[216:219], a[224:227]
v_exp_f32 v237, v149
v_mfma_f32_16x16x32_bf16 a[228:231], v[164:167], v[216:219], a[228:231]
v_exp_f32 v238, v150
v_mfma_f32_16x16x32_bf16 a[232:235], v[168:171], v[216:219], a[232:235]
v_add_f32 v225, v229, v236
v_cvt_pk_bf16_f32 v182, v236, v237
v_mfma_f32_16x16x32_bf16 a[236:239], v[172:175], v[216:219], a[236:239]
ds_read_b128 v[216:219], v240 offset:4096
s_waitcnt lgkmcnt(3)
v_mfma_f32_16x16x32_bf16 a[240:243], v[160:163], v[220:223], a[240:243]
v_exp_f32 v239, v151
v_mfma_f32_16x16x32_bf16 a[244:247], v[164:167], v[220:223], a[244:247]
v_add_f32 v225, v225, v237
v_add_f32 v225, v225, v238
v_mfma_f32_16x16x32_bf16 a[248:251], v[168:171], v[220:223], a[248:251]
v_add_f32 v225, v225, v239
v_cvt_pk_bf16_f32 v183, v238, v239
v_mfma_f32_16x16x32_bf16 a[252:255], v[172:175], v[220:223], a[252:255]
ds_read_b128 v[220:223], v240 offset:4608
s_waitcnt lgkmcnt(2)
v_mfma_f32_16x16x32_bf16 v[128:131], v[208:211], v[0:3], v[192:195]
v_exp_f32 v232, v152
v_mfma_f32_16x16x32_bf16 v[128:131], v[212:215], v[4:7], v[128:131]
v_exp_f32 v233, v153
v_mfma_f32_16x16x32_bf16 v[132:135], v[208:211], v[32:35], v[196:199]
v_exp_f32 v234, v154
v_mfma_f32_16x16x32_bf16 v[132:135], v[212:215], v[36:39], v[132:135]
v_add_f32 v226, v230, v232
v_cvt_pk_bf16_f32 v186, v232, v233
v_mfma_f32_16x16x32_bf16 v[136:139], v[208:211], v[64:67], v[200:203]
v_exp_f32 v235, v155
v_mfma_f32_16x16x32_bf16 v[136:139], v[212:215], v[68:71], v[136:139]
v_add_f32 v226, v226, v233
v_add_f32 v226, v226, v234
v_mfma_f32_16x16x32_bf16 v[140:143], v[208:211], v[96:99], v[204:207]
ds_read_b128 v[208:211], v240 offset:8192
v_add_f32 v226, v226, v235
v_mfma_f32_16x16x32_bf16 v[140:143], v[212:215], v[100:103], v[140:143]
ds_read_b128 v[212:215], v240 offset:8704
s_waitcnt lgkmcnt(2)
v_mfma_f32_16x16x32_bf16 v[128:131], v[216:219], v[8:11], v[128:131]
v_cvt_pk_bf16_f32 v187, v234, v235
v_mfma_f32_16x16x32_bf16 v[128:131], v[220:223], v[12:15], v[128:131]
v_exp_f32 v236, v156
v_mfma_f32_16x16x32_bf16 v[132:135], v[216:219], v[40:43], v[132:135]
v_exp_f32 v237, v157
v_mfma_f32_16x16x32_bf16 v[132:135], v[220:223], v[44:47], v[132:135]
v_exp_f32 v238, v158
v_mfma_f32_16x16x32_bf16 v[136:139], v[216:219], v[72:75], v[136:139]
v_add_f32 v227, v231, v236
v_cvt_pk_bf16_f32 v190, v236, v237
v_mfma_f32_16x16x32_bf16 v[136:139], v[220:223], v[76:79], v[136:139]
v_exp_f32 v239, v159
v_mfma_f32_16x16x32_bf16 v[140:143], v[216:219], v[104:107], v[140:143]
ds_read_b128 v[216:219], v240 offset:12288
v_add_f32 v227, v227, v237
v_mfma_f32_16x16x32_bf16 v[140:143], v[220:223], v[108:111], v[140:143]
ds_read_b128 v[220:223], v240 offset:12800
s_waitcnt lgkmcnt(2)
v_mfma_f32_16x16x32_bf16 v[128:131], v[208:211], v[16:19], v[128:131]
v_add_f32 v227, v227, v238
v_add_f32 v227, v227, v239
v_mfma_f32_16x16x32_bf16 v[128:131], v[212:215], v[20:23], v[128:131]
v_cvt_pk_bf16_f32 v191, v238, v239
v_max3_f32 v242, v224, v225, v226
v_mfma_f32_16x16x32_bf16 v[132:135], v[208:211], v[48:51], v[132:135]
v_max_f32 v242, v242, v227
v_mfma_f32_16x16x32_bf16 v[132:135], v[212:215], v[52:55], v[132:135]
v_cmp_lt_f32 vcc, s32, v242
v_mfma_f32_16x16x32_bf16 v[136:139], v[208:211], v[80:83], v[136:139]
v_mfma_f32_16x16x32_bf16 v[136:139], v[212:215], v[84:87], v[136:139]
v_mfma_f32_16x16x32_bf16 v[140:143], v[208:211], v[112:115], v[140:143]
ds_read_b64_tr_b16 v[208:209], v249 offset:16384
s_cbranch_vccnz L2_rare_site1
L2_ret1:
v_mfma_f32_16x16x32_bf16 v[140:143], v[212:215], v[116:119], v[140:143]
ds_read_b64_tr_b16 v[210:211], v249 offset:18432
ds_read_b64_tr_b16 v[212:213], v250 offset:16384
s_waitcnt lgkmcnt(3)
v_mfma_f32_16x16x32_bf16 v[128:131], v[216:219], v[24:27], v[128:131]
ds_read_b64_tr_b16 v[214:215], v250 offset:18432
v_mfma_f32_16x16x32_bf16 v[128:131], v[220:223], v[28:31], v[128:131]
v_mfma_f32_16x16x32_bf16 v[132:135], v[216:219], v[56:59], v[132:135]
s_cmp_eq_u32 s31, 0
v_mfma_f32_16x16x32_bf16 v[132:135], v[220:223], v[60:63], v[132:135]
v_mfma_f32_16x16x32_bf16 v[136:139], v[216:219], v[88:91], v[136:139]
v_mfma_f32_16x16x32_bf16 v[136:139], v[220:223], v[92:95], v[136:139]
v_mfma_f32_16x16x32_bf16 v[140:143], v[216:219], v[120:123], v[140:143]
ds_read_b64_tr_b16 v[216:217], v249 offset:16896
v_mfma_f32_16x16x32_bf16 v[140:143], v[220:223], v[124:127], v[140:143]
ds_read_b64_tr_b16 v[218:219], v249 offset:18944
ds_read_b64_tr_b16 v[220:221], v250 offset:16896
ds_read_b64_tr_b16 v[222:223], v250 offset:18944
s_cbranch_scc1 L2_x1
L2_loop1:
s_waitcnt lgkmcnt(6)
v_mfma_f32_16x16x32_bf16 a[0:3], v[176:179], v[208:211], a[0:3]
v_mfma_f32_16x16x32_bf16 a[4:7], v[180:183], v[208:211], a[4:7]
v_mfma_f32_16x16x32_bf16 a[8:11], v[184:187], v[208:211], a[8:11]
v_mfma_f32_16x16x32_bf16 a[12:15], v[188:191], v[208:211], a[12:15]
ds_read_b64_tr_b16 v[208:209], v249 offset:20480
s_waitcnt lgkmcnt(5)
v_mfma_f32_16x16x32_bf16 a[16:19], v[176:179], v[212:215], a[16:19]
ds_read_b64_tr_b16 v[210:211], v249 offset:22528
v_mfma_f32_16x16x32_bf16 a[20:23], v[180:183], v[212:215], a[20:23]
v_mfma_f32_16x16x32_bf16 a[24:27], v[184:187], v[212:215], a[24:27]
v_mfma_f32_16x16x32_bf16 a[28:31], v[188:191], v[212:215], a[28:31]
ds_read_b64_tr_b16 v[212:213], v250 offset:20480
s_waitcnt lgkmcnt(5)
v_mfma_f32_16x16x32_bf16 a[32:35], v[176:179], v[216:219], a[32:35]
ds_read_b64_tr_b16 v[214:215], v250 offset:22528
v_mfma_f32_16x16x32_bf16 a[36:39], v[180:183], v[216:219], a[36:39]
v_exp_f32 v232, v128
v_mfma_f32_16x16x32_bf16 a[40:43], v[184:187], v[216:219], a[40:43]
v_exp_f32 v233, v129
v_mfma_f32_16x16x32_bf16 a[44:47], v[188:191], v[216:219], a[44:47]
ds_read_b64_tr_b16 v[216:217], v249 offset:20992
s_waitcnt lgkmcnt(5)
v_mfma_f32_16x16x32_bf16 a[48:51], v[176:179], v[220:223], a[48:51]
ds_read_b64_tr_b16 v[218:219], v249 offset:23040
v_mfma_f32_16x16x32_bf16 a[52:55], v[180:183], v[220:223], a[52:55]
v_exp_f32 v234, v130
v_mfma_f32_16x16x32_bf16 a[56:59], v[184:187], v[220:223], a[56:59]
v_add_f32 v228, v224, v232
v_cvt_pk_bf16_f32 v160, v232, v233
v_mfma_f32_16x16x32_bf16 a[60:63], v[188:191], v[220:223], a[60:63]
ds_read_b64_tr_b16 v[220:221], v250 offset:20992
s_waitcnt lgkmcnt(5)
v_mfma_f32_16x16x32_bf16 a[64:67], v[176:179], v[208:211], a[64:67]
ds_read_b64_tr_b16 v[222:223], v250 offset:23040
v_mfma_f32_16x16x32_bf16 a[68:71], v[180:183], v[208:211], a[68:71]
v_exp_f32 v235, v131
v_mfma_f32_16x16x32_bf16 a[72:75], v[184:187], v[208:211], a[72:75]
v_add_f32 v228, v228, v233
v_add_f32 v228, v228, v234
v_mfma_f32_16x16x32_bf16 a[76:79], v[188:191], v[208:211], a[76:79]
ds_read_b128 v[208:211], v240 offset:2048
s_waitcnt lgkmcnt(5)
v_mfma_f32_16x16x32_bf16 a[80:83], v[176:179], v[212:215], a[80:83]
v_add_f32 v228, v228, v235
v_cvt_pk_bf16_f32 v161, v234, v235
v_mfma_f32_16x16x32_bf16 a[84:87], v[180:183], v[212:215], a[84:87]
v_exp_f32 v236, v132
v_mfma_f32_16x16x32_bf16 a[88:91], v[184:187], v[212:215], a[88:91]
v_exp_f32 v237, v133
v_mfma_f32_16x16x32_bf16 a[92:95], v[188:191], v[212:215], a[92:95]
ds_read_b128 v[212:215], v240 offset:2560
s_waitcnt lgkmcnt(4)
v_mfma_f32_16x16x32_bf16 a[96:99], v[176:179], v[216:219], a[96:99]
v_exp_f32 v238, v134
v_mfma_f32_16x16x32_bf16 a[100:103], v[180:183], v[216:219], a[100:103]
v_add_f32 v229, v225, v236
v_cvt_pk_bf16_f32 v164, v236, v237
v_mfma_f32_16x16x32_bf16 a[104:107], v[184:187], v[216:219], a[104:107]
v_exp_f32 v239, v135
v_mfma_f32_16x16x32_bf16 a[108:111], v[188:191], v[216:219], a[108:111]
ds_read_b128 v[216:219], v240 offset:6144
s_waitcnt lgkmcnt(3)
v_mfma_f32_16x16x32_bf16 a[112:115], v[176:179], v[220:223], a[112:115]
v_add_f32 v229, v229, v237
v_add_f32 v229, v229, v238
v_mfma_f32_16x16x32_bf16 a[116:119], v[180:183], v[220:223], a[116:119]
v_add_f32 v229, v229, v239
v_cvt_pk_bf16_f32 v165, v238, v239
v_mfma_f32_16x16x32_bf16 a[120:123], v[184:187], v[220:223], a[120:123]
v_exp_f32 v232, v136
v_mfma_f32_16x16x32_bf16 a[124:127], v[188:191], v[220:223], a[124:127]
ds_read_b128 v[220:223], v240 offset:6656
s_waitcnt lgkmcnt(2)
v_mfma_f32_16x16x32_bf16 v[144:147], v[208:211], v[0:3], v[192:195]
v_exp_f32 v233, v137
v_mfma_f32_16x16x32_bf16 v[144:147], v[212:215], v[4:7], v[144:147]
v_exp_f32 v234, v138
v_mfma_f32_16x16x32_bf16 v[148:151], v[208:211], v[32:35], v[196:199]
v_add_f32 v230, v226, v232
v_cvt_pk_bf16_f32 v168, v232, v233
v_mfma_f32_16x16x32_bf16 v[148:151], v[212:215], v[36:39], v[148:151]
v_exp_f32 v235, v139
v_mfma_f32_16x16x32_bf16 v[152:155], v[208:211], v[64:67], v[200:203]
v_add_f32 v230, v230, v233
v_add_f32 v230, v230, v234
v_mfma_f32_16x16x32_bf16 v[152:155], v[212:215], v[68:71], v[152:155]
v_add_f32 v230, v230, v235
v_cvt_pk_bf16_f32 v169, v234, v235
v_mfma_f32_16x16x32_bf16 v[156:159], v[208:211], v[96:99], v[204:207]
ds_read_b128 v[208:211], v240 offset:10240
v_mfma_f32_16x16x32_bf16 v[156:159], v[212:215], v[100:103], v[156:159]
ds_read_b128 v[212:215], v240 offset:10752
s_waitcnt lgkmcnt(2)
v_mfma_f32_16x16x32_bf16 v[144:147], v[216:219], v[8:11], v[144:147]
v_exp_f32 v236, v140
v_mfma_f32_16x16x32_bf16 v[144:147], v[220:223], v[12:15], v[144:147]
v_exp_f32 v237, v141
v_mfma_f32_16x16x32_bf16 v[148:151], v[216:219], v[40:43], v[148:151]
v_exp_f32 v238, v142
v_mfma_f32_16x16x32_bf16 v[148:151], v[220:223], v[44:47], v[148:151]
v_add_f32 v231, v227, v236
v_cvt_pk_bf16_f32 v172, v236, v237
v_mfma_f32_16x16x32_bf16 v[152:155], v[216:219], v[72:75], v[152:155]
v_exp_f32 v239, v143
v_mfma_f32_16x16x32_bf16 v[152:155], v[220:223], v[76:79], v[152:155]
v_add_f32 v231, v231, v237
v_add_f32 v231, v231, v238
v_mfma_f32_16x16x32_bf16 v[156:159], v[216:219], v[104:107], v[156:159]
ds_read_b128 v[216:219], v240 offset:14336
v_add_f32 v231, v231, v239
v_mfma_f32_16x16x32_bf16 v[156:159], v[220:223], v[108:111], v[156:159]
ds_read_b128 v[220:223], v240 offset:14848
s_waitcnt lgkmcnt(2)
v_mfma_f32_16x16x32_bf16 v[144:147], v[208:211], v[16:19], v[144:147]
v_cvt_pk_bf16_f32 v173, v238, v239
v_max3_f32 v242, v228, v229, v230
v_mfma_f32_16x16x32_bf16 v[144:147], v[212:215], v[20:23], v[144:147]
v_max_f32 v242, v242, v231
v_mfma_f32_16x16x32_bf16 v[148:151], v[208:211], v[48:51], v[148:151]
v_cmp_lt_f32 vcc, s32, v242
v_mfma_f32_16x16x32_bf16 v[148:151], v[212:215], v[52:55], v[148:151]
v_mfma_f32_16x16x32_bf16 v[152:155], v[208:211], v[80:83], v[152:155]
s_mov_b32 m0, s30
v_mfma_f32_16x16x32_bf16 v[152:155], v[212:215], v[84:87], v[152:155]
buffer_load_dwordx4 v241, s[12:15], s28 offen offset:0 sc1 lds
s_cbranch_vccnz L2_rare_site2
L2_ret2:
v_mfma_f32_16x16x32_bf16 v[156:159], v[208:211], v[112:115], v[156:159]
ds_read_b64_tr_b16 v[208:209], v249 offset:24576
v_mfma_f32_16x16x32_bf16 v[156:159], v[212:215], v[116:119], v[156:159]
ds_read_b64_tr_b16 v[210:211], v249 offset:26624
ds_read_b64_tr_b16 v[212:213], v250 offset:24576
s_waitcnt lgkmcnt(3)
v_mfma_f32_16x16x32_bf16 v[144:147], v[216:219], v[24:27], v[144:147]
ds_read_b64_tr_b16 v[214:215], v250 offset:26624
v_mfma_f32_16x16x32_bf16 v[144:147], v[220:223], v[28:31], v[144:147]
buffer_load_dwordx4 v241, s[12:15], s28 offen offset:1024 sc1 lds
v_mfma_f32_16x16x32_bf16 v[148:151], v[216:219], v[56:59], v[148:151]
v_mfma_f32_16x16x32_bf16 v[148:151], v[220:223], v[60:63], v[148:151]
v_mfma_f32_16x16x32_bf16 v[152:155], v[216:219], v[88:91], v[152:155]
v_mfma_f32_16x16x32_bf16 v[152:155], v[220:223], v[92:95], v[152:155]
buffer_load_dwordx4 v241, s[12:15], s28 offen offset:2048 sc1 lds
v_mfma_f32_16x16x32_bf16 v[156:159], v[216:219], v[120:123], v[156:159]
ds_read_b64_tr_b16 v[216:217], v249 offset:25088
v_mfma_f32_16x16x32_bf16 v[156:159], v[220:223], v[124:127], v[156:159]
ds_read_b64_tr_b16 v[218:219], v249 offset:27136
ds_read_b64_tr_b16 v[220:221], v250 offset:25088
s_waitcnt lgkmcnt(5)
v_mfma_f32_16x16x32_bf16 a[128:131], v[176:179], v[208:211], a[128:131]
ds_read_b64_tr_b16 v[222:223], v250 offset:27136
v_mfma_f32_16x16x32_bf16 a[132:135], v[180:183], v[208:211], a[132:135]
buffer_load_dwordx4 v241, s[12:15], s28 offen offset:3072 sc1 lds
v_mfma_f32_16x16x32_bf16 a[136:139], v[184:187], v[208:211], a[136:139]
s_add_u32 s28, s28, s101
s_add_u32 s30, s30, 0x4000
v_mfma_f32_16x16x32_bf16 a[140:143], v[188:191], v[208:211], a[140:143]
ds_read_b64_tr_b16 v[208:209], v249 offset:28672
s_waitcnt lgkmcnt(5)
v_mfma_f32_16x16x32_bf16 a[144:147], v[176:179], v[212:215], a[144:147]
ds_read_b64_tr_b16 v[210:211], v249 offset:30720
s_and_b32 s30, s30, 0x1ffff
v_mfma_f32_16x16x32_bf16 a[148:151], v[180:183], v[212:215], a[148:151]
s_sub_u32 s31, s31, 1
v_mfma_f32_16x16x32_bf16 a[152:155], v[184:187], v[212:215], a[152:155]
v_mfma_f32_16x16x32_bf16 a[156:159], v[188:191], v[212:215], a[156:159]
ds_read_b64_tr_b16 v[212:213], v250 offset:28672
s_waitcnt lgkmcnt(5)
v_mfma_f32_16x16x32_bf16 a[160:163], v[176:179], v[216:219], a[160:163]
ds_read_b64_tr_b16 v[214:215], v250 offset:30720
v_mfma_f32_16x16x32_bf16 a[164:167], v[180:183], v[216:219], a[164:167]
v_exp_f32 v232, v144
v_mfma_f32_16x16x32_bf16 a[168:171], v[184:187], v[216:219], a[168:171]
v_exp_f32 v233, v145
v_mfma_f32_16x16x32_bf16 a[172:175], v[188:191], v[216:219], a[172:175]
ds_read_b64_tr_b16 v[216:217], v249 offset:29184
s_waitcnt lgkmcnt(5)
v_mfma_f32_16x16x32_bf16 a[176:179], v[176:179], v[220:223], a[176:179]
ds_read_b64_tr_b16 v[218:219], v249 offset:31232
v_mfma_f32_16x16x32_bf16 a[180:183], v[180:183], v[220:223], a[180:183]
v_exp_f32 v234, v146
v_mfma_f32_16x16x32_bf16 a[184:187], v[184:187], v[220:223], a[184:187]
v_add_f32 v224, v228, v232
v_cvt_pk_bf16_f32 v162, v232, v233
v_mfma_f32_16x16x32_bf16 a[188:191], v[188:191], v[220:223], a[188:191]
ds_read_b64_tr_b16 v[220:221], v250 offset:29184
s_waitcnt lgkmcnt(5)
v_mfma_f32_16x16x32_bf16 a[192:195], v[176:179], v[208:211], a[192:195]
ds_read_b64_tr_b16 v[222:223], v250 offset:31232
v_mfma_f32_16x16x32_bf16 a[196:199], v[180:183], v[208:211], a[196:199]
s_waitcnt vmcnt(4)
s_barrier
v_mfma_f32_16x16x32_bf16 a[200:203], v[184:187], v[208:211], a[200:203]
v_exp_f32 v235, v147
v_mfma_f32_16x16x32_bf16 a[204:207], v[188:191], v[208:211], a[204:207]
ds_read_b128 v[208:211], v240 offset:16384
s_waitcnt lgkmcnt(5)
v_mfma_f32_16x16x32_bf16 a[208:211], v[176:179], v[212:215], a[208:211]
v_add_u32 v249, 0x8000, v249
v_and_b32 v249, 0x1ffff, v249
v_mfma_f32_16x16x32_bf16 a[212:215], v[180:183], v[212:215], a[212:215]
v_xor_b32 v250, 32, v249
v_add_f32 v224, v224, v233
v_mfma_f32_16x16x32_bf16 a[216:219], v[184:187], v[212:215], a[216:219]
v_add_f32 v224, v224, v234
v_add_f32 v224, v224, v235
v_mfma_f32_16x16x32_bf16 a[220:223], v[188:191], v[212:215], a[220:223]
ds_read_b128 v[212:215], v240 offset:16896
s_waitcnt lgkmcnt(4)
v_mfma_f32_16x16x32_bf16 a[224:227], v[176:179], v[216:219], a[224:227]
v_cvt_pk_bf16_f32 v163, v234, v235
v_mfma_f32_16x16x32_bf16 a[228:231], v[180:183], v[216:219], a[228:231]
v_exp_f32 v236, v148
v_mfma_f32_16x16x32_bf16 a[232:235], v[184:187], v[216:219], a[232:235]
v_exp_f32 v237, v149
v_mfma_f32_16x16x32_bf16 a[236:239], v[188:191], v[216:219], a[236:239]
ds_read_b128 v[216:219], v240 offset:20480
s_waitcnt lgkmcnt(3)
v_mfma_f32_16x16x32_bf16 a[240:243], v[176:179], v[220:223], a[240:243]
v_exp_f32 v238, v150
v_mfma_f32_16x16x32_bf16 a[244:247], v[180:183], v[220:223], a[244:247]
v_add_f32 v225, v229, v236
v_cvt_pk_bf16_f32 v166, v236, v237
v_mfma_f32_16x16x32_bf16 a[248:251], v[184:187], v[220:223], a[248:251]
v_exp_f32 v239, v151
v_mfma_f32_16x16x32_bf16 a[252:255], v[188:191], v[220:223], a[252:255]
ds_read_b128 v[220:223], v240 offset:20992
s_waitcnt lgkmcnt(2)
v_mfma_f32_16x16x32_bf16 v[128:131], v[208:211], v[0:3], v[192:195]
v_add_f32 v225, v225, v237
v_add_f32 v225, v225, v238
v_mfma_f32_16x16x32_bf16 v[128:131], v[212:215], v[4:7], v[128:131]
v_add_f32 v225, v225, v239
v_cvt_pk_bf16_f32 v167, v238, v239
v_mfma_f32_16x16x32_bf16 v[132:135], v[208:211], v[32:35], v[196:199]
v_exp_f32 v232, v152
v_mfma_f32_16x16x32_bf16 v[132:135], v[212:215], v[36:39], v[132:135]
v_exp_f32 v233, v153
v_mfma_f32_16x16x32_bf16 v[136:139], v[208:211], v[64:67], v[200:203]
v_exp_f32 v234, v154
v_mfma_f32_16x16x32_bf16 v[136:139], v[212:215], v[68:71], v[136:139]
v_add_f32 v226, v230, v232
v_cvt_pk_bf16_f32 v170, v232, v233
v_mfma_f32_16x16x32_bf16 v[140:143], v[208:211], v[96:99], v[204:207]
ds_read_b128 v[208:211], v240 offset:24576
v_mfma_f32_16x16x32_bf16 v[140:143], v[212:215], v[100:103], v[140:143]
ds_read_b128 v[212:215], v240 offset:25088
s_waitcnt lgkmcnt(2)
v_mfma_f32_16x16x32_bf16 v[128:131], v[216:219], v[8:11], v[128:131]
v_exp_f32 v235, v155
v_mfma_f32_16x16x32_bf16 v[128:131], v[220:223], v[12:15], v[128:131]
v_add_f32 v226, v226, v233
v_add_f32 v226, v226, v234
v_mfma_f32_16x16x32_bf16 v[132:135], v[216:219], v[40:43], v[132:135]
v_add_f32 v226, v226, v235
v_cvt_pk_bf16_f32 v171, v234, v235
v_mfma_f32_16x16x32_bf16 v[132:135], v[220:223], v[44:47], v[132:135]
v_exp_f32 v236, v156
v_mfma_f32_16x16x32_bf16 v[136:139], v[216:219], v[72:75], v[136:139]
v_exp_f32 v237, v157
v_mfma_f32_16x16x32_bf16 v[136:139], v[220:223], v[76:79], v[136:139]
v_exp_f32 v238, v158
v_mfma_f32_16x16x32_bf16 v[140:143], v[216:219], v[104:107], v[140:143]
ds_read_b128 v[216:219], v240 offset:28672
v_add_f32 v227, v231, v236
v_mfma_f32_16x16x32_bf16 v[140:143], v[220:223], v[108:111], v[140:143]
ds_read_b128 v[220:223], v240 offset:29184
s_waitcnt lgkmcnt(2)
v_mfma_f32_16x16x32_bf16 v[128:131], v[208:211], v[16:19], v[128:131]
v_cvt_pk_bf16_f32 v174, v236, v237
v_mfma_f32_16x16x32_bf16 v[128:131], v[212:215], v[20:23], v[128:131]
v_exp_f32 v239, v159
v_mfma_f32_16x16x32_bf16 v[132:135], v[208:211], v[48:51], v[132:135]
v_add_f32 v227, v227, v237
v_add_f32 v227, v227, v238
v_mfma_f32_16x16x32_bf16 v[132:135], v[212:215], v[52:55], v[132:135]
v_add_f32 v227, v227, v239
v_cvt_pk_bf16_f32 v175, v238, v239
v_mfma_f32_16x16x32_bf16 v[136:139], v[208:211], v[80:83], v[136:139]
v_max3_f32 v242, v224, v225, v226
v_mfma_f32_16x16x32_bf16 v[136:139], v[212:215], v[84:87], v[136:139]
v_max_f32 v242, v242, v227
v_mfma_f32_16x16x32_bf16 v[140:143], v[208:211], v[112:115], v[140:143]
ds_read_b64_tr_b16 v[208:209], v249 offset:0
v_cmp_lt_f32 vcc, s32, v242
v_mfma_f32_16x16x32_bf16 v[140:143], v[212:215], v[116:119], v[140:143]
ds_read_b64_tr_b16 v[210:211], v249 offset:2048
ds_read_b64_tr_b16 v[212:213], v250 offset:0
s_waitcnt lgkmcnt(3)
v_mfma_f32_16x16x32_bf16 v[128:131], v[216:219], v[24:27], v[128:131]
ds_read_b64_tr_b16 v[214:215], v250 offset:2048
v_mfma_f32_16x16x32_bf16 v[128:131], v[220:223], v[28:31], v[128:131]
s_cbranch_vccnz L2_rare_site3
L2_ret3:
v_mfma_f32_16x16x32_bf16 v[132:135], v[216:219], v[56:59], v[132:135]
s_cmp_eq_u32 s31, 0
v_mfma_f32_16x16x32_bf16 v[132:135], v[220:223], v[60:63], v[132:135]
v_mfma_f32_16x16x32_bf16 v[136:139], v[216:219], v[88:91], v[136:139]
v_mfma_f32_16x16x32_bf16 v[136:139], v[220:223], v[92:95], v[136:139]
v_mfma_f32_16x16x32_bf16 v[140:143], v[216:219], v[120:123], v[140:143]
ds_read_b64_tr_b16 v[216:217], v249 offset:512
v_mfma_f32_16x16x32_bf16 v[140:143], v[220:223], v[124:127], v[140:143]
ds_read_b64_tr_b16 v[218:219], v249 offset:2560
ds_read_b64_tr_b16 v[220:221], v250 offset:512
ds_read_b64_tr_b16 v[222:223], v250 offset:2560
s_cbranch_scc0 L2_loop
s_cmp_eq_u32 s100, 0
s_cbranch_scc1 L2_tail_0
s_mov_b32 s3, 0
s_branch L2_ev
L2_x1:
s_cmp_eq_u32 s100, 0
s_cbranch_scc1 L2_tail_1
s_mov_b32 s3, 1
L2_ev:
s_sub_u32 s100, s100, 1
s_mov_b32 s31, 1
v_mov_b32 v251, 0x20000
s_cmp_eq_u32 s100, 0
s_cbranch_scc1 L2_ev3
s_cmp_lg_u32 s34, 0
s_cbranch_scc1 L2_evr
s_cmp_eq_u32 s100, 1
s_cbranch_scc1 L2_ev2
v_mov_b32 v252, s98
v_mov_b32 v253, s99
s_mov_b64 exec, 1
buffer_atomic_swap_x2 v[252:253], off, s[16:19], s49 sc0 sc1
s_mov_b64 exec, -1
s_branch L2_evr
L2_ev2:
s_mov_b64 exec, 1
ds_write_b64 v251, v[252:253]
s_mov_b64 exec, -1
s_branch L2_evr
L2_ev3:
ds_read_b64 v[252:253], v251
s_waitcnt lgkmcnt(0)
v_cmp_eq_u64 vcc, s[98:99], v[252:253]
s_nop 1
s_cmp_eq_u64 vcc, 0
s_cselect_b32 s31, s39, s35
L2_evr:
s_cmp_eq_u32 s3, 0
s_cbranch_scc1 L2_loop
s_branch L2_loop1
L2_tail_0:
s_waitcnt lgkmcnt(6)
v_mfma_f32_16x16x32_bf16 a[0:3], v[160:163], v[208:211], a[0:3]
s_mov_b32 m0, s30
v_mfma_f32_16x16x32_bf16 a[4:7], v[164:167], v[208:211], a[4:7]
buffer_load_dwordx4 v241, s[12:15], s28 offen offset:0 sc1 lds
v_add_u32 v253, s50, v248
v_mfma_f32_16x16x32_bf16 a[8:11], v[168:171], v[208:211], a[8:11]
buffer_load_dwordx4 v241, s[12:15], s28 offen offset:1024 sc1 lds
v_mfma_f32_16x16x32_bf16 a[12:15], v[172:175], v[208:211], a[12:15]
ds_read_b128 v[208:211], v240 offset:18432
s_waitcnt lgkmcnt(5)
buffer_load_dwordx4 v241, s[12:15], s28 offen offset:2048 sc1 lds
v_mfma_f32_16x16x32_bf16 a[16:19], v[160:163], v[212:215], a[16:19]
buffer_load_dwordx4 v241, s[12:15], s28 offen offset:3072 sc1 lds
v_mfma_f32_16x16x32_bf16 a[20:23], v[164:167], v[212:215], a[20:23]
s_add_u32 s28, s28, s101
s_add_u32 s30, s30, 0x4000
s_and_b32 s30, s30, 0x1ffff
v_mfma_f32_16x16x32_bf16 a[24:27], v[168:171], v[212:215], a[24:27]
s_mov_b32 m0, s30
v_mfma_f32_16x16x32_bf16 a[28:31], v[172:175], v[212:215], a[28:31]
ds_read_b128 v[212:215], v240 offset:18944
s_waitcnt lgkmcnt(4)
buffer_load_dwordx4 v241, s[12:15], s28 offen offset:0 sc1 lds
v_mfma_f32_16x16x32_bf16 a[32:35], v[160:163], v[216:219], a[32:35]
buffer_load_dwordx4 v241, s[12:15], s28 offen offset:1024 sc1 lds
v_mfma_f32_16x16x32_bf16 a[36:39], v[164:167], v[216:219], a[36:39]
buffer_load_dwordx4 v241, s[12:15], s28 offen offset:2048 sc1 lds
v_mfma_f32_16x16x32_bf16 a[40:43], v[168:171], v[216:219], a[40:43]
buffer_load_dwordx4 v241, s[12:15], s28 offen offset:3072 sc1 lds
v_mfma_f32_16x16x32_bf16 a[44:47], v[172:175], v[216:219], a[44:47]
ds_read_b128 v[216:219], v240 offset:22528
s_waitcnt lgkmcnt(3)
v_mfma_f32_16x16x32_bf16 a[48:51], v[160:163], v[220:223], a[48:51]
v_exp_f32 v232, v128
s_and_b32 s30, s30, 0x1c000
v_mfma_f32_16x16x32_bf16 a[52:55], v[164:167], v[220:223], a[52:55]
v_add_u32 v251, 0x8000, v240
v_and_b32 v251, 0x1ffff, v251
s_add_u32 s28, s30, 0x4000
v_mfma_f32_16x16x32_bf16 a[56:59], v[168:171], v[220:223], a[56:59]
v_add_u32 v252, 0x10000, v240
v_and_b32 v252, 0x1ffff, v252
s_and_b32 s28, s28, 0x1ffff
v_mfma_f32_16x16x32_bf16 a[60:63], v[172:175], v[220:223], a[60:63]
ds_read_b128 v[220:223], v240 offset:23040
s_waitcnt lgkmcnt(2)
s_add_u32 s30, s30, 0x8000
v_mfma_f32_16x16x32_bf16 v[144:147], v[208:211], v[0:3], v[192:195]
ds_write_b128 v253, v[160:163] offset:0
s_and_b32 s30, s30, 0x1ffff
s_mul_i32 s31, s34, 6144
v_mfma_f32_16x16x32_bf16 v[144:147], v[212:215], v[4:7], v[144:147]
ds_write_b128 v253, v[164:167] offset:1024
s_add_u32 s31, s31, s30
s_lshl_b32 s3, s34, 10
v_mfma_f32_16x16x32_bf16 v[148:151], v[208:211], v[32:35], v[196:199]
ds_write_b128 v253, v[168:171] offset:2048
s_add_u32 s28, s28, s3
s_add_u32 s3, s3, 24576
v_mfma_f32_16x16x32_bf16 v[148:151], v[212:215], v[36:39], v[148:151]
ds_write_b128 v253, v[172:175] offset:3072
s_add_u32 s30, s30, s3
v_lshrrev_b32 v241, 4, v248
v_mfma_f32_16x16x32_bf16 v[152:155], v[208:211], v[64:67], v[200:203]
v_exp_f32 v233, v129
v_and_b32 v241, 0x30, v241
v_mfma_f32_16x16x32_bf16 v[152:155], v[212:215], v[68:71], v[152:155]
v_exp_f32 v234, v130
v_xor_b32 v241, v241, v248
v_mfma_f32_16x16x32_bf16 v[156:159], v[208:211], v[96:99], v[204:207]
ds_read_b128 v[208:211], v240 offset:26624
v_add_f32 v228, v224, v232
v_mfma_f32_16x16x32_bf16 v[156:159], v[212:215], v[100:103], v[156:159]
ds_read_b128 v[212:215], v240 offset:27136
s_waitcnt lgkmcnt(2)
v_mfma_f32_16x16x32_bf16 v[144:147], v[216:219], v[8:11], v[144:147]
v_cvt_pk_bf16_f32 v176, v232, v233
v_and_b32 v243, 0x380, v248
v_mad_u32_u24 v241, v243, 3, v241
v_mfma_f32_16x16x32_bf16 v[144:147], v[220:223], v[12:15], v[144:147]
v_exp_f32 v235, v131
v_mfma_f32_16x16x32_bf16 v[148:151], v[216:219], v[40:43], v[148:151]
v_add_f32 v228, v228, v233
v_add_f32 v228, v228, v234
v_mfma_f32_16x16x32_bf16 v[148:151], v[220:223], v[44:47], v[148:151]
v_add_f32 v228, v228, v235
v_cvt_pk_bf16_f32 v177, v234, v235
v_mfma_f32_16x16x32_bf16 v[152:155], v[216:219], v[72:75], v[152:155]
v_exp_f32 v236, v132
v_mfma_f32_16x16x32_bf16 v[152:155], v[220:223], v[76:79], v[152:155]
v_exp_f32 v237, v133
v_mfma_f32_16x16x32_bf16 v[156:159], v[216:219], v[104:107], v[156:159]
ds_read_b128 v[216:219], v240 offset:30720
v_mfma_f32_16x16x32_bf16 v[156:159], v[220:223], v[108:111], v[156:159]
ds_read_b128 v[220:223], v240 offset:31232
s_waitcnt lgkmcnt(2)
v_mfma_f32_16x16x32_bf16 v[144:147], v[208:211], v[16:19], v[144:147]
v_exp_f32 v238, v134
v_mfma_f32_16x16x32_bf16 v[144:147], v[212:215], v[20:23], v[144:147]
s_waitcnt vmcnt(8)
s_barrier
v_mfma_f32_16x16x32_bf16 v[148:151], v[208:211], v[48:51], v[148:151]
v_add_f32 v229, v225, v236
v_cvt_pk_bf16_f32 v180, v236, v237
v_mfma_f32_16x16x32_bf16 v[148:151], v[212:215], v[52:55], v[148:151]
v_exp_f32 v239, v135
v_mfma_f32_16x16x32_bf16 v[152:155], v[208:211], v[80:83], v[152:155]
v_add_f32 v229, v229, v237
v_add_f32 v229, v229, v238
v_mfma_f32_16x16x32_bf16 v[152:155], v[212:215], v[84:87], v[152:155]
v_add_f32 v229, v229, v239
v_cvt_pk_bf16_f32 v181, v238, v239
v_mfma_f32_16x16x32_bf16 v[156:159], v[208:211], v[112:115], v[156:159]
ds_read_b128 v[208:211], v251 offset:0
s_add_u32 m0, s31, 0
v_mfma_f32_16x16x32_bf16 v[156:159], v[212:215], v[116:119], v[156:159]
ds_read_b128 v[212:215], v251 offset:512
s_waitcnt lgkmcnt(2)
v_mfma_f32_16x16x32_bf16 v[144:147], v[216:219], v[24:27], v[144:147]
v_exp_f32 v232, v136
v_mfma_f32_16x16x32_bf16 v[144:147], v[220:223], v[28:31], v[144:147]
v_exp_f32 v233, v137
v_mfma_f32_16x16x32_bf16 v[148:151], v[216:219], v[56:59], v[148:151]
v_exp_f32 v234, v138
v_mfma_f32_16x16x32_bf16 v[148:151], v[220:223], v[60:63], v[148:151]
v_add_f32 v230, v226, v232
v_cvt_pk_bf16_f32 v184, v232, v233
v_mfma_f32_16x16x32_bf16 v[152:155], v[216:219], v[88:91], v[152:155]
v_exp_f32 v235, v139
v_mfma_f32_16x16x32_bf16 v[152:155], v[220:223], v[92:95], v[152:155]
v_add_f32 v230, v230, v233
v_add_f32 v230, v230, v234
v_mfma_f32_16x16x32_bf16 v[156:159], v[216:219], v[120:123], v[156:159]
ds_read_b128 v[216:219], v251 offset:4096
v_add_f32 v230, v230, v235
v_mfma_f32_16x16x32_bf16 v[156:159], v[220:223], v[124:127], v[156:159]
ds_read_b128 v[220:223], v251 offset:4608
s_waitcnt lgkmcnt(2)
v_cvt_pk_bf16_f32 v185, v234, v235
v_exp_f32 v236, v140
v_exp_f32 v237, v141
v_exp_f32 v238, v142
v_add_f32 v231, v227, v236
v_cvt_pk_bf16_f32 v188, v236, v237
v_exp_f32 v239, v143
v_add_f32 v231, v231, v237
v_add_f32 v231, v231, v238
v_add_f32 v231, v231, v239
v_cvt_pk_bf16_f32 v189, v238, v239
v_max3_f32 v242, v228, v229, v230
v_max_f32 v242, v242, v231
v_cmp_lt_f32 vcc, s32, v242
s_cbranch_vccnz L2_rare_site4
L2_ret4:
v_mfma_f32_16x16x32_bf16 v[128:131], v[208:211], v[0:3], v[192:195]
buffer_load_dwordx4 v241, s[8:11], s6 offen lds
s_add_u32 m0, s31, 2048
v_mfma_f32_16x16x32_bf16 v[128:131], v[212:215], v[4:7], v[128:131]
v_exp_f32 v232, v144
v_mfma_f32_16x16x32_bf16 v[132:135], v[208:211], v[32:35], v[196:199]
v_exp_f32 v233, v145
v_mfma_f32_16x16x32_bf16 v[132:135], v[212:215], v[36:39], v[132:135]
v_exp_f32 v234, v146
v_add_f32 v224, v228, v232
v_mfma_f32_16x16x32_bf16 v[136:139], v[208:211], v[64:67], v[200:203]
v_cvt_pk_bf16_f32 v178, v232, v233
v_exp_f32 v235, v147
v_mfma_f32_16x16x32_bf16 v[136:139], v[212:215], v[68:71], v[136:139]
v_add_f32 v224, v224, v233
v_add_f32 v224, v224, v234
v_add_f32 v224, v224, v235
v_mfma_f32_16x16x32_bf16 v[140:143], v[208:211], v[96:99], v[204:207]
ds_read_b128 v[208:211], v251 offset:8192
v_cvt_pk_bf16_f32 v179, v234, v235
v_mfma_f32_16x16x32_bf16 v[140:143], v[212:215], v[100:103], v[140:143]
ds_read_b128 v[212:215], v251 offset:8704
s_waitcnt lgkmcnt(2)
v_mfma_f32_16x16x32_bf16 v[128:131], v[216:219], v[8:11], v[128:131]
v_exp_f32 v236, v148
v_mfma_f32_16x16x32_bf16 v[128:131], v[220:223], v[12:15], v[128:131]
v_exp_f32 v237, v149
v_mfma_f32_16x16x32_bf16 v[132:135], v[216:219], v[40:43], v[132:135]
v_exp_f32 v238, v150
v_add_f32 v225, v229, v236
v_mfma_f32_16x16x32_bf16 v[132:135], v[220:223], v[44:47], v[132:135]
v_cvt_pk_bf16_f32 v182, v236, v237
v_exp_f32 v239, v151
v_mfma_f32_16x16x32_bf16 v[136:139], v[216:219], v[72:75], v[136:139]
v_add_f32 v225, v225, v237
v_add_f32 v225, v225, v238
v_add_f32 v225, v225, v239
v_mfma_f32_16x16x32_bf16 v[136:139], v[220:223], v[76:79], v[136:139]
v_cvt_pk_bf16_f32 v183, v238, v239
v_exp_f32 v232, v152
v_mfma_f32_16x16x32_bf16 v[140:143], v[216:219], v[104:107], v[140:143]
ds_read_b128 v[216:219], v251 offset:12288
v_exp_f32 v233, v153
v_mfma_f32_16x16x32_bf16 v[140:143], v[220:223], v[108:111], v[140:143]
ds_read_b128 v[220:223], v251 offset:12800
s_waitcnt lgkmcnt(2)
v_mfma_f32_16x16x32_bf16 v[128:131], v[208:211], v[16:19], v[128:131]
v_exp_f32 v234, v154
v_add_f32 v226, v230, v232
v_mfma_f32_16x16x32_bf16 v[128:131], v[212:215], v[20:23], v[128:131]
v_cvt_pk_bf16_f32 v186, v232, v233
v_exp_f32 v235, v155
v_mfma_f32_16x16x32_bf16 v[132:135], v[208:211], v[48:51], v[132:135]
v_add_f32 v226, v226, v233
v_add_f32 v226, v226, v234
v_add_f32 v226, v226, v235
v_mfma_f32_16x16x32_bf16 v[132:135], v[212:215], v[52:55], v[132:135]
v_cvt_pk_bf16_f32 v187, v234, v235
v_exp_f32 v236, v156
v_mfma_f32_16x16x32_bf16 v[136:139], v[208:211], v[80:83], v[136:139]
v_exp_f32 v237, v157
v_mfma_f32_16x16x32_bf16 v[136:139], v[212:215], v[84:87], v[136:139]
v_exp_f32 v238, v158
v_add_f32 v227, v231, v236
v_mfma_f32_16x16x32_bf16 v[140:143], v[208:211], v[112:115], v[140:143]
ds_read_b128 v[208:211], v251 offset:2048
v_cvt_pk_bf16_f32 v190, v236, v237
v_mfma_f32_16x16x32_bf16 v[140:143], v[212:215], v[116:119], v[140:143]
ds_read_b128 v[212:215], v251 offset:2560
s_waitcnt lgkmcnt(2)
v_mfma_f32_16x16x32_bf16 v[128:131], v[216:219], v[24:27], v[128:131]
v_exp_f32 v239, v159
v_add_f32 v227, v227, v237
v_mfma_f32_16x16x32_bf16 v[128:131], v[220:223], v[28:31], v[128:131]
v_add_f32 v227, v227, v238
v_add_f32 v227, v227, v239
v_cvt_pk_bf16_f32 v191, v238, v239
v_mfma_f32_16x16x32_bf16 v[132:135], v[216:219], v[56:59], v[132:135]
v_max3_f32 v242, v224, v225, v226
v_max_f32 v242, v242, v227
v_cmp_lt_f32 vcc, s32, v242
s_cbranch_vccnz L2_rare_site5
L2_ret5:
v_mfma_f32_16x16x32_bf16 v[132:135], v[220:223], v[60:63], v[132:135]
buffer_load_dwordx4 v241, s[8:11], s7 offen lds
s_add_u32 m0, s31, 4096
v_mfma_f32_16x16x32_bf16 v[136:139], v[216:219], v[88:91], v[136:139]
buffer_load_dwordx4 v241, s[8:11], s29 offen lds
s_add_u32 m0, s31, 1024
v_xor_b32 v241, 0x1040, v241
v_mfma_f32_16x16x32_bf16 v[136:139], v[220:223], v[92:95], v[136:139]
buffer_load_dwordx4 v241, s[8:11], s6 offen lds
s_add_u32 m0, s31, 3072
v_mfma_f32_16x16x32_bf16 v[140:143], v[216:219], v[120:123], v[140:143]
ds_read_b128 v[216:219], v251 offset:6144
buffer_load_dwordx4 v241, s[8:11], s7 offen lds
s_add_u32 m0, s31, 5120
v_mfma_f32_16x16x32_bf16 v[140:143], v[220:223], v[124:127], v[140:143]
ds_read_b128 v[220:223], v251 offset:6656
s_waitcnt lgkmcnt(2)
v_mfma_f32_16x16x32_bf16 v[144:147], v[208:211], v[0:3], v[192:195]
ds_write_b128 v253, v[176:179] offset:4096
buffer_load_dwordx4 v241, s[8:11], s29 offen lds
v_mfma_f32_16x16x32_bf16 v[144:147], v[212:215], v[4:7], v[144:147]
ds_write_b128 v253, v[180:183] offset:5120
v_exp_f32 v232, v128
v_mfma_f32_16x16x32_bf16 v[148:151], v[208:211], v[32:35], v[196:199]
ds_write_b128 v253, v[184:187] offset:6144
v_exp_f32 v233, v129
v_mfma_f32_16x16x32_bf16 v[148:151], v[212:215], v[36:39], v[148:151]
ds_write_b128 v253, v[188:191] offset:7168
v_exp_f32 v234, v130
v_mfma_f32_16x16x32_bf16 v[152:155], v[208:211], v[64:67], v[200:203]
v_add_f32 v228, v224, v232
v_cvt_pk_bf16_f32 v160, v232, v233
v_mfma_f32_16x16x32_bf16 v[152:155], v[212:215], v[68:71], v[152:155]
v_exp_f32 v235, v131
v_add_f32 v228, v228, v233
v_mfma_f32_16x16x32_bf16 v[156:159], v[208:211], v[96:99], v[204:207]
ds_read_b128 v[208:211], v251 offset:10240
v_add_f32 v228, v228, v234
v_add_f32 v228, v228, v235
v_mfma_f32_16x16x32_bf16 v[156:159], v[212:215], v[100:103], v[156:159]
ds_read_b128 v[212:215], v251 offset:10752
s_waitcnt lgkmcnt(2)
v_cvt_pk_bf16_f32 v161, v234, v235
v_mfma_f32_16x16x32_bf16 v[144:147], v[216:219], v[8:11], v[144:147]
v_exp_f32 v236, v132
v_mfma_f32_16x16x32_bf16 v[144:147], v[220:223], v[12:15], v[144:147]
v_exp_f32 v237, v133
v_mfma_f32_16x16x32_bf16 v[148:151], v[216:219], v[40:43], v[148:151]
v_exp_f32 v238, v134
v_add_f32 v229, v225, v236
v_mfma_f32_16x16x32_bf16 v[148:151], v[220:223], v[44:47], v[148:151]
v_cvt_pk_bf16_f32 v164, v236, v237
v_exp_f32 v239, v135
v_mfma_f32_16x16x32_bf16 v[152:155], v[216:219], v[72:75], v[152:155]
v_add_f32 v229, v229, v237
v_add_f32 v229, v229, v238
v_add_f32 v229, v229, v239
v_mfma_f32_16x16x32_bf16 v[152:155], v[220:223], v[76:79], v[152:155]
v_cvt_pk_bf16_f32 v165, v238, v239
v_exp_f32 v232, v136
v_mfma_f32_16x16x32_bf16 v[156:159], v[216:219], v[104:107], v[156:159]
ds_read_b128 v[216:219], v251 offset:14336
v_exp_f32 v233, v137
v_mfma_f32_16x16x32_bf16 v[156:159], v[220:223], v[108:111], v[156:159]
ds_read_b128 v[220:223], v251 offset:14848
s_waitcnt lgkmcnt(2)
v_mfma_f32_16x16x32_bf16 v[144:147], v[208:211], v[16:19], v[144:147]
v_exp_f32 v234, v138
v_add_f32 v230, v226, v232
v_mfma_f32_16x16x32_bf16 v[144:147], v[212:215], v[20:23], v[144:147]
s_waitcnt vmcnt(10)
s_barrier
v_cvt_pk_bf16_f32 v168, v232, v233
v_mfma_f32_16x16x32_bf16 v[148:151], v[208:211], v[48:51], v[148:151]
v_exp_f32 v235, v139
v_add_f32 v230, v230, v233
v_mfma_f32_16x16x32_bf16 v[148:151], v[212:215], v[52:55], v[148:151]
v_add_f32 v230, v230, v234
v_add_f32 v230, v230, v235
v_cvt_pk_bf16_f32 v169, v234, v235
v_mfma_f32_16x16x32_bf16 v[152:155], v[208:211], v[80:83], v[152:155]
v_exp_f32 v236, v140
v_mfma_f32_16x16x32_bf16 v[152:155], v[212:215], v[84:87], v[152:155]
v_exp_f32 v237, v141
v_mfma_f32_16x16x32_bf16 v[156:159], v[208:211], v[112:115], v[156:159]
ds_read_b128 v[208:211], v251 offset:16384
v_exp_f32 v238, v142
v_mfma_f32_16x16x32_bf16 v[156:159], v[212:215], v[116:119], v[156:159]
ds_read_b128 v[212:215], v251 offset:16896
s_waitcnt lgkmcnt(2)
v_add_f32 v231, v227, v236
v_mfma_f32_16x16x32_bf16 v[144:147], v[216:219], v[24:27], v[144:147]
v_cvt_pk_bf16_f32 v172, v236, v237
v_exp_f32 v239, v143
v_mfma_f32_16x16x32_bf16 v[144:147], v[220:223], v[28:31], v[144:147]
v_add_f32 v231, v231, v237
v_add_f32 v231, v231, v238
v_add_f32 v231, v231, v239
v_mfma_f32_16x16x32_bf16 v[148:151], v[216:219], v[56:59], v[148:151]
v_cvt_pk_bf16_f32 v173, v238, v239
v_max3_f32 v242, v228, v229, v230
v_max_f32 v242, v242, v231
v_mfma_f32_16x16x32_bf16 v[148:151], v[220:223], v[60:63], v[148:151]
v_cmp_lt_f32 vcc, s32, v242
v_mfma_f32_16x16x32_bf16 v[152:155], v[216:219], v[88:91], v[152:155]
v_mfma_f32_16x16x32_bf16 v[152:155], v[220:223], v[92:95], v[152:155]
s_cbranch_vccnz L2_rare_site6
L2_ret6:
v_mfma_f32_16x16x32_bf16 v[156:159], v[216:219], v[120:123], v[156:159]
ds_read_b128 v[216:219], v251 offset:20480
v_mfma_f32_16x16x32_bf16 v[156:159], v[220:223], v[124:127], v[156:159]
ds_read_b128 v[220:223], v251 offset:20992
s_waitcnt lgkmcnt(2)
v_mfma_f32_16x16x32_bf16 v[128:131], v[208:211], v[0:3], v[192:195]
v_mfma_f32_16x16x32_bf16 v[128:131], v[212:215], v[4:7], v[128:131]
v_exp_f32 v232, v144
v_mfma_f32_16x16x32_bf16 v[132:135], v[208:211], v[32:35], v[196:199]
v_exp_f32 v233, v145
v_mfma_f32_16x16x32_bf16 v[132:135], v[212:215], v[36:39], v[132:135]
v_exp_f32 v234, v146
v_add_f32 v224, v228, v232
v_mfma_f32_16x16x32_bf16 v[136:139], v[208:211], v[64:67], v[200:203]
v_cvt_pk_bf16_f32 v162, v232, v233
v_exp_f32 v235, v147
v_mfma_f32_16x16x32_bf16 v[136:139], v[212:215], v[68:71], v[136:139]
v_add_f32 v224, v224, v233
v_add_f32 v224, v224, v234
v_add_f32 v224, v224, v235
v_mfma_f32_16x16x32_bf16 v[140:143], v[208:211], v[96:99], v[204:207]
ds_read_b128 v[208:211], v251 offset:24576
v_cvt_pk_bf16_f32 v163, v234, v235
v_mfma_f32_16x16x32_bf16 v[140:143], v[212:215], v[100:103], v[140:143]
ds_read_b128 v[212:215], v251 offset:25088
s_waitcnt lgkmcnt(2)
v_mfma_f32_16x16x32_bf16 v[128:131], v[216:219], v[8:11], v[128:131]
v_exp_f32 v236, v148
v_mfma_f32_16x16x32_bf16 v[128:131], v[220:223], v[12:15], v[128:131]
v_exp_f32 v237, v149
v_mfma_f32_16x16x32_bf16 v[132:135], v[216:219], v[40:43], v[132:135]
v_exp_f32 v238, v150
v_add_f32 v225, v229, v236
v_mfma_f32_16x16x32_bf16 v[132:135], v[220:223], v[44:47], v[132:135]
v_cvt_pk_bf16_f32 v166, v236, v237
v_exp_f32 v239, v151
v_mfma_f32_16x16x32_bf16 v[136:139], v[216:219], v[72:75], v[136:139]
v_add_f32 v225, v225, v237
v_add_f32 v225, v225, v238
v_add_f32 v225, v225, v239
v_mfma_f32_16x16x32_bf16 v[136:139], v[220:223], v[76:79], v[136:139]
v_cvt_pk_bf16_f32 v167, v238, v239
v_exp_f32 v232, v152
v_mfma_f32_16x16x32_bf16 v[140:143], v[216:219], v[104:107], v[140:143]
ds_read_b128 v[216:219], v251 offset:28672
v_exp_f32 v233, v153
v_mfma_f32_16x16x32_bf16 v[140:143], v[220:223], v[108:111], v[140:143]
ds_read_b128 v[220:223], v251 offset:29184
s_waitcnt lgkmcnt(2)
v_mfma_f32_16x16x32_bf16 v[128:131], v[208:211], v[16:19], v[128:131]
v_exp_f32 v234, v154
v_add_f32 v226, v230, v232
v_mfma_f32_16x16x32_bf16 v[128:131], v[212:215], v[20:23], v[128:131]
v_cvt_pk_bf16_f32 v170, v232, v233
v_exp_f32 v235, v155
v_mfma_f32_16x16x32_bf16 v[132:135], v[208:211], v[48:51], v[132:135]
v_add_f32 v226, v226, v233
v_add_f32 v226, v226, v234
v_add_f32 v226, v226, v235
v_mfma_f32_16x16x32_bf16 v[132:135], v[212:215], v[52:55], v[132:135]
v_cvt_pk_bf16_f32 v171, v234, v235
v_exp_f32 v236, v156
v_mfma_f32_16x16x32_bf16 v[136:139], v[208:211], v[80:83], v[136:139]
v_exp_f32 v237, v157
v_mfma_f32_16x16x32_bf16 v[136:139], v[212:215], v[84:87], v[136:139]
v_exp_f32 v238, v158
v_add_f32 v227, v231, v236
v_mfma_f32_16x16x32_bf16 v[140:143], v[208:211], v[112:115], v[140:143]
ds_read_b128 v[208:211], v251 offset:18432
v_cvt_pk_bf16_f32 v174, v236, v237
v_mfma_f32_16x16x32_bf16 v[140:143], v[212:215], v[116:119], v[140:143]
ds_read_b128 v[212:215], v251 offset:18944
s_waitcnt lgkmcnt(2)
v_mfma_f32_16x16x32_bf16 v[128:131], v[216:219], v[24:27], v[128:131]
v_exp_f32 v239, v159
v_add_f32 v227, v227, v237
v_mfma_f32_16x16x32_bf16 v[128:131], v[220:223], v[28:31], v[128:131]
v_add_f32 v227, v227, v238
v_add_f32 v227, v227, v239
v_cvt_pk_bf16_f32 v175, v238, v239
v_mfma_f32_16x16x32_bf16 v[132:135], v[216:219], v[56:59], v[132:135]
v_max3_f32 v242, v224, v225, v226
v_max_f32 v242, v242, v227
v_cmp_lt_f32 vcc, s32, v242
s_cbranch_vccnz L2_rare_site7
L2_ret7:
v_mfma_f32_16x16x32_bf16 v[132:135], v[220:223], v[60:63], v[132:135]
v_mfma_f32_16x16x32_bf16 v[136:139], v[216:219], v[88:91], v[136:139]
v_mfma_f32_16x16x32_bf16 v[136:139], v[220:223], v[92:95], v[136:139]
v_mfma_f32_16x16x32_bf16 v[140:143], v[216:219], v[120:123], v[140:143]
ds_read_b128 v[216:219], v251 offset:22528
v_mfma_f32_16x16x32_bf16 v[140:143], v[220:223], v[124:127], v[140:143]
ds_read_b128 v[220:223], v251 offset:23040
s_waitcnt lgkmcnt(2)
v_mfma_f32_16x16x32_bf16 v[144:147], v[208:211], v[0:3], v[192:195]
v_mfma_f32_16x16x32_bf16 v[144:147], v[212:215], v[4:7], v[144:147]
v_exp_f32 v232, v128
v_lshlrev_b32 v241, 3, v248
v_mfma_f32_16x16x32_bf16 v[148:151], v[208:211], v[32:35], v[196:199]
v_exp_f32 v233, v129
s_mov_b32 s3, 0x7c28000
v_mfma_f32_16x16x32_bf16 v[148:151], v[212:215], v[36:39], v[148:151]
v_exp_f32 v234, v130
v_add_f32 v228, v224, v232
v_mfma_f32_16x16x32_bf16 v[152:155], v[208:211], v[64:67], v[200:203]
v_cvt_pk_bf16_f32 v176, v232, v233
v_exp_f32 v235, v131
v_mfma_f32_16x16x32_bf16 v[152:155], v[212:215], v[68:71], v[152:155]
v_add_f32 v228, v228, v233
v_add_f32 v228, v228, v234
v_add_f32 v228, v228, v235
v_mfma_f32_16x16x32_bf16 v[156:159], v[208:211], v[96:99], v[204:207]
ds_read_b128 v[208:211], v251 offset:26624
v_cvt_pk_bf16_f32 v177, v234, v235
buffer_load_dwordx2 v[240:241], v241, s[16:19], s3 offen sc1
v_mfma_f32_16x16x32_bf16 v[156:159], v[212:215], v[100:103], v[156:159]
ds_read_b128 v[212:215], v251 offset:27136
s_waitcnt lgkmcnt(2)
v_mfma_f32_16x16x32_bf16 v[144:147], v[216:219], v[8:11], v[144:147]
v_exp_f32 v236, v132
v_mfma_f32_16x16x32_bf16 v[144:147], v[220:223], v[12:15], v[144:147]
v_exp_f32 v237, v133
v_mfma_f32_16x16x32_bf16 v[148:151], v[216:219], v[40:43], v[148:151]
v_exp_f32 v238, v134
v_add_f32 v229, v225, v236
v_mfma_f32_16x16x32_bf16 v[148:151], v[220:223], v[44:47], v[148:151]
v_cvt_pk_bf16_f32 v180, v236, v237
v_exp_f32 v239, v135
v_mfma_f32_16x16x32_bf16 v[152:155], v[216:219], v[72:75], v[152:155]
v_add_f32 v229, v229, v237
v_add_f32 v229, v229, v238
v_add_f32 v229, v229, v239
v_mfma_f32_16x16x32_bf16 v[152:155], v[220:223], v[76:79], v[152:155]
v_cvt_pk_bf16_f32 v181, v238, v239
v_exp_f32 v232, v136
v_mfma_f32_16x16x32_bf16 v[156:159], v[216:219], v[104:107], v[156:159]
ds_read_b128 v[216:219], v251 offset:30720
v_exp_f32 v233, v137
v_mfma_f32_16x16x32_bf16 v[156:159], v[220:223], v[108:111], v[156:159]
ds_read_b128 v[220:223], v251 offset:31232
s_waitcnt lgkmcnt(2)
v_mfma_f32_16x16x32_bf16 v[144:147], v[208:211], v[16:19], v[144:147]
v_exp_f32 v234, v138
v_add_f32 v230, v226, v232
v_mfma_f32_16x16x32_bf16 v[144:147], v[212:215], v[20:23], v[144:147]
s_waitcnt vmcnt(7)
s_barrier
v_cvt_pk_bf16_f32 v184, v232, v233
v_mfma_f32_16x16x32_bf16 v[148:151], v[208:211], v[48:51], v[148:151]
v_exp_f32 v235, v139
v_add_f32 v230, v230, v233
v_mfma_f32_16x16x32_bf16 v[148:151], v[212:215], v[52:55], v[148:151]
v_add_f32 v230, v230, v234
v_add_f32 v230, v230, v235
v_cvt_pk_bf16_f32 v185, v234, v235
v_mfma_f32_16x16x32_bf16 v[152:155], v[208:211], v[80:83], v[152:155]
v_exp_f32 v236, v140
v_mfma_f32_16x16x32_bf16 v[152:155], v[212:215], v[84:87], v[152:155]
v_exp_f32 v237, v141
v_mfma_f32_16x16x32_bf16 v[156:159], v[208:211], v[112:115], v[156:159]
ds_read_b128 v[208:211], v252 offset:0
v_exp_f32 v238, v142
v_mfma_f32_16x16x32_bf16 v[156:159], v[212:215], v[116:119], v[156:159]
ds_read_b128 v[212:215], v252 offset:512
s_waitcnt lgkmcnt(2)
v_add_f32 v231, v227, v236
v_mfma_f32_16x16x32_bf16 v[144:147], v[216:219], v[24:27], v[144:147]
v_cvt_pk_bf16_f32 v188, v236, v237
v_exp_f32 v239, v143
v_mfma_f32_16x16x32_bf16 v[144:147], v[220:223], v[28:31], v[144:147]
v_add_f32 v231, v231, v237
v_add_f32 v231, v231, v238
v_add_f32 v231, v231, v239
v_mfma_f32_16x16x32_bf16 v[148:151], v[216:219], v[56:59], v[148:151]
v_cvt_pk_bf16_f32 v189, v238, v239
v_max3_f32 v242, v228, v229, v230
v_max_f32 v242, v242, v231
v_mfma_f32_16x16x32_bf16 v[148:151], v[220:223], v[60:63], v[148:151]
v_cmp_lt_f32 vcc, s32, v242
s_cbranch_vccnz L2_rare_site8
L2_ret8:
v_mfma_f32_16x16x32_bf16 v[152:155], v[216:219], v[88:91], v[152:155]
v_mfma_f32_16x16x32_bf16 v[152:155], v[220:223], v[92:95], v[152:155]
v_mfma_f32_16x16x32_bf16 v[156:159], v[216:219], v[120:123], v[156:159]
ds_read_b128 v[216:219], v252 offset:4096
v_mfma_f32_16x16x32_bf16 v[156:159], v[220:223], v[124:127], v[156:159]
ds_read_b128 v[220:223], v252 offset:4608
s_waitcnt lgkmcnt(2)
v_mfma_f32_16x16x32_bf16 v[128:131], v[208:211], v[0:3], v[192:195]
v_mfma_f32_16x16x32_bf16 v[128:131], v[212:215], v[4:7], v[128:131]
v_exp_f32 v232, v144
v_mfma_f32_16x16x32_bf16 v[132:135], v[208:211], v[32:35], v[196:199]
v_exp_f32 v233, v145
v_mfma_f32_16x16x32_bf16 v[132:135], v[212:215], v[36:39], v[132:135]
v_exp_f32 v234, v146
v_add_f32 v224, v228, v232
v_mfma_f32_16x16x32_bf16 v[136:139], v[208:211], v[64:67], v[200:203]
v_cvt_pk_bf16_f32 v178, v232, v233
v_exp_f32 v235, v147
v_mfma_f32_16x16x32_bf16 v[136:139], v[212:215], v[68:71], v[136:139]
v_add_f32 v224, v224, v233
v_add_f32 v224, v224, v234
v_add_f32 v224, v224, v235
v_mfma_f32_16x16x32_bf16 v[140:143], v[208:211], v[96:99], v[204:207]
ds_read_b128 v[208:211], v252 offset:8192
v_cvt_pk_bf16_f32 v179, v234, v235
v_mfma_f32_16x16x32_bf16 v[140:143], v[212:215], v[100:103], v[140:143]
ds_read_b128 v[212:215], v252 offset:8704
s_waitcnt lgkmcnt(2)
v_mfma_f32_16x16x32_bf16 v[128:131], v[216:219], v[8:11], v[128:131]
v_exp_f32 v236, v148
v_mfma_f32_16x16x32_bf16 v[128:131], v[220:223], v[12:15], v[128:131]
v_exp_f32 v237, v149
v_mfma_f32_16x16x32_bf16 v[132:135], v[216:219], v[40:43], v[132:135]
v_exp_f32 v238, v150
v_add_f32 v225, v229, v236
v_mfma_f32_16x16x32_bf16 v[132:135], v[220:223], v[44:47], v[132:135]
v_cvt_pk_bf16_f32 v182, v236, v237
v_exp_f32 v239, v151
v_mfma_f32_16x16x32_bf16 v[136:139], v[216:219], v[72:75], v[136:139]
v_add_f32 v225, v225, v237
v_add_f32 v225, v225, v238
v_add_f32 v225, v225, v239
v_mfma_f32_16x16x32_bf16 v[136:139], v[220:223], v[76:79], v[136:139]
v_cvt_pk_bf16_f32 v183, v238, v239
v_exp_f32 v232, v152
v_mfma_f32_16x16x32_bf16 v[140:143], v[216:219], v[104:107], v[140:143]
ds_read_b128 v[216:219], v252 offset:12288
v_exp_f32 v233, v153
v_mfma_f32_16x16x32_bf16 v[140:143], v[220:223], v[108:111], v[140:143]
ds_read_b128 v[220:223], v252 offset:12800
s_waitcnt lgkmcnt(2)
v_mfma_f32_16x16x32_bf16 v[128:131], v[208:211], v[16:19], v[128:131]
v_exp_f32 v234, v154
v_add_f32 v226, v230, v232
v_mfma_f32_16x16x32_bf16 v[128:131], v[212:215], v[20:23], v[128:131]
v_cvt_pk_bf16_f32 v186, v232, v233
v_exp_f32 v235, v155
v_mfma_f32_16x16x32_bf16 v[132:135], v[208:211], v[48:51], v[132:135]
v_add_f32 v226, v226, v233
v_add_f32 v226, v226, v234
v_add_f32 v226, v226, v235
v_mfma_f32_16x16x32_bf16 v[132:135], v[212:215], v[52:55], v[132:135]
v_cvt_pk_bf16_f32 v187, v234, v235
v_exp_f32 v236, v156
v_mfma_f32_16x16x32_bf16 v[136:139], v[208:211], v[80:83], v[136:139]
v_exp_f32 v237, v157
v_mfma_f32_16x16x32_bf16 v[136:139], v[212:215], v[84:87], v[136:139]
v_exp_f32 v238, v158
v_add_f32 v227, v231, v236
v_mfma_f32_16x16x32_bf16 v[140:143], v[208:211], v[112:115], v[140:143]
ds_read_b128 v[208:211], v252 offset:2048
v_cvt_pk_bf16_f32 v190, v236, v237
v_mfma_f32_16x16x32_bf16 v[140:143], v[212:215], v[116:119], v[140:143]
ds_read_b128 v[212:215], v252 offset:2560
s_waitcnt lgkmcnt(2)
v_mfma_f32_16x16x32_bf16 v[128:131], v[216:219], v[24:27], v[128:131]
v_exp_f32 v239, v159
v_add_f32 v227, v227, v237
v_mfma_f32_16x16x32_bf16 v[128:131], v[220:223], v[28:31], v[128:131]
v_add_f32 v227, v227, v238
v_add_f32 v227, v227, v239
v_cvt_pk_bf16_f32 v191, v238, v239
v_mfma_f32_16x16x32_bf16 v[132:135], v[216:219], v[56:59], v[132:135]
v_max3_f32 v242, v224, v225, v226
v_max_f32 v242, v242, v227
v_cmp_lt_f32 vcc, s32, v242
s_cbranch_vccnz L2_rare_site9
L2_ret9:
v_mfma_f32_16x16x32_bf16 v[132:135], v[220:223], v[60:63], v[132:135]
v_mfma_f32_16x16x32_bf16 v[136:139], v[216:219], v[88:91], v[136:139]
v_mfma_f32_16x16x32_bf16 v[136:139], v[220:223], v[92:95], v[136:139]
v_mfma_f32_16x16x32_bf16 v[140:143], v[216:219], v[120:123], v[140:143]
ds_read_b128 v[216:219], v252 offset:6144
v_mfma_f32_16x16x32_bf16 v[140:143], v[220:223], v[124:127], v[140:143]
ds_read_b128 v[220:223], v252 offset:6656
s_waitcnt lgkmcnt(2)
v_mfma_f32_16x16x32_bf16 v[144:147], v[208:211], v[0:3], v[192:195]
v_mfma_f32_16x16x32_bf16 v[144:147], v[212:215], v[4:7], v[144:147]
v_mfma_f32_16x16x32_bf16 v[148:151], v[208:211], v[32:35], v[196:199]
v_mfma_f32_16x16x32_bf16 v[148:151], v[212:215], v[36:39], v[148:151]
v_mfma_f32_16x16x32_bf16 v[152:155], v[208:211], v[64:67], v[200:203]
v_exp_f32 v232, v128
v_mfma_f32_16x16x32_bf16 v[152:155], v[212:215], v[68:71], v[152:155]
v_exp_f32 v233, v129
v_mfma_f32_16x16x32_bf16 v[156:159], v[208:211], v[96:99], v[204:207]
ds_read_b128 v[208:211], v252 offset:10240
v_exp_f32 v234, v130
v_mfma_f32_16x16x32_bf16 v[156:159], v[212:215], v[100:103], v[156:159]
ds_read_b128 v[212:215], v252 offset:10752
s_waitcnt lgkmcnt(2)
v_add_f32 v228, v224, v232
v_mfma_f32_16x16x32_bf16 v[144:147], v[216:219], v[8:11], v[144:147]
v_cvt_pk_bf16_f32 v0, v232, v233
v_exp_f32 v235, v131
v_mfma_f32_16x16x32_bf16 v[144:147], v[220:223], v[12:15], v[144:147]
ds_read_b128 v[4:7], v253 offset:0
v_add_f32 v228, v228, v233
v_add_f32 v228, v228, v234
v_mfma_f32_16x16x32_bf16 v[148:151], v[216:219], v[40:43], v[148:151]
ds_read_b128 v[36:39], v253 offset:1024
v_add_f32 v228, v228, v235
v_cvt_pk_bf16_f32 v1, v234, v235
v_mfma_f32_16x16x32_bf16 v[148:151], v[220:223], v[44:47], v[148:151]
v_exp_f32 v236, v132
v_mfma_f32_16x16x32_bf16 v[152:155], v[216:219], v[72:75], v[152:155]
v_exp_f32 v237, v133
v_mfma_f32_16x16x32_bf16 v[152:155], v[220:223], v[76:79], v[152:155]
ds_read_b128 v[68:71], v253 offset:2048
ds_read_b128 v[8:11], v253 offset:4096
v_mfma_f32_16x16x32_bf16 v[156:159], v[216:219], v[104:107], v[156:159]
ds_read_b128 v[216:219], v252 offset:14336
v_add_u32 v12, 0x8000, v249
v_and_b32 v12, 0x1ffff, v12
ds_read_b128 v[100:103], v253 offset:3072
ds_read_b128 v[40:43], v253 offset:5120
v_mfma_f32_16x16x32_bf16 v[156:159], v[220:223], v[108:111], v[156:159]
ds_read_b128 v[220:223], v252 offset:14848
s_waitcnt lgkmcnt(2)
v_add_u32 v14, 0x10000, v249
v_and_b32 v14, 0x1ffff, v14
v_mfma_f32_16x16x32_bf16 v[144:147], v[208:211], v[16:19], v[144:147]
v_xor_b32 v13, 32, v12
v_xor_b32 v15, 32, v14
v_mfma_f32_16x16x32_bf16 v[144:147], v[212:215], v[20:23], v[144:147]
ds_read_b128 v[72:75], v253 offset:6144
v_exp_f32 v238, v134
v_mfma_f32_16x16x32_bf16 v[148:151], v[208:211], v[48:51], v[148:151]
ds_read_b128 v[104:107], v253 offset:7168
v_add_f32 v229, v225, v236
v_cvt_pk_bf16_f32 v32, v236, v237
v_mfma_f32_16x16x32_bf16 v[148:151], v[212:215], v[52:55], v[148:151]
v_exp_f32 v239, v135
v_add_f32 v229, v229, v237
v_mfma_f32_16x16x32_bf16 v[152:155], v[208:211], v[80:83], v[152:155]
v_add_f32 v229, v229, v238
v_add_f32 v229, v229, v239
v_cvt_pk_bf16_f32 v33, v238, v239
v_mfma_f32_16x16x32_bf16 v[152:155], v[212:215], v[84:87], v[152:155]
v_exp_f32 v232, v136
v_mfma_f32_16x16x32_bf16 v[156:159], v[208:211], v[112:115], v[156:159]
ds_read_b64_tr_b16 v[208:209], v249 offset:16384
v_exp_f32 v233, v137
v_mfma_f32_16x16x32_bf16 v[156:159], v[212:215], v[116:119], v[156:159]
ds_read_b64_tr_b16 v[210:211], v249 offset:18432
ds_read_b64_tr_b16 v[212:213], v12 offset:0
s_waitcnt lgkmcnt(3)
v_mfma_f32_16x16x32_bf16 v[144:147], v[216:219], v[24:27], v[144:147]
ds_read_b64_tr_b16 v[214:215], v12 offset:2048
v_exp_f32 v234, v138
v_mfma_f32_16x16x32_bf16 v[144:147], v[220:223], v[28:31], v[144:147]
v_add_f32 v230, v226, v232
v_cvt_pk_bf16_f32 v64, v232, v233
v_mfma_f32_16x16x32_bf16 v[148:151], v[216:219], v[56:59], v[148:151]
v_exp_f32 v235, v139
v_add_f32 v230, v230, v233
v_mfma_f32_16x16x32_bf16 v[148:151], v[220:223], v[60:63], v[148:151]
v_add_f32 v230, v230, v234
v_add_f32 v230, v230, v235
v_cvt_pk_bf16_f32 v65, v234, v235
v_mfma_f32_16x16x32_bf16 v[152:155], v[216:219], v[88:91], v[152:155]
v_exp_f32 v236, v140
s_waitcnt vmcnt(0)
v_mfma_f32_16x16x32_bf16 v[152:155], v[220:223], v[92:95], v[152:155]
v_exp_f32 v237, v141
v_cmp_ne_u64_e64 s[38:39], s[98:99], v[240:241]
v_mfma_f32_16x16x32_bf16 v[156:159], v[216:219], v[120:123], v[156:159]
ds_read_b64_tr_b16 v[216:217], v12 offset:16384
v_exp_f32 v238, v142
v_mfma_f32_16x16x32_bf16 v[156:159], v[220:223], v[124:127], v[156:159]
ds_read_b64_tr_b16 v[218:219], v12 offset:18432
ds_read_b64_tr_b16 v[220:221], v250 offset:16384
s_waitcnt lgkmcnt(3)
v_add_f32 v231, v227, v236
v_cvt_pk_bf16_f32 v96, v236, v237
v_exp_f32 v239, v143
v_add_f32 v231, v231, v237
v_add_f32 v231, v231, v238
v_add_f32 v231, v231, v239
v_cvt_pk_bf16_f32 v97, v238, v239
v_max3_f32 v242, v228, v229, v230
v_max_f32 v242, v242, v231
v_cmp_lt_f32 vcc, s32, v242
s_cbranch_vccnz L2_rare_site10
L2_ret10:
v_mfma_f32_16x16x32_bf16 a[0:3], v[8:11], v[208:211], a[0:3]
ds_read_b64_tr_b16 v[222:223], v250 offset:18432
s_and_b64 s[38:39], s[38:39], s[96:97]
s_cbranch_scc1 LF_hl_0
LF_hlret_0:
v_mfma_f32_16x16x32_bf16 a[0:3], v[160:163], v[212:215], a[0:3]
v_exp_f32 v232, v144
v_lshrrev_b32 v241, 4, v248
v_mfma_f32_16x16x32_bf16 a[4:7], v[40:43], v[208:211], a[4:7]
v_exp_f32 v233, v145
v_and_b32 v241, 0x30, v241
v_mfma_f32_16x16x32_bf16 a[4:7], v[164:167], v[212:215], a[4:7]
v_exp_f32 v234, v146
v_xor_b32 v241, v241, v248
v_mfma_f32_16x16x32_bf16 a[8:11], v[72:75], v[208:211], a[8:11]
v_add_f32 v224, v228, v232
v_cvt_pk_bf16_f32 v2, v232, v233
v_mfma_f32_16x16x32_bf16 a[8:11], v[168:171], v[212:215], a[8:11]
v_exp_f32 v235, v147
v_mfma_f32_16x16x32_bf16 a[12:15], v[104:107], v[208:211], a[12:15]
ds_read_b64_tr_b16 v[208:209], v13 offset:0
v_add_f32 v224, v224, v233
v_mfma_f32_16x16x32_bf16 a[12:15], v[172:175], v[212:215], a[12:15]
ds_read_b64_tr_b16 v[210:211], v13 offset:2048
ds_read_b64_tr_b16 v[212:213], v13 offset:16384
s_waitcnt lgkmcnt(5)
v_mfma_f32_16x16x32_bf16 a[0:3], v[176:179], v[216:219], a[0:3]
ds_read_b64_tr_b16 v[214:215], v13 offset:18432
v_add_f32 v224, v224, v234
v_mfma_f32_16x16x32_bf16 a[4:7], v[180:183], v[216:219], a[4:7]
v_add_f32 v224, v224, v235
v_cvt_pk_bf16_f32 v3, v234, v235
v_mfma_f32_16x16x32_bf16 a[8:11], v[184:187], v[216:219], a[8:11]
v_exp_f32 v236, v148
v_mfma_f32_16x16x32_bf16 a[12:15], v[188:191], v[216:219], a[12:15]
ds_read_b64_tr_b16 v[216:217], v249 offset:16896
s_waitcnt lgkmcnt(5)
v_mfma_f32_16x16x32_bf16 a[16:19], v[8:11], v[220:223], a[16:19]
ds_read_b64_tr_b16 v[218:219], v249 offset:18944
v_and_b32 v243, 0x380, v248
v_mad_u32_u24 v241, v243, 3, v241
v_mfma_f32_16x16x32_bf16 a[20:23], v[40:43], v[220:223], a[20:23]
v_exp_f32 v237, v149
v_add_u32 v241, 0x7000000, v241
v_mfma_f32_16x16x32_bf16 a[24:27], v[72:75], v[220:223], a[24:27]
v_exp_f32 v238, v150
v_and_b32 v110, 0x70, v248
v_mfma_f32_16x16x32_bf16 a[28:31], v[104:107], v[220:223], a[28:31]
ds_read_b64_tr_b16 v[220:221], v12 offset:512
s_waitcnt lgkmcnt(3)
v_lshlrev_b32 v110, 3, v110
v_mfma_f32_16x16x32_bf16 a[16:19], v[160:163], v[208:211], a[16:19]
ds_read_b64_tr_b16 v[222:223], v12 offset:2560
v_add_f32 v225, v229, v236
v_add_u32 v110, 0x7c32000, v110
v_mfma_f32_16x16x32_bf16 a[16:19], v[176:179], v[212:215], a[16:19]
v_cvt_pk_bf16_f32 v34, v236, v237
buffer_load_dwordx2 v[108:109], v110, s[16:19], 0 offen sc1
v_mfma_f32_16x16x32_bf16 a[20:23], v[164:167], v[208:211], a[20:23]
v_exp_f32 v239, v151
v_mfma_f32_16x16x32_bf16 a[20:23], v[180:183], v[212:215], a[20:23]
v_add_f32 v225, v225, v237
v_add_f32 v225, v225, v238
v_mfma_f32_16x16x32_bf16 a[24:27], v[168:171], v[208:211], a[24:27]
v_add_f32 v225, v225, v239
v_cvt_pk_bf16_f32 v35, v238, v239
v_mfma_f32_16x16x32_bf16 a[24:27], v[184:187], v[212:215], a[24:27]
v_exp_f32 v232, v152
v_mfma_f32_16x16x32_bf16 a[28:31], v[172:175], v[208:211], a[28:31]
ds_read_b64_tr_b16 v[208:209], v12 offset:16896
s_add_u32 m0, s28, 0
v_mfma_f32_16x16x32_bf16 a[28:31], v[188:191], v[212:215], a[28:31]
ds_read_b64_tr_b16 v[210:211], v12 offset:18944
ds_read_b64_tr_b16 v[212:213], v250 offset:16896
s_waitcnt lgkmcnt(3)
v_mfma_f32_16x16x32_bf16 a[32:35], v[8:11], v[216:219], a[32:35]
ds_read_b64_tr_b16 v[214:215], v250 offset:18944
buffer_load_dwordx4 v241, s[16:19], s6 offen sc1 lds
s_add_u32 m0, s28, 8192
v_mfma_f32_16x16x32_bf16 a[32:35], v[160:163], v[220:223], a[32:35]
v_exp_f32 v233, v153
v_mfma_f32_16x16x32_bf16 a[36:39], v[40:43], v[216:219], a[36:39]
v_exp_f32 v234, v154
v_mfma_f32_16x16x32_bf16 a[36:39], v[164:167], v[220:223], a[36:39]
v_add_f32 v226, v230, v232
v_cvt_pk_bf16_f32 v66, v232, v233
v_mfma_f32_16x16x32_bf16 a[40:43], v[72:75], v[216:219], a[40:43]
v_exp_f32 v235, v155
v_mfma_f32_16x16x32_bf16 a[40:43], v[168:171], v[220:223], a[40:43]
v_add_f32 v226, v226, v233
v_add_f32 v226, v226, v234
v_mfma_f32_16x16x32_bf16 a[44:47], v[104:107], v[216:219], a[44:47]
ds_read_b64_tr_b16 v[216:217], v13 offset:512
v_add_f32 v226, v226, v235
v_mfma_f32_16x16x32_bf16 a[44:47], v[172:175], v[220:223], a[44:47]
ds_read_b64_tr_b16 v[218:219], v13 offset:2560
ds_read_b64_tr_b16 v[220:221], v13 offset:16896
s_waitcnt lgkmcnt(5)
v_mfma_f32_16x16x32_bf16 a[32:35], v[176:179], v[208:211], a[32:35]
ds_read_b64_tr_b16 v[222:223], v13 offset:18944
v_cvt_pk_bf16_f32 v67, v234, v235
v_mfma_f32_16x16x32_bf16 a[36:39], v[180:183], v[208:211], a[36:39]
v_exp_f32 v236, v156
v_mfma_f32_16x16x32_bf16 a[40:43], v[184:187], v[208:211], a[40:43]
v_exp_f32 v237, v157
v_mfma_f32_16x16x32_bf16 a[44:47], v[188:191], v[208:211], a[44:47]
ds_read_b64_tr_b16 v[208:209], v14 offset:0
s_waitcnt lgkmcnt(5)
v_mfma_f32_16x16x32_bf16 a[48:51], v[8:11], v[212:215], a[48:51]
ds_read_b64_tr_b16 v[210:211], v14 offset:2048
buffer_load_dwordx4 v241, s[16:19], s7 offen sc1 lds
s_add_u32 m0, s30, 0
v_mfma_f32_16x16x32_bf16 a[52:55], v[40:43], v[212:215], a[52:55]
v_exp_f32 v238, v158
v_mfma_f32_16x16x32_bf16 a[56:59], v[72:75], v[212:215], a[56:59]
v_add_f32 v227, v231, v236
v_cvt_pk_bf16_f32 v98, v236, v237
v_mfma_f32_16x16x32_bf16 a[60:63], v[104:107], v[212:215], a[60:63]
ds_read_b64_tr_b16 v[212:213], v15 offset:0
s_waitcnt lgkmcnt(3)
v_mfma_f32_16x16x32_bf16 a[48:51], v[160:163], v[216:219], a[48:51]
ds_read_b64_tr_b16 v[214:215], v15 offset:2048
buffer_load_dwordx4 v241, s[16:19], s29 offen sc1 lds
s_add_u32 m0, s28, 4096
v_mfma_f32_16x16x32_bf16 a[48:51], v[176:179], v[220:223], a[48:51]
v_exp_f32 v239, v159
v_xor_b32 v241, 0x1040, v241
v_mfma_f32_16x16x32_bf16 a[52:55], v[164:167], v[216:219], a[52:55]
v_add_f32 v227, v227, v237
v_add_f32 v227, v227, v238
v_mfma_f32_16x16x32_bf16 a[52:55], v[180:183], v[220:223], a[52:55]
v_add_f32 v227, v227, v239
v_cvt_pk_bf16_f32 v99, v238, v239
v_mfma_f32_16x16x32_bf16 a[56:59], v[168:171], v[216:219], a[56:59]
v_max3_f32 v242, v224, v225, v226
v_max_f32 v242, v242, v227
v_mfma_f32_16x16x32_bf16 a[56:59], v[184:187], v[220:223], a[56:59]
v_cmp_lt_f32 vcc, s32, v242
s_cbranch_vccnz L2_rare_site11
L2_ret11:
v_mfma_f32_16x16x32_bf16 a[60:63], v[172:175], v[216:219], a[60:63]
ds_read_b64_tr_b16 v[216:217], v14 offset:512
buffer_load_dwordx4 v241, s[16:19], s6 offen sc1 lds
s_add_u32 m0, s28, 12288
v_mfma_f32_16x16x32_bf16 a[60:63], v[188:191], v[220:223], a[60:63]
ds_read_b64_tr_b16 v[218:219], v14 offset:2560
ds_read_b64_tr_b16 v[220:221], v15 offset:512
s_waitcnt lgkmcnt(5)
v_mfma_f32_16x16x32_bf16 a[0:3], v[0:3], v[208:211], a[0:3]
ds_read_b64_tr_b16 v[222:223], v15 offset:2560
buffer_load_dwordx4 v241, s[16:19], s7 offen sc1 lds
s_add_u32 m0, s30, 4096
v_mfma_f32_16x16x32_bf16 a[4:7], v[32:35], v[208:211], a[4:7]
buffer_load_dwordx4 v241, s[16:19], s29 offen sc1 lds
v_bfe_u32 v242, v248, 8, 1
v_mfma_f32_16x16x32_bf16 a[8:11], v[64:67], v[208:211], a[8:11]
v_mul_u32_u24 v242, 48, v242
v_lshl_add_u32 v242, s37, 3, v242
v_and_b32 v243, 0xf0, v248
v_mfma_f32_16x16x32_bf16 a[12:15], v[96:99], v[208:211], a[12:15]
ds_read_b64_tr_b16 v[208:209], v249 offset:4096
s_waitcnt lgkmcnt(5)
v_lshl_add_u32 v242, v243, 3, v242
v_mfma_f32_16x16x32_bf16 a[16:19], v[0:3], v[212:215], a[16:19]
ds_read_b64_tr_b16 v[210:211], v249 offset:6144
v_mov_b32 v232, v224
v_mov_b32 v234, v225
v_mfma_f32_16x16x32_bf16 a[20:23], v[32:35], v[212:215], a[20:23]
v_mov_b32 v236, v226
v_mov_b32 v238, v227
v_permlane32_swap_b32 v224, v232
v_mfma_f32_16x16x32_bf16 a[24:27], v[64:67], v[212:215], a[24:27]
v_permlane32_swap_b32 v225, v234
v_permlane32_swap_b32 v226, v236
v_permlane32_swap_b32 v227, v238
v_mfma_f32_16x16x32_bf16 a[28:31], v[96:99], v[212:215], a[28:31]
ds_read_b64_tr_b16 v[212:213], v249 offset:20480
s_waitcnt lgkmcnt(5)
v_add_f32 v224, v224, v232
v_mfma_f32_16x16x32_bf16 a[32:35], v[0:3], v[216:219], a[32:35]
ds_read_b64_tr_b16 v[214:215], v249 offset:22528
v_add_f32 v225, v225, v234
v_add_f32 v226, v226, v236
v_mfma_f32_16x16x32_bf16 a[36:39], v[32:35], v[216:219], a[36:39]
v_add_f32 v227, v227, v238
v_mov_b32 v232, v224
v_mov_b32 v234, v225
v_mfma_f32_16x16x32_bf16 a[40:43], v[64:67], v[216:219], a[40:43]
v_mov_b32 v236, v226
v_mov_b32 v238, v227
v_permlane16_swap_b32 v224, v232
v_mfma_f32_16x16x32_bf16 a[44:47], v[96:99], v[216:219], a[44:47]
ds_read_b64_tr_b16 v[216:217], v12 offset:4096
s_waitcnt lgkmcnt(5)
v_permlane16_swap_b32 v225, v234
v_mfma_f32_16x16x32_bf16 a[48:51], v[0:3], v[220:223], a[48:51]
ds_read_b64_tr_b16 v[218:219], v12 offset:6144
v_permlane16_swap_b32 v226, v236
v_permlane16_swap_b32 v227, v238
v_mfma_f32_16x16x32_bf16 a[52:55], v[32:35], v[220:223], a[52:55]
v_add_f32 v233, v224, v232
v_add_f32 v235, v225, v234
v_add_f32 v237, v226, v236
v_mfma_f32_16x16x32_bf16 a[56:59], v[64:67], v[220:223], a[56:59]
v_add_f32 v239, v227, v238
v_mov_b32 v232, v244
v_mov_b32 v234, v245
v_mfma_f32_16x16x32_bf16 a[60:63], v[96:99], v[220:223], a[60:63]
ds_read_b64_tr_b16 v[220:221], v12 offset:20480
s_waitcnt lgkmcnt(3)
v_mov_b32 v236, v246
v_mfma_f32_16x16x32_bf16 a[64:67], v[4:7], v[208:211], a[64:67]
ds_read_b64_tr_b16 v[222:223], v12 offset:22528
v_mov_b32 v238, v247
v_mfma_f32_16x16x32_bf16 a[64:67], v[8:11], v[212:215], a[64:67]
s_mov_b32 exec_hi, 0
buffer_store_dwordx2 v[232:233], v242, s[24:27], s48 offen sc1
s_lshr_b32 s3, s41, 2
buffer_store_dwordx2 v[234:235], v242, s[24:27], s3 offen sc1
s_lshr_b32 s3, s42, 2
buffer_store_dwordx2 v[236:237], v242, s[24:27], s3 offen sc1
s_lshr_b32 s3, s43, 2
buffer_store_dwordx2 v[238:239], v242, s[24:27], s3 offen sc1
s_mov_b32 exec_hi, -1
v_mfma_f32_16x16x32_bf16 a[68:71], v[36:39], v[208:211], a[68:71]
v_accvgpr_read_b32 v128, a0
v_accvgpr_read_b32 v129, a1
v_accvgpr_read_b32 v130, a2
v_mfma_f32_16x16x32_bf16 a[68:71], v[40:43], v[212:215], a[68:71]
v_accvgpr_read_b32 v131, a3
v_cvt_pk_bf16_f32 v16, v128, v129
v_cvt_pk_bf16_f32 v17, v130, v131
v_mfma_f32_16x16x32_bf16 a[72:75], v[68:71], v[208:211], a[72:75]
v_accvgpr_read_b32 v136, a4
v_accvgpr_read_b32 v137, a5
v_accvgpr_read_b32 v138, a6
v_mfma_f32_16x16x32_bf16 a[72:75], v[72:75], v[212:215], a[72:75]
v_accvgpr_read_b32 v139, a7
v_cvt_pk_bf16_f32 v48, v136, v137
v_cvt_pk_bf16_f32 v49, v138, v139
v_mfma_f32_16x16x32_bf16 a[76:79], v[100:103], v[208:211], a[76:79]
ds_read_b64_tr_b16 v[208:209], v14 offset:4096
v_accvgpr_read_b32 v144, a8
v_accvgpr_read_b32 v145, a9
v_mfma_f32_16x16x32_bf16 a[76:79], v[104:107], v[212:215], a[76:79]
ds_read_b64_tr_b16 v[210:211], v14 offset:6144
ds_read_b64_tr_b16 v[212:213], v250 offset:4096
s_waitcnt lgkmcnt(3)
v_mfma_f32_16x16x32_bf16 a[64:67], v[160:163], v[216:219], a[64:67]
ds_read_b64_tr_b16 v[214:215], v250 offset:6144
v_accvgpr_read_b32 v146, a10
v_accvgpr_read_b32 v147, a11
v_mfma_f32_16x16x32_bf16 a[64:67], v[176:179], v[220:223], a[64:67]
v_cvt_pk_bf16_f32 v80, v144, v145
v_cvt_pk_bf16_f32 v81, v146, v147
v_accvgpr_read_b32 v152, a12
v_mfma_f32_16x16x32_bf16 a[68:71], v[164:167], v[216:219], a[68:71]
v_accvgpr_read_b32 v153, a13
v_accvgpr_read_b32 v154, a14
v_accvgpr_read_b32 v155, a15
v_mfma_f32_16x16x32_bf16 a[68:71], v[180:183], v[220:223], a[68:71]
v_cvt_pk_bf16_f32 v112, v152, v153
v_cvt_pk_bf16_f32 v113, v154, v155
v_accvgpr_read_b32 v132, a16
v_mfma_f32_16x16x32_bf16 a[72:75], v[168:171], v[216:219], a[72:75]
v_accvgpr_read_b32 v133, a17
v_accvgpr_read_b32 v134, a18
v_accvgpr_read_b32 v135, a19
v_mfma_f32_16x16x32_bf16 a[72:75], v[184:187], v[220:223], a[72:75]
v_cvt_pk_bf16_f32 v18, v132, v133
v_cvt_pk_bf16_f32 v19, v134, v135
buffer_store_dwordx4 v[16:19], v248, s[20:23], s40 offen offset:0 sc1
v_mfma_f32_16x16x32_bf16 a[76:79], v[172:175], v[216:219], a[76:79]
ds_read_b64_tr_b16 v[216:217], v250 offset:20480
ds_write_b128 v253, v[16:19] offset:0
v_accvgpr_read_b32 v140, a20
v_mfma_f32_16x16x32_bf16 a[76:79], v[188:191], v[220:223], a[76:79]
ds_read_b64_tr_b16 v[218:219], v250 offset:22528
ds_read_b64_tr_b16 v[220:221], v13 offset:4096
s_waitcnt lgkmcnt(5)
v_mfma_f32_16x16x32_bf16 a[64:67], v[0:3], v[208:211], a[64:67]
ds_read_b64_tr_b16 v[222:223], v13 offset:6144
v_accvgpr_read_b32 v141, a21
v_accvgpr_read_b32 v142, a22
v_mfma_f32_16x16x32_bf16 a[68:71], v[32:35], v[208:211], a[68:71]
v_accvgpr_read_b32 v143, a23
v_cvt_pk_bf16_f32 v50, v140, v141
v_cvt_pk_bf16_f32 v51, v142, v143
v_mfma_f32_16x16x32_bf16 a[72:75], v[64:67], v[208:211], a[72:75]
buffer_store_dwordx4 v[48:51], v248, s[20:23], s41 offen offset:0 sc1
v_accvgpr_read_b32 v148, a24
v_accvgpr_read_b32 v149, a25
v_mfma_f32_16x16x32_bf16 a[76:79], v[96:99], v[208:211], a[76:79]
ds_read_b64_tr_b16 v[208:209], v13 offset:20480
s_waitcnt lgkmcnt(5)
v_accvgpr_read_b32 v150, a26
v_mfma_f32_16x16x32_bf16 a[80:83], v[4:7], v[212:215], a[80:83]
ds_read_b64_tr_b16 v[210:211], v13 offset:22528
v_accvgpr_read_b32 v151, a27
v_cvt_pk_bf16_f32 v82, v148, v149
v_mfma_f32_16x16x32_bf16 a[84:87], v[36:39], v[212:215], a[84:87]
v_cvt_pk_bf16_f32 v83, v150, v151
buffer_store_dwordx4 v[80:83], v248, s[20:23], s42 offen offset:0 sc1
v_accvgpr_read_b32 v156, a28
v_mfma_f32_16x16x32_bf16 a[88:91], v[68:71], v[212:215], a[88:91]
v_accvgpr_read_b32 v157, a29
v_accvgpr_read_b32 v158, a30
v_accvgpr_read_b32 v159, a31
v_mfma_f32_16x16x32_bf16 a[92:95], v[100:103], v[212:215], a[92:95]
ds_read_b64_tr_b16 v[212:213], v15 offset:4096
s_waitcnt lgkmcnt(3)
v_cvt_pk_bf16_f32 v114, v156, v157
v_mfma_f32_16x16x32_bf16 a[80:83], v[8:11], v[216:219], a[80:83]
ds_read_b64_tr_b16 v[214:215], v15 offset:6144
v_cvt_pk_bf16_f32 v115, v158, v159
buffer_store_dwordx4 v[112:115], v248, s[20:23], s43 offen offset:0 sc1
v_mfma_f32_16x16x32_bf16 a[80:83], v[160:163], v[220:223], a[80:83]
v_accvgpr_read_b32 v128, a32
v_accvgpr_read_b32 v129, a33
v_accvgpr_read_b32 v130, a34
v_mfma_f32_16x16x32_bf16 a[84:87], v[40:43], v[216:219], a[84:87]
v_accvgpr_read_b32 v131, a35
v_cvt_pk_bf16_f32 v20, v128, v129
v_cvt_pk_bf16_f32 v21, v130, v131
v_mfma_f32_16x16x32_bf16 a[84:87], v[164:167], v[220:223], a[84:87]
v_accvgpr_read_b32 v136, a36
v_accvgpr_read_b32 v137, a37
v_accvgpr_read_b32 v138, a38
v_mfma_f32_16x16x32_bf16 a[88:91], v[72:75], v[216:219], a[88:91]
v_accvgpr_read_b32 v139, a39
v_cvt_pk_bf16_f32 v52, v136, v137
v_cvt_pk_bf16_f32 v53, v138, v139
v_mfma_f32_16x16x32_bf16 a[88:91], v[168:171], v[220:223], a[88:91]
v_accvgpr_read_b32 v144, a40
v_accvgpr_read_b32 v145, a41
v_accvgpr_read_b32 v146, a42
v_mfma_f32_16x16x32_bf16 a[92:95], v[104:107], v[216:219], a[92:95]
ds_read_b64_tr_b16 v[216:217], v249 offset:4608
v_accvgpr_read_b32 v147, a43
v_cvt_pk_bf16_f32 v84, v144, v145
v_mfma_f32_16x16x32_bf16 a[92:95], v[172:175], v[220:223], a[92:95]
ds_read_b64_tr_b16 v[218:219], v249 offset:6656
ds_read_b64_tr_b16 v[220:221], v249 offset:20992
s_waitcnt lgkmcnt(3)
v_mfma_f32_16x16x32_bf16 a[80:83], v[176:179], v[208:211], a[80:83]
ds_read_b64_tr_b16 v[222:223], v249 offset:23040
v_cvt_pk_bf16_f32 v85, v146, v147
v_accvgpr_read_b32 v152, a44
v_mfma_f32_16x16x32_bf16 a[80:83], v[0:3], v[212:215], a[80:83]
v_accvgpr_read_b32 v153, a45
v_accvgpr_read_b32 v154, a46
v_accvgpr_read_b32 v155, a47
v_mfma_f32_16x16x32_bf16 a[84:87], v[180:183], v[208:211], a[84:87]
v_cvt_pk_bf16_f32 v116, v152, v153
v_cvt_pk_bf16_f32 v117, v154, v155
v_accvgpr_read_b32 v132, a48
v_mfma_f32_16x16x32_bf16 a[84:87], v[32:35], v[212:215], a[84:87]
v_accvgpr_read_b32 v133, a49
v_accvgpr_read_b32 v134, a50
v_accvgpr_read_b32 v135, a51
v_mfma_f32_16x16x32_bf16 a[88:91], v[184:187], v[208:211], a[88:91]
v_cvt_pk_bf16_f32 v22, v132, v133
v_cvt_pk_bf16_f32 v23, v134, v135
buffer_store_dwordx4 v[20:23], v248, s[20:23], s40 offen offset:1024 sc1
v_mfma_f32_16x16x32_bf16 a[88:91], v[64:67], v[212:215], a[88:91]
ds_write_b128 v253, v[20:23] offset:1024
v_accvgpr_read_b32 v140, a52
v_accvgpr_read_b32 v141, a53
v_mfma_f32_16x16x32_bf16 a[92:95], v[188:191], v[208:211], a[92:95]
ds_read_b64_tr_b16 v[208:209], v12 offset:4608
v_accvgpr_read_b32 v142, a54
v_accvgpr_read_b32 v143, a55
v_mfma_f32_16x16x32_bf16 a[92:95], v[96:99], v[212:215], a[92:95]
ds_read_b64_tr_b16 v[210:211], v12 offset:6656
ds_read_b64_tr_b16 v[212:213], v12 offset:20992
s_waitcnt lgkmcnt(3)
v_mfma_f32_16x16x32_bf16 a[96:99], v[4:7], v[216:219], a[96:99]
ds_read_b64_tr_b16 v[214:215], v12 offset:23040
v_cvt_pk_bf16_f32 v54, v140, v141
v_cvt_pk_bf16_f32 v55, v142, v143
v_mfma_f32_16x16x32_bf16 a[96:99], v[8:11], v[220:223], a[96:99]
buffer_store_dwordx4 v[52:55], v248, s[20:23], s41 offen offset:1024 sc1
v_accvgpr_read_b32 v148, a56
v_accvgpr_read_b32 v149, a57
v_mfma_f32_16x16x32_bf16 a[100:103], v[36:39], v[216:219], a[100:103]
v_accvgpr_read_b32 v150, a58
v_accvgpr_read_b32 v151, a59
v_cvt_pk_bf16_f32 v86, v148, v149
v_mfma_f32_16x16x32_bf16 a[100:103], v[40:43], v[220:223], a[100:103]
v_cvt_pk_bf16_f32 v87, v150, v151
buffer_store_dwordx4 v[84:87], v248, s[20:23], s42 offen offset:1024 sc1
v_accvgpr_read_b32 v156, a60
v_mfma_f32_16x16x32_bf16 a[104:107], v[68:71], v[216:219], a[104:107]
v_accvgpr_read_b32 v157, a61
v_accvgpr_read_b32 v158, a62
v_accvgpr_read_b32 v159, a63
v_mfma_f32_16x16x32_bf16 a[104:107], v[72:75], v[220:223], a[104:107]
v_cvt_pk_bf16_f32 v118, v156, v157
v_cvt_pk_bf16_f32 v119, v158, v159
buffer_store_dwordx4 v[116:119], v248, s[20:23], s43 offen offset:1024 sc1
v_mfma_f32_16x16x32_bf16 a[108:111], v[100:103], v[216:219], a[108:111]
ds_read_b64_tr_b16 v[216:217], v14 offset:4608
v_accvgpr_read_b32 v128, a64
v_accvgpr_read_b32 v129, a65
v_mfma_f32_16x16x32_bf16 a[108:111], v[104:107], v[220:223], a[108:111]
ds_read_b64_tr_b16 v[218:219], v14 offset:6656
ds_read_b64_tr_b16 v[220:221], v250 offset:4608
s_waitcnt lgkmcnt(3)
v_mfma_f32_16x16x32_bf16 a[96:99], v[160:163], v[208:211], a[96:99]
ds_read_b64_tr_b16 v[222:223], v250 offset:6656
v_accvgpr_read_b32 v130, a66
v_accvgpr_read_b32 v131, a67
v_mfma_f32_16x16x32_bf16 a[96:99], v[176:179], v[212:215], a[96:99]
v_cvt_pk_bf16_f32 v24, v128, v129
v_cvt_pk_bf16_f32 v25, v130, v131
v_accvgpr_read_b32 v136, a68
v_mfma_f32_16x16x32_bf16 a[100:103], v[164:167], v[208:211], a[100:103]
v_accvgpr_read_b32 v137, a69
v_accvgpr_read_b32 v138, a70
v_accvgpr_read_b32 v139, a71
v_mfma_f32_16x16x32_bf16 a[100:103], v[180:183], v[212:215], a[100:103]
v_cvt_pk_bf16_f32 v56, v136, v137
v_cvt_pk_bf16_f32 v57, v138, v139
v_accvgpr_read_b32 v144, a72
v_mfma_f32_16x16x32_bf16 a[104:107], v[168:171], v[208:211], a[104:107]
v_accvgpr_read_b32 v145, a73
v_accvgpr_read_b32 v146, a74
v_accvgpr_read_b32 v147, a75
v_mfma_f32_16x16x32_bf16 a[104:107], v[184:187], v[212:215], a[104:107]
v_cvt_pk_bf16_f32 v88, v144, v145
v_cvt_pk_bf16_f32 v89, v146, v147
v_accvgpr_read_b32 v152, a76
v_mfma_f32_16x16x32_bf16 a[108:111], v[172:175], v[208:211], a[108:111]
ds_read_b64_tr_b16 v[208:209], v250 offset:20992
v_accvgpr_read_b32 v153, a77
v_accvgpr_read_b32 v154, a78
v_mfma_f32_16x16x32_bf16 a[108:111], v[188:191], v[212:215], a[108:111]
ds_read_b64_tr_b16 v[210:211], v250 offset:23040
ds_read_b64_tr_b16 v[212:213], v13 offset:4608
s_waitcnt lgkmcnt(5)
v_mfma_f32_16x16x32_bf16 a[96:99], v[0:3], v[216:219], a[96:99]
ds_read_b64_tr_b16 v[214:215], v13 offset:6656
v_accvgpr_read_b32 v155, a79
v_cvt_pk_bf16_f32 v120, v152, v153
v_mfma_f32_16x16x32_bf16 a[100:103], v[32:35], v[216:219], a[100:103]
v_cvt_pk_bf16_f32 v121, v154, v155
v_accvgpr_read_b32 v132, a80
v_accvgpr_read_b32 v133, a81
v_mfma_f32_16x16x32_bf16 a[104:107], v[64:67], v[216:219], a[104:107]
v_accvgpr_read_b32 v134, a82
v_accvgpr_read_b32 v135, a83
v_cvt_pk_bf16_f32 v26, v132, v133
v_mfma_f32_16x16x32_bf16 a[108:111], v[96:99], v[216:219], a[108:111]
ds_read_b64_tr_b16 v[216:217], v13 offset:20992
s_waitcnt lgkmcnt(5)
v_cvt_pk_bf16_f32 v27, v134, v135
v_mfma_f32_16x16x32_bf16 a[112:115], v[4:7], v[220:223], a[112:115]
ds_read_b64_tr_b16 v[218:219], v13 offset:23040
buffer_store_dwordx4 v[24:27], v248, s[20:23], s40 offen offset:2048 sc1
ds_write_b128 v253, v[24:27] offset:2048
v_mfma_f32_16x16x32_bf16 a[116:119], v[36:39], v[220:223], a[116:119]
v_accvgpr_read_b32 v140, a84
v_accvgpr_read_b32 v141, a85
v_accvgpr_read_b32 v142, a86
v_mfma_f32_16x16x32_bf16 a[120:123], v[68:71], v[220:223], a[120:123]
v_accvgpr_read_b32 v143, a87
v_cvt_pk_bf16_f32 v58, v140, v141
v_cvt_pk_bf16_f32 v59, v142, v143
v_mfma_f32_16x16x32_bf16 a[124:127], v[100:103], v[220:223], a[124:127]
ds_read_b64_tr_b16 v[220:221], v15 offset:4608
s_waitcnt lgkmcnt(3)
buffer_store_dwordx4 v[56:59], v248, s[20:23], s41 offen offset:2048 sc1
v_mfma_f32_16x16x32_bf16 a[112:115], v[8:11], v[208:211], a[112:115]
ds_read_b64_tr_b16 v[222:223], v15 offset:6656
v_accvgpr_read_b32 v148, a88
v_accvgpr_read_b32 v149, a89
v_mfma_f32_16x16x32_bf16 a[112:115], v[160:163], v[212:215], a[112:115]
v_accvgpr_read_b32 v150, a90
v_accvgpr_read_b32 v151, a91
v_cvt_pk_bf16_f32 v90, v148, v149
v_mfma_f32_16x16x32_bf16 a[116:119], v[40:43], v[208:211], a[116:119]
v_cvt_pk_bf16_f32 v91, v150, v151
buffer_store_dwordx4 v[88:91], v248, s[20:23], s42 offen offset:2048 sc1
v_accvgpr_read_b32 v156, a92
v_mfma_f32_16x16x32_bf16 a[116:119], v[164:167], v[212:215], a[116:119]
v_accvgpr_read_b32 v157, a93
v_accvgpr_read_b32 v158, a94
v_accvgpr_read_b32 v159, a95
v_mfma_f32_16x16x32_bf16 a[120:123], v[72:75], v[208:211], a[120:123]
v_cvt_pk_bf16_f32 v122, v156, v157
v_cvt_pk_bf16_f32 v123, v158, v159
buffer_store_dwordx4 v[120:123], v248, s[20:23], s43 offen offset:2048 sc1
v_mfma_f32_16x16x32_bf16 a[120:123], v[168:171], v[212:215], a[120:123]
v_accvgpr_read_b32 v128, a96
v_accvgpr_read_b32 v129, a97
v_mfma_f32_16x16x32_bf16 a[124:127], v[104:107], v[208:211], a[124:127]
ds_read_b64_tr_b16 v[208:209], v249 offset:8192
v_accvgpr_read_b32 v130, a98
v_mfma_f32_16x16x32_bf16 a[124:127], v[172:175], v[212:215], a[124:127]
ds_read_b64_tr_b16 v[210:211], v249 offset:10240
ds_read_b64_tr_b16 v[212:213], v249 offset:24576
s_waitcnt lgkmcnt(3)
v_mfma_f32_16x16x32_bf16 a[112:115], v[176:179], v[216:219], a[112:115]
ds_read_b64_tr_b16 v[214:215], v249 offset:26624
v_accvgpr_read_b32 v131, a99
v_mfma_f32_16x16x32_bf16 a[112:115], v[0:3], v[220:223], a[112:115]
v_cvt_pk_bf16_f32 v28, v128, v129
v_cvt_pk_bf16_f32 v29, v130, v131
v_mfma_f32_16x16x32_bf16 a[116:119], v[180:183], v[216:219], a[116:119]
v_accvgpr_read_b32 v136, a100
v_accvgpr_read_b32 v137, a101
v_mfma_f32_16x16x32_bf16 a[116:119], v[32:35], v[220:223], a[116:119]
v_accvgpr_read_b32 v138, a102
v_accvgpr_read_b32 v139, a103
v_mfma_f32_16x16x32_bf16 a[120:123], v[184:187], v[216:219], a[120:123]
v_cvt_pk_bf16_f32 v60, v136, v137
v_cvt_pk_bf16_f32 v61, v138, v139
v_mfma_f32_16x16x32_bf16 a[120:123], v[64:67], v[220:223], a[120:123]
v_accvgpr_read_b32 v144, a104
v_accvgpr_read_b32 v145, a105
v_mfma_f32_16x16x32_bf16 a[124:127], v[188:191], v[216:219], a[124:127]
ds_read_b64_tr_b16 v[216:217], v12 offset:8192
v_accvgpr_read_b32 v146, a106
v_mfma_f32_16x16x32_bf16 a[124:127], v[96:99], v[220:223], a[124:127]
ds_read_b64_tr_b16 v[218:219], v12 offset:10240
ds_read_b64_tr_b16 v[220:221], v12 offset:24576
s_waitcnt lgkmcnt(3)
v_mfma_f32_16x16x32_bf16 a[128:131], v[4:7], v[208:211], a[128:131]
ds_read_b64_tr_b16 v[222:223], v12 offset:26624
v_accvgpr_read_b32 v147, a107
v_mfma_f32_16x16x32_bf16 a[128:131], v[8:11], v[212:215], a[128:131]
v_cvt_pk_bf16_f32 v92, v144, v145
v_cvt_pk_bf16_f32 v93, v146, v147
v_mfma_f32_16x16x32_bf16 a[132:135], v[36:39], v[208:211], a[132:135]
v_accvgpr_read_b32 v152, a108
v_accvgpr_read_b32 v153, a109
v_mfma_f32_16x16x32_bf16 a[132:135], v[40:43], v[212:215], a[132:135]
v_accvgpr_read_b32 v154, a110
v_accvgpr_read_b32 v155, a111
v_mfma_f32_16x16x32_bf16 a[136:139], v[68:71], v[208:211], a[136:139]
v_cvt_pk_bf16_f32 v124, v152, v153
v_cvt_pk_bf16_f32 v125, v154, v155
v_mfma_f32_16x16x32_bf16 a[136:139], v[72:75], v[212:215], a[136:139]
v_accvgpr_read_b32 v132, a112
v_accvgpr_read_b32 v133, a113
v_mfma_f32_16x16x32_bf16 a[140:143], v[100:103], v[208:211], a[140:143]
ds_read_b64_tr_b16 v[208:209], v14 offset:8192
v_accvgpr_read_b32 v134, a114
v_mfma_f32_16x16x32_bf16 a[140:143], v[104:107], v[212:215], a[140:143]
ds_read_b64_tr_b16 v[210:211], v14 offset:10240
ds_read_b64_tr_b16 v[212:213], v250 offset:8192
s_waitcnt lgkmcnt(3)
v_mfma_f32_16x16x32_bf16 a[128:131], v[160:163], v[216:219], a[128:131]
ds_read_b64_tr_b16 v[214:215], v250 offset:10240
v_accvgpr_read_b32 v135, a115
v_mfma_f32_16x16x32_bf16 a[128:131], v[176:179], v[220:223], a[128:131]
v_cvt_pk_bf16_f32 v30, v132, v133
v_cvt_pk_bf16_f32 v31, v134, v135
v_mfma_f32_16x16x32_bf16 a[132:135], v[164:167], v[216:219], a[132:135]
buffer_store_dwordx4 v[28:31], v248, s[20:23], s40 offen offset:3072 sc1
ds_write_b128 v253, v[28:31] offset:3072
v_mfma_f32_16x16x32_bf16 a[132:135], v[180:183], v[220:223], a[132:135]
v_accvgpr_read_b32 v140, a116
v_accvgpr_read_b32 v141, a117
v_mfma_f32_16x16x32_bf16 a[136:139], v[168:171], v[216:219], a[136:139]
v_accvgpr_read_b32 v142, a118
v_accvgpr_read_b32 v143, a119
v_mfma_f32_16x16x32_bf16 a[136:139], v[184:187], v[220:223], a[136:139]
v_cvt_pk_bf16_f32 v62, v140, v141
v_cvt_pk_bf16_f32 v63, v142, v143
v_mfma_f32_16x16x32_bf16 a[140:143], v[172:175], v[216:219], a[140:143]
ds_read_b64_tr_b16 v[216:217], v250 offset:24576
buffer_store_dwordx4 v[60:63], v248, s[20:23], s41 offen offset:3072 sc1
v_mfma_f32_16x16x32_bf16 a[140:143], v[188:191], v[220:223], a[140:143]
ds_read_b64_tr_b16 v[218:219], v250 offset:26624
ds_read_b64_tr_b16 v[220:221], v13 offset:8192
s_waitcnt lgkmcnt(5)
v_mfma_f32_16x16x32_bf16 a[128:131], v[0:3], v[208:211], a[128:131]
ds_read_b64_tr_b16 v[222:223], v13 offset:10240
v_accvgpr_read_b32 v148, a120
v_mfma_f32_16x16x32_bf16 a[132:135], v[32:35], v[208:211], a[132:135]
v_accvgpr_read_b32 v149, a121
v_accvgpr_read_b32 v150, a122
v_mfma_f32_16x16x32_bf16 a[136:139], v[64:67], v[208:211], a[136:139]
v_accvgpr_read_b32 v151, a123
v_cvt_pk_bf16_f32 v94, v148, v149
v_mfma_f32_16x16x32_bf16 a[140:143], v[96:99], v[208:211], a[140:143]
ds_read_b64_tr_b16 v[208:209], v13 offset:24576
s_waitcnt lgkmcnt(5)
v_mfma_f32_16x16x32_bf16 a[144:147], v[4:7], v[212:215], a[144:147]
ds_read_b64_tr_b16 v[210:211], v13 offset:26624
v_cvt_pk_bf16_f32 v95, v150, v151
v_mfma_f32_16x16x32_bf16 a[148:151], v[36:39], v[212:215], a[148:151]
buffer_store_dwordx4 v[92:95], v248, s[20:23], s42 offen offset:3072 sc1
v_accvgpr_read_b32 v156, a124
v_mfma_f32_16x16x32_bf16 a[152:155], v[68:71], v[212:215], a[152:155]
v_accvgpr_read_b32 v157, a125
v_accvgpr_read_b32 v158, a126
v_mfma_f32_16x16x32_bf16 a[156:159], v[100:103], v[212:215], a[156:159]
ds_read_b64_tr_b16 v[212:213], v15 offset:8192
s_waitcnt lgkmcnt(3)
v_mfma_f32_16x16x32_bf16 a[144:147], v[8:11], v[216:219], a[144:147]
ds_read_b64_tr_b16 v[214:215], v15 offset:10240
v_accvgpr_read_b32 v159, a127
v_mfma_f32_16x16x32_bf16 a[144:147], v[160:163], v[220:223], a[144:147]
v_cvt_pk_bf16_f32 v126, v156, v157
v_cvt_pk_bf16_f32 v127, v158, v159
v_mfma_f32_16x16x32_bf16 a[148:151], v[40:43], v[216:219], a[148:151]
buffer_store_dwordx4 v[124:127], v248, s[20:23], s43 offen offset:3072 sc1
v_accvgpr_read_b32 v128, a128
v_mfma_f32_16x16x32_bf16 a[148:151], v[164:167], v[220:223], a[148:151]
v_accvgpr_read_b32 v129, a129
v_accvgpr_read_b32 v130, a130
v_mfma_f32_16x16x32_bf16 a[152:155], v[72:75], v[216:219], a[152:155]
v_accvgpr_read_b32 v131, a131
v_cvt_pk_bf16_f32 v16, v128, v129
v_mfma_f32_16x16x32_bf16 a[152:155], v[168:171], v[220:223], a[152:155]
v_cvt_pk_bf16_f32 v17, v130, v131
v_accvgpr_read_b32 v136, a132
v_mfma_f32_16x16x32_bf16 a[156:159], v[104:107], v[216:219], a[156:159]
ds_read_b64_tr_b16 v[216:217], v249 offset:8704
v_accvgpr_read_b32 v137, a133
v_mfma_f32_16x16x32_bf16 a[156:159], v[172:175], v[220:223], a[156:159]
ds_read_b64_tr_b16 v[218:219], v249 offset:10752
ds_read_b64_tr_b16 v[220:221], v249 offset:25088
s_waitcnt lgkmcnt(3)
v_mfma_f32_16x16x32_bf16 a[144:147], v[176:179], v[208:211], a[144:147]
ds_read_b64_tr_b16 v[222:223], v249 offset:27136
v_accvgpr_read_b32 v138, a134
v_mfma_f32_16x16x32_bf16 a[144:147], v[0:3], v[212:215], a[144:147]
v_accvgpr_read_b32 v139, a135
v_cvt_pk_bf16_f32 v48, v136, v137
v_mfma_f32_16x16x32_bf16 a[148:151], v[180:183], v[208:211], a[148:151]
v_cvt_pk_bf16_f32 v49, v138, v139
v_accvgpr_read_b32 v144, a136
v_mfma_f32_16x16x32_bf16 a[148:151], v[32:35], v[212:215], a[148:151]
v_accvgpr_read_b32 v145, a137
v_accvgpr_read_b32 v146, a138
v_mfma_f32_16x16x32_bf16 a[152:155], v[184:187], v[208:211], a[152:155]
v_accvgpr_read_b32 v147, a139
v_cvt_pk_bf16_f32 v80, v144, v145
v_mfma_f32_16x16x32_bf16 a[152:155], v[64:67], v[212:215], a[152:155]
v_cvt_pk_bf16_f32 v81, v146, v147
v_accvgpr_read_b32 v152, a140
v_mfma_f32_16x16x32_bf16 a[156:159], v[188:191], v[208:211], a[156:159]
ds_read_b64_tr_b16 v[208:209], v12 offset:8704
v_accvgpr_read_b32 v153, a141
v_mfma_f32_16x16x32_bf16 a[156:159], v[96:99], v[212:215], a[156:159]
ds_read_b64_tr_b16 v[210:211], v12 offset:10752
ds_read_b64_tr_b16 v[212:213], v12 offset:25088
s_waitcnt lgkmcnt(3)
v_mfma_f32_16x16x32_bf16 a[160:163], v[4:7], v[216:219], a[160:163]
ds_read_b64_tr_b16 v[214:215], v12 offset:27136
v_accvgpr_read_b32 v154, a142
v_mfma_f32_16x16x32_bf16 a[160:163], v[8:11], v[220:223], a[160:163]
v_accvgpr_read_b32 v155, a143
v_cvt_pk_bf16_f32 v112, v152, v153
v_mfma_f32_16x16x32_bf16 a[164:167], v[36:39], v[216:219], a[164:167]
v_cvt_pk_bf16_f32 v113, v154, v155
v_accvgpr_read_b32 v132, a144
v_mfma_f32_16x16x32_bf16 a[164:167], v[40:43], v[220:223], a[164:167]
v_accvgpr_read_b32 v133, a145
v_accvgpr_read_b32 v134, a146
v_mfma_f32_16x16x32_bf16 a[168:171], v[68:71], v[216:219], a[168:171]
v_accvgpr_read_b32 v135, a147
v_cvt_pk_bf16_f32 v18, v132, v133
v_mfma_f32_16x16x32_bf16 a[168:171], v[72:75], v[220:223], a[168:171]
v_cvt_pk_bf16_f32 v19, v134, v135
buffer_store_dwordx4 v[16:19], v248, s[20:23], s44 offen offset:0 sc1
v_mfma_f32_16x16x32_bf16 a[172:175], v[100:103], v[216:219], a[172:175]
ds_read_b64_tr_b16 v[216:217], v14 offset:8704
ds_write_b128 v253, v[16:19] offset:4096
v_mfma_f32_16x16x32_bf16 a[172:175], v[104:107], v[220:223], a[172:175]
ds_read_b64_tr_b16 v[218:219], v14 offset:10752
ds_read_b64_tr_b16 v[220:221], v250 offset:8704
s_waitcnt lgkmcnt(3)
v_mfma_f32_16x16x32_bf16 a[160:163], v[160:163], v[208:211], a[160:163]
ds_read_b64_tr_b16 v[222:223], v250 offset:10752
v_accvgpr_read_b32 v140, a148
v_mfma_f32_16x16x32_bf16 a[160:163], v[176:179], v[212:215], a[160:163]
v_accvgpr_read_b32 v141, a149
v_accvgpr_read_b32 v142, a150
v_mfma_f32_16x16x32_bf16 a[164:167], v[164:167], v[208:211], a[164:167]
v_accvgpr_read_b32 v143, a151
v_cvt_pk_bf16_f32 v50, v140, v141
v_mfma_f32_16x16x32_bf16 a[164:167], v[180:183], v[212:215], a[164:167]
v_cvt_pk_bf16_f32 v51, v142, v143
buffer_store_dwordx4 v[48:51], v248, s[20:23], s45 offen offset:0 sc1
v_mfma_f32_16x16x32_bf16 a[168:171], v[168:171], v[208:211], a[168:171]
v_accvgpr_read_b32 v148, a152
v_accvgpr_read_b32 v149, a153
v_mfma_f32_16x16x32_bf16 a[168:171], v[184:187], v[212:215], a[168:171]
v_accvgpr_read_b32 v150, a154
v_accvgpr_read_b32 v151, a155
v_mfma_f32_16x16x32_bf16 a[172:175], v[172:175], v[208:211], a[172:175]
ds_read_b64_tr_b16 v[208:209], v250 offset:25088
v_cvt_pk_bf16_f32 v82, v148, v149
v_mfma_f32_16x16x32_bf16 a[172:175], v[188:191], v[212:215], a[172:175]
ds_read_b64_tr_b16 v[210:211], v250 offset:27136
ds_read_b64_tr_b16 v[212:213], v13 offset:8704
s_waitcnt lgkmcnt(5)
v_mfma_f32_16x16x32_bf16 a[160:163], v[0:3], v[216:219], a[160:163]
ds_read_b64_tr_b16 v[214:215], v13 offset:10752
v_cvt_pk_bf16_f32 v83, v150, v151
v_mfma_f32_16x16x32_bf16 a[164:167], v[32:35], v[216:219], a[164:167]
buffer_store_dwordx4 v[80:83], v248, s[20:23], s46 offen offset:0 sc1
v_accvgpr_read_b32 v156, a156
v_mfma_f32_16x16x32_bf16 a[168:171], v[64:67], v[216:219], a[168:171]
v_accvgpr_read_b32 v157, a157
v_accvgpr_read_b32 v158, a158
v_mfma_f32_16x16x32_bf16 a[172:175], v[96:99], v[216:219], a[172:175]
ds_read_b64_tr_b16 v[216:217], v13 offset:25088
s_waitcnt lgkmcnt(5)
v_mfma_f32_16x16x32_bf16 a[176:179], v[4:7], v[220:223], a[176:179]
ds_read_b64_tr_b16 v[218:219], v13 offset:27136
v_accvgpr_read_b32 v159, a159
v_mfma_f32_16x16x32_bf16 a[180:183], v[36:39], v[220:223], a[180:183]
v_cvt_pk_bf16_f32 v114, v156, v157
v_cvt_pk_bf16_f32 v115, v158, v159
v_mfma_f32_16x16x32_bf16 a[184:187], v[68:71], v[220:223], a[184:187]
buffer_store_dwordx4 v[112:115], v248, s[20:23], s47 offen offset:0 sc1
v_accvgpr_read_b32 v128, a160
v_mfma_f32_16x16x32_bf16 a[188:191], v[100:103], v[220:223], a[188:191]
ds_read_b64_tr_b16 v[220:221], v15 offset:8704
s_waitcnt lgkmcnt(3)
v_mfma_f32_16x16x32_bf16 a[176:179], v[8:11], v[208:211], a[176:179]
ds_read_b64_tr_b16 v[222:223], v15 offset:10752
v_accvgpr_read_b32 v129, a161
v_mfma_f32_16x16x32_bf16 a[176:179], v[160:163], v[212:215], a[176:179]
v_accvgpr_read_b32 v130, a162
v_accvgpr_read_b32 v131, a163
v_mfma_f32_16x16x32_bf16 a[180:183], v[40:43], v[208:211], a[180:183]
v_cvt_pk_bf16_f32 v20, v128, v129
v_cvt_pk_bf16_f32 v21, v130, v131
v_mfma_f32_16x16x32_bf16 a[180:183], v[164:167], v[212:215], a[180:183]
v_accvgpr_read_b32 v136, a164
v_accvgpr_read_b32 v137, a165
v_mfma_f32_16x16x32_bf16 a[184:187], v[72:75], v[208:211], a[184:187]
v_accvgpr_read_b32 v138, a166
v_accvgpr_read_b32 v139, a167
v_mfma_f32_16x16x32_bf16 a[184:187], v[168:171], v[212:215], a[184:187]
v_cvt_pk_bf16_f32 v52, v136, v137
v_cvt_pk_bf16_f32 v53, v138, v139
v_mfma_f32_16x16x32_bf16 a[188:191], v[104:107], v[208:211], a[188:191]
ds_read_b64_tr_b16 v[208:209], v249 offset:12288
v_accvgpr_read_b32 v144, a168
v_mfma_f32_16x16x32_bf16 a[188:191], v[172:175], v[212:215], a[188:191]
ds_read_b64_tr_b16 v[210:211], v249 offset:14336
ds_read_b64_tr_b16 v[212:213], v249 offset:28672
s_waitcnt lgkmcnt(3)
v_mfma_f32_16x16x32_bf16 a[176:179], v[176:179], v[216:219], a[176:179]
ds_read_b64_tr_b16 v[214:215], v249 offset:30720
v_accvgpr_read_b32 v145, a169
v_mfma_f32_16x16x32_bf16 a[176:179], v[0:3], v[220:223], a[176:179]
v_accvgpr_read_b32 v146, a170
v_accvgpr_read_b32 v147, a171
v_mfma_f32_16x16x32_bf16 a[180:183], v[180:183], v[216:219], a[180:183]
v_cvt_pk_bf16_f32 v84, v144, v145
v_cvt_pk_bf16_f32 v85, v146, v147
v_mfma_f32_16x16x32_bf16 a[180:183], v[32:35], v[220:223], a[180:183]
v_accvgpr_read_b32 v152, a172
v_accvgpr_read_b32 v153, a173
v_mfma_f32_16x16x32_bf16 a[184:187], v[184:187], v[216:219], a[184:187]
v_accvgpr_read_b32 v154, a174
v_accvgpr_read_b32 v155, a175
v_mfma_f32_16x16x32_bf16 a[184:187], v[64:67], v[220:223], a[184:187]
v_cvt_pk_bf16_f32 v116, v152, v153
v_cvt_pk_bf16_f32 v117, v154, v155
v_mfma_f32_16x16x32_bf16 a[188:191], v[188:191], v[216:219], a[188:191]
ds_read_b64_tr_b16 v[216:217], v12 offset:12288
v_mfma_f32_16x16x32_bf16 a[188:191], v[96:99], v[220:223], a[188:191]
ds_read_b64_tr_b16 v[218:219], v12 offset:14336
ds_read_b64_tr_b16 v[220:221], v12 offset:28672
s_waitcnt lgkmcnt(3)
v_mfma_f32_16x16x32_bf16 a[192:195], v[4:7], v[208:211], a[192:195]
ds_read_b64_tr_b16 v[222:223], v12 offset:30720
v_mfma_f32_16x16x32_bf16 a[192:195], v[8:11], v[212:215], a[192:195]
v_mfma_f32_16x16x32_bf16 a[196:199], v[36:39], v[208:211], a[196:199]
v_accvgpr_read_b32 v132, a176
v_accvgpr_read_b32 v133, a177
v_mfma_f32_16x16x32_bf16 a[196:199], v[40:43], v[212:215], a[196:199]
v_accvgpr_read_b32 v134, a178
v_accvgpr_read_b32 v135, a179
v_mfma_f32_16x16x32_bf16 a[200:203], v[68:71], v[208:211], a[200:203]
v_cvt_pk_bf16_f32 v22, v132, v133
v_cvt_pk_bf16_f32 v23, v134, v135
v_mfma_f32_16x16x32_bf16 a[200:203], v[72:75], v[212:215], a[200:203]
buffer_store_dwordx4 v[20:23], v248, s[20:23], s44 offen offset:1024 sc1
ds_write_b128 v253, v[20:23] offset:5120
v_mfma_f32_16x16x32_bf16 a[204:207], v[100:103], v[208:211], a[204:207]
ds_read_b64_tr_b16 v[208:209], v14 offset:12288
v_accvgpr_read_b32 v140, a180
v_mfma_f32_16x16x32_bf16 a[204:207], v[104:107], v[212:215], a[204:207]
ds_read_b64_tr_b16 v[210:211], v14 offset:14336
ds_read_b64_tr_b16 v[212:213], v250 offset:12288
s_waitcnt lgkmcnt(3)
v_mfma_f32_16x16x32_bf16 a[192:195], v[160:163], v[216:219], a[192:195]
ds_read_b64_tr_b16 v[214:215], v250 offset:14336
v_accvgpr_read_b32 v141, a181
v_mfma_f32_16x16x32_bf16 a[192:195], v[176:179], v[220:223], a[192:195]
v_accvgpr_read_b32 v142, a182
v_accvgpr_read_b32 v143, a183
v_mfma_f32_16x16x32_bf16 a[196:199], v[164:167], v[216:219], a[196:199]
v_cvt_pk_bf16_f32 v54, v140, v141
v_cvt_pk_bf16_f32 v55, v142, v143
v_mfma_f32_16x16x32_bf16 a[196:199], v[180:183], v[220:223], a[196:199]
buffer_store_dwordx4 v[52:55], v248, s[20:23], s45 offen offset:1024 sc1
v_accvgpr_read_b32 v148, a184
v_mfma_f32_16x16x32_bf16 a[200:203], v[168:171], v[216:219], a[200:203]
v_accvgpr_read_b32 v149, a185
v_accvgpr_read_b32 v150, a186
v_mfma_f32_16x16x32_bf16 a[200:203], v[184:187], v[220:223], a[200:203]
v_accvgpr_read_b32 v151, a187
v_cvt_pk_bf16_f32 v86, v148, v149
v_mfma_f32_16x16x32_bf16 a[204:207], v[172:175], v[216:219], a[204:207]
ds_read_b64_tr_b16 v[216:217], v250 offset:28672
v_cvt_pk_bf16_f32 v87, v150, v151
v_mfma_f32_16x16x32_bf16 a[204:207], v[188:191], v[220:223], a[204:207]
ds_read_b64_tr_b16 v[218:219], v250 offset:30720
ds_read_b64_tr_b16 v[220:221], v13 offset:12288
s_waitcnt lgkmcnt(5)
v_mfma_f32_16x16x32_bf16 a[192:195], v[0:3], v[208:211], a[192:195]
ds_read_b64_tr_b16 v[222:223], v13 offset:14336
buffer_store_dwordx4 v[84:87], v248, s[20:23], s46 offen offset:1024 sc1
v_mfma_f32_16x16x32_bf16 a[196:199], v[32:35], v[208:211], a[196:199]
v_accvgpr_read_b32 v156, a188
v_accvgpr_read_b32 v157, a189
v_mfma_f32_16x16x32_bf16 a[200:203], v[64:67], v[208:211], a[200:203]
v_accvgpr_read_b32 v158, a190
v_accvgpr_read_b32 v159, a191
v_mfma_f32_16x16x32_bf16 a[204:207], v[96:99], v[208:211], a[204:207]
ds_read_b64_tr_b16 v[208:209], v13 offset:28672
s_waitcnt lgkmcnt(5)
v_mfma_f32_16x16x32_bf16 a[208:211], v[4:7], v[212:215], a[208:211]
ds_read_b64_tr_b16 v[210:211], v13 offset:30720
v_cvt_pk_bf16_f32 v118, v156, v157
v_mfma_f32_16x16x32_bf16 a[212:215], v[36:39], v[212:215], a[212:215]
v_cvt_pk_bf16_f32 v119, v158, v159
buffer_store_dwordx4 v[116:119], v248, s[20:23], s47 offen offset:1024 sc1
v_mfma_f32_16x16x32_bf16 a[216:219], v[68:71], v[212:215], a[216:219]
v_accvgpr_read_b32 v128, a192
v_accvgpr_read_b32 v129, a193
v_mfma_f32_16x16x32_bf16 a[220:223], v[100:103], v[212:215], a[220:223]
ds_read_b64_tr_b16 v[212:213], v15 offset:12288
s_waitcnt lgkmcnt(3)
v_mfma_f32_16x16x32_bf16 a[208:211], v[8:11], v[216:219], a[208:211]
ds_read_b64_tr_b16 v[214:215], v15 offset:14336
v_accvgpr_read_b32 v130, a194
v_mfma_f32_16x16x32_bf16 a[208:211], v[160:163], v[220:223], a[208:211]
v_accvgpr_read_b32 v131, a195
v_cvt_pk_bf16_f32 v24, v128, v129
v_mfma_f32_16x16x32_bf16 a[212:215], v[40:43], v[216:219], a[212:215]
v_cvt_pk_bf16_f32 v25, v130, v131
v_accvgpr_read_b32 v136, a196
v_mfma_f32_16x16x32_bf16 a[212:215], v[164:167], v[220:223], a[212:215]
v_accvgpr_read_b32 v137, a197
v_accvgpr_read_b32 v138, a198
v_mfma_f32_16x16x32_bf16 a[216:219], v[72:75], v[216:219], a[216:219]
v_accvgpr_read_b32 v139, a199
v_cvt_pk_bf16_f32 v56, v136, v137
v_mfma_f32_16x16x32_bf16 a[216:219], v[168:171], v[220:223], a[216:219]
v_cvt_pk_bf16_f32 v57, v138, v139
v_accvgpr_read_b32 v144, a200
v_mfma_f32_16x16x32_bf16 a[220:223], v[104:107], v[216:219], a[220:223]
ds_read_b64_tr_b16 v[216:217], v249 offset:12800
v_accvgpr_read_b32 v145, a201
v_mfma_f32_16x16x32_bf16 a[220:223], v[172:175], v[220:223], a[220:223]
ds_read_b64_tr_b16 v[218:219], v249 offset:14848
ds_read_b64_tr_b16 v[220:221], v249 offset:29184
s_waitcnt lgkmcnt(3)
v_mfma_f32_16x16x32_bf16 a[208:211], v[176:179], v[208:211], a[208:211]
ds_read_b64_tr_b16 v[222:223], v249 offset:31232
v_accvgpr_read_b32 v146, a202
v_mfma_f32_16x16x32_bf16 a[208:211], v[0:3], v[212:215], a[208:211]
v_accvgpr_read_b32 v147, a203
v_cvt_pk_bf16_f32 v88, v144, v145
v_mfma_f32_16x16x32_bf16 a[212:215], v[180:183], v[208:211], a[212:215]
v_cvt_pk_bf16_f32 v89, v146, v147
v_accvgpr_read_b32 v152, a204
v_mfma_f32_16x16x32_bf16 a[212:215], v[32:35], v[212:215], a[212:215]
v_accvgpr_read_b32 v153, a205
v_accvgpr_read_b32 v154, a206
v_mfma_f32_16x16x32_bf16 a[216:219], v[184:187], v[208:211], a[216:219]
v_accvgpr_read_b32 v155, a207
v_cvt_pk_bf16_f32 v120, v152, v153
v_mfma_f32_16x16x32_bf16 a[216:219], v[64:67], v[212:215], a[216:219]
v_cvt_pk_bf16_f32 v121, v154, v155
v_mfma_f32_16x16x32_bf16 a[220:223], v[188:191], v[208:211], a[220:223]
ds_read_b64_tr_b16 v[208:209], v12 offset:12800
v_mfma_f32_16x16x32_bf16 a[220:223], v[96:99], v[212:215], a[220:223]
ds_read_b64_tr_b16 v[210:211], v12 offset:14848
ds_read_b64_tr_b16 v[212:213], v12 offset:29184
s_waitcnt lgkmcnt(3)
v_mfma_f32_16x16x32_bf16 a[224:227], v[4:7], v[216:219], a[224:227]
ds_read_b64_tr_b16 v[214:215], v12 offset:31232
v_mfma_f32_16x16x32_bf16 a[224:227], v[8:11], v[220:223], a[224:227]
v_mfma_f32_16x16x32_bf16 a[228:231], v[36:39], v[216:219], a[228:231]
v_accvgpr_read_b32 v132, a208
v_accvgpr_read_b32 v133, a209
v_mfma_f32_16x16x32_bf16 a[228:231], v[40:43], v[220:223], a[228:231]
v_accvgpr_read_b32 v134, a210
v_accvgpr_read_b32 v135, a211
v_mfma_f32_16x16x32_bf16 a[232:235], v[68:71], v[216:219], a[232:235]
v_cvt_pk_bf16_f32 v26, v132, v133
v_cvt_pk_bf16_f32 v27, v134, v135
v_mfma_f32_16x16x32_bf16 a[232:235], v[72:75], v[220:223], a[232:235]
buffer_store_dwordx4 v[24:27], v248, s[20:23], s44 offen offset:2048 sc1
ds_write_b128 v253, v[24:27] offset:6144
v_mfma_f32_16x16x32_bf16 a[236:239], v[100:103], v[216:219], a[236:239]
ds_read_b64_tr_b16 v[216:217], v14 offset:12800
v_accvgpr_read_b32 v140, a212
v_mfma_f32_16x16x32_bf16 a[236:239], v[104:107], v[220:223], a[236:239]
ds_read_b64_tr_b16 v[218:219], v14 offset:14848
ds_read_b64_tr_b16 v[220:221], v250 offset:12800
s_waitcnt lgkmcnt(3)
v_mfma_f32_16x16x32_bf16 a[224:227], v[160:163], v[208:211], a[224:227]
ds_read_b64_tr_b16 v[222:223], v250 offset:14848
v_accvgpr_read_b32 v141, a213
v_mfma_f32_16x16x32_bf16 a[224:227], v[176:179], v[212:215], a[224:227]
v_accvgpr_read_b32 v142, a214
v_accvgpr_read_b32 v143, a215
v_mfma_f32_16x16x32_bf16 a[228:231], v[164:167], v[208:211], a[228:231]
v_cvt_pk_bf16_f32 v58, v140, v141
v_cvt_pk_bf16_f32 v59, v142, v143
v_mfma_f32_16x16x32_bf16 a[228:231], v[180:183], v[212:215], a[228:231]
buffer_store_dwordx4 v[56:59], v248, s[20:23], s45 offen offset:2048 sc1
v_accvgpr_read_b32 v148, a216
v_mfma_f32_16x16x32_bf16 a[232:235], v[168:171], v[208:211], a[232:235]
v_accvgpr_read_b32 v149, a217
v_accvgpr_read_b32 v150, a218
v_mfma_f32_16x16x32_bf16 a[232:235], v[184:187], v[212:215], a[232:235]
v_accvgpr_read_b32 v151, a219
v_cvt_pk_bf16_f32 v90, v148, v149
v_mfma_f32_16x16x32_bf16 a[236:239], v[172:175], v[208:211], a[236:239]
ds_read_b64_tr_b16 v[208:209], v250 offset:29184
v_cvt_pk_bf16_f32 v91, v150, v151
v_mfma_f32_16x16x32_bf16 a[236:239], v[188:191], v[212:215], a[236:239]
ds_read_b64_tr_b16 v[210:211], v250 offset:31232
ds_read_b64_tr_b16 v[212:213], v13 offset:12800
s_waitcnt lgkmcnt(5)
v_mfma_f32_16x16x32_bf16 a[224:227], v[0:3], v[216:219], a[224:227]
ds_read_b64_tr_b16 v[214:215], v13 offset:14848
buffer_store_dwordx4 v[88:91], v248, s[20:23], s46 offen offset:2048 sc1
v_mfma_f32_16x16x32_bf16 a[228:231], v[32:35], v[216:219], a[228:231]
v_accvgpr_read_b32 v156, a220
v_accvgpr_read_b32 v157, a221
v_mfma_f32_16x16x32_bf16 a[232:235], v[64:67], v[216:219], a[232:235]
v_accvgpr_read_b32 v158, a222
v_accvgpr_read_b32 v159, a223
v_mfma_f32_16x16x32_bf16 a[236:239], v[96:99], v[216:219], a[236:239]
ds_read_b64_tr_b16 v[216:217], v13 offset:29184
s_waitcnt lgkmcnt(5)
v_mfma_f32_16x16x32_bf16 a[240:243], v[4:7], v[220:223], a[240:243]
ds_read_b64_tr_b16 v[218:219], v13 offset:31232
v_cvt_pk_bf16_f32 v122, v156, v157
v_mfma_f32_16x16x32_bf16 a[244:247], v[36:39], v[220:223], a[244:247]
v_cvt_pk_bf16_f32 v123, v158, v159
buffer_store_dwordx4 v[120:123], v248, s[20:23], s47 offen offset:2048 sc1
v_mfma_f32_16x16x32_bf16 a[248:251], v[68:71], v[220:223], a[248:251]
v_accvgpr_read_b32 v128, a224
v_accvgpr_read_b32 v129, a225
v_mfma_f32_16x16x32_bf16 a[252:255], v[100:103], v[220:223], a[252:255]
ds_read_b64_tr_b16 v[220:221], v15 offset:12800
s_waitcnt lgkmcnt(3)
v_mfma_f32_16x16x32_bf16 a[240:243], v[8:11], v[208:211], a[240:243]
ds_read_b64_tr_b16 v[222:223], v15 offset:14848
v_accvgpr_read_b32 v130, a226
v_mfma_f32_16x16x32_bf16 a[240:243], v[160:163], v[212:215], a[240:243]
v_accvgpr_read_b32 v131, a227
v_cvt_pk_bf16_f32 v28, v128, v129
v_mfma_f32_16x16x32_bf16 a[244:247], v[40:43], v[208:211], a[244:247]
v_cvt_pk_bf16_f32 v29, v130, v131
v_accvgpr_read_b32 v136, a228
v_mfma_f32_16x16x32_bf16 a[244:247], v[164:167], v[212:215], a[244:247]
v_accvgpr_read_b32 v137, a229
v_accvgpr_read_b32 v138, a230
v_mfma_f32_16x16x32_bf16 a[248:251], v[72:75], v[208:211], a[248:251]
v_accvgpr_read_b32 v139, a231
v_cvt_pk_bf16_f32 v60, v136, v137
v_mfma_f32_16x16x32_bf16 a[248:251], v[168:171], v[212:215], a[248:251]
v_cvt_pk_bf16_f32 v61, v138, v139
v_accvgpr_read_b32 v144, a232
v_mfma_f32_16x16x32_bf16 a[252:255], v[104:107], v[208:211], a[252:255]
v_accvgpr_read_b32 v145, a233
v_accvgpr_read_b32 v146, a234
v_mfma_f32_16x16x32_bf16 a[252:255], v[172:175], v[212:215], a[252:255]
s_waitcnt lgkmcnt(0)
v_accvgpr_read_b32 v147, a235
v_mfma_f32_16x16x32_bf16 a[240:243], v[176:179], v[216:219], a[240:243]
v_cvt_pk_bf16_f32 v92, v144, v145
v_cvt_pk_bf16_f32 v93, v146, v147
v_mfma_f32_16x16x32_bf16 a[240:243], v[0:3], v[220:223], a[240:243]
v_accvgpr_read_b32 v152, a236
v_accvgpr_read_b32 v153, a237
v_mfma_f32_16x16x32_bf16 a[244:247], v[180:183], v[216:219], a[244:247]
v_accvgpr_read_b32 v154, a238
v_accvgpr_read_b32 v155, a239
v_mfma_f32_16x16x32_bf16 a[244:247], v[32:35], v[220:223], a[244:247]
v_cvt_pk_bf16_f32 v124, v152, v153
v_cvt_pk_bf16_f32 v125, v154, v155
v_mfma_f32_16x16x32_bf16 a[248:251], v[184:187], v[216:219], a[248:251]
v_mfma_f32_16x16x32_bf16 a[248:251], v[64:67], v[220:223], a[248:251]
v_mfma_f32_16x16x32_bf16 a[252:255], v[188:191], v[216:219], a[252:255]
v_mfma_f32_16x16x32_bf16 a[252:255], v[96:99], v[220:223], a[252:255]
v_accvgpr_read_b32 v132, a240
v_accvgpr_read_b32 v133, a241
v_accvgpr_read_b32 v134, a242
v_accvgpr_read_b32 v135, a243
v_cvt_pk_bf16_f32 v30, v132, v133
v_cvt_pk_bf16_f32 v31, v134, v135
buffer_store_dwordx4 v[28:31], v248, s[20:23], s44 offen offset:3072 sc1
ds_write_b128 v253, v[28:31] offset:7168
v_accvgpr_read_b32 v140, a244
v_accvgpr_read_b32 v141, a245
v_accvgpr_read_b32 v142, a246
v_accvgpr_read_b32 v143, a247
v_cvt_pk_bf16_f32 v62, v140, v141
v_cvt_pk_bf16_f32 v63, v142, v143
buffer_store_dwordx4 v[60:63], v248, s[20:23], s45 offen offset:3072 sc1
v_accvgpr_read_b32 v148, a248
v_accvgpr_read_b32 v149, a249
v_accvgpr_read_b32 v150, a250
v_accvgpr_read_b32 v151, a251
v_cvt_pk_bf16_f32 v94, v148, v149
v_cvt_pk_bf16_f32 v95, v150, v151
buffer_store_dwordx4 v[92:95], v248, s[20:23], s46 offen offset:3072 sc1
v_accvgpr_read_b32 v156, a252
v_accvgpr_read_b32 v157, a253
v_accvgpr_read_b32 v158, a254
v_accvgpr_read_b32 v159, a255
v_cvt_pk_bf16_f32 v126, v156, v157
v_cvt_pk_bf16_f32 v127, v158, v159
buffer_store_dwordx4 v[124:127], v248, s[20:23], s47 offen offset:3072 sc1
s_waitcnt vmcnt(36)
s_branch L2_F
L2_tail_1:
s_waitcnt lgkmcnt(6)
v_mfma_f32_16x16x32_bf16 a[0:3], v[176:179], v[208:211], a[0:3]
s_mov_b32 m0, s30
v_mfma_f32_16x16x32_bf16 a[4:7], v[180:183], v[208:211], a[4:7]
buffer_load_dwordx4 v241, s[12:15], s28 offen offset:0 sc1 lds
v_add_u32 v253, s50, v248
v_mfma_f32_16x16x32_bf16 a[8:11], v[184:187], v[208:211], a[8:11]
buffer_load_dwordx4 v241, s[12:15], s28 offen offset:1024 sc1 lds
v_mfma_f32_16x16x32_bf16 a[12:15], v[188:191], v[208:211], a[12:15]
ds_read_b128 v[208:211], v240 offset:2048
s_waitcnt lgkmcnt(5)
buffer_load_dwordx4 v241, s[12:15], s28 offen offset:2048 sc1 lds
v_mfma_f32_16x16x32_bf16 a[16:19], v[176:179], v[212:215], a[16:19]
buffer_load_dwordx4 v241, s[12:15], s28 offen offset:3072 sc1 lds
v_mfma_f32_16x16x32_bf16 a[20:23], v[180:183], v[212:215], a[20:23]
s_add_u32 s28, s28, s101
s_add_u32 s30, s30, 0x4000
s_and_b32 s30, s30, 0x1ffff
v_mfma_f32_16x16x32_bf16 a[24:27], v[184:187], v[212:215], a[24:27]
s_mov_b32 m0, s30
v_mfma_f32_16x16x32_bf16 a[28:31], v[188:191], v[212:215], a[28:31]
ds_read_b128 v[212:215], v240 offset:2560
s_waitcnt lgkmcnt(4)
buffer_load_dwordx4 v241, s[12:15], s28 offen offset:0 sc1 lds
v_mfma_f32_16x16x32_bf16 a[32:35], v[176:179], v[216:219], a[32:35]
buffer_load_dwordx4 v241, s[12:15], s28 offen offset:1024 sc1 lds
v_mfma_f32_16x16x32_bf16 a[36:39], v[180:183], v[216:219], a[36:39]
buffer_load_dwordx4 v241, s[12:15], s28 offen offset:2048 sc1 lds
v_mfma_f32_16x16x32_bf16 a[40:43], v[184:187], v[216:219], a[40:43]
buffer_load_dwordx4 v241, s[12:15], s28 offen offset:3072 sc1 lds
v_mfma_f32_16x16x32_bf16 a[44:47], v[188:191], v[216:219], a[44:47]
ds_read_b128 v[216:219], v240 offset:6144
s_waitcnt lgkmcnt(3)
v_mfma_f32_16x16x32_bf16 a[48:51], v[176:179], v[220:223], a[48:51]
v_exp_f32 v232, v128
s_and_b32 s30, s30, 0x1c000
v_mfma_f32_16x16x32_bf16 a[52:55], v[180:183], v[220:223], a[52:55]
v_add_u32 v251, 0x8000, v240
v_and_b32 v251, 0x1ffff, v251
s_add_u32 s28, s30, 0xc000
v_mfma_f32_16x16x32_bf16 a[56:59], v[184:187], v[220:223], a[56:59]
v_exp_f32 v233, v129
s_and_b32 s28, s28, 0x1ffff
v_mfma_f32_16x16x32_bf16 a[60:63], v[188:191], v[220:223], a[60:63]
ds_read_b128 v[220:223], v240 offset:6656
s_waitcnt lgkmcnt(2)
s_add_u32 s30, s30, 0x4000
v_mfma_f32_16x16x32_bf16 v[144:147], v[208:211], v[0:3], v[192:195]
ds_write_b128 v253, v[176:179] offset:0
s_and_b32 s30, s30, 0x1ffff
s_mul_i32 s31, s34, 6144
v_mfma_f32_16x16x32_bf16 v[144:147], v[212:215], v[4:7], v[144:147]
ds_write_b128 v253, v[180:183] offset:1024
s_add_u32 s31, s31, s30
s_lshl_b32 s3, s34, 10
v_mfma_f32_16x16x32_bf16 v[148:151], v[208:211], v[32:35], v[196:199]
ds_write_b128 v253, v[184:187] offset:2048
s_add_u32 s28, s28, s3
s_add_u32 s3, s3, 24576
v_mfma_f32_16x16x32_bf16 v[148:151], v[212:215], v[36:39], v[148:151]
ds_write_b128 v253, v[188:191] offset:3072
s_add_u32 s30, s30, s3
v_lshrrev_b32 v241, 4, v248
v_mfma_f32_16x16x32_bf16 v[152:155], v[208:211], v[64:67], v[200:203]
v_exp_f32 v234, v130
v_and_b32 v241, 0x30, v241
v_mfma_f32_16x16x32_bf16 v[152:155], v[212:215], v[68:71], v[152:155]
v_add_f32 v228, v224, v232
v_cvt_pk_bf16_f32 v160, v232, v233
v_xor_b32 v241, v241, v248
v_mfma_f32_16x16x32_bf16 v[156:159], v[208:211], v[96:99], v[204:207]
ds_read_b128 v[208:211], v240 offset:10240
v_and_b32 v243, 0x380, v248
v_mad_u32_u24 v241, v243, 3, v241
v_mfma_f32_16x16x32_bf16 v[156:159], v[212:215], v[100:103], v[156:159]
ds_read_b128 v[212:215], v240 offset:10752
s_waitcnt lgkmcnt(2)
v_mfma_f32_16x16x32_bf16 v[144:147], v[216:219], v[8:11], v[144:147]
v_exp_f32 v235, v131
v_mfma_f32_16x16x32_bf16 v[144:147], v[220:223], v[12:15], v[144:147]
v_add_f32 v228, v228, v233
v_add_f32 v228, v228, v234
v_mfma_f32_16x16x32_bf16 v[148:151], v[216:219], v[40:43], v[148:151]
v_add_f32 v228, v228, v235
v_cvt_pk_bf16_f32 v161, v234, v235
v_mfma_f32_16x16x32_bf16 v[148:151], v[220:223], v[44:47], v[148:151]
v_exp_f32 v236, v132
v_mfma_f32_16x16x32_bf16 v[152:155], v[216:219], v[72:75], v[152:155]
v_exp_f32 v237, v133
v_mfma_f32_16x16x32_bf16 v[152:155], v[220:223], v[76:79], v[152:155]
v_exp_f32 v238, v134
v_mfma_f32_16x16x32_bf16 v[156:159], v[216:219], v[104:107], v[156:159]
ds_read_b128 v[216:219], v240 offset:14336
v_add_f32 v229, v225, v236
v_mfma_f32_16x16x32_bf16 v[156:159], v[220:223], v[108:111], v[156:159]
ds_read_b128 v[220:223], v240 offset:14848
s_waitcnt lgkmcnt(2)
v_mfma_f32_16x16x32_bf16 v[144:147], v[208:211], v[16:19], v[144:147]
v_cvt_pk_bf16_f32 v164, v236, v237
v_mfma_f32_16x16x32_bf16 v[144:147], v[212:215], v[20:23], v[144:147]
s_waitcnt vmcnt(8)
s_barrier
v_mfma_f32_16x16x32_bf16 v[148:151], v[208:211], v[48:51], v[148:151]
v_exp_f32 v239, v135
v_mfma_f32_16x16x32_bf16 v[148:151], v[212:215], v[52:55], v[148:151]
v_add_f32 v229, v229, v237
v_add_f32 v229, v229, v238
v_mfma_f32_16x16x32_bf16 v[152:155], v[208:211], v[80:83], v[152:155]
v_add_f32 v229, v229, v239
v_cvt_pk_bf16_f32 v165, v238, v239
v_mfma_f32_16x16x32_bf16 v[152:155], v[212:215], v[84:87], v[152:155]
v_exp_f32 v232, v136
v_mfma_f32_16x16x32_bf16 v[156:159], v[208:211], v[112:115], v[156:159]
ds_read_b128 v[208:211], v240 offset:16384
s_add_u32 m0, s31, 0
v_mfma_f32_16x16x32_bf16 v[156:159], v[212:215], v[116:119], v[156:159]
ds_read_b128 v[212:215], v240 offset:16896
s_waitcnt lgkmcnt(2)
v_mfma_f32_16x16x32_bf16 v[144:147], v[216:219], v[24:27], v[144:147]
v_exp_f32 v233, v137
v_mfma_f32_16x16x32_bf16 v[144:147], v[220:223], v[28:31], v[144:147]
v_exp_f32 v234, v138
v_mfma_f32_16x16x32_bf16 v[148:151], v[216:219], v[56:59], v[148:151]
v_add_f32 v230, v226, v232
v_cvt_pk_bf16_f32 v168, v232, v233
v_mfma_f32_16x16x32_bf16 v[148:151], v[220:223], v[60:63], v[148:151]
v_exp_f32 v235, v139
v_mfma_f32_16x16x32_bf16 v[152:155], v[216:219], v[88:91], v[152:155]
v_add_f32 v230, v230, v233
v_add_f32 v230, v230, v234
v_mfma_f32_16x16x32_bf16 v[152:155], v[220:223], v[92:95], v[152:155]
v_add_f32 v230, v230, v235
v_cvt_pk_bf16_f32 v169, v234, v235
v_mfma_f32_16x16x32_bf16 v[156:159], v[216:219], v[120:123], v[156:159]
ds_read_b128 v[216:219], v240 offset:20480
buffer_load_dwordx4 v241, s[8:11], s6 offen lds
s_add_u32 m0, s31, 2048
v_mfma_f32_16x16x32_bf16 v[156:159], v[220:223], v[124:127], v[156:159]
ds_read_b128 v[220:223], v240 offset:20992
s_waitcnt lgkmcnt(2)
v_exp_f32 v236, v140
v_exp_f32 v237, v141
v_exp_f32 v238, v142
v_add_f32 v231, v227, v236
v_cvt_pk_bf16_f32 v172, v236, v237
v_exp_f32 v239, v143
v_add_f32 v231, v231, v237
v_add_f32 v231, v231, v238
v_add_f32 v231, v231, v239
v_cvt_pk_bf16_f32 v173, v238, v239
v_max3_f32 v242, v228, v229, v230
v_max_f32 v242, v242, v231
v_cmp_lt_f32 vcc, s32, v242
s_cbranch_vccnz L2_rare_site12
L2_ret12:
v_mfma_f32_16x16x32_bf16 v[128:131], v[208:211], v[0:3], v[192:195]
buffer_load_dwordx4 v241, s[8:11], s7 offen lds
s_add_u32 m0, s31, 4096
v_mfma_f32_16x16x32_bf16 v[128:131], v[212:215], v[4:7], v[128:131]
v_exp_f32 v232, v144
v_mfma_f32_16x16x32_bf16 v[132:135], v[208:211], v[32:35], v[196:199]
v_exp_f32 v233, v145
v_mfma_f32_16x16x32_bf16 v[132:135], v[212:215], v[36:39], v[132:135]
v_exp_f32 v234, v146
v_add_f32 v224, v228, v232
v_mfma_f32_16x16x32_bf16 v[136:139], v[208:211], v[64:67], v[200:203]
v_cvt_pk_bf16_f32 v162, v232, v233
v_exp_f32 v235, v147
v_mfma_f32_16x16x32_bf16 v[136:139], v[212:215], v[68:71], v[136:139]
v_add_f32 v224, v224, v233
v_add_f32 v224, v224, v234
v_add_f32 v224, v224, v235
v_mfma_f32_16x16x32_bf16 v[140:143], v[208:211], v[96:99], v[204:207]
ds_read_b128 v[208:211], v240 offset:24576
v_cvt_pk_bf16_f32 v163, v234, v235
v_mfma_f32_16x16x32_bf16 v[140:143], v[212:215], v[100:103], v[140:143]
ds_read_b128 v[212:215], v240 offset:25088
s_waitcnt lgkmcnt(2)
v_mfma_f32_16x16x32_bf16 v[128:131], v[216:219], v[8:11], v[128:131]
v_exp_f32 v236, v148
v_mfma_f32_16x16x32_bf16 v[128:131], v[220:223], v[12:15], v[128:131]
v_exp_f32 v237, v149
v_mfma_f32_16x16x32_bf16 v[132:135], v[216:219], v[40:43], v[132:135]
v_exp_f32 v238, v150
v_add_f32 v225, v229, v236
v_mfma_f32_16x16x32_bf16 v[132:135], v[220:223], v[44:47], v[132:135]
v_cvt_pk_bf16_f32 v166, v236, v237
v_exp_f32 v239, v151
v_mfma_f32_16x16x32_bf16 v[136:139], v[216:219], v[72:75], v[136:139]
v_add_f32 v225, v225, v237
v_add_f32 v225, v225, v238
v_add_f32 v225, v225, v239
v_mfma_f32_16x16x32_bf16 v[136:139], v[220:223], v[76:79], v[136:139]
v_cvt_pk_bf16_f32 v167, v238, v239
v_exp_f32 v232, v152
v_mfma_f32_16x16x32_bf16 v[140:143], v[216:219], v[104:107], v[140:143]
ds_read_b128 v[216:219], v240 offset:28672
v_exp_f32 v233, v153
v_mfma_f32_16x16x32_bf16 v[140:143], v[220:223], v[108:111], v[140:143]
ds_read_b128 v[220:223], v240 offset:29184
s_waitcnt lgkmcnt(2)
v_mfma_f32_16x16x32_bf16 v[128:131], v[208:211], v[16:19], v[128:131]
v_exp_f32 v234, v154
v_add_f32 v226, v230, v232
v_mfma_f32_16x16x32_bf16 v[128:131], v[212:215], v[20:23], v[128:131]
v_cvt_pk_bf16_f32 v170, v232, v233
v_exp_f32 v235, v155
v_mfma_f32_16x16x32_bf16 v[132:135], v[208:211], v[48:51], v[132:135]
v_add_f32 v226, v226, v233
v_add_f32 v226, v226, v234
v_add_f32 v226, v226, v235
v_mfma_f32_16x16x32_bf16 v[132:135], v[212:215], v[52:55], v[132:135]
v_cvt_pk_bf16_f32 v171, v234, v235
v_exp_f32 v236, v156
v_mfma_f32_16x16x32_bf16 v[136:139], v[208:211], v[80:83], v[136:139]
v_exp_f32 v237, v157
v_mfma_f32_16x16x32_bf16 v[136:139], v[212:215], v[84:87], v[136:139]
v_exp_f32 v238, v158
v_add_f32 v227, v231, v236
v_mfma_f32_16x16x32_bf16 v[140:143], v[208:211], v[112:115], v[140:143]
ds_read_b128 v[208:211], v240 offset:18432
v_cvt_pk_bf16_f32 v174, v236, v237
v_mfma_f32_16x16x32_bf16 v[140:143], v[212:215], v[116:119], v[140:143]
ds_read_b128 v[212:215], v240 offset:18944
s_waitcnt lgkmcnt(2)
v_mfma_f32_16x16x32_bf16 v[128:131], v[216:219], v[24:27], v[128:131]
v_exp_f32 v239, v159
v_add_f32 v227, v227, v237
v_mfma_f32_16x16x32_bf16 v[128:131], v[220:223], v[28:31], v[128:131]
v_add_f32 v227, v227, v238
v_add_f32 v227, v227, v239
v_cvt_pk_bf16_f32 v175, v238, v239
v_mfma_f32_16x16x32_bf16 v[132:135], v[216:219], v[56:59], v[132:135]
v_max3_f32 v242, v224, v225, v226
v_max_f32 v242, v242, v227
v_cmp_lt_f32 vcc, s32, v242
s_cbranch_vccnz L2_rare_site13
L2_ret13:
v_mfma_f32_16x16x32_bf16 v[132:135], v[220:223], v[60:63], v[132:135]
buffer_load_dwordx4 v241, s[8:11], s29 offen lds
s_add_u32 m0, s31, 1024
v_xor_b32 v241, 0x1040, v241
v_mfma_f32_16x16x32_bf16 v[136:139], v[216:219], v[88:91], v[136:139]
buffer_load_dwordx4 v241, s[8:11], s6 offen lds
s_add_u32 m0, s31, 3072
v_mfma_f32_16x16x32_bf16 v[136:139], v[220:223], v[92:95], v[136:139]
buffer_load_dwordx4 v241, s[8:11], s7 offen lds
s_add_u32 m0, s31, 5120
v_mfma_f32_16x16x32_bf16 v[140:143], v[216:219], v[120:123], v[140:143]
ds_read_b128 v[216:219], v240 offset:22528
buffer_load_dwordx4 v241, s[8:11], s29 offen lds
v_mfma_f32_16x16x32_bf16 v[140:143], v[220:223], v[124:127], v[140:143]
ds_read_b128 v[220:223], v240 offset:23040
s_waitcnt lgkmcnt(2)
v_mfma_f32_16x16x32_bf16 v[144:147], v[208:211], v[0:3], v[192:195]
ds_write_b128 v253, v[160:163] offset:4096
v_mfma_f32_16x16x32_bf16 v[144:147], v[212:215], v[4:7], v[144:147]
ds_write_b128 v253, v[164:167] offset:5120
v_exp_f32 v232, v128
v_mfma_f32_16x16x32_bf16 v[148:151], v[208:211], v[32:35], v[196:199]
ds_write_b128 v253, v[168:171] offset:6144
v_exp_f32 v233, v129
v_mfma_f32_16x16x32_bf16 v[148:151], v[212:215], v[36:39], v[148:151]
ds_write_b128 v253, v[172:175] offset:7168
v_exp_f32 v234, v130
v_mfma_f32_16x16x32_bf16 v[152:155], v[208:211], v[64:67], v[200:203]
v_add_f32 v228, v224, v232
v_cvt_pk_bf16_f32 v176, v232, v233
v_mfma_f32_16x16x32_bf16 v[152:155], v[212:215], v[68:71], v[152:155]
v_exp_f32 v235, v131
v_add_f32 v228, v228, v233
v_mfma_f32_16x16x32_bf16 v[156:159], v[208:211], v[96:99], v[204:207]
ds_read_b128 v[208:211], v240 offset:26624
v_add_f32 v228, v228, v234
v_add_f32 v228, v228, v235
v_mfma_f32_16x16x32_bf16 v[156:159], v[212:215], v[100:103], v[156:159]
ds_read_b128 v[212:215], v240 offset:27136
s_waitcnt lgkmcnt(2)
v_cvt_pk_bf16_f32 v177, v234, v235
v_mfma_f32_16x16x32_bf16 v[144:147], v[216:219], v[8:11], v[144:147]
v_exp_f32 v236, v132
v_mfma_f32_16x16x32_bf16 v[144:147], v[220:223], v[12:15], v[144:147]
v_exp_f32 v237, v133
v_mfma_f32_16x16x32_bf16 v[148:151], v[216:219], v[40:43], v[148:151]
v_exp_f32 v238, v134
v_add_f32 v229, v225, v236
v_mfma_f32_16x16x32_bf16 v[148:151], v[220:223], v[44:47], v[148:151]
v_cvt_pk_bf16_f32 v180, v236, v237
v_exp_f32 v239, v135
v_mfma_f32_16x16x32_bf16 v[152:155], v[216:219], v[72:75], v[152:155]
v_add_f32 v229, v229, v237
v_add_f32 v229, v229, v238
v_add_f32 v229, v229, v239
v_mfma_f32_16x16x32_bf16 v[152:155], v[220:223], v[76:79], v[152:155]
v_cvt_pk_bf16_f32 v181, v238, v239
v_exp_f32 v232, v136
v_mfma_f32_16x16x32_bf16 v[156:159], v[216:219], v[104:107], v[156:159]
ds_read_b128 v[216:219], v240 offset:30720
v_exp_f32 v233, v137
v_mfma_f32_16x16x32_bf16 v[156:159], v[220:223], v[108:111], v[156:159]
ds_read_b128 v[220:223], v240 offset:31232
s_waitcnt lgkmcnt(2)
v_mfma_f32_16x16x32_bf16 v[144:147], v[208:211], v[16:19], v[144:147]
v_exp_f32 v234, v138
v_add_f32 v230, v226, v232
v_mfma_f32_16x16x32_bf16 v[144:147], v[212:215], v[20:23], v[144:147]
s_waitcnt vmcnt(10)
s_barrier
v_cvt_pk_bf16_f32 v184, v232, v233
v_mfma_f32_16x16x32_bf16 v[148:151], v[208:211], v[48:51], v[148:151]
v_exp_f32 v235, v139
v_add_f32 v230, v230, v233
v_mfma_f32_16x16x32_bf16 v[148:151], v[212:215], v[52:55], v[148:151]
v_add_f32 v230, v230, v234
v_add_f32 v230, v230, v235
v_cvt_pk_bf16_f32 v185, v234, v235
v_mfma_f32_16x16x32_bf16 v[152:155], v[208:211], v[80:83], v[152:155]
v_exp_f32 v236, v140
v_mfma_f32_16x16x32_bf16 v[152:155], v[212:215], v[84:87], v[152:155]
v_exp_f32 v237, v141
v_mfma_f32_16x16x32_bf16 v[156:159], v[208:211], v[112:115], v[156:159]
ds_read_b128 v[208:211], v251 offset:0
v_exp_f32 v238, v142
v_mfma_f32_16x16x32_bf16 v[156:159], v[212:215], v[116:119], v[156:159]
ds_read_b128 v[212:215], v251 offset:512
s_waitcnt lgkmcnt(2)
v_add_f32 v231, v227, v236
v_mfma_f32_16x16x32_bf16 v[144:147], v[216:219], v[24:27], v[144:147]
v_cvt_pk_bf16_f32 v188, v236, v237
v_exp_f32 v239, v143
v_mfma_f32_16x16x32_bf16 v[144:147], v[220:223], v[28:31], v[144:147]
v_add_f32 v231, v231, v237
v_add_f32 v231, v231, v238
v_add_f32 v231, v231, v239
v_mfma_f32_16x16x32_bf16 v[148:151], v[216:219], v[56:59], v[148:151]
v_cvt_pk_bf16_f32 v189, v238, v239
v_max3_f32 v242, v228, v229, v230
v_max_f32 v242, v242, v231
v_mfma_f32_16x16x32_bf16 v[148:151], v[220:223], v[60:63], v[148:151]
v_cmp_lt_f32 vcc, s32, v242
v_mfma_f32_16x16x32_bf16 v[152:155], v[216:219], v[88:91], v[152:155]
v_mfma_f32_16x16x32_bf16 v[152:155], v[220:223], v[92:95], v[152:155]
s_cbranch_vccnz L2_rare_site14
L2_ret14:
v_mfma_f32_16x16x32_bf16 v[156:159], v[216:219], v[120:123], v[156:159]
ds_read_b128 v[216:219], v251 offset:4096
v_mfma_f32_16x16x32_bf16 v[156:159], v[220:223], v[124:127], v[156:159]
ds_read_b128 v[220:223], v251 offset:4608
s_waitcnt lgkmcnt(2)
v_mfma_f32_16x16x32_bf16 v[128:131], v[208:211], v[0:3], v[192:195]
v_mfma_f32_16x16x32_bf16 v[128:131], v[212:215], v[4:7], v[128:131]
v_exp_f32 v232, v144
v_mfma_f32_16x16x32_bf16 v[132:135], v[208:211], v[32:35], v[196:199]
v_exp_f32 v233, v145
v_mfma_f32_16x16x32_bf16 v[132:135], v[212:215], v[36:39], v[132:135]
v_exp_f32 v234, v146
v_add_f32 v224, v228, v232
v_mfma_f32_16x16x32_bf16 v[136:139], v[208:211], v[64:67], v[200:203]
v_cvt_pk_bf16_f32 v178, v232, v233
v_exp_f32 v235, v147
v_mfma_f32_16x16x32_bf16 v[136:139], v[212:215], v[68:71], v[136:139]
v_add_f32 v224, v224, v233
v_add_f32 v224, v224, v234
v_add_f32 v224, v224, v235
v_mfma_f32_16x16x32_bf16 v[140:143], v[208:211], v[96:99], v[204:207]
ds_read_b128 v[208:211], v251 offset:8192
v_cvt_pk_bf16_f32 v179, v234, v235
v_mfma_f32_16x16x32_bf16 v[140:143], v[212:215], v[100:103], v[140:143]
ds_read_b128 v[212:215], v251 offset:8704
s_waitcnt lgkmcnt(2)
v_mfma_f32_16x16x32_bf16 v[128:131], v[216:219], v[8:11], v[128:131]
v_exp_f32 v236, v148
v_mfma_f32_16x16x32_bf16 v[128:131], v[220:223], v[12:15], v[128:131]
v_exp_f32 v237, v149
v_mfma_f32_16x16x32_bf16 v[132:135], v[216:219], v[40:43], v[132:135]
v_exp_f32 v238, v150
v_add_f32 v225, v229, v236
v_mfma_f32_16x16x32_bf16 v[132:135], v[220:223], v[44:47], v[132:135]
v_cvt_pk_bf16_f32 v182, v236, v237
v_exp_f32 v239, v151
v_mfma_f32_16x16x32_bf16 v[136:139], v[216:219], v[72:75], v[136:139]
v_add_f32 v225, v225, v237
v_add_f32 v225, v225, v238
v_add_f32 v225, v225, v239
v_mfma_f32_16x16x32_bf16 v[136:139], v[220:223], v[76:79], v[136:139]
v_cvt_pk_bf16_f32 v183, v238, v239
v_exp_f32 v232, v152
v_mfma_f32_16x16x32_bf16 v[140:143], v[216:219], v[104:107], v[140:143]
ds_read_b128 v[216:219], v251 offset:12288
v_exp_f32 v233, v153
v_mfma_f32_16x16x32_bf16 v[140:143], v[220:223], v[108:111], v[140:143]
ds_read_b128 v[220:223], v251 offset:12800
s_waitcnt lgkmcnt(2)
v_mfma_f32_16x16x32_bf16 v[128:131], v[208:211], v[16:19], v[128:131]
v_exp_f32 v234, v154
v_add_f32 v226, v230, v232
v_mfma_f32_16x16x32_bf16 v[128:131], v[212:215], v[20:23], v[128:131]
v_cvt_pk_bf16_f32 v186, v232, v233
v_exp_f32 v235, v155
v_mfma_f32_16x16x32_bf16 v[132:135], v[208:211], v[48:51], v[132:135]
v_add_f32 v226, v226, v233
v_add_f32 v226, v226, v234
v_add_f32 v226, v226, v235
v_mfma_f32_16x16x32_bf16 v[132:135], v[212:215], v[52:55], v[132:135]
v_cvt_pk_bf16_f32 v187, v234, v235
v_exp_f32 v236, v156
v_mfma_f32_16x16x32_bf16 v[136:139], v[208:211], v[80:83], v[136:139]
v_exp_f32 v237, v157
v_mfma_f32_16x16x32_bf16 v[136:139], v[212:215], v[84:87], v[136:139]
v_exp_f32 v238, v158
v_add_f32 v227, v231, v236
v_mfma_f32_16x16x32_bf16 v[140:143], v[208:211], v[112:115], v[140:143]
ds_read_b128 v[208:211], v251 offset:2048
v_cvt_pk_bf16_f32 v190, v236, v237
v_mfma_f32_16x16x32_bf16 v[140:143], v[212:215], v[116:119], v[140:143]
ds_read_b128 v[212:215], v251 offset:2560
s_waitcnt lgkmcnt(2)
v_mfma_f32_16x16x32_bf16 v[128:131], v[216:219], v[24:27], v[128:131]
v_exp_f32 v239, v159
v_add_f32 v227, v227, v237
v_mfma_f32_16x16x32_bf16 v[128:131], v[220:223], v[28:31], v[128:131]
v_add_f32 v227, v227, v238
v_add_f32 v227, v227, v239
v_cvt_pk_bf16_f32 v191, v238, v239
v_mfma_f32_16x16x32_bf16 v[132:135], v[216:219], v[56:59], v[132:135]
v_max3_f32 v242, v224, v225, v226
v_max_f32 v242, v242, v227
v_cmp_lt_f32 vcc, s32, v242
s_cbranch_vccnz L2_rare_site15
L2_ret15:
v_mfma_f32_16x16x32_bf16 v[132:135], v[220:223], v[60:63], v[132:135]
v_mfma_f32_16x16x32_bf16 v[136:139], v[216:219], v[88:91], v[136:139]
v_mfma_f32_16x16x32_bf16 v[136:139], v[220:223], v[92:95], v[136:139]
v_mfma_f32_16x16x32_bf16 v[140:143], v[216:219], v[120:123], v[140:143]
ds_read_b128 v[216:219], v251 offset:6144
v_mfma_f32_16x16x32_bf16 v[140:143], v[220:223], v[124:127], v[140:143]
ds_read_b128 v[220:223], v251 offset:6656
s_waitcnt lgkmcnt(2)
v_mfma_f32_16x16x32_bf16 v[144:147], v[208:211], v[0:3], v[192:195]
v_mfma_f32_16x16x32_bf16 v[144:147], v[212:215], v[4:7], v[144:147]
v_exp_f32 v232, v128
v_lshlrev_b32 v241, 3, v248
v_mfma_f32_16x16x32_bf16 v[148:151], v[208:211], v[32:35], v[196:199]
v_exp_f32 v233, v129
s_mov_b32 s3, 0x7c28000
v_mfma_f32_16x16x32_bf16 v[148:151], v[212:215], v[36:39], v[148:151]
v_exp_f32 v234, v130
v_add_f32 v228, v224, v232
v_mfma_f32_16x16x32_bf16 v[152:155], v[208:211], v[64:67], v[200:203]
v_cvt_pk_bf16_f32 v160, v232, v233
v_exp_f32 v235, v131
v_mfma_f32_16x16x32_bf16 v[152:155], v[212:215], v[68:71], v[152:155]
v_add_f32 v228, v228, v233
v_add_f32 v228, v228, v234
v_add_f32 v228, v228, v235
v_mfma_f32_16x16x32_bf16 v[156:159], v[208:211], v[96:99], v[204:207]
ds_read_b128 v[208:211], v251 offset:10240
v_cvt_pk_bf16_f32 v161, v234, v235
buffer_load_dwordx2 v[240:241], v241, s[16:19], s3 offen sc1
v_mfma_f32_16x16x32_bf16 v[156:159], v[212:215], v[100:103], v[156:159]
ds_read_b128 v[212:215], v251 offset:10752
s_waitcnt lgkmcnt(2)
v_mfma_f32_16x16x32_bf16 v[144:147], v[216:219], v[8:11], v[144:147]
v_exp_f32 v236, v132
v_mfma_f32_16x16x32_bf16 v[144:147], v[220:223], v[12:15], v[144:147]
v_exp_f32 v237, v133
v_mfma_f32_16x16x32_bf16 v[148:151], v[216:219], v[40:43], v[148:151]
v_exp_f32 v238, v134
v_add_f32 v229, v225, v236
v_mfma_f32_16x16x32_bf16 v[148:151], v[220:223], v[44:47], v[148:151]
v_cvt_pk_bf16_f32 v164, v236, v237
v_exp_f32 v239, v135
v_mfma_f32_16x16x32_bf16 v[152:155], v[216:219], v[72:75], v[152:155]
v_add_f32 v229, v229, v237
v_add_f32 v229, v229, v238
v_add_f32 v229, v229, v239
v_mfma_f32_16x16x32_bf16 v[152:155], v[220:223], v[76:79], v[152:155]
v_cvt_pk_bf16_f32 v165, v238, v239
v_exp_f32 v232, v136
v_mfma_f32_16x16x32_bf16 v[156:159], v[216:219], v[104:107], v[156:159]
ds_read_b128 v[216:219], v251 offset:14336
v_exp_f32 v233, v137
v_mfma_f32_16x16x32_bf16 v[156:159], v[220:223], v[108:111], v[156:159]
ds_read_b128 v[220:223], v251 offset:14848
s_waitcnt lgkmcnt(2)
v_mfma_f32_16x16x32_bf16 v[144:147], v[208:211], v[16:19], v[144:147]
v_exp_f32 v234, v138
v_add_f32 v230, v226, v232
v_mfma_f32_16x16x32_bf16 v[144:147], v[212:215], v[20:23], v[144:147]
s_waitcnt vmcnt(7)
s_barrier
v_cvt_pk_bf16_f32 v168, v232, v233
v_mfma_f32_16x16x32_bf16 v[148:151], v[208:211], v[48:51], v[148:151]
v_exp_f32 v235, v139
v_add_f32 v230, v230, v233
v_mfma_f32_16x16x32_bf16 v[148:151], v[212:215], v[52:55], v[148:151]
v_add_f32 v230, v230, v234
v_add_f32 v230, v230, v235
v_cvt_pk_bf16_f32 v169, v234, v235
v_mfma_f32_16x16x32_bf16 v[152:155], v[208:211], v[80:83], v[152:155]
v_exp_f32 v236, v140
v_mfma_f32_16x16x32_bf16 v[152:155], v[212:215], v[84:87], v[152:155]
v_exp_f32 v237, v141
v_mfma_f32_16x16x32_bf16 v[156:159], v[208:211], v[112:115], v[156:159]
ds_read_b128 v[208:211], v251 offset:16384
v_exp_f32 v238, v142
v_mfma_f32_16x16x32_bf16 v[156:159], v[212:215], v[116:119], v[156:159]
ds_read_b128 v[212:215], v251 offset:16896
s_waitcnt lgkmcnt(2)
v_add_f32 v231, v227, v236
v_mfma_f32_16x16x32_bf16 v[144:147], v[216:219], v[24:27], v[144:147]
v_cvt_pk_bf16_f32 v172, v236, v237
v_exp_f32 v239, v143
v_mfma_f32_16x16x32_bf16 v[144:147], v[220:223], v[28:31], v[144:147]
v_add_f32 v231, v231, v237
v_add_f32 v231, v231, v238
v_add_f32 v231, v231, v239
v_mfma_f32_16x16x32_bf16 v[148:151], v[216:219], v[56:59], v[148:151]
v_cvt_pk_bf16_f32 v173, v238, v239
v_max3_f32 v242, v228, v229, v230
v_max_f32 v242, v242, v231
v_mfma_f32_16x16x32_bf16 v[148:151], v[220:223], v[60:63], v[148:151]
v_cmp_lt_f32 vcc, s32, v242
s_cbranch_vccnz L2_rare_site16
L2_ret16:
v_mfma_f32_16x16x32_bf16 v[152:155], v[216:219], v[88:91], v[152:155]
v_mfma_f32_16x16x32_bf16 v[152:155], v[220:223], v[92:95], v[152:155]
v_mfma_f32_16x16x32_bf16 v[156:159], v[216:219], v[120:123], v[156:159]
ds_read_b128 v[216:219], v251 offset:20480
v_mfma_f32_16x16x32_bf16 v[156:159], v[220:223], v[124:127], v[156:159]
ds_read_b128 v[220:223], v251 offset:20992
s_waitcnt lgkmcnt(2)
v_mfma_f32_16x16x32_bf16 v[128:131], v[208:211], v[0:3], v[192:195]
v_mfma_f32_16x16x32_bf16 v[128:131], v[212:215], v[4:7], v[128:131]
v_exp_f32 v232, v144
v_mfma_f32_16x16x32_bf16 v[132:135], v[208:211], v[32:35], v[196:199]
v_exp_f32 v233, v145
v_mfma_f32_16x16x32_bf16 v[132:135], v[212:215], v[36:39], v[132:135]
v_exp_f32 v234, v146
v_add_f32 v224, v228, v232
v_mfma_f32_16x16x32_bf16 v[136:139], v[208:211], v[64:67], v[200:203]
v_cvt_pk_bf16_f32 v162, v232, v233
v_exp_f32 v235, v147
v_mfma_f32_16x16x32_bf16 v[136:139], v[212:215], v[68:71], v[136:139]
v_add_f32 v224, v224, v233
v_add_f32 v224, v224, v234
v_add_f32 v224, v224, v235
v_mfma_f32_16x16x32_bf16 v[140:143], v[208:211], v[96:99], v[204:207]
ds_read_b128 v[208:211], v251 offset:24576
v_cvt_pk_bf16_f32 v163, v234, v235
v_mfma_f32_16x16x32_bf16 v[140:143], v[212:215], v[100:103], v[140:143]
ds_read_b128 v[212:215], v251 offset:25088
s_waitcnt lgkmcnt(2)
v_mfma_f32_16x16x32_bf16 v[128:131], v[216:219], v[8:11], v[128:131]
v_exp_f32 v236, v148
v_mfma_f32_16x16x32_bf16 v[128:131], v[220:223], v[12:15], v[128:131]
v_exp_f32 v237, v149
v_mfma_f32_16x16x32_bf16 v[132:135], v[216:219], v[40:43], v[132:135]
v_exp_f32 v238, v150
v_add_f32 v225, v229, v236
v_mfma_f32_16x16x32_bf16 v[132:135], v[220:223], v[44:47], v[132:135]
v_cvt_pk_bf16_f32 v166, v236, v237
v_exp_f32 v239, v151
v_mfma_f32_16x16x32_bf16 v[136:139], v[216:219], v[72:75], v[136:139]
v_add_f32 v225, v225, v237
v_add_f32 v225, v225, v238
v_add_f32 v225, v225, v239
v_mfma_f32_16x16x32_bf16 v[136:139], v[220:223], v[76:79], v[136:139]
v_cvt_pk_bf16_f32 v167, v238, v239
v_exp_f32 v232, v152
v_mfma_f32_16x16x32_bf16 v[140:143], v[216:219], v[104:107], v[140:143]
ds_read_b128 v[216:219], v251 offset:28672
v_exp_f32 v233, v153
v_mfma_f32_16x16x32_bf16 v[140:143], v[220:223], v[108:111], v[140:143]
ds_read_b128 v[220:223], v251 offset:29184
s_waitcnt lgkmcnt(2)
v_mfma_f32_16x16x32_bf16 v[128:131], v[208:211], v[16:19], v[128:131]
v_exp_f32 v234, v154
v_add_f32 v226, v230, v232
v_mfma_f32_16x16x32_bf16 v[128:131], v[212:215], v[20:23], v[128:131]
v_cvt_pk_bf16_f32 v170, v232, v233
v_exp_f32 v235, v155
v_mfma_f32_16x16x32_bf16 v[132:135], v[208:211], v[48:51], v[132:135]
v_add_f32 v226, v226, v233
v_add_f32 v226, v226, v234
v_add_f32 v226, v226, v235
v_mfma_f32_16x16x32_bf16 v[132:135], v[212:215], v[52:55], v[132:135]
v_cvt_pk_bf16_f32 v171, v234, v235
v_exp_f32 v236, v156
v_mfma_f32_16x16x32_bf16 v[136:139], v[208:211], v[80:83], v[136:139]
v_exp_f32 v237, v157
v_mfma_f32_16x16x32_bf16 v[136:139], v[212:215], v[84:87], v[136:139]
v_exp_f32 v238, v158
v_add_f32 v227, v231, v236
v_mfma_f32_16x16x32_bf16 v[140:143], v[208:211], v[112:115], v[140:143]
ds_read_b128 v[208:211], v251 offset:18432
v_cvt_pk_bf16_f32 v174, v236, v237
v_mfma_f32_16x16x32_bf16 v[140:143], v[212:215], v[116:119], v[140:143]
ds_read_b128 v[212:215], v251 offset:18944
s_waitcnt lgkmcnt(2)
v_mfma_f32_16x16x32_bf16 v[128:131], v[216:219], v[24:27], v[128:131]
v_exp_f32 v239, v159
v_add_f32 v227, v227, v237
v_mfma_f32_16x16x32_bf16 v[128:131], v[220:223], v[28:31], v[128:131]
v_add_f32 v227, v227, v238
v_add_f32 v227, v227, v239
v_cvt_pk_bf16_f32 v175, v238, v239
v_mfma_f32_16x16x32_bf16 v[132:135], v[216:219], v[56:59], v[132:135]
v_max3_f32 v242, v224, v225, v226
v_max_f32 v242, v242, v227
v_cmp_lt_f32 vcc, s32, v242
s_cbranch_vccnz L2_rare_site17
L2_ret17:
v_mfma_f32_16x16x32_bf16 v[132:135], v[220:223], v[60:63], v[132:135]
v_mfma_f32_16x16x32_bf16 v[136:139], v[216:219], v[88:91], v[136:139]
v_mfma_f32_16x16x32_bf16 v[136:139], v[220:223], v[92:95], v[136:139]
v_mfma_f32_16x16x32_bf16 v[140:143], v[216:219], v[120:123], v[140:143]
ds_read_b128 v[216:219], v251 offset:22528
v_mfma_f32_16x16x32_bf16 v[140:143], v[220:223], v[124:127], v[140:143]
ds_read_b128 v[220:223], v251 offset:23040
s_waitcnt lgkmcnt(2)
v_mfma_f32_16x16x32_bf16 v[144:147], v[208:211], v[0:3], v[192:195]
v_mfma_f32_16x16x32_bf16 v[144:147], v[212:215], v[4:7], v[144:147]
v_mfma_f32_16x16x32_bf16 v[148:151], v[208:211], v[32:35], v[196:199]
v_mfma_f32_16x16x32_bf16 v[148:151], v[212:215], v[36:39], v[148:151]
v_mfma_f32_16x16x32_bf16 v[152:155], v[208:211], v[64:67], v[200:203]
v_exp_f32 v232, v128
v_mfma_f32_16x16x32_bf16 v[152:155], v[212:215], v[68:71], v[152:155]
v_exp_f32 v233, v129
v_mfma_f32_16x16x32_bf16 v[156:159], v[208:211], v[96:99], v[204:207]
ds_read_b128 v[208:211], v251 offset:26624
v_exp_f32 v234, v130
v_mfma_f32_16x16x32_bf16 v[156:159], v[212:215], v[100:103], v[156:159]
ds_read_b128 v[212:215], v251 offset:27136
s_waitcnt lgkmcnt(2)
v_add_f32 v228, v224, v232
v_mfma_f32_16x16x32_bf16 v[144:147], v[216:219], v[8:11], v[144:147]
v_cvt_pk_bf16_f32 v0, v232, v233
v_exp_f32 v235, v131
v_mfma_f32_16x16x32_bf16 v[144:147], v[220:223], v[12:15], v[144:147]
ds_read_b128 v[4:7], v253 offset:0
v_add_f32 v228, v228, v233
v_add_f32 v228, v228, v234
v_mfma_f32_16x16x32_bf16 v[148:151], v[216:219], v[40:43], v[148:151]
ds_read_b128 v[36:39], v253 offset:1024
v_add_f32 v228, v228, v235
v_cvt_pk_bf16_f32 v1, v234, v235
v_mfma_f32_16x16x32_bf16 v[148:151], v[220:223], v[44:47], v[148:151]
v_exp_f32 v236, v132
v_mfma_f32_16x16x32_bf16 v[152:155], v[216:219], v[72:75], v[152:155]
v_exp_f32 v237, v133
v_mfma_f32_16x16x32_bf16 v[152:155], v[220:223], v[76:79], v[152:155]
ds_read_b128 v[68:71], v253 offset:2048
ds_read_b128 v[8:11], v253 offset:4096
v_mfma_f32_16x16x32_bf16 v[156:159], v[216:219], v[104:107], v[156:159]
ds_read_b128 v[216:219], v251 offset:30720
v_add_u32 v12, 0x8000, v249
v_and_b32 v12, 0x1ffff, v12
ds_read_b128 v[100:103], v253 offset:3072
ds_read_b128 v[40:43], v253 offset:5120
v_mfma_f32_16x16x32_bf16 v[156:159], v[220:223], v[108:111], v[156:159]
ds_read_b128 v[220:223], v251 offset:31232
s_waitcnt lgkmcnt(2)
v_add_u32 v14, 0x10000, v249
v_and_b32 v14, 0x1ffff, v14
v_mfma_f32_16x16x32_bf16 v[144:147], v[208:211], v[16:19], v[144:147]
v_xor_b32 v13, 32, v12
v_xor_b32 v15, 32, v14
v_mfma_f32_16x16x32_bf16 v[144:147], v[212:215], v[20:23], v[144:147]
ds_read_b128 v[72:75], v253 offset:6144
v_exp_f32 v238, v134
v_mfma_f32_16x16x32_bf16 v[148:151], v[208:211], v[48:51], v[148:151]
ds_read_b128 v[104:107], v253 offset:7168
v_add_f32 v229, v225, v236
v_cvt_pk_bf16_f32 v32, v236, v237
v_mfma_f32_16x16x32_bf16 v[148:151], v[212:215], v[52:55], v[148:151]
v_exp_f32 v239, v135
v_add_f32 v229, v229, v237
v_mfma_f32_16x16x32_bf16 v[152:155], v[208:211], v[80:83], v[152:155]
v_add_f32 v229, v229, v238
v_add_f32 v229, v229, v239
v_cvt_pk_bf16_f32 v33, v238, v239
v_mfma_f32_16x16x32_bf16 v[152:155], v[212:215], v[84:87], v[152:155]
v_exp_f32 v232, v136
v_mfma_f32_16x16x32_bf16 v[156:159], v[208:211], v[112:115], v[156:159]
ds_read_b64_tr_b16 v[208:209], v12 offset:0
v_exp_f32 v233, v137
v_mfma_f32_16x16x32_bf16 v[156:159], v[212:215], v[116:119], v[156:159]
ds_read_b64_tr_b16 v[210:211], v12 offset:2048
ds_read_b64_tr_b16 v[212:213], v12 offset:16384
s_waitcnt lgkmcnt(3)
v_mfma_f32_16x16x32_bf16 v[144:147], v[216:219], v[24:27], v[144:147]
ds_read_b64_tr_b16 v[214:215], v12 offset:18432
v_exp_f32 v234, v138
v_mfma_f32_16x16x32_bf16 v[144:147], v[220:223], v[28:31], v[144:147]
v_add_f32 v230, v226, v232
v_cvt_pk_bf16_f32 v64, v232, v233
v_mfma_f32_16x16x32_bf16 v[148:151], v[216:219], v[56:59], v[148:151]
v_exp_f32 v235, v139
v_add_f32 v230, v230, v233
v_mfma_f32_16x16x32_bf16 v[148:151], v[220:223], v[60:63], v[148:151]
v_add_f32 v230, v230, v234
v_add_f32 v230, v230, v235
v_cvt_pk_bf16_f32 v65, v234, v235
v_mfma_f32_16x16x32_bf16 v[152:155], v[216:219], v[88:91], v[152:155]
v_exp_f32 v236, v140
s_waitcnt vmcnt(0)
v_mfma_f32_16x16x32_bf16 v[152:155], v[220:223], v[92:95], v[152:155]
v_exp_f32 v237, v141
v_cmp_ne_u64_e64 s[38:39], s[98:99], v[240:241]
v_mfma_f32_16x16x32_bf16 v[156:159], v[216:219], v[120:123], v[156:159]
ds_read_b64_tr_b16 v[216:217], v14 offset:0
v_exp_f32 v238, v142
v_mfma_f32_16x16x32_bf16 v[156:159], v[220:223], v[124:127], v[156:159]
ds_read_b64_tr_b16 v[218:219], v14 offset:2048
ds_read_b64_tr_b16 v[220:221], v13 offset:0
s_waitcnt lgkmcnt(3)
v_add_f32 v231, v227, v236
v_cvt_pk_bf16_f32 v96, v236, v237
v_exp_f32 v239, v143
v_add_f32 v231, v231, v237
v_add_f32 v231, v231, v238
v_add_f32 v231, v231, v239
v_cvt_pk_bf16_f32 v97, v238, v239
v_max3_f32 v242, v228, v229, v230
v_max_f32 v242, v242, v231
v_cmp_lt_f32 vcc, s32, v242
s_cbranch_vccnz L2_rare_site18
L2_ret18:
v_mfma_f32_16x16x32_bf16 a[0:3], v[8:11], v[208:211], a[0:3]
ds_read_b64_tr_b16 v[222:223], v13 offset:2048
s_and_b64 s[38:39], s[38:39], s[96:97]
s_cbranch_scc1 LF_hl_1
LF_hlret_1:
v_mfma_f32_16x16x32_bf16 a[0:3], v[176:179], v[212:215], a[0:3]
v_exp_f32 v232, v144
v_lshrrev_b32 v241, 4, v248
v_mfma_f32_16x16x32_bf16 a[4:7], v[40:43], v[208:211], a[4:7]
v_exp_f32 v233, v145
v_and_b32 v241, 0x30, v241
v_mfma_f32_16x16x32_bf16 a[4:7], v[180:183], v[212:215], a[4:7]
v_exp_f32 v234, v146
v_xor_b32 v241, v241, v248
v_mfma_f32_16x16x32_bf16 a[8:11], v[72:75], v[208:211], a[8:11]
v_add_f32 v224, v228, v232
v_cvt_pk_bf16_f32 v2, v232, v233
v_mfma_f32_16x16x32_bf16 a[8:11], v[184:187], v[212:215], a[8:11]
v_exp_f32 v235, v147
v_mfma_f32_16x16x32_bf16 a[12:15], v[104:107], v[208:211], a[12:15]
ds_read_b64_tr_b16 v[208:209], v13 offset:16384
v_add_f32 v224, v224, v233
v_mfma_f32_16x16x32_bf16 a[12:15], v[188:191], v[212:215], a[12:15]
ds_read_b64_tr_b16 v[210:211], v13 offset:18432
ds_read_b64_tr_b16 v[212:213], v15 offset:0
s_waitcnt lgkmcnt(5)
v_mfma_f32_16x16x32_bf16 a[0:3], v[160:163], v[216:219], a[0:3]
ds_read_b64_tr_b16 v[214:215], v15 offset:2048
v_add_f32 v224, v224, v234
v_mfma_f32_16x16x32_bf16 a[4:7], v[164:167], v[216:219], a[4:7]
v_add_f32 v224, v224, v235
v_cvt_pk_bf16_f32 v3, v234, v235
v_mfma_f32_16x16x32_bf16 a[8:11], v[168:171], v[216:219], a[8:11]
v_exp_f32 v236, v148
v_mfma_f32_16x16x32_bf16 a[12:15], v[172:175], v[216:219], a[12:15]
ds_read_b64_tr_b16 v[216:217], v12 offset:512
s_waitcnt lgkmcnt(5)
v_mfma_f32_16x16x32_bf16 a[16:19], v[8:11], v[220:223], a[16:19]
ds_read_b64_tr_b16 v[218:219], v12 offset:2560
v_and_b32 v243, 0x380, v248
v_mad_u32_u24 v241, v243, 3, v241
v_mfma_f32_16x16x32_bf16 a[20:23], v[40:43], v[220:223], a[20:23]
v_exp_f32 v237, v149
v_add_u32 v241, 0x7000000, v241
v_mfma_f32_16x16x32_bf16 a[24:27], v[72:75], v[220:223], a[24:27]
v_exp_f32 v238, v150
v_and_b32 v110, 0x70, v248
v_mfma_f32_16x16x32_bf16 a[28:31], v[104:107], v[220:223], a[28:31]
ds_read_b64_tr_b16 v[220:221], v12 offset:16896
s_waitcnt lgkmcnt(3)
v_lshlrev_b32 v110, 3, v110
v_mfma_f32_16x16x32_bf16 a[16:19], v[176:179], v[208:211], a[16:19]
ds_read_b64_tr_b16 v[222:223], v12 offset:18944
v_add_f32 v225, v229, v236
v_add_u32 v110, 0x7c32000, v110
v_mfma_f32_16x16x32_bf16 a[16:19], v[160:163], v[212:215], a[16:19]
v_cvt_pk_bf16_f32 v34, v236, v237
buffer_load_dwordx2 v[108:109], v110, s[16:19], 0 offen sc1
v_mfma_f32_16x16x32_bf16 a[20:23], v[180:183], v[208:211], a[20:23]
v_exp_f32 v239, v151
v_mfma_f32_16x16x32_bf16 a[20:23], v[164:167], v[212:215], a[20:23]
v_add_f32 v225, v225, v237
v_add_f32 v225, v225, v238
v_mfma_f32_16x16x32_bf16 a[24:27], v[184:187], v[208:211], a[24:27]
v_add_f32 v225, v225, v239
v_cvt_pk_bf16_f32 v35, v238, v239
v_mfma_f32_16x16x32_bf16 a[24:27], v[168:171], v[212:215], a[24:27]
v_exp_f32 v232, v152
v_mfma_f32_16x16x32_bf16 a[28:31], v[188:191], v[208:211], a[28:31]
ds_read_b64_tr_b16 v[208:209], v14 offset:512
s_add_u32 m0, s28, 0
v_mfma_f32_16x16x32_bf16 a[28:31], v[172:175], v[212:215], a[28:31]
ds_read_b64_tr_b16 v[210:211], v14 offset:2560
ds_read_b64_tr_b16 v[212:213], v13 offset:512
s_waitcnt lgkmcnt(3)
v_mfma_f32_16x16x32_bf16 a[32:35], v[8:11], v[216:219], a[32:35]
ds_read_b64_tr_b16 v[214:215], v13 offset:2560
buffer_load_dwordx4 v241, s[16:19], s6 offen sc1 lds
s_add_u32 m0, s28, 8192
v_mfma_f32_16x16x32_bf16 a[32:35], v[176:179], v[220:223], a[32:35]
v_exp_f32 v233, v153
v_mfma_f32_16x16x32_bf16 a[36:39], v[40:43], v[216:219], a[36:39]
v_exp_f32 v234, v154
v_mfma_f32_16x16x32_bf16 a[36:39], v[180:183], v[220:223], a[36:39]
v_add_f32 v226, v230, v232
v_cvt_pk_bf16_f32 v66, v232, v233
v_mfma_f32_16x16x32_bf16 a[40:43], v[72:75], v[216:219], a[40:43]
v_exp_f32 v235, v155
v_mfma_f32_16x16x32_bf16 a[40:43], v[184:187], v[220:223], a[40:43]
v_add_f32 v226, v226, v233
v_add_f32 v226, v226, v234
v_mfma_f32_16x16x32_bf16 a[44:47], v[104:107], v[216:219], a[44:47]
ds_read_b64_tr_b16 v[216:217], v13 offset:16896
v_add_f32 v226, v226, v235
v_mfma_f32_16x16x32_bf16 a[44:47], v[188:191], v[220:223], a[44:47]
ds_read_b64_tr_b16 v[218:219], v13 offset:18944
ds_read_b64_tr_b16 v[220:221], v15 offset:512
s_waitcnt lgkmcnt(5)
v_mfma_f32_16x16x32_bf16 a[32:35], v[160:163], v[208:211], a[32:35]
ds_read_b64_tr_b16 v[222:223], v15 offset:2560
v_cvt_pk_bf16_f32 v67, v234, v235
v_mfma_f32_16x16x32_bf16 a[36:39], v[164:167], v[208:211], a[36:39]
v_exp_f32 v236, v156
v_mfma_f32_16x16x32_bf16 a[40:43], v[168:171], v[208:211], a[40:43]
v_exp_f32 v237, v157
v_mfma_f32_16x16x32_bf16 a[44:47], v[172:175], v[208:211], a[44:47]
ds_read_b64_tr_b16 v[208:209], v14 offset:16384
s_waitcnt lgkmcnt(5)
v_mfma_f32_16x16x32_bf16 a[48:51], v[8:11], v[212:215], a[48:51]
ds_read_b64_tr_b16 v[210:211], v14 offset:18432
buffer_load_dwordx4 v241, s[16:19], s7 offen sc1 lds
s_add_u32 m0, s30, 0
v_mfma_f32_16x16x32_bf16 a[52:55], v[40:43], v[212:215], a[52:55]
v_exp_f32 v238, v158
v_mfma_f32_16x16x32_bf16 a[56:59], v[72:75], v[212:215], a[56:59]
v_add_f32 v227, v231, v236
v_cvt_pk_bf16_f32 v98, v236, v237
v_mfma_f32_16x16x32_bf16 a[60:63], v[104:107], v[212:215], a[60:63]
ds_read_b64_tr_b16 v[212:213], v15 offset:16384
s_waitcnt lgkmcnt(3)
v_mfma_f32_16x16x32_bf16 a[48:51], v[176:179], v[216:219], a[48:51]
ds_read_b64_tr_b16 v[214:215], v15 offset:18432
buffer_load_dwordx4 v241, s[16:19], s29 offen sc1 lds
s_add_u32 m0, s28, 4096
v_mfma_f32_16x16x32_bf16 a[48:51], v[160:163], v[220:223], a[48:51]
v_exp_f32 v239, v159
v_xor_b32 v241, 0x1040, v241
v_mfma_f32_16x16x32_bf16 a[52:55], v[180:183], v[216:219], a[52:55]
v_add_f32 v227, v227, v237
v_add_f32 v227, v227, v238
v_mfma_f32_16x16x32_bf16 a[52:55], v[164:167], v[220:223], a[52:55]
v_add_f32 v227, v227, v239
v_cvt_pk_bf16_f32 v99, v238, v239
v_mfma_f32_16x16x32_bf16 a[56:59], v[184:187], v[216:219], a[56:59]
v_max3_f32 v242, v224, v225, v226
v_max_f32 v242, v242, v227
v_mfma_f32_16x16x32_bf16 a[56:59], v[168:171], v[220:223], a[56:59]
v_cmp_lt_f32 vcc, s32, v242
s_cbranch_vccnz L2_rare_site19
L2_ret19:
v_mfma_f32_16x16x32_bf16 a[60:63], v[188:191], v[216:219], a[60:63]
ds_read_b64_tr_b16 v[216:217], v14 offset:16896
buffer_load_dwordx4 v241, s[16:19], s6 offen sc1 lds
s_add_u32 m0, s28, 12288
v_mfma_f32_16x16x32_bf16 a[60:63], v[172:175], v[220:223], a[60:63]
ds_read_b64_tr_b16 v[218:219], v14 offset:18944
ds_read_b64_tr_b16 v[220:221], v15 offset:16896
s_waitcnt lgkmcnt(5)
v_mfma_f32_16x16x32_bf16 a[0:3], v[0:3], v[208:211], a[0:3]
ds_read_b64_tr_b16 v[222:223], v15 offset:18944
buffer_load_dwordx4 v241, s[16:19], s7 offen sc1 lds
s_add_u32 m0, s30, 4096
v_mfma_f32_16x16x32_bf16 a[4:7], v[32:35], v[208:211], a[4:7]
buffer_load_dwordx4 v241, s[16:19], s29 offen sc1 lds
v_bfe_u32 v242, v248, 8, 1
v_mfma_f32_16x16x32_bf16 a[8:11], v[64:67], v[208:211], a[8:11]
v_mul_u32_u24 v242, 48, v242
v_lshl_add_u32 v242, s37, 3, v242
v_and_b32 v243, 0xf0, v248
v_mfma_f32_16x16x32_bf16 a[12:15], v[96:99], v[208:211], a[12:15]
ds_read_b64_tr_b16 v[208:209], v249 offset:20480
s_waitcnt lgkmcnt(5)
v_lshl_add_u32 v242, v243, 3, v242
v_mfma_f32_16x16x32_bf16 a[16:19], v[0:3], v[212:215], a[16:19]
ds_read_b64_tr_b16 v[210:211], v249 offset:22528
v_mov_b32 v232, v224
v_mov_b32 v234, v225
v_mfma_f32_16x16x32_bf16 a[20:23], v[32:35], v[212:215], a[20:23]
v_mov_b32 v236, v226
v_mov_b32 v238, v227
v_permlane32_swap_b32 v224, v232
v_mfma_f32_16x16x32_bf16 a[24:27], v[64:67], v[212:215], a[24:27]
v_permlane32_swap_b32 v225, v234
v_permlane32_swap_b32 v226, v236
v_permlane32_swap_b32 v227, v238
v_mfma_f32_16x16x32_bf16 a[28:31], v[96:99], v[212:215], a[28:31]
ds_read_b64_tr_b16 v[212:213], v12 offset:4096
s_waitcnt lgkmcnt(5)
v_add_f32 v224, v224, v232
v_mfma_f32_16x16x32_bf16 a[32:35], v[0:3], v[216:219], a[32:35]
ds_read_b64_tr_b16 v[214:215], v12 offset:6144
v_add_f32 v225, v225, v234
v_add_f32 v226, v226, v236
v_mfma_f32_16x16x32_bf16 a[36:39], v[32:35], v[216:219], a[36:39]
v_add_f32 v227, v227, v238
v_mov_b32 v232, v224
v_mov_b32 v234, v225
v_mfma_f32_16x16x32_bf16 a[40:43], v[64:67], v[216:219], a[40:43]
v_mov_b32 v236, v226
v_mov_b32 v238, v227
v_permlane16_swap_b32 v224, v232
v_mfma_f32_16x16x32_bf16 a[44:47], v[96:99], v[216:219], a[44:47]
ds_read_b64_tr_b16 v[216:217], v12 offset:20480
s_waitcnt lgkmcnt(5)
v_permlane16_swap_b32 v225, v234
v_mfma_f32_16x16x32_bf16 a[48:51], v[0:3], v[220:223], a[48:51]
ds_read_b64_tr_b16 v[218:219], v12 offset:22528
v_permlane16_swap_b32 v226, v236
v_permlane16_swap_b32 v227, v238
v_mfma_f32_16x16x32_bf16 a[52:55], v[32:35], v[220:223], a[52:55]
v_add_f32 v233, v224, v232
v_add_f32 v235, v225, v234
v_add_f32 v237, v226, v236
v_mfma_f32_16x16x32_bf16 a[56:59], v[64:67], v[220:223], a[56:59]
v_add_f32 v239, v227, v238
v_mov_b32 v232, v244
v_mov_b32 v234, v245
v_mfma_f32_16x16x32_bf16 a[60:63], v[96:99], v[220:223], a[60:63]
ds_read_b64_tr_b16 v[220:221], v14 offset:4096
s_waitcnt lgkmcnt(3)
v_mov_b32 v236, v246
v_mfma_f32_16x16x32_bf16 a[64:67], v[4:7], v[208:211], a[64:67]
ds_read_b64_tr_b16 v[222:223], v14 offset:6144
v_mov_b32 v238, v247
v_mfma_f32_16x16x32_bf16 a[64:67], v[8:11], v[212:215], a[64:67]
s_mov_b32 exec_hi, 0
buffer_store_dwordx2 v[232:233], v242, s[24:27], s48 offen sc1
s_lshr_b32 s3, s41, 2
buffer_store_dwordx2 v[234:235], v242, s[24:27], s3 offen sc1
s_lshr_b32 s3, s42, 2
buffer_store_dwordx2 v[236:237], v242, s[24:27], s3 offen sc1
s_lshr_b32 s3, s43, 2
buffer_store_dwordx2 v[238:239], v242, s[24:27], s3 offen sc1
s_mov_b32 exec_hi, -1
v_mfma_f32_16x16x32_bf16 a[68:71], v[36:39], v[208:211], a[68:71]
v_accvgpr_read_b32 v128, a0
v_accvgpr_read_b32 v129, a1
v_accvgpr_read_b32 v130, a2
v_mfma_f32_16x16x32_bf16 a[68:71], v[40:43], v[212:215], a[68:71]
v_accvgpr_read_b32 v131, a3
v_cvt_pk_bf16_f32 v16, v128, v129
v_cvt_pk_bf16_f32 v17, v130, v131
v_mfma_f32_16x16x32_bf16 a[72:75], v[68:71], v[208:211], a[72:75]
v_accvgpr_read_b32 v136, a4
v_accvgpr_read_b32 v137, a5
v_accvgpr_read_b32 v138, a6
v_mfma_f32_16x16x32_bf16 a[72:75], v[72:75], v[212:215], a[72:75]
v_accvgpr_read_b32 v139, a7
v_cvt_pk_bf16_f32 v48, v136, v137
v_cvt_pk_bf16_f32 v49, v138, v139
v_mfma_f32_16x16x32_bf16 a[76:79], v[100:103], v[208:211], a[76:79]
ds_read_b64_tr_b16 v[208:209], v14 offset:20480
v_accvgpr_read_b32 v144, a8
v_accvgpr_read_b32 v145, a9
v_mfma_f32_16x16x32_bf16 a[76:79], v[104:107], v[212:215], a[76:79]
ds_read_b64_tr_b16 v[210:211], v14 offset:22528
ds_read_b64_tr_b16 v[212:213], v250 offset:20480
s_waitcnt lgkmcnt(3)
v_mfma_f32_16x16x32_bf16 a[64:67], v[176:179], v[216:219], a[64:67]
ds_read_b64_tr_b16 v[214:215], v250 offset:22528
v_accvgpr_read_b32 v146, a10
v_accvgpr_read_b32 v147, a11
v_mfma_f32_16x16x32_bf16 a[64:67], v[160:163], v[220:223], a[64:67]
v_cvt_pk_bf16_f32 v80, v144, v145
v_cvt_pk_bf16_f32 v81, v146, v147
v_accvgpr_read_b32 v152, a12
v_mfma_f32_16x16x32_bf16 a[68:71], v[180:183], v[216:219], a[68:71]
v_accvgpr_read_b32 v153, a13
v_accvgpr_read_b32 v154, a14
v_accvgpr_read_b32 v155, a15
v_mfma_f32_16x16x32_bf16 a[68:71], v[164:167], v[220:223], a[68:71]
v_cvt_pk_bf16_f32 v112, v152, v153
v_cvt_pk_bf16_f32 v113, v154, v155
v_accvgpr_read_b32 v132, a16
v_mfma_f32_16x16x32_bf16 a[72:75], v[184:187], v[216:219], a[72:75]
v_accvgpr_read_b32 v133, a17
v_accvgpr_read_b32 v134, a18
v_accvgpr_read_b32 v135, a19
v_mfma_f32_16x16x32_bf16 a[72:75], v[168:171], v[220:223], a[72:75]
v_cvt_pk_bf16_f32 v18, v132, v133
v_cvt_pk_bf16_f32 v19, v134, v135
buffer_store_dwordx4 v[16:19], v248, s[20:23], s40 offen offset:0 sc1
v_mfma_f32_16x16x32_bf16 a[76:79], v[188:191], v[216:219], a[76:79]
ds_read_b64_tr_b16 v[216:217], v13 offset:4096
ds_write_b128 v253, v[16:19] offset:0
v_accvgpr_read_b32 v140, a20
v_mfma_f32_16x16x32_bf16 a[76:79], v[172:175], v[220:223], a[76:79]
ds_read_b64_tr_b16 v[218:219], v13 offset:6144
ds_read_b64_tr_b16 v[220:221], v13 offset:20480
s_waitcnt lgkmcnt(5)
v_mfma_f32_16x16x32_bf16 a[64:67], v[0:3], v[208:211], a[64:67]
ds_read_b64_tr_b16 v[222:223], v13 offset:22528
v_accvgpr_read_b32 v141, a21
v_accvgpr_read_b32 v142, a22
v_mfma_f32_16x16x32_bf16 a[68:71], v[32:35], v[208:211], a[68:71]
v_accvgpr_read_b32 v143, a23
v_cvt_pk_bf16_f32 v50, v140, v141
v_cvt_pk_bf16_f32 v51, v142, v143
v_mfma_f32_16x16x32_bf16 a[72:75], v[64:67], v[208:211], a[72:75]
buffer_store_dwordx4 v[48:51], v248, s[20:23], s41 offen offset:0 sc1
v_accvgpr_read_b32 v148, a24
v_accvgpr_read_b32 v149, a25
v_mfma_f32_16x16x32_bf16 a[76:79], v[96:99], v[208:211], a[76:79]
ds_read_b64_tr_b16 v[208:209], v15 offset:4096
s_waitcnt lgkmcnt(5)
v_accvgpr_read_b32 v150, a26
v_mfma_f32_16x16x32_bf16 a[80:83], v[4:7], v[212:215], a[80:83]
ds_read_b64_tr_b16 v[210:211], v15 offset:6144
v_accvgpr_read_b32 v151, a27
v_cvt_pk_bf16_f32 v82, v148, v149
v_mfma_f32_16x16x32_bf16 a[84:87], v[36:39], v[212:215], a[84:87]
v_cvt_pk_bf16_f32 v83, v150, v151
buffer_store_dwordx4 v[80:83], v248, s[20:23], s42 offen offset:0 sc1
v_accvgpr_read_b32 v156, a28
v_mfma_f32_16x16x32_bf16 a[88:91], v[68:71], v[212:215], a[88:91]
v_accvgpr_read_b32 v157, a29
v_accvgpr_read_b32 v158, a30
v_accvgpr_read_b32 v159, a31
v_mfma_f32_16x16x32_bf16 a[92:95], v[100:103], v[212:215], a[92:95]
ds_read_b64_tr_b16 v[212:213], v15 offset:20480
s_waitcnt lgkmcnt(3)
v_cvt_pk_bf16_f32 v114, v156, v157
v_mfma_f32_16x16x32_bf16 a[80:83], v[8:11], v[216:219], a[80:83]
ds_read_b64_tr_b16 v[214:215], v15 offset:22528
v_cvt_pk_bf16_f32 v115, v158, v159
buffer_store_dwordx4 v[112:115], v248, s[20:23], s43 offen offset:0 sc1
v_mfma_f32_16x16x32_bf16 a[80:83], v[176:179], v[220:223], a[80:83]
v_accvgpr_read_b32 v128, a32
v_accvgpr_read_b32 v129, a33
v_accvgpr_read_b32 v130, a34
v_mfma_f32_16x16x32_bf16 a[84:87], v[40:43], v[216:219], a[84:87]
v_accvgpr_read_b32 v131, a35
v_cvt_pk_bf16_f32 v20, v128, v129
v_cvt_pk_bf16_f32 v21, v130, v131
v_mfma_f32_16x16x32_bf16 a[84:87], v[180:183], v[220:223], a[84:87]
v_accvgpr_read_b32 v136, a36
v_accvgpr_read_b32 v137, a37
v_accvgpr_read_b32 v138, a38
v_mfma_f32_16x16x32_bf16 a[88:91], v[72:75], v[216:219], a[88:91]
v_accvgpr_read_b32 v139, a39
v_cvt_pk_bf16_f32 v52, v136, v137
v_cvt_pk_bf16_f32 v53, v138, v139
v_mfma_f32_16x16x32_bf16 a[88:91], v[184:187], v[220:223], a[88:91]
v_accvgpr_read_b32 v144, a40
v_accvgpr_read_b32 v145, a41
v_accvgpr_read_b32 v146, a42
v_mfma_f32_16x16x32_bf16 a[92:95], v[104:107], v[216:219], a[92:95]
ds_read_b64_tr_b16 v[216:217], v249 offset:20992
v_accvgpr_read_b32 v147, a43
v_cvt_pk_bf16_f32 v84, v144, v145
v_mfma_f32_16x16x32_bf16 a[92:95], v[188:191], v[220:223], a[92:95]
ds_read_b64_tr_b16 v[218:219], v249 offset:23040
ds_read_b64_tr_b16 v[220:221], v12 offset:4608
s_waitcnt lgkmcnt(3)
v_mfma_f32_16x16x32_bf16 a[80:83], v[160:163], v[208:211], a[80:83]
ds_read_b64_tr_b16 v[222:223], v12 offset:6656
v_cvt_pk_bf16_f32 v85, v146, v147
v_accvgpr_read_b32 v152, a44
v_mfma_f32_16x16x32_bf16 a[80:83], v[0:3], v[212:215], a[80:83]
v_accvgpr_read_b32 v153, a45
v_accvgpr_read_b32 v154, a46
v_accvgpr_read_b32 v155, a47
v_mfma_f32_16x16x32_bf16 a[84:87], v[164:167], v[208:211], a[84:87]
v_cvt_pk_bf16_f32 v116, v152, v153
v_cvt_pk_bf16_f32 v117, v154, v155
v_accvgpr_read_b32 v132, a48
v_mfma_f32_16x16x32_bf16 a[84:87], v[32:35], v[212:215], a[84:87]
v_accvgpr_read_b32 v133, a49
v_accvgpr_read_b32 v134, a50
v_accvgpr_read_b32 v135, a51
v_mfma_f32_16x16x32_bf16 a[88:91], v[168:171], v[208:211], a[88:91]
v_cvt_pk_bf16_f32 v22, v132, v133
v_cvt_pk_bf16_f32 v23, v134, v135
buffer_store_dwordx4 v[20:23], v248, s[20:23], s40 offen offset:1024 sc1
v_mfma_f32_16x16x32_bf16 a[88:91], v[64:67], v[212:215], a[88:91]
ds_write_b128 v253, v[20:23] offset:1024
v_accvgpr_read_b32 v140, a52
v_accvgpr_read_b32 v141, a53
v_mfma_f32_16x16x32_bf16 a[92:95], v[172:175], v[208:211], a[92:95]
ds_read_b64_tr_b16 v[208:209], v12 offset:20992
v_accvgpr_read_b32 v142, a54
v_accvgpr_read_b32 v143, a55
v_mfma_f32_16x16x32_bf16 a[92:95], v[96:99], v[212:215], a[92:95]
ds_read_b64_tr_b16 v[210:211], v12 offset:23040
ds_read_b64_tr_b16 v[212:213], v14 offset:4608
s_waitcnt lgkmcnt(3)
v_mfma_f32_16x16x32_bf16 a[96:99], v[4:7], v[216:219], a[96:99]
ds_read_b64_tr_b16 v[214:215], v14 offset:6656
v_cvt_pk_bf16_f32 v54, v140, v141
v_cvt_pk_bf16_f32 v55, v142, v143
v_mfma_f32_16x16x32_bf16 a[96:99], v[8:11], v[220:223], a[96:99]
buffer_store_dwordx4 v[52:55], v248, s[20:23], s41 offen offset:1024 sc1
v_accvgpr_read_b32 v148, a56
v_accvgpr_read_b32 v149, a57
v_mfma_f32_16x16x32_bf16 a[100:103], v[36:39], v[216:219], a[100:103]
v_accvgpr_read_b32 v150, a58
v_accvgpr_read_b32 v151, a59
v_cvt_pk_bf16_f32 v86, v148, v149
v_mfma_f32_16x16x32_bf16 a[100:103], v[40:43], v[220:223], a[100:103]
v_cvt_pk_bf16_f32 v87, v150, v151
buffer_store_dwordx4 v[84:87], v248, s[20:23], s42 offen offset:1024 sc1
v_accvgpr_read_b32 v156, a60
v_mfma_f32_16x16x32_bf16 a[104:107], v[68:71], v[216:219], a[104:107]
v_accvgpr_read_b32 v157, a61
v_accvgpr_read_b32 v158, a62
v_accvgpr_read_b32 v159, a63
v_mfma_f32_16x16x32_bf16 a[104:107], v[72:75], v[220:223], a[104:107]
v_cvt_pk_bf16_f32 v118, v156, v157
v_cvt_pk_bf16_f32 v119, v158, v159
buffer_store_dwordx4 v[116:119], v248, s[20:23], s43 offen offset:1024 sc1
v_mfma_f32_16x16x32_bf16 a[108:111], v[100:103], v[216:219], a[108:111]
ds_read_b64_tr_b16 v[216:217], v14 offset:20992
v_accvgpr_read_b32 v128, a64
v_accvgpr_read_b32 v129, a65
v_mfma_f32_16x16x32_bf16 a[108:111], v[104:107], v[220:223], a[108:111]
ds_read_b64_tr_b16 v[218:219], v14 offset:23040
ds_read_b64_tr_b16 v[220:221], v250 offset:20992
s_waitcnt lgkmcnt(3)
v_mfma_f32_16x16x32_bf16 a[96:99], v[176:179], v[208:211], a[96:99]
ds_read_b64_tr_b16 v[222:223], v250 offset:23040
v_accvgpr_read_b32 v130, a66
v_accvgpr_read_b32 v131, a67
v_mfma_f32_16x16x32_bf16 a[96:99], v[160:163], v[212:215], a[96:99]
v_cvt_pk_bf16_f32 v24, v128, v129
v_cvt_pk_bf16_f32 v25, v130, v131
v_accvgpr_read_b32 v136, a68
v_mfma_f32_16x16x32_bf16 a[100:103], v[180:183], v[208:211], a[100:103]
v_accvgpr_read_b32 v137, a69
v_accvgpr_read_b32 v138, a70
v_accvgpr_read_b32 v139, a71
v_mfma_f32_16x16x32_bf16 a[100:103], v[164:167], v[212:215], a[100:103]
v_cvt_pk_bf16_f32 v56, v136, v137
v_cvt_pk_bf16_f32 v57, v138, v139
v_accvgpr_read_b32 v144, a72
v_mfma_f32_16x16x32_bf16 a[104:107], v[184:187], v[208:211], a[104:107]
v_accvgpr_read_b32 v145, a73
v_accvgpr_read_b32 v146, a74
v_accvgpr_read_b32 v147, a75
v_mfma_f32_16x16x32_bf16 a[104:107], v[168:171], v[212:215], a[104:107]
v_cvt_pk_bf16_f32 v88, v144, v145
v_cvt_pk_bf16_f32 v89, v146, v147
v_accvgpr_read_b32 v152, a76
v_mfma_f32_16x16x32_bf16 a[108:111], v[188:191], v[208:211], a[108:111]
ds_read_b64_tr_b16 v[208:209], v13 offset:4608
v_accvgpr_read_b32 v153, a77
v_accvgpr_read_b32 v154, a78
v_mfma_f32_16x16x32_bf16 a[108:111], v[172:175], v[212:215], a[108:111]
ds_read_b64_tr_b16 v[210:211], v13 offset:6656
ds_read_b64_tr_b16 v[212:213], v13 offset:20992
s_waitcnt lgkmcnt(5)
v_mfma_f32_16x16x32_bf16 a[96:99], v[0:3], v[216:219], a[96:99]
ds_read_b64_tr_b16 v[214:215], v13 offset:23040
v_accvgpr_read_b32 v155, a79
v_cvt_pk_bf16_f32 v120, v152, v153
v_mfma_f32_16x16x32_bf16 a[100:103], v[32:35], v[216:219], a[100:103]
v_cvt_pk_bf16_f32 v121, v154, v155
v_accvgpr_read_b32 v132, a80
v_accvgpr_read_b32 v133, a81
v_mfma_f32_16x16x32_bf16 a[104:107], v[64:67], v[216:219], a[104:107]
v_accvgpr_read_b32 v134, a82
v_accvgpr_read_b32 v135, a83
v_cvt_pk_bf16_f32 v26, v132, v133
v_mfma_f32_16x16x32_bf16 a[108:111], v[96:99], v[216:219], a[108:111]
ds_read_b64_tr_b16 v[216:217], v15 offset:4608
s_waitcnt lgkmcnt(5)
v_cvt_pk_bf16_f32 v27, v134, v135
v_mfma_f32_16x16x32_bf16 a[112:115], v[4:7], v[220:223], a[112:115]
ds_read_b64_tr_b16 v[218:219], v15 offset:6656
buffer_store_dwordx4 v[24:27], v248, s[20:23], s40 offen offset:2048 sc1
ds_write_b128 v253, v[24:27] offset:2048
v_mfma_f32_16x16x32_bf16 a[116:119], v[36:39], v[220:223], a[116:119]
v_accvgpr_read_b32 v140, a84
v_accvgpr_read_b32 v141, a85
v_accvgpr_read_b32 v142, a86
v_mfma_f32_16x16x32_bf16 a[120:123], v[68:71], v[220:223], a[120:123]
v_accvgpr_read_b32 v143, a87
v_cvt_pk_bf16_f32 v58, v140, v141
v_cvt_pk_bf16_f32 v59, v142, v143
v_mfma_f32_16x16x32_bf16 a[124:127], v[100:103], v[220:223], a[124:127]
ds_read_b64_tr_b16 v[220:221], v15 offset:20992
s_waitcnt lgkmcnt(3)
buffer_store_dwordx4 v[56:59], v248, s[20:23], s41 offen offset:2048 sc1
v_mfma_f32_16x16x32_bf16 a[112:115], v[8:11], v[208:211], a[112:115]
ds_read_b64_tr_b16 v[222:223], v15 offset:23040
v_accvgpr_read_b32 v148, a88
v_accvgpr_read_b32 v149, a89
v_mfma_f32_16x16x32_bf16 a[112:115], v[176:179], v[212:215], a[112:115]
v_accvgpr_read_b32 v150, a90
v_accvgpr_read_b32 v151, a91
v_cvt_pk_bf16_f32 v90, v148, v149
v_mfma_f32_16x16x32_bf16 a[116:119], v[40:43], v[208:211], a[116:119]
v_cvt_pk_bf16_f32 v91, v150, v151
buffer_store_dwordx4 v[88:91], v248, s[20:23], s42 offen offset:2048 sc1
v_accvgpr_read_b32 v156, a92
v_mfma_f32_16x16x32_bf16 a[116:119], v[180:183], v[212:215], a[116:119]
v_accvgpr_read_b32 v157, a93
v_accvgpr_read_b32 v158, a94
v_accvgpr_read_b32 v159, a95
v_mfma_f32_16x16x32_bf16 a[120:123], v[72:75], v[208:211], a[120:123]
v_cvt_pk_bf16_f32 v122, v156, v157
v_cvt_pk_bf16_f32 v123, v158, v159
buffer_store_dwordx4 v[120:123], v248, s[20:23], s43 offen offset:2048 sc1
v_mfma_f32_16x16x32_bf16 a[120:123], v[184:187], v[212:215], a[120:123]
v_accvgpr_read_b32 v128, a96
v_accvgpr_read_b32 v129, a97
v_mfma_f32_16x16x32_bf16 a[124:127], v[104:107], v[208:211], a[124:127]
ds_read_b64_tr_b16 v[208:209], v249 offset:24576
v_accvgpr_read_b32 v130, a98
v_mfma_f32_16x16x32_bf16 a[124:127], v[188:191], v[212:215], a[124:127]
ds_read_b64_tr_b16 v[210:211], v249 offset:26624
ds_read_b64_tr_b16 v[212:213], v12 offset:8192
s_waitcnt lgkmcnt(3)
v_mfma_f32_16x16x32_bf16 a[112:115], v[160:163], v[216:219], a[112:115]
ds_read_b64_tr_b16 v[214:215], v12 offset:10240
v_accvgpr_read_b32 v131, a99
v_mfma_f32_16x16x32_bf16 a[112:115], v[0:3], v[220:223], a[112:115]
v_cvt_pk_bf16_f32 v28, v128, v129
v_cvt_pk_bf16_f32 v29, v130, v131
v_mfma_f32_16x16x32_bf16 a[116:119], v[164:167], v[216:219], a[116:119]
v_accvgpr_read_b32 v136, a100
v_accvgpr_read_b32 v137, a101
v_mfma_f32_16x16x32_bf16 a[116:119], v[32:35], v[220:223], a[116:119]
v_accvgpr_read_b32 v138, a102
v_accvgpr_read_b32 v139, a103
v_mfma_f32_16x16x32_bf16 a[120:123], v[168:171], v[216:219], a[120:123]
v_cvt_pk_bf16_f32 v60, v136, v137
v_cvt_pk_bf16_f32 v61, v138, v139
v_mfma_f32_16x16x32_bf16 a[120:123], v[64:67], v[220:223], a[120:123]
v_accvgpr_read_b32 v144, a104
v_accvgpr_read_b32 v145, a105
v_mfma_f32_16x16x32_bf16 a[124:127], v[172:175], v[216:219], a[124:127]
ds_read_b64_tr_b16 v[216:217], v12 offset:24576
v_accvgpr_read_b32 v146, a106
v_mfma_f32_16x16x32_bf16 a[124:127], v[96:99], v[220:223], a[124:127]
ds_read_b64_tr_b16 v[218:219], v12 offset:26624
ds_read_b64_tr_b16 v[220:221], v14 offset:8192
s_waitcnt lgkmcnt(3)
v_mfma_f32_16x16x32_bf16 a[128:131], v[4:7], v[208:211], a[128:131]
ds_read_b64_tr_b16 v[222:223], v14 offset:10240
v_accvgpr_read_b32 v147, a107
v_mfma_f32_16x16x32_bf16 a[128:131], v[8:11], v[212:215], a[128:131]
v_cvt_pk_bf16_f32 v92, v144, v145
v_cvt_pk_bf16_f32 v93, v146, v147
v_mfma_f32_16x16x32_bf16 a[132:135], v[36:39], v[208:211], a[132:135]
v_accvgpr_read_b32 v152, a108
v_accvgpr_read_b32 v153, a109
v_mfma_f32_16x16x32_bf16 a[132:135], v[40:43], v[212:215], a[132:135]
v_accvgpr_read_b32 v154, a110
v_accvgpr_read_b32 v155, a111
v_mfma_f32_16x16x32_bf16 a[136:139], v[68:71], v[208:211], a[136:139]
v_cvt_pk_bf16_f32 v124, v152, v153
v_cvt_pk_bf16_f32 v125, v154, v155
v_mfma_f32_16x16x32_bf16 a[136:139], v[72:75], v[212:215], a[136:139]
v_accvgpr_read_b32 v132, a112
v_accvgpr_read_b32 v133, a113
v_mfma_f32_16x16x32_bf16 a[140:143], v[100:103], v[208:211], a[140:143]
ds_read_b64_tr_b16 v[208:209], v14 offset:24576
v_accvgpr_read_b32 v134, a114
v_mfma_f32_16x16x32_bf16 a[140:143], v[104:107], v[212:215], a[140:143]
ds_read_b64_tr_b16 v[210:211], v14 offset:26624
ds_read_b64_tr_b16 v[212:213], v250 offset:24576
s_waitcnt lgkmcnt(3)
v_mfma_f32_16x16x32_bf16 a[128:131], v[176:179], v[216:219], a[128:131]
ds_read_b64_tr_b16 v[214:215], v250 offset:26624
v_accvgpr_read_b32 v135, a115
v_mfma_f32_16x16x32_bf16 a[128:131], v[160:163], v[220:223], a[128:131]
v_cvt_pk_bf16_f32 v30, v132, v133
v_cvt_pk_bf16_f32 v31, v134, v135
v_mfma_f32_16x16x32_bf16 a[132:135], v[180:183], v[216:219], a[132:135]
buffer_store_dwordx4 v[28:31], v248, s[20:23], s40 offen offset:3072 sc1
ds_write_b128 v253, v[28:31] offset:3072
v_mfma_f32_16x16x32_bf16 a[132:135], v[164:167], v[220:223], a[132:135]
v_accvgpr_read_b32 v140, a116
v_accvgpr_read_b32 v141, a117
v_mfma_f32_16x16x32_bf16 a[136:139], v[184:187], v[216:219], a[136:139]
v_accvgpr_read_b32 v142, a118
v_accvgpr_read_b32 v143, a119
v_mfma_f32_16x16x32_bf16 a[136:139], v[168:171], v[220:223], a[136:139]
v_cvt_pk_bf16_f32 v62, v140, v141
v_cvt_pk_bf16_f32 v63, v142, v143
v_mfma_f32_16x16x32_bf16 a[140:143], v[188:191], v[216:219], a[140:143]
ds_read_b64_tr_b16 v[216:217], v13 offset:8192
buffer_store_dwordx4 v[60:63], v248, s[20:23], s41 offen offset:3072 sc1
v_mfma_f32_16x16x32_bf16 a[140:143], v[172:175], v[220:223], a[140:143]
ds_read_b64_tr_b16 v[218:219], v13 offset:10240
ds_read_b64_tr_b16 v[220:221], v13 offset:24576
s_waitcnt lgkmcnt(5)
v_mfma_f32_16x16x32_bf16 a[128:131], v[0:3], v[208:211], a[128:131]
ds_read_b64_tr_b16 v[222:223], v13 offset:26624
v_accvgpr_read_b32 v148, a120
v_mfma_f32_16x16x32_bf16 a[132:135], v[32:35], v[208:211], a[132:135]
v_accvgpr_read_b32 v149, a121
v_accvgpr_read_b32 v150, a122
v_mfma_f32_16x16x32_bf16 a[136:139], v[64:67], v[208:211], a[136:139]
v_accvgpr_read_b32 v151, a123
v_cvt_pk_bf16_f32 v94, v148, v149
v_mfma_f32_16x16x32_bf16 a[140:143], v[96:99], v[208:211], a[140:143]
ds_read_b64_tr_b16 v[208:209], v15 offset:8192
s_waitcnt lgkmcnt(5)
v_mfma_f32_16x16x32_bf16 a[144:147], v[4:7], v[212:215], a[144:147]
ds_read_b64_tr_b16 v[210:211], v15 offset:10240
v_cvt_pk_bf16_f32 v95, v150, v151
v_mfma_f32_16x16x32_bf16 a[148:151], v[36:39], v[212:215], a[148:151]
buffer_store_dwordx4 v[92:95], v248, s[20:23], s42 offen offset:3072 sc1
v_accvgpr_read_b32 v156, a124
v_mfma_f32_16x16x32_bf16 a[152:155], v[68:71], v[212:215], a[152:155]
v_accvgpr_read_b32 v157, a125
v_accvgpr_read_b32 v158, a126
v_mfma_f32_16x16x32_bf16 a[156:159], v[100:103], v[212:215], a[156:159]
ds_read_b64_tr_b16 v[212:213], v15 offset:24576
s_waitcnt lgkmcnt(3)
v_mfma_f32_16x16x32_bf16 a[144:147], v[8:11], v[216:219], a[144:147]
ds_read_b64_tr_b16 v[214:215], v15 offset:26624
v_accvgpr_read_b32 v159, a127
v_mfma_f32_16x16x32_bf16 a[144:147], v[176:179], v[220:223], a[144:147]
v_cvt_pk_bf16_f32 v126, v156, v157
v_cvt_pk_bf16_f32 v127, v158, v159
v_mfma_f32_16x16x32_bf16 a[148:151], v[40:43], v[216:219], a[148:151]
buffer_store_dwordx4 v[124:127], v248, s[20:23], s43 offen offset:3072 sc1
v_accvgpr_read_b32 v128, a128
v_mfma_f32_16x16x32_bf16 a[148:151], v[180:183], v[220:223], a[148:151]
v_accvgpr_read_b32 v129, a129
v_accvgpr_read_b32 v130, a130
v_mfma_f32_16x16x32_bf16 a[152:155], v[72:75], v[216:219], a[152:155]
v_accvgpr_read_b32 v131, a131
v_cvt_pk_bf16_f32 v16, v128, v129
v_mfma_f32_16x16x32_bf16 a[152:155], v[184:187], v[220:223], a[152:155]
v_cvt_pk_bf16_f32 v17, v130, v131
v_accvgpr_read_b32 v136, a132
v_mfma_f32_16x16x32_bf16 a[156:159], v[104:107], v[216:219], a[156:159]
ds_read_b64_tr_b16 v[216:217], v249 offset:25088
v_accvgpr_read_b32 v137, a133
v_mfma_f32_16x16x32_bf16 a[156:159], v[188:191], v[220:223], a[156:159]
ds_read_b64_tr_b16 v[218:219], v249 offset:27136
ds_read_b64_tr_b16 v[220:221], v12 offset:8704
s_waitcnt lgkmcnt(3)
v_mfma_f32_16x16x32_bf16 a[144:147], v[160:163], v[208:211], a[144:147]
ds_read_b64_tr_b16 v[222:223], v12 offset:10752
v_accvgpr_read_b32 v138, a134
v_mfma_f32_16x16x32_bf16 a[144:147], v[0:3], v[212:215], a[144:147]
v_accvgpr_read_b32 v139, a135
v_cvt_pk_bf16_f32 v48, v136, v137
v_mfma_f32_16x16x32_bf16 a[148:151], v[164:167], v[208:211], a[148:151]
v_cvt_pk_bf16_f32 v49, v138, v139
v_accvgpr_read_b32 v144, a136
v_mfma_f32_16x16x32_bf16 a[148:151], v[32:35], v[212:215], a[148:151]
v_accvgpr_read_b32 v145, a137
v_accvgpr_read_b32 v146, a138
v_mfma_f32_16x16x32_bf16 a[152:155], v[168:171], v[208:211], a[152:155]
v_accvgpr_read_b32 v147, a139
v_cvt_pk_bf16_f32 v80, v144, v145
v_mfma_f32_16x16x32_bf16 a[152:155], v[64:67], v[212:215], a[152:155]
v_cvt_pk_bf16_f32 v81, v146, v147
v_accvgpr_read_b32 v152, a140
v_mfma_f32_16x16x32_bf16 a[156:159], v[172:175], v[208:211], a[156:159]
ds_read_b64_tr_b16 v[208:209], v12 offset:25088
v_accvgpr_read_b32 v153, a141
v_mfma_f32_16x16x32_bf16 a[156:159], v[96:99], v[212:215], a[156:159]
ds_read_b64_tr_b16 v[210:211], v12 offset:27136
ds_read_b64_tr_b16 v[212:213], v14 offset:8704
s_waitcnt lgkmcnt(3)
v_mfma_f32_16x16x32_bf16 a[160:163], v[4:7], v[216:219], a[160:163]
ds_read_b64_tr_b16 v[214:215], v14 offset:10752
v_accvgpr_read_b32 v154, a142
v_mfma_f32_16x16x32_bf16 a[160:163], v[8:11], v[220:223], a[160:163]
v_accvgpr_read_b32 v155, a143
v_cvt_pk_bf16_f32 v112, v152, v153
v_mfma_f32_16x16x32_bf16 a[164:167], v[36:39], v[216:219], a[164:167]
v_cvt_pk_bf16_f32 v113, v154, v155
v_accvgpr_read_b32 v132, a144
v_mfma_f32_16x16x32_bf16 a[164:167], v[40:43], v[220:223], a[164:167]
v_accvgpr_read_b32 v133, a145
v_accvgpr_read_b32 v134, a146
v_mfma_f32_16x16x32_bf16 a[168:171], v[68:71], v[216:219], a[168:171]
v_accvgpr_read_b32 v135, a147
v_cvt_pk_bf16_f32 v18, v132, v133
v_mfma_f32_16x16x32_bf16 a[168:171], v[72:75], v[220:223], a[168:171]
v_cvt_pk_bf16_f32 v19, v134, v135
buffer_store_dwordx4 v[16:19], v248, s[20:23], s44 offen offset:0 sc1
v_mfma_f32_16x16x32_bf16 a[172:175], v[100:103], v[216:219], a[172:175]
ds_read_b64_tr_b16 v[216:217], v14 offset:25088
ds_write_b128 v253, v[16:19] offset:4096
v_mfma_f32_16x16x32_bf16 a[172:175], v[104:107], v[220:223], a[172:175]
ds_read_b64_tr_b16 v[218:219], v14 offset:27136
ds_read_b64_tr_b16 v[220:221], v250 offset:25088
s_waitcnt lgkmcnt(3)
v_mfma_f32_16x16x32_bf16 a[160:163], v[176:179], v[208:211], a[160:163]
ds_read_b64_tr_b16 v[222:223], v250 offset:27136
v_accvgpr_read_b32 v140, a148
v_mfma_f32_16x16x32_bf16 a[160:163], v[160:163], v[212:215], a[160:163]
v_accvgpr_read_b32 v141, a149
v_accvgpr_read_b32 v142, a150
v_mfma_f32_16x16x32_bf16 a[164:167], v[180:183], v[208:211], a[164:167]
v_accvgpr_read_b32 v143, a151
v_cvt_pk_bf16_f32 v50, v140, v141
v_mfma_f32_16x16x32_bf16 a[164:167], v[164:167], v[212:215], a[164:167]
v_cvt_pk_bf16_f32 v51, v142, v143
buffer_store_dwordx4 v[48:51], v248, s[20:23], s45 offen offset:0 sc1
v_mfma_f32_16x16x32_bf16 a[168:171], v[184:187], v[208:211], a[168:171]
v_accvgpr_read_b32 v148, a152
v_accvgpr_read_b32 v149, a153
v_mfma_f32_16x16x32_bf16 a[168:171], v[168:171], v[212:215], a[168:171]
v_accvgpr_read_b32 v150, a154
v_accvgpr_read_b32 v151, a155
v_mfma_f32_16x16x32_bf16 a[172:175], v[188:191], v[208:211], a[172:175]
ds_read_b64_tr_b16 v[208:209], v13 offset:8704
v_cvt_pk_bf16_f32 v82, v148, v149
v_mfma_f32_16x16x32_bf16 a[172:175], v[172:175], v[212:215], a[172:175]
ds_read_b64_tr_b16 v[210:211], v13 offset:10752
ds_read_b64_tr_b16 v[212:213], v13 offset:25088
s_waitcnt lgkmcnt(5)
v_mfma_f32_16x16x32_bf16 a[160:163], v[0:3], v[216:219], a[160:163]
ds_read_b64_tr_b16 v[214:215], v13 offset:27136
v_cvt_pk_bf16_f32 v83, v150, v151
v_mfma_f32_16x16x32_bf16 a[164:167], v[32:35], v[216:219], a[164:167]
buffer_store_dwordx4 v[80:83], v248, s[20:23], s46 offen offset:0 sc1
v_accvgpr_read_b32 v156, a156
v_mfma_f32_16x16x32_bf16 a[168:171], v[64:67], v[216:219], a[168:171]
v_accvgpr_read_b32 v157, a157
v_accvgpr_read_b32 v158, a158
v_mfma_f32_16x16x32_bf16 a[172:175], v[96:99], v[216:219], a[172:175]
ds_read_b64_tr_b16 v[216:217], v15 offset:8704
s_waitcnt lgkmcnt(5)
v_mfma_f32_16x16x32_bf16 a[176:179], v[4:7], v[220:223], a[176:179]
ds_read_b64_tr_b16 v[218:219], v15 offset:10752
v_accvgpr_read_b32 v159, a159
v_mfma_f32_16x16x32_bf16 a[180:183], v[36:39], v[220:223], a[180:183]
v_cvt_pk_bf16_f32 v114, v156, v157
v_cvt_pk_bf16_f32 v115, v158, v159
v_mfma_f32_16x16x32_bf16 a[184:187], v[68:71], v[220:223], a[184:187]
buffer_store_dwordx4 v[112:115], v248, s[20:23], s47 offen offset:0 sc1
v_accvgpr_read_b32 v128, a160
v_mfma_f32_16x16x32_bf16 a[188:191], v[100:103], v[220:223], a[188:191]
ds_read_b64_tr_b16 v[220:221], v15 offset:25088
s_waitcnt lgkmcnt(3)
v_mfma_f32_16x16x32_bf16 a[176:179], v[8:11], v[208:211], a[176:179]
ds_read_b64_tr_b16 v[222:223], v15 offset:27136
v_accvgpr_read_b32 v129, a161
v_mfma_f32_16x16x32_bf16 a[176:179], v[176:179], v[212:215], a[176:179]
v_accvgpr_read_b32 v130, a162
v_accvgpr_read_b32 v131, a163
v_mfma_f32_16x16x32_bf16 a[180:183], v[40:43], v[208:211], a[180:183]
v_cvt_pk_bf16_f32 v20, v128, v129
v_cvt_pk_bf16_f32 v21, v130, v131
v_mfma_f32_16x16x32_bf16 a[180:183], v[180:183], v[212:215], a[180:183]
v_accvgpr_read_b32 v136, a164
v_accvgpr_read_b32 v137, a165
v_mfma_f32_16x16x32_bf16 a[184:187], v[72:75], v[208:211], a[184:187]
v_accvgpr_read_b32 v138, a166
v_accvgpr_read_b32 v139, a167
v_mfma_f32_16x16x32_bf16 a[184:187], v[184:187], v[212:215], a[184:187]
v_cvt_pk_bf16_f32 v52, v136, v137
v_cvt_pk_bf16_f32 v53, v138, v139
v_mfma_f32_16x16x32_bf16 a[188:191], v[104:107], v[208:211], a[188:191]
ds_read_b64_tr_b16 v[208:209], v249 offset:28672
v_accvgpr_read_b32 v144, a168
v_mfma_f32_16x16x32_bf16 a[188:191], v[188:191], v[212:215], a[188:191]
ds_read_b64_tr_b16 v[210:211], v249 offset:30720
ds_read_b64_tr_b16 v[212:213], v12 offset:12288
s_waitcnt lgkmcnt(3)
v_mfma_f32_16x16x32_bf16 a[176:179], v[160:163], v[216:219], a[176:179]
ds_read_b64_tr_b16 v[214:215], v12 offset:14336
v_accvgpr_read_b32 v145, a169
v_mfma_f32_16x16x32_bf16 a[176:179], v[0:3], v[220:223], a[176:179]
v_accvgpr_read_b32 v146, a170
v_accvgpr_read_b32 v147, a171
v_mfma_f32_16x16x32_bf16 a[180:183], v[164:167], v[216:219], a[180:183]
v_cvt_pk_bf16_f32 v84, v144, v145
v_cvt_pk_bf16_f32 v85, v146, v147
v_mfma_f32_16x16x32_bf16 a[180:183], v[32:35], v[220:223], a[180:183]
v_accvgpr_read_b32 v152, a172
v_accvgpr_read_b32 v153, a173
v_mfma_f32_16x16x32_bf16 a[184:187], v[168:171], v[216:219], a[184:187]
v_accvgpr_read_b32 v154, a174
v_accvgpr_read_b32 v155, a175
v_mfma_f32_16x16x32_bf16 a[184:187], v[64:67], v[220:223], a[184:187]
v_cvt_pk_bf16_f32 v116, v152, v153
v_cvt_pk_bf16_f32 v117, v154, v155
v_mfma_f32_16x16x32_bf16 a[188:191], v[172:175], v[216:219], a[188:191]
ds_read_b64_tr_b16 v[216:217], v12 offset:28672
v_mfma_f32_16x16x32_bf16 a[188:191], v[96:99], v[220:223], a[188:191]
ds_read_b64_tr_b16 v[218:219], v12 offset:30720
ds_read_b64_tr_b16 v[220:221], v14 offset:12288
s_waitcnt lgkmcnt(3)
v_mfma_f32_16x16x32_bf16 a[192:195], v[4:7], v[208:211], a[192:195]
ds_read_b64_tr_b16 v[222:223], v14 offset:14336
v_mfma_f32_16x16x32_bf16 a[192:195], v[8:11], v[212:215], a[192:195]
v_mfma_f32_16x16x32_bf16 a[196:199], v[36:39], v[208:211], a[196:199]
v_accvgpr_read_b32 v132, a176
v_accvgpr_read_b32 v133, a177
v_mfma_f32_16x16x32_bf16 a[196:199], v[40:43], v[212:215], a[196:199]
v_accvgpr_read_b32 v134, a178
v_accvgpr_read_b32 v135, a179
v_mfma_f32_16x16x32_bf16 a[200:203], v[68:71], v[208:211], a[200:203]
v_cvt_pk_bf16_f32 v22, v132, v133
v_cvt_pk_bf16_f32 v23, v134, v135
v_mfma_f32_16x16x32_bf16 a[200:203], v[72:75], v[212:215], a[200:203]
buffer_store_dwordx4 v[20:23], v248, s[20:23], s44 offen offset:1024 sc1
ds_write_b128 v253, v[20:23] offset:5120
v_mfma_f32_16x16x32_bf16 a[204:207], v[100:103], v[208:211], a[204:207]
ds_read_b64_tr_b16 v[208:209], v14 offset:28672
v_accvgpr_read_b32 v140, a180
v_mfma_f32_16x16x32_bf16 a[204:207], v[104:107], v[212:215], a[204:207]
ds_read_b64_tr_b16 v[210:211], v14 offset:30720
ds_read_b64_tr_b16 v[212:213], v250 offset:28672
s_waitcnt lgkmcnt(3)
v_mfma_f32_16x16x32_bf16 a[192:195], v[176:179], v[216:219], a[192:195]
ds_read_b64_tr_b16 v[214:215], v250 offset:30720
v_accvgpr_read_b32 v141, a181
v_mfma_f32_16x16x32_bf16 a[192:195], v[160:163], v[220:223], a[192:195]
v_accvgpr_read_b32 v142, a182
v_accvgpr_read_b32 v143, a183
v_mfma_f32_16x16x32_bf16 a[196:199], v[180:183], v[216:219], a[196:199]
v_cvt_pk_bf16_f32 v54, v140, v141
v_cvt_pk_bf16_f32 v55, v142, v143
v_mfma_f32_16x16x32_bf16 a[196:199], v[164:167], v[220:223], a[196:199]
buffer_store_dwordx4 v[52:55], v248, s[20:23], s45 offen offset:1024 sc1
v_accvgpr_read_b32 v148, a184
v_mfma_f32_16x16x32_bf16 a[200:203], v[184:187], v[216:219], a[200:203]
v_accvgpr_read_b32 v149, a185
v_accvgpr_read_b32 v150, a186
v_mfma_f32_16x16x32_bf16 a[200:203], v[168:171], v[220:223], a[200:203]
v_accvgpr_read_b32 v151, a187
v_cvt_pk_bf16_f32 v86, v148, v149
v_mfma_f32_16x16x32_bf16 a[204:207], v[188:191], v[216:219], a[204:207]
ds_read_b64_tr_b16 v[216:217], v13 offset:12288
v_cvt_pk_bf16_f32 v87, v150, v151
v_mfma_f32_16x16x32_bf16 a[204:207], v[172:175], v[220:223], a[204:207]
ds_read_b64_tr_b16 v[218:219], v13 offset:14336
ds_read_b64_tr_b16 v[220:221], v13 offset:28672
s_waitcnt lgkmcnt(5)
v_mfma_f32_16x16x32_bf16 a[192:195], v[0:3], v[208:211], a[192:195]
ds_read_b64_tr_b16 v[222:223], v13 offset:30720
buffer_store_dwordx4 v[84:87], v248, s[20:23], s46 offen offset:1024 sc1
v_mfma_f32_16x16x32_bf16 a[196:199], v[32:35], v[208:211], a[196:199]
v_accvgpr_read_b32 v156, a188
v_accvgpr_read_b32 v157, a189
v_mfma_f32_16x16x32_bf16 a[200:203], v[64:67], v[208:211], a[200:203]
v_accvgpr_read_b32 v158, a190
v_accvgpr_read_b32 v159, a191
v_mfma_f32_16x16x32_bf16 a[204:207], v[96:99], v[208:211], a[204:207]
ds_read_b64_tr_b16 v[208:209], v15 offset:12288
s_waitcnt lgkmcnt(5)
v_mfma_f32_16x16x32_bf16 a[208:211], v[4:7], v[212:215], a[208:211]
ds_read_b64_tr_b16 v[210:211], v15 offset:14336
v_cvt_pk_bf16_f32 v118, v156, v157
v_mfma_f32_16x16x32_bf16 a[212:215], v[36:39], v[212:215], a[212:215]
v_cvt_pk_bf16_f32 v119, v158, v159
buffer_store_dwordx4 v[116:119], v248, s[20:23], s47 offen offset:1024 sc1
v_mfma_f32_16x16x32_bf16 a[216:219], v[68:71], v[212:215], a[216:219]
v_accvgpr_read_b32 v128, a192
v_accvgpr_read_b32 v129, a193
v_mfma_f32_16x16x32_bf16 a[220:223], v[100:103], v[212:215], a[220:223]
ds_read_b64_tr_b16 v[212:213], v15 offset:28672
s_waitcnt lgkmcnt(3)
v_mfma_f32_16x16x32_bf16 a[208:211], v[8:11], v[216:219], a[208:211]
ds_read_b64_tr_b16 v[214:215], v15 offset:30720
v_accvgpr_read_b32 v130, a194
v_mfma_f32_16x16x32_bf16 a[208:211], v[176:179], v[220:223], a[208:211]
v_accvgpr_read_b32 v131, a195
v_cvt_pk_bf16_f32 v24, v128, v129
v_mfma_f32_16x16x32_bf16 a[212:215], v[40:43], v[216:219], a[212:215]
v_cvt_pk_bf16_f32 v25, v130, v131
v_accvgpr_read_b32 v136, a196
v_mfma_f32_16x16x32_bf16 a[212:215], v[180:183], v[220:223], a[212:215]
v_accvgpr_read_b32 v137, a197
v_accvgpr_read_b32 v138, a198
v_mfma_f32_16x16x32_bf16 a[216:219], v[72:75], v[216:219], a[216:219]
v_accvgpr_read_b32 v139, a199
v_cvt_pk_bf16_f32 v56, v136, v137
v_mfma_f32_16x16x32_bf16 a[216:219], v[184:187], v[220:223], a[216:219]
v_cvt_pk_bf16_f32 v57, v138, v139
v_accvgpr_read_b32 v144, a200
v_mfma_f32_16x16x32_bf16 a[220:223], v[104:107], v[216:219], a[220:223]
ds_read_b64_tr_b16 v[216:217], v249 offset:29184
v_accvgpr_read_b32 v145, a201
v_mfma_f32_16x16x32_bf16 a[220:223], v[188:191], v[220:223], a[220:223]
ds_read_b64_tr_b16 v[218:219], v249 offset:31232
ds_read_b64_tr_b16 v[220:221], v12 offset:12800
s_waitcnt lgkmcnt(3)
v_mfma_f32_16x16x32_bf16 a[208:211], v[160:163], v[208:211], a[208:211]
ds_read_b64_tr_b16 v[222:223], v12 offset:14848
v_accvgpr_read_b32 v146, a202
v_mfma_f32_16x16x32_bf16 a[208:211], v[0:3], v[212:215], a[208:211]
v_accvgpr_read_b32 v147, a203
v_cvt_pk_bf16_f32 v88, v144, v145
v_mfma_f32_16x16x32_bf16 a[212:215], v[164:167], v[208:211], a[212:215]
v_cvt_pk_bf16_f32 v89, v146, v147
v_accvgpr_read_b32 v152, a204
v_mfma_f32_16x16x32_bf16 a[212:215], v[32:35], v[212:215], a[212:215]
v_accvgpr_read_b32 v153, a205
v_accvgpr_read_b32 v154, a206
v_mfma_f32_16x16x32_bf16 a[216:219], v[168:171], v[208:211], a[216:219]
v_accvgpr_read_b32 v155, a207
v_cvt_pk_bf16_f32 v120, v152, v153
v_mfma_f32_16x16x32_bf16 a[216:219], v[64:67], v[212:215], a[216:219]
v_cvt_pk_bf16_f32 v121, v154, v155
v_mfma_f32_16x16x32_bf16 a[220:223], v[172:175], v[208:211], a[220:223]
ds_read_b64_tr_b16 v[208:209], v12 offset:29184
v_mfma_f32_16x16x32_bf16 a[220:223], v[96:99], v[212:215], a[220:223]
ds_read_b64_tr_b16 v[210:211], v12 offset:31232
ds_read_b64_tr_b16 v[212:213], v14 offset:12800
s_waitcnt lgkmcnt(3)
v_mfma_f32_16x16x32_bf16 a[224:227], v[4:7], v[216:219], a[224:227]
ds_read_b64_tr_b16 v[214:215], v14 offset:14848
v_mfma_f32_16x16x32_bf16 a[224:227], v[8:11], v[220:223], a[224:227]
v_mfma_f32_16x16x32_bf16 a[228:231], v[36:39], v[216:219], a[228:231]
v_accvgpr_read_b32 v132, a208
v_accvgpr_read_b32 v133, a209
v_mfma_f32_16x16x32_bf16 a[228:231], v[40:43], v[220:223], a[228:231]
v_accvgpr_read_b32 v134, a210
v_accvgpr_read_b32 v135, a211
v_mfma_f32_16x16x32_bf16 a[232:235], v[68:71], v[216:219], a[232:235]
v_cvt_pk_bf16_f32 v26, v132, v133
v_cvt_pk_bf16_f32 v27, v134, v135
v_mfma_f32_16x16x32_bf16 a[232:235], v[72:75], v[220:223], a[232:235]
buffer_store_dwordx4 v[24:27], v248, s[20:23], s44 offen offset:2048 sc1
ds_write_b128 v253, v[24:27] offset:6144
v_mfma_f32_16x16x32_bf16 a[236:239], v[100:103], v[216:219], a[236:239]
ds_read_b64_tr_b16 v[216:217], v14 offset:29184
v_accvgpr_read_b32 v140, a212
v_mfma_f32_16x16x32_bf16 a[236:239], v[104:107], v[220:223], a[236:239]
ds_read_b64_tr_b16 v[218:219], v14 offset:31232
ds_read_b64_tr_b16 v[220:221], v250 offset:29184
s_waitcnt lgkmcnt(3)
v_mfma_f32_16x16x32_bf16 a[224:227], v[176:179], v[208:211], a[224:227]
ds_read_b64_tr_b16 v[222:223], v250 offset:31232
v_accvgpr_read_b32 v141, a213
v_mfma_f32_16x16x32_bf16 a[224:227], v[160:163], v[212:215], a[224:227]
v_accvgpr_read_b32 v142, a214
v_accvgpr_read_b32 v143, a215
v_mfma_f32_16x16x32_bf16 a[228:231], v[180:183], v[208:211], a[228:231]
v_cvt_pk_bf16_f32 v58, v140, v141
v_cvt_pk_bf16_f32 v59, v142, v143
v_mfma_f32_16x16x32_bf16 a[228:231], v[164:167], v[212:215], a[228:231]
buffer_store_dwordx4 v[56:59], v248, s[20:23], s45 offen offset:2048 sc1
v_accvgpr_read_b32 v148, a216
v_mfma_f32_16x16x32_bf16 a[232:235], v[184:187], v[208:211], a[232:235]
v_accvgpr_read_b32 v149, a217
v_accvgpr_read_b32 v150, a218
v_mfma_f32_16x16x32_bf16 a[232:235], v[168:171], v[212:215], a[232:235]
v_accvgpr_read_b32 v151, a219
v_cvt_pk_bf16_f32 v90, v148, v149
v_mfma_f32_16x16x32_bf16 a[236:239], v[188:191], v[208:211], a[236:239]
ds_read_b64_tr_b16 v[208:209], v13 offset:12800
v_cvt_pk_bf16_f32 v91, v150, v151
v_mfma_f32_16x16x32_bf16 a[236:239], v[172:175], v[212:215], a[236:239]
ds_read_b64_tr_b16 v[210:211], v13 offset:14848
ds_read_b64_tr_b16 v[212:213], v13 offset:29184
s_waitcnt lgkmcnt(5)
v_mfma_f32_16x16x32_bf16 a[224:227], v[0:3], v[216:219], a[224:227]
ds_read_b64_tr_b16 v[214:215], v13 offset:31232
buffer_store_dwordx4 v[88:91], v248, s[20:23], s46 offen offset:2048 sc1
v_mfma_f32_16x16x32_bf16 a[228:231], v[32:35], v[216:219], a[228:231]
v_accvgpr_read_b32 v156, a220
v_accvgpr_read_b32 v157, a221
v_mfma_f32_16x16x32_bf16 a[232:235], v[64:67], v[216:219], a[232:235]
v_accvgpr_read_b32 v158, a222
v_accvgpr_read_b32 v159, a223
v_mfma_f32_16x16x32_bf16 a[236:239], v[96:99], v[216:219], a[236:239]
ds_read_b64_tr_b16 v[216:217], v15 offset:12800
s_waitcnt lgkmcnt(5)
v_mfma_f32_16x16x32_bf16 a[240:243], v[4:7], v[220:223], a[240:243]
ds_read_b64_tr_b16 v[218:219], v15 offset:14848
v_cvt_pk_bf16_f32 v122, v156, v157
v_mfma_f32_16x16x32_bf16 a[244:247], v[36:39], v[220:223], a[244:247]
v_cvt_pk_bf16_f32 v123, v158, v159
buffer_store_dwordx4 v[120:123], v248, s[20:23], s47 offen offset:2048 sc1
v_mfma_f32_16x16x32_bf16 a[248:251], v[68:71], v[220:223], a[248:251]
v_accvgpr_read_b32 v128, a224
v_accvgpr_read_b32 v129, a225
v_mfma_f32_16x16x32_bf16 a[252:255], v[100:103], v[220:223], a[252:255]
ds_read_b64_tr_b16 v[220:221], v15 offset:29184
s_waitcnt lgkmcnt(3)
v_mfma_f32_16x16x32_bf16 a[240:243], v[8:11], v[208:211], a[240:243]
ds_read_b64_tr_b16 v[222:223], v15 offset:31232
v_accvgpr_read_b32 v130, a226
v_mfma_f32_16x16x32_bf16 a[240:243], v[176:179], v[212:215], a[240:243]
v_accvgpr_read_b32 v131, a227
v_cvt_pk_bf16_f32 v28, v128, v129
v_mfma_f32_16x16x32_bf16 a[244:247], v[40:43], v[208:211], a[244:247]
v_cvt_pk_bf16_f32 v29, v130, v131
v_accvgpr_read_b32 v136, a228
v_mfma_f32_16x16x32_bf16 a[244:247], v[180:183], v[212:215], a[244:247]
v_accvgpr_read_b32 v137, a229
v_accvgpr_read_b32 v138, a230
v_mfma_f32_16x16x32_bf16 a[248:251], v[72:75], v[208:211], a[248:251]
v_accvgpr_read_b32 v139, a231
v_cvt_pk_bf16_f32 v60, v136, v137
v_mfma_f32_16x16x32_bf16 a[248:251], v[184:187], v[212:215], a[248:251]
v_cvt_pk_bf16_f32 v61, v138, v139
v_accvgpr_read_b32 v144, a232
v_mfma_f32_16x16x32_bf16 a[252:255], v[104:107], v[208:211], a[252:255]
v_accvgpr_read_b32 v145, a233
v_accvgpr_read_b32 v146, a234
v_mfma_f32_16x16x32_bf16 a[252:255], v[188:191], v[212:215], a[252:255]
s_waitcnt lgkmcnt(0)
v_accvgpr_read_b32 v147, a235
v_mfma_f32_16x16x32_bf16 a[240:243], v[160:163], v[216:219], a[240:243]
v_cvt_pk_bf16_f32 v92, v144, v145
v_cvt_pk_bf16_f32 v93, v146, v147
v_mfma_f32_16x16x32_bf16 a[240:243], v[0:3], v[220:223], a[240:243]
v_accvgpr_read_b32 v152, a236
v_accvgpr_read_b32 v153, a237
v_mfma_f32_16x16x32_bf16 a[244:247], v[164:167], v[216:219], a[244:247]
v_accvgpr_read_b32 v154, a238
v_accvgpr_read_b32 v155, a239
v_mfma_f32_16x16x32_bf16 a[244:247], v[32:35], v[220:223], a[244:247]
v_cvt_pk_bf16_f32 v124, v152, v153
v_cvt_pk_bf16_f32 v125, v154, v155
v_mfma_f32_16x16x32_bf16 a[248:251], v[168:171], v[216:219], a[248:251]
v_mfma_f32_16x16x32_bf16 a[248:251], v[64:67], v[220:223], a[248:251]
v_mfma_f32_16x16x32_bf16 a[252:255], v[172:175], v[216:219], a[252:255]
v_mfma_f32_16x16x32_bf16 a[252:255], v[96:99], v[220:223], a[252:255]
v_accvgpr_read_b32 v132, a240
v_accvgpr_read_b32 v133, a241
v_accvgpr_read_b32 v134, a242
v_accvgpr_read_b32 v135, a243
v_cvt_pk_bf16_f32 v30, v132, v133
v_cvt_pk_bf16_f32 v31, v134, v135
buffer_store_dwordx4 v[28:31], v248, s[20:23], s44 offen offset:3072 sc1
ds_write_b128 v253, v[28:31] offset:7168
v_accvgpr_read_b32 v140, a244
v_accvgpr_read_b32 v141, a245
v_accvgpr_read_b32 v142, a246
v_accvgpr_read_b32 v143, a247
v_cvt_pk_bf16_f32 v62, v140, v141
v_cvt_pk_bf16_f32 v63, v142, v143
buffer_store_dwordx4 v[60:63], v248, s[20:23], s45 offen offset:3072 sc1
v_accvgpr_read_b32 v148, a248
v_accvgpr_read_b32 v149, a249
v_accvgpr_read_b32 v150, a250
v_accvgpr_read_b32 v151, a251
v_cvt_pk_bf16_f32 v94, v148, v149
v_cvt_pk_bf16_f32 v95, v150, v151
buffer_store_dwordx4 v[92:95], v248, s[20:23], s46 offen offset:3072 sc1
v_accvgpr_read_b32 v156, a252
v_accvgpr_read_b32 v157, a253
v_accvgpr_read_b32 v158, a254
v_accvgpr_read_b32 v159, a255
v_cvt_pk_bf16_f32 v126, v156, v157
v_cvt_pk_bf16_f32 v127, v158, v159
buffer_store_dwordx4 v[124:127], v248, s[20:23], s47 offen offset:3072 sc1
s_waitcnt vmcnt(36)
s_branch L2_F
L2_F:
v_cmp_ne_u64 vcc, s[98:99], v[108:109]
s_lshl_b32 s3, s34, 15
s_add_u32 s3, s3, 0x1000000
s_cbranch_vccnz LF_wf
LF_wf_go:
v_add_u32 v240, s3, v248
v_add_u32 v241, 0x4000, v240
s_mov_b32 s32, 0x0
s_mov_b32 s33, 0x1000
s_mov_b32 s35, 0x2000
s_mov_b32 s36, 0x3000
s_mov_b32 s38, 0x20000
s_mov_b32 s39, 0x21000
s_mov_b32 s40, 0x22000
s_mov_b32 s41, 0x23000
s_lshr_b32 s42, s6, 13
s_lshr_b32 s43, s7, 13
s_lshr_b32 s44, s29, 13
v_mov_b32 v244, s42
v_mov_b32 v232, s43
v_cmp_lt_u32 vcc, 0xff, v248
v_mov_b32 v233, s44
s_nop 0
v_cndmask_b32 v244, v244, v232, vcc
v_cmp_lt_u32 vcc, 0x1ff, v248
v_and_b32 v235, 0xf0, v248
s_nop 0
v_cndmask_b32 v244, v244, v233, vcc
v_lshlrev_b32 v244, 11, v244
v_lshl_add_u32 v244, v235, 3, v244
v_lshrrev_b32 v79, 6, v244
buffer_load_ushort v79, v79, s[52:55], 0 offen
buffer_load_dwordx4 a[0:3], v240, s[16:19], s32 offen offset:0 sc1
buffer_load_dwordx4 a[4:7], v240, s[16:19], s32 offen offset:1024 sc1
buffer_load_dwordx4 a[8:11], v241, s[16:19], s32 offen offset:0 sc1
buffer_load_dwordx4 a[12:15], v241, s[16:19], s32 offen offset:1024 sc1
buffer_load_dwordx4 a[16:19], v240, s[16:19], s32 offen offset:2048 sc1
buffer_load_dwordx4 a[20:23], v240, s[16:19], s32 offen offset:3072 sc1
buffer_load_dwordx4 a[24:27], v241, s[16:19], s32 offen offset:2048 sc1
buffer_load_dwordx4 a[28:31], v241, s[16:19], s32 offen offset:3072 sc1
buffer_load_dwordx4 a[32:35], v240, s[16:19], s33 offen offset:0 sc1
buffer_load_dwordx4 a[36:39], v240, s[16:19], s33 offen offset:1024 sc1
buffer_load_dwordx4 a[40:43], v241, s[16:19], s33 offen offset:0 sc1
buffer_load_dwordx4 a[44:47], v241, s[16:19], s33 offen offset:1024 sc1
s_lshl_b32 s3, s37, 3
v_add3_u32 v244, v244, s3, 8
s_cmp_ge_u32 s29, 0x70000000
s_cselect_b32 s44, s43, s44
v_mov_b32 v46, s42
v_mov_b32 v232, s43
v_cmp_lt_u32 vcc, 0x7f, v248
v_mov_b32 v233, s44
s_nop 0
v_cndmask_b32 v46, v46, v232, vcc
v_cmp_lt_u32 vcc, 0xff, v248
v_bfe_u32 v232, v248, 4, 3
s_nop 0
v_cndmask_b32 v46, v46, v233, vcc
v_min_u32 v232, 5, v232
v_lshrrev_b32 v46, 2, v46
v_lshl_add_u32 v46, v46, 3, v232
v_lshlrev_b32 v46, 7, v46
v_add_u32 v46, 0x7c00000, v46
s_lshl_b32 s49, s34, 10
s_add_u32 s49, s49, 0x20000
s_bfe_u32 s3, s6, 0x2000f
s_lshl_b32 s3, s3, 13
s_add_u32 s3, s3, s49
v_add_u32 v76, s3, v248
s_bfe_u32 s3, s7, 0x2000f
s_lshl_b32 s3, s3, 13
s_add_u32 s3, s3, s49
v_add_u32 v77, s3, v248
s_bfe_u32 s3, s29, 0x2000f
s_lshl_b32 s3, s3, 13
s_add_u32 s3, s3, s49
v_add_u32 v78, s3, v248
s_add_u32 s3, s37, 1
s_sub_u32 s49, s3, 6
s_cselect_b32 s3, s3, s49
s_mul_i32 s3, s3, 0x600000
s_add_u32 s42, s3, 0x2000000
s_add_u32 s3, s37, 2
s_sub_u32 s49, s3, 6
s_cselect_b32 s3, s3, s49
s_mul_i32 s3, s3, 0x600000
s_add_u32 s43, s3, 0x2000000
s_add_u32 s3, s37, 3
s_sub_u32 s49, s3, 6
s_cselect_b32 s3, s3, s49
s_mul_i32 s3, s3, 0x600000
s_add_u32 s44, s3, 0x2000000
s_add_u32 s3, s37, 4
s_sub_u32 s49, s3, 6
s_cselect_b32 s3, s3, s49
s_mul_i32 s3, s3, 0x600000
s_add_u32 s45, s3, 0x2000000
s_add_u32 s3, s37, 5
s_sub_u32 s49, s3, 6
s_cselect_b32 s3, s3, s49
s_mul_i32 s3, s3, 0x600000
s_add_u32 s46, s3, 0x2000000
s_add_u32 s3, s37, 6
s_sub_u32 s49, s3, 6
s_cselect_b32 s3, s3, s49
s_mul_i32 s3, s3, 0x600000
s_add_u32 s47, s3, 0x2000000
s_mul_i32 s3, s34, 896
v_add_u32 v47, s3, v248
v_add_u32 v43, 0x1000, v47
v_lshrrev_b32 v44, 4, v248
v_and_b32 v44, 0x30, v44
v_xor_b32 v44, v44, v248
v_and_b32 v232, 0x380, v248
v_mad_u32_u24 v44, v232, 3, v44
v_xor_b32 v45, 0x1040, v44
v_bfe_u32 v232, v248, 5, 3
v_lshrrev_b32 v234, 8, v248
v_xor_b32 v232, v232, v234
v_bfe_u32 v233, v248, 4, 3
v_lshlrev_b32 v233, 7, v233
v_lshl_or_b32 v232, v232, 4, v233
v_bfe_u32 v233, v248, 7, 1
s_lshl_b32 s49, s34, 10
s_sub_u32 s3, s28, s49
v_lshl_add_u32 v74, v233, 12, v232
v_add_u32 v72, s3, v74
s_sub_u32 s3, s30, s49
v_add_u32 v74, s3, v74
v_xor_b32 v73, 64, v72
v_xor_b32 v75, 64, v74
v_lshl_add_u32 v245, v233, 10, v232
v_add_u32 v245, s31, v245
v_xor_b32 v246, 64, v245
v_add_u32 v247, s31, v248
s_add_u32 s3, s3, 0xa000
s_and_b32 s3, s3, 0x1ffff
v_add_u32 v252, s3, v248
v_add_u32 v251, s49, v252
s_lshl_b32 s49, s34, 11
s_add_u32 s3, s3, s49
s_add_u32 s3, s3, 24576
v_lshl_add_u32 v249, v248, 1, s3
v_lshl_add_u32 v250, v235, 1, s3
v_lshrrev_b32 v232, 4, v235
v_lshlrev_b32 v234, 2, v234
v_sub_u32 v232, v232, v234
v_and_b32 v233, 1, v232
v_lshlrev_b32 v233, 4, v233
v_mov_b32 v234, 0xffff
v_lshlrev_b32 v233, v233, v234
v_lshrrev_b32 v232, 1, v232
v_cmp_eq_u32 vcc, 0, v232
s_nop 1
v_cndmask_b32 v156, 0, v233, vcc
v_cmp_eq_u32 vcc, 1, v232
s_nop 1
v_cndmask_b32 v157, 0, v233, vcc
s_mov_b32 s95, 0xffff0000
s_waitcnt vmcnt(13)
v_mov_b32 v158, s98
v_mov_b32 v159, s99
s_mov_b64 exec, 1
buffer_store_dwordx2 v[158:159], off, s[16:19], s51 sc1
s_mov_b64 exec, -1
s_waitcnt lgkmcnt(0)
s_barrier
ds_read_b128 v[208:211], v72 offset:0
ds_read_b128 v[212:215], v72 offset:8192
ds_read_b128 v[216:219], v74 offset:0
ds_read_b128 v[220:223], v73 offset:0
ds_read_b128 v[224:227], v73 offset:8192
ds_read_b128 v[104:107], v245 offset:0
ds_read_b128 v[108:111], v246 offset:0
ds_read_b128 v[152:155], v245 offset:2048
s_waitcnt vmcnt(13)
v_lshlrev_b32 v79, 16, v79
ds_write_b32 v249, v79 offset:28
ds_read_b32 v253, v250 offset:28
ds_read_b32 v254, v250 offset:540
ds_read_b32 v255, v250 offset:1052
s_waitcnt vmcnt(12)
buffer_load_dwordx4 a[48:51], v240, s[16:19], s33 offen offset:2048 sc1
s_waitcnt vmcnt(12)
buffer_load_dwordx4 a[52:55], v240, s[16:19], s33 offen offset:3072 sc1
s_waitcnt vmcnt(12)
buffer_load_dwordx4 a[56:59], v241, s[16:19], s33 offen offset:2048 sc1
s_waitcnt vmcnt(12)
s_waitcnt lgkmcnt(11)
v_mfma_f32_16x16x32_bf16 v[160:163], a[0:3], v[208:211], 0
ds_read_b128 v[228:231], v75 offset:0
buffer_load_dwordx4 a[60:63], v241, s[16:19], s33 offen offset:3072 sc1
v_mfma_f32_16x16x32_bf16 v[164:167], a[4:7], v[208:211], 0
v_mfma_f32_16x16x32_bf16 v[168:171], a[8:11], v[208:211], 0
v_mfma_f32_16x16x32_bf16 v[172:175], a[12:15], v[208:211], 0
s_waitcnt vmcnt(12)
s_waitcnt lgkmcnt(11)
v_mfma_f32_16x16x32_bf16 v[176:179], a[0:3], v[212:215], 0
ds_read_b128 v[208:211], v72 offset:1024
buffer_load_dwordx4 a[64:67], v240, s[16:19], s35 offen offset:0 sc1
v_mfma_f32_16x16x32_bf16 v[180:183], a[4:7], v[212:215], 0
v_mfma_f32_16x16x32_bf16 v[184:187], a[8:11], v[212:215], 0
v_mfma_f32_16x16x32_bf16 v[188:191], a[12:15], v[212:215], 0
s_waitcnt vmcnt(12)
s_waitcnt lgkmcnt(11)
v_mfma_f32_16x16x32_bf16 v[192:195], a[0:3], v[216:219], 0
ds_read_b128 v[212:215], v72 offset:9216
buffer_load_dwordx4 a[68:71], v240, s[16:19], s35 offen offset:1024 sc1
v_mfma_f32_16x16x32_bf16 v[196:199], a[4:7], v[216:219], 0
v_mfma_f32_16x16x32_bf16 v[200:203], a[8:11], v[216:219], 0
v_mfma_f32_16x16x32_bf16 v[204:207], a[12:15], v[216:219], 0
s_waitcnt vmcnt(12)
buffer_load_dwordx4 a[72:75], v241, s[16:19], s35 offen offset:0 sc1
s_waitcnt vmcnt(12)
s_waitcnt lgkmcnt(11)
v_mfma_f32_16x16x32_bf16 v[160:163], a[16:19], v[220:223], v[160:163]
ds_read_b128 v[216:219], v74 offset:1024
buffer_load_dwordx4 a[76:79], v241, s[16:19], s35 offen offset:1024 sc1
v_mfma_f32_16x16x32_bf16 v[164:167], a[20:23], v[220:223], v[164:167]
v_mfma_f32_16x16x32_bf16 v[168:171], a[24:27], v[220:223], v[168:171]
v_mfma_f32_16x16x32_bf16 v[172:175], a[28:31], v[220:223], v[172:175]
s_waitcnt vmcnt(12)
s_waitcnt lgkmcnt(11)
v_mfma_f32_16x16x32_bf16 v[176:179], a[16:19], v[224:227], v[176:179]
ds_read_b128 v[220:223], v73 offset:1024
buffer_load_dwordx4 a[80:83], v240, s[16:19], s35 offen offset:2048 sc1
v_mfma_f32_16x16x32_bf16 v[180:183], a[20:23], v[224:227], v[180:183]
v_mfma_f32_16x16x32_bf16 v[184:187], a[24:27], v[224:227], v[184:187]
v_mfma_f32_16x16x32_bf16 v[188:191], a[28:31], v[224:227], v[188:191]
s_waitcnt vmcnt(12)
s_waitcnt lgkmcnt(4)
v_mfma_f32_16x16x32_bf16 v[192:195], a[16:19], v[228:231], v[192:195]
ds_read_b128 v[224:227], v73 offset:9216
buffer_load_dwordx4 a[84:87], v240, s[16:19], s35 offen offset:3072 sc1
v_mfma_f32_16x16x32_bf16 v[196:199], a[20:23], v[228:231], v[196:199]
v_mfma_f32_16x16x32_bf16 v[200:203], a[24:27], v[228:231], v[200:203]
v_mfma_f32_16x16x32_bf16 v[204:207], a[28:31], v[228:231], v[204:207]
s_waitcnt vmcnt(12)
buffer_load_dwordx4 a[88:91], v241, s[16:19], s35 offen offset:2048 sc1
s_waitcnt vmcnt(12)
s_waitcnt lgkmcnt(4)
v_mfma_f32_16x16x32_bf16 v[160:163], a[32:35], v[208:211], v[160:163]
ds_read_b128 v[228:231], v75 offset:1024
buffer_load_dwordx4 a[92:95], v241, s[16:19], s35 offen offset:3072 sc1
v_mfma_f32_16x16x32_bf16 v[164:167], a[36:39], v[208:211], v[164:167]
v_mfma_f32_16x16x32_bf16 v[168:171], a[40:43], v[208:211], v[168:171]
v_mfma_f32_16x16x32_bf16 v[172:175], a[44:47], v[208:211], v[172:175]
s_waitcnt lgkmcnt(4)
v_mfma_f32_16x16x32_bf16 v[176:179], a[32:35], v[212:215], v[176:179]
ds_read_b128 v[208:211], v72 offset:2048
v_mfma_f32_16x16x32_bf16 v[180:183], a[36:39], v[212:215], v[180:183]
v_mfma_f32_16x16x32_bf16 v[184:187], a[40:43], v[212:215], v[184:187]
v_mfma_f32_16x16x32_bf16 v[188:191], a[44:47], v[212:215], v[188:191]
s_waitcnt vmcnt(11)
s_waitcnt lgkmcnt(4)
v_mfma_f32_16x16x32_bf16 v[192:195], a[32:35], v[216:219], v[192:195]
ds_read_b128 v[212:215], v72 offset:10240
buffer_load_dwordx4 a[96:99], v240, s[16:19], s36 offen offset:0 sc1
v_mfma_f32_16x16x32_bf16 v[196:199], a[36:39], v[216:219], v[196:199]
v_mfma_f32_16x16x32_bf16 v[200:203], a[40:43], v[216:219], v[200:203]
v_mfma_f32_16x16x32_bf16 v[204:207], a[44:47], v[216:219], v[204:207]
s_waitcnt vmcnt(11)
buffer_load_dwordx4 a[100:103], v240, s[16:19], s36 offen offset:1024 sc1
s_waitcnt vmcnt(11)
buffer_load_dwordx4 a[104:107], v241, s[16:19], s36 offen offset:0 sc1
s_waitcnt vmcnt(11)
s_waitcnt lgkmcnt(4)
v_mfma_f32_16x16x32_bf16 v[160:163], a[48:51], v[220:223], v[160:163]
ds_read_b128 v[216:219], v74 offset:2048
buffer_load_dwordx4 a[108:111], v241, s[16:19], s36 offen offset:1024 sc1
v_mfma_f32_16x16x32_bf16 v[164:167], a[52:55], v[220:223], v[164:167]
v_mfma_f32_16x16x32_bf16 v[168:171], a[56:59], v[220:223], v[168:171]
v_mfma_f32_16x16x32_bf16 v[172:175], a[60:63], v[220:223], v[172:175]
s_waitcnt vmcnt(11)
s_waitcnt lgkmcnt(4)
v_mfma_f32_16x16x32_bf16 v[176:179], a[48:51], v[224:227], v[176:179]
ds_read_b128 v[220:223], v73 offset:2048
buffer_load_dwordx4 a[112:115], v240, s[16:19], s36 offen offset:2048 sc1
v_mfma_f32_16x16x32_bf16 v[180:183], a[52:55], v[224:227], v[180:183]
v_mfma_f32_16x16x32_bf16 v[184:187], a[56:59], v[224:227], v[184:187]
v_mfma_f32_16x16x32_bf16 v[188:191], a[60:63], v[224:227], v[188:191]
s_waitcnt vmcnt(11)
s_waitcnt lgkmcnt(4)
v_mfma_f32_16x16x32_bf16 v[192:195], a[48:51], v[228:231], v[192:195]
ds_read_b128 v[224:227], v73 offset:10240
buffer_load_dwordx4 a[116:119], v240, s[16:19], s36 offen offset:3072 sc1
v_mfma_f32_16x16x32_bf16 v[196:199], a[52:55], v[228:231], v[196:199]
v_mfma_f32_16x16x32_bf16 v[200:203], a[56:59], v[228:231], v[200:203]
v_mfma_f32_16x16x32_bf16 v[204:207], a[60:63], v[228:231], v[204:207]
s_waitcnt vmcnt(11)
buffer_load_dwordx4 a[120:123], v241, s[16:19], s36 offen offset:2048 sc1
s_waitcnt vmcnt(11)
s_waitcnt lgkmcnt(4)
v_mfma_f32_16x16x32_bf16 v[160:163], a[64:67], v[208:211], v[160:163]
ds_read_b128 v[228:231], v75 offset:2048
buffer_load_dwordx4 a[124:127], v241, s[16:19], s36 offen offset:3072 sc1
v_mfma_f32_16x16x32_bf16 v[164:167], a[68:71], v[208:211], v[164:167]
v_mfma_f32_16x16x32_bf16 v[168:171], a[72:75], v[208:211], v[168:171]
v_mfma_f32_16x16x32_bf16 v[172:175], a[76:79], v[208:211], v[172:175]
s_waitcnt vmcnt(11)
s_waitcnt lgkmcnt(4)
v_mfma_f32_16x16x32_bf16 v[176:179], a[64:67], v[212:215], v[176:179]
ds_read_b128 v[208:211], v72 offset:3072
buffer_load_dwordx4 a[128:131], v240, s[16:19], s38 offen offset:0 sc1
v_mfma_f32_16x16x32_bf16 v[180:183], a[68:71], v[212:215], v[180:183]
v_mfma_f32_16x16x32_bf16 v[184:187], a[72:75], v[212:215], v[184:187]
v_mfma_f32_16x16x32_bf16 v[188:191], a[76:79], v[212:215], v[188:191]
s_waitcnt vmcnt(11)
s_waitcnt lgkmcnt(4)
v_mfma_f32_16x16x32_bf16 v[192:195], a[64:67], v[216:219], v[192:195]
ds_read_b128 v[212:215], v72 offset:11264
buffer_load_dwordx4 a[132:135], v240, s[16:19], s38 offen offset:1024 sc1
v_mfma_f32_16x16x32_bf16 v[196:199], a[68:71], v[216:219], v[196:199]
v_mfma_f32_16x16x32_bf16 v[200:203], a[72:75], v[216:219], v[200:203]
v_mfma_f32_16x16x32_bf16 v[204:207], a[76:79], v[216:219], v[204:207]
s_waitcnt vmcnt(11)
buffer_load_dwordx4 a[136:139], v241, s[16:19], s38 offen offset:0 sc1
s_waitcnt vmcnt(11)
s_waitcnt lgkmcnt(4)
v_mfma_f32_16x16x32_bf16 v[160:163], a[80:83], v[220:223], v[160:163]
ds_read_b128 v[216:219], v74 offset:3072
buffer_load_dwordx4 a[140:143], v241, s[16:19], s38 offen offset:1024 sc1
v_mfma_f32_16x16x32_bf16 v[164:167], a[84:87], v[220:223], v[164:167]
v_mfma_f32_16x16x32_bf16 v[168:171], a[88:91], v[220:223], v[168:171]
v_mfma_f32_16x16x32_bf16 v[172:175], a[92:95], v[220:223], v[172:175]
s_waitcnt vmcnt(11)
s_waitcnt lgkmcnt(4)
v_mfma_f32_16x16x32_bf16 v[176:179], a[80:83], v[224:227], v[176:179]
ds_read_b128 v[220:223], v73 offset:3072
buffer_load_dwordx4 a[144:147], v240, s[16:19], s38 offen offset:2048 sc1
v_mfma_f32_16x16x32_bf16 v[180:183], a[84:87], v[224:227], v[180:183]
v_mfma_f32_16x16x32_bf16 v[184:187], a[88:91], v[224:227], v[184:187]
v_mfma_f32_16x16x32_bf16 v[188:191], a[92:95], v[224:227], v[188:191]
s_waitcnt vmcnt(11)
s_waitcnt lgkmcnt(4)
v_mfma_f32_16x16x32_bf16 v[192:195], a[80:83], v[228:231], v[192:195]
ds_read_b128 v[224:227], v73 offset:11264
buffer_load_dwordx4 a[148:151], v240, s[16:19], s38 offen offset:3072 sc1
v_mfma_f32_16x16x32_bf16 v[196:199], a[84:87], v[228:231], v[196:199]
v_mfma_f32_16x16x32_bf16 v[200:203], a[88:91], v[228:231], v[200:203]
v_mfma_f32_16x16x32_bf16 v[204:207], a[92:95], v[228:231], v[204:207]
s_waitcnt vmcnt(11)
buffer_load_dwordx4 a[152:155], v241, s[16:19], s38 offen offset:2048 sc1
s_waitcnt vmcnt(11)
s_waitcnt lgkmcnt(4)
v_mfma_f32_16x16x32_bf16 v[160:163], a[96:99], v[208:211], v[160:163]
ds_read_b128 v[228:231], v75 offset:3072
buffer_load_dwordx4 a[156:159], v241, s[16:19], s38 offen offset:3072 sc1
v_mfma_f32_16x16x32_bf16 v[164:167], a[100:103], v[208:211], v[164:167]
v_mfma_f32_16x16x32_bf16 v[168:171], a[104:107], v[208:211], v[168:171]
v_mfma_f32_16x16x32_bf16 v[172:175], a[108:111], v[208:211], v[172:175]
s_waitcnt vmcnt(11)
s_waitcnt lgkmcnt(4)
v_mfma_f32_16x16x32_bf16 v[176:179], a[96:99], v[212:215], v[176:179]
buffer_load_dwordx4 a[160:163], v240, s[16:19], s39 offen offset:0 sc1
v_mfma_f32_16x16x32_bf16 v[180:183], a[100:103], v[212:215], v[180:183]
v_mfma_f32_16x16x32_bf16 v[184:187], a[104:107], v[212:215], v[184:187]
v_mfma_f32_16x16x32_bf16 v[188:191], a[108:111], v[212:215], v[188:191]
s_waitcnt vmcnt(11)
s_waitcnt lgkmcnt(3)
v_mfma_f32_16x16x32_bf16 v[192:195], a[96:99], v[216:219], v[192:195]
buffer_load_dwordx4 a[164:167], v240, s[16:19], s39 offen offset:1024 sc1
v_mfma_f32_16x16x32_bf16 v[196:199], a[100:103], v[216:219], v[196:199]
v_mfma_f32_16x16x32_bf16 v[200:203], a[104:107], v[216:219], v[200:203]
v_mfma_f32_16x16x32_bf16 v[204:207], a[108:111], v[216:219], v[204:207]
s_waitcnt vmcnt(11)
buffer_load_dwordx4 a[168:171], v241, s[16:19], s39 offen offset:0 sc1
s_waitcnt vmcnt(11)
s_waitcnt lgkmcnt(2)
v_mfma_f32_16x16x32_bf16 v[160:163], a[112:115], v[220:223], v[160:163]
buffer_load_dwordx4 a[172:175], v241, s[16:19], s39 offen offset:1024 sc1
v_mfma_f32_16x16x32_bf16 v[164:167], a[116:119], v[220:223], v[164:167]
v_mfma_f32_16x16x32_bf16 v[168:171], a[120:123], v[220:223], v[168:171]
v_mfma_f32_16x16x32_bf16 v[172:175], a[124:127], v[220:223], v[172:175]
s_waitcnt vmcnt(11)
s_waitcnt lgkmcnt(1)
v_mfma_f32_16x16x32_bf16 v[176:179], a[112:115], v[224:227], v[176:179]
buffer_load_dwordx2 v[242:243], v46, s[16:19], 0 offen offset:0 sc1
v_mfma_f32_16x16x32_bf16 v[180:183], a[116:119], v[224:227], v[180:183]
v_lshlrev_b32 v234, 16, v104
v_and_b32 v235, s95, v104
v_mfma_f32_16x16x32_bf16 v[184:187], a[120:123], v[224:227], v[184:187]
v_fma_f32 v160, v160, v253, v234
v_fma_f32 v161, v161, v253, v235
v_mfma_f32_16x16x32_bf16 v[188:191], a[124:127], v[224:227], v[188:191]
v_lshlrev_b32 v236, 16, v105
v_and_b32 v237, s95, v105
s_waitcnt lgkmcnt(0)
v_mfma_f32_16x16x32_bf16 v[192:195], a[112:115], v[228:231], v[192:195]
v_fma_f32 v162, v162, v253, v236
v_fma_f32 v163, v163, v253, v237
v_mfma_f32_16x16x32_bf16 v[196:199], a[116:119], v[228:231], v[196:199]
v_lshlrev_b32 v238, 16, v106
v_and_b32 v239, s95, v106
v_mfma_f32_16x16x32_bf16 v[200:203], a[120:123], v[228:231], v[200:203]
v_fma_f32 v164, v164, v253, v238
v_fma_f32 v165, v165, v253, v239
v_mfma_f32_16x16x32_bf16 v[204:207], a[124:127], v[228:231], v[204:207]
v_lshlrev_b32 v232, 16, v107
v_and_b32 v233, s95, v107
v_fma_f32 v166, v166, v253, v232
v_fma_f32 v167, v167, v253, v233
ds_read_b128 v[104:107], v246 offset:2048
v_lshlrev_b32 v234, 16, v108
v_and_b32 v235, s95, v108
v_fma_f32 v168, v168, v253, v234
v_fma_f32 v169, v169, v253, v235
v_lshlrev_b32 v236, 16, v109
v_and_b32 v237, s95, v109
v_fma_f32 v170, v170, v253, v236
v_fma_f32 v171, v171, v253, v237
v_lshlrev_b32 v238, 16, v110
v_and_b32 v239, s95, v110
v_fma_f32 v172, v172, v253, v238
v_fma_f32 v173, v173, v253, v239
v_lshlrev_b32 v232, 16, v111
v_and_b32 v233, s95, v111
v_fma_f32 v174, v174, v253, v232
v_fma_f32 v175, v175, v253, v233
ds_read_b128 v[108:111], v245 offset:4096
s_waitcnt vmcnt(11)
buffer_load_dwordx4 a[176:179], v240, s[16:19], s39 offen offset:2048 sc1
v_lshlrev_b32 v234, 16, v152
v_and_b32 v235, s95, v152
v_fma_f32 v176, v176, v254, v234
v_fma_f32 v177, v177, v254, v235
v_lshlrev_b32 v236, 16, v153
v_and_b32 v237, s95, v153
v_fma_f32 v178, v178, v254, v236
v_fma_f32 v179, v179, v254, v237
v_lshlrev_b32 v238, 16, v154
v_and_b32 v239, s95, v154
v_fma_f32 v180, v180, v254, v238
v_fma_f32 v181, v181, v254, v239
v_lshlrev_b32 v232, 16, v155
v_and_b32 v233, s95, v155
v_fma_f32 v182, v182, v254, v232
v_fma_f32 v183, v183, v254, v233
ds_read_b128 v[152:155], v246 offset:4096
s_waitcnt lgkmcnt(2)
v_lshlrev_b32 v234, 16, v104
v_and_b32 v235, s95, v104
v_fma_f32 v184, v184, v254, v234
v_fma_f32 v185, v185, v254, v235
v_lshlrev_b32 v236, 16, v105
v_and_b32 v237, s95, v105
v_fma_f32 v186, v186, v254, v236
v_fma_f32 v187, v187, v254, v237
v_lshlrev_b32 v238, 16, v106
v_and_b32 v239, s95, v106
v_fma_f32 v188, v188, v254, v238
v_fma_f32 v189, v189, v254, v239
v_lshlrev_b32 v232, 16, v107
v_and_b32 v233, s95, v107
v_fma_f32 v190, v190, v254, v232
v_fma_f32 v191, v191, v254, v233
s_waitcnt vmcnt(11)
buffer_load_dwordx4 a[180:183], v240, s[16:19], s39 offen offset:3072 sc1
s_waitcnt lgkmcnt(1)
v_lshlrev_b32 v234, 16, v108
v_and_b32 v235, s95, v108
v_fma_f32 v192, v192, v255, v234
v_fma_f32 v193, v193, v255, v235
v_lshlrev_b32 v236, 16, v109
v_and_b32 v237, s95, v109
v_fma_f32 v194, v194, v255, v236
v_fma_f32 v195, v195, v255, v237
v_lshlrev_b32 v238, 16, v110
v_and_b32 v239, s95, v110
v_fma_f32 v196, v196, v255, v238
v_fma_f32 v197, v197, v255, v239
v_lshlrev_b32 v232, 16, v111
v_and_b32 v233, s95, v111
v_fma_f32 v198, v198, v255, v232
v_fma_f32 v199, v199, v255, v233
s_waitcnt lgkmcnt(0)
v_lshlrev_b32 v234, 16, v152
v_and_b32 v235, s95, v152
v_fma_f32 v200, v200, v255, v234
v_fma_f32 v201, v201, v255, v235
v_lshlrev_b32 v236, 16, v153
v_and_b32 v237, s95, v153
v_fma_f32 v202, v202, v255, v236
v_fma_f32 v203, v203, v255, v237
v_lshlrev_b32 v238, 16, v154
v_and_b32 v239, s95, v154
v_fma_f32 v204, v204, v255, v238
v_fma_f32 v205, v205, v255, v239
v_lshlrev_b32 v232, 16, v155
v_and_b32 v233, s95, v155
v_fma_f32 v206, v206, v255, v232
v_fma_f32 v207, v207, v255, v233
s_waitcnt vmcnt(11)
buffer_load_dwordx4 a[184:187], v241, s[16:19], s39 offen offset:2048 sc1
s_waitcnt vmcnt(11)
buffer_load_dwordx4 a[188:191], v241, s[16:19], s39 offen offset:3072 sc1
s_waitcnt vmcnt(11)
buffer_load_dwordx4 a[192:195], v240, s[16:19], s40 offen offset:0 sc1
s_waitcnt vmcnt(11)
buffer_load_dwordx4 a[196:199], v240, s[16:19], s40 offen offset:1024 sc1
s_waitcnt vmcnt(11)
buffer_load_dwordx4 a[200:203], v241, s[16:19], s40 offen offset:0 sc1
s_waitcnt vmcnt(11)
buffer_load_dwordx4 a[204:207], v241, s[16:19], s40 offen offset:1024 sc1
s_waitcnt vmcnt(11)
buffer_load_dwordx4 a[208:211], v240, s[16:19], s40 offen offset:2048 sc1
s_waitcnt vmcnt(11)
buffer_load_dwordx4 a[212:215], v240, s[16:19], s40 offen offset:3072 sc1
s_waitcnt vmcnt(11)
s_waitcnt vmcnt(10)
v_cmp_ne_u64 vcc, s[98:99], v[242:243]
s_nop 1
s_cbranch_vccnz LF_spinQ
LF_goQ:
buffer_load_dwordx4 v[128:131], v244, s[24:27], 0 offen offset:0 sc1
buffer_load_dwordx4 v[132:135], v244, s[24:27], 0 offen offset:16 sc1
s_waitcnt vmcnt(11)
buffer_load_dwordx4 v[136:139], v244, s[24:27], 0 offen offset:32 sc1
s_waitcnt vmcnt(11)
s_waitcnt vmcnt(10)
s_add_u32 s49, s6, s42
buffer_load_dwordx4 v[48:51], v47, s[16:19], s49 offen sc1
s_add_u32 s3, s6, s43
buffer_load_dwordx4 v[52:55], v47, s[16:19], s3 offen sc1
s_waitcnt vmcnt(11)
buffer_load_dwordx4 a[216:219], v241, s[16:19], s40 offen offset:2048 sc1
s_waitcnt vmcnt(11)
s_waitcnt vmcnt(10)
s_add_u32 s49, s6, s44
buffer_load_dwordx4 v[56:59], v47, s[16:19], s49 offen sc1
s_add_u32 s3, s6, s45
buffer_load_dwordx4 v[60:63], v47, s[16:19], s3 offen sc1
s_waitcnt vmcnt(11)
buffer_load_dwordx4 a[220:223], v241, s[16:19], s40 offen offset:3072 sc1
s_waitcnt vmcnt(11)
s_add_u32 s49, s6, s46
buffer_load_dwordx4 v[64:67], v47, s[16:19], s49 offen sc1
ds_read_b128 v[68:71], v76 offset:0
s_waitcnt vmcnt(11)
buffer_load_dwordx4 a[224:227], v240, s[16:19], s41 offen offset:0 sc1
s_waitcnt vmcnt(11)
s_waitcnt vmcnt(10)
s_add_u32 s49, s6, s42
buffer_load_dwordx4 v[80:83], v43, s[16:19], s49 offen sc1
s_add_u32 s3, s6, s43
buffer_load_dwordx4 v[84:87], v43, s[16:19], s3 offen sc1
s_waitcnt vmcnt(11)
buffer_load_dwordx4 a[228:231], v240, s[16:19], s41 offen offset:1024 sc1
s_waitcnt vmcnt(11)
v_max3_f32 v232, v128, v130, v132
v_max3_f32 v233, v134, v136, v138
v_max_f32 v232, v232, v233
v_subrev_f32 v232, 0x42fe0000, v232
v_sub_f32 v128, v128, v232
v_sub_f32 v130, v130, v232
v_sub_f32 v132, v132, v232
v_sub_f32 v134, v134, v232
v_sub_f32 v136, v136, v232
v_sub_f32 v138, v138, v232
v_cvt_u32_f32 v128, v128
v_cvt_u32_f32 v130, v130
v_cvt_u32_f32 v132, v132
v_cvt_u32_f32 v134, v134
v_cvt_u32_f32 v136, v136
v_cvt_u32_f32 v138, v138
v_lshlrev_b32 v234, 23, v128
v_lshlrev_b32 v235, 23, v130
v_lshlrev_b32 v236, 23, v132
v_lshlrev_b32 v237, 23, v134
v_lshlrev_b32 v238, 23, v136
v_lshlrev_b32 v239, 23, v138
v_mul_f32 v232, v234, v129
v_fmac_f32 v232, v235, v131
v_fmac_f32 v232, v236, v133
v_fmac_f32 v232, v237, v135
v_fmac_f32 v232, v238, v137
v_fmac_f32 v232, v239, v139
v_rcp_f32 v150, v232
v_mul_u32_u24 v144, 0x800080, v128
v_mul_u32_u24 v145, 0x800080, v130
v_mul_u32_u24 v146, 0x800080, v132
v_mul_u32_u24 v147, 0x800080, v134
v_mul_u32_u24 v148, 0x800080, v136
v_mul_u32_u24 v149, 0x800080, v138
ds_write_b128 v249, v[144:147]
ds_write_b96 v249, v[148:150] offset:16
ds_read_b128 v[144:147], v250 offset:0
ds_read_b128 v[148:151], v250 offset:16
ds_read_b128 v[128:131], v250 offset:512
ds_read_b128 v[132:135], v250 offset:528
ds_read_b128 v[136:139], v250 offset:1024
ds_read_b128 v[140:143], v250 offset:1040
s_waitcnt lgkmcnt(4)
v_and_b32 v0, v144, v156
v_and_b32 v1, v144, v157
v_and_b32 v2, v145, v156
v_and_b32 v3, v145, v157
v_and_b32 v4, v146, v156
v_and_b32 v5, v146, v157
v_and_b32 v6, v147, v156
v_and_b32 v7, v147, v157
v_and_b32 v8, v148, v156
v_and_b32 v9, v148, v157
v_and_b32 v10, v149, v156
v_and_b32 v11, v149, v157
v_mov_b32 v40, v150
s_waitcnt lgkmcnt(2)
v_and_b32 v12, v128, v156
v_and_b32 v13, v128, v157
v_and_b32 v14, v129, v156
v_and_b32 v15, v129, v157
v_and_b32 v16, v130, v156
v_and_b32 v17, v130, v157
v_and_b32 v18, v131, v156
v_and_b32 v19, v131, v157
v_and_b32 v20, v132, v156
v_and_b32 v21, v132, v157
v_and_b32 v22, v133, v156
v_and_b32 v23, v133, v157
v_mov_b32 v41, v134
s_waitcnt lgkmcnt(0)
v_and_b32 v24, v136, v156
v_and_b32 v25, v136, v157
v_and_b32 v26, v137, v156
v_and_b32 v27, v137, v157
v_and_b32 v28, v138, v156
v_and_b32 v29, v138, v157
v_and_b32 v30, v139, v156
v_and_b32 v31, v139, v157
v_and_b32 v32, v140, v156
v_and_b32 v33, v140, v157
v_and_b32 v34, v141, v156
v_and_b32 v35, v141, v157
v_mov_b32 v42, v142
s_waitcnt vmcnt(9)
v_swap_b32 v50, v52
v_swap_b32 v51, v53
s_nop 1
v_mfma_f32_16x16x32_bf16 v[136:139], v[48:51], v[0:3], 0
s_add_u32 s49, s6, s44
buffer_load_dwordx4 v[88:91], v43, s[16:19], s49 offen sc1
v_mfma_f32_16x16x32_bf16 v[140:143], v[52:55], v[0:3], 0
s_add_u32 s3, s6, s45
buffer_load_dwordx4 v[92:95], v43, s[16:19], s3 offen sc1
buffer_load_dwordx4 a[232:235], v241, s[16:19], s41 offen offset:0 sc1
s_waitcnt vmcnt(11)
s_add_u32 s49, s6, s46
buffer_load_dwordx4 v[96:99], v43, s[16:19], s49 offen sc1
ds_read_b128 v[100:103], v76 offset:4096
s_waitcnt vmcnt(10)
v_swap_b32 v58, v60
v_swap_b32 v59, v61
s_nop 1
v_mfma_f32_16x16x32_bf16 v[136:139], v[56:59], v[4:7], v[136:139]
buffer_load_dwordx4 a[236:239], v241, s[16:19], s41 offen offset:1024 sc1
v_mfma_f32_16x16x32_bf16 v[140:143], v[60:63], v[4:7], v[140:143]
s_waitcnt vmcnt(10)
s_add_u32 s49, s7, s42
buffer_load_dwordx4 v[112:115], v47, s[16:19], s49 offen sc1
s_add_u32 s3, s7, s43
buffer_load_dwordx4 v[116:119], v47, s[16:19], s3 offen sc1
s_waitcnt vmcnt(11)
v_swap_b32 v66, v68
v_swap_b32 v67, v69
s_nop 1
v_mfma_f32_16x16x32_bf16 v[136:139], v[64:67], v[8:11], v[136:139]
buffer_load_dwordx4 a[240:243], v240, s[16:19], s41 offen offset:2048 sc1
v_mfma_f32_16x16x32_bf16 v[140:143], v[68:71], v[8:11], v[140:143]
s_waitcnt vmcnt(11)
s_nop 4
v_mul_f32 v136, v136, v40
v_mul_f32 v137, v137, v40
v_mul_f32 v138, v138, v40
v_mul_f32 v139, v139, v40
v_mul_f32 v140, v140, v40
v_mul_f32 v141, v141, v40
v_mul_f32 v142, v142, v40
v_mul_f32 v143, v143, v40
v_cvt_pk_bf16_f32 v136, v136, v137
v_cvt_pk_bf16_f32 v137, v138, v139
v_cvt_pk_bf16_f32 v138, v140, v141
v_cvt_pk_bf16_f32 v139, v142, v143
ds_write_b128 v251, v[136:139] offset:0
s_waitcnt vmcnt(9)
v_swap_b32 v82, v84
v_swap_b32 v83, v85
s_nop 1
v_mfma_f32_16x16x32_bf16 v[128:131], v[80:83], v[0:3], 0
s_add_u32 s49, s7, s44
buffer_load_dwordx4 v[120:123], v47, s[16:19], s49 offen sc1
v_mfma_f32_16x16x32_bf16 v[132:135], v[84:87], v[0:3], 0
s_add_u32 s3, s7, s45
buffer_load_dwordx4 v[124:127], v47, s[16:19], s3 offen sc1
buffer_load_dwordx4 a[244:247], v240, s[16:19], s41 offen offset:3072 sc1
s_waitcnt vmcnt(11)
s_add_u32 s49, s7, s46
buffer_load_dwordx4 v[48:51], v47, s[16:19], s49 offen sc1
ds_read_b128 v[52:55], v77 offset:0
s_waitcnt vmcnt(10)
v_swap_b32 v90, v92
v_swap_b32 v91, v93
s_nop 1
v_mfma_f32_16x16x32_bf16 v[128:131], v[88:91], v[4:7], v[128:131]
buffer_load_dwordx4 a[248:251], v241, s[16:19], s41 offen offset:2048 sc1
v_mfma_f32_16x16x32_bf16 v[132:135], v[92:95], v[4:7], v[132:135]
s_waitcnt vmcnt(10)
s_add_u32 s49, s7, s42
buffer_load_dwordx4 v[56:59], v43, s[16:19], s49 offen sc1
s_add_u32 s3, s7, s43
buffer_load_dwordx4 v[60:63], v43, s[16:19], s3 offen sc1
s_waitcnt vmcnt(11)
s_waitcnt lgkmcnt(2)
v_swap_b32 v98, v100
v_swap_b32 v99, v101
s_nop 1
v_mfma_f32_16x16x32_bf16 v[128:131], v[96:99], v[8:11], v[128:131]
buffer_load_dwordx4 a[252:255], v241, s[16:19], s41 offen offset:3072 sc1
v_mfma_f32_16x16x32_bf16 v[132:135], v[100:103], v[8:11], v[132:135]
s_waitcnt vmcnt(11)
s_nop 4
v_mul_f32 v128, v128, v40
v_mul_f32 v129, v129, v40
v_mul_f32 v130, v130, v40
v_mul_f32 v131, v131, v40
v_mul_f32 v132, v132, v40
v_mul_f32 v133, v133, v40
v_mul_f32 v134, v134, v40
v_mul_f32 v135, v135, v40
v_cvt_pk_bf16_f32 v128, v128, v129
v_cvt_pk_bf16_f32 v129, v130, v131
v_cvt_pk_bf16_f32 v130, v132, v133
v_cvt_pk_bf16_f32 v131, v134, v135
ds_write_b128 v251, v[128:131] offset:4096
s_waitcnt lgkmcnt(0)
s_barrier
ds_read_b128 v[208:211], v252 offset:0
ds_read_b128 v[212:215], v252 offset:1024
ds_read_b128 v[216:219], v252 offset:2048
ds_read_b128 v[220:223], v252 offset:3072
ds_read_b128 v[224:227], v252 offset:4096
s_waitcnt vmcnt(9)
s_waitcnt lgkmcnt(4)
v_mfma_f32_16x16x32_bf16 v[160:163], a[128:131], v[208:211], v[160:163]
ds_read_b128 v[228:231], v252 offset:5120
v_swap_b32 v114, v116
v_mfma_f32_16x16x32_bf16 v[164:167], a[132:135], v[208:211], v[164:167]
v_swap_b32 v115, v117
s_nop 1
v_mfma_f32_16x16x32_bf16 v[136:139], v[112:115], v[12:15], 0
s_add_u32 s49, s7, s44
buffer_load_dwordx4 v[64:67], v43, s[16:19], s49 offen sc1
v_mfma_f32_16x16x32_bf16 v[140:143], v[116:119], v[12:15], 0
s_add_u32 s3, s7, s45
buffer_load_dwordx4 v[68:71], v43, s[16:19], s3 offen sc1
v_mfma_f32_16x16x32_bf16 v[168:171], a[136:139], v[208:211], v[168:171]
s_add_u32 s49, s7, s46
buffer_load_dwordx4 v[80:83], v43, s[16:19], s49 offen sc1
v_mfma_f32_16x16x32_bf16 v[172:175], a[140:143], v[208:211], v[172:175]
ds_read_b128 v[84:87], v77 offset:4096
s_waitcnt lgkmcnt(5)
v_mfma_f32_16x16x32_bf16 v[160:163], a[144:147], v[212:215], v[160:163]
ds_read_b128 v[208:211], v252 offset:6144
v_mfma_f32_16x16x32_bf16 v[164:167], a[148:151], v[212:215], v[164:167]
v_mfma_f32_16x16x32_bf16 v[168:171], a[152:155], v[212:215], v[168:171]
v_mfma_f32_16x16x32_bf16 v[172:175], a[156:159], v[212:215], v[172:175]
s_waitcnt vmcnt(11)
s_waitcnt lgkmcnt(5)
v_mfma_f32_16x16x32_bf16 v[160:163], a[160:163], v[216:219], v[160:163]
ds_read_b128 v[212:215], v252 offset:7168
v_mfma_f32_16x16x32_bf16 v[164:167], a[164:167], v[216:219], v[164:167]
v_mfma_f32_16x16x32_bf16 v[168:171], a[168:171], v[216:219], v[168:171]
v_mfma_f32_16x16x32_bf16 v[172:175], a[172:175], v[216:219], v[172:175]
s_waitcnt vmcnt(9)
s_waitcnt lgkmcnt(5)
v_mfma_f32_16x16x32_bf16 v[160:163], a[176:179], v[220:223], v[160:163]
v_swap_b32 v122, v124
v_mfma_f32_16x16x32_bf16 v[164:167], a[180:183], v[220:223], v[164:167]
v_swap_b32 v123, v125
s_nop 1
v_mfma_f32_16x16x32_bf16 v[136:139], v[120:123], v[16:19], v[136:139]
s_add_u32 s49, s29, s42
buffer_load_dwordx4 v[88:91], v47, s[16:19], s49 offen sc1
v_mfma_f32_16x16x32_bf16 v[140:143], v[124:127], v[16:19], v[140:143]
s_add_u32 s3, s29, s43
buffer_load_dwordx4 v[92:95], v47, s[16:19], s3 offen sc1
v_mfma_f32_16x16x32_bf16 v[168:171], a[184:187], v[220:223], v[168:171]
v_mfma_f32_16x16x32_bf16 v[172:175], a[188:191], v[220:223], v[172:175]
s_waitcnt lgkmcnt(4)
v_mfma_f32_16x16x32_bf16 v[160:163], a[192:195], v[224:227], v[160:163]
v_mfma_f32_16x16x32_bf16 v[164:167], a[196:199], v[224:227], v[164:167]
v_mfma_f32_16x16x32_bf16 v[168:171], a[200:203], v[224:227], v[168:171]
v_mfma_f32_16x16x32_bf16 v[172:175], a[204:207], v[224:227], v[172:175]
s_waitcnt vmcnt(10)
s_waitcnt lgkmcnt(3)
v_mfma_f32_16x16x32_bf16 v[160:163], a[208:211], v[228:231], v[160:163]
s_add_u32 s49, s29, s44
buffer_load_dwordx4 v[96:99], v47, s[16:19], s49 offen sc1
v_mfma_f32_16x16x32_bf16 v[164:167], a[212:215], v[228:231], v[164:167]
s_add_u32 s3, s29, s45
buffer_load_dwordx4 v[100:103], v47, s[16:19], s3 offen sc1
v_mfma_f32_16x16x32_bf16 v[168:171], a[216:219], v[228:231], v[168:171]
v_mfma_f32_16x16x32_bf16 v[172:175], a[220:223], v[228:231], v[172:175]
s_waitcnt vmcnt(11)
s_waitcnt lgkmcnt(1)
v_mfma_f32_16x16x32_bf16 v[160:163], a[224:227], v[208:211], v[160:163]
v_swap_b32 v50, v52
v_mfma_f32_16x16x32_bf16 v[164:167], a[228:231], v[208:211], v[164:167]
v_swap_b32 v51, v53
s_nop 1
v_mfma_f32_16x16x32_bf16 v[136:139], v[48:51], v[20:23], v[136:139]
v_mfma_f32_16x16x32_bf16 v[140:143], v[52:55], v[20:23], v[140:143]
v_mfma_f32_16x16x32_bf16 v[168:171], a[232:235], v[208:211], v[168:171]
v_mfma_f32_16x16x32_bf16 v[172:175], a[236:239], v[208:211], v[172:175]
s_waitcnt vmcnt(10)
s_add_u32 s49, s29, s46
buffer_load_dwordx4 v[112:115], v47, s[16:19], s49 offen sc1
s_add_u32 s3, s29, s47
s_cmp_lt_u32 s37, 4
s_cbranch_scc1 LF_o0
buffer_load_dwordx4 v[116:119], v47, s[16:19], s3 offen sc1
ds_read_b128 v[36:39], v78 offset:0
s_branch LF_j0
LF_o0:
s_mov_b32 s3, 0x70000000
buffer_load_dwordx4 v[36:39], v47, s[16:19], s3 offen sc1
ds_read_b128 v[116:119], v78 offset:0
LF_j0:
v_mul_f32 v136, v136, v41
v_mul_f32 v137, v137, v41
v_mul_f32 v138, v138, v41
v_mul_f32 v139, v139, v41
v_mul_f32 v140, v140, v41
v_mul_f32 v141, v141, v41
v_mul_f32 v142, v142, v41
v_mul_f32 v143, v143, v41
v_cvt_pk_bf16_f32 v136, v136, v137
v_cvt_pk_bf16_f32 v137, v138, v139
v_cvt_pk_bf16_f32 v138, v140, v141
v_cvt_pk_bf16_f32 v139, v142, v143
ds_write_b128 v251, v[136:139] offset:8192
s_waitcnt vmcnt(10)
v_swap_b32 v58, v60
v_swap_b32 v59, v61
s_nop 1
v_mfma_f32_16x16x32_bf16 v[128:131], v[56:59], v[12:15], 0
s_add_u32 s49, s29, s42
buffer_load_dwordx4 v[120:123], v43, s[16:19], s49 offen sc1
v_mfma_f32_16x16x32_bf16 v[132:135], v[60:63], v[12:15], 0
s_add_u32 s3, s29, s43
buffer_load_dwordx4 v[124:127], v43, s[16:19], s3 offen sc1
s_waitcnt vmcnt(11)
s_waitcnt lgkmcnt(2)
v_mfma_f32_16x16x32_bf16 v[160:163], a[240:243], v[212:215], v[160:163]
v_mfma_f32_16x16x32_bf16 v[164:167], a[244:247], v[212:215], v[164:167]
v_mfma_f32_16x16x32_bf16 v[168:171], a[248:251], v[212:215], v[168:171]
v_mfma_f32_16x16x32_bf16 v[172:175], a[252:255], v[212:215], v[172:175]
s_waitcnt vmcnt(9)
v_swap_b32 v66, v68
v_swap_b32 v67, v69
s_nop 1
v_mfma_f32_16x16x32_bf16 v[128:131], v[64:67], v[16:19], v[128:131]
s_add_u32 s49, s29, s44
buffer_load_dwordx4 v[48:51], v43, s[16:19], s49 offen sc1
v_mfma_f32_16x16x32_bf16 v[132:135], v[68:71], v[16:19], v[132:135]
s_add_u32 s3, s29, s45
buffer_load_dwordx4 v[52:55], v43, s[16:19], s3 offen sc1
v_cvt_pk_bf16_f32 v160, v160, v161
v_cvt_pk_bf16_f32 v161, v162, v163
v_cvt_pk_bf16_f32 v162, v164, v165
v_cvt_pk_bf16_f32 v163, v166, v167
ds_write_b128 v245, v[160:163] offset:0
v_cvt_pk_bf16_f32 v168, v168, v169
v_cvt_pk_bf16_f32 v169, v170, v171
v_cvt_pk_bf16_f32 v170, v172, v173
v_cvt_pk_bf16_f32 v171, v174, v175
ds_write_b128 v246, v[168:171] offset:0
ds_read_b128 v[164:167], v247 offset:0
ds_read_b128 v[172:175], v247 offset:1024
s_waitcnt vmcnt(10)
v_swap_b32 v82, v84
v_swap_b32 v83, v85
s_nop 1
v_mfma_f32_16x16x32_bf16 v[128:131], v[80:83], v[20:23], v[128:131]
s_add_u32 s49, s29, s46
buffer_load_dwordx4 v[56:59], v43, s[16:19], s49 offen sc1
v_mfma_f32_16x16x32_bf16 v[132:135], v[84:87], v[20:23], v[132:135]
s_add_u32 s3, s29, s47
s_cmp_lt_u32 s37, 4
s_cbranch_scc1 LF_o1
buffer_load_dwordx4 v[60:63], v43, s[16:19], s3 offen sc1
ds_read_b128 v[36:39], v78 offset:4096
s_branch LF_j1
LF_o1:
s_mov_b32 s3, 0x70000000
buffer_load_dwordx4 v[36:39], v43, s[16:19], s3 offen sc1
ds_read_b128 v[60:63], v78 offset:4096
LF_j1:
s_waitcnt lgkmcnt(2)
buffer_store_dwordx4 v[164:167], v44, s[56:59], s6 offen sc1
s_waitcnt lgkmcnt(1)
buffer_store_dwordx4 v[172:175], v45, s[56:59], s6 offen sc1
v_mul_f32 v128, v128, v41
v_mul_f32 v129, v129, v41
v_mul_f32 v130, v130, v41
v_mul_f32 v131, v131, v41
v_mul_f32 v132, v132, v41
v_mul_f32 v133, v133, v41
v_mul_f32 v134, v134, v41
v_mul_f32 v135, v135, v41
v_cvt_pk_bf16_f32 v128, v128, v129
v_cvt_pk_bf16_f32 v129, v130, v131
v_cvt_pk_bf16_f32 v130, v132, v133
v_cvt_pk_bf16_f32 v131, v134, v135
ds_write_b128 v251, v[128:131] offset:12288
s_waitcnt lgkmcnt(0)
s_barrier
ds_read_b128 v[216:219], v252 offset:8192
ds_read_b128 v[220:223], v252 offset:9216
ds_read_b128 v[224:227], v252 offset:10240
ds_read_b128 v[228:231], v252 offset:11264
ds_read_b128 v[208:211], v252 offset:12288
s_waitcnt vmcnt(12)
s_waitcnt lgkmcnt(4)
v_mfma_f32_16x16x32_bf16 v[176:179], a[128:131], v[216:219], v[176:179]
ds_read_b128 v[212:215], v252 offset:13312
v_swap_b32 v90, v92
v_mfma_f32_16x16x32_bf16 v[180:183], a[132:135], v[216:219], v[180:183]
v_swap_b32 v91, v93
s_nop 1
v_mfma_f32_16x16x32_bf16 v[136:139], v[88:91], v[24:27], 0
v_mfma_f32_16x16x32_bf16 v[140:143], v[92:95], v[24:27], 0
v_mfma_f32_16x16x32_bf16 v[184:187], a[136:139], v[216:219], v[184:187]
v_mfma_f32_16x16x32_bf16 v[188:191], a[140:143], v[216:219], v[188:191]
s_waitcnt lgkmcnt(4)
v_mfma_f32_16x16x32_bf16 v[176:179], a[144:147], v[220:223], v[176:179]
ds_read_b128 v[216:219], v252 offset:14336
v_mfma_f32_16x16x32_bf16 v[180:183], a[148:151], v[220:223], v[180:183]
v_mfma_f32_16x16x32_bf16 v[184:187], a[152:155], v[220:223], v[184:187]
v_mfma_f32_16x16x32_bf16 v[188:191], a[156:159], v[220:223], v[188:191]
s_waitcnt vmcnt(10)
s_waitcnt lgkmcnt(4)
v_mfma_f32_16x16x32_bf16 v[176:179], a[160:163], v[224:227], v[176:179]
v_swap_b32 v98, v100
v_mfma_f32_16x16x32_bf16 v[180:183], a[164:167], v[224:227], v[180:183]
v_swap_b32 v99, v101
s_nop 1
v_mfma_f32_16x16x32_bf16 v[136:139], v[96:99], v[28:31], v[136:139]
v_mfma_f32_16x16x32_bf16 v[140:143], v[100:103], v[28:31], v[140:143]
v_mfma_f32_16x16x32_bf16 v[184:187], a[168:171], v[224:227], v[184:187]
v_mfma_f32_16x16x32_bf16 v[188:191], a[172:175], v[224:227], v[188:191]
s_waitcnt lgkmcnt(3)
v_mfma_f32_16x16x32_bf16 v[176:179], a[176:179], v[228:231], v[176:179]
v_mfma_f32_16x16x32_bf16 v[180:183], a[180:183], v[228:231], v[180:183]
v_mfma_f32_16x16x32_bf16 v[184:187], a[184:187], v[228:231], v[184:187]
v_mfma_f32_16x16x32_bf16 v[188:191], a[188:191], v[228:231], v[188:191]
s_waitcnt vmcnt(8)
s_waitcnt lgkmcnt(2)
v_mfma_f32_16x16x32_bf16 v[176:179], a[192:195], v[208:211], v[176:179]
v_swap_b32 v114, v116
v_mfma_f32_16x16x32_bf16 v[180:183], a[196:199], v[208:211], v[180:183]
v_swap_b32 v115, v117
s_nop 1
v_mfma_f32_16x16x32_bf16 v[136:139], v[112:115], v[32:35], v[136:139]
v_mfma_f32_16x16x32_bf16 v[140:143], v[116:119], v[32:35], v[140:143]
v_mfma_f32_16x16x32_bf16 v[184:187], a[200:203], v[208:211], v[184:187]
v_mfma_f32_16x16x32_bf16 v[188:191], a[204:207], v[208:211], v[188:191]
s_waitcnt lgkmcnt(1)
v_mfma_f32_16x16x32_bf16 v[176:179], a[208:211], v[212:215], v[176:179]
v_mfma_f32_16x16x32_bf16 v[180:183], a[212:215], v[212:215], v[180:183]
v_mfma_f32_16x16x32_bf16 v[184:187], a[216:219], v[212:215], v[184:187]
v_mfma_f32_16x16x32_bf16 v[188:191], a[220:223], v[212:215], v[188:191]
s_waitcnt lgkmcnt(0)
v_mfma_f32_16x16x32_bf16 v[176:179], a[224:227], v[216:219], v[176:179]
v_mul_f32 v136, v136, v42
v_mul_f32 v137, v137, v42
v_mfma_f32_16x16x32_bf16 v[180:183], a[228:231], v[216:219], v[180:183]
v_mul_f32 v138, v138, v42
v_mul_f32 v139, v139, v42
v_mfma_f32_16x16x32_bf16 v[184:187], a[232:235], v[216:219], v[184:187]
v_mul_f32 v140, v140, v42
v_mul_f32 v141, v141, v42
v_mfma_f32_16x16x32_bf16 v[188:191], a[236:239], v[216:219], v[188:191]
v_mul_f32 v142, v142, v42
v_mul_f32 v143, v143, v42
v_cvt_pk_bf16_f32 v136, v136, v137
v_cvt_pk_bf16_f32 v137, v138, v139
v_cvt_pk_bf16_f32 v138, v140, v141
v_cvt_pk_bf16_f32 v139, v142, v143
ds_write_b128 v251, v[136:139] offset:16384
s_waitcnt lgkmcnt(0)
s_barrier
ds_read_b128 v[220:223], v252 offset:15360
ds_read_b128 v[224:227], v252 offset:16384
ds_read_b128 v[228:231], v252 offset:17408
ds_read_b128 v[208:211], v252 offset:18432
ds_read_b128 v[212:215], v252 offset:19456
s_waitcnt vmcnt(6)
s_waitcnt lgkmcnt(4)
v_mfma_f32_16x16x32_bf16 v[176:179], a[240:243], v[220:223], v[176:179]
v_swap_b32 v122, v124
v_mfma_f32_16x16x32_bf16 v[180:183], a[244:247], v[220:223], v[180:183]
v_swap_b32 v123, v125
s_nop 1
v_mfma_f32_16x16x32_bf16 v[128:131], v[120:123], v[24:27], 0
v_mfma_f32_16x16x32_bf16 v[132:135], v[124:127], v[24:27], 0
v_mfma_f32_16x16x32_bf16 v[184:187], a[248:251], v[220:223], v[184:187]
v_mfma_f32_16x16x32_bf16 v[188:191], a[252:255], v[220:223], v[188:191]
s_waitcnt lgkmcnt(3)
v_mfma_f32_16x16x32_bf16 v[192:195], a[128:131], v[224:227], v[192:195]
v_mfma_f32_16x16x32_bf16 v[196:199], a[132:135], v[224:227], v[196:199]
v_mfma_f32_16x16x32_bf16 v[200:203], a[136:139], v[224:227], v[200:203]
v_mfma_f32_16x16x32_bf16 v[204:207], a[140:143], v[224:227], v[204:207]
s_waitcnt vmcnt(4)
s_waitcnt lgkmcnt(2)
v_mfma_f32_16x16x32_bf16 v[192:195], a[144:147], v[228:231], v[192:195]
v_swap_b32 v50, v52
v_mfma_f32_16x16x32_bf16 v[196:199], a[148:151], v[228:231], v[196:199]
v_swap_b32 v51, v53
s_nop 1
v_mfma_f32_16x16x32_bf16 v[128:131], v[48:51], v[28:31], v[128:131]
v_cvt_pk_bf16_f32 v176, v176, v177
v_cvt_pk_bf16_f32 v177, v178, v179
v_mfma_f32_16x16x32_bf16 v[132:135], v[52:55], v[28:31], v[132:135]
v_cvt_pk_bf16_f32 v178, v180, v181
v_cvt_pk_bf16_f32 v179, v182, v183
v_mfma_f32_16x16x32_bf16 v[200:203], a[152:155], v[228:231], v[200:203]
ds_write_b128 v245, v[176:179] offset:2048
v_cvt_pk_bf16_f32 v184, v184, v185
v_mfma_f32_16x16x32_bf16 v[204:207], a[156:159], v[228:231], v[204:207]
v_cvt_pk_bf16_f32 v185, v186, v187
v_cvt_pk_bf16_f32 v186, v188, v189
s_waitcnt lgkmcnt(2)
v_mfma_f32_16x16x32_bf16 v[192:195], a[160:163], v[208:211], v[192:195]
v_cvt_pk_bf16_f32 v187, v190, v191
ds_write_b128 v246, v[184:187] offset:2048
v_mfma_f32_16x16x32_bf16 v[196:199], a[164:167], v[208:211], v[196:199]
ds_read_b128 v[180:183], v247 offset:2048
ds_read_b128 v[188:191], v247 offset:3072
v_mfma_f32_16x16x32_bf16 v[200:203], a[168:171], v[208:211], v[200:203]
v_mfma_f32_16x16x32_bf16 v[204:207], a[172:175], v[208:211], v[204:207]
s_waitcnt vmcnt(2)
s_waitcnt lgkmcnt(4)
v_mfma_f32_16x16x32_bf16 v[192:195], a[176:179], v[212:215], v[192:195]
v_swap_b32 v58, v60
v_mfma_f32_16x16x32_bf16 v[196:199], a[180:183], v[212:215], v[196:199]
v_swap_b32 v59, v61
s_nop 1
v_mfma_f32_16x16x32_bf16 v[128:131], v[56:59], v[32:35], v[128:131]
s_waitcnt lgkmcnt(1)
buffer_store_dwordx4 v[180:183], v44, s[56:59], s7 offen sc1
v_mfma_f32_16x16x32_bf16 v[132:135], v[60:63], v[32:35], v[132:135]
s_waitcnt lgkmcnt(0)
buffer_store_dwordx4 v[188:191], v45, s[56:59], s7 offen sc1
v_mfma_f32_16x16x32_bf16 v[200:203], a[184:187], v[212:215], v[200:203]
v_mfma_f32_16x16x32_bf16 v[204:207], a[188:191], v[212:215], v[204:207]
s_nop 0
v_mul_f32 v128, v128, v42
v_mul_f32 v129, v129, v42
v_mul_f32 v130, v130, v42
v_mul_f32 v131, v131, v42
v_mul_f32 v132, v132, v42
v_mul_f32 v133, v133, v42
v_mul_f32 v134, v134, v42
v_mul_f32 v135, v135, v42
v_cvt_pk_bf16_f32 v128, v128, v129
v_cvt_pk_bf16_f32 v129, v130, v131
v_cvt_pk_bf16_f32 v130, v132, v133
v_cvt_pk_bf16_f32 v131, v134, v135
ds_write_b128 v251, v[128:131] offset:20480
s_waitcnt lgkmcnt(0)
s_barrier
ds_read_b128 v[216:219], v252 offset:20480
ds_read_b128 v[220:223], v252 offset:21504
ds_read_b128 v[224:227], v252 offset:22528
ds_read_b128 v[228:231], v252 offset:23552
s_waitcnt lgkmcnt(3)
v_mfma_f32_16x16x32_bf16 v[192:195], a[192:195], v[216:219], v[192:195]
v_mfma_f32_16x16x32_bf16 v[196:199], a[196:199], v[216:219], v[196:199]
v_mfma_f32_16x16x32_bf16 v[200:203], a[200:203], v[216:219], v[200:203]
v_mfma_f32_16x16x32_bf16 v[204:207], a[204:207], v[216:219], v[204:207]
s_waitcnt lgkmcnt(2)
v_mfma_f32_16x16x32_bf16 v[192:195], a[208:211], v[220:223], v[192:195]
v_mfma_f32_16x16x32_bf16 v[196:199], a[212:215], v[220:223], v[196:199]
v_mfma_f32_16x16x32_bf16 v[200:203], a[216:219], v[220:223], v[200:203]
v_mfma_f32_16x16x32_bf16 v[204:207], a[220:223], v[220:223], v[204:207]
s_waitcnt lgkmcnt(1)
v_mfma_f32_16x16x32_bf16 v[192:195], a[224:227], v[224:227], v[192:195]
v_mfma_f32_16x16x32_bf16 v[196:199], a[228:231], v[224:227], v[196:199]
v_mfma_f32_16x16x32_bf16 v[200:203], a[232:235], v[224:227], v[200:203]
v_mfma_f32_16x16x32_bf16 v[204:207], a[236:239], v[224:227], v[204:207]
s_waitcnt lgkmcnt(0)
v_mfma_f32_16x16x32_bf16 v[192:195], a[240:243], v[228:231], v[192:195]
v_mfma_f32_16x16x32_bf16 v[196:199], a[244:247], v[228:231], v[196:199]
v_mfma_f32_16x16x32_bf16 v[200:203], a[248:251], v[228:231], v[200:203]
v_mfma_f32_16x16x32_bf16 v[204:207], a[252:255], v[228:231], v[204:207]
s_nop 4
v_cvt_pk_bf16_f32 v192, v192, v193
v_cvt_pk_bf16_f32 v193, v194, v195
v_cvt_pk_bf16_f32 v194, v196, v197
v_cvt_pk_bf16_f32 v195, v198, v199
ds_write_b128 v245, v[192:195] offset:4096
v_cvt_pk_bf16_f32 v200, v200, v201
v_cvt_pk_bf16_f32 v201, v202, v203
v_cvt_pk_bf16_f32 v202, v204, v205
v_cvt_pk_bf16_f32 v203, v206, v207
ds_write_b128 v246, v[200:203] offset:4096
ds_read_b128 v[196:199], v247 offset:4096
ds_read_b128 v[204:207], v247 offset:5120
s_waitcnt lgkmcnt(1)
buffer_store_dwordx4 v[196:199], v44, s[56:59], s29 offen sc1
s_waitcnt lgkmcnt(0)
buffer_store_dwordx4 v[204:207], v45, s[56:59], s29 offen sc1
s_branch L2_fin
LF_spinQ:
s_mov_b32 s94, 0x10000
LF_spin2Q:
buffer_load_dwordx2 v[242:243], v46, s[16:19], 0 offen offset:0 sc1
s_sub_u32 s94, s94, 1
s_waitcnt vmcnt(0)
s_cbranch_scc1 LF_spin2Q_go
v_cmp_ne_u64 vcc, s[98:99], v[242:243]
s_nop 1
s_cbranch_vccnz LF_spin2Q
LF_spin2Q_go:
s_branch LF_goQ
LF_wf:
s_mov_b32 s94, 0x10000
LF_wf2:
buffer_load_dwordx2 v[108:109], v110, s[16:19], 0 offen sc1
s_sub_u32 s94, s94, 1
s_waitcnt vmcnt(0)
s_cbranch_scc1 LF_wf2_go
v_cmp_ne_u64 vcc, s[98:99], v[108:109]
s_nop 1
s_cbranch_vccnz LF_wf2
LF_wf2_go:
s_branch LF_wf_go
LM_pb:
s_mov_b32 s3, 0x10000
LM_pb2:
buffer_load_dwordx2 v[252:253], v251, s[16:19], 0 offen sc1
s_sub_u32 s3, s3, 1
s_waitcnt vmcnt(0)
s_cbranch_scc1 LM_pb2_go
v_cmp_ne_u64 vcc, s[98:99], v[252:253]
s_nop 1
s_cbranch_vccnz LM_pb2
LM_pb2_go:
s_branch LM_pb_ret
L2_Fend:
L2_rare_site0:
s_mov_b32 s36, 0
s_branch L2_rare_0_0
L2_rare_0_0:
s_nop 15
s_nop 15
s_waitcnt lgkmcnt(0)
v_log_f32 v243, v224
v_max3_f32 v232, v128, v129, v130
v_max3_f32 v232, v232, v131, v243
v_mov_b32 v243, v232
s_nop 1
v_permlane32_swap_b32 v232, v243
s_nop 1
v_max_f32 v232, v232, v243
v_mov_b32 v243, v232
s_nop 1
v_permlane16_swap_b32 v232, v243
s_nop 1
v_max_f32 v232, v232, v243
v_ceil_f32 v232, v232
v_max_f32 v232, 0, v232
v_sub_f32 v243, 0, v232
v_exp_f32 v236, v243
s_nop 1
v_mul_f32 v224, v224, v236
v_add_f32 v244, v244, v232
v_sub_f32 v192, v192, v232
v_sub_f32 v128, v128, v232
v_sub_f32 v144, v144, v232
v_sub_f32 v193, v193, v232
v_sub_f32 v129, v129, v232
v_sub_f32 v145, v145, v232
v_sub_f32 v194, v194, v232
v_sub_f32 v130, v130, v232
v_sub_f32 v146, v146, v232
v_sub_f32 v195, v195, v232
v_sub_f32 v131, v131, v232
v_sub_f32 v147, v147, v232
v_lshlrev_b32 v242, 16, v160
v_and_b32 v243, 0xffff0000, v160
v_mul_f32 v242, v242, v236
v_mul_f32 v243, v243, v236
v_cvt_pk_bf16_f32 v160, v242, v243
v_lshlrev_b32 v242, 16, v161
v_and_b32 v243, 0xffff0000, v161
v_mul_f32 v242, v242, v236
v_mul_f32 v243, v243, v236
v_cvt_pk_bf16_f32 v161, v242, v243
v_lshlrev_b32 v242, 16, v162
v_and_b32 v243, 0xffff0000, v162
v_mul_f32 v242, v242, v236
v_mul_f32 v243, v243, v236
v_cvt_pk_bf16_f32 v162, v242, v243
v_lshlrev_b32 v242, 16, v163
v_and_b32 v243, 0xffff0000, v163
v_mul_f32 v242, v242, v236
v_mul_f32 v243, v243, v236
v_cvt_pk_bf16_f32 v163, v242, v243
v_log_f32 v243, v225
v_max3_f32 v233, v132, v133, v134
v_max3_f32 v233, v233, v135, v243
v_mov_b32 v243, v233
s_nop 1
v_permlane32_swap_b32 v233, v243
s_nop 1
v_max_f32 v233, v233, v243
v_mov_b32 v243, v233
s_nop 1
v_permlane16_swap_b32 v233, v243
s_nop 1
v_max_f32 v233, v233, v243
v_ceil_f32 v233, v233
v_max_f32 v233, 0, v233
v_sub_f32 v243, 0, v233
v_exp_f32 v237, v243
s_nop 1
v_mul_f32 v225, v225, v237
v_add_f32 v245, v245, v233
v_sub_f32 v196, v196, v233
v_sub_f32 v132, v132, v233
v_sub_f32 v148, v148, v233
v_sub_f32 v197, v197, v233
v_sub_f32 v133, v133, v233
v_sub_f32 v149, v149, v233
v_sub_f32 v198, v198, v233
v_sub_f32 v134, v134, v233
v_sub_f32 v150, v150, v233
v_sub_f32 v199, v199, v233
v_sub_f32 v135, v135, v233
v_sub_f32 v151, v151, v233
v_lshlrev_b32 v242, 16, v164
v_and_b32 v243, 0xffff0000, v164
v_mul_f32 v242, v242, v237
v_mul_f32 v243, v243, v237
v_cvt_pk_bf16_f32 v164, v242, v243
v_lshlrev_b32 v242, 16, v165
v_and_b32 v243, 0xffff0000, v165
v_mul_f32 v242, v242, v237
v_mul_f32 v243, v243, v237
v_cvt_pk_bf16_f32 v165, v242, v243
v_lshlrev_b32 v242, 16, v166
v_and_b32 v243, 0xffff0000, v166
v_mul_f32 v242, v242, v237
v_mul_f32 v243, v243, v237
v_cvt_pk_bf16_f32 v166, v242, v243
v_lshlrev_b32 v242, 16, v167
v_and_b32 v243, 0xffff0000, v167
v_mul_f32 v242, v242, v237
v_mul_f32 v243, v243, v237
v_cvt_pk_bf16_f32 v167, v242, v243
v_log_f32 v243, v226
v_max3_f32 v234, v136, v137, v138
v_max3_f32 v234, v234, v139, v243
v_mov_b32 v243, v234
s_nop 1
v_permlane32_swap_b32 v234, v243
s_nop 1
v_max_f32 v234, v234, v243
v_mov_b32 v243, v234
s_nop 1
v_permlane16_swap_b32 v234, v243
s_nop 1
v_max_f32 v234, v234, v243
v_ceil_f32 v234, v234
v_max_f32 v234, 0, v234
v_sub_f32 v243, 0, v234
v_exp_f32 v238, v243
s_nop 1
v_mul_f32 v226, v226, v238
v_add_f32 v246, v246, v234
v_sub_f32 v200, v200, v234
v_sub_f32 v136, v136, v234
v_sub_f32 v152, v152, v234
v_sub_f32 v201, v201, v234
v_sub_f32 v137, v137, v234
v_sub_f32 v153, v153, v234
v_sub_f32 v202, v202, v234
v_sub_f32 v138, v138, v234
v_sub_f32 v154, v154, v234
v_sub_f32 v203, v203, v234
v_sub_f32 v139, v139, v234
v_sub_f32 v155, v155, v234
v_lshlrev_b32 v242, 16, v168
v_and_b32 v243, 0xffff0000, v168
v_mul_f32 v242, v242, v238
v_mul_f32 v243, v243, v238
v_cvt_pk_bf16_f32 v168, v242, v243
v_lshlrev_b32 v242, 16, v169
v_and_b32 v243, 0xffff0000, v169
v_mul_f32 v242, v242, v238
v_mul_f32 v243, v243, v238
v_cvt_pk_bf16_f32 v169, v242, v243
v_lshlrev_b32 v242, 16, v170
v_and_b32 v243, 0xffff0000, v170
v_mul_f32 v242, v242, v238
v_mul_f32 v243, v243, v238
v_cvt_pk_bf16_f32 v170, v242, v243
v_lshlrev_b32 v242, 16, v171
v_and_b32 v243, 0xffff0000, v171
v_mul_f32 v242, v242, v238
v_mul_f32 v243, v243, v238
v_cvt_pk_bf16_f32 v171, v242, v243
v_log_f32 v243, v227
v_max3_f32 v235, v140, v141, v142
v_max3_f32 v235, v235, v143, v243
v_mov_b32 v243, v235
s_nop 1
v_permlane32_swap_b32 v235, v243
s_nop 1
v_max_f32 v235, v235, v243
v_mov_b32 v243, v235
s_nop 1
v_permlane16_swap_b32 v235, v243
s_nop 1
v_max_f32 v235, v235, v243
v_ceil_f32 v235, v235
v_max_f32 v235, 0, v235
v_sub_f32 v243, 0, v235
v_exp_f32 v239, v243
s_nop 1
v_mul_f32 v227, v227, v239
v_add_f32 v247, v247, v235
v_sub_f32 v204, v204, v235
v_sub_f32 v140, v140, v235
v_sub_f32 v156, v156, v235
v_sub_f32 v205, v205, v235
v_sub_f32 v141, v141, v235
v_sub_f32 v157, v157, v235
v_sub_f32 v206, v206, v235
v_sub_f32 v142, v142, v235
v_sub_f32 v158, v158, v235
v_sub_f32 v207, v207, v235
v_sub_f32 v143, v143, v235
v_sub_f32 v159, v159, v235
v_lshlrev_b32 v242, 16, v172
v_and_b32 v243, 0xffff0000, v172
v_mul_f32 v242, v242, v239
v_mul_f32 v243, v243, v239
v_cvt_pk_bf16_f32 v172, v242, v243
v_lshlrev_b32 v242, 16, v173
v_and_b32 v243, 0xffff0000, v173
v_mul_f32 v242, v242, v239
v_mul_f32 v243, v243, v239
v_cvt_pk_bf16_f32 v173, v242, v243
v_lshlrev_b32 v242, 16, v174
v_and_b32 v243, 0xffff0000, v174
v_mul_f32 v242, v242, v239
v_mul_f32 v243, v243, v239
v_cvt_pk_bf16_f32 v174, v242, v243
v_lshlrev_b32 v242, 16, v175
v_and_b32 v243, 0xffff0000, v175
v_mul_f32 v242, v242, v239
v_mul_f32 v243, v243, v239
v_cvt_pk_bf16_f32 v175, v242, v243
v_exp_f32 v232, v128
v_exp_f32 v233, v129
v_exp_f32 v234, v130
v_exp_f32 v235, v131
s_nop 1
v_add_f32 v228, v224, v232
v_add_f32 v228, v228, v233
v_add_f32 v228, v228, v234
v_add_f32 v228, v228, v235
v_cvt_pk_bf16_f32 v176, v232, v233
v_cvt_pk_bf16_f32 v177, v234, v235
v_exp_f32 v232, v132
v_exp_f32 v233, v133
v_exp_f32 v234, v134
v_exp_f32 v235, v135
s_nop 1
v_add_f32 v229, v225, v232
v_add_f32 v229, v229, v233
v_add_f32 v229, v229, v234
v_add_f32 v229, v229, v235
v_cvt_pk_bf16_f32 v180, v232, v233
v_cvt_pk_bf16_f32 v181, v234, v235
v_exp_f32 v232, v136
v_exp_f32 v233, v137
v_exp_f32 v234, v138
v_exp_f32 v235, v139
s_nop 1
v_add_f32 v230, v226, v232
v_add_f32 v230, v230, v233
v_add_f32 v230, v230, v234
v_add_f32 v230, v230, v235
v_cvt_pk_bf16_f32 v184, v232, v233
v_cvt_pk_bf16_f32 v185, v234, v235
v_exp_f32 v232, v140
v_exp_f32 v233, v141
v_exp_f32 v234, v142
v_exp_f32 v235, v143
s_nop 1
v_add_f32 v231, v227, v232
v_add_f32 v231, v231, v233
v_add_f32 v231, v231, v234
v_add_f32 v231, v231, v235
v_cvt_pk_bf16_f32 v188, v232, v233
v_cvt_pk_bf16_f32 v189, v234, v235
s_branch L2_rare_common
L2_rare_site1:
s_mov_b32 s36, 1
s_branch L2_rare_0_1
L2_rare_0_1:
s_nop 15
s_nop 15
s_waitcnt lgkmcnt(0)
v_log_f32 v243, v228
v_max3_f32 v232, v144, v145, v146
v_max3_f32 v232, v232, v147, v243
v_mov_b32 v243, v232
s_nop 1
v_permlane32_swap_b32 v232, v243
s_nop 1
v_max_f32 v232, v232, v243
v_mov_b32 v243, v232
s_nop 1
v_permlane16_swap_b32 v232, v243
s_nop 1
v_max_f32 v232, v232, v243
v_ceil_f32 v232, v232
v_max_f32 v232, 0, v232
v_sub_f32 v243, 0, v232
v_exp_f32 v236, v243
s_nop 1
v_mul_f32 v228, v228, v236
v_add_f32 v244, v244, v232
v_sub_f32 v192, v192, v232
v_sub_f32 v128, v128, v232
v_sub_f32 v144, v144, v232
v_sub_f32 v193, v193, v232
v_sub_f32 v129, v129, v232
v_sub_f32 v145, v145, v232
v_sub_f32 v194, v194, v232
v_sub_f32 v130, v130, v232
v_sub_f32 v146, v146, v232
v_sub_f32 v195, v195, v232
v_sub_f32 v131, v131, v232
v_sub_f32 v147, v147, v232
v_lshlrev_b32 v242, 16, v160
v_and_b32 v243, 0xffff0000, v160
v_mul_f32 v242, v242, v236
v_mul_f32 v243, v243, v236
v_cvt_pk_bf16_f32 v160, v242, v243
v_lshlrev_b32 v242, 16, v161
v_and_b32 v243, 0xffff0000, v161
v_mul_f32 v242, v242, v236
v_mul_f32 v243, v243, v236
v_cvt_pk_bf16_f32 v161, v242, v243
v_lshlrev_b32 v242, 16, v162
v_and_b32 v243, 0xffff0000, v162
v_mul_f32 v242, v242, v236
v_mul_f32 v243, v243, v236
v_cvt_pk_bf16_f32 v162, v242, v243
v_lshlrev_b32 v242, 16, v163
v_and_b32 v243, 0xffff0000, v163
v_mul_f32 v242, v242, v236
v_mul_f32 v243, v243, v236
v_cvt_pk_bf16_f32 v163, v242, v243
v_lshlrev_b32 v242, 16, v176
v_and_b32 v243, 0xffff0000, v176
v_mul_f32 v242, v242, v236
v_mul_f32 v243, v243, v236
v_cvt_pk_bf16_f32 v176, v242, v243
v_lshlrev_b32 v242, 16, v177
v_and_b32 v243, 0xffff0000, v177
v_mul_f32 v242, v242, v236
v_mul_f32 v243, v243, v236
v_cvt_pk_bf16_f32 v177, v242, v243
v_log_f32 v243, v229
v_max3_f32 v233, v148, v149, v150
v_max3_f32 v233, v233, v151, v243
v_mov_b32 v243, v233
s_nop 1
v_permlane32_swap_b32 v233, v243
s_nop 1
v_max_f32 v233, v233, v243
v_mov_b32 v243, v233
s_nop 1
v_permlane16_swap_b32 v233, v243
s_nop 1
v_max_f32 v233, v233, v243
v_ceil_f32 v233, v233
v_max_f32 v233, 0, v233
v_sub_f32 v243, 0, v233
v_exp_f32 v237, v243
s_nop 1
v_mul_f32 v229, v229, v237
v_add_f32 v245, v245, v233
v_sub_f32 v196, v196, v233
v_sub_f32 v132, v132, v233
v_sub_f32 v148, v148, v233
v_sub_f32 v197, v197, v233
v_sub_f32 v133, v133, v233
v_sub_f32 v149, v149, v233
v_sub_f32 v198, v198, v233
v_sub_f32 v134, v134, v233
v_sub_f32 v150, v150, v233
v_sub_f32 v199, v199, v233
v_sub_f32 v135, v135, v233
v_sub_f32 v151, v151, v233
v_lshlrev_b32 v242, 16, v164
v_and_b32 v243, 0xffff0000, v164
v_mul_f32 v242, v242, v237
v_mul_f32 v243, v243, v237
v_cvt_pk_bf16_f32 v164, v242, v243
v_lshlrev_b32 v242, 16, v165
v_and_b32 v243, 0xffff0000, v165
v_mul_f32 v242, v242, v237
v_mul_f32 v243, v243, v237
v_cvt_pk_bf16_f32 v165, v242, v243
v_lshlrev_b32 v242, 16, v166
v_and_b32 v243, 0xffff0000, v166
v_mul_f32 v242, v242, v237
v_mul_f32 v243, v243, v237
v_cvt_pk_bf16_f32 v166, v242, v243
v_lshlrev_b32 v242, 16, v167
v_and_b32 v243, 0xffff0000, v167
v_mul_f32 v242, v242, v237
v_mul_f32 v243, v243, v237
v_cvt_pk_bf16_f32 v167, v242, v243
v_lshlrev_b32 v242, 16, v180
v_and_b32 v243, 0xffff0000, v180
v_mul_f32 v242, v242, v237
v_mul_f32 v243, v243, v237
v_cvt_pk_bf16_f32 v180, v242, v243
v_lshlrev_b32 v242, 16, v181
v_and_b32 v243, 0xffff0000, v181
v_mul_f32 v242, v242, v237
v_mul_f32 v243, v243, v237
v_cvt_pk_bf16_f32 v181, v242, v243
v_log_f32 v243, v230
v_max3_f32 v234, v152, v153, v154
v_max3_f32 v234, v234, v155, v243
v_mov_b32 v243, v234
s_nop 1
v_permlane32_swap_b32 v234, v243
s_nop 1
v_max_f32 v234, v234, v243
v_mov_b32 v243, v234
s_nop 1
v_permlane16_swap_b32 v234, v243
s_nop 1
v_max_f32 v234, v234, v243
v_ceil_f32 v234, v234
v_max_f32 v234, 0, v234
v_sub_f32 v243, 0, v234
v_exp_f32 v238, v243
s_nop 1
v_mul_f32 v230, v230, v238
v_add_f32 v246, v246, v234
v_sub_f32 v200, v200, v234
v_sub_f32 v136, v136, v234
v_sub_f32 v152, v152, v234
v_sub_f32 v201, v201, v234
v_sub_f32 v137, v137, v234
v_sub_f32 v153, v153, v234
v_sub_f32 v202, v202, v234
v_sub_f32 v138, v138, v234
v_sub_f32 v154, v154, v234
v_sub_f32 v203, v203, v234
v_sub_f32 v139, v139, v234
v_sub_f32 v155, v155, v234
v_lshlrev_b32 v242, 16, v168
v_and_b32 v243, 0xffff0000, v168
v_mul_f32 v242, v242, v238
v_mul_f32 v243, v243, v238
v_cvt_pk_bf16_f32 v168, v242, v243
v_lshlrev_b32 v242, 16, v169
v_and_b32 v243, 0xffff0000, v169
v_mul_f32 v242, v242, v238
v_mul_f32 v243, v243, v238
v_cvt_pk_bf16_f32 v169, v242, v243
v_lshlrev_b32 v242, 16, v170
v_and_b32 v243, 0xffff0000, v170
v_mul_f32 v242, v242, v238
v_mul_f32 v243, v243, v238
v_cvt_pk_bf16_f32 v170, v242, v243
v_lshlrev_b32 v242, 16, v171
v_and_b32 v243, 0xffff0000, v171
v_mul_f32 v242, v242, v238
v_mul_f32 v243, v243, v238
v_cvt_pk_bf16_f32 v171, v242, v243
v_lshlrev_b32 v242, 16, v184
v_and_b32 v243, 0xffff0000, v184
v_mul_f32 v242, v242, v238
v_mul_f32 v243, v243, v238
v_cvt_pk_bf16_f32 v184, v242, v243
v_lshlrev_b32 v242, 16, v185
v_and_b32 v243, 0xffff0000, v185
v_mul_f32 v242, v242, v238
v_mul_f32 v243, v243, v238
v_cvt_pk_bf16_f32 v185, v242, v243
v_log_f32 v243, v231
v_max3_f32 v235, v156, v157, v158
v_max3_f32 v235, v235, v159, v243
v_mov_b32 v243, v235
s_nop 1
v_permlane32_swap_b32 v235, v243
s_nop 1
v_max_f32 v235, v235, v243
v_mov_b32 v243, v235
s_nop 1
v_permlane16_swap_b32 v235, v243
s_nop 1
v_max_f32 v235, v235, v243
v_ceil_f32 v235, v235
v_max_f32 v235, 0, v235
v_sub_f32 v243, 0, v235
v_exp_f32 v239, v243
s_nop 1
v_mul_f32 v231, v231, v239
v_add_f32 v247, v247, v235
v_sub_f32 v204, v204, v235
v_sub_f32 v140, v140, v235
v_sub_f32 v156, v156, v235
v_sub_f32 v205, v205, v235
v_sub_f32 v141, v141, v235
v_sub_f32 v157, v157, v235
v_sub_f32 v206, v206, v235
v_sub_f32 v142, v142, v235
v_sub_f32 v158, v158, v235
v_sub_f32 v207, v207, v235
v_sub_f32 v143, v143, v235
v_sub_f32 v159, v159, v235
v_lshlrev_b32 v242, 16, v172
v_and_b32 v243, 0xffff0000, v172
v_mul_f32 v242, v242, v239
v_mul_f32 v243, v243, v239
v_cvt_pk_bf16_f32 v172, v242, v243
v_lshlrev_b32 v242, 16, v173
v_and_b32 v243, 0xffff0000, v173
v_mul_f32 v242, v242, v239
v_mul_f32 v243, v243, v239
v_cvt_pk_bf16_f32 v173, v242, v243
v_lshlrev_b32 v242, 16, v174
v_and_b32 v243, 0xffff0000, v174
v_mul_f32 v242, v242, v239
v_mul_f32 v243, v243, v239
v_cvt_pk_bf16_f32 v174, v242, v243
v_lshlrev_b32 v242, 16, v175
v_and_b32 v243, 0xffff0000, v175
v_mul_f32 v242, v242, v239
v_mul_f32 v243, v243, v239
v_cvt_pk_bf16_f32 v175, v242, v243
v_lshlrev_b32 v242, 16, v188
v_and_b32 v243, 0xffff0000, v188
v_mul_f32 v242, v242, v239
v_mul_f32 v243, v243, v239
v_cvt_pk_bf16_f32 v188, v242, v243
v_lshlrev_b32 v242, 16, v189
v_and_b32 v243, 0xffff0000, v189
v_mul_f32 v242, v242, v239
v_mul_f32 v243, v243, v239
v_cvt_pk_bf16_f32 v189, v242, v243
v_exp_f32 v232, v144
v_exp_f32 v233, v145
v_exp_f32 v234, v146
v_exp_f32 v235, v147
s_nop 1
v_add_f32 v224, v228, v232
v_add_f32 v224, v224, v233
v_add_f32 v224, v224, v234
v_add_f32 v224, v224, v235
v_cvt_pk_bf16_f32 v178, v232, v233
v_cvt_pk_bf16_f32 v179, v234, v235
v_exp_f32 v232, v148
v_exp_f32 v233, v149
v_exp_f32 v234, v150
v_exp_f32 v235, v151
s_nop 1
v_add_f32 v225, v229, v232
v_add_f32 v225, v225, v233
v_add_f32 v225, v225, v234
v_add_f32 v225, v225, v235
v_cvt_pk_bf16_f32 v182, v232, v233
v_cvt_pk_bf16_f32 v183, v234, v235
v_exp_f32 v232, v152
v_exp_f32 v233, v153
v_exp_f32 v234, v154
v_exp_f32 v235, v155
s_nop 1
v_add_f32 v226, v230, v232
v_add_f32 v226, v226, v233
v_add_f32 v226, v226, v234
v_add_f32 v226, v226, v235
v_cvt_pk_bf16_f32 v186, v232, v233
v_cvt_pk_bf16_f32 v187, v234, v235
v_exp_f32 v232, v156
v_exp_f32 v233, v157
v_exp_f32 v234, v158
v_exp_f32 v235, v159
s_nop 1
v_add_f32 v227, v231, v232
v_add_f32 v227, v227, v233
v_add_f32 v227, v227, v234
v_add_f32 v227, v227, v235
v_cvt_pk_bf16_f32 v190, v232, v233
v_cvt_pk_bf16_f32 v191, v234, v235
s_branch L2_rare_common
L2_rare_site2:
s_mov_b32 s36, 2
s_branch L2_rare_1_0
L2_rare_1_0:
s_nop 15
s_nop 15
s_waitcnt lgkmcnt(0)
v_log_f32 v243, v224
v_max3_f32 v232, v128, v129, v130
v_max3_f32 v232, v232, v131, v243
v_mov_b32 v243, v232
s_nop 1
v_permlane32_swap_b32 v232, v243
s_nop 1
v_max_f32 v232, v232, v243
v_mov_b32 v243, v232
s_nop 1
v_permlane16_swap_b32 v232, v243
s_nop 1
v_max_f32 v232, v232, v243
v_ceil_f32 v232, v232
v_max_f32 v232, 0, v232
v_sub_f32 v243, 0, v232
v_exp_f32 v236, v243
s_nop 1
v_mul_f32 v224, v224, v236
v_add_f32 v244, v244, v232
v_sub_f32 v192, v192, v232
v_sub_f32 v128, v128, v232
v_sub_f32 v144, v144, v232
v_sub_f32 v193, v193, v232
v_sub_f32 v129, v129, v232
v_sub_f32 v145, v145, v232
v_sub_f32 v194, v194, v232
v_sub_f32 v130, v130, v232
v_sub_f32 v146, v146, v232
v_sub_f32 v195, v195, v232
v_sub_f32 v131, v131, v232
v_sub_f32 v147, v147, v232
v_lshlrev_b32 v242, 16, v176
v_and_b32 v243, 0xffff0000, v176
v_mul_f32 v242, v242, v236
v_mul_f32 v243, v243, v236
v_cvt_pk_bf16_f32 v176, v242, v243
v_lshlrev_b32 v242, 16, v177
v_and_b32 v243, 0xffff0000, v177
v_mul_f32 v242, v242, v236
v_mul_f32 v243, v243, v236
v_cvt_pk_bf16_f32 v177, v242, v243
v_lshlrev_b32 v242, 16, v178
v_and_b32 v243, 0xffff0000, v178
v_mul_f32 v242, v242, v236
v_mul_f32 v243, v243, v236
v_cvt_pk_bf16_f32 v178, v242, v243
v_lshlrev_b32 v242, 16, v179
v_and_b32 v243, 0xffff0000, v179
v_mul_f32 v242, v242, v236
v_mul_f32 v243, v243, v236
v_cvt_pk_bf16_f32 v179, v242, v243
v_log_f32 v243, v225
v_max3_f32 v233, v132, v133, v134
v_max3_f32 v233, v233, v135, v243
v_mov_b32 v243, v233
s_nop 1
v_permlane32_swap_b32 v233, v243
s_nop 1
v_max_f32 v233, v233, v243
v_mov_b32 v243, v233
s_nop 1
v_permlane16_swap_b32 v233, v243
s_nop 1
v_max_f32 v233, v233, v243
v_ceil_f32 v233, v233
v_max_f32 v233, 0, v233
v_sub_f32 v243, 0, v233
v_exp_f32 v237, v243
s_nop 1
v_mul_f32 v225, v225, v237
v_add_f32 v245, v245, v233
v_sub_f32 v196, v196, v233
v_sub_f32 v132, v132, v233
v_sub_f32 v148, v148, v233
v_sub_f32 v197, v197, v233
v_sub_f32 v133, v133, v233
v_sub_f32 v149, v149, v233
v_sub_f32 v198, v198, v233
v_sub_f32 v134, v134, v233
v_sub_f32 v150, v150, v233
v_sub_f32 v199, v199, v233
v_sub_f32 v135, v135, v233
v_sub_f32 v151, v151, v233
v_lshlrev_b32 v242, 16, v180
v_and_b32 v243, 0xffff0000, v180
v_mul_f32 v242, v242, v237
v_mul_f32 v243, v243, v237
v_cvt_pk_bf16_f32 v180, v242, v243
v_lshlrev_b32 v242, 16, v181
v_and_b32 v243, 0xffff0000, v181
v_mul_f32 v242, v242, v237
v_mul_f32 v243, v243, v237
v_cvt_pk_bf16_f32 v181, v242, v243
v_lshlrev_b32 v242, 16, v182
v_and_b32 v243, 0xffff0000, v182
v_mul_f32 v242, v242, v237
v_mul_f32 v243, v243, v237
v_cvt_pk_bf16_f32 v182, v242, v243
v_lshlrev_b32 v242, 16, v183
v_and_b32 v243, 0xffff0000, v183
v_mul_f32 v242, v242, v237
v_mul_f32 v243, v243, v237
v_cvt_pk_bf16_f32 v183, v242, v243
v_log_f32 v243, v226
v_max3_f32 v234, v136, v137, v138
v_max3_f32 v234, v234, v139, v243
v_mov_b32 v243, v234
s_nop 1
v_permlane32_swap_b32 v234, v243
s_nop 1
v_max_f32 v234, v234, v243
v_mov_b32 v243, v234
s_nop 1
v_permlane16_swap_b32 v234, v243
s_nop 1
v_max_f32 v234, v234, v243
v_ceil_f32 v234, v234
v_max_f32 v234, 0, v234
v_sub_f32 v243, 0, v234
v_exp_f32 v238, v243
s_nop 1
v_mul_f32 v226, v226, v238
v_add_f32 v246, v246, v234
v_sub_f32 v200, v200, v234
v_sub_f32 v136, v136, v234
v_sub_f32 v152, v152, v234
v_sub_f32 v201, v201, v234
v_sub_f32 v137, v137, v234
v_sub_f32 v153, v153, v234
v_sub_f32 v202, v202, v234
v_sub_f32 v138, v138, v234
v_sub_f32 v154, v154, v234
v_sub_f32 v203, v203, v234
v_sub_f32 v139, v139, v234
v_sub_f32 v155, v155, v234
v_lshlrev_b32 v242, 16, v184
v_and_b32 v243, 0xffff0000, v184
v_mul_f32 v242, v242, v238
v_mul_f32 v243, v243, v238
v_cvt_pk_bf16_f32 v184, v242, v243
v_lshlrev_b32 v242, 16, v185
v_and_b32 v243, 0xffff0000, v185
v_mul_f32 v242, v242, v238
v_mul_f32 v243, v243, v238
v_cvt_pk_bf16_f32 v185, v242, v243
v_lshlrev_b32 v242, 16, v186
v_and_b32 v243, 0xffff0000, v186
v_mul_f32 v242, v242, v238
v_mul_f32 v243, v243, v238
v_cvt_pk_bf16_f32 v186, v242, v243
v_lshlrev_b32 v242, 16, v187
v_and_b32 v243, 0xffff0000, v187
v_mul_f32 v242, v242, v238
v_mul_f32 v243, v243, v238
v_cvt_pk_bf16_f32 v187, v242, v243
v_log_f32 v243, v227
v_max3_f32 v235, v140, v141, v142
v_max3_f32 v235, v235, v143, v243
v_mov_b32 v243, v235
s_nop 1
v_permlane32_swap_b32 v235, v243
s_nop 1
v_max_f32 v235, v235, v243
v_mov_b32 v243, v235
s_nop 1
v_permlane16_swap_b32 v235, v243
s_nop 1
v_max_f32 v235, v235, v243
v_ceil_f32 v235, v235
v_max_f32 v235, 0, v235
v_sub_f32 v243, 0, v235
v_exp_f32 v239, v243
s_nop 1
v_mul_f32 v227, v227, v239
v_add_f32 v247, v247, v235
v_sub_f32 v204, v204, v235
v_sub_f32 v140, v140, v235
v_sub_f32 v156, v156, v235
v_sub_f32 v205, v205, v235
v_sub_f32 v141, v141, v235
v_sub_f32 v157, v157, v235
v_sub_f32 v206, v206, v235
v_sub_f32 v142, v142, v235
v_sub_f32 v158, v158, v235
v_sub_f32 v207, v207, v235
v_sub_f32 v143, v143, v235
v_sub_f32 v159, v159, v235
v_lshlrev_b32 v242, 16, v188
v_and_b32 v243, 0xffff0000, v188
v_mul_f32 v242, v242, v239
v_mul_f32 v243, v243, v239
v_cvt_pk_bf16_f32 v188, v242, v243
v_lshlrev_b32 v242, 16, v189
v_and_b32 v243, 0xffff0000, v189
v_mul_f32 v242, v242, v239
v_mul_f32 v243, v243, v239
v_cvt_pk_bf16_f32 v189, v242, v243
v_lshlrev_b32 v242, 16, v190
v_and_b32 v243, 0xffff0000, v190
v_mul_f32 v242, v242, v239
v_mul_f32 v243, v243, v239
v_cvt_pk_bf16_f32 v190, v242, v243
v_lshlrev_b32 v242, 16, v191
v_and_b32 v243, 0xffff0000, v191
v_mul_f32 v242, v242, v239
v_mul_f32 v243, v243, v239
v_cvt_pk_bf16_f32 v191, v242, v243
v_exp_f32 v232, v128
v_exp_f32 v233, v129
v_exp_f32 v234, v130
v_exp_f32 v235, v131
s_nop 1
v_add_f32 v228, v224, v232
v_add_f32 v228, v228, v233
v_add_f32 v228, v228, v234
v_add_f32 v228, v228, v235
v_cvt_pk_bf16_f32 v160, v232, v233
v_cvt_pk_bf16_f32 v161, v234, v235
v_exp_f32 v232, v132
v_exp_f32 v233, v133
v_exp_f32 v234, v134
v_exp_f32 v235, v135
s_nop 1
v_add_f32 v229, v225, v232
v_add_f32 v229, v229, v233
v_add_f32 v229, v229, v234
v_add_f32 v229, v229, v235
v_cvt_pk_bf16_f32 v164, v232, v233
v_cvt_pk_bf16_f32 v165, v234, v235
v_exp_f32 v232, v136
v_exp_f32 v233, v137
v_exp_f32 v234, v138
v_exp_f32 v235, v139
s_nop 1
v_add_f32 v230, v226, v232
v_add_f32 v230, v230, v233
v_add_f32 v230, v230, v234
v_add_f32 v230, v230, v235
v_cvt_pk_bf16_f32 v168, v232, v233
v_cvt_pk_bf16_f32 v169, v234, v235
v_exp_f32 v232, v140
v_exp_f32 v233, v141
v_exp_f32 v234, v142
v_exp_f32 v235, v143
s_nop 1
v_add_f32 v231, v227, v232
v_add_f32 v231, v231, v233
v_add_f32 v231, v231, v234
v_add_f32 v231, v231, v235
v_cvt_pk_bf16_f32 v172, v232, v233
v_cvt_pk_bf16_f32 v173, v234, v235
s_branch L2_rare_common
L2_rare_site3:
s_mov_b32 s36, 3
s_branch L2_rare_1_1
L2_rare_1_1:
s_nop 15
s_nop 15
s_waitcnt lgkmcnt(0)
v_log_f32 v243, v228
v_max3_f32 v232, v144, v145, v146
v_max3_f32 v232, v232, v147, v243
v_mov_b32 v243, v232
s_nop 1
v_permlane32_swap_b32 v232, v243
s_nop 1
v_max_f32 v232, v232, v243
v_mov_b32 v243, v232
s_nop 1
v_permlane16_swap_b32 v232, v243
s_nop 1
v_max_f32 v232, v232, v243
v_ceil_f32 v232, v232
v_max_f32 v232, 0, v232
v_sub_f32 v243, 0, v232
v_exp_f32 v236, v243
s_nop 1
v_mul_f32 v228, v228, v236
v_add_f32 v244, v244, v232
v_sub_f32 v192, v192, v232
v_sub_f32 v128, v128, v232
v_sub_f32 v144, v144, v232
v_sub_f32 v193, v193, v232
v_sub_f32 v129, v129, v232
v_sub_f32 v145, v145, v232
v_sub_f32 v194, v194, v232
v_sub_f32 v130, v130, v232
v_sub_f32 v146, v146, v232
v_sub_f32 v195, v195, v232
v_sub_f32 v131, v131, v232
v_sub_f32 v147, v147, v232
v_lshlrev_b32 v242, 16, v176
v_and_b32 v243, 0xffff0000, v176
v_mul_f32 v242, v242, v236
v_mul_f32 v243, v243, v236
v_cvt_pk_bf16_f32 v176, v242, v243
v_lshlrev_b32 v242, 16, v177
v_and_b32 v243, 0xffff0000, v177
v_mul_f32 v242, v242, v236
v_mul_f32 v243, v243, v236
v_cvt_pk_bf16_f32 v177, v242, v243
v_lshlrev_b32 v242, 16, v178
v_and_b32 v243, 0xffff0000, v178
v_mul_f32 v242, v242, v236
v_mul_f32 v243, v243, v236
v_cvt_pk_bf16_f32 v178, v242, v243
v_lshlrev_b32 v242, 16, v179
v_and_b32 v243, 0xffff0000, v179
v_mul_f32 v242, v242, v236
v_mul_f32 v243, v243, v236
v_cvt_pk_bf16_f32 v179, v242, v243
v_lshlrev_b32 v242, 16, v160
v_and_b32 v243, 0xffff0000, v160
v_mul_f32 v242, v242, v236
v_mul_f32 v243, v243, v236
v_cvt_pk_bf16_f32 v160, v242, v243
v_lshlrev_b32 v242, 16, v161
v_and_b32 v243, 0xffff0000, v161
v_mul_f32 v242, v242, v236
v_mul_f32 v243, v243, v236
v_cvt_pk_bf16_f32 v161, v242, v243
v_log_f32 v243, v229
v_max3_f32 v233, v148, v149, v150
v_max3_f32 v233, v233, v151, v243
v_mov_b32 v243, v233
s_nop 1
v_permlane32_swap_b32 v233, v243
s_nop 1
v_max_f32 v233, v233, v243
v_mov_b32 v243, v233
s_nop 1
v_permlane16_swap_b32 v233, v243
s_nop 1
v_max_f32 v233, v233, v243
v_ceil_f32 v233, v233
v_max_f32 v233, 0, v233
v_sub_f32 v243, 0, v233
v_exp_f32 v237, v243
s_nop 1
v_mul_f32 v229, v229, v237
v_add_f32 v245, v245, v233
v_sub_f32 v196, v196, v233
v_sub_f32 v132, v132, v233
v_sub_f32 v148, v148, v233
v_sub_f32 v197, v197, v233
v_sub_f32 v133, v133, v233
v_sub_f32 v149, v149, v233
v_sub_f32 v198, v198, v233
v_sub_f32 v134, v134, v233
v_sub_f32 v150, v150, v233
v_sub_f32 v199, v199, v233
v_sub_f32 v135, v135, v233
v_sub_f32 v151, v151, v233
v_lshlrev_b32 v242, 16, v180
v_and_b32 v243, 0xffff0000, v180
v_mul_f32 v242, v242, v237
v_mul_f32 v243, v243, v237
v_cvt_pk_bf16_f32 v180, v242, v243
v_lshlrev_b32 v242, 16, v181
v_and_b32 v243, 0xffff0000, v181
v_mul_f32 v242, v242, v237
v_mul_f32 v243, v243, v237
v_cvt_pk_bf16_f32 v181, v242, v243
v_lshlrev_b32 v242, 16, v182
v_and_b32 v243, 0xffff0000, v182
v_mul_f32 v242, v242, v237
v_mul_f32 v243, v243, v237
v_cvt_pk_bf16_f32 v182, v242, v243
v_lshlrev_b32 v242, 16, v183
v_and_b32 v243, 0xffff0000, v183
v_mul_f32 v242, v242, v237
v_mul_f32 v243, v243, v237
v_cvt_pk_bf16_f32 v183, v242, v243
v_lshlrev_b32 v242, 16, v164
v_and_b32 v243, 0xffff0000, v164
v_mul_f32 v242, v242, v237
v_mul_f32 v243, v243, v237
v_cvt_pk_bf16_f32 v164, v242, v243
v_lshlrev_b32 v242, 16, v165
v_and_b32 v243, 0xffff0000, v165
v_mul_f32 v242, v242, v237
v_mul_f32 v243, v243, v237
v_cvt_pk_bf16_f32 v165, v242, v243
v_log_f32 v243, v230
v_max3_f32 v234, v152, v153, v154
v_max3_f32 v234, v234, v155, v243
v_mov_b32 v243, v234
s_nop 1
v_permlane32_swap_b32 v234, v243
s_nop 1
v_max_f32 v234, v234, v243
v_mov_b32 v243, v234
s_nop 1
v_permlane16_swap_b32 v234, v243
s_nop 1
v_max_f32 v234, v234, v243
v_ceil_f32 v234, v234
v_max_f32 v234, 0, v234
v_sub_f32 v243, 0, v234
v_exp_f32 v238, v243
s_nop 1
v_mul_f32 v230, v230, v238
v_add_f32 v246, v246, v234
v_sub_f32 v200, v200, v234
v_sub_f32 v136, v136, v234
v_sub_f32 v152, v152, v234
v_sub_f32 v201, v201, v234
v_sub_f32 v137, v137, v234
v_sub_f32 v153, v153, v234
v_sub_f32 v202, v202, v234
v_sub_f32 v138, v138, v234
v_sub_f32 v154, v154, v234
v_sub_f32 v203, v203, v234
v_sub_f32 v139, v139, v234
v_sub_f32 v155, v155, v234
v_lshlrev_b32 v242, 16, v184
v_and_b32 v243, 0xffff0000, v184
v_mul_f32 v242, v242, v238
v_mul_f32 v243, v243, v238
v_cvt_pk_bf16_f32 v184, v242, v243
v_lshlrev_b32 v242, 16, v185
v_and_b32 v243, 0xffff0000, v185
v_mul_f32 v242, v242, v238
v_mul_f32 v243, v243, v238
v_cvt_pk_bf16_f32 v185, v242, v243
v_lshlrev_b32 v242, 16, v186
v_and_b32 v243, 0xffff0000, v186
v_mul_f32 v242, v242, v238
v_mul_f32 v243, v243, v238
v_cvt_pk_bf16_f32 v186, v242, v243
v_lshlrev_b32 v242, 16, v187
v_and_b32 v243, 0xffff0000, v187
v_mul_f32 v242, v242, v238
v_mul_f32 v243, v243, v238
v_cvt_pk_bf16_f32 v187, v242, v243
v_lshlrev_b32 v242, 16, v168
v_and_b32 v243, 0xffff0000, v168
v_mul_f32 v242, v242, v238
v_mul_f32 v243, v243, v238
v_cvt_pk_bf16_f32 v168, v242, v243
v_lshlrev_b32 v242, 16, v169
v_and_b32 v243, 0xffff0000, v169
v_mul_f32 v242, v242, v238
v_mul_f32 v243, v243, v238
v_cvt_pk_bf16_f32 v169, v242, v243
v_log_f32 v243, v231
v_max3_f32 v235, v156, v157, v158
v_max3_f32 v235, v235, v159, v243
v_mov_b32 v243, v235
s_nop 1
v_permlane32_swap_b32 v235, v243
s_nop 1
v_max_f32 v235, v235, v243
v_mov_b32 v243, v235
s_nop 1
v_permlane16_swap_b32 v235, v243
s_nop 1
v_max_f32 v235, v235, v243
v_ceil_f32 v235, v235
v_max_f32 v235, 0, v235
v_sub_f32 v243, 0, v235
v_exp_f32 v239, v243
s_nop 1
v_mul_f32 v231, v231, v239
v_add_f32 v247, v247, v235
v_sub_f32 v204, v204, v235
v_sub_f32 v140, v140, v235
v_sub_f32 v156, v156, v235
v_sub_f32 v205, v205, v235
v_sub_f32 v141, v141, v235
v_sub_f32 v157, v157, v235
v_sub_f32 v206, v206, v235
v_sub_f32 v142, v142, v235
v_sub_f32 v158, v158, v235
v_sub_f32 v207, v207, v235
v_sub_f32 v143, v143, v235
v_sub_f32 v159, v159, v235
v_lshlrev_b32 v242, 16, v188
v_and_b32 v243, 0xffff0000, v188
v_mul_f32 v242, v242, v239
v_mul_f32 v243, v243, v239
v_cvt_pk_bf16_f32 v188, v242, v243
v_lshlrev_b32 v242, 16, v189
v_and_b32 v243, 0xffff0000, v189
v_mul_f32 v242, v242, v239
v_mul_f32 v243, v243, v239
v_cvt_pk_bf16_f32 v189, v242, v243
v_lshlrev_b32 v242, 16, v190
v_and_b32 v243, 0xffff0000, v190
v_mul_f32 v242, v242, v239
v_mul_f32 v243, v243, v239
v_cvt_pk_bf16_f32 v190, v242, v243
v_lshlrev_b32 v242, 16, v191
v_and_b32 v243, 0xffff0000, v191
v_mul_f32 v242, v242, v239
v_mul_f32 v243, v243, v239
v_cvt_pk_bf16_f32 v191, v242, v243
v_lshlrev_b32 v242, 16, v172
v_and_b32 v243, 0xffff0000, v172
v_mul_f32 v242, v242, v239
v_mul_f32 v243, v243, v239
v_cvt_pk_bf16_f32 v172, v242, v243
v_lshlrev_b32 v242, 16, v173
v_and_b32 v243, 0xffff0000, v173
v_mul_f32 v242, v242, v239
v_mul_f32 v243, v243, v239
v_cvt_pk_bf16_f32 v173, v242, v243
v_exp_f32 v232, v144
v_exp_f32 v233, v145
v_exp_f32 v234, v146
v_exp_f32 v235, v147
s_nop 1
v_add_f32 v224, v228, v232
v_add_f32 v224, v224, v233
v_add_f32 v224, v224, v234
v_add_f32 v224, v224, v235
v_cvt_pk_bf16_f32 v162, v232, v233
v_cvt_pk_bf16_f32 v163, v234, v235
v_exp_f32 v232, v148
v_exp_f32 v233, v149
v_exp_f32 v234, v150
v_exp_f32 v235, v151
s_nop 1
v_add_f32 v225, v229, v232
v_add_f32 v225, v225, v233
v_add_f32 v225, v225, v234
v_add_f32 v225, v225, v235
v_cvt_pk_bf16_f32 v166, v232, v233
v_cvt_pk_bf16_f32 v167, v234, v235
v_exp_f32 v232, v152
v_exp_f32 v233, v153
v_exp_f32 v234, v154
v_exp_f32 v235, v155
s_nop 1
v_add_f32 v226, v230, v232
v_add_f32 v226, v226, v233
v_add_f32 v226, v226, v234
v_add_f32 v226, v226, v235
v_cvt_pk_bf16_f32 v170, v232, v233
v_cvt_pk_bf16_f32 v171, v234, v235
v_exp_f32 v232, v156
v_exp_f32 v233, v157
v_exp_f32 v234, v158
v_exp_f32 v235, v159
s_nop 1
v_add_f32 v227, v231, v232
v_add_f32 v227, v227, v233
v_add_f32 v227, v227, v234
v_add_f32 v227, v227, v235
v_cvt_pk_bf16_f32 v174, v232, v233
v_cvt_pk_bf16_f32 v175, v234, v235
s_branch L2_rare_common
L2_rare_site4:
s_mov_b32 s36, 4
s_branch L2_rare_t0_0_0
L2_rare_t0_0_0:
s_nop 15
s_nop 15
s_waitcnt lgkmcnt(0)
v_log_f32 v243, v224
v_max3_f32 v232, v128, v129, v130
v_max3_f32 v232, v232, v131, v243
v_mov_b32 v243, v232
s_nop 1
v_permlane32_swap_b32 v232, v243
s_nop 1
v_max_f32 v232, v232, v243
v_mov_b32 v243, v232
s_nop 1
v_permlane16_swap_b32 v232, v243
s_nop 1
v_max_f32 v232, v232, v243
v_ceil_f32 v232, v232
v_max_f32 v232, 0, v232
v_sub_f32 v243, 0, v232
v_exp_f32 v236, v243
s_nop 1
v_mul_f32 v224, v224, v236
v_add_f32 v244, v244, v232
v_sub_f32 v192, v192, v232
v_sub_f32 v128, v128, v232
v_sub_f32 v144, v144, v232
v_sub_f32 v193, v193, v232
v_sub_f32 v129, v129, v232
v_sub_f32 v145, v145, v232
v_sub_f32 v194, v194, v232
v_sub_f32 v130, v130, v232
v_sub_f32 v146, v146, v232
v_sub_f32 v195, v195, v232
v_sub_f32 v131, v131, v232
v_sub_f32 v147, v147, v232
ds_read_b64 v[254:255], v253 offset:0
s_waitcnt lgkmcnt(0)
v_lshlrev_b32 v242, 16, v254
v_and_b32 v243, 0xffff0000, v254
v_mul_f32 v242, v242, v236
v_mul_f32 v243, v243, v236
v_cvt_pk_bf16_f32 v254, v242, v243
v_lshlrev_b32 v242, 16, v255
v_and_b32 v243, 0xffff0000, v255
v_mul_f32 v242, v242, v236
v_mul_f32 v243, v243, v236
v_cvt_pk_bf16_f32 v255, v242, v243
ds_write_b64 v253, v[254:255] offset:0
s_waitcnt lgkmcnt(0)
ds_read_b64 v[254:255], v253 offset:8
s_waitcnt lgkmcnt(0)
v_lshlrev_b32 v242, 16, v254
v_and_b32 v243, 0xffff0000, v254
v_mul_f32 v242, v242, v236
v_mul_f32 v243, v243, v236
v_cvt_pk_bf16_f32 v254, v242, v243
v_lshlrev_b32 v242, 16, v255
v_and_b32 v243, 0xffff0000, v255
v_mul_f32 v242, v242, v236
v_mul_f32 v243, v243, v236
v_cvt_pk_bf16_f32 v255, v242, v243
ds_write_b64 v253, v[254:255] offset:8
s_waitcnt lgkmcnt(0)
v_log_f32 v243, v225
v_max3_f32 v233, v132, v133, v134
v_max3_f32 v233, v233, v135, v243
v_mov_b32 v243, v233
s_nop 1
v_permlane32_swap_b32 v233, v243
s_nop 1
v_max_f32 v233, v233, v243
v_mov_b32 v243, v233
s_nop 1
v_permlane16_swap_b32 v233, v243
s_nop 1
v_max_f32 v233, v233, v243
v_ceil_f32 v233, v233
v_max_f32 v233, 0, v233
v_sub_f32 v243, 0, v233
v_exp_f32 v237, v243
s_nop 1
v_mul_f32 v225, v225, v237
v_add_f32 v245, v245, v233
v_sub_f32 v196, v196, v233
v_sub_f32 v132, v132, v233
v_sub_f32 v148, v148, v233
v_sub_f32 v197, v197, v233
v_sub_f32 v133, v133, v233
v_sub_f32 v149, v149, v233
v_sub_f32 v198, v198, v233
v_sub_f32 v134, v134, v233
v_sub_f32 v150, v150, v233
v_sub_f32 v199, v199, v233
v_sub_f32 v135, v135, v233
v_sub_f32 v151, v151, v233
ds_read_b64 v[254:255], v253 offset:1024
s_waitcnt lgkmcnt(0)
v_lshlrev_b32 v242, 16, v254
v_and_b32 v243, 0xffff0000, v254
v_mul_f32 v242, v242, v237
v_mul_f32 v243, v243, v237
v_cvt_pk_bf16_f32 v254, v242, v243
v_lshlrev_b32 v242, 16, v255
v_and_b32 v243, 0xffff0000, v255
v_mul_f32 v242, v242, v237
v_mul_f32 v243, v243, v237
v_cvt_pk_bf16_f32 v255, v242, v243
ds_write_b64 v253, v[254:255] offset:1024
s_waitcnt lgkmcnt(0)
ds_read_b64 v[254:255], v253 offset:1032
s_waitcnt lgkmcnt(0)
v_lshlrev_b32 v242, 16, v254
v_and_b32 v243, 0xffff0000, v254
v_mul_f32 v242, v242, v237
v_mul_f32 v243, v243, v237
v_cvt_pk_bf16_f32 v254, v242, v243
v_lshlrev_b32 v242, 16, v255
v_and_b32 v243, 0xffff0000, v255
v_mul_f32 v242, v242, v237
v_mul_f32 v243, v243, v237
v_cvt_pk_bf16_f32 v255, v242, v243
ds_write_b64 v253, v[254:255] offset:1032
s_waitcnt lgkmcnt(0)
v_log_f32 v243, v226
v_max3_f32 v234, v136, v137, v138
v_max3_f32 v234, v234, v139, v243
v_mov_b32 v243, v234
s_nop 1
v_permlane32_swap_b32 v234, v243
s_nop 1
v_max_f32 v234, v234, v243
v_mov_b32 v243, v234
s_nop 1
v_permlane16_swap_b32 v234, v243
s_nop 1
v_max_f32 v234, v234, v243
v_ceil_f32 v234, v234
v_max_f32 v234, 0, v234
v_sub_f32 v243, 0, v234
v_exp_f32 v238, v243
s_nop 1
v_mul_f32 v226, v226, v238
v_add_f32 v246, v246, v234
v_sub_f32 v200, v200, v234
v_sub_f32 v136, v136, v234
v_sub_f32 v152, v152, v234
v_sub_f32 v201, v201, v234
v_sub_f32 v137, v137, v234
v_sub_f32 v153, v153, v234
v_sub_f32 v202, v202, v234
v_sub_f32 v138, v138, v234
v_sub_f32 v154, v154, v234
v_sub_f32 v203, v203, v234
v_sub_f32 v139, v139, v234
v_sub_f32 v155, v155, v234
ds_read_b64 v[254:255], v253 offset:2048
s_waitcnt lgkmcnt(0)
v_lshlrev_b32 v242, 16, v254
v_and_b32 v243, 0xffff0000, v254
v_mul_f32 v242, v242, v238
v_mul_f32 v243, v243, v238
v_cvt_pk_bf16_f32 v254, v242, v243
v_lshlrev_b32 v242, 16, v255
v_and_b32 v243, 0xffff0000, v255
v_mul_f32 v242, v242, v238
v_mul_f32 v243, v243, v238
v_cvt_pk_bf16_f32 v255, v242, v243
ds_write_b64 v253, v[254:255] offset:2048
s_waitcnt lgkmcnt(0)
ds_read_b64 v[254:255], v253 offset:2056
s_waitcnt lgkmcnt(0)
v_lshlrev_b32 v242, 16, v254
v_and_b32 v243, 0xffff0000, v254
v_mul_f32 v242, v242, v238
v_mul_f32 v243, v243, v238
v_cvt_pk_bf16_f32 v254, v242, v243
v_lshlrev_b32 v242, 16, v255
v_and_b32 v243, 0xffff0000, v255
v_mul_f32 v242, v242, v238
v_mul_f32 v243, v243, v238
v_cvt_pk_bf16_f32 v255, v242, v243
ds_write_b64 v253, v[254:255] offset:2056
s_waitcnt lgkmcnt(0)
v_log_f32 v243, v227
v_max3_f32 v235, v140, v141, v142
v_max3_f32 v235, v235, v143, v243
v_mov_b32 v243, v235
s_nop 1
v_permlane32_swap_b32 v235, v243
s_nop 1
v_max_f32 v235, v235, v243
v_mov_b32 v243, v235
s_nop 1
v_permlane16_swap_b32 v235, v243
s_nop 1
v_max_f32 v235, v235, v243
v_ceil_f32 v235, v235
v_max_f32 v235, 0, v235
v_sub_f32 v243, 0, v235
v_exp_f32 v239, v243
s_nop 1
v_mul_f32 v227, v227, v239
v_add_f32 v247, v247, v235
v_sub_f32 v204, v204, v235
v_sub_f32 v140, v140, v235
v_sub_f32 v156, v156, v235
v_sub_f32 v205, v205, v235
v_sub_f32 v141, v141, v235
v_sub_f32 v157, v157, v235
v_sub_f32 v206, v206, v235
v_sub_f32 v142, v142, v235
v_sub_f32 v158, v158, v235
v_sub_f32 v207, v207, v235
v_sub_f32 v143, v143, v235
v_sub_f32 v159, v159, v235
ds_read_b64 v[254:255], v253 offset:3072
s_waitcnt lgkmcnt(0)
v_lshlrev_b32 v242, 16, v254
v_and_b32 v243, 0xffff0000, v254
v_mul_f32 v242, v242, v239
v_mul_f32 v243, v243, v239
v_cvt_pk_bf16_f32 v254, v242, v243
v_lshlrev_b32 v242, 16, v255
v_and_b32 v243, 0xffff0000, v255
v_mul_f32 v242, v242, v239
v_mul_f32 v243, v243, v239
v_cvt_pk_bf16_f32 v255, v242, v243
ds_write_b64 v253, v[254:255] offset:3072
s_waitcnt lgkmcnt(0)
ds_read_b64 v[254:255], v253 offset:3080
s_waitcnt lgkmcnt(0)
v_lshlrev_b32 v242, 16, v254
v_and_b32 v243, 0xffff0000, v254
v_mul_f32 v242, v242, v239
v_mul_f32 v243, v243, v239
v_cvt_pk_bf16_f32 v254, v242, v243
v_lshlrev_b32 v242, 16, v255
v_and_b32 v243, 0xffff0000, v255
v_mul_f32 v242, v242, v239
v_mul_f32 v243, v243, v239
v_cvt_pk_bf16_f32 v255, v242, v243
ds_write_b64 v253, v[254:255] offset:3080
s_waitcnt lgkmcnt(0)
v_exp_f32 v232, v128
v_exp_f32 v233, v129
v_exp_f32 v234, v130
v_exp_f32 v235, v131
s_nop 1
v_add_f32 v228, v224, v232
v_add_f32 v228, v228, v233
v_add_f32 v228, v228, v234
v_add_f32 v228, v228, v235
v_cvt_pk_bf16_f32 v176, v232, v233
v_cvt_pk_bf16_f32 v177, v234, v235
v_exp_f32 v232, v132
v_exp_f32 v233, v133
v_exp_f32 v234, v134
v_exp_f32 v235, v135
s_nop 1
v_add_f32 v229, v225, v232
v_add_f32 v229, v229, v233
v_add_f32 v229, v229, v234
v_add_f32 v229, v229, v235
v_cvt_pk_bf16_f32 v180, v232, v233
v_cvt_pk_bf16_f32 v181, v234, v235
v_exp_f32 v232, v136
v_exp_f32 v233, v137
v_exp_f32 v234, v138
v_exp_f32 v235, v139
s_nop 1
v_add_f32 v230, v226, v232
v_add_f32 v230, v230, v233
v_add_f32 v230, v230, v234
v_add_f32 v230, v230, v235
v_cvt_pk_bf16_f32 v184, v232, v233
v_cvt_pk_bf16_f32 v185, v234, v235
v_exp_f32 v232, v140
v_exp_f32 v233, v141
v_exp_f32 v234, v142
v_exp_f32 v235, v143
s_nop 1
v_add_f32 v231, v227, v232
v_add_f32 v231, v231, v233
v_add_f32 v231, v231, v234
v_add_f32 v231, v231, v235
v_cvt_pk_bf16_f32 v188, v232, v233
v_cvt_pk_bf16_f32 v189, v234, v235
s_branch L2_rare_common
L2_rare_site5:
s_mov_b32 s36, 5
s_branch L2_rare_t0_1_1
L2_rare_t0_1_1:
s_nop 15
s_nop 15
s_waitcnt lgkmcnt(0)
v_log_f32 v243, v228
v_max3_f32 v232, v144, v145, v146
v_max3_f32 v232, v232, v147, v243
v_mov_b32 v243, v232
s_nop 1
v_permlane32_swap_b32 v232, v243
s_nop 1
v_max_f32 v232, v232, v243
v_mov_b32 v243, v232
s_nop 1
v_permlane16_swap_b32 v232, v243
s_nop 1
v_max_f32 v232, v232, v243
v_ceil_f32 v232, v232
v_max_f32 v232, 0, v232
v_sub_f32 v243, 0, v232
v_exp_f32 v236, v243
s_nop 1
v_mul_f32 v228, v228, v236
v_add_f32 v244, v244, v232
v_sub_f32 v192, v192, v232
v_sub_f32 v128, v128, v232
v_sub_f32 v144, v144, v232
v_sub_f32 v193, v193, v232
v_sub_f32 v129, v129, v232
v_sub_f32 v145, v145, v232
v_sub_f32 v194, v194, v232
v_sub_f32 v130, v130, v232
v_sub_f32 v146, v146, v232
v_sub_f32 v195, v195, v232
v_sub_f32 v131, v131, v232
v_sub_f32 v147, v147, v232
v_lshlrev_b32 v242, 16, v176
v_and_b32 v243, 0xffff0000, v176
v_mul_f32 v242, v242, v236
v_mul_f32 v243, v243, v236
v_cvt_pk_bf16_f32 v176, v242, v243
v_lshlrev_b32 v242, 16, v177
v_and_b32 v243, 0xffff0000, v177
v_mul_f32 v242, v242, v236
v_mul_f32 v243, v243, v236
v_cvt_pk_bf16_f32 v177, v242, v243
ds_read_b64 v[254:255], v253 offset:0
s_waitcnt lgkmcnt(0)
v_lshlrev_b32 v242, 16, v254
v_and_b32 v243, 0xffff0000, v254
v_mul_f32 v242, v242, v236
v_mul_f32 v243, v243, v236
v_cvt_pk_bf16_f32 v254, v242, v243
v_lshlrev_b32 v242, 16, v255
v_and_b32 v243, 0xffff0000, v255
v_mul_f32 v242, v242, v236
v_mul_f32 v243, v243, v236
v_cvt_pk_bf16_f32 v255, v242, v243
ds_write_b64 v253, v[254:255] offset:0
s_waitcnt lgkmcnt(0)
ds_read_b64 v[254:255], v253 offset:8
s_waitcnt lgkmcnt(0)
v_lshlrev_b32 v242, 16, v254
v_and_b32 v243, 0xffff0000, v254
v_mul_f32 v242, v242, v236
v_mul_f32 v243, v243, v236
v_cvt_pk_bf16_f32 v254, v242, v243
v_lshlrev_b32 v242, 16, v255
v_and_b32 v243, 0xffff0000, v255
v_mul_f32 v242, v242, v236
v_mul_f32 v243, v243, v236
v_cvt_pk_bf16_f32 v255, v242, v243
ds_write_b64 v253, v[254:255] offset:8
s_waitcnt lgkmcnt(0)
v_log_f32 v243, v229
v_max3_f32 v233, v148, v149, v150
v_max3_f32 v233, v233, v151, v243
v_mov_b32 v243, v233
s_nop 1
v_permlane32_swap_b32 v233, v243
s_nop 1
v_max_f32 v233, v233, v243
v_mov_b32 v243, v233
s_nop 1
v_permlane16_swap_b32 v233, v243
s_nop 1
v_max_f32 v233, v233, v243
v_ceil_f32 v233, v233
v_max_f32 v233, 0, v233
v_sub_f32 v243, 0, v233
v_exp_f32 v237, v243
s_nop 1
v_mul_f32 v229, v229, v237
v_add_f32 v245, v245, v233
v_sub_f32 v196, v196, v233
v_sub_f32 v132, v132, v233
v_sub_f32 v148, v148, v233
v_sub_f32 v197, v197, v233
v_sub_f32 v133, v133, v233
v_sub_f32 v149, v149, v233
v_sub_f32 v198, v198, v233
v_sub_f32 v134, v134, v233
v_sub_f32 v150, v150, v233
v_sub_f32 v199, v199, v233
v_sub_f32 v135, v135, v233
v_sub_f32 v151, v151, v233
v_lshlrev_b32 v242, 16, v180
v_and_b32 v243, 0xffff0000, v180
v_mul_f32 v242, v242, v237
v_mul_f32 v243, v243, v237
v_cvt_pk_bf16_f32 v180, v242, v243
v_lshlrev_b32 v242, 16, v181
v_and_b32 v243, 0xffff0000, v181
v_mul_f32 v242, v242, v237
v_mul_f32 v243, v243, v237
v_cvt_pk_bf16_f32 v181, v242, v243
ds_read_b64 v[254:255], v253 offset:1024
s_waitcnt lgkmcnt(0)
v_lshlrev_b32 v242, 16, v254
v_and_b32 v243, 0xffff0000, v254
v_mul_f32 v242, v242, v237
v_mul_f32 v243, v243, v237
v_cvt_pk_bf16_f32 v254, v242, v243
v_lshlrev_b32 v242, 16, v255
v_and_b32 v243, 0xffff0000, v255
v_mul_f32 v242, v242, v237
v_mul_f32 v243, v243, v237
v_cvt_pk_bf16_f32 v255, v242, v243
ds_write_b64 v253, v[254:255] offset:1024
s_waitcnt lgkmcnt(0)
ds_read_b64 v[254:255], v253 offset:1032
s_waitcnt lgkmcnt(0)
v_lshlrev_b32 v242, 16, v254
v_and_b32 v243, 0xffff0000, v254
v_mul_f32 v242, v242, v237
v_mul_f32 v243, v243, v237
v_cvt_pk_bf16_f32 v254, v242, v243
v_lshlrev_b32 v242, 16, v255
v_and_b32 v243, 0xffff0000, v255
v_mul_f32 v242, v242, v237
v_mul_f32 v243, v243, v237
v_cvt_pk_bf16_f32 v255, v242, v243
ds_write_b64 v253, v[254:255] offset:1032
s_waitcnt lgkmcnt(0)
v_log_f32 v243, v230
v_max3_f32 v234, v152, v153, v154
v_max3_f32 v234, v234, v155, v243
v_mov_b32 v243, v234
s_nop 1
v_permlane32_swap_b32 v234, v243
s_nop 1
v_max_f32 v234, v234, v243
v_mov_b32 v243, v234
s_nop 1
v_permlane16_swap_b32 v234, v243
s_nop 1
v_max_f32 v234, v234, v243
v_ceil_f32 v234, v234
v_max_f32 v234, 0, v234
v_sub_f32 v243, 0, v234
v_exp_f32 v238, v243
s_nop 1
v_mul_f32 v230, v230, v238
v_add_f32 v246, v246, v234
v_sub_f32 v200, v200, v234
v_sub_f32 v136, v136, v234
v_sub_f32 v152, v152, v234
v_sub_f32 v201, v201, v234
v_sub_f32 v137, v137, v234
v_sub_f32 v153, v153, v234
v_sub_f32 v202, v202, v234
v_sub_f32 v138, v138, v234
v_sub_f32 v154, v154, v234
v_sub_f32 v203, v203, v234
v_sub_f32 v139, v139, v234
v_sub_f32 v155, v155, v234
v_lshlrev_b32 v242, 16, v184
v_and_b32 v243, 0xffff0000, v184
v_mul_f32 v242, v242, v238
v_mul_f32 v243, v243, v238
v_cvt_pk_bf16_f32 v184, v242, v243
v_lshlrev_b32 v242, 16, v185
v_and_b32 v243, 0xffff0000, v185
v_mul_f32 v242, v242, v238
v_mul_f32 v243, v243, v238
v_cvt_pk_bf16_f32 v185, v242, v243
ds_read_b64 v[254:255], v253 offset:2048
s_waitcnt lgkmcnt(0)
v_lshlrev_b32 v242, 16, v254
v_and_b32 v243, 0xffff0000, v254
v_mul_f32 v242, v242, v238
v_mul_f32 v243, v243, v238
v_cvt_pk_bf16_f32 v254, v242, v243
v_lshlrev_b32 v242, 16, v255
v_and_b32 v243, 0xffff0000, v255
v_mul_f32 v242, v242, v238
v_mul_f32 v243, v243, v238
v_cvt_pk_bf16_f32 v255, v242, v243
ds_write_b64 v253, v[254:255] offset:2048
s_waitcnt lgkmcnt(0)
ds_read_b64 v[254:255], v253 offset:2056
s_waitcnt lgkmcnt(0)
v_lshlrev_b32 v242, 16, v254
v_and_b32 v243, 0xffff0000, v254
v_mul_f32 v242, v242, v238
v_mul_f32 v243, v243, v238
v_cvt_pk_bf16_f32 v254, v242, v243
v_lshlrev_b32 v242, 16, v255
v_and_b32 v243, 0xffff0000, v255
v_mul_f32 v242, v242, v238
v_mul_f32 v243, v243, v238
v_cvt_pk_bf16_f32 v255, v242, v243
ds_write_b64 v253, v[254:255] offset:2056
s_waitcnt lgkmcnt(0)
v_log_f32 v243, v231
v_max3_f32 v235, v156, v157, v158
v_max3_f32 v235, v235, v159, v243
v_mov_b32 v243, v235
s_nop 1
v_permlane32_swap_b32 v235, v243
s_nop 1
v_max_f32 v235, v235, v243
v_mov_b32 v243, v235
s_nop 1
v_permlane16_swap_b32 v235, v243
s_nop 1
v_max_f32 v235, v235, v243
v_ceil_f32 v235, v235
v_max_f32 v235, 0, v235
v_sub_f32 v243, 0, v235
v_exp_f32 v239, v243
s_nop 1
v_mul_f32 v231, v231, v239
v_add_f32 v247, v247, v235
v_sub_f32 v204, v204, v235
v_sub_f32 v140, v140, v235
v_sub_f32 v156, v156, v235
v_sub_f32 v205, v205, v235
v_sub_f32 v141, v141, v235
v_sub_f32 v157, v157, v235
v_sub_f32 v206, v206, v235
v_sub_f32 v142, v142, v235
v_sub_f32 v158, v158, v235
v_sub_f32 v207, v207, v235
v_sub_f32 v143, v143, v235
v_sub_f32 v159, v159, v235
v_lshlrev_b32 v242, 16, v188
v_and_b32 v243, 0xffff0000, v188
v_mul_f32 v242, v242, v239
v_mul_f32 v243, v243, v239
v_cvt_pk_bf16_f32 v188, v242, v243
v_lshlrev_b32 v242, 16, v189
v_and_b32 v243, 0xffff0000, v189
v_mul_f32 v242, v242, v239
v_mul_f32 v243, v243, v239
v_cvt_pk_bf16_f32 v189, v242, v243
ds_read_b64 v[254:255], v253 offset:3072
s_waitcnt lgkmcnt(0)
v_lshlrev_b32 v242, 16, v254
v_and_b32 v243, 0xffff0000, v254
v_mul_f32 v242, v242, v239
v_mul_f32 v243, v243, v239
v_cvt_pk_bf16_f32 v254, v242, v243
v_lshlrev_b32 v242, 16, v255
v_and_b32 v243, 0xffff0000, v255
v_mul_f32 v242, v242, v239
v_mul_f32 v243, v243, v239
v_cvt_pk_bf16_f32 v255, v242, v243
ds_write_b64 v253, v[254:255] offset:3072
s_waitcnt lgkmcnt(0)
ds_read_b64 v[254:255], v253 offset:3080
s_waitcnt lgkmcnt(0)
v_lshlrev_b32 v242, 16, v254
v_and_b32 v243, 0xffff0000, v254
v_mul_f32 v242, v242, v239
v_mul_f32 v243, v243, v239
v_cvt_pk_bf16_f32 v254, v242, v243
v_lshlrev_b32 v242, 16, v255
v_and_b32 v243, 0xffff0000, v255
v_mul_f32 v242, v242, v239
v_mul_f32 v243, v243, v239
v_cvt_pk_bf16_f32 v255, v242, v243
ds_write_b64 v253, v[254:255] offset:3080
s_waitcnt lgkmcnt(0)
v_exp_f32 v232, v144
v_exp_f32 v233, v145
v_exp_f32 v234, v146
v_exp_f32 v235, v147
s_nop 1
v_add_f32 v224, v228, v232
v_add_f32 v224, v224, v233
v_add_f32 v224, v224, v234
v_add_f32 v224, v224, v235
v_cvt_pk_bf16_f32 v178, v232, v233
v_cvt_pk_bf16_f32 v179, v234, v235
v_exp_f32 v232, v148
v_exp_f32 v233, v149
v_exp_f32 v234, v150
v_exp_f32 v235, v151
s_nop 1
v_add_f32 v225, v229, v232
v_add_f32 v225, v225, v233
v_add_f32 v225, v225, v234
v_add_f32 v225, v225, v235
v_cvt_pk_bf16_f32 v182, v232, v233
v_cvt_pk_bf16_f32 v183, v234, v235
v_exp_f32 v232, v152
v_exp_f32 v233, v153
v_exp_f32 v234, v154
v_exp_f32 v235, v155
s_nop 1
v_add_f32 v226, v230, v232
v_add_f32 v226, v226, v233
v_add_f32 v226, v226, v234
v_add_f32 v226, v226, v235
v_cvt_pk_bf16_f32 v186, v232, v233
v_cvt_pk_bf16_f32 v187, v234, v235
v_exp_f32 v232, v156
v_exp_f32 v233, v157
v_exp_f32 v234, v158
v_exp_f32 v235, v159
s_nop 1
v_add_f32 v227, v231, v232
v_add_f32 v227, v227, v233
v_add_f32 v227, v227, v234
v_add_f32 v227, v227, v235
v_cvt_pk_bf16_f32 v190, v232, v233
v_cvt_pk_bf16_f32 v191, v234, v235
s_branch L2_rare_common
L2_rare_site6:
s_mov_b32 s36, 6
s_branch L2_rare_t0_2_0
L2_rare_t0_2_0:
s_nop 15
s_nop 15
s_waitcnt lgkmcnt(0)
v_log_f32 v243, v224
v_max3_f32 v232, v128, v129, v130
v_max3_f32 v232, v232, v131, v243
v_mov_b32 v243, v232
s_nop 1
v_permlane32_swap_b32 v232, v243
s_nop 1
v_max_f32 v232, v232, v243
v_mov_b32 v243, v232
s_nop 1
v_permlane16_swap_b32 v232, v243
s_nop 1
v_max_f32 v232, v232, v243
v_ceil_f32 v232, v232
v_max_f32 v232, 0, v232
v_sub_f32 v243, 0, v232
v_exp_f32 v236, v243
s_nop 1
v_mul_f32 v224, v224, v236
v_add_f32 v244, v244, v232
v_sub_f32 v192, v192, v232
v_sub_f32 v128, v128, v232
v_sub_f32 v144, v144, v232
v_sub_f32 v193, v193, v232
v_sub_f32 v129, v129, v232
v_sub_f32 v145, v145, v232
v_sub_f32 v194, v194, v232
v_sub_f32 v130, v130, v232
v_sub_f32 v146, v146, v232
v_sub_f32 v195, v195, v232
v_sub_f32 v131, v131, v232
v_sub_f32 v147, v147, v232
ds_read_b64 v[254:255], v253 offset:0
s_waitcnt lgkmcnt(0)
v_lshlrev_b32 v242, 16, v254
v_and_b32 v243, 0xffff0000, v254
v_mul_f32 v242, v242, v236
v_mul_f32 v243, v243, v236
v_cvt_pk_bf16_f32 v254, v242, v243
v_lshlrev_b32 v242, 16, v255
v_and_b32 v243, 0xffff0000, v255
v_mul_f32 v242, v242, v236
v_mul_f32 v243, v243, v236
v_cvt_pk_bf16_f32 v255, v242, v243
ds_write_b64 v253, v[254:255] offset:0
s_waitcnt lgkmcnt(0)
ds_read_b64 v[254:255], v253 offset:8
s_waitcnt lgkmcnt(0)
v_lshlrev_b32 v242, 16, v254
v_and_b32 v243, 0xffff0000, v254
v_mul_f32 v242, v242, v236
v_mul_f32 v243, v243, v236
v_cvt_pk_bf16_f32 v254, v242, v243
v_lshlrev_b32 v242, 16, v255
v_and_b32 v243, 0xffff0000, v255
v_mul_f32 v242, v242, v236
v_mul_f32 v243, v243, v236
v_cvt_pk_bf16_f32 v255, v242, v243
ds_write_b64 v253, v[254:255] offset:8
s_waitcnt lgkmcnt(0)
ds_read_b64 v[254:255], v253 offset:4096
s_waitcnt lgkmcnt(0)
v_lshlrev_b32 v242, 16, v254
v_and_b32 v243, 0xffff0000, v254
v_mul_f32 v242, v242, v236
v_mul_f32 v243, v243, v236
v_cvt_pk_bf16_f32 v254, v242, v243
v_lshlrev_b32 v242, 16, v255
v_and_b32 v243, 0xffff0000, v255
v_mul_f32 v242, v242, v236
v_mul_f32 v243, v243, v236
v_cvt_pk_bf16_f32 v255, v242, v243
ds_write_b64 v253, v[254:255] offset:4096
s_waitcnt lgkmcnt(0)
ds_read_b64 v[254:255], v253 offset:4104
s_waitcnt lgkmcnt(0)
v_lshlrev_b32 v242, 16, v254
v_and_b32 v243, 0xffff0000, v254
v_mul_f32 v242, v242, v236
v_mul_f32 v243, v243, v236
v_cvt_pk_bf16_f32 v254, v242, v243
v_lshlrev_b32 v242, 16, v255
v_and_b32 v243, 0xffff0000, v255
v_mul_f32 v242, v242, v236
v_mul_f32 v243, v243, v236
v_cvt_pk_bf16_f32 v255, v242, v243
ds_write_b64 v253, v[254:255] offset:4104
s_waitcnt lgkmcnt(0)
v_log_f32 v243, v225
v_max3_f32 v233, v132, v133, v134
v_max3_f32 v233, v233, v135, v243
v_mov_b32 v243, v233
s_nop 1
v_permlane32_swap_b32 v233, v243
s_nop 1
v_max_f32 v233, v233, v243
v_mov_b32 v243, v233
s_nop 1
v_permlane16_swap_b32 v233, v243
s_nop 1
v_max_f32 v233, v233, v243
v_ceil_f32 v233, v233
v_max_f32 v233, 0, v233
v_sub_f32 v243, 0, v233
v_exp_f32 v237, v243
s_nop 1
v_mul_f32 v225, v225, v237
v_add_f32 v245, v245, v233
v_sub_f32 v196, v196, v233
v_sub_f32 v132, v132, v233
v_sub_f32 v148, v148, v233
v_sub_f32 v197, v197, v233
v_sub_f32 v133, v133, v233
v_sub_f32 v149, v149, v233
v_sub_f32 v198, v198, v233
v_sub_f32 v134, v134, v233
v_sub_f32 v150, v150, v233
v_sub_f32 v199, v199, v233
v_sub_f32 v135, v135, v233
v_sub_f32 v151, v151, v233
ds_read_b64 v[254:255], v253 offset:1024
s_waitcnt lgkmcnt(0)
v_lshlrev_b32 v242, 16, v254
v_and_b32 v243, 0xffff0000, v254
v_mul_f32 v242, v242, v237
v_mul_f32 v243, v243, v237
v_cvt_pk_bf16_f32 v254, v242, v243
v_lshlrev_b32 v242, 16, v255
v_and_b32 v243, 0xffff0000, v255
v_mul_f32 v242, v242, v237
v_mul_f32 v243, v243, v237
v_cvt_pk_bf16_f32 v255, v242, v243
ds_write_b64 v253, v[254:255] offset:1024
s_waitcnt lgkmcnt(0)
ds_read_b64 v[254:255], v253 offset:1032
s_waitcnt lgkmcnt(0)
v_lshlrev_b32 v242, 16, v254
v_and_b32 v243, 0xffff0000, v254
v_mul_f32 v242, v242, v237
v_mul_f32 v243, v243, v237
v_cvt_pk_bf16_f32 v254, v242, v243
v_lshlrev_b32 v242, 16, v255
v_and_b32 v243, 0xffff0000, v255
v_mul_f32 v242, v242, v237
v_mul_f32 v243, v243, v237
v_cvt_pk_bf16_f32 v255, v242, v243
ds_write_b64 v253, v[254:255] offset:1032
s_waitcnt lgkmcnt(0)
ds_read_b64 v[254:255], v253 offset:5120
s_waitcnt lgkmcnt(0)
v_lshlrev_b32 v242, 16, v254
v_and_b32 v243, 0xffff0000, v254
v_mul_f32 v242, v242, v237
v_mul_f32 v243, v243, v237
v_cvt_pk_bf16_f32 v254, v242, v243
v_lshlrev_b32 v242, 16, v255
v_and_b32 v243, 0xffff0000, v255
v_mul_f32 v242, v242, v237
v_mul_f32 v243, v243, v237
v_cvt_pk_bf16_f32 v255, v242, v243
ds_write_b64 v253, v[254:255] offset:5120
s_waitcnt lgkmcnt(0)
ds_read_b64 v[254:255], v253 offset:5128
s_waitcnt lgkmcnt(0)
v_lshlrev_b32 v242, 16, v254
v_and_b32 v243, 0xffff0000, v254
v_mul_f32 v242, v242, v237
v_mul_f32 v243, v243, v237
v_cvt_pk_bf16_f32 v254, v242, v243
v_lshlrev_b32 v242, 16, v255
v_and_b32 v243, 0xffff0000, v255
v_mul_f32 v242, v242, v237
v_mul_f32 v243, v243, v237
v_cvt_pk_bf16_f32 v255, v242, v243
ds_write_b64 v253, v[254:255] offset:5128
s_waitcnt lgkmcnt(0)
v_log_f32 v243, v226
v_max3_f32 v234, v136, v137, v138
v_max3_f32 v234, v234, v139, v243
v_mov_b32 v243, v234
s_nop 1
v_permlane32_swap_b32 v234, v243
s_nop 1
v_max_f32 v234, v234, v243
v_mov_b32 v243, v234
s_nop 1
v_permlane16_swap_b32 v234, v243
s_nop 1
v_max_f32 v234, v234, v243
v_ceil_f32 v234, v234
v_max_f32 v234, 0, v234
v_sub_f32 v243, 0, v234
v_exp_f32 v238, v243
s_nop 1
v_mul_f32 v226, v226, v238
v_add_f32 v246, v246, v234
v_sub_f32 v200, v200, v234
v_sub_f32 v136, v136, v234
v_sub_f32 v152, v152, v234
v_sub_f32 v201, v201, v234
v_sub_f32 v137, v137, v234
v_sub_f32 v153, v153, v234
v_sub_f32 v202, v202, v234
v_sub_f32 v138, v138, v234
v_sub_f32 v154, v154, v234
v_sub_f32 v203, v203, v234
v_sub_f32 v139, v139, v234
v_sub_f32 v155, v155, v234
ds_read_b64 v[254:255], v253 offset:2048
s_waitcnt lgkmcnt(0)
v_lshlrev_b32 v242, 16, v254
v_and_b32 v243, 0xffff0000, v254
v_mul_f32 v242, v242, v238
v_mul_f32 v243, v243, v238
v_cvt_pk_bf16_f32 v254, v242, v243
v_lshlrev_b32 v242, 16, v255
v_and_b32 v243, 0xffff0000, v255
v_mul_f32 v242, v242, v238
v_mul_f32 v243, v243, v238
v_cvt_pk_bf16_f32 v255, v242, v243
ds_write_b64 v253, v[254:255] offset:2048
s_waitcnt lgkmcnt(0)
ds_read_b64 v[254:255], v253 offset:2056
s_waitcnt lgkmcnt(0)
v_lshlrev_b32 v242, 16, v254
v_and_b32 v243, 0xffff0000, v254
v_mul_f32 v242, v242, v238
v_mul_f32 v243, v243, v238
v_cvt_pk_bf16_f32 v254, v242, v243
v_lshlrev_b32 v242, 16, v255
v_and_b32 v243, 0xffff0000, v255
v_mul_f32 v242, v242, v238
v_mul_f32 v243, v243, v238
v_cvt_pk_bf16_f32 v255, v242, v243
ds_write_b64 v253, v[254:255] offset:2056
s_waitcnt lgkmcnt(0)
ds_read_b64 v[254:255], v253 offset:6144
s_waitcnt lgkmcnt(0)
v_lshlrev_b32 v242, 16, v254
v_and_b32 v243, 0xffff0000, v254
v_mul_f32 v242, v242, v238
v_mul_f32 v243, v243, v238
v_cvt_pk_bf16_f32 v254, v242, v243
v_lshlrev_b32 v242, 16, v255
v_and_b32 v243, 0xffff0000, v255
v_mul_f32 v242, v242, v238
v_mul_f32 v243, v243, v238
v_cvt_pk_bf16_f32 v255, v242, v243
ds_write_b64 v253, v[254:255] offset:6144
s_waitcnt lgkmcnt(0)
ds_read_b64 v[254:255], v253 offset:6152
s_waitcnt lgkmcnt(0)
v_lshlrev_b32 v242, 16, v254
v_and_b32 v243, 0xffff0000, v254
v_mul_f32 v242, v242, v238
v_mul_f32 v243, v243, v238
v_cvt_pk_bf16_f32 v254, v242, v243
v_lshlrev_b32 v242, 16, v255
v_and_b32 v243, 0xffff0000, v255
v_mul_f32 v242, v242, v238
v_mul_f32 v243, v243, v238
v_cvt_pk_bf16_f32 v255, v242, v243
ds_write_b64 v253, v[254:255] offset:6152
s_waitcnt lgkmcnt(0)
v_log_f32 v243, v227
v_max3_f32 v235, v140, v141, v142
v_max3_f32 v235, v235, v143, v243
v_mov_b32 v243, v235
s_nop 1
v_permlane32_swap_b32 v235, v243
s_nop 1
v_max_f32 v235, v235, v243
v_mov_b32 v243, v235
s_nop 1
v_permlane16_swap_b32 v235, v243
s_nop 1
v_max_f32 v235, v235, v243
v_ceil_f32 v235, v235
v_max_f32 v235, 0, v235
v_sub_f32 v243, 0, v235
v_exp_f32 v239, v243
s_nop 1
v_mul_f32 v227, v227, v239
v_add_f32 v247, v247, v235
v_sub_f32 v204, v204, v235
v_sub_f32 v140, v140, v235
v_sub_f32 v156, v156, v235
v_sub_f32 v205, v205, v235
v_sub_f32 v141, v141, v235
v_sub_f32 v157, v157, v235
v_sub_f32 v206, v206, v235
v_sub_f32 v142, v142, v235
v_sub_f32 v158, v158, v235
v_sub_f32 v207, v207, v235
v_sub_f32 v143, v143, v235
v_sub_f32 v159, v159, v235
ds_read_b64 v[254:255], v253 offset:3072
s_waitcnt lgkmcnt(0)
v_lshlrev_b32 v242, 16, v254
v_and_b32 v243, 0xffff0000, v254
v_mul_f32 v242, v242, v239
v_mul_f32 v243, v243, v239
v_cvt_pk_bf16_f32 v254, v242, v243
v_lshlrev_b32 v242, 16, v255
v_and_b32 v243, 0xffff0000, v255
v_mul_f32 v242, v242, v239
v_mul_f32 v243, v243, v239
v_cvt_pk_bf16_f32 v255, v242, v243
ds_write_b64 v253, v[254:255] offset:3072
s_waitcnt lgkmcnt(0)
ds_read_b64 v[254:255], v253 offset:3080
s_waitcnt lgkmcnt(0)
v_lshlrev_b32 v242, 16, v254
v_and_b32 v243, 0xffff0000, v254
v_mul_f32 v242, v242, v239
v_mul_f32 v243, v243, v239
v_cvt_pk_bf16_f32 v254, v242, v243
v_lshlrev_b32 v242, 16, v255
v_and_b32 v243, 0xffff0000, v255
v_mul_f32 v242, v242, v239
v_mul_f32 v243, v243, v239
v_cvt_pk_bf16_f32 v255, v242, v243
ds_write_b64 v253, v[254:255] offset:3080
s_waitcnt lgkmcnt(0)
ds_read_b64 v[254:255], v253 offset:7168
s_waitcnt lgkmcnt(0)
v_lshlrev_b32 v242, 16, v254
v_and_b32 v243, 0xffff0000, v254
v_mul_f32 v242, v242, v239
v_mul_f32 v243, v243, v239
v_cvt_pk_bf16_f32 v254, v242, v243
v_lshlrev_b32 v242, 16, v255
v_and_b32 v243, 0xffff0000, v255
v_mul_f32 v242, v242, v239
v_mul_f32 v243, v243, v239
v_cvt_pk_bf16_f32 v255, v242, v243
ds_write_b64 v253, v[254:255] offset:7168
s_waitcnt lgkmcnt(0)
ds_read_b64 v[254:255], v253 offset:7176
s_waitcnt lgkmcnt(0)
v_lshlrev_b32 v242, 16, v254
v_and_b32 v243, 0xffff0000, v254
v_mul_f32 v242, v242, v239
v_mul_f32 v243, v243, v239
v_cvt_pk_bf16_f32 v254, v242, v243
v_lshlrev_b32 v242, 16, v255
v_and_b32 v243, 0xffff0000, v255
v_mul_f32 v242, v242, v239
v_mul_f32 v243, v243, v239
v_cvt_pk_bf16_f32 v255, v242, v243
ds_write_b64 v253, v[254:255] offset:7176
s_waitcnt lgkmcnt(0)
v_exp_f32 v232, v128
v_exp_f32 v233, v129
v_exp_f32 v234, v130
v_exp_f32 v235, v131
s_nop 1
v_add_f32 v228, v224, v232
v_add_f32 v228, v228, v233
v_add_f32 v228, v228, v234
v_add_f32 v228, v228, v235
v_cvt_pk_bf16_f32 v160, v232, v233
v_cvt_pk_bf16_f32 v161, v234, v235
v_exp_f32 v232, v132
v_exp_f32 v233, v133
v_exp_f32 v234, v134
v_exp_f32 v235, v135
s_nop 1
v_add_f32 v229, v225, v232
v_add_f32 v229, v229, v233
v_add_f32 v229, v229, v234
v_add_f32 v229, v229, v235
v_cvt_pk_bf16_f32 v164, v232, v233
v_cvt_pk_bf16_f32 v165, v234, v235
v_exp_f32 v232, v136
v_exp_f32 v233, v137
v_exp_f32 v234, v138
v_exp_f32 v235, v139
s_nop 1
v_add_f32 v230, v226, v232
v_add_f32 v230, v230, v233
v_add_f32 v230, v230, v234
v_add_f32 v230, v230, v235
v_cvt_pk_bf16_f32 v168, v232, v233
v_cvt_pk_bf16_f32 v169, v234, v235
v_exp_f32 v232, v140
v_exp_f32 v233, v141
v_exp_f32 v234, v142
v_exp_f32 v235, v143
s_nop 1
v_add_f32 v231, v227, v232
v_add_f32 v231, v231, v233
v_add_f32 v231, v231, v234
v_add_f32 v231, v231, v235
v_cvt_pk_bf16_f32 v172, v232, v233
v_cvt_pk_bf16_f32 v173, v234, v235
s_branch L2_rare_common
L2_rare_site7:
s_mov_b32 s36, 7
s_branch L2_rare_t0_3_1
L2_rare_t0_3_1:
s_nop 15
s_nop 15
s_waitcnt lgkmcnt(0)
v_log_f32 v243, v228
v_max3_f32 v232, v144, v145, v146
v_max3_f32 v232, v232, v147, v243
v_mov_b32 v243, v232
s_nop 1
v_permlane32_swap_b32 v232, v243
s_nop 1
v_max_f32 v232, v232, v243
v_mov_b32 v243, v232
s_nop 1
v_permlane16_swap_b32 v232, v243
s_nop 1
v_max_f32 v232, v232, v243
v_ceil_f32 v232, v232
v_max_f32 v232, 0, v232
v_sub_f32 v243, 0, v232
v_exp_f32 v236, v243
s_nop 1
v_mul_f32 v228, v228, v236
v_add_f32 v244, v244, v232
v_sub_f32 v192, v192, v232
v_sub_f32 v128, v128, v232
v_sub_f32 v144, v144, v232
v_sub_f32 v193, v193, v232
v_sub_f32 v129, v129, v232
v_sub_f32 v145, v145, v232
v_sub_f32 v194, v194, v232
v_sub_f32 v130, v130, v232
v_sub_f32 v146, v146, v232
v_sub_f32 v195, v195, v232
v_sub_f32 v131, v131, v232
v_sub_f32 v147, v147, v232
v_lshlrev_b32 v242, 16, v160
v_and_b32 v243, 0xffff0000, v160
v_mul_f32 v242, v242, v236
v_mul_f32 v243, v243, v236
v_cvt_pk_bf16_f32 v160, v242, v243
v_lshlrev_b32 v242, 16, v161
v_and_b32 v243, 0xffff0000, v161
v_mul_f32 v242, v242, v236
v_mul_f32 v243, v243, v236
v_cvt_pk_bf16_f32 v161, v242, v243
ds_read_b64 v[254:255], v253 offset:0
s_waitcnt lgkmcnt(0)
v_lshlrev_b32 v242, 16, v254
v_and_b32 v243, 0xffff0000, v254
v_mul_f32 v242, v242, v236
v_mul_f32 v243, v243, v236
v_cvt_pk_bf16_f32 v254, v242, v243
v_lshlrev_b32 v242, 16, v255
v_and_b32 v243, 0xffff0000, v255
v_mul_f32 v242, v242, v236
v_mul_f32 v243, v243, v236
v_cvt_pk_bf16_f32 v255, v242, v243
ds_write_b64 v253, v[254:255] offset:0
s_waitcnt lgkmcnt(0)
ds_read_b64 v[254:255], v253 offset:8
s_waitcnt lgkmcnt(0)
v_lshlrev_b32 v242, 16, v254
v_and_b32 v243, 0xffff0000, v254
v_mul_f32 v242, v242, v236
v_mul_f32 v243, v243, v236
v_cvt_pk_bf16_f32 v254, v242, v243
v_lshlrev_b32 v242, 16, v255
v_and_b32 v243, 0xffff0000, v255
v_mul_f32 v242, v242, v236
v_mul_f32 v243, v243, v236
v_cvt_pk_bf16_f32 v255, v242, v243
ds_write_b64 v253, v[254:255] offset:8
s_waitcnt lgkmcnt(0)
ds_read_b64 v[254:255], v253 offset:4096
s_waitcnt lgkmcnt(0)
v_lshlrev_b32 v242, 16, v254
v_and_b32 v243, 0xffff0000, v254
v_mul_f32 v242, v242, v236
v_mul_f32 v243, v243, v236
v_cvt_pk_bf16_f32 v254, v242, v243
v_lshlrev_b32 v242, 16, v255
v_and_b32 v243, 0xffff0000, v255
v_mul_f32 v242, v242, v236
v_mul_f32 v243, v243, v236
v_cvt_pk_bf16_f32 v255, v242, v243
ds_write_b64 v253, v[254:255] offset:4096
s_waitcnt lgkmcnt(0)
ds_read_b64 v[254:255], v253 offset:4104
s_waitcnt lgkmcnt(0)
v_lshlrev_b32 v242, 16, v254
v_and_b32 v243, 0xffff0000, v254
v_mul_f32 v242, v242, v236
v_mul_f32 v243, v243, v236
v_cvt_pk_bf16_f32 v254, v242, v243
v_lshlrev_b32 v242, 16, v255
v_and_b32 v243, 0xffff0000, v255
v_mul_f32 v242, v242, v236
v_mul_f32 v243, v243, v236
v_cvt_pk_bf16_f32 v255, v242, v243
ds_write_b64 v253, v[254:255] offset:4104
s_waitcnt lgkmcnt(0)
v_log_f32 v243, v229
v_max3_f32 v233, v148, v149, v150
v_max3_f32 v233, v233, v151, v243
v_mov_b32 v243, v233
s_nop 1
v_permlane32_swap_b32 v233, v243
s_nop 1
v_max_f32 v233, v233, v243
v_mov_b32 v243, v233
s_nop 1
v_permlane16_swap_b32 v233, v243
s_nop 1
v_max_f32 v233, v233, v243
v_ceil_f32 v233, v233
v_max_f32 v233, 0, v233
v_sub_f32 v243, 0, v233
v_exp_f32 v237, v243
s_nop 1
v_mul_f32 v229, v229, v237
v_add_f32 v245, v245, v233
v_sub_f32 v196, v196, v233
v_sub_f32 v132, v132, v233
v_sub_f32 v148, v148, v233
v_sub_f32 v197, v197, v233
v_sub_f32 v133, v133, v233
v_sub_f32 v149, v149, v233
v_sub_f32 v198, v198, v233
v_sub_f32 v134, v134, v233
v_sub_f32 v150, v150, v233
v_sub_f32 v199, v199, v233
v_sub_f32 v135, v135, v233
v_sub_f32 v151, v151, v233
v_lshlrev_b32 v242, 16, v164
v_and_b32 v243, 0xffff0000, v164
v_mul_f32 v242, v242, v237
v_mul_f32 v243, v243, v237
v_cvt_pk_bf16_f32 v164, v242, v243
v_lshlrev_b32 v242, 16, v165
v_and_b32 v243, 0xffff0000, v165
v_mul_f32 v242, v242, v237
v_mul_f32 v243, v243, v237
v_cvt_pk_bf16_f32 v165, v242, v243
ds_read_b64 v[254:255], v253 offset:1024
s_waitcnt lgkmcnt(0)
v_lshlrev_b32 v242, 16, v254
v_and_b32 v243, 0xffff0000, v254
v_mul_f32 v242, v242, v237
v_mul_f32 v243, v243, v237
v_cvt_pk_bf16_f32 v254, v242, v243
v_lshlrev_b32 v242, 16, v255
v_and_b32 v243, 0xffff0000, v255
v_mul_f32 v242, v242, v237
v_mul_f32 v243, v243, v237
v_cvt_pk_bf16_f32 v255, v242, v243
ds_write_b64 v253, v[254:255] offset:1024
s_waitcnt lgkmcnt(0)
ds_read_b64 v[254:255], v253 offset:1032
s_waitcnt lgkmcnt(0)
v_lshlrev_b32 v242, 16, v254
v_and_b32 v243, 0xffff0000, v254
v_mul_f32 v242, v242, v237
v_mul_f32 v243, v243, v237
v_cvt_pk_bf16_f32 v254, v242, v243
v_lshlrev_b32 v242, 16, v255
v_and_b32 v243, 0xffff0000, v255
v_mul_f32 v242, v242, v237
v_mul_f32 v243, v243, v237
v_cvt_pk_bf16_f32 v255, v242, v243
ds_write_b64 v253, v[254:255] offset:1032
s_waitcnt lgkmcnt(0)
ds_read_b64 v[254:255], v253 offset:5120
s_waitcnt lgkmcnt(0)
v_lshlrev_b32 v242, 16, v254
v_and_b32 v243, 0xffff0000, v254
v_mul_f32 v242, v242, v237
v_mul_f32 v243, v243, v237
v_cvt_pk_bf16_f32 v254, v242, v243
v_lshlrev_b32 v242, 16, v255
v_and_b32 v243, 0xffff0000, v255
v_mul_f32 v242, v242, v237
v_mul_f32 v243, v243, v237
v_cvt_pk_bf16_f32 v255, v242, v243
ds_write_b64 v253, v[254:255] offset:5120
s_waitcnt lgkmcnt(0)
ds_read_b64 v[254:255], v253 offset:5128
s_waitcnt lgkmcnt(0)
v_lshlrev_b32 v242, 16, v254
v_and_b32 v243, 0xffff0000, v254
v_mul_f32 v242, v242, v237
v_mul_f32 v243, v243, v237
v_cvt_pk_bf16_f32 v254, v242, v243
v_lshlrev_b32 v242, 16, v255
v_and_b32 v243, 0xffff0000, v255
v_mul_f32 v242, v242, v237
v_mul_f32 v243, v243, v237
v_cvt_pk_bf16_f32 v255, v242, v243
ds_write_b64 v253, v[254:255] offset:5128
s_waitcnt lgkmcnt(0)
v_log_f32 v243, v230
v_max3_f32 v234, v152, v153, v154
v_max3_f32 v234, v234, v155, v243
v_mov_b32 v243, v234
s_nop 1
v_permlane32_swap_b32 v234, v243
s_nop 1
v_max_f32 v234, v234, v243
v_mov_b32 v243, v234
s_nop 1
v_permlane16_swap_b32 v234, v243
s_nop 1
v_max_f32 v234, v234, v243
v_ceil_f32 v234, v234
v_max_f32 v234, 0, v234
v_sub_f32 v243, 0, v234
v_exp_f32 v238, v243
s_nop 1
v_mul_f32 v230, v230, v238
v_add_f32 v246, v246, v234
v_sub_f32 v200, v200, v234
v_sub_f32 v136, v136, v234
v_sub_f32 v152, v152, v234
v_sub_f32 v201, v201, v234
v_sub_f32 v137, v137, v234
v_sub_f32 v153, v153, v234
v_sub_f32 v202, v202, v234
v_sub_f32 v138, v138, v234
v_sub_f32 v154, v154, v234
v_sub_f32 v203, v203, v234
v_sub_f32 v139, v139, v234
v_sub_f32 v155, v155, v234
v_lshlrev_b32 v242, 16, v168
v_and_b32 v243, 0xffff0000, v168
v_mul_f32 v242, v242, v238
v_mul_f32 v243, v243, v238
v_cvt_pk_bf16_f32 v168, v242, v243
v_lshlrev_b32 v242, 16, v169
v_and_b32 v243, 0xffff0000, v169
v_mul_f32 v242, v242, v238
v_mul_f32 v243, v243, v238
v_cvt_pk_bf16_f32 v169, v242, v243
ds_read_b64 v[254:255], v253 offset:2048
s_waitcnt lgkmcnt(0)
v_lshlrev_b32 v242, 16, v254
v_and_b32 v243, 0xffff0000, v254
v_mul_f32 v242, v242, v238
v_mul_f32 v243, v243, v238
v_cvt_pk_bf16_f32 v254, v242, v243
v_lshlrev_b32 v242, 16, v255
v_and_b32 v243, 0xffff0000, v255
v_mul_f32 v242, v242, v238
v_mul_f32 v243, v243, v238
v_cvt_pk_bf16_f32 v255, v242, v243
ds_write_b64 v253, v[254:255] offset:2048
s_waitcnt lgkmcnt(0)
ds_read_b64 v[254:255], v253 offset:2056
s_waitcnt lgkmcnt(0)
v_lshlrev_b32 v242, 16, v254
v_and_b32 v243, 0xffff0000, v254
v_mul_f32 v242, v242, v238
v_mul_f32 v243, v243, v238
v_cvt_pk_bf16_f32 v254, v242, v243
v_lshlrev_b32 v242, 16, v255
v_and_b32 v243, 0xffff0000, v255
v_mul_f32 v242, v242, v238
v_mul_f32 v243, v243, v238
v_cvt_pk_bf16_f32 v255, v242, v243
ds_write_b64 v253, v[254:255] offset:2056
s_waitcnt lgkmcnt(0)
ds_read_b64 v[254:255], v253 offset:6144
s_waitcnt lgkmcnt(0)
v_lshlrev_b32 v242, 16, v254
v_and_b32 v243, 0xffff0000, v254
v_mul_f32 v242, v242, v238
v_mul_f32 v243, v243, v238
v_cvt_pk_bf16_f32 v254, v242, v243
v_lshlrev_b32 v242, 16, v255
v_and_b32 v243, 0xffff0000, v255
v_mul_f32 v242, v242, v238
v_mul_f32 v243, v243, v238
v_cvt_pk_bf16_f32 v255, v242, v243
ds_write_b64 v253, v[254:255] offset:6144
s_waitcnt lgkmcnt(0)
ds_read_b64 v[254:255], v253 offset:6152
s_waitcnt lgkmcnt(0)
v_lshlrev_b32 v242, 16, v254
v_and_b32 v243, 0xffff0000, v254
v_mul_f32 v242, v242, v238
v_mul_f32 v243, v243, v238
v_cvt_pk_bf16_f32 v254, v242, v243
v_lshlrev_b32 v242, 16, v255
v_and_b32 v243, 0xffff0000, v255
v_mul_f32 v242, v242, v238
v_mul_f32 v243, v243, v238
v_cvt_pk_bf16_f32 v255, v242, v243
ds_write_b64 v253, v[254:255] offset:6152
s_waitcnt lgkmcnt(0)
v_log_f32 v243, v231
v_max3_f32 v235, v156, v157, v158
v_max3_f32 v235, v235, v159, v243
v_mov_b32 v243, v235
s_nop 1
v_permlane32_swap_b32 v235, v243
s_nop 1
v_max_f32 v235, v235, v243
v_mov_b32 v243, v235
s_nop 1
v_permlane16_swap_b32 v235, v243
s_nop 1
v_max_f32 v235, v235, v243
v_ceil_f32 v235, v235
v_max_f32 v235, 0, v235
v_sub_f32 v243, 0, v235
v_exp_f32 v239, v243
s_nop 1
v_mul_f32 v231, v231, v239
v_add_f32 v247, v247, v235
v_sub_f32 v204, v204, v235
v_sub_f32 v140, v140, v235
v_sub_f32 v156, v156, v235
v_sub_f32 v205, v205, v235
v_sub_f32 v141, v141, v235
v_sub_f32 v157, v157, v235
v_sub_f32 v206, v206, v235
v_sub_f32 v142, v142, v235
v_sub_f32 v158, v158, v235
v_sub_f32 v207, v207, v235
v_sub_f32 v143, v143, v235
v_sub_f32 v159, v159, v235
v_lshlrev_b32 v242, 16, v172
v_and_b32 v243, 0xffff0000, v172
v_mul_f32 v242, v242, v239
v_mul_f32 v243, v243, v239
v_cvt_pk_bf16_f32 v172, v242, v243
v_lshlrev_b32 v242, 16, v173
v_and_b32 v243, 0xffff0000, v173
v_mul_f32 v242, v242, v239
v_mul_f32 v243, v243, v239
v_cvt_pk_bf16_f32 v173, v242, v243
ds_read_b64 v[254:255], v253 offset:3072
s_waitcnt lgkmcnt(0)
v_lshlrev_b32 v242, 16, v254
v_and_b32 v243, 0xffff0000, v254
v_mul_f32 v242, v242, v239
v_mul_f32 v243, v243, v239
v_cvt_pk_bf16_f32 v254, v242, v243
v_lshlrev_b32 v242, 16, v255
v_and_b32 v243, 0xffff0000, v255
v_mul_f32 v242, v242, v239
v_mul_f32 v243, v243, v239
v_cvt_pk_bf16_f32 v255, v242, v243
ds_write_b64 v253, v[254:255] offset:3072
s_waitcnt lgkmcnt(0)
ds_read_b64 v[254:255], v253 offset:3080
s_waitcnt lgkmcnt(0)
v_lshlrev_b32 v242, 16, v254
v_and_b32 v243, 0xffff0000, v254
v_mul_f32 v242, v242, v239
v_mul_f32 v243, v243, v239
v_cvt_pk_bf16_f32 v254, v242, v243
v_lshlrev_b32 v242, 16, v255
v_and_b32 v243, 0xffff0000, v255
v_mul_f32 v242, v242, v239
v_mul_f32 v243, v243, v239
v_cvt_pk_bf16_f32 v255, v242, v243
ds_write_b64 v253, v[254:255] offset:3080
s_waitcnt lgkmcnt(0)
ds_read_b64 v[254:255], v253 offset:7168
s_waitcnt lgkmcnt(0)
v_lshlrev_b32 v242, 16, v254
v_and_b32 v243, 0xffff0000, v254
v_mul_f32 v242, v242, v239
v_mul_f32 v243, v243, v239
v_cvt_pk_bf16_f32 v254, v242, v243
v_lshlrev_b32 v242, 16, v255
v_and_b32 v243, 0xffff0000, v255
v_mul_f32 v242, v242, v239
v_mul_f32 v243, v243, v239
v_cvt_pk_bf16_f32 v255, v242, v243
ds_write_b64 v253, v[254:255] offset:7168
s_waitcnt lgkmcnt(0)
ds_read_b64 v[254:255], v253 offset:7176
s_waitcnt lgkmcnt(0)
v_lshlrev_b32 v242, 16, v254
v_and_b32 v243, 0xffff0000, v254
v_mul_f32 v242, v242, v239
v_mul_f32 v243, v243, v239
v_cvt_pk_bf16_f32 v254, v242, v243
v_lshlrev_b32 v242, 16, v255
v_and_b32 v243, 0xffff0000, v255
v_mul_f32 v242, v242, v239
v_mul_f32 v243, v243, v239
v_cvt_pk_bf16_f32 v255, v242, v243
ds_write_b64 v253, v[254:255] offset:7176
s_waitcnt lgkmcnt(0)
v_exp_f32 v232, v144
v_exp_f32 v233, v145
v_exp_f32 v234, v146
v_exp_f32 v235, v147
s_nop 1
v_add_f32 v224, v228, v232
v_add_f32 v224, v224, v233
v_add_f32 v224, v224, v234
v_add_f32 v224, v224, v235
v_cvt_pk_bf16_f32 v162, v232, v233
v_cvt_pk_bf16_f32 v163, v234, v235
v_exp_f32 v232, v148
v_exp_f32 v233, v149
v_exp_f32 v234, v150
v_exp_f32 v235, v151
s_nop 1
v_add_f32 v225, v229, v232
v_add_f32 v225, v225, v233
v_add_f32 v225, v225, v234
v_add_f32 v225, v225, v235
v_cvt_pk_bf16_f32 v166, v232, v233
v_cvt_pk_bf16_f32 v167, v234, v235
v_exp_f32 v232, v152
v_exp_f32 v233, v153
v_exp_f32 v234, v154
v_exp_f32 v235, v155
s_nop 1
v_add_f32 v226, v230, v232
v_add_f32 v226, v226, v233
v_add_f32 v226, v226, v234
v_add_f32 v226, v226, v235
v_cvt_pk_bf16_f32 v170, v232, v233
v_cvt_pk_bf16_f32 v171, v234, v235
v_exp_f32 v232, v156
v_exp_f32 v233, v157
v_exp_f32 v234, v158
v_exp_f32 v235, v159
s_nop 1
v_add_f32 v227, v231, v232
v_add_f32 v227, v227, v233
v_add_f32 v227, v227, v234
v_add_f32 v227, v227, v235
v_cvt_pk_bf16_f32 v174, v232, v233
v_cvt_pk_bf16_f32 v175, v234, v235
s_branch L2_rare_common
L2_rare_site8:
s_mov_b32 s36, 8
s_branch L2_rare_t0_4_0
L2_rare_t0_4_0:
s_nop 15
s_nop 15
s_waitcnt lgkmcnt(0)
v_log_f32 v243, v224
v_max3_f32 v232, v128, v129, v130
v_max3_f32 v232, v232, v131, v243
v_mov_b32 v243, v232
s_nop 1
v_permlane32_swap_b32 v232, v243
s_nop 1
v_max_f32 v232, v232, v243
v_mov_b32 v243, v232
s_nop 1
v_permlane16_swap_b32 v232, v243
s_nop 1
v_max_f32 v232, v232, v243
v_ceil_f32 v232, v232
v_max_f32 v232, 0, v232
v_sub_f32 v243, 0, v232
v_exp_f32 v236, v243
s_nop 1
v_mul_f32 v224, v224, v236
v_add_f32 v244, v244, v232
v_sub_f32 v192, v192, v232
v_sub_f32 v128, v128, v232
v_sub_f32 v144, v144, v232
v_sub_f32 v193, v193, v232
v_sub_f32 v129, v129, v232
v_sub_f32 v145, v145, v232
v_sub_f32 v194, v194, v232
v_sub_f32 v130, v130, v232
v_sub_f32 v146, v146, v232
v_sub_f32 v195, v195, v232
v_sub_f32 v131, v131, v232
v_sub_f32 v147, v147, v232
v_lshlrev_b32 v242, 16, v160
v_and_b32 v243, 0xffff0000, v160
v_mul_f32 v242, v242, v236
v_mul_f32 v243, v243, v236
v_cvt_pk_bf16_f32 v160, v242, v243
v_lshlrev_b32 v242, 16, v161
v_and_b32 v243, 0xffff0000, v161
v_mul_f32 v242, v242, v236
v_mul_f32 v243, v243, v236
v_cvt_pk_bf16_f32 v161, v242, v243
v_lshlrev_b32 v242, 16, v162
v_and_b32 v243, 0xffff0000, v162
v_mul_f32 v242, v242, v236
v_mul_f32 v243, v243, v236
v_cvt_pk_bf16_f32 v162, v242, v243
v_lshlrev_b32 v242, 16, v163
v_and_b32 v243, 0xffff0000, v163
v_mul_f32 v242, v242, v236
v_mul_f32 v243, v243, v236
v_cvt_pk_bf16_f32 v163, v242, v243
ds_read_b64 v[254:255], v253 offset:0
s_waitcnt lgkmcnt(0)
v_lshlrev_b32 v242, 16, v254
v_and_b32 v243, 0xffff0000, v254
v_mul_f32 v242, v242, v236
v_mul_f32 v243, v243, v236
v_cvt_pk_bf16_f32 v254, v242, v243
v_lshlrev_b32 v242, 16, v255
v_and_b32 v243, 0xffff0000, v255
v_mul_f32 v242, v242, v236
v_mul_f32 v243, v243, v236
v_cvt_pk_bf16_f32 v255, v242, v243
ds_write_b64 v253, v[254:255] offset:0
s_waitcnt lgkmcnt(0)
ds_read_b64 v[254:255], v253 offset:8
s_waitcnt lgkmcnt(0)
v_lshlrev_b32 v242, 16, v254
v_and_b32 v243, 0xffff0000, v254
v_mul_f32 v242, v242, v236
v_mul_f32 v243, v243, v236
v_cvt_pk_bf16_f32 v254, v242, v243
v_lshlrev_b32 v242, 16, v255
v_and_b32 v243, 0xffff0000, v255
v_mul_f32 v242, v242, v236
v_mul_f32 v243, v243, v236
v_cvt_pk_bf16_f32 v255, v242, v243
ds_write_b64 v253, v[254:255] offset:8
s_waitcnt lgkmcnt(0)
ds_read_b64 v[254:255], v253 offset:4096
s_waitcnt lgkmcnt(0)
v_lshlrev_b32 v242, 16, v254
v_and_b32 v243, 0xffff0000, v254
v_mul_f32 v242, v242, v236
v_mul_f32 v243, v243, v236
v_cvt_pk_bf16_f32 v254, v242, v243
v_lshlrev_b32 v242, 16, v255
v_and_b32 v243, 0xffff0000, v255
v_mul_f32 v242, v242, v236
v_mul_f32 v243, v243, v236
v_cvt_pk_bf16_f32 v255, v242, v243
ds_write_b64 v253, v[254:255] offset:4096
s_waitcnt lgkmcnt(0)
ds_read_b64 v[254:255], v253 offset:4104
s_waitcnt lgkmcnt(0)
v_lshlrev_b32 v242, 16, v254
v_and_b32 v243, 0xffff0000, v254
v_mul_f32 v242, v242, v236
v_mul_f32 v243, v243, v236
v_cvt_pk_bf16_f32 v254, v242, v243
v_lshlrev_b32 v242, 16, v255
v_and_b32 v243, 0xffff0000, v255
v_mul_f32 v242, v242, v236
v_mul_f32 v243, v243, v236
v_cvt_pk_bf16_f32 v255, v242, v243
ds_write_b64 v253, v[254:255] offset:4104
s_waitcnt lgkmcnt(0)
v_log_f32 v243, v225
v_max3_f32 v233, v132, v133, v134
v_max3_f32 v233, v233, v135, v243
v_mov_b32 v243, v233
s_nop 1
v_permlane32_swap_b32 v233, v243
s_nop 1
v_max_f32 v233, v233, v243
v_mov_b32 v243, v233
s_nop 1
v_permlane16_swap_b32 v233, v243
s_nop 1
v_max_f32 v233, v233, v243
v_ceil_f32 v233, v233
v_max_f32 v233, 0, v233
v_sub_f32 v243, 0, v233
v_exp_f32 v237, v243
s_nop 1
v_mul_f32 v225, v225, v237
v_add_f32 v245, v245, v233
v_sub_f32 v196, v196, v233
v_sub_f32 v132, v132, v233
v_sub_f32 v148, v148, v233
v_sub_f32 v197, v197, v233
v_sub_f32 v133, v133, v233
v_sub_f32 v149, v149, v233
v_sub_f32 v198, v198, v233
v_sub_f32 v134, v134, v233
v_sub_f32 v150, v150, v233
v_sub_f32 v199, v199, v233
v_sub_f32 v135, v135, v233
v_sub_f32 v151, v151, v233
v_lshlrev_b32 v242, 16, v164
v_and_b32 v243, 0xffff0000, v164
v_mul_f32 v242, v242, v237
v_mul_f32 v243, v243, v237
v_cvt_pk_bf16_f32 v164, v242, v243
v_lshlrev_b32 v242, 16, v165
v_and_b32 v243, 0xffff0000, v165
v_mul_f32 v242, v242, v237
v_mul_f32 v243, v243, v237
v_cvt_pk_bf16_f32 v165, v242, v243
v_lshlrev_b32 v242, 16, v166
v_and_b32 v243, 0xffff0000, v166
v_mul_f32 v242, v242, v237
v_mul_f32 v243, v243, v237
v_cvt_pk_bf16_f32 v166, v242, v243
v_lshlrev_b32 v242, 16, v167
v_and_b32 v243, 0xffff0000, v167
v_mul_f32 v242, v242, v237
v_mul_f32 v243, v243, v237
v_cvt_pk_bf16_f32 v167, v242, v243
ds_read_b64 v[254:255], v253 offset:1024
s_waitcnt lgkmcnt(0)
v_lshlrev_b32 v242, 16, v254
v_and_b32 v243, 0xffff0000, v254
v_mul_f32 v242, v242, v237
v_mul_f32 v243, v243, v237
v_cvt_pk_bf16_f32 v254, v242, v243
v_lshlrev_b32 v242, 16, v255
v_and_b32 v243, 0xffff0000, v255
v_mul_f32 v242, v242, v237
v_mul_f32 v243, v243, v237
v_cvt_pk_bf16_f32 v255, v242, v243
ds_write_b64 v253, v[254:255] offset:1024
s_waitcnt lgkmcnt(0)
ds_read_b64 v[254:255], v253 offset:1032
s_waitcnt lgkmcnt(0)
v_lshlrev_b32 v242, 16, v254
v_and_b32 v243, 0xffff0000, v254
v_mul_f32 v242, v242, v237
v_mul_f32 v243, v243, v237
v_cvt_pk_bf16_f32 v254, v242, v243
v_lshlrev_b32 v242, 16, v255
v_and_b32 v243, 0xffff0000, v255
v_mul_f32 v242, v242, v237
v_mul_f32 v243, v243, v237
v_cvt_pk_bf16_f32 v255, v242, v243
ds_write_b64 v253, v[254:255] offset:1032
s_waitcnt lgkmcnt(0)
ds_read_b64 v[254:255], v253 offset:5120
s_waitcnt lgkmcnt(0)
v_lshlrev_b32 v242, 16, v254
v_and_b32 v243, 0xffff0000, v254
v_mul_f32 v242, v242, v237
v_mul_f32 v243, v243, v237
v_cvt_pk_bf16_f32 v254, v242, v243
v_lshlrev_b32 v242, 16, v255
v_and_b32 v243, 0xffff0000, v255
v_mul_f32 v242, v242, v237
v_mul_f32 v243, v243, v237
v_cvt_pk_bf16_f32 v255, v242, v243
ds_write_b64 v253, v[254:255] offset:5120
s_waitcnt lgkmcnt(0)
ds_read_b64 v[254:255], v253 offset:5128
s_waitcnt lgkmcnt(0)
v_lshlrev_b32 v242, 16, v254
v_and_b32 v243, 0xffff0000, v254
v_mul_f32 v242, v242, v237
v_mul_f32 v243, v243, v237
v_cvt_pk_bf16_f32 v254, v242, v243
v_lshlrev_b32 v242, 16, v255
v_and_b32 v243, 0xffff0000, v255
v_mul_f32 v242, v242, v237
v_mul_f32 v243, v243, v237
v_cvt_pk_bf16_f32 v255, v242, v243
ds_write_b64 v253, v[254:255] offset:5128
s_waitcnt lgkmcnt(0)
v_log_f32 v243, v226
v_max3_f32 v234, v136, v137, v138
v_max3_f32 v234, v234, v139, v243
v_mov_b32 v243, v234
s_nop 1
v_permlane32_swap_b32 v234, v243
s_nop 1
v_max_f32 v234, v234, v243
v_mov_b32 v243, v234
s_nop 1
v_permlane16_swap_b32 v234, v243
s_nop 1
v_max_f32 v234, v234, v243
v_ceil_f32 v234, v234
v_max_f32 v234, 0, v234
v_sub_f32 v243, 0, v234
v_exp_f32 v238, v243
s_nop 1
v_mul_f32 v226, v226, v238
v_add_f32 v246, v246, v234
v_sub_f32 v200, v200, v234
v_sub_f32 v136, v136, v234
v_sub_f32 v152, v152, v234
v_sub_f32 v201, v201, v234
v_sub_f32 v137, v137, v234
v_sub_f32 v153, v153, v234
v_sub_f32 v202, v202, v234
v_sub_f32 v138, v138, v234
v_sub_f32 v154, v154, v234
v_sub_f32 v203, v203, v234
v_sub_f32 v139, v139, v234
v_sub_f32 v155, v155, v234
v_lshlrev_b32 v242, 16, v168
v_and_b32 v243, 0xffff0000, v168
v_mul_f32 v242, v242, v238
v_mul_f32 v243, v243, v238
v_cvt_pk_bf16_f32 v168, v242, v243
v_lshlrev_b32 v242, 16, v169
v_and_b32 v243, 0xffff0000, v169
v_mul_f32 v242, v242, v238
v_mul_f32 v243, v243, v238
v_cvt_pk_bf16_f32 v169, v242, v243
v_lshlrev_b32 v242, 16, v170
v_and_b32 v243, 0xffff0000, v170
v_mul_f32 v242, v242, v238
v_mul_f32 v243, v243, v238
v_cvt_pk_bf16_f32 v170, v242, v243
v_lshlrev_b32 v242, 16, v171
v_and_b32 v243, 0xffff0000, v171
v_mul_f32 v242, v242, v238
v_mul_f32 v243, v243, v238
v_cvt_pk_bf16_f32 v171, v242, v243
ds_read_b64 v[254:255], v253 offset:2048
s_waitcnt lgkmcnt(0)
v_lshlrev_b32 v242, 16, v254
v_and_b32 v243, 0xffff0000, v254
v_mul_f32 v242, v242, v238
v_mul_f32 v243, v243, v238
v_cvt_pk_bf16_f32 v254, v242, v243
v_lshlrev_b32 v242, 16, v255
v_and_b32 v243, 0xffff0000, v255
v_mul_f32 v242, v242, v238
v_mul_f32 v243, v243, v238
v_cvt_pk_bf16_f32 v255, v242, v243
ds_write_b64 v253, v[254:255] offset:2048
s_waitcnt lgkmcnt(0)
ds_read_b64 v[254:255], v253 offset:2056
s_waitcnt lgkmcnt(0)
v_lshlrev_b32 v242, 16, v254
v_and_b32 v243, 0xffff0000, v254
v_mul_f32 v242, v242, v238
v_mul_f32 v243, v243, v238
v_cvt_pk_bf16_f32 v254, v242, v243
v_lshlrev_b32 v242, 16, v255
v_and_b32 v243, 0xffff0000, v255
v_mul_f32 v242, v242, v238
v_mul_f32 v243, v243, v238
v_cvt_pk_bf16_f32 v255, v242, v243
ds_write_b64 v253, v[254:255] offset:2056
s_waitcnt lgkmcnt(0)
ds_read_b64 v[254:255], v253 offset:6144
s_waitcnt lgkmcnt(0)
v_lshlrev_b32 v242, 16, v254
v_and_b32 v243, 0xffff0000, v254
v_mul_f32 v242, v242, v238
v_mul_f32 v243, v243, v238
v_cvt_pk_bf16_f32 v254, v242, v243
v_lshlrev_b32 v242, 16, v255
v_and_b32 v243, 0xffff0000, v255
v_mul_f32 v242, v242, v238
v_mul_f32 v243, v243, v238
v_cvt_pk_bf16_f32 v255, v242, v243
ds_write_b64 v253, v[254:255] offset:6144
s_waitcnt lgkmcnt(0)
ds_read_b64 v[254:255], v253 offset:6152
s_waitcnt lgkmcnt(0)
v_lshlrev_b32 v242, 16, v254
v_and_b32 v243, 0xffff0000, v254
v_mul_f32 v242, v242, v238
v_mul_f32 v243, v243, v238
v_cvt_pk_bf16_f32 v254, v242, v243
v_lshlrev_b32 v242, 16, v255
v_and_b32 v243, 0xffff0000, v255
v_mul_f32 v242, v242, v238
v_mul_f32 v243, v243, v238
v_cvt_pk_bf16_f32 v255, v242, v243
ds_write_b64 v253, v[254:255] offset:6152
s_waitcnt lgkmcnt(0)
v_log_f32 v243, v227
v_max3_f32 v235, v140, v141, v142
v_max3_f32 v235, v235, v143, v243
v_mov_b32 v243, v235
s_nop 1
v_permlane32_swap_b32 v235, v243
s_nop 1
v_max_f32 v235, v235, v243
v_mov_b32 v243, v235
s_nop 1
v_permlane16_swap_b32 v235, v243
s_nop 1
v_max_f32 v235, v235, v243
v_ceil_f32 v235, v235
v_max_f32 v235, 0, v235
v_sub_f32 v243, 0, v235
v_exp_f32 v239, v243
s_nop 1
v_mul_f32 v227, v227, v239
v_add_f32 v247, v247, v235
v_sub_f32 v204, v204, v235
v_sub_f32 v140, v140, v235
v_sub_f32 v156, v156, v235
v_sub_f32 v205, v205, v235
v_sub_f32 v141, v141, v235
v_sub_f32 v157, v157, v235
v_sub_f32 v206, v206, v235
v_sub_f32 v142, v142, v235
v_sub_f32 v158, v158, v235
v_sub_f32 v207, v207, v235
v_sub_f32 v143, v143, v235
v_sub_f32 v159, v159, v235
v_lshlrev_b32 v242, 16, v172
v_and_b32 v243, 0xffff0000, v172
v_mul_f32 v242, v242, v239
v_mul_f32 v243, v243, v239
v_cvt_pk_bf16_f32 v172, v242, v243
v_lshlrev_b32 v242, 16, v173
v_and_b32 v243, 0xffff0000, v173
v_mul_f32 v242, v242, v239
v_mul_f32 v243, v243, v239
v_cvt_pk_bf16_f32 v173, v242, v243
v_lshlrev_b32 v242, 16, v174
v_and_b32 v243, 0xffff0000, v174
v_mul_f32 v242, v242, v239
v_mul_f32 v243, v243, v239
v_cvt_pk_bf16_f32 v174, v242, v243
v_lshlrev_b32 v242, 16, v175
v_and_b32 v243, 0xffff0000, v175
v_mul_f32 v242, v242, v239
v_mul_f32 v243, v243, v239
v_cvt_pk_bf16_f32 v175, v242, v243
ds_read_b64 v[254:255], v253 offset:3072
s_waitcnt lgkmcnt(0)
v_lshlrev_b32 v242, 16, v254
v_and_b32 v243, 0xffff0000, v254
v_mul_f32 v242, v242, v239
v_mul_f32 v243, v243, v239
v_cvt_pk_bf16_f32 v254, v242, v243
v_lshlrev_b32 v242, 16, v255
v_and_b32 v243, 0xffff0000, v255
v_mul_f32 v242, v242, v239
v_mul_f32 v243, v243, v239
v_cvt_pk_bf16_f32 v255, v242, v243
ds_write_b64 v253, v[254:255] offset:3072
s_waitcnt lgkmcnt(0)
ds_read_b64 v[254:255], v253 offset:3080
s_waitcnt lgkmcnt(0)
v_lshlrev_b32 v242, 16, v254
v_and_b32 v243, 0xffff0000, v254
v_mul_f32 v242, v242, v239
v_mul_f32 v243, v243, v239
v_cvt_pk_bf16_f32 v254, v242, v243
v_lshlrev_b32 v242, 16, v255
v_and_b32 v243, 0xffff0000, v255
v_mul_f32 v242, v242, v239
v_mul_f32 v243, v243, v239
v_cvt_pk_bf16_f32 v255, v242, v243
ds_write_b64 v253, v[254:255] offset:3080
s_waitcnt lgkmcnt(0)
ds_read_b64 v[254:255], v253 offset:7168
s_waitcnt lgkmcnt(0)
v_lshlrev_b32 v242, 16, v254
v_and_b32 v243, 0xffff0000, v254
v_mul_f32 v242, v242, v239
v_mul_f32 v243, v243, v239
v_cvt_pk_bf16_f32 v254, v242, v243
v_lshlrev_b32 v242, 16, v255
v_and_b32 v243, 0xffff0000, v255
v_mul_f32 v242, v242, v239
v_mul_f32 v243, v243, v239
v_cvt_pk_bf16_f32 v255, v242, v243
ds_write_b64 v253, v[254:255] offset:7168
s_waitcnt lgkmcnt(0)
ds_read_b64 v[254:255], v253 offset:7176
s_waitcnt lgkmcnt(0)
v_lshlrev_b32 v242, 16, v254
v_and_b32 v243, 0xffff0000, v254
v_mul_f32 v242, v242, v239
v_mul_f32 v243, v243, v239
v_cvt_pk_bf16_f32 v254, v242, v243
v_lshlrev_b32 v242, 16, v255
v_and_b32 v243, 0xffff0000, v255
v_mul_f32 v242, v242, v239
v_mul_f32 v243, v243, v239
v_cvt_pk_bf16_f32 v255, v242, v243
ds_write_b64 v253, v[254:255] offset:7176
s_waitcnt lgkmcnt(0)
v_exp_f32 v232, v128
v_exp_f32 v233, v129
v_exp_f32 v234, v130
v_exp_f32 v235, v131
s_nop 1
v_add_f32 v228, v224, v232
v_add_f32 v228, v228, v233
v_add_f32 v228, v228, v234
v_add_f32 v228, v228, v235
v_cvt_pk_bf16_f32 v176, v232, v233
v_cvt_pk_bf16_f32 v177, v234, v235
v_exp_f32 v232, v132
v_exp_f32 v233, v133
v_exp_f32 v234, v134
v_exp_f32 v235, v135
s_nop 1
v_add_f32 v229, v225, v232
v_add_f32 v229, v229, v233
v_add_f32 v229, v229, v234
v_add_f32 v229, v229, v235
v_cvt_pk_bf16_f32 v180, v232, v233
v_cvt_pk_bf16_f32 v181, v234, v235
v_exp_f32 v232, v136
v_exp_f32 v233, v137
v_exp_f32 v234, v138
v_exp_f32 v235, v139
s_nop 1
v_add_f32 v230, v226, v232
v_add_f32 v230, v230, v233
v_add_f32 v230, v230, v234
v_add_f32 v230, v230, v235
v_cvt_pk_bf16_f32 v184, v232, v233
v_cvt_pk_bf16_f32 v185, v234, v235
v_exp_f32 v232, v140
v_exp_f32 v233, v141
v_exp_f32 v234, v142
v_exp_f32 v235, v143
s_nop 1
v_add_f32 v231, v227, v232
v_add_f32 v231, v231, v233
v_add_f32 v231, v231, v234
v_add_f32 v231, v231, v235
v_cvt_pk_bf16_f32 v188, v232, v233
v_cvt_pk_bf16_f32 v189, v234, v235
s_branch L2_rare_common
L2_rare_site9:
s_mov_b32 s36, 9
s_branch L2_rare_t0_5_1
L2_rare_t0_5_1:
s_nop 15
s_nop 15
s_waitcnt lgkmcnt(0)
v_log_f32 v243, v228
v_max3_f32 v232, v144, v145, v146
v_max3_f32 v232, v232, v147, v243
v_mov_b32 v243, v232
s_nop 1
v_permlane32_swap_b32 v232, v243
s_nop 1
v_max_f32 v232, v232, v243
v_mov_b32 v243, v232
s_nop 1
v_permlane16_swap_b32 v232, v243
s_nop 1
v_max_f32 v232, v232, v243
v_ceil_f32 v232, v232
v_max_f32 v232, 0, v232
v_sub_f32 v243, 0, v232
v_exp_f32 v236, v243
s_nop 1
v_mul_f32 v228, v228, v236
v_add_f32 v244, v244, v232
v_sub_f32 v192, v192, v232
v_sub_f32 v128, v128, v232
v_sub_f32 v144, v144, v232
v_sub_f32 v193, v193, v232
v_sub_f32 v129, v129, v232
v_sub_f32 v145, v145, v232
v_sub_f32 v194, v194, v232
v_sub_f32 v130, v130, v232
v_sub_f32 v146, v146, v232
v_sub_f32 v195, v195, v232
v_sub_f32 v131, v131, v232
v_sub_f32 v147, v147, v232
v_lshlrev_b32 v242, 16, v160
v_and_b32 v243, 0xffff0000, v160
v_mul_f32 v242, v242, v236
v_mul_f32 v243, v243, v236
v_cvt_pk_bf16_f32 v160, v242, v243
v_lshlrev_b32 v242, 16, v161
v_and_b32 v243, 0xffff0000, v161
v_mul_f32 v242, v242, v236
v_mul_f32 v243, v243, v236
v_cvt_pk_bf16_f32 v161, v242, v243
v_lshlrev_b32 v242, 16, v162
v_and_b32 v243, 0xffff0000, v162
v_mul_f32 v242, v242, v236
v_mul_f32 v243, v243, v236
v_cvt_pk_bf16_f32 v162, v242, v243
v_lshlrev_b32 v242, 16, v163
v_and_b32 v243, 0xffff0000, v163
v_mul_f32 v242, v242, v236
v_mul_f32 v243, v243, v236
v_cvt_pk_bf16_f32 v163, v242, v243
v_lshlrev_b32 v242, 16, v176
v_and_b32 v243, 0xffff0000, v176
v_mul_f32 v242, v242, v236
v_mul_f32 v243, v243, v236
v_cvt_pk_bf16_f32 v176, v242, v243
v_lshlrev_b32 v242, 16, v177
v_and_b32 v243, 0xffff0000, v177
v_mul_f32 v242, v242, v236
v_mul_f32 v243, v243, v236
v_cvt_pk_bf16_f32 v177, v242, v243
ds_read_b64 v[254:255], v253 offset:0
s_waitcnt lgkmcnt(0)
v_lshlrev_b32 v242, 16, v254
v_and_b32 v243, 0xffff0000, v254
v_mul_f32 v242, v242, v236
v_mul_f32 v243, v243, v236
v_cvt_pk_bf16_f32 v254, v242, v243
v_lshlrev_b32 v242, 16, v255
v_and_b32 v243, 0xffff0000, v255
v_mul_f32 v242, v242, v236
v_mul_f32 v243, v243, v236
v_cvt_pk_bf16_f32 v255, v242, v243
ds_write_b64 v253, v[254:255] offset:0
s_waitcnt lgkmcnt(0)
ds_read_b64 v[254:255], v253 offset:8
s_waitcnt lgkmcnt(0)
v_lshlrev_b32 v242, 16, v254
v_and_b32 v243, 0xffff0000, v254
v_mul_f32 v242, v242, v236
v_mul_f32 v243, v243, v236
v_cvt_pk_bf16_f32 v254, v242, v243
v_lshlrev_b32 v242, 16, v255
v_and_b32 v243, 0xffff0000, v255
v_mul_f32 v242, v242, v236
v_mul_f32 v243, v243, v236
v_cvt_pk_bf16_f32 v255, v242, v243
ds_write_b64 v253, v[254:255] offset:8
s_waitcnt lgkmcnt(0)
ds_read_b64 v[254:255], v253 offset:4096
s_waitcnt lgkmcnt(0)
v_lshlrev_b32 v242, 16, v254
v_and_b32 v243, 0xffff0000, v254
v_mul_f32 v242, v242, v236
v_mul_f32 v243, v243, v236
v_cvt_pk_bf16_f32 v254, v242, v243
v_lshlrev_b32 v242, 16, v255
v_and_b32 v243, 0xffff0000, v255
v_mul_f32 v242, v242, v236
v_mul_f32 v243, v243, v236
v_cvt_pk_bf16_f32 v255, v242, v243
ds_write_b64 v253, v[254:255] offset:4096
s_waitcnt lgkmcnt(0)
ds_read_b64 v[254:255], v253 offset:4104
s_waitcnt lgkmcnt(0)
v_lshlrev_b32 v242, 16, v254
v_and_b32 v243, 0xffff0000, v254
v_mul_f32 v242, v242, v236
v_mul_f32 v243, v243, v236
v_cvt_pk_bf16_f32 v254, v242, v243
v_lshlrev_b32 v242, 16, v255
v_and_b32 v243, 0xffff0000, v255
v_mul_f32 v242, v242, v236
v_mul_f32 v243, v243, v236
v_cvt_pk_bf16_f32 v255, v242, v243
ds_write_b64 v253, v[254:255] offset:4104
s_waitcnt lgkmcnt(0)
v_log_f32 v243, v229
v_max3_f32 v233, v148, v149, v150
v_max3_f32 v233, v233, v151, v243
v_mov_b32 v243, v233
s_nop 1
v_permlane32_swap_b32 v233, v243
s_nop 1
v_max_f32 v233, v233, v243
v_mov_b32 v243, v233
s_nop 1
v_permlane16_swap_b32 v233, v243
s_nop 1
v_max_f32 v233, v233, v243
v_ceil_f32 v233, v233
v_max_f32 v233, 0, v233
v_sub_f32 v243, 0, v233
v_exp_f32 v237, v243
s_nop 1
v_mul_f32 v229, v229, v237
v_add_f32 v245, v245, v233
v_sub_f32 v196, v196, v233
v_sub_f32 v132, v132, v233
v_sub_f32 v148, v148, v233
v_sub_f32 v197, v197, v233
v_sub_f32 v133, v133, v233
v_sub_f32 v149, v149, v233
v_sub_f32 v198, v198, v233
v_sub_f32 v134, v134, v233
v_sub_f32 v150, v150, v233
v_sub_f32 v199, v199, v233
v_sub_f32 v135, v135, v233
v_sub_f32 v151, v151, v233
v_lshlrev_b32 v242, 16, v164
v_and_b32 v243, 0xffff0000, v164
v_mul_f32 v242, v242, v237
v_mul_f32 v243, v243, v237
v_cvt_pk_bf16_f32 v164, v242, v243
v_lshlrev_b32 v242, 16, v165
v_and_b32 v243, 0xffff0000, v165
v_mul_f32 v242, v242, v237
v_mul_f32 v243, v243, v237
v_cvt_pk_bf16_f32 v165, v242, v243
v_lshlrev_b32 v242, 16, v166
v_and_b32 v243, 0xffff0000, v166
v_mul_f32 v242, v242, v237
v_mul_f32 v243, v243, v237
v_cvt_pk_bf16_f32 v166, v242, v243
v_lshlrev_b32 v242, 16, v167
v_and_b32 v243, 0xffff0000, v167
v_mul_f32 v242, v242, v237
v_mul_f32 v243, v243, v237
v_cvt_pk_bf16_f32 v167, v242, v243
v_lshlrev_b32 v242, 16, v180
v_and_b32 v243, 0xffff0000, v180
v_mul_f32 v242, v242, v237
v_mul_f32 v243, v243, v237
v_cvt_pk_bf16_f32 v180, v242, v243
v_lshlrev_b32 v242, 16, v181
v_and_b32 v243, 0xffff0000, v181
v_mul_f32 v242, v242, v237
v_mul_f32 v243, v243, v237
v_cvt_pk_bf16_f32 v181, v242, v243
ds_read_b64 v[254:255], v253 offset:1024
s_waitcnt lgkmcnt(0)
v_lshlrev_b32 v242, 16, v254
v_and_b32 v243, 0xffff0000, v254
v_mul_f32 v242, v242, v237
v_mul_f32 v243, v243, v237
v_cvt_pk_bf16_f32 v254, v242, v243
v_lshlrev_b32 v242, 16, v255
v_and_b32 v243, 0xffff0000, v255
v_mul_f32 v242, v242, v237
v_mul_f32 v243, v243, v237
v_cvt_pk_bf16_f32 v255, v242, v243
ds_write_b64 v253, v[254:255] offset:1024
s_waitcnt lgkmcnt(0)
ds_read_b64 v[254:255], v253 offset:1032
s_waitcnt lgkmcnt(0)
v_lshlrev_b32 v242, 16, v254
v_and_b32 v243, 0xffff0000, v254
v_mul_f32 v242, v242, v237
v_mul_f32 v243, v243, v237
v_cvt_pk_bf16_f32 v254, v242, v243
v_lshlrev_b32 v242, 16, v255
v_and_b32 v243, 0xffff0000, v255
v_mul_f32 v242, v242, v237
v_mul_f32 v243, v243, v237
v_cvt_pk_bf16_f32 v255, v242, v243
ds_write_b64 v253, v[254:255] offset:1032
s_waitcnt lgkmcnt(0)
ds_read_b64 v[254:255], v253 offset:5120
s_waitcnt lgkmcnt(0)
v_lshlrev_b32 v242, 16, v254
v_and_b32 v243, 0xffff0000, v254
v_mul_f32 v242, v242, v237
v_mul_f32 v243, v243, v237
v_cvt_pk_bf16_f32 v254, v242, v243
v_lshlrev_b32 v242, 16, v255
v_and_b32 v243, 0xffff0000, v255
v_mul_f32 v242, v242, v237
v_mul_f32 v243, v243, v237
v_cvt_pk_bf16_f32 v255, v242, v243
ds_write_b64 v253, v[254:255] offset:5120
s_waitcnt lgkmcnt(0)
ds_read_b64 v[254:255], v253 offset:5128
s_waitcnt lgkmcnt(0)
v_lshlrev_b32 v242, 16, v254
v_and_b32 v243, 0xffff0000, v254
v_mul_f32 v242, v242, v237
v_mul_f32 v243, v243, v237
v_cvt_pk_bf16_f32 v254, v242, v243
v_lshlrev_b32 v242, 16, v255
v_and_b32 v243, 0xffff0000, v255
v_mul_f32 v242, v242, v237
v_mul_f32 v243, v243, v237
v_cvt_pk_bf16_f32 v255, v242, v243
ds_write_b64 v253, v[254:255] offset:5128
s_waitcnt lgkmcnt(0)
v_log_f32 v243, v230
v_max3_f32 v234, v152, v153, v154
v_max3_f32 v234, v234, v155, v243
v_mov_b32 v243, v234
s_nop 1
v_permlane32_swap_b32 v234, v243
s_nop 1
v_max_f32 v234, v234, v243
v_mov_b32 v243, v234
s_nop 1
v_permlane16_swap_b32 v234, v243
s_nop 1
v_max_f32 v234, v234, v243
v_ceil_f32 v234, v234
v_max_f32 v234, 0, v234
v_sub_f32 v243, 0, v234
v_exp_f32 v238, v243
s_nop 1
v_mul_f32 v230, v230, v238
v_add_f32 v246, v246, v234
v_sub_f32 v200, v200, v234
v_sub_f32 v136, v136, v234
v_sub_f32 v152, v152, v234
v_sub_f32 v201, v201, v234
v_sub_f32 v137, v137, v234
v_sub_f32 v153, v153, v234
v_sub_f32 v202, v202, v234
v_sub_f32 v138, v138, v234
v_sub_f32 v154, v154, v234
v_sub_f32 v203, v203, v234
v_sub_f32 v139, v139, v234
v_sub_f32 v155, v155, v234
v_lshlrev_b32 v242, 16, v168
v_and_b32 v243, 0xffff0000, v168
v_mul_f32 v242, v242, v238
v_mul_f32 v243, v243, v238
v_cvt_pk_bf16_f32 v168, v242, v243
v_lshlrev_b32 v242, 16, v169
v_and_b32 v243, 0xffff0000, v169
v_mul_f32 v242, v242, v238
v_mul_f32 v243, v243, v238
v_cvt_pk_bf16_f32 v169, v242, v243
v_lshlrev_b32 v242, 16, v170
v_and_b32 v243, 0xffff0000, v170
v_mul_f32 v242, v242, v238
v_mul_f32 v243, v243, v238
v_cvt_pk_bf16_f32 v170, v242, v243
v_lshlrev_b32 v242, 16, v171
v_and_b32 v243, 0xffff0000, v171
v_mul_f32 v242, v242, v238
v_mul_f32 v243, v243, v238
v_cvt_pk_bf16_f32 v171, v242, v243
v_lshlrev_b32 v242, 16, v184
v_and_b32 v243, 0xffff0000, v184
v_mul_f32 v242, v242, v238
v_mul_f32 v243, v243, v238
v_cvt_pk_bf16_f32 v184, v242, v243
v_lshlrev_b32 v242, 16, v185
v_and_b32 v243, 0xffff0000, v185
v_mul_f32 v242, v242, v238
v_mul_f32 v243, v243, v238
v_cvt_pk_bf16_f32 v185, v242, v243
ds_read_b64 v[254:255], v253 offset:2048
s_waitcnt lgkmcnt(0)
v_lshlrev_b32 v242, 16, v254
v_and_b32 v243, 0xffff0000, v254
v_mul_f32 v242, v242, v238
v_mul_f32 v243, v243, v238
v_cvt_pk_bf16_f32 v254, v242, v243
v_lshlrev_b32 v242, 16, v255
v_and_b32 v243, 0xffff0000, v255
v_mul_f32 v242, v242, v238
v_mul_f32 v243, v243, v238
v_cvt_pk_bf16_f32 v255, v242, v243
ds_write_b64 v253, v[254:255] offset:2048
s_waitcnt lgkmcnt(0)
ds_read_b64 v[254:255], v253 offset:2056
s_waitcnt lgkmcnt(0)
v_lshlrev_b32 v242, 16, v254
v_and_b32 v243, 0xffff0000, v254
v_mul_f32 v242, v242, v238
v_mul_f32 v243, v243, v238
v_cvt_pk_bf16_f32 v254, v242, v243
v_lshlrev_b32 v242, 16, v255
v_and_b32 v243, 0xffff0000, v255
v_mul_f32 v242, v242, v238
v_mul_f32 v243, v243, v238
v_cvt_pk_bf16_f32 v255, v242, v243
ds_write_b64 v253, v[254:255] offset:2056
s_waitcnt lgkmcnt(0)
ds_read_b64 v[254:255], v253 offset:6144
s_waitcnt lgkmcnt(0)
v_lshlrev_b32 v242, 16, v254
v_and_b32 v243, 0xffff0000, v254
v_mul_f32 v242, v242, v238
v_mul_f32 v243, v243, v238
v_cvt_pk_bf16_f32 v254, v242, v243
v_lshlrev_b32 v242, 16, v255
v_and_b32 v243, 0xffff0000, v255
v_mul_f32 v242, v242, v238
v_mul_f32 v243, v243, v238
v_cvt_pk_bf16_f32 v255, v242, v243
ds_write_b64 v253, v[254:255] offset:6144
s_waitcnt lgkmcnt(0)
ds_read_b64 v[254:255], v253 offset:6152
s_waitcnt lgkmcnt(0)
v_lshlrev_b32 v242, 16, v254
v_and_b32 v243, 0xffff0000, v254
v_mul_f32 v242, v242, v238
v_mul_f32 v243, v243, v238
v_cvt_pk_bf16_f32 v254, v242, v243
v_lshlrev_b32 v242, 16, v255
v_and_b32 v243, 0xffff0000, v255
v_mul_f32 v242, v242, v238
v_mul_f32 v243, v243, v238
v_cvt_pk_bf16_f32 v255, v242, v243
ds_write_b64 v253, v[254:255] offset:6152
s_waitcnt lgkmcnt(0)
v_log_f32 v243, v231
v_max3_f32 v235, v156, v157, v158
v_max3_f32 v235, v235, v159, v243
v_mov_b32 v243, v235
s_nop 1
v_permlane32_swap_b32 v235, v243
s_nop 1
v_max_f32 v235, v235, v243
v_mov_b32 v243, v235
s_nop 1
v_permlane16_swap_b32 v235, v243
s_nop 1
v_max_f32 v235, v235, v243
v_ceil_f32 v235, v235
v_max_f32 v235, 0, v235
v_sub_f32 v243, 0, v235
v_exp_f32 v239, v243
s_nop 1
v_mul_f32 v231, v231, v239
v_add_f32 v247, v247, v235
v_sub_f32 v204, v204, v235
v_sub_f32 v140, v140, v235
v_sub_f32 v156, v156, v235
v_sub_f32 v205, v205, v235
v_sub_f32 v141, v141, v235
v_sub_f32 v157, v157, v235
v_sub_f32 v206, v206, v235
v_sub_f32 v142, v142, v235
v_sub_f32 v158, v158, v235
v_sub_f32 v207, v207, v235
v_sub_f32 v143, v143, v235
v_sub_f32 v159, v159, v235
v_lshlrev_b32 v242, 16, v172
v_and_b32 v243, 0xffff0000, v172
v_mul_f32 v242, v242, v239
v_mul_f32 v243, v243, v239
v_cvt_pk_bf16_f32 v172, v242, v243
v_lshlrev_b32 v242, 16, v173
v_and_b32 v243, 0xffff0000, v173
v_mul_f32 v242, v242, v239
v_mul_f32 v243, v243, v239
v_cvt_pk_bf16_f32 v173, v242, v243
v_lshlrev_b32 v242, 16, v174
v_and_b32 v243, 0xffff0000, v174
v_mul_f32 v242, v242, v239
v_mul_f32 v243, v243, v239
v_cvt_pk_bf16_f32 v174, v242, v243
v_lshlrev_b32 v242, 16, v175
v_and_b32 v243, 0xffff0000, v175
v_mul_f32 v242, v242, v239
v_mul_f32 v243, v243, v239
v_cvt_pk_bf16_f32 v175, v242, v243
v_lshlrev_b32 v242, 16, v188
v_and_b32 v243, 0xffff0000, v188
v_mul_f32 v242, v242, v239
v_mul_f32 v243, v243, v239
v_cvt_pk_bf16_f32 v188, v242, v243
v_lshlrev_b32 v242, 16, v189
v_and_b32 v243, 0xffff0000, v189
v_mul_f32 v242, v242, v239
v_mul_f32 v243, v243, v239
v_cvt_pk_bf16_f32 v189, v242, v243
ds_read_b64 v[254:255], v253 offset:3072
s_waitcnt lgkmcnt(0)
v_lshlrev_b32 v242, 16, v254
v_and_b32 v243, 0xffff0000, v254
v_mul_f32 v242, v242, v239
v_mul_f32 v243, v243, v239
v_cvt_pk_bf16_f32 v254, v242, v243
v_lshlrev_b32 v242, 16, v255
v_and_b32 v243, 0xffff0000, v255
v_mul_f32 v242, v242, v239
v_mul_f32 v243, v243, v239
v_cvt_pk_bf16_f32 v255, v242, v243
ds_write_b64 v253, v[254:255] offset:3072
s_waitcnt lgkmcnt(0)
ds_read_b64 v[254:255], v253 offset:3080
s_waitcnt lgkmcnt(0)
v_lshlrev_b32 v242, 16, v254
v_and_b32 v243, 0xffff0000, v254
v_mul_f32 v242, v242, v239
v_mul_f32 v243, v243, v239
v_cvt_pk_bf16_f32 v254, v242, v243
v_lshlrev_b32 v242, 16, v255
v_and_b32 v243, 0xffff0000, v255
v_mul_f32 v242, v242, v239
v_mul_f32 v243, v243, v239
v_cvt_pk_bf16_f32 v255, v242, v243
ds_write_b64 v253, v[254:255] offset:3080
s_waitcnt lgkmcnt(0)
ds_read_b64 v[254:255], v253 offset:7168
s_waitcnt lgkmcnt(0)
v_lshlrev_b32 v242, 16, v254
v_and_b32 v243, 0xffff0000, v254
v_mul_f32 v242, v242, v239
v_mul_f32 v243, v243, v239
v_cvt_pk_bf16_f32 v254, v242, v243
v_lshlrev_b32 v242, 16, v255
v_and_b32 v243, 0xffff0000, v255
v_mul_f32 v242, v242, v239
v_mul_f32 v243, v243, v239
v_cvt_pk_bf16_f32 v255, v242, v243
ds_write_b64 v253, v[254:255] offset:7168
s_waitcnt lgkmcnt(0)
ds_read_b64 v[254:255], v253 offset:7176
s_waitcnt lgkmcnt(0)
v_lshlrev_b32 v242, 16, v254
v_and_b32 v243, 0xffff0000, v254
v_mul_f32 v242, v242, v239
v_mul_f32 v243, v243, v239
v_cvt_pk_bf16_f32 v254, v242, v243
v_lshlrev_b32 v242, 16, v255
v_and_b32 v243, 0xffff0000, v255
v_mul_f32 v242, v242, v239
v_mul_f32 v243, v243, v239
v_cvt_pk_bf16_f32 v255, v242, v243
ds_write_b64 v253, v[254:255] offset:7176
s_waitcnt lgkmcnt(0)
v_exp_f32 v232, v144
v_exp_f32 v233, v145
v_exp_f32 v234, v146
v_exp_f32 v235, v147
s_nop 1
v_add_f32 v224, v228, v232
v_add_f32 v224, v224, v233
v_add_f32 v224, v224, v234
v_add_f32 v224, v224, v235
v_cvt_pk_bf16_f32 v178, v232, v233
v_cvt_pk_bf16_f32 v179, v234, v235
v_exp_f32 v232, v148
v_exp_f32 v233, v149
v_exp_f32 v234, v150
v_exp_f32 v235, v151
s_nop 1
v_add_f32 v225, v229, v232
v_add_f32 v225, v225, v233
v_add_f32 v225, v225, v234
v_add_f32 v225, v225, v235
v_cvt_pk_bf16_f32 v182, v232, v233
v_cvt_pk_bf16_f32 v183, v234, v235
v_exp_f32 v232, v152
v_exp_f32 v233, v153
v_exp_f32 v234, v154
v_exp_f32 v235, v155
s_nop 1
v_add_f32 v226, v230, v232
v_add_f32 v226, v226, v233
v_add_f32 v226, v226, v234
v_add_f32 v226, v226, v235
v_cvt_pk_bf16_f32 v186, v232, v233
v_cvt_pk_bf16_f32 v187, v234, v235
v_exp_f32 v232, v156
v_exp_f32 v233, v157
v_exp_f32 v234, v158
v_exp_f32 v235, v159
s_nop 1
v_add_f32 v227, v231, v232
v_add_f32 v227, v227, v233
v_add_f32 v227, v227, v234
v_add_f32 v227, v227, v235
v_cvt_pk_bf16_f32 v190, v232, v233
v_cvt_pk_bf16_f32 v191, v234, v235
s_branch L2_rare_common
L2_rare_site10:
s_mov_b32 s36, 10
s_branch L2_rare_t0_6_0
L2_rare_t0_6_0:
s_nop 15
s_nop 15
s_waitcnt lgkmcnt(0)
v_log_f32 v243, v224
v_max3_f32 v232, v128, v129, v130
v_max3_f32 v232, v232, v131, v243
v_mov_b32 v243, v232
s_nop 1
v_permlane32_swap_b32 v232, v243
s_nop 1
v_max_f32 v232, v232, v243
v_mov_b32 v243, v232
s_nop 1
v_permlane16_swap_b32 v232, v243
s_nop 1
v_max_f32 v232, v232, v243
v_ceil_f32 v232, v232
v_max_f32 v232, 0, v232
v_sub_f32 v243, 0, v232
v_exp_f32 v236, v243
s_nop 1
v_mul_f32 v224, v224, v236
v_add_f32 v244, v244, v232
v_sub_f32 v192, v192, v232
v_sub_f32 v128, v128, v232
v_sub_f32 v144, v144, v232
v_sub_f32 v193, v193, v232
v_sub_f32 v129, v129, v232
v_sub_f32 v145, v145, v232
v_sub_f32 v194, v194, v232
v_sub_f32 v130, v130, v232
v_sub_f32 v146, v146, v232
v_sub_f32 v195, v195, v232
v_sub_f32 v131, v131, v232
v_sub_f32 v147, v147, v232
v_lshlrev_b32 v242, 16, v4
v_and_b32 v243, 0xffff0000, v4
v_mul_f32 v242, v242, v236
v_mul_f32 v243, v243, v236
v_cvt_pk_bf16_f32 v4, v242, v243
v_lshlrev_b32 v242, 16, v5
v_and_b32 v243, 0xffff0000, v5
v_mul_f32 v242, v242, v236
v_mul_f32 v243, v243, v236
v_cvt_pk_bf16_f32 v5, v242, v243
v_lshlrev_b32 v242, 16, v6
v_and_b32 v243, 0xffff0000, v6
v_mul_f32 v242, v242, v236
v_mul_f32 v243, v243, v236
v_cvt_pk_bf16_f32 v6, v242, v243
v_lshlrev_b32 v242, 16, v7
v_and_b32 v243, 0xffff0000, v7
v_mul_f32 v242, v242, v236
v_mul_f32 v243, v243, v236
v_cvt_pk_bf16_f32 v7, v242, v243
v_lshlrev_b32 v242, 16, v8
v_and_b32 v243, 0xffff0000, v8
v_mul_f32 v242, v242, v236
v_mul_f32 v243, v243, v236
v_cvt_pk_bf16_f32 v8, v242, v243
v_lshlrev_b32 v242, 16, v9
v_and_b32 v243, 0xffff0000, v9
v_mul_f32 v242, v242, v236
v_mul_f32 v243, v243, v236
v_cvt_pk_bf16_f32 v9, v242, v243
v_lshlrev_b32 v242, 16, v10
v_and_b32 v243, 0xffff0000, v10
v_mul_f32 v242, v242, v236
v_mul_f32 v243, v243, v236
v_cvt_pk_bf16_f32 v10, v242, v243
v_lshlrev_b32 v242, 16, v11
v_and_b32 v243, 0xffff0000, v11
v_mul_f32 v242, v242, v236
v_mul_f32 v243, v243, v236
v_cvt_pk_bf16_f32 v11, v242, v243
v_lshlrev_b32 v242, 16, v160
v_and_b32 v243, 0xffff0000, v160
v_mul_f32 v242, v242, v236
v_mul_f32 v243, v243, v236
v_cvt_pk_bf16_f32 v160, v242, v243
v_lshlrev_b32 v242, 16, v161
v_and_b32 v243, 0xffff0000, v161
v_mul_f32 v242, v242, v236
v_mul_f32 v243, v243, v236
v_cvt_pk_bf16_f32 v161, v242, v243
v_lshlrev_b32 v242, 16, v162
v_and_b32 v243, 0xffff0000, v162
v_mul_f32 v242, v242, v236
v_mul_f32 v243, v243, v236
v_cvt_pk_bf16_f32 v162, v242, v243
v_lshlrev_b32 v242, 16, v163
v_and_b32 v243, 0xffff0000, v163
v_mul_f32 v242, v242, v236
v_mul_f32 v243, v243, v236
v_cvt_pk_bf16_f32 v163, v242, v243
v_lshlrev_b32 v242, 16, v176
v_and_b32 v243, 0xffff0000, v176
v_mul_f32 v242, v242, v236
v_mul_f32 v243, v243, v236
v_cvt_pk_bf16_f32 v176, v242, v243
v_lshlrev_b32 v242, 16, v177
v_and_b32 v243, 0xffff0000, v177
v_mul_f32 v242, v242, v236
v_mul_f32 v243, v243, v236
v_cvt_pk_bf16_f32 v177, v242, v243
v_lshlrev_b32 v242, 16, v178
v_and_b32 v243, 0xffff0000, v178
v_mul_f32 v242, v242, v236
v_mul_f32 v243, v243, v236
v_cvt_pk_bf16_f32 v178, v242, v243
v_lshlrev_b32 v242, 16, v179
v_and_b32 v243, 0xffff0000, v179
v_mul_f32 v242, v242, v236
v_mul_f32 v243, v243, v236
v_cvt_pk_bf16_f32 v179, v242, v243
v_log_f32 v243, v225
v_max3_f32 v233, v132, v133, v134
v_max3_f32 v233, v233, v135, v243
v_mov_b32 v243, v233
s_nop 1
v_permlane32_swap_b32 v233, v243
s_nop 1
v_max_f32 v233, v233, v243
v_mov_b32 v243, v233
s_nop 1
v_permlane16_swap_b32 v233, v243
s_nop 1
v_max_f32 v233, v233, v243
v_ceil_f32 v233, v233
v_max_f32 v233, 0, v233
v_sub_f32 v243, 0, v233
v_exp_f32 v237, v243
s_nop 1
v_mul_f32 v225, v225, v237
v_add_f32 v245, v245, v233
v_sub_f32 v196, v196, v233
v_sub_f32 v132, v132, v233
v_sub_f32 v148, v148, v233
v_sub_f32 v197, v197, v233
v_sub_f32 v133, v133, v233
v_sub_f32 v149, v149, v233
v_sub_f32 v198, v198, v233
v_sub_f32 v134, v134, v233
v_sub_f32 v150, v150, v233
v_sub_f32 v199, v199, v233
v_sub_f32 v135, v135, v233
v_sub_f32 v151, v151, v233
v_lshlrev_b32 v242, 16, v36
v_and_b32 v243, 0xffff0000, v36
v_mul_f32 v242, v242, v237
v_mul_f32 v243, v243, v237
v_cvt_pk_bf16_f32 v36, v242, v243
v_lshlrev_b32 v242, 16, v37
v_and_b32 v243, 0xffff0000, v37
v_mul_f32 v242, v242, v237
v_mul_f32 v243, v243, v237
v_cvt_pk_bf16_f32 v37, v242, v243
v_lshlrev_b32 v242, 16, v38
v_and_b32 v243, 0xffff0000, v38
v_mul_f32 v242, v242, v237
v_mul_f32 v243, v243, v237
v_cvt_pk_bf16_f32 v38, v242, v243
v_lshlrev_b32 v242, 16, v39
v_and_b32 v243, 0xffff0000, v39
v_mul_f32 v242, v242, v237
v_mul_f32 v243, v243, v237
v_cvt_pk_bf16_f32 v39, v242, v243
v_lshlrev_b32 v242, 16, v40
v_and_b32 v243, 0xffff0000, v40
v_mul_f32 v242, v242, v237
v_mul_f32 v243, v243, v237
v_cvt_pk_bf16_f32 v40, v242, v243
v_lshlrev_b32 v242, 16, v41
v_and_b32 v243, 0xffff0000, v41
v_mul_f32 v242, v242, v237
v_mul_f32 v243, v243, v237
v_cvt_pk_bf16_f32 v41, v242, v243
v_lshlrev_b32 v242, 16, v42
v_and_b32 v243, 0xffff0000, v42
v_mul_f32 v242, v242, v237
v_mul_f32 v243, v243, v237
v_cvt_pk_bf16_f32 v42, v242, v243
v_lshlrev_b32 v242, 16, v43
v_and_b32 v243, 0xffff0000, v43
v_mul_f32 v242, v242, v237
v_mul_f32 v243, v243, v237
v_cvt_pk_bf16_f32 v43, v242, v243
v_lshlrev_b32 v242, 16, v164
v_and_b32 v243, 0xffff0000, v164
v_mul_f32 v242, v242, v237
v_mul_f32 v243, v243, v237
v_cvt_pk_bf16_f32 v164, v242, v243
v_lshlrev_b32 v242, 16, v165
v_and_b32 v243, 0xffff0000, v165
v_mul_f32 v242, v242, v237
v_mul_f32 v243, v243, v237
v_cvt_pk_bf16_f32 v165, v242, v243
v_lshlrev_b32 v242, 16, v166
v_and_b32 v243, 0xffff0000, v166
v_mul_f32 v242, v242, v237
v_mul_f32 v243, v243, v237
v_cvt_pk_bf16_f32 v166, v242, v243
v_lshlrev_b32 v242, 16, v167
v_and_b32 v243, 0xffff0000, v167
v_mul_f32 v242, v242, v237
v_mul_f32 v243, v243, v237
v_cvt_pk_bf16_f32 v167, v242, v243
v_lshlrev_b32 v242, 16, v180
v_and_b32 v243, 0xffff0000, v180
v_mul_f32 v242, v242, v237
v_mul_f32 v243, v243, v237
v_cvt_pk_bf16_f32 v180, v242, v243
v_lshlrev_b32 v242, 16, v181
v_and_b32 v243, 0xffff0000, v181
v_mul_f32 v242, v242, v237
v_mul_f32 v243, v243, v237
v_cvt_pk_bf16_f32 v181, v242, v243
v_lshlrev_b32 v242, 16, v182
v_and_b32 v243, 0xffff0000, v182
v_mul_f32 v242, v242, v237
v_mul_f32 v243, v243, v237
v_cvt_pk_bf16_f32 v182, v242, v243
v_lshlrev_b32 v242, 16, v183
v_and_b32 v243, 0xffff0000, v183
v_mul_f32 v242, v242, v237
v_mul_f32 v243, v243, v237
v_cvt_pk_bf16_f32 v183, v242, v243
v_log_f32 v243, v226
v_max3_f32 v234, v136, v137, v138
v_max3_f32 v234, v234, v139, v243
v_mov_b32 v243, v234
s_nop 1
v_permlane32_swap_b32 v234, v243
s_nop 1
v_max_f32 v234, v234, v243
v_mov_b32 v243, v234
s_nop 1
v_permlane16_swap_b32 v234, v243
s_nop 1
v_max_f32 v234, v234, v243
v_ceil_f32 v234, v234
v_max_f32 v234, 0, v234
v_sub_f32 v243, 0, v234
v_exp_f32 v238, v243
s_nop 1
v_mul_f32 v226, v226, v238
v_add_f32 v246, v246, v234
v_sub_f32 v200, v200, v234
v_sub_f32 v136, v136, v234
v_sub_f32 v152, v152, v234
v_sub_f32 v201, v201, v234
v_sub_f32 v137, v137, v234
v_sub_f32 v153, v153, v234
v_sub_f32 v202, v202, v234
v_sub_f32 v138, v138, v234
v_sub_f32 v154, v154, v234
v_sub_f32 v203, v203, v234
v_sub_f32 v139, v139, v234
v_sub_f32 v155, v155, v234
v_lshlrev_b32 v242, 16, v68
v_and_b32 v243, 0xffff0000, v68
v_mul_f32 v242, v242, v238
v_mul_f32 v243, v243, v238
v_cvt_pk_bf16_f32 v68, v242, v243
v_lshlrev_b32 v242, 16, v69
v_and_b32 v243, 0xffff0000, v69
v_mul_f32 v242, v242, v238
v_mul_f32 v243, v243, v238
v_cvt_pk_bf16_f32 v69, v242, v243
v_lshlrev_b32 v242, 16, v70
v_and_b32 v243, 0xffff0000, v70
v_mul_f32 v242, v242, v238
v_mul_f32 v243, v243, v238
v_cvt_pk_bf16_f32 v70, v242, v243
v_lshlrev_b32 v242, 16, v71
v_and_b32 v243, 0xffff0000, v71
v_mul_f32 v242, v242, v238
v_mul_f32 v243, v243, v238
v_cvt_pk_bf16_f32 v71, v242, v243
v_lshlrev_b32 v242, 16, v72
v_and_b32 v243, 0xffff0000, v72
v_mul_f32 v242, v242, v238
v_mul_f32 v243, v243, v238
v_cvt_pk_bf16_f32 v72, v242, v243
v_lshlrev_b32 v242, 16, v73
v_and_b32 v243, 0xffff0000, v73
v_mul_f32 v242, v242, v238
v_mul_f32 v243, v243, v238
v_cvt_pk_bf16_f32 v73, v242, v243
v_lshlrev_b32 v242, 16, v74
v_and_b32 v243, 0xffff0000, v74
v_mul_f32 v242, v242, v238
v_mul_f32 v243, v243, v238
v_cvt_pk_bf16_f32 v74, v242, v243
v_lshlrev_b32 v242, 16, v75
v_and_b32 v243, 0xffff0000, v75
v_mul_f32 v242, v242, v238
v_mul_f32 v243, v243, v238
v_cvt_pk_bf16_f32 v75, v242, v243
v_lshlrev_b32 v242, 16, v168
v_and_b32 v243, 0xffff0000, v168
v_mul_f32 v242, v242, v238
v_mul_f32 v243, v243, v238
v_cvt_pk_bf16_f32 v168, v242, v243
v_lshlrev_b32 v242, 16, v169
v_and_b32 v243, 0xffff0000, v169
v_mul_f32 v242, v242, v238
v_mul_f32 v243, v243, v238
v_cvt_pk_bf16_f32 v169, v242, v243
v_lshlrev_b32 v242, 16, v170
v_and_b32 v243, 0xffff0000, v170
v_mul_f32 v242, v242, v238
v_mul_f32 v243, v243, v238
v_cvt_pk_bf16_f32 v170, v242, v243
v_lshlrev_b32 v242, 16, v171
v_and_b32 v243, 0xffff0000, v171
v_mul_f32 v242, v242, v238
v_mul_f32 v243, v243, v238
v_cvt_pk_bf16_f32 v171, v242, v243
v_lshlrev_b32 v242, 16, v184
v_and_b32 v243, 0xffff0000, v184
v_mul_f32 v242, v242, v238
v_mul_f32 v243, v243, v238
v_cvt_pk_bf16_f32 v184, v242, v243
v_lshlrev_b32 v242, 16, v185
v_and_b32 v243, 0xffff0000, v185
v_mul_f32 v242, v242, v238
v_mul_f32 v243, v243, v238
v_cvt_pk_bf16_f32 v185, v242, v243
v_lshlrev_b32 v242, 16, v186
v_and_b32 v243, 0xffff0000, v186
v_mul_f32 v242, v242, v238
v_mul_f32 v243, v243, v238
v_cvt_pk_bf16_f32 v186, v242, v243
v_lshlrev_b32 v242, 16, v187
v_and_b32 v243, 0xffff0000, v187
v_mul_f32 v242, v242, v238
v_mul_f32 v243, v243, v238
v_cvt_pk_bf16_f32 v187, v242, v243
v_log_f32 v243, v227
v_max3_f32 v235, v140, v141, v142
v_max3_f32 v235, v235, v143, v243
v_mov_b32 v243, v235
s_nop 1
v_permlane32_swap_b32 v235, v243
s_nop 1
v_max_f32 v235, v235, v243
v_mov_b32 v243, v235
s_nop 1
v_permlane16_swap_b32 v235, v243
s_nop 1
v_max_f32 v235, v235, v243
v_ceil_f32 v235, v235
v_max_f32 v235, 0, v235
v_sub_f32 v243, 0, v235
v_exp_f32 v239, v243
s_nop 1
v_mul_f32 v227, v227, v239
v_add_f32 v247, v247, v235
v_sub_f32 v204, v204, v235
v_sub_f32 v140, v140, v235
v_sub_f32 v156, v156, v235
v_sub_f32 v205, v205, v235
v_sub_f32 v141, v141, v235
v_sub_f32 v157, v157, v235
v_sub_f32 v206, v206, v235
v_sub_f32 v142, v142, v235
v_sub_f32 v158, v158, v235
v_sub_f32 v207, v207, v235
v_sub_f32 v143, v143, v235
v_sub_f32 v159, v159, v235
v_lshlrev_b32 v242, 16, v100
v_and_b32 v243, 0xffff0000, v100
v_mul_f32 v242, v242, v239
v_mul_f32 v243, v243, v239
v_cvt_pk_bf16_f32 v100, v242, v243
v_lshlrev_b32 v242, 16, v101
v_and_b32 v243, 0xffff0000, v101
v_mul_f32 v242, v242, v239
v_mul_f32 v243, v243, v239
v_cvt_pk_bf16_f32 v101, v242, v243
v_lshlrev_b32 v242, 16, v102
v_and_b32 v243, 0xffff0000, v102
v_mul_f32 v242, v242, v239
v_mul_f32 v243, v243, v239
v_cvt_pk_bf16_f32 v102, v242, v243
v_lshlrev_b32 v242, 16, v103
v_and_b32 v243, 0xffff0000, v103
v_mul_f32 v242, v242, v239
v_mul_f32 v243, v243, v239
v_cvt_pk_bf16_f32 v103, v242, v243
v_lshlrev_b32 v242, 16, v104
v_and_b32 v243, 0xffff0000, v104
v_mul_f32 v242, v242, v239
v_mul_f32 v243, v243, v239
v_cvt_pk_bf16_f32 v104, v242, v243
v_lshlrev_b32 v242, 16, v105
v_and_b32 v243, 0xffff0000, v105
v_mul_f32 v242, v242, v239
v_mul_f32 v243, v243, v239
v_cvt_pk_bf16_f32 v105, v242, v243
v_lshlrev_b32 v242, 16, v106
v_and_b32 v243, 0xffff0000, v106
v_mul_f32 v242, v242, v239
v_mul_f32 v243, v243, v239
v_cvt_pk_bf16_f32 v106, v242, v243
v_lshlrev_b32 v242, 16, v107
v_and_b32 v243, 0xffff0000, v107
v_mul_f32 v242, v242, v239
v_mul_f32 v243, v243, v239
v_cvt_pk_bf16_f32 v107, v242, v243
v_lshlrev_b32 v242, 16, v172
v_and_b32 v243, 0xffff0000, v172
v_mul_f32 v242, v242, v239
v_mul_f32 v243, v243, v239
v_cvt_pk_bf16_f32 v172, v242, v243
v_lshlrev_b32 v242, 16, v173
v_and_b32 v243, 0xffff0000, v173
v_mul_f32 v242, v242, v239
v_mul_f32 v243, v243, v239
v_cvt_pk_bf16_f32 v173, v242, v243
v_lshlrev_b32 v242, 16, v174
v_and_b32 v243, 0xffff0000, v174
v_mul_f32 v242, v242, v239
v_mul_f32 v243, v243, v239
v_cvt_pk_bf16_f32 v174, v242, v243
v_lshlrev_b32 v242, 16, v175
v_and_b32 v243, 0xffff0000, v175
v_mul_f32 v242, v242, v239
v_mul_f32 v243, v243, v239
v_cvt_pk_bf16_f32 v175, v242, v243
v_lshlrev_b32 v242, 16, v188
v_and_b32 v243, 0xffff0000, v188
v_mul_f32 v242, v242, v239
v_mul_f32 v243, v243, v239
v_cvt_pk_bf16_f32 v188, v242, v243
v_lshlrev_b32 v242, 16, v189
v_and_b32 v243, 0xffff0000, v189
v_mul_f32 v242, v242, v239
v_mul_f32 v243, v243, v239
v_cvt_pk_bf16_f32 v189, v242, v243
v_lshlrev_b32 v242, 16, v190
v_and_b32 v243, 0xffff0000, v190
v_mul_f32 v242, v242, v239
v_mul_f32 v243, v243, v239
v_cvt_pk_bf16_f32 v190, v242, v243
v_lshlrev_b32 v242, 16, v191
v_and_b32 v243, 0xffff0000, v191
v_mul_f32 v242, v242, v239
v_mul_f32 v243, v243, v239
v_cvt_pk_bf16_f32 v191, v242, v243
v_exp_f32 v232, v128
v_exp_f32 v233, v129
v_exp_f32 v234, v130
v_exp_f32 v235, v131
s_nop 1
v_add_f32 v228, v224, v232
v_add_f32 v228, v228, v233
v_add_f32 v228, v228, v234
v_add_f32 v228, v228, v235
v_cvt_pk_bf16_f32 v0, v232, v233
v_cvt_pk_bf16_f32 v1, v234, v235
v_exp_f32 v232, v132
v_exp_f32 v233, v133
v_exp_f32 v234, v134
v_exp_f32 v235, v135
s_nop 1
v_add_f32 v229, v225, v232
v_add_f32 v229, v229, v233
v_add_f32 v229, v229, v234
v_add_f32 v229, v229, v235
v_cvt_pk_bf16_f32 v32, v232, v233
v_cvt_pk_bf16_f32 v33, v234, v235
v_exp_f32 v232, v136
v_exp_f32 v233, v137
v_exp_f32 v234, v138
v_exp_f32 v235, v139
s_nop 1
v_add_f32 v230, v226, v232
v_add_f32 v230, v230, v233
v_add_f32 v230, v230, v234
v_add_f32 v230, v230, v235
v_cvt_pk_bf16_f32 v64, v232, v233
v_cvt_pk_bf16_f32 v65, v234, v235
v_exp_f32 v232, v140
v_exp_f32 v233, v141
v_exp_f32 v234, v142
v_exp_f32 v235, v143
s_nop 1
v_add_f32 v231, v227, v232
v_add_f32 v231, v231, v233
v_add_f32 v231, v231, v234
v_add_f32 v231, v231, v235
v_cvt_pk_bf16_f32 v96, v232, v233
v_cvt_pk_bf16_f32 v97, v234, v235
s_branch L2_rare_common
L2_rare_site11:
s_mov_b32 s36, 11
s_branch L2_rare_t0_7_1
L2_rare_t0_7_1:
s_nop 15
s_nop 15
s_waitcnt lgkmcnt(0)
v_log_f32 v243, v228
v_max3_f32 v232, v144, v145, v146
v_max3_f32 v232, v232, v147, v243
v_mov_b32 v243, v232
s_nop 1
v_permlane32_swap_b32 v232, v243
s_nop 1
v_max_f32 v232, v232, v243
v_mov_b32 v243, v232
s_nop 1
v_permlane16_swap_b32 v232, v243
s_nop 1
v_max_f32 v232, v232, v243
v_ceil_f32 v232, v232
v_max_f32 v232, 0, v232
v_sub_f32 v243, 0, v232
v_exp_f32 v236, v243
s_nop 1
v_mul_f32 v228, v228, v236
v_add_f32 v244, v244, v232
v_sub_f32 v192, v192, v232
v_sub_f32 v128, v128, v232
v_sub_f32 v144, v144, v232
v_sub_f32 v193, v193, v232
v_sub_f32 v129, v129, v232
v_sub_f32 v145, v145, v232
v_sub_f32 v194, v194, v232
v_sub_f32 v130, v130, v232
v_sub_f32 v146, v146, v232
v_sub_f32 v195, v195, v232
v_sub_f32 v131, v131, v232
v_sub_f32 v147, v147, v232
v_lshlrev_b32 v242, 16, v4
v_and_b32 v243, 0xffff0000, v4
v_mul_f32 v242, v242, v236
v_mul_f32 v243, v243, v236
v_cvt_pk_bf16_f32 v4, v242, v243
v_lshlrev_b32 v242, 16, v5
v_and_b32 v243, 0xffff0000, v5
v_mul_f32 v242, v242, v236
v_mul_f32 v243, v243, v236
v_cvt_pk_bf16_f32 v5, v242, v243
v_lshlrev_b32 v242, 16, v6
v_and_b32 v243, 0xffff0000, v6
v_mul_f32 v242, v242, v236
v_mul_f32 v243, v243, v236
v_cvt_pk_bf16_f32 v6, v242, v243
v_lshlrev_b32 v242, 16, v7
v_and_b32 v243, 0xffff0000, v7
v_mul_f32 v242, v242, v236
v_mul_f32 v243, v243, v236
v_cvt_pk_bf16_f32 v7, v242, v243
v_lshlrev_b32 v242, 16, v8
v_and_b32 v243, 0xffff0000, v8
v_mul_f32 v242, v242, v236
v_mul_f32 v243, v243, v236
v_cvt_pk_bf16_f32 v8, v242, v243
v_lshlrev_b32 v242, 16, v9
v_and_b32 v243, 0xffff0000, v9
v_mul_f32 v242, v242, v236
v_mul_f32 v243, v243, v236
v_cvt_pk_bf16_f32 v9, v242, v243
v_lshlrev_b32 v242, 16, v10
v_and_b32 v243, 0xffff0000, v10
v_mul_f32 v242, v242, v236
v_mul_f32 v243, v243, v236
v_cvt_pk_bf16_f32 v10, v242, v243
v_lshlrev_b32 v242, 16, v11
v_and_b32 v243, 0xffff0000, v11
v_mul_f32 v242, v242, v236
v_mul_f32 v243, v243, v236
v_cvt_pk_bf16_f32 v11, v242, v243
v_lshlrev_b32 v242, 16, v160
v_and_b32 v243, 0xffff0000, v160
v_mul_f32 v242, v242, v236
v_mul_f32 v243, v243, v236
v_cvt_pk_bf16_f32 v160, v242, v243
v_lshlrev_b32 v242, 16, v161
v_and_b32 v243, 0xffff0000, v161
v_mul_f32 v242, v242, v236
v_mul_f32 v243, v243, v236
v_cvt_pk_bf16_f32 v161, v242, v243
v_lshlrev_b32 v242, 16, v162
v_and_b32 v243, 0xffff0000, v162
v_mul_f32 v242, v242, v236
v_mul_f32 v243, v243, v236
v_cvt_pk_bf16_f32 v162, v242, v243
v_lshlrev_b32 v242, 16, v163
v_and_b32 v243, 0xffff0000, v163
v_mul_f32 v242, v242, v236
v_mul_f32 v243, v243, v236
v_cvt_pk_bf16_f32 v163, v242, v243
v_lshlrev_b32 v242, 16, v176
v_and_b32 v243, 0xffff0000, v176
v_mul_f32 v242, v242, v236
v_mul_f32 v243, v243, v236
v_cvt_pk_bf16_f32 v176, v242, v243
v_lshlrev_b32 v242, 16, v177
v_and_b32 v243, 0xffff0000, v177
v_mul_f32 v242, v242, v236
v_mul_f32 v243, v243, v236
v_cvt_pk_bf16_f32 v177, v242, v243
v_lshlrev_b32 v242, 16, v178
v_and_b32 v243, 0xffff0000, v178
v_mul_f32 v242, v242, v236
v_mul_f32 v243, v243, v236
v_cvt_pk_bf16_f32 v178, v242, v243
v_lshlrev_b32 v242, 16, v179
v_and_b32 v243, 0xffff0000, v179
v_mul_f32 v242, v242, v236
v_mul_f32 v243, v243, v236
v_cvt_pk_bf16_f32 v179, v242, v243
v_lshlrev_b32 v242, 16, v0
v_and_b32 v243, 0xffff0000, v0
v_mul_f32 v242, v242, v236
v_mul_f32 v243, v243, v236
v_cvt_pk_bf16_f32 v0, v242, v243
v_lshlrev_b32 v242, 16, v1
v_and_b32 v243, 0xffff0000, v1
v_mul_f32 v242, v242, v236
v_mul_f32 v243, v243, v236
v_cvt_pk_bf16_f32 v1, v242, v243
v_log_f32 v243, v229
v_max3_f32 v233, v148, v149, v150
v_max3_f32 v233, v233, v151, v243
v_mov_b32 v243, v233
s_nop 1
v_permlane32_swap_b32 v233, v243
s_nop 1
v_max_f32 v233, v233, v243
v_mov_b32 v243, v233
s_nop 1
v_permlane16_swap_b32 v233, v243
s_nop 1
v_max_f32 v233, v233, v243
v_ceil_f32 v233, v233
v_max_f32 v233, 0, v233
v_sub_f32 v243, 0, v233
v_exp_f32 v237, v243
s_nop 1
v_mul_f32 v229, v229, v237
v_add_f32 v245, v245, v233
v_sub_f32 v196, v196, v233
v_sub_f32 v132, v132, v233
v_sub_f32 v148, v148, v233
v_sub_f32 v197, v197, v233
v_sub_f32 v133, v133, v233
v_sub_f32 v149, v149, v233
v_sub_f32 v198, v198, v233
v_sub_f32 v134, v134, v233
v_sub_f32 v150, v150, v233
v_sub_f32 v199, v199, v233
v_sub_f32 v135, v135, v233
v_sub_f32 v151, v151, v233
v_lshlrev_b32 v242, 16, v36
v_and_b32 v243, 0xffff0000, v36
v_mul_f32 v242, v242, v237
v_mul_f32 v243, v243, v237
v_cvt_pk_bf16_f32 v36, v242, v243
v_lshlrev_b32 v242, 16, v37
v_and_b32 v243, 0xffff0000, v37
v_mul_f32 v242, v242, v237
v_mul_f32 v243, v243, v237
v_cvt_pk_bf16_f32 v37, v242, v243
v_lshlrev_b32 v242, 16, v38
v_and_b32 v243, 0xffff0000, v38
v_mul_f32 v242, v242, v237
v_mul_f32 v243, v243, v237
v_cvt_pk_bf16_f32 v38, v242, v243
v_lshlrev_b32 v242, 16, v39
v_and_b32 v243, 0xffff0000, v39
v_mul_f32 v242, v242, v237
v_mul_f32 v243, v243, v237
v_cvt_pk_bf16_f32 v39, v242, v243
v_lshlrev_b32 v242, 16, v40
v_and_b32 v243, 0xffff0000, v40
v_mul_f32 v242, v242, v237
v_mul_f32 v243, v243, v237
v_cvt_pk_bf16_f32 v40, v242, v243
v_lshlrev_b32 v242, 16, v41
v_and_b32 v243, 0xffff0000, v41
v_mul_f32 v242, v242, v237
v_mul_f32 v243, v243, v237
v_cvt_pk_bf16_f32 v41, v242, v243
v_lshlrev_b32 v242, 16, v42
v_and_b32 v243, 0xffff0000, v42
v_mul_f32 v242, v242, v237
v_mul_f32 v243, v243, v237
v_cvt_pk_bf16_f32 v42, v242, v243
v_lshlrev_b32 v242, 16, v43
v_and_b32 v243, 0xffff0000, v43
v_mul_f32 v242, v242, v237
v_mul_f32 v243, v243, v237
v_cvt_pk_bf16_f32 v43, v242, v243
v_lshlrev_b32 v242, 16, v164
v_and_b32 v243, 0xffff0000, v164
v_mul_f32 v242, v242, v237
v_mul_f32 v243, v243, v237
v_cvt_pk_bf16_f32 v164, v242, v243
v_lshlrev_b32 v242, 16, v165
v_and_b32 v243, 0xffff0000, v165
v_mul_f32 v242, v242, v237
v_mul_f32 v243, v243, v237
v_cvt_pk_bf16_f32 v165, v242, v243
v_lshlrev_b32 v242, 16, v166
v_and_b32 v243, 0xffff0000, v166
v_mul_f32 v242, v242, v237
v_mul_f32 v243, v243, v237
v_cvt_pk_bf16_f32 v166, v242, v243
v_lshlrev_b32 v242, 16, v167
v_and_b32 v243, 0xffff0000, v167
v_mul_f32 v242, v242, v237
v_mul_f32 v243, v243, v237
v_cvt_pk_bf16_f32 v167, v242, v243
v_lshlrev_b32 v242, 16, v180
v_and_b32 v243, 0xffff0000, v180
v_mul_f32 v242, v242, v237
v_mul_f32 v243, v243, v237
v_cvt_pk_bf16_f32 v180, v242, v243
v_lshlrev_b32 v242, 16, v181
v_and_b32 v243, 0xffff0000, v181
v_mul_f32 v242, v242, v237
v_mul_f32 v243, v243, v237
v_cvt_pk_bf16_f32 v181, v242, v243
v_lshlrev_b32 v242, 16, v182
v_and_b32 v243, 0xffff0000, v182
v_mul_f32 v242, v242, v237
v_mul_f32 v243, v243, v237
v_cvt_pk_bf16_f32 v182, v242, v243
v_lshlrev_b32 v242, 16, v183
v_and_b32 v243, 0xffff0000, v183
v_mul_f32 v242, v242, v237
v_mul_f32 v243, v243, v237
v_cvt_pk_bf16_f32 v183, v242, v243
v_lshlrev_b32 v242, 16, v32
v_and_b32 v243, 0xffff0000, v32
v_mul_f32 v242, v242, v237
v_mul_f32 v243, v243, v237
v_cvt_pk_bf16_f32 v32, v242, v243
v_lshlrev_b32 v242, 16, v33
v_and_b32 v243, 0xffff0000, v33
v_mul_f32 v242, v242, v237
v_mul_f32 v243, v243, v237
v_cvt_pk_bf16_f32 v33, v242, v243
v_log_f32 v243, v230
v_max3_f32 v234, v152, v153, v154
v_max3_f32 v234, v234, v155, v243
v_mov_b32 v243, v234
s_nop 1
v_permlane32_swap_b32 v234, v243
s_nop 1
v_max_f32 v234, v234, v243
v_mov_b32 v243, v234
s_nop 1
v_permlane16_swap_b32 v234, v243
s_nop 1
v_max_f32 v234, v234, v243
v_ceil_f32 v234, v234
v_max_f32 v234, 0, v234
v_sub_f32 v243, 0, v234
v_exp_f32 v238, v243
s_nop 1
v_mul_f32 v230, v230, v238
v_add_f32 v246, v246, v234
v_sub_f32 v200, v200, v234
v_sub_f32 v136, v136, v234
v_sub_f32 v152, v152, v234
v_sub_f32 v201, v201, v234
v_sub_f32 v137, v137, v234
v_sub_f32 v153, v153, v234
v_sub_f32 v202, v202, v234
v_sub_f32 v138, v138, v234
v_sub_f32 v154, v154, v234
v_sub_f32 v203, v203, v234
v_sub_f32 v139, v139, v234
v_sub_f32 v155, v155, v234
v_lshlrev_b32 v242, 16, v68
v_and_b32 v243, 0xffff0000, v68
v_mul_f32 v242, v242, v238
v_mul_f32 v243, v243, v238
v_cvt_pk_bf16_f32 v68, v242, v243
v_lshlrev_b32 v242, 16, v69
v_and_b32 v243, 0xffff0000, v69
v_mul_f32 v242, v242, v238
v_mul_f32 v243, v243, v238
v_cvt_pk_bf16_f32 v69, v242, v243
v_lshlrev_b32 v242, 16, v70
v_and_b32 v243, 0xffff0000, v70
v_mul_f32 v242, v242, v238
v_mul_f32 v243, v243, v238
v_cvt_pk_bf16_f32 v70, v242, v243
v_lshlrev_b32 v242, 16, v71
v_and_b32 v243, 0xffff0000, v71
v_mul_f32 v242, v242, v238
v_mul_f32 v243, v243, v238
v_cvt_pk_bf16_f32 v71, v242, v243
v_lshlrev_b32 v242, 16, v72
v_and_b32 v243, 0xffff0000, v72
v_mul_f32 v242, v242, v238
v_mul_f32 v243, v243, v238
v_cvt_pk_bf16_f32 v72, v242, v243
v_lshlrev_b32 v242, 16, v73
v_and_b32 v243, 0xffff0000, v73
v_mul_f32 v242, v242, v238
v_mul_f32 v243, v243, v238
v_cvt_pk_bf16_f32 v73, v242, v243
v_lshlrev_b32 v242, 16, v74
v_and_b32 v243, 0xffff0000, v74
v_mul_f32 v242, v242, v238
v_mul_f32 v243, v243, v238
v_cvt_pk_bf16_f32 v74, v242, v243
v_lshlrev_b32 v242, 16, v75
v_and_b32 v243, 0xffff0000, v75
v_mul_f32 v242, v242, v238
v_mul_f32 v243, v243, v238
v_cvt_pk_bf16_f32 v75, v242, v243
v_lshlrev_b32 v242, 16, v168
v_and_b32 v243, 0xffff0000, v168
v_mul_f32 v242, v242, v238
v_mul_f32 v243, v243, v238
v_cvt_pk_bf16_f32 v168, v242, v243
v_lshlrev_b32 v242, 16, v169
v_and_b32 v243, 0xffff0000, v169
v_mul_f32 v242, v242, v238
v_mul_f32 v243, v243, v238
v_cvt_pk_bf16_f32 v169, v242, v243
v_lshlrev_b32 v242, 16, v170
v_and_b32 v243, 0xffff0000, v170
v_mul_f32 v242, v242, v238
v_mul_f32 v243, v243, v238
v_cvt_pk_bf16_f32 v170, v242, v243
v_lshlrev_b32 v242, 16, v171
v_and_b32 v243, 0xffff0000, v171
v_mul_f32 v242, v242, v238
v_mul_f32 v243, v243, v238
v_cvt_pk_bf16_f32 v171, v242, v243
v_lshlrev_b32 v242, 16, v184
v_and_b32 v243, 0xffff0000, v184
v_mul_f32 v242, v242, v238
v_mul_f32 v243, v243, v238
v_cvt_pk_bf16_f32 v184, v242, v243
v_lshlrev_b32 v242, 16, v185
v_and_b32 v243, 0xffff0000, v185
v_mul_f32 v242, v242, v238
v_mul_f32 v243, v243, v238
v_cvt_pk_bf16_f32 v185, v242, v243
v_lshlrev_b32 v242, 16, v186
v_and_b32 v243, 0xffff0000, v186
v_mul_f32 v242, v242, v238
v_mul_f32 v243, v243, v238
v_cvt_pk_bf16_f32 v186, v242, v243
v_lshlrev_b32 v242, 16, v187
v_and_b32 v243, 0xffff0000, v187
v_mul_f32 v242, v242, v238
v_mul_f32 v243, v243, v238
v_cvt_pk_bf16_f32 v187, v242, v243
v_lshlrev_b32 v242, 16, v64
v_and_b32 v243, 0xffff0000, v64
v_mul_f32 v242, v242, v238
v_mul_f32 v243, v243, v238
v_cvt_pk_bf16_f32 v64, v242, v243
v_lshlrev_b32 v242, 16, v65
v_and_b32 v243, 0xffff0000, v65
v_mul_f32 v242, v242, v238
v_mul_f32 v243, v243, v238
v_cvt_pk_bf16_f32 v65, v242, v243
v_log_f32 v243, v231
v_max3_f32 v235, v156, v157, v158
v_max3_f32 v235, v235, v159, v243
v_mov_b32 v243, v235
s_nop 1
v_permlane32_swap_b32 v235, v243
s_nop 1
v_max_f32 v235, v235, v243
v_mov_b32 v243, v235
s_nop 1
v_permlane16_swap_b32 v235, v243
s_nop 1
v_max_f32 v235, v235, v243
v_ceil_f32 v235, v235
v_max_f32 v235, 0, v235
v_sub_f32 v243, 0, v235
v_exp_f32 v239, v243
s_nop 1
v_mul_f32 v231, v231, v239
v_add_f32 v247, v247, v235
v_sub_f32 v204, v204, v235
v_sub_f32 v140, v140, v235
v_sub_f32 v156, v156, v235
v_sub_f32 v205, v205, v235
v_sub_f32 v141, v141, v235
v_sub_f32 v157, v157, v235
v_sub_f32 v206, v206, v235
v_sub_f32 v142, v142, v235
v_sub_f32 v158, v158, v235
v_sub_f32 v207, v207, v235
v_sub_f32 v143, v143, v235
v_sub_f32 v159, v159, v235
v_lshlrev_b32 v242, 16, v100
v_and_b32 v243, 0xffff0000, v100
v_mul_f32 v242, v242, v239
v_mul_f32 v243, v243, v239
v_cvt_pk_bf16_f32 v100, v242, v243
v_lshlrev_b32 v242, 16, v101
v_and_b32 v243, 0xffff0000, v101
v_mul_f32 v242, v242, v239
v_mul_f32 v243, v243, v239
v_cvt_pk_bf16_f32 v101, v242, v243
v_lshlrev_b32 v242, 16, v102
v_and_b32 v243, 0xffff0000, v102
v_mul_f32 v242, v242, v239
v_mul_f32 v243, v243, v239
v_cvt_pk_bf16_f32 v102, v242, v243
v_lshlrev_b32 v242, 16, v103
v_and_b32 v243, 0xffff0000, v103
v_mul_f32 v242, v242, v239
v_mul_f32 v243, v243, v239
v_cvt_pk_bf16_f32 v103, v242, v243
v_lshlrev_b32 v242, 16, v104
v_and_b32 v243, 0xffff0000, v104
v_mul_f32 v242, v242, v239
v_mul_f32 v243, v243, v239
v_cvt_pk_bf16_f32 v104, v242, v243
v_lshlrev_b32 v242, 16, v105
v_and_b32 v243, 0xffff0000, v105
v_mul_f32 v242, v242, v239
v_mul_f32 v243, v243, v239
v_cvt_pk_bf16_f32 v105, v242, v243
v_lshlrev_b32 v242, 16, v106
v_and_b32 v243, 0xffff0000, v106
v_mul_f32 v242, v242, v239
v_mul_f32 v243, v243, v239
v_cvt_pk_bf16_f32 v106, v242, v243
v_lshlrev_b32 v242, 16, v107
v_and_b32 v243, 0xffff0000, v107
v_mul_f32 v242, v242, v239
v_mul_f32 v243, v243, v239
v_cvt_pk_bf16_f32 v107, v242, v243
v_lshlrev_b32 v242, 16, v172
v_and_b32 v243, 0xffff0000, v172
v_mul_f32 v242, v242, v239
v_mul_f32 v243, v243, v239
v_cvt_pk_bf16_f32 v172, v242, v243
v_lshlrev_b32 v242, 16, v173
v_and_b32 v243, 0xffff0000, v173
v_mul_f32 v242, v242, v239
v_mul_f32 v243, v243, v239
v_cvt_pk_bf16_f32 v173, v242, v243
v_lshlrev_b32 v242, 16, v174
v_and_b32 v243, 0xffff0000, v174
v_mul_f32 v242, v242, v239
v_mul_f32 v243, v243, v239
v_cvt_pk_bf16_f32 v174, v242, v243
v_lshlrev_b32 v242, 16, v175
v_and_b32 v243, 0xffff0000, v175
v_mul_f32 v242, v242, v239
v_mul_f32 v243, v243, v239
v_cvt_pk_bf16_f32 v175, v242, v243
v_lshlrev_b32 v242, 16, v188
v_and_b32 v243, 0xffff0000, v188
v_mul_f32 v242, v242, v239
v_mul_f32 v243, v243, v239
v_cvt_pk_bf16_f32 v188, v242, v243
v_lshlrev_b32 v242, 16, v189
v_and_b32 v243, 0xffff0000, v189
v_mul_f32 v242, v242, v239
v_mul_f32 v243, v243, v239
v_cvt_pk_bf16_f32 v189, v242, v243
v_lshlrev_b32 v242, 16, v190
v_and_b32 v243, 0xffff0000, v190
v_mul_f32 v242, v242, v239
v_mul_f32 v243, v243, v239
v_cvt_pk_bf16_f32 v190, v242, v243
v_lshlrev_b32 v242, 16, v191
v_and_b32 v243, 0xffff0000, v191
v_mul_f32 v242, v242, v239
v_mul_f32 v243, v243, v239
v_cvt_pk_bf16_f32 v191, v242, v243
v_lshlrev_b32 v242, 16, v96
v_and_b32 v243, 0xffff0000, v96
v_mul_f32 v242, v242, v239
v_mul_f32 v243, v243, v239
v_cvt_pk_bf16_f32 v96, v242, v243
v_lshlrev_b32 v242, 16, v97
v_and_b32 v243, 0xffff0000, v97
v_mul_f32 v242, v242, v239
v_mul_f32 v243, v243, v239
v_cvt_pk_bf16_f32 v97, v242, v243
v_exp_f32 v232, v144
v_exp_f32 v233, v145
v_exp_f32 v234, v146
v_exp_f32 v235, v147
s_nop 1
v_add_f32 v224, v228, v232
v_add_f32 v224, v224, v233
v_add_f32 v224, v224, v234
v_add_f32 v224, v224, v235
v_cvt_pk_bf16_f32 v2, v232, v233
v_cvt_pk_bf16_f32 v3, v234, v235
v_exp_f32 v232, v148
v_exp_f32 v233, v149
v_exp_f32 v234, v150
v_exp_f32 v235, v151
s_nop 1
v_add_f32 v225, v229, v232
v_add_f32 v225, v225, v233
v_add_f32 v225, v225, v234
v_add_f32 v225, v225, v235
v_cvt_pk_bf16_f32 v34, v232, v233
v_cvt_pk_bf16_f32 v35, v234, v235
v_exp_f32 v232, v152
v_exp_f32 v233, v153
v_exp_f32 v234, v154
v_exp_f32 v235, v155
s_nop 1
v_add_f32 v226, v230, v232
v_add_f32 v226, v226, v233
v_add_f32 v226, v226, v234
v_add_f32 v226, v226, v235
v_cvt_pk_bf16_f32 v66, v232, v233
v_cvt_pk_bf16_f32 v67, v234, v235
v_exp_f32 v232, v156
v_exp_f32 v233, v157
v_exp_f32 v234, v158
v_exp_f32 v235, v159
s_nop 1
v_add_f32 v227, v231, v232
v_add_f32 v227, v227, v233
v_add_f32 v227, v227, v234
v_add_f32 v227, v227, v235
v_cvt_pk_bf16_f32 v98, v232, v233
v_cvt_pk_bf16_f32 v99, v234, v235
s_branch L2_rare_common
LF_hl_0:
s_mov_b32 s94, 0x10000
s_mov_b32 s3, 0x7c28000
LF_hl2_0:
v_lshlrev_b32 v241, 3, v248
buffer_load_dwordx2 v[240:241], v241, s[16:19], s3 offen sc1
s_sub_u32 s94, s94, 1
s_waitcnt vmcnt(0)
s_cbranch_scc1 LF_hlret_0
v_cmp_ne_u64_e64 s[38:39], s[98:99], v[240:241]
s_and_b64 s[38:39], s[38:39], s[96:97]
s_cbranch_scc1 LF_hl2_0
s_branch LF_hlret_0
L2_rare_site12:
s_mov_b32 s36, 12
s_branch L2_rare_t1_0_0
L2_rare_t1_0_0:
s_nop 15
s_nop 15
s_waitcnt lgkmcnt(0)
v_log_f32 v243, v224
v_max3_f32 v232, v128, v129, v130
v_max3_f32 v232, v232, v131, v243
v_mov_b32 v243, v232
s_nop 1
v_permlane32_swap_b32 v232, v243
s_nop 1
v_max_f32 v232, v232, v243
v_mov_b32 v243, v232
s_nop 1
v_permlane16_swap_b32 v232, v243
s_nop 1
v_max_f32 v232, v232, v243
v_ceil_f32 v232, v232
v_max_f32 v232, 0, v232
v_sub_f32 v243, 0, v232
v_exp_f32 v236, v243
s_nop 1
v_mul_f32 v224, v224, v236
v_add_f32 v244, v244, v232
v_sub_f32 v192, v192, v232
v_sub_f32 v128, v128, v232
v_sub_f32 v144, v144, v232
v_sub_f32 v193, v193, v232
v_sub_f32 v129, v129, v232
v_sub_f32 v145, v145, v232
v_sub_f32 v194, v194, v232
v_sub_f32 v130, v130, v232
v_sub_f32 v146, v146, v232
v_sub_f32 v195, v195, v232
v_sub_f32 v131, v131, v232
v_sub_f32 v147, v147, v232
ds_read_b64 v[254:255], v253 offset:0
s_waitcnt lgkmcnt(0)
v_lshlrev_b32 v242, 16, v254
v_and_b32 v243, 0xffff0000, v254
v_mul_f32 v242, v242, v236
v_mul_f32 v243, v243, v236
v_cvt_pk_bf16_f32 v254, v242, v243
v_lshlrev_b32 v242, 16, v255
v_and_b32 v243, 0xffff0000, v255
v_mul_f32 v242, v242, v236
v_mul_f32 v243, v243, v236
v_cvt_pk_bf16_f32 v255, v242, v243
ds_write_b64 v253, v[254:255] offset:0
s_waitcnt lgkmcnt(0)
ds_read_b64 v[254:255], v253 offset:8
s_waitcnt lgkmcnt(0)
v_lshlrev_b32 v242, 16, v254
v_and_b32 v243, 0xffff0000, v254
v_mul_f32 v242, v242, v236
v_mul_f32 v243, v243, v236
v_cvt_pk_bf16_f32 v254, v242, v243
v_lshlrev_b32 v242, 16, v255
v_and_b32 v243, 0xffff0000, v255
v_mul_f32 v242, v242, v236
v_mul_f32 v243, v243, v236
v_cvt_pk_bf16_f32 v255, v242, v243
ds_write_b64 v253, v[254:255] offset:8
s_waitcnt lgkmcnt(0)
v_log_f32 v243, v225
v_max3_f32 v233, v132, v133, v134
v_max3_f32 v233, v233, v135, v243
v_mov_b32 v243, v233
s_nop 1
v_permlane32_swap_b32 v233, v243
s_nop 1
v_max_f32 v233, v233, v243
v_mov_b32 v243, v233
s_nop 1
v_permlane16_swap_b32 v233, v243
s_nop 1
v_max_f32 v233, v233, v243
v_ceil_f32 v233, v233
v_max_f32 v233, 0, v233
v_sub_f32 v243, 0, v233
v_exp_f32 v237, v243
s_nop 1
v_mul_f32 v225, v225, v237
v_add_f32 v245, v245, v233
v_sub_f32 v196, v196, v233
v_sub_f32 v132, v132, v233
v_sub_f32 v148, v148, v233
v_sub_f32 v197, v197, v233
v_sub_f32 v133, v133, v233
v_sub_f32 v149, v149, v233
v_sub_f32 v198, v198, v233
v_sub_f32 v134, v134, v233
v_sub_f32 v150, v150, v233
v_sub_f32 v199, v199, v233
v_sub_f32 v135, v135, v233
v_sub_f32 v151, v151, v233
ds_read_b64 v[254:255], v253 offset:1024
s_waitcnt lgkmcnt(0)
v_lshlrev_b32 v242, 16, v254
v_and_b32 v243, 0xffff0000, v254
v_mul_f32 v242, v242, v237
v_mul_f32 v243, v243, v237
v_cvt_pk_bf16_f32 v254, v242, v243
v_lshlrev_b32 v242, 16, v255
v_and_b32 v243, 0xffff0000, v255
v_mul_f32 v242, v242, v237
v_mul_f32 v243, v243, v237
v_cvt_pk_bf16_f32 v255, v242, v243
ds_write_b64 v253, v[254:255] offset:1024
s_waitcnt lgkmcnt(0)
ds_read_b64 v[254:255], v253 offset:1032
s_waitcnt lgkmcnt(0)
v_lshlrev_b32 v242, 16, v254
v_and_b32 v243, 0xffff0000, v254
v_mul_f32 v242, v242, v237
v_mul_f32 v243, v243, v237
v_cvt_pk_bf16_f32 v254, v242, v243
v_lshlrev_b32 v242, 16, v255
v_and_b32 v243, 0xffff0000, v255
v_mul_f32 v242, v242, v237
v_mul_f32 v243, v243, v237
v_cvt_pk_bf16_f32 v255, v242, v243
ds_write_b64 v253, v[254:255] offset:1032
s_waitcnt lgkmcnt(0)
v_log_f32 v243, v226
v_max3_f32 v234, v136, v137, v138
v_max3_f32 v234, v234, v139, v243
v_mov_b32 v243, v234
s_nop 1
v_permlane32_swap_b32 v234, v243
s_nop 1
v_max_f32 v234, v234, v243
v_mov_b32 v243, v234
s_nop 1
v_permlane16_swap_b32 v234, v243
s_nop 1
v_max_f32 v234, v234, v243
v_ceil_f32 v234, v234
v_max_f32 v234, 0, v234
v_sub_f32 v243, 0, v234
v_exp_f32 v238, v243
s_nop 1
v_mul_f32 v226, v226, v238
v_add_f32 v246, v246, v234
v_sub_f32 v200, v200, v234
v_sub_f32 v136, v136, v234
v_sub_f32 v152, v152, v234
v_sub_f32 v201, v201, v234
v_sub_f32 v137, v137, v234
v_sub_f32 v153, v153, v234
v_sub_f32 v202, v202, v234
v_sub_f32 v138, v138, v234
v_sub_f32 v154, v154, v234
v_sub_f32 v203, v203, v234
v_sub_f32 v139, v139, v234
v_sub_f32 v155, v155, v234
ds_read_b64 v[254:255], v253 offset:2048
s_waitcnt lgkmcnt(0)
v_lshlrev_b32 v242, 16, v254
v_and_b32 v243, 0xffff0000, v254
v_mul_f32 v242, v242, v238
v_mul_f32 v243, v243, v238
v_cvt_pk_bf16_f32 v254, v242, v243
v_lshlrev_b32 v242, 16, v255
v_and_b32 v243, 0xffff0000, v255
v_mul_f32 v242, v242, v238
v_mul_f32 v243, v243, v238
v_cvt_pk_bf16_f32 v255, v242, v243
ds_write_b64 v253, v[254:255] offset:2048
s_waitcnt lgkmcnt(0)
ds_read_b64 v[254:255], v253 offset:2056
s_waitcnt lgkmcnt(0)
v_lshlrev_b32 v242, 16, v254
v_and_b32 v243, 0xffff0000, v254
v_mul_f32 v242, v242, v238
v_mul_f32 v243, v243, v238
v_cvt_pk_bf16_f32 v254, v242, v243
v_lshlrev_b32 v242, 16, v255
v_and_b32 v243, 0xffff0000, v255
v_mul_f32 v242, v242, v238
v_mul_f32 v243, v243, v238
v_cvt_pk_bf16_f32 v255, v242, v243
ds_write_b64 v253, v[254:255] offset:2056
s_waitcnt lgkmcnt(0)
v_log_f32 v243, v227
v_max3_f32 v235, v140, v141, v142
v_max3_f32 v235, v235, v143, v243
v_mov_b32 v243, v235
s_nop 1
v_permlane32_swap_b32 v235, v243
s_nop 1
v_max_f32 v235, v235, v243
v_mov_b32 v243, v235
s_nop 1
v_permlane16_swap_b32 v235, v243
s_nop 1
v_max_f32 v235, v235, v243
v_ceil_f32 v235, v235
v_max_f32 v235, 0, v235
v_sub_f32 v243, 0, v235
v_exp_f32 v239, v243
s_nop 1
v_mul_f32 v227, v227, v239
v_add_f32 v247, v247, v235
v_sub_f32 v204, v204, v235
v_sub_f32 v140, v140, v235
v_sub_f32 v156, v156, v235
v_sub_f32 v205, v205, v235
v_sub_f32 v141, v141, v235
v_sub_f32 v157, v157, v235
v_sub_f32 v206, v206, v235
v_sub_f32 v142, v142, v235
v_sub_f32 v158, v158, v235
v_sub_f32 v207, v207, v235
v_sub_f32 v143, v143, v235
v_sub_f32 v159, v159, v235
ds_read_b64 v[254:255], v253 offset:3072
s_waitcnt lgkmcnt(0)
v_lshlrev_b32 v242, 16, v254
v_and_b32 v243, 0xffff0000, v254
v_mul_f32 v242, v242, v239
v_mul_f32 v243, v243, v239
v_cvt_pk_bf16_f32 v254, v242, v243
v_lshlrev_b32 v242, 16, v255
v_and_b32 v243, 0xffff0000, v255
v_mul_f32 v242, v242, v239
v_mul_f32 v243, v243, v239
v_cvt_pk_bf16_f32 v255, v242, v243
ds_write_b64 v253, v[254:255] offset:3072
s_waitcnt lgkmcnt(0)
ds_read_b64 v[254:255], v253 offset:3080
s_waitcnt lgkmcnt(0)
v_lshlrev_b32 v242, 16, v254
v_and_b32 v243, 0xffff0000, v254
v_mul_f32 v242, v242, v239
v_mul_f32 v243, v243, v239
v_cvt_pk_bf16_f32 v254, v242, v243
v_lshlrev_b32 v242, 16, v255
v_and_b32 v243, 0xffff0000, v255
v_mul_f32 v242, v242, v239
v_mul_f32 v243, v243, v239
v_cvt_pk_bf16_f32 v255, v242, v243
ds_write_b64 v253, v[254:255] offset:3080
s_waitcnt lgkmcnt(0)
v_exp_f32 v232, v128
v_exp_f32 v233, v129
v_exp_f32 v234, v130
v_exp_f32 v235, v131
s_nop 1
v_add_f32 v228, v224, v232
v_add_f32 v228, v228, v233
v_add_f32 v228, v228, v234
v_add_f32 v228, v228, v235
v_cvt_pk_bf16_f32 v160, v232, v233
v_cvt_pk_bf16_f32 v161, v234, v235
v_exp_f32 v232, v132
v_exp_f32 v233, v133
v_exp_f32 v234, v134
v_exp_f32 v235, v135
s_nop 1
v_add_f32 v229, v225, v232
v_add_f32 v229, v229, v233
v_add_f32 v229, v229, v234
v_add_f32 v229, v229, v235
v_cvt_pk_bf16_f32 v164, v232, v233
v_cvt_pk_bf16_f32 v165, v234, v235
v_exp_f32 v232, v136
v_exp_f32 v233, v137
v_exp_f32 v234, v138
v_exp_f32 v235, v139
s_nop 1
v_add_f32 v230, v226, v232
v_add_f32 v230, v230, v233
v_add_f32 v230, v230, v234
v_add_f32 v230, v230, v235
v_cvt_pk_bf16_f32 v168, v232, v233
v_cvt_pk_bf16_f32 v169, v234, v235
v_exp_f32 v232, v140
v_exp_f32 v233, v141
v_exp_f32 v234, v142
v_exp_f32 v235, v143
s_nop 1
v_add_f32 v231, v227, v232
v_add_f32 v231, v231, v233
v_add_f32 v231, v231, v234
v_add_f32 v231, v231, v235
v_cvt_pk_bf16_f32 v172, v232, v233
v_cvt_pk_bf16_f32 v173, v234, v235
s_branch L2_rare_common
L2_rare_site13:
s_mov_b32 s36, 13
s_branch L2_rare_t1_1_1
L2_rare_t1_1_1:
s_nop 15
s_nop 15
s_waitcnt lgkmcnt(0)
v_log_f32 v243, v228
v_max3_f32 v232, v144, v145, v146
v_max3_f32 v232, v232, v147, v243
v_mov_b32 v243, v232
s_nop 1
v_permlane32_swap_b32 v232, v243
s_nop 1
v_max_f32 v232, v232, v243
v_mov_b32 v243, v232
s_nop 1
v_permlane16_swap_b32 v232, v243
s_nop 1
v_max_f32 v232, v232, v243
v_ceil_f32 v232, v232
v_max_f32 v232, 0, v232
v_sub_f32 v243, 0, v232
v_exp_f32 v236, v243
s_nop 1
v_mul_f32 v228, v228, v236
v_add_f32 v244, v244, v232
v_sub_f32 v192, v192, v232
v_sub_f32 v128, v128, v232
v_sub_f32 v144, v144, v232
v_sub_f32 v193, v193, v232
v_sub_f32 v129, v129, v232
v_sub_f32 v145, v145, v232
v_sub_f32 v194, v194, v232
v_sub_f32 v130, v130, v232
v_sub_f32 v146, v146, v232
v_sub_f32 v195, v195, v232
v_sub_f32 v131, v131, v232
v_sub_f32 v147, v147, v232
v_lshlrev_b32 v242, 16, v160
v_and_b32 v243, 0xffff0000, v160
v_mul_f32 v242, v242, v236
v_mul_f32 v243, v243, v236
v_cvt_pk_bf16_f32 v160, v242, v243
v_lshlrev_b32 v242, 16, v161
v_and_b32 v243, 0xffff0000, v161
v_mul_f32 v242, v242, v236
v_mul_f32 v243, v243, v236
v_cvt_pk_bf16_f32 v161, v242, v243
ds_read_b64 v[254:255], v253 offset:0
s_waitcnt lgkmcnt(0)
v_lshlrev_b32 v242, 16, v254
v_and_b32 v243, 0xffff0000, v254
v_mul_f32 v242, v242, v236
v_mul_f32 v243, v243, v236
v_cvt_pk_bf16_f32 v254, v242, v243
v_lshlrev_b32 v242, 16, v255
v_and_b32 v243, 0xffff0000, v255
v_mul_f32 v242, v242, v236
v_mul_f32 v243, v243, v236
v_cvt_pk_bf16_f32 v255, v242, v243
ds_write_b64 v253, v[254:255] offset:0
s_waitcnt lgkmcnt(0)
ds_read_b64 v[254:255], v253 offset:8
s_waitcnt lgkmcnt(0)
v_lshlrev_b32 v242, 16, v254
v_and_b32 v243, 0xffff0000, v254
v_mul_f32 v242, v242, v236
v_mul_f32 v243, v243, v236
v_cvt_pk_bf16_f32 v254, v242, v243
v_lshlrev_b32 v242, 16, v255
v_and_b32 v243, 0xffff0000, v255
v_mul_f32 v242, v242, v236
v_mul_f32 v243, v243, v236
v_cvt_pk_bf16_f32 v255, v242, v243
ds_write_b64 v253, v[254:255] offset:8
s_waitcnt lgkmcnt(0)
v_log_f32 v243, v229
v_max3_f32 v233, v148, v149, v150
v_max3_f32 v233, v233, v151, v243
v_mov_b32 v243, v233
s_nop 1
v_permlane32_swap_b32 v233, v243
s_nop 1
v_max_f32 v233, v233, v243
v_mov_b32 v243, v233
s_nop 1
v_permlane16_swap_b32 v233, v243
s_nop 1
v_max_f32 v233, v233, v243
v_ceil_f32 v233, v233
v_max_f32 v233, 0, v233
v_sub_f32 v243, 0, v233
v_exp_f32 v237, v243
s_nop 1
v_mul_f32 v229, v229, v237
v_add_f32 v245, v245, v233
v_sub_f32 v196, v196, v233
v_sub_f32 v132, v132, v233
v_sub_f32 v148, v148, v233
v_sub_f32 v197, v197, v233
v_sub_f32 v133, v133, v233
v_sub_f32 v149, v149, v233
v_sub_f32 v198, v198, v233
v_sub_f32 v134, v134, v233
v_sub_f32 v150, v150, v233
v_sub_f32 v199, v199, v233
v_sub_f32 v135, v135, v233
v_sub_f32 v151, v151, v233
v_lshlrev_b32 v242, 16, v164
v_and_b32 v243, 0xffff0000, v164
v_mul_f32 v242, v242, v237
v_mul_f32 v243, v243, v237
v_cvt_pk_bf16_f32 v164, v242, v243
v_lshlrev_b32 v242, 16, v165
v_and_b32 v243, 0xffff0000, v165
v_mul_f32 v242, v242, v237
v_mul_f32 v243, v243, v237
v_cvt_pk_bf16_f32 v165, v242, v243
ds_read_b64 v[254:255], v253 offset:1024
s_waitcnt lgkmcnt(0)
v_lshlrev_b32 v242, 16, v254
v_and_b32 v243, 0xffff0000, v254
v_mul_f32 v242, v242, v237
v_mul_f32 v243, v243, v237
v_cvt_pk_bf16_f32 v254, v242, v243
v_lshlrev_b32 v242, 16, v255
v_and_b32 v243, 0xffff0000, v255
v_mul_f32 v242, v242, v237
v_mul_f32 v243, v243, v237
v_cvt_pk_bf16_f32 v255, v242, v243
ds_write_b64 v253, v[254:255] offset:1024
s_waitcnt lgkmcnt(0)
ds_read_b64 v[254:255], v253 offset:1032
s_waitcnt lgkmcnt(0)
v_lshlrev_b32 v242, 16, v254
v_and_b32 v243, 0xffff0000, v254
v_mul_f32 v242, v242, v237
v_mul_f32 v243, v243, v237
v_cvt_pk_bf16_f32 v254, v242, v243
v_lshlrev_b32 v242, 16, v255
v_and_b32 v243, 0xffff0000, v255
v_mul_f32 v242, v242, v237
v_mul_f32 v243, v243, v237
v_cvt_pk_bf16_f32 v255, v242, v243
ds_write_b64 v253, v[254:255] offset:1032
s_waitcnt lgkmcnt(0)
v_log_f32 v243, v230
v_max3_f32 v234, v152, v153, v154
v_max3_f32 v234, v234, v155, v243
v_mov_b32 v243, v234
s_nop 1
v_permlane32_swap_b32 v234, v243
s_nop 1
v_max_f32 v234, v234, v243
v_mov_b32 v243, v234
s_nop 1
v_permlane16_swap_b32 v234, v243
s_nop 1
v_max_f32 v234, v234, v243
v_ceil_f32 v234, v234
v_max_f32 v234, 0, v234
v_sub_f32 v243, 0, v234
v_exp_f32 v238, v243
s_nop 1
v_mul_f32 v230, v230, v238
v_add_f32 v246, v246, v234
v_sub_f32 v200, v200, v234
v_sub_f32 v136, v136, v234
v_sub_f32 v152, v152, v234
v_sub_f32 v201, v201, v234
v_sub_f32 v137, v137, v234
v_sub_f32 v153, v153, v234
v_sub_f32 v202, v202, v234
v_sub_f32 v138, v138, v234
v_sub_f32 v154, v154, v234
v_sub_f32 v203, v203, v234
v_sub_f32 v139, v139, v234
v_sub_f32 v155, v155, v234
v_lshlrev_b32 v242, 16, v168
v_and_b32 v243, 0xffff0000, v168
v_mul_f32 v242, v242, v238
v_mul_f32 v243, v243, v238
v_cvt_pk_bf16_f32 v168, v242, v243
v_lshlrev_b32 v242, 16, v169
v_and_b32 v243, 0xffff0000, v169
v_mul_f32 v242, v242, v238
v_mul_f32 v243, v243, v238
v_cvt_pk_bf16_f32 v169, v242, v243
ds_read_b64 v[254:255], v253 offset:2048
s_waitcnt lgkmcnt(0)
v_lshlrev_b32 v242, 16, v254
v_and_b32 v243, 0xffff0000, v254
v_mul_f32 v242, v242, v238
v_mul_f32 v243, v243, v238
v_cvt_pk_bf16_f32 v254, v242, v243
v_lshlrev_b32 v242, 16, v255
v_and_b32 v243, 0xffff0000, v255
v_mul_f32 v242, v242, v238
v_mul_f32 v243, v243, v238
v_cvt_pk_bf16_f32 v255, v242, v243
ds_write_b64 v253, v[254:255] offset:2048
s_waitcnt lgkmcnt(0)
ds_read_b64 v[254:255], v253 offset:2056
s_waitcnt lgkmcnt(0)
v_lshlrev_b32 v242, 16, v254
v_and_b32 v243, 0xffff0000, v254
v_mul_f32 v242, v242, v238
v_mul_f32 v243, v243, v238
v_cvt_pk_bf16_f32 v254, v242, v243
v_lshlrev_b32 v242, 16, v255
v_and_b32 v243, 0xffff0000, v255
v_mul_f32 v242, v242, v238
v_mul_f32 v243, v243, v238
v_cvt_pk_bf16_f32 v255, v242, v243
ds_write_b64 v253, v[254:255] offset:2056
s_waitcnt lgkmcnt(0)
v_log_f32 v243, v231
v_max3_f32 v235, v156, v157, v158
v_max3_f32 v235, v235, v159, v243
v_mov_b32 v243, v235
s_nop 1
v_permlane32_swap_b32 v235, v243
s_nop 1
v_max_f32 v235, v235, v243
v_mov_b32 v243, v235
s_nop 1
v_permlane16_swap_b32 v235, v243
s_nop 1
v_max_f32 v235, v235, v243
v_ceil_f32 v235, v235
v_max_f32 v235, 0, v235
v_sub_f32 v243, 0, v235
v_exp_f32 v239, v243
s_nop 1
v_mul_f32 v231, v231, v239
v_add_f32 v247, v247, v235
v_sub_f32 v204, v204, v235
v_sub_f32 v140, v140, v235
v_sub_f32 v156, v156, v235
v_sub_f32 v205, v205, v235
v_sub_f32 v141, v141, v235
v_sub_f32 v157, v157, v235
v_sub_f32 v206, v206, v235
v_sub_f32 v142, v142, v235
v_sub_f32 v158, v158, v235
v_sub_f32 v207, v207, v235
v_sub_f32 v143, v143, v235
v_sub_f32 v159, v159, v235
v_lshlrev_b32 v242, 16, v172
v_and_b32 v243, 0xffff0000, v172
v_mul_f32 v242, v242, v239
v_mul_f32 v243, v243, v239
v_cvt_pk_bf16_f32 v172, v242, v243
v_lshlrev_b32 v242, 16, v173
v_and_b32 v243, 0xffff0000, v173
v_mul_f32 v242, v242, v239
v_mul_f32 v243, v243, v239
v_cvt_pk_bf16_f32 v173, v242, v243
ds_read_b64 v[254:255], v253 offset:3072
s_waitcnt lgkmcnt(0)
v_lshlrev_b32 v242, 16, v254
v_and_b32 v243, 0xffff0000, v254
v_mul_f32 v242, v242, v239
v_mul_f32 v243, v243, v239
v_cvt_pk_bf16_f32 v254, v242, v243
v_lshlrev_b32 v242, 16, v255
v_and_b32 v243, 0xffff0000, v255
v_mul_f32 v242, v242, v239
v_mul_f32 v243, v243, v239
v_cvt_pk_bf16_f32 v255, v242, v243
ds_write_b64 v253, v[254:255] offset:3072
s_waitcnt lgkmcnt(0)
ds_read_b64 v[254:255], v253 offset:3080
s_waitcnt lgkmcnt(0)
v_lshlrev_b32 v242, 16, v254
v_and_b32 v243, 0xffff0000, v254
v_mul_f32 v242, v242, v239
v_mul_f32 v243, v243, v239
v_cvt_pk_bf16_f32 v254, v242, v243
v_lshlrev_b32 v242, 16, v255
v_and_b32 v243, 0xffff0000, v255
v_mul_f32 v242, v242, v239
v_mul_f32 v243, v243, v239
v_cvt_pk_bf16_f32 v255, v242, v243
ds_write_b64 v253, v[254:255] offset:3080
s_waitcnt lgkmcnt(0)
v_exp_f32 v232, v144
v_exp_f32 v233, v145
v_exp_f32 v234, v146
v_exp_f32 v235, v147
s_nop 1
v_add_f32 v224, v228, v232
v_add_f32 v224, v224, v233
v_add_f32 v224, v224, v234
v_add_f32 v224, v224, v235
v_cvt_pk_bf16_f32 v162, v232, v233
v_cvt_pk_bf16_f32 v163, v234, v235
v_exp_f32 v232, v148
v_exp_f32 v233, v149
v_exp_f32 v234, v150
v_exp_f32 v235, v151
s_nop 1
v_add_f32 v225, v229, v232
v_add_f32 v225, v225, v233
v_add_f32 v225, v225, v234
v_add_f32 v225, v225, v235
v_cvt_pk_bf16_f32 v166, v232, v233
v_cvt_pk_bf16_f32 v167, v234, v235
v_exp_f32 v232, v152
v_exp_f32 v233, v153
v_exp_f32 v234, v154
v_exp_f32 v235, v155
s_nop 1
v_add_f32 v226, v230, v232
v_add_f32 v226, v226, v233
v_add_f32 v226, v226, v234
v_add_f32 v226, v226, v235
v_cvt_pk_bf16_f32 v170, v232, v233
v_cvt_pk_bf16_f32 v171, v234, v235
v_exp_f32 v232, v156
v_exp_f32 v233, v157
v_exp_f32 v234, v158
v_exp_f32 v235, v159
s_nop 1
v_add_f32 v227, v231, v232
v_add_f32 v227, v227, v233
v_add_f32 v227, v227, v234
v_add_f32 v227, v227, v235
v_cvt_pk_bf16_f32 v174, v232, v233
v_cvt_pk_bf16_f32 v175, v234, v235
s_branch L2_rare_common
L2_rare_site14:
s_mov_b32 s36, 14
s_branch L2_rare_t1_2_0
L2_rare_t1_2_0:
s_nop 15
s_nop 15
s_waitcnt lgkmcnt(0)
v_log_f32 v243, v224
v_max3_f32 v232, v128, v129, v130
v_max3_f32 v232, v232, v131, v243
v_mov_b32 v243, v232
s_nop 1
v_permlane32_swap_b32 v232, v243
s_nop 1
v_max_f32 v232, v232, v243
v_mov_b32 v243, v232
s_nop 1
v_permlane16_swap_b32 v232, v243
s_nop 1
v_max_f32 v232, v232, v243
v_ceil_f32 v232, v232
v_max_f32 v232, 0, v232
v_sub_f32 v243, 0, v232
v_exp_f32 v236, v243
s_nop 1
v_mul_f32 v224, v224, v236
v_add_f32 v244, v244, v232
v_sub_f32 v192, v192, v232
v_sub_f32 v128, v128, v232
v_sub_f32 v144, v144, v232
v_sub_f32 v193, v193, v232
v_sub_f32 v129, v129, v232
v_sub_f32 v145, v145, v232
v_sub_f32 v194, v194, v232
v_sub_f32 v130, v130, v232
v_sub_f32 v146, v146, v232
v_sub_f32 v195, v195, v232
v_sub_f32 v131, v131, v232
v_sub_f32 v147, v147, v232
ds_read_b64 v[254:255], v253 offset:0
s_waitcnt lgkmcnt(0)
v_lshlrev_b32 v242, 16, v254
v_and_b32 v243, 0xffff0000, v254
v_mul_f32 v242, v242, v236
v_mul_f32 v243, v243, v236
v_cvt_pk_bf16_f32 v254, v242, v243
v_lshlrev_b32 v242, 16, v255
v_and_b32 v243, 0xffff0000, v255
v_mul_f32 v242, v242, v236
v_mul_f32 v243, v243, v236
v_cvt_pk_bf16_f32 v255, v242, v243
ds_write_b64 v253, v[254:255] offset:0
s_waitcnt lgkmcnt(0)
ds_read_b64 v[254:255], v253 offset:8
s_waitcnt lgkmcnt(0)
v_lshlrev_b32 v242, 16, v254
v_and_b32 v243, 0xffff0000, v254
v_mul_f32 v242, v242, v236
v_mul_f32 v243, v243, v236
v_cvt_pk_bf16_f32 v254, v242, v243
v_lshlrev_b32 v242, 16, v255
v_and_b32 v243, 0xffff0000, v255
v_mul_f32 v242, v242, v236
v_mul_f32 v243, v243, v236
v_cvt_pk_bf16_f32 v255, v242, v243
ds_write_b64 v253, v[254:255] offset:8
s_waitcnt lgkmcnt(0)
ds_read_b64 v[254:255], v253 offset:4096
s_waitcnt lgkmcnt(0)
v_lshlrev_b32 v242, 16, v254
v_and_b32 v243, 0xffff0000, v254
v_mul_f32 v242, v242, v236
v_mul_f32 v243, v243, v236
v_cvt_pk_bf16_f32 v254, v242, v243
v_lshlrev_b32 v242, 16, v255
v_and_b32 v243, 0xffff0000, v255
v_mul_f32 v242, v242, v236
v_mul_f32 v243, v243, v236
v_cvt_pk_bf16_f32 v255, v242, v243
ds_write_b64 v253, v[254:255] offset:4096
s_waitcnt lgkmcnt(0)
ds_read_b64 v[254:255], v253 offset:4104
s_waitcnt lgkmcnt(0)
v_lshlrev_b32 v242, 16, v254
v_and_b32 v243, 0xffff0000, v254
v_mul_f32 v242, v242, v236
v_mul_f32 v243, v243, v236
v_cvt_pk_bf16_f32 v254, v242, v243
v_lshlrev_b32 v242, 16, v255
v_and_b32 v243, 0xffff0000, v255
v_mul_f32 v242, v242, v236
v_mul_f32 v243, v243, v236
v_cvt_pk_bf16_f32 v255, v242, v243
ds_write_b64 v253, v[254:255] offset:4104
s_waitcnt lgkmcnt(0)
v_log_f32 v243, v225
v_max3_f32 v233, v132, v133, v134
v_max3_f32 v233, v233, v135, v243
v_mov_b32 v243, v233
s_nop 1
v_permlane32_swap_b32 v233, v243
s_nop 1
v_max_f32 v233, v233, v243
v_mov_b32 v243, v233
s_nop 1
v_permlane16_swap_b32 v233, v243
s_nop 1
v_max_f32 v233, v233, v243
v_ceil_f32 v233, v233
v_max_f32 v233, 0, v233
v_sub_f32 v243, 0, v233
v_exp_f32 v237, v243
s_nop 1
v_mul_f32 v225, v225, v237
v_add_f32 v245, v245, v233
v_sub_f32 v196, v196, v233
v_sub_f32 v132, v132, v233
v_sub_f32 v148, v148, v233
v_sub_f32 v197, v197, v233
v_sub_f32 v133, v133, v233
v_sub_f32 v149, v149, v233
v_sub_f32 v198, v198, v233
v_sub_f32 v134, v134, v233
v_sub_f32 v150, v150, v233
v_sub_f32 v199, v199, v233
v_sub_f32 v135, v135, v233
v_sub_f32 v151, v151, v233
ds_read_b64 v[254:255], v253 offset:1024
s_waitcnt lgkmcnt(0)
v_lshlrev_b32 v242, 16, v254
v_and_b32 v243, 0xffff0000, v254
v_mul_f32 v242, v242, v237
v_mul_f32 v243, v243, v237
v_cvt_pk_bf16_f32 v254, v242, v243
v_lshlrev_b32 v242, 16, v255
v_and_b32 v243, 0xffff0000, v255
v_mul_f32 v242, v242, v237
v_mul_f32 v243, v243, v237
v_cvt_pk_bf16_f32 v255, v242, v243
ds_write_b64 v253, v[254:255] offset:1024
s_waitcnt lgkmcnt(0)
ds_read_b64 v[254:255], v253 offset:1032
s_waitcnt lgkmcnt(0)
v_lshlrev_b32 v242, 16, v254
v_and_b32 v243, 0xffff0000, v254
v_mul_f32 v242, v242, v237
v_mul_f32 v243, v243, v237
v_cvt_pk_bf16_f32 v254, v242, v243
v_lshlrev_b32 v242, 16, v255
v_and_b32 v243, 0xffff0000, v255
v_mul_f32 v242, v242, v237
v_mul_f32 v243, v243, v237
v_cvt_pk_bf16_f32 v255, v242, v243
ds_write_b64 v253, v[254:255] offset:1032
s_waitcnt lgkmcnt(0)
ds_read_b64 v[254:255], v253 offset:5120
s_waitcnt lgkmcnt(0)
v_lshlrev_b32 v242, 16, v254
v_and_b32 v243, 0xffff0000, v254
v_mul_f32 v242, v242, v237
v_mul_f32 v243, v243, v237
v_cvt_pk_bf16_f32 v254, v242, v243
v_lshlrev_b32 v242, 16, v255
v_and_b32 v243, 0xffff0000, v255
v_mul_f32 v242, v242, v237
v_mul_f32 v243, v243, v237
v_cvt_pk_bf16_f32 v255, v242, v243
ds_write_b64 v253, v[254:255] offset:5120
s_waitcnt lgkmcnt(0)
ds_read_b64 v[254:255], v253 offset:5128
s_waitcnt lgkmcnt(0)
v_lshlrev_b32 v242, 16, v254
v_and_b32 v243, 0xffff0000, v254
v_mul_f32 v242, v242, v237
v_mul_f32 v243, v243, v237
v_cvt_pk_bf16_f32 v254, v242, v243
v_lshlrev_b32 v242, 16, v255
v_and_b32 v243, 0xffff0000, v255
v_mul_f32 v242, v242, v237
v_mul_f32 v243, v243, v237
v_cvt_pk_bf16_f32 v255, v242, v243
ds_write_b64 v253, v[254:255] offset:5128
s_waitcnt lgkmcnt(0)
v_log_f32 v243, v226
v_max3_f32 v234, v136, v137, v138
v_max3_f32 v234, v234, v139, v243
v_mov_b32 v243, v234
s_nop 1
v_permlane32_swap_b32 v234, v243
s_nop 1
v_max_f32 v234, v234, v243
v_mov_b32 v243, v234
s_nop 1
v_permlane16_swap_b32 v234, v243
s_nop 1
v_max_f32 v234, v234, v243
v_ceil_f32 v234, v234
v_max_f32 v234, 0, v234
v_sub_f32 v243, 0, v234
v_exp_f32 v238, v243
s_nop 1
v_mul_f32 v226, v226, v238
v_add_f32 v246, v246, v234
v_sub_f32 v200, v200, v234
v_sub_f32 v136, v136, v234
v_sub_f32 v152, v152, v234
v_sub_f32 v201, v201, v234
v_sub_f32 v137, v137, v234
v_sub_f32 v153, v153, v234
v_sub_f32 v202, v202, v234
v_sub_f32 v138, v138, v234
v_sub_f32 v154, v154, v234
v_sub_f32 v203, v203, v234
v_sub_f32 v139, v139, v234
v_sub_f32 v155, v155, v234
ds_read_b64 v[254:255], v253 offset:2048
s_waitcnt lgkmcnt(0)
v_lshlrev_b32 v242, 16, v254
v_and_b32 v243, 0xffff0000, v254
v_mul_f32 v242, v242, v238
v_mul_f32 v243, v243, v238
v_cvt_pk_bf16_f32 v254, v242, v243
v_lshlrev_b32 v242, 16, v255
v_and_b32 v243, 0xffff0000, v255
v_mul_f32 v242, v242, v238
v_mul_f32 v243, v243, v238
v_cvt_pk_bf16_f32 v255, v242, v243
ds_write_b64 v253, v[254:255] offset:2048
s_waitcnt lgkmcnt(0)
ds_read_b64 v[254:255], v253 offset:2056
s_waitcnt lgkmcnt(0)
v_lshlrev_b32 v242, 16, v254
v_and_b32 v243, 0xffff0000, v254
v_mul_f32 v242, v242, v238
v_mul_f32 v243, v243, v238
v_cvt_pk_bf16_f32 v254, v242, v243
v_lshlrev_b32 v242, 16, v255
v_and_b32 v243, 0xffff0000, v255
v_mul_f32 v242, v242, v238
v_mul_f32 v243, v243, v238
v_cvt_pk_bf16_f32 v255, v242, v243
ds_write_b64 v253, v[254:255] offset:2056
s_waitcnt lgkmcnt(0)
ds_read_b64 v[254:255], v253 offset:6144
s_waitcnt lgkmcnt(0)
v_lshlrev_b32 v242, 16, v254
v_and_b32 v243, 0xffff0000, v254
v_mul_f32 v242, v242, v238
v_mul_f32 v243, v243, v238
v_cvt_pk_bf16_f32 v254, v242, v243
v_lshlrev_b32 v242, 16, v255
v_and_b32 v243, 0xffff0000, v255
v_mul_f32 v242, v242, v238
v_mul_f32 v243, v243, v238
v_cvt_pk_bf16_f32 v255, v242, v243
ds_write_b64 v253, v[254:255] offset:6144
s_waitcnt lgkmcnt(0)
ds_read_b64 v[254:255], v253 offset:6152
s_waitcnt lgkmcnt(0)
v_lshlrev_b32 v242, 16, v254
v_and_b32 v243, 0xffff0000, v254
v_mul_f32 v242, v242, v238
v_mul_f32 v243, v243, v238
v_cvt_pk_bf16_f32 v254, v242, v243
v_lshlrev_b32 v242, 16, v255
v_and_b32 v243, 0xffff0000, v255
v_mul_f32 v242, v242, v238
v_mul_f32 v243, v243, v238
v_cvt_pk_bf16_f32 v255, v242, v243
ds_write_b64 v253, v[254:255] offset:6152
s_waitcnt lgkmcnt(0)
v_log_f32 v243, v227
v_max3_f32 v235, v140, v141, v142
v_max3_f32 v235, v235, v143, v243
v_mov_b32 v243, v235
s_nop 1
v_permlane32_swap_b32 v235, v243
s_nop 1
v_max_f32 v235, v235, v243
v_mov_b32 v243, v235
s_nop 1
v_permlane16_swap_b32 v235, v243
s_nop 1
v_max_f32 v235, v235, v243
v_ceil_f32 v235, v235
v_max_f32 v235, 0, v235
v_sub_f32 v243, 0, v235
v_exp_f32 v239, v243
s_nop 1
v_mul_f32 v227, v227, v239
v_add_f32 v247, v247, v235
v_sub_f32 v204, v204, v235
v_sub_f32 v140, v140, v235
v_sub_f32 v156, v156, v235
v_sub_f32 v205, v205, v235
v_sub_f32 v141, v141, v235
v_sub_f32 v157, v157, v235
v_sub_f32 v206, v206, v235
v_sub_f32 v142, v142, v235
v_sub_f32 v158, v158, v235
v_sub_f32 v207, v207, v235
v_sub_f32 v143, v143, v235
v_sub_f32 v159, v159, v235
ds_read_b64 v[254:255], v253 offset:3072
s_waitcnt lgkmcnt(0)
v_lshlrev_b32 v242, 16, v254
v_and_b32 v243, 0xffff0000, v254
v_mul_f32 v242, v242, v239
v_mul_f32 v243, v243, v239
v_cvt_pk_bf16_f32 v254, v242, v243
v_lshlrev_b32 v242, 16, v255
v_and_b32 v243, 0xffff0000, v255
v_mul_f32 v242, v242, v239
v_mul_f32 v243, v243, v239
v_cvt_pk_bf16_f32 v255, v242, v243
ds_write_b64 v253, v[254:255] offset:3072
s_waitcnt lgkmcnt(0)
ds_read_b64 v[254:255], v253 offset:3080
s_waitcnt lgkmcnt(0)
v_lshlrev_b32 v242, 16, v254
v_and_b32 v243, 0xffff0000, v254
v_mul_f32 v242, v242, v239
v_mul_f32 v243, v243, v239
v_cvt_pk_bf16_f32 v254, v242, v243
v_lshlrev_b32 v242, 16, v255
v_and_b32 v243, 0xffff0000, v255
v_mul_f32 v242, v242, v239
v_mul_f32 v243, v243, v239
v_cvt_pk_bf16_f32 v255, v242, v243
ds_write_b64 v253, v[254:255] offset:3080
s_waitcnt lgkmcnt(0)
ds_read_b64 v[254:255], v253 offset:7168
s_waitcnt lgkmcnt(0)
v_lshlrev_b32 v242, 16, v254
v_and_b32 v243, 0xffff0000, v254
v_mul_f32 v242, v242, v239
v_mul_f32 v243, v243, v239
v_cvt_pk_bf16_f32 v254, v242, v243
v_lshlrev_b32 v242, 16, v255
v_and_b32 v243, 0xffff0000, v255
v_mul_f32 v242, v242, v239
v_mul_f32 v243, v243, v239
v_cvt_pk_bf16_f32 v255, v242, v243
ds_write_b64 v253, v[254:255] offset:7168
s_waitcnt lgkmcnt(0)
ds_read_b64 v[254:255], v253 offset:7176
s_waitcnt lgkmcnt(0)
v_lshlrev_b32 v242, 16, v254
v_and_b32 v243, 0xffff0000, v254
v_mul_f32 v242, v242, v239
v_mul_f32 v243, v243, v239
v_cvt_pk_bf16_f32 v254, v242, v243
v_lshlrev_b32 v242, 16, v255
v_and_b32 v243, 0xffff0000, v255
v_mul_f32 v242, v242, v239
v_mul_f32 v243, v243, v239
v_cvt_pk_bf16_f32 v255, v242, v243
ds_write_b64 v253, v[254:255] offset:7176
s_waitcnt lgkmcnt(0)
v_exp_f32 v232, v128
v_exp_f32 v233, v129
v_exp_f32 v234, v130
v_exp_f32 v235, v131
s_nop 1
v_add_f32 v228, v224, v232
v_add_f32 v228, v228, v233
v_add_f32 v228, v228, v234
v_add_f32 v228, v228, v235
v_cvt_pk_bf16_f32 v176, v232, v233
v_cvt_pk_bf16_f32 v177, v234, v235
v_exp_f32 v232, v132
v_exp_f32 v233, v133
v_exp_f32 v234, v134
v_exp_f32 v235, v135
s_nop 1
v_add_f32 v229, v225, v232
v_add_f32 v229, v229, v233
v_add_f32 v229, v229, v234
v_add_f32 v229, v229, v235
v_cvt_pk_bf16_f32 v180, v232, v233
v_cvt_pk_bf16_f32 v181, v234, v235
v_exp_f32 v232, v136
v_exp_f32 v233, v137
v_exp_f32 v234, v138
v_exp_f32 v235, v139
s_nop 1
v_add_f32 v230, v226, v232
v_add_f32 v230, v230, v233
v_add_f32 v230, v230, v234
v_add_f32 v230, v230, v235
v_cvt_pk_bf16_f32 v184, v232, v233
v_cvt_pk_bf16_f32 v185, v234, v235
v_exp_f32 v232, v140
v_exp_f32 v233, v141
v_exp_f32 v234, v142
v_exp_f32 v235, v143
s_nop 1
v_add_f32 v231, v227, v232
v_add_f32 v231, v231, v233
v_add_f32 v231, v231, v234
v_add_f32 v231, v231, v235
v_cvt_pk_bf16_f32 v188, v232, v233
v_cvt_pk_bf16_f32 v189, v234, v235
s_branch L2_rare_common
L2_rare_site15:
s_mov_b32 s36, 15
s_branch L2_rare_t1_3_1
L2_rare_t1_3_1:
s_nop 15
s_nop 15
s_waitcnt lgkmcnt(0)
v_log_f32 v243, v228
v_max3_f32 v232, v144, v145, v146
v_max3_f32 v232, v232, v147, v243
v_mov_b32 v243, v232
s_nop 1
v_permlane32_swap_b32 v232, v243
s_nop 1
v_max_f32 v232, v232, v243
v_mov_b32 v243, v232
s_nop 1
v_permlane16_swap_b32 v232, v243
s_nop 1
v_max_f32 v232, v232, v243
v_ceil_f32 v232, v232
v_max_f32 v232, 0, v232
v_sub_f32 v243, 0, v232
v_exp_f32 v236, v243
s_nop 1
v_mul_f32 v228, v228, v236
v_add_f32 v244, v244, v232
v_sub_f32 v192, v192, v232
v_sub_f32 v128, v128, v232
v_sub_f32 v144, v144, v232
v_sub_f32 v193, v193, v232
v_sub_f32 v129, v129, v232
v_sub_f32 v145, v145, v232
v_sub_f32 v194, v194, v232
v_sub_f32 v130, v130, v232
v_sub_f32 v146, v146, v232
v_sub_f32 v195, v195, v232
v_sub_f32 v131, v131, v232
v_sub_f32 v147, v147, v232
v_lshlrev_b32 v242, 16, v176
v_and_b32 v243, 0xffff0000, v176
v_mul_f32 v242, v242, v236
v_mul_f32 v243, v243, v236
v_cvt_pk_bf16_f32 v176, v242, v243
v_lshlrev_b32 v242, 16, v177
v_and_b32 v243, 0xffff0000, v177
v_mul_f32 v242, v242, v236
v_mul_f32 v243, v243, v236
v_cvt_pk_bf16_f32 v177, v242, v243
ds_read_b64 v[254:255], v253 offset:0
s_waitcnt lgkmcnt(0)
v_lshlrev_b32 v242, 16, v254
v_and_b32 v243, 0xffff0000, v254
v_mul_f32 v242, v242, v236
v_mul_f32 v243, v243, v236
v_cvt_pk_bf16_f32 v254, v242, v243
v_lshlrev_b32 v242, 16, v255
v_and_b32 v243, 0xffff0000, v255
v_mul_f32 v242, v242, v236
v_mul_f32 v243, v243, v236
v_cvt_pk_bf16_f32 v255, v242, v243
ds_write_b64 v253, v[254:255] offset:0
s_waitcnt lgkmcnt(0)
ds_read_b64 v[254:255], v253 offset:8
s_waitcnt lgkmcnt(0)
v_lshlrev_b32 v242, 16, v254
v_and_b32 v243, 0xffff0000, v254
v_mul_f32 v242, v242, v236
v_mul_f32 v243, v243, v236
v_cvt_pk_bf16_f32 v254, v242, v243
v_lshlrev_b32 v242, 16, v255
v_and_b32 v243, 0xffff0000, v255
v_mul_f32 v242, v242, v236
v_mul_f32 v243, v243, v236
v_cvt_pk_bf16_f32 v255, v242, v243
ds_write_b64 v253, v[254:255] offset:8
s_waitcnt lgkmcnt(0)
ds_read_b64 v[254:255], v253 offset:4096
s_waitcnt lgkmcnt(0)
v_lshlrev_b32 v242, 16, v254
v_and_b32 v243, 0xffff0000, v254
v_mul_f32 v242, v242, v236
v_mul_f32 v243, v243, v236
v_cvt_pk_bf16_f32 v254, v242, v243
v_lshlrev_b32 v242, 16, v255
v_and_b32 v243, 0xffff0000, v255
v_mul_f32 v242, v242, v236
v_mul_f32 v243, v243, v236
v_cvt_pk_bf16_f32 v255, v242, v243
ds_write_b64 v253, v[254:255] offset:4096
s_waitcnt lgkmcnt(0)
ds_read_b64 v[254:255], v253 offset:4104
s_waitcnt lgkmcnt(0)
v_lshlrev_b32 v242, 16, v254
v_and_b32 v243, 0xffff0000, v254
v_mul_f32 v242, v242, v236
v_mul_f32 v243, v243, v236
v_cvt_pk_bf16_f32 v254, v242, v243
v_lshlrev_b32 v242, 16, v255
v_and_b32 v243, 0xffff0000, v255
v_mul_f32 v242, v242, v236
v_mul_f32 v243, v243, v236
v_cvt_pk_bf16_f32 v255, v242, v243
ds_write_b64 v253, v[254:255] offset:4104
s_waitcnt lgkmcnt(0)
v_log_f32 v243, v229
v_max3_f32 v233, v148, v149, v150
v_max3_f32 v233, v233, v151, v243
v_mov_b32 v243, v233
s_nop 1
v_permlane32_swap_b32 v233, v243
s_nop 1
v_max_f32 v233, v233, v243
v_mov_b32 v243, v233
s_nop 1
v_permlane16_swap_b32 v233, v243
s_nop 1
v_max_f32 v233, v233, v243
v_ceil_f32 v233, v233
v_max_f32 v233, 0, v233
v_sub_f32 v243, 0, v233
v_exp_f32 v237, v243
s_nop 1
v_mul_f32 v229, v229, v237
v_add_f32 v245, v245, v233
v_sub_f32 v196, v196, v233
v_sub_f32 v132, v132, v233
v_sub_f32 v148, v148, v233
v_sub_f32 v197, v197, v233
v_sub_f32 v133, v133, v233
v_sub_f32 v149, v149, v233
v_sub_f32 v198, v198, v233
v_sub_f32 v134, v134, v233
v_sub_f32 v150, v150, v233
v_sub_f32 v199, v199, v233
v_sub_f32 v135, v135, v233
v_sub_f32 v151, v151, v233
v_lshlrev_b32 v242, 16, v180
v_and_b32 v243, 0xffff0000, v180
v_mul_f32 v242, v242, v237
v_mul_f32 v243, v243, v237
v_cvt_pk_bf16_f32 v180, v242, v243
v_lshlrev_b32 v242, 16, v181
v_and_b32 v243, 0xffff0000, v181
v_mul_f32 v242, v242, v237
v_mul_f32 v243, v243, v237
v_cvt_pk_bf16_f32 v181, v242, v243
ds_read_b64 v[254:255], v253 offset:1024
s_waitcnt lgkmcnt(0)
v_lshlrev_b32 v242, 16, v254
v_and_b32 v243, 0xffff0000, v254
v_mul_f32 v242, v242, v237
v_mul_f32 v243, v243, v237
v_cvt_pk_bf16_f32 v254, v242, v243
v_lshlrev_b32 v242, 16, v255
v_and_b32 v243, 0xffff0000, v255
v_mul_f32 v242, v242, v237
v_mul_f32 v243, v243, v237
v_cvt_pk_bf16_f32 v255, v242, v243
ds_write_b64 v253, v[254:255] offset:1024
s_waitcnt lgkmcnt(0)
ds_read_b64 v[254:255], v253 offset:1032
s_waitcnt lgkmcnt(0)
v_lshlrev_b32 v242, 16, v254
v_and_b32 v243, 0xffff0000, v254
v_mul_f32 v242, v242, v237
v_mul_f32 v243, v243, v237
v_cvt_pk_bf16_f32 v254, v242, v243
v_lshlrev_b32 v242, 16, v255
v_and_b32 v243, 0xffff0000, v255
v_mul_f32 v242, v242, v237
v_mul_f32 v243, v243, v237
v_cvt_pk_bf16_f32 v255, v242, v243
ds_write_b64 v253, v[254:255] offset:1032
s_waitcnt lgkmcnt(0)
ds_read_b64 v[254:255], v253 offset:5120
s_waitcnt lgkmcnt(0)
v_lshlrev_b32 v242, 16, v254
v_and_b32 v243, 0xffff0000, v254
v_mul_f32 v242, v242, v237
v_mul_f32 v243, v243, v237
v_cvt_pk_bf16_f32 v254, v242, v243
v_lshlrev_b32 v242, 16, v255
v_and_b32 v243, 0xffff0000, v255
v_mul_f32 v242, v242, v237
v_mul_f32 v243, v243, v237
v_cvt_pk_bf16_f32 v255, v242, v243
ds_write_b64 v253, v[254:255] offset:5120
s_waitcnt lgkmcnt(0)
ds_read_b64 v[254:255], v253 offset:5128
s_waitcnt lgkmcnt(0)
v_lshlrev_b32 v242, 16, v254
v_and_b32 v243, 0xffff0000, v254
v_mul_f32 v242, v242, v237
v_mul_f32 v243, v243, v237
v_cvt_pk_bf16_f32 v254, v242, v243
v_lshlrev_b32 v242, 16, v255
v_and_b32 v243, 0xffff0000, v255
v_mul_f32 v242, v242, v237
v_mul_f32 v243, v243, v237
v_cvt_pk_bf16_f32 v255, v242, v243
ds_write_b64 v253, v[254:255] offset:5128
s_waitcnt lgkmcnt(0)
v_log_f32 v243, v230
v_max3_f32 v234, v152, v153, v154
v_max3_f32 v234, v234, v155, v243
v_mov_b32 v243, v234
s_nop 1
v_permlane32_swap_b32 v234, v243
s_nop 1
v_max_f32 v234, v234, v243
v_mov_b32 v243, v234
s_nop 1
v_permlane16_swap_b32 v234, v243
s_nop 1
v_max_f32 v234, v234, v243
v_ceil_f32 v234, v234
v_max_f32 v234, 0, v234
v_sub_f32 v243, 0, v234
v_exp_f32 v238, v243
s_nop 1
v_mul_f32 v230, v230, v238
v_add_f32 v246, v246, v234
v_sub_f32 v200, v200, v234
v_sub_f32 v136, v136, v234
v_sub_f32 v152, v152, v234
v_sub_f32 v201, v201, v234
v_sub_f32 v137, v137, v234
v_sub_f32 v153, v153, v234
v_sub_f32 v202, v202, v234
v_sub_f32 v138, v138, v234
v_sub_f32 v154, v154, v234
v_sub_f32 v203, v203, v234
v_sub_f32 v139, v139, v234
v_sub_f32 v155, v155, v234
v_lshlrev_b32 v242, 16, v184
v_and_b32 v243, 0xffff0000, v184
v_mul_f32 v242, v242, v238
v_mul_f32 v243, v243, v238
v_cvt_pk_bf16_f32 v184, v242, v243
v_lshlrev_b32 v242, 16, v185
v_and_b32 v243, 0xffff0000, v185
v_mul_f32 v242, v242, v238
v_mul_f32 v243, v243, v238
v_cvt_pk_bf16_f32 v185, v242, v243
ds_read_b64 v[254:255], v253 offset:2048
s_waitcnt lgkmcnt(0)
v_lshlrev_b32 v242, 16, v254
v_and_b32 v243, 0xffff0000, v254
v_mul_f32 v242, v242, v238
v_mul_f32 v243, v243, v238
v_cvt_pk_bf16_f32 v254, v242, v243
v_lshlrev_b32 v242, 16, v255
v_and_b32 v243, 0xffff0000, v255
v_mul_f32 v242, v242, v238
v_mul_f32 v243, v243, v238
v_cvt_pk_bf16_f32 v255, v242, v243
ds_write_b64 v253, v[254:255] offset:2048
s_waitcnt lgkmcnt(0)
ds_read_b64 v[254:255], v253 offset:2056
s_waitcnt lgkmcnt(0)
v_lshlrev_b32 v242, 16, v254
v_and_b32 v243, 0xffff0000, v254
v_mul_f32 v242, v242, v238
v_mul_f32 v243, v243, v238
v_cvt_pk_bf16_f32 v254, v242, v243
v_lshlrev_b32 v242, 16, v255
v_and_b32 v243, 0xffff0000, v255
v_mul_f32 v242, v242, v238
v_mul_f32 v243, v243, v238
v_cvt_pk_bf16_f32 v255, v242, v243
ds_write_b64 v253, v[254:255] offset:2056
s_waitcnt lgkmcnt(0)
ds_read_b64 v[254:255], v253 offset:6144
s_waitcnt lgkmcnt(0)
v_lshlrev_b32 v242, 16, v254
v_and_b32 v243, 0xffff0000, v254
v_mul_f32 v242, v242, v238
v_mul_f32 v243, v243, v238
v_cvt_pk_bf16_f32 v254, v242, v243
v_lshlrev_b32 v242, 16, v255
v_and_b32 v243, 0xffff0000, v255
v_mul_f32 v242, v242, v238
v_mul_f32 v243, v243, v238
v_cvt_pk_bf16_f32 v255, v242, v243
ds_write_b64 v253, v[254:255] offset:6144
s_waitcnt lgkmcnt(0)
ds_read_b64 v[254:255], v253 offset:6152
s_waitcnt lgkmcnt(0)
v_lshlrev_b32 v242, 16, v254
v_and_b32 v243, 0xffff0000, v254
v_mul_f32 v242, v242, v238
v_mul_f32 v243, v243, v238
v_cvt_pk_bf16_f32 v254, v242, v243
v_lshlrev_b32 v242, 16, v255
v_and_b32 v243, 0xffff0000, v255
v_mul_f32 v242, v242, v238
v_mul_f32 v243, v243, v238
v_cvt_pk_bf16_f32 v255, v242, v243
ds_write_b64 v253, v[254:255] offset:6152
s_waitcnt lgkmcnt(0)
v_log_f32 v243, v231
v_max3_f32 v235, v156, v157, v158
v_max3_f32 v235, v235, v159, v243
v_mov_b32 v243, v235
s_nop 1
v_permlane32_swap_b32 v235, v243
s_nop 1
v_max_f32 v235, v235, v243
v_mov_b32 v243, v235
s_nop 1
v_permlane16_swap_b32 v235, v243
s_nop 1
v_max_f32 v235, v235, v243
v_ceil_f32 v235, v235
v_max_f32 v235, 0, v235
v_sub_f32 v243, 0, v235
v_exp_f32 v239, v243
s_nop 1
v_mul_f32 v231, v231, v239
v_add_f32 v247, v247, v235
v_sub_f32 v204, v204, v235
v_sub_f32 v140, v140, v235
v_sub_f32 v156, v156, v235
v_sub_f32 v205, v205, v235
v_sub_f32 v141, v141, v235
v_sub_f32 v157, v157, v235
v_sub_f32 v206, v206, v235
v_sub_f32 v142, v142, v235
v_sub_f32 v158, v158, v235
v_sub_f32 v207, v207, v235
v_sub_f32 v143, v143, v235
v_sub_f32 v159, v159, v235
v_lshlrev_b32 v242, 16, v188
v_and_b32 v243, 0xffff0000, v188
v_mul_f32 v242, v242, v239
v_mul_f32 v243, v243, v239
v_cvt_pk_bf16_f32 v188, v242, v243
v_lshlrev_b32 v242, 16, v189
v_and_b32 v243, 0xffff0000, v189
v_mul_f32 v242, v242, v239
v_mul_f32 v243, v243, v239
v_cvt_pk_bf16_f32 v189, v242, v243
ds_read_b64 v[254:255], v253 offset:3072
s_waitcnt lgkmcnt(0)
v_lshlrev_b32 v242, 16, v254
v_and_b32 v243, 0xffff0000, v254
v_mul_f32 v242, v242, v239
v_mul_f32 v243, v243, v239
v_cvt_pk_bf16_f32 v254, v242, v243
v_lshlrev_b32 v242, 16, v255
v_and_b32 v243, 0xffff0000, v255
v_mul_f32 v242, v242, v239
v_mul_f32 v243, v243, v239
v_cvt_pk_bf16_f32 v255, v242, v243
ds_write_b64 v253, v[254:255] offset:3072
s_waitcnt lgkmcnt(0)
ds_read_b64 v[254:255], v253 offset:3080
s_waitcnt lgkmcnt(0)
v_lshlrev_b32 v242, 16, v254
v_and_b32 v243, 0xffff0000, v254
v_mul_f32 v242, v242, v239
v_mul_f32 v243, v243, v239
v_cvt_pk_bf16_f32 v254, v242, v243
v_lshlrev_b32 v242, 16, v255
v_and_b32 v243, 0xffff0000, v255
v_mul_f32 v242, v242, v239
v_mul_f32 v243, v243, v239
v_cvt_pk_bf16_f32 v255, v242, v243
ds_write_b64 v253, v[254:255] offset:3080
s_waitcnt lgkmcnt(0)
ds_read_b64 v[254:255], v253 offset:7168
s_waitcnt lgkmcnt(0)
v_lshlrev_b32 v242, 16, v254
v_and_b32 v243, 0xffff0000, v254
v_mul_f32 v242, v242, v239
v_mul_f32 v243, v243, v239
v_cvt_pk_bf16_f32 v254, v242, v243
v_lshlrev_b32 v242, 16, v255
v_and_b32 v243, 0xffff0000, v255
v_mul_f32 v242, v242, v239
v_mul_f32 v243, v243, v239
v_cvt_pk_bf16_f32 v255, v242, v243
ds_write_b64 v253, v[254:255] offset:7168
s_waitcnt lgkmcnt(0)
ds_read_b64 v[254:255], v253 offset:7176
s_waitcnt lgkmcnt(0)
v_lshlrev_b32 v242, 16, v254
v_and_b32 v243, 0xffff0000, v254
v_mul_f32 v242, v242, v239
v_mul_f32 v243, v243, v239
v_cvt_pk_bf16_f32 v254, v242, v243
v_lshlrev_b32 v242, 16, v255
v_and_b32 v243, 0xffff0000, v255
v_mul_f32 v242, v242, v239
v_mul_f32 v243, v243, v239
v_cvt_pk_bf16_f32 v255, v242, v243
ds_write_b64 v253, v[254:255] offset:7176
s_waitcnt lgkmcnt(0)
v_exp_f32 v232, v144
v_exp_f32 v233, v145
v_exp_f32 v234, v146
v_exp_f32 v235, v147
s_nop 1
v_add_f32 v224, v228, v232
v_add_f32 v224, v224, v233
v_add_f32 v224, v224, v234
v_add_f32 v224, v224, v235
v_cvt_pk_bf16_f32 v178, v232, v233
v_cvt_pk_bf16_f32 v179, v234, v235
v_exp_f32 v232, v148
v_exp_f32 v233, v149
v_exp_f32 v234, v150
v_exp_f32 v235, v151
s_nop 1
v_add_f32 v225, v229, v232
v_add_f32 v225, v225, v233
v_add_f32 v225, v225, v234
v_add_f32 v225, v225, v235
v_cvt_pk_bf16_f32 v182, v232, v233
v_cvt_pk_bf16_f32 v183, v234, v235
v_exp_f32 v232, v152
v_exp_f32 v233, v153
v_exp_f32 v234, v154
v_exp_f32 v235, v155
s_nop 1
v_add_f32 v226, v230, v232
v_add_f32 v226, v226, v233
v_add_f32 v226, v226, v234
v_add_f32 v226, v226, v235
v_cvt_pk_bf16_f32 v186, v232, v233
v_cvt_pk_bf16_f32 v187, v234, v235
v_exp_f32 v232, v156
v_exp_f32 v233, v157
v_exp_f32 v234, v158
v_exp_f32 v235, v159
s_nop 1
v_add_f32 v227, v231, v232
v_add_f32 v227, v227, v233
v_add_f32 v227, v227, v234
v_add_f32 v227, v227, v235
v_cvt_pk_bf16_f32 v190, v232, v233
v_cvt_pk_bf16_f32 v191, v234, v235
s_branch L2_rare_common
L2_rare_site16:
s_mov_b32 s36, 16
s_branch L2_rare_t1_4_0
L2_rare_t1_4_0:
s_nop 15
s_nop 15
s_waitcnt lgkmcnt(0)
v_log_f32 v243, v224
v_max3_f32 v232, v128, v129, v130
v_max3_f32 v232, v232, v131, v243
v_mov_b32 v243, v232
s_nop 1
v_permlane32_swap_b32 v232, v243
s_nop 1
v_max_f32 v232, v232, v243
v_mov_b32 v243, v232
s_nop 1
v_permlane16_swap_b32 v232, v243
s_nop 1
v_max_f32 v232, v232, v243
v_ceil_f32 v232, v232
v_max_f32 v232, 0, v232
v_sub_f32 v243, 0, v232
v_exp_f32 v236, v243
s_nop 1
v_mul_f32 v224, v224, v236
v_add_f32 v244, v244, v232
v_sub_f32 v192, v192, v232
v_sub_f32 v128, v128, v232
v_sub_f32 v144, v144, v232
v_sub_f32 v193, v193, v232
v_sub_f32 v129, v129, v232
v_sub_f32 v145, v145, v232
v_sub_f32 v194, v194, v232
v_sub_f32 v130, v130, v232
v_sub_f32 v146, v146, v232
v_sub_f32 v195, v195, v232
v_sub_f32 v131, v131, v232
v_sub_f32 v147, v147, v232
v_lshlrev_b32 v242, 16, v176
v_and_b32 v243, 0xffff0000, v176
v_mul_f32 v242, v242, v236
v_mul_f32 v243, v243, v236
v_cvt_pk_bf16_f32 v176, v242, v243
v_lshlrev_b32 v242, 16, v177
v_and_b32 v243, 0xffff0000, v177
v_mul_f32 v242, v242, v236
v_mul_f32 v243, v243, v236
v_cvt_pk_bf16_f32 v177, v242, v243
v_lshlrev_b32 v242, 16, v178
v_and_b32 v243, 0xffff0000, v178
v_mul_f32 v242, v242, v236
v_mul_f32 v243, v243, v236
v_cvt_pk_bf16_f32 v178, v242, v243
v_lshlrev_b32 v242, 16, v179
v_and_b32 v243, 0xffff0000, v179
v_mul_f32 v242, v242, v236
v_mul_f32 v243, v243, v236
v_cvt_pk_bf16_f32 v179, v242, v243
ds_read_b64 v[254:255], v253 offset:0
s_waitcnt lgkmcnt(0)
v_lshlrev_b32 v242, 16, v254
v_and_b32 v243, 0xffff0000, v254
v_mul_f32 v242, v242, v236
v_mul_f32 v243, v243, v236
v_cvt_pk_bf16_f32 v254, v242, v243
v_lshlrev_b32 v242, 16, v255
v_and_b32 v243, 0xffff0000, v255
v_mul_f32 v242, v242, v236
v_mul_f32 v243, v243, v236
v_cvt_pk_bf16_f32 v255, v242, v243
ds_write_b64 v253, v[254:255] offset:0
s_waitcnt lgkmcnt(0)
ds_read_b64 v[254:255], v253 offset:8
s_waitcnt lgkmcnt(0)
v_lshlrev_b32 v242, 16, v254
v_and_b32 v243, 0xffff0000, v254
v_mul_f32 v242, v242, v236
v_mul_f32 v243, v243, v236
v_cvt_pk_bf16_f32 v254, v242, v243
v_lshlrev_b32 v242, 16, v255
v_and_b32 v243, 0xffff0000, v255
v_mul_f32 v242, v242, v236
v_mul_f32 v243, v243, v236
v_cvt_pk_bf16_f32 v255, v242, v243
ds_write_b64 v253, v[254:255] offset:8
s_waitcnt lgkmcnt(0)
ds_read_b64 v[254:255], v253 offset:4096
s_waitcnt lgkmcnt(0)
v_lshlrev_b32 v242, 16, v254
v_and_b32 v243, 0xffff0000, v254
v_mul_f32 v242, v242, v236
v_mul_f32 v243, v243, v236
v_cvt_pk_bf16_f32 v254, v242, v243
v_lshlrev_b32 v242, 16, v255
v_and_b32 v243, 0xffff0000, v255
v_mul_f32 v242, v242, v236
v_mul_f32 v243, v243, v236
v_cvt_pk_bf16_f32 v255, v242, v243
ds_write_b64 v253, v[254:255] offset:4096
s_waitcnt lgkmcnt(0)
ds_read_b64 v[254:255], v253 offset:4104
s_waitcnt lgkmcnt(0)
v_lshlrev_b32 v242, 16, v254
v_and_b32 v243, 0xffff0000, v254
v_mul_f32 v242, v242, v236
v_mul_f32 v243, v243, v236
v_cvt_pk_bf16_f32 v254, v242, v243
v_lshlrev_b32 v242, 16, v255
v_and_b32 v243, 0xffff0000, v255
v_mul_f32 v242, v242, v236
v_mul_f32 v243, v243, v236
v_cvt_pk_bf16_f32 v255, v242, v243
ds_write_b64 v253, v[254:255] offset:4104
s_waitcnt lgkmcnt(0)
v_log_f32 v243, v225
v_max3_f32 v233, v132, v133, v134
v_max3_f32 v233, v233, v135, v243
v_mov_b32 v243, v233
s_nop 1
v_permlane32_swap_b32 v233, v243
s_nop 1
v_max_f32 v233, v233, v243
v_mov_b32 v243, v233
s_nop 1
v_permlane16_swap_b32 v233, v243
s_nop 1
v_max_f32 v233, v233, v243
v_ceil_f32 v233, v233
v_max_f32 v233, 0, v233
v_sub_f32 v243, 0, v233
v_exp_f32 v237, v243
s_nop 1
v_mul_f32 v225, v225, v237
v_add_f32 v245, v245, v233
v_sub_f32 v196, v196, v233
v_sub_f32 v132, v132, v233
v_sub_f32 v148, v148, v233
v_sub_f32 v197, v197, v233
v_sub_f32 v133, v133, v233
v_sub_f32 v149, v149, v233
v_sub_f32 v198, v198, v233
v_sub_f32 v134, v134, v233
v_sub_f32 v150, v150, v233
v_sub_f32 v199, v199, v233
v_sub_f32 v135, v135, v233
v_sub_f32 v151, v151, v233
v_lshlrev_b32 v242, 16, v180
v_and_b32 v243, 0xffff0000, v180
v_mul_f32 v242, v242, v237
v_mul_f32 v243, v243, v237
v_cvt_pk_bf16_f32 v180, v242, v243
v_lshlrev_b32 v242, 16, v181
v_and_b32 v243, 0xffff0000, v181
v_mul_f32 v242, v242, v237
v_mul_f32 v243, v243, v237
v_cvt_pk_bf16_f32 v181, v242, v243
v_lshlrev_b32 v242, 16, v182
v_and_b32 v243, 0xffff0000, v182
v_mul_f32 v242, v242, v237
v_mul_f32 v243, v243, v237
v_cvt_pk_bf16_f32 v182, v242, v243
v_lshlrev_b32 v242, 16, v183
v_and_b32 v243, 0xffff0000, v183
v_mul_f32 v242, v242, v237
v_mul_f32 v243, v243, v237
v_cvt_pk_bf16_f32 v183, v242, v243
ds_read_b64 v[254:255], v253 offset:1024
s_waitcnt lgkmcnt(0)
v_lshlrev_b32 v242, 16, v254
v_and_b32 v243, 0xffff0000, v254
v_mul_f32 v242, v242, v237
v_mul_f32 v243, v243, v237
v_cvt_pk_bf16_f32 v254, v242, v243
v_lshlrev_b32 v242, 16, v255
v_and_b32 v243, 0xffff0000, v255
v_mul_f32 v242, v242, v237
v_mul_f32 v243, v243, v237
v_cvt_pk_bf16_f32 v255, v242, v243
ds_write_b64 v253, v[254:255] offset:1024
s_waitcnt lgkmcnt(0)
ds_read_b64 v[254:255], v253 offset:1032
s_waitcnt lgkmcnt(0)
v_lshlrev_b32 v242, 16, v254
v_and_b32 v243, 0xffff0000, v254
v_mul_f32 v242, v242, v237
v_mul_f32 v243, v243, v237
v_cvt_pk_bf16_f32 v254, v242, v243
v_lshlrev_b32 v242, 16, v255
v_and_b32 v243, 0xffff0000, v255
v_mul_f32 v242, v242, v237
v_mul_f32 v243, v243, v237
v_cvt_pk_bf16_f32 v255, v242, v243
ds_write_b64 v253, v[254:255] offset:1032
s_waitcnt lgkmcnt(0)
ds_read_b64 v[254:255], v253 offset:5120
s_waitcnt lgkmcnt(0)
v_lshlrev_b32 v242, 16, v254
v_and_b32 v243, 0xffff0000, v254
v_mul_f32 v242, v242, v237
v_mul_f32 v243, v243, v237
v_cvt_pk_bf16_f32 v254, v242, v243
v_lshlrev_b32 v242, 16, v255
v_and_b32 v243, 0xffff0000, v255
v_mul_f32 v242, v242, v237
v_mul_f32 v243, v243, v237
v_cvt_pk_bf16_f32 v255, v242, v243
ds_write_b64 v253, v[254:255] offset:5120
s_waitcnt lgkmcnt(0)
ds_read_b64 v[254:255], v253 offset:5128
s_waitcnt lgkmcnt(0)
v_lshlrev_b32 v242, 16, v254
v_and_b32 v243, 0xffff0000, v254
v_mul_f32 v242, v242, v237
v_mul_f32 v243, v243, v237
v_cvt_pk_bf16_f32 v254, v242, v243
v_lshlrev_b32 v242, 16, v255
v_and_b32 v243, 0xffff0000, v255
v_mul_f32 v242, v242, v237
v_mul_f32 v243, v243, v237
v_cvt_pk_bf16_f32 v255, v242, v243
ds_write_b64 v253, v[254:255] offset:5128
s_waitcnt lgkmcnt(0)
v_log_f32 v243, v226
v_max3_f32 v234, v136, v137, v138
v_max3_f32 v234, v234, v139, v243
v_mov_b32 v243, v234
s_nop 1
v_permlane32_swap_b32 v234, v243
s_nop 1
v_max_f32 v234, v234, v243
v_mov_b32 v243, v234
s_nop 1
v_permlane16_swap_b32 v234, v243
s_nop 1
v_max_f32 v234, v234, v243
v_ceil_f32 v234, v234
v_max_f32 v234, 0, v234
v_sub_f32 v243, 0, v234
v_exp_f32 v238, v243
s_nop 1
v_mul_f32 v226, v226, v238
v_add_f32 v246, v246, v234
v_sub_f32 v200, v200, v234
v_sub_f32 v136, v136, v234
v_sub_f32 v152, v152, v234
v_sub_f32 v201, v201, v234
v_sub_f32 v137, v137, v234
v_sub_f32 v153, v153, v234
v_sub_f32 v202, v202, v234
v_sub_f32 v138, v138, v234
v_sub_f32 v154, v154, v234
v_sub_f32 v203, v203, v234
v_sub_f32 v139, v139, v234
v_sub_f32 v155, v155, v234
v_lshlrev_b32 v242, 16, v184
v_and_b32 v243, 0xffff0000, v184
v_mul_f32 v242, v242, v238
v_mul_f32 v243, v243, v238
v_cvt_pk_bf16_f32 v184, v242, v243
v_lshlrev_b32 v242, 16, v185
v_and_b32 v243, 0xffff0000, v185
v_mul_f32 v242, v242, v238
v_mul_f32 v243, v243, v238
v_cvt_pk_bf16_f32 v185, v242, v243
v_lshlrev_b32 v242, 16, v186
v_and_b32 v243, 0xffff0000, v186
v_mul_f32 v242, v242, v238
v_mul_f32 v243, v243, v238
v_cvt_pk_bf16_f32 v186, v242, v243
v_lshlrev_b32 v242, 16, v187
v_and_b32 v243, 0xffff0000, v187
v_mul_f32 v242, v242, v238
v_mul_f32 v243, v243, v238
v_cvt_pk_bf16_f32 v187, v242, v243
ds_read_b64 v[254:255], v253 offset:2048
s_waitcnt lgkmcnt(0)
v_lshlrev_b32 v242, 16, v254
v_and_b32 v243, 0xffff0000, v254
v_mul_f32 v242, v242, v238
v_mul_f32 v243, v243, v238
v_cvt_pk_bf16_f32 v254, v242, v243
v_lshlrev_b32 v242, 16, v255
v_and_b32 v243, 0xffff0000, v255
v_mul_f32 v242, v242, v238
v_mul_f32 v243, v243, v238
v_cvt_pk_bf16_f32 v255, v242, v243
ds_write_b64 v253, v[254:255] offset:2048
s_waitcnt lgkmcnt(0)
ds_read_b64 v[254:255], v253 offset:2056
s_waitcnt lgkmcnt(0)
v_lshlrev_b32 v242, 16, v254
v_and_b32 v243, 0xffff0000, v254
v_mul_f32 v242, v242, v238
v_mul_f32 v243, v243, v238
v_cvt_pk_bf16_f32 v254, v242, v243
v_lshlrev_b32 v242, 16, v255
v_and_b32 v243, 0xffff0000, v255
v_mul_f32 v242, v242, v238
v_mul_f32 v243, v243, v238
v_cvt_pk_bf16_f32 v255, v242, v243
ds_write_b64 v253, v[254:255] offset:2056
s_waitcnt lgkmcnt(0)
ds_read_b64 v[254:255], v253 offset:6144
s_waitcnt lgkmcnt(0)
v_lshlrev_b32 v242, 16, v254
v_and_b32 v243, 0xffff0000, v254
v_mul_f32 v242, v242, v238
v_mul_f32 v243, v243, v238
v_cvt_pk_bf16_f32 v254, v242, v243
v_lshlrev_b32 v242, 16, v255
v_and_b32 v243, 0xffff0000, v255
v_mul_f32 v242, v242, v238
v_mul_f32 v243, v243, v238
v_cvt_pk_bf16_f32 v255, v242, v243
ds_write_b64 v253, v[254:255] offset:6144
s_waitcnt lgkmcnt(0)
ds_read_b64 v[254:255], v253 offset:6152
s_waitcnt lgkmcnt(0)
v_lshlrev_b32 v242, 16, v254
v_and_b32 v243, 0xffff0000, v254
v_mul_f32 v242, v242, v238
v_mul_f32 v243, v243, v238
v_cvt_pk_bf16_f32 v254, v242, v243
v_lshlrev_b32 v242, 16, v255
v_and_b32 v243, 0xffff0000, v255
v_mul_f32 v242, v242, v238
v_mul_f32 v243, v243, v238
v_cvt_pk_bf16_f32 v255, v242, v243
ds_write_b64 v253, v[254:255] offset:6152
s_waitcnt lgkmcnt(0)
v_log_f32 v243, v227
v_max3_f32 v235, v140, v141, v142
v_max3_f32 v235, v235, v143, v243
v_mov_b32 v243, v235
s_nop 1
v_permlane32_swap_b32 v235, v243
s_nop 1
v_max_f32 v235, v235, v243
v_mov_b32 v243, v235
s_nop 1
v_permlane16_swap_b32 v235, v243
s_nop 1
v_max_f32 v235, v235, v243
v_ceil_f32 v235, v235
v_max_f32 v235, 0, v235
v_sub_f32 v243, 0, v235
v_exp_f32 v239, v243
s_nop 1
v_mul_f32 v227, v227, v239
v_add_f32 v247, v247, v235
v_sub_f32 v204, v204, v235
v_sub_f32 v140, v140, v235
v_sub_f32 v156, v156, v235
v_sub_f32 v205, v205, v235
v_sub_f32 v141, v141, v235
v_sub_f32 v157, v157, v235
v_sub_f32 v206, v206, v235
v_sub_f32 v142, v142, v235
v_sub_f32 v158, v158, v235
v_sub_f32 v207, v207, v235
v_sub_f32 v143, v143, v235
v_sub_f32 v159, v159, v235
v_lshlrev_b32 v242, 16, v188
v_and_b32 v243, 0xffff0000, v188
v_mul_f32 v242, v242, v239
v_mul_f32 v243, v243, v239
v_cvt_pk_bf16_f32 v188, v242, v243
v_lshlrev_b32 v242, 16, v189
v_and_b32 v243, 0xffff0000, v189
v_mul_f32 v242, v242, v239
v_mul_f32 v243, v243, v239
v_cvt_pk_bf16_f32 v189, v242, v243
v_lshlrev_b32 v242, 16, v190
v_and_b32 v243, 0xffff0000, v190
v_mul_f32 v242, v242, v239
v_mul_f32 v243, v243, v239
v_cvt_pk_bf16_f32 v190, v242, v243
v_lshlrev_b32 v242, 16, v191
v_and_b32 v243, 0xffff0000, v191
v_mul_f32 v242, v242, v239
v_mul_f32 v243, v243, v239
v_cvt_pk_bf16_f32 v191, v242, v243
ds_read_b64 v[254:255], v253 offset:3072
s_waitcnt lgkmcnt(0)
v_lshlrev_b32 v242, 16, v254
v_and_b32 v243, 0xffff0000, v254
v_mul_f32 v242, v242, v239
v_mul_f32 v243, v243, v239
v_cvt_pk_bf16_f32 v254, v242, v243
v_lshlrev_b32 v242, 16, v255
v_and_b32 v243, 0xffff0000, v255
v_mul_f32 v242, v242, v239
v_mul_f32 v243, v243, v239
v_cvt_pk_bf16_f32 v255, v242, v243
ds_write_b64 v253, v[254:255] offset:3072
s_waitcnt lgkmcnt(0)
ds_read_b64 v[254:255], v253 offset:3080
s_waitcnt lgkmcnt(0)
v_lshlrev_b32 v242, 16, v254
v_and_b32 v243, 0xffff0000, v254
v_mul_f32 v242, v242, v239
v_mul_f32 v243, v243, v239
v_cvt_pk_bf16_f32 v254, v242, v243
v_lshlrev_b32 v242, 16, v255
v_and_b32 v243, 0xffff0000, v255
v_mul_f32 v242, v242, v239
v_mul_f32 v243, v243, v239
v_cvt_pk_bf16_f32 v255, v242, v243
ds_write_b64 v253, v[254:255] offset:3080
s_waitcnt lgkmcnt(0)
ds_read_b64 v[254:255], v253 offset:7168
s_waitcnt lgkmcnt(0)
v_lshlrev_b32 v242, 16, v254
v_and_b32 v243, 0xffff0000, v254
v_mul_f32 v242, v242, v239
v_mul_f32 v243, v243, v239
v_cvt_pk_bf16_f32 v254, v242, v243
v_lshlrev_b32 v242, 16, v255
v_and_b32 v243, 0xffff0000, v255
v_mul_f32 v242, v242, v239
v_mul_f32 v243, v243, v239
v_cvt_pk_bf16_f32 v255, v242, v243
ds_write_b64 v253, v[254:255] offset:7168
s_waitcnt lgkmcnt(0)
ds_read_b64 v[254:255], v253 offset:7176
s_waitcnt lgkmcnt(0)
v_lshlrev_b32 v242, 16, v254
v_and_b32 v243, 0xffff0000, v254
v_mul_f32 v242, v242, v239
v_mul_f32 v243, v243, v239
v_cvt_pk_bf16_f32 v254, v242, v243
v_lshlrev_b32 v242, 16, v255
v_and_b32 v243, 0xffff0000, v255
v_mul_f32 v242, v242, v239
v_mul_f32 v243, v243, v239
v_cvt_pk_bf16_f32 v255, v242, v243
ds_write_b64 v253, v[254:255] offset:7176
s_waitcnt lgkmcnt(0)
v_exp_f32 v232, v128
v_exp_f32 v233, v129
v_exp_f32 v234, v130
v_exp_f32 v235, v131
s_nop 1
v_add_f32 v228, v224, v232
v_add_f32 v228, v228, v233
v_add_f32 v228, v228, v234
v_add_f32 v228, v228, v235
v_cvt_pk_bf16_f32 v160, v232, v233
v_cvt_pk_bf16_f32 v161, v234, v235
v_exp_f32 v232, v132
v_exp_f32 v233, v133
v_exp_f32 v234, v134
v_exp_f32 v235, v135
s_nop 1
v_add_f32 v229, v225, v232
v_add_f32 v229, v229, v233
v_add_f32 v229, v229, v234
v_add_f32 v229, v229, v235
v_cvt_pk_bf16_f32 v164, v232, v233
v_cvt_pk_bf16_f32 v165, v234, v235
v_exp_f32 v232, v136
v_exp_f32 v233, v137
v_exp_f32 v234, v138
v_exp_f32 v235, v139
s_nop 1
v_add_f32 v230, v226, v232
v_add_f32 v230, v230, v233
v_add_f32 v230, v230, v234
v_add_f32 v230, v230, v235
v_cvt_pk_bf16_f32 v168, v232, v233
v_cvt_pk_bf16_f32 v169, v234, v235
v_exp_f32 v232, v140
v_exp_f32 v233, v141
v_exp_f32 v234, v142
v_exp_f32 v235, v143
s_nop 1
v_add_f32 v231, v227, v232
v_add_f32 v231, v231, v233
v_add_f32 v231, v231, v234
v_add_f32 v231, v231, v235
v_cvt_pk_bf16_f32 v172, v232, v233
v_cvt_pk_bf16_f32 v173, v234, v235
s_branch L2_rare_common
L2_rare_site17:
s_mov_b32 s36, 17
s_branch L2_rare_t1_5_1
L2_rare_t1_5_1:
s_nop 15
s_nop 15
s_waitcnt lgkmcnt(0)
v_log_f32 v243, v228
v_max3_f32 v232, v144, v145, v146
v_max3_f32 v232, v232, v147, v243
v_mov_b32 v243, v232
s_nop 1
v_permlane32_swap_b32 v232, v243
s_nop 1
v_max_f32 v232, v232, v243
v_mov_b32 v243, v232
s_nop 1
v_permlane16_swap_b32 v232, v243
s_nop 1
v_max_f32 v232, v232, v243
v_ceil_f32 v232, v232
v_max_f32 v232, 0, v232
v_sub_f32 v243, 0, v232
v_exp_f32 v236, v243
s_nop 1
v_mul_f32 v228, v228, v236
v_add_f32 v244, v244, v232
v_sub_f32 v192, v192, v232
v_sub_f32 v128, v128, v232
v_sub_f32 v144, v144, v232
v_sub_f32 v193, v193, v232
v_sub_f32 v129, v129, v232
v_sub_f32 v145, v145, v232
v_sub_f32 v194, v194, v232
v_sub_f32 v130, v130, v232
v_sub_f32 v146, v146, v232
v_sub_f32 v195, v195, v232
v_sub_f32 v131, v131, v232
v_sub_f32 v147, v147, v232
v_lshlrev_b32 v242, 16, v176
v_and_b32 v243, 0xffff0000, v176
v_mul_f32 v242, v242, v236
v_mul_f32 v243, v243, v236
v_cvt_pk_bf16_f32 v176, v242, v243
v_lshlrev_b32 v242, 16, v177
v_and_b32 v243, 0xffff0000, v177
v_mul_f32 v242, v242, v236
v_mul_f32 v243, v243, v236
v_cvt_pk_bf16_f32 v177, v242, v243
v_lshlrev_b32 v242, 16, v178
v_and_b32 v243, 0xffff0000, v178
v_mul_f32 v242, v242, v236
v_mul_f32 v243, v243, v236
v_cvt_pk_bf16_f32 v178, v242, v243
v_lshlrev_b32 v242, 16, v179
v_and_b32 v243, 0xffff0000, v179
v_mul_f32 v242, v242, v236
v_mul_f32 v243, v243, v236
v_cvt_pk_bf16_f32 v179, v242, v243
v_lshlrev_b32 v242, 16, v160
v_and_b32 v243, 0xffff0000, v160
v_mul_f32 v242, v242, v236
v_mul_f32 v243, v243, v236
v_cvt_pk_bf16_f32 v160, v242, v243
v_lshlrev_b32 v242, 16, v161
v_and_b32 v243, 0xffff0000, v161
v_mul_f32 v242, v242, v236
v_mul_f32 v243, v243, v236
v_cvt_pk_bf16_f32 v161, v242, v243
ds_read_b64 v[254:255], v253 offset:0
s_waitcnt lgkmcnt(0)
v_lshlrev_b32 v242, 16, v254
v_and_b32 v243, 0xffff0000, v254
v_mul_f32 v242, v242, v236
v_mul_f32 v243, v243, v236
v_cvt_pk_bf16_f32 v254, v242, v243
v_lshlrev_b32 v242, 16, v255
v_and_b32 v243, 0xffff0000, v255
v_mul_f32 v242, v242, v236
v_mul_f32 v243, v243, v236
v_cvt_pk_bf16_f32 v255, v242, v243
ds_write_b64 v253, v[254:255] offset:0
s_waitcnt lgkmcnt(0)
ds_read_b64 v[254:255], v253 offset:8
s_waitcnt lgkmcnt(0)
v_lshlrev_b32 v242, 16, v254
v_and_b32 v243, 0xffff0000, v254
v_mul_f32 v242, v242, v236
v_mul_f32 v243, v243, v236
v_cvt_pk_bf16_f32 v254, v242, v243
v_lshlrev_b32 v242, 16, v255
v_and_b32 v243, 0xffff0000, v255
v_mul_f32 v242, v242, v236
v_mul_f32 v243, v243, v236
v_cvt_pk_bf16_f32 v255, v242, v243
ds_write_b64 v253, v[254:255] offset:8
s_waitcnt lgkmcnt(0)
ds_read_b64 v[254:255], v253 offset:4096
s_waitcnt lgkmcnt(0)
v_lshlrev_b32 v242, 16, v254
v_and_b32 v243, 0xffff0000, v254
v_mul_f32 v242, v242, v236
v_mul_f32 v243, v243, v236
v_cvt_pk_bf16_f32 v254, v242, v243
v_lshlrev_b32 v242, 16, v255
v_and_b32 v243, 0xffff0000, v255
v_mul_f32 v242, v242, v236
v_mul_f32 v243, v243, v236
v_cvt_pk_bf16_f32 v255, v242, v243
ds_write_b64 v253, v[254:255] offset:4096
s_waitcnt lgkmcnt(0)
ds_read_b64 v[254:255], v253 offset:4104
s_waitcnt lgkmcnt(0)
v_lshlrev_b32 v242, 16, v254
v_and_b32 v243, 0xffff0000, v254
v_mul_f32 v242, v242, v236
v_mul_f32 v243, v243, v236
v_cvt_pk_bf16_f32 v254, v242, v243
v_lshlrev_b32 v242, 16, v255
v_and_b32 v243, 0xffff0000, v255
v_mul_f32 v242, v242, v236
v_mul_f32 v243, v243, v236
v_cvt_pk_bf16_f32 v255, v242, v243
ds_write_b64 v253, v[254:255] offset:4104
s_waitcnt lgkmcnt(0)
v_log_f32 v243, v229
v_max3_f32 v233, v148, v149, v150
v_max3_f32 v233, v233, v151, v243
v_mov_b32 v243, v233
s_nop 1
v_permlane32_swap_b32 v233, v243
s_nop 1
v_max_f32 v233, v233, v243
v_mov_b32 v243, v233
s_nop 1
v_permlane16_swap_b32 v233, v243
s_nop 1
v_max_f32 v233, v233, v243
v_ceil_f32 v233, v233
v_max_f32 v233, 0, v233
v_sub_f32 v243, 0, v233
v_exp_f32 v237, v243
s_nop 1
v_mul_f32 v229, v229, v237
v_add_f32 v245, v245, v233
v_sub_f32 v196, v196, v233
v_sub_f32 v132, v132, v233
v_sub_f32 v148, v148, v233
v_sub_f32 v197, v197, v233
v_sub_f32 v133, v133, v233
v_sub_f32 v149, v149, v233
v_sub_f32 v198, v198, v233
v_sub_f32 v134, v134, v233
v_sub_f32 v150, v150, v233
v_sub_f32 v199, v199, v233
v_sub_f32 v135, v135, v233
v_sub_f32 v151, v151, v233
v_lshlrev_b32 v242, 16, v180
v_and_b32 v243, 0xffff0000, v180
v_mul_f32 v242, v242, v237
v_mul_f32 v243, v243, v237
v_cvt_pk_bf16_f32 v180, v242, v243
v_lshlrev_b32 v242, 16, v181
v_and_b32 v243, 0xffff0000, v181
v_mul_f32 v242, v242, v237
v_mul_f32 v243, v243, v237
v_cvt_pk_bf16_f32 v181, v242, v243
v_lshlrev_b32 v242, 16, v182
v_and_b32 v243, 0xffff0000, v182
v_mul_f32 v242, v242, v237
v_mul_f32 v243, v243, v237
v_cvt_pk_bf16_f32 v182, v242, v243
v_lshlrev_b32 v242, 16, v183
v_and_b32 v243, 0xffff0000, v183
v_mul_f32 v242, v242, v237
v_mul_f32 v243, v243, v237
v_cvt_pk_bf16_f32 v183, v242, v243
v_lshlrev_b32 v242, 16, v164
v_and_b32 v243, 0xffff0000, v164
v_mul_f32 v242, v242, v237
v_mul_f32 v243, v243, v237
v_cvt_pk_bf16_f32 v164, v242, v243
v_lshlrev_b32 v242, 16, v165
v_and_b32 v243, 0xffff0000, v165
v_mul_f32 v242, v242, v237
v_mul_f32 v243, v243, v237
v_cvt_pk_bf16_f32 v165, v242, v243
ds_read_b64 v[254:255], v253 offset:1024
s_waitcnt lgkmcnt(0)
v_lshlrev_b32 v242, 16, v254
v_and_b32 v243, 0xffff0000, v254
v_mul_f32 v242, v242, v237
v_mul_f32 v243, v243, v237
v_cvt_pk_bf16_f32 v254, v242, v243
v_lshlrev_b32 v242, 16, v255
v_and_b32 v243, 0xffff0000, v255
v_mul_f32 v242, v242, v237
v_mul_f32 v243, v243, v237
v_cvt_pk_bf16_f32 v255, v242, v243
ds_write_b64 v253, v[254:255] offset:1024
s_waitcnt lgkmcnt(0)
ds_read_b64 v[254:255], v253 offset:1032
s_waitcnt lgkmcnt(0)
v_lshlrev_b32 v242, 16, v254
v_and_b32 v243, 0xffff0000, v254
v_mul_f32 v242, v242, v237
v_mul_f32 v243, v243, v237
v_cvt_pk_bf16_f32 v254, v242, v243
v_lshlrev_b32 v242, 16, v255
v_and_b32 v243, 0xffff0000, v255
v_mul_f32 v242, v242, v237
v_mul_f32 v243, v243, v237
v_cvt_pk_bf16_f32 v255, v242, v243
ds_write_b64 v253, v[254:255] offset:1032
s_waitcnt lgkmcnt(0)
ds_read_b64 v[254:255], v253 offset:5120
s_waitcnt lgkmcnt(0)
v_lshlrev_b32 v242, 16, v254
v_and_b32 v243, 0xffff0000, v254
v_mul_f32 v242, v242, v237
v_mul_f32 v243, v243, v237
v_cvt_pk_bf16_f32 v254, v242, v243
v_lshlrev_b32 v242, 16, v255
v_and_b32 v243, 0xffff0000, v255
v_mul_f32 v242, v242, v237
v_mul_f32 v243, v243, v237
v_cvt_pk_bf16_f32 v255, v242, v243
ds_write_b64 v253, v[254:255] offset:5120
s_waitcnt lgkmcnt(0)
ds_read_b64 v[254:255], v253 offset:5128
s_waitcnt lgkmcnt(0)
v_lshlrev_b32 v242, 16, v254
v_and_b32 v243, 0xffff0000, v254
v_mul_f32 v242, v242, v237
v_mul_f32 v243, v243, v237
v_cvt_pk_bf16_f32 v254, v242, v243
v_lshlrev_b32 v242, 16, v255
v_and_b32 v243, 0xffff0000, v255
v_mul_f32 v242, v242, v237
v_mul_f32 v243, v243, v237
v_cvt_pk_bf16_f32 v255, v242, v243
ds_write_b64 v253, v[254:255] offset:5128
s_waitcnt lgkmcnt(0)
v_log_f32 v243, v230
v_max3_f32 v234, v152, v153, v154
v_max3_f32 v234, v234, v155, v243
v_mov_b32 v243, v234
s_nop 1
v_permlane32_swap_b32 v234, v243
s_nop 1
v_max_f32 v234, v234, v243
v_mov_b32 v243, v234
s_nop 1
v_permlane16_swap_b32 v234, v243
s_nop 1
v_max_f32 v234, v234, v243
v_ceil_f32 v234, v234
v_max_f32 v234, 0, v234
v_sub_f32 v243, 0, v234
v_exp_f32 v238, v243
s_nop 1
v_mul_f32 v230, v230, v238
v_add_f32 v246, v246, v234
v_sub_f32 v200, v200, v234
v_sub_f32 v136, v136, v234
v_sub_f32 v152, v152, v234
v_sub_f32 v201, v201, v234
v_sub_f32 v137, v137, v234
v_sub_f32 v153, v153, v234
v_sub_f32 v202, v202, v234
v_sub_f32 v138, v138, v234
v_sub_f32 v154, v154, v234
v_sub_f32 v203, v203, v234
v_sub_f32 v139, v139, v234
v_sub_f32 v155, v155, v234
v_lshlrev_b32 v242, 16, v184
v_and_b32 v243, 0xffff0000, v184
v_mul_f32 v242, v242, v238
v_mul_f32 v243, v243, v238
v_cvt_pk_bf16_f32 v184, v242, v243
v_lshlrev_b32 v242, 16, v185
v_and_b32 v243, 0xffff0000, v185
v_mul_f32 v242, v242, v238
v_mul_f32 v243, v243, v238
v_cvt_pk_bf16_f32 v185, v242, v243
v_lshlrev_b32 v242, 16, v186
v_and_b32 v243, 0xffff0000, v186
v_mul_f32 v242, v242, v238
v_mul_f32 v243, v243, v238
v_cvt_pk_bf16_f32 v186, v242, v243
v_lshlrev_b32 v242, 16, v187
v_and_b32 v243, 0xffff0000, v187
v_mul_f32 v242, v242, v238
v_mul_f32 v243, v243, v238
v_cvt_pk_bf16_f32 v187, v242, v243
v_lshlrev_b32 v242, 16, v168
v_and_b32 v243, 0xffff0000, v168
v_mul_f32 v242, v242, v238
v_mul_f32 v243, v243, v238
v_cvt_pk_bf16_f32 v168, v242, v243
v_lshlrev_b32 v242, 16, v169
v_and_b32 v243, 0xffff0000, v169
v_mul_f32 v242, v242, v238
v_mul_f32 v243, v243, v238
v_cvt_pk_bf16_f32 v169, v242, v243
ds_read_b64 v[254:255], v253 offset:2048
s_waitcnt lgkmcnt(0)
v_lshlrev_b32 v242, 16, v254
v_and_b32 v243, 0xffff0000, v254
v_mul_f32 v242, v242, v238
v_mul_f32 v243, v243, v238
v_cvt_pk_bf16_f32 v254, v242, v243
v_lshlrev_b32 v242, 16, v255
v_and_b32 v243, 0xffff0000, v255
v_mul_f32 v242, v242, v238
v_mul_f32 v243, v243, v238
v_cvt_pk_bf16_f32 v255, v242, v243
ds_write_b64 v253, v[254:255] offset:2048
s_waitcnt lgkmcnt(0)
ds_read_b64 v[254:255], v253 offset:2056
s_waitcnt lgkmcnt(0)
v_lshlrev_b32 v242, 16, v254
v_and_b32 v243, 0xffff0000, v254
v_mul_f32 v242, v242, v238
v_mul_f32 v243, v243, v238
v_cvt_pk_bf16_f32 v254, v242, v243
v_lshlrev_b32 v242, 16, v255
v_and_b32 v243, 0xffff0000, v255
v_mul_f32 v242, v242, v238
v_mul_f32 v243, v243, v238
v_cvt_pk_bf16_f32 v255, v242, v243
ds_write_b64 v253, v[254:255] offset:2056
s_waitcnt lgkmcnt(0)
ds_read_b64 v[254:255], v253 offset:6144
s_waitcnt lgkmcnt(0)
v_lshlrev_b32 v242, 16, v254
v_and_b32 v243, 0xffff0000, v254
v_mul_f32 v242, v242, v238
v_mul_f32 v243, v243, v238
v_cvt_pk_bf16_f32 v254, v242, v243
v_lshlrev_b32 v242, 16, v255
v_and_b32 v243, 0xffff0000, v255
v_mul_f32 v242, v242, v238
v_mul_f32 v243, v243, v238
v_cvt_pk_bf16_f32 v255, v242, v243
ds_write_b64 v253, v[254:255] offset:6144
s_waitcnt lgkmcnt(0)
ds_read_b64 v[254:255], v253 offset:6152
s_waitcnt lgkmcnt(0)
v_lshlrev_b32 v242, 16, v254
v_and_b32 v243, 0xffff0000, v254
v_mul_f32 v242, v242, v238
v_mul_f32 v243, v243, v238
v_cvt_pk_bf16_f32 v254, v242, v243
v_lshlrev_b32 v242, 16, v255
v_and_b32 v243, 0xffff0000, v255
v_mul_f32 v242, v242, v238
v_mul_f32 v243, v243, v238
v_cvt_pk_bf16_f32 v255, v242, v243
ds_write_b64 v253, v[254:255] offset:6152
s_waitcnt lgkmcnt(0)
v_log_f32 v243, v231
v_max3_f32 v235, v156, v157, v158
v_max3_f32 v235, v235, v159, v243
v_mov_b32 v243, v235
s_nop 1
v_permlane32_swap_b32 v235, v243
s_nop 1
v_max_f32 v235, v235, v243
v_mov_b32 v243, v235
s_nop 1
v_permlane16_swap_b32 v235, v243
s_nop 1
v_max_f32 v235, v235, v243
v_ceil_f32 v235, v235
v_max_f32 v235, 0, v235
v_sub_f32 v243, 0, v235
v_exp_f32 v239, v243
s_nop 1
v_mul_f32 v231, v231, v239
v_add_f32 v247, v247, v235
v_sub_f32 v204, v204, v235
v_sub_f32 v140, v140, v235
v_sub_f32 v156, v156, v235
v_sub_f32 v205, v205, v235
v_sub_f32 v141, v141, v235
v_sub_f32 v157, v157, v235
v_sub_f32 v206, v206, v235
v_sub_f32 v142, v142, v235
v_sub_f32 v158, v158, v235
v_sub_f32 v207, v207, v235
v_sub_f32 v143, v143, v235
v_sub_f32 v159, v159, v235
v_lshlrev_b32 v242, 16, v188
v_and_b32 v243, 0xffff0000, v188
v_mul_f32 v242, v242, v239
v_mul_f32 v243, v243, v239
v_cvt_pk_bf16_f32 v188, v242, v243
v_lshlrev_b32 v242, 16, v189
v_and_b32 v243, 0xffff0000, v189
v_mul_f32 v242, v242, v239
v_mul_f32 v243, v243, v239
v_cvt_pk_bf16_f32 v189, v242, v243
v_lshlrev_b32 v242, 16, v190
v_and_b32 v243, 0xffff0000, v190
v_mul_f32 v242, v242, v239
v_mul_f32 v243, v243, v239
v_cvt_pk_bf16_f32 v190, v242, v243
v_lshlrev_b32 v242, 16, v191
v_and_b32 v243, 0xffff0000, v191
v_mul_f32 v242, v242, v239
v_mul_f32 v243, v243, v239
v_cvt_pk_bf16_f32 v191, v242, v243
v_lshlrev_b32 v242, 16, v172
v_and_b32 v243, 0xffff0000, v172
v_mul_f32 v242, v242, v239
v_mul_f32 v243, v243, v239
v_cvt_pk_bf16_f32 v172, v242, v243
v_lshlrev_b32 v242, 16, v173
v_and_b32 v243, 0xffff0000, v173
v_mul_f32 v242, v242, v239
v_mul_f32 v243, v243, v239
v_cvt_pk_bf16_f32 v173, v242, v243
ds_read_b64 v[254:255], v253 offset:3072
s_waitcnt lgkmcnt(0)
v_lshlrev_b32 v242, 16, v254
v_and_b32 v243, 0xffff0000, v254
v_mul_f32 v242, v242, v239
v_mul_f32 v243, v243, v239
v_cvt_pk_bf16_f32 v254, v242, v243
v_lshlrev_b32 v242, 16, v255
v_and_b32 v243, 0xffff0000, v255
v_mul_f32 v242, v242, v239
v_mul_f32 v243, v243, v239
v_cvt_pk_bf16_f32 v255, v242, v243
ds_write_b64 v253, v[254:255] offset:3072
s_waitcnt lgkmcnt(0)
ds_read_b64 v[254:255], v253 offset:3080
s_waitcnt lgkmcnt(0)
v_lshlrev_b32 v242, 16, v254
v_and_b32 v243, 0xffff0000, v254
v_mul_f32 v242, v242, v239
v_mul_f32 v243, v243, v239
v_cvt_pk_bf16_f32 v254, v242, v243
v_lshlrev_b32 v242, 16, v255
v_and_b32 v243, 0xffff0000, v255
v_mul_f32 v242, v242, v239
v_mul_f32 v243, v243, v239
v_cvt_pk_bf16_f32 v255, v242, v243
ds_write_b64 v253, v[254:255] offset:3080
s_waitcnt lgkmcnt(0)
ds_read_b64 v[254:255], v253 offset:7168
s_waitcnt lgkmcnt(0)
v_lshlrev_b32 v242, 16, v254
v_and_b32 v243, 0xffff0000, v254
v_mul_f32 v242, v242, v239
v_mul_f32 v243, v243, v239
v_cvt_pk_bf16_f32 v254, v242, v243
v_lshlrev_b32 v242, 16, v255
v_and_b32 v243, 0xffff0000, v255
v_mul_f32 v242, v242, v239
v_mul_f32 v243, v243, v239
v_cvt_pk_bf16_f32 v255, v242, v243
ds_write_b64 v253, v[254:255] offset:7168
s_waitcnt lgkmcnt(0)
ds_read_b64 v[254:255], v253 offset:7176
s_waitcnt lgkmcnt(0)
v_lshlrev_b32 v242, 16, v254
v_and_b32 v243, 0xffff0000, v254
v_mul_f32 v242, v242, v239
v_mul_f32 v243, v243, v239
v_cvt_pk_bf16_f32 v254, v242, v243
v_lshlrev_b32 v242, 16, v255
v_and_b32 v243, 0xffff0000, v255
v_mul_f32 v242, v242, v239
v_mul_f32 v243, v243, v239
v_cvt_pk_bf16_f32 v255, v242, v243
ds_write_b64 v253, v[254:255] offset:7176
s_waitcnt lgkmcnt(0)
v_exp_f32 v232, v144
v_exp_f32 v233, v145
v_exp_f32 v234, v146
v_exp_f32 v235, v147
s_nop 1
v_add_f32 v224, v228, v232
v_add_f32 v224, v224, v233
v_add_f32 v224, v224, v234
v_add_f32 v224, v224, v235
v_cvt_pk_bf16_f32 v162, v232, v233
v_cvt_pk_bf16_f32 v163, v234, v235
v_exp_f32 v232, v148
v_exp_f32 v233, v149
v_exp_f32 v234, v150
v_exp_f32 v235, v151
s_nop 1
v_add_f32 v225, v229, v232
v_add_f32 v225, v225, v233
v_add_f32 v225, v225, v234
v_add_f32 v225, v225, v235
v_cvt_pk_bf16_f32 v166, v232, v233
v_cvt_pk_bf16_f32 v167, v234, v235
v_exp_f32 v232, v152
v_exp_f32 v233, v153
v_exp_f32 v234, v154
v_exp_f32 v235, v155
s_nop 1
v_add_f32 v226, v230, v232
v_add_f32 v226, v226, v233
v_add_f32 v226, v226, v234
v_add_f32 v226, v226, v235
v_cvt_pk_bf16_f32 v170, v232, v233
v_cvt_pk_bf16_f32 v171, v234, v235
v_exp_f32 v232, v156
v_exp_f32 v233, v157
v_exp_f32 v234, v158
v_exp_f32 v235, v159
s_nop 1
v_add_f32 v227, v231, v232
v_add_f32 v227, v227, v233
v_add_f32 v227, v227, v234
v_add_f32 v227, v227, v235
v_cvt_pk_bf16_f32 v174, v232, v233
v_cvt_pk_bf16_f32 v175, v234, v235
s_branch L2_rare_common
L2_rare_site18:
s_mov_b32 s36, 18
s_branch L2_rare_t1_6_0
L2_rare_t1_6_0:
s_nop 15
s_nop 15
s_waitcnt lgkmcnt(0)
v_log_f32 v243, v224
v_max3_f32 v232, v128, v129, v130
v_max3_f32 v232, v232, v131, v243
v_mov_b32 v243, v232
s_nop 1
v_permlane32_swap_b32 v232, v243
s_nop 1
v_max_f32 v232, v232, v243
v_mov_b32 v243, v232
s_nop 1
v_permlane16_swap_b32 v232, v243
s_nop 1
v_max_f32 v232, v232, v243
v_ceil_f32 v232, v232
v_max_f32 v232, 0, v232
v_sub_f32 v243, 0, v232
v_exp_f32 v236, v243
s_nop 1
v_mul_f32 v224, v224, v236
v_add_f32 v244, v244, v232
v_sub_f32 v192, v192, v232
v_sub_f32 v128, v128, v232
v_sub_f32 v144, v144, v232
v_sub_f32 v193, v193, v232
v_sub_f32 v129, v129, v232
v_sub_f32 v145, v145, v232
v_sub_f32 v194, v194, v232
v_sub_f32 v130, v130, v232
v_sub_f32 v146, v146, v232
v_sub_f32 v195, v195, v232
v_sub_f32 v131, v131, v232
v_sub_f32 v147, v147, v232
v_lshlrev_b32 v242, 16, v4
v_and_b32 v243, 0xffff0000, v4
v_mul_f32 v242, v242, v236
v_mul_f32 v243, v243, v236
v_cvt_pk_bf16_f32 v4, v242, v243
v_lshlrev_b32 v242, 16, v5
v_and_b32 v243, 0xffff0000, v5
v_mul_f32 v242, v242, v236
v_mul_f32 v243, v243, v236
v_cvt_pk_bf16_f32 v5, v242, v243
v_lshlrev_b32 v242, 16, v6
v_and_b32 v243, 0xffff0000, v6
v_mul_f32 v242, v242, v236
v_mul_f32 v243, v243, v236
v_cvt_pk_bf16_f32 v6, v242, v243
v_lshlrev_b32 v242, 16, v7
v_and_b32 v243, 0xffff0000, v7
v_mul_f32 v242, v242, v236
v_mul_f32 v243, v243, v236
v_cvt_pk_bf16_f32 v7, v242, v243
v_lshlrev_b32 v242, 16, v8
v_and_b32 v243, 0xffff0000, v8
v_mul_f32 v242, v242, v236
v_mul_f32 v243, v243, v236
v_cvt_pk_bf16_f32 v8, v242, v243
v_lshlrev_b32 v242, 16, v9
v_and_b32 v243, 0xffff0000, v9
v_mul_f32 v242, v242, v236
v_mul_f32 v243, v243, v236
v_cvt_pk_bf16_f32 v9, v242, v243
v_lshlrev_b32 v242, 16, v10
v_and_b32 v243, 0xffff0000, v10
v_mul_f32 v242, v242, v236
v_mul_f32 v243, v243, v236
v_cvt_pk_bf16_f32 v10, v242, v243
v_lshlrev_b32 v242, 16, v11
v_and_b32 v243, 0xffff0000, v11
v_mul_f32 v242, v242, v236
v_mul_f32 v243, v243, v236
v_cvt_pk_bf16_f32 v11, v242, v243
v_lshlrev_b32 v242, 16, v176
v_and_b32 v243, 0xffff0000, v176
v_mul_f32 v242, v242, v236
v_mul_f32 v243, v243, v236
v_cvt_pk_bf16_f32 v176, v242, v243
v_lshlrev_b32 v242, 16, v177
v_and_b32 v243, 0xffff0000, v177
v_mul_f32 v242, v242, v236
v_mul_f32 v243, v243, v236
v_cvt_pk_bf16_f32 v177, v242, v243
v_lshlrev_b32 v242, 16, v178
v_and_b32 v243, 0xffff0000, v178
v_mul_f32 v242, v242, v236
v_mul_f32 v243, v243, v236
v_cvt_pk_bf16_f32 v178, v242, v243
v_lshlrev_b32 v242, 16, v179
v_and_b32 v243, 0xffff0000, v179
v_mul_f32 v242, v242, v236
v_mul_f32 v243, v243, v236
v_cvt_pk_bf16_f32 v179, v242, v243
v_lshlrev_b32 v242, 16, v160
v_and_b32 v243, 0xffff0000, v160
v_mul_f32 v242, v242, v236
v_mul_f32 v243, v243, v236
v_cvt_pk_bf16_f32 v160, v242, v243
v_lshlrev_b32 v242, 16, v161
v_and_b32 v243, 0xffff0000, v161
v_mul_f32 v242, v242, v236
v_mul_f32 v243, v243, v236
v_cvt_pk_bf16_f32 v161, v242, v243
v_lshlrev_b32 v242, 16, v162
v_and_b32 v243, 0xffff0000, v162
v_mul_f32 v242, v242, v236
v_mul_f32 v243, v243, v236
v_cvt_pk_bf16_f32 v162, v242, v243
v_lshlrev_b32 v242, 16, v163
v_and_b32 v243, 0xffff0000, v163
v_mul_f32 v242, v242, v236
v_mul_f32 v243, v243, v236
v_cvt_pk_bf16_f32 v163, v242, v243
v_log_f32 v243, v225
v_max3_f32 v233, v132, v133, v134
v_max3_f32 v233, v233, v135, v243
v_mov_b32 v243, v233
s_nop 1
v_permlane32_swap_b32 v233, v243
s_nop 1
v_max_f32 v233, v233, v243
v_mov_b32 v243, v233
s_nop 1
v_permlane16_swap_b32 v233, v243
s_nop 1
v_max_f32 v233, v233, v243
v_ceil_f32 v233, v233
v_max_f32 v233, 0, v233
v_sub_f32 v243, 0, v233
v_exp_f32 v237, v243
s_nop 1
v_mul_f32 v225, v225, v237
v_add_f32 v245, v245, v233
v_sub_f32 v196, v196, v233
v_sub_f32 v132, v132, v233
v_sub_f32 v148, v148, v233
v_sub_f32 v197, v197, v233
v_sub_f32 v133, v133, v233
v_sub_f32 v149, v149, v233
v_sub_f32 v198, v198, v233
v_sub_f32 v134, v134, v233
v_sub_f32 v150, v150, v233
v_sub_f32 v199, v199, v233
v_sub_f32 v135, v135, v233
v_sub_f32 v151, v151, v233
v_lshlrev_b32 v242, 16, v36
v_and_b32 v243, 0xffff0000, v36
v_mul_f32 v242, v242, v237
v_mul_f32 v243, v243, v237
v_cvt_pk_bf16_f32 v36, v242, v243
v_lshlrev_b32 v242, 16, v37
v_and_b32 v243, 0xffff0000, v37
v_mul_f32 v242, v242, v237
v_mul_f32 v243, v243, v237
v_cvt_pk_bf16_f32 v37, v242, v243
v_lshlrev_b32 v242, 16, v38
v_and_b32 v243, 0xffff0000, v38
v_mul_f32 v242, v242, v237
v_mul_f32 v243, v243, v237
v_cvt_pk_bf16_f32 v38, v242, v243
v_lshlrev_b32 v242, 16, v39
v_and_b32 v243, 0xffff0000, v39
v_mul_f32 v242, v242, v237
v_mul_f32 v243, v243, v237
v_cvt_pk_bf16_f32 v39, v242, v243
v_lshlrev_b32 v242, 16, v40
v_and_b32 v243, 0xffff0000, v40
v_mul_f32 v242, v242, v237
v_mul_f32 v243, v243, v237
v_cvt_pk_bf16_f32 v40, v242, v243
v_lshlrev_b32 v242, 16, v41
v_and_b32 v243, 0xffff0000, v41
v_mul_f32 v242, v242, v237
v_mul_f32 v243, v243, v237
v_cvt_pk_bf16_f32 v41, v242, v243
v_lshlrev_b32 v242, 16, v42
v_and_b32 v243, 0xffff0000, v42
v_mul_f32 v242, v242, v237
v_mul_f32 v243, v243, v237
v_cvt_pk_bf16_f32 v42, v242, v243
v_lshlrev_b32 v242, 16, v43
v_and_b32 v243, 0xffff0000, v43
v_mul_f32 v242, v242, v237
v_mul_f32 v243, v243, v237
v_cvt_pk_bf16_f32 v43, v242, v243
v_lshlrev_b32 v242, 16, v180
v_and_b32 v243, 0xffff0000, v180
v_mul_f32 v242, v242, v237
v_mul_f32 v243, v243, v237
v_cvt_pk_bf16_f32 v180, v242, v243
v_lshlrev_b32 v242, 16, v181
v_and_b32 v243, 0xffff0000, v181
v_mul_f32 v242, v242, v237
v_mul_f32 v243, v243, v237
v_cvt_pk_bf16_f32 v181, v242, v243
v_lshlrev_b32 v242, 16, v182
v_and_b32 v243, 0xffff0000, v182
v_mul_f32 v242, v242, v237
v_mul_f32 v243, v243, v237
v_cvt_pk_bf16_f32 v182, v242, v243
v_lshlrev_b32 v242, 16, v183
v_and_b32 v243, 0xffff0000, v183
v_mul_f32 v242, v242, v237
v_mul_f32 v243, v243, v237
v_cvt_pk_bf16_f32 v183, v242, v243
v_lshlrev_b32 v242, 16, v164
v_and_b32 v243, 0xffff0000, v164
v_mul_f32 v242, v242, v237
v_mul_f32 v243, v243, v237
v_cvt_pk_bf16_f32 v164, v242, v243
v_lshlrev_b32 v242, 16, v165
v_and_b32 v243, 0xffff0000, v165
v_mul_f32 v242, v242, v237
v_mul_f32 v243, v243, v237
v_cvt_pk_bf16_f32 v165, v242, v243
v_lshlrev_b32 v242, 16, v166
v_and_b32 v243, 0xffff0000, v166
v_mul_f32 v242, v242, v237
v_mul_f32 v243, v243, v237
v_cvt_pk_bf16_f32 v166, v242, v243
v_lshlrev_b32 v242, 16, v167
v_and_b32 v243, 0xffff0000, v167
v_mul_f32 v242, v242, v237
v_mul_f32 v243, v243, v237
v_cvt_pk_bf16_f32 v167, v242, v243
v_log_f32 v243, v226
v_max3_f32 v234, v136, v137, v138
v_max3_f32 v234, v234, v139, v243
v_mov_b32 v243, v234
s_nop 1
v_permlane32_swap_b32 v234, v243
s_nop 1
v_max_f32 v234, v234, v243
v_mov_b32 v243, v234
s_nop 1
v_permlane16_swap_b32 v234, v243
s_nop 1
v_max_f32 v234, v234, v243
v_ceil_f32 v234, v234
v_max_f32 v234, 0, v234
v_sub_f32 v243, 0, v234
v_exp_f32 v238, v243
s_nop 1
v_mul_f32 v226, v226, v238
v_add_f32 v246, v246, v234
v_sub_f32 v200, v200, v234
v_sub_f32 v136, v136, v234
v_sub_f32 v152, v152, v234
v_sub_f32 v201, v201, v234
v_sub_f32 v137, v137, v234
v_sub_f32 v153, v153, v234
v_sub_f32 v202, v202, v234
v_sub_f32 v138, v138, v234
v_sub_f32 v154, v154, v234
v_sub_f32 v203, v203, v234
v_sub_f32 v139, v139, v234
v_sub_f32 v155, v155, v234
v_lshlrev_b32 v242, 16, v68
v_and_b32 v243, 0xffff0000, v68
v_mul_f32 v242, v242, v238
v_mul_f32 v243, v243, v238
v_cvt_pk_bf16_f32 v68, v242, v243
v_lshlrev_b32 v242, 16, v69
v_and_b32 v243, 0xffff0000, v69
v_mul_f32 v242, v242, v238
v_mul_f32 v243, v243, v238
v_cvt_pk_bf16_f32 v69, v242, v243
v_lshlrev_b32 v242, 16, v70
v_and_b32 v243, 0xffff0000, v70
v_mul_f32 v242, v242, v238
v_mul_f32 v243, v243, v238
v_cvt_pk_bf16_f32 v70, v242, v243
v_lshlrev_b32 v242, 16, v71
v_and_b32 v243, 0xffff0000, v71
v_mul_f32 v242, v242, v238
v_mul_f32 v243, v243, v238
v_cvt_pk_bf16_f32 v71, v242, v243
v_lshlrev_b32 v242, 16, v72
v_and_b32 v243, 0xffff0000, v72
v_mul_f32 v242, v242, v238
v_mul_f32 v243, v243, v238
v_cvt_pk_bf16_f32 v72, v242, v243
v_lshlrev_b32 v242, 16, v73
v_and_b32 v243, 0xffff0000, v73
v_mul_f32 v242, v242, v238
v_mul_f32 v243, v243, v238
v_cvt_pk_bf16_f32 v73, v242, v243
v_lshlrev_b32 v242, 16, v74
v_and_b32 v243, 0xffff0000, v74
v_mul_f32 v242, v242, v238
v_mul_f32 v243, v243, v238
v_cvt_pk_bf16_f32 v74, v242, v243
v_lshlrev_b32 v242, 16, v75
v_and_b32 v243, 0xffff0000, v75
v_mul_f32 v242, v242, v238
v_mul_f32 v243, v243, v238
v_cvt_pk_bf16_f32 v75, v242, v243
v_lshlrev_b32 v242, 16, v184
v_and_b32 v243, 0xffff0000, v184
v_mul_f32 v242, v242, v238
v_mul_f32 v243, v243, v238
v_cvt_pk_bf16_f32 v184, v242, v243
v_lshlrev_b32 v242, 16, v185
v_and_b32 v243, 0xffff0000, v185
v_mul_f32 v242, v242, v238
v_mul_f32 v243, v243, v238
v_cvt_pk_bf16_f32 v185, v242, v243
v_lshlrev_b32 v242, 16, v186
v_and_b32 v243, 0xffff0000, v186
v_mul_f32 v242, v242, v238
v_mul_f32 v243, v243, v238
v_cvt_pk_bf16_f32 v186, v242, v243
v_lshlrev_b32 v242, 16, v187
v_and_b32 v243, 0xffff0000, v187
v_mul_f32 v242, v242, v238
v_mul_f32 v243, v243, v238
v_cvt_pk_bf16_f32 v187, v242, v243
v_lshlrev_b32 v242, 16, v168
v_and_b32 v243, 0xffff0000, v168
v_mul_f32 v242, v242, v238
v_mul_f32 v243, v243, v238
v_cvt_pk_bf16_f32 v168, v242, v243
v_lshlrev_b32 v242, 16, v169
v_and_b32 v243, 0xffff0000, v169
v_mul_f32 v242, v242, v238
v_mul_f32 v243, v243, v238
v_cvt_pk_bf16_f32 v169, v242, v243
v_lshlrev_b32 v242, 16, v170
v_and_b32 v243, 0xffff0000, v170
v_mul_f32 v242, v242, v238
v_mul_f32 v243, v243, v238
v_cvt_pk_bf16_f32 v170, v242, v243
v_lshlrev_b32 v242, 16, v171
v_and_b32 v243, 0xffff0000, v171
v_mul_f32 v242, v242, v238
v_mul_f32 v243, v243, v238
v_cvt_pk_bf16_f32 v171, v242, v243
v_log_f32 v243, v227
v_max3_f32 v235, v140, v141, v142
v_max3_f32 v235, v235, v143, v243
v_mov_b32 v243, v235
s_nop 1
v_permlane32_swap_b32 v235, v243
s_nop 1
v_max_f32 v235, v235, v243
v_mov_b32 v243, v235
s_nop 1
v_permlane16_swap_b32 v235, v243
s_nop 1
v_max_f32 v235, v235, v243
v_ceil_f32 v235, v235
v_max_f32 v235, 0, v235
v_sub_f32 v243, 0, v235
v_exp_f32 v239, v243
s_nop 1
v_mul_f32 v227, v227, v239
v_add_f32 v247, v247, v235
v_sub_f32 v204, v204, v235
v_sub_f32 v140, v140, v235
v_sub_f32 v156, v156, v235
v_sub_f32 v205, v205, v235
v_sub_f32 v141, v141, v235
v_sub_f32 v157, v157, v235
v_sub_f32 v206, v206, v235
v_sub_f32 v142, v142, v235
v_sub_f32 v158, v158, v235
v_sub_f32 v207, v207, v235
v_sub_f32 v143, v143, v235
v_sub_f32 v159, v159, v235
v_lshlrev_b32 v242, 16, v100
v_and_b32 v243, 0xffff0000, v100
v_mul_f32 v242, v242, v239
v_mul_f32 v243, v243, v239
v_cvt_pk_bf16_f32 v100, v242, v243
v_lshlrev_b32 v242, 16, v101
v_and_b32 v243, 0xffff0000, v101
v_mul_f32 v242, v242, v239
v_mul_f32 v243, v243, v239
v_cvt_pk_bf16_f32 v101, v242, v243
v_lshlrev_b32 v242, 16, v102
v_and_b32 v243, 0xffff0000, v102
v_mul_f32 v242, v242, v239
v_mul_f32 v243, v243, v239
v_cvt_pk_bf16_f32 v102, v242, v243
v_lshlrev_b32 v242, 16, v103
v_and_b32 v243, 0xffff0000, v103
v_mul_f32 v242, v242, v239
v_mul_f32 v243, v243, v239
v_cvt_pk_bf16_f32 v103, v242, v243
v_lshlrev_b32 v242, 16, v104
v_and_b32 v243, 0xffff0000, v104
v_mul_f32 v242, v242, v239
v_mul_f32 v243, v243, v239
v_cvt_pk_bf16_f32 v104, v242, v243
v_lshlrev_b32 v242, 16, v105
v_and_b32 v243, 0xffff0000, v105
v_mul_f32 v242, v242, v239
v_mul_f32 v243, v243, v239
v_cvt_pk_bf16_f32 v105, v242, v243
v_lshlrev_b32 v242, 16, v106
v_and_b32 v243, 0xffff0000, v106
v_mul_f32 v242, v242, v239
v_mul_f32 v243, v243, v239
v_cvt_pk_bf16_f32 v106, v242, v243
v_lshlrev_b32 v242, 16, v107
v_and_b32 v243, 0xffff0000, v107
v_mul_f32 v242, v242, v239
v_mul_f32 v243, v243, v239
v_cvt_pk_bf16_f32 v107, v242, v243
v_lshlrev_b32 v242, 16, v188
v_and_b32 v243, 0xffff0000, v188
v_mul_f32 v242, v242, v239
v_mul_f32 v243, v243, v239
v_cvt_pk_bf16_f32 v188, v242, v243
v_lshlrev_b32 v242, 16, v189
v_and_b32 v243, 0xffff0000, v189
v_mul_f32 v242, v242, v239
v_mul_f32 v243, v243, v239
v_cvt_pk_bf16_f32 v189, v242, v243
v_lshlrev_b32 v242, 16, v190
v_and_b32 v243, 0xffff0000, v190
v_mul_f32 v242, v242, v239
v_mul_f32 v243, v243, v239
v_cvt_pk_bf16_f32 v190, v242, v243
v_lshlrev_b32 v242, 16, v191
v_and_b32 v243, 0xffff0000, v191
v_mul_f32 v242, v242, v239
v_mul_f32 v243, v243, v239
v_cvt_pk_bf16_f32 v191, v242, v243
v_lshlrev_b32 v242, 16, v172
v_and_b32 v243, 0xffff0000, v172
v_mul_f32 v242, v242, v239
v_mul_f32 v243, v243, v239
v_cvt_pk_bf16_f32 v172, v242, v243
v_lshlrev_b32 v242, 16, v173
v_and_b32 v243, 0xffff0000, v173
v_mul_f32 v242, v242, v239
v_mul_f32 v243, v243, v239
v_cvt_pk_bf16_f32 v173, v242, v243
v_lshlrev_b32 v242, 16, v174
v_and_b32 v243, 0xffff0000, v174
v_mul_f32 v242, v242, v239
v_mul_f32 v243, v243, v239
v_cvt_pk_bf16_f32 v174, v242, v243
v_lshlrev_b32 v242, 16, v175
v_and_b32 v243, 0xffff0000, v175
v_mul_f32 v242, v242, v239
v_mul_f32 v243, v243, v239
v_cvt_pk_bf16_f32 v175, v242, v243
v_exp_f32 v232, v128
v_exp_f32 v233, v129
v_exp_f32 v234, v130
v_exp_f32 v235, v131
s_nop 1
v_add_f32 v228, v224, v232
v_add_f32 v228, v228, v233
v_add_f32 v228, v228, v234
v_add_f32 v228, v228, v235
v_cvt_pk_bf16_f32 v0, v232, v233
v_cvt_pk_bf16_f32 v1, v234, v235
v_exp_f32 v232, v132
v_exp_f32 v233, v133
v_exp_f32 v234, v134
v_exp_f32 v235, v135
s_nop 1
v_add_f32 v229, v225, v232
v_add_f32 v229, v229, v233
v_add_f32 v229, v229, v234
v_add_f32 v229, v229, v235
v_cvt_pk_bf16_f32 v32, v232, v233
v_cvt_pk_bf16_f32 v33, v234, v235
v_exp_f32 v232, v136
v_exp_f32 v233, v137
v_exp_f32 v234, v138
v_exp_f32 v235, v139
s_nop 1
v_add_f32 v230, v226, v232
v_add_f32 v230, v230, v233
v_add_f32 v230, v230, v234
v_add_f32 v230, v230, v235
v_cvt_pk_bf16_f32 v64, v232, v233
v_cvt_pk_bf16_f32 v65, v234, v235
v_exp_f32 v232, v140
v_exp_f32 v233, v141
v_exp_f32 v234, v142
v_exp_f32 v235, v143
s_nop 1
v_add_f32 v231, v227, v232
v_add_f32 v231, v231, v233
v_add_f32 v231, v231, v234
v_add_f32 v231, v231, v235
v_cvt_pk_bf16_f32 v96, v232, v233
v_cvt_pk_bf16_f32 v97, v234, v235
s_branch L2_rare_common
L2_rare_site19:
s_mov_b32 s36, 19
s_branch L2_rare_t1_7_1
L2_rare_t1_7_1:
s_nop 15
s_nop 15
s_waitcnt lgkmcnt(0)
v_log_f32 v243, v228
v_max3_f32 v232, v144, v145, v146
v_max3_f32 v232, v232, v147, v243
v_mov_b32 v243, v232
s_nop 1
v_permlane32_swap_b32 v232, v243
s_nop 1
v_max_f32 v232, v232, v243
v_mov_b32 v243, v232
s_nop 1
v_permlane16_swap_b32 v232, v243
s_nop 1
v_max_f32 v232, v232, v243
v_ceil_f32 v232, v232
v_max_f32 v232, 0, v232
v_sub_f32 v243, 0, v232
v_exp_f32 v236, v243
s_nop 1
v_mul_f32 v228, v228, v236
v_add_f32 v244, v244, v232
v_sub_f32 v192, v192, v232
v_sub_f32 v128, v128, v232
v_sub_f32 v144, v144, v232
v_sub_f32 v193, v193, v232
v_sub_f32 v129, v129, v232
v_sub_f32 v145, v145, v232
v_sub_f32 v194, v194, v232
v_sub_f32 v130, v130, v232
v_sub_f32 v146, v146, v232
v_sub_f32 v195, v195, v232
v_sub_f32 v131, v131, v232
v_sub_f32 v147, v147, v232
v_lshlrev_b32 v242, 16, v4
v_and_b32 v243, 0xffff0000, v4
v_mul_f32 v242, v242, v236
v_mul_f32 v243, v243, v236
v_cvt_pk_bf16_f32 v4, v242, v243
v_lshlrev_b32 v242, 16, v5
v_and_b32 v243, 0xffff0000, v5
v_mul_f32 v242, v242, v236
v_mul_f32 v243, v243, v236
v_cvt_pk_bf16_f32 v5, v242, v243
v_lshlrev_b32 v242, 16, v6
v_and_b32 v243, 0xffff0000, v6
v_mul_f32 v242, v242, v236
v_mul_f32 v243, v243, v236
v_cvt_pk_bf16_f32 v6, v242, v243
v_lshlrev_b32 v242, 16, v7
v_and_b32 v243, 0xffff0000, v7
v_mul_f32 v242, v242, v236
v_mul_f32 v243, v243, v236
v_cvt_pk_bf16_f32 v7, v242, v243
v_lshlrev_b32 v242, 16, v8
v_and_b32 v243, 0xffff0000, v8
v_mul_f32 v242, v242, v236
v_mul_f32 v243, v243, v236
v_cvt_pk_bf16_f32 v8, v242, v243
v_lshlrev_b32 v242, 16, v9
v_and_b32 v243, 0xffff0000, v9
v_mul_f32 v242, v242, v236
v_mul_f32 v243, v243, v236
v_cvt_pk_bf16_f32 v9, v242, v243
v_lshlrev_b32 v242, 16, v10
v_and_b32 v243, 0xffff0000, v10
v_mul_f32 v242, v242, v236
v_mul_f32 v243, v243, v236
v_cvt_pk_bf16_f32 v10, v242, v243
v_lshlrev_b32 v242, 16, v11
v_and_b32 v243, 0xffff0000, v11
v_mul_f32 v242, v242, v236
v_mul_f32 v243, v243, v236
v_cvt_pk_bf16_f32 v11, v242, v243
v_lshlrev_b32 v242, 16, v176
v_and_b32 v243, 0xffff0000, v176
v_mul_f32 v242, v242, v236
v_mul_f32 v243, v243, v236
v_cvt_pk_bf16_f32 v176, v242, v243
v_lshlrev_b32 v242, 16, v177
v_and_b32 v243, 0xffff0000, v177
v_mul_f32 v242, v242, v236
v_mul_f32 v243, v243, v236
v_cvt_pk_bf16_f32 v177, v242, v243
v_lshlrev_b32 v242, 16, v178
v_and_b32 v243, 0xffff0000, v178
v_mul_f32 v242, v242, v236
v_mul_f32 v243, v243, v236
v_cvt_pk_bf16_f32 v178, v242, v243
v_lshlrev_b32 v242, 16, v179
v_and_b32 v243, 0xffff0000, v179
v_mul_f32 v242, v242, v236
v_mul_f32 v243, v243, v236
v_cvt_pk_bf16_f32 v179, v242, v243
v_lshlrev_b32 v242, 16, v160
v_and_b32 v243, 0xffff0000, v160
v_mul_f32 v242, v242, v236
v_mul_f32 v243, v243, v236
v_cvt_pk_bf16_f32 v160, v242, v243
v_lshlrev_b32 v242, 16, v161
v_and_b32 v243, 0xffff0000, v161
v_mul_f32 v242, v242, v236
v_mul_f32 v243, v243, v236
v_cvt_pk_bf16_f32 v161, v242, v243
v_lshlrev_b32 v242, 16, v162
v_and_b32 v243, 0xffff0000, v162
v_mul_f32 v242, v242, v236
v_mul_f32 v243, v243, v236
v_cvt_pk_bf16_f32 v162, v242, v243
v_lshlrev_b32 v242, 16, v163
v_and_b32 v243, 0xffff0000, v163
v_mul_f32 v242, v242, v236
v_mul_f32 v243, v243, v236
v_cvt_pk_bf16_f32 v163, v242, v243
v_lshlrev_b32 v242, 16, v0
v_and_b32 v243, 0xffff0000, v0
v_mul_f32 v242, v242, v236
v_mul_f32 v243, v243, v236
v_cvt_pk_bf16_f32 v0, v242, v243
v_lshlrev_b32 v242, 16, v1
v_and_b32 v243, 0xffff0000, v1
v_mul_f32 v242, v242, v236
v_mul_f32 v243, v243, v236
v_cvt_pk_bf16_f32 v1, v242, v243
v_log_f32 v243, v229
v_max3_f32 v233, v148, v149, v150
v_max3_f32 v233, v233, v151, v243
v_mov_b32 v243, v233
s_nop 1
v_permlane32_swap_b32 v233, v243
s_nop 1
v_max_f32 v233, v233, v243
v_mov_b32 v243, v233
s_nop 1
v_permlane16_swap_b32 v233, v243
s_nop 1
v_max_f32 v233, v233, v243
v_ceil_f32 v233, v233
v_max_f32 v233, 0, v233
v_sub_f32 v243, 0, v233
v_exp_f32 v237, v243
s_nop 1
v_mul_f32 v229, v229, v237
v_add_f32 v245, v245, v233
v_sub_f32 v196, v196, v233
v_sub_f32 v132, v132, v233
v_sub_f32 v148, v148, v233
v_sub_f32 v197, v197, v233
v_sub_f32 v133, v133, v233
v_sub_f32 v149, v149, v233
v_sub_f32 v198, v198, v233
v_sub_f32 v134, v134, v233
v_sub_f32 v150, v150, v233
v_sub_f32 v199, v199, v233
v_sub_f32 v135, v135, v233
v_sub_f32 v151, v151, v233
v_lshlrev_b32 v242, 16, v36
v_and_b32 v243, 0xffff0000, v36
v_mul_f32 v242, v242, v237
v_mul_f32 v243, v243, v237
v_cvt_pk_bf16_f32 v36, v242, v243
v_lshlrev_b32 v242, 16, v37
v_and_b32 v243, 0xffff0000, v37
v_mul_f32 v242, v242, v237
v_mul_f32 v243, v243, v237
v_cvt_pk_bf16_f32 v37, v242, v243
v_lshlrev_b32 v242, 16, v38
v_and_b32 v243, 0xffff0000, v38
v_mul_f32 v242, v242, v237
v_mul_f32 v243, v243, v237
v_cvt_pk_bf16_f32 v38, v242, v243
v_lshlrev_b32 v242, 16, v39
v_and_b32 v243, 0xffff0000, v39
v_mul_f32 v242, v242, v237
v_mul_f32 v243, v243, v237
v_cvt_pk_bf16_f32 v39, v242, v243
v_lshlrev_b32 v242, 16, v40
v_and_b32 v243, 0xffff0000, v40
v_mul_f32 v242, v242, v237
v_mul_f32 v243, v243, v237
v_cvt_pk_bf16_f32 v40, v242, v243
v_lshlrev_b32 v242, 16, v41
v_and_b32 v243, 0xffff0000, v41
v_mul_f32 v242, v242, v237
v_mul_f32 v243, v243, v237
v_cvt_pk_bf16_f32 v41, v242, v243
v_lshlrev_b32 v242, 16, v42
v_and_b32 v243, 0xffff0000, v42
v_mul_f32 v242, v242, v237
v_mul_f32 v243, v243, v237
v_cvt_pk_bf16_f32 v42, v242, v243
v_lshlrev_b32 v242, 16, v43
v_and_b32 v243, 0xffff0000, v43
v_mul_f32 v242, v242, v237
v_mul_f32 v243, v243, v237
v_cvt_pk_bf16_f32 v43, v242, v243
v_lshlrev_b32 v242, 16, v180
v_and_b32 v243, 0xffff0000, v180
v_mul_f32 v242, v242, v237
v_mul_f32 v243, v243, v237
v_cvt_pk_bf16_f32 v180, v242, v243
v_lshlrev_b32 v242, 16, v181
v_and_b32 v243, 0xffff0000, v181
v_mul_f32 v242, v242, v237
v_mul_f32 v243, v243, v237
v_cvt_pk_bf16_f32 v181, v242, v243
v_lshlrev_b32 v242, 16, v182
v_and_b32 v243, 0xffff0000, v182
v_mul_f32 v242, v242, v237
v_mul_f32 v243, v243, v237
v_cvt_pk_bf16_f32 v182, v242, v243
v_lshlrev_b32 v242, 16, v183
v_and_b32 v243, 0xffff0000, v183
v_mul_f32 v242, v242, v237
v_mul_f32 v243, v243, v237
v_cvt_pk_bf16_f32 v183, v242, v243
v_lshlrev_b32 v242, 16, v164
v_and_b32 v243, 0xffff0000, v164
v_mul_f32 v242, v242, v237
v_mul_f32 v243, v243, v237
v_cvt_pk_bf16_f32 v164, v242, v243
v_lshlrev_b32 v242, 16, v165
v_and_b32 v243, 0xffff0000, v165
v_mul_f32 v242, v242, v237
v_mul_f32 v243, v243, v237
v_cvt_pk_bf16_f32 v165, v242, v243
v_lshlrev_b32 v242, 16, v166
v_and_b32 v243, 0xffff0000, v166
v_mul_f32 v242, v242, v237
v_mul_f32 v243, v243, v237
v_cvt_pk_bf16_f32 v166, v242, v243
v_lshlrev_b32 v242, 16, v167
v_and_b32 v243, 0xffff0000, v167
v_mul_f32 v242, v242, v237
v_mul_f32 v243, v243, v237
v_cvt_pk_bf16_f32 v167, v242, v243
v_lshlrev_b32 v242, 16, v32
v_and_b32 v243, 0xffff0000, v32
v_mul_f32 v242, v242, v237
v_mul_f32 v243, v243, v237
v_cvt_pk_bf16_f32 v32, v242, v243
v_lshlrev_b32 v242, 16, v33
v_and_b32 v243, 0xffff0000, v33
v_mul_f32 v242, v242, v237
v_mul_f32 v243, v243, v237
v_cvt_pk_bf16_f32 v33, v242, v243
v_log_f32 v243, v230
v_max3_f32 v234, v152, v153, v154
v_max3_f32 v234, v234, v155, v243
v_mov_b32 v243, v234
s_nop 1
v_permlane32_swap_b32 v234, v243
s_nop 1
v_max_f32 v234, v234, v243
v_mov_b32 v243, v234
s_nop 1
v_permlane16_swap_b32 v234, v243
s_nop 1
v_max_f32 v234, v234, v243
v_ceil_f32 v234, v234
v_max_f32 v234, 0, v234
v_sub_f32 v243, 0, v234
v_exp_f32 v238, v243
s_nop 1
v_mul_f32 v230, v230, v238
v_add_f32 v246, v246, v234
v_sub_f32 v200, v200, v234
v_sub_f32 v136, v136, v234
v_sub_f32 v152, v152, v234
v_sub_f32 v201, v201, v234
v_sub_f32 v137, v137, v234
v_sub_f32 v153, v153, v234
v_sub_f32 v202, v202, v234
v_sub_f32 v138, v138, v234
v_sub_f32 v154, v154, v234
v_sub_f32 v203, v203, v234
v_sub_f32 v139, v139, v234
v_sub_f32 v155, v155, v234
v_lshlrev_b32 v242, 16, v68
v_and_b32 v243, 0xffff0000, v68
v_mul_f32 v242, v242, v238
v_mul_f32 v243, v243, v238
v_cvt_pk_bf16_f32 v68, v242, v243
v_lshlrev_b32 v242, 16, v69
v_and_b32 v243, 0xffff0000, v69
v_mul_f32 v242, v242, v238
v_mul_f32 v243, v243, v238
v_cvt_pk_bf16_f32 v69, v242, v243
v_lshlrev_b32 v242, 16, v70
v_and_b32 v243, 0xffff0000, v70
v_mul_f32 v242, v242, v238
v_mul_f32 v243, v243, v238
v_cvt_pk_bf16_f32 v70, v242, v243
v_lshlrev_b32 v242, 16, v71
v_and_b32 v243, 0xffff0000, v71
v_mul_f32 v242, v242, v238
v_mul_f32 v243, v243, v238
v_cvt_pk_bf16_f32 v71, v242, v243
v_lshlrev_b32 v242, 16, v72
v_and_b32 v243, 0xffff0000, v72
v_mul_f32 v242, v242, v238
v_mul_f32 v243, v243, v238
v_cvt_pk_bf16_f32 v72, v242, v243
v_lshlrev_b32 v242, 16, v73
v_and_b32 v243, 0xffff0000, v73
v_mul_f32 v242, v242, v238
v_mul_f32 v243, v243, v238
v_cvt_pk_bf16_f32 v73, v242, v243
v_lshlrev_b32 v242, 16, v74
v_and_b32 v243, 0xffff0000, v74
v_mul_f32 v242, v242, v238
v_mul_f32 v243, v243, v238
v_cvt_pk_bf16_f32 v74, v242, v243
v_lshlrev_b32 v242, 16, v75
v_and_b32 v243, 0xffff0000, v75
v_mul_f32 v242, v242, v238
v_mul_f32 v243, v243, v238
v_cvt_pk_bf16_f32 v75, v242, v243
v_lshlrev_b32 v242, 16, v184
v_and_b32 v243, 0xffff0000, v184
v_mul_f32 v242, v242, v238
v_mul_f32 v243, v243, v238
v_cvt_pk_bf16_f32 v184, v242, v243
v_lshlrev_b32 v242, 16, v185
v_and_b32 v243, 0xffff0000, v185
v_mul_f32 v242, v242, v238
v_mul_f32 v243, v243, v238
v_cvt_pk_bf16_f32 v185, v242, v243
v_lshlrev_b32 v242, 16, v186
v_and_b32 v243, 0xffff0000, v186
v_mul_f32 v242, v242, v238
v_mul_f32 v243, v243, v238
v_cvt_pk_bf16_f32 v186, v242, v243
v_lshlrev_b32 v242, 16, v187
v_and_b32 v243, 0xffff0000, v187
v_mul_f32 v242, v242, v238
v_mul_f32 v243, v243, v238
v_cvt_pk_bf16_f32 v187, v242, v243
v_lshlrev_b32 v242, 16, v168
v_and_b32 v243, 0xffff0000, v168
v_mul_f32 v242, v242, v238
v_mul_f32 v243, v243, v238
v_cvt_pk_bf16_f32 v168, v242, v243
v_lshlrev_b32 v242, 16, v169
v_and_b32 v243, 0xffff0000, v169
v_mul_f32 v242, v242, v238
v_mul_f32 v243, v243, v238
v_cvt_pk_bf16_f32 v169, v242, v243
v_lshlrev_b32 v242, 16, v170
v_and_b32 v243, 0xffff0000, v170
v_mul_f32 v242, v242, v238
v_mul_f32 v243, v243, v238
v_cvt_pk_bf16_f32 v170, v242, v243
v_lshlrev_b32 v242, 16, v171
v_and_b32 v243, 0xffff0000, v171
v_mul_f32 v242, v242, v238
v_mul_f32 v243, v243, v238
v_cvt_pk_bf16_f32 v171, v242, v243
v_lshlrev_b32 v242, 16, v64
v_and_b32 v243, 0xffff0000, v64
v_mul_f32 v242, v242, v238
v_mul_f32 v243, v243, v238
v_cvt_pk_bf16_f32 v64, v242, v243
v_lshlrev_b32 v242, 16, v65
v_and_b32 v243, 0xffff0000, v65
v_mul_f32 v242, v242, v238
v_mul_f32 v243, v243, v238
v_cvt_pk_bf16_f32 v65, v242, v243
v_log_f32 v243, v231
v_max3_f32 v235, v156, v157, v158
v_max3_f32 v235, v235, v159, v243
v_mov_b32 v243, v235
s_nop 1
v_permlane32_swap_b32 v235, v243
s_nop 1
v_max_f32 v235, v235, v243
v_mov_b32 v243, v235
s_nop 1
v_permlane16_swap_b32 v235, v243
s_nop 1
v_max_f32 v235, v235, v243
v_ceil_f32 v235, v235
v_max_f32 v235, 0, v235
v_sub_f32 v243, 0, v235
v_exp_f32 v239, v243
s_nop 1
v_mul_f32 v231, v231, v239
v_add_f32 v247, v247, v235
v_sub_f32 v204, v204, v235
v_sub_f32 v140, v140, v235
v_sub_f32 v156, v156, v235
v_sub_f32 v205, v205, v235
v_sub_f32 v141, v141, v235
v_sub_f32 v157, v157, v235
v_sub_f32 v206, v206, v235
v_sub_f32 v142, v142, v235
v_sub_f32 v158, v158, v235
v_sub_f32 v207, v207, v235
v_sub_f32 v143, v143, v235
v_sub_f32 v159, v159, v235
v_lshlrev_b32 v242, 16, v100
v_and_b32 v243, 0xffff0000, v100
v_mul_f32 v242, v242, v239
v_mul_f32 v243, v243, v239
v_cvt_pk_bf16_f32 v100, v242, v243
v_lshlrev_b32 v242, 16, v101
v_and_b32 v243, 0xffff0000, v101
v_mul_f32 v242, v242, v239
v_mul_f32 v243, v243, v239
v_cvt_pk_bf16_f32 v101, v242, v243
v_lshlrev_b32 v242, 16, v102
v_and_b32 v243, 0xffff0000, v102
v_mul_f32 v242, v242, v239
v_mul_f32 v243, v243, v239
v_cvt_pk_bf16_f32 v102, v242, v243
v_lshlrev_b32 v242, 16, v103
v_and_b32 v243, 0xffff0000, v103
v_mul_f32 v242, v242, v239
v_mul_f32 v243, v243, v239
v_cvt_pk_bf16_f32 v103, v242, v243
v_lshlrev_b32 v242, 16, v104
v_and_b32 v243, 0xffff0000, v104
v_mul_f32 v242, v242, v239
v_mul_f32 v243, v243, v239
v_cvt_pk_bf16_f32 v104, v242, v243
v_lshlrev_b32 v242, 16, v105
v_and_b32 v243, 0xffff0000, v105
v_mul_f32 v242, v242, v239
v_mul_f32 v243, v243, v239
v_cvt_pk_bf16_f32 v105, v242, v243
v_lshlrev_b32 v242, 16, v106
v_and_b32 v243, 0xffff0000, v106
v_mul_f32 v242, v242, v239
v_mul_f32 v243, v243, v239
v_cvt_pk_bf16_f32 v106, v242, v243
v_lshlrev_b32 v242, 16, v107
v_and_b32 v243, 0xffff0000, v107
v_mul_f32 v242, v242, v239
v_mul_f32 v243, v243, v239
v_cvt_pk_bf16_f32 v107, v242, v243
v_lshlrev_b32 v242, 16, v188
v_and_b32 v243, 0xffff0000, v188
v_mul_f32 v242, v242, v239
v_mul_f32 v243, v243, v239
v_cvt_pk_bf16_f32 v188, v242, v243
v_lshlrev_b32 v242, 16, v189
v_and_b32 v243, 0xffff0000, v189
v_mul_f32 v242, v242, v239
v_mul_f32 v243, v243, v239
v_cvt_pk_bf16_f32 v189, v242, v243
v_lshlrev_b32 v242, 16, v190
v_and_b32 v243, 0xffff0000, v190
v_mul_f32 v242, v242, v239
v_mul_f32 v243, v243, v239
v_cvt_pk_bf16_f32 v190, v242, v243
v_lshlrev_b32 v242, 16, v191
v_and_b32 v243, 0xffff0000, v191
v_mul_f32 v242, v242, v239
v_mul_f32 v243, v243, v239
v_cvt_pk_bf16_f32 v191, v242, v243
v_lshlrev_b32 v242, 16, v172
v_and_b32 v243, 0xffff0000, v172
v_mul_f32 v242, v242, v239
v_mul_f32 v243, v243, v239
v_cvt_pk_bf16_f32 v172, v242, v243
v_lshlrev_b32 v242, 16, v173
v_and_b32 v243, 0xffff0000, v173
v_mul_f32 v242, v242, v239
v_mul_f32 v243, v243, v239
v_cvt_pk_bf16_f32 v173, v242, v243
v_lshlrev_b32 v242, 16, v174
v_and_b32 v243, 0xffff0000, v174
v_mul_f32 v242, v242, v239
v_mul_f32 v243, v243, v239
v_cvt_pk_bf16_f32 v174, v242, v243
v_lshlrev_b32 v242, 16, v175
v_and_b32 v243, 0xffff0000, v175
v_mul_f32 v242, v242, v239
v_mul_f32 v243, v243, v239
v_cvt_pk_bf16_f32 v175, v242, v243
v_lshlrev_b32 v242, 16, v96
v_and_b32 v243, 0xffff0000, v96
v_mul_f32 v242, v242, v239
v_mul_f32 v243, v243, v239
v_cvt_pk_bf16_f32 v96, v242, v243
v_lshlrev_b32 v242, 16, v97
v_and_b32 v243, 0xffff0000, v97
v_mul_f32 v242, v242, v239
v_mul_f32 v243, v243, v239
v_cvt_pk_bf16_f32 v97, v242, v243
v_exp_f32 v232, v144
v_exp_f32 v233, v145
v_exp_f32 v234, v146
v_exp_f32 v235, v147
s_nop 1
v_add_f32 v224, v228, v232
v_add_f32 v224, v224, v233
v_add_f32 v224, v224, v234
v_add_f32 v224, v224, v235
v_cvt_pk_bf16_f32 v2, v232, v233
v_cvt_pk_bf16_f32 v3, v234, v235
v_exp_f32 v232, v148
v_exp_f32 v233, v149
v_exp_f32 v234, v150
v_exp_f32 v235, v151
s_nop 1
v_add_f32 v225, v229, v232
v_add_f32 v225, v225, v233
v_add_f32 v225, v225, v234
v_add_f32 v225, v225, v235
v_cvt_pk_bf16_f32 v34, v232, v233
v_cvt_pk_bf16_f32 v35, v234, v235
v_exp_f32 v232, v152
v_exp_f32 v233, v153
v_exp_f32 v234, v154
v_exp_f32 v235, v155
s_nop 1
v_add_f32 v226, v230, v232
v_add_f32 v226, v226, v233
v_add_f32 v226, v226, v234
v_add_f32 v226, v226, v235
v_cvt_pk_bf16_f32 v66, v232, v233
v_cvt_pk_bf16_f32 v67, v234, v235
v_exp_f32 v232, v156
v_exp_f32 v233, v157
v_exp_f32 v234, v158
v_exp_f32 v235, v159
s_nop 1
v_add_f32 v227, v231, v232
v_add_f32 v227, v227, v233
v_add_f32 v227, v227, v234
v_add_f32 v227, v227, v235
v_cvt_pk_bf16_f32 v98, v232, v233
v_cvt_pk_bf16_f32 v99, v234, v235
s_branch L2_rare_common
LF_hl_1:
s_mov_b32 s94, 0x10000
s_mov_b32 s3, 0x7c28000
LF_hl2_1:
v_lshlrev_b32 v241, 3, v248
buffer_load_dwordx2 v[240:241], v241, s[16:19], s3 offen sc1
s_sub_u32 s94, s94, 1
s_waitcnt vmcnt(0)
s_cbranch_scc1 LF_hlret_1
v_cmp_ne_u64_e64 s[38:39], s[98:99], v[240:241]
s_and_b64 s[38:39], s[38:39], s[96:97]
s_cbranch_scc1 LF_hl2_1
s_branch LF_hlret_1
L2_rare_common:
v_lshrrev_b32 v232, 4, v248
v_and_b32 v232, 0x30, v232
ds_bpermute_b32 v242, v232, v236 offset:0
ds_bpermute_b32 v243, v232, v236 offset:4
ds_bpermute_b32 v254, v232, v236 offset:8
ds_bpermute_b32 v255, v232, v236 offset:12
s_waitcnt lgkmcnt(0)
v_accvgpr_read_b32 v232, a0
v_accvgpr_read_b32 v233, a1
v_accvgpr_read_b32 v234, a2
v_accvgpr_read_b32 v235, a3
v_mul_f32 v232, v232, v242
v_mul_f32 v233, v233, v243
v_mul_f32 v234, v234, v254
v_mul_f32 v235, v235, v255
v_accvgpr_write_b32 a0, v232
v_accvgpr_write_b32 a1, v233
v_accvgpr_write_b32 a2, v234
v_accvgpr_write_b32 a3, v235
v_accvgpr_read_b32 v232, a16
v_accvgpr_read_b32 v233, a17
v_accvgpr_read_b32 v234, a18
v_accvgpr_read_b32 v235, a19
v_mul_f32 v232, v232, v242
v_mul_f32 v233, v233, v243
v_mul_f32 v234, v234, v254
v_mul_f32 v235, v235, v255
v_accvgpr_write_b32 a16, v232
v_accvgpr_write_b32 a17, v233
v_accvgpr_write_b32 a18, v234
v_accvgpr_write_b32 a19, v235
v_accvgpr_read_b32 v232, a32
v_accvgpr_read_b32 v233, a33
v_accvgpr_read_b32 v234, a34
v_accvgpr_read_b32 v235, a35
v_mul_f32 v232, v232, v242
v_mul_f32 v233, v233, v243
v_mul_f32 v234, v234, v254
v_mul_f32 v235, v235, v255
v_accvgpr_write_b32 a32, v232
v_accvgpr_write_b32 a33, v233
v_accvgpr_write_b32 a34, v234
v_accvgpr_write_b32 a35, v235
v_accvgpr_read_b32 v232, a48
v_accvgpr_read_b32 v233, a49
v_accvgpr_read_b32 v234, a50
v_accvgpr_read_b32 v235, a51
v_mul_f32 v232, v232, v242
v_mul_f32 v233, v233, v243
v_mul_f32 v234, v234, v254
v_mul_f32 v235, v235, v255
v_accvgpr_write_b32 a48, v232
v_accvgpr_write_b32 a49, v233
v_accvgpr_write_b32 a50, v234
v_accvgpr_write_b32 a51, v235
v_accvgpr_read_b32 v232, a64
v_accvgpr_read_b32 v233, a65
v_accvgpr_read_b32 v234, a66
v_accvgpr_read_b32 v235, a67
v_mul_f32 v232, v232, v242
v_mul_f32 v233, v233, v243
v_mul_f32 v234, v234, v254
v_mul_f32 v235, v235, v255
v_accvgpr_write_b32 a64, v232
v_accvgpr_write_b32 a65, v233
v_accvgpr_write_b32 a66, v234
v_accvgpr_write_b32 a67, v235
v_accvgpr_read_b32 v232, a80
v_accvgpr_read_b32 v233, a81
v_accvgpr_read_b32 v234, a82
v_accvgpr_read_b32 v235, a83
v_mul_f32 v232, v232, v242
v_mul_f32 v233, v233, v243
v_mul_f32 v234, v234, v254
v_mul_f32 v235, v235, v255
v_accvgpr_write_b32 a80, v232
v_accvgpr_write_b32 a81, v233
v_accvgpr_write_b32 a82, v234
v_accvgpr_write_b32 a83, v235
v_accvgpr_read_b32 v232, a96
v_accvgpr_read_b32 v233, a97
v_accvgpr_read_b32 v234, a98
v_accvgpr_read_b32 v235, a99
v_mul_f32 v232, v232, v242
v_mul_f32 v233, v233, v243
v_mul_f32 v234, v234, v254
v_mul_f32 v235, v235, v255
v_accvgpr_write_b32 a96, v232
v_accvgpr_write_b32 a97, v233
v_accvgpr_write_b32 a98, v234
v_accvgpr_write_b32 a99, v235
v_accvgpr_read_b32 v232, a112
v_accvgpr_read_b32 v233, a113
v_accvgpr_read_b32 v234, a114
v_accvgpr_read_b32 v235, a115
v_mul_f32 v232, v232, v242
v_mul_f32 v233, v233, v243
v_mul_f32 v234, v234, v254
v_mul_f32 v235, v235, v255
v_accvgpr_write_b32 a112, v232
v_accvgpr_write_b32 a113, v233
v_accvgpr_write_b32 a114, v234
v_accvgpr_write_b32 a115, v235
v_accvgpr_read_b32 v232, a128
v_accvgpr_read_b32 v233, a129
v_accvgpr_read_b32 v234, a130
v_accvgpr_read_b32 v235, a131
v_mul_f32 v232, v232, v242
v_mul_f32 v233, v233, v243
v_mul_f32 v234, v234, v254
v_mul_f32 v235, v235, v255
v_accvgpr_write_b32 a128, v232
v_accvgpr_write_b32 a129, v233
v_accvgpr_write_b32 a130, v234
v_accvgpr_write_b32 a131, v235
v_accvgpr_read_b32 v232, a144
v_accvgpr_read_b32 v233, a145
v_accvgpr_read_b32 v234, a146
v_accvgpr_read_b32 v235, a147
v_mul_f32 v232, v232, v242
v_mul_f32 v233, v233, v243
v_mul_f32 v234, v234, v254
v_mul_f32 v235, v235, v255
v_accvgpr_write_b32 a144, v232
v_accvgpr_write_b32 a145, v233
v_accvgpr_write_b32 a146, v234
v_accvgpr_write_b32 a147, v235
v_accvgpr_read_b32 v232, a160
v_accvgpr_read_b32 v233, a161
v_accvgpr_read_b32 v234, a162
v_accvgpr_read_b32 v235, a163
v_mul_f32 v232, v232, v242
v_mul_f32 v233, v233, v243
v_mul_f32 v234, v234, v254
v_mul_f32 v235, v235, v255
v_accvgpr_write_b32 a160, v232
v_accvgpr_write_b32 a161, v233
v_accvgpr_write_b32 a162, v234
v_accvgpr_write_b32 a163, v235
v_accvgpr_read_b32 v232, a176
v_accvgpr_read_b32 v233, a177
v_accvgpr_read_b32 v234, a178
v_accvgpr_read_b32 v235, a179
v_mul_f32 v232, v232, v242
v_mul_f32 v233, v233, v243
v_mul_f32 v234, v234, v254
v_mul_f32 v235, v235, v255
v_accvgpr_write_b32 a176, v232
v_accvgpr_write_b32 a177, v233
v_accvgpr_write_b32 a178, v234
v_accvgpr_write_b32 a179, v235
v_accvgpr_read_b32 v232, a192
v_accvgpr_read_b32 v233, a193
v_accvgpr_read_b32 v234, a194
v_accvgpr_read_b32 v235, a195
v_mul_f32 v232, v232, v242
v_mul_f32 v233, v233, v243
v_mul_f32 v234, v234, v254
v_mul_f32 v235, v235, v255
v_accvgpr_write_b32 a192, v232
v_accvgpr_write_b32 a193, v233
v_accvgpr_write_b32 a194, v234
v_accvgpr_write_b32 a195, v235
v_accvgpr_read_b32 v232, a208
v_accvgpr_read_b32 v233, a209
v_accvgpr_read_b32 v234, a210
v_accvgpr_read_b32 v235, a211
v_mul_f32 v232, v232, v242
v_mul_f32 v233, v233, v243
v_mul_f32 v234, v234, v254
v_mul_f32 v235, v235, v255
v_accvgpr_write_b32 a208, v232
v_accvgpr_write_b32 a209, v233
v_accvgpr_write_b32 a210, v234
v_accvgpr_write_b32 a211, v235
v_accvgpr_read_b32 v232, a224
v_accvgpr_read_b32 v233, a225
v_accvgpr_read_b32 v234, a226
v_accvgpr_read_b32 v235, a227
v_mul_f32 v232, v232, v242
v_mul_f32 v233, v233, v243
v_mul_f32 v234, v234, v254
v_mul_f32 v235, v235, v255
v_accvgpr_write_b32 a224, v232
v_accvgpr_write_b32 a225, v233
v_accvgpr_write_b32 a226, v234
v_accvgpr_write_b32 a227, v235
v_accvgpr_read_b32 v232, a240
v_accvgpr_read_b32 v233, a241
v_accvgpr_read_b32 v234, a242
v_accvgpr_read_b32 v235, a243
v_mul_f32 v232, v232, v242
v_mul_f32 v233, v233, v243
v_mul_f32 v234, v234, v254
v_mul_f32 v235, v235, v255
v_accvgpr_write_b32 a240, v232
v_accvgpr_write_b32 a241, v233
v_accvgpr_write_b32 a242, v234
v_accvgpr_write_b32 a243, v235
v_lshrrev_b32 v232, 4, v248
v_and_b32 v232, 0x30, v232
ds_bpermute_b32 v242, v232, v237 offset:0
ds_bpermute_b32 v243, v232, v237 offset:4
ds_bpermute_b32 v254, v232, v237 offset:8
ds_bpermute_b32 v255, v232, v237 offset:12
s_waitcnt lgkmcnt(0)
v_accvgpr_read_b32 v232, a4
v_accvgpr_read_b32 v233, a5
v_accvgpr_read_b32 v234, a6
v_accvgpr_read_b32 v235, a7
v_mul_f32 v232, v232, v242
v_mul_f32 v233, v233, v243
v_mul_f32 v234, v234, v254
v_mul_f32 v235, v235, v255
v_accvgpr_write_b32 a4, v232
v_accvgpr_write_b32 a5, v233
v_accvgpr_write_b32 a6, v234
v_accvgpr_write_b32 a7, v235
v_accvgpr_read_b32 v232, a20
v_accvgpr_read_b32 v233, a21
v_accvgpr_read_b32 v234, a22
v_accvgpr_read_b32 v235, a23
v_mul_f32 v232, v232, v242
v_mul_f32 v233, v233, v243
v_mul_f32 v234, v234, v254
v_mul_f32 v235, v235, v255
v_accvgpr_write_b32 a20, v232
v_accvgpr_write_b32 a21, v233
v_accvgpr_write_b32 a22, v234
v_accvgpr_write_b32 a23, v235
v_accvgpr_read_b32 v232, a36
v_accvgpr_read_b32 v233, a37
v_accvgpr_read_b32 v234, a38
v_accvgpr_read_b32 v235, a39
v_mul_f32 v232, v232, v242
v_mul_f32 v233, v233, v243
v_mul_f32 v234, v234, v254
v_mul_f32 v235, v235, v255
v_accvgpr_write_b32 a36, v232
v_accvgpr_write_b32 a37, v233
v_accvgpr_write_b32 a38, v234
v_accvgpr_write_b32 a39, v235
v_accvgpr_read_b32 v232, a52
v_accvgpr_read_b32 v233, a53
v_accvgpr_read_b32 v234, a54
v_accvgpr_read_b32 v235, a55
v_mul_f32 v232, v232, v242
v_mul_f32 v233, v233, v243
v_mul_f32 v234, v234, v254
v_mul_f32 v235, v235, v255
v_accvgpr_write_b32 a52, v232
v_accvgpr_write_b32 a53, v233
v_accvgpr_write_b32 a54, v234
v_accvgpr_write_b32 a55, v235
v_accvgpr_read_b32 v232, a68
v_accvgpr_read_b32 v233, a69
v_accvgpr_read_b32 v234, a70
v_accvgpr_read_b32 v235, a71
v_mul_f32 v232, v232, v242
v_mul_f32 v233, v233, v243
v_mul_f32 v234, v234, v254
v_mul_f32 v235, v235, v255
v_accvgpr_write_b32 a68, v232
v_accvgpr_write_b32 a69, v233
v_accvgpr_write_b32 a70, v234
v_accvgpr_write_b32 a71, v235
v_accvgpr_read_b32 v232, a84
v_accvgpr_read_b32 v233, a85
v_accvgpr_read_b32 v234, a86
v_accvgpr_read_b32 v235, a87
v_mul_f32 v232, v232, v242
v_mul_f32 v233, v233, v243
v_mul_f32 v234, v234, v254
v_mul_f32 v235, v235, v255
v_accvgpr_write_b32 a84, v232
v_accvgpr_write_b32 a85, v233
v_accvgpr_write_b32 a86, v234
v_accvgpr_write_b32 a87, v235
v_accvgpr_read_b32 v232, a100
v_accvgpr_read_b32 v233, a101
v_accvgpr_read_b32 v234, a102
v_accvgpr_read_b32 v235, a103
v_mul_f32 v232, v232, v242
v_mul_f32 v233, v233, v243
v_mul_f32 v234, v234, v254
v_mul_f32 v235, v235, v255
v_accvgpr_write_b32 a100, v232
v_accvgpr_write_b32 a101, v233
v_accvgpr_write_b32 a102, v234
v_accvgpr_write_b32 a103, v235
v_accvgpr_read_b32 v232, a116
v_accvgpr_read_b32 v233, a117
v_accvgpr_read_b32 v234, a118
v_accvgpr_read_b32 v235, a119
v_mul_f32 v232, v232, v242
v_mul_f32 v233, v233, v243
v_mul_f32 v234, v234, v254
v_mul_f32 v235, v235, v255
v_accvgpr_write_b32 a116, v232
v_accvgpr_write_b32 a117, v233
v_accvgpr_write_b32 a118, v234
v_accvgpr_write_b32 a119, v235
v_accvgpr_read_b32 v232, a132
v_accvgpr_read_b32 v233, a133
v_accvgpr_read_b32 v234, a134
v_accvgpr_read_b32 v235, a135
v_mul_f32 v232, v232, v242
v_mul_f32 v233, v233, v243
v_mul_f32 v234, v234, v254
v_mul_f32 v235, v235, v255
v_accvgpr_write_b32 a132, v232
v_accvgpr_write_b32 a133, v233
v_accvgpr_write_b32 a134, v234
v_accvgpr_write_b32 a135, v235
v_accvgpr_read_b32 v232, a148
v_accvgpr_read_b32 v233, a149
v_accvgpr_read_b32 v234, a150
v_accvgpr_read_b32 v235, a151
v_mul_f32 v232, v232, v242
v_mul_f32 v233, v233, v243
v_mul_f32 v234, v234, v254
v_mul_f32 v235, v235, v255
v_accvgpr_write_b32 a148, v232
v_accvgpr_write_b32 a149, v233
v_accvgpr_write_b32 a150, v234
v_accvgpr_write_b32 a151, v235
v_accvgpr_read_b32 v232, a164
v_accvgpr_read_b32 v233, a165
v_accvgpr_read_b32 v234, a166
v_accvgpr_read_b32 v235, a167
v_mul_f32 v232, v232, v242
v_mul_f32 v233, v233, v243
v_mul_f32 v234, v234, v254
v_mul_f32 v235, v235, v255
v_accvgpr_write_b32 a164, v232
v_accvgpr_write_b32 a165, v233
v_accvgpr_write_b32 a166, v234
v_accvgpr_write_b32 a167, v235
v_accvgpr_read_b32 v232, a180
v_accvgpr_read_b32 v233, a181
v_accvgpr_read_b32 v234, a182
v_accvgpr_read_b32 v235, a183
v_mul_f32 v232, v232, v242
v_mul_f32 v233, v233, v243
v_mul_f32 v234, v234, v254
v_mul_f32 v235, v235, v255
v_accvgpr_write_b32 a180, v232
v_accvgpr_write_b32 a181, v233
v_accvgpr_write_b32 a182, v234
v_accvgpr_write_b32 a183, v235
v_accvgpr_read_b32 v232, a196
v_accvgpr_read_b32 v233, a197
v_accvgpr_read_b32 v234, a198
v_accvgpr_read_b32 v235, a199
v_mul_f32 v232, v232, v242
v_mul_f32 v233, v233, v243
v_mul_f32 v234, v234, v254
v_mul_f32 v235, v235, v255
v_accvgpr_write_b32 a196, v232
v_accvgpr_write_b32 a197, v233
v_accvgpr_write_b32 a198, v234
v_accvgpr_write_b32 a199, v235
v_accvgpr_read_b32 v232, a212
v_accvgpr_read_b32 v233, a213
v_accvgpr_read_b32 v234, a214
v_accvgpr_read_b32 v235, a215
v_mul_f32 v232, v232, v242
v_mul_f32 v233, v233, v243
v_mul_f32 v234, v234, v254
v_mul_f32 v235, v235, v255
v_accvgpr_write_b32 a212, v232
v_accvgpr_write_b32 a213, v233
v_accvgpr_write_b32 a214, v234
v_accvgpr_write_b32 a215, v235
v_accvgpr_read_b32 v232, a228
v_accvgpr_read_b32 v233, a229
v_accvgpr_read_b32 v234, a230
v_accvgpr_read_b32 v235, a231
v_mul_f32 v232, v232, v242
v_mul_f32 v233, v233, v243
v_mul_f32 v234, v234, v254
v_mul_f32 v235, v235, v255
v_accvgpr_write_b32 a228, v232
v_accvgpr_write_b32 a229, v233
v_accvgpr_write_b32 a230, v234
v_accvgpr_write_b32 a231, v235
v_accvgpr_read_b32 v232, a244
v_accvgpr_read_b32 v233, a245
v_accvgpr_read_b32 v234, a246
v_accvgpr_read_b32 v235, a247
v_mul_f32 v232, v232, v242
v_mul_f32 v233, v233, v243
v_mul_f32 v234, v234, v254
v_mul_f32 v235, v235, v255
v_accvgpr_write_b32 a244, v232
v_accvgpr_write_b32 a245, v233
v_accvgpr_write_b32 a246, v234
v_accvgpr_write_b32 a247, v235
v_lshrrev_b32 v232, 4, v248
v_and_b32 v232, 0x30, v232
ds_bpermute_b32 v242, v232, v238 offset:0
ds_bpermute_b32 v243, v232, v238 offset:4
ds_bpermute_b32 v254, v232, v238 offset:8
ds_bpermute_b32 v255, v232, v238 offset:12
s_waitcnt lgkmcnt(0)
v_accvgpr_read_b32 v232, a8
v_accvgpr_read_b32 v233, a9
v_accvgpr_read_b32 v234, a10
v_accvgpr_read_b32 v235, a11
v_mul_f32 v232, v232, v242
v_mul_f32 v233, v233, v243
v_mul_f32 v234, v234, v254
v_mul_f32 v235, v235, v255
v_accvgpr_write_b32 a8, v232
v_accvgpr_write_b32 a9, v233
v_accvgpr_write_b32 a10, v234
v_accvgpr_write_b32 a11, v235
v_accvgpr_read_b32 v232, a24
v_accvgpr_read_b32 v233, a25
v_accvgpr_read_b32 v234, a26
v_accvgpr_read_b32 v235, a27
v_mul_f32 v232, v232, v242
v_mul_f32 v233, v233, v243
v_mul_f32 v234, v234, v254
v_mul_f32 v235, v235, v255
v_accvgpr_write_b32 a24, v232
v_accvgpr_write_b32 a25, v233
v_accvgpr_write_b32 a26, v234
v_accvgpr_write_b32 a27, v235
v_accvgpr_read_b32 v232, a40
v_accvgpr_read_b32 v233, a41
v_accvgpr_read_b32 v234, a42
v_accvgpr_read_b32 v235, a43
v_mul_f32 v232, v232, v242
v_mul_f32 v233, v233, v243
v_mul_f32 v234, v234, v254
v_mul_f32 v235, v235, v255
v_accvgpr_write_b32 a40, v232
v_accvgpr_write_b32 a41, v233
v_accvgpr_write_b32 a42, v234
v_accvgpr_write_b32 a43, v235
v_accvgpr_read_b32 v232, a56
v_accvgpr_read_b32 v233, a57
v_accvgpr_read_b32 v234, a58
v_accvgpr_read_b32 v235, a59
v_mul_f32 v232, v232, v242
v_mul_f32 v233, v233, v243
v_mul_f32 v234, v234, v254
v_mul_f32 v235, v235, v255
v_accvgpr_write_b32 a56, v232
v_accvgpr_write_b32 a57, v233
v_accvgpr_write_b32 a58, v234
v_accvgpr_write_b32 a59, v235
v_accvgpr_read_b32 v232, a72
v_accvgpr_read_b32 v233, a73
v_accvgpr_read_b32 v234, a74
v_accvgpr_read_b32 v235, a75
v_mul_f32 v232, v232, v242
v_mul_f32 v233, v233, v243
v_mul_f32 v234, v234, v254
v_mul_f32 v235, v235, v255
v_accvgpr_write_b32 a72, v232
v_accvgpr_write_b32 a73, v233
v_accvgpr_write_b32 a74, v234
v_accvgpr_write_b32 a75, v235
v_accvgpr_read_b32 v232, a88
v_accvgpr_read_b32 v233, a89
v_accvgpr_read_b32 v234, a90
v_accvgpr_read_b32 v235, a91
v_mul_f32 v232, v232, v242
v_mul_f32 v233, v233, v243
v_mul_f32 v234, v234, v254
v_mul_f32 v235, v235, v255
v_accvgpr_write_b32 a88, v232
v_accvgpr_write_b32 a89, v233
v_accvgpr_write_b32 a90, v234
v_accvgpr_write_b32 a91, v235
v_accvgpr_read_b32 v232, a104
v_accvgpr_read_b32 v233, a105
v_accvgpr_read_b32 v234, a106
v_accvgpr_read_b32 v235, a107
v_mul_f32 v232, v232, v242
v_mul_f32 v233, v233, v243
v_mul_f32 v234, v234, v254
v_mul_f32 v235, v235, v255
v_accvgpr_write_b32 a104, v232
v_accvgpr_write_b32 a105, v233
v_accvgpr_write_b32 a106, v234
v_accvgpr_write_b32 a107, v235
v_accvgpr_read_b32 v232, a120
v_accvgpr_read_b32 v233, a121
v_accvgpr_read_b32 v234, a122
v_accvgpr_read_b32 v235, a123
v_mul_f32 v232, v232, v242
v_mul_f32 v233, v233, v243
v_mul_f32 v234, v234, v254
v_mul_f32 v235, v235, v255
v_accvgpr_write_b32 a120, v232
v_accvgpr_write_b32 a121, v233
v_accvgpr_write_b32 a122, v234
v_accvgpr_write_b32 a123, v235
v_accvgpr_read_b32 v232, a136
v_accvgpr_read_b32 v233, a137
v_accvgpr_read_b32 v234, a138
v_accvgpr_read_b32 v235, a139
v_mul_f32 v232, v232, v242
v_mul_f32 v233, v233, v243
v_mul_f32 v234, v234, v254
v_mul_f32 v235, v235, v255
v_accvgpr_write_b32 a136, v232
v_accvgpr_write_b32 a137, v233
v_accvgpr_write_b32 a138, v234
v_accvgpr_write_b32 a139, v235
v_accvgpr_read_b32 v232, a152
v_accvgpr_read_b32 v233, a153
v_accvgpr_read_b32 v234, a154
v_accvgpr_read_b32 v235, a155
v_mul_f32 v232, v232, v242
v_mul_f32 v233, v233, v243
v_mul_f32 v234, v234, v254
v_mul_f32 v235, v235, v255
v_accvgpr_write_b32 a152, v232
v_accvgpr_write_b32 a153, v233
v_accvgpr_write_b32 a154, v234
v_accvgpr_write_b32 a155, v235
v_accvgpr_read_b32 v232, a168
v_accvgpr_read_b32 v233, a169
v_accvgpr_read_b32 v234, a170
v_accvgpr_read_b32 v235, a171
v_mul_f32 v232, v232, v242
v_mul_f32 v233, v233, v243
v_mul_f32 v234, v234, v254
v_mul_f32 v235, v235, v255
v_accvgpr_write_b32 a168, v232
v_accvgpr_write_b32 a169, v233
v_accvgpr_write_b32 a170, v234
v_accvgpr_write_b32 a171, v235
v_accvgpr_read_b32 v232, a184
v_accvgpr_read_b32 v233, a185
v_accvgpr_read_b32 v234, a186
v_accvgpr_read_b32 v235, a187
v_mul_f32 v232, v232, v242
v_mul_f32 v233, v233, v243
v_mul_f32 v234, v234, v254
v_mul_f32 v235, v235, v255
v_accvgpr_write_b32 a184, v232
v_accvgpr_write_b32 a185, v233
v_accvgpr_write_b32 a186, v234
v_accvgpr_write_b32 a187, v235
v_accvgpr_read_b32 v232, a200
v_accvgpr_read_b32 v233, a201
v_accvgpr_read_b32 v234, a202
v_accvgpr_read_b32 v235, a203
v_mul_f32 v232, v232, v242
v_mul_f32 v233, v233, v243
v_mul_f32 v234, v234, v254
v_mul_f32 v235, v235, v255
v_accvgpr_write_b32 a200, v232
v_accvgpr_write_b32 a201, v233
v_accvgpr_write_b32 a202, v234
v_accvgpr_write_b32 a203, v235
v_accvgpr_read_b32 v232, a216
v_accvgpr_read_b32 v233, a217
v_accvgpr_read_b32 v234, a218
v_accvgpr_read_b32 v235, a219
v_mul_f32 v232, v232, v242
v_mul_f32 v233, v233, v243
v_mul_f32 v234, v234, v254
v_mul_f32 v235, v235, v255
v_accvgpr_write_b32 a216, v232
v_accvgpr_write_b32 a217, v233
v_accvgpr_write_b32 a218, v234
v_accvgpr_write_b32 a219, v235
v_accvgpr_read_b32 v232, a232
v_accvgpr_read_b32 v233, a233
v_accvgpr_read_b32 v234, a234
v_accvgpr_read_b32 v235, a235
v_mul_f32 v232, v232, v242
v_mul_f32 v233, v233, v243
v_mul_f32 v234, v234, v254
v_mul_f32 v235, v235, v255
v_accvgpr_write_b32 a232, v232
v_accvgpr_write_b32 a233, v233
v_accvgpr_write_b32 a234, v234
v_accvgpr_write_b32 a235, v235
v_accvgpr_read_b32 v232, a248
v_accvgpr_read_b32 v233, a249
v_accvgpr_read_b32 v234, a250
v_accvgpr_read_b32 v235, a251
v_mul_f32 v232, v232, v242
v_mul_f32 v233, v233, v243
v_mul_f32 v234, v234, v254
v_mul_f32 v235, v235, v255
v_accvgpr_write_b32 a248, v232
v_accvgpr_write_b32 a249, v233
v_accvgpr_write_b32 a250, v234
v_accvgpr_write_b32 a251, v235
v_lshrrev_b32 v232, 4, v248
v_and_b32 v232, 0x30, v232
ds_bpermute_b32 v242, v232, v239 offset:0
ds_bpermute_b32 v243, v232, v239 offset:4
ds_bpermute_b32 v254, v232, v239 offset:8
ds_bpermute_b32 v255, v232, v239 offset:12
s_waitcnt lgkmcnt(0)
v_accvgpr_read_b32 v232, a12
v_accvgpr_read_b32 v233, a13
v_accvgpr_read_b32 v234, a14
v_accvgpr_read_b32 v235, a15
v_mul_f32 v232, v232, v242
v_mul_f32 v233, v233, v243
v_mul_f32 v234, v234, v254
v_mul_f32 v235, v235, v255
v_accvgpr_write_b32 a12, v232
v_accvgpr_write_b32 a13, v233
v_accvgpr_write_b32 a14, v234
v_accvgpr_write_b32 a15, v235
v_accvgpr_read_b32 v232, a28
v_accvgpr_read_b32 v233, a29
v_accvgpr_read_b32 v234, a30
v_accvgpr_read_b32 v235, a31
v_mul_f32 v232, v232, v242
v_mul_f32 v233, v233, v243
v_mul_f32 v234, v234, v254
v_mul_f32 v235, v235, v255
v_accvgpr_write_b32 a28, v232
v_accvgpr_write_b32 a29, v233
v_accvgpr_write_b32 a30, v234
v_accvgpr_write_b32 a31, v235
v_accvgpr_read_b32 v232, a44
v_accvgpr_read_b32 v233, a45
v_accvgpr_read_b32 v234, a46
v_accvgpr_read_b32 v235, a47
v_mul_f32 v232, v232, v242
v_mul_f32 v233, v233, v243
v_mul_f32 v234, v234, v254
v_mul_f32 v235, v235, v255
v_accvgpr_write_b32 a44, v232
v_accvgpr_write_b32 a45, v233
v_accvgpr_write_b32 a46, v234
v_accvgpr_write_b32 a47, v235
v_accvgpr_read_b32 v232, a60
v_accvgpr_read_b32 v233, a61
v_accvgpr_read_b32 v234, a62
v_accvgpr_read_b32 v235, a63
v_mul_f32 v232, v232, v242
v_mul_f32 v233, v233, v243
v_mul_f32 v234, v234, v254
v_mul_f32 v235, v235, v255
v_accvgpr_write_b32 a60, v232
v_accvgpr_write_b32 a61, v233
v_accvgpr_write_b32 a62, v234
v_accvgpr_write_b32 a63, v235
v_accvgpr_read_b32 v232, a76
v_accvgpr_read_b32 v233, a77
v_accvgpr_read_b32 v234, a78
v_accvgpr_read_b32 v235, a79
v_mul_f32 v232, v232, v242
v_mul_f32 v233, v233, v243
v_mul_f32 v234, v234, v254
v_mul_f32 v235, v235, v255
v_accvgpr_write_b32 a76, v232
v_accvgpr_write_b32 a77, v233
v_accvgpr_write_b32 a78, v234
v_accvgpr_write_b32 a79, v235
v_accvgpr_read_b32 v232, a92
v_accvgpr_read_b32 v233, a93
v_accvgpr_read_b32 v234, a94
v_accvgpr_read_b32 v235, a95
v_mul_f32 v232, v232, v242
v_mul_f32 v233, v233, v243
v_mul_f32 v234, v234, v254
v_mul_f32 v235, v235, v255
v_accvgpr_write_b32 a92, v232
v_accvgpr_write_b32 a93, v233
v_accvgpr_write_b32 a94, v234
v_accvgpr_write_b32 a95, v235
v_accvgpr_read_b32 v232, a108
v_accvgpr_read_b32 v233, a109
v_accvgpr_read_b32 v234, a110
v_accvgpr_read_b32 v235, a111
v_mul_f32 v232, v232, v242
v_mul_f32 v233, v233, v243
v_mul_f32 v234, v234, v254
v_mul_f32 v235, v235, v255
v_accvgpr_write_b32 a108, v232
v_accvgpr_write_b32 a109, v233
v_accvgpr_write_b32 a110, v234
v_accvgpr_write_b32 a111, v235
v_accvgpr_read_b32 v232, a124
v_accvgpr_read_b32 v233, a125
v_accvgpr_read_b32 v234, a126
v_accvgpr_read_b32 v235, a127
v_mul_f32 v232, v232, v242
v_mul_f32 v233, v233, v243
v_mul_f32 v234, v234, v254
v_mul_f32 v235, v235, v255
v_accvgpr_write_b32 a124, v232
v_accvgpr_write_b32 a125, v233
v_accvgpr_write_b32 a126, v234
v_accvgpr_write_b32 a127, v235
v_accvgpr_read_b32 v232, a140
v_accvgpr_read_b32 v233, a141
v_accvgpr_read_b32 v234, a142
v_accvgpr_read_b32 v235, a143
v_mul_f32 v232, v232, v242
v_mul_f32 v233, v233, v243
v_mul_f32 v234, v234, v254
v_mul_f32 v235, v235, v255
v_accvgpr_write_b32 a140, v232
v_accvgpr_write_b32 a141, v233
v_accvgpr_write_b32 a142, v234
v_accvgpr_write_b32 a143, v235
v_accvgpr_read_b32 v232, a156
v_accvgpr_read_b32 v233, a157
v_accvgpr_read_b32 v234, a158
v_accvgpr_read_b32 v235, a159
v_mul_f32 v232, v232, v242
v_mul_f32 v233, v233, v243
v_mul_f32 v234, v234, v254
v_mul_f32 v235, v235, v255
v_accvgpr_write_b32 a156, v232
v_accvgpr_write_b32 a157, v233
v_accvgpr_write_b32 a158, v234
v_accvgpr_write_b32 a159, v235
v_accvgpr_read_b32 v232, a172
v_accvgpr_read_b32 v233, a173
v_accvgpr_read_b32 v234, a174
v_accvgpr_read_b32 v235, a175
v_mul_f32 v232, v232, v242
v_mul_f32 v233, v233, v243
v_mul_f32 v234, v234, v254
v_mul_f32 v235, v235, v255
v_accvgpr_write_b32 a172, v232
v_accvgpr_write_b32 a173, v233
v_accvgpr_write_b32 a174, v234
v_accvgpr_write_b32 a175, v235
v_accvgpr_read_b32 v232, a188
v_accvgpr_read_b32 v233, a189
v_accvgpr_read_b32 v234, a190
v_accvgpr_read_b32 v235, a191
v_mul_f32 v232, v232, v242
v_mul_f32 v233, v233, v243
v_mul_f32 v234, v234, v254
v_mul_f32 v235, v235, v255
v_accvgpr_write_b32 a188, v232
v_accvgpr_write_b32 a189, v233
v_accvgpr_write_b32 a190, v234
v_accvgpr_write_b32 a191, v235
v_accvgpr_read_b32 v232, a204
v_accvgpr_read_b32 v233, a205
v_accvgpr_read_b32 v234, a206
v_accvgpr_read_b32 v235, a207
v_mul_f32 v232, v232, v242
v_mul_f32 v233, v233, v243
v_mul_f32 v234, v234, v254
v_mul_f32 v235, v235, v255
v_accvgpr_write_b32 a204, v232
v_accvgpr_write_b32 a205, v233
v_accvgpr_write_b32 a206, v234
v_accvgpr_write_b32 a207, v235
v_accvgpr_read_b32 v232, a220
v_accvgpr_read_b32 v233, a221
v_accvgpr_read_b32 v234, a222
v_accvgpr_read_b32 v235, a223
v_mul_f32 v232, v232, v242
v_mul_f32 v233, v233, v243
v_mul_f32 v234, v234, v254
v_mul_f32 v235, v235, v255
v_accvgpr_write_b32 a220, v232
v_accvgpr_write_b32 a221, v233
v_accvgpr_write_b32 a222, v234
v_accvgpr_write_b32 a223, v235
v_accvgpr_read_b32 v232, a236
v_accvgpr_read_b32 v233, a237
v_accvgpr_read_b32 v234, a238
v_accvgpr_read_b32 v235, a239
v_mul_f32 v232, v232, v242
v_mul_f32 v233, v233, v243
v_mul_f32 v234, v234, v254
v_mul_f32 v235, v235, v255
v_accvgpr_write_b32 a236, v232
v_accvgpr_write_b32 a237, v233
v_accvgpr_write_b32 a238, v234
v_accvgpr_write_b32 a239, v235
v_accvgpr_read_b32 v232, a252
v_accvgpr_read_b32 v233, a253
v_accvgpr_read_b32 v234, a254
v_accvgpr_read_b32 v235, a255
v_mul_f32 v232, v232, v242
v_mul_f32 v233, v233, v243
v_mul_f32 v234, v234, v254
v_mul_f32 v235, v235, v255
v_accvgpr_write_b32 a252, v232
v_accvgpr_write_b32 a253, v233
v_accvgpr_write_b32 a254, v234
v_accvgpr_write_b32 a255, v235
s_nop 3
s_cmp_eq_u32 s36, 0
s_cbranch_scc1 L2_ret0
s_cmp_eq_u32 s36, 1
s_cbranch_scc1 L2_ret1
s_cmp_eq_u32 s36, 2
s_cbranch_scc1 L2_ret2
s_cmp_eq_u32 s36, 3
s_cbranch_scc1 L2_ret3
s_cmp_eq_u32 s36, 4
s_cbranch_scc1 L2_ret4
s_cmp_eq_u32 s36, 5
s_cbranch_scc1 L2_ret5
s_cmp_eq_u32 s36, 6
s_cbranch_scc1 L2_ret6
s_cmp_eq_u32 s36, 7
s_cbranch_scc1 L2_ret7
s_cmp_eq_u32 s36, 8
s_cbranch_scc1 L2_ret8
s_cmp_eq_u32 s36, 9
s_cbranch_scc1 L2_ret9
s_cmp_eq_u32 s36, 10
s_cbranch_scc1 L2_ret10
s_cmp_eq_u32 s36, 11
s_cbranch_scc1 L2_ret11
s_cmp_eq_u32 s36, 12
s_cbranch_scc1 L2_ret12
s_cmp_eq_u32 s36, 13
s_cbranch_scc1 L2_ret13
s_cmp_eq_u32 s36, 14
s_cbranch_scc1 L2_ret14
s_cmp_eq_u32 s36, 15
s_cbranch_scc1 L2_ret15
s_cmp_eq_u32 s36, 16
s_cbranch_scc1 L2_ret16
s_cmp_eq_u32 s36, 17
s_cbranch_scc1 L2_ret17
s_cmp_eq_u32 s36, 18
s_cbranch_scc1 L2_ret18
s_branch L2_ret19
LT_disp:
s_cmp_eq_u32 s34, 0
s_cbranch_scc1 LT_start
s_mov_b32 s41, s34
s_mul_i32 s40, s34, 6
s_add_u32 s40, s40, s37
s_add_u32 s40, s40, 42
s_cmp_lt_u32 s40, 64
s_cbranch_scc1 LE_common
s_branch L2_end
LT_start:
s_waitcnt lgkmcnt(0)
s_add_u32 s12, s4, 0x7c2a000
s_addc_u32 s13, s5, 0
s_mov_b32 s14, 0x8000
s_mov_b32 s15, 0x00020000
v_and_b32 v8, 63, v0
v_lshlrev_b32 v8, 7, v8
s_mov_b32 s91, 8192
s_mov_b32 s90, 16384
s_mov_b32 s95, 24576
s_mov_b32 s94, 0x10000
LT_poll:
buffer_load_dwordx2 v[0:1], v8, s[12:15], 0 offen sc1
buffer_load_dwordx2 v[2:3], v8, s[12:15], s91 offen sc1
buffer_load_dwordx2 v[4:5], v8, s[12:15], s90 offen sc1
buffer_load_dwordx2 v[6:7], v8, s[12:15], s95 offen sc1
s_sub_u32 s94, s94, 1
s_waitcnt vmcnt(0)
s_cbranch_scc1 LT_poll_go
v_cmp_ne_u64 vcc, s[98:99], v[0:1]
s_nop 1
s_cbranch_vccnz LT_poll
v_cmp_ne_u64 vcc, s[98:99], v[2:3]
s_nop 1
s_cbranch_vccnz LT_poll
v_cmp_ne_u64 vcc, s[98:99], v[4:5]
s_nop 1
s_cbranch_vccnz LT_poll
v_cmp_ne_u64 vcc, s[98:99], v[6:7]
s_nop 1
s_cbranch_vccnz LT_poll
LT_poll_go:
s_add_u32 s12, s4, 0x6800000
s_addc_u32 s13, s5, 0
s_mov_b32 s14, 0x0
s_mov_b32 s15, 0x00020000
s_mov_b32 s14, s49
s_add_u32 s8, s4, 0x0
s_addc_u32 s9, s5, 0
s_mov_b32 s10, 0x4e4000
s_mov_b32 s11, 0x00020000
s_mov_b32 s40, 5111808
s_mov_b32 s44, 5115904
buffer_load_dwordx4 v[0:3], v248, s[8:11], s40 offen offset:0 sc1
buffer_load_dwordx4 v[4:7], v248, s[8:11], s40 offen offset:1024 sc1
buffer_load_dwordx4 v[8:11], v248, s[8:11], s40 offen offset:2048 sc1
buffer_load_dwordx4 v[12:15], v248, s[8:11], s40 offen offset:3072 sc1
buffer_load_dwordx4 v[16:19], v248, s[8:11], s44 offen offset:0 sc1
buffer_load_dwordx4 v[20:23], v248, s[8:11], s44 offen offset:1024 sc1
buffer_load_dwordx4 v[24:27], v248, s[8:11], s44 offen offset:2048 sc1
buffer_load_dwordx4 v[28:31], v248, s[8:11], s44 offen offset:3072 sc1
s_mov_b32 s53, 0
s_add_u32 m0, s53, 90112
s_add_u32 s54, s39, 0
buffer_load_dwordx4 v241, s[12:15], s54 offen offset:0 sc1 lds
buffer_load_dwordx4 v241, s[12:15], s54 offen offset:1024 sc1 lds
buffer_load_dwordx4 v241, s[12:15], s54 offen offset:2048 sc1 lds
buffer_load_dwordx4 v241, s[12:15], s54 offen offset:3072 sc1 lds
s_add_u32 m0, s53, 94208
s_add_u32 s54, s39, 128
buffer_load_dwordx4 v241, s[12:15], s54 offen offset:0 sc1 lds
buffer_load_dwordx4 v241, s[12:15], s54 offen offset:1024 sc1 lds
buffer_load_dwordx4 v241, s[12:15], s54 offen offset:2048 sc1 lds
buffer_load_dwordx4 v241, s[12:15], s54 offen offset:3072 sc1 lds
s_add_u32 m0, s53, 98304
s_add_u32 s54, s39, 256
buffer_load_dwordx4 v241, s[12:15], s54 offen offset:0 sc1 lds
buffer_load_dwordx4 v241, s[12:15], s54 offen offset:1024 sc1 lds
buffer_load_dwordx4 v241, s[12:15], s54 offen offset:2048 sc1 lds
buffer_load_dwordx4 v241, s[12:15], s54 offen offset:3072 sc1 lds
s_add_u32 m0, s53, 102400
s_add_u32 s54, s39, 384
buffer_load_dwordx4 v241, s[12:15], s54 offen offset:0 sc1 lds
buffer_load_dwordx4 v241, s[12:15], s54 offen offset:1024 sc1 lds
buffer_load_dwordx4 v241, s[12:15], s54 offen offset:2048 sc1 lds
buffer_load_dwordx4 v241, s[12:15], s54 offen offset:3072 sc1 lds
s_add_u32 s53, s53, 0x4000
s_and_b32 s53, s53, 0xffff
s_add_u32 m0, s53, 90112
s_add_u32 s54, s28, 0
buffer_load_dwordx4 v241, s[12:15], s54 offen offset:0 sc1 lds
buffer_load_dwordx4 v241, s[12:15], s54 offen offset:1024 sc1 lds
buffer_load_dwordx4 v241, s[12:15], s54 offen offset:2048 sc1 lds
buffer_load_dwordx4 v241, s[12:15], s54 offen offset:3072 sc1 lds
s_add_u32 m0, s53, 94208
s_add_u32 s54, s28, 128
buffer_load_dwordx4 v241, s[12:15], s54 offen offset:0 sc1 lds
buffer_load_dwordx4 v241, s[12:15], s54 offen offset:1024 sc1 lds
buffer_load_dwordx4 v241, s[12:15], s54 offen offset:2048 sc1 lds
buffer_load_dwordx4 v241, s[12:15], s54 offen offset:3072 sc1 lds
s_add_u32 m0, s53, 98304
s_add_u32 s54, s28, 256
buffer_load_dwordx4 v241, s[12:15], s54 offen offset:0 sc1 lds
buffer_load_dwordx4 v241, s[12:15], s54 offen offset:1024 sc1 lds
buffer_load_dwordx4 v241, s[12:15], s54 offen offset:2048 sc1 lds
buffer_load_dwordx4 v241, s[12:15], s54 offen offset:3072 sc1 lds
s_add_u32 m0, s53, 102400
s_add_u32 s54, s28, 384
buffer_load_dwordx4 v241, s[12:15], s54 offen offset:0 sc1 lds
buffer_load_dwordx4 v241, s[12:15], s54 offen offset:1024 sc1 lds
buffer_load_dwordx4 v241, s[12:15], s54 offen offset:2048 sc1 lds
buffer_load_dwordx4 v241, s[12:15], s54 offen offset:3072 sc1 lds
s_add_u32 s53, s53, 0x4000
s_and_b32 s53, s53, 0xffff
s_add_u32 s28, s28, 0x4000
s_add_u32 m0, s53, 90112
s_add_u32 s54, s28, 0
buffer_load_dwordx4 v241, s[12:15], s54 offen offset:0 sc1 lds
buffer_load_dwordx4 v241, s[12:15], s54 offen offset:1024 sc1 lds
buffer_load_dwordx4 v241, s[12:15], s54 offen offset:2048 sc1 lds
buffer_load_dwordx4 v241, s[12:15], s54 offen offset:3072 sc1 lds
s_add_u32 m0, s53, 94208
s_add_u32 s54, s28, 128
buffer_load_dwordx4 v241, s[12:15], s54 offen offset:0 sc1 lds
buffer_load_dwordx4 v241, s[12:15], s54 offen offset:1024 sc1 lds
buffer_load_dwordx4 v241, s[12:15], s54 offen offset:2048 sc1 lds
buffer_load_dwordx4 v241, s[12:15], s54 offen offset:3072 sc1 lds
s_add_u32 m0, s53, 98304
s_add_u32 s54, s28, 256
buffer_load_dwordx4 v241, s[12:15], s54 offen offset:0 sc1 lds
buffer_load_dwordx4 v241, s[12:15], s54 offen offset:1024 sc1 lds
buffer_load_dwordx4 v241, s[12:15], s54 offen offset:2048 sc1 lds
buffer_load_dwordx4 v241, s[12:15], s54 offen offset:3072 sc1 lds
s_add_u32 m0, s53, 102400
s_add_u32 s54, s28, 384
buffer_load_dwordx4 v241, s[12:15], s54 offen offset:0 sc1 lds
buffer_load_dwordx4 v241, s[12:15], s54 offen offset:1024 sc1 lds
buffer_load_dwordx4 v241, s[12:15], s54 offen offset:2048 sc1 lds
buffer_load_dwordx4 v241, s[12:15], s54 offen offset:3072 sc1 lds
s_add_u32 s53, s53, 0x4000
s_and_b32 s53, s53, 0xffff
s_add_u32 s28, s28, 0x4000
s_mul_i32 s35, s37, 0x600000
s_add_u32 s20, s4, 0x2000000
s_addc_u32 s21, s5, 0
s_add_u32 s20, s20, s35
s_addc_u32 s21, s21, 0
s_mov_b32 s22, 0x4e4000
s_mov_b32 s23, 0x00020000
s_add_u32 s24, s4, 0x6000000
s_addc_u32 s25, s5, 0
s_mov_b32 s26, 0x139000
s_mov_b32 s27, 0x00020000
s_lshl_b32 s48, s37, 3
s_add_u32 s48, s48, 638976
s_mov_b32 s48, 1277952
v_bfe_u32 v240, v248, 4, 3
v_lshlrev_b32 v240, 6, v240
v_bfe_u32 v242, v248, 7, 1
v_lshl_or_b32 v240, v242, 10, v240
v_bfe_u32 v242, v248, 8, 2
v_lshl_or_b32 v240, v242, 4, v240
v_bfe_u32 v242, v248, 6, 1
v_lshlrev_b32 v242, 5, v242
v_xor_b32 v240, v240, v242
v_and_b32 v249, 0x1c0, v248
v_bfe_u32 v242, v248, 9, 1
v_lshl_or_b32 v249, v242, 10, v249
v_bfe_u32 v242, v248, 8, 1
v_lshl_or_b32 v249, v242, 5, v249
v_bfe_u32 v242, v248, 4, 2
v_lshl_or_b32 v249, v242, 3, v249
v_xor_b32 v250, 32, v249
v_bfe_i32 v242, v248, 8, 1
v_and_b32 v192, s33, v242
v_and_b32 v193, s33, v242
v_and_b32 v194, s33, v242
v_and_b32 v195, s33, v242
s_add_u32 s51, s31, 5
s_mov_b32 s52, 90112
v_mov_b32 v172, 0xff800000
v_mov_b32 v173, 0
v_accvgpr_write_b32 a0, 0
v_accvgpr_write_b32 a1, 0
v_accvgpr_write_b32 a2, 0
v_accvgpr_write_b32 a3, 0
v_accvgpr_write_b32 a4, 0
v_accvgpr_write_b32 a5, 0
v_accvgpr_write_b32 a6, 0
v_accvgpr_write_b32 a7, 0
v_accvgpr_write_b32 a8, 0
v_accvgpr_write_b32 a9, 0
v_accvgpr_write_b32 a10, 0
v_accvgpr_write_b32 a11, 0
v_accvgpr_write_b32 a12, 0
v_accvgpr_write_b32 a13, 0
v_accvgpr_write_b32 a14, 0
v_accvgpr_write_b32 a15, 0
v_accvgpr_write_b32 a16, 0
v_accvgpr_write_b32 a17, 0
v_accvgpr_write_b32 a18, 0
v_accvgpr_write_b32 a19, 0
v_accvgpr_write_b32 a20, 0
v_accvgpr_write_b32 a21, 0
v_accvgpr_write_b32 a22, 0
v_accvgpr_write_b32 a23, 0
v_accvgpr_write_b32 a24, 0
v_accvgpr_write_b32 a25, 0
v_accvgpr_write_b32 a26, 0
v_accvgpr_write_b32 a27, 0
v_accvgpr_write_b32 a28, 0
v_accvgpr_write_b32 a29, 0
v_accvgpr_write_b32 a30, 0
v_accvgpr_write_b32 a31, 0
v_accvgpr_write_b32 a32, 0
v_accvgpr_write_b32 a33, 0
v_accvgpr_write_b32 a34, 0
v_accvgpr_write_b32 a35, 0
v_accvgpr_write_b32 a36, 0
v_accvgpr_write_b32 a37, 0
v_accvgpr_write_b32 a38, 0
v_accvgpr_write_b32 a39, 0
v_accvgpr_write_b32 a40, 0
v_accvgpr_write_b32 a41, 0
v_accvgpr_write_b32 a42, 0
v_accvgpr_write_b32 a43, 0
v_accvgpr_write_b32 a44, 0
v_accvgpr_write_b32 a45, 0
v_accvgpr_write_b32 a46, 0
v_accvgpr_write_b32 a47, 0
v_accvgpr_write_b32 a48, 0
v_accvgpr_write_b32 a49, 0
v_accvgpr_write_b32 a50, 0
v_accvgpr_write_b32 a51, 0
v_accvgpr_write_b32 a52, 0
v_accvgpr_write_b32 a53, 0
v_accvgpr_write_b32 a54, 0
v_accvgpr_write_b32 a55, 0
v_accvgpr_write_b32 a56, 0
v_accvgpr_write_b32 a57, 0
v_accvgpr_write_b32 a58, 0
v_accvgpr_write_b32 a59, 0
v_accvgpr_write_b32 a60, 0
v_accvgpr_write_b32 a61, 0
v_accvgpr_write_b32 a62, 0
v_accvgpr_write_b32 a63, 0
LT_loop:
s_add_u32 m0, s53, 90112
s_add_u32 s54, s28, 0
buffer_load_dwordx4 v241, s[12:15], s54 offen offset:0 sc1 lds
buffer_load_dwordx4 v241, s[12:15], s54 offen offset:1024 sc1 lds
buffer_load_dwordx4 v241, s[12:15], s54 offen offset:2048 sc1 lds
buffer_load_dwordx4 v241, s[12:15], s54 offen offset:3072 sc1 lds
s_add_u32 m0, s53, 94208
s_add_u32 s54, s28, 128
buffer_load_dwordx4 v241, s[12:15], s54 offen offset:0 sc1 lds
buffer_load_dwordx4 v241, s[12:15], s54 offen offset:1024 sc1 lds
buffer_load_dwordx4 v241, s[12:15], s54 offen offset:2048 sc1 lds
buffer_load_dwordx4 v241, s[12:15], s54 offen offset:3072 sc1 lds
s_add_u32 m0, s53, 98304
s_add_u32 s54, s28, 256
buffer_load_dwordx4 v241, s[12:15], s54 offen offset:0 sc1 lds
buffer_load_dwordx4 v241, s[12:15], s54 offen offset:1024 sc1 lds
buffer_load_dwordx4 v241, s[12:15], s54 offen offset:2048 sc1 lds
buffer_load_dwordx4 v241, s[12:15], s54 offen offset:3072 sc1 lds
s_add_u32 m0, s53, 102400
s_add_u32 s54, s28, 384
buffer_load_dwordx4 v241, s[12:15], s54 offen offset:0 sc1 lds
buffer_load_dwordx4 v241, s[12:15], s54 offen offset:1024 sc1 lds
buffer_load_dwordx4 v241, s[12:15], s54 offen offset:2048 sc1 lds
buffer_load_dwordx4 v241, s[12:15], s54 offen offset:3072 sc1 lds
s_add_u32 s53, s53, 0x4000
s_and_b32 s53, s53, 0xffff
s_add_u32 s28, s28, 0x4000
v_add_u32 v177, s52, v240
v_add_u32 v178, s52, v249
v_add_u32 v179, s52, v250
s_add_u32 s52, s52, 0x4000
s_cmp_eq_u32 s52, 155648
s_cselect_b32 s52, 90112, s52
s_waitcnt vmcnt(48)
ds_read_b128 v[32:35], v177 offset:0
ds_read_b128 v[64:67], v177 offset:2048
ds_read_b128 v[36:39], v177 offset:512
ds_read_b128 v[68:71], v177 offset:2560
ds_read_b128 v[40:43], v177 offset:4096
ds_read_b128 v[72:75], v177 offset:6144
ds_read_b128 v[44:47], v177 offset:4608
ds_read_b128 v[76:79], v177 offset:6656
ds_read_b128 v[48:51], v177 offset:8192
ds_read_b128 v[80:83], v177 offset:10240
ds_read_b128 v[52:55], v177 offset:8704
ds_read_b128 v[84:87], v177 offset:10752
ds_read_b128 v[56:59], v177 offset:12288
ds_read_b128 v[88:91], v177 offset:14336
ds_read_b128 v[60:63], v177 offset:12800
ds_read_b128 v[92:95], v177 offset:14848
s_waitcnt lgkmcnt(14)
v_mfma_f32_16x16x32_bf16 v[160:163], v[32:35], v[0:3], v[192:195]
v_mfma_f32_16x16x32_bf16 v[164:167], v[64:67], v[0:3], v[192:195]
s_waitcnt lgkmcnt(12)
v_mfma_f32_16x16x32_bf16 v[160:163], v[36:39], v[4:7], v[160:163]
v_mfma_f32_16x16x32_bf16 v[164:167], v[68:71], v[4:7], v[164:167]
s_waitcnt lgkmcnt(10)
v_mfma_f32_16x16x32_bf16 v[160:163], v[40:43], v[8:11], v[160:163]
v_mfma_f32_16x16x32_bf16 v[164:167], v[72:75], v[8:11], v[164:167]
s_waitcnt lgkmcnt(8)
v_mfma_f32_16x16x32_bf16 v[160:163], v[44:47], v[12:15], v[160:163]
v_mfma_f32_16x16x32_bf16 v[164:167], v[76:79], v[12:15], v[164:167]
s_waitcnt lgkmcnt(6)
v_mfma_f32_16x16x32_bf16 v[160:163], v[48:51], v[16:19], v[160:163]
v_mfma_f32_16x16x32_bf16 v[164:167], v[80:83], v[16:19], v[164:167]
s_waitcnt lgkmcnt(4)
v_mfma_f32_16x16x32_bf16 v[160:163], v[52:55], v[20:23], v[160:163]
v_mfma_f32_16x16x32_bf16 v[164:167], v[84:87], v[20:23], v[164:167]
s_waitcnt lgkmcnt(2)
v_mfma_f32_16x16x32_bf16 v[160:163], v[56:59], v[24:27], v[160:163]
v_mfma_f32_16x16x32_bf16 v[164:167], v[88:91], v[24:27], v[164:167]
s_waitcnt lgkmcnt(0)
v_mfma_f32_16x16x32_bf16 v[160:163], v[60:63], v[28:31], v[160:163]
v_mfma_f32_16x16x32_bf16 v[164:167], v[92:95], v[28:31], v[164:167]
ds_read_b64_tr_b16 v[96:97], v178 offset:0
ds_read_b64_tr_b16 v[98:99], v178 offset:2048
ds_read_b64_tr_b16 v[100:101], v179 offset:0
ds_read_b64_tr_b16 v[102:103], v179 offset:2048
ds_read_b64_tr_b16 v[104:105], v178 offset:512
ds_read_b64_tr_b16 v[106:107], v178 offset:2560
ds_read_b64_tr_b16 v[108:109], v179 offset:512
ds_read_b64_tr_b16 v[110:111], v179 offset:2560
ds_read_b64_tr_b16 v[112:113], v178 offset:4096
ds_read_b64_tr_b16 v[114:115], v178 offset:6144
ds_read_b64_tr_b16 v[116:117], v179 offset:4096
ds_read_b64_tr_b16 v[118:119], v179 offset:6144
ds_read_b64_tr_b16 v[120:121], v178 offset:4608
ds_read_b64_tr_b16 v[122:123], v178 offset:6656
ds_read_b64_tr_b16 v[124:125], v179 offset:4608
ds_read_b64_tr_b16 v[126:127], v179 offset:6656
ds_read_b64_tr_b16 v[128:129], v178 offset:8192
ds_read_b64_tr_b16 v[130:131], v178 offset:10240
ds_read_b64_tr_b16 v[132:133], v179 offset:8192
ds_read_b64_tr_b16 v[134:135], v179 offset:10240
ds_read_b64_tr_b16 v[136:137], v178 offset:8704
ds_read_b64_tr_b16 v[138:139], v178 offset:10752
ds_read_b64_tr_b16 v[140:141], v179 offset:8704
ds_read_b64_tr_b16 v[142:143], v179 offset:10752
ds_read_b64_tr_b16 v[144:145], v178 offset:12288
ds_read_b64_tr_b16 v[146:147], v178 offset:14336
ds_read_b64_tr_b16 v[148:149], v179 offset:12288
ds_read_b64_tr_b16 v[150:151], v179 offset:14336
ds_read_b64_tr_b16 v[152:153], v178 offset:12800
ds_read_b64_tr_b16 v[154:155], v178 offset:14848
ds_read_b64_tr_b16 v[156:157], v179 offset:12800
ds_read_b64_tr_b16 v[158:159], v179 offset:14848
v_mov_b32 v192, 0
v_mov_b32 v193, 0
v_mov_b32 v194, 0
v_mov_b32 v195, 0
s_nop 7
v_max3_f32 v175, v160, v161, v162
v_max3_f32 v175, v175, v163, v164
v_max3_f32 v175, v175, v165, v166
v_max3_f32 v175, v175, v167, v172
v_mov_b32 v176, v175
s_nop 1
v_permlane32_swap_b32 v175, v176
s_nop 1
v_max_f32 v175, v175, v176
v_mov_b32 v176, v175
s_nop 1
v_permlane16_swap_b32 v175, v176
s_nop 1
v_max_f32 v175, v175, v176
v_ceil_f32 v175, v175
v_sub_f32 v174, v172, v175
v_exp_f32 v174, v174
v_mov_b32 v172, v175
v_sub_f32 v160, v160, v172
v_sub_f32 v161, v161, v172
v_sub_f32 v162, v162, v172
v_sub_f32 v163, v163, v172
v_sub_f32 v164, v164, v172
v_sub_f32 v165, v165, v172
v_sub_f32 v166, v166, v172
v_sub_f32 v167, v167, v172
v_exp_f32 v160, v160
v_exp_f32 v161, v161
v_exp_f32 v162, v162
v_exp_f32 v163, v163
v_exp_f32 v164, v164
v_exp_f32 v165, v165
v_exp_f32 v166, v166
v_exp_f32 v167, v167
v_mul_f32 v173, v173, v174
v_cvt_pk_bf16_f32 v168, v160, v161
v_cvt_pk_bf16_f32 v169, v162, v163
v_cvt_pk_bf16_f32 v170, v164, v165
v_cvt_pk_bf16_f32 v171, v166, v167
v_cmp_neq_f32 vcc, 1.0, v174
v_add_f32 v173, v173, v160
v_add_f32 v173, v173, v161
v_add_f32 v173, v173, v162
v_add_f32 v173, v173, v163
v_add_f32 v173, v173, v164
v_add_f32 v173, v173, v165
v_add_f32 v173, v173, v166
v_add_f32 v173, v173, v167
s_cbranch_vccz LT_nors
v_lshrrev_b32 v176, 4, v248
v_and_b32 v176, 0x30, v176
ds_bpermute_b32 v188, v176, v174 offset:0
ds_bpermute_b32 v189, v176, v174 offset:4
ds_bpermute_b32 v190, v176, v174 offset:8
ds_bpermute_b32 v191, v176, v174 offset:12
s_waitcnt lgkmcnt(0)
v_accvgpr_read_b32 v180, a0
v_accvgpr_read_b32 v181, a1
v_accvgpr_read_b32 v182, a2
v_accvgpr_read_b32 v183, a3
v_accvgpr_read_b32 v184, a4
v_accvgpr_read_b32 v185, a5
v_accvgpr_read_b32 v186, a6
v_accvgpr_read_b32 v187, a7
v_mul_f32 v180, v180, v188
v_mul_f32 v181, v181, v189
v_mul_f32 v182, v182, v190
v_mul_f32 v183, v183, v191
v_mul_f32 v184, v184, v188
v_mul_f32 v185, v185, v189
v_mul_f32 v186, v186, v190
v_mul_f32 v187, v187, v191
v_accvgpr_write_b32 a0, v180
v_accvgpr_write_b32 a1, v181
v_accvgpr_write_b32 a2, v182
v_accvgpr_write_b32 a3, v183
v_accvgpr_write_b32 a4, v184
v_accvgpr_write_b32 a5, v185
v_accvgpr_write_b32 a6, v186
v_accvgpr_write_b32 a7, v187
v_accvgpr_read_b32 v180, a8
v_accvgpr_read_b32 v181, a9
v_accvgpr_read_b32 v182, a10
v_accvgpr_read_b32 v183, a11
v_accvgpr_read_b32 v184, a12
v_accvgpr_read_b32 v185, a13
v_accvgpr_read_b32 v186, a14
v_accvgpr_read_b32 v187, a15
v_mul_f32 v180, v180, v188
v_mul_f32 v181, v181, v189
v_mul_f32 v182, v182, v190
v_mul_f32 v183, v183, v191
v_mul_f32 v184, v184, v188
v_mul_f32 v185, v185, v189
v_mul_f32 v186, v186, v190
v_mul_f32 v187, v187, v191
v_accvgpr_write_b32 a8, v180
v_accvgpr_write_b32 a9, v181
v_accvgpr_write_b32 a10, v182
v_accvgpr_write_b32 a11, v183
v_accvgpr_write_b32 a12, v184
v_accvgpr_write_b32 a13, v185
v_accvgpr_write_b32 a14, v186
v_accvgpr_write_b32 a15, v187
v_accvgpr_read_b32 v180, a16
v_accvgpr_read_b32 v181, a17
v_accvgpr_read_b32 v182, a18
v_accvgpr_read_b32 v183, a19
v_accvgpr_read_b32 v184, a20
v_accvgpr_read_b32 v185, a21
v_accvgpr_read_b32 v186, a22
v_accvgpr_read_b32 v187, a23
v_mul_f32 v180, v180, v188
v_mul_f32 v181, v181, v189
v_mul_f32 v182, v182, v190
v_mul_f32 v183, v183, v191
v_mul_f32 v184, v184, v188
v_mul_f32 v185, v185, v189
v_mul_f32 v186, v186, v190
v_mul_f32 v187, v187, v191
v_accvgpr_write_b32 a16, v180
v_accvgpr_write_b32 a17, v181
v_accvgpr_write_b32 a18, v182
v_accvgpr_write_b32 a19, v183
v_accvgpr_write_b32 a20, v184
v_accvgpr_write_b32 a21, v185
v_accvgpr_write_b32 a22, v186
v_accvgpr_write_b32 a23, v187
v_accvgpr_read_b32 v180, a24
v_accvgpr_read_b32 v181, a25
v_accvgpr_read_b32 v182, a26
v_accvgpr_read_b32 v183, a27
v_accvgpr_read_b32 v184, a28
v_accvgpr_read_b32 v185, a29
v_accvgpr_read_b32 v186, a30
v_accvgpr_read_b32 v187, a31
v_mul_f32 v180, v180, v188
v_mul_f32 v181, v181, v189
v_mul_f32 v182, v182, v190
v_mul_f32 v183, v183, v191
v_mul_f32 v184, v184, v188
v_mul_f32 v185, v185, v189
v_mul_f32 v186, v186, v190
v_mul_f32 v187, v187, v191
v_accvgpr_write_b32 a24, v180
v_accvgpr_write_b32 a25, v181
v_accvgpr_write_b32 a26, v182
v_accvgpr_write_b32 a27, v183
v_accvgpr_write_b32 a28, v184
v_accvgpr_write_b32 a29, v185
v_accvgpr_write_b32 a30, v186
v_accvgpr_write_b32 a31, v187
v_accvgpr_read_b32 v180, a32
v_accvgpr_read_b32 v181, a33
v_accvgpr_read_b32 v182, a34
v_accvgpr_read_b32 v183, a35
v_accvgpr_read_b32 v184, a36
v_accvgpr_read_b32 v185, a37
v_accvgpr_read_b32 v186, a38
v_accvgpr_read_b32 v187, a39
v_mul_f32 v180, v180, v188
v_mul_f32 v181, v181, v189
v_mul_f32 v182, v182, v190
v_mul_f32 v183, v183, v191
v_mul_f32 v184, v184, v188
v_mul_f32 v185, v185, v189
v_mul_f32 v186, v186, v190
v_mul_f32 v187, v187, v191
v_accvgpr_write_b32 a32, v180
v_accvgpr_write_b32 a33, v181
v_accvgpr_write_b32 a34, v182
v_accvgpr_write_b32 a35, v183
v_accvgpr_write_b32 a36, v184
v_accvgpr_write_b32 a37, v185
v_accvgpr_write_b32 a38, v186
v_accvgpr_write_b32 a39, v187
v_accvgpr_read_b32 v180, a40
v_accvgpr_read_b32 v181, a41
v_accvgpr_read_b32 v182, a42
v_accvgpr_read_b32 v183, a43
v_accvgpr_read_b32 v184, a44
v_accvgpr_read_b32 v185, a45
v_accvgpr_read_b32 v186, a46
v_accvgpr_read_b32 v187, a47
v_mul_f32 v180, v180, v188
v_mul_f32 v181, v181, v189
v_mul_f32 v182, v182, v190
v_mul_f32 v183, v183, v191
v_mul_f32 v184, v184, v188
v_mul_f32 v185, v185, v189
v_mul_f32 v186, v186, v190
v_mul_f32 v187, v187, v191
v_accvgpr_write_b32 a40, v180
v_accvgpr_write_b32 a41, v181
v_accvgpr_write_b32 a42, v182
v_accvgpr_write_b32 a43, v183
v_accvgpr_write_b32 a44, v184
v_accvgpr_write_b32 a45, v185
v_accvgpr_write_b32 a46, v186
v_accvgpr_write_b32 a47, v187
v_accvgpr_read_b32 v180, a48
v_accvgpr_read_b32 v181, a49
v_accvgpr_read_b32 v182, a50
v_accvgpr_read_b32 v183, a51
v_accvgpr_read_b32 v184, a52
v_accvgpr_read_b32 v185, a53
v_accvgpr_read_b32 v186, a54
v_accvgpr_read_b32 v187, a55
v_mul_f32 v180, v180, v188
v_mul_f32 v181, v181, v189
v_mul_f32 v182, v182, v190
v_mul_f32 v183, v183, v191
v_mul_f32 v184, v184, v188
v_mul_f32 v185, v185, v189
v_mul_f32 v186, v186, v190
v_mul_f32 v187, v187, v191
v_accvgpr_write_b32 a48, v180
v_accvgpr_write_b32 a49, v181
v_accvgpr_write_b32 a50, v182
v_accvgpr_write_b32 a51, v183
v_accvgpr_write_b32 a52, v184
v_accvgpr_write_b32 a53, v185
v_accvgpr_write_b32 a54, v186
v_accvgpr_write_b32 a55, v187
v_accvgpr_read_b32 v180, a56
v_accvgpr_read_b32 v181, a57
v_accvgpr_read_b32 v182, a58
v_accvgpr_read_b32 v183, a59
v_accvgpr_read_b32 v184, a60
v_accvgpr_read_b32 v185, a61
v_accvgpr_read_b32 v186, a62
v_accvgpr_read_b32 v187, a63
v_mul_f32 v180, v180, v188
v_mul_f32 v181, v181, v189
v_mul_f32 v182, v182, v190
v_mul_f32 v183, v183, v191
v_mul_f32 v184, v184, v188
v_mul_f32 v185, v185, v189
v_mul_f32 v186, v186, v190
v_mul_f32 v187, v187, v191
v_accvgpr_write_b32 a56, v180
v_accvgpr_write_b32 a57, v181
v_accvgpr_write_b32 a58, v182
v_accvgpr_write_b32 a59, v183
v_accvgpr_write_b32 a60, v184
v_accvgpr_write_b32 a61, v185
v_accvgpr_write_b32 a62, v186
v_accvgpr_write_b32 a63, v187
LT_nors:
s_waitcnt lgkmcnt(0)
s_nop 1
v_mfma_f32_16x16x32_bf16 a[0:3], v[168:171], v[96:99], a[0:3]
v_mfma_f32_16x16x32_bf16 a[4:7], v[168:171], v[100:103], a[4:7]
v_mfma_f32_16x16x32_bf16 a[8:11], v[168:171], v[104:107], a[8:11]
v_mfma_f32_16x16x32_bf16 a[12:15], v[168:171], v[108:111], a[12:15]
v_mfma_f32_16x16x32_bf16 a[16:19], v[168:171], v[112:115], a[16:19]
v_mfma_f32_16x16x32_bf16 a[20:23], v[168:171], v[116:119], a[20:23]
v_mfma_f32_16x16x32_bf16 a[24:27], v[168:171], v[120:123], a[24:27]
v_mfma_f32_16x16x32_bf16 a[28:31], v[168:171], v[124:127], a[28:31]
v_mfma_f32_16x16x32_bf16 a[32:35], v[168:171], v[128:131], a[32:35]
v_mfma_f32_16x16x32_bf16 a[36:39], v[168:171], v[132:135], a[36:39]
v_mfma_f32_16x16x32_bf16 a[40:43], v[168:171], v[136:139], a[40:43]
v_mfma_f32_16x16x32_bf16 a[44:47], v[168:171], v[140:143], a[44:47]
v_mfma_f32_16x16x32_bf16 a[48:51], v[168:171], v[144:147], a[48:51]
v_mfma_f32_16x16x32_bf16 a[52:55], v[168:171], v[148:151], a[52:55]
v_mfma_f32_16x16x32_bf16 a[56:59], v[168:171], v[152:155], a[56:59]
v_mfma_f32_16x16x32_bf16 a[60:63], v[168:171], v[156:159], a[60:63]
s_sub_u32 s51, s51, 1
s_cmp_lg_u32 s51, 0
s_cbranch_scc1 LT_loop
s_nop 15
v_accvgpr_read_b32 v180, a0
v_accvgpr_read_b32 v181, a1
v_accvgpr_read_b32 v182, a2
v_accvgpr_read_b32 v183, a3
v_accvgpr_read_b32 v184, a4
v_accvgpr_read_b32 v185, a5
v_accvgpr_read_b32 v186, a6
v_accvgpr_read_b32 v187, a7
v_cvt_pk_bf16_f32 v32, v180, v181
v_cvt_pk_bf16_f32 v33, v182, v183
v_cvt_pk_bf16_f32 v34, v184, v185
v_cvt_pk_bf16_f32 v35, v186, v187
buffer_store_dwordx4 v[32:35], v248, s[20:23], s40 offen offset:0 sc1
v_accvgpr_read_b32 v180, a8
v_accvgpr_read_b32 v181, a9
v_accvgpr_read_b32 v182, a10
v_accvgpr_read_b32 v183, a11
v_accvgpr_read_b32 v184, a12
v_accvgpr_read_b32 v185, a13
v_accvgpr_read_b32 v186, a14
v_accvgpr_read_b32 v187, a15
v_cvt_pk_bf16_f32 v36, v180, v181
v_cvt_pk_bf16_f32 v37, v182, v183
v_cvt_pk_bf16_f32 v38, v184, v185
v_cvt_pk_bf16_f32 v39, v186, v187
buffer_store_dwordx4 v[36:39], v248, s[20:23], s40 offen offset:1024 sc1
v_accvgpr_read_b32 v180, a16
v_accvgpr_read_b32 v181, a17
v_accvgpr_read_b32 v182, a18
v_accvgpr_read_b32 v183, a19
v_accvgpr_read_b32 v184, a20
v_accvgpr_read_b32 v185, a21
v_accvgpr_read_b32 v186, a22
v_accvgpr_read_b32 v187, a23
v_cvt_pk_bf16_f32 v40, v180, v181
v_cvt_pk_bf16_f32 v41, v182, v183
v_cvt_pk_bf16_f32 v42, v184, v185
v_cvt_pk_bf16_f32 v43, v186, v187
buffer_store_dwordx4 v[40:43], v248, s[20:23], s40 offen offset:2048 sc1
v_accvgpr_read_b32 v180, a24
v_accvgpr_read_b32 v181, a25
v_accvgpr_read_b32 v182, a26
v_accvgpr_read_b32 v183, a27
v_accvgpr_read_b32 v184, a28
v_accvgpr_read_b32 v185, a29
v_accvgpr_read_b32 v186, a30
v_accvgpr_read_b32 v187, a31
v_cvt_pk_bf16_f32 v44, v180, v181
v_cvt_pk_bf16_f32 v45, v182, v183
v_cvt_pk_bf16_f32 v46, v184, v185
v_cvt_pk_bf16_f32 v47, v186, v187
buffer_store_dwordx4 v[44:47], v248, s[20:23], s40 offen offset:3072 sc1
v_accvgpr_read_b32 v180, a32
v_accvgpr_read_b32 v181, a33
v_accvgpr_read_b32 v182, a34
v_accvgpr_read_b32 v183, a35
v_accvgpr_read_b32 v184, a36
v_accvgpr_read_b32 v185, a37
v_accvgpr_read_b32 v186, a38
v_accvgpr_read_b32 v187, a39
v_cvt_pk_bf16_f32 v48, v180, v181
v_cvt_pk_bf16_f32 v49, v182, v183
v_cvt_pk_bf16_f32 v50, v184, v185
v_cvt_pk_bf16_f32 v51, v186, v187
buffer_store_dwordx4 v[48:51], v248, s[20:23], s44 offen offset:0 sc1
v_accvgpr_read_b32 v180, a40
v_accvgpr_read_b32 v181, a41
v_accvgpr_read_b32 v182, a42
v_accvgpr_read_b32 v183, a43
v_accvgpr_read_b32 v184, a44
v_accvgpr_read_b32 v185, a45
v_accvgpr_read_b32 v186, a46
v_accvgpr_read_b32 v187, a47
v_cvt_pk_bf16_f32 v52, v180, v181
v_cvt_pk_bf16_f32 v53, v182, v183
v_cvt_pk_bf16_f32 v54, v184, v185
v_cvt_pk_bf16_f32 v55, v186, v187
buffer_store_dwordx4 v[52:55], v248, s[20:23], s44 offen offset:1024 sc1
v_accvgpr_read_b32 v180, a48
v_accvgpr_read_b32 v181, a49
v_accvgpr_read_b32 v182, a50
v_accvgpr_read_b32 v183, a51
v_accvgpr_read_b32 v184, a52
v_accvgpr_read_b32 v185, a53
v_accvgpr_read_b32 v186, a54
v_accvgpr_read_b32 v187, a55
v_cvt_pk_bf16_f32 v56, v180, v181
v_cvt_pk_bf16_f32 v57, v182, v183
v_cvt_pk_bf16_f32 v58, v184, v185
v_cvt_pk_bf16_f32 v59, v186, v187
buffer_store_dwordx4 v[56:59], v248, s[20:23], s44 offen offset:2048 sc1
v_accvgpr_read_b32 v180, a56
v_accvgpr_read_b32 v181, a57
v_accvgpr_read_b32 v182, a58
v_accvgpr_read_b32 v183, a59
v_accvgpr_read_b32 v184, a60
v_accvgpr_read_b32 v185, a61
v_accvgpr_read_b32 v186, a62
v_accvgpr_read_b32 v187, a63
v_cvt_pk_bf16_f32 v60, v180, v181
v_cvt_pk_bf16_f32 v61, v182, v183
v_cvt_pk_bf16_f32 v62, v184, v185
v_cvt_pk_bf16_f32 v63, v186, v187
buffer_store_dwordx4 v[60:63], v248, s[20:23], s44 offen offset:3072 sc1
v_mov_b32 v176, v173
s_nop 1
v_permlane32_swap_b32 v173, v176
s_nop 1
v_add_f32 v173, v173, v176
v_mov_b32 v176, v173
s_nop 1
v_permlane16_swap_b32 v173, v176
s_nop 1
v_add_f32 v173, v173, v176
v_lshlrev_b32 v175, 2, v248
s_mov_b64 exec, 0xffff
s_mov_b64 exec, -1
v_bfe_u32 v175, v248, 8, 1
v_mul_u32_u24 v175, 48, v175
v_lshl_add_u32 v175, s37, 3, v175
v_and_b32 v176, 0xf0, v248
v_lshl_add_u32 v175, v176, 3, v175
s_mov_b32 exec_hi, 0
buffer_store_dwordx2 v[172:173], v175, s[24:27], s48 offen sc1
s_add_u32 s16, s4, 0x7c00000
s_addc_u32 s17, s5, 0
s_mov_b32 s18, 0x40000
s_mov_b32 s19, 0x00020000
s_add_u32 s48, s37, 1248
s_mul_i32 s48, s48, 128
s_waitcnt vmcnt(0)
v_mov_b32 v176, s98
v_mov_b32 v177, s99
s_mov_b64 exec, 1
buffer_store_dwordx2 v[176:177], off, s[16:19], s48 sc1
buffer_store_dwordx2 v[176:177], off, s[16:19], s48 offset:8 sc1
s_mov_b64 exec, -1
s_branch L2_fin
LE_start:
s_cmp_ge_u32 s37, 32
s_cbranch_scc1 L2_end
v_lshrrev_b32 v1, 6, v0
s_sub_u32 s37, s37, 30
s_lshl_b32 s35, s35, 1
v_readfirstlane_b32 s41, v1
s_add_u32 s35, s35, s37
s_mul_i32 s35, s35, 3
s_add_u32 s40, s35, s41
s_cmp_ge_u32 s41, 3
s_cbranch_scc1 L2_end
LE_common:
v_and_b32 v1, 63, v0
s_sub_u32 s36, s40, 0
s_mov_b32 s54, 154
s_mul_i32 s36, s36, 154
s_mov_b32 s55, s36
s_sub_u32 s36, s40, 24
s_cselect_b32 s54, s54, 169
s_mul_i32 s36, s36, 169
s_add_u32 s36, s36, 3696
s_cmp_lt_u32 s40, 24
s_cselect_b32 s55, s55, s36
s_sub_u32 s36, s40, 48
s_cselect_b32 s54, s54, 141
s_mul_i32 s36, s36, 141
s_add_u32 s36, s36, 7752
s_cmp_lt_u32 s40, 48
s_cselect_b32 s55, s55, s36
s_mov_b32 s42, 0
s_mov_b32 s49, 512
v_lshrrev_b32 v33, 2, v1
v_and_b32 v34, 3, v1
v_mul_u32_u24 v6, 0xa000, v33
v_lshl_add_u32 v6, v34, 4, v6
v_lshlrev_b32 v33, 2, v33
s_mul_i32 s50, s40, 655360
s_mul_i32 s48, s40, 64
s_waitcnt lgkmcnt(0)
s_add_u32 s8, s4, 0x7c2a000
s_addc_u32 s9, s5, 0
s_mov_b32 s10, 0x8000
s_mov_b32 s11, 0x00020000
v_and_b32 v200, 63, v0
v_lshlrev_b32 v200, 7, v200
s_mov_b32 s91, 8192
s_mov_b32 s90, 16384
s_mov_b32 s95, 24576
s_mov_b32 s94, 0x10000
LE_poll:
buffer_load_dwordx2 v[192:193], v200, s[8:11], 0 offen sc1
buffer_load_dwordx2 v[194:195], v200, s[8:11], s91 offen sc1
buffer_load_dwordx2 v[196:197], v200, s[8:11], s90 offen sc1
buffer_load_dwordx2 v[198:199], v200, s[8:11], s95 offen sc1
s_sub_u32 s94, s94, 1
s_waitcnt vmcnt(0)
s_cbranch_scc1 LE_poll_go
v_cmp_ne_u64 vcc, s[98:99], v[192:193]
s_nop 1
s_cbranch_vccnz LE_poll
v_cmp_ne_u64 vcc, s[98:99], v[194:195]
s_nop 1
s_cbranch_vccnz LE_poll
v_cmp_ne_u64 vcc, s[98:99], v[196:197]
s_nop 1
s_cbranch_vccnz LE_poll
v_cmp_ne_u64 vcc, s[98:99], v[198:199]
s_nop 1
s_cbranch_vccnz LE_poll
LE_poll_go:
s_cmp_lg_u32 s40, 0
s_cbranch_scc1 LE_nobump
s_mov_b32 s90, 89984
s_mov_b32 s10, 90112
v_mov_b32 v192, s98
v_mov_b32 v193, s99
s_mov_b64 exec, 1
buffer_store_dwordx2 v[192:193], off, s[8:11], s90 sc1
s_mov_b64 exec, -1
LE_nobump:
s_add_u32 s8, s4, 0x7800000
s_addc_u32 s9, s5, 0
s_mov_b32 s10, 0x1000
s_mov_b32 s11, 0x00020000
s_add_u32 s12, s4, 0x8000000
s_addc_u32 s13, s5, 0
s_mov_b32 s14, 0x2800000
s_mov_b32 s15, 0x00020000
buffer_load_dword v4, v33, s[8:11], s48 offen sc1
buffer_load_dwordx4 v[192:195], v6, s[12:15], s50 offen offset:0 sc1
buffer_load_dwordx4 v[196:199], v6, s[12:15], s50 offen offset:64 sc1
buffer_load_dwordx4 v[200:203], v6, s[12:15], s50 offen offset:128 sc1
buffer_load_dwordx4 v[204:207], v6, s[12:15], s50 offen offset:192 sc1
buffer_load_dwordx4 v[208:211], v6, s[12:15], s50 offen offset:256 sc1
buffer_load_dwordx4 v[212:215], v6, s[12:15], s50 offen offset:320 sc1
buffer_load_dwordx4 v[216:219], v6, s[12:15], s50 offen offset:384 sc1
buffer_load_dwordx4 v[220:223], v6, s[12:15], s50 offen offset:448 sc1
buffer_load_dwordx4 v[224:227], v6, s[12:15], s50 offen offset:512 sc1
buffer_load_dwordx4 v[228:231], v6, s[12:15], s50 offen offset:576 sc1
buffer_load_dwordx4 v[232:235], v6, s[12:15], s50 offen offset:640 sc1
buffer_load_dwordx4 v[236:239], v6, s[12:15], s50 offen offset:704 sc1
buffer_load_dwordx4 v[240:243], v6, s[12:15], s50 offen offset:768 sc1
buffer_load_dwordx4 v[244:247], v6, s[12:15], s50 offen offset:832 sc1
buffer_load_dwordx4 v[248:251], v6, s[12:15], s50 offen offset:896 sc1
buffer_load_dwordx4 v[252:255], v6, s[12:15], s50 offen offset:960 sc1
s_add_u32 s16, s4, 0x6800000
s_addc_u32 s17, s5, 0
s_mov_b32 s18, 0x4e2000
s_mov_b32 s19, 0x00020000
s_add_u32 s20, s4, 0x7000000
s_addc_u32 s21, s5, 0
s_mov_b32 s22, 0x4e2000
s_mov_b32 s23, 0x00020000
v_lshlrev_b32 v5, 2, v34
v_and_b32 v2, 15, v1
v_lshrrev_b32 v3, 4, v1
v_mov_b32 v16, 1
v_mov_b32 v17, 4
v_and_b32 v33, 1, v2
v_lshlrev_b32 v33, 4, v33
v_lshlrev_b32 v33, v33, v16
v_mul_u32_u24 v33, 0x3f80, v33
v_lshrrev_b32 v34, 1, v2
v_cmp_eq_u32 vcc, 0, v34
s_nop 1
v_cndmask_b32 v40, 0, v33, vcc
v_cmp_eq_u32 vcc, 1, v34
s_nop 1
v_cndmask_b32 v41, 0, v33, vcc
v_cmp_eq_u32 vcc, 2, v34
s_nop 1
v_cndmask_b32 v42, 0, v33, vcc
v_cmp_eq_u32 vcc, 3, v34
s_nop 1
v_cndmask_b32 v43, 0, v33, vcc
v_cmp_eq_u32 vcc, 4, v34
s_nop 1
v_cndmask_b32 v44, 0, v33, vcc
v_cmp_eq_u32 vcc, 5, v34
s_nop 1
v_cndmask_b32 v45, 0, v33, vcc
v_cmp_eq_u32 vcc, 6, v34
s_nop 1
v_cndmask_b32 v46, 0, v33, vcc
v_cmp_eq_u32 vcc, 7, v34
s_nop 1
v_cndmask_b32 v47, 0, v33, vcc
v_lshlrev_b32 v39, 5, v2
v_lshl_add_u32 v39, v3, 3, v39
v_lshlrev_b32 v2, 4, v2
s_mul_i32 s48, s41, 21504
s_add_u32 s48, s48, 4096
v_mov_b32 v36, s48
v_lshl_add_u32 v38, v3, 2, v36
s_lshl_b32 s36, s41, 10
s_lshl_b32 s35, s55, 2
s_sub_u32 s35, s36, s35
v_mov_b32 v7, s35
v_lshlrev_b32 v35, 4, v1
v_add_u32 v68, s48, v35
v_add_u32 v35, s36, v35
v_lshlrev_b32 v33, 2, v1
v_mov_b32 v72, 0xffff
v_mov_b32 v73, 0xffff
v_mov_b32 v74, 0xffff
v_mov_b32 v75, 0xffff
v_cmp_gt_u32 vcc, s54, v33
v_mov_b32 v48, 0
s_nop 0
v_cndmask_b32 v18, 0, v16, vcc
v_add_u32 v33, 1, v33
v_cmp_gt_u32 vcc, s54, v33
v_mov_b32 v49, 0
s_nop 0
v_cndmask_b32 v19, 0, v16, vcc
v_add_u32 v33, 1, v33
v_cmp_gt_u32 vcc, s54, v33
v_mov_b32 v50, 0
s_nop 0
v_cndmask_b32 v20, 0, v16, vcc
v_add_u32 v33, 1, v33
v_cmp_gt_u32 vcc, s54, v33
v_mov_b32 v51, 0
s_nop 0
v_cndmask_b32 v21, 0, v16, vcc
LE_pass:
ds_write_b128 v35, v[48:51]
ds_write_b128 v68, v[72:75] offset:0
ds_write_b128 v68, v[72:75] offset:1024
ds_write_b128 v68, v[72:75] offset:2048
ds_write_b128 v68, v[72:75] offset:3072
ds_write_b128 v68, v[72:75] offset:4096
ds_write_b128 v68, v[72:75] offset:5120
ds_write_b128 v68, v[72:75] offset:6144
ds_write_b128 v68, v[72:75] offset:7168
ds_write_b128 v68, v[72:75] offset:8192
ds_write_b128 v68, v[72:75] offset:9216
ds_write_b128 v68, v[72:75] offset:10240
ds_write_b128 v68, v[72:75] offset:11264
ds_write_b128 v68, v[72:75] offset:12288
ds_write_b128 v68, v[72:75] offset:13312
ds_write_b128 v68, v[72:75] offset:14336
ds_write_b128 v68, v[72:75] offset:15360
ds_write_b128 v68, v[72:75] offset:16384
ds_write_b128 v68, v[72:75] offset:17408
ds_write_b128 v68, v[72:75] offset:18432
ds_write_b128 v68, v[72:75] offset:19456
v_lshl_add_u32 v32, v1, 2, v36
ds_write_b32 v32, v48 offset:20480
s_waitcnt vmcnt(16)
v_sub_u32 v32, v4, v5
s_waitcnt vmcnt(15)
v_cmpx_lt_i32 vcc, 0, v32
s_cbranch_execz LE_c
v_mad_u32_u16 v128, v192, 1, v7 op_sel:[1,0,0,0]
ds_add_u32 v128, v16
v_cmpx_lt_i32 vcc, 1, v32
v_mad_u32_u16 v129, v193, 1, v7 op_sel:[1,0,0,0]
ds_add_u32 v129, v16
v_cmpx_lt_i32 vcc, 2, v32
v_mad_u32_u16 v130, v194, 1, v7 op_sel:[1,0,0,0]
ds_add_u32 v130, v16
v_cmpx_lt_i32 vcc, 3, v32
v_mad_u32_u16 v131, v195, 1, v7 op_sel:[1,0,0,0]
ds_add_u32 v131, v16
s_waitcnt vmcnt(14)
v_cmpx_lt_i32 vcc, 16, v32
s_cbranch_execz LE_c
v_mad_u32_u16 v132, v196, 1, v7 op_sel:[1,0,0,0]
ds_add_u32 v132, v16
v_cmpx_lt_i32 vcc, 17, v32
v_mad_u32_u16 v133, v197, 1, v7 op_sel:[1,0,0,0]
ds_add_u32 v133, v16
v_cmpx_lt_i32 vcc, 18, v32
v_mad_u32_u16 v134, v198, 1, v7 op_sel:[1,0,0,0]
ds_add_u32 v134, v16
v_cmpx_lt_i32 vcc, 19, v32
v_mad_u32_u16 v135, v199, 1, v7 op_sel:[1,0,0,0]
ds_add_u32 v135, v16
s_waitcnt vmcnt(13)
v_cmpx_lt_i32 vcc, 32, v32
s_cbranch_execz LE_c
v_mad_u32_u16 v136, v200, 1, v7 op_sel:[1,0,0,0]
ds_add_u32 v136, v16
v_cmpx_lt_i32 vcc, 33, v32
v_mad_u32_u16 v137, v201, 1, v7 op_sel:[1,0,0,0]
ds_add_u32 v137, v16
v_cmpx_lt_i32 vcc, 34, v32
v_mad_u32_u16 v138, v202, 1, v7 op_sel:[1,0,0,0]
ds_add_u32 v138, v16
v_cmpx_lt_i32 vcc, 35, v32
v_mad_u32_u16 v139, v203, 1, v7 op_sel:[1,0,0,0]
ds_add_u32 v139, v16
s_waitcnt vmcnt(12)
v_cmpx_lt_i32 vcc, 48, v32
s_cbranch_execz LE_c
v_mad_u32_u16 v140, v204, 1, v7 op_sel:[1,0,0,0]
ds_add_u32 v140, v16
v_cmpx_lt_i32 vcc, 49, v32
v_mad_u32_u16 v141, v205, 1, v7 op_sel:[1,0,0,0]
ds_add_u32 v141, v16
v_cmpx_lt_i32 vcc, 50, v32
v_mad_u32_u16 v142, v206, 1, v7 op_sel:[1,0,0,0]
ds_add_u32 v142, v16
v_cmpx_lt_i32 vcc, 51, v32
v_mad_u32_u16 v143, v207, 1, v7 op_sel:[1,0,0,0]
ds_add_u32 v143, v16
s_waitcnt vmcnt(11)
v_cmpx_lt_i32 vcc, 64, v32
s_cbranch_execz LE_c
v_mad_u32_u16 v144, v208, 1, v7 op_sel:[1,0,0,0]
ds_add_u32 v144, v16
v_cmpx_lt_i32 vcc, 65, v32
v_mad_u32_u16 v145, v209, 1, v7 op_sel:[1,0,0,0]
ds_add_u32 v145, v16
v_cmpx_lt_i32 vcc, 66, v32
v_mad_u32_u16 v146, v210, 1, v7 op_sel:[1,0,0,0]
ds_add_u32 v146, v16
v_cmpx_lt_i32 vcc, 67, v32
v_mad_u32_u16 v147, v211, 1, v7 op_sel:[1,0,0,0]
ds_add_u32 v147, v16
s_waitcnt vmcnt(10)
v_cmpx_lt_i32 vcc, 80, v32
s_cbranch_execz LE_c
v_mad_u32_u16 v148, v212, 1, v7 op_sel:[1,0,0,0]
ds_add_u32 v148, v16
v_cmpx_lt_i32 vcc, 81, v32
v_mad_u32_u16 v149, v213, 1, v7 op_sel:[1,0,0,0]
ds_add_u32 v149, v16
v_cmpx_lt_i32 vcc, 82, v32
v_mad_u32_u16 v150, v214, 1, v7 op_sel:[1,0,0,0]
ds_add_u32 v150, v16
v_cmpx_lt_i32 vcc, 83, v32
v_mad_u32_u16 v151, v215, 1, v7 op_sel:[1,0,0,0]
ds_add_u32 v151, v16
s_waitcnt vmcnt(9)
v_cmpx_lt_i32 vcc, 96, v32
s_cbranch_execz LE_c
v_mad_u32_u16 v152, v216, 1, v7 op_sel:[1,0,0,0]
ds_add_u32 v152, v16
v_cmpx_lt_i32 vcc, 97, v32
v_mad_u32_u16 v153, v217, 1, v7 op_sel:[1,0,0,0]
ds_add_u32 v153, v16
v_cmpx_lt_i32 vcc, 98, v32
v_mad_u32_u16 v154, v218, 1, v7 op_sel:[1,0,0,0]
ds_add_u32 v154, v16
v_cmpx_lt_i32 vcc, 99, v32
v_mad_u32_u16 v155, v219, 1, v7 op_sel:[1,0,0,0]
ds_add_u32 v155, v16
s_waitcnt vmcnt(8)
v_cmpx_lt_i32 vcc, 112, v32
s_cbranch_execz LE_c
v_mad_u32_u16 v156, v220, 1, v7 op_sel:[1,0,0,0]
ds_add_u32 v156, v16
v_cmpx_lt_i32 vcc, 113, v32
v_mad_u32_u16 v157, v221, 1, v7 op_sel:[1,0,0,0]
ds_add_u32 v157, v16
v_cmpx_lt_i32 vcc, 114, v32
v_mad_u32_u16 v158, v222, 1, v7 op_sel:[1,0,0,0]
ds_add_u32 v158, v16
v_cmpx_lt_i32 vcc, 115, v32
v_mad_u32_u16 v159, v223, 1, v7 op_sel:[1,0,0,0]
ds_add_u32 v159, v16
s_waitcnt vmcnt(7)
v_cmpx_lt_i32 vcc, 128, v32
s_cbranch_execz LE_c
v_mad_u32_u16 v160, v224, 1, v7 op_sel:[1,0,0,0]
ds_add_u32 v160, v16
v_cmpx_lt_i32 vcc, 129, v32
v_mad_u32_u16 v161, v225, 1, v7 op_sel:[1,0,0,0]
ds_add_u32 v161, v16
v_cmpx_lt_i32 vcc, 130, v32
v_mad_u32_u16 v162, v226, 1, v7 op_sel:[1,0,0,0]
ds_add_u32 v162, v16
v_cmpx_lt_i32 vcc, 131, v32
v_mad_u32_u16 v163, v227, 1, v7 op_sel:[1,0,0,0]
ds_add_u32 v163, v16
s_waitcnt vmcnt(6)
v_cmpx_lt_i32 vcc, 144, v32
s_cbranch_execz LE_c
v_mad_u32_u16 v164, v228, 1, v7 op_sel:[1,0,0,0]
ds_add_u32 v164, v16
v_cmpx_lt_i32 vcc, 145, v32
v_mad_u32_u16 v165, v229, 1, v7 op_sel:[1,0,0,0]
ds_add_u32 v165, v16
v_cmpx_lt_i32 vcc, 146, v32
v_mad_u32_u16 v166, v230, 1, v7 op_sel:[1,0,0,0]
ds_add_u32 v166, v16
v_cmpx_lt_i32 vcc, 147, v32
v_mad_u32_u16 v167, v231, 1, v7 op_sel:[1,0,0,0]
ds_add_u32 v167, v16
s_waitcnt vmcnt(5)
v_cmpx_lt_i32 vcc, 160, v32
s_cbranch_execz LE_c
v_mad_u32_u16 v168, v232, 1, v7 op_sel:[1,0,0,0]
ds_add_u32 v168, v16
v_cmpx_lt_i32 vcc, 161, v32
v_mad_u32_u16 v169, v233, 1, v7 op_sel:[1,0,0,0]
ds_add_u32 v169, v16
v_cmpx_lt_i32 vcc, 162, v32
v_mad_u32_u16 v170, v234, 1, v7 op_sel:[1,0,0,0]
ds_add_u32 v170, v16
v_cmpx_lt_i32 vcc, 163, v32
v_mad_u32_u16 v171, v235, 1, v7 op_sel:[1,0,0,0]
ds_add_u32 v171, v16
s_waitcnt vmcnt(4)
v_cmpx_lt_i32 vcc, 176, v32
s_cbranch_execz LE_c
v_mad_u32_u16 v172, v236, 1, v7 op_sel:[1,0,0,0]
ds_add_u32 v172, v16
v_cmpx_lt_i32 vcc, 177, v32
v_mad_u32_u16 v173, v237, 1, v7 op_sel:[1,0,0,0]
ds_add_u32 v173, v16
v_cmpx_lt_i32 vcc, 178, v32
v_mad_u32_u16 v174, v238, 1, v7 op_sel:[1,0,0,0]
ds_add_u32 v174, v16
v_cmpx_lt_i32 vcc, 179, v32
v_mad_u32_u16 v175, v239, 1, v7 op_sel:[1,0,0,0]
ds_add_u32 v175, v16
s_waitcnt vmcnt(3)
v_cmpx_lt_i32 vcc, 192, v32
s_cbranch_execz LE_c
v_mad_u32_u16 v176, v240, 1, v7 op_sel:[1,0,0,0]
ds_add_u32 v176, v16
v_cmpx_lt_i32 vcc, 193, v32
v_mad_u32_u16 v177, v241, 1, v7 op_sel:[1,0,0,0]
ds_add_u32 v177, v16
v_cmpx_lt_i32 vcc, 194, v32
v_mad_u32_u16 v178, v242, 1, v7 op_sel:[1,0,0,0]
ds_add_u32 v178, v16
v_cmpx_lt_i32 vcc, 195, v32
v_mad_u32_u16 v179, v243, 1, v7 op_sel:[1,0,0,0]
ds_add_u32 v179, v16
s_waitcnt vmcnt(2)
v_cmpx_lt_i32 vcc, 208, v32
s_cbranch_execz LE_c
v_mad_u32_u16 v180, v244, 1, v7 op_sel:[1,0,0,0]
ds_add_u32 v180, v16
v_cmpx_lt_i32 vcc, 209, v32
v_mad_u32_u16 v181, v245, 1, v7 op_sel:[1,0,0,0]
ds_add_u32 v181, v16
v_cmpx_lt_i32 vcc, 210, v32
v_mad_u32_u16 v182, v246, 1, v7 op_sel:[1,0,0,0]
ds_add_u32 v182, v16
v_cmpx_lt_i32 vcc, 211, v32
v_mad_u32_u16 v183, v247, 1, v7 op_sel:[1,0,0,0]
ds_add_u32 v183, v16
s_waitcnt vmcnt(1)
v_cmpx_lt_i32 vcc, 224, v32
s_cbranch_execz LE_c
v_mad_u32_u16 v184, v248, 1, v7 op_sel:[1,0,0,0]
ds_add_u32 v184, v16
v_cmpx_lt_i32 vcc, 225, v32
v_mad_u32_u16 v185, v249, 1, v7 op_sel:[1,0,0,0]
ds_add_u32 v185, v16
v_cmpx_lt_i32 vcc, 226, v32
v_mad_u32_u16 v186, v250, 1, v7 op_sel:[1,0,0,0]
ds_add_u32 v186, v16
v_cmpx_lt_i32 vcc, 227, v32
v_mad_u32_u16 v187, v251, 1, v7 op_sel:[1,0,0,0]
ds_add_u32 v187, v16
s_waitcnt vmcnt(0)
v_cmpx_lt_i32 vcc, 240, v32
s_cbranch_execz LE_c
v_mad_u32_u16 v188, v252, 1, v7 op_sel:[1,0,0,0]
ds_add_u32 v188, v16
v_cmpx_lt_i32 vcc, 241, v32
v_mad_u32_u16 v189, v253, 1, v7 op_sel:[1,0,0,0]
ds_add_u32 v189, v16
v_cmpx_lt_i32 vcc, 242, v32
v_mad_u32_u16 v190, v254, 1, v7 op_sel:[1,0,0,0]
ds_add_u32 v190, v16
v_cmpx_lt_i32 vcc, 243, v32
v_mad_u32_u16 v191, v255, 1, v7 op_sel:[1,0,0,0]
ds_add_u32 v191, v16
LE_c:
s_mov_b64 exec, -1
ds_read_b128 v[24:27], v35
s_waitcnt lgkmcnt(0)
v_add_u32 v24, 3, v24
v_lshrrev_b32 v24, 2, v24
v_max_u32 v24, v24, v18
v_add_u32 v25, 3, v25
v_lshrrev_b32 v25, 2, v25
v_max_u32 v25, v25, v19
v_add_u32 v26, 3, v26
v_lshrrev_b32 v26, 2, v26
v_max_u32 v26, v26, v20
v_add_u32 v27, 3, v27
v_lshrrev_b32 v27, 2, v27
v_max_u32 v27, v27, v21
v_add_u32 v33, v24, v25
v_add3_u32 v33, v33, v26, v27
v_mov_b32 v64, v33
s_nop 1
v_add_u32_dpp v64, v64, v64 row_shr:1 row_mask:0xf bank_mask:0xf
s_nop 1
v_add_u32_dpp v64, v64, v64 row_shr:2 row_mask:0xf bank_mask:0xf
s_nop 1
v_add_u32_dpp v64, v64, v64 row_shr:4 row_mask:0xf bank_mask:0xf
s_nop 1
v_add_u32_dpp v64, v64, v64 row_shr:8 row_mask:0xf bank_mask:0xf
s_nop 1
v_add_u32_dpp v64, v64, v64 row_bcast:15 row_mask:0xa bank_mask:0xf
s_nop 1
v_add_u32_dpp v64, v64, v64 row_bcast:31 row_mask:0xc bank_mask:0xf
s_nop 1
v_readlane_b32 s44, v64, 63
v_sub_u32 v28, v64, v33
v_add_u32 v29, v28, v24
v_add_u32 v30, v29, v25
v_add_u32 v31, v30, v26
v_add3_u32 v33, v28, v24, -1
v_lshlrev_b32 v34, v33, v18
v_lshrrev_b32 v33, 5, v33
v_lshl_add_u32 v33, v33, 2, v36
ds_or_b32 v33, v34 offset:20480
v_lshl_add_u32 v28, v28, 4, v36
v_add3_u32 v33, v29, v25, -1
v_lshlrev_b32 v34, v33, v19
v_lshrrev_b32 v33, 5, v33
v_lshl_add_u32 v33, v33, 2, v36
ds_or_b32 v33, v34 offset:20480
v_lshl_add_u32 v29, v29, 4, v36
v_add3_u32 v33, v30, v26, -1
v_lshlrev_b32 v34, v33, v20
v_lshrrev_b32 v33, 5, v33
v_lshl_add_u32 v33, v33, 2, v36
ds_or_b32 v33, v34 offset:20480
v_lshl_add_u32 v30, v30, 4, v36
v_add3_u32 v33, v31, v27, -1
v_lshlrev_b32 v34, v33, v21
v_lshrrev_b32 v33, 5, v33
v_lshl_add_u32 v33, v33, 2, v36
ds_or_b32 v33, v34 offset:20480
v_lshl_add_u32 v31, v31, 4, v36
ds_write_b128 v35, v[28:31]
s_add_u32 s44, s44, 31
s_lshr_b32 s44, s44, 5
v_cmpx_lt_i32 vcc, 0, v32
s_cbranch_execz LE_p
ds_add_rtn_u32 v128, v128, v17
v_cmpx_lt_i32 vcc, 1, v32
ds_add_rtn_u32 v129, v129, v17
v_cmpx_lt_i32 vcc, 2, v32
ds_add_rtn_u32 v130, v130, v17
v_cmpx_lt_i32 vcc, 3, v32
ds_add_rtn_u32 v131, v131, v17
v_cmpx_lt_i32 vcc, 16, v32
s_cbranch_execz LE_p
ds_add_rtn_u32 v132, v132, v17
v_cmpx_lt_i32 vcc, 17, v32
ds_add_rtn_u32 v133, v133, v17
v_cmpx_lt_i32 vcc, 18, v32
ds_add_rtn_u32 v134, v134, v17
v_cmpx_lt_i32 vcc, 19, v32
ds_add_rtn_u32 v135, v135, v17
v_cmpx_lt_i32 vcc, 32, v32
s_cbranch_execz LE_p
ds_add_rtn_u32 v136, v136, v17
v_cmpx_lt_i32 vcc, 33, v32
ds_add_rtn_u32 v137, v137, v17
v_cmpx_lt_i32 vcc, 34, v32
ds_add_rtn_u32 v138, v138, v17
v_cmpx_lt_i32 vcc, 35, v32
ds_add_rtn_u32 v139, v139, v17
v_cmpx_lt_i32 vcc, 48, v32
s_cbranch_execz LE_p
ds_add_rtn_u32 v140, v140, v17
v_cmpx_lt_i32 vcc, 49, v32
ds_add_rtn_u32 v141, v141, v17
v_cmpx_lt_i32 vcc, 50, v32
ds_add_rtn_u32 v142, v142, v17
v_cmpx_lt_i32 vcc, 51, v32
ds_add_rtn_u32 v143, v143, v17
v_cmpx_lt_i32 vcc, 64, v32
s_cbranch_execz LE_p
ds_add_rtn_u32 v144, v144, v17
v_cmpx_lt_i32 vcc, 65, v32
ds_add_rtn_u32 v145, v145, v17
v_cmpx_lt_i32 vcc, 66, v32
ds_add_rtn_u32 v146, v146, v17
v_cmpx_lt_i32 vcc, 67, v32
ds_add_rtn_u32 v147, v147, v17
v_cmpx_lt_i32 vcc, 80, v32
s_cbranch_execz LE_p
ds_add_rtn_u32 v148, v148, v17
v_cmpx_lt_i32 vcc, 81, v32
ds_add_rtn_u32 v149, v149, v17
v_cmpx_lt_i32 vcc, 82, v32
ds_add_rtn_u32 v150, v150, v17
v_cmpx_lt_i32 vcc, 83, v32
ds_add_rtn_u32 v151, v151, v17
v_cmpx_lt_i32 vcc, 96, v32
s_cbranch_execz LE_p
ds_add_rtn_u32 v152, v152, v17
v_cmpx_lt_i32 vcc, 97, v32
ds_add_rtn_u32 v153, v153, v17
v_cmpx_lt_i32 vcc, 98, v32
ds_add_rtn_u32 v154, v154, v17
v_cmpx_lt_i32 vcc, 99, v32
ds_add_rtn_u32 v155, v155, v17
v_cmpx_lt_i32 vcc, 112, v32
s_cbranch_execz LE_p
ds_add_rtn_u32 v156, v156, v17
v_cmpx_lt_i32 vcc, 113, v32
ds_add_rtn_u32 v157, v157, v17
v_cmpx_lt_i32 vcc, 114, v32
ds_add_rtn_u32 v158, v158, v17
v_cmpx_lt_i32 vcc, 115, v32
ds_add_rtn_u32 v159, v159, v17
v_cmpx_lt_i32 vcc, 128, v32
s_cbranch_execz LE_p
ds_add_rtn_u32 v160, v160, v17
v_cmpx_lt_i32 vcc, 129, v32
ds_add_rtn_u32 v161, v161, v17
v_cmpx_lt_i32 vcc, 130, v32
ds_add_rtn_u32 v162, v162, v17
v_cmpx_lt_i32 vcc, 131, v32
ds_add_rtn_u32 v163, v163, v17
v_cmpx_lt_i32 vcc, 144, v32
s_cbranch_execz LE_p
ds_add_rtn_u32 v164, v164, v17
v_cmpx_lt_i32 vcc, 145, v32
ds_add_rtn_u32 v165, v165, v17
v_cmpx_lt_i32 vcc, 146, v32
ds_add_rtn_u32 v166, v166, v17
v_cmpx_lt_i32 vcc, 147, v32
ds_add_rtn_u32 v167, v167, v17
v_cmpx_lt_i32 vcc, 160, v32
s_cbranch_execz LE_p
ds_add_rtn_u32 v168, v168, v17
v_cmpx_lt_i32 vcc, 161, v32
ds_add_rtn_u32 v169, v169, v17
v_cmpx_lt_i32 vcc, 162, v32
ds_add_rtn_u32 v170, v170, v17
v_cmpx_lt_i32 vcc, 163, v32
ds_add_rtn_u32 v171, v171, v17
v_cmpx_lt_i32 vcc, 176, v32
s_cbranch_execz LE_p
ds_add_rtn_u32 v172, v172, v17
v_cmpx_lt_i32 vcc, 177, v32
ds_add_rtn_u32 v173, v173, v17
v_cmpx_lt_i32 vcc, 178, v32
ds_add_rtn_u32 v174, v174, v17
v_cmpx_lt_i32 vcc, 179, v32
ds_add_rtn_u32 v175, v175, v17
v_cmpx_lt_i32 vcc, 192, v32
s_cbranch_execz LE_p
ds_add_rtn_u32 v176, v176, v17
v_cmpx_lt_i32 vcc, 193, v32
ds_add_rtn_u32 v177, v177, v17
v_cmpx_lt_i32 vcc, 194, v32
ds_add_rtn_u32 v178, v178, v17
v_cmpx_lt_i32 vcc, 195, v32
ds_add_rtn_u32 v179, v179, v17
v_cmpx_lt_i32 vcc, 208, v32
s_cbranch_execz LE_p
ds_add_rtn_u32 v180, v180, v17
v_cmpx_lt_i32 vcc, 209, v32
ds_add_rtn_u32 v181, v181, v17
v_cmpx_lt_i32 vcc, 210, v32
ds_add_rtn_u32 v182, v182, v17
v_cmpx_lt_i32 vcc, 211, v32
ds_add_rtn_u32 v183, v183, v17
v_cmpx_lt_i32 vcc, 224, v32
s_cbranch_execz LE_p
ds_add_rtn_u32 v184, v184, v17
v_cmpx_lt_i32 vcc, 225, v32
ds_add_rtn_u32 v185, v185, v17
v_cmpx_lt_i32 vcc, 226, v32
ds_add_rtn_u32 v186, v186, v17
v_cmpx_lt_i32 vcc, 227, v32
ds_add_rtn_u32 v187, v187, v17
v_cmpx_lt_i32 vcc, 240, v32
s_cbranch_execz LE_p
ds_add_rtn_u32 v188, v188, v17
v_cmpx_lt_i32 vcc, 241, v32
ds_add_rtn_u32 v189, v189, v17
v_cmpx_lt_i32 vcc, 242, v32
ds_add_rtn_u32 v190, v190, v17
v_cmpx_lt_i32 vcc, 243, v32
ds_add_rtn_u32 v191, v191, v17
LE_p:
s_mov_b64 exec, -1
v_lshl_add_u32 v33, v1, 2, v36
ds_read_b32 v37, v33 offset:20480
s_waitcnt lgkmcnt(0)
v_cmpx_lt_i32 vcc, 0, v32
s_cbranch_execz LE_w
ds_write_b32 v128, v192
v_cmpx_lt_i32 vcc, 1, v32
ds_write_b32 v129, v193
v_cmpx_lt_i32 vcc, 2, v32
ds_write_b32 v130, v194
v_cmpx_lt_i32 vcc, 3, v32
ds_write_b32 v131, v195
v_cmpx_lt_i32 vcc, 16, v32
s_cbranch_execz LE_w
ds_write_b32 v132, v196
v_cmpx_lt_i32 vcc, 17, v32
ds_write_b32 v133, v197
v_cmpx_lt_i32 vcc, 18, v32
ds_write_b32 v134, v198
v_cmpx_lt_i32 vcc, 19, v32
ds_write_b32 v135, v199
v_cmpx_lt_i32 vcc, 32, v32
s_cbranch_execz LE_w
ds_write_b32 v136, v200
v_cmpx_lt_i32 vcc, 33, v32
ds_write_b32 v137, v201
v_cmpx_lt_i32 vcc, 34, v32
ds_write_b32 v138, v202
v_cmpx_lt_i32 vcc, 35, v32
ds_write_b32 v139, v203
v_cmpx_lt_i32 vcc, 48, v32
s_cbranch_execz LE_w
ds_write_b32 v140, v204
v_cmpx_lt_i32 vcc, 49, v32
ds_write_b32 v141, v205
v_cmpx_lt_i32 vcc, 50, v32
ds_write_b32 v142, v206
v_cmpx_lt_i32 vcc, 51, v32
ds_write_b32 v143, v207
v_cmpx_lt_i32 vcc, 64, v32
s_cbranch_execz LE_w
ds_write_b32 v144, v208
v_cmpx_lt_i32 vcc, 65, v32
ds_write_b32 v145, v209
v_cmpx_lt_i32 vcc, 66, v32
ds_write_b32 v146, v210
v_cmpx_lt_i32 vcc, 67, v32
ds_write_b32 v147, v211
v_cmpx_lt_i32 vcc, 80, v32
s_cbranch_execz LE_w
ds_write_b32 v148, v212
v_cmpx_lt_i32 vcc, 81, v32
ds_write_b32 v149, v213
v_cmpx_lt_i32 vcc, 82, v32
ds_write_b32 v150, v214
v_cmpx_lt_i32 vcc, 83, v32
ds_write_b32 v151, v215
v_cmpx_lt_i32 vcc, 96, v32
s_cbranch_execz LE_w
ds_write_b32 v152, v216
v_cmpx_lt_i32 vcc, 97, v32
ds_write_b32 v153, v217
v_cmpx_lt_i32 vcc, 98, v32
ds_write_b32 v154, v218
v_cmpx_lt_i32 vcc, 99, v32
ds_write_b32 v155, v219
v_cmpx_lt_i32 vcc, 112, v32
s_cbranch_execz LE_w
ds_write_b32 v156, v220
v_cmpx_lt_i32 vcc, 113, v32
ds_write_b32 v157, v221
v_cmpx_lt_i32 vcc, 114, v32
ds_write_b32 v158, v222
v_cmpx_lt_i32 vcc, 115, v32
ds_write_b32 v159, v223
v_cmpx_lt_i32 vcc, 128, v32
s_cbranch_execz LE_w
ds_write_b32 v160, v224
v_cmpx_lt_i32 vcc, 129, v32
ds_write_b32 v161, v225
v_cmpx_lt_i32 vcc, 130, v32
ds_write_b32 v162, v226
v_cmpx_lt_i32 vcc, 131, v32
ds_write_b32 v163, v227
v_cmpx_lt_i32 vcc, 144, v32
s_cbranch_execz LE_w
ds_write_b32 v164, v228
v_cmpx_lt_i32 vcc, 145, v32
ds_write_b32 v165, v229
v_cmpx_lt_i32 vcc, 146, v32
ds_write_b32 v166, v230
v_cmpx_lt_i32 vcc, 147, v32
ds_write_b32 v167, v231
v_cmpx_lt_i32 vcc, 160, v32
s_cbranch_execz LE_w
ds_write_b32 v168, v232
v_cmpx_lt_i32 vcc, 161, v32
ds_write_b32 v169, v233
v_cmpx_lt_i32 vcc, 162, v32
ds_write_b32 v170, v234
v_cmpx_lt_i32 vcc, 163, v32
ds_write_b32 v171, v235
v_cmpx_lt_i32 vcc, 176, v32
s_cbranch_execz LE_w
ds_write_b32 v172, v236
v_cmpx_lt_i32 vcc, 177, v32
ds_write_b32 v173, v237
v_cmpx_lt_i32 vcc, 178, v32
ds_write_b32 v174, v238
v_cmpx_lt_i32 vcc, 179, v32
ds_write_b32 v175, v239
v_cmpx_lt_i32 vcc, 192, v32
s_cbranch_execz LE_w
ds_write_b32 v176, v240
v_cmpx_lt_i32 vcc, 193, v32
ds_write_b32 v177, v241
v_cmpx_lt_i32 vcc, 194, v32
ds_write_b32 v178, v242
v_cmpx_lt_i32 vcc, 195, v32
ds_write_b32 v179, v243
v_cmpx_lt_i32 vcc, 208, v32
s_cbranch_execz LE_w
ds_write_b32 v180, v244
v_cmpx_lt_i32 vcc, 209, v32
ds_write_b32 v181, v245
v_cmpx_lt_i32 vcc, 210, v32
ds_write_b32 v182, v246
v_cmpx_lt_i32 vcc, 211, v32
ds_write_b32 v183, v247
v_cmpx_lt_i32 vcc, 224, v32
s_cbranch_execz LE_w
ds_write_b32 v184, v248
v_cmpx_lt_i32 vcc, 225, v32
ds_write_b32 v185, v249
v_cmpx_lt_i32 vcc, 226, v32
ds_write_b32 v186, v250
v_cmpx_lt_i32 vcc, 227, v32
ds_write_b32 v187, v251
v_cmpx_lt_i32 vcc, 240, v32
s_cbranch_execz LE_w
ds_write_b32 v188, v252
v_cmpx_lt_i32 vcc, 241, v32
ds_write_b32 v189, v253
v_cmpx_lt_i32 vcc, 242, v32
ds_write_b32 v190, v254
v_cmpx_lt_i32 vcc, 243, v32
ds_write_b32 v191, v255
LE_w:
s_mov_b64 exec, -1
v_mov_b32 v34, v38
ds_read2_b32 v[52:53], v34 offset0:0 offset1:4
ds_read2_b32 v[54:55], v34 offset0:8 offset1:12
s_waitcnt lgkmcnt(0)
ds_read2_b32 v[56:57], v34 offset0:16 offset1:20
ds_read2_b32 v[58:59], v34 offset0:24 offset1:28
v_mad_u32_u16 v60, v52, s49, v2
v_mad_u32_u16 v61, v53, s49, v2
v_mad_u32_u16 v62, v54, s49, v2
v_mad_u32_u16 v63, v55, s49, v2
buffer_load_dwordx4 a[0:3], v60, s[16:19], 0 offen sc1
buffer_load_dwordx4 a[4:7], v60, s[16:19], 0 offen offset:256 sc1
buffer_load_dwordx4 a[8:11], v61, s[16:19], 0 offen sc1
buffer_load_dwordx4 a[12:15], v61, s[16:19], 0 offen offset:256 sc1
buffer_load_dwordx4 a[16:19], v62, s[16:19], 0 offen sc1
buffer_load_dwordx4 a[20:23], v62, s[16:19], 0 offen offset:256 sc1
buffer_load_dwordx4 a[24:27], v63, s[16:19], 0 offen sc1
buffer_load_dwordx4 a[28:31], v63, s[16:19], 0 offen offset:256 sc1
s_waitcnt lgkmcnt(0)
ds_read2_b32 v[52:53], v34 offset0:32 offset1:36
ds_read2_b32 v[54:55], v34 offset0:40 offset1:44
v_mad_u32_u16 v60, v56, s49, v2
v_mad_u32_u16 v61, v57, s49, v2
v_mad_u32_u16 v62, v58, s49, v2
v_mad_u32_u16 v63, v59, s49, v2
buffer_load_dwordx4 a[32:35], v60, s[16:19], 0 offen sc1
buffer_load_dwordx4 a[36:39], v60, s[16:19], 0 offen offset:256 sc1
buffer_load_dwordx4 a[40:43], v61, s[16:19], 0 offen sc1
buffer_load_dwordx4 a[44:47], v61, s[16:19], 0 offen offset:256 sc1
buffer_load_dwordx4 a[48:51], v62, s[16:19], 0 offen sc1
buffer_load_dwordx4 a[52:55], v62, s[16:19], 0 offen offset:256 sc1
buffer_load_dwordx4 a[56:59], v63, s[16:19], 0 offen sc1
buffer_load_dwordx4 a[60:63], v63, s[16:19], 0 offen offset:256 sc1
s_waitcnt lgkmcnt(0)
ds_read2_b32 v[56:57], v34 offset0:48 offset1:52
ds_read2_b32 v[58:59], v34 offset0:56 offset1:60
v_mad_u32_u16 v60, v52, s49, v2
v_mad_u32_u16 v61, v53, s49, v2
v_mad_u32_u16 v62, v54, s49, v2
v_mad_u32_u16 v63, v55, s49, v2
buffer_load_dwordx4 a[64:67], v60, s[16:19], 0 offen sc1
buffer_load_dwordx4 a[68:71], v60, s[16:19], 0 offen offset:256 sc1
buffer_load_dwordx4 a[72:75], v61, s[16:19], 0 offen sc1
buffer_load_dwordx4 a[76:79], v61, s[16:19], 0 offen offset:256 sc1
buffer_load_dwordx4 a[80:83], v62, s[16:19], 0 offen sc1
buffer_load_dwordx4 a[84:87], v62, s[16:19], 0 offen offset:256 sc1
buffer_load_dwordx4 a[88:91], v63, s[16:19], 0 offen sc1
buffer_load_dwordx4 a[92:95], v63, s[16:19], 0 offen offset:256 sc1
s_waitcnt lgkmcnt(0)
ds_read2_b32 v[52:53], v34 offset0:64 offset1:68
ds_read2_b32 v[54:55], v34 offset0:72 offset1:76
v_mad_u32_u16 v60, v56, s49, v2
v_mad_u32_u16 v61, v57, s49, v2
v_mad_u32_u16 v62, v58, s49, v2
v_mad_u32_u16 v63, v59, s49, v2
buffer_load_dwordx4 a[96:99], v60, s[16:19], 0 offen sc1
buffer_load_dwordx4 a[100:103], v60, s[16:19], 0 offen offset:256 sc1
buffer_load_dwordx4 a[104:107], v61, s[16:19], 0 offen sc1
buffer_load_dwordx4 a[108:111], v61, s[16:19], 0 offen offset:256 sc1
buffer_load_dwordx4 a[112:115], v62, s[16:19], 0 offen sc1
buffer_load_dwordx4 a[116:119], v62, s[16:19], 0 offen offset:256 sc1
buffer_load_dwordx4 a[120:123], v63, s[16:19], 0 offen sc1
buffer_load_dwordx4 a[124:127], v63, s[16:19], 0 offen offset:256 sc1
s_waitcnt lgkmcnt(0)
ds_read2_b32 v[56:57], v34 offset0:80 offset1:84
ds_read2_b32 v[58:59], v34 offset0:88 offset1:92
v_mad_u32_u16 v60, v52, s49, v2
v_mad_u32_u16 v61, v53, s49, v2
v_mad_u32_u16 v62, v54, s49, v2
v_mad_u32_u16 v63, v55, s49, v2
buffer_load_dwordx4 a[128:131], v60, s[16:19], 0 offen sc1
buffer_load_dwordx4 a[132:135], v60, s[16:19], 0 offen offset:256 sc1
buffer_load_dwordx4 a[136:139], v61, s[16:19], 0 offen sc1
buffer_load_dwordx4 a[140:143], v61, s[16:19], 0 offen offset:256 sc1
buffer_load_dwordx4 a[144:147], v62, s[16:19], 0 offen sc1
buffer_load_dwordx4 a[148:151], v62, s[16:19], 0 offen offset:256 sc1
buffer_load_dwordx4 a[152:155], v63, s[16:19], 0 offen sc1
buffer_load_dwordx4 a[156:159], v63, s[16:19], 0 offen offset:256 sc1
s_waitcnt lgkmcnt(0)
ds_read2_b32 v[52:53], v34 offset0:96 offset1:100
ds_read2_b32 v[54:55], v34 offset0:104 offset1:108
v_mad_u32_u16 v60, v56, s49, v2
v_mad_u32_u16 v61, v57, s49, v2
v_mad_u32_u16 v62, v58, s49, v2
v_mad_u32_u16 v63, v59, s49, v2
buffer_load_dwordx4 a[160:163], v60, s[16:19], 0 offen sc1
buffer_load_dwordx4 a[164:167], v60, s[16:19], 0 offen offset:256 sc1
buffer_load_dwordx4 a[168:171], v61, s[16:19], 0 offen sc1
buffer_load_dwordx4 a[172:175], v61, s[16:19], 0 offen offset:256 sc1
buffer_load_dwordx4 a[176:179], v62, s[16:19], 0 offen sc1
buffer_load_dwordx4 a[180:183], v62, s[16:19], 0 offen offset:256 sc1
buffer_load_dwordx4 a[184:187], v63, s[16:19], 0 offen sc1
buffer_load_dwordx4 a[188:191], v63, s[16:19], 0 offen offset:256 sc1
s_waitcnt lgkmcnt(0)
ds_read2_b32 v[56:57], v34 offset0:112 offset1:116
ds_read2_b32 v[58:59], v34 offset0:120 offset1:124
v_mad_u32_u16 v60, v52, s49, v2
v_mad_u32_u16 v61, v53, s49, v2
v_mad_u32_u16 v62, v54, s49, v2
v_mad_u32_u16 v63, v55, s49, v2
buffer_load_dwordx4 a[192:195], v60, s[16:19], 0 offen sc1
buffer_load_dwordx4 a[196:199], v60, s[16:19], 0 offen offset:256 sc1
buffer_load_dwordx4 a[200:203], v61, s[16:19], 0 offen sc1
buffer_load_dwordx4 a[204:207], v61, s[16:19], 0 offen offset:256 sc1
buffer_load_dwordx4 a[208:211], v62, s[16:19], 0 offen sc1
buffer_load_dwordx4 a[212:215], v62, s[16:19], 0 offen offset:256 sc1
buffer_load_dwordx4 a[216:219], v63, s[16:19], 0 offen sc1
buffer_load_dwordx4 a[220:223], v63, s[16:19], 0 offen offset:256 sc1
s_waitcnt lgkmcnt(0)
ds_read2_b32 v[52:53], v34 offset0:128 offset1:132
ds_read2_b32 v[54:55], v34 offset0:136 offset1:140
v_mad_u32_u16 v60, v56, s49, v2
v_mad_u32_u16 v61, v57, s49, v2
v_mad_u32_u16 v62, v58, s49, v2
v_mad_u32_u16 v63, v59, s49, v2
buffer_load_dwordx4 a[224:227], v60, s[16:19], 0 offen sc1
buffer_load_dwordx4 a[228:231], v60, s[16:19], 0 offen offset:256 sc1
buffer_load_dwordx4 a[232:235], v61, s[16:19], 0 offen sc1
buffer_load_dwordx4 a[236:239], v61, s[16:19], 0 offen offset:256 sc1
buffer_load_dwordx4 a[240:243], v62, s[16:19], 0 offen sc1
buffer_load_dwordx4 a[244:247], v62, s[16:19], 0 offen offset:256 sc1
buffer_load_dwordx4 a[248:251], v63, s[16:19], 0 offen sc1
buffer_load_dwordx4 a[252:255], v63, s[16:19], 0 offen offset:256 sc1
v_add_u32 v34, 512, v34
s_mov_b32 s45, 0
s_lshl_b32 s47, s55, 9
LE_loop:
v_readlane_b32 s46, v37, s45
s_add_u32 s45, s45, 1
s_waitcnt vmcnt(56)
v_mfma_f32_16x16x32_bf16 v[48:51], a[0:3], v[40:43], v[48:51]
v_mfma_f32_16x16x32_bf16 v[48:51], a[4:7], v[44:47], v[48:51]
s_bitcmp1_b32 s46, 0
s_cbranch_scc0 LE_nf0
s_cmp_eq_u32 s42, 0
s_cbranch_scc1 LE_fl0
buffer_load_dwordx2 v[66:67], v39, s[20:23], s47 offen sc1
s_waitcnt vmcnt(0)
v_lshlrev_b32 v64, 16, v66
v_and_b32 v65, 0xffff0000, v66
v_add_f32 v48, v48, v64
v_add_f32 v49, v49, v65
v_lshlrev_b32 v64, 16, v67
v_and_b32 v65, 0xffff0000, v67
v_add_f32 v50, v50, v64
v_add_f32 v51, v51, v65
LE_fl0:
s_nop 3
v_cvt_pk_bf16_f32 v64, v48, v49
v_cvt_pk_bf16_f32 v65, v50, v51
v_mov_b32 v48, 0
v_mov_b32 v49, 0
v_mov_b32 v50, 0
v_mov_b32 v51, 0
buffer_store_dwordx2 v[64:65], v39, s[20:23], s47 offen sc1
s_add_u32 s47, s47, 512
LE_nf0:
v_mfma_f32_16x16x32_bf16 v[48:51], a[8:11], v[40:43], v[48:51]
v_mfma_f32_16x16x32_bf16 v[48:51], a[12:15], v[44:47], v[48:51]
s_bitcmp1_b32 s46, 1
s_cbranch_scc0 LE_nf1
s_cmp_eq_u32 s42, 0
s_cbranch_scc1 LE_fl1
buffer_load_dwordx2 v[66:67], v39, s[20:23], s47 offen sc1
s_waitcnt vmcnt(0)
v_lshlrev_b32 v64, 16, v66
v_and_b32 v65, 0xffff0000, v66
v_add_f32 v48, v48, v64
v_add_f32 v49, v49, v65
v_lshlrev_b32 v64, 16, v67
v_and_b32 v65, 0xffff0000, v67
v_add_f32 v50, v50, v64
v_add_f32 v51, v51, v65
LE_fl1:
s_nop 3
v_cvt_pk_bf16_f32 v64, v48, v49
v_cvt_pk_bf16_f32 v65, v50, v51
v_mov_b32 v48, 0
v_mov_b32 v49, 0
v_mov_b32 v50, 0
v_mov_b32 v51, 0
buffer_store_dwordx2 v[64:65], v39, s[20:23], s47 offen sc1
s_add_u32 s47, s47, 512
LE_nf1:
v_mfma_f32_16x16x32_bf16 v[48:51], a[16:19], v[40:43], v[48:51]
v_mfma_f32_16x16x32_bf16 v[48:51], a[20:23], v[44:47], v[48:51]
s_bitcmp1_b32 s46, 2
s_cbranch_scc0 LE_nf2
s_cmp_eq_u32 s42, 0
s_cbranch_scc1 LE_fl2
buffer_load_dwordx2 v[66:67], v39, s[20:23], s47 offen sc1
s_waitcnt vmcnt(0)
v_lshlrev_b32 v64, 16, v66
v_and_b32 v65, 0xffff0000, v66
v_add_f32 v48, v48, v64
v_add_f32 v49, v49, v65
v_lshlrev_b32 v64, 16, v67
v_and_b32 v65, 0xffff0000, v67
v_add_f32 v50, v50, v64
v_add_f32 v51, v51, v65
LE_fl2:
s_nop 3
v_cvt_pk_bf16_f32 v64, v48, v49
v_cvt_pk_bf16_f32 v65, v50, v51
v_mov_b32 v48, 0
v_mov_b32 v49, 0
v_mov_b32 v50, 0
v_mov_b32 v51, 0
buffer_store_dwordx2 v[64:65], v39, s[20:23], s47 offen sc1
s_add_u32 s47, s47, 512
LE_nf2:
v_mfma_f32_16x16x32_bf16 v[48:51], a[24:27], v[40:43], v[48:51]
v_mfma_f32_16x16x32_bf16 v[48:51], a[28:31], v[44:47], v[48:51]
s_bitcmp1_b32 s46, 3
s_cbranch_scc0 LE_nf3
s_cmp_eq_u32 s42, 0
s_cbranch_scc1 LE_fl3
buffer_load_dwordx2 v[66:67], v39, s[20:23], s47 offen sc1
s_waitcnt vmcnt(0)
v_lshlrev_b32 v64, 16, v66
v_and_b32 v65, 0xffff0000, v66
v_add_f32 v48, v48, v64
v_add_f32 v49, v49, v65
v_lshlrev_b32 v64, 16, v67
v_and_b32 v65, 0xffff0000, v67
v_add_f32 v50, v50, v64
v_add_f32 v51, v51, v65
LE_fl3:
s_nop 3
v_cvt_pk_bf16_f32 v64, v48, v49
v_cvt_pk_bf16_f32 v65, v50, v51
v_mov_b32 v48, 0
v_mov_b32 v49, 0
v_mov_b32 v50, 0
v_mov_b32 v51, 0
buffer_store_dwordx2 v[64:65], v39, s[20:23], s47 offen sc1
s_add_u32 s47, s47, 512
LE_nf3:
s_waitcnt lgkmcnt(0)
ds_read2_b32 v[56:57], v34 offset0:16 offset1:20
ds_read2_b32 v[58:59], v34 offset0:24 offset1:28
v_mad_u32_u16 v60, v52, s49, v2
v_mad_u32_u16 v61, v53, s49, v2
v_mad_u32_u16 v62, v54, s49, v2
v_mad_u32_u16 v63, v55, s49, v2
buffer_load_dwordx4 a[0:3], v60, s[16:19], 0 offen sc1
buffer_load_dwordx4 a[4:7], v60, s[16:19], 0 offen offset:256 sc1
buffer_load_dwordx4 a[8:11], v61, s[16:19], 0 offen sc1
buffer_load_dwordx4 a[12:15], v61, s[16:19], 0 offen offset:256 sc1
buffer_load_dwordx4 a[16:19], v62, s[16:19], 0 offen sc1
buffer_load_dwordx4 a[20:23], v62, s[16:19], 0 offen offset:256 sc1
buffer_load_dwordx4 a[24:27], v63, s[16:19], 0 offen sc1
buffer_load_dwordx4 a[28:31], v63, s[16:19], 0 offen offset:256 sc1
s_waitcnt vmcnt(56)
v_mfma_f32_16x16x32_bf16 v[48:51], a[32:35], v[40:43], v[48:51]
v_mfma_f32_16x16x32_bf16 v[48:51], a[36:39], v[44:47], v[48:51]
s_bitcmp1_b32 s46, 4
s_cbranch_scc0 LE_nf4
s_cmp_eq_u32 s42, 0
s_cbranch_scc1 LE_fl4
buffer_load_dwordx2 v[66:67], v39, s[20:23], s47 offen sc1
s_waitcnt vmcnt(0)
v_lshlrev_b32 v64, 16, v66
v_and_b32 v65, 0xffff0000, v66
v_add_f32 v48, v48, v64
v_add_f32 v49, v49, v65
v_lshlrev_b32 v64, 16, v67
v_and_b32 v65, 0xffff0000, v67
v_add_f32 v50, v50, v64
v_add_f32 v51, v51, v65
LE_fl4:
s_nop 3
v_cvt_pk_bf16_f32 v64, v48, v49
v_cvt_pk_bf16_f32 v65, v50, v51
v_mov_b32 v48, 0
v_mov_b32 v49, 0
v_mov_b32 v50, 0
v_mov_b32 v51, 0
buffer_store_dwordx2 v[64:65], v39, s[20:23], s47 offen sc1
s_add_u32 s47, s47, 512
LE_nf4:
v_mfma_f32_16x16x32_bf16 v[48:51], a[40:43], v[40:43], v[48:51]
v_mfma_f32_16x16x32_bf16 v[48:51], a[44:47], v[44:47], v[48:51]
s_bitcmp1_b32 s46, 5
s_cbranch_scc0 LE_nf5
s_cmp_eq_u32 s42, 0
s_cbranch_scc1 LE_fl5
buffer_load_dwordx2 v[66:67], v39, s[20:23], s47 offen sc1
s_waitcnt vmcnt(0)
v_lshlrev_b32 v64, 16, v66
v_and_b32 v65, 0xffff0000, v66
v_add_f32 v48, v48, v64
v_add_f32 v49, v49, v65
v_lshlrev_b32 v64, 16, v67
v_and_b32 v65, 0xffff0000, v67
v_add_f32 v50, v50, v64
v_add_f32 v51, v51, v65
LE_fl5:
s_nop 3
v_cvt_pk_bf16_f32 v64, v48, v49
v_cvt_pk_bf16_f32 v65, v50, v51
v_mov_b32 v48, 0
v_mov_b32 v49, 0
v_mov_b32 v50, 0
v_mov_b32 v51, 0
buffer_store_dwordx2 v[64:65], v39, s[20:23], s47 offen sc1
s_add_u32 s47, s47, 512
LE_nf5:
v_mfma_f32_16x16x32_bf16 v[48:51], a[48:51], v[40:43], v[48:51]
v_mfma_f32_16x16x32_bf16 v[48:51], a[52:55], v[44:47], v[48:51]
s_bitcmp1_b32 s46, 6
s_cbranch_scc0 LE_nf6
s_cmp_eq_u32 s42, 0
s_cbranch_scc1 LE_fl6
buffer_load_dwordx2 v[66:67], v39, s[20:23], s47 offen sc1
s_waitcnt vmcnt(0)
v_lshlrev_b32 v64, 16, v66
v_and_b32 v65, 0xffff0000, v66
v_add_f32 v48, v48, v64
v_add_f32 v49, v49, v65
v_lshlrev_b32 v64, 16, v67
v_and_b32 v65, 0xffff0000, v67
v_add_f32 v50, v50, v64
v_add_f32 v51, v51, v65
LE_fl6:
s_nop 3
v_cvt_pk_bf16_f32 v64, v48, v49
v_cvt_pk_bf16_f32 v65, v50, v51
v_mov_b32 v48, 0
v_mov_b32 v49, 0
v_mov_b32 v50, 0
v_mov_b32 v51, 0
buffer_store_dwordx2 v[64:65], v39, s[20:23], s47 offen sc1
s_add_u32 s47, s47, 512
LE_nf6:
v_mfma_f32_16x16x32_bf16 v[48:51], a[56:59], v[40:43], v[48:51]
v_mfma_f32_16x16x32_bf16 v[48:51], a[60:63], v[44:47], v[48:51]
s_bitcmp1_b32 s46, 7
s_cbranch_scc0 LE_nf7
s_cmp_eq_u32 s42, 0
s_cbranch_scc1 LE_fl7
buffer_load_dwordx2 v[66:67], v39, s[20:23], s47 offen sc1
s_waitcnt vmcnt(0)
v_lshlrev_b32 v64, 16, v66
v_and_b32 v65, 0xffff0000, v66
v_add_f32 v48, v48, v64
v_add_f32 v49, v49, v65
v_lshlrev_b32 v64, 16, v67
v_and_b32 v65, 0xffff0000, v67
v_add_f32 v50, v50, v64
v_add_f32 v51, v51, v65
LE_fl7:
s_nop 3
v_cvt_pk_bf16_f32 v64, v48, v49
v_cvt_pk_bf16_f32 v65, v50, v51
v_mov_b32 v48, 0
v_mov_b32 v49, 0
v_mov_b32 v50, 0
v_mov_b32 v51, 0
buffer_store_dwordx2 v[64:65], v39, s[20:23], s47 offen sc1
s_add_u32 s47, s47, 512
LE_nf7:
s_waitcnt lgkmcnt(0)
ds_read2_b32 v[52:53], v34 offset0:32 offset1:36
ds_read2_b32 v[54:55], v34 offset0:40 offset1:44
v_mad_u32_u16 v60, v56, s49, v2
v_mad_u32_u16 v61, v57, s49, v2
v_mad_u32_u16 v62, v58, s49, v2
v_mad_u32_u16 v63, v59, s49, v2
buffer_load_dwordx4 a[32:35], v60, s[16:19], 0 offen sc1
buffer_load_dwordx4 a[36:39], v60, s[16:19], 0 offen offset:256 sc1
buffer_load_dwordx4 a[40:43], v61, s[16:19], 0 offen sc1
buffer_load_dwordx4 a[44:47], v61, s[16:19], 0 offen offset:256 sc1
buffer_load_dwordx4 a[48:51], v62, s[16:19], 0 offen sc1
buffer_load_dwordx4 a[52:55], v62, s[16:19], 0 offen offset:256 sc1
buffer_load_dwordx4 a[56:59], v63, s[16:19], 0 offen sc1
buffer_load_dwordx4 a[60:63], v63, s[16:19], 0 offen offset:256 sc1
s_waitcnt vmcnt(56)
v_mfma_f32_16x16x32_bf16 v[48:51], a[64:67], v[40:43], v[48:51]
v_mfma_f32_16x16x32_bf16 v[48:51], a[68:71], v[44:47], v[48:51]
s_bitcmp1_b32 s46, 8
s_cbranch_scc0 LE_nf8
s_cmp_eq_u32 s42, 0
s_cbranch_scc1 LE_fl8
buffer_load_dwordx2 v[66:67], v39, s[20:23], s47 offen sc1
s_waitcnt vmcnt(0)
v_lshlrev_b32 v64, 16, v66
v_and_b32 v65, 0xffff0000, v66
v_add_f32 v48, v48, v64
v_add_f32 v49, v49, v65
v_lshlrev_b32 v64, 16, v67
v_and_b32 v65, 0xffff0000, v67
v_add_f32 v50, v50, v64
v_add_f32 v51, v51, v65
LE_fl8:
s_nop 3
v_cvt_pk_bf16_f32 v64, v48, v49
v_cvt_pk_bf16_f32 v65, v50, v51
v_mov_b32 v48, 0
v_mov_b32 v49, 0
v_mov_b32 v50, 0
v_mov_b32 v51, 0
buffer_store_dwordx2 v[64:65], v39, s[20:23], s47 offen sc1
s_add_u32 s47, s47, 512
LE_nf8:
v_mfma_f32_16x16x32_bf16 v[48:51], a[72:75], v[40:43], v[48:51]
v_mfma_f32_16x16x32_bf16 v[48:51], a[76:79], v[44:47], v[48:51]
s_bitcmp1_b32 s46, 9
s_cbranch_scc0 LE_nf9
s_cmp_eq_u32 s42, 0
s_cbranch_scc1 LE_fl9
buffer_load_dwordx2 v[66:67], v39, s[20:23], s47 offen sc1
s_waitcnt vmcnt(0)
v_lshlrev_b32 v64, 16, v66
v_and_b32 v65, 0xffff0000, v66
v_add_f32 v48, v48, v64
v_add_f32 v49, v49, v65
v_lshlrev_b32 v64, 16, v67
v_and_b32 v65, 0xffff0000, v67
v_add_f32 v50, v50, v64
v_add_f32 v51, v51, v65
LE_fl9:
s_nop 3
v_cvt_pk_bf16_f32 v64, v48, v49
v_cvt_pk_bf16_f32 v65, v50, v51
v_mov_b32 v48, 0
v_mov_b32 v49, 0
v_mov_b32 v50, 0
v_mov_b32 v51, 0
buffer_store_dwordx2 v[64:65], v39, s[20:23], s47 offen sc1
s_add_u32 s47, s47, 512
LE_nf9:
v_mfma_f32_16x16x32_bf16 v[48:51], a[80:83], v[40:43], v[48:51]
v_mfma_f32_16x16x32_bf16 v[48:51], a[84:87], v[44:47], v[48:51]
s_bitcmp1_b32 s46, 10
s_cbranch_scc0 LE_nf10
s_cmp_eq_u32 s42, 0
s_cbranch_scc1 LE_fl10
buffer_load_dwordx2 v[66:67], v39, s[20:23], s47 offen sc1
s_waitcnt vmcnt(0)
v_lshlrev_b32 v64, 16, v66
v_and_b32 v65, 0xffff0000, v66
v_add_f32 v48, v48, v64
v_add_f32 v49, v49, v65
v_lshlrev_b32 v64, 16, v67
v_and_b32 v65, 0xffff0000, v67
v_add_f32 v50, v50, v64
v_add_f32 v51, v51, v65
LE_fl10:
s_nop 3
v_cvt_pk_bf16_f32 v64, v48, v49
v_cvt_pk_bf16_f32 v65, v50, v51
v_mov_b32 v48, 0
v_mov_b32 v49, 0
v_mov_b32 v50, 0
v_mov_b32 v51, 0
buffer_store_dwordx2 v[64:65], v39, s[20:23], s47 offen sc1
s_add_u32 s47, s47, 512
LE_nf10:
v_mfma_f32_16x16x32_bf16 v[48:51], a[88:91], v[40:43], v[48:51]
v_mfma_f32_16x16x32_bf16 v[48:51], a[92:95], v[44:47], v[48:51]
s_bitcmp1_b32 s46, 11
s_cbranch_scc0 LE_nf11
s_cmp_eq_u32 s42, 0
s_cbranch_scc1 LE_fl11
buffer_load_dwordx2 v[66:67], v39, s[20:23], s47 offen sc1
s_waitcnt vmcnt(0)
v_lshlrev_b32 v64, 16, v66
v_and_b32 v65, 0xffff0000, v66
v_add_f32 v48, v48, v64
v_add_f32 v49, v49, v65
v_lshlrev_b32 v64, 16, v67
v_and_b32 v65, 0xffff0000, v67
v_add_f32 v50, v50, v64
v_add_f32 v51, v51, v65
LE_fl11:
s_nop 3
v_cvt_pk_bf16_f32 v64, v48, v49
v_cvt_pk_bf16_f32 v65, v50, v51
v_mov_b32 v48, 0
v_mov_b32 v49, 0
v_mov_b32 v50, 0
v_mov_b32 v51, 0
buffer_store_dwordx2 v[64:65], v39, s[20:23], s47 offen sc1
s_add_u32 s47, s47, 512
LE_nf11:
s_waitcnt lgkmcnt(0)
ds_read2_b32 v[56:57], v34 offset0:48 offset1:52
ds_read2_b32 v[58:59], v34 offset0:56 offset1:60
v_mad_u32_u16 v60, v52, s49, v2
v_mad_u32_u16 v61, v53, s49, v2
v_mad_u32_u16 v62, v54, s49, v2
v_mad_u32_u16 v63, v55, s49, v2
buffer_load_dwordx4 a[64:67], v60, s[16:19], 0 offen sc1
buffer_load_dwordx4 a[68:71], v60, s[16:19], 0 offen offset:256 sc1
buffer_load_dwordx4 a[72:75], v61, s[16:19], 0 offen sc1
buffer_load_dwordx4 a[76:79], v61, s[16:19], 0 offen offset:256 sc1
buffer_load_dwordx4 a[80:83], v62, s[16:19], 0 offen sc1
buffer_load_dwordx4 a[84:87], v62, s[16:19], 0 offen offset:256 sc1
buffer_load_dwordx4 a[88:91], v63, s[16:19], 0 offen sc1
buffer_load_dwordx4 a[92:95], v63, s[16:19], 0 offen offset:256 sc1
s_waitcnt vmcnt(56)
v_mfma_f32_16x16x32_bf16 v[48:51], a[96:99], v[40:43], v[48:51]
v_mfma_f32_16x16x32_bf16 v[48:51], a[100:103], v[44:47], v[48:51]
s_bitcmp1_b32 s46, 12
s_cbranch_scc0 LE_nf12
s_cmp_eq_u32 s42, 0
s_cbranch_scc1 LE_fl12
buffer_load_dwordx2 v[66:67], v39, s[20:23], s47 offen sc1
s_waitcnt vmcnt(0)
v_lshlrev_b32 v64, 16, v66
v_and_b32 v65, 0xffff0000, v66
v_add_f32 v48, v48, v64
v_add_f32 v49, v49, v65
v_lshlrev_b32 v64, 16, v67
v_and_b32 v65, 0xffff0000, v67
v_add_f32 v50, v50, v64
v_add_f32 v51, v51, v65
LE_fl12:
s_nop 3
v_cvt_pk_bf16_f32 v64, v48, v49
v_cvt_pk_bf16_f32 v65, v50, v51
v_mov_b32 v48, 0
v_mov_b32 v49, 0
v_mov_b32 v50, 0
v_mov_b32 v51, 0
buffer_store_dwordx2 v[64:65], v39, s[20:23], s47 offen sc1
s_add_u32 s47, s47, 512
LE_nf12:
v_mfma_f32_16x16x32_bf16 v[48:51], a[104:107], v[40:43], v[48:51]
v_mfma_f32_16x16x32_bf16 v[48:51], a[108:111], v[44:47], v[48:51]
s_bitcmp1_b32 s46, 13
s_cbranch_scc0 LE_nf13
s_cmp_eq_u32 s42, 0
s_cbranch_scc1 LE_fl13
buffer_load_dwordx2 v[66:67], v39, s[20:23], s47 offen sc1
s_waitcnt vmcnt(0)
v_lshlrev_b32 v64, 16, v66
v_and_b32 v65, 0xffff0000, v66
v_add_f32 v48, v48, v64
v_add_f32 v49, v49, v65
v_lshlrev_b32 v64, 16, v67
v_and_b32 v65, 0xffff0000, v67
v_add_f32 v50, v50, v64
v_add_f32 v51, v51, v65
LE_fl13:
s_nop 3
v_cvt_pk_bf16_f32 v64, v48, v49
v_cvt_pk_bf16_f32 v65, v50, v51
v_mov_b32 v48, 0
v_mov_b32 v49, 0
v_mov_b32 v50, 0
v_mov_b32 v51, 0
buffer_store_dwordx2 v[64:65], v39, s[20:23], s47 offen sc1
s_add_u32 s47, s47, 512
LE_nf13:
v_mfma_f32_16x16x32_bf16 v[48:51], a[112:115], v[40:43], v[48:51]
v_mfma_f32_16x16x32_bf16 v[48:51], a[116:119], v[44:47], v[48:51]
s_bitcmp1_b32 s46, 14
s_cbranch_scc0 LE_nf14
s_cmp_eq_u32 s42, 0
s_cbranch_scc1 LE_fl14
buffer_load_dwordx2 v[66:67], v39, s[20:23], s47 offen sc1
s_waitcnt vmcnt(0)
v_lshlrev_b32 v64, 16, v66
v_and_b32 v65, 0xffff0000, v66
v_add_f32 v48, v48, v64
v_add_f32 v49, v49, v65
v_lshlrev_b32 v64, 16, v67
v_and_b32 v65, 0xffff0000, v67
v_add_f32 v50, v50, v64
v_add_f32 v51, v51, v65
LE_fl14:
s_nop 3
v_cvt_pk_bf16_f32 v64, v48, v49
v_cvt_pk_bf16_f32 v65, v50, v51
v_mov_b32 v48, 0
v_mov_b32 v49, 0
v_mov_b32 v50, 0
v_mov_b32 v51, 0
buffer_store_dwordx2 v[64:65], v39, s[20:23], s47 offen sc1
s_add_u32 s47, s47, 512
LE_nf14:
v_mfma_f32_16x16x32_bf16 v[48:51], a[120:123], v[40:43], v[48:51]
v_mfma_f32_16x16x32_bf16 v[48:51], a[124:127], v[44:47], v[48:51]
s_bitcmp1_b32 s46, 15
s_cbranch_scc0 LE_nf15
s_cmp_eq_u32 s42, 0
s_cbranch_scc1 LE_fl15
buffer_load_dwordx2 v[66:67], v39, s[20:23], s47 offen sc1
s_waitcnt vmcnt(0)
v_lshlrev_b32 v64, 16, v66
v_and_b32 v65, 0xffff0000, v66
v_add_f32 v48, v48, v64
v_add_f32 v49, v49, v65
v_lshlrev_b32 v64, 16, v67
v_and_b32 v65, 0xffff0000, v67
v_add_f32 v50, v50, v64
v_add_f32 v51, v51, v65
LE_fl15:
s_nop 3
v_cvt_pk_bf16_f32 v64, v48, v49
v_cvt_pk_bf16_f32 v65, v50, v51
v_mov_b32 v48, 0
v_mov_b32 v49, 0
v_mov_b32 v50, 0
v_mov_b32 v51, 0
buffer_store_dwordx2 v[64:65], v39, s[20:23], s47 offen sc1
s_add_u32 s47, s47, 512
LE_nf15:
s_waitcnt lgkmcnt(0)
ds_read2_b32 v[52:53], v34 offset0:64 offset1:68
ds_read2_b32 v[54:55], v34 offset0:72 offset1:76
v_mad_u32_u16 v60, v56, s49, v2
v_mad_u32_u16 v61, v57, s49, v2
v_mad_u32_u16 v62, v58, s49, v2
v_mad_u32_u16 v63, v59, s49, v2
buffer_load_dwordx4 a[96:99], v60, s[16:19], 0 offen sc1
buffer_load_dwordx4 a[100:103], v60, s[16:19], 0 offen offset:256 sc1
buffer_load_dwordx4 a[104:107], v61, s[16:19], 0 offen sc1
buffer_load_dwordx4 a[108:111], v61, s[16:19], 0 offen offset:256 sc1
buffer_load_dwordx4 a[112:115], v62, s[16:19], 0 offen sc1
buffer_load_dwordx4 a[116:119], v62, s[16:19], 0 offen offset:256 sc1
buffer_load_dwordx4 a[120:123], v63, s[16:19], 0 offen sc1
buffer_load_dwordx4 a[124:127], v63, s[16:19], 0 offen offset:256 sc1
s_waitcnt vmcnt(56)
v_mfma_f32_16x16x32_bf16 v[48:51], a[128:131], v[40:43], v[48:51]
v_mfma_f32_16x16x32_bf16 v[48:51], a[132:135], v[44:47], v[48:51]
s_bitcmp1_b32 s46, 16
s_cbranch_scc0 LE_nf16
s_cmp_eq_u32 s42, 0
s_cbranch_scc1 LE_fl16
buffer_load_dwordx2 v[66:67], v39, s[20:23], s47 offen sc1
s_waitcnt vmcnt(0)
v_lshlrev_b32 v64, 16, v66
v_and_b32 v65, 0xffff0000, v66
v_add_f32 v48, v48, v64
v_add_f32 v49, v49, v65
v_lshlrev_b32 v64, 16, v67
v_and_b32 v65, 0xffff0000, v67
v_add_f32 v50, v50, v64
v_add_f32 v51, v51, v65
LE_fl16:
s_nop 3
v_cvt_pk_bf16_f32 v64, v48, v49
v_cvt_pk_bf16_f32 v65, v50, v51
v_mov_b32 v48, 0
v_mov_b32 v49, 0
v_mov_b32 v50, 0
v_mov_b32 v51, 0
buffer_store_dwordx2 v[64:65], v39, s[20:23], s47 offen sc1
s_add_u32 s47, s47, 512
LE_nf16:
v_mfma_f32_16x16x32_bf16 v[48:51], a[136:139], v[40:43], v[48:51]
v_mfma_f32_16x16x32_bf16 v[48:51], a[140:143], v[44:47], v[48:51]
s_bitcmp1_b32 s46, 17
s_cbranch_scc0 LE_nf17
s_cmp_eq_u32 s42, 0
s_cbranch_scc1 LE_fl17
buffer_load_dwordx2 v[66:67], v39, s[20:23], s47 offen sc1
s_waitcnt vmcnt(0)
v_lshlrev_b32 v64, 16, v66
v_and_b32 v65, 0xffff0000, v66
v_add_f32 v48, v48, v64
v_add_f32 v49, v49, v65
v_lshlrev_b32 v64, 16, v67
v_and_b32 v65, 0xffff0000, v67
v_add_f32 v50, v50, v64
v_add_f32 v51, v51, v65
LE_fl17:
s_nop 3
v_cvt_pk_bf16_f32 v64, v48, v49
v_cvt_pk_bf16_f32 v65, v50, v51
v_mov_b32 v48, 0
v_mov_b32 v49, 0
v_mov_b32 v50, 0
v_mov_b32 v51, 0
buffer_store_dwordx2 v[64:65], v39, s[20:23], s47 offen sc1
s_add_u32 s47, s47, 512
LE_nf17:
v_mfma_f32_16x16x32_bf16 v[48:51], a[144:147], v[40:43], v[48:51]
v_mfma_f32_16x16x32_bf16 v[48:51], a[148:151], v[44:47], v[48:51]
s_bitcmp1_b32 s46, 18
s_cbranch_scc0 LE_nf18
s_cmp_eq_u32 s42, 0
s_cbranch_scc1 LE_fl18
buffer_load_dwordx2 v[66:67], v39, s[20:23], s47 offen sc1
s_waitcnt vmcnt(0)
v_lshlrev_b32 v64, 16, v66
v_and_b32 v65, 0xffff0000, v66
v_add_f32 v48, v48, v64
v_add_f32 v49, v49, v65
v_lshlrev_b32 v64, 16, v67
v_and_b32 v65, 0xffff0000, v67
v_add_f32 v50, v50, v64
v_add_f32 v51, v51, v65
LE_fl18:
s_nop 3
v_cvt_pk_bf16_f32 v64, v48, v49
v_cvt_pk_bf16_f32 v65, v50, v51
v_mov_b32 v48, 0
v_mov_b32 v49, 0
v_mov_b32 v50, 0
v_mov_b32 v51, 0
buffer_store_dwordx2 v[64:65], v39, s[20:23], s47 offen sc1
s_add_u32 s47, s47, 512
LE_nf18:
v_mfma_f32_16x16x32_bf16 v[48:51], a[152:155], v[40:43], v[48:51]
v_mfma_f32_16x16x32_bf16 v[48:51], a[156:159], v[44:47], v[48:51]
s_bitcmp1_b32 s46, 19
s_cbranch_scc0 LE_nf19
s_cmp_eq_u32 s42, 0
s_cbranch_scc1 LE_fl19
buffer_load_dwordx2 v[66:67], v39, s[20:23], s47 offen sc1
s_waitcnt vmcnt(0)
v_lshlrev_b32 v64, 16, v66
v_and_b32 v65, 0xffff0000, v66
v_add_f32 v48, v48, v64
v_add_f32 v49, v49, v65
v_lshlrev_b32 v64, 16, v67
v_and_b32 v65, 0xffff0000, v67
v_add_f32 v50, v50, v64
v_add_f32 v51, v51, v65
LE_fl19:
s_nop 3
v_cvt_pk_bf16_f32 v64, v48, v49
v_cvt_pk_bf16_f32 v65, v50, v51
v_mov_b32 v48, 0
v_mov_b32 v49, 0
v_mov_b32 v50, 0
v_mov_b32 v51, 0
buffer_store_dwordx2 v[64:65], v39, s[20:23], s47 offen sc1
s_add_u32 s47, s47, 512
LE_nf19:
s_waitcnt lgkmcnt(0)
ds_read2_b32 v[56:57], v34 offset0:80 offset1:84
ds_read2_b32 v[58:59], v34 offset0:88 offset1:92
v_mad_u32_u16 v60, v52, s49, v2
v_mad_u32_u16 v61, v53, s49, v2
v_mad_u32_u16 v62, v54, s49, v2
v_mad_u32_u16 v63, v55, s49, v2
buffer_load_dwordx4 a[128:131], v60, s[16:19], 0 offen sc1
buffer_load_dwordx4 a[132:135], v60, s[16:19], 0 offen offset:256 sc1
buffer_load_dwordx4 a[136:139], v61, s[16:19], 0 offen sc1
buffer_load_dwordx4 a[140:143], v61, s[16:19], 0 offen offset:256 sc1
buffer_load_dwordx4 a[144:147], v62, s[16:19], 0 offen sc1
buffer_load_dwordx4 a[148:151], v62, s[16:19], 0 offen offset:256 sc1
buffer_load_dwordx4 a[152:155], v63, s[16:19], 0 offen sc1
buffer_load_dwordx4 a[156:159], v63, s[16:19], 0 offen offset:256 sc1
s_waitcnt vmcnt(56)
v_mfma_f32_16x16x32_bf16 v[48:51], a[160:163], v[40:43], v[48:51]
v_mfma_f32_16x16x32_bf16 v[48:51], a[164:167], v[44:47], v[48:51]
s_bitcmp1_b32 s46, 20
s_cbranch_scc0 LE_nf20
s_cmp_eq_u32 s42, 0
s_cbranch_scc1 LE_fl20
buffer_load_dwordx2 v[66:67], v39, s[20:23], s47 offen sc1
s_waitcnt vmcnt(0)
v_lshlrev_b32 v64, 16, v66
v_and_b32 v65, 0xffff0000, v66
v_add_f32 v48, v48, v64
v_add_f32 v49, v49, v65
v_lshlrev_b32 v64, 16, v67
v_and_b32 v65, 0xffff0000, v67
v_add_f32 v50, v50, v64
v_add_f32 v51, v51, v65
LE_fl20:
s_nop 3
v_cvt_pk_bf16_f32 v64, v48, v49
v_cvt_pk_bf16_f32 v65, v50, v51
v_mov_b32 v48, 0
v_mov_b32 v49, 0
v_mov_b32 v50, 0
v_mov_b32 v51, 0
buffer_store_dwordx2 v[64:65], v39, s[20:23], s47 offen sc1
s_add_u32 s47, s47, 512
LE_nf20:
v_mfma_f32_16x16x32_bf16 v[48:51], a[168:171], v[40:43], v[48:51]
v_mfma_f32_16x16x32_bf16 v[48:51], a[172:175], v[44:47], v[48:51]
s_bitcmp1_b32 s46, 21
s_cbranch_scc0 LE_nf21
s_cmp_eq_u32 s42, 0
s_cbranch_scc1 LE_fl21
buffer_load_dwordx2 v[66:67], v39, s[20:23], s47 offen sc1
s_waitcnt vmcnt(0)
v_lshlrev_b32 v64, 16, v66
v_and_b32 v65, 0xffff0000, v66
v_add_f32 v48, v48, v64
v_add_f32 v49, v49, v65
v_lshlrev_b32 v64, 16, v67
v_and_b32 v65, 0xffff0000, v67
v_add_f32 v50, v50, v64
v_add_f32 v51, v51, v65
LE_fl21:
s_nop 3
v_cvt_pk_bf16_f32 v64, v48, v49
v_cvt_pk_bf16_f32 v65, v50, v51
v_mov_b32 v48, 0
v_mov_b32 v49, 0
v_mov_b32 v50, 0
v_mov_b32 v51, 0
buffer_store_dwordx2 v[64:65], v39, s[20:23], s47 offen sc1
s_add_u32 s47, s47, 512
LE_nf21:
v_mfma_f32_16x16x32_bf16 v[48:51], a[176:179], v[40:43], v[48:51]
v_mfma_f32_16x16x32_bf16 v[48:51], a[180:183], v[44:47], v[48:51]
s_bitcmp1_b32 s46, 22
s_cbranch_scc0 LE_nf22
s_cmp_eq_u32 s42, 0
s_cbranch_scc1 LE_fl22
buffer_load_dwordx2 v[66:67], v39, s[20:23], s47 offen sc1
s_waitcnt vmcnt(0)
v_lshlrev_b32 v64, 16, v66
v_and_b32 v65, 0xffff0000, v66
v_add_f32 v48, v48, v64
v_add_f32 v49, v49, v65
v_lshlrev_b32 v64, 16, v67
v_and_b32 v65, 0xffff0000, v67
v_add_f32 v50, v50, v64
v_add_f32 v51, v51, v65
LE_fl22:
s_nop 3
v_cvt_pk_bf16_f32 v64, v48, v49
v_cvt_pk_bf16_f32 v65, v50, v51
v_mov_b32 v48, 0
v_mov_b32 v49, 0
v_mov_b32 v50, 0
v_mov_b32 v51, 0
buffer_store_dwordx2 v[64:65], v39, s[20:23], s47 offen sc1
s_add_u32 s47, s47, 512
LE_nf22:
v_mfma_f32_16x16x32_bf16 v[48:51], a[184:187], v[40:43], v[48:51]
v_mfma_f32_16x16x32_bf16 v[48:51], a[188:191], v[44:47], v[48:51]
s_bitcmp1_b32 s46, 23
s_cbranch_scc0 LE_nf23
s_cmp_eq_u32 s42, 0
s_cbranch_scc1 LE_fl23
buffer_load_dwordx2 v[66:67], v39, s[20:23], s47 offen sc1
s_waitcnt vmcnt(0)
v_lshlrev_b32 v64, 16, v66
v_and_b32 v65, 0xffff0000, v66
v_add_f32 v48, v48, v64
v_add_f32 v49, v49, v65
v_lshlrev_b32 v64, 16, v67
v_and_b32 v65, 0xffff0000, v67
v_add_f32 v50, v50, v64
v_add_f32 v51, v51, v65
LE_fl23:
s_nop 3
v_cvt_pk_bf16_f32 v64, v48, v49
v_cvt_pk_bf16_f32 v65, v50, v51
v_mov_b32 v48, 0
v_mov_b32 v49, 0
v_mov_b32 v50, 0
v_mov_b32 v51, 0
buffer_store_dwordx2 v[64:65], v39, s[20:23], s47 offen sc1
s_add_u32 s47, s47, 512
LE_nf23:
s_waitcnt lgkmcnt(0)
ds_read2_b32 v[52:53], v34 offset0:96 offset1:100
ds_read2_b32 v[54:55], v34 offset0:104 offset1:108
v_mad_u32_u16 v60, v56, s49, v2
v_mad_u32_u16 v61, v57, s49, v2
v_mad_u32_u16 v62, v58, s49, v2
v_mad_u32_u16 v63, v59, s49, v2
buffer_load_dwordx4 a[160:163], v60, s[16:19], 0 offen sc1
buffer_load_dwordx4 a[164:167], v60, s[16:19], 0 offen offset:256 sc1
buffer_load_dwordx4 a[168:171], v61, s[16:19], 0 offen sc1
buffer_load_dwordx4 a[172:175], v61, s[16:19], 0 offen offset:256 sc1
buffer_load_dwordx4 a[176:179], v62, s[16:19], 0 offen sc1
buffer_load_dwordx4 a[180:183], v62, s[16:19], 0 offen offset:256 sc1
buffer_load_dwordx4 a[184:187], v63, s[16:19], 0 offen sc1
buffer_load_dwordx4 a[188:191], v63, s[16:19], 0 offen offset:256 sc1
s_waitcnt vmcnt(56)
v_mfma_f32_16x16x32_bf16 v[48:51], a[192:195], v[40:43], v[48:51]
v_mfma_f32_16x16x32_bf16 v[48:51], a[196:199], v[44:47], v[48:51]
s_bitcmp1_b32 s46, 24
s_cbranch_scc0 LE_nf24
s_cmp_eq_u32 s42, 0
s_cbranch_scc1 LE_fl24
buffer_load_dwordx2 v[66:67], v39, s[20:23], s47 offen sc1
s_waitcnt vmcnt(0)
v_lshlrev_b32 v64, 16, v66
v_and_b32 v65, 0xffff0000, v66
v_add_f32 v48, v48, v64
v_add_f32 v49, v49, v65
v_lshlrev_b32 v64, 16, v67
v_and_b32 v65, 0xffff0000, v67
v_add_f32 v50, v50, v64
v_add_f32 v51, v51, v65
LE_fl24:
s_nop 3
v_cvt_pk_bf16_f32 v64, v48, v49
v_cvt_pk_bf16_f32 v65, v50, v51
v_mov_b32 v48, 0
v_mov_b32 v49, 0
v_mov_b32 v50, 0
v_mov_b32 v51, 0
buffer_store_dwordx2 v[64:65], v39, s[20:23], s47 offen sc1
s_add_u32 s47, s47, 512
LE_nf24:
v_mfma_f32_16x16x32_bf16 v[48:51], a[200:203], v[40:43], v[48:51]
v_mfma_f32_16x16x32_bf16 v[48:51], a[204:207], v[44:47], v[48:51]
s_bitcmp1_b32 s46, 25
s_cbranch_scc0 LE_nf25
s_cmp_eq_u32 s42, 0
s_cbranch_scc1 LE_fl25
buffer_load_dwordx2 v[66:67], v39, s[20:23], s47 offen sc1
s_waitcnt vmcnt(0)
v_lshlrev_b32 v64, 16, v66
v_and_b32 v65, 0xffff0000, v66
v_add_f32 v48, v48, v64
v_add_f32 v49, v49, v65
v_lshlrev_b32 v64, 16, v67
v_and_b32 v65, 0xffff0000, v67
v_add_f32 v50, v50, v64
v_add_f32 v51, v51, v65
LE_fl25:
s_nop 3
v_cvt_pk_bf16_f32 v64, v48, v49
v_cvt_pk_bf16_f32 v65, v50, v51
v_mov_b32 v48, 0
v_mov_b32 v49, 0
v_mov_b32 v50, 0
v_mov_b32 v51, 0
buffer_store_dwordx2 v[64:65], v39, s[20:23], s47 offen sc1
s_add_u32 s47, s47, 512
LE_nf25:
v_mfma_f32_16x16x32_bf16 v[48:51], a[208:211], v[40:43], v[48:51]
v_mfma_f32_16x16x32_bf16 v[48:51], a[212:215], v[44:47], v[48:51]
s_bitcmp1_b32 s46, 26
s_cbranch_scc0 LE_nf26
s_cmp_eq_u32 s42, 0
s_cbranch_scc1 LE_fl26
buffer_load_dwordx2 v[66:67], v39, s[20:23], s47 offen sc1
s_waitcnt vmcnt(0)
v_lshlrev_b32 v64, 16, v66
v_and_b32 v65, 0xffff0000, v66
v_add_f32 v48, v48, v64
v_add_f32 v49, v49, v65
v_lshlrev_b32 v64, 16, v67
v_and_b32 v65, 0xffff0000, v67
v_add_f32 v50, v50, v64
v_add_f32 v51, v51, v65
LE_fl26:
s_nop 3
v_cvt_pk_bf16_f32 v64, v48, v49
v_cvt_pk_bf16_f32 v65, v50, v51
v_mov_b32 v48, 0
v_mov_b32 v49, 0
v_mov_b32 v50, 0
v_mov_b32 v51, 0
buffer_store_dwordx2 v[64:65], v39, s[20:23], s47 offen sc1
s_add_u32 s47, s47, 512
LE_nf26:
v_mfma_f32_16x16x32_bf16 v[48:51], a[216:219], v[40:43], v[48:51]
v_mfma_f32_16x16x32_bf16 v[48:51], a[220:223], v[44:47], v[48:51]
s_bitcmp1_b32 s46, 27
s_cbranch_scc0 LE_nf27
s_cmp_eq_u32 s42, 0
s_cbranch_scc1 LE_fl27
buffer_load_dwordx2 v[66:67], v39, s[20:23], s47 offen sc1
s_waitcnt vmcnt(0)
v_lshlrev_b32 v64, 16, v66
v_and_b32 v65, 0xffff0000, v66
v_add_f32 v48, v48, v64
v_add_f32 v49, v49, v65
v_lshlrev_b32 v64, 16, v67
v_and_b32 v65, 0xffff0000, v67
v_add_f32 v50, v50, v64
v_add_f32 v51, v51, v65
LE_fl27:
s_nop 3
v_cvt_pk_bf16_f32 v64, v48, v49
v_cvt_pk_bf16_f32 v65, v50, v51
v_mov_b32 v48, 0
v_mov_b32 v49, 0
v_mov_b32 v50, 0
v_mov_b32 v51, 0
buffer_store_dwordx2 v[64:65], v39, s[20:23], s47 offen sc1
s_add_u32 s47, s47, 512
LE_nf27:
s_waitcnt lgkmcnt(0)
ds_read2_b32 v[56:57], v34 offset0:112 offset1:116
ds_read2_b32 v[58:59], v34 offset0:120 offset1:124
v_mad_u32_u16 v60, v52, s49, v2
v_mad_u32_u16 v61, v53, s49, v2
v_mad_u32_u16 v62, v54, s49, v2
v_mad_u32_u16 v63, v55, s49, v2
buffer_load_dwordx4 a[192:195], v60, s[16:19], 0 offen sc1
buffer_load_dwordx4 a[196:199], v60, s[16:19], 0 offen offset:256 sc1
buffer_load_dwordx4 a[200:203], v61, s[16:19], 0 offen sc1
buffer_load_dwordx4 a[204:207], v61, s[16:19], 0 offen offset:256 sc1
buffer_load_dwordx4 a[208:211], v62, s[16:19], 0 offen sc1
buffer_load_dwordx4 a[212:215], v62, s[16:19], 0 offen offset:256 sc1
buffer_load_dwordx4 a[216:219], v63, s[16:19], 0 offen sc1
buffer_load_dwordx4 a[220:223], v63, s[16:19], 0 offen offset:256 sc1
s_waitcnt vmcnt(56)
v_mfma_f32_16x16x32_bf16 v[48:51], a[224:227], v[40:43], v[48:51]
v_mfma_f32_16x16x32_bf16 v[48:51], a[228:231], v[44:47], v[48:51]
s_bitcmp1_b32 s46, 28
s_cbranch_scc0 LE_nf28
s_cmp_eq_u32 s42, 0
s_cbranch_scc1 LE_fl28
buffer_load_dwordx2 v[66:67], v39, s[20:23], s47 offen sc1
s_waitcnt vmcnt(0)
v_lshlrev_b32 v64, 16, v66
v_and_b32 v65, 0xffff0000, v66
v_add_f32 v48, v48, v64
v_add_f32 v49, v49, v65
v_lshlrev_b32 v64, 16, v67
v_and_b32 v65, 0xffff0000, v67
v_add_f32 v50, v50, v64
v_add_f32 v51, v51, v65
LE_fl28:
s_nop 3
v_cvt_pk_bf16_f32 v64, v48, v49
v_cvt_pk_bf16_f32 v65, v50, v51
v_mov_b32 v48, 0
v_mov_b32 v49, 0
v_mov_b32 v50, 0
v_mov_b32 v51, 0
buffer_store_dwordx2 v[64:65], v39, s[20:23], s47 offen sc1
s_add_u32 s47, s47, 512
LE_nf28:
v_mfma_f32_16x16x32_bf16 v[48:51], a[232:235], v[40:43], v[48:51]
v_mfma_f32_16x16x32_bf16 v[48:51], a[236:239], v[44:47], v[48:51]
s_bitcmp1_b32 s46, 29
s_cbranch_scc0 LE_nf29
s_cmp_eq_u32 s42, 0
s_cbranch_scc1 LE_fl29
buffer_load_dwordx2 v[66:67], v39, s[20:23], s47 offen sc1
s_waitcnt vmcnt(0)
v_lshlrev_b32 v64, 16, v66
v_and_b32 v65, 0xffff0000, v66
v_add_f32 v48, v48, v64
v_add_f32 v49, v49, v65
v_lshlrev_b32 v64, 16, v67
v_and_b32 v65, 0xffff0000, v67
v_add_f32 v50, v50, v64
v_add_f32 v51, v51, v65
LE_fl29:
s_nop 3
v_cvt_pk_bf16_f32 v64, v48, v49
v_cvt_pk_bf16_f32 v65, v50, v51
v_mov_b32 v48, 0
v_mov_b32 v49, 0
v_mov_b32 v50, 0
v_mov_b32 v51, 0
buffer_store_dwordx2 v[64:65], v39, s[20:23], s47 offen sc1
s_add_u32 s47, s47, 512
LE_nf29:
v_mfma_f32_16x16x32_bf16 v[48:51], a[240:243], v[40:43], v[48:51]
v_mfma_f32_16x16x32_bf16 v[48:51], a[244:247], v[44:47], v[48:51]
s_bitcmp1_b32 s46, 30
s_cbranch_scc0 LE_nf30
s_cmp_eq_u32 s42, 0
s_cbranch_scc1 LE_fl30
buffer_load_dwordx2 v[66:67], v39, s[20:23], s47 offen sc1
s_waitcnt vmcnt(0)
v_lshlrev_b32 v64, 16, v66
v_and_b32 v65, 0xffff0000, v66
v_add_f32 v48, v48, v64
v_add_f32 v49, v49, v65
v_lshlrev_b32 v64, 16, v67
v_and_b32 v65, 0xffff0000, v67
v_add_f32 v50, v50, v64
v_add_f32 v51, v51, v65
LE_fl30:
s_nop 3
v_cvt_pk_bf16_f32 v64, v48, v49
v_cvt_pk_bf16_f32 v65, v50, v51
v_mov_b32 v48, 0
v_mov_b32 v49, 0
v_mov_b32 v50, 0
v_mov_b32 v51, 0
buffer_store_dwordx2 v[64:65], v39, s[20:23], s47 offen sc1
s_add_u32 s47, s47, 512
LE_nf30:
v_mfma_f32_16x16x32_bf16 v[48:51], a[248:251], v[40:43], v[48:51]
v_mfma_f32_16x16x32_bf16 v[48:51], a[252:255], v[44:47], v[48:51]
s_bitcmp1_b32 s46, 31
s_cbranch_scc0 LE_nf31
s_cmp_eq_u32 s42, 0
s_cbranch_scc1 LE_fl31
buffer_load_dwordx2 v[66:67], v39, s[20:23], s47 offen sc1
s_waitcnt vmcnt(0)
v_lshlrev_b32 v64, 16, v66
v_and_b32 v65, 0xffff0000, v66
v_add_f32 v48, v48, v64
v_add_f32 v49, v49, v65
v_lshlrev_b32 v64, 16, v67
v_and_b32 v65, 0xffff0000, v67
v_add_f32 v50, v50, v64
v_add_f32 v51, v51, v65
LE_fl31:
s_nop 3
v_cvt_pk_bf16_f32 v64, v48, v49
v_cvt_pk_bf16_f32 v65, v50, v51
v_mov_b32 v48, 0
v_mov_b32 v49, 0
v_mov_b32 v50, 0
v_mov_b32 v51, 0
buffer_store_dwordx2 v[64:65], v39, s[20:23], s47 offen sc1
s_add_u32 s47, s47, 512
LE_nf31:
s_waitcnt lgkmcnt(0)
ds_read2_b32 v[52:53], v34 offset0:128 offset1:132
ds_read2_b32 v[54:55], v34 offset0:136 offset1:140
v_mad_u32_u16 v60, v56, s49, v2
v_mad_u32_u16 v61, v57, s49, v2
v_mad_u32_u16 v62, v58, s49, v2
v_mad_u32_u16 v63, v59, s49, v2
buffer_load_dwordx4 a[224:227], v60, s[16:19], 0 offen sc1
buffer_load_dwordx4 a[228:231], v60, s[16:19], 0 offen offset:256 sc1
buffer_load_dwordx4 a[232:235], v61, s[16:19], 0 offen sc1
buffer_load_dwordx4 a[236:239], v61, s[16:19], 0 offen offset:256 sc1
buffer_load_dwordx4 a[240:243], v62, s[16:19], 0 offen sc1
buffer_load_dwordx4 a[244:247], v62, s[16:19], 0 offen offset:256 sc1
buffer_load_dwordx4 a[248:251], v63, s[16:19], 0 offen sc1
buffer_load_dwordx4 a[252:255], v63, s[16:19], 0 offen offset:256 sc1
v_add_u32 v34, 512, v34
s_cmp_lt_u32 s45, s44
s_cbranch_scc1 LE_loop
s_add_u32 s42, s42, 1
s_mul_i32 s43, s42, 256
v_cmp_lt_u32 vcc, s43, v4
s_cbranch_vccz LE_done
s_cmp_ge_u32 s42, 40
s_cbranch_scc1 LE_done
s_waitcnt vmcnt(0) lgkmcnt(0)
s_add_u32 s50, s50, 1024
v_add_u32 v5, 0x100, v5
buffer_load_dwordx4 v[192:195], v6, s[12:15], s50 offen offset:0 sc1
buffer_load_dwordx4 v[196:199], v6, s[12:15], s50 offen offset:64 sc1
buffer_load_dwordx4 v[200:203], v6, s[12:15], s50 offen offset:128 sc1
buffer_load_dwordx4 v[204:207], v6, s[12:15], s50 offen offset:192 sc1
buffer_load_dwordx4 v[208:211], v6, s[12:15], s50 offen offset:256 sc1
buffer_load_dwordx4 v[212:215], v6, s[12:15], s50 offen offset:320 sc1
buffer_load_dwordx4 v[216:219], v6, s[12:15], s50 offen offset:384 sc1
buffer_load_dwordx4 v[220:223], v6, s[12:15], s50 offen offset:448 sc1
buffer_load_dwordx4 v[224:227], v6, s[12:15], s50 offen offset:512 sc1
buffer_load_dwordx4 v[228:231], v6, s[12:15], s50 offen offset:576 sc1
buffer_load_dwordx4 v[232:235], v6, s[12:15], s50 offen offset:640 sc1
buffer_load_dwordx4 v[236:239], v6, s[12:15], s50 offen offset:704 sc1
buffer_load_dwordx4 v[240:243], v6, s[12:15], s50 offen offset:768 sc1
buffer_load_dwordx4 v[244:247], v6, s[12:15], s50 offen offset:832 sc1
buffer_load_dwordx4 v[248:251], v6, s[12:15], s50 offen offset:896 sc1
buffer_load_dwordx4 v[252:255], v6, s[12:15], s50 offen offset:960 sc1
s_branch LE_pass
LE_done:
s_add_u32 s24, s4, 0x7c00000
s_addc_u32 s25, s5, 0
s_mov_b32 s26, 0x40000
s_mov_b32 s27, 0x00020000
s_add_u32 s48, s40, 1280
s_mul_i32 s48, s48, 128
s_waitcnt vmcnt(0)
v_mov_b32 v32, s98
v_mov_b32 v33, s99
s_mov_b64 exec, 1
buffer_store_dwordx2 v[32:33], off, s[24:27], s48 sc1
s_mov_b64 exec, -1
s_branch L2_end
L2_fin:
L2_end:
s_endpgm
.section .rodata,"a"
.p2align 6
.amdhsa_kernel standalone__hybrid_graph_tf_graphgps__graph_kernel
  .amdhsa_next_free_vgpr 512
  .amdhsa_next_free_sgpr 102
  .amdhsa_accum_offset 256
  .amdhsa_group_segment_fixed_size 0
  .amdhsa_kernarg_size 96
  .amdhsa_user_sgpr_count 2
  .amdhsa_user_sgpr_kernarg_segment_ptr 1
  .amdhsa_system_sgpr_workgroup_id_x 1
.end_amdhsa_kernel
```

```asm
; @launch grid=(256,1,1) block=(256,1,1) lds=163840
.amdgcn_target "amdgcn-amd-amdhsa--gfx950"
.text
.globl standalone__hybrid_graph_tf_graphgps__graph_kernel
.p2align 8
.type standalone__hybrid_graph_tf_graphgps__graph_kernel,@function
standalone__hybrid_graph_tf_graphgps__graph_kernel:
s_getpc_b64 s[56:57]
s_load_dwordx16 s[16:31], s[0:1], 0
s_load_dwordx8 s[32:39], s[0:1], 64
s_cmp_ge_u32 s2, 256
s_cbranch_scc1 L2_end
v_lshrrev_b32 v1, 6, v0
v_and_b32 v2, 63, v0
s_lshr_b32 s3, s2, 3
s_add_u32 s3, s3, 30
s_and_b32 s3, s3, 31
v_readfirstlane_b32 s60, v1
s_lshl_b32 s5, s3, 2
s_add_u32 s5, s5, s60
s_and_b32 s56, s56, 0xffffff00
s_mov_b32 s58, L2_end-standalone__hybrid_graph_tf_graphgps__graph_kernel
s_mov_b32 s59, 0x00020000
s_and_b32 s6, s5, 15
s_lshl_b32 s6, s6, 13
v_lshlrev_b32 v10, 7, v2
buffer_load_dword v255, v10, s[56:59], s6 offen
v_and_b32 v3, 15, v2
v_lshrrev_b32 v4, 4, v2
s_and_b32 s62, s3, 7
s_mov_b64 s[14:15], 0
s_and_b32 s8, s2, 7
s_cmp_ge_u32 s3, 30
s_cbranch_scc1 LM_edge
s_mul_i32 s12, s3, 26
s_lshr_b32 s12, s12, 8
s_mul_i32 s9, s12, 10
s_sub_u32 s9, s3, s9
s_and_b32 s13, s8, 1
s_mul_i32 s13, s13, 3
s_add_u32 s13, s13, s12
s_lshr_b32 s12, s8, 1
s_mul_i32 s12, s12, 10
s_add_u32 s12, s12, s9
s_mul_i32 s91, s12, 6
s_add_u32 s91, s91, s13
s_mov_b32 s61, 0
s_cmp_eq_u32 s12, 39
s_cbranch_scc1 LM_light
s_mul_i32 s14, s13, 3
s_min_u32 s14, s14, 14
s_lshl_b32 s9, s12, 4
s_add_u32 s14, s14, s9
s_lshl_b32 s14, s14, 13
s_cmp_eq_u32 s91, 233
s_cselect_b32 s9, 0, s13
s_cmp_lt_u32 s9, 4
s_cselect_b32 s15, 3, 2
s_lshl_b32 s15, s15, 13
s_add_u32 s15, s15, s14
v_lshlrev_b32 v16, 4, v2
s_mul_i32 s63, s60, 12288
s_mov_b32 s6, s14
s_mul_i32 s7, s60, 6144
s_add_u32 s64, s6, s7
s_add_u32 s65, s64, 4096
s_lshl_b32 s7, s60, 7
v_lshrrev_b32 v5, 3, v2
v_and_b32 v6, 7, v2
v_and_b32 v7, 2, v5
v_xor_b32 v6, v6, v7
v_lshl_add_u32 v5, v5, 9, s7
v_lshl_add_u32 v17, v6, 4, v5
v_xor_b32 v6, 4, v6
v_lshl_add_u32 v18, v6, 4, v5
v_add_u32 v18, 0xc00, v18
v_add_u32 v19, 0x1800, v17
v_add_u32 v20, 0x1800, v18
s_xor_b32 s6, s62, 0
s_lshl_b32 s66, s6, 14
s_xor_b32 s6, s62, 1
s_lshl_b32 s67, s6, 14
s_xor_b32 s6, s62, 2
s_lshl_b32 s68, s6, 14
s_xor_b32 s6, s62, 3
s_lshl_b32 s69, s6, 14
s_xor_b32 s6, s62, 4
s_lshl_b32 s70, s6, 14
s_xor_b32 s6, s62, 5
s_lshl_b32 s71, s6, 14
s_xor_b32 s6, s62, 6
s_lshl_b32 s72, s6, 14
s_xor_b32 s6, s62, 7
s_lshl_b32 s73, s6, 14
s_waitcnt lgkmcnt(0)
s_add_u32 s40, s16, 0x0
s_addc_u32 s41, s17, 0
s_mov_b32 s42, s15
s_mov_b32 s43, 0x00020000
s_add_u32 s44, s26, 0x0
s_addc_u32 s45, s27, 0
s_mov_b32 s46, 0x20000
s_mov_b32 s47, 0x00020000
buffer_load_dwordx4 v[44:47], v16, s[40:43], s64 offen offset:0
buffer_load_dwordx4 v[48:51], v16, s[40:43], s64 offen offset:1024
buffer_load_dwordx4 v[52:55], v16, s[40:43], s64 offen offset:2048
buffer_load_dwordx4 v[56:59], v16, s[40:43], s64 offen offset:3072
buffer_load_dwordx4 v[60:63], v16, s[40:43], s65 offen offset:0
buffer_load_dwordx4 v[64:67], v16, s[40:43], s65 offen offset:1024
s_add_u32 m0, s63, 0x0
s_nop 0
buffer_load_dwordx4 v17, s[44:47], s66 offen offset:0 lds
buffer_load_dwordx4 v18, s[44:47], s66 offen offset:1024 lds
buffer_load_dwordx4 v19, s[44:47], s66 offen offset:2048 lds
buffer_load_dwordx4 v20, s[44:47], s66 offen offset:3072 lds
s_add_u32 m0, s63, 0x1000
s_nop 0
buffer_load_dwordx4 v17, s[44:47], s67 offen offset:0 lds
buffer_load_dwordx4 v18, s[44:47], s67 offen offset:1024 lds
buffer_load_dwordx4 v19, s[44:47], s67 offen offset:2048 lds
buffer_load_dwordx4 v20, s[44:47], s67 offen offset:3072 lds
s_mov_b32 s98, 0x7c3ff80
s_load_dwordx2 s[98:99], s[38:39], s98
v_bfe_u32 v5, v2, 2, 3
v_xor_b32 v5, s62, v5
v_and_b32 v6, 3, v2
v_lshlrev_b32 v7, 10, v5
v_lshl_add_u32 v7, v6, 8, v7
v_add_u32 v7, 0xc000, v7
v_and_b32 v5, 1, v5
v_lshl_or_b32 v6, v5, 2, v6
v_lshrrev_b32 v5, 5, v2
s_mul_i32 s6, s60, 12
v_add3_u32 v8, v5, s6, 0
v_lshrrev_b32 v9, 4, v8
v_lshl_add_u32 v9, v9, 13, v7
v_and_b32 v8, 15, v8
v_xor_b32 v8, v8, v6
v_lshl_add_u32 v36, v8, 4, v9
v_add3_u32 v8, v5, s6, 2
v_lshrrev_b32 v9, 4, v8
v_lshl_add_u32 v9, v9, 13, v7
v_and_b32 v8, 15, v8
v_xor_b32 v8, v8, v6
v_lshl_add_u32 v37, v8, 4, v9
v_add3_u32 v8, v5, s6, 4
v_lshrrev_b32 v9, 4, v8
v_lshl_add_u32 v9, v9, 13, v7
v_and_b32 v8, 15, v8
v_xor_b32 v8, v8, v6
v_lshl_add_u32 v38, v8, 4, v9
v_add3_u32 v8, v5, s6, 6
v_lshrrev_b32 v9, 4, v8
v_lshl_add_u32 v9, v9, 13, v7
v_and_b32 v8, 15, v8
v_xor_b32 v8, v8, v6
v_lshl_add_u32 v39, v8, 4, v9
v_add3_u32 v8, v5, s6, 8
v_lshrrev_b32 v9, 4, v8
v_lshl_add_u32 v9, v9, 13, v7
v_and_b32 v8, 15, v8
v_xor_b32 v8, v8, v6
v_lshl_add_u32 v40, v8, 4, v9
v_add3_u32 v8, v5, s6, 10
v_lshrrev_b32 v9, 4, v8
v_lshl_add_u32 v9, v9, 13, v7
v_and_b32 v8, 15, v8
v_xor_b32 v8, v8, v6
v_lshl_add_u32 v41, v8, 4, v9
v_xor_b32 v5, v3, v4
v_lshlrev_b32 v5, 4, v5
v_lshl_add_u32 v5, v4, 8, v5
v_add_u32 v31, 0xc000, v5
v_xor_b32 v32, 64, v31
v_lshrrev_b32 v5, 2, v3
v_and_b32 v6, 3, v3
v_and_b32 v7, 1, v4
v_lshlrev_b32 v7, 2, v7
v_and_b32 v8, 2, v5
v_or_b32 v7, v7, v8
v_lshl_add_u32 v8, v4, 3, v5
v_lshlrev_b32 v8, 7, v8
v_add_u32 v8, s63, v8
v_and_b32 v9, 1, v6
v_lshl_add_u32 v8, v9, 3, v8
v_lshrrev_b32 v6, 1, v6
v_xor_b32 v6, v6, v7
v_xor_b32 v9, 0, v6
v_lshl_add_u32 v25, v9, 4, v8
v_xor_b32 v9, 2, v6
v_lshl_add_u32 v26, v9, 4, v8
v_xor_b32 v9, 4, v6
v_lshl_add_u32 v27, v9, 4, v8
v_xor_b32 v9, 6, v6
v_lshl_add_u32 v28, v9, 4, v8
v_lshrrev_b32 v5, 3, v2
v_and_b32 v6, 7, v2
v_lshrrev_b32 v7, 1, v5
v_xor_b32 v6, v6, v7
v_and_b32 v7, 4, v5
v_add_u32 v5, v5, v7
s_mul_i32 s6, s60, 32768
v_lshl_add_u32 v5, v5, 9, s6
v_lshl_add_u32 v21, v6, 4, v5
v_xor_b32 v6, 4, v6
v_lshl_add_u32 v22, v6, 4, v5
v_add_u32 v22, 0x1c00, v22
v_mov_b32 v23, v21
v_mov_b32 v24, v22
s_lshr_b32 s7, s62, 1
s_xor_b32 s6, s7, 0
s_lshl_b32 s74, s6, 7
s_add_u32 s75, s74, 16384
s_xor_b32 s6, s7, 1
s_lshl_b32 s76, s6, 7
s_add_u32 s77, s76, 16384
s_xor_b32 s6, s7, 2
s_lshl_b32 s78, s6, 7
s_add_u32 s79, s78, 16384
s_xor_b32 s6, s7, 3
s_lshl_b32 s80, s6, 7
s_add_u32 s81, s80, 16384
s_and_b32 s6, s62, 1
s_lshl_b32 s6, s6, 2
v_lshrrev_b32 v5, 1, v3
v_xor_b32 v5, v5, v4
v_xor_b32 v5, s6, v5
v_lshl_add_u32 v6, v3, 7, s63
v_lshl_add_u32 v29, v5, 4, v6
v_xor_b32 v30, 64, v29
s_mul_i32 s6, s60, 2
s_xor_b32 s6, s6, s62
s_lshl_b32 s6, s6, 10
s_add_u32 s6, s6, 0x12000
v_lshrrev_b32 v5, 1, v4
v_and_b32 v6, 1, v4
v_lshl_add_u32 v5, v5, 8, s6
v_lshl_add_u32 v5, v6, 3, v5
v_lshl_add_u32 v33, v3, 4, v5
v_xor_b32 v34, 0x400, v33
v_add_u32 v35, 0x12000, v16
s_mov_b32 s6, s14
s_mul_i32 s7, s60, 2048
s_add_u32 s82, s6, s7
s_add_u32 s83, s82, 8192
s_add_u32 s84, s82, 16384
s_mov_b32 s86, 0x3db8aa3b
s_mov_b32 s87, 0x3db8aa3b
s_mov_b32 s88, 0x3727c5ac
s_mov_b32 s89, 0x3b800000
s_mov_b32 s90, 0xffff0000
s_add_u32 s48, s28, 0x0
s_addc_u32 s49, s29, 0
s_mov_b32 s50, 0x20000
s_mov_b32 s51, 0x00020000
s_add_u32 s52, s38, 0x0
s_addc_u32 s53, s39, 0
s_mov_b32 s54, s15
s_mov_b32 s55, 0x00020000
s_add_u32 s56, s38, 0x6800000
s_addc_u32 s57, s39, 0
s_mov_b32 s58, s15
s_mov_b32 s59, 0x00020000
s_waitcnt vmcnt(13)
v_lshlrev_b32 v116, 16, v44
v_and_b32 v117, s90, v44
v_lshlrev_b32 v118, 16, v45
v_and_b32 v119, s90, v45
v_lshlrev_b32 v120, 16, v46
v_and_b32 v121, s90, v46
v_lshlrev_b32 v122, 16, v47
v_and_b32 v123, s90, v47
v_pk_add_f32 v[164:165], v[116:117], v[118:119]
v_pk_mul_f32 v[166:167], v[116:117], v[116:117]
v_pk_add_f32 v[44:45], v[120:121], v[122:123]
v_pk_fma_f32 v[166:167], v[118:119], v[118:119], v[166:167]
v_pk_add_f32 v[164:165], v[164:165], v[44:45]
v_pk_fma_f32 v[166:167], v[120:121], v[120:121], v[166:167]
v_add_f32 v164, v164, v165
v_pk_fma_f32 v[166:167], v[122:123], v[122:123], v[166:167]
v_add_f32 v166, v166, v167
s_waitcnt vmcnt(12)
v_lshlrev_b32 v124, 16, v48
v_and_b32 v125, s90, v48
v_lshlrev_b32 v126, 16, v49
v_and_b32 v127, s90, v49
v_lshlrev_b32 v128, 16, v50
v_and_b32 v129, s90, v50
v_lshlrev_b32 v130, 16, v51
v_and_b32 v131, s90, v51
v_pk_add_f32 v[168:169], v[124:125], v[126:127]
v_pk_mul_f32 v[170:171], v[124:125], v[124:125]
v_pk_add_f32 v[48:49], v[128:129], v[130:131]
v_pk_fma_f32 v[170:171], v[126:127], v[126:127], v[170:171]
v_pk_add_f32 v[168:169], v[168:169], v[48:49]
v_pk_fma_f32 v[170:171], v[128:129], v[128:129], v[170:171]
v_add_f32 v168, v168, v169
v_pk_fma_f32 v[170:171], v[130:131], v[130:131], v[170:171]
v_add_f32 v170, v170, v171
s_waitcnt vmcnt(11)
v_lshlrev_b32 v132, 16, v52
v_and_b32 v133, s90, v52
v_lshlrev_b32 v134, 16, v53
v_and_b32 v135, s90, v53
v_lshlrev_b32 v136, 16, v54
v_and_b32 v137, s90, v54
v_lshlrev_b32 v138, 16, v55
v_and_b32 v139, s90, v55
v_pk_add_f32 v[172:173], v[132:133], v[134:135]
v_pk_mul_f32 v[174:175], v[132:133], v[132:133]
v_pk_add_f32 v[52:53], v[136:137], v[138:139]
v_pk_fma_f32 v[174:175], v[134:135], v[134:135], v[174:175]
v_pk_add_f32 v[172:173], v[172:173], v[52:53]
v_pk_fma_f32 v[174:175], v[136:137], v[136:137], v[174:175]
v_add_f32 v172, v172, v173
v_pk_fma_f32 v[174:175], v[138:139], v[138:139], v[174:175]
v_add_f32 v174, v174, v175
s_waitcnt vmcnt(10)
v_lshlrev_b32 v140, 16, v56
v_and_b32 v141, s90, v56
v_lshlrev_b32 v142, 16, v57
v_and_b32 v143, s90, v57
v_lshlrev_b32 v144, 16, v58
v_and_b32 v145, s90, v58
v_lshlrev_b32 v146, 16, v59
v_and_b32 v147, s90, v59
v_pk_add_f32 v[176:177], v[140:141], v[142:143]
v_pk_mul_f32 v[178:179], v[140:141], v[140:141]
v_pk_add_f32 v[56:57], v[144:145], v[146:147]
v_pk_fma_f32 v[178:179], v[142:143], v[142:143], v[178:179]
v_pk_add_f32 v[176:177], v[176:177], v[56:57]
v_pk_fma_f32 v[178:179], v[144:145], v[144:145], v[178:179]
v_add_f32 v176, v176, v177
v_pk_fma_f32 v[178:179], v[146:147], v[146:147], v[178:179]
v_add_f32 v178, v178, v179
s_waitcnt vmcnt(9)
v_lshlrev_b32 v148, 16, v60
v_and_b32 v149, s90, v60
v_lshlrev_b32 v150, 16, v61
v_and_b32 v151, s90, v61
v_lshlrev_b32 v152, 16, v62
v_and_b32 v153, s90, v62
v_lshlrev_b32 v154, 16, v63
v_and_b32 v155, s90, v63
v_pk_add_f32 v[180:181], v[148:149], v[150:151]
v_pk_mul_f32 v[182:183], v[148:149], v[148:149]
v_pk_add_f32 v[60:61], v[152:153], v[154:155]
v_pk_fma_f32 v[182:183], v[150:151], v[150:151], v[182:183]
v_pk_add_f32 v[180:181], v[180:181], v[60:61]
v_pk_fma_f32 v[182:183], v[152:153], v[152:153], v[182:183]
v_add_f32 v180, v180, v181
v_pk_fma_f32 v[182:183], v[154:155], v[154:155], v[182:183]
v_add_f32 v182, v182, v183
s_waitcnt vmcnt(8)
v_lshlrev_b32 v156, 16, v64
v_and_b32 v157, s90, v64
v_lshlrev_b32 v158, 16, v65
v_and_b32 v159, s90, v65
v_lshlrev_b32 v160, 16, v66
v_and_b32 v161, s90, v66
v_lshlrev_b32 v162, 16, v67
v_and_b32 v163, s90, v67
v_pk_add_f32 v[184:185], v[156:157], v[158:159]
v_pk_mul_f32 v[186:187], v[156:157], v[156:157]
v_pk_add_f32 v[64:65], v[160:161], v[162:163]
v_pk_fma_f32 v[186:187], v[158:159], v[158:159], v[186:187]
v_pk_add_f32 v[184:185], v[184:185], v[64:65]
v_pk_fma_f32 v[186:187], v[160:161], v[160:161], v[186:187]
v_add_f32 v184, v184, v185
v_pk_fma_f32 v[186:187], v[162:163], v[162:163], v[186:187]
v_add_f32 v186, v186, v187
v_permlane16_swap_b32 v164, v166
v_permlane16_swap_b32 v168, v170
v_permlane16_swap_b32 v172, v174
v_permlane16_swap_b32 v176, v178
v_permlane16_swap_b32 v180, v182
v_permlane16_swap_b32 v184, v186
v_add_f32 v164, v164, v166
v_add_f32 v168, v168, v170
v_add_f32 v172, v172, v174
v_add_f32 v176, v176, v178
v_add_f32 v180, v180, v182
v_add_f32 v184, v184, v186
v_add_f32_dpp v165, v164, v164 row_ror:8 row_mask:0xf bank_mask:0x3
v_add_f32_dpp v165, v168, v168 row_ror:8 row_mask:0xf bank_mask:0xc
v_add_f32_dpp v173, v172, v172 row_ror:8 row_mask:0xf bank_mask:0x3
v_add_f32_dpp v173, v176, v176 row_ror:8 row_mask:0xf bank_mask:0xc
v_add_f32_dpp v181, v180, v180 row_ror:8 row_mask:0xf bank_mask:0x3
v_add_f32_dpp v181, v184, v184 row_ror:8 row_mask:0xf bank_mask:0xc
v_add_f32_dpp v166, v165, v165 row_half_mirror row_mask:0xf bank_mask:0x5
v_add_f32_dpp v166, v173, v173 row_half_mirror row_mask:0xf bank_mask:0xa
v_add_f32_dpp v182, v181, v181 row_half_mirror row_mask:0xf bank_mask:0xf
s_nop 0
v_add_f32_dpp v166, v166, v166 quad_perm:[1,0,3,2] row_mask:0xf bank_mask:0xf
v_add_f32_dpp v182, v182, v182 quad_perm:[1,0,3,2] row_mask:0xf bank_mask:0xf
s_nop 0
v_add_f32_dpp v166, v166, v166 quad_perm:[2,3,0,1] row_mask:0xf bank_mask:0xf
v_add_f32_dpp v182, v182, v182 quad_perm:[2,3,0,1] row_mask:0xf bank_mask:0xf
v_mov_b32 v167, v166
v_mov_b32 v183, v182
s_nop 0
v_permlane16_swap_b32 v167, v166
v_permlane16_swap_b32 v183, v182
v_mul_f32 v167, s89, v167
v_mul_f32 v183, s89, v183
v_mul_f32 v166, s89, v166
v_mul_f32 v182, s89, v182
v_fma_f32 v166, -v167, v167, v166
v_fma_f32 v182, -v183, v183, v182
v_cvt_pk_bf16_f32 v167, v167, v167
v_cvt_pk_bf16_f32 v183, v183, v183
v_max_f32 v166, 0, v166
v_max_f32 v182, 0, v182
v_cvt_pk_bf16_f32 v166, v166, v166
v_cvt_pk_bf16_f32 v182, v182, v182
v_and_b32 v166, s90, v166
v_and_b32 v182, s90, v182
v_add_f32 v166, s88, v166
v_add_f32 v182, s88, v182
v_cvt_pk_bf16_f32 v166, v166, v166
v_cvt_pk_bf16_f32 v182, v182, v182
v_and_b32 v166, s90, v166
v_and_b32 v182, s90, v182
v_sqrt_f32 v166, v166
v_sqrt_f32 v182, v182
v_and_b32 v167, s90, v167
v_and_b32 v183, s90, v183
v_cvt_pk_bf16_f32 v166, v166, v166
v_cvt_pk_bf16_f32 v182, v182, v182
v_and_b32 v166, s90, v166
v_and_b32 v182, s90, v182
v_rcp_f32 v166, v166
v_rcp_f32 v182, v182
v_mul_f32 v167, -v167, v166
v_mul_f32 v183, -v183, v182
s_nop 0
v_mov_b64_dpp v[164:165], v[166:167] row_newbcast:0 row_mask:0xf bank_mask:0xf
v_mov_b64_dpp v[168:169], v[166:167] row_newbcast:8 row_mask:0xf bank_mask:0xf
v_mov_b64_dpp v[172:173], v[166:167] row_newbcast:4 row_mask:0xf bank_mask:0xf
v_mov_b64_dpp v[176:177], v[166:167] row_newbcast:12 row_mask:0xf bank_mask:0xf
v_mov_b64_dpp v[180:181], v[182:183] row_newbcast:0 row_mask:0xf bank_mask:0xf
v_mov_b64_dpp v[184:185], v[182:183] row_newbcast:8 row_mask:0xf bank_mask:0xf
v_fma_f32 v116, v116, v164, v165
v_fma_f32 v117, v117, v164, v165
v_fma_f32 v118, v118, v164, v165
v_fma_f32 v119, v119, v164, v165
v_fma_f32 v120, v120, v164, v165
v_fma_f32 v121, v121, v164, v165
v_fma_f32 v122, v122, v164, v165
v_fma_f32 v123, v123, v164, v165
v_cvt_pk_bf16_f32 v44, v116, v117
v_cvt_pk_bf16_f32 v45, v118, v119
v_cvt_pk_bf16_f32 v46, v120, v121
v_cvt_pk_bf16_f32 v47, v122, v123
ds_write_b128 v36, v[44:47]
v_fma_f32 v124, v124, v168, v169
v_fma_f32 v125, v125, v168, v169
v_fma_f32 v126, v126, v168, v169
v_fma_f32 v127, v127, v168, v169
v_fma_f32 v128, v128, v168, v169
v_fma_f32 v129, v129, v168, v169
v_fma_f32 v130, v130, v168, v169
v_fma_f32 v131, v131, v168, v169
v_cvt_pk_bf16_f32 v48, v124, v125
v_cvt_pk_bf16_f32 v49, v126, v127
v_cvt_pk_bf16_f32 v50, v128, v129
v_cvt_pk_bf16_f32 v51, v130, v131
ds_write_b128 v37, v[48:51]
v_fma_f32 v132, v132, v172, v173
v_fma_f32 v133, v133, v172, v173
v_fma_f32 v134, v134, v172, v173
v_fma_f32 v135, v135, v172, v173
v_fma_f32 v136, v136, v172, v173
v_fma_f32 v137, v137, v172, v173
v_fma_f32 v138, v138, v172, v173
v_fma_f32 v139, v139, v172, v173
v_cvt_pk_bf16_f32 v52, v132, v133
v_cvt_pk_bf16_f32 v53, v134, v135
v_cvt_pk_bf16_f32 v54, v136, v137
v_cvt_pk_bf16_f32 v55, v138, v139
ds_write_b128 v38, v[52:55]
v_fma_f32 v140, v140, v176, v177
v_fma_f32 v141, v141, v176, v177
v_fma_f32 v142, v142, v176, v177
v_fma_f32 v143, v143, v176, v177
v_fma_f32 v144, v144, v176, v177
v_fma_f32 v145, v145, v176, v177
v_fma_f32 v146, v146, v176, v177
v_fma_f32 v147, v147, v176, v177
v_cvt_pk_bf16_f32 v56, v140, v141
v_cvt_pk_bf16_f32 v57, v142, v143
v_cvt_pk_bf16_f32 v58, v144, v145
v_cvt_pk_bf16_f32 v59, v146, v147
ds_write_b128 v39, v[56:59]
v_fma_f32 v148, v148, v180, v181
v_fma_f32 v149, v149, v180, v181
v_fma_f32 v150, v150, v180, v181
v_fma_f32 v151, v151, v180, v181
v_fma_f32 v152, v152, v180, v181
v_fma_f32 v153, v153, v180, v181
v_fma_f32 v154, v154, v180, v181
v_fma_f32 v155, v155, v180, v181
v_cvt_pk_bf16_f32 v60, v148, v149
v_cvt_pk_bf16_f32 v61, v150, v151
v_cvt_pk_bf16_f32 v62, v152, v153
v_cvt_pk_bf16_f32 v63, v154, v155
ds_write_b128 v40, v[60:63]
v_fma_f32 v156, v156, v184, v185
v_fma_f32 v157, v157, v184, v185
v_fma_f32 v158, v158, v184, v185
v_fma_f32 v159, v159, v184, v185
v_fma_f32 v160, v160, v184, v185
v_fma_f32 v161, v161, v184, v185
v_fma_f32 v162, v162, v184, v185
v_fma_f32 v163, v163, v184, v185
v_cvt_pk_bf16_f32 v64, v156, v157
v_cvt_pk_bf16_f32 v65, v158, v159
v_cvt_pk_bf16_f32 v66, v160, v161
v_cvt_pk_bf16_f32 v67, v162, v163
ds_write_b128 v41, v[64:67]
s_add_u32 m0, s63, 0x2000
s_nop 0
buffer_load_dwordx4 v17, s[44:47], s68 offen offset:0 lds
buffer_load_dwordx4 v18, s[44:47], s68 offen offset:1024 lds
buffer_load_dwordx4 v19, s[44:47], s68 offen offset:2048 lds
buffer_load_dwordx4 v20, s[44:47], s68 offen offset:3072 lds
s_waitcnt vmcnt(8)
ds_read_b64_tr_b16 v[164:165], v25 offset:0
ds_read_b64_tr_b16 v[166:167], v25 offset:512
ds_read_b64_tr_b16 v[168:169], v26 offset:0
ds_read_b64_tr_b16 v[170:171], v26 offset:512
ds_read_b64_tr_b16 v[172:173], v27 offset:0
ds_read_b64_tr_b16 v[174:175], v27 offset:512
s_waitcnt lgkmcnt(6)
s_barrier
ds_read_b128 v[204:207], v31 offset:0
ds_read_b128 v[208:211], v31 offset:8192
ds_read_b128 v[212:215], v31 offset:16384
s_waitcnt lgkmcnt(2)
v_mfma_f32_16x16x32_bf16 v[68:71], v[164:167], v[204:207], 0
s_waitcnt lgkmcnt(1)
v_mfma_f32_16x16x32_bf16 v[72:75], v[164:167], v[208:211], 0
s_waitcnt lgkmcnt(0)
v_mfma_f32_16x16x32_bf16 v[76:79], v[164:167], v[212:215], 0
ds_read_b64_tr_b16 v[176:177], v28 offset:0
ds_read_b64_tr_b16 v[178:179], v28 offset:512
v_mfma_f32_16x16x32_bf16 v[80:83], v[168:171], v[204:207], 0
v_mfma_f32_16x16x32_bf16 v[84:87], v[168:171], v[208:211], 0
v_mfma_f32_16x16x32_bf16 v[88:91], v[168:171], v[212:215], 0
ds_read_b128 v[216:219], v32 offset:1024
s_waitcnt vmcnt(4)
ds_read_b64_tr_b16 v[180:181], v25 offset:4096
ds_read_b64_tr_b16 v[182:183], v25 offset:4608
v_mfma_f32_16x16x32_bf16 v[92:95], v[172:175], v[204:207], 0
ds_read_b128 v[220:223], v32 offset:9216
v_mfma_f32_16x16x32_bf16 v[96:99], v[172:175], v[208:211], 0
ds_read_b128 v[224:227], v32 offset:17408
v_mfma_f32_16x16x32_bf16 v[100:103], v[172:175], v[212:215], 0
ds_read_b64_tr_b16 v[184:185], v26 offset:4096
ds_read_b64_tr_b16 v[186:187], v26 offset:4608
s_waitcnt lgkmcnt(7)
v_mfma_f32_16x16x32_bf16 v[104:107], v[176:179], v[204:207], 0
s_add_u32 m0, s63, 0x0
s_nop 0
buffer_load_dwordx4 v17, s[44:47], s69 offen offset:0 lds
buffer_load_dwordx4 v18, s[44:47], s69 offen offset:1024 lds
buffer_load_dwordx4 v19, s[44:47], s69 offen offset:2048 lds
buffer_load_dwordx4 v20, s[44:47], s69 offen offset:3072 lds
v_mfma_f32_16x16x32_bf16 v[108:111], v[176:179], v[208:211], 0
v_mfma_f32_16x16x32_bf16 v[112:115], v[176:179], v[212:215], 0
ds_read_b64_tr_b16 v[188:189], v27 offset:4096
ds_read_b64_tr_b16 v[190:191], v27 offset:4608
s_waitcnt lgkmcnt(6)
v_mfma_f32_16x16x32_bf16 v[68:71], v[180:183], v[216:219], v[68:71]
s_waitcnt lgkmcnt(5)
v_mfma_f32_16x16x32_bf16 v[72:75], v[180:183], v[220:223], v[72:75]
s_waitcnt lgkmcnt(4)
v_mfma_f32_16x16x32_bf16 v[76:79], v[180:183], v[224:227], v[76:79]
ds_read_b64_tr_b16 v[192:193], v28 offset:4096
ds_read_b64_tr_b16 v[194:195], v28 offset:4608
s_waitcnt lgkmcnt(4)
v_mfma_f32_16x16x32_bf16 v[80:83], v[184:187], v[216:219], v[80:83]
v_mfma_f32_16x16x32_bf16 v[84:87], v[184:187], v[220:223], v[84:87]
v_mfma_f32_16x16x32_bf16 v[88:91], v[184:187], v[224:227], v[88:91]
ds_read_b128 v[228:231], v31 offset:2048
s_waitcnt vmcnt(4)
ds_read_b64_tr_b16 v[196:197], v25 offset:8192
ds_read_b64_tr_b16 v[198:199], v25 offset:8704
s_waitcnt lgkmcnt(5)
v_mfma_f32_16x16x32_bf16 v[92:95], v[188:191], v[216:219], v[92:95]
ds_read_b128 v[232:235], v31 offset:10240
v_mfma_f32_16x16x32_bf16 v[96:99], v[188:191], v[220:223], v[96:99]
ds_read_b128 v[236:239], v31 offset:18432
v_mfma_f32_16x16x32_bf16 v[100:103], v[188:191], v[224:227], v[100:103]
ds_read_b64_tr_b16 v[200:201], v26 offset:8192
ds_read_b64_tr_b16 v[202:203], v26 offset:8704
s_waitcnt lgkmcnt(7)
v_mfma_f32_16x16x32_bf16 v[104:107], v[192:195], v[216:219], v[104:107]
s_add_u32 m0, s63, 0x1000
s_nop 0
buffer_load_dwordx4 v17, s[44:47], s70 offen offset:0 lds
buffer_load_dwordx4 v18, s[44:47], s70 offen offset:1024 lds
buffer_load_dwordx4 v19, s[44:47], s70 offen offset:2048 lds
buffer_load_dwordx4 v20, s[44:47], s70 offen offset:3072 lds
v_mfma_f32_16x16x32_bf16 v[108:111], v[192:195], v[220:223], v[108:111]
v_mfma_f32_16x16x32_bf16 v[112:115], v[192:195], v[224:227], v[112:115]
ds_read_b64_tr_b16 v[164:165], v27 offset:8192
ds_read_b64_tr_b16 v[166:167], v27 offset:8704
s_waitcnt lgkmcnt(6)
v_mfma_f32_16x16x32_bf16 v[68:71], v[196:199], v[228:231], v[68:71]
s_waitcnt lgkmcnt(5)
v_mfma_f32_16x16x32_bf16 v[72:75], v[196:199], v[232:235], v[72:75]
s_waitcnt lgkmcnt(4)
v_mfma_f32_16x16x32_bf16 v[76:79], v[196:199], v[236:239], v[76:79]
ds_read_b64_tr_b16 v[168:169], v28 offset:8192
ds_read_b64_tr_b16 v[170:171], v28 offset:8704
s_waitcnt lgkmcnt(4)
v_mfma_f32_16x16x32_bf16 v[80:83], v[200:203], v[228:231], v[80:83]
v_mfma_f32_16x16x32_bf16 v[84:87], v[200:203], v[232:235], v[84:87]
v_mfma_f32_16x16x32_bf16 v[88:91], v[200:203], v[236:239], v[88:91]
ds_read_b128 v[204:207], v32 offset:3072
s_waitcnt vmcnt(4)
ds_read_b64_tr_b16 v[172:173], v25 offset:0
ds_read_b64_tr_b16 v[174:175], v25 offset:512
s_waitcnt lgkmcnt(5)
v_mfma_f32_16x16x32_bf16 v[92:95], v[164:167], v[228:231], v[92:95]
ds_read_b128 v[208:211], v32 offset:11264
v_mfma_f32_16x16x32_bf16 v[96:99], v[164:167], v[232:235], v[96:99]
ds_read_b128 v[212:215], v32 offset:19456
v_mfma_f32_16x16x32_bf16 v[100:103], v[164:167], v[236:239], v[100:103]
ds_read_b64_tr_b16 v[176:177], v26 offset:0
ds_read_b64_tr_b16 v[178:179], v26 offset:512
s_waitcnt lgkmcnt(7)
v_mfma_f32_16x16x32_bf16 v[104:107], v[168:171], v[228:231], v[104:107]
s_add_u32 m0, s63, 0x2000
s_nop 0
buffer_load_dwordx4 v17, s[44:47], s71 offen offset:0 lds
buffer_load_dwordx4 v18, s[44:47], s71 offen offset:1024 lds
buffer_load_dwordx4 v19, s[44:47], s71 offen offset:2048 lds
buffer_load_dwordx4 v20, s[44:47], s71 offen offset:3072 lds
v_mfma_f32_16x16x32_bf16 v[108:111], v[168:171], v[232:235], v[108:111]
v_mfma_f32_16x16x32_bf16 v[112:115], v[168:171], v[236:239], v[112:115]
ds_read_b64_tr_b16 v[180:181], v27 offset:0
ds_read_b64_tr_b16 v[182:183], v27 offset:512
s_waitcnt lgkmcnt(6)
v_mfma_f32_16x16x32_bf16 v[68:71], v[172:175], v[204:207], v[68:71]
s_waitcnt lgkmcnt(5)
v_mfma_f32_16x16x32_bf16 v[72:75], v[172:175], v[208:211], v[72:75]
s_waitcnt lgkmcnt(4)
v_mfma_f32_16x16x32_bf16 v[76:79], v[172:175], v[212:215], v[76:79]
ds_read_b64_tr_b16 v[184:185], v28 offset:0
ds_read_b64_tr_b16 v[186:187], v28 offset:512
s_waitcnt lgkmcnt(4)
v_mfma_f32_16x16x32_bf16 v[80:83], v[176:179], v[204:207], v[80:83]
v_mfma_f32_16x16x32_bf16 v[84:87], v[176:179], v[208:211], v[84:87]
v_mfma_f32_16x16x32_bf16 v[88:91], v[176:179], v[212:215], v[88:91]
ds_read_b128 v[216:219], v31 offset:4096
s_waitcnt vmcnt(4)
ds_read_b64_tr_b16 v[188:189], v25 offset:4096
ds_read_b64_tr_b16 v[190:191], v25 offset:4608
s_waitcnt lgkmcnt(5)
v_mfma_f32_16x16x32_bf16 v[92:95], v[180:183], v[204:207], v[92:95]
ds_read_b128 v[220:223], v31 offset:12288
v_mfma_f32_16x16x32_bf16 v[96:99], v[180:183], v[208:211], v[96:99]
ds_read_b128 v[224:227], v31 offset:20480
v_mfma_f32_16x16x32_bf16 v[100:103], v[180:183], v[212:215], v[100:103]
ds_read_b64_tr_b16 v[192:193], v26 offset:4096
ds_read_b64_tr_b16 v[194:195], v26 offset:4608
s_waitcnt lgkmcnt(7)
v_mfma_f32_16x16x32_bf16 v[104:107], v[184:187], v[204:207], v[104:107]
s_add_u32 m0, s63, 0x0
s_nop 0
buffer_load_dwordx4 v17, s[44:47], s72 offen offset:0 lds
buffer_load_dwordx4 v18, s[44:47], s72 offen offset:1024 lds
buffer_load_dwordx4 v19, s[44:47], s72 offen offset:2048 lds
buffer_load_dwordx4 v20, s[44:47], s72 offen offset:3072 lds
v_mfma_f32_16x16x32_bf16 v[108:111], v[184:187], v[208:211], v[108:111]
v_mfma_f32_16x16x32_bf16 v[112:115], v[184:187], v[212:215], v[112:115]
ds_read_b64_tr_b16 v[196:197], v27 offset:4096
ds_read_b64_tr_b16 v[198:199], v27 offset:4608
s_waitcnt lgkmcnt(6)
v_mfma_f32_16x16x32_bf16 v[68:71], v[188:191], v[216:219], v[68:71]
s_waitcnt lgkmcnt(5)
v_mfma_f32_16x16x32_bf16 v[72:75], v[188:191], v[220:223], v[72:75]
s_waitcnt lgkmcnt(4)
v_mfma_f32_16x16x32_bf16 v[76:79], v[188:191], v[224:227], v[76:79]
ds_read_b64_tr_b16 v[200:201], v28 offset:4096
ds_read_b64_tr_b16 v[202:203], v28 offset:4608
s_waitcnt lgkmcnt(4)
v_mfma_f32_16x16x32_bf16 v[80:83], v[192:195], v[216:219], v[80:83]
v_mfma_f32_16x16x32_bf16 v[84:87], v[192:195], v[220:223], v[84:87]
v_mfma_f32_16x16x32_bf16 v[88:91], v[192:195], v[224:227], v[88:91]
ds_read_b128 v[228:231], v32 offset:5120
s_waitcnt vmcnt(4)
ds_read_b64_tr_b16 v[164:165], v25 offset:8192
ds_read_b64_tr_b16 v[166:167], v25 offset:8704
s_waitcnt lgkmcnt(5)
v_mfma_f32_16x16x32_bf16 v[92:95], v[196:199], v[216:219], v[92:95]
ds_read_b128 v[232:235], v32 offset:13312
v_mfma_f32_16x16x32_bf16 v[96:99], v[196:199], v[220:223], v[96:99]
ds_read_b128 v[236:239], v32 offset:21504
v_mfma_f32_16x16x32_bf16 v[100:103], v[196:199], v[224:227], v[100:103]
ds_read_b64_tr_b16 v[168:169], v26 offset:8192
ds_read_b64_tr_b16 v[170:171], v26 offset:8704
s_waitcnt lgkmcnt(7)
v_mfma_f32_16x16x32_bf16 v[104:107], v[200:203], v[216:219], v[104:107]
s_add_u32 m0, s63, 0x1000
s_nop 0
buffer_load_dwordx4 v17, s[44:47], s73 offen offset:0 lds
buffer_load_dwordx4 v18, s[44:47], s73 offen offset:1024 lds
buffer_load_dwordx4 v19, s[44:47], s73 offen offset:2048 lds
buffer_load_dwordx4 v20, s[44:47], s73 offen offset:3072 lds
v_mfma_f32_16x16x32_bf16 v[108:111], v[200:203], v[220:223], v[108:111]
v_mfma_f32_16x16x32_bf16 v[112:115], v[200:203], v[224:227], v[112:115]
ds_read_b64_tr_b16 v[172:173], v27 offset:8192
ds_read_b64_tr_b16 v[174:175], v27 offset:8704
s_waitcnt lgkmcnt(6)
v_mfma_f32_16x16x32_bf16 v[68:71], v[164:167], v[228:231], v[68:71]
s_waitcnt lgkmcnt(5)
v_mfma_f32_16x16x32_bf16 v[72:75], v[164:167], v[232:235], v[72:75]
s_waitcnt lgkmcnt(4)
v_mfma_f32_16x16x32_bf16 v[76:79], v[164:167], v[236:239], v[76:79]
ds_read_b64_tr_b16 v[176:177], v28 offset:8192
ds_read_b64_tr_b16 v[178:179], v28 offset:8704
s_waitcnt lgkmcnt(4)
v_mfma_f32_16x16x32_bf16 v[80:83], v[168:171], v[228:231], v[80:83]
v_mfma_f32_16x16x32_bf16 v[84:87], v[168:171], v[232:235], v[84:87]
v_mfma_f32_16x16x32_bf16 v[88:91], v[168:171], v[236:239], v[88:91]
ds_read_b128 v[204:207], v31 offset:6144
s_waitcnt vmcnt(4)
ds_read_b64_tr_b16 v[180:181], v25 offset:0
ds_read_b64_tr_b16 v[182:183], v25 offset:512
s_waitcnt lgkmcnt(5)
v_mfma_f32_16x16x32_bf16 v[92:95], v[172:175], v[228:231], v[92:95]
ds_read_b128 v[208:211], v31 offset:14336
v_mfma_f32_16x16x32_bf16 v[96:99], v[172:175], v[232:235], v[96:99]
ds_read_b128 v[212:215], v31 offset:22528
v_mfma_f32_16x16x32_bf16 v[100:103], v[172:175], v[236:239], v[100:103]
ds_read_b64_tr_b16 v[184:185], v26 offset:0
ds_read_b64_tr_b16 v[186:187], v26 offset:512
s_waitcnt lgkmcnt(7)
v_mfma_f32_16x16x32_bf16 v[104:107], v[176:179], v[228:231], v[104:107]
s_add_u32 m0, s63, 0x2000
s_nop 0
buffer_load_dwordx4 v21, s[48:51], s74 offen offset:0 lds
buffer_load_dwordx4 v22, s[48:51], s74 offen offset:1024 lds
buffer_load_dwordx4 v23, s[48:51], s74 offen offset:2048 lds
buffer_load_dwordx4 v24, s[48:51], s74 offen offset:3072 lds
v_mfma_f32_16x16x32_bf16 v[108:111], v[176:179], v[232:235], v[108:111]
v_mfma_f32_16x16x32_bf16 v[112:115], v[176:179], v[236:239], v[112:115]
ds_read_b64_tr_b16 v[188:189], v27 offset:0
ds_read_b64_tr_b16 v[190:191], v27 offset:512
s_waitcnt lgkmcnt(6)
v_mfma_f32_16x16x32_bf16 v[68:71], v[180:183], v[204:207], v[68:71]
s_waitcnt lgkmcnt(5)
v_mfma_f32_16x16x32_bf16 v[72:75], v[180:183], v[208:211], v[72:75]
s_waitcnt lgkmcnt(4)
v_mfma_f32_16x16x32_bf16 v[76:79], v[180:183], v[212:215], v[76:79]
ds_read_b64_tr_b16 v[192:193], v28 offset:0
ds_read_b64_tr_b16 v[194:195], v28 offset:512
s_waitcnt lgkmcnt(4)
v_mfma_f32_16x16x32_bf16 v[80:83], v[184:187], v[204:207], v[80:83]
v_mfma_f32_16x16x32_bf16 v[84:87], v[184:187], v[208:211], v[84:87]
v_mfma_f32_16x16x32_bf16 v[88:91], v[184:187], v[212:215], v[88:91]
ds_read_b128 v[216:219], v32 offset:7168
s_waitcnt vmcnt(4)
ds_read_b64_tr_b16 v[196:197], v25 offset:4096
ds_read_b64_tr_b16 v[198:199], v25 offset:4608
s_waitcnt lgkmcnt(5)
v_mfma_f32_16x16x32_bf16 v[92:95], v[188:191], v[204:207], v[92:95]
ds_read_b128 v[220:223], v32 offset:15360
v_mfma_f32_16x16x32_bf16 v[96:99], v[188:191], v[208:211], v[96:99]
ds_read_b128 v[224:227], v32 offset:23552
v_mfma_f32_16x16x32_bf16 v[100:103], v[188:191], v[212:215], v[100:103]
ds_read_b64_tr_b16 v[200:201], v26 offset:4096
ds_read_b64_tr_b16 v[202:203], v26 offset:4608
s_waitcnt lgkmcnt(7)
v_mfma_f32_16x16x32_bf16 v[104:107], v[192:195], v[204:207], v[104:107]
s_add_u32 m0, s63, 0x0
s_nop 0
buffer_load_dwordx4 v21, s[48:51], s75 offen offset:0 lds
buffer_load_dwordx4 v22, s[48:51], s75 offen offset:1024 lds
buffer_load_dwordx4 v23, s[48:51], s75 offen offset:2048 lds
buffer_load_dwordx4 v24, s[48:51], s75 offen offset:3072 lds
v_mfma_f32_16x16x32_bf16 v[108:111], v[192:195], v[208:211], v[108:111]
v_mfma_f32_16x16x32_bf16 v[112:115], v[192:195], v[212:215], v[112:115]
ds_read_b64_tr_b16 v[164:165], v27 offset:4096
ds_read_b64_tr_b16 v[166:167], v27 offset:4608
s_waitcnt lgkmcnt(6)
v_mfma_f32_16x16x32_bf16 v[68:71], v[196:199], v[216:219], v[68:71]
s_waitcnt lgkmcnt(5)
v_mfma_f32_16x16x32_bf16 v[72:75], v[196:199], v[220:223], v[72:75]
s_waitcnt lgkmcnt(4)
v_mfma_f32_16x16x32_bf16 v[76:79], v[196:199], v[224:227], v[76:79]
ds_read_b64_tr_b16 v[168:169], v28 offset:4096
ds_read_b64_tr_b16 v[170:171], v28 offset:4608
s_waitcnt lgkmcnt(4)
v_mfma_f32_16x16x32_bf16 v[80:83], v[200:203], v[216:219], v[80:83]
v_cvt_pk_bf16_f32 v68, v68, v69
v_cvt_pk_bf16_f32 v69, v70, v71
ds_write_b64 v33, v[68:69] offset:0
v_mfma_f32_16x16x32_bf16 v[84:87], v[200:203], v[220:223], v[84:87]
v_cvt_pk_bf16_f32 v72, v72, v73
v_cvt_pk_bf16_f32 v73, v74, v75
ds_write_b64 v33, v[72:73] offset:8192
v_mfma_f32_16x16x32_bf16 v[88:91], v[200:203], v[224:227], v[88:91]
v_cvt_pk_bf16_f32 v76, v76, v77
v_cvt_pk_bf16_f32 v77, v78, v79
ds_write_b64 v33, v[76:77] offset:16384
s_waitcnt lgkmcnt(5)
v_mfma_f32_16x16x32_bf16 v[92:95], v[164:167], v[216:219], v[92:95]
v_cvt_pk_bf16_f32 v80, v80, v81
v_cvt_pk_bf16_f32 v81, v82, v83
ds_write_b64 v33, v[80:81] offset:512
v_mfma_f32_16x16x32_bf16 v[96:99], v[164:167], v[220:223], v[96:99]
v_cvt_pk_bf16_f32 v84, v84, v85
v_cvt_pk_bf16_f32 v85, v86, v87
ds_write_b64 v33, v[84:85] offset:8704
v_mfma_f32_16x16x32_bf16 v[100:103], v[164:167], v[224:227], v[100:103]
v_cvt_pk_bf16_f32 v88, v88, v89
v_cvt_pk_bf16_f32 v89, v90, v91
ds_write_b64 v33, v[88:89] offset:16896
s_waitcnt lgkmcnt(6)
v_mfma_f32_16x16x32_bf16 v[104:107], v[168:171], v[216:219], v[104:107]
v_cvt_pk_bf16_f32 v92, v92, v93
v_cvt_pk_bf16_f32 v93, v94, v95
ds_write_b64 v34, v[92:93] offset:0
s_add_u32 m0, s63, 0x1000
s_nop 0
buffer_load_dwordx4 v21, s[48:51], s76 offen offset:0 lds
buffer_load_dwordx4 v22, s[48:51], s76 offen offset:1024 lds
buffer_load_dwordx4 v23, s[48:51], s76 offen offset:2048 lds
buffer_load_dwordx4 v24, s[48:51], s76 offen offset:3072 lds
v_mfma_f32_16x16x32_bf16 v[108:111], v[168:171], v[220:223], v[108:111]
v_cvt_pk_bf16_f32 v96, v96, v97
v_cvt_pk_bf16_f32 v97, v98, v99
ds_write_b64 v34, v[96:97] offset:8192
v_mfma_f32_16x16x32_bf16 v[112:115], v[168:171], v[224:227], v[112:115]
v_cvt_pk_bf16_f32 v100, v100, v101
v_cvt_pk_bf16_f32 v101, v102, v103
ds_write_b64 v34, v[100:101] offset:16384
v_cvt_pk_bf16_f32 v104, v104, v105
v_cvt_pk_bf16_f32 v105, v106, v107
ds_write_b64 v34, v[104:105] offset:512
v_cvt_pk_bf16_f32 v108, v108, v109
v_cvt_pk_bf16_f32 v109, v110, v111
ds_write_b64 v34, v[108:109] offset:8704
v_cvt_pk_bf16_f32 v112, v112, v113
v_cvt_pk_bf16_f32 v113, v114, v115
ds_write_b64 v34, v[112:113] offset:16896
s_waitcnt vmcnt(8)
ds_read_b128 v[172:175], v29 offset:8192
ds_read_b128 v[176:179], v30 offset:8192
ds_read_b128 v[180:183], v29 offset:10240
s_waitcnt lgkmcnt(3)
s_barrier
ds_read_b128 v[228:231], v35 offset:0
ds_read_b128 v[232:235], v35 offset:8192
ds_read_b128 v[236:239], v35 offset:16384
ds_read_b128 v[204:207], v35 offset:1024
ds_read_b128 v[208:211], v35 offset:9216
ds_read_b128 v[212:215], v35 offset:17408
s_waitcnt lgkmcnt(5)
v_mfma_f32_16x16x32_bf16 v[116:119], v[172:175], v[228:231], 0
s_waitcnt lgkmcnt(4)
v_mfma_f32_16x16x32_bf16 v[132:135], v[172:175], v[232:235], 0
s_waitcnt lgkmcnt(3)
v_mfma_f32_16x16x32_bf16 v[148:151], v[172:175], v[236:239], 0
ds_read_b128 v[184:187], v30 offset:10240
s_waitcnt lgkmcnt(3)
v_mfma_f32_16x16x32_bf16 v[116:119], v[176:179], v[204:207], v[116:119]
s_waitcnt lgkmcnt(2)
v_mfma_f32_16x16x32_bf16 v[132:135], v[176:179], v[208:211], v[132:135]
s_waitcnt lgkmcnt(1)
v_mfma_f32_16x16x32_bf16 v[148:151], v[176:179], v[212:215], v[148:151]
s_waitcnt vmcnt(4)
ds_read_b128 v[188:191], v29 offset:0
v_mfma_f32_16x16x32_bf16 v[120:123], v[180:183], v[228:231], 0
v_mfma_f32_16x16x32_bf16 v[136:139], v[180:183], v[232:235], 0
v_mfma_f32_16x16x32_bf16 v[152:155], v[180:183], v[236:239], 0
ds_read_b128 v[192:195], v30 offset:0
s_waitcnt lgkmcnt(2)
v_mfma_f32_16x16x32_bf16 v[120:123], v[184:187], v[204:207], v[120:123]
s_add_u32 m0, s63, 0x2000
s_nop 0
buffer_load_dwordx4 v21, s[48:51], s77 offen offset:0 lds
buffer_load_dwordx4 v22, s[48:51], s77 offen offset:1024 lds
buffer_load_dwordx4 v23, s[48:51], s77 offen offset:2048 lds
buffer_load_dwordx4 v24, s[48:51], s77 offen offset:3072 lds
v_mfma_f32_16x16x32_bf16 v[136:139], v[184:187], v[208:211], v[136:139]
v_mfma_f32_16x16x32_bf16 v[152:155], v[184:187], v[212:215], v[152:155]
ds_read_b128 v[196:199], v29 offset:2048
s_waitcnt lgkmcnt(2)
v_mfma_f32_16x16x32_bf16 v[124:127], v[188:191], v[228:231], 0
v_mfma_f32_16x16x32_bf16 v[140:143], v[188:191], v[232:235], 0
v_mfma_f32_16x16x32_bf16 v[156:159], v[188:191], v[236:239], 0
ds_read_b128 v[200:203], v30 offset:2048
s_waitcnt lgkmcnt(2)
v_mfma_f32_16x16x32_bf16 v[124:127], v[192:195], v[204:207], v[124:127]
v_mfma_f32_16x16x32_bf16 v[140:143], v[192:195], v[208:211], v[140:143]
v_mfma_f32_16x16x32_bf16 v[156:159], v[192:195], v[212:215], v[156:159]
ds_read_b128 v[216:219], v35 offset:2048
s_waitcnt vmcnt(4)
ds_read_b128 v[164:167], v29 offset:4096
s_waitcnt lgkmcnt(3)
v_mfma_f32_16x16x32_bf16 v[128:131], v[196:199], v[228:231], 0
ds_read_b128 v[220:223], v35 offset:10240
v_mfma_f32_16x16x32_bf16 v[144:147], v[196:199], v[232:235], 0
ds_read_b128 v[224:227], v35 offset:18432
v_mfma_f32_16x16x32_bf16 v[160:163], v[196:199], v[236:239], 0
ds_read_b128 v[228:231], v35 offset:3072
ds_read_b128 v[168:171], v30 offset:4096
s_waitcnt lgkmcnt(6)
v_mfma_f32_16x16x32_bf16 v[128:131], v[200:203], v[204:207], v[128:131]
ds_read_b128 v[232:235], v35 offset:11264
s_add_u32 m0, s63, 0x0
s_nop 0
buffer_load_dwordx4 v21, s[48:51], s78 offen offset:0 lds
buffer_load_dwordx4 v22, s[48:51], s78 offen offset:1024 lds
buffer_load_dwordx4 v23, s[48:51], s78 offen offset:2048 lds
buffer_load_dwordx4 v24, s[48:51], s78 offen offset:3072 lds
v_mfma_f32_16x16x32_bf16 v[144:147], v[200:203], v[208:211], v[144:147]
ds_read_b128 v[236:239], v35 offset:19456
v_mfma_f32_16x16x32_bf16 v[160:163], v[200:203], v[212:215], v[160:163]
ds_read_b128 v[172:175], v29 offset:6144
s_waitcnt lgkmcnt(7)
v_mfma_f32_16x16x32_bf16 v[116:119], v[164:167], v[216:219], v[116:119]
s_waitcnt lgkmcnt(6)
v_mfma_f32_16x16x32_bf16 v[132:135], v[164:167], v[220:223], v[132:135]
s_waitcnt lgkmcnt(5)
v_mfma_f32_16x16x32_bf16 v[148:151], v[164:167], v[224:227], v[148:151]
ds_read_b128 v[176:179], v30 offset:6144
s_waitcnt lgkmcnt(4)
v_mfma_f32_16x16x32_bf16 v[116:119], v[168:171], v[228:231], v[116:119]
s_waitcnt lgkmcnt(3)
v_mfma_f32_16x16x32_bf16 v[132:135], v[168:171], v[232:235], v[132:135]
s_waitcnt lgkmcnt(2)
v_mfma_f32_16x16x32_bf16 v[148:151], v[168:171], v[236:239], v[148:151]
s_waitcnt vmcnt(4)
ds_read_b128 v[180:183], v29 offset:8192
s_waitcnt lgkmcnt(2)
v_mfma_f32_16x16x32_bf16 v[120:123], v[172:175], v[216:219], v[120:123]
v_mfma_f32_16x16x32_bf16 v[136:139], v[172:175], v[220:223], v[136:139]
v_mfma_f32_16x16x32_bf16 v[152:155], v[172:175], v[224:227], v[152:155]
ds_read_b128 v[184:187], v30 offset:8192
s_waitcnt lgkmcnt(2)
v_mfma_f32_16x16x32_bf16 v[120:123], v[176:179], v[228:231], v[120:123]
s_add_u32 m0, s63, 0x1000
s_nop 0
buffer_load_dwordx4 v21, s[48:51], s79 offen offset:0 lds
buffer_load_dwordx4 v22, s[48:51], s79 offen offset:1024 lds
buffer_load_dwordx4 v23, s[48:51], s79 offen offset:2048 lds
buffer_load_dwordx4 v24, s[48:51], s79 offen offset:3072 lds
v_mfma_f32_16x16x32_bf16 v[136:139], v[176:179], v[232:235], v[136:139]
v_mfma_f32_16x16x32_bf16 v[152:155], v[176:179], v[236:239], v[152:155]
ds_read_b128 v[188:191], v29 offset:10240
s_waitcnt lgkmcnt(2)
v_mfma_f32_16x16x32_bf16 v[124:127], v[180:183], v[216:219], v[124:127]
v_mfma_f32_16x16x32_bf16 v[140:143], v[180:183], v[220:223], v[140:143]
v_mfma_f32_16x16x32_bf16 v[156:159], v[180:183], v[224:227], v[156:159]
ds_read_b128 v[192:195], v30 offset:10240
s_waitcnt lgkmcnt(2)
v_mfma_f32_16x16x32_bf16 v[124:127], v[184:187], v[228:231], v[124:127]
v_mfma_f32_16x16x32_bf16 v[140:143], v[184:187], v[232:235], v[140:143]
v_mfma_f32_16x16x32_bf16 v[156:159], v[184:187], v[236:239], v[156:159]
ds_read_b128 v[204:207], v35 offset:4096
s_waitcnt vmcnt(4)
ds_read_b128 v[196:199], v29 offset:0
s_waitcnt lgkmcnt(3)
v_mfma_f32_16x16x32_bf16 v[128:131], v[188:191], v[216:219], v[128:131]
ds_read_b128 v[208:211], v35 offset:12288
v_mfma_f32_16x16x32_bf16 v[144:147], v[188:191], v[220:223], v[144:147]
ds_read_b128 v[212:215], v35 offset:20480
v_mfma_f32_16x16x32_bf16 v[160:163], v[188:191], v[224:227], v[160:163]
ds_read_b128 v[216:219], v35 offset:5120
ds_read_b128 v[200:203], v30 offset:0
s_waitcnt lgkmcnt(6)
v_mfma_f32_16x16x32_bf16 v[128:131], v[192:195], v[228:231], v[128:131]
ds_read_b128 v[220:223], v35 offset:13312
s_add_u32 m0, s63, 0x2000
s_nop 0
buffer_load_dwordx4 v21, s[48:51], s80 offen offset:0 lds
buffer_load_dwordx4 v22, s[48:51], s80 offen offset:1024 lds
buffer_load_dwordx4 v23, s[48:51], s80 offen offset:2048 lds
buffer_load_dwordx4 v24, s[48:51], s80 offen offset:3072 lds
v_mfma_f32_16x16x32_bf16 v[144:147], v[192:195], v[232:235], v[144:147]
ds_read_b128 v[224:227], v35 offset:21504
v_mfma_f32_16x16x32_bf16 v[160:163], v[192:195], v[236:239], v[160:163]
ds_read_b128 v[164:167], v29 offset:2048
s_waitcnt lgkmcnt(7)
v_mfma_f32_16x16x32_bf16 v[116:119], v[196:199], v[204:207], v[116:119]
s_waitcnt lgkmcnt(6)
v_mfma_f32_16x16x32_bf16 v[132:135], v[196:199], v[208:211], v[132:135]
s_waitcnt lgkmcnt(5)
v_mfma_f32_16x16x32_bf16 v[148:151], v[196:199], v[212:215], v[148:151]
ds_read_b128 v[168:171], v30 offset:2048
s_waitcnt lgkmcnt(4)
v_mfma_f32_16x16x32_bf16 v[116:119], v[200:203], v[216:219], v[116:119]
s_waitcnt lgkmcnt(3)
v_mfma_f32_16x16x32_bf16 v[132:135], v[200:203], v[220:223], v[132:135]
s_waitcnt lgkmcnt(2)
v_mfma_f32_16x16x32_bf16 v[148:151], v[200:203], v[224:227], v[148:151]
s_waitcnt vmcnt(4)
ds_read_b128 v[172:175], v29 offset:4096
s_waitcnt lgkmcnt(2)
v_mfma_f32_16x16x32_bf16 v[120:123], v[164:167], v[204:207], v[120:123]
v_mfma_f32_16x16x32_bf16 v[136:139], v[164:167], v[208:211], v[136:139]
v_mfma_f32_16x16x32_bf16 v[152:155], v[164:167], v[212:215], v[152:155]
ds_read_b128 v[176:179], v30 offset:4096
s_waitcnt lgkmcnt(2)
v_mfma_f32_16x16x32_bf16 v[120:123], v[168:171], v[216:219], v[120:123]
s_add_u32 m0, s63, 0x0
s_nop 0
buffer_load_dwordx4 v21, s[48:51], s81 offen offset:0 lds
buffer_load_dwordx4 v22, s[48:51], s81 offen offset:1024 lds
buffer_load_dwordx4 v23, s[48:51], s81 offen offset:2048 lds
buffer_load_dwordx4 v24, s[48:51], s81 offen offset:3072 lds
v_mfma_f32_16x16x32_bf16 v[136:139], v[168:171], v[220:223], v[136:139]
buffer_store_dwordx4 v[44:47], v16, s[56:59], s64 offen offset:0 sc1
buffer_store_dwordx4 v[48:51], v16, s[56:59], s64 offen offset:1024 sc1
v_mfma_f32_16x16x32_bf16 v[152:155], v[168:171], v[224:227], v[152:155]
ds_read_b128 v[180:183], v29 offset:6144
buffer_store_dwordx4 v[52:55], v16, s[56:59], s64 offen offset:2048 sc1
s_waitcnt lgkmcnt(2)
v_mfma_f32_16x16x32_bf16 v[124:127], v[172:175], v[204:207], v[124:127]
buffer_store_dwordx4 v[56:59], v16, s[56:59], s64 offen offset:3072 sc1
buffer_store_dwordx4 v[60:63], v16, s[56:59], s65 offen offset:0 sc1
v_mfma_f32_16x16x32_bf16 v[140:143], v[172:175], v[208:211], v[140:143]
buffer_store_dwordx4 v[64:67], v16, s[56:59], s65 offen offset:1024 sc1
v_mfma_f32_16x16x32_bf16 v[156:159], v[172:175], v[212:215], v[156:159]
ds_read_b128 v[184:187], v30 offset:6144
s_waitcnt lgkmcnt(2)
v_mfma_f32_16x16x32_bf16 v[124:127], v[176:179], v[216:219], v[124:127]
v_mfma_f32_16x16x32_bf16 v[140:143], v[176:179], v[220:223], v[140:143]
v_mfma_f32_16x16x32_bf16 v[156:159], v[176:179], v[224:227], v[156:159]
ds_read_b128 v[228:231], v35 offset:6144
s_waitcnt vmcnt(10)
ds_read_b128 v[188:191], v29 offset:8192
s_waitcnt lgkmcnt(3)
v_mfma_f32_16x16x32_bf16 v[128:131], v[180:183], v[204:207], v[128:131]
ds_read_b128 v[232:235], v35 offset:14336
v_mfma_f32_16x16x32_bf16 v[144:147], v[180:183], v[208:211], v[144:147]
ds_read_b128 v[236:239], v35 offset:22528
v_mfma_f32_16x16x32_bf16 v[160:163], v[180:183], v[212:215], v[160:163]
ds_read_b128 v[204:207], v35 offset:7168
ds_read_b128 v[192:195], v30 offset:8192
s_waitcnt lgkmcnt(6)
v_mfma_f32_16x16x32_bf16 v[128:131], v[184:187], v[216:219], v[128:131]
ds_read_b128 v[208:211], v35 offset:15360
v_mfma_f32_16x16x32_bf16 v[144:147], v[184:187], v[220:223], v[144:147]
ds_read_b128 v[212:215], v35 offset:23552
v_mfma_f32_16x16x32_bf16 v[160:163], v[184:187], v[224:227], v[160:163]
ds_read_b128 v[196:199], v29 offset:10240
s_waitcnt lgkmcnt(7)
v_mfma_f32_16x16x32_bf16 v[116:119], v[188:191], v[228:231], v[116:119]
s_waitcnt lgkmcnt(6)
v_mfma_f32_16x16x32_bf16 v[132:135], v[188:191], v[232:235], v[132:135]
s_waitcnt lgkmcnt(5)
v_mfma_f32_16x16x32_bf16 v[148:151], v[188:191], v[236:239], v[148:151]
ds_read_b128 v[200:203], v30 offset:10240
s_waitcnt lgkmcnt(4)
v_mfma_f32_16x16x32_bf16 v[116:119], v[192:195], v[204:207], v[116:119]
s_waitcnt lgkmcnt(3)
v_mfma_f32_16x16x32_bf16 v[132:135], v[192:195], v[208:211], v[132:135]
s_waitcnt lgkmcnt(2)
v_mfma_f32_16x16x32_bf16 v[148:151], v[192:195], v[212:215], v[148:151]
s_waitcnt vmcnt(6)
ds_read_b128 v[164:167], v29 offset:0
s_waitcnt lgkmcnt(2)
v_mfma_f32_16x16x32_bf16 v[120:123], v[196:199], v[228:231], v[120:123]
v_mfma_f32_16x16x32_bf16 v[136:139], v[196:199], v[232:235], v[136:139]
v_mfma_f32_16x16x32_bf16 v[152:155], v[196:199], v[236:239], v[152:155]
ds_read_b128 v[168:171], v30 offset:0
s_waitcnt lgkmcnt(2)
v_mfma_f32_16x16x32_bf16 v[120:123], v[200:203], v[204:207], v[120:123]
v_mfma_f32_16x16x32_bf16 v[136:139], v[200:203], v[208:211], v[136:139]
v_mfma_f32_16x16x32_bf16 v[152:155], v[200:203], v[212:215], v[152:155]
ds_read_b128 v[172:175], v29 offset:2048
s_waitcnt lgkmcnt(2)
v_mfma_f32_16x16x32_bf16 v[124:127], v[164:167], v[228:231], v[124:127]
v_mul_f32 v116, s86, v116
v_mul_f32 v117, s86, v117
v_mul_f32 v118, s86, v118
v_mul_f32 v119, s86, v119
v_mul_f32 v120, s86, v120
v_mul_f32 v121, s86, v121
v_mul_f32 v122, s86, v122
v_mul_f32 v123, s86, v123
v_cvt_pk_bf16_f32 v116, v116, v117
v_cvt_pk_bf16_f32 v117, v118, v119
v_cvt_pk_bf16_f32 v118, v120, v121
v_cvt_pk_bf16_f32 v119, v122, v123
buffer_store_dwordx4 v[116:119], v16, s[52:55], s82 offen offset:0 sc1
v_mfma_f32_16x16x32_bf16 v[140:143], v[164:167], v[232:235], v[140:143]
v_mul_f32 v132, s86, v132
v_mul_f32 v133, s86, v133
v_mul_f32 v134, s86, v134
v_mul_f32 v135, s86, v135
v_mul_f32 v136, s86, v136
v_mul_f32 v137, s86, v137
v_mul_f32 v138, s86, v138
v_mul_f32 v139, s86, v139
v_cvt_pk_bf16_f32 v132, v132, v133
v_cvt_pk_bf16_f32 v133, v134, v135
v_cvt_pk_bf16_f32 v134, v136, v137
v_cvt_pk_bf16_f32 v135, v138, v139
buffer_store_dwordx4 v[132:135], v16, s[52:55], s83 offen offset:0 sc1
v_mfma_f32_16x16x32_bf16 v[156:159], v[164:167], v[236:239], v[156:159]
ds_read_b128 v[176:179], v30 offset:2048
v_mul_f32 v148, s86, v148
v_mul_f32 v149, s86, v149
v_mul_f32 v150, s86, v150
v_mul_f32 v151, s86, v151
v_mul_f32 v152, s86, v152
v_mul_f32 v153, s86, v153
v_mul_f32 v154, s86, v154
v_mul_f32 v155, s86, v155
v_cvt_pk_bf16_f32 v148, v148, v149
v_cvt_pk_bf16_f32 v149, v150, v151
v_cvt_pk_bf16_f32 v150, v152, v153
v_cvt_pk_bf16_f32 v151, v154, v155
buffer_store_dwordx4 v[148:151], v16, s[52:55], s84 offen offset:0 sc1
s_waitcnt lgkmcnt(2)
v_mfma_f32_16x16x32_bf16 v[124:127], v[168:171], v[204:207], v[124:127]
v_mfma_f32_16x16x32_bf16 v[140:143], v[168:171], v[208:211], v[140:143]
v_mfma_f32_16x16x32_bf16 v[156:159], v[168:171], v[212:215], v[156:159]
s_waitcnt lgkmcnt(1)
v_mfma_f32_16x16x32_bf16 v[128:131], v[172:175], v[228:231], v[128:131]
v_mfma_f32_16x16x32_bf16 v[144:147], v[172:175], v[232:235], v[144:147]
v_mfma_f32_16x16x32_bf16 v[160:163], v[172:175], v[236:239], v[160:163]
s_waitcnt lgkmcnt(0)
v_mfma_f32_16x16x32_bf16 v[128:131], v[176:179], v[204:207], v[128:131]
v_mfma_f32_16x16x32_bf16 v[144:147], v[176:179], v[208:211], v[144:147]
v_mfma_f32_16x16x32_bf16 v[160:163], v[176:179], v[212:215], v[160:163]
v_mul_f32 v124, s86, v124
v_mul_f32 v125, s86, v125
v_mul_f32 v126, s86, v126
v_mul_f32 v127, s86, v127
s_nop 1
v_mul_f32 v128, s86, v128
v_mul_f32 v129, s86, v129
v_mul_f32 v130, s86, v130
v_mul_f32 v131, s86, v131
v_cvt_pk_bf16_f32 v124, v124, v125
v_cvt_pk_bf16_f32 v125, v126, v127
v_cvt_pk_bf16_f32 v126, v128, v129
v_cvt_pk_bf16_f32 v127, v130, v131
buffer_store_dwordx4 v[124:127], v16, s[52:55], s82 offen offset:1024 sc1
v_mul_f32 v140, s86, v140
v_mul_f32 v141, s86, v141
v_mul_f32 v142, s86, v142
v_mul_f32 v143, s86, v143
v_mul_f32 v144, s86, v144
v_mul_f32 v145, s86, v145
v_mul_f32 v146, s86, v146
v_mul_f32 v147, s86, v147
v_cvt_pk_bf16_f32 v140, v140, v141
v_cvt_pk_bf16_f32 v141, v142, v143
v_cvt_pk_bf16_f32 v142, v144, v145
v_cvt_pk_bf16_f32 v143, v146, v147
buffer_store_dwordx4 v[140:143], v16, s[52:55], s83 offen offset:1024 sc1
v_mul_f32 v156, s86, v156
v_mul_f32 v157, s86, v157
v_mul_f32 v158, s86, v158
v_mul_f32 v159, s86, v159
v_mul_f32 v160, s86, v160
v_mul_f32 v161, s86, v161
v_mul_f32 v162, s86, v162
v_mul_f32 v163, s86, v163
v_cvt_pk_bf16_f32 v156, v156, v157
v_cvt_pk_bf16_f32 v157, v158, v159
v_cvt_pk_bf16_f32 v158, v160, v161
v_cvt_pk_bf16_f32 v159, v162, v163
buffer_store_dwordx4 v[156:159], v16, s[52:55], s84 offen offset:1024 sc1
L1_fin:
s_add_u32 s91, s91, 1344
s_waitcnt lgkmcnt(0)
s_add_u32 s98, s98, 0x7f4a7c15
s_addc_u32 s99, s99, 0x9e3779b9
LM_pub:
s_add_u32 s40, s38, 0x7c00000
s_addc_u32 s41, s39, 0
s_mov_b32 s42, 0x40000
s_mov_b32 s43, 0x00020000
s_lshl_b32 s6, s91, 7
s_cmp_eq_u32 s60, 0
s_cselect_b32 s6, s6, 0x70000000
s_waitcnt vmcnt(0) lgkmcnt(0)
s_barrier
v_mov_b32 v6, s98
v_mov_b32 v7, s99
s_mov_b64 exec, 1
buffer_store_dwordx2 v[6:7], off, s[40:43], s6 sc1
s_mov_b64 exec, -1
s_cmp_eq_u32 s61, 0
s_cbranch_scc1 L2_entry
s_mov_b32 s61, 0
s_sub_u32 s4, s91, 1578
s_min_u32 s6, s4, 14
s_cmp_lt_u32 s4, 6
s_cselect_b32 s6, 0, s6
s_sub_u32 s4, s4, s6
s_add_u32 s91, s4, 1600
v_lshlrev_b32 v16, 4, v2
s_mul_i32 s63, s60, 12288
s_and_b32 s6, s4, 3
s_lshl_b32 s6, s6, 6
s_mul_i32 s7, s60, 16
s_add_u32 s6, s6, s7
v_lshrrev_b32 v5, 5, v2
v_and_b32 v6, 31, v2
v_lshlrev_b32 v6, 4, v6
s_cmp_ge_u32 s4, 4
s_cselect_b64 vcc, -1, 0
v_add3_u32 v7, v5, s6, 0
v_and_b32 v8, 0x80, v7
v_bfe_u32 v9, v7, 2, 1
v_lshl_or_b32 v8, v9, 6, v8
v_bfe_u32 v9, v7, 4, 1
v_lshl_or_b32 v8, v9, 5, v8
v_and_b32 v9, 3, v7
v_lshl_or_b32 v8, v9, 3, v8
v_bfe_u32 v9, v7, 5, 2
v_lshl_or_b32 v8, v9, 1, v8
v_bfe_u32 v9, v7, 3, 1
v_or_b32 v8, v9, v8
v_cndmask_b32 v8, v8, v7, vcc
v_lshl_add_u32 v44, v8, 9, v6
v_add3_u32 v7, v5, s6, 2
v_and_b32 v8, 0x80, v7
v_bfe_u32 v9, v7, 2, 1
v_lshl_or_b32 v8, v9, 6, v8
v_bfe_u32 v9, v7, 4, 1
v_lshl_or_b32 v8, v9, 5, v8
v_and_b32 v9, 3, v7
v_lshl_or_b32 v8, v9, 3, v8
v_bfe_u32 v9, v7, 5, 2
v_lshl_or_b32 v8, v9, 1, v8
v_bfe_u32 v9, v7, 3, 1
v_or_b32 v8, v9, v8
v_cndmask_b32 v8, v8, v7, vcc
v_lshl_add_u32 v48, v8, 9, v6
v_add3_u32 v7, v5, s6, 4
v_and_b32 v8, 0x80, v7
v_bfe_u32 v9, v7, 2, 1
v_lshl_or_b32 v8, v9, 6, v8
v_bfe_u32 v9, v7, 4, 1
v_lshl_or_b32 v8, v9, 5, v8
v_and_b32 v9, 3, v7
v_lshl_or_b32 v8, v9, 3, v8
v_bfe_u32 v9, v7, 5, 2
v_lshl_or_b32 v8, v9, 1, v8
v_bfe_u32 v9, v7, 3, 1
v_or_b32 v8, v9, v8
v_cndmask_b32 v8, v8, v7, vcc
v_lshl_add_u32 v52, v8, 9, v6
v_add3_u32 v7, v5, s6, 6
v_and_b32 v8, 0x80, v7
v_bfe_u32 v9, v7, 2, 1
v_lshl_or_b32 v8, v9, 6, v8
v_bfe_u32 v9, v7, 4, 1
v_lshl_or_b32 v8, v9, 5, v8
v_and_b32 v9, 3, v7
v_lshl_or_b32 v8, v9, 3, v8
v_bfe_u32 v9, v7, 5, 2
v_lshl_or_b32 v8, v9, 1, v8
v_bfe_u32 v9, v7, 3, 1
v_or_b32 v8, v9, v8
v_cndmask_b32 v8, v8, v7, vcc
v_lshl_add_u32 v56, v8, 9, v6
v_add3_u32 v7, v5, s6, 8
v_and_b32 v8, 0x80, v7
v_bfe_u32 v9, v7, 2, 1
v_lshl_or_b32 v8, v9, 6, v8
v_bfe_u32 v9, v7, 4, 1
v_lshl_or_b32 v8, v9, 5, v8
v_and_b32 v9, 3, v7
v_lshl_or_b32 v8, v9, 3, v8
v_bfe_u32 v9, v7, 5, 2
v_lshl_or_b32 v8, v9, 1, v8
v_bfe_u32 v9, v7, 3, 1
v_or_b32 v8, v9, v8
v_cndmask_b32 v8, v8, v7, vcc
v_lshl_add_u32 v60, v8, 9, v6
v_add3_u32 v7, v5, s6, 10
v_and_b32 v8, 0x80, v7
v_bfe_u32 v9, v7, 2, 1
v_lshl_or_b32 v8, v9, 6, v8
v_bfe_u32 v9, v7, 4, 1
v_lshl_or_b32 v8, v9, 5, v8
v_and_b32 v9, 3, v7
v_lshl_or_b32 v8, v9, 3, v8
v_bfe_u32 v9, v7, 5, 2
v_lshl_or_b32 v8, v9, 1, v8
v_bfe_u32 v9, v7, 3, 1
v_or_b32 v8, v9, v8
v_cndmask_b32 v8, v8, v7, vcc
v_lshl_add_u32 v64, v8, 9, v6
v_add3_u32 v7, v5, s6, 12
v_and_b32 v8, 0x80, v7
v_bfe_u32 v9, v7, 2, 1
v_lshl_or_b32 v8, v9, 6, v8
v_bfe_u32 v9, v7, 4, 1
v_lshl_or_b32 v8, v9, 5, v8
v_and_b32 v9, 3, v7
v_lshl_or_b32 v8, v9, 3, v8
v_bfe_u32 v9, v7, 5, 2
v_lshl_or_b32 v8, v9, 1, v8
v_bfe_u32 v9, v7, 3, 1
v_or_b32 v8, v9, v8
v_cndmask_b32 v8, v8, v7, vcc
v_lshl_add_u32 v68, v8, 9, v6
v_add3_u32 v7, v5, s6, 14
v_and_b32 v8, 0x80, v7
v_bfe_u32 v9, v7, 2, 1
v_lshl_or_b32 v8, v9, 6, v8
v_bfe_u32 v9, v7, 4, 1
v_lshl_or_b32 v8, v9, 5, v8
v_and_b32 v9, 3, v7
v_lshl_or_b32 v8, v9, 3, v8
v_bfe_u32 v9, v7, 5, 2
v_lshl_or_b32 v8, v9, 1, v8
v_bfe_u32 v9, v7, 3, 1
v_or_b32 v8, v9, v8
v_cndmask_b32 v8, v8, v7, vcc
v_lshl_add_u32 v72, v8, 9, v6
s_lshl_b32 s7, s60, 7
v_lshrrev_b32 v5, 3, v2
v_and_b32 v6, 7, v2
v_and_b32 v7, 2, v5
v_xor_b32 v6, v6, v7
v_lshl_add_u32 v5, v5, 9, s7
v_lshl_add_u32 v17, v6, 4, v5
v_xor_b32 v6, 4, v6
v_lshl_add_u32 v18, v6, 4, v5
v_add_u32 v18, 0xc00, v18
v_add_u32 v19, 0x1800, v17
v_add_u32 v20, 0x1800, v18
s_xor_b32 s6, s62, 0
s_lshl_b32 s66, s6, 14
s_xor_b32 s6, s62, 1
s_lshl_b32 s67, s6, 14
s_xor_b32 s6, s62, 2
s_lshl_b32 s68, s6, 14
s_xor_b32 s6, s62, 3
s_lshl_b32 s69, s6, 14
s_xor_b32 s6, s62, 4
s_lshl_b32 s70, s6, 14
s_xor_b32 s6, s62, 5
s_lshl_b32 s71, s6, 14
s_xor_b32 s6, s62, 6
s_lshl_b32 s72, s6, 14
s_xor_b32 s6, s62, 7
s_lshl_b32 s73, s6, 14
s_waitcnt lgkmcnt(0)
s_cmp_ge_u32 s4, 4
s_cselect_b32 s6, s30, s24
s_cselect_b32 s7, s31, s25
s_add_u32 s40, s6, 0x0
s_addc_u32 s41, s7, 0
s_mov_b32 s42, 0x20000
s_mov_b32 s43, 0x00020000
s_add_u32 s44, s32, 0x0
s_addc_u32 s45, s33, 0
s_mov_b32 s46, 0x20000
s_mov_b32 s47, 0x00020000
buffer_load_dwordx4 v[44:47], v44, s[40:43], 0 offen
buffer_load_dwordx4 v[48:51], v48, s[40:43], 0 offen
buffer_load_dwordx4 v[52:55], v52, s[40:43], 0 offen
buffer_load_dwordx4 v[56:59], v56, s[40:43], 0 offen
buffer_load_dwordx4 v[60:63], v60, s[40:43], 0 offen
buffer_load_dwordx4 v[64:67], v64, s[40:43], 0 offen
buffer_load_dwordx4 v[68:71], v68, s[40:43], 0 offen
buffer_load_dwordx4 v[72:75], v72, s[40:43], 0 offen
s_add_u32 m0, s63, 0x0
s_nop 0
buffer_load_dwordx4 v17, s[44:47], s66 offen offset:0 lds
buffer_load_dwordx4 v18, s[44:47], s66 offen offset:1024 lds
buffer_load_dwordx4 v19, s[44:47], s66 offen offset:2048 lds
buffer_load_dwordx4 v20, s[44:47], s66 offen offset:3072 lds
s_add_u32 m0, s63, 0x1000
s_nop 0
buffer_load_dwordx4 v17, s[44:47], s67 offen offset:0 lds
buffer_load_dwordx4 v18, s[44:47], s67 offen offset:1024 lds
buffer_load_dwordx4 v19, s[44:47], s67 offen offset:2048 lds
buffer_load_dwordx4 v20, s[44:47], s67 offen offset:3072 lds
v_bfe_u32 v5, v2, 2, 3
v_xor_b32 v5, s62, v5
v_and_b32 v6, 3, v2
v_lshlrev_b32 v7, 10, v5
v_lshl_add_u32 v7, v6, 8, v7
v_add_u32 v7, 0xc000, v7
v_and_b32 v5, 1, v5
v_lshl_or_b32 v6, v5, 2, v6
v_lshrrev_b32 v5, 5, v2
s_mul_i32 s6, s60, 16
v_add3_u32 v8, v5, s6, 0
v_lshrrev_b32 v9, 4, v8
v_lshl_add_u32 v9, v9, 13, v7
v_and_b32 v8, 15, v8
v_xor_b32 v8, v8, v6
v_lshl_add_u32 v36, v8, 4, v9
v_add3_u32 v8, v5, s6, 2
v_lshrrev_b32 v9, 4, v8
v_lshl_add_u32 v9, v9, 13, v7
v_and_b32 v8, 15, v8
v_xor_b32 v8, v8, v6
v_lshl_add_u32 v37, v8, 4, v9
v_add3_u32 v8, v5, s6, 4
v_lshrrev_b32 v9, 4, v8
v_lshl_add_u32 v9, v9, 13, v7
v_and_b32 v8, 15, v8
v_xor_b32 v8, v8, v6
v_lshl_add_u32 v38, v8, 4, v9
v_add3_u32 v8, v5, s6, 6
v_lshrrev_b32 v9, 4, v8
v_lshl_add_u32 v9, v9, 13, v7
v_and_b32 v8, 15, v8
v_xor_b32 v8, v8, v6
v_lshl_add_u32 v39, v8, 4, v9
v_add3_u32 v8, v5, s6, 8
v_lshrrev_b32 v9, 4, v8
v_lshl_add_u32 v9, v9, 13, v7
v_and_b32 v8, 15, v8
v_xor_b32 v8, v8, v6
v_lshl_add_u32 v40, v8, 4, v9
v_add3_u32 v8, v5, s6, 10
v_lshrrev_b32 v9, 4, v8
v_lshl_add_u32 v9, v9, 13, v7
v_and_b32 v8, 15, v8
v_xor_b32 v8, v8, v6
v_lshl_add_u32 v41, v8, 4, v9
v_add3_u32 v8, v5, s6, 12
v_lshrrev_b32 v9, 4, v8
v_lshl_add_u32 v9, v9, 13, v7
v_and_b32 v8, 15, v8
v_xor_b32 v8, v8, v6
v_lshl_add_u32 v42, v8, 4, v9
v_add3_u32 v8, v5, s6, 14
v_lshrrev_b32 v9, 4, v8
v_lshl_add_u32 v9, v9, 13, v7
v_and_b32 v8, 15, v8
v_xor_b32 v8, v8, v6
v_lshl_add_u32 v43, v8, 4, v9
v_xor_b32 v5, v3, v4
v_lshlrev_b32 v5, 4, v5
v_lshl_add_u32 v5, v4, 8, v5
v_add_u32 v31, 0xc000, v5
v_xor_b32 v32, 64, v31
v_lshrrev_b32 v5, 2, v3
v_and_b32 v6, 3, v3
v_and_b32 v7, 1, v4
v_lshlrev_b32 v7, 2, v7
v_and_b32 v8, 2, v5
v_or_b32 v7, v7, v8
v_lshl_add_u32 v8, v4, 3, v5
v_lshlrev_b32 v8, 7, v8
v_add_u32 v8, s63, v8
v_xor_b32 v6, v6, v7
v_xor_b32 v9, 0, v6
v_lshl_add_u32 v25, v9, 4, v8
v_add_u32 v26, 8, v25
v_xor_b32 v9, 4, v6
v_lshl_add_u32 v27, v9, 4, v8
v_add_u32 v28, 8, v27
s_lshr_b32 s6, s4, 2
s_lshl_b32 s6, s6, 17
s_and_b32 s7, s4, 3
s_lshl_b32 s7, s7, 12
s_add_u32 s6, s6, s7
s_mul_i32 s7, s60, 32768
s_add_u32 s82, s6, s7
s_add_u32 s83, s82, 16384
s_add_u32 s52, s38, 0x1000000
s_addc_u32 s53, s39, 0
s_mov_b32 s54, 0x40000
s_mov_b32 s55, 0x00020000
s_waitcnt vmcnt(15)
ds_write_b128 v36, v[44:47]
s_waitcnt vmcnt(14)
ds_write_b128 v37, v[48:51]
s_waitcnt vmcnt(13)
ds_write_b128 v38, v[52:55]
s_waitcnt vmcnt(12)
ds_write_b128 v39, v[56:59]
s_waitcnt vmcnt(11)
ds_write_b128 v40, v[60:63]
s_waitcnt vmcnt(10)
ds_write_b128 v41, v[64:67]
s_waitcnt vmcnt(9)
ds_write_b128 v42, v[68:71]
s_waitcnt vmcnt(8)
ds_write_b128 v43, v[72:75]
s_add_u32 m0, s63, 0x2000
s_nop 0
buffer_load_dwordx4 v17, s[44:47], s68 offen offset:0 lds
buffer_load_dwordx4 v18, s[44:47], s68 offen offset:1024 lds
buffer_load_dwordx4 v19, s[44:47], s68 offen offset:2048 lds
buffer_load_dwordx4 v20, s[44:47], s68 offen offset:3072 lds
s_waitcnt vmcnt(8)
ds_read_b64_tr_b16 v[140:141], v25 offset:0
ds_read_b64_tr_b16 v[142:143], v25 offset:512
ds_read_b64_tr_b16 v[144:145], v26 offset:0
ds_read_b64_tr_b16 v[146:147], v26 offset:512
ds_read_b64_tr_b16 v[148:149], v27 offset:0
ds_read_b64_tr_b16 v[150:151], v27 offset:512
s_waitcnt lgkmcnt(6)
s_barrier
ds_read_b128 v[180:183], v31 offset:0
ds_read_b128 v[184:187], v31 offset:8192
ds_read_b128 v[188:191], v31 offset:16384
ds_read_b128 v[192:195], v31 offset:24576
s_waitcnt lgkmcnt(3)
v_mfma_f32_16x16x32_bf16 v[76:79], v[180:183], v[140:143], 0
s_waitcnt lgkmcnt(2)
v_mfma_f32_16x16x32_bf16 v[80:83], v[184:187], v[140:143], 0
s_waitcnt lgkmcnt(1)
v_mfma_f32_16x16x32_bf16 v[84:87], v[188:191], v[140:143], 0
s_waitcnt lgkmcnt(0)
v_mfma_f32_16x16x32_bf16 v[88:91], v[192:195], v[140:143], 0
ds_read_b64_tr_b16 v[152:153], v28 offset:0
ds_read_b64_tr_b16 v[154:155], v28 offset:512
v_mfma_f32_16x16x32_bf16 v[92:95], v[180:183], v[144:147], 0
v_mfma_f32_16x16x32_bf16 v[96:99], v[184:187], v[144:147], 0
v_mfma_f32_16x16x32_bf16 v[100:103], v[188:191], v[144:147], 0
v_mfma_f32_16x16x32_bf16 v[104:107], v[192:195], v[144:147], 0
ds_read_b128 v[196:199], v32 offset:1024
s_waitcnt vmcnt(4)
ds_read_b64_tr_b16 v[156:157], v25 offset:4096
ds_read_b64_tr_b16 v[158:159], v25 offset:4608
v_mfma_f32_16x16x32_bf16 v[108:111], v[180:183], v[148:151], 0
ds_read_b128 v[200:203], v32 offset:9216
v_mfma_f32_16x16x32_bf16 v[112:115], v[184:187], v[148:151], 0
ds_read_b128 v[204:207], v32 offset:17408
v_mfma_f32_16x16x32_bf16 v[116:119], v[188:191], v[148:151], 0
ds_read_b128 v[208:211], v32 offset:25600
v_mfma_f32_16x16x32_bf16 v[120:123], v[192:195], v[148:151], 0
ds_read_b64_tr_b16 v[160:161], v26 offset:4096
ds_read_b64_tr_b16 v[162:163], v26 offset:4608
s_waitcnt lgkmcnt(8)
v_mfma_f32_16x16x32_bf16 v[124:127], v[180:183], v[152:155], 0
s_add_u32 m0, s63, 0x0
s_nop 0
buffer_load_dwordx4 v17, s[44:47], s69 offen offset:0 lds
buffer_load_dwordx4 v18, s[44:47], s69 offen offset:1024 lds
buffer_load_dwordx4 v19, s[44:47], s69 offen offset:2048 lds
buffer_load_dwordx4 v20, s[44:47], s69 offen offset:3072 lds
v_mfma_f32_16x16x32_bf16 v[128:131], v[184:187], v[152:155], 0
v_mfma_f32_16x16x32_bf16 v[132:135], v[188:191], v[152:155], 0
v_mfma_f32_16x16x32_bf16 v[136:139], v[192:195], v[152:155], 0
ds_read_b64_tr_b16 v[164:165], v27 offset:4096
ds_read_b64_tr_b16 v[166:167], v27 offset:4608
s_waitcnt lgkmcnt(7)
v_mfma_f32_16x16x32_bf16 v[76:79], v[196:199], v[156:159], v[76:79]
s_waitcnt lgkmcnt(6)
v_mfma_f32_16x16x32_bf16 v[80:83], v[200:203], v[156:159], v[80:83]
s_waitcnt lgkmcnt(5)
v_mfma_f32_16x16x32_bf16 v[84:87], v[204:207], v[156:159], v[84:87]
s_waitcnt lgkmcnt(4)
v_mfma_f32_16x16x32_bf16 v[88:91], v[208:211], v[156:159], v[88:91]
ds_read_b64_tr_b16 v[168:169], v28 offset:4096
ds_read_b64_tr_b16 v[170:171], v28 offset:4608
s_waitcnt lgkmcnt(4)
v_mfma_f32_16x16x32_bf16 v[92:95], v[196:199], v[160:163], v[92:95]
v_mfma_f32_16x16x32_bf16 v[96:99], v[200:203], v[160:163], v[96:99]
v_mfma_f32_16x16x32_bf16 v[100:103], v[204:207], v[160:163], v[100:103]
v_mfma_f32_16x16x32_bf16 v[104:107], v[208:211], v[160:163], v[104:107]
ds_read_b128 v[212:215], v31 offset:2048
s_waitcnt vmcnt(4)
ds_read_b64_tr_b16 v[172:173], v25 offset:8192
ds_read_b64_tr_b16 v[174:175], v25 offset:8704
s_waitcnt lgkmcnt(5)
v_mfma_f32_16x16x32_bf16 v[108:111], v[196:199], v[164:167], v[108:111]
ds_read_b128 v[216:219], v31 offset:10240
v_mfma_f32_16x16x32_bf16 v[112:115], v[200:203], v[164:167], v[112:115]
ds_read_b128 v[220:223], v31 offset:18432
v_mfma_f32_16x16x32_bf16 v[116:119], v[204:207], v[164:167], v[116:119]
ds_read_b128 v[224:227], v31 offset:26624
v_mfma_f32_16x16x32_bf16 v[120:123], v[208:211], v[164:167], v[120:123]
ds_read_b64_tr_b16 v[176:177], v26 offset:8192
ds_read_b64_tr_b16 v[178:179], v26 offset:8704
s_waitcnt lgkmcnt(8)
v_mfma_f32_16x16x32_bf16 v[124:127], v[196:199], v[168:171], v[124:127]
s_add_u32 m0, s63, 0x1000
s_nop 0
buffer_load_dwordx4 v17, s[44:47], s70 offen offset:0 lds
buffer_load_dwordx4 v18, s[44:47], s70 offen offset:1024 lds
buffer_load_dwordx4 v19, s[44:47], s70 offen offset:2048 lds
buffer_load_dwordx4 v20, s[44:47], s70 offen offset:3072 lds
v_mfma_f32_16x16x32_bf16 v[128:131], v[200:203], v[168:171], v[128:131]
v_mfma_f32_16x16x32_bf16 v[132:135], v[204:207], v[168:171], v[132:135]
v_mfma_f32_16x16x32_bf16 v[136:139], v[208:211], v[168:171], v[136:139]
ds_read_b64_tr_b16 v[140:141], v27 offset:8192
ds_read_b64_tr_b16 v[142:143], v27 offset:8704
s_waitcnt lgkmcnt(7)
v_mfma_f32_16x16x32_bf16 v[76:79], v[212:215], v[172:175], v[76:79]
s_waitcnt lgkmcnt(6)
v_mfma_f32_16x16x32_bf16 v[80:83], v[216:219], v[172:175], v[80:83]
s_waitcnt lgkmcnt(5)
v_mfma_f32_16x16x32_bf16 v[84:87], v[220:223], v[172:175], v[84:87]
s_waitcnt lgkmcnt(4)
v_mfma_f32_16x16x32_bf16 v[88:91], v[224:227], v[172:175], v[88:91]
ds_read_b64_tr_b16 v[144:145], v28 offset:8192
ds_read_b64_tr_b16 v[146:147], v28 offset:8704
s_waitcnt lgkmcnt(4)
v_mfma_f32_16x16x32_bf16 v[92:95], v[212:215], v[176:179], v[92:95]
v_mfma_f32_16x16x32_bf16 v[96:99], v[216:219], v[176:179], v[96:99]
v_mfma_f32_16x16x32_bf16 v[100:103], v[220:223], v[176:179], v[100:103]
v_mfma_f32_16x16x32_bf16 v[104:107], v[224:227], v[176:179], v[104:107]
ds_read_b128 v[180:183], v32 offset:3072
s_waitcnt vmcnt(4)
ds_read_b64_tr_b16 v[148:149], v25 offset:0
ds_read_b64_tr_b16 v[150:151], v25 offset:512
s_waitcnt lgkmcnt(5)
v_mfma_f32_16x16x32_bf16 v[108:111], v[212:215], v[140:143], v[108:111]
ds_read_b128 v[184:187], v32 offset:11264
v_mfma_f32_16x16x32_bf16 v[112:115], v[216:219], v[140:143], v[112:115]
ds_read_b128 v[188:191], v32 offset:19456
v_mfma_f32_16x16x32_bf16 v[116:119], v[220:223], v[140:143], v[116:119]
ds_read_b128 v[192:195], v32 offset:27648
v_mfma_f32_16x16x32_bf16 v[120:123], v[224:227], v[140:143], v[120:123]
ds_read_b64_tr_b16 v[152:153], v26 offset:0
ds_read_b64_tr_b16 v[154:155], v26 offset:512
s_waitcnt lgkmcnt(8)
v_mfma_f32_16x16x32_bf16 v[124:127], v[212:215], v[144:147], v[124:127]
s_add_u32 m0, s63, 0x2000
s_nop 0
buffer_load_dwordx4 v17, s[44:47], s71 offen offset:0 lds
buffer_load_dwordx4 v18, s[44:47], s71 offen offset:1024 lds
buffer_load_dwordx4 v19, s[44:47], s71 offen offset:2048 lds
buffer_load_dwordx4 v20, s[44:47], s71 offen offset:3072 lds
v_mfma_f32_16x16x32_bf16 v[128:131], v[216:219], v[144:147], v[128:131]
v_mfma_f32_16x16x32_bf16 v[132:135], v[220:223], v[144:147], v[132:135]
v_mfma_f32_16x16x32_bf16 v[136:139], v[224:227], v[144:147], v[136:139]
ds_read_b64_tr_b16 v[156:157], v27 offset:0
ds_read_b64_tr_b16 v[158:159], v27 offset:512
s_waitcnt lgkmcnt(7)
v_mfma_f32_16x16x32_bf16 v[76:79], v[180:183], v[148:151], v[76:79]
s_waitcnt lgkmcnt(6)
v_mfma_f32_16x16x32_bf16 v[80:83], v[184:187], v[148:151], v[80:83]
s_waitcnt lgkmcnt(5)
v_mfma_f32_16x16x32_bf16 v[84:87], v[188:191], v[148:151], v[84:87]
s_waitcnt lgkmcnt(4)
v_mfma_f32_16x16x32_bf16 v[88:91], v[192:195], v[148:151], v[88:91]
ds_read_b64_tr_b16 v[160:161], v28 offset:0
ds_read_b64_tr_b16 v[162:163], v28 offset:512
s_waitcnt lgkmcnt(4)
v_mfma_f32_16x16x32_bf16 v[92:95], v[180:183], v[152:155], v[92:95]
v_mfma_f32_16x16x32_bf16 v[96:99], v[184:187], v[152:155], v[96:99]
v_mfma_f32_16x16x32_bf16 v[100:103], v[188:191], v[152:155], v[100:103]
v_mfma_f32_16x16x32_bf16 v[104:107], v[192:195], v[152:155], v[104:107]
ds_read_b128 v[196:199], v31 offset:4096
s_waitcnt vmcnt(4)
ds_read_b64_tr_b16 v[164:165], v25 offset:4096
ds_read_b64_tr_b16 v[166:167], v25 offset:4608
s_waitcnt lgkmcnt(5)
v_mfma_f32_16x16x32_bf16 v[108:111], v[180:183], v[156:159], v[108:111]
ds_read_b128 v[200:203], v31 offset:12288
v_mfma_f32_16x16x32_bf16 v[112:115], v[184:187], v[156:159], v[112:115]
ds_read_b128 v[204:207], v31 offset:20480
v_mfma_f32_16x16x32_bf16 v[116:119], v[188:191], v[156:159], v[116:119]
ds_read_b128 v[208:211], v31 offset:28672
v_mfma_f32_16x16x32_bf16 v[120:123], v[192:195], v[156:159], v[120:123]
ds_read_b64_tr_b16 v[168:169], v26 offset:4096
ds_read_b64_tr_b16 v[170:171], v26 offset:4608
s_waitcnt lgkmcnt(8)
v_mfma_f32_16x16x32_bf16 v[124:127], v[180:183], v[160:163], v[124:127]
s_add_u32 m0, s63, 0x0
s_nop 0
buffer_load_dwordx4 v17, s[44:47], s72 offen offset:0 lds
buffer_load_dwordx4 v18, s[44:47], s72 offen offset:1024 lds
buffer_load_dwordx4 v19, s[44:47], s72 offen offset:2048 lds
buffer_load_dwordx4 v20, s[44:47], s72 offen offset:3072 lds
v_mfma_f32_16x16x32_bf16 v[128:131], v[184:187], v[160:163], v[128:131]
v_mfma_f32_16x16x32_bf16 v[132:135], v[188:191], v[160:163], v[132:135]
v_mfma_f32_16x16x32_bf16 v[136:139], v[192:195], v[160:163], v[136:139]
ds_read_b64_tr_b16 v[172:173], v27 offset:4096
ds_read_b64_tr_b16 v[174:175], v27 offset:4608
s_waitcnt lgkmcnt(7)
v_mfma_f32_16x16x32_bf16 v[76:79], v[196:199], v[164:167], v[76:79]
s_waitcnt lgkmcnt(6)
v_mfma_f32_16x16x32_bf16 v[80:83], v[200:203], v[164:167], v[80:83]
s_waitcnt lgkmcnt(5)
v_mfma_f32_16x16x32_bf16 v[84:87], v[204:207], v[164:167], v[84:87]
s_waitcnt lgkmcnt(4)
v_mfma_f32_16x16x32_bf16 v[88:91], v[208:211], v[164:167], v[88:91]
ds_read_b64_tr_b16 v[176:177], v28 offset:4096
ds_read_b64_tr_b16 v[178:179], v28 offset:4608
s_waitcnt lgkmcnt(4)
v_mfma_f32_16x16x32_bf16 v[92:95], v[196:199], v[168:171], v[92:95]
v_mfma_f32_16x16x32_bf16 v[96:99], v[200:203], v[168:171], v[96:99]
v_mfma_f32_16x16x32_bf16 v[100:103], v[204:207], v[168:171], v[100:103]
v_mfma_f32_16x16x32_bf16 v[104:107], v[208:211], v[168:171], v[104:107]
ds_read_b128 v[212:215], v32 offset:5120
s_waitcnt vmcnt(4)
ds_read_b64_tr_b16 v[140:141], v25 offset:8192
ds_read_b64_tr_b16 v[142:143], v25 offset:8704
s_waitcnt lgkmcnt(5)
v_mfma_f32_16x16x32_bf16 v[108:111], v[196:199], v[172:175], v[108:111]
ds_read_b128 v[216:219], v32 offset:13312
v_mfma_f32_16x16x32_bf16 v[112:115], v[200:203], v[172:175], v[112:115]
ds_read_b128 v[220:223], v32 offset:21504
v_mfma_f32_16x16x32_bf16 v[116:119], v[204:207], v[172:175], v[116:119]
ds_read_b128 v[224:227], v32 offset:29696
v_mfma_f32_16x16x32_bf16 v[120:123], v[208:211], v[172:175], v[120:123]
ds_read_b64_tr_b16 v[144:145], v26 offset:8192
ds_read_b64_tr_b16 v[146:147], v26 offset:8704
s_waitcnt lgkmcnt(8)
v_mfma_f32_16x16x32_bf16 v[124:127], v[196:199], v[176:179], v[124:127]
s_add_u32 m0, s63, 0x1000
s_nop 0
buffer_load_dwordx4 v17, s[44:47], s73 offen offset:0 lds
buffer_load_dwordx4 v18, s[44:47], s73 offen offset:1024 lds
buffer_load_dwordx4 v19, s[44:47], s73 offen offset:2048 lds
buffer_load_dwordx4 v20, s[44:47], s73 offen offset:3072 lds
v_mfma_f32_16x16x32_bf16 v[128:131], v[200:203], v[176:179], v[128:131]
v_mfma_f32_16x16x32_bf16 v[132:135], v[204:207], v[176:179], v[132:135]
v_mfma_f32_16x16x32_bf16 v[136:139], v[208:211], v[176:179], v[136:139]
ds_read_b64_tr_b16 v[148:149], v27 offset:8192
ds_read_b64_tr_b16 v[150:151], v27 offset:8704
s_waitcnt lgkmcnt(7)
v_mfma_f32_16x16x32_bf16 v[76:79], v[212:215], v[140:143], v[76:79]
s_waitcnt lgkmcnt(6)
v_mfma_f32_16x16x32_bf16 v[80:83], v[216:219], v[140:143], v[80:83]
s_waitcnt lgkmcnt(5)
v_mfma_f32_16x16x32_bf16 v[84:87], v[220:223], v[140:143], v[84:87]
s_waitcnt lgkmcnt(4)
v_mfma_f32_16x16x32_bf16 v[88:91], v[224:227], v[140:143], v[88:91]
ds_read_b64_tr_b16 v[152:153], v28 offset:8192
ds_read_b64_tr_b16 v[154:155], v28 offset:8704
s_waitcnt lgkmcnt(4)
v_mfma_f32_16x16x32_bf16 v[92:95], v[212:215], v[144:147], v[92:95]
v_mfma_f32_16x16x32_bf16 v[96:99], v[216:219], v[144:147], v[96:99]
v_mfma_f32_16x16x32_bf16 v[100:103], v[220:223], v[144:147], v[100:103]
v_mfma_f32_16x16x32_bf16 v[104:107], v[224:227], v[144:147], v[104:107]
ds_read_b128 v[180:183], v31 offset:6144
s_waitcnt vmcnt(4)
ds_read_b64_tr_b16 v[156:157], v25 offset:0
ds_read_b64_tr_b16 v[158:159], v25 offset:512
s_waitcnt lgkmcnt(5)
v_mfma_f32_16x16x32_bf16 v[108:111], v[212:215], v[148:151], v[108:111]
ds_read_b128 v[184:187], v31 offset:14336
v_mfma_f32_16x16x32_bf16 v[112:115], v[216:219], v[148:151], v[112:115]
ds_read_b128 v[188:191], v31 offset:22528
v_mfma_f32_16x16x32_bf16 v[116:119], v[220:223], v[148:151], v[116:119]
ds_read_b128 v[192:195], v31 offset:30720
v_mfma_f32_16x16x32_bf16 v[120:123], v[224:227], v[148:151], v[120:123]
ds_read_b64_tr_b16 v[160:161], v26 offset:0
ds_read_b64_tr_b16 v[162:163], v26 offset:512
s_waitcnt lgkmcnt(8)
v_mfma_f32_16x16x32_bf16 v[124:127], v[212:215], v[152:155], v[124:127]
v_mfma_f32_16x16x32_bf16 v[128:131], v[216:219], v[152:155], v[128:131]
v_mfma_f32_16x16x32_bf16 v[132:135], v[220:223], v[152:155], v[132:135]
v_mfma_f32_16x16x32_bf16 v[136:139], v[224:227], v[152:155], v[136:139]
ds_read_b64_tr_b16 v[164:165], v27 offset:0
ds_read_b64_tr_b16 v[166:167], v27 offset:512
s_waitcnt lgkmcnt(7)
v_mfma_f32_16x16x32_bf16 v[76:79], v[180:183], v[156:159], v[76:79]
s_waitcnt lgkmcnt(6)
v_mfma_f32_16x16x32_bf16 v[80:83], v[184:187], v[156:159], v[80:83]
s_waitcnt lgkmcnt(5)
v_mfma_f32_16x16x32_bf16 v[84:87], v[188:191], v[156:159], v[84:87]
s_waitcnt lgkmcnt(4)
v_mfma_f32_16x16x32_bf16 v[88:91], v[192:195], v[156:159], v[88:91]
ds_read_b64_tr_b16 v[168:169], v28 offset:0
ds_read_b64_tr_b16 v[170:171], v28 offset:512
s_waitcnt lgkmcnt(4)
v_mfma_f32_16x16x32_bf16 v[92:95], v[180:183], v[160:163], v[92:95]
v_mfma_f32_16x16x32_bf16 v[96:99], v[184:187], v[160:163], v[96:99]
v_mfma_f32_16x16x32_bf16 v[100:103], v[188:191], v[160:163], v[100:103]
v_mfma_f32_16x16x32_bf16 v[104:107], v[192:195], v[160:163], v[104:107]
ds_read_b128 v[196:199], v32 offset:7168
s_waitcnt vmcnt(0)
ds_read_b64_tr_b16 v[172:173], v25 offset:4096
ds_read_b64_tr_b16 v[174:175], v25 offset:4608
s_waitcnt lgkmcnt(5)
v_mfma_f32_16x16x32_bf16 v[108:111], v[180:183], v[164:167], v[108:111]
ds_read_b128 v[200:203], v32 offset:15360
v_mfma_f32_16x16x32_bf16 v[112:115], v[184:187], v[164:167], v[112:115]
ds_read_b128 v[204:207], v32 offset:23552
v_mfma_f32_16x16x32_bf16 v[116:119], v[188:191], v[164:167], v[116:119]
ds_read_b128 v[208:211], v32 offset:31744
v_mfma_f32_16x16x32_bf16 v[120:123], v[192:195], v[164:167], v[120:123]
ds_read_b64_tr_b16 v[176:177], v26 offset:4096
ds_read_b64_tr_b16 v[178:179], v26 offset:4608
s_waitcnt lgkmcnt(8)
v_mfma_f32_16x16x32_bf16 v[124:127], v[180:183], v[168:171], v[124:127]
v_mfma_f32_16x16x32_bf16 v[128:131], v[184:187], v[168:171], v[128:131]
v_mfma_f32_16x16x32_bf16 v[132:135], v[188:191], v[168:171], v[132:135]
v_mfma_f32_16x16x32_bf16 v[136:139], v[192:195], v[168:171], v[136:139]
ds_read_b64_tr_b16 v[140:141], v27 offset:4096
ds_read_b64_tr_b16 v[142:143], v27 offset:4608
s_waitcnt lgkmcnt(7)
v_mfma_f32_16x16x32_bf16 v[76:79], v[196:199], v[172:175], v[76:79]
s_waitcnt lgkmcnt(6)
v_mfma_f32_16x16x32_bf16 v[80:83], v[200:203], v[172:175], v[80:83]
s_waitcnt lgkmcnt(5)
v_mfma_f32_16x16x32_bf16 v[84:87], v[204:207], v[172:175], v[84:87]
s_waitcnt lgkmcnt(4)
v_mfma_f32_16x16x32_bf16 v[88:91], v[208:211], v[172:175], v[88:91]
ds_read_b64_tr_b16 v[144:145], v28 offset:4096
ds_read_b64_tr_b16 v[146:147], v28 offset:4608
s_waitcnt lgkmcnt(4)
v_mfma_f32_16x16x32_bf16 v[92:95], v[196:199], v[176:179], v[92:95]
v_cvt_pk_bf16_f32 v76, v76, v77
v_cvt_pk_bf16_f32 v77, v78, v79
v_cvt_pk_bf16_f32 v78, v80, v81
v_cvt_pk_bf16_f32 v79, v82, v83
buffer_store_dwordx4 v[76:79], v16, s[52:55], s82 offen offset:0 sc1
v_mfma_f32_16x16x32_bf16 v[96:99], v[200:203], v[176:179], v[96:99]
v_mfma_f32_16x16x32_bf16 v[100:103], v[204:207], v[176:179], v[100:103]
v_cvt_pk_bf16_f32 v84, v84, v85
v_cvt_pk_bf16_f32 v85, v86, v87
v_cvt_pk_bf16_f32 v86, v88, v89
v_cvt_pk_bf16_f32 v87, v90, v91
buffer_store_dwordx4 v[84:87], v16, s[52:55], s82 offen offset:2048 sc1
v_mfma_f32_16x16x32_bf16 v[104:107], v[208:211], v[176:179], v[104:107]
s_waitcnt lgkmcnt(2)
v_mfma_f32_16x16x32_bf16 v[108:111], v[196:199], v[140:143], v[108:111]
v_cvt_pk_bf16_f32 v92, v92, v93
v_cvt_pk_bf16_f32 v93, v94, v95
v_cvt_pk_bf16_f32 v94, v96, v97
v_cvt_pk_bf16_f32 v95, v98, v99
buffer_store_dwordx4 v[92:95], v16, s[52:55], s82 offen offset:1024 sc1
v_mfma_f32_16x16x32_bf16 v[112:115], v[200:203], v[140:143], v[112:115]
v_mfma_f32_16x16x32_bf16 v[116:119], v[204:207], v[140:143], v[116:119]
v_cvt_pk_bf16_f32 v100, v100, v101
v_cvt_pk_bf16_f32 v101, v102, v103
v_cvt_pk_bf16_f32 v102, v104, v105
v_cvt_pk_bf16_f32 v103, v106, v107
buffer_store_dwordx4 v[100:103], v16, s[52:55], s82 offen offset:3072 sc1
v_mfma_f32_16x16x32_bf16 v[120:123], v[208:211], v[140:143], v[120:123]
s_waitcnt lgkmcnt(0)
v_mfma_f32_16x16x32_bf16 v[124:127], v[196:199], v[144:147], v[124:127]
v_cvt_pk_bf16_f32 v108, v108, v109
v_cvt_pk_bf16_f32 v109, v110, v111
v_cvt_pk_bf16_f32 v110, v112, v113
v_cvt_pk_bf16_f32 v111, v114, v115
buffer_store_dwordx4 v[108:111], v16, s[52:55], s83 offen offset:0 sc1
v_mfma_f32_16x16x32_bf16 v[128:131], v[200:203], v[144:147], v[128:131]
v_mfma_f32_16x16x32_bf16 v[132:135], v[204:207], v[144:147], v[132:135]
v_cvt_pk_bf16_f32 v116, v116, v117
v_cvt_pk_bf16_f32 v117, v118, v119
v_cvt_pk_bf16_f32 v118, v120, v121
v_cvt_pk_bf16_f32 v119, v122, v123
buffer_store_dwordx4 v[116:119], v16, s[52:55], s83 offen offset:2048 sc1
v_mfma_f32_16x16x32_bf16 v[136:139], v[208:211], v[144:147], v[136:139]
v_cvt_pk_bf16_f32 v124, v124, v125
v_cvt_pk_bf16_f32 v125, v126, v127
v_cvt_pk_bf16_f32 v126, v128, v129
v_cvt_pk_bf16_f32 v127, v130, v131
buffer_store_dwordx4 v[124:127], v16, s[52:55], s83 offen offset:1024 sc1
v_cvt_pk_bf16_f32 v132, v132, v133
v_cvt_pk_bf16_f32 v133, v134, v135
s_nop 0
v_cvt_pk_bf16_f32 v134, v136, v137
v_cvt_pk_bf16_f32 v135, v138, v139
buffer_store_dwordx4 v[132:135], v16, s[52:55], s83 offen offset:3072 sc1
s_branch LM_pub
LM_light:
s_mov_b32 s61, 1
s_waitcnt lgkmcnt(0)
s_mov_b32 s98, 0x7c3ff80
s_load_dwordx2 s[98:99], s[38:39], s98
s_branch L1_fin
LM_edge:
s_sub_u32 s4, s3, 30
s_lshl_b32 s8, s8, 1
s_add_u32 s4, s4, s8
s_add_u32 s91, s4, 240
s_cmp_ge_u32 s4, 14
s_cselect_b32 s61, 1, 0
s_mul_i32 s6, s4, 40000
v_lshlrev_b32 v5, 4, v0
v_lshlrev_b32 v6, 2, v2
v_add_u32 v6, 0x10000, v6
v_mov_b32 v7, 0
ds_write_b32 v6, v7
s_mov_b32 s66, 0
s_mov_b32 s67, 4096
s_mov_b32 s68, 8192
s_mov_b32 s69, 12288
s_mov_b32 s70, 16384
s_mov_b32 s71, 20480
s_mov_b32 s72, 24576
s_mov_b32 s73, 28672
s_mov_b32 s74, 32768
s_mov_b32 s75, 36864
s_waitcnt lgkmcnt(0)
s_add_u32 s40, s20, 0x0
s_addc_u32 s41, s21, 0
s_add_u32 s40, s40, s6
s_addc_u32 s41, s41, 0
s_mov_b32 s42, 0x9c40
s_mov_b32 s43, 0x00020000
s_add_u32 s44, s18, 0x0
s_addc_u32 s45, s19, 0
s_add_u32 s44, s44, s6
s_addc_u32 s45, s45, 0
s_mov_b32 s46, 0x9c40
s_mov_b32 s47, 0x00020000
buffer_load_dwordx4 v[16:19], v5, s[40:43], s66 offen
buffer_load_dwordx4 v[20:23], v5, s[40:43], s67 offen
buffer_load_dwordx4 v[24:27], v5, s[40:43], s68 offen
buffer_load_dwordx4 v[28:31], v5, s[40:43], s69 offen
buffer_load_dwordx4 v[32:35], v5, s[40:43], s70 offen
buffer_load_dwordx4 v[36:39], v5, s[40:43], s71 offen
buffer_load_dwordx4 v[40:43], v5, s[40:43], s72 offen
buffer_load_dwordx4 v[44:47], v5, s[40:43], s73 offen
buffer_load_dwordx4 v[48:51], v5, s[40:43], s74 offen
buffer_load_dwordx4 v[52:55], v5, s[40:43], s75 offen
buffer_load_dwordx4 v[56:59], v5, s[44:47], s66 offen
buffer_load_dwordx4 v[60:63], v5, s[44:47], s67 offen
buffer_load_dwordx4 v[64:67], v5, s[44:47], s68 offen
buffer_load_dwordx4 v[68:71], v5, s[44:47], s69 offen
buffer_load_dwordx4 v[72:75], v5, s[44:47], s70 offen
buffer_load_dwordx4 v[76:79], v5, s[44:47], s71 offen
buffer_load_dwordx4 v[80:83], v5, s[44:47], s72 offen
buffer_load_dwordx4 v[84:87], v5, s[44:47], s73 offen
buffer_load_dwordx4 v[88:91], v5, s[44:47], s74 offen
buffer_load_dwordx4 v[92:95], v5, s[44:47], s75 offen
s_mov_b32 s98, 0x7c3ff80
s_load_dwordx2 s[98:99], s[38:39], s98
s_add_u32 s48, s38, 0x8000000
s_addc_u32 s49, s39, 0
s_mov_b32 s50, 0x2800000
s_mov_b32 s51, 0x00020000
s_add_u32 s52, s38, 0x7800000
s_addc_u32 s53, s39, 0
s_mov_b32 s54, 0x1000
s_mov_b32 s55, 0x00020000
v_mov_b32 v240, 6945
v_mov_b32 v241, 0x0
v_mov_b32 v242, 6317
v_mov_b32 v243, 0x340674
v_mov_b32 v244, 6899
v_mov_b32 v245, 0xfffae6a0
v_mov_b32 v246, 6242
v_mov_b32 v247, 0x4484a0
s_mov_b32 s11, 0x10000
v_mov_b32 v7, 1
v_cmp_gt_u32 vcc, 0xc4, v0
s_mov_b64 s[12:13], vcc
s_barrier
s_waitcnt vmcnt(19)
v_cmp_le_u32 vcc, 5436, v16
s_nop 1
v_cndmask_b32 v96, v240, v242, vcc
v_cndmask_b32 v136, v241, v243, vcc
v_cmp_le_u32 vcc, 6432, v16
s_nop 1
v_cndmask_b32 v96, v96, v244, vcc
v_cndmask_b32 v136, v136, v245, vcc
v_cmp_le_u32 vcc, 7344, v16
s_nop 1
v_cndmask_b32 v96, v96, v246, vcc
v_cndmask_b32 v136, v136, v247, vcc
v_mad_u32_u24 v96, v96, v16, v136
v_lshrrev_b32 v96, 20, v96
v_lshl_add_u32 v136, v96, 2, s11
ds_add_rtn_u32 v136, v136, v7
v_cmp_le_u32 vcc, 5436, v17
s_nop 1
v_cndmask_b32 v97, v240, v242, vcc
v_cndmask_b32 v137, v241, v243, vcc
v_cmp_le_u32 vcc, 6432, v17
s_nop 1
v_cndmask_b32 v97, v97, v244, vcc
v_cndmask_b32 v137, v137, v245, vcc
v_cmp_le_u32 vcc, 7344, v17
s_nop 1
v_cndmask_b32 v97, v97, v246, vcc
v_cndmask_b32 v137, v137, v247, vcc
v_mad_u32_u24 v97, v97, v17, v137
v_lshrrev_b32 v97, 20, v97
v_lshl_add_u32 v137, v97, 2, s11
ds_add_rtn_u32 v137, v137, v7
v_cmp_le_u32 vcc, 5436, v18
s_nop 1
v_cndmask_b32 v98, v240, v242, vcc
v_cndmask_b32 v138, v241, v243, vcc
v_cmp_le_u32 vcc, 6432, v18
s_nop 1
v_cndmask_b32 v98, v98, v244, vcc
v_cndmask_b32 v138, v138, v245, vcc
v_cmp_le_u32 vcc, 7344, v18
s_nop 1
v_cndmask_b32 v98, v98, v246, vcc
v_cndmask_b32 v138, v138, v247, vcc
v_mad_u32_u24 v98, v98, v18, v138
v_lshrrev_b32 v98, 20, v98
v_lshl_add_u32 v138, v98, 2, s11
ds_add_rtn_u32 v138, v138, v7
v_cmp_le_u32 vcc, 5436, v19
s_nop 1
v_cndmask_b32 v99, v240, v242, vcc
v_cndmask_b32 v139, v241, v243, vcc
v_cmp_le_u32 vcc, 6432, v19
s_nop 1
v_cndmask_b32 v99, v99, v244, vcc
v_cndmask_b32 v139, v139, v245, vcc
v_cmp_le_u32 vcc, 7344, v19
s_nop 1
v_cndmask_b32 v99, v99, v246, vcc
v_cndmask_b32 v139, v139, v247, vcc
v_mad_u32_u24 v99, v99, v19, v139
v_lshrrev_b32 v99, 20, v99
v_lshl_add_u32 v139, v99, 2, s11
ds_add_rtn_u32 v139, v139, v7
s_waitcnt vmcnt(18)
v_cmp_le_u32 vcc, 5436, v20
s_nop 1
v_cndmask_b32 v100, v240, v242, vcc
v_cndmask_b32 v140, v241, v243, vcc
v_cmp_le_u32 vcc, 6432, v20
s_nop 1
v_cndmask_b32 v100, v100, v244, vcc
v_cndmask_b32 v140, v140, v245, vcc
v_cmp_le_u32 vcc, 7344, v20
s_nop 1
v_cndmask_b32 v100, v100, v246, vcc
v_cndmask_b32 v140, v140, v247, vcc
v_mad_u32_u24 v100, v100, v20, v140
v_lshrrev_b32 v100, 20, v100
v_lshl_add_u32 v140, v100, 2, s11
ds_add_rtn_u32 v140, v140, v7
v_cmp_le_u32 vcc, 5436, v21
s_nop 1
v_cndmask_b32 v101, v240, v242, vcc
v_cndmask_b32 v141, v241, v243, vcc
v_cmp_le_u32 vcc, 6432, v21
s_nop 1
v_cndmask_b32 v101, v101, v244, vcc
v_cndmask_b32 v141, v141, v245, vcc
v_cmp_le_u32 vcc, 7344, v21
s_nop 1
v_cndmask_b32 v101, v101, v246, vcc
v_cndmask_b32 v141, v141, v247, vcc
v_mad_u32_u24 v101, v101, v21, v141
v_lshrrev_b32 v101, 20, v101
v_lshl_add_u32 v141, v101, 2, s11
ds_add_rtn_u32 v141, v141, v7
v_cmp_le_u32 vcc, 5436, v22
s_nop 1
v_cndmask_b32 v102, v240, v242, vcc
v_cndmask_b32 v142, v241, v243, vcc
v_cmp_le_u32 vcc, 6432, v22
s_nop 1
v_cndmask_b32 v102, v102, v244, vcc
v_cndmask_b32 v142, v142, v245, vcc
v_cmp_le_u32 vcc, 7344, v22
s_nop 1
v_cndmask_b32 v102, v102, v246, vcc
v_cndmask_b32 v142, v142, v247, vcc
v_mad_u32_u24 v102, v102, v22, v142
v_lshrrev_b32 v102, 20, v102
v_lshl_add_u32 v142, v102, 2, s11
ds_add_rtn_u32 v142, v142, v7
v_cmp_le_u32 vcc, 5436, v23
s_nop 1
v_cndmask_b32 v103, v240, v242, vcc
v_cndmask_b32 v143, v241, v243, vcc
v_cmp_le_u32 vcc, 6432, v23
s_nop 1
v_cndmask_b32 v103, v103, v244, vcc
v_cndmask_b32 v143, v143, v245, vcc
v_cmp_le_u32 vcc, 7344, v23
s_nop 1
v_cndmask_b32 v103, v103, v246, vcc
v_cndmask_b32 v143, v143, v247, vcc
v_mad_u32_u24 v103, v103, v23, v143
v_lshrrev_b32 v103, 20, v103
v_lshl_add_u32 v143, v103, 2, s11
ds_add_rtn_u32 v143, v143, v7
s_waitcnt vmcnt(17)
v_cmp_le_u32 vcc, 5436, v24
s_nop 1
v_cndmask_b32 v104, v240, v242, vcc
v_cndmask_b32 v144, v241, v243, vcc
v_cmp_le_u32 vcc, 6432, v24
s_nop 1
v_cndmask_b32 v104, v104, v244, vcc
v_cndmask_b32 v144, v144, v245, vcc
v_cmp_le_u32 vcc, 7344, v24
s_nop 1
v_cndmask_b32 v104, v104, v246, vcc
v_cndmask_b32 v144, v144, v247, vcc
v_mad_u32_u24 v104, v104, v24, v144
v_lshrrev_b32 v104, 20, v104
v_lshl_add_u32 v144, v104, 2, s11
ds_add_rtn_u32 v144, v144, v7
v_cmp_le_u32 vcc, 5436, v25
s_nop 1
v_cndmask_b32 v105, v240, v242, vcc
v_cndmask_b32 v145, v241, v243, vcc
v_cmp_le_u32 vcc, 6432, v25
s_nop 1
v_cndmask_b32 v105, v105, v244, vcc
v_cndmask_b32 v145, v145, v245, vcc
v_cmp_le_u32 vcc, 7344, v25
s_nop 1
v_cndmask_b32 v105, v105, v246, vcc
v_cndmask_b32 v145, v145, v247, vcc
v_mad_u32_u24 v105, v105, v25, v145
v_lshrrev_b32 v105, 20, v105
v_lshl_add_u32 v145, v105, 2, s11
ds_add_rtn_u32 v145, v145, v7
v_cmp_le_u32 vcc, 5436, v26
s_nop 1
v_cndmask_b32 v106, v240, v242, vcc
v_cndmask_b32 v146, v241, v243, vcc
v_cmp_le_u32 vcc, 6432, v26
s_nop 1
v_cndmask_b32 v106, v106, v244, vcc
v_cndmask_b32 v146, v146, v245, vcc
v_cmp_le_u32 vcc, 7344, v26
s_nop 1
v_cndmask_b32 v106, v106, v246, vcc
v_cndmask_b32 v146, v146, v247, vcc
v_mad_u32_u24 v106, v106, v26, v146
v_lshrrev_b32 v106, 20, v106
v_lshl_add_u32 v146, v106, 2, s11
ds_add_rtn_u32 v146, v146, v7
v_cmp_le_u32 vcc, 5436, v27
s_nop 1
v_cndmask_b32 v107, v240, v242, vcc
v_cndmask_b32 v147, v241, v243, vcc
v_cmp_le_u32 vcc, 6432, v27
s_nop 1
v_cndmask_b32 v107, v107, v244, vcc
v_cndmask_b32 v147, v147, v245, vcc
v_cmp_le_u32 vcc, 7344, v27
s_nop 1
v_cndmask_b32 v107, v107, v246, vcc
v_cndmask_b32 v147, v147, v247, vcc
v_mad_u32_u24 v107, v107, v27, v147
v_lshrrev_b32 v107, 20, v107
v_lshl_add_u32 v147, v107, 2, s11
ds_add_rtn_u32 v147, v147, v7
s_waitcnt vmcnt(16)
v_cmp_le_u32 vcc, 5436, v28
s_nop 1
v_cndmask_b32 v108, v240, v242, vcc
v_cndmask_b32 v148, v241, v243, vcc
v_cmp_le_u32 vcc, 6432, v28
s_nop 1
v_cndmask_b32 v108, v108, v244, vcc
v_cndmask_b32 v148, v148, v245, vcc
v_cmp_le_u32 vcc, 7344, v28
s_nop 1
v_cndmask_b32 v108, v108, v246, vcc
v_cndmask_b32 v148, v148, v247, vcc
v_mad_u32_u24 v108, v108, v28, v148
v_lshrrev_b32 v108, 20, v108
v_lshl_add_u32 v148, v108, 2, s11
ds_add_rtn_u32 v148, v148, v7
v_cmp_le_u32 vcc, 5436, v29
s_nop 1
v_cndmask_b32 v109, v240, v242, vcc
v_cndmask_b32 v149, v241, v243, vcc
v_cmp_le_u32 vcc, 6432, v29
s_nop 1
v_cndmask_b32 v109, v109, v244, vcc
v_cndmask_b32 v149, v149, v245, vcc
v_cmp_le_u32 vcc, 7344, v29
s_nop 1
v_cndmask_b32 v109, v109, v246, vcc
v_cndmask_b32 v149, v149, v247, vcc
v_mad_u32_u24 v109, v109, v29, v149
v_lshrrev_b32 v109, 20, v109
v_lshl_add_u32 v149, v109, 2, s11
ds_add_rtn_u32 v149, v149, v7
v_cmp_le_u32 vcc, 5436, v30
s_nop 1
v_cndmask_b32 v110, v240, v242, vcc
v_cndmask_b32 v150, v241, v243, vcc
v_cmp_le_u32 vcc, 6432, v30
s_nop 1
v_cndmask_b32 v110, v110, v244, vcc
v_cndmask_b32 v150, v150, v245, vcc
v_cmp_le_u32 vcc, 7344, v30
s_nop 1
v_cndmask_b32 v110, v110, v246, vcc
v_cndmask_b32 v150, v150, v247, vcc
v_mad_u32_u24 v110, v110, v30, v150
v_lshrrev_b32 v110, 20, v110
v_lshl_add_u32 v150, v110, 2, s11
ds_add_rtn_u32 v150, v150, v7
v_cmp_le_u32 vcc, 5436, v31
s_nop 1
v_cndmask_b32 v111, v240, v242, vcc
v_cndmask_b32 v151, v241, v243, vcc
v_cmp_le_u32 vcc, 6432, v31
s_nop 1
v_cndmask_b32 v111, v111, v244, vcc
v_cndmask_b32 v151, v151, v245, vcc
v_cmp_le_u32 vcc, 7344, v31
s_nop 1
v_cndmask_b32 v111, v111, v246, vcc
v_cndmask_b32 v151, v151, v247, vcc
v_mad_u32_u24 v111, v111, v31, v151
v_lshrrev_b32 v111, 20, v111
v_lshl_add_u32 v151, v111, 2, s11
ds_add_rtn_u32 v151, v151, v7
s_waitcnt vmcnt(15)
v_cmp_le_u32 vcc, 5436, v32
s_nop 1
v_cndmask_b32 v112, v240, v242, vcc
v_cndmask_b32 v152, v241, v243, vcc
v_cmp_le_u32 vcc, 6432, v32
s_nop 1
v_cndmask_b32 v112, v112, v244, vcc
v_cndmask_b32 v152, v152, v245, vcc
v_cmp_le_u32 vcc, 7344, v32
s_nop 1
v_cndmask_b32 v112, v112, v246, vcc
v_cndmask_b32 v152, v152, v247, vcc
v_mad_u32_u24 v112, v112, v32, v152
v_lshrrev_b32 v112, 20, v112
v_lshl_add_u32 v152, v112, 2, s11
ds_add_rtn_u32 v152, v152, v7
v_cmp_le_u32 vcc, 5436, v33
s_nop 1
v_cndmask_b32 v113, v240, v242, vcc
v_cndmask_b32 v153, v241, v243, vcc
v_cmp_le_u32 vcc, 6432, v33
s_nop 1
v_cndmask_b32 v113, v113, v244, vcc
v_cndmask_b32 v153, v153, v245, vcc
v_cmp_le_u32 vcc, 7344, v33
s_nop 1
v_cndmask_b32 v113, v113, v246, vcc
v_cndmask_b32 v153, v153, v247, vcc
v_mad_u32_u24 v113, v113, v33, v153
v_lshrrev_b32 v113, 20, v113
v_lshl_add_u32 v153, v113, 2, s11
ds_add_rtn_u32 v153, v153, v7
v_cmp_le_u32 vcc, 5436, v34
s_nop 1
v_cndmask_b32 v114, v240, v242, vcc
v_cndmask_b32 v154, v241, v243, vcc
v_cmp_le_u32 vcc, 6432, v34
s_nop 1
v_cndmask_b32 v114, v114, v244, vcc
v_cndmask_b32 v154, v154, v245, vcc
v_cmp_le_u32 vcc, 7344, v34
s_nop 1
v_cndmask_b32 v114, v114, v246, vcc
v_cndmask_b32 v154, v154, v247, vcc
v_mad_u32_u24 v114, v114, v34, v154
v_lshrrev_b32 v114, 20, v114
v_lshl_add_u32 v154, v114, 2, s11
ds_add_rtn_u32 v154, v154, v7
v_cmp_le_u32 vcc, 5436, v35
s_nop 1
v_cndmask_b32 v115, v240, v242, vcc
v_cndmask_b32 v155, v241, v243, vcc
v_cmp_le_u32 vcc, 6432, v35
s_nop 1
v_cndmask_b32 v115, v115, v244, vcc
v_cndmask_b32 v155, v155, v245, vcc
v_cmp_le_u32 vcc, 7344, v35
s_nop 1
v_cndmask_b32 v115, v115, v246, vcc
v_cndmask_b32 v155, v155, v247, vcc
v_mad_u32_u24 v115, v115, v35, v155
v_lshrrev_b32 v115, 20, v115
v_lshl_add_u32 v155, v115, 2, s11
ds_add_rtn_u32 v155, v155, v7
s_waitcnt vmcnt(14)
v_cmp_le_u32 vcc, 5436, v36
s_nop 1
v_cndmask_b32 v116, v240, v242, vcc
v_cndmask_b32 v156, v241, v243, vcc
v_cmp_le_u32 vcc, 6432, v36
s_nop 1
v_cndmask_b32 v116, v116, v244, vcc
v_cndmask_b32 v156, v156, v245, vcc
v_cmp_le_u32 vcc, 7344, v36
s_nop 1
v_cndmask_b32 v116, v116, v246, vcc
v_cndmask_b32 v156, v156, v247, vcc
v_mad_u32_u24 v116, v116, v36, v156
v_lshrrev_b32 v116, 20, v116
v_lshl_add_u32 v156, v116, 2, s11
ds_add_rtn_u32 v156, v156, v7
v_cmp_le_u32 vcc, 5436, v37
s_nop 1
v_cndmask_b32 v117, v240, v242, vcc
v_cndmask_b32 v157, v241, v243, vcc
v_cmp_le_u32 vcc, 6432, v37
s_nop 1
v_cndmask_b32 v117, v117, v244, vcc
v_cndmask_b32 v157, v157, v245, vcc
v_cmp_le_u32 vcc, 7344, v37
s_nop 1
v_cndmask_b32 v117, v117, v246, vcc
v_cndmask_b32 v157, v157, v247, vcc
v_mad_u32_u24 v117, v117, v37, v157
v_lshrrev_b32 v117, 20, v117
v_lshl_add_u32 v157, v117, 2, s11
ds_add_rtn_u32 v157, v157, v7
v_cmp_le_u32 vcc, 5436, v38
s_nop 1
v_cndmask_b32 v118, v240, v242, vcc
v_cndmask_b32 v158, v241, v243, vcc
v_cmp_le_u32 vcc, 6432, v38
s_nop 1
v_cndmask_b32 v118, v118, v244, vcc
v_cndmask_b32 v158, v158, v245, vcc
v_cmp_le_u32 vcc, 7344, v38
s_nop 1
v_cndmask_b32 v118, v118, v246, vcc
v_cndmask_b32 v158, v158, v247, vcc
v_mad_u32_u24 v118, v118, v38, v158
v_lshrrev_b32 v118, 20, v118
v_lshl_add_u32 v158, v118, 2, s11
ds_add_rtn_u32 v158, v158, v7
v_cmp_le_u32 vcc, 5436, v39
s_nop 1
v_cndmask_b32 v119, v240, v242, vcc
v_cndmask_b32 v159, v241, v243, vcc
v_cmp_le_u32 vcc, 6432, v39
s_nop 1
v_cndmask_b32 v119, v119, v244, vcc
v_cndmask_b32 v159, v159, v245, vcc
v_cmp_le_u32 vcc, 7344, v39
s_nop 1
v_cndmask_b32 v119, v119, v246, vcc
v_cndmask_b32 v159, v159, v247, vcc
v_mad_u32_u24 v119, v119, v39, v159
v_lshrrev_b32 v119, 20, v119
v_lshl_add_u32 v159, v119, 2, s11
ds_add_rtn_u32 v159, v159, v7
s_waitcnt vmcnt(13)
v_cmp_le_u32 vcc, 5436, v40
s_nop 1
v_cndmask_b32 v120, v240, v242, vcc
v_cndmask_b32 v160, v241, v243, vcc
v_cmp_le_u32 vcc, 6432, v40
s_nop 1
v_cndmask_b32 v120, v120, v244, vcc
v_cndmask_b32 v160, v160, v245, vcc
v_cmp_le_u32 vcc, 7344, v40
s_nop 1
v_cndmask_b32 v120, v120, v246, vcc
v_cndmask_b32 v160, v160, v247, vcc
v_mad_u32_u24 v120, v120, v40, v160
v_lshrrev_b32 v120, 20, v120
v_lshl_add_u32 v160, v120, 2, s11
ds_add_rtn_u32 v160, v160, v7
v_cmp_le_u32 vcc, 5436, v41
s_nop 1
v_cndmask_b32 v121, v240, v242, vcc
v_cndmask_b32 v161, v241, v243, vcc
v_cmp_le_u32 vcc, 6432, v41
s_nop 1
v_cndmask_b32 v121, v121, v244, vcc
v_cndmask_b32 v161, v161, v245, vcc
v_cmp_le_u32 vcc, 7344, v41
s_nop 1
v_cndmask_b32 v121, v121, v246, vcc
v_cndmask_b32 v161, v161, v247, vcc
v_mad_u32_u24 v121, v121, v41, v161
v_lshrrev_b32 v121, 20, v121
v_lshl_add_u32 v161, v121, 2, s11
ds_add_rtn_u32 v161, v161, v7
v_cmp_le_u32 vcc, 5436, v42
s_nop 1
v_cndmask_b32 v122, v240, v242, vcc
v_cndmask_b32 v162, v241, v243, vcc
v_cmp_le_u32 vcc, 6432, v42
s_nop 1
v_cndmask_b32 v122, v122, v244, vcc
v_cndmask_b32 v162, v162, v245, vcc
v_cmp_le_u32 vcc, 7344, v42
s_nop 1
v_cndmask_b32 v122, v122, v246, vcc
v_cndmask_b32 v162, v162, v247, vcc
v_mad_u32_u24 v122, v122, v42, v162
v_lshrrev_b32 v122, 20, v122
v_lshl_add_u32 v162, v122, 2, s11
ds_add_rtn_u32 v162, v162, v7
v_cmp_le_u32 vcc, 5436, v43
s_nop 1
v_cndmask_b32 v123, v240, v242, vcc
v_cndmask_b32 v163, v241, v243, vcc
v_cmp_le_u32 vcc, 6432, v43
s_nop 1
v_cndmask_b32 v123, v123, v244, vcc
v_cndmask_b32 v163, v163, v245, vcc
v_cmp_le_u32 vcc, 7344, v43
s_nop 1
v_cndmask_b32 v123, v123, v246, vcc
v_cndmask_b32 v163, v163, v247, vcc
v_mad_u32_u24 v123, v123, v43, v163
v_lshrrev_b32 v123, 20, v123
v_lshl_add_u32 v163, v123, 2, s11
ds_add_rtn_u32 v163, v163, v7
s_waitcnt vmcnt(12)
v_cmp_le_u32 vcc, 5436, v44
s_nop 1
v_cndmask_b32 v124, v240, v242, vcc
v_cndmask_b32 v164, v241, v243, vcc
v_cmp_le_u32 vcc, 6432, v44
s_nop 1
v_cndmask_b32 v124, v124, v244, vcc
v_cndmask_b32 v164, v164, v245, vcc
v_cmp_le_u32 vcc, 7344, v44
s_nop 1
v_cndmask_b32 v124, v124, v246, vcc
v_cndmask_b32 v164, v164, v247, vcc
v_mad_u32_u24 v124, v124, v44, v164
v_lshrrev_b32 v124, 20, v124
v_lshl_add_u32 v164, v124, 2, s11
ds_add_rtn_u32 v164, v164, v7
v_cmp_le_u32 vcc, 5436, v45
s_nop 1
v_cndmask_b32 v125, v240, v242, vcc
v_cndmask_b32 v165, v241, v243, vcc
v_cmp_le_u32 vcc, 6432, v45
s_nop 1
v_cndmask_b32 v125, v125, v244, vcc
v_cndmask_b32 v165, v165, v245, vcc
v_cmp_le_u32 vcc, 7344, v45
s_nop 1
v_cndmask_b32 v125, v125, v246, vcc
v_cndmask_b32 v165, v165, v247, vcc
v_mad_u32_u24 v125, v125, v45, v165
v_lshrrev_b32 v125, 20, v125
v_lshl_add_u32 v165, v125, 2, s11
ds_add_rtn_u32 v165, v165, v7
v_cmp_le_u32 vcc, 5436, v46
s_nop 1
v_cndmask_b32 v126, v240, v242, vcc
v_cndmask_b32 v166, v241, v243, vcc
v_cmp_le_u32 vcc, 6432, v46
s_nop 1
v_cndmask_b32 v126, v126, v244, vcc
v_cndmask_b32 v166, v166, v245, vcc
v_cmp_le_u32 vcc, 7344, v46
s_nop 1
v_cndmask_b32 v126, v126, v246, vcc
v_cndmask_b32 v166, v166, v247, vcc
v_mad_u32_u24 v126, v126, v46, v166
v_lshrrev_b32 v126, 20, v126
v_lshl_add_u32 v166, v126, 2, s11
ds_add_rtn_u32 v166, v166, v7
v_cmp_le_u32 vcc, 5436, v47
s_nop 1
v_cndmask_b32 v127, v240, v242, vcc
v_cndmask_b32 v167, v241, v243, vcc
v_cmp_le_u32 vcc, 6432, v47
s_nop 1
v_cndmask_b32 v127, v127, v244, vcc
v_cndmask_b32 v167, v167, v245, vcc
v_cmp_le_u32 vcc, 7344, v47
s_nop 1
v_cndmask_b32 v127, v127, v246, vcc
v_cndmask_b32 v167, v167, v247, vcc
v_mad_u32_u24 v127, v127, v47, v167
v_lshrrev_b32 v127, 20, v127
v_lshl_add_u32 v167, v127, 2, s11
ds_add_rtn_u32 v167, v167, v7
s_waitcnt vmcnt(11)
v_cmp_le_u32 vcc, 5436, v48
s_nop 1
v_cndmask_b32 v128, v240, v242, vcc
v_cndmask_b32 v168, v241, v243, vcc
v_cmp_le_u32 vcc, 6432, v48
s_nop 1
v_cndmask_b32 v128, v128, v244, vcc
v_cndmask_b32 v168, v168, v245, vcc
v_cmp_le_u32 vcc, 7344, v48
s_nop 1
v_cndmask_b32 v128, v128, v246, vcc
v_cndmask_b32 v168, v168, v247, vcc
v_mad_u32_u24 v128, v128, v48, v168
v_lshrrev_b32 v128, 20, v128
v_lshl_add_u32 v168, v128, 2, s11
ds_add_rtn_u32 v168, v168, v7
v_cmp_le_u32 vcc, 5436, v49
s_nop 1
v_cndmask_b32 v129, v240, v242, vcc
v_cndmask_b32 v169, v241, v243, vcc
v_cmp_le_u32 vcc, 6432, v49
s_nop 1
v_cndmask_b32 v129, v129, v244, vcc
v_cndmask_b32 v169, v169, v245, vcc
v_cmp_le_u32 vcc, 7344, v49
s_nop 1
v_cndmask_b32 v129, v129, v246, vcc
v_cndmask_b32 v169, v169, v247, vcc
v_mad_u32_u24 v129, v129, v49, v169
v_lshrrev_b32 v129, 20, v129
v_lshl_add_u32 v169, v129, 2, s11
ds_add_rtn_u32 v169, v169, v7
v_cmp_le_u32 vcc, 5436, v50
s_nop 1
v_cndmask_b32 v130, v240, v242, vcc
v_cndmask_b32 v170, v241, v243, vcc
v_cmp_le_u32 vcc, 6432, v50
s_nop 1
v_cndmask_b32 v130, v130, v244, vcc
v_cndmask_b32 v170, v170, v245, vcc
v_cmp_le_u32 vcc, 7344, v50
s_nop 1
v_cndmask_b32 v130, v130, v246, vcc
v_cndmask_b32 v170, v170, v247, vcc
v_mad_u32_u24 v130, v130, v50, v170
v_lshrrev_b32 v130, 20, v130
v_lshl_add_u32 v170, v130, 2, s11
ds_add_rtn_u32 v170, v170, v7
v_cmp_le_u32 vcc, 5436, v51
s_nop 1
v_cndmask_b32 v131, v240, v242, vcc
v_cndmask_b32 v171, v241, v243, vcc
v_cmp_le_u32 vcc, 6432, v51
s_nop 1
v_cndmask_b32 v131, v131, v244, vcc
v_cndmask_b32 v171, v171, v245, vcc
v_cmp_le_u32 vcc, 7344, v51
s_nop 1
v_cndmask_b32 v131, v131, v246, vcc
v_cndmask_b32 v171, v171, v247, vcc
v_mad_u32_u24 v131, v131, v51, v171
v_lshrrev_b32 v131, 20, v131
v_lshl_add_u32 v171, v131, 2, s11
ds_add_rtn_u32 v171, v171, v7
s_waitcnt vmcnt(10)
s_mov_b64 exec, s[12:13]
v_cmp_le_u32 vcc, 5436, v52
s_nop 1
v_cndmask_b32 v132, v240, v242, vcc
v_cndmask_b32 v172, v241, v243, vcc
v_cmp_le_u32 vcc, 6432, v52
s_nop 1
v_cndmask_b32 v132, v132, v244, vcc
v_cndmask_b32 v172, v172, v245, vcc
v_cmp_le_u32 vcc, 7344, v52
s_nop 1
v_cndmask_b32 v132, v132, v246, vcc
v_cndmask_b32 v172, v172, v247, vcc
v_mad_u32_u24 v132, v132, v52, v172
v_lshrrev_b32 v132, 20, v132
v_lshl_add_u32 v172, v132, 2, s11
ds_add_rtn_u32 v172, v172, v7
v_cmp_le_u32 vcc, 5436, v53
s_nop 1
v_cndmask_b32 v133, v240, v242, vcc
v_cndmask_b32 v173, v241, v243, vcc
v_cmp_le_u32 vcc, 6432, v53
s_nop 1
v_cndmask_b32 v133, v133, v244, vcc
v_cndmask_b32 v173, v173, v245, vcc
v_cmp_le_u32 vcc, 7344, v53
s_nop 1
v_cndmask_b32 v133, v133, v246, vcc
v_cndmask_b32 v173, v173, v247, vcc
v_mad_u32_u24 v133, v133, v53, v173
v_lshrrev_b32 v133, 20, v133
v_lshl_add_u32 v173, v133, 2, s11
ds_add_rtn_u32 v173, v173, v7
v_cmp_le_u32 vcc, 5436, v54
s_nop 1
v_cndmask_b32 v134, v240, v242, vcc
v_cndmask_b32 v174, v241, v243, vcc
v_cmp_le_u32 vcc, 6432, v54
s_nop 1
v_cndmask_b32 v134, v134, v244, vcc
v_cndmask_b32 v174, v174, v245, vcc
v_cmp_le_u32 vcc, 7344, v54
s_nop 1
v_cndmask_b32 v134, v134, v246, vcc
v_cndmask_b32 v174, v174, v247, vcc
v_mad_u32_u24 v134, v134, v54, v174
v_lshrrev_b32 v134, 20, v134
v_lshl_add_u32 v174, v134, 2, s11
ds_add_rtn_u32 v174, v174, v7
v_cmp_le_u32 vcc, 5436, v55
s_nop 1
v_cndmask_b32 v135, v240, v242, vcc
v_cndmask_b32 v175, v241, v243, vcc
v_cmp_le_u32 vcc, 6432, v55
s_nop 1
v_cndmask_b32 v135, v135, v244, vcc
v_cndmask_b32 v175, v175, v245, vcc
v_cmp_le_u32 vcc, 7344, v55
s_nop 1
v_cndmask_b32 v135, v135, v246, vcc
v_cndmask_b32 v175, v175, v247, vcc
v_mad_u32_u24 v135, v135, v55, v175
v_lshrrev_b32 v135, 20, v135
v_lshl_add_u32 v175, v135, 2, s11
ds_add_rtn_u32 v175, v175, v7
s_mov_b64 exec, -1
s_waitcnt vmcnt(9) lgkmcnt(15)
v_and_b32 v8, 0xff, v136
v_lshl_or_b32 v56, v16, 18, v56
v_lshlrev_b32 v8, 2, v8
v_lshl_add_u32 v8, v96, 10, v8
ds_write_b32 v8, v56
v_and_b32 v8, 0xff, v137
v_lshl_or_b32 v57, v17, 18, v57
v_lshlrev_b32 v8, 2, v8
v_lshl_add_u32 v8, v97, 10, v8
ds_write_b32 v8, v57
v_and_b32 v8, 0xff, v138
v_lshl_or_b32 v58, v18, 18, v58
v_lshlrev_b32 v8, 2, v8
v_lshl_add_u32 v8, v98, 10, v8
ds_write_b32 v8, v58
v_and_b32 v8, 0xff, v139
v_lshl_or_b32 v59, v19, 18, v59
v_lshlrev_b32 v8, 2, v8
v_lshl_add_u32 v8, v99, 10, v8
ds_write_b32 v8, v59
s_waitcnt vmcnt(8) lgkmcnt(15)
v_and_b32 v8, 0xff, v140
v_lshl_or_b32 v60, v20, 18, v60
v_lshlrev_b32 v8, 2, v8
v_lshl_add_u32 v8, v100, 10, v8
ds_write_b32 v8, v60
v_and_b32 v8, 0xff, v141
v_lshl_or_b32 v61, v21, 18, v61
v_lshlrev_b32 v8, 2, v8
v_lshl_add_u32 v8, v101, 10, v8
ds_write_b32 v8, v61
v_and_b32 v8, 0xff, v142
v_lshl_or_b32 v62, v22, 18, v62
v_lshlrev_b32 v8, 2, v8
v_lshl_add_u32 v8, v102, 10, v8
ds_write_b32 v8, v62
v_and_b32 v8, 0xff, v143
v_lshl_or_b32 v63, v23, 18, v63
v_lshlrev_b32 v8, 2, v8
v_lshl_add_u32 v8, v103, 10, v8
ds_write_b32 v8, v63
s_waitcnt vmcnt(7) lgkmcnt(15)
v_and_b32 v8, 0xff, v144
v_lshl_or_b32 v64, v24, 18, v64
v_lshlrev_b32 v8, 2, v8
v_lshl_add_u32 v8, v104, 10, v8
ds_write_b32 v8, v64
v_and_b32 v8, 0xff, v145
v_lshl_or_b32 v65, v25, 18, v65
v_lshlrev_b32 v8, 2, v8
v_lshl_add_u32 v8, v105, 10, v8
ds_write_b32 v8, v65
v_and_b32 v8, 0xff, v146
v_lshl_or_b32 v66, v26, 18, v66
v_lshlrev_b32 v8, 2, v8
v_lshl_add_u32 v8, v106, 10, v8
ds_write_b32 v8, v66
v_and_b32 v8, 0xff, v147
v_lshl_or_b32 v67, v27, 18, v67
v_lshlrev_b32 v8, 2, v8
v_lshl_add_u32 v8, v107, 10, v8
ds_write_b32 v8, v67
s_waitcnt vmcnt(6) lgkmcnt(15)
v_and_b32 v8, 0xff, v148
v_lshl_or_b32 v68, v28, 18, v68
v_lshlrev_b32 v8, 2, v8
v_lshl_add_u32 v8, v108, 10, v8
ds_write_b32 v8, v68
v_and_b32 v8, 0xff, v149
v_lshl_or_b32 v69, v29, 18, v69
v_lshlrev_b32 v8, 2, v8
v_lshl_add_u32 v8, v109, 10, v8
ds_write_b32 v8, v69
v_and_b32 v8, 0xff, v150
v_lshl_or_b32 v70, v30, 18, v70
v_lshlrev_b32 v8, 2, v8
v_lshl_add_u32 v8, v110, 10, v8
ds_write_b32 v8, v70
v_and_b32 v8, 0xff, v151
v_lshl_or_b32 v71, v31, 18, v71
v_lshlrev_b32 v8, 2, v8
v_lshl_add_u32 v8, v111, 10, v8
ds_write_b32 v8, v71
s_waitcnt vmcnt(5) lgkmcnt(15)
v_and_b32 v8, 0xff, v152
v_lshl_or_b32 v72, v32, 18, v72
v_lshlrev_b32 v8, 2, v8
v_lshl_add_u32 v8, v112, 10, v8
ds_write_b32 v8, v72
v_and_b32 v8, 0xff, v153
v_lshl_or_b32 v73, v33, 18, v73
v_lshlrev_b32 v8, 2, v8
v_lshl_add_u32 v8, v113, 10, v8
ds_write_b32 v8, v73
v_and_b32 v8, 0xff, v154
v_lshl_or_b32 v74, v34, 18, v74
v_lshlrev_b32 v8, 2, v8
v_lshl_add_u32 v8, v114, 10, v8
ds_write_b32 v8, v74
v_and_b32 v8, 0xff, v155
v_lshl_or_b32 v75, v35, 18, v75
v_lshlrev_b32 v8, 2, v8
v_lshl_add_u32 v8, v115, 10, v8
ds_write_b32 v8, v75
s_waitcnt vmcnt(4) lgkmcnt(15)
v_and_b32 v8, 0xff, v156
v_lshl_or_b32 v76, v36, 18, v76
v_lshlrev_b32 v8, 2, v8
v_lshl_add_u32 v8, v116, 10, v8
ds_write_b32 v8, v76
v_and_b32 v8, 0xff, v157
v_lshl_or_b32 v77, v37, 18, v77
v_lshlrev_b32 v8, 2, v8
v_lshl_add_u32 v8, v117, 10, v8
ds_write_b32 v8, v77
v_and_b32 v8, 0xff, v158
v_lshl_or_b32 v78, v38, 18, v78
v_lshlrev_b32 v8, 2, v8
v_lshl_add_u32 v8, v118, 10, v8
ds_write_b32 v8, v78
v_and_b32 v8, 0xff, v159
v_lshl_or_b32 v79, v39, 18, v79
v_lshlrev_b32 v8, 2, v8
v_lshl_add_u32 v8, v119, 10, v8
ds_write_b32 v8, v79
s_waitcnt vmcnt(3) lgkmcnt(15)
v_and_b32 v8, 0xff, v160
v_lshl_or_b32 v80, v40, 18, v80
v_lshlrev_b32 v8, 2, v8
v_lshl_add_u32 v8, v120, 10, v8
ds_write_b32 v8, v80
v_and_b32 v8, 0xff, v161
v_lshl_or_b32 v81, v41, 18, v81
v_lshlrev_b32 v8, 2, v8
v_lshl_add_u32 v8, v121, 10, v8
ds_write_b32 v8, v81
v_and_b32 v8, 0xff, v162
v_lshl_or_b32 v82, v42, 18, v82
v_lshlrev_b32 v8, 2, v8
v_lshl_add_u32 v8, v122, 10, v8
ds_write_b32 v8, v82
v_and_b32 v8, 0xff, v163
v_lshl_or_b32 v83, v43, 18, v83
v_lshlrev_b32 v8, 2, v8
v_lshl_add_u32 v8, v123, 10, v8
ds_write_b32 v8, v83
s_waitcnt vmcnt(2) lgkmcnt(15)
v_and_b32 v8, 0xff, v164
v_lshl_or_b32 v84, v44, 18, v84
v_lshlrev_b32 v8, 2, v8
v_lshl_add_u32 v8, v124, 10, v8
ds_write_b32 v8, v84
v_and_b32 v8, 0xff, v165
v_lshl_or_b32 v85, v45, 18, v85
v_lshlrev_b32 v8, 2, v8
v_lshl_add_u32 v8, v125, 10, v8
ds_write_b32 v8, v85
v_and_b32 v8, 0xff, v166
v_lshl_or_b32 v86, v46, 18, v86
v_lshlrev_b32 v8, 2, v8
v_lshl_add_u32 v8, v126, 10, v8
ds_write_b32 v8, v86
v_and_b32 v8, 0xff, v167
v_lshl_or_b32 v87, v47, 18, v87
v_lshlrev_b32 v8, 2, v8
v_lshl_add_u32 v8, v127, 10, v8
ds_write_b32 v8, v87
s_waitcnt vmcnt(1) lgkmcnt(15)
v_and_b32 v8, 0xff, v168
v_lshl_or_b32 v88, v48, 18, v88
v_lshlrev_b32 v8, 2, v8
v_lshl_add_u32 v8, v128, 10, v8
ds_write_b32 v8, v88
v_and_b32 v8, 0xff, v169
v_lshl_or_b32 v89, v49, 18, v89
v_lshlrev_b32 v8, 2, v8
v_lshl_add_u32 v8, v129, 10, v8
ds_write_b32 v8, v89
v_and_b32 v8, 0xff, v170
v_lshl_or_b32 v90, v50, 18, v90
v_lshlrev_b32 v8, 2, v8
v_lshl_add_u32 v8, v130, 10, v8
ds_write_b32 v8, v90
v_and_b32 v8, 0xff, v171
v_lshl_or_b32 v91, v51, 18, v91
v_lshlrev_b32 v8, 2, v8
v_lshl_add_u32 v8, v131, 10, v8
ds_write_b32 v8, v91
s_waitcnt vmcnt(0) lgkmcnt(15)
s_mov_b64 exec, s[12:13]
v_and_b32 v8, 0xff, v172
v_lshl_or_b32 v92, v52, 18, v92
v_lshlrev_b32 v8, 2, v8
v_lshl_add_u32 v8, v132, 10, v8
ds_write_b32 v8, v92
v_and_b32 v8, 0xff, v173
v_lshl_or_b32 v93, v53, 18, v93
v_lshlrev_b32 v8, 2, v8
v_lshl_add_u32 v8, v133, 10, v8
ds_write_b32 v8, v93
v_and_b32 v8, 0xff, v174
v_lshl_or_b32 v94, v54, 18, v94
v_lshlrev_b32 v8, 2, v8
v_lshl_add_u32 v8, v134, 10, v8
ds_write_b32 v8, v94
v_and_b32 v8, 0xff, v175
v_lshl_or_b32 v95, v55, 18, v95
v_lshlrev_b32 v8, 2, v8
v_lshl_add_u32 v8, v135, 10, v8
ds_write_b32 v8, v95
s_mov_b64 exec, -1
s_waitcnt lgkmcnt(0)
s_barrier
ds_read_b32 v8, v6
s_mul_i32 s6, s60, 16384
v_lshlrev_b32 v10, 4, v2
v_add_u32 v9, s6, v10
ds_read_b128 v[176:179], v9 offset:0
ds_read_b128 v[180:183], v9 offset:1024
ds_read_b128 v[184:187], v9 offset:2048
ds_read_b128 v[188:191], v9 offset:3072
ds_read_b128 v[192:195], v9 offset:4096
ds_read_b128 v[196:199], v9 offset:5120
ds_read_b128 v[200:203], v9 offset:6144
ds_read_b128 v[204:207], v9 offset:7168
ds_read_b128 v[208:211], v9 offset:8192
ds_read_b128 v[212:215], v9 offset:9216
ds_read_b128 v[216:219], v9 offset:10240
ds_read_b128 v[220:223], v9 offset:11264
ds_read_b128 v[224:227], v9 offset:12288
ds_read_b128 v[228:231], v9 offset:13312
ds_read_b128 v[232:235], v9 offset:14336
ds_read_b128 v[236:239], v9 offset:15360
s_mul_i32 s6, s60, 10485760
s_mul_i32 s7, s4, 40960
s_add_u32 s6, s6, s7
v_lshlrev_b32 v9, 6, v2
s_lshl_b32 s8, s4, 2
s_cmp_eq_u32 s60, 0
s_cselect_b32 s8, s8, 0x7fff0000
s_waitcnt lgkmcnt(15)
buffer_store_dword v8, v9, s[52:55], s8 offen sc1
v_cmp_lt_u32 vcc, 0x100, v8
s_cbranch_vccnz L1_eslow
s_waitcnt lgkmcnt(15)
buffer_store_dwordx4 v[176:179], v10, s[48:51], s6 offen sc1
s_add_u32 s6, s6, 655360
s_waitcnt lgkmcnt(14)
buffer_store_dwordx4 v[180:183], v10, s[48:51], s6 offen sc1
s_add_u32 s6, s6, 655360
s_waitcnt lgkmcnt(13)
buffer_store_dwordx4 v[184:187], v10, s[48:51], s6 offen sc1
s_add_u32 s6, s6, 655360
s_waitcnt lgkmcnt(12)
buffer_store_dwordx4 v[188:191], v10, s[48:51], s6 offen sc1
s_add_u32 s6, s6, 655360
s_waitcnt lgkmcnt(11)
buffer_store_dwordx4 v[192:195], v10, s[48:51], s6 offen sc1
s_add_u32 s6, s6, 655360
s_waitcnt lgkmcnt(10)
buffer_store_dwordx4 v[196:199], v10, s[48:51], s6 offen sc1
s_add_u32 s6, s6, 655360
s_waitcnt lgkmcnt(9)
buffer_store_dwordx4 v[200:203], v10, s[48:51], s6 offen sc1
s_add_u32 s6, s6, 655360
s_waitcnt lgkmcnt(8)
buffer_store_dwordx4 v[204:207], v10, s[48:51], s6 offen sc1
s_add_u32 s6, s6, 655360
s_waitcnt lgkmcnt(7)
buffer_store_dwordx4 v[208:211], v10, s[48:51], s6 offen sc1
s_add_u32 s6, s6, 655360
s_waitcnt lgkmcnt(6)
buffer_store_dwordx4 v[212:215], v10, s[48:51], s6 offen sc1
s_add_u32 s6, s6, 655360
s_waitcnt lgkmcnt(5)
buffer_store_dwordx4 v[216:219], v10, s[48:51], s6 offen sc1
s_add_u32 s6, s6, 655360
s_waitcnt lgkmcnt(4)
buffer_store_dwordx4 v[220:223], v10, s[48:51], s6 offen sc1
s_add_u32 s6, s6, 655360
s_waitcnt lgkmcnt(3)
buffer_store_dwordx4 v[224:227], v10, s[48:51], s6 offen sc1
s_add_u32 s6, s6, 655360
s_waitcnt lgkmcnt(2)
buffer_store_dwordx4 v[228:231], v10, s[48:51], s6 offen sc1
s_add_u32 s6, s6, 655360
s_waitcnt lgkmcnt(1)
buffer_store_dwordx4 v[232:235], v10, s[48:51], s6 offen sc1
s_add_u32 s6, s6, 655360
s_waitcnt lgkmcnt(0)
buffer_store_dwordx4 v[236:239], v10, s[48:51], s6 offen sc1
s_add_u32 s6, s6, 655360
s_branch L1_fin
L1_eslow:
s_mov_b32 s9, 655360
v_mul_u32_u24 v96, s9, v96
v_lshl_add_u32 v96, v136, 2, v96
v_mul_u32_u24 v97, s9, v97
v_lshl_add_u32 v97, v137, 2, v97
v_mul_u32_u24 v98, s9, v98
v_lshl_add_u32 v98, v138, 2, v98
v_mul_u32_u24 v99, s9, v99
v_lshl_add_u32 v99, v139, 2, v99
v_mul_u32_u24 v100, s9, v100
v_lshl_add_u32 v100, v140, 2, v100
v_mul_u32_u24 v101, s9, v101
v_lshl_add_u32 v101, v141, 2, v101
v_mul_u32_u24 v102, s9, v102
v_lshl_add_u32 v102, v142, 2, v102
v_mul_u32_u24 v103, s9, v103
v_lshl_add_u32 v103, v143, 2, v103
v_mul_u32_u24 v104, s9, v104
v_lshl_add_u32 v104, v144, 2, v104
v_mul_u32_u24 v105, s9, v105
v_lshl_add_u32 v105, v145, 2, v105
v_mul_u32_u24 v106, s9, v106
v_lshl_add_u32 v106, v146, 2, v106
v_mul_u32_u24 v107, s9, v107
v_lshl_add_u32 v107, v147, 2, v107
v_mul_u32_u24 v108, s9, v108
v_lshl_add_u32 v108, v148, 2, v108
v_mul_u32_u24 v109, s9, v109
v_lshl_add_u32 v109, v149, 2, v109
v_mul_u32_u24 v110, s9, v110
v_lshl_add_u32 v110, v150, 2, v110
v_mul_u32_u24 v111, s9, v111
v_lshl_add_u32 v111, v151, 2, v111
v_mul_u32_u24 v112, s9, v112
v_lshl_add_u32 v112, v152, 2, v112
v_mul_u32_u24 v113, s9, v113
v_lshl_add_u32 v113, v153, 2, v113
v_mul_u32_u24 v114, s9, v114
v_lshl_add_u32 v114, v154, 2, v114
v_mul_u32_u24 v115, s9, v115
v_lshl_add_u32 v115, v155, 2, v115
v_mul_u32_u24 v116, s9, v116
v_lshl_add_u32 v116, v156, 2, v116
v_mul_u32_u24 v117, s9, v117
v_lshl_add_u32 v117, v157, 2, v117
v_mul_u32_u24 v118, s9, v118
v_lshl_add_u32 v118, v158, 2, v118
v_mul_u32_u24 v119, s9, v119
v_lshl_add_u32 v119, v159, 2, v119
v_mul_u32_u24 v120, s9, v120
v_lshl_add_u32 v120, v160, 2, v120
v_mul_u32_u24 v121, s9, v121
v_lshl_add_u32 v121, v161, 2, v121
v_mul_u32_u24 v122, s9, v122
v_lshl_add_u32 v122, v162, 2, v122
v_mul_u32_u24 v123, s9, v123
v_lshl_add_u32 v123, v163, 2, v123
v_mul_u32_u24 v124, s9, v124
v_lshl_add_u32 v124, v164, 2, v124
v_mul_u32_u24 v125, s9, v125
v_lshl_add_u32 v125, v165, 2, v125
v_mul_u32_u24 v126, s9, v126
v_lshl_add_u32 v126, v166, 2, v126
v_mul_u32_u24 v127, s9, v127
v_lshl_add_u32 v127, v167, 2, v127
v_mul_u32_u24 v128, s9, v128
v_lshl_add_u32 v128, v168, 2, v128
v_mul_u32_u24 v129, s9, v129
v_lshl_add_u32 v129, v169, 2, v129
v_mul_u32_u24 v130, s9, v130
v_lshl_add_u32 v130, v170, 2, v130
v_mul_u32_u24 v131, s9, v131
v_lshl_add_u32 v131, v171, 2, v131
v_mul_u32_u24 v132, s9, v132
v_lshl_add_u32 v132, v172, 2, v132
v_mul_u32_u24 v133, s9, v133
v_lshl_add_u32 v133, v173, 2, v133
v_mul_u32_u24 v134, s9, v134
v_lshl_add_u32 v134, v174, 2, v134
v_mul_u32_u24 v135, s9, v135
v_lshl_add_u32 v135, v175, 2, v135
buffer_store_dword v56, v96, s[48:51], s7 offen sc1
buffer_store_dword v57, v97, s[48:51], s7 offen sc1
buffer_store_dword v58, v98, s[48:51], s7 offen sc1
buffer_store_dword v59, v99, s[48:51], s7 offen sc1
buffer_store_dword v60, v100, s[48:51], s7 offen sc1
buffer_store_dword v61, v101, s[48:51], s7 offen sc1
buffer_store_dword v62, v102, s[48:51], s7 offen sc1
buffer_store_dword v63, v103, s[48:51], s7 offen sc1
buffer_store_dword v64, v104, s[48:51], s7 offen sc1
buffer_store_dword v65, v105, s[48:51], s7 offen sc1
buffer_store_dword v66, v106, s[48:51], s7 offen sc1
buffer_store_dword v67, v107, s[48:51], s7 offen sc1
buffer_store_dword v68, v108, s[48:51], s7 offen sc1
buffer_store_dword v69, v109, s[48:51], s7 offen sc1
buffer_store_dword v70, v110, s[48:51], s7 offen sc1
buffer_store_dword v71, v111, s[48:51], s7 offen sc1
buffer_store_dword v72, v112, s[48:51], s7 offen sc1
buffer_store_dword v73, v113, s[48:51], s7 offen sc1
buffer_store_dword v74, v114, s[48:51], s7 offen sc1
buffer_store_dword v75, v115, s[48:51], s7 offen sc1
buffer_store_dword v76, v116, s[48:51], s7 offen sc1
buffer_store_dword v77, v117, s[48:51], s7 offen sc1
buffer_store_dword v78, v118, s[48:51], s7 offen sc1
buffer_store_dword v79, v119, s[48:51], s7 offen sc1
buffer_store_dword v80, v120, s[48:51], s7 offen sc1
buffer_store_dword v81, v121, s[48:51], s7 offen sc1
buffer_store_dword v82, v122, s[48:51], s7 offen sc1
buffer_store_dword v83, v123, s[48:51], s7 offen sc1
buffer_store_dword v84, v124, s[48:51], s7 offen sc1
buffer_store_dword v85, v125, s[48:51], s7 offen sc1
buffer_store_dword v86, v126, s[48:51], s7 offen sc1
buffer_store_dword v87, v127, s[48:51], s7 offen sc1
buffer_store_dword v88, v128, s[48:51], s7 offen sc1
buffer_store_dword v89, v129, s[48:51], s7 offen sc1
buffer_store_dword v90, v130, s[48:51], s7 offen sc1
buffer_store_dword v91, v131, s[48:51], s7 offen sc1
s_mov_b64 exec, s[12:13]
buffer_store_dword v92, v132, s[48:51], s7 offen sc1
buffer_store_dword v93, v133, s[48:51], s7 offen sc1
buffer_store_dword v94, v134, s[48:51], s7 offen sc1
buffer_store_dword v95, v135, s[48:51], s7 offen sc1
s_mov_b64 exec, -1
s_branch L1_fin
L2_entry:
s_load_dwordx2 s[4:5], s[0:1], 88
s_load_dwordx2 s[60:61], s[0:1], 0
s_load_dwordx2 s[52:53], s[0:1], 24
s_load_dwordx2 s[56:57], s[0:1], 72
s_and_b32 s35, s2, 7
s_lshr_b32 s37, s2, 3
s_add_u32 s37, s37, 30
s_and_b32 s37, s37, 31
v_lshrrev_b32 v1, 6, v0
s_mov_b32 s36, -1
v_readfirstlane_b32 s38, v1
s_cmp_lt_u32 s37, 30
s_cbranch_scc1 L2_att
s_lshl_b32 s39, s35, 1
s_add_u32 s39, s39, s37
s_sub_u32 s39, s39, 30
s_cmp_lt_u32 s38, 3
s_cbranch_scc1 LE_start
s_cmp_ge_u32 s39, 12
s_cbranch_scc1 L2_end
s_and_b32 s36, s39, 1
s_lshr_b32 s37, s39, 1
s_mov_b32 s38, 39
v_and_b32 v0, 63, v0
s_branch L2_att2
L2_att:
s_mul_i32 s38, s37, 26
s_lshr_b32 s38, s38, 8
s_mul_i32 s39, s38, 10
s_sub_u32 s39, s37, s39
s_and_b32 s37, s35, 1
s_mul_i32 s37, s37, 3
s_add_u32 s37, s37, s38
s_lshr_b32 s38, s35, 1
s_mul_i32 s38, s38, 10
s_add_u32 s38, s38, s39
L2_att2:
v_lshrrev_b32 v1, 6, v0
v_and_b32 v248, 63, v0
v_lshlrev_b32 v248, 4, v248
v_readfirstlane_b32 s34, v1
s_mov_b32 s50, 0xe1a06800
s_mov_b32 s51, 0x4e20ad04
s_mul_i32 s39, s37, 9
s_lshr_b64 s[50:51], s[50:51], s39
s_and_b32 s39, s50, 0x1ff
s_bfe_u32 s49, s50, 0x90009
s_sub_u32 s31, s49, s39
s_sub_u32 s31, s31, 4
s_lshl_b32 s39, s39, 14
s_lshl_b32 s49, s49, 14
s_add_u32 s28, s39, 0x4000
s_cmp_eq_u32 s37, 5
s_addc_u32 s31, s31, 0
s_cmp_eq_u32 s37, 5
s_cselect_b32 s28, s39, s28
s_cselect_b32 s39, 5111808, s39
s_cselect_b32 s49, 5120000, s49
s_cselect_b32 s33, 0xff800000, 0
s_mov_b32 s32, 0x5d800000
v_and_b32 v2, 63, v0
v_bfe_u32 v3, v2, 3, 2
v_bfe_u32 v4, v2, 2, 1
v_lshlrev_b32 v241, 12, v3
v_lshl_or_b32 v241, v4, 9, v241
v_lshl_or_b32 v241, v1, 7, v241
v_lshrrev_b32 v4, 5, v2
v_lshl_or_b32 v241, v4, 6, v241
v_and_b32 v3, 2, v3
v_and_b32 v4, 3, v2
v_xor_b32 v3, v3, v4
v_lshl_or_b32 v241, v3, 4, v241
s_cmp_eq_u32 s38, 39
s_cbranch_scc1 LT_disp
s_cmp_lt_u32 s37, 3
s_cselect_b32 s101, 1, -1
s_cselect_b32 s39, 0, 103
s_cselect_b32 s3, 0, 3
s_sub_u32 s3, s37, s3
s_mul_i32 s3, s3, 104
s_add_u32 s39, s39, s3
s_cmp_eq_u32 s37, 5
s_addc_u32 s39, s39, 0
s_lshl_b32 s101, s101, 14
s_lshl_b32 s39, s39, 14
s_add_u32 s28, s39, s101
s_mov_b32 s49, 5120000
s_mov_b32 s31, 40
s_mov_b32 s100, 3
s_lshl_b32 s30, s34, 12
s_lshl_b32 s50, s34, 13
s_add_u32 s50, s50, 0x20000
s_mov_b32 m0, s30
s_mov_b32 s6, 0x92c51840
s_mov_b32 s7, 0xfb73ea6d
s_mul_i32 s3, s37, 12
s_min_u32 s3, s3, 56
s_lshr_b64 s[6:7], s[6:7], s3
s_bfe_u32 s29, s6, 0x40008
s_bfe_u32 s7, s6, 0x40004
s_and_b32 s6, s6, 15
s_cmp_lt_u32 s37, 4
s_cselect_b32 s29, s29, 16
s_mov_b32 s94, 0
s_mov_b32 s95, 0
s_lshr_b32 s3, s6, 2
s_cmp_eq_u32 s3, s34
s_cselect_b32 s94, s6, s94
s_cselect_b32 s95, 1, s95
s_lshr_b32 s3, s7, 2
s_cmp_eq_u32 s3, s34
s_cselect_b32 s94, s7, s94
s_cselect_b32 s95, 1, s95
s_lshr_b32 s3, s29, 2
s_cmp_eq_u32 s3, s34
s_cselect_b32 s94, s29, s94
s_cselect_b32 s95, 1, s95
s_and_b32 s94, s94, 3
s_lshl_b32 s3, s38, 17
s_lshl_b32 s51, s34, 7
s_add_u32 s3, s3, s51
s_lshl_b32 s6, s6, 13
s_add_u32 s6, s6, s3
s_lshl_b32 s7, s7, 13
s_add_u32 s7, s7, s3
s_lshl_b32 s29, s29, 13
s_add_u32 s29, s29, s3
s_mov_b64 s[96:97], 0
s_lshr_b32 s3, s6, 9
s_mul_i32 s40, s3, 6945
s_mov_b32 s41, s40
s_mul_i32 s40, s3, 6317
s_add_u32 s40, s40, 0x340674
s_cmp_lt_u32 s3, 5436
s_cselect_b32 s41, s41, s40
s_mul_i32 s40, s3, 6899
s_add_u32 s40, s40, 0xfffae6a0
s_cmp_lt_u32 s3, 6432
s_cselect_b32 s41, s41, s40
s_mul_i32 s40, s3, 6242
s_add_u32 s40, s40, 0x4484a0
s_cmp_lt_u32 s3, 7344
s_cselect_b32 s41, s41, s40
s_lshr_b32 s3, s41, 20
s_bitset1_b64 s[96:97], s3
s_lshr_b32 s3, s6, 9
s_add_u32 s3, s3, 15
s_mul_i32 s40, s3, 6945
s_mov_b32 s41, s40
s_mul_i32 s40, s3, 6317
s_add_u32 s40, s40, 0x340674
s_cmp_lt_u32 s3, 5436
s_cselect_b32 s41, s41, s40
s_mul_i32 s40, s3, 6899
s_add_u32 s40, s40, 0xfffae6a0
s_cmp_lt_u32 s3, 6432
s_cselect_b32 s41, s41, s40
s_mul_i32 s40, s3, 6242
s_add_u32 s40, s40, 0x4484a0
s_cmp_lt_u32 s3, 7344
s_cselect_b32 s41, s41, s40
s_lshr_b32 s3, s41, 20
s_bitset1_b64 s[96:97], s3
s_lshr_b32 s3, s7, 9
s_mul_i32 s40, s3, 6945
s_mov_b32 s41, s40
s_mul_i32 s40, s3, 6317
s_add_u32 s40, s40, 0x340674
s_cmp_lt_u32 s3, 5436
s_cselect_b32 s41, s41, s40
s_mul_i32 s40, s3, 6899
s_add_u32 s40, s40, 0xfffae6a0
s_cmp_lt_u32 s3, 6432
s_cselect_b32 s41, s41, s40
s_mul_i32 s40, s3, 6242
s_add_u32 s40, s40, 0x4484a0
s_cmp_lt_u32 s3, 7344
s_cselect_b32 s41, s41, s40
s_lshr_b32 s3, s41, 20
s_bitset1_b64 s[96:97], s3
s_lshr_b32 s3, s7, 9
s_add_u32 s3, s3, 15
s_mul_i32 s40, s3, 6945
s_mov_b32 s41, s40
s_mul_i32 s40, s3, 6317
s_add_u32 s40, s40, 0x340674
s_cmp_lt_u32 s3, 5436
s_cselect_b32 s41, s41, s40
s_mul_i32 s40, s3, 6899
s_add_u32 s40, s40, 0xfffae6a0
s_cmp_lt_u32 s3, 6432
s_cselect_b32 s41, s41, s40
s_mul_i32 s40, s3, 6242
s_add_u32 s40, s40, 0x4484a0
s_cmp_lt_u32 s3, 7344
s_cselect_b32 s41, s41, s40
s_lshr_b32 s3, s41, 20
s_bitset1_b64 s[96:97], s3
s_lshr_b32 s3, s29, 9
s_mul_i32 s40, s3, 6945
s_mov_b32 s41, s40
s_mul_i32 s40, s3, 6317
s_add_u32 s40, s40, 0x340674
s_cmp_lt_u32 s3, 5436
s_cselect_b32 s41, s41, s40
s_mul_i32 s40, s3, 6899
s_add_u32 s40, s40, 0xfffae6a0
s_cmp_lt_u32 s3, 6432
s_cselect_b32 s41, s41, s40
s_mul_i32 s40, s3, 6242
s_add_u32 s40, s40, 0x4484a0
s_cmp_lt_u32 s3, 7344
s_cselect_b32 s41, s41, s40
s_lshr_b32 s3, s41, 20
s_bitset1_b64 s[96:97], s3
s_lshr_b32 s3, s29, 9
s_add_u32 s3, s3, 15
s_mul_i32 s40, s3, 6945
s_mov_b32 s41, s40
s_mul_i32 s40, s3, 6317
s_add_u32 s40, s40, 0x340674
s_cmp_lt_u32 s3, 5436
s_cselect_b32 s41, s41, s40
s_mul_i32 s40, s3, 6899
s_add_u32 s40, s40, 0xfffae6a0
s_cmp_lt_u32 s3, 6432
s_cselect_b32 s41, s41, s40
s_mul_i32 s40, s3, 6242
s_add_u32 s40, s40, 0x4484a0
s_cmp_lt_u32 s3, 7344
s_cselect_b32 s41, s41, s40
s_lshr_b32 s3, s41, 20
s_bitset1_b64 s[96:97], s3
s_mul_i32 s3, s38, 6
s_add_u32 s3, s3, s37
s_cmp_eq_u32 s3, 233
s_cselect_b32 s3, 0, s37
s_cmp_lt_u32 s3, 4
s_cselect_b32 s29, s29, 0x70000000
s_lshl_b32 s51, s38, 5
s_lshl_b32 s3, s34, 3
s_add_u32 s51, s51, s3
s_add_u32 s51, s51, s37
s_mul_i32 s51, s51, 128
s_add_u32 s51, s51, 0x7c00000
s_lshr_b32 s40, s39, 17
s_min_u32 s40, s40, 38
s_lshr_b32 s41, s28, 17
s_add_u32 s3, s28, s101
s_lshr_b32 s3, s3, 17
v_mov_b32 v5, s38
v_mov_b32 v6, s40
v_cmp_lt_u32 vcc, 0x7f, v248
s_nop 1
v_cndmask_b32 v5, v5, v6, vcc
v_mov_b32 v6, s41
v_cmp_lt_u32 vcc, 0xff, v248
s_nop 1
v_cndmask_b32 v5, v5, v6, vcc
v_mov_b32 v6, s3
v_cmp_lt_u32 vcc, 0x17f, v248
s_nop 1
v_cndmask_b32 v5, v5, v6, vcc
v_bfe_u32 v6, v248, 4, 3
v_min_u32 v6, 5, v6
v_mad_u32_u24 v5, v5, 6, v6
v_lshlrev_b32 v5, 7, v5
v_add_u32 v5, 0x7c2a000, v5
s_mul_i32 s3, s101, 54
s_add_u32 s3, s3, s39
s_min_u32 s41, s3, s39
s_max_u32 s3, s3, s39
s_lshr_b32 s41, s41, 17
s_min_u32 s40, s40, s41
s_mul_i32 s40, s40, 6
s_lshr_b32 s3, s3, 17
s_min_u32 s3, s3, 38
s_mul_i32 s3, s3, 6
s_add_u32 s3, s3, 5
v_lshrrev_b32 v251, 4, v248
v_add_u32 v251, s40, v251
v_min_u32 v251, s3, v251
v_lshlrev_b32 v251, 7, v251
v_add_u32 v251, 0x7c2a000, v251
s_waitcnt lgkmcnt(0)
s_add_u32 s12, s4, 0x6800000
s_addc_u32 s13, s5, 0
s_mov_b32 s14, 0x0
s_mov_b32 s15, 0x00020000
s_mov_b32 s14, s49
s_add_u32 s8, s4, 0x0
s_addc_u32 s9, s5, 0
s_mov_b32 s10, 0x4e4000
s_mov_b32 s11, 0x00020000
s_mul_i32 s35, s37, 0x600000
s_add_u32 s20, s4, 0x2000000
s_addc_u32 s21, s5, 0
s_add_u32 s20, s20, s35
s_addc_u32 s21, s21, 0
s_mov_b32 s22, 0x4e4000
s_mov_b32 s23, 0x00020000
s_add_u32 s24, s4, 0x6000000
s_addc_u32 s25, s5, 0
s_mov_b32 s26, 0x139000
s_mov_b32 s27, 0x00020000
s_lshl_b32 s35, s38, 4
s_lshl_b32 s41, s34, 2
s_add_u32 s35, s35, s41
s_lshl_b32 s40, s35, 13
s_lshl_b32 s94, s94, 13
s_add_u32 s40, s40, s94
s_xor_b32 s41, s40, 8192
s_xor_b32 s42, s40, 16384
s_xor_b32 s43, s40, 24576
s_add_u32 s44, s40, 4096
s_add_u32 s45, s41, 4096
s_add_u32 s46, s42, 4096
s_add_u32 s47, s43, 4096
s_lshl_b32 s48, s35, 10
s_lshl_b32 s35, s37, 3
s_add_u32 s48, s48, s35
v_mov_b32 v232, 0
v_mov_b32 v233, 0
v_mov_b32 v234, 0
v_mov_b32 v235, 0
v_bfe_u32 v240, v248, 4, 3
v_lshlrev_b32 v240, 6, v240
v_bfe_u32 v242, v248, 7, 1
v_lshl_or_b32 v240, v242, 10, v240
v_bfe_u32 v242, v248, 8, 2
v_lshl_or_b32 v240, v242, 4, v240
v_bfe_u32 v242, v248, 6, 1
v_lshlrev_b32 v242, 5, v242
v_xor_b32 v240, v240, v242
v_and_b32 v249, 0x1c0, v248
v_bfe_u32 v242, v248, 9, 1
v_lshl_or_b32 v249, v242, 10, v249
v_bfe_u32 v242, v248, 8, 1
v_lshl_or_b32 v249, v242, 5, v249
v_bfe_u32 v242, v248, 4, 2
v_lshl_or_b32 v249, v242, 3, v249
v_xor_b32 v250, 32, v249
v_bfe_i32 v242, v248, 8, 1
v_and_b32 v192, s33, v242
v_and_b32 v193, s33, v242
v_and_b32 v194, s33, v242
v_and_b32 v195, s33, v242
v_mfma_f32_32x32x16_bf16 a[0:15], v[232:235], v[232:235], 0
v_mfma_f32_32x32x16_bf16 a[16:31], v[232:235], v[232:235], 0
v_mfma_f32_32x32x16_bf16 a[32:47], v[232:235], v[232:235], 0
v_mfma_f32_32x32x16_bf16 a[48:63], v[232:235], v[232:235], 0
v_mfma_f32_32x32x16_bf16 a[64:79], v[232:235], v[232:235], 0
v_mfma_f32_32x32x16_bf16 a[80:95], v[232:235], v[232:235], 0
v_mfma_f32_32x32x16_bf16 a[96:111], v[232:235], v[232:235], 0
v_mfma_f32_32x32x16_bf16 a[112:127], v[232:235], v[232:235], 0
v_mfma_f32_32x32x16_bf16 a[128:143], v[232:235], v[232:235], 0
v_mfma_f32_32x32x16_bf16 a[144:159], v[232:235], v[232:235], 0
v_mfma_f32_32x32x16_bf16 a[160:175], v[232:235], v[232:235], 0
v_mfma_f32_32x32x16_bf16 a[176:191], v[232:235], v[232:235], 0
v_mfma_f32_32x32x16_bf16 a[192:207], v[232:235], v[232:235], 0
v_mfma_f32_32x32x16_bf16 a[208:223], v[232:235], v[232:235], 0
v_mfma_f32_32x32x16_bf16 a[224:239], v[232:235], v[232:235], 0
v_mfma_f32_32x32x16_bf16 a[240:255], v[232:235], v[232:235], 0
s_add_u32 s16, s4, 0x0
s_addc_u32 s17, s5, 0
s_mov_b32 s18, 0x10000000
s_mov_b32 s19, 0x00020000
s_mov_b32 s3, 0x10000
LM_pa:
buffer_load_dwordx2 v[6:7], v5, s[16:19], 0 offen sc1
s_sub_u32 s3, s3, 1
s_waitcnt vmcnt(0)
s_cbranch_scc1 LM_pa_go
v_cmp_ne_u64 vcc, s[98:99], v[6:7]
s_nop 1
s_cbranch_vccnz LM_pa
LM_pa_go:
buffer_load_dwordx4 v241, s[12:15], s39 offen offset:0 sc1 lds
buffer_load_dwordx4 v241, s[12:15], s39 offen offset:1024 sc1 lds
buffer_load_dwordx4 v241, s[12:15], s39 offen offset:2048 sc1 lds
buffer_load_dwordx4 v241, s[12:15], s39 offen offset:3072 sc1 lds
s_add_u32 m0, s30, 0x4000
s_nop 0
buffer_load_dwordx4 v241, s[12:15], s28 offen offset:0 sc1 lds
buffer_load_dwordx4 v241, s[12:15], s28 offen offset:1024 sc1 lds
buffer_load_dwordx4 v[0:3], v248, s[8:11], s40 offen offset:0 sc1
buffer_load_dwordx4 v[32:35], v248, s[8:11], s41 offen offset:0 sc1
buffer_load_dwordx4 v[64:67], v248, s[8:11], s42 offen offset:0 sc1
buffer_load_dwordx4 v[96:99], v248, s[8:11], s43 offen offset:0 sc1
buffer_load_dwordx4 v[4:7], v248, s[8:11], s40 offen offset:1024 sc1
buffer_load_dwordx4 v[36:39], v248, s[8:11], s41 offen offset:1024 sc1
buffer_load_dwordx4 v[68:71], v248, s[8:11], s42 offen offset:1024 sc1
buffer_load_dwordx4 v[100:103], v248, s[8:11], s43 offen offset:1024 sc1
buffer_load_dwordx4 v[8:11], v248, s[8:11], s40 offen offset:2048 sc1
buffer_load_dwordx4 v[40:43], v248, s[8:11], s41 offen offset:2048 sc1
buffer_load_dwordx4 v[72:75], v248, s[8:11], s42 offen offset:2048 sc1
buffer_load_dwordx4 v[104:107], v248, s[8:11], s43 offen offset:2048 sc1
buffer_load_dwordx4 v[12:15], v248, s[8:11], s40 offen offset:3072 sc1
buffer_load_dwordx4 v[44:47], v248, s[8:11], s41 offen offset:3072 sc1
buffer_load_dwordx4 v[76:79], v248, s[8:11], s42 offen offset:3072 sc1
buffer_load_dwordx4 v[108:111], v248, s[8:11], s43 offen offset:3072 sc1
buffer_load_dwordx4 v[16:19], v248, s[8:11], s44 offen offset:0 sc1
buffer_load_dwordx4 v[48:51], v248, s[8:11], s45 offen offset:0 sc1
buffer_load_dwordx4 v[80:83], v248, s[8:11], s46 offen offset:0 sc1
buffer_load_dwordx4 v[112:115], v248, s[8:11], s47 offen offset:0 sc1
buffer_load_dwordx2 v[252:253], v251, s[16:19], 0 offen sc1
s_waitcnt vmcnt(21)
s_barrier
ds_read_b128 v[208:211], v240 offset:0
ds_read_b128 v[212:215], v240 offset:2048
ds_read_b128 v[216:219], v240 offset:16384
ds_read_b128 v[220:223], v240 offset:512
s_waitcnt lgkmcnt(3)
s_waitcnt vmcnt(17)
v_mfma_f32_16x16x32_bf16 v[128:131], v[208:211], v[0:3], v[192:195]
buffer_load_dwordx4 v[20:23], v248, s[8:11], s44 offen offset:1024 sc1
v_mfma_f32_16x16x32_bf16 v[132:135], v[208:211], v[32:35], v[192:195]
v_mfma_f32_16x16x32_bf16 v[136:139], v[208:211], v[64:67], v[192:195]
v_mfma_f32_16x16x32_bf16 v[140:143], v[208:211], v[96:99], v[192:195]
ds_read_b128 v[208:211], v240 offset:2560
s_waitcnt lgkmcnt(3)
buffer_load_dwordx4 v[52:55], v248, s[8:11], s45 offen offset:1024 sc1
v_mfma_f32_16x16x32_bf16 v[144:147], v[212:215], v[0:3], v[192:195]
v_mfma_f32_16x16x32_bf16 v[148:151], v[212:215], v[32:35], v[192:195]
v_mfma_f32_16x16x32_bf16 v[152:155], v[212:215], v[64:67], v[192:195]
buffer_load_dwordx4 v[84:87], v248, s[8:11], s46 offen offset:1024 sc1
v_mfma_f32_16x16x32_bf16 v[156:159], v[212:215], v[96:99], v[192:195]
ds_read_b128 v[212:215], v240 offset:16896
s_waitcnt lgkmcnt(3)
v_mfma_f32_16x16x32_bf16 v[176:179], v[216:219], v[0:3], 0
v_mfma_f32_16x16x32_bf16 v[180:183], v[216:219], v[32:35], 0
buffer_load_dwordx4 v[116:119], v248, s[8:11], s47 offen offset:1024 sc1
v_mfma_f32_16x16x32_bf16 v[184:187], v[216:219], v[64:67], 0
v_mfma_f32_16x16x32_bf16 v[188:191], v[216:219], v[96:99], 0
ds_read_b128 v[216:219], v240 offset:4096
s_waitcnt lgkmcnt(3)
s_waitcnt vmcnt(17)
v_mfma_f32_16x16x32_bf16 v[128:131], v[220:223], v[4:7], v[128:131]
buffer_load_dwordx4 v[24:27], v248, s[8:11], s44 offen offset:2048 sc1
v_mfma_f32_16x16x32_bf16 v[132:135], v[220:223], v[36:39], v[132:135]
v_mfma_f32_16x16x32_bf16 v[136:139], v[220:223], v[68:71], v[136:139]
v_mfma_f32_16x16x32_bf16 v[140:143], v[220:223], v[100:103], v[140:143]
ds_read_b128 v[220:223], v240 offset:6144
s_waitcnt lgkmcnt(3)
buffer_load_dwordx4 v[56:59], v248, s[8:11], s45 offen offset:2048 sc1
v_mfma_f32_16x16x32_bf16 v[144:147], v[208:211], v[4:7], v[144:147]
v_mfma_f32_16x16x32_bf16 v[148:151], v[208:211], v[36:39], v[148:151]
v_mfma_f32_16x16x32_bf16 v[152:155], v[208:211], v[68:71], v[152:155]
buffer_load_dwordx4 v[88:91], v248, s[8:11], s46 offen offset:2048 sc1
v_mfma_f32_16x16x32_bf16 v[156:159], v[208:211], v[100:103], v[156:159]
ds_read_b128 v[208:211], v240 offset:20480
s_waitcnt lgkmcnt(3)
v_mfma_f32_16x16x32_bf16 v[176:179], v[212:215], v[4:7], v[176:179]
v_mfma_f32_16x16x32_bf16 v[180:183], v[212:215], v[36:39], v[180:183]
buffer_load_dwordx4 v[120:123], v248, s[8:11], s47 offen offset:2048 sc1
v_mfma_f32_16x16x32_bf16 v[184:187], v[212:215], v[68:71], v[184:187]
v_mfma_f32_16x16x32_bf16 v[188:191], v[212:215], v[100:103], v[188:191]
ds_read_b128 v[212:215], v240 offset:4608
s_waitcnt lgkmcnt(3)
s_waitcnt vmcnt(17)
v_mfma_f32_16x16x32_bf16 v[128:131], v[216:219], v[8:11], v[128:131]
buffer_load_dwordx4 v[28:31], v248, s[8:11], s44 offen offset:3072 sc1
v_mfma_f32_16x16x32_bf16 v[132:135], v[216:219], v[40:43], v[132:135]
v_mfma_f32_16x16x32_bf16 v[136:139], v[216:219], v[72:75], v[136:139]
v_mfma_f32_16x16x32_bf16 v[140:143], v[216:219], v[104:107], v[140:143]
ds_read_b128 v[216:219], v240 offset:6656
s_waitcnt lgkmcnt(3)
buffer_load_dwordx4 v[60:63], v248, s[8:11], s45 offen offset:3072 sc1
v_mfma_f32_16x16x32_bf16 v[144:147], v[220:223], v[8:11], v[144:147]
v_mfma_f32_16x16x32_bf16 v[148:151], v[220:223], v[40:43], v[148:151]
v_mfma_f32_16x16x32_bf16 v[152:155], v[220:223], v[72:75], v[152:155]
buffer_load_dwordx4 v[92:95], v248, s[8:11], s46 offen offset:3072 sc1
v_mfma_f32_16x16x32_bf16 v[156:159], v[220:223], v[104:107], v[156:159]
ds_read_b128 v[220:223], v240 offset:20992
s_waitcnt lgkmcnt(3)
v_mfma_f32_16x16x32_bf16 v[176:179], v[208:211], v[8:11], v[176:179]
v_mfma_f32_16x16x32_bf16 v[180:183], v[208:211], v[40:43], v[180:183]
buffer_load_dwordx4 v[124:127], v248, s[8:11], s47 offen offset:3072 sc1
v_mfma_f32_16x16x32_bf16 v[184:187], v[208:211], v[72:75], v[184:187]
v_mfma_f32_16x16x32_bf16 v[188:191], v[208:211], v[104:107], v[188:191]
ds_read_b128 v[208:211], v240 offset:8192
s_waitcnt lgkmcnt(3)
s_waitcnt vmcnt(17)
v_mfma_f32_16x16x32_bf16 v[128:131], v[212:215], v[12:15], v[128:131]
s_add_u32 s16, s4, 0x0
s_addc_u32 s17, s5, 0
s_mov_b32 s18, 0x10000000
v_mfma_f32_16x16x32_bf16 v[132:135], v[212:215], v[44:47], v[132:135]
buffer_load_dwordx4 v241, s[12:15], s28 offen offset:2048 sc1 lds
s_mov_b32 s19, 0x00020000
s_add_u32 s8, s60, 0x0
v_mfma_f32_16x16x32_bf16 v[136:139], v[212:215], v[76:79], v[136:139]
s_addc_u32 s9, s61, 0
s_mov_b32 s10, 0x4e2000
s_mov_b32 s11, 0x00020000
v_mfma_f32_16x16x32_bf16 v[140:143], v[212:215], v[108:111], v[140:143]
ds_read_b128 v[212:215], v240 offset:10240
s_waitcnt lgkmcnt(3)
buffer_load_dwordx4 v241, s[12:15], s28 offen offset:3072 sc1 lds
v_mfma_f32_16x16x32_bf16 v[144:147], v[216:219], v[12:15], v[144:147]
s_mov_b32 s54, 0x4e20
s_mov_b32 s55, 0x00020000
s_mov_b32 s58, 0x4e2000
v_mfma_f32_16x16x32_bf16 v[148:151], v[216:219], v[44:47], v[148:151]
s_mov_b32 s59, 0x00020000
s_lshr_b32 s48, s40, 2
s_cmp_eq_u32 s95, 1
v_mfma_f32_16x16x32_bf16 v[152:155], v[216:219], v[76:79], v[152:155]
s_cselect_b32 s40, 0x70000000, s40
s_cselect_b32 s44, 0x70000000, s44
s_cmp_lt_u32 s37, 3
v_mfma_f32_16x16x32_bf16 v[156:159], v[216:219], v[108:111], v[156:159]
ds_read_b128 v[216:219], v240 offset:24576
s_waitcnt lgkmcnt(3)
s_cselect_b32 s3, 0, 3
v_mfma_f32_16x16x32_bf16 v[176:179], v[220:223], v[12:15], v[176:179]
s_sub_u32 s3, s37, s3
s_cmp_eq_u32 s3, 2
s_cselect_b32 s39, 8, 7
v_mfma_f32_16x16x32_bf16 v[180:183], v[220:223], v[44:47], v[180:183]
s_cselect_b32 s35, 5, 5
s_lshl_b32 s49, s38, 2
s_add_u32 s49, s49, s3
v_mfma_f32_16x16x32_bf16 v[184:187], v[220:223], v[76:79], v[184:187]
s_lshl_b32 s49, s49, 10
s_add_u32 s49, s49, 0x7c00300
v_mfma_f32_16x16x32_bf16 v[188:191], v[220:223], v[108:111], v[188:191]
ds_read_b128 v[220:223], v240 offset:8704
s_waitcnt lgkmcnt(3)
s_waitcnt vmcnt(15)
v_mfma_f32_16x16x32_bf16 v[128:131], v[208:211], v[16:19], v[128:131]
v_mfma_f32_16x16x32_bf16 v[132:135], v[208:211], v[48:51], v[132:135]
s_add_u32 s28, s28, s101
s_add_u32 m0, s30, 0x8000
s_nop 0
v_mfma_f32_16x16x32_bf16 v[136:139], v[208:211], v[80:83], v[136:139]
v_mfma_f32_16x16x32_bf16 v[140:143], v[208:211], v[112:115], v[140:143]
ds_read_b128 v[208:211], v240 offset:10752
s_waitcnt lgkmcnt(3)
buffer_load_dwordx4 v241, s[12:15], s28 offen offset:0 sc1 lds
v_mfma_f32_16x16x32_bf16 v[144:147], v[212:215], v[16:19], v[144:147]
v_mfma_f32_16x16x32_bf16 v[148:151], v[212:215], v[48:51], v[148:151]
buffer_load_dwordx4 v241, s[12:15], s28 offen offset:1024 sc1 lds
v_mfma_f32_16x16x32_bf16 v[152:155], v[212:215], v[80:83], v[152:155]
v_mfma_f32_16x16x32_bf16 v[156:159], v[212:215], v[112:115], v[156:159]
ds_read_b128 v[212:215], v240 offset:25088
s_waitcnt lgkmcnt(3)
v_mfma_f32_16x16x32_bf16 v[176:179], v[216:219], v[16:19], v[176:179]
v_mfma_f32_16x16x32_bf16 v[180:183], v[216:219], v[48:51], v[180:183]
v_mfma_f32_16x16x32_bf16 v[184:187], v[216:219], v[80:83], v[184:187]
v_mfma_f32_16x16x32_bf16 v[188:191], v[216:219], v[112:115], v[188:191]
ds_read_b128 v[216:219], v240 offset:12288
s_waitcnt lgkmcnt(3)
s_waitcnt vmcnt(12)
v_mfma_f32_16x16x32_bf16 v[128:131], v[220:223], v[20:23], v[128:131]
v_mfma_f32_16x16x32_bf16 v[132:135], v[220:223], v[52:55], v[132:135]
buffer_load_dwordx4 v241, s[12:15], s28 offen offset:2048 sc1 lds
v_mfma_f32_16x16x32_bf16 v[136:139], v[220:223], v[84:87], v[136:139]
v_mfma_f32_16x16x32_bf16 v[140:143], v[220:223], v[116:119], v[140:143]
ds_read_b128 v[220:223], v240 offset:14336
s_waitcnt lgkmcnt(3)
buffer_load_dwordx4 v241, s[12:15], s28 offen offset:3072 sc1 lds
v_mfma_f32_16x16x32_bf16 v[144:147], v[208:211], v[20:23], v[144:147]
v_mfma_f32_16x16x32_bf16 v[148:151], v[208:211], v[52:55], v[148:151]
v_mfma_f32_16x16x32_bf16 v[152:155], v[208:211], v[84:87], v[152:155]
v_mfma_f32_16x16x32_bf16 v[156:159], v[208:211], v[116:119], v[156:159]
ds_read_b128 v[208:211], v240 offset:28672
s_waitcnt lgkmcnt(3)
v_mfma_f32_16x16x32_bf16 v[176:179], v[212:215], v[20:23], v[176:179]
v_mfma_f32_16x16x32_bf16 v[180:183], v[212:215], v[52:55], v[180:183]
v_mfma_f32_16x16x32_bf16 v[184:187], v[212:215], v[84:87], v[184:187]
v_mfma_f32_16x16x32_bf16 v[188:191], v[212:215], v[116:119], v[188:191]
ds_read_b128 v[212:215], v240 offset:12800
s_waitcnt lgkmcnt(3)
s_waitcnt vmcnt(10)
v_mfma_f32_16x16x32_bf16 v[128:131], v[216:219], v[24:27], v[128:131]
v_mfma_f32_16x16x32_bf16 v[132:135], v[216:219], v[56:59], v[132:135]
s_add_u32 s28, s28, s101
s_add_u32 s30, s30, 0xc000
v_mfma_f32_16x16x32_bf16 v[136:139], v[216:219], v[88:91], v[136:139]
v_mfma_f32_16x16x32_bf16 v[140:143], v[216:219], v[120:123], v[140:143]
ds_read_b128 v[216:219], v240 offset:14848
s_waitcnt lgkmcnt(3)
v_mfma_f32_16x16x32_bf16 v[144:147], v[220:223], v[24:27], v[144:147]
v_mfma_f32_16x16x32_bf16 v[148:151], v[220:223], v[56:59], v[148:151]
v_mfma_f32_16x16x32_bf16 v[152:155], v[220:223], v[88:91], v[152:155]
v_mfma_f32_16x16x32_bf16 v[156:159], v[220:223], v[120:123], v[156:159]
ds_read_b128 v[220:223], v240 offset:29184
s_waitcnt lgkmcnt(3)
v_mfma_f32_16x16x32_bf16 v[176:179], v[208:211], v[24:27], v[176:179]
v_mfma_f32_16x16x32_bf16 v[180:183], v[208:211], v[56:59], v[180:183]
v_mfma_f32_16x16x32_bf16 v[184:187], v[208:211], v[88:91], v[184:187]
v_mfma_f32_16x16x32_bf16 v[188:191], v[208:211], v[120:123], v[188:191]
s_waitcnt lgkmcnt(2)
s_waitcnt vmcnt(6)
v_mfma_f32_16x16x32_bf16 v[128:131], v[212:215], v[28:31], v[128:131]
v_mfma_f32_16x16x32_bf16 v[132:135], v[212:215], v[60:63], v[132:135]
v_mfma_f32_16x16x32_bf16 v[136:139], v[212:215], v[92:95], v[136:139]
v_mfma_f32_16x16x32_bf16 v[140:143], v[212:215], v[124:127], v[140:143]
s_waitcnt lgkmcnt(1)
v_mfma_f32_16x16x32_bf16 v[144:147], v[216:219], v[28:31], v[144:147]
v_mfma_f32_16x16x32_bf16 v[148:151], v[216:219], v[60:63], v[148:151]
v_mfma_f32_16x16x32_bf16 v[152:155], v[216:219], v[92:95], v[152:155]
v_mfma_f32_16x16x32_bf16 v[156:159], v[216:219], v[124:127], v[156:159]
s_waitcnt lgkmcnt(0)
v_mfma_f32_16x16x32_bf16 v[176:179], v[220:223], v[28:31], v[176:179]
v_mfma_f32_16x16x32_bf16 v[180:183], v[220:223], v[60:63], v[180:183]
v_mfma_f32_16x16x32_bf16 v[184:187], v[220:223], v[92:95], v[184:187]
v_mfma_f32_16x16x32_bf16 v[188:191], v[220:223], v[124:127], v[188:191]
v_max3_f32 v244, v128, v129, v130
v_max3_f32 v245, v132, v133, v134
v_max3_f32 v246, v136, v137, v138
v_max3_f32 v247, v140, v141, v142
v_max3_f32 v244, v244, v131, v144
v_max3_f32 v245, v245, v135, v148
v_max3_f32 v246, v246, v139, v152
v_max3_f32 v247, v247, v143, v156
v_max3_f32 v244, v244, v145, v146
v_max3_f32 v245, v245, v149, v150
v_max3_f32 v246, v246, v153, v154
v_max3_f32 v247, v247, v157, v158
v_max_f32 v244, v244, v147
v_max_f32 v245, v245, v151
v_max_f32 v246, v246, v155
v_max_f32 v247, v247, v159
v_mov_b32 v232, v244
v_mov_b32 v233, v245
v_mov_b32 v234, v246
v_mov_b32 v235, v247
v_permlane32_swap_b32 v244, v232
v_permlane32_swap_b32 v245, v233
v_permlane32_swap_b32 v246, v234
v_permlane32_swap_b32 v247, v235
v_max_f32 v244, v244, v232
v_max_f32 v245, v245, v233
v_max_f32 v246, v246, v234
v_max_f32 v247, v247, v235
v_mov_b32 v232, v244
v_mov_b32 v233, v245
v_mov_b32 v234, v246
v_mov_b32 v235, v247
v_permlane16_swap_b32 v244, v232
v_permlane16_swap_b32 v245, v233
v_permlane16_swap_b32 v246, v234
v_permlane16_swap_b32 v247, v235
v_max_f32 v244, v244, v232
v_max_f32 v245, v245, v233
v_max_f32 v246, v246, v234
v_max_f32 v247, v247, v235
v_ceil_f32 v244, v244
v_ceil_f32 v245, v245
v_ceil_f32 v246, v246
v_ceil_f32 v247, v247
v_sub_f32 v128, v128, v244
v_sub_f32 v129, v129, v244
v_sub_f32 v130, v130, v244
v_sub_f32 v131, v131, v244
v_exp_f32 v128, v128
v_exp_f32 v129, v129
v_exp_f32 v130, v130
v_exp_f32 v131, v131
v_sub_f32 v192, 0, v244
v_sub_f32 v193, 0, v244
v_sub_f32 v194, 0, v244
v_sub_f32 v195, 0, v244
v_sub_f32 v132, v132, v245
v_sub_f32 v133, v133, v245
v_sub_f32 v134, v134, v245
v_sub_f32 v135, v135, v245
v_exp_f32 v132, v132
v_exp_f32 v133, v133
v_exp_f32 v134, v134
v_exp_f32 v135, v135
v_sub_f32 v196, 0, v245
v_sub_f32 v197, 0, v245
v_sub_f32 v198, 0, v245
v_sub_f32 v199, 0, v245
v_sub_f32 v136, v136, v246
v_sub_f32 v137, v137, v246
v_sub_f32 v138, v138, v246
v_sub_f32 v139, v139, v246
v_exp_f32 v136, v136
v_exp_f32 v137, v137
v_exp_f32 v138, v138
v_exp_f32 v139, v139
v_sub_f32 v200, 0, v246
v_sub_f32 v201, 0, v246
v_sub_f32 v202, 0, v246
v_sub_f32 v203, 0, v246
v_sub_f32 v140, v140, v247
v_sub_f32 v141, v141, v247
v_sub_f32 v142, v142, v247
v_sub_f32 v143, v143, v247
v_exp_f32 v140, v140
v_exp_f32 v141, v141
v_exp_f32 v142, v142
v_exp_f32 v143, v143
v_sub_f32 v204, 0, v247
v_sub_f32 v205, 0, v247
v_sub_f32 v206, 0, v247
v_sub_f32 v207, 0, v247
s_waitcnt vmcnt(4)
s_barrier
ds_read_b128 v[208:211], v240 offset:18432
ds_read_b128 v[212:215], v240 offset:18944
ds_read_b128 v[216:219], v240 offset:22528
ds_read_b128 v[220:223], v240 offset:23040
v_sub_f32 v144, v144, v244
v_sub_f32 v145, v145, v244
v_sub_f32 v146, v146, v244
v_sub_f32 v147, v147, v244
v_exp_f32 v144, v144
v_exp_f32 v145, v145
v_exp_f32 v146, v146
v_exp_f32 v147, v147
v_sub_f32 v148, v148, v245
v_sub_f32 v149, v149, v245
v_sub_f32 v150, v150, v245
v_sub_f32 v151, v151, v245
v_exp_f32 v148, v148
v_exp_f32 v149, v149
v_exp_f32 v150, v150
v_exp_f32 v151, v151
v_sub_f32 v152, v152, v246
v_sub_f32 v153, v153, v246
v_sub_f32 v154, v154, v246
v_sub_f32 v155, v155, v246
v_exp_f32 v152, v152
v_exp_f32 v153, v153
v_exp_f32 v154, v154
v_exp_f32 v155, v155
v_sub_f32 v156, v156, v247
v_sub_f32 v157, v157, v247
v_sub_f32 v158, v158, v247
v_sub_f32 v159, v159, v247
v_exp_f32 v156, v156
v_exp_f32 v157, v157
v_exp_f32 v158, v158
v_exp_f32 v159, v159
v_cvt_pk_bf16_f32 v160, v128, v129
v_cvt_pk_bf16_f32 v161, v130, v131
v_cvt_pk_bf16_f32 v164, v132, v133
v_cvt_pk_bf16_f32 v165, v134, v135
v_cvt_pk_bf16_f32 v168, v136, v137
v_cvt_pk_bf16_f32 v169, v138, v139
v_cvt_pk_bf16_f32 v172, v140, v141
v_cvt_pk_bf16_f32 v173, v142, v143
v_cvt_pk_bf16_f32 v162, v144, v145
v_cvt_pk_bf16_f32 v163, v146, v147
v_cvt_pk_bf16_f32 v166, v148, v149
v_cvt_pk_bf16_f32 v167, v150, v151
v_cvt_pk_bf16_f32 v170, v152, v153
v_cvt_pk_bf16_f32 v171, v154, v155
v_cvt_pk_bf16_f32 v174, v156, v157
v_cvt_pk_bf16_f32 v175, v158, v159
v_add_f32 v224, v128, v129
v_add_f32 v225, v132, v133
v_add_f32 v226, v136, v137
v_add_f32 v227, v140, v141
v_add_f32 v228, v130, v131
v_add_f32 v229, v134, v135
v_add_f32 v230, v138, v139
v_add_f32 v231, v142, v143
v_add_f32 v224, v224, v144
v_add_f32 v225, v225, v148
v_add_f32 v226, v226, v152
v_add_f32 v227, v227, v156
v_add_f32 v228, v228, v145
v_add_f32 v229, v229, v149
v_add_f32 v230, v230, v153
v_add_f32 v231, v231, v157
v_add_f32 v224, v224, v146
v_add_f32 v225, v225, v150
v_add_f32 v226, v226, v154
v_add_f32 v227, v227, v158
v_add_f32 v228, v228, v147
v_add_f32 v229, v229, v151
v_add_f32 v230, v230, v155
v_add_f32 v231, v231, v159
v_add_f32 v224, v224, v228
v_add_f32 v225, v225, v229
v_add_f32 v226, v226, v230
v_add_f32 v227, v227, v231
v_sub_f32 v128, v176, v244
v_sub_f32 v129, v177, v244
v_sub_f32 v130, v178, v244
v_sub_f32 v131, v179, v244
v_sub_f32 v132, v180, v245
v_sub_f32 v133, v181, v245
v_sub_f32 v134, v182, v245
v_sub_f32 v135, v183, v245
v_sub_f32 v136, v184, v246
v_sub_f32 v137, v185, v246
v_sub_f32 v138, v186, v246
v_sub_f32 v139, v187, v246
v_sub_f32 v140, v188, v247
v_sub_f32 v141, v189, v247
v_sub_f32 v142, v190, v247
v_sub_f32 v143, v191, v247
v_cmp_ne_u64 vcc, s[98:99], v[252:253]
s_nop 1
s_cbranch_vccnz LM_pb
LM_pb_ret:
s_nop 1
s_waitcnt lgkmcnt(2)
v_mfma_f32_16x16x32_bf16 v[144:147], v[208:211], v[0:3], v[192:195]
v_mfma_f32_16x16x32_bf16 v[144:147], v[212:215], v[4:7], v[144:147]
v_mfma_f32_16x16x32_bf16 v[148:151], v[208:211], v[32:35], v[196:199]
v_mfma_f32_16x16x32_bf16 v[148:151], v[212:215], v[36:39], v[148:151]
v_mfma_f32_16x16x32_bf16 v[152:155], v[208:211], v[64:67], v[200:203]
v_exp_f32 v128, v128
v_mfma_f32_16x16x32_bf16 v[152:155], v[212:215], v[68:71], v[152:155]
v_exp_f32 v129, v129
v_mfma_f32_16x16x32_bf16 v[156:159], v[208:211], v[96:99], v[204:207]
ds_read_b128 v[208:211], v240 offset:26624
v_exp_f32 v130, v130
v_mfma_f32_16x16x32_bf16 v[156:159], v[212:215], v[100:103], v[156:159]
ds_read_b128 v[212:215], v240 offset:27136
s_waitcnt lgkmcnt(2)
v_add_f32 v228, v224, v128
v_mfma_f32_16x16x32_bf16 v[144:147], v[216:219], v[8:11], v[144:147]
v_exp_f32 v131, v131
v_add_f32 v228, v228, v129
v_mfma_f32_16x16x32_bf16 v[144:147], v[220:223], v[12:15], v[144:147]
v_add_f32 v228, v228, v130
v_add_f32 v228, v228, v131
v_mfma_f32_16x16x32_bf16 v[148:151], v[216:219], v[40:43], v[148:151]
v_exp_f32 v132, v132
v_mfma_f32_16x16x32_bf16 v[148:151], v[220:223], v[44:47], v[148:151]
v_exp_f32 v133, v133
v_mfma_f32_16x16x32_bf16 v[152:155], v[216:219], v[72:75], v[152:155]
v_exp_f32 v134, v134
v_add_f32 v229, v225, v132
v_mfma_f32_16x16x32_bf16 v[152:155], v[220:223], v[76:79], v[152:155]
v_exp_f32 v135, v135
v_add_f32 v229, v229, v133
v_mfma_f32_16x16x32_bf16 v[156:159], v[216:219], v[104:107], v[156:159]
ds_read_b128 v[216:219], v240 offset:30720
v_add_f32 v229, v229, v134
v_add_f32 v229, v229, v135
v_mfma_f32_16x16x32_bf16 v[156:159], v[220:223], v[108:111], v[156:159]
ds_read_b128 v[220:223], v240 offset:31232
s_waitcnt lgkmcnt(2)
v_mfma_f32_16x16x32_bf16 v[144:147], v[208:211], v[16:19], v[144:147]
v_exp_f32 v136, v136
v_mfma_f32_16x16x32_bf16 v[144:147], v[212:215], v[20:23], v[144:147]
v_add_u32 v240, 0x8000, v240
v_exp_f32 v137, v137
v_mfma_f32_16x16x32_bf16 v[148:151], v[208:211], v[48:51], v[148:151]
v_and_b32 v240, 0x1ffff, v240
v_exp_f32 v138, v138
v_mfma_f32_16x16x32_bf16 v[148:151], v[212:215], v[52:55], v[148:151]
v_add_f32 v230, v226, v136
v_exp_f32 v139, v139
v_mfma_f32_16x16x32_bf16 v[152:155], v[208:211], v[80:83], v[152:155]
v_add_f32 v230, v230, v137
v_add_f32 v230, v230, v138
v_add_f32 v230, v230, v139
v_mfma_f32_16x16x32_bf16 v[152:155], v[212:215], v[84:87], v[152:155]
v_exp_f32 v140, v140
v_mfma_f32_16x16x32_bf16 v[156:159], v[208:211], v[112:115], v[156:159]
ds_read_b64_tr_b16 v[208:209], v249 offset:0
ds_read_b64_tr_b16 v[210:211], v249 offset:2048
v_mfma_f32_16x16x32_bf16 v[156:159], v[212:215], v[116:119], v[156:159]
ds_read_b64_tr_b16 v[212:213], v250 offset:0
s_waitcnt lgkmcnt(3)
v_mfma_f32_16x16x32_bf16 v[144:147], v[216:219], v[24:27], v[144:147]
ds_read_b64_tr_b16 v[214:215], v250 offset:2048
v_exp_f32 v141, v141
v_mfma_f32_16x16x32_bf16 v[144:147], v[220:223], v[28:31], v[144:147]
v_exp_f32 v142, v142
v_add_f32 v231, v227, v140
v_mfma_f32_16x16x32_bf16 v[148:151], v[216:219], v[56:59], v[148:151]
v_exp_f32 v143, v143
v_add_f32 v231, v231, v141
v_mfma_f32_16x16x32_bf16 v[148:151], v[220:223], v[60:63], v[148:151]
v_add_f32 v231, v231, v142
v_add_f32 v231, v231, v143
v_max3_f32 v242, v228, v229, v230
v_mfma_f32_16x16x32_bf16 v[152:155], v[216:219], v[88:91], v[152:155]
v_max_f32 v242, v242, v231
v_mfma_f32_16x16x32_bf16 v[152:155], v[220:223], v[92:95], v[152:155]
v_cmp_lt_f32 vcc, s32, v242
v_mfma_f32_16x16x32_bf16 v[156:159], v[216:219], v[120:123], v[156:159]
ds_read_b64_tr_b16 v[216:217], v249 offset:512
ds_read_b64_tr_b16 v[218:219], v249 offset:2560
v_mfma_f32_16x16x32_bf16 v[156:159], v[220:223], v[124:127], v[156:159]
ds_read_b64_tr_b16 v[220:221], v250 offset:512
s_waitcnt lgkmcnt(5)
v_mfma_f32_16x16x32_bf16 a[0:3], v[160:163], v[208:211], a[0:3]
ds_read_b64_tr_b16 v[222:223], v250 offset:2560
s_cbranch_vccnz L2_rare_site4
L2_ret4:
v_mfma_f32_16x16x32_bf16 a[4:7], v[164:167], v[208:211], a[4:7]
s_mov_b32 m0, s30
v_mfma_f32_16x16x32_bf16 a[8:11], v[168:171], v[208:211], a[8:11]
buffer_load_dwordx4 v241, s[12:15], s28 offen offset:0 sc1 lds
v_mfma_f32_16x16x32_bf16 a[12:15], v[172:175], v[208:211], a[12:15]
ds_read_b64_tr_b16 v[208:209], v249 offset:4096
s_waitcnt lgkmcnt(5)
v_mfma_f32_16x16x32_bf16 a[16:19], v[160:163], v[212:215], a[16:19]
ds_read_b64_tr_b16 v[210:211], v249 offset:6144
buffer_load_dwordx4 v241, s[12:15], s28 offen offset:1024 sc1 lds
v_mfma_f32_16x16x32_bf16 a[20:23], v[164:167], v[212:215], a[20:23]
v_mfma_f32_16x16x32_bf16 a[24:27], v[168:171], v[212:215], a[24:27]
buffer_load_dwordx4 v241, s[12:15], s28 offen offset:2048 sc1 lds
v_mfma_f32_16x16x32_bf16 a[28:31], v[172:175], v[212:215], a[28:31]
ds_read_b64_tr_b16 v[212:213], v250 offset:4096
s_waitcnt lgkmcnt(5)
v_mfma_f32_16x16x32_bf16 a[32:35], v[160:163], v[216:219], a[32:35]
ds_read_b64_tr_b16 v[214:215], v250 offset:6144
v_exp_f32 v144, v144
v_mfma_f32_16x16x32_bf16 a[36:39], v[164:167], v[216:219], a[36:39]
buffer_load_dwordx4 v241, s[12:15], s28 offen offset:3072 sc1 lds
v_exp_f32 v145, v145
v_mfma_f32_16x16x32_bf16 a[40:43], v[168:171], v[216:219], a[40:43]
v_exp_f32 v146, v146
v_add_f32 v224, v228, v144
v_mfma_f32_16x16x32_bf16 a[44:47], v[172:175], v[216:219], a[44:47]
ds_read_b64_tr_b16 v[216:217], v249 offset:4608
s_waitcnt lgkmcnt(5)
v_mfma_f32_16x16x32_bf16 a[48:51], v[160:163], v[220:223], a[48:51]
ds_read_b64_tr_b16 v[218:219], v249 offset:6656
v_exp_f32 v147, v147
v_mfma_f32_16x16x32_bf16 a[52:55], v[164:167], v[220:223], a[52:55]
v_add_f32 v224, v224, v145
v_add_f32 v224, v224, v146
v_add_f32 v224, v224, v147
v_mfma_f32_16x16x32_bf16 a[56:59], v[168:171], v[220:223], a[56:59]
v_exp_f32 v148, v148
v_mfma_f32_16x16x32_bf16 a[60:63], v[172:175], v[220:223], a[60:63]
ds_read_b64_tr_b16 v[220:221], v250 offset:4608
s_waitcnt lgkmcnt(5)
v_mfma_f32_16x16x32_bf16 a[64:67], v[160:163], v[208:211], a[64:67]
ds_read_b64_tr_b16 v[222:223], v250 offset:6656
v_exp_f32 v149, v149
v_mfma_f32_16x16x32_bf16 a[68:71], v[164:167], v[208:211], a[68:71]
s_waitcnt vmcnt(4)
s_barrier
v_mfma_f32_16x16x32_bf16 a[72:75], v[168:171], v[208:211], a[72:75]
v_exp_f32 v150, v150
v_add_f32 v225, v229, v148
v_mfma_f32_16x16x32_bf16 a[76:79], v[172:175], v[208:211], a[76:79]
ds_read_b128 v[208:211], v240 offset:0
s_waitcnt lgkmcnt(5)
v_mfma_f32_16x16x32_bf16 a[80:83], v[160:163], v[212:215], a[80:83]
v_exp_f32 v151, v151
v_add_f32 v225, v225, v149
v_mfma_f32_16x16x32_bf16 a[84:87], v[164:167], v[212:215], a[84:87]
v_add_f32 v225, v225, v150
v_add_f32 v225, v225, v151
v_mfma_f32_16x16x32_bf16 a[88:91], v[168:171], v[212:215], a[88:91]
v_exp_f32 v152, v152
v_mfma_f32_16x16x32_bf16 a[92:95], v[172:175], v[212:215], a[92:95]
ds_read_b128 v[212:215], v240 offset:512
s_waitcnt lgkmcnt(4)
v_mfma_f32_16x16x32_bf16 a[96:99], v[160:163], v[216:219], a[96:99]
v_exp_f32 v153, v153
v_mfma_f32_16x16x32_bf16 a[100:103], v[164:167], v[216:219], a[100:103]
v_cvt_pk_bf16_f32 v176, v128, v129
v_cvt_pk_bf16_f32 v177, v130, v131
v_mfma_f32_16x16x32_bf16 a[104:107], v[168:171], v[216:219], a[104:107]
v_exp_f32 v154, v154
v_add_f32 v226, v230, v152
v_mfma_f32_16x16x32_bf16 a[108:111], v[172:175], v[216:219], a[108:111]
ds_read_b128 v[216:219], v240 offset:4096
s_waitcnt lgkmcnt(3)
v_cvt_pk_bf16_f32 v180, v132, v133
v_cvt_pk_bf16_f32 v181, v134, v135
v_mfma_f32_16x16x32_bf16 a[112:115], v[160:163], v[220:223], a[112:115]
v_exp_f32 v155, v155
v_add_f32 v226, v226, v153
v_mfma_f32_16x16x32_bf16 a[116:119], v[164:167], v[220:223], a[116:119]
v_cvt_pk_bf16_f32 v184, v136, v137
v_cvt_pk_bf16_f32 v185, v138, v139
v_add_f32 v226, v226, v154
v_mfma_f32_16x16x32_bf16 a[120:123], v[168:171], v[220:223], a[120:123]
v_add_f32 v226, v226, v155
v_exp_f32 v156, v156
v_mfma_f32_16x16x32_bf16 a[124:127], v[172:175], v[220:223], a[124:127]
ds_read_b128 v[220:223], v240 offset:4608
s_waitcnt lgkmcnt(2)
v_mfma_f32_16x16x32_bf16 v[128:131], v[208:211], v[0:3], v[192:195]
v_exp_f32 v157, v157
v_mfma_f32_16x16x32_bf16 v[128:131], v[212:215], v[4:7], v[128:131]
v_cvt_pk_bf16_f32 v188, v140, v141
v_cvt_pk_bf16_f32 v189, v142, v143
v_mfma_f32_16x16x32_bf16 v[132:135], v[208:211], v[32:35], v[196:199]
v_exp_f32 v158, v158
v_add_f32 v227, v231, v156
v_mfma_f32_16x16x32_bf16 v[132:135], v[212:215], v[36:39], v[132:135]
v_exp_f32 v159, v159
v_add_f32 v227, v227, v157
v_mfma_f32_16x16x32_bf16 v[136:139], v[208:211], v[64:67], v[200:203]
v_add_f32 v227, v227, v158
v_add_f32 v227, v227, v159
v_max3_f32 v242, v224, v225, v226
v_mfma_f32_16x16x32_bf16 v[136:139], v[212:215], v[68:71], v[136:139]
v_max_f32 v242, v242, v227
v_mfma_f32_16x16x32_bf16 v[140:143], v[208:211], v[96:99], v[204:207]
ds_read_b128 v[208:211], v240 offset:8192
v_cmp_lt_f32 vcc, s32, v242
v_mfma_f32_16x16x32_bf16 v[140:143], v[212:215], v[100:103], v[140:143]
ds_read_b128 v[212:215], v240 offset:8704
s_waitcnt lgkmcnt(2)
v_mfma_f32_16x16x32_bf16 v[128:131], v[216:219], v[8:11], v[128:131]
v_mfma_f32_16x16x32_bf16 v[128:131], v[220:223], v[12:15], v[128:131]
s_cbranch_vccnz L2_rare_site5
L2_ret5:
v_cvt_pk_bf16_f32 v178, v144, v145
v_cvt_pk_bf16_f32 v179, v146, v147
v_mfma_f32_16x16x32_bf16 v[132:135], v[216:219], v[40:43], v[132:135]
v_cvt_pk_bf16_f32 v182, v148, v149
v_cvt_pk_bf16_f32 v183, v150, v151
v_cvt_pk_bf16_f32 v186, v152, v153
v_mfma_f32_16x16x32_bf16 v[132:135], v[220:223], v[44:47], v[132:135]
v_cvt_pk_bf16_f32 v187, v154, v155
v_cvt_pk_bf16_f32 v190, v156, v157
v_cvt_pk_bf16_f32 v191, v158, v159
v_mfma_f32_16x16x32_bf16 v[136:139], v[216:219], v[72:75], v[136:139]
v_mfma_f32_16x16x32_bf16 v[136:139], v[220:223], v[76:79], v[136:139]
v_mfma_f32_16x16x32_bf16 v[140:143], v[216:219], v[104:107], v[140:143]
ds_read_b128 v[216:219], v240 offset:12288
v_mfma_f32_16x16x32_bf16 v[140:143], v[220:223], v[108:111], v[140:143]
ds_read_b128 v[220:223], v240 offset:12800
s_waitcnt lgkmcnt(2)
v_mfma_f32_16x16x32_bf16 v[128:131], v[208:211], v[16:19], v[128:131]
v_mfma_f32_16x16x32_bf16 v[128:131], v[212:215], v[20:23], v[128:131]
v_mfma_f32_16x16x32_bf16 v[132:135], v[208:211], v[48:51], v[132:135]
v_mfma_f32_16x16x32_bf16 v[132:135], v[212:215], v[52:55], v[132:135]
v_mfma_f32_16x16x32_bf16 v[136:139], v[208:211], v[80:83], v[136:139]
v_mfma_f32_16x16x32_bf16 v[136:139], v[212:215], v[84:87], v[136:139]
s_sub_u32 s31, s31, 1
v_mfma_f32_16x16x32_bf16 v[140:143], v[208:211], v[112:115], v[140:143]
ds_read_b128 v[208:211], v240 offset:2048
v_mfma_f32_16x16x32_bf16 v[140:143], v[212:215], v[116:119], v[140:143]
ds_read_b128 v[212:215], v240 offset:2560
s_waitcnt lgkmcnt(2)
v_mfma_f32_16x16x32_bf16 v[128:131], v[216:219], v[24:27], v[128:131]
s_add_u32 s28, s28, s101
s_add_u32 s30, s30, 0x4000
v_mfma_f32_16x16x32_bf16 v[128:131], v[220:223], v[28:31], v[128:131]
s_and_b32 s30, s30, 0x1ffff
v_mfma_f32_16x16x32_bf16 v[132:135], v[216:219], v[56:59], v[132:135]
v_mfma_f32_16x16x32_bf16 v[132:135], v[220:223], v[60:63], v[132:135]
v_mfma_f32_16x16x32_bf16 v[136:139], v[216:219], v[88:91], v[136:139]
v_mfma_f32_16x16x32_bf16 v[136:139], v[220:223], v[92:95], v[136:139]
v_mfma_f32_16x16x32_bf16 v[140:143], v[216:219], v[120:123], v[140:143]
ds_read_b128 v[216:219], v240 offset:6144
v_mfma_f32_16x16x32_bf16 v[140:143], v[220:223], v[124:127], v[140:143]
ds_read_b128 v[220:223], v240 offset:6656
s_branch L2_loop1
.p2align 6
L2_loop:
s_waitcnt lgkmcnt(2)
v_mfma_f32_16x16x32_bf16 v[144:147], v[208:211], v[0:3], v[192:195]
v_mfma_f32_16x16x32_bf16 v[144:147], v[212:215], v[4:7], v[144:147]
v_mfma_f32_16x16x32_bf16 v[148:151], v[208:211], v[32:35], v[196:199]
v_mfma_f32_16x16x32_bf16 v[148:151], v[212:215], v[36:39], v[148:151]
v_mfma_f32_16x16x32_bf16 v[152:155], v[208:211], v[64:67], v[200:203]
v_exp_f32 v128, v128
v_mfma_f32_16x16x32_bf16 v[152:155], v[212:215], v[68:71], v[152:155]
v_exp_f32 v129, v129
v_mfma_f32_16x16x32_bf16 v[156:159], v[208:211], v[96:99], v[204:207]
ds_read_b128 v[208:211], v240 offset:26624
v_mfma_f32_16x16x32_bf16 v[156:159], v[212:215], v[100:103], v[156:159]
ds_read_b128 v[212:215], v240 offset:27136
s_waitcnt lgkmcnt(2)
v_mfma_f32_16x16x32_bf16 v[144:147], v[216:219], v[8:11], v[144:147]
v_exp_f32 v130, v130
v_mfma_f32_16x16x32_bf16 v[144:147], v[220:223], v[12:15], v[144:147]
v_add_f32 v228, v224, v128
v_mfma_f32_16x16x32_bf16 v[148:151], v[216:219], v[40:43], v[148:151]
v_exp_f32 v131, v131
v_mfma_f32_16x16x32_bf16 v[148:151], v[220:223], v[44:47], v[148:151]
v_add_f32 v228, v228, v129
v_add_f32 v228, v228, v130
v_mfma_f32_16x16x32_bf16 v[152:155], v[216:219], v[72:75], v[152:155]
v_add_f32 v228, v228, v131
v_mfma_f32_16x16x32_bf16 v[152:155], v[220:223], v[76:79], v[152:155]
v_exp_f32 v132, v132
v_mfma_f32_16x16x32_bf16 v[156:159], v[216:219], v[104:107], v[156:159]
ds_read_b128 v[216:219], v240 offset:30720
v_mfma_f32_16x16x32_bf16 v[156:159], v[220:223], v[108:111], v[156:159]
ds_read_b128 v[220:223], v240 offset:31232
s_waitcnt lgkmcnt(2)
v_mfma_f32_16x16x32_bf16 v[144:147], v[208:211], v[16:19], v[144:147]
v_exp_f32 v133, v133
v_mfma_f32_16x16x32_bf16 v[144:147], v[212:215], v[20:23], v[144:147]
v_add_u32 v240, 0x8000, v240
v_mfma_f32_16x16x32_bf16 v[148:151], v[208:211], v[48:51], v[148:151]
v_and_b32 v240, 0x1ffff, v240
v_mfma_f32_16x16x32_bf16 v[148:151], v[212:215], v[52:55], v[148:151]
v_exp_f32 v134, v134
v_mfma_f32_16x16x32_bf16 v[152:155], v[208:211], v[80:83], v[152:155]
v_add_f32 v229, v225, v132
v_mfma_f32_16x16x32_bf16 v[152:155], v[212:215], v[84:87], v[152:155]
v_exp_f32 v135, v135
v_mfma_f32_16x16x32_bf16 v[156:159], v[208:211], v[112:115], v[156:159]
ds_read_b64_tr_b16 v[208:209], v244 offset:16384
ds_read_b64_tr_b16 v[210:211], v244 offset:18432
v_mfma_f32_16x16x32_bf16 v[156:159], v[212:215], v[116:119], v[156:159]
ds_read_b64_tr_b16 v[212:213], v249 offset:0
s_waitcnt lgkmcnt(3)
v_mfma_f32_16x16x32_bf16 v[144:147], v[216:219], v[24:27], v[144:147]
ds_read_b64_tr_b16 v[214:215], v249 offset:2048
v_add_f32 v229, v229, v133
v_mfma_f32_16x16x32_bf16 v[144:147], v[220:223], v[28:31], v[144:147]
v_add_f32 v229, v229, v134
v_add_f32 v229, v229, v135
v_mfma_f32_16x16x32_bf16 v[148:151], v[216:219], v[56:59], v[148:151]
v_exp_f32 v136, v136
v_mfma_f32_16x16x32_bf16 v[148:151], v[220:223], v[60:63], v[148:151]
v_exp_f32 v137, v137
v_mfma_f32_16x16x32_bf16 v[152:155], v[216:219], v[88:91], v[152:155]
v_exp_f32 v138, v138
v_mfma_f32_16x16x32_bf16 v[152:155], v[220:223], v[92:95], v[152:155]
v_add_f32 v230, v226, v136
v_mfma_f32_16x16x32_bf16 v[156:159], v[216:219], v[120:123], v[156:159]
ds_read_b64_tr_b16 v[216:217], v245 offset:16384
ds_read_b64_tr_b16 v[218:219], v245 offset:18432
v_mfma_f32_16x16x32_bf16 v[156:159], v[220:223], v[124:127], v[156:159]
ds_read_b64_tr_b16 v[220:221], v250 offset:0
s_waitcnt lgkmcnt(3)
v_mfma_f32_16x16x32_bf16 a[0:3], v[176:179], v[208:211], a[0:3]
ds_read_b64_tr_b16 v[222:223], v250 offset:2048
v_mfma_f32_16x16x32_bf16 a[0:3], v[160:163], v[212:215], a[0:3]
v_exp_f32 v139, v139
v_mfma_f32_16x16x32_bf16 a[4:7], v[180:183], v[208:211], a[4:7]
v_add_f32 v230, v230, v137
v_add_f32 v230, v230, v138
v_mfma_f32_16x16x32_bf16 a[4:7], v[164:167], v[212:215], a[4:7]
v_add_f32 v230, v230, v139
v_mfma_f32_16x16x32_bf16 a[8:11], v[184:187], v[208:211], a[8:11]
v_exp_f32 v140, v140
v_mfma_f32_16x16x32_bf16 a[8:11], v[168:171], v[212:215], a[8:11]
v_exp_f32 v141, v141
v_mfma_f32_16x16x32_bf16 a[12:15], v[188:191], v[208:211], a[12:15]
ds_read_b64_tr_b16 v[208:209], v244 offset:16896
ds_read_b64_tr_b16 v[210:211], v244 offset:18944
v_mfma_f32_16x16x32_bf16 a[12:15], v[172:175], v[212:215], a[12:15]
ds_read_b64_tr_b16 v[212:213], v249 offset:512
s_waitcnt lgkmcnt(3)
v_mfma_f32_16x16x32_bf16 a[16:19], v[176:179], v[216:219], a[16:19]
ds_read_b64_tr_b16 v[214:215], v249 offset:2560
v_mfma_f32_16x16x32_bf16 a[16:19], v[160:163], v[220:223], a[16:19]
v_exp_f32 v142, v142
v_mfma_f32_16x16x32_bf16 a[20:23], v[180:183], v[216:219], a[20:23]
v_add_f32 v231, v227, v140
v_mfma_f32_16x16x32_bf16 a[20:23], v[164:167], v[220:223], a[20:23]
v_exp_f32 v143, v143
v_mfma_f32_16x16x32_bf16 a[24:27], v[184:187], v[216:219], a[24:27]
v_add_f32 v231, v231, v141
v_add_f32 v231, v231, v142
v_mfma_f32_16x16x32_bf16 a[24:27], v[168:171], v[220:223], a[24:27]
v_add_f32 v231, v231, v143
v_max3_f32 v242, v228, v229, v230
v_mfma_f32_16x16x32_bf16 a[28:31], v[188:191], v[216:219], a[28:31]
ds_read_b64_tr_b16 v[216:217], v245 offset:16896
ds_read_b64_tr_b16 v[218:219], v245 offset:18944
v_mfma_f32_16x16x32_bf16 a[28:31], v[172:175], v[220:223], a[28:31]
ds_read_b64_tr_b16 v[220:221], v250 offset:512
s_waitcnt lgkmcnt(3)
v_mfma_f32_16x16x32_bf16 a[32:35], v[176:179], v[208:211], a[32:35]
ds_read_b64_tr_b16 v[222:223], v250 offset:2560
v_max_f32 v242, v242, v231
v_mfma_f32_16x16x32_bf16 a[32:35], v[160:163], v[212:215], a[32:35]
v_cmp_lt_f32 vcc, s32, v242
v_mfma_f32_16x16x32_bf16 a[36:39], v[180:183], v[208:211], a[36:39]
v_mfma_f32_16x16x32_bf16 a[36:39], v[164:167], v[212:215], a[36:39]
v_mfma_f32_16x16x32_bf16 a[40:43], v[184:187], v[208:211], a[40:43]
s_mov_b32 m0, s30
s_cbranch_vccnz L2_rare_site0
L2_ret0:
v_mfma_f32_16x16x32_bf16 a[40:43], v[168:171], v[212:215], a[40:43]
buffer_load_dwordx4 v241, s[12:15], s28 offen offset:0 sc1 lds
v_mfma_f32_16x16x32_bf16 a[44:47], v[188:191], v[208:211], a[44:47]
ds_read_b64_tr_b16 v[208:209], v244 offset:20480
ds_read_b64_tr_b16 v[210:211], v244 offset:22528
v_mfma_f32_16x16x32_bf16 a[44:47], v[172:175], v[212:215], a[44:47]
ds_read_b64_tr_b16 v[212:213], v249 offset:4096
s_waitcnt lgkmcnt(3)
v_mfma_f32_16x16x32_bf16 a[48:51], v[176:179], v[216:219], a[48:51]
ds_read_b64_tr_b16 v[214:215], v249 offset:6144
v_mfma_f32_16x16x32_bf16 a[48:51], v[160:163], v[220:223], a[48:51]
buffer_load_dwordx4 v241, s[12:15], s28 offen offset:1024 sc1 lds
v_mfma_f32_16x16x32_bf16 a[52:55], v[180:183], v[216:219], a[52:55]
v_exp_f32 v144, v144
v_mfma_f32_16x16x32_bf16 a[52:55], v[164:167], v[220:223], a[52:55]
v_exp_f32 v145, v145
v_mfma_f32_16x16x32_bf16 a[56:59], v[184:187], v[216:219], a[56:59]
v_exp_f32 v146, v146
v_mfma_f32_16x16x32_bf16 a[56:59], v[168:171], v[220:223], a[56:59]
buffer_load_dwordx4 v241, s[12:15], s28 offen offset:2048 sc1 lds
v_add_f32 v224, v228, v144
v_mfma_f32_16x16x32_bf16 a[60:63], v[188:191], v[216:219], a[60:63]
ds_read_b64_tr_b16 v[216:217], v245 offset:20480
ds_read_b64_tr_b16 v[218:219], v245 offset:22528
v_mfma_f32_16x16x32_bf16 a[60:63], v[172:175], v[220:223], a[60:63]
ds_read_b64_tr_b16 v[220:221], v250 offset:4096
s_waitcnt lgkmcnt(3)
v_mfma_f32_16x16x32_bf16 a[64:67], v[176:179], v[208:211], a[64:67]
ds_read_b64_tr_b16 v[222:223], v250 offset:6144
v_mfma_f32_16x16x32_bf16 a[64:67], v[160:163], v[212:215], a[64:67]
buffer_load_dwordx4 v241, s[12:15], s28 offen offset:3072 sc1 lds
v_mfma_f32_16x16x32_bf16 a[68:71], v[180:183], v[208:211], a[68:71]
v_exp_f32 v147, v147
v_mfma_f32_16x16x32_bf16 a[68:71], v[164:167], v[212:215], a[68:71]
v_add_f32 v224, v224, v145
v_add_f32 v224, v224, v146
v_mfma_f32_16x16x32_bf16 a[72:75], v[184:187], v[208:211], a[72:75]
v_add_f32 v224, v224, v147
v_mfma_f32_16x16x32_bf16 a[72:75], v[168:171], v[212:215], a[72:75]
v_exp_f32 v148, v148
v_mfma_f32_16x16x32_bf16 a[76:79], v[188:191], v[208:211], a[76:79]
ds_read_b64_tr_b16 v[208:209], v244 offset:20992
ds_read_b64_tr_b16 v[210:211], v244 offset:23040
v_mfma_f32_16x16x32_bf16 a[76:79], v[172:175], v[212:215], a[76:79]
ds_read_b64_tr_b16 v[212:213], v249 offset:4608
s_waitcnt lgkmcnt(3)
v_mfma_f32_16x16x32_bf16 a[80:83], v[176:179], v[216:219], a[80:83]
ds_read_b64_tr_b16 v[214:215], v249 offset:6656
v_mfma_f32_16x16x32_bf16 a[80:83], v[160:163], v[220:223], a[80:83]
v_exp_f32 v149, v149
v_mfma_f32_16x16x32_bf16 a[84:87], v[180:183], v[216:219], a[84:87]
v_exp_f32 v150, v150
v_mfma_f32_16x16x32_bf16 a[84:87], v[164:167], v[220:223], a[84:87]
v_add_f32 v225, v229, v148
v_mfma_f32_16x16x32_bf16 a[88:91], v[184:187], v[216:219], a[88:91]
v_exp_f32 v151, v151
v_mfma_f32_16x16x32_bf16 a[88:91], v[168:171], v[220:223], a[88:91]
v_add_f32 v225, v225, v149
v_add_f32 v225, v225, v150
v_mfma_f32_16x16x32_bf16 a[92:95], v[188:191], v[216:219], a[92:95]
ds_read_b64_tr_b16 v[216:217], v245 offset:20992
ds_read_b64_tr_b16 v[218:219], v245 offset:23040
v_mfma_f32_16x16x32_bf16 a[92:95], v[172:175], v[220:223], a[92:95]
ds_read_b64_tr_b16 v[220:221], v250 offset:4608
s_waitcnt lgkmcnt(3)
v_mfma_f32_16x16x32_bf16 a[96:99], v[176:179], v[208:211], a[96:99]
ds_read_b64_tr_b16 v[222:223], v250 offset:6656
v_add_f32 v225, v225, v151
v_mfma_f32_16x16x32_bf16 a[96:99], v[160:163], v[212:215], a[96:99]
s_waitcnt vmcnt(4)
s_barrier
v_mfma_f32_16x16x32_bf16 a[100:103], v[180:183], v[208:211], a[100:103]
v_exp_f32 v152, v152
v_mfma_f32_16x16x32_bf16 a[100:103], v[164:167], v[212:215], a[100:103]
v_exp_f32 v153, v153
v_mfma_f32_16x16x32_bf16 a[104:107], v[184:187], v[208:211], a[104:107]
v_exp_f32 v154, v154
v_mfma_f32_16x16x32_bf16 a[104:107], v[168:171], v[212:215], a[104:107]
v_add_f32 v226, v230, v152
v_mfma_f32_16x16x32_bf16 a[108:111], v[188:191], v[208:211], a[108:111]
ds_read_b128 v[208:211], v240 offset:0
v_mfma_f32_16x16x32_bf16 a[108:111], v[172:175], v[212:215], a[108:111]
ds_read_b128 v[212:215], v240 offset:512
s_waitcnt lgkmcnt(2)
v_mfma_f32_16x16x32_bf16 a[112:115], v[176:179], v[216:219], a[112:115]
v_exp_f32 v155, v155
v_mfma_f32_16x16x32_bf16 a[112:115], v[160:163], v[220:223], a[112:115]
v_cvt_pk_bf16_f32 v176, v128, v129
v_cvt_pk_bf16_f32 v177, v130, v131
v_mfma_f32_16x16x32_bf16 a[116:119], v[180:183], v[216:219], a[116:119]
v_add_f32 v226, v226, v153
v_add_f32 v226, v226, v154
v_mfma_f32_16x16x32_bf16 a[116:119], v[164:167], v[220:223], a[116:119]
v_cvt_pk_bf16_f32 v180, v132, v133
v_cvt_pk_bf16_f32 v181, v134, v135
v_mfma_f32_16x16x32_bf16 a[120:123], v[184:187], v[216:219], a[120:123]
v_add_f32 v226, v226, v155
v_mfma_f32_16x16x32_bf16 a[120:123], v[168:171], v[220:223], a[120:123]
v_cvt_pk_bf16_f32 v184, v136, v137
v_cvt_pk_bf16_f32 v185, v138, v139
v_mfma_f32_16x16x32_bf16 a[124:127], v[188:191], v[216:219], a[124:127]
ds_read_b128 v[216:219], v240 offset:4096
v_mfma_f32_16x16x32_bf16 a[124:127], v[172:175], v[220:223], a[124:127]
ds_read_b128 v[220:223], v240 offset:4608
s_waitcnt lgkmcnt(2)
v_mfma_f32_16x16x32_bf16 v[128:131], v[208:211], v[0:3], v[192:195]
v_exp_f32 v156, v156
v_mfma_f32_16x16x32_bf16 v[128:131], v[212:215], v[4:7], v[128:131]
v_cvt_pk_bf16_f32 v188, v140, v141
v_cvt_pk_bf16_f32 v189, v142, v143
v_mfma_f32_16x16x32_bf16 v[132:135], v[208:211], v[32:35], v[196:199]
v_exp_f32 v157, v157
v_mfma_f32_16x16x32_bf16 v[132:135], v[212:215], v[36:39], v[132:135]
v_exp_f32 v158, v158
v_mfma_f32_16x16x32_bf16 v[136:139], v[208:211], v[64:67], v[200:203]
v_add_f32 v227, v231, v156
v_mfma_f32_16x16x32_bf16 v[136:139], v[212:215], v[68:71], v[136:139]
v_exp_f32 v159, v159
v_mfma_f32_16x16x32_bf16 v[140:143], v[208:211], v[96:99], v[204:207]
ds_read_b128 v[208:211], v240 offset:8192
v_add_f32 v227, v227, v157
v_mfma_f32_16x16x32_bf16 v[140:143], v[212:215], v[100:103], v[140:143]
ds_read_b128 v[212:215], v240 offset:8704
s_waitcnt lgkmcnt(2)
v_mfma_f32_16x16x32_bf16 v[128:131], v[216:219], v[8:11], v[128:131]
v_add_f32 v227, v227, v158
v_add_f32 v227, v227, v159
v_mfma_f32_16x16x32_bf16 v[128:131], v[220:223], v[12:15], v[128:131]
v_max3_f32 v242, v224, v225, v226
v_mfma_f32_16x16x32_bf16 v[132:135], v[216:219], v[40:43], v[132:135]
v_max_f32 v242, v242, v227
v_mfma_f32_16x16x32_bf16 v[132:135], v[220:223], v[44:47], v[132:135]
v_cmp_lt_f32 vcc, s32, v242
v_mfma_f32_16x16x32_bf16 v[136:139], v[216:219], v[72:75], v[136:139]
v_mfma_f32_16x16x32_bf16 v[136:139], v[220:223], v[76:79], v[136:139]
v_mfma_f32_16x16x32_bf16 v[140:143], v[216:219], v[104:107], v[140:143]
ds_read_b128 v[216:219], v240 offset:12288
s_cbranch_vccnz L2_rare_site1
L2_ret1:
v_mfma_f32_16x16x32_bf16 v[140:143], v[220:223], v[108:111], v[140:143]
ds_read_b128 v[220:223], v240 offset:12800
s_waitcnt lgkmcnt(2)
v_mfma_f32_16x16x32_bf16 v[128:131], v[208:211], v[16:19], v[128:131]
v_cvt_pk_bf16_f32 v178, v144, v145
v_cvt_pk_bf16_f32 v179, v146, v147
v_mfma_f32_16x16x32_bf16 v[128:131], v[212:215], v[20:23], v[128:131]
v_cvt_pk_bf16_f32 v182, v148, v149
v_cvt_pk_bf16_f32 v183, v150, v151
v_mfma_f32_16x16x32_bf16 v[132:135], v[208:211], v[48:51], v[132:135]
v_cvt_pk_bf16_f32 v186, v152, v153
v_cvt_pk_bf16_f32 v187, v154, v155
v_mfma_f32_16x16x32_bf16 v[132:135], v[212:215], v[52:55], v[132:135]
v_cvt_pk_bf16_f32 v190, v156, v157
v_cvt_pk_bf16_f32 v191, v158, v159
v_mfma_f32_16x16x32_bf16 v[136:139], v[208:211], v[80:83], v[136:139]
v_mfma_f32_16x16x32_bf16 v[136:139], v[212:215], v[84:87], v[136:139]
s_sub_u32 s31, s31, 1
v_mfma_f32_16x16x32_bf16 v[140:143], v[208:211], v[112:115], v[140:143]
ds_read_b128 v[208:211], v240 offset:2048
v_mfma_f32_16x16x32_bf16 v[140:143], v[212:215], v[116:119], v[140:143]
ds_read_b128 v[212:215], v240 offset:2560
s_waitcnt lgkmcnt(2)
v_mfma_f32_16x16x32_bf16 v[128:131], v[216:219], v[24:27], v[128:131]
s_add_u32 s28, s28, s101
s_add_u32 s30, s30, 0x4000
v_mfma_f32_16x16x32_bf16 v[128:131], v[220:223], v[28:31], v[128:131]
s_and_b32 s30, s30, 0x1ffff
v_mfma_f32_16x16x32_bf16 v[132:135], v[216:219], v[56:59], v[132:135]
s_cmp_eq_u32 s31, 0
v_mfma_f32_16x16x32_bf16 v[132:135], v[220:223], v[60:63], v[132:135]
v_mfma_f32_16x16x32_bf16 v[136:139], v[216:219], v[88:91], v[136:139]
v_mfma_f32_16x16x32_bf16 v[136:139], v[220:223], v[92:95], v[136:139]
v_mfma_f32_16x16x32_bf16 v[140:143], v[216:219], v[120:123], v[140:143]
ds_read_b128 v[216:219], v240 offset:6144
v_mfma_f32_16x16x32_bf16 v[140:143], v[220:223], v[124:127], v[140:143]
ds_read_b128 v[220:223], v240 offset:6656
s_cbranch_scc1 L2_x1
L2_loop1:
s_waitcnt lgkmcnt(2)
v_mfma_f32_16x16x32_bf16 v[144:147], v[208:211], v[0:3], v[192:195]
v_mfma_f32_16x16x32_bf16 v[144:147], v[212:215], v[4:7], v[144:147]
v_mfma_f32_16x16x32_bf16 v[148:151], v[208:211], v[32:35], v[196:199]
v_mfma_f32_16x16x32_bf16 v[148:151], v[212:215], v[36:39], v[148:151]
v_mfma_f32_16x16x32_bf16 v[152:155], v[208:211], v[64:67], v[200:203]
v_exp_f32 v128, v128
v_mfma_f32_16x16x32_bf16 v[152:155], v[212:215], v[68:71], v[152:155]
v_exp_f32 v129, v129
v_mfma_f32_16x16x32_bf16 v[156:159], v[208:211], v[96:99], v[204:207]
ds_read_b128 v[208:211], v240 offset:10240
v_mfma_f32_16x16x32_bf16 v[156:159], v[212:215], v[100:103], v[156:159]
ds_read_b128 v[212:215], v240 offset:10752
s_waitcnt lgkmcnt(2)
v_mfma_f32_16x16x32_bf16 v[144:147], v[216:219], v[8:11], v[144:147]
v_exp_f32 v130, v130
v_mfma_f32_16x16x32_bf16 v[144:147], v[220:223], v[12:15], v[144:147]
v_add_f32 v228, v224, v128
v_mfma_f32_16x16x32_bf16 v[148:151], v[216:219], v[40:43], v[148:151]
v_exp_f32 v131, v131
v_mfma_f32_16x16x32_bf16 v[148:151], v[220:223], v[44:47], v[148:151]
v_add_f32 v228, v228, v129
v_add_f32 v228, v228, v130
v_mfma_f32_16x16x32_bf16 v[152:155], v[216:219], v[72:75], v[152:155]
v_add_f32 v228, v228, v131
v_mfma_f32_16x16x32_bf16 v[152:155], v[220:223], v[76:79], v[152:155]
v_exp_f32 v132, v132
v_mfma_f32_16x16x32_bf16 v[156:159], v[216:219], v[104:107], v[156:159]
ds_read_b128 v[216:219], v240 offset:14336
v_mfma_f32_16x16x32_bf16 v[156:159], v[220:223], v[108:111], v[156:159]
ds_read_b128 v[220:223], v240 offset:14848
s_waitcnt lgkmcnt(2)
v_mfma_f32_16x16x32_bf16 v[144:147], v[208:211], v[16:19], v[144:147]
v_exp_f32 v133, v133
v_mfma_f32_16x16x32_bf16 v[144:147], v[212:215], v[20:23], v[144:147]
v_exp_f32 v134, v134
v_mfma_f32_16x16x32_bf16 v[148:151], v[208:211], v[48:51], v[148:151]
v_add_f32 v229, v225, v132
v_mfma_f32_16x16x32_bf16 v[148:151], v[212:215], v[52:55], v[148:151]
v_exp_f32 v135, v135
v_mfma_f32_16x16x32_bf16 v[152:155], v[208:211], v[80:83], v[152:155]
v_add_f32 v229, v229, v133
v_add_f32 v229, v229, v134
v_mfma_f32_16x16x32_bf16 v[152:155], v[212:215], v[84:87], v[152:155]
v_add_f32 v229, v229, v135
v_mfma_f32_16x16x32_bf16 v[156:159], v[208:211], v[112:115], v[156:159]
ds_read_b64_tr_b16 v[208:209], v249 offset:8192
ds_read_b64_tr_b16 v[210:211], v249 offset:10240
v_mfma_f32_16x16x32_bf16 v[156:159], v[212:215], v[116:119], v[156:159]
ds_read_b64_tr_b16 v[212:213], v249 offset:24576
s_waitcnt lgkmcnt(3)
v_mfma_f32_16x16x32_bf16 v[144:147], v[216:219], v[24:27], v[144:147]
ds_read_b64_tr_b16 v[214:215], v249 offset:26624
v_mfma_f32_16x16x32_bf16 v[144:147], v[220:223], v[28:31], v[144:147]
v_exp_f32 v136, v136
v_mfma_f32_16x16x32_bf16 v[148:151], v[216:219], v[56:59], v[148:151]
v_exp_f32 v137, v137
v_mfma_f32_16x16x32_bf16 v[148:151], v[220:223], v[60:63], v[148:151]
v_exp_f32 v138, v138
v_mfma_f32_16x16x32_bf16 v[152:155], v[216:219], v[88:91], v[152:155]
v_add_f32 v230, v226, v136
v_mfma_f32_16x16x32_bf16 v[152:155], v[220:223], v[92:95], v[152:155]
v_exp_f32 v139, v139
v_mfma_f32_16x16x32_bf16 v[156:159], v[216:219], v[120:123], v[156:159]
ds_read_b64_tr_b16 v[216:217], v250 offset:8192
ds_read_b64_tr_b16 v[218:219], v250 offset:10240
v_mfma_f32_16x16x32_bf16 v[156:159], v[220:223], v[124:127], v[156:159]
ds_read_b64_tr_b16 v[220:221], v250 offset:24576
s_waitcnt lgkmcnt(3)
v_mfma_f32_16x16x32_bf16 a[128:131], v[160:163], v[208:211], a[128:131]
ds_read_b64_tr_b16 v[222:223], v250 offset:26624
v_add_f32 v230, v230, v137
v_mfma_f32_16x16x32_bf16 a[128:131], v[176:179], v[212:215], a[128:131]
v_add_f32 v230, v230, v138
v_add_f32 v230, v230, v139
v_mfma_f32_16x16x32_bf16 a[132:135], v[164:167], v[208:211], a[132:135]
v_exp_f32 v140, v140
v_mfma_f32_16x16x32_bf16 a[132:135], v[180:183], v[212:215], a[132:135]
v_exp_f32 v141, v141
v_mfma_f32_16x16x32_bf16 a[136:139], v[168:171], v[208:211], a[136:139]
v_exp_f32 v142, v142
v_mfma_f32_16x16x32_bf16 a[136:139], v[184:187], v[212:215], a[136:139]
v_add_f32 v231, v227, v140
v_mfma_f32_16x16x32_bf16 a[140:143], v[172:175], v[208:211], a[140:143]
ds_read_b64_tr_b16 v[208:209], v249 offset:8704
ds_read_b64_tr_b16 v[210:211], v249 offset:10752
v_mfma_f32_16x16x32_bf16 a[140:143], v[188:191], v[212:215], a[140:143]
ds_read_b64_tr_b16 v[212:213], v249 offset:25088
s_waitcnt lgkmcnt(3)
v_mfma_f32_16x16x32_bf16 a[144:147], v[160:163], v[216:219], a[144:147]
ds_read_b64_tr_b16 v[214:215], v249 offset:27136
v_mfma_f32_16x16x32_bf16 a[144:147], v[176:179], v[220:223], a[144:147]
v_exp_f32 v143, v143
v_mfma_f32_16x16x32_bf16 a[148:151], v[164:167], v[216:219], a[148:151]
v_add_f32 v231, v231, v141
v_add_f32 v231, v231, v142
v_mfma_f32_16x16x32_bf16 a[148:151], v[180:183], v[220:223], a[148:151]
v_add_f32 v231, v231, v143
v_max3_f32 v242, v228, v229, v230
v_mfma_f32_16x16x32_bf16 a[152:155], v[168:171], v[216:219], a[152:155]
v_max_f32 v242, v242, v231
v_mfma_f32_16x16x32_bf16 a[152:155], v[184:187], v[220:223], a[152:155]
v_cmp_lt_f32 vcc, s32, v242
v_mfma_f32_16x16x32_bf16 a[156:159], v[172:175], v[216:219], a[156:159]
ds_read_b64_tr_b16 v[216:217], v250 offset:8704
ds_read_b64_tr_b16 v[218:219], v250 offset:10752
v_mfma_f32_16x16x32_bf16 a[156:159], v[188:191], v[220:223], a[156:159]
ds_read_b64_tr_b16 v[220:221], v250 offset:25088
s_waitcnt lgkmcnt(3)
v_mfma_f32_16x16x32_bf16 a[160:163], v[160:163], v[208:211], a[160:163]
ds_read_b64_tr_b16 v[222:223], v250 offset:27136
s_cbranch_vccnz L2_rare_site2
L2_ret2:
v_mfma_f32_16x16x32_bf16 a[160:163], v[176:179], v[212:215], a[160:163]
v_exp_f32 v144, v144
v_mfma_f32_16x16x32_bf16 a[164:167], v[164:167], v[208:211], a[164:167]
v_exp_f32 v145, v145
v_mfma_f32_16x16x32_bf16 a[164:167], v[180:183], v[212:215], a[164:167]
v_exp_f32 v146, v146
v_mfma_f32_16x16x32_bf16 a[168:171], v[168:171], v[208:211], a[168:171]
s_mov_b32 m0, s30
v_add_f32 v224, v228, v144
v_mfma_f32_16x16x32_bf16 a[168:171], v[184:187], v[212:215], a[168:171]
buffer_load_dwordx4 v241, s[12:15], s28 offen offset:0 sc1 lds
v_mfma_f32_16x16x32_bf16 a[172:175], v[172:175], v[208:211], a[172:175]
ds_read_b64_tr_b16 v[208:209], v249 offset:12288
ds_read_b64_tr_b16 v[210:211], v249 offset:14336
v_mfma_f32_16x16x32_bf16 a[172:175], v[188:191], v[212:215], a[172:175]
ds_read_b64_tr_b16 v[212:213], v249 offset:28672
s_waitcnt lgkmcnt(3)
v_mfma_f32_16x16x32_bf16 a[176:179], v[160:163], v[216:219], a[176:179]
ds_read_b64_tr_b16 v[214:215], v249 offset:30720
v_mfma_f32_16x16x32_bf16 a[176:179], v[176:179], v[220:223], a[176:179]
buffer_load_dwordx4 v241, s[12:15], s28 offen offset:1024 sc1 lds
v_mfma_f32_16x16x32_bf16 a[180:183], v[164:167], v[216:219], a[180:183]
v_exp_f32 v147, v147
v_mfma_f32_16x16x32_bf16 a[180:183], v[180:183], v[220:223], a[180:183]
v_add_f32 v224, v224, v145
v_add_f32 v224, v224, v146
v_mfma_f32_16x16x32_bf16 a[184:187], v[168:171], v[216:219], a[184:187]
v_add_f32 v224, v224, v147
v_mfma_f32_16x16x32_bf16 a[184:187], v[184:187], v[220:223], a[184:187]
buffer_load_dwordx4 v241, s[12:15], s28 offen offset:2048 sc1 lds
v_mfma_f32_16x16x32_bf16 a[188:191], v[172:175], v[216:219], a[188:191]
ds_read_b64_tr_b16 v[216:217], v250 offset:12288
ds_read_b64_tr_b16 v[218:219], v250 offset:14336
v_mfma_f32_16x16x32_bf16 a[188:191], v[188:191], v[220:223], a[188:191]
ds_read_b64_tr_b16 v[220:221], v250 offset:28672
s_waitcnt lgkmcnt(3)
v_mfma_f32_16x16x32_bf16 a[192:195], v[160:163], v[208:211], a[192:195]
ds_read_b64_tr_b16 v[222:223], v250 offset:30720
v_mfma_f32_16x16x32_bf16 a[192:195], v[176:179], v[212:215], a[192:195]
buffer_load_dwordx4 v241, s[12:15], s28 offen offset:3072 sc1 lds
v_mfma_f32_16x16x32_bf16 a[196:199], v[164:167], v[208:211], a[196:199]
v_exp_f32 v148, v148
v_mfma_f32_16x16x32_bf16 a[196:199], v[180:183], v[212:215], a[196:199]
v_exp_f32 v149, v149
v_mfma_f32_16x16x32_bf16 a[200:203], v[168:171], v[208:211], a[200:203]
v_exp_f32 v150, v150
v_mfma_f32_16x16x32_bf16 a[200:203], v[184:187], v[212:215], a[200:203]
v_add_f32 v225, v229, v148
v_mfma_f32_16x16x32_bf16 a[204:207], v[172:175], v[208:211], a[204:207]
ds_read_b64_tr_b16 v[208:209], v249 offset:12800
ds_read_b64_tr_b16 v[210:211], v249 offset:14848
v_mfma_f32_16x16x32_bf16 a[204:207], v[188:191], v[212:215], a[204:207]
ds_read_b64_tr_b16 v[212:213], v249 offset:29184
s_waitcnt lgkmcnt(3)
v_mfma_f32_16x16x32_bf16 a[208:211], v[160:163], v[216:219], a[208:211]
ds_read_b64_tr_b16 v[214:215], v249 offset:31232
v_mfma_f32_16x16x32_bf16 a[208:211], v[176:179], v[220:223], a[208:211]
v_exp_f32 v151, v151
v_mfma_f32_16x16x32_bf16 a[212:215], v[164:167], v[216:219], a[212:215]
v_add_f32 v225, v225, v149
v_add_f32 v225, v225, v150
v_mfma_f32_16x16x32_bf16 a[212:215], v[180:183], v[220:223], a[212:215]
v_add_f32 v225, v225, v151
v_mfma_f32_16x16x32_bf16 a[216:219], v[168:171], v[216:219], a[216:219]
v_exp_f32 v152, v152
v_mfma_f32_16x16x32_bf16 a[216:219], v[184:187], v[220:223], a[216:219]
v_exp_f32 v153, v153
v_mfma_f32_16x16x32_bf16 a[220:223], v[172:175], v[216:219], a[220:223]
ds_read_b64_tr_b16 v[216:217], v250 offset:12800
ds_read_b64_tr_b16 v[218:219], v250 offset:14848
v_mfma_f32_16x16x32_bf16 a[220:223], v[188:191], v[220:223], a[220:223]
ds_read_b64_tr_b16 v[220:221], v250 offset:29184
s_waitcnt lgkmcnt(3)
v_mfma_f32_16x16x32_bf16 a[224:227], v[160:163], v[208:211], a[224:227]
ds_read_b64_tr_b16 v[222:223], v250 offset:31232
v_mfma_f32_16x16x32_bf16 a[224:227], v[176:179], v[212:215], a[224:227]
s_waitcnt vmcnt(4)
s_barrier
v_mfma_f32_16x16x32_bf16 a[228:231], v[164:167], v[208:211], a[228:231]
v_exp_f32 v154, v154
v_mfma_f32_16x16x32_bf16 a[228:231], v[180:183], v[212:215], a[228:231]
v_add_f32 v226, v230, v152
v_mfma_f32_16x16x32_bf16 a[232:235], v[168:171], v[208:211], a[232:235]
v_exp_f32 v155, v155
v_mfma_f32_16x16x32_bf16 a[232:235], v[184:187], v[212:215], a[232:235]
v_add_f32 v226, v226, v153
v_add_f32 v226, v226, v154
v_mfma_f32_16x16x32_bf16 a[236:239], v[172:175], v[208:211], a[236:239]
ds_read_b128 v[208:211], v240 offset:16384
v_add_f32 v226, v226, v155
v_mfma_f32_16x16x32_bf16 a[236:239], v[188:191], v[212:215], a[236:239]
ds_read_b128 v[212:215], v240 offset:16896
s_waitcnt lgkmcnt(2)
v_mfma_f32_16x16x32_bf16 a[240:243], v[160:163], v[216:219], a[240:243]
v_exp_f32 v156, v156
v_mfma_f32_16x16x32_bf16 a[240:243], v[176:179], v[220:223], a[240:243]
v_cvt_pk_bf16_f32 v160, v128, v129
v_cvt_pk_bf16_f32 v161, v130, v131
v_mfma_f32_16x16x32_bf16 a[244:247], v[164:167], v[216:219], a[244:247]
v_exp_f32 v157, v157
v_mfma_f32_16x16x32_bf16 a[244:247], v[180:183], v[220:223], a[244:247]
v_cvt_pk_bf16_f32 v164, v132, v133
v_cvt_pk_bf16_f32 v165, v134, v135
v_mfma_f32_16x16x32_bf16 a[248:251], v[168:171], v[216:219], a[248:251]
v_exp_f32 v158, v158
v_mfma_f32_16x16x32_bf16 a[248:251], v[184:187], v[220:223], a[248:251]
v_cvt_pk_bf16_f32 v168, v136, v137
v_cvt_pk_bf16_f32 v169, v138, v139
v_mfma_f32_16x16x32_bf16 a[252:255], v[172:175], v[216:219], a[252:255]
ds_read_b128 v[216:219], v240 offset:20480
v_add_f32 v227, v231, v156
v_mfma_f32_16x16x32_bf16 a[252:255], v[188:191], v[220:223], a[252:255]
ds_read_b128 v[220:223], v240 offset:20992
s_waitcnt lgkmcnt(2)
v_mfma_f32_16x16x32_bf16 v[128:131], v[208:211], v[0:3], v[192:195]
v_exp_f32 v159, v159
v_mfma_f32_16x16x32_bf16 v[128:131], v[212:215], v[4:7], v[128:131]
v_cvt_pk_bf16_f32 v172, v140, v141
v_cvt_pk_bf16_f32 v173, v142, v143
v_mfma_f32_16x16x32_bf16 v[132:135], v[208:211], v[32:35], v[196:199]
v_add_f32 v227, v227, v157
v_add_f32 v227, v227, v158
v_mfma_f32_16x16x32_bf16 v[132:135], v[212:215], v[36:39], v[132:135]
v_add_f32 v227, v227, v159
v_max3_f32 v242, v224, v225, v226
v_mfma_f32_16x16x32_bf16 v[136:139], v[208:211], v[64:67], v[200:203]
v_max_f32 v242, v242, v227
v_mfma_f32_16x16x32_bf16 v[136:139], v[212:215], v[68:71], v[136:139]
v_cmp_lt_f32 vcc, s32, v242
v_mfma_f32_16x16x32_bf16 v[140:143], v[208:211], v[96:99], v[204:207]
ds_read_b128 v[208:211], v240 offset:24576
v_mfma_f32_16x16x32_bf16 v[140:143], v[212:215], v[100:103], v[140:143]
ds_read_b128 v[212:215], v240 offset:25088
s_waitcnt lgkmcnt(2)
v_mfma_f32_16x16x32_bf16 v[128:131], v[216:219], v[8:11], v[128:131]
v_mov_b32 v244, v249
v_mov_b32 v245, v250
v_mfma_f32_16x16x32_bf16 v[128:131], v[220:223], v[12:15], v[128:131]
v_add_u32 v249, 0x8000, v249
s_cbranch_vccnz L2_rare_site3
L2_ret3:
v_mfma_f32_16x16x32_bf16 v[132:135], v[216:219], v[40:43], v[132:135]
v_and_b32 v249, 0x1ffff, v249
v_cvt_pk_bf16_f32 v162, v144, v145
v_mfma_f32_16x16x32_bf16 v[132:135], v[220:223], v[44:47], v[132:135]
v_cvt_pk_bf16_f32 v163, v146, v147
v_cvt_pk_bf16_f32 v166, v148, v149
v_mfma_f32_16x16x32_bf16 v[136:139], v[216:219], v[72:75], v[136:139]
v_xor_b32 v250, 32, v249
v_cvt_pk_bf16_f32 v167, v150, v151
v_mfma_f32_16x16x32_bf16 v[136:139], v[220:223], v[76:79], v[136:139]
v_cvt_pk_bf16_f32 v170, v152, v153
v_cvt_pk_bf16_f32 v171, v154, v155
v_mfma_f32_16x16x32_bf16 v[140:143], v[216:219], v[104:107], v[140:143]
ds_read_b128 v[216:219], v240 offset:28672
v_cvt_pk_bf16_f32 v174, v156, v157
v_mfma_f32_16x16x32_bf16 v[140:143], v[220:223], v[108:111], v[140:143]
ds_read_b128 v[220:223], v240 offset:29184
s_waitcnt lgkmcnt(2)
v_mfma_f32_16x16x32_bf16 v[128:131], v[208:211], v[16:19], v[128:131]
v_cvt_pk_bf16_f32 v175, v158, v159
v_mfma_f32_16x16x32_bf16 v[128:131], v[212:215], v[20:23], v[128:131]
v_mfma_f32_16x16x32_bf16 v[132:135], v[208:211], v[48:51], v[132:135]
v_mfma_f32_16x16x32_bf16 v[132:135], v[212:215], v[52:55], v[132:135]
v_mfma_f32_16x16x32_bf16 v[136:139], v[208:211], v[80:83], v[136:139]
v_mfma_f32_16x16x32_bf16 v[136:139], v[212:215], v[84:87], v[136:139]
s_sub_u32 s31, s31, 1
v_mfma_f32_16x16x32_bf16 v[140:143], v[208:211], v[112:115], v[140:143]
ds_read_b128 v[208:211], v240 offset:18432
v_mfma_f32_16x16x32_bf16 v[140:143], v[212:215], v[116:119], v[140:143]
ds_read_b128 v[212:215], v240 offset:18944
s_waitcnt lgkmcnt(2)
v_mfma_f32_16x16x32_bf16 v[128:131], v[216:219], v[24:27], v[128:131]
s_add_u32 s28, s28, s101
s_add_u32 s30, s30, 0x4000
v_mfma_f32_16x16x32_bf16 v[128:131], v[220:223], v[28:31], v[128:131]
s_and_b32 s30, s30, 0x1ffff
v_mfma_f32_16x16x32_bf16 v[132:135], v[216:219], v[56:59], v[132:135]
s_cmp_eq_u32 s31, 0
v_mfma_f32_16x16x32_bf16 v[132:135], v[220:223], v[60:63], v[132:135]
v_mfma_f32_16x16x32_bf16 v[136:139], v[216:219], v[88:91], v[136:139]
v_mfma_f32_16x16x32_bf16 v[136:139], v[220:223], v[92:95], v[136:139]
v_mfma_f32_16x16x32_bf16 v[140:143], v[216:219], v[120:123], v[140:143]
ds_read_b128 v[216:219], v240 offset:22528
v_mfma_f32_16x16x32_bf16 v[140:143], v[220:223], v[124:127], v[140:143]
ds_read_b128 v[220:223], v240 offset:23040
s_cbranch_scc0 L2_loop
s_cmp_eq_u32 s100, 0
s_cbranch_scc1 L2_tail_0
s_mov_b32 s3, 0
s_branch L2_ev
L2_x1:
s_cmp_eq_u32 s100, 0
s_cbranch_scc1 L2_tail_1
s_mov_b32 s3, 1
L2_ev:
s_sub_u32 s100, s100, 1
s_mov_b32 s31, 1
v_mov_b32 v251, 0x20000
s_cmp_eq_u32 s100, 0
s_cbranch_scc1 L2_ev3
s_cmp_lg_u32 s34, 0
s_cbranch_scc1 L2_evr
s_cmp_eq_u32 s100, 1
s_cbranch_scc1 L2_ev2
v_mov_b32 v252, s98
v_mov_b32 v253, s99
s_mov_b64 exec, 1
buffer_atomic_swap_x2 v[252:253], off, s[16:19], s49 sc0 sc1
s_mov_b64 exec, -1
s_branch L2_evr
L2_ev2:
s_mov_b64 exec, 1
ds_write_b64 v251, v[252:253]
s_mov_b64 exec, -1
s_branch L2_evr
L2_ev3:
ds_read_b64 v[252:253], v251
s_waitcnt lgkmcnt(0)
v_cmp_eq_u64 vcc, s[98:99], v[252:253]
s_nop 1
s_cmp_eq_u64 vcc, 0
s_cselect_b32 s31, s39, s35
L2_evr:
s_cmp_eq_u32 s3, 0
s_cbranch_scc1 L2_loop
s_branch L2_loop1
L2_tail_0:
s_waitcnt lgkmcnt(2)
v_add_u32 v253, s50, v248
v_mfma_f32_16x16x32_bf16 v[144:147], v[208:211], v[0:3], v[192:195]
s_mov_b32 m0, s30
ds_write_b128 v253, v[176:179] offset:0
v_mfma_f32_16x16x32_bf16 v[144:147], v[212:215], v[4:7], v[144:147]
buffer_load_dwordx4 v241, s[12:15], s28 offen offset:0 sc1 lds
ds_write_b128 v253, v[180:183] offset:1024
v_mfma_f32_16x16x32_bf16 v[148:151], v[208:211], v[32:35], v[196:199]
buffer_load_dwordx4 v241, s[12:15], s28 offen offset:1024 sc1 lds
ds_write_b128 v253, v[184:187] offset:2048
v_mfma_f32_16x16x32_bf16 v[148:151], v[212:215], v[36:39], v[148:151]
buffer_load_dwordx4 v241, s[12:15], s28 offen offset:2048 sc1 lds
ds_write_b128 v253, v[188:191] offset:3072
v_mfma_f32_16x16x32_bf16 v[152:155], v[208:211], v[64:67], v[200:203]
buffer_load_dwordx4 v241, s[12:15], s28 offen offset:3072 sc1 lds
v_add_u32 v251, 0x8000, v240
v_and_b32 v251, 0x1ffff, v251
v_mfma_f32_16x16x32_bf16 v[152:155], v[212:215], v[68:71], v[152:155]
v_exp_f32 v232, v128
v_mfma_f32_16x16x32_bf16 v[156:159], v[208:211], v[96:99], v[204:207]
ds_read_b128 v[208:211], v240 offset:26624
v_exp_f32 v233, v129
v_mfma_f32_16x16x32_bf16 v[156:159], v[212:215], v[100:103], v[156:159]
ds_read_b128 v[212:215], v240 offset:27136
s_waitcnt lgkmcnt(2)
s_and_b32 s30, s30, 0x1c000
v_mfma_f32_16x16x32_bf16 v[144:147], v[216:219], v[8:11], v[144:147]
v_exp_f32 v234, v130
v_add_f32 v228, v224, v232
v_mfma_f32_16x16x32_bf16 v[144:147], v[220:223], v[12:15], v[144:147]
v_cvt_pk_bf16_f32 v176, v232, v233
v_exp_f32 v235, v131
v_mfma_f32_16x16x32_bf16 v[148:151], v[216:219], v[40:43], v[148:151]
v_add_f32 v228, v228, v233
v_add_f32 v228, v228, v234
v_add_f32 v228, v228, v235
v_mfma_f32_16x16x32_bf16 v[148:151], v[220:223], v[44:47], v[148:151]
v_cvt_pk_bf16_f32 v177, v234, v235
v_exp_f32 v236, v132
v_mfma_f32_16x16x32_bf16 v[152:155], v[216:219], v[72:75], v[152:155]
v_exp_f32 v237, v133
s_add_u32 s28, s30, 0xc000
v_mfma_f32_16x16x32_bf16 v[152:155], v[220:223], v[76:79], v[152:155]
v_exp_f32 v238, v134
v_add_f32 v229, v225, v236
v_mfma_f32_16x16x32_bf16 v[156:159], v[216:219], v[104:107], v[156:159]
ds_read_b128 v[216:219], v240 offset:30720
v_cvt_pk_bf16_f32 v180, v236, v237
s_and_b32 s28, s28, 0x1ffff
v_mfma_f32_16x16x32_bf16 v[156:159], v[220:223], v[108:111], v[156:159]
ds_read_b128 v[220:223], v240 offset:31232
s_waitcnt lgkmcnt(2)
s_add_u32 s30, s30, 0x4000
v_mfma_f32_16x16x32_bf16 v[144:147], v[208:211], v[16:19], v[144:147]
v_exp_f32 v239, v135
v_add_f32 v229, v229, v237
v_mfma_f32_16x16x32_bf16 v[144:147], v[212:215], v[20:23], v[144:147]
s_waitcnt vmcnt(4)
s_barrier
v_add_f32 v229, v229, v238
v_mfma_f32_16x16x32_bf16 v[148:151], v[208:211], v[48:51], v[148:151]
v_add_f32 v229, v229, v239
v_cvt_pk_bf16_f32 v181, v238, v239
s_and_b32 s30, s30, 0x1ffff
v_mfma_f32_16x16x32_bf16 v[148:151], v[212:215], v[52:55], v[148:151]
v_exp_f32 v232, v136
s_mul_i32 s31, s34, 6144
v_mfma_f32_16x16x32_bf16 v[152:155], v[208:211], v[80:83], v[152:155]
v_exp_f32 v233, v137
s_add_u32 s31, s31, s30
v_mfma_f32_16x16x32_bf16 v[152:155], v[212:215], v[84:87], v[152:155]
v_exp_f32 v234, v138
v_add_f32 v230, v226, v232
v_mfma_f32_16x16x32_bf16 v[156:159], v[208:211], v[112:115], v[156:159]
ds_read_b128 v[208:211], v251 offset:0
v_cvt_pk_bf16_f32 v184, v232, v233
s_lshl_b32 s3, s34, 10
v_mfma_f32_16x16x32_bf16 v[156:159], v[212:215], v[116:119], v[156:159]
ds_read_b128 v[212:215], v251 offset:512
s_waitcnt lgkmcnt(2)
s_add_u32 s28, s28, s3
v_mfma_f32_16x16x32_bf16 v[144:147], v[216:219], v[24:27], v[144:147]
v_exp_f32 v235, v139
v_add_f32 v230, v230, v233
v_mfma_f32_16x16x32_bf16 v[144:147], v[220:223], v[28:31], v[144:147]
v_add_f32 v230, v230, v234
v_add_f32 v230, v230, v235
v_cvt_pk_bf16_f32 v185, v234, v235
v_mfma_f32_16x16x32_bf16 v[148:151], v[216:219], v[56:59], v[148:151]
v_exp_f32 v236, v140
s_add_u32 s3, s3, 24576
v_mfma_f32_16x16x32_bf16 v[148:151], v[220:223], v[60:63], v[148:151]
v_exp_f32 v237, v141
s_add_u32 s30, s30, s3
v_mfma_f32_16x16x32_bf16 v[152:155], v[216:219], v[88:91], v[152:155]
v_exp_f32 v238, v142
v_add_f32 v231, v227, v236
v_mfma_f32_16x16x32_bf16 v[152:155], v[220:223], v[92:95], v[152:155]
v_cvt_pk_bf16_f32 v188, v236, v237
v_exp_f32 v239, v143
v_mfma_f32_16x16x32_bf16 v[156:159], v[216:219], v[120:123], v[156:159]
ds_read_b128 v[216:219], v251 offset:4096
v_add_f32 v231, v231, v237
v_add_f32 v231, v231, v238
v_mfma_f32_16x16x32_bf16 v[156:159], v[220:223], v[124:127], v[156:159]
ds_read_b128 v[220:223], v251 offset:4608
s_waitcnt lgkmcnt(2)
v_add_f32 v231, v231, v239
v_cvt_pk_bf16_f32 v189, v238, v239
v_max3_f32 v242, v228, v229, v230
v_max_f32 v242, v242, v231
v_cmp_lt_f32 vcc, s32, v242
s_cbranch_vccnz L2_rare_site6
L2_ret6:
v_mfma_f32_16x16x32_bf16 v[128:131], v[208:211], v[0:3], v[192:195]
v_lshrrev_b32 v241, 4, v248
v_and_b32 v241, 0x30, v241
v_xor_b32 v241, v241, v248
v_and_b32 v243, 0x380, v248
v_mad_u32_u24 v241, v243, 3, v241
v_mfma_f32_16x16x32_bf16 v[128:131], v[212:215], v[4:7], v[128:131]
v_exp_f32 v232, v144
v_mfma_f32_16x16x32_bf16 v[132:135], v[208:211], v[32:35], v[196:199]
v_exp_f32 v233, v145
v_mfma_f32_16x16x32_bf16 v[132:135], v[212:215], v[36:39], v[132:135]
v_exp_f32 v234, v146
v_add_f32 v224, v228, v232
v_mfma_f32_16x16x32_bf16 v[136:139], v[208:211], v[64:67], v[200:203]
v_cvt_pk_bf16_f32 v178, v232, v233
v_exp_f32 v235, v147
v_mfma_f32_16x16x32_bf16 v[136:139], v[212:215], v[68:71], v[136:139]
v_add_f32 v224, v224, v233
v_add_f32 v224, v224, v234
v_add_f32 v224, v224, v235
v_mfma_f32_16x16x32_bf16 v[140:143], v[208:211], v[96:99], v[204:207]
ds_read_b128 v[208:211], v251 offset:8192
v_cvt_pk_bf16_f32 v179, v234, v235
v_mfma_f32_16x16x32_bf16 v[140:143], v[212:215], v[100:103], v[140:143]
ds_read_b128 v[212:215], v251 offset:8704
s_waitcnt lgkmcnt(2)
v_mfma_f32_16x16x32_bf16 v[128:131], v[216:219], v[8:11], v[128:131]
ds_write_b128 v253, v[160:163] offset:4096
v_exp_f32 v236, v148
v_mfma_f32_16x16x32_bf16 v[128:131], v[220:223], v[12:15], v[128:131]
ds_write_b128 v253, v[164:167] offset:5120
v_exp_f32 v237, v149
v_mfma_f32_16x16x32_bf16 v[132:135], v[216:219], v[40:43], v[132:135]
ds_write_b128 v253, v[168:171] offset:6144
v_exp_f32 v238, v150
v_mfma_f32_16x16x32_bf16 v[132:135], v[220:223], v[44:47], v[132:135]
ds_write_b128 v253, v[172:175] offset:7168
v_add_f32 v225, v229, v236
v_cvt_pk_bf16_f32 v182, v236, v237
v_mfma_f32_16x16x32_bf16 v[136:139], v[216:219], v[72:75], v[136:139]
v_exp_f32 v239, v151
v_add_f32 v225, v225, v237
v_mfma_f32_16x16x32_bf16 v[136:139], v[220:223], v[76:79], v[136:139]
v_add_f32 v225, v225, v238
v_add_f32 v225, v225, v239
v_cvt_pk_bf16_f32 v183, v238, v239
v_mfma_f32_16x16x32_bf16 v[140:143], v[216:219], v[104:107], v[140:143]
ds_read_b128 v[216:219], v251 offset:12288
v_exp_f32 v232, v152
v_mfma_f32_16x16x32_bf16 v[140:143], v[220:223], v[108:111], v[140:143]
ds_read_b128 v[220:223], v251 offset:12800
s_waitcnt lgkmcnt(2)
v_mfma_f32_16x16x32_bf16 v[128:131], v[208:211], v[16:19], v[128:131]
v_exp_f32 v233, v153
v_mfma_f32_16x16x32_bf16 v[128:131], v[212:215], v[20:23], v[128:131]
v_exp_f32 v234, v154
v_add_f32 v226, v230, v232
v_mfma_f32_16x16x32_bf16 v[132:135], v[208:211], v[48:51], v[132:135]
v_cvt_pk_bf16_f32 v186, v232, v233
v_exp_f32 v235, v155
v_mfma_f32_16x16x32_bf16 v[132:135], v[212:215], v[52:55], v[132:135]
v_add_f32 v226, v226, v233
v_add_f32 v226, v226, v234
v_add_f32 v226, v226, v235
v_mfma_f32_16x16x32_bf16 v[136:139], v[208:211], v[80:83], v[136:139]
v_cvt_pk_bf16_f32 v187, v234, v235
v_exp_f32 v236, v156
v_mfma_f32_16x16x32_bf16 v[136:139], v[212:215], v[84:87], v[136:139]
v_exp_f32 v237, v157
v_mfma_f32_16x16x32_bf16 v[140:143], v[208:211], v[112:115], v[140:143]
ds_read_b128 v[208:211], v251 offset:2048
v_exp_f32 v238, v158
v_mfma_f32_16x16x32_bf16 v[140:143], v[212:215], v[116:119], v[140:143]
ds_read_b128 v[212:215], v251 offset:2560
s_waitcnt lgkmcnt(2)
v_add_f32 v227, v231, v236
v_mfma_f32_16x16x32_bf16 v[128:131], v[216:219], v[24:27], v[128:131]
v_cvt_pk_bf16_f32 v190, v236, v237
v_exp_f32 v239, v159
v_mfma_f32_16x16x32_bf16 v[128:131], v[220:223], v[28:31], v[128:131]
v_add_f32 v227, v227, v237
v_add_f32 v227, v227, v238
v_add_f32 v227, v227, v239
v_mfma_f32_16x16x32_bf16 v[132:135], v[216:219], v[56:59], v[132:135]
v_cvt_pk_bf16_f32 v191, v238, v239
v_max3_f32 v242, v224, v225, v226
v_max_f32 v242, v242, v227
v_mfma_f32_16x16x32_bf16 v[132:135], v[220:223], v[60:63], v[132:135]
v_cmp_lt_f32 vcc, s32, v242
s_cbranch_vccnz L2_rare_site7
L2_ret7:
v_mfma_f32_16x16x32_bf16 v[136:139], v[216:219], v[88:91], v[136:139]
s_add_u32 m0, s31, 0
v_mfma_f32_16x16x32_bf16 v[136:139], v[220:223], v[92:95], v[136:139]
buffer_load_dwordx4 v241, s[8:11], s6 offen lds
s_add_u32 m0, s31, 2048
v_mfma_f32_16x16x32_bf16 v[140:143], v[216:219], v[120:123], v[140:143]
ds_read_b128 v[216:219], v251 offset:6144
buffer_load_dwordx4 v241, s[8:11], s7 offen lds
s_add_u32 m0, s31, 4096
v_mfma_f32_16x16x32_bf16 v[140:143], v[220:223], v[124:127], v[140:143]
ds_read_b128 v[220:223], v251 offset:6656
s_waitcnt lgkmcnt(2)
v_mfma_f32_16x16x32_bf16 v[144:147], v[208:211], v[0:3], v[192:195]
buffer_load_dwordx4 v241, s[8:11], s29 offen lds
s_add_u32 m0, s31, 1024
v_xor_b32 v241, 0x1040, v241
v_mfma_f32_16x16x32_bf16 v[144:147], v[212:215], v[4:7], v[144:147]
v_exp_f32 v232, v128
v_mfma_f32_16x16x32_bf16 v[148:151], v[208:211], v[32:35], v[196:199]
v_exp_f32 v233, v129
v_mfma_f32_16x16x32_bf16 v[148:151], v[212:215], v[36:39], v[148:151]
v_exp_f32 v234, v130
v_add_f32 v228, v224, v232
v_mfma_f32_16x16x32_bf16 v[152:155], v[208:211], v[64:67], v[200:203]
v_cvt_pk_bf16_f32 v160, v232, v233
v_exp_f32 v235, v131
v_mfma_f32_16x16x32_bf16 v[152:155], v[212:215], v[68:71], v[152:155]
v_add_f32 v228, v228, v233
v_add_f32 v228, v228, v234
v_add_f32 v228, v228, v235
v_mfma_f32_16x16x32_bf16 v[156:159], v[208:211], v[96:99], v[204:207]
ds_read_b128 v[208:211], v251 offset:10240
v_cvt_pk_bf16_f32 v161, v234, v235
v_mfma_f32_16x16x32_bf16 v[156:159], v[212:215], v[100:103], v[156:159]
ds_read_b128 v[212:215], v251 offset:10752
s_waitcnt lgkmcnt(2)
v_mfma_f32_16x16x32_bf16 v[144:147], v[216:219], v[8:11], v[144:147]
v_exp_f32 v236, v132
v_mfma_f32_16x16x32_bf16 v[144:147], v[220:223], v[12:15], v[144:147]
v_exp_f32 v237, v133
v_mfma_f32_16x16x32_bf16 v[148:151], v[216:219], v[40:43], v[148:151]
v_exp_f32 v238, v134
v_add_f32 v229, v225, v236
v_mfma_f32_16x16x32_bf16 v[148:151], v[220:223], v[44:47], v[148:151]
v_cvt_pk_bf16_f32 v164, v236, v237
v_exp_f32 v239, v135
v_mfma_f32_16x16x32_bf16 v[152:155], v[216:219], v[72:75], v[152:155]
v_add_f32 v229, v229, v237
v_add_f32 v229, v229, v238
v_add_f32 v229, v229, v239
v_mfma_f32_16x16x32_bf16 v[152:155], v[220:223], v[76:79], v[152:155]
v_cvt_pk_bf16_f32 v165, v238, v239
v_exp_f32 v232, v136
v_mfma_f32_16x16x32_bf16 v[156:159], v[216:219], v[104:107], v[156:159]
ds_read_b128 v[216:219], v251 offset:14336
v_exp_f32 v233, v137
v_mfma_f32_16x16x32_bf16 v[156:159], v[220:223], v[108:111], v[156:159]
ds_read_b128 v[220:223], v251 offset:14848
s_waitcnt lgkmcnt(2)
v_mfma_f32_16x16x32_bf16 v[144:147], v[208:211], v[16:19], v[144:147]
v_exp_f32 v234, v138
v_add_f32 v230, v226, v232
v_mfma_f32_16x16x32_bf16 v[144:147], v[212:215], v[20:23], v[144:147]
s_waitcnt vmcnt(3)
s_barrier
v_cvt_pk_bf16_f32 v168, v232, v233
v_mfma_f32_16x16x32_bf16 v[148:151], v[208:211], v[48:51], v[148:151]
v_exp_f32 v235, v139
v_add_f32 v230, v230, v233
v_mfma_f32_16x16x32_bf16 v[148:151], v[212:215], v[52:55], v[148:151]
v_add_f32 v230, v230, v234
v_add_f32 v230, v230, v235
v_cvt_pk_bf16_f32 v169, v234, v235
v_mfma_f32_16x16x32_bf16 v[152:155], v[208:211], v[80:83], v[152:155]
v_exp_f32 v236, v140
v_mfma_f32_16x16x32_bf16 v[152:155], v[212:215], v[84:87], v[152:155]
v_exp_f32 v237, v141
v_mfma_f32_16x16x32_bf16 v[156:159], v[208:211], v[112:115], v[156:159]
ds_read_b128 v[208:211], v251 offset:16384
v_exp_f32 v238, v142
v_mfma_f32_16x16x32_bf16 v[156:159], v[212:215], v[116:119], v[156:159]
ds_read_b128 v[212:215], v251 offset:16896
s_waitcnt lgkmcnt(2)
v_add_f32 v231, v227, v236
v_mfma_f32_16x16x32_bf16 v[144:147], v[216:219], v[24:27], v[144:147]
v_cvt_pk_bf16_f32 v172, v236, v237
v_exp_f32 v239, v143
v_mfma_f32_16x16x32_bf16 v[144:147], v[220:223], v[28:31], v[144:147]
v_add_f32 v231, v231, v237
v_add_f32 v231, v231, v238
v_add_f32 v231, v231, v239
v_mfma_f32_16x16x32_bf16 v[148:151], v[216:219], v[56:59], v[148:151]
v_cvt_pk_bf16_f32 v173, v238, v239
v_max3_f32 v242, v228, v229, v230
v_max_f32 v242, v242, v231
v_mfma_f32_16x16x32_bf16 v[148:151], v[220:223], v[60:63], v[148:151]
v_cmp_lt_f32 vcc, s32, v242
s_cbranch_vccnz L2_rare_site8
L2_ret8:
v_mfma_f32_16x16x32_bf16 v[152:155], v[216:219], v[88:91], v[152:155]
buffer_load_dwordx4 v241, s[8:11], s6 offen lds
s_add_u32 m0, s31, 3072
v_mfma_f32_16x16x32_bf16 v[152:155], v[220:223], v[92:95], v[152:155]
buffer_load_dwordx4 v241, s[8:11], s7 offen lds
s_add_u32 m0, s31, 5120
v_mfma_f32_16x16x32_bf16 v[156:159], v[216:219], v[120:123], v[156:159]
ds_read_b128 v[216:219], v251 offset:20480
buffer_load_dwordx4 v241, s[8:11], s29 offen lds
v_mfma_f32_16x16x32_bf16 v[156:159], v[220:223], v[124:127], v[156:159]
ds_read_b128 v[220:223], v251 offset:20992
s_waitcnt lgkmcnt(2)
v_mfma_f32_16x16x32_bf16 v[128:131], v[208:211], v[0:3], v[192:195]
v_mfma_f32_16x16x32_bf16 v[128:131], v[212:215], v[4:7], v[128:131]
v_exp_f32 v232, v144
v_mfma_f32_16x16x32_bf16 v[132:135], v[208:211], v[32:35], v[196:199]
v_exp_f32 v233, v145
v_mfma_f32_16x16x32_bf16 v[132:135], v[212:215], v[36:39], v[132:135]
v_exp_f32 v234, v146
v_add_f32 v224, v228, v232
v_mfma_f32_16x16x32_bf16 v[136:139], v[208:211], v[64:67], v[200:203]
v_cvt_pk_bf16_f32 v162, v232, v233
v_exp_f32 v235, v147
v_mfma_f32_16x16x32_bf16 v[136:139], v[212:215], v[68:71], v[136:139]
v_add_f32 v224, v224, v233
v_add_f32 v224, v224, v234
v_add_f32 v224, v224, v235
v_mfma_f32_16x16x32_bf16 v[140:143], v[208:211], v[96:99], v[204:207]
ds_read_b128 v[208:211], v251 offset:24576
v_cvt_pk_bf16_f32 v163, v234, v235
v_lshlrev_b32 v241, 3, v248
v_mfma_f32_16x16x32_bf16 v[140:143], v[212:215], v[100:103], v[140:143]
ds_read_b128 v[212:215], v251 offset:25088
s_waitcnt lgkmcnt(2)
s_mov_b32 s3, 0x7c28000
v_mfma_f32_16x16x32_bf16 v[128:131], v[216:219], v[8:11], v[128:131]
v_exp_f32 v236, v148
buffer_load_dwordx2 v[240:241], v241, s[16:19], s3 offen sc1
v_mfma_f32_16x16x32_bf16 v[128:131], v[220:223], v[12:15], v[128:131]
v_exp_f32 v237, v149
v_mfma_f32_16x16x32_bf16 v[132:135], v[216:219], v[40:43], v[132:135]
v_exp_f32 v238, v150
v_add_f32 v225, v229, v236
v_mfma_f32_16x16x32_bf16 v[132:135], v[220:223], v[44:47], v[132:135]
v_cvt_pk_bf16_f32 v166, v236, v237
v_exp_f32 v239, v151
v_mfma_f32_16x16x32_bf16 v[136:139], v[216:219], v[72:75], v[136:139]
v_add_f32 v225, v225, v237
v_add_f32 v225, v225, v238
v_add_f32 v225, v225, v239
v_mfma_f32_16x16x32_bf16 v[136:139], v[220:223], v[76:79], v[136:139]
v_cvt_pk_bf16_f32 v167, v238, v239
v_exp_f32 v232, v152
v_mfma_f32_16x16x32_bf16 v[140:143], v[216:219], v[104:107], v[140:143]
ds_read_b128 v[216:219], v251 offset:28672
v_exp_f32 v233, v153
v_mfma_f32_16x16x32_bf16 v[140:143], v[220:223], v[108:111], v[140:143]
ds_read_b128 v[220:223], v251 offset:29184
s_waitcnt lgkmcnt(2)
v_mfma_f32_16x16x32_bf16 v[128:131], v[208:211], v[16:19], v[128:131]
v_exp_f32 v234, v154
v_add_f32 v226, v230, v232
v_mfma_f32_16x16x32_bf16 v[128:131], v[212:215], v[20:23], v[128:131]
v_cvt_pk_bf16_f32 v170, v232, v233
v_exp_f32 v235, v155
v_mfma_f32_16x16x32_bf16 v[132:135], v[208:211], v[48:51], v[132:135]
v_add_f32 v226, v226, v233
v_add_f32 v226, v226, v234
v_add_f32 v226, v226, v235
v_mfma_f32_16x16x32_bf16 v[132:135], v[212:215], v[52:55], v[132:135]
v_cvt_pk_bf16_f32 v171, v234, v235
v_exp_f32 v236, v156
v_mfma_f32_16x16x32_bf16 v[136:139], v[208:211], v[80:83], v[136:139]
v_exp_f32 v237, v157
v_mfma_f32_16x16x32_bf16 v[136:139], v[212:215], v[84:87], v[136:139]
v_exp_f32 v238, v158
v_add_f32 v227, v231, v236
v_mfma_f32_16x16x32_bf16 v[140:143], v[208:211], v[112:115], v[140:143]
ds_read_b128 v[208:211], v251 offset:18432
v_cvt_pk_bf16_f32 v174, v236, v237
v_mfma_f32_16x16x32_bf16 v[140:143], v[212:215], v[116:119], v[140:143]
ds_read_b128 v[212:215], v251 offset:18944
s_waitcnt lgkmcnt(2)
v_mfma_f32_16x16x32_bf16 v[128:131], v[216:219], v[24:27], v[128:131]
v_exp_f32 v239, v159
v_add_f32 v227, v227, v237
v_mfma_f32_16x16x32_bf16 v[128:131], v[220:223], v[28:31], v[128:131]
v_add_f32 v227, v227, v238
v_add_f32 v227, v227, v239
v_cvt_pk_bf16_f32 v175, v238, v239
v_mfma_f32_16x16x32_bf16 v[132:135], v[216:219], v[56:59], v[132:135]
v_max3_f32 v242, v224, v225, v226
v_max_f32 v242, v242, v227
v_cmp_lt_f32 vcc, s32, v242
s_cbranch_vccnz L2_rare_site9
L2_ret9:
v_mfma_f32_16x16x32_bf16 v[132:135], v[220:223], v[60:63], v[132:135]
v_mfma_f32_16x16x32_bf16 v[136:139], v[216:219], v[88:91], v[136:139]
v_mfma_f32_16x16x32_bf16 v[136:139], v[220:223], v[92:95], v[136:139]
v_mfma_f32_16x16x32_bf16 v[140:143], v[216:219], v[120:123], v[140:143]
ds_read_b128 v[216:219], v251 offset:22528
v_mfma_f32_16x16x32_bf16 v[140:143], v[220:223], v[124:127], v[140:143]
ds_read_b128 v[220:223], v251 offset:23040
s_waitcnt lgkmcnt(2)
v_mfma_f32_16x16x32_bf16 v[144:147], v[208:211], v[0:3], v[192:195]
v_mfma_f32_16x16x32_bf16 v[144:147], v[212:215], v[4:7], v[144:147]
v_mfma_f32_16x16x32_bf16 v[148:151], v[208:211], v[32:35], v[196:199]
v_mfma_f32_16x16x32_bf16 v[148:151], v[212:215], v[36:39], v[148:151]
v_mfma_f32_16x16x32_bf16 v[152:155], v[208:211], v[64:67], v[200:203]
v_exp_f32 v232, v128
v_mfma_f32_16x16x32_bf16 v[152:155], v[212:215], v[68:71], v[152:155]
v_exp_f32 v233, v129
v_mfma_f32_16x16x32_bf16 v[156:159], v[208:211], v[96:99], v[204:207]
ds_read_b128 v[208:211], v251 offset:26624
v_exp_f32 v234, v130
v_mfma_f32_16x16x32_bf16 v[156:159], v[212:215], v[100:103], v[156:159]
ds_read_b128 v[212:215], v251 offset:27136
s_waitcnt lgkmcnt(2)
v_add_f32 v228, v224, v232
v_mfma_f32_16x16x32_bf16 v[144:147], v[216:219], v[8:11], v[144:147]
v_cvt_pk_bf16_f32 v0, v232, v233
v_exp_f32 v235, v131
v_mfma_f32_16x16x32_bf16 v[144:147], v[220:223], v[12:15], v[144:147]
ds_read_b128 v[4:7], v253 offset:0
v_add_f32 v228, v228, v233
v_add_f32 v228, v228, v234
v_mfma_f32_16x16x32_bf16 v[148:151], v[216:219], v[40:43], v[148:151]
ds_read_b128 v[36:39], v253 offset:1024
v_add_f32 v228, v228, v235
v_cvt_pk_bf16_f32 v1, v234, v235
v_mfma_f32_16x16x32_bf16 v[148:151], v[220:223], v[44:47], v[148:151]
v_exp_f32 v236, v132
v_mfma_f32_16x16x32_bf16 v[152:155], v[216:219], v[72:75], v[152:155]
v_exp_f32 v237, v133
v_mfma_f32_16x16x32_bf16 v[152:155], v[220:223], v[76:79], v[152:155]
ds_read_b128 v[68:71], v253 offset:2048
ds_read_b128 v[8:11], v253 offset:4096
v_mfma_f32_16x16x32_bf16 v[156:159], v[216:219], v[104:107], v[156:159]
ds_read_b128 v[216:219], v251 offset:30720
v_add_u32 v12, 0x8000, v244
v_and_b32 v12, 0x1ffff, v12
ds_read_b128 v[100:103], v253 offset:3072
ds_read_b128 v[40:43], v253 offset:5120
v_mfma_f32_16x16x32_bf16 v[156:159], v[220:223], v[108:111], v[156:159]
ds_read_b128 v[220:223], v251 offset:31232
s_waitcnt lgkmcnt(2)
v_add_u32 v14, 0x10000, v244
v_and_b32 v14, 0x1ffff, v14
v_mfma_f32_16x16x32_bf16 v[144:147], v[208:211], v[16:19], v[144:147]
v_xor_b32 v13, 32, v12
v_xor_b32 v15, 32, v14
v_mfma_f32_16x16x32_bf16 v[144:147], v[212:215], v[20:23], v[144:147]
ds_read_b128 v[72:75], v253 offset:6144
v_exp_f32 v238, v134
v_mfma_f32_16x16x32_bf16 v[148:151], v[208:211], v[48:51], v[148:151]
ds_read_b128 v[104:107], v253 offset:7168
v_add_f32 v229, v225, v236
v_cvt_pk_bf16_f32 v32, v236, v237
v_mfma_f32_16x16x32_bf16 v[148:151], v[212:215], v[52:55], v[148:151]
v_exp_f32 v239, v135
v_add_f32 v229, v229, v237
v_mfma_f32_16x16x32_bf16 v[152:155], v[208:211], v[80:83], v[152:155]
v_add_f32 v229, v229, v238
v_add_f32 v229, v229, v239
v_cvt_pk_bf16_f32 v33, v238, v239
v_mfma_f32_16x16x32_bf16 v[152:155], v[212:215], v[84:87], v[152:155]
v_exp_f32 v232, v136
v_mfma_f32_16x16x32_bf16 v[156:159], v[208:211], v[112:115], v[156:159]
ds_read_b64_tr_b16 v[208:209], v244 offset:16384
ds_read_b64_tr_b16 v[210:211], v244 offset:18432
v_mfma_f32_16x16x32_bf16 v[156:159], v[212:215], v[116:119], v[156:159]
ds_read_b64_tr_b16 v[212:213], v12 offset:0
s_waitcnt lgkmcnt(3)
v_mfma_f32_16x16x32_bf16 v[144:147], v[216:219], v[24:27], v[144:147]
ds_read_b64_tr_b16 v[214:215], v12 offset:2048
v_exp_f32 v233, v137
v_mfma_f32_16x16x32_bf16 v[144:147], v[220:223], v[28:31], v[144:147]
v_exp_f32 v234, v138
v_add_f32 v230, v226, v232
v_mfma_f32_16x16x32_bf16 v[148:151], v[216:219], v[56:59], v[148:151]
v_cvt_pk_bf16_f32 v64, v232, v233
v_exp_f32 v235, v139
v_mfma_f32_16x16x32_bf16 v[148:151], v[220:223], v[60:63], v[148:151]
v_add_f32 v230, v230, v233
v_add_f32 v230, v230, v234
v_add_f32 v230, v230, v235
v_mfma_f32_16x16x32_bf16 v[152:155], v[216:219], v[88:91], v[152:155]
v_cvt_pk_bf16_f32 v65, v234, v235
v_exp_f32 v236, v140
v_mfma_f32_16x16x32_bf16 v[152:155], v[220:223], v[92:95], v[152:155]
v_exp_f32 v237, v141
s_waitcnt vmcnt(0)
v_mfma_f32_16x16x32_bf16 v[156:159], v[216:219], v[120:123], v[156:159]
ds_read_b64_tr_b16 v[216:217], v12 offset:16384
ds_read_b64_tr_b16 v[218:219], v12 offset:18432
v_cmp_ne_u64_e64 s[38:39], s[98:99], v[240:241]
v_mfma_f32_16x16x32_bf16 v[156:159], v[220:223], v[124:127], v[156:159]
ds_read_b64_tr_b16 v[220:221], v14 offset:0
s_waitcnt lgkmcnt(3)
v_exp_f32 v238, v142
v_add_f32 v231, v227, v236
v_cvt_pk_bf16_f32 v96, v236, v237
v_exp_f32 v239, v143
v_add_f32 v231, v231, v237
v_add_f32 v231, v231, v238
v_add_f32 v231, v231, v239
v_cvt_pk_bf16_f32 v97, v238, v239
v_max3_f32 v242, v228, v229, v230
v_max_f32 v242, v242, v231
v_cmp_lt_f32 vcc, s32, v242
s_cbranch_vccnz L2_rare_site10
L2_ret10:
v_mfma_f32_16x16x32_bf16 a[0:3], v[4:7], v[208:211], a[0:3]
ds_read_b64_tr_b16 v[222:223], v14 offset:2048
s_and_b64 s[38:39], s[38:39], s[96:97]
s_cbranch_scc1 LF_hl_1
LF_hlret_1:
v_mfma_f32_16x16x32_bf16 a[0:3], v[8:11], v[212:215], a[0:3]
v_exp_f32 v232, v144
v_lshrrev_b32 v241, 4, v248
v_mfma_f32_16x16x32_bf16 a[4:7], v[36:39], v[208:211], a[4:7]
v_exp_f32 v233, v145
v_and_b32 v241, 0x30, v241
v_mfma_f32_16x16x32_bf16 a[4:7], v[40:43], v[212:215], a[4:7]
v_exp_f32 v234, v146
v_xor_b32 v241, v241, v248
v_mfma_f32_16x16x32_bf16 a[8:11], v[68:71], v[208:211], a[8:11]
v_add_f32 v224, v228, v232
v_cvt_pk_bf16_f32 v2, v232, v233
v_mfma_f32_16x16x32_bf16 a[8:11], v[72:75], v[212:215], a[8:11]
v_exp_f32 v235, v147
v_mfma_f32_16x16x32_bf16 a[12:15], v[100:103], v[208:211], a[12:15]
ds_read_b64_tr_b16 v[208:209], v245 offset:16384
ds_read_b64_tr_b16 v[210:211], v245 offset:18432
v_mfma_f32_16x16x32_bf16 a[12:15], v[104:107], v[212:215], a[12:15]
ds_read_b64_tr_b16 v[212:213], v13 offset:0
s_waitcnt lgkmcnt(3)
v_mfma_f32_16x16x32_bf16 a[0:3], v[176:179], v[216:219], a[0:3]
ds_read_b64_tr_b16 v[214:215], v13 offset:2048
v_add_f32 v224, v224, v233
v_mfma_f32_16x16x32_bf16 a[0:3], v[160:163], v[220:223], a[0:3]
v_add_f32 v224, v224, v234
v_add_f32 v224, v224, v235
v_mfma_f32_16x16x32_bf16 a[4:7], v[180:183], v[216:219], a[4:7]
v_cvt_pk_bf16_f32 v3, v234, v235
v_and_b32 v243, 0x380, v248
v_mad_u32_u24 v241, v243, 3, v241
v_mfma_f32_16x16x32_bf16 a[4:7], v[164:167], v[220:223], a[4:7]
v_exp_f32 v236, v148
v_add_u32 v241, 0x7000000, v241
v_mfma_f32_16x16x32_bf16 a[8:11], v[184:187], v[216:219], a[8:11]
v_exp_f32 v237, v149
v_and_b32 v110, 0x70, v248
v_mfma_f32_16x16x32_bf16 a[8:11], v[168:171], v[220:223], a[8:11]
v_exp_f32 v238, v150
v_lshlrev_b32 v110, 3, v110
v_mfma_f32_16x16x32_bf16 a[12:15], v[188:191], v[216:219], a[12:15]
ds_read_b64_tr_b16 v[216:217], v13 offset:16384
ds_read_b64_tr_b16 v[218:219], v13 offset:18432
v_add_u32 v110, 0x7c32000, v110
v_mfma_f32_16x16x32_bf16 a[12:15], v[172:175], v[220:223], a[12:15]
ds_read_b64_tr_b16 v[220:221], v15 offset:0
s_waitcnt lgkmcnt(3)
buffer_load_dwordx2 v[108:109], v110, s[16:19], 0 offen sc1
v_mfma_f32_16x16x32_bf16 a[16:19], v[4:7], v[208:211], a[16:19]
ds_read_b64_tr_b16 v[222:223], v15 offset:2048
v_add_f32 v225, v229, v236
v_mfma_f32_16x16x32_bf16 a[16:19], v[8:11], v[212:215], a[16:19]
v_cvt_pk_bf16_f32 v34, v236, v237
s_add_u32 m0, s28, 0
v_mfma_f32_16x16x32_bf16 a[20:23], v[36:39], v[208:211], a[20:23]
v_exp_f32 v239, v151
v_mfma_f32_16x16x32_bf16 a[20:23], v[40:43], v[212:215], a[20:23]
v_add_f32 v225, v225, v237
v_add_f32 v225, v225, v238
v_mfma_f32_16x16x32_bf16 a[24:27], v[68:71], v[208:211], a[24:27]
v_add_f32 v225, v225, v239
v_cvt_pk_bf16_f32 v35, v238, v239
v_mfma_f32_16x16x32_bf16 a[24:27], v[72:75], v[212:215], a[24:27]
v_exp_f32 v232, v152
v_mfma_f32_16x16x32_bf16 a[28:31], v[100:103], v[208:211], a[28:31]
ds_read_b64_tr_b16 v[208:209], v244 offset:16896
ds_read_b64_tr_b16 v[210:211], v244 offset:18944
v_mfma_f32_16x16x32_bf16 a[28:31], v[104:107], v[212:215], a[28:31]
ds_read_b64_tr_b16 v[212:213], v12 offset:512
s_waitcnt lgkmcnt(3)
v_mfma_f32_16x16x32_bf16 a[16:19], v[176:179], v[216:219], a[16:19]
ds_read_b64_tr_b16 v[214:215], v12 offset:2560
buffer_load_dwordx4 v241, s[16:19], s6 offen sc1 lds
s_add_u32 m0, s28, 8192
v_mfma_f32_16x16x32_bf16 a[16:19], v[160:163], v[220:223], a[16:19]
v_exp_f32 v233, v153
v_mfma_f32_16x16x32_bf16 a[20:23], v[180:183], v[216:219], a[20:23]
v_exp_f32 v234, v154
v_mfma_f32_16x16x32_bf16 a[20:23], v[164:167], v[220:223], a[20:23]
v_add_f32 v226, v230, v232
v_cvt_pk_bf16_f32 v66, v232, v233
v_mfma_f32_16x16x32_bf16 a[24:27], v[184:187], v[216:219], a[24:27]
v_exp_f32 v235, v155
v_mfma_f32_16x16x32_bf16 a[24:27], v[168:171], v[220:223], a[24:27]
v_add_f32 v226, v226, v233
v_add_f32 v226, v226, v234
v_mfma_f32_16x16x32_bf16 a[28:31], v[188:191], v[216:219], a[28:31]
ds_read_b64_tr_b16 v[216:217], v12 offset:16896
ds_read_b64_tr_b16 v[218:219], v12 offset:18944
v_mfma_f32_16x16x32_bf16 a[28:31], v[172:175], v[220:223], a[28:31]
ds_read_b64_tr_b16 v[220:221], v14 offset:512
s_waitcnt lgkmcnt(3)
v_mfma_f32_16x16x32_bf16 a[32:35], v[4:7], v[208:211], a[32:35]
ds_read_b64_tr_b16 v[222:223], v14 offset:2560
v_add_f32 v226, v226, v235
v_mfma_f32_16x16x32_bf16 a[32:35], v[8:11], v[212:215], a[32:35]
v_cvt_pk_bf16_f32 v67, v234, v235
buffer_load_dwordx4 v241, s[16:19], s7 offen sc1 lds
s_add_u32 m0, s30, 0
v_mfma_f32_16x16x32_bf16 a[36:39], v[36:39], v[208:211], a[36:39]
v_exp_f32 v236, v156
v_mfma_f32_16x16x32_bf16 a[36:39], v[40:43], v[212:215], a[36:39]
v_exp_f32 v237, v157
v_mfma_f32_16x16x32_bf16 a[40:43], v[68:71], v[208:211], a[40:43]
v_exp_f32 v238, v158
v_mfma_f32_16x16x32_bf16 a[40:43], v[72:75], v[212:215], a[40:43]
v_add_f32 v227, v231, v236
v_cvt_pk_bf16_f32 v98, v236, v237
v_mfma_f32_16x16x32_bf16 a[44:47], v[100:103], v[208:211], a[44:47]
ds_read_b64_tr_b16 v[208:209], v245 offset:16896
ds_read_b64_tr_b16 v[210:211], v245 offset:18944
v_mfma_f32_16x16x32_bf16 a[44:47], v[104:107], v[212:215], a[44:47]
ds_read_b64_tr_b16 v[212:213], v13 offset:512
s_waitcnt lgkmcnt(3)
v_mfma_f32_16x16x32_bf16 a[32:35], v[176:179], v[216:219], a[32:35]
ds_read_b64_tr_b16 v[214:215], v13 offset:2560
buffer_load_dwordx4 v241, s[16:19], s29 offen sc1 lds
s_add_u32 m0, s28, 4096
v_mfma_f32_16x16x32_bf16 a[32:35], v[160:163], v[220:223], a[32:35]
v_exp_f32 v239, v159
v_xor_b32 v241, 0x1040, v241
v_mfma_f32_16x16x32_bf16 a[36:39], v[180:183], v[216:219], a[36:39]
v_add_f32 v227, v227, v237
v_add_f32 v227, v227, v238
v_mfma_f32_16x16x32_bf16 a[36:39], v[164:167], v[220:223], a[36:39]
v_add_f32 v227, v227, v239
v_cvt_pk_bf16_f32 v99, v238, v239
v_mfma_f32_16x16x32_bf16 a[40:43], v[184:187], v[216:219], a[40:43]
v_max3_f32 v242, v224, v225, v226
v_max_f32 v242, v242, v227
v_mfma_f32_16x16x32_bf16 a[40:43], v[168:171], v[220:223], a[40:43]
v_cmp_lt_f32 vcc, s32, v242
s_cbranch_vccnz L2_rare_site11
L2_ret11:
v_mfma_f32_16x16x32_bf16 a[44:47], v[188:191], v[216:219], a[44:47]
ds_read_b64_tr_b16 v[216:217], v13 offset:16896
ds_read_b64_tr_b16 v[218:219], v13 offset:18944
v_mfma_f32_16x16x32_bf16 a[44:47], v[172:175], v[220:223], a[44:47]
ds_read_b64_tr_b16 v[220:221], v15 offset:512
s_waitcnt lgkmcnt(3)
v_mfma_f32_16x16x32_bf16 a[48:51], v[4:7], v[208:211], a[48:51]
ds_read_b64_tr_b16 v[222:223], v15 offset:2560
buffer_load_dwordx4 v241, s[16:19], s6 offen sc1 lds
s_add_u32 m0, s28, 12288
v_mfma_f32_16x16x32_bf16 a[48:51], v[8:11], v[212:215], a[48:51]
buffer_load_dwordx4 v241, s[16:19], s7 offen sc1 lds
s_add_u32 m0, s30, 4096
v_mfma_f32_16x16x32_bf16 a[52:55], v[36:39], v[208:211], a[52:55]
buffer_load_dwordx4 v241, s[16:19], s29 offen sc1 lds
v_mfma_f32_16x16x32_bf16 a[52:55], v[40:43], v[212:215], a[52:55]
v_mfma_f32_16x16x32_bf16 a[56:59], v[68:71], v[208:211], a[56:59]
v_mfma_f32_16x16x32_bf16 a[56:59], v[72:75], v[212:215], a[56:59]
v_mfma_f32_16x16x32_bf16 a[60:63], v[100:103], v[208:211], a[60:63]
ds_read_b64_tr_b16 v[208:209], v14 offset:16384
ds_read_b64_tr_b16 v[210:211], v14 offset:18432
v_mfma_f32_16x16x32_bf16 a[60:63], v[104:107], v[212:215], a[60:63]
ds_read_b64_tr_b16 v[212:213], v15 offset:16384
s_waitcnt lgkmcnt(3)
v_mfma_f32_16x16x32_bf16 a[48:51], v[176:179], v[216:219], a[48:51]
ds_read_b64_tr_b16 v[214:215], v15 offset:18432
v_mfma_f32_16x16x32_bf16 a[48:51], v[160:163], v[220:223], a[48:51]
v_mfma_f32_16x16x32_bf16 a[52:55], v[180:183], v[216:219], a[52:55]
v_mfma_f32_16x16x32_bf16 a[52:55], v[164:167], v[220:223], a[52:55]
v_mfma_f32_16x16x32_bf16 a[56:59], v[184:187], v[216:219], a[56:59]
v_mfma_f32_16x16x32_bf16 a[56:59], v[168:171], v[220:223], a[56:59]
v_mfma_f32_16x16x32_bf16 a[60:63], v[188:191], v[216:219], a[60:63]
ds_read_b64_tr_b16 v[216:217], v14 offset:16896
ds_read_b64_tr_b16 v[218:219], v14 offset:18944
v_mfma_f32_16x16x32_bf16 a[60:63], v[172:175], v[220:223], a[60:63]
ds_read_b64_tr_b16 v[220:221], v15 offset:16896
s_waitcnt lgkmcnt(5)
v_mfma_f32_16x16x32_bf16 a[0:3], v[0:3], v[208:211], a[0:3]
ds_read_b64_tr_b16 v[222:223], v15 offset:18944
v_bfe_u32 v242, v248, 8, 1
v_mul_u32_u24 v242, 48, v242
v_mfma_f32_16x16x32_bf16 a[4:7], v[32:35], v[208:211], a[4:7]
v_lshl_add_u32 v242, s37, 3, v242
v_and_b32 v243, 0xf0, v248
v_lshl_add_u32 v242, v243, 3, v242
v_mfma_f32_16x16x32_bf16 a[8:11], v[64:67], v[208:211], a[8:11]
v_mov_b32 v232, v224
v_mov_b32 v234, v225
v_mov_b32 v236, v226
v_mfma_f32_16x16x32_bf16 a[12:15], v[96:99], v[208:211], a[12:15]
ds_read_b64_tr_b16 v[208:209], v244 offset:20480
s_waitcnt lgkmcnt(5)
v_mov_b32 v238, v227
v_mfma_f32_16x16x32_bf16 a[16:19], v[0:3], v[212:215], a[16:19]
ds_read_b64_tr_b16 v[210:211], v244 offset:22528
v_permlane32_swap_b32 v224, v232
v_permlane32_swap_b32 v225, v234
v_mfma_f32_16x16x32_bf16 a[20:23], v[32:35], v[212:215], a[20:23]
v_permlane32_swap_b32 v226, v236
v_permlane32_swap_b32 v227, v238
v_add_f32 v224, v224, v232
v_mfma_f32_16x16x32_bf16 a[24:27], v[64:67], v[212:215], a[24:27]
v_add_f32 v225, v225, v234
v_add_f32 v226, v226, v236
v_add_f32 v227, v227, v238
v_mfma_f32_16x16x32_bf16 a[28:31], v[96:99], v[212:215], a[28:31]
ds_read_b64_tr_b16 v[212:213], v12 offset:4096
s_waitcnt lgkmcnt(5)
v_mov_b32 v232, v224
v_mfma_f32_16x16x32_bf16 a[32:35], v[0:3], v[216:219], a[32:35]
ds_read_b64_tr_b16 v[214:215], v12 offset:6144
v_mov_b32 v234, v225
v_mov_b32 v236, v226
v_mfma_f32_16x16x32_bf16 a[36:39], v[32:35], v[216:219], a[36:39]
v_mov_b32 v238, v227
v_permlane16_swap_b32 v224, v232
v_permlane16_swap_b32 v225, v234
v_mfma_f32_16x16x32_bf16 a[40:43], v[64:67], v[216:219], a[40:43]
v_permlane16_swap_b32 v226, v236
v_permlane16_swap_b32 v227, v238
v_add_f32 v233, v224, v232
v_mfma_f32_16x16x32_bf16 a[44:47], v[96:99], v[216:219], a[44:47]
ds_read_b64_tr_b16 v[216:217], v12 offset:20480
s_waitcnt lgkmcnt(5)
v_add_f32 v235, v225, v234
v_mfma_f32_16x16x32_bf16 a[48:51], v[0:3], v[220:223], a[48:51]
ds_read_b64_tr_b16 v[218:219], v12 offset:22528
v_add_f32 v237, v226, v236
v_add_f32 v239, v227, v238
v_mfma_f32_16x16x32_bf16 a[52:55], v[32:35], v[220:223], a[52:55]
v_sub_f32 v232, 0, v192
v_sub_f32 v234, 0, v196
v_sub_f32 v236, 0, v200
v_mfma_f32_16x16x32_bf16 a[56:59], v[64:67], v[220:223], a[56:59]
v_sub_f32 v238, 0, v204
v_mfma_f32_16x16x32_bf16 a[60:63], v[96:99], v[220:223], a[60:63]
ds_read_b64_tr_b16 v[220:221], v14 offset:4096
s_waitcnt lgkmcnt(3)
v_mfma_f32_16x16x32_bf16 a[64:67], v[4:7], v[208:211], a[64:67]
ds_read_b64_tr_b16 v[222:223], v14 offset:6144
v_mfma_f32_16x16x32_bf16 a[64:67], v[8:11], v[212:215], a[64:67]
s_mov_b32 exec_hi, 0
buffer_store_dwordx2 v[232:233], v242, s[24:27], s48 offen sc1
s_lshr_b32 s3, s41, 2
buffer_store_dwordx2 v[234:235], v242, s[24:27], s3 offen sc1
s_lshr_b32 s3, s42, 2
buffer_store_dwordx2 v[236:237], v242, s[24:27], s3 offen sc1
s_lshr_b32 s3, s43, 2
buffer_store_dwordx2 v[238:239], v242, s[24:27], s3 offen sc1
s_mov_b32 exec_hi, -1
v_mfma_f32_16x16x32_bf16 a[68:71], v[36:39], v[208:211], a[68:71]
v_accvgpr_read_b32 v128, a0
v_accvgpr_read_b32 v129, a1
v_accvgpr_read_b32 v130, a2
v_mfma_f32_16x16x32_bf16 a[68:71], v[40:43], v[212:215], a[68:71]
v_accvgpr_read_b32 v131, a3
v_cvt_pk_bf16_f32 v16, v128, v129
v_cvt_pk_bf16_f32 v17, v130, v131
v_mfma_f32_16x16x32_bf16 a[72:75], v[68:71], v[208:211], a[72:75]
v_accvgpr_read_b32 v136, a4
v_accvgpr_read_b32 v137, a5
v_accvgpr_read_b32 v138, a6
v_mfma_f32_16x16x32_bf16 a[72:75], v[72:75], v[212:215], a[72:75]
v_accvgpr_read_b32 v139, a7
v_cvt_pk_bf16_f32 v48, v136, v137
v_cvt_pk_bf16_f32 v49, v138, v139
v_mfma_f32_16x16x32_bf16 a[76:79], v[100:103], v[208:211], a[76:79]
ds_read_b64_tr_b16 v[208:209], v14 offset:20480
ds_read_b64_tr_b16 v[210:211], v14 offset:22528
v_accvgpr_read_b32 v144, a8
v_mfma_f32_16x16x32_bf16 a[76:79], v[104:107], v[212:215], a[76:79]
ds_read_b64_tr_b16 v[212:213], v245 offset:20480
s_waitcnt lgkmcnt(3)
v_accvgpr_read_b32 v145, a9
v_mfma_f32_16x16x32_bf16 a[64:67], v[176:179], v[216:219], a[64:67]
ds_read_b64_tr_b16 v[214:215], v245 offset:22528
v_accvgpr_read_b32 v146, a10
v_accvgpr_read_b32 v147, a11
v_mfma_f32_16x16x32_bf16 a[64:67], v[160:163], v[220:223], a[64:67]
v_cvt_pk_bf16_f32 v80, v144, v145
v_cvt_pk_bf16_f32 v81, v146, v147
v_accvgpr_read_b32 v152, a12
v_mfma_f32_16x16x32_bf16 a[68:71], v[180:183], v[216:219], a[68:71]
v_accvgpr_read_b32 v153, a13
v_accvgpr_read_b32 v154, a14
v_accvgpr_read_b32 v155, a15
v_mfma_f32_16x16x32_bf16 a[68:71], v[164:167], v[220:223], a[68:71]
v_cvt_pk_bf16_f32 v112, v152, v153
v_cvt_pk_bf16_f32 v113, v154, v155
v_accvgpr_read_b32 v132, a16
v_mfma_f32_16x16x32_bf16 a[72:75], v[184:187], v[216:219], a[72:75]
v_accvgpr_read_b32 v133, a17
v_accvgpr_read_b32 v134, a18
v_accvgpr_read_b32 v135, a19
v_mfma_f32_16x16x32_bf16 a[72:75], v[168:171], v[220:223], a[72:75]
v_cvt_pk_bf16_f32 v18, v132, v133
v_cvt_pk_bf16_f32 v19, v134, v135
buffer_store_dwordx4 v[16:19], v248, s[20:23], s40 offen offset:0 sc1
v_mfma_f32_16x16x32_bf16 a[76:79], v[188:191], v[216:219], a[76:79]
ds_read_b64_tr_b16 v[216:217], v13 offset:4096
ds_read_b64_tr_b16 v[218:219], v13 offset:6144
ds_write_b128 v253, v[16:19] offset:0
v_mfma_f32_16x16x32_bf16 a[76:79], v[172:175], v[220:223], a[76:79]
ds_read_b64_tr_b16 v[220:221], v13 offset:20480
s_waitcnt lgkmcnt(5)
v_accvgpr_read_b32 v140, a20
v_mfma_f32_16x16x32_bf16 a[64:67], v[0:3], v[208:211], a[64:67]
ds_read_b64_tr_b16 v[222:223], v13 offset:22528
v_accvgpr_read_b32 v141, a21
v_accvgpr_read_b32 v142, a22
v_mfma_f32_16x16x32_bf16 a[68:71], v[32:35], v[208:211], a[68:71]
v_accvgpr_read_b32 v143, a23
v_cvt_pk_bf16_f32 v50, v140, v141
v_cvt_pk_bf16_f32 v51, v142, v143
v_mfma_f32_16x16x32_bf16 a[72:75], v[64:67], v[208:211], a[72:75]
buffer_store_dwordx4 v[48:51], v248, s[20:23], s41 offen offset:0 sc1
v_accvgpr_read_b32 v148, a24
v_accvgpr_read_b32 v149, a25
v_mfma_f32_16x16x32_bf16 a[76:79], v[96:99], v[208:211], a[76:79]
ds_read_b64_tr_b16 v[208:209], v15 offset:4096
s_waitcnt lgkmcnt(5)
v_accvgpr_read_b32 v150, a26
v_mfma_f32_16x16x32_bf16 a[80:83], v[4:7], v[212:215], a[80:83]
ds_read_b64_tr_b16 v[210:211], v15 offset:6144
v_accvgpr_read_b32 v151, a27
v_cvt_pk_bf16_f32 v82, v148, v149
v_mfma_f32_16x16x32_bf16 a[84:87], v[36:39], v[212:215], a[84:87]
v_cvt_pk_bf16_f32 v83, v150, v151
buffer_store_dwordx4 v[80:83], v248, s[20:23], s42 offen offset:0 sc1
v_accvgpr_read_b32 v156, a28
v_mfma_f32_16x16x32_bf16 a[88:91], v[68:71], v[212:215], a[88:91]
v_accvgpr_read_b32 v157, a29
v_accvgpr_read_b32 v158, a30
v_accvgpr_read_b32 v159, a31
v_mfma_f32_16x16x32_bf16 a[92:95], v[100:103], v[212:215], a[92:95]
ds_read_b64_tr_b16 v[212:213], v15 offset:20480
s_waitcnt lgkmcnt(3)
v_cvt_pk_bf16_f32 v114, v156, v157
v_mfma_f32_16x16x32_bf16 a[80:83], v[8:11], v[216:219], a[80:83]
ds_read_b64_tr_b16 v[214:215], v15 offset:22528
v_cvt_pk_bf16_f32 v115, v158, v159
buffer_store_dwordx4 v[112:115], v248, s[20:23], s43 offen offset:0 sc1
v_mfma_f32_16x16x32_bf16 a[80:83], v[176:179], v[220:223], a[80:83]
v_accvgpr_read_b32 v128, a32
v_accvgpr_read_b32 v129, a33
v_accvgpr_read_b32 v130, a34
v_mfma_f32_16x16x32_bf16 a[84:87], v[40:43], v[216:219], a[84:87]
v_accvgpr_read_b32 v131, a35
v_cvt_pk_bf16_f32 v20, v128, v129
v_cvt_pk_bf16_f32 v21, v130, v131
v_mfma_f32_16x16x32_bf16 a[84:87], v[180:183], v[220:223], a[84:87]
v_accvgpr_read_b32 v136, a36
v_accvgpr_read_b32 v137, a37
v_accvgpr_read_b32 v138, a38
v_mfma_f32_16x16x32_bf16 a[88:91], v[72:75], v[216:219], a[88:91]
v_accvgpr_read_b32 v139, a39
v_cvt_pk_bf16_f32 v52, v136, v137
v_cvt_pk_bf16_f32 v53, v138, v139
v_mfma_f32_16x16x32_bf16 a[88:91], v[184:187], v[220:223], a[88:91]
v_accvgpr_read_b32 v144, a40
v_accvgpr_read_b32 v145, a41
v_accvgpr_read_b32 v146, a42
v_mfma_f32_16x16x32_bf16 a[92:95], v[104:107], v[216:219], a[92:95]
ds_read_b64_tr_b16 v[216:217], v244 offset:20992
ds_read_b64_tr_b16 v[218:219], v244 offset:23040
v_accvgpr_read_b32 v147, a43
v_mfma_f32_16x16x32_bf16 a[92:95], v[188:191], v[220:223], a[92:95]
ds_read_b64_tr_b16 v[220:221], v12 offset:4608
s_waitcnt lgkmcnt(3)
v_cvt_pk_bf16_f32 v84, v144, v145
v_mfma_f32_16x16x32_bf16 a[80:83], v[160:163], v[208:211], a[80:83]
ds_read_b64_tr_b16 v[222:223], v12 offset:6656
v_cvt_pk_bf16_f32 v85, v146, v147
v_accvgpr_read_b32 v152, a44
v_mfma_f32_16x16x32_bf16 a[80:83], v[0:3], v[212:215], a[80:83]
v_accvgpr_read_b32 v153, a45
v_accvgpr_read_b32 v154, a46
v_accvgpr_read_b32 v155, a47
v_mfma_f32_16x16x32_bf16 a[84:87], v[164:167], v[208:211], a[84:87]
v_cvt_pk_bf16_f32 v116, v152, v153
v_cvt_pk_bf16_f32 v117, v154, v155
v_accvgpr_read_b32 v132, a48
v_mfma_f32_16x16x32_bf16 a[84:87], v[32:35], v[212:215], a[84:87]
v_accvgpr_read_b32 v133, a49
v_accvgpr_read_b32 v134, a50
v_accvgpr_read_b32 v135, a51
v_mfma_f32_16x16x32_bf16 a[88:91], v[168:171], v[208:211], a[88:91]
v_cvt_pk_bf16_f32 v22, v132, v133
v_cvt_pk_bf16_f32 v23, v134, v135
buffer_store_dwordx4 v[20:23], v248, s[20:23], s40 offen offset:1024 sc1
v_mfma_f32_16x16x32_bf16 a[88:91], v[64:67], v[212:215], a[88:91]
ds_write_b128 v253, v[20:23] offset:1024
v_accvgpr_read_b32 v140, a52
v_accvgpr_read_b32 v141, a53
v_mfma_f32_16x16x32_bf16 a[92:95], v[172:175], v[208:211], a[92:95]
ds_read_b64_tr_b16 v[208:209], v12 offset:20992
ds_read_b64_tr_b16 v[210:211], v12 offset:23040
v_accvgpr_read_b32 v142, a54
v_mfma_f32_16x16x32_bf16 a[92:95], v[96:99], v[212:215], a[92:95]
ds_read_b64_tr_b16 v[212:213], v14 offset:4608
s_waitcnt lgkmcnt(3)
v_accvgpr_read_b32 v143, a55
v_mfma_f32_16x16x32_bf16 a[96:99], v[4:7], v[216:219], a[96:99]
ds_read_b64_tr_b16 v[214:215], v14 offset:6656
v_cvt_pk_bf16_f32 v54, v140, v141
v_cvt_pk_bf16_f32 v55, v142, v143
v_mfma_f32_16x16x32_bf16 a[96:99], v[8:11], v[220:223], a[96:99]
buffer_store_dwordx4 v[52:55], v248, s[20:23], s41 offen offset:1024 sc1
v_accvgpr_read_b32 v148, a56
v_accvgpr_read_b32 v149, a57
v_mfma_f32_16x16x32_bf16 a[100:103], v[36:39], v[216:219], a[100:103]
v_accvgpr_read_b32 v150, a58
v_accvgpr_read_b32 v151, a59
v_cvt_pk_bf16_f32 v86, v148, v149
v_mfma_f32_16x16x32_bf16 a[100:103], v[40:43], v[220:223], a[100:103]
v_cvt_pk_bf16_f32 v87, v150, v151
buffer_store_dwordx4 v[84:87], v248, s[20:23], s42 offen offset:1024 sc1
v_accvgpr_read_b32 v156, a60
v_mfma_f32_16x16x32_bf16 a[104:107], v[68:71], v[216:219], a[104:107]
v_accvgpr_read_b32 v157, a61
v_accvgpr_read_b32 v158, a62
v_accvgpr_read_b32 v159, a63
v_mfma_f32_16x16x32_bf16 a[104:107], v[72:75], v[220:223], a[104:107]
v_cvt_pk_bf16_f32 v118, v156, v157
v_cvt_pk_bf16_f32 v119, v158, v159
buffer_store_dwordx4 v[116:119], v248, s[20:23], s43 offen offset:1024 sc1
v_mfma_f32_16x16x32_bf16 a[108:111], v[100:103], v[216:219], a[108:111]
ds_read_b64_tr_b16 v[216:217], v14 offset:20992
ds_read_b64_tr_b16 v[218:219], v14 offset:23040
v_accvgpr_read_b32 v128, a64
v_mfma_f32_16x16x32_bf16 a[108:111], v[104:107], v[220:223], a[108:111]
ds_read_b64_tr_b16 v[220:221], v245 offset:20992
s_waitcnt lgkmcnt(3)
v_accvgpr_read_b32 v129, a65
v_mfma_f32_16x16x32_bf16 a[96:99], v[176:179], v[208:211], a[96:99]
ds_read_b64_tr_b16 v[222:223], v245 offset:23040
v_accvgpr_read_b32 v130, a66
v_accvgpr_read_b32 v131, a67
v_mfma_f32_16x16x32_bf16 a[96:99], v[160:163], v[212:215], a[96:99]
v_cvt_pk_bf16_f32 v24, v128, v129
v_cvt_pk_bf16_f32 v25, v130, v131
v_accvgpr_read_b32 v136, a68
v_mfma_f32_16x16x32_bf16 a[100:103], v[180:183], v[208:211], a[100:103]
v_accvgpr_read_b32 v137, a69
v_accvgpr_read_b32 v138, a70
v_accvgpr_read_b32 v139, a71
v_mfma_f32_16x16x32_bf16 a[100:103], v[164:167], v[212:215], a[100:103]
v_cvt_pk_bf16_f32 v56, v136, v137
v_cvt_pk_bf16_f32 v57, v138, v139
v_accvgpr_read_b32 v144, a72
v_mfma_f32_16x16x32_bf16 a[104:107], v[184:187], v[208:211], a[104:107]
v_accvgpr_read_b32 v145, a73
v_accvgpr_read_b32 v146, a74
v_accvgpr_read_b32 v147, a75
v_mfma_f32_16x16x32_bf16 a[104:107], v[168:171], v[212:215], a[104:107]
v_cvt_pk_bf16_f32 v88, v144, v145
v_cvt_pk_bf16_f32 v89, v146, v147
v_accvgpr_read_b32 v152, a76
v_mfma_f32_16x16x32_bf16 a[108:111], v[188:191], v[208:211], a[108:111]
ds_read_b64_tr_b16 v[208:209], v13 offset:4608
ds_read_b64_tr_b16 v[210:211], v13 offset:6656
v_accvgpr_read_b32 v153, a77
v_mfma_f32_16x16x32_bf16 a[108:111], v[172:175], v[212:215], a[108:111]
ds_read_b64_tr_b16 v[212:213], v13 offset:20992
s_waitcnt lgkmcnt(5)
v_accvgpr_read_b32 v154, a78
v_mfma_f32_16x16x32_bf16 a[96:99], v[0:3], v[216:219], a[96:99]
ds_read_b64_tr_b16 v[214:215], v13 offset:23040
v_accvgpr_read_b32 v155, a79
v_cvt_pk_bf16_f32 v120, v152, v153
v_mfma_f32_16x16x32_bf16 a[100:103], v[32:35], v[216:219], a[100:103]
v_cvt_pk_bf16_f32 v121, v154, v155
v_accvgpr_read_b32 v132, a80
v_accvgpr_read_b32 v133, a81
v_mfma_f32_16x16x32_bf16 a[104:107], v[64:67], v[216:219], a[104:107]
v_accvgpr_read_b32 v134, a82
v_accvgpr_read_b32 v135, a83
v_cvt_pk_bf16_f32 v26, v132, v133
v_mfma_f32_16x16x32_bf16 a[108:111], v[96:99], v[216:219], a[108:111]
ds_read_b64_tr_b16 v[216:217], v15 offset:4608
s_waitcnt lgkmcnt(5)
v_cvt_pk_bf16_f32 v27, v134, v135
v_mfma_f32_16x16x32_bf16 a[112:115], v[4:7], v[220:223], a[112:115]
ds_read_b64_tr_b16 v[218:219], v15 offset:6656
buffer_store_dwordx4 v[24:27], v248, s[20:23], s40 offen offset:2048 sc1
ds_write_b128 v253, v[24:27] offset:2048
v_mfma_f32_16x16x32_bf16 a[116:119], v[36:39], v[220:223], a[116:119]
v_accvgpr_read_b32 v140, a84
v_accvgpr_read_b32 v141, a85
v_accvgpr_read_b32 v142, a86
v_mfma_f32_16x16x32_bf16 a[120:123], v[68:71], v[220:223], a[120:123]
v_accvgpr_read_b32 v143, a87
v_cvt_pk_bf16_f32 v58, v140, v141
v_cvt_pk_bf16_f32 v59, v142, v143
v_mfma_f32_16x16x32_bf16 a[124:127], v[100:103], v[220:223], a[124:127]
ds_read_b64_tr_b16 v[220:221], v15 offset:20992
s_waitcnt lgkmcnt(3)
buffer_store_dwordx4 v[56:59], v248, s[20:23], s41 offen offset:2048 sc1
v_mfma_f32_16x16x32_bf16 a[112:115], v[8:11], v[208:211], a[112:115]
ds_read_b64_tr_b16 v[222:223], v15 offset:23040
v_accvgpr_read_b32 v148, a88
v_accvgpr_read_b32 v149, a89
v_mfma_f32_16x16x32_bf16 a[112:115], v[176:179], v[212:215], a[112:115]
v_accvgpr_read_b32 v150, a90
v_accvgpr_read_b32 v151, a91
v_cvt_pk_bf16_f32 v90, v148, v149
v_mfma_f32_16x16x32_bf16 a[116:119], v[40:43], v[208:211], a[116:119]
v_cvt_pk_bf16_f32 v91, v150, v151
buffer_store_dwordx4 v[88:91], v248, s[20:23], s42 offen offset:2048 sc1
v_accvgpr_read_b32 v156, a92
v_mfma_f32_16x16x32_bf16 a[116:119], v[180:183], v[212:215], a[116:119]
v_accvgpr_read_b32 v157, a93
v_accvgpr_read_b32 v158, a94
v_accvgpr_read_b32 v159, a95
v_mfma_f32_16x16x32_bf16 a[120:123], v[72:75], v[208:211], a[120:123]
v_cvt_pk_bf16_f32 v122, v156, v157
v_cvt_pk_bf16_f32 v123, v158, v159
buffer_store_dwordx4 v[120:123], v248, s[20:23], s43 offen offset:2048 sc1
v_mfma_f32_16x16x32_bf16 a[120:123], v[184:187], v[212:215], a[120:123]
v_accvgpr_read_b32 v128, a96
v_accvgpr_read_b32 v129, a97
v_mfma_f32_16x16x32_bf16 a[124:127], v[104:107], v[208:211], a[124:127]
ds_read_b64_tr_b16 v[208:209], v12 offset:8192
ds_read_b64_tr_b16 v[210:211], v12 offset:10240
v_mfma_f32_16x16x32_bf16 a[124:127], v[188:191], v[212:215], a[124:127]
ds_read_b64_tr_b16 v[212:213], v12 offset:24576
s_waitcnt lgkmcnt(3)
v_mfma_f32_16x16x32_bf16 a[112:115], v[160:163], v[216:219], a[112:115]
ds_read_b64_tr_b16 v[214:215], v12 offset:26624
v_accvgpr_read_b32 v130, a98
v_mfma_f32_16x16x32_bf16 a[112:115], v[0:3], v[220:223], a[112:115]
v_accvgpr_read_b32 v131, a99
v_cvt_pk_bf16_f32 v28, v128, v129
v_mfma_f32_16x16x32_bf16 a[116:119], v[164:167], v[216:219], a[116:119]
v_cvt_pk_bf16_f32 v29, v130, v131
v_accvgpr_read_b32 v136, a100
v_mfma_f32_16x16x32_bf16 a[116:119], v[32:35], v[220:223], a[116:119]
v_accvgpr_read_b32 v137, a101
v_accvgpr_read_b32 v138, a102
v_mfma_f32_16x16x32_bf16 a[120:123], v[168:171], v[216:219], a[120:123]
v_accvgpr_read_b32 v139, a103
v_cvt_pk_bf16_f32 v60, v136, v137
v_mfma_f32_16x16x32_bf16 a[120:123], v[64:67], v[220:223], a[120:123]
v_cvt_pk_bf16_f32 v61, v138, v139
v_accvgpr_read_b32 v144, a104
v_mfma_f32_16x16x32_bf16 a[124:127], v[172:175], v[216:219], a[124:127]
ds_read_b64_tr_b16 v[216:217], v14 offset:8192
ds_read_b64_tr_b16 v[218:219], v14 offset:10240
v_mfma_f32_16x16x32_bf16 a[124:127], v[96:99], v[220:223], a[124:127]
ds_read_b64_tr_b16 v[220:221], v14 offset:24576
s_waitcnt lgkmcnt(3)
v_mfma_f32_16x16x32_bf16 a[128:131], v[8:11], v[208:211], a[128:131]
ds_read_b64_tr_b16 v[222:223], v14 offset:26624
v_accvgpr_read_b32 v145, a105
v_mfma_f32_16x16x32_bf16 a[128:131], v[176:179], v[212:215], a[128:131]
v_accvgpr_read_b32 v146, a106
v_accvgpr_read_b32 v147, a107
v_mfma_f32_16x16x32_bf16 a[132:135], v[40:43], v[208:211], a[132:135]
v_cvt_pk_bf16_f32 v92, v144, v145
v_cvt_pk_bf16_f32 v93, v146, v147
v_mfma_f32_16x16x32_bf16 a[132:135], v[180:183], v[212:215], a[132:135]
v_accvgpr_read_b32 v152, a108
v_accvgpr_read_b32 v153, a109
v_mfma_f32_16x16x32_bf16 a[136:139], v[72:75], v[208:211], a[136:139]
v_accvgpr_read_b32 v154, a110
v_accvgpr_read_b32 v155, a111
v_mfma_f32_16x16x32_bf16 a[136:139], v[184:187], v[212:215], a[136:139]
v_cvt_pk_bf16_f32 v124, v152, v153
v_cvt_pk_bf16_f32 v125, v154, v155
v_mfma_f32_16x16x32_bf16 a[140:143], v[104:107], v[208:211], a[140:143]
ds_read_b64_tr_b16 v[208:209], v13 offset:8192
ds_read_b64_tr_b16 v[210:211], v13 offset:10240
v_mfma_f32_16x16x32_bf16 a[140:143], v[188:191], v[212:215], a[140:143]
ds_read_b64_tr_b16 v[212:213], v13 offset:24576
s_waitcnt lgkmcnt(3)
v_mfma_f32_16x16x32_bf16 a[128:131], v[160:163], v[216:219], a[128:131]
ds_read_b64_tr_b16 v[214:215], v13 offset:26624
v_accvgpr_read_b32 v132, a112
v_mfma_f32_16x16x32_bf16 a[128:131], v[0:3], v[220:223], a[128:131]
v_accvgpr_read_b32 v133, a113
v_accvgpr_read_b32 v134, a114
v_mfma_f32_16x16x32_bf16 a[132:135], v[164:167], v[216:219], a[132:135]
v_accvgpr_read_b32 v135, a115
v_cvt_pk_bf16_f32 v30, v132, v133
v_mfma_f32_16x16x32_bf16 a[132:135], v[32:35], v[220:223], a[132:135]
v_cvt_pk_bf16_f32 v31, v134, v135
buffer_store_dwordx4 v[28:31], v248, s[20:23], s40 offen offset:3072 sc1
v_mfma_f32_16x16x32_bf16 a[136:139], v[168:171], v[216:219], a[136:139]
ds_write_b128 v253, v[28:31] offset:3072
v_accvgpr_read_b32 v140, a116
v_mfma_f32_16x16x32_bf16 a[136:139], v[64:67], v[220:223], a[136:139]
v_accvgpr_read_b32 v141, a117
v_accvgpr_read_b32 v142, a118
v_mfma_f32_16x16x32_bf16 a[140:143], v[172:175], v[216:219], a[140:143]
ds_read_b64_tr_b16 v[216:217], v15 offset:8192
ds_read_b64_tr_b16 v[218:219], v15 offset:10240
v_mfma_f32_16x16x32_bf16 a[140:143], v[96:99], v[220:223], a[140:143]
ds_read_b64_tr_b16 v[220:221], v15 offset:24576
s_waitcnt lgkmcnt(3)
v_mfma_f32_16x16x32_bf16 a[144:147], v[8:11], v[208:211], a[144:147]
ds_read_b64_tr_b16 v[222:223], v15 offset:26624
v_accvgpr_read_b32 v143, a119
v_mfma_f32_16x16x32_bf16 a[144:147], v[176:179], v[212:215], a[144:147]
v_cvt_pk_bf16_f32 v62, v140, v141
v_cvt_pk_bf16_f32 v63, v142, v143
v_mfma_f32_16x16x32_bf16 a[148:151], v[40:43], v[208:211], a[148:151]
buffer_store_dwordx4 v[60:63], v248, s[20:23], s41 offen offset:3072 sc1
v_accvgpr_read_b32 v148, a120
v_mfma_f32_16x16x32_bf16 a[148:151], v[180:183], v[212:215], a[148:151]
v_accvgpr_read_b32 v149, a121
v_accvgpr_read_b32 v150, a122
v_mfma_f32_16x16x32_bf16 a[152:155], v[72:75], v[208:211], a[152:155]
v_accvgpr_read_b32 v151, a123
v_cvt_pk_bf16_f32 v94, v148, v149
v_mfma_f32_16x16x32_bf16 a[152:155], v[184:187], v[212:215], a[152:155]
v_cvt_pk_bf16_f32 v95, v150, v151
buffer_store_dwordx4 v[92:95], v248, s[20:23], s42 offen offset:3072 sc1
v_mfma_f32_16x16x32_bf16 a[156:159], v[104:107], v[208:211], a[156:159]
ds_read_b64_tr_b16 v[208:209], v12 offset:8704
ds_read_b64_tr_b16 v[210:211], v12 offset:10752
v_mfma_f32_16x16x32_bf16 a[156:159], v[188:191], v[212:215], a[156:159]
ds_read_b64_tr_b16 v[212:213], v12 offset:25088
s_waitcnt lgkmcnt(3)
v_mfma_f32_16x16x32_bf16 a[144:147], v[160:163], v[216:219], a[144:147]
ds_read_b64_tr_b16 v[214:215], v12 offset:27136
v_accvgpr_read_b32 v156, a124
v_mfma_f32_16x16x32_bf16 a[144:147], v[0:3], v[220:223], a[144:147]
v_accvgpr_read_b32 v157, a125
v_accvgpr_read_b32 v158, a126
v_mfma_f32_16x16x32_bf16 a[148:151], v[164:167], v[216:219], a[148:151]
v_accvgpr_read_b32 v159, a127
v_cvt_pk_bf16_f32 v126, v156, v157
v_mfma_f32_16x16x32_bf16 a[148:151], v[32:35], v[220:223], a[148:151]
v_cvt_pk_bf16_f32 v127, v158, v159
buffer_store_dwordx4 v[124:127], v248, s[20:23], s43 offen offset:3072 sc1
v_mfma_f32_16x16x32_bf16 a[152:155], v[168:171], v[216:219], a[152:155]
v_accvgpr_read_b32 v128, a128
v_accvgpr_read_b32 v129, a129
v_mfma_f32_16x16x32_bf16 a[152:155], v[64:67], v[220:223], a[152:155]
v_accvgpr_read_b32 v130, a130
v_accvgpr_read_b32 v131, a131
v_mfma_f32_16x16x32_bf16 a[156:159], v[172:175], v[216:219], a[156:159]
ds_read_b64_tr_b16 v[216:217], v14 offset:8704
ds_read_b64_tr_b16 v[218:219], v14 offset:10752
v_mfma_f32_16x16x32_bf16 a[156:159], v[96:99], v[220:223], a[156:159]
ds_read_b64_tr_b16 v[220:221], v14 offset:25088
s_waitcnt lgkmcnt(3)
v_mfma_f32_16x16x32_bf16 a[160:163], v[8:11], v[208:211], a[160:163]
ds_read_b64_tr_b16 v[222:223], v14 offset:27136
v_cvt_pk_bf16_f32 v16, v128, v129
v_mfma_f32_16x16x32_bf16 a[160:163], v[176:179], v[212:215], a[160:163]
v_cvt_pk_bf16_f32 v17, v130, v131
v_accvgpr_read_b32 v136, a132
v_mfma_f32_16x16x32_bf16 a[164:167], v[40:43], v[208:211], a[164:167]
v_accvgpr_read_b32 v137, a133
v_accvgpr_read_b32 v138, a134
v_mfma_f32_16x16x32_bf16 a[164:167], v[180:183], v[212:215], a[164:167]
v_accvgpr_read_b32 v139, a135
v_cvt_pk_bf16_f32 v48, v136, v137
v_mfma_f32_16x16x32_bf16 a[168:171], v[72:75], v[208:211], a[168:171]
v_cvt_pk_bf16_f32 v49, v138, v139
v_accvgpr_read_b32 v144, a136
v_mfma_f32_16x16x32_bf16 a[168:171], v[184:187], v[212:215], a[168:171]
v_accvgpr_read_b32 v145, a137
v_accvgpr_read_b32 v146, a138
v_mfma_f32_16x16x32_bf16 a[172:175], v[104:107], v[208:211], a[172:175]
ds_read_b64_tr_b16 v[208:209], v13 offset:8704
ds_read_b64_tr_b16 v[210:211], v13 offset:10752
v_mfma_f32_16x16x32_bf16 a[172:175], v[188:191], v[212:215], a[172:175]
ds_read_b64_tr_b16 v[212:213], v13 offset:25088
s_waitcnt lgkmcnt(3)
v_mfma_f32_16x16x32_bf16 a[160:163], v[160:163], v[216:219], a[160:163]
ds_read_b64_tr_b16 v[214:215], v13 offset:27136
v_accvgpr_read_b32 v147, a139
v_mfma_f32_16x16x32_bf16 a[160:163], v[0:3], v[220:223], a[160:163]
v_cvt_pk_bf16_f32 v80, v144, v145
v_cvt_pk_bf16_f32 v81, v146, v147
v_mfma_f32_16x16x32_bf16 a[164:167], v[164:167], v[216:219], a[164:167]
v_accvgpr_read_b32 v152, a140
v_accvgpr_read_b32 v153, a141
v_mfma_f32_16x16x32_bf16 a[164:167], v[32:35], v[220:223], a[164:167]
v_accvgpr_read_b32 v154, a142
v_accvgpr_read_b32 v155, a143
v_mfma_f32_16x16x32_bf16 a[168:171], v[168:171], v[216:219], a[168:171]
v_cvt_pk_bf16_f32 v112, v152, v153
v_cvt_pk_bf16_f32 v113, v154, v155
v_mfma_f32_16x16x32_bf16 a[168:171], v[64:67], v[220:223], a[168:171]
v_accvgpr_read_b32 v132, a144
v_accvgpr_read_b32 v133, a145
v_mfma_f32_16x16x32_bf16 a[172:175], v[172:175], v[216:219], a[172:175]
ds_read_b64_tr_b16 v[216:217], v15 offset:8704
ds_read_b64_tr_b16 v[218:219], v15 offset:10752
v_mfma_f32_16x16x32_bf16 a[172:175], v[96:99], v[220:223], a[172:175]
ds_read_b64_tr_b16 v[220:221], v15 offset:25088
s_waitcnt lgkmcnt(3)
v_mfma_f32_16x16x32_bf16 a[176:179], v[8:11], v[208:211], a[176:179]
ds_read_b64_tr_b16 v[222:223], v15 offset:27136
v_accvgpr_read_b32 v134, a146
v_mfma_f32_16x16x32_bf16 a[176:179], v[176:179], v[212:215], a[176:179]
v_accvgpr_read_b32 v135, a147
v_cvt_pk_bf16_f32 v18, v132, v133
v_mfma_f32_16x16x32_bf16 a[180:183], v[40:43], v[208:211], a[180:183]
v_cvt_pk_bf16_f32 v19, v134, v135
buffer_store_dwordx4 v[16:19], v248, s[20:23], s44 offen offset:0 sc1
v_mfma_f32_16x16x32_bf16 a[180:183], v[180:183], v[212:215], a[180:183]
ds_write_b128 v253, v[16:19] offset:4096
v_accvgpr_read_b32 v140, a148
v_mfma_f32_16x16x32_bf16 a[184:187], v[72:75], v[208:211], a[184:187]
v_accvgpr_read_b32 v141, a149
v_accvgpr_read_b32 v142, a150
v_mfma_f32_16x16x32_bf16 a[184:187], v[184:187], v[212:215], a[184:187]
v_accvgpr_read_b32 v143, a151
v_cvt_pk_bf16_f32 v50, v140, v141
v_mfma_f32_16x16x32_bf16 a[188:191], v[104:107], v[208:211], a[188:191]
ds_read_b64_tr_b16 v[208:209], v12 offset:12288
ds_read_b64_tr_b16 v[210:211], v12 offset:14336
v_mfma_f32_16x16x32_bf16 a[188:191], v[188:191], v[212:215], a[188:191]
ds_read_b64_tr_b16 v[212:213], v12 offset:28672
s_waitcnt lgkmcnt(3)
v_mfma_f32_16x16x32_bf16 a[176:179], v[160:163], v[216:219], a[176:179]
ds_read_b64_tr_b16 v[214:215], v12 offset:30720
v_cvt_pk_bf16_f32 v51, v142, v143
v_mfma_f32_16x16x32_bf16 a[176:179], v[0:3], v[220:223], a[176:179]
buffer_store_dwordx4 v[48:51], v248, s[20:23], s45 offen offset:0 sc1
v_accvgpr_read_b32 v148, a152
v_mfma_f32_16x16x32_bf16 a[180:183], v[164:167], v[216:219], a[180:183]
v_accvgpr_read_b32 v149, a153
v_accvgpr_read_b32 v150, a154
v_mfma_f32_16x16x32_bf16 a[180:183], v[32:35], v[220:223], a[180:183]
v_accvgpr_read_b32 v151, a155
v_cvt_pk_bf16_f32 v82, v148, v149
v_mfma_f32_16x16x32_bf16 a[184:187], v[168:171], v[216:219], a[184:187]
v_cvt_pk_bf16_f32 v83, v150, v151
buffer_store_dwordx4 v[80:83], v248, s[20:23], s46 offen offset:0 sc1
v_mfma_f32_16x16x32_bf16 a[184:187], v[64:67], v[220:223], a[184:187]
v_accvgpr_read_b32 v156, a156
v_accvgpr_read_b32 v157, a157
v_mfma_f32_16x16x32_bf16 a[188:191], v[172:175], v[216:219], a[188:191]
ds_read_b64_tr_b16 v[216:217], v14 offset:12288
ds_read_b64_tr_b16 v[218:219], v14 offset:14336
v_mfma_f32_16x16x32_bf16 a[188:191], v[96:99], v[220:223], a[188:191]
ds_read_b64_tr_b16 v[220:221], v14 offset:28672
s_waitcnt lgkmcnt(3)
v_mfma_f32_16x16x32_bf16 a[192:195], v[8:11], v[208:211], a[192:195]
ds_read_b64_tr_b16 v[222:223], v14 offset:30720
v_accvgpr_read_b32 v158, a158
v_mfma_f32_16x16x32_bf16 a[192:195], v[176:179], v[212:215], a[192:195]
v_accvgpr_read_b32 v159, a159
v_cvt_pk_bf16_f32 v114, v156, v157
v_mfma_f32_16x16x32_bf16 a[196:199], v[40:43], v[208:211], a[196:199]
v_cvt_pk_bf16_f32 v115, v158, v159
buffer_store_dwordx4 v[112:115], v248, s[20:23], s47 offen offset:0 sc1
v_mfma_f32_16x16x32_bf16 a[196:199], v[180:183], v[212:215], a[196:199]
v_accvgpr_read_b32 v128, a160
v_accvgpr_read_b32 v129, a161
v_mfma_f32_16x16x32_bf16 a[200:203], v[72:75], v[208:211], a[200:203]
v_accvgpr_read_b32 v130, a162
v_accvgpr_read_b32 v131, a163
v_mfma_f32_16x16x32_bf16 a[200:203], v[184:187], v[212:215], a[200:203]
v_cvt_pk_bf16_f32 v20, v128, v129
v_cvt_pk_bf16_f32 v21, v130, v131
v_mfma_f32_16x16x32_bf16 a[204:207], v[104:107], v[208:211], a[204:207]
ds_read_b64_tr_b16 v[208:209], v13 offset:12288
ds_read_b64_tr_b16 v[210:211], v13 offset:14336
v_mfma_f32_16x16x32_bf16 a[204:207], v[188:191], v[212:215], a[204:207]
ds_read_b64_tr_b16 v[212:213], v13 offset:28672
s_waitcnt lgkmcnt(3)
v_mfma_f32_16x16x32_bf16 a[192:195], v[160:163], v[216:219], a[192:195]
ds_read_b64_tr_b16 v[214:215], v13 offset:30720
v_accvgpr_read_b32 v136, a164
v_mfma_f32_16x16x32_bf16 a[192:195], v[0:3], v[220:223], a[192:195]
v_accvgpr_read_b32 v137, a165
v_accvgpr_read_b32 v138, a166
v_mfma_f32_16x16x32_bf16 a[196:199], v[164:167], v[216:219], a[196:199]
v_accvgpr_read_b32 v139, a167
v_cvt_pk_bf16_f32 v52, v136, v137
v_mfma_f32_16x16x32_bf16 a[196:199], v[32:35], v[220:223], a[196:199]
v_cvt_pk_bf16_f32 v53, v138, v139
v_accvgpr_read_b32 v144, a168
v_mfma_f32_16x16x32_bf16 a[200:203], v[168:171], v[216:219], a[200:203]
v_accvgpr_read_b32 v145, a169
v_accvgpr_read_b32 v146, a170
v_mfma_f32_16x16x32_bf16 a[200:203], v[64:67], v[220:223], a[200:203]
v_accvgpr_read_b32 v147, a171
v_cvt_pk_bf16_f32 v84, v144, v145
v_mfma_f32_16x16x32_bf16 a[204:207], v[172:175], v[216:219], a[204:207]
ds_read_b64_tr_b16 v[216:217], v15 offset:12288
ds_read_b64_tr_b16 v[218:219], v15 offset:14336
v_mfma_f32_16x16x32_bf16 a[204:207], v[96:99], v[220:223], a[204:207]
ds_read_b64_tr_b16 v[220:221], v15 offset:28672
s_waitcnt lgkmcnt(3)
v_mfma_f32_16x16x32_bf16 a[208:211], v[8:11], v[208:211], a[208:211]
ds_read_b64_tr_b16 v[222:223], v15 offset:30720
v_cvt_pk_bf16_f32 v85, v146, v147
v_mfma_f32_16x16x32_bf16 a[208:211], v[176:179], v[212:215], a[208:211]
v_accvgpr_read_b32 v152, a172
v_accvgpr_read_b32 v153, a173
v_mfma_f32_16x16x32_bf16 a[212:215], v[40:43], v[208:211], a[212:215]
v_accvgpr_read_b32 v154, a174
v_accvgpr_read_b32 v155, a175
v_mfma_f32_16x16x32_bf16 a[212:215], v[180:183], v[212:215], a[212:215]
v_cvt_pk_bf16_f32 v116, v152, v153
v_cvt_pk_bf16_f32 v117, v154, v155
v_mfma_f32_16x16x32_bf16 a[216:219], v[72:75], v[208:211], a[216:219]
v_accvgpr_read_b32 v132, a176
v_accvgpr_read_b32 v133, a177
v_mfma_f32_16x16x32_bf16 a[216:219], v[184:187], v[212:215], a[216:219]
v_accvgpr_read_b32 v134, a178
v_accvgpr_read_b32 v135, a179
v_mfma_f32_16x16x32_bf16 a[220:223], v[104:107], v[208:211], a[220:223]
ds_read_b64_tr_b16 v[208:209], v12 offset:12800
ds_read_b64_tr_b16 v[210:211], v12 offset:14848
v_mfma_f32_16x16x32_bf16 a[220:223], v[188:191], v[212:215], a[220:223]
ds_read_b64_tr_b16 v[212:213], v12 offset:29184
s_waitcnt lgkmcnt(3)
v_mfma_f32_16x16x32_bf16 a[208:211], v[160:163], v[216:219], a[208:211]
ds_read_b64_tr_b16 v[214:215], v12 offset:31232
v_cvt_pk_bf16_f32 v22, v132, v133
v_mfma_f32_16x16x32_bf16 a[208:211], v[0:3], v[220:223], a[208:211]
v_cvt_pk_bf16_f32 v23, v134, v135
buffer_store_dwordx4 v[20:23], v248, s[20:23], s44 offen offset:1024 sc1
v_mfma_f32_16x16x32_bf16 a[212:215], v[164:167], v[216:219], a[212:215]
ds_write_b128 v253, v[20:23] offset:5120
v_accvgpr_read_b32 v140, a180
v_mfma_f32_16x16x32_bf16 a[212:215], v[32:35], v[220:223], a[212:215]
v_accvgpr_read_b32 v141, a181
v_accvgpr_read_b32 v142, a182
v_mfma_f32_16x16x32_bf16 a[216:219], v[168:171], v[216:219], a[216:219]
v_accvgpr_read_b32 v143, a183
v_cvt_pk_bf16_f32 v54, v140, v141
v_mfma_f32_16x16x32_bf16 a[216:219], v[64:67], v[220:223], a[216:219]
v_cvt_pk_bf16_f32 v55, v142, v143
buffer_store_dwordx4 v[52:55], v248, s[20:23], s45 offen offset:1024 sc1
v_mfma_f32_16x16x32_bf16 a[220:223], v[172:175], v[216:219], a[220:223]
ds_read_b64_tr_b16 v[216:217], v14 offset:12800
ds_read_b64_tr_b16 v[218:219], v14 offset:14848
v_mfma_f32_16x16x32_bf16 a[220:223], v[96:99], v[220:223], a[220:223]
ds_read_b64_tr_b16 v[220:221], v14 offset:29184
s_waitcnt lgkmcnt(3)
v_mfma_f32_16x16x32_bf16 a[224:227], v[8:11], v[208:211], a[224:227]
ds_read_b64_tr_b16 v[222:223], v14 offset:31232
v_accvgpr_read_b32 v148, a184
v_mfma_f32_16x16x32_bf16 a[224:227], v[176:179], v[212:215], a[224:227]
v_accvgpr_read_b32 v149, a185
v_accvgpr_read_b32 v150, a186
v_mfma_f32_16x16x32_bf16 a[228:231], v[40:43], v[208:211], a[228:231]
v_accvgpr_read_b32 v151, a187
v_cvt_pk_bf16_f32 v86, v148, v149
v_mfma_f32_16x16x32_bf16 a[228:231], v[180:183], v[212:215], a[228:231]
v_cvt_pk_bf16_f32 v87, v150, v151
buffer_store_dwordx4 v[84:87], v248, s[20:23], s46 offen offset:1024 sc1
v_mfma_f32_16x16x32_bf16 a[232:235], v[72:75], v[208:211], a[232:235]
v_accvgpr_read_b32 v156, a188
v_accvgpr_read_b32 v157, a189
v_mfma_f32_16x16x32_bf16 a[232:235], v[184:187], v[212:215], a[232:235]
v_accvgpr_read_b32 v158, a190
v_accvgpr_read_b32 v159, a191
v_mfma_f32_16x16x32_bf16 a[236:239], v[104:107], v[208:211], a[236:239]
ds_read_b64_tr_b16 v[208:209], v13 offset:12800
ds_read_b64_tr_b16 v[210:211], v13 offset:14848
v_mfma_f32_16x16x32_bf16 a[236:239], v[188:191], v[212:215], a[236:239]
ds_read_b64_tr_b16 v[212:213], v13 offset:29184
s_waitcnt lgkmcnt(3)
v_mfma_f32_16x16x32_bf16 a[224:227], v[160:163], v[216:219], a[224:227]
ds_read_b64_tr_b16 v[214:215], v13 offset:31232
v_cvt_pk_bf16_f32 v118, v156, v157
v_mfma_f32_16x16x32_bf16 a[224:227], v[0:3], v[220:223], a[224:227]
v_cvt_pk_bf16_f32 v119, v158, v159
buffer_store_dwordx4 v[116:119], v248, s[20:23], s47 offen offset:1024 sc1
v_mfma_f32_16x16x32_bf16 a[228:231], v[164:167], v[216:219], a[228:231]
v_accvgpr_read_b32 v128, a192
v_accvgpr_read_b32 v129, a193
v_mfma_f32_16x16x32_bf16 a[228:231], v[32:35], v[220:223], a[228:231]
v_accvgpr_read_b32 v130, a194
v_accvgpr_read_b32 v131, a195
v_mfma_f32_16x16x32_bf16 a[232:235], v[168:171], v[216:219], a[232:235]
v_cvt_pk_bf16_f32 v24, v128, v129
v_cvt_pk_bf16_f32 v25, v130, v131
v_mfma_f32_16x16x32_bf16 a[232:235], v[64:67], v[220:223], a[232:235]
v_accvgpr_read_b32 v136, a196
v_accvgpr_read_b32 v137, a197
v_mfma_f32_16x16x32_bf16 a[236:239], v[172:175], v[216:219], a[236:239]
ds_read_b64_tr_b16 v[216:217], v15 offset:12800
ds_read_b64_tr_b16 v[218:219], v15 offset:14848
v_mfma_f32_16x16x32_bf16 a[236:239], v[96:99], v[220:223], a[236:239]
ds_read_b64_tr_b16 v[220:221], v15 offset:29184
s_waitcnt lgkmcnt(3)
v_mfma_f32_16x16x32_bf16 a[240:243], v[8:11], v[208:211], a[240:243]
ds_read_b64_tr_b16 v[222:223], v15 offset:31232
v_accvgpr_read_b32 v138, a198
v_mfma_f32_16x16x32_bf16 a[240:243], v[176:179], v[212:215], a[240:243]
v_accvgpr_read_b32 v139, a199
v_cvt_pk_bf16_f32 v56, v136, v137
v_mfma_f32_16x16x32_bf16 a[244:247], v[40:43], v[208:211], a[244:247]
v_cvt_pk_bf16_f32 v57, v138, v139
v_accvgpr_read_b32 v144, a200
v_mfma_f32_16x16x32_bf16 a[244:247], v[180:183], v[212:215], a[244:247]
v_accvgpr_read_b32 v145, a201
v_accvgpr_read_b32 v146, a202
v_mfma_f32_16x16x32_bf16 a[248:251], v[72:75], v[208:211], a[248:251]
v_accvgpr_read_b32 v147, a203
v_cvt_pk_bf16_f32 v88, v144, v145
v_mfma_f32_16x16x32_bf16 a[248:251], v[184:187], v[212:215], a[248:251]
v_cvt_pk_bf16_f32 v89, v146, v147
v_accvgpr_read_b32 v152, a204
v_mfma_f32_16x16x32_bf16 a[252:255], v[104:107], v[208:211], a[252:255]
v_accvgpr_read_b32 v153, a205
v_accvgpr_read_b32 v154, a206
v_mfma_f32_16x16x32_bf16 a[252:255], v[188:191], v[212:215], a[252:255]
s_waitcnt lgkmcnt(0)
v_accvgpr_read_b32 v155, a207
v_mfma_f32_16x16x32_bf16 a[240:243], v[160:163], v[216:219], a[240:243]
v_cvt_pk_bf16_f32 v120, v152, v153
v_cvt_pk_bf16_f32 v121, v154, v155
v_mfma_f32_16x16x32_bf16 a[240:243], v[0:3], v[220:223], a[240:243]
v_accvgpr_read_b32 v132, a208
v_accvgpr_read_b32 v133, a209
v_mfma_f32_16x16x32_bf16 a[244:247], v[164:167], v[216:219], a[244:247]
v_accvgpr_read_b32 v134, a210
v_accvgpr_read_b32 v135, a211
v_mfma_f32_16x16x32_bf16 a[244:247], v[32:35], v[220:223], a[244:247]
v_cvt_pk_bf16_f32 v26, v132, v133
v_cvt_pk_bf16_f32 v27, v134, v135
v_mfma_f32_16x16x32_bf16 a[248:251], v[168:171], v[216:219], a[248:251]
buffer_store_dwordx4 v[24:27], v248, s[20:23], s44 offen offset:2048 sc1
ds_write_b128 v253, v[24:27] offset:6144
v_mfma_f32_16x16x32_bf16 a[248:251], v[64:67], v[220:223], a[248:251]
v_accvgpr_read_b32 v140, a212
v_accvgpr_read_b32 v141, a213
v_mfma_f32_16x16x32_bf16 a[252:255], v[172:175], v[216:219], a[252:255]
v_accvgpr_read_b32 v142, a214
v_accvgpr_read_b32 v143, a215
v_mfma_f32_16x16x32_bf16 a[252:255], v[96:99], v[220:223], a[252:255]
v_cvt_pk_bf16_f32 v58, v140, v141
v_cvt_pk_bf16_f32 v59, v142, v143
buffer_store_dwordx4 v[56:59], v248, s[20:23], s45 offen offset:2048 sc1
v_accvgpr_read_b32 v148, a216
v_accvgpr_read_b32 v149, a217
v_accvgpr_read_b32 v150, a218
v_accvgpr_read_b32 v151, a219
v_cvt_pk_bf16_f32 v90, v148, v149
v_cvt_pk_bf16_f32 v91, v150, v151
buffer_store_dwordx4 v[88:91], v248, s[20:23], s46 offen offset:2048 sc1
v_accvgpr_read_b32 v156, a220
v_accvgpr_read_b32 v157, a221
v_accvgpr_read_b32 v158, a222
v_accvgpr_read_b32 v159, a223
v_cvt_pk_bf16_f32 v122, v156, v157
v_cvt_pk_bf16_f32 v123, v158, v159
buffer_store_dwordx4 v[120:123], v248, s[20:23], s47 offen offset:2048 sc1
v_accvgpr_read_b32 v128, a224
v_accvgpr_read_b32 v129, a225
v_accvgpr_read_b32 v130, a226
v_accvgpr_read_b32 v131, a227
v_cvt_pk_bf16_f32 v28, v128, v129
v_cvt_pk_bf16_f32 v29, v130, v131
v_accvgpr_read_b32 v136, a228
v_accvgpr_read_b32 v137, a229
v_accvgpr_read_b32 v138, a230
v_accvgpr_read_b32 v139, a231
v_cvt_pk_bf16_f32 v60, v136, v137
v_cvt_pk_bf16_f32 v61, v138, v139
v_accvgpr_read_b32 v144, a232
v_accvgpr_read_b32 v145, a233
v_accvgpr_read_b32 v146, a234
v_accvgpr_read_b32 v147, a235
v_cvt_pk_bf16_f32 v92, v144, v145
v_cvt_pk_bf16_f32 v93, v146, v147
v_accvgpr_read_b32 v152, a236
v_accvgpr_read_b32 v153, a237
v_accvgpr_read_b32 v154, a238
v_accvgpr_read_b32 v155, a239
v_cvt_pk_bf16_f32 v124, v152, v153
v_cvt_pk_bf16_f32 v125, v154, v155
v_accvgpr_read_b32 v132, a240
v_accvgpr_read_b32 v133, a241
v_accvgpr_read_b32 v134, a242
v_accvgpr_read_b32 v135, a243
v_cvt_pk_bf16_f32 v30, v132, v133
v_cvt_pk_bf16_f32 v31, v134, v135
buffer_store_dwordx4 v[28:31], v248, s[20:23], s44 offen offset:3072 sc1
ds_write_b128 v253, v[28:31] offset:7168
v_accvgpr_read_b32 v140, a244
v_accvgpr_read_b32 v141, a245
v_accvgpr_read_b32 v142, a246
v_accvgpr_read_b32 v143, a247
v_cvt_pk_bf16_f32 v62, v140, v141
v_cvt_pk_bf16_f32 v63, v142, v143
buffer_store_dwordx4 v[60:63], v248, s[20:23], s45 offen offset:3072 sc1
v_accvgpr_read_b32 v148, a248
v_accvgpr_read_b32 v149, a249
v_accvgpr_read_b32 v150, a250
v_accvgpr_read_b32 v151, a251
v_cvt_pk_bf16_f32 v94, v148, v149
v_cvt_pk_bf16_f32 v95, v150, v151
buffer_store_dwordx4 v[92:95], v248, s[20:23], s46 offen offset:3072 sc1
v_accvgpr_read_b32 v156, a252
v_accvgpr_read_b32 v157, a253
v_accvgpr_read_b32 v158, a254
v_accvgpr_read_b32 v159, a255
v_cvt_pk_bf16_f32 v126, v156, v157
v_cvt_pk_bf16_f32 v127, v158, v159
buffer_store_dwordx4 v[124:127], v248, s[20:23], s47 offen offset:3072 sc1
s_waitcnt vmcnt(36)
s_branch L2_F
L2_tail_1:
s_waitcnt lgkmcnt(2)
v_add_u32 v253, s50, v248
v_mfma_f32_16x16x32_bf16 v[144:147], v[208:211], v[0:3], v[192:195]
s_mov_b32 m0, s30
ds_write_b128 v253, v[160:163] offset:0
v_mfma_f32_16x16x32_bf16 v[144:147], v[212:215], v[4:7], v[144:147]
buffer_load_dwordx4 v241, s[12:15], s28 offen offset:0 sc1 lds
ds_write_b128 v253, v[164:167] offset:1024
v_mfma_f32_16x16x32_bf16 v[148:151], v[208:211], v[32:35], v[196:199]
buffer_load_dwordx4 v241, s[12:15], s28 offen offset:1024 sc1 lds
ds_write_b128 v253, v[168:171] offset:2048
v_mfma_f32_16x16x32_bf16 v[148:151], v[212:215], v[36:39], v[148:151]
buffer_load_dwordx4 v241, s[12:15], s28 offen offset:2048 sc1 lds
ds_write_b128 v253, v[172:175] offset:3072
v_mfma_f32_16x16x32_bf16 v[152:155], v[208:211], v[64:67], v[200:203]
buffer_load_dwordx4 v241, s[12:15], s28 offen offset:3072 sc1 lds
v_add_u32 v251, 0x8000, v240
v_and_b32 v251, 0x1ffff, v251
v_mfma_f32_16x16x32_bf16 v[152:155], v[212:215], v[68:71], v[152:155]
v_exp_f32 v232, v128
v_mfma_f32_16x16x32_bf16 v[156:159], v[208:211], v[96:99], v[204:207]
ds_read_b128 v[208:211], v240 offset:10240
v_exp_f32 v233, v129
v_mfma_f32_16x16x32_bf16 v[156:159], v[212:215], v[100:103], v[156:159]
ds_read_b128 v[212:215], v240 offset:10752
s_waitcnt lgkmcnt(2)
s_and_b32 s30, s30, 0x1c000
v_mfma_f32_16x16x32_bf16 v[144:147], v[216:219], v[8:11], v[144:147]
v_exp_f32 v234, v130
v_add_f32 v228, v224, v232
v_mfma_f32_16x16x32_bf16 v[144:147], v[220:223], v[12:15], v[144:147]
v_cvt_pk_bf16_f32 v160, v232, v233
v_exp_f32 v235, v131
v_mfma_f32_16x16x32_bf16 v[148:151], v[216:219], v[40:43], v[148:151]
v_add_f32 v228, v228, v233
v_add_f32 v228, v228, v234
v_add_f32 v228, v228, v235
v_mfma_f32_16x16x32_bf16 v[148:151], v[220:223], v[44:47], v[148:151]
v_cvt_pk_bf16_f32 v161, v234, v235
v_exp_f32 v236, v132
v_mfma_f32_16x16x32_bf16 v[152:155], v[216:219], v[72:75], v[152:155]
v_exp_f32 v237, v133
s_add_u32 s28, s30, 0x4000
v_mfma_f32_16x16x32_bf16 v[152:155], v[220:223], v[76:79], v[152:155]
v_exp_f32 v238, v134
v_add_f32 v229, v225, v236
v_mfma_f32_16x16x32_bf16 v[156:159], v[216:219], v[104:107], v[156:159]
ds_read_b128 v[216:219], v240 offset:14336
v_cvt_pk_bf16_f32 v164, v236, v237
s_and_b32 s28, s28, 0x1ffff
v_mfma_f32_16x16x32_bf16 v[156:159], v[220:223], v[108:111], v[156:159]
ds_read_b128 v[220:223], v240 offset:14848
s_waitcnt lgkmcnt(2)
s_add_u32 s30, s30, 0x8000
v_mfma_f32_16x16x32_bf16 v[144:147], v[208:211], v[16:19], v[144:147]
v_exp_f32 v239, v135
v_add_f32 v229, v229, v237
v_mfma_f32_16x16x32_bf16 v[144:147], v[212:215], v[20:23], v[144:147]
s_waitcnt vmcnt(4)
s_barrier
v_add_f32 v229, v229, v238
v_mfma_f32_16x16x32_bf16 v[148:151], v[208:211], v[48:51], v[148:151]
v_add_f32 v229, v229, v239
v_cvt_pk_bf16_f32 v165, v238, v239
s_and_b32 s30, s30, 0x1ffff
v_mfma_f32_16x16x32_bf16 v[148:151], v[212:215], v[52:55], v[148:151]
v_exp_f32 v232, v136
s_mul_i32 s31, s34, 6144
v_mfma_f32_16x16x32_bf16 v[152:155], v[208:211], v[80:83], v[152:155]
v_exp_f32 v233, v137
s_add_u32 s31, s31, s30
v_mfma_f32_16x16x32_bf16 v[152:155], v[212:215], v[84:87], v[152:155]
v_exp_f32 v234, v138
v_add_f32 v230, v226, v232
v_mfma_f32_16x16x32_bf16 v[156:159], v[208:211], v[112:115], v[156:159]
ds_read_b128 v[208:211], v240 offset:16384
v_cvt_pk_bf16_f32 v168, v232, v233
s_lshl_b32 s3, s34, 10
v_mfma_f32_16x16x32_bf16 v[156:159], v[212:215], v[116:119], v[156:159]
ds_read_b128 v[212:215], v240 offset:16896
s_waitcnt lgkmcnt(2)
s_add_u32 s28, s28, s3
v_mfma_f32_16x16x32_bf16 v[144:147], v[216:219], v[24:27], v[144:147]
v_exp_f32 v235, v139
v_add_f32 v230, v230, v233
v_mfma_f32_16x16x32_bf16 v[144:147], v[220:223], v[28:31], v[144:147]
v_add_f32 v230, v230, v234
v_add_f32 v230, v230, v235
v_cvt_pk_bf16_f32 v169, v234, v235
v_mfma_f32_16x16x32_bf16 v[148:151], v[216:219], v[56:59], v[148:151]
v_exp_f32 v236, v140
s_add_u32 s3, s3, 24576
v_mfma_f32_16x16x32_bf16 v[148:151], v[220:223], v[60:63], v[148:151]
v_exp_f32 v237, v141
s_add_u32 s30, s30, s3
v_mfma_f32_16x16x32_bf16 v[152:155], v[216:219], v[88:91], v[152:155]
v_exp_f32 v238, v142
v_add_f32 v231, v227, v236
v_mfma_f32_16x16x32_bf16 v[152:155], v[220:223], v[92:95], v[152:155]
v_cvt_pk_bf16_f32 v172, v236, v237
v_exp_f32 v239, v143
v_mfma_f32_16x16x32_bf16 v[156:159], v[216:219], v[120:123], v[156:159]
ds_read_b128 v[216:219], v240 offset:20480
v_add_f32 v231, v231, v237
v_add_f32 v231, v231, v238
v_mfma_f32_16x16x32_bf16 v[156:159], v[220:223], v[124:127], v[156:159]
ds_read_b128 v[220:223], v240 offset:20992
s_waitcnt lgkmcnt(2)
v_add_f32 v231, v231, v239
v_cvt_pk_bf16_f32 v173, v238, v239
v_max3_f32 v242, v228, v229, v230
v_max_f32 v242, v242, v231
v_cmp_lt_f32 vcc, s32, v242
s_cbranch_vccnz L2_rare_site12
L2_ret12:
v_mfma_f32_16x16x32_bf16 v[128:131], v[208:211], v[0:3], v[192:195]
v_lshrrev_b32 v241, 4, v248
v_and_b32 v241, 0x30, v241
v_xor_b32 v241, v241, v248
v_and_b32 v243, 0x380, v248
v_mad_u32_u24 v241, v243, 3, v241
v_mfma_f32_16x16x32_bf16 v[128:131], v[212:215], v[4:7], v[128:131]
v_exp_f32 v232, v144
v_mfma_f32_16x16x32_bf16 v[132:135], v[208:211], v[32:35], v[196:199]
v_exp_f32 v233, v145
v_mfma_f32_16x16x32_bf16 v[132:135], v[212:215], v[36:39], v[132:135]
v_exp_f32 v234, v146
v_add_f32 v224, v228, v232
v_mfma_f32_16x16x32_bf16 v[136:139], v[208:211], v[64:67], v[200:203]
v_cvt_pk_bf16_f32 v162, v232, v233
v_exp_f32 v235, v147
v_mfma_f32_16x16x32_bf16 v[136:139], v[212:215], v[68:71], v[136:139]
v_add_f32 v224, v224, v233
v_add_f32 v224, v224, v234
v_add_f32 v224, v224, v235
v_mfma_f32_16x16x32_bf16 v[140:143], v[208:211], v[96:99], v[204:207]
ds_read_b128 v[208:211], v240 offset:24576
v_cvt_pk_bf16_f32 v163, v234, v235
v_mfma_f32_16x16x32_bf16 v[140:143], v[212:215], v[100:103], v[140:143]
ds_read_b128 v[212:215], v240 offset:25088
s_waitcnt lgkmcnt(2)
v_mfma_f32_16x16x32_bf16 v[128:131], v[216:219], v[8:11], v[128:131]
ds_write_b128 v253, v[176:179] offset:4096
v_exp_f32 v236, v148
v_mfma_f32_16x16x32_bf16 v[128:131], v[220:223], v[12:15], v[128:131]
ds_write_b128 v253, v[180:183] offset:5120
v_exp_f32 v237, v149
v_mfma_f32_16x16x32_bf16 v[132:135], v[216:219], v[40:43], v[132:135]
ds_write_b128 v253, v[184:187] offset:6144
v_exp_f32 v238, v150
v_mfma_f32_16x16x32_bf16 v[132:135], v[220:223], v[44:47], v[132:135]
ds_write_b128 v253, v[188:191] offset:7168
v_add_f32 v225, v229, v236
v_cvt_pk_bf16_f32 v166, v236, v237
v_mfma_f32_16x16x32_bf16 v[136:139], v[216:219], v[72:75], v[136:139]
v_exp_f32 v239, v151
v_add_f32 v225, v225, v237
v_mfma_f32_16x16x32_bf16 v[136:139], v[220:223], v[76:79], v[136:139]
v_add_f32 v225, v225, v238
v_add_f32 v225, v225, v239
v_cvt_pk_bf16_f32 v167, v238, v239
v_mfma_f32_16x16x32_bf16 v[140:143], v[216:219], v[104:107], v[140:143]
ds_read_b128 v[216:219], v240 offset:28672
v_exp_f32 v232, v152
v_mfma_f32_16x16x32_bf16 v[140:143], v[220:223], v[108:111], v[140:143]
ds_read_b128 v[220:223], v240 offset:29184
s_waitcnt lgkmcnt(2)
v_mfma_f32_16x16x32_bf16 v[128:131], v[208:211], v[16:19], v[128:131]
v_exp_f32 v233, v153
v_mfma_f32_16x16x32_bf16 v[128:131], v[212:215], v[20:23], v[128:131]
v_exp_f32 v234, v154
v_add_f32 v226, v230, v232
v_mfma_f32_16x16x32_bf16 v[132:135], v[208:211], v[48:51], v[132:135]
v_cvt_pk_bf16_f32 v170, v232, v233
v_exp_f32 v235, v155
v_mfma_f32_16x16x32_bf16 v[132:135], v[212:215], v[52:55], v[132:135]
v_add_f32 v226, v226, v233
v_add_f32 v226, v226, v234
v_add_f32 v226, v226, v235
v_mfma_f32_16x16x32_bf16 v[136:139], v[208:211], v[80:83], v[136:139]
v_cvt_pk_bf16_f32 v171, v234, v235
v_exp_f32 v236, v156
v_mfma_f32_16x16x32_bf16 v[136:139], v[212:215], v[84:87], v[136:139]
v_exp_f32 v237, v157
v_mfma_f32_16x16x32_bf16 v[140:143], v[208:211], v[112:115], v[140:143]
ds_read_b128 v[208:211], v240 offset:18432
v_exp_f32 v238, v158
v_mfma_f32_16x16x32_bf16 v[140:143], v[212:215], v[116:119], v[140:143]
ds_read_b128 v[212:215], v240 offset:18944
s_waitcnt lgkmcnt(2)
v_add_f32 v227, v231, v236
v_mfma_f32_16x16x32_bf16 v[128:131], v[216:219], v[24:27], v[128:131]
v_cvt_pk_bf16_f32 v174, v236, v237
v_exp_f32 v239, v159
v_mfma_f32_16x16x32_bf16 v[128:131], v[220:223], v[28:31], v[128:131]
v_add_f32 v227, v227, v237
v_add_f32 v227, v227, v238
v_add_f32 v227, v227, v239
v_mfma_f32_16x16x32_bf16 v[132:135], v[216:219], v[56:59], v[132:135]
v_cvt_pk_bf16_f32 v175, v238, v239
v_max3_f32 v242, v224, v225, v226
v_max_f32 v242, v242, v227
v_mfma_f32_16x16x32_bf16 v[132:135], v[220:223], v[60:63], v[132:135]
v_cmp_lt_f32 vcc, s32, v242
s_cbranch_vccnz L2_rare_site13
L2_ret13:
v_mfma_f32_16x16x32_bf16 v[136:139], v[216:219], v[88:91], v[136:139]
s_add_u32 m0, s31, 0
v_mfma_f32_16x16x32_bf16 v[136:139], v[220:223], v[92:95], v[136:139]
buffer_load_dwordx4 v241, s[8:11], s6 offen lds
s_add_u32 m0, s31, 2048
v_mfma_f32_16x16x32_bf16 v[140:143], v[216:219], v[120:123], v[140:143]
ds_read_b128 v[216:219], v240 offset:22528
buffer_load_dwordx4 v241, s[8:11], s7 offen lds
s_add_u32 m0, s31, 4096
v_mfma_f32_16x16x32_bf16 v[140:143], v[220:223], v[124:127], v[140:143]
ds_read_b128 v[220:223], v240 offset:23040
s_waitcnt lgkmcnt(2)
v_mfma_f32_16x16x32_bf16 v[144:147], v[208:211], v[0:3], v[192:195]
buffer_load_dwordx4 v241, s[8:11], s29 offen lds
s_add_u32 m0, s31, 1024
v_xor_b32 v241, 0x1040, v241
v_mfma_f32_16x16x32_bf16 v[144:147], v[212:215], v[4:7], v[144:147]
v_exp_f32 v232, v128
v_mfma_f32_16x16x32_bf16 v[148:151], v[208:211], v[32:35], v[196:199]
v_exp_f32 v233, v129
v_mfma_f32_16x16x32_bf16 v[148:151], v[212:215], v[36:39], v[148:151]
v_exp_f32 v234, v130
v_add_f32 v228, v224, v232
v_mfma_f32_16x16x32_bf16 v[152:155], v[208:211], v[64:67], v[200:203]
v_cvt_pk_bf16_f32 v176, v232, v233
v_exp_f32 v235, v131
v_mfma_f32_16x16x32_bf16 v[152:155], v[212:215], v[68:71], v[152:155]
v_add_f32 v228, v228, v233
v_add_f32 v228, v228, v234
v_add_f32 v228, v228, v235
v_mfma_f32_16x16x32_bf16 v[156:159], v[208:211], v[96:99], v[204:207]
ds_read_b128 v[208:211], v240 offset:26624
v_cvt_pk_bf16_f32 v177, v234, v235
v_mfma_f32_16x16x32_bf16 v[156:159], v[212:215], v[100:103], v[156:159]
ds_read_b128 v[212:215], v240 offset:27136
s_waitcnt lgkmcnt(2)
v_mfma_f32_16x16x32_bf16 v[144:147], v[216:219], v[8:11], v[144:147]
v_exp_f32 v236, v132
v_mfma_f32_16x16x32_bf16 v[144:147], v[220:223], v[12:15], v[144:147]
v_exp_f32 v237, v133
v_mfma_f32_16x16x32_bf16 v[148:151], v[216:219], v[40:43], v[148:151]
v_exp_f32 v238, v134
v_add_f32 v229, v225, v236
v_mfma_f32_16x16x32_bf16 v[148:151], v[220:223], v[44:47], v[148:151]
v_cvt_pk_bf16_f32 v180, v236, v237
v_exp_f32 v239, v135
v_mfma_f32_16x16x32_bf16 v[152:155], v[216:219], v[72:75], v[152:155]
v_add_f32 v229, v229, v237
v_add_f32 v229, v229, v238
v_add_f32 v229, v229, v239
v_mfma_f32_16x16x32_bf16 v[152:155], v[220:223], v[76:79], v[152:155]
v_cvt_pk_bf16_f32 v181, v238, v239
v_exp_f32 v232, v136
v_mfma_f32_16x16x32_bf16 v[156:159], v[216:219], v[104:107], v[156:159]
ds_read_b128 v[216:219], v240 offset:30720
v_exp_f32 v233, v137
v_mfma_f32_16x16x32_bf16 v[156:159], v[220:223], v[108:111], v[156:159]
ds_read_b128 v[220:223], v240 offset:31232
s_waitcnt lgkmcnt(2)
v_mfma_f32_16x16x32_bf16 v[144:147], v[208:211], v[16:19], v[144:147]
v_exp_f32 v234, v138
v_add_f32 v230, v226, v232
v_mfma_f32_16x16x32_bf16 v[144:147], v[212:215], v[20:23], v[144:147]
s_waitcnt vmcnt(3)
s_barrier
v_cvt_pk_bf16_f32 v184, v232, v233
v_mfma_f32_16x16x32_bf16 v[148:151], v[208:211], v[48:51], v[148:151]
v_exp_f32 v235, v139
v_add_f32 v230, v230, v233
v_mfma_f32_16x16x32_bf16 v[148:151], v[212:215], v[52:55], v[148:151]
v_add_f32 v230, v230, v234
v_add_f32 v230, v230, v235
v_cvt_pk_bf16_f32 v185, v234, v235
v_mfma_f32_16x16x32_bf16 v[152:155], v[208:211], v[80:83], v[152:155]
v_exp_f32 v236, v140
v_mfma_f32_16x16x32_bf16 v[152:155], v[212:215], v[84:87], v[152:155]
v_exp_f32 v237, v141
v_mfma_f32_16x16x32_bf16 v[156:159], v[208:211], v[112:115], v[156:159]
ds_read_b128 v[208:211], v251 offset:0
v_exp_f32 v238, v142
v_mfma_f32_16x16x32_bf16 v[156:159], v[212:215], v[116:119], v[156:159]
ds_read_b128 v[212:215], v251 offset:512
s_waitcnt lgkmcnt(2)
v_add_f32 v231, v227, v236
v_mfma_f32_16x16x32_bf16 v[144:147], v[216:219], v[24:27], v[144:147]
v_cvt_pk_bf16_f32 v188, v236, v237
v_exp_f32 v239, v143
v_mfma_f32_16x16x32_bf16 v[144:147], v[220:223], v[28:31], v[144:147]
v_add_f32 v231, v231, v237
v_add_f32 v231, v231, v238
v_add_f32 v231, v231, v239
v_mfma_f32_16x16x32_bf16 v[148:151], v[216:219], v[56:59], v[148:151]
v_cvt_pk_bf16_f32 v189, v238, v239
v_max3_f32 v242, v228, v229, v230
v_max_f32 v242, v242, v231
v_mfma_f32_16x16x32_bf16 v[148:151], v[220:223], v[60:63], v[148:151]
v_cmp_lt_f32 vcc, s32, v242
s_cbranch_vccnz L2_rare_site14
L2_ret14:
v_mfma_f32_16x16x32_bf16 v[152:155], v[216:219], v[88:91], v[152:155]
buffer_load_dwordx4 v241, s[8:11], s6 offen lds
s_add_u32 m0, s31, 3072
v_mfma_f32_16x16x32_bf16 v[152:155], v[220:223], v[92:95], v[152:155]
buffer_load_dwordx4 v241, s[8:11], s7 offen lds
s_add_u32 m0, s31, 5120
v_mfma_f32_16x16x32_bf16 v[156:159], v[216:219], v[120:123], v[156:159]
ds_read_b128 v[216:219], v251 offset:4096
buffer_load_dwordx4 v241, s[8:11], s29 offen lds
v_mfma_f32_16x16x32_bf16 v[156:159], v[220:223], v[124:127], v[156:159]
ds_read_b128 v[220:223], v251 offset:4608
s_waitcnt lgkmcnt(2)
v_mfma_f32_16x16x32_bf16 v[128:131], v[208:211], v[0:3], v[192:195]
v_mfma_f32_16x16x32_bf16 v[128:131], v[212:215], v[4:7], v[128:131]
v_exp_f32 v232, v144
v_mfma_f32_16x16x32_bf16 v[132:135], v[208:211], v[32:35], v[196:199]
v_exp_f32 v233, v145
v_mfma_f32_16x16x32_bf16 v[132:135], v[212:215], v[36:39], v[132:135]
v_exp_f32 v234, v146
v_add_f32 v224, v228, v232
v_mfma_f32_16x16x32_bf16 v[136:139], v[208:211], v[64:67], v[200:203]
v_cvt_pk_bf16_f32 v178, v232, v233
v_exp_f32 v235, v147
v_mfma_f32_16x16x32_bf16 v[136:139], v[212:215], v[68:71], v[136:139]
v_add_f32 v224, v224, v233
v_add_f32 v224, v224, v234
v_add_f32 v224, v224, v235
v_mfma_f32_16x16x32_bf16 v[140:143], v[208:211], v[96:99], v[204:207]
ds_read_b128 v[208:211], v251 offset:8192
v_cvt_pk_bf16_f32 v179, v234, v235
v_lshlrev_b32 v241, 3, v248
v_mfma_f32_16x16x32_bf16 v[140:143], v[212:215], v[100:103], v[140:143]
ds_read_b128 v[212:215], v251 offset:8704
s_waitcnt lgkmcnt(2)
s_mov_b32 s3, 0x7c28000
v_mfma_f32_16x16x32_bf16 v[128:131], v[216:219], v[8:11], v[128:131]
v_exp_f32 v236, v148
buffer_load_dwordx2 v[240:241], v241, s[16:19], s3 offen sc1
v_mfma_f32_16x16x32_bf16 v[128:131], v[220:223], v[12:15], v[128:131]
v_exp_f32 v237, v149
v_mfma_f32_16x16x32_bf16 v[132:135], v[216:219], v[40:43], v[132:135]
v_exp_f32 v238, v150
v_add_f32 v225, v229, v236
v_mfma_f32_16x16x32_bf16 v[132:135], v[220:223], v[44:47], v[132:135]
v_cvt_pk_bf16_f32 v182, v236, v237
v_exp_f32 v239, v151
v_mfma_f32_16x16x32_bf16 v[136:139], v[216:219], v[72:75], v[136:139]
v_add_f32 v225, v225, v237
v_add_f32 v225, v225, v238
v_add_f32 v225, v225, v239
v_mfma_f32_16x16x32_bf16 v[136:139], v[220:223], v[76:79], v[136:139]
v_cvt_pk_bf16_f32 v183, v238, v239
v_exp_f32 v232, v152
v_mfma_f32_16x16x32_bf16 v[140:143], v[216:219], v[104:107], v[140:143]
ds_read_b128 v[216:219], v251 offset:12288
v_exp_f32 v233, v153
v_mfma_f32_16x16x32_bf16 v[140:143], v[220:223], v[108:111], v[140:143]
ds_read_b128 v[220:223], v251 offset:12800
s_waitcnt lgkmcnt(2)
v_mfma_f32_16x16x32_bf16 v[128:131], v[208:211], v[16:19], v[128:131]
v_exp_f32 v234, v154
v_add_f32 v226, v230, v232
v_mfma_f32_16x16x32_bf16 v[128:131], v[212:215], v[20:23], v[128:131]
v_cvt_pk_bf16_f32 v186, v232, v233
v_exp_f32 v235, v155
v_mfma_f32_16x16x32_bf16 v[132:135], v[208:211], v[48:51], v[132:135]
v_add_f32 v226, v226, v233
v_add_f32 v226, v226, v234
v_add_f32 v226, v226, v235
v_mfma_f32_16x16x32_bf16 v[132:135], v[212:215], v[52:55], v[132:135]
v_cvt_pk_bf16_f32 v187, v234, v235
v_exp_f32 v236, v156
v_mfma_f32_16x16x32_bf16 v[136:139], v[208:211], v[80:83], v[136:139]
v_exp_f32 v237, v157
v_mfma_f32_16x16x32_bf16 v[136:139], v[212:215], v[84:87], v[136:139]
v_exp_f32 v238, v158
v_add_f32 v227, v231, v236
v_mfma_f32_16x16x32_bf16 v[140:143], v[208:211], v[112:115], v[140:143]
ds_read_b128 v[208:211], v251 offset:2048
v_cvt_pk_bf16_f32 v190, v236, v237
v_mfma_f32_16x16x32_bf16 v[140:143], v[212:215], v[116:119], v[140:143]
ds_read_b128 v[212:215], v251 offset:2560
s_waitcnt lgkmcnt(2)
v_mfma_f32_16x16x32_bf16 v[128:131], v[216:219], v[24:27], v[128:131]
v_exp_f32 v239, v159
v_add_f32 v227, v227, v237
v_mfma_f32_16x16x32_bf16 v[128:131], v[220:223], v[28:31], v[128:131]
v_add_f32 v227, v227, v238
v_add_f32 v227, v227, v239
v_cvt_pk_bf16_f32 v191, v238, v239
v_mfma_f32_16x16x32_bf16 v[132:135], v[216:219], v[56:59], v[132:135]
v_max3_f32 v242, v224, v225, v226
v_max_f32 v242, v242, v227
v_cmp_lt_f32 vcc, s32, v242
s_cbranch_vccnz L2_rare_site15
L2_ret15:
v_mfma_f32_16x16x32_bf16 v[132:135], v[220:223], v[60:63], v[132:135]
v_mfma_f32_16x16x32_bf16 v[136:139], v[216:219], v[88:91], v[136:139]
v_mfma_f32_16x16x32_bf16 v[136:139], v[220:223], v[92:95], v[136:139]
v_mfma_f32_16x16x32_bf16 v[140:143], v[216:219], v[120:123], v[140:143]
ds_read_b128 v[216:219], v251 offset:6144
v_mfma_f32_16x16x32_bf16 v[140:143], v[220:223], v[124:127], v[140:143]
ds_read_b128 v[220:223], v251 offset:6656
s_waitcnt lgkmcnt(2)
v_mfma_f32_16x16x32_bf16 v[144:147], v[208:211], v[0:3], v[192:195]
v_mfma_f32_16x16x32_bf16 v[144:147], v[212:215], v[4:7], v[144:147]
v_mfma_f32_16x16x32_bf16 v[148:151], v[208:211], v[32:35], v[196:199]
v_mfma_f32_16x16x32_bf16 v[148:151], v[212:215], v[36:39], v[148:151]
v_mfma_f32_16x16x32_bf16 v[152:155], v[208:211], v[64:67], v[200:203]
v_exp_f32 v232, v128
v_mfma_f32_16x16x32_bf16 v[152:155], v[212:215], v[68:71], v[152:155]
v_exp_f32 v233, v129
v_mfma_f32_16x16x32_bf16 v[156:159], v[208:211], v[96:99], v[204:207]
ds_read_b128 v[208:211], v251 offset:10240
v_exp_f32 v234, v130
v_mfma_f32_16x16x32_bf16 v[156:159], v[212:215], v[100:103], v[156:159]
ds_read_b128 v[212:215], v251 offset:10752
s_waitcnt lgkmcnt(2)
v_add_f32 v228, v224, v232
v_mfma_f32_16x16x32_bf16 v[144:147], v[216:219], v[8:11], v[144:147]
v_cvt_pk_bf16_f32 v0, v232, v233
v_exp_f32 v235, v131
v_mfma_f32_16x16x32_bf16 v[144:147], v[220:223], v[12:15], v[144:147]
ds_read_b128 v[4:7], v253 offset:0
v_add_f32 v228, v228, v233
v_add_f32 v228, v228, v234
v_mfma_f32_16x16x32_bf16 v[148:151], v[216:219], v[40:43], v[148:151]
ds_read_b128 v[36:39], v253 offset:1024
v_add_f32 v228, v228, v235
v_cvt_pk_bf16_f32 v1, v234, v235
v_mfma_f32_16x16x32_bf16 v[148:151], v[220:223], v[44:47], v[148:151]
v_exp_f32 v236, v132
v_mfma_f32_16x16x32_bf16 v[152:155], v[216:219], v[72:75], v[152:155]
v_exp_f32 v237, v133
v_mfma_f32_16x16x32_bf16 v[152:155], v[220:223], v[76:79], v[152:155]
ds_read_b128 v[68:71], v253 offset:2048
ds_read_b128 v[8:11], v253 offset:4096
v_mfma_f32_16x16x32_bf16 v[156:159], v[216:219], v[104:107], v[156:159]
ds_read_b128 v[216:219], v251 offset:14336
v_add_u32 v12, 0x8000, v249
v_and_b32 v12, 0x1ffff, v12
ds_read_b128 v[100:103], v253 offset:3072
ds_read_b128 v[40:43], v253 offset:5120
v_mfma_f32_16x16x32_bf16 v[156:159], v[220:223], v[108:111], v[156:159]
ds_read_b128 v[220:223], v251 offset:14848
s_waitcnt lgkmcnt(2)
v_add_u32 v14, 0x10000, v249
v_and_b32 v14, 0x1ffff, v14
v_mfma_f32_16x16x32_bf16 v[144:147], v[208:211], v[16:19], v[144:147]
v_xor_b32 v13, 32, v12
v_xor_b32 v15, 32, v14
v_mfma_f32_16x16x32_bf16 v[144:147], v[212:215], v[20:23], v[144:147]
ds_read_b128 v[72:75], v253 offset:6144
v_exp_f32 v238, v134
v_mfma_f32_16x16x32_bf16 v[148:151], v[208:211], v[48:51], v[148:151]
ds_read_b128 v[104:107], v253 offset:7168
v_add_f32 v229, v225, v236
v_cvt_pk_bf16_f32 v32, v236, v237
v_mfma_f32_16x16x32_bf16 v[148:151], v[212:215], v[52:55], v[148:151]
v_exp_f32 v239, v135
v_add_f32 v229, v229, v237
v_mfma_f32_16x16x32_bf16 v[152:155], v[208:211], v[80:83], v[152:155]
v_add_f32 v229, v229, v238
v_add_f32 v229, v229, v239
v_cvt_pk_bf16_f32 v33, v238, v239
v_mfma_f32_16x16x32_bf16 v[152:155], v[212:215], v[84:87], v[152:155]
v_exp_f32 v232, v136
v_mfma_f32_16x16x32_bf16 v[156:159], v[208:211], v[112:115], v[156:159]
ds_read_b64_tr_b16 v[208:209], v249 offset:16384
ds_read_b64_tr_b16 v[210:211], v249 offset:18432
v_mfma_f32_16x16x32_bf16 v[156:159], v[212:215], v[116:119], v[156:159]
ds_read_b64_tr_b16 v[212:213], v12 offset:0
s_waitcnt lgkmcnt(3)
v_mfma_f32_16x16x32_bf16 v[144:147], v[216:219], v[24:27], v[144:147]
ds_read_b64_tr_b16 v[214:215], v12 offset:2048
v_exp_f32 v233, v137
v_mfma_f32_16x16x32_bf16 v[144:147], v[220:223], v[28:31], v[144:147]
v_exp_f32 v234, v138
v_add_f32 v230, v226, v232
v_mfma_f32_16x16x32_bf16 v[148:151], v[216:219], v[56:59], v[148:151]
v_cvt_pk_bf16_f32 v64, v232, v233
v_exp_f32 v235, v139
v_mfma_f32_16x16x32_bf16 v[148:151], v[220:223], v[60:63], v[148:151]
v_add_f32 v230, v230, v233
v_add_f32 v230, v230, v234
v_add_f32 v230, v230, v235
v_mfma_f32_16x16x32_bf16 v[152:155], v[216:219], v[88:91], v[152:155]
v_cvt_pk_bf16_f32 v65, v234, v235
v_exp_f32 v236, v140
v_mfma_f32_16x16x32_bf16 v[152:155], v[220:223], v[92:95], v[152:155]
v_exp_f32 v237, v141
s_waitcnt vmcnt(0)
v_mfma_f32_16x16x32_bf16 v[156:159], v[216:219], v[120:123], v[156:159]
ds_read_b64_tr_b16 v[216:217], v12 offset:16384
ds_read_b64_tr_b16 v[218:219], v12 offset:18432
v_cmp_ne_u64_e64 s[38:39], s[98:99], v[240:241]
v_mfma_f32_16x16x32_bf16 v[156:159], v[220:223], v[124:127], v[156:159]
ds_read_b64_tr_b16 v[220:221], v250 offset:16384
s_waitcnt lgkmcnt(3)
v_exp_f32 v238, v142
v_add_f32 v231, v227, v236
v_cvt_pk_bf16_f32 v96, v236, v237
v_exp_f32 v239, v143
v_add_f32 v231, v231, v237
v_add_f32 v231, v231, v238
v_add_f32 v231, v231, v239
v_cvt_pk_bf16_f32 v97, v238, v239
v_max3_f32 v242, v228, v229, v230
v_max_f32 v242, v242, v231
v_cmp_lt_f32 vcc, s32, v242
s_cbranch_vccnz L2_rare_site16
L2_ret16:
v_mfma_f32_16x16x32_bf16 a[0:3], v[8:11], v[208:211], a[0:3]
ds_read_b64_tr_b16 v[222:223], v250 offset:18432
s_and_b64 s[38:39], s[38:39], s[96:97]
s_cbranch_scc1 LF_hl_0
LF_hlret_0:
v_mfma_f32_16x16x32_bf16 a[0:3], v[160:163], v[212:215], a[0:3]
v_exp_f32 v232, v144
v_lshrrev_b32 v241, 4, v248
v_mfma_f32_16x16x32_bf16 a[4:7], v[40:43], v[208:211], a[4:7]
v_exp_f32 v233, v145
v_and_b32 v241, 0x30, v241
v_mfma_f32_16x16x32_bf16 a[4:7], v[164:167], v[212:215], a[4:7]
v_exp_f32 v234, v146
v_xor_b32 v241, v241, v248
v_mfma_f32_16x16x32_bf16 a[8:11], v[72:75], v[208:211], a[8:11]
v_add_f32 v224, v228, v232
v_cvt_pk_bf16_f32 v2, v232, v233
v_mfma_f32_16x16x32_bf16 a[8:11], v[168:171], v[212:215], a[8:11]
v_exp_f32 v235, v147
v_mfma_f32_16x16x32_bf16 a[12:15], v[104:107], v[208:211], a[12:15]
ds_read_b64_tr_b16 v[208:209], v13 offset:0
ds_read_b64_tr_b16 v[210:211], v13 offset:2048
v_mfma_f32_16x16x32_bf16 a[12:15], v[172:175], v[212:215], a[12:15]
ds_read_b64_tr_b16 v[212:213], v13 offset:16384
s_waitcnt lgkmcnt(5)
v_mfma_f32_16x16x32_bf16 a[0:3], v[176:179], v[216:219], a[0:3]
ds_read_b64_tr_b16 v[214:215], v13 offset:18432
v_add_f32 v224, v224, v233
v_mfma_f32_16x16x32_bf16 a[4:7], v[180:183], v[216:219], a[4:7]
v_add_f32 v224, v224, v234
v_add_f32 v224, v224, v235
v_mfma_f32_16x16x32_bf16 a[8:11], v[184:187], v[216:219], a[8:11]
v_cvt_pk_bf16_f32 v3, v234, v235
v_and_b32 v243, 0x380, v248
v_mad_u32_u24 v241, v243, 3, v241
v_mfma_f32_16x16x32_bf16 a[12:15], v[188:191], v[216:219], a[12:15]
ds_read_b64_tr_b16 v[216:217], v249 offset:16896
s_waitcnt lgkmcnt(5)
v_add_u32 v241, 0x7000000, v241
v_mfma_f32_16x16x32_bf16 a[16:19], v[8:11], v[220:223], a[16:19]
ds_read_b64_tr_b16 v[218:219], v249 offset:18944
v_and_b32 v110, 0x70, v248
v_lshlrev_b32 v110, 3, v110
v_mfma_f32_16x16x32_bf16 a[20:23], v[40:43], v[220:223], a[20:23]
v_exp_f32 v236, v148
v_add_u32 v110, 0x7c32000, v110
v_mfma_f32_16x16x32_bf16 a[24:27], v[72:75], v[220:223], a[24:27]
v_exp_f32 v237, v149
buffer_load_dwordx2 v[108:109], v110, s[16:19], 0 offen sc1
v_mfma_f32_16x16x32_bf16 a[28:31], v[104:107], v[220:223], a[28:31]
ds_read_b64_tr_b16 v[220:221], v12 offset:512
s_waitcnt lgkmcnt(3)
v_mfma_f32_16x16x32_bf16 a[16:19], v[160:163], v[208:211], a[16:19]
ds_read_b64_tr_b16 v[222:223], v12 offset:2560
s_add_u32 m0, s28, 0
v_mfma_f32_16x16x32_bf16 a[16:19], v[176:179], v[212:215], a[16:19]
v_exp_f32 v238, v150
v_mfma_f32_16x16x32_bf16 a[20:23], v[164:167], v[208:211], a[20:23]
v_add_f32 v225, v229, v236
v_cvt_pk_bf16_f32 v34, v236, v237
v_mfma_f32_16x16x32_bf16 a[20:23], v[180:183], v[212:215], a[20:23]
v_exp_f32 v239, v151
v_mfma_f32_16x16x32_bf16 a[24:27], v[168:171], v[208:211], a[24:27]
v_add_f32 v225, v225, v237
v_add_f32 v225, v225, v238
v_mfma_f32_16x16x32_bf16 a[24:27], v[184:187], v[212:215], a[24:27]
v_add_f32 v225, v225, v239
v_cvt_pk_bf16_f32 v35, v238, v239
v_mfma_f32_16x16x32_bf16 a[28:31], v[172:175], v[208:211], a[28:31]
ds_read_b64_tr_b16 v[208:209], v12 offset:16896
ds_read_b64_tr_b16 v[210:211], v12 offset:18944
v_mfma_f32_16x16x32_bf16 a[28:31], v[188:191], v[212:215], a[28:31]
ds_read_b64_tr_b16 v[212:213], v250 offset:16896
s_waitcnt lgkmcnt(3)
v_mfma_f32_16x16x32_bf16 a[32:35], v[8:11], v[216:219], a[32:35]
ds_read_b64_tr_b16 v[214:215], v250 offset:18944
buffer_load_dwordx4 v241, s[16:19], s6 offen sc1 lds
s_add_u32 m0, s28, 8192
v_mfma_f32_16x16x32_bf16 a[32:35], v[160:163], v[220:223], a[32:35]
v_exp_f32 v232, v152
v_mfma_f32_16x16x32_bf16 a[36:39], v[40:43], v[216:219], a[36:39]
v_exp_f32 v233, v153
v_mfma_f32_16x16x32_bf16 a[36:39], v[164:167], v[220:223], a[36:39]
v_exp_f32 v234, v154
v_mfma_f32_16x16x32_bf16 a[40:43], v[72:75], v[216:219], a[40:43]
v_add_f32 v226, v230, v232
v_cvt_pk_bf16_f32 v66, v232, v233
v_mfma_f32_16x16x32_bf16 a[40:43], v[168:171], v[220:223], a[40:43]
v_exp_f32 v235, v155
v_mfma_f32_16x16x32_bf16 a[44:47], v[104:107], v[216:219], a[44:47]
ds_read_b64_tr_b16 v[216:217], v13 offset:512
ds_read_b64_tr_b16 v[218:219], v13 offset:2560
v_mfma_f32_16x16x32_bf16 a[44:47], v[172:175], v[220:223], a[44:47]
ds_read_b64_tr_b16 v[220:221], v13 offset:16896
s_waitcnt lgkmcnt(5)
v_mfma_f32_16x16x32_bf16 a[32:35], v[176:179], v[208:211], a[32:35]
ds_read_b64_tr_b16 v[222:223], v13 offset:18944
v_add_f32 v226, v226, v233
v_mfma_f32_16x16x32_bf16 a[36:39], v[180:183], v[208:211], a[36:39]
v_add_f32 v226, v226, v234
v_add_f32 v226, v226, v235
v_mfma_f32_16x16x32_bf16 a[40:43], v[184:187], v[208:211], a[40:43]
v_cvt_pk_bf16_f32 v67, v234, v235
buffer_load_dwordx4 v241, s[16:19], s7 offen sc1 lds
s_add_u32 m0, s30, 0
v_mfma_f32_16x16x32_bf16 a[44:47], v[188:191], v[208:211], a[44:47]
ds_read_b64_tr_b16 v[208:209], v14 offset:0
s_waitcnt lgkmcnt(5)
v_mfma_f32_16x16x32_bf16 a[48:51], v[8:11], v[212:215], a[48:51]
ds_read_b64_tr_b16 v[210:211], v14 offset:2048
buffer_load_dwordx4 v241, s[16:19], s29 offen sc1 lds
s_add_u32 m0, s28, 4096
v_mfma_f32_16x16x32_bf16 a[52:55], v[40:43], v[212:215], a[52:55]
v_exp_f32 v236, v156
v_xor_b32 v241, 0x1040, v241
v_mfma_f32_16x16x32_bf16 a[56:59], v[72:75], v[212:215], a[56:59]
v_exp_f32 v237, v157
v_mfma_f32_16x16x32_bf16 a[60:63], v[104:107], v[212:215], a[60:63]
ds_read_b64_tr_b16 v[212:213], v15 offset:0
s_waitcnt lgkmcnt(3)
v_mfma_f32_16x16x32_bf16 a[48:51], v[160:163], v[216:219], a[48:51]
ds_read_b64_tr_b16 v[214:215], v15 offset:2048
buffer_load_dwordx4 v241, s[16:19], s6 offen sc1 lds
s_add_u32 m0, s28, 12288
v_mfma_f32_16x16x32_bf16 a[48:51], v[176:179], v[220:223], a[48:51]
v_exp_f32 v238, v158
v_mfma_f32_16x16x32_bf16 a[52:55], v[164:167], v[216:219], a[52:55]
v_add_f32 v227, v231, v236
v_cvt_pk_bf16_f32 v98, v236, v237
v_mfma_f32_16x16x32_bf16 a[52:55], v[180:183], v[220:223], a[52:55]
v_exp_f32 v239, v159
v_mfma_f32_16x16x32_bf16 a[56:59], v[168:171], v[216:219], a[56:59]
v_add_f32 v227, v227, v237
v_add_f32 v227, v227, v238
v_mfma_f32_16x16x32_bf16 a[56:59], v[184:187], v[220:223], a[56:59]
v_add_f32 v227, v227, v239
v_cvt_pk_bf16_f32 v99, v238, v239
v_mfma_f32_16x16x32_bf16 a[60:63], v[172:175], v[216:219], a[60:63]
ds_read_b64_tr_b16 v[216:217], v14 offset:512
ds_read_b64_tr_b16 v[218:219], v14 offset:2560
v_max3_f32 v242, v224, v225, v226
v_max_f32 v242, v242, v227
v_cmp_lt_f32 vcc, s32, v242
s_cbranch_vccnz L2_rare_site17
L2_ret17:
v_mfma_f32_16x16x32_bf16 a[60:63], v[188:191], v[220:223], a[60:63]
ds_read_b64_tr_b16 v[220:221], v15 offset:512
s_waitcnt lgkmcnt(5)
v_mfma_f32_16x16x32_bf16 a[0:3], v[0:3], v[208:211], a[0:3]
ds_read_b64_tr_b16 v[222:223], v15 offset:2560
buffer_load_dwordx4 v241, s[16:19], s7 offen sc1 lds
s_add_u32 m0, s30, 4096
v_mfma_f32_16x16x32_bf16 a[4:7], v[32:35], v[208:211], a[4:7]
buffer_load_dwordx4 v241, s[16:19], s29 offen sc1 lds
v_bfe_u32 v242, v248, 8, 1
v_mfma_f32_16x16x32_bf16 a[8:11], v[64:67], v[208:211], a[8:11]
v_mul_u32_u24 v242, 48, v242
v_lshl_add_u32 v242, s37, 3, v242
v_and_b32 v243, 0xf0, v248
v_mfma_f32_16x16x32_bf16 a[12:15], v[96:99], v[208:211], a[12:15]
ds_read_b64_tr_b16 v[208:209], v249 offset:20480
s_waitcnt lgkmcnt(5)
v_lshl_add_u32 v242, v243, 3, v242
v_mfma_f32_16x16x32_bf16 a[16:19], v[0:3], v[212:215], a[16:19]
ds_read_b64_tr_b16 v[210:211], v249 offset:22528
v_mov_b32 v232, v224
v_mov_b32 v234, v225
v_mfma_f32_16x16x32_bf16 a[20:23], v[32:35], v[212:215], a[20:23]
v_mov_b32 v236, v226
v_mov_b32 v238, v227
v_permlane32_swap_b32 v224, v232
v_mfma_f32_16x16x32_bf16 a[24:27], v[64:67], v[212:215], a[24:27]
v_permlane32_swap_b32 v225, v234
v_permlane32_swap_b32 v226, v236
v_permlane32_swap_b32 v227, v238
v_mfma_f32_16x16x32_bf16 a[28:31], v[96:99], v[212:215], a[28:31]
ds_read_b64_tr_b16 v[212:213], v12 offset:4096
s_waitcnt lgkmcnt(5)
v_add_f32 v224, v224, v232
v_mfma_f32_16x16x32_bf16 a[32:35], v[0:3], v[216:219], a[32:35]
ds_read_b64_tr_b16 v[214:215], v12 offset:6144
v_add_f32 v225, v225, v234
v_add_f32 v226, v226, v236
v_mfma_f32_16x16x32_bf16 a[36:39], v[32:35], v[216:219], a[36:39]
v_add_f32 v227, v227, v238
v_mov_b32 v232, v224
v_mov_b32 v234, v225
v_mfma_f32_16x16x32_bf16 a[40:43], v[64:67], v[216:219], a[40:43]
v_mov_b32 v236, v226
v_mov_b32 v238, v227
v_permlane16_swap_b32 v224, v232
v_mfma_f32_16x16x32_bf16 a[44:47], v[96:99], v[216:219], a[44:47]
ds_read_b64_tr_b16 v[216:217], v12 offset:20480
s_waitcnt lgkmcnt(5)
v_permlane16_swap_b32 v225, v234
v_mfma_f32_16x16x32_bf16 a[48:51], v[0:3], v[220:223], a[48:51]
ds_read_b64_tr_b16 v[218:219], v12 offset:22528
v_permlane16_swap_b32 v226, v236
v_permlane16_swap_b32 v227, v238
v_mfma_f32_16x16x32_bf16 a[52:55], v[32:35], v[220:223], a[52:55]
v_add_f32 v233, v224, v232
v_add_f32 v235, v225, v234
v_add_f32 v237, v226, v236
v_mfma_f32_16x16x32_bf16 a[56:59], v[64:67], v[220:223], a[56:59]
v_add_f32 v239, v227, v238
v_sub_f32 v232, 0, v192
v_sub_f32 v234, 0, v196
v_mfma_f32_16x16x32_bf16 a[60:63], v[96:99], v[220:223], a[60:63]
ds_read_b64_tr_b16 v[220:221], v14 offset:4096
s_waitcnt lgkmcnt(3)
v_sub_f32 v236, 0, v200
v_mfma_f32_16x16x32_bf16 a[64:67], v[8:11], v[208:211], a[64:67]
ds_read_b64_tr_b16 v[222:223], v14 offset:6144
v_sub_f32 v238, 0, v204
v_mfma_f32_16x16x32_bf16 a[64:67], v[160:163], v[212:215], a[64:67]
s_mov_b32 exec_hi, 0
buffer_store_dwordx2 v[232:233], v242, s[24:27], s48 offen sc1
s_lshr_b32 s3, s41, 2
buffer_store_dwordx2 v[234:235], v242, s[24:27], s3 offen sc1
s_lshr_b32 s3, s42, 2
buffer_store_dwordx2 v[236:237], v242, s[24:27], s3 offen sc1
s_lshr_b32 s3, s43, 2
buffer_store_dwordx2 v[238:239], v242, s[24:27], s3 offen sc1
s_mov_b32 exec_hi, -1
v_mfma_f32_16x16x32_bf16 a[68:71], v[40:43], v[208:211], a[68:71]
v_accvgpr_read_b32 v128, a0
v_accvgpr_read_b32 v129, a1
v_accvgpr_read_b32 v130, a2
v_mfma_f32_16x16x32_bf16 a[68:71], v[164:167], v[212:215], a[68:71]
v_accvgpr_read_b32 v131, a3
v_cvt_pk_bf16_f32 v16, v128, v129
v_cvt_pk_bf16_f32 v17, v130, v131
v_mfma_f32_16x16x32_bf16 a[72:75], v[72:75], v[208:211], a[72:75]
v_accvgpr_read_b32 v136, a4
v_accvgpr_read_b32 v137, a5
v_accvgpr_read_b32 v138, a6
v_mfma_f32_16x16x32_bf16 a[72:75], v[168:171], v[212:215], a[72:75]
v_accvgpr_read_b32 v139, a7
v_cvt_pk_bf16_f32 v48, v136, v137
v_cvt_pk_bf16_f32 v49, v138, v139
v_mfma_f32_16x16x32_bf16 a[76:79], v[104:107], v[208:211], a[76:79]
ds_read_b64_tr_b16 v[208:209], v250 offset:20480
ds_read_b64_tr_b16 v[210:211], v250 offset:22528
v_accvgpr_read_b32 v144, a8
v_mfma_f32_16x16x32_bf16 a[76:79], v[172:175], v[212:215], a[76:79]
ds_read_b64_tr_b16 v[212:213], v13 offset:4096
s_waitcnt lgkmcnt(3)
v_accvgpr_read_b32 v145, a9
v_mfma_f32_16x16x32_bf16 a[64:67], v[176:179], v[216:219], a[64:67]
ds_read_b64_tr_b16 v[214:215], v13 offset:6144
v_accvgpr_read_b32 v146, a10
v_accvgpr_read_b32 v147, a11
v_mfma_f32_16x16x32_bf16 a[64:67], v[0:3], v[220:223], a[64:67]
v_cvt_pk_bf16_f32 v80, v144, v145
v_cvt_pk_bf16_f32 v81, v146, v147
v_accvgpr_read_b32 v152, a12
v_mfma_f32_16x16x32_bf16 a[68:71], v[180:183], v[216:219], a[68:71]
v_accvgpr_read_b32 v153, a13
v_accvgpr_read_b32 v154, a14
v_accvgpr_read_b32 v155, a15
v_mfma_f32_16x16x32_bf16 a[68:71], v[32:35], v[220:223], a[68:71]
v_cvt_pk_bf16_f32 v112, v152, v153
v_cvt_pk_bf16_f32 v113, v154, v155
v_accvgpr_read_b32 v132, a16
v_mfma_f32_16x16x32_bf16 a[72:75], v[184:187], v[216:219], a[72:75]
v_accvgpr_read_b32 v133, a17
v_accvgpr_read_b32 v134, a18
v_accvgpr_read_b32 v135, a19
v_mfma_f32_16x16x32_bf16 a[72:75], v[64:67], v[220:223], a[72:75]
v_cvt_pk_bf16_f32 v18, v132, v133
v_cvt_pk_bf16_f32 v19, v134, v135
buffer_store_dwordx4 v[16:19], v248, s[20:23], s40 offen offset:0 sc1
v_mfma_f32_16x16x32_bf16 a[76:79], v[188:191], v[216:219], a[76:79]
ds_read_b64_tr_b16 v[216:217], v13 offset:20480
ds_read_b64_tr_b16 v[218:219], v13 offset:22528
ds_write_b128 v253, v[16:19] offset:0
v_mfma_f32_16x16x32_bf16 a[76:79], v[96:99], v[220:223], a[76:79]
ds_read_b64_tr_b16 v[220:221], v15 offset:4096
s_waitcnt lgkmcnt(3)
v_accvgpr_read_b32 v140, a20
v_mfma_f32_16x16x32_bf16 a[80:83], v[8:11], v[208:211], a[80:83]
ds_read_b64_tr_b16 v[222:223], v15 offset:6144
v_accvgpr_read_b32 v141, a21
v_accvgpr_read_b32 v142, a22
v_mfma_f32_16x16x32_bf16 a[80:83], v[160:163], v[212:215], a[80:83]
v_accvgpr_read_b32 v143, a23
v_cvt_pk_bf16_f32 v50, v140, v141
v_cvt_pk_bf16_f32 v51, v142, v143
v_mfma_f32_16x16x32_bf16 a[84:87], v[40:43], v[208:211], a[84:87]
buffer_store_dwordx4 v[48:51], v248, s[20:23], s41 offen offset:0 sc1
v_accvgpr_read_b32 v148, a24
v_accvgpr_read_b32 v149, a25
v_mfma_f32_16x16x32_bf16 a[84:87], v[164:167], v[212:215], a[84:87]
v_accvgpr_read_b32 v150, a26
v_accvgpr_read_b32 v151, a27
v_cvt_pk_bf16_f32 v82, v148, v149
v_mfma_f32_16x16x32_bf16 a[88:91], v[72:75], v[208:211], a[88:91]
v_cvt_pk_bf16_f32 v83, v150, v151
buffer_store_dwordx4 v[80:83], v248, s[20:23], s42 offen offset:0 sc1
v_accvgpr_read_b32 v156, a28
v_mfma_f32_16x16x32_bf16 a[88:91], v[168:171], v[212:215], a[88:91]
v_accvgpr_read_b32 v157, a29
v_accvgpr_read_b32 v158, a30
v_accvgpr_read_b32 v159, a31
v_mfma_f32_16x16x32_bf16 a[92:95], v[104:107], v[208:211], a[92:95]
ds_read_b64_tr_b16 v[208:209], v249 offset:20992
ds_read_b64_tr_b16 v[210:211], v249 offset:23040
v_cvt_pk_bf16_f32 v114, v156, v157
v_mfma_f32_16x16x32_bf16 a[92:95], v[172:175], v[212:215], a[92:95]
ds_read_b64_tr_b16 v[212:213], v12 offset:4608
s_waitcnt lgkmcnt(3)
v_cvt_pk_bf16_f32 v115, v158, v159
v_mfma_f32_16x16x32_bf16 a[80:83], v[176:179], v[216:219], a[80:83]
ds_read_b64_tr_b16 v[214:215], v12 offset:6656
buffer_store_dwordx4 v[112:115], v248, s[20:23], s43 offen offset:0 sc1
v_accvgpr_read_b32 v128, a32
v_mfma_f32_16x16x32_bf16 a[80:83], v[0:3], v[220:223], a[80:83]
v_accvgpr_read_b32 v129, a33
v_accvgpr_read_b32 v130, a34
v_accvgpr_read_b32 v131, a35
v_mfma_f32_16x16x32_bf16 a[84:87], v[180:183], v[216:219], a[84:87]
v_cvt_pk_bf16_f32 v20, v128, v129
v_cvt_pk_bf16_f32 v21, v130, v131
v_accvgpr_read_b32 v136, a36
v_mfma_f32_16x16x32_bf16 a[84:87], v[32:35], v[220:223], a[84:87]
v_accvgpr_read_b32 v137, a37
v_accvgpr_read_b32 v138, a38
v_accvgpr_read_b32 v139, a39
v_mfma_f32_16x16x32_bf16 a[88:91], v[184:187], v[216:219], a[88:91]
v_cvt_pk_bf16_f32 v52, v136, v137
v_cvt_pk_bf16_f32 v53, v138, v139
v_accvgpr_read_b32 v144, a40
v_mfma_f32_16x16x32_bf16 a[88:91], v[64:67], v[220:223], a[88:91]
v_accvgpr_read_b32 v145, a41
v_accvgpr_read_b32 v146, a42
v_accvgpr_read_b32 v147, a43
v_mfma_f32_16x16x32_bf16 a[92:95], v[188:191], v[216:219], a[92:95]
ds_read_b64_tr_b16 v[216:217], v12 offset:20992
ds_read_b64_tr_b16 v[218:219], v12 offset:23040
v_cvt_pk_bf16_f32 v84, v144, v145
v_mfma_f32_16x16x32_bf16 a[92:95], v[96:99], v[220:223], a[92:95]
ds_read_b64_tr_b16 v[220:221], v14 offset:4608
s_waitcnt lgkmcnt(3)
v_cvt_pk_bf16_f32 v85, v146, v147
v_mfma_f32_16x16x32_bf16 a[96:99], v[8:11], v[208:211], a[96:99]
ds_read_b64_tr_b16 v[222:223], v14 offset:6656
v_accvgpr_read_b32 v152, a44
v_accvgpr_read_b32 v153, a45
v_mfma_f32_16x16x32_bf16 a[96:99], v[160:163], v[212:215], a[96:99]
v_accvgpr_read_b32 v154, a46
v_accvgpr_read_b32 v155, a47
v_cvt_pk_bf16_f32 v116, v152, v153
v_mfma_f32_16x16x32_bf16 a[100:103], v[40:43], v[208:211], a[100:103]
v_cvt_pk_bf16_f32 v117, v154, v155
v_accvgpr_read_b32 v132, a48
v_accvgpr_read_b32 v133, a49
v_mfma_f32_16x16x32_bf16 a[100:103], v[164:167], v[212:215], a[100:103]
v_accvgpr_read_b32 v134, a50
v_accvgpr_read_b32 v135, a51
v_cvt_pk_bf16_f32 v22, v132, v133
v_mfma_f32_16x16x32_bf16 a[104:107], v[72:75], v[208:211], a[104:107]
v_cvt_pk_bf16_f32 v23, v134, v135
buffer_store_dwordx4 v[20:23], v248, s[20:23], s40 offen offset:1024 sc1
ds_write_b128 v253, v[20:23] offset:1024
v_mfma_f32_16x16x32_bf16 a[104:107], v[168:171], v[212:215], a[104:107]
v_accvgpr_read_b32 v140, a52
v_accvgpr_read_b32 v141, a53
v_accvgpr_read_b32 v142, a54
v_mfma_f32_16x16x32_bf16 a[108:111], v[104:107], v[208:211], a[108:111]
ds_read_b64_tr_b16 v[208:209], v250 offset:20992
ds_read_b64_tr_b16 v[210:211], v250 offset:23040
v_accvgpr_read_b32 v143, a55
v_mfma_f32_16x16x32_bf16 a[108:111], v[172:175], v[212:215], a[108:111]
ds_read_b64_tr_b16 v[212:213], v13 offset:4608
s_waitcnt lgkmcnt(3)
v_cvt_pk_bf16_f32 v54, v140, v141
v_mfma_f32_16x16x32_bf16 a[96:99], v[176:179], v[216:219], a[96:99]
ds_read_b64_tr_b16 v[214:215], v13 offset:6656
v_cvt_pk_bf16_f32 v55, v142, v143
buffer_store_dwordx4 v[52:55], v248, s[20:23], s41 offen offset:1024 sc1
v_mfma_f32_16x16x32_bf16 a[96:99], v[0:3], v[220:223], a[96:99]
v_accvgpr_read_b32 v148, a56
v_accvgpr_read_b32 v149, a57
v_accvgpr_read_b32 v150, a58
v_mfma_f32_16x16x32_bf16 a[100:103], v[180:183], v[216:219], a[100:103]
v_accvgpr_read_b32 v151, a59
v_cvt_pk_bf16_f32 v86, v148, v149
v_cvt_pk_bf16_f32 v87, v150, v151
v_mfma_f32_16x16x32_bf16 a[100:103], v[32:35], v[220:223], a[100:103]
buffer_store_dwordx4 v[84:87], v248, s[20:23], s42 offen offset:1024 sc1
v_accvgpr_read_b32 v156, a60
v_accvgpr_read_b32 v157, a61
v_mfma_f32_16x16x32_bf16 a[104:107], v[184:187], v[216:219], a[104:107]
v_accvgpr_read_b32 v158, a62
v_accvgpr_read_b32 v159, a63
v_cvt_pk_bf16_f32 v118, v156, v157
v_mfma_f32_16x16x32_bf16 a[104:107], v[64:67], v[220:223], a[104:107]
v_cvt_pk_bf16_f32 v119, v158, v159
buffer_store_dwordx4 v[116:119], v248, s[20:23], s43 offen offset:1024 sc1
v_accvgpr_read_b32 v128, a64
v_mfma_f32_16x16x32_bf16 a[108:111], v[188:191], v[216:219], a[108:111]
ds_read_b64_tr_b16 v[216:217], v13 offset:20992
ds_read_b64_tr_b16 v[218:219], v13 offset:23040
v_accvgpr_read_b32 v129, a65
v_mfma_f32_16x16x32_bf16 a[108:111], v[96:99], v[220:223], a[108:111]
ds_read_b64_tr_b16 v[220:221], v15 offset:4608
s_waitcnt lgkmcnt(3)
v_accvgpr_read_b32 v130, a66
v_mfma_f32_16x16x32_bf16 a[112:115], v[8:11], v[208:211], a[112:115]
ds_read_b64_tr_b16 v[222:223], v15 offset:6656
v_accvgpr_read_b32 v131, a67
v_cvt_pk_bf16_f32 v24, v128, v129
v_mfma_f32_16x16x32_bf16 a[112:115], v[160:163], v[212:215], a[112:115]
v_cvt_pk_bf16_f32 v25, v130, v131
v_accvgpr_read_b32 v136, a68
v_accvgpr_read_b32 v137, a69
v_mfma_f32_16x16x32_bf16 a[116:119], v[40:43], v[208:211], a[116:119]
v_accvgpr_read_b32 v138, a70
v_accvgpr_read_b32 v139, a71
v_cvt_pk_bf16_f32 v56, v136, v137
v_mfma_f32_16x16x32_bf16 a[116:119], v[164:167], v[212:215], a[116:119]
v_cvt_pk_bf16_f32 v57, v138, v139
v_accvgpr_read_b32 v144, a72
v_accvgpr_read_b32 v145, a73
v_mfma_f32_16x16x32_bf16 a[120:123], v[72:75], v[208:211], a[120:123]
v_accvgpr_read_b32 v146, a74
v_accvgpr_read_b32 v147, a75
v_cvt_pk_bf16_f32 v88, v144, v145
v_mfma_f32_16x16x32_bf16 a[120:123], v[168:171], v[212:215], a[120:123]
v_cvt_pk_bf16_f32 v89, v146, v147
v_accvgpr_read_b32 v152, a76
v_accvgpr_read_b32 v153, a77
v_mfma_f32_16x16x32_bf16 a[124:127], v[104:107], v[208:211], a[124:127]
ds_read_b64_tr_b16 v[208:209], v249 offset:8192
ds_read_b64_tr_b16 v[210:211], v249 offset:10240
v_accvgpr_read_b32 v154, a78
v_mfma_f32_16x16x32_bf16 a[124:127], v[172:175], v[212:215], a[124:127]
ds_read_b64_tr_b16 v[212:213], v249 offset:24576
s_waitcnt lgkmcnt(3)
v_accvgpr_read_b32 v155, a79
v_mfma_f32_16x16x32_bf16 a[112:115], v[176:179], v[216:219], a[112:115]
ds_read_b64_tr_b16 v[214:215], v249 offset:26624
v_cvt_pk_bf16_f32 v120, v152, v153
v_cvt_pk_bf16_f32 v121, v154, v155
v_mfma_f32_16x16x32_bf16 a[112:115], v[0:3], v[220:223], a[112:115]
v_accvgpr_read_b32 v132, a80
v_accvgpr_read_b32 v133, a81
v_accvgpr_read_b32 v134, a82
v_mfma_f32_16x16x32_bf16 a[116:119], v[180:183], v[216:219], a[116:119]
v_accvgpr_read_b32 v135, a83
v_cvt_pk_bf16_f32 v26, v132, v133
v_cvt_pk_bf16_f32 v27, v134, v135
v_mfma_f32_16x16x32_bf16 a[116:119], v[32:35], v[220:223], a[116:119]
buffer_store_dwordx4 v[24:27], v248, s[20:23], s40 offen offset:2048 sc1
ds_write_b128 v253, v[24:27] offset:2048
v_accvgpr_read_b32 v140, a84
v_mfma_f32_16x16x32_bf16 a[120:123], v[184:187], v[216:219], a[120:123]
v_accvgpr_read_b32 v141, a85
v_accvgpr_read_b32 v142, a86
v_accvgpr_read_b32 v143, a87
v_mfma_f32_16x16x32_bf16 a[120:123], v[64:67], v[220:223], a[120:123]
v_cvt_pk_bf16_f32 v58, v140, v141
v_cvt_pk_bf16_f32 v59, v142, v143
buffer_store_dwordx4 v[56:59], v248, s[20:23], s41 offen offset:2048 sc1
v_mfma_f32_16x16x32_bf16 a[124:127], v[188:191], v[216:219], a[124:127]
ds_read_b64_tr_b16 v[216:217], v12 offset:8192
ds_read_b64_tr_b16 v[218:219], v12 offset:10240
v_accvgpr_read_b32 v148, a88
v_mfma_f32_16x16x32_bf16 a[124:127], v[96:99], v[220:223], a[124:127]
ds_read_b64_tr_b16 v[220:221], v12 offset:24576
s_waitcnt lgkmcnt(3)
v_accvgpr_read_b32 v149, a89
v_mfma_f32_16x16x32_bf16 a[128:131], v[4:7], v[208:211], a[128:131]
ds_read_b64_tr_b16 v[222:223], v12 offset:26624
v_accvgpr_read_b32 v150, a90
v_accvgpr_read_b32 v151, a91
v_mfma_f32_16x16x32_bf16 a[128:131], v[8:11], v[212:215], a[128:131]
v_cvt_pk_bf16_f32 v90, v148, v149
v_cvt_pk_bf16_f32 v91, v150, v151
buffer_store_dwordx4 v[88:91], v248, s[20:23], s42 offen offset:2048 sc1
v_mfma_f32_16x16x32_bf16 a[132:135], v[36:39], v[208:211], a[132:135]
v_accvgpr_read_b32 v156, a92
v_accvgpr_read_b32 v157, a93
v_accvgpr_read_b32 v158, a94
v_mfma_f32_16x16x32_bf16 a[132:135], v[40:43], v[212:215], a[132:135]
v_accvgpr_read_b32 v159, a95
v_cvt_pk_bf16_f32 v122, v156, v157
v_cvt_pk_bf16_f32 v123, v158, v159
v_mfma_f32_16x16x32_bf16 a[136:139], v[68:71], v[208:211], a[136:139]
buffer_store_dwordx4 v[120:123], v248, s[20:23], s43 offen offset:2048 sc1
v_accvgpr_read_b32 v128, a96
v_mfma_f32_16x16x32_bf16 a[136:139], v[72:75], v[212:215], a[136:139]
v_accvgpr_read_b32 v129, a97
v_accvgpr_read_b32 v130, a98
v_mfma_f32_16x16x32_bf16 a[140:143], v[100:103], v[208:211], a[140:143]
ds_read_b64_tr_b16 v[208:209], v14 offset:8192
ds_read_b64_tr_b16 v[210:211], v14 offset:10240
v_mfma_f32_16x16x32_bf16 a[140:143], v[104:107], v[212:215], a[140:143]
ds_read_b64_tr_b16 v[212:213], v250 offset:8192
s_waitcnt lgkmcnt(3)
v_mfma_f32_16x16x32_bf16 a[128:131], v[160:163], v[216:219], a[128:131]
ds_read_b64_tr_b16 v[214:215], v250 offset:10240
v_accvgpr_read_b32 v131, a99
v_mfma_f32_16x16x32_bf16 a[128:131], v[176:179], v[220:223], a[128:131]
v_cvt_pk_bf16_f32 v28, v128, v129
v_cvt_pk_bf16_f32 v29, v130, v131
v_mfma_f32_16x16x32_bf16 a[132:135], v[164:167], v[216:219], a[132:135]
v_accvgpr_read_b32 v136, a100
v_accvgpr_read_b32 v137, a101
v_mfma_f32_16x16x32_bf16 a[132:135], v[180:183], v[220:223], a[132:135]
v_accvgpr_read_b32 v138, a102
v_accvgpr_read_b32 v139, a103
v_mfma_f32_16x16x32_bf16 a[136:139], v[168:171], v[216:219], a[136:139]
v_cvt_pk_bf16_f32 v60, v136, v137
v_cvt_pk_bf16_f32 v61, v138, v139
v_mfma_f32_16x16x32_bf16 a[136:139], v[184:187], v[220:223], a[136:139]
v_accvgpr_read_b32 v144, a104
v_accvgpr_read_b32 v145, a105
v_mfma_f32_16x16x32_bf16 a[140:143], v[172:175], v[216:219], a[140:143]
ds_read_b64_tr_b16 v[216:217], v250 offset:24576
ds_read_b64_tr_b16 v[218:219], v250 offset:26624
v_mfma_f32_16x16x32_bf16 a[140:143], v[188:191], v[220:223], a[140:143]
ds_read_b64_tr_b16 v[220:221], v13 offset:8192
s_waitcnt lgkmcnt(5)
v_mfma_f32_16x16x32_bf16 a[128:131], v[0:3], v[208:211], a[128:131]
ds_read_b64_tr_b16 v[222:223], v13 offset:10240
v_accvgpr_read_b32 v146, a106
v_mfma_f32_16x16x32_bf16 a[132:135], v[32:35], v[208:211], a[132:135]
v_accvgpr_read_b32 v147, a107
v_cvt_pk_bf16_f32 v92, v144, v145
v_mfma_f32_16x16x32_bf16 a[136:139], v[64:67], v[208:211], a[136:139]
v_cvt_pk_bf16_f32 v93, v146, v147
v_accvgpr_read_b32 v152, a108
v_mfma_f32_16x16x32_bf16 a[140:143], v[96:99], v[208:211], a[140:143]
ds_read_b64_tr_b16 v[208:209], v13 offset:24576
s_waitcnt lgkmcnt(5)
v_mfma_f32_16x16x32_bf16 a[144:147], v[4:7], v[212:215], a[144:147]
ds_read_b64_tr_b16 v[210:211], v13 offset:26624
v_accvgpr_read_b32 v153, a109
v_mfma_f32_16x16x32_bf16 a[148:151], v[36:39], v[212:215], a[148:151]
v_accvgpr_read_b32 v154, a110
v_accvgpr_read_b32 v155, a111
v_mfma_f32_16x16x32_bf16 a[152:155], v[68:71], v[212:215], a[152:155]
v_cvt_pk_bf16_f32 v124, v152, v153
v_cvt_pk_bf16_f32 v125, v154, v155
v_mfma_f32_16x16x32_bf16 a[156:159], v[100:103], v[212:215], a[156:159]
ds_read_b64_tr_b16 v[212:213], v15 offset:8192
s_waitcnt lgkmcnt(3)
v_mfma_f32_16x16x32_bf16 a[144:147], v[8:11], v[216:219], a[144:147]
ds_read_b64_tr_b16 v[214:215], v15 offset:10240
v_accvgpr_read_b32 v132, a112
v_mfma_f32_16x16x32_bf16 a[144:147], v[160:163], v[220:223], a[144:147]
v_accvgpr_read_b32 v133, a113
v_accvgpr_read_b32 v134, a114
v_mfma_f32_16x16x32_bf16 a[148:151], v[40:43], v[216:219], a[148:151]
v_accvgpr_read_b32 v135, a115
v_cvt_pk_bf16_f32 v30, v132, v133
v_mfma_f32_16x16x32_bf16 a[148:151], v[164:167], v[220:223], a[148:151]
v_cvt_pk_bf16_f32 v31, v134, v135
buffer_store_dwordx4 v[28:31], v248, s[20:23], s40 offen offset:3072 sc1
v_mfma_f32_16x16x32_bf16 a[152:155], v[72:75], v[216:219], a[152:155]
ds_write_b128 v253, v[28:31] offset:3072
v_accvgpr_read_b32 v140, a116
v_mfma_f32_16x16x32_bf16 a[152:155], v[168:171], v[220:223], a[152:155]
v_accvgpr_read_b32 v141, a117
v_accvgpr_read_b32 v142, a118
v_mfma_f32_16x16x32_bf16 a[156:159], v[104:107], v[216:219], a[156:159]
ds_read_b64_tr_b16 v[216:217], v249 offset:8704
ds_read_b64_tr_b16 v[218:219], v249 offset:10752
v_mfma_f32_16x16x32_bf16 a[156:159], v[172:175], v[220:223], a[156:159]
ds_read_b64_tr_b16 v[220:221], v249 offset:25088
s_waitcnt lgkmcnt(3)
v_mfma_f32_16x16x32_bf16 a[144:147], v[176:179], v[208:211], a[144:147]
ds_read_b64_tr_b16 v[222:223], v249 offset:27136
v_accvgpr_read_b32 v143, a119
v_mfma_f32_16x16x32_bf16 a[144:147], v[0:3], v[212:215], a[144:147]
v_cvt_pk_bf16_f32 v62, v140, v141
v_cvt_pk_bf16_f32 v63, v142, v143
v_mfma_f32_16x16x32_bf16 a[148:151], v[180:183], v[208:211], a[148:151]
buffer_store_dwordx4 v[60:63], v248, s[20:23], s41 offen offset:3072 sc1
v_accvgpr_read_b32 v148, a120
v_mfma_f32_16x16x32_bf16 a[148:151], v[32:35], v[212:215], a[148:151]
v_accvgpr_read_b32 v149, a121
v_accvgpr_read_b32 v150, a122
v_mfma_f32_16x16x32_bf16 a[152:155], v[184:187], v[208:211], a[152:155]
v_accvgpr_read_b32 v151, a123
v_cvt_pk_bf16_f32 v94, v148, v149
v_mfma_f32_16x16x32_bf16 a[152:155], v[64:67], v[212:215], a[152:155]
v_cvt_pk_bf16_f32 v95, v150, v151
buffer_store_dwordx4 v[92:95], v248, s[20:23], s42 offen offset:3072 sc1
v_mfma_f32_16x16x32_bf16 a[156:159], v[188:191], v[208:211], a[156:159]
ds_read_b64_tr_b16 v[208:209], v12 offset:8704
ds_read_b64_tr_b16 v[210:211], v12 offset:10752
v_mfma_f32_16x16x32_bf16 a[156:159], v[96:99], v[212:215], a[156:159]
ds_read_b64_tr_b16 v[212:213], v12 offset:25088
s_waitcnt lgkmcnt(3)
v_mfma_f32_16x16x32_bf16 a[160:163], v[4:7], v[216:219], a[160:163]
ds_read_b64_tr_b16 v[214:215], v12 offset:27136
v_accvgpr_read_b32 v156, a124
v_mfma_f32_16x16x32_bf16 a[160:163], v[8:11], v[220:223], a[160:163]
v_accvgpr_read_b32 v157, a125
v_accvgpr_read_b32 v158, a126
v_mfma_f32_16x16x32_bf16 a[164:167], v[36:39], v[216:219], a[164:167]
v_accvgpr_read_b32 v159, a127
v_cvt_pk_bf16_f32 v126, v156, v157
v_mfma_f32_16x16x32_bf16 a[164:167], v[40:43], v[220:223], a[164:167]
v_cvt_pk_bf16_f32 v127, v158, v159
buffer_store_dwordx4 v[124:127], v248, s[20:23], s43 offen offset:3072 sc1
v_mfma_f32_16x16x32_bf16 a[168:171], v[68:71], v[216:219], a[168:171]
v_accvgpr_read_b32 v128, a128
v_accvgpr_read_b32 v129, a129
v_mfma_f32_16x16x32_bf16 a[168:171], v[72:75], v[220:223], a[168:171]
v_accvgpr_read_b32 v130, a130
v_accvgpr_read_b32 v131, a131
v_mfma_f32_16x16x32_bf16 a[172:175], v[100:103], v[216:219], a[172:175]
ds_read_b64_tr_b16 v[216:217], v14 offset:8704
ds_read_b64_tr_b16 v[218:219], v14 offset:10752
v_mfma_f32_16x16x32_bf16 a[172:175], v[104:107], v[220:223], a[172:175]
ds_read_b64_tr_b16 v[220:221], v250 offset:8704
s_waitcnt lgkmcnt(3)
v_mfma_f32_16x16x32_bf16 a[160:163], v[160:163], v[208:211], a[160:163]
ds_read_b64_tr_b16 v[222:223], v250 offset:10752
v_cvt_pk_bf16_f32 v16, v128, v129
v_mfma_f32_16x16x32_bf16 a[160:163], v[176:179], v[212:215], a[160:163]
v_cvt_pk_bf16_f32 v17, v130, v131
v_accvgpr_read_b32 v136, a132
v_mfma_f32_16x16x32_bf16 a[164:167], v[164:167], v[208:211], a[164:167]
v_accvgpr_read_b32 v137, a133
v_accvgpr_read_b32 v138, a134
v_mfma_f32_16x16x32_bf16 a[164:167], v[180:183], v[212:215], a[164:167]
v_accvgpr_read_b32 v139, a135
v_cvt_pk_bf16_f32 v48, v136, v137
v_mfma_f32_16x16x32_bf16 a[168:171], v[168:171], v[208:211], a[168:171]
v_cvt_pk_bf16_f32 v49, v138, v139
v_accvgpr_read_b32 v144, a136
v_mfma_f32_16x16x32_bf16 a[168:171], v[184:187], v[212:215], a[168:171]
v_accvgpr_read_b32 v145, a137
v_accvgpr_read_b32 v146, a138
v_mfma_f32_16x16x32_bf16 a[172:175], v[172:175], v[208:211], a[172:175]
ds_read_b64_tr_b16 v[208:209], v250 offset:25088
ds_read_b64_tr_b16 v[210:211], v250 offset:27136
v_mfma_f32_16x16x32_bf16 a[172:175], v[188:191], v[212:215], a[172:175]
ds_read_b64_tr_b16 v[212:213], v13 offset:8704
s_waitcnt lgkmcnt(5)
v_mfma_f32_16x16x32_bf16 a[160:163], v[0:3], v[216:219], a[160:163]
ds_read_b64_tr_b16 v[214:215], v13 offset:10752
v_accvgpr_read_b32 v147, a139
v_mfma_f32_16x16x32_bf16 a[164:167], v[32:35], v[216:219], a[164:167]
v_cvt_pk_bf16_f32 v80, v144, v145
v_cvt_pk_bf16_f32 v81, v146, v147
v_mfma_f32_16x16x32_bf16 a[168:171], v[64:67], v[216:219], a[168:171]
v_accvgpr_read_b32 v152, a140
v_accvgpr_read_b32 v153, a141
v_mfma_f32_16x16x32_bf16 a[172:175], v[96:99], v[216:219], a[172:175]
ds_read_b64_tr_b16 v[216:217], v13 offset:25088
s_waitcnt lgkmcnt(5)
v_mfma_f32_16x16x32_bf16 a[176:179], v[4:7], v[220:223], a[176:179]
ds_read_b64_tr_b16 v[218:219], v13 offset:27136
v_accvgpr_read_b32 v154, a142
v_mfma_f32_16x16x32_bf16 a[180:183], v[36:39], v[220:223], a[180:183]
v_accvgpr_read_b32 v155, a143
v_cvt_pk_bf16_f32 v112, v152, v153
v_mfma_f32_16x16x32_bf16 a[184:187], v[68:71], v[220:223], a[184:187]
v_cvt_pk_bf16_f32 v113, v154, v155
v_accvgpr_read_b32 v132, a144
v_mfma_f32_16x16x32_bf16 a[188:191], v[100:103], v[220:223], a[188:191]
ds_read_b64_tr_b16 v[220:221], v15 offset:8704
s_waitcnt lgkmcnt(3)
v_mfma_f32_16x16x32_bf16 a[176:179], v[8:11], v[208:211], a[176:179]
ds_read_b64_tr_b16 v[222:223], v15 offset:10752
v_accvgpr_read_b32 v133, a145
v_mfma_f32_16x16x32_bf16 a[176:179], v[160:163], v[212:215], a[176:179]
v_accvgpr_read_b32 v134, a146
v_accvgpr_read_b32 v135, a147
v_mfma_f32_16x16x32_bf16 a[180:183], v[40:43], v[208:211], a[180:183]
v_cvt_pk_bf16_f32 v18, v132, v133
v_cvt_pk_bf16_f32 v19, v134, v135
v_mfma_f32_16x16x32_bf16 a[180:183], v[164:167], v[212:215], a[180:183]
buffer_store_dwordx4 v[16:19], v248, s[20:23], s44 offen offset:0 sc1
ds_write_b128 v253, v[16:19] offset:4096
v_mfma_f32_16x16x32_bf16 a[184:187], v[72:75], v[208:211], a[184:187]
v_accvgpr_read_b32 v140, a148
v_accvgpr_read_b32 v141, a149
v_mfma_f32_16x16x32_bf16 a[184:187], v[168:171], v[212:215], a[184:187]
v_accvgpr_read_b32 v142, a150
v_accvgpr_read_b32 v143, a151
v_mfma_f32_16x16x32_bf16 a[188:191], v[104:107], v[208:211], a[188:191]
ds_read_b64_tr_b16 v[208:209], v249 offset:12288
ds_read_b64_tr_b16 v[210:211], v249 offset:14336
v_mfma_f32_16x16x32_bf16 a[188:191], v[172:175], v[212:215], a[188:191]
ds_read_b64_tr_b16 v[212:213], v249 offset:28672
s_waitcnt lgkmcnt(3)
v_mfma_f32_16x16x32_bf16 a[176:179], v[176:179], v[216:219], a[176:179]
ds_read_b64_tr_b16 v[214:215], v249 offset:30720
v_cvt_pk_bf16_f32 v50, v140, v141
v_mfma_f32_16x16x32_bf16 a[176:179], v[0:3], v[220:223], a[176:179]
v_cvt_pk_bf16_f32 v51, v142, v143
buffer_store_dwordx4 v[48:51], v248, s[20:23], s45 offen offset:0 sc1
v_mfma_f32_16x16x32_bf16 a[180:183], v[180:183], v[216:219], a[180:183]
v_accvgpr_read_b32 v148, a152
v_accvgpr_read_b32 v149, a153
v_mfma_f32_16x16x32_bf16 a[180:183], v[32:35], v[220:223], a[180:183]
v_accvgpr_read_b32 v150, a154
v_accvgpr_read_b32 v151, a155
v_mfma_f32_16x16x32_bf16 a[184:187], v[184:187], v[216:219], a[184:187]
v_cvt_pk_bf16_f32 v82, v148, v149
v_cvt_pk_bf16_f32 v83, v150, v151
v_mfma_f32_16x16x32_bf16 a[184:187], v[64:67], v[220:223], a[184:187]
buffer_store_dwordx4 v[80:83], v248, s[20:23], s46 offen offset:0 sc1
v_accvgpr_read_b32 v156, a156
v_mfma_f32_16x16x32_bf16 a[188:191], v[188:191], v[216:219], a[188:191]
ds_read_b64_tr_b16 v[216:217], v12 offset:12288
ds_read_b64_tr_b16 v[218:219], v12 offset:14336
v_mfma_f32_16x16x32_bf16 a[188:191], v[96:99], v[220:223], a[188:191]
ds_read_b64_tr_b16 v[220:221], v12 offset:28672
s_waitcnt lgkmcnt(3)
v_mfma_f32_16x16x32_bf16 a[192:195], v[4:7], v[208:211], a[192:195]
ds_read_b64_tr_b16 v[222:223], v12 offset:30720
v_accvgpr_read_b32 v157, a157
v_mfma_f32_16x16x32_bf16 a[192:195], v[8:11], v[212:215], a[192:195]
v_accvgpr_read_b32 v158, a158
v_accvgpr_read_b32 v159, a159
v_mfma_f32_16x16x32_bf16 a[196:199], v[36:39], v[208:211], a[196:199]
v_cvt_pk_bf16_f32 v114, v156, v157
v_cvt_pk_bf16_f32 v115, v158, v159
v_mfma_f32_16x16x32_bf16 a[196:199], v[40:43], v[212:215], a[196:199]
buffer_store_dwordx4 v[112:115], v248, s[20:23], s47 offen offset:0 sc1
v_accvgpr_read_b32 v128, a160
v_mfma_f32_16x16x32_bf16 a[200:203], v[68:71], v[208:211], a[200:203]
v_accvgpr_read_b32 v129, a161
v_accvgpr_read_b32 v130, a162
v_mfma_f32_16x16x32_bf16 a[200:203], v[72:75], v[212:215], a[200:203]
v_accvgpr_read_b32 v131, a163
v_cvt_pk_bf16_f32 v20, v128, v129
v_mfma_f32_16x16x32_bf16 a[204:207], v[100:103], v[208:211], a[204:207]
ds_read_b64_tr_b16 v[208:209], v14 offset:12288
ds_read_b64_tr_b16 v[210:211], v14 offset:14336
v_mfma_f32_16x16x32_bf16 a[204:207], v[104:107], v[212:215], a[204:207]
ds_read_b64_tr_b16 v[212:213], v250 offset:12288
s_waitcnt lgkmcnt(3)
v_mfma_f32_16x16x32_bf16 a[192:195], v[160:163], v[216:219], a[192:195]
ds_read_b64_tr_b16 v[214:215], v250 offset:14336
v_cvt_pk_bf16_f32 v21, v130, v131
v_mfma_f32_16x16x32_bf16 a[192:195], v[176:179], v[220:223], a[192:195]
v_accvgpr_read_b32 v136, a164
v_accvgpr_read_b32 v137, a165
v_mfma_f32_16x16x32_bf16 a[196:199], v[164:167], v[216:219], a[196:199]
v_accvgpr_read_b32 v138, a166
v_accvgpr_read_b32 v139, a167
v_mfma_f32_16x16x32_bf16 a[196:199], v[180:183], v[220:223], a[196:199]
v_cvt_pk_bf16_f32 v52, v136, v137
v_cvt_pk_bf16_f32 v53, v138, v139
v_mfma_f32_16x16x32_bf16 a[200:203], v[168:171], v[216:219], a[200:203]
v_accvgpr_read_b32 v144, a168
v_accvgpr_read_b32 v145, a169
v_mfma_f32_16x16x32_bf16 a[200:203], v[184:187], v[220:223], a[200:203]
v_accvgpr_read_b32 v146, a170
v_accvgpr_read_b32 v147, a171
v_mfma_f32_16x16x32_bf16 a[204:207], v[172:175], v[216:219], a[204:207]
ds_read_b64_tr_b16 v[216:217], v250 offset:28672
ds_read_b64_tr_b16 v[218:219], v250 offset:30720
v_mfma_f32_16x16x32_bf16 a[204:207], v[188:191], v[220:223], a[204:207]
ds_read_b64_tr_b16 v[220:221], v13 offset:12288
s_waitcnt lgkmcnt(5)
v_mfma_f32_16x16x32_bf16 a[192:195], v[0:3], v[208:211], a[192:195]
ds_read_b64_tr_b16 v[222:223], v13 offset:14336
v_cvt_pk_bf16_f32 v84, v144, v145
v_mfma_f32_16x16x32_bf16 a[196:199], v[32:35], v[208:211], a[196:199]
v_cvt_pk_bf16_f32 v85, v146, v147
v_accvgpr_read_b32 v152, a172
v_mfma_f32_16x16x32_bf16 a[200:203], v[64:67], v[208:211], a[200:203]
v_accvgpr_read_b32 v153, a173
v_accvgpr_read_b32 v154, a174
v_mfma_f32_16x16x32_bf16 a[204:207], v[96:99], v[208:211], a[204:207]
ds_read_b64_tr_b16 v[208:209], v13 offset:28672
s_waitcnt lgkmcnt(5)
v_mfma_f32_16x16x32_bf16 a[208:211], v[4:7], v[212:215], a[208:211]
ds_read_b64_tr_b16 v[210:211], v13 offset:30720
v_accvgpr_read_b32 v155, a175
v_mfma_f32_16x16x32_bf16 a[212:215], v[36:39], v[212:215], a[212:215]
v_cvt_pk_bf16_f32 v116, v152, v153
v_cvt_pk_bf16_f32 v117, v154, v155
v_mfma_f32_16x16x32_bf16 a[216:219], v[68:71], v[212:215], a[216:219]
v_accvgpr_read_b32 v132, a176
v_accvgpr_read_b32 v133, a177
v_mfma_f32_16x16x32_bf16 a[220:223], v[100:103], v[212:215], a[220:223]
ds_read_b64_tr_b16 v[212:213], v15 offset:12288
s_waitcnt lgkmcnt(3)
v_mfma_f32_16x16x32_bf16 a[208:211], v[8:11], v[216:219], a[208:211]
ds_read_b64_tr_b16 v[214:215], v15 offset:14336
v_accvgpr_read_b32 v134, a178
v_mfma_f32_16x16x32_bf16 a[208:211], v[160:163], v[220:223], a[208:211]
v_accvgpr_read_b32 v135, a179
v_cvt_pk_bf16_f32 v22, v132, v133
v_mfma_f32_16x16x32_bf16 a[212:215], v[40:43], v[216:219], a[212:215]
v_cvt_pk_bf16_f32 v23, v134, v135
buffer_store_dwordx4 v[20:23], v248, s[20:23], s44 offen offset:1024 sc1
v_mfma_f32_16x16x32_bf16 a[212:215], v[164:167], v[220:223], a[212:215]
ds_write_b128 v253, v[20:23] offset:5120
v_accvgpr_read_b32 v140, a180
v_mfma_f32_16x16x32_bf16 a[216:219], v[72:75], v[216:219], a[216:219]
v_accvgpr_read_b32 v141, a181
v_accvgpr_read_b32 v142, a182
v_mfma_f32_16x16x32_bf16 a[216:219], v[168:171], v[220:223], a[216:219]
v_accvgpr_read_b32 v143, a183
v_cvt_pk_bf16_f32 v54, v140, v141
v_mfma_f32_16x16x32_bf16 a[220:223], v[104:107], v[216:219], a[220:223]
ds_read_b64_tr_b16 v[216:217], v249 offset:12800
ds_read_b64_tr_b16 v[218:219], v249 offset:14848
v_mfma_f32_16x16x32_bf16 a[220:223], v[172:175], v[220:223], a[220:223]
ds_read_b64_tr_b16 v[220:221], v249 offset:29184
s_waitcnt lgkmcnt(3)
v_mfma_f32_16x16x32_bf16 a[208:211], v[176:179], v[208:211], a[208:211]
ds_read_b64_tr_b16 v[222:223], v249 offset:31232
v_cvt_pk_bf16_f32 v55, v142, v143
v_mfma_f32_16x16x32_bf16 a[208:211], v[0:3], v[212:215], a[208:211]
buffer_store_dwordx4 v[52:55], v248, s[20:23], s45 offen offset:1024 sc1
v_accvgpr_read_b32 v148, a184
v_mfma_f32_16x16x32_bf16 a[212:215], v[180:183], v[208:211], a[212:215]
v_accvgpr_read_b32 v149, a185
v_accvgpr_read_b32 v150, a186
v_mfma_f32_16x16x32_bf16 a[212:215], v[32:35], v[212:215], a[212:215]
v_accvgpr_read_b32 v151, a187
v_cvt_pk_bf16_f32 v86, v148, v149
v_mfma_f32_16x16x32_bf16 a[216:219], v[184:187], v[208:211], a[216:219]
v_cvt_pk_bf16_f32 v87, v150, v151
buffer_store_dwordx4 v[84:87], v248, s[20:23], s46 offen offset:1024 sc1
v_mfma_f32_16x16x32_bf16 a[216:219], v[64:67], v[212:215], a[216:219]
v_accvgpr_read_b32 v156, a188
v_accvgpr_read_b32 v157, a189
v_mfma_f32_16x16x32_bf16 a[220:223], v[188:191], v[208:211], a[220:223]
ds_read_b64_tr_b16 v[208:209], v12 offset:12800
ds_read_b64_tr_b16 v[210:211], v12 offset:14848
v_mfma_f32_16x16x32_bf16 a[220:223], v[96:99], v[212:215], a[220:223]
ds_read_b64_tr_b16 v[212:213], v12 offset:29184
s_waitcnt lgkmcnt(3)
v_mfma_f32_16x16x32_bf16 a[224:227], v[4:7], v[216:219], a[224:227]
ds_read_b64_tr_b16 v[214:215], v12 offset:31232
v_accvgpr_read_b32 v158, a190
v_mfma_f32_16x16x32_bf16 a[224:227], v[8:11], v[220:223], a[224:227]
v_accvgpr_read_b32 v159, a191
v_cvt_pk_bf16_f32 v118, v156, v157
v_mfma_f32_16x16x32_bf16 a[228:231], v[36:39], v[216:219], a[228:231]
v_cvt_pk_bf16_f32 v119, v158, v159
buffer_store_dwordx4 v[116:119], v248, s[20:23], s47 offen offset:1024 sc1
v_mfma_f32_16x16x32_bf16 a[228:231], v[40:43], v[220:223], a[228:231]
v_accvgpr_read_b32 v128, a192
v_accvgpr_read_b32 v129, a193
v_mfma_f32_16x16x32_bf16 a[232:235], v[68:71], v[216:219], a[232:235]
v_accvgpr_read_b32 v130, a194
v_accvgpr_read_b32 v131, a195
v_mfma_f32_16x16x32_bf16 a[232:235], v[72:75], v[220:223], a[232:235]
v_cvt_pk_bf16_f32 v24, v128, v129
v_cvt_pk_bf16_f32 v25, v130, v131
v_mfma_f32_16x16x32_bf16 a[236:239], v[100:103], v[216:219], a[236:239]
ds_read_b64_tr_b16 v[216:217], v14 offset:12800
ds_read_b64_tr_b16 v[218:219], v14 offset:14848
v_mfma_f32_16x16x32_bf16 a[236:239], v[104:107], v[220:223], a[236:239]
ds_read_b64_tr_b16 v[220:221], v250 offset:12800
s_waitcnt lgkmcnt(3)
v_mfma_f32_16x16x32_bf16 a[224:227], v[160:163], v[208:211], a[224:227]
ds_read_b64_tr_b16 v[222:223], v250 offset:14848
v_accvgpr_read_b32 v136, a196
v_mfma_f32_16x16x32_bf16 a[224:227], v[176:179], v[212:215], a[224:227]
v_accvgpr_read_b32 v137, a197
v_accvgpr_read_b32 v138, a198
v_mfma_f32_16x16x32_bf16 a[228:231], v[164:167], v[208:211], a[228:231]
v_accvgpr_read_b32 v139, a199
v_cvt_pk_bf16_f32 v56, v136, v137
v_mfma_f32_16x16x32_bf16 a[228:231], v[180:183], v[212:215], a[228:231]
v_cvt_pk_bf16_f32 v57, v138, v139
v_accvgpr_read_b32 v144, a200
v_mfma_f32_16x16x32_bf16 a[232:235], v[168:171], v[208:211], a[232:235]
v_accvgpr_read_b32 v145, a201
v_accvgpr_read_b32 v146, a202
v_mfma_f32_16x16x32_bf16 a[232:235], v[184:187], v[212:215], a[232:235]
v_accvgpr_read_b32 v147, a203
v_cvt_pk_bf16_f32 v88, v144, v145
v_mfma_f32_16x16x32_bf16 a[236:239], v[172:175], v[208:211], a[236:239]
ds_read_b64_tr_b16 v[208:209], v250 offset:29184
ds_read_b64_tr_b16 v[210:211], v250 offset:31232
v_mfma_f32_16x16x32_bf16 a[236:239], v[188:191], v[212:215], a[236:239]
ds_read_b64_tr_b16 v[212:213], v13 offset:12800
s_waitcnt lgkmcnt(5)
v_mfma_f32_16x16x32_bf16 a[224:227], v[0:3], v[216:219], a[224:227]
ds_read_b64_tr_b16 v[214:215], v13 offset:14848
v_cvt_pk_bf16_f32 v89, v146, v147
v_mfma_f32_16x16x32_bf16 a[228:231], v[32:35], v[216:219], a[228:231]
v_accvgpr_read_b32 v152, a204
v_accvgpr_read_b32 v153, a205
v_mfma_f32_16x16x32_bf16 a[232:235], v[64:67], v[216:219], a[232:235]
v_accvgpr_read_b32 v154, a206
v_accvgpr_read_b32 v155, a207
v_mfma_f32_16x16x32_bf16 a[236:239], v[96:99], v[216:219], a[236:239]
ds_read_b64_tr_b16 v[216:217], v13 offset:29184
s_waitcnt lgkmcnt(5)
v_mfma_f32_16x16x32_bf16 a[240:243], v[4:7], v[220:223], a[240:243]
ds_read_b64_tr_b16 v[218:219], v13 offset:31232
v_cvt_pk_bf16_f32 v120, v152, v153
v_mfma_f32_16x16x32_bf16 a[244:247], v[36:39], v[220:223], a[244:247]
v_cvt_pk_bf16_f32 v121, v154, v155
v_accvgpr_read_b32 v132, a208
v_mfma_f32_16x16x32_bf16 a[248:251], v[68:71], v[220:223], a[248:251]
v_accvgpr_read_b32 v133, a209
v_accvgpr_read_b32 v134, a210
v_mfma_f32_16x16x32_bf16 a[252:255], v[100:103], v[220:223], a[252:255]
ds_read_b64_tr_b16 v[220:221], v15 offset:12800
s_waitcnt lgkmcnt(3)
v_mfma_f32_16x16x32_bf16 a[240:243], v[8:11], v[208:211], a[240:243]
ds_read_b64_tr_b16 v[222:223], v15 offset:14848
v_accvgpr_read_b32 v135, a211
v_mfma_f32_16x16x32_bf16 a[240:243], v[160:163], v[212:215], a[240:243]
v_cvt_pk_bf16_f32 v26, v132, v133
v_cvt_pk_bf16_f32 v27, v134, v135
v_mfma_f32_16x16x32_bf16 a[244:247], v[40:43], v[208:211], a[244:247]
buffer_store_dwordx4 v[24:27], v248, s[20:23], s44 offen offset:2048 sc1
ds_write_b128 v253, v[24:27] offset:6144
v_mfma_f32_16x16x32_bf16 a[244:247], v[164:167], v[212:215], a[244:247]
v_accvgpr_read_b32 v140, a212
v_accvgpr_read_b32 v141, a213
v_mfma_f32_16x16x32_bf16 a[248:251], v[72:75], v[208:211], a[248:251]
v_accvgpr_read_b32 v142, a214
v_accvgpr_read_b32 v143, a215
v_mfma_f32_16x16x32_bf16 a[248:251], v[168:171], v[212:215], a[248:251]
v_cvt_pk_bf16_f32 v58, v140, v141
v_cvt_pk_bf16_f32 v59, v142, v143
v_mfma_f32_16x16x32_bf16 a[252:255], v[104:107], v[208:211], a[252:255]
buffer_store_dwordx4 v[56:59], v248, s[20:23], s45 offen offset:2048 sc1
v_accvgpr_read_b32 v148, a216
v_mfma_f32_16x16x32_bf16 a[252:255], v[172:175], v[212:215], a[252:255]
s_waitcnt lgkmcnt(0)
v_accvgpr_read_b32 v149, a217
v_mfma_f32_16x16x32_bf16 a[240:243], v[176:179], v[216:219], a[240:243]
v_accvgpr_read_b32 v150, a218
v_accvgpr_read_b32 v151, a219
v_mfma_f32_16x16x32_bf16 a[240:243], v[0:3], v[220:223], a[240:243]
v_cvt_pk_bf16_f32 v90, v148, v149
v_cvt_pk_bf16_f32 v91, v150, v151
v_mfma_f32_16x16x32_bf16 a[244:247], v[180:183], v[216:219], a[244:247]
buffer_store_dwordx4 v[88:91], v248, s[20:23], s46 offen offset:2048 sc1
v_accvgpr_read_b32 v156, a220
v_mfma_f32_16x16x32_bf16 a[244:247], v[32:35], v[220:223], a[244:247]
v_accvgpr_read_b32 v157, a221
v_accvgpr_read_b32 v158, a222
v_mfma_f32_16x16x32_bf16 a[248:251], v[184:187], v[216:219], a[248:251]
v_accvgpr_read_b32 v159, a223
v_cvt_pk_bf16_f32 v122, v156, v157
v_mfma_f32_16x16x32_bf16 a[248:251], v[64:67], v[220:223], a[248:251]
v_cvt_pk_bf16_f32 v123, v158, v159
buffer_store_dwordx4 v[120:123], v248, s[20:23], s47 offen offset:2048 sc1
v_mfma_f32_16x16x32_bf16 a[252:255], v[188:191], v[216:219], a[252:255]
v_accvgpr_read_b32 v128, a224
v_accvgpr_read_b32 v129, a225
v_mfma_f32_16x16x32_bf16 a[252:255], v[96:99], v[220:223], a[252:255]
v_accvgpr_read_b32 v130, a226
v_accvgpr_read_b32 v131, a227
v_cvt_pk_bf16_f32 v28, v128, v129
v_cvt_pk_bf16_f32 v29, v130, v131
v_accvgpr_read_b32 v136, a228
v_accvgpr_read_b32 v137, a229
v_accvgpr_read_b32 v138, a230
v_accvgpr_read_b32 v139, a231
v_cvt_pk_bf16_f32 v60, v136, v137
v_cvt_pk_bf16_f32 v61, v138, v139
v_accvgpr_read_b32 v144, a232
v_accvgpr_read_b32 v145, a233
v_accvgpr_read_b32 v146, a234
v_accvgpr_read_b32 v147, a235
v_cvt_pk_bf16_f32 v92, v144, v145
v_cvt_pk_bf16_f32 v93, v146, v147
v_accvgpr_read_b32 v152, a236
v_accvgpr_read_b32 v153, a237
v_accvgpr_read_b32 v154, a238
v_accvgpr_read_b32 v155, a239
v_cvt_pk_bf16_f32 v124, v152, v153
v_cvt_pk_bf16_f32 v125, v154, v155
v_accvgpr_read_b32 v132, a240
v_accvgpr_read_b32 v133, a241
v_accvgpr_read_b32 v134, a242
v_accvgpr_read_b32 v135, a243
v_cvt_pk_bf16_f32 v30, v132, v133
v_cvt_pk_bf16_f32 v31, v134, v135
buffer_store_dwordx4 v[28:31], v248, s[20:23], s44 offen offset:3072 sc1
ds_write_b128 v253, v[28:31] offset:7168
v_accvgpr_read_b32 v140, a244
v_accvgpr_read_b32 v141, a245
v_accvgpr_read_b32 v142, a246
v_accvgpr_read_b32 v143, a247
v_cvt_pk_bf16_f32 v62, v140, v141
v_cvt_pk_bf16_f32 v63, v142, v143
buffer_store_dwordx4 v[60:63], v248, s[20:23], s45 offen offset:3072 sc1
v_accvgpr_read_b32 v148, a248
v_accvgpr_read_b32 v149, a249
v_accvgpr_read_b32 v150, a250
v_accvgpr_read_b32 v151, a251
v_cvt_pk_bf16_f32 v94, v148, v149
v_cvt_pk_bf16_f32 v95, v150, v151
buffer_store_dwordx4 v[92:95], v248, s[20:23], s46 offen offset:3072 sc1
v_accvgpr_read_b32 v156, a252
v_accvgpr_read_b32 v157, a253
v_accvgpr_read_b32 v158, a254
v_accvgpr_read_b32 v159, a255
v_cvt_pk_bf16_f32 v126, v156, v157
v_cvt_pk_bf16_f32 v127, v158, v159
buffer_store_dwordx4 v[124:127], v248, s[20:23], s47 offen offset:3072 sc1
s_waitcnt vmcnt(36)
s_branch L2_F
L2_F:
v_cmp_ne_u64 vcc, s[98:99], v[108:109]
s_lshl_b32 s3, s34, 15
s_add_u32 s3, s3, 0x1000000
s_cbranch_vccnz LF_wf
LF_wf_go:
v_add_u32 v240, s3, v248
v_add_u32 v241, 0x4000, v240
s_mov_b32 s32, 0x0
s_mov_b32 s33, 0x1000
s_mov_b32 s35, 0x2000
s_mov_b32 s36, 0x3000
s_mov_b32 s38, 0x20000
s_mov_b32 s39, 0x21000
s_mov_b32 s40, 0x22000
s_mov_b32 s41, 0x23000
s_lshr_b32 s42, s6, 13
s_lshr_b32 s43, s7, 13
s_lshr_b32 s44, s29, 13
v_mov_b32 v244, s42
v_mov_b32 v232, s43
v_cmp_lt_u32 vcc, 0xff, v248
v_mov_b32 v233, s44
s_nop 0
v_cndmask_b32 v244, v244, v232, vcc
v_cmp_lt_u32 vcc, 0x1ff, v248
v_and_b32 v235, 0xf0, v248
s_nop 0
v_cndmask_b32 v244, v244, v233, vcc
v_lshlrev_b32 v244, 11, v244
v_lshl_add_u32 v244, v235, 3, v244
v_lshrrev_b32 v79, 6, v244
buffer_load_ushort v79, v79, s[52:55], 0 offen
buffer_load_dwordx4 a[0:3], v240, s[16:19], s32 offen offset:0 sc1
buffer_load_dwordx4 a[4:7], v240, s[16:19], s32 offen offset:1024 sc1
buffer_load_dwordx4 a[8:11], v241, s[16:19], s32 offen offset:0 sc1
buffer_load_dwordx4 a[12:15], v241, s[16:19], s32 offen offset:1024 sc1
buffer_load_dwordx4 a[16:19], v240, s[16:19], s32 offen offset:2048 sc1
buffer_load_dwordx4 a[20:23], v240, s[16:19], s32 offen offset:3072 sc1
buffer_load_dwordx4 a[24:27], v241, s[16:19], s32 offen offset:2048 sc1
buffer_load_dwordx4 a[28:31], v241, s[16:19], s32 offen offset:3072 sc1
buffer_load_dwordx4 a[32:35], v240, s[16:19], s33 offen offset:0 sc1
buffer_load_dwordx4 a[36:39], v240, s[16:19], s33 offen offset:1024 sc1
buffer_load_dwordx4 a[40:43], v241, s[16:19], s33 offen offset:0 sc1
buffer_load_dwordx4 a[44:47], v241, s[16:19], s33 offen offset:1024 sc1
s_lshl_b32 s3, s37, 3
v_add3_u32 v244, v244, s3, 8
s_cmp_ge_u32 s29, 0x70000000
s_cselect_b32 s44, s43, s44
v_mov_b32 v46, s42
v_mov_b32 v232, s43
v_cmp_lt_u32 vcc, 0x7f, v248
v_mov_b32 v233, s44
s_nop 0
v_cndmask_b32 v46, v46, v232, vcc
v_cmp_lt_u32 vcc, 0xff, v248
v_bfe_u32 v232, v248, 4, 3
s_nop 0
v_cndmask_b32 v46, v46, v233, vcc
v_min_u32 v232, 5, v232
v_lshrrev_b32 v46, 2, v46
v_lshl_add_u32 v46, v46, 3, v232
v_lshlrev_b32 v46, 7, v46
v_add_u32 v46, 0x7c00000, v46
s_lshl_b32 s49, s34, 10
s_add_u32 s49, s49, 0x20000
s_bfe_u32 s3, s6, 0x2000f
s_lshl_b32 s3, s3, 13
s_add_u32 s3, s3, s49
v_add_u32 v76, s3, v248
s_bfe_u32 s3, s7, 0x2000f
s_lshl_b32 s3, s3, 13
s_add_u32 s3, s3, s49
v_add_u32 v77, s3, v248
s_bfe_u32 s3, s29, 0x2000f
s_lshl_b32 s3, s3, 13
s_add_u32 s3, s3, s49
v_add_u32 v78, s3, v248
s_add_u32 s3, s37, 1
s_sub_u32 s49, s3, 6
s_cselect_b32 s3, s3, s49
s_mul_i32 s3, s3, 0x600000
s_add_u32 s42, s3, 0x2000000
s_add_u32 s3, s37, 2
s_sub_u32 s49, s3, 6
s_cselect_b32 s3, s3, s49
s_mul_i32 s3, s3, 0x600000
s_add_u32 s43, s3, 0x2000000
s_add_u32 s3, s37, 3
s_sub_u32 s49, s3, 6
s_cselect_b32 s3, s3, s49
s_mul_i32 s3, s3, 0x600000
s_add_u32 s44, s3, 0x2000000
s_add_u32 s3, s37, 4
s_sub_u32 s49, s3, 6
s_cselect_b32 s3, s3, s49
s_mul_i32 s3, s3, 0x600000
s_add_u32 s45, s3, 0x2000000
s_add_u32 s3, s37, 5
s_sub_u32 s49, s3, 6
s_cselect_b32 s3, s3, s49
s_mul_i32 s3, s3, 0x600000
s_add_u32 s46, s3, 0x2000000
s_add_u32 s3, s37, 6
s_sub_u32 s49, s3, 6
s_cselect_b32 s3, s3, s49
s_mul_i32 s3, s3, 0x600000
s_add_u32 s47, s3, 0x2000000
s_mul_i32 s3, s34, 896
v_add_u32 v47, s3, v248
v_add_u32 v43, 0x1000, v47
v_lshrrev_b32 v44, 4, v248
v_and_b32 v44, 0x30, v44
v_xor_b32 v44, v44, v248
v_and_b32 v232, 0x380, v248
v_mad_u32_u24 v44, v232, 3, v44
v_xor_b32 v45, 0x1040, v44
v_bfe_u32 v232, v248, 5, 3
v_lshrrev_b32 v234, 8, v248
v_xor_b32 v232, v232, v234
v_bfe_u32 v233, v248, 4, 3
v_lshlrev_b32 v233, 7, v233
v_lshl_or_b32 v232, v232, 4, v233
v_bfe_u32 v233, v248, 7, 1
s_lshl_b32 s49, s34, 10
s_sub_u32 s3, s28, s49
v_lshl_add_u32 v74, v233, 12, v232
v_add_u32 v72, s3, v74
s_sub_u32 s3, s30, s49
v_add_u32 v74, s3, v74
v_xor_b32 v73, 64, v72
v_xor_b32 v75, 64, v74
v_lshl_add_u32 v245, v233, 10, v232
v_add_u32 v245, s31, v245
v_xor_b32 v246, 64, v245
v_add_u32 v247, s31, v248
s_add_u32 s3, s3, 0xa000
s_and_b32 s3, s3, 0x1ffff
v_add_u32 v252, s3, v248
v_add_u32 v251, s49, v252
s_lshl_b32 s49, s34, 11
s_add_u32 s3, s3, s49
s_add_u32 s3, s3, 24576
v_lshl_add_u32 v249, v248, 1, s3
v_lshl_add_u32 v250, v235, 1, s3
v_lshrrev_b32 v232, 4, v235
v_lshlrev_b32 v234, 2, v234
v_sub_u32 v232, v232, v234
v_and_b32 v233, 1, v232
v_lshlrev_b32 v233, 4, v233
v_mov_b32 v234, 0xffff
v_lshlrev_b32 v233, v233, v234
v_lshrrev_b32 v232, 1, v232
v_cmp_eq_u32 vcc, 0, v232
s_nop 1
v_cndmask_b32 v156, 0, v233, vcc
v_cmp_eq_u32 vcc, 1, v232
s_nop 1
v_cndmask_b32 v157, 0, v233, vcc
s_mov_b32 s95, 0xffff0000
s_waitcnt vmcnt(13)
v_mov_b32 v158, s98
v_mov_b32 v159, s99
s_mov_b64 exec, 1
buffer_store_dwordx2 v[158:159], off, s[16:19], s51 sc1
s_mov_b64 exec, -1
s_waitcnt lgkmcnt(0)
s_barrier
ds_read_b128 v[208:211], v72 offset:0
ds_read_b128 v[212:215], v72 offset:8192
ds_read_b128 v[216:219], v74 offset:0
ds_read_b128 v[220:223], v73 offset:0
ds_read_b128 v[224:227], v73 offset:8192
ds_read_b128 v[104:107], v245 offset:0
ds_read_b128 v[108:111], v246 offset:0
ds_read_b128 v[152:155], v245 offset:2048
s_waitcnt vmcnt(13)
v_lshlrev_b32 v79, 16, v79
ds_write_b32 v249, v79 offset:28
ds_read_b32 v253, v250 offset:28
ds_read_b32 v254, v250 offset:540
ds_read_b32 v255, v250 offset:1052
s_waitcnt vmcnt(12)
buffer_load_dwordx4 a[48:51], v240, s[16:19], s33 offen offset:2048 sc1
s_waitcnt vmcnt(12)
buffer_load_dwordx4 a[52:55], v240, s[16:19], s33 offen offset:3072 sc1
s_waitcnt vmcnt(12)
buffer_load_dwordx4 a[56:59], v241, s[16:19], s33 offen offset:2048 sc1
s_waitcnt vmcnt(12)
s_waitcnt lgkmcnt(11)
v_mfma_f32_16x16x32_bf16 v[160:163], a[0:3], v[208:211], 0
ds_read_b128 v[228:231], v75 offset:0
buffer_load_dwordx4 a[60:63], v241, s[16:19], s33 offen offset:3072 sc1
v_mfma_f32_16x16x32_bf16 v[164:167], a[4:7], v[208:211], 0
v_mfma_f32_16x16x32_bf16 v[168:171], a[8:11], v[208:211], 0
v_mfma_f32_16x16x32_bf16 v[172:175], a[12:15], v[208:211], 0
s_waitcnt vmcnt(12)
s_waitcnt lgkmcnt(11)
v_mfma_f32_16x16x32_bf16 v[176:179], a[0:3], v[212:215], 0
ds_read_b128 v[208:211], v72 offset:1024
buffer_load_dwordx4 a[64:67], v240, s[16:19], s35 offen offset:0 sc1
v_mfma_f32_16x16x32_bf16 v[180:183], a[4:7], v[212:215], 0
v_mfma_f32_16x16x32_bf16 v[184:187], a[8:11], v[212:215], 0
v_mfma_f32_16x16x32_bf16 v[188:191], a[12:15], v[212:215], 0
s_waitcnt vmcnt(12)
s_waitcnt lgkmcnt(11)
v_mfma_f32_16x16x32_bf16 v[192:195], a[0:3], v[216:219], 0
ds_read_b128 v[212:215], v72 offset:9216
buffer_load_dwordx4 a[68:71], v240, s[16:19], s35 offen offset:1024 sc1
v_mfma_f32_16x16x32_bf16 v[196:199], a[4:7], v[216:219], 0
v_mfma_f32_16x16x32_bf16 v[200:203], a[8:11], v[216:219], 0
v_mfma_f32_16x16x32_bf16 v[204:207], a[12:15], v[216:219], 0
s_waitcnt vmcnt(12)
buffer_load_dwordx4 a[72:75], v241, s[16:19], s35 offen offset:0 sc1
s_waitcnt vmcnt(12)
s_waitcnt lgkmcnt(11)
v_mfma_f32_16x16x32_bf16 v[160:163], a[16:19], v[220:223], v[160:163]
ds_read_b128 v[216:219], v74 offset:1024
buffer_load_dwordx4 a[76:79], v241, s[16:19], s35 offen offset:1024 sc1
v_mfma_f32_16x16x32_bf16 v[164:167], a[20:23], v[220:223], v[164:167]
v_mfma_f32_16x16x32_bf16 v[168:171], a[24:27], v[220:223], v[168:171]
v_mfma_f32_16x16x32_bf16 v[172:175], a[28:31], v[220:223], v[172:175]
s_waitcnt vmcnt(12)
s_waitcnt lgkmcnt(11)
v_mfma_f32_16x16x32_bf16 v[176:179], a[16:19], v[224:227], v[176:179]
ds_read_b128 v[220:223], v73 offset:1024
buffer_load_dwordx4 a[80:83], v240, s[16:19], s35 offen offset:2048 sc1
v_mfma_f32_16x16x32_bf16 v[180:183], a[20:23], v[224:227], v[180:183]
v_mfma_f32_16x16x32_bf16 v[184:187], a[24:27], v[224:227], v[184:187]
v_mfma_f32_16x16x32_bf16 v[188:191], a[28:31], v[224:227], v[188:191]
s_waitcnt vmcnt(12)
s_waitcnt lgkmcnt(4)
v_mfma_f32_16x16x32_bf16 v[192:195], a[16:19], v[228:231], v[192:195]
ds_read_b128 v[224:227], v73 offset:9216
buffer_load_dwordx4 a[84:87], v240, s[16:19], s35 offen offset:3072 sc1
v_mfma_f32_16x16x32_bf16 v[196:199], a[20:23], v[228:231], v[196:199]
v_mfma_f32_16x16x32_bf16 v[200:203], a[24:27], v[228:231], v[200:203]
v_mfma_f32_16x16x32_bf16 v[204:207], a[28:31], v[228:231], v[204:207]
s_waitcnt vmcnt(12)
buffer_load_dwordx4 a[88:91], v241, s[16:19], s35 offen offset:2048 sc1
s_waitcnt vmcnt(12)
s_waitcnt lgkmcnt(4)
v_mfma_f32_16x16x32_bf16 v[160:163], a[32:35], v[208:211], v[160:163]
ds_read_b128 v[228:231], v75 offset:1024
buffer_load_dwordx4 a[92:95], v241, s[16:19], s35 offen offset:3072 sc1
v_mfma_f32_16x16x32_bf16 v[164:167], a[36:39], v[208:211], v[164:167]
v_mfma_f32_16x16x32_bf16 v[168:171], a[40:43], v[208:211], v[168:171]
v_mfma_f32_16x16x32_bf16 v[172:175], a[44:47], v[208:211], v[172:175]
s_waitcnt lgkmcnt(4)
v_mfma_f32_16x16x32_bf16 v[176:179], a[32:35], v[212:215], v[176:179]
ds_read_b128 v[208:211], v72 offset:2048
v_mfma_f32_16x16x32_bf16 v[180:183], a[36:39], v[212:215], v[180:183]
v_mfma_f32_16x16x32_bf16 v[184:187], a[40:43], v[212:215], v[184:187]
v_mfma_f32_16x16x32_bf16 v[188:191], a[44:47], v[212:215], v[188:191]
s_waitcnt vmcnt(11)
s_waitcnt lgkmcnt(4)
v_mfma_f32_16x16x32_bf16 v[192:195], a[32:35], v[216:219], v[192:195]
ds_read_b128 v[212:215], v72 offset:10240
buffer_load_dwordx4 a[96:99], v240, s[16:19], s36 offen offset:0 sc1
v_mfma_f32_16x16x32_bf16 v[196:199], a[36:39], v[216:219], v[196:199]
v_mfma_f32_16x16x32_bf16 v[200:203], a[40:43], v[216:219], v[200:203]
v_mfma_f32_16x16x32_bf16 v[204:207], a[44:47], v[216:219], v[204:207]
s_waitcnt vmcnt(11)
buffer_load_dwordx4 a[100:103], v240, s[16:19], s36 offen offset:1024 sc1
s_waitcnt vmcnt(11)
buffer_load_dwordx4 a[104:107], v241, s[16:19], s36 offen offset:0 sc1
s_waitcnt vmcnt(11)
s_waitcnt lgkmcnt(4)
v_mfma_f32_16x16x32_bf16 v[160:163], a[48:51], v[220:223], v[160:163]
ds_read_b128 v[216:219], v74 offset:2048
buffer_load_dwordx4 a[108:111], v241, s[16:19], s36 offen offset:1024 sc1
v_mfma_f32_16x16x32_bf16 v[164:167], a[52:55], v[220:223], v[164:167]
v_mfma_f32_16x16x32_bf16 v[168:171], a[56:59], v[220:223], v[168:171]
v_mfma_f32_16x16x32_bf16 v[172:175], a[60:63], v[220:223], v[172:175]
s_waitcnt vmcnt(11)
s_waitcnt lgkmcnt(4)
v_mfma_f32_16x16x32_bf16 v[176:179], a[48:51], v[224:227], v[176:179]
ds_read_b128 v[220:223], v73 offset:2048
buffer_load_dwordx4 a[112:115], v240, s[16:19], s36 offen offset:2048 sc1
v_mfma_f32_16x16x32_bf16 v[180:183], a[52:55], v[224:227], v[180:183]
v_mfma_f32_16x16x32_bf16 v[184:187], a[56:59], v[224:227], v[184:187]
v_mfma_f32_16x16x32_bf16 v[188:191], a[60:63], v[224:227], v[188:191]
s_waitcnt vmcnt(11)
s_waitcnt lgkmcnt(4)
v_mfma_f32_16x16x32_bf16 v[192:195], a[48:51], v[228:231], v[192:195]
ds_read_b128 v[224:227], v73 offset:10240
buffer_load_dwordx4 a[116:119], v240, s[16:19], s36 offen offset:3072 sc1
v_mfma_f32_16x16x32_bf16 v[196:199], a[52:55], v[228:231], v[196:199]
v_mfma_f32_16x16x32_bf16 v[200:203], a[56:59], v[228:231], v[200:203]
v_mfma_f32_16x16x32_bf16 v[204:207], a[60:63], v[228:231], v[204:207]
s_waitcnt vmcnt(11)
buffer_load_dwordx4 a[120:123], v241, s[16:19], s36 offen offset:2048 sc1
s_waitcnt vmcnt(11)
s_waitcnt lgkmcnt(4)
v_mfma_f32_16x16x32_bf16 v[160:163], a[64:67], v[208:211], v[160:163]
ds_read_b128 v[228:231], v75 offset:2048
buffer_load_dwordx4 a[124:127], v241, s[16:19], s36 offen offset:3072 sc1
v_mfma_f32_16x16x32_bf16 v[164:167], a[68:71], v[208:211], v[164:167]
v_mfma_f32_16x16x32_bf16 v[168:171], a[72:75], v[208:211], v[168:171]
v_mfma_f32_16x16x32_bf16 v[172:175], a[76:79], v[208:211], v[172:175]
s_waitcnt vmcnt(11)
s_waitcnt lgkmcnt(4)
v_mfma_f32_16x16x32_bf16 v[176:179], a[64:67], v[212:215], v[176:179]
ds_read_b128 v[208:211], v72 offset:3072
buffer_load_dwordx4 a[128:131], v240, s[16:19], s38 offen offset:0 sc1
v_mfma_f32_16x16x32_bf16 v[180:183], a[68:71], v[212:215], v[180:183]
v_mfma_f32_16x16x32_bf16 v[184:187], a[72:75], v[212:215], v[184:187]
v_mfma_f32_16x16x32_bf16 v[188:191], a[76:79], v[212:215], v[188:191]
s_waitcnt vmcnt(11)
s_waitcnt lgkmcnt(4)
v_mfma_f32_16x16x32_bf16 v[192:195], a[64:67], v[216:219], v[192:195]
ds_read_b128 v[212:215], v72 offset:11264
buffer_load_dwordx4 a[132:135], v240, s[16:19], s38 offen offset:1024 sc1
v_mfma_f32_16x16x32_bf16 v[196:199], a[68:71], v[216:219], v[196:199]
v_mfma_f32_16x16x32_bf16 v[200:203], a[72:75], v[216:219], v[200:203]
v_mfma_f32_16x16x32_bf16 v[204:207], a[76:79], v[216:219], v[204:207]
s_waitcnt vmcnt(11)
buffer_load_dwordx4 a[136:139], v241, s[16:19], s38 offen offset:0 sc1
s_waitcnt vmcnt(11)
s_waitcnt lgkmcnt(4)
v_mfma_f32_16x16x32_bf16 v[160:163], a[80:83], v[220:223], v[160:163]
ds_read_b128 v[216:219], v74 offset:3072
buffer_load_dwordx4 a[140:143], v241, s[16:19], s38 offen offset:1024 sc1
v_mfma_f32_16x16x32_bf16 v[164:167], a[84:87], v[220:223], v[164:167]
v_mfma_f32_16x16x32_bf16 v[168:171], a[88:91], v[220:223], v[168:171]
v_mfma_f32_16x16x32_bf16 v[172:175], a[92:95], v[220:223], v[172:175]
s_waitcnt vmcnt(11)
s_waitcnt lgkmcnt(4)
v_mfma_f32_16x16x32_bf16 v[176:179], a[80:83], v[224:227], v[176:179]
ds_read_b128 v[220:223], v73 offset:3072
buffer_load_dwordx4 a[144:147], v240, s[16:19], s38 offen offset:2048 sc1
v_mfma_f32_16x16x32_bf16 v[180:183], a[84:87], v[224:227], v[180:183]
v_mfma_f32_16x16x32_bf16 v[184:187], a[88:91], v[224:227], v[184:187]
v_mfma_f32_16x16x32_bf16 v[188:191], a[92:95], v[224:227], v[188:191]
s_waitcnt vmcnt(11)
s_waitcnt lgkmcnt(4)
v_mfma_f32_16x16x32_bf16 v[192:195], a[80:83], v[228:231], v[192:195]
ds_read_b128 v[224:227], v73 offset:11264
buffer_load_dwordx4 a[148:151], v240, s[16:19], s38 offen offset:3072 sc1
v_mfma_f32_16x16x32_bf16 v[196:199], a[84:87], v[228:231], v[196:199]
v_mfma_f32_16x16x32_bf16 v[200:203], a[88:91], v[228:231], v[200:203]
v_mfma_f32_16x16x32_bf16 v[204:207], a[92:95], v[228:231], v[204:207]
s_waitcnt vmcnt(11)
buffer_load_dwordx4 a[152:155], v241, s[16:19], s38 offen offset:2048 sc1
s_waitcnt vmcnt(11)
s_waitcnt lgkmcnt(4)
v_mfma_f32_16x16x32_bf16 v[160:163], a[96:99], v[208:211], v[160:163]
ds_read_b128 v[228:231], v75 offset:3072
buffer_load_dwordx4 a[156:159], v241, s[16:19], s38 offen offset:3072 sc1
v_mfma_f32_16x16x32_bf16 v[164:167], a[100:103], v[208:211], v[164:167]
v_mfma_f32_16x16x32_bf16 v[168:171], a[104:107], v[208:211], v[168:171]
v_mfma_f32_16x16x32_bf16 v[172:175], a[108:111], v[208:211], v[172:175]
s_waitcnt vmcnt(11)
s_waitcnt lgkmcnt(4)
v_mfma_f32_16x16x32_bf16 v[176:179], a[96:99], v[212:215], v[176:179]
buffer_load_dwordx4 a[160:163], v240, s[16:19], s39 offen offset:0 sc1
v_mfma_f32_16x16x32_bf16 v[180:183], a[100:103], v[212:215], v[180:183]
v_mfma_f32_16x16x32_bf16 v[184:187], a[104:107], v[212:215], v[184:187]
v_mfma_f32_16x16x32_bf16 v[188:191], a[108:111], v[212:215], v[188:191]
s_waitcnt vmcnt(11)
s_waitcnt lgkmcnt(3)
v_mfma_f32_16x16x32_bf16 v[192:195], a[96:99], v[216:219], v[192:195]
buffer_load_dwordx4 a[164:167], v240, s[16:19], s39 offen offset:1024 sc1
v_mfma_f32_16x16x32_bf16 v[196:199], a[100:103], v[216:219], v[196:199]
v_mfma_f32_16x16x32_bf16 v[200:203], a[104:107], v[216:219], v[200:203]
v_mfma_f32_16x16x32_bf16 v[204:207], a[108:111], v[216:219], v[204:207]
s_waitcnt vmcnt(11)
buffer_load_dwordx4 a[168:171], v241, s[16:19], s39 offen offset:0 sc1
s_waitcnt vmcnt(11)
s_waitcnt lgkmcnt(2)
v_mfma_f32_16x16x32_bf16 v[160:163], a[112:115], v[220:223], v[160:163]
buffer_load_dwordx4 a[172:175], v241, s[16:19], s39 offen offset:1024 sc1
v_mfma_f32_16x16x32_bf16 v[164:167], a[116:119], v[220:223], v[164:167]
v_mfma_f32_16x16x32_bf16 v[168:171], a[120:123], v[220:223], v[168:171]
v_mfma_f32_16x16x32_bf16 v[172:175], a[124:127], v[220:223], v[172:175]
s_waitcnt vmcnt(11)
s_waitcnt lgkmcnt(1)
v_mfma_f32_16x16x32_bf16 v[176:179], a[112:115], v[224:227], v[176:179]
buffer_load_dwordx2 v[242:243], v46, s[16:19], 0 offen offset:0 sc1
v_mfma_f32_16x16x32_bf16 v[180:183], a[116:119], v[224:227], v[180:183]
v_lshlrev_b32 v234, 16, v104
v_and_b32 v235, s95, v104
v_mfma_f32_16x16x32_bf16 v[184:187], a[120:123], v[224:227], v[184:187]
v_fma_f32 v160, v160, v253, v234
v_fma_f32 v161, v161, v253, v235
v_mfma_f32_16x16x32_bf16 v[188:191], a[124:127], v[224:227], v[188:191]
v_lshlrev_b32 v236, 16, v105
v_and_b32 v237, s95, v105
s_waitcnt lgkmcnt(0)
v_mfma_f32_16x16x32_bf16 v[192:195], a[112:115], v[228:231], v[192:195]
v_fma_f32 v162, v162, v253, v236
v_fma_f32 v163, v163, v253, v237
v_mfma_f32_16x16x32_bf16 v[196:199], a[116:119], v[228:231], v[196:199]
v_lshlrev_b32 v238, 16, v106
v_and_b32 v239, s95, v106
v_mfma_f32_16x16x32_bf16 v[200:203], a[120:123], v[228:231], v[200:203]
v_fma_f32 v164, v164, v253, v238
v_fma_f32 v165, v165, v253, v239
v_mfma_f32_16x16x32_bf16 v[204:207], a[124:127], v[228:231], v[204:207]
v_lshlrev_b32 v232, 16, v107
v_and_b32 v233, s95, v107
v_fma_f32 v166, v166, v253, v232
v_fma_f32 v167, v167, v253, v233
ds_read_b128 v[104:107], v246 offset:2048
v_lshlrev_b32 v234, 16, v108
v_and_b32 v235, s95, v108
v_fma_f32 v168, v168, v253, v234
v_fma_f32 v169, v169, v253, v235
v_lshlrev_b32 v236, 16, v109
v_and_b32 v237, s95, v109
v_fma_f32 v170, v170, v253, v236
v_fma_f32 v171, v171, v253, v237
v_lshlrev_b32 v238, 16, v110
v_and_b32 v239, s95, v110
v_fma_f32 v172, v172, v253, v238
v_fma_f32 v173, v173, v253, v239
v_lshlrev_b32 v232, 16, v111
v_and_b32 v233, s95, v111
v_fma_f32 v174, v174, v253, v232
v_fma_f32 v175, v175, v253, v233
ds_read_b128 v[108:111], v245 offset:4096
s_waitcnt vmcnt(11)
buffer_load_dwordx4 a[176:179], v240, s[16:19], s39 offen offset:2048 sc1
v_lshlrev_b32 v234, 16, v152
v_and_b32 v235, s95, v152
v_fma_f32 v176, v176, v254, v234
v_fma_f32 v177, v177, v254, v235
v_lshlrev_b32 v236, 16, v153
v_and_b32 v237, s95, v153
v_fma_f32 v178, v178, v254, v236
v_fma_f32 v179, v179, v254, v237
v_lshlrev_b32 v238, 16, v154
v_and_b32 v239, s95, v154
v_fma_f32 v180, v180, v254, v238
v_fma_f32 v181, v181, v254, v239
v_lshlrev_b32 v232, 16, v155
v_and_b32 v233, s95, v155
v_fma_f32 v182, v182, v254, v232
v_fma_f32 v183, v183, v254, v233
ds_read_b128 v[152:155], v246 offset:4096
s_waitcnt lgkmcnt(2)
v_lshlrev_b32 v234, 16, v104
v_and_b32 v235, s95, v104
v_fma_f32 v184, v184, v254, v234
v_fma_f32 v185, v185, v254, v235
v_lshlrev_b32 v236, 16, v105
v_and_b32 v237, s95, v105
v_fma_f32 v186, v186, v254, v236
v_fma_f32 v187, v187, v254, v237
v_lshlrev_b32 v238, 16, v106
v_and_b32 v239, s95, v106
v_fma_f32 v188, v188, v254, v238
v_fma_f32 v189, v189, v254, v239
v_lshlrev_b32 v232, 16, v107
v_and_b32 v233, s95, v107
v_fma_f32 v190, v190, v254, v232
v_fma_f32 v191, v191, v254, v233
s_waitcnt vmcnt(11)
buffer_load_dwordx4 a[180:183], v240, s[16:19], s39 offen offset:3072 sc1
s_waitcnt lgkmcnt(1)
v_lshlrev_b32 v234, 16, v108
v_and_b32 v235, s95, v108
v_fma_f32 v192, v192, v255, v234
v_fma_f32 v193, v193, v255, v235
v_lshlrev_b32 v236, 16, v109
v_and_b32 v237, s95, v109
v_fma_f32 v194, v194, v255, v236
v_fma_f32 v195, v195, v255, v237
v_lshlrev_b32 v238, 16, v110
v_and_b32 v239, s95, v110
v_fma_f32 v196, v196, v255, v238
v_fma_f32 v197, v197, v255, v239
v_lshlrev_b32 v232, 16, v111
v_and_b32 v233, s95, v111
v_fma_f32 v198, v198, v255, v232
v_fma_f32 v199, v199, v255, v233
s_waitcnt lgkmcnt(0)
v_lshlrev_b32 v234, 16, v152
v_and_b32 v235, s95, v152
v_fma_f32 v200, v200, v255, v234
v_fma_f32 v201, v201, v255, v235
v_lshlrev_b32 v236, 16, v153
v_and_b32 v237, s95, v153
v_fma_f32 v202, v202, v255, v236
v_fma_f32 v203, v203, v255, v237
v_lshlrev_b32 v238, 16, v154
v_and_b32 v239, s95, v154
v_fma_f32 v204, v204, v255, v238
v_fma_f32 v205, v205, v255, v239
v_lshlrev_b32 v232, 16, v155
v_and_b32 v233, s95, v155
v_fma_f32 v206, v206, v255, v232
v_fma_f32 v207, v207, v255, v233
s_waitcnt vmcnt(11)
buffer_load_dwordx4 a[184:187], v241, s[16:19], s39 offen offset:2048 sc1
s_waitcnt vmcnt(11)
buffer_load_dwordx4 a[188:191], v241, s[16:19], s39 offen offset:3072 sc1
s_waitcnt vmcnt(11)
buffer_load_dwordx4 a[192:195], v240, s[16:19], s40 offen offset:0 sc1
s_waitcnt vmcnt(11)
buffer_load_dwordx4 a[196:199], v240, s[16:19], s40 offen offset:1024 sc1
s_waitcnt vmcnt(11)
buffer_load_dwordx4 a[200:203], v241, s[16:19], s40 offen offset:0 sc1
s_waitcnt vmcnt(11)
buffer_load_dwordx4 a[204:207], v241, s[16:19], s40 offen offset:1024 sc1
s_waitcnt vmcnt(11)
buffer_load_dwordx4 a[208:211], v240, s[16:19], s40 offen offset:2048 sc1
s_waitcnt vmcnt(11)
buffer_load_dwordx4 a[212:215], v240, s[16:19], s40 offen offset:3072 sc1
s_waitcnt vmcnt(11)
s_waitcnt vmcnt(10)
v_cmp_ne_u64 vcc, s[98:99], v[242:243]
s_nop 1
s_cbranch_vccnz LF_spinQ
LF_goQ:
buffer_load_dwordx4 v[128:131], v244, s[24:27], 0 offen offset:0 sc1
buffer_load_dwordx4 v[132:135], v244, s[24:27], 0 offen offset:16 sc1
s_waitcnt vmcnt(11)
buffer_load_dwordx4 v[136:139], v244, s[24:27], 0 offen offset:32 sc1
s_waitcnt vmcnt(11)
s_waitcnt vmcnt(10)
s_add_u32 s49, s6, s42
buffer_load_dwordx4 v[48:51], v47, s[16:19], s49 offen sc1
s_add_u32 s3, s6, s43
buffer_load_dwordx4 v[52:55], v47, s[16:19], s3 offen sc1
s_waitcnt vmcnt(11)
buffer_load_dwordx4 a[216:219], v241, s[16:19], s40 offen offset:2048 sc1
s_waitcnt vmcnt(11)
s_waitcnt vmcnt(10)
s_add_u32 s49, s6, s44
buffer_load_dwordx4 v[56:59], v47, s[16:19], s49 offen sc1
s_add_u32 s3, s6, s45
buffer_load_dwordx4 v[60:63], v47, s[16:19], s3 offen sc1
s_waitcnt vmcnt(11)
buffer_load_dwordx4 a[220:223], v241, s[16:19], s40 offen offset:3072 sc1
s_waitcnt vmcnt(11)
s_add_u32 s49, s6, s46
buffer_load_dwordx4 v[64:67], v47, s[16:19], s49 offen sc1
ds_read_b128 v[68:71], v76 offset:0
s_waitcnt vmcnt(11)
buffer_load_dwordx4 a[224:227], v240, s[16:19], s41 offen offset:0 sc1
s_waitcnt vmcnt(11)
s_waitcnt vmcnt(10)
s_add_u32 s49, s6, s42
buffer_load_dwordx4 v[80:83], v43, s[16:19], s49 offen sc1
s_add_u32 s3, s6, s43
buffer_load_dwordx4 v[84:87], v43, s[16:19], s3 offen sc1
s_waitcnt vmcnt(11)
buffer_load_dwordx4 a[228:231], v240, s[16:19], s41 offen offset:1024 sc1
s_waitcnt vmcnt(11)
v_max3_f32 v232, v128, v130, v132
v_max3_f32 v233, v134, v136, v138
v_max_f32 v232, v232, v233
v_subrev_f32 v232, 0x42fe0000, v232
v_sub_f32 v128, v128, v232
v_sub_f32 v130, v130, v232
v_sub_f32 v132, v132, v232
v_sub_f32 v134, v134, v232
v_sub_f32 v136, v136, v232
v_sub_f32 v138, v138, v232
v_cvt_u32_f32 v128, v128
v_cvt_u32_f32 v130, v130
v_cvt_u32_f32 v132, v132
v_cvt_u32_f32 v134, v134
v_cvt_u32_f32 v136, v136
v_cvt_u32_f32 v138, v138
v_lshlrev_b32 v234, 23, v128
v_lshlrev_b32 v235, 23, v130
v_lshlrev_b32 v236, 23, v132
v_lshlrev_b32 v237, 23, v134
v_lshlrev_b32 v238, 23, v136
v_lshlrev_b32 v239, 23, v138
v_mul_f32 v232, v234, v129
v_fmac_f32 v232, v235, v131
v_fmac_f32 v232, v236, v133
v_fmac_f32 v232, v237, v135
v_fmac_f32 v232, v238, v137
v_fmac_f32 v232, v239, v139
v_rcp_f32 v150, v232
v_mul_u32_u24 v144, 0x800080, v128
v_mul_u32_u24 v145, 0x800080, v130
v_mul_u32_u24 v146, 0x800080, v132
v_mul_u32_u24 v147, 0x800080, v134
v_mul_u32_u24 v148, 0x800080, v136
v_mul_u32_u24 v149, 0x800080, v138
ds_write_b128 v249, v[144:147]
ds_write_b96 v249, v[148:150] offset:16
ds_read_b128 v[144:147], v250 offset:0
ds_read_b128 v[148:151], v250 offset:16
ds_read_b128 v[128:131], v250 offset:512
ds_read_b128 v[132:135], v250 offset:528
ds_read_b128 v[136:139], v250 offset:1024
ds_read_b128 v[140:143], v250 offset:1040
s_waitcnt lgkmcnt(4)
v_and_b32 v0, v144, v156
v_and_b32 v1, v144, v157
v_and_b32 v2, v145, v156
v_and_b32 v3, v145, v157
v_and_b32 v4, v146, v156
v_and_b32 v5, v146, v157
v_and_b32 v6, v147, v156
v_and_b32 v7, v147, v157
v_and_b32 v8, v148, v156
v_and_b32 v9, v148, v157
v_and_b32 v10, v149, v156
v_and_b32 v11, v149, v157
v_mov_b32 v40, v150
s_waitcnt lgkmcnt(2)
v_and_b32 v12, v128, v156
v_and_b32 v13, v128, v157
v_and_b32 v14, v129, v156
v_and_b32 v15, v129, v157
v_and_b32 v16, v130, v156
v_and_b32 v17, v130, v157
v_and_b32 v18, v131, v156
v_and_b32 v19, v131, v157
v_and_b32 v20, v132, v156
v_and_b32 v21, v132, v157
v_and_b32 v22, v133, v156
v_and_b32 v23, v133, v157
v_mov_b32 v41, v134
s_waitcnt lgkmcnt(0)
v_and_b32 v24, v136, v156
v_and_b32 v25, v136, v157
v_and_b32 v26, v137, v156
v_and_b32 v27, v137, v157
v_and_b32 v28, v138, v156
v_and_b32 v29, v138, v157
v_and_b32 v30, v139, v156
v_and_b32 v31, v139, v157
v_and_b32 v32, v140, v156
v_and_b32 v33, v140, v157
v_and_b32 v34, v141, v156
v_and_b32 v35, v141, v157
v_mov_b32 v42, v142
s_waitcnt vmcnt(9)
v_swap_b32 v50, v52
v_swap_b32 v51, v53
s_nop 1
v_mfma_f32_16x16x32_bf16 v[136:139], v[48:51], v[0:3], 0
s_add_u32 s49, s6, s44
buffer_load_dwordx4 v[88:91], v43, s[16:19], s49 offen sc1
v_mfma_f32_16x16x32_bf16 v[140:143], v[52:55], v[0:3], 0
s_add_u32 s3, s6, s45
buffer_load_dwordx4 v[92:95], v43, s[16:19], s3 offen sc1
buffer_load_dwordx4 a[232:235], v241, s[16:19], s41 offen offset:0 sc1
s_waitcnt vmcnt(11)
s_add_u32 s49, s6, s46
buffer_load_dwordx4 v[96:99], v43, s[16:19], s49 offen sc1
ds_read_b128 v[100:103], v76 offset:4096
s_waitcnt vmcnt(10)
v_swap_b32 v58, v60
v_swap_b32 v59, v61
s_nop 1
v_mfma_f32_16x16x32_bf16 v[136:139], v[56:59], v[4:7], v[136:139]
buffer_load_dwordx4 a[236:239], v241, s[16:19], s41 offen offset:1024 sc1
v_mfma_f32_16x16x32_bf16 v[140:143], v[60:63], v[4:7], v[140:143]
s_waitcnt vmcnt(10)
s_add_u32 s49, s7, s42
buffer_load_dwordx4 v[112:115], v47, s[16:19], s49 offen sc1
s_add_u32 s3, s7, s43
buffer_load_dwordx4 v[116:119], v47, s[16:19], s3 offen sc1
s_waitcnt vmcnt(11)
v_swap_b32 v66, v68
v_swap_b32 v67, v69
s_nop 1
v_mfma_f32_16x16x32_bf16 v[136:139], v[64:67], v[8:11], v[136:139]
buffer_load_dwordx4 a[240:243], v240, s[16:19], s41 offen offset:2048 sc1
v_mfma_f32_16x16x32_bf16 v[140:143], v[68:71], v[8:11], v[140:143]
s_waitcnt vmcnt(11)
s_nop 4
v_mul_f32 v136, v136, v40
v_mul_f32 v137, v137, v40
v_mul_f32 v138, v138, v40
v_mul_f32 v139, v139, v40
v_mul_f32 v140, v140, v40
v_mul_f32 v141, v141, v40
v_mul_f32 v142, v142, v40
v_mul_f32 v143, v143, v40
v_cvt_pk_bf16_f32 v136, v136, v137
v_cvt_pk_bf16_f32 v137, v138, v139
v_cvt_pk_bf16_f32 v138, v140, v141
v_cvt_pk_bf16_f32 v139, v142, v143
ds_write_b128 v251, v[136:139] offset:0
s_waitcnt vmcnt(9)
v_swap_b32 v82, v84
v_swap_b32 v83, v85
s_nop 1
v_mfma_f32_16x16x32_bf16 v[128:131], v[80:83], v[0:3], 0
s_add_u32 s49, s7, s44
buffer_load_dwordx4 v[120:123], v47, s[16:19], s49 offen sc1
v_mfma_f32_16x16x32_bf16 v[132:135], v[84:87], v[0:3], 0
s_add_u32 s3, s7, s45
buffer_load_dwordx4 v[124:127], v47, s[16:19], s3 offen sc1
buffer_load_dwordx4 a[244:247], v240, s[16:19], s41 offen offset:3072 sc1
s_waitcnt vmcnt(11)
s_add_u32 s49, s7, s46
buffer_load_dwordx4 v[48:51], v47, s[16:19], s49 offen sc1
ds_read_b128 v[52:55], v77 offset:0
s_waitcnt vmcnt(10)
v_swap_b32 v90, v92
v_swap_b32 v91, v93
s_nop 1
v_mfma_f32_16x16x32_bf16 v[128:131], v[88:91], v[4:7], v[128:131]
buffer_load_dwordx4 a[248:251], v241, s[16:19], s41 offen offset:2048 sc1
v_mfma_f32_16x16x32_bf16 v[132:135], v[92:95], v[4:7], v[132:135]
s_waitcnt vmcnt(10)
s_add_u32 s49, s7, s42
buffer_load_dwordx4 v[56:59], v43, s[16:19], s49 offen sc1
s_add_u32 s3, s7, s43
buffer_load_dwordx4 v[60:63], v43, s[16:19], s3 offen sc1
s_waitcnt vmcnt(11)
s_waitcnt lgkmcnt(2)
v_swap_b32 v98, v100
v_swap_b32 v99, v101
s_nop 1
v_mfma_f32_16x16x32_bf16 v[128:131], v[96:99], v[8:11], v[128:131]
buffer_load_dwordx4 a[252:255], v241, s[16:19], s41 offen offset:3072 sc1
v_mfma_f32_16x16x32_bf16 v[132:135], v[100:103], v[8:11], v[132:135]
s_waitcnt vmcnt(11)
s_nop 4
v_mul_f32 v128, v128, v40
v_mul_f32 v129, v129, v40
v_mul_f32 v130, v130, v40
v_mul_f32 v131, v131, v40
v_mul_f32 v132, v132, v40
v_mul_f32 v133, v133, v40
v_mul_f32 v134, v134, v40
v_mul_f32 v135, v135, v40
v_cvt_pk_bf16_f32 v128, v128, v129
v_cvt_pk_bf16_f32 v129, v130, v131
v_cvt_pk_bf16_f32 v130, v132, v133
v_cvt_pk_bf16_f32 v131, v134, v135
ds_write_b128 v251, v[128:131] offset:4096
s_waitcnt lgkmcnt(0)
s_barrier
ds_read_b128 v[208:211], v252 offset:0
ds_read_b128 v[212:215], v252 offset:1024
ds_read_b128 v[216:219], v252 offset:2048
ds_read_b128 v[220:223], v252 offset:3072
ds_read_b128 v[224:227], v252 offset:4096
s_waitcnt vmcnt(9)
s_waitcnt lgkmcnt(4)
v_mfma_f32_16x16x32_bf16 v[160:163], a[128:131], v[208:211], v[160:163]
ds_read_b128 v[228:231], v252 offset:5120
v_swap_b32 v114, v116
v_mfma_f32_16x16x32_bf16 v[164:167], a[132:135], v[208:211], v[164:167]
v_swap_b32 v115, v117
s_nop 1
v_mfma_f32_16x16x32_bf16 v[136:139], v[112:115], v[12:15], 0
s_add_u32 s49, s7, s44
buffer_load_dwordx4 v[64:67], v43, s[16:19], s49 offen sc1
v_mfma_f32_16x16x32_bf16 v[140:143], v[116:119], v[12:15], 0
s_add_u32 s3, s7, s45
buffer_load_dwordx4 v[68:71], v43, s[16:19], s3 offen sc1
v_mfma_f32_16x16x32_bf16 v[168:171], a[136:139], v[208:211], v[168:171]
s_add_u32 s49, s7, s46
buffer_load_dwordx4 v[80:83], v43, s[16:19], s49 offen sc1
v_mfma_f32_16x16x32_bf16 v[172:175], a[140:143], v[208:211], v[172:175]
ds_read_b128 v[84:87], v77 offset:4096
s_waitcnt lgkmcnt(5)
v_mfma_f32_16x16x32_bf16 v[160:163], a[144:147], v[212:215], v[160:163]
ds_read_b128 v[208:211], v252 offset:6144
v_mfma_f32_16x16x32_bf16 v[164:167], a[148:151], v[212:215], v[164:167]
v_mfma_f32_16x16x32_bf16 v[168:171], a[152:155], v[212:215], v[168:171]
v_mfma_f32_16x16x32_bf16 v[172:175], a[156:159], v[212:215], v[172:175]
s_waitcnt vmcnt(11)
s_waitcnt lgkmcnt(5)
v_mfma_f32_16x16x32_bf16 v[160:163], a[160:163], v[216:219], v[160:163]
ds_read_b128 v[212:215], v252 offset:7168
v_mfma_f32_16x16x32_bf16 v[164:167], a[164:167], v[216:219], v[164:167]
v_mfma_f32_16x16x32_bf16 v[168:171], a[168:171], v[216:219], v[168:171]
v_mfma_f32_16x16x32_bf16 v[172:175], a[172:175], v[216:219], v[172:175]
s_waitcnt vmcnt(9)
s_waitcnt lgkmcnt(5)
v_mfma_f32_16x16x32_bf16 v[160:163], a[176:179], v[220:223], v[160:163]
v_swap_b32 v122, v124
v_mfma_f32_16x16x32_bf16 v[164:167], a[180:183], v[220:223], v[164:167]
v_swap_b32 v123, v125
s_nop 1
v_mfma_f32_16x16x32_bf16 v[136:139], v[120:123], v[16:19], v[136:139]
s_add_u32 s49, s29, s42
buffer_load_dwordx4 v[88:91], v47, s[16:19], s49 offen sc1
v_mfma_f32_16x16x32_bf16 v[140:143], v[124:127], v[16:19], v[140:143]
s_add_u32 s3, s29, s43
buffer_load_dwordx4 v[92:95], v47, s[16:19], s3 offen sc1
v_mfma_f32_16x16x32_bf16 v[168:171], a[184:187], v[220:223], v[168:171]
v_mfma_f32_16x16x32_bf16 v[172:175], a[188:191], v[220:223], v[172:175]
s_waitcnt lgkmcnt(4)
v_mfma_f32_16x16x32_bf16 v[160:163], a[192:195], v[224:227], v[160:163]
v_mfma_f32_16x16x32_bf16 v[164:167], a[196:199], v[224:227], v[164:167]
v_mfma_f32_16x16x32_bf16 v[168:171], a[200:203], v[224:227], v[168:171]
v_mfma_f32_16x16x32_bf16 v[172:175], a[204:207], v[224:227], v[172:175]
s_waitcnt vmcnt(10)
s_waitcnt lgkmcnt(3)
v_mfma_f32_16x16x32_bf16 v[160:163], a[208:211], v[228:231], v[160:163]
s_add_u32 s49, s29, s44
buffer_load_dwordx4 v[96:99], v47, s[16:19], s49 offen sc1
v_mfma_f32_16x16x32_bf16 v[164:167], a[212:215], v[228:231], v[164:167]
s_add_u32 s3, s29, s45
buffer_load_dwordx4 v[100:103], v47, s[16:19], s3 offen sc1
v_mfma_f32_16x16x32_bf16 v[168:171], a[216:219], v[228:231], v[168:171]
v_mfma_f32_16x16x32_bf16 v[172:175], a[220:223], v[228:231], v[172:175]
s_waitcnt vmcnt(11)
s_waitcnt lgkmcnt(1)
v_mfma_f32_16x16x32_bf16 v[160:163], a[224:227], v[208:211], v[160:163]
v_swap_b32 v50, v52
v_mfma_f32_16x16x32_bf16 v[164:167], a[228:231], v[208:211], v[164:167]
v_swap_b32 v51, v53
s_nop 1
v_mfma_f32_16x16x32_bf16 v[136:139], v[48:51], v[20:23], v[136:139]
v_mfma_f32_16x16x32_bf16 v[140:143], v[52:55], v[20:23], v[140:143]
v_mfma_f32_16x16x32_bf16 v[168:171], a[232:235], v[208:211], v[168:171]
v_mfma_f32_16x16x32_bf16 v[172:175], a[236:239], v[208:211], v[172:175]
s_waitcnt vmcnt(10)
s_add_u32 s49, s29, s46
buffer_load_dwordx4 v[112:115], v47, s[16:19], s49 offen sc1
s_add_u32 s3, s29, s47
s_cmp_lt_u32 s37, 4
s_cbranch_scc1 LF_o0
buffer_load_dwordx4 v[116:119], v47, s[16:19], s3 offen sc1
ds_read_b128 v[36:39], v78 offset:0
s_branch LF_j0
LF_o0:
s_mov_b32 s3, 0x70000000
buffer_load_dwordx4 v[36:39], v47, s[16:19], s3 offen sc1
ds_read_b128 v[116:119], v78 offset:0
LF_j0:
v_mul_f32 v136, v136, v41
v_mul_f32 v137, v137, v41
v_mul_f32 v138, v138, v41
v_mul_f32 v139, v139, v41
v_mul_f32 v140, v140, v41
v_mul_f32 v141, v141, v41
v_mul_f32 v142, v142, v41
v_mul_f32 v143, v143, v41
v_cvt_pk_bf16_f32 v136, v136, v137
v_cvt_pk_bf16_f32 v137, v138, v139
v_cvt_pk_bf16_f32 v138, v140, v141
v_cvt_pk_bf16_f32 v139, v142, v143
ds_write_b128 v251, v[136:139] offset:8192
s_waitcnt vmcnt(10)
v_swap_b32 v58, v60
v_swap_b32 v59, v61
s_nop 1
v_mfma_f32_16x16x32_bf16 v[128:131], v[56:59], v[12:15], 0
s_add_u32 s49, s29, s42
buffer_load_dwordx4 v[120:123], v43, s[16:19], s49 offen sc1
v_mfma_f32_16x16x32_bf16 v[132:135], v[60:63], v[12:15], 0
s_add_u32 s3, s29, s43
buffer_load_dwordx4 v[124:127], v43, s[16:19], s3 offen sc1
s_waitcnt vmcnt(11)
s_waitcnt lgkmcnt(2)
v_mfma_f32_16x16x32_bf16 v[160:163], a[240:243], v[212:215], v[160:163]
v_mfma_f32_16x16x32_bf16 v[164:167], a[244:247], v[212:215], v[164:167]
v_mfma_f32_16x16x32_bf16 v[168:171], a[248:251], v[212:215], v[168:171]
v_mfma_f32_16x16x32_bf16 v[172:175], a[252:255], v[212:215], v[172:175]
s_waitcnt vmcnt(9)
v_swap_b32 v66, v68
v_swap_b32 v67, v69
s_nop 1
v_mfma_f32_16x16x32_bf16 v[128:131], v[64:67], v[16:19], v[128:131]
s_add_u32 s49, s29, s44
buffer_load_dwordx4 v[48:51], v43, s[16:19], s49 offen sc1
v_mfma_f32_16x16x32_bf16 v[132:135], v[68:71], v[16:19], v[132:135]
s_add_u32 s3, s29, s45
buffer_load_dwordx4 v[52:55], v43, s[16:19], s3 offen sc1
v_cvt_pk_bf16_f32 v160, v160, v161
v_cvt_pk_bf16_f32 v161, v162, v163
v_cvt_pk_bf16_f32 v162, v164, v165
v_cvt_pk_bf16_f32 v163, v166, v167
ds_write_b128 v245, v[160:163] offset:0
v_cvt_pk_bf16_f32 v168, v168, v169
v_cvt_pk_bf16_f32 v169, v170, v171
v_cvt_pk_bf16_f32 v170, v172, v173
v_cvt_pk_bf16_f32 v171, v174, v175
ds_write_b128 v246, v[168:171] offset:0
ds_read_b128 v[164:167], v247 offset:0
ds_read_b128 v[172:175], v247 offset:1024
s_waitcnt vmcnt(10)
v_swap_b32 v82, v84
v_swap_b32 v83, v85
s_nop 1
v_mfma_f32_16x16x32_bf16 v[128:131], v[80:83], v[20:23], v[128:131]
s_add_u32 s49, s29, s46
buffer_load_dwordx4 v[56:59], v43, s[16:19], s49 offen sc1
v_mfma_f32_16x16x32_bf16 v[132:135], v[84:87], v[20:23], v[132:135]
s_add_u32 s3, s29, s47
s_cmp_lt_u32 s37, 4
s_cbranch_scc1 LF_o1
buffer_load_dwordx4 v[60:63], v43, s[16:19], s3 offen sc1
ds_read_b128 v[36:39], v78 offset:4096
s_branch LF_j1
LF_o1:
s_mov_b32 s3, 0x70000000
buffer_load_dwordx4 v[36:39], v43, s[16:19], s3 offen sc1
ds_read_b128 v[60:63], v78 offset:4096
LF_j1:
s_waitcnt lgkmcnt(2)
buffer_store_dwordx4 v[164:167], v44, s[56:59], s6 offen sc1
s_waitcnt lgkmcnt(1)
buffer_store_dwordx4 v[172:175], v45, s[56:59], s6 offen sc1
v_mul_f32 v128, v128, v41
v_mul_f32 v129, v129, v41
v_mul_f32 v130, v130, v41
v_mul_f32 v131, v131, v41
v_mul_f32 v132, v132, v41
v_mul_f32 v133, v133, v41
v_mul_f32 v134, v134, v41
v_mul_f32 v135, v135, v41
v_cvt_pk_bf16_f32 v128, v128, v129
v_cvt_pk_bf16_f32 v129, v130, v131
v_cvt_pk_bf16_f32 v130, v132, v133
v_cvt_pk_bf16_f32 v131, v134, v135
ds_write_b128 v251, v[128:131] offset:12288
s_waitcnt lgkmcnt(0)
s_barrier
ds_read_b128 v[216:219], v252 offset:8192
ds_read_b128 v[220:223], v252 offset:9216
ds_read_b128 v[224:227], v252 offset:10240
ds_read_b128 v[228:231], v252 offset:11264
ds_read_b128 v[208:211], v252 offset:12288
s_waitcnt vmcnt(12)
s_waitcnt lgkmcnt(4)
v_mfma_f32_16x16x32_bf16 v[176:179], a[128:131], v[216:219], v[176:179]
ds_read_b128 v[212:215], v252 offset:13312
v_swap_b32 v90, v92
v_mfma_f32_16x16x32_bf16 v[180:183], a[132:135], v[216:219], v[180:183]
v_swap_b32 v91, v93
s_nop 1
v_mfma_f32_16x16x32_bf16 v[136:139], v[88:91], v[24:27], 0
v_mfma_f32_16x16x32_bf16 v[140:143], v[92:95], v[24:27], 0
v_mfma_f32_16x16x32_bf16 v[184:187], a[136:139], v[216:219], v[184:187]
v_mfma_f32_16x16x32_bf16 v[188:191], a[140:143], v[216:219], v[188:191]
s_waitcnt lgkmcnt(4)
v_mfma_f32_16x16x32_bf16 v[176:179], a[144:147], v[220:223], v[176:179]
ds_read_b128 v[216:219], v252 offset:14336
v_mfma_f32_16x16x32_bf16 v[180:183], a[148:151], v[220:223], v[180:183]
v_mfma_f32_16x16x32_bf16 v[184:187], a[152:155], v[220:223], v[184:187]
v_mfma_f32_16x16x32_bf16 v[188:191], a[156:159], v[220:223], v[188:191]
s_waitcnt vmcnt(10)
s_waitcnt lgkmcnt(4)
v_mfma_f32_16x16x32_bf16 v[176:179], a[160:163], v[224:227], v[176:179]
v_swap_b32 v98, v100
v_mfma_f32_16x16x32_bf16 v[180:183], a[164:167], v[224:227], v[180:183]
v_swap_b32 v99, v101
s_nop 1
v_mfma_f32_16x16x32_bf16 v[136:139], v[96:99], v[28:31], v[136:139]
v_mfma_f32_16x16x32_bf16 v[140:143], v[100:103], v[28:31], v[140:143]
v_mfma_f32_16x16x32_bf16 v[184:187], a[168:171], v[224:227], v[184:187]
v_mfma_f32_16x16x32_bf16 v[188:191], a[172:175], v[224:227], v[188:191]
s_waitcnt lgkmcnt(3)
v_mfma_f32_16x16x32_bf16 v[176:179], a[176:179], v[228:231], v[176:179]
v_mfma_f32_16x16x32_bf16 v[180:183], a[180:183], v[228:231], v[180:183]
v_mfma_f32_16x16x32_bf16 v[184:187], a[184:187], v[228:231], v[184:187]
v_mfma_f32_16x16x32_bf16 v[188:191], a[188:191], v[228:231], v[188:191]
s_waitcnt vmcnt(8)
s_waitcnt lgkmcnt(2)
v_mfma_f32_16x16x32_bf16 v[176:179], a[192:195], v[208:211], v[176:179]
v_swap_b32 v114, v116
v_mfma_f32_16x16x32_bf16 v[180:183], a[196:199], v[208:211], v[180:183]
v_swap_b32 v115, v117
s_nop 1
v_mfma_f32_16x16x32_bf16 v[136:139], v[112:115], v[32:35], v[136:139]
v_mfma_f32_16x16x32_bf16 v[140:143], v[116:119], v[32:35], v[140:143]
v_mfma_f32_16x16x32_bf16 v[184:187], a[200:203], v[208:211], v[184:187]
v_mfma_f32_16x16x32_bf16 v[188:191], a[204:207], v[208:211], v[188:191]
s_waitcnt lgkmcnt(1)
v_mfma_f32_16x16x32_bf16 v[176:179], a[208:211], v[212:215], v[176:179]
v_mfma_f32_16x16x32_bf16 v[180:183], a[212:215], v[212:215], v[180:183]
v_mfma_f32_16x16x32_bf16 v[184:187], a[216:219], v[212:215], v[184:187]
v_mfma_f32_16x16x32_bf16 v[188:191], a[220:223], v[212:215], v[188:191]
s_waitcnt lgkmcnt(0)
v_mfma_f32_16x16x32_bf16 v[176:179], a[224:227], v[216:219], v[176:179]
v_mul_f32 v136, v136, v42
v_mul_f32 v137, v137, v42
v_mfma_f32_16x16x32_bf16 v[180:183], a[228:231], v[216:219], v[180:183]
v_mul_f32 v138, v138, v42
v_mul_f32 v139, v139, v42
v_mfma_f32_16x16x32_bf16 v[184:187], a[232:235], v[216:219], v[184:187]
v_mul_f32 v140, v140, v42
v_mul_f32 v141, v141, v42
v_mfma_f32_16x16x32_bf16 v[188:191], a[236:239], v[216:219], v[188:191]
v_mul_f32 v142, v142, v42
v_mul_f32 v143, v143, v42
v_cvt_pk_bf16_f32 v136, v136, v137
v_cvt_pk_bf16_f32 v137, v138, v139
v_cvt_pk_bf16_f32 v138, v140, v141
v_cvt_pk_bf16_f32 v139, v142, v143
ds_write_b128 v251, v[136:139] offset:16384
s_waitcnt lgkmcnt(0)
s_barrier
ds_read_b128 v[220:223], v252 offset:15360
ds_read_b128 v[224:227], v252 offset:16384
ds_read_b128 v[228:231], v252 offset:17408
ds_read_b128 v[208:211], v252 offset:18432
ds_read_b128 v[212:215], v252 offset:19456
s_waitcnt vmcnt(6)
s_waitcnt lgkmcnt(4)
v_mfma_f32_16x16x32_bf16 v[176:179], a[240:243], v[220:223], v[176:179]
v_swap_b32 v122, v124
v_mfma_f32_16x16x32_bf16 v[180:183], a[244:247], v[220:223], v[180:183]
v_swap_b32 v123, v125
s_nop 1
v_mfma_f32_16x16x32_bf16 v[128:131], v[120:123], v[24:27], 0
v_mfma_f32_16x16x32_bf16 v[132:135], v[124:127], v[24:27], 0
v_mfma_f32_16x16x32_bf16 v[184:187], a[248:251], v[220:223], v[184:187]
v_mfma_f32_16x16x32_bf16 v[188:191], a[252:255], v[220:223], v[188:191]
s_waitcnt lgkmcnt(3)
v_mfma_f32_16x16x32_bf16 v[192:195], a[128:131], v[224:227], v[192:195]
v_mfma_f32_16x16x32_bf16 v[196:199], a[132:135], v[224:227], v[196:199]
v_mfma_f32_16x16x32_bf16 v[200:203], a[136:139], v[224:227], v[200:203]
v_mfma_f32_16x16x32_bf16 v[204:207], a[140:143], v[224:227], v[204:207]
s_waitcnt vmcnt(4)
s_waitcnt lgkmcnt(2)
v_mfma_f32_16x16x32_bf16 v[192:195], a[144:147], v[228:231], v[192:195]
v_swap_b32 v50, v52
v_mfma_f32_16x16x32_bf16 v[196:199], a[148:151], v[228:231], v[196:199]
v_swap_b32 v51, v53
s_nop 1
v_mfma_f32_16x16x32_bf16 v[128:131], v[48:51], v[28:31], v[128:131]
v_cvt_pk_bf16_f32 v176, v176, v177
v_cvt_pk_bf16_f32 v177, v178, v179
v_mfma_f32_16x16x32_bf16 v[132:135], v[52:55], v[28:31], v[132:135]
v_cvt_pk_bf16_f32 v178, v180, v181
v_cvt_pk_bf16_f32 v179, v182, v183
v_mfma_f32_16x16x32_bf16 v[200:203], a[152:155], v[228:231], v[200:203]
ds_write_b128 v245, v[176:179] offset:2048
v_cvt_pk_bf16_f32 v184, v184, v185
v_mfma_f32_16x16x32_bf16 v[204:207], a[156:159], v[228:231], v[204:207]
v_cvt_pk_bf16_f32 v185, v186, v187
v_cvt_pk_bf16_f32 v186, v188, v189
s_waitcnt lgkmcnt(2)
v_mfma_f32_16x16x32_bf16 v[192:195], a[160:163], v[208:211], v[192:195]
v_cvt_pk_bf16_f32 v187, v190, v191
ds_write_b128 v246, v[184:187] offset:2048
v_mfma_f32_16x16x32_bf16 v[196:199], a[164:167], v[208:211], v[196:199]
ds_read_b128 v[180:183], v247 offset:2048
ds_read_b128 v[188:191], v247 offset:3072
v_mfma_f32_16x16x32_bf16 v[200:203], a[168:171], v[208:211], v[200:203]
v_mfma_f32_16x16x32_bf16 v[204:207], a[172:175], v[208:211], v[204:207]
s_waitcnt vmcnt(2)
s_waitcnt lgkmcnt(4)
v_mfma_f32_16x16x32_bf16 v[192:195], a[176:179], v[212:215], v[192:195]
v_swap_b32 v58, v60
v_mfma_f32_16x16x32_bf16 v[196:199], a[180:183], v[212:215], v[196:199]
v_swap_b32 v59, v61
s_nop 1
v_mfma_f32_16x16x32_bf16 v[128:131], v[56:59], v[32:35], v[128:131]
s_waitcnt lgkmcnt(1)
buffer_store_dwordx4 v[180:183], v44, s[56:59], s7 offen sc1
v_mfma_f32_16x16x32_bf16 v[132:135], v[60:63], v[32:35], v[132:135]
s_waitcnt lgkmcnt(0)
buffer_store_dwordx4 v[188:191], v45, s[56:59], s7 offen sc1
v_mfma_f32_16x16x32_bf16 v[200:203], a[184:187], v[212:215], v[200:203]
v_mfma_f32_16x16x32_bf16 v[204:207], a[188:191], v[212:215], v[204:207]
s_nop 0
v_mul_f32 v128, v128, v42
v_mul_f32 v129, v129, v42
v_mul_f32 v130, v130, v42
v_mul_f32 v131, v131, v42
v_mul_f32 v132, v132, v42
v_mul_f32 v133, v133, v42
v_mul_f32 v134, v134, v42
v_mul_f32 v135, v135, v42
v_cvt_pk_bf16_f32 v128, v128, v129
v_cvt_pk_bf16_f32 v129, v130, v131
v_cvt_pk_bf16_f32 v130, v132, v133
v_cvt_pk_bf16_f32 v131, v134, v135
ds_write_b128 v251, v[128:131] offset:20480
s_waitcnt lgkmcnt(0)
s_barrier
ds_read_b128 v[216:219], v252 offset:20480
ds_read_b128 v[220:223], v252 offset:21504
ds_read_b128 v[224:227], v252 offset:22528
ds_read_b128 v[228:231], v252 offset:23552
s_waitcnt lgkmcnt(3)
v_mfma_f32_16x16x32_bf16 v[192:195], a[192:195], v[216:219], v[192:195]
v_mfma_f32_16x16x32_bf16 v[196:199], a[196:199], v[216:219], v[196:199]
v_mfma_f32_16x16x32_bf16 v[200:203], a[200:203], v[216:219], v[200:203]
v_mfma_f32_16x16x32_bf16 v[204:207], a[204:207], v[216:219], v[204:207]
s_waitcnt lgkmcnt(2)
v_mfma_f32_16x16x32_bf16 v[192:195], a[208:211], v[220:223], v[192:195]
v_mfma_f32_16x16x32_bf16 v[196:199], a[212:215], v[220:223], v[196:199]
v_mfma_f32_16x16x32_bf16 v[200:203], a[216:219], v[220:223], v[200:203]
v_mfma_f32_16x16x32_bf16 v[204:207], a[220:223], v[220:223], v[204:207]
s_waitcnt lgkmcnt(1)
v_mfma_f32_16x16x32_bf16 v[192:195], a[224:227], v[224:227], v[192:195]
v_mfma_f32_16x16x32_bf16 v[196:199], a[228:231], v[224:227], v[196:199]
v_mfma_f32_16x16x32_bf16 v[200:203], a[232:235], v[224:227], v[200:203]
v_mfma_f32_16x16x32_bf16 v[204:207], a[236:239], v[224:227], v[204:207]
s_waitcnt lgkmcnt(0)
v_mfma_f32_16x16x32_bf16 v[192:195], a[240:243], v[228:231], v[192:195]
v_mfma_f32_16x16x32_bf16 v[196:199], a[244:247], v[228:231], v[196:199]
v_mfma_f32_16x16x32_bf16 v[200:203], a[248:251], v[228:231], v[200:203]
v_mfma_f32_16x16x32_bf16 v[204:207], a[252:255], v[228:231], v[204:207]
s_nop 4
v_cvt_pk_bf16_f32 v192, v192, v193
v_cvt_pk_bf16_f32 v193, v194, v195
v_cvt_pk_bf16_f32 v194, v196, v197
v_cvt_pk_bf16_f32 v195, v198, v199
ds_write_b128 v245, v[192:195] offset:4096
v_cvt_pk_bf16_f32 v200, v200, v201
v_cvt_pk_bf16_f32 v201, v202, v203
v_cvt_pk_bf16_f32 v202, v204, v205
v_cvt_pk_bf16_f32 v203, v206, v207
ds_write_b128 v246, v[200:203] offset:4096
ds_read_b128 v[196:199], v247 offset:4096
ds_read_b128 v[204:207], v247 offset:5120
s_waitcnt lgkmcnt(1)
buffer_store_dwordx4 v[196:199], v44, s[56:59], s29 offen sc1
s_waitcnt lgkmcnt(0)
buffer_store_dwordx4 v[204:207], v45, s[56:59], s29 offen sc1
s_branch L2_fin
LF_spinQ:
s_mov_b32 s94, 0x10000
LF_spin2Q:
buffer_load_dwordx2 v[242:243], v46, s[16:19], 0 offen offset:0 sc1
s_sub_u32 s94, s94, 1
s_waitcnt vmcnt(0)
s_cbranch_scc1 LF_spin2Q_go
v_cmp_ne_u64 vcc, s[98:99], v[242:243]
s_nop 1
s_cbranch_vccnz LF_spin2Q
LF_spin2Q_go:
s_branch LF_goQ
LF_wf:
s_mov_b32 s94, 0x10000
LF_wf2:
buffer_load_dwordx2 v[108:109], v110, s[16:19], 0 offen sc1
s_sub_u32 s94, s94, 1
s_waitcnt vmcnt(0)
s_cbranch_scc1 LF_wf2_go
v_cmp_ne_u64 vcc, s[98:99], v[108:109]
s_nop 1
s_cbranch_vccnz LF_wf2
LF_wf2_go:
s_branch LF_wf_go
LM_pb:
s_mov_b32 s3, 0x10000
LM_pb2:
buffer_load_dwordx2 v[252:253], v251, s[16:19], 0 offen sc1
s_sub_u32 s3, s3, 1
s_waitcnt vmcnt(0)
s_cbranch_scc1 LM_pb2_go
v_cmp_ne_u64 vcc, s[98:99], v[252:253]
s_nop 1
s_cbranch_vccnz LM_pb2
LM_pb2_go:
s_branch LM_pb_ret
L2_Fend:
L2_rare_site0:
s_mov_b32 s36, 0
s_branch L2_rare_0_0
L2_rare_site4:
s_mov_b32 s36, 4
s_branch L2_rare_0_0
L2_rare_0_0:
s_nop 15
s_nop 15
s_waitcnt lgkmcnt(0)
v_add_u32 v254, 0x18000, v240
v_and_b32 v254, 0x1ffff, v254
ds_read_b128 v[232:235], v254 offset:16384
s_waitcnt lgkmcnt(0)
v_mfma_f32_16x16x32_bf16 v[128:131], v[232:235], v[0:3], v[192:195]
v_mfma_f32_16x16x32_bf16 v[132:135], v[232:235], v[32:35], v[196:199]
v_mfma_f32_16x16x32_bf16 v[136:139], v[232:235], v[64:67], v[200:203]
v_mfma_f32_16x16x32_bf16 v[140:143], v[232:235], v[96:99], v[204:207]
s_nop 7
ds_read_b128 v[232:235], v254 offset:16896
s_waitcnt lgkmcnt(0)
v_mfma_f32_16x16x32_bf16 v[128:131], v[232:235], v[4:7], v[128:131]
v_mfma_f32_16x16x32_bf16 v[132:135], v[232:235], v[36:39], v[132:135]
v_mfma_f32_16x16x32_bf16 v[136:139], v[232:235], v[68:71], v[136:139]
v_mfma_f32_16x16x32_bf16 v[140:143], v[232:235], v[100:103], v[140:143]
s_nop 7
ds_read_b128 v[232:235], v254 offset:20480
s_waitcnt lgkmcnt(0)
v_mfma_f32_16x16x32_bf16 v[128:131], v[232:235], v[8:11], v[128:131]
v_mfma_f32_16x16x32_bf16 v[132:135], v[232:235], v[40:43], v[132:135]
v_mfma_f32_16x16x32_bf16 v[136:139], v[232:235], v[72:75], v[136:139]
v_mfma_f32_16x16x32_bf16 v[140:143], v[232:235], v[104:107], v[140:143]
s_nop 7
ds_read_b128 v[232:235], v254 offset:20992
s_waitcnt lgkmcnt(0)
v_mfma_f32_16x16x32_bf16 v[128:131], v[232:235], v[12:15], v[128:131]
v_mfma_f32_16x16x32_bf16 v[132:135], v[232:235], v[44:47], v[132:135]
v_mfma_f32_16x16x32_bf16 v[136:139], v[232:235], v[76:79], v[136:139]
v_mfma_f32_16x16x32_bf16 v[140:143], v[232:235], v[108:111], v[140:143]
s_nop 7
ds_read_b128 v[232:235], v254 offset:24576
s_waitcnt lgkmcnt(0)
v_mfma_f32_16x16x32_bf16 v[128:131], v[232:235], v[16:19], v[128:131]
v_mfma_f32_16x16x32_bf16 v[132:135], v[232:235], v[48:51], v[132:135]
v_mfma_f32_16x16x32_bf16 v[136:139], v[232:235], v[80:83], v[136:139]
v_mfma_f32_16x16x32_bf16 v[140:143], v[232:235], v[112:115], v[140:143]
s_nop 7
ds_read_b128 v[232:235], v254 offset:25088
s_waitcnt lgkmcnt(0)
v_mfma_f32_16x16x32_bf16 v[128:131], v[232:235], v[20:23], v[128:131]
v_mfma_f32_16x16x32_bf16 v[132:135], v[232:235], v[52:55], v[132:135]
v_mfma_f32_16x16x32_bf16 v[136:139], v[232:235], v[84:87], v[136:139]
v_mfma_f32_16x16x32_bf16 v[140:143], v[232:235], v[116:119], v[140:143]
s_nop 7
ds_read_b128 v[232:235], v254 offset:28672
s_waitcnt lgkmcnt(0)
v_mfma_f32_16x16x32_bf16 v[128:131], v[232:235], v[24:27], v[128:131]
v_mfma_f32_16x16x32_bf16 v[132:135], v[232:235], v[56:59], v[132:135]
v_mfma_f32_16x16x32_bf16 v[136:139], v[232:235], v[88:91], v[136:139]
v_mfma_f32_16x16x32_bf16 v[140:143], v[232:235], v[120:123], v[140:143]
s_nop 7
ds_read_b128 v[232:235], v254 offset:29184
s_waitcnt lgkmcnt(0)
v_mfma_f32_16x16x32_bf16 v[128:131], v[232:235], v[28:31], v[128:131]
v_mfma_f32_16x16x32_bf16 v[132:135], v[232:235], v[60:63], v[132:135]
v_mfma_f32_16x16x32_bf16 v[136:139], v[232:235], v[92:95], v[136:139]
v_mfma_f32_16x16x32_bf16 v[140:143], v[232:235], v[124:127], v[140:143]
s_nop 7
s_nop 7
v_log_f32 v243, v224
v_max3_f32 v232, v128, v129, v130
v_max3_f32 v232, v232, v131, v243
v_mov_b32 v243, v232
s_nop 1
v_permlane32_swap_b32 v232, v243
s_nop 1
v_max_f32 v232, v232, v243
v_mov_b32 v243, v232
s_nop 1
v_permlane16_swap_b32 v232, v243
s_nop 1
v_max_f32 v232, v232, v243
v_ceil_f32 v232, v232
v_max_f32 v232, 0, v232
v_sub_f32 v243, 0, v232
v_exp_f32 v236, v243
s_nop 1
v_mul_f32 v224, v224, v236
v_sub_f32 v192, v192, v232
v_sub_f32 v128, v128, v232
v_sub_f32 v144, v144, v232
v_sub_f32 v193, v193, v232
v_sub_f32 v129, v129, v232
v_sub_f32 v145, v145, v232
v_sub_f32 v194, v194, v232
v_sub_f32 v130, v130, v232
v_sub_f32 v146, v146, v232
v_sub_f32 v195, v195, v232
v_sub_f32 v131, v131, v232
v_sub_f32 v147, v147, v232
v_lshlrev_b32 v242, 16, v160
v_and_b32 v243, 0xffff0000, v160
v_mul_f32 v242, v242, v236
v_mul_f32 v243, v243, v236
v_cvt_pk_bf16_f32 v160, v242, v243
v_lshlrev_b32 v242, 16, v161
v_and_b32 v243, 0xffff0000, v161
v_mul_f32 v242, v242, v236
v_mul_f32 v243, v243, v236
v_cvt_pk_bf16_f32 v161, v242, v243
v_lshlrev_b32 v242, 16, v162
v_and_b32 v243, 0xffff0000, v162
v_mul_f32 v242, v242, v236
v_mul_f32 v243, v243, v236
v_cvt_pk_bf16_f32 v162, v242, v243
v_lshlrev_b32 v242, 16, v163
v_and_b32 v243, 0xffff0000, v163
v_mul_f32 v242, v242, v236
v_mul_f32 v243, v243, v236
v_cvt_pk_bf16_f32 v163, v242, v243
v_lshlrev_b32 v242, 16, v176
v_and_b32 v243, 0xffff0000, v176
v_mul_f32 v242, v242, v236
v_mul_f32 v243, v243, v236
v_cvt_pk_bf16_f32 v176, v242, v243
v_lshlrev_b32 v242, 16, v177
v_and_b32 v243, 0xffff0000, v177
v_mul_f32 v242, v242, v236
v_mul_f32 v243, v243, v236
v_cvt_pk_bf16_f32 v177, v242, v243
v_lshlrev_b32 v242, 16, v178
v_and_b32 v243, 0xffff0000, v178
v_mul_f32 v242, v242, v236
v_mul_f32 v243, v243, v236
v_cvt_pk_bf16_f32 v178, v242, v243
v_lshlrev_b32 v242, 16, v179
v_and_b32 v243, 0xffff0000, v179
v_mul_f32 v242, v242, v236
v_mul_f32 v243, v243, v236
v_cvt_pk_bf16_f32 v179, v242, v243
v_log_f32 v243, v225
v_max3_f32 v233, v132, v133, v134
v_max3_f32 v233, v233, v135, v243
v_mov_b32 v243, v233
s_nop 1
v_permlane32_swap_b32 v233, v243
s_nop 1
v_max_f32 v233, v233, v243
v_mov_b32 v243, v233
s_nop 1
v_permlane16_swap_b32 v233, v243
s_nop 1
v_max_f32 v233, v233, v243
v_ceil_f32 v233, v233
v_max_f32 v233, 0, v233
v_sub_f32 v243, 0, v233
v_exp_f32 v237, v243
s_nop 1
v_mul_f32 v225, v225, v237
v_sub_f32 v196, v196, v233
v_sub_f32 v132, v132, v233
v_sub_f32 v148, v148, v233
v_sub_f32 v197, v197, v233
v_sub_f32 v133, v133, v233
v_sub_f32 v149, v149, v233
v_sub_f32 v198, v198, v233
v_sub_f32 v134, v134, v233
v_sub_f32 v150, v150, v233
v_sub_f32 v199, v199, v233
v_sub_f32 v135, v135, v233
v_sub_f32 v151, v151, v233
v_lshlrev_b32 v242, 16, v164
v_and_b32 v243, 0xffff0000, v164
v_mul_f32 v242, v242, v237
v_mul_f32 v243, v243, v237
v_cvt_pk_bf16_f32 v164, v242, v243
v_lshlrev_b32 v242, 16, v165
v_and_b32 v243, 0xffff0000, v165
v_mul_f32 v242, v242, v237
v_mul_f32 v243, v243, v237
v_cvt_pk_bf16_f32 v165, v242, v243
v_lshlrev_b32 v242, 16, v166
v_and_b32 v243, 0xffff0000, v166
v_mul_f32 v242, v242, v237
v_mul_f32 v243, v243, v237
v_cvt_pk_bf16_f32 v166, v242, v243
v_lshlrev_b32 v242, 16, v167
v_and_b32 v243, 0xffff0000, v167
v_mul_f32 v242, v242, v237
v_mul_f32 v243, v243, v237
v_cvt_pk_bf16_f32 v167, v242, v243
v_lshlrev_b32 v242, 16, v180
v_and_b32 v243, 0xffff0000, v180
v_mul_f32 v242, v242, v237
v_mul_f32 v243, v243, v237
v_cvt_pk_bf16_f32 v180, v242, v243
v_lshlrev_b32 v242, 16, v181
v_and_b32 v243, 0xffff0000, v181
v_mul_f32 v242, v242, v237
v_mul_f32 v243, v243, v237
v_cvt_pk_bf16_f32 v181, v242, v243
v_lshlrev_b32 v242, 16, v182
v_and_b32 v243, 0xffff0000, v182
v_mul_f32 v242, v242, v237
v_mul_f32 v243, v243, v237
v_cvt_pk_bf16_f32 v182, v242, v243
v_lshlrev_b32 v242, 16, v183
v_and_b32 v243, 0xffff0000, v183
v_mul_f32 v242, v242, v237
v_mul_f32 v243, v243, v237
v_cvt_pk_bf16_f32 v183, v242, v243
v_log_f32 v243, v226
v_max3_f32 v234, v136, v137, v138
v_max3_f32 v234, v234, v139, v243
v_mov_b32 v243, v234
s_nop 1
v_permlane32_swap_b32 v234, v243
s_nop 1
v_max_f32 v234, v234, v243
v_mov_b32 v243, v234
s_nop 1
v_permlane16_swap_b32 v234, v243
s_nop 1
v_max_f32 v234, v234, v243
v_ceil_f32 v234, v234
v_max_f32 v234, 0, v234
v_sub_f32 v243, 0, v234
v_exp_f32 v238, v243
s_nop 1
v_mul_f32 v226, v226, v238
v_sub_f32 v200, v200, v234
v_sub_f32 v136, v136, v234
v_sub_f32 v152, v152, v234
v_sub_f32 v201, v201, v234
v_sub_f32 v137, v137, v234
v_sub_f32 v153, v153, v234
v_sub_f32 v202, v202, v234
v_sub_f32 v138, v138, v234
v_sub_f32 v154, v154, v234
v_sub_f32 v203, v203, v234
v_sub_f32 v139, v139, v234
v_sub_f32 v155, v155, v234
v_lshlrev_b32 v242, 16, v168
v_and_b32 v243, 0xffff0000, v168
v_mul_f32 v242, v242, v238
v_mul_f32 v243, v243, v238
v_cvt_pk_bf16_f32 v168, v242, v243
v_lshlrev_b32 v242, 16, v169
v_and_b32 v243, 0xffff0000, v169
v_mul_f32 v242, v242, v238
v_mul_f32 v243, v243, v238
v_cvt_pk_bf16_f32 v169, v242, v243
v_lshlrev_b32 v242, 16, v170
v_and_b32 v243, 0xffff0000, v170
v_mul_f32 v242, v242, v238
v_mul_f32 v243, v243, v238
v_cvt_pk_bf16_f32 v170, v242, v243
v_lshlrev_b32 v242, 16, v171
v_and_b32 v243, 0xffff0000, v171
v_mul_f32 v242, v242, v238
v_mul_f32 v243, v243, v238
v_cvt_pk_bf16_f32 v171, v242, v243
v_lshlrev_b32 v242, 16, v184
v_and_b32 v243, 0xffff0000, v184
v_mul_f32 v242, v242, v238
v_mul_f32 v243, v243, v238
v_cvt_pk_bf16_f32 v184, v242, v243
v_lshlrev_b32 v242, 16, v185
v_and_b32 v243, 0xffff0000, v185
v_mul_f32 v242, v242, v238
v_mul_f32 v243, v243, v238
v_cvt_pk_bf16_f32 v185, v242, v243
v_lshlrev_b32 v242, 16, v186
v_and_b32 v243, 0xffff0000, v186
v_mul_f32 v242, v242, v238
v_mul_f32 v243, v243, v238
v_cvt_pk_bf16_f32 v186, v242, v243
v_lshlrev_b32 v242, 16, v187
v_and_b32 v243, 0xffff0000, v187
v_mul_f32 v242, v242, v238
v_mul_f32 v243, v243, v238
v_cvt_pk_bf16_f32 v187, v242, v243
v_log_f32 v243, v227
v_max3_f32 v235, v140, v141, v142
v_max3_f32 v235, v235, v143, v243
v_mov_b32 v243, v235
s_nop 1
v_permlane32_swap_b32 v235, v243
s_nop 1
v_max_f32 v235, v235, v243
v_mov_b32 v243, v235
s_nop 1
v_permlane16_swap_b32 v235, v243
s_nop 1
v_max_f32 v235, v235, v243
v_ceil_f32 v235, v235
v_max_f32 v235, 0, v235
v_sub_f32 v243, 0, v235
v_exp_f32 v239, v243
s_nop 1
v_mul_f32 v227, v227, v239
v_sub_f32 v204, v204, v235
v_sub_f32 v140, v140, v235
v_sub_f32 v156, v156, v235
v_sub_f32 v205, v205, v235
v_sub_f32 v141, v141, v235
v_sub_f32 v157, v157, v235
v_sub_f32 v206, v206, v235
v_sub_f32 v142, v142, v235
v_sub_f32 v158, v158, v235
v_sub_f32 v207, v207, v235
v_sub_f32 v143, v143, v235
v_sub_f32 v159, v159, v235
v_lshlrev_b32 v242, 16, v172
v_and_b32 v243, 0xffff0000, v172
v_mul_f32 v242, v242, v239
v_mul_f32 v243, v243, v239
v_cvt_pk_bf16_f32 v172, v242, v243
v_lshlrev_b32 v242, 16, v173
v_and_b32 v243, 0xffff0000, v173
v_mul_f32 v242, v242, v239
v_mul_f32 v243, v243, v239
v_cvt_pk_bf16_f32 v173, v242, v243
v_lshlrev_b32 v242, 16, v174
v_and_b32 v243, 0xffff0000, v174
v_mul_f32 v242, v242, v239
v_mul_f32 v243, v243, v239
v_cvt_pk_bf16_f32 v174, v242, v243
v_lshlrev_b32 v242, 16, v175
v_and_b32 v243, 0xffff0000, v175
v_mul_f32 v242, v242, v239
v_mul_f32 v243, v243, v239
v_cvt_pk_bf16_f32 v175, v242, v243
v_lshlrev_b32 v242, 16, v188
v_and_b32 v243, 0xffff0000, v188
v_mul_f32 v242, v242, v239
v_mul_f32 v243, v243, v239
v_cvt_pk_bf16_f32 v188, v242, v243
v_lshlrev_b32 v242, 16, v189
v_and_b32 v243, 0xffff0000, v189
v_mul_f32 v242, v242, v239
v_mul_f32 v243, v243, v239
v_cvt_pk_bf16_f32 v189, v242, v243
v_lshlrev_b32 v242, 16, v190
v_and_b32 v243, 0xffff0000, v190
v_mul_f32 v242, v242, v239
v_mul_f32 v243, v243, v239
v_cvt_pk_bf16_f32 v190, v242, v243
v_lshlrev_b32 v242, 16, v191
v_and_b32 v243, 0xffff0000, v191
v_mul_f32 v242, v242, v239
v_mul_f32 v243, v243, v239
v_cvt_pk_bf16_f32 v191, v242, v243
v_exp_f32 v128, v128
v_exp_f32 v129, v129
v_exp_f32 v130, v130
v_exp_f32 v131, v131
s_nop 1
v_add_f32 v228, v224, v128
v_add_f32 v228, v228, v129
v_add_f32 v228, v228, v130
v_add_f32 v228, v228, v131
v_exp_f32 v132, v132
v_exp_f32 v133, v133
v_exp_f32 v134, v134
v_exp_f32 v135, v135
s_nop 1
v_add_f32 v229, v225, v132
v_add_f32 v229, v229, v133
v_add_f32 v229, v229, v134
v_add_f32 v229, v229, v135
v_exp_f32 v136, v136
v_exp_f32 v137, v137
v_exp_f32 v138, v138
v_exp_f32 v139, v139
s_nop 1
v_add_f32 v230, v226, v136
v_add_f32 v230, v230, v137
v_add_f32 v230, v230, v138
v_add_f32 v230, v230, v139
v_exp_f32 v140, v140
v_exp_f32 v141, v141
v_exp_f32 v142, v142
v_exp_f32 v143, v143
s_nop 1
v_add_f32 v231, v227, v140
v_add_f32 v231, v231, v141
v_add_f32 v231, v231, v142
v_add_f32 v231, v231, v143
s_branch L2_rare_common
L2_rare_site1:
s_mov_b32 s36, 1
s_branch L2_rare_0_1
L2_rare_site5:
s_mov_b32 s36, 5
s_branch L2_rare_0_1
L2_rare_0_1:
s_nop 15
s_nop 15
s_waitcnt lgkmcnt(0)
v_add_u32 v254, 0x18000, v240
v_and_b32 v254, 0x1ffff, v254
ds_read_b128 v[232:235], v254 offset:18432
s_waitcnt lgkmcnt(0)
v_mfma_f32_16x16x32_bf16 v[144:147], v[232:235], v[0:3], v[192:195]
v_mfma_f32_16x16x32_bf16 v[148:151], v[232:235], v[32:35], v[196:199]
v_mfma_f32_16x16x32_bf16 v[152:155], v[232:235], v[64:67], v[200:203]
v_mfma_f32_16x16x32_bf16 v[156:159], v[232:235], v[96:99], v[204:207]
s_nop 7
ds_read_b128 v[232:235], v254 offset:18944
s_waitcnt lgkmcnt(0)
v_mfma_f32_16x16x32_bf16 v[144:147], v[232:235], v[4:7], v[144:147]
v_mfma_f32_16x16x32_bf16 v[148:151], v[232:235], v[36:39], v[148:151]
v_mfma_f32_16x16x32_bf16 v[152:155], v[232:235], v[68:71], v[152:155]
v_mfma_f32_16x16x32_bf16 v[156:159], v[232:235], v[100:103], v[156:159]
s_nop 7
ds_read_b128 v[232:235], v254 offset:22528
s_waitcnt lgkmcnt(0)
v_mfma_f32_16x16x32_bf16 v[144:147], v[232:235], v[8:11], v[144:147]
v_mfma_f32_16x16x32_bf16 v[148:151], v[232:235], v[40:43], v[148:151]
v_mfma_f32_16x16x32_bf16 v[152:155], v[232:235], v[72:75], v[152:155]
v_mfma_f32_16x16x32_bf16 v[156:159], v[232:235], v[104:107], v[156:159]
s_nop 7
ds_read_b128 v[232:235], v254 offset:23040
s_waitcnt lgkmcnt(0)
v_mfma_f32_16x16x32_bf16 v[144:147], v[232:235], v[12:15], v[144:147]
v_mfma_f32_16x16x32_bf16 v[148:151], v[232:235], v[44:47], v[148:151]
v_mfma_f32_16x16x32_bf16 v[152:155], v[232:235], v[76:79], v[152:155]
v_mfma_f32_16x16x32_bf16 v[156:159], v[232:235], v[108:111], v[156:159]
s_nop 7
ds_read_b128 v[232:235], v254 offset:26624
s_waitcnt lgkmcnt(0)
v_mfma_f32_16x16x32_bf16 v[144:147], v[232:235], v[16:19], v[144:147]
v_mfma_f32_16x16x32_bf16 v[148:151], v[232:235], v[48:51], v[148:151]
v_mfma_f32_16x16x32_bf16 v[152:155], v[232:235], v[80:83], v[152:155]
v_mfma_f32_16x16x32_bf16 v[156:159], v[232:235], v[112:115], v[156:159]
s_nop 7
ds_read_b128 v[232:235], v254 offset:27136
s_waitcnt lgkmcnt(0)
v_mfma_f32_16x16x32_bf16 v[144:147], v[232:235], v[20:23], v[144:147]
v_mfma_f32_16x16x32_bf16 v[148:151], v[232:235], v[52:55], v[148:151]
v_mfma_f32_16x16x32_bf16 v[152:155], v[232:235], v[84:87], v[152:155]
v_mfma_f32_16x16x32_bf16 v[156:159], v[232:235], v[116:119], v[156:159]
s_nop 7
ds_read_b128 v[232:235], v254 offset:30720
s_waitcnt lgkmcnt(0)
v_mfma_f32_16x16x32_bf16 v[144:147], v[232:235], v[24:27], v[144:147]
v_mfma_f32_16x16x32_bf16 v[148:151], v[232:235], v[56:59], v[148:151]
v_mfma_f32_16x16x32_bf16 v[152:155], v[232:235], v[88:91], v[152:155]
v_mfma_f32_16x16x32_bf16 v[156:159], v[232:235], v[120:123], v[156:159]
s_nop 7
ds_read_b128 v[232:235], v254 offset:31232
s_waitcnt lgkmcnt(0)
v_mfma_f32_16x16x32_bf16 v[144:147], v[232:235], v[28:31], v[144:147]
v_mfma_f32_16x16x32_bf16 v[148:151], v[232:235], v[60:63], v[148:151]
v_mfma_f32_16x16x32_bf16 v[152:155], v[232:235], v[92:95], v[152:155]
v_mfma_f32_16x16x32_bf16 v[156:159], v[232:235], v[124:127], v[156:159]
s_nop 7
s_nop 7
v_log_f32 v243, v228
v_max3_f32 v232, v144, v145, v146
v_max3_f32 v232, v232, v147, v243
v_mov_b32 v243, v232
s_nop 1
v_permlane32_swap_b32 v232, v243
s_nop 1
v_max_f32 v232, v232, v243
v_mov_b32 v243, v232
s_nop 1
v_permlane16_swap_b32 v232, v243
s_nop 1
v_max_f32 v232, v232, v243
v_ceil_f32 v232, v232
v_max_f32 v232, 0, v232
v_sub_f32 v243, 0, v232
v_exp_f32 v236, v243
s_nop 1
v_mul_f32 v228, v228, v236
v_sub_f32 v192, v192, v232
v_sub_f32 v128, v128, v232
v_sub_f32 v144, v144, v232
v_sub_f32 v193, v193, v232
v_sub_f32 v129, v129, v232
v_sub_f32 v145, v145, v232
v_sub_f32 v194, v194, v232
v_sub_f32 v130, v130, v232
v_sub_f32 v146, v146, v232
v_sub_f32 v195, v195, v232
v_sub_f32 v131, v131, v232
v_sub_f32 v147, v147, v232
v_lshlrev_b32 v242, 16, v160
v_and_b32 v243, 0xffff0000, v160
v_mul_f32 v242, v242, v236
v_mul_f32 v243, v243, v236
v_cvt_pk_bf16_f32 v160, v242, v243
v_lshlrev_b32 v242, 16, v161
v_and_b32 v243, 0xffff0000, v161
v_mul_f32 v242, v242, v236
v_mul_f32 v243, v243, v236
v_cvt_pk_bf16_f32 v161, v242, v243
v_lshlrev_b32 v242, 16, v162
v_and_b32 v243, 0xffff0000, v162
v_mul_f32 v242, v242, v236
v_mul_f32 v243, v243, v236
v_cvt_pk_bf16_f32 v162, v242, v243
v_lshlrev_b32 v242, 16, v163
v_and_b32 v243, 0xffff0000, v163
v_mul_f32 v242, v242, v236
v_mul_f32 v243, v243, v236
v_cvt_pk_bf16_f32 v163, v242, v243
v_lshlrev_b32 v242, 16, v176
v_and_b32 v243, 0xffff0000, v176
v_mul_f32 v242, v242, v236
v_mul_f32 v243, v243, v236
v_cvt_pk_bf16_f32 v176, v242, v243
v_lshlrev_b32 v242, 16, v177
v_and_b32 v243, 0xffff0000, v177
v_mul_f32 v242, v242, v236
v_mul_f32 v243, v243, v236
v_cvt_pk_bf16_f32 v177, v242, v243
v_log_f32 v243, v229
v_max3_f32 v233, v148, v149, v150
v_max3_f32 v233, v233, v151, v243
v_mov_b32 v243, v233
s_nop 1
v_permlane32_swap_b32 v233, v243
s_nop 1
v_max_f32 v233, v233, v243
v_mov_b32 v243, v233
s_nop 1
v_permlane16_swap_b32 v233, v243
s_nop 1
v_max_f32 v233, v233, v243
v_ceil_f32 v233, v233
v_max_f32 v233, 0, v233
v_sub_f32 v243, 0, v233
v_exp_f32 v237, v243
s_nop 1
v_mul_f32 v229, v229, v237
v_sub_f32 v196, v196, v233
v_sub_f32 v132, v132, v233
v_sub_f32 v148, v148, v233
v_sub_f32 v197, v197, v233
v_sub_f32 v133, v133, v233
v_sub_f32 v149, v149, v233
v_sub_f32 v198, v198, v233
v_sub_f32 v134, v134, v233
v_sub_f32 v150, v150, v233
v_sub_f32 v199, v199, v233
v_sub_f32 v135, v135, v233
v_sub_f32 v151, v151, v233
v_lshlrev_b32 v242, 16, v164
v_and_b32 v243, 0xffff0000, v164
v_mul_f32 v242, v242, v237
v_mul_f32 v243, v243, v237
v_cvt_pk_bf16_f32 v164, v242, v243
v_lshlrev_b32 v242, 16, v165
v_and_b32 v243, 0xffff0000, v165
v_mul_f32 v242, v242, v237
v_mul_f32 v243, v243, v237
v_cvt_pk_bf16_f32 v165, v242, v243
v_lshlrev_b32 v242, 16, v166
v_and_b32 v243, 0xffff0000, v166
v_mul_f32 v242, v242, v237
v_mul_f32 v243, v243, v237
v_cvt_pk_bf16_f32 v166, v242, v243
v_lshlrev_b32 v242, 16, v167
v_and_b32 v243, 0xffff0000, v167
v_mul_f32 v242, v242, v237
v_mul_f32 v243, v243, v237
v_cvt_pk_bf16_f32 v167, v242, v243
v_lshlrev_b32 v242, 16, v180
v_and_b32 v243, 0xffff0000, v180
v_mul_f32 v242, v242, v237
v_mul_f32 v243, v243, v237
v_cvt_pk_bf16_f32 v180, v242, v243
v_lshlrev_b32 v242, 16, v181
v_and_b32 v243, 0xffff0000, v181
v_mul_f32 v242, v242, v237
v_mul_f32 v243, v243, v237
v_cvt_pk_bf16_f32 v181, v242, v243
v_log_f32 v243, v230
v_max3_f32 v234, v152, v153, v154
v_max3_f32 v234, v234, v155, v243
v_mov_b32 v243, v234
s_nop 1
v_permlane32_swap_b32 v234, v243
s_nop 1
v_max_f32 v234, v234, v243
v_mov_b32 v243, v234
s_nop 1
v_permlane16_swap_b32 v234, v243
s_nop 1
v_max_f32 v234, v234, v243
v_ceil_f32 v234, v234
v_max_f32 v234, 0, v234
v_sub_f32 v243, 0, v234
v_exp_f32 v238, v243
s_nop 1
v_mul_f32 v230, v230, v238
v_sub_f32 v200, v200, v234
v_sub_f32 v136, v136, v234
v_sub_f32 v152, v152, v234
v_sub_f32 v201, v201, v234
v_sub_f32 v137, v137, v234
v_sub_f32 v153, v153, v234
v_sub_f32 v202, v202, v234
v_sub_f32 v138, v138, v234
v_sub_f32 v154, v154, v234
v_sub_f32 v203, v203, v234
v_sub_f32 v139, v139, v234
v_sub_f32 v155, v155, v234
v_lshlrev_b32 v242, 16, v168
v_and_b32 v243, 0xffff0000, v168
v_mul_f32 v242, v242, v238
v_mul_f32 v243, v243, v238
v_cvt_pk_bf16_f32 v168, v242, v243
v_lshlrev_b32 v242, 16, v169
v_and_b32 v243, 0xffff0000, v169
v_mul_f32 v242, v242, v238
v_mul_f32 v243, v243, v238
v_cvt_pk_bf16_f32 v169, v242, v243
v_lshlrev_b32 v242, 16, v170
v_and_b32 v243, 0xffff0000, v170
v_mul_f32 v242, v242, v238
v_mul_f32 v243, v243, v238
v_cvt_pk_bf16_f32 v170, v242, v243
v_lshlrev_b32 v242, 16, v171
v_and_b32 v243, 0xffff0000, v171
v_mul_f32 v242, v242, v238
v_mul_f32 v243, v243, v238
v_cvt_pk_bf16_f32 v171, v242, v243
v_lshlrev_b32 v242, 16, v184
v_and_b32 v243, 0xffff0000, v184
v_mul_f32 v242, v242, v238
v_mul_f32 v243, v243, v238
v_cvt_pk_bf16_f32 v184, v242, v243
v_lshlrev_b32 v242, 16, v185
v_and_b32 v243, 0xffff0000, v185
v_mul_f32 v242, v242, v238
v_mul_f32 v243, v243, v238
v_cvt_pk_bf16_f32 v185, v242, v243
v_log_f32 v243, v231
v_max3_f32 v235, v156, v157, v158
v_max3_f32 v235, v235, v159, v243
v_mov_b32 v243, v235
s_nop 1
v_permlane32_swap_b32 v235, v243
s_nop 1
v_max_f32 v235, v235, v243
v_mov_b32 v243, v235
s_nop 1
v_permlane16_swap_b32 v235, v243
s_nop 1
v_max_f32 v235, v235, v243
v_ceil_f32 v235, v235
v_max_f32 v235, 0, v235
v_sub_f32 v243, 0, v235
v_exp_f32 v239, v243
s_nop 1
v_mul_f32 v231, v231, v239
v_sub_f32 v204, v204, v235
v_sub_f32 v140, v140, v235
v_sub_f32 v156, v156, v235
v_sub_f32 v205, v205, v235
v_sub_f32 v141, v141, v235
v_sub_f32 v157, v157, v235
v_sub_f32 v206, v206, v235
v_sub_f32 v142, v142, v235
v_sub_f32 v158, v158, v235
v_sub_f32 v207, v207, v235
v_sub_f32 v143, v143, v235
v_sub_f32 v159, v159, v235
v_lshlrev_b32 v242, 16, v172
v_and_b32 v243, 0xffff0000, v172
v_mul_f32 v242, v242, v239
v_mul_f32 v243, v243, v239
v_cvt_pk_bf16_f32 v172, v242, v243
v_lshlrev_b32 v242, 16, v173
v_and_b32 v243, 0xffff0000, v173
v_mul_f32 v242, v242, v239
v_mul_f32 v243, v243, v239
v_cvt_pk_bf16_f32 v173, v242, v243
v_lshlrev_b32 v242, 16, v174
v_and_b32 v243, 0xffff0000, v174
v_mul_f32 v242, v242, v239
v_mul_f32 v243, v243, v239
v_cvt_pk_bf16_f32 v174, v242, v243
v_lshlrev_b32 v242, 16, v175
v_and_b32 v243, 0xffff0000, v175
v_mul_f32 v242, v242, v239
v_mul_f32 v243, v243, v239
v_cvt_pk_bf16_f32 v175, v242, v243
v_lshlrev_b32 v242, 16, v188
v_and_b32 v243, 0xffff0000, v188
v_mul_f32 v242, v242, v239
v_mul_f32 v243, v243, v239
v_cvt_pk_bf16_f32 v188, v242, v243
v_lshlrev_b32 v242, 16, v189
v_and_b32 v243, 0xffff0000, v189
v_mul_f32 v242, v242, v239
v_mul_f32 v243, v243, v239
v_cvt_pk_bf16_f32 v189, v242, v243
v_exp_f32 v144, v144
v_exp_f32 v145, v145
v_exp_f32 v146, v146
v_exp_f32 v147, v147
s_nop 1
v_add_f32 v224, v228, v144
v_add_f32 v224, v224, v145
v_add_f32 v224, v224, v146
v_add_f32 v224, v224, v147
v_exp_f32 v148, v148
v_exp_f32 v149, v149
v_exp_f32 v150, v150
v_exp_f32 v151, v151
s_nop 1
v_add_f32 v225, v229, v148
v_add_f32 v225, v225, v149
v_add_f32 v225, v225, v150
v_add_f32 v225, v225, v151
v_exp_f32 v152, v152
v_exp_f32 v153, v153
v_exp_f32 v154, v154
v_exp_f32 v155, v155
s_nop 1
v_add_f32 v226, v230, v152
v_add_f32 v226, v226, v153
v_add_f32 v226, v226, v154
v_add_f32 v226, v226, v155
v_exp_f32 v156, v156
v_exp_f32 v157, v157
v_exp_f32 v158, v158
v_exp_f32 v159, v159
s_nop 1
v_add_f32 v227, v231, v156
v_add_f32 v227, v227, v157
v_add_f32 v227, v227, v158
v_add_f32 v227, v227, v159
s_branch L2_rare_common
L2_rare_site2:
s_mov_b32 s36, 2
s_branch L2_rare_1_0
L2_rare_1_0:
s_nop 15
s_nop 15
s_waitcnt lgkmcnt(0)
v_add_u32 v254, 0x0, v240
v_and_b32 v254, 0x1ffff, v254
ds_read_b128 v[232:235], v254 offset:0
s_waitcnt lgkmcnt(0)
v_mfma_f32_16x16x32_bf16 v[128:131], v[232:235], v[0:3], v[192:195]
v_mfma_f32_16x16x32_bf16 v[132:135], v[232:235], v[32:35], v[196:199]
v_mfma_f32_16x16x32_bf16 v[136:139], v[232:235], v[64:67], v[200:203]
v_mfma_f32_16x16x32_bf16 v[140:143], v[232:235], v[96:99], v[204:207]
s_nop 7
ds_read_b128 v[232:235], v254 offset:512
s_waitcnt lgkmcnt(0)
v_mfma_f32_16x16x32_bf16 v[128:131], v[232:235], v[4:7], v[128:131]
v_mfma_f32_16x16x32_bf16 v[132:135], v[232:235], v[36:39], v[132:135]
v_mfma_f32_16x16x32_bf16 v[136:139], v[232:235], v[68:71], v[136:139]
v_mfma_f32_16x16x32_bf16 v[140:143], v[232:235], v[100:103], v[140:143]
s_nop 7
ds_read_b128 v[232:235], v254 offset:4096
s_waitcnt lgkmcnt(0)
v_mfma_f32_16x16x32_bf16 v[128:131], v[232:235], v[8:11], v[128:131]
v_mfma_f32_16x16x32_bf16 v[132:135], v[232:235], v[40:43], v[132:135]
v_mfma_f32_16x16x32_bf16 v[136:139], v[232:235], v[72:75], v[136:139]
v_mfma_f32_16x16x32_bf16 v[140:143], v[232:235], v[104:107], v[140:143]
s_nop 7
ds_read_b128 v[232:235], v254 offset:4608
s_waitcnt lgkmcnt(0)
v_mfma_f32_16x16x32_bf16 v[128:131], v[232:235], v[12:15], v[128:131]
v_mfma_f32_16x16x32_bf16 v[132:135], v[232:235], v[44:47], v[132:135]
v_mfma_f32_16x16x32_bf16 v[136:139], v[232:235], v[76:79], v[136:139]
v_mfma_f32_16x16x32_bf16 v[140:143], v[232:235], v[108:111], v[140:143]
s_nop 7
ds_read_b128 v[232:235], v254 offset:8192
s_waitcnt lgkmcnt(0)
v_mfma_f32_16x16x32_bf16 v[128:131], v[232:235], v[16:19], v[128:131]
v_mfma_f32_16x16x32_bf16 v[132:135], v[232:235], v[48:51], v[132:135]
v_mfma_f32_16x16x32_bf16 v[136:139], v[232:235], v[80:83], v[136:139]
v_mfma_f32_16x16x32_bf16 v[140:143], v[232:235], v[112:115], v[140:143]
s_nop 7
ds_read_b128 v[232:235], v254 offset:8704
s_waitcnt lgkmcnt(0)
v_mfma_f32_16x16x32_bf16 v[128:131], v[232:235], v[20:23], v[128:131]
v_mfma_f32_16x16x32_bf16 v[132:135], v[232:235], v[52:55], v[132:135]
v_mfma_f32_16x16x32_bf16 v[136:139], v[232:235], v[84:87], v[136:139]
v_mfma_f32_16x16x32_bf16 v[140:143], v[232:235], v[116:119], v[140:143]
s_nop 7
ds_read_b128 v[232:235], v254 offset:12288
s_waitcnt lgkmcnt(0)
v_mfma_f32_16x16x32_bf16 v[128:131], v[232:235], v[24:27], v[128:131]
v_mfma_f32_16x16x32_bf16 v[132:135], v[232:235], v[56:59], v[132:135]
v_mfma_f32_16x16x32_bf16 v[136:139], v[232:235], v[88:91], v[136:139]
v_mfma_f32_16x16x32_bf16 v[140:143], v[232:235], v[120:123], v[140:143]
s_nop 7
ds_read_b128 v[232:235], v254 offset:12800
s_waitcnt lgkmcnt(0)
v_mfma_f32_16x16x32_bf16 v[128:131], v[232:235], v[28:31], v[128:131]
v_mfma_f32_16x16x32_bf16 v[132:135], v[232:235], v[60:63], v[132:135]
v_mfma_f32_16x16x32_bf16 v[136:139], v[232:235], v[92:95], v[136:139]
v_mfma_f32_16x16x32_bf16 v[140:143], v[232:235], v[124:127], v[140:143]
s_nop 7
s_nop 7
v_log_f32 v243, v224
v_max3_f32 v232, v128, v129, v130
v_max3_f32 v232, v232, v131, v243
v_mov_b32 v243, v232
s_nop 1
v_permlane32_swap_b32 v232, v243
s_nop 1
v_max_f32 v232, v232, v243
v_mov_b32 v243, v232
s_nop 1
v_permlane16_swap_b32 v232, v243
s_nop 1
v_max_f32 v232, v232, v243
v_ceil_f32 v232, v232
v_max_f32 v232, 0, v232
v_sub_f32 v243, 0, v232
v_exp_f32 v236, v243
s_nop 1
v_mul_f32 v224, v224, v236
v_sub_f32 v192, v192, v232
v_sub_f32 v128, v128, v232
v_sub_f32 v144, v144, v232
v_sub_f32 v193, v193, v232
v_sub_f32 v129, v129, v232
v_sub_f32 v145, v145, v232
v_sub_f32 v194, v194, v232
v_sub_f32 v130, v130, v232
v_sub_f32 v146, v146, v232
v_sub_f32 v195, v195, v232
v_sub_f32 v131, v131, v232
v_sub_f32 v147, v147, v232
v_lshlrev_b32 v242, 16, v176
v_and_b32 v243, 0xffff0000, v176
v_mul_f32 v242, v242, v236
v_mul_f32 v243, v243, v236
v_cvt_pk_bf16_f32 v176, v242, v243
v_lshlrev_b32 v242, 16, v177
v_and_b32 v243, 0xffff0000, v177
v_mul_f32 v242, v242, v236
v_mul_f32 v243, v243, v236
v_cvt_pk_bf16_f32 v177, v242, v243
v_lshlrev_b32 v242, 16, v178
v_and_b32 v243, 0xffff0000, v178
v_mul_f32 v242, v242, v236
v_mul_f32 v243, v243, v236
v_cvt_pk_bf16_f32 v178, v242, v243
v_lshlrev_b32 v242, 16, v179
v_and_b32 v243, 0xffff0000, v179
v_mul_f32 v242, v242, v236
v_mul_f32 v243, v243, v236
v_cvt_pk_bf16_f32 v179, v242, v243
v_lshlrev_b32 v242, 16, v160
v_and_b32 v243, 0xffff0000, v160
v_mul_f32 v242, v242, v236
v_mul_f32 v243, v243, v236
v_cvt_pk_bf16_f32 v160, v242, v243
v_lshlrev_b32 v242, 16, v161
v_and_b32 v243, 0xffff0000, v161
v_mul_f32 v242, v242, v236
v_mul_f32 v243, v243, v236
v_cvt_pk_bf16_f32 v161, v242, v243
v_lshlrev_b32 v242, 16, v162
v_and_b32 v243, 0xffff0000, v162
v_mul_f32 v242, v242, v236
v_mul_f32 v243, v243, v236
v_cvt_pk_bf16_f32 v162, v242, v243
v_lshlrev_b32 v242, 16, v163
v_and_b32 v243, 0xffff0000, v163
v_mul_f32 v242, v242, v236
v_mul_f32 v243, v243, v236
v_cvt_pk_bf16_f32 v163, v242, v243
v_log_f32 v243, v225
v_max3_f32 v233, v132, v133, v134
v_max3_f32 v233, v233, v135, v243
v_mov_b32 v243, v233
s_nop 1
v_permlane32_swap_b32 v233, v243
s_nop 1
v_max_f32 v233, v233, v243
v_mov_b32 v243, v233
s_nop 1
v_permlane16_swap_b32 v233, v243
s_nop 1
v_max_f32 v233, v233, v243
v_ceil_f32 v233, v233
v_max_f32 v233, 0, v233
v_sub_f32 v243, 0, v233
v_exp_f32 v237, v243
s_nop 1
v_mul_f32 v225, v225, v237
v_sub_f32 v196, v196, v233
v_sub_f32 v132, v132, v233
v_sub_f32 v148, v148, v233
v_sub_f32 v197, v197, v233
v_sub_f32 v133, v133, v233
v_sub_f32 v149, v149, v233
v_sub_f32 v198, v198, v233
v_sub_f32 v134, v134, v233
v_sub_f32 v150, v150, v233
v_sub_f32 v199, v199, v233
v_sub_f32 v135, v135, v233
v_sub_f32 v151, v151, v233
v_lshlrev_b32 v242, 16, v180
v_and_b32 v243, 0xffff0000, v180
v_mul_f32 v242, v242, v237
v_mul_f32 v243, v243, v237
v_cvt_pk_bf16_f32 v180, v242, v243
v_lshlrev_b32 v242, 16, v181
v_and_b32 v243, 0xffff0000, v181
v_mul_f32 v242, v242, v237
v_mul_f32 v243, v243, v237
v_cvt_pk_bf16_f32 v181, v242, v243
v_lshlrev_b32 v242, 16, v182
v_and_b32 v243, 0xffff0000, v182
v_mul_f32 v242, v242, v237
v_mul_f32 v243, v243, v237
v_cvt_pk_bf16_f32 v182, v242, v243
v_lshlrev_b32 v242, 16, v183
v_and_b32 v243, 0xffff0000, v183
v_mul_f32 v242, v242, v237
v_mul_f32 v243, v243, v237
v_cvt_pk_bf16_f32 v183, v242, v243
v_lshlrev_b32 v242, 16, v164
v_and_b32 v243, 0xffff0000, v164
v_mul_f32 v242, v242, v237
v_mul_f32 v243, v243, v237
v_cvt_pk_bf16_f32 v164, v242, v243
v_lshlrev_b32 v242, 16, v165
v_and_b32 v243, 0xffff0000, v165
v_mul_f32 v242, v242, v237
v_mul_f32 v243, v243, v237
v_cvt_pk_bf16_f32 v165, v242, v243
v_lshlrev_b32 v242, 16, v166
v_and_b32 v243, 0xffff0000, v166
v_mul_f32 v242, v242, v237
v_mul_f32 v243, v243, v237
v_cvt_pk_bf16_f32 v166, v242, v243
v_lshlrev_b32 v242, 16, v167
v_and_b32 v243, 0xffff0000, v167
v_mul_f32 v242, v242, v237
v_mul_f32 v243, v243, v237
v_cvt_pk_bf16_f32 v167, v242, v243
v_log_f32 v243, v226
v_max3_f32 v234, v136, v137, v138
v_max3_f32 v234, v234, v139, v243
v_mov_b32 v243, v234
s_nop 1
v_permlane32_swap_b32 v234, v243
s_nop 1
v_max_f32 v234, v234, v243
v_mov_b32 v243, v234
s_nop 1
v_permlane16_swap_b32 v234, v243
s_nop 1
v_max_f32 v234, v234, v243
v_ceil_f32 v234, v234
v_max_f32 v234, 0, v234
v_sub_f32 v243, 0, v234
v_exp_f32 v238, v243
s_nop 1
v_mul_f32 v226, v226, v238
v_sub_f32 v200, v200, v234
v_sub_f32 v136, v136, v234
v_sub_f32 v152, v152, v234
v_sub_f32 v201, v201, v234
v_sub_f32 v137, v137, v234
v_sub_f32 v153, v153, v234
v_sub_f32 v202, v202, v234
v_sub_f32 v138, v138, v234
v_sub_f32 v154, v154, v234
v_sub_f32 v203, v203, v234
v_sub_f32 v139, v139, v234
v_sub_f32 v155, v155, v234
v_lshlrev_b32 v242, 16, v184
v_and_b32 v243, 0xffff0000, v184
v_mul_f32 v242, v242, v238
v_mul_f32 v243, v243, v238
v_cvt_pk_bf16_f32 v184, v242, v243
v_lshlrev_b32 v242, 16, v185
v_and_b32 v243, 0xffff0000, v185
v_mul_f32 v242, v242, v238
v_mul_f32 v243, v243, v238
v_cvt_pk_bf16_f32 v185, v242, v243
v_lshlrev_b32 v242, 16, v186
v_and_b32 v243, 0xffff0000, v186
v_mul_f32 v242, v242, v238
v_mul_f32 v243, v243, v238
v_cvt_pk_bf16_f32 v186, v242, v243
v_lshlrev_b32 v242, 16, v187
v_and_b32 v243, 0xffff0000, v187
v_mul_f32 v242, v242, v238
v_mul_f32 v243, v243, v238
v_cvt_pk_bf16_f32 v187, v242, v243
v_lshlrev_b32 v242, 16, v168
v_and_b32 v243, 0xffff0000, v168
v_mul_f32 v242, v242, v238
v_mul_f32 v243, v243, v238
v_cvt_pk_bf16_f32 v168, v242, v243
v_lshlrev_b32 v242, 16, v169
v_and_b32 v243, 0xffff0000, v169
v_mul_f32 v242, v242, v238
v_mul_f32 v243, v243, v238
v_cvt_pk_bf16_f32 v169, v242, v243
v_lshlrev_b32 v242, 16, v170
v_and_b32 v243, 0xffff0000, v170
v_mul_f32 v242, v242, v238
v_mul_f32 v243, v243, v238
v_cvt_pk_bf16_f32 v170, v242, v243
v_lshlrev_b32 v242, 16, v171
v_and_b32 v243, 0xffff0000, v171
v_mul_f32 v242, v242, v238
v_mul_f32 v243, v243, v238
v_cvt_pk_bf16_f32 v171, v242, v243
v_log_f32 v243, v227
v_max3_f32 v235, v140, v141, v142
v_max3_f32 v235, v235, v143, v243
v_mov_b32 v243, v235
s_nop 1
v_permlane32_swap_b32 v235, v243
s_nop 1
v_max_f32 v235, v235, v243
v_mov_b32 v243, v235
s_nop 1
v_permlane16_swap_b32 v235, v243
s_nop 1
v_max_f32 v235, v235, v243
v_ceil_f32 v235, v235
v_max_f32 v235, 0, v235
v_sub_f32 v243, 0, v235
v_exp_f32 v239, v243
s_nop 1
v_mul_f32 v227, v227, v239
v_sub_f32 v204, v204, v235
v_sub_f32 v140, v140, v235
v_sub_f32 v156, v156, v235
v_sub_f32 v205, v205, v235
v_sub_f32 v141, v141, v235
v_sub_f32 v157, v157, v235
v_sub_f32 v206, v206, v235
v_sub_f32 v142, v142, v235
v_sub_f32 v158, v158, v235
v_sub_f32 v207, v207, v235
v_sub_f32 v143, v143, v235
v_sub_f32 v159, v159, v235
v_lshlrev_b32 v242, 16, v188
v_and_b32 v243, 0xffff0000, v188
v_mul_f32 v242, v242, v239
v_mul_f32 v243, v243, v239
v_cvt_pk_bf16_f32 v188, v242, v243
v_lshlrev_b32 v242, 16, v189
v_and_b32 v243, 0xffff0000, v189
v_mul_f32 v242, v242, v239
v_mul_f32 v243, v243, v239
v_cvt_pk_bf16_f32 v189, v242, v243
v_lshlrev_b32 v242, 16, v190
v_and_b32 v243, 0xffff0000, v190
v_mul_f32 v242, v242, v239
v_mul_f32 v243, v243, v239
v_cvt_pk_bf16_f32 v190, v242, v243
v_lshlrev_b32 v242, 16, v191
v_and_b32 v243, 0xffff0000, v191
v_mul_f32 v242, v242, v239
v_mul_f32 v243, v243, v239
v_cvt_pk_bf16_f32 v191, v242, v243
v_lshlrev_b32 v242, 16, v172
v_and_b32 v243, 0xffff0000, v172
v_mul_f32 v242, v242, v239
v_mul_f32 v243, v243, v239
v_cvt_pk_bf16_f32 v172, v242, v243
v_lshlrev_b32 v242, 16, v173
v_and_b32 v243, 0xffff0000, v173
v_mul_f32 v242, v242, v239
v_mul_f32 v243, v243, v239
v_cvt_pk_bf16_f32 v173, v242, v243
v_lshlrev_b32 v242, 16, v174
v_and_b32 v243, 0xffff0000, v174
v_mul_f32 v242, v242, v239
v_mul_f32 v243, v243, v239
v_cvt_pk_bf16_f32 v174, v242, v243
v_lshlrev_b32 v242, 16, v175
v_and_b32 v243, 0xffff0000, v175
v_mul_f32 v242, v242, v239
v_mul_f32 v243, v243, v239
v_cvt_pk_bf16_f32 v175, v242, v243
v_exp_f32 v128, v128
v_exp_f32 v129, v129
v_exp_f32 v130, v130
v_exp_f32 v131, v131
s_nop 1
v_add_f32 v228, v224, v128
v_add_f32 v228, v228, v129
v_add_f32 v228, v228, v130
v_add_f32 v228, v228, v131
v_exp_f32 v132, v132
v_exp_f32 v133, v133
v_exp_f32 v134, v134
v_exp_f32 v135, v135
s_nop 1
v_add_f32 v229, v225, v132
v_add_f32 v229, v229, v133
v_add_f32 v229, v229, v134
v_add_f32 v229, v229, v135
v_exp_f32 v136, v136
v_exp_f32 v137, v137
v_exp_f32 v138, v138
v_exp_f32 v139, v139
s_nop 1
v_add_f32 v230, v226, v136
v_add_f32 v230, v230, v137
v_add_f32 v230, v230, v138
v_add_f32 v230, v230, v139
v_exp_f32 v140, v140
v_exp_f32 v141, v141
v_exp_f32 v142, v142
v_exp_f32 v143, v143
s_nop 1
v_add_f32 v231, v227, v140
v_add_f32 v231, v231, v141
v_add_f32 v231, v231, v142
v_add_f32 v231, v231, v143
s_branch L2_rare_common
L2_rare_site3:
s_mov_b32 s36, 3
s_branch L2_rare_1_1
L2_rare_1_1:
s_nop 15
s_nop 15
s_waitcnt lgkmcnt(0)
v_add_u32 v254, 0x0, v240
v_and_b32 v254, 0x1ffff, v254
ds_read_b128 v[232:235], v254 offset:2048
s_waitcnt lgkmcnt(0)
v_mfma_f32_16x16x32_bf16 v[144:147], v[232:235], v[0:3], v[192:195]
v_mfma_f32_16x16x32_bf16 v[148:151], v[232:235], v[32:35], v[196:199]
v_mfma_f32_16x16x32_bf16 v[152:155], v[232:235], v[64:67], v[200:203]
v_mfma_f32_16x16x32_bf16 v[156:159], v[232:235], v[96:99], v[204:207]
s_nop 7
ds_read_b128 v[232:235], v254 offset:2560
s_waitcnt lgkmcnt(0)
v_mfma_f32_16x16x32_bf16 v[144:147], v[232:235], v[4:7], v[144:147]
v_mfma_f32_16x16x32_bf16 v[148:151], v[232:235], v[36:39], v[148:151]
v_mfma_f32_16x16x32_bf16 v[152:155], v[232:235], v[68:71], v[152:155]
v_mfma_f32_16x16x32_bf16 v[156:159], v[232:235], v[100:103], v[156:159]
s_nop 7
ds_read_b128 v[232:235], v254 offset:6144
s_waitcnt lgkmcnt(0)
v_mfma_f32_16x16x32_bf16 v[144:147], v[232:235], v[8:11], v[144:147]
v_mfma_f32_16x16x32_bf16 v[148:151], v[232:235], v[40:43], v[148:151]
v_mfma_f32_16x16x32_bf16 v[152:155], v[232:235], v[72:75], v[152:155]
v_mfma_f32_16x16x32_bf16 v[156:159], v[232:235], v[104:107], v[156:159]
s_nop 7
ds_read_b128 v[232:235], v254 offset:6656
s_waitcnt lgkmcnt(0)
v_mfma_f32_16x16x32_bf16 v[144:147], v[232:235], v[12:15], v[144:147]
v_mfma_f32_16x16x32_bf16 v[148:151], v[232:235], v[44:47], v[148:151]
v_mfma_f32_16x16x32_bf16 v[152:155], v[232:235], v[76:79], v[152:155]
v_mfma_f32_16x16x32_bf16 v[156:159], v[232:235], v[108:111], v[156:159]
s_nop 7
ds_read_b128 v[232:235], v254 offset:10240
s_waitcnt lgkmcnt(0)
v_mfma_f32_16x16x32_bf16 v[144:147], v[232:235], v[16:19], v[144:147]
v_mfma_f32_16x16x32_bf16 v[148:151], v[232:235], v[48:51], v[148:151]
v_mfma_f32_16x16x32_bf16 v[152:155], v[232:235], v[80:83], v[152:155]
v_mfma_f32_16x16x32_bf16 v[156:159], v[232:235], v[112:115], v[156:159]
s_nop 7
ds_read_b128 v[232:235], v254 offset:10752
s_waitcnt lgkmcnt(0)
v_mfma_f32_16x16x32_bf16 v[144:147], v[232:235], v[20:23], v[144:147]
v_mfma_f32_16x16x32_bf16 v[148:151], v[232:235], v[52:55], v[148:151]
v_mfma_f32_16x16x32_bf16 v[152:155], v[232:235], v[84:87], v[152:155]
v_mfma_f32_16x16x32_bf16 v[156:159], v[232:235], v[116:119], v[156:159]
s_nop 7
ds_read_b128 v[232:235], v254 offset:14336
s_waitcnt lgkmcnt(0)
v_mfma_f32_16x16x32_bf16 v[144:147], v[232:235], v[24:27], v[144:147]
v_mfma_f32_16x16x32_bf16 v[148:151], v[232:235], v[56:59], v[148:151]
v_mfma_f32_16x16x32_bf16 v[152:155], v[232:235], v[88:91], v[152:155]
v_mfma_f32_16x16x32_bf16 v[156:159], v[232:235], v[120:123], v[156:159]
s_nop 7
ds_read_b128 v[232:235], v254 offset:14848
s_waitcnt lgkmcnt(0)
v_mfma_f32_16x16x32_bf16 v[144:147], v[232:235], v[28:31], v[144:147]
v_mfma_f32_16x16x32_bf16 v[148:151], v[232:235], v[60:63], v[148:151]
v_mfma_f32_16x16x32_bf16 v[152:155], v[232:235], v[92:95], v[152:155]
v_mfma_f32_16x16x32_bf16 v[156:159], v[232:235], v[124:127], v[156:159]
s_nop 7
s_nop 7
v_log_f32 v243, v228
v_max3_f32 v232, v144, v145, v146
v_max3_f32 v232, v232, v147, v243
v_mov_b32 v243, v232
s_nop 1
v_permlane32_swap_b32 v232, v243
s_nop 1
v_max_f32 v232, v232, v243
v_mov_b32 v243, v232
s_nop 1
v_permlane16_swap_b32 v232, v243
s_nop 1
v_max_f32 v232, v232, v243
v_ceil_f32 v232, v232
v_max_f32 v232, 0, v232
v_sub_f32 v243, 0, v232
v_exp_f32 v236, v243
s_nop 1
v_mul_f32 v228, v228, v236
v_sub_f32 v192, v192, v232
v_sub_f32 v128, v128, v232
v_sub_f32 v144, v144, v232
v_sub_f32 v193, v193, v232
v_sub_f32 v129, v129, v232
v_sub_f32 v145, v145, v232
v_sub_f32 v194, v194, v232
v_sub_f32 v130, v130, v232
v_sub_f32 v146, v146, v232
v_sub_f32 v195, v195, v232
v_sub_f32 v131, v131, v232
v_sub_f32 v147, v147, v232
v_lshlrev_b32 v242, 16, v176
v_and_b32 v243, 0xffff0000, v176
v_mul_f32 v242, v242, v236
v_mul_f32 v243, v243, v236
v_cvt_pk_bf16_f32 v176, v242, v243
v_lshlrev_b32 v242, 16, v177
v_and_b32 v243, 0xffff0000, v177
v_mul_f32 v242, v242, v236
v_mul_f32 v243, v243, v236
v_cvt_pk_bf16_f32 v177, v242, v243
v_lshlrev_b32 v242, 16, v178
v_and_b32 v243, 0xffff0000, v178
v_mul_f32 v242, v242, v236
v_mul_f32 v243, v243, v236
v_cvt_pk_bf16_f32 v178, v242, v243
v_lshlrev_b32 v242, 16, v179
v_and_b32 v243, 0xffff0000, v179
v_mul_f32 v242, v242, v236
v_mul_f32 v243, v243, v236
v_cvt_pk_bf16_f32 v179, v242, v243
v_lshlrev_b32 v242, 16, v160
v_and_b32 v243, 0xffff0000, v160
v_mul_f32 v242, v242, v236
v_mul_f32 v243, v243, v236
v_cvt_pk_bf16_f32 v160, v242, v243
v_lshlrev_b32 v242, 16, v161
v_and_b32 v243, 0xffff0000, v161
v_mul_f32 v242, v242, v236
v_mul_f32 v243, v243, v236
v_cvt_pk_bf16_f32 v161, v242, v243
v_log_f32 v243, v229
v_max3_f32 v233, v148, v149, v150
v_max3_f32 v233, v233, v151, v243
v_mov_b32 v243, v233
s_nop 1
v_permlane32_swap_b32 v233, v243
s_nop 1
v_max_f32 v233, v233, v243
v_mov_b32 v243, v233
s_nop 1
v_permlane16_swap_b32 v233, v243
s_nop 1
v_max_f32 v233, v233, v243
v_ceil_f32 v233, v233
v_max_f32 v233, 0, v233
v_sub_f32 v243, 0, v233
v_exp_f32 v237, v243
s_nop 1
v_mul_f32 v229, v229, v237
v_sub_f32 v196, v196, v233
v_sub_f32 v132, v132, v233
v_sub_f32 v148, v148, v233
v_sub_f32 v197, v197, v233
v_sub_f32 v133, v133, v233
v_sub_f32 v149, v149, v233
v_sub_f32 v198, v198, v233
v_sub_f32 v134, v134, v233
v_sub_f32 v150, v150, v233
v_sub_f32 v199, v199, v233
v_sub_f32 v135, v135, v233
v_sub_f32 v151, v151, v233
v_lshlrev_b32 v242, 16, v180
v_and_b32 v243, 0xffff0000, v180
v_mul_f32 v242, v242, v237
v_mul_f32 v243, v243, v237
v_cvt_pk_bf16_f32 v180, v242, v243
v_lshlrev_b32 v242, 16, v181
v_and_b32 v243, 0xffff0000, v181
v_mul_f32 v242, v242, v237
v_mul_f32 v243, v243, v237
v_cvt_pk_bf16_f32 v181, v242, v243
v_lshlrev_b32 v242, 16, v182
v_and_b32 v243, 0xffff0000, v182
v_mul_f32 v242, v242, v237
v_mul_f32 v243, v243, v237
v_cvt_pk_bf16_f32 v182, v242, v243
v_lshlrev_b32 v242, 16, v183
v_and_b32 v243, 0xffff0000, v183
v_mul_f32 v242, v242, v237
v_mul_f32 v243, v243, v237
v_cvt_pk_bf16_f32 v183, v242, v243
v_lshlrev_b32 v242, 16, v164
v_and_b32 v243, 0xffff0000, v164
v_mul_f32 v242, v242, v237
v_mul_f32 v243, v243, v237
v_cvt_pk_bf16_f32 v164, v242, v243
v_lshlrev_b32 v242, 16, v165
v_and_b32 v243, 0xffff0000, v165
v_mul_f32 v242, v242, v237
v_mul_f32 v243, v243, v237
v_cvt_pk_bf16_f32 v165, v242, v243
v_log_f32 v243, v230
v_max3_f32 v234, v152, v153, v154
v_max3_f32 v234, v234, v155, v243
v_mov_b32 v243, v234
s_nop 1
v_permlane32_swap_b32 v234, v243
s_nop 1
v_max_f32 v234, v234, v243
v_mov_b32 v243, v234
s_nop 1
v_permlane16_swap_b32 v234, v243
s_nop 1
v_max_f32 v234, v234, v243
v_ceil_f32 v234, v234
v_max_f32 v234, 0, v234
v_sub_f32 v243, 0, v234
v_exp_f32 v238, v243
s_nop 1
v_mul_f32 v230, v230, v238
v_sub_f32 v200, v200, v234
v_sub_f32 v136, v136, v234
v_sub_f32 v152, v152, v234
v_sub_f32 v201, v201, v234
v_sub_f32 v137, v137, v234
v_sub_f32 v153, v153, v234
v_sub_f32 v202, v202, v234
v_sub_f32 v138, v138, v234
v_sub_f32 v154, v154, v234
v_sub_f32 v203, v203, v234
v_sub_f32 v139, v139, v234
v_sub_f32 v155, v155, v234
v_lshlrev_b32 v242, 16, v184
v_and_b32 v243, 0xffff0000, v184
v_mul_f32 v242, v242, v238
v_mul_f32 v243, v243, v238
v_cvt_pk_bf16_f32 v184, v242, v243
v_lshlrev_b32 v242, 16, v185
v_and_b32 v243, 0xffff0000, v185
v_mul_f32 v242, v242, v238
v_mul_f32 v243, v243, v238
v_cvt_pk_bf16_f32 v185, v242, v243
v_lshlrev_b32 v242, 16, v186
v_and_b32 v243, 0xffff0000, v186
v_mul_f32 v242, v242, v238
v_mul_f32 v243, v243, v238
v_cvt_pk_bf16_f32 v186, v242, v243
v_lshlrev_b32 v242, 16, v187
v_and_b32 v243, 0xffff0000, v187
v_mul_f32 v242, v242, v238
v_mul_f32 v243, v243, v238
v_cvt_pk_bf16_f32 v187, v242, v243
v_lshlrev_b32 v242, 16, v168
v_and_b32 v243, 0xffff0000, v168
v_mul_f32 v242, v242, v238
v_mul_f32 v243, v243, v238
v_cvt_pk_bf16_f32 v168, v242, v243
v_lshlrev_b32 v242, 16, v169
v_and_b32 v243, 0xffff0000, v169
v_mul_f32 v242, v242, v238
v_mul_f32 v243, v243, v238
v_cvt_pk_bf16_f32 v169, v242, v243
v_log_f32 v243, v231
v_max3_f32 v235, v156, v157, v158
v_max3_f32 v235, v235, v159, v243
v_mov_b32 v243, v235
s_nop 1
v_permlane32_swap_b32 v235, v243
s_nop 1
v_max_f32 v235, v235, v243
v_mov_b32 v243, v235
s_nop 1
v_permlane16_swap_b32 v235, v243
s_nop 1
v_max_f32 v235, v235, v243
v_ceil_f32 v235, v235
v_max_f32 v235, 0, v235
v_sub_f32 v243, 0, v235
v_exp_f32 v239, v243
s_nop 1
v_mul_f32 v231, v231, v239
v_sub_f32 v204, v204, v235
v_sub_f32 v140, v140, v235
v_sub_f32 v156, v156, v235
v_sub_f32 v205, v205, v235
v_sub_f32 v141, v141, v235
v_sub_f32 v157, v157, v235
v_sub_f32 v206, v206, v235
v_sub_f32 v142, v142, v235
v_sub_f32 v158, v158, v235
v_sub_f32 v207, v207, v235
v_sub_f32 v143, v143, v235
v_sub_f32 v159, v159, v235
v_lshlrev_b32 v242, 16, v188
v_and_b32 v243, 0xffff0000, v188
v_mul_f32 v242, v242, v239
v_mul_f32 v243, v243, v239
v_cvt_pk_bf16_f32 v188, v242, v243
v_lshlrev_b32 v242, 16, v189
v_and_b32 v243, 0xffff0000, v189
v_mul_f32 v242, v242, v239
v_mul_f32 v243, v243, v239
v_cvt_pk_bf16_f32 v189, v242, v243
v_lshlrev_b32 v242, 16, v190
v_and_b32 v243, 0xffff0000, v190
v_mul_f32 v242, v242, v239
v_mul_f32 v243, v243, v239
v_cvt_pk_bf16_f32 v190, v242, v243
v_lshlrev_b32 v242, 16, v191
v_and_b32 v243, 0xffff0000, v191
v_mul_f32 v242, v242, v239
v_mul_f32 v243, v243, v239
v_cvt_pk_bf16_f32 v191, v242, v243
v_lshlrev_b32 v242, 16, v172
v_and_b32 v243, 0xffff0000, v172
v_mul_f32 v242, v242, v239
v_mul_f32 v243, v243, v239
v_cvt_pk_bf16_f32 v172, v242, v243
v_lshlrev_b32 v242, 16, v173
v_and_b32 v243, 0xffff0000, v173
v_mul_f32 v242, v242, v239
v_mul_f32 v243, v243, v239
v_cvt_pk_bf16_f32 v173, v242, v243
v_exp_f32 v144, v144
v_exp_f32 v145, v145
v_exp_f32 v146, v146
v_exp_f32 v147, v147
s_nop 1
v_add_f32 v224, v228, v144
v_add_f32 v224, v224, v145
v_add_f32 v224, v224, v146
v_add_f32 v224, v224, v147
v_exp_f32 v148, v148
v_exp_f32 v149, v149
v_exp_f32 v150, v150
v_exp_f32 v151, v151
s_nop 1
v_add_f32 v225, v229, v148
v_add_f32 v225, v225, v149
v_add_f32 v225, v225, v150
v_add_f32 v225, v225, v151
v_exp_f32 v152, v152
v_exp_f32 v153, v153
v_exp_f32 v154, v154
v_exp_f32 v155, v155
s_nop 1
v_add_f32 v226, v230, v152
v_add_f32 v226, v226, v153
v_add_f32 v226, v226, v154
v_add_f32 v226, v226, v155
v_exp_f32 v156, v156
v_exp_f32 v157, v157
v_exp_f32 v158, v158
v_exp_f32 v159, v159
s_nop 1
v_add_f32 v227, v231, v156
v_add_f32 v227, v227, v157
v_add_f32 v227, v227, v158
v_add_f32 v227, v227, v159
s_branch L2_rare_common
L2_rare_site6:
s_mov_b32 s36, 6
s_branch L2_rare_t1_0_0
L2_rare_t1_0_0:
s_nop 15
s_nop 15
s_waitcnt lgkmcnt(0)
v_log_f32 v243, v224
v_max3_f32 v232, v128, v129, v130
v_max3_f32 v232, v232, v131, v243
v_mov_b32 v243, v232
s_nop 1
v_permlane32_swap_b32 v232, v243
s_nop 1
v_max_f32 v232, v232, v243
v_mov_b32 v243, v232
s_nop 1
v_permlane16_swap_b32 v232, v243
s_nop 1
v_max_f32 v232, v232, v243
v_ceil_f32 v232, v232
v_max_f32 v232, 0, v232
v_sub_f32 v243, 0, v232
v_exp_f32 v236, v243
s_nop 1
v_mul_f32 v224, v224, v236
v_sub_f32 v192, v192, v232
v_sub_f32 v128, v128, v232
v_sub_f32 v144, v144, v232
v_sub_f32 v193, v193, v232
v_sub_f32 v129, v129, v232
v_sub_f32 v145, v145, v232
v_sub_f32 v194, v194, v232
v_sub_f32 v130, v130, v232
v_sub_f32 v146, v146, v232
v_sub_f32 v195, v195, v232
v_sub_f32 v131, v131, v232
v_sub_f32 v147, v147, v232
v_lshlrev_b32 v242, 16, v160
v_and_b32 v243, 0xffff0000, v160
v_mul_f32 v242, v242, v236
v_mul_f32 v243, v243, v236
v_cvt_pk_bf16_f32 v160, v242, v243
v_lshlrev_b32 v242, 16, v161
v_and_b32 v243, 0xffff0000, v161
v_mul_f32 v242, v242, v236
v_mul_f32 v243, v243, v236
v_cvt_pk_bf16_f32 v161, v242, v243
v_lshlrev_b32 v242, 16, v162
v_and_b32 v243, 0xffff0000, v162
v_mul_f32 v242, v242, v236
v_mul_f32 v243, v243, v236
v_cvt_pk_bf16_f32 v162, v242, v243
v_lshlrev_b32 v242, 16, v163
v_and_b32 v243, 0xffff0000, v163
v_mul_f32 v242, v242, v236
v_mul_f32 v243, v243, v236
v_cvt_pk_bf16_f32 v163, v242, v243
ds_read_b64 v[254:255], v253 offset:0
s_waitcnt lgkmcnt(0)
v_lshlrev_b32 v242, 16, v254
v_and_b32 v243, 0xffff0000, v254
v_mul_f32 v242, v242, v236
v_mul_f32 v243, v243, v236
v_cvt_pk_bf16_f32 v254, v242, v243
v_lshlrev_b32 v242, 16, v255
v_and_b32 v243, 0xffff0000, v255
v_mul_f32 v242, v242, v236
v_mul_f32 v243, v243, v236
v_cvt_pk_bf16_f32 v255, v242, v243
ds_write_b64 v253, v[254:255] offset:0
s_waitcnt lgkmcnt(0)
ds_read_b64 v[254:255], v253 offset:8
s_waitcnt lgkmcnt(0)
v_lshlrev_b32 v242, 16, v254
v_and_b32 v243, 0xffff0000, v254
v_mul_f32 v242, v242, v236
v_mul_f32 v243, v243, v236
v_cvt_pk_bf16_f32 v254, v242, v243
v_lshlrev_b32 v242, 16, v255
v_and_b32 v243, 0xffff0000, v255
v_mul_f32 v242, v242, v236
v_mul_f32 v243, v243, v236
v_cvt_pk_bf16_f32 v255, v242, v243
ds_write_b64 v253, v[254:255] offset:8
s_waitcnt lgkmcnt(0)
v_log_f32 v243, v225
v_max3_f32 v233, v132, v133, v134
v_max3_f32 v233, v233, v135, v243
v_mov_b32 v243, v233
s_nop 1
v_permlane32_swap_b32 v233, v243
s_nop 1
v_max_f32 v233, v233, v243
v_mov_b32 v243, v233
s_nop 1
v_permlane16_swap_b32 v233, v243
s_nop 1
v_max_f32 v233, v233, v243
v_ceil_f32 v233, v233
v_max_f32 v233, 0, v233
v_sub_f32 v243, 0, v233
v_exp_f32 v237, v243
s_nop 1
v_mul_f32 v225, v225, v237
v_sub_f32 v196, v196, v233
v_sub_f32 v132, v132, v233
v_sub_f32 v148, v148, v233
v_sub_f32 v197, v197, v233
v_sub_f32 v133, v133, v233
v_sub_f32 v149, v149, v233
v_sub_f32 v198, v198, v233
v_sub_f32 v134, v134, v233
v_sub_f32 v150, v150, v233
v_sub_f32 v199, v199, v233
v_sub_f32 v135, v135, v233
v_sub_f32 v151, v151, v233
v_lshlrev_b32 v242, 16, v164
v_and_b32 v243, 0xffff0000, v164
v_mul_f32 v242, v242, v237
v_mul_f32 v243, v243, v237
v_cvt_pk_bf16_f32 v164, v242, v243
v_lshlrev_b32 v242, 16, v165
v_and_b32 v243, 0xffff0000, v165
v_mul_f32 v242, v242, v237
v_mul_f32 v243, v243, v237
v_cvt_pk_bf16_f32 v165, v242, v243
v_lshlrev_b32 v242, 16, v166
v_and_b32 v243, 0xffff0000, v166
v_mul_f32 v242, v242, v237
v_mul_f32 v243, v243, v237
v_cvt_pk_bf16_f32 v166, v242, v243
v_lshlrev_b32 v242, 16, v167
v_and_b32 v243, 0xffff0000, v167
v_mul_f32 v242, v242, v237
v_mul_f32 v243, v243, v237
v_cvt_pk_bf16_f32 v167, v242, v243
ds_read_b64 v[254:255], v253 offset:1024
s_waitcnt lgkmcnt(0)
v_lshlrev_b32 v242, 16, v254
v_and_b32 v243, 0xffff0000, v254
v_mul_f32 v242, v242, v237
v_mul_f32 v243, v243, v237
v_cvt_pk_bf16_f32 v254, v242, v243
v_lshlrev_b32 v242, 16, v255
v_and_b32 v243, 0xffff0000, v255
v_mul_f32 v242, v242, v237
v_mul_f32 v243, v243, v237
v_cvt_pk_bf16_f32 v255, v242, v243
ds_write_b64 v253, v[254:255] offset:1024
s_waitcnt lgkmcnt(0)
ds_read_b64 v[254:255], v253 offset:1032
s_waitcnt lgkmcnt(0)
v_lshlrev_b32 v242, 16, v254
v_and_b32 v243, 0xffff0000, v254
v_mul_f32 v242, v242, v237
v_mul_f32 v243, v243, v237
v_cvt_pk_bf16_f32 v254, v242, v243
v_lshlrev_b32 v242, 16, v255
v_and_b32 v243, 0xffff0000, v255
v_mul_f32 v242, v242, v237
v_mul_f32 v243, v243, v237
v_cvt_pk_bf16_f32 v255, v242, v243
ds_write_b64 v253, v[254:255] offset:1032
s_waitcnt lgkmcnt(0)
v_log_f32 v243, v226
v_max3_f32 v234, v136, v137, v138
v_max3_f32 v234, v234, v139, v243
v_mov_b32 v243, v234
s_nop 1
v_permlane32_swap_b32 v234, v243
s_nop 1
v_max_f32 v234, v234, v243
v_mov_b32 v243, v234
s_nop 1
v_permlane16_swap_b32 v234, v243
s_nop 1
v_max_f32 v234, v234, v243
v_ceil_f32 v234, v234
v_max_f32 v234, 0, v234
v_sub_f32 v243, 0, v234
v_exp_f32 v238, v243
s_nop 1
v_mul_f32 v226, v226, v238
v_sub_f32 v200, v200, v234
v_sub_f32 v136, v136, v234
v_sub_f32 v152, v152, v234
v_sub_f32 v201, v201, v234
v_sub_f32 v137, v137, v234
v_sub_f32 v153, v153, v234
v_sub_f32 v202, v202, v234
v_sub_f32 v138, v138, v234
v_sub_f32 v154, v154, v234
v_sub_f32 v203, v203, v234
v_sub_f32 v139, v139, v234
v_sub_f32 v155, v155, v234
v_lshlrev_b32 v242, 16, v168
v_and_b32 v243, 0xffff0000, v168
v_mul_f32 v242, v242, v238
v_mul_f32 v243, v243, v238
v_cvt_pk_bf16_f32 v168, v242, v243
v_lshlrev_b32 v242, 16, v169
v_and_b32 v243, 0xffff0000, v169
v_mul_f32 v242, v242, v238
v_mul_f32 v243, v243, v238
v_cvt_pk_bf16_f32 v169, v242, v243
v_lshlrev_b32 v242, 16, v170
v_and_b32 v243, 0xffff0000, v170
v_mul_f32 v242, v242, v238
v_mul_f32 v243, v243, v238
v_cvt_pk_bf16_f32 v170, v242, v243
v_lshlrev_b32 v242, 16, v171
v_and_b32 v243, 0xffff0000, v171
v_mul_f32 v242, v242, v238
v_mul_f32 v243, v243, v238
v_cvt_pk_bf16_f32 v171, v242, v243
ds_read_b64 v[254:255], v253 offset:2048
s_waitcnt lgkmcnt(0)
v_lshlrev_b32 v242, 16, v254
v_and_b32 v243, 0xffff0000, v254
v_mul_f32 v242, v242, v238
v_mul_f32 v243, v243, v238
v_cvt_pk_bf16_f32 v254, v242, v243
v_lshlrev_b32 v242, 16, v255
v_and_b32 v243, 0xffff0000, v255
v_mul_f32 v242, v242, v238
v_mul_f32 v243, v243, v238
v_cvt_pk_bf16_f32 v255, v242, v243
ds_write_b64 v253, v[254:255] offset:2048
s_waitcnt lgkmcnt(0)
ds_read_b64 v[254:255], v253 offset:2056
s_waitcnt lgkmcnt(0)
v_lshlrev_b32 v242, 16, v254
v_and_b32 v243, 0xffff0000, v254
v_mul_f32 v242, v242, v238
v_mul_f32 v243, v243, v238
v_cvt_pk_bf16_f32 v254, v242, v243
v_lshlrev_b32 v242, 16, v255
v_and_b32 v243, 0xffff0000, v255
v_mul_f32 v242, v242, v238
v_mul_f32 v243, v243, v238
v_cvt_pk_bf16_f32 v255, v242, v243
ds_write_b64 v253, v[254:255] offset:2056
s_waitcnt lgkmcnt(0)
v_log_f32 v243, v227
v_max3_f32 v235, v140, v141, v142
v_max3_f32 v235, v235, v143, v243
v_mov_b32 v243, v235
s_nop 1
v_permlane32_swap_b32 v235, v243
s_nop 1
v_max_f32 v235, v235, v243
v_mov_b32 v243, v235
s_nop 1
v_permlane16_swap_b32 v235, v243
s_nop 1
v_max_f32 v235, v235, v243
v_ceil_f32 v235, v235
v_max_f32 v235, 0, v235
v_sub_f32 v243, 0, v235
v_exp_f32 v239, v243
s_nop 1
v_mul_f32 v227, v227, v239
v_sub_f32 v204, v204, v235
v_sub_f32 v140, v140, v235
v_sub_f32 v156, v156, v235
v_sub_f32 v205, v205, v235
v_sub_f32 v141, v141, v235
v_sub_f32 v157, v157, v235
v_sub_f32 v206, v206, v235
v_sub_f32 v142, v142, v235
v_sub_f32 v158, v158, v235
v_sub_f32 v207, v207, v235
v_sub_f32 v143, v143, v235
v_sub_f32 v159, v159, v235
v_lshlrev_b32 v242, 16, v172
v_and_b32 v243, 0xffff0000, v172
v_mul_f32 v242, v242, v239
v_mul_f32 v243, v243, v239
v_cvt_pk_bf16_f32 v172, v242, v243
v_lshlrev_b32 v242, 16, v173
v_and_b32 v243, 0xffff0000, v173
v_mul_f32 v242, v242, v239
v_mul_f32 v243, v243, v239
v_cvt_pk_bf16_f32 v173, v242, v243
v_lshlrev_b32 v242, 16, v174
v_and_b32 v243, 0xffff0000, v174
v_mul_f32 v242, v242, v239
v_mul_f32 v243, v243, v239
v_cvt_pk_bf16_f32 v174, v242, v243
v_lshlrev_b32 v242, 16, v175
v_and_b32 v243, 0xffff0000, v175
v_mul_f32 v242, v242, v239
v_mul_f32 v243, v243, v239
v_cvt_pk_bf16_f32 v175, v242, v243
ds_read_b64 v[254:255], v253 offset:3072
s_waitcnt lgkmcnt(0)
v_lshlrev_b32 v242, 16, v254
v_and_b32 v243, 0xffff0000, v254
v_mul_f32 v242, v242, v239
v_mul_f32 v243, v243, v239
v_cvt_pk_bf16_f32 v254, v242, v243
v_lshlrev_b32 v242, 16, v255
v_and_b32 v243, 0xffff0000, v255
v_mul_f32 v242, v242, v239
v_mul_f32 v243, v243, v239
v_cvt_pk_bf16_f32 v255, v242, v243
ds_write_b64 v253, v[254:255] offset:3072
s_waitcnt lgkmcnt(0)
ds_read_b64 v[254:255], v253 offset:3080
s_waitcnt lgkmcnt(0)
v_lshlrev_b32 v242, 16, v254
v_and_b32 v243, 0xffff0000, v254
v_mul_f32 v242, v242, v239
v_mul_f32 v243, v243, v239
v_cvt_pk_bf16_f32 v254, v242, v243
v_lshlrev_b32 v242, 16, v255
v_and_b32 v243, 0xffff0000, v255
v_mul_f32 v242, v242, v239
v_mul_f32 v243, v243, v239
v_cvt_pk_bf16_f32 v255, v242, v243
ds_write_b64 v253, v[254:255] offset:3080
s_waitcnt lgkmcnt(0)
v_exp_f32 v232, v128
v_exp_f32 v233, v129
v_exp_f32 v234, v130
v_exp_f32 v235, v131
s_nop 1
v_add_f32 v228, v224, v232
v_add_f32 v228, v228, v233
v_add_f32 v228, v228, v234
v_add_f32 v228, v228, v235
v_cvt_pk_bf16_f32 v176, v232, v233
v_cvt_pk_bf16_f32 v177, v234, v235
v_exp_f32 v232, v132
v_exp_f32 v233, v133
v_exp_f32 v234, v134
v_exp_f32 v235, v135
s_nop 1
v_add_f32 v229, v225, v232
v_add_f32 v229, v229, v233
v_add_f32 v229, v229, v234
v_add_f32 v229, v229, v235
v_cvt_pk_bf16_f32 v180, v232, v233
v_cvt_pk_bf16_f32 v181, v234, v235
v_exp_f32 v232, v136
v_exp_f32 v233, v137
v_exp_f32 v234, v138
v_exp_f32 v235, v139
s_nop 1
v_add_f32 v230, v226, v232
v_add_f32 v230, v230, v233
v_add_f32 v230, v230, v234
v_add_f32 v230, v230, v235
v_cvt_pk_bf16_f32 v184, v232, v233
v_cvt_pk_bf16_f32 v185, v234, v235
v_exp_f32 v232, v140
v_exp_f32 v233, v141
v_exp_f32 v234, v142
v_exp_f32 v235, v143
s_nop 1
v_add_f32 v231, v227, v232
v_add_f32 v231, v231, v233
v_add_f32 v231, v231, v234
v_add_f32 v231, v231, v235
v_cvt_pk_bf16_f32 v188, v232, v233
v_cvt_pk_bf16_f32 v189, v234, v235
s_branch L2_rare_common
L2_rare_site7:
s_mov_b32 s36, 7
s_branch L2_rare_t1_1_1
L2_rare_t1_1_1:
s_nop 15
s_nop 15
s_waitcnt lgkmcnt(0)
v_log_f32 v243, v228
v_max3_f32 v232, v144, v145, v146
v_max3_f32 v232, v232, v147, v243
v_mov_b32 v243, v232
s_nop 1
v_permlane32_swap_b32 v232, v243
s_nop 1
v_max_f32 v232, v232, v243
v_mov_b32 v243, v232
s_nop 1
v_permlane16_swap_b32 v232, v243
s_nop 1
v_max_f32 v232, v232, v243
v_ceil_f32 v232, v232
v_max_f32 v232, 0, v232
v_sub_f32 v243, 0, v232
v_exp_f32 v236, v243
s_nop 1
v_mul_f32 v228, v228, v236
v_sub_f32 v192, v192, v232
v_sub_f32 v128, v128, v232
v_sub_f32 v144, v144, v232
v_sub_f32 v193, v193, v232
v_sub_f32 v129, v129, v232
v_sub_f32 v145, v145, v232
v_sub_f32 v194, v194, v232
v_sub_f32 v130, v130, v232
v_sub_f32 v146, v146, v232
v_sub_f32 v195, v195, v232
v_sub_f32 v131, v131, v232
v_sub_f32 v147, v147, v232
v_lshlrev_b32 v242, 16, v176
v_and_b32 v243, 0xffff0000, v176
v_mul_f32 v242, v242, v236
v_mul_f32 v243, v243, v236
v_cvt_pk_bf16_f32 v176, v242, v243
v_lshlrev_b32 v242, 16, v177
v_and_b32 v243, 0xffff0000, v177
v_mul_f32 v242, v242, v236
v_mul_f32 v243, v243, v236
v_cvt_pk_bf16_f32 v177, v242, v243
ds_read_b64 v[254:255], v253 offset:0
s_waitcnt lgkmcnt(0)
v_lshlrev_b32 v242, 16, v254
v_and_b32 v243, 0xffff0000, v254
v_mul_f32 v242, v242, v236
v_mul_f32 v243, v243, v236
v_cvt_pk_bf16_f32 v254, v242, v243
v_lshlrev_b32 v242, 16, v255
v_and_b32 v243, 0xffff0000, v255
v_mul_f32 v242, v242, v236
v_mul_f32 v243, v243, v236
v_cvt_pk_bf16_f32 v255, v242, v243
ds_write_b64 v253, v[254:255] offset:0
s_waitcnt lgkmcnt(0)
ds_read_b64 v[254:255], v253 offset:8
s_waitcnt lgkmcnt(0)
v_lshlrev_b32 v242, 16, v254
v_and_b32 v243, 0xffff0000, v254
v_mul_f32 v242, v242, v236
v_mul_f32 v243, v243, v236
v_cvt_pk_bf16_f32 v254, v242, v243
v_lshlrev_b32 v242, 16, v255
v_and_b32 v243, 0xffff0000, v255
v_mul_f32 v242, v242, v236
v_mul_f32 v243, v243, v236
v_cvt_pk_bf16_f32 v255, v242, v243
ds_write_b64 v253, v[254:255] offset:8
s_waitcnt lgkmcnt(0)
ds_read_b64 v[254:255], v253 offset:4096
s_waitcnt lgkmcnt(0)
v_lshlrev_b32 v242, 16, v254
v_and_b32 v243, 0xffff0000, v254
v_mul_f32 v242, v242, v236
v_mul_f32 v243, v243, v236
v_cvt_pk_bf16_f32 v254, v242, v243
v_lshlrev_b32 v242, 16, v255
v_and_b32 v243, 0xffff0000, v255
v_mul_f32 v242, v242, v236
v_mul_f32 v243, v243, v236
v_cvt_pk_bf16_f32 v255, v242, v243
ds_write_b64 v253, v[254:255] offset:4096
s_waitcnt lgkmcnt(0)
ds_read_b64 v[254:255], v253 offset:4104
s_waitcnt lgkmcnt(0)
v_lshlrev_b32 v242, 16, v254
v_and_b32 v243, 0xffff0000, v254
v_mul_f32 v242, v242, v236
v_mul_f32 v243, v243, v236
v_cvt_pk_bf16_f32 v254, v242, v243
v_lshlrev_b32 v242, 16, v255
v_and_b32 v243, 0xffff0000, v255
v_mul_f32 v242, v242, v236
v_mul_f32 v243, v243, v236
v_cvt_pk_bf16_f32 v255, v242, v243
ds_write_b64 v253, v[254:255] offset:4104
s_waitcnt lgkmcnt(0)
v_log_f32 v243, v229
v_max3_f32 v233, v148, v149, v150
v_max3_f32 v233, v233, v151, v243
v_mov_b32 v243, v233
s_nop 1
v_permlane32_swap_b32 v233, v243
s_nop 1
v_max_f32 v233, v233, v243
v_mov_b32 v243, v233
s_nop 1
v_permlane16_swap_b32 v233, v243
s_nop 1
v_max_f32 v233, v233, v243
v_ceil_f32 v233, v233
v_max_f32 v233, 0, v233
v_sub_f32 v243, 0, v233
v_exp_f32 v237, v243
s_nop 1
v_mul_f32 v229, v229, v237
v_sub_f32 v196, v196, v233
v_sub_f32 v132, v132, v233
v_sub_f32 v148, v148, v233
v_sub_f32 v197, v197, v233
v_sub_f32 v133, v133, v233
v_sub_f32 v149, v149, v233
v_sub_f32 v198, v198, v233
v_sub_f32 v134, v134, v233
v_sub_f32 v150, v150, v233
v_sub_f32 v199, v199, v233
v_sub_f32 v135, v135, v233
v_sub_f32 v151, v151, v233
v_lshlrev_b32 v242, 16, v180
v_and_b32 v243, 0xffff0000, v180
v_mul_f32 v242, v242, v237
v_mul_f32 v243, v243, v237
v_cvt_pk_bf16_f32 v180, v242, v243
v_lshlrev_b32 v242, 16, v181
v_and_b32 v243, 0xffff0000, v181
v_mul_f32 v242, v242, v237
v_mul_f32 v243, v243, v237
v_cvt_pk_bf16_f32 v181, v242, v243
ds_read_b64 v[254:255], v253 offset:1024
s_waitcnt lgkmcnt(0)
v_lshlrev_b32 v242, 16, v254
v_and_b32 v243, 0xffff0000, v254
v_mul_f32 v242, v242, v237
v_mul_f32 v243, v243, v237
v_cvt_pk_bf16_f32 v254, v242, v243
v_lshlrev_b32 v242, 16, v255
v_and_b32 v243, 0xffff0000, v255
v_mul_f32 v242, v242, v237
v_mul_f32 v243, v243, v237
v_cvt_pk_bf16_f32 v255, v242, v243
ds_write_b64 v253, v[254:255] offset:1024
s_waitcnt lgkmcnt(0)
ds_read_b64 v[254:255], v253 offset:1032
s_waitcnt lgkmcnt(0)
v_lshlrev_b32 v242, 16, v254
v_and_b32 v243, 0xffff0000, v254
v_mul_f32 v242, v242, v237
v_mul_f32 v243, v243, v237
v_cvt_pk_bf16_f32 v254, v242, v243
v_lshlrev_b32 v242, 16, v255
v_and_b32 v243, 0xffff0000, v255
v_mul_f32 v242, v242, v237
v_mul_f32 v243, v243, v237
v_cvt_pk_bf16_f32 v255, v242, v243
ds_write_b64 v253, v[254:255] offset:1032
s_waitcnt lgkmcnt(0)
ds_read_b64 v[254:255], v253 offset:5120
s_waitcnt lgkmcnt(0)
v_lshlrev_b32 v242, 16, v254
v_and_b32 v243, 0xffff0000, v254
v_mul_f32 v242, v242, v237
v_mul_f32 v243, v243, v237
v_cvt_pk_bf16_f32 v254, v242, v243
v_lshlrev_b32 v242, 16, v255
v_and_b32 v243, 0xffff0000, v255
v_mul_f32 v242, v242, v237
v_mul_f32 v243, v243, v237
v_cvt_pk_bf16_f32 v255, v242, v243
ds_write_b64 v253, v[254:255] offset:5120
s_waitcnt lgkmcnt(0)
ds_read_b64 v[254:255], v253 offset:5128
s_waitcnt lgkmcnt(0)
v_lshlrev_b32 v242, 16, v254
v_and_b32 v243, 0xffff0000, v254
v_mul_f32 v242, v242, v237
v_mul_f32 v243, v243, v237
v_cvt_pk_bf16_f32 v254, v242, v243
v_lshlrev_b32 v242, 16, v255
v_and_b32 v243, 0xffff0000, v255
v_mul_f32 v242, v242, v237
v_mul_f32 v243, v243, v237
v_cvt_pk_bf16_f32 v255, v242, v243
ds_write_b64 v253, v[254:255] offset:5128
s_waitcnt lgkmcnt(0)
v_log_f32 v243, v230
v_max3_f32 v234, v152, v153, v154
v_max3_f32 v234, v234, v155, v243
v_mov_b32 v243, v234
s_nop 1
v_permlane32_swap_b32 v234, v243
s_nop 1
v_max_f32 v234, v234, v243
v_mov_b32 v243, v234
s_nop 1
v_permlane16_swap_b32 v234, v243
s_nop 1
v_max_f32 v234, v234, v243
v_ceil_f32 v234, v234
v_max_f32 v234, 0, v234
v_sub_f32 v243, 0, v234
v_exp_f32 v238, v243
s_nop 1
v_mul_f32 v230, v230, v238
v_sub_f32 v200, v200, v234
v_sub_f32 v136, v136, v234
v_sub_f32 v152, v152, v234
v_sub_f32 v201, v201, v234
v_sub_f32 v137, v137, v234
v_sub_f32 v153, v153, v234
v_sub_f32 v202, v202, v234
v_sub_f32 v138, v138, v234
v_sub_f32 v154, v154, v234
v_sub_f32 v203, v203, v234
v_sub_f32 v139, v139, v234
v_sub_f32 v155, v155, v234
v_lshlrev_b32 v242, 16, v184
v_and_b32 v243, 0xffff0000, v184
v_mul_f32 v242, v242, v238
v_mul_f32 v243, v243, v238
v_cvt_pk_bf16_f32 v184, v242, v243
v_lshlrev_b32 v242, 16, v185
v_and_b32 v243, 0xffff0000, v185
v_mul_f32 v242, v242, v238
v_mul_f32 v243, v243, v238
v_cvt_pk_bf16_f32 v185, v242, v243
ds_read_b64 v[254:255], v253 offset:2048
s_waitcnt lgkmcnt(0)
v_lshlrev_b32 v242, 16, v254
v_and_b32 v243, 0xffff0000, v254
v_mul_f32 v242, v242, v238
v_mul_f32 v243, v243, v238
v_cvt_pk_bf16_f32 v254, v242, v243
v_lshlrev_b32 v242, 16, v255
v_and_b32 v243, 0xffff0000, v255
v_mul_f32 v242, v242, v238
v_mul_f32 v243, v243, v238
v_cvt_pk_bf16_f32 v255, v242, v243
ds_write_b64 v253, v[254:255] offset:2048
s_waitcnt lgkmcnt(0)
ds_read_b64 v[254:255], v253 offset:2056
s_waitcnt lgkmcnt(0)
v_lshlrev_b32 v242, 16, v254
v_and_b32 v243, 0xffff0000, v254
v_mul_f32 v242, v242, v238
v_mul_f32 v243, v243, v238
v_cvt_pk_bf16_f32 v254, v242, v243
v_lshlrev_b32 v242, 16, v255
v_and_b32 v243, 0xffff0000, v255
v_mul_f32 v242, v242, v238
v_mul_f32 v243, v243, v238
v_cvt_pk_bf16_f32 v255, v242, v243
ds_write_b64 v253, v[254:255] offset:2056
s_waitcnt lgkmcnt(0)
ds_read_b64 v[254:255], v253 offset:6144
s_waitcnt lgkmcnt(0)
v_lshlrev_b32 v242, 16, v254
v_and_b32 v243, 0xffff0000, v254
v_mul_f32 v242, v242, v238
v_mul_f32 v243, v243, v238
v_cvt_pk_bf16_f32 v254, v242, v243
v_lshlrev_b32 v242, 16, v255
v_and_b32 v243, 0xffff0000, v255
v_mul_f32 v242, v242, v238
v_mul_f32 v243, v243, v238
v_cvt_pk_bf16_f32 v255, v242, v243
ds_write_b64 v253, v[254:255] offset:6144
s_waitcnt lgkmcnt(0)
ds_read_b64 v[254:255], v253 offset:6152
s_waitcnt lgkmcnt(0)
v_lshlrev_b32 v242, 16, v254
v_and_b32 v243, 0xffff0000, v254
v_mul_f32 v242, v242, v238
v_mul_f32 v243, v243, v238
v_cvt_pk_bf16_f32 v254, v242, v243
v_lshlrev_b32 v242, 16, v255
v_and_b32 v243, 0xffff0000, v255
v_mul_f32 v242, v242, v238
v_mul_f32 v243, v243, v238
v_cvt_pk_bf16_f32 v255, v242, v243
ds_write_b64 v253, v[254:255] offset:6152
s_waitcnt lgkmcnt(0)
v_log_f32 v243, v231
v_max3_f32 v235, v156, v157, v158
v_max3_f32 v235, v235, v159, v243
v_mov_b32 v243, v235
s_nop 1
v_permlane32_swap_b32 v235, v243
s_nop 1
v_max_f32 v235, v235, v243
v_mov_b32 v243, v235
s_nop 1
v_permlane16_swap_b32 v235, v243
s_nop 1
v_max_f32 v235, v235, v243
v_ceil_f32 v235, v235
v_max_f32 v235, 0, v235
v_sub_f32 v243, 0, v235
v_exp_f32 v239, v243
s_nop 1
v_mul_f32 v231, v231, v239
v_sub_f32 v204, v204, v235
v_sub_f32 v140, v140, v235
v_sub_f32 v156, v156, v235
v_sub_f32 v205, v205, v235
v_sub_f32 v141, v141, v235
v_sub_f32 v157, v157, v235
v_sub_f32 v206, v206, v235
v_sub_f32 v142, v142, v235
v_sub_f32 v158, v158, v235
v_sub_f32 v207, v207, v235
v_sub_f32 v143, v143, v235
v_sub_f32 v159, v159, v235
v_lshlrev_b32 v242, 16, v188
v_and_b32 v243, 0xffff0000, v188
v_mul_f32 v242, v242, v239
v_mul_f32 v243, v243, v239
v_cvt_pk_bf16_f32 v188, v242, v243
v_lshlrev_b32 v242, 16, v189
v_and_b32 v243, 0xffff0000, v189
v_mul_f32 v242, v242, v239
v_mul_f32 v243, v243, v239
v_cvt_pk_bf16_f32 v189, v242, v243
ds_read_b64 v[254:255], v253 offset:3072
s_waitcnt lgkmcnt(0)
v_lshlrev_b32 v242, 16, v254
v_and_b32 v243, 0xffff0000, v254
v_mul_f32 v242, v242, v239
v_mul_f32 v243, v243, v239
v_cvt_pk_bf16_f32 v254, v242, v243
v_lshlrev_b32 v242, 16, v255
v_and_b32 v243, 0xffff0000, v255
v_mul_f32 v242, v242, v239
v_mul_f32 v243, v243, v239
v_cvt_pk_bf16_f32 v255, v242, v243
ds_write_b64 v253, v[254:255] offset:3072
s_waitcnt lgkmcnt(0)
ds_read_b64 v[254:255], v253 offset:3080
s_waitcnt lgkmcnt(0)
v_lshlrev_b32 v242, 16, v254
v_and_b32 v243, 0xffff0000, v254
v_mul_f32 v242, v242, v239
v_mul_f32 v243, v243, v239
v_cvt_pk_bf16_f32 v254, v242, v243
v_lshlrev_b32 v242, 16, v255
v_and_b32 v243, 0xffff0000, v255
v_mul_f32 v242, v242, v239
v_mul_f32 v243, v243, v239
v_cvt_pk_bf16_f32 v255, v242, v243
ds_write_b64 v253, v[254:255] offset:3080
s_waitcnt lgkmcnt(0)
ds_read_b64 v[254:255], v253 offset:7168
s_waitcnt lgkmcnt(0)
v_lshlrev_b32 v242, 16, v254
v_and_b32 v243, 0xffff0000, v254
v_mul_f32 v242, v242, v239
v_mul_f32 v243, v243, v239
v_cvt_pk_bf16_f32 v254, v242, v243
v_lshlrev_b32 v242, 16, v255
v_and_b32 v243, 0xffff0000, v255
v_mul_f32 v242, v242, v239
v_mul_f32 v243, v243, v239
v_cvt_pk_bf16_f32 v255, v242, v243
ds_write_b64 v253, v[254:255] offset:7168
s_waitcnt lgkmcnt(0)
ds_read_b64 v[254:255], v253 offset:7176
s_waitcnt lgkmcnt(0)
v_lshlrev_b32 v242, 16, v254
v_and_b32 v243, 0xffff0000, v254
v_mul_f32 v242, v242, v239
v_mul_f32 v243, v243, v239
v_cvt_pk_bf16_f32 v254, v242, v243
v_lshlrev_b32 v242, 16, v255
v_and_b32 v243, 0xffff0000, v255
v_mul_f32 v242, v242, v239
v_mul_f32 v243, v243, v239
v_cvt_pk_bf16_f32 v255, v242, v243
ds_write_b64 v253, v[254:255] offset:7176
s_waitcnt lgkmcnt(0)
v_exp_f32 v232, v144
v_exp_f32 v233, v145
v_exp_f32 v234, v146
v_exp_f32 v235, v147
s_nop 1
v_add_f32 v224, v228, v232
v_add_f32 v224, v224, v233
v_add_f32 v224, v224, v234
v_add_f32 v224, v224, v235
v_cvt_pk_bf16_f32 v178, v232, v233
v_cvt_pk_bf16_f32 v179, v234, v235
v_exp_f32 v232, v148
v_exp_f32 v233, v149
v_exp_f32 v234, v150
v_exp_f32 v235, v151
s_nop 1
v_add_f32 v225, v229, v232
v_add_f32 v225, v225, v233
v_add_f32 v225, v225, v234
v_add_f32 v225, v225, v235
v_cvt_pk_bf16_f32 v182, v232, v233
v_cvt_pk_bf16_f32 v183, v234, v235
v_exp_f32 v232, v152
v_exp_f32 v233, v153
v_exp_f32 v234, v154
v_exp_f32 v235, v155
s_nop 1
v_add_f32 v226, v230, v232
v_add_f32 v226, v226, v233
v_add_f32 v226, v226, v234
v_add_f32 v226, v226, v235
v_cvt_pk_bf16_f32 v186, v232, v233
v_cvt_pk_bf16_f32 v187, v234, v235
v_exp_f32 v232, v156
v_exp_f32 v233, v157
v_exp_f32 v234, v158
v_exp_f32 v235, v159
s_nop 1
v_add_f32 v227, v231, v232
v_add_f32 v227, v227, v233
v_add_f32 v227, v227, v234
v_add_f32 v227, v227, v235
v_cvt_pk_bf16_f32 v190, v232, v233
v_cvt_pk_bf16_f32 v191, v234, v235
s_branch L2_rare_common
L2_rare_site8:
s_mov_b32 s36, 8
s_branch L2_rare_t1_2_0
L2_rare_t1_2_0:
s_nop 15
s_nop 15
s_waitcnt lgkmcnt(0)
v_log_f32 v243, v224
v_max3_f32 v232, v128, v129, v130
v_max3_f32 v232, v232, v131, v243
v_mov_b32 v243, v232
s_nop 1
v_permlane32_swap_b32 v232, v243
s_nop 1
v_max_f32 v232, v232, v243
v_mov_b32 v243, v232
s_nop 1
v_permlane16_swap_b32 v232, v243
s_nop 1
v_max_f32 v232, v232, v243
v_ceil_f32 v232, v232
v_max_f32 v232, 0, v232
v_sub_f32 v243, 0, v232
v_exp_f32 v236, v243
s_nop 1
v_mul_f32 v224, v224, v236
v_sub_f32 v192, v192, v232
v_sub_f32 v128, v128, v232
v_sub_f32 v144, v144, v232
v_sub_f32 v193, v193, v232
v_sub_f32 v129, v129, v232
v_sub_f32 v145, v145, v232
v_sub_f32 v194, v194, v232
v_sub_f32 v130, v130, v232
v_sub_f32 v146, v146, v232
v_sub_f32 v195, v195, v232
v_sub_f32 v131, v131, v232
v_sub_f32 v147, v147, v232
v_lshlrev_b32 v242, 16, v176
v_and_b32 v243, 0xffff0000, v176
v_mul_f32 v242, v242, v236
v_mul_f32 v243, v243, v236
v_cvt_pk_bf16_f32 v176, v242, v243
v_lshlrev_b32 v242, 16, v177
v_and_b32 v243, 0xffff0000, v177
v_mul_f32 v242, v242, v236
v_mul_f32 v243, v243, v236
v_cvt_pk_bf16_f32 v177, v242, v243
v_lshlrev_b32 v242, 16, v178
v_and_b32 v243, 0xffff0000, v178
v_mul_f32 v242, v242, v236
v_mul_f32 v243, v243, v236
v_cvt_pk_bf16_f32 v178, v242, v243
v_lshlrev_b32 v242, 16, v179
v_and_b32 v243, 0xffff0000, v179
v_mul_f32 v242, v242, v236
v_mul_f32 v243, v243, v236
v_cvt_pk_bf16_f32 v179, v242, v243
ds_read_b64 v[254:255], v253 offset:0
s_waitcnt lgkmcnt(0)
v_lshlrev_b32 v242, 16, v254
v_and_b32 v243, 0xffff0000, v254
v_mul_f32 v242, v242, v236
v_mul_f32 v243, v243, v236
v_cvt_pk_bf16_f32 v254, v242, v243
v_lshlrev_b32 v242, 16, v255
v_and_b32 v243, 0xffff0000, v255
v_mul_f32 v242, v242, v236
v_mul_f32 v243, v243, v236
v_cvt_pk_bf16_f32 v255, v242, v243
ds_write_b64 v253, v[254:255] offset:0
s_waitcnt lgkmcnt(0)
ds_read_b64 v[254:255], v253 offset:8
s_waitcnt lgkmcnt(0)
v_lshlrev_b32 v242, 16, v254
v_and_b32 v243, 0xffff0000, v254
v_mul_f32 v242, v242, v236
v_mul_f32 v243, v243, v236
v_cvt_pk_bf16_f32 v254, v242, v243
v_lshlrev_b32 v242, 16, v255
v_and_b32 v243, 0xffff0000, v255
v_mul_f32 v242, v242, v236
v_mul_f32 v243, v243, v236
v_cvt_pk_bf16_f32 v255, v242, v243
ds_write_b64 v253, v[254:255] offset:8
s_waitcnt lgkmcnt(0)
ds_read_b64 v[254:255], v253 offset:4096
s_waitcnt lgkmcnt(0)
v_lshlrev_b32 v242, 16, v254
v_and_b32 v243, 0xffff0000, v254
v_mul_f32 v242, v242, v236
v_mul_f32 v243, v243, v236
v_cvt_pk_bf16_f32 v254, v242, v243
v_lshlrev_b32 v242, 16, v255
v_and_b32 v243, 0xffff0000, v255
v_mul_f32 v242, v242, v236
v_mul_f32 v243, v243, v236
v_cvt_pk_bf16_f32 v255, v242, v243
ds_write_b64 v253, v[254:255] offset:4096
s_waitcnt lgkmcnt(0)
ds_read_b64 v[254:255], v253 offset:4104
s_waitcnt lgkmcnt(0)
v_lshlrev_b32 v242, 16, v254
v_and_b32 v243, 0xffff0000, v254
v_mul_f32 v242, v242, v236
v_mul_f32 v243, v243, v236
v_cvt_pk_bf16_f32 v254, v242, v243
v_lshlrev_b32 v242, 16, v255
v_and_b32 v243, 0xffff0000, v255
v_mul_f32 v242, v242, v236
v_mul_f32 v243, v243, v236
v_cvt_pk_bf16_f32 v255, v242, v243
ds_write_b64 v253, v[254:255] offset:4104
s_waitcnt lgkmcnt(0)
v_log_f32 v243, v225
v_max3_f32 v233, v132, v133, v134
v_max3_f32 v233, v233, v135, v243
v_mov_b32 v243, v233
s_nop 1
v_permlane32_swap_b32 v233, v243
s_nop 1
v_max_f32 v233, v233, v243
v_mov_b32 v243, v233
s_nop 1
v_permlane16_swap_b32 v233, v243
s_nop 1
v_max_f32 v233, v233, v243
v_ceil_f32 v233, v233
v_max_f32 v233, 0, v233
v_sub_f32 v243, 0, v233
v_exp_f32 v237, v243
s_nop 1
v_mul_f32 v225, v225, v237
v_sub_f32 v196, v196, v233
v_sub_f32 v132, v132, v233
v_sub_f32 v148, v148, v233
v_sub_f32 v197, v197, v233
v_sub_f32 v133, v133, v233
v_sub_f32 v149, v149, v233
v_sub_f32 v198, v198, v233
v_sub_f32 v134, v134, v233
v_sub_f32 v150, v150, v233
v_sub_f32 v199, v199, v233
v_sub_f32 v135, v135, v233
v_sub_f32 v151, v151, v233
v_lshlrev_b32 v242, 16, v180
v_and_b32 v243, 0xffff0000, v180
v_mul_f32 v242, v242, v237
v_mul_f32 v243, v243, v237
v_cvt_pk_bf16_f32 v180, v242, v243
v_lshlrev_b32 v242, 16, v181
v_and_b32 v243, 0xffff0000, v181
v_mul_f32 v242, v242, v237
v_mul_f32 v243, v243, v237
v_cvt_pk_bf16_f32 v181, v242, v243
v_lshlrev_b32 v242, 16, v182
v_and_b32 v243, 0xffff0000, v182
v_mul_f32 v242, v242, v237
v_mul_f32 v243, v243, v237
v_cvt_pk_bf16_f32 v182, v242, v243
v_lshlrev_b32 v242, 16, v183
v_and_b32 v243, 0xffff0000, v183
v_mul_f32 v242, v242, v237
v_mul_f32 v243, v243, v237
v_cvt_pk_bf16_f32 v183, v242, v243
ds_read_b64 v[254:255], v253 offset:1024
s_waitcnt lgkmcnt(0)
v_lshlrev_b32 v242, 16, v254
v_and_b32 v243, 0xffff0000, v254
v_mul_f32 v242, v242, v237
v_mul_f32 v243, v243, v237
v_cvt_pk_bf16_f32 v254, v242, v243
v_lshlrev_b32 v242, 16, v255
v_and_b32 v243, 0xffff0000, v255
v_mul_f32 v242, v242, v237
v_mul_f32 v243, v243, v237
v_cvt_pk_bf16_f32 v255, v242, v243
ds_write_b64 v253, v[254:255] offset:1024
s_waitcnt lgkmcnt(0)
ds_read_b64 v[254:255], v253 offset:1032
s_waitcnt lgkmcnt(0)
v_lshlrev_b32 v242, 16, v254
v_and_b32 v243, 0xffff0000, v254
v_mul_f32 v242, v242, v237
v_mul_f32 v243, v243, v237
v_cvt_pk_bf16_f32 v254, v242, v243
v_lshlrev_b32 v242, 16, v255
v_and_b32 v243, 0xffff0000, v255
v_mul_f32 v242, v242, v237
v_mul_f32 v243, v243, v237
v_cvt_pk_bf16_f32 v255, v242, v243
ds_write_b64 v253, v[254:255] offset:1032
s_waitcnt lgkmcnt(0)
ds_read_b64 v[254:255], v253 offset:5120
s_waitcnt lgkmcnt(0)
v_lshlrev_b32 v242, 16, v254
v_and_b32 v243, 0xffff0000, v254
v_mul_f32 v242, v242, v237
v_mul_f32 v243, v243, v237
v_cvt_pk_bf16_f32 v254, v242, v243
v_lshlrev_b32 v242, 16, v255
v_and_b32 v243, 0xffff0000, v255
v_mul_f32 v242, v242, v237
v_mul_f32 v243, v243, v237
v_cvt_pk_bf16_f32 v255, v242, v243
ds_write_b64 v253, v[254:255] offset:5120
s_waitcnt lgkmcnt(0)
ds_read_b64 v[254:255], v253 offset:5128
s_waitcnt lgkmcnt(0)
v_lshlrev_b32 v242, 16, v254
v_and_b32 v243, 0xffff0000, v254
v_mul_f32 v242, v242, v237
v_mul_f32 v243, v243, v237
v_cvt_pk_bf16_f32 v254, v242, v243
v_lshlrev_b32 v242, 16, v255
v_and_b32 v243, 0xffff0000, v255
v_mul_f32 v242, v242, v237
v_mul_f32 v243, v243, v237
v_cvt_pk_bf16_f32 v255, v242, v243
ds_write_b64 v253, v[254:255] offset:5128
s_waitcnt lgkmcnt(0)
v_log_f32 v243, v226
v_max3_f32 v234, v136, v137, v138
v_max3_f32 v234, v234, v139, v243
v_mov_b32 v243, v234
s_nop 1
v_permlane32_swap_b32 v234, v243
s_nop 1
v_max_f32 v234, v234, v243
v_mov_b32 v243, v234
s_nop 1
v_permlane16_swap_b32 v234, v243
s_nop 1
v_max_f32 v234, v234, v243
v_ceil_f32 v234, v234
v_max_f32 v234, 0, v234
v_sub_f32 v243, 0, v234
v_exp_f32 v238, v243
s_nop 1
v_mul_f32 v226, v226, v238
v_sub_f32 v200, v200, v234
v_sub_f32 v136, v136, v234
v_sub_f32 v152, v152, v234
v_sub_f32 v201, v201, v234
v_sub_f32 v137, v137, v234
v_sub_f32 v153, v153, v234
v_sub_f32 v202, v202, v234
v_sub_f32 v138, v138, v234
v_sub_f32 v154, v154, v234
v_sub_f32 v203, v203, v234
v_sub_f32 v139, v139, v234
v_sub_f32 v155, v155, v234
v_lshlrev_b32 v242, 16, v184
v_and_b32 v243, 0xffff0000, v184
v_mul_f32 v242, v242, v238
v_mul_f32 v243, v243, v238
v_cvt_pk_bf16_f32 v184, v242, v243
v_lshlrev_b32 v242, 16, v185
v_and_b32 v243, 0xffff0000, v185
v_mul_f32 v242, v242, v238
v_mul_f32 v243, v243, v238
v_cvt_pk_bf16_f32 v185, v242, v243
v_lshlrev_b32 v242, 16, v186
v_and_b32 v243, 0xffff0000, v186
v_mul_f32 v242, v242, v238
v_mul_f32 v243, v243, v238
v_cvt_pk_bf16_f32 v186, v242, v243
v_lshlrev_b32 v242, 16, v187
v_and_b32 v243, 0xffff0000, v187
v_mul_f32 v242, v242, v238
v_mul_f32 v243, v243, v238
v_cvt_pk_bf16_f32 v187, v242, v243
ds_read_b64 v[254:255], v253 offset:2048
s_waitcnt lgkmcnt(0)
v_lshlrev_b32 v242, 16, v254
v_and_b32 v243, 0xffff0000, v254
v_mul_f32 v242, v242, v238
v_mul_f32 v243, v243, v238
v_cvt_pk_bf16_f32 v254, v242, v243
v_lshlrev_b32 v242, 16, v255
v_and_b32 v243, 0xffff0000, v255
v_mul_f32 v242, v242, v238
v_mul_f32 v243, v243, v238
v_cvt_pk_bf16_f32 v255, v242, v243
ds_write_b64 v253, v[254:255] offset:2048
s_waitcnt lgkmcnt(0)
ds_read_b64 v[254:255], v253 offset:2056
s_waitcnt lgkmcnt(0)
v_lshlrev_b32 v242, 16, v254
v_and_b32 v243, 0xffff0000, v254
v_mul_f32 v242, v242, v238
v_mul_f32 v243, v243, v238
v_cvt_pk_bf16_f32 v254, v242, v243
v_lshlrev_b32 v242, 16, v255
v_and_b32 v243, 0xffff0000, v255
v_mul_f32 v242, v242, v238
v_mul_f32 v243, v243, v238
v_cvt_pk_bf16_f32 v255, v242, v243
ds_write_b64 v253, v[254:255] offset:2056
s_waitcnt lgkmcnt(0)
ds_read_b64 v[254:255], v253 offset:6144
s_waitcnt lgkmcnt(0)
v_lshlrev_b32 v242, 16, v254
v_and_b32 v243, 0xffff0000, v254
v_mul_f32 v242, v242, v238
v_mul_f32 v243, v243, v238
v_cvt_pk_bf16_f32 v254, v242, v243
v_lshlrev_b32 v242, 16, v255
v_and_b32 v243, 0xffff0000, v255
v_mul_f32 v242, v242, v238
v_mul_f32 v243, v243, v238
v_cvt_pk_bf16_f32 v255, v242, v243
ds_write_b64 v253, v[254:255] offset:6144
s_waitcnt lgkmcnt(0)
ds_read_b64 v[254:255], v253 offset:6152
s_waitcnt lgkmcnt(0)
v_lshlrev_b32 v242, 16, v254
v_and_b32 v243, 0xffff0000, v254
v_mul_f32 v242, v242, v238
v_mul_f32 v243, v243, v238
v_cvt_pk_bf16_f32 v254, v242, v243
v_lshlrev_b32 v242, 16, v255
v_and_b32 v243, 0xffff0000, v255
v_mul_f32 v242, v242, v238
v_mul_f32 v243, v243, v238
v_cvt_pk_bf16_f32 v255, v242, v243
ds_write_b64 v253, v[254:255] offset:6152
s_waitcnt lgkmcnt(0)
v_log_f32 v243, v227
v_max3_f32 v235, v140, v141, v142
v_max3_f32 v235, v235, v143, v243
v_mov_b32 v243, v235
s_nop 1
v_permlane32_swap_b32 v235, v243
s_nop 1
v_max_f32 v235, v235, v243
v_mov_b32 v243, v235
s_nop 1
v_permlane16_swap_b32 v235, v243
s_nop 1
v_max_f32 v235, v235, v243
v_ceil_f32 v235, v235
v_max_f32 v235, 0, v235
v_sub_f32 v243, 0, v235
v_exp_f32 v239, v243
s_nop 1
v_mul_f32 v227, v227, v239
v_sub_f32 v204, v204, v235
v_sub_f32 v140, v140, v235
v_sub_f32 v156, v156, v235
v_sub_f32 v205, v205, v235
v_sub_f32 v141, v141, v235
v_sub_f32 v157, v157, v235
v_sub_f32 v206, v206, v235
v_sub_f32 v142, v142, v235
v_sub_f32 v158, v158, v235
v_sub_f32 v207, v207, v235
v_sub_f32 v143, v143, v235
v_sub_f32 v159, v159, v235
v_lshlrev_b32 v242, 16, v188
v_and_b32 v243, 0xffff0000, v188
v_mul_f32 v242, v242, v239
v_mul_f32 v243, v243, v239
v_cvt_pk_bf16_f32 v188, v242, v243
v_lshlrev_b32 v242, 16, v189
v_and_b32 v243, 0xffff0000, v189
v_mul_f32 v242, v242, v239
v_mul_f32 v243, v243, v239
v_cvt_pk_bf16_f32 v189, v242, v243
v_lshlrev_b32 v242, 16, v190
v_and_b32 v243, 0xffff0000, v190
v_mul_f32 v242, v242, v239
v_mul_f32 v243, v243, v239
v_cvt_pk_bf16_f32 v190, v242, v243
v_lshlrev_b32 v242, 16, v191
v_and_b32 v243, 0xffff0000, v191
v_mul_f32 v242, v242, v239
v_mul_f32 v243, v243, v239
v_cvt_pk_bf16_f32 v191, v242, v243
ds_read_b64 v[254:255], v253 offset:3072
s_waitcnt lgkmcnt(0)
v_lshlrev_b32 v242, 16, v254
v_and_b32 v243, 0xffff0000, v254
v_mul_f32 v242, v242, v239
v_mul_f32 v243, v243, v239
v_cvt_pk_bf16_f32 v254, v242, v243
v_lshlrev_b32 v242, 16, v255
v_and_b32 v243, 0xffff0000, v255
v_mul_f32 v242, v242, v239
v_mul_f32 v243, v243, v239
v_cvt_pk_bf16_f32 v255, v242, v243
ds_write_b64 v253, v[254:255] offset:3072
s_waitcnt lgkmcnt(0)
ds_read_b64 v[254:255], v253 offset:3080
s_waitcnt lgkmcnt(0)
v_lshlrev_b32 v242, 16, v254
v_and_b32 v243, 0xffff0000, v254
v_mul_f32 v242, v242, v239
v_mul_f32 v243, v243, v239
v_cvt_pk_bf16_f32 v254, v242, v243
v_lshlrev_b32 v242, 16, v255
v_and_b32 v243, 0xffff0000, v255
v_mul_f32 v242, v242, v239
v_mul_f32 v243, v243, v239
v_cvt_pk_bf16_f32 v255, v242, v243
ds_write_b64 v253, v[254:255] offset:3080
s_waitcnt lgkmcnt(0)
ds_read_b64 v[254:255], v253 offset:7168
s_waitcnt lgkmcnt(0)
v_lshlrev_b32 v242, 16, v254
v_and_b32 v243, 0xffff0000, v254
v_mul_f32 v242, v242, v239
v_mul_f32 v243, v243, v239
v_cvt_pk_bf16_f32 v254, v242, v243
v_lshlrev_b32 v242, 16, v255
v_and_b32 v243, 0xffff0000, v255
v_mul_f32 v242, v242, v239
v_mul_f32 v243, v243, v239
v_cvt_pk_bf16_f32 v255, v242, v243
ds_write_b64 v253, v[254:255] offset:7168
s_waitcnt lgkmcnt(0)
ds_read_b64 v[254:255], v253 offset:7176
s_waitcnt lgkmcnt(0)
v_lshlrev_b32 v242, 16, v254
v_and_b32 v243, 0xffff0000, v254
v_mul_f32 v242, v242, v239
v_mul_f32 v243, v243, v239
v_cvt_pk_bf16_f32 v254, v242, v243
v_lshlrev_b32 v242, 16, v255
v_and_b32 v243, 0xffff0000, v255
v_mul_f32 v242, v242, v239
v_mul_f32 v243, v243, v239
v_cvt_pk_bf16_f32 v255, v242, v243
ds_write_b64 v253, v[254:255] offset:7176
s_waitcnt lgkmcnt(0)
v_exp_f32 v232, v128
v_exp_f32 v233, v129
v_exp_f32 v234, v130
v_exp_f32 v235, v131
s_nop 1
v_add_f32 v228, v224, v232
v_add_f32 v228, v228, v233
v_add_f32 v228, v228, v234
v_add_f32 v228, v228, v235
v_cvt_pk_bf16_f32 v160, v232, v233
v_cvt_pk_bf16_f32 v161, v234, v235
v_exp_f32 v232, v132
v_exp_f32 v233, v133
v_exp_f32 v234, v134
v_exp_f32 v235, v135
s_nop 1
v_add_f32 v229, v225, v232
v_add_f32 v229, v229, v233
v_add_f32 v229, v229, v234
v_add_f32 v229, v229, v235
v_cvt_pk_bf16_f32 v164, v232, v233
v_cvt_pk_bf16_f32 v165, v234, v235
v_exp_f32 v232, v136
v_exp_f32 v233, v137
v_exp_f32 v234, v138
v_exp_f32 v235, v139
s_nop 1
v_add_f32 v230, v226, v232
v_add_f32 v230, v230, v233
v_add_f32 v230, v230, v234
v_add_f32 v230, v230, v235
v_cvt_pk_bf16_f32 v168, v232, v233
v_cvt_pk_bf16_f32 v169, v234, v235
v_exp_f32 v232, v140
v_exp_f32 v233, v141
v_exp_f32 v234, v142
v_exp_f32 v235, v143
s_nop 1
v_add_f32 v231, v227, v232
v_add_f32 v231, v231, v233
v_add_f32 v231, v231, v234
v_add_f32 v231, v231, v235
v_cvt_pk_bf16_f32 v172, v232, v233
v_cvt_pk_bf16_f32 v173, v234, v235
s_branch L2_rare_common
L2_rare_site9:
s_mov_b32 s36, 9
s_branch L2_rare_t1_3_1
L2_rare_t1_3_1:
s_nop 15
s_nop 15
s_waitcnt lgkmcnt(0)
v_log_f32 v243, v228
v_max3_f32 v232, v144, v145, v146
v_max3_f32 v232, v232, v147, v243
v_mov_b32 v243, v232
s_nop 1
v_permlane32_swap_b32 v232, v243
s_nop 1
v_max_f32 v232, v232, v243
v_mov_b32 v243, v232
s_nop 1
v_permlane16_swap_b32 v232, v243
s_nop 1
v_max_f32 v232, v232, v243
v_ceil_f32 v232, v232
v_max_f32 v232, 0, v232
v_sub_f32 v243, 0, v232
v_exp_f32 v236, v243
s_nop 1
v_mul_f32 v228, v228, v236
v_sub_f32 v192, v192, v232
v_sub_f32 v128, v128, v232
v_sub_f32 v144, v144, v232
v_sub_f32 v193, v193, v232
v_sub_f32 v129, v129, v232
v_sub_f32 v145, v145, v232
v_sub_f32 v194, v194, v232
v_sub_f32 v130, v130, v232
v_sub_f32 v146, v146, v232
v_sub_f32 v195, v195, v232
v_sub_f32 v131, v131, v232
v_sub_f32 v147, v147, v232
v_lshlrev_b32 v242, 16, v176
v_and_b32 v243, 0xffff0000, v176
v_mul_f32 v242, v242, v236
v_mul_f32 v243, v243, v236
v_cvt_pk_bf16_f32 v176, v242, v243
v_lshlrev_b32 v242, 16, v177
v_and_b32 v243, 0xffff0000, v177
v_mul_f32 v242, v242, v236
v_mul_f32 v243, v243, v236
v_cvt_pk_bf16_f32 v177, v242, v243
v_lshlrev_b32 v242, 16, v178
v_and_b32 v243, 0xffff0000, v178
v_mul_f32 v242, v242, v236
v_mul_f32 v243, v243, v236
v_cvt_pk_bf16_f32 v178, v242, v243
v_lshlrev_b32 v242, 16, v179
v_and_b32 v243, 0xffff0000, v179
v_mul_f32 v242, v242, v236
v_mul_f32 v243, v243, v236
v_cvt_pk_bf16_f32 v179, v242, v243
v_lshlrev_b32 v242, 16, v160
v_and_b32 v243, 0xffff0000, v160
v_mul_f32 v242, v242, v236
v_mul_f32 v243, v243, v236
v_cvt_pk_bf16_f32 v160, v242, v243
v_lshlrev_b32 v242, 16, v161
v_and_b32 v243, 0xffff0000, v161
v_mul_f32 v242, v242, v236
v_mul_f32 v243, v243, v236
v_cvt_pk_bf16_f32 v161, v242, v243
ds_read_b64 v[254:255], v253 offset:0
s_waitcnt lgkmcnt(0)
v_lshlrev_b32 v242, 16, v254
v_and_b32 v243, 0xffff0000, v254
v_mul_f32 v242, v242, v236
v_mul_f32 v243, v243, v236
v_cvt_pk_bf16_f32 v254, v242, v243
v_lshlrev_b32 v242, 16, v255
v_and_b32 v243, 0xffff0000, v255
v_mul_f32 v242, v242, v236
v_mul_f32 v243, v243, v236
v_cvt_pk_bf16_f32 v255, v242, v243
ds_write_b64 v253, v[254:255] offset:0
s_waitcnt lgkmcnt(0)
ds_read_b64 v[254:255], v253 offset:8
s_waitcnt lgkmcnt(0)
v_lshlrev_b32 v242, 16, v254
v_and_b32 v243, 0xffff0000, v254
v_mul_f32 v242, v242, v236
v_mul_f32 v243, v243, v236
v_cvt_pk_bf16_f32 v254, v242, v243
v_lshlrev_b32 v242, 16, v255
v_and_b32 v243, 0xffff0000, v255
v_mul_f32 v242, v242, v236
v_mul_f32 v243, v243, v236
v_cvt_pk_bf16_f32 v255, v242, v243
ds_write_b64 v253, v[254:255] offset:8
s_waitcnt lgkmcnt(0)
ds_read_b64 v[254:255], v253 offset:4096
s_waitcnt lgkmcnt(0)
v_lshlrev_b32 v242, 16, v254
v_and_b32 v243, 0xffff0000, v254
v_mul_f32 v242, v242, v236
v_mul_f32 v243, v243, v236
v_cvt_pk_bf16_f32 v254, v242, v243
v_lshlrev_b32 v242, 16, v255
v_and_b32 v243, 0xffff0000, v255
v_mul_f32 v242, v242, v236
v_mul_f32 v243, v243, v236
v_cvt_pk_bf16_f32 v255, v242, v243
ds_write_b64 v253, v[254:255] offset:4096
s_waitcnt lgkmcnt(0)
ds_read_b64 v[254:255], v253 offset:4104
s_waitcnt lgkmcnt(0)
v_lshlrev_b32 v242, 16, v254
v_and_b32 v243, 0xffff0000, v254
v_mul_f32 v242, v242, v236
v_mul_f32 v243, v243, v236
v_cvt_pk_bf16_f32 v254, v242, v243
v_lshlrev_b32 v242, 16, v255
v_and_b32 v243, 0xffff0000, v255
v_mul_f32 v242, v242, v236
v_mul_f32 v243, v243, v236
v_cvt_pk_bf16_f32 v255, v242, v243
ds_write_b64 v253, v[254:255] offset:4104
s_waitcnt lgkmcnt(0)
v_log_f32 v243, v229
v_max3_f32 v233, v148, v149, v150
v_max3_f32 v233, v233, v151, v243
v_mov_b32 v243, v233
s_nop 1
v_permlane32_swap_b32 v233, v243
s_nop 1
v_max_f32 v233, v233, v243
v_mov_b32 v243, v233
s_nop 1
v_permlane16_swap_b32 v233, v243
s_nop 1
v_max_f32 v233, v233, v243
v_ceil_f32 v233, v233
v_max_f32 v233, 0, v233
v_sub_f32 v243, 0, v233
v_exp_f32 v237, v243
s_nop 1
v_mul_f32 v229, v229, v237
v_sub_f32 v196, v196, v233
v_sub_f32 v132, v132, v233
v_sub_f32 v148, v148, v233
v_sub_f32 v197, v197, v233
v_sub_f32 v133, v133, v233
v_sub_f32 v149, v149, v233
v_sub_f32 v198, v198, v233
v_sub_f32 v134, v134, v233
v_sub_f32 v150, v150, v233
v_sub_f32 v199, v199, v233
v_sub_f32 v135, v135, v233
v_sub_f32 v151, v151, v233
v_lshlrev_b32 v242, 16, v180
v_and_b32 v243, 0xffff0000, v180
v_mul_f32 v242, v242, v237
v_mul_f32 v243, v243, v237
v_cvt_pk_bf16_f32 v180, v242, v243
v_lshlrev_b32 v242, 16, v181
v_and_b32 v243, 0xffff0000, v181
v_mul_f32 v242, v242, v237
v_mul_f32 v243, v243, v237
v_cvt_pk_bf16_f32 v181, v242, v243
v_lshlrev_b32 v242, 16, v182
v_and_b32 v243, 0xffff0000, v182
v_mul_f32 v242, v242, v237
v_mul_f32 v243, v243, v237
v_cvt_pk_bf16_f32 v182, v242, v243
v_lshlrev_b32 v242, 16, v183
v_and_b32 v243, 0xffff0000, v183
v_mul_f32 v242, v242, v237
v_mul_f32 v243, v243, v237
v_cvt_pk_bf16_f32 v183, v242, v243
v_lshlrev_b32 v242, 16, v164
v_and_b32 v243, 0xffff0000, v164
v_mul_f32 v242, v242, v237
v_mul_f32 v243, v243, v237
v_cvt_pk_bf16_f32 v164, v242, v243
v_lshlrev_b32 v242, 16, v165
v_and_b32 v243, 0xffff0000, v165
v_mul_f32 v242, v242, v237
v_mul_f32 v243, v243, v237
v_cvt_pk_bf16_f32 v165, v242, v243
ds_read_b64 v[254:255], v253 offset:1024
s_waitcnt lgkmcnt(0)
v_lshlrev_b32 v242, 16, v254
v_and_b32 v243, 0xffff0000, v254
v_mul_f32 v242, v242, v237
v_mul_f32 v243, v243, v237
v_cvt_pk_bf16_f32 v254, v242, v243
v_lshlrev_b32 v242, 16, v255
v_and_b32 v243, 0xffff0000, v255
v_mul_f32 v242, v242, v237
v_mul_f32 v243, v243, v237
v_cvt_pk_bf16_f32 v255, v242, v243
ds_write_b64 v253, v[254:255] offset:1024
s_waitcnt lgkmcnt(0)
ds_read_b64 v[254:255], v253 offset:1032
s_waitcnt lgkmcnt(0)
v_lshlrev_b32 v242, 16, v254
v_and_b32 v243, 0xffff0000, v254
v_mul_f32 v242, v242, v237
v_mul_f32 v243, v243, v237
v_cvt_pk_bf16_f32 v254, v242, v243
v_lshlrev_b32 v242, 16, v255
v_and_b32 v243, 0xffff0000, v255
v_mul_f32 v242, v242, v237
v_mul_f32 v243, v243, v237
v_cvt_pk_bf16_f32 v255, v242, v243
ds_write_b64 v253, v[254:255] offset:1032
s_waitcnt lgkmcnt(0)
ds_read_b64 v[254:255], v253 offset:5120
s_waitcnt lgkmcnt(0)
v_lshlrev_b32 v242, 16, v254
v_and_b32 v243, 0xffff0000, v254
v_mul_f32 v242, v242, v237
v_mul_f32 v243, v243, v237
v_cvt_pk_bf16_f32 v254, v242, v243
v_lshlrev_b32 v242, 16, v255
v_and_b32 v243, 0xffff0000, v255
v_mul_f32 v242, v242, v237
v_mul_f32 v243, v243, v237
v_cvt_pk_bf16_f32 v255, v242, v243
ds_write_b64 v253, v[254:255] offset:5120
s_waitcnt lgkmcnt(0)
ds_read_b64 v[254:255], v253 offset:5128
s_waitcnt lgkmcnt(0)
v_lshlrev_b32 v242, 16, v254
v_and_b32 v243, 0xffff0000, v254
v_mul_f32 v242, v242, v237
v_mul_f32 v243, v243, v237
v_cvt_pk_bf16_f32 v254, v242, v243
v_lshlrev_b32 v242, 16, v255
v_and_b32 v243, 0xffff0000, v255
v_mul_f32 v242, v242, v237
v_mul_f32 v243, v243, v237
v_cvt_pk_bf16_f32 v255, v242, v243
ds_write_b64 v253, v[254:255] offset:5128
s_waitcnt lgkmcnt(0)
v_log_f32 v243, v230
v_max3_f32 v234, v152, v153, v154
v_max3_f32 v234, v234, v155, v243
v_mov_b32 v243, v234
s_nop 1
v_permlane32_swap_b32 v234, v243
s_nop 1
v_max_f32 v234, v234, v243
v_mov_b32 v243, v234
s_nop 1
v_permlane16_swap_b32 v234, v243
s_nop 1
v_max_f32 v234, v234, v243
v_ceil_f32 v234, v234
v_max_f32 v234, 0, v234
v_sub_f32 v243, 0, v234
v_exp_f32 v238, v243
s_nop 1
v_mul_f32 v230, v230, v238
v_sub_f32 v200, v200, v234
v_sub_f32 v136, v136, v234
v_sub_f32 v152, v152, v234
v_sub_f32 v201, v201, v234
v_sub_f32 v137, v137, v234
v_sub_f32 v153, v153, v234
v_sub_f32 v202, v202, v234
v_sub_f32 v138, v138, v234
v_sub_f32 v154, v154, v234
v_sub_f32 v203, v203, v234
v_sub_f32 v139, v139, v234
v_sub_f32 v155, v155, v234
v_lshlrev_b32 v242, 16, v184
v_and_b32 v243, 0xffff0000, v184
v_mul_f32 v242, v242, v238
v_mul_f32 v243, v243, v238
v_cvt_pk_bf16_f32 v184, v242, v243
v_lshlrev_b32 v242, 16, v185
v_and_b32 v243, 0xffff0000, v185
v_mul_f32 v242, v242, v238
v_mul_f32 v243, v243, v238
v_cvt_pk_bf16_f32 v185, v242, v243
v_lshlrev_b32 v242, 16, v186
v_and_b32 v243, 0xffff0000, v186
v_mul_f32 v242, v242, v238
v_mul_f32 v243, v243, v238
v_cvt_pk_bf16_f32 v186, v242, v243
v_lshlrev_b32 v242, 16, v187
v_and_b32 v243, 0xffff0000, v187
v_mul_f32 v242, v242, v238
v_mul_f32 v243, v243, v238
v_cvt_pk_bf16_f32 v187, v242, v243
v_lshlrev_b32 v242, 16, v168
v_and_b32 v243, 0xffff0000, v168
v_mul_f32 v242, v242, v238
v_mul_f32 v243, v243, v238
v_cvt_pk_bf16_f32 v168, v242, v243
v_lshlrev_b32 v242, 16, v169
v_and_b32 v243, 0xffff0000, v169
v_mul_f32 v242, v242, v238
v_mul_f32 v243, v243, v238
v_cvt_pk_bf16_f32 v169, v242, v243
ds_read_b64 v[254:255], v253 offset:2048
s_waitcnt lgkmcnt(0)
v_lshlrev_b32 v242, 16, v254
v_and_b32 v243, 0xffff0000, v254
v_mul_f32 v242, v242, v238
v_mul_f32 v243, v243, v238
v_cvt_pk_bf16_f32 v254, v242, v243
v_lshlrev_b32 v242, 16, v255
v_and_b32 v243, 0xffff0000, v255
v_mul_f32 v242, v242, v238
v_mul_f32 v243, v243, v238
v_cvt_pk_bf16_f32 v255, v242, v243
ds_write_b64 v253, v[254:255] offset:2048
s_waitcnt lgkmcnt(0)
ds_read_b64 v[254:255], v253 offset:2056
s_waitcnt lgkmcnt(0)
v_lshlrev_b32 v242, 16, v254
v_and_b32 v243, 0xffff0000, v254
v_mul_f32 v242, v242, v238
v_mul_f32 v243, v243, v238
v_cvt_pk_bf16_f32 v254, v242, v243
v_lshlrev_b32 v242, 16, v255
v_and_b32 v243, 0xffff0000, v255
v_mul_f32 v242, v242, v238
v_mul_f32 v243, v243, v238
v_cvt_pk_bf16_f32 v255, v242, v243
ds_write_b64 v253, v[254:255] offset:2056
s_waitcnt lgkmcnt(0)
ds_read_b64 v[254:255], v253 offset:6144
s_waitcnt lgkmcnt(0)
v_lshlrev_b32 v242, 16, v254
v_and_b32 v243, 0xffff0000, v254
v_mul_f32 v242, v242, v238
v_mul_f32 v243, v243, v238
v_cvt_pk_bf16_f32 v254, v242, v243
v_lshlrev_b32 v242, 16, v255
v_and_b32 v243, 0xffff0000, v255
v_mul_f32 v242, v242, v238
v_mul_f32 v243, v243, v238
v_cvt_pk_bf16_f32 v255, v242, v243
ds_write_b64 v253, v[254:255] offset:6144
s_waitcnt lgkmcnt(0)
ds_read_b64 v[254:255], v253 offset:6152
s_waitcnt lgkmcnt(0)
v_lshlrev_b32 v242, 16, v254
v_and_b32 v243, 0xffff0000, v254
v_mul_f32 v242, v242, v238
v_mul_f32 v243, v243, v238
v_cvt_pk_bf16_f32 v254, v242, v243
v_lshlrev_b32 v242, 16, v255
v_and_b32 v243, 0xffff0000, v255
v_mul_f32 v242, v242, v238
v_mul_f32 v243, v243, v238
v_cvt_pk_bf16_f32 v255, v242, v243
ds_write_b64 v253, v[254:255] offset:6152
s_waitcnt lgkmcnt(0)
v_log_f32 v243, v231
v_max3_f32 v235, v156, v157, v158
v_max3_f32 v235, v235, v159, v243
v_mov_b32 v243, v235
s_nop 1
v_permlane32_swap_b32 v235, v243
s_nop 1
v_max_f32 v235, v235, v243
v_mov_b32 v243, v235
s_nop 1
v_permlane16_swap_b32 v235, v243
s_nop 1
v_max_f32 v235, v235, v243
v_ceil_f32 v235, v235
v_max_f32 v235, 0, v235
v_sub_f32 v243, 0, v235
v_exp_f32 v239, v243
s_nop 1
v_mul_f32 v231, v231, v239
v_sub_f32 v204, v204, v235
v_sub_f32 v140, v140, v235
v_sub_f32 v156, v156, v235
v_sub_f32 v205, v205, v235
v_sub_f32 v141, v141, v235
v_sub_f32 v157, v157, v235
v_sub_f32 v206, v206, v235
v_sub_f32 v142, v142, v235
v_sub_f32 v158, v158, v235
v_sub_f32 v207, v207, v235
v_sub_f32 v143, v143, v235
v_sub_f32 v159, v159, v235
v_lshlrev_b32 v242, 16, v188
v_and_b32 v243, 0xffff0000, v188
v_mul_f32 v242, v242, v239
v_mul_f32 v243, v243, v239
v_cvt_pk_bf16_f32 v188, v242, v243
v_lshlrev_b32 v242, 16, v189
v_and_b32 v243, 0xffff0000, v189
v_mul_f32 v242, v242, v239
v_mul_f32 v243, v243, v239
v_cvt_pk_bf16_f32 v189, v242, v243
v_lshlrev_b32 v242, 16, v190
v_and_b32 v243, 0xffff0000, v190
v_mul_f32 v242, v242, v239
v_mul_f32 v243, v243, v239
v_cvt_pk_bf16_f32 v190, v242, v243
v_lshlrev_b32 v242, 16, v191
v_and_b32 v243, 0xffff0000, v191
v_mul_f32 v242, v242, v239
v_mul_f32 v243, v243, v239
v_cvt_pk_bf16_f32 v191, v242, v243
v_lshlrev_b32 v242, 16, v172
v_and_b32 v243, 0xffff0000, v172
v_mul_f32 v242, v242, v239
v_mul_f32 v243, v243, v239
v_cvt_pk_bf16_f32 v172, v242, v243
v_lshlrev_b32 v242, 16, v173
v_and_b32 v243, 0xffff0000, v173
v_mul_f32 v242, v242, v239
v_mul_f32 v243, v243, v239
v_cvt_pk_bf16_f32 v173, v242, v243
ds_read_b64 v[254:255], v253 offset:3072
s_waitcnt lgkmcnt(0)
v_lshlrev_b32 v242, 16, v254
v_and_b32 v243, 0xffff0000, v254
v_mul_f32 v242, v242, v239
v_mul_f32 v243, v243, v239
v_cvt_pk_bf16_f32 v254, v242, v243
v_lshlrev_b32 v242, 16, v255
v_and_b32 v243, 0xffff0000, v255
v_mul_f32 v242, v242, v239
v_mul_f32 v243, v243, v239
v_cvt_pk_bf16_f32 v255, v242, v243
ds_write_b64 v253, v[254:255] offset:3072
s_waitcnt lgkmcnt(0)
ds_read_b64 v[254:255], v253 offset:3080
s_waitcnt lgkmcnt(0)
v_lshlrev_b32 v242, 16, v254
v_and_b32 v243, 0xffff0000, v254
v_mul_f32 v242, v242, v239
v_mul_f32 v243, v243, v239
v_cvt_pk_bf16_f32 v254, v242, v243
v_lshlrev_b32 v242, 16, v255
v_and_b32 v243, 0xffff0000, v255
v_mul_f32 v242, v242, v239
v_mul_f32 v243, v243, v239
v_cvt_pk_bf16_f32 v255, v242, v243
ds_write_b64 v253, v[254:255] offset:3080
s_waitcnt lgkmcnt(0)
ds_read_b64 v[254:255], v253 offset:7168
s_waitcnt lgkmcnt(0)
v_lshlrev_b32 v242, 16, v254
v_and_b32 v243, 0xffff0000, v254
v_mul_f32 v242, v242, v239
v_mul_f32 v243, v243, v239
v_cvt_pk_bf16_f32 v254, v242, v243
v_lshlrev_b32 v242, 16, v255
v_and_b32 v243, 0xffff0000, v255
v_mul_f32 v242, v242, v239
v_mul_f32 v243, v243, v239
v_cvt_pk_bf16_f32 v255, v242, v243
ds_write_b64 v253, v[254:255] offset:7168
s_waitcnt lgkmcnt(0)
ds_read_b64 v[254:255], v253 offset:7176
s_waitcnt lgkmcnt(0)
v_lshlrev_b32 v242, 16, v254
v_and_b32 v243, 0xffff0000, v254
v_mul_f32 v242, v242, v239
v_mul_f32 v243, v243, v239
v_cvt_pk_bf16_f32 v254, v242, v243
v_lshlrev_b32 v242, 16, v255
v_and_b32 v243, 0xffff0000, v255
v_mul_f32 v242, v242, v239
v_mul_f32 v243, v243, v239
v_cvt_pk_bf16_f32 v255, v242, v243
ds_write_b64 v253, v[254:255] offset:7176
s_waitcnt lgkmcnt(0)
v_exp_f32 v232, v144
v_exp_f32 v233, v145
v_exp_f32 v234, v146
v_exp_f32 v235, v147
s_nop 1
v_add_f32 v224, v228, v232
v_add_f32 v224, v224, v233
v_add_f32 v224, v224, v234
v_add_f32 v224, v224, v235
v_cvt_pk_bf16_f32 v162, v232, v233
v_cvt_pk_bf16_f32 v163, v234, v235
v_exp_f32 v232, v148
v_exp_f32 v233, v149
v_exp_f32 v234, v150
v_exp_f32 v235, v151
s_nop 1
v_add_f32 v225, v229, v232
v_add_f32 v225, v225, v233
v_add_f32 v225, v225, v234
v_add_f32 v225, v225, v235
v_cvt_pk_bf16_f32 v166, v232, v233
v_cvt_pk_bf16_f32 v167, v234, v235
v_exp_f32 v232, v152
v_exp_f32 v233, v153
v_exp_f32 v234, v154
v_exp_f32 v235, v155
s_nop 1
v_add_f32 v226, v230, v232
v_add_f32 v226, v226, v233
v_add_f32 v226, v226, v234
v_add_f32 v226, v226, v235
v_cvt_pk_bf16_f32 v170, v232, v233
v_cvt_pk_bf16_f32 v171, v234, v235
v_exp_f32 v232, v156
v_exp_f32 v233, v157
v_exp_f32 v234, v158
v_exp_f32 v235, v159
s_nop 1
v_add_f32 v227, v231, v232
v_add_f32 v227, v227, v233
v_add_f32 v227, v227, v234
v_add_f32 v227, v227, v235
v_cvt_pk_bf16_f32 v174, v232, v233
v_cvt_pk_bf16_f32 v175, v234, v235
s_branch L2_rare_common
L2_rare_site10:
s_mov_b32 s36, 10
s_branch L2_rare_t1_4_0
L2_rare_t1_4_0:
s_nop 15
s_nop 15
s_waitcnt lgkmcnt(0)
v_log_f32 v243, v224
v_max3_f32 v232, v128, v129, v130
v_max3_f32 v232, v232, v131, v243
v_mov_b32 v243, v232
s_nop 1
v_permlane32_swap_b32 v232, v243
s_nop 1
v_max_f32 v232, v232, v243
v_mov_b32 v243, v232
s_nop 1
v_permlane16_swap_b32 v232, v243
s_nop 1
v_max_f32 v232, v232, v243
v_ceil_f32 v232, v232
v_max_f32 v232, 0, v232
v_sub_f32 v243, 0, v232
v_exp_f32 v236, v243
s_nop 1
v_mul_f32 v224, v224, v236
v_sub_f32 v192, v192, v232
v_sub_f32 v128, v128, v232
v_sub_f32 v144, v144, v232
v_sub_f32 v193, v193, v232
v_sub_f32 v129, v129, v232
v_sub_f32 v145, v145, v232
v_sub_f32 v194, v194, v232
v_sub_f32 v130, v130, v232
v_sub_f32 v146, v146, v232
v_sub_f32 v195, v195, v232
v_sub_f32 v131, v131, v232
v_sub_f32 v147, v147, v232
v_lshlrev_b32 v242, 16, v4
v_and_b32 v243, 0xffff0000, v4
v_mul_f32 v242, v242, v236
v_mul_f32 v243, v243, v236
v_cvt_pk_bf16_f32 v4, v242, v243
v_lshlrev_b32 v242, 16, v5
v_and_b32 v243, 0xffff0000, v5
v_mul_f32 v242, v242, v236
v_mul_f32 v243, v243, v236
v_cvt_pk_bf16_f32 v5, v242, v243
v_lshlrev_b32 v242, 16, v6
v_and_b32 v243, 0xffff0000, v6
v_mul_f32 v242, v242, v236
v_mul_f32 v243, v243, v236
v_cvt_pk_bf16_f32 v6, v242, v243
v_lshlrev_b32 v242, 16, v7
v_and_b32 v243, 0xffff0000, v7
v_mul_f32 v242, v242, v236
v_mul_f32 v243, v243, v236
v_cvt_pk_bf16_f32 v7, v242, v243
v_lshlrev_b32 v242, 16, v8
v_and_b32 v243, 0xffff0000, v8
v_mul_f32 v242, v242, v236
v_mul_f32 v243, v243, v236
v_cvt_pk_bf16_f32 v8, v242, v243
v_lshlrev_b32 v242, 16, v9
v_and_b32 v243, 0xffff0000, v9
v_mul_f32 v242, v242, v236
v_mul_f32 v243, v243, v236
v_cvt_pk_bf16_f32 v9, v242, v243
v_lshlrev_b32 v242, 16, v10
v_and_b32 v243, 0xffff0000, v10
v_mul_f32 v242, v242, v236
v_mul_f32 v243, v243, v236
v_cvt_pk_bf16_f32 v10, v242, v243
v_lshlrev_b32 v242, 16, v11
v_and_b32 v243, 0xffff0000, v11
v_mul_f32 v242, v242, v236
v_mul_f32 v243, v243, v236
v_cvt_pk_bf16_f32 v11, v242, v243
v_lshlrev_b32 v242, 16, v176
v_and_b32 v243, 0xffff0000, v176
v_mul_f32 v242, v242, v236
v_mul_f32 v243, v243, v236
v_cvt_pk_bf16_f32 v176, v242, v243
v_lshlrev_b32 v242, 16, v177
v_and_b32 v243, 0xffff0000, v177
v_mul_f32 v242, v242, v236
v_mul_f32 v243, v243, v236
v_cvt_pk_bf16_f32 v177, v242, v243
v_lshlrev_b32 v242, 16, v178
v_and_b32 v243, 0xffff0000, v178
v_mul_f32 v242, v242, v236
v_mul_f32 v243, v243, v236
v_cvt_pk_bf16_f32 v178, v242, v243
v_lshlrev_b32 v242, 16, v179
v_and_b32 v243, 0xffff0000, v179
v_mul_f32 v242, v242, v236
v_mul_f32 v243, v243, v236
v_cvt_pk_bf16_f32 v179, v242, v243
v_lshlrev_b32 v242, 16, v160
v_and_b32 v243, 0xffff0000, v160
v_mul_f32 v242, v242, v236
v_mul_f32 v243, v243, v236
v_cvt_pk_bf16_f32 v160, v242, v243
v_lshlrev_b32 v242, 16, v161
v_and_b32 v243, 0xffff0000, v161
v_mul_f32 v242, v242, v236
v_mul_f32 v243, v243, v236
v_cvt_pk_bf16_f32 v161, v242, v243
v_lshlrev_b32 v242, 16, v162
v_and_b32 v243, 0xffff0000, v162
v_mul_f32 v242, v242, v236
v_mul_f32 v243, v243, v236
v_cvt_pk_bf16_f32 v162, v242, v243
v_lshlrev_b32 v242, 16, v163
v_and_b32 v243, 0xffff0000, v163
v_mul_f32 v242, v242, v236
v_mul_f32 v243, v243, v236
v_cvt_pk_bf16_f32 v163, v242, v243
v_log_f32 v243, v225
v_max3_f32 v233, v132, v133, v134
v_max3_f32 v233, v233, v135, v243
v_mov_b32 v243, v233
s_nop 1
v_permlane32_swap_b32 v233, v243
s_nop 1
v_max_f32 v233, v233, v243
v_mov_b32 v243, v233
s_nop 1
v_permlane16_swap_b32 v233, v243
s_nop 1
v_max_f32 v233, v233, v243
v_ceil_f32 v233, v233
v_max_f32 v233, 0, v233
v_sub_f32 v243, 0, v233
v_exp_f32 v237, v243
s_nop 1
v_mul_f32 v225, v225, v237
v_sub_f32 v196, v196, v233
v_sub_f32 v132, v132, v233
v_sub_f32 v148, v148, v233
v_sub_f32 v197, v197, v233
v_sub_f32 v133, v133, v233
v_sub_f32 v149, v149, v233
v_sub_f32 v198, v198, v233
v_sub_f32 v134, v134, v233
v_sub_f32 v150, v150, v233
v_sub_f32 v199, v199, v233
v_sub_f32 v135, v135, v233
v_sub_f32 v151, v151, v233
v_lshlrev_b32 v242, 16, v36
v_and_b32 v243, 0xffff0000, v36
v_mul_f32 v242, v242, v237
v_mul_f32 v243, v243, v237
v_cvt_pk_bf16_f32 v36, v242, v243
v_lshlrev_b32 v242, 16, v37
v_and_b32 v243, 0xffff0000, v37
v_mul_f32 v242, v242, v237
v_mul_f32 v243, v243, v237
v_cvt_pk_bf16_f32 v37, v242, v243
v_lshlrev_b32 v242, 16, v38
v_and_b32 v243, 0xffff0000, v38
v_mul_f32 v242, v242, v237
v_mul_f32 v243, v243, v237
v_cvt_pk_bf16_f32 v38, v242, v243
v_lshlrev_b32 v242, 16, v39
v_and_b32 v243, 0xffff0000, v39
v_mul_f32 v242, v242, v237
v_mul_f32 v243, v243, v237
v_cvt_pk_bf16_f32 v39, v242, v243
v_lshlrev_b32 v242, 16, v40
v_and_b32 v243, 0xffff0000, v40
v_mul_f32 v242, v242, v237
v_mul_f32 v243, v243, v237
v_cvt_pk_bf16_f32 v40, v242, v243
v_lshlrev_b32 v242, 16, v41
v_and_b32 v243, 0xffff0000, v41
v_mul_f32 v242, v242, v237
v_mul_f32 v243, v243, v237
v_cvt_pk_bf16_f32 v41, v242, v243
v_lshlrev_b32 v242, 16, v42
v_and_b32 v243, 0xffff0000, v42
v_mul_f32 v242, v242, v237
v_mul_f32 v243, v243, v237
v_cvt_pk_bf16_f32 v42, v242, v243
v_lshlrev_b32 v242, 16, v43
v_and_b32 v243, 0xffff0000, v43
v_mul_f32 v242, v242, v237
v_mul_f32 v243, v243, v237
v_cvt_pk_bf16_f32 v43, v242, v243
v_lshlrev_b32 v242, 16, v180
v_and_b32 v243, 0xffff0000, v180
v_mul_f32 v242, v242, v237
v_mul_f32 v243, v243, v237
v_cvt_pk_bf16_f32 v180, v242, v243
v_lshlrev_b32 v242, 16, v181
v_and_b32 v243, 0xffff0000, v181
v_mul_f32 v242, v242, v237
v_mul_f32 v243, v243, v237
v_cvt_pk_bf16_f32 v181, v242, v243
v_lshlrev_b32 v242, 16, v182
v_and_b32 v243, 0xffff0000, v182
v_mul_f32 v242, v242, v237
v_mul_f32 v243, v243, v237
v_cvt_pk_bf16_f32 v182, v242, v243
v_lshlrev_b32 v242, 16, v183
v_and_b32 v243, 0xffff0000, v183
v_mul_f32 v242, v242, v237
v_mul_f32 v243, v243, v237
v_cvt_pk_bf16_f32 v183, v242, v243
v_lshlrev_b32 v242, 16, v164
v_and_b32 v243, 0xffff0000, v164
v_mul_f32 v242, v242, v237
v_mul_f32 v243, v243, v237
v_cvt_pk_bf16_f32 v164, v242, v243
v_lshlrev_b32 v242, 16, v165
v_and_b32 v243, 0xffff0000, v165
v_mul_f32 v242, v242, v237
v_mul_f32 v243, v243, v237
v_cvt_pk_bf16_f32 v165, v242, v243
v_lshlrev_b32 v242, 16, v166
v_and_b32 v243, 0xffff0000, v166
v_mul_f32 v242, v242, v237
v_mul_f32 v243, v243, v237
v_cvt_pk_bf16_f32 v166, v242, v243
v_lshlrev_b32 v242, 16, v167
v_and_b32 v243, 0xffff0000, v167
v_mul_f32 v242, v242, v237
v_mul_f32 v243, v243, v237
v_cvt_pk_bf16_f32 v167, v242, v243
v_log_f32 v243, v226
v_max3_f32 v234, v136, v137, v138
v_max3_f32 v234, v234, v139, v243
v_mov_b32 v243, v234
s_nop 1
v_permlane32_swap_b32 v234, v243
s_nop 1
v_max_f32 v234, v234, v243
v_mov_b32 v243, v234
s_nop 1
v_permlane16_swap_b32 v234, v243
s_nop 1
v_max_f32 v234, v234, v243
v_ceil_f32 v234, v234
v_max_f32 v234, 0, v234
v_sub_f32 v243, 0, v234
v_exp_f32 v238, v243
s_nop 1
v_mul_f32 v226, v226, v238
v_sub_f32 v200, v200, v234
v_sub_f32 v136, v136, v234
v_sub_f32 v152, v152, v234
v_sub_f32 v201, v201, v234
v_sub_f32 v137, v137, v234
v_sub_f32 v153, v153, v234
v_sub_f32 v202, v202, v234
v_sub_f32 v138, v138, v234
v_sub_f32 v154, v154, v234
v_sub_f32 v203, v203, v234
v_sub_f32 v139, v139, v234
v_sub_f32 v155, v155, v234
v_lshlrev_b32 v242, 16, v68
v_and_b32 v243, 0xffff0000, v68
v_mul_f32 v242, v242, v238
v_mul_f32 v243, v243, v238
v_cvt_pk_bf16_f32 v68, v242, v243
v_lshlrev_b32 v242, 16, v69
v_and_b32 v243, 0xffff0000, v69
v_mul_f32 v242, v242, v238
v_mul_f32 v243, v243, v238
v_cvt_pk_bf16_f32 v69, v242, v243
v_lshlrev_b32 v242, 16, v70
v_and_b32 v243, 0xffff0000, v70
v_mul_f32 v242, v242, v238
v_mul_f32 v243, v243, v238
v_cvt_pk_bf16_f32 v70, v242, v243
v_lshlrev_b32 v242, 16, v71
v_and_b32 v243, 0xffff0000, v71
v_mul_f32 v242, v242, v238
v_mul_f32 v243, v243, v238
v_cvt_pk_bf16_f32 v71, v242, v243
v_lshlrev_b32 v242, 16, v72
v_and_b32 v243, 0xffff0000, v72
v_mul_f32 v242, v242, v238
v_mul_f32 v243, v243, v238
v_cvt_pk_bf16_f32 v72, v242, v243
v_lshlrev_b32 v242, 16, v73
v_and_b32 v243, 0xffff0000, v73
v_mul_f32 v242, v242, v238
v_mul_f32 v243, v243, v238
v_cvt_pk_bf16_f32 v73, v242, v243
v_lshlrev_b32 v242, 16, v74
v_and_b32 v243, 0xffff0000, v74
v_mul_f32 v242, v242, v238
v_mul_f32 v243, v243, v238
v_cvt_pk_bf16_f32 v74, v242, v243
v_lshlrev_b32 v242, 16, v75
v_and_b32 v243, 0xffff0000, v75
v_mul_f32 v242, v242, v238
v_mul_f32 v243, v243, v238
v_cvt_pk_bf16_f32 v75, v242, v243
v_lshlrev_b32 v242, 16, v184
v_and_b32 v243, 0xffff0000, v184
v_mul_f32 v242, v242, v238
v_mul_f32 v243, v243, v238
v_cvt_pk_bf16_f32 v184, v242, v243
v_lshlrev_b32 v242, 16, v185
v_and_b32 v243, 0xffff0000, v185
v_mul_f32 v242, v242, v238
v_mul_f32 v243, v243, v238
v_cvt_pk_bf16_f32 v185, v242, v243
v_lshlrev_b32 v242, 16, v186
v_and_b32 v243, 0xffff0000, v186
v_mul_f32 v242, v242, v238
v_mul_f32 v243, v243, v238
v_cvt_pk_bf16_f32 v186, v242, v243
v_lshlrev_b32 v242, 16, v187
v_and_b32 v243, 0xffff0000, v187
v_mul_f32 v242, v242, v238
v_mul_f32 v243, v243, v238
v_cvt_pk_bf16_f32 v187, v242, v243
v_lshlrev_b32 v242, 16, v168
v_and_b32 v243, 0xffff0000, v168
v_mul_f32 v242, v242, v238
v_mul_f32 v243, v243, v238
v_cvt_pk_bf16_f32 v168, v242, v243
v_lshlrev_b32 v242, 16, v169
v_and_b32 v243, 0xffff0000, v169
v_mul_f32 v242, v242, v238
v_mul_f32 v243, v243, v238
v_cvt_pk_bf16_f32 v169, v242, v243
v_lshlrev_b32 v242, 16, v170
v_and_b32 v243, 0xffff0000, v170
v_mul_f32 v242, v242, v238
v_mul_f32 v243, v243, v238
v_cvt_pk_bf16_f32 v170, v242, v243
v_lshlrev_b32 v242, 16, v171
v_and_b32 v243, 0xffff0000, v171
v_mul_f32 v242, v242, v238
v_mul_f32 v243, v243, v238
v_cvt_pk_bf16_f32 v171, v242, v243
v_log_f32 v243, v227
v_max3_f32 v235, v140, v141, v142
v_max3_f32 v235, v235, v143, v243
v_mov_b32 v243, v235
s_nop 1
v_permlane32_swap_b32 v235, v243
s_nop 1
v_max_f32 v235, v235, v243
v_mov_b32 v243, v235
s_nop 1
v_permlane16_swap_b32 v235, v243
s_nop 1
v_max_f32 v235, v235, v243
v_ceil_f32 v235, v235
v_max_f32 v235, 0, v235
v_sub_f32 v243, 0, v235
v_exp_f32 v239, v243
s_nop 1
v_mul_f32 v227, v227, v239
v_sub_f32 v204, v204, v235
v_sub_f32 v140, v140, v235
v_sub_f32 v156, v156, v235
v_sub_f32 v205, v205, v235
v_sub_f32 v141, v141, v235
v_sub_f32 v157, v157, v235
v_sub_f32 v206, v206, v235
v_sub_f32 v142, v142, v235
v_sub_f32 v158, v158, v235
v_sub_f32 v207, v207, v235
v_sub_f32 v143, v143, v235
v_sub_f32 v159, v159, v235
v_lshlrev_b32 v242, 16, v100
v_and_b32 v243, 0xffff0000, v100
v_mul_f32 v242, v242, v239
v_mul_f32 v243, v243, v239
v_cvt_pk_bf16_f32 v100, v242, v243
v_lshlrev_b32 v242, 16, v101
v_and_b32 v243, 0xffff0000, v101
v_mul_f32 v242, v242, v239
v_mul_f32 v243, v243, v239
v_cvt_pk_bf16_f32 v101, v242, v243
v_lshlrev_b32 v242, 16, v102
v_and_b32 v243, 0xffff0000, v102
v_mul_f32 v242, v242, v239
v_mul_f32 v243, v243, v239
v_cvt_pk_bf16_f32 v102, v242, v243
v_lshlrev_b32 v242, 16, v103
v_and_b32 v243, 0xffff0000, v103
v_mul_f32 v242, v242, v239
v_mul_f32 v243, v243, v239
v_cvt_pk_bf16_f32 v103, v242, v243
v_lshlrev_b32 v242, 16, v104
v_and_b32 v243, 0xffff0000, v104
v_mul_f32 v242, v242, v239
v_mul_f32 v243, v243, v239
v_cvt_pk_bf16_f32 v104, v242, v243
v_lshlrev_b32 v242, 16, v105
v_and_b32 v243, 0xffff0000, v105
v_mul_f32 v242, v242, v239
v_mul_f32 v243, v243, v239
v_cvt_pk_bf16_f32 v105, v242, v243
v_lshlrev_b32 v242, 16, v106
v_and_b32 v243, 0xffff0000, v106
v_mul_f32 v242, v242, v239
v_mul_f32 v243, v243, v239
v_cvt_pk_bf16_f32 v106, v242, v243
v_lshlrev_b32 v242, 16, v107
v_and_b32 v243, 0xffff0000, v107
v_mul_f32 v242, v242, v239
v_mul_f32 v243, v243, v239
v_cvt_pk_bf16_f32 v107, v242, v243
v_lshlrev_b32 v242, 16, v188
v_and_b32 v243, 0xffff0000, v188
v_mul_f32 v242, v242, v239
v_mul_f32 v243, v243, v239
v_cvt_pk_bf16_f32 v188, v242, v243
v_lshlrev_b32 v242, 16, v189
v_and_b32 v243, 0xffff0000, v189
v_mul_f32 v242, v242, v239
v_mul_f32 v243, v243, v239
v_cvt_pk_bf16_f32 v189, v242, v243
v_lshlrev_b32 v242, 16, v190
v_and_b32 v243, 0xffff0000, v190
v_mul_f32 v242, v242, v239
v_mul_f32 v243, v243, v239
v_cvt_pk_bf16_f32 v190, v242, v243
v_lshlrev_b32 v242, 16, v191
v_and_b32 v243, 0xffff0000, v191
v_mul_f32 v242, v242, v239
v_mul_f32 v243, v243, v239
v_cvt_pk_bf16_f32 v191, v242, v243
v_lshlrev_b32 v242, 16, v172
v_and_b32 v243, 0xffff0000, v172
v_mul_f32 v242, v242, v239
v_mul_f32 v243, v243, v239
v_cvt_pk_bf16_f32 v172, v242, v243
v_lshlrev_b32 v242, 16, v173
v_and_b32 v243, 0xffff0000, v173
v_mul_f32 v242, v242, v239
v_mul_f32 v243, v243, v239
v_cvt_pk_bf16_f32 v173, v242, v243
v_lshlrev_b32 v242, 16, v174
v_and_b32 v243, 0xffff0000, v174
v_mul_f32 v242, v242, v239
v_mul_f32 v243, v243, v239
v_cvt_pk_bf16_f32 v174, v242, v243
v_lshlrev_b32 v242, 16, v175
v_and_b32 v243, 0xffff0000, v175
v_mul_f32 v242, v242, v239
v_mul_f32 v243, v243, v239
v_cvt_pk_bf16_f32 v175, v242, v243
v_exp_f32 v232, v128
v_exp_f32 v233, v129
v_exp_f32 v234, v130
v_exp_f32 v235, v131
s_nop 1
v_add_f32 v228, v224, v232
v_add_f32 v228, v228, v233
v_add_f32 v228, v228, v234
v_add_f32 v228, v228, v235
v_cvt_pk_bf16_f32 v0, v232, v233
v_cvt_pk_bf16_f32 v1, v234, v235
v_exp_f32 v232, v132
v_exp_f32 v233, v133
v_exp_f32 v234, v134
v_exp_f32 v235, v135
s_nop 1
v_add_f32 v229, v225, v232
v_add_f32 v229, v229, v233
v_add_f32 v229, v229, v234
v_add_f32 v229, v229, v235
v_cvt_pk_bf16_f32 v32, v232, v233
v_cvt_pk_bf16_f32 v33, v234, v235
v_exp_f32 v232, v136
v_exp_f32 v233, v137
v_exp_f32 v234, v138
v_exp_f32 v235, v139
s_nop 1
v_add_f32 v230, v226, v232
v_add_f32 v230, v230, v233
v_add_f32 v230, v230, v234
v_add_f32 v230, v230, v235
v_cvt_pk_bf16_f32 v64, v232, v233
v_cvt_pk_bf16_f32 v65, v234, v235
v_exp_f32 v232, v140
v_exp_f32 v233, v141
v_exp_f32 v234, v142
v_exp_f32 v235, v143
s_nop 1
v_add_f32 v231, v227, v232
v_add_f32 v231, v231, v233
v_add_f32 v231, v231, v234
v_add_f32 v231, v231, v235
v_cvt_pk_bf16_f32 v96, v232, v233
v_cvt_pk_bf16_f32 v97, v234, v235
s_branch L2_rare_common
L2_rare_site11:
s_mov_b32 s36, 11
s_branch L2_rare_t1_5_1
L2_rare_t1_5_1:
s_nop 15
s_nop 15
s_waitcnt lgkmcnt(0)
v_log_f32 v243, v228
v_max3_f32 v232, v144, v145, v146
v_max3_f32 v232, v232, v147, v243
v_mov_b32 v243, v232
s_nop 1
v_permlane32_swap_b32 v232, v243
s_nop 1
v_max_f32 v232, v232, v243
v_mov_b32 v243, v232
s_nop 1
v_permlane16_swap_b32 v232, v243
s_nop 1
v_max_f32 v232, v232, v243
v_ceil_f32 v232, v232
v_max_f32 v232, 0, v232
v_sub_f32 v243, 0, v232
v_exp_f32 v236, v243
s_nop 1
v_mul_f32 v228, v228, v236
v_sub_f32 v192, v192, v232
v_sub_f32 v128, v128, v232
v_sub_f32 v144, v144, v232
v_sub_f32 v193, v193, v232
v_sub_f32 v129, v129, v232
v_sub_f32 v145, v145, v232
v_sub_f32 v194, v194, v232
v_sub_f32 v130, v130, v232
v_sub_f32 v146, v146, v232
v_sub_f32 v195, v195, v232
v_sub_f32 v131, v131, v232
v_sub_f32 v147, v147, v232
v_lshlrev_b32 v242, 16, v4
v_and_b32 v243, 0xffff0000, v4
v_mul_f32 v242, v242, v236
v_mul_f32 v243, v243, v236
v_cvt_pk_bf16_f32 v4, v242, v243
v_lshlrev_b32 v242, 16, v5
v_and_b32 v243, 0xffff0000, v5
v_mul_f32 v242, v242, v236
v_mul_f32 v243, v243, v236
v_cvt_pk_bf16_f32 v5, v242, v243
v_lshlrev_b32 v242, 16, v6
v_and_b32 v243, 0xffff0000, v6
v_mul_f32 v242, v242, v236
v_mul_f32 v243, v243, v236
v_cvt_pk_bf16_f32 v6, v242, v243
v_lshlrev_b32 v242, 16, v7
v_and_b32 v243, 0xffff0000, v7
v_mul_f32 v242, v242, v236
v_mul_f32 v243, v243, v236
v_cvt_pk_bf16_f32 v7, v242, v243
v_lshlrev_b32 v242, 16, v8
v_and_b32 v243, 0xffff0000, v8
v_mul_f32 v242, v242, v236
v_mul_f32 v243, v243, v236
v_cvt_pk_bf16_f32 v8, v242, v243
v_lshlrev_b32 v242, 16, v9
v_and_b32 v243, 0xffff0000, v9
v_mul_f32 v242, v242, v236
v_mul_f32 v243, v243, v236
v_cvt_pk_bf16_f32 v9, v242, v243
v_lshlrev_b32 v242, 16, v10
v_and_b32 v243, 0xffff0000, v10
v_mul_f32 v242, v242, v236
v_mul_f32 v243, v243, v236
v_cvt_pk_bf16_f32 v10, v242, v243
v_lshlrev_b32 v242, 16, v11
v_and_b32 v243, 0xffff0000, v11
v_mul_f32 v242, v242, v236
v_mul_f32 v243, v243, v236
v_cvt_pk_bf16_f32 v11, v242, v243
v_lshlrev_b32 v242, 16, v176
v_and_b32 v243, 0xffff0000, v176
v_mul_f32 v242, v242, v236
v_mul_f32 v243, v243, v236
v_cvt_pk_bf16_f32 v176, v242, v243
v_lshlrev_b32 v242, 16, v177
v_and_b32 v243, 0xffff0000, v177
v_mul_f32 v242, v242, v236
v_mul_f32 v243, v243, v236
v_cvt_pk_bf16_f32 v177, v242, v243
v_lshlrev_b32 v242, 16, v178
v_and_b32 v243, 0xffff0000, v178
v_mul_f32 v242, v242, v236
v_mul_f32 v243, v243, v236
v_cvt_pk_bf16_f32 v178, v242, v243
v_lshlrev_b32 v242, 16, v179
v_and_b32 v243, 0xffff0000, v179
v_mul_f32 v242, v242, v236
v_mul_f32 v243, v243, v236
v_cvt_pk_bf16_f32 v179, v242, v243
v_lshlrev_b32 v242, 16, v160
v_and_b32 v243, 0xffff0000, v160
v_mul_f32 v242, v242, v236
v_mul_f32 v243, v243, v236
v_cvt_pk_bf16_f32 v160, v242, v243
v_lshlrev_b32 v242, 16, v161
v_and_b32 v243, 0xffff0000, v161
v_mul_f32 v242, v242, v236
v_mul_f32 v243, v243, v236
v_cvt_pk_bf16_f32 v161, v242, v243
v_lshlrev_b32 v242, 16, v162
v_and_b32 v243, 0xffff0000, v162
v_mul_f32 v242, v242, v236
v_mul_f32 v243, v243, v236
v_cvt_pk_bf16_f32 v162, v242, v243
v_lshlrev_b32 v242, 16, v163
v_and_b32 v243, 0xffff0000, v163
v_mul_f32 v242, v242, v236
v_mul_f32 v243, v243, v236
v_cvt_pk_bf16_f32 v163, v242, v243
v_lshlrev_b32 v242, 16, v0
v_and_b32 v243, 0xffff0000, v0
v_mul_f32 v242, v242, v236
v_mul_f32 v243, v243, v236
v_cvt_pk_bf16_f32 v0, v242, v243
v_lshlrev_b32 v242, 16, v1
v_and_b32 v243, 0xffff0000, v1
v_mul_f32 v242, v242, v236
v_mul_f32 v243, v243, v236
v_cvt_pk_bf16_f32 v1, v242, v243
v_log_f32 v243, v229
v_max3_f32 v233, v148, v149, v150
v_max3_f32 v233, v233, v151, v243
v_mov_b32 v243, v233
s_nop 1
v_permlane32_swap_b32 v233, v243
s_nop 1
v_max_f32 v233, v233, v243
v_mov_b32 v243, v233
s_nop 1
v_permlane16_swap_b32 v233, v243
s_nop 1
v_max_f32 v233, v233, v243
v_ceil_f32 v233, v233
v_max_f32 v233, 0, v233
v_sub_f32 v243, 0, v233
v_exp_f32 v237, v243
s_nop 1
v_mul_f32 v229, v229, v237
v_sub_f32 v196, v196, v233
v_sub_f32 v132, v132, v233
v_sub_f32 v148, v148, v233
v_sub_f32 v197, v197, v233
v_sub_f32 v133, v133, v233
v_sub_f32 v149, v149, v233
v_sub_f32 v198, v198, v233
v_sub_f32 v134, v134, v233
v_sub_f32 v150, v150, v233
v_sub_f32 v199, v199, v233
v_sub_f32 v135, v135, v233
v_sub_f32 v151, v151, v233
v_lshlrev_b32 v242, 16, v36
v_and_b32 v243, 0xffff0000, v36
v_mul_f32 v242, v242, v237
v_mul_f32 v243, v243, v237
v_cvt_pk_bf16_f32 v36, v242, v243
v_lshlrev_b32 v242, 16, v37
v_and_b32 v243, 0xffff0000, v37
v_mul_f32 v242, v242, v237
v_mul_f32 v243, v243, v237
v_cvt_pk_bf16_f32 v37, v242, v243
v_lshlrev_b32 v242, 16, v38
v_and_b32 v243, 0xffff0000, v38
v_mul_f32 v242, v242, v237
v_mul_f32 v243, v243, v237
v_cvt_pk_bf16_f32 v38, v242, v243
v_lshlrev_b32 v242, 16, v39
v_and_b32 v243, 0xffff0000, v39
v_mul_f32 v242, v242, v237
v_mul_f32 v243, v243, v237
v_cvt_pk_bf16_f32 v39, v242, v243
v_lshlrev_b32 v242, 16, v40
v_and_b32 v243, 0xffff0000, v40
v_mul_f32 v242, v242, v237
v_mul_f32 v243, v243, v237
v_cvt_pk_bf16_f32 v40, v242, v243
v_lshlrev_b32 v242, 16, v41
v_and_b32 v243, 0xffff0000, v41
v_mul_f32 v242, v242, v237
v_mul_f32 v243, v243, v237
v_cvt_pk_bf16_f32 v41, v242, v243
v_lshlrev_b32 v242, 16, v42
v_and_b32 v243, 0xffff0000, v42
v_mul_f32 v242, v242, v237
v_mul_f32 v243, v243, v237
v_cvt_pk_bf16_f32 v42, v242, v243
v_lshlrev_b32 v242, 16, v43
v_and_b32 v243, 0xffff0000, v43
v_mul_f32 v242, v242, v237
v_mul_f32 v243, v243, v237
v_cvt_pk_bf16_f32 v43, v242, v243
v_lshlrev_b32 v242, 16, v180
v_and_b32 v243, 0xffff0000, v180
v_mul_f32 v242, v242, v237
v_mul_f32 v243, v243, v237
v_cvt_pk_bf16_f32 v180, v242, v243
v_lshlrev_b32 v242, 16, v181
v_and_b32 v243, 0xffff0000, v181
v_mul_f32 v242, v242, v237
v_mul_f32 v243, v243, v237
v_cvt_pk_bf16_f32 v181, v242, v243
v_lshlrev_b32 v242, 16, v182
v_and_b32 v243, 0xffff0000, v182
v_mul_f32 v242, v242, v237
v_mul_f32 v243, v243, v237
v_cvt_pk_bf16_f32 v182, v242, v243
v_lshlrev_b32 v242, 16, v183
v_and_b32 v243, 0xffff0000, v183
v_mul_f32 v242, v242, v237
v_mul_f32 v243, v243, v237
v_cvt_pk_bf16_f32 v183, v242, v243
v_lshlrev_b32 v242, 16, v164
v_and_b32 v243, 0xffff0000, v164
v_mul_f32 v242, v242, v237
v_mul_f32 v243, v243, v237
v_cvt_pk_bf16_f32 v164, v242, v243
v_lshlrev_b32 v242, 16, v165
v_and_b32 v243, 0xffff0000, v165
v_mul_f32 v242, v242, v237
v_mul_f32 v243, v243, v237
v_cvt_pk_bf16_f32 v165, v242, v243
v_lshlrev_b32 v242, 16, v166
v_and_b32 v243, 0xffff0000, v166
v_mul_f32 v242, v242, v237
v_mul_f32 v243, v243, v237
v_cvt_pk_bf16_f32 v166, v242, v243
v_lshlrev_b32 v242, 16, v167
v_and_b32 v243, 0xffff0000, v167
v_mul_f32 v242, v242, v237
v_mul_f32 v243, v243, v237
v_cvt_pk_bf16_f32 v167, v242, v243
v_lshlrev_b32 v242, 16, v32
v_and_b32 v243, 0xffff0000, v32
v_mul_f32 v242, v242, v237
v_mul_f32 v243, v243, v237
v_cvt_pk_bf16_f32 v32, v242, v243
v_lshlrev_b32 v242, 16, v33
v_and_b32 v243, 0xffff0000, v33
v_mul_f32 v242, v242, v237
v_mul_f32 v243, v243, v237
v_cvt_pk_bf16_f32 v33, v242, v243
v_log_f32 v243, v230
v_max3_f32 v234, v152, v153, v154
v_max3_f32 v234, v234, v155, v243
v_mov_b32 v243, v234
s_nop 1
v_permlane32_swap_b32 v234, v243
s_nop 1
v_max_f32 v234, v234, v243
v_mov_b32 v243, v234
s_nop 1
v_permlane16_swap_b32 v234, v243
s_nop 1
v_max_f32 v234, v234, v243
v_ceil_f32 v234, v234
v_max_f32 v234, 0, v234
v_sub_f32 v243, 0, v234
v_exp_f32 v238, v243
s_nop 1
v_mul_f32 v230, v230, v238
v_sub_f32 v200, v200, v234
v_sub_f32 v136, v136, v234
v_sub_f32 v152, v152, v234
v_sub_f32 v201, v201, v234
v_sub_f32 v137, v137, v234
v_sub_f32 v153, v153, v234
v_sub_f32 v202, v202, v234
v_sub_f32 v138, v138, v234
v_sub_f32 v154, v154, v234
v_sub_f32 v203, v203, v234
v_sub_f32 v139, v139, v234
v_sub_f32 v155, v155, v234
v_lshlrev_b32 v242, 16, v68
v_and_b32 v243, 0xffff0000, v68
v_mul_f32 v242, v242, v238
v_mul_f32 v243, v243, v238
v_cvt_pk_bf16_f32 v68, v242, v243
v_lshlrev_b32 v242, 16, v69
v_and_b32 v243, 0xffff0000, v69
v_mul_f32 v242, v242, v238
v_mul_f32 v243, v243, v238
v_cvt_pk_bf16_f32 v69, v242, v243
v_lshlrev_b32 v242, 16, v70
v_and_b32 v243, 0xffff0000, v70
v_mul_f32 v242, v242, v238
v_mul_f32 v243, v243, v238
v_cvt_pk_bf16_f32 v70, v242, v243
v_lshlrev_b32 v242, 16, v71
v_and_b32 v243, 0xffff0000, v71
v_mul_f32 v242, v242, v238
v_mul_f32 v243, v243, v238
v_cvt_pk_bf16_f32 v71, v242, v243
v_lshlrev_b32 v242, 16, v72
v_and_b32 v243, 0xffff0000, v72
v_mul_f32 v242, v242, v238
v_mul_f32 v243, v243, v238
v_cvt_pk_bf16_f32 v72, v242, v243
v_lshlrev_b32 v242, 16, v73
v_and_b32 v243, 0xffff0000, v73
v_mul_f32 v242, v242, v238
v_mul_f32 v243, v243, v238
v_cvt_pk_bf16_f32 v73, v242, v243
v_lshlrev_b32 v242, 16, v74
v_and_b32 v243, 0xffff0000, v74
v_mul_f32 v242, v242, v238
v_mul_f32 v243, v243, v238
v_cvt_pk_bf16_f32 v74, v242, v243
v_lshlrev_b32 v242, 16, v75
v_and_b32 v243, 0xffff0000, v75
v_mul_f32 v242, v242, v238
v_mul_f32 v243, v243, v238
v_cvt_pk_bf16_f32 v75, v242, v243
v_lshlrev_b32 v242, 16, v184
v_and_b32 v243, 0xffff0000, v184
v_mul_f32 v242, v242, v238
v_mul_f32 v243, v243, v238
v_cvt_pk_bf16_f32 v184, v242, v243
v_lshlrev_b32 v242, 16, v185
v_and_b32 v243, 0xffff0000, v185
v_mul_f32 v242, v242, v238
v_mul_f32 v243, v243, v238
v_cvt_pk_bf16_f32 v185, v242, v243
v_lshlrev_b32 v242, 16, v186
v_and_b32 v243, 0xffff0000, v186
v_mul_f32 v242, v242, v238
v_mul_f32 v243, v243, v238
v_cvt_pk_bf16_f32 v186, v242, v243
v_lshlrev_b32 v242, 16, v187
v_and_b32 v243, 0xffff0000, v187
v_mul_f32 v242, v242, v238
v_mul_f32 v243, v243, v238
v_cvt_pk_bf16_f32 v187, v242, v243
v_lshlrev_b32 v242, 16, v168
v_and_b32 v243, 0xffff0000, v168
v_mul_f32 v242, v242, v238
v_mul_f32 v243, v243, v238
v_cvt_pk_bf16_f32 v168, v242, v243
v_lshlrev_b32 v242, 16, v169
v_and_b32 v243, 0xffff0000, v169
v_mul_f32 v242, v242, v238
v_mul_f32 v243, v243, v238
v_cvt_pk_bf16_f32 v169, v242, v243
v_lshlrev_b32 v242, 16, v170
v_and_b32 v243, 0xffff0000, v170
v_mul_f32 v242, v242, v238
v_mul_f32 v243, v243, v238
v_cvt_pk_bf16_f32 v170, v242, v243
v_lshlrev_b32 v242, 16, v171
v_and_b32 v243, 0xffff0000, v171
v_mul_f32 v242, v242, v238
v_mul_f32 v243, v243, v238
v_cvt_pk_bf16_f32 v171, v242, v243
v_lshlrev_b32 v242, 16, v64
v_and_b32 v243, 0xffff0000, v64
v_mul_f32 v242, v242, v238
v_mul_f32 v243, v243, v238
v_cvt_pk_bf16_f32 v64, v242, v243
v_lshlrev_b32 v242, 16, v65
v_and_b32 v243, 0xffff0000, v65
v_mul_f32 v242, v242, v238
v_mul_f32 v243, v243, v238
v_cvt_pk_bf16_f32 v65, v242, v243
v_log_f32 v243, v231
v_max3_f32 v235, v156, v157, v158
v_max3_f32 v235, v235, v159, v243
v_mov_b32 v243, v235
s_nop 1
v_permlane32_swap_b32 v235, v243
s_nop 1
v_max_f32 v235, v235, v243
v_mov_b32 v243, v235
s_nop 1
v_permlane16_swap_b32 v235, v243
s_nop 1
v_max_f32 v235, v235, v243
v_ceil_f32 v235, v235
v_max_f32 v235, 0, v235
v_sub_f32 v243, 0, v235
v_exp_f32 v239, v243
s_nop 1
v_mul_f32 v231, v231, v239
v_sub_f32 v204, v204, v235
v_sub_f32 v140, v140, v235
v_sub_f32 v156, v156, v235
v_sub_f32 v205, v205, v235
v_sub_f32 v141, v141, v235
v_sub_f32 v157, v157, v235
v_sub_f32 v206, v206, v235
v_sub_f32 v142, v142, v235
v_sub_f32 v158, v158, v235
v_sub_f32 v207, v207, v235
v_sub_f32 v143, v143, v235
v_sub_f32 v159, v159, v235
v_lshlrev_b32 v242, 16, v100
v_and_b32 v243, 0xffff0000, v100
v_mul_f32 v242, v242, v239
v_mul_f32 v243, v243, v239
v_cvt_pk_bf16_f32 v100, v242, v243
v_lshlrev_b32 v242, 16, v101
v_and_b32 v243, 0xffff0000, v101
v_mul_f32 v242, v242, v239
v_mul_f32 v243, v243, v239
v_cvt_pk_bf16_f32 v101, v242, v243
v_lshlrev_b32 v242, 16, v102
v_and_b32 v243, 0xffff0000, v102
v_mul_f32 v242, v242, v239
v_mul_f32 v243, v243, v239
v_cvt_pk_bf16_f32 v102, v242, v243
v_lshlrev_b32 v242, 16, v103
v_and_b32 v243, 0xffff0000, v103
v_mul_f32 v242, v242, v239
v_mul_f32 v243, v243, v239
v_cvt_pk_bf16_f32 v103, v242, v243
v_lshlrev_b32 v242, 16, v104
v_and_b32 v243, 0xffff0000, v104
v_mul_f32 v242, v242, v239
v_mul_f32 v243, v243, v239
v_cvt_pk_bf16_f32 v104, v242, v243
v_lshlrev_b32 v242, 16, v105
v_and_b32 v243, 0xffff0000, v105
v_mul_f32 v242, v242, v239
v_mul_f32 v243, v243, v239
v_cvt_pk_bf16_f32 v105, v242, v243
v_lshlrev_b32 v242, 16, v106
v_and_b32 v243, 0xffff0000, v106
v_mul_f32 v242, v242, v239
v_mul_f32 v243, v243, v239
v_cvt_pk_bf16_f32 v106, v242, v243
v_lshlrev_b32 v242, 16, v107
v_and_b32 v243, 0xffff0000, v107
v_mul_f32 v242, v242, v239
v_mul_f32 v243, v243, v239
v_cvt_pk_bf16_f32 v107, v242, v243
v_lshlrev_b32 v242, 16, v188
v_and_b32 v243, 0xffff0000, v188
v_mul_f32 v242, v242, v239
v_mul_f32 v243, v243, v239
v_cvt_pk_bf16_f32 v188, v242, v243
v_lshlrev_b32 v242, 16, v189
v_and_b32 v243, 0xffff0000, v189
v_mul_f32 v242, v242, v239
v_mul_f32 v243, v243, v239
v_cvt_pk_bf16_f32 v189, v242, v243
v_lshlrev_b32 v242, 16, v190
v_and_b32 v243, 0xffff0000, v190
v_mul_f32 v242, v242, v239
v_mul_f32 v243, v243, v239
v_cvt_pk_bf16_f32 v190, v242, v243
v_lshlrev_b32 v242, 16, v191
v_and_b32 v243, 0xffff0000, v191
v_mul_f32 v242, v242, v239
v_mul_f32 v243, v243, v239
v_cvt_pk_bf16_f32 v191, v242, v243
v_lshlrev_b32 v242, 16, v172
v_and_b32 v243, 0xffff0000, v172
v_mul_f32 v242, v242, v239
v_mul_f32 v243, v243, v239
v_cvt_pk_bf16_f32 v172, v242, v243
v_lshlrev_b32 v242, 16, v173
v_and_b32 v243, 0xffff0000, v173
v_mul_f32 v242, v242, v239
v_mul_f32 v243, v243, v239
v_cvt_pk_bf16_f32 v173, v242, v243
v_lshlrev_b32 v242, 16, v174
v_and_b32 v243, 0xffff0000, v174
v_mul_f32 v242, v242, v239
v_mul_f32 v243, v243, v239
v_cvt_pk_bf16_f32 v174, v242, v243
v_lshlrev_b32 v242, 16, v175
v_and_b32 v243, 0xffff0000, v175
v_mul_f32 v242, v242, v239
v_mul_f32 v243, v243, v239
v_cvt_pk_bf16_f32 v175, v242, v243
v_lshlrev_b32 v242, 16, v96
v_and_b32 v243, 0xffff0000, v96
v_mul_f32 v242, v242, v239
v_mul_f32 v243, v243, v239
v_cvt_pk_bf16_f32 v96, v242, v243
v_lshlrev_b32 v242, 16, v97
v_and_b32 v243, 0xffff0000, v97
v_mul_f32 v242, v242, v239
v_mul_f32 v243, v243, v239
v_cvt_pk_bf16_f32 v97, v242, v243
v_exp_f32 v232, v144
v_exp_f32 v233, v145
v_exp_f32 v234, v146
v_exp_f32 v235, v147
s_nop 1
v_add_f32 v224, v228, v232
v_add_f32 v224, v224, v233
v_add_f32 v224, v224, v234
v_add_f32 v224, v224, v235
v_cvt_pk_bf16_f32 v2, v232, v233
v_cvt_pk_bf16_f32 v3, v234, v235
v_exp_f32 v232, v148
v_exp_f32 v233, v149
v_exp_f32 v234, v150
v_exp_f32 v235, v151
s_nop 1
v_add_f32 v225, v229, v232
v_add_f32 v225, v225, v233
v_add_f32 v225, v225, v234
v_add_f32 v225, v225, v235
v_cvt_pk_bf16_f32 v34, v232, v233
v_cvt_pk_bf16_f32 v35, v234, v235
v_exp_f32 v232, v152
v_exp_f32 v233, v153
v_exp_f32 v234, v154
v_exp_f32 v235, v155
s_nop 1
v_add_f32 v226, v230, v232
v_add_f32 v226, v226, v233
v_add_f32 v226, v226, v234
v_add_f32 v226, v226, v235
v_cvt_pk_bf16_f32 v66, v232, v233
v_cvt_pk_bf16_f32 v67, v234, v235
v_exp_f32 v232, v156
v_exp_f32 v233, v157
v_exp_f32 v234, v158
v_exp_f32 v235, v159
s_nop 1
v_add_f32 v227, v231, v232
v_add_f32 v227, v227, v233
v_add_f32 v227, v227, v234
v_add_f32 v227, v227, v235
v_cvt_pk_bf16_f32 v98, v232, v233
v_cvt_pk_bf16_f32 v99, v234, v235
s_branch L2_rare_common
LF_hl_1:
s_mov_b32 s94, 0x10000
s_mov_b32 s3, 0x7c28000
LF_hl2_1:
v_lshlrev_b32 v241, 3, v248
buffer_load_dwordx2 v[240:241], v241, s[16:19], s3 offen sc1
s_sub_u32 s94, s94, 1
s_waitcnt vmcnt(0)
s_cbranch_scc1 LF_hlret_1
v_cmp_ne_u64_e64 s[38:39], s[98:99], v[240:241]
s_and_b64 s[38:39], s[38:39], s[96:97]
s_cbranch_scc1 LF_hl2_1
s_branch LF_hlret_1
L2_rare_site12:
s_mov_b32 s36, 12
s_branch L2_rare_t0_0_0
L2_rare_t0_0_0:
s_nop 15
s_nop 15
s_waitcnt lgkmcnt(0)
v_log_f32 v243, v224
v_max3_f32 v232, v128, v129, v130
v_max3_f32 v232, v232, v131, v243
v_mov_b32 v243, v232
s_nop 1
v_permlane32_swap_b32 v232, v243
s_nop 1
v_max_f32 v232, v232, v243
v_mov_b32 v243, v232
s_nop 1
v_permlane16_swap_b32 v232, v243
s_nop 1
v_max_f32 v232, v232, v243
v_ceil_f32 v232, v232
v_max_f32 v232, 0, v232
v_sub_f32 v243, 0, v232
v_exp_f32 v236, v243
s_nop 1
v_mul_f32 v224, v224, v236
v_sub_f32 v192, v192, v232
v_sub_f32 v128, v128, v232
v_sub_f32 v144, v144, v232
v_sub_f32 v193, v193, v232
v_sub_f32 v129, v129, v232
v_sub_f32 v145, v145, v232
v_sub_f32 v194, v194, v232
v_sub_f32 v130, v130, v232
v_sub_f32 v146, v146, v232
v_sub_f32 v195, v195, v232
v_sub_f32 v131, v131, v232
v_sub_f32 v147, v147, v232
v_lshlrev_b32 v242, 16, v176
v_and_b32 v243, 0xffff0000, v176
v_mul_f32 v242, v242, v236
v_mul_f32 v243, v243, v236
v_cvt_pk_bf16_f32 v176, v242, v243
v_lshlrev_b32 v242, 16, v177
v_and_b32 v243, 0xffff0000, v177
v_mul_f32 v242, v242, v236
v_mul_f32 v243, v243, v236
v_cvt_pk_bf16_f32 v177, v242, v243
v_lshlrev_b32 v242, 16, v178
v_and_b32 v243, 0xffff0000, v178
v_mul_f32 v242, v242, v236
v_mul_f32 v243, v243, v236
v_cvt_pk_bf16_f32 v178, v242, v243
v_lshlrev_b32 v242, 16, v179
v_and_b32 v243, 0xffff0000, v179
v_mul_f32 v242, v242, v236
v_mul_f32 v243, v243, v236
v_cvt_pk_bf16_f32 v179, v242, v243
ds_read_b64 v[254:255], v253 offset:0
s_waitcnt lgkmcnt(0)
v_lshlrev_b32 v242, 16, v254
v_and_b32 v243, 0xffff0000, v254
v_mul_f32 v242, v242, v236
v_mul_f32 v243, v243, v236
v_cvt_pk_bf16_f32 v254, v242, v243
v_lshlrev_b32 v242, 16, v255
v_and_b32 v243, 0xffff0000, v255
v_mul_f32 v242, v242, v236
v_mul_f32 v243, v243, v236
v_cvt_pk_bf16_f32 v255, v242, v243
ds_write_b64 v253, v[254:255] offset:0
s_waitcnt lgkmcnt(0)
ds_read_b64 v[254:255], v253 offset:8
s_waitcnt lgkmcnt(0)
v_lshlrev_b32 v242, 16, v254
v_and_b32 v243, 0xffff0000, v254
v_mul_f32 v242, v242, v236
v_mul_f32 v243, v243, v236
v_cvt_pk_bf16_f32 v254, v242, v243
v_lshlrev_b32 v242, 16, v255
v_and_b32 v243, 0xffff0000, v255
v_mul_f32 v242, v242, v236
v_mul_f32 v243, v243, v236
v_cvt_pk_bf16_f32 v255, v242, v243
ds_write_b64 v253, v[254:255] offset:8
s_waitcnt lgkmcnt(0)
v_log_f32 v243, v225
v_max3_f32 v233, v132, v133, v134
v_max3_f32 v233, v233, v135, v243
v_mov_b32 v243, v233
s_nop 1
v_permlane32_swap_b32 v233, v243
s_nop 1
v_max_f32 v233, v233, v243
v_mov_b32 v243, v233
s_nop 1
v_permlane16_swap_b32 v233, v243
s_nop 1
v_max_f32 v233, v233, v243
v_ceil_f32 v233, v233
v_max_f32 v233, 0, v233
v_sub_f32 v243, 0, v233
v_exp_f32 v237, v243
s_nop 1
v_mul_f32 v225, v225, v237
v_sub_f32 v196, v196, v233
v_sub_f32 v132, v132, v233
v_sub_f32 v148, v148, v233
v_sub_f32 v197, v197, v233
v_sub_f32 v133, v133, v233
v_sub_f32 v149, v149, v233
v_sub_f32 v198, v198, v233
v_sub_f32 v134, v134, v233
v_sub_f32 v150, v150, v233
v_sub_f32 v199, v199, v233
v_sub_f32 v135, v135, v233
v_sub_f32 v151, v151, v233
v_lshlrev_b32 v242, 16, v180
v_and_b32 v243, 0xffff0000, v180
v_mul_f32 v242, v242, v237
v_mul_f32 v243, v243, v237
v_cvt_pk_bf16_f32 v180, v242, v243
v_lshlrev_b32 v242, 16, v181
v_and_b32 v243, 0xffff0000, v181
v_mul_f32 v242, v242, v237
v_mul_f32 v243, v243, v237
v_cvt_pk_bf16_f32 v181, v242, v243
v_lshlrev_b32 v242, 16, v182
v_and_b32 v243, 0xffff0000, v182
v_mul_f32 v242, v242, v237
v_mul_f32 v243, v243, v237
v_cvt_pk_bf16_f32 v182, v242, v243
v_lshlrev_b32 v242, 16, v183
v_and_b32 v243, 0xffff0000, v183
v_mul_f32 v242, v242, v237
v_mul_f32 v243, v243, v237
v_cvt_pk_bf16_f32 v183, v242, v243
ds_read_b64 v[254:255], v253 offset:1024
s_waitcnt lgkmcnt(0)
v_lshlrev_b32 v242, 16, v254
v_and_b32 v243, 0xffff0000, v254
v_mul_f32 v242, v242, v237
v_mul_f32 v243, v243, v237
v_cvt_pk_bf16_f32 v254, v242, v243
v_lshlrev_b32 v242, 16, v255
v_and_b32 v243, 0xffff0000, v255
v_mul_f32 v242, v242, v237
v_mul_f32 v243, v243, v237
v_cvt_pk_bf16_f32 v255, v242, v243
ds_write_b64 v253, v[254:255] offset:1024
s_waitcnt lgkmcnt(0)
ds_read_b64 v[254:255], v253 offset:1032
s_waitcnt lgkmcnt(0)
v_lshlrev_b32 v242, 16, v254
v_and_b32 v243, 0xffff0000, v254
v_mul_f32 v242, v242, v237
v_mul_f32 v243, v243, v237
v_cvt_pk_bf16_f32 v254, v242, v243
v_lshlrev_b32 v242, 16, v255
v_and_b32 v243, 0xffff0000, v255
v_mul_f32 v242, v242, v237
v_mul_f32 v243, v243, v237
v_cvt_pk_bf16_f32 v255, v242, v243
ds_write_b64 v253, v[254:255] offset:1032
s_waitcnt lgkmcnt(0)
v_log_f32 v243, v226
v_max3_f32 v234, v136, v137, v138
v_max3_f32 v234, v234, v139, v243
v_mov_b32 v243, v234
s_nop 1
v_permlane32_swap_b32 v234, v243
s_nop 1
v_max_f32 v234, v234, v243
v_mov_b32 v243, v234
s_nop 1
v_permlane16_swap_b32 v234, v243
s_nop 1
v_max_f32 v234, v234, v243
v_ceil_f32 v234, v234
v_max_f32 v234, 0, v234
v_sub_f32 v243, 0, v234
v_exp_f32 v238, v243
s_nop 1
v_mul_f32 v226, v226, v238
v_sub_f32 v200, v200, v234
v_sub_f32 v136, v136, v234
v_sub_f32 v152, v152, v234
v_sub_f32 v201, v201, v234
v_sub_f32 v137, v137, v234
v_sub_f32 v153, v153, v234
v_sub_f32 v202, v202, v234
v_sub_f32 v138, v138, v234
v_sub_f32 v154, v154, v234
v_sub_f32 v203, v203, v234
v_sub_f32 v139, v139, v234
v_sub_f32 v155, v155, v234
v_lshlrev_b32 v242, 16, v184
v_and_b32 v243, 0xffff0000, v184
v_mul_f32 v242, v242, v238
v_mul_f32 v243, v243, v238
v_cvt_pk_bf16_f32 v184, v242, v243
v_lshlrev_b32 v242, 16, v185
v_and_b32 v243, 0xffff0000, v185
v_mul_f32 v242, v242, v238
v_mul_f32 v243, v243, v238
v_cvt_pk_bf16_f32 v185, v242, v243
v_lshlrev_b32 v242, 16, v186
v_and_b32 v243, 0xffff0000, v186
v_mul_f32 v242, v242, v238
v_mul_f32 v243, v243, v238
v_cvt_pk_bf16_f32 v186, v242, v243
v_lshlrev_b32 v242, 16, v187
v_and_b32 v243, 0xffff0000, v187
v_mul_f32 v242, v242, v238
v_mul_f32 v243, v243, v238
v_cvt_pk_bf16_f32 v187, v242, v243
ds_read_b64 v[254:255], v253 offset:2048
s_waitcnt lgkmcnt(0)
v_lshlrev_b32 v242, 16, v254
v_and_b32 v243, 0xffff0000, v254
v_mul_f32 v242, v242, v238
v_mul_f32 v243, v243, v238
v_cvt_pk_bf16_f32 v254, v242, v243
v_lshlrev_b32 v242, 16, v255
v_and_b32 v243, 0xffff0000, v255
v_mul_f32 v242, v242, v238
v_mul_f32 v243, v243, v238
v_cvt_pk_bf16_f32 v255, v242, v243
ds_write_b64 v253, v[254:255] offset:2048
s_waitcnt lgkmcnt(0)
ds_read_b64 v[254:255], v253 offset:2056
s_waitcnt lgkmcnt(0)
v_lshlrev_b32 v242, 16, v254
v_and_b32 v243, 0xffff0000, v254
v_mul_f32 v242, v242, v238
v_mul_f32 v243, v243, v238
v_cvt_pk_bf16_f32 v254, v242, v243
v_lshlrev_b32 v242, 16, v255
v_and_b32 v243, 0xffff0000, v255
v_mul_f32 v242, v242, v238
v_mul_f32 v243, v243, v238
v_cvt_pk_bf16_f32 v255, v242, v243
ds_write_b64 v253, v[254:255] offset:2056
s_waitcnt lgkmcnt(0)
v_log_f32 v243, v227
v_max3_f32 v235, v140, v141, v142
v_max3_f32 v235, v235, v143, v243
v_mov_b32 v243, v235
s_nop 1
v_permlane32_swap_b32 v235, v243
s_nop 1
v_max_f32 v235, v235, v243
v_mov_b32 v243, v235
s_nop 1
v_permlane16_swap_b32 v235, v243
s_nop 1
v_max_f32 v235, v235, v243
v_ceil_f32 v235, v235
v_max_f32 v235, 0, v235
v_sub_f32 v243, 0, v235
v_exp_f32 v239, v243
s_nop 1
v_mul_f32 v227, v227, v239
v_sub_f32 v204, v204, v235
v_sub_f32 v140, v140, v235
v_sub_f32 v156, v156, v235
v_sub_f32 v205, v205, v235
v_sub_f32 v141, v141, v235
v_sub_f32 v157, v157, v235
v_sub_f32 v206, v206, v235
v_sub_f32 v142, v142, v235
v_sub_f32 v158, v158, v235
v_sub_f32 v207, v207, v235
v_sub_f32 v143, v143, v235
v_sub_f32 v159, v159, v235
v_lshlrev_b32 v242, 16, v188
v_and_b32 v243, 0xffff0000, v188
v_mul_f32 v242, v242, v239
v_mul_f32 v243, v243, v239
v_cvt_pk_bf16_f32 v188, v242, v243
v_lshlrev_b32 v242, 16, v189
v_and_b32 v243, 0xffff0000, v189
v_mul_f32 v242, v242, v239
v_mul_f32 v243, v243, v239
v_cvt_pk_bf16_f32 v189, v242, v243
v_lshlrev_b32 v242, 16, v190
v_and_b32 v243, 0xffff0000, v190
v_mul_f32 v242, v242, v239
v_mul_f32 v243, v243, v239
v_cvt_pk_bf16_f32 v190, v242, v243
v_lshlrev_b32 v242, 16, v191
v_and_b32 v243, 0xffff0000, v191
v_mul_f32 v242, v242, v239
v_mul_f32 v243, v243, v239
v_cvt_pk_bf16_f32 v191, v242, v243
ds_read_b64 v[254:255], v253 offset:3072
s_waitcnt lgkmcnt(0)
v_lshlrev_b32 v242, 16, v254
v_and_b32 v243, 0xffff0000, v254
v_mul_f32 v242, v242, v239
v_mul_f32 v243, v243, v239
v_cvt_pk_bf16_f32 v254, v242, v243
v_lshlrev_b32 v242, 16, v255
v_and_b32 v243, 0xffff0000, v255
v_mul_f32 v242, v242, v239
v_mul_f32 v243, v243, v239
v_cvt_pk_bf16_f32 v255, v242, v243
ds_write_b64 v253, v[254:255] offset:3072
s_waitcnt lgkmcnt(0)
ds_read_b64 v[254:255], v253 offset:3080
s_waitcnt lgkmcnt(0)
v_lshlrev_b32 v242, 16, v254
v_and_b32 v243, 0xffff0000, v254
v_mul_f32 v242, v242, v239
v_mul_f32 v243, v243, v239
v_cvt_pk_bf16_f32 v254, v242, v243
v_lshlrev_b32 v242, 16, v255
v_and_b32 v243, 0xffff0000, v255
v_mul_f32 v242, v242, v239
v_mul_f32 v243, v243, v239
v_cvt_pk_bf16_f32 v255, v242, v243
ds_write_b64 v253, v[254:255] offset:3080
s_waitcnt lgkmcnt(0)
v_exp_f32 v232, v128
v_exp_f32 v233, v129
v_exp_f32 v234, v130
v_exp_f32 v235, v131
s_nop 1
v_add_f32 v228, v224, v232
v_add_f32 v228, v228, v233
v_add_f32 v228, v228, v234
v_add_f32 v228, v228, v235
v_cvt_pk_bf16_f32 v160, v232, v233
v_cvt_pk_bf16_f32 v161, v234, v235
v_exp_f32 v232, v132
v_exp_f32 v233, v133
v_exp_f32 v234, v134
v_exp_f32 v235, v135
s_nop 1
v_add_f32 v229, v225, v232
v_add_f32 v229, v229, v233
v_add_f32 v229, v229, v234
v_add_f32 v229, v229, v235
v_cvt_pk_bf16_f32 v164, v232, v233
v_cvt_pk_bf16_f32 v165, v234, v235
v_exp_f32 v232, v136
v_exp_f32 v233, v137
v_exp_f32 v234, v138
v_exp_f32 v235, v139
s_nop 1
v_add_f32 v230, v226, v232
v_add_f32 v230, v230, v233
v_add_f32 v230, v230, v234
v_add_f32 v230, v230, v235
v_cvt_pk_bf16_f32 v168, v232, v233
v_cvt_pk_bf16_f32 v169, v234, v235
v_exp_f32 v232, v140
v_exp_f32 v233, v141
v_exp_f32 v234, v142
v_exp_f32 v235, v143
s_nop 1
v_add_f32 v231, v227, v232
v_add_f32 v231, v231, v233
v_add_f32 v231, v231, v234
v_add_f32 v231, v231, v235
v_cvt_pk_bf16_f32 v172, v232, v233
v_cvt_pk_bf16_f32 v173, v234, v235
s_branch L2_rare_common
L2_rare_site13:
s_mov_b32 s36, 13
s_branch L2_rare_t0_1_1
L2_rare_t0_1_1:
s_nop 15
s_nop 15
s_waitcnt lgkmcnt(0)
v_log_f32 v243, v228
v_max3_f32 v232, v144, v145, v146
v_max3_f32 v232, v232, v147, v243
v_mov_b32 v243, v232
s_nop 1
v_permlane32_swap_b32 v232, v243
s_nop 1
v_max_f32 v232, v232, v243
v_mov_b32 v243, v232
s_nop 1
v_permlane16_swap_b32 v232, v243
s_nop 1
v_max_f32 v232, v232, v243
v_ceil_f32 v232, v232
v_max_f32 v232, 0, v232
v_sub_f32 v243, 0, v232
v_exp_f32 v236, v243
s_nop 1
v_mul_f32 v228, v228, v236
v_sub_f32 v192, v192, v232
v_sub_f32 v128, v128, v232
v_sub_f32 v144, v144, v232
v_sub_f32 v193, v193, v232
v_sub_f32 v129, v129, v232
v_sub_f32 v145, v145, v232
v_sub_f32 v194, v194, v232
v_sub_f32 v130, v130, v232
v_sub_f32 v146, v146, v232
v_sub_f32 v195, v195, v232
v_sub_f32 v131, v131, v232
v_sub_f32 v147, v147, v232
v_lshlrev_b32 v242, 16, v160
v_and_b32 v243, 0xffff0000, v160
v_mul_f32 v242, v242, v236
v_mul_f32 v243, v243, v236
v_cvt_pk_bf16_f32 v160, v242, v243
v_lshlrev_b32 v242, 16, v161
v_and_b32 v243, 0xffff0000, v161
v_mul_f32 v242, v242, v236
v_mul_f32 v243, v243, v236
v_cvt_pk_bf16_f32 v161, v242, v243
ds_read_b64 v[254:255], v253 offset:0
s_waitcnt lgkmcnt(0)
v_lshlrev_b32 v242, 16, v254
v_and_b32 v243, 0xffff0000, v254
v_mul_f32 v242, v242, v236
v_mul_f32 v243, v243, v236
v_cvt_pk_bf16_f32 v254, v242, v243
v_lshlrev_b32 v242, 16, v255
v_and_b32 v243, 0xffff0000, v255
v_mul_f32 v242, v242, v236
v_mul_f32 v243, v243, v236
v_cvt_pk_bf16_f32 v255, v242, v243
ds_write_b64 v253, v[254:255] offset:0
s_waitcnt lgkmcnt(0)
ds_read_b64 v[254:255], v253 offset:8
s_waitcnt lgkmcnt(0)
v_lshlrev_b32 v242, 16, v254
v_and_b32 v243, 0xffff0000, v254
v_mul_f32 v242, v242, v236
v_mul_f32 v243, v243, v236
v_cvt_pk_bf16_f32 v254, v242, v243
v_lshlrev_b32 v242, 16, v255
v_and_b32 v243, 0xffff0000, v255
v_mul_f32 v242, v242, v236
v_mul_f32 v243, v243, v236
v_cvt_pk_bf16_f32 v255, v242, v243
ds_write_b64 v253, v[254:255] offset:8
s_waitcnt lgkmcnt(0)
ds_read_b64 v[254:255], v253 offset:4096
s_waitcnt lgkmcnt(0)
v_lshlrev_b32 v242, 16, v254
v_and_b32 v243, 0xffff0000, v254
v_mul_f32 v242, v242, v236
v_mul_f32 v243, v243, v236
v_cvt_pk_bf16_f32 v254, v242, v243
v_lshlrev_b32 v242, 16, v255
v_and_b32 v243, 0xffff0000, v255
v_mul_f32 v242, v242, v236
v_mul_f32 v243, v243, v236
v_cvt_pk_bf16_f32 v255, v242, v243
ds_write_b64 v253, v[254:255] offset:4096
s_waitcnt lgkmcnt(0)
ds_read_b64 v[254:255], v253 offset:4104
s_waitcnt lgkmcnt(0)
v_lshlrev_b32 v242, 16, v254
v_and_b32 v243, 0xffff0000, v254
v_mul_f32 v242, v242, v236
v_mul_f32 v243, v243, v236
v_cvt_pk_bf16_f32 v254, v242, v243
v_lshlrev_b32 v242, 16, v255
v_and_b32 v243, 0xffff0000, v255
v_mul_f32 v242, v242, v236
v_mul_f32 v243, v243, v236
v_cvt_pk_bf16_f32 v255, v242, v243
ds_write_b64 v253, v[254:255] offset:4104
s_waitcnt lgkmcnt(0)
v_log_f32 v243, v229
v_max3_f32 v233, v148, v149, v150
v_max3_f32 v233, v233, v151, v243
v_mov_b32 v243, v233
s_nop 1
v_permlane32_swap_b32 v233, v243
s_nop 1
v_max_f32 v233, v233, v243
v_mov_b32 v243, v233
s_nop 1
v_permlane16_swap_b32 v233, v243
s_nop 1
v_max_f32 v233, v233, v243
v_ceil_f32 v233, v233
v_max_f32 v233, 0, v233
v_sub_f32 v243, 0, v233
v_exp_f32 v237, v243
s_nop 1
v_mul_f32 v229, v229, v237
v_sub_f32 v196, v196, v233
v_sub_f32 v132, v132, v233
v_sub_f32 v148, v148, v233
v_sub_f32 v197, v197, v233
v_sub_f32 v133, v133, v233
v_sub_f32 v149, v149, v233
v_sub_f32 v198, v198, v233
v_sub_f32 v134, v134, v233
v_sub_f32 v150, v150, v233
v_sub_f32 v199, v199, v233
v_sub_f32 v135, v135, v233
v_sub_f32 v151, v151, v233
v_lshlrev_b32 v242, 16, v164
v_and_b32 v243, 0xffff0000, v164
v_mul_f32 v242, v242, v237
v_mul_f32 v243, v243, v237
v_cvt_pk_bf16_f32 v164, v242, v243
v_lshlrev_b32 v242, 16, v165
v_and_b32 v243, 0xffff0000, v165
v_mul_f32 v242, v242, v237
v_mul_f32 v243, v243, v237
v_cvt_pk_bf16_f32 v165, v242, v243
ds_read_b64 v[254:255], v253 offset:1024
s_waitcnt lgkmcnt(0)
v_lshlrev_b32 v242, 16, v254
v_and_b32 v243, 0xffff0000, v254
v_mul_f32 v242, v242, v237
v_mul_f32 v243, v243, v237
v_cvt_pk_bf16_f32 v254, v242, v243
v_lshlrev_b32 v242, 16, v255
v_and_b32 v243, 0xffff0000, v255
v_mul_f32 v242, v242, v237
v_mul_f32 v243, v243, v237
v_cvt_pk_bf16_f32 v255, v242, v243
ds_write_b64 v253, v[254:255] offset:1024
s_waitcnt lgkmcnt(0)
ds_read_b64 v[254:255], v253 offset:1032
s_waitcnt lgkmcnt(0)
v_lshlrev_b32 v242, 16, v254
v_and_b32 v243, 0xffff0000, v254
v_mul_f32 v242, v242, v237
v_mul_f32 v243, v243, v237
v_cvt_pk_bf16_f32 v254, v242, v243
v_lshlrev_b32 v242, 16, v255
v_and_b32 v243, 0xffff0000, v255
v_mul_f32 v242, v242, v237
v_mul_f32 v243, v243, v237
v_cvt_pk_bf16_f32 v255, v242, v243
ds_write_b64 v253, v[254:255] offset:1032
s_waitcnt lgkmcnt(0)
ds_read_b64 v[254:255], v253 offset:5120
s_waitcnt lgkmcnt(0)
v_lshlrev_b32 v242, 16, v254
v_and_b32 v243, 0xffff0000, v254
v_mul_f32 v242, v242, v237
v_mul_f32 v243, v243, v237
v_cvt_pk_bf16_f32 v254, v242, v243
v_lshlrev_b32 v242, 16, v255
v_and_b32 v243, 0xffff0000, v255
v_mul_f32 v242, v242, v237
v_mul_f32 v243, v243, v237
v_cvt_pk_bf16_f32 v255, v242, v243
ds_write_b64 v253, v[254:255] offset:5120
s_waitcnt lgkmcnt(0)
ds_read_b64 v[254:255], v253 offset:5128
s_waitcnt lgkmcnt(0)
v_lshlrev_b32 v242, 16, v254
v_and_b32 v243, 0xffff0000, v254
v_mul_f32 v242, v242, v237
v_mul_f32 v243, v243, v237
v_cvt_pk_bf16_f32 v254, v242, v243
v_lshlrev_b32 v242, 16, v255
v_and_b32 v243, 0xffff0000, v255
v_mul_f32 v242, v242, v237
v_mul_f32 v243, v243, v237
v_cvt_pk_bf16_f32 v255, v242, v243
ds_write_b64 v253, v[254:255] offset:5128
s_waitcnt lgkmcnt(0)
v_log_f32 v243, v230
v_max3_f32 v234, v152, v153, v154
v_max3_f32 v234, v234, v155, v243
v_mov_b32 v243, v234
s_nop 1
v_permlane32_swap_b32 v234, v243
s_nop 1
v_max_f32 v234, v234, v243
v_mov_b32 v243, v234
s_nop 1
v_permlane16_swap_b32 v234, v243
s_nop 1
v_max_f32 v234, v234, v243
v_ceil_f32 v234, v234
v_max_f32 v234, 0, v234
v_sub_f32 v243, 0, v234
v_exp_f32 v238, v243
s_nop 1
v_mul_f32 v230, v230, v238
v_sub_f32 v200, v200, v234
v_sub_f32 v136, v136, v234
v_sub_f32 v152, v152, v234
v_sub_f32 v201, v201, v234
v_sub_f32 v137, v137, v234
v_sub_f32 v153, v153, v234
v_sub_f32 v202, v202, v234
v_sub_f32 v138, v138, v234
v_sub_f32 v154, v154, v234
v_sub_f32 v203, v203, v234
v_sub_f32 v139, v139, v234
v_sub_f32 v155, v155, v234
v_lshlrev_b32 v242, 16, v168
v_and_b32 v243, 0xffff0000, v168
v_mul_f32 v242, v242, v238
v_mul_f32 v243, v243, v238
v_cvt_pk_bf16_f32 v168, v242, v243
v_lshlrev_b32 v242, 16, v169
v_and_b32 v243, 0xffff0000, v169
v_mul_f32 v242, v242, v238
v_mul_f32 v243, v243, v238
v_cvt_pk_bf16_f32 v169, v242, v243
ds_read_b64 v[254:255], v253 offset:2048
s_waitcnt lgkmcnt(0)
v_lshlrev_b32 v242, 16, v254
v_and_b32 v243, 0xffff0000, v254
v_mul_f32 v242, v242, v238
v_mul_f32 v243, v243, v238
v_cvt_pk_bf16_f32 v254, v242, v243
v_lshlrev_b32 v242, 16, v255
v_and_b32 v243, 0xffff0000, v255
v_mul_f32 v242, v242, v238
v_mul_f32 v243, v243, v238
v_cvt_pk_bf16_f32 v255, v242, v243
ds_write_b64 v253, v[254:255] offset:2048
s_waitcnt lgkmcnt(0)
ds_read_b64 v[254:255], v253 offset:2056
s_waitcnt lgkmcnt(0)
v_lshlrev_b32 v242, 16, v254
v_and_b32 v243, 0xffff0000, v254
v_mul_f32 v242, v242, v238
v_mul_f32 v243, v243, v238
v_cvt_pk_bf16_f32 v254, v242, v243
v_lshlrev_b32 v242, 16, v255
v_and_b32 v243, 0xffff0000, v255
v_mul_f32 v242, v242, v238
v_mul_f32 v243, v243, v238
v_cvt_pk_bf16_f32 v255, v242, v243
ds_write_b64 v253, v[254:255] offset:2056
s_waitcnt lgkmcnt(0)
ds_read_b64 v[254:255], v253 offset:6144
s_waitcnt lgkmcnt(0)
v_lshlrev_b32 v242, 16, v254
v_and_b32 v243, 0xffff0000, v254
v_mul_f32 v242, v242, v238
v_mul_f32 v243, v243, v238
v_cvt_pk_bf16_f32 v254, v242, v243
v_lshlrev_b32 v242, 16, v255
v_and_b32 v243, 0xffff0000, v255
v_mul_f32 v242, v242, v238
v_mul_f32 v243, v243, v238
v_cvt_pk_bf16_f32 v255, v242, v243
ds_write_b64 v253, v[254:255] offset:6144
s_waitcnt lgkmcnt(0)
ds_read_b64 v[254:255], v253 offset:6152
s_waitcnt lgkmcnt(0)
v_lshlrev_b32 v242, 16, v254
v_and_b32 v243, 0xffff0000, v254
v_mul_f32 v242, v242, v238
v_mul_f32 v243, v243, v238
v_cvt_pk_bf16_f32 v254, v242, v243
v_lshlrev_b32 v242, 16, v255
v_and_b32 v243, 0xffff0000, v255
v_mul_f32 v242, v242, v238
v_mul_f32 v243, v243, v238
v_cvt_pk_bf16_f32 v255, v242, v243
ds_write_b64 v253, v[254:255] offset:6152
s_waitcnt lgkmcnt(0)
v_log_f32 v243, v231
v_max3_f32 v235, v156, v157, v158
v_max3_f32 v235, v235, v159, v243
v_mov_b32 v243, v235
s_nop 1
v_permlane32_swap_b32 v235, v243
s_nop 1
v_max_f32 v235, v235, v243
v_mov_b32 v243, v235
s_nop 1
v_permlane16_swap_b32 v235, v243
s_nop 1
v_max_f32 v235, v235, v243
v_ceil_f32 v235, v235
v_max_f32 v235, 0, v235
v_sub_f32 v243, 0, v235
v_exp_f32 v239, v243
s_nop 1
v_mul_f32 v231, v231, v239
v_sub_f32 v204, v204, v235
v_sub_f32 v140, v140, v235
v_sub_f32 v156, v156, v235
v_sub_f32 v205, v205, v235
v_sub_f32 v141, v141, v235
v_sub_f32 v157, v157, v235
v_sub_f32 v206, v206, v235
v_sub_f32 v142, v142, v235
v_sub_f32 v158, v158, v235
v_sub_f32 v207, v207, v235
v_sub_f32 v143, v143, v235
v_sub_f32 v159, v159, v235
v_lshlrev_b32 v242, 16, v172
v_and_b32 v243, 0xffff0000, v172
v_mul_f32 v242, v242, v239
v_mul_f32 v243, v243, v239
v_cvt_pk_bf16_f32 v172, v242, v243
v_lshlrev_b32 v242, 16, v173
v_and_b32 v243, 0xffff0000, v173
v_mul_f32 v242, v242, v239
v_mul_f32 v243, v243, v239
v_cvt_pk_bf16_f32 v173, v242, v243
ds_read_b64 v[254:255], v253 offset:3072
s_waitcnt lgkmcnt(0)
v_lshlrev_b32 v242, 16, v254
v_and_b32 v243, 0xffff0000, v254
v_mul_f32 v242, v242, v239
v_mul_f32 v243, v243, v239
v_cvt_pk_bf16_f32 v254, v242, v243
v_lshlrev_b32 v242, 16, v255
v_and_b32 v243, 0xffff0000, v255
v_mul_f32 v242, v242, v239
v_mul_f32 v243, v243, v239
v_cvt_pk_bf16_f32 v255, v242, v243
ds_write_b64 v253, v[254:255] offset:3072
s_waitcnt lgkmcnt(0)
ds_read_b64 v[254:255], v253 offset:3080
s_waitcnt lgkmcnt(0)
v_lshlrev_b32 v242, 16, v254
v_and_b32 v243, 0xffff0000, v254
v_mul_f32 v242, v242, v239
v_mul_f32 v243, v243, v239
v_cvt_pk_bf16_f32 v254, v242, v243
v_lshlrev_b32 v242, 16, v255
v_and_b32 v243, 0xffff0000, v255
v_mul_f32 v242, v242, v239
v_mul_f32 v243, v243, v239
v_cvt_pk_bf16_f32 v255, v242, v243
ds_write_b64 v253, v[254:255] offset:3080
s_waitcnt lgkmcnt(0)
ds_read_b64 v[254:255], v253 offset:7168
s_waitcnt lgkmcnt(0)
v_lshlrev_b32 v242, 16, v254
v_and_b32 v243, 0xffff0000, v254
v_mul_f32 v242, v242, v239
v_mul_f32 v243, v243, v239
v_cvt_pk_bf16_f32 v254, v242, v243
v_lshlrev_b32 v242, 16, v255
v_and_b32 v243, 0xffff0000, v255
v_mul_f32 v242, v242, v239
v_mul_f32 v243, v243, v239
v_cvt_pk_bf16_f32 v255, v242, v243
ds_write_b64 v253, v[254:255] offset:7168
s_waitcnt lgkmcnt(0)
ds_read_b64 v[254:255], v253 offset:7176
s_waitcnt lgkmcnt(0)
v_lshlrev_b32 v242, 16, v254
v_and_b32 v243, 0xffff0000, v254
v_mul_f32 v242, v242, v239
v_mul_f32 v243, v243, v239
v_cvt_pk_bf16_f32 v254, v242, v243
v_lshlrev_b32 v242, 16, v255
v_and_b32 v243, 0xffff0000, v255
v_mul_f32 v242, v242, v239
v_mul_f32 v243, v243, v239
v_cvt_pk_bf16_f32 v255, v242, v243
ds_write_b64 v253, v[254:255] offset:7176
s_waitcnt lgkmcnt(0)
v_exp_f32 v232, v144
v_exp_f32 v233, v145
v_exp_f32 v234, v146
v_exp_f32 v235, v147
s_nop 1
v_add_f32 v224, v228, v232
v_add_f32 v224, v224, v233
v_add_f32 v224, v224, v234
v_add_f32 v224, v224, v235
v_cvt_pk_bf16_f32 v162, v232, v233
v_cvt_pk_bf16_f32 v163, v234, v235
v_exp_f32 v232, v148
v_exp_f32 v233, v149
v_exp_f32 v234, v150
v_exp_f32 v235, v151
s_nop 1
v_add_f32 v225, v229, v232
v_add_f32 v225, v225, v233
v_add_f32 v225, v225, v234
v_add_f32 v225, v225, v235
v_cvt_pk_bf16_f32 v166, v232, v233
v_cvt_pk_bf16_f32 v167, v234, v235
v_exp_f32 v232, v152
v_exp_f32 v233, v153
v_exp_f32 v234, v154
v_exp_f32 v235, v155
s_nop 1
v_add_f32 v226, v230, v232
v_add_f32 v226, v226, v233
v_add_f32 v226, v226, v234
v_add_f32 v226, v226, v235
v_cvt_pk_bf16_f32 v170, v232, v233
v_cvt_pk_bf16_f32 v171, v234, v235
v_exp_f32 v232, v156
v_exp_f32 v233, v157
v_exp_f32 v234, v158
v_exp_f32 v235, v159
s_nop 1
v_add_f32 v227, v231, v232
v_add_f32 v227, v227, v233
v_add_f32 v227, v227, v234
v_add_f32 v227, v227, v235
v_cvt_pk_bf16_f32 v174, v232, v233
v_cvt_pk_bf16_f32 v175, v234, v235
s_branch L2_rare_common
L2_rare_site14:
s_mov_b32 s36, 14
s_branch L2_rare_t0_2_0
L2_rare_t0_2_0:
s_nop 15
s_nop 15
s_waitcnt lgkmcnt(0)
v_log_f32 v243, v224
v_max3_f32 v232, v128, v129, v130
v_max3_f32 v232, v232, v131, v243
v_mov_b32 v243, v232
s_nop 1
v_permlane32_swap_b32 v232, v243
s_nop 1
v_max_f32 v232, v232, v243
v_mov_b32 v243, v232
s_nop 1
v_permlane16_swap_b32 v232, v243
s_nop 1
v_max_f32 v232, v232, v243
v_ceil_f32 v232, v232
v_max_f32 v232, 0, v232
v_sub_f32 v243, 0, v232
v_exp_f32 v236, v243
s_nop 1
v_mul_f32 v224, v224, v236
v_sub_f32 v192, v192, v232
v_sub_f32 v128, v128, v232
v_sub_f32 v144, v144, v232
v_sub_f32 v193, v193, v232
v_sub_f32 v129, v129, v232
v_sub_f32 v145, v145, v232
v_sub_f32 v194, v194, v232
v_sub_f32 v130, v130, v232
v_sub_f32 v146, v146, v232
v_sub_f32 v195, v195, v232
v_sub_f32 v131, v131, v232
v_sub_f32 v147, v147, v232
v_lshlrev_b32 v242, 16, v160
v_and_b32 v243, 0xffff0000, v160
v_mul_f32 v242, v242, v236
v_mul_f32 v243, v243, v236
v_cvt_pk_bf16_f32 v160, v242, v243
v_lshlrev_b32 v242, 16, v161
v_and_b32 v243, 0xffff0000, v161
v_mul_f32 v242, v242, v236
v_mul_f32 v243, v243, v236
v_cvt_pk_bf16_f32 v161, v242, v243
v_lshlrev_b32 v242, 16, v162
v_and_b32 v243, 0xffff0000, v162
v_mul_f32 v242, v242, v236
v_mul_f32 v243, v243, v236
v_cvt_pk_bf16_f32 v162, v242, v243
v_lshlrev_b32 v242, 16, v163
v_and_b32 v243, 0xffff0000, v163
v_mul_f32 v242, v242, v236
v_mul_f32 v243, v243, v236
v_cvt_pk_bf16_f32 v163, v242, v243
ds_read_b64 v[254:255], v253 offset:0
s_waitcnt lgkmcnt(0)
v_lshlrev_b32 v242, 16, v254
v_and_b32 v243, 0xffff0000, v254
v_mul_f32 v242, v242, v236
v_mul_f32 v243, v243, v236
v_cvt_pk_bf16_f32 v254, v242, v243
v_lshlrev_b32 v242, 16, v255
v_and_b32 v243, 0xffff0000, v255
v_mul_f32 v242, v242, v236
v_mul_f32 v243, v243, v236
v_cvt_pk_bf16_f32 v255, v242, v243
ds_write_b64 v253, v[254:255] offset:0
s_waitcnt lgkmcnt(0)
ds_read_b64 v[254:255], v253 offset:8
s_waitcnt lgkmcnt(0)
v_lshlrev_b32 v242, 16, v254
v_and_b32 v243, 0xffff0000, v254
v_mul_f32 v242, v242, v236
v_mul_f32 v243, v243, v236
v_cvt_pk_bf16_f32 v254, v242, v243
v_lshlrev_b32 v242, 16, v255
v_and_b32 v243, 0xffff0000, v255
v_mul_f32 v242, v242, v236
v_mul_f32 v243, v243, v236
v_cvt_pk_bf16_f32 v255, v242, v243
ds_write_b64 v253, v[254:255] offset:8
s_waitcnt lgkmcnt(0)
ds_read_b64 v[254:255], v253 offset:4096
s_waitcnt lgkmcnt(0)
v_lshlrev_b32 v242, 16, v254
v_and_b32 v243, 0xffff0000, v254
v_mul_f32 v242, v242, v236
v_mul_f32 v243, v243, v236
v_cvt_pk_bf16_f32 v254, v242, v243
v_lshlrev_b32 v242, 16, v255
v_and_b32 v243, 0xffff0000, v255
v_mul_f32 v242, v242, v236
v_mul_f32 v243, v243, v236
v_cvt_pk_bf16_f32 v255, v242, v243
ds_write_b64 v253, v[254:255] offset:4096
s_waitcnt lgkmcnt(0)
ds_read_b64 v[254:255], v253 offset:4104
s_waitcnt lgkmcnt(0)
v_lshlrev_b32 v242, 16, v254
v_and_b32 v243, 0xffff0000, v254
v_mul_f32 v242, v242, v236
v_mul_f32 v243, v243, v236
v_cvt_pk_bf16_f32 v254, v242, v243
v_lshlrev_b32 v242, 16, v255
v_and_b32 v243, 0xffff0000, v255
v_mul_f32 v242, v242, v236
v_mul_f32 v243, v243, v236
v_cvt_pk_bf16_f32 v255, v242, v243
ds_write_b64 v253, v[254:255] offset:4104
s_waitcnt lgkmcnt(0)
v_log_f32 v243, v225
v_max3_f32 v233, v132, v133, v134
v_max3_f32 v233, v233, v135, v243
v_mov_b32 v243, v233
s_nop 1
v_permlane32_swap_b32 v233, v243
s_nop 1
v_max_f32 v233, v233, v243
v_mov_b32 v243, v233
s_nop 1
v_permlane16_swap_b32 v233, v243
s_nop 1
v_max_f32 v233, v233, v243
v_ceil_f32 v233, v233
v_max_f32 v233, 0, v233
v_sub_f32 v243, 0, v233
v_exp_f32 v237, v243
s_nop 1
v_mul_f32 v225, v225, v237
v_sub_f32 v196, v196, v233
v_sub_f32 v132, v132, v233
v_sub_f32 v148, v148, v233
v_sub_f32 v197, v197, v233
v_sub_f32 v133, v133, v233
v_sub_f32 v149, v149, v233
v_sub_f32 v198, v198, v233
v_sub_f32 v134, v134, v233
v_sub_f32 v150, v150, v233
v_sub_f32 v199, v199, v233
v_sub_f32 v135, v135, v233
v_sub_f32 v151, v151, v233
v_lshlrev_b32 v242, 16, v164
v_and_b32 v243, 0xffff0000, v164
v_mul_f32 v242, v242, v237
v_mul_f32 v243, v243, v237
v_cvt_pk_bf16_f32 v164, v242, v243
v_lshlrev_b32 v242, 16, v165
v_and_b32 v243, 0xffff0000, v165
v_mul_f32 v242, v242, v237
v_mul_f32 v243, v243, v237
v_cvt_pk_bf16_f32 v165, v242, v243
v_lshlrev_b32 v242, 16, v166
v_and_b32 v243, 0xffff0000, v166
v_mul_f32 v242, v242, v237
v_mul_f32 v243, v243, v237
v_cvt_pk_bf16_f32 v166, v242, v243
v_lshlrev_b32 v242, 16, v167
v_and_b32 v243, 0xffff0000, v167
v_mul_f32 v242, v242, v237
v_mul_f32 v243, v243, v237
v_cvt_pk_bf16_f32 v167, v242, v243
ds_read_b64 v[254:255], v253 offset:1024
s_waitcnt lgkmcnt(0)
v_lshlrev_b32 v242, 16, v254
v_and_b32 v243, 0xffff0000, v254
v_mul_f32 v242, v242, v237
v_mul_f32 v243, v243, v237
v_cvt_pk_bf16_f32 v254, v242, v243
v_lshlrev_b32 v242, 16, v255
v_and_b32 v243, 0xffff0000, v255
v_mul_f32 v242, v242, v237
v_mul_f32 v243, v243, v237
v_cvt_pk_bf16_f32 v255, v242, v243
ds_write_b64 v253, v[254:255] offset:1024
s_waitcnt lgkmcnt(0)
ds_read_b64 v[254:255], v253 offset:1032
s_waitcnt lgkmcnt(0)
v_lshlrev_b32 v242, 16, v254
v_and_b32 v243, 0xffff0000, v254
v_mul_f32 v242, v242, v237
v_mul_f32 v243, v243, v237
v_cvt_pk_bf16_f32 v254, v242, v243
v_lshlrev_b32 v242, 16, v255
v_and_b32 v243, 0xffff0000, v255
v_mul_f32 v242, v242, v237
v_mul_f32 v243, v243, v237
v_cvt_pk_bf16_f32 v255, v242, v243
ds_write_b64 v253, v[254:255] offset:1032
s_waitcnt lgkmcnt(0)
ds_read_b64 v[254:255], v253 offset:5120
s_waitcnt lgkmcnt(0)
v_lshlrev_b32 v242, 16, v254
v_and_b32 v243, 0xffff0000, v254
v_mul_f32 v242, v242, v237
v_mul_f32 v243, v243, v237
v_cvt_pk_bf16_f32 v254, v242, v243
v_lshlrev_b32 v242, 16, v255
v_and_b32 v243, 0xffff0000, v255
v_mul_f32 v242, v242, v237
v_mul_f32 v243, v243, v237
v_cvt_pk_bf16_f32 v255, v242, v243
ds_write_b64 v253, v[254:255] offset:5120
s_waitcnt lgkmcnt(0)
ds_read_b64 v[254:255], v253 offset:5128
s_waitcnt lgkmcnt(0)
v_lshlrev_b32 v242, 16, v254
v_and_b32 v243, 0xffff0000, v254
v_mul_f32 v242, v242, v237
v_mul_f32 v243, v243, v237
v_cvt_pk_bf16_f32 v254, v242, v243
v_lshlrev_b32 v242, 16, v255
v_and_b32 v243, 0xffff0000, v255
v_mul_f32 v242, v242, v237
v_mul_f32 v243, v243, v237
v_cvt_pk_bf16_f32 v255, v242, v243
ds_write_b64 v253, v[254:255] offset:5128
s_waitcnt lgkmcnt(0)
v_log_f32 v243, v226
v_max3_f32 v234, v136, v137, v138
v_max3_f32 v234, v234, v139, v243
v_mov_b32 v243, v234
s_nop 1
v_permlane32_swap_b32 v234, v243
s_nop 1
v_max_f32 v234, v234, v243
v_mov_b32 v243, v234
s_nop 1
v_permlane16_swap_b32 v234, v243
s_nop 1
v_max_f32 v234, v234, v243
v_ceil_f32 v234, v234
v_max_f32 v234, 0, v234
v_sub_f32 v243, 0, v234
v_exp_f32 v238, v243
s_nop 1
v_mul_f32 v226, v226, v238
v_sub_f32 v200, v200, v234
v_sub_f32 v136, v136, v234
v_sub_f32 v152, v152, v234
v_sub_f32 v201, v201, v234
v_sub_f32 v137, v137, v234
v_sub_f32 v153, v153, v234
v_sub_f32 v202, v202, v234
v_sub_f32 v138, v138, v234
v_sub_f32 v154, v154, v234
v_sub_f32 v203, v203, v234
v_sub_f32 v139, v139, v234
v_sub_f32 v155, v155, v234
v_lshlrev_b32 v242, 16, v168
v_and_b32 v243, 0xffff0000, v168
v_mul_f32 v242, v242, v238
v_mul_f32 v243, v243, v238
v_cvt_pk_bf16_f32 v168, v242, v243
v_lshlrev_b32 v242, 16, v169
v_and_b32 v243, 0xffff0000, v169
v_mul_f32 v242, v242, v238
v_mul_f32 v243, v243, v238
v_cvt_pk_bf16_f32 v169, v242, v243
v_lshlrev_b32 v242, 16, v170
v_and_b32 v243, 0xffff0000, v170
v_mul_f32 v242, v242, v238
v_mul_f32 v243, v243, v238
v_cvt_pk_bf16_f32 v170, v242, v243
v_lshlrev_b32 v242, 16, v171
v_and_b32 v243, 0xffff0000, v171
v_mul_f32 v242, v242, v238
v_mul_f32 v243, v243, v238
v_cvt_pk_bf16_f32 v171, v242, v243
ds_read_b64 v[254:255], v253 offset:2048
s_waitcnt lgkmcnt(0)
v_lshlrev_b32 v242, 16, v254
v_and_b32 v243, 0xffff0000, v254
v_mul_f32 v242, v242, v238
v_mul_f32 v243, v243, v238
v_cvt_pk_bf16_f32 v254, v242, v243
v_lshlrev_b32 v242, 16, v255
v_and_b32 v243, 0xffff0000, v255
v_mul_f32 v242, v242, v238
v_mul_f32 v243, v243, v238
v_cvt_pk_bf16_f32 v255, v242, v243
ds_write_b64 v253, v[254:255] offset:2048
s_waitcnt lgkmcnt(0)
ds_read_b64 v[254:255], v253 offset:2056
s_waitcnt lgkmcnt(0)
v_lshlrev_b32 v242, 16, v254
v_and_b32 v243, 0xffff0000, v254
v_mul_f32 v242, v242, v238
v_mul_f32 v243, v243, v238
v_cvt_pk_bf16_f32 v254, v242, v243
v_lshlrev_b32 v242, 16, v255
v_and_b32 v243, 0xffff0000, v255
v_mul_f32 v242, v242, v238
v_mul_f32 v243, v243, v238
v_cvt_pk_bf16_f32 v255, v242, v243
ds_write_b64 v253, v[254:255] offset:2056
s_waitcnt lgkmcnt(0)
ds_read_b64 v[254:255], v253 offset:6144
s_waitcnt lgkmcnt(0)
v_lshlrev_b32 v242, 16, v254
v_and_b32 v243, 0xffff0000, v254
v_mul_f32 v242, v242, v238
v_mul_f32 v243, v243, v238
v_cvt_pk_bf16_f32 v254, v242, v243
v_lshlrev_b32 v242, 16, v255
v_and_b32 v243, 0xffff0000, v255
v_mul_f32 v242, v242, v238
v_mul_f32 v243, v243, v238
v_cvt_pk_bf16_f32 v255, v242, v243
ds_write_b64 v253, v[254:255] offset:6144
s_waitcnt lgkmcnt(0)
ds_read_b64 v[254:255], v253 offset:6152
s_waitcnt lgkmcnt(0)
v_lshlrev_b32 v242, 16, v254
v_and_b32 v243, 0xffff0000, v254
v_mul_f32 v242, v242, v238
v_mul_f32 v243, v243, v238
v_cvt_pk_bf16_f32 v254, v242, v243
v_lshlrev_b32 v242, 16, v255
v_and_b32 v243, 0xffff0000, v255
v_mul_f32 v242, v242, v238
v_mul_f32 v243, v243, v238
v_cvt_pk_bf16_f32 v255, v242, v243
ds_write_b64 v253, v[254:255] offset:6152
s_waitcnt lgkmcnt(0)
v_log_f32 v243, v227
v_max3_f32 v235, v140, v141, v142
v_max3_f32 v235, v235, v143, v243
v_mov_b32 v243, v235
s_nop 1
v_permlane32_swap_b32 v235, v243
s_nop 1
v_max_f32 v235, v235, v243
v_mov_b32 v243, v235
s_nop 1
v_permlane16_swap_b32 v235, v243
s_nop 1
v_max_f32 v235, v235, v243
v_ceil_f32 v235, v235
v_max_f32 v235, 0, v235
v_sub_f32 v243, 0, v235
v_exp_f32 v239, v243
s_nop 1
v_mul_f32 v227, v227, v239
v_sub_f32 v204, v204, v235
v_sub_f32 v140, v140, v235
v_sub_f32 v156, v156, v235
v_sub_f32 v205, v205, v235
v_sub_f32 v141, v141, v235
v_sub_f32 v157, v157, v235
v_sub_f32 v206, v206, v235
v_sub_f32 v142, v142, v235
v_sub_f32 v158, v158, v235
v_sub_f32 v207, v207, v235
v_sub_f32 v143, v143, v235
v_sub_f32 v159, v159, v235
v_lshlrev_b32 v242, 16, v172
v_and_b32 v243, 0xffff0000, v172
v_mul_f32 v242, v242, v239
v_mul_f32 v243, v243, v239
v_cvt_pk_bf16_f32 v172, v242, v243
v_lshlrev_b32 v242, 16, v173
v_and_b32 v243, 0xffff0000, v173
v_mul_f32 v242, v242, v239
v_mul_f32 v243, v243, v239
v_cvt_pk_bf16_f32 v173, v242, v243
v_lshlrev_b32 v242, 16, v174
v_and_b32 v243, 0xffff0000, v174
v_mul_f32 v242, v242, v239
v_mul_f32 v243, v243, v239
v_cvt_pk_bf16_f32 v174, v242, v243
v_lshlrev_b32 v242, 16, v175
v_and_b32 v243, 0xffff0000, v175
v_mul_f32 v242, v242, v239
v_mul_f32 v243, v243, v239
v_cvt_pk_bf16_f32 v175, v242, v243
ds_read_b64 v[254:255], v253 offset:3072
s_waitcnt lgkmcnt(0)
v_lshlrev_b32 v242, 16, v254
v_and_b32 v243, 0xffff0000, v254
v_mul_f32 v242, v242, v239
v_mul_f32 v243, v243, v239
v_cvt_pk_bf16_f32 v254, v242, v243
v_lshlrev_b32 v242, 16, v255
v_and_b32 v243, 0xffff0000, v255
v_mul_f32 v242, v242, v239
v_mul_f32 v243, v243, v239
v_cvt_pk_bf16_f32 v255, v242, v243
ds_write_b64 v253, v[254:255] offset:3072
s_waitcnt lgkmcnt(0)
ds_read_b64 v[254:255], v253 offset:3080
s_waitcnt lgkmcnt(0)
v_lshlrev_b32 v242, 16, v254
v_and_b32 v243, 0xffff0000, v254
v_mul_f32 v242, v242, v239
v_mul_f32 v243, v243, v239
v_cvt_pk_bf16_f32 v254, v242, v243
v_lshlrev_b32 v242, 16, v255
v_and_b32 v243, 0xffff0000, v255
v_mul_f32 v242, v242, v239
v_mul_f32 v243, v243, v239
v_cvt_pk_bf16_f32 v255, v242, v243
ds_write_b64 v253, v[254:255] offset:3080
s_waitcnt lgkmcnt(0)
ds_read_b64 v[254:255], v253 offset:7168
s_waitcnt lgkmcnt(0)
v_lshlrev_b32 v242, 16, v254
v_and_b32 v243, 0xffff0000, v254
v_mul_f32 v242, v242, v239
v_mul_f32 v243, v243, v239
v_cvt_pk_bf16_f32 v254, v242, v243
v_lshlrev_b32 v242, 16, v255
v_and_b32 v243, 0xffff0000, v255
v_mul_f32 v242, v242, v239
v_mul_f32 v243, v243, v239
v_cvt_pk_bf16_f32 v255, v242, v243
ds_write_b64 v253, v[254:255] offset:7168
s_waitcnt lgkmcnt(0)
ds_read_b64 v[254:255], v253 offset:7176
s_waitcnt lgkmcnt(0)
v_lshlrev_b32 v242, 16, v254
v_and_b32 v243, 0xffff0000, v254
v_mul_f32 v242, v242, v239
v_mul_f32 v243, v243, v239
v_cvt_pk_bf16_f32 v254, v242, v243
v_lshlrev_b32 v242, 16, v255
v_and_b32 v243, 0xffff0000, v255
v_mul_f32 v242, v242, v239
v_mul_f32 v243, v243, v239
v_cvt_pk_bf16_f32 v255, v242, v243
ds_write_b64 v253, v[254:255] offset:7176
s_waitcnt lgkmcnt(0)
v_exp_f32 v232, v128
v_exp_f32 v233, v129
v_exp_f32 v234, v130
v_exp_f32 v235, v131
s_nop 1
v_add_f32 v228, v224, v232
v_add_f32 v228, v228, v233
v_add_f32 v228, v228, v234
v_add_f32 v228, v228, v235
v_cvt_pk_bf16_f32 v176, v232, v233
v_cvt_pk_bf16_f32 v177, v234, v235
v_exp_f32 v232, v132
v_exp_f32 v233, v133
v_exp_f32 v234, v134
v_exp_f32 v235, v135
s_nop 1
v_add_f32 v229, v225, v232
v_add_f32 v229, v229, v233
v_add_f32 v229, v229, v234
v_add_f32 v229, v229, v235
v_cvt_pk_bf16_f32 v180, v232, v233
v_cvt_pk_bf16_f32 v181, v234, v235
v_exp_f32 v232, v136
v_exp_f32 v233, v137
v_exp_f32 v234, v138
v_exp_f32 v235, v139
s_nop 1
v_add_f32 v230, v226, v232
v_add_f32 v230, v230, v233
v_add_f32 v230, v230, v234
v_add_f32 v230, v230, v235
v_cvt_pk_bf16_f32 v184, v232, v233
v_cvt_pk_bf16_f32 v185, v234, v235
v_exp_f32 v232, v140
v_exp_f32 v233, v141
v_exp_f32 v234, v142
v_exp_f32 v235, v143
s_nop 1
v_add_f32 v231, v227, v232
v_add_f32 v231, v231, v233
v_add_f32 v231, v231, v234
v_add_f32 v231, v231, v235
v_cvt_pk_bf16_f32 v188, v232, v233
v_cvt_pk_bf16_f32 v189, v234, v235
s_branch L2_rare_common
L2_rare_site15:
s_mov_b32 s36, 15
s_branch L2_rare_t0_3_1
L2_rare_t0_3_1:
s_nop 15
s_nop 15
s_waitcnt lgkmcnt(0)
v_log_f32 v243, v228
v_max3_f32 v232, v144, v145, v146
v_max3_f32 v232, v232, v147, v243
v_mov_b32 v243, v232
s_nop 1
v_permlane32_swap_b32 v232, v243
s_nop 1
v_max_f32 v232, v232, v243
v_mov_b32 v243, v232
s_nop 1
v_permlane16_swap_b32 v232, v243
s_nop 1
v_max_f32 v232, v232, v243
v_ceil_f32 v232, v232
v_max_f32 v232, 0, v232
v_sub_f32 v243, 0, v232
v_exp_f32 v236, v243
s_nop 1
v_mul_f32 v228, v228, v236
v_sub_f32 v192, v192, v232
v_sub_f32 v128, v128, v232
v_sub_f32 v144, v144, v232
v_sub_f32 v193, v193, v232
v_sub_f32 v129, v129, v232
v_sub_f32 v145, v145, v232
v_sub_f32 v194, v194, v232
v_sub_f32 v130, v130, v232
v_sub_f32 v146, v146, v232
v_sub_f32 v195, v195, v232
v_sub_f32 v131, v131, v232
v_sub_f32 v147, v147, v232
v_lshlrev_b32 v242, 16, v160
v_and_b32 v243, 0xffff0000, v160
v_mul_f32 v242, v242, v236
v_mul_f32 v243, v243, v236
v_cvt_pk_bf16_f32 v160, v242, v243
v_lshlrev_b32 v242, 16, v161
v_and_b32 v243, 0xffff0000, v161
v_mul_f32 v242, v242, v236
v_mul_f32 v243, v243, v236
v_cvt_pk_bf16_f32 v161, v242, v243
v_lshlrev_b32 v242, 16, v162
v_and_b32 v243, 0xffff0000, v162
v_mul_f32 v242, v242, v236
v_mul_f32 v243, v243, v236
v_cvt_pk_bf16_f32 v162, v242, v243
v_lshlrev_b32 v242, 16, v163
v_and_b32 v243, 0xffff0000, v163
v_mul_f32 v242, v242, v236
v_mul_f32 v243, v243, v236
v_cvt_pk_bf16_f32 v163, v242, v243
v_lshlrev_b32 v242, 16, v176
v_and_b32 v243, 0xffff0000, v176
v_mul_f32 v242, v242, v236
v_mul_f32 v243, v243, v236
v_cvt_pk_bf16_f32 v176, v242, v243
v_lshlrev_b32 v242, 16, v177
v_and_b32 v243, 0xffff0000, v177
v_mul_f32 v242, v242, v236
v_mul_f32 v243, v243, v236
v_cvt_pk_bf16_f32 v177, v242, v243
ds_read_b64 v[254:255], v253 offset:0
s_waitcnt lgkmcnt(0)
v_lshlrev_b32 v242, 16, v254
v_and_b32 v243, 0xffff0000, v254
v_mul_f32 v242, v242, v236
v_mul_f32 v243, v243, v236
v_cvt_pk_bf16_f32 v254, v242, v243
v_lshlrev_b32 v242, 16, v255
v_and_b32 v243, 0xffff0000, v255
v_mul_f32 v242, v242, v236
v_mul_f32 v243, v243, v236
v_cvt_pk_bf16_f32 v255, v242, v243
ds_write_b64 v253, v[254:255] offset:0
s_waitcnt lgkmcnt(0)
ds_read_b64 v[254:255], v253 offset:8
s_waitcnt lgkmcnt(0)
v_lshlrev_b32 v242, 16, v254
v_and_b32 v243, 0xffff0000, v254
v_mul_f32 v242, v242, v236
v_mul_f32 v243, v243, v236
v_cvt_pk_bf16_f32 v254, v242, v243
v_lshlrev_b32 v242, 16, v255
v_and_b32 v243, 0xffff0000, v255
v_mul_f32 v242, v242, v236
v_mul_f32 v243, v243, v236
v_cvt_pk_bf16_f32 v255, v242, v243
ds_write_b64 v253, v[254:255] offset:8
s_waitcnt lgkmcnt(0)
ds_read_b64 v[254:255], v253 offset:4096
s_waitcnt lgkmcnt(0)
v_lshlrev_b32 v242, 16, v254
v_and_b32 v243, 0xffff0000, v254
v_mul_f32 v242, v242, v236
v_mul_f32 v243, v243, v236
v_cvt_pk_bf16_f32 v254, v242, v243
v_lshlrev_b32 v242, 16, v255
v_and_b32 v243, 0xffff0000, v255
v_mul_f32 v242, v242, v236
v_mul_f32 v243, v243, v236
v_cvt_pk_bf16_f32 v255, v242, v243
ds_write_b64 v253, v[254:255] offset:4096
s_waitcnt lgkmcnt(0)
ds_read_b64 v[254:255], v253 offset:4104
s_waitcnt lgkmcnt(0)
v_lshlrev_b32 v242, 16, v254
v_and_b32 v243, 0xffff0000, v254
v_mul_f32 v242, v242, v236
v_mul_f32 v243, v243, v236
v_cvt_pk_bf16_f32 v254, v242, v243
v_lshlrev_b32 v242, 16, v255
v_and_b32 v243, 0xffff0000, v255
v_mul_f32 v242, v242, v236
v_mul_f32 v243, v243, v236
v_cvt_pk_bf16_f32 v255, v242, v243
ds_write_b64 v253, v[254:255] offset:4104
s_waitcnt lgkmcnt(0)
v_log_f32 v243, v229
v_max3_f32 v233, v148, v149, v150
v_max3_f32 v233, v233, v151, v243
v_mov_b32 v243, v233
s_nop 1
v_permlane32_swap_b32 v233, v243
s_nop 1
v_max_f32 v233, v233, v243
v_mov_b32 v243, v233
s_nop 1
v_permlane16_swap_b32 v233, v243
s_nop 1
v_max_f32 v233, v233, v243
v_ceil_f32 v233, v233
v_max_f32 v233, 0, v233
v_sub_f32 v243, 0, v233
v_exp_f32 v237, v243
s_nop 1
v_mul_f32 v229, v229, v237
v_sub_f32 v196, v196, v233
v_sub_f32 v132, v132, v233
v_sub_f32 v148, v148, v233
v_sub_f32 v197, v197, v233
v_sub_f32 v133, v133, v233
v_sub_f32 v149, v149, v233
v_sub_f32 v198, v198, v233
v_sub_f32 v134, v134, v233
v_sub_f32 v150, v150, v233
v_sub_f32 v199, v199, v233
v_sub_f32 v135, v135, v233
v_sub_f32 v151, v151, v233
v_lshlrev_b32 v242, 16, v164
v_and_b32 v243, 0xffff0000, v164
v_mul_f32 v242, v242, v237
v_mul_f32 v243, v243, v237
v_cvt_pk_bf16_f32 v164, v242, v243
v_lshlrev_b32 v242, 16, v165
v_and_b32 v243, 0xffff0000, v165
v_mul_f32 v242, v242, v237
v_mul_f32 v243, v243, v237
v_cvt_pk_bf16_f32 v165, v242, v243
v_lshlrev_b32 v242, 16, v166
v_and_b32 v243, 0xffff0000, v166
v_mul_f32 v242, v242, v237
v_mul_f32 v243, v243, v237
v_cvt_pk_bf16_f32 v166, v242, v243
v_lshlrev_b32 v242, 16, v167
v_and_b32 v243, 0xffff0000, v167
v_mul_f32 v242, v242, v237
v_mul_f32 v243, v243, v237
v_cvt_pk_bf16_f32 v167, v242, v243
v_lshlrev_b32 v242, 16, v180
v_and_b32 v243, 0xffff0000, v180
v_mul_f32 v242, v242, v237
v_mul_f32 v243, v243, v237
v_cvt_pk_bf16_f32 v180, v242, v243
v_lshlrev_b32 v242, 16, v181
v_and_b32 v243, 0xffff0000, v181
v_mul_f32 v242, v242, v237
v_mul_f32 v243, v243, v237
v_cvt_pk_bf16_f32 v181, v242, v243
ds_read_b64 v[254:255], v253 offset:1024
s_waitcnt lgkmcnt(0)
v_lshlrev_b32 v242, 16, v254
v_and_b32 v243, 0xffff0000, v254
v_mul_f32 v242, v242, v237
v_mul_f32 v243, v243, v237
v_cvt_pk_bf16_f32 v254, v242, v243
v_lshlrev_b32 v242, 16, v255
v_and_b32 v243, 0xffff0000, v255
v_mul_f32 v242, v242, v237
v_mul_f32 v243, v243, v237
v_cvt_pk_bf16_f32 v255, v242, v243
ds_write_b64 v253, v[254:255] offset:1024
s_waitcnt lgkmcnt(0)
ds_read_b64 v[254:255], v253 offset:1032
s_waitcnt lgkmcnt(0)
v_lshlrev_b32 v242, 16, v254
v_and_b32 v243, 0xffff0000, v254
v_mul_f32 v242, v242, v237
v_mul_f32 v243, v243, v237
v_cvt_pk_bf16_f32 v254, v242, v243
v_lshlrev_b32 v242, 16, v255
v_and_b32 v243, 0xffff0000, v255
v_mul_f32 v242, v242, v237
v_mul_f32 v243, v243, v237
v_cvt_pk_bf16_f32 v255, v242, v243
ds_write_b64 v253, v[254:255] offset:1032
s_waitcnt lgkmcnt(0)
ds_read_b64 v[254:255], v253 offset:5120
s_waitcnt lgkmcnt(0)
v_lshlrev_b32 v242, 16, v254
v_and_b32 v243, 0xffff0000, v254
v_mul_f32 v242, v242, v237
v_mul_f32 v243, v243, v237
v_cvt_pk_bf16_f32 v254, v242, v243
v_lshlrev_b32 v242, 16, v255
v_and_b32 v243, 0xffff0000, v255
v_mul_f32 v242, v242, v237
v_mul_f32 v243, v243, v237
v_cvt_pk_bf16_f32 v255, v242, v243
ds_write_b64 v253, v[254:255] offset:5120
s_waitcnt lgkmcnt(0)
ds_read_b64 v[254:255], v253 offset:5128
s_waitcnt lgkmcnt(0)
v_lshlrev_b32 v242, 16, v254
v_and_b32 v243, 0xffff0000, v254
v_mul_f32 v242, v242, v237
v_mul_f32 v243, v243, v237
v_cvt_pk_bf16_f32 v254, v242, v243
v_lshlrev_b32 v242, 16, v255
v_and_b32 v243, 0xffff0000, v255
v_mul_f32 v242, v242, v237
v_mul_f32 v243, v243, v237
v_cvt_pk_bf16_f32 v255, v242, v243
ds_write_b64 v253, v[254:255] offset:5128
s_waitcnt lgkmcnt(0)
v_log_f32 v243, v230
v_max3_f32 v234, v152, v153, v154
v_max3_f32 v234, v234, v155, v243
v_mov_b32 v243, v234
s_nop 1
v_permlane32_swap_b32 v234, v243
s_nop 1
v_max_f32 v234, v234, v243
v_mov_b32 v243, v234
s_nop 1
v_permlane16_swap_b32 v234, v243
s_nop 1
v_max_f32 v234, v234, v243
v_ceil_f32 v234, v234
v_max_f32 v234, 0, v234
v_sub_f32 v243, 0, v234
v_exp_f32 v238, v243
s_nop 1
v_mul_f32 v230, v230, v238
v_sub_f32 v200, v200, v234
v_sub_f32 v136, v136, v234
v_sub_f32 v152, v152, v234
v_sub_f32 v201, v201, v234
v_sub_f32 v137, v137, v234
v_sub_f32 v153, v153, v234
v_sub_f32 v202, v202, v234
v_sub_f32 v138, v138, v234
v_sub_f32 v154, v154, v234
v_sub_f32 v203, v203, v234
v_sub_f32 v139, v139, v234
v_sub_f32 v155, v155, v234
v_lshlrev_b32 v242, 16, v168
v_and_b32 v243, 0xffff0000, v168
v_mul_f32 v242, v242, v238
v_mul_f32 v243, v243, v238
v_cvt_pk_bf16_f32 v168, v242, v243
v_lshlrev_b32 v242, 16, v169
v_and_b32 v243, 0xffff0000, v169
v_mul_f32 v242, v242, v238
v_mul_f32 v243, v243, v238
v_cvt_pk_bf16_f32 v169, v242, v243
v_lshlrev_b32 v242, 16, v170
v_and_b32 v243, 0xffff0000, v170
v_mul_f32 v242, v242, v238
v_mul_f32 v243, v243, v238
v_cvt_pk_bf16_f32 v170, v242, v243
v_lshlrev_b32 v242, 16, v171
v_and_b32 v243, 0xffff0000, v171
v_mul_f32 v242, v242, v238
v_mul_f32 v243, v243, v238
v_cvt_pk_bf16_f32 v171, v242, v243
v_lshlrev_b32 v242, 16, v184
v_and_b32 v243, 0xffff0000, v184
v_mul_f32 v242, v242, v238
v_mul_f32 v243, v243, v238
v_cvt_pk_bf16_f32 v184, v242, v243
v_lshlrev_b32 v242, 16, v185
v_and_b32 v243, 0xffff0000, v185
v_mul_f32 v242, v242, v238
v_mul_f32 v243, v243, v238
v_cvt_pk_bf16_f32 v185, v242, v243
ds_read_b64 v[254:255], v253 offset:2048
s_waitcnt lgkmcnt(0)
v_lshlrev_b32 v242, 16, v254
v_and_b32 v243, 0xffff0000, v254
v_mul_f32 v242, v242, v238
v_mul_f32 v243, v243, v238
v_cvt_pk_bf16_f32 v254, v242, v243
v_lshlrev_b32 v242, 16, v255
v_and_b32 v243, 0xffff0000, v255
v_mul_f32 v242, v242, v238
v_mul_f32 v243, v243, v238
v_cvt_pk_bf16_f32 v255, v242, v243
ds_write_b64 v253, v[254:255] offset:2048
s_waitcnt lgkmcnt(0)
ds_read_b64 v[254:255], v253 offset:2056
s_waitcnt lgkmcnt(0)
v_lshlrev_b32 v242, 16, v254
v_and_b32 v243, 0xffff0000, v254
v_mul_f32 v242, v242, v238
v_mul_f32 v243, v243, v238
v_cvt_pk_bf16_f32 v254, v242, v243
v_lshlrev_b32 v242, 16, v255
v_and_b32 v243, 0xffff0000, v255
v_mul_f32 v242, v242, v238
v_mul_f32 v243, v243, v238
v_cvt_pk_bf16_f32 v255, v242, v243
ds_write_b64 v253, v[254:255] offset:2056
s_waitcnt lgkmcnt(0)
ds_read_b64 v[254:255], v253 offset:6144
s_waitcnt lgkmcnt(0)
v_lshlrev_b32 v242, 16, v254
v_and_b32 v243, 0xffff0000, v254
v_mul_f32 v242, v242, v238
v_mul_f32 v243, v243, v238
v_cvt_pk_bf16_f32 v254, v242, v243
v_lshlrev_b32 v242, 16, v255
v_and_b32 v243, 0xffff0000, v255
v_mul_f32 v242, v242, v238
v_mul_f32 v243, v243, v238
v_cvt_pk_bf16_f32 v255, v242, v243
ds_write_b64 v253, v[254:255] offset:6144
s_waitcnt lgkmcnt(0)
ds_read_b64 v[254:255], v253 offset:6152
s_waitcnt lgkmcnt(0)
v_lshlrev_b32 v242, 16, v254
v_and_b32 v243, 0xffff0000, v254
v_mul_f32 v242, v242, v238
v_mul_f32 v243, v243, v238
v_cvt_pk_bf16_f32 v254, v242, v243
v_lshlrev_b32 v242, 16, v255
v_and_b32 v243, 0xffff0000, v255
v_mul_f32 v242, v242, v238
v_mul_f32 v243, v243, v238
v_cvt_pk_bf16_f32 v255, v242, v243
ds_write_b64 v253, v[254:255] offset:6152
s_waitcnt lgkmcnt(0)
v_log_f32 v243, v231
v_max3_f32 v235, v156, v157, v158
v_max3_f32 v235, v235, v159, v243
v_mov_b32 v243, v235
s_nop 1
v_permlane32_swap_b32 v235, v243
s_nop 1
v_max_f32 v235, v235, v243
v_mov_b32 v243, v235
s_nop 1
v_permlane16_swap_b32 v235, v243
s_nop 1
v_max_f32 v235, v235, v243
v_ceil_f32 v235, v235
v_max_f32 v235, 0, v235
v_sub_f32 v243, 0, v235
v_exp_f32 v239, v243
s_nop 1
v_mul_f32 v231, v231, v239
v_sub_f32 v204, v204, v235
v_sub_f32 v140, v140, v235
v_sub_f32 v156, v156, v235
v_sub_f32 v205, v205, v235
v_sub_f32 v141, v141, v235
v_sub_f32 v157, v157, v235
v_sub_f32 v206, v206, v235
v_sub_f32 v142, v142, v235
v_sub_f32 v158, v158, v235
v_sub_f32 v207, v207, v235
v_sub_f32 v143, v143, v235
v_sub_f32 v159, v159, v235
v_lshlrev_b32 v242, 16, v172
v_and_b32 v243, 0xffff0000, v172
v_mul_f32 v242, v242, v239
v_mul_f32 v243, v243, v239
v_cvt_pk_bf16_f32 v172, v242, v243
v_lshlrev_b32 v242, 16, v173
v_and_b32 v243, 0xffff0000, v173
v_mul_f32 v242, v242, v239
v_mul_f32 v243, v243, v239
v_cvt_pk_bf16_f32 v173, v242, v243
v_lshlrev_b32 v242, 16, v174
v_and_b32 v243, 0xffff0000, v174
v_mul_f32 v242, v242, v239
v_mul_f32 v243, v243, v239
v_cvt_pk_bf16_f32 v174, v242, v243
v_lshlrev_b32 v242, 16, v175
v_and_b32 v243, 0xffff0000, v175
v_mul_f32 v242, v242, v239
v_mul_f32 v243, v243, v239
v_cvt_pk_bf16_f32 v175, v242, v243
v_lshlrev_b32 v242, 16, v188
v_and_b32 v243, 0xffff0000, v188
v_mul_f32 v242, v242, v239
v_mul_f32 v243, v243, v239
v_cvt_pk_bf16_f32 v188, v242, v243
v_lshlrev_b32 v242, 16, v189
v_and_b32 v243, 0xffff0000, v189
v_mul_f32 v242, v242, v239
v_mul_f32 v243, v243, v239
v_cvt_pk_bf16_f32 v189, v242, v243
ds_read_b64 v[254:255], v253 offset:3072
s_waitcnt lgkmcnt(0)
v_lshlrev_b32 v242, 16, v254
v_and_b32 v243, 0xffff0000, v254
v_mul_f32 v242, v242, v239
v_mul_f32 v243, v243, v239
v_cvt_pk_bf16_f32 v254, v242, v243
v_lshlrev_b32 v242, 16, v255
v_and_b32 v243, 0xffff0000, v255
v_mul_f32 v242, v242, v239
v_mul_f32 v243, v243, v239
v_cvt_pk_bf16_f32 v255, v242, v243
ds_write_b64 v253, v[254:255] offset:3072
s_waitcnt lgkmcnt(0)
ds_read_b64 v[254:255], v253 offset:3080
s_waitcnt lgkmcnt(0)
v_lshlrev_b32 v242, 16, v254
v_and_b32 v243, 0xffff0000, v254
v_mul_f32 v242, v242, v239
v_mul_f32 v243, v243, v239
v_cvt_pk_bf16_f32 v254, v242, v243
v_lshlrev_b32 v242, 16, v255
v_and_b32 v243, 0xffff0000, v255
v_mul_f32 v242, v242, v239
v_mul_f32 v243, v243, v239
v_cvt_pk_bf16_f32 v255, v242, v243
ds_write_b64 v253, v[254:255] offset:3080
s_waitcnt lgkmcnt(0)
ds_read_b64 v[254:255], v253 offset:7168
s_waitcnt lgkmcnt(0)
v_lshlrev_b32 v242, 16, v254
v_and_b32 v243, 0xffff0000, v254
v_mul_f32 v242, v242, v239
v_mul_f32 v243, v243, v239
v_cvt_pk_bf16_f32 v254, v242, v243
v_lshlrev_b32 v242, 16, v255
v_and_b32 v243, 0xffff0000, v255
v_mul_f32 v242, v242, v239
v_mul_f32 v243, v243, v239
v_cvt_pk_bf16_f32 v255, v242, v243
ds_write_b64 v253, v[254:255] offset:7168
s_waitcnt lgkmcnt(0)
ds_read_b64 v[254:255], v253 offset:7176
s_waitcnt lgkmcnt(0)
v_lshlrev_b32 v242, 16, v254
v_and_b32 v243, 0xffff0000, v254
v_mul_f32 v242, v242, v239
v_mul_f32 v243, v243, v239
v_cvt_pk_bf16_f32 v254, v242, v243
v_lshlrev_b32 v242, 16, v255
v_and_b32 v243, 0xffff0000, v255
v_mul_f32 v242, v242, v239
v_mul_f32 v243, v243, v239
v_cvt_pk_bf16_f32 v255, v242, v243
ds_write_b64 v253, v[254:255] offset:7176
s_waitcnt lgkmcnt(0)
v_exp_f32 v232, v144
v_exp_f32 v233, v145
v_exp_f32 v234, v146
v_exp_f32 v235, v147
s_nop 1
v_add_f32 v224, v228, v232
v_add_f32 v224, v224, v233
v_add_f32 v224, v224, v234
v_add_f32 v224, v224, v235
v_cvt_pk_bf16_f32 v178, v232, v233
v_cvt_pk_bf16_f32 v179, v234, v235
v_exp_f32 v232, v148
v_exp_f32 v233, v149
v_exp_f32 v234, v150
v_exp_f32 v235, v151
s_nop 1
v_add_f32 v225, v229, v232
v_add_f32 v225, v225, v233
v_add_f32 v225, v225, v234
v_add_f32 v225, v225, v235
v_cvt_pk_bf16_f32 v182, v232, v233
v_cvt_pk_bf16_f32 v183, v234, v235
v_exp_f32 v232, v152
v_exp_f32 v233, v153
v_exp_f32 v234, v154
v_exp_f32 v235, v155
s_nop 1
v_add_f32 v226, v230, v232
v_add_f32 v226, v226, v233
v_add_f32 v226, v226, v234
v_add_f32 v226, v226, v235
v_cvt_pk_bf16_f32 v186, v232, v233
v_cvt_pk_bf16_f32 v187, v234, v235
v_exp_f32 v232, v156
v_exp_f32 v233, v157
v_exp_f32 v234, v158
v_exp_f32 v235, v159
s_nop 1
v_add_f32 v227, v231, v232
v_add_f32 v227, v227, v233
v_add_f32 v227, v227, v234
v_add_f32 v227, v227, v235
v_cvt_pk_bf16_f32 v190, v232, v233
v_cvt_pk_bf16_f32 v191, v234, v235
s_branch L2_rare_common
L2_rare_site16:
s_mov_b32 s36, 16
s_branch L2_rare_t0_4_0
L2_rare_t0_4_0:
s_nop 15
s_nop 15
s_waitcnt lgkmcnt(0)
v_log_f32 v243, v224
v_max3_f32 v232, v128, v129, v130
v_max3_f32 v232, v232, v131, v243
v_mov_b32 v243, v232
s_nop 1
v_permlane32_swap_b32 v232, v243
s_nop 1
v_max_f32 v232, v232, v243
v_mov_b32 v243, v232
s_nop 1
v_permlane16_swap_b32 v232, v243
s_nop 1
v_max_f32 v232, v232, v243
v_ceil_f32 v232, v232
v_max_f32 v232, 0, v232
v_sub_f32 v243, 0, v232
v_exp_f32 v236, v243
s_nop 1
v_mul_f32 v224, v224, v236
v_sub_f32 v192, v192, v232
v_sub_f32 v128, v128, v232
v_sub_f32 v144, v144, v232
v_sub_f32 v193, v193, v232
v_sub_f32 v129, v129, v232
v_sub_f32 v145, v145, v232
v_sub_f32 v194, v194, v232
v_sub_f32 v130, v130, v232
v_sub_f32 v146, v146, v232
v_sub_f32 v195, v195, v232
v_sub_f32 v131, v131, v232
v_sub_f32 v147, v147, v232
v_lshlrev_b32 v242, 16, v4
v_and_b32 v243, 0xffff0000, v4
v_mul_f32 v242, v242, v236
v_mul_f32 v243, v243, v236
v_cvt_pk_bf16_f32 v4, v242, v243
v_lshlrev_b32 v242, 16, v5
v_and_b32 v243, 0xffff0000, v5
v_mul_f32 v242, v242, v236
v_mul_f32 v243, v243, v236
v_cvt_pk_bf16_f32 v5, v242, v243
v_lshlrev_b32 v242, 16, v6
v_and_b32 v243, 0xffff0000, v6
v_mul_f32 v242, v242, v236
v_mul_f32 v243, v243, v236
v_cvt_pk_bf16_f32 v6, v242, v243
v_lshlrev_b32 v242, 16, v7
v_and_b32 v243, 0xffff0000, v7
v_mul_f32 v242, v242, v236
v_mul_f32 v243, v243, v236
v_cvt_pk_bf16_f32 v7, v242, v243
v_lshlrev_b32 v242, 16, v8
v_and_b32 v243, 0xffff0000, v8
v_mul_f32 v242, v242, v236
v_mul_f32 v243, v243, v236
v_cvt_pk_bf16_f32 v8, v242, v243
v_lshlrev_b32 v242, 16, v9
v_and_b32 v243, 0xffff0000, v9
v_mul_f32 v242, v242, v236
v_mul_f32 v243, v243, v236
v_cvt_pk_bf16_f32 v9, v242, v243
v_lshlrev_b32 v242, 16, v10
v_and_b32 v243, 0xffff0000, v10
v_mul_f32 v242, v242, v236
v_mul_f32 v243, v243, v236
v_cvt_pk_bf16_f32 v10, v242, v243
v_lshlrev_b32 v242, 16, v11
v_and_b32 v243, 0xffff0000, v11
v_mul_f32 v242, v242, v236
v_mul_f32 v243, v243, v236
v_cvt_pk_bf16_f32 v11, v242, v243
v_lshlrev_b32 v242, 16, v160
v_and_b32 v243, 0xffff0000, v160
v_mul_f32 v242, v242, v236
v_mul_f32 v243, v243, v236
v_cvt_pk_bf16_f32 v160, v242, v243
v_lshlrev_b32 v242, 16, v161
v_and_b32 v243, 0xffff0000, v161
v_mul_f32 v242, v242, v236
v_mul_f32 v243, v243, v236
v_cvt_pk_bf16_f32 v161, v242, v243
v_lshlrev_b32 v242, 16, v162
v_and_b32 v243, 0xffff0000, v162
v_mul_f32 v242, v242, v236
v_mul_f32 v243, v243, v236
v_cvt_pk_bf16_f32 v162, v242, v243
v_lshlrev_b32 v242, 16, v163
v_and_b32 v243, 0xffff0000, v163
v_mul_f32 v242, v242, v236
v_mul_f32 v243, v243, v236
v_cvt_pk_bf16_f32 v163, v242, v243
v_lshlrev_b32 v242, 16, v176
v_and_b32 v243, 0xffff0000, v176
v_mul_f32 v242, v242, v236
v_mul_f32 v243, v243, v236
v_cvt_pk_bf16_f32 v176, v242, v243
v_lshlrev_b32 v242, 16, v177
v_and_b32 v243, 0xffff0000, v177
v_mul_f32 v242, v242, v236
v_mul_f32 v243, v243, v236
v_cvt_pk_bf16_f32 v177, v242, v243
v_lshlrev_b32 v242, 16, v178
v_and_b32 v243, 0xffff0000, v178
v_mul_f32 v242, v242, v236
v_mul_f32 v243, v243, v236
v_cvt_pk_bf16_f32 v178, v242, v243
v_lshlrev_b32 v242, 16, v179
v_and_b32 v243, 0xffff0000, v179
v_mul_f32 v242, v242, v236
v_mul_f32 v243, v243, v236
v_cvt_pk_bf16_f32 v179, v242, v243
v_log_f32 v243, v225
v_max3_f32 v233, v132, v133, v134
v_max3_f32 v233, v233, v135, v243
v_mov_b32 v243, v233
s_nop 1
v_permlane32_swap_b32 v233, v243
s_nop 1
v_max_f32 v233, v233, v243
v_mov_b32 v243, v233
s_nop 1
v_permlane16_swap_b32 v233, v243
s_nop 1
v_max_f32 v233, v233, v243
v_ceil_f32 v233, v233
v_max_f32 v233, 0, v233
v_sub_f32 v243, 0, v233
v_exp_f32 v237, v243
s_nop 1
v_mul_f32 v225, v225, v237
v_sub_f32 v196, v196, v233
v_sub_f32 v132, v132, v233
v_sub_f32 v148, v148, v233
v_sub_f32 v197, v197, v233
v_sub_f32 v133, v133, v233
v_sub_f32 v149, v149, v233
v_sub_f32 v198, v198, v233
v_sub_f32 v134, v134, v233
v_sub_f32 v150, v150, v233
v_sub_f32 v199, v199, v233
v_sub_f32 v135, v135, v233
v_sub_f32 v151, v151, v233
v_lshlrev_b32 v242, 16, v36
v_and_b32 v243, 0xffff0000, v36
v_mul_f32 v242, v242, v237
v_mul_f32 v243, v243, v237
v_cvt_pk_bf16_f32 v36, v242, v243
v_lshlrev_b32 v242, 16, v37
v_and_b32 v243, 0xffff0000, v37
v_mul_f32 v242, v242, v237
v_mul_f32 v243, v243, v237
v_cvt_pk_bf16_f32 v37, v242, v243
v_lshlrev_b32 v242, 16, v38
v_and_b32 v243, 0xffff0000, v38
v_mul_f32 v242, v242, v237
v_mul_f32 v243, v243, v237
v_cvt_pk_bf16_f32 v38, v242, v243
v_lshlrev_b32 v242, 16, v39
v_and_b32 v243, 0xffff0000, v39
v_mul_f32 v242, v242, v237
v_mul_f32 v243, v243, v237
v_cvt_pk_bf16_f32 v39, v242, v243
v_lshlrev_b32 v242, 16, v40
v_and_b32 v243, 0xffff0000, v40
v_mul_f32 v242, v242, v237
v_mul_f32 v243, v243, v237
v_cvt_pk_bf16_f32 v40, v242, v243
v_lshlrev_b32 v242, 16, v41
v_and_b32 v243, 0xffff0000, v41
v_mul_f32 v242, v242, v237
v_mul_f32 v243, v243, v237
v_cvt_pk_bf16_f32 v41, v242, v243
v_lshlrev_b32 v242, 16, v42
v_and_b32 v243, 0xffff0000, v42
v_mul_f32 v242, v242, v237
v_mul_f32 v243, v243, v237
v_cvt_pk_bf16_f32 v42, v242, v243
v_lshlrev_b32 v242, 16, v43
v_and_b32 v243, 0xffff0000, v43
v_mul_f32 v242, v242, v237
v_mul_f32 v243, v243, v237
v_cvt_pk_bf16_f32 v43, v242, v243
v_lshlrev_b32 v242, 16, v164
v_and_b32 v243, 0xffff0000, v164
v_mul_f32 v242, v242, v237
v_mul_f32 v243, v243, v237
v_cvt_pk_bf16_f32 v164, v242, v243
v_lshlrev_b32 v242, 16, v165
v_and_b32 v243, 0xffff0000, v165
v_mul_f32 v242, v242, v237
v_mul_f32 v243, v243, v237
v_cvt_pk_bf16_f32 v165, v242, v243
v_lshlrev_b32 v242, 16, v166
v_and_b32 v243, 0xffff0000, v166
v_mul_f32 v242, v242, v237
v_mul_f32 v243, v243, v237
v_cvt_pk_bf16_f32 v166, v242, v243
v_lshlrev_b32 v242, 16, v167
v_and_b32 v243, 0xffff0000, v167
v_mul_f32 v242, v242, v237
v_mul_f32 v243, v243, v237
v_cvt_pk_bf16_f32 v167, v242, v243
v_lshlrev_b32 v242, 16, v180
v_and_b32 v243, 0xffff0000, v180
v_mul_f32 v242, v242, v237
v_mul_f32 v243, v243, v237
v_cvt_pk_bf16_f32 v180, v242, v243
v_lshlrev_b32 v242, 16, v181
v_and_b32 v243, 0xffff0000, v181
v_mul_f32 v242, v242, v237
v_mul_f32 v243, v243, v237
v_cvt_pk_bf16_f32 v181, v242, v243
v_lshlrev_b32 v242, 16, v182
v_and_b32 v243, 0xffff0000, v182
v_mul_f32 v242, v242, v237
v_mul_f32 v243, v243, v237
v_cvt_pk_bf16_f32 v182, v242, v243
v_lshlrev_b32 v242, 16, v183
v_and_b32 v243, 0xffff0000, v183
v_mul_f32 v242, v242, v237
v_mul_f32 v243, v243, v237
v_cvt_pk_bf16_f32 v183, v242, v243
v_log_f32 v243, v226
v_max3_f32 v234, v136, v137, v138
v_max3_f32 v234, v234, v139, v243
v_mov_b32 v243, v234
s_nop 1
v_permlane32_swap_b32 v234, v243
s_nop 1
v_max_f32 v234, v234, v243
v_mov_b32 v243, v234
s_nop 1
v_permlane16_swap_b32 v234, v243
s_nop 1
v_max_f32 v234, v234, v243
v_ceil_f32 v234, v234
v_max_f32 v234, 0, v234
v_sub_f32 v243, 0, v234
v_exp_f32 v238, v243
s_nop 1
v_mul_f32 v226, v226, v238
v_sub_f32 v200, v200, v234
v_sub_f32 v136, v136, v234
v_sub_f32 v152, v152, v234
v_sub_f32 v201, v201, v234
v_sub_f32 v137, v137, v234
v_sub_f32 v153, v153, v234
v_sub_f32 v202, v202, v234
v_sub_f32 v138, v138, v234
v_sub_f32 v154, v154, v234
v_sub_f32 v203, v203, v234
v_sub_f32 v139, v139, v234
v_sub_f32 v155, v155, v234
v_lshlrev_b32 v242, 16, v68
v_and_b32 v243, 0xffff0000, v68
v_mul_f32 v242, v242, v238
v_mul_f32 v243, v243, v238
v_cvt_pk_bf16_f32 v68, v242, v243
v_lshlrev_b32 v242, 16, v69
v_and_b32 v243, 0xffff0000, v69
v_mul_f32 v242, v242, v238
v_mul_f32 v243, v243, v238
v_cvt_pk_bf16_f32 v69, v242, v243
v_lshlrev_b32 v242, 16, v70
v_and_b32 v243, 0xffff0000, v70
v_mul_f32 v242, v242, v238
v_mul_f32 v243, v243, v238
v_cvt_pk_bf16_f32 v70, v242, v243
v_lshlrev_b32 v242, 16, v71
v_and_b32 v243, 0xffff0000, v71
v_mul_f32 v242, v242, v238
v_mul_f32 v243, v243, v238
v_cvt_pk_bf16_f32 v71, v242, v243
v_lshlrev_b32 v242, 16, v72
v_and_b32 v243, 0xffff0000, v72
v_mul_f32 v242, v242, v238
v_mul_f32 v243, v243, v238
v_cvt_pk_bf16_f32 v72, v242, v243
v_lshlrev_b32 v242, 16, v73
v_and_b32 v243, 0xffff0000, v73
v_mul_f32 v242, v242, v238
v_mul_f32 v243, v243, v238
v_cvt_pk_bf16_f32 v73, v242, v243
v_lshlrev_b32 v242, 16, v74
v_and_b32 v243, 0xffff0000, v74
v_mul_f32 v242, v242, v238
v_mul_f32 v243, v243, v238
v_cvt_pk_bf16_f32 v74, v242, v243
v_lshlrev_b32 v242, 16, v75
v_and_b32 v243, 0xffff0000, v75
v_mul_f32 v242, v242, v238
v_mul_f32 v243, v243, v238
v_cvt_pk_bf16_f32 v75, v242, v243
v_lshlrev_b32 v242, 16, v168
v_and_b32 v243, 0xffff0000, v168
v_mul_f32 v242, v242, v238
v_mul_f32 v243, v243, v238
v_cvt_pk_bf16_f32 v168, v242, v243
v_lshlrev_b32 v242, 16, v169
v_and_b32 v243, 0xffff0000, v169
v_mul_f32 v242, v242, v238
v_mul_f32 v243, v243, v238
v_cvt_pk_bf16_f32 v169, v242, v243
v_lshlrev_b32 v242, 16, v170
v_and_b32 v243, 0xffff0000, v170
v_mul_f32 v242, v242, v238
v_mul_f32 v243, v243, v238
v_cvt_pk_bf16_f32 v170, v242, v243
v_lshlrev_b32 v242, 16, v171
v_and_b32 v243, 0xffff0000, v171
v_mul_f32 v242, v242, v238
v_mul_f32 v243, v243, v238
v_cvt_pk_bf16_f32 v171, v242, v243
v_lshlrev_b32 v242, 16, v184
v_and_b32 v243, 0xffff0000, v184
v_mul_f32 v242, v242, v238
v_mul_f32 v243, v243, v238
v_cvt_pk_bf16_f32 v184, v242, v243
v_lshlrev_b32 v242, 16, v185
v_and_b32 v243, 0xffff0000, v185
v_mul_f32 v242, v242, v238
v_mul_f32 v243, v243, v238
v_cvt_pk_bf16_f32 v185, v242, v243
v_lshlrev_b32 v242, 16, v186
v_and_b32 v243, 0xffff0000, v186
v_mul_f32 v242, v242, v238
v_mul_f32 v243, v243, v238
v_cvt_pk_bf16_f32 v186, v242, v243
v_lshlrev_b32 v242, 16, v187
v_and_b32 v243, 0xffff0000, v187
v_mul_f32 v242, v242, v238
v_mul_f32 v243, v243, v238
v_cvt_pk_bf16_f32 v187, v242, v243
v_log_f32 v243, v227
v_max3_f32 v235, v140, v141, v142
v_max3_f32 v235, v235, v143, v243
v_mov_b32 v243, v235
s_nop 1
v_permlane32_swap_b32 v235, v243
s_nop 1
v_max_f32 v235, v235, v243
v_mov_b32 v243, v235
s_nop 1
v_permlane16_swap_b32 v235, v243
s_nop 1
v_max_f32 v235, v235, v243
v_ceil_f32 v235, v235
v_max_f32 v235, 0, v235
v_sub_f32 v243, 0, v235
v_exp_f32 v239, v243
s_nop 1
v_mul_f32 v227, v227, v239
v_sub_f32 v204, v204, v235
v_sub_f32 v140, v140, v235
v_sub_f32 v156, v156, v235
v_sub_f32 v205, v205, v235
v_sub_f32 v141, v141, v235
v_sub_f32 v157, v157, v235
v_sub_f32 v206, v206, v235
v_sub_f32 v142, v142, v235
v_sub_f32 v158, v158, v235
v_sub_f32 v207, v207, v235
v_sub_f32 v143, v143, v235
v_sub_f32 v159, v159, v235
v_lshlrev_b32 v242, 16, v100
v_and_b32 v243, 0xffff0000, v100
v_mul_f32 v242, v242, v239
v_mul_f32 v243, v243, v239
v_cvt_pk_bf16_f32 v100, v242, v243
v_lshlrev_b32 v242, 16, v101
v_and_b32 v243, 0xffff0000, v101
v_mul_f32 v242, v242, v239
v_mul_f32 v243, v243, v239
v_cvt_pk_bf16_f32 v101, v242, v243
v_lshlrev_b32 v242, 16, v102
v_and_b32 v243, 0xffff0000, v102
v_mul_f32 v242, v242, v239
v_mul_f32 v243, v243, v239
v_cvt_pk_bf16_f32 v102, v242, v243
v_lshlrev_b32 v242, 16, v103
v_and_b32 v243, 0xffff0000, v103
v_mul_f32 v242, v242, v239
v_mul_f32 v243, v243, v239
v_cvt_pk_bf16_f32 v103, v242, v243
v_lshlrev_b32 v242, 16, v104
v_and_b32 v243, 0xffff0000, v104
v_mul_f32 v242, v242, v239
v_mul_f32 v243, v243, v239
v_cvt_pk_bf16_f32 v104, v242, v243
v_lshlrev_b32 v242, 16, v105
v_and_b32 v243, 0xffff0000, v105
v_mul_f32 v242, v242, v239
v_mul_f32 v243, v243, v239
v_cvt_pk_bf16_f32 v105, v242, v243
v_lshlrev_b32 v242, 16, v106
v_and_b32 v243, 0xffff0000, v106
v_mul_f32 v242, v242, v239
v_mul_f32 v243, v243, v239
v_cvt_pk_bf16_f32 v106, v242, v243
v_lshlrev_b32 v242, 16, v107
v_and_b32 v243, 0xffff0000, v107
v_mul_f32 v242, v242, v239
v_mul_f32 v243, v243, v239
v_cvt_pk_bf16_f32 v107, v242, v243
v_lshlrev_b32 v242, 16, v172
v_and_b32 v243, 0xffff0000, v172
v_mul_f32 v242, v242, v239
v_mul_f32 v243, v243, v239
v_cvt_pk_bf16_f32 v172, v242, v243
v_lshlrev_b32 v242, 16, v173
v_and_b32 v243, 0xffff0000, v173
v_mul_f32 v242, v242, v239
v_mul_f32 v243, v243, v239
v_cvt_pk_bf16_f32 v173, v242, v243
v_lshlrev_b32 v242, 16, v174
v_and_b32 v243, 0xffff0000, v174
v_mul_f32 v242, v242, v239
v_mul_f32 v243, v243, v239
v_cvt_pk_bf16_f32 v174, v242, v243
v_lshlrev_b32 v242, 16, v175
v_and_b32 v243, 0xffff0000, v175
v_mul_f32 v242, v242, v239
v_mul_f32 v243, v243, v239
v_cvt_pk_bf16_f32 v175, v242, v243
v_lshlrev_b32 v242, 16, v188
v_and_b32 v243, 0xffff0000, v188
v_mul_f32 v242, v242, v239
v_mul_f32 v243, v243, v239
v_cvt_pk_bf16_f32 v188, v242, v243
v_lshlrev_b32 v242, 16, v189
v_and_b32 v243, 0xffff0000, v189
v_mul_f32 v242, v242, v239
v_mul_f32 v243, v243, v239
v_cvt_pk_bf16_f32 v189, v242, v243
v_lshlrev_b32 v242, 16, v190
v_and_b32 v243, 0xffff0000, v190
v_mul_f32 v242, v242, v239
v_mul_f32 v243, v243, v239
v_cvt_pk_bf16_f32 v190, v242, v243
v_lshlrev_b32 v242, 16, v191
v_and_b32 v243, 0xffff0000, v191
v_mul_f32 v242, v242, v239
v_mul_f32 v243, v243, v239
v_cvt_pk_bf16_f32 v191, v242, v243
v_exp_f32 v232, v128
v_exp_f32 v233, v129
v_exp_f32 v234, v130
v_exp_f32 v235, v131
s_nop 1
v_add_f32 v228, v224, v232
v_add_f32 v228, v228, v233
v_add_f32 v228, v228, v234
v_add_f32 v228, v228, v235
v_cvt_pk_bf16_f32 v0, v232, v233
v_cvt_pk_bf16_f32 v1, v234, v235
v_exp_f32 v232, v132
v_exp_f32 v233, v133
v_exp_f32 v234, v134
v_exp_f32 v235, v135
s_nop 1
v_add_f32 v229, v225, v232
v_add_f32 v229, v229, v233
v_add_f32 v229, v229, v234
v_add_f32 v229, v229, v235
v_cvt_pk_bf16_f32 v32, v232, v233
v_cvt_pk_bf16_f32 v33, v234, v235
v_exp_f32 v232, v136
v_exp_f32 v233, v137
v_exp_f32 v234, v138
v_exp_f32 v235, v139
s_nop 1
v_add_f32 v230, v226, v232
v_add_f32 v230, v230, v233
v_add_f32 v230, v230, v234
v_add_f32 v230, v230, v235
v_cvt_pk_bf16_f32 v64, v232, v233
v_cvt_pk_bf16_f32 v65, v234, v235
v_exp_f32 v232, v140
v_exp_f32 v233, v141
v_exp_f32 v234, v142
v_exp_f32 v235, v143
s_nop 1
v_add_f32 v231, v227, v232
v_add_f32 v231, v231, v233
v_add_f32 v231, v231, v234
v_add_f32 v231, v231, v235
v_cvt_pk_bf16_f32 v96, v232, v233
v_cvt_pk_bf16_f32 v97, v234, v235
s_branch L2_rare_common
L2_rare_site17:
s_mov_b32 s36, 17
s_branch L2_rare_t0_5_1
L2_rare_t0_5_1:
s_nop 15
s_nop 15
s_waitcnt lgkmcnt(0)
v_log_f32 v243, v228
v_max3_f32 v232, v144, v145, v146
v_max3_f32 v232, v232, v147, v243
v_mov_b32 v243, v232
s_nop 1
v_permlane32_swap_b32 v232, v243
s_nop 1
v_max_f32 v232, v232, v243
v_mov_b32 v243, v232
s_nop 1
v_permlane16_swap_b32 v232, v243
s_nop 1
v_max_f32 v232, v232, v243
v_ceil_f32 v232, v232
v_max_f32 v232, 0, v232
v_sub_f32 v243, 0, v232
v_exp_f32 v236, v243
s_nop 1
v_mul_f32 v228, v228, v236
v_sub_f32 v192, v192, v232
v_sub_f32 v128, v128, v232
v_sub_f32 v144, v144, v232
v_sub_f32 v193, v193, v232
v_sub_f32 v129, v129, v232
v_sub_f32 v145, v145, v232
v_sub_f32 v194, v194, v232
v_sub_f32 v130, v130, v232
v_sub_f32 v146, v146, v232
v_sub_f32 v195, v195, v232
v_sub_f32 v131, v131, v232
v_sub_f32 v147, v147, v232
v_lshlrev_b32 v242, 16, v4
v_and_b32 v243, 0xffff0000, v4
v_mul_f32 v242, v242, v236
v_mul_f32 v243, v243, v236
v_cvt_pk_bf16_f32 v4, v242, v243
v_lshlrev_b32 v242, 16, v5
v_and_b32 v243, 0xffff0000, v5
v_mul_f32 v242, v242, v236
v_mul_f32 v243, v243, v236
v_cvt_pk_bf16_f32 v5, v242, v243
v_lshlrev_b32 v242, 16, v6
v_and_b32 v243, 0xffff0000, v6
v_mul_f32 v242, v242, v236
v_mul_f32 v243, v243, v236
v_cvt_pk_bf16_f32 v6, v242, v243
v_lshlrev_b32 v242, 16, v7
v_and_b32 v243, 0xffff0000, v7
v_mul_f32 v242, v242, v236
v_mul_f32 v243, v243, v236
v_cvt_pk_bf16_f32 v7, v242, v243
v_lshlrev_b32 v242, 16, v8
v_and_b32 v243, 0xffff0000, v8
v_mul_f32 v242, v242, v236
v_mul_f32 v243, v243, v236
v_cvt_pk_bf16_f32 v8, v242, v243
v_lshlrev_b32 v242, 16, v9
v_and_b32 v243, 0xffff0000, v9
v_mul_f32 v242, v242, v236
v_mul_f32 v243, v243, v236
v_cvt_pk_bf16_f32 v9, v242, v243
v_lshlrev_b32 v242, 16, v10
v_and_b32 v243, 0xffff0000, v10
v_mul_f32 v242, v242, v236
v_mul_f32 v243, v243, v236
v_cvt_pk_bf16_f32 v10, v242, v243
v_lshlrev_b32 v242, 16, v11
v_and_b32 v243, 0xffff0000, v11
v_mul_f32 v242, v242, v236
v_mul_f32 v243, v243, v236
v_cvt_pk_bf16_f32 v11, v242, v243
v_lshlrev_b32 v242, 16, v160
v_and_b32 v243, 0xffff0000, v160
v_mul_f32 v242, v242, v236
v_mul_f32 v243, v243, v236
v_cvt_pk_bf16_f32 v160, v242, v243
v_lshlrev_b32 v242, 16, v161
v_and_b32 v243, 0xffff0000, v161
v_mul_f32 v242, v242, v236
v_mul_f32 v243, v243, v236
v_cvt_pk_bf16_f32 v161, v242, v243
v_lshlrev_b32 v242, 16, v162
v_and_b32 v243, 0xffff0000, v162
v_mul_f32 v242, v242, v236
v_mul_f32 v243, v243, v236
v_cvt_pk_bf16_f32 v162, v242, v243
v_lshlrev_b32 v242, 16, v163
v_and_b32 v243, 0xffff0000, v163
v_mul_f32 v242, v242, v236
v_mul_f32 v243, v243, v236
v_cvt_pk_bf16_f32 v163, v242, v243
v_lshlrev_b32 v242, 16, v176
v_and_b32 v243, 0xffff0000, v176
v_mul_f32 v242, v242, v236
v_mul_f32 v243, v243, v236
v_cvt_pk_bf16_f32 v176, v242, v243
v_lshlrev_b32 v242, 16, v177
v_and_b32 v243, 0xffff0000, v177
v_mul_f32 v242, v242, v236
v_mul_f32 v243, v243, v236
v_cvt_pk_bf16_f32 v177, v242, v243
v_lshlrev_b32 v242, 16, v178
v_and_b32 v243, 0xffff0000, v178
v_mul_f32 v242, v242, v236
v_mul_f32 v243, v243, v236
v_cvt_pk_bf16_f32 v178, v242, v243
v_lshlrev_b32 v242, 16, v179
v_and_b32 v243, 0xffff0000, v179
v_mul_f32 v242, v242, v236
v_mul_f32 v243, v243, v236
v_cvt_pk_bf16_f32 v179, v242, v243
v_lshlrev_b32 v242, 16, v0
v_and_b32 v243, 0xffff0000, v0
v_mul_f32 v242, v242, v236
v_mul_f32 v243, v243, v236
v_cvt_pk_bf16_f32 v0, v242, v243
v_lshlrev_b32 v242, 16, v1
v_and_b32 v243, 0xffff0000, v1
v_mul_f32 v242, v242, v236
v_mul_f32 v243, v243, v236
v_cvt_pk_bf16_f32 v1, v242, v243
v_log_f32 v243, v229
v_max3_f32 v233, v148, v149, v150
v_max3_f32 v233, v233, v151, v243
v_mov_b32 v243, v233
s_nop 1
v_permlane32_swap_b32 v233, v243
s_nop 1
v_max_f32 v233, v233, v243
v_mov_b32 v243, v233
s_nop 1
v_permlane16_swap_b32 v233, v243
s_nop 1
v_max_f32 v233, v233, v243
v_ceil_f32 v233, v233
v_max_f32 v233, 0, v233
v_sub_f32 v243, 0, v233
v_exp_f32 v237, v243
s_nop 1
v_mul_f32 v229, v229, v237
v_sub_f32 v196, v196, v233
v_sub_f32 v132, v132, v233
v_sub_f32 v148, v148, v233
v_sub_f32 v197, v197, v233
v_sub_f32 v133, v133, v233
v_sub_f32 v149, v149, v233
v_sub_f32 v198, v198, v233
v_sub_f32 v134, v134, v233
v_sub_f32 v150, v150, v233
v_sub_f32 v199, v199, v233
v_sub_f32 v135, v135, v233
v_sub_f32 v151, v151, v233
v_lshlrev_b32 v242, 16, v36
v_and_b32 v243, 0xffff0000, v36
v_mul_f32 v242, v242, v237
v_mul_f32 v243, v243, v237
v_cvt_pk_bf16_f32 v36, v242, v243
v_lshlrev_b32 v242, 16, v37
v_and_b32 v243, 0xffff0000, v37
v_mul_f32 v242, v242, v237
v_mul_f32 v243, v243, v237
v_cvt_pk_bf16_f32 v37, v242, v243
v_lshlrev_b32 v242, 16, v38
v_and_b32 v243, 0xffff0000, v38
v_mul_f32 v242, v242, v237
v_mul_f32 v243, v243, v237
v_cvt_pk_bf16_f32 v38, v242, v243
v_lshlrev_b32 v242, 16, v39
v_and_b32 v243, 0xffff0000, v39
v_mul_f32 v242, v242, v237
v_mul_f32 v243, v243, v237
v_cvt_pk_bf16_f32 v39, v242, v243
v_lshlrev_b32 v242, 16, v40
v_and_b32 v243, 0xffff0000, v40
v_mul_f32 v242, v242, v237
v_mul_f32 v243, v243, v237
v_cvt_pk_bf16_f32 v40, v242, v243
v_lshlrev_b32 v242, 16, v41
v_and_b32 v243, 0xffff0000, v41
v_mul_f32 v242, v242, v237
v_mul_f32 v243, v243, v237
v_cvt_pk_bf16_f32 v41, v242, v243
v_lshlrev_b32 v242, 16, v42
v_and_b32 v243, 0xffff0000, v42
v_mul_f32 v242, v242, v237
v_mul_f32 v243, v243, v237
v_cvt_pk_bf16_f32 v42, v242, v243
v_lshlrev_b32 v242, 16, v43
v_and_b32 v243, 0xffff0000, v43
v_mul_f32 v242, v242, v237
v_mul_f32 v243, v243, v237
v_cvt_pk_bf16_f32 v43, v242, v243
v_lshlrev_b32 v242, 16, v164
v_and_b32 v243, 0xffff0000, v164
v_mul_f32 v242, v242, v237
v_mul_f32 v243, v243, v237
v_cvt_pk_bf16_f32 v164, v242, v243
v_lshlrev_b32 v242, 16, v165
v_and_b32 v243, 0xffff0000, v165
v_mul_f32 v242, v242, v237
v_mul_f32 v243, v243, v237
v_cvt_pk_bf16_f32 v165, v242, v243
v_lshlrev_b32 v242, 16, v166
v_and_b32 v243, 0xffff0000, v166
v_mul_f32 v242, v242, v237
v_mul_f32 v243, v243, v237
v_cvt_pk_bf16_f32 v166, v242, v243
v_lshlrev_b32 v242, 16, v167
v_and_b32 v243, 0xffff0000, v167
v_mul_f32 v242, v242, v237
v_mul_f32 v243, v243, v237
v_cvt_pk_bf16_f32 v167, v242, v243
v_lshlrev_b32 v242, 16, v180
v_and_b32 v243, 0xffff0000, v180
v_mul_f32 v242, v242, v237
v_mul_f32 v243, v243, v237
v_cvt_pk_bf16_f32 v180, v242, v243
v_lshlrev_b32 v242, 16, v181
v_and_b32 v243, 0xffff0000, v181
v_mul_f32 v242, v242, v237
v_mul_f32 v243, v243, v237
v_cvt_pk_bf16_f32 v181, v242, v243
v_lshlrev_b32 v242, 16, v182
v_and_b32 v243, 0xffff0000, v182
v_mul_f32 v242, v242, v237
v_mul_f32 v243, v243, v237
v_cvt_pk_bf16_f32 v182, v242, v243
v_lshlrev_b32 v242, 16, v183
v_and_b32 v243, 0xffff0000, v183
v_mul_f32 v242, v242, v237
v_mul_f32 v243, v243, v237
v_cvt_pk_bf16_f32 v183, v242, v243
v_lshlrev_b32 v242, 16, v32
v_and_b32 v243, 0xffff0000, v32
v_mul_f32 v242, v242, v237
v_mul_f32 v243, v243, v237
v_cvt_pk_bf16_f32 v32, v242, v243
v_lshlrev_b32 v242, 16, v33
v_and_b32 v243, 0xffff0000, v33
v_mul_f32 v242, v242, v237
v_mul_f32 v243, v243, v237
v_cvt_pk_bf16_f32 v33, v242, v243
v_log_f32 v243, v230
v_max3_f32 v234, v152, v153, v154
v_max3_f32 v234, v234, v155, v243
v_mov_b32 v243, v234
s_nop 1
v_permlane32_swap_b32 v234, v243
s_nop 1
v_max_f32 v234, v234, v243
v_mov_b32 v243, v234
s_nop 1
v_permlane16_swap_b32 v234, v243
s_nop 1
v_max_f32 v234, v234, v243
v_ceil_f32 v234, v234
v_max_f32 v234, 0, v234
v_sub_f32 v243, 0, v234
v_exp_f32 v238, v243
s_nop 1
v_mul_f32 v230, v230, v238
v_sub_f32 v200, v200, v234
v_sub_f32 v136, v136, v234
v_sub_f32 v152, v152, v234
v_sub_f32 v201, v201, v234
v_sub_f32 v137, v137, v234
v_sub_f32 v153, v153, v234
v_sub_f32 v202, v202, v234
v_sub_f32 v138, v138, v234
v_sub_f32 v154, v154, v234
v_sub_f32 v203, v203, v234
v_sub_f32 v139, v139, v234
v_sub_f32 v155, v155, v234
v_lshlrev_b32 v242, 16, v68
v_and_b32 v243, 0xffff0000, v68
v_mul_f32 v242, v242, v238
v_mul_f32 v243, v243, v238
v_cvt_pk_bf16_f32 v68, v242, v243
v_lshlrev_b32 v242, 16, v69
v_and_b32 v243, 0xffff0000, v69
v_mul_f32 v242, v242, v238
v_mul_f32 v243, v243, v238
v_cvt_pk_bf16_f32 v69, v242, v243
v_lshlrev_b32 v242, 16, v70
v_and_b32 v243, 0xffff0000, v70
v_mul_f32 v242, v242, v238
v_mul_f32 v243, v243, v238
v_cvt_pk_bf16_f32 v70, v242, v243
v_lshlrev_b32 v242, 16, v71
v_and_b32 v243, 0xffff0000, v71
v_mul_f32 v242, v242, v238
v_mul_f32 v243, v243, v238
v_cvt_pk_bf16_f32 v71, v242, v243
v_lshlrev_b32 v242, 16, v72
v_and_b32 v243, 0xffff0000, v72
v_mul_f32 v242, v242, v238
v_mul_f32 v243, v243, v238
v_cvt_pk_bf16_f32 v72, v242, v243
v_lshlrev_b32 v242, 16, v73
v_and_b32 v243, 0xffff0000, v73
v_mul_f32 v242, v242, v238
v_mul_f32 v243, v243, v238
v_cvt_pk_bf16_f32 v73, v242, v243
v_lshlrev_b32 v242, 16, v74
v_and_b32 v243, 0xffff0000, v74
v_mul_f32 v242, v242, v238
v_mul_f32 v243, v243, v238
v_cvt_pk_bf16_f32 v74, v242, v243
v_lshlrev_b32 v242, 16, v75
v_and_b32 v243, 0xffff0000, v75
v_mul_f32 v242, v242, v238
v_mul_f32 v243, v243, v238
v_cvt_pk_bf16_f32 v75, v242, v243
v_lshlrev_b32 v242, 16, v168
v_and_b32 v243, 0xffff0000, v168
v_mul_f32 v242, v242, v238
v_mul_f32 v243, v243, v238
v_cvt_pk_bf16_f32 v168, v242, v243
v_lshlrev_b32 v242, 16, v169
v_and_b32 v243, 0xffff0000, v169
v_mul_f32 v242, v242, v238
v_mul_f32 v243, v243, v238
v_cvt_pk_bf16_f32 v169, v242, v243
v_lshlrev_b32 v242, 16, v170
v_and_b32 v243, 0xffff0000, v170
v_mul_f32 v242, v242, v238
v_mul_f32 v243, v243, v238
v_cvt_pk_bf16_f32 v170, v242, v243
v_lshlrev_b32 v242, 16, v171
v_and_b32 v243, 0xffff0000, v171
v_mul_f32 v242, v242, v238
v_mul_f32 v243, v243, v238
v_cvt_pk_bf16_f32 v171, v242, v243
v_lshlrev_b32 v242, 16, v184
v_and_b32 v243, 0xffff0000, v184
v_mul_f32 v242, v242, v238
v_mul_f32 v243, v243, v238
v_cvt_pk_bf16_f32 v184, v242, v243
v_lshlrev_b32 v242, 16, v185
v_and_b32 v243, 0xffff0000, v185
v_mul_f32 v242, v242, v238
v_mul_f32 v243, v243, v238
v_cvt_pk_bf16_f32 v185, v242, v243
v_lshlrev_b32 v242, 16, v186
v_and_b32 v243, 0xffff0000, v186
v_mul_f32 v242, v242, v238
v_mul_f32 v243, v243, v238
v_cvt_pk_bf16_f32 v186, v242, v243
v_lshlrev_b32 v242, 16, v187
v_and_b32 v243, 0xffff0000, v187
v_mul_f32 v242, v242, v238
v_mul_f32 v243, v243, v238
v_cvt_pk_bf16_f32 v187, v242, v243
v_lshlrev_b32 v242, 16, v64
v_and_b32 v243, 0xffff0000, v64
v_mul_f32 v242, v242, v238
v_mul_f32 v243, v243, v238
v_cvt_pk_bf16_f32 v64, v242, v243
v_lshlrev_b32 v242, 16, v65
v_and_b32 v243, 0xffff0000, v65
v_mul_f32 v242, v242, v238
v_mul_f32 v243, v243, v238
v_cvt_pk_bf16_f32 v65, v242, v243
v_log_f32 v243, v231
v_max3_f32 v235, v156, v157, v158
v_max3_f32 v235, v235, v159, v243
v_mov_b32 v243, v235
s_nop 1
v_permlane32_swap_b32 v235, v243
s_nop 1
v_max_f32 v235, v235, v243
v_mov_b32 v243, v235
s_nop 1
v_permlane16_swap_b32 v235, v243
s_nop 1
v_max_f32 v235, v235, v243
v_ceil_f32 v235, v235
v_max_f32 v235, 0, v235
v_sub_f32 v243, 0, v235
v_exp_f32 v239, v243
s_nop 1
v_mul_f32 v231, v231, v239
v_sub_f32 v204, v204, v235
v_sub_f32 v140, v140, v235
v_sub_f32 v156, v156, v235
v_sub_f32 v205, v205, v235
v_sub_f32 v141, v141, v235
v_sub_f32 v157, v157, v235
v_sub_f32 v206, v206, v235
v_sub_f32 v142, v142, v235
v_sub_f32 v158, v158, v235
v_sub_f32 v207, v207, v235
v_sub_f32 v143, v143, v235
v_sub_f32 v159, v159, v235
v_lshlrev_b32 v242, 16, v100
v_and_b32 v243, 0xffff0000, v100
v_mul_f32 v242, v242, v239
v_mul_f32 v243, v243, v239
v_cvt_pk_bf16_f32 v100, v242, v243
v_lshlrev_b32 v242, 16, v101
v_and_b32 v243, 0xffff0000, v101
v_mul_f32 v242, v242, v239
v_mul_f32 v243, v243, v239
v_cvt_pk_bf16_f32 v101, v242, v243
v_lshlrev_b32 v242, 16, v102
v_and_b32 v243, 0xffff0000, v102
v_mul_f32 v242, v242, v239
v_mul_f32 v243, v243, v239
v_cvt_pk_bf16_f32 v102, v242, v243
v_lshlrev_b32 v242, 16, v103
v_and_b32 v243, 0xffff0000, v103
v_mul_f32 v242, v242, v239
v_mul_f32 v243, v243, v239
v_cvt_pk_bf16_f32 v103, v242, v243
v_lshlrev_b32 v242, 16, v104
v_and_b32 v243, 0xffff0000, v104
v_mul_f32 v242, v242, v239
v_mul_f32 v243, v243, v239
v_cvt_pk_bf16_f32 v104, v242, v243
v_lshlrev_b32 v242, 16, v105
v_and_b32 v243, 0xffff0000, v105
v_mul_f32 v242, v242, v239
v_mul_f32 v243, v243, v239
v_cvt_pk_bf16_f32 v105, v242, v243
v_lshlrev_b32 v242, 16, v106
v_and_b32 v243, 0xffff0000, v106
v_mul_f32 v242, v242, v239
v_mul_f32 v243, v243, v239
v_cvt_pk_bf16_f32 v106, v242, v243
v_lshlrev_b32 v242, 16, v107
v_and_b32 v243, 0xffff0000, v107
v_mul_f32 v242, v242, v239
v_mul_f32 v243, v243, v239
v_cvt_pk_bf16_f32 v107, v242, v243
v_lshlrev_b32 v242, 16, v172
v_and_b32 v243, 0xffff0000, v172
v_mul_f32 v242, v242, v239
v_mul_f32 v243, v243, v239
v_cvt_pk_bf16_f32 v172, v242, v243
v_lshlrev_b32 v242, 16, v173
v_and_b32 v243, 0xffff0000, v173
v_mul_f32 v242, v242, v239
v_mul_f32 v243, v243, v239
v_cvt_pk_bf16_f32 v173, v242, v243
v_lshlrev_b32 v242, 16, v174
v_and_b32 v243, 0xffff0000, v174
v_mul_f32 v242, v242, v239
v_mul_f32 v243, v243, v239
v_cvt_pk_bf16_f32 v174, v242, v243
v_lshlrev_b32 v242, 16, v175
v_and_b32 v243, 0xffff0000, v175
v_mul_f32 v242, v242, v239
v_mul_f32 v243, v243, v239
v_cvt_pk_bf16_f32 v175, v242, v243
v_lshlrev_b32 v242, 16, v188
v_and_b32 v243, 0xffff0000, v188
v_mul_f32 v242, v242, v239
v_mul_f32 v243, v243, v239
v_cvt_pk_bf16_f32 v188, v242, v243
v_lshlrev_b32 v242, 16, v189
v_and_b32 v243, 0xffff0000, v189
v_mul_f32 v242, v242, v239
v_mul_f32 v243, v243, v239
v_cvt_pk_bf16_f32 v189, v242, v243
v_lshlrev_b32 v242, 16, v190
v_and_b32 v243, 0xffff0000, v190
v_mul_f32 v242, v242, v239
v_mul_f32 v243, v243, v239
v_cvt_pk_bf16_f32 v190, v242, v243
v_lshlrev_b32 v242, 16, v191
v_and_b32 v243, 0xffff0000, v191
v_mul_f32 v242, v242, v239
v_mul_f32 v243, v243, v239
v_cvt_pk_bf16_f32 v191, v242, v243
v_lshlrev_b32 v242, 16, v96
v_and_b32 v243, 0xffff0000, v96
v_mul_f32 v242, v242, v239
v_mul_f32 v243, v243, v239
v_cvt_pk_bf16_f32 v96, v242, v243
v_lshlrev_b32 v242, 16, v97
v_and_b32 v243, 0xffff0000, v97
v_mul_f32 v242, v242, v239
v_mul_f32 v243, v243, v239
v_cvt_pk_bf16_f32 v97, v242, v243
v_exp_f32 v232, v144
v_exp_f32 v233, v145
v_exp_f32 v234, v146
v_exp_f32 v235, v147
s_nop 1
v_add_f32 v224, v228, v232
v_add_f32 v224, v224, v233
v_add_f32 v224, v224, v234
v_add_f32 v224, v224, v235
v_cvt_pk_bf16_f32 v2, v232, v233
v_cvt_pk_bf16_f32 v3, v234, v235
v_exp_f32 v232, v148
v_exp_f32 v233, v149
v_exp_f32 v234, v150
v_exp_f32 v235, v151
s_nop 1
v_add_f32 v225, v229, v232
v_add_f32 v225, v225, v233
v_add_f32 v225, v225, v234
v_add_f32 v225, v225, v235
v_cvt_pk_bf16_f32 v34, v232, v233
v_cvt_pk_bf16_f32 v35, v234, v235
v_exp_f32 v232, v152
v_exp_f32 v233, v153
v_exp_f32 v234, v154
v_exp_f32 v235, v155
s_nop 1
v_add_f32 v226, v230, v232
v_add_f32 v226, v226, v233
v_add_f32 v226, v226, v234
v_add_f32 v226, v226, v235
v_cvt_pk_bf16_f32 v66, v232, v233
v_cvt_pk_bf16_f32 v67, v234, v235
v_exp_f32 v232, v156
v_exp_f32 v233, v157
v_exp_f32 v234, v158
v_exp_f32 v235, v159
s_nop 1
v_add_f32 v227, v231, v232
v_add_f32 v227, v227, v233
v_add_f32 v227, v227, v234
v_add_f32 v227, v227, v235
v_cvt_pk_bf16_f32 v98, v232, v233
v_cvt_pk_bf16_f32 v99, v234, v235
s_branch L2_rare_common
LF_hl_0:
s_mov_b32 s94, 0x10000
s_mov_b32 s3, 0x7c28000
LF_hl2_0:
v_lshlrev_b32 v241, 3, v248
buffer_load_dwordx2 v[240:241], v241, s[16:19], s3 offen sc1
s_sub_u32 s94, s94, 1
s_waitcnt vmcnt(0)
s_cbranch_scc1 LF_hlret_0
v_cmp_ne_u64_e64 s[38:39], s[98:99], v[240:241]
s_and_b64 s[38:39], s[38:39], s[96:97]
s_cbranch_scc1 LF_hl2_0
s_branch LF_hlret_0
L2_rare_common:
v_lshrrev_b32 v232, 4, v248
v_and_b32 v232, 0x30, v232
ds_bpermute_b32 v242, v232, v236 offset:0
ds_bpermute_b32 v243, v232, v236 offset:4
ds_bpermute_b32 v254, v232, v236 offset:8
ds_bpermute_b32 v255, v232, v236 offset:12
s_waitcnt lgkmcnt(0)
v_accvgpr_read_b32 v232, a0
v_accvgpr_read_b32 v233, a1
v_accvgpr_read_b32 v234, a2
v_accvgpr_read_b32 v235, a3
v_mul_f32 v232, v232, v242
v_mul_f32 v233, v233, v243
v_mul_f32 v234, v234, v254
v_mul_f32 v235, v235, v255
v_accvgpr_write_b32 a0, v232
v_accvgpr_write_b32 a1, v233
v_accvgpr_write_b32 a2, v234
v_accvgpr_write_b32 a3, v235
v_accvgpr_read_b32 v232, a16
v_accvgpr_read_b32 v233, a17
v_accvgpr_read_b32 v234, a18
v_accvgpr_read_b32 v235, a19
v_mul_f32 v232, v232, v242
v_mul_f32 v233, v233, v243
v_mul_f32 v234, v234, v254
v_mul_f32 v235, v235, v255
v_accvgpr_write_b32 a16, v232
v_accvgpr_write_b32 a17, v233
v_accvgpr_write_b32 a18, v234
v_accvgpr_write_b32 a19, v235
v_accvgpr_read_b32 v232, a32
v_accvgpr_read_b32 v233, a33
v_accvgpr_read_b32 v234, a34
v_accvgpr_read_b32 v235, a35
v_mul_f32 v232, v232, v242
v_mul_f32 v233, v233, v243
v_mul_f32 v234, v234, v254
v_mul_f32 v235, v235, v255
v_accvgpr_write_b32 a32, v232
v_accvgpr_write_b32 a33, v233
v_accvgpr_write_b32 a34, v234
v_accvgpr_write_b32 a35, v235
v_accvgpr_read_b32 v232, a48
v_accvgpr_read_b32 v233, a49
v_accvgpr_read_b32 v234, a50
v_accvgpr_read_b32 v235, a51
v_mul_f32 v232, v232, v242
v_mul_f32 v233, v233, v243
v_mul_f32 v234, v234, v254
v_mul_f32 v235, v235, v255
v_accvgpr_write_b32 a48, v232
v_accvgpr_write_b32 a49, v233
v_accvgpr_write_b32 a50, v234
v_accvgpr_write_b32 a51, v235
v_accvgpr_read_b32 v232, a64
v_accvgpr_read_b32 v233, a65
v_accvgpr_read_b32 v234, a66
v_accvgpr_read_b32 v235, a67
v_mul_f32 v232, v232, v242
v_mul_f32 v233, v233, v243
v_mul_f32 v234, v234, v254
v_mul_f32 v235, v235, v255
v_accvgpr_write_b32 a64, v232
v_accvgpr_write_b32 a65, v233
v_accvgpr_write_b32 a66, v234
v_accvgpr_write_b32 a67, v235
v_accvgpr_read_b32 v232, a80
v_accvgpr_read_b32 v233, a81
v_accvgpr_read_b32 v234, a82
v_accvgpr_read_b32 v235, a83
v_mul_f32 v232, v232, v242
v_mul_f32 v233, v233, v243
v_mul_f32 v234, v234, v254
v_mul_f32 v235, v235, v255
v_accvgpr_write_b32 a80, v232
v_accvgpr_write_b32 a81, v233
v_accvgpr_write_b32 a82, v234
v_accvgpr_write_b32 a83, v235
v_accvgpr_read_b32 v232, a96
v_accvgpr_read_b32 v233, a97
v_accvgpr_read_b32 v234, a98
v_accvgpr_read_b32 v235, a99
v_mul_f32 v232, v232, v242
v_mul_f32 v233, v233, v243
v_mul_f32 v234, v234, v254
v_mul_f32 v235, v235, v255
v_accvgpr_write_b32 a96, v232
v_accvgpr_write_b32 a97, v233
v_accvgpr_write_b32 a98, v234
v_accvgpr_write_b32 a99, v235
v_accvgpr_read_b32 v232, a112
v_accvgpr_read_b32 v233, a113
v_accvgpr_read_b32 v234, a114
v_accvgpr_read_b32 v235, a115
v_mul_f32 v232, v232, v242
v_mul_f32 v233, v233, v243
v_mul_f32 v234, v234, v254
v_mul_f32 v235, v235, v255
v_accvgpr_write_b32 a112, v232
v_accvgpr_write_b32 a113, v233
v_accvgpr_write_b32 a114, v234
v_accvgpr_write_b32 a115, v235
v_accvgpr_read_b32 v232, a128
v_accvgpr_read_b32 v233, a129
v_accvgpr_read_b32 v234, a130
v_accvgpr_read_b32 v235, a131
v_mul_f32 v232, v232, v242
v_mul_f32 v233, v233, v243
v_mul_f32 v234, v234, v254
v_mul_f32 v235, v235, v255
v_accvgpr_write_b32 a128, v232
v_accvgpr_write_b32 a129, v233
v_accvgpr_write_b32 a130, v234
v_accvgpr_write_b32 a131, v235
v_accvgpr_read_b32 v232, a144
v_accvgpr_read_b32 v233, a145
v_accvgpr_read_b32 v234, a146
v_accvgpr_read_b32 v235, a147
v_mul_f32 v232, v232, v242
v_mul_f32 v233, v233, v243
v_mul_f32 v234, v234, v254
v_mul_f32 v235, v235, v255
v_accvgpr_write_b32 a144, v232
v_accvgpr_write_b32 a145, v233
v_accvgpr_write_b32 a146, v234
v_accvgpr_write_b32 a147, v235
v_accvgpr_read_b32 v232, a160
v_accvgpr_read_b32 v233, a161
v_accvgpr_read_b32 v234, a162
v_accvgpr_read_b32 v235, a163
v_mul_f32 v232, v232, v242
v_mul_f32 v233, v233, v243
v_mul_f32 v234, v234, v254
v_mul_f32 v235, v235, v255
v_accvgpr_write_b32 a160, v232
v_accvgpr_write_b32 a161, v233
v_accvgpr_write_b32 a162, v234
v_accvgpr_write_b32 a163, v235
v_accvgpr_read_b32 v232, a176
v_accvgpr_read_b32 v233, a177
v_accvgpr_read_b32 v234, a178
v_accvgpr_read_b32 v235, a179
v_mul_f32 v232, v232, v242
v_mul_f32 v233, v233, v243
v_mul_f32 v234, v234, v254
v_mul_f32 v235, v235, v255
v_accvgpr_write_b32 a176, v232
v_accvgpr_write_b32 a177, v233
v_accvgpr_write_b32 a178, v234
v_accvgpr_write_b32 a179, v235
v_accvgpr_read_b32 v232, a192
v_accvgpr_read_b32 v233, a193
v_accvgpr_read_b32 v234, a194
v_accvgpr_read_b32 v235, a195
v_mul_f32 v232, v232, v242
v_mul_f32 v233, v233, v243
v_mul_f32 v234, v234, v254
v_mul_f32 v235, v235, v255
v_accvgpr_write_b32 a192, v232
v_accvgpr_write_b32 a193, v233
v_accvgpr_write_b32 a194, v234
v_accvgpr_write_b32 a195, v235
v_accvgpr_read_b32 v232, a208
v_accvgpr_read_b32 v233, a209
v_accvgpr_read_b32 v234, a210
v_accvgpr_read_b32 v235, a211
v_mul_f32 v232, v232, v242
v_mul_f32 v233, v233, v243
v_mul_f32 v234, v234, v254
v_mul_f32 v235, v235, v255
v_accvgpr_write_b32 a208, v232
v_accvgpr_write_b32 a209, v233
v_accvgpr_write_b32 a210, v234
v_accvgpr_write_b32 a211, v235
v_accvgpr_read_b32 v232, a224
v_accvgpr_read_b32 v233, a225
v_accvgpr_read_b32 v234, a226
v_accvgpr_read_b32 v235, a227
v_mul_f32 v232, v232, v242
v_mul_f32 v233, v233, v243
v_mul_f32 v234, v234, v254
v_mul_f32 v235, v235, v255
v_accvgpr_write_b32 a224, v232
v_accvgpr_write_b32 a225, v233
v_accvgpr_write_b32 a226, v234
v_accvgpr_write_b32 a227, v235
v_accvgpr_read_b32 v232, a240
v_accvgpr_read_b32 v233, a241
v_accvgpr_read_b32 v234, a242
v_accvgpr_read_b32 v235, a243
v_mul_f32 v232, v232, v242
v_mul_f32 v233, v233, v243
v_mul_f32 v234, v234, v254
v_mul_f32 v235, v235, v255
v_accvgpr_write_b32 a240, v232
v_accvgpr_write_b32 a241, v233
v_accvgpr_write_b32 a242, v234
v_accvgpr_write_b32 a243, v235
v_lshrrev_b32 v232, 4, v248
v_and_b32 v232, 0x30, v232
ds_bpermute_b32 v242, v232, v237 offset:0
ds_bpermute_b32 v243, v232, v237 offset:4
ds_bpermute_b32 v254, v232, v237 offset:8
ds_bpermute_b32 v255, v232, v237 offset:12
s_waitcnt lgkmcnt(0)
v_accvgpr_read_b32 v232, a4
v_accvgpr_read_b32 v233, a5
v_accvgpr_read_b32 v234, a6
v_accvgpr_read_b32 v235, a7
v_mul_f32 v232, v232, v242
v_mul_f32 v233, v233, v243
v_mul_f32 v234, v234, v254
v_mul_f32 v235, v235, v255
v_accvgpr_write_b32 a4, v232
v_accvgpr_write_b32 a5, v233
v_accvgpr_write_b32 a6, v234
v_accvgpr_write_b32 a7, v235
v_accvgpr_read_b32 v232, a20
v_accvgpr_read_b32 v233, a21
v_accvgpr_read_b32 v234, a22
v_accvgpr_read_b32 v235, a23
v_mul_f32 v232, v232, v242
v_mul_f32 v233, v233, v243
v_mul_f32 v234, v234, v254
v_mul_f32 v235, v235, v255
v_accvgpr_write_b32 a20, v232
v_accvgpr_write_b32 a21, v233
v_accvgpr_write_b32 a22, v234
v_accvgpr_write_b32 a23, v235
v_accvgpr_read_b32 v232, a36
v_accvgpr_read_b32 v233, a37
v_accvgpr_read_b32 v234, a38
v_accvgpr_read_b32 v235, a39
v_mul_f32 v232, v232, v242
v_mul_f32 v233, v233, v243
v_mul_f32 v234, v234, v254
v_mul_f32 v235, v235, v255
v_accvgpr_write_b32 a36, v232
v_accvgpr_write_b32 a37, v233
v_accvgpr_write_b32 a38, v234
v_accvgpr_write_b32 a39, v235
v_accvgpr_read_b32 v232, a52
v_accvgpr_read_b32 v233, a53
v_accvgpr_read_b32 v234, a54
v_accvgpr_read_b32 v235, a55
v_mul_f32 v232, v232, v242
v_mul_f32 v233, v233, v243
v_mul_f32 v234, v234, v254
v_mul_f32 v235, v235, v255
v_accvgpr_write_b32 a52, v232
v_accvgpr_write_b32 a53, v233
v_accvgpr_write_b32 a54, v234
v_accvgpr_write_b32 a55, v235
v_accvgpr_read_b32 v232, a68
v_accvgpr_read_b32 v233, a69
v_accvgpr_read_b32 v234, a70
v_accvgpr_read_b32 v235, a71
v_mul_f32 v232, v232, v242
v_mul_f32 v233, v233, v243
v_mul_f32 v234, v234, v254
v_mul_f32 v235, v235, v255
v_accvgpr_write_b32 a68, v232
v_accvgpr_write_b32 a69, v233
v_accvgpr_write_b32 a70, v234
v_accvgpr_write_b32 a71, v235
v_accvgpr_read_b32 v232, a84
v_accvgpr_read_b32 v233, a85
v_accvgpr_read_b32 v234, a86
v_accvgpr_read_b32 v235, a87
v_mul_f32 v232, v232, v242
v_mul_f32 v233, v233, v243
v_mul_f32 v234, v234, v254
v_mul_f32 v235, v235, v255
v_accvgpr_write_b32 a84, v232
v_accvgpr_write_b32 a85, v233
v_accvgpr_write_b32 a86, v234
v_accvgpr_write_b32 a87, v235
v_accvgpr_read_b32 v232, a100
v_accvgpr_read_b32 v233, a101
v_accvgpr_read_b32 v234, a102
v_accvgpr_read_b32 v235, a103
v_mul_f32 v232, v232, v242
v_mul_f32 v233, v233, v243
v_mul_f32 v234, v234, v254
v_mul_f32 v235, v235, v255
v_accvgpr_write_b32 a100, v232
v_accvgpr_write_b32 a101, v233
v_accvgpr_write_b32 a102, v234
v_accvgpr_write_b32 a103, v235
v_accvgpr_read_b32 v232, a116
v_accvgpr_read_b32 v233, a117
v_accvgpr_read_b32 v234, a118
v_accvgpr_read_b32 v235, a119
v_mul_f32 v232, v232, v242
v_mul_f32 v233, v233, v243
v_mul_f32 v234, v234, v254
v_mul_f32 v235, v235, v255
v_accvgpr_write_b32 a116, v232
v_accvgpr_write_b32 a117, v233
v_accvgpr_write_b32 a118, v234
v_accvgpr_write_b32 a119, v235
v_accvgpr_read_b32 v232, a132
v_accvgpr_read_b32 v233, a133
v_accvgpr_read_b32 v234, a134
v_accvgpr_read_b32 v235, a135
v_mul_f32 v232, v232, v242
v_mul_f32 v233, v233, v243
v_mul_f32 v234, v234, v254
v_mul_f32 v235, v235, v255
v_accvgpr_write_b32 a132, v232
v_accvgpr_write_b32 a133, v233
v_accvgpr_write_b32 a134, v234
v_accvgpr_write_b32 a135, v235
v_accvgpr_read_b32 v232, a148
v_accvgpr_read_b32 v233, a149
v_accvgpr_read_b32 v234, a150
v_accvgpr_read_b32 v235, a151
v_mul_f32 v232, v232, v242
v_mul_f32 v233, v233, v243
v_mul_f32 v234, v234, v254
v_mul_f32 v235, v235, v255
v_accvgpr_write_b32 a148, v232
v_accvgpr_write_b32 a149, v233
v_accvgpr_write_b32 a150, v234
v_accvgpr_write_b32 a151, v235
v_accvgpr_read_b32 v232, a164
v_accvgpr_read_b32 v233, a165
v_accvgpr_read_b32 v234, a166
v_accvgpr_read_b32 v235, a167
v_mul_f32 v232, v232, v242
v_mul_f32 v233, v233, v243
v_mul_f32 v234, v234, v254
v_mul_f32 v235, v235, v255
v_accvgpr_write_b32 a164, v232
v_accvgpr_write_b32 a165, v233
v_accvgpr_write_b32 a166, v234
v_accvgpr_write_b32 a167, v235
v_accvgpr_read_b32 v232, a180
v_accvgpr_read_b32 v233, a181
v_accvgpr_read_b32 v234, a182
v_accvgpr_read_b32 v235, a183
v_mul_f32 v232, v232, v242
v_mul_f32 v233, v233, v243
v_mul_f32 v234, v234, v254
v_mul_f32 v235, v235, v255
v_accvgpr_write_b32 a180, v232
v_accvgpr_write_b32 a181, v233
v_accvgpr_write_b32 a182, v234
v_accvgpr_write_b32 a183, v235
v_accvgpr_read_b32 v232, a196
v_accvgpr_read_b32 v233, a197
v_accvgpr_read_b32 v234, a198
v_accvgpr_read_b32 v235, a199
v_mul_f32 v232, v232, v242
v_mul_f32 v233, v233, v243
v_mul_f32 v234, v234, v254
v_mul_f32 v235, v235, v255
v_accvgpr_write_b32 a196, v232
v_accvgpr_write_b32 a197, v233
v_accvgpr_write_b32 a198, v234
v_accvgpr_write_b32 a199, v235
v_accvgpr_read_b32 v232, a212
v_accvgpr_read_b32 v233, a213
v_accvgpr_read_b32 v234, a214
v_accvgpr_read_b32 v235, a215
v_mul_f32 v232, v232, v242
v_mul_f32 v233, v233, v243
v_mul_f32 v234, v234, v254
v_mul_f32 v235, v235, v255
v_accvgpr_write_b32 a212, v232
v_accvgpr_write_b32 a213, v233
v_accvgpr_write_b32 a214, v234
v_accvgpr_write_b32 a215, v235
v_accvgpr_read_b32 v232, a228
v_accvgpr_read_b32 v233, a229
v_accvgpr_read_b32 v234, a230
v_accvgpr_read_b32 v235, a231
v_mul_f32 v232, v232, v242
v_mul_f32 v233, v233, v243
v_mul_f32 v234, v234, v254
v_mul_f32 v235, v235, v255
v_accvgpr_write_b32 a228, v232
v_accvgpr_write_b32 a229, v233
v_accvgpr_write_b32 a230, v234
v_accvgpr_write_b32 a231, v235
v_accvgpr_read_b32 v232, a244
v_accvgpr_read_b32 v233, a245
v_accvgpr_read_b32 v234, a246
v_accvgpr_read_b32 v235, a247
v_mul_f32 v232, v232, v242
v_mul_f32 v233, v233, v243
v_mul_f32 v234, v234, v254
v_mul_f32 v235, v235, v255
v_accvgpr_write_b32 a244, v232
v_accvgpr_write_b32 a245, v233
v_accvgpr_write_b32 a246, v234
v_accvgpr_write_b32 a247, v235
v_lshrrev_b32 v232, 4, v248
v_and_b32 v232, 0x30, v232
ds_bpermute_b32 v242, v232, v238 offset:0
ds_bpermute_b32 v243, v232, v238 offset:4
ds_bpermute_b32 v254, v232, v238 offset:8
ds_bpermute_b32 v255, v232, v238 offset:12
s_waitcnt lgkmcnt(0)
v_accvgpr_read_b32 v232, a8
v_accvgpr_read_b32 v233, a9
v_accvgpr_read_b32 v234, a10
v_accvgpr_read_b32 v235, a11
v_mul_f32 v232, v232, v242
v_mul_f32 v233, v233, v243
v_mul_f32 v234, v234, v254
v_mul_f32 v235, v235, v255
v_accvgpr_write_b32 a8, v232
v_accvgpr_write_b32 a9, v233
v_accvgpr_write_b32 a10, v234
v_accvgpr_write_b32 a11, v235
v_accvgpr_read_b32 v232, a24
v_accvgpr_read_b32 v233, a25
v_accvgpr_read_b32 v234, a26
v_accvgpr_read_b32 v235, a27
v_mul_f32 v232, v232, v242
v_mul_f32 v233, v233, v243
v_mul_f32 v234, v234, v254
v_mul_f32 v235, v235, v255
v_accvgpr_write_b32 a24, v232
v_accvgpr_write_b32 a25, v233
v_accvgpr_write_b32 a26, v234
v_accvgpr_write_b32 a27, v235
v_accvgpr_read_b32 v232, a40
v_accvgpr_read_b32 v233, a41
v_accvgpr_read_b32 v234, a42
v_accvgpr_read_b32 v235, a43
v_mul_f32 v232, v232, v242
v_mul_f32 v233, v233, v243
v_mul_f32 v234, v234, v254
v_mul_f32 v235, v235, v255
v_accvgpr_write_b32 a40, v232
v_accvgpr_write_b32 a41, v233
v_accvgpr_write_b32 a42, v234
v_accvgpr_write_b32 a43, v235
v_accvgpr_read_b32 v232, a56
v_accvgpr_read_b32 v233, a57
v_accvgpr_read_b32 v234, a58
v_accvgpr_read_b32 v235, a59
v_mul_f32 v232, v232, v242
v_mul_f32 v233, v233, v243
v_mul_f32 v234, v234, v254
v_mul_f32 v235, v235, v255
v_accvgpr_write_b32 a56, v232
v_accvgpr_write_b32 a57, v233
v_accvgpr_write_b32 a58, v234
v_accvgpr_write_b32 a59, v235
v_accvgpr_read_b32 v232, a72
v_accvgpr_read_b32 v233, a73
v_accvgpr_read_b32 v234, a74
v_accvgpr_read_b32 v235, a75
v_mul_f32 v232, v232, v242
v_mul_f32 v233, v233, v243
v_mul_f32 v234, v234, v254
v_mul_f32 v235, v235, v255
v_accvgpr_write_b32 a72, v232
v_accvgpr_write_b32 a73, v233
v_accvgpr_write_b32 a74, v234
v_accvgpr_write_b32 a75, v235
v_accvgpr_read_b32 v232, a88
v_accvgpr_read_b32 v233, a89
v_accvgpr_read_b32 v234, a90
v_accvgpr_read_b32 v235, a91
v_mul_f32 v232, v232, v242
v_mul_f32 v233, v233, v243
v_mul_f32 v234, v234, v254
v_mul_f32 v235, v235, v255
v_accvgpr_write_b32 a88, v232
v_accvgpr_write_b32 a89, v233
v_accvgpr_write_b32 a90, v234
v_accvgpr_write_b32 a91, v235
v_accvgpr_read_b32 v232, a104
v_accvgpr_read_b32 v233, a105
v_accvgpr_read_b32 v234, a106
v_accvgpr_read_b32 v235, a107
v_mul_f32 v232, v232, v242
v_mul_f32 v233, v233, v243
v_mul_f32 v234, v234, v254
v_mul_f32 v235, v235, v255
v_accvgpr_write_b32 a104, v232
v_accvgpr_write_b32 a105, v233
v_accvgpr_write_b32 a106, v234
v_accvgpr_write_b32 a107, v235
v_accvgpr_read_b32 v232, a120
v_accvgpr_read_b32 v233, a121
v_accvgpr_read_b32 v234, a122
v_accvgpr_read_b32 v235, a123
v_mul_f32 v232, v232, v242
v_mul_f32 v233, v233, v243
v_mul_f32 v234, v234, v254
v_mul_f32 v235, v235, v255
v_accvgpr_write_b32 a120, v232
v_accvgpr_write_b32 a121, v233
v_accvgpr_write_b32 a122, v234
v_accvgpr_write_b32 a123, v235
v_accvgpr_read_b32 v232, a136
v_accvgpr_read_b32 v233, a137
v_accvgpr_read_b32 v234, a138
v_accvgpr_read_b32 v235, a139
v_mul_f32 v232, v232, v242
v_mul_f32 v233, v233, v243
v_mul_f32 v234, v234, v254
v_mul_f32 v235, v235, v255
v_accvgpr_write_b32 a136, v232
v_accvgpr_write_b32 a137, v233
v_accvgpr_write_b32 a138, v234
v_accvgpr_write_b32 a139, v235
v_accvgpr_read_b32 v232, a152
v_accvgpr_read_b32 v233, a153
v_accvgpr_read_b32 v234, a154
v_accvgpr_read_b32 v235, a155
v_mul_f32 v232, v232, v242
v_mul_f32 v233, v233, v243
v_mul_f32 v234, v234, v254
v_mul_f32 v235, v235, v255
v_accvgpr_write_b32 a152, v232
v_accvgpr_write_b32 a153, v233
v_accvgpr_write_b32 a154, v234
v_accvgpr_write_b32 a155, v235
v_accvgpr_read_b32 v232, a168
v_accvgpr_read_b32 v233, a169
v_accvgpr_read_b32 v234, a170
v_accvgpr_read_b32 v235, a171
v_mul_f32 v232, v232, v242
v_mul_f32 v233, v233, v243
v_mul_f32 v234, v234, v254
v_mul_f32 v235, v235, v255
v_accvgpr_write_b32 a168, v232
v_accvgpr_write_b32 a169, v233
v_accvgpr_write_b32 a170, v234
v_accvgpr_write_b32 a171, v235
v_accvgpr_read_b32 v232, a184
v_accvgpr_read_b32 v233, a185
v_accvgpr_read_b32 v234, a186
v_accvgpr_read_b32 v235, a187
v_mul_f32 v232, v232, v242
v_mul_f32 v233, v233, v243
v_mul_f32 v234, v234, v254
v_mul_f32 v235, v235, v255
v_accvgpr_write_b32 a184, v232
v_accvgpr_write_b32 a185, v233
v_accvgpr_write_b32 a186, v234
v_accvgpr_write_b32 a187, v235
v_accvgpr_read_b32 v232, a200
v_accvgpr_read_b32 v233, a201
v_accvgpr_read_b32 v234, a202
v_accvgpr_read_b32 v235, a203
v_mul_f32 v232, v232, v242
v_mul_f32 v233, v233, v243
v_mul_f32 v234, v234, v254
v_mul_f32 v235, v235, v255
v_accvgpr_write_b32 a200, v232
v_accvgpr_write_b32 a201, v233
v_accvgpr_write_b32 a202, v234
v_accvgpr_write_b32 a203, v235
v_accvgpr_read_b32 v232, a216
v_accvgpr_read_b32 v233, a217
v_accvgpr_read_b32 v234, a218
v_accvgpr_read_b32 v235, a219
v_mul_f32 v232, v232, v242
v_mul_f32 v233, v233, v243
v_mul_f32 v234, v234, v254
v_mul_f32 v235, v235, v255
v_accvgpr_write_b32 a216, v232
v_accvgpr_write_b32 a217, v233
v_accvgpr_write_b32 a218, v234
v_accvgpr_write_b32 a219, v235
v_accvgpr_read_b32 v232, a232
v_accvgpr_read_b32 v233, a233
v_accvgpr_read_b32 v234, a234
v_accvgpr_read_b32 v235, a235
v_mul_f32 v232, v232, v242
v_mul_f32 v233, v233, v243
v_mul_f32 v234, v234, v254
v_mul_f32 v235, v235, v255
v_accvgpr_write_b32 a232, v232
v_accvgpr_write_b32 a233, v233
v_accvgpr_write_b32 a234, v234
v_accvgpr_write_b32 a235, v235
v_accvgpr_read_b32 v232, a248
v_accvgpr_read_b32 v233, a249
v_accvgpr_read_b32 v234, a250
v_accvgpr_read_b32 v235, a251
v_mul_f32 v232, v232, v242
v_mul_f32 v233, v233, v243
v_mul_f32 v234, v234, v254
v_mul_f32 v235, v235, v255
v_accvgpr_write_b32 a248, v232
v_accvgpr_write_b32 a249, v233
v_accvgpr_write_b32 a250, v234
v_accvgpr_write_b32 a251, v235
v_lshrrev_b32 v232, 4, v248
v_and_b32 v232, 0x30, v232
ds_bpermute_b32 v242, v232, v239 offset:0
ds_bpermute_b32 v243, v232, v239 offset:4
ds_bpermute_b32 v254, v232, v239 offset:8
ds_bpermute_b32 v255, v232, v239 offset:12
s_waitcnt lgkmcnt(0)
v_accvgpr_read_b32 v232, a12
v_accvgpr_read_b32 v233, a13
v_accvgpr_read_b32 v234, a14
v_accvgpr_read_b32 v235, a15
v_mul_f32 v232, v232, v242
v_mul_f32 v233, v233, v243
v_mul_f32 v234, v234, v254
v_mul_f32 v235, v235, v255
v_accvgpr_write_b32 a12, v232
v_accvgpr_write_b32 a13, v233
v_accvgpr_write_b32 a14, v234
v_accvgpr_write_b32 a15, v235
v_accvgpr_read_b32 v232, a28
v_accvgpr_read_b32 v233, a29
v_accvgpr_read_b32 v234, a30
v_accvgpr_read_b32 v235, a31
v_mul_f32 v232, v232, v242
v_mul_f32 v233, v233, v243
v_mul_f32 v234, v234, v254
v_mul_f32 v235, v235, v255
v_accvgpr_write_b32 a28, v232
v_accvgpr_write_b32 a29, v233
v_accvgpr_write_b32 a30, v234
v_accvgpr_write_b32 a31, v235
v_accvgpr_read_b32 v232, a44
v_accvgpr_read_b32 v233, a45
v_accvgpr_read_b32 v234, a46
v_accvgpr_read_b32 v235, a47
v_mul_f32 v232, v232, v242
v_mul_f32 v233, v233, v243
v_mul_f32 v234, v234, v254
v_mul_f32 v235, v235, v255
v_accvgpr_write_b32 a44, v232
v_accvgpr_write_b32 a45, v233
v_accvgpr_write_b32 a46, v234
v_accvgpr_write_b32 a47, v235
v_accvgpr_read_b32 v232, a60
v_accvgpr_read_b32 v233, a61
v_accvgpr_read_b32 v234, a62
v_accvgpr_read_b32 v235, a63
v_mul_f32 v232, v232, v242
v_mul_f32 v233, v233, v243
v_mul_f32 v234, v234, v254
v_mul_f32 v235, v235, v255
v_accvgpr_write_b32 a60, v232
v_accvgpr_write_b32 a61, v233
v_accvgpr_write_b32 a62, v234
v_accvgpr_write_b32 a63, v235
v_accvgpr_read_b32 v232, a76
v_accvgpr_read_b32 v233, a77
v_accvgpr_read_b32 v234, a78
v_accvgpr_read_b32 v235, a79
v_mul_f32 v232, v232, v242
v_mul_f32 v233, v233, v243
v_mul_f32 v234, v234, v254
v_mul_f32 v235, v235, v255
v_accvgpr_write_b32 a76, v232
v_accvgpr_write_b32 a77, v233
v_accvgpr_write_b32 a78, v234
v_accvgpr_write_b32 a79, v235
v_accvgpr_read_b32 v232, a92
v_accvgpr_read_b32 v233, a93
v_accvgpr_read_b32 v234, a94
v_accvgpr_read_b32 v235, a95
v_mul_f32 v232, v232, v242
v_mul_f32 v233, v233, v243
v_mul_f32 v234, v234, v254
v_mul_f32 v235, v235, v255
v_accvgpr_write_b32 a92, v232
v_accvgpr_write_b32 a93, v233
v_accvgpr_write_b32 a94, v234
v_accvgpr_write_b32 a95, v235
v_accvgpr_read_b32 v232, a108
v_accvgpr_read_b32 v233, a109
v_accvgpr_read_b32 v234, a110
v_accvgpr_read_b32 v235, a111
v_mul_f32 v232, v232, v242
v_mul_f32 v233, v233, v243
v_mul_f32 v234, v234, v254
v_mul_f32 v235, v235, v255
v_accvgpr_write_b32 a108, v232
v_accvgpr_write_b32 a109, v233
v_accvgpr_write_b32 a110, v234
v_accvgpr_write_b32 a111, v235
v_accvgpr_read_b32 v232, a124
v_accvgpr_read_b32 v233, a125
v_accvgpr_read_b32 v234, a126
v_accvgpr_read_b32 v235, a127
v_mul_f32 v232, v232, v242
v_mul_f32 v233, v233, v243
v_mul_f32 v234, v234, v254
v_mul_f32 v235, v235, v255
v_accvgpr_write_b32 a124, v232
v_accvgpr_write_b32 a125, v233
v_accvgpr_write_b32 a126, v234
v_accvgpr_write_b32 a127, v235
v_accvgpr_read_b32 v232, a140
v_accvgpr_read_b32 v233, a141
v_accvgpr_read_b32 v234, a142
v_accvgpr_read_b32 v235, a143
v_mul_f32 v232, v232, v242
v_mul_f32 v233, v233, v243
v_mul_f32 v234, v234, v254
v_mul_f32 v235, v235, v255
v_accvgpr_write_b32 a140, v232
v_accvgpr_write_b32 a141, v233
v_accvgpr_write_b32 a142, v234
v_accvgpr_write_b32 a143, v235
v_accvgpr_read_b32 v232, a156
v_accvgpr_read_b32 v233, a157
v_accvgpr_read_b32 v234, a158
v_accvgpr_read_b32 v235, a159
v_mul_f32 v232, v232, v242
v_mul_f32 v233, v233, v243
v_mul_f32 v234, v234, v254
v_mul_f32 v235, v235, v255
v_accvgpr_write_b32 a156, v232
v_accvgpr_write_b32 a157, v233
v_accvgpr_write_b32 a158, v234
v_accvgpr_write_b32 a159, v235
v_accvgpr_read_b32 v232, a172
v_accvgpr_read_b32 v233, a173
v_accvgpr_read_b32 v234, a174
v_accvgpr_read_b32 v235, a175
v_mul_f32 v232, v232, v242
v_mul_f32 v233, v233, v243
v_mul_f32 v234, v234, v254
v_mul_f32 v235, v235, v255
v_accvgpr_write_b32 a172, v232
v_accvgpr_write_b32 a173, v233
v_accvgpr_write_b32 a174, v234
v_accvgpr_write_b32 a175, v235
v_accvgpr_read_b32 v232, a188
v_accvgpr_read_b32 v233, a189
v_accvgpr_read_b32 v234, a190
v_accvgpr_read_b32 v235, a191
v_mul_f32 v232, v232, v242
v_mul_f32 v233, v233, v243
v_mul_f32 v234, v234, v254
v_mul_f32 v235, v235, v255
v_accvgpr_write_b32 a188, v232
v_accvgpr_write_b32 a189, v233
v_accvgpr_write_b32 a190, v234
v_accvgpr_write_b32 a191, v235
v_accvgpr_read_b32 v232, a204
v_accvgpr_read_b32 v233, a205
v_accvgpr_read_b32 v234, a206
v_accvgpr_read_b32 v235, a207
v_mul_f32 v232, v232, v242
v_mul_f32 v233, v233, v243
v_mul_f32 v234, v234, v254
v_mul_f32 v235, v235, v255
v_accvgpr_write_b32 a204, v232
v_accvgpr_write_b32 a205, v233
v_accvgpr_write_b32 a206, v234
v_accvgpr_write_b32 a207, v235
v_accvgpr_read_b32 v232, a220
v_accvgpr_read_b32 v233, a221
v_accvgpr_read_b32 v234, a222
v_accvgpr_read_b32 v235, a223
v_mul_f32 v232, v232, v242
v_mul_f32 v233, v233, v243
v_mul_f32 v234, v234, v254
v_mul_f32 v235, v235, v255
v_accvgpr_write_b32 a220, v232
v_accvgpr_write_b32 a221, v233
v_accvgpr_write_b32 a222, v234
v_accvgpr_write_b32 a223, v235
v_accvgpr_read_b32 v232, a236
v_accvgpr_read_b32 v233, a237
v_accvgpr_read_b32 v234, a238
v_accvgpr_read_b32 v235, a239
v_mul_f32 v232, v232, v242
v_mul_f32 v233, v233, v243
v_mul_f32 v234, v234, v254
v_mul_f32 v235, v235, v255
v_accvgpr_write_b32 a236, v232
v_accvgpr_write_b32 a237, v233
v_accvgpr_write_b32 a238, v234
v_accvgpr_write_b32 a239, v235
v_accvgpr_read_b32 v232, a252
v_accvgpr_read_b32 v233, a253
v_accvgpr_read_b32 v234, a254
v_accvgpr_read_b32 v235, a255
v_mul_f32 v232, v232, v242
v_mul_f32 v233, v233, v243
v_mul_f32 v234, v234, v254
v_mul_f32 v235, v235, v255
v_accvgpr_write_b32 a252, v232
v_accvgpr_write_b32 a253, v233
v_accvgpr_write_b32 a254, v234
v_accvgpr_write_b32 a255, v235
s_nop 3
s_cmp_eq_u32 s36, 0
s_cbranch_scc1 L2_ret0
s_cmp_eq_u32 s36, 1
s_cbranch_scc1 L2_ret1
s_cmp_eq_u32 s36, 2
s_cbranch_scc1 L2_ret2
s_cmp_eq_u32 s36, 3
s_cbranch_scc1 L2_ret3
s_cmp_eq_u32 s36, 4
s_cbranch_scc1 L2_ret4
s_cmp_eq_u32 s36, 5
s_cbranch_scc1 L2_ret5
s_cmp_eq_u32 s36, 6
s_cbranch_scc1 L2_ret6
s_cmp_eq_u32 s36, 7
s_cbranch_scc1 L2_ret7
s_cmp_eq_u32 s36, 8
s_cbranch_scc1 L2_ret8
s_cmp_eq_u32 s36, 9
s_cbranch_scc1 L2_ret9
s_cmp_eq_u32 s36, 10
s_cbranch_scc1 L2_ret10
s_cmp_eq_u32 s36, 11
s_cbranch_scc1 L2_ret11
s_cmp_eq_u32 s36, 12
s_cbranch_scc1 L2_ret12
s_cmp_eq_u32 s36, 13
s_cbranch_scc1 L2_ret13
s_cmp_eq_u32 s36, 14
s_cbranch_scc1 L2_ret14
s_cmp_eq_u32 s36, 15
s_cbranch_scc1 L2_ret15
s_cmp_eq_u32 s36, 16
s_cbranch_scc1 L2_ret16
s_branch L2_ret17
LT_disp:
s_cmp_ge_i32 s36, 0
s_cbranch_scc1 LT_start
s_cmp_eq_u32 s34, 0
s_cbranch_scc1 L2_end
s_mov_b32 s41, s34
s_mul_i32 s40, s34, 6
s_add_u32 s40, s40, s37
s_add_u32 s40, s40, 42
s_cmp_lt_u32 s40, 64
s_cbranch_scc1 LE_common
s_branch L2_end
LT_start:
s_waitcnt lgkmcnt(0)
s_add_u32 s12, s4, 0x7c2a000
s_addc_u32 s13, s5, 0
s_mov_b32 s14, 0x8000
s_mov_b32 s15, 0x00020000
v_and_b32 v8, 63, v0
v_lshlrev_b32 v8, 7, v8
s_mov_b32 s91, 8192
s_mov_b32 s90, 16384
s_mov_b32 s95, 24576
v_min_u32 v9, 5248, v8
s_mov_b32 s94, 0x10000
LT_poll:
buffer_load_dwordx2 v[0:1], v8, s[12:15], 0 offen sc1
buffer_load_dwordx2 v[2:3], v8, s[12:15], s91 offen sc1
buffer_load_dwordx2 v[4:5], v8, s[12:15], s90 offen sc1
buffer_load_dwordx2 v[6:7], v9, s[12:15], s95 offen sc1
s_sub_u32 s94, s94, 1
s_waitcnt vmcnt(0)
s_cbranch_scc1 LT_poll_go
v_cmp_ne_u64 vcc, s[98:99], v[0:1]
s_nop 1
s_cbranch_vccnz LT_poll
v_cmp_ne_u64 vcc, s[98:99], v[2:3]
s_nop 1
s_cbranch_vccnz LT_poll
v_cmp_ne_u64 vcc, s[98:99], v[4:5]
s_nop 1
s_cbranch_vccnz LT_poll
v_cmp_ne_u64 vcc, s[98:99], v[6:7]
s_nop 1
s_cbranch_vccnz LT_poll
LT_poll_go:
s_add_u32 s31, s31, -22
s_add_u32 s3, s28, 409600
s_cmp_eq_u32 s36, 0
s_cselect_b32 s31, 26, s31
s_cselect_b32 s39, s39, s3
s_cselect_b32 s33, s33, 0
s_cselect_b32 s3, 0, 425984
s_add_u32 s28, s28, s3
s_add_u32 s12, s4, 0x6800000
s_addc_u32 s13, s5, 0
s_mov_b32 s14, 0x0
s_mov_b32 s15, 0x00020000
s_mov_b32 s14, s49
s_add_u32 s8, s4, 0x0
s_addc_u32 s9, s5, 0
s_mov_b32 s10, 0x4e4000
s_mov_b32 s11, 0x00020000
s_mov_b32 s40, 5111808
s_mov_b32 s44, 5115904
buffer_load_dwordx4 v[0:3], v248, s[8:11], s40 offen offset:0 sc1
buffer_load_dwordx4 v[4:7], v248, s[8:11], s40 offen offset:1024 sc1
buffer_load_dwordx4 v[8:11], v248, s[8:11], s40 offen offset:2048 sc1
buffer_load_dwordx4 v[12:15], v248, s[8:11], s40 offen offset:3072 sc1
buffer_load_dwordx4 v[16:19], v248, s[8:11], s44 offen offset:0 sc1
buffer_load_dwordx4 v[20:23], v248, s[8:11], s44 offen offset:1024 sc1
buffer_load_dwordx4 v[24:27], v248, s[8:11], s44 offen offset:2048 sc1
buffer_load_dwordx4 v[28:31], v248, s[8:11], s44 offen offset:3072 sc1
s_mov_b32 s53, 0
s_add_u32 m0, s53, 90112
s_add_u32 s54, s39, 0
buffer_load_dwordx4 v241, s[12:15], s54 offen offset:0 sc1 lds
buffer_load_dwordx4 v241, s[12:15], s54 offen offset:1024 sc1 lds
buffer_load_dwordx4 v241, s[12:15], s54 offen offset:2048 sc1 lds
buffer_load_dwordx4 v241, s[12:15], s54 offen offset:3072 sc1 lds
s_add_u32 m0, s53, 94208
s_add_u32 s54, s39, 128
buffer_load_dwordx4 v241, s[12:15], s54 offen offset:0 sc1 lds
buffer_load_dwordx4 v241, s[12:15], s54 offen offset:1024 sc1 lds
buffer_load_dwordx4 v241, s[12:15], s54 offen offset:2048 sc1 lds
buffer_load_dwordx4 v241, s[12:15], s54 offen offset:3072 sc1 lds
s_add_u32 m0, s53, 98304
s_add_u32 s54, s39, 256
buffer_load_dwordx4 v241, s[12:15], s54 offen offset:0 sc1 lds
buffer_load_dwordx4 v241, s[12:15], s54 offen offset:1024 sc1 lds
buffer_load_dwordx4 v241, s[12:15], s54 offen offset:2048 sc1 lds
buffer_load_dwordx4 v241, s[12:15], s54 offen offset:3072 sc1 lds
s_add_u32 m0, s53, 102400
s_add_u32 s54, s39, 384
buffer_load_dwordx4 v241, s[12:15], s54 offen offset:0 sc1 lds
buffer_load_dwordx4 v241, s[12:15], s54 offen offset:1024 sc1 lds
buffer_load_dwordx4 v241, s[12:15], s54 offen offset:2048 sc1 lds
buffer_load_dwordx4 v241, s[12:15], s54 offen offset:3072 sc1 lds
s_add_u32 s53, s53, 0x4000
s_and_b32 s53, s53, 0xffff
s_add_u32 m0, s53, 90112
s_add_u32 s54, s28, 0
buffer_load_dwordx4 v241, s[12:15], s54 offen offset:0 sc1 lds
buffer_load_dwordx4 v241, s[12:15], s54 offen offset:1024 sc1 lds
buffer_load_dwordx4 v241, s[12:15], s54 offen offset:2048 sc1 lds
buffer_load_dwordx4 v241, s[12:15], s54 offen offset:3072 sc1 lds
s_add_u32 m0, s53, 94208
s_add_u32 s54, s28, 128
buffer_load_dwordx4 v241, s[12:15], s54 offen offset:0 sc1 lds
buffer_load_dwordx4 v241, s[12:15], s54 offen offset:1024 sc1 lds
buffer_load_dwordx4 v241, s[12:15], s54 offen offset:2048 sc1 lds
buffer_load_dwordx4 v241, s[12:15], s54 offen offset:3072 sc1 lds
s_add_u32 m0, s53, 98304
s_add_u32 s54, s28, 256
buffer_load_dwordx4 v241, s[12:15], s54 offen offset:0 sc1 lds
buffer_load_dwordx4 v241, s[12:15], s54 offen offset:1024 sc1 lds
buffer_load_dwordx4 v241, s[12:15], s54 offen offset:2048 sc1 lds
buffer_load_dwordx4 v241, s[12:15], s54 offen offset:3072 sc1 lds
s_add_u32 m0, s53, 102400
s_add_u32 s54, s28, 384
buffer_load_dwordx4 v241, s[12:15], s54 offen offset:0 sc1 lds
buffer_load_dwordx4 v241, s[12:15], s54 offen offset:1024 sc1 lds
buffer_load_dwordx4 v241, s[12:15], s54 offen offset:2048 sc1 lds
buffer_load_dwordx4 v241, s[12:15], s54 offen offset:3072 sc1 lds
s_add_u32 s53, s53, 0x4000
s_and_b32 s53, s53, 0xffff
s_add_u32 s28, s28, 0x4000
s_add_u32 m0, s53, 90112
s_add_u32 s54, s28, 0
buffer_load_dwordx4 v241, s[12:15], s54 offen offset:0 sc1 lds
buffer_load_dwordx4 v241, s[12:15], s54 offen offset:1024 sc1 lds
buffer_load_dwordx4 v241, s[12:15], s54 offen offset:2048 sc1 lds
buffer_load_dwordx4 v241, s[12:15], s54 offen offset:3072 sc1 lds
s_add_u32 m0, s53, 94208
s_add_u32 s54, s28, 128
buffer_load_dwordx4 v241, s[12:15], s54 offen offset:0 sc1 lds
buffer_load_dwordx4 v241, s[12:15], s54 offen offset:1024 sc1 lds
buffer_load_dwordx4 v241, s[12:15], s54 offen offset:2048 sc1 lds
buffer_load_dwordx4 v241, s[12:15], s54 offen offset:3072 sc1 lds
s_add_u32 m0, s53, 98304
s_add_u32 s54, s28, 256
buffer_load_dwordx4 v241, s[12:15], s54 offen offset:0 sc1 lds
buffer_load_dwordx4 v241, s[12:15], s54 offen offset:1024 sc1 lds
buffer_load_dwordx4 v241, s[12:15], s54 offen offset:2048 sc1 lds
buffer_load_dwordx4 v241, s[12:15], s54 offen offset:3072 sc1 lds
s_add_u32 m0, s53, 102400
s_add_u32 s54, s28, 384
buffer_load_dwordx4 v241, s[12:15], s54 offen offset:0 sc1 lds
buffer_load_dwordx4 v241, s[12:15], s54 offen offset:1024 sc1 lds
buffer_load_dwordx4 v241, s[12:15], s54 offen offset:2048 sc1 lds
buffer_load_dwordx4 v241, s[12:15], s54 offen offset:3072 sc1 lds
s_add_u32 s53, s53, 0x4000
s_and_b32 s53, s53, 0xffff
s_add_u32 s28, s28, 0x4000
s_mul_i32 s35, s37, 0x600000
s_add_u32 s20, s4, 0x2000000
s_addc_u32 s21, s5, 0
s_add_u32 s20, s20, s35
s_addc_u32 s21, s21, 0
s_mov_b32 s22, 0x4e4000
s_mov_b32 s23, 0x00020000
s_add_u32 s24, s4, 0x6000000
s_addc_u32 s25, s5, 0
s_mov_b32 s26, 0x139000
s_mov_b32 s27, 0x00020000
s_lshl_b32 s48, s37, 3
s_add_u32 s48, s48, 638976
s_mov_b32 s48, 1277952
v_bfe_u32 v240, v248, 4, 3
v_lshlrev_b32 v240, 6, v240
v_bfe_u32 v242, v248, 7, 1
v_lshl_or_b32 v240, v242, 10, v240
v_bfe_u32 v242, v248, 8, 2
v_lshl_or_b32 v240, v242, 4, v240
v_bfe_u32 v242, v248, 6, 1
v_lshlrev_b32 v242, 5, v242
v_xor_b32 v240, v240, v242
v_and_b32 v249, 0x1c0, v248
v_bfe_u32 v242, v248, 9, 1
v_lshl_or_b32 v249, v242, 10, v249
v_bfe_u32 v242, v248, 8, 1
v_lshl_or_b32 v249, v242, 5, v249
v_bfe_u32 v242, v248, 4, 2
v_lshl_or_b32 v249, v242, 3, v249
v_xor_b32 v250, 32, v249
v_bfe_i32 v242, v248, 8, 1
v_and_b32 v192, s33, v242
v_and_b32 v193, s33, v242
v_and_b32 v194, s33, v242
v_and_b32 v195, s33, v242
s_add_u32 s51, s31, 0
s_mov_b32 s52, 90112
v_mov_b32 v172, 0xff800000
v_mov_b32 v173, 0
v_accvgpr_write_b32 a0, 0
v_accvgpr_write_b32 a1, 0
v_accvgpr_write_b32 a2, 0
v_accvgpr_write_b32 a3, 0
v_accvgpr_write_b32 a4, 0
v_accvgpr_write_b32 a5, 0
v_accvgpr_write_b32 a6, 0
v_accvgpr_write_b32 a7, 0
v_accvgpr_write_b32 a8, 0
v_accvgpr_write_b32 a9, 0
v_accvgpr_write_b32 a10, 0
v_accvgpr_write_b32 a11, 0
v_accvgpr_write_b32 a12, 0
v_accvgpr_write_b32 a13, 0
v_accvgpr_write_b32 a14, 0
v_accvgpr_write_b32 a15, 0
v_accvgpr_write_b32 a16, 0
v_accvgpr_write_b32 a17, 0
v_accvgpr_write_b32 a18, 0
v_accvgpr_write_b32 a19, 0
v_accvgpr_write_b32 a20, 0
v_accvgpr_write_b32 a21, 0
v_accvgpr_write_b32 a22, 0
v_accvgpr_write_b32 a23, 0
v_accvgpr_write_b32 a24, 0
v_accvgpr_write_b32 a25, 0
v_accvgpr_write_b32 a26, 0
v_accvgpr_write_b32 a27, 0
v_accvgpr_write_b32 a28, 0
v_accvgpr_write_b32 a29, 0
v_accvgpr_write_b32 a30, 0
v_accvgpr_write_b32 a31, 0
v_accvgpr_write_b32 a32, 0
v_accvgpr_write_b32 a33, 0
v_accvgpr_write_b32 a34, 0
v_accvgpr_write_b32 a35, 0
v_accvgpr_write_b32 a36, 0
v_accvgpr_write_b32 a37, 0
v_accvgpr_write_b32 a38, 0
v_accvgpr_write_b32 a39, 0
v_accvgpr_write_b32 a40, 0
v_accvgpr_write_b32 a41, 0
v_accvgpr_write_b32 a42, 0
v_accvgpr_write_b32 a43, 0
v_accvgpr_write_b32 a44, 0
v_accvgpr_write_b32 a45, 0
v_accvgpr_write_b32 a46, 0
v_accvgpr_write_b32 a47, 0
v_accvgpr_write_b32 a48, 0
v_accvgpr_write_b32 a49, 0
v_accvgpr_write_b32 a50, 0
v_accvgpr_write_b32 a51, 0
v_accvgpr_write_b32 a52, 0
v_accvgpr_write_b32 a53, 0
v_accvgpr_write_b32 a54, 0
v_accvgpr_write_b32 a55, 0
v_accvgpr_write_b32 a56, 0
v_accvgpr_write_b32 a57, 0
v_accvgpr_write_b32 a58, 0
v_accvgpr_write_b32 a59, 0
v_accvgpr_write_b32 a60, 0
v_accvgpr_write_b32 a61, 0
v_accvgpr_write_b32 a62, 0
v_accvgpr_write_b32 a63, 0
LT_loop:
s_add_u32 m0, s53, 90112
s_add_u32 s54, s28, 0
buffer_load_dwordx4 v241, s[12:15], s54 offen offset:0 sc1 lds
buffer_load_dwordx4 v241, s[12:15], s54 offen offset:1024 sc1 lds
buffer_load_dwordx4 v241, s[12:15], s54 offen offset:2048 sc1 lds
buffer_load_dwordx4 v241, s[12:15], s54 offen offset:3072 sc1 lds
s_add_u32 m0, s53, 94208
s_add_u32 s54, s28, 128
buffer_load_dwordx4 v241, s[12:15], s54 offen offset:0 sc1 lds
buffer_load_dwordx4 v241, s[12:15], s54 offen offset:1024 sc1 lds
buffer_load_dwordx4 v241, s[12:15], s54 offen offset:2048 sc1 lds
buffer_load_dwordx4 v241, s[12:15], s54 offen offset:3072 sc1 lds
s_add_u32 m0, s53, 98304
s_add_u32 s54, s28, 256
buffer_load_dwordx4 v241, s[12:15], s54 offen offset:0 sc1 lds
buffer_load_dwordx4 v241, s[12:15], s54 offen offset:1024 sc1 lds
buffer_load_dwordx4 v241, s[12:15], s54 offen offset:2048 sc1 lds
buffer_load_dwordx4 v241, s[12:15], s54 offen offset:3072 sc1 lds
s_add_u32 m0, s53, 102400
s_add_u32 s54, s28, 384
buffer_load_dwordx4 v241, s[12:15], s54 offen offset:0 sc1 lds
buffer_load_dwordx4 v241, s[12:15], s54 offen offset:1024 sc1 lds
buffer_load_dwordx4 v241, s[12:15], s54 offen offset:2048 sc1 lds
buffer_load_dwordx4 v241, s[12:15], s54 offen offset:3072 sc1 lds
s_add_u32 s53, s53, 0x4000
s_and_b32 s53, s53, 0xffff
s_add_u32 s28, s28, 0x4000
v_add_u32 v177, s52, v240
v_add_u32 v178, s52, v249
v_add_u32 v179, s52, v250
s_add_u32 s52, s52, 0x4000
s_cmp_eq_u32 s52, 155648
s_cselect_b32 s52, 90112, s52
s_waitcnt vmcnt(48)
ds_read_b128 v[32:35], v177 offset:0
ds_read_b128 v[64:67], v177 offset:2048
ds_read_b128 v[36:39], v177 offset:512
ds_read_b128 v[68:71], v177 offset:2560
ds_read_b128 v[40:43], v177 offset:4096
ds_read_b128 v[72:75], v177 offset:6144
ds_read_b128 v[44:47], v177 offset:4608
ds_read_b128 v[76:79], v177 offset:6656
ds_read_b128 v[48:51], v177 offset:8192
ds_read_b128 v[80:83], v177 offset:10240
ds_read_b128 v[52:55], v177 offset:8704
ds_read_b128 v[84:87], v177 offset:10752
ds_read_b128 v[56:59], v177 offset:12288
ds_read_b128 v[88:91], v177 offset:14336
ds_read_b128 v[60:63], v177 offset:12800
ds_read_b128 v[92:95], v177 offset:14848
s_waitcnt lgkmcnt(14)
v_mfma_f32_16x16x32_bf16 v[160:163], v[32:35], v[0:3], v[192:195]
v_mfma_f32_16x16x32_bf16 v[164:167], v[64:67], v[0:3], v[192:195]
s_waitcnt lgkmcnt(12)
v_mfma_f32_16x16x32_bf16 v[160:163], v[36:39], v[4:7], v[160:163]
v_mfma_f32_16x16x32_bf16 v[164:167], v[68:71], v[4:7], v[164:167]
s_waitcnt lgkmcnt(10)
v_mfma_f32_16x16x32_bf16 v[160:163], v[40:43], v[8:11], v[160:163]
v_mfma_f32_16x16x32_bf16 v[164:167], v[72:75], v[8:11], v[164:167]
s_waitcnt lgkmcnt(8)
v_mfma_f32_16x16x32_bf16 v[160:163], v[44:47], v[12:15], v[160:163]
v_mfma_f32_16x16x32_bf16 v[164:167], v[76:79], v[12:15], v[164:167]
s_waitcnt lgkmcnt(6)
v_mfma_f32_16x16x32_bf16 v[160:163], v[48:51], v[16:19], v[160:163]
v_mfma_f32_16x16x32_bf16 v[164:167], v[80:83], v[16:19], v[164:167]
s_waitcnt lgkmcnt(4)
v_mfma_f32_16x16x32_bf16 v[160:163], v[52:55], v[20:23], v[160:163]
v_mfma_f32_16x16x32_bf16 v[164:167], v[84:87], v[20:23], v[164:167]
s_waitcnt lgkmcnt(2)
v_mfma_f32_16x16x32_bf16 v[160:163], v[56:59], v[24:27], v[160:163]
v_mfma_f32_16x16x32_bf16 v[164:167], v[88:91], v[24:27], v[164:167]
s_waitcnt lgkmcnt(0)
v_mfma_f32_16x16x32_bf16 v[160:163], v[60:63], v[28:31], v[160:163]
v_mfma_f32_16x16x32_bf16 v[164:167], v[92:95], v[28:31], v[164:167]
ds_read_b64_tr_b16 v[96:97], v178 offset:0
ds_read_b64_tr_b16 v[98:99], v178 offset:2048
ds_read_b64_tr_b16 v[100:101], v179 offset:0
ds_read_b64_tr_b16 v[102:103], v179 offset:2048
ds_read_b64_tr_b16 v[104:105], v178 offset:512
ds_read_b64_tr_b16 v[106:107], v178 offset:2560
ds_read_b64_tr_b16 v[108:109], v179 offset:512
ds_read_b64_tr_b16 v[110:111], v179 offset:2560
ds_read_b64_tr_b16 v[112:113], v178 offset:4096
ds_read_b64_tr_b16 v[114:115], v178 offset:6144
ds_read_b64_tr_b16 v[116:117], v179 offset:4096
ds_read_b64_tr_b16 v[118:119], v179 offset:6144
ds_read_b64_tr_b16 v[120:121], v178 offset:4608
ds_read_b64_tr_b16 v[122:123], v178 offset:6656
ds_read_b64_tr_b16 v[124:125], v179 offset:4608
ds_read_b64_tr_b16 v[126:127], v179 offset:6656
ds_read_b64_tr_b16 v[128:129], v178 offset:8192
ds_read_b64_tr_b16 v[130:131], v178 offset:10240
ds_read_b64_tr_b16 v[132:133], v179 offset:8192
ds_read_b64_tr_b16 v[134:135], v179 offset:10240
ds_read_b64_tr_b16 v[136:137], v178 offset:8704
ds_read_b64_tr_b16 v[138:139], v178 offset:10752
ds_read_b64_tr_b16 v[140:141], v179 offset:8704
ds_read_b64_tr_b16 v[142:143], v179 offset:10752
ds_read_b64_tr_b16 v[144:145], v178 offset:12288
ds_read_b64_tr_b16 v[146:147], v178 offset:14336
ds_read_b64_tr_b16 v[148:149], v179 offset:12288
ds_read_b64_tr_b16 v[150:151], v179 offset:14336
ds_read_b64_tr_b16 v[152:153], v178 offset:12800
ds_read_b64_tr_b16 v[154:155], v178 offset:14848
ds_read_b64_tr_b16 v[156:157], v179 offset:12800
ds_read_b64_tr_b16 v[158:159], v179 offset:14848
v_mov_b32 v192, 0
v_mov_b32 v193, 0
v_mov_b32 v194, 0
v_mov_b32 v195, 0
s_nop 7
v_max3_f32 v175, v160, v161, v162
v_max3_f32 v175, v175, v163, v164
v_max3_f32 v175, v175, v165, v166
v_max3_f32 v175, v175, v167, v172
v_mov_b32 v176, v175
s_nop 1
v_permlane32_swap_b32 v175, v176
s_nop 1
v_max_f32 v175, v175, v176
v_mov_b32 v176, v175
s_nop 1
v_permlane16_swap_b32 v175, v176
s_nop 1
v_max_f32 v175, v175, v176
v_ceil_f32 v175, v175
v_sub_f32 v174, v172, v175
v_exp_f32 v174, v174
v_mov_b32 v172, v175
v_sub_f32 v160, v160, v172
v_sub_f32 v161, v161, v172
v_sub_f32 v162, v162, v172
v_sub_f32 v163, v163, v172
v_sub_f32 v164, v164, v172
v_sub_f32 v165, v165, v172
v_sub_f32 v166, v166, v172
v_sub_f32 v167, v167, v172
v_exp_f32 v160, v160
v_exp_f32 v161, v161
v_exp_f32 v162, v162
v_exp_f32 v163, v163
v_exp_f32 v164, v164
v_exp_f32 v165, v165
v_exp_f32 v166, v166
v_exp_f32 v167, v167
v_mul_f32 v173, v173, v174
v_cvt_pk_bf16_f32 v168, v160, v161
v_cvt_pk_bf16_f32 v169, v162, v163
v_cvt_pk_bf16_f32 v170, v164, v165
v_cvt_pk_bf16_f32 v171, v166, v167
v_cmp_neq_f32 vcc, 1.0, v174
v_add_f32 v173, v173, v160
v_add_f32 v173, v173, v161
v_add_f32 v173, v173, v162
v_add_f32 v173, v173, v163
v_add_f32 v173, v173, v164
v_add_f32 v173, v173, v165
v_add_f32 v173, v173, v166
v_add_f32 v173, v173, v167
s_cbranch_vccz LT_nors
v_lshrrev_b32 v176, 4, v248
v_and_b32 v176, 0x30, v176
ds_bpermute_b32 v188, v176, v174 offset:0
ds_bpermute_b32 v189, v176, v174 offset:4
ds_bpermute_b32 v190, v176, v174 offset:8
ds_bpermute_b32 v191, v176, v174 offset:12
s_waitcnt lgkmcnt(0)
v_accvgpr_read_b32 v180, a0
v_accvgpr_read_b32 v181, a1
v_accvgpr_read_b32 v182, a2
v_accvgpr_read_b32 v183, a3
v_accvgpr_read_b32 v184, a4
v_accvgpr_read_b32 v185, a5
v_accvgpr_read_b32 v186, a6
v_accvgpr_read_b32 v187, a7
v_mul_f32 v180, v180, v188
v_mul_f32 v181, v181, v189
v_mul_f32 v182, v182, v190
v_mul_f32 v183, v183, v191
v_mul_f32 v184, v184, v188
v_mul_f32 v185, v185, v189
v_mul_f32 v186, v186, v190
v_mul_f32 v187, v187, v191
v_accvgpr_write_b32 a0, v180
v_accvgpr_write_b32 a1, v181
v_accvgpr_write_b32 a2, v182
v_accvgpr_write_b32 a3, v183
v_accvgpr_write_b32 a4, v184
v_accvgpr_write_b32 a5, v185
v_accvgpr_write_b32 a6, v186
v_accvgpr_write_b32 a7, v187
v_accvgpr_read_b32 v180, a8
v_accvgpr_read_b32 v181, a9
v_accvgpr_read_b32 v182, a10
v_accvgpr_read_b32 v183, a11
v_accvgpr_read_b32 v184, a12
v_accvgpr_read_b32 v185, a13
v_accvgpr_read_b32 v186, a14
v_accvgpr_read_b32 v187, a15
v_mul_f32 v180, v180, v188
v_mul_f32 v181, v181, v189
v_mul_f32 v182, v182, v190
v_mul_f32 v183, v183, v191
v_mul_f32 v184, v184, v188
v_mul_f32 v185, v185, v189
v_mul_f32 v186, v186, v190
v_mul_f32 v187, v187, v191
v_accvgpr_write_b32 a8, v180
v_accvgpr_write_b32 a9, v181
v_accvgpr_write_b32 a10, v182
v_accvgpr_write_b32 a11, v183
v_accvgpr_write_b32 a12, v184
v_accvgpr_write_b32 a13, v185
v_accvgpr_write_b32 a14, v186
v_accvgpr_write_b32 a15, v187
v_accvgpr_read_b32 v180, a16
v_accvgpr_read_b32 v181, a17
v_accvgpr_read_b32 v182, a18
v_accvgpr_read_b32 v183, a19
v_accvgpr_read_b32 v184, a20
v_accvgpr_read_b32 v185, a21
v_accvgpr_read_b32 v186, a22
v_accvgpr_read_b32 v187, a23
v_mul_f32 v180, v180, v188
v_mul_f32 v181, v181, v189
v_mul_f32 v182, v182, v190
v_mul_f32 v183, v183, v191
v_mul_f32 v184, v184, v188
v_mul_f32 v185, v185, v189
v_mul_f32 v186, v186, v190
v_mul_f32 v187, v187, v191
v_accvgpr_write_b32 a16, v180
v_accvgpr_write_b32 a17, v181
v_accvgpr_write_b32 a18, v182
v_accvgpr_write_b32 a19, v183
v_accvgpr_write_b32 a20, v184
v_accvgpr_write_b32 a21, v185
v_accvgpr_write_b32 a22, v186
v_accvgpr_write_b32 a23, v187
v_accvgpr_read_b32 v180, a24
v_accvgpr_read_b32 v181, a25
v_accvgpr_read_b32 v182, a26
v_accvgpr_read_b32 v183, a27
v_accvgpr_read_b32 v184, a28
v_accvgpr_read_b32 v185, a29
v_accvgpr_read_b32 v186, a30
v_accvgpr_read_b32 v187, a31
v_mul_f32 v180, v180, v188
v_mul_f32 v181, v181, v189
v_mul_f32 v182, v182, v190
v_mul_f32 v183, v183, v191
v_mul_f32 v184, v184, v188
v_mul_f32 v185, v185, v189
v_mul_f32 v186, v186, v190
v_mul_f32 v187, v187, v191
v_accvgpr_write_b32 a24, v180
v_accvgpr_write_b32 a25, v181
v_accvgpr_write_b32 a26, v182
v_accvgpr_write_b32 a27, v183
v_accvgpr_write_b32 a28, v184
v_accvgpr_write_b32 a29, v185
v_accvgpr_write_b32 a30, v186
v_accvgpr_write_b32 a31, v187
v_accvgpr_read_b32 v180, a32
v_accvgpr_read_b32 v181, a33
v_accvgpr_read_b32 v182, a34
v_accvgpr_read_b32 v183, a35
v_accvgpr_read_b32 v184, a36
v_accvgpr_read_b32 v185, a37
v_accvgpr_read_b32 v186, a38
v_accvgpr_read_b32 v187, a39
v_mul_f32 v180, v180, v188
v_mul_f32 v181, v181, v189
v_mul_f32 v182, v182, v190
v_mul_f32 v183, v183, v191
v_mul_f32 v184, v184, v188
v_mul_f32 v185, v185, v189
v_mul_f32 v186, v186, v190
v_mul_f32 v187, v187, v191
v_accvgpr_write_b32 a32, v180
v_accvgpr_write_b32 a33, v181
v_accvgpr_write_b32 a34, v182
v_accvgpr_write_b32 a35, v183
v_accvgpr_write_b32 a36, v184
v_accvgpr_write_b32 a37, v185
v_accvgpr_write_b32 a38, v186
v_accvgpr_write_b32 a39, v187
v_accvgpr_read_b32 v180, a40
v_accvgpr_read_b32 v181, a41
v_accvgpr_read_b32 v182, a42
v_accvgpr_read_b32 v183, a43
v_accvgpr_read_b32 v184, a44
v_accvgpr_read_b32 v185, a45
v_accvgpr_read_b32 v186, a46
v_accvgpr_read_b32 v187, a47
v_mul_f32 v180, v180, v188
v_mul_f32 v181, v181, v189
v_mul_f32 v182, v182, v190
v_mul_f32 v183, v183, v191
v_mul_f32 v184, v184, v188
v_mul_f32 v185, v185, v189
v_mul_f32 v186, v186, v190
v_mul_f32 v187, v187, v191
v_accvgpr_write_b32 a40, v180
v_accvgpr_write_b32 a41, v181
v_accvgpr_write_b32 a42, v182
v_accvgpr_write_b32 a43, v183
v_accvgpr_write_b32 a44, v184
v_accvgpr_write_b32 a45, v185
v_accvgpr_write_b32 a46, v186
v_accvgpr_write_b32 a47, v187
v_accvgpr_read_b32 v180, a48
v_accvgpr_read_b32 v181, a49
v_accvgpr_read_b32 v182, a50
v_accvgpr_read_b32 v183, a51
v_accvgpr_read_b32 v184, a52
v_accvgpr_read_b32 v185, a53
v_accvgpr_read_b32 v186, a54
v_accvgpr_read_b32 v187, a55
v_mul_f32 v180, v180, v188
v_mul_f32 v181, v181, v189
v_mul_f32 v182, v182, v190
v_mul_f32 v183, v183, v191
v_mul_f32 v184, v184, v188
v_mul_f32 v185, v185, v189
v_mul_f32 v186, v186, v190
v_mul_f32 v187, v187, v191
v_accvgpr_write_b32 a48, v180
v_accvgpr_write_b32 a49, v181
v_accvgpr_write_b32 a50, v182
v_accvgpr_write_b32 a51, v183
v_accvgpr_write_b32 a52, v184
v_accvgpr_write_b32 a53, v185
v_accvgpr_write_b32 a54, v186
v_accvgpr_write_b32 a55, v187
v_accvgpr_read_b32 v180, a56
v_accvgpr_read_b32 v181, a57
v_accvgpr_read_b32 v182, a58
v_accvgpr_read_b32 v183, a59
v_accvgpr_read_b32 v184, a60
v_accvgpr_read_b32 v185, a61
v_accvgpr_read_b32 v186, a62
v_accvgpr_read_b32 v187, a63
v_mul_f32 v180, v180, v188
v_mul_f32 v181, v181, v189
v_mul_f32 v182, v182, v190
v_mul_f32 v183, v183, v191
v_mul_f32 v184, v184, v188
v_mul_f32 v185, v185, v189
v_mul_f32 v186, v186, v190
v_mul_f32 v187, v187, v191
v_accvgpr_write_b32 a56, v180
v_accvgpr_write_b32 a57, v181
v_accvgpr_write_b32 a58, v182
v_accvgpr_write_b32 a59, v183
v_accvgpr_write_b32 a60, v184
v_accvgpr_write_b32 a61, v185
v_accvgpr_write_b32 a62, v186
v_accvgpr_write_b32 a63, v187
LT_nors:
s_waitcnt lgkmcnt(0)
s_nop 1
v_mfma_f32_16x16x32_bf16 a[0:3], v[168:171], v[96:99], a[0:3]
v_mfma_f32_16x16x32_bf16 a[4:7], v[168:171], v[100:103], a[4:7]
v_mfma_f32_16x16x32_bf16 a[8:11], v[168:171], v[104:107], a[8:11]
v_mfma_f32_16x16x32_bf16 a[12:15], v[168:171], v[108:111], a[12:15]
v_mfma_f32_16x16x32_bf16 a[16:19], v[168:171], v[112:115], a[16:19]
v_mfma_f32_16x16x32_bf16 a[20:23], v[168:171], v[116:119], a[20:23]
v_mfma_f32_16x16x32_bf16 a[24:27], v[168:171], v[120:123], a[24:27]
v_mfma_f32_16x16x32_bf16 a[28:31], v[168:171], v[124:127], a[28:31]
v_mfma_f32_16x16x32_bf16 a[32:35], v[168:171], v[128:131], a[32:35]
v_mfma_f32_16x16x32_bf16 a[36:39], v[168:171], v[132:135], a[36:39]
v_mfma_f32_16x16x32_bf16 a[40:43], v[168:171], v[136:139], a[40:43]
v_mfma_f32_16x16x32_bf16 a[44:47], v[168:171], v[140:143], a[44:47]
v_mfma_f32_16x16x32_bf16 a[48:51], v[168:171], v[144:147], a[48:51]
v_mfma_f32_16x16x32_bf16 a[52:55], v[168:171], v[148:151], a[52:55]
v_mfma_f32_16x16x32_bf16 a[56:59], v[168:171], v[152:155], a[56:59]
v_mfma_f32_16x16x32_bf16 a[60:63], v[168:171], v[156:159], a[60:63]
s_sub_u32 s51, s51, 1
s_cmp_lg_u32 s51, 0
s_cbranch_scc1 LT_loop
s_nop 15
s_add_u32 s16, s4, 0x0
s_addc_u32 s17, s5, 0
s_mov_b32 s18, 0x10000000
s_mov_b32 s19, 0x00020000
s_mul_i32 s52, s37, 0x5000
s_add_u32 s52, s52, 0x1200000
s_add_u32 s53, s37, 1610
s_lshl_b32 s53, s53, 7
s_add_u32 s53, s53, 0x7c00000
s_waitcnt vmcnt(0)
s_cmp_eq_u32 s36, 0
s_cbranch_scc1 LT_merge
buffer_store_dwordx4 a[0:3], v248, s[16:19], s52 offen offset:0 sc1
buffer_store_dwordx4 a[4:7], v248, s[16:19], s52 offen offset:1024 sc1
buffer_store_dwordx4 a[8:11], v248, s[16:19], s52 offen offset:2048 sc1
buffer_store_dwordx4 a[12:15], v248, s[16:19], s52 offen offset:3072 sc1
s_add_u32 s52, s52, 4096
buffer_store_dwordx4 a[16:19], v248, s[16:19], s52 offen offset:0 sc1
buffer_store_dwordx4 a[20:23], v248, s[16:19], s52 offen offset:1024 sc1
buffer_store_dwordx4 a[24:27], v248, s[16:19], s52 offen offset:2048 sc1
buffer_store_dwordx4 a[28:31], v248, s[16:19], s52 offen offset:3072 sc1
s_add_u32 s52, s52, 4096
buffer_store_dwordx4 a[32:35], v248, s[16:19], s52 offen offset:0 sc1
buffer_store_dwordx4 a[36:39], v248, s[16:19], s52 offen offset:1024 sc1
buffer_store_dwordx4 a[40:43], v248, s[16:19], s52 offen offset:2048 sc1
buffer_store_dwordx4 a[44:47], v248, s[16:19], s52 offen offset:3072 sc1
s_add_u32 s52, s52, 4096
buffer_store_dwordx4 a[48:51], v248, s[16:19], s52 offen offset:0 sc1
buffer_store_dwordx4 a[52:55], v248, s[16:19], s52 offen offset:1024 sc1
buffer_store_dwordx4 a[56:59], v248, s[16:19], s52 offen offset:2048 sc1
buffer_store_dwordx4 a[60:63], v248, s[16:19], s52 offen offset:3072 sc1
s_add_u32 s52, s52, 4096
buffer_store_dwordx2 v[172:173], v248, s[16:19], s52 offen sc1
s_waitcnt vmcnt(0)
v_mov_b32 v176, s98
v_mov_b32 v177, s99
s_mov_b64 exec, 1
buffer_store_dwordx2 v[176:177], off, s[16:19], s53 sc1
s_mov_b64 exec, -1
s_branch L2_fin
LT_merge:
s_mov_b32 s94, 0x10000
LT_mw:
buffer_load_dwordx2 v[0:1], off, s[16:19], s53 sc1
s_sub_u32 s94, s94, 1
s_waitcnt vmcnt(0)
s_cbranch_scc1 LT_mw_go
v_cmp_ne_u64 vcc, s[98:99], v[0:1]
s_nop 1
s_cbranch_vccnz LT_mw
LT_mw_go:
buffer_load_dwordx4 v[96:99], v248, s[16:19], s52 offen offset:0 sc1
buffer_load_dwordx4 v[100:103], v248, s[16:19], s52 offen offset:1024 sc1
buffer_load_dwordx4 v[104:107], v248, s[16:19], s52 offen offset:2048 sc1
buffer_load_dwordx4 v[108:111], v248, s[16:19], s52 offen offset:3072 sc1
s_add_u32 s52, s52, 4096
buffer_load_dwordx4 v[112:115], v248, s[16:19], s52 offen offset:0 sc1
buffer_load_dwordx4 v[116:119], v248, s[16:19], s52 offen offset:1024 sc1
buffer_load_dwordx4 v[120:123], v248, s[16:19], s52 offen offset:2048 sc1
buffer_load_dwordx4 v[124:127], v248, s[16:19], s52 offen offset:3072 sc1
s_add_u32 s52, s52, 4096
buffer_load_dwordx4 v[128:131], v248, s[16:19], s52 offen offset:0 sc1
buffer_load_dwordx4 v[132:135], v248, s[16:19], s52 offen offset:1024 sc1
buffer_load_dwordx4 v[136:139], v248, s[16:19], s52 offen offset:2048 sc1
buffer_load_dwordx4 v[140:143], v248, s[16:19], s52 offen offset:3072 sc1
s_add_u32 s52, s52, 4096
buffer_load_dwordx4 v[144:147], v248, s[16:19], s52 offen offset:0 sc1
buffer_load_dwordx4 v[148:151], v248, s[16:19], s52 offen offset:1024 sc1
buffer_load_dwordx4 v[152:155], v248, s[16:19], s52 offen offset:2048 sc1
buffer_load_dwordx4 v[156:159], v248, s[16:19], s52 offen offset:3072 sc1
s_add_u32 s52, s52, 4096
buffer_load_dwordx2 v[0:1], v248, s[16:19], s52 offen sc1
v_lshrrev_b32 v176, 4, v248
v_and_b32 v176, 0x30, v176
s_waitcnt vmcnt(0)
v_max_f32 v175, v172, v0
v_sub_f32 v2, v172, v175
v_sub_f32 v3, v0, v175
v_mov_b32 v172, v175
v_exp_f32 v2, v2
v_exp_f32 v3, v3
s_nop 0
v_mul_f32 v173, v173, v2
v_fmac_f32 v173, v1, v3
ds_bpermute_b32 v4, v176, v2 offset:0
ds_bpermute_b32 v8, v176, v3 offset:0
ds_bpermute_b32 v5, v176, v2 offset:4
ds_bpermute_b32 v9, v176, v3 offset:4
ds_bpermute_b32 v6, v176, v2 offset:8
ds_bpermute_b32 v10, v176, v3 offset:8
ds_bpermute_b32 v7, v176, v2 offset:12
ds_bpermute_b32 v11, v176, v3 offset:12
s_waitcnt lgkmcnt(0)
v_accvgpr_read_b32 v180, a0
v_accvgpr_read_b32 v181, a1
v_accvgpr_read_b32 v182, a2
v_accvgpr_read_b32 v183, a3
v_accvgpr_read_b32 v184, a4
v_accvgpr_read_b32 v185, a5
v_accvgpr_read_b32 v186, a6
v_accvgpr_read_b32 v187, a7
v_mul_f32 v180, v180, v4
v_mul_f32 v181, v181, v5
v_mul_f32 v182, v182, v6
v_mul_f32 v183, v183, v7
v_mul_f32 v184, v184, v4
v_mul_f32 v185, v185, v5
v_mul_f32 v186, v186, v6
v_mul_f32 v187, v187, v7
v_fmac_f32 v180, v96, v8
v_fmac_f32 v181, v97, v9
v_fmac_f32 v182, v98, v10
v_fmac_f32 v183, v99, v11
v_fmac_f32 v184, v100, v8
v_fmac_f32 v185, v101, v9
v_fmac_f32 v186, v102, v10
v_fmac_f32 v187, v103, v11
v_cvt_pk_bf16_f32 v32, v180, v181
v_cvt_pk_bf16_f32 v33, v182, v183
v_cvt_pk_bf16_f32 v34, v184, v185
v_cvt_pk_bf16_f32 v35, v186, v187
buffer_store_dwordx4 v[32:35], v248, s[20:23], s40 offen offset:0 sc1
v_accvgpr_read_b32 v180, a8
v_accvgpr_read_b32 v181, a9
v_accvgpr_read_b32 v182, a10
v_accvgpr_read_b32 v183, a11
v_accvgpr_read_b32 v184, a12
v_accvgpr_read_b32 v185, a13
v_accvgpr_read_b32 v186, a14
v_accvgpr_read_b32 v187, a15
v_mul_f32 v180, v180, v4
v_mul_f32 v181, v181, v5
v_mul_f32 v182, v182, v6
v_mul_f32 v183, v183, v7
v_mul_f32 v184, v184, v4
v_mul_f32 v185, v185, v5
v_mul_f32 v186, v186, v6
v_mul_f32 v187, v187, v7
v_fmac_f32 v180, v104, v8
v_fmac_f32 v181, v105, v9
v_fmac_f32 v182, v106, v10
v_fmac_f32 v183, v107, v11
v_fmac_f32 v184, v108, v8
v_fmac_f32 v185, v109, v9
v_fmac_f32 v186, v110, v10
v_fmac_f32 v187, v111, v11
v_cvt_pk_bf16_f32 v36, v180, v181
v_cvt_pk_bf16_f32 v37, v182, v183
v_cvt_pk_bf16_f32 v38, v184, v185
v_cvt_pk_bf16_f32 v39, v186, v187
buffer_store_dwordx4 v[36:39], v248, s[20:23], s40 offen offset:1024 sc1
v_accvgpr_read_b32 v180, a16
v_accvgpr_read_b32 v181, a17
v_accvgpr_read_b32 v182, a18
v_accvgpr_read_b32 v183, a19
v_accvgpr_read_b32 v184, a20
v_accvgpr_read_b32 v185, a21
v_accvgpr_read_b32 v186, a22
v_accvgpr_read_b32 v187, a23
v_mul_f32 v180, v180, v4
v_mul_f32 v181, v181, v5
v_mul_f32 v182, v182, v6
v_mul_f32 v183, v183, v7
v_mul_f32 v184, v184, v4
v_mul_f32 v185, v185, v5
v_mul_f32 v186, v186, v6
v_mul_f32 v187, v187, v7
v_fmac_f32 v180, v112, v8
v_fmac_f32 v181, v113, v9
v_fmac_f32 v182, v114, v10
v_fmac_f32 v183, v115, v11
v_fmac_f32 v184, v116, v8
v_fmac_f32 v185, v117, v9
v_fmac_f32 v186, v118, v10
v_fmac_f32 v187, v119, v11
v_cvt_pk_bf16_f32 v40, v180, v181
v_cvt_pk_bf16_f32 v41, v182, v183
v_cvt_pk_bf16_f32 v42, v184, v185
v_cvt_pk_bf16_f32 v43, v186, v187
buffer_store_dwordx4 v[40:43], v248, s[20:23], s40 offen offset:2048 sc1
v_accvgpr_read_b32 v180, a24
v_accvgpr_read_b32 v181, a25
v_accvgpr_read_b32 v182, a26
v_accvgpr_read_b32 v183, a27
v_accvgpr_read_b32 v184, a28
v_accvgpr_read_b32 v185, a29
v_accvgpr_read_b32 v186, a30
v_accvgpr_read_b32 v187, a31
v_mul_f32 v180, v180, v4
v_mul_f32 v181, v181, v5
v_mul_f32 v182, v182, v6
v_mul_f32 v183, v183, v7
v_mul_f32 v184, v184, v4
v_mul_f32 v185, v185, v5
v_mul_f32 v186, v186, v6
v_mul_f32 v187, v187, v7
v_fmac_f32 v180, v120, v8
v_fmac_f32 v181, v121, v9
v_fmac_f32 v182, v122, v10
v_fmac_f32 v183, v123, v11
v_fmac_f32 v184, v124, v8
v_fmac_f32 v185, v125, v9
v_fmac_f32 v186, v126, v10
v_fmac_f32 v187, v127, v11
v_cvt_pk_bf16_f32 v44, v180, v181
v_cvt_pk_bf16_f32 v45, v182, v183
v_cvt_pk_bf16_f32 v46, v184, v185
v_cvt_pk_bf16_f32 v47, v186, v187
buffer_store_dwordx4 v[44:47], v248, s[20:23], s40 offen offset:3072 sc1
v_accvgpr_read_b32 v180, a32
v_accvgpr_read_b32 v181, a33
v_accvgpr_read_b32 v182, a34
v_accvgpr_read_b32 v183, a35
v_accvgpr_read_b32 v184, a36
v_accvgpr_read_b32 v185, a37
v_accvgpr_read_b32 v186, a38
v_accvgpr_read_b32 v187, a39
v_mul_f32 v180, v180, v4
v_mul_f32 v181, v181, v5
v_mul_f32 v182, v182, v6
v_mul_f32 v183, v183, v7
v_mul_f32 v184, v184, v4
v_mul_f32 v185, v185, v5
v_mul_f32 v186, v186, v6
v_mul_f32 v187, v187, v7
v_fmac_f32 v180, v128, v8
v_fmac_f32 v181, v129, v9
v_fmac_f32 v182, v130, v10
v_fmac_f32 v183, v131, v11
v_fmac_f32 v184, v132, v8
v_fmac_f32 v185, v133, v9
v_fmac_f32 v186, v134, v10
v_fmac_f32 v187, v135, v11
v_cvt_pk_bf16_f32 v48, v180, v181
v_cvt_pk_bf16_f32 v49, v182, v183
v_cvt_pk_bf16_f32 v50, v184, v185
v_cvt_pk_bf16_f32 v51, v186, v187
buffer_store_dwordx4 v[48:51], v248, s[20:23], s44 offen offset:0 sc1
v_accvgpr_read_b32 v180, a40
v_accvgpr_read_b32 v181, a41
v_accvgpr_read_b32 v182, a42
v_accvgpr_read_b32 v183, a43
v_accvgpr_read_b32 v184, a44
v_accvgpr_read_b32 v185, a45
v_accvgpr_read_b32 v186, a46
v_accvgpr_read_b32 v187, a47
v_mul_f32 v180, v180, v4
v_mul_f32 v181, v181, v5
v_mul_f32 v182, v182, v6
v_mul_f32 v183, v183, v7
v_mul_f32 v184, v184, v4
v_mul_f32 v185, v185, v5
v_mul_f32 v186, v186, v6
v_mul_f32 v187, v187, v7
v_fmac_f32 v180, v136, v8
v_fmac_f32 v181, v137, v9
v_fmac_f32 v182, v138, v10
v_fmac_f32 v183, v139, v11
v_fmac_f32 v184, v140, v8
v_fmac_f32 v185, v141, v9
v_fmac_f32 v186, v142, v10
v_fmac_f32 v187, v143, v11
v_cvt_pk_bf16_f32 v52, v180, v181
v_cvt_pk_bf16_f32 v53, v182, v183
v_cvt_pk_bf16_f32 v54, v184, v185
v_cvt_pk_bf16_f32 v55, v186, v187
buffer_store_dwordx4 v[52:55], v248, s[20:23], s44 offen offset:1024 sc1
v_accvgpr_read_b32 v180, a48
v_accvgpr_read_b32 v181, a49
v_accvgpr_read_b32 v182, a50
v_accvgpr_read_b32 v183, a51
v_accvgpr_read_b32 v184, a52
v_accvgpr_read_b32 v185, a53
v_accvgpr_read_b32 v186, a54
v_accvgpr_read_b32 v187, a55
v_mul_f32 v180, v180, v4
v_mul_f32 v181, v181, v5
v_mul_f32 v182, v182, v6
v_mul_f32 v183, v183, v7
v_mul_f32 v184, v184, v4
v_mul_f32 v185, v185, v5
v_mul_f32 v186, v186, v6
v_mul_f32 v187, v187, v7
v_fmac_f32 v180, v144, v8
v_fmac_f32 v181, v145, v9
v_fmac_f32 v182, v146, v10
v_fmac_f32 v183, v147, v11
v_fmac_f32 v184, v148, v8
v_fmac_f32 v185, v149, v9
v_fmac_f32 v186, v150, v10
v_fmac_f32 v187, v151, v11
v_cvt_pk_bf16_f32 v56, v180, v181
v_cvt_pk_bf16_f32 v57, v182, v183
v_cvt_pk_bf16_f32 v58, v184, v185
v_cvt_pk_bf16_f32 v59, v186, v187
buffer_store_dwordx4 v[56:59], v248, s[20:23], s44 offen offset:2048 sc1
v_accvgpr_read_b32 v180, a56
v_accvgpr_read_b32 v181, a57
v_accvgpr_read_b32 v182, a58
v_accvgpr_read_b32 v183, a59
v_accvgpr_read_b32 v184, a60
v_accvgpr_read_b32 v185, a61
v_accvgpr_read_b32 v186, a62
v_accvgpr_read_b32 v187, a63
v_mul_f32 v180, v180, v4
v_mul_f32 v181, v181, v5
v_mul_f32 v182, v182, v6
v_mul_f32 v183, v183, v7
v_mul_f32 v184, v184, v4
v_mul_f32 v185, v185, v5
v_mul_f32 v186, v186, v6
v_mul_f32 v187, v187, v7
v_fmac_f32 v180, v152, v8
v_fmac_f32 v181, v153, v9
v_fmac_f32 v182, v154, v10
v_fmac_f32 v183, v155, v11
v_fmac_f32 v184, v156, v8
v_fmac_f32 v185, v157, v9
v_fmac_f32 v186, v158, v10
v_fmac_f32 v187, v159, v11
v_cvt_pk_bf16_f32 v60, v180, v181
v_cvt_pk_bf16_f32 v61, v182, v183
v_cvt_pk_bf16_f32 v62, v184, v185
v_cvt_pk_bf16_f32 v63, v186, v187
buffer_store_dwordx4 v[60:63], v248, s[20:23], s44 offen offset:3072 sc1
v_mov_b32 v176, v173
s_nop 1
v_permlane32_swap_b32 v173, v176
s_nop 1
v_add_f32 v173, v173, v176
v_mov_b32 v176, v173
s_nop 1
v_permlane16_swap_b32 v173, v176
s_nop 1
v_add_f32 v173, v173, v176
v_lshlrev_b32 v175, 2, v248
s_mov_b64 exec, 0xffff
s_mov_b64 exec, -1
v_bfe_u32 v175, v248, 8, 1
v_mul_u32_u24 v175, 48, v175
v_lshl_add_u32 v175, s37, 3, v175
v_and_b32 v176, 0xf0, v248
v_lshl_add_u32 v175, v176, 3, v175
s_mov_b32 exec_hi, 0
buffer_store_dwordx2 v[172:173], v175, s[24:27], s48 offen sc1
s_add_u32 s16, s4, 0x7c00000
s_addc_u32 s17, s5, 0
s_mov_b32 s18, 0x40000
s_mov_b32 s19, 0x00020000
s_add_u32 s48, s37, 1248
s_mul_i32 s48, s48, 128
s_waitcnt vmcnt(0)
v_mov_b32 v176, s98
v_mov_b32 v177, s99
s_mov_b64 exec, 1
buffer_store_dwordx2 v[176:177], off, s[16:19], s48 sc1
buffer_store_dwordx2 v[176:177], off, s[16:19], s48 offset:8 sc1
s_mov_b64 exec, -1
s_branch L2_fin
LE_start:
s_cmp_ge_u32 s37, 32
s_cbranch_scc1 L2_end
v_lshrrev_b32 v1, 6, v0
s_sub_u32 s37, s37, 30
s_lshl_b32 s35, s35, 1
v_readfirstlane_b32 s41, v1
s_add_u32 s35, s35, s37
s_mul_i32 s35, s35, 3
s_add_u32 s40, s35, s41
s_cmp_ge_u32 s41, 3
s_cbranch_scc1 L2_end
LE_common:
v_and_b32 v1, 63, v0
s_sub_u32 s36, s40, 0
s_mov_b32 s54, 151
s_mul_i32 s36, s36, 151
s_mov_b32 s55, s36
s_sub_u32 s36, s40, 36
s_cselect_b32 s54, s54, 166
s_mul_i32 s36, s36, 166
s_add_u32 s36, s36, 5436
s_cmp_lt_u32 s40, 36
s_cselect_b32 s55, s55, s36
s_sub_u32 s36, s40, 42
s_cselect_b32 s54, s54, 152
s_mul_i32 s36, s36, 152
s_add_u32 s36, s36, 6432
s_cmp_lt_u32 s40, 42
s_cselect_b32 s55, s55, s36
s_sub_u32 s36, s40, 48
s_cselect_b32 s54, s54, 168
s_mul_i32 s36, s36, 168
s_add_u32 s36, s36, 7344
s_cmp_lt_u32 s40, 48
s_cselect_b32 s55, s55, s36
s_mov_b32 s42, 0
s_mov_b32 s49, 512
v_lshrrev_b32 v33, 2, v1
v_and_b32 v34, 3, v1
v_mul_u32_u24 v6, 0xa000, v33
v_lshl_add_u32 v6, v34, 4, v6
v_lshlrev_b32 v33, 2, v33
s_mul_i32 s50, s40, 655360
s_mul_i32 s48, s40, 64
s_waitcnt lgkmcnt(0)
s_add_u32 s8, s4, 0x7c31800
s_addc_u32 s9, s5, 0
s_mov_b32 s10, 0x800
s_mov_b32 s11, 0x00020000
v_and_b32 v194, 15, v0
v_lshlrev_b32 v194, 7, v194
s_mov_b32 s94, 0x10000
LE_poll0:
buffer_load_dwordx2 v[192:193], v194, s[8:11], 0 offen sc1
s_sub_u32 s94, s94, 1
s_waitcnt vmcnt(0)
s_cbranch_scc1 LE_poll0_go
v_cmp_ne_u64 vcc, s[98:99], v[192:193]
s_nop 1
s_cbranch_vccnz LE_poll0
LE_poll0_go:
s_add_u32 s8, s4, 0x7800000
s_addc_u32 s9, s5, 0
s_mov_b32 s10, 0x1000
s_mov_b32 s11, 0x00020000
s_add_u32 s12, s4, 0x8000000
s_addc_u32 s13, s5, 0
s_mov_b32 s14, 0x2800000
s_mov_b32 s15, 0x00020000
buffer_load_dword v4, v33, s[8:11], s48 offen sc1
buffer_load_dwordx4 v[192:195], v6, s[12:15], s50 offen offset:0 sc1
buffer_load_dwordx4 v[196:199], v6, s[12:15], s50 offen offset:64 sc1
buffer_load_dwordx4 v[200:203], v6, s[12:15], s50 offen offset:128 sc1
buffer_load_dwordx4 v[204:207], v6, s[12:15], s50 offen offset:192 sc1
buffer_load_dwordx4 v[208:211], v6, s[12:15], s50 offen offset:256 sc1
buffer_load_dwordx4 v[212:215], v6, s[12:15], s50 offen offset:320 sc1
buffer_load_dwordx4 v[216:219], v6, s[12:15], s50 offen offset:384 sc1
buffer_load_dwordx4 v[220:223], v6, s[12:15], s50 offen offset:448 sc1
buffer_load_dwordx4 v[224:227], v6, s[12:15], s50 offen offset:512 sc1
buffer_load_dwordx4 v[228:231], v6, s[12:15], s50 offen offset:576 sc1
buffer_load_dwordx4 v[232:235], v6, s[12:15], s50 offen offset:640 sc1
buffer_load_dwordx4 v[236:239], v6, s[12:15], s50 offen offset:704 sc1
buffer_load_dwordx4 v[240:243], v6, s[12:15], s50 offen offset:768 sc1
buffer_load_dwordx4 v[244:247], v6, s[12:15], s50 offen offset:832 sc1
buffer_load_dwordx4 v[248:251], v6, s[12:15], s50 offen offset:896 sc1
buffer_load_dwordx4 v[252:255], v6, s[12:15], s50 offen offset:960 sc1
s_add_u32 s16, s4, 0x6800000
s_addc_u32 s17, s5, 0
s_mov_b32 s18, 0x4e2000
s_mov_b32 s19, 0x00020000
s_add_u32 s20, s4, 0x7000000
s_addc_u32 s21, s5, 0
s_mov_b32 s22, 0x4e2000
s_mov_b32 s23, 0x00020000
v_lshlrev_b32 v5, 2, v34
v_and_b32 v2, 15, v1
v_lshrrev_b32 v3, 4, v1
v_mov_b32 v16, 1
v_mov_b32 v17, 4
v_and_b32 v33, 1, v2
v_lshlrev_b32 v33, 4, v33
v_lshlrev_b32 v33, v33, v16
v_mul_u32_u24 v33, 0x3f80, v33
v_lshrrev_b32 v34, 1, v2
v_cmp_eq_u32 vcc, 0, v34
s_nop 1
v_cndmask_b32 v40, 0, v33, vcc
v_cmp_eq_u32 vcc, 1, v34
s_nop 1
v_cndmask_b32 v41, 0, v33, vcc
v_cmp_eq_u32 vcc, 2, v34
s_nop 1
v_cndmask_b32 v42, 0, v33, vcc
v_cmp_eq_u32 vcc, 3, v34
s_nop 1
v_cndmask_b32 v43, 0, v33, vcc
v_cmp_eq_u32 vcc, 4, v34
s_nop 1
v_cndmask_b32 v44, 0, v33, vcc
v_cmp_eq_u32 vcc, 5, v34
s_nop 1
v_cndmask_b32 v45, 0, v33, vcc
v_cmp_eq_u32 vcc, 6, v34
s_nop 1
v_cndmask_b32 v46, 0, v33, vcc
v_cmp_eq_u32 vcc, 7, v34
s_nop 1
v_cndmask_b32 v47, 0, v33, vcc
v_lshlrev_b32 v39, 5, v2
v_lshl_add_u32 v39, v3, 3, v39
v_lshlrev_b32 v2, 4, v2
s_mul_i32 s48, s41, 21504
s_add_u32 s48, s48, 4096
v_mov_b32 v36, s48
v_lshl_add_u32 v38, v3, 2, v36
s_lshl_b32 s36, s41, 10
s_lshl_b32 s35, s55, 2
s_sub_u32 s35, s36, s35
v_mov_b32 v7, s35
v_lshlrev_b32 v35, 4, v1
v_add_u32 v68, s48, v35
v_add_u32 v35, s36, v35
v_lshlrev_b32 v33, 2, v1
v_mov_b32 v72, 0xffff
v_mov_b32 v73, 0xffff
v_mov_b32 v74, 0xffff
v_mov_b32 v75, 0xffff
v_cmp_gt_u32 vcc, s54, v33
v_mov_b32 v48, 0
s_nop 0
v_cndmask_b32 v18, 0, v16, vcc
v_add_u32 v33, 1, v33
v_cmp_gt_u32 vcc, s54, v33
v_mov_b32 v49, 0
s_nop 0
v_cndmask_b32 v19, 0, v16, vcc
v_add_u32 v33, 1, v33
v_cmp_gt_u32 vcc, s54, v33
v_mov_b32 v50, 0
s_nop 0
v_cndmask_b32 v20, 0, v16, vcc
v_add_u32 v33, 1, v33
v_cmp_gt_u32 vcc, s54, v33
v_mov_b32 v51, 0
s_nop 0
v_cndmask_b32 v21, 0, v16, vcc
LE_pass:
ds_write_b128 v35, v[48:51]
ds_write_b128 v68, v[72:75] offset:0
ds_write_b128 v68, v[72:75] offset:1024
ds_write_b128 v68, v[72:75] offset:2048
ds_write_b128 v68, v[72:75] offset:3072
ds_write_b128 v68, v[72:75] offset:4096
ds_write_b128 v68, v[72:75] offset:5120
ds_write_b128 v68, v[72:75] offset:6144
ds_write_b128 v68, v[72:75] offset:7168
ds_write_b128 v68, v[72:75] offset:8192
ds_write_b128 v68, v[72:75] offset:9216
ds_write_b128 v68, v[72:75] offset:10240
ds_write_b128 v68, v[72:75] offset:11264
ds_write_b128 v68, v[72:75] offset:12288
ds_write_b128 v68, v[72:75] offset:13312
ds_write_b128 v68, v[72:75] offset:14336
ds_write_b128 v68, v[72:75] offset:15360
ds_write_b128 v68, v[72:75] offset:16384
ds_write_b128 v68, v[72:75] offset:17408
ds_write_b128 v68, v[72:75] offset:18432
ds_write_b128 v68, v[72:75] offset:19456
v_lshl_add_u32 v32, v1, 2, v36
ds_write_b32 v32, v48 offset:20480
s_waitcnt vmcnt(16)
v_sub_u32 v32, v4, v5
s_waitcnt vmcnt(15)
v_cmpx_lt_i32 vcc, 0, v32
s_cbranch_execz LE_c
v_mad_u32_u16 v128, v192, 1, v7 op_sel:[1,0,0,0]
ds_add_u32 v128, v16
v_cmpx_lt_i32 vcc, 1, v32
v_mad_u32_u16 v129, v193, 1, v7 op_sel:[1,0,0,0]
ds_add_u32 v129, v16
v_cmpx_lt_i32 vcc, 2, v32
v_mad_u32_u16 v130, v194, 1, v7 op_sel:[1,0,0,0]
ds_add_u32 v130, v16
v_cmpx_lt_i32 vcc, 3, v32
v_mad_u32_u16 v131, v195, 1, v7 op_sel:[1,0,0,0]
ds_add_u32 v131, v16
s_waitcnt vmcnt(14)
v_cmpx_lt_i32 vcc, 16, v32
s_cbranch_execz LE_c
v_mad_u32_u16 v132, v196, 1, v7 op_sel:[1,0,0,0]
ds_add_u32 v132, v16
v_cmpx_lt_i32 vcc, 17, v32
v_mad_u32_u16 v133, v197, 1, v7 op_sel:[1,0,0,0]
ds_add_u32 v133, v16
v_cmpx_lt_i32 vcc, 18, v32
v_mad_u32_u16 v134, v198, 1, v7 op_sel:[1,0,0,0]
ds_add_u32 v134, v16
v_cmpx_lt_i32 vcc, 19, v32
v_mad_u32_u16 v135, v199, 1, v7 op_sel:[1,0,0,0]
ds_add_u32 v135, v16
s_waitcnt vmcnt(13)
v_cmpx_lt_i32 vcc, 32, v32
s_cbranch_execz LE_c
v_mad_u32_u16 v136, v200, 1, v7 op_sel:[1,0,0,0]
ds_add_u32 v136, v16
v_cmpx_lt_i32 vcc, 33, v32
v_mad_u32_u16 v137, v201, 1, v7 op_sel:[1,0,0,0]
ds_add_u32 v137, v16
v_cmpx_lt_i32 vcc, 34, v32
v_mad_u32_u16 v138, v202, 1, v7 op_sel:[1,0,0,0]
ds_add_u32 v138, v16
v_cmpx_lt_i32 vcc, 35, v32
v_mad_u32_u16 v139, v203, 1, v7 op_sel:[1,0,0,0]
ds_add_u32 v139, v16
s_waitcnt vmcnt(12)
v_cmpx_lt_i32 vcc, 48, v32
s_cbranch_execz LE_c
v_mad_u32_u16 v140, v204, 1, v7 op_sel:[1,0,0,0]
ds_add_u32 v140, v16
v_cmpx_lt_i32 vcc, 49, v32
v_mad_u32_u16 v141, v205, 1, v7 op_sel:[1,0,0,0]
ds_add_u32 v141, v16
v_cmpx_lt_i32 vcc, 50, v32
v_mad_u32_u16 v142, v206, 1, v7 op_sel:[1,0,0,0]
ds_add_u32 v142, v16
v_cmpx_lt_i32 vcc, 51, v32
v_mad_u32_u16 v143, v207, 1, v7 op_sel:[1,0,0,0]
ds_add_u32 v143, v16
s_waitcnt vmcnt(11)
v_cmpx_lt_i32 vcc, 64, v32
s_cbranch_execz LE_c
v_mad_u32_u16 v144, v208, 1, v7 op_sel:[1,0,0,0]
ds_add_u32 v144, v16
v_cmpx_lt_i32 vcc, 65, v32
v_mad_u32_u16 v145, v209, 1, v7 op_sel:[1,0,0,0]
ds_add_u32 v145, v16
v_cmpx_lt_i32 vcc, 66, v32
v_mad_u32_u16 v146, v210, 1, v7 op_sel:[1,0,0,0]
ds_add_u32 v146, v16
v_cmpx_lt_i32 vcc, 67, v32
v_mad_u32_u16 v147, v211, 1, v7 op_sel:[1,0,0,0]
ds_add_u32 v147, v16
s_waitcnt vmcnt(10)
v_cmpx_lt_i32 vcc, 80, v32
s_cbranch_execz LE_c
v_mad_u32_u16 v148, v212, 1, v7 op_sel:[1,0,0,0]
ds_add_u32 v148, v16
v_cmpx_lt_i32 vcc, 81, v32
v_mad_u32_u16 v149, v213, 1, v7 op_sel:[1,0,0,0]
ds_add_u32 v149, v16
v_cmpx_lt_i32 vcc, 82, v32
v_mad_u32_u16 v150, v214, 1, v7 op_sel:[1,0,0,0]
ds_add_u32 v150, v16
v_cmpx_lt_i32 vcc, 83, v32
v_mad_u32_u16 v151, v215, 1, v7 op_sel:[1,0,0,0]
ds_add_u32 v151, v16
s_waitcnt vmcnt(9)
v_cmpx_lt_i32 vcc, 96, v32
s_cbranch_execz LE_c
v_mad_u32_u16 v152, v216, 1, v7 op_sel:[1,0,0,0]
ds_add_u32 v152, v16
v_cmpx_lt_i32 vcc, 97, v32
v_mad_u32_u16 v153, v217, 1, v7 op_sel:[1,0,0,0]
ds_add_u32 v153, v16
v_cmpx_lt_i32 vcc, 98, v32
v_mad_u32_u16 v154, v218, 1, v7 op_sel:[1,0,0,0]
ds_add_u32 v154, v16
v_cmpx_lt_i32 vcc, 99, v32
v_mad_u32_u16 v155, v219, 1, v7 op_sel:[1,0,0,0]
ds_add_u32 v155, v16
s_waitcnt vmcnt(8)
v_cmpx_lt_i32 vcc, 112, v32
s_cbranch_execz LE_c
v_mad_u32_u16 v156, v220, 1, v7 op_sel:[1,0,0,0]
ds_add_u32 v156, v16
v_cmpx_lt_i32 vcc, 113, v32
v_mad_u32_u16 v157, v221, 1, v7 op_sel:[1,0,0,0]
ds_add_u32 v157, v16
v_cmpx_lt_i32 vcc, 114, v32
v_mad_u32_u16 v158, v222, 1, v7 op_sel:[1,0,0,0]
ds_add_u32 v158, v16
v_cmpx_lt_i32 vcc, 115, v32
v_mad_u32_u16 v159, v223, 1, v7 op_sel:[1,0,0,0]
ds_add_u32 v159, v16
s_waitcnt vmcnt(7)
v_cmpx_lt_i32 vcc, 128, v32
s_cbranch_execz LE_c
v_mad_u32_u16 v160, v224, 1, v7 op_sel:[1,0,0,0]
ds_add_u32 v160, v16
v_cmpx_lt_i32 vcc, 129, v32
v_mad_u32_u16 v161, v225, 1, v7 op_sel:[1,0,0,0]
ds_add_u32 v161, v16
v_cmpx_lt_i32 vcc, 130, v32
v_mad_u32_u16 v162, v226, 1, v7 op_sel:[1,0,0,0]
ds_add_u32 v162, v16
v_cmpx_lt_i32 vcc, 131, v32
v_mad_u32_u16 v163, v227, 1, v7 op_sel:[1,0,0,0]
ds_add_u32 v163, v16
s_waitcnt vmcnt(6)
v_cmpx_lt_i32 vcc, 144, v32
s_cbranch_execz LE_c
v_mad_u32_u16 v164, v228, 1, v7 op_sel:[1,0,0,0]
ds_add_u32 v164, v16
v_cmpx_lt_i32 vcc, 145, v32
v_mad_u32_u16 v165, v229, 1, v7 op_sel:[1,0,0,0]
ds_add_u32 v165, v16
v_cmpx_lt_i32 vcc, 146, v32
v_mad_u32_u16 v166, v230, 1, v7 op_sel:[1,0,0,0]
ds_add_u32 v166, v16
v_cmpx_lt_i32 vcc, 147, v32
v_mad_u32_u16 v167, v231, 1, v7 op_sel:[1,0,0,0]
ds_add_u32 v167, v16
s_waitcnt vmcnt(5)
v_cmpx_lt_i32 vcc, 160, v32
s_cbranch_execz LE_c
v_mad_u32_u16 v168, v232, 1, v7 op_sel:[1,0,0,0]
ds_add_u32 v168, v16
v_cmpx_lt_i32 vcc, 161, v32
v_mad_u32_u16 v169, v233, 1, v7 op_sel:[1,0,0,0]
ds_add_u32 v169, v16
v_cmpx_lt_i32 vcc, 162, v32
v_mad_u32_u16 v170, v234, 1, v7 op_sel:[1,0,0,0]
ds_add_u32 v170, v16
v_cmpx_lt_i32 vcc, 163, v32
v_mad_u32_u16 v171, v235, 1, v7 op_sel:[1,0,0,0]
ds_add_u32 v171, v16
s_waitcnt vmcnt(4)
v_cmpx_lt_i32 vcc, 176, v32
s_cbranch_execz LE_c
v_mad_u32_u16 v172, v236, 1, v7 op_sel:[1,0,0,0]
ds_add_u32 v172, v16
v_cmpx_lt_i32 vcc, 177, v32
v_mad_u32_u16 v173, v237, 1, v7 op_sel:[1,0,0,0]
ds_add_u32 v173, v16
v_cmpx_lt_i32 vcc, 178, v32
v_mad_u32_u16 v174, v238, 1, v7 op_sel:[1,0,0,0]
ds_add_u32 v174, v16
v_cmpx_lt_i32 vcc, 179, v32
v_mad_u32_u16 v175, v239, 1, v7 op_sel:[1,0,0,0]
ds_add_u32 v175, v16
s_waitcnt vmcnt(3)
v_cmpx_lt_i32 vcc, 192, v32
s_cbranch_execz LE_c
v_mad_u32_u16 v176, v240, 1, v7 op_sel:[1,0,0,0]
ds_add_u32 v176, v16
v_cmpx_lt_i32 vcc, 193, v32
v_mad_u32_u16 v177, v241, 1, v7 op_sel:[1,0,0,0]
ds_add_u32 v177, v16
v_cmpx_lt_i32 vcc, 194, v32
v_mad_u32_u16 v178, v242, 1, v7 op_sel:[1,0,0,0]
ds_add_u32 v178, v16
v_cmpx_lt_i32 vcc, 195, v32
v_mad_u32_u16 v179, v243, 1, v7 op_sel:[1,0,0,0]
ds_add_u32 v179, v16
s_waitcnt vmcnt(2)
v_cmpx_lt_i32 vcc, 208, v32
s_cbranch_execz LE_c
v_mad_u32_u16 v180, v244, 1, v7 op_sel:[1,0,0,0]
ds_add_u32 v180, v16
v_cmpx_lt_i32 vcc, 209, v32
v_mad_u32_u16 v181, v245, 1, v7 op_sel:[1,0,0,0]
ds_add_u32 v181, v16
v_cmpx_lt_i32 vcc, 210, v32
v_mad_u32_u16 v182, v246, 1, v7 op_sel:[1,0,0,0]
ds_add_u32 v182, v16
v_cmpx_lt_i32 vcc, 211, v32
v_mad_u32_u16 v183, v247, 1, v7 op_sel:[1,0,0,0]
ds_add_u32 v183, v16
s_waitcnt vmcnt(1)
v_cmpx_lt_i32 vcc, 224, v32
s_cbranch_execz LE_c
v_mad_u32_u16 v184, v248, 1, v7 op_sel:[1,0,0,0]
ds_add_u32 v184, v16
v_cmpx_lt_i32 vcc, 225, v32
v_mad_u32_u16 v185, v249, 1, v7 op_sel:[1,0,0,0]
ds_add_u32 v185, v16
v_cmpx_lt_i32 vcc, 226, v32
v_mad_u32_u16 v186, v250, 1, v7 op_sel:[1,0,0,0]
ds_add_u32 v186, v16
v_cmpx_lt_i32 vcc, 227, v32
v_mad_u32_u16 v187, v251, 1, v7 op_sel:[1,0,0,0]
ds_add_u32 v187, v16
s_waitcnt vmcnt(0)
v_cmpx_lt_i32 vcc, 240, v32
s_cbranch_execz LE_c
v_mad_u32_u16 v188, v252, 1, v7 op_sel:[1,0,0,0]
ds_add_u32 v188, v16
v_cmpx_lt_i32 vcc, 241, v32
v_mad_u32_u16 v189, v253, 1, v7 op_sel:[1,0,0,0]
ds_add_u32 v189, v16
v_cmpx_lt_i32 vcc, 242, v32
v_mad_u32_u16 v190, v254, 1, v7 op_sel:[1,0,0,0]
ds_add_u32 v190, v16
v_cmpx_lt_i32 vcc, 243, v32
v_mad_u32_u16 v191, v255, 1, v7 op_sel:[1,0,0,0]
ds_add_u32 v191, v16
LE_c:
s_mov_b64 exec, -1
ds_read_b128 v[24:27], v35
s_waitcnt lgkmcnt(0)
v_add_u32 v24, 3, v24
v_lshrrev_b32 v24, 2, v24
v_max_u32 v24, v24, v18
v_add_u32 v25, 3, v25
v_lshrrev_b32 v25, 2, v25
v_max_u32 v25, v25, v19
v_add_u32 v26, 3, v26
v_lshrrev_b32 v26, 2, v26
v_max_u32 v26, v26, v20
v_add_u32 v27, 3, v27
v_lshrrev_b32 v27, 2, v27
v_max_u32 v27, v27, v21
v_add_u32 v33, v24, v25
v_add3_u32 v33, v33, v26, v27
v_mov_b32 v64, v33
s_nop 1
v_add_u32_dpp v64, v64, v64 row_shr:1 row_mask:0xf bank_mask:0xf
s_nop 1
v_add_u32_dpp v64, v64, v64 row_shr:2 row_mask:0xf bank_mask:0xf
s_nop 1
v_add_u32_dpp v64, v64, v64 row_shr:4 row_mask:0xf bank_mask:0xf
s_nop 1
v_add_u32_dpp v64, v64, v64 row_shr:8 row_mask:0xf bank_mask:0xf
s_nop 1
v_add_u32_dpp v64, v64, v64 row_bcast:15 row_mask:0xa bank_mask:0xf
s_nop 1
v_add_u32_dpp v64, v64, v64 row_bcast:31 row_mask:0xc bank_mask:0xf
s_nop 1
v_readlane_b32 s44, v64, 63
v_sub_u32 v28, v64, v33
v_add_u32 v29, v28, v24
v_add_u32 v30, v29, v25
v_add_u32 v31, v30, v26
v_add3_u32 v33, v28, v24, -1
v_lshlrev_b32 v34, v33, v18
v_lshrrev_b32 v33, 5, v33
v_lshl_add_u32 v33, v33, 2, v36
ds_or_b32 v33, v34 offset:20480
v_lshl_add_u32 v28, v28, 4, v36
v_add3_u32 v33, v29, v25, -1
v_lshlrev_b32 v34, v33, v19
v_lshrrev_b32 v33, 5, v33
v_lshl_add_u32 v33, v33, 2, v36
ds_or_b32 v33, v34 offset:20480
v_lshl_add_u32 v29, v29, 4, v36
v_add3_u32 v33, v30, v26, -1
v_lshlrev_b32 v34, v33, v20
v_lshrrev_b32 v33, 5, v33
v_lshl_add_u32 v33, v33, 2, v36
ds_or_b32 v33, v34 offset:20480
v_lshl_add_u32 v30, v30, 4, v36
v_add3_u32 v33, v31, v27, -1
v_lshlrev_b32 v34, v33, v21
v_lshrrev_b32 v33, 5, v33
v_lshl_add_u32 v33, v33, 2, v36
ds_or_b32 v33, v34 offset:20480
v_lshl_add_u32 v31, v31, 4, v36
ds_write_b128 v35, v[28:31]
s_add_u32 s44, s44, 31
s_lshr_b32 s44, s44, 5
v_cmpx_lt_i32 vcc, 0, v32
s_cbranch_execz LE_p
ds_add_rtn_u32 v128, v128, v17
v_cmpx_lt_i32 vcc, 1, v32
ds_add_rtn_u32 v129, v129, v17
v_cmpx_lt_i32 vcc, 2, v32
ds_add_rtn_u32 v130, v130, v17
v_cmpx_lt_i32 vcc, 3, v32
ds_add_rtn_u32 v131, v131, v17
v_cmpx_lt_i32 vcc, 16, v32
s_cbranch_execz LE_p
ds_add_rtn_u32 v132, v132, v17
v_cmpx_lt_i32 vcc, 17, v32
ds_add_rtn_u32 v133, v133, v17
v_cmpx_lt_i32 vcc, 18, v32
ds_add_rtn_u32 v134, v134, v17
v_cmpx_lt_i32 vcc, 19, v32
ds_add_rtn_u32 v135, v135, v17
v_cmpx_lt_i32 vcc, 32, v32
s_cbranch_execz LE_p
ds_add_rtn_u32 v136, v136, v17
v_cmpx_lt_i32 vcc, 33, v32
ds_add_rtn_u32 v137, v137, v17
v_cmpx_lt_i32 vcc, 34, v32
ds_add_rtn_u32 v138, v138, v17
v_cmpx_lt_i32 vcc, 35, v32
ds_add_rtn_u32 v139, v139, v17
v_cmpx_lt_i32 vcc, 48, v32
s_cbranch_execz LE_p
ds_add_rtn_u32 v140, v140, v17
v_cmpx_lt_i32 vcc, 49, v32
ds_add_rtn_u32 v141, v141, v17
v_cmpx_lt_i32 vcc, 50, v32
ds_add_rtn_u32 v142, v142, v17
v_cmpx_lt_i32 vcc, 51, v32
ds_add_rtn_u32 v143, v143, v17
v_cmpx_lt_i32 vcc, 64, v32
s_cbranch_execz LE_p
ds_add_rtn_u32 v144, v144, v17
v_cmpx_lt_i32 vcc, 65, v32
ds_add_rtn_u32 v145, v145, v17
v_cmpx_lt_i32 vcc, 66, v32
ds_add_rtn_u32 v146, v146, v17
v_cmpx_lt_i32 vcc, 67, v32
ds_add_rtn_u32 v147, v147, v17
v_cmpx_lt_i32 vcc, 80, v32
s_cbranch_execz LE_p
ds_add_rtn_u32 v148, v148, v17
v_cmpx_lt_i32 vcc, 81, v32
ds_add_rtn_u32 v149, v149, v17
v_cmpx_lt_i32 vcc, 82, v32
ds_add_rtn_u32 v150, v150, v17
v_cmpx_lt_i32 vcc, 83, v32
ds_add_rtn_u32 v151, v151, v17
v_cmpx_lt_i32 vcc, 96, v32
s_cbranch_execz LE_p
ds_add_rtn_u32 v152, v152, v17
v_cmpx_lt_i32 vcc, 97, v32
ds_add_rtn_u32 v153, v153, v17
v_cmpx_lt_i32 vcc, 98, v32
ds_add_rtn_u32 v154, v154, v17
v_cmpx_lt_i32 vcc, 99, v32
ds_add_rtn_u32 v155, v155, v17
v_cmpx_lt_i32 vcc, 112, v32
s_cbranch_execz LE_p
ds_add_rtn_u32 v156, v156, v17
v_cmpx_lt_i32 vcc, 113, v32
ds_add_rtn_u32 v157, v157, v17
v_cmpx_lt_i32 vcc, 114, v32
ds_add_rtn_u32 v158, v158, v17
v_cmpx_lt_i32 vcc, 115, v32
ds_add_rtn_u32 v159, v159, v17
v_cmpx_lt_i32 vcc, 128, v32
s_cbranch_execz LE_p
ds_add_rtn_u32 v160, v160, v17
v_cmpx_lt_i32 vcc, 129, v32
ds_add_rtn_u32 v161, v161, v17
v_cmpx_lt_i32 vcc, 130, v32
ds_add_rtn_u32 v162, v162, v17
v_cmpx_lt_i32 vcc, 131, v32
ds_add_rtn_u32 v163, v163, v17
v_cmpx_lt_i32 vcc, 144, v32
s_cbranch_execz LE_p
ds_add_rtn_u32 v164, v164, v17
v_cmpx_lt_i32 vcc, 145, v32
ds_add_rtn_u32 v165, v165, v17
v_cmpx_lt_i32 vcc, 146, v32
ds_add_rtn_u32 v166, v166, v17
v_cmpx_lt_i32 vcc, 147, v32
ds_add_rtn_u32 v167, v167, v17
v_cmpx_lt_i32 vcc, 160, v32
s_cbranch_execz LE_p
ds_add_rtn_u32 v168, v168, v17
v_cmpx_lt_i32 vcc, 161, v32
ds_add_rtn_u32 v169, v169, v17
v_cmpx_lt_i32 vcc, 162, v32
ds_add_rtn_u32 v170, v170, v17
v_cmpx_lt_i32 vcc, 163, v32
ds_add_rtn_u32 v171, v171, v17
v_cmpx_lt_i32 vcc, 176, v32
s_cbranch_execz LE_p
ds_add_rtn_u32 v172, v172, v17
v_cmpx_lt_i32 vcc, 177, v32
ds_add_rtn_u32 v173, v173, v17
v_cmpx_lt_i32 vcc, 178, v32
ds_add_rtn_u32 v174, v174, v17
v_cmpx_lt_i32 vcc, 179, v32
ds_add_rtn_u32 v175, v175, v17
v_cmpx_lt_i32 vcc, 192, v32
s_cbranch_execz LE_p
ds_add_rtn_u32 v176, v176, v17
v_cmpx_lt_i32 vcc, 193, v32
ds_add_rtn_u32 v177, v177, v17
v_cmpx_lt_i32 vcc, 194, v32
ds_add_rtn_u32 v178, v178, v17
v_cmpx_lt_i32 vcc, 195, v32
ds_add_rtn_u32 v179, v179, v17
v_cmpx_lt_i32 vcc, 208, v32
s_cbranch_execz LE_p
ds_add_rtn_u32 v180, v180, v17
v_cmpx_lt_i32 vcc, 209, v32
ds_add_rtn_u32 v181, v181, v17
v_cmpx_lt_i32 vcc, 210, v32
ds_add_rtn_u32 v182, v182, v17
v_cmpx_lt_i32 vcc, 211, v32
ds_add_rtn_u32 v183, v183, v17
v_cmpx_lt_i32 vcc, 224, v32
s_cbranch_execz LE_p
ds_add_rtn_u32 v184, v184, v17
v_cmpx_lt_i32 vcc, 225, v32
ds_add_rtn_u32 v185, v185, v17
v_cmpx_lt_i32 vcc, 226, v32
ds_add_rtn_u32 v186, v186, v17
v_cmpx_lt_i32 vcc, 227, v32
ds_add_rtn_u32 v187, v187, v17
v_cmpx_lt_i32 vcc, 240, v32
s_cbranch_execz LE_p
ds_add_rtn_u32 v188, v188, v17
v_cmpx_lt_i32 vcc, 241, v32
ds_add_rtn_u32 v189, v189, v17
v_cmpx_lt_i32 vcc, 242, v32
ds_add_rtn_u32 v190, v190, v17
v_cmpx_lt_i32 vcc, 243, v32
ds_add_rtn_u32 v191, v191, v17
LE_p:
s_mov_b64 exec, -1
v_lshl_add_u32 v33, v1, 2, v36
ds_read_b32 v37, v33 offset:20480
s_waitcnt lgkmcnt(0)
v_cmpx_lt_i32 vcc, 0, v32
s_cbranch_execz LE_w
ds_write_b32 v128, v192
v_cmpx_lt_i32 vcc, 1, v32
ds_write_b32 v129, v193
v_cmpx_lt_i32 vcc, 2, v32
ds_write_b32 v130, v194
v_cmpx_lt_i32 vcc, 3, v32
ds_write_b32 v131, v195
v_cmpx_lt_i32 vcc, 16, v32
s_cbranch_execz LE_w
ds_write_b32 v132, v196
v_cmpx_lt_i32 vcc, 17, v32
ds_write_b32 v133, v197
v_cmpx_lt_i32 vcc, 18, v32
ds_write_b32 v134, v198
v_cmpx_lt_i32 vcc, 19, v32
ds_write_b32 v135, v199
v_cmpx_lt_i32 vcc, 32, v32
s_cbranch_execz LE_w
ds_write_b32 v136, v200
v_cmpx_lt_i32 vcc, 33, v32
ds_write_b32 v137, v201
v_cmpx_lt_i32 vcc, 34, v32
ds_write_b32 v138, v202
v_cmpx_lt_i32 vcc, 35, v32
ds_write_b32 v139, v203
v_cmpx_lt_i32 vcc, 48, v32
s_cbranch_execz LE_w
ds_write_b32 v140, v204
v_cmpx_lt_i32 vcc, 49, v32
ds_write_b32 v141, v205
v_cmpx_lt_i32 vcc, 50, v32
ds_write_b32 v142, v206
v_cmpx_lt_i32 vcc, 51, v32
ds_write_b32 v143, v207
v_cmpx_lt_i32 vcc, 64, v32
s_cbranch_execz LE_w
ds_write_b32 v144, v208
v_cmpx_lt_i32 vcc, 65, v32
ds_write_b32 v145, v209
v_cmpx_lt_i32 vcc, 66, v32
ds_write_b32 v146, v210
v_cmpx_lt_i32 vcc, 67, v32
ds_write_b32 v147, v211
v_cmpx_lt_i32 vcc, 80, v32
s_cbranch_execz LE_w
ds_write_b32 v148, v212
v_cmpx_lt_i32 vcc, 81, v32
ds_write_b32 v149, v213
v_cmpx_lt_i32 vcc, 82, v32
ds_write_b32 v150, v214
v_cmpx_lt_i32 vcc, 83, v32
ds_write_b32 v151, v215
v_cmpx_lt_i32 vcc, 96, v32
s_cbranch_execz LE_w
ds_write_b32 v152, v216
v_cmpx_lt_i32 vcc, 97, v32
ds_write_b32 v153, v217
v_cmpx_lt_i32 vcc, 98, v32
ds_write_b32 v154, v218
v_cmpx_lt_i32 vcc, 99, v32
ds_write_b32 v155, v219
v_cmpx_lt_i32 vcc, 112, v32
s_cbranch_execz LE_w
ds_write_b32 v156, v220
v_cmpx_lt_i32 vcc, 113, v32
ds_write_b32 v157, v221
v_cmpx_lt_i32 vcc, 114, v32
ds_write_b32 v158, v222
v_cmpx_lt_i32 vcc, 115, v32
ds_write_b32 v159, v223
v_cmpx_lt_i32 vcc, 128, v32
s_cbranch_execz LE_w
ds_write_b32 v160, v224
v_cmpx_lt_i32 vcc, 129, v32
ds_write_b32 v161, v225
v_cmpx_lt_i32 vcc, 130, v32
ds_write_b32 v162, v226
v_cmpx_lt_i32 vcc, 131, v32
ds_write_b32 v163, v227
v_cmpx_lt_i32 vcc, 144, v32
s_cbranch_execz LE_w
ds_write_b32 v164, v228
v_cmpx_lt_i32 vcc, 145, v32
ds_write_b32 v165, v229
v_cmpx_lt_i32 vcc, 146, v32
ds_write_b32 v166, v230
v_cmpx_lt_i32 vcc, 147, v32
ds_write_b32 v167, v231
v_cmpx_lt_i32 vcc, 160, v32
s_cbranch_execz LE_w
ds_write_b32 v168, v232
v_cmpx_lt_i32 vcc, 161, v32
ds_write_b32 v169, v233
v_cmpx_lt_i32 vcc, 162, v32
ds_write_b32 v170, v234
v_cmpx_lt_i32 vcc, 163, v32
ds_write_b32 v171, v235
v_cmpx_lt_i32 vcc, 176, v32
s_cbranch_execz LE_w
ds_write_b32 v172, v236
v_cmpx_lt_i32 vcc, 177, v32
ds_write_b32 v173, v237
v_cmpx_lt_i32 vcc, 178, v32
ds_write_b32 v174, v238
v_cmpx_lt_i32 vcc, 179, v32
ds_write_b32 v175, v239
v_cmpx_lt_i32 vcc, 192, v32
s_cbranch_execz LE_w
ds_write_b32 v176, v240
v_cmpx_lt_i32 vcc, 193, v32
ds_write_b32 v177, v241
v_cmpx_lt_i32 vcc, 194, v32
ds_write_b32 v178, v242
v_cmpx_lt_i32 vcc, 195, v32
ds_write_b32 v179, v243
v_cmpx_lt_i32 vcc, 208, v32
s_cbranch_execz LE_w
ds_write_b32 v180, v244
v_cmpx_lt_i32 vcc, 209, v32
ds_write_b32 v181, v245
v_cmpx_lt_i32 vcc, 210, v32
ds_write_b32 v182, v246
v_cmpx_lt_i32 vcc, 211, v32
ds_write_b32 v183, v247
v_cmpx_lt_i32 vcc, 224, v32
s_cbranch_execz LE_w
ds_write_b32 v184, v248
v_cmpx_lt_i32 vcc, 225, v32
ds_write_b32 v185, v249
v_cmpx_lt_i32 vcc, 226, v32
ds_write_b32 v186, v250
v_cmpx_lt_i32 vcc, 227, v32
ds_write_b32 v187, v251
v_cmpx_lt_i32 vcc, 240, v32
s_cbranch_execz LE_w
ds_write_b32 v188, v252
v_cmpx_lt_i32 vcc, 241, v32
ds_write_b32 v189, v253
v_cmpx_lt_i32 vcc, 242, v32
ds_write_b32 v190, v254
v_cmpx_lt_i32 vcc, 243, v32
ds_write_b32 v191, v255
LE_w:
s_mov_b64 exec, -1
s_add_u32 s8, s4, 0x7c2a000
s_addc_u32 s9, s5, 0
s_mov_b32 s10, 0x8000
s_mov_b32 s11, 0x00020000
v_and_b32 v200, 63, v0
v_lshlrev_b32 v200, 7, v200
s_mov_b32 s91, 8192
s_mov_b32 s90, 16384
s_mov_b32 s95, 24576
s_mov_b32 s94, 0x10000
LE_poll:
buffer_load_dwordx2 v[192:193], v200, s[8:11], 0 offen sc1
buffer_load_dwordx2 v[194:195], v200, s[8:11], s91 offen sc1
buffer_load_dwordx2 v[196:197], v200, s[8:11], s90 offen sc1
buffer_load_dwordx2 v[198:199], v200, s[8:11], s95 offen sc1
s_sub_u32 s94, s94, 1
s_waitcnt vmcnt(0)
s_cbranch_scc1 LE_poll_go
v_cmp_ne_u64 vcc, s[98:99], v[192:193]
s_nop 1
s_cbranch_vccnz LE_poll
v_cmp_ne_u64 vcc, s[98:99], v[194:195]
s_nop 1
s_cbranch_vccnz LE_poll
v_cmp_ne_u64 vcc, s[98:99], v[196:197]
s_nop 1
s_cbranch_vccnz LE_poll
v_cmp_ne_u64 vcc, s[98:99], v[198:199]
s_nop 1
s_cbranch_vccnz LE_poll
LE_poll_go:
s_cmp_lg_u32 s40, 0
s_cbranch_scc1 LE_nobump
s_mov_b32 s90, 89984
s_mov_b32 s10, 90112
v_mov_b32 v192, s98
v_mov_b32 v193, s99
s_mov_b64 exec, 1
buffer_store_dwordx2 v[192:193], off, s[8:11], s90 sc1
s_mov_b64 exec, -1
LE_nobump:
v_mov_b32 v34, v38
ds_read2_b32 v[52:53], v34 offset0:0 offset1:4
ds_read2_b32 v[54:55], v34 offset0:8 offset1:12
s_waitcnt lgkmcnt(0)
ds_read2_b32 v[56:57], v34 offset0:16 offset1:20
ds_read2_b32 v[58:59], v34 offset0:24 offset1:28
v_mad_u32_u16 v60, v52, s49, v2
v_mad_u32_u16 v61, v53, s49, v2
v_mad_u32_u16 v62, v54, s49, v2
v_mad_u32_u16 v63, v55, s49, v2
buffer_load_dwordx4 a[0:3], v60, s[16:19], 0 offen sc1
buffer_load_dwordx4 a[4:7], v60, s[16:19], 0 offen offset:256 sc1
buffer_load_dwordx4 a[8:11], v61, s[16:19], 0 offen sc1
buffer_load_dwordx4 a[12:15], v61, s[16:19], 0 offen offset:256 sc1
buffer_load_dwordx4 a[16:19], v62, s[16:19], 0 offen sc1
buffer_load_dwordx4 a[20:23], v62, s[16:19], 0 offen offset:256 sc1
buffer_load_dwordx4 a[24:27], v63, s[16:19], 0 offen sc1
buffer_load_dwordx4 a[28:31], v63, s[16:19], 0 offen offset:256 sc1
s_waitcnt lgkmcnt(0)
ds_read2_b32 v[52:53], v34 offset0:32 offset1:36
ds_read2_b32 v[54:55], v34 offset0:40 offset1:44
v_mad_u32_u16 v60, v56, s49, v2
v_mad_u32_u16 v61, v57, s49, v2
v_mad_u32_u16 v62, v58, s49, v2
v_mad_u32_u16 v63, v59, s49, v2
buffer_load_dwordx4 a[32:35], v60, s[16:19], 0 offen sc1
buffer_load_dwordx4 a[36:39], v60, s[16:19], 0 offen offset:256 sc1
buffer_load_dwordx4 a[40:43], v61, s[16:19], 0 offen sc1
buffer_load_dwordx4 a[44:47], v61, s[16:19], 0 offen offset:256 sc1
buffer_load_dwordx4 a[48:51], v62, s[16:19], 0 offen sc1
buffer_load_dwordx4 a[52:55], v62, s[16:19], 0 offen offset:256 sc1
buffer_load_dwordx4 a[56:59], v63, s[16:19], 0 offen sc1
buffer_load_dwordx4 a[60:63], v63, s[16:19], 0 offen offset:256 sc1
s_waitcnt lgkmcnt(0)
ds_read2_b32 v[56:57], v34 offset0:48 offset1:52
ds_read2_b32 v[58:59], v34 offset0:56 offset1:60
v_mad_u32_u16 v60, v52, s49, v2
v_mad_u32_u16 v61, v53, s49, v2
v_mad_u32_u16 v62, v54, s49, v2
v_mad_u32_u16 v63, v55, s49, v2
buffer_load_dwordx4 a[64:67], v60, s[16:19], 0 offen sc1
buffer_load_dwordx4 a[68:71], v60, s[16:19], 0 offen offset:256 sc1
buffer_load_dwordx4 a[72:75], v61, s[16:19], 0 offen sc1
buffer_load_dwordx4 a[76:79], v61, s[16:19], 0 offen offset:256 sc1
buffer_load_dwordx4 a[80:83], v62, s[16:19], 0 offen sc1
buffer_load_dwordx4 a[84:87], v62, s[16:19], 0 offen offset:256 sc1
buffer_load_dwordx4 a[88:91], v63, s[16:19], 0 offen sc1
buffer_load_dwordx4 a[92:95], v63, s[16:19], 0 offen offset:256 sc1
s_waitcnt lgkmcnt(0)
ds_read2_b32 v[52:53], v34 offset0:64 offset1:68
ds_read2_b32 v[54:55], v34 offset0:72 offset1:76
v_mad_u32_u16 v60, v56, s49, v2
v_mad_u32_u16 v61, v57, s49, v2
v_mad_u32_u16 v62, v58, s49, v2
v_mad_u32_u16 v63, v59, s49, v2
buffer_load_dwordx4 a[96:99], v60, s[16:19], 0 offen sc1
buffer_load_dwordx4 a[100:103], v60, s[16:19], 0 offen offset:256 sc1
buffer_load_dwordx4 a[104:107], v61, s[16:19], 0 offen sc1
buffer_load_dwordx4 a[108:111], v61, s[16:19], 0 offen offset:256 sc1
buffer_load_dwordx4 a[112:115], v62, s[16:19], 0 offen sc1
buffer_load_dwordx4 a[116:119], v62, s[16:19], 0 offen offset:256 sc1
buffer_load_dwordx4 a[120:123], v63, s[16:19], 0 offen sc1
buffer_load_dwordx4 a[124:127], v63, s[16:19], 0 offen offset:256 sc1
s_waitcnt lgkmcnt(0)
ds_read2_b32 v[56:57], v34 offset0:80 offset1:84
ds_read2_b32 v[58:59], v34 offset0:88 offset1:92
v_mad_u32_u16 v60, v52, s49, v2
v_mad_u32_u16 v61, v53, s49, v2
v_mad_u32_u16 v62, v54, s49, v2
v_mad_u32_u16 v63, v55, s49, v2
buffer_load_dwordx4 a[128:131], v60, s[16:19], 0 offen sc1
buffer_load_dwordx4 a[132:135], v60, s[16:19], 0 offen offset:256 sc1
buffer_load_dwordx4 a[136:139], v61, s[16:19], 0 offen sc1
buffer_load_dwordx4 a[140:143], v61, s[16:19], 0 offen offset:256 sc1
buffer_load_dwordx4 a[144:147], v62, s[16:19], 0 offen sc1
buffer_load_dwordx4 a[148:151], v62, s[16:19], 0 offen offset:256 sc1
buffer_load_dwordx4 a[152:155], v63, s[16:19], 0 offen sc1
buffer_load_dwordx4 a[156:159], v63, s[16:19], 0 offen offset:256 sc1
s_waitcnt lgkmcnt(0)
ds_read2_b32 v[52:53], v34 offset0:96 offset1:100
ds_read2_b32 v[54:55], v34 offset0:104 offset1:108
v_mad_u32_u16 v60, v56, s49, v2
v_mad_u32_u16 v61, v57, s49, v2
v_mad_u32_u16 v62, v58, s49, v2
v_mad_u32_u16 v63, v59, s49, v2
buffer_load_dwordx4 a[160:163], v60, s[16:19], 0 offen sc1
buffer_load_dwordx4 a[164:167], v60, s[16:19], 0 offen offset:256 sc1
buffer_load_dwordx4 a[168:171], v61, s[16:19], 0 offen sc1
buffer_load_dwordx4 a[172:175], v61, s[16:19], 0 offen offset:256 sc1
buffer_load_dwordx4 a[176:179], v62, s[16:19], 0 offen sc1
buffer_load_dwordx4 a[180:183], v62, s[16:19], 0 offen offset:256 sc1
buffer_load_dwordx4 a[184:187], v63, s[16:19], 0 offen sc1
buffer_load_dwordx4 a[188:191], v63, s[16:19], 0 offen offset:256 sc1
s_waitcnt lgkmcnt(0)
ds_read2_b32 v[56:57], v34 offset0:112 offset1:116
ds_read2_b32 v[58:59], v34 offset0:120 offset1:124
v_mad_u32_u16 v60, v52, s49, v2
v_mad_u32_u16 v61, v53, s49, v2
v_mad_u32_u16 v62, v54, s49, v2
v_mad_u32_u16 v63, v55, s49, v2
buffer_load_dwordx4 a[192:195], v60, s[16:19], 0 offen sc1
buffer_load_dwordx4 a[196:199], v60, s[16:19], 0 offen offset:256 sc1
buffer_load_dwordx4 a[200:203], v61, s[16:19], 0 offen sc1
buffer_load_dwordx4 a[204:207], v61, s[16:19], 0 offen offset:256 sc1
buffer_load_dwordx4 a[208:211], v62, s[16:19], 0 offen sc1
buffer_load_dwordx4 a[212:215], v62, s[16:19], 0 offen offset:256 sc1
buffer_load_dwordx4 a[216:219], v63, s[16:19], 0 offen sc1
buffer_load_dwordx4 a[220:223], v63, s[16:19], 0 offen offset:256 sc1
s_waitcnt lgkmcnt(0)
ds_read2_b32 v[52:53], v34 offset0:128 offset1:132
ds_read2_b32 v[54:55], v34 offset0:136 offset1:140
v_mad_u32_u16 v60, v56, s49, v2
v_mad_u32_u16 v61, v57, s49, v2
v_mad_u32_u16 v62, v58, s49, v2
v_mad_u32_u16 v63, v59, s49, v2
buffer_load_dwordx4 a[224:227], v60, s[16:19], 0 offen sc1
buffer_load_dwordx4 a[228:231], v60, s[16:19], 0 offen offset:256 sc1
buffer_load_dwordx4 a[232:235], v61, s[16:19], 0 offen sc1
buffer_load_dwordx4 a[236:239], v61, s[16:19], 0 offen offset:256 sc1
buffer_load_dwordx4 a[240:243], v62, s[16:19], 0 offen sc1
buffer_load_dwordx4 a[244:247], v62, s[16:19], 0 offen offset:256 sc1
buffer_load_dwordx4 a[248:251], v63, s[16:19], 0 offen sc1
buffer_load_dwordx4 a[252:255], v63, s[16:19], 0 offen offset:256 sc1
v_add_u32 v34, 512, v34
s_mov_b32 s45, 0
s_lshl_b32 s47, s55, 9
LE_loop:
v_readlane_b32 s46, v37, s45
s_add_u32 s45, s45, 1
s_waitcnt vmcnt(56)
v_mfma_f32_16x16x32_bf16 v[48:51], a[0:3], v[40:43], v[48:51]
v_mfma_f32_16x16x32_bf16 v[48:51], a[4:7], v[44:47], v[48:51]
s_bitcmp1_b32 s46, 0
s_cbranch_scc0 LE_nf0
s_cmp_eq_u32 s42, 0
s_cbranch_scc1 LE_fl0
buffer_load_dwordx2 v[66:67], v39, s[20:23], s47 offen sc1
s_waitcnt vmcnt(0)
v_lshlrev_b32 v64, 16, v66
v_and_b32 v65, 0xffff0000, v66
v_add_f32 v48, v48, v64
v_add_f32 v49, v49, v65
v_lshlrev_b32 v64, 16, v67
v_and_b32 v65, 0xffff0000, v67
v_add_f32 v50, v50, v64
v_add_f32 v51, v51, v65
LE_fl0:
s_nop 3
v_cvt_pk_bf16_f32 v64, v48, v49
v_cvt_pk_bf16_f32 v65, v50, v51
v_mov_b32 v48, 0
v_mov_b32 v49, 0
v_mov_b32 v50, 0
v_mov_b32 v51, 0
buffer_store_dwordx2 v[64:65], v39, s[20:23], s47 offen sc1
s_add_u32 s47, s47, 512
LE_nf0:
v_mfma_f32_16x16x32_bf16 v[48:51], a[8:11], v[40:43], v[48:51]
v_mfma_f32_16x16x32_bf16 v[48:51], a[12:15], v[44:47], v[48:51]
s_bitcmp1_b32 s46, 1
s_cbranch_scc0 LE_nf1
s_cmp_eq_u32 s42, 0
s_cbranch_scc1 LE_fl1
buffer_load_dwordx2 v[66:67], v39, s[20:23], s47 offen sc1
s_waitcnt vmcnt(0)
v_lshlrev_b32 v64, 16, v66
v_and_b32 v65, 0xffff0000, v66
v_add_f32 v48, v48, v64
v_add_f32 v49, v49, v65
v_lshlrev_b32 v64, 16, v67
v_and_b32 v65, 0xffff0000, v67
v_add_f32 v50, v50, v64
v_add_f32 v51, v51, v65
LE_fl1:
s_nop 3
v_cvt_pk_bf16_f32 v64, v48, v49
v_cvt_pk_bf16_f32 v65, v50, v51
v_mov_b32 v48, 0
v_mov_b32 v49, 0
v_mov_b32 v50, 0
v_mov_b32 v51, 0
buffer_store_dwordx2 v[64:65], v39, s[20:23], s47 offen sc1
s_add_u32 s47, s47, 512
LE_nf1:
v_mfma_f32_16x16x32_bf16 v[48:51], a[16:19], v[40:43], v[48:51]
v_mfma_f32_16x16x32_bf16 v[48:51], a[20:23], v[44:47], v[48:51]
s_bitcmp1_b32 s46, 2
s_cbranch_scc0 LE_nf2
s_cmp_eq_u32 s42, 0
s_cbranch_scc1 LE_fl2
buffer_load_dwordx2 v[66:67], v39, s[20:23], s47 offen sc1
s_waitcnt vmcnt(0)
v_lshlrev_b32 v64, 16, v66
v_and_b32 v65, 0xffff0000, v66
v_add_f32 v48, v48, v64
v_add_f32 v49, v49, v65
v_lshlrev_b32 v64, 16, v67
v_and_b32 v65, 0xffff0000, v67
v_add_f32 v50, v50, v64
v_add_f32 v51, v51, v65
LE_fl2:
s_nop 3
v_cvt_pk_bf16_f32 v64, v48, v49
v_cvt_pk_bf16_f32 v65, v50, v51
v_mov_b32 v48, 0
v_mov_b32 v49, 0
v_mov_b32 v50, 0
v_mov_b32 v51, 0
buffer_store_dwordx2 v[64:65], v39, s[20:23], s47 offen sc1
s_add_u32 s47, s47, 512
LE_nf2:
v_mfma_f32_16x16x32_bf16 v[48:51], a[24:27], v[40:43], v[48:51]
v_mfma_f32_16x16x32_bf16 v[48:51], a[28:31], v[44:47], v[48:51]
s_bitcmp1_b32 s46, 3
s_cbranch_scc0 LE_nf3
s_cmp_eq_u32 s42, 0
s_cbranch_scc1 LE_fl3
buffer_load_dwordx2 v[66:67], v39, s[20:23], s47 offen sc1
s_waitcnt vmcnt(0)
v_lshlrev_b32 v64, 16, v66
v_and_b32 v65, 0xffff0000, v66
v_add_f32 v48, v48, v64
v_add_f32 v49, v49, v65
v_lshlrev_b32 v64, 16, v67
v_and_b32 v65, 0xffff0000, v67
v_add_f32 v50, v50, v64
v_add_f32 v51, v51, v65
LE_fl3:
s_nop 3
v_cvt_pk_bf16_f32 v64, v48, v49
v_cvt_pk_bf16_f32 v65, v50, v51
v_mov_b32 v48, 0
v_mov_b32 v49, 0
v_mov_b32 v50, 0
v_mov_b32 v51, 0
buffer_store_dwordx2 v[64:65], v39, s[20:23], s47 offen sc1
s_add_u32 s47, s47, 512
LE_nf3:
s_waitcnt lgkmcnt(0)
ds_read2_b32 v[56:57], v34 offset0:16 offset1:20
ds_read2_b32 v[58:59], v34 offset0:24 offset1:28
v_mad_u32_u16 v60, v52, s49, v2
v_mad_u32_u16 v61, v53, s49, v2
v_mad_u32_u16 v62, v54, s49, v2
v_mad_u32_u16 v63, v55, s49, v2
buffer_load_dwordx4 a[0:3], v60, s[16:19], 0 offen sc1
buffer_load_dwordx4 a[4:7], v60, s[16:19], 0 offen offset:256 sc1
buffer_load_dwordx4 a[8:11], v61, s[16:19], 0 offen sc1
buffer_load_dwordx4 a[12:15], v61, s[16:19], 0 offen offset:256 sc1
buffer_load_dwordx4 a[16:19], v62, s[16:19], 0 offen sc1
buffer_load_dwordx4 a[20:23], v62, s[16:19], 0 offen offset:256 sc1
buffer_load_dwordx4 a[24:27], v63, s[16:19], 0 offen sc1
buffer_load_dwordx4 a[28:31], v63, s[16:19], 0 offen offset:256 sc1
s_waitcnt vmcnt(56)
v_mfma_f32_16x16x32_bf16 v[48:51], a[32:35], v[40:43], v[48:51]
v_mfma_f32_16x16x32_bf16 v[48:51], a[36:39], v[44:47], v[48:51]
s_bitcmp1_b32 s46, 4
s_cbranch_scc0 LE_nf4
s_cmp_eq_u32 s42, 0
s_cbranch_scc1 LE_fl4
buffer_load_dwordx2 v[66:67], v39, s[20:23], s47 offen sc1
s_waitcnt vmcnt(0)
v_lshlrev_b32 v64, 16, v66
v_and_b32 v65, 0xffff0000, v66
v_add_f32 v48, v48, v64
v_add_f32 v49, v49, v65
v_lshlrev_b32 v64, 16, v67
v_and_b32 v65, 0xffff0000, v67
v_add_f32 v50, v50, v64
v_add_f32 v51, v51, v65
LE_fl4:
s_nop 3
v_cvt_pk_bf16_f32 v64, v48, v49
v_cvt_pk_bf16_f32 v65, v50, v51
v_mov_b32 v48, 0
v_mov_b32 v49, 0
v_mov_b32 v50, 0
v_mov_b32 v51, 0
buffer_store_dwordx2 v[64:65], v39, s[20:23], s47 offen sc1
s_add_u32 s47, s47, 512
LE_nf4:
v_mfma_f32_16x16x32_bf16 v[48:51], a[40:43], v[40:43], v[48:51]
v_mfma_f32_16x16x32_bf16 v[48:51], a[44:47], v[44:47], v[48:51]
s_bitcmp1_b32 s46, 5
s_cbranch_scc0 LE_nf5
s_cmp_eq_u32 s42, 0
s_cbranch_scc1 LE_fl5
buffer_load_dwordx2 v[66:67], v39, s[20:23], s47 offen sc1
s_waitcnt vmcnt(0)
v_lshlrev_b32 v64, 16, v66
v_and_b32 v65, 0xffff0000, v66
v_add_f32 v48, v48, v64
v_add_f32 v49, v49, v65
v_lshlrev_b32 v64, 16, v67
v_and_b32 v65, 0xffff0000, v67
v_add_f32 v50, v50, v64
v_add_f32 v51, v51, v65
LE_fl5:
s_nop 3
v_cvt_pk_bf16_f32 v64, v48, v49
v_cvt_pk_bf16_f32 v65, v50, v51
v_mov_b32 v48, 0
v_mov_b32 v49, 0
v_mov_b32 v50, 0
v_mov_b32 v51, 0
buffer_store_dwordx2 v[64:65], v39, s[20:23], s47 offen sc1
s_add_u32 s47, s47, 512
LE_nf5:
v_mfma_f32_16x16x32_bf16 v[48:51], a[48:51], v[40:43], v[48:51]
v_mfma_f32_16x16x32_bf16 v[48:51], a[52:55], v[44:47], v[48:51]
s_bitcmp1_b32 s46, 6
s_cbranch_scc0 LE_nf6
s_cmp_eq_u32 s42, 0
s_cbranch_scc1 LE_fl6
buffer_load_dwordx2 v[66:67], v39, s[20:23], s47 offen sc1
s_waitcnt vmcnt(0)
v_lshlrev_b32 v64, 16, v66
v_and_b32 v65, 0xffff0000, v66
v_add_f32 v48, v48, v64
v_add_f32 v49, v49, v65
v_lshlrev_b32 v64, 16, v67
v_and_b32 v65, 0xffff0000, v67
v_add_f32 v50, v50, v64
v_add_f32 v51, v51, v65
LE_fl6:
s_nop 3
v_cvt_pk_bf16_f32 v64, v48, v49
v_cvt_pk_bf16_f32 v65, v50, v51
v_mov_b32 v48, 0
v_mov_b32 v49, 0
v_mov_b32 v50, 0
v_mov_b32 v51, 0
buffer_store_dwordx2 v[64:65], v39, s[20:23], s47 offen sc1
s_add_u32 s47, s47, 512
LE_nf6:
v_mfma_f32_16x16x32_bf16 v[48:51], a[56:59], v[40:43], v[48:51]
v_mfma_f32_16x16x32_bf16 v[48:51], a[60:63], v[44:47], v[48:51]
s_bitcmp1_b32 s46, 7
s_cbranch_scc0 LE_nf7
s_cmp_eq_u32 s42, 0
s_cbranch_scc1 LE_fl7
buffer_load_dwordx2 v[66:67], v39, s[20:23], s47 offen sc1
s_waitcnt vmcnt(0)
v_lshlrev_b32 v64, 16, v66
v_and_b32 v65, 0xffff0000, v66
v_add_f32 v48, v48, v64
v_add_f32 v49, v49, v65
v_lshlrev_b32 v64, 16, v67
v_and_b32 v65, 0xffff0000, v67
v_add_f32 v50, v50, v64
v_add_f32 v51, v51, v65
LE_fl7:
s_nop 3
v_cvt_pk_bf16_f32 v64, v48, v49
v_cvt_pk_bf16_f32 v65, v50, v51
v_mov_b32 v48, 0
v_mov_b32 v49, 0
v_mov_b32 v50, 0
v_mov_b32 v51, 0
buffer_store_dwordx2 v[64:65], v39, s[20:23], s47 offen sc1
s_add_u32 s47, s47, 512
LE_nf7:
s_waitcnt lgkmcnt(0)
ds_read2_b32 v[52:53], v34 offset0:32 offset1:36
ds_read2_b32 v[54:55], v34 offset0:40 offset1:44
v_mad_u32_u16 v60, v56, s49, v2
v_mad_u32_u16 v61, v57, s49, v2
v_mad_u32_u16 v62, v58, s49, v2
v_mad_u32_u16 v63, v59, s49, v2
buffer_load_dwordx4 a[32:35], v60, s[16:19], 0 offen sc1
buffer_load_dwordx4 a[36:39], v60, s[16:19], 0 offen offset:256 sc1
buffer_load_dwordx4 a[40:43], v61, s[16:19], 0 offen sc1
buffer_load_dwordx4 a[44:47], v61, s[16:19], 0 offen offset:256 sc1
buffer_load_dwordx4 a[48:51], v62, s[16:19], 0 offen sc1
buffer_load_dwordx4 a[52:55], v62, s[16:19], 0 offen offset:256 sc1
buffer_load_dwordx4 a[56:59], v63, s[16:19], 0 offen sc1
buffer_load_dwordx4 a[60:63], v63, s[16:19], 0 offen offset:256 sc1
s_waitcnt vmcnt(56)
v_mfma_f32_16x16x32_bf16 v[48:51], a[64:67], v[40:43], v[48:51]
v_mfma_f32_16x16x32_bf16 v[48:51], a[68:71], v[44:47], v[48:51]
s_bitcmp1_b32 s46, 8
s_cbranch_scc0 LE_nf8
s_cmp_eq_u32 s42, 0
s_cbranch_scc1 LE_fl8
buffer_load_dwordx2 v[66:67], v39, s[20:23], s47 offen sc1
s_waitcnt vmcnt(0)
v_lshlrev_b32 v64, 16, v66
v_and_b32 v65, 0xffff0000, v66
v_add_f32 v48, v48, v64
v_add_f32 v49, v49, v65
v_lshlrev_b32 v64, 16, v67
v_and_b32 v65, 0xffff0000, v67
v_add_f32 v50, v50, v64
v_add_f32 v51, v51, v65
LE_fl8:
s_nop 3
v_cvt_pk_bf16_f32 v64, v48, v49
v_cvt_pk_bf16_f32 v65, v50, v51
v_mov_b32 v48, 0
v_mov_b32 v49, 0
v_mov_b32 v50, 0
v_mov_b32 v51, 0
buffer_store_dwordx2 v[64:65], v39, s[20:23], s47 offen sc1
s_add_u32 s47, s47, 512
LE_nf8:
v_mfma_f32_16x16x32_bf16 v[48:51], a[72:75], v[40:43], v[48:51]
v_mfma_f32_16x16x32_bf16 v[48:51], a[76:79], v[44:47], v[48:51]
s_bitcmp1_b32 s46, 9
s_cbranch_scc0 LE_nf9
s_cmp_eq_u32 s42, 0
s_cbranch_scc1 LE_fl9
buffer_load_dwordx2 v[66:67], v39, s[20:23], s47 offen sc1
s_waitcnt vmcnt(0)
v_lshlrev_b32 v64, 16, v66
v_and_b32 v65, 0xffff0000, v66
v_add_f32 v48, v48, v64
v_add_f32 v49, v49, v65
v_lshlrev_b32 v64, 16, v67
v_and_b32 v65, 0xffff0000, v67
v_add_f32 v50, v50, v64
v_add_f32 v51, v51, v65
LE_fl9:
s_nop 3
v_cvt_pk_bf16_f32 v64, v48, v49
v_cvt_pk_bf16_f32 v65, v50, v51
v_mov_b32 v48, 0
v_mov_b32 v49, 0
v_mov_b32 v50, 0
v_mov_b32 v51, 0
buffer_store_dwordx2 v[64:65], v39, s[20:23], s47 offen sc1
s_add_u32 s47, s47, 512
LE_nf9:
v_mfma_f32_16x16x32_bf16 v[48:51], a[80:83], v[40:43], v[48:51]
v_mfma_f32_16x16x32_bf16 v[48:51], a[84:87], v[44:47], v[48:51]
s_bitcmp1_b32 s46, 10
s_cbranch_scc0 LE_nf10
s_cmp_eq_u32 s42, 0
s_cbranch_scc1 LE_fl10
buffer_load_dwordx2 v[66:67], v39, s[20:23], s47 offen sc1
s_waitcnt vmcnt(0)
v_lshlrev_b32 v64, 16, v66
v_and_b32 v65, 0xffff0000, v66
v_add_f32 v48, v48, v64
v_add_f32 v49, v49, v65
v_lshlrev_b32 v64, 16, v67
v_and_b32 v65, 0xffff0000, v67
v_add_f32 v50, v50, v64
v_add_f32 v51, v51, v65
LE_fl10:
s_nop 3
v_cvt_pk_bf16_f32 v64, v48, v49
v_cvt_pk_bf16_f32 v65, v50, v51
v_mov_b32 v48, 0
v_mov_b32 v49, 0
v_mov_b32 v50, 0
v_mov_b32 v51, 0
buffer_store_dwordx2 v[64:65], v39, s[20:23], s47 offen sc1
s_add_u32 s47, s47, 512
LE_nf10:
v_mfma_f32_16x16x32_bf16 v[48:51], a[88:91], v[40:43], v[48:51]
v_mfma_f32_16x16x32_bf16 v[48:51], a[92:95], v[44:47], v[48:51]
s_bitcmp1_b32 s46, 11
s_cbranch_scc0 LE_nf11
s_cmp_eq_u32 s42, 0
s_cbranch_scc1 LE_fl11
buffer_load_dwordx2 v[66:67], v39, s[20:23], s47 offen sc1
s_waitcnt vmcnt(0)
v_lshlrev_b32 v64, 16, v66
v_and_b32 v65, 0xffff0000, v66
v_add_f32 v48, v48, v64
v_add_f32 v49, v49, v65
v_lshlrev_b32 v64, 16, v67
v_and_b32 v65, 0xffff0000, v67
v_add_f32 v50, v50, v64
v_add_f32 v51, v51, v65
LE_fl11:
s_nop 3
v_cvt_pk_bf16_f32 v64, v48, v49
v_cvt_pk_bf16_f32 v65, v50, v51
v_mov_b32 v48, 0
v_mov_b32 v49, 0
v_mov_b32 v50, 0
v_mov_b32 v51, 0
buffer_store_dwordx2 v[64:65], v39, s[20:23], s47 offen sc1
s_add_u32 s47, s47, 512
LE_nf11:
s_waitcnt lgkmcnt(0)
ds_read2_b32 v[56:57], v34 offset0:48 offset1:52
ds_read2_b32 v[58:59], v34 offset0:56 offset1:60
v_mad_u32_u16 v60, v52, s49, v2
v_mad_u32_u16 v61, v53, s49, v2
v_mad_u32_u16 v62, v54, s49, v2
v_mad_u32_u16 v63, v55, s49, v2
buffer_load_dwordx4 a[64:67], v60, s[16:19], 0 offen sc1
buffer_load_dwordx4 a[68:71], v60, s[16:19], 0 offen offset:256 sc1
buffer_load_dwordx4 a[72:75], v61, s[16:19], 0 offen sc1
buffer_load_dwordx4 a[76:79], v61, s[16:19], 0 offen offset:256 sc1
buffer_load_dwordx4 a[80:83], v62, s[16:19], 0 offen sc1
buffer_load_dwordx4 a[84:87], v62, s[16:19], 0 offen offset:256 sc1
buffer_load_dwordx4 a[88:91], v63, s[16:19], 0 offen sc1
buffer_load_dwordx4 a[92:95], v63, s[16:19], 0 offen offset:256 sc1
s_waitcnt vmcnt(56)
v_mfma_f32_16x16x32_bf16 v[48:51], a[96:99], v[40:43], v[48:51]
v_mfma_f32_16x16x32_bf16 v[48:51], a[100:103], v[44:47], v[48:51]
s_bitcmp1_b32 s46, 12
s_cbranch_scc0 LE_nf12
s_cmp_eq_u32 s42, 0
s_cbranch_scc1 LE_fl12
buffer_load_dwordx2 v[66:67], v39, s[20:23], s47 offen sc1
s_waitcnt vmcnt(0)
v_lshlrev_b32 v64, 16, v66
v_and_b32 v65, 0xffff0000, v66
v_add_f32 v48, v48, v64
v_add_f32 v49, v49, v65
v_lshlrev_b32 v64, 16, v67
v_and_b32 v65, 0xffff0000, v67
v_add_f32 v50, v50, v64
v_add_f32 v51, v51, v65
LE_fl12:
s_nop 3
v_cvt_pk_bf16_f32 v64, v48, v49
v_cvt_pk_bf16_f32 v65, v50, v51
v_mov_b32 v48, 0
v_mov_b32 v49, 0
v_mov_b32 v50, 0
v_mov_b32 v51, 0
buffer_store_dwordx2 v[64:65], v39, s[20:23], s47 offen sc1
s_add_u32 s47, s47, 512
LE_nf12:
v_mfma_f32_16x16x32_bf16 v[48:51], a[104:107], v[40:43], v[48:51]
v_mfma_f32_16x16x32_bf16 v[48:51], a[108:111], v[44:47], v[48:51]
s_bitcmp1_b32 s46, 13
s_cbranch_scc0 LE_nf13
s_cmp_eq_u32 s42, 0
s_cbranch_scc1 LE_fl13
buffer_load_dwordx2 v[66:67], v39, s[20:23], s47 offen sc1
s_waitcnt vmcnt(0)
v_lshlrev_b32 v64, 16, v66
v_and_b32 v65, 0xffff0000, v66
v_add_f32 v48, v48, v64
v_add_f32 v49, v49, v65
v_lshlrev_b32 v64, 16, v67
v_and_b32 v65, 0xffff0000, v67
v_add_f32 v50, v50, v64
v_add_f32 v51, v51, v65
LE_fl13:
s_nop 3
v_cvt_pk_bf16_f32 v64, v48, v49
v_cvt_pk_bf16_f32 v65, v50, v51
v_mov_b32 v48, 0
v_mov_b32 v49, 0
v_mov_b32 v50, 0
v_mov_b32 v51, 0
buffer_store_dwordx2 v[64:65], v39, s[20:23], s47 offen sc1
s_add_u32 s47, s47, 512
LE_nf13:
v_mfma_f32_16x16x32_bf16 v[48:51], a[112:115], v[40:43], v[48:51]
v_mfma_f32_16x16x32_bf16 v[48:51], a[116:119], v[44:47], v[48:51]
s_bitcmp1_b32 s46, 14
s_cbranch_scc0 LE_nf14
s_cmp_eq_u32 s42, 0
s_cbranch_scc1 LE_fl14
buffer_load_dwordx2 v[66:67], v39, s[20:23], s47 offen sc1
s_waitcnt vmcnt(0)
v_lshlrev_b32 v64, 16, v66
v_and_b32 v65, 0xffff0000, v66
v_add_f32 v48, v48, v64
v_add_f32 v49, v49, v65
v_lshlrev_b32 v64, 16, v67
v_and_b32 v65, 0xffff0000, v67
v_add_f32 v50, v50, v64
v_add_f32 v51, v51, v65
LE_fl14:
s_nop 3
v_cvt_pk_bf16_f32 v64, v48, v49
v_cvt_pk_bf16_f32 v65, v50, v51
v_mov_b32 v48, 0
v_mov_b32 v49, 0
v_mov_b32 v50, 0
v_mov_b32 v51, 0
buffer_store_dwordx2 v[64:65], v39, s[20:23], s47 offen sc1
s_add_u32 s47, s47, 512
LE_nf14:
v_mfma_f32_16x16x32_bf16 v[48:51], a[120:123], v[40:43], v[48:51]
v_mfma_f32_16x16x32_bf16 v[48:51], a[124:127], v[44:47], v[48:51]
s_bitcmp1_b32 s46, 15
s_cbranch_scc0 LE_nf15
s_cmp_eq_u32 s42, 0
s_cbranch_scc1 LE_fl15
buffer_load_dwordx2 v[66:67], v39, s[20:23], s47 offen sc1
s_waitcnt vmcnt(0)
v_lshlrev_b32 v64, 16, v66
v_and_b32 v65, 0xffff0000, v66
v_add_f32 v48, v48, v64
v_add_f32 v49, v49, v65
v_lshlrev_b32 v64, 16, v67
v_and_b32 v65, 0xffff0000, v67
v_add_f32 v50, v50, v64
v_add_f32 v51, v51, v65
LE_fl15:
s_nop 3
v_cvt_pk_bf16_f32 v64, v48, v49
v_cvt_pk_bf16_f32 v65, v50, v51
v_mov_b32 v48, 0
v_mov_b32 v49, 0
v_mov_b32 v50, 0
v_mov_b32 v51, 0
buffer_store_dwordx2 v[64:65], v39, s[20:23], s47 offen sc1
s_add_u32 s47, s47, 512
LE_nf15:
s_waitcnt lgkmcnt(0)
ds_read2_b32 v[52:53], v34 offset0:64 offset1:68
ds_read2_b32 v[54:55], v34 offset0:72 offset1:76
v_mad_u32_u16 v60, v56, s49, v2
v_mad_u32_u16 v61, v57, s49, v2
v_mad_u32_u16 v62, v58, s49, v2
v_mad_u32_u16 v63, v59, s49, v2
buffer_load_dwordx4 a[96:99], v60, s[16:19], 0 offen sc1
buffer_load_dwordx4 a[100:103], v60, s[16:19], 0 offen offset:256 sc1
buffer_load_dwordx4 a[104:107], v61, s[16:19], 0 offen sc1
buffer_load_dwordx4 a[108:111], v61, s[16:19], 0 offen offset:256 sc1
buffer_load_dwordx4 a[112:115], v62, s[16:19], 0 offen sc1
buffer_load_dwordx4 a[116:119], v62, s[16:19], 0 offen offset:256 sc1
buffer_load_dwordx4 a[120:123], v63, s[16:19], 0 offen sc1
buffer_load_dwordx4 a[124:127], v63, s[16:19], 0 offen offset:256 sc1
s_waitcnt vmcnt(56)
v_mfma_f32_16x16x32_bf16 v[48:51], a[128:131], v[40:43], v[48:51]
v_mfma_f32_16x16x32_bf16 v[48:51], a[132:135], v[44:47], v[48:51]
s_bitcmp1_b32 s46, 16
s_cbranch_scc0 LE_nf16
s_cmp_eq_u32 s42, 0
s_cbranch_scc1 LE_fl16
buffer_load_dwordx2 v[66:67], v39, s[20:23], s47 offen sc1
s_waitcnt vmcnt(0)
v_lshlrev_b32 v64, 16, v66
v_and_b32 v65, 0xffff0000, v66
v_add_f32 v48, v48, v64
v_add_f32 v49, v49, v65
v_lshlrev_b32 v64, 16, v67
v_and_b32 v65, 0xffff0000, v67
v_add_f32 v50, v50, v64
v_add_f32 v51, v51, v65
LE_fl16:
s_nop 3
v_cvt_pk_bf16_f32 v64, v48, v49
v_cvt_pk_bf16_f32 v65, v50, v51
v_mov_b32 v48, 0
v_mov_b32 v49, 0
v_mov_b32 v50, 0
v_mov_b32 v51, 0
buffer_store_dwordx2 v[64:65], v39, s[20:23], s47 offen sc1
s_add_u32 s47, s47, 512
LE_nf16:
v_mfma_f32_16x16x32_bf16 v[48:51], a[136:139], v[40:43], v[48:51]
v_mfma_f32_16x16x32_bf16 v[48:51], a[140:143], v[44:47], v[48:51]
s_bitcmp1_b32 s46, 17
s_cbranch_scc0 LE_nf17
s_cmp_eq_u32 s42, 0
s_cbranch_scc1 LE_fl17
buffer_load_dwordx2 v[66:67], v39, s[20:23], s47 offen sc1
s_waitcnt vmcnt(0)
v_lshlrev_b32 v64, 16, v66
v_and_b32 v65, 0xffff0000, v66
v_add_f32 v48, v48, v64
v_add_f32 v49, v49, v65
v_lshlrev_b32 v64, 16, v67
v_and_b32 v65, 0xffff0000, v67
v_add_f32 v50, v50, v64
v_add_f32 v51, v51, v65
LE_fl17:
s_nop 3
v_cvt_pk_bf16_f32 v64, v48, v49
v_cvt_pk_bf16_f32 v65, v50, v51
v_mov_b32 v48, 0
v_mov_b32 v49, 0
v_mov_b32 v50, 0
v_mov_b32 v51, 0
buffer_store_dwordx2 v[64:65], v39, s[20:23], s47 offen sc1
s_add_u32 s47, s47, 512
LE_nf17:
v_mfma_f32_16x16x32_bf16 v[48:51], a[144:147], v[40:43], v[48:51]
v_mfma_f32_16x16x32_bf16 v[48:51], a[148:151], v[44:47], v[48:51]
s_bitcmp1_b32 s46, 18
s_cbranch_scc0 LE_nf18
s_cmp_eq_u32 s42, 0
s_cbranch_scc1 LE_fl18
buffer_load_dwordx2 v[66:67], v39, s[20:23], s47 offen sc1
s_waitcnt vmcnt(0)
v_lshlrev_b32 v64, 16, v66
v_and_b32 v65, 0xffff0000, v66
v_add_f32 v48, v48, v64
v_add_f32 v49, v49, v65
v_lshlrev_b32 v64, 16, v67
v_and_b32 v65, 0xffff0000, v67
v_add_f32 v50, v50, v64
v_add_f32 v51, v51, v65
LE_fl18:
s_nop 3
v_cvt_pk_bf16_f32 v64, v48, v49
v_cvt_pk_bf16_f32 v65, v50, v51
v_mov_b32 v48, 0
v_mov_b32 v49, 0
v_mov_b32 v50, 0
v_mov_b32 v51, 0
buffer_store_dwordx2 v[64:65], v39, s[20:23], s47 offen sc1
s_add_u32 s47, s47, 512
LE_nf18:
v_mfma_f32_16x16x32_bf16 v[48:51], a[152:155], v[40:43], v[48:51]
v_mfma_f32_16x16x32_bf16 v[48:51], a[156:159], v[44:47], v[48:51]
s_bitcmp1_b32 s46, 19
s_cbranch_scc0 LE_nf19
s_cmp_eq_u32 s42, 0
s_cbranch_scc1 LE_fl19
buffer_load_dwordx2 v[66:67], v39, s[20:23], s47 offen sc1
s_waitcnt vmcnt(0)
v_lshlrev_b32 v64, 16, v66
v_and_b32 v65, 0xffff0000, v66
v_add_f32 v48, v48, v64
v_add_f32 v49, v49, v65
v_lshlrev_b32 v64, 16, v67
v_and_b32 v65, 0xffff0000, v67
v_add_f32 v50, v50, v64
v_add_f32 v51, v51, v65
LE_fl19:
s_nop 3
v_cvt_pk_bf16_f32 v64, v48, v49
v_cvt_pk_bf16_f32 v65, v50, v51
v_mov_b32 v48, 0
v_mov_b32 v49, 0
v_mov_b32 v50, 0
v_mov_b32 v51, 0
buffer_store_dwordx2 v[64:65], v39, s[20:23], s47 offen sc1
s_add_u32 s47, s47, 512
LE_nf19:
s_waitcnt lgkmcnt(0)
ds_read2_b32 v[56:57], v34 offset0:80 offset1:84
ds_read2_b32 v[58:59], v34 offset0:88 offset1:92
v_mad_u32_u16 v60, v52, s49, v2
v_mad_u32_u16 v61, v53, s49, v2
v_mad_u32_u16 v62, v54, s49, v2
v_mad_u32_u16 v63, v55, s49, v2
buffer_load_dwordx4 a[128:131], v60, s[16:19], 0 offen sc1
buffer_load_dwordx4 a[132:135], v60, s[16:19], 0 offen offset:256 sc1
buffer_load_dwordx4 a[136:139], v61, s[16:19], 0 offen sc1
buffer_load_dwordx4 a[140:143], v61, s[16:19], 0 offen offset:256 sc1
buffer_load_dwordx4 a[144:147], v62, s[16:19], 0 offen sc1
buffer_load_dwordx4 a[148:151], v62, s[16:19], 0 offen offset:256 sc1
buffer_load_dwordx4 a[152:155], v63, s[16:19], 0 offen sc1
buffer_load_dwordx4 a[156:159], v63, s[16:19], 0 offen offset:256 sc1
s_waitcnt vmcnt(56)
v_mfma_f32_16x16x32_bf16 v[48:51], a[160:163], v[40:43], v[48:51]
v_mfma_f32_16x16x32_bf16 v[48:51], a[164:167], v[44:47], v[48:51]
s_bitcmp1_b32 s46, 20
s_cbranch_scc0 LE_nf20
s_cmp_eq_u32 s42, 0
s_cbranch_scc1 LE_fl20
buffer_load_dwordx2 v[66:67], v39, s[20:23], s47 offen sc1
s_waitcnt vmcnt(0)
v_lshlrev_b32 v64, 16, v66
v_and_b32 v65, 0xffff0000, v66
v_add_f32 v48, v48, v64
v_add_f32 v49, v49, v65
v_lshlrev_b32 v64, 16, v67
v_and_b32 v65, 0xffff0000, v67
v_add_f32 v50, v50, v64
v_add_f32 v51, v51, v65
LE_fl20:
s_nop 3
v_cvt_pk_bf16_f32 v64, v48, v49
v_cvt_pk_bf16_f32 v65, v50, v51
v_mov_b32 v48, 0
v_mov_b32 v49, 0
v_mov_b32 v50, 0
v_mov_b32 v51, 0
buffer_store_dwordx2 v[64:65], v39, s[20:23], s47 offen sc1
s_add_u32 s47, s47, 512
LE_nf20:
v_mfma_f32_16x16x32_bf16 v[48:51], a[168:171], v[40:43], v[48:51]
v_mfma_f32_16x16x32_bf16 v[48:51], a[172:175], v[44:47], v[48:51]
s_bitcmp1_b32 s46, 21
s_cbranch_scc0 LE_nf21
s_cmp_eq_u32 s42, 0
s_cbranch_scc1 LE_fl21
buffer_load_dwordx2 v[66:67], v39, s[20:23], s47 offen sc1
s_waitcnt vmcnt(0)
v_lshlrev_b32 v64, 16, v66
v_and_b32 v65, 0xffff0000, v66
v_add_f32 v48, v48, v64
v_add_f32 v49, v49, v65
v_lshlrev_b32 v64, 16, v67
v_and_b32 v65, 0xffff0000, v67
v_add_f32 v50, v50, v64
v_add_f32 v51, v51, v65
LE_fl21:
s_nop 3
v_cvt_pk_bf16_f32 v64, v48, v49
v_cvt_pk_bf16_f32 v65, v50, v51
v_mov_b32 v48, 0
v_mov_b32 v49, 0
v_mov_b32 v50, 0
v_mov_b32 v51, 0
buffer_store_dwordx2 v[64:65], v39, s[20:23], s47 offen sc1
s_add_u32 s47, s47, 512
LE_nf21:
v_mfma_f32_16x16x32_bf16 v[48:51], a[176:179], v[40:43], v[48:51]
v_mfma_f32_16x16x32_bf16 v[48:51], a[180:183], v[44:47], v[48:51]
s_bitcmp1_b32 s46, 22
s_cbranch_scc0 LE_nf22
s_cmp_eq_u32 s42, 0
s_cbranch_scc1 LE_fl22
buffer_load_dwordx2 v[66:67], v39, s[20:23], s47 offen sc1
s_waitcnt vmcnt(0)
v_lshlrev_b32 v64, 16, v66
v_and_b32 v65, 0xffff0000, v66
v_add_f32 v48, v48, v64
v_add_f32 v49, v49, v65
v_lshlrev_b32 v64, 16, v67
v_and_b32 v65, 0xffff0000, v67
v_add_f32 v50, v50, v64
v_add_f32 v51, v51, v65
LE_fl22:
s_nop 3
v_cvt_pk_bf16_f32 v64, v48, v49
v_cvt_pk_bf16_f32 v65, v50, v51
v_mov_b32 v48, 0
v_mov_b32 v49, 0
v_mov_b32 v50, 0
v_mov_b32 v51, 0
buffer_store_dwordx2 v[64:65], v39, s[20:23], s47 offen sc1
s_add_u32 s47, s47, 512
LE_nf22:
v_mfma_f32_16x16x32_bf16 v[48:51], a[184:187], v[40:43], v[48:51]
v_mfma_f32_16x16x32_bf16 v[48:51], a[188:191], v[44:47], v[48:51]
s_bitcmp1_b32 s46, 23
s_cbranch_scc0 LE_nf23
s_cmp_eq_u32 s42, 0
s_cbranch_scc1 LE_fl23
buffer_load_dwordx2 v[66:67], v39, s[20:23], s47 offen sc1
s_waitcnt vmcnt(0)
v_lshlrev_b32 v64, 16, v66
v_and_b32 v65, 0xffff0000, v66
v_add_f32 v48, v48, v64
v_add_f32 v49, v49, v65
v_lshlrev_b32 v64, 16, v67
v_and_b32 v65, 0xffff0000, v67
v_add_f32 v50, v50, v64
v_add_f32 v51, v51, v65
LE_fl23:
s_nop 3
v_cvt_pk_bf16_f32 v64, v48, v49
v_cvt_pk_bf16_f32 v65, v50, v51
v_mov_b32 v48, 0
v_mov_b32 v49, 0
v_mov_b32 v50, 0
v_mov_b32 v51, 0
buffer_store_dwordx2 v[64:65], v39, s[20:23], s47 offen sc1
s_add_u32 s47, s47, 512
LE_nf23:
s_waitcnt lgkmcnt(0)
ds_read2_b32 v[52:53], v34 offset0:96 offset1:100
ds_read2_b32 v[54:55], v34 offset0:104 offset1:108
v_mad_u32_u16 v60, v56, s49, v2
v_mad_u32_u16 v61, v57, s49, v2
v_mad_u32_u16 v62, v58, s49, v2
v_mad_u32_u16 v63, v59, s49, v2
buffer_load_dwordx4 a[160:163], v60, s[16:19], 0 offen sc1
buffer_load_dwordx4 a[164:167], v60, s[16:19], 0 offen offset:256 sc1
buffer_load_dwordx4 a[168:171], v61, s[16:19], 0 offen sc1
buffer_load_dwordx4 a[172:175], v61, s[16:19], 0 offen offset:256 sc1
buffer_load_dwordx4 a[176:179], v62, s[16:19], 0 offen sc1
buffer_load_dwordx4 a[180:183], v62, s[16:19], 0 offen offset:256 sc1
buffer_load_dwordx4 a[184:187], v63, s[16:19], 0 offen sc1
buffer_load_dwordx4 a[188:191], v63, s[16:19], 0 offen offset:256 sc1
s_waitcnt vmcnt(56)
v_mfma_f32_16x16x32_bf16 v[48:51], a[192:195], v[40:43], v[48:51]
v_mfma_f32_16x16x32_bf16 v[48:51], a[196:199], v[44:47], v[48:51]
s_bitcmp1_b32 s46, 24
s_cbranch_scc0 LE_nf24
s_cmp_eq_u32 s42, 0
s_cbranch_scc1 LE_fl24
buffer_load_dwordx2 v[66:67], v39, s[20:23], s47 offen sc1
s_waitcnt vmcnt(0)
v_lshlrev_b32 v64, 16, v66
v_and_b32 v65, 0xffff0000, v66
v_add_f32 v48, v48, v64
v_add_f32 v49, v49, v65
v_lshlrev_b32 v64, 16, v67
v_and_b32 v65, 0xffff0000, v67
v_add_f32 v50, v50, v64
v_add_f32 v51, v51, v65
LE_fl24:
s_nop 3
v_cvt_pk_bf16_f32 v64, v48, v49
v_cvt_pk_bf16_f32 v65, v50, v51
v_mov_b32 v48, 0
v_mov_b32 v49, 0
v_mov_b32 v50, 0
v_mov_b32 v51, 0
buffer_store_dwordx2 v[64:65], v39, s[20:23], s47 offen sc1
s_add_u32 s47, s47, 512
LE_nf24:
v_mfma_f32_16x16x32_bf16 v[48:51], a[200:203], v[40:43], v[48:51]
v_mfma_f32_16x16x32_bf16 v[48:51], a[204:207], v[44:47], v[48:51]
s_bitcmp1_b32 s46, 25
s_cbranch_scc0 LE_nf25
s_cmp_eq_u32 s42, 0
s_cbranch_scc1 LE_fl25
buffer_load_dwordx2 v[66:67], v39, s[20:23], s47 offen sc1
s_waitcnt vmcnt(0)
v_lshlrev_b32 v64, 16, v66
v_and_b32 v65, 0xffff0000, v66
v_add_f32 v48, v48, v64
v_add_f32 v49, v49, v65
v_lshlrev_b32 v64, 16, v67
v_and_b32 v65, 0xffff0000, v67
v_add_f32 v50, v50, v64
v_add_f32 v51, v51, v65
LE_fl25:
s_nop 3
v_cvt_pk_bf16_f32 v64, v48, v49
v_cvt_pk_bf16_f32 v65, v50, v51
v_mov_b32 v48, 0
v_mov_b32 v49, 0
v_mov_b32 v50, 0
v_mov_b32 v51, 0
buffer_store_dwordx2 v[64:65], v39, s[20:23], s47 offen sc1
s_add_u32 s47, s47, 512
LE_nf25:
v_mfma_f32_16x16x32_bf16 v[48:51], a[208:211], v[40:43], v[48:51]
v_mfma_f32_16x16x32_bf16 v[48:51], a[212:215], v[44:47], v[48:51]
s_bitcmp1_b32 s46, 26
s_cbranch_scc0 LE_nf26
s_cmp_eq_u32 s42, 0
s_cbranch_scc1 LE_fl26
buffer_load_dwordx2 v[66:67], v39, s[20:23], s47 offen sc1
s_waitcnt vmcnt(0)
v_lshlrev_b32 v64, 16, v66
v_and_b32 v65, 0xffff0000, v66
v_add_f32 v48, v48, v64
v_add_f32 v49, v49, v65
v_lshlrev_b32 v64, 16, v67
v_and_b32 v65, 0xffff0000, v67
v_add_f32 v50, v50, v64
v_add_f32 v51, v51, v65
LE_fl26:
s_nop 3
v_cvt_pk_bf16_f32 v64, v48, v49
v_cvt_pk_bf16_f32 v65, v50, v51
v_mov_b32 v48, 0
v_mov_b32 v49, 0
v_mov_b32 v50, 0
v_mov_b32 v51, 0
buffer_store_dwordx2 v[64:65], v39, s[20:23], s47 offen sc1
s_add_u32 s47, s47, 512
LE_nf26:
v_mfma_f32_16x16x32_bf16 v[48:51], a[216:219], v[40:43], v[48:51]
v_mfma_f32_16x16x32_bf16 v[48:51], a[220:223], v[44:47], v[48:51]
s_bitcmp1_b32 s46, 27
s_cbranch_scc0 LE_nf27
s_cmp_eq_u32 s42, 0
s_cbranch_scc1 LE_fl27
buffer_load_dwordx2 v[66:67], v39, s[20:23], s47 offen sc1
s_waitcnt vmcnt(0)
v_lshlrev_b32 v64, 16, v66
v_and_b32 v65, 0xffff0000, v66
v_add_f32 v48, v48, v64
v_add_f32 v49, v49, v65
v_lshlrev_b32 v64, 16, v67
v_and_b32 v65, 0xffff0000, v67
v_add_f32 v50, v50, v64
v_add_f32 v51, v51, v65
LE_fl27:
s_nop 3
v_cvt_pk_bf16_f32 v64, v48, v49
v_cvt_pk_bf16_f32 v65, v50, v51
v_mov_b32 v48, 0
v_mov_b32 v49, 0
v_mov_b32 v50, 0
v_mov_b32 v51, 0
buffer_store_dwordx2 v[64:65], v39, s[20:23], s47 offen sc1
s_add_u32 s47, s47, 512
LE_nf27:
s_waitcnt lgkmcnt(0)
ds_read2_b32 v[56:57], v34 offset0:112 offset1:116
ds_read2_b32 v[58:59], v34 offset0:120 offset1:124
v_mad_u32_u16 v60, v52, s49, v2
v_mad_u32_u16 v61, v53, s49, v2
v_mad_u32_u16 v62, v54, s49, v2
v_mad_u32_u16 v63, v55, s49, v2
buffer_load_dwordx4 a[192:195], v60, s[16:19], 0 offen sc1
buffer_load_dwordx4 a[196:199], v60, s[16:19], 0 offen offset:256 sc1
buffer_load_dwordx4 a[200:203], v61, s[16:19], 0 offen sc1
buffer_load_dwordx4 a[204:207], v61, s[16:19], 0 offen offset:256 sc1
buffer_load_dwordx4 a[208:211], v62, s[16:19], 0 offen sc1
buffer_load_dwordx4 a[212:215], v62, s[16:19], 0 offen offset:256 sc1
buffer_load_dwordx4 a[216:219], v63, s[16:19], 0 offen sc1
buffer_load_dwordx4 a[220:223], v63, s[16:19], 0 offen offset:256 sc1
s_waitcnt vmcnt(56)
v_mfma_f32_16x16x32_bf16 v[48:51], a[224:227], v[40:43], v[48:51]
v_mfma_f32_16x16x32_bf16 v[48:51], a[228:231], v[44:47], v[48:51]
s_bitcmp1_b32 s46, 28
s_cbranch_scc0 LE_nf28
s_cmp_eq_u32 s42, 0
s_cbranch_scc1 LE_fl28
buffer_load_dwordx2 v[66:67], v39, s[20:23], s47 offen sc1
s_waitcnt vmcnt(0)
v_lshlrev_b32 v64, 16, v66
v_and_b32 v65, 0xffff0000, v66
v_add_f32 v48, v48, v64
v_add_f32 v49, v49, v65
v_lshlrev_b32 v64, 16, v67
v_and_b32 v65, 0xffff0000, v67
v_add_f32 v50, v50, v64
v_add_f32 v51, v51, v65
LE_fl28:
s_nop 3
v_cvt_pk_bf16_f32 v64, v48, v49
v_cvt_pk_bf16_f32 v65, v50, v51
v_mov_b32 v48, 0
v_mov_b32 v49, 0
v_mov_b32 v50, 0
v_mov_b32 v51, 0
buffer_store_dwordx2 v[64:65], v39, s[20:23], s47 offen sc1
s_add_u32 s47, s47, 512
LE_nf28:
v_mfma_f32_16x16x32_bf16 v[48:51], a[232:235], v[40:43], v[48:51]
v_mfma_f32_16x16x32_bf16 v[48:51], a[236:239], v[44:47], v[48:51]
s_bitcmp1_b32 s46, 29
s_cbranch_scc0 LE_nf29
s_cmp_eq_u32 s42, 0
s_cbranch_scc1 LE_fl29
buffer_load_dwordx2 v[66:67], v39, s[20:23], s47 offen sc1
s_waitcnt vmcnt(0)
v_lshlrev_b32 v64, 16, v66
v_and_b32 v65, 0xffff0000, v66
v_add_f32 v48, v48, v64
v_add_f32 v49, v49, v65
v_lshlrev_b32 v64, 16, v67
v_and_b32 v65, 0xffff0000, v67
v_add_f32 v50, v50, v64
v_add_f32 v51, v51, v65
LE_fl29:
s_nop 3
v_cvt_pk_bf16_f32 v64, v48, v49
v_cvt_pk_bf16_f32 v65, v50, v51
v_mov_b32 v48, 0
v_mov_b32 v49, 0
v_mov_b32 v50, 0
v_mov_b32 v51, 0
buffer_store_dwordx2 v[64:65], v39, s[20:23], s47 offen sc1
s_add_u32 s47, s47, 512
LE_nf29:
v_mfma_f32_16x16x32_bf16 v[48:51], a[240:243], v[40:43], v[48:51]
v_mfma_f32_16x16x32_bf16 v[48:51], a[244:247], v[44:47], v[48:51]
s_bitcmp1_b32 s46, 30
s_cbranch_scc0 LE_nf30
s_cmp_eq_u32 s42, 0
s_cbranch_scc1 LE_fl30
buffer_load_dwordx2 v[66:67], v39, s[20:23], s47 offen sc1
s_waitcnt vmcnt(0)
v_lshlrev_b32 v64, 16, v66
v_and_b32 v65, 0xffff0000, v66
v_add_f32 v48, v48, v64
v_add_f32 v49, v49, v65
v_lshlrev_b32 v64, 16, v67
v_and_b32 v65, 0xffff0000, v67
v_add_f32 v50, v50, v64
v_add_f32 v51, v51, v65
LE_fl30:
s_nop 3
v_cvt_pk_bf16_f32 v64, v48, v49
v_cvt_pk_bf16_f32 v65, v50, v51
v_mov_b32 v48, 0
v_mov_b32 v49, 0
v_mov_b32 v50, 0
v_mov_b32 v51, 0
buffer_store_dwordx2 v[64:65], v39, s[20:23], s47 offen sc1
s_add_u32 s47, s47, 512
LE_nf30:
v_mfma_f32_16x16x32_bf16 v[48:51], a[248:251], v[40:43], v[48:51]
v_mfma_f32_16x16x32_bf16 v[48:51], a[252:255], v[44:47], v[48:51]
s_bitcmp1_b32 s46, 31
s_cbranch_scc0 LE_nf31
s_cmp_eq_u32 s42, 0
s_cbranch_scc1 LE_fl31
buffer_load_dwordx2 v[66:67], v39, s[20:23], s47 offen sc1
s_waitcnt vmcnt(0)
v_lshlrev_b32 v64, 16, v66
v_and_b32 v65, 0xffff0000, v66
v_add_f32 v48, v48, v64
v_add_f32 v49, v49, v65
v_lshlrev_b32 v64, 16, v67
v_and_b32 v65, 0xffff0000, v67
v_add_f32 v50, v50, v64
v_add_f32 v51, v51, v65
LE_fl31:
s_nop 3
v_cvt_pk_bf16_f32 v64, v48, v49
v_cvt_pk_bf16_f32 v65, v50, v51
v_mov_b32 v48, 0
v_mov_b32 v49, 0
v_mov_b32 v50, 0
v_mov_b32 v51, 0
buffer_store_dwordx2 v[64:65], v39, s[20:23], s47 offen sc1
s_add_u32 s47, s47, 512
LE_nf31:
s_waitcnt lgkmcnt(0)
ds_read2_b32 v[52:53], v34 offset0:128 offset1:132
ds_read2_b32 v[54:55], v34 offset0:136 offset1:140
v_mad_u32_u16 v60, v56, s49, v2
v_mad_u32_u16 v61, v57, s49, v2
v_mad_u32_u16 v62, v58, s49, v2
v_mad_u32_u16 v63, v59, s49, v2
buffer_load_dwordx4 a[224:227], v60, s[16:19], 0 offen sc1
buffer_load_dwordx4 a[228:231], v60, s[16:19], 0 offen offset:256 sc1
buffer_load_dwordx4 a[232:235], v61, s[16:19], 0 offen sc1
buffer_load_dwordx4 a[236:239], v61, s[16:19], 0 offen offset:256 sc1
buffer_load_dwordx4 a[240:243], v62, s[16:19], 0 offen sc1
buffer_load_dwordx4 a[244:247], v62, s[16:19], 0 offen offset:256 sc1
buffer_load_dwordx4 a[248:251], v63, s[16:19], 0 offen sc1
buffer_load_dwordx4 a[252:255], v63, s[16:19], 0 offen offset:256 sc1
v_add_u32 v34, 512, v34
s_cmp_lt_u32 s45, s44
s_cbranch_scc1 LE_loop
s_add_u32 s42, s42, 1
s_mul_i32 s43, s42, 256
v_cmp_lt_u32 vcc, s43, v4
s_cbranch_vccz LE_done
s_cmp_ge_u32 s42, 40
s_cbranch_scc1 LE_done
s_waitcnt vmcnt(0) lgkmcnt(0)
s_add_u32 s50, s50, 1024
v_add_u32 v5, 0x100, v5
buffer_load_dwordx4 v[192:195], v6, s[12:15], s50 offen offset:0 sc1
buffer_load_dwordx4 v[196:199], v6, s[12:15], s50 offen offset:64 sc1
buffer_load_dwordx4 v[200:203], v6, s[12:15], s50 offen offset:128 sc1
buffer_load_dwordx4 v[204:207], v6, s[12:15], s50 offen offset:192 sc1
buffer_load_dwordx4 v[208:211], v6, s[12:15], s50 offen offset:256 sc1
buffer_load_dwordx4 v[212:215], v6, s[12:15], s50 offen offset:320 sc1
buffer_load_dwordx4 v[216:219], v6, s[12:15], s50 offen offset:384 sc1
buffer_load_dwordx4 v[220:223], v6, s[12:15], s50 offen offset:448 sc1
buffer_load_dwordx4 v[224:227], v6, s[12:15], s50 offen offset:512 sc1
buffer_load_dwordx4 v[228:231], v6, s[12:15], s50 offen offset:576 sc1
buffer_load_dwordx4 v[232:235], v6, s[12:15], s50 offen offset:640 sc1
buffer_load_dwordx4 v[236:239], v6, s[12:15], s50 offen offset:704 sc1
buffer_load_dwordx4 v[240:243], v6, s[12:15], s50 offen offset:768 sc1
buffer_load_dwordx4 v[244:247], v6, s[12:15], s50 offen offset:832 sc1
buffer_load_dwordx4 v[248:251], v6, s[12:15], s50 offen offset:896 sc1
buffer_load_dwordx4 v[252:255], v6, s[12:15], s50 offen offset:960 sc1
s_branch LE_pass
LE_done:
s_add_u32 s24, s4, 0x7c00000
s_addc_u32 s25, s5, 0
s_mov_b32 s26, 0x40000
s_mov_b32 s27, 0x00020000
s_add_u32 s48, s40, 1280
s_mul_i32 s48, s48, 128
s_waitcnt vmcnt(0)
v_mov_b32 v32, s98
v_mov_b32 v33, s99
s_mov_b64 exec, 1
buffer_store_dwordx2 v[32:33], off, s[24:27], s48 sc1
s_mov_b64 exec, -1
s_branch L2_end
L2_fin:
L2_end:
s_endpgm
.section .rodata,"a"
.p2align 6
.amdhsa_kernel standalone__hybrid_graph_tf_graphgps__graph_kernel
  .amdhsa_next_free_vgpr 512
  .amdhsa_next_free_sgpr 102
  .amdhsa_accum_offset 256
  .amdhsa_group_segment_fixed_size 0
  .amdhsa_kernarg_size 96
  .amdhsa_user_sgpr_count 2
  .amdhsa_user_sgpr_kernarg_segment_ptr 1
  .amdhsa_system_sgpr_workgroup_id_x 1
.end_amdhsa_kernel
```

```asm
; @launch grid=(256,1,1) block=(256,1,1) lds=163840
.amdgcn_target "amdgcn-amd-amdhsa--gfx950"
.text
.globl standalone__hybrid_graph_tf_graphgps__graph_kernel
.p2align 8
.type standalone__hybrid_graph_tf_graphgps__graph_kernel,@function
standalone__hybrid_graph_tf_graphgps__graph_kernel:
s_getpc_b64 s[56:57]
s_load_dwordx16 s[16:31], s[0:1], 0
s_load_dwordx8 s[32:39], s[0:1], 64
s_cmp_ge_u32 s2, 256
s_cbranch_scc1 L2_end
v_lshrrev_b32 v1, 6, v0
v_and_b32 v2, 63, v0
s_lshr_b32 s3, s2, 3
s_add_u32 s3, s3, 30
s_and_b32 s3, s3, 31
v_readfirstlane_b32 s60, v1
s_lshl_b32 s5, s3, 2
s_add_u32 s5, s5, s60
s_and_b32 s56, s56, 0xffffff00
s_mov_b32 s58, L2_end-standalone__hybrid_graph_tf_graphgps__graph_kernel
s_mov_b32 s59, 0x00020000
s_and_b32 s6, s5, 15
s_lshl_b32 s6, s6, 13
v_lshlrev_b32 v10, 7, v2
buffer_load_dword v255, v10, s[56:59], s6 offen
v_and_b32 v3, 15, v2
v_lshrrev_b32 v4, 4, v2
s_and_b32 s62, s3, 7
s_mov_b64 s[14:15], 0
s_and_b32 s8, s2, 7
s_cmp_ge_u32 s3, 30
s_cbranch_scc1 LM_edge
s_mul_i32 s12, s3, 26
s_lshr_b32 s12, s12, 8
s_mul_i32 s9, s12, 10
s_sub_u32 s9, s3, s9
s_and_b32 s13, s8, 1
s_mul_i32 s13, s13, 3
s_add_u32 s13, s13, s12
s_lshr_b32 s12, s8, 1
s_mul_i32 s12, s12, 10
s_add_u32 s12, s12, s9
s_mul_i32 s91, s12, 6
s_add_u32 s91, s91, s13
s_mov_b32 s61, 0
s_cmp_eq_u32 s12, 39
s_cbranch_scc1 LM_light
s_mul_i32 s14, s13, 3
s_min_u32 s14, s14, 14
s_lshl_b32 s9, s12, 4
s_add_u32 s14, s14, s9
s_lshl_b32 s14, s14, 13
s_cmp_eq_u32 s91, 233
s_cselect_b32 s9, 0, s13
s_cmp_lt_u32 s9, 4
s_cselect_b32 s15, 3, 2
s_lshl_b32 s15, s15, 13
s_add_u32 s15, s15, s14
v_lshlrev_b32 v16, 4, v2
s_mul_i32 s63, s60, 12288
s_mov_b32 s6, s14
s_mul_i32 s7, s60, 6144
s_add_u32 s64, s6, s7
s_add_u32 s65, s64, 4096
s_lshl_b32 s7, s60, 7
v_lshrrev_b32 v5, 3, v2
v_and_b32 v6, 7, v2
v_and_b32 v7, 2, v5
v_xor_b32 v6, v6, v7
v_lshl_add_u32 v5, v5, 9, s7
v_lshl_add_u32 v17, v6, 4, v5
v_xor_b32 v6, 4, v6
v_lshl_add_u32 v18, v6, 4, v5
v_add_u32 v18, 0xc00, v18
v_add_u32 v19, 0x1800, v17
v_add_u32 v20, 0x1800, v18
s_xor_b32 s6, s62, 0
s_lshl_b32 s66, s6, 14
s_xor_b32 s6, s62, 1
s_lshl_b32 s67, s6, 14
s_xor_b32 s6, s62, 2
s_lshl_b32 s68, s6, 14
s_xor_b32 s6, s62, 3
s_lshl_b32 s69, s6, 14
s_xor_b32 s6, s62, 4
s_lshl_b32 s70, s6, 14
s_xor_b32 s6, s62, 5
s_lshl_b32 s71, s6, 14
s_xor_b32 s6, s62, 6
s_lshl_b32 s72, s6, 14
s_xor_b32 s6, s62, 7
s_lshl_b32 s73, s6, 14
s_waitcnt lgkmcnt(0)
s_add_u32 s40, s16, 0x0
s_addc_u32 s41, s17, 0
s_mov_b32 s42, s15
s_mov_b32 s43, 0x00020000
s_add_u32 s44, s26, 0x0
s_addc_u32 s45, s27, 0
s_mov_b32 s46, 0x20000
s_mov_b32 s47, 0x00020000
buffer_load_dwordx4 v[44:47], v16, s[40:43], s64 offen offset:0
buffer_load_dwordx4 v[48:51], v16, s[40:43], s64 offen offset:1024
buffer_load_dwordx4 v[52:55], v16, s[40:43], s64 offen offset:2048
buffer_load_dwordx4 v[56:59], v16, s[40:43], s64 offen offset:3072
buffer_load_dwordx4 v[60:63], v16, s[40:43], s65 offen offset:0
buffer_load_dwordx4 v[64:67], v16, s[40:43], s65 offen offset:1024
s_add_u32 m0, s63, 0x0
s_nop 0
buffer_load_dwordx4 v17, s[44:47], s66 offen offset:0 lds
buffer_load_dwordx4 v18, s[44:47], s66 offen offset:1024 lds
buffer_load_dwordx4 v19, s[44:47], s66 offen offset:2048 lds
buffer_load_dwordx4 v20, s[44:47], s66 offen offset:3072 lds
s_add_u32 m0, s63, 0x1000
s_nop 0
buffer_load_dwordx4 v17, s[44:47], s67 offen offset:0 lds
buffer_load_dwordx4 v18, s[44:47], s67 offen offset:1024 lds
buffer_load_dwordx4 v19, s[44:47], s67 offen offset:2048 lds
buffer_load_dwordx4 v20, s[44:47], s67 offen offset:3072 lds
s_mov_b32 s98, 0x7c3ff80
s_load_dwordx2 s[98:99], s[38:39], s98
v_bfe_u32 v5, v2, 2, 3
v_xor_b32 v5, s62, v5
v_and_b32 v6, 3, v2
v_lshlrev_b32 v7, 10, v5
v_lshl_add_u32 v7, v6, 8, v7
v_add_u32 v7, 0xc000, v7
v_and_b32 v5, 1, v5
v_lshl_or_b32 v6, v5, 2, v6
v_lshrrev_b32 v5, 5, v2
s_mul_i32 s6, s60, 12
v_add3_u32 v8, v5, s6, 0
v_lshrrev_b32 v9, 4, v8
v_lshl_add_u32 v9, v9, 13, v7
v_and_b32 v8, 15, v8
v_xor_b32 v8, v8, v6
v_lshl_add_u32 v36, v8, 4, v9
v_add3_u32 v8, v5, s6, 2
v_lshrrev_b32 v9, 4, v8
v_lshl_add_u32 v9, v9, 13, v7
v_and_b32 v8, 15, v8
v_xor_b32 v8, v8, v6
v_lshl_add_u32 v37, v8, 4, v9
v_add3_u32 v8, v5, s6, 4
v_lshrrev_b32 v9, 4, v8
v_lshl_add_u32 v9, v9, 13, v7
v_and_b32 v8, 15, v8
v_xor_b32 v8, v8, v6
v_lshl_add_u32 v38, v8, 4, v9
v_add3_u32 v8, v5, s6, 6
v_lshrrev_b32 v9, 4, v8
v_lshl_add_u32 v9, v9, 13, v7
v_and_b32 v8, 15, v8
v_xor_b32 v8, v8, v6
v_lshl_add_u32 v39, v8, 4, v9
v_add3_u32 v8, v5, s6, 8
v_lshrrev_b32 v9, 4, v8
v_lshl_add_u32 v9, v9, 13, v7
v_and_b32 v8, 15, v8
v_xor_b32 v8, v8, v6
v_lshl_add_u32 v40, v8, 4, v9
v_add3_u32 v8, v5, s6, 10
v_lshrrev_b32 v9, 4, v8
v_lshl_add_u32 v9, v9, 13, v7
v_and_b32 v8, 15, v8
v_xor_b32 v8, v8, v6
v_lshl_add_u32 v41, v8, 4, v9
v_xor_b32 v5, v3, v4
v_lshlrev_b32 v5, 4, v5
v_lshl_add_u32 v5, v4, 8, v5
v_add_u32 v31, 0xc000, v5
v_xor_b32 v32, 64, v31
v_lshrrev_b32 v5, 2, v3
v_and_b32 v6, 3, v3
v_and_b32 v7, 1, v4
v_lshlrev_b32 v7, 2, v7
v_and_b32 v8, 2, v5
v_or_b32 v7, v7, v8
v_lshl_add_u32 v8, v4, 3, v5
v_lshlrev_b32 v8, 7, v8
v_add_u32 v8, s63, v8
v_and_b32 v9, 1, v6
v_lshl_add_u32 v8, v9, 3, v8
v_lshrrev_b32 v6, 1, v6
v_xor_b32 v6, v6, v7
v_xor_b32 v9, 0, v6
v_lshl_add_u32 v25, v9, 4, v8
v_xor_b32 v9, 2, v6
v_lshl_add_u32 v26, v9, 4, v8
v_xor_b32 v9, 4, v6
v_lshl_add_u32 v27, v9, 4, v8
v_xor_b32 v9, 6, v6
v_lshl_add_u32 v28, v9, 4, v8
v_lshrrev_b32 v5, 3, v2
v_and_b32 v6, 7, v2
v_lshrrev_b32 v7, 1, v5
v_xor_b32 v6, v6, v7
v_and_b32 v7, 4, v5
v_add_u32 v5, v5, v7
s_mul_i32 s6, s60, 32768
v_lshl_add_u32 v5, v5, 9, s6
v_lshl_add_u32 v21, v6, 4, v5
v_xor_b32 v6, 4, v6
v_lshl_add_u32 v22, v6, 4, v5
v_add_u32 v22, 0x1c00, v22
v_mov_b32 v23, v21
v_mov_b32 v24, v22
s_lshr_b32 s7, s62, 1
s_xor_b32 s6, s7, 0
s_lshl_b32 s74, s6, 7
s_add_u32 s75, s74, 16384
s_xor_b32 s6, s7, 1
s_lshl_b32 s76, s6, 7
s_add_u32 s77, s76, 16384
s_xor_b32 s6, s7, 2
s_lshl_b32 s78, s6, 7
s_add_u32 s79, s78, 16384
s_xor_b32 s6, s7, 3
s_lshl_b32 s80, s6, 7
s_add_u32 s81, s80, 16384
s_and_b32 s6, s62, 1
s_lshl_b32 s6, s6, 2
v_lshrrev_b32 v5, 1, v3
v_xor_b32 v5, v5, v4
v_xor_b32 v5, s6, v5
v_lshl_add_u32 v6, v3, 7, s63
v_lshl_add_u32 v29, v5, 4, v6
v_xor_b32 v30, 64, v29
s_mul_i32 s6, s60, 2
s_xor_b32 s6, s6, s62
s_lshl_b32 s6, s6, 10
s_add_u32 s6, s6, 0x12000
v_lshrrev_b32 v5, 1, v4
v_and_b32 v6, 1, v4
v_lshl_add_u32 v5, v5, 8, s6
v_lshl_add_u32 v5, v6, 3, v5
v_lshl_add_u32 v33, v3, 4, v5
v_xor_b32 v34, 0x400, v33
v_add_u32 v35, 0x12000, v16
s_mov_b32 s6, s14
s_mul_i32 s7, s60, 2048
s_add_u32 s82, s6, s7
s_add_u32 s83, s82, 8192
s_add_u32 s84, s82, 16384
s_mov_b32 s86, 0x3db8aa3b
s_mov_b32 s87, 0x3db8aa3b
s_mov_b32 s88, 0x3727c5ac
s_mov_b32 s89, 0x3b800000
s_mov_b32 s90, 0xffff0000
s_add_u32 s48, s28, 0x0
s_addc_u32 s49, s29, 0
s_mov_b32 s50, 0x20000
s_mov_b32 s51, 0x00020000
s_add_u32 s52, s38, 0x0
s_addc_u32 s53, s39, 0
s_mov_b32 s54, s15
s_mov_b32 s55, 0x00020000
s_add_u32 s56, s38, 0x6800000
s_addc_u32 s57, s39, 0
s_mov_b32 s58, s15
s_mov_b32 s59, 0x00020000
s_waitcnt vmcnt(13)
v_lshlrev_b32 v116, 16, v44
v_and_b32 v117, s90, v44
v_lshlrev_b32 v118, 16, v45
v_and_b32 v119, s90, v45
v_lshlrev_b32 v120, 16, v46
v_and_b32 v121, s90, v46
v_lshlrev_b32 v122, 16, v47
v_and_b32 v123, s90, v47
v_pk_add_f32 v[164:165], v[116:117], v[118:119]
v_pk_mul_f32 v[166:167], v[116:117], v[116:117]
v_pk_add_f32 v[44:45], v[120:121], v[122:123]
v_pk_fma_f32 v[166:167], v[118:119], v[118:119], v[166:167]
v_pk_add_f32 v[164:165], v[164:165], v[44:45]
v_pk_fma_f32 v[166:167], v[120:121], v[120:121], v[166:167]
v_add_f32 v164, v164, v165
v_pk_fma_f32 v[166:167], v[122:123], v[122:123], v[166:167]
v_add_f32 v166, v166, v167
s_waitcnt vmcnt(12)
v_lshlrev_b32 v124, 16, v48
v_and_b32 v125, s90, v48
v_lshlrev_b32 v126, 16, v49
v_and_b32 v127, s90, v49
v_lshlrev_b32 v128, 16, v50
v_and_b32 v129, s90, v50
v_lshlrev_b32 v130, 16, v51
v_and_b32 v131, s90, v51
v_pk_add_f32 v[168:169], v[124:125], v[126:127]
v_pk_mul_f32 v[170:171], v[124:125], v[124:125]
v_pk_add_f32 v[48:49], v[128:129], v[130:131]
v_pk_fma_f32 v[170:171], v[126:127], v[126:127], v[170:171]
v_pk_add_f32 v[168:169], v[168:169], v[48:49]
v_pk_fma_f32 v[170:171], v[128:129], v[128:129], v[170:171]
v_add_f32 v168, v168, v169
v_pk_fma_f32 v[170:171], v[130:131], v[130:131], v[170:171]
v_add_f32 v170, v170, v171
s_waitcnt vmcnt(11)
v_lshlrev_b32 v132, 16, v52
v_and_b32 v133, s90, v52
v_lshlrev_b32 v134, 16, v53
v_and_b32 v135, s90, v53
v_lshlrev_b32 v136, 16, v54
v_and_b32 v137, s90, v54
v_lshlrev_b32 v138, 16, v55
v_and_b32 v139, s90, v55
v_pk_add_f32 v[172:173], v[132:133], v[134:135]
v_pk_mul_f32 v[174:175], v[132:133], v[132:133]
v_pk_add_f32 v[52:53], v[136:137], v[138:139]
v_pk_fma_f32 v[174:175], v[134:135], v[134:135], v[174:175]
v_pk_add_f32 v[172:173], v[172:173], v[52:53]
v_pk_fma_f32 v[174:175], v[136:137], v[136:137], v[174:175]
v_add_f32 v172, v172, v173
v_pk_fma_f32 v[174:175], v[138:139], v[138:139], v[174:175]
v_add_f32 v174, v174, v175
s_waitcnt vmcnt(10)
v_lshlrev_b32 v140, 16, v56
v_and_b32 v141, s90, v56
v_lshlrev_b32 v142, 16, v57
v_and_b32 v143, s90, v57
v_lshlrev_b32 v144, 16, v58
v_and_b32 v145, s90, v58
v_lshlrev_b32 v146, 16, v59
v_and_b32 v147, s90, v59
v_pk_add_f32 v[176:177], v[140:141], v[142:143]
v_pk_mul_f32 v[178:179], v[140:141], v[140:141]
v_pk_add_f32 v[56:57], v[144:145], v[146:147]
v_pk_fma_f32 v[178:179], v[142:143], v[142:143], v[178:179]
v_pk_add_f32 v[176:177], v[176:177], v[56:57]
v_pk_fma_f32 v[178:179], v[144:145], v[144:145], v[178:179]
v_add_f32 v176, v176, v177
v_pk_fma_f32 v[178:179], v[146:147], v[146:147], v[178:179]
v_add_f32 v178, v178, v179
s_waitcnt vmcnt(9)
v_lshlrev_b32 v148, 16, v60
v_and_b32 v149, s90, v60
v_lshlrev_b32 v150, 16, v61
v_and_b32 v151, s90, v61
v_lshlrev_b32 v152, 16, v62
v_and_b32 v153, s90, v62
v_lshlrev_b32 v154, 16, v63
v_and_b32 v155, s90, v63
v_pk_add_f32 v[180:181], v[148:149], v[150:151]
v_pk_mul_f32 v[182:183], v[148:149], v[148:149]
v_pk_add_f32 v[60:61], v[152:153], v[154:155]
v_pk_fma_f32 v[182:183], v[150:151], v[150:151], v[182:183]
v_pk_add_f32 v[180:181], v[180:181], v[60:61]
v_pk_fma_f32 v[182:183], v[152:153], v[152:153], v[182:183]
v_add_f32 v180, v180, v181
v_pk_fma_f32 v[182:183], v[154:155], v[154:155], v[182:183]
v_add_f32 v182, v182, v183
s_waitcnt vmcnt(8)
v_lshlrev_b32 v156, 16, v64
v_and_b32 v157, s90, v64
v_lshlrev_b32 v158, 16, v65
v_and_b32 v159, s90, v65
v_lshlrev_b32 v160, 16, v66
v_and_b32 v161, s90, v66
v_lshlrev_b32 v162, 16, v67
v_and_b32 v163, s90, v67
v_pk_add_f32 v[184:185], v[156:157], v[158:159]
v_pk_mul_f32 v[186:187], v[156:157], v[156:157]
v_pk_add_f32 v[64:65], v[160:161], v[162:163]
v_pk_fma_f32 v[186:187], v[158:159], v[158:159], v[186:187]
v_pk_add_f32 v[184:185], v[184:185], v[64:65]
v_pk_fma_f32 v[186:187], v[160:161], v[160:161], v[186:187]
v_add_f32 v184, v184, v185
v_pk_fma_f32 v[186:187], v[162:163], v[162:163], v[186:187]
v_add_f32 v186, v186, v187
v_permlane16_swap_b32 v164, v166
v_permlane16_swap_b32 v168, v170
v_permlane16_swap_b32 v172, v174
v_permlane16_swap_b32 v176, v178
v_permlane16_swap_b32 v180, v182
v_permlane16_swap_b32 v184, v186
v_add_f32 v164, v164, v166
v_add_f32 v168, v168, v170
v_add_f32 v172, v172, v174
v_add_f32 v176, v176, v178
v_add_f32 v180, v180, v182
v_add_f32 v184, v184, v186
v_add_f32_dpp v165, v164, v164 row_ror:8 row_mask:0xf bank_mask:0x3
v_add_f32_dpp v165, v168, v168 row_ror:8 row_mask:0xf bank_mask:0xc
v_add_f32_dpp v173, v172, v172 row_ror:8 row_mask:0xf bank_mask:0x3
v_add_f32_dpp v173, v176, v176 row_ror:8 row_mask:0xf bank_mask:0xc
v_add_f32_dpp v181, v180, v180 row_ror:8 row_mask:0xf bank_mask:0x3
v_add_f32_dpp v181, v184, v184 row_ror:8 row_mask:0xf bank_mask:0xc
v_add_f32_dpp v166, v165, v165 row_half_mirror row_mask:0xf bank_mask:0x5
v_add_f32_dpp v166, v173, v173 row_half_mirror row_mask:0xf bank_mask:0xa
v_add_f32_dpp v182, v181, v181 row_half_mirror row_mask:0xf bank_mask:0xf
s_nop 0
v_add_f32_dpp v166, v166, v166 quad_perm:[1,0,3,2] row_mask:0xf bank_mask:0xf
v_add_f32_dpp v182, v182, v182 quad_perm:[1,0,3,2] row_mask:0xf bank_mask:0xf
s_nop 0
v_add_f32_dpp v166, v166, v166 quad_perm:[2,3,0,1] row_mask:0xf bank_mask:0xf
v_add_f32_dpp v182, v182, v182 quad_perm:[2,3,0,1] row_mask:0xf bank_mask:0xf
v_mov_b32 v167, v166
v_mov_b32 v183, v182
s_nop 0
v_permlane16_swap_b32 v167, v166
v_permlane16_swap_b32 v183, v182
v_mul_f32 v167, s89, v167
v_mul_f32 v183, s89, v183
v_mul_f32 v166, s89, v166
v_mul_f32 v182, s89, v182
v_fma_f32 v166, -v167, v167, v166
v_fma_f32 v182, -v183, v183, v182
v_cvt_pk_bf16_f32 v167, v167, v167
v_cvt_pk_bf16_f32 v183, v183, v183
v_max_f32 v166, 0, v166
v_max_f32 v182, 0, v182
v_cvt_pk_bf16_f32 v166, v166, v166
v_cvt_pk_bf16_f32 v182, v182, v182
v_and_b32 v166, s90, v166
v_and_b32 v182, s90, v182
v_add_f32 v166, s88, v166
v_add_f32 v182, s88, v182
v_cvt_pk_bf16_f32 v166, v166, v166
v_cvt_pk_bf16_f32 v182, v182, v182
v_and_b32 v166, s90, v166
v_and_b32 v182, s90, v182
v_sqrt_f32 v166, v166
v_sqrt_f32 v182, v182
v_and_b32 v167, s90, v167
v_and_b32 v183, s90, v183
v_cvt_pk_bf16_f32 v166, v166, v166
v_cvt_pk_bf16_f32 v182, v182, v182
v_and_b32 v166, s90, v166
v_and_b32 v182, s90, v182
v_rcp_f32 v166, v166
v_rcp_f32 v182, v182
v_mul_f32 v167, -v167, v166
v_mul_f32 v183, -v183, v182
s_nop 0
v_mov_b64_dpp v[164:165], v[166:167] row_newbcast:0 row_mask:0xf bank_mask:0xf
v_mov_b64_dpp v[168:169], v[166:167] row_newbcast:8 row_mask:0xf bank_mask:0xf
v_mov_b64_dpp v[172:173], v[166:167] row_newbcast:4 row_mask:0xf bank_mask:0xf
v_mov_b64_dpp v[176:177], v[166:167] row_newbcast:12 row_mask:0xf bank_mask:0xf
v_mov_b64_dpp v[180:181], v[182:183] row_newbcast:0 row_mask:0xf bank_mask:0xf
v_mov_b64_dpp v[184:185], v[182:183] row_newbcast:8 row_mask:0xf bank_mask:0xf
v_fma_f32 v116, v116, v164, v165
v_fma_f32 v117, v117, v164, v165
v_fma_f32 v118, v118, v164, v165
v_fma_f32 v119, v119, v164, v165
v_fma_f32 v120, v120, v164, v165
v_fma_f32 v121, v121, v164, v165
v_fma_f32 v122, v122, v164, v165
v_fma_f32 v123, v123, v164, v165
v_cvt_pk_bf16_f32 v44, v116, v117
v_cvt_pk_bf16_f32 v45, v118, v119
v_cvt_pk_bf16_f32 v46, v120, v121
v_cvt_pk_bf16_f32 v47, v122, v123
ds_write_b128 v36, v[44:47]
v_fma_f32 v124, v124, v168, v169
v_fma_f32 v125, v125, v168, v169
v_fma_f32 v126, v126, v168, v169
v_fma_f32 v127, v127, v168, v169
v_fma_f32 v128, v128, v168, v169
v_fma_f32 v129, v129, v168, v169
v_fma_f32 v130, v130, v168, v169
v_fma_f32 v131, v131, v168, v169
v_cvt_pk_bf16_f32 v48, v124, v125
v_cvt_pk_bf16_f32 v49, v126, v127
v_cvt_pk_bf16_f32 v50, v128, v129
v_cvt_pk_bf16_f32 v51, v130, v131
ds_write_b128 v37, v[48:51]
v_fma_f32 v132, v132, v172, v173
v_fma_f32 v133, v133, v172, v173
v_fma_f32 v134, v134, v172, v173
v_fma_f32 v135, v135, v172, v173
v_fma_f32 v136, v136, v172, v173
v_fma_f32 v137, v137, v172, v173
v_fma_f32 v138, v138, v172, v173
v_fma_f32 v139, v139, v172, v173
v_cvt_pk_bf16_f32 v52, v132, v133
v_cvt_pk_bf16_f32 v53, v134, v135
v_cvt_pk_bf16_f32 v54, v136, v137
v_cvt_pk_bf16_f32 v55, v138, v139
ds_write_b128 v38, v[52:55]
v_fma_f32 v140, v140, v176, v177
v_fma_f32 v141, v141, v176, v177
v_fma_f32 v142, v142, v176, v177
v_fma_f32 v143, v143, v176, v177
v_fma_f32 v144, v144, v176, v177
v_fma_f32 v145, v145, v176, v177
v_fma_f32 v146, v146, v176, v177
v_fma_f32 v147, v147, v176, v177
v_cvt_pk_bf16_f32 v56, v140, v141
v_cvt_pk_bf16_f32 v57, v142, v143
v_cvt_pk_bf16_f32 v58, v144, v145
v_cvt_pk_bf16_f32 v59, v146, v147
ds_write_b128 v39, v[56:59]
v_fma_f32 v148, v148, v180, v181
v_fma_f32 v149, v149, v180, v181
v_fma_f32 v150, v150, v180, v181
v_fma_f32 v151, v151, v180, v181
v_fma_f32 v152, v152, v180, v181
v_fma_f32 v153, v153, v180, v181
v_fma_f32 v154, v154, v180, v181
v_fma_f32 v155, v155, v180, v181
v_cvt_pk_bf16_f32 v60, v148, v149
v_cvt_pk_bf16_f32 v61, v150, v151
v_cvt_pk_bf16_f32 v62, v152, v153
v_cvt_pk_bf16_f32 v63, v154, v155
ds_write_b128 v40, v[60:63]
v_fma_f32 v156, v156, v184, v185
v_fma_f32 v157, v157, v184, v185
v_fma_f32 v158, v158, v184, v185
v_fma_f32 v159, v159, v184, v185
v_fma_f32 v160, v160, v184, v185
v_fma_f32 v161, v161, v184, v185
v_fma_f32 v162, v162, v184, v185
v_fma_f32 v163, v163, v184, v185
v_cvt_pk_bf16_f32 v64, v156, v157
v_cvt_pk_bf16_f32 v65, v158, v159
v_cvt_pk_bf16_f32 v66, v160, v161
v_cvt_pk_bf16_f32 v67, v162, v163
ds_write_b128 v41, v[64:67]
s_add_u32 m0, s63, 0x2000
s_nop 0
buffer_load_dwordx4 v17, s[44:47], s68 offen offset:0 lds
buffer_load_dwordx4 v18, s[44:47], s68 offen offset:1024 lds
buffer_load_dwordx4 v19, s[44:47], s68 offen offset:2048 lds
buffer_load_dwordx4 v20, s[44:47], s68 offen offset:3072 lds
s_waitcnt vmcnt(8)
ds_read_b64_tr_b16 v[164:165], v25 offset:0
ds_read_b64_tr_b16 v[166:167], v25 offset:512
ds_read_b64_tr_b16 v[168:169], v26 offset:0
ds_read_b64_tr_b16 v[170:171], v26 offset:512
ds_read_b64_tr_b16 v[172:173], v27 offset:0
ds_read_b64_tr_b16 v[174:175], v27 offset:512
s_waitcnt lgkmcnt(6)
s_barrier
ds_read_b128 v[204:207], v31 offset:0
ds_read_b128 v[208:211], v31 offset:8192
ds_read_b128 v[212:215], v31 offset:16384
s_waitcnt lgkmcnt(2)
v_mfma_f32_16x16x32_bf16 v[68:71], v[164:167], v[204:207], 0
s_waitcnt lgkmcnt(1)
v_mfma_f32_16x16x32_bf16 v[72:75], v[164:167], v[208:211], 0
s_waitcnt lgkmcnt(0)
v_mfma_f32_16x16x32_bf16 v[76:79], v[164:167], v[212:215], 0
ds_read_b64_tr_b16 v[176:177], v28 offset:0
ds_read_b64_tr_b16 v[178:179], v28 offset:512
v_mfma_f32_16x16x32_bf16 v[80:83], v[168:171], v[204:207], 0
v_mfma_f32_16x16x32_bf16 v[84:87], v[168:171], v[208:211], 0
v_mfma_f32_16x16x32_bf16 v[88:91], v[168:171], v[212:215], 0
ds_read_b128 v[216:219], v32 offset:1024
s_waitcnt vmcnt(4)
ds_read_b64_tr_b16 v[180:181], v25 offset:4096
ds_read_b64_tr_b16 v[182:183], v25 offset:4608
v_mfma_f32_16x16x32_bf16 v[92:95], v[172:175], v[204:207], 0
ds_read_b128 v[220:223], v32 offset:9216
v_mfma_f32_16x16x32_bf16 v[96:99], v[172:175], v[208:211], 0
ds_read_b128 v[224:227], v32 offset:17408
v_mfma_f32_16x16x32_bf16 v[100:103], v[172:175], v[212:215], 0
ds_read_b64_tr_b16 v[184:185], v26 offset:4096
ds_read_b64_tr_b16 v[186:187], v26 offset:4608
s_waitcnt lgkmcnt(7)
v_mfma_f32_16x16x32_bf16 v[104:107], v[176:179], v[204:207], 0
s_add_u32 m0, s63, 0x0
s_nop 0
buffer_load_dwordx4 v17, s[44:47], s69 offen offset:0 lds
buffer_load_dwordx4 v18, s[44:47], s69 offen offset:1024 lds
buffer_load_dwordx4 v19, s[44:47], s69 offen offset:2048 lds
buffer_load_dwordx4 v20, s[44:47], s69 offen offset:3072 lds
v_mfma_f32_16x16x32_bf16 v[108:111], v[176:179], v[208:211], 0
v_mfma_f32_16x16x32_bf16 v[112:115], v[176:179], v[212:215], 0
ds_read_b64_tr_b16 v[188:189], v27 offset:4096
ds_read_b64_tr_b16 v[190:191], v27 offset:4608
s_waitcnt lgkmcnt(6)
v_mfma_f32_16x16x32_bf16 v[68:71], v[180:183], v[216:219], v[68:71]
s_waitcnt lgkmcnt(5)
v_mfma_f32_16x16x32_bf16 v[72:75], v[180:183], v[220:223], v[72:75]
s_waitcnt lgkmcnt(4)
v_mfma_f32_16x16x32_bf16 v[76:79], v[180:183], v[224:227], v[76:79]
ds_read_b64_tr_b16 v[192:193], v28 offset:4096
ds_read_b64_tr_b16 v[194:195], v28 offset:4608
s_waitcnt lgkmcnt(4)
v_mfma_f32_16x16x32_bf16 v[80:83], v[184:187], v[216:219], v[80:83]
v_mfma_f32_16x16x32_bf16 v[84:87], v[184:187], v[220:223], v[84:87]
v_mfma_f32_16x16x32_bf16 v[88:91], v[184:187], v[224:227], v[88:91]
ds_read_b128 v[228:231], v31 offset:2048
s_waitcnt vmcnt(4)
ds_read_b64_tr_b16 v[196:197], v25 offset:8192
ds_read_b64_tr_b16 v[198:199], v25 offset:8704
s_waitcnt lgkmcnt(5)
v_mfma_f32_16x16x32_bf16 v[92:95], v[188:191], v[216:219], v[92:95]
ds_read_b128 v[232:235], v31 offset:10240
v_mfma_f32_16x16x32_bf16 v[96:99], v[188:191], v[220:223], v[96:99]
ds_read_b128 v[236:239], v31 offset:18432
v_mfma_f32_16x16x32_bf16 v[100:103], v[188:191], v[224:227], v[100:103]
ds_read_b64_tr_b16 v[200:201], v26 offset:8192
ds_read_b64_tr_b16 v[202:203], v26 offset:8704
s_waitcnt lgkmcnt(7)
v_mfma_f32_16x16x32_bf16 v[104:107], v[192:195], v[216:219], v[104:107]
s_add_u32 m0, s63, 0x1000
s_nop 0
buffer_load_dwordx4 v17, s[44:47], s70 offen offset:0 lds
buffer_load_dwordx4 v18, s[44:47], s70 offen offset:1024 lds
buffer_load_dwordx4 v19, s[44:47], s70 offen offset:2048 lds
buffer_load_dwordx4 v20, s[44:47], s70 offen offset:3072 lds
v_mfma_f32_16x16x32_bf16 v[108:111], v[192:195], v[220:223], v[108:111]
v_mfma_f32_16x16x32_bf16 v[112:115], v[192:195], v[224:227], v[112:115]
ds_read_b64_tr_b16 v[164:165], v27 offset:8192
ds_read_b64_tr_b16 v[166:167], v27 offset:8704
s_waitcnt lgkmcnt(6)
v_mfma_f32_16x16x32_bf16 v[68:71], v[196:199], v[228:231], v[68:71]
s_waitcnt lgkmcnt(5)
v_mfma_f32_16x16x32_bf16 v[72:75], v[196:199], v[232:235], v[72:75]
s_waitcnt lgkmcnt(4)
v_mfma_f32_16x16x32_bf16 v[76:79], v[196:199], v[236:239], v[76:79]
ds_read_b64_tr_b16 v[168:169], v28 offset:8192
ds_read_b64_tr_b16 v[170:171], v28 offset:8704
s_waitcnt lgkmcnt(4)
v_mfma_f32_16x16x32_bf16 v[80:83], v[200:203], v[228:231], v[80:83]
v_mfma_f32_16x16x32_bf16 v[84:87], v[200:203], v[232:235], v[84:87]
v_mfma_f32_16x16x32_bf16 v[88:91], v[200:203], v[236:239], v[88:91]
ds_read_b128 v[204:207], v32 offset:3072
s_waitcnt vmcnt(4)
ds_read_b64_tr_b16 v[172:173], v25 offset:0
ds_read_b64_tr_b16 v[174:175], v25 offset:512
s_waitcnt lgkmcnt(5)
v_mfma_f32_16x16x32_bf16 v[92:95], v[164:167], v[228:231], v[92:95]
ds_read_b128 v[208:211], v32 offset:11264
v_mfma_f32_16x16x32_bf16 v[96:99], v[164:167], v[232:235], v[96:99]
ds_read_b128 v[212:215], v32 offset:19456
v_mfma_f32_16x16x32_bf16 v[100:103], v[164:167], v[236:239], v[100:103]
ds_read_b64_tr_b16 v[176:177], v26 offset:0
ds_read_b64_tr_b16 v[178:179], v26 offset:512
s_waitcnt lgkmcnt(7)
v_mfma_f32_16x16x32_bf16 v[104:107], v[168:171], v[228:231], v[104:107]
s_add_u32 m0, s63, 0x2000
s_nop 0
buffer_load_dwordx4 v17, s[44:47], s71 offen offset:0 lds
buffer_load_dwordx4 v18, s[44:47], s71 offen offset:1024 lds
buffer_load_dwordx4 v19, s[44:47], s71 offen offset:2048 lds
buffer_load_dwordx4 v20, s[44:47], s71 offen offset:3072 lds
v_mfma_f32_16x16x32_bf16 v[108:111], v[168:171], v[232:235], v[108:111]
v_mfma_f32_16x16x32_bf16 v[112:115], v[168:171], v[236:239], v[112:115]
ds_read_b64_tr_b16 v[180:181], v27 offset:0
ds_read_b64_tr_b16 v[182:183], v27 offset:512
s_waitcnt lgkmcnt(6)
v_mfma_f32_16x16x32_bf16 v[68:71], v[172:175], v[204:207], v[68:71]
s_waitcnt lgkmcnt(5)
v_mfma_f32_16x16x32_bf16 v[72:75], v[172:175], v[208:211], v[72:75]
s_waitcnt lgkmcnt(4)
v_mfma_f32_16x16x32_bf16 v[76:79], v[172:175], v[212:215], v[76:79]
ds_read_b64_tr_b16 v[184:185], v28 offset:0
ds_read_b64_tr_b16 v[186:187], v28 offset:512
s_waitcnt lgkmcnt(4)
v_mfma_f32_16x16x32_bf16 v[80:83], v[176:179], v[204:207], v[80:83]
v_mfma_f32_16x16x32_bf16 v[84:87], v[176:179], v[208:211], v[84:87]
v_mfma_f32_16x16x32_bf16 v[88:91], v[176:179], v[212:215], v[88:91]
ds_read_b128 v[216:219], v31 offset:4096
s_waitcnt vmcnt(4)
ds_read_b64_tr_b16 v[188:189], v25 offset:4096
ds_read_b64_tr_b16 v[190:191], v25 offset:4608
s_waitcnt lgkmcnt(5)
v_mfma_f32_16x16x32_bf16 v[92:95], v[180:183], v[204:207], v[92:95]
ds_read_b128 v[220:223], v31 offset:12288
v_mfma_f32_16x16x32_bf16 v[96:99], v[180:183], v[208:211], v[96:99]
ds_read_b128 v[224:227], v31 offset:20480
v_mfma_f32_16x16x32_bf16 v[100:103], v[180:183], v[212:215], v[100:103]
ds_read_b64_tr_b16 v[192:193], v26 offset:4096
ds_read_b64_tr_b16 v[194:195], v26 offset:4608
s_waitcnt lgkmcnt(7)
v_mfma_f32_16x16x32_bf16 v[104:107], v[184:187], v[204:207], v[104:107]
s_add_u32 m0, s63, 0x0
s_nop 0
buffer_load_dwordx4 v17, s[44:47], s72 offen offset:0 lds
buffer_load_dwordx4 v18, s[44:47], s72 offen offset:1024 lds
buffer_load_dwordx4 v19, s[44:47], s72 offen offset:2048 lds
buffer_load_dwordx4 v20, s[44:47], s72 offen offset:3072 lds
v_mfma_f32_16x16x32_bf16 v[108:111], v[184:187], v[208:211], v[108:111]
v_mfma_f32_16x16x32_bf16 v[112:115], v[184:187], v[212:215], v[112:115]
ds_read_b64_tr_b16 v[196:197], v27 offset:4096
ds_read_b64_tr_b16 v[198:199], v27 offset:4608
s_waitcnt lgkmcnt(6)
v_mfma_f32_16x16x32_bf16 v[68:71], v[188:191], v[216:219], v[68:71]
s_waitcnt lgkmcnt(5)
v_mfma_f32_16x16x32_bf16 v[72:75], v[188:191], v[220:223], v[72:75]
s_waitcnt lgkmcnt(4)
v_mfma_f32_16x16x32_bf16 v[76:79], v[188:191], v[224:227], v[76:79]
ds_read_b64_tr_b16 v[200:201], v28 offset:4096
ds_read_b64_tr_b16 v[202:203], v28 offset:4608
s_waitcnt lgkmcnt(4)
v_mfma_f32_16x16x32_bf16 v[80:83], v[192:195], v[216:219], v[80:83]
v_mfma_f32_16x16x32_bf16 v[84:87], v[192:195], v[220:223], v[84:87]
v_mfma_f32_16x16x32_bf16 v[88:91], v[192:195], v[224:227], v[88:91]
ds_read_b128 v[228:231], v32 offset:5120
s_waitcnt vmcnt(4)
ds_read_b64_tr_b16 v[164:165], v25 offset:8192
ds_read_b64_tr_b16 v[166:167], v25 offset:8704
s_waitcnt lgkmcnt(5)
v_mfma_f32_16x16x32_bf16 v[92:95], v[196:199], v[216:219], v[92:95]
ds_read_b128 v[232:235], v32 offset:13312
v_mfma_f32_16x16x32_bf16 v[96:99], v[196:199], v[220:223], v[96:99]
ds_read_b128 v[236:239], v32 offset:21504
v_mfma_f32_16x16x32_bf16 v[100:103], v[196:199], v[224:227], v[100:103]
ds_read_b64_tr_b16 v[168:169], v26 offset:8192
ds_read_b64_tr_b16 v[170:171], v26 offset:8704
s_waitcnt lgkmcnt(7)
v_mfma_f32_16x16x32_bf16 v[104:107], v[200:203], v[216:219], v[104:107]
s_add_u32 m0, s63, 0x1000
s_nop 0
buffer_load_dwordx4 v17, s[44:47], s73 offen offset:0 lds
buffer_load_dwordx4 v18, s[44:47], s73 offen offset:1024 lds
buffer_load_dwordx4 v19, s[44:47], s73 offen offset:2048 lds
buffer_load_dwordx4 v20, s[44:47], s73 offen offset:3072 lds
v_mfma_f32_16x16x32_bf16 v[108:111], v[200:203], v[220:223], v[108:111]
v_mfma_f32_16x16x32_bf16 v[112:115], v[200:203], v[224:227], v[112:115]
ds_read_b64_tr_b16 v[172:173], v27 offset:8192
ds_read_b64_tr_b16 v[174:175], v27 offset:8704
s_waitcnt lgkmcnt(6)
v_mfma_f32_16x16x32_bf16 v[68:71], v[164:167], v[228:231], v[68:71]
s_waitcnt lgkmcnt(5)
v_mfma_f32_16x16x32_bf16 v[72:75], v[164:167], v[232:235], v[72:75]
s_waitcnt lgkmcnt(4)
v_mfma_f32_16x16x32_bf16 v[76:79], v[164:167], v[236:239], v[76:79]
ds_read_b64_tr_b16 v[176:177], v28 offset:8192
ds_read_b64_tr_b16 v[178:179], v28 offset:8704
s_waitcnt lgkmcnt(4)
v_mfma_f32_16x16x32_bf16 v[80:83], v[168:171], v[228:231], v[80:83]
v_mfma_f32_16x16x32_bf16 v[84:87], v[168:171], v[232:235], v[84:87]
v_mfma_f32_16x16x32_bf16 v[88:91], v[168:171], v[236:239], v[88:91]
ds_read_b128 v[204:207], v31 offset:6144
s_waitcnt vmcnt(4)
ds_read_b64_tr_b16 v[180:181], v25 offset:0
ds_read_b64_tr_b16 v[182:183], v25 offset:512
s_waitcnt lgkmcnt(5)
v_mfma_f32_16x16x32_bf16 v[92:95], v[172:175], v[228:231], v[92:95]
ds_read_b128 v[208:211], v31 offset:14336
v_mfma_f32_16x16x32_bf16 v[96:99], v[172:175], v[232:235], v[96:99]
ds_read_b128 v[212:215], v31 offset:22528
v_mfma_f32_16x16x32_bf16 v[100:103], v[172:175], v[236:239], v[100:103]
ds_read_b64_tr_b16 v[184:185], v26 offset:0
ds_read_b64_tr_b16 v[186:187], v26 offset:512
s_waitcnt lgkmcnt(7)
v_mfma_f32_16x16x32_bf16 v[104:107], v[176:179], v[228:231], v[104:107]
s_add_u32 m0, s63, 0x2000
s_nop 0
buffer_load_dwordx4 v21, s[48:51], s74 offen offset:0 lds
buffer_load_dwordx4 v22, s[48:51], s74 offen offset:1024 lds
buffer_load_dwordx4 v23, s[48:51], s74 offen offset:2048 lds
buffer_load_dwordx4 v24, s[48:51], s74 offen offset:3072 lds
v_mfma_f32_16x16x32_bf16 v[108:111], v[176:179], v[232:235], v[108:111]
v_mfma_f32_16x16x32_bf16 v[112:115], v[176:179], v[236:239], v[112:115]
ds_read_b64_tr_b16 v[188:189], v27 offset:0
ds_read_b64_tr_b16 v[190:191], v27 offset:512
s_waitcnt lgkmcnt(6)
v_mfma_f32_16x16x32_bf16 v[68:71], v[180:183], v[204:207], v[68:71]
s_waitcnt lgkmcnt(5)
v_mfma_f32_16x16x32_bf16 v[72:75], v[180:183], v[208:211], v[72:75]
s_waitcnt lgkmcnt(4)
v_mfma_f32_16x16x32_bf16 v[76:79], v[180:183], v[212:215], v[76:79]
ds_read_b64_tr_b16 v[192:193], v28 offset:0
ds_read_b64_tr_b16 v[194:195], v28 offset:512
s_waitcnt lgkmcnt(4)
v_mfma_f32_16x16x32_bf16 v[80:83], v[184:187], v[204:207], v[80:83]
v_mfma_f32_16x16x32_bf16 v[84:87], v[184:187], v[208:211], v[84:87]
v_mfma_f32_16x16x32_bf16 v[88:91], v[184:187], v[212:215], v[88:91]
ds_read_b128 v[216:219], v32 offset:7168
s_waitcnt vmcnt(4)
ds_read_b64_tr_b16 v[196:197], v25 offset:4096
ds_read_b64_tr_b16 v[198:199], v25 offset:4608
s_waitcnt lgkmcnt(5)
v_mfma_f32_16x16x32_bf16 v[92:95], v[188:191], v[204:207], v[92:95]
ds_read_b128 v[220:223], v32 offset:15360
v_mfma_f32_16x16x32_bf16 v[96:99], v[188:191], v[208:211], v[96:99]
ds_read_b128 v[224:227], v32 offset:23552
v_mfma_f32_16x16x32_bf16 v[100:103], v[188:191], v[212:215], v[100:103]
ds_read_b64_tr_b16 v[200:201], v26 offset:4096
ds_read_b64_tr_b16 v[202:203], v26 offset:4608
s_waitcnt lgkmcnt(7)
v_mfma_f32_16x16x32_bf16 v[104:107], v[192:195], v[204:207], v[104:107]
s_add_u32 m0, s63, 0x0
s_nop 0
buffer_load_dwordx4 v21, s[48:51], s75 offen offset:0 lds
buffer_load_dwordx4 v22, s[48:51], s75 offen offset:1024 lds
buffer_load_dwordx4 v23, s[48:51], s75 offen offset:2048 lds
buffer_load_dwordx4 v24, s[48:51], s75 offen offset:3072 lds
v_mfma_f32_16x16x32_bf16 v[108:111], v[192:195], v[208:211], v[108:111]
v_mfma_f32_16x16x32_bf16 v[112:115], v[192:195], v[212:215], v[112:115]
ds_read_b64_tr_b16 v[164:165], v27 offset:4096
ds_read_b64_tr_b16 v[166:167], v27 offset:4608
s_waitcnt lgkmcnt(6)
v_mfma_f32_16x16x32_bf16 v[68:71], v[196:199], v[216:219], v[68:71]
s_waitcnt lgkmcnt(5)
v_mfma_f32_16x16x32_bf16 v[72:75], v[196:199], v[220:223], v[72:75]
s_waitcnt lgkmcnt(4)
v_mfma_f32_16x16x32_bf16 v[76:79], v[196:199], v[224:227], v[76:79]
ds_read_b64_tr_b16 v[168:169], v28 offset:4096
ds_read_b64_tr_b16 v[170:171], v28 offset:4608
s_waitcnt lgkmcnt(4)
v_mfma_f32_16x16x32_bf16 v[80:83], v[200:203], v[216:219], v[80:83]
v_cvt_pk_bf16_f32 v68, v68, v69
v_cvt_pk_bf16_f32 v69, v70, v71
ds_write_b64 v33, v[68:69] offset:0
v_mfma_f32_16x16x32_bf16 v[84:87], v[200:203], v[220:223], v[84:87]
v_cvt_pk_bf16_f32 v72, v72, v73
v_cvt_pk_bf16_f32 v73, v74, v75
ds_write_b64 v33, v[72:73] offset:8192
v_mfma_f32_16x16x32_bf16 v[88:91], v[200:203], v[224:227], v[88:91]
v_cvt_pk_bf16_f32 v76, v76, v77
v_cvt_pk_bf16_f32 v77, v78, v79
ds_write_b64 v33, v[76:77] offset:16384
s_waitcnt lgkmcnt(5)
v_mfma_f32_16x16x32_bf16 v[92:95], v[164:167], v[216:219], v[92:95]
v_cvt_pk_bf16_f32 v80, v80, v81
v_cvt_pk_bf16_f32 v81, v82, v83
ds_write_b64 v33, v[80:81] offset:512
v_mfma_f32_16x16x32_bf16 v[96:99], v[164:167], v[220:223], v[96:99]
v_cvt_pk_bf16_f32 v84, v84, v85
v_cvt_pk_bf16_f32 v85, v86, v87
ds_write_b64 v33, v[84:85] offset:8704
v_mfma_f32_16x16x32_bf16 v[100:103], v[164:167], v[224:227], v[100:103]
v_cvt_pk_bf16_f32 v88, v88, v89
v_cvt_pk_bf16_f32 v89, v90, v91
ds_write_b64 v33, v[88:89] offset:16896
s_waitcnt lgkmcnt(6)
v_mfma_f32_16x16x32_bf16 v[104:107], v[168:171], v[216:219], v[104:107]
v_cvt_pk_bf16_f32 v92, v92, v93
v_cvt_pk_bf16_f32 v93, v94, v95
ds_write_b64 v34, v[92:93] offset:0
s_add_u32 m0, s63, 0x1000
s_nop 0
buffer_load_dwordx4 v21, s[48:51], s76 offen offset:0 lds
buffer_load_dwordx4 v22, s[48:51], s76 offen offset:1024 lds
buffer_load_dwordx4 v23, s[48:51], s76 offen offset:2048 lds
buffer_load_dwordx4 v24, s[48:51], s76 offen offset:3072 lds
v_mfma_f32_16x16x32_bf16 v[108:111], v[168:171], v[220:223], v[108:111]
v_cvt_pk_bf16_f32 v96, v96, v97
v_cvt_pk_bf16_f32 v97, v98, v99
ds_write_b64 v34, v[96:97] offset:8192
v_mfma_f32_16x16x32_bf16 v[112:115], v[168:171], v[224:227], v[112:115]
v_cvt_pk_bf16_f32 v100, v100, v101
v_cvt_pk_bf16_f32 v101, v102, v103
ds_write_b64 v34, v[100:101] offset:16384
v_cvt_pk_bf16_f32 v104, v104, v105
v_cvt_pk_bf16_f32 v105, v106, v107
ds_write_b64 v34, v[104:105] offset:512
v_cvt_pk_bf16_f32 v108, v108, v109
v_cvt_pk_bf16_f32 v109, v110, v111
ds_write_b64 v34, v[108:109] offset:8704
v_cvt_pk_bf16_f32 v112, v112, v113
v_cvt_pk_bf16_f32 v113, v114, v115
ds_write_b64 v34, v[112:113] offset:16896
s_waitcnt vmcnt(8)
ds_read_b128 v[172:175], v29 offset:8192
ds_read_b128 v[176:179], v30 offset:8192
ds_read_b128 v[180:183], v29 offset:10240
s_waitcnt lgkmcnt(3)
s_barrier
ds_read_b128 v[228:231], v35 offset:0
ds_read_b128 v[232:235], v35 offset:8192
ds_read_b128 v[236:239], v35 offset:16384
ds_read_b128 v[204:207], v35 offset:1024
ds_read_b128 v[208:211], v35 offset:9216
ds_read_b128 v[212:215], v35 offset:17408
s_waitcnt lgkmcnt(5)
v_mfma_f32_16x16x32_bf16 v[116:119], v[172:175], v[228:231], 0
s_waitcnt lgkmcnt(4)
v_mfma_f32_16x16x32_bf16 v[132:135], v[172:175], v[232:235], 0
s_waitcnt lgkmcnt(3)
v_mfma_f32_16x16x32_bf16 v[148:151], v[172:175], v[236:239], 0
ds_read_b128 v[184:187], v30 offset:10240
s_waitcnt lgkmcnt(3)
v_mfma_f32_16x16x32_bf16 v[116:119], v[176:179], v[204:207], v[116:119]
s_waitcnt lgkmcnt(2)
v_mfma_f32_16x16x32_bf16 v[132:135], v[176:179], v[208:211], v[132:135]
s_waitcnt lgkmcnt(1)
v_mfma_f32_16x16x32_bf16 v[148:151], v[176:179], v[212:215], v[148:151]
s_waitcnt vmcnt(4)
ds_read_b128 v[188:191], v29 offset:0
v_mfma_f32_16x16x32_bf16 v[120:123], v[180:183], v[228:231], 0
v_mfma_f32_16x16x32_bf16 v[136:139], v[180:183], v[232:235], 0
v_mfma_f32_16x16x32_bf16 v[152:155], v[180:183], v[236:239], 0
ds_read_b128 v[192:195], v30 offset:0
s_waitcnt lgkmcnt(2)
v_mfma_f32_16x16x32_bf16 v[120:123], v[184:187], v[204:207], v[120:123]
s_add_u32 m0, s63, 0x2000
s_nop 0
buffer_load_dwordx4 v21, s[48:51], s77 offen offset:0 lds
buffer_load_dwordx4 v22, s[48:51], s77 offen offset:1024 lds
buffer_load_dwordx4 v23, s[48:51], s77 offen offset:2048 lds
buffer_load_dwordx4 v24, s[48:51], s77 offen offset:3072 lds
v_mfma_f32_16x16x32_bf16 v[136:139], v[184:187], v[208:211], v[136:139]
v_mfma_f32_16x16x32_bf16 v[152:155], v[184:187], v[212:215], v[152:155]
ds_read_b128 v[196:199], v29 offset:2048
s_waitcnt lgkmcnt(2)
v_mfma_f32_16x16x32_bf16 v[124:127], v[188:191], v[228:231], 0
v_mfma_f32_16x16x32_bf16 v[140:143], v[188:191], v[232:235], 0
v_mfma_f32_16x16x32_bf16 v[156:159], v[188:191], v[236:239], 0
ds_read_b128 v[200:203], v30 offset:2048
s_waitcnt lgkmcnt(2)
v_mfma_f32_16x16x32_bf16 v[124:127], v[192:195], v[204:207], v[124:127]
v_mfma_f32_16x16x32_bf16 v[140:143], v[192:195], v[208:211], v[140:143]
v_mfma_f32_16x16x32_bf16 v[156:159], v[192:195], v[212:215], v[156:159]
ds_read_b128 v[216:219], v35 offset:2048
s_waitcnt vmcnt(4)
ds_read_b128 v[164:167], v29 offset:4096
s_waitcnt lgkmcnt(3)
v_mfma_f32_16x16x32_bf16 v[128:131], v[196:199], v[228:231], 0
ds_read_b128 v[220:223], v35 offset:10240
v_mfma_f32_16x16x32_bf16 v[144:147], v[196:199], v[232:235], 0
ds_read_b128 v[224:227], v35 offset:18432
v_mfma_f32_16x16x32_bf16 v[160:163], v[196:199], v[236:239], 0
ds_read_b128 v[228:231], v35 offset:3072
ds_read_b128 v[168:171], v30 offset:4096
s_waitcnt lgkmcnt(6)
v_mfma_f32_16x16x32_bf16 v[128:131], v[200:203], v[204:207], v[128:131]
ds_read_b128 v[232:235], v35 offset:11264
s_add_u32 m0, s63, 0x0
s_nop 0
buffer_load_dwordx4 v21, s[48:51], s78 offen offset:0 lds
buffer_load_dwordx4 v22, s[48:51], s78 offen offset:1024 lds
buffer_load_dwordx4 v23, s[48:51], s78 offen offset:2048 lds
buffer_load_dwordx4 v24, s[48:51], s78 offen offset:3072 lds
v_mfma_f32_16x16x32_bf16 v[144:147], v[200:203], v[208:211], v[144:147]
ds_read_b128 v[236:239], v35 offset:19456
v_mfma_f32_16x16x32_bf16 v[160:163], v[200:203], v[212:215], v[160:163]
ds_read_b128 v[172:175], v29 offset:6144
s_waitcnt lgkmcnt(7)
v_mfma_f32_16x16x32_bf16 v[116:119], v[164:167], v[216:219], v[116:119]
s_waitcnt lgkmcnt(6)
v_mfma_f32_16x16x32_bf16 v[132:135], v[164:167], v[220:223], v[132:135]
s_waitcnt lgkmcnt(5)
v_mfma_f32_16x16x32_bf16 v[148:151], v[164:167], v[224:227], v[148:151]
ds_read_b128 v[176:179], v30 offset:6144
s_waitcnt lgkmcnt(4)
v_mfma_f32_16x16x32_bf16 v[116:119], v[168:171], v[228:231], v[116:119]
s_waitcnt lgkmcnt(3)
v_mfma_f32_16x16x32_bf16 v[132:135], v[168:171], v[232:235], v[132:135]
s_waitcnt lgkmcnt(2)
v_mfma_f32_16x16x32_bf16 v[148:151], v[168:171], v[236:239], v[148:151]
s_waitcnt vmcnt(4)
ds_read_b128 v[180:183], v29 offset:8192
s_waitcnt lgkmcnt(2)
v_mfma_f32_16x16x32_bf16 v[120:123], v[172:175], v[216:219], v[120:123]
v_mfma_f32_16x16x32_bf16 v[136:139], v[172:175], v[220:223], v[136:139]
v_mfma_f32_16x16x32_bf16 v[152:155], v[172:175], v[224:227], v[152:155]
ds_read_b128 v[184:187], v30 offset:8192
s_waitcnt lgkmcnt(2)
v_mfma_f32_16x16x32_bf16 v[120:123], v[176:179], v[228:231], v[120:123]
s_add_u32 m0, s63, 0x1000
s_nop 0
buffer_load_dwordx4 v21, s[48:51], s79 offen offset:0 lds
buffer_load_dwordx4 v22, s[48:51], s79 offen offset:1024 lds
buffer_load_dwordx4 v23, s[48:51], s79 offen offset:2048 lds
buffer_load_dwordx4 v24, s[48:51], s79 offen offset:3072 lds
v_mfma_f32_16x16x32_bf16 v[136:139], v[176:179], v[232:235], v[136:139]
v_mfma_f32_16x16x32_bf16 v[152:155], v[176:179], v[236:239], v[152:155]
ds_read_b128 v[188:191], v29 offset:10240
s_waitcnt lgkmcnt(2)
v_mfma_f32_16x16x32_bf16 v[124:127], v[180:183], v[216:219], v[124:127]
v_mfma_f32_16x16x32_bf16 v[140:143], v[180:183], v[220:223], v[140:143]
v_mfma_f32_16x16x32_bf16 v[156:159], v[180:183], v[224:227], v[156:159]
ds_read_b128 v[192:195], v30 offset:10240
s_waitcnt lgkmcnt(2)
v_mfma_f32_16x16x32_bf16 v[124:127], v[184:187], v[228:231], v[124:127]
v_mfma_f32_16x16x32_bf16 v[140:143], v[184:187], v[232:235], v[140:143]
v_mfma_f32_16x16x32_bf16 v[156:159], v[184:187], v[236:239], v[156:159]
ds_read_b128 v[204:207], v35 offset:4096
s_waitcnt vmcnt(4)
ds_read_b128 v[196:199], v29 offset:0
s_waitcnt lgkmcnt(3)
v_mfma_f32_16x16x32_bf16 v[128:131], v[188:191], v[216:219], v[128:131]
ds_read_b128 v[208:211], v35 offset:12288
v_mfma_f32_16x16x32_bf16 v[144:147], v[188:191], v[220:223], v[144:147]
ds_read_b128 v[212:215], v35 offset:20480
v_mfma_f32_16x16x32_bf16 v[160:163], v[188:191], v[224:227], v[160:163]
ds_read_b128 v[216:219], v35 offset:5120
ds_read_b128 v[200:203], v30 offset:0
s_waitcnt lgkmcnt(6)
v_mfma_f32_16x16x32_bf16 v[128:131], v[192:195], v[228:231], v[128:131]
ds_read_b128 v[220:223], v35 offset:13312
s_add_u32 m0, s63, 0x2000
s_nop 0
buffer_load_dwordx4 v21, s[48:51], s80 offen offset:0 lds
buffer_load_dwordx4 v22, s[48:51], s80 offen offset:1024 lds
buffer_load_dwordx4 v23, s[48:51], s80 offen offset:2048 lds
buffer_load_dwordx4 v24, s[48:51], s80 offen offset:3072 lds
v_mfma_f32_16x16x32_bf16 v[144:147], v[192:195], v[232:235], v[144:147]
ds_read_b128 v[224:227], v35 offset:21504
v_mfma_f32_16x16x32_bf16 v[160:163], v[192:195], v[236:239], v[160:163]
ds_read_b128 v[164:167], v29 offset:2048
s_waitcnt lgkmcnt(7)
v_mfma_f32_16x16x32_bf16 v[116:119], v[196:199], v[204:207], v[116:119]
s_waitcnt lgkmcnt(6)
v_mfma_f32_16x16x32_bf16 v[132:135], v[196:199], v[208:211], v[132:135]
s_waitcnt lgkmcnt(5)
v_mfma_f32_16x16x32_bf16 v[148:151], v[196:199], v[212:215], v[148:151]
ds_read_b128 v[168:171], v30 offset:2048
s_waitcnt lgkmcnt(4)
v_mfma_f32_16x16x32_bf16 v[116:119], v[200:203], v[216:219], v[116:119]
s_waitcnt lgkmcnt(3)
v_mfma_f32_16x16x32_bf16 v[132:135], v[200:203], v[220:223], v[132:135]
s_waitcnt lgkmcnt(2)
v_mfma_f32_16x16x32_bf16 v[148:151], v[200:203], v[224:227], v[148:151]
s_waitcnt vmcnt(4)
ds_read_b128 v[172:175], v29 offset:4096
s_waitcnt lgkmcnt(2)
v_mfma_f32_16x16x32_bf16 v[120:123], v[164:167], v[204:207], v[120:123]
v_mfma_f32_16x16x32_bf16 v[136:139], v[164:167], v[208:211], v[136:139]
v_mfma_f32_16x16x32_bf16 v[152:155], v[164:167], v[212:215], v[152:155]
ds_read_b128 v[176:179], v30 offset:4096
s_waitcnt lgkmcnt(2)
v_mfma_f32_16x16x32_bf16 v[120:123], v[168:171], v[216:219], v[120:123]
s_add_u32 m0, s63, 0x0
s_nop 0
buffer_load_dwordx4 v21, s[48:51], s81 offen offset:0 lds
buffer_load_dwordx4 v22, s[48:51], s81 offen offset:1024 lds
buffer_load_dwordx4 v23, s[48:51], s81 offen offset:2048 lds
buffer_load_dwordx4 v24, s[48:51], s81 offen offset:3072 lds
v_mfma_f32_16x16x32_bf16 v[136:139], v[168:171], v[220:223], v[136:139]
buffer_store_dwordx4 v[44:47], v16, s[56:59], s64 offen offset:0 sc1
buffer_store_dwordx4 v[48:51], v16, s[56:59], s64 offen offset:1024 sc1
v_mfma_f32_16x16x32_bf16 v[152:155], v[168:171], v[224:227], v[152:155]
ds_read_b128 v[180:183], v29 offset:6144
buffer_store_dwordx4 v[52:55], v16, s[56:59], s64 offen offset:2048 sc1
s_waitcnt lgkmcnt(2)
v_mfma_f32_16x16x32_bf16 v[124:127], v[172:175], v[204:207], v[124:127]
buffer_store_dwordx4 v[56:59], v16, s[56:59], s64 offen offset:3072 sc1
buffer_store_dwordx4 v[60:63], v16, s[56:59], s65 offen offset:0 sc1
v_mfma_f32_16x16x32_bf16 v[140:143], v[172:175], v[208:211], v[140:143]
buffer_store_dwordx4 v[64:67], v16, s[56:59], s65 offen offset:1024 sc1
v_mfma_f32_16x16x32_bf16 v[156:159], v[172:175], v[212:215], v[156:159]
ds_read_b128 v[184:187], v30 offset:6144
s_waitcnt lgkmcnt(2)
v_mfma_f32_16x16x32_bf16 v[124:127], v[176:179], v[216:219], v[124:127]
v_mfma_f32_16x16x32_bf16 v[140:143], v[176:179], v[220:223], v[140:143]
v_mfma_f32_16x16x32_bf16 v[156:159], v[176:179], v[224:227], v[156:159]
ds_read_b128 v[228:231], v35 offset:6144
s_waitcnt vmcnt(10)
ds_read_b128 v[188:191], v29 offset:8192
s_waitcnt lgkmcnt(3)
v_mfma_f32_16x16x32_bf16 v[128:131], v[180:183], v[204:207], v[128:131]
ds_read_b128 v[232:235], v35 offset:14336
v_mfma_f32_16x16x32_bf16 v[144:147], v[180:183], v[208:211], v[144:147]
ds_read_b128 v[236:239], v35 offset:22528
v_mfma_f32_16x16x32_bf16 v[160:163], v[180:183], v[212:215], v[160:163]
ds_read_b128 v[204:207], v35 offset:7168
ds_read_b128 v[192:195], v30 offset:8192
s_waitcnt lgkmcnt(6)
v_mfma_f32_16x16x32_bf16 v[128:131], v[184:187], v[216:219], v[128:131]
ds_read_b128 v[208:211], v35 offset:15360
v_mfma_f32_16x16x32_bf16 v[144:147], v[184:187], v[220:223], v[144:147]
ds_read_b128 v[212:215], v35 offset:23552
v_mfma_f32_16x16x32_bf16 v[160:163], v[184:187], v[224:227], v[160:163]
ds_read_b128 v[196:199], v29 offset:10240
s_waitcnt lgkmcnt(7)
v_mfma_f32_16x16x32_bf16 v[116:119], v[188:191], v[228:231], v[116:119]
s_waitcnt lgkmcnt(6)
v_mfma_f32_16x16x32_bf16 v[132:135], v[188:191], v[232:235], v[132:135]
s_waitcnt lgkmcnt(5)
v_mfma_f32_16x16x32_bf16 v[148:151], v[188:191], v[236:239], v[148:151]
ds_read_b128 v[200:203], v30 offset:10240
s_waitcnt lgkmcnt(4)
v_mfma_f32_16x16x32_bf16 v[116:119], v[192:195], v[204:207], v[116:119]
s_waitcnt lgkmcnt(3)
v_mfma_f32_16x16x32_bf16 v[132:135], v[192:195], v[208:211], v[132:135]
s_waitcnt lgkmcnt(2)
v_mfma_f32_16x16x32_bf16 v[148:151], v[192:195], v[212:215], v[148:151]
s_waitcnt vmcnt(6)
ds_read_b128 v[164:167], v29 offset:0
s_waitcnt lgkmcnt(2)
v_mfma_f32_16x16x32_bf16 v[120:123], v[196:199], v[228:231], v[120:123]
v_mfma_f32_16x16x32_bf16 v[136:139], v[196:199], v[232:235], v[136:139]
v_mfma_f32_16x16x32_bf16 v[152:155], v[196:199], v[236:239], v[152:155]
ds_read_b128 v[168:171], v30 offset:0
s_waitcnt lgkmcnt(2)
v_mfma_f32_16x16x32_bf16 v[120:123], v[200:203], v[204:207], v[120:123]
v_mfma_f32_16x16x32_bf16 v[136:139], v[200:203], v[208:211], v[136:139]
v_mfma_f32_16x16x32_bf16 v[152:155], v[200:203], v[212:215], v[152:155]
ds_read_b128 v[172:175], v29 offset:2048
s_waitcnt lgkmcnt(2)
v_mfma_f32_16x16x32_bf16 v[124:127], v[164:167], v[228:231], v[124:127]
v_mul_f32 v116, s86, v116
v_mul_f32 v117, s86, v117
v_mul_f32 v118, s86, v118
v_mul_f32 v119, s86, v119
v_mul_f32 v120, s86, v120
v_mul_f32 v121, s86, v121
v_mul_f32 v122, s86, v122
v_mul_f32 v123, s86, v123
v_cvt_pk_bf16_f32 v116, v116, v117
v_cvt_pk_bf16_f32 v117, v118, v119
v_cvt_pk_bf16_f32 v118, v120, v121
v_cvt_pk_bf16_f32 v119, v122, v123
buffer_store_dwordx4 v[116:119], v16, s[52:55], s82 offen offset:0 sc1
v_mfma_f32_16x16x32_bf16 v[140:143], v[164:167], v[232:235], v[140:143]
v_mul_f32 v132, s86, v132
v_mul_f32 v133, s86, v133
v_mul_f32 v134, s86, v134
v_mul_f32 v135, s86, v135
v_mul_f32 v136, s86, v136
v_mul_f32 v137, s86, v137
v_mul_f32 v138, s86, v138
v_mul_f32 v139, s86, v139
v_cvt_pk_bf16_f32 v132, v132, v133
v_cvt_pk_bf16_f32 v133, v134, v135
v_cvt_pk_bf16_f32 v134, v136, v137
v_cvt_pk_bf16_f32 v135, v138, v139
buffer_store_dwordx4 v[132:135], v16, s[52:55], s83 offen offset:0 sc1
v_mfma_f32_16x16x32_bf16 v[156:159], v[164:167], v[236:239], v[156:159]
ds_read_b128 v[176:179], v30 offset:2048
v_mul_f32 v148, s86, v148
v_mul_f32 v149, s86, v149
v_mul_f32 v150, s86, v150
v_mul_f32 v151, s86, v151
v_mul_f32 v152, s86, v152
v_mul_f32 v153, s86, v153
v_mul_f32 v154, s86, v154
v_mul_f32 v155, s86, v155
v_cvt_pk_bf16_f32 v148, v148, v149
v_cvt_pk_bf16_f32 v149, v150, v151
v_cvt_pk_bf16_f32 v150, v152, v153
v_cvt_pk_bf16_f32 v151, v154, v155
buffer_store_dwordx4 v[148:151], v16, s[52:55], s84 offen offset:0 sc1
s_waitcnt lgkmcnt(2)
v_mfma_f32_16x16x32_bf16 v[124:127], v[168:171], v[204:207], v[124:127]
v_mfma_f32_16x16x32_bf16 v[140:143], v[168:171], v[208:211], v[140:143]
v_mfma_f32_16x16x32_bf16 v[156:159], v[168:171], v[212:215], v[156:159]
s_waitcnt lgkmcnt(1)
v_mfma_f32_16x16x32_bf16 v[128:131], v[172:175], v[228:231], v[128:131]
v_mfma_f32_16x16x32_bf16 v[144:147], v[172:175], v[232:235], v[144:147]
v_mfma_f32_16x16x32_bf16 v[160:163], v[172:175], v[236:239], v[160:163]
s_waitcnt lgkmcnt(0)
v_mfma_f32_16x16x32_bf16 v[128:131], v[176:179], v[204:207], v[128:131]
v_mfma_f32_16x16x32_bf16 v[144:147], v[176:179], v[208:211], v[144:147]
v_mfma_f32_16x16x32_bf16 v[160:163], v[176:179], v[212:215], v[160:163]
v_mul_f32 v124, s86, v124
v_mul_f32 v125, s86, v125
v_mul_f32 v126, s86, v126
v_mul_f32 v127, s86, v127
s_nop 1
v_mul_f32 v128, s86, v128
v_mul_f32 v129, s86, v129
v_mul_f32 v130, s86, v130
v_mul_f32 v131, s86, v131
v_cvt_pk_bf16_f32 v124, v124, v125
v_cvt_pk_bf16_f32 v125, v126, v127
v_cvt_pk_bf16_f32 v126, v128, v129
v_cvt_pk_bf16_f32 v127, v130, v131
buffer_store_dwordx4 v[124:127], v16, s[52:55], s82 offen offset:1024 sc1
v_mul_f32 v140, s86, v140
v_mul_f32 v141, s86, v141
v_mul_f32 v142, s86, v142
v_mul_f32 v143, s86, v143
v_mul_f32 v144, s86, v144
v_mul_f32 v145, s86, v145
v_mul_f32 v146, s86, v146
v_mul_f32 v147, s86, v147
v_cvt_pk_bf16_f32 v140, v140, v141
v_cvt_pk_bf16_f32 v141, v142, v143
v_cvt_pk_bf16_f32 v142, v144, v145
v_cvt_pk_bf16_f32 v143, v146, v147
buffer_store_dwordx4 v[140:143], v16, s[52:55], s83 offen offset:1024 sc1
v_mul_f32 v156, s86, v156
v_mul_f32 v157, s86, v157
v_mul_f32 v158, s86, v158
v_mul_f32 v159, s86, v159
v_mul_f32 v160, s86, v160
v_mul_f32 v161, s86, v161
v_mul_f32 v162, s86, v162
v_mul_f32 v163, s86, v163
v_cvt_pk_bf16_f32 v156, v156, v157
v_cvt_pk_bf16_f32 v157, v158, v159
v_cvt_pk_bf16_f32 v158, v160, v161
v_cvt_pk_bf16_f32 v159, v162, v163
buffer_store_dwordx4 v[156:159], v16, s[52:55], s84 offen offset:1024 sc1
L1_fin:
s_add_u32 s91, s91, 1344
s_waitcnt lgkmcnt(0)
s_add_u32 s98, s98, 0x7f4a7c15
s_addc_u32 s99, s99, 0x9e3779b9
LM_pub:
s_add_u32 s40, s38, 0x7c00000
s_addc_u32 s41, s39, 0
s_mov_b32 s42, 0x40000
s_mov_b32 s43, 0x00020000
s_lshl_b32 s6, s91, 7
s_cmp_eq_u32 s60, 0
s_cselect_b32 s6, s6, 0x70000000
s_waitcnt vmcnt(0) lgkmcnt(0)
s_barrier
v_mov_b32 v6, s98
v_mov_b32 v7, s99
s_mov_b64 exec, 1
buffer_store_dwordx2 v[6:7], off, s[40:43], s6 sc1
s_mov_b64 exec, -1
s_cmp_eq_u32 s61, 0
s_cbranch_scc1 L2_entry
s_mov_b32 s61, 0
s_sub_u32 s4, s91, 1578
s_min_u32 s6, s4, 14
s_cmp_lt_u32 s4, 6
s_cselect_b32 s6, 0, s6
s_sub_u32 s4, s4, s6
s_add_u32 s91, s4, 1600
v_lshlrev_b32 v16, 4, v2
s_mul_i32 s63, s60, 12288
s_and_b32 s6, s4, 3
s_lshl_b32 s6, s6, 6
s_mul_i32 s7, s60, 16
s_add_u32 s6, s6, s7
v_lshrrev_b32 v5, 5, v2
v_and_b32 v6, 31, v2
v_lshlrev_b32 v6, 4, v6
s_cmp_ge_u32 s4, 4
s_cselect_b64 vcc, -1, 0
v_add3_u32 v7, v5, s6, 0
v_and_b32 v8, 0x80, v7
v_bfe_u32 v9, v7, 2, 1
v_lshl_or_b32 v8, v9, 6, v8
v_bfe_u32 v9, v7, 4, 1
v_lshl_or_b32 v8, v9, 5, v8
v_and_b32 v9, 3, v7
v_lshl_or_b32 v8, v9, 3, v8
v_bfe_u32 v9, v7, 5, 2
v_lshl_or_b32 v8, v9, 1, v8
v_bfe_u32 v9, v7, 3, 1
v_or_b32 v8, v9, v8
v_cndmask_b32 v8, v8, v7, vcc
v_lshl_add_u32 v44, v8, 9, v6
v_add3_u32 v7, v5, s6, 2
v_and_b32 v8, 0x80, v7
v_bfe_u32 v9, v7, 2, 1
v_lshl_or_b32 v8, v9, 6, v8
v_bfe_u32 v9, v7, 4, 1
v_lshl_or_b32 v8, v9, 5, v8
v_and_b32 v9, 3, v7
v_lshl_or_b32 v8, v9, 3, v8
v_bfe_u32 v9, v7, 5, 2
v_lshl_or_b32 v8, v9, 1, v8
v_bfe_u32 v9, v7, 3, 1
v_or_b32 v8, v9, v8
v_cndmask_b32 v8, v8, v7, vcc
v_lshl_add_u32 v48, v8, 9, v6
v_add3_u32 v7, v5, s6, 4
v_and_b32 v8, 0x80, v7
v_bfe_u32 v9, v7, 2, 1
v_lshl_or_b32 v8, v9, 6, v8
v_bfe_u32 v9, v7, 4, 1
v_lshl_or_b32 v8, v9, 5, v8
v_and_b32 v9, 3, v7
v_lshl_or_b32 v8, v9, 3, v8
v_bfe_u32 v9, v7, 5, 2
v_lshl_or_b32 v8, v9, 1, v8
v_bfe_u32 v9, v7, 3, 1
v_or_b32 v8, v9, v8
v_cndmask_b32 v8, v8, v7, vcc
v_lshl_add_u32 v52, v8, 9, v6
v_add3_u32 v7, v5, s6, 6
v_and_b32 v8, 0x80, v7
v_bfe_u32 v9, v7, 2, 1
v_lshl_or_b32 v8, v9, 6, v8
v_bfe_u32 v9, v7, 4, 1
v_lshl_or_b32 v8, v9, 5, v8
v_and_b32 v9, 3, v7
v_lshl_or_b32 v8, v9, 3, v8
v_bfe_u32 v9, v7, 5, 2
v_lshl_or_b32 v8, v9, 1, v8
v_bfe_u32 v9, v7, 3, 1
v_or_b32 v8, v9, v8
v_cndmask_b32 v8, v8, v7, vcc
v_lshl_add_u32 v56, v8, 9, v6
v_add3_u32 v7, v5, s6, 8
v_and_b32 v8, 0x80, v7
v_bfe_u32 v9, v7, 2, 1
v_lshl_or_b32 v8, v9, 6, v8
v_bfe_u32 v9, v7, 4, 1
v_lshl_or_b32 v8, v9, 5, v8
v_and_b32 v9, 3, v7
v_lshl_or_b32 v8, v9, 3, v8
v_bfe_u32 v9, v7, 5, 2
v_lshl_or_b32 v8, v9, 1, v8
v_bfe_u32 v9, v7, 3, 1
v_or_b32 v8, v9, v8
v_cndmask_b32 v8, v8, v7, vcc
v_lshl_add_u32 v60, v8, 9, v6
v_add3_u32 v7, v5, s6, 10
v_and_b32 v8, 0x80, v7
v_bfe_u32 v9, v7, 2, 1
v_lshl_or_b32 v8, v9, 6, v8
v_bfe_u32 v9, v7, 4, 1
v_lshl_or_b32 v8, v9, 5, v8
v_and_b32 v9, 3, v7
v_lshl_or_b32 v8, v9, 3, v8
v_bfe_u32 v9, v7, 5, 2
v_lshl_or_b32 v8, v9, 1, v8
v_bfe_u32 v9, v7, 3, 1
v_or_b32 v8, v9, v8
v_cndmask_b32 v8, v8, v7, vcc
v_lshl_add_u32 v64, v8, 9, v6
v_add3_u32 v7, v5, s6, 12
v_and_b32 v8, 0x80, v7
v_bfe_u32 v9, v7, 2, 1
v_lshl_or_b32 v8, v9, 6, v8
v_bfe_u32 v9, v7, 4, 1
v_lshl_or_b32 v8, v9, 5, v8
v_and_b32 v9, 3, v7
v_lshl_or_b32 v8, v9, 3, v8
v_bfe_u32 v9, v7, 5, 2
v_lshl_or_b32 v8, v9, 1, v8
v_bfe_u32 v9, v7, 3, 1
v_or_b32 v8, v9, v8
v_cndmask_b32 v8, v8, v7, vcc
v_lshl_add_u32 v68, v8, 9, v6
v_add3_u32 v7, v5, s6, 14
v_and_b32 v8, 0x80, v7
v_bfe_u32 v9, v7, 2, 1
v_lshl_or_b32 v8, v9, 6, v8
v_bfe_u32 v9, v7, 4, 1
v_lshl_or_b32 v8, v9, 5, v8
v_and_b32 v9, 3, v7
v_lshl_or_b32 v8, v9, 3, v8
v_bfe_u32 v9, v7, 5, 2
v_lshl_or_b32 v8, v9, 1, v8
v_bfe_u32 v9, v7, 3, 1
v_or_b32 v8, v9, v8
v_cndmask_b32 v8, v8, v7, vcc
v_lshl_add_u32 v72, v8, 9, v6
s_lshl_b32 s7, s60, 7
v_lshrrev_b32 v5, 3, v2
v_and_b32 v6, 7, v2
v_and_b32 v7, 2, v5
v_xor_b32 v6, v6, v7
v_lshl_add_u32 v5, v5, 9, s7
v_lshl_add_u32 v17, v6, 4, v5
v_xor_b32 v6, 4, v6
v_lshl_add_u32 v18, v6, 4, v5
v_add_u32 v18, 0xc00, v18
v_add_u32 v19, 0x1800, v17
v_add_u32 v20, 0x1800, v18
s_xor_b32 s6, s62, 0
s_lshl_b32 s66, s6, 14
s_xor_b32 s6, s62, 1
s_lshl_b32 s67, s6, 14
s_xor_b32 s6, s62, 2
s_lshl_b32 s68, s6, 14
s_xor_b32 s6, s62, 3
s_lshl_b32 s69, s6, 14
s_xor_b32 s6, s62, 4
s_lshl_b32 s70, s6, 14
s_xor_b32 s6, s62, 5
s_lshl_b32 s71, s6, 14
s_xor_b32 s6, s62, 6
s_lshl_b32 s72, s6, 14
s_xor_b32 s6, s62, 7
s_lshl_b32 s73, s6, 14
s_waitcnt lgkmcnt(0)
s_cmp_ge_u32 s4, 4
s_cselect_b32 s6, s30, s24
s_cselect_b32 s7, s31, s25
s_add_u32 s40, s6, 0x0
s_addc_u32 s41, s7, 0
s_mov_b32 s42, 0x20000
s_mov_b32 s43, 0x00020000
s_add_u32 s44, s32, 0x0
s_addc_u32 s45, s33, 0
s_mov_b32 s46, 0x20000
s_mov_b32 s47, 0x00020000
buffer_load_dwordx4 v[44:47], v44, s[40:43], 0 offen
buffer_load_dwordx4 v[48:51], v48, s[40:43], 0 offen
buffer_load_dwordx4 v[52:55], v52, s[40:43], 0 offen
buffer_load_dwordx4 v[56:59], v56, s[40:43], 0 offen
buffer_load_dwordx4 v[60:63], v60, s[40:43], 0 offen
buffer_load_dwordx4 v[64:67], v64, s[40:43], 0 offen
buffer_load_dwordx4 v[68:71], v68, s[40:43], 0 offen
buffer_load_dwordx4 v[72:75], v72, s[40:43], 0 offen
s_add_u32 m0, s63, 0x0
s_nop 0
buffer_load_dwordx4 v17, s[44:47], s66 offen offset:0 lds
buffer_load_dwordx4 v18, s[44:47], s66 offen offset:1024 lds
buffer_load_dwordx4 v19, s[44:47], s66 offen offset:2048 lds
buffer_load_dwordx4 v20, s[44:47], s66 offen offset:3072 lds
s_add_u32 m0, s63, 0x1000
s_nop 0
buffer_load_dwordx4 v17, s[44:47], s67 offen offset:0 lds
buffer_load_dwordx4 v18, s[44:47], s67 offen offset:1024 lds
buffer_load_dwordx4 v19, s[44:47], s67 offen offset:2048 lds
buffer_load_dwordx4 v20, s[44:47], s67 offen offset:3072 lds
v_bfe_u32 v5, v2, 2, 3
v_xor_b32 v5, s62, v5
v_and_b32 v6, 3, v2
v_lshlrev_b32 v7, 10, v5
v_lshl_add_u32 v7, v6, 8, v7
v_add_u32 v7, 0xc000, v7
v_and_b32 v5, 1, v5
v_lshl_or_b32 v6, v5, 2, v6
v_lshrrev_b32 v5, 5, v2
s_mul_i32 s6, s60, 16
v_add3_u32 v8, v5, s6, 0
v_lshrrev_b32 v9, 4, v8
v_lshl_add_u32 v9, v9, 13, v7
v_and_b32 v8, 15, v8
v_xor_b32 v8, v8, v6
v_lshl_add_u32 v36, v8, 4, v9
v_add3_u32 v8, v5, s6, 2
v_lshrrev_b32 v9, 4, v8
v_lshl_add_u32 v9, v9, 13, v7
v_and_b32 v8, 15, v8
v_xor_b32 v8, v8, v6
v_lshl_add_u32 v37, v8, 4, v9
v_add3_u32 v8, v5, s6, 4
v_lshrrev_b32 v9, 4, v8
v_lshl_add_u32 v9, v9, 13, v7
v_and_b32 v8, 15, v8
v_xor_b32 v8, v8, v6
v_lshl_add_u32 v38, v8, 4, v9
v_add3_u32 v8, v5, s6, 6
v_lshrrev_b32 v9, 4, v8
v_lshl_add_u32 v9, v9, 13, v7
v_and_b32 v8, 15, v8
v_xor_b32 v8, v8, v6
v_lshl_add_u32 v39, v8, 4, v9
v_add3_u32 v8, v5, s6, 8
v_lshrrev_b32 v9, 4, v8
v_lshl_add_u32 v9, v9, 13, v7
v_and_b32 v8, 15, v8
v_xor_b32 v8, v8, v6
v_lshl_add_u32 v40, v8, 4, v9
v_add3_u32 v8, v5, s6, 10
v_lshrrev_b32 v9, 4, v8
v_lshl_add_u32 v9, v9, 13, v7
v_and_b32 v8, 15, v8
v_xor_b32 v8, v8, v6
v_lshl_add_u32 v41, v8, 4, v9
v_add3_u32 v8, v5, s6, 12
v_lshrrev_b32 v9, 4, v8
v_lshl_add_u32 v9, v9, 13, v7
v_and_b32 v8, 15, v8
v_xor_b32 v8, v8, v6
v_lshl_add_u32 v42, v8, 4, v9
v_add3_u32 v8, v5, s6, 14
v_lshrrev_b32 v9, 4, v8
v_lshl_add_u32 v9, v9, 13, v7
v_and_b32 v8, 15, v8
v_xor_b32 v8, v8, v6
v_lshl_add_u32 v43, v8, 4, v9
v_xor_b32 v5, v3, v4
v_lshlrev_b32 v5, 4, v5
v_lshl_add_u32 v5, v4, 8, v5
v_add_u32 v31, 0xc000, v5
v_xor_b32 v32, 64, v31
v_lshrrev_b32 v5, 2, v3
v_and_b32 v6, 3, v3
v_and_b32 v7, 1, v4
v_lshlrev_b32 v7, 2, v7
v_and_b32 v8, 2, v5
v_or_b32 v7, v7, v8
v_lshl_add_u32 v8, v4, 3, v5
v_lshlrev_b32 v8, 7, v8
v_add_u32 v8, s63, v8
v_xor_b32 v6, v6, v7
v_xor_b32 v9, 0, v6
v_lshl_add_u32 v25, v9, 4, v8
v_add_u32 v26, 8, v25
v_xor_b32 v9, 4, v6
v_lshl_add_u32 v27, v9, 4, v8
v_add_u32 v28, 8, v27
s_lshr_b32 s6, s4, 2
s_lshl_b32 s6, s6, 17
s_and_b32 s7, s4, 3
s_lshl_b32 s7, s7, 12
s_add_u32 s6, s6, s7
s_mul_i32 s7, s60, 32768
s_add_u32 s82, s6, s7
s_add_u32 s83, s82, 16384
s_add_u32 s52, s38, 0x1000000
s_addc_u32 s53, s39, 0
s_mov_b32 s54, 0x40000
s_mov_b32 s55, 0x00020000
s_waitcnt vmcnt(15)
ds_write_b128 v36, v[44:47]
s_waitcnt vmcnt(14)
ds_write_b128 v37, v[48:51]
s_waitcnt vmcnt(13)
ds_write_b128 v38, v[52:55]
s_waitcnt vmcnt(12)
ds_write_b128 v39, v[56:59]
s_waitcnt vmcnt(11)
ds_write_b128 v40, v[60:63]
s_waitcnt vmcnt(10)
ds_write_b128 v41, v[64:67]
s_waitcnt vmcnt(9)
ds_write_b128 v42, v[68:71]
s_waitcnt vmcnt(8)
ds_write_b128 v43, v[72:75]
s_add_u32 m0, s63, 0x2000
s_nop 0
buffer_load_dwordx4 v17, s[44:47], s68 offen offset:0 lds
buffer_load_dwordx4 v18, s[44:47], s68 offen offset:1024 lds
buffer_load_dwordx4 v19, s[44:47], s68 offen offset:2048 lds
buffer_load_dwordx4 v20, s[44:47], s68 offen offset:3072 lds
s_waitcnt vmcnt(8)
ds_read_b64_tr_b16 v[140:141], v25 offset:0
ds_read_b64_tr_b16 v[142:143], v25 offset:512
ds_read_b64_tr_b16 v[144:145], v26 offset:0
ds_read_b64_tr_b16 v[146:147], v26 offset:512
ds_read_b64_tr_b16 v[148:149], v27 offset:0
ds_read_b64_tr_b16 v[150:151], v27 offset:512
s_waitcnt lgkmcnt(6)
s_barrier
ds_read_b128 v[180:183], v31 offset:0
ds_read_b128 v[184:187], v31 offset:8192
ds_read_b128 v[188:191], v31 offset:16384
ds_read_b128 v[192:195], v31 offset:24576
s_waitcnt lgkmcnt(3)
v_mfma_f32_16x16x32_bf16 v[76:79], v[180:183], v[140:143], 0
s_waitcnt lgkmcnt(2)
v_mfma_f32_16x16x32_bf16 v[80:83], v[184:187], v[140:143], 0
s_waitcnt lgkmcnt(1)
v_mfma_f32_16x16x32_bf16 v[84:87], v[188:191], v[140:143], 0
s_waitcnt lgkmcnt(0)
v_mfma_f32_16x16x32_bf16 v[88:91], v[192:195], v[140:143], 0
ds_read_b64_tr_b16 v[152:153], v28 offset:0
ds_read_b64_tr_b16 v[154:155], v28 offset:512
v_mfma_f32_16x16x32_bf16 v[92:95], v[180:183], v[144:147], 0
v_mfma_f32_16x16x32_bf16 v[96:99], v[184:187], v[144:147], 0
v_mfma_f32_16x16x32_bf16 v[100:103], v[188:191], v[144:147], 0
v_mfma_f32_16x16x32_bf16 v[104:107], v[192:195], v[144:147], 0
ds_read_b128 v[196:199], v32 offset:1024
s_waitcnt vmcnt(4)
ds_read_b64_tr_b16 v[156:157], v25 offset:4096
ds_read_b64_tr_b16 v[158:159], v25 offset:4608
v_mfma_f32_16x16x32_bf16 v[108:111], v[180:183], v[148:151], 0
ds_read_b128 v[200:203], v32 offset:9216
v_mfma_f32_16x16x32_bf16 v[112:115], v[184:187], v[148:151], 0
ds_read_b128 v[204:207], v32 offset:17408
v_mfma_f32_16x16x32_bf16 v[116:119], v[188:191], v[148:151], 0
ds_read_b128 v[208:211], v32 offset:25600
v_mfma_f32_16x16x32_bf16 v[120:123], v[192:195], v[148:151], 0
ds_read_b64_tr_b16 v[160:161], v26 offset:4096
ds_read_b64_tr_b16 v[162:163], v26 offset:4608
s_waitcnt lgkmcnt(8)
v_mfma_f32_16x16x32_bf16 v[124:127], v[180:183], v[152:155], 0
s_add_u32 m0, s63, 0x0
s_nop 0
buffer_load_dwordx4 v17, s[44:47], s69 offen offset:0 lds
buffer_load_dwordx4 v18, s[44:47], s69 offen offset:1024 lds
buffer_load_dwordx4 v19, s[44:47], s69 offen offset:2048 lds
buffer_load_dwordx4 v20, s[44:47], s69 offen offset:3072 lds
v_mfma_f32_16x16x32_bf16 v[128:131], v[184:187], v[152:155], 0
v_mfma_f32_16x16x32_bf16 v[132:135], v[188:191], v[152:155], 0
v_mfma_f32_16x16x32_bf16 v[136:139], v[192:195], v[152:155], 0
ds_read_b64_tr_b16 v[164:165], v27 offset:4096
ds_read_b64_tr_b16 v[166:167], v27 offset:4608
s_waitcnt lgkmcnt(7)
v_mfma_f32_16x16x32_bf16 v[76:79], v[196:199], v[156:159], v[76:79]
s_waitcnt lgkmcnt(6)
v_mfma_f32_16x16x32_bf16 v[80:83], v[200:203], v[156:159], v[80:83]
s_waitcnt lgkmcnt(5)
v_mfma_f32_16x16x32_bf16 v[84:87], v[204:207], v[156:159], v[84:87]
s_waitcnt lgkmcnt(4)
v_mfma_f32_16x16x32_bf16 v[88:91], v[208:211], v[156:159], v[88:91]
ds_read_b64_tr_b16 v[168:169], v28 offset:4096
ds_read_b64_tr_b16 v[170:171], v28 offset:4608
s_waitcnt lgkmcnt(4)
v_mfma_f32_16x16x32_bf16 v[92:95], v[196:199], v[160:163], v[92:95]
v_mfma_f32_16x16x32_bf16 v[96:99], v[200:203], v[160:163], v[96:99]
v_mfma_f32_16x16x32_bf16 v[100:103], v[204:207], v[160:163], v[100:103]
v_mfma_f32_16x16x32_bf16 v[104:107], v[208:211], v[160:163], v[104:107]
ds_read_b128 v[212:215], v31 offset:2048
s_waitcnt vmcnt(4)
ds_read_b64_tr_b16 v[172:173], v25 offset:8192
ds_read_b64_tr_b16 v[174:175], v25 offset:8704
s_waitcnt lgkmcnt(5)
v_mfma_f32_16x16x32_bf16 v[108:111], v[196:199], v[164:167], v[108:111]
ds_read_b128 v[216:219], v31 offset:10240
v_mfma_f32_16x16x32_bf16 v[112:115], v[200:203], v[164:167], v[112:115]
ds_read_b128 v[220:223], v31 offset:18432
v_mfma_f32_16x16x32_bf16 v[116:119], v[204:207], v[164:167], v[116:119]
ds_read_b128 v[224:227], v31 offset:26624
v_mfma_f32_16x16x32_bf16 v[120:123], v[208:211], v[164:167], v[120:123]
ds_read_b64_tr_b16 v[176:177], v26 offset:8192
ds_read_b64_tr_b16 v[178:179], v26 offset:8704
s_waitcnt lgkmcnt(8)
v_mfma_f32_16x16x32_bf16 v[124:127], v[196:199], v[168:171], v[124:127]
s_add_u32 m0, s63, 0x1000
s_nop 0
buffer_load_dwordx4 v17, s[44:47], s70 offen offset:0 lds
buffer_load_dwordx4 v18, s[44:47], s70 offen offset:1024 lds
buffer_load_dwordx4 v19, s[44:47], s70 offen offset:2048 lds
buffer_load_dwordx4 v20, s[44:47], s70 offen offset:3072 lds
v_mfma_f32_16x16x32_bf16 v[128:131], v[200:203], v[168:171], v[128:131]
v_mfma_f32_16x16x32_bf16 v[132:135], v[204:207], v[168:171], v[132:135]
v_mfma_f32_16x16x32_bf16 v[136:139], v[208:211], v[168:171], v[136:139]
ds_read_b64_tr_b16 v[140:141], v27 offset:8192
ds_read_b64_tr_b16 v[142:143], v27 offset:8704
s_waitcnt lgkmcnt(7)
v_mfma_f32_16x16x32_bf16 v[76:79], v[212:215], v[172:175], v[76:79]
s_waitcnt lgkmcnt(6)
v_mfma_f32_16x16x32_bf16 v[80:83], v[216:219], v[172:175], v[80:83]
s_waitcnt lgkmcnt(5)
v_mfma_f32_16x16x32_bf16 v[84:87], v[220:223], v[172:175], v[84:87]
s_waitcnt lgkmcnt(4)
v_mfma_f32_16x16x32_bf16 v[88:91], v[224:227], v[172:175], v[88:91]
ds_read_b64_tr_b16 v[144:145], v28 offset:8192
ds_read_b64_tr_b16 v[146:147], v28 offset:8704
s_waitcnt lgkmcnt(4)
v_mfma_f32_16x16x32_bf16 v[92:95], v[212:215], v[176:179], v[92:95]
v_mfma_f32_16x16x32_bf16 v[96:99], v[216:219], v[176:179], v[96:99]
v_mfma_f32_16x16x32_bf16 v[100:103], v[220:223], v[176:179], v[100:103]
v_mfma_f32_16x16x32_bf16 v[104:107], v[224:227], v[176:179], v[104:107]
ds_read_b128 v[180:183], v32 offset:3072
s_waitcnt vmcnt(4)
ds_read_b64_tr_b16 v[148:149], v25 offset:0
ds_read_b64_tr_b16 v[150:151], v25 offset:512
s_waitcnt lgkmcnt(5)
v_mfma_f32_16x16x32_bf16 v[108:111], v[212:215], v[140:143], v[108:111]
ds_read_b128 v[184:187], v32 offset:11264
v_mfma_f32_16x16x32_bf16 v[112:115], v[216:219], v[140:143], v[112:115]
ds_read_b128 v[188:191], v32 offset:19456
v_mfma_f32_16x16x32_bf16 v[116:119], v[220:223], v[140:143], v[116:119]
ds_read_b128 v[192:195], v32 offset:27648
v_mfma_f32_16x16x32_bf16 v[120:123], v[224:227], v[140:143], v[120:123]
ds_read_b64_tr_b16 v[152:153], v26 offset:0
ds_read_b64_tr_b16 v[154:155], v26 offset:512
s_waitcnt lgkmcnt(8)
v_mfma_f32_16x16x32_bf16 v[124:127], v[212:215], v[144:147], v[124:127]
s_add_u32 m0, s63, 0x2000
s_nop 0
buffer_load_dwordx4 v17, s[44:47], s71 offen offset:0 lds
buffer_load_dwordx4 v18, s[44:47], s71 offen offset:1024 lds
buffer_load_dwordx4 v19, s[44:47], s71 offen offset:2048 lds
buffer_load_dwordx4 v20, s[44:47], s71 offen offset:3072 lds
v_mfma_f32_16x16x32_bf16 v[128:131], v[216:219], v[144:147], v[128:131]
v_mfma_f32_16x16x32_bf16 v[132:135], v[220:223], v[144:147], v[132:135]
v_mfma_f32_16x16x32_bf16 v[136:139], v[224:227], v[144:147], v[136:139]
ds_read_b64_tr_b16 v[156:157], v27 offset:0
ds_read_b64_tr_b16 v[158:159], v27 offset:512
s_waitcnt lgkmcnt(7)
v_mfma_f32_16x16x32_bf16 v[76:79], v[180:183], v[148:151], v[76:79]
s_waitcnt lgkmcnt(6)
v_mfma_f32_16x16x32_bf16 v[80:83], v[184:187], v[148:151], v[80:83]
s_waitcnt lgkmcnt(5)
v_mfma_f32_16x16x32_bf16 v[84:87], v[188:191], v[148:151], v[84:87]
s_waitcnt lgkmcnt(4)
v_mfma_f32_16x16x32_bf16 v[88:91], v[192:195], v[148:151], v[88:91]
ds_read_b64_tr_b16 v[160:161], v28 offset:0
ds_read_b64_tr_b16 v[162:163], v28 offset:512
s_waitcnt lgkmcnt(4)
v_mfma_f32_16x16x32_bf16 v[92:95], v[180:183], v[152:155], v[92:95]
v_mfma_f32_16x16x32_bf16 v[96:99], v[184:187], v[152:155], v[96:99]
v_mfma_f32_16x16x32_bf16 v[100:103], v[188:191], v[152:155], v[100:103]
v_mfma_f32_16x16x32_bf16 v[104:107], v[192:195], v[152:155], v[104:107]
ds_read_b128 v[196:199], v31 offset:4096
s_waitcnt vmcnt(4)
ds_read_b64_tr_b16 v[164:165], v25 offset:4096
ds_read_b64_tr_b16 v[166:167], v25 offset:4608
s_waitcnt lgkmcnt(5)
v_mfma_f32_16x16x32_bf16 v[108:111], v[180:183], v[156:159], v[108:111]
ds_read_b128 v[200:203], v31 offset:12288
v_mfma_f32_16x16x32_bf16 v[112:115], v[184:187], v[156:159], v[112:115]
ds_read_b128 v[204:207], v31 offset:20480
v_mfma_f32_16x16x32_bf16 v[116:119], v[188:191], v[156:159], v[116:119]
ds_read_b128 v[208:211], v31 offset:28672
v_mfma_f32_16x16x32_bf16 v[120:123], v[192:195], v[156:159], v[120:123]
ds_read_b64_tr_b16 v[168:169], v26 offset:4096
ds_read_b64_tr_b16 v[170:171], v26 offset:4608
s_waitcnt lgkmcnt(8)
v_mfma_f32_16x16x32_bf16 v[124:127], v[180:183], v[160:163], v[124:127]
s_add_u32 m0, s63, 0x0
s_nop 0
buffer_load_dwordx4 v17, s[44:47], s72 offen offset:0 lds
buffer_load_dwordx4 v18, s[44:47], s72 offen offset:1024 lds
buffer_load_dwordx4 v19, s[44:47], s72 offen offset:2048 lds
buffer_load_dwordx4 v20, s[44:47], s72 offen offset:3072 lds
v_mfma_f32_16x16x32_bf16 v[128:131], v[184:187], v[160:163], v[128:131]
v_mfma_f32_16x16x32_bf16 v[132:135], v[188:191], v[160:163], v[132:135]
v_mfma_f32_16x16x32_bf16 v[136:139], v[192:195], v[160:163], v[136:139]
ds_read_b64_tr_b16 v[172:173], v27 offset:4096
ds_read_b64_tr_b16 v[174:175], v27 offset:4608
s_waitcnt lgkmcnt(7)
v_mfma_f32_16x16x32_bf16 v[76:79], v[196:199], v[164:167], v[76:79]
s_waitcnt lgkmcnt(6)
v_mfma_f32_16x16x32_bf16 v[80:83], v[200:203], v[164:167], v[80:83]
s_waitcnt lgkmcnt(5)
v_mfma_f32_16x16x32_bf16 v[84:87], v[204:207], v[164:167], v[84:87]
s_waitcnt lgkmcnt(4)
v_mfma_f32_16x16x32_bf16 v[88:91], v[208:211], v[164:167], v[88:91]
ds_read_b64_tr_b16 v[176:177], v28 offset:4096
ds_read_b64_tr_b16 v[178:179], v28 offset:4608
s_waitcnt lgkmcnt(4)
v_mfma_f32_16x16x32_bf16 v[92:95], v[196:199], v[168:171], v[92:95]
v_mfma_f32_16x16x32_bf16 v[96:99], v[200:203], v[168:171], v[96:99]
v_mfma_f32_16x16x32_bf16 v[100:103], v[204:207], v[168:171], v[100:103]
v_mfma_f32_16x16x32_bf16 v[104:107], v[208:211], v[168:171], v[104:107]
ds_read_b128 v[212:215], v32 offset:5120
s_waitcnt vmcnt(4)
ds_read_b64_tr_b16 v[140:141], v25 offset:8192
ds_read_b64_tr_b16 v[142:143], v25 offset:8704
s_waitcnt lgkmcnt(5)
v_mfma_f32_16x16x32_bf16 v[108:111], v[196:199], v[172:175], v[108:111]
ds_read_b128 v[216:219], v32 offset:13312
v_mfma_f32_16x16x32_bf16 v[112:115], v[200:203], v[172:175], v[112:115]
ds_read_b128 v[220:223], v32 offset:21504
v_mfma_f32_16x16x32_bf16 v[116:119], v[204:207], v[172:175], v[116:119]
ds_read_b128 v[224:227], v32 offset:29696
v_mfma_f32_16x16x32_bf16 v[120:123], v[208:211], v[172:175], v[120:123]
ds_read_b64_tr_b16 v[144:145], v26 offset:8192
ds_read_b64_tr_b16 v[146:147], v26 offset:8704
s_waitcnt lgkmcnt(8)
v_mfma_f32_16x16x32_bf16 v[124:127], v[196:199], v[176:179], v[124:127]
s_add_u32 m0, s63, 0x1000
s_nop 0
buffer_load_dwordx4 v17, s[44:47], s73 offen offset:0 lds
buffer_load_dwordx4 v18, s[44:47], s73 offen offset:1024 lds
buffer_load_dwordx4 v19, s[44:47], s73 offen offset:2048 lds
buffer_load_dwordx4 v20, s[44:47], s73 offen offset:3072 lds
v_mfma_f32_16x16x32_bf16 v[128:131], v[200:203], v[176:179], v[128:131]
v_mfma_f32_16x16x32_bf16 v[132:135], v[204:207], v[176:179], v[132:135]
v_mfma_f32_16x16x32_bf16 v[136:139], v[208:211], v[176:179], v[136:139]
ds_read_b64_tr_b16 v[148:149], v27 offset:8192
ds_read_b64_tr_b16 v[150:151], v27 offset:8704
s_waitcnt lgkmcnt(7)
v_mfma_f32_16x16x32_bf16 v[76:79], v[212:215], v[140:143], v[76:79]
s_waitcnt lgkmcnt(6)
v_mfma_f32_16x16x32_bf16 v[80:83], v[216:219], v[140:143], v[80:83]
s_waitcnt lgkmcnt(5)
v_mfma_f32_16x16x32_bf16 v[84:87], v[220:223], v[140:143], v[84:87]
s_waitcnt lgkmcnt(4)
v_mfma_f32_16x16x32_bf16 v[88:91], v[224:227], v[140:143], v[88:91]
ds_read_b64_tr_b16 v[152:153], v28 offset:8192
ds_read_b64_tr_b16 v[154:155], v28 offset:8704
s_waitcnt lgkmcnt(4)
v_mfma_f32_16x16x32_bf16 v[92:95], v[212:215], v[144:147], v[92:95]
v_mfma_f32_16x16x32_bf16 v[96:99], v[216:219], v[144:147], v[96:99]
v_mfma_f32_16x16x32_bf16 v[100:103], v[220:223], v[144:147], v[100:103]
v_mfma_f32_16x16x32_bf16 v[104:107], v[224:227], v[144:147], v[104:107]
ds_read_b128 v[180:183], v31 offset:6144
s_waitcnt vmcnt(4)
ds_read_b64_tr_b16 v[156:157], v25 offset:0
ds_read_b64_tr_b16 v[158:159], v25 offset:512
s_waitcnt lgkmcnt(5)
v_mfma_f32_16x16x32_bf16 v[108:111], v[212:215], v[148:151], v[108:111]
ds_read_b128 v[184:187], v31 offset:14336
v_mfma_f32_16x16x32_bf16 v[112:115], v[216:219], v[148:151], v[112:115]
ds_read_b128 v[188:191], v31 offset:22528
v_mfma_f32_16x16x32_bf16 v[116:119], v[220:223], v[148:151], v[116:119]
ds_read_b128 v[192:195], v31 offset:30720
v_mfma_f32_16x16x32_bf16 v[120:123], v[224:227], v[148:151], v[120:123]
ds_read_b64_tr_b16 v[160:161], v26 offset:0
ds_read_b64_tr_b16 v[162:163], v26 offset:512
s_waitcnt lgkmcnt(8)
v_mfma_f32_16x16x32_bf16 v[124:127], v[212:215], v[152:155], v[124:127]
v_mfma_f32_16x16x32_bf16 v[128:131], v[216:219], v[152:155], v[128:131]
v_mfma_f32_16x16x32_bf16 v[132:135], v[220:223], v[152:155], v[132:135]
v_mfma_f32_16x16x32_bf16 v[136:139], v[224:227], v[152:155], v[136:139]
ds_read_b64_tr_b16 v[164:165], v27 offset:0
ds_read_b64_tr_b16 v[166:167], v27 offset:512
s_waitcnt lgkmcnt(7)
v_mfma_f32_16x16x32_bf16 v[76:79], v[180:183], v[156:159], v[76:79]
s_waitcnt lgkmcnt(6)
v_mfma_f32_16x16x32_bf16 v[80:83], v[184:187], v[156:159], v[80:83]
s_waitcnt lgkmcnt(5)
v_mfma_f32_16x16x32_bf16 v[84:87], v[188:191], v[156:159], v[84:87]
s_waitcnt lgkmcnt(4)
v_mfma_f32_16x16x32_bf16 v[88:91], v[192:195], v[156:159], v[88:91]
ds_read_b64_tr_b16 v[168:169], v28 offset:0
ds_read_b64_tr_b16 v[170:171], v28 offset:512
s_waitcnt lgkmcnt(4)
v_mfma_f32_16x16x32_bf16 v[92:95], v[180:183], v[160:163], v[92:95]
v_mfma_f32_16x16x32_bf16 v[96:99], v[184:187], v[160:163], v[96:99]
v_mfma_f32_16x16x32_bf16 v[100:103], v[188:191], v[160:163], v[100:103]
v_mfma_f32_16x16x32_bf16 v[104:107], v[192:195], v[160:163], v[104:107]
ds_read_b128 v[196:199], v32 offset:7168
s_waitcnt vmcnt(0)
ds_read_b64_tr_b16 v[172:173], v25 offset:4096
ds_read_b64_tr_b16 v[174:175], v25 offset:4608
s_waitcnt lgkmcnt(5)
v_mfma_f32_16x16x32_bf16 v[108:111], v[180:183], v[164:167], v[108:111]
ds_read_b128 v[200:203], v32 offset:15360
v_mfma_f32_16x16x32_bf16 v[112:115], v[184:187], v[164:167], v[112:115]
ds_read_b128 v[204:207], v32 offset:23552
v_mfma_f32_16x16x32_bf16 v[116:119], v[188:191], v[164:167], v[116:119]
ds_read_b128 v[208:211], v32 offset:31744
v_mfma_f32_16x16x32_bf16 v[120:123], v[192:195], v[164:167], v[120:123]
ds_read_b64_tr_b16 v[176:177], v26 offset:4096
ds_read_b64_tr_b16 v[178:179], v26 offset:4608
s_waitcnt lgkmcnt(8)
v_mfma_f32_16x16x32_bf16 v[124:127], v[180:183], v[168:171], v[124:127]
v_mfma_f32_16x16x32_bf16 v[128:131], v[184:187], v[168:171], v[128:131]
v_mfma_f32_16x16x32_bf16 v[132:135], v[188:191], v[168:171], v[132:135]
v_mfma_f32_16x16x32_bf16 v[136:139], v[192:195], v[168:171], v[136:139]
ds_read_b64_tr_b16 v[140:141], v27 offset:4096
ds_read_b64_tr_b16 v[142:143], v27 offset:4608
s_waitcnt lgkmcnt(7)
v_mfma_f32_16x16x32_bf16 v[76:79], v[196:199], v[172:175], v[76:79]
s_waitcnt lgkmcnt(6)
v_mfma_f32_16x16x32_bf16 v[80:83], v[200:203], v[172:175], v[80:83]
s_waitcnt lgkmcnt(5)
v_mfma_f32_16x16x32_bf16 v[84:87], v[204:207], v[172:175], v[84:87]
s_waitcnt lgkmcnt(4)
v_mfma_f32_16x16x32_bf16 v[88:91], v[208:211], v[172:175], v[88:91]
ds_read_b64_tr_b16 v[144:145], v28 offset:4096
ds_read_b64_tr_b16 v[146:147], v28 offset:4608
s_waitcnt lgkmcnt(4)
v_mfma_f32_16x16x32_bf16 v[92:95], v[196:199], v[176:179], v[92:95]
v_cvt_pk_bf16_f32 v76, v76, v77
v_cvt_pk_bf16_f32 v77, v78, v79
v_cvt_pk_bf16_f32 v78, v80, v81
v_cvt_pk_bf16_f32 v79, v82, v83
buffer_store_dwordx4 v[76:79], v16, s[52:55], s82 offen offset:0 sc1
v_mfma_f32_16x16x32_bf16 v[96:99], v[200:203], v[176:179], v[96:99]
v_mfma_f32_16x16x32_bf16 v[100:103], v[204:207], v[176:179], v[100:103]
v_cvt_pk_bf16_f32 v84, v84, v85
v_cvt_pk_bf16_f32 v85, v86, v87
v_cvt_pk_bf16_f32 v86, v88, v89
v_cvt_pk_bf16_f32 v87, v90, v91
buffer_store_dwordx4 v[84:87], v16, s[52:55], s82 offen offset:2048 sc1
v_mfma_f32_16x16x32_bf16 v[104:107], v[208:211], v[176:179], v[104:107]
s_waitcnt lgkmcnt(2)
v_mfma_f32_16x16x32_bf16 v[108:111], v[196:199], v[140:143], v[108:111]
v_cvt_pk_bf16_f32 v92, v92, v93
v_cvt_pk_bf16_f32 v93, v94, v95
v_cvt_pk_bf16_f32 v94, v96, v97
v_cvt_pk_bf16_f32 v95, v98, v99
buffer_store_dwordx4 v[92:95], v16, s[52:55], s82 offen offset:1024 sc1
v_mfma_f32_16x16x32_bf16 v[112:115], v[200:203], v[140:143], v[112:115]
v_mfma_f32_16x16x32_bf16 v[116:119], v[204:207], v[140:143], v[116:119]
v_cvt_pk_bf16_f32 v100, v100, v101
v_cvt_pk_bf16_f32 v101, v102, v103
v_cvt_pk_bf16_f32 v102, v104, v105
v_cvt_pk_bf16_f32 v103, v106, v107
buffer_store_dwordx4 v[100:103], v16, s[52:55], s82 offen offset:3072 sc1
v_mfma_f32_16x16x32_bf16 v[120:123], v[208:211], v[140:143], v[120:123]
s_waitcnt lgkmcnt(0)
v_mfma_f32_16x16x32_bf16 v[124:127], v[196:199], v[144:147], v[124:127]
v_cvt_pk_bf16_f32 v108, v108, v109
v_cvt_pk_bf16_f32 v109, v110, v111
v_cvt_pk_bf16_f32 v110, v112, v113
v_cvt_pk_bf16_f32 v111, v114, v115
buffer_store_dwordx4 v[108:111], v16, s[52:55], s83 offen offset:0 sc1
v_mfma_f32_16x16x32_bf16 v[128:131], v[200:203], v[144:147], v[128:131]
v_mfma_f32_16x16x32_bf16 v[132:135], v[204:207], v[144:147], v[132:135]
v_cvt_pk_bf16_f32 v116, v116, v117
v_cvt_pk_bf16_f32 v117, v118, v119
v_cvt_pk_bf16_f32 v118, v120, v121
v_cvt_pk_bf16_f32 v119, v122, v123
buffer_store_dwordx4 v[116:119], v16, s[52:55], s83 offen offset:2048 sc1
v_mfma_f32_16x16x32_bf16 v[136:139], v[208:211], v[144:147], v[136:139]
v_cvt_pk_bf16_f32 v124, v124, v125
v_cvt_pk_bf16_f32 v125, v126, v127
v_cvt_pk_bf16_f32 v126, v128, v129
v_cvt_pk_bf16_f32 v127, v130, v131
buffer_store_dwordx4 v[124:127], v16, s[52:55], s83 offen offset:1024 sc1
v_cvt_pk_bf16_f32 v132, v132, v133
v_cvt_pk_bf16_f32 v133, v134, v135
s_nop 0
v_cvt_pk_bf16_f32 v134, v136, v137
v_cvt_pk_bf16_f32 v135, v138, v139
buffer_store_dwordx4 v[132:135], v16, s[52:55], s83 offen offset:3072 sc1
s_branch LM_pub
LM_light:
s_mov_b32 s61, 1
s_waitcnt lgkmcnt(0)
s_mov_b32 s98, 0x7c3ff80
s_load_dwordx2 s[98:99], s[38:39], s98
s_branch L1_fin
LM_edge:
s_sub_u32 s4, s3, 30
s_lshl_b32 s8, s8, 1
s_add_u32 s4, s4, s8
s_add_u32 s91, s4, 240
s_cmp_ge_u32 s4, 14
s_cselect_b32 s61, 1, 0
s_mul_i32 s6, s4, 40000
v_lshlrev_b32 v5, 4, v0
v_lshlrev_b32 v6, 2, v2
v_add_u32 v6, 0x10000, v6
v_mov_b32 v7, 0
ds_write_b32 v6, v7
s_mov_b32 s66, 0
s_mov_b32 s67, 4096
s_mov_b32 s68, 8192
s_mov_b32 s69, 12288
s_mov_b32 s70, 16384
s_mov_b32 s71, 20480
s_mov_b32 s72, 24576
s_mov_b32 s73, 28672
s_mov_b32 s74, 32768
s_mov_b32 s75, 36864
s_waitcnt lgkmcnt(0)
s_add_u32 s40, s20, 0x0
s_addc_u32 s41, s21, 0
s_add_u32 s40, s40, s6
s_addc_u32 s41, s41, 0
s_mov_b32 s42, 0x9c40
s_mov_b32 s43, 0x00020000
s_add_u32 s44, s18, 0x0
s_addc_u32 s45, s19, 0
s_add_u32 s44, s44, s6
s_addc_u32 s45, s45, 0
s_mov_b32 s46, 0x9c40
s_mov_b32 s47, 0x00020000
buffer_load_dwordx4 v[16:19], v5, s[40:43], s66 offen
buffer_load_dwordx4 v[20:23], v5, s[40:43], s67 offen
buffer_load_dwordx4 v[24:27], v5, s[40:43], s68 offen
buffer_load_dwordx4 v[28:31], v5, s[40:43], s69 offen
buffer_load_dwordx4 v[32:35], v5, s[40:43], s70 offen
buffer_load_dwordx4 v[36:39], v5, s[40:43], s71 offen
buffer_load_dwordx4 v[40:43], v5, s[40:43], s72 offen
buffer_load_dwordx4 v[44:47], v5, s[40:43], s73 offen
buffer_load_dwordx4 v[48:51], v5, s[40:43], s74 offen
buffer_load_dwordx4 v[52:55], v5, s[40:43], s75 offen
buffer_load_dwordx4 v[56:59], v5, s[44:47], s66 offen
buffer_load_dwordx4 v[60:63], v5, s[44:47], s67 offen
buffer_load_dwordx4 v[64:67], v5, s[44:47], s68 offen
buffer_load_dwordx4 v[68:71], v5, s[44:47], s69 offen
buffer_load_dwordx4 v[72:75], v5, s[44:47], s70 offen
buffer_load_dwordx4 v[76:79], v5, s[44:47], s71 offen
buffer_load_dwordx4 v[80:83], v5, s[44:47], s72 offen
buffer_load_dwordx4 v[84:87], v5, s[44:47], s73 offen
buffer_load_dwordx4 v[88:91], v5, s[44:47], s74 offen
buffer_load_dwordx4 v[92:95], v5, s[44:47], s75 offen
s_mov_b32 s98, 0x7c3ff80
s_load_dwordx2 s[98:99], s[38:39], s98
s_add_u32 s48, s38, 0x8000000
s_addc_u32 s49, s39, 0
s_mov_b32 s50, 0x2800000
s_mov_b32 s51, 0x00020000
s_add_u32 s52, s38, 0x7800000
s_addc_u32 s53, s39, 0
s_mov_b32 s54, 0x1000
s_mov_b32 s55, 0x00020000
v_mov_b32 v240, 6945
v_mov_b32 v241, 0x0
v_mov_b32 v242, 6317
v_mov_b32 v243, 0x340674
v_mov_b32 v244, 6899
v_mov_b32 v245, 0xfffae6a0
v_mov_b32 v246, 6242
v_mov_b32 v247, 0x4484a0
s_mov_b32 s11, 0x10000
v_mov_b32 v7, 1
v_cmp_gt_u32 vcc, 0xc4, v0
s_mov_b64 s[12:13], vcc
s_barrier
s_waitcnt vmcnt(19)
v_cmp_le_u32 vcc, 5436, v16
s_nop 1
v_cndmask_b32 v96, v240, v242, vcc
v_cndmask_b32 v136, v241, v243, vcc
v_cmp_le_u32 vcc, 6432, v16
s_nop 1
v_cndmask_b32 v96, v96, v244, vcc
v_cndmask_b32 v136, v136, v245, vcc
v_cmp_le_u32 vcc, 7344, v16
s_nop 1
v_cndmask_b32 v96, v96, v246, vcc
v_cndmask_b32 v136, v136, v247, vcc
v_mad_u32_u24 v96, v96, v16, v136
v_lshrrev_b32 v96, 20, v96
v_lshl_add_u32 v136, v96, 2, s11
ds_add_rtn_u32 v136, v136, v7
v_cmp_le_u32 vcc, 5436, v17
s_nop 1
v_cndmask_b32 v97, v240, v242, vcc
v_cndmask_b32 v137, v241, v243, vcc
v_cmp_le_u32 vcc, 6432, v17
s_nop 1
v_cndmask_b32 v97, v97, v244, vcc
v_cndmask_b32 v137, v137, v245, vcc
v_cmp_le_u32 vcc, 7344, v17
s_nop 1
v_cndmask_b32 v97, v97, v246, vcc
v_cndmask_b32 v137, v137, v247, vcc
v_mad_u32_u24 v97, v97, v17, v137
v_lshrrev_b32 v97, 20, v97
v_lshl_add_u32 v137, v97, 2, s11
ds_add_rtn_u32 v137, v137, v7
v_cmp_le_u32 vcc, 5436, v18
s_nop 1
v_cndmask_b32 v98, v240, v242, vcc
v_cndmask_b32 v138, v241, v243, vcc
v_cmp_le_u32 vcc, 6432, v18
s_nop 1
v_cndmask_b32 v98, v98, v244, vcc
v_cndmask_b32 v138, v138, v245, vcc
v_cmp_le_u32 vcc, 7344, v18
s_nop 1
v_cndmask_b32 v98, v98, v246, vcc
v_cndmask_b32 v138, v138, v247, vcc
v_mad_u32_u24 v98, v98, v18, v138
v_lshrrev_b32 v98, 20, v98
v_lshl_add_u32 v138, v98, 2, s11
ds_add_rtn_u32 v138, v138, v7
v_cmp_le_u32 vcc, 5436, v19
s_nop 1
v_cndmask_b32 v99, v240, v242, vcc
v_cndmask_b32 v139, v241, v243, vcc
v_cmp_le_u32 vcc, 6432, v19
s_nop 1
v_cndmask_b32 v99, v99, v244, vcc
v_cndmask_b32 v139, v139, v245, vcc
v_cmp_le_u32 vcc, 7344, v19
s_nop 1
v_cndmask_b32 v99, v99, v246, vcc
v_cndmask_b32 v139, v139, v247, vcc
v_mad_u32_u24 v99, v99, v19, v139
v_lshrrev_b32 v99, 20, v99
v_lshl_add_u32 v139, v99, 2, s11
ds_add_rtn_u32 v139, v139, v7
s_waitcnt vmcnt(18)
v_cmp_le_u32 vcc, 5436, v20
s_nop 1
v_cndmask_b32 v100, v240, v242, vcc
v_cndmask_b32 v140, v241, v243, vcc
v_cmp_le_u32 vcc, 6432, v20
s_nop 1
v_cndmask_b32 v100, v100, v244, vcc
v_cndmask_b32 v140, v140, v245, vcc
v_cmp_le_u32 vcc, 7344, v20
s_nop 1
v_cndmask_b32 v100, v100, v246, vcc
v_cndmask_b32 v140, v140, v247, vcc
v_mad_u32_u24 v100, v100, v20, v140
v_lshrrev_b32 v100, 20, v100
v_lshl_add_u32 v140, v100, 2, s11
ds_add_rtn_u32 v140, v140, v7
v_cmp_le_u32 vcc, 5436, v21
s_nop 1
v_cndmask_b32 v101, v240, v242, vcc
v_cndmask_b32 v141, v241, v243, vcc
v_cmp_le_u32 vcc, 6432, v21
s_nop 1
v_cndmask_b32 v101, v101, v244, vcc
v_cndmask_b32 v141, v141, v245, vcc
v_cmp_le_u32 vcc, 7344, v21
s_nop 1
v_cndmask_b32 v101, v101, v246, vcc
v_cndmask_b32 v141, v141, v247, vcc
v_mad_u32_u24 v101, v101, v21, v141
v_lshrrev_b32 v101, 20, v101
v_lshl_add_u32 v141, v101, 2, s11
ds_add_rtn_u32 v141, v141, v7
v_cmp_le_u32 vcc, 5436, v22
s_nop 1
v_cndmask_b32 v102, v240, v242, vcc
v_cndmask_b32 v142, v241, v243, vcc
v_cmp_le_u32 vcc, 6432, v22
s_nop 1
v_cndmask_b32 v102, v102, v244, vcc
v_cndmask_b32 v142, v142, v245, vcc
v_cmp_le_u32 vcc, 7344, v22
s_nop 1
v_cndmask_b32 v102, v102, v246, vcc
v_cndmask_b32 v142, v142, v247, vcc
v_mad_u32_u24 v102, v102, v22, v142
v_lshrrev_b32 v102, 20, v102
v_lshl_add_u32 v142, v102, 2, s11
ds_add_rtn_u32 v142, v142, v7
v_cmp_le_u32 vcc, 5436, v23
s_nop 1
v_cndmask_b32 v103, v240, v242, vcc
v_cndmask_b32 v143, v241, v243, vcc
v_cmp_le_u32 vcc, 6432, v23
s_nop 1
v_cndmask_b32 v103, v103, v244, vcc
v_cndmask_b32 v143, v143, v245, vcc
v_cmp_le_u32 vcc, 7344, v23
s_nop 1
v_cndmask_b32 v103, v103, v246, vcc
v_cndmask_b32 v143, v143, v247, vcc
v_mad_u32_u24 v103, v103, v23, v143
v_lshrrev_b32 v103, 20, v103
v_lshl_add_u32 v143, v103, 2, s11
ds_add_rtn_u32 v143, v143, v7
s_waitcnt vmcnt(17)
v_cmp_le_u32 vcc, 5436, v24
s_nop 1
v_cndmask_b32 v104, v240, v242, vcc
v_cndmask_b32 v144, v241, v243, vcc
v_cmp_le_u32 vcc, 6432, v24
s_nop 1
v_cndmask_b32 v104, v104, v244, vcc
v_cndmask_b32 v144, v144, v245, vcc
v_cmp_le_u32 vcc, 7344, v24
s_nop 1
v_cndmask_b32 v104, v104, v246, vcc
v_cndmask_b32 v144, v144, v247, vcc
v_mad_u32_u24 v104, v104, v24, v144
v_lshrrev_b32 v104, 20, v104
v_lshl_add_u32 v144, v104, 2, s11
ds_add_rtn_u32 v144, v144, v7
v_cmp_le_u32 vcc, 5436, v25
s_nop 1
v_cndmask_b32 v105, v240, v242, vcc
v_cndmask_b32 v145, v241, v243, vcc
v_cmp_le_u32 vcc, 6432, v25
s_nop 1
v_cndmask_b32 v105, v105, v244, vcc
v_cndmask_b32 v145, v145, v245, vcc
v_cmp_le_u32 vcc, 7344, v25
s_nop 1
v_cndmask_b32 v105, v105, v246, vcc
v_cndmask_b32 v145, v145, v247, vcc
v_mad_u32_u24 v105, v105, v25, v145
v_lshrrev_b32 v105, 20, v105
v_lshl_add_u32 v145, v105, 2, s11
ds_add_rtn_u32 v145, v145, v7
v_cmp_le_u32 vcc, 5436, v26
s_nop 1
v_cndmask_b32 v106, v240, v242, vcc
v_cndmask_b32 v146, v241, v243, vcc
v_cmp_le_u32 vcc, 6432, v26
s_nop 1
v_cndmask_b32 v106, v106, v244, vcc
v_cndmask_b32 v146, v146, v245, vcc
v_cmp_le_u32 vcc, 7344, v26
s_nop 1
v_cndmask_b32 v106, v106, v246, vcc
v_cndmask_b32 v146, v146, v247, vcc
v_mad_u32_u24 v106, v106, v26, v146
v_lshrrev_b32 v106, 20, v106
v_lshl_add_u32 v146, v106, 2, s11
ds_add_rtn_u32 v146, v146, v7
v_cmp_le_u32 vcc, 5436, v27
s_nop 1
v_cndmask_b32 v107, v240, v242, vcc
v_cndmask_b32 v147, v241, v243, vcc
v_cmp_le_u32 vcc, 6432, v27
s_nop 1
v_cndmask_b32 v107, v107, v244, vcc
v_cndmask_b32 v147, v147, v245, vcc
v_cmp_le_u32 vcc, 7344, v27
s_nop 1
v_cndmask_b32 v107, v107, v246, vcc
v_cndmask_b32 v147, v147, v247, vcc
v_mad_u32_u24 v107, v107, v27, v147
v_lshrrev_b32 v107, 20, v107
v_lshl_add_u32 v147, v107, 2, s11
ds_add_rtn_u32 v147, v147, v7
s_waitcnt vmcnt(16)
v_cmp_le_u32 vcc, 5436, v28
s_nop 1
v_cndmask_b32 v108, v240, v242, vcc
v_cndmask_b32 v148, v241, v243, vcc
v_cmp_le_u32 vcc, 6432, v28
s_nop 1
v_cndmask_b32 v108, v108, v244, vcc
v_cndmask_b32 v148, v148, v245, vcc
v_cmp_le_u32 vcc, 7344, v28
s_nop 1
v_cndmask_b32 v108, v108, v246, vcc
v_cndmask_b32 v148, v148, v247, vcc
v_mad_u32_u24 v108, v108, v28, v148
v_lshrrev_b32 v108, 20, v108
v_lshl_add_u32 v148, v108, 2, s11
ds_add_rtn_u32 v148, v148, v7
v_cmp_le_u32 vcc, 5436, v29
s_nop 1
v_cndmask_b32 v109, v240, v242, vcc
v_cndmask_b32 v149, v241, v243, vcc
v_cmp_le_u32 vcc, 6432, v29
s_nop 1
v_cndmask_b32 v109, v109, v244, vcc
v_cndmask_b32 v149, v149, v245, vcc
v_cmp_le_u32 vcc, 7344, v29
s_nop 1
v_cndmask_b32 v109, v109, v246, vcc
v_cndmask_b32 v149, v149, v247, vcc
v_mad_u32_u24 v109, v109, v29, v149
v_lshrrev_b32 v109, 20, v109
v_lshl_add_u32 v149, v109, 2, s11
ds_add_rtn_u32 v149, v149, v7
v_cmp_le_u32 vcc, 5436, v30
s_nop 1
v_cndmask_b32 v110, v240, v242, vcc
v_cndmask_b32 v150, v241, v243, vcc
v_cmp_le_u32 vcc, 6432, v30
s_nop 1
v_cndmask_b32 v110, v110, v244, vcc
v_cndmask_b32 v150, v150, v245, vcc
v_cmp_le_u32 vcc, 7344, v30
s_nop 1
v_cndmask_b32 v110, v110, v246, vcc
v_cndmask_b32 v150, v150, v247, vcc
v_mad_u32_u24 v110, v110, v30, v150
v_lshrrev_b32 v110, 20, v110
v_lshl_add_u32 v150, v110, 2, s11
ds_add_rtn_u32 v150, v150, v7
v_cmp_le_u32 vcc, 5436, v31
s_nop 1
v_cndmask_b32 v111, v240, v242, vcc
v_cndmask_b32 v151, v241, v243, vcc
v_cmp_le_u32 vcc, 6432, v31
s_nop 1
v_cndmask_b32 v111, v111, v244, vcc
v_cndmask_b32 v151, v151, v245, vcc
v_cmp_le_u32 vcc, 7344, v31
s_nop 1
v_cndmask_b32 v111, v111, v246, vcc
v_cndmask_b32 v151, v151, v247, vcc
v_mad_u32_u24 v111, v111, v31, v151
v_lshrrev_b32 v111, 20, v111
v_lshl_add_u32 v151, v111, 2, s11
ds_add_rtn_u32 v151, v151, v7
s_waitcnt vmcnt(15)
v_cmp_le_u32 vcc, 5436, v32
s_nop 1
v_cndmask_b32 v112, v240, v242, vcc
v_cndmask_b32 v152, v241, v243, vcc
v_cmp_le_u32 vcc, 6432, v32
s_nop 1
v_cndmask_b32 v112, v112, v244, vcc
v_cndmask_b32 v152, v152, v245, vcc
v_cmp_le_u32 vcc, 7344, v32
s_nop 1
v_cndmask_b32 v112, v112, v246, vcc
v_cndmask_b32 v152, v152, v247, vcc
v_mad_u32_u24 v112, v112, v32, v152
v_lshrrev_b32 v112, 20, v112
v_lshl_add_u32 v152, v112, 2, s11
ds_add_rtn_u32 v152, v152, v7
v_cmp_le_u32 vcc, 5436, v33
s_nop 1
v_cndmask_b32 v113, v240, v242, vcc
v_cndmask_b32 v153, v241, v243, vcc
v_cmp_le_u32 vcc, 6432, v33
s_nop 1
v_cndmask_b32 v113, v113, v244, vcc
v_cndmask_b32 v153, v153, v245, vcc
v_cmp_le_u32 vcc, 7344, v33
s_nop 1
v_cndmask_b32 v113, v113, v246, vcc
v_cndmask_b32 v153, v153, v247, vcc
v_mad_u32_u24 v113, v113, v33, v153
v_lshrrev_b32 v113, 20, v113
v_lshl_add_u32 v153, v113, 2, s11
ds_add_rtn_u32 v153, v153, v7
v_cmp_le_u32 vcc, 5436, v34
s_nop 1
v_cndmask_b32 v114, v240, v242, vcc
v_cndmask_b32 v154, v241, v243, vcc
v_cmp_le_u32 vcc, 6432, v34
s_nop 1
v_cndmask_b32 v114, v114, v244, vcc
v_cndmask_b32 v154, v154, v245, vcc
v_cmp_le_u32 vcc, 7344, v34
s_nop 1
v_cndmask_b32 v114, v114, v246, vcc
v_cndmask_b32 v154, v154, v247, vcc
v_mad_u32_u24 v114, v114, v34, v154
v_lshrrev_b32 v114, 20, v114
v_lshl_add_u32 v154, v114, 2, s11
ds_add_rtn_u32 v154, v154, v7
v_cmp_le_u32 vcc, 5436, v35
s_nop 1
v_cndmask_b32 v115, v240, v242, vcc
v_cndmask_b32 v155, v241, v243, vcc
v_cmp_le_u32 vcc, 6432, v35
s_nop 1
v_cndmask_b32 v115, v115, v244, vcc
v_cndmask_b32 v155, v155, v245, vcc
v_cmp_le_u32 vcc, 7344, v35
s_nop 1
v_cndmask_b32 v115, v115, v246, vcc
v_cndmask_b32 v155, v155, v247, vcc
v_mad_u32_u24 v115, v115, v35, v155
v_lshrrev_b32 v115, 20, v115
v_lshl_add_u32 v155, v115, 2, s11
ds_add_rtn_u32 v155, v155, v7
s_waitcnt vmcnt(14)
v_cmp_le_u32 vcc, 5436, v36
s_nop 1
v_cndmask_b32 v116, v240, v242, vcc
v_cndmask_b32 v156, v241, v243, vcc
v_cmp_le_u32 vcc, 6432, v36
s_nop 1
v_cndmask_b32 v116, v116, v244, vcc
v_cndmask_b32 v156, v156, v245, vcc
v_cmp_le_u32 vcc, 7344, v36
s_nop 1
v_cndmask_b32 v116, v116, v246, vcc
v_cndmask_b32 v156, v156, v247, vcc
v_mad_u32_u24 v116, v116, v36, v156
v_lshrrev_b32 v116, 20, v116
v_lshl_add_u32 v156, v116, 2, s11
ds_add_rtn_u32 v156, v156, v7
v_cmp_le_u32 vcc, 5436, v37
s_nop 1
v_cndmask_b32 v117, v240, v242, vcc
v_cndmask_b32 v157, v241, v243, vcc
v_cmp_le_u32 vcc, 6432, v37
s_nop 1
v_cndmask_b32 v117, v117, v244, vcc
v_cndmask_b32 v157, v157, v245, vcc
v_cmp_le_u32 vcc, 7344, v37
s_nop 1
v_cndmask_b32 v117, v117, v246, vcc
v_cndmask_b32 v157, v157, v247, vcc
v_mad_u32_u24 v117, v117, v37, v157
v_lshrrev_b32 v117, 20, v117
v_lshl_add_u32 v157, v117, 2, s11
ds_add_rtn_u32 v157, v157, v7
v_cmp_le_u32 vcc, 5436, v38
s_nop 1
v_cndmask_b32 v118, v240, v242, vcc
v_cndmask_b32 v158, v241, v243, vcc
v_cmp_le_u32 vcc, 6432, v38
s_nop 1
v_cndmask_b32 v118, v118, v244, vcc
v_cndmask_b32 v158, v158, v245, vcc
v_cmp_le_u32 vcc, 7344, v38
s_nop 1
v_cndmask_b32 v118, v118, v246, vcc
v_cndmask_b32 v158, v158, v247, vcc
v_mad_u32_u24 v118, v118, v38, v158
v_lshrrev_b32 v118, 20, v118
v_lshl_add_u32 v158, v118, 2, s11
ds_add_rtn_u32 v158, v158, v7
v_cmp_le_u32 vcc, 5436, v39
s_nop 1
v_cndmask_b32 v119, v240, v242, vcc
v_cndmask_b32 v159, v241, v243, vcc
v_cmp_le_u32 vcc, 6432, v39
s_nop 1
v_cndmask_b32 v119, v119, v244, vcc
v_cndmask_b32 v159, v159, v245, vcc
v_cmp_le_u32 vcc, 7344, v39
s_nop 1
v_cndmask_b32 v119, v119, v246, vcc
v_cndmask_b32 v159, v159, v247, vcc
v_mad_u32_u24 v119, v119, v39, v159
v_lshrrev_b32 v119, 20, v119
v_lshl_add_u32 v159, v119, 2, s11
ds_add_rtn_u32 v159, v159, v7
s_waitcnt vmcnt(13)
v_cmp_le_u32 vcc, 5436, v40
s_nop 1
v_cndmask_b32 v120, v240, v242, vcc
v_cndmask_b32 v160, v241, v243, vcc
v_cmp_le_u32 vcc, 6432, v40
s_nop 1
v_cndmask_b32 v120, v120, v244, vcc
v_cndmask_b32 v160, v160, v245, vcc
v_cmp_le_u32 vcc, 7344, v40
s_nop 1
v_cndmask_b32 v120, v120, v246, vcc
v_cndmask_b32 v160, v160, v247, vcc
v_mad_u32_u24 v120, v120, v40, v160
v_lshrrev_b32 v120, 20, v120
v_lshl_add_u32 v160, v120, 2, s11
ds_add_rtn_u32 v160, v160, v7
v_cmp_le_u32 vcc, 5436, v41
s_nop 1
v_cndmask_b32 v121, v240, v242, vcc
v_cndmask_b32 v161, v241, v243, vcc
v_cmp_le_u32 vcc, 6432, v41
s_nop 1
v_cndmask_b32 v121, v121, v244, vcc
v_cndmask_b32 v161, v161, v245, vcc
v_cmp_le_u32 vcc, 7344, v41
s_nop 1
v_cndmask_b32 v121, v121, v246, vcc
v_cndmask_b32 v161, v161, v247, vcc
v_mad_u32_u24 v121, v121, v41, v161
v_lshrrev_b32 v121, 20, v121
v_lshl_add_u32 v161, v121, 2, s11
ds_add_rtn_u32 v161, v161, v7
v_cmp_le_u32 vcc, 5436, v42
s_nop 1
v_cndmask_b32 v122, v240, v242, vcc
v_cndmask_b32 v162, v241, v243, vcc
v_cmp_le_u32 vcc, 6432, v42
s_nop 1
v_cndmask_b32 v122, v122, v244, vcc
v_cndmask_b32 v162, v162, v245, vcc
v_cmp_le_u32 vcc, 7344, v42
s_nop 1
v_cndmask_b32 v122, v122, v246, vcc
v_cndmask_b32 v162, v162, v247, vcc
v_mad_u32_u24 v122, v122, v42, v162
v_lshrrev_b32 v122, 20, v122
v_lshl_add_u32 v162, v122, 2, s11
ds_add_rtn_u32 v162, v162, v7
v_cmp_le_u32 vcc, 5436, v43
s_nop 1
v_cndmask_b32 v123, v240, v242, vcc
v_cndmask_b32 v163, v241, v243, vcc
v_cmp_le_u32 vcc, 6432, v43
s_nop 1
v_cndmask_b32 v123, v123, v244, vcc
v_cndmask_b32 v163, v163, v245, vcc
v_cmp_le_u32 vcc, 7344, v43
s_nop 1
v_cndmask_b32 v123, v123, v246, vcc
v_cndmask_b32 v163, v163, v247, vcc
v_mad_u32_u24 v123, v123, v43, v163
v_lshrrev_b32 v123, 20, v123
v_lshl_add_u32 v163, v123, 2, s11
ds_add_rtn_u32 v163, v163, v7
s_waitcnt vmcnt(12)
v_cmp_le_u32 vcc, 5436, v44
s_nop 1
v_cndmask_b32 v124, v240, v242, vcc
v_cndmask_b32 v164, v241, v243, vcc
v_cmp_le_u32 vcc, 6432, v44
s_nop 1
v_cndmask_b32 v124, v124, v244, vcc
v_cndmask_b32 v164, v164, v245, vcc
v_cmp_le_u32 vcc, 7344, v44
s_nop 1
v_cndmask_b32 v124, v124, v246, vcc
v_cndmask_b32 v164, v164, v247, vcc
v_mad_u32_u24 v124, v124, v44, v164
v_lshrrev_b32 v124, 20, v124
v_lshl_add_u32 v164, v124, 2, s11
ds_add_rtn_u32 v164, v164, v7
v_cmp_le_u32 vcc, 5436, v45
s_nop 1
v_cndmask_b32 v125, v240, v242, vcc
v_cndmask_b32 v165, v241, v243, vcc
v_cmp_le_u32 vcc, 6432, v45
s_nop 1
v_cndmask_b32 v125, v125, v244, vcc
v_cndmask_b32 v165, v165, v245, vcc
v_cmp_le_u32 vcc, 7344, v45
s_nop 1
v_cndmask_b32 v125, v125, v246, vcc
v_cndmask_b32 v165, v165, v247, vcc
v_mad_u32_u24 v125, v125, v45, v165
v_lshrrev_b32 v125, 20, v125
v_lshl_add_u32 v165, v125, 2, s11
ds_add_rtn_u32 v165, v165, v7
v_cmp_le_u32 vcc, 5436, v46
s_nop 1
v_cndmask_b32 v126, v240, v242, vcc
v_cndmask_b32 v166, v241, v243, vcc
v_cmp_le_u32 vcc, 6432, v46
s_nop 1
v_cndmask_b32 v126, v126, v244, vcc
v_cndmask_b32 v166, v166, v245, vcc
v_cmp_le_u32 vcc, 7344, v46
s_nop 1
v_cndmask_b32 v126, v126, v246, vcc
v_cndmask_b32 v166, v166, v247, vcc
v_mad_u32_u24 v126, v126, v46, v166
v_lshrrev_b32 v126, 20, v126
v_lshl_add_u32 v166, v126, 2, s11
ds_add_rtn_u32 v166, v166, v7
v_cmp_le_u32 vcc, 5436, v47
s_nop 1
v_cndmask_b32 v127, v240, v242, vcc
v_cndmask_b32 v167, v241, v243, vcc
v_cmp_le_u32 vcc, 6432, v47
s_nop 1
v_cndmask_b32 v127, v127, v244, vcc
v_cndmask_b32 v167, v167, v245, vcc
v_cmp_le_u32 vcc, 7344, v47
s_nop 1
v_cndmask_b32 v127, v127, v246, vcc
v_cndmask_b32 v167, v167, v247, vcc
v_mad_u32_u24 v127, v127, v47, v167
v_lshrrev_b32 v127, 20, v127
v_lshl_add_u32 v167, v127, 2, s11
ds_add_rtn_u32 v167, v167, v7
s_waitcnt vmcnt(11)
v_cmp_le_u32 vcc, 5436, v48
s_nop 1
v_cndmask_b32 v128, v240, v242, vcc
v_cndmask_b32 v168, v241, v243, vcc
v_cmp_le_u32 vcc, 6432, v48
s_nop 1
v_cndmask_b32 v128, v128, v244, vcc
v_cndmask_b32 v168, v168, v245, vcc
v_cmp_le_u32 vcc, 7344, v48
s_nop 1
v_cndmask_b32 v128, v128, v246, vcc
v_cndmask_b32 v168, v168, v247, vcc
v_mad_u32_u24 v128, v128, v48, v168
v_lshrrev_b32 v128, 20, v128
v_lshl_add_u32 v168, v128, 2, s11
ds_add_rtn_u32 v168, v168, v7
v_cmp_le_u32 vcc, 5436, v49
s_nop 1
v_cndmask_b32 v129, v240, v242, vcc
v_cndmask_b32 v169, v241, v243, vcc
v_cmp_le_u32 vcc, 6432, v49
s_nop 1
v_cndmask_b32 v129, v129, v244, vcc
v_cndmask_b32 v169, v169, v245, vcc
v_cmp_le_u32 vcc, 7344, v49
s_nop 1
v_cndmask_b32 v129, v129, v246, vcc
v_cndmask_b32 v169, v169, v247, vcc
v_mad_u32_u24 v129, v129, v49, v169
v_lshrrev_b32 v129, 20, v129
v_lshl_add_u32 v169, v129, 2, s11
ds_add_rtn_u32 v169, v169, v7
v_cmp_le_u32 vcc, 5436, v50
s_nop 1
v_cndmask_b32 v130, v240, v242, vcc
v_cndmask_b32 v170, v241, v243, vcc
v_cmp_le_u32 vcc, 6432, v50
s_nop 1
v_cndmask_b32 v130, v130, v244, vcc
v_cndmask_b32 v170, v170, v245, vcc
v_cmp_le_u32 vcc, 7344, v50
s_nop 1
v_cndmask_b32 v130, v130, v246, vcc
v_cndmask_b32 v170, v170, v247, vcc
v_mad_u32_u24 v130, v130, v50, v170
v_lshrrev_b32 v130, 20, v130
v_lshl_add_u32 v170, v130, 2, s11
ds_add_rtn_u32 v170, v170, v7
v_cmp_le_u32 vcc, 5436, v51
s_nop 1
v_cndmask_b32 v131, v240, v242, vcc
v_cndmask_b32 v171, v241, v243, vcc
v_cmp_le_u32 vcc, 6432, v51
s_nop 1
v_cndmask_b32 v131, v131, v244, vcc
v_cndmask_b32 v171, v171, v245, vcc
v_cmp_le_u32 vcc, 7344, v51
s_nop 1
v_cndmask_b32 v131, v131, v246, vcc
v_cndmask_b32 v171, v171, v247, vcc
v_mad_u32_u24 v131, v131, v51, v171
v_lshrrev_b32 v131, 20, v131
v_lshl_add_u32 v171, v131, 2, s11
ds_add_rtn_u32 v171, v171, v7
s_waitcnt vmcnt(10)
s_mov_b64 exec, s[12:13]
v_cmp_le_u32 vcc, 5436, v52
s_nop 1
v_cndmask_b32 v132, v240, v242, vcc
v_cndmask_b32 v172, v241, v243, vcc
v_cmp_le_u32 vcc, 6432, v52
s_nop 1
v_cndmask_b32 v132, v132, v244, vcc
v_cndmask_b32 v172, v172, v245, vcc
v_cmp_le_u32 vcc, 7344, v52
s_nop 1
v_cndmask_b32 v132, v132, v246, vcc
v_cndmask_b32 v172, v172, v247, vcc
v_mad_u32_u24 v132, v132, v52, v172
v_lshrrev_b32 v132, 20, v132
v_lshl_add_u32 v172, v132, 2, s11
ds_add_rtn_u32 v172, v172, v7
v_cmp_le_u32 vcc, 5436, v53
s_nop 1
v_cndmask_b32 v133, v240, v242, vcc
v_cndmask_b32 v173, v241, v243, vcc
v_cmp_le_u32 vcc, 6432, v53
s_nop 1
v_cndmask_b32 v133, v133, v244, vcc
v_cndmask_b32 v173, v173, v245, vcc
v_cmp_le_u32 vcc, 7344, v53
s_nop 1
v_cndmask_b32 v133, v133, v246, vcc
v_cndmask_b32 v173, v173, v247, vcc
v_mad_u32_u24 v133, v133, v53, v173
v_lshrrev_b32 v133, 20, v133
v_lshl_add_u32 v173, v133, 2, s11
ds_add_rtn_u32 v173, v173, v7
v_cmp_le_u32 vcc, 5436, v54
s_nop 1
v_cndmask_b32 v134, v240, v242, vcc
v_cndmask_b32 v174, v241, v243, vcc
v_cmp_le_u32 vcc, 6432, v54
s_nop 1
v_cndmask_b32 v134, v134, v244, vcc
v_cndmask_b32 v174, v174, v245, vcc
v_cmp_le_u32 vcc, 7344, v54
s_nop 1
v_cndmask_b32 v134, v134, v246, vcc
v_cndmask_b32 v174, v174, v247, vcc
v_mad_u32_u24 v134, v134, v54, v174
v_lshrrev_b32 v134, 20, v134
v_lshl_add_u32 v174, v134, 2, s11
ds_add_rtn_u32 v174, v174, v7
v_cmp_le_u32 vcc, 5436, v55
s_nop 1
v_cndmask_b32 v135, v240, v242, vcc
v_cndmask_b32 v175, v241, v243, vcc
v_cmp_le_u32 vcc, 6432, v55
s_nop 1
v_cndmask_b32 v135, v135, v244, vcc
v_cndmask_b32 v175, v175, v245, vcc
v_cmp_le_u32 vcc, 7344, v55
s_nop 1
v_cndmask_b32 v135, v135, v246, vcc
v_cndmask_b32 v175, v175, v247, vcc
v_mad_u32_u24 v135, v135, v55, v175
v_lshrrev_b32 v135, 20, v135
v_lshl_add_u32 v175, v135, 2, s11
ds_add_rtn_u32 v175, v175, v7
s_mov_b64 exec, -1
s_waitcnt vmcnt(9) lgkmcnt(15)
v_and_b32 v8, 0xff, v136
v_lshl_or_b32 v56, v16, 18, v56
v_lshlrev_b32 v8, 2, v8
v_lshl_add_u32 v8, v96, 10, v8
ds_write_b32 v8, v56
v_and_b32 v8, 0xff, v137
v_lshl_or_b32 v57, v17, 18, v57
v_lshlrev_b32 v8, 2, v8
v_lshl_add_u32 v8, v97, 10, v8
ds_write_b32 v8, v57
v_and_b32 v8, 0xff, v138
v_lshl_or_b32 v58, v18, 18, v58
v_lshlrev_b32 v8, 2, v8
v_lshl_add_u32 v8, v98, 10, v8
ds_write_b32 v8, v58
v_and_b32 v8, 0xff, v139
v_lshl_or_b32 v59, v19, 18, v59
v_lshlrev_b32 v8, 2, v8
v_lshl_add_u32 v8, v99, 10, v8
ds_write_b32 v8, v59
s_waitcnt vmcnt(8) lgkmcnt(15)
v_and_b32 v8, 0xff, v140
v_lshl_or_b32 v60, v20, 18, v60
v_lshlrev_b32 v8, 2, v8
v_lshl_add_u32 v8, v100, 10, v8
ds_write_b32 v8, v60
v_and_b32 v8, 0xff, v141
v_lshl_or_b32 v61, v21, 18, v61
v_lshlrev_b32 v8, 2, v8
v_lshl_add_u32 v8, v101, 10, v8
ds_write_b32 v8, v61
v_and_b32 v8, 0xff, v142
v_lshl_or_b32 v62, v22, 18, v62
v_lshlrev_b32 v8, 2, v8
v_lshl_add_u32 v8, v102, 10, v8
ds_write_b32 v8, v62
v_and_b32 v8, 0xff, v143
v_lshl_or_b32 v63, v23, 18, v63
v_lshlrev_b32 v8, 2, v8
v_lshl_add_u32 v8, v103, 10, v8
ds_write_b32 v8, v63
s_waitcnt vmcnt(7) lgkmcnt(15)
v_and_b32 v8, 0xff, v144
v_lshl_or_b32 v64, v24, 18, v64
v_lshlrev_b32 v8, 2, v8
v_lshl_add_u32 v8, v104, 10, v8
ds_write_b32 v8, v64
v_and_b32 v8, 0xff, v145
v_lshl_or_b32 v65, v25, 18, v65
v_lshlrev_b32 v8, 2, v8
v_lshl_add_u32 v8, v105, 10, v8
ds_write_b32 v8, v65
v_and_b32 v8, 0xff, v146
v_lshl_or_b32 v66, v26, 18, v66
v_lshlrev_b32 v8, 2, v8
v_lshl_add_u32 v8, v106, 10, v8
ds_write_b32 v8, v66
v_and_b32 v8, 0xff, v147
v_lshl_or_b32 v67, v27, 18, v67
v_lshlrev_b32 v8, 2, v8
v_lshl_add_u32 v8, v107, 10, v8
ds_write_b32 v8, v67
s_waitcnt vmcnt(6) lgkmcnt(15)
v_and_b32 v8, 0xff, v148
v_lshl_or_b32 v68, v28, 18, v68
v_lshlrev_b32 v8, 2, v8
v_lshl_add_u32 v8, v108, 10, v8
ds_write_b32 v8, v68
v_and_b32 v8, 0xff, v149
v_lshl_or_b32 v69, v29, 18, v69
v_lshlrev_b32 v8, 2, v8
v_lshl_add_u32 v8, v109, 10, v8
ds_write_b32 v8, v69
v_and_b32 v8, 0xff, v150
v_lshl_or_b32 v70, v30, 18, v70
v_lshlrev_b32 v8, 2, v8
v_lshl_add_u32 v8, v110, 10, v8
ds_write_b32 v8, v70
v_and_b32 v8, 0xff, v151
v_lshl_or_b32 v71, v31, 18, v71
v_lshlrev_b32 v8, 2, v8
v_lshl_add_u32 v8, v111, 10, v8
ds_write_b32 v8, v71
s_waitcnt vmcnt(5) lgkmcnt(15)
v_and_b32 v8, 0xff, v152
v_lshl_or_b32 v72, v32, 18, v72
v_lshlrev_b32 v8, 2, v8
v_lshl_add_u32 v8, v112, 10, v8
ds_write_b32 v8, v72
v_and_b32 v8, 0xff, v153
v_lshl_or_b32 v73, v33, 18, v73
v_lshlrev_b32 v8, 2, v8
v_lshl_add_u32 v8, v113, 10, v8
ds_write_b32 v8, v73
v_and_b32 v8, 0xff, v154
v_lshl_or_b32 v74, v34, 18, v74
v_lshlrev_b32 v8, 2, v8
v_lshl_add_u32 v8, v114, 10, v8
ds_write_b32 v8, v74
v_and_b32 v8, 0xff, v155
v_lshl_or_b32 v75, v35, 18, v75
v_lshlrev_b32 v8, 2, v8
v_lshl_add_u32 v8, v115, 10, v8
ds_write_b32 v8, v75
s_waitcnt vmcnt(4) lgkmcnt(15)
v_and_b32 v8, 0xff, v156
v_lshl_or_b32 v76, v36, 18, v76
v_lshlrev_b32 v8, 2, v8
v_lshl_add_u32 v8, v116, 10, v8
ds_write_b32 v8, v76
v_and_b32 v8, 0xff, v157
v_lshl_or_b32 v77, v37, 18, v77
v_lshlrev_b32 v8, 2, v8
v_lshl_add_u32 v8, v117, 10, v8
ds_write_b32 v8, v77
v_and_b32 v8, 0xff, v158
v_lshl_or_b32 v78, v38, 18, v78
v_lshlrev_b32 v8, 2, v8
v_lshl_add_u32 v8, v118, 10, v8
ds_write_b32 v8, v78
v_and_b32 v8, 0xff, v159
v_lshl_or_b32 v79, v39, 18, v79
v_lshlrev_b32 v8, 2, v8
v_lshl_add_u32 v8, v119, 10, v8
ds_write_b32 v8, v79
s_waitcnt vmcnt(3) lgkmcnt(15)
v_and_b32 v8, 0xff, v160
v_lshl_or_b32 v80, v40, 18, v80
v_lshlrev_b32 v8, 2, v8
v_lshl_add_u32 v8, v120, 10, v8
ds_write_b32 v8, v80
v_and_b32 v8, 0xff, v161
v_lshl_or_b32 v81, v41, 18, v81
v_lshlrev_b32 v8, 2, v8
v_lshl_add_u32 v8, v121, 10, v8
ds_write_b32 v8, v81
v_and_b32 v8, 0xff, v162
v_lshl_or_b32 v82, v42, 18, v82
v_lshlrev_b32 v8, 2, v8
v_lshl_add_u32 v8, v122, 10, v8
ds_write_b32 v8, v82
v_and_b32 v8, 0xff, v163
v_lshl_or_b32 v83, v43, 18, v83
v_lshlrev_b32 v8, 2, v8
v_lshl_add_u32 v8, v123, 10, v8
ds_write_b32 v8, v83
s_waitcnt vmcnt(2) lgkmcnt(15)
v_and_b32 v8, 0xff, v164
v_lshl_or_b32 v84, v44, 18, v84
v_lshlrev_b32 v8, 2, v8
v_lshl_add_u32 v8, v124, 10, v8
ds_write_b32 v8, v84
v_and_b32 v8, 0xff, v165
v_lshl_or_b32 v85, v45, 18, v85
v_lshlrev_b32 v8, 2, v8
v_lshl_add_u32 v8, v125, 10, v8
ds_write_b32 v8, v85
v_and_b32 v8, 0xff, v166
v_lshl_or_b32 v86, v46, 18, v86
v_lshlrev_b32 v8, 2, v8
v_lshl_add_u32 v8, v126, 10, v8
ds_write_b32 v8, v86
v_and_b32 v8, 0xff, v167
v_lshl_or_b32 v87, v47, 18, v87
v_lshlrev_b32 v8, 2, v8
v_lshl_add_u32 v8, v127, 10, v8
ds_write_b32 v8, v87
s_waitcnt vmcnt(1) lgkmcnt(15)
v_and_b32 v8, 0xff, v168
v_lshl_or_b32 v88, v48, 18, v88
v_lshlrev_b32 v8, 2, v8
v_lshl_add_u32 v8, v128, 10, v8
ds_write_b32 v8, v88
v_and_b32 v8, 0xff, v169
v_lshl_or_b32 v89, v49, 18, v89
v_lshlrev_b32 v8, 2, v8
v_lshl_add_u32 v8, v129, 10, v8
ds_write_b32 v8, v89
v_and_b32 v8, 0xff, v170
v_lshl_or_b32 v90, v50, 18, v90
v_lshlrev_b32 v8, 2, v8
v_lshl_add_u32 v8, v130, 10, v8
ds_write_b32 v8, v90
v_and_b32 v8, 0xff, v171
v_lshl_or_b32 v91, v51, 18, v91
v_lshlrev_b32 v8, 2, v8
v_lshl_add_u32 v8, v131, 10, v8
ds_write_b32 v8, v91
s_waitcnt vmcnt(0) lgkmcnt(15)
s_mov_b64 exec, s[12:13]
v_and_b32 v8, 0xff, v172
v_lshl_or_b32 v92, v52, 18, v92
v_lshlrev_b32 v8, 2, v8
v_lshl_add_u32 v8, v132, 10, v8
ds_write_b32 v8, v92
v_and_b32 v8, 0xff, v173
v_lshl_or_b32 v93, v53, 18, v93
v_lshlrev_b32 v8, 2, v8
v_lshl_add_u32 v8, v133, 10, v8
ds_write_b32 v8, v93
v_and_b32 v8, 0xff, v174
v_lshl_or_b32 v94, v54, 18, v94
v_lshlrev_b32 v8, 2, v8
v_lshl_add_u32 v8, v134, 10, v8
ds_write_b32 v8, v94
v_and_b32 v8, 0xff, v175
v_lshl_or_b32 v95, v55, 18, v95
v_lshlrev_b32 v8, 2, v8
v_lshl_add_u32 v8, v135, 10, v8
ds_write_b32 v8, v95
s_mov_b64 exec, -1
s_waitcnt lgkmcnt(0)
s_barrier
ds_read_b32 v8, v6
s_mul_i32 s6, s60, 16384
v_lshlrev_b32 v10, 4, v2
v_add_u32 v9, s6, v10
ds_read_b128 v[176:179], v9 offset:0
ds_read_b128 v[180:183], v9 offset:1024
ds_read_b128 v[184:187], v9 offset:2048
ds_read_b128 v[188:191], v9 offset:3072
ds_read_b128 v[192:195], v9 offset:4096
ds_read_b128 v[196:199], v9 offset:5120
ds_read_b128 v[200:203], v9 offset:6144
ds_read_b128 v[204:207], v9 offset:7168
ds_read_b128 v[208:211], v9 offset:8192
ds_read_b128 v[212:215], v9 offset:9216
ds_read_b128 v[216:219], v9 offset:10240
ds_read_b128 v[220:223], v9 offset:11264
ds_read_b128 v[224:227], v9 offset:12288
ds_read_b128 v[228:231], v9 offset:13312
ds_read_b128 v[232:235], v9 offset:14336
ds_read_b128 v[236:239], v9 offset:15360
s_mul_i32 s6, s60, 10485760
s_mul_i32 s7, s4, 40960
s_add_u32 s6, s6, s7
v_lshlrev_b32 v9, 6, v2
s_lshl_b32 s8, s4, 2
s_cmp_eq_u32 s60, 0
s_cselect_b32 s8, s8, 0x7fff0000
s_waitcnt lgkmcnt(15)
buffer_store_dword v8, v9, s[52:55], s8 offen sc1
v_cmp_lt_u32 vcc, 0x100, v8
s_cbranch_vccnz L1_eslow
s_waitcnt lgkmcnt(15)
buffer_store_dwordx4 v[176:179], v10, s[48:51], s6 offen sc1
s_add_u32 s6, s6, 655360
s_waitcnt lgkmcnt(14)
buffer_store_dwordx4 v[180:183], v10, s[48:51], s6 offen sc1
s_add_u32 s6, s6, 655360
s_waitcnt lgkmcnt(13)
buffer_store_dwordx4 v[184:187], v10, s[48:51], s6 offen sc1
s_add_u32 s6, s6, 655360
s_waitcnt lgkmcnt(12)
buffer_store_dwordx4 v[188:191], v10, s[48:51], s6 offen sc1
s_add_u32 s6, s6, 655360
s_waitcnt lgkmcnt(11)
buffer_store_dwordx4 v[192:195], v10, s[48:51], s6 offen sc1
s_add_u32 s6, s6, 655360
s_waitcnt lgkmcnt(10)
buffer_store_dwordx4 v[196:199], v10, s[48:51], s6 offen sc1
s_add_u32 s6, s6, 655360
s_waitcnt lgkmcnt(9)
buffer_store_dwordx4 v[200:203], v10, s[48:51], s6 offen sc1
s_add_u32 s6, s6, 655360
s_waitcnt lgkmcnt(8)
buffer_store_dwordx4 v[204:207], v10, s[48:51], s6 offen sc1
s_add_u32 s6, s6, 655360
s_waitcnt lgkmcnt(7)
buffer_store_dwordx4 v[208:211], v10, s[48:51], s6 offen sc1
s_add_u32 s6, s6, 655360
s_waitcnt lgkmcnt(6)
buffer_store_dwordx4 v[212:215], v10, s[48:51], s6 offen sc1
s_add_u32 s6, s6, 655360
s_waitcnt lgkmcnt(5)
buffer_store_dwordx4 v[216:219], v10, s[48:51], s6 offen sc1
s_add_u32 s6, s6, 655360
s_waitcnt lgkmcnt(4)
buffer_store_dwordx4 v[220:223], v10, s[48:51], s6 offen sc1
s_add_u32 s6, s6, 655360
s_waitcnt lgkmcnt(3)
buffer_store_dwordx4 v[224:227], v10, s[48:51], s6 offen sc1
s_add_u32 s6, s6, 655360
s_waitcnt lgkmcnt(2)
buffer_store_dwordx4 v[228:231], v10, s[48:51], s6 offen sc1
s_add_u32 s6, s6, 655360
s_waitcnt lgkmcnt(1)
buffer_store_dwordx4 v[232:235], v10, s[48:51], s6 offen sc1
s_add_u32 s6, s6, 655360
s_waitcnt lgkmcnt(0)
buffer_store_dwordx4 v[236:239], v10, s[48:51], s6 offen sc1
s_add_u32 s6, s6, 655360
s_branch L1_fin
L1_eslow:
s_mov_b32 s9, 655360
v_mul_u32_u24 v96, s9, v96
v_lshl_add_u32 v96, v136, 2, v96
v_mul_u32_u24 v97, s9, v97
v_lshl_add_u32 v97, v137, 2, v97
v_mul_u32_u24 v98, s9, v98
v_lshl_add_u32 v98, v138, 2, v98
v_mul_u32_u24 v99, s9, v99
v_lshl_add_u32 v99, v139, 2, v99
v_mul_u32_u24 v100, s9, v100
v_lshl_add_u32 v100, v140, 2, v100
v_mul_u32_u24 v101, s9, v101
v_lshl_add_u32 v101, v141, 2, v101
v_mul_u32_u24 v102, s9, v102
v_lshl_add_u32 v102, v142, 2, v102
v_mul_u32_u24 v103, s9, v103
v_lshl_add_u32 v103, v143, 2, v103
v_mul_u32_u24 v104, s9, v104
v_lshl_add_u32 v104, v144, 2, v104
v_mul_u32_u24 v105, s9, v105
v_lshl_add_u32 v105, v145, 2, v105
v_mul_u32_u24 v106, s9, v106
v_lshl_add_u32 v106, v146, 2, v106
v_mul_u32_u24 v107, s9, v107
v_lshl_add_u32 v107, v147, 2, v107
v_mul_u32_u24 v108, s9, v108
v_lshl_add_u32 v108, v148, 2, v108
v_mul_u32_u24 v109, s9, v109
v_lshl_add_u32 v109, v149, 2, v109
v_mul_u32_u24 v110, s9, v110
v_lshl_add_u32 v110, v150, 2, v110
v_mul_u32_u24 v111, s9, v111
v_lshl_add_u32 v111, v151, 2, v111
v_mul_u32_u24 v112, s9, v112
v_lshl_add_u32 v112, v152, 2, v112
v_mul_u32_u24 v113, s9, v113
v_lshl_add_u32 v113, v153, 2, v113
v_mul_u32_u24 v114, s9, v114
v_lshl_add_u32 v114, v154, 2, v114
v_mul_u32_u24 v115, s9, v115
v_lshl_add_u32 v115, v155, 2, v115
v_mul_u32_u24 v116, s9, v116
v_lshl_add_u32 v116, v156, 2, v116
v_mul_u32_u24 v117, s9, v117
v_lshl_add_u32 v117, v157, 2, v117
v_mul_u32_u24 v118, s9, v118
v_lshl_add_u32 v118, v158, 2, v118
v_mul_u32_u24 v119, s9, v119
v_lshl_add_u32 v119, v159, 2, v119
v_mul_u32_u24 v120, s9, v120
v_lshl_add_u32 v120, v160, 2, v120
v_mul_u32_u24 v121, s9, v121
v_lshl_add_u32 v121, v161, 2, v121
v_mul_u32_u24 v122, s9, v122
v_lshl_add_u32 v122, v162, 2, v122
v_mul_u32_u24 v123, s9, v123
v_lshl_add_u32 v123, v163, 2, v123
v_mul_u32_u24 v124, s9, v124
v_lshl_add_u32 v124, v164, 2, v124
v_mul_u32_u24 v125, s9, v125
v_lshl_add_u32 v125, v165, 2, v125
v_mul_u32_u24 v126, s9, v126
v_lshl_add_u32 v126, v166, 2, v126
v_mul_u32_u24 v127, s9, v127
v_lshl_add_u32 v127, v167, 2, v127
v_mul_u32_u24 v128, s9, v128
v_lshl_add_u32 v128, v168, 2, v128
v_mul_u32_u24 v129, s9, v129
v_lshl_add_u32 v129, v169, 2, v129
v_mul_u32_u24 v130, s9, v130
v_lshl_add_u32 v130, v170, 2, v130
v_mul_u32_u24 v131, s9, v131
v_lshl_add_u32 v131, v171, 2, v131
v_mul_u32_u24 v132, s9, v132
v_lshl_add_u32 v132, v172, 2, v132
v_mul_u32_u24 v133, s9, v133
v_lshl_add_u32 v133, v173, 2, v133
v_mul_u32_u24 v134, s9, v134
v_lshl_add_u32 v134, v174, 2, v134
v_mul_u32_u24 v135, s9, v135
v_lshl_add_u32 v135, v175, 2, v135
buffer_store_dword v56, v96, s[48:51], s7 offen sc1
buffer_store_dword v57, v97, s[48:51], s7 offen sc1
buffer_store_dword v58, v98, s[48:51], s7 offen sc1
buffer_store_dword v59, v99, s[48:51], s7 offen sc1
buffer_store_dword v60, v100, s[48:51], s7 offen sc1
buffer_store_dword v61, v101, s[48:51], s7 offen sc1
buffer_store_dword v62, v102, s[48:51], s7 offen sc1
buffer_store_dword v63, v103, s[48:51], s7 offen sc1
buffer_store_dword v64, v104, s[48:51], s7 offen sc1
buffer_store_dword v65, v105, s[48:51], s7 offen sc1
buffer_store_dword v66, v106, s[48:51], s7 offen sc1
buffer_store_dword v67, v107, s[48:51], s7 offen sc1
buffer_store_dword v68, v108, s[48:51], s7 offen sc1
buffer_store_dword v69, v109, s[48:51], s7 offen sc1
buffer_store_dword v70, v110, s[48:51], s7 offen sc1
buffer_store_dword v71, v111, s[48:51], s7 offen sc1
buffer_store_dword v72, v112, s[48:51], s7 offen sc1
buffer_store_dword v73, v113, s[48:51], s7 offen sc1
buffer_store_dword v74, v114, s[48:51], s7 offen sc1
buffer_store_dword v75, v115, s[48:51], s7 offen sc1
buffer_store_dword v76, v116, s[48:51], s7 offen sc1
buffer_store_dword v77, v117, s[48:51], s7 offen sc1
buffer_store_dword v78, v118, s[48:51], s7 offen sc1
buffer_store_dword v79, v119, s[48:51], s7 offen sc1
buffer_store_dword v80, v120, s[48:51], s7 offen sc1
buffer_store_dword v81, v121, s[48:51], s7 offen sc1
buffer_store_dword v82, v122, s[48:51], s7 offen sc1
buffer_store_dword v83, v123, s[48:51], s7 offen sc1
buffer_store_dword v84, v124, s[48:51], s7 offen sc1
buffer_store_dword v85, v125, s[48:51], s7 offen sc1
buffer_store_dword v86, v126, s[48:51], s7 offen sc1
buffer_store_dword v87, v127, s[48:51], s7 offen sc1
buffer_store_dword v88, v128, s[48:51], s7 offen sc1
buffer_store_dword v89, v129, s[48:51], s7 offen sc1
buffer_store_dword v90, v130, s[48:51], s7 offen sc1
buffer_store_dword v91, v131, s[48:51], s7 offen sc1
s_mov_b64 exec, s[12:13]
buffer_store_dword v92, v132, s[48:51], s7 offen sc1
buffer_store_dword v93, v133, s[48:51], s7 offen sc1
buffer_store_dword v94, v134, s[48:51], s7 offen sc1
buffer_store_dword v95, v135, s[48:51], s7 offen sc1
s_mov_b64 exec, -1
s_branch L1_fin
L2_entry:
s_load_dwordx2 s[4:5], s[0:1], 88
s_load_dwordx2 s[60:61], s[0:1], 0
s_load_dwordx2 s[52:53], s[0:1], 24
s_load_dwordx2 s[56:57], s[0:1], 72
s_and_b32 s35, s2, 7
s_lshr_b32 s37, s2, 3
s_add_u32 s37, s37, 30
s_and_b32 s37, s37, 31
v_lshrrev_b32 v1, 6, v0
s_mov_b32 s36, -1
v_readfirstlane_b32 s38, v1
s_cmp_lt_u32 s37, 30
s_cbranch_scc1 L2_att
s_lshl_b32 s39, s35, 1
s_add_u32 s39, s39, s37
s_sub_u32 s39, s39, 30
s_cmp_lt_u32 s38, 3
s_cbranch_scc1 LE_start
s_cmp_ge_u32 s39, 12
s_cbranch_scc1 L2_end
s_and_b32 s36, s39, 1
s_lshr_b32 s37, s39, 1
s_mov_b32 s38, 39
v_and_b32 v0, 63, v0
s_branch L2_att2
L2_att:
s_mul_i32 s38, s37, 26
s_lshr_b32 s38, s38, 8
s_mul_i32 s39, s38, 10
s_sub_u32 s39, s37, s39
s_and_b32 s37, s35, 1
s_mul_i32 s37, s37, 3
s_add_u32 s37, s37, s38
s_lshr_b32 s38, s35, 1
s_mul_i32 s38, s38, 10
s_add_u32 s38, s38, s39
L2_att2:
v_lshrrev_b32 v1, 6, v0
v_and_b32 v243, 63, v0
v_lshlrev_b32 v243, 4, v243
v_readfirstlane_b32 s34, v1
s_mov_b32 s50, 0xe1a06800
s_mov_b32 s51, 0x4e20ad04
s_mul_i32 s39, s37, 9
s_lshr_b64 s[50:51], s[50:51], s39
s_and_b32 s39, s50, 0x1ff
s_bfe_u32 s49, s50, 0x90009
s_sub_u32 s31, s49, s39
s_sub_u32 s31, s31, 4
s_lshl_b32 s39, s39, 14
s_lshl_b32 s49, s49, 14
s_add_u32 s28, s39, 0x4000
s_cmp_eq_u32 s37, 5
s_addc_u32 s31, s31, 0
s_cmp_eq_u32 s37, 5
s_cselect_b32 s28, s39, s28
s_cselect_b32 s39, 5111808, s39
s_cselect_b32 s49, 5120000, s49
s_cselect_b32 s33, 0xff800000, 0
s_mov_b32 s32, 0x5d800000
v_and_b32 v2, 63, v0
v_bfe_u32 v3, v2, 3, 2
v_bfe_u32 v4, v2, 2, 1
v_lshlrev_b32 v241, 12, v3
v_lshl_or_b32 v241, v4, 9, v241
v_lshl_or_b32 v241, v1, 7, v241
v_lshrrev_b32 v4, 5, v2
v_lshl_or_b32 v241, v4, 6, v241
v_and_b32 v3, 2, v3
v_and_b32 v4, 3, v2
v_xor_b32 v3, v3, v4
v_lshl_or_b32 v241, v3, 4, v241
s_cmp_eq_u32 s38, 39
s_cbranch_scc1 LT_disp
s_cmp_lt_u32 s37, 3
s_cselect_b32 s101, 1, -1
s_cselect_b32 s39, 0, 103
s_cselect_b32 s3, 0, 3
s_sub_u32 s3, s37, s3
s_mul_i32 s3, s3, 104
s_add_u32 s39, s39, s3
s_cmp_eq_u32 s37, 5
s_addc_u32 s39, s39, 0
s_lshl_b32 s101, s101, 14
s_lshl_b32 s39, s39, 14
s_add_u32 s28, s39, s101
s_mov_b32 s49, 5120000
s_mov_b32 s31, 40
s_mov_b32 s100, 3
s_lshl_b32 s30, s34, 12
s_lshl_b32 s50, s34, 13
s_add_u32 s50, s50, 0x20000
s_mov_b32 m0, s30
s_mov_b32 s6, 0x92c51840
s_mov_b32 s7, 0xfb73ea6d
s_mul_i32 s3, s37, 12
s_min_u32 s3, s3, 56
s_lshr_b64 s[6:7], s[6:7], s3
s_bfe_u32 s29, s6, 0x40008
s_bfe_u32 s7, s6, 0x40004
s_and_b32 s6, s6, 15
s_cmp_lt_u32 s37, 4
s_cselect_b32 s29, s29, 16
s_mov_b32 s94, 0
s_mov_b32 s95, 0
s_lshr_b32 s3, s6, 2
s_cmp_eq_u32 s3, s34
s_cselect_b32 s94, s6, s94
s_cselect_b32 s95, 1, s95
s_lshr_b32 s3, s7, 2
s_cmp_eq_u32 s3, s34
s_cselect_b32 s94, s7, s94
s_cselect_b32 s95, 1, s95
s_lshr_b32 s3, s29, 2
s_cmp_eq_u32 s3, s34
s_cselect_b32 s94, s29, s94
s_cselect_b32 s95, 1, s95
s_and_b32 s94, s94, 3
s_lshl_b32 s3, s38, 17
s_lshl_b32 s51, s34, 7
s_add_u32 s3, s3, s51
s_lshl_b32 s6, s6, 13
s_add_u32 s6, s6, s3
s_lshl_b32 s7, s7, 13
s_add_u32 s7, s7, s3
s_lshl_b32 s29, s29, 13
s_add_u32 s29, s29, s3
s_mov_b64 s[96:97], 0
s_lshr_b32 s3, s6, 9
s_mul_i32 s40, s3, 6945
s_mov_b32 s41, s40
s_mul_i32 s40, s3, 6317
s_add_u32 s40, s40, 0x340674
s_cmp_lt_u32 s3, 5436
s_cselect_b32 s41, s41, s40
s_mul_i32 s40, s3, 6899
s_add_u32 s40, s40, 0xfffae6a0
s_cmp_lt_u32 s3, 6432
s_cselect_b32 s41, s41, s40
s_mul_i32 s40, s3, 6242
s_add_u32 s40, s40, 0x4484a0
s_cmp_lt_u32 s3, 7344
s_cselect_b32 s41, s41, s40
s_lshr_b32 s3, s41, 20
s_bitset1_b64 s[96:97], s3
s_lshr_b32 s3, s6, 9
s_add_u32 s3, s3, 15
s_mul_i32 s40, s3, 6945
s_mov_b32 s41, s40
s_mul_i32 s40, s3, 6317
s_add_u32 s40, s40, 0x340674
s_cmp_lt_u32 s3, 5436
s_cselect_b32 s41, s41, s40
s_mul_i32 s40, s3, 6899
s_add_u32 s40, s40, 0xfffae6a0
s_cmp_lt_u32 s3, 6432
s_cselect_b32 s41, s41, s40
s_mul_i32 s40, s3, 6242
s_add_u32 s40, s40, 0x4484a0
s_cmp_lt_u32 s3, 7344
s_cselect_b32 s41, s41, s40
s_lshr_b32 s3, s41, 20
s_bitset1_b64 s[96:97], s3
s_lshr_b32 s3, s7, 9
s_mul_i32 s40, s3, 6945
s_mov_b32 s41, s40
s_mul_i32 s40, s3, 6317
s_add_u32 s40, s40, 0x340674
s_cmp_lt_u32 s3, 5436
s_cselect_b32 s41, s41, s40
s_mul_i32 s40, s3, 6899
s_add_u32 s40, s40, 0xfffae6a0
s_cmp_lt_u32 s3, 6432
s_cselect_b32 s41, s41, s40
s_mul_i32 s40, s3, 6242
s_add_u32 s40, s40, 0x4484a0
s_cmp_lt_u32 s3, 7344
s_cselect_b32 s41, s41, s40
s_lshr_b32 s3, s41, 20
s_bitset1_b64 s[96:97], s3
s_lshr_b32 s3, s7, 9
s_add_u32 s3, s3, 15
s_mul_i32 s40, s3, 6945
s_mov_b32 s41, s40
s_mul_i32 s40, s3, 6317
s_add_u32 s40, s40, 0x340674
s_cmp_lt_u32 s3, 5436
s_cselect_b32 s41, s41, s40
s_mul_i32 s40, s3, 6899
s_add_u32 s40, s40, 0xfffae6a0
s_cmp_lt_u32 s3, 6432
s_cselect_b32 s41, s41, s40
s_mul_i32 s40, s3, 6242
s_add_u32 s40, s40, 0x4484a0
s_cmp_lt_u32 s3, 7344
s_cselect_b32 s41, s41, s40
s_lshr_b32 s3, s41, 20
s_bitset1_b64 s[96:97], s3
s_lshr_b32 s3, s29, 9
s_mul_i32 s40, s3, 6945
s_mov_b32 s41, s40
s_mul_i32 s40, s3, 6317
s_add_u32 s40, s40, 0x340674
s_cmp_lt_u32 s3, 5436
s_cselect_b32 s41, s41, s40
s_mul_i32 s40, s3, 6899
s_add_u32 s40, s40, 0xfffae6a0
s_cmp_lt_u32 s3, 6432
s_cselect_b32 s41, s41, s40
s_mul_i32 s40, s3, 6242
s_add_u32 s40, s40, 0x4484a0
s_cmp_lt_u32 s3, 7344
s_cselect_b32 s41, s41, s40
s_lshr_b32 s3, s41, 20
s_bitset1_b64 s[96:97], s3
s_lshr_b32 s3, s29, 9
s_add_u32 s3, s3, 15
s_mul_i32 s40, s3, 6945
s_mov_b32 s41, s40
s_mul_i32 s40, s3, 6317
s_add_u32 s40, s40, 0x340674
s_cmp_lt_u32 s3, 5436
s_cselect_b32 s41, s41, s40
s_mul_i32 s40, s3, 6899
s_add_u32 s40, s40, 0xfffae6a0
s_cmp_lt_u32 s3, 6432
s_cselect_b32 s41, s41, s40
s_mul_i32 s40, s3, 6242
s_add_u32 s40, s40, 0x4484a0
s_cmp_lt_u32 s3, 7344
s_cselect_b32 s41, s41, s40
s_lshr_b32 s3, s41, 20
s_bitset1_b64 s[96:97], s3
s_mul_i32 s3, s38, 6
s_add_u32 s3, s3, s37
s_cmp_eq_u32 s3, 233
s_cselect_b32 s3, 0, s37
s_cmp_lt_u32 s3, 4
s_cselect_b32 s29, s29, 0x70000000
s_lshl_b32 s51, s38, 5
s_lshl_b32 s3, s34, 3
s_add_u32 s51, s51, s3
s_add_u32 s51, s51, s37
s_mul_i32 s51, s51, 128
s_add_u32 s51, s51, 0x7c00000
s_lshr_b32 s40, s39, 17
s_min_u32 s40, s40, 38
s_lshr_b32 s41, s28, 17
s_add_u32 s3, s28, s101
s_lshr_b32 s3, s3, 17
v_mov_b32 v5, s38
v_mov_b32 v6, s40
v_cmp_lt_u32 vcc, 0x7f, v243
s_nop 1
v_cndmask_b32 v5, v5, v6, vcc
v_mov_b32 v6, s41
v_cmp_lt_u32 vcc, 0xff, v243
s_nop 1
v_cndmask_b32 v5, v5, v6, vcc
v_mov_b32 v6, s3
v_cmp_lt_u32 vcc, 0x17f, v243
s_nop 1
v_cndmask_b32 v5, v5, v6, vcc
v_bfe_u32 v6, v243, 4, 3
v_min_u32 v6, 5, v6
v_mad_u32_u24 v5, v5, 6, v6
v_lshlrev_b32 v5, 7, v5
v_add_u32 v5, 0x7c2a000, v5
s_mul_i32 s3, s101, 54
s_add_u32 s3, s3, s39
s_min_u32 s41, s3, s39
s_max_u32 s3, s3, s39
s_lshr_b32 s41, s41, 17
s_min_u32 s40, s40, s41
s_mul_i32 s40, s40, 6
s_lshr_b32 s3, s3, 17
s_min_u32 s3, s3, 38
s_mul_i32 s3, s3, 6
s_add_u32 s3, s3, 5
v_lshrrev_b32 v230, 4, v243
v_add_u32 v230, s40, v230
v_min_u32 v230, s3, v230
v_lshlrev_b32 v230, 7, v230
v_add_u32 v230, 0x7c2a000, v230
s_waitcnt lgkmcnt(0)
s_add_u32 s12, s4, 0x6800000
s_addc_u32 s13, s5, 0
s_mov_b32 s14, 0x0
s_mov_b32 s15, 0x00020000
s_mov_b32 s14, s49
s_add_u32 s8, s4, 0x0
s_addc_u32 s9, s5, 0
s_mov_b32 s10, 0x4e4000
s_mov_b32 s11, 0x00020000
s_mul_i32 s35, s37, 0x600000
s_add_u32 s20, s4, 0x2000000
s_addc_u32 s21, s5, 0
s_add_u32 s20, s20, s35
s_addc_u32 s21, s21, 0
s_mov_b32 s22, 0x4e4000
s_mov_b32 s23, 0x00020000
s_add_u32 s24, s4, 0x6000000
s_addc_u32 s25, s5, 0
s_mov_b32 s26, 0x139000
s_mov_b32 s27, 0x00020000
s_lshl_b32 s35, s38, 4
s_lshl_b32 s41, s34, 2
s_add_u32 s35, s35, s41
s_lshl_b32 s40, s35, 13
s_lshl_b32 s94, s94, 13
s_add_u32 s40, s40, s94
s_xor_b32 s41, s40, 8192
s_xor_b32 s42, s40, 16384
s_xor_b32 s43, s40, 24576
s_add_u32 s44, s40, 4096
s_add_u32 s45, s41, 4096
s_add_u32 s46, s42, 4096
s_add_u32 s47, s43, 4096
s_lshl_b32 s48, s35, 10
s_lshl_b32 s35, s37, 3
s_add_u32 s48, s48, s35
v_mov_b32 v232, 0
v_mov_b32 v233, 0
v_mov_b32 v234, 0
v_mov_b32 v235, 0
v_bfe_u32 v240, v243, 4, 3
v_lshlrev_b32 v240, 6, v240
v_bfe_u32 v242, v243, 7, 1
v_lshl_or_b32 v240, v242, 10, v240
v_bfe_u32 v242, v243, 8, 2
v_lshl_or_b32 v240, v242, 4, v240
v_bfe_u32 v242, v243, 6, 1
v_lshlrev_b32 v242, 5, v242
v_xor_b32 v240, v240, v242
v_and_b32 v246, 0x1c0, v243
v_bfe_u32 v242, v243, 9, 1
v_lshl_or_b32 v246, v242, 10, v246
v_bfe_u32 v242, v243, 8, 1
v_lshl_or_b32 v246, v242, 5, v246
v_bfe_u32 v242, v243, 4, 2
v_lshl_or_b32 v246, v242, 3, v246
v_xor_b32 v247, 32, v246
v_bfe_i32 v242, v243, 8, 1
v_and_b32 v192, s33, v242
v_and_b32 v193, s33, v242
v_and_b32 v194, s33, v242
v_and_b32 v195, s33, v242
v_mfma_f32_32x32x16_bf16 a[0:15], v[232:235], v[232:235], 0
v_mfma_f32_32x32x16_bf16 a[16:31], v[232:235], v[232:235], 0
v_mfma_f32_32x32x16_bf16 a[32:47], v[232:235], v[232:235], 0
v_mfma_f32_32x32x16_bf16 a[48:63], v[232:235], v[232:235], 0
v_mfma_f32_32x32x16_bf16 a[64:79], v[232:235], v[232:235], 0
v_mfma_f32_32x32x16_bf16 a[80:95], v[232:235], v[232:235], 0
v_mfma_f32_32x32x16_bf16 a[96:111], v[232:235], v[232:235], 0
v_mfma_f32_32x32x16_bf16 a[112:127], v[232:235], v[232:235], 0
v_mfma_f32_32x32x16_bf16 a[128:143], v[232:235], v[232:235], 0
v_mfma_f32_32x32x16_bf16 a[144:159], v[232:235], v[232:235], 0
v_mfma_f32_32x32x16_bf16 a[160:175], v[232:235], v[232:235], 0
v_mfma_f32_32x32x16_bf16 a[176:191], v[232:235], v[232:235], 0
v_mfma_f32_32x32x16_bf16 a[192:207], v[232:235], v[232:235], 0
v_mfma_f32_32x32x16_bf16 a[208:223], v[232:235], v[232:235], 0
v_mfma_f32_32x32x16_bf16 a[224:239], v[232:235], v[232:235], 0
v_mfma_f32_32x32x16_bf16 a[240:255], v[232:235], v[232:235], 0
s_add_u32 s16, s4, 0x0
s_addc_u32 s17, s5, 0
s_mov_b32 s18, 0x10000000
s_mov_b32 s19, 0x00020000
s_mov_b32 s3, 0x10000
LM_pa:
buffer_load_dwordx2 v[6:7], v5, s[16:19], 0 offen sc1
s_sub_u32 s3, s3, 1
s_waitcnt vmcnt(0)
s_cbranch_scc1 LM_pa_go
v_cmp_ne_u64 vcc, s[98:99], v[6:7]
s_nop 1
s_cbranch_vccnz LM_pa
LM_pa_go:
buffer_load_dwordx4 v241, s[12:15], s39 offen offset:0 sc1 lds
buffer_load_dwordx4 v241, s[12:15], s39 offen offset:1024 sc1 lds
buffer_load_dwordx4 v241, s[12:15], s39 offen offset:2048 sc1 lds
buffer_load_dwordx4 v241, s[12:15], s39 offen offset:3072 sc1 lds
s_add_u32 m0, s30, 0x4000
s_nop 0
buffer_load_dwordx4 v241, s[12:15], s28 offen offset:0 sc1 lds
buffer_load_dwordx4 v241, s[12:15], s28 offen offset:1024 sc1 lds
buffer_load_dwordx4 v[0:3], v243, s[8:11], s40 offen offset:0 sc1
buffer_load_dwordx4 v[32:35], v243, s[8:11], s41 offen offset:0 sc1
buffer_load_dwordx4 v[64:67], v243, s[8:11], s42 offen offset:0 sc1
buffer_load_dwordx4 v[96:99], v243, s[8:11], s43 offen offset:0 sc1
buffer_load_dwordx4 v[4:7], v243, s[8:11], s40 offen offset:1024 sc1
buffer_load_dwordx4 v[36:39], v243, s[8:11], s41 offen offset:1024 sc1
buffer_load_dwordx4 v[68:71], v243, s[8:11], s42 offen offset:1024 sc1
buffer_load_dwordx4 v[100:103], v243, s[8:11], s43 offen offset:1024 sc1
buffer_load_dwordx4 v[8:11], v243, s[8:11], s40 offen offset:2048 sc1
buffer_load_dwordx4 v[40:43], v243, s[8:11], s41 offen offset:2048 sc1
buffer_load_dwordx4 v[72:75], v243, s[8:11], s42 offen offset:2048 sc1
buffer_load_dwordx4 v[104:107], v243, s[8:11], s43 offen offset:2048 sc1
buffer_load_dwordx4 v[12:15], v243, s[8:11], s40 offen offset:3072 sc1
buffer_load_dwordx4 v[44:47], v243, s[8:11], s41 offen offset:3072 sc1
buffer_load_dwordx4 v[76:79], v243, s[8:11], s42 offen offset:3072 sc1
buffer_load_dwordx4 v[108:111], v243, s[8:11], s43 offen offset:3072 sc1
buffer_load_dwordx4 v[16:19], v243, s[8:11], s44 offen offset:0 sc1
buffer_load_dwordx4 v[48:51], v243, s[8:11], s45 offen offset:0 sc1
buffer_load_dwordx4 v[80:83], v243, s[8:11], s46 offen offset:0 sc1
buffer_load_dwordx4 v[112:115], v243, s[8:11], s47 offen offset:0 sc1
buffer_load_dwordx2 v[228:229], v230, s[16:19], 0 offen sc1
s_waitcnt vmcnt(21)
s_barrier
ds_read_b128 v[208:211], v240 offset:0
ds_read_b128 v[212:215], v240 offset:2048
ds_read_b128 v[216:219], v240 offset:16384
ds_read_b128 v[220:223], v240 offset:512
s_waitcnt lgkmcnt(3)
s_waitcnt vmcnt(17)
v_mfma_f32_16x16x32_bf16 v[128:131], v[208:211], v[0:3], v[192:195]
buffer_load_dwordx4 v[20:23], v243, s[8:11], s44 offen offset:1024 sc1
v_mfma_f32_16x16x32_bf16 v[132:135], v[208:211], v[32:35], v[192:195]
v_mfma_f32_16x16x32_bf16 v[136:139], v[208:211], v[64:67], v[192:195]
v_mfma_f32_16x16x32_bf16 v[140:143], v[208:211], v[96:99], v[192:195]
ds_read_b128 v[208:211], v240 offset:2560
s_waitcnt lgkmcnt(3)
buffer_load_dwordx4 v[52:55], v243, s[8:11], s45 offen offset:1024 sc1
v_mfma_f32_16x16x32_bf16 v[144:147], v[212:215], v[0:3], v[192:195]
v_mfma_f32_16x16x32_bf16 v[148:151], v[212:215], v[32:35], v[192:195]
v_mfma_f32_16x16x32_bf16 v[152:155], v[212:215], v[64:67], v[192:195]
buffer_load_dwordx4 v[84:87], v243, s[8:11], s46 offen offset:1024 sc1
v_mfma_f32_16x16x32_bf16 v[156:159], v[212:215], v[96:99], v[192:195]
ds_read_b128 v[212:215], v240 offset:16896
s_waitcnt lgkmcnt(3)
v_mfma_f32_16x16x32_bf16 v[176:179], v[216:219], v[0:3], 0
v_mfma_f32_16x16x32_bf16 v[180:183], v[216:219], v[32:35], 0
buffer_load_dwordx4 v[116:119], v243, s[8:11], s47 offen offset:1024 sc1
v_mfma_f32_16x16x32_bf16 v[184:187], v[216:219], v[64:67], 0
v_mfma_f32_16x16x32_bf16 v[188:191], v[216:219], v[96:99], 0
ds_read_b128 v[216:219], v240 offset:4096
s_waitcnt lgkmcnt(3)
s_waitcnt vmcnt(17)
v_mfma_f32_16x16x32_bf16 v[128:131], v[220:223], v[4:7], v[128:131]
buffer_load_dwordx4 v[24:27], v243, s[8:11], s44 offen offset:2048 sc1
v_mfma_f32_16x16x32_bf16 v[132:135], v[220:223], v[36:39], v[132:135]
v_mfma_f32_16x16x32_bf16 v[136:139], v[220:223], v[68:71], v[136:139]
v_mfma_f32_16x16x32_bf16 v[140:143], v[220:223], v[100:103], v[140:143]
ds_read_b128 v[220:223], v240 offset:6144
s_waitcnt lgkmcnt(3)
buffer_load_dwordx4 v[56:59], v243, s[8:11], s45 offen offset:2048 sc1
v_mfma_f32_16x16x32_bf16 v[144:147], v[208:211], v[4:7], v[144:147]
v_mfma_f32_16x16x32_bf16 v[148:151], v[208:211], v[36:39], v[148:151]
v_mfma_f32_16x16x32_bf16 v[152:155], v[208:211], v[68:71], v[152:155]
buffer_load_dwordx4 v[88:91], v243, s[8:11], s46 offen offset:2048 sc1
v_mfma_f32_16x16x32_bf16 v[156:159], v[208:211], v[100:103], v[156:159]
ds_read_b128 v[208:211], v240 offset:20480
s_waitcnt lgkmcnt(3)
v_mfma_f32_16x16x32_bf16 v[176:179], v[212:215], v[4:7], v[176:179]
v_mfma_f32_16x16x32_bf16 v[180:183], v[212:215], v[36:39], v[180:183]
buffer_load_dwordx4 v[120:123], v243, s[8:11], s47 offen offset:2048 sc1
v_mfma_f32_16x16x32_bf16 v[184:187], v[212:215], v[68:71], v[184:187]
v_mfma_f32_16x16x32_bf16 v[188:191], v[212:215], v[100:103], v[188:191]
ds_read_b128 v[212:215], v240 offset:4608
s_waitcnt lgkmcnt(3)
s_waitcnt vmcnt(17)
v_mfma_f32_16x16x32_bf16 v[128:131], v[216:219], v[8:11], v[128:131]
buffer_load_dwordx4 v[28:31], v243, s[8:11], s44 offen offset:3072 sc1
v_mfma_f32_16x16x32_bf16 v[132:135], v[216:219], v[40:43], v[132:135]
v_mfma_f32_16x16x32_bf16 v[136:139], v[216:219], v[72:75], v[136:139]
v_mfma_f32_16x16x32_bf16 v[140:143], v[216:219], v[104:107], v[140:143]
ds_read_b128 v[216:219], v240 offset:6656
s_waitcnt lgkmcnt(3)
buffer_load_dwordx4 v[60:63], v243, s[8:11], s45 offen offset:3072 sc1
v_mfma_f32_16x16x32_bf16 v[144:147], v[220:223], v[8:11], v[144:147]
v_mfma_f32_16x16x32_bf16 v[148:151], v[220:223], v[40:43], v[148:151]
v_mfma_f32_16x16x32_bf16 v[152:155], v[220:223], v[72:75], v[152:155]
buffer_load_dwordx4 v[92:95], v243, s[8:11], s46 offen offset:3072 sc1
v_mfma_f32_16x16x32_bf16 v[156:159], v[220:223], v[104:107], v[156:159]
ds_read_b128 v[220:223], v240 offset:20992
s_waitcnt lgkmcnt(3)
v_mfma_f32_16x16x32_bf16 v[176:179], v[208:211], v[8:11], v[176:179]
v_mfma_f32_16x16x32_bf16 v[180:183], v[208:211], v[40:43], v[180:183]
buffer_load_dwordx4 v[124:127], v243, s[8:11], s47 offen offset:3072 sc1
v_mfma_f32_16x16x32_bf16 v[184:187], v[208:211], v[72:75], v[184:187]
v_mfma_f32_16x16x32_bf16 v[188:191], v[208:211], v[104:107], v[188:191]
ds_read_b128 v[208:211], v240 offset:8192
s_waitcnt lgkmcnt(3)
s_waitcnt vmcnt(17)
v_mfma_f32_16x16x32_bf16 v[128:131], v[212:215], v[12:15], v[128:131]
s_add_u32 s16, s4, 0x0
s_addc_u32 s17, s5, 0
s_mov_b32 s18, 0x10000000
v_mfma_f32_16x16x32_bf16 v[132:135], v[212:215], v[44:47], v[132:135]
buffer_load_dwordx4 v241, s[12:15], s28 offen offset:2048 sc1 lds
s_mov_b32 s19, 0x00020000
s_add_u32 s8, s60, 0x0
v_mfma_f32_16x16x32_bf16 v[136:139], v[212:215], v[76:79], v[136:139]
s_addc_u32 s9, s61, 0
s_mov_b32 s10, 0x4e2000
s_mov_b32 s11, 0x00020000
v_mfma_f32_16x16x32_bf16 v[140:143], v[212:215], v[108:111], v[140:143]
ds_read_b128 v[212:215], v240 offset:10240
s_waitcnt lgkmcnt(3)
buffer_load_dwordx4 v241, s[12:15], s28 offen offset:3072 sc1 lds
v_mfma_f32_16x16x32_bf16 v[144:147], v[216:219], v[12:15], v[144:147]
s_mov_b32 s54, 0x4e20
s_mov_b32 s55, 0x00020000
s_mov_b32 s58, 0x4e2000
v_mfma_f32_16x16x32_bf16 v[148:151], v[216:219], v[44:47], v[148:151]
s_mov_b32 s59, 0x00020000
s_lshr_b32 s48, s40, 2
s_cmp_eq_u32 s95, 1
v_mfma_f32_16x16x32_bf16 v[152:155], v[216:219], v[76:79], v[152:155]
s_cselect_b32 s40, 0x70000000, s40
s_cselect_b32 s44, 0x70000000, s44
s_cmp_lt_u32 s37, 3
v_mfma_f32_16x16x32_bf16 v[156:159], v[216:219], v[108:111], v[156:159]
ds_read_b128 v[216:219], v240 offset:24576
s_waitcnt lgkmcnt(3)
s_cselect_b32 s3, 0, 3
v_mfma_f32_16x16x32_bf16 v[176:179], v[220:223], v[12:15], v[176:179]
s_sub_u32 s3, s37, s3
s_cmp_eq_u32 s3, 2
s_cselect_b32 s39, 8, 7
v_mfma_f32_16x16x32_bf16 v[180:183], v[220:223], v[44:47], v[180:183]
s_cselect_b32 s35, 5, 5
s_lshl_b32 s49, s38, 2
s_add_u32 s49, s49, s3
v_mfma_f32_16x16x32_bf16 v[184:187], v[220:223], v[76:79], v[184:187]
s_lshl_b32 s49, s49, 10
s_add_u32 s49, s49, 0x7c00300
v_mfma_f32_16x16x32_bf16 v[188:191], v[220:223], v[108:111], v[188:191]
ds_read_b128 v[220:223], v240 offset:8704
s_waitcnt lgkmcnt(3)
s_waitcnt vmcnt(15)
v_mfma_f32_16x16x32_bf16 v[128:131], v[208:211], v[16:19], v[128:131]
v_mfma_f32_16x16x32_bf16 v[132:135], v[208:211], v[48:51], v[132:135]
s_add_u32 s28, s28, s101
s_add_u32 m0, s30, 0x8000
s_nop 0
v_mfma_f32_16x16x32_bf16 v[136:139], v[208:211], v[80:83], v[136:139]
v_mfma_f32_16x16x32_bf16 v[140:143], v[208:211], v[112:115], v[140:143]
ds_read_b128 v[208:211], v240 offset:10752
s_waitcnt lgkmcnt(3)
buffer_load_dwordx4 v241, s[12:15], s28 offen offset:0 sc1 lds
v_mfma_f32_16x16x32_bf16 v[144:147], v[212:215], v[16:19], v[144:147]
v_mfma_f32_16x16x32_bf16 v[148:151], v[212:215], v[48:51], v[148:151]
buffer_load_dwordx4 v241, s[12:15], s28 offen offset:1024 sc1 lds
v_mfma_f32_16x16x32_bf16 v[152:155], v[212:215], v[80:83], v[152:155]
v_mfma_f32_16x16x32_bf16 v[156:159], v[212:215], v[112:115], v[156:159]
ds_read_b128 v[212:215], v240 offset:25088
s_waitcnt lgkmcnt(3)
v_mfma_f32_16x16x32_bf16 v[176:179], v[216:219], v[16:19], v[176:179]
v_mfma_f32_16x16x32_bf16 v[180:183], v[216:219], v[48:51], v[180:183]
v_mfma_f32_16x16x32_bf16 v[184:187], v[216:219], v[80:83], v[184:187]
v_mfma_f32_16x16x32_bf16 v[188:191], v[216:219], v[112:115], v[188:191]
ds_read_b128 v[216:219], v240 offset:12288
s_waitcnt lgkmcnt(3)
s_waitcnt vmcnt(12)
v_mfma_f32_16x16x32_bf16 v[128:131], v[220:223], v[20:23], v[128:131]
v_mfma_f32_16x16x32_bf16 v[132:135], v[220:223], v[52:55], v[132:135]
buffer_load_dwordx4 v241, s[12:15], s28 offen offset:2048 sc1 lds
v_mfma_f32_16x16x32_bf16 v[136:139], v[220:223], v[84:87], v[136:139]
v_mfma_f32_16x16x32_bf16 v[140:143], v[220:223], v[116:119], v[140:143]
ds_read_b128 v[220:223], v240 offset:14336
s_waitcnt lgkmcnt(3)
buffer_load_dwordx4 v241, s[12:15], s28 offen offset:3072 sc1 lds
v_mfma_f32_16x16x32_bf16 v[144:147], v[208:211], v[20:23], v[144:147]
v_mfma_f32_16x16x32_bf16 v[148:151], v[208:211], v[52:55], v[148:151]
v_mfma_f32_16x16x32_bf16 v[152:155], v[208:211], v[84:87], v[152:155]
v_mfma_f32_16x16x32_bf16 v[156:159], v[208:211], v[116:119], v[156:159]
ds_read_b128 v[208:211], v240 offset:28672
s_waitcnt lgkmcnt(3)
v_mfma_f32_16x16x32_bf16 v[176:179], v[212:215], v[20:23], v[176:179]
v_mfma_f32_16x16x32_bf16 v[180:183], v[212:215], v[52:55], v[180:183]
v_mfma_f32_16x16x32_bf16 v[184:187], v[212:215], v[84:87], v[184:187]
v_mfma_f32_16x16x32_bf16 v[188:191], v[212:215], v[116:119], v[188:191]
ds_read_b128 v[212:215], v240 offset:12800
s_waitcnt lgkmcnt(3)
s_waitcnt vmcnt(10)
v_mfma_f32_16x16x32_bf16 v[128:131], v[216:219], v[24:27], v[128:131]
v_mfma_f32_16x16x32_bf16 v[132:135], v[216:219], v[56:59], v[132:135]
s_add_u32 s28, s28, s101
s_add_u32 s30, s30, 0xc000
v_mfma_f32_16x16x32_bf16 v[136:139], v[216:219], v[88:91], v[136:139]
v_mfma_f32_16x16x32_bf16 v[140:143], v[216:219], v[120:123], v[140:143]
ds_read_b128 v[216:219], v240 offset:14848
s_waitcnt lgkmcnt(3)
v_mfma_f32_16x16x32_bf16 v[144:147], v[220:223], v[24:27], v[144:147]
v_mfma_f32_16x16x32_bf16 v[148:151], v[220:223], v[56:59], v[148:151]
v_mfma_f32_16x16x32_bf16 v[152:155], v[220:223], v[88:91], v[152:155]
v_mfma_f32_16x16x32_bf16 v[156:159], v[220:223], v[120:123], v[156:159]
ds_read_b128 v[220:223], v240 offset:29184
s_waitcnt lgkmcnt(3)
v_mfma_f32_16x16x32_bf16 v[176:179], v[208:211], v[24:27], v[176:179]
v_mfma_f32_16x16x32_bf16 v[180:183], v[208:211], v[56:59], v[180:183]
v_mfma_f32_16x16x32_bf16 v[184:187], v[208:211], v[88:91], v[184:187]
v_mfma_f32_16x16x32_bf16 v[188:191], v[208:211], v[120:123], v[188:191]
s_waitcnt lgkmcnt(2)
s_waitcnt vmcnt(6)
v_mfma_f32_16x16x32_bf16 v[128:131], v[212:215], v[28:31], v[128:131]
v_mfma_f32_16x16x32_bf16 v[132:135], v[212:215], v[60:63], v[132:135]
v_mfma_f32_16x16x32_bf16 v[136:139], v[212:215], v[92:95], v[136:139]
v_mfma_f32_16x16x32_bf16 v[140:143], v[212:215], v[124:127], v[140:143]
s_waitcnt lgkmcnt(1)
v_mfma_f32_16x16x32_bf16 v[144:147], v[216:219], v[28:31], v[144:147]
v_mfma_f32_16x16x32_bf16 v[148:151], v[216:219], v[60:63], v[148:151]
v_mfma_f32_16x16x32_bf16 v[152:155], v[216:219], v[92:95], v[152:155]
v_mfma_f32_16x16x32_bf16 v[156:159], v[216:219], v[124:127], v[156:159]
s_waitcnt lgkmcnt(0)
v_mfma_f32_16x16x32_bf16 v[176:179], v[220:223], v[28:31], v[176:179]
v_mfma_f32_16x16x32_bf16 v[180:183], v[220:223], v[60:63], v[180:183]
v_mfma_f32_16x16x32_bf16 v[184:187], v[220:223], v[92:95], v[184:187]
v_mfma_f32_16x16x32_bf16 v[188:191], v[220:223], v[124:127], v[188:191]
v_max3_f32 v248, v128, v129, v130
v_max3_f32 v249, v132, v133, v134
v_max3_f32 v250, v136, v137, v138
v_max3_f32 v251, v140, v141, v142
v_max3_f32 v248, v248, v131, v144
v_max3_f32 v249, v249, v135, v148
v_max3_f32 v250, v250, v139, v152
v_max3_f32 v251, v251, v143, v156
v_max3_f32 v248, v248, v145, v146
v_max3_f32 v249, v249, v149, v150
v_max3_f32 v250, v250, v153, v154
v_max3_f32 v251, v251, v157, v158
v_max_f32 v248, v248, v147
v_max_f32 v249, v249, v151
v_max_f32 v250, v250, v155
v_max_f32 v251, v251, v159
v_mov_b32 v232, v248
v_mov_b32 v233, v249
v_mov_b32 v234, v250
v_mov_b32 v235, v251
v_permlane32_swap_b32 v248, v232
v_permlane32_swap_b32 v249, v233
v_permlane32_swap_b32 v250, v234
v_permlane32_swap_b32 v251, v235
v_max_f32 v248, v248, v232
v_max_f32 v249, v249, v233
v_max_f32 v250, v250, v234
v_max_f32 v251, v251, v235
v_mov_b32 v232, v248
v_mov_b32 v233, v249
v_mov_b32 v234, v250
v_mov_b32 v235, v251
v_permlane16_swap_b32 v248, v232
v_permlane16_swap_b32 v249, v233
v_permlane16_swap_b32 v250, v234
v_permlane16_swap_b32 v251, v235
v_max_f32 v248, v248, v232
v_max_f32 v249, v249, v233
v_max_f32 v250, v250, v234
v_max_f32 v251, v251, v235
v_ceil_f32 v248, v248
v_ceil_f32 v249, v249
v_ceil_f32 v250, v250
v_ceil_f32 v251, v251
v_sub_f32 v128, v128, v248
v_sub_f32 v129, v129, v248
v_sub_f32 v130, v130, v248
v_sub_f32 v131, v131, v248
v_exp_f32 v128, v128
v_exp_f32 v129, v129
v_exp_f32 v130, v130
v_exp_f32 v131, v131
v_sub_f32 v192, 0, v248
v_sub_f32 v193, 0, v248
v_sub_f32 v194, 0, v248
v_sub_f32 v195, 0, v248
v_sub_f32 v132, v132, v249
v_sub_f32 v133, v133, v249
v_sub_f32 v134, v134, v249
v_sub_f32 v135, v135, v249
v_exp_f32 v132, v132
v_exp_f32 v133, v133
v_exp_f32 v134, v134
v_exp_f32 v135, v135
v_sub_f32 v196, 0, v249
v_sub_f32 v197, 0, v249
v_sub_f32 v198, 0, v249
v_sub_f32 v199, 0, v249
v_sub_f32 v136, v136, v250
v_sub_f32 v137, v137, v250
v_sub_f32 v138, v138, v250
v_sub_f32 v139, v139, v250
v_exp_f32 v136, v136
v_exp_f32 v137, v137
v_exp_f32 v138, v138
v_exp_f32 v139, v139
v_sub_f32 v200, 0, v250
v_sub_f32 v201, 0, v250
v_sub_f32 v202, 0, v250
v_sub_f32 v203, 0, v250
v_sub_f32 v140, v140, v251
v_sub_f32 v141, v141, v251
v_sub_f32 v142, v142, v251
v_sub_f32 v143, v143, v251
v_exp_f32 v140, v140
v_exp_f32 v141, v141
v_exp_f32 v142, v142
v_exp_f32 v143, v143
v_sub_f32 v204, 0, v251
v_sub_f32 v205, 0, v251
v_sub_f32 v206, 0, v251
v_sub_f32 v207, 0, v251
s_waitcnt vmcnt(4)
s_barrier
ds_read_b128 v[208:211], v240 offset:18432
ds_read_b128 v[212:215], v240 offset:18944
ds_read_b128 v[216:219], v240 offset:22528
ds_read_b128 v[220:223], v240 offset:23040
v_add_f32 v144, v144, v192
v_add_f32 v145, v145, v192
v_add_f32 v146, v146, v192
v_add_f32 v147, v147, v192
v_exp_f32 v144, v144
v_exp_f32 v145, v145
v_exp_f32 v146, v146
v_exp_f32 v147, v147
v_add_f32 v148, v148, v196
v_add_f32 v149, v149, v196
v_add_f32 v150, v150, v196
v_add_f32 v151, v151, v196
v_exp_f32 v148, v148
v_exp_f32 v149, v149
v_exp_f32 v150, v150
v_exp_f32 v151, v151
v_add_f32 v152, v152, v200
v_add_f32 v153, v153, v200
v_add_f32 v154, v154, v200
v_add_f32 v155, v155, v200
v_exp_f32 v152, v152
v_exp_f32 v153, v153
v_exp_f32 v154, v154
v_exp_f32 v155, v155
v_add_f32 v156, v156, v204
v_add_f32 v157, v157, v204
v_add_f32 v158, v158, v204
v_add_f32 v159, v159, v204
v_exp_f32 v156, v156
v_exp_f32 v157, v157
v_exp_f32 v158, v158
v_exp_f32 v159, v159
v_cvt_pk_bf16_f32 v160, v128, v129
v_cvt_pk_bf16_f32 v161, v130, v131
v_cvt_pk_bf16_f32 v164, v132, v133
v_cvt_pk_bf16_f32 v165, v134, v135
v_cvt_pk_bf16_f32 v168, v136, v137
v_cvt_pk_bf16_f32 v169, v138, v139
v_cvt_pk_bf16_f32 v172, v140, v141
v_cvt_pk_bf16_f32 v173, v142, v143
v_cvt_pk_bf16_f32 v162, v144, v145
v_cvt_pk_bf16_f32 v163, v146, v147
v_cvt_pk_bf16_f32 v166, v148, v149
v_cvt_pk_bf16_f32 v167, v150, v151
v_cvt_pk_bf16_f32 v170, v152, v153
v_cvt_pk_bf16_f32 v171, v154, v155
v_cvt_pk_bf16_f32 v174, v156, v157
v_cvt_pk_bf16_f32 v175, v158, v159
v_add_f32 v224, v128, v129
v_add_f32 v225, v132, v133
v_add_f32 v226, v136, v137
v_add_f32 v227, v140, v141
v_add_f32 v224, v224, v130
v_add_f32 v225, v225, v134
v_add_f32 v226, v226, v138
v_add_f32 v227, v227, v142
v_add_f32 v224, v224, v131
v_add_f32 v225, v225, v135
v_add_f32 v226, v226, v139
v_add_f32 v227, v227, v143
v_add_f32 v224, v224, v144
v_add_f32 v225, v225, v148
v_add_f32 v226, v226, v152
v_add_f32 v227, v227, v156
v_add_f32 v224, v224, v145
v_add_f32 v225, v225, v149
v_add_f32 v226, v226, v153
v_add_f32 v227, v227, v157
v_add_f32 v224, v224, v146
v_add_f32 v225, v225, v150
v_add_f32 v226, v226, v154
v_add_f32 v227, v227, v158
v_add_f32 v224, v224, v147
v_add_f32 v225, v225, v151
v_add_f32 v226, v226, v155
v_add_f32 v227, v227, v159
v_add_f32 v128, v176, v192
v_add_f32 v129, v177, v192
v_add_f32 v130, v178, v192
v_add_f32 v131, v179, v192
v_add_f32 v132, v180, v196
v_add_f32 v133, v181, v196
v_add_f32 v134, v182, v196
v_add_f32 v135, v183, v196
v_add_f32 v136, v184, v200
v_add_f32 v137, v185, v200
v_add_f32 v138, v186, v200
v_add_f32 v139, v187, v200
v_add_f32 v140, v188, v204
v_add_f32 v141, v189, v204
v_add_f32 v142, v190, v204
v_add_f32 v143, v191, v204
v_cmp_ne_u64 vcc, s[98:99], v[228:229]
s_nop 1
s_cbranch_vccnz LM_pb
LM_pb_ret:
s_nop 1
s_waitcnt lgkmcnt(2)
v_mfma_f32_16x16x32_bf16 v[144:147], v[208:211], v[0:3], v[192:195]
v_mfma_f32_16x16x32_bf16 v[144:147], v[212:215], v[4:7], v[144:147]
v_mfma_f32_16x16x32_bf16 v[148:151], v[208:211], v[32:35], v[196:199]
v_mfma_f32_16x16x32_bf16 v[148:151], v[212:215], v[36:39], v[148:151]
v_mfma_f32_16x16x32_bf16 v[152:155], v[208:211], v[64:67], v[200:203]
v_exp_f32 v128, v128
v_mfma_f32_16x16x32_bf16 v[152:155], v[212:215], v[68:71], v[152:155]
v_exp_f32 v129, v129
v_mfma_f32_16x16x32_bf16 v[156:159], v[208:211], v[96:99], v[204:207]
ds_read_b128 v[208:211], v240 offset:26624
v_exp_f32 v130, v130
v_mfma_f32_16x16x32_bf16 v[156:159], v[212:215], v[100:103], v[156:159]
ds_read_b128 v[212:215], v240 offset:27136
s_waitcnt lgkmcnt(2)
v_add_f32 v224, v224, v128
v_mfma_f32_16x16x32_bf16 v[144:147], v[216:219], v[8:11], v[144:147]
v_exp_f32 v131, v131
v_add_f32 v224, v224, v129
v_mfma_f32_16x16x32_bf16 v[144:147], v[220:223], v[12:15], v[144:147]
v_add_f32 v224, v224, v130
v_add_f32 v224, v224, v131
v_mfma_f32_16x16x32_bf16 v[148:151], v[216:219], v[40:43], v[148:151]
v_exp_f32 v132, v132
v_mfma_f32_16x16x32_bf16 v[148:151], v[220:223], v[44:47], v[148:151]
v_exp_f32 v133, v133
v_mfma_f32_16x16x32_bf16 v[152:155], v[216:219], v[72:75], v[152:155]
v_exp_f32 v134, v134
v_add_f32 v225, v225, v132
v_mfma_f32_16x16x32_bf16 v[152:155], v[220:223], v[76:79], v[152:155]
v_exp_f32 v135, v135
v_add_f32 v225, v225, v133
v_mfma_f32_16x16x32_bf16 v[156:159], v[216:219], v[104:107], v[156:159]
ds_read_b128 v[216:219], v240 offset:30720
v_add_f32 v225, v225, v134
v_add_f32 v225, v225, v135
v_mfma_f32_16x16x32_bf16 v[156:159], v[220:223], v[108:111], v[156:159]
ds_read_b128 v[220:223], v240 offset:31232
s_waitcnt lgkmcnt(2)
v_mfma_f32_16x16x32_bf16 v[144:147], v[208:211], v[16:19], v[144:147]
v_exp_f32 v136, v136
v_mfma_f32_16x16x32_bf16 v[144:147], v[212:215], v[20:23], v[144:147]
v_add_u32 v240, 0x8000, v240
v_exp_f32 v137, v137
v_mfma_f32_16x16x32_bf16 v[148:151], v[208:211], v[48:51], v[148:151]
v_and_b32 v240, 0x1ffff, v240
v_exp_f32 v138, v138
v_mfma_f32_16x16x32_bf16 v[148:151], v[212:215], v[52:55], v[148:151]
v_add_f32 v226, v226, v136
v_exp_f32 v139, v139
v_mfma_f32_16x16x32_bf16 v[152:155], v[208:211], v[80:83], v[152:155]
v_add_f32 v226, v226, v137
v_add_f32 v226, v226, v138
v_add_f32 v226, v226, v139
v_mfma_f32_16x16x32_bf16 v[152:155], v[212:215], v[84:87], v[152:155]
v_exp_f32 v140, v140
v_mfma_f32_16x16x32_bf16 v[156:159], v[208:211], v[112:115], v[156:159]
ds_read_b64_tr_b16 v[208:209], v246 offset:0
ds_read_b64_tr_b16 v[210:211], v246 offset:2048
v_mfma_f32_16x16x32_bf16 v[156:159], v[212:215], v[116:119], v[156:159]
ds_read_b64_tr_b16 v[212:213], v247 offset:0
s_waitcnt lgkmcnt(3)
v_mfma_f32_16x16x32_bf16 v[144:147], v[216:219], v[24:27], v[144:147]
ds_read_b64_tr_b16 v[214:215], v247 offset:2048
v_exp_f32 v141, v141
v_mfma_f32_16x16x32_bf16 v[144:147], v[220:223], v[28:31], v[144:147]
v_exp_f32 v142, v142
v_add_f32 v227, v227, v140
v_mfma_f32_16x16x32_bf16 v[148:151], v[216:219], v[56:59], v[148:151]
v_exp_f32 v143, v143
v_add_f32 v227, v227, v141
v_mfma_f32_16x16x32_bf16 v[148:151], v[220:223], v[60:63], v[148:151]
v_add_f32 v227, v227, v142
v_add_f32 v227, v227, v143
v_max3_f32 v242, v224, v225, v226
v_mfma_f32_16x16x32_bf16 v[152:155], v[216:219], v[88:91], v[152:155]
v_max_f32 v242, v242, v227
v_mfma_f32_16x16x32_bf16 v[152:155], v[220:223], v[92:95], v[152:155]
v_cmp_lt_f32 vcc, s32, v242
v_mfma_f32_16x16x32_bf16 v[156:159], v[216:219], v[120:123], v[156:159]
ds_read_b64_tr_b16 v[216:217], v246 offset:512
ds_read_b64_tr_b16 v[218:219], v246 offset:2560
v_mfma_f32_16x16x32_bf16 v[156:159], v[220:223], v[124:127], v[156:159]
ds_read_b64_tr_b16 v[220:221], v247 offset:512
s_waitcnt lgkmcnt(5)
v_mfma_f32_16x16x32_bf16 a[0:3], v[160:163], v[208:211], a[0:3]
ds_read_b64_tr_b16 v[222:223], v247 offset:2560
s_cbranch_vccnz L2_rare_site4
L2_ret4:
v_mfma_f32_16x16x32_bf16 a[4:7], v[164:167], v[208:211], a[4:7]
s_mov_b32 m0, s30
v_mfma_f32_16x16x32_bf16 a[8:11], v[168:171], v[208:211], a[8:11]
buffer_load_dwordx4 v241, s[12:15], s28 offen offset:0 sc1 lds
v_mfma_f32_16x16x32_bf16 a[12:15], v[172:175], v[208:211], a[12:15]
ds_read_b64_tr_b16 v[208:209], v246 offset:4096
s_waitcnt lgkmcnt(5)
v_mfma_f32_16x16x32_bf16 a[16:19], v[160:163], v[212:215], a[16:19]
ds_read_b64_tr_b16 v[210:211], v246 offset:6144
buffer_load_dwordx4 v241, s[12:15], s28 offen offset:1024 sc1 lds
v_mfma_f32_16x16x32_bf16 a[20:23], v[164:167], v[212:215], a[20:23]
v_mfma_f32_16x16x32_bf16 a[24:27], v[168:171], v[212:215], a[24:27]
buffer_load_dwordx4 v241, s[12:15], s28 offen offset:2048 sc1 lds
v_mfma_f32_16x16x32_bf16 a[28:31], v[172:175], v[212:215], a[28:31]
ds_read_b64_tr_b16 v[212:213], v247 offset:4096
s_waitcnt lgkmcnt(5)
v_mfma_f32_16x16x32_bf16 a[32:35], v[160:163], v[216:219], a[32:35]
ds_read_b64_tr_b16 v[214:215], v247 offset:6144
v_exp_f32 v144, v144
v_mfma_f32_16x16x32_bf16 a[36:39], v[164:167], v[216:219], a[36:39]
buffer_load_dwordx4 v241, s[12:15], s28 offen offset:3072 sc1 lds
v_exp_f32 v145, v145
v_mfma_f32_16x16x32_bf16 a[40:43], v[168:171], v[216:219], a[40:43]
v_exp_f32 v146, v146
v_add_f32 v224, v224, v144
v_mfma_f32_16x16x32_bf16 a[44:47], v[172:175], v[216:219], a[44:47]
ds_read_b64_tr_b16 v[216:217], v246 offset:4608
s_waitcnt lgkmcnt(5)
v_mfma_f32_16x16x32_bf16 a[48:51], v[160:163], v[220:223], a[48:51]
ds_read_b64_tr_b16 v[218:219], v246 offset:6656
v_exp_f32 v147, v147
v_mfma_f32_16x16x32_bf16 a[52:55], v[164:167], v[220:223], a[52:55]
v_add_f32 v224, v224, v145
v_add_f32 v224, v224, v146
v_add_f32 v224, v224, v147
v_mfma_f32_16x16x32_bf16 a[56:59], v[168:171], v[220:223], a[56:59]
v_exp_f32 v148, v148
v_mfma_f32_16x16x32_bf16 a[60:63], v[172:175], v[220:223], a[60:63]
ds_read_b64_tr_b16 v[220:221], v247 offset:4608
s_waitcnt lgkmcnt(5)
v_mfma_f32_16x16x32_bf16 a[64:67], v[160:163], v[208:211], a[64:67]
ds_read_b64_tr_b16 v[222:223], v247 offset:6656
v_exp_f32 v149, v149
v_mfma_f32_16x16x32_bf16 a[68:71], v[164:167], v[208:211], a[68:71]
s_waitcnt vmcnt(4)
s_barrier
v_mfma_f32_16x16x32_bf16 a[72:75], v[168:171], v[208:211], a[72:75]
v_exp_f32 v150, v150
v_add_f32 v225, v225, v148
v_mfma_f32_16x16x32_bf16 a[76:79], v[172:175], v[208:211], a[76:79]
ds_read_b128 v[208:211], v240 offset:0
s_waitcnt lgkmcnt(5)
v_mfma_f32_16x16x32_bf16 a[80:83], v[160:163], v[212:215], a[80:83]
v_exp_f32 v151, v151
v_add_f32 v225, v225, v149
v_mfma_f32_16x16x32_bf16 a[84:87], v[164:167], v[212:215], a[84:87]
v_add_f32 v225, v225, v150
v_add_f32 v225, v225, v151
v_mfma_f32_16x16x32_bf16 a[88:91], v[168:171], v[212:215], a[88:91]
v_exp_f32 v152, v152
v_mfma_f32_16x16x32_bf16 a[92:95], v[172:175], v[212:215], a[92:95]
ds_read_b128 v[212:215], v240 offset:512
s_waitcnt lgkmcnt(4)
v_mfma_f32_16x16x32_bf16 a[96:99], v[160:163], v[216:219], a[96:99]
v_exp_f32 v153, v153
v_mfma_f32_16x16x32_bf16 a[100:103], v[164:167], v[216:219], a[100:103]
v_cvt_pk_bf16_f32 v176, v128, v129
v_cvt_pk_bf16_f32 v177, v130, v131
v_mfma_f32_16x16x32_bf16 a[104:107], v[168:171], v[216:219], a[104:107]
v_exp_f32 v154, v154
v_add_f32 v226, v226, v152
v_mfma_f32_16x16x32_bf16 a[108:111], v[172:175], v[216:219], a[108:111]
ds_read_b128 v[216:219], v240 offset:4096
s_waitcnt lgkmcnt(3)
v_cvt_pk_bf16_f32 v180, v132, v133
v_cvt_pk_bf16_f32 v181, v134, v135
v_mfma_f32_16x16x32_bf16 a[112:115], v[160:163], v[220:223], a[112:115]
v_exp_f32 v155, v155
v_add_f32 v226, v226, v153
v_mfma_f32_16x16x32_bf16 a[116:119], v[164:167], v[220:223], a[116:119]
v_cvt_pk_bf16_f32 v184, v136, v137
v_cvt_pk_bf16_f32 v185, v138, v139
v_add_f32 v226, v226, v154
v_mfma_f32_16x16x32_bf16 a[120:123], v[168:171], v[220:223], a[120:123]
v_add_f32 v226, v226, v155
v_exp_f32 v156, v156
v_mfma_f32_16x16x32_bf16 a[124:127], v[172:175], v[220:223], a[124:127]
ds_read_b128 v[220:223], v240 offset:4608
s_waitcnt lgkmcnt(2)
v_mfma_f32_16x16x32_bf16 v[128:131], v[208:211], v[0:3], v[192:195]
v_exp_f32 v157, v157
v_mfma_f32_16x16x32_bf16 v[128:131], v[212:215], v[4:7], v[128:131]
v_cvt_pk_bf16_f32 v188, v140, v141
v_cvt_pk_bf16_f32 v189, v142, v143
v_mfma_f32_16x16x32_bf16 v[132:135], v[208:211], v[32:35], v[196:199]
v_exp_f32 v158, v158
v_add_f32 v227, v227, v156
v_mfma_f32_16x16x32_bf16 v[132:135], v[212:215], v[36:39], v[132:135]
v_exp_f32 v159, v159
v_add_f32 v227, v227, v157
v_mfma_f32_16x16x32_bf16 v[136:139], v[208:211], v[64:67], v[200:203]
v_add_f32 v227, v227, v158
v_add_f32 v227, v227, v159
v_max3_f32 v242, v224, v225, v226
v_mfma_f32_16x16x32_bf16 v[136:139], v[212:215], v[68:71], v[136:139]
v_max_f32 v242, v242, v227
v_mfma_f32_16x16x32_bf16 v[140:143], v[208:211], v[96:99], v[204:207]
ds_read_b128 v[208:211], v240 offset:8192
v_cmp_lt_f32 vcc, s32, v242
v_mfma_f32_16x16x32_bf16 v[140:143], v[212:215], v[100:103], v[140:143]
ds_read_b128 v[212:215], v240 offset:8704
s_waitcnt lgkmcnt(2)
v_mfma_f32_16x16x32_bf16 v[128:131], v[216:219], v[8:11], v[128:131]
v_mfma_f32_16x16x32_bf16 v[128:131], v[220:223], v[12:15], v[128:131]
s_cbranch_vccnz L2_rare_site5
L2_ret5:
v_cvt_pk_bf16_f32 v178, v144, v145
v_cvt_pk_bf16_f32 v179, v146, v147
v_mfma_f32_16x16x32_bf16 v[132:135], v[216:219], v[40:43], v[132:135]
v_cvt_pk_bf16_f32 v182, v148, v149
v_cvt_pk_bf16_f32 v183, v150, v151
v_cvt_pk_bf16_f32 v186, v152, v153
v_mfma_f32_16x16x32_bf16 v[132:135], v[220:223], v[44:47], v[132:135]
v_cvt_pk_bf16_f32 v187, v154, v155
v_cvt_pk_bf16_f32 v190, v156, v157
v_cvt_pk_bf16_f32 v191, v158, v159
v_mfma_f32_16x16x32_bf16 v[136:139], v[216:219], v[72:75], v[136:139]
v_mfma_f32_16x16x32_bf16 v[136:139], v[220:223], v[76:79], v[136:139]
v_mfma_f32_16x16x32_bf16 v[140:143], v[216:219], v[104:107], v[140:143]
ds_read_b128 v[216:219], v240 offset:12288
v_mfma_f32_16x16x32_bf16 v[140:143], v[220:223], v[108:111], v[140:143]
ds_read_b128 v[220:223], v240 offset:12800
s_waitcnt lgkmcnt(2)
v_mfma_f32_16x16x32_bf16 v[128:131], v[208:211], v[16:19], v[128:131]
v_mfma_f32_16x16x32_bf16 v[128:131], v[212:215], v[20:23], v[128:131]
v_mfma_f32_16x16x32_bf16 v[132:135], v[208:211], v[48:51], v[132:135]
v_mfma_f32_16x16x32_bf16 v[132:135], v[212:215], v[52:55], v[132:135]
v_mfma_f32_16x16x32_bf16 v[136:139], v[208:211], v[80:83], v[136:139]
v_mfma_f32_16x16x32_bf16 v[136:139], v[212:215], v[84:87], v[136:139]
s_sub_u32 s31, s31, 1
v_mfma_f32_16x16x32_bf16 v[140:143], v[208:211], v[112:115], v[140:143]
ds_read_b128 v[208:211], v240 offset:2048
v_mfma_f32_16x16x32_bf16 v[140:143], v[212:215], v[116:119], v[140:143]
ds_read_b128 v[212:215], v240 offset:2560
s_waitcnt lgkmcnt(2)
v_mfma_f32_16x16x32_bf16 v[128:131], v[216:219], v[24:27], v[128:131]
s_add_u32 s28, s28, s101
s_add_u32 s30, s30, 0x4000
v_mfma_f32_16x16x32_bf16 v[128:131], v[220:223], v[28:31], v[128:131]
s_and_b32 s30, s30, 0x1ffff
v_mfma_f32_16x16x32_bf16 v[132:135], v[216:219], v[56:59], v[132:135]
v_mfma_f32_16x16x32_bf16 v[132:135], v[220:223], v[60:63], v[132:135]
v_mfma_f32_16x16x32_bf16 v[136:139], v[216:219], v[88:91], v[136:139]
v_mfma_f32_16x16x32_bf16 v[136:139], v[220:223], v[92:95], v[136:139]
v_mfma_f32_16x16x32_bf16 v[140:143], v[216:219], v[120:123], v[140:143]
ds_read_b128 v[216:219], v240 offset:6144
v_mfma_f32_16x16x32_bf16 v[140:143], v[220:223], v[124:127], v[140:143]
ds_read_b128 v[220:223], v240 offset:6656
s_branch L2_loop1
.p2align 6
L2_loop:
s_waitcnt lgkmcnt(2)
v_mfma_f32_16x16x32_bf16 v[144:147], v[208:211], v[0:3], v[192:195]
v_mfma_f32_16x16x32_bf16 v[144:147], v[212:215], v[4:7], v[144:147]
v_mfma_f32_16x16x32_bf16 v[148:151], v[208:211], v[32:35], v[196:199]
v_mfma_f32_16x16x32_bf16 v[148:151], v[212:215], v[36:39], v[148:151]
v_mfma_f32_16x16x32_bf16 v[152:155], v[208:211], v[64:67], v[200:203]
v_exp_f32 v128, v128
v_mfma_f32_16x16x32_bf16 v[152:155], v[212:215], v[68:71], v[152:155]
v_exp_f32 v129, v129
v_mfma_f32_16x16x32_bf16 v[156:159], v[208:211], v[96:99], v[204:207]
ds_read_b128 v[208:211], v240 offset:26624
v_mfma_f32_16x16x32_bf16 v[156:159], v[212:215], v[100:103], v[156:159]
ds_read_b128 v[212:215], v240 offset:27136
s_waitcnt lgkmcnt(2)
v_mfma_f32_16x16x32_bf16 v[144:147], v[216:219], v[8:11], v[144:147]
v_exp_f32 v130, v130
v_mfma_f32_16x16x32_bf16 v[144:147], v[220:223], v[12:15], v[144:147]
v_add_f32 v224, v224, v128
v_mfma_f32_16x16x32_bf16 v[148:151], v[216:219], v[40:43], v[148:151]
v_exp_f32 v131, v131
v_mfma_f32_16x16x32_bf16 v[148:151], v[220:223], v[44:47], v[148:151]
v_add_f32 v224, v224, v129
v_add_f32 v224, v224, v130
v_mfma_f32_16x16x32_bf16 v[152:155], v[216:219], v[72:75], v[152:155]
v_add_f32 v224, v224, v131
v_mfma_f32_16x16x32_bf16 v[152:155], v[220:223], v[76:79], v[152:155]
v_exp_f32 v132, v132
v_mfma_f32_16x16x32_bf16 v[156:159], v[216:219], v[104:107], v[156:159]
ds_read_b128 v[216:219], v240 offset:30720
v_mfma_f32_16x16x32_bf16 v[156:159], v[220:223], v[108:111], v[156:159]
ds_read_b128 v[220:223], v240 offset:31232
s_waitcnt lgkmcnt(2)
v_mfma_f32_16x16x32_bf16 v[144:147], v[208:211], v[16:19], v[144:147]
v_exp_f32 v133, v133
v_mfma_f32_16x16x32_bf16 v[144:147], v[212:215], v[20:23], v[144:147]
v_add_u32 v240, 0x8000, v240
v_mfma_f32_16x16x32_bf16 v[148:151], v[208:211], v[48:51], v[148:151]
v_and_b32 v240, 0x1ffff, v240
v_mfma_f32_16x16x32_bf16 v[148:151], v[212:215], v[52:55], v[148:151]
v_exp_f32 v134, v134
v_mfma_f32_16x16x32_bf16 v[152:155], v[208:211], v[80:83], v[152:155]
v_add_f32 v225, v225, v132
v_mfma_f32_16x16x32_bf16 v[152:155], v[212:215], v[84:87], v[152:155]
v_exp_f32 v135, v135
v_mfma_f32_16x16x32_bf16 v[156:159], v[208:211], v[112:115], v[156:159]
ds_read_b64_tr_b16 v[208:209], v244 offset:16384
ds_read_b64_tr_b16 v[210:211], v244 offset:18432
v_mfma_f32_16x16x32_bf16 v[156:159], v[212:215], v[116:119], v[156:159]
ds_read_b64_tr_b16 v[212:213], v246 offset:0
s_waitcnt lgkmcnt(3)
v_mfma_f32_16x16x32_bf16 v[144:147], v[216:219], v[24:27], v[144:147]
ds_read_b64_tr_b16 v[214:215], v246 offset:2048
v_add_f32 v225, v225, v133
v_mfma_f32_16x16x32_bf16 v[144:147], v[220:223], v[28:31], v[144:147]
v_add_f32 v225, v225, v134
v_add_f32 v225, v225, v135
v_mfma_f32_16x16x32_bf16 v[148:151], v[216:219], v[56:59], v[148:151]
v_exp_f32 v136, v136
v_mfma_f32_16x16x32_bf16 v[148:151], v[220:223], v[60:63], v[148:151]
v_exp_f32 v137, v137
v_mfma_f32_16x16x32_bf16 v[152:155], v[216:219], v[88:91], v[152:155]
v_exp_f32 v138, v138
v_mfma_f32_16x16x32_bf16 v[152:155], v[220:223], v[92:95], v[152:155]
v_add_f32 v226, v226, v136
v_mfma_f32_16x16x32_bf16 v[156:159], v[216:219], v[120:123], v[156:159]
ds_read_b64_tr_b16 v[216:217], v245 offset:16384
ds_read_b64_tr_b16 v[218:219], v245 offset:18432
v_mfma_f32_16x16x32_bf16 v[156:159], v[220:223], v[124:127], v[156:159]
ds_read_b64_tr_b16 v[220:221], v247 offset:0
s_waitcnt lgkmcnt(3)
v_mfma_f32_16x16x32_bf16 a[0:3], v[176:179], v[208:211], a[0:3]
ds_read_b64_tr_b16 v[222:223], v247 offset:2048
v_mfma_f32_16x16x32_bf16 a[0:3], v[160:163], v[212:215], a[0:3]
v_exp_f32 v139, v139
v_mfma_f32_16x16x32_bf16 a[4:7], v[180:183], v[208:211], a[4:7]
v_add_f32 v226, v226, v137
v_add_f32 v226, v226, v138
v_mfma_f32_16x16x32_bf16 a[4:7], v[164:167], v[212:215], a[4:7]
v_add_f32 v226, v226, v139
v_mfma_f32_16x16x32_bf16 a[8:11], v[184:187], v[208:211], a[8:11]
v_exp_f32 v140, v140
v_mfma_f32_16x16x32_bf16 a[8:11], v[168:171], v[212:215], a[8:11]
v_exp_f32 v141, v141
v_mfma_f32_16x16x32_bf16 a[12:15], v[188:191], v[208:211], a[12:15]
ds_read_b64_tr_b16 v[208:209], v244 offset:16896
ds_read_b64_tr_b16 v[210:211], v244 offset:18944
v_mfma_f32_16x16x32_bf16 a[12:15], v[172:175], v[212:215], a[12:15]
ds_read_b64_tr_b16 v[212:213], v246 offset:512
s_waitcnt lgkmcnt(3)
v_mfma_f32_16x16x32_bf16 a[16:19], v[176:179], v[216:219], a[16:19]
ds_read_b64_tr_b16 v[214:215], v246 offset:2560
v_mfma_f32_16x16x32_bf16 a[16:19], v[160:163], v[220:223], a[16:19]
v_exp_f32 v142, v142
v_mfma_f32_16x16x32_bf16 a[20:23], v[180:183], v[216:219], a[20:23]
v_add_f32 v227, v227, v140
v_mfma_f32_16x16x32_bf16 a[20:23], v[164:167], v[220:223], a[20:23]
v_exp_f32 v143, v143
v_mfma_f32_16x16x32_bf16 a[24:27], v[184:187], v[216:219], a[24:27]
v_add_f32 v227, v227, v141
v_add_f32 v227, v227, v142
v_mfma_f32_16x16x32_bf16 a[24:27], v[168:171], v[220:223], a[24:27]
v_add_f32 v227, v227, v143
v_max3_f32 v242, v224, v225, v226
v_mfma_f32_16x16x32_bf16 a[28:31], v[188:191], v[216:219], a[28:31]
ds_read_b64_tr_b16 v[216:217], v245 offset:16896
ds_read_b64_tr_b16 v[218:219], v245 offset:18944
v_mfma_f32_16x16x32_bf16 a[28:31], v[172:175], v[220:223], a[28:31]
ds_read_b64_tr_b16 v[220:221], v247 offset:512
s_waitcnt lgkmcnt(3)
v_mfma_f32_16x16x32_bf16 a[32:35], v[176:179], v[208:211], a[32:35]
ds_read_b64_tr_b16 v[222:223], v247 offset:2560
v_max_f32 v242, v242, v227
v_mfma_f32_16x16x32_bf16 a[32:35], v[160:163], v[212:215], a[32:35]
v_cmp_lt_f32 vcc, s32, v242
v_mfma_f32_16x16x32_bf16 a[36:39], v[180:183], v[208:211], a[36:39]
v_mfma_f32_16x16x32_bf16 a[36:39], v[164:167], v[212:215], a[36:39]
v_mfma_f32_16x16x32_bf16 a[40:43], v[184:187], v[208:211], a[40:43]
s_mov_b32 m0, s30
s_cbranch_vccnz L2_rare_site0
L2_ret0:
v_mfma_f32_16x16x32_bf16 a[40:43], v[168:171], v[212:215], a[40:43]
buffer_load_dwordx4 v241, s[12:15], s28 offen offset:0 sc1 lds
v_mfma_f32_16x16x32_bf16 a[44:47], v[188:191], v[208:211], a[44:47]
ds_read_b64_tr_b16 v[208:209], v244 offset:20480
ds_read_b64_tr_b16 v[210:211], v244 offset:22528
v_mfma_f32_16x16x32_bf16 a[44:47], v[172:175], v[212:215], a[44:47]
ds_read_b64_tr_b16 v[212:213], v246 offset:4096
s_waitcnt lgkmcnt(3)
v_mfma_f32_16x16x32_bf16 a[48:51], v[176:179], v[216:219], a[48:51]
ds_read_b64_tr_b16 v[214:215], v246 offset:6144
v_mfma_f32_16x16x32_bf16 a[48:51], v[160:163], v[220:223], a[48:51]
buffer_load_dwordx4 v241, s[12:15], s28 offen offset:1024 sc1 lds
v_mfma_f32_16x16x32_bf16 a[52:55], v[180:183], v[216:219], a[52:55]
v_exp_f32 v144, v144
v_mfma_f32_16x16x32_bf16 a[52:55], v[164:167], v[220:223], a[52:55]
v_exp_f32 v145, v145
v_mfma_f32_16x16x32_bf16 a[56:59], v[184:187], v[216:219], a[56:59]
v_exp_f32 v146, v146
v_mfma_f32_16x16x32_bf16 a[56:59], v[168:171], v[220:223], a[56:59]
buffer_load_dwordx4 v241, s[12:15], s28 offen offset:2048 sc1 lds
v_add_f32 v224, v224, v144
v_mfma_f32_16x16x32_bf16 a[60:63], v[188:191], v[216:219], a[60:63]
ds_read_b64_tr_b16 v[216:217], v245 offset:20480
ds_read_b64_tr_b16 v[218:219], v245 offset:22528
v_mfma_f32_16x16x32_bf16 a[60:63], v[172:175], v[220:223], a[60:63]
ds_read_b64_tr_b16 v[220:221], v247 offset:4096
s_waitcnt lgkmcnt(3)
v_mfma_f32_16x16x32_bf16 a[64:67], v[176:179], v[208:211], a[64:67]
ds_read_b64_tr_b16 v[222:223], v247 offset:6144
v_mfma_f32_16x16x32_bf16 a[64:67], v[160:163], v[212:215], a[64:67]
buffer_load_dwordx4 v241, s[12:15], s28 offen offset:3072 sc1 lds
v_mfma_f32_16x16x32_bf16 a[68:71], v[180:183], v[208:211], a[68:71]
v_exp_f32 v147, v147
v_mfma_f32_16x16x32_bf16 a[68:71], v[164:167], v[212:215], a[68:71]
v_add_f32 v224, v224, v145
v_add_f32 v224, v224, v146
v_mfma_f32_16x16x32_bf16 a[72:75], v[184:187], v[208:211], a[72:75]
v_add_f32 v224, v224, v147
v_mfma_f32_16x16x32_bf16 a[72:75], v[168:171], v[212:215], a[72:75]
v_exp_f32 v148, v148
v_mfma_f32_16x16x32_bf16 a[76:79], v[188:191], v[208:211], a[76:79]
ds_read_b64_tr_b16 v[208:209], v244 offset:20992
ds_read_b64_tr_b16 v[210:211], v244 offset:23040
v_mfma_f32_16x16x32_bf16 a[76:79], v[172:175], v[212:215], a[76:79]
ds_read_b64_tr_b16 v[212:213], v246 offset:4608
s_waitcnt lgkmcnt(3)
v_mfma_f32_16x16x32_bf16 a[80:83], v[176:179], v[216:219], a[80:83]
ds_read_b64_tr_b16 v[214:215], v246 offset:6656
v_mfma_f32_16x16x32_bf16 a[80:83], v[160:163], v[220:223], a[80:83]
v_exp_f32 v149, v149
v_mfma_f32_16x16x32_bf16 a[84:87], v[180:183], v[216:219], a[84:87]
v_exp_f32 v150, v150
v_mfma_f32_16x16x32_bf16 a[84:87], v[164:167], v[220:223], a[84:87]
v_add_f32 v225, v225, v148
v_mfma_f32_16x16x32_bf16 a[88:91], v[184:187], v[216:219], a[88:91]
v_exp_f32 v151, v151
v_mfma_f32_16x16x32_bf16 a[88:91], v[168:171], v[220:223], a[88:91]
v_add_f32 v225, v225, v149
v_add_f32 v225, v225, v150
v_mfma_f32_16x16x32_bf16 a[92:95], v[188:191], v[216:219], a[92:95]
ds_read_b64_tr_b16 v[216:217], v245 offset:20992
ds_read_b64_tr_b16 v[218:219], v245 offset:23040
v_mfma_f32_16x16x32_bf16 a[92:95], v[172:175], v[220:223], a[92:95]
ds_read_b64_tr_b16 v[220:221], v247 offset:4608
s_waitcnt lgkmcnt(3)
v_mfma_f32_16x16x32_bf16 a[96:99], v[176:179], v[208:211], a[96:99]
ds_read_b64_tr_b16 v[222:223], v247 offset:6656
v_add_f32 v225, v225, v151
v_mfma_f32_16x16x32_bf16 a[96:99], v[160:163], v[212:215], a[96:99]
s_waitcnt vmcnt(4)
s_barrier
v_mfma_f32_16x16x32_bf16 a[100:103], v[180:183], v[208:211], a[100:103]
v_exp_f32 v152, v152
v_mfma_f32_16x16x32_bf16 a[100:103], v[164:167], v[212:215], a[100:103]
v_exp_f32 v153, v153
v_mfma_f32_16x16x32_bf16 a[104:107], v[184:187], v[208:211], a[104:107]
v_exp_f32 v154, v154
v_mfma_f32_16x16x32_bf16 a[104:107], v[168:171], v[212:215], a[104:107]
v_add_f32 v226, v226, v152
v_mfma_f32_16x16x32_bf16 a[108:111], v[188:191], v[208:211], a[108:111]
ds_read_b128 v[208:211], v240 offset:0
v_mfma_f32_16x16x32_bf16 a[108:111], v[172:175], v[212:215], a[108:111]
ds_read_b128 v[212:215], v240 offset:512
s_waitcnt lgkmcnt(2)
v_mfma_f32_16x16x32_bf16 a[112:115], v[176:179], v[216:219], a[112:115]
v_exp_f32 v155, v155
v_mfma_f32_16x16x32_bf16 a[112:115], v[160:163], v[220:223], a[112:115]
v_cvt_pk_bf16_f32 v176, v128, v129
v_cvt_pk_bf16_f32 v177, v130, v131
v_mfma_f32_16x16x32_bf16 a[116:119], v[180:183], v[216:219], a[116:119]
v_add_f32 v226, v226, v153
v_add_f32 v226, v226, v154
v_mfma_f32_16x16x32_bf16 a[116:119], v[164:167], v[220:223], a[116:119]
v_cvt_pk_bf16_f32 v180, v132, v133
v_cvt_pk_bf16_f32 v181, v134, v135
v_mfma_f32_16x16x32_bf16 a[120:123], v[184:187], v[216:219], a[120:123]
v_add_f32 v226, v226, v155
v_mfma_f32_16x16x32_bf16 a[120:123], v[168:171], v[220:223], a[120:123]
v_cvt_pk_bf16_f32 v184, v136, v137
v_cvt_pk_bf16_f32 v185, v138, v139
v_mfma_f32_16x16x32_bf16 a[124:127], v[188:191], v[216:219], a[124:127]
ds_read_b128 v[216:219], v240 offset:4096
v_mfma_f32_16x16x32_bf16 a[124:127], v[172:175], v[220:223], a[124:127]
ds_read_b128 v[220:223], v240 offset:4608
s_waitcnt lgkmcnt(2)
v_mfma_f32_16x16x32_bf16 v[128:131], v[208:211], v[0:3], v[192:195]
v_exp_f32 v156, v156
v_mfma_f32_16x16x32_bf16 v[128:131], v[212:215], v[4:7], v[128:131]
v_cvt_pk_bf16_f32 v188, v140, v141
v_cvt_pk_bf16_f32 v189, v142, v143
v_mfma_f32_16x16x32_bf16 v[132:135], v[208:211], v[32:35], v[196:199]
v_exp_f32 v157, v157
v_mfma_f32_16x16x32_bf16 v[132:135], v[212:215], v[36:39], v[132:135]
v_exp_f32 v158, v158
v_mfma_f32_16x16x32_bf16 v[136:139], v[208:211], v[64:67], v[200:203]
v_add_f32 v227, v227, v156
v_mfma_f32_16x16x32_bf16 v[136:139], v[212:215], v[68:71], v[136:139]
v_exp_f32 v159, v159
v_mfma_f32_16x16x32_bf16 v[140:143], v[208:211], v[96:99], v[204:207]
ds_read_b128 v[208:211], v240 offset:8192
v_add_f32 v227, v227, v157
v_mfma_f32_16x16x32_bf16 v[140:143], v[212:215], v[100:103], v[140:143]
ds_read_b128 v[212:215], v240 offset:8704
s_waitcnt lgkmcnt(2)
v_mfma_f32_16x16x32_bf16 v[128:131], v[216:219], v[8:11], v[128:131]
v_add_f32 v227, v227, v158
v_add_f32 v227, v227, v159
v_mfma_f32_16x16x32_bf16 v[128:131], v[220:223], v[12:15], v[128:131]
v_max3_f32 v242, v224, v225, v226
v_mfma_f32_16x16x32_bf16 v[132:135], v[216:219], v[40:43], v[132:135]
v_max_f32 v242, v242, v227
v_mfma_f32_16x16x32_bf16 v[132:135], v[220:223], v[44:47], v[132:135]
v_cmp_lt_f32 vcc, s32, v242
v_mfma_f32_16x16x32_bf16 v[136:139], v[216:219], v[72:75], v[136:139]
v_mfma_f32_16x16x32_bf16 v[136:139], v[220:223], v[76:79], v[136:139]
v_mfma_f32_16x16x32_bf16 v[140:143], v[216:219], v[104:107], v[140:143]
ds_read_b128 v[216:219], v240 offset:12288
s_cbranch_vccnz L2_rare_site1
L2_ret1:
v_mfma_f32_16x16x32_bf16 v[140:143], v[220:223], v[108:111], v[140:143]
ds_read_b128 v[220:223], v240 offset:12800
s_waitcnt lgkmcnt(2)
v_mfma_f32_16x16x32_bf16 v[128:131], v[208:211], v[16:19], v[128:131]
v_cvt_pk_bf16_f32 v178, v144, v145
v_cvt_pk_bf16_f32 v179, v146, v147
v_mfma_f32_16x16x32_bf16 v[128:131], v[212:215], v[20:23], v[128:131]
v_cvt_pk_bf16_f32 v182, v148, v149
v_cvt_pk_bf16_f32 v183, v150, v151
v_mfma_f32_16x16x32_bf16 v[132:135], v[208:211], v[48:51], v[132:135]
v_cvt_pk_bf16_f32 v186, v152, v153
v_cvt_pk_bf16_f32 v187, v154, v155
v_mfma_f32_16x16x32_bf16 v[132:135], v[212:215], v[52:55], v[132:135]
v_cvt_pk_bf16_f32 v190, v156, v157
v_cvt_pk_bf16_f32 v191, v158, v159
v_mfma_f32_16x16x32_bf16 v[136:139], v[208:211], v[80:83], v[136:139]
v_mfma_f32_16x16x32_bf16 v[136:139], v[212:215], v[84:87], v[136:139]
s_sub_u32 s31, s31, 1
v_mfma_f32_16x16x32_bf16 v[140:143], v[208:211], v[112:115], v[140:143]
ds_read_b128 v[208:211], v240 offset:2048
v_mfma_f32_16x16x32_bf16 v[140:143], v[212:215], v[116:119], v[140:143]
ds_read_b128 v[212:215], v240 offset:2560
s_waitcnt lgkmcnt(2)
v_mfma_f32_16x16x32_bf16 v[128:131], v[216:219], v[24:27], v[128:131]
s_add_u32 s28, s28, s101
s_add_u32 s30, s30, 0x4000
v_mfma_f32_16x16x32_bf16 v[128:131], v[220:223], v[28:31], v[128:131]
s_and_b32 s30, s30, 0x1ffff
v_mfma_f32_16x16x32_bf16 v[132:135], v[216:219], v[56:59], v[132:135]
s_cmp_eq_u32 s31, 0
v_mfma_f32_16x16x32_bf16 v[132:135], v[220:223], v[60:63], v[132:135]
v_mfma_f32_16x16x32_bf16 v[136:139], v[216:219], v[88:91], v[136:139]
v_mfma_f32_16x16x32_bf16 v[136:139], v[220:223], v[92:95], v[136:139]
v_mfma_f32_16x16x32_bf16 v[140:143], v[216:219], v[120:123], v[140:143]
ds_read_b128 v[216:219], v240 offset:6144
v_mfma_f32_16x16x32_bf16 v[140:143], v[220:223], v[124:127], v[140:143]
ds_read_b128 v[220:223], v240 offset:6656
s_cbranch_scc1 L2_x1
L2_loop1:
s_waitcnt lgkmcnt(2)
v_mfma_f32_16x16x32_bf16 v[144:147], v[208:211], v[0:3], v[192:195]
v_mfma_f32_16x16x32_bf16 v[144:147], v[212:215], v[4:7], v[144:147]
v_mfma_f32_16x16x32_bf16 v[148:151], v[208:211], v[32:35], v[196:199]
v_mfma_f32_16x16x32_bf16 v[148:151], v[212:215], v[36:39], v[148:151]
v_mfma_f32_16x16x32_bf16 v[152:155], v[208:211], v[64:67], v[200:203]
v_exp_f32 v128, v128
v_mfma_f32_16x16x32_bf16 v[152:155], v[212:215], v[68:71], v[152:155]
v_exp_f32 v129, v129
v_mfma_f32_16x16x32_bf16 v[156:159], v[208:211], v[96:99], v[204:207]
ds_read_b128 v[208:211], v240 offset:10240
v_mfma_f32_16x16x32_bf16 v[156:159], v[212:215], v[100:103], v[156:159]
ds_read_b128 v[212:215], v240 offset:10752
s_waitcnt lgkmcnt(2)
v_mfma_f32_16x16x32_bf16 v[144:147], v[216:219], v[8:11], v[144:147]
v_exp_f32 v130, v130
v_mfma_f32_16x16x32_bf16 v[144:147], v[220:223], v[12:15], v[144:147]
v_add_f32 v224, v224, v128
v_mfma_f32_16x16x32_bf16 v[148:151], v[216:219], v[40:43], v[148:151]
v_exp_f32 v131, v131
v_mfma_f32_16x16x32_bf16 v[148:151], v[220:223], v[44:47], v[148:151]
v_add_f32 v224, v224, v129
v_add_f32 v224, v224, v130
v_mfma_f32_16x16x32_bf16 v[152:155], v[216:219], v[72:75], v[152:155]
v_add_f32 v224, v224, v131
v_mfma_f32_16x16x32_bf16 v[152:155], v[220:223], v[76:79], v[152:155]
v_exp_f32 v132, v132
v_mfma_f32_16x16x32_bf16 v[156:159], v[216:219], v[104:107], v[156:159]
ds_read_b128 v[216:219], v240 offset:14336
v_mfma_f32_16x16x32_bf16 v[156:159], v[220:223], v[108:111], v[156:159]
ds_read_b128 v[220:223], v240 offset:14848
s_waitcnt lgkmcnt(2)
v_mfma_f32_16x16x32_bf16 v[144:147], v[208:211], v[16:19], v[144:147]
v_exp_f32 v133, v133
v_mfma_f32_16x16x32_bf16 v[144:147], v[212:215], v[20:23], v[144:147]
v_exp_f32 v134, v134
v_mfma_f32_16x16x32_bf16 v[148:151], v[208:211], v[48:51], v[148:151]
v_add_f32 v225, v225, v132
v_mfma_f32_16x16x32_bf16 v[148:151], v[212:215], v[52:55], v[148:151]
v_exp_f32 v135, v135
v_mfma_f32_16x16x32_bf16 v[152:155], v[208:211], v[80:83], v[152:155]
v_add_f32 v225, v225, v133
v_add_f32 v225, v225, v134
v_mfma_f32_16x16x32_bf16 v[152:155], v[212:215], v[84:87], v[152:155]
v_add_f32 v225, v225, v135
v_mfma_f32_16x16x32_bf16 v[156:159], v[208:211], v[112:115], v[156:159]
ds_read_b64_tr_b16 v[208:209], v246 offset:8192
ds_read_b64_tr_b16 v[210:211], v246 offset:10240
v_mfma_f32_16x16x32_bf16 v[156:159], v[212:215], v[116:119], v[156:159]
ds_read_b64_tr_b16 v[212:213], v246 offset:24576
s_waitcnt lgkmcnt(3)
v_mfma_f32_16x16x32_bf16 v[144:147], v[216:219], v[24:27], v[144:147]
ds_read_b64_tr_b16 v[214:215], v246 offset:26624
v_mfma_f32_16x16x32_bf16 v[144:147], v[220:223], v[28:31], v[144:147]
v_exp_f32 v136, v136
v_mfma_f32_16x16x32_bf16 v[148:151], v[216:219], v[56:59], v[148:151]
v_exp_f32 v137, v137
v_mfma_f32_16x16x32_bf16 v[148:151], v[220:223], v[60:63], v[148:151]
v_exp_f32 v138, v138
v_mfma_f32_16x16x32_bf16 v[152:155], v[216:219], v[88:91], v[152:155]
v_add_f32 v226, v226, v136
v_mfma_f32_16x16x32_bf16 v[152:155], v[220:223], v[92:95], v[152:155]
v_exp_f32 v139, v139
v_mfma_f32_16x16x32_bf16 v[156:159], v[216:219], v[120:123], v[156:159]
ds_read_b64_tr_b16 v[216:217], v247 offset:8192
ds_read_b64_tr_b16 v[218:219], v247 offset:10240
v_mfma_f32_16x16x32_bf16 v[156:159], v[220:223], v[124:127], v[156:159]
ds_read_b64_tr_b16 v[220:221], v247 offset:24576
s_waitcnt lgkmcnt(3)
v_mfma_f32_16x16x32_bf16 a[128:131], v[160:163], v[208:211], a[128:131]
ds_read_b64_tr_b16 v[222:223], v247 offset:26624
v_add_f32 v226, v226, v137
v_mfma_f32_16x16x32_bf16 a[128:131], v[176:179], v[212:215], a[128:131]
v_add_f32 v226, v226, v138
v_add_f32 v226, v226, v139
v_mfma_f32_16x16x32_bf16 a[132:135], v[164:167], v[208:211], a[132:135]
v_exp_f32 v140, v140
v_mfma_f32_16x16x32_bf16 a[132:135], v[180:183], v[212:215], a[132:135]
v_exp_f32 v141, v141
v_mfma_f32_16x16x32_bf16 a[136:139], v[168:171], v[208:211], a[136:139]
v_exp_f32 v142, v142
v_mfma_f32_16x16x32_bf16 a[136:139], v[184:187], v[212:215], a[136:139]
v_add_f32 v227, v227, v140
v_mfma_f32_16x16x32_bf16 a[140:143], v[172:175], v[208:211], a[140:143]
ds_read_b64_tr_b16 v[208:209], v246 offset:8704
ds_read_b64_tr_b16 v[210:211], v246 offset:10752
v_mfma_f32_16x16x32_bf16 a[140:143], v[188:191], v[212:215], a[140:143]
ds_read_b64_tr_b16 v[212:213], v246 offset:25088
s_waitcnt lgkmcnt(3)
v_mfma_f32_16x16x32_bf16 a[144:147], v[160:163], v[216:219], a[144:147]
ds_read_b64_tr_b16 v[214:215], v246 offset:27136
v_mfma_f32_16x16x32_bf16 a[144:147], v[176:179], v[220:223], a[144:147]
v_exp_f32 v143, v143
v_mfma_f32_16x16x32_bf16 a[148:151], v[164:167], v[216:219], a[148:151]
v_add_f32 v227, v227, v141
v_add_f32 v227, v227, v142
v_mfma_f32_16x16x32_bf16 a[148:151], v[180:183], v[220:223], a[148:151]
v_add_f32 v227, v227, v143
v_max3_f32 v242, v224, v225, v226
v_mfma_f32_16x16x32_bf16 a[152:155], v[168:171], v[216:219], a[152:155]
v_max_f32 v242, v242, v227
v_mfma_f32_16x16x32_bf16 a[152:155], v[184:187], v[220:223], a[152:155]
v_cmp_lt_f32 vcc, s32, v242
v_mfma_f32_16x16x32_bf16 a[156:159], v[172:175], v[216:219], a[156:159]
ds_read_b64_tr_b16 v[216:217], v247 offset:8704
ds_read_b64_tr_b16 v[218:219], v247 offset:10752
v_mfma_f32_16x16x32_bf16 a[156:159], v[188:191], v[220:223], a[156:159]
ds_read_b64_tr_b16 v[220:221], v247 offset:25088
s_waitcnt lgkmcnt(3)
v_mfma_f32_16x16x32_bf16 a[160:163], v[160:163], v[208:211], a[160:163]
ds_read_b64_tr_b16 v[222:223], v247 offset:27136
s_cbranch_vccnz L2_rare_site2
L2_ret2:
v_mfma_f32_16x16x32_bf16 a[160:163], v[176:179], v[212:215], a[160:163]
v_exp_f32 v144, v144
v_mfma_f32_16x16x32_bf16 a[164:167], v[164:167], v[208:211], a[164:167]
v_exp_f32 v145, v145
v_mfma_f32_16x16x32_bf16 a[164:167], v[180:183], v[212:215], a[164:167]
v_exp_f32 v146, v146
v_mfma_f32_16x16x32_bf16 a[168:171], v[168:171], v[208:211], a[168:171]
s_mov_b32 m0, s30
v_add_f32 v224, v224, v144
v_mfma_f32_16x16x32_bf16 a[168:171], v[184:187], v[212:215], a[168:171]
buffer_load_dwordx4 v241, s[12:15], s28 offen offset:0 sc1 lds
v_mfma_f32_16x16x32_bf16 a[172:175], v[172:175], v[208:211], a[172:175]
ds_read_b64_tr_b16 v[208:209], v246 offset:12288
ds_read_b64_tr_b16 v[210:211], v246 offset:14336
v_mfma_f32_16x16x32_bf16 a[172:175], v[188:191], v[212:215], a[172:175]
ds_read_b64_tr_b16 v[212:213], v246 offset:28672
s_waitcnt lgkmcnt(3)
v_mfma_f32_16x16x32_bf16 a[176:179], v[160:163], v[216:219], a[176:179]
ds_read_b64_tr_b16 v[214:215], v246 offset:30720
v_mfma_f32_16x16x32_bf16 a[176:179], v[176:179], v[220:223], a[176:179]
buffer_load_dwordx4 v241, s[12:15], s28 offen offset:1024 sc1 lds
v_mfma_f32_16x16x32_bf16 a[180:183], v[164:167], v[216:219], a[180:183]
v_exp_f32 v147, v147
v_mfma_f32_16x16x32_bf16 a[180:183], v[180:183], v[220:223], a[180:183]
v_add_f32 v224, v224, v145
v_add_f32 v224, v224, v146
v_mfma_f32_16x16x32_bf16 a[184:187], v[168:171], v[216:219], a[184:187]
v_add_f32 v224, v224, v147
v_mfma_f32_16x16x32_bf16 a[184:187], v[184:187], v[220:223], a[184:187]
buffer_load_dwordx4 v241, s[12:15], s28 offen offset:2048 sc1 lds
v_mfma_f32_16x16x32_bf16 a[188:191], v[172:175], v[216:219], a[188:191]
ds_read_b64_tr_b16 v[216:217], v247 offset:12288
ds_read_b64_tr_b16 v[218:219], v247 offset:14336
v_mfma_f32_16x16x32_bf16 a[188:191], v[188:191], v[220:223], a[188:191]
ds_read_b64_tr_b16 v[220:221], v247 offset:28672
s_waitcnt lgkmcnt(3)
v_mfma_f32_16x16x32_bf16 a[192:195], v[160:163], v[208:211], a[192:195]
ds_read_b64_tr_b16 v[222:223], v247 offset:30720
v_mfma_f32_16x16x32_bf16 a[192:195], v[176:179], v[212:215], a[192:195]
buffer_load_dwordx4 v241, s[12:15], s28 offen offset:3072 sc1 lds
v_mfma_f32_16x16x32_bf16 a[196:199], v[164:167], v[208:211], a[196:199]
v_exp_f32 v148, v148
v_mfma_f32_16x16x32_bf16 a[196:199], v[180:183], v[212:215], a[196:199]
v_exp_f32 v149, v149
v_mfma_f32_16x16x32_bf16 a[200:203], v[168:171], v[208:211], a[200:203]
v_exp_f32 v150, v150
v_mfma_f32_16x16x32_bf16 a[200:203], v[184:187], v[212:215], a[200:203]
v_add_f32 v225, v225, v148
v_mfma_f32_16x16x32_bf16 a[204:207], v[172:175], v[208:211], a[204:207]
ds_read_b64_tr_b16 v[208:209], v246 offset:12800
ds_read_b64_tr_b16 v[210:211], v246 offset:14848
v_mfma_f32_16x16x32_bf16 a[204:207], v[188:191], v[212:215], a[204:207]
ds_read_b64_tr_b16 v[212:213], v246 offset:29184
s_waitcnt lgkmcnt(3)
v_mfma_f32_16x16x32_bf16 a[208:211], v[160:163], v[216:219], a[208:211]
ds_read_b64_tr_b16 v[214:215], v246 offset:31232
v_mfma_f32_16x16x32_bf16 a[208:211], v[176:179], v[220:223], a[208:211]
v_exp_f32 v151, v151
v_mfma_f32_16x16x32_bf16 a[212:215], v[164:167], v[216:219], a[212:215]
v_add_f32 v225, v225, v149
v_add_f32 v225, v225, v150
v_mfma_f32_16x16x32_bf16 a[212:215], v[180:183], v[220:223], a[212:215]
v_add_f32 v225, v225, v151
v_mfma_f32_16x16x32_bf16 a[216:219], v[168:171], v[216:219], a[216:219]
v_exp_f32 v152, v152
v_mfma_f32_16x16x32_bf16 a[216:219], v[184:187], v[220:223], a[216:219]
v_exp_f32 v153, v153
v_mfma_f32_16x16x32_bf16 a[220:223], v[172:175], v[216:219], a[220:223]
ds_read_b64_tr_b16 v[216:217], v247 offset:12800
ds_read_b64_tr_b16 v[218:219], v247 offset:14848
v_mfma_f32_16x16x32_bf16 a[220:223], v[188:191], v[220:223], a[220:223]
ds_read_b64_tr_b16 v[220:221], v247 offset:29184
s_waitcnt lgkmcnt(3)
v_mfma_f32_16x16x32_bf16 a[224:227], v[160:163], v[208:211], a[224:227]
ds_read_b64_tr_b16 v[222:223], v247 offset:31232
v_mfma_f32_16x16x32_bf16 a[224:227], v[176:179], v[212:215], a[224:227]
s_waitcnt vmcnt(4)
s_barrier
v_mfma_f32_16x16x32_bf16 a[228:231], v[164:167], v[208:211], a[228:231]
v_exp_f32 v154, v154
v_mfma_f32_16x16x32_bf16 a[228:231], v[180:183], v[212:215], a[228:231]
v_add_f32 v226, v226, v152
v_mfma_f32_16x16x32_bf16 a[232:235], v[168:171], v[208:211], a[232:235]
v_exp_f32 v155, v155
v_mfma_f32_16x16x32_bf16 a[232:235], v[184:187], v[212:215], a[232:235]
v_add_f32 v226, v226, v153
v_add_f32 v226, v226, v154
v_mfma_f32_16x16x32_bf16 a[236:239], v[172:175], v[208:211], a[236:239]
ds_read_b128 v[208:211], v240 offset:16384
v_add_f32 v226, v226, v155
v_mfma_f32_16x16x32_bf16 a[236:239], v[188:191], v[212:215], a[236:239]
ds_read_b128 v[212:215], v240 offset:16896
s_waitcnt lgkmcnt(2)
v_mfma_f32_16x16x32_bf16 a[240:243], v[160:163], v[216:219], a[240:243]
v_exp_f32 v156, v156
v_mfma_f32_16x16x32_bf16 a[240:243], v[176:179], v[220:223], a[240:243]
v_cvt_pk_bf16_f32 v160, v128, v129
v_cvt_pk_bf16_f32 v161, v130, v131
v_mfma_f32_16x16x32_bf16 a[244:247], v[164:167], v[216:219], a[244:247]
v_exp_f32 v157, v157
v_mfma_f32_16x16x32_bf16 a[244:247], v[180:183], v[220:223], a[244:247]
v_cvt_pk_bf16_f32 v164, v132, v133
v_cvt_pk_bf16_f32 v165, v134, v135
v_mfma_f32_16x16x32_bf16 a[248:251], v[168:171], v[216:219], a[248:251]
v_exp_f32 v158, v158
v_mfma_f32_16x16x32_bf16 a[248:251], v[184:187], v[220:223], a[248:251]
v_cvt_pk_bf16_f32 v168, v136, v137
v_cvt_pk_bf16_f32 v169, v138, v139
v_mfma_f32_16x16x32_bf16 a[252:255], v[172:175], v[216:219], a[252:255]
ds_read_b128 v[216:219], v240 offset:20480
v_add_f32 v227, v227, v156
v_mfma_f32_16x16x32_bf16 a[252:255], v[188:191], v[220:223], a[252:255]
ds_read_b128 v[220:223], v240 offset:20992
s_waitcnt lgkmcnt(2)
v_mfma_f32_16x16x32_bf16 v[128:131], v[208:211], v[0:3], v[192:195]
v_exp_f32 v159, v159
v_mfma_f32_16x16x32_bf16 v[128:131], v[212:215], v[4:7], v[128:131]
v_cvt_pk_bf16_f32 v172, v140, v141
v_cvt_pk_bf16_f32 v173, v142, v143
v_mfma_f32_16x16x32_bf16 v[132:135], v[208:211], v[32:35], v[196:199]
v_add_f32 v227, v227, v157
v_add_f32 v227, v227, v158
v_mfma_f32_16x16x32_bf16 v[132:135], v[212:215], v[36:39], v[132:135]
v_add_f32 v227, v227, v159
v_max3_f32 v242, v224, v225, v226
v_mfma_f32_16x16x32_bf16 v[136:139], v[208:211], v[64:67], v[200:203]
v_max_f32 v242, v242, v227
v_mfma_f32_16x16x32_bf16 v[136:139], v[212:215], v[68:71], v[136:139]
v_cmp_lt_f32 vcc, s32, v242
v_mfma_f32_16x16x32_bf16 v[140:143], v[208:211], v[96:99], v[204:207]
ds_read_b128 v[208:211], v240 offset:24576
v_mfma_f32_16x16x32_bf16 v[140:143], v[212:215], v[100:103], v[140:143]
ds_read_b128 v[212:215], v240 offset:25088
s_waitcnt lgkmcnt(2)
v_mfma_f32_16x16x32_bf16 v[128:131], v[216:219], v[8:11], v[128:131]
v_mov_b32 v244, v246
v_mov_b32 v245, v247
v_mfma_f32_16x16x32_bf16 v[128:131], v[220:223], v[12:15], v[128:131]
v_add_u32 v246, 0x8000, v246
s_cbranch_vccnz L2_rare_site3
L2_ret3:
v_mfma_f32_16x16x32_bf16 v[132:135], v[216:219], v[40:43], v[132:135]
v_and_b32 v246, 0x1ffff, v246
v_cvt_pk_bf16_f32 v162, v144, v145
v_mfma_f32_16x16x32_bf16 v[132:135], v[220:223], v[44:47], v[132:135]
v_cvt_pk_bf16_f32 v163, v146, v147
v_cvt_pk_bf16_f32 v166, v148, v149
v_mfma_f32_16x16x32_bf16 v[136:139], v[216:219], v[72:75], v[136:139]
v_xor_b32 v247, 32, v246
v_cvt_pk_bf16_f32 v167, v150, v151
v_mfma_f32_16x16x32_bf16 v[136:139], v[220:223], v[76:79], v[136:139]
v_cvt_pk_bf16_f32 v170, v152, v153
v_cvt_pk_bf16_f32 v171, v154, v155
v_mfma_f32_16x16x32_bf16 v[140:143], v[216:219], v[104:107], v[140:143]
ds_read_b128 v[216:219], v240 offset:28672
v_cvt_pk_bf16_f32 v174, v156, v157
v_mfma_f32_16x16x32_bf16 v[140:143], v[220:223], v[108:111], v[140:143]
ds_read_b128 v[220:223], v240 offset:29184
s_waitcnt lgkmcnt(2)
v_mfma_f32_16x16x32_bf16 v[128:131], v[208:211], v[16:19], v[128:131]
v_cvt_pk_bf16_f32 v175, v158, v159
v_mfma_f32_16x16x32_bf16 v[128:131], v[212:215], v[20:23], v[128:131]
v_mfma_f32_16x16x32_bf16 v[132:135], v[208:211], v[48:51], v[132:135]
v_mfma_f32_16x16x32_bf16 v[132:135], v[212:215], v[52:55], v[132:135]
v_mfma_f32_16x16x32_bf16 v[136:139], v[208:211], v[80:83], v[136:139]
v_mfma_f32_16x16x32_bf16 v[136:139], v[212:215], v[84:87], v[136:139]
s_sub_u32 s31, s31, 1
v_mfma_f32_16x16x32_bf16 v[140:143], v[208:211], v[112:115], v[140:143]
ds_read_b128 v[208:211], v240 offset:18432
v_mfma_f32_16x16x32_bf16 v[140:143], v[212:215], v[116:119], v[140:143]
ds_read_b128 v[212:215], v240 offset:18944
s_waitcnt lgkmcnt(2)
v_mfma_f32_16x16x32_bf16 v[128:131], v[216:219], v[24:27], v[128:131]
s_add_u32 s28, s28, s101
s_add_u32 s30, s30, 0x4000
v_mfma_f32_16x16x32_bf16 v[128:131], v[220:223], v[28:31], v[128:131]
s_and_b32 s30, s30, 0x1ffff
v_mfma_f32_16x16x32_bf16 v[132:135], v[216:219], v[56:59], v[132:135]
s_cmp_eq_u32 s31, 0
v_mfma_f32_16x16x32_bf16 v[132:135], v[220:223], v[60:63], v[132:135]
v_mfma_f32_16x16x32_bf16 v[136:139], v[216:219], v[88:91], v[136:139]
v_mfma_f32_16x16x32_bf16 v[136:139], v[220:223], v[92:95], v[136:139]
v_mfma_f32_16x16x32_bf16 v[140:143], v[216:219], v[120:123], v[140:143]
ds_read_b128 v[216:219], v240 offset:22528
v_mfma_f32_16x16x32_bf16 v[140:143], v[220:223], v[124:127], v[140:143]
ds_read_b128 v[220:223], v240 offset:23040
s_cbranch_scc0 L2_loop
s_cmp_eq_u32 s100, 0
s_cbranch_scc1 L2_tail_0
s_mov_b32 s3, 0
s_branch L2_ev
L2_x1:
s_cmp_eq_u32 s100, 0
s_cbranch_scc1 L2_tail_1
s_mov_b32 s3, 1
L2_ev:
s_sub_u32 s100, s100, 1
s_mov_b32 s31, 1
v_mov_b32 v230, 0x20000
s_cmp_eq_u32 s100, 0
s_cbranch_scc1 L2_ev3
s_cmp_lg_u32 s34, 0
s_cbranch_scc1 L2_evr
s_cmp_eq_u32 s100, 1
s_cbranch_scc1 L2_ev2
v_mov_b32 v228, s98
v_mov_b32 v229, s99
s_mov_b64 exec, 1
buffer_atomic_swap_x2 v[228:229], off, s[16:19], s49 sc0 sc1
s_mov_b64 exec, -1
s_branch L2_evr
L2_ev2:
s_mov_b64 exec, 1
ds_write_b64 v230, v[228:229]
s_mov_b64 exec, -1
s_branch L2_evr
L2_ev3:
ds_read_b64 v[228:229], v230
s_waitcnt lgkmcnt(0)
v_cmp_eq_u64 vcc, s[98:99], v[228:229]
s_nop 1
s_cmp_eq_u64 vcc, 0
s_cselect_b32 s31, s39, s35
L2_evr:
s_cmp_eq_u32 s3, 0
s_cbranch_scc1 L2_loop
s_branch L2_loop1
L2_tail_0:
s_waitcnt lgkmcnt(2)
v_add_u32 v231, s50, v243
v_mfma_f32_16x16x32_bf16 v[144:147], v[208:211], v[0:3], v[192:195]
s_mov_b32 m0, s30
ds_write_b128 v231, v[176:179] offset:0
v_mfma_f32_16x16x32_bf16 v[144:147], v[212:215], v[4:7], v[144:147]
buffer_load_dwordx4 v241, s[12:15], s28 offen offset:0 sc1 lds
ds_write_b128 v231, v[180:183] offset:1024
v_mfma_f32_16x16x32_bf16 v[148:151], v[208:211], v[32:35], v[196:199]
buffer_load_dwordx4 v241, s[12:15], s28 offen offset:1024 sc1 lds
ds_write_b128 v231, v[184:187] offset:2048
v_mfma_f32_16x16x32_bf16 v[148:151], v[212:215], v[36:39], v[148:151]
buffer_load_dwordx4 v241, s[12:15], s28 offen offset:2048 sc1 lds
ds_write_b128 v231, v[188:191] offset:3072
v_mfma_f32_16x16x32_bf16 v[152:155], v[208:211], v[64:67], v[200:203]
buffer_load_dwordx4 v241, s[12:15], s28 offen offset:3072 sc1 lds
v_add_u32 v230, 0x8000, v240
v_and_b32 v230, 0x1ffff, v230
v_mfma_f32_16x16x32_bf16 v[152:155], v[212:215], v[68:71], v[152:155]
v_exp_f32 v232, v128
v_mfma_f32_16x16x32_bf16 v[156:159], v[208:211], v[96:99], v[204:207]
ds_read_b128 v[208:211], v240 offset:26624
v_exp_f32 v233, v129
v_mfma_f32_16x16x32_bf16 v[156:159], v[212:215], v[100:103], v[156:159]
ds_read_b128 v[212:215], v240 offset:27136
s_waitcnt lgkmcnt(2)
s_and_b32 s30, s30, 0x1c000
v_mfma_f32_16x16x32_bf16 v[144:147], v[216:219], v[8:11], v[144:147]
v_exp_f32 v234, v130
v_add_f32 v224, v224, v232
v_mfma_f32_16x16x32_bf16 v[144:147], v[220:223], v[12:15], v[144:147]
v_cvt_pk_bf16_f32 v176, v232, v233
v_exp_f32 v235, v131
v_mfma_f32_16x16x32_bf16 v[148:151], v[216:219], v[40:43], v[148:151]
v_add_f32 v224, v224, v233
v_add_f32 v224, v224, v234
v_add_f32 v224, v224, v235
v_mfma_f32_16x16x32_bf16 v[148:151], v[220:223], v[44:47], v[148:151]
v_cvt_pk_bf16_f32 v177, v234, v235
v_exp_f32 v236, v132
v_mfma_f32_16x16x32_bf16 v[152:155], v[216:219], v[72:75], v[152:155]
v_exp_f32 v237, v133
s_add_u32 s28, s30, 0xc000
v_mfma_f32_16x16x32_bf16 v[152:155], v[220:223], v[76:79], v[152:155]
v_exp_f32 v238, v134
v_add_f32 v225, v225, v236
v_mfma_f32_16x16x32_bf16 v[156:159], v[216:219], v[104:107], v[156:159]
ds_read_b128 v[216:219], v240 offset:30720
v_cvt_pk_bf16_f32 v180, v236, v237
s_and_b32 s28, s28, 0x1ffff
v_mfma_f32_16x16x32_bf16 v[156:159], v[220:223], v[108:111], v[156:159]
ds_read_b128 v[220:223], v240 offset:31232
s_waitcnt lgkmcnt(2)
s_add_u32 s30, s30, 0x4000
v_mfma_f32_16x16x32_bf16 v[144:147], v[208:211], v[16:19], v[144:147]
v_exp_f32 v239, v135
v_add_f32 v225, v225, v237
v_mfma_f32_16x16x32_bf16 v[144:147], v[212:215], v[20:23], v[144:147]
s_waitcnt vmcnt(4)
s_barrier
v_add_f32 v225, v225, v238
v_mfma_f32_16x16x32_bf16 v[148:151], v[208:211], v[48:51], v[148:151]
v_add_f32 v225, v225, v239
v_cvt_pk_bf16_f32 v181, v238, v239
s_and_b32 s30, s30, 0x1ffff
v_mfma_f32_16x16x32_bf16 v[148:151], v[212:215], v[52:55], v[148:151]
v_exp_f32 v232, v136
s_mul_i32 s31, s34, 6144
v_mfma_f32_16x16x32_bf16 v[152:155], v[208:211], v[80:83], v[152:155]
v_exp_f32 v233, v137
s_add_u32 s31, s31, s30
v_mfma_f32_16x16x32_bf16 v[152:155], v[212:215], v[84:87], v[152:155]
v_exp_f32 v234, v138
v_add_f32 v226, v226, v232
v_mfma_f32_16x16x32_bf16 v[156:159], v[208:211], v[112:115], v[156:159]
ds_read_b128 v[208:211], v230 offset:0
v_cvt_pk_bf16_f32 v184, v232, v233
s_lshl_b32 s3, s34, 10
v_mfma_f32_16x16x32_bf16 v[156:159], v[212:215], v[116:119], v[156:159]
ds_read_b128 v[212:215], v230 offset:512
s_waitcnt lgkmcnt(2)
s_add_u32 s28, s28, s3
v_mfma_f32_16x16x32_bf16 v[144:147], v[216:219], v[24:27], v[144:147]
v_exp_f32 v235, v139
v_add_f32 v226, v226, v233
v_mfma_f32_16x16x32_bf16 v[144:147], v[220:223], v[28:31], v[144:147]
v_add_f32 v226, v226, v234
v_add_f32 v226, v226, v235
v_cvt_pk_bf16_f32 v185, v234, v235
v_mfma_f32_16x16x32_bf16 v[148:151], v[216:219], v[56:59], v[148:151]
v_exp_f32 v236, v140
s_add_u32 s3, s3, 24576
v_mfma_f32_16x16x32_bf16 v[148:151], v[220:223], v[60:63], v[148:151]
v_exp_f32 v237, v141
s_add_u32 s30, s30, s3
v_mfma_f32_16x16x32_bf16 v[152:155], v[216:219], v[88:91], v[152:155]
v_exp_f32 v238, v142
v_add_f32 v227, v227, v236
v_mfma_f32_16x16x32_bf16 v[152:155], v[220:223], v[92:95], v[152:155]
v_cvt_pk_bf16_f32 v188, v236, v237
v_exp_f32 v239, v143
v_mfma_f32_16x16x32_bf16 v[156:159], v[216:219], v[120:123], v[156:159]
ds_read_b128 v[216:219], v230 offset:4096
v_add_f32 v227, v227, v237
v_add_f32 v227, v227, v238
v_mfma_f32_16x16x32_bf16 v[156:159], v[220:223], v[124:127], v[156:159]
ds_read_b128 v[220:223], v230 offset:4608
s_waitcnt lgkmcnt(2)
v_add_f32 v227, v227, v239
v_cvt_pk_bf16_f32 v189, v238, v239
v_max3_f32 v242, v224, v225, v226
v_max_f32 v242, v242, v227
v_cmp_lt_f32 vcc, s32, v242
s_cbranch_vccnz L2_rare_site6
L2_ret6:
v_mfma_f32_16x16x32_bf16 v[128:131], v[208:211], v[0:3], v[192:195]
v_lshrrev_b32 v241, 4, v243
v_and_b32 v241, 0x30, v241
v_xor_b32 v241, v241, v243
v_and_b32 v228, 0x380, v243
v_mad_u32_u24 v241, v228, 3, v241
v_mfma_f32_16x16x32_bf16 v[128:131], v[212:215], v[4:7], v[128:131]
v_exp_f32 v232, v144
v_mfma_f32_16x16x32_bf16 v[132:135], v[208:211], v[32:35], v[196:199]
v_exp_f32 v233, v145
v_mfma_f32_16x16x32_bf16 v[132:135], v[212:215], v[36:39], v[132:135]
v_exp_f32 v234, v146
v_add_f32 v224, v224, v232
v_mfma_f32_16x16x32_bf16 v[136:139], v[208:211], v[64:67], v[200:203]
v_cvt_pk_bf16_f32 v178, v232, v233
v_exp_f32 v235, v147
v_mfma_f32_16x16x32_bf16 v[136:139], v[212:215], v[68:71], v[136:139]
v_add_f32 v224, v224, v233
v_add_f32 v224, v224, v234
v_add_f32 v224, v224, v235
v_mfma_f32_16x16x32_bf16 v[140:143], v[208:211], v[96:99], v[204:207]
ds_read_b128 v[208:211], v230 offset:8192
v_cvt_pk_bf16_f32 v179, v234, v235
v_mfma_f32_16x16x32_bf16 v[140:143], v[212:215], v[100:103], v[140:143]
ds_read_b128 v[212:215], v230 offset:8704
s_waitcnt lgkmcnt(2)
v_mfma_f32_16x16x32_bf16 v[128:131], v[216:219], v[8:11], v[128:131]
ds_write_b128 v231, v[160:163] offset:4096
v_exp_f32 v236, v148
v_mfma_f32_16x16x32_bf16 v[128:131], v[220:223], v[12:15], v[128:131]
ds_write_b128 v231, v[164:167] offset:5120
v_exp_f32 v237, v149
v_mfma_f32_16x16x32_bf16 v[132:135], v[216:219], v[40:43], v[132:135]
ds_write_b128 v231, v[168:171] offset:6144
v_exp_f32 v238, v150
v_mfma_f32_16x16x32_bf16 v[132:135], v[220:223], v[44:47], v[132:135]
ds_write_b128 v231, v[172:175] offset:7168
v_add_f32 v225, v225, v236
v_cvt_pk_bf16_f32 v182, v236, v237
v_mfma_f32_16x16x32_bf16 v[136:139], v[216:219], v[72:75], v[136:139]
v_exp_f32 v239, v151
v_add_f32 v225, v225, v237
v_mfma_f32_16x16x32_bf16 v[136:139], v[220:223], v[76:79], v[136:139]
v_add_f32 v225, v225, v238
v_add_f32 v225, v225, v239
v_cvt_pk_bf16_f32 v183, v238, v239
v_mfma_f32_16x16x32_bf16 v[140:143], v[216:219], v[104:107], v[140:143]
ds_read_b128 v[216:219], v230 offset:12288
v_exp_f32 v232, v152
v_mfma_f32_16x16x32_bf16 v[140:143], v[220:223], v[108:111], v[140:143]
ds_read_b128 v[220:223], v230 offset:12800
s_waitcnt lgkmcnt(2)
v_mfma_f32_16x16x32_bf16 v[128:131], v[208:211], v[16:19], v[128:131]
v_exp_f32 v233, v153
v_mfma_f32_16x16x32_bf16 v[128:131], v[212:215], v[20:23], v[128:131]
v_exp_f32 v234, v154
v_add_f32 v226, v226, v232
v_mfma_f32_16x16x32_bf16 v[132:135], v[208:211], v[48:51], v[132:135]
v_cvt_pk_bf16_f32 v186, v232, v233
v_exp_f32 v235, v155
v_mfma_f32_16x16x32_bf16 v[132:135], v[212:215], v[52:55], v[132:135]
v_add_f32 v226, v226, v233
v_add_f32 v226, v226, v234
v_add_f32 v226, v226, v235
v_mfma_f32_16x16x32_bf16 v[136:139], v[208:211], v[80:83], v[136:139]
v_cvt_pk_bf16_f32 v187, v234, v235
v_exp_f32 v236, v156
v_mfma_f32_16x16x32_bf16 v[136:139], v[212:215], v[84:87], v[136:139]
v_exp_f32 v237, v157
v_mfma_f32_16x16x32_bf16 v[140:143], v[208:211], v[112:115], v[140:143]
ds_read_b128 v[208:211], v230 offset:2048
v_exp_f32 v238, v158
v_mfma_f32_16x16x32_bf16 v[140:143], v[212:215], v[116:119], v[140:143]
ds_read_b128 v[212:215], v230 offset:2560
s_waitcnt lgkmcnt(2)
v_add_f32 v227, v227, v236
v_mfma_f32_16x16x32_bf16 v[128:131], v[216:219], v[24:27], v[128:131]
v_cvt_pk_bf16_f32 v190, v236, v237
v_exp_f32 v239, v159
v_mfma_f32_16x16x32_bf16 v[128:131], v[220:223], v[28:31], v[128:131]
v_add_f32 v227, v227, v237
v_add_f32 v227, v227, v238
v_add_f32 v227, v227, v239
v_mfma_f32_16x16x32_bf16 v[132:135], v[216:219], v[56:59], v[132:135]
v_cvt_pk_bf16_f32 v191, v238, v239
v_max3_f32 v242, v224, v225, v226
v_max_f32 v242, v242, v227
v_mfma_f32_16x16x32_bf16 v[132:135], v[220:223], v[60:63], v[132:135]
v_cmp_lt_f32 vcc, s32, v242
s_cbranch_vccnz L2_rare_site7
L2_ret7:
v_mfma_f32_16x16x32_bf16 v[136:139], v[216:219], v[88:91], v[136:139]
s_add_u32 m0, s31, 0
v_mfma_f32_16x16x32_bf16 v[136:139], v[220:223], v[92:95], v[136:139]
buffer_load_dwordx4 v241, s[8:11], s6 offen lds
s_add_u32 m0, s31, 2048
v_mfma_f32_16x16x32_bf16 v[140:143], v[216:219], v[120:123], v[140:143]
ds_read_b128 v[216:219], v230 offset:6144
buffer_load_dwordx4 v241, s[8:11], s7 offen lds
s_add_u32 m0, s31, 4096
v_mfma_f32_16x16x32_bf16 v[140:143], v[220:223], v[124:127], v[140:143]
ds_read_b128 v[220:223], v230 offset:6656
s_waitcnt lgkmcnt(2)
v_mfma_f32_16x16x32_bf16 v[144:147], v[208:211], v[0:3], v[192:195]
buffer_load_dwordx4 v241, s[8:11], s29 offen lds
s_add_u32 m0, s31, 1024
v_xor_b32 v241, 0x1040, v241
v_mfma_f32_16x16x32_bf16 v[144:147], v[212:215], v[4:7], v[144:147]
v_exp_f32 v232, v128
v_mfma_f32_16x16x32_bf16 v[148:151], v[208:211], v[32:35], v[196:199]
v_exp_f32 v233, v129
v_mfma_f32_16x16x32_bf16 v[148:151], v[212:215], v[36:39], v[148:151]
v_exp_f32 v234, v130
v_add_f32 v224, v224, v232
v_mfma_f32_16x16x32_bf16 v[152:155], v[208:211], v[64:67], v[200:203]
v_cvt_pk_bf16_f32 v160, v232, v233
v_exp_f32 v235, v131
v_mfma_f32_16x16x32_bf16 v[152:155], v[212:215], v[68:71], v[152:155]
v_add_f32 v224, v224, v233
v_add_f32 v224, v224, v234
v_add_f32 v224, v224, v235
v_mfma_f32_16x16x32_bf16 v[156:159], v[208:211], v[96:99], v[204:207]
ds_read_b128 v[208:211], v230 offset:10240
v_cvt_pk_bf16_f32 v161, v234, v235
v_mfma_f32_16x16x32_bf16 v[156:159], v[212:215], v[100:103], v[156:159]
ds_read_b128 v[212:215], v230 offset:10752
s_waitcnt lgkmcnt(2)
v_mfma_f32_16x16x32_bf16 v[144:147], v[216:219], v[8:11], v[144:147]
v_exp_f32 v236, v132
v_mfma_f32_16x16x32_bf16 v[144:147], v[220:223], v[12:15], v[144:147]
v_exp_f32 v237, v133
v_mfma_f32_16x16x32_bf16 v[148:151], v[216:219], v[40:43], v[148:151]
v_exp_f32 v238, v134
v_add_f32 v225, v225, v236
v_mfma_f32_16x16x32_bf16 v[148:151], v[220:223], v[44:47], v[148:151]
v_cvt_pk_bf16_f32 v164, v236, v237
v_exp_f32 v239, v135
v_mfma_f32_16x16x32_bf16 v[152:155], v[216:219], v[72:75], v[152:155]
v_add_f32 v225, v225, v237
v_add_f32 v225, v225, v238
v_add_f32 v225, v225, v239
v_mfma_f32_16x16x32_bf16 v[152:155], v[220:223], v[76:79], v[152:155]
v_cvt_pk_bf16_f32 v165, v238, v239
v_exp_f32 v232, v136
v_mfma_f32_16x16x32_bf16 v[156:159], v[216:219], v[104:107], v[156:159]
ds_read_b128 v[216:219], v230 offset:14336
v_exp_f32 v233, v137
v_mfma_f32_16x16x32_bf16 v[156:159], v[220:223], v[108:111], v[156:159]
ds_read_b128 v[220:223], v230 offset:14848
s_waitcnt lgkmcnt(2)
v_mfma_f32_16x16x32_bf16 v[144:147], v[208:211], v[16:19], v[144:147]
v_exp_f32 v234, v138
v_add_f32 v226, v226, v232
v_mfma_f32_16x16x32_bf16 v[144:147], v[212:215], v[20:23], v[144:147]
s_waitcnt vmcnt(3)
s_barrier
v_cvt_pk_bf16_f32 v168, v232, v233
v_mfma_f32_16x16x32_bf16 v[148:151], v[208:211], v[48:51], v[148:151]
v_exp_f32 v235, v139
v_add_f32 v226, v226, v233
v_mfma_f32_16x16x32_bf16 v[148:151], v[212:215], v[52:55], v[148:151]
v_add_f32 v226, v226, v234
v_add_f32 v226, v226, v235
v_cvt_pk_bf16_f32 v169, v234, v235
v_mfma_f32_16x16x32_bf16 v[152:155], v[208:211], v[80:83], v[152:155]
v_exp_f32 v236, v140
v_mfma_f32_16x16x32_bf16 v[152:155], v[212:215], v[84:87], v[152:155]
v_exp_f32 v237, v141
v_mfma_f32_16x16x32_bf16 v[156:159], v[208:211], v[112:115], v[156:159]
ds_read_b128 v[208:211], v230 offset:16384
v_exp_f32 v238, v142
v_mfma_f32_16x16x32_bf16 v[156:159], v[212:215], v[116:119], v[156:159]
ds_read_b128 v[212:215], v230 offset:16896
s_waitcnt lgkmcnt(2)
v_add_f32 v227, v227, v236
v_mfma_f32_16x16x32_bf16 v[144:147], v[216:219], v[24:27], v[144:147]
v_cvt_pk_bf16_f32 v172, v236, v237
v_exp_f32 v239, v143
v_mfma_f32_16x16x32_bf16 v[144:147], v[220:223], v[28:31], v[144:147]
v_add_f32 v227, v227, v237
v_add_f32 v227, v227, v238
v_add_f32 v227, v227, v239
v_mfma_f32_16x16x32_bf16 v[148:151], v[216:219], v[56:59], v[148:151]
v_cvt_pk_bf16_f32 v173, v238, v239
v_max3_f32 v242, v224, v225, v226
v_max_f32 v242, v242, v227
v_mfma_f32_16x16x32_bf16 v[148:151], v[220:223], v[60:63], v[148:151]
v_cmp_lt_f32 vcc, s32, v242
s_cbranch_vccnz L2_rare_site8
L2_ret8:
v_mfma_f32_16x16x32_bf16 v[152:155], v[216:219], v[88:91], v[152:155]
buffer_load_dwordx4 v241, s[8:11], s6 offen lds
s_add_u32 m0, s31, 3072
v_mfma_f32_16x16x32_bf16 v[152:155], v[220:223], v[92:95], v[152:155]
buffer_load_dwordx4 v241, s[8:11], s7 offen lds
s_add_u32 m0, s31, 5120
v_mfma_f32_16x16x32_bf16 v[156:159], v[216:219], v[120:123], v[156:159]
ds_read_b128 v[216:219], v230 offset:20480
buffer_load_dwordx4 v241, s[8:11], s29 offen lds
v_mfma_f32_16x16x32_bf16 v[156:159], v[220:223], v[124:127], v[156:159]
ds_read_b128 v[220:223], v230 offset:20992
s_waitcnt lgkmcnt(2)
v_mfma_f32_16x16x32_bf16 v[128:131], v[208:211], v[0:3], v[192:195]
v_mfma_f32_16x16x32_bf16 v[128:131], v[212:215], v[4:7], v[128:131]
v_exp_f32 v232, v144
v_mfma_f32_16x16x32_bf16 v[132:135], v[208:211], v[32:35], v[196:199]
v_exp_f32 v233, v145
v_mfma_f32_16x16x32_bf16 v[132:135], v[212:215], v[36:39], v[132:135]
v_exp_f32 v234, v146
v_add_f32 v224, v224, v232
v_mfma_f32_16x16x32_bf16 v[136:139], v[208:211], v[64:67], v[200:203]
v_cvt_pk_bf16_f32 v162, v232, v233
v_exp_f32 v235, v147
v_mfma_f32_16x16x32_bf16 v[136:139], v[212:215], v[68:71], v[136:139]
v_add_f32 v224, v224, v233
v_add_f32 v224, v224, v234
v_add_f32 v224, v224, v235
v_mfma_f32_16x16x32_bf16 v[140:143], v[208:211], v[96:99], v[204:207]
ds_read_b128 v[208:211], v230 offset:24576
v_cvt_pk_bf16_f32 v163, v234, v235
v_lshlrev_b32 v241, 3, v243
v_mfma_f32_16x16x32_bf16 v[140:143], v[212:215], v[100:103], v[140:143]
ds_read_b128 v[212:215], v230 offset:25088
s_waitcnt lgkmcnt(2)
s_mov_b32 s3, 0x7c28000
v_mfma_f32_16x16x32_bf16 v[128:131], v[216:219], v[8:11], v[128:131]
v_exp_f32 v236, v148
buffer_load_dwordx2 v[240:241], v241, s[16:19], s3 offen sc1
v_mfma_f32_16x16x32_bf16 v[128:131], v[220:223], v[12:15], v[128:131]
v_exp_f32 v237, v149
v_mfma_f32_16x16x32_bf16 v[132:135], v[216:219], v[40:43], v[132:135]
v_exp_f32 v238, v150
v_add_f32 v225, v225, v236
v_mfma_f32_16x16x32_bf16 v[132:135], v[220:223], v[44:47], v[132:135]
v_cvt_pk_bf16_f32 v166, v236, v237
v_exp_f32 v239, v151
v_mfma_f32_16x16x32_bf16 v[136:139], v[216:219], v[72:75], v[136:139]
v_add_f32 v225, v225, v237
v_add_f32 v225, v225, v238
v_add_f32 v225, v225, v239
v_mfma_f32_16x16x32_bf16 v[136:139], v[220:223], v[76:79], v[136:139]
v_cvt_pk_bf16_f32 v167, v238, v239
v_exp_f32 v232, v152
v_mfma_f32_16x16x32_bf16 v[140:143], v[216:219], v[104:107], v[140:143]
ds_read_b128 v[216:219], v230 offset:28672
v_exp_f32 v233, v153
v_mfma_f32_16x16x32_bf16 v[140:143], v[220:223], v[108:111], v[140:143]
ds_read_b128 v[220:223], v230 offset:29184
s_waitcnt lgkmcnt(2)
v_mfma_f32_16x16x32_bf16 v[128:131], v[208:211], v[16:19], v[128:131]
v_exp_f32 v234, v154
v_add_f32 v226, v226, v232
v_mfma_f32_16x16x32_bf16 v[128:131], v[212:215], v[20:23], v[128:131]
v_cvt_pk_bf16_f32 v170, v232, v233
v_exp_f32 v235, v155
v_mfma_f32_16x16x32_bf16 v[132:135], v[208:211], v[48:51], v[132:135]
v_add_f32 v226, v226, v233
v_add_f32 v226, v226, v234
v_add_f32 v226, v226, v235
v_mfma_f32_16x16x32_bf16 v[132:135], v[212:215], v[52:55], v[132:135]
v_cvt_pk_bf16_f32 v171, v234, v235
v_exp_f32 v236, v156
v_mfma_f32_16x16x32_bf16 v[136:139], v[208:211], v[80:83], v[136:139]
v_exp_f32 v237, v157
v_mfma_f32_16x16x32_bf16 v[136:139], v[212:215], v[84:87], v[136:139]
v_exp_f32 v238, v158
v_add_f32 v227, v227, v236
v_mfma_f32_16x16x32_bf16 v[140:143], v[208:211], v[112:115], v[140:143]
ds_read_b128 v[208:211], v230 offset:18432
v_cvt_pk_bf16_f32 v174, v236, v237
v_mfma_f32_16x16x32_bf16 v[140:143], v[212:215], v[116:119], v[140:143]
ds_read_b128 v[212:215], v230 offset:18944
s_waitcnt lgkmcnt(2)
v_mfma_f32_16x16x32_bf16 v[128:131], v[216:219], v[24:27], v[128:131]
v_exp_f32 v239, v159
v_add_f32 v227, v227, v237
v_mfma_f32_16x16x32_bf16 v[128:131], v[220:223], v[28:31], v[128:131]
v_add_f32 v227, v227, v238
v_add_f32 v227, v227, v239
v_cvt_pk_bf16_f32 v175, v238, v239
v_mfma_f32_16x16x32_bf16 v[132:135], v[216:219], v[56:59], v[132:135]
v_max3_f32 v242, v224, v225, v226
v_max_f32 v242, v242, v227
v_cmp_lt_f32 vcc, s32, v242
s_cbranch_vccnz L2_rare_site9
L2_ret9:
v_mfma_f32_16x16x32_bf16 v[132:135], v[220:223], v[60:63], v[132:135]
v_mfma_f32_16x16x32_bf16 v[136:139], v[216:219], v[88:91], v[136:139]
v_mfma_f32_16x16x32_bf16 v[136:139], v[220:223], v[92:95], v[136:139]
v_mfma_f32_16x16x32_bf16 v[140:143], v[216:219], v[120:123], v[140:143]
ds_read_b128 v[216:219], v230 offset:22528
v_mfma_f32_16x16x32_bf16 v[140:143], v[220:223], v[124:127], v[140:143]
ds_read_b128 v[220:223], v230 offset:23040
s_waitcnt lgkmcnt(2)
v_mfma_f32_16x16x32_bf16 v[144:147], v[208:211], v[0:3], v[192:195]
v_mfma_f32_16x16x32_bf16 v[144:147], v[212:215], v[4:7], v[144:147]
v_mfma_f32_16x16x32_bf16 v[148:151], v[208:211], v[32:35], v[196:199]
v_mfma_f32_16x16x32_bf16 v[148:151], v[212:215], v[36:39], v[148:151]
v_mfma_f32_16x16x32_bf16 v[152:155], v[208:211], v[64:67], v[200:203]
v_exp_f32 v232, v128
v_mfma_f32_16x16x32_bf16 v[152:155], v[212:215], v[68:71], v[152:155]
v_exp_f32 v233, v129
v_mfma_f32_16x16x32_bf16 v[156:159], v[208:211], v[96:99], v[204:207]
ds_read_b128 v[208:211], v230 offset:26624
v_exp_f32 v234, v130
v_mfma_f32_16x16x32_bf16 v[156:159], v[212:215], v[100:103], v[156:159]
ds_read_b128 v[212:215], v230 offset:27136
s_waitcnt lgkmcnt(2)
v_add_f32 v224, v224, v232
v_mfma_f32_16x16x32_bf16 v[144:147], v[216:219], v[8:11], v[144:147]
v_cvt_pk_bf16_f32 v0, v232, v233
v_exp_f32 v235, v131
v_mfma_f32_16x16x32_bf16 v[144:147], v[220:223], v[12:15], v[144:147]
ds_read_b128 v[4:7], v231 offset:0
v_add_f32 v224, v224, v233
v_add_f32 v224, v224, v234
v_mfma_f32_16x16x32_bf16 v[148:151], v[216:219], v[40:43], v[148:151]
ds_read_b128 v[36:39], v231 offset:1024
v_add_f32 v224, v224, v235
v_cvt_pk_bf16_f32 v1, v234, v235
v_mfma_f32_16x16x32_bf16 v[148:151], v[220:223], v[44:47], v[148:151]
v_exp_f32 v236, v132
v_mfma_f32_16x16x32_bf16 v[152:155], v[216:219], v[72:75], v[152:155]
v_exp_f32 v237, v133
v_mfma_f32_16x16x32_bf16 v[152:155], v[220:223], v[76:79], v[152:155]
ds_read_b128 v[68:71], v231 offset:2048
ds_read_b128 v[8:11], v231 offset:4096
v_mfma_f32_16x16x32_bf16 v[156:159], v[216:219], v[104:107], v[156:159]
ds_read_b128 v[216:219], v230 offset:30720
v_add_u32 v12, 0x8000, v244
v_and_b32 v12, 0x1ffff, v12
ds_read_b128 v[100:103], v231 offset:3072
ds_read_b128 v[40:43], v231 offset:5120
v_mfma_f32_16x16x32_bf16 v[156:159], v[220:223], v[108:111], v[156:159]
ds_read_b128 v[220:223], v230 offset:31232
s_waitcnt lgkmcnt(2)
v_add_u32 v14, 0x10000, v244
v_and_b32 v14, 0x1ffff, v14
v_mfma_f32_16x16x32_bf16 v[144:147], v[208:211], v[16:19], v[144:147]
v_xor_b32 v13, 32, v12
v_xor_b32 v15, 32, v14
v_mfma_f32_16x16x32_bf16 v[144:147], v[212:215], v[20:23], v[144:147]
ds_read_b128 v[72:75], v231 offset:6144
v_exp_f32 v238, v134
v_mfma_f32_16x16x32_bf16 v[148:151], v[208:211], v[48:51], v[148:151]
ds_read_b128 v[104:107], v231 offset:7168
v_add_f32 v225, v225, v236
v_cvt_pk_bf16_f32 v32, v236, v237
v_mfma_f32_16x16x32_bf16 v[148:151], v[212:215], v[52:55], v[148:151]
v_exp_f32 v239, v135
v_add_f32 v225, v225, v237
v_mfma_f32_16x16x32_bf16 v[152:155], v[208:211], v[80:83], v[152:155]
v_add_f32 v225, v225, v238
v_add_f32 v225, v225, v239
v_cvt_pk_bf16_f32 v33, v238, v239
v_mfma_f32_16x16x32_bf16 v[152:155], v[212:215], v[84:87], v[152:155]
v_exp_f32 v232, v136
v_mfma_f32_16x16x32_bf16 v[156:159], v[208:211], v[112:115], v[156:159]
ds_read_b64_tr_b16 v[208:209], v244 offset:16384
ds_read_b64_tr_b16 v[210:211], v244 offset:18432
v_mfma_f32_16x16x32_bf16 v[156:159], v[212:215], v[116:119], v[156:159]
ds_read_b64_tr_b16 v[212:213], v12 offset:0
s_waitcnt lgkmcnt(3)
v_mfma_f32_16x16x32_bf16 v[144:147], v[216:219], v[24:27], v[144:147]
ds_read_b64_tr_b16 v[214:215], v12 offset:2048
v_exp_f32 v233, v137
v_mfma_f32_16x16x32_bf16 v[144:147], v[220:223], v[28:31], v[144:147]
v_exp_f32 v234, v138
v_add_f32 v226, v226, v232
v_mfma_f32_16x16x32_bf16 v[148:151], v[216:219], v[56:59], v[148:151]
v_cvt_pk_bf16_f32 v64, v232, v233
v_exp_f32 v235, v139
v_mfma_f32_16x16x32_bf16 v[148:151], v[220:223], v[60:63], v[148:151]
v_add_f32 v226, v226, v233
v_add_f32 v226, v226, v234
v_add_f32 v226, v226, v235
v_mfma_f32_16x16x32_bf16 v[152:155], v[216:219], v[88:91], v[152:155]
v_cvt_pk_bf16_f32 v65, v234, v235
v_exp_f32 v236, v140
v_mfma_f32_16x16x32_bf16 v[152:155], v[220:223], v[92:95], v[152:155]
v_exp_f32 v237, v141
s_waitcnt vmcnt(0)
v_mfma_f32_16x16x32_bf16 v[156:159], v[216:219], v[120:123], v[156:159]
ds_read_b64_tr_b16 v[216:217], v12 offset:16384
ds_read_b64_tr_b16 v[218:219], v12 offset:18432
v_cmp_ne_u64_e64 s[38:39], s[98:99], v[240:241]
v_mfma_f32_16x16x32_bf16 v[156:159], v[220:223], v[124:127], v[156:159]
ds_read_b64_tr_b16 v[220:221], v14 offset:0
s_waitcnt lgkmcnt(3)
v_exp_f32 v238, v142
v_add_f32 v227, v227, v236
v_cvt_pk_bf16_f32 v96, v236, v237
v_exp_f32 v239, v143
v_add_f32 v227, v227, v237
v_add_f32 v227, v227, v238
v_add_f32 v227, v227, v239
v_cvt_pk_bf16_f32 v97, v238, v239
v_max3_f32 v242, v224, v225, v226
v_max_f32 v242, v242, v227
v_cmp_lt_f32 vcc, s32, v242
s_cbranch_vccnz L2_rare_site10
L2_ret10:
v_mfma_f32_16x16x32_bf16 a[0:3], v[4:7], v[208:211], a[0:3]
ds_read_b64_tr_b16 v[222:223], v14 offset:2048
s_and_b64 s[38:39], s[38:39], s[96:97]
s_cbranch_scc1 LF_hl_1
LF_hlret_1:
v_mfma_f32_16x16x32_bf16 a[0:3], v[8:11], v[212:215], a[0:3]
v_exp_f32 v232, v144
v_lshrrev_b32 v241, 4, v243
v_mfma_f32_16x16x32_bf16 a[4:7], v[36:39], v[208:211], a[4:7]
v_exp_f32 v233, v145
v_and_b32 v241, 0x30, v241
v_mfma_f32_16x16x32_bf16 a[4:7], v[40:43], v[212:215], a[4:7]
v_exp_f32 v234, v146
v_xor_b32 v241, v241, v243
v_mfma_f32_16x16x32_bf16 a[8:11], v[68:71], v[208:211], a[8:11]
v_add_f32 v224, v224, v232
v_cvt_pk_bf16_f32 v2, v232, v233
v_mfma_f32_16x16x32_bf16 a[8:11], v[72:75], v[212:215], a[8:11]
v_exp_f32 v235, v147
v_mfma_f32_16x16x32_bf16 a[12:15], v[100:103], v[208:211], a[12:15]
ds_read_b64_tr_b16 v[208:209], v245 offset:16384
ds_read_b64_tr_b16 v[210:211], v245 offset:18432
v_mfma_f32_16x16x32_bf16 a[12:15], v[104:107], v[212:215], a[12:15]
ds_read_b64_tr_b16 v[212:213], v13 offset:0
s_waitcnt lgkmcnt(3)
v_mfma_f32_16x16x32_bf16 a[0:3], v[176:179], v[216:219], a[0:3]
ds_read_b64_tr_b16 v[214:215], v13 offset:2048
v_add_f32 v224, v224, v233
v_mfma_f32_16x16x32_bf16 a[0:3], v[160:163], v[220:223], a[0:3]
v_add_f32 v224, v224, v234
v_add_f32 v224, v224, v235
v_mfma_f32_16x16x32_bf16 a[4:7], v[180:183], v[216:219], a[4:7]
v_cvt_pk_bf16_f32 v3, v234, v235
v_and_b32 v228, 0x380, v243
v_mad_u32_u24 v241, v228, 3, v241
v_mfma_f32_16x16x32_bf16 a[4:7], v[164:167], v[220:223], a[4:7]
v_exp_f32 v236, v148
v_add_u32 v241, 0x7000000, v241
v_mfma_f32_16x16x32_bf16 a[8:11], v[184:187], v[216:219], a[8:11]
v_exp_f32 v237, v149
v_and_b32 v110, 0x70, v243
v_mfma_f32_16x16x32_bf16 a[8:11], v[168:171], v[220:223], a[8:11]
v_exp_f32 v238, v150
v_lshlrev_b32 v110, 3, v110
v_mfma_f32_16x16x32_bf16 a[12:15], v[188:191], v[216:219], a[12:15]
ds_read_b64_tr_b16 v[216:217], v13 offset:16384
ds_read_b64_tr_b16 v[218:219], v13 offset:18432
v_add_u32 v110, 0x7c32000, v110
v_mfma_f32_16x16x32_bf16 a[12:15], v[172:175], v[220:223], a[12:15]
ds_read_b64_tr_b16 v[220:221], v15 offset:0
s_waitcnt lgkmcnt(3)
buffer_load_dwordx2 v[108:109], v110, s[16:19], 0 offen sc1
v_mfma_f32_16x16x32_bf16 a[16:19], v[4:7], v[208:211], a[16:19]
ds_read_b64_tr_b16 v[222:223], v15 offset:2048
v_add_f32 v225, v225, v236
v_mfma_f32_16x16x32_bf16 a[16:19], v[8:11], v[212:215], a[16:19]
v_cvt_pk_bf16_f32 v34, v236, v237
s_add_u32 m0, s28, 0
v_mfma_f32_16x16x32_bf16 a[20:23], v[36:39], v[208:211], a[20:23]
v_exp_f32 v239, v151
v_mfma_f32_16x16x32_bf16 a[20:23], v[40:43], v[212:215], a[20:23]
v_add_f32 v225, v225, v237
v_add_f32 v225, v225, v238
v_mfma_f32_16x16x32_bf16 a[24:27], v[68:71], v[208:211], a[24:27]
v_add_f32 v225, v225, v239
v_cvt_pk_bf16_f32 v35, v238, v239
v_mfma_f32_16x16x32_bf16 a[24:27], v[72:75], v[212:215], a[24:27]
v_exp_f32 v232, v152
v_mfma_f32_16x16x32_bf16 a[28:31], v[100:103], v[208:211], a[28:31]
ds_read_b64_tr_b16 v[208:209], v244 offset:16896
ds_read_b64_tr_b16 v[210:211], v244 offset:18944
v_mfma_f32_16x16x32_bf16 a[28:31], v[104:107], v[212:215], a[28:31]
ds_read_b64_tr_b16 v[212:213], v12 offset:512
s_waitcnt lgkmcnt(3)
v_mfma_f32_16x16x32_bf16 a[16:19], v[176:179], v[216:219], a[16:19]
ds_read_b64_tr_b16 v[214:215], v12 offset:2560
buffer_load_dwordx4 v241, s[16:19], s6 offen sc1 lds
s_add_u32 m0, s28, 8192
v_mfma_f32_16x16x32_bf16 a[16:19], v[160:163], v[220:223], a[16:19]
v_exp_f32 v233, v153
v_mfma_f32_16x16x32_bf16 a[20:23], v[180:183], v[216:219], a[20:23]
v_exp_f32 v234, v154
v_mfma_f32_16x16x32_bf16 a[20:23], v[164:167], v[220:223], a[20:23]
v_add_f32 v226, v226, v232
v_cvt_pk_bf16_f32 v66, v232, v233
v_mfma_f32_16x16x32_bf16 a[24:27], v[184:187], v[216:219], a[24:27]
v_exp_f32 v235, v155
v_mfma_f32_16x16x32_bf16 a[24:27], v[168:171], v[220:223], a[24:27]
v_add_f32 v226, v226, v233
v_add_f32 v226, v226, v234
v_mfma_f32_16x16x32_bf16 a[28:31], v[188:191], v[216:219], a[28:31]
ds_read_b64_tr_b16 v[216:217], v12 offset:16896
ds_read_b64_tr_b16 v[218:219], v12 offset:18944
v_mfma_f32_16x16x32_bf16 a[28:31], v[172:175], v[220:223], a[28:31]
ds_read_b64_tr_b16 v[220:221], v14 offset:512
s_waitcnt lgkmcnt(3)
v_mfma_f32_16x16x32_bf16 a[32:35], v[4:7], v[208:211], a[32:35]
ds_read_b64_tr_b16 v[222:223], v14 offset:2560
v_add_f32 v226, v226, v235
v_mfma_f32_16x16x32_bf16 a[32:35], v[8:11], v[212:215], a[32:35]
v_cvt_pk_bf16_f32 v67, v234, v235
buffer_load_dwordx4 v241, s[16:19], s7 offen sc1 lds
s_add_u32 m0, s30, 0
v_mfma_f32_16x16x32_bf16 a[36:39], v[36:39], v[208:211], a[36:39]
v_exp_f32 v236, v156
v_mfma_f32_16x16x32_bf16 a[36:39], v[40:43], v[212:215], a[36:39]
v_exp_f32 v237, v157
v_mfma_f32_16x16x32_bf16 a[40:43], v[68:71], v[208:211], a[40:43]
v_exp_f32 v238, v158
v_mfma_f32_16x16x32_bf16 a[40:43], v[72:75], v[212:215], a[40:43]
v_add_f32 v227, v227, v236
v_cvt_pk_bf16_f32 v98, v236, v237
v_mfma_f32_16x16x32_bf16 a[44:47], v[100:103], v[208:211], a[44:47]
ds_read_b64_tr_b16 v[208:209], v245 offset:16896
ds_read_b64_tr_b16 v[210:211], v245 offset:18944
v_mfma_f32_16x16x32_bf16 a[44:47], v[104:107], v[212:215], a[44:47]
ds_read_b64_tr_b16 v[212:213], v13 offset:512
s_waitcnt lgkmcnt(3)
v_mfma_f32_16x16x32_bf16 a[32:35], v[176:179], v[216:219], a[32:35]
ds_read_b64_tr_b16 v[214:215], v13 offset:2560
buffer_load_dwordx4 v241, s[16:19], s29 offen sc1 lds
s_add_u32 m0, s28, 4096
v_mfma_f32_16x16x32_bf16 a[32:35], v[160:163], v[220:223], a[32:35]
v_exp_f32 v239, v159
v_xor_b32 v241, 0x1040, v241
v_mfma_f32_16x16x32_bf16 a[36:39], v[180:183], v[216:219], a[36:39]
v_add_f32 v227, v227, v237
v_add_f32 v227, v227, v238
v_mfma_f32_16x16x32_bf16 a[36:39], v[164:167], v[220:223], a[36:39]
v_add_f32 v227, v227, v239
v_cvt_pk_bf16_f32 v99, v238, v239
v_mfma_f32_16x16x32_bf16 a[40:43], v[184:187], v[216:219], a[40:43]
v_max3_f32 v242, v224, v225, v226
v_max_f32 v242, v242, v227
v_mfma_f32_16x16x32_bf16 a[40:43], v[168:171], v[220:223], a[40:43]
v_cmp_lt_f32 vcc, s32, v242
s_cbranch_vccnz L2_rare_site11
L2_ret11:
v_mfma_f32_16x16x32_bf16 a[44:47], v[188:191], v[216:219], a[44:47]
ds_read_b64_tr_b16 v[216:217], v13 offset:16896
ds_read_b64_tr_b16 v[218:219], v13 offset:18944
v_mfma_f32_16x16x32_bf16 a[44:47], v[172:175], v[220:223], a[44:47]
ds_read_b64_tr_b16 v[220:221], v15 offset:512
s_waitcnt lgkmcnt(3)
v_mfma_f32_16x16x32_bf16 a[48:51], v[4:7], v[208:211], a[48:51]
ds_read_b64_tr_b16 v[222:223], v15 offset:2560
buffer_load_dwordx4 v241, s[16:19], s6 offen sc1 lds
s_add_u32 m0, s28, 12288
v_mfma_f32_16x16x32_bf16 a[48:51], v[8:11], v[212:215], a[48:51]
buffer_load_dwordx4 v241, s[16:19], s7 offen sc1 lds
s_add_u32 m0, s30, 4096
v_mfma_f32_16x16x32_bf16 a[52:55], v[36:39], v[208:211], a[52:55]
buffer_load_dwordx4 v241, s[16:19], s29 offen sc1 lds
v_mfma_f32_16x16x32_bf16 a[52:55], v[40:43], v[212:215], a[52:55]
v_mfma_f32_16x16x32_bf16 a[56:59], v[68:71], v[208:211], a[56:59]
v_mfma_f32_16x16x32_bf16 a[56:59], v[72:75], v[212:215], a[56:59]
v_mfma_f32_16x16x32_bf16 a[60:63], v[100:103], v[208:211], a[60:63]
ds_read_b64_tr_b16 v[208:209], v14 offset:16384
ds_read_b64_tr_b16 v[210:211], v14 offset:18432
v_mfma_f32_16x16x32_bf16 a[60:63], v[104:107], v[212:215], a[60:63]
ds_read_b64_tr_b16 v[212:213], v15 offset:16384
s_waitcnt lgkmcnt(3)
v_mfma_f32_16x16x32_bf16 a[48:51], v[176:179], v[216:219], a[48:51]
ds_read_b64_tr_b16 v[214:215], v15 offset:18432
v_mfma_f32_16x16x32_bf16 a[48:51], v[160:163], v[220:223], a[48:51]
v_mfma_f32_16x16x32_bf16 a[52:55], v[180:183], v[216:219], a[52:55]
v_mfma_f32_16x16x32_bf16 a[52:55], v[164:167], v[220:223], a[52:55]
v_mfma_f32_16x16x32_bf16 a[56:59], v[184:187], v[216:219], a[56:59]
v_mfma_f32_16x16x32_bf16 a[56:59], v[168:171], v[220:223], a[56:59]
v_mfma_f32_16x16x32_bf16 a[60:63], v[188:191], v[216:219], a[60:63]
ds_read_b64_tr_b16 v[216:217], v14 offset:16896
ds_read_b64_tr_b16 v[218:219], v14 offset:18944
v_mfma_f32_16x16x32_bf16 a[60:63], v[172:175], v[220:223], a[60:63]
ds_read_b64_tr_b16 v[220:221], v15 offset:16896
s_waitcnt lgkmcnt(5)
v_mfma_f32_16x16x32_bf16 a[0:3], v[0:3], v[208:211], a[0:3]
ds_read_b64_tr_b16 v[222:223], v15 offset:18944
v_bfe_u32 v242, v243, 8, 1
v_mul_u32_u24 v242, 48, v242
v_mfma_f32_16x16x32_bf16 a[4:7], v[32:35], v[208:211], a[4:7]
v_lshl_add_u32 v242, s37, 3, v242
v_and_b32 v228, 0xf0, v243
v_lshl_add_u32 v242, v228, 3, v242
v_mfma_f32_16x16x32_bf16 a[8:11], v[64:67], v[208:211], a[8:11]
v_mov_b32 v232, v224
v_mov_b32 v234, v225
v_mov_b32 v236, v226
v_mfma_f32_16x16x32_bf16 a[12:15], v[96:99], v[208:211], a[12:15]
ds_read_b64_tr_b16 v[208:209], v244 offset:20480
s_waitcnt lgkmcnt(5)
v_mov_b32 v238, v227
v_mfma_f32_16x16x32_bf16 a[16:19], v[0:3], v[212:215], a[16:19]
ds_read_b64_tr_b16 v[210:211], v244 offset:22528
v_permlane32_swap_b32 v224, v232
v_permlane32_swap_b32 v225, v234
v_mfma_f32_16x16x32_bf16 a[20:23], v[32:35], v[212:215], a[20:23]
v_permlane32_swap_b32 v226, v236
v_permlane32_swap_b32 v227, v238
v_add_f32 v224, v224, v232
v_mfma_f32_16x16x32_bf16 a[24:27], v[64:67], v[212:215], a[24:27]
v_add_f32 v225, v225, v234
v_add_f32 v226, v226, v236
v_add_f32 v227, v227, v238
v_mfma_f32_16x16x32_bf16 a[28:31], v[96:99], v[212:215], a[28:31]
ds_read_b64_tr_b16 v[212:213], v12 offset:4096
s_waitcnt lgkmcnt(5)
v_mov_b32 v232, v224
v_mfma_f32_16x16x32_bf16 a[32:35], v[0:3], v[216:219], a[32:35]
ds_read_b64_tr_b16 v[214:215], v12 offset:6144
v_mov_b32 v234, v225
v_mov_b32 v236, v226
v_mfma_f32_16x16x32_bf16 a[36:39], v[32:35], v[216:219], a[36:39]
v_mov_b32 v238, v227
v_permlane16_swap_b32 v224, v232
v_permlane16_swap_b32 v225, v234
v_mfma_f32_16x16x32_bf16 a[40:43], v[64:67], v[216:219], a[40:43]
v_permlane16_swap_b32 v226, v236
v_permlane16_swap_b32 v227, v238
v_add_f32 v233, v224, v232
v_mfma_f32_16x16x32_bf16 a[44:47], v[96:99], v[216:219], a[44:47]
ds_read_b64_tr_b16 v[216:217], v12 offset:20480
s_waitcnt lgkmcnt(5)
v_add_f32 v235, v225, v234
v_mfma_f32_16x16x32_bf16 a[48:51], v[0:3], v[220:223], a[48:51]
ds_read_b64_tr_b16 v[218:219], v12 offset:22528
v_add_f32 v237, v226, v236
v_add_f32 v239, v227, v238
v_mfma_f32_16x16x32_bf16 a[52:55], v[32:35], v[220:223], a[52:55]
v_sub_f32 v232, 0, v192
v_sub_f32 v234, 0, v196
v_sub_f32 v236, 0, v200
v_mfma_f32_16x16x32_bf16 a[56:59], v[64:67], v[220:223], a[56:59]
v_sub_f32 v238, 0, v204
v_mfma_f32_16x16x32_bf16 a[60:63], v[96:99], v[220:223], a[60:63]
ds_read_b64_tr_b16 v[220:221], v14 offset:4096
s_waitcnt lgkmcnt(3)
v_mfma_f32_16x16x32_bf16 a[64:67], v[4:7], v[208:211], a[64:67]
ds_read_b64_tr_b16 v[222:223], v14 offset:6144
v_mfma_f32_16x16x32_bf16 a[64:67], v[8:11], v[212:215], a[64:67]
s_mov_b32 exec_hi, 0
buffer_store_dwordx2 v[232:233], v242, s[24:27], s48 offen sc1
s_lshr_b32 s3, s41, 2
buffer_store_dwordx2 v[234:235], v242, s[24:27], s3 offen sc1
s_lshr_b32 s3, s42, 2
buffer_store_dwordx2 v[236:237], v242, s[24:27], s3 offen sc1
s_lshr_b32 s3, s43, 2
buffer_store_dwordx2 v[238:239], v242, s[24:27], s3 offen sc1
s_mov_b32 exec_hi, -1
v_mfma_f32_16x16x32_bf16 a[68:71], v[36:39], v[208:211], a[68:71]
v_accvgpr_read_b32 v128, a0
v_accvgpr_read_b32 v129, a1
v_accvgpr_read_b32 v130, a2
v_mfma_f32_16x16x32_bf16 a[68:71], v[40:43], v[212:215], a[68:71]
v_accvgpr_read_b32 v131, a3
v_cvt_pk_bf16_f32 v16, v128, v129
v_cvt_pk_bf16_f32 v17, v130, v131
v_mfma_f32_16x16x32_bf16 a[72:75], v[68:71], v[208:211], a[72:75]
v_accvgpr_read_b32 v136, a4
v_accvgpr_read_b32 v137, a5
v_accvgpr_read_b32 v138, a6
v_mfma_f32_16x16x32_bf16 a[72:75], v[72:75], v[212:215], a[72:75]
v_accvgpr_read_b32 v139, a7
v_cvt_pk_bf16_f32 v48, v136, v137
v_cvt_pk_bf16_f32 v49, v138, v139
v_mfma_f32_16x16x32_bf16 a[76:79], v[100:103], v[208:211], a[76:79]
ds_read_b64_tr_b16 v[208:209], v14 offset:20480
ds_read_b64_tr_b16 v[210:211], v14 offset:22528
v_accvgpr_read_b32 v144, a8
v_mfma_f32_16x16x32_bf16 a[76:79], v[104:107], v[212:215], a[76:79]
ds_read_b64_tr_b16 v[212:213], v245 offset:20480
s_waitcnt lgkmcnt(3)
v_accvgpr_read_b32 v145, a9
v_mfma_f32_16x16x32_bf16 a[64:67], v[176:179], v[216:219], a[64:67]
ds_read_b64_tr_b16 v[214:215], v245 offset:22528
v_accvgpr_read_b32 v146, a10
v_accvgpr_read_b32 v147, a11
v_mfma_f32_16x16x32_bf16 a[64:67], v[160:163], v[220:223], a[64:67]
v_cvt_pk_bf16_f32 v80, v144, v145
v_cvt_pk_bf16_f32 v81, v146, v147
v_accvgpr_read_b32 v152, a12
v_mfma_f32_16x16x32_bf16 a[68:71], v[180:183], v[216:219], a[68:71]
v_accvgpr_read_b32 v153, a13
v_accvgpr_read_b32 v154, a14
v_accvgpr_read_b32 v155, a15
v_mfma_f32_16x16x32_bf16 a[68:71], v[164:167], v[220:223], a[68:71]
v_cvt_pk_bf16_f32 v112, v152, v153
v_cvt_pk_bf16_f32 v113, v154, v155
v_accvgpr_read_b32 v132, a16
v_mfma_f32_16x16x32_bf16 a[72:75], v[184:187], v[216:219], a[72:75]
v_accvgpr_read_b32 v133, a17
v_accvgpr_read_b32 v134, a18
v_accvgpr_read_b32 v135, a19
v_mfma_f32_16x16x32_bf16 a[72:75], v[168:171], v[220:223], a[72:75]
v_cvt_pk_bf16_f32 v18, v132, v133
v_cvt_pk_bf16_f32 v19, v134, v135
buffer_store_dwordx4 v[16:19], v243, s[20:23], s40 offen offset:0 sc1
v_mfma_f32_16x16x32_bf16 a[76:79], v[188:191], v[216:219], a[76:79]
ds_read_b64_tr_b16 v[216:217], v13 offset:4096
ds_read_b64_tr_b16 v[218:219], v13 offset:6144
ds_write_b128 v231, v[16:19] offset:0
v_mfma_f32_16x16x32_bf16 a[76:79], v[172:175], v[220:223], a[76:79]
ds_read_b64_tr_b16 v[220:221], v13 offset:20480
s_waitcnt lgkmcnt(5)
v_accvgpr_read_b32 v140, a20
v_mfma_f32_16x16x32_bf16 a[64:67], v[0:3], v[208:211], a[64:67]
ds_read_b64_tr_b16 v[222:223], v13 offset:22528
v_accvgpr_read_b32 v141, a21
v_accvgpr_read_b32 v142, a22
v_mfma_f32_16x16x32_bf16 a[68:71], v[32:35], v[208:211], a[68:71]
v_accvgpr_read_b32 v143, a23
v_cvt_pk_bf16_f32 v50, v140, v141
v_cvt_pk_bf16_f32 v51, v142, v143
v_mfma_f32_16x16x32_bf16 a[72:75], v[64:67], v[208:211], a[72:75]
buffer_store_dwordx4 v[48:51], v243, s[20:23], s41 offen offset:0 sc1
v_accvgpr_read_b32 v148, a24
v_accvgpr_read_b32 v149, a25
v_mfma_f32_16x16x32_bf16 a[76:79], v[96:99], v[208:211], a[76:79]
ds_read_b64_tr_b16 v[208:209], v15 offset:4096
s_waitcnt lgkmcnt(5)
v_accvgpr_read_b32 v150, a26
v_mfma_f32_16x16x32_bf16 a[80:83], v[4:7], v[212:215], a[80:83]
ds_read_b64_tr_b16 v[210:211], v15 offset:6144
v_accvgpr_read_b32 v151, a27
v_cvt_pk_bf16_f32 v82, v148, v149
v_mfma_f32_16x16x32_bf16 a[84:87], v[36:39], v[212:215], a[84:87]
v_cvt_pk_bf16_f32 v83, v150, v151
buffer_store_dwordx4 v[80:83], v243, s[20:23], s42 offen offset:0 sc1
v_accvgpr_read_b32 v156, a28
v_mfma_f32_16x16x32_bf16 a[88:91], v[68:71], v[212:215], a[88:91]
v_accvgpr_read_b32 v157, a29
v_accvgpr_read_b32 v158, a30
v_accvgpr_read_b32 v159, a31
v_mfma_f32_16x16x32_bf16 a[92:95], v[100:103], v[212:215], a[92:95]
ds_read_b64_tr_b16 v[212:213], v15 offset:20480
s_waitcnt lgkmcnt(3)
v_cvt_pk_bf16_f32 v114, v156, v157
v_mfma_f32_16x16x32_bf16 a[80:83], v[8:11], v[216:219], a[80:83]
ds_read_b64_tr_b16 v[214:215], v15 offset:22528
v_cvt_pk_bf16_f32 v115, v158, v159
buffer_store_dwordx4 v[112:115], v243, s[20:23], s43 offen offset:0 sc1
v_mfma_f32_16x16x32_bf16 a[80:83], v[176:179], v[220:223], a[80:83]
v_accvgpr_read_b32 v128, a32
v_accvgpr_read_b32 v129, a33
v_accvgpr_read_b32 v130, a34
v_mfma_f32_16x16x32_bf16 a[84:87], v[40:43], v[216:219], a[84:87]
v_accvgpr_read_b32 v131, a35
v_cvt_pk_bf16_f32 v20, v128, v129
v_cvt_pk_bf16_f32 v21, v130, v131
v_mfma_f32_16x16x32_bf16 a[84:87], v[180:183], v[220:223], a[84:87]
v_accvgpr_read_b32 v136, a36
v_accvgpr_read_b32 v137, a37
v_accvgpr_read_b32 v138, a38
v_mfma_f32_16x16x32_bf16 a[88:91], v[72:75], v[216:219], a[88:91]
v_accvgpr_read_b32 v139, a39
v_cvt_pk_bf16_f32 v52, v136, v137
v_cvt_pk_bf16_f32 v53, v138, v139
v_mfma_f32_16x16x32_bf16 a[88:91], v[184:187], v[220:223], a[88:91]
v_accvgpr_read_b32 v144, a40
v_accvgpr_read_b32 v145, a41
v_accvgpr_read_b32 v146, a42
v_mfma_f32_16x16x32_bf16 a[92:95], v[104:107], v[216:219], a[92:95]
ds_read_b64_tr_b16 v[216:217], v244 offset:20992
ds_read_b64_tr_b16 v[218:219], v244 offset:23040
v_accvgpr_read_b32 v147, a43
v_mfma_f32_16x16x32_bf16 a[92:95], v[188:191], v[220:223], a[92:95]
ds_read_b64_tr_b16 v[220:221], v12 offset:4608
s_waitcnt lgkmcnt(3)
v_cvt_pk_bf16_f32 v84, v144, v145
v_mfma_f32_16x16x32_bf16 a[80:83], v[160:163], v[208:211], a[80:83]
ds_read_b64_tr_b16 v[222:223], v12 offset:6656
v_cvt_pk_bf16_f32 v85, v146, v147
v_accvgpr_read_b32 v152, a44
v_mfma_f32_16x16x32_bf16 a[80:83], v[0:3], v[212:215], a[80:83]
v_accvgpr_read_b32 v153, a45
v_accvgpr_read_b32 v154, a46
v_accvgpr_read_b32 v155, a47
v_mfma_f32_16x16x32_bf16 a[84:87], v[164:167], v[208:211], a[84:87]
v_cvt_pk_bf16_f32 v116, v152, v153
v_cvt_pk_bf16_f32 v117, v154, v155
v_accvgpr_read_b32 v132, a48
v_mfma_f32_16x16x32_bf16 a[84:87], v[32:35], v[212:215], a[84:87]
v_accvgpr_read_b32 v133, a49
v_accvgpr_read_b32 v134, a50
v_accvgpr_read_b32 v135, a51
v_mfma_f32_16x16x32_bf16 a[88:91], v[168:171], v[208:211], a[88:91]
v_cvt_pk_bf16_f32 v22, v132, v133
v_cvt_pk_bf16_f32 v23, v134, v135
buffer_store_dwordx4 v[20:23], v243, s[20:23], s40 offen offset:1024 sc1
v_mfma_f32_16x16x32_bf16 a[88:91], v[64:67], v[212:215], a[88:91]
ds_write_b128 v231, v[20:23] offset:1024
v_accvgpr_read_b32 v140, a52
v_accvgpr_read_b32 v141, a53
v_mfma_f32_16x16x32_bf16 a[92:95], v[172:175], v[208:211], a[92:95]
ds_read_b64_tr_b16 v[208:209], v12 offset:20992
ds_read_b64_tr_b16 v[210:211], v12 offset:23040
v_accvgpr_read_b32 v142, a54
v_mfma_f32_16x16x32_bf16 a[92:95], v[96:99], v[212:215], a[92:95]
ds_read_b64_tr_b16 v[212:213], v14 offset:4608
s_waitcnt lgkmcnt(3)
v_accvgpr_read_b32 v143, a55
v_mfma_f32_16x16x32_bf16 a[96:99], v[4:7], v[216:219], a[96:99]
ds_read_b64_tr_b16 v[214:215], v14 offset:6656
v_cvt_pk_bf16_f32 v54, v140, v141
v_cvt_pk_bf16_f32 v55, v142, v143
v_mfma_f32_16x16x32_bf16 a[96:99], v[8:11], v[220:223], a[96:99]
buffer_store_dwordx4 v[52:55], v243, s[20:23], s41 offen offset:1024 sc1
v_accvgpr_read_b32 v148, a56
v_accvgpr_read_b32 v149, a57
v_mfma_f32_16x16x32_bf16 a[100:103], v[36:39], v[216:219], a[100:103]
v_accvgpr_read_b32 v150, a58
v_accvgpr_read_b32 v151, a59
v_cvt_pk_bf16_f32 v86, v148, v149
v_mfma_f32_16x16x32_bf16 a[100:103], v[40:43], v[220:223], a[100:103]
v_cvt_pk_bf16_f32 v87, v150, v151
buffer_store_dwordx4 v[84:87], v243, s[20:23], s42 offen offset:1024 sc1
v_accvgpr_read_b32 v156, a60
v_mfma_f32_16x16x32_bf16 a[104:107], v[68:71], v[216:219], a[104:107]
v_accvgpr_read_b32 v157, a61
v_accvgpr_read_b32 v158, a62
v_accvgpr_read_b32 v159, a63
v_mfma_f32_16x16x32_bf16 a[104:107], v[72:75], v[220:223], a[104:107]
v_cvt_pk_bf16_f32 v118, v156, v157
v_cvt_pk_bf16_f32 v119, v158, v159
buffer_store_dwordx4 v[116:119], v243, s[20:23], s43 offen offset:1024 sc1
v_mfma_f32_16x16x32_bf16 a[108:111], v[100:103], v[216:219], a[108:111]
ds_read_b64_tr_b16 v[216:217], v14 offset:20992
ds_read_b64_tr_b16 v[218:219], v14 offset:23040
v_accvgpr_read_b32 v128, a64
v_mfma_f32_16x16x32_bf16 a[108:111], v[104:107], v[220:223], a[108:111]
ds_read_b64_tr_b16 v[220:221], v245 offset:20992
s_waitcnt lgkmcnt(3)
v_accvgpr_read_b32 v129, a65
v_mfma_f32_16x16x32_bf16 a[96:99], v[176:179], v[208:211], a[96:99]
ds_read_b64_tr_b16 v[222:223], v245 offset:23040
v_accvgpr_read_b32 v130, a66
v_accvgpr_read_b32 v131, a67
v_mfma_f32_16x16x32_bf16 a[96:99], v[160:163], v[212:215], a[96:99]
v_cvt_pk_bf16_f32 v24, v128, v129
v_cvt_pk_bf16_f32 v25, v130, v131
v_accvgpr_read_b32 v136, a68
v_mfma_f32_16x16x32_bf16 a[100:103], v[180:183], v[208:211], a[100:103]
v_accvgpr_read_b32 v137, a69
v_accvgpr_read_b32 v138, a70
v_accvgpr_read_b32 v139, a71
v_mfma_f32_16x16x32_bf16 a[100:103], v[164:167], v[212:215], a[100:103]
v_cvt_pk_bf16_f32 v56, v136, v137
v_cvt_pk_bf16_f32 v57, v138, v139
v_accvgpr_read_b32 v144, a72
v_mfma_f32_16x16x32_bf16 a[104:107], v[184:187], v[208:211], a[104:107]
v_accvgpr_read_b32 v145, a73
v_accvgpr_read_b32 v146, a74
v_accvgpr_read_b32 v147, a75
v_mfma_f32_16x16x32_bf16 a[104:107], v[168:171], v[212:215], a[104:107]
v_cvt_pk_bf16_f32 v88, v144, v145
v_cvt_pk_bf16_f32 v89, v146, v147
v_accvgpr_read_b32 v152, a76
v_mfma_f32_16x16x32_bf16 a[108:111], v[188:191], v[208:211], a[108:111]
ds_read_b64_tr_b16 v[208:209], v13 offset:4608
ds_read_b64_tr_b16 v[210:211], v13 offset:6656
v_accvgpr_read_b32 v153, a77
v_mfma_f32_16x16x32_bf16 a[108:111], v[172:175], v[212:215], a[108:111]
ds_read_b64_tr_b16 v[212:213], v13 offset:20992
s_waitcnt lgkmcnt(5)
v_accvgpr_read_b32 v154, a78
v_mfma_f32_16x16x32_bf16 a[96:99], v[0:3], v[216:219], a[96:99]
ds_read_b64_tr_b16 v[214:215], v13 offset:23040
v_accvgpr_read_b32 v155, a79
v_cvt_pk_bf16_f32 v120, v152, v153
v_mfma_f32_16x16x32_bf16 a[100:103], v[32:35], v[216:219], a[100:103]
v_cvt_pk_bf16_f32 v121, v154, v155
v_accvgpr_read_b32 v132, a80
v_accvgpr_read_b32 v133, a81
v_mfma_f32_16x16x32_bf16 a[104:107], v[64:67], v[216:219], a[104:107]
v_accvgpr_read_b32 v134, a82
v_accvgpr_read_b32 v135, a83
v_cvt_pk_bf16_f32 v26, v132, v133
v_mfma_f32_16x16x32_bf16 a[108:111], v[96:99], v[216:219], a[108:111]
ds_read_b64_tr_b16 v[216:217], v15 offset:4608
s_waitcnt lgkmcnt(5)
v_cvt_pk_bf16_f32 v27, v134, v135
v_mfma_f32_16x16x32_bf16 a[112:115], v[4:7], v[220:223], a[112:115]
ds_read_b64_tr_b16 v[218:219], v15 offset:6656
buffer_store_dwordx4 v[24:27], v243, s[20:23], s40 offen offset:2048 sc1
ds_write_b128 v231, v[24:27] offset:2048
v_mfma_f32_16x16x32_bf16 a[116:119], v[36:39], v[220:223], a[116:119]
v_accvgpr_read_b32 v140, a84
v_accvgpr_read_b32 v141, a85
v_accvgpr_read_b32 v142, a86
v_mfma_f32_16x16x32_bf16 a[120:123], v[68:71], v[220:223], a[120:123]
v_accvgpr_read_b32 v143, a87
v_cvt_pk_bf16_f32 v58, v140, v141
v_cvt_pk_bf16_f32 v59, v142, v143
v_mfma_f32_16x16x32_bf16 a[124:127], v[100:103], v[220:223], a[124:127]
ds_read_b64_tr_b16 v[220:221], v15 offset:20992
s_waitcnt lgkmcnt(3)
buffer_store_dwordx4 v[56:59], v243, s[20:23], s41 offen offset:2048 sc1
v_mfma_f32_16x16x32_bf16 a[112:115], v[8:11], v[208:211], a[112:115]
ds_read_b64_tr_b16 v[222:223], v15 offset:23040
v_accvgpr_read_b32 v148, a88
v_accvgpr_read_b32 v149, a89
v_mfma_f32_16x16x32_bf16 a[112:115], v[176:179], v[212:215], a[112:115]
v_accvgpr_read_b32 v150, a90
v_accvgpr_read_b32 v151, a91
v_cvt_pk_bf16_f32 v90, v148, v149
v_mfma_f32_16x16x32_bf16 a[116:119], v[40:43], v[208:211], a[116:119]
v_cvt_pk_bf16_f32 v91, v150, v151
buffer_store_dwordx4 v[88:91], v243, s[20:23], s42 offen offset:2048 sc1
v_accvgpr_read_b32 v156, a92
v_mfma_f32_16x16x32_bf16 a[116:119], v[180:183], v[212:215], a[116:119]
v_accvgpr_read_b32 v157, a93
v_accvgpr_read_b32 v158, a94
v_accvgpr_read_b32 v159, a95
v_mfma_f32_16x16x32_bf16 a[120:123], v[72:75], v[208:211], a[120:123]
v_cvt_pk_bf16_f32 v122, v156, v157
v_cvt_pk_bf16_f32 v123, v158, v159
buffer_store_dwordx4 v[120:123], v243, s[20:23], s43 offen offset:2048 sc1
v_mfma_f32_16x16x32_bf16 a[120:123], v[184:187], v[212:215], a[120:123]
v_accvgpr_read_b32 v128, a96
v_accvgpr_read_b32 v129, a97
v_mfma_f32_16x16x32_bf16 a[124:127], v[104:107], v[208:211], a[124:127]
ds_read_b64_tr_b16 v[208:209], v12 offset:8192
ds_read_b64_tr_b16 v[210:211], v12 offset:10240
v_mfma_f32_16x16x32_bf16 a[124:127], v[188:191], v[212:215], a[124:127]
ds_read_b64_tr_b16 v[212:213], v12 offset:24576
s_waitcnt lgkmcnt(3)
v_mfma_f32_16x16x32_bf16 a[112:115], v[160:163], v[216:219], a[112:115]
ds_read_b64_tr_b16 v[214:215], v12 offset:26624
v_accvgpr_read_b32 v130, a98
v_mfma_f32_16x16x32_bf16 a[112:115], v[0:3], v[220:223], a[112:115]
v_accvgpr_read_b32 v131, a99
v_cvt_pk_bf16_f32 v28, v128, v129
v_mfma_f32_16x16x32_bf16 a[116:119], v[164:167], v[216:219], a[116:119]
v_cvt_pk_bf16_f32 v29, v130, v131
v_accvgpr_read_b32 v136, a100
v_mfma_f32_16x16x32_bf16 a[116:119], v[32:35], v[220:223], a[116:119]
v_accvgpr_read_b32 v137, a101
v_accvgpr_read_b32 v138, a102
v_mfma_f32_16x16x32_bf16 a[120:123], v[168:171], v[216:219], a[120:123]
v_accvgpr_read_b32 v139, a103
v_cvt_pk_bf16_f32 v60, v136, v137
v_mfma_f32_16x16x32_bf16 a[120:123], v[64:67], v[220:223], a[120:123]
v_cvt_pk_bf16_f32 v61, v138, v139
v_accvgpr_read_b32 v144, a104
v_mfma_f32_16x16x32_bf16 a[124:127], v[172:175], v[216:219], a[124:127]
ds_read_b64_tr_b16 v[216:217], v14 offset:8192
ds_read_b64_tr_b16 v[218:219], v14 offset:10240
v_mfma_f32_16x16x32_bf16 a[124:127], v[96:99], v[220:223], a[124:127]
ds_read_b64_tr_b16 v[220:221], v14 offset:24576
s_waitcnt lgkmcnt(3)
v_mfma_f32_16x16x32_bf16 a[128:131], v[8:11], v[208:211], a[128:131]
ds_read_b64_tr_b16 v[222:223], v14 offset:26624
v_accvgpr_read_b32 v145, a105
v_mfma_f32_16x16x32_bf16 a[128:131], v[176:179], v[212:215], a[128:131]
v_accvgpr_read_b32 v146, a106
v_accvgpr_read_b32 v147, a107
v_mfma_f32_16x16x32_bf16 a[132:135], v[40:43], v[208:211], a[132:135]
v_cvt_pk_bf16_f32 v92, v144, v145
v_cvt_pk_bf16_f32 v93, v146, v147
v_mfma_f32_16x16x32_bf16 a[132:135], v[180:183], v[212:215], a[132:135]
v_accvgpr_read_b32 v152, a108
v_accvgpr_read_b32 v153, a109
v_mfma_f32_16x16x32_bf16 a[136:139], v[72:75], v[208:211], a[136:139]
v_accvgpr_read_b32 v154, a110
v_accvgpr_read_b32 v155, a111
v_mfma_f32_16x16x32_bf16 a[136:139], v[184:187], v[212:215], a[136:139]
v_cvt_pk_bf16_f32 v124, v152, v153
v_cvt_pk_bf16_f32 v125, v154, v155
v_mfma_f32_16x16x32_bf16 a[140:143], v[104:107], v[208:211], a[140:143]
ds_read_b64_tr_b16 v[208:209], v13 offset:8192
ds_read_b64_tr_b16 v[210:211], v13 offset:10240
v_mfma_f32_16x16x32_bf16 a[140:143], v[188:191], v[212:215], a[140:143]
ds_read_b64_tr_b16 v[212:213], v13 offset:24576
s_waitcnt lgkmcnt(3)
v_mfma_f32_16x16x32_bf16 a[128:131], v[160:163], v[216:219], a[128:131]
ds_read_b64_tr_b16 v[214:215], v13 offset:26624
v_accvgpr_read_b32 v132, a112
v_mfma_f32_16x16x32_bf16 a[128:131], v[0:3], v[220:223], a[128:131]
v_accvgpr_read_b32 v133, a113
v_accvgpr_read_b32 v134, a114
v_mfma_f32_16x16x32_bf16 a[132:135], v[164:167], v[216:219], a[132:135]
v_accvgpr_read_b32 v135, a115
v_cvt_pk_bf16_f32 v30, v132, v133
v_mfma_f32_16x16x32_bf16 a[132:135], v[32:35], v[220:223], a[132:135]
v_cvt_pk_bf16_f32 v31, v134, v135
buffer_store_dwordx4 v[28:31], v243, s[20:23], s40 offen offset:3072 sc1
v_mfma_f32_16x16x32_bf16 a[136:139], v[168:171], v[216:219], a[136:139]
ds_write_b128 v231, v[28:31] offset:3072
v_accvgpr_read_b32 v140, a116
v_mfma_f32_16x16x32_bf16 a[136:139], v[64:67], v[220:223], a[136:139]
v_accvgpr_read_b32 v141, a117
v_accvgpr_read_b32 v142, a118
v_mfma_f32_16x16x32_bf16 a[140:143], v[172:175], v[216:219], a[140:143]
ds_read_b64_tr_b16 v[216:217], v15 offset:8192
ds_read_b64_tr_b16 v[218:219], v15 offset:10240
v_mfma_f32_16x16x32_bf16 a[140:143], v[96:99], v[220:223], a[140:143]
ds_read_b64_tr_b16 v[220:221], v15 offset:24576
s_waitcnt lgkmcnt(3)
v_mfma_f32_16x16x32_bf16 a[144:147], v[8:11], v[208:211], a[144:147]
ds_read_b64_tr_b16 v[222:223], v15 offset:26624
v_accvgpr_read_b32 v143, a119
v_mfma_f32_16x16x32_bf16 a[144:147], v[176:179], v[212:215], a[144:147]
v_cvt_pk_bf16_f32 v62, v140, v141
v_cvt_pk_bf16_f32 v63, v142, v143
v_mfma_f32_16x16x32_bf16 a[148:151], v[40:43], v[208:211], a[148:151]
buffer_store_dwordx4 v[60:63], v243, s[20:23], s41 offen offset:3072 sc1
v_accvgpr_read_b32 v148, a120
v_mfma_f32_16x16x32_bf16 a[148:151], v[180:183], v[212:215], a[148:151]
v_accvgpr_read_b32 v149, a121
v_accvgpr_read_b32 v150, a122
v_mfma_f32_16x16x32_bf16 a[152:155], v[72:75], v[208:211], a[152:155]
v_accvgpr_read_b32 v151, a123
v_cvt_pk_bf16_f32 v94, v148, v149
v_mfma_f32_16x16x32_bf16 a[152:155], v[184:187], v[212:215], a[152:155]
v_cvt_pk_bf16_f32 v95, v150, v151
buffer_store_dwordx4 v[92:95], v243, s[20:23], s42 offen offset:3072 sc1
v_mfma_f32_16x16x32_bf16 a[156:159], v[104:107], v[208:211], a[156:159]
ds_read_b64_tr_b16 v[208:209], v12 offset:8704
ds_read_b64_tr_b16 v[210:211], v12 offset:10752
v_mfma_f32_16x16x32_bf16 a[156:159], v[188:191], v[212:215], a[156:159]
ds_read_b64_tr_b16 v[212:213], v12 offset:25088
s_waitcnt lgkmcnt(3)
v_mfma_f32_16x16x32_bf16 a[144:147], v[160:163], v[216:219], a[144:147]
ds_read_b64_tr_b16 v[214:215], v12 offset:27136
v_accvgpr_read_b32 v156, a124
v_mfma_f32_16x16x32_bf16 a[144:147], v[0:3], v[220:223], a[144:147]
v_accvgpr_read_b32 v157, a125
v_accvgpr_read_b32 v158, a126
v_mfma_f32_16x16x32_bf16 a[148:151], v[164:167], v[216:219], a[148:151]
v_accvgpr_read_b32 v159, a127
v_cvt_pk_bf16_f32 v126, v156, v157
v_mfma_f32_16x16x32_bf16 a[148:151], v[32:35], v[220:223], a[148:151]
v_cvt_pk_bf16_f32 v127, v158, v159
buffer_store_dwordx4 v[124:127], v243, s[20:23], s43 offen offset:3072 sc1
v_mfma_f32_16x16x32_bf16 a[152:155], v[168:171], v[216:219], a[152:155]
v_accvgpr_read_b32 v128, a128
v_accvgpr_read_b32 v129, a129
v_mfma_f32_16x16x32_bf16 a[152:155], v[64:67], v[220:223], a[152:155]
v_accvgpr_read_b32 v130, a130
v_accvgpr_read_b32 v131, a131
v_mfma_f32_16x16x32_bf16 a[156:159], v[172:175], v[216:219], a[156:159]
ds_read_b64_tr_b16 v[216:217], v14 offset:8704
ds_read_b64_tr_b16 v[218:219], v14 offset:10752
v_mfma_f32_16x16x32_bf16 a[156:159], v[96:99], v[220:223], a[156:159]
ds_read_b64_tr_b16 v[220:221], v14 offset:25088
s_waitcnt lgkmcnt(3)
v_mfma_f32_16x16x32_bf16 a[160:163], v[8:11], v[208:211], a[160:163]
ds_read_b64_tr_b16 v[222:223], v14 offset:27136
v_cvt_pk_bf16_f32 v16, v128, v129
v_mfma_f32_16x16x32_bf16 a[160:163], v[176:179], v[212:215], a[160:163]
v_cvt_pk_bf16_f32 v17, v130, v131
v_accvgpr_read_b32 v136, a132
v_mfma_f32_16x16x32_bf16 a[164:167], v[40:43], v[208:211], a[164:167]
v_accvgpr_read_b32 v137, a133
v_accvgpr_read_b32 v138, a134
v_mfma_f32_16x16x32_bf16 a[164:167], v[180:183], v[212:215], a[164:167]
v_accvgpr_read_b32 v139, a135
v_cvt_pk_bf16_f32 v48, v136, v137
v_mfma_f32_16x16x32_bf16 a[168:171], v[72:75], v[208:211], a[168:171]
v_cvt_pk_bf16_f32 v49, v138, v139
v_accvgpr_read_b32 v144, a136
v_mfma_f32_16x16x32_bf16 a[168:171], v[184:187], v[212:215], a[168:171]
v_accvgpr_read_b32 v145, a137
v_accvgpr_read_b32 v146, a138
v_mfma_f32_16x16x32_bf16 a[172:175], v[104:107], v[208:211], a[172:175]
ds_read_b64_tr_b16 v[208:209], v13 offset:8704
ds_read_b64_tr_b16 v[210:211], v13 offset:10752
v_mfma_f32_16x16x32_bf16 a[172:175], v[188:191], v[212:215], a[172:175]
ds_read_b64_tr_b16 v[212:213], v13 offset:25088
s_waitcnt lgkmcnt(3)
v_mfma_f32_16x16x32_bf16 a[160:163], v[160:163], v[216:219], a[160:163]
ds_read_b64_tr_b16 v[214:215], v13 offset:27136
v_accvgpr_read_b32 v147, a139
v_mfma_f32_16x16x32_bf16 a[160:163], v[0:3], v[220:223], a[160:163]
v_cvt_pk_bf16_f32 v80, v144, v145
v_cvt_pk_bf16_f32 v81, v146, v147
v_mfma_f32_16x16x32_bf16 a[164:167], v[164:167], v[216:219], a[164:167]
v_accvgpr_read_b32 v152, a140
v_accvgpr_read_b32 v153, a141
v_mfma_f32_16x16x32_bf16 a[164:167], v[32:35], v[220:223], a[164:167]
v_accvgpr_read_b32 v154, a142
v_accvgpr_read_b32 v155, a143
v_mfma_f32_16x16x32_bf16 a[168:171], v[168:171], v[216:219], a[168:171]
v_cvt_pk_bf16_f32 v112, v152, v153
v_cvt_pk_bf16_f32 v113, v154, v155
v_mfma_f32_16x16x32_bf16 a[168:171], v[64:67], v[220:223], a[168:171]
v_accvgpr_read_b32 v132, a144
v_accvgpr_read_b32 v133, a145
v_mfma_f32_16x16x32_bf16 a[172:175], v[172:175], v[216:219], a[172:175]
ds_read_b64_tr_b16 v[216:217], v15 offset:8704
ds_read_b64_tr_b16 v[218:219], v15 offset:10752
v_mfma_f32_16x16x32_bf16 a[172:175], v[96:99], v[220:223], a[172:175]
ds_read_b64_tr_b16 v[220:221], v15 offset:25088
s_waitcnt lgkmcnt(3)
v_mfma_f32_16x16x32_bf16 a[176:179], v[8:11], v[208:211], a[176:179]
ds_read_b64_tr_b16 v[222:223], v15 offset:27136
v_accvgpr_read_b32 v134, a146
v_mfma_f32_16x16x32_bf16 a[176:179], v[176:179], v[212:215], a[176:179]
v_accvgpr_read_b32 v135, a147
v_cvt_pk_bf16_f32 v18, v132, v133
v_mfma_f32_16x16x32_bf16 a[180:183], v[40:43], v[208:211], a[180:183]
v_cvt_pk_bf16_f32 v19, v134, v135
buffer_store_dwordx4 v[16:19], v243, s[20:23], s44 offen offset:0 sc1
v_mfma_f32_16x16x32_bf16 a[180:183], v[180:183], v[212:215], a[180:183]
ds_write_b128 v231, v[16:19] offset:4096
v_accvgpr_read_b32 v140, a148
v_mfma_f32_16x16x32_bf16 a[184:187], v[72:75], v[208:211], a[184:187]
v_accvgpr_read_b32 v141, a149
v_accvgpr_read_b32 v142, a150
v_mfma_f32_16x16x32_bf16 a[184:187], v[184:187], v[212:215], a[184:187]
v_accvgpr_read_b32 v143, a151
v_cvt_pk_bf16_f32 v50, v140, v141
v_mfma_f32_16x16x32_bf16 a[188:191], v[104:107], v[208:211], a[188:191]
ds_read_b64_tr_b16 v[208:209], v12 offset:12288
ds_read_b64_tr_b16 v[210:211], v12 offset:14336
v_mfma_f32_16x16x32_bf16 a[188:191], v[188:191], v[212:215], a[188:191]
ds_read_b64_tr_b16 v[212:213], v12 offset:28672
s_waitcnt lgkmcnt(3)
v_mfma_f32_16x16x32_bf16 a[176:179], v[160:163], v[216:219], a[176:179]
ds_read_b64_tr_b16 v[214:215], v12 offset:30720
v_cvt_pk_bf16_f32 v51, v142, v143
v_mfma_f32_16x16x32_bf16 a[176:179], v[0:3], v[220:223], a[176:179]
buffer_store_dwordx4 v[48:51], v243, s[20:23], s45 offen offset:0 sc1
v_accvgpr_read_b32 v148, a152
v_mfma_f32_16x16x32_bf16 a[180:183], v[164:167], v[216:219], a[180:183]
v_accvgpr_read_b32 v149, a153
v_accvgpr_read_b32 v150, a154
v_mfma_f32_16x16x32_bf16 a[180:183], v[32:35], v[220:223], a[180:183]
v_accvgpr_read_b32 v151, a155
v_cvt_pk_bf16_f32 v82, v148, v149
v_mfma_f32_16x16x32_bf16 a[184:187], v[168:171], v[216:219], a[184:187]
v_cvt_pk_bf16_f32 v83, v150, v151
buffer_store_dwordx4 v[80:83], v243, s[20:23], s46 offen offset:0 sc1
v_mfma_f32_16x16x32_bf16 a[184:187], v[64:67], v[220:223], a[184:187]
v_accvgpr_read_b32 v156, a156
v_accvgpr_read_b32 v157, a157
v_mfma_f32_16x16x32_bf16 a[188:191], v[172:175], v[216:219], a[188:191]
ds_read_b64_tr_b16 v[216:217], v14 offset:12288
ds_read_b64_tr_b16 v[218:219], v14 offset:14336
v_mfma_f32_16x16x32_bf16 a[188:191], v[96:99], v[220:223], a[188:191]
ds_read_b64_tr_b16 v[220:221], v14 offset:28672
s_waitcnt lgkmcnt(3)
v_mfma_f32_16x16x32_bf16 a[192:195], v[8:11], v[208:211], a[192:195]
ds_read_b64_tr_b16 v[222:223], v14 offset:30720
v_accvgpr_read_b32 v158, a158
v_mfma_f32_16x16x32_bf16 a[192:195], v[176:179], v[212:215], a[192:195]
v_accvgpr_read_b32 v159, a159
v_cvt_pk_bf16_f32 v114, v156, v157
v_mfma_f32_16x16x32_bf16 a[196:199], v[40:43], v[208:211], a[196:199]
v_cvt_pk_bf16_f32 v115, v158, v159
buffer_store_dwordx4 v[112:115], v243, s[20:23], s47 offen offset:0 sc1
v_mfma_f32_16x16x32_bf16 a[196:199], v[180:183], v[212:215], a[196:199]
v_accvgpr_read_b32 v128, a160
v_accvgpr_read_b32 v129, a161
v_mfma_f32_16x16x32_bf16 a[200:203], v[72:75], v[208:211], a[200:203]
v_accvgpr_read_b32 v130, a162
v_accvgpr_read_b32 v131, a163
v_mfma_f32_16x16x32_bf16 a[200:203], v[184:187], v[212:215], a[200:203]
v_cvt_pk_bf16_f32 v20, v128, v129
v_cvt_pk_bf16_f32 v21, v130, v131
v_mfma_f32_16x16x32_bf16 a[204:207], v[104:107], v[208:211], a[204:207]
ds_read_b64_tr_b16 v[208:209], v13 offset:12288
ds_read_b64_tr_b16 v[210:211], v13 offset:14336
v_mfma_f32_16x16x32_bf16 a[204:207], v[188:191], v[212:215], a[204:207]
ds_read_b64_tr_b16 v[212:213], v13 offset:28672
s_waitcnt lgkmcnt(3)
v_mfma_f32_16x16x32_bf16 a[192:195], v[160:163], v[216:219], a[192:195]
ds_read_b64_tr_b16 v[214:215], v13 offset:30720
v_accvgpr_read_b32 v136, a164
v_mfma_f32_16x16x32_bf16 a[192:195], v[0:3], v[220:223], a[192:195]
v_accvgpr_read_b32 v137, a165
v_accvgpr_read_b32 v138, a166
v_mfma_f32_16x16x32_bf16 a[196:199], v[164:167], v[216:219], a[196:199]
v_accvgpr_read_b32 v139, a167
v_cvt_pk_bf16_f32 v52, v136, v137
v_mfma_f32_16x16x32_bf16 a[196:199], v[32:35], v[220:223], a[196:199]
v_cvt_pk_bf16_f32 v53, v138, v139
v_accvgpr_read_b32 v144, a168
v_mfma_f32_16x16x32_bf16 a[200:203], v[168:171], v[216:219], a[200:203]
v_accvgpr_read_b32 v145, a169
v_accvgpr_read_b32 v146, a170
v_mfma_f32_16x16x32_bf16 a[200:203], v[64:67], v[220:223], a[200:203]
v_accvgpr_read_b32 v147, a171
v_cvt_pk_bf16_f32 v84, v144, v145
v_mfma_f32_16x16x32_bf16 a[204:207], v[172:175], v[216:219], a[204:207]
ds_read_b64_tr_b16 v[216:217], v15 offset:12288
ds_read_b64_tr_b16 v[218:219], v15 offset:14336
v_mfma_f32_16x16x32_bf16 a[204:207], v[96:99], v[220:223], a[204:207]
ds_read_b64_tr_b16 v[220:221], v15 offset:28672
s_waitcnt lgkmcnt(3)
v_mfma_f32_16x16x32_bf16 a[208:211], v[8:11], v[208:211], a[208:211]
ds_read_b64_tr_b16 v[222:223], v15 offset:30720
v_cvt_pk_bf16_f32 v85, v146, v147
v_mfma_f32_16x16x32_bf16 a[208:211], v[176:179], v[212:215], a[208:211]
v_accvgpr_read_b32 v152, a172
v_accvgpr_read_b32 v153, a173
v_mfma_f32_16x16x32_bf16 a[212:215], v[40:43], v[208:211], a[212:215]
v_accvgpr_read_b32 v154, a174
v_accvgpr_read_b32 v155, a175
v_mfma_f32_16x16x32_bf16 a[212:215], v[180:183], v[212:215], a[212:215]
v_cvt_pk_bf16_f32 v116, v152, v153
v_cvt_pk_bf16_f32 v117, v154, v155
v_mfma_f32_16x16x32_bf16 a[216:219], v[72:75], v[208:211], a[216:219]
v_accvgpr_read_b32 v132, a176
v_accvgpr_read_b32 v133, a177
v_mfma_f32_16x16x32_bf16 a[216:219], v[184:187], v[212:215], a[216:219]
v_accvgpr_read_b32 v134, a178
v_accvgpr_read_b32 v135, a179
v_mfma_f32_16x16x32_bf16 a[220:223], v[104:107], v[208:211], a[220:223]
ds_read_b64_tr_b16 v[208:209], v12 offset:12800
ds_read_b64_tr_b16 v[210:211], v12 offset:14848
v_mfma_f32_16x16x32_bf16 a[220:223], v[188:191], v[212:215], a[220:223]
ds_read_b64_tr_b16 v[212:213], v12 offset:29184
s_waitcnt lgkmcnt(3)
v_mfma_f32_16x16x32_bf16 a[208:211], v[160:163], v[216:219], a[208:211]
ds_read_b64_tr_b16 v[214:215], v12 offset:31232
v_cvt_pk_bf16_f32 v22, v132, v133
v_mfma_f32_16x16x32_bf16 a[208:211], v[0:3], v[220:223], a[208:211]
v_cvt_pk_bf16_f32 v23, v134, v135
buffer_store_dwordx4 v[20:23], v243, s[20:23], s44 offen offset:1024 sc1
v_mfma_f32_16x16x32_bf16 a[212:215], v[164:167], v[216:219], a[212:215]
ds_write_b128 v231, v[20:23] offset:5120
v_accvgpr_read_b32 v140, a180
v_mfma_f32_16x16x32_bf16 a[212:215], v[32:35], v[220:223], a[212:215]
v_accvgpr_read_b32 v141, a181
v_accvgpr_read_b32 v142, a182
v_mfma_f32_16x16x32_bf16 a[216:219], v[168:171], v[216:219], a[216:219]
v_accvgpr_read_b32 v143, a183
v_cvt_pk_bf16_f32 v54, v140, v141
v_mfma_f32_16x16x32_bf16 a[216:219], v[64:67], v[220:223], a[216:219]
v_cvt_pk_bf16_f32 v55, v142, v143
buffer_store_dwordx4 v[52:55], v243, s[20:23], s45 offen offset:1024 sc1
v_mfma_f32_16x16x32_bf16 a[220:223], v[172:175], v[216:219], a[220:223]
ds_read_b64_tr_b16 v[216:217], v14 offset:12800
ds_read_b64_tr_b16 v[218:219], v14 offset:14848
v_mfma_f32_16x16x32_bf16 a[220:223], v[96:99], v[220:223], a[220:223]
ds_read_b64_tr_b16 v[220:221], v14 offset:29184
s_waitcnt lgkmcnt(3)
v_mfma_f32_16x16x32_bf16 a[224:227], v[8:11], v[208:211], a[224:227]
ds_read_b64_tr_b16 v[222:223], v14 offset:31232
v_accvgpr_read_b32 v148, a184
v_mfma_f32_16x16x32_bf16 a[224:227], v[176:179], v[212:215], a[224:227]
v_accvgpr_read_b32 v149, a185
v_accvgpr_read_b32 v150, a186
v_mfma_f32_16x16x32_bf16 a[228:231], v[40:43], v[208:211], a[228:231]
v_accvgpr_read_b32 v151, a187
v_cvt_pk_bf16_f32 v86, v148, v149
v_mfma_f32_16x16x32_bf16 a[228:231], v[180:183], v[212:215], a[228:231]
v_cvt_pk_bf16_f32 v87, v150, v151
buffer_store_dwordx4 v[84:87], v243, s[20:23], s46 offen offset:1024 sc1
v_mfma_f32_16x16x32_bf16 a[232:235], v[72:75], v[208:211], a[232:235]
v_accvgpr_read_b32 v156, a188
v_accvgpr_read_b32 v157, a189
v_mfma_f32_16x16x32_bf16 a[232:235], v[184:187], v[212:215], a[232:235]
v_accvgpr_read_b32 v158, a190
v_accvgpr_read_b32 v159, a191
v_mfma_f32_16x16x32_bf16 a[236:239], v[104:107], v[208:211], a[236:239]
ds_read_b64_tr_b16 v[208:209], v13 offset:12800
ds_read_b64_tr_b16 v[210:211], v13 offset:14848
v_mfma_f32_16x16x32_bf16 a[236:239], v[188:191], v[212:215], a[236:239]
ds_read_b64_tr_b16 v[212:213], v13 offset:29184
s_waitcnt lgkmcnt(3)
v_mfma_f32_16x16x32_bf16 a[224:227], v[160:163], v[216:219], a[224:227]
ds_read_b64_tr_b16 v[214:215], v13 offset:31232
v_cvt_pk_bf16_f32 v118, v156, v157
v_mfma_f32_16x16x32_bf16 a[224:227], v[0:3], v[220:223], a[224:227]
v_cvt_pk_bf16_f32 v119, v158, v159
buffer_store_dwordx4 v[116:119], v243, s[20:23], s47 offen offset:1024 sc1
v_mfma_f32_16x16x32_bf16 a[228:231], v[164:167], v[216:219], a[228:231]
v_accvgpr_read_b32 v128, a192
v_accvgpr_read_b32 v129, a193
v_mfma_f32_16x16x32_bf16 a[228:231], v[32:35], v[220:223], a[228:231]
v_accvgpr_read_b32 v130, a194
v_accvgpr_read_b32 v131, a195
v_mfma_f32_16x16x32_bf16 a[232:235], v[168:171], v[216:219], a[232:235]
v_cvt_pk_bf16_f32 v24, v128, v129
v_cvt_pk_bf16_f32 v25, v130, v131
v_mfma_f32_16x16x32_bf16 a[232:235], v[64:67], v[220:223], a[232:235]
v_accvgpr_read_b32 v136, a196
v_accvgpr_read_b32 v137, a197
v_mfma_f32_16x16x32_bf16 a[236:239], v[172:175], v[216:219], a[236:239]
ds_read_b64_tr_b16 v[216:217], v15 offset:12800
ds_read_b64_tr_b16 v[218:219], v15 offset:14848
v_mfma_f32_16x16x32_bf16 a[236:239], v[96:99], v[220:223], a[236:239]
ds_read_b64_tr_b16 v[220:221], v15 offset:29184
s_waitcnt lgkmcnt(3)
v_mfma_f32_16x16x32_bf16 a[240:243], v[8:11], v[208:211], a[240:243]
ds_read_b64_tr_b16 v[222:223], v15 offset:31232
v_accvgpr_read_b32 v138, a198
v_mfma_f32_16x16x32_bf16 a[240:243], v[176:179], v[212:215], a[240:243]
v_accvgpr_read_b32 v139, a199
v_cvt_pk_bf16_f32 v56, v136, v137
v_mfma_f32_16x16x32_bf16 a[244:247], v[40:43], v[208:211], a[244:247]
v_cvt_pk_bf16_f32 v57, v138, v139
v_accvgpr_read_b32 v144, a200
v_mfma_f32_16x16x32_bf16 a[244:247], v[180:183], v[212:215], a[244:247]
v_accvgpr_read_b32 v145, a201
v_accvgpr_read_b32 v146, a202
v_mfma_f32_16x16x32_bf16 a[248:251], v[72:75], v[208:211], a[248:251]
v_accvgpr_read_b32 v147, a203
v_cvt_pk_bf16_f32 v88, v144, v145
v_mfma_f32_16x16x32_bf16 a[248:251], v[184:187], v[212:215], a[248:251]
v_cvt_pk_bf16_f32 v89, v146, v147
v_accvgpr_read_b32 v152, a204
v_mfma_f32_16x16x32_bf16 a[252:255], v[104:107], v[208:211], a[252:255]
v_accvgpr_read_b32 v153, a205
v_accvgpr_read_b32 v154, a206
v_mfma_f32_16x16x32_bf16 a[252:255], v[188:191], v[212:215], a[252:255]
s_waitcnt lgkmcnt(0)
v_accvgpr_read_b32 v155, a207
v_mfma_f32_16x16x32_bf16 a[240:243], v[160:163], v[216:219], a[240:243]
v_cvt_pk_bf16_f32 v120, v152, v153
v_cvt_pk_bf16_f32 v121, v154, v155
v_mfma_f32_16x16x32_bf16 a[240:243], v[0:3], v[220:223], a[240:243]
v_accvgpr_read_b32 v132, a208
v_accvgpr_read_b32 v133, a209
v_mfma_f32_16x16x32_bf16 a[244:247], v[164:167], v[216:219], a[244:247]
v_accvgpr_read_b32 v134, a210
v_accvgpr_read_b32 v135, a211
v_mfma_f32_16x16x32_bf16 a[244:247], v[32:35], v[220:223], a[244:247]
v_cvt_pk_bf16_f32 v26, v132, v133
v_cvt_pk_bf16_f32 v27, v134, v135
v_mfma_f32_16x16x32_bf16 a[248:251], v[168:171], v[216:219], a[248:251]
buffer_store_dwordx4 v[24:27], v243, s[20:23], s44 offen offset:2048 sc1
ds_write_b128 v231, v[24:27] offset:6144
v_mfma_f32_16x16x32_bf16 a[248:251], v[64:67], v[220:223], a[248:251]
v_accvgpr_read_b32 v140, a212
v_accvgpr_read_b32 v141, a213
v_mfma_f32_16x16x32_bf16 a[252:255], v[172:175], v[216:219], a[252:255]
v_accvgpr_read_b32 v142, a214
v_accvgpr_read_b32 v143, a215
v_mfma_f32_16x16x32_bf16 a[252:255], v[96:99], v[220:223], a[252:255]
v_cvt_pk_bf16_f32 v58, v140, v141
v_cvt_pk_bf16_f32 v59, v142, v143
buffer_store_dwordx4 v[56:59], v243, s[20:23], s45 offen offset:2048 sc1
v_accvgpr_read_b32 v148, a216
v_accvgpr_read_b32 v149, a217
v_accvgpr_read_b32 v150, a218
v_accvgpr_read_b32 v151, a219
v_cvt_pk_bf16_f32 v90, v148, v149
v_cvt_pk_bf16_f32 v91, v150, v151
buffer_store_dwordx4 v[88:91], v243, s[20:23], s46 offen offset:2048 sc1
v_accvgpr_read_b32 v156, a220
v_accvgpr_read_b32 v157, a221
v_accvgpr_read_b32 v158, a222
v_accvgpr_read_b32 v159, a223
v_cvt_pk_bf16_f32 v122, v156, v157
v_cvt_pk_bf16_f32 v123, v158, v159
buffer_store_dwordx4 v[120:123], v243, s[20:23], s47 offen offset:2048 sc1
v_accvgpr_read_b32 v128, a224
v_accvgpr_read_b32 v129, a225
v_accvgpr_read_b32 v130, a226
v_accvgpr_read_b32 v131, a227
v_cvt_pk_bf16_f32 v28, v128, v129
v_cvt_pk_bf16_f32 v29, v130, v131
v_accvgpr_read_b32 v136, a228
v_accvgpr_read_b32 v137, a229
v_accvgpr_read_b32 v138, a230
v_accvgpr_read_b32 v139, a231
v_cvt_pk_bf16_f32 v60, v136, v137
v_cvt_pk_bf16_f32 v61, v138, v139
v_accvgpr_read_b32 v144, a232
v_accvgpr_read_b32 v145, a233
v_accvgpr_read_b32 v146, a234
v_accvgpr_read_b32 v147, a235
v_cvt_pk_bf16_f32 v92, v144, v145
v_cvt_pk_bf16_f32 v93, v146, v147
v_accvgpr_read_b32 v152, a236
v_accvgpr_read_b32 v153, a237
v_accvgpr_read_b32 v154, a238
v_accvgpr_read_b32 v155, a239
v_cvt_pk_bf16_f32 v124, v152, v153
v_cvt_pk_bf16_f32 v125, v154, v155
v_accvgpr_read_b32 v132, a240
v_accvgpr_read_b32 v133, a241
v_accvgpr_read_b32 v134, a242
v_accvgpr_read_b32 v135, a243
v_cvt_pk_bf16_f32 v30, v132, v133
v_cvt_pk_bf16_f32 v31, v134, v135
buffer_store_dwordx4 v[28:31], v243, s[20:23], s44 offen offset:3072 sc1
ds_write_b128 v231, v[28:31] offset:7168
v_accvgpr_read_b32 v140, a244
v_accvgpr_read_b32 v141, a245
v_accvgpr_read_b32 v142, a246
v_accvgpr_read_b32 v143, a247
v_cvt_pk_bf16_f32 v62, v140, v141
v_cvt_pk_bf16_f32 v63, v142, v143
buffer_store_dwordx4 v[60:63], v243, s[20:23], s45 offen offset:3072 sc1
v_accvgpr_read_b32 v148, a248
v_accvgpr_read_b32 v149, a249
v_accvgpr_read_b32 v150, a250
v_accvgpr_read_b32 v151, a251
v_cvt_pk_bf16_f32 v94, v148, v149
v_cvt_pk_bf16_f32 v95, v150, v151
buffer_store_dwordx4 v[92:95], v243, s[20:23], s46 offen offset:3072 sc1
v_accvgpr_read_b32 v156, a252
v_accvgpr_read_b32 v157, a253
v_accvgpr_read_b32 v158, a254
v_accvgpr_read_b32 v159, a255
v_cvt_pk_bf16_f32 v126, v156, v157
v_cvt_pk_bf16_f32 v127, v158, v159
buffer_store_dwordx4 v[124:127], v243, s[20:23], s47 offen offset:3072 sc1
s_waitcnt vmcnt(36)
s_branch L2_F
L2_tail_1:
s_waitcnt lgkmcnt(2)
v_add_u32 v231, s50, v243
v_mfma_f32_16x16x32_bf16 v[144:147], v[208:211], v[0:3], v[192:195]
s_mov_b32 m0, s30
ds_write_b128 v231, v[160:163] offset:0
v_mfma_f32_16x16x32_bf16 v[144:147], v[212:215], v[4:7], v[144:147]
buffer_load_dwordx4 v241, s[12:15], s28 offen offset:0 sc1 lds
ds_write_b128 v231, v[164:167] offset:1024
v_mfma_f32_16x16x32_bf16 v[148:151], v[208:211], v[32:35], v[196:199]
buffer_load_dwordx4 v241, s[12:15], s28 offen offset:1024 sc1 lds
ds_write_b128 v231, v[168:171] offset:2048
v_mfma_f32_16x16x32_bf16 v[148:151], v[212:215], v[36:39], v[148:151]
buffer_load_dwordx4 v241, s[12:15], s28 offen offset:2048 sc1 lds
ds_write_b128 v231, v[172:175] offset:3072
v_mfma_f32_16x16x32_bf16 v[152:155], v[208:211], v[64:67], v[200:203]
buffer_load_dwordx4 v241, s[12:15], s28 offen offset:3072 sc1 lds
v_add_u32 v230, 0x8000, v240
v_and_b32 v230, 0x1ffff, v230
v_mfma_f32_16x16x32_bf16 v[152:155], v[212:215], v[68:71], v[152:155]
v_exp_f32 v232, v128
v_mfma_f32_16x16x32_bf16 v[156:159], v[208:211], v[96:99], v[204:207]
ds_read_b128 v[208:211], v240 offset:10240
v_exp_f32 v233, v129
v_mfma_f32_16x16x32_bf16 v[156:159], v[212:215], v[100:103], v[156:159]
ds_read_b128 v[212:215], v240 offset:10752
s_waitcnt lgkmcnt(2)
s_and_b32 s30, s30, 0x1c000
v_mfma_f32_16x16x32_bf16 v[144:147], v[216:219], v[8:11], v[144:147]
v_exp_f32 v234, v130
v_add_f32 v224, v224, v232
v_mfma_f32_16x16x32_bf16 v[144:147], v[220:223], v[12:15], v[144:147]
v_cvt_pk_bf16_f32 v160, v232, v233
v_exp_f32 v235, v131
v_mfma_f32_16x16x32_bf16 v[148:151], v[216:219], v[40:43], v[148:151]
v_add_f32 v224, v224, v233
v_add_f32 v224, v224, v234
v_add_f32 v224, v224, v235
v_mfma_f32_16x16x32_bf16 v[148:151], v[220:223], v[44:47], v[148:151]
v_cvt_pk_bf16_f32 v161, v234, v235
v_exp_f32 v236, v132
v_mfma_f32_16x16x32_bf16 v[152:155], v[216:219], v[72:75], v[152:155]
v_exp_f32 v237, v133
s_add_u32 s28, s30, 0x4000
v_mfma_f32_16x16x32_bf16 v[152:155], v[220:223], v[76:79], v[152:155]
v_exp_f32 v238, v134
v_add_f32 v225, v225, v236
v_mfma_f32_16x16x32_bf16 v[156:159], v[216:219], v[104:107], v[156:159]
ds_read_b128 v[216:219], v240 offset:14336
v_cvt_pk_bf16_f32 v164, v236, v237
s_and_b32 s28, s28, 0x1ffff
v_mfma_f32_16x16x32_bf16 v[156:159], v[220:223], v[108:111], v[156:159]
ds_read_b128 v[220:223], v240 offset:14848
s_waitcnt lgkmcnt(2)
s_add_u32 s30, s30, 0x8000
v_mfma_f32_16x16x32_bf16 v[144:147], v[208:211], v[16:19], v[144:147]
v_exp_f32 v239, v135
v_add_f32 v225, v225, v237
v_mfma_f32_16x16x32_bf16 v[144:147], v[212:215], v[20:23], v[144:147]
s_waitcnt vmcnt(4)
s_barrier
v_add_f32 v225, v225, v238
v_mfma_f32_16x16x32_bf16 v[148:151], v[208:211], v[48:51], v[148:151]
v_add_f32 v225, v225, v239
v_cvt_pk_bf16_f32 v165, v238, v239
s_and_b32 s30, s30, 0x1ffff
v_mfma_f32_16x16x32_bf16 v[148:151], v[212:215], v[52:55], v[148:151]
v_exp_f32 v232, v136
s_mul_i32 s31, s34, 6144
v_mfma_f32_16x16x32_bf16 v[152:155], v[208:211], v[80:83], v[152:155]
v_exp_f32 v233, v137
s_add_u32 s31, s31, s30
v_mfma_f32_16x16x32_bf16 v[152:155], v[212:215], v[84:87], v[152:155]
v_exp_f32 v234, v138
v_add_f32 v226, v226, v232
v_mfma_f32_16x16x32_bf16 v[156:159], v[208:211], v[112:115], v[156:159]
ds_read_b128 v[208:211], v240 offset:16384
v_cvt_pk_bf16_f32 v168, v232, v233
s_lshl_b32 s3, s34, 10
v_mfma_f32_16x16x32_bf16 v[156:159], v[212:215], v[116:119], v[156:159]
ds_read_b128 v[212:215], v240 offset:16896
s_waitcnt lgkmcnt(2)
s_add_u32 s28, s28, s3
v_mfma_f32_16x16x32_bf16 v[144:147], v[216:219], v[24:27], v[144:147]
v_exp_f32 v235, v139
v_add_f32 v226, v226, v233
v_mfma_f32_16x16x32_bf16 v[144:147], v[220:223], v[28:31], v[144:147]
v_add_f32 v226, v226, v234
v_add_f32 v226, v226, v235
v_cvt_pk_bf16_f32 v169, v234, v235
v_mfma_f32_16x16x32_bf16 v[148:151], v[216:219], v[56:59], v[148:151]
v_exp_f32 v236, v140
s_add_u32 s3, s3, 24576
v_mfma_f32_16x16x32_bf16 v[148:151], v[220:223], v[60:63], v[148:151]
v_exp_f32 v237, v141
s_add_u32 s30, s30, s3
v_mfma_f32_16x16x32_bf16 v[152:155], v[216:219], v[88:91], v[152:155]
v_exp_f32 v238, v142
v_add_f32 v227, v227, v236
v_mfma_f32_16x16x32_bf16 v[152:155], v[220:223], v[92:95], v[152:155]
v_cvt_pk_bf16_f32 v172, v236, v237
v_exp_f32 v239, v143
v_mfma_f32_16x16x32_bf16 v[156:159], v[216:219], v[120:123], v[156:159]
ds_read_b128 v[216:219], v240 offset:20480
v_add_f32 v227, v227, v237
v_add_f32 v227, v227, v238
v_mfma_f32_16x16x32_bf16 v[156:159], v[220:223], v[124:127], v[156:159]
ds_read_b128 v[220:223], v240 offset:20992
s_waitcnt lgkmcnt(2)
v_add_f32 v227, v227, v239
v_cvt_pk_bf16_f32 v173, v238, v239
v_max3_f32 v242, v224, v225, v226
v_max_f32 v242, v242, v227
v_cmp_lt_f32 vcc, s32, v242
s_cbranch_vccnz L2_rare_site12
L2_ret12:
v_mfma_f32_16x16x32_bf16 v[128:131], v[208:211], v[0:3], v[192:195]
v_lshrrev_b32 v241, 4, v243
v_and_b32 v241, 0x30, v241
v_xor_b32 v241, v241, v243
v_and_b32 v228, 0x380, v243
v_mad_u32_u24 v241, v228, 3, v241
v_mfma_f32_16x16x32_bf16 v[128:131], v[212:215], v[4:7], v[128:131]
v_exp_f32 v232, v144
v_mfma_f32_16x16x32_bf16 v[132:135], v[208:211], v[32:35], v[196:199]
v_exp_f32 v233, v145
v_mfma_f32_16x16x32_bf16 v[132:135], v[212:215], v[36:39], v[132:135]
v_exp_f32 v234, v146
v_add_f32 v224, v224, v232
v_mfma_f32_16x16x32_bf16 v[136:139], v[208:211], v[64:67], v[200:203]
v_cvt_pk_bf16_f32 v162, v232, v233
v_exp_f32 v235, v147
v_mfma_f32_16x16x32_bf16 v[136:139], v[212:215], v[68:71], v[136:139]
v_add_f32 v224, v224, v233
v_add_f32 v224, v224, v234
v_add_f32 v224, v224, v235
v_mfma_f32_16x16x32_bf16 v[140:143], v[208:211], v[96:99], v[204:207]
ds_read_b128 v[208:211], v240 offset:24576
v_cvt_pk_bf16_f32 v163, v234, v235
v_mfma_f32_16x16x32_bf16 v[140:143], v[212:215], v[100:103], v[140:143]
ds_read_b128 v[212:215], v240 offset:25088
s_waitcnt lgkmcnt(2)
v_mfma_f32_16x16x32_bf16 v[128:131], v[216:219], v[8:11], v[128:131]
ds_write_b128 v231, v[176:179] offset:4096
v_exp_f32 v236, v148
v_mfma_f32_16x16x32_bf16 v[128:131], v[220:223], v[12:15], v[128:131]
ds_write_b128 v231, v[180:183] offset:5120
v_exp_f32 v237, v149
v_mfma_f32_16x16x32_bf16 v[132:135], v[216:219], v[40:43], v[132:135]
ds_write_b128 v231, v[184:187] offset:6144
v_exp_f32 v238, v150
v_mfma_f32_16x16x32_bf16 v[132:135], v[220:223], v[44:47], v[132:135]
ds_write_b128 v231, v[188:191] offset:7168
v_add_f32 v225, v225, v236
v_cvt_pk_bf16_f32 v166, v236, v237
v_mfma_f32_16x16x32_bf16 v[136:139], v[216:219], v[72:75], v[136:139]
v_exp_f32 v239, v151
v_add_f32 v225, v225, v237
v_mfma_f32_16x16x32_bf16 v[136:139], v[220:223], v[76:79], v[136:139]
v_add_f32 v225, v225, v238
v_add_f32 v225, v225, v239
v_cvt_pk_bf16_f32 v167, v238, v239
v_mfma_f32_16x16x32_bf16 v[140:143], v[216:219], v[104:107], v[140:143]
ds_read_b128 v[216:219], v240 offset:28672
v_exp_f32 v232, v152
v_mfma_f32_16x16x32_bf16 v[140:143], v[220:223], v[108:111], v[140:143]
ds_read_b128 v[220:223], v240 offset:29184
s_waitcnt lgkmcnt(2)
v_mfma_f32_16x16x32_bf16 v[128:131], v[208:211], v[16:19], v[128:131]
v_exp_f32 v233, v153
v_mfma_f32_16x16x32_bf16 v[128:131], v[212:215], v[20:23], v[128:131]
v_exp_f32 v234, v154
v_add_f32 v226, v226, v232
v_mfma_f32_16x16x32_bf16 v[132:135], v[208:211], v[48:51], v[132:135]
v_cvt_pk_bf16_f32 v170, v232, v233
v_exp_f32 v235, v155
v_mfma_f32_16x16x32_bf16 v[132:135], v[212:215], v[52:55], v[132:135]
v_add_f32 v226, v226, v233
v_add_f32 v226, v226, v234
v_add_f32 v226, v226, v235
v_mfma_f32_16x16x32_bf16 v[136:139], v[208:211], v[80:83], v[136:139]
v_cvt_pk_bf16_f32 v171, v234, v235
v_exp_f32 v236, v156
v_mfma_f32_16x16x32_bf16 v[136:139], v[212:215], v[84:87], v[136:139]
v_exp_f32 v237, v157
v_mfma_f32_16x16x32_bf16 v[140:143], v[208:211], v[112:115], v[140:143]
ds_read_b128 v[208:211], v240 offset:18432
v_exp_f32 v238, v158
v_mfma_f32_16x16x32_bf16 v[140:143], v[212:215], v[116:119], v[140:143]
ds_read_b128 v[212:215], v240 offset:18944
s_waitcnt lgkmcnt(2)
v_add_f32 v227, v227, v236
v_mfma_f32_16x16x32_bf16 v[128:131], v[216:219], v[24:27], v[128:131]
v_cvt_pk_bf16_f32 v174, v236, v237
v_exp_f32 v239, v159
v_mfma_f32_16x16x32_bf16 v[128:131], v[220:223], v[28:31], v[128:131]
v_add_f32 v227, v227, v237
v_add_f32 v227, v227, v238
v_add_f32 v227, v227, v239
v_mfma_f32_16x16x32_bf16 v[132:135], v[216:219], v[56:59], v[132:135]
v_cvt_pk_bf16_f32 v175, v238, v239
v_max3_f32 v242, v224, v225, v226
v_max_f32 v242, v242, v227
v_mfma_f32_16x16x32_bf16 v[132:135], v[220:223], v[60:63], v[132:135]
v_cmp_lt_f32 vcc, s32, v242
s_cbranch_vccnz L2_rare_site13
L2_ret13:
v_mfma_f32_16x16x32_bf16 v[136:139], v[216:219], v[88:91], v[136:139]
s_add_u32 m0, s31, 0
v_mfma_f32_16x16x32_bf16 v[136:139], v[220:223], v[92:95], v[136:139]
buffer_load_dwordx4 v241, s[8:11], s6 offen lds
s_add_u32 m0, s31, 2048
v_mfma_f32_16x16x32_bf16 v[140:143], v[216:219], v[120:123], v[140:143]
ds_read_b128 v[216:219], v240 offset:22528
buffer_load_dwordx4 v241, s[8:11], s7 offen lds
s_add_u32 m0, s31, 4096
v_mfma_f32_16x16x32_bf16 v[140:143], v[220:223], v[124:127], v[140:143]
ds_read_b128 v[220:223], v240 offset:23040
s_waitcnt lgkmcnt(2)
v_mfma_f32_16x16x32_bf16 v[144:147], v[208:211], v[0:3], v[192:195]
buffer_load_dwordx4 v241, s[8:11], s29 offen lds
s_add_u32 m0, s31, 1024
v_xor_b32 v241, 0x1040, v241
v_mfma_f32_16x16x32_bf16 v[144:147], v[212:215], v[4:7], v[144:147]
v_exp_f32 v232, v128
v_mfma_f32_16x16x32_bf16 v[148:151], v[208:211], v[32:35], v[196:199]
v_exp_f32 v233, v129
v_mfma_f32_16x16x32_bf16 v[148:151], v[212:215], v[36:39], v[148:151]
v_exp_f32 v234, v130
v_add_f32 v224, v224, v232
v_mfma_f32_16x16x32_bf16 v[152:155], v[208:211], v[64:67], v[200:203]
v_cvt_pk_bf16_f32 v176, v232, v233
v_exp_f32 v235, v131
v_mfma_f32_16x16x32_bf16 v[152:155], v[212:215], v[68:71], v[152:155]
v_add_f32 v224, v224, v233
v_add_f32 v224, v224, v234
v_add_f32 v224, v224, v235
v_mfma_f32_16x16x32_bf16 v[156:159], v[208:211], v[96:99], v[204:207]
ds_read_b128 v[208:211], v240 offset:26624
v_cvt_pk_bf16_f32 v177, v234, v235
v_mfma_f32_16x16x32_bf16 v[156:159], v[212:215], v[100:103], v[156:159]
ds_read_b128 v[212:215], v240 offset:27136
s_waitcnt lgkmcnt(2)
v_mfma_f32_16x16x32_bf16 v[144:147], v[216:219], v[8:11], v[144:147]
v_exp_f32 v236, v132
v_mfma_f32_16x16x32_bf16 v[144:147], v[220:223], v[12:15], v[144:147]
v_exp_f32 v237, v133
v_mfma_f32_16x16x32_bf16 v[148:151], v[216:219], v[40:43], v[148:151]
v_exp_f32 v238, v134
v_add_f32 v225, v225, v236
v_mfma_f32_16x16x32_bf16 v[148:151], v[220:223], v[44:47], v[148:151]
v_cvt_pk_bf16_f32 v180, v236, v237
v_exp_f32 v239, v135
v_mfma_f32_16x16x32_bf16 v[152:155], v[216:219], v[72:75], v[152:155]
v_add_f32 v225, v225, v237
v_add_f32 v225, v225, v238
v_add_f32 v225, v225, v239
v_mfma_f32_16x16x32_bf16 v[152:155], v[220:223], v[76:79], v[152:155]
v_cvt_pk_bf16_f32 v181, v238, v239
v_exp_f32 v232, v136
v_mfma_f32_16x16x32_bf16 v[156:159], v[216:219], v[104:107], v[156:159]
ds_read_b128 v[216:219], v240 offset:30720
v_exp_f32 v233, v137
v_mfma_f32_16x16x32_bf16 v[156:159], v[220:223], v[108:111], v[156:159]
ds_read_b128 v[220:223], v240 offset:31232
s_waitcnt lgkmcnt(2)
v_mfma_f32_16x16x32_bf16 v[144:147], v[208:211], v[16:19], v[144:147]
v_exp_f32 v234, v138
v_add_f32 v226, v226, v232
v_mfma_f32_16x16x32_bf16 v[144:147], v[212:215], v[20:23], v[144:147]
s_waitcnt vmcnt(3)
s_barrier
v_cvt_pk_bf16_f32 v184, v232, v233
v_mfma_f32_16x16x32_bf16 v[148:151], v[208:211], v[48:51], v[148:151]
v_exp_f32 v235, v139
v_add_f32 v226, v226, v233
v_mfma_f32_16x16x32_bf16 v[148:151], v[212:215], v[52:55], v[148:151]
v_add_f32 v226, v226, v234
v_add_f32 v226, v226, v235
v_cvt_pk_bf16_f32 v185, v234, v235
v_mfma_f32_16x16x32_bf16 v[152:155], v[208:211], v[80:83], v[152:155]
v_exp_f32 v236, v140
v_mfma_f32_16x16x32_bf16 v[152:155], v[212:215], v[84:87], v[152:155]
v_exp_f32 v237, v141
v_mfma_f32_16x16x32_bf16 v[156:159], v[208:211], v[112:115], v[156:159]
ds_read_b128 v[208:211], v230 offset:0
v_exp_f32 v238, v142
v_mfma_f32_16x16x32_bf16 v[156:159], v[212:215], v[116:119], v[156:159]
ds_read_b128 v[212:215], v230 offset:512
s_waitcnt lgkmcnt(2)
v_add_f32 v227, v227, v236
v_mfma_f32_16x16x32_bf16 v[144:147], v[216:219], v[24:27], v[144:147]
v_cvt_pk_bf16_f32 v188, v236, v237
v_exp_f32 v239, v143
v_mfma_f32_16x16x32_bf16 v[144:147], v[220:223], v[28:31], v[144:147]
v_add_f32 v227, v227, v237
v_add_f32 v227, v227, v238
v_add_f32 v227, v227, v239
v_mfma_f32_16x16x32_bf16 v[148:151], v[216:219], v[56:59], v[148:151]
v_cvt_pk_bf16_f32 v189, v238, v239
v_max3_f32 v242, v224, v225, v226
v_max_f32 v242, v242, v227
v_mfma_f32_16x16x32_bf16 v[148:151], v[220:223], v[60:63], v[148:151]
v_cmp_lt_f32 vcc, s32, v242
s_cbranch_vccnz L2_rare_site14
L2_ret14:
v_mfma_f32_16x16x32_bf16 v[152:155], v[216:219], v[88:91], v[152:155]
buffer_load_dwordx4 v241, s[8:11], s6 offen lds
s_add_u32 m0, s31, 3072
v_mfma_f32_16x16x32_bf16 v[152:155], v[220:223], v[92:95], v[152:155]
buffer_load_dwordx4 v241, s[8:11], s7 offen lds
s_add_u32 m0, s31, 5120
v_mfma_f32_16x16x32_bf16 v[156:159], v[216:219], v[120:123], v[156:159]
ds_read_b128 v[216:219], v230 offset:4096
buffer_load_dwordx4 v241, s[8:11], s29 offen lds
v_mfma_f32_16x16x32_bf16 v[156:159], v[220:223], v[124:127], v[156:159]
ds_read_b128 v[220:223], v230 offset:4608
s_waitcnt lgkmcnt(2)
v_mfma_f32_16x16x32_bf16 v[128:131], v[208:211], v[0:3], v[192:195]
v_mfma_f32_16x16x32_bf16 v[128:131], v[212:215], v[4:7], v[128:131]
v_exp_f32 v232, v144
v_mfma_f32_16x16x32_bf16 v[132:135], v[208:211], v[32:35], v[196:199]
v_exp_f32 v233, v145
v_mfma_f32_16x16x32_bf16 v[132:135], v[212:215], v[36:39], v[132:135]
v_exp_f32 v234, v146
v_add_f32 v224, v224, v232
v_mfma_f32_16x16x32_bf16 v[136:139], v[208:211], v[64:67], v[200:203]
v_cvt_pk_bf16_f32 v178, v232, v233
v_exp_f32 v235, v147
v_mfma_f32_16x16x32_bf16 v[136:139], v[212:215], v[68:71], v[136:139]
v_add_f32 v224, v224, v233
v_add_f32 v224, v224, v234
v_add_f32 v224, v224, v235
v_mfma_f32_16x16x32_bf16 v[140:143], v[208:211], v[96:99], v[204:207]
ds_read_b128 v[208:211], v230 offset:8192
v_cvt_pk_bf16_f32 v179, v234, v235
v_lshlrev_b32 v241, 3, v243
v_mfma_f32_16x16x32_bf16 v[140:143], v[212:215], v[100:103], v[140:143]
ds_read_b128 v[212:215], v230 offset:8704
s_waitcnt lgkmcnt(2)
s_mov_b32 s3, 0x7c28000
v_mfma_f32_16x16x32_bf16 v[128:131], v[216:219], v[8:11], v[128:131]
v_exp_f32 v236, v148
buffer_load_dwordx2 v[240:241], v241, s[16:19], s3 offen sc1
v_mfma_f32_16x16x32_bf16 v[128:131], v[220:223], v[12:15], v[128:131]
v_exp_f32 v237, v149
v_mfma_f32_16x16x32_bf16 v[132:135], v[216:219], v[40:43], v[132:135]
v_exp_f32 v238, v150
v_add_f32 v225, v225, v236
v_mfma_f32_16x16x32_bf16 v[132:135], v[220:223], v[44:47], v[132:135]
v_cvt_pk_bf16_f32 v182, v236, v237
v_exp_f32 v239, v151
v_mfma_f32_16x16x32_bf16 v[136:139], v[216:219], v[72:75], v[136:139]
v_add_f32 v225, v225, v237
v_add_f32 v225, v225, v238
v_add_f32 v225, v225, v239
v_mfma_f32_16x16x32_bf16 v[136:139], v[220:223], v[76:79], v[136:139]
v_cvt_pk_bf16_f32 v183, v238, v239
v_exp_f32 v232, v152
v_mfma_f32_16x16x32_bf16 v[140:143], v[216:219], v[104:107], v[140:143]
ds_read_b128 v[216:219], v230 offset:12288
v_exp_f32 v233, v153
v_mfma_f32_16x16x32_bf16 v[140:143], v[220:223], v[108:111], v[140:143]
ds_read_b128 v[220:223], v230 offset:12800
s_waitcnt lgkmcnt(2)
v_mfma_f32_16x16x32_bf16 v[128:131], v[208:211], v[16:19], v[128:131]
v_exp_f32 v234, v154
v_add_f32 v226, v226, v232
v_mfma_f32_16x16x32_bf16 v[128:131], v[212:215], v[20:23], v[128:131]
v_cvt_pk_bf16_f32 v186, v232, v233
v_exp_f32 v235, v155
v_mfma_f32_16x16x32_bf16 v[132:135], v[208:211], v[48:51], v[132:135]
v_add_f32 v226, v226, v233
v_add_f32 v226, v226, v234
v_add_f32 v226, v226, v235
v_mfma_f32_16x16x32_bf16 v[132:135], v[212:215], v[52:55], v[132:135]
v_cvt_pk_bf16_f32 v187, v234, v235
v_exp_f32 v236, v156
v_mfma_f32_16x16x32_bf16 v[136:139], v[208:211], v[80:83], v[136:139]
v_exp_f32 v237, v157
v_mfma_f32_16x16x32_bf16 v[136:139], v[212:215], v[84:87], v[136:139]
v_exp_f32 v238, v158
v_add_f32 v227, v227, v236
v_mfma_f32_16x16x32_bf16 v[140:143], v[208:211], v[112:115], v[140:143]
ds_read_b128 v[208:211], v230 offset:2048
v_cvt_pk_bf16_f32 v190, v236, v237
v_mfma_f32_16x16x32_bf16 v[140:143], v[212:215], v[116:119], v[140:143]
ds_read_b128 v[212:215], v230 offset:2560
s_waitcnt lgkmcnt(2)
v_mfma_f32_16x16x32_bf16 v[128:131], v[216:219], v[24:27], v[128:131]
v_exp_f32 v239, v159
v_add_f32 v227, v227, v237
v_mfma_f32_16x16x32_bf16 v[128:131], v[220:223], v[28:31], v[128:131]
v_add_f32 v227, v227, v238
v_add_f32 v227, v227, v239
v_cvt_pk_bf16_f32 v191, v238, v239
v_mfma_f32_16x16x32_bf16 v[132:135], v[216:219], v[56:59], v[132:135]
v_max3_f32 v242, v224, v225, v226
v_max_f32 v242, v242, v227
v_cmp_lt_f32 vcc, s32, v242
s_cbranch_vccnz L2_rare_site15
L2_ret15:
v_mfma_f32_16x16x32_bf16 v[132:135], v[220:223], v[60:63], v[132:135]
v_mfma_f32_16x16x32_bf16 v[136:139], v[216:219], v[88:91], v[136:139]
v_mfma_f32_16x16x32_bf16 v[136:139], v[220:223], v[92:95], v[136:139]
v_mfma_f32_16x16x32_bf16 v[140:143], v[216:219], v[120:123], v[140:143]
ds_read_b128 v[216:219], v230 offset:6144
v_mfma_f32_16x16x32_bf16 v[140:143], v[220:223], v[124:127], v[140:143]
ds_read_b128 v[220:223], v230 offset:6656
s_waitcnt lgkmcnt(2)
v_mfma_f32_16x16x32_bf16 v[144:147], v[208:211], v[0:3], v[192:195]
v_mfma_f32_16x16x32_bf16 v[144:147], v[212:215], v[4:7], v[144:147]
v_mfma_f32_16x16x32_bf16 v[148:151], v[208:211], v[32:35], v[196:199]
v_mfma_f32_16x16x32_bf16 v[148:151], v[212:215], v[36:39], v[148:151]
v_mfma_f32_16x16x32_bf16 v[152:155], v[208:211], v[64:67], v[200:203]
v_exp_f32 v232, v128
v_mfma_f32_16x16x32_bf16 v[152:155], v[212:215], v[68:71], v[152:155]
v_exp_f32 v233, v129
v_mfma_f32_16x16x32_bf16 v[156:159], v[208:211], v[96:99], v[204:207]
ds_read_b128 v[208:211], v230 offset:10240
v_exp_f32 v234, v130
v_mfma_f32_16x16x32_bf16 v[156:159], v[212:215], v[100:103], v[156:159]
ds_read_b128 v[212:215], v230 offset:10752
s_waitcnt lgkmcnt(2)
v_add_f32 v224, v224, v232
v_mfma_f32_16x16x32_bf16 v[144:147], v[216:219], v[8:11], v[144:147]
v_cvt_pk_bf16_f32 v0, v232, v233
v_exp_f32 v235, v131
v_mfma_f32_16x16x32_bf16 v[144:147], v[220:223], v[12:15], v[144:147]
ds_read_b128 v[4:7], v231 offset:0
v_add_f32 v224, v224, v233
v_add_f32 v224, v224, v234
v_mfma_f32_16x16x32_bf16 v[148:151], v[216:219], v[40:43], v[148:151]
ds_read_b128 v[36:39], v231 offset:1024
v_add_f32 v224, v224, v235
v_cvt_pk_bf16_f32 v1, v234, v235
v_mfma_f32_16x16x32_bf16 v[148:151], v[220:223], v[44:47], v[148:151]
v_exp_f32 v236, v132
v_mfma_f32_16x16x32_bf16 v[152:155], v[216:219], v[72:75], v[152:155]
v_exp_f32 v237, v133
v_mfma_f32_16x16x32_bf16 v[152:155], v[220:223], v[76:79], v[152:155]
ds_read_b128 v[68:71], v231 offset:2048
ds_read_b128 v[8:11], v231 offset:4096
v_mfma_f32_16x16x32_bf16 v[156:159], v[216:219], v[104:107], v[156:159]
ds_read_b128 v[216:219], v230 offset:14336
v_add_u32 v12, 0x8000, v246
v_and_b32 v12, 0x1ffff, v12
ds_read_b128 v[100:103], v231 offset:3072
ds_read_b128 v[40:43], v231 offset:5120
v_mfma_f32_16x16x32_bf16 v[156:159], v[220:223], v[108:111], v[156:159]
ds_read_b128 v[220:223], v230 offset:14848
s_waitcnt lgkmcnt(2)
v_add_u32 v14, 0x10000, v246
v_and_b32 v14, 0x1ffff, v14
v_mfma_f32_16x16x32_bf16 v[144:147], v[208:211], v[16:19], v[144:147]
v_xor_b32 v13, 32, v12
v_xor_b32 v15, 32, v14
v_mfma_f32_16x16x32_bf16 v[144:147], v[212:215], v[20:23], v[144:147]
ds_read_b128 v[72:75], v231 offset:6144
v_exp_f32 v238, v134
v_mfma_f32_16x16x32_bf16 v[148:151], v[208:211], v[48:51], v[148:151]
ds_read_b128 v[104:107], v231 offset:7168
v_add_f32 v225, v225, v236
v_cvt_pk_bf16_f32 v32, v236, v237
v_mfma_f32_16x16x32_bf16 v[148:151], v[212:215], v[52:55], v[148:151]
v_exp_f32 v239, v135
v_add_f32 v225, v225, v237
v_mfma_f32_16x16x32_bf16 v[152:155], v[208:211], v[80:83], v[152:155]
v_add_f32 v225, v225, v238
v_add_f32 v225, v225, v239
v_cvt_pk_bf16_f32 v33, v238, v239
v_mfma_f32_16x16x32_bf16 v[152:155], v[212:215], v[84:87], v[152:155]
v_exp_f32 v232, v136
v_mfma_f32_16x16x32_bf16 v[156:159], v[208:211], v[112:115], v[156:159]
ds_read_b64_tr_b16 v[208:209], v246 offset:16384
ds_read_b64_tr_b16 v[210:211], v246 offset:18432
v_mfma_f32_16x16x32_bf16 v[156:159], v[212:215], v[116:119], v[156:159]
ds_read_b64_tr_b16 v[212:213], v12 offset:0
s_waitcnt lgkmcnt(3)
v_mfma_f32_16x16x32_bf16 v[144:147], v[216:219], v[24:27], v[144:147]
ds_read_b64_tr_b16 v[214:215], v12 offset:2048
v_exp_f32 v233, v137
v_mfma_f32_16x16x32_bf16 v[144:147], v[220:223], v[28:31], v[144:147]
v_exp_f32 v234, v138
v_add_f32 v226, v226, v232
v_mfma_f32_16x16x32_bf16 v[148:151], v[216:219], v[56:59], v[148:151]
v_cvt_pk_bf16_f32 v64, v232, v233
v_exp_f32 v235, v139
v_mfma_f32_16x16x32_bf16 v[148:151], v[220:223], v[60:63], v[148:151]
v_add_f32 v226, v226, v233
v_add_f32 v226, v226, v234
v_add_f32 v226, v226, v235
v_mfma_f32_16x16x32_bf16 v[152:155], v[216:219], v[88:91], v[152:155]
v_cvt_pk_bf16_f32 v65, v234, v235
v_exp_f32 v236, v140
v_mfma_f32_16x16x32_bf16 v[152:155], v[220:223], v[92:95], v[152:155]
v_exp_f32 v237, v141
s_waitcnt vmcnt(0)
v_mfma_f32_16x16x32_bf16 v[156:159], v[216:219], v[120:123], v[156:159]
ds_read_b64_tr_b16 v[216:217], v12 offset:16384
ds_read_b64_tr_b16 v[218:219], v12 offset:18432
v_cmp_ne_u64_e64 s[38:39], s[98:99], v[240:241]
v_mfma_f32_16x16x32_bf16 v[156:159], v[220:223], v[124:127], v[156:159]
ds_read_b64_tr_b16 v[220:221], v247 offset:16384
s_waitcnt lgkmcnt(3)
v_exp_f32 v238, v142
v_add_f32 v227, v227, v236
v_cvt_pk_bf16_f32 v96, v236, v237
v_exp_f32 v239, v143
v_add_f32 v227, v227, v237
v_add_f32 v227, v227, v238
v_add_f32 v227, v227, v239
v_cvt_pk_bf16_f32 v97, v238, v239
v_max3_f32 v242, v224, v225, v226
v_max_f32 v242, v242, v227
v_cmp_lt_f32 vcc, s32, v242
s_cbranch_vccnz L2_rare_site16
L2_ret16:
v_mfma_f32_16x16x32_bf16 a[0:3], v[8:11], v[208:211], a[0:3]
ds_read_b64_tr_b16 v[222:223], v247 offset:18432
s_and_b64 s[38:39], s[38:39], s[96:97]
s_cbranch_scc1 LF_hl_0
LF_hlret_0:
v_mfma_f32_16x16x32_bf16 a[0:3], v[160:163], v[212:215], a[0:3]
v_exp_f32 v232, v144
v_lshrrev_b32 v241, 4, v243
v_mfma_f32_16x16x32_bf16 a[4:7], v[40:43], v[208:211], a[4:7]
v_exp_f32 v233, v145
v_and_b32 v241, 0x30, v241
v_mfma_f32_16x16x32_bf16 a[4:7], v[164:167], v[212:215], a[4:7]
v_exp_f32 v234, v146
v_xor_b32 v241, v241, v243
v_mfma_f32_16x16x32_bf16 a[8:11], v[72:75], v[208:211], a[8:11]
v_add_f32 v224, v224, v232
v_cvt_pk_bf16_f32 v2, v232, v233
v_mfma_f32_16x16x32_bf16 a[8:11], v[168:171], v[212:215], a[8:11]
v_exp_f32 v235, v147
v_mfma_f32_16x16x32_bf16 a[12:15], v[104:107], v[208:211], a[12:15]
ds_read_b64_tr_b16 v[208:209], v13 offset:0
ds_read_b64_tr_b16 v[210:211], v13 offset:2048
v_mfma_f32_16x16x32_bf16 a[12:15], v[172:175], v[212:215], a[12:15]
ds_read_b64_tr_b16 v[212:213], v13 offset:16384
s_waitcnt lgkmcnt(5)
v_mfma_f32_16x16x32_bf16 a[0:3], v[176:179], v[216:219], a[0:3]
ds_read_b64_tr_b16 v[214:215], v13 offset:18432
v_add_f32 v224, v224, v233
v_mfma_f32_16x16x32_bf16 a[4:7], v[180:183], v[216:219], a[4:7]
v_add_f32 v224, v224, v234
v_add_f32 v224, v224, v235
v_mfma_f32_16x16x32_bf16 a[8:11], v[184:187], v[216:219], a[8:11]
v_cvt_pk_bf16_f32 v3, v234, v235
v_and_b32 v228, 0x380, v243
v_mad_u32_u24 v241, v228, 3, v241
v_mfma_f32_16x16x32_bf16 a[12:15], v[188:191], v[216:219], a[12:15]
ds_read_b64_tr_b16 v[216:217], v246 offset:16896
s_waitcnt lgkmcnt(5)
v_add_u32 v241, 0x7000000, v241
v_mfma_f32_16x16x32_bf16 a[16:19], v[8:11], v[220:223], a[16:19]
ds_read_b64_tr_b16 v[218:219], v246 offset:18944
v_and_b32 v110, 0x70, v243
v_lshlrev_b32 v110, 3, v110
v_mfma_f32_16x16x32_bf16 a[20:23], v[40:43], v[220:223], a[20:23]
v_exp_f32 v236, v148
v_add_u32 v110, 0x7c32000, v110
v_mfma_f32_16x16x32_bf16 a[24:27], v[72:75], v[220:223], a[24:27]
v_exp_f32 v237, v149
buffer_load_dwordx2 v[108:109], v110, s[16:19], 0 offen sc1
v_mfma_f32_16x16x32_bf16 a[28:31], v[104:107], v[220:223], a[28:31]
ds_read_b64_tr_b16 v[220:221], v12 offset:512
s_waitcnt lgkmcnt(3)
v_mfma_f32_16x16x32_bf16 a[16:19], v[160:163], v[208:211], a[16:19]
ds_read_b64_tr_b16 v[222:223], v12 offset:2560
s_add_u32 m0, s28, 0
v_mfma_f32_16x16x32_bf16 a[16:19], v[176:179], v[212:215], a[16:19]
v_exp_f32 v238, v150
v_mfma_f32_16x16x32_bf16 a[20:23], v[164:167], v[208:211], a[20:23]
v_add_f32 v225, v225, v236
v_cvt_pk_bf16_f32 v34, v236, v237
v_mfma_f32_16x16x32_bf16 a[20:23], v[180:183], v[212:215], a[20:23]
v_exp_f32 v239, v151
v_mfma_f32_16x16x32_bf16 a[24:27], v[168:171], v[208:211], a[24:27]
v_add_f32 v225, v225, v237
v_add_f32 v225, v225, v238
v_mfma_f32_16x16x32_bf16 a[24:27], v[184:187], v[212:215], a[24:27]
v_add_f32 v225, v225, v239
v_cvt_pk_bf16_f32 v35, v238, v239
v_mfma_f32_16x16x32_bf16 a[28:31], v[172:175], v[208:211], a[28:31]
ds_read_b64_tr_b16 v[208:209], v12 offset:16896
ds_read_b64_tr_b16 v[210:211], v12 offset:18944
v_mfma_f32_16x16x32_bf16 a[28:31], v[188:191], v[212:215], a[28:31]
ds_read_b64_tr_b16 v[212:213], v247 offset:16896
s_waitcnt lgkmcnt(3)
v_mfma_f32_16x16x32_bf16 a[32:35], v[8:11], v[216:219], a[32:35]
ds_read_b64_tr_b16 v[214:215], v247 offset:18944
buffer_load_dwordx4 v241, s[16:19], s6 offen sc1 lds
s_add_u32 m0, s28, 8192
v_mfma_f32_16x16x32_bf16 a[32:35], v[160:163], v[220:223], a[32:35]
v_exp_f32 v232, v152
v_mfma_f32_16x16x32_bf16 a[36:39], v[40:43], v[216:219], a[36:39]
v_exp_f32 v233, v153
v_mfma_f32_16x16x32_bf16 a[36:39], v[164:167], v[220:223], a[36:39]
v_exp_f32 v234, v154
v_mfma_f32_16x16x32_bf16 a[40:43], v[72:75], v[216:219], a[40:43]
v_add_f32 v226, v226, v232
v_cvt_pk_bf16_f32 v66, v232, v233
v_mfma_f32_16x16x32_bf16 a[40:43], v[168:171], v[220:223], a[40:43]
v_exp_f32 v235, v155
v_mfma_f32_16x16x32_bf16 a[44:47], v[104:107], v[216:219], a[44:47]
ds_read_b64_tr_b16 v[216:217], v13 offset:512
ds_read_b64_tr_b16 v[218:219], v13 offset:2560
v_mfma_f32_16x16x32_bf16 a[44:47], v[172:175], v[220:223], a[44:47]
ds_read_b64_tr_b16 v[220:221], v13 offset:16896
s_waitcnt lgkmcnt(5)
v_mfma_f32_16x16x32_bf16 a[32:35], v[176:179], v[208:211], a[32:35]
ds_read_b64_tr_b16 v[222:223], v13 offset:18944
v_add_f32 v226, v226, v233
v_mfma_f32_16x16x32_bf16 a[36:39], v[180:183], v[208:211], a[36:39]
v_add_f32 v226, v226, v234
v_add_f32 v226, v226, v235
v_mfma_f32_16x16x32_bf16 a[40:43], v[184:187], v[208:211], a[40:43]
v_cvt_pk_bf16_f32 v67, v234, v235
buffer_load_dwordx4 v241, s[16:19], s7 offen sc1 lds
s_add_u32 m0, s30, 0
v_mfma_f32_16x16x32_bf16 a[44:47], v[188:191], v[208:211], a[44:47]
ds_read_b64_tr_b16 v[208:209], v14 offset:0
s_waitcnt lgkmcnt(5)
v_mfma_f32_16x16x32_bf16 a[48:51], v[8:11], v[212:215], a[48:51]
ds_read_b64_tr_b16 v[210:211], v14 offset:2048
buffer_load_dwordx4 v241, s[16:19], s29 offen sc1 lds
s_add_u32 m0, s28, 4096
v_mfma_f32_16x16x32_bf16 a[52:55], v[40:43], v[212:215], a[52:55]
v_exp_f32 v236, v156
v_xor_b32 v241, 0x1040, v241
v_mfma_f32_16x16x32_bf16 a[56:59], v[72:75], v[212:215], a[56:59]
v_exp_f32 v237, v157
v_mfma_f32_16x16x32_bf16 a[60:63], v[104:107], v[212:215], a[60:63]
ds_read_b64_tr_b16 v[212:213], v15 offset:0
s_waitcnt lgkmcnt(3)
v_mfma_f32_16x16x32_bf16 a[48:51], v[160:163], v[216:219], a[48:51]
ds_read_b64_tr_b16 v[214:215], v15 offset:2048
buffer_load_dwordx4 v241, s[16:19], s6 offen sc1 lds
s_add_u32 m0, s28, 12288
v_mfma_f32_16x16x32_bf16 a[48:51], v[176:179], v[220:223], a[48:51]
v_exp_f32 v238, v158
v_mfma_f32_16x16x32_bf16 a[52:55], v[164:167], v[216:219], a[52:55]
v_add_f32 v227, v227, v236
v_cvt_pk_bf16_f32 v98, v236, v237
v_mfma_f32_16x16x32_bf16 a[52:55], v[180:183], v[220:223], a[52:55]
v_exp_f32 v239, v159
v_mfma_f32_16x16x32_bf16 a[56:59], v[168:171], v[216:219], a[56:59]
v_add_f32 v227, v227, v237
v_add_f32 v227, v227, v238
v_mfma_f32_16x16x32_bf16 a[56:59], v[184:187], v[220:223], a[56:59]
v_add_f32 v227, v227, v239
v_cvt_pk_bf16_f32 v99, v238, v239
v_mfma_f32_16x16x32_bf16 a[60:63], v[172:175], v[216:219], a[60:63]
ds_read_b64_tr_b16 v[216:217], v14 offset:512
ds_read_b64_tr_b16 v[218:219], v14 offset:2560
v_max3_f32 v242, v224, v225, v226
v_max_f32 v242, v242, v227
v_cmp_lt_f32 vcc, s32, v242
s_cbranch_vccnz L2_rare_site17
L2_ret17:
v_mfma_f32_16x16x32_bf16 a[60:63], v[188:191], v[220:223], a[60:63]
ds_read_b64_tr_b16 v[220:221], v15 offset:512
s_waitcnt lgkmcnt(5)
v_mfma_f32_16x16x32_bf16 a[0:3], v[0:3], v[208:211], a[0:3]
ds_read_b64_tr_b16 v[222:223], v15 offset:2560
buffer_load_dwordx4 v241, s[16:19], s7 offen sc1 lds
s_add_u32 m0, s30, 4096
v_mfma_f32_16x16x32_bf16 a[4:7], v[32:35], v[208:211], a[4:7]
buffer_load_dwordx4 v241, s[16:19], s29 offen sc1 lds
v_bfe_u32 v242, v243, 8, 1
v_mfma_f32_16x16x32_bf16 a[8:11], v[64:67], v[208:211], a[8:11]
v_mul_u32_u24 v242, 48, v242
v_lshl_add_u32 v242, s37, 3, v242
v_and_b32 v228, 0xf0, v243
v_mfma_f32_16x16x32_bf16 a[12:15], v[96:99], v[208:211], a[12:15]
ds_read_b64_tr_b16 v[208:209], v246 offset:20480
s_waitcnt lgkmcnt(5)
v_lshl_add_u32 v242, v228, 3, v242
v_mfma_f32_16x16x32_bf16 a[16:19], v[0:3], v[212:215], a[16:19]
ds_read_b64_tr_b16 v[210:211], v246 offset:22528
v_mov_b32 v232, v224
v_mov_b32 v234, v225
v_mfma_f32_16x16x32_bf16 a[20:23], v[32:35], v[212:215], a[20:23]
v_mov_b32 v236, v226
v_mov_b32 v238, v227
v_permlane32_swap_b32 v224, v232
v_mfma_f32_16x16x32_bf16 a[24:27], v[64:67], v[212:215], a[24:27]
v_permlane32_swap_b32 v225, v234
v_permlane32_swap_b32 v226, v236
v_permlane32_swap_b32 v227, v238
v_mfma_f32_16x16x32_bf16 a[28:31], v[96:99], v[212:215], a[28:31]
ds_read_b64_tr_b16 v[212:213], v12 offset:4096
s_waitcnt lgkmcnt(5)
v_add_f32 v224, v224, v232
v_mfma_f32_16x16x32_bf16 a[32:35], v[0:3], v[216:219], a[32:35]
ds_read_b64_tr_b16 v[214:215], v12 offset:6144
v_add_f32 v225, v225, v234
v_add_f32 v226, v226, v236
v_mfma_f32_16x16x32_bf16 a[36:39], v[32:35], v[216:219], a[36:39]
v_add_f32 v227, v227, v238
v_mov_b32 v232, v224
v_mov_b32 v234, v225
v_mfma_f32_16x16x32_bf16 a[40:43], v[64:67], v[216:219], a[40:43]
v_mov_b32 v236, v226
v_mov_b32 v238, v227
v_permlane16_swap_b32 v224, v232
v_mfma_f32_16x16x32_bf16 a[44:47], v[96:99], v[216:219], a[44:47]
ds_read_b64_tr_b16 v[216:217], v12 offset:20480
s_waitcnt lgkmcnt(5)
v_permlane16_swap_b32 v225, v234
v_mfma_f32_16x16x32_bf16 a[48:51], v[0:3], v[220:223], a[48:51]
ds_read_b64_tr_b16 v[218:219], v12 offset:22528
v_permlane16_swap_b32 v226, v236
v_permlane16_swap_b32 v227, v238
v_mfma_f32_16x16x32_bf16 a[52:55], v[32:35], v[220:223], a[52:55]
v_add_f32 v233, v224, v232
v_add_f32 v235, v225, v234
v_add_f32 v237, v226, v236
v_mfma_f32_16x16x32_bf16 a[56:59], v[64:67], v[220:223], a[56:59]
v_add_f32 v239, v227, v238
v_sub_f32 v232, 0, v192
v_sub_f32 v234, 0, v196
v_mfma_f32_16x16x32_bf16 a[60:63], v[96:99], v[220:223], a[60:63]
ds_read_b64_tr_b16 v[220:221], v14 offset:4096
s_waitcnt lgkmcnt(3)
v_sub_f32 v236, 0, v200
v_mfma_f32_16x16x32_bf16 a[64:67], v[8:11], v[208:211], a[64:67]
ds_read_b64_tr_b16 v[222:223], v14 offset:6144
v_sub_f32 v238, 0, v204
v_mfma_f32_16x16x32_bf16 a[64:67], v[160:163], v[212:215], a[64:67]
s_mov_b32 exec_hi, 0
buffer_store_dwordx2 v[232:233], v242, s[24:27], s48 offen sc1
s_lshr_b32 s3, s41, 2
buffer_store_dwordx2 v[234:235], v242, s[24:27], s3 offen sc1
s_lshr_b32 s3, s42, 2
buffer_store_dwordx2 v[236:237], v242, s[24:27], s3 offen sc1
s_lshr_b32 s3, s43, 2
buffer_store_dwordx2 v[238:239], v242, s[24:27], s3 offen sc1
s_mov_b32 exec_hi, -1
v_mfma_f32_16x16x32_bf16 a[68:71], v[40:43], v[208:211], a[68:71]
v_accvgpr_read_b32 v128, a0
v_accvgpr_read_b32 v129, a1
v_accvgpr_read_b32 v130, a2
v_mfma_f32_16x16x32_bf16 a[68:71], v[164:167], v[212:215], a[68:71]
v_accvgpr_read_b32 v131, a3
v_cvt_pk_bf16_f32 v16, v128, v129
v_cvt_pk_bf16_f32 v17, v130, v131
v_mfma_f32_16x16x32_bf16 a[72:75], v[72:75], v[208:211], a[72:75]
v_accvgpr_read_b32 v136, a4
v_accvgpr_read_b32 v137, a5
v_accvgpr_read_b32 v138, a6
v_mfma_f32_16x16x32_bf16 a[72:75], v[168:171], v[212:215], a[72:75]
v_accvgpr_read_b32 v139, a7
v_cvt_pk_bf16_f32 v48, v136, v137
v_cvt_pk_bf16_f32 v49, v138, v139
v_mfma_f32_16x16x32_bf16 a[76:79], v[104:107], v[208:211], a[76:79]
ds_read_b64_tr_b16 v[208:209], v247 offset:20480
ds_read_b64_tr_b16 v[210:211], v247 offset:22528
v_accvgpr_read_b32 v144, a8
v_mfma_f32_16x16x32_bf16 a[76:79], v[172:175], v[212:215], a[76:79]
ds_read_b64_tr_b16 v[212:213], v13 offset:4096
s_waitcnt lgkmcnt(3)
v_accvgpr_read_b32 v145, a9
v_mfma_f32_16x16x32_bf16 a[64:67], v[176:179], v[216:219], a[64:67]
ds_read_b64_tr_b16 v[214:215], v13 offset:6144
v_accvgpr_read_b32 v146, a10
v_accvgpr_read_b32 v147, a11
v_mfma_f32_16x16x32_bf16 a[64:67], v[0:3], v[220:223], a[64:67]
v_cvt_pk_bf16_f32 v80, v144, v145
v_cvt_pk_bf16_f32 v81, v146, v147
v_accvgpr_read_b32 v152, a12
v_mfma_f32_16x16x32_bf16 a[68:71], v[180:183], v[216:219], a[68:71]
v_accvgpr_read_b32 v153, a13
v_accvgpr_read_b32 v154, a14
v_accvgpr_read_b32 v155, a15
v_mfma_f32_16x16x32_bf16 a[68:71], v[32:35], v[220:223], a[68:71]
v_cvt_pk_bf16_f32 v112, v152, v153
v_cvt_pk_bf16_f32 v113, v154, v155
v_accvgpr_read_b32 v132, a16
v_mfma_f32_16x16x32_bf16 a[72:75], v[184:187], v[216:219], a[72:75]
v_accvgpr_read_b32 v133, a17
v_accvgpr_read_b32 v134, a18
v_accvgpr_read_b32 v135, a19
v_mfma_f32_16x16x32_bf16 a[72:75], v[64:67], v[220:223], a[72:75]
v_cvt_pk_bf16_f32 v18, v132, v133
v_cvt_pk_bf16_f32 v19, v134, v135
buffer_store_dwordx4 v[16:19], v243, s[20:23], s40 offen offset:0 sc1
v_mfma_f32_16x16x32_bf16 a[76:79], v[188:191], v[216:219], a[76:79]
ds_read_b64_tr_b16 v[216:217], v13 offset:20480
ds_read_b64_tr_b16 v[218:219], v13 offset:22528
ds_write_b128 v231, v[16:19] offset:0
v_mfma_f32_16x16x32_bf16 a[76:79], v[96:99], v[220:223], a[76:79]
ds_read_b64_tr_b16 v[220:221], v15 offset:4096
s_waitcnt lgkmcnt(3)
v_accvgpr_read_b32 v140, a20
v_mfma_f32_16x16x32_bf16 a[80:83], v[8:11], v[208:211], a[80:83]
ds_read_b64_tr_b16 v[222:223], v15 offset:6144
v_accvgpr_read_b32 v141, a21
v_accvgpr_read_b32 v142, a22
v_mfma_f32_16x16x32_bf16 a[80:83], v[160:163], v[212:215], a[80:83]
v_accvgpr_read_b32 v143, a23
v_cvt_pk_bf16_f32 v50, v140, v141
v_cvt_pk_bf16_f32 v51, v142, v143
v_mfma_f32_16x16x32_bf16 a[84:87], v[40:43], v[208:211], a[84:87]
buffer_store_dwordx4 v[48:51], v243, s[20:23], s41 offen offset:0 sc1
v_accvgpr_read_b32 v148, a24
v_accvgpr_read_b32 v149, a25
v_mfma_f32_16x16x32_bf16 a[84:87], v[164:167], v[212:215], a[84:87]
v_accvgpr_read_b32 v150, a26
v_accvgpr_read_b32 v151, a27
v_cvt_pk_bf16_f32 v82, v148, v149
v_mfma_f32_16x16x32_bf16 a[88:91], v[72:75], v[208:211], a[88:91]
v_cvt_pk_bf16_f32 v83, v150, v151
buffer_store_dwordx4 v[80:83], v243, s[20:23], s42 offen offset:0 sc1
v_accvgpr_read_b32 v156, a28
v_mfma_f32_16x16x32_bf16 a[88:91], v[168:171], v[212:215], a[88:91]
v_accvgpr_read_b32 v157, a29
v_accvgpr_read_b32 v158, a30
v_accvgpr_read_b32 v159, a31
v_mfma_f32_16x16x32_bf16 a[92:95], v[104:107], v[208:211], a[92:95]
ds_read_b64_tr_b16 v[208:209], v246 offset:20992
ds_read_b64_tr_b16 v[210:211], v246 offset:23040
v_cvt_pk_bf16_f32 v114, v156, v157
v_mfma_f32_16x16x32_bf16 a[92:95], v[172:175], v[212:215], a[92:95]
ds_read_b64_tr_b16 v[212:213], v12 offset:4608
s_waitcnt lgkmcnt(3)
v_cvt_pk_bf16_f32 v115, v158, v159
v_mfma_f32_16x16x32_bf16 a[80:83], v[176:179], v[216:219], a[80:83]
ds_read_b64_tr_b16 v[214:215], v12 offset:6656
buffer_store_dwordx4 v[112:115], v243, s[20:23], s43 offen offset:0 sc1
v_accvgpr_read_b32 v128, a32
v_mfma_f32_16x16x32_bf16 a[80:83], v[0:3], v[220:223], a[80:83]
v_accvgpr_read_b32 v129, a33
v_accvgpr_read_b32 v130, a34
v_accvgpr_read_b32 v131, a35
v_mfma_f32_16x16x32_bf16 a[84:87], v[180:183], v[216:219], a[84:87]
v_cvt_pk_bf16_f32 v20, v128, v129
v_cvt_pk_bf16_f32 v21, v130, v131
v_accvgpr_read_b32 v136, a36
v_mfma_f32_16x16x32_bf16 a[84:87], v[32:35], v[220:223], a[84:87]
v_accvgpr_read_b32 v137, a37
v_accvgpr_read_b32 v138, a38
v_accvgpr_read_b32 v139, a39
v_mfma_f32_16x16x32_bf16 a[88:91], v[184:187], v[216:219], a[88:91]
v_cvt_pk_bf16_f32 v52, v136, v137
v_cvt_pk_bf16_f32 v53, v138, v139
v_accvgpr_read_b32 v144, a40
v_mfma_f32_16x16x32_bf16 a[88:91], v[64:67], v[220:223], a[88:91]
v_accvgpr_read_b32 v145, a41
v_accvgpr_read_b32 v146, a42
v_accvgpr_read_b32 v147, a43
v_mfma_f32_16x16x32_bf16 a[92:95], v[188:191], v[216:219], a[92:95]
ds_read_b64_tr_b16 v[216:217], v12 offset:20992
ds_read_b64_tr_b16 v[218:219], v12 offset:23040
v_cvt_pk_bf16_f32 v84, v144, v145
v_mfma_f32_16x16x32_bf16 a[92:95], v[96:99], v[220:223], a[92:95]
ds_read_b64_tr_b16 v[220:221], v14 offset:4608
s_waitcnt lgkmcnt(3)
v_cvt_pk_bf16_f32 v85, v146, v147
v_mfma_f32_16x16x32_bf16 a[96:99], v[8:11], v[208:211], a[96:99]
ds_read_b64_tr_b16 v[222:223], v14 offset:6656
v_accvgpr_read_b32 v152, a44
v_accvgpr_read_b32 v153, a45
v_mfma_f32_16x16x32_bf16 a[96:99], v[160:163], v[212:215], a[96:99]
v_accvgpr_read_b32 v154, a46
v_accvgpr_read_b32 v155, a47
v_cvt_pk_bf16_f32 v116, v152, v153
v_mfma_f32_16x16x32_bf16 a[100:103], v[40:43], v[208:211], a[100:103]
v_cvt_pk_bf16_f32 v117, v154, v155
v_accvgpr_read_b32 v132, a48
v_accvgpr_read_b32 v133, a49
v_mfma_f32_16x16x32_bf16 a[100:103], v[164:167], v[212:215], a[100:103]
v_accvgpr_read_b32 v134, a50
v_accvgpr_read_b32 v135, a51
v_cvt_pk_bf16_f32 v22, v132, v133
v_mfma_f32_16x16x32_bf16 a[104:107], v[72:75], v[208:211], a[104:107]
v_cvt_pk_bf16_f32 v23, v134, v135
buffer_store_dwordx4 v[20:23], v243, s[20:23], s40 offen offset:1024 sc1
ds_write_b128 v231, v[20:23] offset:1024
v_mfma_f32_16x16x32_bf16 a[104:107], v[168:171], v[212:215], a[104:107]
v_accvgpr_read_b32 v140, a52
v_accvgpr_read_b32 v141, a53
v_accvgpr_read_b32 v142, a54
v_mfma_f32_16x16x32_bf16 a[108:111], v[104:107], v[208:211], a[108:111]
ds_read_b64_tr_b16 v[208:209], v247 offset:20992
ds_read_b64_tr_b16 v[210:211], v247 offset:23040
v_accvgpr_read_b32 v143, a55
v_mfma_f32_16x16x32_bf16 a[108:111], v[172:175], v[212:215], a[108:111]
ds_read_b64_tr_b16 v[212:213], v13 offset:4608
s_waitcnt lgkmcnt(3)
v_cvt_pk_bf16_f32 v54, v140, v141
v_mfma_f32_16x16x32_bf16 a[96:99], v[176:179], v[216:219], a[96:99]
ds_read_b64_tr_b16 v[214:215], v13 offset:6656
v_cvt_pk_bf16_f32 v55, v142, v143
buffer_store_dwordx4 v[52:55], v243, s[20:23], s41 offen offset:1024 sc1
v_mfma_f32_16x16x32_bf16 a[96:99], v[0:3], v[220:223], a[96:99]
v_accvgpr_read_b32 v148, a56
v_accvgpr_read_b32 v149, a57
v_accvgpr_read_b32 v150, a58
v_mfma_f32_16x16x32_bf16 a[100:103], v[180:183], v[216:219], a[100:103]
v_accvgpr_read_b32 v151, a59
v_cvt_pk_bf16_f32 v86, v148, v149
v_cvt_pk_bf16_f32 v87, v150, v151
v_mfma_f32_16x16x32_bf16 a[100:103], v[32:35], v[220:223], a[100:103]
buffer_store_dwordx4 v[84:87], v243, s[20:23], s42 offen offset:1024 sc1
v_accvgpr_read_b32 v156, a60
v_accvgpr_read_b32 v157, a61
v_mfma_f32_16x16x32_bf16 a[104:107], v[184:187], v[216:219], a[104:107]
v_accvgpr_read_b32 v158, a62
v_accvgpr_read_b32 v159, a63
v_cvt_pk_bf16_f32 v118, v156, v157
v_mfma_f32_16x16x32_bf16 a[104:107], v[64:67], v[220:223], a[104:107]
v_cvt_pk_bf16_f32 v119, v158, v159
buffer_store_dwordx4 v[116:119], v243, s[20:23], s43 offen offset:1024 sc1
v_accvgpr_read_b32 v128, a64
v_mfma_f32_16x16x32_bf16 a[108:111], v[188:191], v[216:219], a[108:111]
ds_read_b64_tr_b16 v[216:217], v13 offset:20992
ds_read_b64_tr_b16 v[218:219], v13 offset:23040
v_accvgpr_read_b32 v129, a65
v_mfma_f32_16x16x32_bf16 a[108:111], v[96:99], v[220:223], a[108:111]
ds_read_b64_tr_b16 v[220:221], v15 offset:4608
s_waitcnt lgkmcnt(3)
v_accvgpr_read_b32 v130, a66
v_mfma_f32_16x16x32_bf16 a[112:115], v[8:11], v[208:211], a[112:115]
ds_read_b64_tr_b16 v[222:223], v15 offset:6656
v_accvgpr_read_b32 v131, a67
v_cvt_pk_bf16_f32 v24, v128, v129
v_mfma_f32_16x16x32_bf16 a[112:115], v[160:163], v[212:215], a[112:115]
v_cvt_pk_bf16_f32 v25, v130, v131
v_accvgpr_read_b32 v136, a68
v_accvgpr_read_b32 v137, a69
v_mfma_f32_16x16x32_bf16 a[116:119], v[40:43], v[208:211], a[116:119]
v_accvgpr_read_b32 v138, a70
v_accvgpr_read_b32 v139, a71
v_cvt_pk_bf16_f32 v56, v136, v137
v_mfma_f32_16x16x32_bf16 a[116:119], v[164:167], v[212:215], a[116:119]
v_cvt_pk_bf16_f32 v57, v138, v139
v_accvgpr_read_b32 v144, a72
v_accvgpr_read_b32 v145, a73
v_mfma_f32_16x16x32_bf16 a[120:123], v[72:75], v[208:211], a[120:123]
v_accvgpr_read_b32 v146, a74
v_accvgpr_read_b32 v147, a75
v_cvt_pk_bf16_f32 v88, v144, v145
v_mfma_f32_16x16x32_bf16 a[120:123], v[168:171], v[212:215], a[120:123]
v_cvt_pk_bf16_f32 v89, v146, v147
v_accvgpr_read_b32 v152, a76
v_accvgpr_read_b32 v153, a77
v_mfma_f32_16x16x32_bf16 a[124:127], v[104:107], v[208:211], a[124:127]
ds_read_b64_tr_b16 v[208:209], v246 offset:8192
ds_read_b64_tr_b16 v[210:211], v246 offset:10240
v_accvgpr_read_b32 v154, a78
v_mfma_f32_16x16x32_bf16 a[124:127], v[172:175], v[212:215], a[124:127]
ds_read_b64_tr_b16 v[212:213], v246 offset:24576
s_waitcnt lgkmcnt(3)
v_accvgpr_read_b32 v155, a79
v_mfma_f32_16x16x32_bf16 a[112:115], v[176:179], v[216:219], a[112:115]
ds_read_b64_tr_b16 v[214:215], v246 offset:26624
v_cvt_pk_bf16_f32 v120, v152, v153
v_cvt_pk_bf16_f32 v121, v154, v155
v_mfma_f32_16x16x32_bf16 a[112:115], v[0:3], v[220:223], a[112:115]
v_accvgpr_read_b32 v132, a80
v_accvgpr_read_b32 v133, a81
v_accvgpr_read_b32 v134, a82
v_mfma_f32_16x16x32_bf16 a[116:119], v[180:183], v[216:219], a[116:119]
v_accvgpr_read_b32 v135, a83
v_cvt_pk_bf16_f32 v26, v132, v133
v_cvt_pk_bf16_f32 v27, v134, v135
v_mfma_f32_16x16x32_bf16 a[116:119], v[32:35], v[220:223], a[116:119]
buffer_store_dwordx4 v[24:27], v243, s[20:23], s40 offen offset:2048 sc1
ds_write_b128 v231, v[24:27] offset:2048
v_accvgpr_read_b32 v140, a84
v_mfma_f32_16x16x32_bf16 a[120:123], v[184:187], v[216:219], a[120:123]
v_accvgpr_read_b32 v141, a85
v_accvgpr_read_b32 v142, a86
v_accvgpr_read_b32 v143, a87
v_mfma_f32_16x16x32_bf16 a[120:123], v[64:67], v[220:223], a[120:123]
v_cvt_pk_bf16_f32 v58, v140, v141
v_cvt_pk_bf16_f32 v59, v142, v143
buffer_store_dwordx4 v[56:59], v243, s[20:23], s41 offen offset:2048 sc1
v_mfma_f32_16x16x32_bf16 a[124:127], v[188:191], v[216:219], a[124:127]
ds_read_b64_tr_b16 v[216:217], v12 offset:8192
ds_read_b64_tr_b16 v[218:219], v12 offset:10240
v_accvgpr_read_b32 v148, a88
v_mfma_f32_16x16x32_bf16 a[124:127], v[96:99], v[220:223], a[124:127]
ds_read_b64_tr_b16 v[220:221], v12 offset:24576
s_waitcnt lgkmcnt(3)
v_accvgpr_read_b32 v149, a89
v_mfma_f32_16x16x32_bf16 a[128:131], v[4:7], v[208:211], a[128:131]
ds_read_b64_tr_b16 v[222:223], v12 offset:26624
v_accvgpr_read_b32 v150, a90
v_accvgpr_read_b32 v151, a91
v_mfma_f32_16x16x32_bf16 a[128:131], v[8:11], v[212:215], a[128:131]
v_cvt_pk_bf16_f32 v90, v148, v149
v_cvt_pk_bf16_f32 v91, v150, v151
buffer_store_dwordx4 v[88:91], v243, s[20:23], s42 offen offset:2048 sc1
v_mfma_f32_16x16x32_bf16 a[132:135], v[36:39], v[208:211], a[132:135]
v_accvgpr_read_b32 v156, a92
v_accvgpr_read_b32 v157, a93
v_accvgpr_read_b32 v158, a94
v_mfma_f32_16x16x32_bf16 a[132:135], v[40:43], v[212:215], a[132:135]
v_accvgpr_read_b32 v159, a95
v_cvt_pk_bf16_f32 v122, v156, v157
v_cvt_pk_bf16_f32 v123, v158, v159
v_mfma_f32_16x16x32_bf16 a[136:139], v[68:71], v[208:211], a[136:139]
buffer_store_dwordx4 v[120:123], v243, s[20:23], s43 offen offset:2048 sc1
v_accvgpr_read_b32 v128, a96
v_mfma_f32_16x16x32_bf16 a[136:139], v[72:75], v[212:215], a[136:139]
v_accvgpr_read_b32 v129, a97
v_accvgpr_read_b32 v130, a98
v_mfma_f32_16x16x32_bf16 a[140:143], v[100:103], v[208:211], a[140:143]
ds_read_b64_tr_b16 v[208:209], v14 offset:8192
ds_read_b64_tr_b16 v[210:211], v14 offset:10240
v_mfma_f32_16x16x32_bf16 a[140:143], v[104:107], v[212:215], a[140:143]
ds_read_b64_tr_b16 v[212:213], v247 offset:8192
s_waitcnt lgkmcnt(3)
v_mfma_f32_16x16x32_bf16 a[128:131], v[160:163], v[216:219], a[128:131]
ds_read_b64_tr_b16 v[214:215], v247 offset:10240
v_accvgpr_read_b32 v131, a99
v_mfma_f32_16x16x32_bf16 a[128:131], v[176:179], v[220:223], a[128:131]
v_cvt_pk_bf16_f32 v28, v128, v129
v_cvt_pk_bf16_f32 v29, v130, v131
v_mfma_f32_16x16x32_bf16 a[132:135], v[164:167], v[216:219], a[132:135]
v_accvgpr_read_b32 v136, a100
v_accvgpr_read_b32 v137, a101
v_mfma_f32_16x16x32_bf16 a[132:135], v[180:183], v[220:223], a[132:135]
v_accvgpr_read_b32 v138, a102
v_accvgpr_read_b32 v139, a103
v_mfma_f32_16x16x32_bf16 a[136:139], v[168:171], v[216:219], a[136:139]
v_cvt_pk_bf16_f32 v60, v136, v137
v_cvt_pk_bf16_f32 v61, v138, v139
v_mfma_f32_16x16x32_bf16 a[136:139], v[184:187], v[220:223], a[136:139]
v_accvgpr_read_b32 v144, a104
v_accvgpr_read_b32 v145, a105
v_mfma_f32_16x16x32_bf16 a[140:143], v[172:175], v[216:219], a[140:143]
ds_read_b64_tr_b16 v[216:217], v247 offset:24576
ds_read_b64_tr_b16 v[218:219], v247 offset:26624
v_mfma_f32_16x16x32_bf16 a[140:143], v[188:191], v[220:223], a[140:143]
ds_read_b64_tr_b16 v[220:221], v13 offset:8192
s_waitcnt lgkmcnt(5)
v_mfma_f32_16x16x32_bf16 a[128:131], v[0:3], v[208:211], a[128:131]
ds_read_b64_tr_b16 v[222:223], v13 offset:10240
v_accvgpr_read_b32 v146, a106
v_mfma_f32_16x16x32_bf16 a[132:135], v[32:35], v[208:211], a[132:135]
v_accvgpr_read_b32 v147, a107
v_cvt_pk_bf16_f32 v92, v144, v145
v_mfma_f32_16x16x32_bf16 a[136:139], v[64:67], v[208:211], a[136:139]
v_cvt_pk_bf16_f32 v93, v146, v147
v_accvgpr_read_b32 v152, a108
v_mfma_f32_16x16x32_bf16 a[140:143], v[96:99], v[208:211], a[140:143]
ds_read_b64_tr_b16 v[208:209], v13 offset:24576
s_waitcnt lgkmcnt(5)
v_mfma_f32_16x16x32_bf16 a[144:147], v[4:7], v[212:215], a[144:147]
ds_read_b64_tr_b16 v[210:211], v13 offset:26624
v_accvgpr_read_b32 v153, a109
v_mfma_f32_16x16x32_bf16 a[148:151], v[36:39], v[212:215], a[148:151]
v_accvgpr_read_b32 v154, a110
v_accvgpr_read_b32 v155, a111
v_mfma_f32_16x16x32_bf16 a[152:155], v[68:71], v[212:215], a[152:155]
v_cvt_pk_bf16_f32 v124, v152, v153
v_cvt_pk_bf16_f32 v125, v154, v155
v_mfma_f32_16x16x32_bf16 a[156:159], v[100:103], v[212:215], a[156:159]
ds_read_b64_tr_b16 v[212:213], v15 offset:8192
s_waitcnt lgkmcnt(3)
v_mfma_f32_16x16x32_bf16 a[144:147], v[8:11], v[216:219], a[144:147]
ds_read_b64_tr_b16 v[214:215], v15 offset:10240
v_accvgpr_read_b32 v132, a112
v_mfma_f32_16x16x32_bf16 a[144:147], v[160:163], v[220:223], a[144:147]
v_accvgpr_read_b32 v133, a113
v_accvgpr_read_b32 v134, a114
v_mfma_f32_16x16x32_bf16 a[148:151], v[40:43], v[216:219], a[148:151]
v_accvgpr_read_b32 v135, a115
v_cvt_pk_bf16_f32 v30, v132, v133
v_mfma_f32_16x16x32_bf16 a[148:151], v[164:167], v[220:223], a[148:151]
v_cvt_pk_bf16_f32 v31, v134, v135
buffer_store_dwordx4 v[28:31], v243, s[20:23], s40 offen offset:3072 sc1
v_mfma_f32_16x16x32_bf16 a[152:155], v[72:75], v[216:219], a[152:155]
ds_write_b128 v231, v[28:31] offset:3072
v_accvgpr_read_b32 v140, a116
v_mfma_f32_16x16x32_bf16 a[152:155], v[168:171], v[220:223], a[152:155]
v_accvgpr_read_b32 v141, a117
v_accvgpr_read_b32 v142, a118
v_mfma_f32_16x16x32_bf16 a[156:159], v[104:107], v[216:219], a[156:159]
ds_read_b64_tr_b16 v[216:217], v246 offset:8704
ds_read_b64_tr_b16 v[218:219], v246 offset:10752
v_mfma_f32_16x16x32_bf16 a[156:159], v[172:175], v[220:223], a[156:159]
ds_read_b64_tr_b16 v[220:221], v246 offset:25088
s_waitcnt lgkmcnt(3)
v_mfma_f32_16x16x32_bf16 a[144:147], v[176:179], v[208:211], a[144:147]
ds_read_b64_tr_b16 v[222:223], v246 offset:27136
v_accvgpr_read_b32 v143, a119
v_mfma_f32_16x16x32_bf16 a[144:147], v[0:3], v[212:215], a[144:147]
v_cvt_pk_bf16_f32 v62, v140, v141
v_cvt_pk_bf16_f32 v63, v142, v143
v_mfma_f32_16x16x32_bf16 a[148:151], v[180:183], v[208:211], a[148:151]
buffer_store_dwordx4 v[60:63], v243, s[20:23], s41 offen offset:3072 sc1
v_accvgpr_read_b32 v148, a120
v_mfma_f32_16x16x32_bf16 a[148:151], v[32:35], v[212:215], a[148:151]
v_accvgpr_read_b32 v149, a121
v_accvgpr_read_b32 v150, a122
v_mfma_f32_16x16x32_bf16 a[152:155], v[184:187], v[208:211], a[152:155]
v_accvgpr_read_b32 v151, a123
v_cvt_pk_bf16_f32 v94, v148, v149
v_mfma_f32_16x16x32_bf16 a[152:155], v[64:67], v[212:215], a[152:155]
v_cvt_pk_bf16_f32 v95, v150, v151
buffer_store_dwordx4 v[92:95], v243, s[20:23], s42 offen offset:3072 sc1
v_mfma_f32_16x16x32_bf16 a[156:159], v[188:191], v[208:211], a[156:159]
ds_read_b64_tr_b16 v[208:209], v12 offset:8704
ds_read_b64_tr_b16 v[210:211], v12 offset:10752
v_mfma_f32_16x16x32_bf16 a[156:159], v[96:99], v[212:215], a[156:159]
ds_read_b64_tr_b16 v[212:213], v12 offset:25088
s_waitcnt lgkmcnt(3)
v_mfma_f32_16x16x32_bf16 a[160:163], v[4:7], v[216:219], a[160:163]
ds_read_b64_tr_b16 v[214:215], v12 offset:27136
v_accvgpr_read_b32 v156, a124
v_mfma_f32_16x16x32_bf16 a[160:163], v[8:11], v[220:223], a[160:163]
v_accvgpr_read_b32 v157, a125
v_accvgpr_read_b32 v158, a126
v_mfma_f32_16x16x32_bf16 a[164:167], v[36:39], v[216:219], a[164:167]
v_accvgpr_read_b32 v159, a127
v_cvt_pk_bf16_f32 v126, v156, v157
v_mfma_f32_16x16x32_bf16 a[164:167], v[40:43], v[220:223], a[164:167]
v_cvt_pk_bf16_f32 v127, v158, v159
buffer_store_dwordx4 v[124:127], v243, s[20:23], s43 offen offset:3072 sc1
v_mfma_f32_16x16x32_bf16 a[168:171], v[68:71], v[216:219], a[168:171]
v_accvgpr_read_b32 v128, a128
v_accvgpr_read_b32 v129, a129
v_mfma_f32_16x16x32_bf16 a[168:171], v[72:75], v[220:223], a[168:171]
v_accvgpr_read_b32 v130, a130
v_accvgpr_read_b32 v131, a131
v_mfma_f32_16x16x32_bf16 a[172:175], v[100:103], v[216:219], a[172:175]
ds_read_b64_tr_b16 v[216:217], v14 offset:8704
ds_read_b64_tr_b16 v[218:219], v14 offset:10752
v_mfma_f32_16x16x32_bf16 a[172:175], v[104:107], v[220:223], a[172:175]
ds_read_b64_tr_b16 v[220:221], v247 offset:8704
s_waitcnt lgkmcnt(3)
v_mfma_f32_16x16x32_bf16 a[160:163], v[160:163], v[208:211], a[160:163]
ds_read_b64_tr_b16 v[222:223], v247 offset:10752
v_cvt_pk_bf16_f32 v16, v128, v129
v_mfma_f32_16x16x32_bf16 a[160:163], v[176:179], v[212:215], a[160:163]
v_cvt_pk_bf16_f32 v17, v130, v131
v_accvgpr_read_b32 v136, a132
v_mfma_f32_16x16x32_bf16 a[164:167], v[164:167], v[208:211], a[164:167]
v_accvgpr_read_b32 v137, a133
v_accvgpr_read_b32 v138, a134
v_mfma_f32_16x16x32_bf16 a[164:167], v[180:183], v[212:215], a[164:167]
v_accvgpr_read_b32 v139, a135
v_cvt_pk_bf16_f32 v48, v136, v137
v_mfma_f32_16x16x32_bf16 a[168:171], v[168:171], v[208:211], a[168:171]
v_cvt_pk_bf16_f32 v49, v138, v139
v_accvgpr_read_b32 v144, a136
v_mfma_f32_16x16x32_bf16 a[168:171], v[184:187], v[212:215], a[168:171]
v_accvgpr_read_b32 v145, a137
v_accvgpr_read_b32 v146, a138
v_mfma_f32_16x16x32_bf16 a[172:175], v[172:175], v[208:211], a[172:175]
ds_read_b64_tr_b16 v[208:209], v247 offset:25088
ds_read_b64_tr_b16 v[210:211], v247 offset:27136
v_mfma_f32_16x16x32_bf16 a[172:175], v[188:191], v[212:215], a[172:175]
ds_read_b64_tr_b16 v[212:213], v13 offset:8704
s_waitcnt lgkmcnt(5)
v_mfma_f32_16x16x32_bf16 a[160:163], v[0:3], v[216:219], a[160:163]
ds_read_b64_tr_b16 v[214:215], v13 offset:10752
v_accvgpr_read_b32 v147, a139
v_mfma_f32_16x16x32_bf16 a[164:167], v[32:35], v[216:219], a[164:167]
v_cvt_pk_bf16_f32 v80, v144, v145
v_cvt_pk_bf16_f32 v81, v146, v147
v_mfma_f32_16x16x32_bf16 a[168:171], v[64:67], v[216:219], a[168:171]
v_accvgpr_read_b32 v152, a140
v_accvgpr_read_b32 v153, a141
v_mfma_f32_16x16x32_bf16 a[172:175], v[96:99], v[216:219], a[172:175]
ds_read_b64_tr_b16 v[216:217], v13 offset:25088
s_waitcnt lgkmcnt(5)
v_mfma_f32_16x16x32_bf16 a[176:179], v[4:7], v[220:223], a[176:179]
ds_read_b64_tr_b16 v[218:219], v13 offset:27136
v_accvgpr_read_b32 v154, a142
v_mfma_f32_16x16x32_bf16 a[180:183], v[36:39], v[220:223], a[180:183]
v_accvgpr_read_b32 v155, a143
v_cvt_pk_bf16_f32 v112, v152, v153
v_mfma_f32_16x16x32_bf16 a[184:187], v[68:71], v[220:223], a[184:187]
v_cvt_pk_bf16_f32 v113, v154, v155
v_accvgpr_read_b32 v132, a144
v_mfma_f32_16x16x32_bf16 a[188:191], v[100:103], v[220:223], a[188:191]
ds_read_b64_tr_b16 v[220:221], v15 offset:8704
s_waitcnt lgkmcnt(3)
v_mfma_f32_16x16x32_bf16 a[176:179], v[8:11], v[208:211], a[176:179]
ds_read_b64_tr_b16 v[222:223], v15 offset:10752
v_accvgpr_read_b32 v133, a145
v_mfma_f32_16x16x32_bf16 a[176:179], v[160:163], v[212:215], a[176:179]
v_accvgpr_read_b32 v134, a146
v_accvgpr_read_b32 v135, a147
v_mfma_f32_16x16x32_bf16 a[180:183], v[40:43], v[208:211], a[180:183]
v_cvt_pk_bf16_f32 v18, v132, v133
v_cvt_pk_bf16_f32 v19, v134, v135
v_mfma_f32_16x16x32_bf16 a[180:183], v[164:167], v[212:215], a[180:183]
buffer_store_dwordx4 v[16:19], v243, s[20:23], s44 offen offset:0 sc1
ds_write_b128 v231, v[16:19] offset:4096
v_mfma_f32_16x16x32_bf16 a[184:187], v[72:75], v[208:211], a[184:187]
v_accvgpr_read_b32 v140, a148
v_accvgpr_read_b32 v141, a149
v_mfma_f32_16x16x32_bf16 a[184:187], v[168:171], v[212:215], a[184:187]
v_accvgpr_read_b32 v142, a150
v_accvgpr_read_b32 v143, a151
v_mfma_f32_16x16x32_bf16 a[188:191], v[104:107], v[208:211], a[188:191]
ds_read_b64_tr_b16 v[208:209], v246 offset:12288
ds_read_b64_tr_b16 v[210:211], v246 offset:14336
v_mfma_f32_16x16x32_bf16 a[188:191], v[172:175], v[212:215], a[188:191]
ds_read_b64_tr_b16 v[212:213], v246 offset:28672
s_waitcnt lgkmcnt(3)
v_mfma_f32_16x16x32_bf16 a[176:179], v[176:179], v[216:219], a[176:179]
ds_read_b64_tr_b16 v[214:215], v246 offset:30720
v_cvt_pk_bf16_f32 v50, v140, v141
v_mfma_f32_16x16x32_bf16 a[176:179], v[0:3], v[220:223], a[176:179]
v_cvt_pk_bf16_f32 v51, v142, v143
buffer_store_dwordx4 v[48:51], v243, s[20:23], s45 offen offset:0 sc1
v_mfma_f32_16x16x32_bf16 a[180:183], v[180:183], v[216:219], a[180:183]
v_accvgpr_read_b32 v148, a152
v_accvgpr_read_b32 v149, a153
v_mfma_f32_16x16x32_bf16 a[180:183], v[32:35], v[220:223], a[180:183]
v_accvgpr_read_b32 v150, a154
v_accvgpr_read_b32 v151, a155
v_mfma_f32_16x16x32_bf16 a[184:187], v[184:187], v[216:219], a[184:187]
v_cvt_pk_bf16_f32 v82, v148, v149
v_cvt_pk_bf16_f32 v83, v150, v151
v_mfma_f32_16x16x32_bf16 a[184:187], v[64:67], v[220:223], a[184:187]
buffer_store_dwordx4 v[80:83], v243, s[20:23], s46 offen offset:0 sc1
v_accvgpr_read_b32 v156, a156
v_mfma_f32_16x16x32_bf16 a[188:191], v[188:191], v[216:219], a[188:191]
ds_read_b64_tr_b16 v[216:217], v12 offset:12288
ds_read_b64_tr_b16 v[218:219], v12 offset:14336
v_mfma_f32_16x16x32_bf16 a[188:191], v[96:99], v[220:223], a[188:191]
ds_read_b64_tr_b16 v[220:221], v12 offset:28672
s_waitcnt lgkmcnt(3)
v_mfma_f32_16x16x32_bf16 a[192:195], v[4:7], v[208:211], a[192:195]
ds_read_b64_tr_b16 v[222:223], v12 offset:30720
v_accvgpr_read_b32 v157, a157
v_mfma_f32_16x16x32_bf16 a[192:195], v[8:11], v[212:215], a[192:195]
v_accvgpr_read_b32 v158, a158
v_accvgpr_read_b32 v159, a159
v_mfma_f32_16x16x32_bf16 a[196:199], v[36:39], v[208:211], a[196:199]
v_cvt_pk_bf16_f32 v114, v156, v157
v_cvt_pk_bf16_f32 v115, v158, v159
v_mfma_f32_16x16x32_bf16 a[196:199], v[40:43], v[212:215], a[196:199]
buffer_store_dwordx4 v[112:115], v243, s[20:23], s47 offen offset:0 sc1
v_accvgpr_read_b32 v128, a160
v_mfma_f32_16x16x32_bf16 a[200:203], v[68:71], v[208:211], a[200:203]
v_accvgpr_read_b32 v129, a161
v_accvgpr_read_b32 v130, a162
v_mfma_f32_16x16x32_bf16 a[200:203], v[72:75], v[212:215], a[200:203]
v_accvgpr_read_b32 v131, a163
v_cvt_pk_bf16_f32 v20, v128, v129
v_mfma_f32_16x16x32_bf16 a[204:207], v[100:103], v[208:211], a[204:207]
ds_read_b64_tr_b16 v[208:209], v14 offset:12288
ds_read_b64_tr_b16 v[210:211], v14 offset:14336
v_mfma_f32_16x16x32_bf16 a[204:207], v[104:107], v[212:215], a[204:207]
ds_read_b64_tr_b16 v[212:213], v247 offset:12288
s_waitcnt lgkmcnt(3)
v_mfma_f32_16x16x32_bf16 a[192:195], v[160:163], v[216:219], a[192:195]
ds_read_b64_tr_b16 v[214:215], v247 offset:14336
v_cvt_pk_bf16_f32 v21, v130, v131
v_mfma_f32_16x16x32_bf16 a[192:195], v[176:179], v[220:223], a[192:195]
v_accvgpr_read_b32 v136, a164
v_accvgpr_read_b32 v137, a165
v_mfma_f32_16x16x32_bf16 a[196:199], v[164:167], v[216:219], a[196:199]
v_accvgpr_read_b32 v138, a166
v_accvgpr_read_b32 v139, a167
v_mfma_f32_16x16x32_bf16 a[196:199], v[180:183], v[220:223], a[196:199]
v_cvt_pk_bf16_f32 v52, v136, v137
v_cvt_pk_bf16_f32 v53, v138, v139
v_mfma_f32_16x16x32_bf16 a[200:203], v[168:171], v[216:219], a[200:203]
v_accvgpr_read_b32 v144, a168
v_accvgpr_read_b32 v145, a169
v_mfma_f32_16x16x32_bf16 a[200:203], v[184:187], v[220:223], a[200:203]
v_accvgpr_read_b32 v146, a170
v_accvgpr_read_b32 v147, a171
v_mfma_f32_16x16x32_bf16 a[204:207], v[172:175], v[216:219], a[204:207]
ds_read_b64_tr_b16 v[216:217], v247 offset:28672
ds_read_b64_tr_b16 v[218:219], v247 offset:30720
v_mfma_f32_16x16x32_bf16 a[204:207], v[188:191], v[220:223], a[204:207]
ds_read_b64_tr_b16 v[220:221], v13 offset:12288
s_waitcnt lgkmcnt(5)
v_mfma_f32_16x16x32_bf16 a[192:195], v[0:3], v[208:211], a[192:195]
ds_read_b64_tr_b16 v[222:223], v13 offset:14336
v_cvt_pk_bf16_f32 v84, v144, v145
v_mfma_f32_16x16x32_bf16 a[196:199], v[32:35], v[208:211], a[196:199]
v_cvt_pk_bf16_f32 v85, v146, v147
v_accvgpr_read_b32 v152, a172
v_mfma_f32_16x16x32_bf16 a[200:203], v[64:67], v[208:211], a[200:203]
v_accvgpr_read_b32 v153, a173
v_accvgpr_read_b32 v154, a174
v_mfma_f32_16x16x32_bf16 a[204:207], v[96:99], v[208:211], a[204:207]
ds_read_b64_tr_b16 v[208:209], v13 offset:28672
s_waitcnt lgkmcnt(5)
v_mfma_f32_16x16x32_bf16 a[208:211], v[4:7], v[212:215], a[208:211]
ds_read_b64_tr_b16 v[210:211], v13 offset:30720
v_accvgpr_read_b32 v155, a175
v_mfma_f32_16x16x32_bf16 a[212:215], v[36:39], v[212:215], a[212:215]
v_cvt_pk_bf16_f32 v116, v152, v153
v_cvt_pk_bf16_f32 v117, v154, v155
v_mfma_f32_16x16x32_bf16 a[216:219], v[68:71], v[212:215], a[216:219]
v_accvgpr_read_b32 v132, a176
v_accvgpr_read_b32 v133, a177
v_mfma_f32_16x16x32_bf16 a[220:223], v[100:103], v[212:215], a[220:223]
ds_read_b64_tr_b16 v[212:213], v15 offset:12288
s_waitcnt lgkmcnt(3)
v_mfma_f32_16x16x32_bf16 a[208:211], v[8:11], v[216:219], a[208:211]
ds_read_b64_tr_b16 v[214:215], v15 offset:14336
v_accvgpr_read_b32 v134, a178
v_mfma_f32_16x16x32_bf16 a[208:211], v[160:163], v[220:223], a[208:211]
v_accvgpr_read_b32 v135, a179
v_cvt_pk_bf16_f32 v22, v132, v133
v_mfma_f32_16x16x32_bf16 a[212:215], v[40:43], v[216:219], a[212:215]
v_cvt_pk_bf16_f32 v23, v134, v135
buffer_store_dwordx4 v[20:23], v243, s[20:23], s44 offen offset:1024 sc1
v_mfma_f32_16x16x32_bf16 a[212:215], v[164:167], v[220:223], a[212:215]
ds_write_b128 v231, v[20:23] offset:5120
v_accvgpr_read_b32 v140, a180
v_mfma_f32_16x16x32_bf16 a[216:219], v[72:75], v[216:219], a[216:219]
v_accvgpr_read_b32 v141, a181
v_accvgpr_read_b32 v142, a182
v_mfma_f32_16x16x32_bf16 a[216:219], v[168:171], v[220:223], a[216:219]
v_accvgpr_read_b32 v143, a183
v_cvt_pk_bf16_f32 v54, v140, v141
v_mfma_f32_16x16x32_bf16 a[220:223], v[104:107], v[216:219], a[220:223]
ds_read_b64_tr_b16 v[216:217], v246 offset:12800
ds_read_b64_tr_b16 v[218:219], v246 offset:14848
v_mfma_f32_16x16x32_bf16 a[220:223], v[172:175], v[220:223], a[220:223]
ds_read_b64_tr_b16 v[220:221], v246 offset:29184
s_waitcnt lgkmcnt(3)
v_mfma_f32_16x16x32_bf16 a[208:211], v[176:179], v[208:211], a[208:211]
ds_read_b64_tr_b16 v[222:223], v246 offset:31232
v_cvt_pk_bf16_f32 v55, v142, v143
v_mfma_f32_16x16x32_bf16 a[208:211], v[0:3], v[212:215], a[208:211]
buffer_store_dwordx4 v[52:55], v243, s[20:23], s45 offen offset:1024 sc1
v_accvgpr_read_b32 v148, a184
v_mfma_f32_16x16x32_bf16 a[212:215], v[180:183], v[208:211], a[212:215]
v_accvgpr_read_b32 v149, a185
v_accvgpr_read_b32 v150, a186
v_mfma_f32_16x16x32_bf16 a[212:215], v[32:35], v[212:215], a[212:215]
v_accvgpr_read_b32 v151, a187
v_cvt_pk_bf16_f32 v86, v148, v149
v_mfma_f32_16x16x32_bf16 a[216:219], v[184:187], v[208:211], a[216:219]
v_cvt_pk_bf16_f32 v87, v150, v151
buffer_store_dwordx4 v[84:87], v243, s[20:23], s46 offen offset:1024 sc1
v_mfma_f32_16x16x32_bf16 a[216:219], v[64:67], v[212:215], a[216:219]
v_accvgpr_read_b32 v156, a188
v_accvgpr_read_b32 v157, a189
v_mfma_f32_16x16x32_bf16 a[220:223], v[188:191], v[208:211], a[220:223]
ds_read_b64_tr_b16 v[208:209], v12 offset:12800
ds_read_b64_tr_b16 v[210:211], v12 offset:14848
v_mfma_f32_16x16x32_bf16 a[220:223], v[96:99], v[212:215], a[220:223]
ds_read_b64_tr_b16 v[212:213], v12 offset:29184
s_waitcnt lgkmcnt(3)
v_mfma_f32_16x16x32_bf16 a[224:227], v[4:7], v[216:219], a[224:227]
ds_read_b64_tr_b16 v[214:215], v12 offset:31232
v_accvgpr_read_b32 v158, a190
v_mfma_f32_16x16x32_bf16 a[224:227], v[8:11], v[220:223], a[224:227]
v_accvgpr_read_b32 v159, a191
v_cvt_pk_bf16_f32 v118, v156, v157
v_mfma_f32_16x16x32_bf16 a[228:231], v[36:39], v[216:219], a[228:231]
v_cvt_pk_bf16_f32 v119, v158, v159
buffer_store_dwordx4 v[116:119], v243, s[20:23], s47 offen offset:1024 sc1
v_mfma_f32_16x16x32_bf16 a[228:231], v[40:43], v[220:223], a[228:231]
v_accvgpr_read_b32 v128, a192
v_accvgpr_read_b32 v129, a193
v_mfma_f32_16x16x32_bf16 a[232:235], v[68:71], v[216:219], a[232:235]
v_accvgpr_read_b32 v130, a194
v_accvgpr_read_b32 v131, a195
v_mfma_f32_16x16x32_bf16 a[232:235], v[72:75], v[220:223], a[232:235]
v_cvt_pk_bf16_f32 v24, v128, v129
v_cvt_pk_bf16_f32 v25, v130, v131
v_mfma_f32_16x16x32_bf16 a[236:239], v[100:103], v[216:219], a[236:239]
ds_read_b64_tr_b16 v[216:217], v14 offset:12800
ds_read_b64_tr_b16 v[218:219], v14 offset:14848
v_mfma_f32_16x16x32_bf16 a[236:239], v[104:107], v[220:223], a[236:239]
ds_read_b64_tr_b16 v[220:221], v247 offset:12800
s_waitcnt lgkmcnt(3)
v_mfma_f32_16x16x32_bf16 a[224:227], v[160:163], v[208:211], a[224:227]
ds_read_b64_tr_b16 v[222:223], v247 offset:14848
v_accvgpr_read_b32 v136, a196
v_mfma_f32_16x16x32_bf16 a[224:227], v[176:179], v[212:215], a[224:227]
v_accvgpr_read_b32 v137, a197
v_accvgpr_read_b32 v138, a198
v_mfma_f32_16x16x32_bf16 a[228:231], v[164:167], v[208:211], a[228:231]
v_accvgpr_read_b32 v139, a199
v_cvt_pk_bf16_f32 v56, v136, v137
v_mfma_f32_16x16x32_bf16 a[228:231], v[180:183], v[212:215], a[228:231]
v_cvt_pk_bf16_f32 v57, v138, v139
v_accvgpr_read_b32 v144, a200
v_mfma_f32_16x16x32_bf16 a[232:235], v[168:171], v[208:211], a[232:235]
v_accvgpr_read_b32 v145, a201
v_accvgpr_read_b32 v146, a202
v_mfma_f32_16x16x32_bf16 a[232:235], v[184:187], v[212:215], a[232:235]
v_accvgpr_read_b32 v147, a203
v_cvt_pk_bf16_f32 v88, v144, v145
v_mfma_f32_16x16x32_bf16 a[236:239], v[172:175], v[208:211], a[236:239]
ds_read_b64_tr_b16 v[208:209], v247 offset:29184
ds_read_b64_tr_b16 v[210:211], v247 offset:31232
v_mfma_f32_16x16x32_bf16 a[236:239], v[188:191], v[212:215], a[236:239]
ds_read_b64_tr_b16 v[212:213], v13 offset:12800
s_waitcnt lgkmcnt(5)
v_mfma_f32_16x16x32_bf16 a[224:227], v[0:3], v[216:219], a[224:227]
ds_read_b64_tr_b16 v[214:215], v13 offset:14848
v_cvt_pk_bf16_f32 v89, v146, v147
v_mfma_f32_16x16x32_bf16 a[228:231], v[32:35], v[216:219], a[228:231]
v_accvgpr_read_b32 v152, a204
v_accvgpr_read_b32 v153, a205
v_mfma_f32_16x16x32_bf16 a[232:235], v[64:67], v[216:219], a[232:235]
v_accvgpr_read_b32 v154, a206
v_accvgpr_read_b32 v155, a207
v_mfma_f32_16x16x32_bf16 a[236:239], v[96:99], v[216:219], a[236:239]
ds_read_b64_tr_b16 v[216:217], v13 offset:29184
s_waitcnt lgkmcnt(5)
v_mfma_f32_16x16x32_bf16 a[240:243], v[4:7], v[220:223], a[240:243]
ds_read_b64_tr_b16 v[218:219], v13 offset:31232
v_cvt_pk_bf16_f32 v120, v152, v153
v_mfma_f32_16x16x32_bf16 a[244:247], v[36:39], v[220:223], a[244:247]
v_cvt_pk_bf16_f32 v121, v154, v155
v_accvgpr_read_b32 v132, a208
v_mfma_f32_16x16x32_bf16 a[248:251], v[68:71], v[220:223], a[248:251]
v_accvgpr_read_b32 v133, a209
v_accvgpr_read_b32 v134, a210
v_mfma_f32_16x16x32_bf16 a[252:255], v[100:103], v[220:223], a[252:255]
ds_read_b64_tr_b16 v[220:221], v15 offset:12800
s_waitcnt lgkmcnt(3)
v_mfma_f32_16x16x32_bf16 a[240:243], v[8:11], v[208:211], a[240:243]
ds_read_b64_tr_b16 v[222:223], v15 offset:14848
v_accvgpr_read_b32 v135, a211
v_mfma_f32_16x16x32_bf16 a[240:243], v[160:163], v[212:215], a[240:243]
v_cvt_pk_bf16_f32 v26, v132, v133
v_cvt_pk_bf16_f32 v27, v134, v135
v_mfma_f32_16x16x32_bf16 a[244:247], v[40:43], v[208:211], a[244:247]
buffer_store_dwordx4 v[24:27], v243, s[20:23], s44 offen offset:2048 sc1
ds_write_b128 v231, v[24:27] offset:6144
v_mfma_f32_16x16x32_bf16 a[244:247], v[164:167], v[212:215], a[244:247]
v_accvgpr_read_b32 v140, a212
v_accvgpr_read_b32 v141, a213
v_mfma_f32_16x16x32_bf16 a[248:251], v[72:75], v[208:211], a[248:251]
v_accvgpr_read_b32 v142, a214
v_accvgpr_read_b32 v143, a215
v_mfma_f32_16x16x32_bf16 a[248:251], v[168:171], v[212:215], a[248:251]
v_cvt_pk_bf16_f32 v58, v140, v141
v_cvt_pk_bf16_f32 v59, v142, v143
v_mfma_f32_16x16x32_bf16 a[252:255], v[104:107], v[208:211], a[252:255]
buffer_store_dwordx4 v[56:59], v243, s[20:23], s45 offen offset:2048 sc1
v_accvgpr_read_b32 v148, a216
v_mfma_f32_16x16x32_bf16 a[252:255], v[172:175], v[212:215], a[252:255]
s_waitcnt lgkmcnt(0)
v_accvgpr_read_b32 v149, a217
v_mfma_f32_16x16x32_bf16 a[240:243], v[176:179], v[216:219], a[240:243]
v_accvgpr_read_b32 v150, a218
v_accvgpr_read_b32 v151, a219
v_mfma_f32_16x16x32_bf16 a[240:243], v[0:3], v[220:223], a[240:243]
v_cvt_pk_bf16_f32 v90, v148, v149
v_cvt_pk_bf16_f32 v91, v150, v151
v_mfma_f32_16x16x32_bf16 a[244:247], v[180:183], v[216:219], a[244:247]
buffer_store_dwordx4 v[88:91], v243, s[20:23], s46 offen offset:2048 sc1
v_accvgpr_read_b32 v156, a220
v_mfma_f32_16x16x32_bf16 a[244:247], v[32:35], v[220:223], a[244:247]
v_accvgpr_read_b32 v157, a221
v_accvgpr_read_b32 v158, a222
v_mfma_f32_16x16x32_bf16 a[248:251], v[184:187], v[216:219], a[248:251]
v_accvgpr_read_b32 v159, a223
v_cvt_pk_bf16_f32 v122, v156, v157
v_mfma_f32_16x16x32_bf16 a[248:251], v[64:67], v[220:223], a[248:251]
v_cvt_pk_bf16_f32 v123, v158, v159
buffer_store_dwordx4 v[120:123], v243, s[20:23], s47 offen offset:2048 sc1
v_mfma_f32_16x16x32_bf16 a[252:255], v[188:191], v[216:219], a[252:255]
v_accvgpr_read_b32 v128, a224
v_accvgpr_read_b32 v129, a225
v_mfma_f32_16x16x32_bf16 a[252:255], v[96:99], v[220:223], a[252:255]
v_accvgpr_read_b32 v130, a226
v_accvgpr_read_b32 v131, a227
v_cvt_pk_bf16_f32 v28, v128, v129
v_cvt_pk_bf16_f32 v29, v130, v131
v_accvgpr_read_b32 v136, a228
v_accvgpr_read_b32 v137, a229
v_accvgpr_read_b32 v138, a230
v_accvgpr_read_b32 v139, a231
v_cvt_pk_bf16_f32 v60, v136, v137
v_cvt_pk_bf16_f32 v61, v138, v139
v_accvgpr_read_b32 v144, a232
v_accvgpr_read_b32 v145, a233
v_accvgpr_read_b32 v146, a234
v_accvgpr_read_b32 v147, a235
v_cvt_pk_bf16_f32 v92, v144, v145
v_cvt_pk_bf16_f32 v93, v146, v147
v_accvgpr_read_b32 v152, a236
v_accvgpr_read_b32 v153, a237
v_accvgpr_read_b32 v154, a238
v_accvgpr_read_b32 v155, a239
v_cvt_pk_bf16_f32 v124, v152, v153
v_cvt_pk_bf16_f32 v125, v154, v155
v_accvgpr_read_b32 v132, a240
v_accvgpr_read_b32 v133, a241
v_accvgpr_read_b32 v134, a242
v_accvgpr_read_b32 v135, a243
v_cvt_pk_bf16_f32 v30, v132, v133
v_cvt_pk_bf16_f32 v31, v134, v135
buffer_store_dwordx4 v[28:31], v243, s[20:23], s44 offen offset:3072 sc1
ds_write_b128 v231, v[28:31] offset:7168
v_accvgpr_read_b32 v140, a244
v_accvgpr_read_b32 v141, a245
v_accvgpr_read_b32 v142, a246
v_accvgpr_read_b32 v143, a247
v_cvt_pk_bf16_f32 v62, v140, v141
v_cvt_pk_bf16_f32 v63, v142, v143
buffer_store_dwordx4 v[60:63], v243, s[20:23], s45 offen offset:3072 sc1
v_accvgpr_read_b32 v148, a248
v_accvgpr_read_b32 v149, a249
v_accvgpr_read_b32 v150, a250
v_accvgpr_read_b32 v151, a251
v_cvt_pk_bf16_f32 v94, v148, v149
v_cvt_pk_bf16_f32 v95, v150, v151
buffer_store_dwordx4 v[92:95], v243, s[20:23], s46 offen offset:3072 sc1
v_accvgpr_read_b32 v156, a252
v_accvgpr_read_b32 v157, a253
v_accvgpr_read_b32 v158, a254
v_accvgpr_read_b32 v159, a255
v_cvt_pk_bf16_f32 v126, v156, v157
v_cvt_pk_bf16_f32 v127, v158, v159
buffer_store_dwordx4 v[124:127], v243, s[20:23], s47 offen offset:3072 sc1
s_waitcnt vmcnt(36)
s_branch L2_F
L2_F:
v_cmp_ne_u64 vcc, s[98:99], v[108:109]
s_lshl_b32 s3, s34, 15
s_add_u32 s3, s3, 0x1000000
s_cbranch_vccnz LF_wf
LF_wf_go:
v_add_u32 v240, s3, v243
v_add_u32 v241, 0x4000, v240
s_mov_b32 s32, 0x0
s_mov_b32 s33, 0x1000
s_mov_b32 s35, 0x2000
s_mov_b32 s36, 0x3000
s_mov_b32 s38, 0x20000
s_mov_b32 s39, 0x21000
s_mov_b32 s40, 0x22000
s_mov_b32 s41, 0x23000
s_lshr_b32 s42, s6, 13
s_lshr_b32 s43, s7, 13
s_lshr_b32 s44, s29, 13
v_mov_b32 v244, s42
v_mov_b32 v232, s43
v_cmp_lt_u32 vcc, 0xff, v243
v_mov_b32 v233, s44
s_nop 0
v_cndmask_b32 v244, v244, v232, vcc
v_cmp_lt_u32 vcc, 0x1ff, v243
v_and_b32 v235, 0xf0, v243
s_nop 0
v_cndmask_b32 v244, v244, v233, vcc
v_lshlrev_b32 v244, 11, v244
v_lshl_add_u32 v244, v235, 3, v244
v_lshrrev_b32 v79, 6, v244
buffer_load_ushort v79, v79, s[52:55], 0 offen
buffer_load_dwordx4 a[0:3], v240, s[16:19], s32 offen offset:0 sc1
buffer_load_dwordx4 a[4:7], v240, s[16:19], s32 offen offset:1024 sc1
buffer_load_dwordx4 a[8:11], v241, s[16:19], s32 offen offset:0 sc1
buffer_load_dwordx4 a[12:15], v241, s[16:19], s32 offen offset:1024 sc1
buffer_load_dwordx4 a[16:19], v240, s[16:19], s32 offen offset:2048 sc1
buffer_load_dwordx4 a[20:23], v240, s[16:19], s32 offen offset:3072 sc1
buffer_load_dwordx4 a[24:27], v241, s[16:19], s32 offen offset:2048 sc1
buffer_load_dwordx4 a[28:31], v241, s[16:19], s32 offen offset:3072 sc1
buffer_load_dwordx4 a[32:35], v240, s[16:19], s33 offen offset:0 sc1
buffer_load_dwordx4 a[36:39], v240, s[16:19], s33 offen offset:1024 sc1
buffer_load_dwordx4 a[40:43], v241, s[16:19], s33 offen offset:0 sc1
buffer_load_dwordx4 a[44:47], v241, s[16:19], s33 offen offset:1024 sc1
s_lshl_b32 s3, s37, 3
v_add3_u32 v244, v244, s3, 8
s_cmp_ge_u32 s29, 0x70000000
s_cselect_b32 s44, s43, s44
v_mov_b32 v46, s42
v_mov_b32 v232, s43
v_cmp_lt_u32 vcc, 0x7f, v243
v_mov_b32 v233, s44
s_nop 0
v_cndmask_b32 v46, v46, v232, vcc
v_cmp_lt_u32 vcc, 0xff, v243
v_bfe_u32 v232, v243, 4, 3
s_nop 0
v_cndmask_b32 v46, v46, v233, vcc
v_min_u32 v232, 5, v232
v_lshrrev_b32 v46, 2, v46
v_lshl_add_u32 v46, v46, 3, v232
v_lshlrev_b32 v46, 7, v46
v_add_u32 v46, 0x7c00000, v46
s_lshl_b32 s49, s34, 10
s_add_u32 s49, s49, 0x20000
s_bfe_u32 s3, s6, 0x2000f
s_lshl_b32 s3, s3, 13
s_add_u32 s3, s3, s49
v_add_u32 v76, s3, v243
s_bfe_u32 s3, s7, 0x2000f
s_lshl_b32 s3, s3, 13
s_add_u32 s3, s3, s49
v_add_u32 v77, s3, v243
s_bfe_u32 s3, s29, 0x2000f
s_lshl_b32 s3, s3, 13
s_add_u32 s3, s3, s49
v_add_u32 v78, s3, v243
s_add_u32 s3, s37, 1
s_sub_u32 s49, s3, 6
s_cselect_b32 s3, s3, s49
s_mul_i32 s3, s3, 0x600000
s_add_u32 s42, s3, 0x2000000
s_add_u32 s3, s37, 2
s_sub_u32 s49, s3, 6
s_cselect_b32 s3, s3, s49
s_mul_i32 s3, s3, 0x600000
s_add_u32 s43, s3, 0x2000000
s_add_u32 s3, s37, 3
s_sub_u32 s49, s3, 6
s_cselect_b32 s3, s3, s49
s_mul_i32 s3, s3, 0x600000
s_add_u32 s44, s3, 0x2000000
s_add_u32 s3, s37, 4
s_sub_u32 s49, s3, 6
s_cselect_b32 s3, s3, s49
s_mul_i32 s3, s3, 0x600000
s_add_u32 s45, s3, 0x2000000
s_add_u32 s3, s37, 5
s_sub_u32 s49, s3, 6
s_cselect_b32 s3, s3, s49
s_mul_i32 s3, s3, 0x600000
s_add_u32 s46, s3, 0x2000000
s_add_u32 s3, s37, 6
s_sub_u32 s49, s3, 6
s_cselect_b32 s3, s3, s49
s_mul_i32 s3, s3, 0x600000
s_add_u32 s47, s3, 0x2000000
s_mul_i32 s3, s34, 896
v_add_u32 v47, s3, v243
v_add_u32 v43, 0x1000, v47
v_lshrrev_b32 v44, 4, v243
v_and_b32 v44, 0x30, v44
v_xor_b32 v44, v44, v243
v_and_b32 v232, 0x380, v243
v_mad_u32_u24 v44, v232, 3, v44
v_xor_b32 v45, 0x1040, v44
v_bfe_u32 v232, v243, 5, 3
v_lshrrev_b32 v234, 8, v243
v_xor_b32 v232, v232, v234
v_bfe_u32 v233, v243, 4, 3
v_lshlrev_b32 v233, 7, v233
v_lshl_or_b32 v232, v232, 4, v233
v_bfe_u32 v233, v243, 7, 1
s_lshl_b32 s49, s34, 10
s_sub_u32 s3, s28, s49
v_lshl_add_u32 v74, v233, 12, v232
v_add_u32 v72, s3, v74
s_sub_u32 s3, s30, s49
v_add_u32 v74, s3, v74
v_xor_b32 v73, 64, v72
v_xor_b32 v75, 64, v74
v_lshl_add_u32 v245, v233, 10, v232
v_add_u32 v245, s31, v245
v_xor_b32 v246, 64, v245
v_add_u32 v247, s31, v243
s_add_u32 s3, s3, 0xa000
s_and_b32 s3, s3, 0x1ffff
v_add_u32 v252, s3, v243
v_add_u32 v251, s49, v252
s_lshl_b32 s49, s34, 11
s_add_u32 s3, s3, s49
s_add_u32 s3, s3, 24576
v_lshl_add_u32 v242, v243, 1, s3
v_lshl_add_u32 v250, v235, 1, s3
v_lshrrev_b32 v232, 4, v235
v_lshlrev_b32 v234, 2, v234
v_sub_u32 v232, v232, v234
v_and_b32 v233, 1, v232
v_lshlrev_b32 v233, 4, v233
v_mov_b32 v234, 0xffff
v_lshlrev_b32 v233, v233, v234
v_lshrrev_b32 v232, 1, v232
v_cmp_eq_u32 vcc, 0, v232
s_nop 1
v_cndmask_b32 v156, 0, v233, vcc
v_cmp_eq_u32 vcc, 1, v232
s_nop 1
v_cndmask_b32 v157, 0, v233, vcc
s_mov_b32 s95, 0xffff0000
s_waitcnt vmcnt(13)
v_mov_b32 v158, s98
v_mov_b32 v159, s99
s_mov_b64 exec, 1
buffer_store_dwordx2 v[158:159], off, s[16:19], s51 sc1
s_mov_b64 exec, -1
s_waitcnt lgkmcnt(0)
s_barrier
ds_read_b128 v[208:211], v72 offset:0
ds_read_b128 v[212:215], v72 offset:8192
ds_read_b128 v[216:219], v74 offset:0
ds_read_b128 v[220:223], v73 offset:0
ds_read_b128 v[224:227], v73 offset:8192
ds_read_b128 v[104:107], v245 offset:0
ds_read_b128 v[108:111], v246 offset:0
ds_read_b128 v[152:155], v245 offset:2048
s_waitcnt vmcnt(13)
v_lshlrev_b32 v79, 16, v79
ds_write_b32 v242, v79 offset:28
ds_read_b32 v253, v250 offset:28
ds_read_b32 v254, v250 offset:540
ds_read_b32 v255, v250 offset:1052
s_waitcnt vmcnt(12)
buffer_load_dwordx4 a[48:51], v240, s[16:19], s33 offen offset:2048 sc1
s_waitcnt vmcnt(12)
buffer_load_dwordx4 a[52:55], v240, s[16:19], s33 offen offset:3072 sc1
s_waitcnt vmcnt(12)
buffer_load_dwordx4 a[56:59], v241, s[16:19], s33 offen offset:2048 sc1
s_waitcnt vmcnt(12)
s_waitcnt lgkmcnt(11)
v_mfma_f32_16x16x32_bf16 v[160:163], a[0:3], v[208:211], 0
ds_read_b128 v[228:231], v75 offset:0
buffer_load_dwordx4 a[60:63], v241, s[16:19], s33 offen offset:3072 sc1
v_mfma_f32_16x16x32_bf16 v[164:167], a[4:7], v[208:211], 0
v_mfma_f32_16x16x32_bf16 v[168:171], a[8:11], v[208:211], 0
v_mfma_f32_16x16x32_bf16 v[172:175], a[12:15], v[208:211], 0
s_waitcnt vmcnt(12)
s_waitcnt lgkmcnt(11)
v_mfma_f32_16x16x32_bf16 v[176:179], a[0:3], v[212:215], 0
ds_read_b128 v[208:211], v72 offset:1024
buffer_load_dwordx4 a[64:67], v240, s[16:19], s35 offen offset:0 sc1
v_mfma_f32_16x16x32_bf16 v[180:183], a[4:7], v[212:215], 0
v_mfma_f32_16x16x32_bf16 v[184:187], a[8:11], v[212:215], 0
v_mfma_f32_16x16x32_bf16 v[188:191], a[12:15], v[212:215], 0
s_waitcnt vmcnt(12)
s_waitcnt lgkmcnt(11)
v_mfma_f32_16x16x32_bf16 v[192:195], a[0:3], v[216:219], 0
ds_read_b128 v[212:215], v72 offset:9216
buffer_load_dwordx4 a[68:71], v240, s[16:19], s35 offen offset:1024 sc1
v_mfma_f32_16x16x32_bf16 v[196:199], a[4:7], v[216:219], 0
v_mfma_f32_16x16x32_bf16 v[200:203], a[8:11], v[216:219], 0
v_mfma_f32_16x16x32_bf16 v[204:207], a[12:15], v[216:219], 0
s_waitcnt vmcnt(12)
buffer_load_dwordx4 a[72:75], v241, s[16:19], s35 offen offset:0 sc1
s_waitcnt vmcnt(12)
s_waitcnt lgkmcnt(11)
v_mfma_f32_16x16x32_bf16 v[160:163], a[16:19], v[220:223], v[160:163]
ds_read_b128 v[216:219], v74 offset:1024
buffer_load_dwordx4 a[76:79], v241, s[16:19], s35 offen offset:1024 sc1
v_mfma_f32_16x16x32_bf16 v[164:167], a[20:23], v[220:223], v[164:167]
v_mfma_f32_16x16x32_bf16 v[168:171], a[24:27], v[220:223], v[168:171]
v_mfma_f32_16x16x32_bf16 v[172:175], a[28:31], v[220:223], v[172:175]
s_waitcnt vmcnt(12)
s_waitcnt lgkmcnt(11)
v_mfma_f32_16x16x32_bf16 v[176:179], a[16:19], v[224:227], v[176:179]
ds_read_b128 v[220:223], v73 offset:1024
buffer_load_dwordx4 a[80:83], v240, s[16:19], s35 offen offset:2048 sc1
v_mfma_f32_16x16x32_bf16 v[180:183], a[20:23], v[224:227], v[180:183]
v_mfma_f32_16x16x32_bf16 v[184:187], a[24:27], v[224:227], v[184:187]
v_mfma_f32_16x16x32_bf16 v[188:191], a[28:31], v[224:227], v[188:191]
s_waitcnt vmcnt(12)
s_waitcnt lgkmcnt(4)
v_mfma_f32_16x16x32_bf16 v[192:195], a[16:19], v[228:231], v[192:195]
ds_read_b128 v[224:227], v73 offset:9216
buffer_load_dwordx4 a[84:87], v240, s[16:19], s35 offen offset:3072 sc1
v_mfma_f32_16x16x32_bf16 v[196:199], a[20:23], v[228:231], v[196:199]
v_mfma_f32_16x16x32_bf16 v[200:203], a[24:27], v[228:231], v[200:203]
v_mfma_f32_16x16x32_bf16 v[204:207], a[28:31], v[228:231], v[204:207]
s_waitcnt vmcnt(12)
buffer_load_dwordx4 a[88:91], v241, s[16:19], s35 offen offset:2048 sc1
s_waitcnt vmcnt(12)
s_waitcnt lgkmcnt(4)
v_mfma_f32_16x16x32_bf16 v[160:163], a[32:35], v[208:211], v[160:163]
ds_read_b128 v[228:231], v75 offset:1024
buffer_load_dwordx4 a[92:95], v241, s[16:19], s35 offen offset:3072 sc1
v_mfma_f32_16x16x32_bf16 v[164:167], a[36:39], v[208:211], v[164:167]
v_mfma_f32_16x16x32_bf16 v[168:171], a[40:43], v[208:211], v[168:171]
v_mfma_f32_16x16x32_bf16 v[172:175], a[44:47], v[208:211], v[172:175]
s_waitcnt lgkmcnt(4)
v_mfma_f32_16x16x32_bf16 v[176:179], a[32:35], v[212:215], v[176:179]
ds_read_b128 v[208:211], v72 offset:2048
v_mfma_f32_16x16x32_bf16 v[180:183], a[36:39], v[212:215], v[180:183]
v_mfma_f32_16x16x32_bf16 v[184:187], a[40:43], v[212:215], v[184:187]
v_mfma_f32_16x16x32_bf16 v[188:191], a[44:47], v[212:215], v[188:191]
s_waitcnt vmcnt(11)
s_waitcnt lgkmcnt(4)
v_mfma_f32_16x16x32_bf16 v[192:195], a[32:35], v[216:219], v[192:195]
ds_read_b128 v[212:215], v72 offset:10240
buffer_load_dwordx4 a[96:99], v240, s[16:19], s36 offen offset:0 sc1
v_mfma_f32_16x16x32_bf16 v[196:199], a[36:39], v[216:219], v[196:199]
v_mfma_f32_16x16x32_bf16 v[200:203], a[40:43], v[216:219], v[200:203]
v_mfma_f32_16x16x32_bf16 v[204:207], a[44:47], v[216:219], v[204:207]
s_waitcnt vmcnt(11)
buffer_load_dwordx4 a[100:103], v240, s[16:19], s36 offen offset:1024 sc1
s_waitcnt vmcnt(11)
buffer_load_dwordx4 a[104:107], v241, s[16:19], s36 offen offset:0 sc1
s_waitcnt vmcnt(11)
s_waitcnt lgkmcnt(4)
v_mfma_f32_16x16x32_bf16 v[160:163], a[48:51], v[220:223], v[160:163]
ds_read_b128 v[216:219], v74 offset:2048
buffer_load_dwordx4 a[108:111], v241, s[16:19], s36 offen offset:1024 sc1
v_mfma_f32_16x16x32_bf16 v[164:167], a[52:55], v[220:223], v[164:167]
v_mfma_f32_16x16x32_bf16 v[168:171], a[56:59], v[220:223], v[168:171]
v_mfma_f32_16x16x32_bf16 v[172:175], a[60:63], v[220:223], v[172:175]
s_waitcnt vmcnt(11)
s_waitcnt lgkmcnt(4)
v_mfma_f32_16x16x32_bf16 v[176:179], a[48:51], v[224:227], v[176:179]
ds_read_b128 v[220:223], v73 offset:2048
buffer_load_dwordx4 a[112:115], v240, s[16:19], s36 offen offset:2048 sc1
v_mfma_f32_16x16x32_bf16 v[180:183], a[52:55], v[224:227], v[180:183]
v_mfma_f32_16x16x32_bf16 v[184:187], a[56:59], v[224:227], v[184:187]
v_mfma_f32_16x16x32_bf16 v[188:191], a[60:63], v[224:227], v[188:191]
s_waitcnt vmcnt(11)
s_waitcnt lgkmcnt(4)
v_mfma_f32_16x16x32_bf16 v[192:195], a[48:51], v[228:231], v[192:195]
ds_read_b128 v[224:227], v73 offset:10240
buffer_load_dwordx4 a[116:119], v240, s[16:19], s36 offen offset:3072 sc1
v_mfma_f32_16x16x32_bf16 v[196:199], a[52:55], v[228:231], v[196:199]
v_mfma_f32_16x16x32_bf16 v[200:203], a[56:59], v[228:231], v[200:203]
v_mfma_f32_16x16x32_bf16 v[204:207], a[60:63], v[228:231], v[204:207]
s_waitcnt vmcnt(11)
buffer_load_dwordx4 a[120:123], v241, s[16:19], s36 offen offset:2048 sc1
s_waitcnt vmcnt(11)
s_waitcnt lgkmcnt(4)
v_mfma_f32_16x16x32_bf16 v[160:163], a[64:67], v[208:211], v[160:163]
ds_read_b128 v[228:231], v75 offset:2048
buffer_load_dwordx4 a[124:127], v241, s[16:19], s36 offen offset:3072 sc1
v_mfma_f32_16x16x32_bf16 v[164:167], a[68:71], v[208:211], v[164:167]
v_mfma_f32_16x16x32_bf16 v[168:171], a[72:75], v[208:211], v[168:171]
v_mfma_f32_16x16x32_bf16 v[172:175], a[76:79], v[208:211], v[172:175]
s_waitcnt vmcnt(11)
s_waitcnt lgkmcnt(4)
v_mfma_f32_16x16x32_bf16 v[176:179], a[64:67], v[212:215], v[176:179]
ds_read_b128 v[208:211], v72 offset:3072
buffer_load_dwordx4 a[128:131], v240, s[16:19], s38 offen offset:0 sc1
v_mfma_f32_16x16x32_bf16 v[180:183], a[68:71], v[212:215], v[180:183]
v_mfma_f32_16x16x32_bf16 v[184:187], a[72:75], v[212:215], v[184:187]
v_mfma_f32_16x16x32_bf16 v[188:191], a[76:79], v[212:215], v[188:191]
s_waitcnt vmcnt(11)
s_waitcnt lgkmcnt(4)
v_mfma_f32_16x16x32_bf16 v[192:195], a[64:67], v[216:219], v[192:195]
ds_read_b128 v[212:215], v72 offset:11264
buffer_load_dwordx4 a[132:135], v240, s[16:19], s38 offen offset:1024 sc1
v_mfma_f32_16x16x32_bf16 v[196:199], a[68:71], v[216:219], v[196:199]
v_mfma_f32_16x16x32_bf16 v[200:203], a[72:75], v[216:219], v[200:203]
v_mfma_f32_16x16x32_bf16 v[204:207], a[76:79], v[216:219], v[204:207]
s_waitcnt vmcnt(11)
buffer_load_dwordx4 a[136:139], v241, s[16:19], s38 offen offset:0 sc1
s_waitcnt vmcnt(11)
s_waitcnt lgkmcnt(4)
v_mfma_f32_16x16x32_bf16 v[160:163], a[80:83], v[220:223], v[160:163]
ds_read_b128 v[216:219], v74 offset:3072
buffer_load_dwordx4 a[140:143], v241, s[16:19], s38 offen offset:1024 sc1
v_mfma_f32_16x16x32_bf16 v[164:167], a[84:87], v[220:223], v[164:167]
v_mfma_f32_16x16x32_bf16 v[168:171], a[88:91], v[220:223], v[168:171]
v_mfma_f32_16x16x32_bf16 v[172:175], a[92:95], v[220:223], v[172:175]
s_waitcnt vmcnt(11)
s_waitcnt lgkmcnt(4)
v_mfma_f32_16x16x32_bf16 v[176:179], a[80:83], v[224:227], v[176:179]
ds_read_b128 v[220:223], v73 offset:3072
buffer_load_dwordx4 a[144:147], v240, s[16:19], s38 offen offset:2048 sc1
v_mfma_f32_16x16x32_bf16 v[180:183], a[84:87], v[224:227], v[180:183]
v_mfma_f32_16x16x32_bf16 v[184:187], a[88:91], v[224:227], v[184:187]
v_mfma_f32_16x16x32_bf16 v[188:191], a[92:95], v[224:227], v[188:191]
s_waitcnt vmcnt(11)
s_waitcnt lgkmcnt(4)
v_mfma_f32_16x16x32_bf16 v[192:195], a[80:83], v[228:231], v[192:195]
ds_read_b128 v[224:227], v73 offset:11264
buffer_load_dwordx4 a[148:151], v240, s[16:19], s38 offen offset:3072 sc1
v_mfma_f32_16x16x32_bf16 v[196:199], a[84:87], v[228:231], v[196:199]
v_mfma_f32_16x16x32_bf16 v[200:203], a[88:91], v[228:231], v[200:203]
v_mfma_f32_16x16x32_bf16 v[204:207], a[92:95], v[228:231], v[204:207]
s_waitcnt vmcnt(11)
buffer_load_dwordx4 a[152:155], v241, s[16:19], s38 offen offset:2048 sc1
s_waitcnt vmcnt(11)
s_waitcnt lgkmcnt(4)
v_mfma_f32_16x16x32_bf16 v[160:163], a[96:99], v[208:211], v[160:163]
ds_read_b128 v[228:231], v75 offset:3072
buffer_load_dwordx4 a[156:159], v241, s[16:19], s38 offen offset:3072 sc1
v_mfma_f32_16x16x32_bf16 v[164:167], a[100:103], v[208:211], v[164:167]
v_mfma_f32_16x16x32_bf16 v[168:171], a[104:107], v[208:211], v[168:171]
v_mfma_f32_16x16x32_bf16 v[172:175], a[108:111], v[208:211], v[172:175]
s_waitcnt vmcnt(11)
s_waitcnt lgkmcnt(4)
v_mfma_f32_16x16x32_bf16 v[176:179], a[96:99], v[212:215], v[176:179]
buffer_load_dwordx4 a[160:163], v240, s[16:19], s39 offen offset:0 sc1
v_mfma_f32_16x16x32_bf16 v[180:183], a[100:103], v[212:215], v[180:183]
v_mfma_f32_16x16x32_bf16 v[184:187], a[104:107], v[212:215], v[184:187]
v_mfma_f32_16x16x32_bf16 v[188:191], a[108:111], v[212:215], v[188:191]
s_waitcnt vmcnt(11)
s_waitcnt lgkmcnt(3)
v_mfma_f32_16x16x32_bf16 v[192:195], a[96:99], v[216:219], v[192:195]
buffer_load_dwordx4 a[164:167], v240, s[16:19], s39 offen offset:1024 sc1
v_mfma_f32_16x16x32_bf16 v[196:199], a[100:103], v[216:219], v[196:199]
v_mfma_f32_16x16x32_bf16 v[200:203], a[104:107], v[216:219], v[200:203]
v_mfma_f32_16x16x32_bf16 v[204:207], a[108:111], v[216:219], v[204:207]
s_waitcnt vmcnt(11)
buffer_load_dwordx4 a[168:171], v241, s[16:19], s39 offen offset:0 sc1
s_waitcnt vmcnt(11)
s_waitcnt lgkmcnt(2)
v_mfma_f32_16x16x32_bf16 v[160:163], a[112:115], v[220:223], v[160:163]
buffer_load_dwordx4 a[172:175], v241, s[16:19], s39 offen offset:1024 sc1
v_mfma_f32_16x16x32_bf16 v[164:167], a[116:119], v[220:223], v[164:167]
v_mfma_f32_16x16x32_bf16 v[168:171], a[120:123], v[220:223], v[168:171]
v_mfma_f32_16x16x32_bf16 v[172:175], a[124:127], v[220:223], v[172:175]
s_waitcnt vmcnt(11)
s_waitcnt lgkmcnt(1)
v_mfma_f32_16x16x32_bf16 v[176:179], a[112:115], v[224:227], v[176:179]
buffer_load_dwordx2 v[248:249], v46, s[16:19], 0 offen offset:0 sc1
v_mfma_f32_16x16x32_bf16 v[180:183], a[116:119], v[224:227], v[180:183]
v_lshlrev_b32 v234, 16, v104
v_and_b32 v235, s95, v104
v_mfma_f32_16x16x32_bf16 v[184:187], a[120:123], v[224:227], v[184:187]
v_fma_f32 v160, v160, v253, v234
v_fma_f32 v161, v161, v253, v235
v_mfma_f32_16x16x32_bf16 v[188:191], a[124:127], v[224:227], v[188:191]
v_lshlrev_b32 v236, 16, v105
v_and_b32 v237, s95, v105
s_waitcnt lgkmcnt(0)
v_mfma_f32_16x16x32_bf16 v[192:195], a[112:115], v[228:231], v[192:195]
v_fma_f32 v162, v162, v253, v236
v_fma_f32 v163, v163, v253, v237
v_mfma_f32_16x16x32_bf16 v[196:199], a[116:119], v[228:231], v[196:199]
v_lshlrev_b32 v238, 16, v106
v_and_b32 v239, s95, v106
v_mfma_f32_16x16x32_bf16 v[200:203], a[120:123], v[228:231], v[200:203]
v_fma_f32 v164, v164, v253, v238
v_fma_f32 v165, v165, v253, v239
v_mfma_f32_16x16x32_bf16 v[204:207], a[124:127], v[228:231], v[204:207]
v_lshlrev_b32 v232, 16, v107
v_and_b32 v233, s95, v107
v_fma_f32 v166, v166, v253, v232
v_fma_f32 v167, v167, v253, v233
ds_read_b128 v[104:107], v246 offset:2048
v_lshlrev_b32 v234, 16, v108
v_and_b32 v235, s95, v108
v_fma_f32 v168, v168, v253, v234
v_fma_f32 v169, v169, v253, v235
v_lshlrev_b32 v236, 16, v109
v_and_b32 v237, s95, v109
v_fma_f32 v170, v170, v253, v236
v_fma_f32 v171, v171, v253, v237
v_lshlrev_b32 v238, 16, v110
v_and_b32 v239, s95, v110
v_fma_f32 v172, v172, v253, v238
v_fma_f32 v173, v173, v253, v239
v_lshlrev_b32 v232, 16, v111
v_and_b32 v233, s95, v111
v_fma_f32 v174, v174, v253, v232
v_fma_f32 v175, v175, v253, v233
ds_read_b128 v[108:111], v245 offset:4096
s_waitcnt vmcnt(11)
buffer_load_dwordx4 a[176:179], v240, s[16:19], s39 offen offset:2048 sc1
v_lshlrev_b32 v234, 16, v152
v_and_b32 v235, s95, v152
v_fma_f32 v176, v176, v254, v234
v_fma_f32 v177, v177, v254, v235
v_lshlrev_b32 v236, 16, v153
v_and_b32 v237, s95, v153
v_fma_f32 v178, v178, v254, v236
v_fma_f32 v179, v179, v254, v237
v_lshlrev_b32 v238, 16, v154
v_and_b32 v239, s95, v154
v_fma_f32 v180, v180, v254, v238
v_fma_f32 v181, v181, v254, v239
v_lshlrev_b32 v232, 16, v155
v_and_b32 v233, s95, v155
v_fma_f32 v182, v182, v254, v232
v_fma_f32 v183, v183, v254, v233
ds_read_b128 v[152:155], v246 offset:4096
s_waitcnt lgkmcnt(2)
v_lshlrev_b32 v234, 16, v104
v_and_b32 v235, s95, v104
v_fma_f32 v184, v184, v254, v234
v_fma_f32 v185, v185, v254, v235
v_lshlrev_b32 v236, 16, v105
v_and_b32 v237, s95, v105
v_fma_f32 v186, v186, v254, v236
v_fma_f32 v187, v187, v254, v237
v_lshlrev_b32 v238, 16, v106
v_and_b32 v239, s95, v106
v_fma_f32 v188, v188, v254, v238
v_fma_f32 v189, v189, v254, v239
v_lshlrev_b32 v232, 16, v107
v_and_b32 v233, s95, v107
v_fma_f32 v190, v190, v254, v232
v_fma_f32 v191, v191, v254, v233
s_waitcnt vmcnt(11)
buffer_load_dwordx4 a[180:183], v240, s[16:19], s39 offen offset:3072 sc1
s_waitcnt lgkmcnt(1)
v_lshlrev_b32 v234, 16, v108
v_and_b32 v235, s95, v108
v_fma_f32 v192, v192, v255, v234
v_fma_f32 v193, v193, v255, v235
v_lshlrev_b32 v236, 16, v109
v_and_b32 v237, s95, v109
v_fma_f32 v194, v194, v255, v236
v_fma_f32 v195, v195, v255, v237
v_lshlrev_b32 v238, 16, v110
v_and_b32 v239, s95, v110
v_fma_f32 v196, v196, v255, v238
v_fma_f32 v197, v197, v255, v239
v_lshlrev_b32 v232, 16, v111
v_and_b32 v233, s95, v111
v_fma_f32 v198, v198, v255, v232
v_fma_f32 v199, v199, v255, v233
s_waitcnt lgkmcnt(0)
v_lshlrev_b32 v234, 16, v152
v_and_b32 v235, s95, v152
v_fma_f32 v200, v200, v255, v234
v_fma_f32 v201, v201, v255, v235
v_lshlrev_b32 v236, 16, v153
v_and_b32 v237, s95, v153
v_fma_f32 v202, v202, v255, v236
v_fma_f32 v203, v203, v255, v237
v_lshlrev_b32 v238, 16, v154
v_and_b32 v239, s95, v154
v_fma_f32 v204, v204, v255, v238
v_fma_f32 v205, v205, v255, v239
v_lshlrev_b32 v232, 16, v155
v_and_b32 v233, s95, v155
v_fma_f32 v206, v206, v255, v232
v_fma_f32 v207, v207, v255, v233
s_waitcnt vmcnt(11)
buffer_load_dwordx4 a[184:187], v241, s[16:19], s39 offen offset:2048 sc1
s_waitcnt vmcnt(11)
buffer_load_dwordx4 a[188:191], v241, s[16:19], s39 offen offset:3072 sc1
s_waitcnt vmcnt(11)
buffer_load_dwordx4 a[192:195], v240, s[16:19], s40 offen offset:0 sc1
s_waitcnt vmcnt(11)
buffer_load_dwordx4 a[196:199], v240, s[16:19], s40 offen offset:1024 sc1
s_waitcnt vmcnt(11)
buffer_load_dwordx4 a[200:203], v241, s[16:19], s40 offen offset:0 sc1
s_waitcnt vmcnt(11)
buffer_load_dwordx4 a[204:207], v241, s[16:19], s40 offen offset:1024 sc1
s_waitcnt vmcnt(11)
buffer_load_dwordx4 a[208:211], v240, s[16:19], s40 offen offset:2048 sc1
s_waitcnt vmcnt(11)
buffer_load_dwordx4 a[212:215], v240, s[16:19], s40 offen offset:3072 sc1
s_waitcnt vmcnt(11)
s_waitcnt vmcnt(10)
v_cmp_ne_u64 vcc, s[98:99], v[248:249]
s_nop 1
s_cbranch_vccnz LF_spinQ
LF_goQ:
buffer_load_dwordx4 v[128:131], v244, s[24:27], 0 offen offset:0 sc1
buffer_load_dwordx4 v[132:135], v244, s[24:27], 0 offen offset:16 sc1
s_waitcnt vmcnt(11)
buffer_load_dwordx4 v[136:139], v244, s[24:27], 0 offen offset:32 sc1
s_waitcnt vmcnt(11)
s_waitcnt vmcnt(10)
s_add_u32 s49, s6, s42
buffer_load_dwordx4 v[48:51], v47, s[16:19], s49 offen sc1
s_add_u32 s3, s6, s43
buffer_load_dwordx4 v[52:55], v47, s[16:19], s3 offen sc1
s_waitcnt vmcnt(11)
buffer_load_dwordx4 a[216:219], v241, s[16:19], s40 offen offset:2048 sc1
s_waitcnt vmcnt(11)
s_waitcnt vmcnt(10)
s_add_u32 s49, s6, s44
buffer_load_dwordx4 v[56:59], v47, s[16:19], s49 offen sc1
s_add_u32 s3, s6, s45
buffer_load_dwordx4 v[60:63], v47, s[16:19], s3 offen sc1
s_waitcnt vmcnt(11)
buffer_load_dwordx4 a[220:223], v241, s[16:19], s40 offen offset:3072 sc1
s_waitcnt vmcnt(11)
s_add_u32 s49, s6, s46
buffer_load_dwordx4 v[64:67], v47, s[16:19], s49 offen sc1
ds_read_b128 v[68:71], v76 offset:0
s_waitcnt vmcnt(11)
buffer_load_dwordx4 a[224:227], v240, s[16:19], s41 offen offset:0 sc1
s_waitcnt vmcnt(11)
s_waitcnt vmcnt(10)
s_add_u32 s49, s6, s42
buffer_load_dwordx4 v[80:83], v43, s[16:19], s49 offen sc1
s_add_u32 s3, s6, s43
buffer_load_dwordx4 v[84:87], v43, s[16:19], s3 offen sc1
s_waitcnt vmcnt(11)
buffer_load_dwordx4 a[228:231], v240, s[16:19], s41 offen offset:1024 sc1
s_waitcnt vmcnt(11)
v_max3_f32 v232, v128, v130, v132
v_max3_f32 v233, v134, v136, v138
v_max_f32 v232, v232, v233
v_subrev_f32 v232, 0x42fe0000, v232
v_sub_f32 v128, v128, v232
v_sub_f32 v130, v130, v232
v_sub_f32 v132, v132, v232
v_sub_f32 v134, v134, v232
v_sub_f32 v136, v136, v232
v_sub_f32 v138, v138, v232
v_cvt_u32_f32 v128, v128
v_cvt_u32_f32 v130, v130
v_cvt_u32_f32 v132, v132
v_cvt_u32_f32 v134, v134
v_cvt_u32_f32 v136, v136
v_cvt_u32_f32 v138, v138
v_lshlrev_b32 v234, 23, v128
v_lshlrev_b32 v235, 23, v130
v_lshlrev_b32 v236, 23, v132
v_lshlrev_b32 v237, 23, v134
v_lshlrev_b32 v238, 23, v136
v_lshlrev_b32 v239, 23, v138
v_mul_f32 v232, v234, v129
v_fmac_f32 v232, v235, v131
v_fmac_f32 v232, v236, v133
v_fmac_f32 v232, v237, v135
v_fmac_f32 v232, v238, v137
v_fmac_f32 v232, v239, v139
v_rcp_f32 v150, v232
v_mul_u32_u24 v144, 0x800080, v128
v_mul_u32_u24 v145, 0x800080, v130
v_mul_u32_u24 v146, 0x800080, v132
v_mul_u32_u24 v147, 0x800080, v134
v_mul_u32_u24 v148, 0x800080, v136
v_mul_u32_u24 v149, 0x800080, v138
ds_write_b128 v242, v[144:147]
ds_write_b96 v242, v[148:150] offset:16
ds_read_b128 v[144:147], v250 offset:0
ds_read_b128 v[148:151], v250 offset:16
ds_read_b128 v[128:131], v250 offset:512
ds_read_b128 v[132:135], v250 offset:528
ds_read_b128 v[136:139], v250 offset:1024
ds_read_b128 v[140:143], v250 offset:1040
s_waitcnt lgkmcnt(4)
v_and_b32 v0, v144, v156
v_and_b32 v1, v144, v157
v_and_b32 v2, v145, v156
v_and_b32 v3, v145, v157
v_and_b32 v4, v146, v156
v_and_b32 v5, v146, v157
v_and_b32 v6, v147, v156
v_and_b32 v7, v147, v157
v_and_b32 v8, v148, v156
v_and_b32 v9, v148, v157
v_and_b32 v10, v149, v156
v_and_b32 v11, v149, v157
v_mov_b32 v40, v150
s_waitcnt lgkmcnt(2)
v_and_b32 v12, v128, v156
v_and_b32 v13, v128, v157
v_and_b32 v14, v129, v156
v_and_b32 v15, v129, v157
v_and_b32 v16, v130, v156
v_and_b32 v17, v130, v157
v_and_b32 v18, v131, v156
v_and_b32 v19, v131, v157
v_and_b32 v20, v132, v156
v_and_b32 v21, v132, v157
v_and_b32 v22, v133, v156
v_and_b32 v23, v133, v157
v_mov_b32 v41, v134
s_waitcnt lgkmcnt(0)
v_and_b32 v24, v136, v156
v_and_b32 v25, v136, v157
v_and_b32 v26, v137, v156
v_and_b32 v27, v137, v157
v_and_b32 v28, v138, v156
v_and_b32 v29, v138, v157
v_and_b32 v30, v139, v156
v_and_b32 v31, v139, v157
v_and_b32 v32, v140, v156
v_and_b32 v33, v140, v157
v_and_b32 v34, v141, v156
v_and_b32 v35, v141, v157
v_mov_b32 v42, v142
s_waitcnt vmcnt(9)
v_swap_b32 v50, v52
v_swap_b32 v51, v53
s_nop 1
v_mfma_f32_16x16x32_bf16 v[136:139], v[48:51], v[0:3], 0
s_add_u32 s49, s6, s44
buffer_load_dwordx4 v[88:91], v43, s[16:19], s49 offen sc1
v_mfma_f32_16x16x32_bf16 v[140:143], v[52:55], v[0:3], 0
s_add_u32 s3, s6, s45
buffer_load_dwordx4 v[92:95], v43, s[16:19], s3 offen sc1
buffer_load_dwordx4 a[232:235], v241, s[16:19], s41 offen offset:0 sc1
s_waitcnt vmcnt(11)
s_add_u32 s49, s6, s46
buffer_load_dwordx4 v[96:99], v43, s[16:19], s49 offen sc1
ds_read_b128 v[100:103], v76 offset:4096
s_waitcnt vmcnt(10)
v_swap_b32 v58, v60
v_swap_b32 v59, v61
s_nop 1
v_mfma_f32_16x16x32_bf16 v[136:139], v[56:59], v[4:7], v[136:139]
buffer_load_dwordx4 a[236:239], v241, s[16:19], s41 offen offset:1024 sc1
v_mfma_f32_16x16x32_bf16 v[140:143], v[60:63], v[4:7], v[140:143]
s_waitcnt vmcnt(10)
s_add_u32 s49, s7, s42
buffer_load_dwordx4 v[112:115], v47, s[16:19], s49 offen sc1
s_add_u32 s3, s7, s43
buffer_load_dwordx4 v[116:119], v47, s[16:19], s3 offen sc1
s_waitcnt vmcnt(11)
v_swap_b32 v66, v68
v_swap_b32 v67, v69
s_nop 1
v_mfma_f32_16x16x32_bf16 v[136:139], v[64:67], v[8:11], v[136:139]
buffer_load_dwordx4 a[240:243], v240, s[16:19], s41 offen offset:2048 sc1
v_mfma_f32_16x16x32_bf16 v[140:143], v[68:71], v[8:11], v[140:143]
s_waitcnt vmcnt(11)
s_nop 4
v_mul_f32 v136, v136, v40
v_mul_f32 v137, v137, v40
v_mul_f32 v138, v138, v40
v_mul_f32 v139, v139, v40
v_mul_f32 v140, v140, v40
v_mul_f32 v141, v141, v40
v_mul_f32 v142, v142, v40
v_mul_f32 v143, v143, v40
v_cvt_pk_bf16_f32 v136, v136, v137
v_cvt_pk_bf16_f32 v137, v138, v139
v_cvt_pk_bf16_f32 v138, v140, v141
v_cvt_pk_bf16_f32 v139, v142, v143
ds_write_b128 v251, v[136:139] offset:0
s_waitcnt vmcnt(9)
v_swap_b32 v82, v84
v_swap_b32 v83, v85
s_nop 1
v_mfma_f32_16x16x32_bf16 v[128:131], v[80:83], v[0:3], 0
s_add_u32 s49, s7, s44
buffer_load_dwordx4 v[120:123], v47, s[16:19], s49 offen sc1
v_mfma_f32_16x16x32_bf16 v[132:135], v[84:87], v[0:3], 0
s_add_u32 s3, s7, s45
buffer_load_dwordx4 v[124:127], v47, s[16:19], s3 offen sc1
buffer_load_dwordx4 a[244:247], v240, s[16:19], s41 offen offset:3072 sc1
s_waitcnt vmcnt(11)
s_add_u32 s49, s7, s46
buffer_load_dwordx4 v[48:51], v47, s[16:19], s49 offen sc1
ds_read_b128 v[52:55], v77 offset:0
s_waitcnt vmcnt(10)
v_swap_b32 v90, v92
v_swap_b32 v91, v93
s_nop 1
v_mfma_f32_16x16x32_bf16 v[128:131], v[88:91], v[4:7], v[128:131]
buffer_load_dwordx4 a[248:251], v241, s[16:19], s41 offen offset:2048 sc1
v_mfma_f32_16x16x32_bf16 v[132:135], v[92:95], v[4:7], v[132:135]
s_waitcnt vmcnt(10)
s_add_u32 s49, s7, s42
buffer_load_dwordx4 v[56:59], v43, s[16:19], s49 offen sc1
s_add_u32 s3, s7, s43
buffer_load_dwordx4 v[60:63], v43, s[16:19], s3 offen sc1
s_waitcnt vmcnt(11)
s_waitcnt lgkmcnt(2)
v_swap_b32 v98, v100
v_swap_b32 v99, v101
s_nop 1
v_mfma_f32_16x16x32_bf16 v[128:131], v[96:99], v[8:11], v[128:131]
buffer_load_dwordx4 a[252:255], v241, s[16:19], s41 offen offset:3072 sc1
v_mfma_f32_16x16x32_bf16 v[132:135], v[100:103], v[8:11], v[132:135]
s_waitcnt vmcnt(11)
s_nop 4
v_mul_f32 v128, v128, v40
v_mul_f32 v129, v129, v40
v_mul_f32 v130, v130, v40
v_mul_f32 v131, v131, v40
v_mul_f32 v132, v132, v40
v_mul_f32 v133, v133, v40
v_mul_f32 v134, v134, v40
v_mul_f32 v135, v135, v40
v_cvt_pk_bf16_f32 v128, v128, v129
v_cvt_pk_bf16_f32 v129, v130, v131
v_cvt_pk_bf16_f32 v130, v132, v133
v_cvt_pk_bf16_f32 v131, v134, v135
ds_write_b128 v251, v[128:131] offset:4096
s_waitcnt lgkmcnt(0)
s_barrier
ds_read_b128 v[208:211], v252 offset:0
ds_read_b128 v[212:215], v252 offset:1024
ds_read_b128 v[216:219], v252 offset:2048
ds_read_b128 v[220:223], v252 offset:3072
ds_read_b128 v[224:227], v252 offset:4096
s_waitcnt vmcnt(9)
s_waitcnt lgkmcnt(4)
v_mfma_f32_16x16x32_bf16 v[160:163], a[128:131], v[208:211], v[160:163]
ds_read_b128 v[228:231], v252 offset:5120
v_swap_b32 v114, v116
v_mfma_f32_16x16x32_bf16 v[164:167], a[132:135], v[208:211], v[164:167]
v_swap_b32 v115, v117
s_nop 1
v_mfma_f32_16x16x32_bf16 v[136:139], v[112:115], v[12:15], 0
s_add_u32 s49, s7, s44
buffer_load_dwordx4 v[64:67], v43, s[16:19], s49 offen sc1
v_mfma_f32_16x16x32_bf16 v[140:143], v[116:119], v[12:15], 0
s_add_u32 s3, s7, s45
buffer_load_dwordx4 v[68:71], v43, s[16:19], s3 offen sc1
v_mfma_f32_16x16x32_bf16 v[168:171], a[136:139], v[208:211], v[168:171]
s_add_u32 s49, s7, s46
buffer_load_dwordx4 v[80:83], v43, s[16:19], s49 offen sc1
v_mfma_f32_16x16x32_bf16 v[172:175], a[140:143], v[208:211], v[172:175]
ds_read_b128 v[84:87], v77 offset:4096
s_waitcnt lgkmcnt(5)
v_mfma_f32_16x16x32_bf16 v[160:163], a[144:147], v[212:215], v[160:163]
ds_read_b128 v[208:211], v252 offset:6144
v_mfma_f32_16x16x32_bf16 v[164:167], a[148:151], v[212:215], v[164:167]
v_mfma_f32_16x16x32_bf16 v[168:171], a[152:155], v[212:215], v[168:171]
v_mfma_f32_16x16x32_bf16 v[172:175], a[156:159], v[212:215], v[172:175]
s_waitcnt vmcnt(11)
s_waitcnt lgkmcnt(5)
v_mfma_f32_16x16x32_bf16 v[160:163], a[160:163], v[216:219], v[160:163]
ds_read_b128 v[212:215], v252 offset:7168
v_mfma_f32_16x16x32_bf16 v[164:167], a[164:167], v[216:219], v[164:167]
v_mfma_f32_16x16x32_bf16 v[168:171], a[168:171], v[216:219], v[168:171]
v_mfma_f32_16x16x32_bf16 v[172:175], a[172:175], v[216:219], v[172:175]
s_waitcnt vmcnt(9)
s_waitcnt lgkmcnt(5)
v_mfma_f32_16x16x32_bf16 v[160:163], a[176:179], v[220:223], v[160:163]
v_swap_b32 v122, v124
v_mfma_f32_16x16x32_bf16 v[164:167], a[180:183], v[220:223], v[164:167]
v_swap_b32 v123, v125
s_nop 1
v_mfma_f32_16x16x32_bf16 v[136:139], v[120:123], v[16:19], v[136:139]
s_add_u32 s49, s29, s42
buffer_load_dwordx4 v[88:91], v47, s[16:19], s49 offen sc1
v_mfma_f32_16x16x32_bf16 v[140:143], v[124:127], v[16:19], v[140:143]
s_add_u32 s3, s29, s43
buffer_load_dwordx4 v[92:95], v47, s[16:19], s3 offen sc1
v_mfma_f32_16x16x32_bf16 v[168:171], a[184:187], v[220:223], v[168:171]
v_mfma_f32_16x16x32_bf16 v[172:175], a[188:191], v[220:223], v[172:175]
s_waitcnt lgkmcnt(4)
v_mfma_f32_16x16x32_bf16 v[160:163], a[192:195], v[224:227], v[160:163]
v_mfma_f32_16x16x32_bf16 v[164:167], a[196:199], v[224:227], v[164:167]
v_mfma_f32_16x16x32_bf16 v[168:171], a[200:203], v[224:227], v[168:171]
v_mfma_f32_16x16x32_bf16 v[172:175], a[204:207], v[224:227], v[172:175]
s_waitcnt vmcnt(10)
s_waitcnt lgkmcnt(3)
v_mfma_f32_16x16x32_bf16 v[160:163], a[208:211], v[228:231], v[160:163]
s_add_u32 s49, s29, s44
buffer_load_dwordx4 v[96:99], v47, s[16:19], s49 offen sc1
v_mfma_f32_16x16x32_bf16 v[164:167], a[212:215], v[228:231], v[164:167]
s_add_u32 s3, s29, s45
buffer_load_dwordx4 v[100:103], v47, s[16:19], s3 offen sc1
v_mfma_f32_16x16x32_bf16 v[168:171], a[216:219], v[228:231], v[168:171]
v_mfma_f32_16x16x32_bf16 v[172:175], a[220:223], v[228:231], v[172:175]
s_waitcnt vmcnt(11)
s_waitcnt lgkmcnt(1)
v_mfma_f32_16x16x32_bf16 v[160:163], a[224:227], v[208:211], v[160:163]
v_swap_b32 v50, v52
v_mfma_f32_16x16x32_bf16 v[164:167], a[228:231], v[208:211], v[164:167]
v_swap_b32 v51, v53
s_nop 1
v_mfma_f32_16x16x32_bf16 v[136:139], v[48:51], v[20:23], v[136:139]
v_mfma_f32_16x16x32_bf16 v[140:143], v[52:55], v[20:23], v[140:143]
v_mfma_f32_16x16x32_bf16 v[168:171], a[232:235], v[208:211], v[168:171]
v_mfma_f32_16x16x32_bf16 v[172:175], a[236:239], v[208:211], v[172:175]
s_waitcnt vmcnt(10)
s_add_u32 s49, s29, s46
buffer_load_dwordx4 v[112:115], v47, s[16:19], s49 offen sc1
s_add_u32 s3, s29, s47
s_cmp_lt_u32 s37, 4
s_cbranch_scc1 LF_o0
buffer_load_dwordx4 v[116:119], v47, s[16:19], s3 offen sc1
ds_read_b128 v[36:39], v78 offset:0
s_branch LF_j0
LF_o0:
s_mov_b32 s3, 0x70000000
buffer_load_dwordx4 v[36:39], v47, s[16:19], s3 offen sc1
ds_read_b128 v[116:119], v78 offset:0
LF_j0:
v_mul_f32 v136, v136, v41
v_mul_f32 v137, v137, v41
v_mul_f32 v138, v138, v41
v_mul_f32 v139, v139, v41
v_mul_f32 v140, v140, v41
v_mul_f32 v141, v141, v41
v_mul_f32 v142, v142, v41
v_mul_f32 v143, v143, v41
v_cvt_pk_bf16_f32 v136, v136, v137
v_cvt_pk_bf16_f32 v137, v138, v139
v_cvt_pk_bf16_f32 v138, v140, v141
v_cvt_pk_bf16_f32 v139, v142, v143
ds_write_b128 v251, v[136:139] offset:8192
s_waitcnt vmcnt(10)
v_swap_b32 v58, v60
v_swap_b32 v59, v61
s_nop 1
v_mfma_f32_16x16x32_bf16 v[128:131], v[56:59], v[12:15], 0
s_add_u32 s49, s29, s42
buffer_load_dwordx4 v[120:123], v43, s[16:19], s49 offen sc1
v_mfma_f32_16x16x32_bf16 v[132:135], v[60:63], v[12:15], 0
s_add_u32 s3, s29, s43
buffer_load_dwordx4 v[124:127], v43, s[16:19], s3 offen sc1
s_waitcnt vmcnt(11)
s_waitcnt lgkmcnt(2)
v_mfma_f32_16x16x32_bf16 v[160:163], a[240:243], v[212:215], v[160:163]
v_mfma_f32_16x16x32_bf16 v[164:167], a[244:247], v[212:215], v[164:167]
v_mfma_f32_16x16x32_bf16 v[168:171], a[248:251], v[212:215], v[168:171]
v_mfma_f32_16x16x32_bf16 v[172:175], a[252:255], v[212:215], v[172:175]
s_waitcnt vmcnt(9)
v_swap_b32 v66, v68
v_swap_b32 v67, v69
s_nop 1
v_mfma_f32_16x16x32_bf16 v[128:131], v[64:67], v[16:19], v[128:131]
s_add_u32 s49, s29, s44
buffer_load_dwordx4 v[48:51], v43, s[16:19], s49 offen sc1
v_mfma_f32_16x16x32_bf16 v[132:135], v[68:71], v[16:19], v[132:135]
s_add_u32 s3, s29, s45
buffer_load_dwordx4 v[52:55], v43, s[16:19], s3 offen sc1
v_cvt_pk_bf16_f32 v160, v160, v161
v_cvt_pk_bf16_f32 v161, v162, v163
v_cvt_pk_bf16_f32 v162, v164, v165
v_cvt_pk_bf16_f32 v163, v166, v167
ds_write_b128 v245, v[160:163] offset:0
v_cvt_pk_bf16_f32 v168, v168, v169
v_cvt_pk_bf16_f32 v169, v170, v171
v_cvt_pk_bf16_f32 v170, v172, v173
v_cvt_pk_bf16_f32 v171, v174, v175
ds_write_b128 v246, v[168:171] offset:0
ds_read_b128 v[164:167], v247 offset:0
ds_read_b128 v[172:175], v247 offset:1024
s_waitcnt vmcnt(10)
v_swap_b32 v82, v84
v_swap_b32 v83, v85
s_nop 1
v_mfma_f32_16x16x32_bf16 v[128:131], v[80:83], v[20:23], v[128:131]
s_add_u32 s49, s29, s46
buffer_load_dwordx4 v[56:59], v43, s[16:19], s49 offen sc1
v_mfma_f32_16x16x32_bf16 v[132:135], v[84:87], v[20:23], v[132:135]
s_add_u32 s3, s29, s47
s_cmp_lt_u32 s37, 4
s_cbranch_scc1 LF_o1
buffer_load_dwordx4 v[60:63], v43, s[16:19], s3 offen sc1
ds_read_b128 v[36:39], v78 offset:4096
s_branch LF_j1
LF_o1:
s_mov_b32 s3, 0x70000000
buffer_load_dwordx4 v[36:39], v43, s[16:19], s3 offen sc1
ds_read_b128 v[60:63], v78 offset:4096
LF_j1:
s_waitcnt lgkmcnt(2)
buffer_store_dwordx4 v[164:167], v44, s[56:59], s6 offen sc1
s_waitcnt lgkmcnt(1)
buffer_store_dwordx4 v[172:175], v45, s[56:59], s6 offen sc1
v_mul_f32 v128, v128, v41
v_mul_f32 v129, v129, v41
v_mul_f32 v130, v130, v41
v_mul_f32 v131, v131, v41
v_mul_f32 v132, v132, v41
v_mul_f32 v133, v133, v41
v_mul_f32 v134, v134, v41
v_mul_f32 v135, v135, v41
v_cvt_pk_bf16_f32 v128, v128, v129
v_cvt_pk_bf16_f32 v129, v130, v131
v_cvt_pk_bf16_f32 v130, v132, v133
v_cvt_pk_bf16_f32 v131, v134, v135
ds_write_b128 v251, v[128:131] offset:12288
s_waitcnt lgkmcnt(0)
s_barrier
ds_read_b128 v[216:219], v252 offset:8192
ds_read_b128 v[220:223], v252 offset:9216
ds_read_b128 v[224:227], v252 offset:10240
ds_read_b128 v[228:231], v252 offset:11264
ds_read_b128 v[208:211], v252 offset:12288
s_waitcnt vmcnt(12)
s_waitcnt lgkmcnt(4)
v_mfma_f32_16x16x32_bf16 v[176:179], a[128:131], v[216:219], v[176:179]
ds_read_b128 v[212:215], v252 offset:13312
v_swap_b32 v90, v92
v_mfma_f32_16x16x32_bf16 v[180:183], a[132:135], v[216:219], v[180:183]
v_swap_b32 v91, v93
s_nop 1
v_mfma_f32_16x16x32_bf16 v[136:139], v[88:91], v[24:27], 0
v_mfma_f32_16x16x32_bf16 v[140:143], v[92:95], v[24:27], 0
v_mfma_f32_16x16x32_bf16 v[184:187], a[136:139], v[216:219], v[184:187]
v_mfma_f32_16x16x32_bf16 v[188:191], a[140:143], v[216:219], v[188:191]
s_waitcnt lgkmcnt(4)
v_mfma_f32_16x16x32_bf16 v[176:179], a[144:147], v[220:223], v[176:179]
ds_read_b128 v[216:219], v252 offset:14336
v_mfma_f32_16x16x32_bf16 v[180:183], a[148:151], v[220:223], v[180:183]
v_mfma_f32_16x16x32_bf16 v[184:187], a[152:155], v[220:223], v[184:187]
v_mfma_f32_16x16x32_bf16 v[188:191], a[156:159], v[220:223], v[188:191]
s_waitcnt vmcnt(10)
s_waitcnt lgkmcnt(4)
v_mfma_f32_16x16x32_bf16 v[176:179], a[160:163], v[224:227], v[176:179]
v_swap_b32 v98, v100
v_mfma_f32_16x16x32_bf16 v[180:183], a[164:167], v[224:227], v[180:183]
v_swap_b32 v99, v101
s_nop 1
v_mfma_f32_16x16x32_bf16 v[136:139], v[96:99], v[28:31], v[136:139]
v_mfma_f32_16x16x32_bf16 v[140:143], v[100:103], v[28:31], v[140:143]
v_mfma_f32_16x16x32_bf16 v[184:187], a[168:171], v[224:227], v[184:187]
v_mfma_f32_16x16x32_bf16 v[188:191], a[172:175], v[224:227], v[188:191]
s_waitcnt lgkmcnt(3)
v_mfma_f32_16x16x32_bf16 v[176:179], a[176:179], v[228:231], v[176:179]
v_mfma_f32_16x16x32_bf16 v[180:183], a[180:183], v[228:231], v[180:183]
v_mfma_f32_16x16x32_bf16 v[184:187], a[184:187], v[228:231], v[184:187]
v_mfma_f32_16x16x32_bf16 v[188:191], a[188:191], v[228:231], v[188:191]
s_waitcnt vmcnt(8)
s_waitcnt lgkmcnt(2)
v_mfma_f32_16x16x32_bf16 v[176:179], a[192:195], v[208:211], v[176:179]
v_swap_b32 v114, v116
v_mfma_f32_16x16x32_bf16 v[180:183], a[196:199], v[208:211], v[180:183]
v_swap_b32 v115, v117
s_nop 1
v_mfma_f32_16x16x32_bf16 v[136:139], v[112:115], v[32:35], v[136:139]
v_mfma_f32_16x16x32_bf16 v[140:143], v[116:119], v[32:35], v[140:143]
v_mfma_f32_16x16x32_bf16 v[184:187], a[200:203], v[208:211], v[184:187]
v_mfma_f32_16x16x32_bf16 v[188:191], a[204:207], v[208:211], v[188:191]
s_waitcnt lgkmcnt(1)
v_mfma_f32_16x16x32_bf16 v[176:179], a[208:211], v[212:215], v[176:179]
v_mfma_f32_16x16x32_bf16 v[180:183], a[212:215], v[212:215], v[180:183]
v_mfma_f32_16x16x32_bf16 v[184:187], a[216:219], v[212:215], v[184:187]
v_mfma_f32_16x16x32_bf16 v[188:191], a[220:223], v[212:215], v[188:191]
s_waitcnt lgkmcnt(0)
v_mfma_f32_16x16x32_bf16 v[176:179], a[224:227], v[216:219], v[176:179]
v_mul_f32 v136, v136, v42
v_mul_f32 v137, v137, v42
v_mfma_f32_16x16x32_bf16 v[180:183], a[228:231], v[216:219], v[180:183]
v_mul_f32 v138, v138, v42
v_mul_f32 v139, v139, v42
v_mfma_f32_16x16x32_bf16 v[184:187], a[232:235], v[216:219], v[184:187]
v_mul_f32 v140, v140, v42
v_mul_f32 v141, v141, v42
v_mfma_f32_16x16x32_bf16 v[188:191], a[236:239], v[216:219], v[188:191]
v_mul_f32 v142, v142, v42
v_mul_f32 v143, v143, v42
v_cvt_pk_bf16_f32 v136, v136, v137
v_cvt_pk_bf16_f32 v137, v138, v139
v_cvt_pk_bf16_f32 v138, v140, v141
v_cvt_pk_bf16_f32 v139, v142, v143
ds_write_b128 v251, v[136:139] offset:16384
s_waitcnt lgkmcnt(0)
s_barrier
ds_read_b128 v[220:223], v252 offset:15360
ds_read_b128 v[224:227], v252 offset:16384
ds_read_b128 v[228:231], v252 offset:17408
ds_read_b128 v[208:211], v252 offset:18432
ds_read_b128 v[212:215], v252 offset:19456
s_waitcnt vmcnt(6)
s_waitcnt lgkmcnt(4)
v_mfma_f32_16x16x32_bf16 v[176:179], a[240:243], v[220:223], v[176:179]
v_swap_b32 v122, v124
v_mfma_f32_16x16x32_bf16 v[180:183], a[244:247], v[220:223], v[180:183]
v_swap_b32 v123, v125
s_nop 1
v_mfma_f32_16x16x32_bf16 v[128:131], v[120:123], v[24:27], 0
v_mfma_f32_16x16x32_bf16 v[132:135], v[124:127], v[24:27], 0
v_mfma_f32_16x16x32_bf16 v[184:187], a[248:251], v[220:223], v[184:187]
v_mfma_f32_16x16x32_bf16 v[188:191], a[252:255], v[220:223], v[188:191]
s_waitcnt lgkmcnt(3)
v_mfma_f32_16x16x32_bf16 v[192:195], a[128:131], v[224:227], v[192:195]
v_mfma_f32_16x16x32_bf16 v[196:199], a[132:135], v[224:227], v[196:199]
v_mfma_f32_16x16x32_bf16 v[200:203], a[136:139], v[224:227], v[200:203]
v_mfma_f32_16x16x32_bf16 v[204:207], a[140:143], v[224:227], v[204:207]
s_waitcnt vmcnt(4)
s_waitcnt lgkmcnt(2)
v_mfma_f32_16x16x32_bf16 v[192:195], a[144:147], v[228:231], v[192:195]
v_swap_b32 v50, v52
v_mfma_f32_16x16x32_bf16 v[196:199], a[148:151], v[228:231], v[196:199]
v_swap_b32 v51, v53
s_nop 1
v_mfma_f32_16x16x32_bf16 v[128:131], v[48:51], v[28:31], v[128:131]
v_cvt_pk_bf16_f32 v176, v176, v177
v_cvt_pk_bf16_f32 v177, v178, v179
v_mfma_f32_16x16x32_bf16 v[132:135], v[52:55], v[28:31], v[132:135]
v_cvt_pk_bf16_f32 v178, v180, v181
v_cvt_pk_bf16_f32 v179, v182, v183
v_mfma_f32_16x16x32_bf16 v[200:203], a[152:155], v[228:231], v[200:203]
ds_write_b128 v245, v[176:179] offset:2048
v_cvt_pk_bf16_f32 v184, v184, v185
v_mfma_f32_16x16x32_bf16 v[204:207], a[156:159], v[228:231], v[204:207]
v_cvt_pk_bf16_f32 v185, v186, v187
v_cvt_pk_bf16_f32 v186, v188, v189
s_waitcnt lgkmcnt(2)
v_mfma_f32_16x16x32_bf16 v[192:195], a[160:163], v[208:211], v[192:195]
v_cvt_pk_bf16_f32 v187, v190, v191
ds_write_b128 v246, v[184:187] offset:2048
v_mfma_f32_16x16x32_bf16 v[196:199], a[164:167], v[208:211], v[196:199]
ds_read_b128 v[180:183], v247 offset:2048
ds_read_b128 v[188:191], v247 offset:3072
v_mfma_f32_16x16x32_bf16 v[200:203], a[168:171], v[208:211], v[200:203]
v_mfma_f32_16x16x32_bf16 v[204:207], a[172:175], v[208:211], v[204:207]
s_waitcnt vmcnt(2)
s_waitcnt lgkmcnt(4)
v_mfma_f32_16x16x32_bf16 v[192:195], a[176:179], v[212:215], v[192:195]
v_swap_b32 v58, v60
v_mfma_f32_16x16x32_bf16 v[196:199], a[180:183], v[212:215], v[196:199]
v_swap_b32 v59, v61
s_nop 1
v_mfma_f32_16x16x32_bf16 v[128:131], v[56:59], v[32:35], v[128:131]
s_waitcnt lgkmcnt(1)
buffer_store_dwordx4 v[180:183], v44, s[56:59], s7 offen sc1
v_mfma_f32_16x16x32_bf16 v[132:135], v[60:63], v[32:35], v[132:135]
s_waitcnt lgkmcnt(0)
buffer_store_dwordx4 v[188:191], v45, s[56:59], s7 offen sc1
v_mfma_f32_16x16x32_bf16 v[200:203], a[184:187], v[212:215], v[200:203]
v_mfma_f32_16x16x32_bf16 v[204:207], a[188:191], v[212:215], v[204:207]
s_nop 0
v_mul_f32 v128, v128, v42
v_mul_f32 v129, v129, v42
v_mul_f32 v130, v130, v42
v_mul_f32 v131, v131, v42
v_mul_f32 v132, v132, v42
v_mul_f32 v133, v133, v42
v_mul_f32 v134, v134, v42
v_mul_f32 v135, v135, v42
v_cvt_pk_bf16_f32 v128, v128, v129
v_cvt_pk_bf16_f32 v129, v130, v131
v_cvt_pk_bf16_f32 v130, v132, v133
v_cvt_pk_bf16_f32 v131, v134, v135
ds_write_b128 v251, v[128:131] offset:20480
s_waitcnt lgkmcnt(0)
s_barrier
ds_read_b128 v[216:219], v252 offset:20480
ds_read_b128 v[220:223], v252 offset:21504
ds_read_b128 v[224:227], v252 offset:22528
ds_read_b128 v[228:231], v252 offset:23552
s_waitcnt lgkmcnt(3)
v_mfma_f32_16x16x32_bf16 v[192:195], a[192:195], v[216:219], v[192:195]
v_mfma_f32_16x16x32_bf16 v[196:199], a[196:199], v[216:219], v[196:199]
v_mfma_f32_16x16x32_bf16 v[200:203], a[200:203], v[216:219], v[200:203]
v_mfma_f32_16x16x32_bf16 v[204:207], a[204:207], v[216:219], v[204:207]
s_waitcnt lgkmcnt(2)
v_mfma_f32_16x16x32_bf16 v[192:195], a[208:211], v[220:223], v[192:195]
v_mfma_f32_16x16x32_bf16 v[196:199], a[212:215], v[220:223], v[196:199]
v_mfma_f32_16x16x32_bf16 v[200:203], a[216:219], v[220:223], v[200:203]
v_mfma_f32_16x16x32_bf16 v[204:207], a[220:223], v[220:223], v[204:207]
s_waitcnt lgkmcnt(1)
v_mfma_f32_16x16x32_bf16 v[192:195], a[224:227], v[224:227], v[192:195]
v_mfma_f32_16x16x32_bf16 v[196:199], a[228:231], v[224:227], v[196:199]
v_mfma_f32_16x16x32_bf16 v[200:203], a[232:235], v[224:227], v[200:203]
v_mfma_f32_16x16x32_bf16 v[204:207], a[236:239], v[224:227], v[204:207]
s_waitcnt lgkmcnt(0)
v_mfma_f32_16x16x32_bf16 v[192:195], a[240:243], v[228:231], v[192:195]
v_mfma_f32_16x16x32_bf16 v[196:199], a[244:247], v[228:231], v[196:199]
v_mfma_f32_16x16x32_bf16 v[200:203], a[248:251], v[228:231], v[200:203]
v_mfma_f32_16x16x32_bf16 v[204:207], a[252:255], v[228:231], v[204:207]
s_nop 4
v_cvt_pk_bf16_f32 v192, v192, v193
v_cvt_pk_bf16_f32 v193, v194, v195
v_cvt_pk_bf16_f32 v194, v196, v197
v_cvt_pk_bf16_f32 v195, v198, v199
ds_write_b128 v245, v[192:195] offset:4096
v_cvt_pk_bf16_f32 v200, v200, v201
v_cvt_pk_bf16_f32 v201, v202, v203
v_cvt_pk_bf16_f32 v202, v204, v205
v_cvt_pk_bf16_f32 v203, v206, v207
ds_write_b128 v246, v[200:203] offset:4096
ds_read_b128 v[196:199], v247 offset:4096
ds_read_b128 v[204:207], v247 offset:5120
s_waitcnt lgkmcnt(1)
buffer_store_dwordx4 v[196:199], v44, s[56:59], s29 offen sc1
s_waitcnt lgkmcnt(0)
buffer_store_dwordx4 v[204:207], v45, s[56:59], s29 offen sc1
s_branch L2_fin
LF_spinQ:
s_mov_b32 s94, 0x10000
LF_spin2Q:
buffer_load_dwordx2 v[248:249], v46, s[16:19], 0 offen offset:0 sc1
s_sub_u32 s94, s94, 1
s_waitcnt vmcnt(0)
s_cbranch_scc1 LF_spin2Q_go
v_cmp_ne_u64 vcc, s[98:99], v[248:249]
s_nop 1
s_cbranch_vccnz LF_spin2Q
LF_spin2Q_go:
s_branch LF_goQ
LF_wf:
s_mov_b32 s94, 0x10000
LF_wf2:
buffer_load_dwordx2 v[108:109], v110, s[16:19], 0 offen sc1
s_sub_u32 s94, s94, 1
s_waitcnt vmcnt(0)
s_cbranch_scc1 LF_wf2_go
v_cmp_ne_u64 vcc, s[98:99], v[108:109]
s_nop 1
s_cbranch_vccnz LF_wf2
LF_wf2_go:
s_branch LF_wf_go
LM_pb:
s_mov_b32 s3, 0x10000
LM_pb2:
buffer_load_dwordx2 v[228:229], v230, s[16:19], 0 offen sc1
s_sub_u32 s3, s3, 1
s_waitcnt vmcnt(0)
s_cbranch_scc1 LM_pb2_go
v_cmp_ne_u64 vcc, s[98:99], v[228:229]
s_nop 1
s_cbranch_vccnz LM_pb2
LM_pb2_go:
s_branch LM_pb_ret
L2_Fend:
L2_rare_site0:
s_mov_b32 s36, 0
s_branch L2_rare_0_0
L2_rare_site4:
s_mov_b32 s36, 4
s_branch L2_rare_0_0
L2_rare_0_0:
s_nop 15
s_nop 15
s_waitcnt lgkmcnt(0)
v_add_u32 v250, 0x18000, v240
v_and_b32 v250, 0x1ffff, v250
ds_read_b128 v[232:235], v250 offset:16384
s_waitcnt lgkmcnt(0)
v_mfma_f32_16x16x32_bf16 v[128:131], v[232:235], v[0:3], v[192:195]
v_mfma_f32_16x16x32_bf16 v[132:135], v[232:235], v[32:35], v[196:199]
v_mfma_f32_16x16x32_bf16 v[136:139], v[232:235], v[64:67], v[200:203]
v_mfma_f32_16x16x32_bf16 v[140:143], v[232:235], v[96:99], v[204:207]
s_nop 7
ds_read_b128 v[232:235], v250 offset:16896
s_waitcnt lgkmcnt(0)
v_mfma_f32_16x16x32_bf16 v[128:131], v[232:235], v[4:7], v[128:131]
v_mfma_f32_16x16x32_bf16 v[132:135], v[232:235], v[36:39], v[132:135]
v_mfma_f32_16x16x32_bf16 v[136:139], v[232:235], v[68:71], v[136:139]
v_mfma_f32_16x16x32_bf16 v[140:143], v[232:235], v[100:103], v[140:143]
s_nop 7
ds_read_b128 v[232:235], v250 offset:20480
s_waitcnt lgkmcnt(0)
v_mfma_f32_16x16x32_bf16 v[128:131], v[232:235], v[8:11], v[128:131]
v_mfma_f32_16x16x32_bf16 v[132:135], v[232:235], v[40:43], v[132:135]
v_mfma_f32_16x16x32_bf16 v[136:139], v[232:235], v[72:75], v[136:139]
v_mfma_f32_16x16x32_bf16 v[140:143], v[232:235], v[104:107], v[140:143]
s_nop 7
ds_read_b128 v[232:235], v250 offset:20992
s_waitcnt lgkmcnt(0)
v_mfma_f32_16x16x32_bf16 v[128:131], v[232:235], v[12:15], v[128:131]
v_mfma_f32_16x16x32_bf16 v[132:135], v[232:235], v[44:47], v[132:135]
v_mfma_f32_16x16x32_bf16 v[136:139], v[232:235], v[76:79], v[136:139]
v_mfma_f32_16x16x32_bf16 v[140:143], v[232:235], v[108:111], v[140:143]
s_nop 7
ds_read_b128 v[232:235], v250 offset:24576
s_waitcnt lgkmcnt(0)
v_mfma_f32_16x16x32_bf16 v[128:131], v[232:235], v[16:19], v[128:131]
v_mfma_f32_16x16x32_bf16 v[132:135], v[232:235], v[48:51], v[132:135]
v_mfma_f32_16x16x32_bf16 v[136:139], v[232:235], v[80:83], v[136:139]
v_mfma_f32_16x16x32_bf16 v[140:143], v[232:235], v[112:115], v[140:143]
s_nop 7
ds_read_b128 v[232:235], v250 offset:25088
s_waitcnt lgkmcnt(0)
v_mfma_f32_16x16x32_bf16 v[128:131], v[232:235], v[20:23], v[128:131]
v_mfma_f32_16x16x32_bf16 v[132:135], v[232:235], v[52:55], v[132:135]
v_mfma_f32_16x16x32_bf16 v[136:139], v[232:235], v[84:87], v[136:139]
v_mfma_f32_16x16x32_bf16 v[140:143], v[232:235], v[116:119], v[140:143]
s_nop 7
ds_read_b128 v[232:235], v250 offset:28672
s_waitcnt lgkmcnt(0)
v_mfma_f32_16x16x32_bf16 v[128:131], v[232:235], v[24:27], v[128:131]
v_mfma_f32_16x16x32_bf16 v[132:135], v[232:235], v[56:59], v[132:135]
v_mfma_f32_16x16x32_bf16 v[136:139], v[232:235], v[88:91], v[136:139]
v_mfma_f32_16x16x32_bf16 v[140:143], v[232:235], v[120:123], v[140:143]
s_nop 7
ds_read_b128 v[232:235], v250 offset:29184
s_waitcnt lgkmcnt(0)
v_mfma_f32_16x16x32_bf16 v[128:131], v[232:235], v[28:31], v[128:131]
v_mfma_f32_16x16x32_bf16 v[132:135], v[232:235], v[60:63], v[132:135]
v_mfma_f32_16x16x32_bf16 v[136:139], v[232:235], v[92:95], v[136:139]
v_mfma_f32_16x16x32_bf16 v[140:143], v[232:235], v[124:127], v[140:143]
s_nop 7
s_nop 7
v_exp_f32 v248, v128
s_nop 0
v_sub_f32 v224, v224, v248
v_exp_f32 v248, v129
s_nop 0
v_sub_f32 v224, v224, v248
v_exp_f32 v248, v130
s_nop 0
v_sub_f32 v224, v224, v248
v_exp_f32 v248, v131
s_nop 0
v_sub_f32 v224, v224, v248
v_max_f32 v224, 0, v224
v_min_f32 v224, s32, v224
v_log_f32 v248, v224
v_max3_f32 v232, v128, v129, v130
v_max3_f32 v232, v232, v131, v248
v_mov_b32 v248, v232
s_nop 1
v_permlane32_swap_b32 v232, v248
s_nop 1
v_max_f32 v232, v232, v248
v_mov_b32 v248, v232
s_nop 1
v_permlane16_swap_b32 v232, v248
s_nop 1
v_max_f32 v232, v232, v248
v_ceil_f32 v232, v232
v_max_f32 v232, 0, v232
v_sub_f32 v248, 0, v232
v_exp_f32 v236, v248
s_nop 1
v_mul_f32 v224, v224, v236
v_sub_f32 v192, v192, v232
v_sub_f32 v128, v128, v232
v_sub_f32 v144, v144, v232
v_sub_f32 v193, v193, v232
v_sub_f32 v129, v129, v232
v_sub_f32 v145, v145, v232
v_sub_f32 v194, v194, v232
v_sub_f32 v130, v130, v232
v_sub_f32 v146, v146, v232
v_sub_f32 v195, v195, v232
v_sub_f32 v131, v131, v232
v_sub_f32 v147, v147, v232
v_lshlrev_b32 v242, 16, v160
v_and_b32 v248, 0xffff0000, v160
v_mul_f32 v242, v242, v236
v_mul_f32 v248, v248, v236
v_cvt_pk_bf16_f32 v160, v242, v248
v_lshlrev_b32 v242, 16, v161
v_and_b32 v248, 0xffff0000, v161
v_mul_f32 v242, v242, v236
v_mul_f32 v248, v248, v236
v_cvt_pk_bf16_f32 v161, v242, v248
v_lshlrev_b32 v242, 16, v162
v_and_b32 v248, 0xffff0000, v162
v_mul_f32 v242, v242, v236
v_mul_f32 v248, v248, v236
v_cvt_pk_bf16_f32 v162, v242, v248
v_lshlrev_b32 v242, 16, v163
v_and_b32 v248, 0xffff0000, v163
v_mul_f32 v242, v242, v236
v_mul_f32 v248, v248, v236
v_cvt_pk_bf16_f32 v163, v242, v248
v_lshlrev_b32 v242, 16, v176
v_and_b32 v248, 0xffff0000, v176
v_mul_f32 v242, v242, v236
v_mul_f32 v248, v248, v236
v_cvt_pk_bf16_f32 v176, v242, v248
v_lshlrev_b32 v242, 16, v177
v_and_b32 v248, 0xffff0000, v177
v_mul_f32 v242, v242, v236
v_mul_f32 v248, v248, v236
v_cvt_pk_bf16_f32 v177, v242, v248
v_lshlrev_b32 v242, 16, v178
v_and_b32 v248, 0xffff0000, v178
v_mul_f32 v242, v242, v236
v_mul_f32 v248, v248, v236
v_cvt_pk_bf16_f32 v178, v242, v248
v_lshlrev_b32 v242, 16, v179
v_and_b32 v248, 0xffff0000, v179
v_mul_f32 v242, v242, v236
v_mul_f32 v248, v248, v236
v_cvt_pk_bf16_f32 v179, v242, v248
v_exp_f32 v248, v132
s_nop 0
v_sub_f32 v225, v225, v248
v_exp_f32 v248, v133
s_nop 0
v_sub_f32 v225, v225, v248
v_exp_f32 v248, v134
s_nop 0
v_sub_f32 v225, v225, v248
v_exp_f32 v248, v135
s_nop 0
v_sub_f32 v225, v225, v248
v_max_f32 v225, 0, v225
v_min_f32 v225, s32, v225
v_log_f32 v248, v225
v_max3_f32 v233, v132, v133, v134
v_max3_f32 v233, v233, v135, v248
v_mov_b32 v248, v233
s_nop 1
v_permlane32_swap_b32 v233, v248
s_nop 1
v_max_f32 v233, v233, v248
v_mov_b32 v248, v233
s_nop 1
v_permlane16_swap_b32 v233, v248
s_nop 1
v_max_f32 v233, v233, v248
v_ceil_f32 v233, v233
v_max_f32 v233, 0, v233
v_sub_f32 v248, 0, v233
v_exp_f32 v237, v248
s_nop 1
v_mul_f32 v225, v225, v237
v_sub_f32 v196, v196, v233
v_sub_f32 v132, v132, v233
v_sub_f32 v148, v148, v233
v_sub_f32 v197, v197, v233
v_sub_f32 v133, v133, v233
v_sub_f32 v149, v149, v233
v_sub_f32 v198, v198, v233
v_sub_f32 v134, v134, v233
v_sub_f32 v150, v150, v233
v_sub_f32 v199, v199, v233
v_sub_f32 v135, v135, v233
v_sub_f32 v151, v151, v233
v_lshlrev_b32 v242, 16, v164
v_and_b32 v248, 0xffff0000, v164
v_mul_f32 v242, v242, v237
v_mul_f32 v248, v248, v237
v_cvt_pk_bf16_f32 v164, v242, v248
v_lshlrev_b32 v242, 16, v165
v_and_b32 v248, 0xffff0000, v165
v_mul_f32 v242, v242, v237
v_mul_f32 v248, v248, v237
v_cvt_pk_bf16_f32 v165, v242, v248
v_lshlrev_b32 v242, 16, v166
v_and_b32 v248, 0xffff0000, v166
v_mul_f32 v242, v242, v237
v_mul_f32 v248, v248, v237
v_cvt_pk_bf16_f32 v166, v242, v248
v_lshlrev_b32 v242, 16, v167
v_and_b32 v248, 0xffff0000, v167
v_mul_f32 v242, v242, v237
v_mul_f32 v248, v248, v237
v_cvt_pk_bf16_f32 v167, v242, v248
v_lshlrev_b32 v242, 16, v180
v_and_b32 v248, 0xffff0000, v180
v_mul_f32 v242, v242, v237
v_mul_f32 v248, v248, v237
v_cvt_pk_bf16_f32 v180, v242, v248
v_lshlrev_b32 v242, 16, v181
v_and_b32 v248, 0xffff0000, v181
v_mul_f32 v242, v242, v237
v_mul_f32 v248, v248, v237
v_cvt_pk_bf16_f32 v181, v242, v248
v_lshlrev_b32 v242, 16, v182
v_and_b32 v248, 0xffff0000, v182
v_mul_f32 v242, v242, v237
v_mul_f32 v248, v248, v237
v_cvt_pk_bf16_f32 v182, v242, v248
v_lshlrev_b32 v242, 16, v183
v_and_b32 v248, 0xffff0000, v183
v_mul_f32 v242, v242, v237
v_mul_f32 v248, v248, v237
v_cvt_pk_bf16_f32 v183, v242, v248
v_exp_f32 v248, v136
s_nop 0
v_sub_f32 v226, v226, v248
v_exp_f32 v248, v137
s_nop 0
v_sub_f32 v226, v226, v248
v_exp_f32 v248, v138
s_nop 0
v_sub_f32 v226, v226, v248
v_exp_f32 v248, v139
s_nop 0
v_sub_f32 v226, v226, v248
v_max_f32 v226, 0, v226
v_min_f32 v226, s32, v226
v_log_f32 v248, v226
v_max3_f32 v234, v136, v137, v138
v_max3_f32 v234, v234, v139, v248
v_mov_b32 v248, v234
s_nop 1
v_permlane32_swap_b32 v234, v248
s_nop 1
v_max_f32 v234, v234, v248
v_mov_b32 v248, v234
s_nop 1
v_permlane16_swap_b32 v234, v248
s_nop 1
v_max_f32 v234, v234, v248
v_ceil_f32 v234, v234
v_max_f32 v234, 0, v234
v_sub_f32 v248, 0, v234
v_exp_f32 v238, v248
s_nop 1
v_mul_f32 v226, v226, v238
v_sub_f32 v200, v200, v234
v_sub_f32 v136, v136, v234
v_sub_f32 v152, v152, v234
v_sub_f32 v201, v201, v234
v_sub_f32 v137, v137, v234
v_sub_f32 v153, v153, v234
v_sub_f32 v202, v202, v234
v_sub_f32 v138, v138, v234
v_sub_f32 v154, v154, v234
v_sub_f32 v203, v203, v234
v_sub_f32 v139, v139, v234
v_sub_f32 v155, v155, v234
v_lshlrev_b32 v242, 16, v168
v_and_b32 v248, 0xffff0000, v168
v_mul_f32 v242, v242, v238
v_mul_f32 v248, v248, v238
v_cvt_pk_bf16_f32 v168, v242, v248
v_lshlrev_b32 v242, 16, v169
v_and_b32 v248, 0xffff0000, v169
v_mul_f32 v242, v242, v238
v_mul_f32 v248, v248, v238
v_cvt_pk_bf16_f32 v169, v242, v248
v_lshlrev_b32 v242, 16, v170
v_and_b32 v248, 0xffff0000, v170
v_mul_f32 v242, v242, v238
v_mul_f32 v248, v248, v238
v_cvt_pk_bf16_f32 v170, v242, v248
v_lshlrev_b32 v242, 16, v171
v_and_b32 v248, 0xffff0000, v171
v_mul_f32 v242, v242, v238
v_mul_f32 v248, v248, v238
v_cvt_pk_bf16_f32 v171, v242, v248
v_lshlrev_b32 v242, 16, v184
v_and_b32 v248, 0xffff0000, v184
v_mul_f32 v242, v242, v238
v_mul_f32 v248, v248, v238
v_cvt_pk_bf16_f32 v184, v242, v248
v_lshlrev_b32 v242, 16, v185
v_and_b32 v248, 0xffff0000, v185
v_mul_f32 v242, v242, v238
v_mul_f32 v248, v248, v238
v_cvt_pk_bf16_f32 v185, v242, v248
v_lshlrev_b32 v242, 16, v186
v_and_b32 v248, 0xffff0000, v186
v_mul_f32 v242, v242, v238
v_mul_f32 v248, v248, v238
v_cvt_pk_bf16_f32 v186, v242, v248
v_lshlrev_b32 v242, 16, v187
v_and_b32 v248, 0xffff0000, v187
v_mul_f32 v242, v242, v238
v_mul_f32 v248, v248, v238
v_cvt_pk_bf16_f32 v187, v242, v248
v_exp_f32 v248, v140
s_nop 0
v_sub_f32 v227, v227, v248
v_exp_f32 v248, v141
s_nop 0
v_sub_f32 v227, v227, v248
v_exp_f32 v248, v142
s_nop 0
v_sub_f32 v227, v227, v248
v_exp_f32 v248, v143
s_nop 0
v_sub_f32 v227, v227, v248
v_max_f32 v227, 0, v227
v_min_f32 v227, s32, v227
v_log_f32 v248, v227
v_max3_f32 v235, v140, v141, v142
v_max3_f32 v235, v235, v143, v248
v_mov_b32 v248, v235
s_nop 1
v_permlane32_swap_b32 v235, v248
s_nop 1
v_max_f32 v235, v235, v248
v_mov_b32 v248, v235
s_nop 1
v_permlane16_swap_b32 v235, v248
s_nop 1
v_max_f32 v235, v235, v248
v_ceil_f32 v235, v235
v_max_f32 v235, 0, v235
v_sub_f32 v248, 0, v235
v_exp_f32 v239, v248
s_nop 1
v_mul_f32 v227, v227, v239
v_sub_f32 v204, v204, v235
v_sub_f32 v140, v140, v235
v_sub_f32 v156, v156, v235
v_sub_f32 v205, v205, v235
v_sub_f32 v141, v141, v235
v_sub_f32 v157, v157, v235
v_sub_f32 v206, v206, v235
v_sub_f32 v142, v142, v235
v_sub_f32 v158, v158, v235
v_sub_f32 v207, v207, v235
v_sub_f32 v143, v143, v235
v_sub_f32 v159, v159, v235
v_lshlrev_b32 v242, 16, v172
v_and_b32 v248, 0xffff0000, v172
v_mul_f32 v242, v242, v239
v_mul_f32 v248, v248, v239
v_cvt_pk_bf16_f32 v172, v242, v248
v_lshlrev_b32 v242, 16, v173
v_and_b32 v248, 0xffff0000, v173
v_mul_f32 v242, v242, v239
v_mul_f32 v248, v248, v239
v_cvt_pk_bf16_f32 v173, v242, v248
v_lshlrev_b32 v242, 16, v174
v_and_b32 v248, 0xffff0000, v174
v_mul_f32 v242, v242, v239
v_mul_f32 v248, v248, v239
v_cvt_pk_bf16_f32 v174, v242, v248
v_lshlrev_b32 v242, 16, v175
v_and_b32 v248, 0xffff0000, v175
v_mul_f32 v242, v242, v239
v_mul_f32 v248, v248, v239
v_cvt_pk_bf16_f32 v175, v242, v248
v_lshlrev_b32 v242, 16, v188
v_and_b32 v248, 0xffff0000, v188
v_mul_f32 v242, v242, v239
v_mul_f32 v248, v248, v239
v_cvt_pk_bf16_f32 v188, v242, v248
v_lshlrev_b32 v242, 16, v189
v_and_b32 v248, 0xffff0000, v189
v_mul_f32 v242, v242, v239
v_mul_f32 v248, v248, v239
v_cvt_pk_bf16_f32 v189, v242, v248
v_lshlrev_b32 v242, 16, v190
v_and_b32 v248, 0xffff0000, v190
v_mul_f32 v242, v242, v239
v_mul_f32 v248, v248, v239
v_cvt_pk_bf16_f32 v190, v242, v248
v_lshlrev_b32 v242, 16, v191
v_and_b32 v248, 0xffff0000, v191
v_mul_f32 v242, v242, v239
v_mul_f32 v248, v248, v239
v_cvt_pk_bf16_f32 v191, v242, v248
v_exp_f32 v128, v128
v_exp_f32 v129, v129
v_exp_f32 v130, v130
v_exp_f32 v131, v131
s_nop 1
v_add_f32 v224, v224, v128
v_add_f32 v224, v224, v129
v_add_f32 v224, v224, v130
v_add_f32 v224, v224, v131
v_exp_f32 v132, v132
v_exp_f32 v133, v133
v_exp_f32 v134, v134
v_exp_f32 v135, v135
s_nop 1
v_add_f32 v225, v225, v132
v_add_f32 v225, v225, v133
v_add_f32 v225, v225, v134
v_add_f32 v225, v225, v135
v_exp_f32 v136, v136
v_exp_f32 v137, v137
v_exp_f32 v138, v138
v_exp_f32 v139, v139
s_nop 1
v_add_f32 v226, v226, v136
v_add_f32 v226, v226, v137
v_add_f32 v226, v226, v138
v_add_f32 v226, v226, v139
v_exp_f32 v140, v140
v_exp_f32 v141, v141
v_exp_f32 v142, v142
v_exp_f32 v143, v143
s_nop 1
v_add_f32 v227, v227, v140
v_add_f32 v227, v227, v141
v_add_f32 v227, v227, v142
v_add_f32 v227, v227, v143
s_branch L2_rare_common
L2_rare_site1:
s_mov_b32 s36, 1
s_branch L2_rare_0_1
L2_rare_site5:
s_mov_b32 s36, 5
s_branch L2_rare_0_1
L2_rare_0_1:
s_nop 15
s_nop 15
s_waitcnt lgkmcnt(0)
v_add_u32 v250, 0x18000, v240
v_and_b32 v250, 0x1ffff, v250
ds_read_b128 v[232:235], v250 offset:18432
s_waitcnt lgkmcnt(0)
v_mfma_f32_16x16x32_bf16 v[144:147], v[232:235], v[0:3], v[192:195]
v_mfma_f32_16x16x32_bf16 v[148:151], v[232:235], v[32:35], v[196:199]
v_mfma_f32_16x16x32_bf16 v[152:155], v[232:235], v[64:67], v[200:203]
v_mfma_f32_16x16x32_bf16 v[156:159], v[232:235], v[96:99], v[204:207]
s_nop 7
ds_read_b128 v[232:235], v250 offset:18944
s_waitcnt lgkmcnt(0)
v_mfma_f32_16x16x32_bf16 v[144:147], v[232:235], v[4:7], v[144:147]
v_mfma_f32_16x16x32_bf16 v[148:151], v[232:235], v[36:39], v[148:151]
v_mfma_f32_16x16x32_bf16 v[152:155], v[232:235], v[68:71], v[152:155]
v_mfma_f32_16x16x32_bf16 v[156:159], v[232:235], v[100:103], v[156:159]
s_nop 7
ds_read_b128 v[232:235], v250 offset:22528
s_waitcnt lgkmcnt(0)
v_mfma_f32_16x16x32_bf16 v[144:147], v[232:235], v[8:11], v[144:147]
v_mfma_f32_16x16x32_bf16 v[148:151], v[232:235], v[40:43], v[148:151]
v_mfma_f32_16x16x32_bf16 v[152:155], v[232:235], v[72:75], v[152:155]
v_mfma_f32_16x16x32_bf16 v[156:159], v[232:235], v[104:107], v[156:159]
s_nop 7
ds_read_b128 v[232:235], v250 offset:23040
s_waitcnt lgkmcnt(0)
v_mfma_f32_16x16x32_bf16 v[144:147], v[232:235], v[12:15], v[144:147]
v_mfma_f32_16x16x32_bf16 v[148:151], v[232:235], v[44:47], v[148:151]
v_mfma_f32_16x16x32_bf16 v[152:155], v[232:235], v[76:79], v[152:155]
v_mfma_f32_16x16x32_bf16 v[156:159], v[232:235], v[108:111], v[156:159]
s_nop 7
ds_read_b128 v[232:235], v250 offset:26624
s_waitcnt lgkmcnt(0)
v_mfma_f32_16x16x32_bf16 v[144:147], v[232:235], v[16:19], v[144:147]
v_mfma_f32_16x16x32_bf16 v[148:151], v[232:235], v[48:51], v[148:151]
v_mfma_f32_16x16x32_bf16 v[152:155], v[232:235], v[80:83], v[152:155]
v_mfma_f32_16x16x32_bf16 v[156:159], v[232:235], v[112:115], v[156:159]
s_nop 7
ds_read_b128 v[232:235], v250 offset:27136
s_waitcnt lgkmcnt(0)
v_mfma_f32_16x16x32_bf16 v[144:147], v[232:235], v[20:23], v[144:147]
v_mfma_f32_16x16x32_bf16 v[148:151], v[232:235], v[52:55], v[148:151]
v_mfma_f32_16x16x32_bf16 v[152:155], v[232:235], v[84:87], v[152:155]
v_mfma_f32_16x16x32_bf16 v[156:159], v[232:235], v[116:119], v[156:159]
s_nop 7
ds_read_b128 v[232:235], v250 offset:30720
s_waitcnt lgkmcnt(0)
v_mfma_f32_16x16x32_bf16 v[144:147], v[232:235], v[24:27], v[144:147]
v_mfma_f32_16x16x32_bf16 v[148:151], v[232:235], v[56:59], v[148:151]
v_mfma_f32_16x16x32_bf16 v[152:155], v[232:235], v[88:91], v[152:155]
v_mfma_f32_16x16x32_bf16 v[156:159], v[232:235], v[120:123], v[156:159]
s_nop 7
ds_read_b128 v[232:235], v250 offset:31232
s_waitcnt lgkmcnt(0)
v_mfma_f32_16x16x32_bf16 v[144:147], v[232:235], v[28:31], v[144:147]
v_mfma_f32_16x16x32_bf16 v[148:151], v[232:235], v[60:63], v[148:151]
v_mfma_f32_16x16x32_bf16 v[152:155], v[232:235], v[92:95], v[152:155]
v_mfma_f32_16x16x32_bf16 v[156:159], v[232:235], v[124:127], v[156:159]
s_nop 7
s_nop 7
v_exp_f32 v248, v144
s_nop 0
v_sub_f32 v224, v224, v248
v_exp_f32 v248, v145
s_nop 0
v_sub_f32 v224, v224, v248
v_exp_f32 v248, v146
s_nop 0
v_sub_f32 v224, v224, v248
v_exp_f32 v248, v147
s_nop 0
v_sub_f32 v224, v224, v248
v_max_f32 v224, 0, v224
v_min_f32 v224, s32, v224
v_log_f32 v248, v224
v_max3_f32 v232, v144, v145, v146
v_max3_f32 v232, v232, v147, v248
v_mov_b32 v248, v232
s_nop 1
v_permlane32_swap_b32 v232, v248
s_nop 1
v_max_f32 v232, v232, v248
v_mov_b32 v248, v232
s_nop 1
v_permlane16_swap_b32 v232, v248
s_nop 1
v_max_f32 v232, v232, v248
v_ceil_f32 v232, v232
v_max_f32 v232, 0, v232
v_sub_f32 v248, 0, v232
v_exp_f32 v236, v248
s_nop 1
v_mul_f32 v224, v224, v236
v_sub_f32 v192, v192, v232
v_sub_f32 v128, v128, v232
v_sub_f32 v144, v144, v232
v_sub_f32 v193, v193, v232
v_sub_f32 v129, v129, v232
v_sub_f32 v145, v145, v232
v_sub_f32 v194, v194, v232
v_sub_f32 v130, v130, v232
v_sub_f32 v146, v146, v232
v_sub_f32 v195, v195, v232
v_sub_f32 v131, v131, v232
v_sub_f32 v147, v147, v232
v_lshlrev_b32 v242, 16, v160
v_and_b32 v248, 0xffff0000, v160
v_mul_f32 v242, v242, v236
v_mul_f32 v248, v248, v236
v_cvt_pk_bf16_f32 v160, v242, v248
v_lshlrev_b32 v242, 16, v161
v_and_b32 v248, 0xffff0000, v161
v_mul_f32 v242, v242, v236
v_mul_f32 v248, v248, v236
v_cvt_pk_bf16_f32 v161, v242, v248
v_lshlrev_b32 v242, 16, v162
v_and_b32 v248, 0xffff0000, v162
v_mul_f32 v242, v242, v236
v_mul_f32 v248, v248, v236
v_cvt_pk_bf16_f32 v162, v242, v248
v_lshlrev_b32 v242, 16, v163
v_and_b32 v248, 0xffff0000, v163
v_mul_f32 v242, v242, v236
v_mul_f32 v248, v248, v236
v_cvt_pk_bf16_f32 v163, v242, v248
v_lshlrev_b32 v242, 16, v176
v_and_b32 v248, 0xffff0000, v176
v_mul_f32 v242, v242, v236
v_mul_f32 v248, v248, v236
v_cvt_pk_bf16_f32 v176, v242, v248
v_lshlrev_b32 v242, 16, v177
v_and_b32 v248, 0xffff0000, v177
v_mul_f32 v242, v242, v236
v_mul_f32 v248, v248, v236
v_cvt_pk_bf16_f32 v177, v242, v248
v_exp_f32 v248, v148
s_nop 0
v_sub_f32 v225, v225, v248
v_exp_f32 v248, v149
s_nop 0
v_sub_f32 v225, v225, v248
v_exp_f32 v248, v150
s_nop 0
v_sub_f32 v225, v225, v248
v_exp_f32 v248, v151
s_nop 0
v_sub_f32 v225, v225, v248
v_max_f32 v225, 0, v225
v_min_f32 v225, s32, v225
v_log_f32 v248, v225
v_max3_f32 v233, v148, v149, v150
v_max3_f32 v233, v233, v151, v248
v_mov_b32 v248, v233
s_nop 1
v_permlane32_swap_b32 v233, v248
s_nop 1
v_max_f32 v233, v233, v248
v_mov_b32 v248, v233
s_nop 1
v_permlane16_swap_b32 v233, v248
s_nop 1
v_max_f32 v233, v233, v248
v_ceil_f32 v233, v233
v_max_f32 v233, 0, v233
v_sub_f32 v248, 0, v233
v_exp_f32 v237, v248
s_nop 1
v_mul_f32 v225, v225, v237
v_sub_f32 v196, v196, v233
v_sub_f32 v132, v132, v233
v_sub_f32 v148, v148, v233
v_sub_f32 v197, v197, v233
v_sub_f32 v133, v133, v233
v_sub_f32 v149, v149, v233
v_sub_f32 v198, v198, v233
v_sub_f32 v134, v134, v233
v_sub_f32 v150, v150, v233
v_sub_f32 v199, v199, v233
v_sub_f32 v135, v135, v233
v_sub_f32 v151, v151, v233
v_lshlrev_b32 v242, 16, v164
v_and_b32 v248, 0xffff0000, v164
v_mul_f32 v242, v242, v237
v_mul_f32 v248, v248, v237
v_cvt_pk_bf16_f32 v164, v242, v248
v_lshlrev_b32 v242, 16, v165
v_and_b32 v248, 0xffff0000, v165
v_mul_f32 v242, v242, v237
v_mul_f32 v248, v248, v237
v_cvt_pk_bf16_f32 v165, v242, v248
v_lshlrev_b32 v242, 16, v166
v_and_b32 v248, 0xffff0000, v166
v_mul_f32 v242, v242, v237
v_mul_f32 v248, v248, v237
v_cvt_pk_bf16_f32 v166, v242, v248
v_lshlrev_b32 v242, 16, v167
v_and_b32 v248, 0xffff0000, v167
v_mul_f32 v242, v242, v237
v_mul_f32 v248, v248, v237
v_cvt_pk_bf16_f32 v167, v242, v248
v_lshlrev_b32 v242, 16, v180
v_and_b32 v248, 0xffff0000, v180
v_mul_f32 v242, v242, v237
v_mul_f32 v248, v248, v237
v_cvt_pk_bf16_f32 v180, v242, v248
v_lshlrev_b32 v242, 16, v181
v_and_b32 v248, 0xffff0000, v181
v_mul_f32 v242, v242, v237
v_mul_f32 v248, v248, v237
v_cvt_pk_bf16_f32 v181, v242, v248
v_exp_f32 v248, v152
s_nop 0
v_sub_f32 v226, v226, v248
v_exp_f32 v248, v153
s_nop 0
v_sub_f32 v226, v226, v248
v_exp_f32 v248, v154
s_nop 0
v_sub_f32 v226, v226, v248
v_exp_f32 v248, v155
s_nop 0
v_sub_f32 v226, v226, v248
v_max_f32 v226, 0, v226
v_min_f32 v226, s32, v226
v_log_f32 v248, v226
v_max3_f32 v234, v152, v153, v154
v_max3_f32 v234, v234, v155, v248
v_mov_b32 v248, v234
s_nop 1
v_permlane32_swap_b32 v234, v248
s_nop 1
v_max_f32 v234, v234, v248
v_mov_b32 v248, v234
s_nop 1
v_permlane16_swap_b32 v234, v248
s_nop 1
v_max_f32 v234, v234, v248
v_ceil_f32 v234, v234
v_max_f32 v234, 0, v234
v_sub_f32 v248, 0, v234
v_exp_f32 v238, v248
s_nop 1
v_mul_f32 v226, v226, v238
v_sub_f32 v200, v200, v234
v_sub_f32 v136, v136, v234
v_sub_f32 v152, v152, v234
v_sub_f32 v201, v201, v234
v_sub_f32 v137, v137, v234
v_sub_f32 v153, v153, v234
v_sub_f32 v202, v202, v234
v_sub_f32 v138, v138, v234
v_sub_f32 v154, v154, v234
v_sub_f32 v203, v203, v234
v_sub_f32 v139, v139, v234
v_sub_f32 v155, v155, v234
v_lshlrev_b32 v242, 16, v168
v_and_b32 v248, 0xffff0000, v168
v_mul_f32 v242, v242, v238
v_mul_f32 v248, v248, v238
v_cvt_pk_bf16_f32 v168, v242, v248
v_lshlrev_b32 v242, 16, v169
v_and_b32 v248, 0xffff0000, v169
v_mul_f32 v242, v242, v238
v_mul_f32 v248, v248, v238
v_cvt_pk_bf16_f32 v169, v242, v248
v_lshlrev_b32 v242, 16, v170
v_and_b32 v248, 0xffff0000, v170
v_mul_f32 v242, v242, v238
v_mul_f32 v248, v248, v238
v_cvt_pk_bf16_f32 v170, v242, v248
v_lshlrev_b32 v242, 16, v171
v_and_b32 v248, 0xffff0000, v171
v_mul_f32 v242, v242, v238
v_mul_f32 v248, v248, v238
v_cvt_pk_bf16_f32 v171, v242, v248
v_lshlrev_b32 v242, 16, v184
v_and_b32 v248, 0xffff0000, v184
v_mul_f32 v242, v242, v238
v_mul_f32 v248, v248, v238
v_cvt_pk_bf16_f32 v184, v242, v248
v_lshlrev_b32 v242, 16, v185
v_and_b32 v248, 0xffff0000, v185
v_mul_f32 v242, v242, v238
v_mul_f32 v248, v248, v238
v_cvt_pk_bf16_f32 v185, v242, v248
v_exp_f32 v248, v156
s_nop 0
v_sub_f32 v227, v227, v248
v_exp_f32 v248, v157
s_nop 0
v_sub_f32 v227, v227, v248
v_exp_f32 v248, v158
s_nop 0
v_sub_f32 v227, v227, v248
v_exp_f32 v248, v159
s_nop 0
v_sub_f32 v227, v227, v248
v_max_f32 v227, 0, v227
v_min_f32 v227, s32, v227
v_log_f32 v248, v227
v_max3_f32 v235, v156, v157, v158
v_max3_f32 v235, v235, v159, v248
v_mov_b32 v248, v235
s_nop 1
v_permlane32_swap_b32 v235, v248
s_nop 1
v_max_f32 v235, v235, v248
v_mov_b32 v248, v235
s_nop 1
v_permlane16_swap_b32 v235, v248
s_nop 1
v_max_f32 v235, v235, v248
v_ceil_f32 v235, v235
v_max_f32 v235, 0, v235
v_sub_f32 v248, 0, v235
v_exp_f32 v239, v248
s_nop 1
v_mul_f32 v227, v227, v239
v_sub_f32 v204, v204, v235
v_sub_f32 v140, v140, v235
v_sub_f32 v156, v156, v235
v_sub_f32 v205, v205, v235
v_sub_f32 v141, v141, v235
v_sub_f32 v157, v157, v235
v_sub_f32 v206, v206, v235
v_sub_f32 v142, v142, v235
v_sub_f32 v158, v158, v235
v_sub_f32 v207, v207, v235
v_sub_f32 v143, v143, v235
v_sub_f32 v159, v159, v235
v_lshlrev_b32 v242, 16, v172
v_and_b32 v248, 0xffff0000, v172
v_mul_f32 v242, v242, v239
v_mul_f32 v248, v248, v239
v_cvt_pk_bf16_f32 v172, v242, v248
v_lshlrev_b32 v242, 16, v173
v_and_b32 v248, 0xffff0000, v173
v_mul_f32 v242, v242, v239
v_mul_f32 v248, v248, v239
v_cvt_pk_bf16_f32 v173, v242, v248
v_lshlrev_b32 v242, 16, v174
v_and_b32 v248, 0xffff0000, v174
v_mul_f32 v242, v242, v239
v_mul_f32 v248, v248, v239
v_cvt_pk_bf16_f32 v174, v242, v248
v_lshlrev_b32 v242, 16, v175
v_and_b32 v248, 0xffff0000, v175
v_mul_f32 v242, v242, v239
v_mul_f32 v248, v248, v239
v_cvt_pk_bf16_f32 v175, v242, v248
v_lshlrev_b32 v242, 16, v188
v_and_b32 v248, 0xffff0000, v188
v_mul_f32 v242, v242, v239
v_mul_f32 v248, v248, v239
v_cvt_pk_bf16_f32 v188, v242, v248
v_lshlrev_b32 v242, 16, v189
v_and_b32 v248, 0xffff0000, v189
v_mul_f32 v242, v242, v239
v_mul_f32 v248, v248, v239
v_cvt_pk_bf16_f32 v189, v242, v248
v_exp_f32 v144, v144
v_exp_f32 v145, v145
v_exp_f32 v146, v146
v_exp_f32 v147, v147
s_nop 1
v_add_f32 v224, v224, v144
v_add_f32 v224, v224, v145
v_add_f32 v224, v224, v146
v_add_f32 v224, v224, v147
v_exp_f32 v148, v148
v_exp_f32 v149, v149
v_exp_f32 v150, v150
v_exp_f32 v151, v151
s_nop 1
v_add_f32 v225, v225, v148
v_add_f32 v225, v225, v149
v_add_f32 v225, v225, v150
v_add_f32 v225, v225, v151
v_exp_f32 v152, v152
v_exp_f32 v153, v153
v_exp_f32 v154, v154
v_exp_f32 v155, v155
s_nop 1
v_add_f32 v226, v226, v152
v_add_f32 v226, v226, v153
v_add_f32 v226, v226, v154
v_add_f32 v226, v226, v155
v_exp_f32 v156, v156
v_exp_f32 v157, v157
v_exp_f32 v158, v158
v_exp_f32 v159, v159
s_nop 1
v_add_f32 v227, v227, v156
v_add_f32 v227, v227, v157
v_add_f32 v227, v227, v158
v_add_f32 v227, v227, v159
s_branch L2_rare_common
L2_rare_site2:
s_mov_b32 s36, 2
s_branch L2_rare_1_0
L2_rare_1_0:
s_nop 15
s_nop 15
s_waitcnt lgkmcnt(0)
v_add_u32 v250, 0x0, v240
v_and_b32 v250, 0x1ffff, v250
ds_read_b128 v[232:235], v250 offset:0
s_waitcnt lgkmcnt(0)
v_mfma_f32_16x16x32_bf16 v[128:131], v[232:235], v[0:3], v[192:195]
v_mfma_f32_16x16x32_bf16 v[132:135], v[232:235], v[32:35], v[196:199]
v_mfma_f32_16x16x32_bf16 v[136:139], v[232:235], v[64:67], v[200:203]
v_mfma_f32_16x16x32_bf16 v[140:143], v[232:235], v[96:99], v[204:207]
s_nop 7
ds_read_b128 v[232:235], v250 offset:512
s_waitcnt lgkmcnt(0)
v_mfma_f32_16x16x32_bf16 v[128:131], v[232:235], v[4:7], v[128:131]
v_mfma_f32_16x16x32_bf16 v[132:135], v[232:235], v[36:39], v[132:135]
v_mfma_f32_16x16x32_bf16 v[136:139], v[232:235], v[68:71], v[136:139]
v_mfma_f32_16x16x32_bf16 v[140:143], v[232:235], v[100:103], v[140:143]
s_nop 7
ds_read_b128 v[232:235], v250 offset:4096
s_waitcnt lgkmcnt(0)
v_mfma_f32_16x16x32_bf16 v[128:131], v[232:235], v[8:11], v[128:131]
v_mfma_f32_16x16x32_bf16 v[132:135], v[232:235], v[40:43], v[132:135]
v_mfma_f32_16x16x32_bf16 v[136:139], v[232:235], v[72:75], v[136:139]
v_mfma_f32_16x16x32_bf16 v[140:143], v[232:235], v[104:107], v[140:143]
s_nop 7
ds_read_b128 v[232:235], v250 offset:4608
s_waitcnt lgkmcnt(0)
v_mfma_f32_16x16x32_bf16 v[128:131], v[232:235], v[12:15], v[128:131]
v_mfma_f32_16x16x32_bf16 v[132:135], v[232:235], v[44:47], v[132:135]
v_mfma_f32_16x16x32_bf16 v[136:139], v[232:235], v[76:79], v[136:139]
v_mfma_f32_16x16x32_bf16 v[140:143], v[232:235], v[108:111], v[140:143]
s_nop 7
ds_read_b128 v[232:235], v250 offset:8192
s_waitcnt lgkmcnt(0)
v_mfma_f32_16x16x32_bf16 v[128:131], v[232:235], v[16:19], v[128:131]
v_mfma_f32_16x16x32_bf16 v[132:135], v[232:235], v[48:51], v[132:135]
v_mfma_f32_16x16x32_bf16 v[136:139], v[232:235], v[80:83], v[136:139]
v_mfma_f32_16x16x32_bf16 v[140:143], v[232:235], v[112:115], v[140:143]
s_nop 7
ds_read_b128 v[232:235], v250 offset:8704
s_waitcnt lgkmcnt(0)
v_mfma_f32_16x16x32_bf16 v[128:131], v[232:235], v[20:23], v[128:131]
v_mfma_f32_16x16x32_bf16 v[132:135], v[232:235], v[52:55], v[132:135]
v_mfma_f32_16x16x32_bf16 v[136:139], v[232:235], v[84:87], v[136:139]
v_mfma_f32_16x16x32_bf16 v[140:143], v[232:235], v[116:119], v[140:143]
s_nop 7
ds_read_b128 v[232:235], v250 offset:12288
s_waitcnt lgkmcnt(0)
v_mfma_f32_16x16x32_bf16 v[128:131], v[232:235], v[24:27], v[128:131]
v_mfma_f32_16x16x32_bf16 v[132:135], v[232:235], v[56:59], v[132:135]
v_mfma_f32_16x16x32_bf16 v[136:139], v[232:235], v[88:91], v[136:139]
v_mfma_f32_16x16x32_bf16 v[140:143], v[232:235], v[120:123], v[140:143]
s_nop 7
ds_read_b128 v[232:235], v250 offset:12800
s_waitcnt lgkmcnt(0)
v_mfma_f32_16x16x32_bf16 v[128:131], v[232:235], v[28:31], v[128:131]
v_mfma_f32_16x16x32_bf16 v[132:135], v[232:235], v[60:63], v[132:135]
v_mfma_f32_16x16x32_bf16 v[136:139], v[232:235], v[92:95], v[136:139]
v_mfma_f32_16x16x32_bf16 v[140:143], v[232:235], v[124:127], v[140:143]
s_nop 7
s_nop 7
v_exp_f32 v248, v128
s_nop 0
v_sub_f32 v224, v224, v248
v_exp_f32 v248, v129
s_nop 0
v_sub_f32 v224, v224, v248
v_exp_f32 v248, v130
s_nop 0
v_sub_f32 v224, v224, v248
v_exp_f32 v248, v131
s_nop 0
v_sub_f32 v224, v224, v248
v_max_f32 v224, 0, v224
v_min_f32 v224, s32, v224
v_log_f32 v248, v224
v_max3_f32 v232, v128, v129, v130
v_max3_f32 v232, v232, v131, v248
v_mov_b32 v248, v232
s_nop 1
v_permlane32_swap_b32 v232, v248
s_nop 1
v_max_f32 v232, v232, v248
v_mov_b32 v248, v232
s_nop 1
v_permlane16_swap_b32 v232, v248
s_nop 1
v_max_f32 v232, v232, v248
v_ceil_f32 v232, v232
v_max_f32 v232, 0, v232
v_sub_f32 v248, 0, v232
v_exp_f32 v236, v248
s_nop 1
v_mul_f32 v224, v224, v236
v_sub_f32 v192, v192, v232
v_sub_f32 v128, v128, v232
v_sub_f32 v144, v144, v232
v_sub_f32 v193, v193, v232
v_sub_f32 v129, v129, v232
v_sub_f32 v145, v145, v232
v_sub_f32 v194, v194, v232
v_sub_f32 v130, v130, v232
v_sub_f32 v146, v146, v232
v_sub_f32 v195, v195, v232
v_sub_f32 v131, v131, v232
v_sub_f32 v147, v147, v232
v_lshlrev_b32 v242, 16, v176
v_and_b32 v248, 0xffff0000, v176
v_mul_f32 v242, v242, v236
v_mul_f32 v248, v248, v236
v_cvt_pk_bf16_f32 v176, v242, v248
v_lshlrev_b32 v242, 16, v177
v_and_b32 v248, 0xffff0000, v177
v_mul_f32 v242, v242, v236
v_mul_f32 v248, v248, v236
v_cvt_pk_bf16_f32 v177, v242, v248
v_lshlrev_b32 v242, 16, v178
v_and_b32 v248, 0xffff0000, v178
v_mul_f32 v242, v242, v236
v_mul_f32 v248, v248, v236
v_cvt_pk_bf16_f32 v178, v242, v248
v_lshlrev_b32 v242, 16, v179
v_and_b32 v248, 0xffff0000, v179
v_mul_f32 v242, v242, v236
v_mul_f32 v248, v248, v236
v_cvt_pk_bf16_f32 v179, v242, v248
v_lshlrev_b32 v242, 16, v160
v_and_b32 v248, 0xffff0000, v160
v_mul_f32 v242, v242, v236
v_mul_f32 v248, v248, v236
v_cvt_pk_bf16_f32 v160, v242, v248
v_lshlrev_b32 v242, 16, v161
v_and_b32 v248, 0xffff0000, v161
v_mul_f32 v242, v242, v236
v_mul_f32 v248, v248, v236
v_cvt_pk_bf16_f32 v161, v242, v248
v_lshlrev_b32 v242, 16, v162
v_and_b32 v248, 0xffff0000, v162
v_mul_f32 v242, v242, v236
v_mul_f32 v248, v248, v236
v_cvt_pk_bf16_f32 v162, v242, v248
v_lshlrev_b32 v242, 16, v163
v_and_b32 v248, 0xffff0000, v163
v_mul_f32 v242, v242, v236
v_mul_f32 v248, v248, v236
v_cvt_pk_bf16_f32 v163, v242, v248
v_exp_f32 v248, v132
s_nop 0
v_sub_f32 v225, v225, v248
v_exp_f32 v248, v133
s_nop 0
v_sub_f32 v225, v225, v248
v_exp_f32 v248, v134
s_nop 0
v_sub_f32 v225, v225, v248
v_exp_f32 v248, v135
s_nop 0
v_sub_f32 v225, v225, v248
v_max_f32 v225, 0, v225
v_min_f32 v225, s32, v225
v_log_f32 v248, v225
v_max3_f32 v233, v132, v133, v134
v_max3_f32 v233, v233, v135, v248
v_mov_b32 v248, v233
s_nop 1
v_permlane32_swap_b32 v233, v248
s_nop 1
v_max_f32 v233, v233, v248
v_mov_b32 v248, v233
s_nop 1
v_permlane16_swap_b32 v233, v248
s_nop 1
v_max_f32 v233, v233, v248
v_ceil_f32 v233, v233
v_max_f32 v233, 0, v233
v_sub_f32 v248, 0, v233
v_exp_f32 v237, v248
s_nop 1
v_mul_f32 v225, v225, v237
v_sub_f32 v196, v196, v233
v_sub_f32 v132, v132, v233
v_sub_f32 v148, v148, v233
v_sub_f32 v197, v197, v233
v_sub_f32 v133, v133, v233
v_sub_f32 v149, v149, v233
v_sub_f32 v198, v198, v233
v_sub_f32 v134, v134, v233
v_sub_f32 v150, v150, v233
v_sub_f32 v199, v199, v233
v_sub_f32 v135, v135, v233
v_sub_f32 v151, v151, v233
v_lshlrev_b32 v242, 16, v180
v_and_b32 v248, 0xffff0000, v180
v_mul_f32 v242, v242, v237
v_mul_f32 v248, v248, v237
v_cvt_pk_bf16_f32 v180, v242, v248
v_lshlrev_b32 v242, 16, v181
v_and_b32 v248, 0xffff0000, v181
v_mul_f32 v242, v242, v237
v_mul_f32 v248, v248, v237
v_cvt_pk_bf16_f32 v181, v242, v248
v_lshlrev_b32 v242, 16, v182
v_and_b32 v248, 0xffff0000, v182
v_mul_f32 v242, v242, v237
v_mul_f32 v248, v248, v237
v_cvt_pk_bf16_f32 v182, v242, v248
v_lshlrev_b32 v242, 16, v183
v_and_b32 v248, 0xffff0000, v183
v_mul_f32 v242, v242, v237
v_mul_f32 v248, v248, v237
v_cvt_pk_bf16_f32 v183, v242, v248
v_lshlrev_b32 v242, 16, v164
v_and_b32 v248, 0xffff0000, v164
v_mul_f32 v242, v242, v237
v_mul_f32 v248, v248, v237
v_cvt_pk_bf16_f32 v164, v242, v248
v_lshlrev_b32 v242, 16, v165
v_and_b32 v248, 0xffff0000, v165
v_mul_f32 v242, v242, v237
v_mul_f32 v248, v248, v237
v_cvt_pk_bf16_f32 v165, v242, v248
v_lshlrev_b32 v242, 16, v166
v_and_b32 v248, 0xffff0000, v166
v_mul_f32 v242, v242, v237
v_mul_f32 v248, v248, v237
v_cvt_pk_bf16_f32 v166, v242, v248
v_lshlrev_b32 v242, 16, v167
v_and_b32 v248, 0xffff0000, v167
v_mul_f32 v242, v242, v237
v_mul_f32 v248, v248, v237
v_cvt_pk_bf16_f32 v167, v242, v248
v_exp_f32 v248, v136
s_nop 0
v_sub_f32 v226, v226, v248
v_exp_f32 v248, v137
s_nop 0
v_sub_f32 v226, v226, v248
v_exp_f32 v248, v138
s_nop 0
v_sub_f32 v226, v226, v248
v_exp_f32 v248, v139
s_nop 0
v_sub_f32 v226, v226, v248
v_max_f32 v226, 0, v226
v_min_f32 v226, s32, v226
v_log_f32 v248, v226
v_max3_f32 v234, v136, v137, v138
v_max3_f32 v234, v234, v139, v248
v_mov_b32 v248, v234
s_nop 1
v_permlane32_swap_b32 v234, v248
s_nop 1
v_max_f32 v234, v234, v248
v_mov_b32 v248, v234
s_nop 1
v_permlane16_swap_b32 v234, v248
s_nop 1
v_max_f32 v234, v234, v248
v_ceil_f32 v234, v234
v_max_f32 v234, 0, v234
v_sub_f32 v248, 0, v234
v_exp_f32 v238, v248
s_nop 1
v_mul_f32 v226, v226, v238
v_sub_f32 v200, v200, v234
v_sub_f32 v136, v136, v234
v_sub_f32 v152, v152, v234
v_sub_f32 v201, v201, v234
v_sub_f32 v137, v137, v234
v_sub_f32 v153, v153, v234
v_sub_f32 v202, v202, v234
v_sub_f32 v138, v138, v234
v_sub_f32 v154, v154, v234
v_sub_f32 v203, v203, v234
v_sub_f32 v139, v139, v234
v_sub_f32 v155, v155, v234
v_lshlrev_b32 v242, 16, v184
v_and_b32 v248, 0xffff0000, v184
v_mul_f32 v242, v242, v238
v_mul_f32 v248, v248, v238
v_cvt_pk_bf16_f32 v184, v242, v248
v_lshlrev_b32 v242, 16, v185
v_and_b32 v248, 0xffff0000, v185
v_mul_f32 v242, v242, v238
v_mul_f32 v248, v248, v238
v_cvt_pk_bf16_f32 v185, v242, v248
v_lshlrev_b32 v242, 16, v186
v_and_b32 v248, 0xffff0000, v186
v_mul_f32 v242, v242, v238
v_mul_f32 v248, v248, v238
v_cvt_pk_bf16_f32 v186, v242, v248
v_lshlrev_b32 v242, 16, v187
v_and_b32 v248, 0xffff0000, v187
v_mul_f32 v242, v242, v238
v_mul_f32 v248, v248, v238
v_cvt_pk_bf16_f32 v187, v242, v248
v_lshlrev_b32 v242, 16, v168
v_and_b32 v248, 0xffff0000, v168
v_mul_f32 v242, v242, v238
v_mul_f32 v248, v248, v238
v_cvt_pk_bf16_f32 v168, v242, v248
v_lshlrev_b32 v242, 16, v169
v_and_b32 v248, 0xffff0000, v169
v_mul_f32 v242, v242, v238
v_mul_f32 v248, v248, v238
v_cvt_pk_bf16_f32 v169, v242, v248
v_lshlrev_b32 v242, 16, v170
v_and_b32 v248, 0xffff0000, v170
v_mul_f32 v242, v242, v238
v_mul_f32 v248, v248, v238
v_cvt_pk_bf16_f32 v170, v242, v248
v_lshlrev_b32 v242, 16, v171
v_and_b32 v248, 0xffff0000, v171
v_mul_f32 v242, v242, v238
v_mul_f32 v248, v248, v238
v_cvt_pk_bf16_f32 v171, v242, v248
v_exp_f32 v248, v140
s_nop 0
v_sub_f32 v227, v227, v248
v_exp_f32 v248, v141
s_nop 0
v_sub_f32 v227, v227, v248
v_exp_f32 v248, v142
s_nop 0
v_sub_f32 v227, v227, v248
v_exp_f32 v248, v143
s_nop 0
v_sub_f32 v227, v227, v248
v_max_f32 v227, 0, v227
v_min_f32 v227, s32, v227
v_log_f32 v248, v227
v_max3_f32 v235, v140, v141, v142
v_max3_f32 v235, v235, v143, v248
v_mov_b32 v248, v235
s_nop 1
v_permlane32_swap_b32 v235, v248
s_nop 1
v_max_f32 v235, v235, v248
v_mov_b32 v248, v235
s_nop 1
v_permlane16_swap_b32 v235, v248
s_nop 1
v_max_f32 v235, v235, v248
v_ceil_f32 v235, v235
v_max_f32 v235, 0, v235
v_sub_f32 v248, 0, v235
v_exp_f32 v239, v248
s_nop 1
v_mul_f32 v227, v227, v239
v_sub_f32 v204, v204, v235
v_sub_f32 v140, v140, v235
v_sub_f32 v156, v156, v235
v_sub_f32 v205, v205, v235
v_sub_f32 v141, v141, v235
v_sub_f32 v157, v157, v235
v_sub_f32 v206, v206, v235
v_sub_f32 v142, v142, v235
v_sub_f32 v158, v158, v235
v_sub_f32 v207, v207, v235
v_sub_f32 v143, v143, v235
v_sub_f32 v159, v159, v235
v_lshlrev_b32 v242, 16, v188
v_and_b32 v248, 0xffff0000, v188
v_mul_f32 v242, v242, v239
v_mul_f32 v248, v248, v239
v_cvt_pk_bf16_f32 v188, v242, v248
v_lshlrev_b32 v242, 16, v189
v_and_b32 v248, 0xffff0000, v189
v_mul_f32 v242, v242, v239
v_mul_f32 v248, v248, v239
v_cvt_pk_bf16_f32 v189, v242, v248
v_lshlrev_b32 v242, 16, v190
v_and_b32 v248, 0xffff0000, v190
v_mul_f32 v242, v242, v239
v_mul_f32 v248, v248, v239
v_cvt_pk_bf16_f32 v190, v242, v248
v_lshlrev_b32 v242, 16, v191
v_and_b32 v248, 0xffff0000, v191
v_mul_f32 v242, v242, v239
v_mul_f32 v248, v248, v239
v_cvt_pk_bf16_f32 v191, v242, v248
v_lshlrev_b32 v242, 16, v172
v_and_b32 v248, 0xffff0000, v172
v_mul_f32 v242, v242, v239
v_mul_f32 v248, v248, v239
v_cvt_pk_bf16_f32 v172, v242, v248
v_lshlrev_b32 v242, 16, v173
v_and_b32 v248, 0xffff0000, v173
v_mul_f32 v242, v242, v239
v_mul_f32 v248, v248, v239
v_cvt_pk_bf16_f32 v173, v242, v248
v_lshlrev_b32 v242, 16, v174
v_and_b32 v248, 0xffff0000, v174
v_mul_f32 v242, v242, v239
v_mul_f32 v248, v248, v239
v_cvt_pk_bf16_f32 v174, v242, v248
v_lshlrev_b32 v242, 16, v175
v_and_b32 v248, 0xffff0000, v175
v_mul_f32 v242, v242, v239
v_mul_f32 v248, v248, v239
v_cvt_pk_bf16_f32 v175, v242, v248
v_exp_f32 v128, v128
v_exp_f32 v129, v129
v_exp_f32 v130, v130
v_exp_f32 v131, v131
s_nop 1
v_add_f32 v224, v224, v128
v_add_f32 v224, v224, v129
v_add_f32 v224, v224, v130
v_add_f32 v224, v224, v131
v_exp_f32 v132, v132
v_exp_f32 v133, v133
v_exp_f32 v134, v134
v_exp_f32 v135, v135
s_nop 1
v_add_f32 v225, v225, v132
v_add_f32 v225, v225, v133
v_add_f32 v225, v225, v134
v_add_f32 v225, v225, v135
v_exp_f32 v136, v136
v_exp_f32 v137, v137
v_exp_f32 v138, v138
v_exp_f32 v139, v139
s_nop 1
v_add_f32 v226, v226, v136
v_add_f32 v226, v226, v137
v_add_f32 v226, v226, v138
v_add_f32 v226, v226, v139
v_exp_f32 v140, v140
v_exp_f32 v141, v141
v_exp_f32 v142, v142
v_exp_f32 v143, v143
s_nop 1
v_add_f32 v227, v227, v140
v_add_f32 v227, v227, v141
v_add_f32 v227, v227, v142
v_add_f32 v227, v227, v143
s_branch L2_rare_common
L2_rare_site3:
s_mov_b32 s36, 3
s_branch L2_rare_1_1
L2_rare_1_1:
s_nop 15
s_nop 15
s_waitcnt lgkmcnt(0)
v_add_u32 v250, 0x0, v240
v_and_b32 v250, 0x1ffff, v250
ds_read_b128 v[232:235], v250 offset:2048
s_waitcnt lgkmcnt(0)
v_mfma_f32_16x16x32_bf16 v[144:147], v[232:235], v[0:3], v[192:195]
v_mfma_f32_16x16x32_bf16 v[148:151], v[232:235], v[32:35], v[196:199]
v_mfma_f32_16x16x32_bf16 v[152:155], v[232:235], v[64:67], v[200:203]
v_mfma_f32_16x16x32_bf16 v[156:159], v[232:235], v[96:99], v[204:207]
s_nop 7
ds_read_b128 v[232:235], v250 offset:2560
s_waitcnt lgkmcnt(0)
v_mfma_f32_16x16x32_bf16 v[144:147], v[232:235], v[4:7], v[144:147]
v_mfma_f32_16x16x32_bf16 v[148:151], v[232:235], v[36:39], v[148:151]
v_mfma_f32_16x16x32_bf16 v[152:155], v[232:235], v[68:71], v[152:155]
v_mfma_f32_16x16x32_bf16 v[156:159], v[232:235], v[100:103], v[156:159]
s_nop 7
ds_read_b128 v[232:235], v250 offset:6144
s_waitcnt lgkmcnt(0)
v_mfma_f32_16x16x32_bf16 v[144:147], v[232:235], v[8:11], v[144:147]
v_mfma_f32_16x16x32_bf16 v[148:151], v[232:235], v[40:43], v[148:151]
v_mfma_f32_16x16x32_bf16 v[152:155], v[232:235], v[72:75], v[152:155]
v_mfma_f32_16x16x32_bf16 v[156:159], v[232:235], v[104:107], v[156:159]
s_nop 7
ds_read_b128 v[232:235], v250 offset:6656
s_waitcnt lgkmcnt(0)
v_mfma_f32_16x16x32_bf16 v[144:147], v[232:235], v[12:15], v[144:147]
v_mfma_f32_16x16x32_bf16 v[148:151], v[232:235], v[44:47], v[148:151]
v_mfma_f32_16x16x32_bf16 v[152:155], v[232:235], v[76:79], v[152:155]
v_mfma_f32_16x16x32_bf16 v[156:159], v[232:235], v[108:111], v[156:159]
s_nop 7
ds_read_b128 v[232:235], v250 offset:10240
s_waitcnt lgkmcnt(0)
v_mfma_f32_16x16x32_bf16 v[144:147], v[232:235], v[16:19], v[144:147]
v_mfma_f32_16x16x32_bf16 v[148:151], v[232:235], v[48:51], v[148:151]
v_mfma_f32_16x16x32_bf16 v[152:155], v[232:235], v[80:83], v[152:155]
v_mfma_f32_16x16x32_bf16 v[156:159], v[232:235], v[112:115], v[156:159]
s_nop 7
ds_read_b128 v[232:235], v250 offset:10752
s_waitcnt lgkmcnt(0)
v_mfma_f32_16x16x32_bf16 v[144:147], v[232:235], v[20:23], v[144:147]
v_mfma_f32_16x16x32_bf16 v[148:151], v[232:235], v[52:55], v[148:151]
v_mfma_f32_16x16x32_bf16 v[152:155], v[232:235], v[84:87], v[152:155]
v_mfma_f32_16x16x32_bf16 v[156:159], v[232:235], v[116:119], v[156:159]
s_nop 7
ds_read_b128 v[232:235], v250 offset:14336
s_waitcnt lgkmcnt(0)
v_mfma_f32_16x16x32_bf16 v[144:147], v[232:235], v[24:27], v[144:147]
v_mfma_f32_16x16x32_bf16 v[148:151], v[232:235], v[56:59], v[148:151]
v_mfma_f32_16x16x32_bf16 v[152:155], v[232:235], v[88:91], v[152:155]
v_mfma_f32_16x16x32_bf16 v[156:159], v[232:235], v[120:123], v[156:159]
s_nop 7
ds_read_b128 v[232:235], v250 offset:14848
s_waitcnt lgkmcnt(0)
v_mfma_f32_16x16x32_bf16 v[144:147], v[232:235], v[28:31], v[144:147]
v_mfma_f32_16x16x32_bf16 v[148:151], v[232:235], v[60:63], v[148:151]
v_mfma_f32_16x16x32_bf16 v[152:155], v[232:235], v[92:95], v[152:155]
v_mfma_f32_16x16x32_bf16 v[156:159], v[232:235], v[124:127], v[156:159]
s_nop 7
s_nop 7
v_exp_f32 v248, v144
s_nop 0
v_sub_f32 v224, v224, v248
v_exp_f32 v248, v145
s_nop 0
v_sub_f32 v224, v224, v248
v_exp_f32 v248, v146
s_nop 0
v_sub_f32 v224, v224, v248
v_exp_f32 v248, v147
s_nop 0
v_sub_f32 v224, v224, v248
v_max_f32 v224, 0, v224
v_min_f32 v224, s32, v224
v_log_f32 v248, v224
v_max3_f32 v232, v144, v145, v146
v_max3_f32 v232, v232, v147, v248
v_mov_b32 v248, v232
s_nop 1
v_permlane32_swap_b32 v232, v248
s_nop 1
v_max_f32 v232, v232, v248
v_mov_b32 v248, v232
s_nop 1
v_permlane16_swap_b32 v232, v248
s_nop 1
v_max_f32 v232, v232, v248
v_ceil_f32 v232, v232
v_max_f32 v232, 0, v232
v_sub_f32 v248, 0, v232
v_exp_f32 v236, v248
s_nop 1
v_mul_f32 v224, v224, v236
v_sub_f32 v192, v192, v232
v_sub_f32 v128, v128, v232
v_sub_f32 v144, v144, v232
v_sub_f32 v193, v193, v232
v_sub_f32 v129, v129, v232
v_sub_f32 v145, v145, v232
v_sub_f32 v194, v194, v232
v_sub_f32 v130, v130, v232
v_sub_f32 v146, v146, v232
v_sub_f32 v195, v195, v232
v_sub_f32 v131, v131, v232
v_sub_f32 v147, v147, v232
v_lshlrev_b32 v242, 16, v176
v_and_b32 v248, 0xffff0000, v176
v_mul_f32 v242, v242, v236
v_mul_f32 v248, v248, v236
v_cvt_pk_bf16_f32 v176, v242, v248
v_lshlrev_b32 v242, 16, v177
v_and_b32 v248, 0xffff0000, v177
v_mul_f32 v242, v242, v236
v_mul_f32 v248, v248, v236
v_cvt_pk_bf16_f32 v177, v242, v248
v_lshlrev_b32 v242, 16, v178
v_and_b32 v248, 0xffff0000, v178
v_mul_f32 v242, v242, v236
v_mul_f32 v248, v248, v236
v_cvt_pk_bf16_f32 v178, v242, v248
v_lshlrev_b32 v242, 16, v179
v_and_b32 v248, 0xffff0000, v179
v_mul_f32 v242, v242, v236
v_mul_f32 v248, v248, v236
v_cvt_pk_bf16_f32 v179, v242, v248
v_lshlrev_b32 v242, 16, v160
v_and_b32 v248, 0xffff0000, v160
v_mul_f32 v242, v242, v236
v_mul_f32 v248, v248, v236
v_cvt_pk_bf16_f32 v160, v242, v248
v_lshlrev_b32 v242, 16, v161
v_and_b32 v248, 0xffff0000, v161
v_mul_f32 v242, v242, v236
v_mul_f32 v248, v248, v236
v_cvt_pk_bf16_f32 v161, v242, v248
v_exp_f32 v248, v148
s_nop 0
v_sub_f32 v225, v225, v248
v_exp_f32 v248, v149
s_nop 0
v_sub_f32 v225, v225, v248
v_exp_f32 v248, v150
s_nop 0
v_sub_f32 v225, v225, v248
v_exp_f32 v248, v151
s_nop 0
v_sub_f32 v225, v225, v248
v_max_f32 v225, 0, v225
v_min_f32 v225, s32, v225
v_log_f32 v248, v225
v_max3_f32 v233, v148, v149, v150
v_max3_f32 v233, v233, v151, v248
v_mov_b32 v248, v233
s_nop 1
v_permlane32_swap_b32 v233, v248
s_nop 1
v_max_f32 v233, v233, v248
v_mov_b32 v248, v233
s_nop 1
v_permlane16_swap_b32 v233, v248
s_nop 1
v_max_f32 v233, v233, v248
v_ceil_f32 v233, v233
v_max_f32 v233, 0, v233
v_sub_f32 v248, 0, v233
v_exp_f32 v237, v248
s_nop 1
v_mul_f32 v225, v225, v237
v_sub_f32 v196, v196, v233
v_sub_f32 v132, v132, v233
v_sub_f32 v148, v148, v233
v_sub_f32 v197, v197, v233
v_sub_f32 v133, v133, v233
v_sub_f32 v149, v149, v233
v_sub_f32 v198, v198, v233
v_sub_f32 v134, v134, v233
v_sub_f32 v150, v150, v233
v_sub_f32 v199, v199, v233
v_sub_f32 v135, v135, v233
v_sub_f32 v151, v151, v233
v_lshlrev_b32 v242, 16, v180
v_and_b32 v248, 0xffff0000, v180
v_mul_f32 v242, v242, v237
v_mul_f32 v248, v248, v237
v_cvt_pk_bf16_f32 v180, v242, v248
v_lshlrev_b32 v242, 16, v181
v_and_b32 v248, 0xffff0000, v181
v_mul_f32 v242, v242, v237
v_mul_f32 v248, v248, v237
v_cvt_pk_bf16_f32 v181, v242, v248
v_lshlrev_b32 v242, 16, v182
v_and_b32 v248, 0xffff0000, v182
v_mul_f32 v242, v242, v237
v_mul_f32 v248, v248, v237
v_cvt_pk_bf16_f32 v182, v242, v248
v_lshlrev_b32 v242, 16, v183
v_and_b32 v248, 0xffff0000, v183
v_mul_f32 v242, v242, v237
v_mul_f32 v248, v248, v237
v_cvt_pk_bf16_f32 v183, v242, v248
v_lshlrev_b32 v242, 16, v164
v_and_b32 v248, 0xffff0000, v164
v_mul_f32 v242, v242, v237
v_mul_f32 v248, v248, v237
v_cvt_pk_bf16_f32 v164, v242, v248
v_lshlrev_b32 v242, 16, v165
v_and_b32 v248, 0xffff0000, v165
v_mul_f32 v242, v242, v237
v_mul_f32 v248, v248, v237
v_cvt_pk_bf16_f32 v165, v242, v248
v_exp_f32 v248, v152
s_nop 0
v_sub_f32 v226, v226, v248
v_exp_f32 v248, v153
s_nop 0
v_sub_f32 v226, v226, v248
v_exp_f32 v248, v154
s_nop 0
v_sub_f32 v226, v226, v248
v_exp_f32 v248, v155
s_nop 0
v_sub_f32 v226, v226, v248
v_max_f32 v226, 0, v226
v_min_f32 v226, s32, v226
v_log_f32 v248, v226
v_max3_f32 v234, v152, v153, v154
v_max3_f32 v234, v234, v155, v248
v_mov_b32 v248, v234
s_nop 1
v_permlane32_swap_b32 v234, v248
s_nop 1
v_max_f32 v234, v234, v248
v_mov_b32 v248, v234
s_nop 1
v_permlane16_swap_b32 v234, v248
s_nop 1
v_max_f32 v234, v234, v248
v_ceil_f32 v234, v234
v_max_f32 v234, 0, v234
v_sub_f32 v248, 0, v234
v_exp_f32 v238, v248
s_nop 1
v_mul_f32 v226, v226, v238
v_sub_f32 v200, v200, v234
v_sub_f32 v136, v136, v234
v_sub_f32 v152, v152, v234
v_sub_f32 v201, v201, v234
v_sub_f32 v137, v137, v234
v_sub_f32 v153, v153, v234
v_sub_f32 v202, v202, v234
v_sub_f32 v138, v138, v234
v_sub_f32 v154, v154, v234
v_sub_f32 v203, v203, v234
v_sub_f32 v139, v139, v234
v_sub_f32 v155, v155, v234
v_lshlrev_b32 v242, 16, v184
v_and_b32 v248, 0xffff0000, v184
v_mul_f32 v242, v242, v238
v_mul_f32 v248, v248, v238
v_cvt_pk_bf16_f32 v184, v242, v248
v_lshlrev_b32 v242, 16, v185
v_and_b32 v248, 0xffff0000, v185
v_mul_f32 v242, v242, v238
v_mul_f32 v248, v248, v238
v_cvt_pk_bf16_f32 v185, v242, v248
v_lshlrev_b32 v242, 16, v186
v_and_b32 v248, 0xffff0000, v186
v_mul_f32 v242, v242, v238
v_mul_f32 v248, v248, v238
v_cvt_pk_bf16_f32 v186, v242, v248
v_lshlrev_b32 v242, 16, v187
v_and_b32 v248, 0xffff0000, v187
v_mul_f32 v242, v242, v238
v_mul_f32 v248, v248, v238
v_cvt_pk_bf16_f32 v187, v242, v248
v_lshlrev_b32 v242, 16, v168
v_and_b32 v248, 0xffff0000, v168
v_mul_f32 v242, v242, v238
v_mul_f32 v248, v248, v238
v_cvt_pk_bf16_f32 v168, v242, v248
v_lshlrev_b32 v242, 16, v169
v_and_b32 v248, 0xffff0000, v169
v_mul_f32 v242, v242, v238
v_mul_f32 v248, v248, v238
v_cvt_pk_bf16_f32 v169, v242, v248
v_exp_f32 v248, v156
s_nop 0
v_sub_f32 v227, v227, v248
v_exp_f32 v248, v157
s_nop 0
v_sub_f32 v227, v227, v248
v_exp_f32 v248, v158
s_nop 0
v_sub_f32 v227, v227, v248
v_exp_f32 v248, v159
s_nop 0
v_sub_f32 v227, v227, v248
v_max_f32 v227, 0, v227
v_min_f32 v227, s32, v227
v_log_f32 v248, v227
v_max3_f32 v235, v156, v157, v158
v_max3_f32 v235, v235, v159, v248
v_mov_b32 v248, v235
s_nop 1
v_permlane32_swap_b32 v235, v248
s_nop 1
v_max_f32 v235, v235, v248
v_mov_b32 v248, v235
s_nop 1
v_permlane16_swap_b32 v235, v248
s_nop 1
v_max_f32 v235, v235, v248
v_ceil_f32 v235, v235
v_max_f32 v235, 0, v235
v_sub_f32 v248, 0, v235
v_exp_f32 v239, v248
s_nop 1
v_mul_f32 v227, v227, v239
v_sub_f32 v204, v204, v235
v_sub_f32 v140, v140, v235
v_sub_f32 v156, v156, v235
v_sub_f32 v205, v205, v235
v_sub_f32 v141, v141, v235
v_sub_f32 v157, v157, v235
v_sub_f32 v206, v206, v235
v_sub_f32 v142, v142, v235
v_sub_f32 v158, v158, v235
v_sub_f32 v207, v207, v235
v_sub_f32 v143, v143, v235
v_sub_f32 v159, v159, v235
v_lshlrev_b32 v242, 16, v188
v_and_b32 v248, 0xffff0000, v188
v_mul_f32 v242, v242, v239
v_mul_f32 v248, v248, v239
v_cvt_pk_bf16_f32 v188, v242, v248
v_lshlrev_b32 v242, 16, v189
v_and_b32 v248, 0xffff0000, v189
v_mul_f32 v242, v242, v239
v_mul_f32 v248, v248, v239
v_cvt_pk_bf16_f32 v189, v242, v248
v_lshlrev_b32 v242, 16, v190
v_and_b32 v248, 0xffff0000, v190
v_mul_f32 v242, v242, v239
v_mul_f32 v248, v248, v239
v_cvt_pk_bf16_f32 v190, v242, v248
v_lshlrev_b32 v242, 16, v191
v_and_b32 v248, 0xffff0000, v191
v_mul_f32 v242, v242, v239
v_mul_f32 v248, v248, v239
v_cvt_pk_bf16_f32 v191, v242, v248
v_lshlrev_b32 v242, 16, v172
v_and_b32 v248, 0xffff0000, v172
v_mul_f32 v242, v242, v239
v_mul_f32 v248, v248, v239
v_cvt_pk_bf16_f32 v172, v242, v248
v_lshlrev_b32 v242, 16, v173
v_and_b32 v248, 0xffff0000, v173
v_mul_f32 v242, v242, v239
v_mul_f32 v248, v248, v239
v_cvt_pk_bf16_f32 v173, v242, v248
v_exp_f32 v144, v144
v_exp_f32 v145, v145
v_exp_f32 v146, v146
v_exp_f32 v147, v147
s_nop 1
v_add_f32 v224, v224, v144
v_add_f32 v224, v224, v145
v_add_f32 v224, v224, v146
v_add_f32 v224, v224, v147
v_exp_f32 v148, v148
v_exp_f32 v149, v149
v_exp_f32 v150, v150
v_exp_f32 v151, v151
s_nop 1
v_add_f32 v225, v225, v148
v_add_f32 v225, v225, v149
v_add_f32 v225, v225, v150
v_add_f32 v225, v225, v151
v_exp_f32 v152, v152
v_exp_f32 v153, v153
v_exp_f32 v154, v154
v_exp_f32 v155, v155
s_nop 1
v_add_f32 v226, v226, v152
v_add_f32 v226, v226, v153
v_add_f32 v226, v226, v154
v_add_f32 v226, v226, v155
v_exp_f32 v156, v156
v_exp_f32 v157, v157
v_exp_f32 v158, v158
v_exp_f32 v159, v159
s_nop 1
v_add_f32 v227, v227, v156
v_add_f32 v227, v227, v157
v_add_f32 v227, v227, v158
v_add_f32 v227, v227, v159
s_branch L2_rare_common
L2_rare_site6:
s_mov_b32 s36, 6
s_branch L2_rare_t1_0_0
L2_rare_t1_0_0:
s_nop 15
s_nop 15
s_waitcnt lgkmcnt(0)
v_exp_f32 v248, v128
s_nop 0
v_sub_f32 v224, v224, v248
v_exp_f32 v248, v129
s_nop 0
v_sub_f32 v224, v224, v248
v_exp_f32 v248, v130
s_nop 0
v_sub_f32 v224, v224, v248
v_exp_f32 v248, v131
s_nop 0
v_sub_f32 v224, v224, v248
v_max_f32 v224, 0, v224
v_min_f32 v224, s32, v224
v_log_f32 v248, v224
v_max3_f32 v232, v128, v129, v130
v_max3_f32 v232, v232, v131, v248
v_mov_b32 v248, v232
s_nop 1
v_permlane32_swap_b32 v232, v248
s_nop 1
v_max_f32 v232, v232, v248
v_mov_b32 v248, v232
s_nop 1
v_permlane16_swap_b32 v232, v248
s_nop 1
v_max_f32 v232, v232, v248
v_ceil_f32 v232, v232
v_max_f32 v232, 0, v232
v_sub_f32 v248, 0, v232
v_exp_f32 v236, v248
s_nop 1
v_mul_f32 v224, v224, v236
v_sub_f32 v192, v192, v232
v_sub_f32 v128, v128, v232
v_sub_f32 v144, v144, v232
v_sub_f32 v193, v193, v232
v_sub_f32 v129, v129, v232
v_sub_f32 v145, v145, v232
v_sub_f32 v194, v194, v232
v_sub_f32 v130, v130, v232
v_sub_f32 v146, v146, v232
v_sub_f32 v195, v195, v232
v_sub_f32 v131, v131, v232
v_sub_f32 v147, v147, v232
v_lshlrev_b32 v242, 16, v160
v_and_b32 v248, 0xffff0000, v160
v_mul_f32 v242, v242, v236
v_mul_f32 v248, v248, v236
v_cvt_pk_bf16_f32 v160, v242, v248
v_lshlrev_b32 v242, 16, v161
v_and_b32 v248, 0xffff0000, v161
v_mul_f32 v242, v242, v236
v_mul_f32 v248, v248, v236
v_cvt_pk_bf16_f32 v161, v242, v248
v_lshlrev_b32 v242, 16, v162
v_and_b32 v248, 0xffff0000, v162
v_mul_f32 v242, v242, v236
v_mul_f32 v248, v248, v236
v_cvt_pk_bf16_f32 v162, v242, v248
v_lshlrev_b32 v242, 16, v163
v_and_b32 v248, 0xffff0000, v163
v_mul_f32 v242, v242, v236
v_mul_f32 v248, v248, v236
v_cvt_pk_bf16_f32 v163, v242, v248
ds_read_b64 v[250:251], v231 offset:0
s_waitcnt lgkmcnt(0)
v_lshlrev_b32 v242, 16, v250
v_and_b32 v248, 0xffff0000, v250
v_mul_f32 v242, v242, v236
v_mul_f32 v248, v248, v236
v_cvt_pk_bf16_f32 v250, v242, v248
v_lshlrev_b32 v242, 16, v251
v_and_b32 v248, 0xffff0000, v251
v_mul_f32 v242, v242, v236
v_mul_f32 v248, v248, v236
v_cvt_pk_bf16_f32 v251, v242, v248
ds_write_b64 v231, v[250:251] offset:0
s_waitcnt lgkmcnt(0)
ds_read_b64 v[250:251], v231 offset:8
s_waitcnt lgkmcnt(0)
v_lshlrev_b32 v242, 16, v250
v_and_b32 v248, 0xffff0000, v250
v_mul_f32 v242, v242, v236
v_mul_f32 v248, v248, v236
v_cvt_pk_bf16_f32 v250, v242, v248
v_lshlrev_b32 v242, 16, v251
v_and_b32 v248, 0xffff0000, v251
v_mul_f32 v242, v242, v236
v_mul_f32 v248, v248, v236
v_cvt_pk_bf16_f32 v251, v242, v248
ds_write_b64 v231, v[250:251] offset:8
s_waitcnt lgkmcnt(0)
v_exp_f32 v248, v132
s_nop 0
v_sub_f32 v225, v225, v248
v_exp_f32 v248, v133
s_nop 0
v_sub_f32 v225, v225, v248
v_exp_f32 v248, v134
s_nop 0
v_sub_f32 v225, v225, v248
v_exp_f32 v248, v135
s_nop 0
v_sub_f32 v225, v225, v248
v_max_f32 v225, 0, v225
v_min_f32 v225, s32, v225
v_log_f32 v248, v225
v_max3_f32 v233, v132, v133, v134
v_max3_f32 v233, v233, v135, v248
v_mov_b32 v248, v233
s_nop 1
v_permlane32_swap_b32 v233, v248
s_nop 1
v_max_f32 v233, v233, v248
v_mov_b32 v248, v233
s_nop 1
v_permlane16_swap_b32 v233, v248
s_nop 1
v_max_f32 v233, v233, v248
v_ceil_f32 v233, v233
v_max_f32 v233, 0, v233
v_sub_f32 v248, 0, v233
v_exp_f32 v237, v248
s_nop 1
v_mul_f32 v225, v225, v237
v_sub_f32 v196, v196, v233
v_sub_f32 v132, v132, v233
v_sub_f32 v148, v148, v233
v_sub_f32 v197, v197, v233
v_sub_f32 v133, v133, v233
v_sub_f32 v149, v149, v233
v_sub_f32 v198, v198, v233
v_sub_f32 v134, v134, v233
v_sub_f32 v150, v150, v233
v_sub_f32 v199, v199, v233
v_sub_f32 v135, v135, v233
v_sub_f32 v151, v151, v233
v_lshlrev_b32 v242, 16, v164
v_and_b32 v248, 0xffff0000, v164
v_mul_f32 v242, v242, v237
v_mul_f32 v248, v248, v237
v_cvt_pk_bf16_f32 v164, v242, v248
v_lshlrev_b32 v242, 16, v165
v_and_b32 v248, 0xffff0000, v165
v_mul_f32 v242, v242, v237
v_mul_f32 v248, v248, v237
v_cvt_pk_bf16_f32 v165, v242, v248
v_lshlrev_b32 v242, 16, v166
v_and_b32 v248, 0xffff0000, v166
v_mul_f32 v242, v242, v237
v_mul_f32 v248, v248, v237
v_cvt_pk_bf16_f32 v166, v242, v248
v_lshlrev_b32 v242, 16, v167
v_and_b32 v248, 0xffff0000, v167
v_mul_f32 v242, v242, v237
v_mul_f32 v248, v248, v237
v_cvt_pk_bf16_f32 v167, v242, v248
ds_read_b64 v[250:251], v231 offset:1024
s_waitcnt lgkmcnt(0)
v_lshlrev_b32 v242, 16, v250
v_and_b32 v248, 0xffff0000, v250
v_mul_f32 v242, v242, v237
v_mul_f32 v248, v248, v237
v_cvt_pk_bf16_f32 v250, v242, v248
v_lshlrev_b32 v242, 16, v251
v_and_b32 v248, 0xffff0000, v251
v_mul_f32 v242, v242, v237
v_mul_f32 v248, v248, v237
v_cvt_pk_bf16_f32 v251, v242, v248
ds_write_b64 v231, v[250:251] offset:1024
s_waitcnt lgkmcnt(0)
ds_read_b64 v[250:251], v231 offset:1032
s_waitcnt lgkmcnt(0)
v_lshlrev_b32 v242, 16, v250
v_and_b32 v248, 0xffff0000, v250
v_mul_f32 v242, v242, v237
v_mul_f32 v248, v248, v237
v_cvt_pk_bf16_f32 v250, v242, v248
v_lshlrev_b32 v242, 16, v251
v_and_b32 v248, 0xffff0000, v251
v_mul_f32 v242, v242, v237
v_mul_f32 v248, v248, v237
v_cvt_pk_bf16_f32 v251, v242, v248
ds_write_b64 v231, v[250:251] offset:1032
s_waitcnt lgkmcnt(0)
v_exp_f32 v248, v136
s_nop 0
v_sub_f32 v226, v226, v248
v_exp_f32 v248, v137
s_nop 0
v_sub_f32 v226, v226, v248
v_exp_f32 v248, v138
s_nop 0
v_sub_f32 v226, v226, v248
v_exp_f32 v248, v139
s_nop 0
v_sub_f32 v226, v226, v248
v_max_f32 v226, 0, v226
v_min_f32 v226, s32, v226
v_log_f32 v248, v226
v_max3_f32 v234, v136, v137, v138
v_max3_f32 v234, v234, v139, v248
v_mov_b32 v248, v234
s_nop 1
v_permlane32_swap_b32 v234, v248
s_nop 1
v_max_f32 v234, v234, v248
v_mov_b32 v248, v234
s_nop 1
v_permlane16_swap_b32 v234, v248
s_nop 1
v_max_f32 v234, v234, v248
v_ceil_f32 v234, v234
v_max_f32 v234, 0, v234
v_sub_f32 v248, 0, v234
v_exp_f32 v238, v248
s_nop 1
v_mul_f32 v226, v226, v238
v_sub_f32 v200, v200, v234
v_sub_f32 v136, v136, v234
v_sub_f32 v152, v152, v234
v_sub_f32 v201, v201, v234
v_sub_f32 v137, v137, v234
v_sub_f32 v153, v153, v234
v_sub_f32 v202, v202, v234
v_sub_f32 v138, v138, v234
v_sub_f32 v154, v154, v234
v_sub_f32 v203, v203, v234
v_sub_f32 v139, v139, v234
v_sub_f32 v155, v155, v234
v_lshlrev_b32 v242, 16, v168
v_and_b32 v248, 0xffff0000, v168
v_mul_f32 v242, v242, v238
v_mul_f32 v248, v248, v238
v_cvt_pk_bf16_f32 v168, v242, v248
v_lshlrev_b32 v242, 16, v169
v_and_b32 v248, 0xffff0000, v169
v_mul_f32 v242, v242, v238
v_mul_f32 v248, v248, v238
v_cvt_pk_bf16_f32 v169, v242, v248
v_lshlrev_b32 v242, 16, v170
v_and_b32 v248, 0xffff0000, v170
v_mul_f32 v242, v242, v238
v_mul_f32 v248, v248, v238
v_cvt_pk_bf16_f32 v170, v242, v248
v_lshlrev_b32 v242, 16, v171
v_and_b32 v248, 0xffff0000, v171
v_mul_f32 v242, v242, v238
v_mul_f32 v248, v248, v238
v_cvt_pk_bf16_f32 v171, v242, v248
ds_read_b64 v[250:251], v231 offset:2048
s_waitcnt lgkmcnt(0)
v_lshlrev_b32 v242, 16, v250
v_and_b32 v248, 0xffff0000, v250
v_mul_f32 v242, v242, v238
v_mul_f32 v248, v248, v238
v_cvt_pk_bf16_f32 v250, v242, v248
v_lshlrev_b32 v242, 16, v251
v_and_b32 v248, 0xffff0000, v251
v_mul_f32 v242, v242, v238
v_mul_f32 v248, v248, v238
v_cvt_pk_bf16_f32 v251, v242, v248
ds_write_b64 v231, v[250:251] offset:2048
s_waitcnt lgkmcnt(0)
ds_read_b64 v[250:251], v231 offset:2056
s_waitcnt lgkmcnt(0)
v_lshlrev_b32 v242, 16, v250
v_and_b32 v248, 0xffff0000, v250
v_mul_f32 v242, v242, v238
v_mul_f32 v248, v248, v238
v_cvt_pk_bf16_f32 v250, v242, v248
v_lshlrev_b32 v242, 16, v251
v_and_b32 v248, 0xffff0000, v251
v_mul_f32 v242, v242, v238
v_mul_f32 v248, v248, v238
v_cvt_pk_bf16_f32 v251, v242, v248
ds_write_b64 v231, v[250:251] offset:2056
s_waitcnt lgkmcnt(0)
v_exp_f32 v248, v140
s_nop 0
v_sub_f32 v227, v227, v248
v_exp_f32 v248, v141
s_nop 0
v_sub_f32 v227, v227, v248
v_exp_f32 v248, v142
s_nop 0
v_sub_f32 v227, v227, v248
v_exp_f32 v248, v143
s_nop 0
v_sub_f32 v227, v227, v248
v_max_f32 v227, 0, v227
v_min_f32 v227, s32, v227
v_log_f32 v248, v227
v_max3_f32 v235, v140, v141, v142
v_max3_f32 v235, v235, v143, v248
v_mov_b32 v248, v235
s_nop 1
v_permlane32_swap_b32 v235, v248
s_nop 1
v_max_f32 v235, v235, v248
v_mov_b32 v248, v235
s_nop 1
v_permlane16_swap_b32 v235, v248
s_nop 1
v_max_f32 v235, v235, v248
v_ceil_f32 v235, v235
v_max_f32 v235, 0, v235
v_sub_f32 v248, 0, v235
v_exp_f32 v239, v248
s_nop 1
v_mul_f32 v227, v227, v239
v_sub_f32 v204, v204, v235
v_sub_f32 v140, v140, v235
v_sub_f32 v156, v156, v235
v_sub_f32 v205, v205, v235
v_sub_f32 v141, v141, v235
v_sub_f32 v157, v157, v235
v_sub_f32 v206, v206, v235
v_sub_f32 v142, v142, v235
v_sub_f32 v158, v158, v235
v_sub_f32 v207, v207, v235
v_sub_f32 v143, v143, v235
v_sub_f32 v159, v159, v235
v_lshlrev_b32 v242, 16, v172
v_and_b32 v248, 0xffff0000, v172
v_mul_f32 v242, v242, v239
v_mul_f32 v248, v248, v239
v_cvt_pk_bf16_f32 v172, v242, v248
v_lshlrev_b32 v242, 16, v173
v_and_b32 v248, 0xffff0000, v173
v_mul_f32 v242, v242, v239
v_mul_f32 v248, v248, v239
v_cvt_pk_bf16_f32 v173, v242, v248
v_lshlrev_b32 v242, 16, v174
v_and_b32 v248, 0xffff0000, v174
v_mul_f32 v242, v242, v239
v_mul_f32 v248, v248, v239
v_cvt_pk_bf16_f32 v174, v242, v248
v_lshlrev_b32 v242, 16, v175
v_and_b32 v248, 0xffff0000, v175
v_mul_f32 v242, v242, v239
v_mul_f32 v248, v248, v239
v_cvt_pk_bf16_f32 v175, v242, v248
ds_read_b64 v[250:251], v231 offset:3072
s_waitcnt lgkmcnt(0)
v_lshlrev_b32 v242, 16, v250
v_and_b32 v248, 0xffff0000, v250
v_mul_f32 v242, v242, v239
v_mul_f32 v248, v248, v239
v_cvt_pk_bf16_f32 v250, v242, v248
v_lshlrev_b32 v242, 16, v251
v_and_b32 v248, 0xffff0000, v251
v_mul_f32 v242, v242, v239
v_mul_f32 v248, v248, v239
v_cvt_pk_bf16_f32 v251, v242, v248
ds_write_b64 v231, v[250:251] offset:3072
s_waitcnt lgkmcnt(0)
ds_read_b64 v[250:251], v231 offset:3080
s_waitcnt lgkmcnt(0)
v_lshlrev_b32 v242, 16, v250
v_and_b32 v248, 0xffff0000, v250
v_mul_f32 v242, v242, v239
v_mul_f32 v248, v248, v239
v_cvt_pk_bf16_f32 v250, v242, v248
v_lshlrev_b32 v242, 16, v251
v_and_b32 v248, 0xffff0000, v251
v_mul_f32 v242, v242, v239
v_mul_f32 v248, v248, v239
v_cvt_pk_bf16_f32 v251, v242, v248
ds_write_b64 v231, v[250:251] offset:3080
s_waitcnt lgkmcnt(0)
v_exp_f32 v232, v128
v_exp_f32 v233, v129
v_exp_f32 v234, v130
v_exp_f32 v235, v131
s_nop 1
v_add_f32 v224, v224, v232
v_add_f32 v224, v224, v233
v_add_f32 v224, v224, v234
v_add_f32 v224, v224, v235
v_cvt_pk_bf16_f32 v176, v232, v233
v_cvt_pk_bf16_f32 v177, v234, v235
v_exp_f32 v232, v132
v_exp_f32 v233, v133
v_exp_f32 v234, v134
v_exp_f32 v235, v135
s_nop 1
v_add_f32 v225, v225, v232
v_add_f32 v225, v225, v233
v_add_f32 v225, v225, v234
v_add_f32 v225, v225, v235
v_cvt_pk_bf16_f32 v180, v232, v233
v_cvt_pk_bf16_f32 v181, v234, v235
v_exp_f32 v232, v136
v_exp_f32 v233, v137
v_exp_f32 v234, v138
v_exp_f32 v235, v139
s_nop 1
v_add_f32 v226, v226, v232
v_add_f32 v226, v226, v233
v_add_f32 v226, v226, v234
v_add_f32 v226, v226, v235
v_cvt_pk_bf16_f32 v184, v232, v233
v_cvt_pk_bf16_f32 v185, v234, v235
v_exp_f32 v232, v140
v_exp_f32 v233, v141
v_exp_f32 v234, v142
v_exp_f32 v235, v143
s_nop 1
v_add_f32 v227, v227, v232
v_add_f32 v227, v227, v233
v_add_f32 v227, v227, v234
v_add_f32 v227, v227, v235
v_cvt_pk_bf16_f32 v188, v232, v233
v_cvt_pk_bf16_f32 v189, v234, v235
s_branch L2_rare_common
L2_rare_site7:
s_mov_b32 s36, 7
s_branch L2_rare_t1_1_1
L2_rare_t1_1_1:
s_nop 15
s_nop 15
s_waitcnt lgkmcnt(0)
v_exp_f32 v248, v144
s_nop 0
v_sub_f32 v224, v224, v248
v_exp_f32 v248, v145
s_nop 0
v_sub_f32 v224, v224, v248
v_exp_f32 v248, v146
s_nop 0
v_sub_f32 v224, v224, v248
v_exp_f32 v248, v147
s_nop 0
v_sub_f32 v224, v224, v248
v_max_f32 v224, 0, v224
v_min_f32 v224, s32, v224
v_log_f32 v248, v224
v_max3_f32 v232, v144, v145, v146
v_max3_f32 v232, v232, v147, v248
v_mov_b32 v248, v232
s_nop 1
v_permlane32_swap_b32 v232, v248
s_nop 1
v_max_f32 v232, v232, v248
v_mov_b32 v248, v232
s_nop 1
v_permlane16_swap_b32 v232, v248
s_nop 1
v_max_f32 v232, v232, v248
v_ceil_f32 v232, v232
v_max_f32 v232, 0, v232
v_sub_f32 v248, 0, v232
v_exp_f32 v236, v248
s_nop 1
v_mul_f32 v224, v224, v236
v_sub_f32 v192, v192, v232
v_sub_f32 v128, v128, v232
v_sub_f32 v144, v144, v232
v_sub_f32 v193, v193, v232
v_sub_f32 v129, v129, v232
v_sub_f32 v145, v145, v232
v_sub_f32 v194, v194, v232
v_sub_f32 v130, v130, v232
v_sub_f32 v146, v146, v232
v_sub_f32 v195, v195, v232
v_sub_f32 v131, v131, v232
v_sub_f32 v147, v147, v232
v_lshlrev_b32 v242, 16, v176
v_and_b32 v248, 0xffff0000, v176
v_mul_f32 v242, v242, v236
v_mul_f32 v248, v248, v236
v_cvt_pk_bf16_f32 v176, v242, v248
v_lshlrev_b32 v242, 16, v177
v_and_b32 v248, 0xffff0000, v177
v_mul_f32 v242, v242, v236
v_mul_f32 v248, v248, v236
v_cvt_pk_bf16_f32 v177, v242, v248
ds_read_b64 v[250:251], v231 offset:0
s_waitcnt lgkmcnt(0)
v_lshlrev_b32 v242, 16, v250
v_and_b32 v248, 0xffff0000, v250
v_mul_f32 v242, v242, v236
v_mul_f32 v248, v248, v236
v_cvt_pk_bf16_f32 v250, v242, v248
v_lshlrev_b32 v242, 16, v251
v_and_b32 v248, 0xffff0000, v251
v_mul_f32 v242, v242, v236
v_mul_f32 v248, v248, v236
v_cvt_pk_bf16_f32 v251, v242, v248
ds_write_b64 v231, v[250:251] offset:0
s_waitcnt lgkmcnt(0)
ds_read_b64 v[250:251], v231 offset:8
s_waitcnt lgkmcnt(0)
v_lshlrev_b32 v242, 16, v250
v_and_b32 v248, 0xffff0000, v250
v_mul_f32 v242, v242, v236
v_mul_f32 v248, v248, v236
v_cvt_pk_bf16_f32 v250, v242, v248
v_lshlrev_b32 v242, 16, v251
v_and_b32 v248, 0xffff0000, v251
v_mul_f32 v242, v242, v236
v_mul_f32 v248, v248, v236
v_cvt_pk_bf16_f32 v251, v242, v248
ds_write_b64 v231, v[250:251] offset:8
s_waitcnt lgkmcnt(0)
ds_read_b64 v[250:251], v231 offset:4096
s_waitcnt lgkmcnt(0)
v_lshlrev_b32 v242, 16, v250
v_and_b32 v248, 0xffff0000, v250
v_mul_f32 v242, v242, v236
v_mul_f32 v248, v248, v236
v_cvt_pk_bf16_f32 v250, v242, v248
v_lshlrev_b32 v242, 16, v251
v_and_b32 v248, 0xffff0000, v251
v_mul_f32 v242, v242, v236
v_mul_f32 v248, v248, v236
v_cvt_pk_bf16_f32 v251, v242, v248
ds_write_b64 v231, v[250:251] offset:4096
s_waitcnt lgkmcnt(0)
ds_read_b64 v[250:251], v231 offset:4104
s_waitcnt lgkmcnt(0)
v_lshlrev_b32 v242, 16, v250
v_and_b32 v248, 0xffff0000, v250
v_mul_f32 v242, v242, v236
v_mul_f32 v248, v248, v236
v_cvt_pk_bf16_f32 v250, v242, v248
v_lshlrev_b32 v242, 16, v251
v_and_b32 v248, 0xffff0000, v251
v_mul_f32 v242, v242, v236
v_mul_f32 v248, v248, v236
v_cvt_pk_bf16_f32 v251, v242, v248
ds_write_b64 v231, v[250:251] offset:4104
s_waitcnt lgkmcnt(0)
v_exp_f32 v248, v148
s_nop 0
v_sub_f32 v225, v225, v248
v_exp_f32 v248, v149
s_nop 0
v_sub_f32 v225, v225, v248
v_exp_f32 v248, v150
s_nop 0
v_sub_f32 v225, v225, v248
v_exp_f32 v248, v151
s_nop 0
v_sub_f32 v225, v225, v248
v_max_f32 v225, 0, v225
v_min_f32 v225, s32, v225
v_log_f32 v248, v225
v_max3_f32 v233, v148, v149, v150
v_max3_f32 v233, v233, v151, v248
v_mov_b32 v248, v233
s_nop 1
v_permlane32_swap_b32 v233, v248
s_nop 1
v_max_f32 v233, v233, v248
v_mov_b32 v248, v233
s_nop 1
v_permlane16_swap_b32 v233, v248
s_nop 1
v_max_f32 v233, v233, v248
v_ceil_f32 v233, v233
v_max_f32 v233, 0, v233
v_sub_f32 v248, 0, v233
v_exp_f32 v237, v248
s_nop 1
v_mul_f32 v225, v225, v237
v_sub_f32 v196, v196, v233
v_sub_f32 v132, v132, v233
v_sub_f32 v148, v148, v233
v_sub_f32 v197, v197, v233
v_sub_f32 v133, v133, v233
v_sub_f32 v149, v149, v233
v_sub_f32 v198, v198, v233
v_sub_f32 v134, v134, v233
v_sub_f32 v150, v150, v233
v_sub_f32 v199, v199, v233
v_sub_f32 v135, v135, v233
v_sub_f32 v151, v151, v233
v_lshlrev_b32 v242, 16, v180
v_and_b32 v248, 0xffff0000, v180
v_mul_f32 v242, v242, v237
v_mul_f32 v248, v248, v237
v_cvt_pk_bf16_f32 v180, v242, v248
v_lshlrev_b32 v242, 16, v181
v_and_b32 v248, 0xffff0000, v181
v_mul_f32 v242, v242, v237
v_mul_f32 v248, v248, v237
v_cvt_pk_bf16_f32 v181, v242, v248
ds_read_b64 v[250:251], v231 offset:1024
s_waitcnt lgkmcnt(0)
v_lshlrev_b32 v242, 16, v250
v_and_b32 v248, 0xffff0000, v250
v_mul_f32 v242, v242, v237
v_mul_f32 v248, v248, v237
v_cvt_pk_bf16_f32 v250, v242, v248
v_lshlrev_b32 v242, 16, v251
v_and_b32 v248, 0xffff0000, v251
v_mul_f32 v242, v242, v237
v_mul_f32 v248, v248, v237
v_cvt_pk_bf16_f32 v251, v242, v248
ds_write_b64 v231, v[250:251] offset:1024
s_waitcnt lgkmcnt(0)
ds_read_b64 v[250:251], v231 offset:1032
s_waitcnt lgkmcnt(0)
v_lshlrev_b32 v242, 16, v250
v_and_b32 v248, 0xffff0000, v250
v_mul_f32 v242, v242, v237
v_mul_f32 v248, v248, v237
v_cvt_pk_bf16_f32 v250, v242, v248
v_lshlrev_b32 v242, 16, v251
v_and_b32 v248, 0xffff0000, v251
v_mul_f32 v242, v242, v237
v_mul_f32 v248, v248, v237
v_cvt_pk_bf16_f32 v251, v242, v248
ds_write_b64 v231, v[250:251] offset:1032
s_waitcnt lgkmcnt(0)
ds_read_b64 v[250:251], v231 offset:5120
s_waitcnt lgkmcnt(0)
v_lshlrev_b32 v242, 16, v250
v_and_b32 v248, 0xffff0000, v250
v_mul_f32 v242, v242, v237
v_mul_f32 v248, v248, v237
v_cvt_pk_bf16_f32 v250, v242, v248
v_lshlrev_b32 v242, 16, v251
v_and_b32 v248, 0xffff0000, v251
v_mul_f32 v242, v242, v237
v_mul_f32 v248, v248, v237
v_cvt_pk_bf16_f32 v251, v242, v248
ds_write_b64 v231, v[250:251] offset:5120
s_waitcnt lgkmcnt(0)
ds_read_b64 v[250:251], v231 offset:5128
s_waitcnt lgkmcnt(0)
v_lshlrev_b32 v242, 16, v250
v_and_b32 v248, 0xffff0000, v250
v_mul_f32 v242, v242, v237
v_mul_f32 v248, v248, v237
v_cvt_pk_bf16_f32 v250, v242, v248
v_lshlrev_b32 v242, 16, v251
v_and_b32 v248, 0xffff0000, v251
v_mul_f32 v242, v242, v237
v_mul_f32 v248, v248, v237
v_cvt_pk_bf16_f32 v251, v242, v248
ds_write_b64 v231, v[250:251] offset:5128
s_waitcnt lgkmcnt(0)
v_exp_f32 v248, v152
s_nop 0
v_sub_f32 v226, v226, v248
v_exp_f32 v248, v153
s_nop 0
v_sub_f32 v226, v226, v248
v_exp_f32 v248, v154
s_nop 0
v_sub_f32 v226, v226, v248
v_exp_f32 v248, v155
s_nop 0
v_sub_f32 v226, v226, v248
v_max_f32 v226, 0, v226
v_min_f32 v226, s32, v226
v_log_f32 v248, v226
v_max3_f32 v234, v152, v153, v154
v_max3_f32 v234, v234, v155, v248
v_mov_b32 v248, v234
s_nop 1
v_permlane32_swap_b32 v234, v248
s_nop 1
v_max_f32 v234, v234, v248
v_mov_b32 v248, v234
s_nop 1
v_permlane16_swap_b32 v234, v248
s_nop 1
v_max_f32 v234, v234, v248
v_ceil_f32 v234, v234
v_max_f32 v234, 0, v234
v_sub_f32 v248, 0, v234
v_exp_f32 v238, v248
s_nop 1
v_mul_f32 v226, v226, v238
v_sub_f32 v200, v200, v234
v_sub_f32 v136, v136, v234
v_sub_f32 v152, v152, v234
v_sub_f32 v201, v201, v234
v_sub_f32 v137, v137, v234
v_sub_f32 v153, v153, v234
v_sub_f32 v202, v202, v234
v_sub_f32 v138, v138, v234
v_sub_f32 v154, v154, v234
v_sub_f32 v203, v203, v234
v_sub_f32 v139, v139, v234
v_sub_f32 v155, v155, v234
v_lshlrev_b32 v242, 16, v184
v_and_b32 v248, 0xffff0000, v184
v_mul_f32 v242, v242, v238
v_mul_f32 v248, v248, v238
v_cvt_pk_bf16_f32 v184, v242, v248
v_lshlrev_b32 v242, 16, v185
v_and_b32 v248, 0xffff0000, v185
v_mul_f32 v242, v242, v238
v_mul_f32 v248, v248, v238
v_cvt_pk_bf16_f32 v185, v242, v248
ds_read_b64 v[250:251], v231 offset:2048
s_waitcnt lgkmcnt(0)
v_lshlrev_b32 v242, 16, v250
v_and_b32 v248, 0xffff0000, v250
v_mul_f32 v242, v242, v238
v_mul_f32 v248, v248, v238
v_cvt_pk_bf16_f32 v250, v242, v248
v_lshlrev_b32 v242, 16, v251
v_and_b32 v248, 0xffff0000, v251
v_mul_f32 v242, v242, v238
v_mul_f32 v248, v248, v238
v_cvt_pk_bf16_f32 v251, v242, v248
ds_write_b64 v231, v[250:251] offset:2048
s_waitcnt lgkmcnt(0)
ds_read_b64 v[250:251], v231 offset:2056
s_waitcnt lgkmcnt(0)
v_lshlrev_b32 v242, 16, v250
v_and_b32 v248, 0xffff0000, v250
v_mul_f32 v242, v242, v238
v_mul_f32 v248, v248, v238
v_cvt_pk_bf16_f32 v250, v242, v248
v_lshlrev_b32 v242, 16, v251
v_and_b32 v248, 0xffff0000, v251
v_mul_f32 v242, v242, v238
v_mul_f32 v248, v248, v238
v_cvt_pk_bf16_f32 v251, v242, v248
ds_write_b64 v231, v[250:251] offset:2056
s_waitcnt lgkmcnt(0)
ds_read_b64 v[250:251], v231 offset:6144
s_waitcnt lgkmcnt(0)
v_lshlrev_b32 v242, 16, v250
v_and_b32 v248, 0xffff0000, v250
v_mul_f32 v242, v242, v238
v_mul_f32 v248, v248, v238
v_cvt_pk_bf16_f32 v250, v242, v248
v_lshlrev_b32 v242, 16, v251
v_and_b32 v248, 0xffff0000, v251
v_mul_f32 v242, v242, v238
v_mul_f32 v248, v248, v238
v_cvt_pk_bf16_f32 v251, v242, v248
ds_write_b64 v231, v[250:251] offset:6144
s_waitcnt lgkmcnt(0)
ds_read_b64 v[250:251], v231 offset:6152
s_waitcnt lgkmcnt(0)
v_lshlrev_b32 v242, 16, v250
v_and_b32 v248, 0xffff0000, v250
v_mul_f32 v242, v242, v238
v_mul_f32 v248, v248, v238
v_cvt_pk_bf16_f32 v250, v242, v248
v_lshlrev_b32 v242, 16, v251
v_and_b32 v248, 0xffff0000, v251
v_mul_f32 v242, v242, v238
v_mul_f32 v248, v248, v238
v_cvt_pk_bf16_f32 v251, v242, v248
ds_write_b64 v231, v[250:251] offset:6152
s_waitcnt lgkmcnt(0)
v_exp_f32 v248, v156
s_nop 0
v_sub_f32 v227, v227, v248
v_exp_f32 v248, v157
s_nop 0
v_sub_f32 v227, v227, v248
v_exp_f32 v248, v158
s_nop 0
v_sub_f32 v227, v227, v248
v_exp_f32 v248, v159
s_nop 0
v_sub_f32 v227, v227, v248
v_max_f32 v227, 0, v227
v_min_f32 v227, s32, v227
v_log_f32 v248, v227
v_max3_f32 v235, v156, v157, v158
v_max3_f32 v235, v235, v159, v248
v_mov_b32 v248, v235
s_nop 1
v_permlane32_swap_b32 v235, v248
s_nop 1
v_max_f32 v235, v235, v248
v_mov_b32 v248, v235
s_nop 1
v_permlane16_swap_b32 v235, v248
s_nop 1
v_max_f32 v235, v235, v248
v_ceil_f32 v235, v235
v_max_f32 v235, 0, v235
v_sub_f32 v248, 0, v235
v_exp_f32 v239, v248
s_nop 1
v_mul_f32 v227, v227, v239
v_sub_f32 v204, v204, v235
v_sub_f32 v140, v140, v235
v_sub_f32 v156, v156, v235
v_sub_f32 v205, v205, v235
v_sub_f32 v141, v141, v235
v_sub_f32 v157, v157, v235
v_sub_f32 v206, v206, v235
v_sub_f32 v142, v142, v235
v_sub_f32 v158, v158, v235
v_sub_f32 v207, v207, v235
v_sub_f32 v143, v143, v235
v_sub_f32 v159, v159, v235
v_lshlrev_b32 v242, 16, v188
v_and_b32 v248, 0xffff0000, v188
v_mul_f32 v242, v242, v239
v_mul_f32 v248, v248, v239
v_cvt_pk_bf16_f32 v188, v242, v248
v_lshlrev_b32 v242, 16, v189
v_and_b32 v248, 0xffff0000, v189
v_mul_f32 v242, v242, v239
v_mul_f32 v248, v248, v239
v_cvt_pk_bf16_f32 v189, v242, v248
ds_read_b64 v[250:251], v231 offset:3072
s_waitcnt lgkmcnt(0)
v_lshlrev_b32 v242, 16, v250
v_and_b32 v248, 0xffff0000, v250
v_mul_f32 v242, v242, v239
v_mul_f32 v248, v248, v239
v_cvt_pk_bf16_f32 v250, v242, v248
v_lshlrev_b32 v242, 16, v251
v_and_b32 v248, 0xffff0000, v251
v_mul_f32 v242, v242, v239
v_mul_f32 v248, v248, v239
v_cvt_pk_bf16_f32 v251, v242, v248
ds_write_b64 v231, v[250:251] offset:3072
s_waitcnt lgkmcnt(0)
ds_read_b64 v[250:251], v231 offset:3080
s_waitcnt lgkmcnt(0)
v_lshlrev_b32 v242, 16, v250
v_and_b32 v248, 0xffff0000, v250
v_mul_f32 v242, v242, v239
v_mul_f32 v248, v248, v239
v_cvt_pk_bf16_f32 v250, v242, v248
v_lshlrev_b32 v242, 16, v251
v_and_b32 v248, 0xffff0000, v251
v_mul_f32 v242, v242, v239
v_mul_f32 v248, v248, v239
v_cvt_pk_bf16_f32 v251, v242, v248
ds_write_b64 v231, v[250:251] offset:3080
s_waitcnt lgkmcnt(0)
ds_read_b64 v[250:251], v231 offset:7168
s_waitcnt lgkmcnt(0)
v_lshlrev_b32 v242, 16, v250
v_and_b32 v248, 0xffff0000, v250
v_mul_f32 v242, v242, v239
v_mul_f32 v248, v248, v239
v_cvt_pk_bf16_f32 v250, v242, v248
v_lshlrev_b32 v242, 16, v251
v_and_b32 v248, 0xffff0000, v251
v_mul_f32 v242, v242, v239
v_mul_f32 v248, v248, v239
v_cvt_pk_bf16_f32 v251, v242, v248
ds_write_b64 v231, v[250:251] offset:7168
s_waitcnt lgkmcnt(0)
ds_read_b64 v[250:251], v231 offset:7176
s_waitcnt lgkmcnt(0)
v_lshlrev_b32 v242, 16, v250
v_and_b32 v248, 0xffff0000, v250
v_mul_f32 v242, v242, v239
v_mul_f32 v248, v248, v239
v_cvt_pk_bf16_f32 v250, v242, v248
v_lshlrev_b32 v242, 16, v251
v_and_b32 v248, 0xffff0000, v251
v_mul_f32 v242, v242, v239
v_mul_f32 v248, v248, v239
v_cvt_pk_bf16_f32 v251, v242, v248
ds_write_b64 v231, v[250:251] offset:7176
s_waitcnt lgkmcnt(0)
v_exp_f32 v232, v144
v_exp_f32 v233, v145
v_exp_f32 v234, v146
v_exp_f32 v235, v147
s_nop 1
v_add_f32 v224, v224, v232
v_add_f32 v224, v224, v233
v_add_f32 v224, v224, v234
v_add_f32 v224, v224, v235
v_cvt_pk_bf16_f32 v178, v232, v233
v_cvt_pk_bf16_f32 v179, v234, v235
v_exp_f32 v232, v148
v_exp_f32 v233, v149
v_exp_f32 v234, v150
v_exp_f32 v235, v151
s_nop 1
v_add_f32 v225, v225, v232
v_add_f32 v225, v225, v233
v_add_f32 v225, v225, v234
v_add_f32 v225, v225, v235
v_cvt_pk_bf16_f32 v182, v232, v233
v_cvt_pk_bf16_f32 v183, v234, v235
v_exp_f32 v232, v152
v_exp_f32 v233, v153
v_exp_f32 v234, v154
v_exp_f32 v235, v155
s_nop 1
v_add_f32 v226, v226, v232
v_add_f32 v226, v226, v233
v_add_f32 v226, v226, v234
v_add_f32 v226, v226, v235
v_cvt_pk_bf16_f32 v186, v232, v233
v_cvt_pk_bf16_f32 v187, v234, v235
v_exp_f32 v232, v156
v_exp_f32 v233, v157
v_exp_f32 v234, v158
v_exp_f32 v235, v159
s_nop 1
v_add_f32 v227, v227, v232
v_add_f32 v227, v227, v233
v_add_f32 v227, v227, v234
v_add_f32 v227, v227, v235
v_cvt_pk_bf16_f32 v190, v232, v233
v_cvt_pk_bf16_f32 v191, v234, v235
s_branch L2_rare_common
L2_rare_site8:
s_mov_b32 s36, 8
s_branch L2_rare_t1_2_0
L2_rare_t1_2_0:
s_nop 15
s_nop 15
s_waitcnt lgkmcnt(0)
v_exp_f32 v248, v128
s_nop 0
v_sub_f32 v224, v224, v248
v_exp_f32 v248, v129
s_nop 0
v_sub_f32 v224, v224, v248
v_exp_f32 v248, v130
s_nop 0
v_sub_f32 v224, v224, v248
v_exp_f32 v248, v131
s_nop 0
v_sub_f32 v224, v224, v248
v_max_f32 v224, 0, v224
v_min_f32 v224, s32, v224
v_log_f32 v248, v224
v_max3_f32 v232, v128, v129, v130
v_max3_f32 v232, v232, v131, v248
v_mov_b32 v248, v232
s_nop 1
v_permlane32_swap_b32 v232, v248
s_nop 1
v_max_f32 v232, v232, v248
v_mov_b32 v248, v232
s_nop 1
v_permlane16_swap_b32 v232, v248
s_nop 1
v_max_f32 v232, v232, v248
v_ceil_f32 v232, v232
v_max_f32 v232, 0, v232
v_sub_f32 v248, 0, v232
v_exp_f32 v236, v248
s_nop 1
v_mul_f32 v224, v224, v236
v_sub_f32 v192, v192, v232
v_sub_f32 v128, v128, v232
v_sub_f32 v144, v144, v232
v_sub_f32 v193, v193, v232
v_sub_f32 v129, v129, v232
v_sub_f32 v145, v145, v232
v_sub_f32 v194, v194, v232
v_sub_f32 v130, v130, v232
v_sub_f32 v146, v146, v232
v_sub_f32 v195, v195, v232
v_sub_f32 v131, v131, v232
v_sub_f32 v147, v147, v232
v_lshlrev_b32 v242, 16, v176
v_and_b32 v248, 0xffff0000, v176
v_mul_f32 v242, v242, v236
v_mul_f32 v248, v248, v236
v_cvt_pk_bf16_f32 v176, v242, v248
v_lshlrev_b32 v242, 16, v177
v_and_b32 v248, 0xffff0000, v177
v_mul_f32 v242, v242, v236
v_mul_f32 v248, v248, v236
v_cvt_pk_bf16_f32 v177, v242, v248
v_lshlrev_b32 v242, 16, v178
v_and_b32 v248, 0xffff0000, v178
v_mul_f32 v242, v242, v236
v_mul_f32 v248, v248, v236
v_cvt_pk_bf16_f32 v178, v242, v248
v_lshlrev_b32 v242, 16, v179
v_and_b32 v248, 0xffff0000, v179
v_mul_f32 v242, v242, v236
v_mul_f32 v248, v248, v236
v_cvt_pk_bf16_f32 v179, v242, v248
ds_read_b64 v[250:251], v231 offset:0
s_waitcnt lgkmcnt(0)
v_lshlrev_b32 v242, 16, v250
v_and_b32 v248, 0xffff0000, v250
v_mul_f32 v242, v242, v236
v_mul_f32 v248, v248, v236
v_cvt_pk_bf16_f32 v250, v242, v248
v_lshlrev_b32 v242, 16, v251
v_and_b32 v248, 0xffff0000, v251
v_mul_f32 v242, v242, v236
v_mul_f32 v248, v248, v236
v_cvt_pk_bf16_f32 v251, v242, v248
ds_write_b64 v231, v[250:251] offset:0
s_waitcnt lgkmcnt(0)
ds_read_b64 v[250:251], v231 offset:8
s_waitcnt lgkmcnt(0)
v_lshlrev_b32 v242, 16, v250
v_and_b32 v248, 0xffff0000, v250
v_mul_f32 v242, v242, v236
v_mul_f32 v248, v248, v236
v_cvt_pk_bf16_f32 v250, v242, v248
v_lshlrev_b32 v242, 16, v251
v_and_b32 v248, 0xffff0000, v251
v_mul_f32 v242, v242, v236
v_mul_f32 v248, v248, v236
v_cvt_pk_bf16_f32 v251, v242, v248
ds_write_b64 v231, v[250:251] offset:8
s_waitcnt lgkmcnt(0)
ds_read_b64 v[250:251], v231 offset:4096
s_waitcnt lgkmcnt(0)
v_lshlrev_b32 v242, 16, v250
v_and_b32 v248, 0xffff0000, v250
v_mul_f32 v242, v242, v236
v_mul_f32 v248, v248, v236
v_cvt_pk_bf16_f32 v250, v242, v248
v_lshlrev_b32 v242, 16, v251
v_and_b32 v248, 0xffff0000, v251
v_mul_f32 v242, v242, v236
v_mul_f32 v248, v248, v236
v_cvt_pk_bf16_f32 v251, v242, v248
ds_write_b64 v231, v[250:251] offset:4096
s_waitcnt lgkmcnt(0)
ds_read_b64 v[250:251], v231 offset:4104
s_waitcnt lgkmcnt(0)
v_lshlrev_b32 v242, 16, v250
v_and_b32 v248, 0xffff0000, v250
v_mul_f32 v242, v242, v236
v_mul_f32 v248, v248, v236
v_cvt_pk_bf16_f32 v250, v242, v248
v_lshlrev_b32 v242, 16, v251
v_and_b32 v248, 0xffff0000, v251
v_mul_f32 v242, v242, v236
v_mul_f32 v248, v248, v236
v_cvt_pk_bf16_f32 v251, v242, v248
ds_write_b64 v231, v[250:251] offset:4104
s_waitcnt lgkmcnt(0)
v_exp_f32 v248, v132
s_nop 0
v_sub_f32 v225, v225, v248
v_exp_f32 v248, v133
s_nop 0
v_sub_f32 v225, v225, v248
v_exp_f32 v248, v134
s_nop 0
v_sub_f32 v225, v225, v248
v_exp_f32 v248, v135
s_nop 0
v_sub_f32 v225, v225, v248
v_max_f32 v225, 0, v225
v_min_f32 v225, s32, v225
v_log_f32 v248, v225
v_max3_f32 v233, v132, v133, v134
v_max3_f32 v233, v233, v135, v248
v_mov_b32 v248, v233
s_nop 1
v_permlane32_swap_b32 v233, v248
s_nop 1
v_max_f32 v233, v233, v248
v_mov_b32 v248, v233
s_nop 1
v_permlane16_swap_b32 v233, v248
s_nop 1
v_max_f32 v233, v233, v248
v_ceil_f32 v233, v233
v_max_f32 v233, 0, v233
v_sub_f32 v248, 0, v233
v_exp_f32 v237, v248
s_nop 1
v_mul_f32 v225, v225, v237
v_sub_f32 v196, v196, v233
v_sub_f32 v132, v132, v233
v_sub_f32 v148, v148, v233
v_sub_f32 v197, v197, v233
v_sub_f32 v133, v133, v233
v_sub_f32 v149, v149, v233
v_sub_f32 v198, v198, v233
v_sub_f32 v134, v134, v233
v_sub_f32 v150, v150, v233
v_sub_f32 v199, v199, v233
v_sub_f32 v135, v135, v233
v_sub_f32 v151, v151, v233
v_lshlrev_b32 v242, 16, v180
v_and_b32 v248, 0xffff0000, v180
v_mul_f32 v242, v242, v237
v_mul_f32 v248, v248, v237
v_cvt_pk_bf16_f32 v180, v242, v248
v_lshlrev_b32 v242, 16, v181
v_and_b32 v248, 0xffff0000, v181
v_mul_f32 v242, v242, v237
v_mul_f32 v248, v248, v237
v_cvt_pk_bf16_f32 v181, v242, v248
v_lshlrev_b32 v242, 16, v182
v_and_b32 v248, 0xffff0000, v182
v_mul_f32 v242, v242, v237
v_mul_f32 v248, v248, v237
v_cvt_pk_bf16_f32 v182, v242, v248
v_lshlrev_b32 v242, 16, v183
v_and_b32 v248, 0xffff0000, v183
v_mul_f32 v242, v242, v237
v_mul_f32 v248, v248, v237
v_cvt_pk_bf16_f32 v183, v242, v248
ds_read_b64 v[250:251], v231 offset:1024
s_waitcnt lgkmcnt(0)
v_lshlrev_b32 v242, 16, v250
v_and_b32 v248, 0xffff0000, v250
v_mul_f32 v242, v242, v237
v_mul_f32 v248, v248, v237
v_cvt_pk_bf16_f32 v250, v242, v248
v_lshlrev_b32 v242, 16, v251
v_and_b32 v248, 0xffff0000, v251
v_mul_f32 v242, v242, v237
v_mul_f32 v248, v248, v237
v_cvt_pk_bf16_f32 v251, v242, v248
ds_write_b64 v231, v[250:251] offset:1024
s_waitcnt lgkmcnt(0)
ds_read_b64 v[250:251], v231 offset:1032
s_waitcnt lgkmcnt(0)
v_lshlrev_b32 v242, 16, v250
v_and_b32 v248, 0xffff0000, v250
v_mul_f32 v242, v242, v237
v_mul_f32 v248, v248, v237
v_cvt_pk_bf16_f32 v250, v242, v248
v_lshlrev_b32 v242, 16, v251
v_and_b32 v248, 0xffff0000, v251
v_mul_f32 v242, v242, v237
v_mul_f32 v248, v248, v237
v_cvt_pk_bf16_f32 v251, v242, v248
ds_write_b64 v231, v[250:251] offset:1032
s_waitcnt lgkmcnt(0)
ds_read_b64 v[250:251], v231 offset:5120
s_waitcnt lgkmcnt(0)
v_lshlrev_b32 v242, 16, v250
v_and_b32 v248, 0xffff0000, v250
v_mul_f32 v242, v242, v237
v_mul_f32 v248, v248, v237
v_cvt_pk_bf16_f32 v250, v242, v248
v_lshlrev_b32 v242, 16, v251
v_and_b32 v248, 0xffff0000, v251
v_mul_f32 v242, v242, v237
v_mul_f32 v248, v248, v237
v_cvt_pk_bf16_f32 v251, v242, v248
ds_write_b64 v231, v[250:251] offset:5120
s_waitcnt lgkmcnt(0)
ds_read_b64 v[250:251], v231 offset:5128
s_waitcnt lgkmcnt(0)
v_lshlrev_b32 v242, 16, v250
v_and_b32 v248, 0xffff0000, v250
v_mul_f32 v242, v242, v237
v_mul_f32 v248, v248, v237
v_cvt_pk_bf16_f32 v250, v242, v248
v_lshlrev_b32 v242, 16, v251
v_and_b32 v248, 0xffff0000, v251
v_mul_f32 v242, v242, v237
v_mul_f32 v248, v248, v237
v_cvt_pk_bf16_f32 v251, v242, v248
ds_write_b64 v231, v[250:251] offset:5128
s_waitcnt lgkmcnt(0)
v_exp_f32 v248, v136
s_nop 0
v_sub_f32 v226, v226, v248
v_exp_f32 v248, v137
s_nop 0
v_sub_f32 v226, v226, v248
v_exp_f32 v248, v138
s_nop 0
v_sub_f32 v226, v226, v248
v_exp_f32 v248, v139
s_nop 0
v_sub_f32 v226, v226, v248
v_max_f32 v226, 0, v226
v_min_f32 v226, s32, v226
v_log_f32 v248, v226
v_max3_f32 v234, v136, v137, v138
v_max3_f32 v234, v234, v139, v248
v_mov_b32 v248, v234
s_nop 1
v_permlane32_swap_b32 v234, v248
s_nop 1
v_max_f32 v234, v234, v248
v_mov_b32 v248, v234
s_nop 1
v_permlane16_swap_b32 v234, v248
s_nop 1
v_max_f32 v234, v234, v248
v_ceil_f32 v234, v234
v_max_f32 v234, 0, v234
v_sub_f32 v248, 0, v234
v_exp_f32 v238, v248
s_nop 1
v_mul_f32 v226, v226, v238
v_sub_f32 v200, v200, v234
v_sub_f32 v136, v136, v234
v_sub_f32 v152, v152, v234
v_sub_f32 v201, v201, v234
v_sub_f32 v137, v137, v234
v_sub_f32 v153, v153, v234
v_sub_f32 v202, v202, v234
v_sub_f32 v138, v138, v234
v_sub_f32 v154, v154, v234
v_sub_f32 v203, v203, v234
v_sub_f32 v139, v139, v234
v_sub_f32 v155, v155, v234
v_lshlrev_b32 v242, 16, v184
v_and_b32 v248, 0xffff0000, v184
v_mul_f32 v242, v242, v238
v_mul_f32 v248, v248, v238
v_cvt_pk_bf16_f32 v184, v242, v248
v_lshlrev_b32 v242, 16, v185
v_and_b32 v248, 0xffff0000, v185
v_mul_f32 v242, v242, v238
v_mul_f32 v248, v248, v238
v_cvt_pk_bf16_f32 v185, v242, v248
v_lshlrev_b32 v242, 16, v186
v_and_b32 v248, 0xffff0000, v186
v_mul_f32 v242, v242, v238
v_mul_f32 v248, v248, v238
v_cvt_pk_bf16_f32 v186, v242, v248
v_lshlrev_b32 v242, 16, v187
v_and_b32 v248, 0xffff0000, v187
v_mul_f32 v242, v242, v238
v_mul_f32 v248, v248, v238
v_cvt_pk_bf16_f32 v187, v242, v248
ds_read_b64 v[250:251], v231 offset:2048
s_waitcnt lgkmcnt(0)
v_lshlrev_b32 v242, 16, v250
v_and_b32 v248, 0xffff0000, v250
v_mul_f32 v242, v242, v238
v_mul_f32 v248, v248, v238
v_cvt_pk_bf16_f32 v250, v242, v248
v_lshlrev_b32 v242, 16, v251
v_and_b32 v248, 0xffff0000, v251
v_mul_f32 v242, v242, v238
v_mul_f32 v248, v248, v238
v_cvt_pk_bf16_f32 v251, v242, v248
ds_write_b64 v231, v[250:251] offset:2048
s_waitcnt lgkmcnt(0)
ds_read_b64 v[250:251], v231 offset:2056
s_waitcnt lgkmcnt(0)
v_lshlrev_b32 v242, 16, v250
v_and_b32 v248, 0xffff0000, v250
v_mul_f32 v242, v242, v238
v_mul_f32 v248, v248, v238
v_cvt_pk_bf16_f32 v250, v242, v248
v_lshlrev_b32 v242, 16, v251
v_and_b32 v248, 0xffff0000, v251
v_mul_f32 v242, v242, v238
v_mul_f32 v248, v248, v238
v_cvt_pk_bf16_f32 v251, v242, v248
ds_write_b64 v231, v[250:251] offset:2056
s_waitcnt lgkmcnt(0)
ds_read_b64 v[250:251], v231 offset:6144
s_waitcnt lgkmcnt(0)
v_lshlrev_b32 v242, 16, v250
v_and_b32 v248, 0xffff0000, v250
v_mul_f32 v242, v242, v238
v_mul_f32 v248, v248, v238
v_cvt_pk_bf16_f32 v250, v242, v248
v_lshlrev_b32 v242, 16, v251
v_and_b32 v248, 0xffff0000, v251
v_mul_f32 v242, v242, v238
v_mul_f32 v248, v248, v238
v_cvt_pk_bf16_f32 v251, v242, v248
ds_write_b64 v231, v[250:251] offset:6144
s_waitcnt lgkmcnt(0)
ds_read_b64 v[250:251], v231 offset:6152
s_waitcnt lgkmcnt(0)
v_lshlrev_b32 v242, 16, v250
v_and_b32 v248, 0xffff0000, v250
v_mul_f32 v242, v242, v238
v_mul_f32 v248, v248, v238
v_cvt_pk_bf16_f32 v250, v242, v248
v_lshlrev_b32 v242, 16, v251
v_and_b32 v248, 0xffff0000, v251
v_mul_f32 v242, v242, v238
v_mul_f32 v248, v248, v238
v_cvt_pk_bf16_f32 v251, v242, v248
ds_write_b64 v231, v[250:251] offset:6152
s_waitcnt lgkmcnt(0)
v_exp_f32 v248, v140
s_nop 0
v_sub_f32 v227, v227, v248
v_exp_f32 v248, v141
s_nop 0
v_sub_f32 v227, v227, v248
v_exp_f32 v248, v142
s_nop 0
v_sub_f32 v227, v227, v248
v_exp_f32 v248, v143
s_nop 0
v_sub_f32 v227, v227, v248
v_max_f32 v227, 0, v227
v_min_f32 v227, s32, v227
v_log_f32 v248, v227
v_max3_f32 v235, v140, v141, v142
v_max3_f32 v235, v235, v143, v248
v_mov_b32 v248, v235
s_nop 1
v_permlane32_swap_b32 v235, v248
s_nop 1
v_max_f32 v235, v235, v248
v_mov_b32 v248, v235
s_nop 1
v_permlane16_swap_b32 v235, v248
s_nop 1
v_max_f32 v235, v235, v248
v_ceil_f32 v235, v235
v_max_f32 v235, 0, v235
v_sub_f32 v248, 0, v235
v_exp_f32 v239, v248
s_nop 1
v_mul_f32 v227, v227, v239
v_sub_f32 v204, v204, v235
v_sub_f32 v140, v140, v235
v_sub_f32 v156, v156, v235
v_sub_f32 v205, v205, v235
v_sub_f32 v141, v141, v235
v_sub_f32 v157, v157, v235
v_sub_f32 v206, v206, v235
v_sub_f32 v142, v142, v235
v_sub_f32 v158, v158, v235
v_sub_f32 v207, v207, v235
v_sub_f32 v143, v143, v235
v_sub_f32 v159, v159, v235
v_lshlrev_b32 v242, 16, v188
v_and_b32 v248, 0xffff0000, v188
v_mul_f32 v242, v242, v239
v_mul_f32 v248, v248, v239
v_cvt_pk_bf16_f32 v188, v242, v248
v_lshlrev_b32 v242, 16, v189
v_and_b32 v248, 0xffff0000, v189
v_mul_f32 v242, v242, v239
v_mul_f32 v248, v248, v239
v_cvt_pk_bf16_f32 v189, v242, v248
v_lshlrev_b32 v242, 16, v190
v_and_b32 v248, 0xffff0000, v190
v_mul_f32 v242, v242, v239
v_mul_f32 v248, v248, v239
v_cvt_pk_bf16_f32 v190, v242, v248
v_lshlrev_b32 v242, 16, v191
v_and_b32 v248, 0xffff0000, v191
v_mul_f32 v242, v242, v239
v_mul_f32 v248, v248, v239
v_cvt_pk_bf16_f32 v191, v242, v248
ds_read_b64 v[250:251], v231 offset:3072
s_waitcnt lgkmcnt(0)
v_lshlrev_b32 v242, 16, v250
v_and_b32 v248, 0xffff0000, v250
v_mul_f32 v242, v242, v239
v_mul_f32 v248, v248, v239
v_cvt_pk_bf16_f32 v250, v242, v248
v_lshlrev_b32 v242, 16, v251
v_and_b32 v248, 0xffff0000, v251
v_mul_f32 v242, v242, v239
v_mul_f32 v248, v248, v239
v_cvt_pk_bf16_f32 v251, v242, v248
ds_write_b64 v231, v[250:251] offset:3072
s_waitcnt lgkmcnt(0)
ds_read_b64 v[250:251], v231 offset:3080
s_waitcnt lgkmcnt(0)
v_lshlrev_b32 v242, 16, v250
v_and_b32 v248, 0xffff0000, v250
v_mul_f32 v242, v242, v239
v_mul_f32 v248, v248, v239
v_cvt_pk_bf16_f32 v250, v242, v248
v_lshlrev_b32 v242, 16, v251
v_and_b32 v248, 0xffff0000, v251
v_mul_f32 v242, v242, v239
v_mul_f32 v248, v248, v239
v_cvt_pk_bf16_f32 v251, v242, v248
ds_write_b64 v231, v[250:251] offset:3080
s_waitcnt lgkmcnt(0)
ds_read_b64 v[250:251], v231 offset:7168
s_waitcnt lgkmcnt(0)
v_lshlrev_b32 v242, 16, v250
v_and_b32 v248, 0xffff0000, v250
v_mul_f32 v242, v242, v239
v_mul_f32 v248, v248, v239
v_cvt_pk_bf16_f32 v250, v242, v248
v_lshlrev_b32 v242, 16, v251
v_and_b32 v248, 0xffff0000, v251
v_mul_f32 v242, v242, v239
v_mul_f32 v248, v248, v239
v_cvt_pk_bf16_f32 v251, v242, v248
ds_write_b64 v231, v[250:251] offset:7168
s_waitcnt lgkmcnt(0)
ds_read_b64 v[250:251], v231 offset:7176
s_waitcnt lgkmcnt(0)
v_lshlrev_b32 v242, 16, v250
v_and_b32 v248, 0xffff0000, v250
v_mul_f32 v242, v242, v239
v_mul_f32 v248, v248, v239
v_cvt_pk_bf16_f32 v250, v242, v248
v_lshlrev_b32 v242, 16, v251
v_and_b32 v248, 0xffff0000, v251
v_mul_f32 v242, v242, v239
v_mul_f32 v248, v248, v239
v_cvt_pk_bf16_f32 v251, v242, v248
ds_write_b64 v231, v[250:251] offset:7176
s_waitcnt lgkmcnt(0)
v_exp_f32 v232, v128
v_exp_f32 v233, v129
v_exp_f32 v234, v130
v_exp_f32 v235, v131
s_nop 1
v_add_f32 v224, v224, v232
v_add_f32 v224, v224, v233
v_add_f32 v224, v224, v234
v_add_f32 v224, v224, v235
v_cvt_pk_bf16_f32 v160, v232, v233
v_cvt_pk_bf16_f32 v161, v234, v235
v_exp_f32 v232, v132
v_exp_f32 v233, v133
v_exp_f32 v234, v134
v_exp_f32 v235, v135
s_nop 1
v_add_f32 v225, v225, v232
v_add_f32 v225, v225, v233
v_add_f32 v225, v225, v234
v_add_f32 v225, v225, v235
v_cvt_pk_bf16_f32 v164, v232, v233
v_cvt_pk_bf16_f32 v165, v234, v235
v_exp_f32 v232, v136
v_exp_f32 v233, v137
v_exp_f32 v234, v138
v_exp_f32 v235, v139
s_nop 1
v_add_f32 v226, v226, v232
v_add_f32 v226, v226, v233
v_add_f32 v226, v226, v234
v_add_f32 v226, v226, v235
v_cvt_pk_bf16_f32 v168, v232, v233
v_cvt_pk_bf16_f32 v169, v234, v235
v_exp_f32 v232, v140
v_exp_f32 v233, v141
v_exp_f32 v234, v142
v_exp_f32 v235, v143
s_nop 1
v_add_f32 v227, v227, v232
v_add_f32 v227, v227, v233
v_add_f32 v227, v227, v234
v_add_f32 v227, v227, v235
v_cvt_pk_bf16_f32 v172, v232, v233
v_cvt_pk_bf16_f32 v173, v234, v235
s_branch L2_rare_common
L2_rare_site9:
s_mov_b32 s36, 9
s_branch L2_rare_t1_3_1
L2_rare_t1_3_1:
s_nop 15
s_nop 15
s_waitcnt lgkmcnt(0)
v_exp_f32 v248, v144
s_nop 0
v_sub_f32 v224, v224, v248
v_exp_f32 v248, v145
s_nop 0
v_sub_f32 v224, v224, v248
v_exp_f32 v248, v146
s_nop 0
v_sub_f32 v224, v224, v248
v_exp_f32 v248, v147
s_nop 0
v_sub_f32 v224, v224, v248
v_max_f32 v224, 0, v224
v_min_f32 v224, s32, v224
v_log_f32 v248, v224
v_max3_f32 v232, v144, v145, v146
v_max3_f32 v232, v232, v147, v248
v_mov_b32 v248, v232
s_nop 1
v_permlane32_swap_b32 v232, v248
s_nop 1
v_max_f32 v232, v232, v248
v_mov_b32 v248, v232
s_nop 1
v_permlane16_swap_b32 v232, v248
s_nop 1
v_max_f32 v232, v232, v248
v_ceil_f32 v232, v232
v_max_f32 v232, 0, v232
v_sub_f32 v248, 0, v232
v_exp_f32 v236, v248
s_nop 1
v_mul_f32 v224, v224, v236
v_sub_f32 v192, v192, v232
v_sub_f32 v128, v128, v232
v_sub_f32 v144, v144, v232
v_sub_f32 v193, v193, v232
v_sub_f32 v129, v129, v232
v_sub_f32 v145, v145, v232
v_sub_f32 v194, v194, v232
v_sub_f32 v130, v130, v232
v_sub_f32 v146, v146, v232
v_sub_f32 v195, v195, v232
v_sub_f32 v131, v131, v232
v_sub_f32 v147, v147, v232
v_lshlrev_b32 v242, 16, v176
v_and_b32 v248, 0xffff0000, v176
v_mul_f32 v242, v242, v236
v_mul_f32 v248, v248, v236
v_cvt_pk_bf16_f32 v176, v242, v248
v_lshlrev_b32 v242, 16, v177
v_and_b32 v248, 0xffff0000, v177
v_mul_f32 v242, v242, v236
v_mul_f32 v248, v248, v236
v_cvt_pk_bf16_f32 v177, v242, v248
v_lshlrev_b32 v242, 16, v178
v_and_b32 v248, 0xffff0000, v178
v_mul_f32 v242, v242, v236
v_mul_f32 v248, v248, v236
v_cvt_pk_bf16_f32 v178, v242, v248
v_lshlrev_b32 v242, 16, v179
v_and_b32 v248, 0xffff0000, v179
v_mul_f32 v242, v242, v236
v_mul_f32 v248, v248, v236
v_cvt_pk_bf16_f32 v179, v242, v248
v_lshlrev_b32 v242, 16, v160
v_and_b32 v248, 0xffff0000, v160
v_mul_f32 v242, v242, v236
v_mul_f32 v248, v248, v236
v_cvt_pk_bf16_f32 v160, v242, v248
v_lshlrev_b32 v242, 16, v161
v_and_b32 v248, 0xffff0000, v161
v_mul_f32 v242, v242, v236
v_mul_f32 v248, v248, v236
v_cvt_pk_bf16_f32 v161, v242, v248
ds_read_b64 v[250:251], v231 offset:0
s_waitcnt lgkmcnt(0)
v_lshlrev_b32 v242, 16, v250
v_and_b32 v248, 0xffff0000, v250
v_mul_f32 v242, v242, v236
v_mul_f32 v248, v248, v236
v_cvt_pk_bf16_f32 v250, v242, v248
v_lshlrev_b32 v242, 16, v251
v_and_b32 v248, 0xffff0000, v251
v_mul_f32 v242, v242, v236
v_mul_f32 v248, v248, v236
v_cvt_pk_bf16_f32 v251, v242, v248
ds_write_b64 v231, v[250:251] offset:0
s_waitcnt lgkmcnt(0)
ds_read_b64 v[250:251], v231 offset:8
s_waitcnt lgkmcnt(0)
v_lshlrev_b32 v242, 16, v250
v_and_b32 v248, 0xffff0000, v250
v_mul_f32 v242, v242, v236
v_mul_f32 v248, v248, v236
v_cvt_pk_bf16_f32 v250, v242, v248
v_lshlrev_b32 v242, 16, v251
v_and_b32 v248, 0xffff0000, v251
v_mul_f32 v242, v242, v236
v_mul_f32 v248, v248, v236
v_cvt_pk_bf16_f32 v251, v242, v248
ds_write_b64 v231, v[250:251] offset:8
s_waitcnt lgkmcnt(0)
ds_read_b64 v[250:251], v231 offset:4096
s_waitcnt lgkmcnt(0)
v_lshlrev_b32 v242, 16, v250
v_and_b32 v248, 0xffff0000, v250
v_mul_f32 v242, v242, v236
v_mul_f32 v248, v248, v236
v_cvt_pk_bf16_f32 v250, v242, v248
v_lshlrev_b32 v242, 16, v251
v_and_b32 v248, 0xffff0000, v251
v_mul_f32 v242, v242, v236
v_mul_f32 v248, v248, v236
v_cvt_pk_bf16_f32 v251, v242, v248
ds_write_b64 v231, v[250:251] offset:4096
s_waitcnt lgkmcnt(0)
ds_read_b64 v[250:251], v231 offset:4104
s_waitcnt lgkmcnt(0)
v_lshlrev_b32 v242, 16, v250
v_and_b32 v248, 0xffff0000, v250
v_mul_f32 v242, v242, v236
v_mul_f32 v248, v248, v236
v_cvt_pk_bf16_f32 v250, v242, v248
v_lshlrev_b32 v242, 16, v251
v_and_b32 v248, 0xffff0000, v251
v_mul_f32 v242, v242, v236
v_mul_f32 v248, v248, v236
v_cvt_pk_bf16_f32 v251, v242, v248
ds_write_b64 v231, v[250:251] offset:4104
s_waitcnt lgkmcnt(0)
v_exp_f32 v248, v148
s_nop 0
v_sub_f32 v225, v225, v248
v_exp_f32 v248, v149
s_nop 0
v_sub_f32 v225, v225, v248
v_exp_f32 v248, v150
s_nop 0
v_sub_f32 v225, v225, v248
v_exp_f32 v248, v151
s_nop 0
v_sub_f32 v225, v225, v248
v_max_f32 v225, 0, v225
v_min_f32 v225, s32, v225
v_log_f32 v248, v225
v_max3_f32 v233, v148, v149, v150
v_max3_f32 v233, v233, v151, v248
v_mov_b32 v248, v233
s_nop 1
v_permlane32_swap_b32 v233, v248
s_nop 1
v_max_f32 v233, v233, v248
v_mov_b32 v248, v233
s_nop 1
v_permlane16_swap_b32 v233, v248
s_nop 1
v_max_f32 v233, v233, v248
v_ceil_f32 v233, v233
v_max_f32 v233, 0, v233
v_sub_f32 v248, 0, v233
v_exp_f32 v237, v248
s_nop 1
v_mul_f32 v225, v225, v237
v_sub_f32 v196, v196, v233
v_sub_f32 v132, v132, v233
v_sub_f32 v148, v148, v233
v_sub_f32 v197, v197, v233
v_sub_f32 v133, v133, v233
v_sub_f32 v149, v149, v233
v_sub_f32 v198, v198, v233
v_sub_f32 v134, v134, v233
v_sub_f32 v150, v150, v233
v_sub_f32 v199, v199, v233
v_sub_f32 v135, v135, v233
v_sub_f32 v151, v151, v233
v_lshlrev_b32 v242, 16, v180
v_and_b32 v248, 0xffff0000, v180
v_mul_f32 v242, v242, v237
v_mul_f32 v248, v248, v237
v_cvt_pk_bf16_f32 v180, v242, v248
v_lshlrev_b32 v242, 16, v181
v_and_b32 v248, 0xffff0000, v181
v_mul_f32 v242, v242, v237
v_mul_f32 v248, v248, v237
v_cvt_pk_bf16_f32 v181, v242, v248
v_lshlrev_b32 v242, 16, v182
v_and_b32 v248, 0xffff0000, v182
v_mul_f32 v242, v242, v237
v_mul_f32 v248, v248, v237
v_cvt_pk_bf16_f32 v182, v242, v248
v_lshlrev_b32 v242, 16, v183
v_and_b32 v248, 0xffff0000, v183
v_mul_f32 v242, v242, v237
v_mul_f32 v248, v248, v237
v_cvt_pk_bf16_f32 v183, v242, v248
v_lshlrev_b32 v242, 16, v164
v_and_b32 v248, 0xffff0000, v164
v_mul_f32 v242, v242, v237
v_mul_f32 v248, v248, v237
v_cvt_pk_bf16_f32 v164, v242, v248
v_lshlrev_b32 v242, 16, v165
v_and_b32 v248, 0xffff0000, v165
v_mul_f32 v242, v242, v237
v_mul_f32 v248, v248, v237
v_cvt_pk_bf16_f32 v165, v242, v248
ds_read_b64 v[250:251], v231 offset:1024
s_waitcnt lgkmcnt(0)
v_lshlrev_b32 v242, 16, v250
v_and_b32 v248, 0xffff0000, v250
v_mul_f32 v242, v242, v237
v_mul_f32 v248, v248, v237
v_cvt_pk_bf16_f32 v250, v242, v248
v_lshlrev_b32 v242, 16, v251
v_and_b32 v248, 0xffff0000, v251
v_mul_f32 v242, v242, v237
v_mul_f32 v248, v248, v237
v_cvt_pk_bf16_f32 v251, v242, v248
ds_write_b64 v231, v[250:251] offset:1024
s_waitcnt lgkmcnt(0)
ds_read_b64 v[250:251], v231 offset:1032
s_waitcnt lgkmcnt(0)
v_lshlrev_b32 v242, 16, v250
v_and_b32 v248, 0xffff0000, v250
v_mul_f32 v242, v242, v237
v_mul_f32 v248, v248, v237
v_cvt_pk_bf16_f32 v250, v242, v248
v_lshlrev_b32 v242, 16, v251
v_and_b32 v248, 0xffff0000, v251
v_mul_f32 v242, v242, v237
v_mul_f32 v248, v248, v237
v_cvt_pk_bf16_f32 v251, v242, v248
ds_write_b64 v231, v[250:251] offset:1032
s_waitcnt lgkmcnt(0)
ds_read_b64 v[250:251], v231 offset:5120
s_waitcnt lgkmcnt(0)
v_lshlrev_b32 v242, 16, v250
v_and_b32 v248, 0xffff0000, v250
v_mul_f32 v242, v242, v237
v_mul_f32 v248, v248, v237
v_cvt_pk_bf16_f32 v250, v242, v248
v_lshlrev_b32 v242, 16, v251
v_and_b32 v248, 0xffff0000, v251
v_mul_f32 v242, v242, v237
v_mul_f32 v248, v248, v237
v_cvt_pk_bf16_f32 v251, v242, v248
ds_write_b64 v231, v[250:251] offset:5120
s_waitcnt lgkmcnt(0)
ds_read_b64 v[250:251], v231 offset:5128
s_waitcnt lgkmcnt(0)
v_lshlrev_b32 v242, 16, v250
v_and_b32 v248, 0xffff0000, v250
v_mul_f32 v242, v242, v237
v_mul_f32 v248, v248, v237
v_cvt_pk_bf16_f32 v250, v242, v248
v_lshlrev_b32 v242, 16, v251
v_and_b32 v248, 0xffff0000, v251
v_mul_f32 v242, v242, v237
v_mul_f32 v248, v248, v237
v_cvt_pk_bf16_f32 v251, v242, v248
ds_write_b64 v231, v[250:251] offset:5128
s_waitcnt lgkmcnt(0)
v_exp_f32 v248, v152
s_nop 0
v_sub_f32 v226, v226, v248
v_exp_f32 v248, v153
s_nop 0
v_sub_f32 v226, v226, v248
v_exp_f32 v248, v154
s_nop 0
v_sub_f32 v226, v226, v248
v_exp_f32 v248, v155
s_nop 0
v_sub_f32 v226, v226, v248
v_max_f32 v226, 0, v226
v_min_f32 v226, s32, v226
v_log_f32 v248, v226
v_max3_f32 v234, v152, v153, v154
v_max3_f32 v234, v234, v155, v248
v_mov_b32 v248, v234
s_nop 1
v_permlane32_swap_b32 v234, v248
s_nop 1
v_max_f32 v234, v234, v248
v_mov_b32 v248, v234
s_nop 1
v_permlane16_swap_b32 v234, v248
s_nop 1
v_max_f32 v234, v234, v248
v_ceil_f32 v234, v234
v_max_f32 v234, 0, v234
v_sub_f32 v248, 0, v234
v_exp_f32 v238, v248
s_nop 1
v_mul_f32 v226, v226, v238
v_sub_f32 v200, v200, v234
v_sub_f32 v136, v136, v234
v_sub_f32 v152, v152, v234
v_sub_f32 v201, v201, v234
v_sub_f32 v137, v137, v234
v_sub_f32 v153, v153, v234
v_sub_f32 v202, v202, v234
v_sub_f32 v138, v138, v234
v_sub_f32 v154, v154, v234
v_sub_f32 v203, v203, v234
v_sub_f32 v139, v139, v234
v_sub_f32 v155, v155, v234
v_lshlrev_b32 v242, 16, v184
v_and_b32 v248, 0xffff0000, v184
v_mul_f32 v242, v242, v238
v_mul_f32 v248, v248, v238
v_cvt_pk_bf16_f32 v184, v242, v248
v_lshlrev_b32 v242, 16, v185
v_and_b32 v248, 0xffff0000, v185
v_mul_f32 v242, v242, v238
v_mul_f32 v248, v248, v238
v_cvt_pk_bf16_f32 v185, v242, v248
v_lshlrev_b32 v242, 16, v186
v_and_b32 v248, 0xffff0000, v186
v_mul_f32 v242, v242, v238
v_mul_f32 v248, v248, v238
v_cvt_pk_bf16_f32 v186, v242, v248
v_lshlrev_b32 v242, 16, v187
v_and_b32 v248, 0xffff0000, v187
v_mul_f32 v242, v242, v238
v_mul_f32 v248, v248, v238
v_cvt_pk_bf16_f32 v187, v242, v248
v_lshlrev_b32 v242, 16, v168
v_and_b32 v248, 0xffff0000, v168
v_mul_f32 v242, v242, v238
v_mul_f32 v248, v248, v238
v_cvt_pk_bf16_f32 v168, v242, v248
v_lshlrev_b32 v242, 16, v169
v_and_b32 v248, 0xffff0000, v169
v_mul_f32 v242, v242, v238
v_mul_f32 v248, v248, v238
v_cvt_pk_bf16_f32 v169, v242, v248
ds_read_b64 v[250:251], v231 offset:2048
s_waitcnt lgkmcnt(0)
v_lshlrev_b32 v242, 16, v250
v_and_b32 v248, 0xffff0000, v250
v_mul_f32 v242, v242, v238
v_mul_f32 v248, v248, v238
v_cvt_pk_bf16_f32 v250, v242, v248
v_lshlrev_b32 v242, 16, v251
v_and_b32 v248, 0xffff0000, v251
v_mul_f32 v242, v242, v238
v_mul_f32 v248, v248, v238
v_cvt_pk_bf16_f32 v251, v242, v248
ds_write_b64 v231, v[250:251] offset:2048
s_waitcnt lgkmcnt(0)
ds_read_b64 v[250:251], v231 offset:2056
s_waitcnt lgkmcnt(0)
v_lshlrev_b32 v242, 16, v250
v_and_b32 v248, 0xffff0000, v250
v_mul_f32 v242, v242, v238
v_mul_f32 v248, v248, v238
v_cvt_pk_bf16_f32 v250, v242, v248
v_lshlrev_b32 v242, 16, v251
v_and_b32 v248, 0xffff0000, v251
v_mul_f32 v242, v242, v238
v_mul_f32 v248, v248, v238
v_cvt_pk_bf16_f32 v251, v242, v248
ds_write_b64 v231, v[250:251] offset:2056
s_waitcnt lgkmcnt(0)
ds_read_b64 v[250:251], v231 offset:6144
s_waitcnt lgkmcnt(0)
v_lshlrev_b32 v242, 16, v250
v_and_b32 v248, 0xffff0000, v250
v_mul_f32 v242, v242, v238
v_mul_f32 v248, v248, v238
v_cvt_pk_bf16_f32 v250, v242, v248
v_lshlrev_b32 v242, 16, v251
v_and_b32 v248, 0xffff0000, v251
v_mul_f32 v242, v242, v238
v_mul_f32 v248, v248, v238
v_cvt_pk_bf16_f32 v251, v242, v248
ds_write_b64 v231, v[250:251] offset:6144
s_waitcnt lgkmcnt(0)
ds_read_b64 v[250:251], v231 offset:6152
s_waitcnt lgkmcnt(0)
v_lshlrev_b32 v242, 16, v250
v_and_b32 v248, 0xffff0000, v250
v_mul_f32 v242, v242, v238
v_mul_f32 v248, v248, v238
v_cvt_pk_bf16_f32 v250, v242, v248
v_lshlrev_b32 v242, 16, v251
v_and_b32 v248, 0xffff0000, v251
v_mul_f32 v242, v242, v238
v_mul_f32 v248, v248, v238
v_cvt_pk_bf16_f32 v251, v242, v248
ds_write_b64 v231, v[250:251] offset:6152
s_waitcnt lgkmcnt(0)
v_exp_f32 v248, v156
s_nop 0
v_sub_f32 v227, v227, v248
v_exp_f32 v248, v157
s_nop 0
v_sub_f32 v227, v227, v248
v_exp_f32 v248, v158
s_nop 0
v_sub_f32 v227, v227, v248
v_exp_f32 v248, v159
s_nop 0
v_sub_f32 v227, v227, v248
v_max_f32 v227, 0, v227
v_min_f32 v227, s32, v227
v_log_f32 v248, v227
v_max3_f32 v235, v156, v157, v158
v_max3_f32 v235, v235, v159, v248
v_mov_b32 v248, v235
s_nop 1
v_permlane32_swap_b32 v235, v248
s_nop 1
v_max_f32 v235, v235, v248
v_mov_b32 v248, v235
s_nop 1
v_permlane16_swap_b32 v235, v248
s_nop 1
v_max_f32 v235, v235, v248
v_ceil_f32 v235, v235
v_max_f32 v235, 0, v235
v_sub_f32 v248, 0, v235
v_exp_f32 v239, v248
s_nop 1
v_mul_f32 v227, v227, v239
v_sub_f32 v204, v204, v235
v_sub_f32 v140, v140, v235
v_sub_f32 v156, v156, v235
v_sub_f32 v205, v205, v235
v_sub_f32 v141, v141, v235
v_sub_f32 v157, v157, v235
v_sub_f32 v206, v206, v235
v_sub_f32 v142, v142, v235
v_sub_f32 v158, v158, v235
v_sub_f32 v207, v207, v235
v_sub_f32 v143, v143, v235
v_sub_f32 v159, v159, v235
v_lshlrev_b32 v242, 16, v188
v_and_b32 v248, 0xffff0000, v188
v_mul_f32 v242, v242, v239
v_mul_f32 v248, v248, v239
v_cvt_pk_bf16_f32 v188, v242, v248
v_lshlrev_b32 v242, 16, v189
v_and_b32 v248, 0xffff0000, v189
v_mul_f32 v242, v242, v239
v_mul_f32 v248, v248, v239
v_cvt_pk_bf16_f32 v189, v242, v248
v_lshlrev_b32 v242, 16, v190
v_and_b32 v248, 0xffff0000, v190
v_mul_f32 v242, v242, v239
v_mul_f32 v248, v248, v239
v_cvt_pk_bf16_f32 v190, v242, v248
v_lshlrev_b32 v242, 16, v191
v_and_b32 v248, 0xffff0000, v191
v_mul_f32 v242, v242, v239
v_mul_f32 v248, v248, v239
v_cvt_pk_bf16_f32 v191, v242, v248
v_lshlrev_b32 v242, 16, v172
v_and_b32 v248, 0xffff0000, v172
v_mul_f32 v242, v242, v239
v_mul_f32 v248, v248, v239
v_cvt_pk_bf16_f32 v172, v242, v248
v_lshlrev_b32 v242, 16, v173
v_and_b32 v248, 0xffff0000, v173
v_mul_f32 v242, v242, v239
v_mul_f32 v248, v248, v239
v_cvt_pk_bf16_f32 v173, v242, v248
ds_read_b64 v[250:251], v231 offset:3072
s_waitcnt lgkmcnt(0)
v_lshlrev_b32 v242, 16, v250
v_and_b32 v248, 0xffff0000, v250
v_mul_f32 v242, v242, v239
v_mul_f32 v248, v248, v239
v_cvt_pk_bf16_f32 v250, v242, v248
v_lshlrev_b32 v242, 16, v251
v_and_b32 v248, 0xffff0000, v251
v_mul_f32 v242, v242, v239
v_mul_f32 v248, v248, v239
v_cvt_pk_bf16_f32 v251, v242, v248
ds_write_b64 v231, v[250:251] offset:3072
s_waitcnt lgkmcnt(0)
ds_read_b64 v[250:251], v231 offset:3080
s_waitcnt lgkmcnt(0)
v_lshlrev_b32 v242, 16, v250
v_and_b32 v248, 0xffff0000, v250
v_mul_f32 v242, v242, v239
v_mul_f32 v248, v248, v239
v_cvt_pk_bf16_f32 v250, v242, v248
v_lshlrev_b32 v242, 16, v251
v_and_b32 v248, 0xffff0000, v251
v_mul_f32 v242, v242, v239
v_mul_f32 v248, v248, v239
v_cvt_pk_bf16_f32 v251, v242, v248
ds_write_b64 v231, v[250:251] offset:3080
s_waitcnt lgkmcnt(0)
ds_read_b64 v[250:251], v231 offset:7168
s_waitcnt lgkmcnt(0)
v_lshlrev_b32 v242, 16, v250
v_and_b32 v248, 0xffff0000, v250
v_mul_f32 v242, v242, v239
v_mul_f32 v248, v248, v239
v_cvt_pk_bf16_f32 v250, v242, v248
v_lshlrev_b32 v242, 16, v251
v_and_b32 v248, 0xffff0000, v251
v_mul_f32 v242, v242, v239
v_mul_f32 v248, v248, v239
v_cvt_pk_bf16_f32 v251, v242, v248
ds_write_b64 v231, v[250:251] offset:7168
s_waitcnt lgkmcnt(0)
ds_read_b64 v[250:251], v231 offset:7176
s_waitcnt lgkmcnt(0)
v_lshlrev_b32 v242, 16, v250
v_and_b32 v248, 0xffff0000, v250
v_mul_f32 v242, v242, v239
v_mul_f32 v248, v248, v239
v_cvt_pk_bf16_f32 v250, v242, v248
v_lshlrev_b32 v242, 16, v251
v_and_b32 v248, 0xffff0000, v251
v_mul_f32 v242, v242, v239
v_mul_f32 v248, v248, v239
v_cvt_pk_bf16_f32 v251, v242, v248
ds_write_b64 v231, v[250:251] offset:7176
s_waitcnt lgkmcnt(0)
v_exp_f32 v232, v144
v_exp_f32 v233, v145
v_exp_f32 v234, v146
v_exp_f32 v235, v147
s_nop 1
v_add_f32 v224, v224, v232
v_add_f32 v224, v224, v233
v_add_f32 v224, v224, v234
v_add_f32 v224, v224, v235
v_cvt_pk_bf16_f32 v162, v232, v233
v_cvt_pk_bf16_f32 v163, v234, v235
v_exp_f32 v232, v148
v_exp_f32 v233, v149
v_exp_f32 v234, v150
v_exp_f32 v235, v151
s_nop 1
v_add_f32 v225, v225, v232
v_add_f32 v225, v225, v233
v_add_f32 v225, v225, v234
v_add_f32 v225, v225, v235
v_cvt_pk_bf16_f32 v166, v232, v233
v_cvt_pk_bf16_f32 v167, v234, v235
v_exp_f32 v232, v152
v_exp_f32 v233, v153
v_exp_f32 v234, v154
v_exp_f32 v235, v155
s_nop 1
v_add_f32 v226, v226, v232
v_add_f32 v226, v226, v233
v_add_f32 v226, v226, v234
v_add_f32 v226, v226, v235
v_cvt_pk_bf16_f32 v170, v232, v233
v_cvt_pk_bf16_f32 v171, v234, v235
v_exp_f32 v232, v156
v_exp_f32 v233, v157
v_exp_f32 v234, v158
v_exp_f32 v235, v159
s_nop 1
v_add_f32 v227, v227, v232
v_add_f32 v227, v227, v233
v_add_f32 v227, v227, v234
v_add_f32 v227, v227, v235
v_cvt_pk_bf16_f32 v174, v232, v233
v_cvt_pk_bf16_f32 v175, v234, v235
s_branch L2_rare_common
L2_rare_site10:
s_mov_b32 s36, 10
s_branch L2_rare_t1_4_0
L2_rare_t1_4_0:
s_nop 15
s_nop 15
s_waitcnt lgkmcnt(0)
v_exp_f32 v248, v128
s_nop 0
v_sub_f32 v224, v224, v248
v_exp_f32 v248, v129
s_nop 0
v_sub_f32 v224, v224, v248
v_exp_f32 v248, v130
s_nop 0
v_sub_f32 v224, v224, v248
v_exp_f32 v248, v131
s_nop 0
v_sub_f32 v224, v224, v248
v_max_f32 v224, 0, v224
v_min_f32 v224, s32, v224
v_log_f32 v248, v224
v_max3_f32 v232, v128, v129, v130
v_max3_f32 v232, v232, v131, v248
v_mov_b32 v248, v232
s_nop 1
v_permlane32_swap_b32 v232, v248
s_nop 1
v_max_f32 v232, v232, v248
v_mov_b32 v248, v232
s_nop 1
v_permlane16_swap_b32 v232, v248
s_nop 1
v_max_f32 v232, v232, v248
v_ceil_f32 v232, v232
v_max_f32 v232, 0, v232
v_sub_f32 v248, 0, v232
v_exp_f32 v236, v248
s_nop 1
v_mul_f32 v224, v224, v236
v_sub_f32 v192, v192, v232
v_sub_f32 v128, v128, v232
v_sub_f32 v144, v144, v232
v_sub_f32 v193, v193, v232
v_sub_f32 v129, v129, v232
v_sub_f32 v145, v145, v232
v_sub_f32 v194, v194, v232
v_sub_f32 v130, v130, v232
v_sub_f32 v146, v146, v232
v_sub_f32 v195, v195, v232
v_sub_f32 v131, v131, v232
v_sub_f32 v147, v147, v232
v_lshlrev_b32 v242, 16, v4
v_and_b32 v248, 0xffff0000, v4
v_mul_f32 v242, v242, v236
v_mul_f32 v248, v248, v236
v_cvt_pk_bf16_f32 v4, v242, v248
v_lshlrev_b32 v242, 16, v5
v_and_b32 v248, 0xffff0000, v5
v_mul_f32 v242, v242, v236
v_mul_f32 v248, v248, v236
v_cvt_pk_bf16_f32 v5, v242, v248
v_lshlrev_b32 v242, 16, v6
v_and_b32 v248, 0xffff0000, v6
v_mul_f32 v242, v242, v236
v_mul_f32 v248, v248, v236
v_cvt_pk_bf16_f32 v6, v242, v248
v_lshlrev_b32 v242, 16, v7
v_and_b32 v248, 0xffff0000, v7
v_mul_f32 v242, v242, v236
v_mul_f32 v248, v248, v236
v_cvt_pk_bf16_f32 v7, v242, v248
v_lshlrev_b32 v242, 16, v8
v_and_b32 v248, 0xffff0000, v8
v_mul_f32 v242, v242, v236
v_mul_f32 v248, v248, v236
v_cvt_pk_bf16_f32 v8, v242, v248
v_lshlrev_b32 v242, 16, v9
v_and_b32 v248, 0xffff0000, v9
v_mul_f32 v242, v242, v236
v_mul_f32 v248, v248, v236
v_cvt_pk_bf16_f32 v9, v242, v248
v_lshlrev_b32 v242, 16, v10
v_and_b32 v248, 0xffff0000, v10
v_mul_f32 v242, v242, v236
v_mul_f32 v248, v248, v236
v_cvt_pk_bf16_f32 v10, v242, v248
v_lshlrev_b32 v242, 16, v11
v_and_b32 v248, 0xffff0000, v11
v_mul_f32 v242, v242, v236
v_mul_f32 v248, v248, v236
v_cvt_pk_bf16_f32 v11, v242, v248
v_lshlrev_b32 v242, 16, v176
v_and_b32 v248, 0xffff0000, v176
v_mul_f32 v242, v242, v236
v_mul_f32 v248, v248, v236
v_cvt_pk_bf16_f32 v176, v242, v248
v_lshlrev_b32 v242, 16, v177
v_and_b32 v248, 0xffff0000, v177
v_mul_f32 v242, v242, v236
v_mul_f32 v248, v248, v236
v_cvt_pk_bf16_f32 v177, v242, v248
v_lshlrev_b32 v242, 16, v178
v_and_b32 v248, 0xffff0000, v178
v_mul_f32 v242, v242, v236
v_mul_f32 v248, v248, v236
v_cvt_pk_bf16_f32 v178, v242, v248
v_lshlrev_b32 v242, 16, v179
v_and_b32 v248, 0xffff0000, v179
v_mul_f32 v242, v242, v236
v_mul_f32 v248, v248, v236
v_cvt_pk_bf16_f32 v179, v242, v248
v_lshlrev_b32 v242, 16, v160
v_and_b32 v248, 0xffff0000, v160
v_mul_f32 v242, v242, v236
v_mul_f32 v248, v248, v236
v_cvt_pk_bf16_f32 v160, v242, v248
v_lshlrev_b32 v242, 16, v161
v_and_b32 v248, 0xffff0000, v161
v_mul_f32 v242, v242, v236
v_mul_f32 v248, v248, v236
v_cvt_pk_bf16_f32 v161, v242, v248
v_lshlrev_b32 v242, 16, v162
v_and_b32 v248, 0xffff0000, v162
v_mul_f32 v242, v242, v236
v_mul_f32 v248, v248, v236
v_cvt_pk_bf16_f32 v162, v242, v248
v_lshlrev_b32 v242, 16, v163
v_and_b32 v248, 0xffff0000, v163
v_mul_f32 v242, v242, v236
v_mul_f32 v248, v248, v236
v_cvt_pk_bf16_f32 v163, v242, v248
v_exp_f32 v248, v132
s_nop 0
v_sub_f32 v225, v225, v248
v_exp_f32 v248, v133
s_nop 0
v_sub_f32 v225, v225, v248
v_exp_f32 v248, v134
s_nop 0
v_sub_f32 v225, v225, v248
v_exp_f32 v248, v135
s_nop 0
v_sub_f32 v225, v225, v248
v_max_f32 v225, 0, v225
v_min_f32 v225, s32, v225
v_log_f32 v248, v225
v_max3_f32 v233, v132, v133, v134
v_max3_f32 v233, v233, v135, v248
v_mov_b32 v248, v233
s_nop 1
v_permlane32_swap_b32 v233, v248
s_nop 1
v_max_f32 v233, v233, v248
v_mov_b32 v248, v233
s_nop 1
v_permlane16_swap_b32 v233, v248
s_nop 1
v_max_f32 v233, v233, v248
v_ceil_f32 v233, v233
v_max_f32 v233, 0, v233
v_sub_f32 v248, 0, v233
v_exp_f32 v237, v248
s_nop 1
v_mul_f32 v225, v225, v237
v_sub_f32 v196, v196, v233
v_sub_f32 v132, v132, v233
v_sub_f32 v148, v148, v233
v_sub_f32 v197, v197, v233
v_sub_f32 v133, v133, v233
v_sub_f32 v149, v149, v233
v_sub_f32 v198, v198, v233
v_sub_f32 v134, v134, v233
v_sub_f32 v150, v150, v233
v_sub_f32 v199, v199, v233
v_sub_f32 v135, v135, v233
v_sub_f32 v151, v151, v233
v_lshlrev_b32 v242, 16, v36
v_and_b32 v248, 0xffff0000, v36
v_mul_f32 v242, v242, v237
v_mul_f32 v248, v248, v237
v_cvt_pk_bf16_f32 v36, v242, v248
v_lshlrev_b32 v242, 16, v37
v_and_b32 v248, 0xffff0000, v37
v_mul_f32 v242, v242, v237
v_mul_f32 v248, v248, v237
v_cvt_pk_bf16_f32 v37, v242, v248
v_lshlrev_b32 v242, 16, v38
v_and_b32 v248, 0xffff0000, v38
v_mul_f32 v242, v242, v237
v_mul_f32 v248, v248, v237
v_cvt_pk_bf16_f32 v38, v242, v248
v_lshlrev_b32 v242, 16, v39
v_and_b32 v248, 0xffff0000, v39
v_mul_f32 v242, v242, v237
v_mul_f32 v248, v248, v237
v_cvt_pk_bf16_f32 v39, v242, v248
v_lshlrev_b32 v242, 16, v40
v_and_b32 v248, 0xffff0000, v40
v_mul_f32 v242, v242, v237
v_mul_f32 v248, v248, v237
v_cvt_pk_bf16_f32 v40, v242, v248
v_lshlrev_b32 v242, 16, v41
v_and_b32 v248, 0xffff0000, v41
v_mul_f32 v242, v242, v237
v_mul_f32 v248, v248, v237
v_cvt_pk_bf16_f32 v41, v242, v248
v_lshlrev_b32 v242, 16, v42
v_and_b32 v248, 0xffff0000, v42
v_mul_f32 v242, v242, v237
v_mul_f32 v248, v248, v237
v_cvt_pk_bf16_f32 v42, v242, v248
v_lshlrev_b32 v242, 16, v43
v_and_b32 v248, 0xffff0000, v43
v_mul_f32 v242, v242, v237
v_mul_f32 v248, v248, v237
v_cvt_pk_bf16_f32 v43, v242, v248
v_lshlrev_b32 v242, 16, v180
v_and_b32 v248, 0xffff0000, v180
v_mul_f32 v242, v242, v237
v_mul_f32 v248, v248, v237
v_cvt_pk_bf16_f32 v180, v242, v248
v_lshlrev_b32 v242, 16, v181
v_and_b32 v248, 0xffff0000, v181
v_mul_f32 v242, v242, v237
v_mul_f32 v248, v248, v237
v_cvt_pk_bf16_f32 v181, v242, v248
v_lshlrev_b32 v242, 16, v182
v_and_b32 v248, 0xffff0000, v182
v_mul_f32 v242, v242, v237
v_mul_f32 v248, v248, v237
v_cvt_pk_bf16_f32 v182, v242, v248
v_lshlrev_b32 v242, 16, v183
v_and_b32 v248, 0xffff0000, v183
v_mul_f32 v242, v242, v237
v_mul_f32 v248, v248, v237
v_cvt_pk_bf16_f32 v183, v242, v248
v_lshlrev_b32 v242, 16, v164
v_and_b32 v248, 0xffff0000, v164
v_mul_f32 v242, v242, v237
v_mul_f32 v248, v248, v237
v_cvt_pk_bf16_f32 v164, v242, v248
v_lshlrev_b32 v242, 16, v165
v_and_b32 v248, 0xffff0000, v165
v_mul_f32 v242, v242, v237
v_mul_f32 v248, v248, v237
v_cvt_pk_bf16_f32 v165, v242, v248
v_lshlrev_b32 v242, 16, v166
v_and_b32 v248, 0xffff0000, v166
v_mul_f32 v242, v242, v237
v_mul_f32 v248, v248, v237
v_cvt_pk_bf16_f32 v166, v242, v248
v_lshlrev_b32 v242, 16, v167
v_and_b32 v248, 0xffff0000, v167
v_mul_f32 v242, v242, v237
v_mul_f32 v248, v248, v237
v_cvt_pk_bf16_f32 v167, v242, v248
v_exp_f32 v248, v136
s_nop 0
v_sub_f32 v226, v226, v248
v_exp_f32 v248, v137
s_nop 0
v_sub_f32 v226, v226, v248
v_exp_f32 v248, v138
s_nop 0
v_sub_f32 v226, v226, v248
v_exp_f32 v248, v139
s_nop 0
v_sub_f32 v226, v226, v248
v_max_f32 v226, 0, v226
v_min_f32 v226, s32, v226
v_log_f32 v248, v226
v_max3_f32 v234, v136, v137, v138
v_max3_f32 v234, v234, v139, v248
v_mov_b32 v248, v234
s_nop 1
v_permlane32_swap_b32 v234, v248
s_nop 1
v_max_f32 v234, v234, v248
v_mov_b32 v248, v234
s_nop 1
v_permlane16_swap_b32 v234, v248
s_nop 1
v_max_f32 v234, v234, v248
v_ceil_f32 v234, v234
v_max_f32 v234, 0, v234
v_sub_f32 v248, 0, v234
v_exp_f32 v238, v248
s_nop 1
v_mul_f32 v226, v226, v238
v_sub_f32 v200, v200, v234
v_sub_f32 v136, v136, v234
v_sub_f32 v152, v152, v234
v_sub_f32 v201, v201, v234
v_sub_f32 v137, v137, v234
v_sub_f32 v153, v153, v234
v_sub_f32 v202, v202, v234
v_sub_f32 v138, v138, v234
v_sub_f32 v154, v154, v234
v_sub_f32 v203, v203, v234
v_sub_f32 v139, v139, v234
v_sub_f32 v155, v155, v234
v_lshlrev_b32 v242, 16, v68
v_and_b32 v248, 0xffff0000, v68
v_mul_f32 v242, v242, v238
v_mul_f32 v248, v248, v238
v_cvt_pk_bf16_f32 v68, v242, v248
v_lshlrev_b32 v242, 16, v69
v_and_b32 v248, 0xffff0000, v69
v_mul_f32 v242, v242, v238
v_mul_f32 v248, v248, v238
v_cvt_pk_bf16_f32 v69, v242, v248
v_lshlrev_b32 v242, 16, v70
v_and_b32 v248, 0xffff0000, v70
v_mul_f32 v242, v242, v238
v_mul_f32 v248, v248, v238
v_cvt_pk_bf16_f32 v70, v242, v248
v_lshlrev_b32 v242, 16, v71
v_and_b32 v248, 0xffff0000, v71
v_mul_f32 v242, v242, v238
v_mul_f32 v248, v248, v238
v_cvt_pk_bf16_f32 v71, v242, v248
v_lshlrev_b32 v242, 16, v72
v_and_b32 v248, 0xffff0000, v72
v_mul_f32 v242, v242, v238
v_mul_f32 v248, v248, v238
v_cvt_pk_bf16_f32 v72, v242, v248
v_lshlrev_b32 v242, 16, v73
v_and_b32 v248, 0xffff0000, v73
v_mul_f32 v242, v242, v238
v_mul_f32 v248, v248, v238
v_cvt_pk_bf16_f32 v73, v242, v248
v_lshlrev_b32 v242, 16, v74
v_and_b32 v248, 0xffff0000, v74
v_mul_f32 v242, v242, v238
v_mul_f32 v248, v248, v238
v_cvt_pk_bf16_f32 v74, v242, v248
v_lshlrev_b32 v242, 16, v75
v_and_b32 v248, 0xffff0000, v75
v_mul_f32 v242, v242, v238
v_mul_f32 v248, v248, v238
v_cvt_pk_bf16_f32 v75, v242, v248
v_lshlrev_b32 v242, 16, v184
v_and_b32 v248, 0xffff0000, v184
v_mul_f32 v242, v242, v238
v_mul_f32 v248, v248, v238
v_cvt_pk_bf16_f32 v184, v242, v248
v_lshlrev_b32 v242, 16, v185
v_and_b32 v248, 0xffff0000, v185
v_mul_f32 v242, v242, v238
v_mul_f32 v248, v248, v238
v_cvt_pk_bf16_f32 v185, v242, v248
v_lshlrev_b32 v242, 16, v186
v_and_b32 v248, 0xffff0000, v186
v_mul_f32 v242, v242, v238
v_mul_f32 v248, v248, v238
v_cvt_pk_bf16_f32 v186, v242, v248
v_lshlrev_b32 v242, 16, v187
v_and_b32 v248, 0xffff0000, v187
v_mul_f32 v242, v242, v238
v_mul_f32 v248, v248, v238
v_cvt_pk_bf16_f32 v187, v242, v248
v_lshlrev_b32 v242, 16, v168
v_and_b32 v248, 0xffff0000, v168
v_mul_f32 v242, v242, v238
v_mul_f32 v248, v248, v238
v_cvt_pk_bf16_f32 v168, v242, v248
v_lshlrev_b32 v242, 16, v169
v_and_b32 v248, 0xffff0000, v169
v_mul_f32 v242, v242, v238
v_mul_f32 v248, v248, v238
v_cvt_pk_bf16_f32 v169, v242, v248
v_lshlrev_b32 v242, 16, v170
v_and_b32 v248, 0xffff0000, v170
v_mul_f32 v242, v242, v238
v_mul_f32 v248, v248, v238
v_cvt_pk_bf16_f32 v170, v242, v248
v_lshlrev_b32 v242, 16, v171
v_and_b32 v248, 0xffff0000, v171
v_mul_f32 v242, v242, v238
v_mul_f32 v248, v248, v238
v_cvt_pk_bf16_f32 v171, v242, v248
v_exp_f32 v248, v140
s_nop 0
v_sub_f32 v227, v227, v248
v_exp_f32 v248, v141
s_nop 0
v_sub_f32 v227, v227, v248
v_exp_f32 v248, v142
s_nop 0
v_sub_f32 v227, v227, v248
v_exp_f32 v248, v143
s_nop 0
v_sub_f32 v227, v227, v248
v_max_f32 v227, 0, v227
v_min_f32 v227, s32, v227
v_log_f32 v248, v227
v_max3_f32 v235, v140, v141, v142
v_max3_f32 v235, v235, v143, v248
v_mov_b32 v248, v235
s_nop 1
v_permlane32_swap_b32 v235, v248
s_nop 1
v_max_f32 v235, v235, v248
v_mov_b32 v248, v235
s_nop 1
v_permlane16_swap_b32 v235, v248
s_nop 1
v_max_f32 v235, v235, v248
v_ceil_f32 v235, v235
v_max_f32 v235, 0, v235
v_sub_f32 v248, 0, v235
v_exp_f32 v239, v248
s_nop 1
v_mul_f32 v227, v227, v239
v_sub_f32 v204, v204, v235
v_sub_f32 v140, v140, v235
v_sub_f32 v156, v156, v235
v_sub_f32 v205, v205, v235
v_sub_f32 v141, v141, v235
v_sub_f32 v157, v157, v235
v_sub_f32 v206, v206, v235
v_sub_f32 v142, v142, v235
v_sub_f32 v158, v158, v235
v_sub_f32 v207, v207, v235
v_sub_f32 v143, v143, v235
v_sub_f32 v159, v159, v235
v_lshlrev_b32 v242, 16, v100
v_and_b32 v248, 0xffff0000, v100
v_mul_f32 v242, v242, v239
v_mul_f32 v248, v248, v239
v_cvt_pk_bf16_f32 v100, v242, v248
v_lshlrev_b32 v242, 16, v101
v_and_b32 v248, 0xffff0000, v101
v_mul_f32 v242, v242, v239
v_mul_f32 v248, v248, v239
v_cvt_pk_bf16_f32 v101, v242, v248
v_lshlrev_b32 v242, 16, v102
v_and_b32 v248, 0xffff0000, v102
v_mul_f32 v242, v242, v239
v_mul_f32 v248, v248, v239
v_cvt_pk_bf16_f32 v102, v242, v248
v_lshlrev_b32 v242, 16, v103
v_and_b32 v248, 0xffff0000, v103
v_mul_f32 v242, v242, v239
v_mul_f32 v248, v248, v239
v_cvt_pk_bf16_f32 v103, v242, v248
v_lshlrev_b32 v242, 16, v104
v_and_b32 v248, 0xffff0000, v104
v_mul_f32 v242, v242, v239
v_mul_f32 v248, v248, v239
v_cvt_pk_bf16_f32 v104, v242, v248
v_lshlrev_b32 v242, 16, v105
v_and_b32 v248, 0xffff0000, v105
v_mul_f32 v242, v242, v239
v_mul_f32 v248, v248, v239
v_cvt_pk_bf16_f32 v105, v242, v248
v_lshlrev_b32 v242, 16, v106
v_and_b32 v248, 0xffff0000, v106
v_mul_f32 v242, v242, v239
v_mul_f32 v248, v248, v239
v_cvt_pk_bf16_f32 v106, v242, v248
v_lshlrev_b32 v242, 16, v107
v_and_b32 v248, 0xffff0000, v107
v_mul_f32 v242, v242, v239
v_mul_f32 v248, v248, v239
v_cvt_pk_bf16_f32 v107, v242, v248
v_lshlrev_b32 v242, 16, v188
v_and_b32 v248, 0xffff0000, v188
v_mul_f32 v242, v242, v239
v_mul_f32 v248, v248, v239
v_cvt_pk_bf16_f32 v188, v242, v248
v_lshlrev_b32 v242, 16, v189
v_and_b32 v248, 0xffff0000, v189
v_mul_f32 v242, v242, v239
v_mul_f32 v248, v248, v239
v_cvt_pk_bf16_f32 v189, v242, v248
v_lshlrev_b32 v242, 16, v190
v_and_b32 v248, 0xffff0000, v190
v_mul_f32 v242, v242, v239
v_mul_f32 v248, v248, v239
v_cvt_pk_bf16_f32 v190, v242, v248
v_lshlrev_b32 v242, 16, v191
v_and_b32 v248, 0xffff0000, v191
v_mul_f32 v242, v242, v239
v_mul_f32 v248, v248, v239
v_cvt_pk_bf16_f32 v191, v242, v248
v_lshlrev_b32 v242, 16, v172
v_and_b32 v248, 0xffff0000, v172
v_mul_f32 v242, v242, v239
v_mul_f32 v248, v248, v239
v_cvt_pk_bf16_f32 v172, v242, v248
v_lshlrev_b32 v242, 16, v173
v_and_b32 v248, 0xffff0000, v173
v_mul_f32 v242, v242, v239
v_mul_f32 v248, v248, v239
v_cvt_pk_bf16_f32 v173, v242, v248
v_lshlrev_b32 v242, 16, v174
v_and_b32 v248, 0xffff0000, v174
v_mul_f32 v242, v242, v239
v_mul_f32 v248, v248, v239
v_cvt_pk_bf16_f32 v174, v242, v248
v_lshlrev_b32 v242, 16, v175
v_and_b32 v248, 0xffff0000, v175
v_mul_f32 v242, v242, v239
v_mul_f32 v248, v248, v239
v_cvt_pk_bf16_f32 v175, v242, v248
v_exp_f32 v232, v128
v_exp_f32 v233, v129
v_exp_f32 v234, v130
v_exp_f32 v235, v131
s_nop 1
v_add_f32 v224, v224, v232
v_add_f32 v224, v224, v233
v_add_f32 v224, v224, v234
v_add_f32 v224, v224, v235
v_cvt_pk_bf16_f32 v0, v232, v233
v_cvt_pk_bf16_f32 v1, v234, v235
v_exp_f32 v232, v132
v_exp_f32 v233, v133
v_exp_f32 v234, v134
v_exp_f32 v235, v135
s_nop 1
v_add_f32 v225, v225, v232
v_add_f32 v225, v225, v233
v_add_f32 v225, v225, v234
v_add_f32 v225, v225, v235
v_cvt_pk_bf16_f32 v32, v232, v233
v_cvt_pk_bf16_f32 v33, v234, v235
v_exp_f32 v232, v136
v_exp_f32 v233, v137
v_exp_f32 v234, v138
v_exp_f32 v235, v139
s_nop 1
v_add_f32 v226, v226, v232
v_add_f32 v226, v226, v233
v_add_f32 v226, v226, v234
v_add_f32 v226, v226, v235
v_cvt_pk_bf16_f32 v64, v232, v233
v_cvt_pk_bf16_f32 v65, v234, v235
v_exp_f32 v232, v140
v_exp_f32 v233, v141
v_exp_f32 v234, v142
v_exp_f32 v235, v143
s_nop 1
v_add_f32 v227, v227, v232
v_add_f32 v227, v227, v233
v_add_f32 v227, v227, v234
v_add_f32 v227, v227, v235
v_cvt_pk_bf16_f32 v96, v232, v233
v_cvt_pk_bf16_f32 v97, v234, v235
s_branch L2_rare_common
L2_rare_site11:
s_mov_b32 s36, 11
s_branch L2_rare_t1_5_1
L2_rare_t1_5_1:
s_nop 15
s_nop 15
s_waitcnt lgkmcnt(0)
v_exp_f32 v248, v144
s_nop 0
v_sub_f32 v224, v224, v248
v_exp_f32 v248, v145
s_nop 0
v_sub_f32 v224, v224, v248
v_exp_f32 v248, v146
s_nop 0
v_sub_f32 v224, v224, v248
v_exp_f32 v248, v147
s_nop 0
v_sub_f32 v224, v224, v248
v_max_f32 v224, 0, v224
v_min_f32 v224, s32, v224
v_log_f32 v248, v224
v_max3_f32 v232, v144, v145, v146
v_max3_f32 v232, v232, v147, v248
v_mov_b32 v248, v232
s_nop 1
v_permlane32_swap_b32 v232, v248
s_nop 1
v_max_f32 v232, v232, v248
v_mov_b32 v248, v232
s_nop 1
v_permlane16_swap_b32 v232, v248
s_nop 1
v_max_f32 v232, v232, v248
v_ceil_f32 v232, v232
v_max_f32 v232, 0, v232
v_sub_f32 v248, 0, v232
v_exp_f32 v236, v248
s_nop 1
v_mul_f32 v224, v224, v236
v_sub_f32 v192, v192, v232
v_sub_f32 v128, v128, v232
v_sub_f32 v144, v144, v232
v_sub_f32 v193, v193, v232
v_sub_f32 v129, v129, v232
v_sub_f32 v145, v145, v232
v_sub_f32 v194, v194, v232
v_sub_f32 v130, v130, v232
v_sub_f32 v146, v146, v232
v_sub_f32 v195, v195, v232
v_sub_f32 v131, v131, v232
v_sub_f32 v147, v147, v232
v_lshlrev_b32 v242, 16, v4
v_and_b32 v248, 0xffff0000, v4
v_mul_f32 v242, v242, v236
v_mul_f32 v248, v248, v236
v_cvt_pk_bf16_f32 v4, v242, v248
v_lshlrev_b32 v242, 16, v5
v_and_b32 v248, 0xffff0000, v5
v_mul_f32 v242, v242, v236
v_mul_f32 v248, v248, v236
v_cvt_pk_bf16_f32 v5, v242, v248
v_lshlrev_b32 v242, 16, v6
v_and_b32 v248, 0xffff0000, v6
v_mul_f32 v242, v242, v236
v_mul_f32 v248, v248, v236
v_cvt_pk_bf16_f32 v6, v242, v248
v_lshlrev_b32 v242, 16, v7
v_and_b32 v248, 0xffff0000, v7
v_mul_f32 v242, v242, v236
v_mul_f32 v248, v248, v236
v_cvt_pk_bf16_f32 v7, v242, v248
v_lshlrev_b32 v242, 16, v8
v_and_b32 v248, 0xffff0000, v8
v_mul_f32 v242, v242, v236
v_mul_f32 v248, v248, v236
v_cvt_pk_bf16_f32 v8, v242, v248
v_lshlrev_b32 v242, 16, v9
v_and_b32 v248, 0xffff0000, v9
v_mul_f32 v242, v242, v236
v_mul_f32 v248, v248, v236
v_cvt_pk_bf16_f32 v9, v242, v248
v_lshlrev_b32 v242, 16, v10
v_and_b32 v248, 0xffff0000, v10
v_mul_f32 v242, v242, v236
v_mul_f32 v248, v248, v236
v_cvt_pk_bf16_f32 v10, v242, v248
v_lshlrev_b32 v242, 16, v11
v_and_b32 v248, 0xffff0000, v11
v_mul_f32 v242, v242, v236
v_mul_f32 v248, v248, v236
v_cvt_pk_bf16_f32 v11, v242, v248
v_lshlrev_b32 v242, 16, v176
v_and_b32 v248, 0xffff0000, v176
v_mul_f32 v242, v242, v236
v_mul_f32 v248, v248, v236
v_cvt_pk_bf16_f32 v176, v242, v248
v_lshlrev_b32 v242, 16, v177
v_and_b32 v248, 0xffff0000, v177
v_mul_f32 v242, v242, v236
v_mul_f32 v248, v248, v236
v_cvt_pk_bf16_f32 v177, v242, v248
v_lshlrev_b32 v242, 16, v178
v_and_b32 v248, 0xffff0000, v178
v_mul_f32 v242, v242, v236
v_mul_f32 v248, v248, v236
v_cvt_pk_bf16_f32 v178, v242, v248
v_lshlrev_b32 v242, 16, v179
v_and_b32 v248, 0xffff0000, v179
v_mul_f32 v242, v242, v236
v_mul_f32 v248, v248, v236
v_cvt_pk_bf16_f32 v179, v242, v248
v_lshlrev_b32 v242, 16, v160
v_and_b32 v248, 0xffff0000, v160
v_mul_f32 v242, v242, v236
v_mul_f32 v248, v248, v236
v_cvt_pk_bf16_f32 v160, v242, v248
v_lshlrev_b32 v242, 16, v161
v_and_b32 v248, 0xffff0000, v161
v_mul_f32 v242, v242, v236
v_mul_f32 v248, v248, v236
v_cvt_pk_bf16_f32 v161, v242, v248
v_lshlrev_b32 v242, 16, v162
v_and_b32 v248, 0xffff0000, v162
v_mul_f32 v242, v242, v236
v_mul_f32 v248, v248, v236
v_cvt_pk_bf16_f32 v162, v242, v248
v_lshlrev_b32 v242, 16, v163
v_and_b32 v248, 0xffff0000, v163
v_mul_f32 v242, v242, v236
v_mul_f32 v248, v248, v236
v_cvt_pk_bf16_f32 v163, v242, v248
v_lshlrev_b32 v242, 16, v0
v_and_b32 v248, 0xffff0000, v0
v_mul_f32 v242, v242, v236
v_mul_f32 v248, v248, v236
v_cvt_pk_bf16_f32 v0, v242, v248
v_lshlrev_b32 v242, 16, v1
v_and_b32 v248, 0xffff0000, v1
v_mul_f32 v242, v242, v236
v_mul_f32 v248, v248, v236
v_cvt_pk_bf16_f32 v1, v242, v248
v_exp_f32 v248, v148
s_nop 0
v_sub_f32 v225, v225, v248
v_exp_f32 v248, v149
s_nop 0
v_sub_f32 v225, v225, v248
v_exp_f32 v248, v150
s_nop 0
v_sub_f32 v225, v225, v248
v_exp_f32 v248, v151
s_nop 0
v_sub_f32 v225, v225, v248
v_max_f32 v225, 0, v225
v_min_f32 v225, s32, v225
v_log_f32 v248, v225
v_max3_f32 v233, v148, v149, v150
v_max3_f32 v233, v233, v151, v248
v_mov_b32 v248, v233
s_nop 1
v_permlane32_swap_b32 v233, v248
s_nop 1
v_max_f32 v233, v233, v248
v_mov_b32 v248, v233
s_nop 1
v_permlane16_swap_b32 v233, v248
s_nop 1
v_max_f32 v233, v233, v248
v_ceil_f32 v233, v233
v_max_f32 v233, 0, v233
v_sub_f32 v248, 0, v233
v_exp_f32 v237, v248
s_nop 1
v_mul_f32 v225, v225, v237
v_sub_f32 v196, v196, v233
v_sub_f32 v132, v132, v233
v_sub_f32 v148, v148, v233
v_sub_f32 v197, v197, v233
v_sub_f32 v133, v133, v233
v_sub_f32 v149, v149, v233
v_sub_f32 v198, v198, v233
v_sub_f32 v134, v134, v233
v_sub_f32 v150, v150, v233
v_sub_f32 v199, v199, v233
v_sub_f32 v135, v135, v233
v_sub_f32 v151, v151, v233
v_lshlrev_b32 v242, 16, v36
v_and_b32 v248, 0xffff0000, v36
v_mul_f32 v242, v242, v237
v_mul_f32 v248, v248, v237
v_cvt_pk_bf16_f32 v36, v242, v248
v_lshlrev_b32 v242, 16, v37
v_and_b32 v248, 0xffff0000, v37
v_mul_f32 v242, v242, v237
v_mul_f32 v248, v248, v237
v_cvt_pk_bf16_f32 v37, v242, v248
v_lshlrev_b32 v242, 16, v38
v_and_b32 v248, 0xffff0000, v38
v_mul_f32 v242, v242, v237
v_mul_f32 v248, v248, v237
v_cvt_pk_bf16_f32 v38, v242, v248
v_lshlrev_b32 v242, 16, v39
v_and_b32 v248, 0xffff0000, v39
v_mul_f32 v242, v242, v237
v_mul_f32 v248, v248, v237
v_cvt_pk_bf16_f32 v39, v242, v248
v_lshlrev_b32 v242, 16, v40
v_and_b32 v248, 0xffff0000, v40
v_mul_f32 v242, v242, v237
v_mul_f32 v248, v248, v237
v_cvt_pk_bf16_f32 v40, v242, v248
v_lshlrev_b32 v242, 16, v41
v_and_b32 v248, 0xffff0000, v41
v_mul_f32 v242, v242, v237
v_mul_f32 v248, v248, v237
v_cvt_pk_bf16_f32 v41, v242, v248
v_lshlrev_b32 v242, 16, v42
v_and_b32 v248, 0xffff0000, v42
v_mul_f32 v242, v242, v237
v_mul_f32 v248, v248, v237
v_cvt_pk_bf16_f32 v42, v242, v248
v_lshlrev_b32 v242, 16, v43
v_and_b32 v248, 0xffff0000, v43
v_mul_f32 v242, v242, v237
v_mul_f32 v248, v248, v237
v_cvt_pk_bf16_f32 v43, v242, v248
v_lshlrev_b32 v242, 16, v180
v_and_b32 v248, 0xffff0000, v180
v_mul_f32 v242, v242, v237
v_mul_f32 v248, v248, v237
v_cvt_pk_bf16_f32 v180, v242, v248
v_lshlrev_b32 v242, 16, v181
v_and_b32 v248, 0xffff0000, v181
v_mul_f32 v242, v242, v237
v_mul_f32 v248, v248, v237
v_cvt_pk_bf16_f32 v181, v242, v248
v_lshlrev_b32 v242, 16, v182
v_and_b32 v248, 0xffff0000, v182
v_mul_f32 v242, v242, v237
v_mul_f32 v248, v248, v237
v_cvt_pk_bf16_f32 v182, v242, v248
v_lshlrev_b32 v242, 16, v183
v_and_b32 v248, 0xffff0000, v183
v_mul_f32 v242, v242, v237
v_mul_f32 v248, v248, v237
v_cvt_pk_bf16_f32 v183, v242, v248
v_lshlrev_b32 v242, 16, v164
v_and_b32 v248, 0xffff0000, v164
v_mul_f32 v242, v242, v237
v_mul_f32 v248, v248, v237
v_cvt_pk_bf16_f32 v164, v242, v248
v_lshlrev_b32 v242, 16, v165
v_and_b32 v248, 0xffff0000, v165
v_mul_f32 v242, v242, v237
v_mul_f32 v248, v248, v237
v_cvt_pk_bf16_f32 v165, v242, v248
v_lshlrev_b32 v242, 16, v166
v_and_b32 v248, 0xffff0000, v166
v_mul_f32 v242, v242, v237
v_mul_f32 v248, v248, v237
v_cvt_pk_bf16_f32 v166, v242, v248
v_lshlrev_b32 v242, 16, v167
v_and_b32 v248, 0xffff0000, v167
v_mul_f32 v242, v242, v237
v_mul_f32 v248, v248, v237
v_cvt_pk_bf16_f32 v167, v242, v248
v_lshlrev_b32 v242, 16, v32
v_and_b32 v248, 0xffff0000, v32
v_mul_f32 v242, v242, v237
v_mul_f32 v248, v248, v237
v_cvt_pk_bf16_f32 v32, v242, v248
v_lshlrev_b32 v242, 16, v33
v_and_b32 v248, 0xffff0000, v33
v_mul_f32 v242, v242, v237
v_mul_f32 v248, v248, v237
v_cvt_pk_bf16_f32 v33, v242, v248
v_exp_f32 v248, v152
s_nop 0
v_sub_f32 v226, v226, v248
v_exp_f32 v248, v153
s_nop 0
v_sub_f32 v226, v226, v248
v_exp_f32 v248, v154
s_nop 0
v_sub_f32 v226, v226, v248
v_exp_f32 v248, v155
s_nop 0
v_sub_f32 v226, v226, v248
v_max_f32 v226, 0, v226
v_min_f32 v226, s32, v226
v_log_f32 v248, v226
v_max3_f32 v234, v152, v153, v154
v_max3_f32 v234, v234, v155, v248
v_mov_b32 v248, v234
s_nop 1
v_permlane32_swap_b32 v234, v248
s_nop 1
v_max_f32 v234, v234, v248
v_mov_b32 v248, v234
s_nop 1
v_permlane16_swap_b32 v234, v248
s_nop 1
v_max_f32 v234, v234, v248
v_ceil_f32 v234, v234
v_max_f32 v234, 0, v234
v_sub_f32 v248, 0, v234
v_exp_f32 v238, v248
s_nop 1
v_mul_f32 v226, v226, v238
v_sub_f32 v200, v200, v234
v_sub_f32 v136, v136, v234
v_sub_f32 v152, v152, v234
v_sub_f32 v201, v201, v234
v_sub_f32 v137, v137, v234
v_sub_f32 v153, v153, v234
v_sub_f32 v202, v202, v234
v_sub_f32 v138, v138, v234
v_sub_f32 v154, v154, v234
v_sub_f32 v203, v203, v234
v_sub_f32 v139, v139, v234
v_sub_f32 v155, v155, v234
v_lshlrev_b32 v242, 16, v68
v_and_b32 v248, 0xffff0000, v68
v_mul_f32 v242, v242, v238
v_mul_f32 v248, v248, v238
v_cvt_pk_bf16_f32 v68, v242, v248
v_lshlrev_b32 v242, 16, v69
v_and_b32 v248, 0xffff0000, v69
v_mul_f32 v242, v242, v238
v_mul_f32 v248, v248, v238
v_cvt_pk_bf16_f32 v69, v242, v248
v_lshlrev_b32 v242, 16, v70
v_and_b32 v248, 0xffff0000, v70
v_mul_f32 v242, v242, v238
v_mul_f32 v248, v248, v238
v_cvt_pk_bf16_f32 v70, v242, v248
v_lshlrev_b32 v242, 16, v71
v_and_b32 v248, 0xffff0000, v71
v_mul_f32 v242, v242, v238
v_mul_f32 v248, v248, v238
v_cvt_pk_bf16_f32 v71, v242, v248
v_lshlrev_b32 v242, 16, v72
v_and_b32 v248, 0xffff0000, v72
v_mul_f32 v242, v242, v238
v_mul_f32 v248, v248, v238
v_cvt_pk_bf16_f32 v72, v242, v248
v_lshlrev_b32 v242, 16, v73
v_and_b32 v248, 0xffff0000, v73
v_mul_f32 v242, v242, v238
v_mul_f32 v248, v248, v238
v_cvt_pk_bf16_f32 v73, v242, v248
v_lshlrev_b32 v242, 16, v74
v_and_b32 v248, 0xffff0000, v74
v_mul_f32 v242, v242, v238
v_mul_f32 v248, v248, v238
v_cvt_pk_bf16_f32 v74, v242, v248
v_lshlrev_b32 v242, 16, v75
v_and_b32 v248, 0xffff0000, v75
v_mul_f32 v242, v242, v238
v_mul_f32 v248, v248, v238
v_cvt_pk_bf16_f32 v75, v242, v248
v_lshlrev_b32 v242, 16, v184
v_and_b32 v248, 0xffff0000, v184
v_mul_f32 v242, v242, v238
v_mul_f32 v248, v248, v238
v_cvt_pk_bf16_f32 v184, v242, v248
v_lshlrev_b32 v242, 16, v185
v_and_b32 v248, 0xffff0000, v185
v_mul_f32 v242, v242, v238
v_mul_f32 v248, v248, v238
v_cvt_pk_bf16_f32 v185, v242, v248
v_lshlrev_b32 v242, 16, v186
v_and_b32 v248, 0xffff0000, v186
v_mul_f32 v242, v242, v238
v_mul_f32 v248, v248, v238
v_cvt_pk_bf16_f32 v186, v242, v248
v_lshlrev_b32 v242, 16, v187
v_and_b32 v248, 0xffff0000, v187
v_mul_f32 v242, v242, v238
v_mul_f32 v248, v248, v238
v_cvt_pk_bf16_f32 v187, v242, v248
v_lshlrev_b32 v242, 16, v168
v_and_b32 v248, 0xffff0000, v168
v_mul_f32 v242, v242, v238
v_mul_f32 v248, v248, v238
v_cvt_pk_bf16_f32 v168, v242, v248
v_lshlrev_b32 v242, 16, v169
v_and_b32 v248, 0xffff0000, v169
v_mul_f32 v242, v242, v238
v_mul_f32 v248, v248, v238
v_cvt_pk_bf16_f32 v169, v242, v248
v_lshlrev_b32 v242, 16, v170
v_and_b32 v248, 0xffff0000, v170
v_mul_f32 v242, v242, v238
v_mul_f32 v248, v248, v238
v_cvt_pk_bf16_f32 v170, v242, v248
v_lshlrev_b32 v242, 16, v171
v_and_b32 v248, 0xffff0000, v171
v_mul_f32 v242, v242, v238
v_mul_f32 v248, v248, v238
v_cvt_pk_bf16_f32 v171, v242, v248
v_lshlrev_b32 v242, 16, v64
v_and_b32 v248, 0xffff0000, v64
v_mul_f32 v242, v242, v238
v_mul_f32 v248, v248, v238
v_cvt_pk_bf16_f32 v64, v242, v248
v_lshlrev_b32 v242, 16, v65
v_and_b32 v248, 0xffff0000, v65
v_mul_f32 v242, v242, v238
v_mul_f32 v248, v248, v238
v_cvt_pk_bf16_f32 v65, v242, v248
v_exp_f32 v248, v156
s_nop 0
v_sub_f32 v227, v227, v248
v_exp_f32 v248, v157
s_nop 0
v_sub_f32 v227, v227, v248
v_exp_f32 v248, v158
s_nop 0
v_sub_f32 v227, v227, v248
v_exp_f32 v248, v159
s_nop 0
v_sub_f32 v227, v227, v248
v_max_f32 v227, 0, v227
v_min_f32 v227, s32, v227
v_log_f32 v248, v227
v_max3_f32 v235, v156, v157, v158
v_max3_f32 v235, v235, v159, v248
v_mov_b32 v248, v235
s_nop 1
v_permlane32_swap_b32 v235, v248
s_nop 1
v_max_f32 v235, v235, v248
v_mov_b32 v248, v235
s_nop 1
v_permlane16_swap_b32 v235, v248
s_nop 1
v_max_f32 v235, v235, v248
v_ceil_f32 v235, v235
v_max_f32 v235, 0, v235
v_sub_f32 v248, 0, v235
v_exp_f32 v239, v248
s_nop 1
v_mul_f32 v227, v227, v239
v_sub_f32 v204, v204, v235
v_sub_f32 v140, v140, v235
v_sub_f32 v156, v156, v235
v_sub_f32 v205, v205, v235
v_sub_f32 v141, v141, v235
v_sub_f32 v157, v157, v235
v_sub_f32 v206, v206, v235
v_sub_f32 v142, v142, v235
v_sub_f32 v158, v158, v235
v_sub_f32 v207, v207, v235
v_sub_f32 v143, v143, v235
v_sub_f32 v159, v159, v235
v_lshlrev_b32 v242, 16, v100
v_and_b32 v248, 0xffff0000, v100
v_mul_f32 v242, v242, v239
v_mul_f32 v248, v248, v239
v_cvt_pk_bf16_f32 v100, v242, v248
v_lshlrev_b32 v242, 16, v101
v_and_b32 v248, 0xffff0000, v101
v_mul_f32 v242, v242, v239
v_mul_f32 v248, v248, v239
v_cvt_pk_bf16_f32 v101, v242, v248
v_lshlrev_b32 v242, 16, v102
v_and_b32 v248, 0xffff0000, v102
v_mul_f32 v242, v242, v239
v_mul_f32 v248, v248, v239
v_cvt_pk_bf16_f32 v102, v242, v248
v_lshlrev_b32 v242, 16, v103
v_and_b32 v248, 0xffff0000, v103
v_mul_f32 v242, v242, v239
v_mul_f32 v248, v248, v239
v_cvt_pk_bf16_f32 v103, v242, v248
v_lshlrev_b32 v242, 16, v104
v_and_b32 v248, 0xffff0000, v104
v_mul_f32 v242, v242, v239
v_mul_f32 v248, v248, v239
v_cvt_pk_bf16_f32 v104, v242, v248
v_lshlrev_b32 v242, 16, v105
v_and_b32 v248, 0xffff0000, v105
v_mul_f32 v242, v242, v239
v_mul_f32 v248, v248, v239
v_cvt_pk_bf16_f32 v105, v242, v248
v_lshlrev_b32 v242, 16, v106
v_and_b32 v248, 0xffff0000, v106
v_mul_f32 v242, v242, v239
v_mul_f32 v248, v248, v239
v_cvt_pk_bf16_f32 v106, v242, v248
v_lshlrev_b32 v242, 16, v107
v_and_b32 v248, 0xffff0000, v107
v_mul_f32 v242, v242, v239
v_mul_f32 v248, v248, v239
v_cvt_pk_bf16_f32 v107, v242, v248
v_lshlrev_b32 v242, 16, v188
v_and_b32 v248, 0xffff0000, v188
v_mul_f32 v242, v242, v239
v_mul_f32 v248, v248, v239
v_cvt_pk_bf16_f32 v188, v242, v248
v_lshlrev_b32 v242, 16, v189
v_and_b32 v248, 0xffff0000, v189
v_mul_f32 v242, v242, v239
v_mul_f32 v248, v248, v239
v_cvt_pk_bf16_f32 v189, v242, v248
v_lshlrev_b32 v242, 16, v190
v_and_b32 v248, 0xffff0000, v190
v_mul_f32 v242, v242, v239
v_mul_f32 v248, v248, v239
v_cvt_pk_bf16_f32 v190, v242, v248
v_lshlrev_b32 v242, 16, v191
v_and_b32 v248, 0xffff0000, v191
v_mul_f32 v242, v242, v239
v_mul_f32 v248, v248, v239
v_cvt_pk_bf16_f32 v191, v242, v248
v_lshlrev_b32 v242, 16, v172
v_and_b32 v248, 0xffff0000, v172
v_mul_f32 v242, v242, v239
v_mul_f32 v248, v248, v239
v_cvt_pk_bf16_f32 v172, v242, v248
v_lshlrev_b32 v242, 16, v173
v_and_b32 v248, 0xffff0000, v173
v_mul_f32 v242, v242, v239
v_mul_f32 v248, v248, v239
v_cvt_pk_bf16_f32 v173, v242, v248
v_lshlrev_b32 v242, 16, v174
v_and_b32 v248, 0xffff0000, v174
v_mul_f32 v242, v242, v239
v_mul_f32 v248, v248, v239
v_cvt_pk_bf16_f32 v174, v242, v248
v_lshlrev_b32 v242, 16, v175
v_and_b32 v248, 0xffff0000, v175
v_mul_f32 v242, v242, v239
v_mul_f32 v248, v248, v239
v_cvt_pk_bf16_f32 v175, v242, v248
v_lshlrev_b32 v242, 16, v96
v_and_b32 v248, 0xffff0000, v96
v_mul_f32 v242, v242, v239
v_mul_f32 v248, v248, v239
v_cvt_pk_bf16_f32 v96, v242, v248
v_lshlrev_b32 v242, 16, v97
v_and_b32 v248, 0xffff0000, v97
v_mul_f32 v242, v242, v239
v_mul_f32 v248, v248, v239
v_cvt_pk_bf16_f32 v97, v242, v248
v_exp_f32 v232, v144
v_exp_f32 v233, v145
v_exp_f32 v234, v146
v_exp_f32 v235, v147
s_nop 1
v_add_f32 v224, v224, v232
v_add_f32 v224, v224, v233
v_add_f32 v224, v224, v234
v_add_f32 v224, v224, v235
v_cvt_pk_bf16_f32 v2, v232, v233
v_cvt_pk_bf16_f32 v3, v234, v235
v_exp_f32 v232, v148
v_exp_f32 v233, v149
v_exp_f32 v234, v150
v_exp_f32 v235, v151
s_nop 1
v_add_f32 v225, v225, v232
v_add_f32 v225, v225, v233
v_add_f32 v225, v225, v234
v_add_f32 v225, v225, v235
v_cvt_pk_bf16_f32 v34, v232, v233
v_cvt_pk_bf16_f32 v35, v234, v235
v_exp_f32 v232, v152
v_exp_f32 v233, v153
v_exp_f32 v234, v154
v_exp_f32 v235, v155
s_nop 1
v_add_f32 v226, v226, v232
v_add_f32 v226, v226, v233
v_add_f32 v226, v226, v234
v_add_f32 v226, v226, v235
v_cvt_pk_bf16_f32 v66, v232, v233
v_cvt_pk_bf16_f32 v67, v234, v235
v_exp_f32 v232, v156
v_exp_f32 v233, v157
v_exp_f32 v234, v158
v_exp_f32 v235, v159
s_nop 1
v_add_f32 v227, v227, v232
v_add_f32 v227, v227, v233
v_add_f32 v227, v227, v234
v_add_f32 v227, v227, v235
v_cvt_pk_bf16_f32 v98, v232, v233
v_cvt_pk_bf16_f32 v99, v234, v235
s_branch L2_rare_common
LF_hl_1:
s_mov_b32 s94, 0x10000
s_mov_b32 s3, 0x7c28000
LF_hl2_1:
v_lshlrev_b32 v241, 3, v243
buffer_load_dwordx2 v[240:241], v241, s[16:19], s3 offen sc1
s_sub_u32 s94, s94, 1
s_waitcnt vmcnt(0)
s_cbranch_scc1 LF_hlret_1
v_cmp_ne_u64_e64 s[38:39], s[98:99], v[240:241]
s_and_b64 s[38:39], s[38:39], s[96:97]
s_cbranch_scc1 LF_hl2_1
s_branch LF_hlret_1
L2_rare_site12:
s_mov_b32 s36, 12
s_branch L2_rare_t0_0_0
L2_rare_t0_0_0:
s_nop 15
s_nop 15
s_waitcnt lgkmcnt(0)
v_exp_f32 v248, v128
s_nop 0
v_sub_f32 v224, v224, v248
v_exp_f32 v248, v129
s_nop 0
v_sub_f32 v224, v224, v248
v_exp_f32 v248, v130
s_nop 0
v_sub_f32 v224, v224, v248
v_exp_f32 v248, v131
s_nop 0
v_sub_f32 v224, v224, v248
v_max_f32 v224, 0, v224
v_min_f32 v224, s32, v224
v_log_f32 v248, v224
v_max3_f32 v232, v128, v129, v130
v_max3_f32 v232, v232, v131, v248
v_mov_b32 v248, v232
s_nop 1
v_permlane32_swap_b32 v232, v248
s_nop 1
v_max_f32 v232, v232, v248
v_mov_b32 v248, v232
s_nop 1
v_permlane16_swap_b32 v232, v248
s_nop 1
v_max_f32 v232, v232, v248
v_ceil_f32 v232, v232
v_max_f32 v232, 0, v232
v_sub_f32 v248, 0, v232
v_exp_f32 v236, v248
s_nop 1
v_mul_f32 v224, v224, v236
v_sub_f32 v192, v192, v232
v_sub_f32 v128, v128, v232
v_sub_f32 v144, v144, v232
v_sub_f32 v193, v193, v232
v_sub_f32 v129, v129, v232
v_sub_f32 v145, v145, v232
v_sub_f32 v194, v194, v232
v_sub_f32 v130, v130, v232
v_sub_f32 v146, v146, v232
v_sub_f32 v195, v195, v232
v_sub_f32 v131, v131, v232
v_sub_f32 v147, v147, v232
v_lshlrev_b32 v242, 16, v176
v_and_b32 v248, 0xffff0000, v176
v_mul_f32 v242, v242, v236
v_mul_f32 v248, v248, v236
v_cvt_pk_bf16_f32 v176, v242, v248
v_lshlrev_b32 v242, 16, v177
v_and_b32 v248, 0xffff0000, v177
v_mul_f32 v242, v242, v236
v_mul_f32 v248, v248, v236
v_cvt_pk_bf16_f32 v177, v242, v248
v_lshlrev_b32 v242, 16, v178
v_and_b32 v248, 0xffff0000, v178
v_mul_f32 v242, v242, v236
v_mul_f32 v248, v248, v236
v_cvt_pk_bf16_f32 v178, v242, v248
v_lshlrev_b32 v242, 16, v179
v_and_b32 v248, 0xffff0000, v179
v_mul_f32 v242, v242, v236
v_mul_f32 v248, v248, v236
v_cvt_pk_bf16_f32 v179, v242, v248
ds_read_b64 v[250:251], v231 offset:0
s_waitcnt lgkmcnt(0)
v_lshlrev_b32 v242, 16, v250
v_and_b32 v248, 0xffff0000, v250
v_mul_f32 v242, v242, v236
v_mul_f32 v248, v248, v236
v_cvt_pk_bf16_f32 v250, v242, v248
v_lshlrev_b32 v242, 16, v251
v_and_b32 v248, 0xffff0000, v251
v_mul_f32 v242, v242, v236
v_mul_f32 v248, v248, v236
v_cvt_pk_bf16_f32 v251, v242, v248
ds_write_b64 v231, v[250:251] offset:0
s_waitcnt lgkmcnt(0)
ds_read_b64 v[250:251], v231 offset:8
s_waitcnt lgkmcnt(0)
v_lshlrev_b32 v242, 16, v250
v_and_b32 v248, 0xffff0000, v250
v_mul_f32 v242, v242, v236
v_mul_f32 v248, v248, v236
v_cvt_pk_bf16_f32 v250, v242, v248
v_lshlrev_b32 v242, 16, v251
v_and_b32 v248, 0xffff0000, v251
v_mul_f32 v242, v242, v236
v_mul_f32 v248, v248, v236
v_cvt_pk_bf16_f32 v251, v242, v248
ds_write_b64 v231, v[250:251] offset:8
s_waitcnt lgkmcnt(0)
v_exp_f32 v248, v132
s_nop 0
v_sub_f32 v225, v225, v248
v_exp_f32 v248, v133
s_nop 0
v_sub_f32 v225, v225, v248
v_exp_f32 v248, v134
s_nop 0
v_sub_f32 v225, v225, v248
v_exp_f32 v248, v135
s_nop 0
v_sub_f32 v225, v225, v248
v_max_f32 v225, 0, v225
v_min_f32 v225, s32, v225
v_log_f32 v248, v225
v_max3_f32 v233, v132, v133, v134
v_max3_f32 v233, v233, v135, v248
v_mov_b32 v248, v233
s_nop 1
v_permlane32_swap_b32 v233, v248
s_nop 1
v_max_f32 v233, v233, v248
v_mov_b32 v248, v233
s_nop 1
v_permlane16_swap_b32 v233, v248
s_nop 1
v_max_f32 v233, v233, v248
v_ceil_f32 v233, v233
v_max_f32 v233, 0, v233
v_sub_f32 v248, 0, v233
v_exp_f32 v237, v248
s_nop 1
v_mul_f32 v225, v225, v237
v_sub_f32 v196, v196, v233
v_sub_f32 v132, v132, v233
v_sub_f32 v148, v148, v233
v_sub_f32 v197, v197, v233
v_sub_f32 v133, v133, v233
v_sub_f32 v149, v149, v233
v_sub_f32 v198, v198, v233
v_sub_f32 v134, v134, v233
v_sub_f32 v150, v150, v233
v_sub_f32 v199, v199, v233
v_sub_f32 v135, v135, v233
v_sub_f32 v151, v151, v233
v_lshlrev_b32 v242, 16, v180
v_and_b32 v248, 0xffff0000, v180
v_mul_f32 v242, v242, v237
v_mul_f32 v248, v248, v237
v_cvt_pk_bf16_f32 v180, v242, v248
v_lshlrev_b32 v242, 16, v181
v_and_b32 v248, 0xffff0000, v181
v_mul_f32 v242, v242, v237
v_mul_f32 v248, v248, v237
v_cvt_pk_bf16_f32 v181, v242, v248
v_lshlrev_b32 v242, 16, v182
v_and_b32 v248, 0xffff0000, v182
v_mul_f32 v242, v242, v237
v_mul_f32 v248, v248, v237
v_cvt_pk_bf16_f32 v182, v242, v248
v_lshlrev_b32 v242, 16, v183
v_and_b32 v248, 0xffff0000, v183
v_mul_f32 v242, v242, v237
v_mul_f32 v248, v248, v237
v_cvt_pk_bf16_f32 v183, v242, v248
ds_read_b64 v[250:251], v231 offset:1024
s_waitcnt lgkmcnt(0)
v_lshlrev_b32 v242, 16, v250
v_and_b32 v248, 0xffff0000, v250
v_mul_f32 v242, v242, v237
v_mul_f32 v248, v248, v237
v_cvt_pk_bf16_f32 v250, v242, v248
v_lshlrev_b32 v242, 16, v251
v_and_b32 v248, 0xffff0000, v251
v_mul_f32 v242, v242, v237
v_mul_f32 v248, v248, v237
v_cvt_pk_bf16_f32 v251, v242, v248
ds_write_b64 v231, v[250:251] offset:1024
s_waitcnt lgkmcnt(0)
ds_read_b64 v[250:251], v231 offset:1032
s_waitcnt lgkmcnt(0)
v_lshlrev_b32 v242, 16, v250
v_and_b32 v248, 0xffff0000, v250
v_mul_f32 v242, v242, v237
v_mul_f32 v248, v248, v237
v_cvt_pk_bf16_f32 v250, v242, v248
v_lshlrev_b32 v242, 16, v251
v_and_b32 v248, 0xffff0000, v251
v_mul_f32 v242, v242, v237
v_mul_f32 v248, v248, v237
v_cvt_pk_bf16_f32 v251, v242, v248
ds_write_b64 v231, v[250:251] offset:1032
s_waitcnt lgkmcnt(0)
v_exp_f32 v248, v136
s_nop 0
v_sub_f32 v226, v226, v248
v_exp_f32 v248, v137
s_nop 0
v_sub_f32 v226, v226, v248
v_exp_f32 v248, v138
s_nop 0
v_sub_f32 v226, v226, v248
v_exp_f32 v248, v139
s_nop 0
v_sub_f32 v226, v226, v248
v_max_f32 v226, 0, v226
v_min_f32 v226, s32, v226
v_log_f32 v248, v226
v_max3_f32 v234, v136, v137, v138
v_max3_f32 v234, v234, v139, v248
v_mov_b32 v248, v234
s_nop 1
v_permlane32_swap_b32 v234, v248
s_nop 1
v_max_f32 v234, v234, v248
v_mov_b32 v248, v234
s_nop 1
v_permlane16_swap_b32 v234, v248
s_nop 1
v_max_f32 v234, v234, v248
v_ceil_f32 v234, v234
v_max_f32 v234, 0, v234
v_sub_f32 v248, 0, v234
v_exp_f32 v238, v248
s_nop 1
v_mul_f32 v226, v226, v238
v_sub_f32 v200, v200, v234
v_sub_f32 v136, v136, v234
v_sub_f32 v152, v152, v234
v_sub_f32 v201, v201, v234
v_sub_f32 v137, v137, v234
v_sub_f32 v153, v153, v234
v_sub_f32 v202, v202, v234
v_sub_f32 v138, v138, v234
v_sub_f32 v154, v154, v234
v_sub_f32 v203, v203, v234
v_sub_f32 v139, v139, v234
v_sub_f32 v155, v155, v234
v_lshlrev_b32 v242, 16, v184
v_and_b32 v248, 0xffff0000, v184
v_mul_f32 v242, v242, v238
v_mul_f32 v248, v248, v238
v_cvt_pk_bf16_f32 v184, v242, v248
v_lshlrev_b32 v242, 16, v185
v_and_b32 v248, 0xffff0000, v185
v_mul_f32 v242, v242, v238
v_mul_f32 v248, v248, v238
v_cvt_pk_bf16_f32 v185, v242, v248
v_lshlrev_b32 v242, 16, v186
v_and_b32 v248, 0xffff0000, v186
v_mul_f32 v242, v242, v238
v_mul_f32 v248, v248, v238
v_cvt_pk_bf16_f32 v186, v242, v248
v_lshlrev_b32 v242, 16, v187
v_and_b32 v248, 0xffff0000, v187
v_mul_f32 v242, v242, v238
v_mul_f32 v248, v248, v238
v_cvt_pk_bf16_f32 v187, v242, v248
ds_read_b64 v[250:251], v231 offset:2048
s_waitcnt lgkmcnt(0)
v_lshlrev_b32 v242, 16, v250
v_and_b32 v248, 0xffff0000, v250
v_mul_f32 v242, v242, v238
v_mul_f32 v248, v248, v238
v_cvt_pk_bf16_f32 v250, v242, v248
v_lshlrev_b32 v242, 16, v251
v_and_b32 v248, 0xffff0000, v251
v_mul_f32 v242, v242, v238
v_mul_f32 v248, v248, v238
v_cvt_pk_bf16_f32 v251, v242, v248
ds_write_b64 v231, v[250:251] offset:2048
s_waitcnt lgkmcnt(0)
ds_read_b64 v[250:251], v231 offset:2056
s_waitcnt lgkmcnt(0)
v_lshlrev_b32 v242, 16, v250
v_and_b32 v248, 0xffff0000, v250
v_mul_f32 v242, v242, v238
v_mul_f32 v248, v248, v238
v_cvt_pk_bf16_f32 v250, v242, v248
v_lshlrev_b32 v242, 16, v251
v_and_b32 v248, 0xffff0000, v251
v_mul_f32 v242, v242, v238
v_mul_f32 v248, v248, v238
v_cvt_pk_bf16_f32 v251, v242, v248
ds_write_b64 v231, v[250:251] offset:2056
s_waitcnt lgkmcnt(0)
v_exp_f32 v248, v140
s_nop 0
v_sub_f32 v227, v227, v248
v_exp_f32 v248, v141
s_nop 0
v_sub_f32 v227, v227, v248
v_exp_f32 v248, v142
s_nop 0
v_sub_f32 v227, v227, v248
v_exp_f32 v248, v143
s_nop 0
v_sub_f32 v227, v227, v248
v_max_f32 v227, 0, v227
v_min_f32 v227, s32, v227
v_log_f32 v248, v227
v_max3_f32 v235, v140, v141, v142
v_max3_f32 v235, v235, v143, v248
v_mov_b32 v248, v235
s_nop 1
v_permlane32_swap_b32 v235, v248
s_nop 1
v_max_f32 v235, v235, v248
v_mov_b32 v248, v235
s_nop 1
v_permlane16_swap_b32 v235, v248
s_nop 1
v_max_f32 v235, v235, v248
v_ceil_f32 v235, v235
v_max_f32 v235, 0, v235
v_sub_f32 v248, 0, v235
v_exp_f32 v239, v248
s_nop 1
v_mul_f32 v227, v227, v239
v_sub_f32 v204, v204, v235
v_sub_f32 v140, v140, v235
v_sub_f32 v156, v156, v235
v_sub_f32 v205, v205, v235
v_sub_f32 v141, v141, v235
v_sub_f32 v157, v157, v235
v_sub_f32 v206, v206, v235
v_sub_f32 v142, v142, v235
v_sub_f32 v158, v158, v235
v_sub_f32 v207, v207, v235
v_sub_f32 v143, v143, v235
v_sub_f32 v159, v159, v235
v_lshlrev_b32 v242, 16, v188
v_and_b32 v248, 0xffff0000, v188
v_mul_f32 v242, v242, v239
v_mul_f32 v248, v248, v239
v_cvt_pk_bf16_f32 v188, v242, v248
v_lshlrev_b32 v242, 16, v189
v_and_b32 v248, 0xffff0000, v189
v_mul_f32 v242, v242, v239
v_mul_f32 v248, v248, v239
v_cvt_pk_bf16_f32 v189, v242, v248
v_lshlrev_b32 v242, 16, v190
v_and_b32 v248, 0xffff0000, v190
v_mul_f32 v242, v242, v239
v_mul_f32 v248, v248, v239
v_cvt_pk_bf16_f32 v190, v242, v248
v_lshlrev_b32 v242, 16, v191
v_and_b32 v248, 0xffff0000, v191
v_mul_f32 v242, v242, v239
v_mul_f32 v248, v248, v239
v_cvt_pk_bf16_f32 v191, v242, v248
ds_read_b64 v[250:251], v231 offset:3072
s_waitcnt lgkmcnt(0)
v_lshlrev_b32 v242, 16, v250
v_and_b32 v248, 0xffff0000, v250
v_mul_f32 v242, v242, v239
v_mul_f32 v248, v248, v239
v_cvt_pk_bf16_f32 v250, v242, v248
v_lshlrev_b32 v242, 16, v251
v_and_b32 v248, 0xffff0000, v251
v_mul_f32 v242, v242, v239
v_mul_f32 v248, v248, v239
v_cvt_pk_bf16_f32 v251, v242, v248
ds_write_b64 v231, v[250:251] offset:3072
s_waitcnt lgkmcnt(0)
ds_read_b64 v[250:251], v231 offset:3080
s_waitcnt lgkmcnt(0)
v_lshlrev_b32 v242, 16, v250
v_and_b32 v248, 0xffff0000, v250
v_mul_f32 v242, v242, v239
v_mul_f32 v248, v248, v239
v_cvt_pk_bf16_f32 v250, v242, v248
v_lshlrev_b32 v242, 16, v251
v_and_b32 v248, 0xffff0000, v251
v_mul_f32 v242, v242, v239
v_mul_f32 v248, v248, v239
v_cvt_pk_bf16_f32 v251, v242, v248
ds_write_b64 v231, v[250:251] offset:3080
s_waitcnt lgkmcnt(0)
v_exp_f32 v232, v128
v_exp_f32 v233, v129
v_exp_f32 v234, v130
v_exp_f32 v235, v131
s_nop 1
v_add_f32 v224, v224, v232
v_add_f32 v224, v224, v233
v_add_f32 v224, v224, v234
v_add_f32 v224, v224, v235
v_cvt_pk_bf16_f32 v160, v232, v233
v_cvt_pk_bf16_f32 v161, v234, v235
v_exp_f32 v232, v132
v_exp_f32 v233, v133
v_exp_f32 v234, v134
v_exp_f32 v235, v135
s_nop 1
v_add_f32 v225, v225, v232
v_add_f32 v225, v225, v233
v_add_f32 v225, v225, v234
v_add_f32 v225, v225, v235
v_cvt_pk_bf16_f32 v164, v232, v233
v_cvt_pk_bf16_f32 v165, v234, v235
v_exp_f32 v232, v136
v_exp_f32 v233, v137
v_exp_f32 v234, v138
v_exp_f32 v235, v139
s_nop 1
v_add_f32 v226, v226, v232
v_add_f32 v226, v226, v233
v_add_f32 v226, v226, v234
v_add_f32 v226, v226, v235
v_cvt_pk_bf16_f32 v168, v232, v233
v_cvt_pk_bf16_f32 v169, v234, v235
v_exp_f32 v232, v140
v_exp_f32 v233, v141
v_exp_f32 v234, v142
v_exp_f32 v235, v143
s_nop 1
v_add_f32 v227, v227, v232
v_add_f32 v227, v227, v233
v_add_f32 v227, v227, v234
v_add_f32 v227, v227, v235
v_cvt_pk_bf16_f32 v172, v232, v233
v_cvt_pk_bf16_f32 v173, v234, v235
s_branch L2_rare_common
L2_rare_site13:
s_mov_b32 s36, 13
s_branch L2_rare_t0_1_1
L2_rare_t0_1_1:
s_nop 15
s_nop 15
s_waitcnt lgkmcnt(0)
v_exp_f32 v248, v144
s_nop 0
v_sub_f32 v224, v224, v248
v_exp_f32 v248, v145
s_nop 0
v_sub_f32 v224, v224, v248
v_exp_f32 v248, v146
s_nop 0
v_sub_f32 v224, v224, v248
v_exp_f32 v248, v147
s_nop 0
v_sub_f32 v224, v224, v248
v_max_f32 v224, 0, v224
v_min_f32 v224, s32, v224
v_log_f32 v248, v224
v_max3_f32 v232, v144, v145, v146
v_max3_f32 v232, v232, v147, v248
v_mov_b32 v248, v232
s_nop 1
v_permlane32_swap_b32 v232, v248
s_nop 1
v_max_f32 v232, v232, v248
v_mov_b32 v248, v232
s_nop 1
v_permlane16_swap_b32 v232, v248
s_nop 1
v_max_f32 v232, v232, v248
v_ceil_f32 v232, v232
v_max_f32 v232, 0, v232
v_sub_f32 v248, 0, v232
v_exp_f32 v236, v248
s_nop 1
v_mul_f32 v224, v224, v236
v_sub_f32 v192, v192, v232
v_sub_f32 v128, v128, v232
v_sub_f32 v144, v144, v232
v_sub_f32 v193, v193, v232
v_sub_f32 v129, v129, v232
v_sub_f32 v145, v145, v232
v_sub_f32 v194, v194, v232
v_sub_f32 v130, v130, v232
v_sub_f32 v146, v146, v232
v_sub_f32 v195, v195, v232
v_sub_f32 v131, v131, v232
v_sub_f32 v147, v147, v232
v_lshlrev_b32 v242, 16, v160
v_and_b32 v248, 0xffff0000, v160
v_mul_f32 v242, v242, v236
v_mul_f32 v248, v248, v236
v_cvt_pk_bf16_f32 v160, v242, v248
v_lshlrev_b32 v242, 16, v161
v_and_b32 v248, 0xffff0000, v161
v_mul_f32 v242, v242, v236
v_mul_f32 v248, v248, v236
v_cvt_pk_bf16_f32 v161, v242, v248
ds_read_b64 v[250:251], v231 offset:0
s_waitcnt lgkmcnt(0)
v_lshlrev_b32 v242, 16, v250
v_and_b32 v248, 0xffff0000, v250
v_mul_f32 v242, v242, v236
v_mul_f32 v248, v248, v236
v_cvt_pk_bf16_f32 v250, v242, v248
v_lshlrev_b32 v242, 16, v251
v_and_b32 v248, 0xffff0000, v251
v_mul_f32 v242, v242, v236
v_mul_f32 v248, v248, v236
v_cvt_pk_bf16_f32 v251, v242, v248
ds_write_b64 v231, v[250:251] offset:0
s_waitcnt lgkmcnt(0)
ds_read_b64 v[250:251], v231 offset:8
s_waitcnt lgkmcnt(0)
v_lshlrev_b32 v242, 16, v250
v_and_b32 v248, 0xffff0000, v250
v_mul_f32 v242, v242, v236
v_mul_f32 v248, v248, v236
v_cvt_pk_bf16_f32 v250, v242, v248
v_lshlrev_b32 v242, 16, v251
v_and_b32 v248, 0xffff0000, v251
v_mul_f32 v242, v242, v236
v_mul_f32 v248, v248, v236
v_cvt_pk_bf16_f32 v251, v242, v248
ds_write_b64 v231, v[250:251] offset:8
s_waitcnt lgkmcnt(0)
ds_read_b64 v[250:251], v231 offset:4096
s_waitcnt lgkmcnt(0)
v_lshlrev_b32 v242, 16, v250
v_and_b32 v248, 0xffff0000, v250
v_mul_f32 v242, v242, v236
v_mul_f32 v248, v248, v236
v_cvt_pk_bf16_f32 v250, v242, v248
v_lshlrev_b32 v242, 16, v251
v_and_b32 v248, 0xffff0000, v251
v_mul_f32 v242, v242, v236
v_mul_f32 v248, v248, v236
v_cvt_pk_bf16_f32 v251, v242, v248
ds_write_b64 v231, v[250:251] offset:4096
s_waitcnt lgkmcnt(0)
ds_read_b64 v[250:251], v231 offset:4104
s_waitcnt lgkmcnt(0)
v_lshlrev_b32 v242, 16, v250
v_and_b32 v248, 0xffff0000, v250
v_mul_f32 v242, v242, v236
v_mul_f32 v248, v248, v236
v_cvt_pk_bf16_f32 v250, v242, v248
v_lshlrev_b32 v242, 16, v251
v_and_b32 v248, 0xffff0000, v251
v_mul_f32 v242, v242, v236
v_mul_f32 v248, v248, v236
v_cvt_pk_bf16_f32 v251, v242, v248
ds_write_b64 v231, v[250:251] offset:4104
s_waitcnt lgkmcnt(0)
v_exp_f32 v248, v148
s_nop 0
v_sub_f32 v225, v225, v248
v_exp_f32 v248, v149
s_nop 0
v_sub_f32 v225, v225, v248
v_exp_f32 v248, v150
s_nop 0
v_sub_f32 v225, v225, v248
v_exp_f32 v248, v151
s_nop 0
v_sub_f32 v225, v225, v248
v_max_f32 v225, 0, v225
v_min_f32 v225, s32, v225
v_log_f32 v248, v225
v_max3_f32 v233, v148, v149, v150
v_max3_f32 v233, v233, v151, v248
v_mov_b32 v248, v233
s_nop 1
v_permlane32_swap_b32 v233, v248
s_nop 1
v_max_f32 v233, v233, v248
v_mov_b32 v248, v233
s_nop 1
v_permlane16_swap_b32 v233, v248
s_nop 1
v_max_f32 v233, v233, v248
v_ceil_f32 v233, v233
v_max_f32 v233, 0, v233
v_sub_f32 v248, 0, v233
v_exp_f32 v237, v248
s_nop 1
v_mul_f32 v225, v225, v237
v_sub_f32 v196, v196, v233
v_sub_f32 v132, v132, v233
v_sub_f32 v148, v148, v233
v_sub_f32 v197, v197, v233
v_sub_f32 v133, v133, v233
v_sub_f32 v149, v149, v233
v_sub_f32 v198, v198, v233
v_sub_f32 v134, v134, v233
v_sub_f32 v150, v150, v233
v_sub_f32 v199, v199, v233
v_sub_f32 v135, v135, v233
v_sub_f32 v151, v151, v233
v_lshlrev_b32 v242, 16, v164
v_and_b32 v248, 0xffff0000, v164
v_mul_f32 v242, v242, v237
v_mul_f32 v248, v248, v237
v_cvt_pk_bf16_f32 v164, v242, v248
v_lshlrev_b32 v242, 16, v165
v_and_b32 v248, 0xffff0000, v165
v_mul_f32 v242, v242, v237
v_mul_f32 v248, v248, v237
v_cvt_pk_bf16_f32 v165, v242, v248
ds_read_b64 v[250:251], v231 offset:1024
s_waitcnt lgkmcnt(0)
v_lshlrev_b32 v242, 16, v250
v_and_b32 v248, 0xffff0000, v250
v_mul_f32 v242, v242, v237
v_mul_f32 v248, v248, v237
v_cvt_pk_bf16_f32 v250, v242, v248
v_lshlrev_b32 v242, 16, v251
v_and_b32 v248, 0xffff0000, v251
v_mul_f32 v242, v242, v237
v_mul_f32 v248, v248, v237
v_cvt_pk_bf16_f32 v251, v242, v248
ds_write_b64 v231, v[250:251] offset:1024
s_waitcnt lgkmcnt(0)
ds_read_b64 v[250:251], v231 offset:1032
s_waitcnt lgkmcnt(0)
v_lshlrev_b32 v242, 16, v250
v_and_b32 v248, 0xffff0000, v250
v_mul_f32 v242, v242, v237
v_mul_f32 v248, v248, v237
v_cvt_pk_bf16_f32 v250, v242, v248
v_lshlrev_b32 v242, 16, v251
v_and_b32 v248, 0xffff0000, v251
v_mul_f32 v242, v242, v237
v_mul_f32 v248, v248, v237
v_cvt_pk_bf16_f32 v251, v242, v248
ds_write_b64 v231, v[250:251] offset:1032
s_waitcnt lgkmcnt(0)
ds_read_b64 v[250:251], v231 offset:5120
s_waitcnt lgkmcnt(0)
v_lshlrev_b32 v242, 16, v250
v_and_b32 v248, 0xffff0000, v250
v_mul_f32 v242, v242, v237
v_mul_f32 v248, v248, v237
v_cvt_pk_bf16_f32 v250, v242, v248
v_lshlrev_b32 v242, 16, v251
v_and_b32 v248, 0xffff0000, v251
v_mul_f32 v242, v242, v237
v_mul_f32 v248, v248, v237
v_cvt_pk_bf16_f32 v251, v242, v248
ds_write_b64 v231, v[250:251] offset:5120
s_waitcnt lgkmcnt(0)
ds_read_b64 v[250:251], v231 offset:5128
s_waitcnt lgkmcnt(0)
v_lshlrev_b32 v242, 16, v250
v_and_b32 v248, 0xffff0000, v250
v_mul_f32 v242, v242, v237
v_mul_f32 v248, v248, v237
v_cvt_pk_bf16_f32 v250, v242, v248
v_lshlrev_b32 v242, 16, v251
v_and_b32 v248, 0xffff0000, v251
v_mul_f32 v242, v242, v237
v_mul_f32 v248, v248, v237
v_cvt_pk_bf16_f32 v251, v242, v248
ds_write_b64 v231, v[250:251] offset:5128
s_waitcnt lgkmcnt(0)
v_exp_f32 v248, v152
s_nop 0
v_sub_f32 v226, v226, v248
v_exp_f32 v248, v153
s_nop 0
v_sub_f32 v226, v226, v248
v_exp_f32 v248, v154
s_nop 0
v_sub_f32 v226, v226, v248
v_exp_f32 v248, v155
s_nop 0
v_sub_f32 v226, v226, v248
v_max_f32 v226, 0, v226
v_min_f32 v226, s32, v226
v_log_f32 v248, v226
v_max3_f32 v234, v152, v153, v154
v_max3_f32 v234, v234, v155, v248
v_mov_b32 v248, v234
s_nop 1
v_permlane32_swap_b32 v234, v248
s_nop 1
v_max_f32 v234, v234, v248
v_mov_b32 v248, v234
s_nop 1
v_permlane16_swap_b32 v234, v248
s_nop 1
v_max_f32 v234, v234, v248
v_ceil_f32 v234, v234
v_max_f32 v234, 0, v234
v_sub_f32 v248, 0, v234
v_exp_f32 v238, v248
s_nop 1
v_mul_f32 v226, v226, v238
v_sub_f32 v200, v200, v234
v_sub_f32 v136, v136, v234
v_sub_f32 v152, v152, v234
v_sub_f32 v201, v201, v234
v_sub_f32 v137, v137, v234
v_sub_f32 v153, v153, v234
v_sub_f32 v202, v202, v234
v_sub_f32 v138, v138, v234
v_sub_f32 v154, v154, v234
v_sub_f32 v203, v203, v234
v_sub_f32 v139, v139, v234
v_sub_f32 v155, v155, v234
v_lshlrev_b32 v242, 16, v168
v_and_b32 v248, 0xffff0000, v168
v_mul_f32 v242, v242, v238
v_mul_f32 v248, v248, v238
v_cvt_pk_bf16_f32 v168, v242, v248
v_lshlrev_b32 v242, 16, v169
v_and_b32 v248, 0xffff0000, v169
v_mul_f32 v242, v242, v238
v_mul_f32 v248, v248, v238
v_cvt_pk_bf16_f32 v169, v242, v248
ds_read_b64 v[250:251], v231 offset:2048
s_waitcnt lgkmcnt(0)
v_lshlrev_b32 v242, 16, v250
v_and_b32 v248, 0xffff0000, v250
v_mul_f32 v242, v242, v238
v_mul_f32 v248, v248, v238
v_cvt_pk_bf16_f32 v250, v242, v248
v_lshlrev_b32 v242, 16, v251
v_and_b32 v248, 0xffff0000, v251
v_mul_f32 v242, v242, v238
v_mul_f32 v248, v248, v238
v_cvt_pk_bf16_f32 v251, v242, v248
ds_write_b64 v231, v[250:251] offset:2048
s_waitcnt lgkmcnt(0)
ds_read_b64 v[250:251], v231 offset:2056
s_waitcnt lgkmcnt(0)
v_lshlrev_b32 v242, 16, v250
v_and_b32 v248, 0xffff0000, v250
v_mul_f32 v242, v242, v238
v_mul_f32 v248, v248, v238
v_cvt_pk_bf16_f32 v250, v242, v248
v_lshlrev_b32 v242, 16, v251
v_and_b32 v248, 0xffff0000, v251
v_mul_f32 v242, v242, v238
v_mul_f32 v248, v248, v238
v_cvt_pk_bf16_f32 v251, v242, v248
ds_write_b64 v231, v[250:251] offset:2056
s_waitcnt lgkmcnt(0)
ds_read_b64 v[250:251], v231 offset:6144
s_waitcnt lgkmcnt(0)
v_lshlrev_b32 v242, 16, v250
v_and_b32 v248, 0xffff0000, v250
v_mul_f32 v242, v242, v238
v_mul_f32 v248, v248, v238
v_cvt_pk_bf16_f32 v250, v242, v248
v_lshlrev_b32 v242, 16, v251
v_and_b32 v248, 0xffff0000, v251
v_mul_f32 v242, v242, v238
v_mul_f32 v248, v248, v238
v_cvt_pk_bf16_f32 v251, v242, v248
ds_write_b64 v231, v[250:251] offset:6144
s_waitcnt lgkmcnt(0)
ds_read_b64 v[250:251], v231 offset:6152
s_waitcnt lgkmcnt(0)
v_lshlrev_b32 v242, 16, v250
v_and_b32 v248, 0xffff0000, v250
v_mul_f32 v242, v242, v238
v_mul_f32 v248, v248, v238
v_cvt_pk_bf16_f32 v250, v242, v248
v_lshlrev_b32 v242, 16, v251
v_and_b32 v248, 0xffff0000, v251
v_mul_f32 v242, v242, v238
v_mul_f32 v248, v248, v238
v_cvt_pk_bf16_f32 v251, v242, v248
ds_write_b64 v231, v[250:251] offset:6152
s_waitcnt lgkmcnt(0)
v_exp_f32 v248, v156
s_nop 0
v_sub_f32 v227, v227, v248
v_exp_f32 v248, v157
s_nop 0
v_sub_f32 v227, v227, v248
v_exp_f32 v248, v158
s_nop 0
v_sub_f32 v227, v227, v248
v_exp_f32 v248, v159
s_nop 0
v_sub_f32 v227, v227, v248
v_max_f32 v227, 0, v227
v_min_f32 v227, s32, v227
v_log_f32 v248, v227
v_max3_f32 v235, v156, v157, v158
v_max3_f32 v235, v235, v159, v248
v_mov_b32 v248, v235
s_nop 1
v_permlane32_swap_b32 v235, v248
s_nop 1
v_max_f32 v235, v235, v248
v_mov_b32 v248, v235
s_nop 1
v_permlane16_swap_b32 v235, v248
s_nop 1
v_max_f32 v235, v235, v248
v_ceil_f32 v235, v235
v_max_f32 v235, 0, v235
v_sub_f32 v248, 0, v235
v_exp_f32 v239, v248
s_nop 1
v_mul_f32 v227, v227, v239
v_sub_f32 v204, v204, v235
v_sub_f32 v140, v140, v235
v_sub_f32 v156, v156, v235
v_sub_f32 v205, v205, v235
v_sub_f32 v141, v141, v235
v_sub_f32 v157, v157, v235
v_sub_f32 v206, v206, v235
v_sub_f32 v142, v142, v235
v_sub_f32 v158, v158, v235
v_sub_f32 v207, v207, v235
v_sub_f32 v143, v143, v235
v_sub_f32 v159, v159, v235
v_lshlrev_b32 v242, 16, v172
v_and_b32 v248, 0xffff0000, v172
v_mul_f32 v242, v242, v239
v_mul_f32 v248, v248, v239
v_cvt_pk_bf16_f32 v172, v242, v248
v_lshlrev_b32 v242, 16, v173
v_and_b32 v248, 0xffff0000, v173
v_mul_f32 v242, v242, v239
v_mul_f32 v248, v248, v239
v_cvt_pk_bf16_f32 v173, v242, v248
ds_read_b64 v[250:251], v231 offset:3072
s_waitcnt lgkmcnt(0)
v_lshlrev_b32 v242, 16, v250
v_and_b32 v248, 0xffff0000, v250
v_mul_f32 v242, v242, v239
v_mul_f32 v248, v248, v239
v_cvt_pk_bf16_f32 v250, v242, v248
v_lshlrev_b32 v242, 16, v251
v_and_b32 v248, 0xffff0000, v251
v_mul_f32 v242, v242, v239
v_mul_f32 v248, v248, v239
v_cvt_pk_bf16_f32 v251, v242, v248
ds_write_b64 v231, v[250:251] offset:3072
s_waitcnt lgkmcnt(0)
ds_read_b64 v[250:251], v231 offset:3080
s_waitcnt lgkmcnt(0)
v_lshlrev_b32 v242, 16, v250
v_and_b32 v248, 0xffff0000, v250
v_mul_f32 v242, v242, v239
v_mul_f32 v248, v248, v239
v_cvt_pk_bf16_f32 v250, v242, v248
v_lshlrev_b32 v242, 16, v251
v_and_b32 v248, 0xffff0000, v251
v_mul_f32 v242, v242, v239
v_mul_f32 v248, v248, v239
v_cvt_pk_bf16_f32 v251, v242, v248
ds_write_b64 v231, v[250:251] offset:3080
s_waitcnt lgkmcnt(0)
ds_read_b64 v[250:251], v231 offset:7168
s_waitcnt lgkmcnt(0)
v_lshlrev_b32 v242, 16, v250
v_and_b32 v248, 0xffff0000, v250
v_mul_f32 v242, v242, v239
v_mul_f32 v248, v248, v239
v_cvt_pk_bf16_f32 v250, v242, v248
v_lshlrev_b32 v242, 16, v251
v_and_b32 v248, 0xffff0000, v251
v_mul_f32 v242, v242, v239
v_mul_f32 v248, v248, v239
v_cvt_pk_bf16_f32 v251, v242, v248
ds_write_b64 v231, v[250:251] offset:7168
s_waitcnt lgkmcnt(0)
ds_read_b64 v[250:251], v231 offset:7176
s_waitcnt lgkmcnt(0)
v_lshlrev_b32 v242, 16, v250
v_and_b32 v248, 0xffff0000, v250
v_mul_f32 v242, v242, v239
v_mul_f32 v248, v248, v239
v_cvt_pk_bf16_f32 v250, v242, v248
v_lshlrev_b32 v242, 16, v251
v_and_b32 v248, 0xffff0000, v251
v_mul_f32 v242, v242, v239
v_mul_f32 v248, v248, v239
v_cvt_pk_bf16_f32 v251, v242, v248
ds_write_b64 v231, v[250:251] offset:7176
s_waitcnt lgkmcnt(0)
v_exp_f32 v232, v144
v_exp_f32 v233, v145
v_exp_f32 v234, v146
v_exp_f32 v235, v147
s_nop 1
v_add_f32 v224, v224, v232
v_add_f32 v224, v224, v233
v_add_f32 v224, v224, v234
v_add_f32 v224, v224, v235
v_cvt_pk_bf16_f32 v162, v232, v233
v_cvt_pk_bf16_f32 v163, v234, v235
v_exp_f32 v232, v148
v_exp_f32 v233, v149
v_exp_f32 v234, v150
v_exp_f32 v235, v151
s_nop 1
v_add_f32 v225, v225, v232
v_add_f32 v225, v225, v233
v_add_f32 v225, v225, v234
v_add_f32 v225, v225, v235
v_cvt_pk_bf16_f32 v166, v232, v233
v_cvt_pk_bf16_f32 v167, v234, v235
v_exp_f32 v232, v152
v_exp_f32 v233, v153
v_exp_f32 v234, v154
v_exp_f32 v235, v155
s_nop 1
v_add_f32 v226, v226, v232
v_add_f32 v226, v226, v233
v_add_f32 v226, v226, v234
v_add_f32 v226, v226, v235
v_cvt_pk_bf16_f32 v170, v232, v233
v_cvt_pk_bf16_f32 v171, v234, v235
v_exp_f32 v232, v156
v_exp_f32 v233, v157
v_exp_f32 v234, v158
v_exp_f32 v235, v159
s_nop 1
v_add_f32 v227, v227, v232
v_add_f32 v227, v227, v233
v_add_f32 v227, v227, v234
v_add_f32 v227, v227, v235
v_cvt_pk_bf16_f32 v174, v232, v233
v_cvt_pk_bf16_f32 v175, v234, v235
s_branch L2_rare_common
L2_rare_site14:
s_mov_b32 s36, 14
s_branch L2_rare_t0_2_0
L2_rare_t0_2_0:
s_nop 15
s_nop 15
s_waitcnt lgkmcnt(0)
v_exp_f32 v248, v128
s_nop 0
v_sub_f32 v224, v224, v248
v_exp_f32 v248, v129
s_nop 0
v_sub_f32 v224, v224, v248
v_exp_f32 v248, v130
s_nop 0
v_sub_f32 v224, v224, v248
v_exp_f32 v248, v131
s_nop 0
v_sub_f32 v224, v224, v248
v_max_f32 v224, 0, v224
v_min_f32 v224, s32, v224
v_log_f32 v248, v224
v_max3_f32 v232, v128, v129, v130
v_max3_f32 v232, v232, v131, v248
v_mov_b32 v248, v232
s_nop 1
v_permlane32_swap_b32 v232, v248
s_nop 1
v_max_f32 v232, v232, v248
v_mov_b32 v248, v232
s_nop 1
v_permlane16_swap_b32 v232, v248
s_nop 1
v_max_f32 v232, v232, v248
v_ceil_f32 v232, v232
v_max_f32 v232, 0, v232
v_sub_f32 v248, 0, v232
v_exp_f32 v236, v248
s_nop 1
v_mul_f32 v224, v224, v236
v_sub_f32 v192, v192, v232
v_sub_f32 v128, v128, v232
v_sub_f32 v144, v144, v232
v_sub_f32 v193, v193, v232
v_sub_f32 v129, v129, v232
v_sub_f32 v145, v145, v232
v_sub_f32 v194, v194, v232
v_sub_f32 v130, v130, v232
v_sub_f32 v146, v146, v232
v_sub_f32 v195, v195, v232
v_sub_f32 v131, v131, v232
v_sub_f32 v147, v147, v232
v_lshlrev_b32 v242, 16, v160
v_and_b32 v248, 0xffff0000, v160
v_mul_f32 v242, v242, v236
v_mul_f32 v248, v248, v236
v_cvt_pk_bf16_f32 v160, v242, v248
v_lshlrev_b32 v242, 16, v161
v_and_b32 v248, 0xffff0000, v161
v_mul_f32 v242, v242, v236
v_mul_f32 v248, v248, v236
v_cvt_pk_bf16_f32 v161, v242, v248
v_lshlrev_b32 v242, 16, v162
v_and_b32 v248, 0xffff0000, v162
v_mul_f32 v242, v242, v236
v_mul_f32 v248, v248, v236
v_cvt_pk_bf16_f32 v162, v242, v248
v_lshlrev_b32 v242, 16, v163
v_and_b32 v248, 0xffff0000, v163
v_mul_f32 v242, v242, v236
v_mul_f32 v248, v248, v236
v_cvt_pk_bf16_f32 v163, v242, v248
ds_read_b64 v[250:251], v231 offset:0
s_waitcnt lgkmcnt(0)
v_lshlrev_b32 v242, 16, v250
v_and_b32 v248, 0xffff0000, v250
v_mul_f32 v242, v242, v236
v_mul_f32 v248, v248, v236
v_cvt_pk_bf16_f32 v250, v242, v248
v_lshlrev_b32 v242, 16, v251
v_and_b32 v248, 0xffff0000, v251
v_mul_f32 v242, v242, v236
v_mul_f32 v248, v248, v236
v_cvt_pk_bf16_f32 v251, v242, v248
ds_write_b64 v231, v[250:251] offset:0
s_waitcnt lgkmcnt(0)
ds_read_b64 v[250:251], v231 offset:8
s_waitcnt lgkmcnt(0)
v_lshlrev_b32 v242, 16, v250
v_and_b32 v248, 0xffff0000, v250
v_mul_f32 v242, v242, v236
v_mul_f32 v248, v248, v236
v_cvt_pk_bf16_f32 v250, v242, v248
v_lshlrev_b32 v242, 16, v251
v_and_b32 v248, 0xffff0000, v251
v_mul_f32 v242, v242, v236
v_mul_f32 v248, v248, v236
v_cvt_pk_bf16_f32 v251, v242, v248
ds_write_b64 v231, v[250:251] offset:8
s_waitcnt lgkmcnt(0)
ds_read_b64 v[250:251], v231 offset:4096
s_waitcnt lgkmcnt(0)
v_lshlrev_b32 v242, 16, v250
v_and_b32 v248, 0xffff0000, v250
v_mul_f32 v242, v242, v236
v_mul_f32 v248, v248, v236
v_cvt_pk_bf16_f32 v250, v242, v248
v_lshlrev_b32 v242, 16, v251
v_and_b32 v248, 0xffff0000, v251
v_mul_f32 v242, v242, v236
v_mul_f32 v248, v248, v236
v_cvt_pk_bf16_f32 v251, v242, v248
ds_write_b64 v231, v[250:251] offset:4096
s_waitcnt lgkmcnt(0)
ds_read_b64 v[250:251], v231 offset:4104
s_waitcnt lgkmcnt(0)
v_lshlrev_b32 v242, 16, v250
v_and_b32 v248, 0xffff0000, v250
v_mul_f32 v242, v242, v236
v_mul_f32 v248, v248, v236
v_cvt_pk_bf16_f32 v250, v242, v248
v_lshlrev_b32 v242, 16, v251
v_and_b32 v248, 0xffff0000, v251
v_mul_f32 v242, v242, v236
v_mul_f32 v248, v248, v236
v_cvt_pk_bf16_f32 v251, v242, v248
ds_write_b64 v231, v[250:251] offset:4104
s_waitcnt lgkmcnt(0)
v_exp_f32 v248, v132
s_nop 0
v_sub_f32 v225, v225, v248
v_exp_f32 v248, v133
s_nop 0
v_sub_f32 v225, v225, v248
v_exp_f32 v248, v134
s_nop 0
v_sub_f32 v225, v225, v248
v_exp_f32 v248, v135
s_nop 0
v_sub_f32 v225, v225, v248
v_max_f32 v225, 0, v225
v_min_f32 v225, s32, v225
v_log_f32 v248, v225
v_max3_f32 v233, v132, v133, v134
v_max3_f32 v233, v233, v135, v248
v_mov_b32 v248, v233
s_nop 1
v_permlane32_swap_b32 v233, v248
s_nop 1
v_max_f32 v233, v233, v248
v_mov_b32 v248, v233
s_nop 1
v_permlane16_swap_b32 v233, v248
s_nop 1
v_max_f32 v233, v233, v248
v_ceil_f32 v233, v233
v_max_f32 v233, 0, v233
v_sub_f32 v248, 0, v233
v_exp_f32 v237, v248
s_nop 1
v_mul_f32 v225, v225, v237
v_sub_f32 v196, v196, v233
v_sub_f32 v132, v132, v233
v_sub_f32 v148, v148, v233
v_sub_f32 v197, v197, v233
v_sub_f32 v133, v133, v233
v_sub_f32 v149, v149, v233
v_sub_f32 v198, v198, v233
v_sub_f32 v134, v134, v233
v_sub_f32 v150, v150, v233
v_sub_f32 v199, v199, v233
v_sub_f32 v135, v135, v233
v_sub_f32 v151, v151, v233
v_lshlrev_b32 v242, 16, v164
v_and_b32 v248, 0xffff0000, v164
v_mul_f32 v242, v242, v237
v_mul_f32 v248, v248, v237
v_cvt_pk_bf16_f32 v164, v242, v248
v_lshlrev_b32 v242, 16, v165
v_and_b32 v248, 0xffff0000, v165
v_mul_f32 v242, v242, v237
v_mul_f32 v248, v248, v237
v_cvt_pk_bf16_f32 v165, v242, v248
v_lshlrev_b32 v242, 16, v166
v_and_b32 v248, 0xffff0000, v166
v_mul_f32 v242, v242, v237
v_mul_f32 v248, v248, v237
v_cvt_pk_bf16_f32 v166, v242, v248
v_lshlrev_b32 v242, 16, v167
v_and_b32 v248, 0xffff0000, v167
v_mul_f32 v242, v242, v237
v_mul_f32 v248, v248, v237
v_cvt_pk_bf16_f32 v167, v242, v248
ds_read_b64 v[250:251], v231 offset:1024
s_waitcnt lgkmcnt(0)
v_lshlrev_b32 v242, 16, v250
v_and_b32 v248, 0xffff0000, v250
v_mul_f32 v242, v242, v237
v_mul_f32 v248, v248, v237
v_cvt_pk_bf16_f32 v250, v242, v248
v_lshlrev_b32 v242, 16, v251
v_and_b32 v248, 0xffff0000, v251
v_mul_f32 v242, v242, v237
v_mul_f32 v248, v248, v237
v_cvt_pk_bf16_f32 v251, v242, v248
ds_write_b64 v231, v[250:251] offset:1024
s_waitcnt lgkmcnt(0)
ds_read_b64 v[250:251], v231 offset:1032
s_waitcnt lgkmcnt(0)
v_lshlrev_b32 v242, 16, v250
v_and_b32 v248, 0xffff0000, v250
v_mul_f32 v242, v242, v237
v_mul_f32 v248, v248, v237
v_cvt_pk_bf16_f32 v250, v242, v248
v_lshlrev_b32 v242, 16, v251
v_and_b32 v248, 0xffff0000, v251
v_mul_f32 v242, v242, v237
v_mul_f32 v248, v248, v237
v_cvt_pk_bf16_f32 v251, v242, v248
ds_write_b64 v231, v[250:251] offset:1032
s_waitcnt lgkmcnt(0)
ds_read_b64 v[250:251], v231 offset:5120
s_waitcnt lgkmcnt(0)
v_lshlrev_b32 v242, 16, v250
v_and_b32 v248, 0xffff0000, v250
v_mul_f32 v242, v242, v237
v_mul_f32 v248, v248, v237
v_cvt_pk_bf16_f32 v250, v242, v248
v_lshlrev_b32 v242, 16, v251
v_and_b32 v248, 0xffff0000, v251
v_mul_f32 v242, v242, v237
v_mul_f32 v248, v248, v237
v_cvt_pk_bf16_f32 v251, v242, v248
ds_write_b64 v231, v[250:251] offset:5120
s_waitcnt lgkmcnt(0)
ds_read_b64 v[250:251], v231 offset:5128
s_waitcnt lgkmcnt(0)
v_lshlrev_b32 v242, 16, v250
v_and_b32 v248, 0xffff0000, v250
v_mul_f32 v242, v242, v237
v_mul_f32 v248, v248, v237
v_cvt_pk_bf16_f32 v250, v242, v248
v_lshlrev_b32 v242, 16, v251
v_and_b32 v248, 0xffff0000, v251
v_mul_f32 v242, v242, v237
v_mul_f32 v248, v248, v237
v_cvt_pk_bf16_f32 v251, v242, v248
ds_write_b64 v231, v[250:251] offset:5128
s_waitcnt lgkmcnt(0)
v_exp_f32 v248, v136
s_nop 0
v_sub_f32 v226, v226, v248
v_exp_f32 v248, v137
s_nop 0
v_sub_f32 v226, v226, v248
v_exp_f32 v248, v138
s_nop 0
v_sub_f32 v226, v226, v248
v_exp_f32 v248, v139
s_nop 0
v_sub_f32 v226, v226, v248
v_max_f32 v226, 0, v226
v_min_f32 v226, s32, v226
v_log_f32 v248, v226
v_max3_f32 v234, v136, v137, v138
v_max3_f32 v234, v234, v139, v248
v_mov_b32 v248, v234
s_nop 1
v_permlane32_swap_b32 v234, v248
s_nop 1
v_max_f32 v234, v234, v248
v_mov_b32 v248, v234
s_nop 1
v_permlane16_swap_b32 v234, v248
s_nop 1
v_max_f32 v234, v234, v248
v_ceil_f32 v234, v234
v_max_f32 v234, 0, v234
v_sub_f32 v248, 0, v234
v_exp_f32 v238, v248
s_nop 1
v_mul_f32 v226, v226, v238
v_sub_f32 v200, v200, v234
v_sub_f32 v136, v136, v234
v_sub_f32 v152, v152, v234
v_sub_f32 v201, v201, v234
v_sub_f32 v137, v137, v234
v_sub_f32 v153, v153, v234
v_sub_f32 v202, v202, v234
v_sub_f32 v138, v138, v234
v_sub_f32 v154, v154, v234
v_sub_f32 v203, v203, v234
v_sub_f32 v139, v139, v234
v_sub_f32 v155, v155, v234
v_lshlrev_b32 v242, 16, v168
v_and_b32 v248, 0xffff0000, v168
v_mul_f32 v242, v242, v238
v_mul_f32 v248, v248, v238
v_cvt_pk_bf16_f32 v168, v242, v248
v_lshlrev_b32 v242, 16, v169
v_and_b32 v248, 0xffff0000, v169
v_mul_f32 v242, v242, v238
v_mul_f32 v248, v248, v238
v_cvt_pk_bf16_f32 v169, v242, v248
v_lshlrev_b32 v242, 16, v170
v_and_b32 v248, 0xffff0000, v170
v_mul_f32 v242, v242, v238
v_mul_f32 v248, v248, v238
v_cvt_pk_bf16_f32 v170, v242, v248
v_lshlrev_b32 v242, 16, v171
v_and_b32 v248, 0xffff0000, v171
v_mul_f32 v242, v242, v238
v_mul_f32 v248, v248, v238
v_cvt_pk_bf16_f32 v171, v242, v248
ds_read_b64 v[250:251], v231 offset:2048
s_waitcnt lgkmcnt(0)
v_lshlrev_b32 v242, 16, v250
v_and_b32 v248, 0xffff0000, v250
v_mul_f32 v242, v242, v238
v_mul_f32 v248, v248, v238
v_cvt_pk_bf16_f32 v250, v242, v248
v_lshlrev_b32 v242, 16, v251
v_and_b32 v248, 0xffff0000, v251
v_mul_f32 v242, v242, v238
v_mul_f32 v248, v248, v238
v_cvt_pk_bf16_f32 v251, v242, v248
ds_write_b64 v231, v[250:251] offset:2048
s_waitcnt lgkmcnt(0)
ds_read_b64 v[250:251], v231 offset:2056
s_waitcnt lgkmcnt(0)
v_lshlrev_b32 v242, 16, v250
v_and_b32 v248, 0xffff0000, v250
v_mul_f32 v242, v242, v238
v_mul_f32 v248, v248, v238
v_cvt_pk_bf16_f32 v250, v242, v248
v_lshlrev_b32 v242, 16, v251
v_and_b32 v248, 0xffff0000, v251
v_mul_f32 v242, v242, v238
v_mul_f32 v248, v248, v238
v_cvt_pk_bf16_f32 v251, v242, v248
ds_write_b64 v231, v[250:251] offset:2056
s_waitcnt lgkmcnt(0)
ds_read_b64 v[250:251], v231 offset:6144
s_waitcnt lgkmcnt(0)
v_lshlrev_b32 v242, 16, v250
v_and_b32 v248, 0xffff0000, v250
v_mul_f32 v242, v242, v238
v_mul_f32 v248, v248, v238
v_cvt_pk_bf16_f32 v250, v242, v248
v_lshlrev_b32 v242, 16, v251
v_and_b32 v248, 0xffff0000, v251
v_mul_f32 v242, v242, v238
v_mul_f32 v248, v248, v238
v_cvt_pk_bf16_f32 v251, v242, v248
ds_write_b64 v231, v[250:251] offset:6144
s_waitcnt lgkmcnt(0)
ds_read_b64 v[250:251], v231 offset:6152
s_waitcnt lgkmcnt(0)
v_lshlrev_b32 v242, 16, v250
v_and_b32 v248, 0xffff0000, v250
v_mul_f32 v242, v242, v238
v_mul_f32 v248, v248, v238
v_cvt_pk_bf16_f32 v250, v242, v248
v_lshlrev_b32 v242, 16, v251
v_and_b32 v248, 0xffff0000, v251
v_mul_f32 v242, v242, v238
v_mul_f32 v248, v248, v238
v_cvt_pk_bf16_f32 v251, v242, v248
ds_write_b64 v231, v[250:251] offset:6152
s_waitcnt lgkmcnt(0)
v_exp_f32 v248, v140
s_nop 0
v_sub_f32 v227, v227, v248
v_exp_f32 v248, v141
s_nop 0
v_sub_f32 v227, v227, v248
v_exp_f32 v248, v142
s_nop 0
v_sub_f32 v227, v227, v248
v_exp_f32 v248, v143
s_nop 0
v_sub_f32 v227, v227, v248
v_max_f32 v227, 0, v227
v_min_f32 v227, s32, v227
v_log_f32 v248, v227
v_max3_f32 v235, v140, v141, v142
v_max3_f32 v235, v235, v143, v248
v_mov_b32 v248, v235
s_nop 1
v_permlane32_swap_b32 v235, v248
s_nop 1
v_max_f32 v235, v235, v248
v_mov_b32 v248, v235
s_nop 1
v_permlane16_swap_b32 v235, v248
s_nop 1
v_max_f32 v235, v235, v248
v_ceil_f32 v235, v235
v_max_f32 v235, 0, v235
v_sub_f32 v248, 0, v235
v_exp_f32 v239, v248
s_nop 1
v_mul_f32 v227, v227, v239
v_sub_f32 v204, v204, v235
v_sub_f32 v140, v140, v235
v_sub_f32 v156, v156, v235
v_sub_f32 v205, v205, v235
v_sub_f32 v141, v141, v235
v_sub_f32 v157, v157, v235
v_sub_f32 v206, v206, v235
v_sub_f32 v142, v142, v235
v_sub_f32 v158, v158, v235
v_sub_f32 v207, v207, v235
v_sub_f32 v143, v143, v235
v_sub_f32 v159, v159, v235
v_lshlrev_b32 v242, 16, v172
v_and_b32 v248, 0xffff0000, v172
v_mul_f32 v242, v242, v239
v_mul_f32 v248, v248, v239
v_cvt_pk_bf16_f32 v172, v242, v248
v_lshlrev_b32 v242, 16, v173
v_and_b32 v248, 0xffff0000, v173
v_mul_f32 v242, v242, v239
v_mul_f32 v248, v248, v239
v_cvt_pk_bf16_f32 v173, v242, v248
v_lshlrev_b32 v242, 16, v174
v_and_b32 v248, 0xffff0000, v174
v_mul_f32 v242, v242, v239
v_mul_f32 v248, v248, v239
v_cvt_pk_bf16_f32 v174, v242, v248
v_lshlrev_b32 v242, 16, v175
v_and_b32 v248, 0xffff0000, v175
v_mul_f32 v242, v242, v239
v_mul_f32 v248, v248, v239
v_cvt_pk_bf16_f32 v175, v242, v248
ds_read_b64 v[250:251], v231 offset:3072
s_waitcnt lgkmcnt(0)
v_lshlrev_b32 v242, 16, v250
v_and_b32 v248, 0xffff0000, v250
v_mul_f32 v242, v242, v239
v_mul_f32 v248, v248, v239
v_cvt_pk_bf16_f32 v250, v242, v248
v_lshlrev_b32 v242, 16, v251
v_and_b32 v248, 0xffff0000, v251
v_mul_f32 v242, v242, v239
v_mul_f32 v248, v248, v239
v_cvt_pk_bf16_f32 v251, v242, v248
ds_write_b64 v231, v[250:251] offset:3072
s_waitcnt lgkmcnt(0)
ds_read_b64 v[250:251], v231 offset:3080
s_waitcnt lgkmcnt(0)
v_lshlrev_b32 v242, 16, v250
v_and_b32 v248, 0xffff0000, v250
v_mul_f32 v242, v242, v239
v_mul_f32 v248, v248, v239
v_cvt_pk_bf16_f32 v250, v242, v248
v_lshlrev_b32 v242, 16, v251
v_and_b32 v248, 0xffff0000, v251
v_mul_f32 v242, v242, v239
v_mul_f32 v248, v248, v239
v_cvt_pk_bf16_f32 v251, v242, v248
ds_write_b64 v231, v[250:251] offset:3080
s_waitcnt lgkmcnt(0)
ds_read_b64 v[250:251], v231 offset:7168
s_waitcnt lgkmcnt(0)
v_lshlrev_b32 v242, 16, v250
v_and_b32 v248, 0xffff0000, v250
v_mul_f32 v242, v242, v239
v_mul_f32 v248, v248, v239
v_cvt_pk_bf16_f32 v250, v242, v248
v_lshlrev_b32 v242, 16, v251
v_and_b32 v248, 0xffff0000, v251
v_mul_f32 v242, v242, v239
v_mul_f32 v248, v248, v239
v_cvt_pk_bf16_f32 v251, v242, v248
ds_write_b64 v231, v[250:251] offset:7168
s_waitcnt lgkmcnt(0)
ds_read_b64 v[250:251], v231 offset:7176
s_waitcnt lgkmcnt(0)
v_lshlrev_b32 v242, 16, v250
v_and_b32 v248, 0xffff0000, v250
v_mul_f32 v242, v242, v239
v_mul_f32 v248, v248, v239
v_cvt_pk_bf16_f32 v250, v242, v248
v_lshlrev_b32 v242, 16, v251
v_and_b32 v248, 0xffff0000, v251
v_mul_f32 v242, v242, v239
v_mul_f32 v248, v248, v239
v_cvt_pk_bf16_f32 v251, v242, v248
ds_write_b64 v231, v[250:251] offset:7176
s_waitcnt lgkmcnt(0)
v_exp_f32 v232, v128
v_exp_f32 v233, v129
v_exp_f32 v234, v130
v_exp_f32 v235, v131
s_nop 1
v_add_f32 v224, v224, v232
v_add_f32 v224, v224, v233
v_add_f32 v224, v224, v234
v_add_f32 v224, v224, v235
v_cvt_pk_bf16_f32 v176, v232, v233
v_cvt_pk_bf16_f32 v177, v234, v235
v_exp_f32 v232, v132
v_exp_f32 v233, v133
v_exp_f32 v234, v134
v_exp_f32 v235, v135
s_nop 1
v_add_f32 v225, v225, v232
v_add_f32 v225, v225, v233
v_add_f32 v225, v225, v234
v_add_f32 v225, v225, v235
v_cvt_pk_bf16_f32 v180, v232, v233
v_cvt_pk_bf16_f32 v181, v234, v235
v_exp_f32 v232, v136
v_exp_f32 v233, v137
v_exp_f32 v234, v138
v_exp_f32 v235, v139
s_nop 1
v_add_f32 v226, v226, v232
v_add_f32 v226, v226, v233
v_add_f32 v226, v226, v234
v_add_f32 v226, v226, v235
v_cvt_pk_bf16_f32 v184, v232, v233
v_cvt_pk_bf16_f32 v185, v234, v235
v_exp_f32 v232, v140
v_exp_f32 v233, v141
v_exp_f32 v234, v142
v_exp_f32 v235, v143
s_nop 1
v_add_f32 v227, v227, v232
v_add_f32 v227, v227, v233
v_add_f32 v227, v227, v234
v_add_f32 v227, v227, v235
v_cvt_pk_bf16_f32 v188, v232, v233
v_cvt_pk_bf16_f32 v189, v234, v235
s_branch L2_rare_common
L2_rare_site15:
s_mov_b32 s36, 15
s_branch L2_rare_t0_3_1
L2_rare_t0_3_1:
s_nop 15
s_nop 15
s_waitcnt lgkmcnt(0)
v_exp_f32 v248, v144
s_nop 0
v_sub_f32 v224, v224, v248
v_exp_f32 v248, v145
s_nop 0
v_sub_f32 v224, v224, v248
v_exp_f32 v248, v146
s_nop 0
v_sub_f32 v224, v224, v248
v_exp_f32 v248, v147
s_nop 0
v_sub_f32 v224, v224, v248
v_max_f32 v224, 0, v224
v_min_f32 v224, s32, v224
v_log_f32 v248, v224
v_max3_f32 v232, v144, v145, v146
v_max3_f32 v232, v232, v147, v248
v_mov_b32 v248, v232
s_nop 1
v_permlane32_swap_b32 v232, v248
s_nop 1
v_max_f32 v232, v232, v248
v_mov_b32 v248, v232
s_nop 1
v_permlane16_swap_b32 v232, v248
s_nop 1
v_max_f32 v232, v232, v248
v_ceil_f32 v232, v232
v_max_f32 v232, 0, v232
v_sub_f32 v248, 0, v232
v_exp_f32 v236, v248
s_nop 1
v_mul_f32 v224, v224, v236
v_sub_f32 v192, v192, v232
v_sub_f32 v128, v128, v232
v_sub_f32 v144, v144, v232
v_sub_f32 v193, v193, v232
v_sub_f32 v129, v129, v232
v_sub_f32 v145, v145, v232
v_sub_f32 v194, v194, v232
v_sub_f32 v130, v130, v232
v_sub_f32 v146, v146, v232
v_sub_f32 v195, v195, v232
v_sub_f32 v131, v131, v232
v_sub_f32 v147, v147, v232
v_lshlrev_b32 v242, 16, v160
v_and_b32 v248, 0xffff0000, v160
v_mul_f32 v242, v242, v236
v_mul_f32 v248, v248, v236
v_cvt_pk_bf16_f32 v160, v242, v248
v_lshlrev_b32 v242, 16, v161
v_and_b32 v248, 0xffff0000, v161
v_mul_f32 v242, v242, v236
v_mul_f32 v248, v248, v236
v_cvt_pk_bf16_f32 v161, v242, v248
v_lshlrev_b32 v242, 16, v162
v_and_b32 v248, 0xffff0000, v162
v_mul_f32 v242, v242, v236
v_mul_f32 v248, v248, v236
v_cvt_pk_bf16_f32 v162, v242, v248
v_lshlrev_b32 v242, 16, v163
v_and_b32 v248, 0xffff0000, v163
v_mul_f32 v242, v242, v236
v_mul_f32 v248, v248, v236
v_cvt_pk_bf16_f32 v163, v242, v248
v_lshlrev_b32 v242, 16, v176
v_and_b32 v248, 0xffff0000, v176
v_mul_f32 v242, v242, v236
v_mul_f32 v248, v248, v236
v_cvt_pk_bf16_f32 v176, v242, v248
v_lshlrev_b32 v242, 16, v177
v_and_b32 v248, 0xffff0000, v177
v_mul_f32 v242, v242, v236
v_mul_f32 v248, v248, v236
v_cvt_pk_bf16_f32 v177, v242, v248
ds_read_b64 v[250:251], v231 offset:0
s_waitcnt lgkmcnt(0)
v_lshlrev_b32 v242, 16, v250
v_and_b32 v248, 0xffff0000, v250
v_mul_f32 v242, v242, v236
v_mul_f32 v248, v248, v236
v_cvt_pk_bf16_f32 v250, v242, v248
v_lshlrev_b32 v242, 16, v251
v_and_b32 v248, 0xffff0000, v251
v_mul_f32 v242, v242, v236
v_mul_f32 v248, v248, v236
v_cvt_pk_bf16_f32 v251, v242, v248
ds_write_b64 v231, v[250:251] offset:0
s_waitcnt lgkmcnt(0)
ds_read_b64 v[250:251], v231 offset:8
s_waitcnt lgkmcnt(0)
v_lshlrev_b32 v242, 16, v250
v_and_b32 v248, 0xffff0000, v250
v_mul_f32 v242, v242, v236
v_mul_f32 v248, v248, v236
v_cvt_pk_bf16_f32 v250, v242, v248
v_lshlrev_b32 v242, 16, v251
v_and_b32 v248, 0xffff0000, v251
v_mul_f32 v242, v242, v236
v_mul_f32 v248, v248, v236
v_cvt_pk_bf16_f32 v251, v242, v248
ds_write_b64 v231, v[250:251] offset:8
s_waitcnt lgkmcnt(0)
ds_read_b64 v[250:251], v231 offset:4096
s_waitcnt lgkmcnt(0)
v_lshlrev_b32 v242, 16, v250
v_and_b32 v248, 0xffff0000, v250
v_mul_f32 v242, v242, v236
v_mul_f32 v248, v248, v236
v_cvt_pk_bf16_f32 v250, v242, v248
v_lshlrev_b32 v242, 16, v251
v_and_b32 v248, 0xffff0000, v251
v_mul_f32 v242, v242, v236
v_mul_f32 v248, v248, v236
v_cvt_pk_bf16_f32 v251, v242, v248
ds_write_b64 v231, v[250:251] offset:4096
s_waitcnt lgkmcnt(0)
ds_read_b64 v[250:251], v231 offset:4104
s_waitcnt lgkmcnt(0)
v_lshlrev_b32 v242, 16, v250
v_and_b32 v248, 0xffff0000, v250
v_mul_f32 v242, v242, v236
v_mul_f32 v248, v248, v236
v_cvt_pk_bf16_f32 v250, v242, v248
v_lshlrev_b32 v242, 16, v251
v_and_b32 v248, 0xffff0000, v251
v_mul_f32 v242, v242, v236
v_mul_f32 v248, v248, v236
v_cvt_pk_bf16_f32 v251, v242, v248
ds_write_b64 v231, v[250:251] offset:4104
s_waitcnt lgkmcnt(0)
v_exp_f32 v248, v148
s_nop 0
v_sub_f32 v225, v225, v248
v_exp_f32 v248, v149
s_nop 0
v_sub_f32 v225, v225, v248
v_exp_f32 v248, v150
s_nop 0
v_sub_f32 v225, v225, v248
v_exp_f32 v248, v151
s_nop 0
v_sub_f32 v225, v225, v248
v_max_f32 v225, 0, v225
v_min_f32 v225, s32, v225
v_log_f32 v248, v225
v_max3_f32 v233, v148, v149, v150
v_max3_f32 v233, v233, v151, v248
v_mov_b32 v248, v233
s_nop 1
v_permlane32_swap_b32 v233, v248
s_nop 1
v_max_f32 v233, v233, v248
v_mov_b32 v248, v233
s_nop 1
v_permlane16_swap_b32 v233, v248
s_nop 1
v_max_f32 v233, v233, v248
v_ceil_f32 v233, v233
v_max_f32 v233, 0, v233
v_sub_f32 v248, 0, v233
v_exp_f32 v237, v248
s_nop 1
v_mul_f32 v225, v225, v237
v_sub_f32 v196, v196, v233
v_sub_f32 v132, v132, v233
v_sub_f32 v148, v148, v233
v_sub_f32 v197, v197, v233
v_sub_f32 v133, v133, v233
v_sub_f32 v149, v149, v233
v_sub_f32 v198, v198, v233
v_sub_f32 v134, v134, v233
v_sub_f32 v150, v150, v233
v_sub_f32 v199, v199, v233
v_sub_f32 v135, v135, v233
v_sub_f32 v151, v151, v233
v_lshlrev_b32 v242, 16, v164
v_and_b32 v248, 0xffff0000, v164
v_mul_f32 v242, v242, v237
v_mul_f32 v248, v248, v237
v_cvt_pk_bf16_f32 v164, v242, v248
v_lshlrev_b32 v242, 16, v165
v_and_b32 v248, 0xffff0000, v165
v_mul_f32 v242, v242, v237
v_mul_f32 v248, v248, v237
v_cvt_pk_bf16_f32 v165, v242, v248
v_lshlrev_b32 v242, 16, v166
v_and_b32 v248, 0xffff0000, v166
v_mul_f32 v242, v242, v237
v_mul_f32 v248, v248, v237
v_cvt_pk_bf16_f32 v166, v242, v248
v_lshlrev_b32 v242, 16, v167
v_and_b32 v248, 0xffff0000, v167
v_mul_f32 v242, v242, v237
v_mul_f32 v248, v248, v237
v_cvt_pk_bf16_f32 v167, v242, v248
v_lshlrev_b32 v242, 16, v180
v_and_b32 v248, 0xffff0000, v180
v_mul_f32 v242, v242, v237
v_mul_f32 v248, v248, v237
v_cvt_pk_bf16_f32 v180, v242, v248
v_lshlrev_b32 v242, 16, v181
v_and_b32 v248, 0xffff0000, v181
v_mul_f32 v242, v242, v237
v_mul_f32 v248, v248, v237
v_cvt_pk_bf16_f32 v181, v242, v248
ds_read_b64 v[250:251], v231 offset:1024
s_waitcnt lgkmcnt(0)
v_lshlrev_b32 v242, 16, v250
v_and_b32 v248, 0xffff0000, v250
v_mul_f32 v242, v242, v237
v_mul_f32 v248, v248, v237
v_cvt_pk_bf16_f32 v250, v242, v248
v_lshlrev_b32 v242, 16, v251
v_and_b32 v248, 0xffff0000, v251
v_mul_f32 v242, v242, v237
v_mul_f32 v248, v248, v237
v_cvt_pk_bf16_f32 v251, v242, v248
ds_write_b64 v231, v[250:251] offset:1024
s_waitcnt lgkmcnt(0)
ds_read_b64 v[250:251], v231 offset:1032
s_waitcnt lgkmcnt(0)
v_lshlrev_b32 v242, 16, v250
v_and_b32 v248, 0xffff0000, v250
v_mul_f32 v242, v242, v237
v_mul_f32 v248, v248, v237
v_cvt_pk_bf16_f32 v250, v242, v248
v_lshlrev_b32 v242, 16, v251
v_and_b32 v248, 0xffff0000, v251
v_mul_f32 v242, v242, v237
v_mul_f32 v248, v248, v237
v_cvt_pk_bf16_f32 v251, v242, v248
ds_write_b64 v231, v[250:251] offset:1032
s_waitcnt lgkmcnt(0)
ds_read_b64 v[250:251], v231 offset:5120
s_waitcnt lgkmcnt(0)
v_lshlrev_b32 v242, 16, v250
v_and_b32 v248, 0xffff0000, v250
v_mul_f32 v242, v242, v237
v_mul_f32 v248, v248, v237
v_cvt_pk_bf16_f32 v250, v242, v248
v_lshlrev_b32 v242, 16, v251
v_and_b32 v248, 0xffff0000, v251
v_mul_f32 v242, v242, v237
v_mul_f32 v248, v248, v237
v_cvt_pk_bf16_f32 v251, v242, v248
ds_write_b64 v231, v[250:251] offset:5120
s_waitcnt lgkmcnt(0)
ds_read_b64 v[250:251], v231 offset:5128
s_waitcnt lgkmcnt(0)
v_lshlrev_b32 v242, 16, v250
v_and_b32 v248, 0xffff0000, v250
v_mul_f32 v242, v242, v237
v_mul_f32 v248, v248, v237
v_cvt_pk_bf16_f32 v250, v242, v248
v_lshlrev_b32 v242, 16, v251
v_and_b32 v248, 0xffff0000, v251
v_mul_f32 v242, v242, v237
v_mul_f32 v248, v248, v237
v_cvt_pk_bf16_f32 v251, v242, v248
ds_write_b64 v231, v[250:251] offset:5128
s_waitcnt lgkmcnt(0)
v_exp_f32 v248, v152
s_nop 0
v_sub_f32 v226, v226, v248
v_exp_f32 v248, v153
s_nop 0
v_sub_f32 v226, v226, v248
v_exp_f32 v248, v154
s_nop 0
v_sub_f32 v226, v226, v248
v_exp_f32 v248, v155
s_nop 0
v_sub_f32 v226, v226, v248
v_max_f32 v226, 0, v226
v_min_f32 v226, s32, v226
v_log_f32 v248, v226
v_max3_f32 v234, v152, v153, v154
v_max3_f32 v234, v234, v155, v248
v_mov_b32 v248, v234
s_nop 1
v_permlane32_swap_b32 v234, v248
s_nop 1
v_max_f32 v234, v234, v248
v_mov_b32 v248, v234
s_nop 1
v_permlane16_swap_b32 v234, v248
s_nop 1
v_max_f32 v234, v234, v248
v_ceil_f32 v234, v234
v_max_f32 v234, 0, v234
v_sub_f32 v248, 0, v234
v_exp_f32 v238, v248
s_nop 1
v_mul_f32 v226, v226, v238
v_sub_f32 v200, v200, v234
v_sub_f32 v136, v136, v234
v_sub_f32 v152, v152, v234
v_sub_f32 v201, v201, v234
v_sub_f32 v137, v137, v234
v_sub_f32 v153, v153, v234
v_sub_f32 v202, v202, v234
v_sub_f32 v138, v138, v234
v_sub_f32 v154, v154, v234
v_sub_f32 v203, v203, v234
v_sub_f32 v139, v139, v234
v_sub_f32 v155, v155, v234
v_lshlrev_b32 v242, 16, v168
v_and_b32 v248, 0xffff0000, v168
v_mul_f32 v242, v242, v238
v_mul_f32 v248, v248, v238
v_cvt_pk_bf16_f32 v168, v242, v248
v_lshlrev_b32 v242, 16, v169
v_and_b32 v248, 0xffff0000, v169
v_mul_f32 v242, v242, v238
v_mul_f32 v248, v248, v238
v_cvt_pk_bf16_f32 v169, v242, v248
v_lshlrev_b32 v242, 16, v170
v_and_b32 v248, 0xffff0000, v170
v_mul_f32 v242, v242, v238
v_mul_f32 v248, v248, v238
v_cvt_pk_bf16_f32 v170, v242, v248
v_lshlrev_b32 v242, 16, v171
v_and_b32 v248, 0xffff0000, v171
v_mul_f32 v242, v242, v238
v_mul_f32 v248, v248, v238
v_cvt_pk_bf16_f32 v171, v242, v248
v_lshlrev_b32 v242, 16, v184
v_and_b32 v248, 0xffff0000, v184
v_mul_f32 v242, v242, v238
v_mul_f32 v248, v248, v238
v_cvt_pk_bf16_f32 v184, v242, v248
v_lshlrev_b32 v242, 16, v185
v_and_b32 v248, 0xffff0000, v185
v_mul_f32 v242, v242, v238
v_mul_f32 v248, v248, v238
v_cvt_pk_bf16_f32 v185, v242, v248
ds_read_b64 v[250:251], v231 offset:2048
s_waitcnt lgkmcnt(0)
v_lshlrev_b32 v242, 16, v250
v_and_b32 v248, 0xffff0000, v250
v_mul_f32 v242, v242, v238
v_mul_f32 v248, v248, v238
v_cvt_pk_bf16_f32 v250, v242, v248
v_lshlrev_b32 v242, 16, v251
v_and_b32 v248, 0xffff0000, v251
v_mul_f32 v242, v242, v238
v_mul_f32 v248, v248, v238
v_cvt_pk_bf16_f32 v251, v242, v248
ds_write_b64 v231, v[250:251] offset:2048
s_waitcnt lgkmcnt(0)
ds_read_b64 v[250:251], v231 offset:2056
s_waitcnt lgkmcnt(0)
v_lshlrev_b32 v242, 16, v250
v_and_b32 v248, 0xffff0000, v250
v_mul_f32 v242, v242, v238
v_mul_f32 v248, v248, v238
v_cvt_pk_bf16_f32 v250, v242, v248
v_lshlrev_b32 v242, 16, v251
v_and_b32 v248, 0xffff0000, v251
v_mul_f32 v242, v242, v238
v_mul_f32 v248, v248, v238
v_cvt_pk_bf16_f32 v251, v242, v248
ds_write_b64 v231, v[250:251] offset:2056
s_waitcnt lgkmcnt(0)
ds_read_b64 v[250:251], v231 offset:6144
s_waitcnt lgkmcnt(0)
v_lshlrev_b32 v242, 16, v250
v_and_b32 v248, 0xffff0000, v250
v_mul_f32 v242, v242, v238
v_mul_f32 v248, v248, v238
v_cvt_pk_bf16_f32 v250, v242, v248
v_lshlrev_b32 v242, 16, v251
v_and_b32 v248, 0xffff0000, v251
v_mul_f32 v242, v242, v238
v_mul_f32 v248, v248, v238
v_cvt_pk_bf16_f32 v251, v242, v248
ds_write_b64 v231, v[250:251] offset:6144
s_waitcnt lgkmcnt(0)
ds_read_b64 v[250:251], v231 offset:6152
s_waitcnt lgkmcnt(0)
v_lshlrev_b32 v242, 16, v250
v_and_b32 v248, 0xffff0000, v250
v_mul_f32 v242, v242, v238
v_mul_f32 v248, v248, v238
v_cvt_pk_bf16_f32 v250, v242, v248
v_lshlrev_b32 v242, 16, v251
v_and_b32 v248, 0xffff0000, v251
v_mul_f32 v242, v242, v238
v_mul_f32 v248, v248, v238
v_cvt_pk_bf16_f32 v251, v242, v248
ds_write_b64 v231, v[250:251] offset:6152
s_waitcnt lgkmcnt(0)
v_exp_f32 v248, v156
s_nop 0
v_sub_f32 v227, v227, v248
v_exp_f32 v248, v157
s_nop 0
v_sub_f32 v227, v227, v248
v_exp_f32 v248, v158
s_nop 0
v_sub_f32 v227, v227, v248
v_exp_f32 v248, v159
s_nop 0
v_sub_f32 v227, v227, v248
v_max_f32 v227, 0, v227
v_min_f32 v227, s32, v227
v_log_f32 v248, v227
v_max3_f32 v235, v156, v157, v158
v_max3_f32 v235, v235, v159, v248
v_mov_b32 v248, v235
s_nop 1
v_permlane32_swap_b32 v235, v248
s_nop 1
v_max_f32 v235, v235, v248
v_mov_b32 v248, v235
s_nop 1
v_permlane16_swap_b32 v235, v248
s_nop 1
v_max_f32 v235, v235, v248
v_ceil_f32 v235, v235
v_max_f32 v235, 0, v235
v_sub_f32 v248, 0, v235
v_exp_f32 v239, v248
s_nop 1
v_mul_f32 v227, v227, v239
v_sub_f32 v204, v204, v235
v_sub_f32 v140, v140, v235
v_sub_f32 v156, v156, v235
v_sub_f32 v205, v205, v235
v_sub_f32 v141, v141, v235
v_sub_f32 v157, v157, v235
v_sub_f32 v206, v206, v235
v_sub_f32 v142, v142, v235
v_sub_f32 v158, v158, v235
v_sub_f32 v207, v207, v235
v_sub_f32 v143, v143, v235
v_sub_f32 v159, v159, v235
v_lshlrev_b32 v242, 16, v172
v_and_b32 v248, 0xffff0000, v172
v_mul_f32 v242, v242, v239
v_mul_f32 v248, v248, v239
v_cvt_pk_bf16_f32 v172, v242, v248
v_lshlrev_b32 v242, 16, v173
v_and_b32 v248, 0xffff0000, v173
v_mul_f32 v242, v242, v239
v_mul_f32 v248, v248, v239
v_cvt_pk_bf16_f32 v173, v242, v248
v_lshlrev_b32 v242, 16, v174
v_and_b32 v248, 0xffff0000, v174
v_mul_f32 v242, v242, v239
v_mul_f32 v248, v248, v239
v_cvt_pk_bf16_f32 v174, v242, v248
v_lshlrev_b32 v242, 16, v175
v_and_b32 v248, 0xffff0000, v175
v_mul_f32 v242, v242, v239
v_mul_f32 v248, v248, v239
v_cvt_pk_bf16_f32 v175, v242, v248
v_lshlrev_b32 v242, 16, v188
v_and_b32 v248, 0xffff0000, v188
v_mul_f32 v242, v242, v239
v_mul_f32 v248, v248, v239
v_cvt_pk_bf16_f32 v188, v242, v248
v_lshlrev_b32 v242, 16, v189
v_and_b32 v248, 0xffff0000, v189
v_mul_f32 v242, v242, v239
v_mul_f32 v248, v248, v239
v_cvt_pk_bf16_f32 v189, v242, v248
ds_read_b64 v[250:251], v231 offset:3072
s_waitcnt lgkmcnt(0)
v_lshlrev_b32 v242, 16, v250
v_and_b32 v248, 0xffff0000, v250
v_mul_f32 v242, v242, v239
v_mul_f32 v248, v248, v239
v_cvt_pk_bf16_f32 v250, v242, v248
v_lshlrev_b32 v242, 16, v251
v_and_b32 v248, 0xffff0000, v251
v_mul_f32 v242, v242, v239
v_mul_f32 v248, v248, v239
v_cvt_pk_bf16_f32 v251, v242, v248
ds_write_b64 v231, v[250:251] offset:3072
s_waitcnt lgkmcnt(0)
ds_read_b64 v[250:251], v231 offset:3080
s_waitcnt lgkmcnt(0)
v_lshlrev_b32 v242, 16, v250
v_and_b32 v248, 0xffff0000, v250
v_mul_f32 v242, v242, v239
v_mul_f32 v248, v248, v239
v_cvt_pk_bf16_f32 v250, v242, v248
v_lshlrev_b32 v242, 16, v251
v_and_b32 v248, 0xffff0000, v251
v_mul_f32 v242, v242, v239
v_mul_f32 v248, v248, v239
v_cvt_pk_bf16_f32 v251, v242, v248
ds_write_b64 v231, v[250:251] offset:3080
s_waitcnt lgkmcnt(0)
ds_read_b64 v[250:251], v231 offset:7168
s_waitcnt lgkmcnt(0)
v_lshlrev_b32 v242, 16, v250
v_and_b32 v248, 0xffff0000, v250
v_mul_f32 v242, v242, v239
v_mul_f32 v248, v248, v239
v_cvt_pk_bf16_f32 v250, v242, v248
v_lshlrev_b32 v242, 16, v251
v_and_b32 v248, 0xffff0000, v251
v_mul_f32 v242, v242, v239
v_mul_f32 v248, v248, v239
v_cvt_pk_bf16_f32 v251, v242, v248
ds_write_b64 v231, v[250:251] offset:7168
s_waitcnt lgkmcnt(0)
ds_read_b64 v[250:251], v231 offset:7176
s_waitcnt lgkmcnt(0)
v_lshlrev_b32 v242, 16, v250
v_and_b32 v248, 0xffff0000, v250
v_mul_f32 v242, v242, v239
v_mul_f32 v248, v248, v239
v_cvt_pk_bf16_f32 v250, v242, v248
v_lshlrev_b32 v242, 16, v251
v_and_b32 v248, 0xffff0000, v251
v_mul_f32 v242, v242, v239
v_mul_f32 v248, v248, v239
v_cvt_pk_bf16_f32 v251, v242, v248
ds_write_b64 v231, v[250:251] offset:7176
s_waitcnt lgkmcnt(0)
v_exp_f32 v232, v144
v_exp_f32 v233, v145
v_exp_f32 v234, v146
v_exp_f32 v235, v147
s_nop 1
v_add_f32 v224, v224, v232
v_add_f32 v224, v224, v233
v_add_f32 v224, v224, v234
v_add_f32 v224, v224, v235
v_cvt_pk_bf16_f32 v178, v232, v233
v_cvt_pk_bf16_f32 v179, v234, v235
v_exp_f32 v232, v148
v_exp_f32 v233, v149
v_exp_f32 v234, v150
v_exp_f32 v235, v151
s_nop 1
v_add_f32 v225, v225, v232
v_add_f32 v225, v225, v233
v_add_f32 v225, v225, v234
v_add_f32 v225, v225, v235
v_cvt_pk_bf16_f32 v182, v232, v233
v_cvt_pk_bf16_f32 v183, v234, v235
v_exp_f32 v232, v152
v_exp_f32 v233, v153
v_exp_f32 v234, v154
v_exp_f32 v235, v155
s_nop 1
v_add_f32 v226, v226, v232
v_add_f32 v226, v226, v233
v_add_f32 v226, v226, v234
v_add_f32 v226, v226, v235
v_cvt_pk_bf16_f32 v186, v232, v233
v_cvt_pk_bf16_f32 v187, v234, v235
v_exp_f32 v232, v156
v_exp_f32 v233, v157
v_exp_f32 v234, v158
v_exp_f32 v235, v159
s_nop 1
v_add_f32 v227, v227, v232
v_add_f32 v227, v227, v233
v_add_f32 v227, v227, v234
v_add_f32 v227, v227, v235
v_cvt_pk_bf16_f32 v190, v232, v233
v_cvt_pk_bf16_f32 v191, v234, v235
s_branch L2_rare_common
L2_rare_site16:
s_mov_b32 s36, 16
s_branch L2_rare_t0_4_0
L2_rare_t0_4_0:
s_nop 15
s_nop 15
s_waitcnt lgkmcnt(0)
v_exp_f32 v248, v128
s_nop 0
v_sub_f32 v224, v224, v248
v_exp_f32 v248, v129
s_nop 0
v_sub_f32 v224, v224, v248
v_exp_f32 v248, v130
s_nop 0
v_sub_f32 v224, v224, v248
v_exp_f32 v248, v131
s_nop 0
v_sub_f32 v224, v224, v248
v_max_f32 v224, 0, v224
v_min_f32 v224, s32, v224
v_log_f32 v248, v224
v_max3_f32 v232, v128, v129, v130
v_max3_f32 v232, v232, v131, v248
v_mov_b32 v248, v232
s_nop 1
v_permlane32_swap_b32 v232, v248
s_nop 1
v_max_f32 v232, v232, v248
v_mov_b32 v248, v232
s_nop 1
v_permlane16_swap_b32 v232, v248
s_nop 1
v_max_f32 v232, v232, v248
v_ceil_f32 v232, v232
v_max_f32 v232, 0, v232
v_sub_f32 v248, 0, v232
v_exp_f32 v236, v248
s_nop 1
v_mul_f32 v224, v224, v236
v_sub_f32 v192, v192, v232
v_sub_f32 v128, v128, v232
v_sub_f32 v144, v144, v232
v_sub_f32 v193, v193, v232
v_sub_f32 v129, v129, v232
v_sub_f32 v145, v145, v232
v_sub_f32 v194, v194, v232
v_sub_f32 v130, v130, v232
v_sub_f32 v146, v146, v232
v_sub_f32 v195, v195, v232
v_sub_f32 v131, v131, v232
v_sub_f32 v147, v147, v232
v_lshlrev_b32 v242, 16, v4
v_and_b32 v248, 0xffff0000, v4
v_mul_f32 v242, v242, v236
v_mul_f32 v248, v248, v236
v_cvt_pk_bf16_f32 v4, v242, v248
v_lshlrev_b32 v242, 16, v5
v_and_b32 v248, 0xffff0000, v5
v_mul_f32 v242, v242, v236
v_mul_f32 v248, v248, v236
v_cvt_pk_bf16_f32 v5, v242, v248
v_lshlrev_b32 v242, 16, v6
v_and_b32 v248, 0xffff0000, v6
v_mul_f32 v242, v242, v236
v_mul_f32 v248, v248, v236
v_cvt_pk_bf16_f32 v6, v242, v248
v_lshlrev_b32 v242, 16, v7
v_and_b32 v248, 0xffff0000, v7
v_mul_f32 v242, v242, v236
v_mul_f32 v248, v248, v236
v_cvt_pk_bf16_f32 v7, v242, v248
v_lshlrev_b32 v242, 16, v8
v_and_b32 v248, 0xffff0000, v8
v_mul_f32 v242, v242, v236
v_mul_f32 v248, v248, v236
v_cvt_pk_bf16_f32 v8, v242, v248
v_lshlrev_b32 v242, 16, v9
v_and_b32 v248, 0xffff0000, v9
v_mul_f32 v242, v242, v236
v_mul_f32 v248, v248, v236
v_cvt_pk_bf16_f32 v9, v242, v248
v_lshlrev_b32 v242, 16, v10
v_and_b32 v248, 0xffff0000, v10
v_mul_f32 v242, v242, v236
v_mul_f32 v248, v248, v236
v_cvt_pk_bf16_f32 v10, v242, v248
v_lshlrev_b32 v242, 16, v11
v_and_b32 v248, 0xffff0000, v11
v_mul_f32 v242, v242, v236
v_mul_f32 v248, v248, v236
v_cvt_pk_bf16_f32 v11, v242, v248
v_lshlrev_b32 v242, 16, v160
v_and_b32 v248, 0xffff0000, v160
v_mul_f32 v242, v242, v236
v_mul_f32 v248, v248, v236
v_cvt_pk_bf16_f32 v160, v242, v248
v_lshlrev_b32 v242, 16, v161
v_and_b32 v248, 0xffff0000, v161
v_mul_f32 v242, v242, v236
v_mul_f32 v248, v248, v236
v_cvt_pk_bf16_f32 v161, v242, v248
v_lshlrev_b32 v242, 16, v162
v_and_b32 v248, 0xffff0000, v162
v_mul_f32 v242, v242, v236
v_mul_f32 v248, v248, v236
v_cvt_pk_bf16_f32 v162, v242, v248
v_lshlrev_b32 v242, 16, v163
v_and_b32 v248, 0xffff0000, v163
v_mul_f32 v242, v242, v236
v_mul_f32 v248, v248, v236
v_cvt_pk_bf16_f32 v163, v242, v248
v_lshlrev_b32 v242, 16, v176
v_and_b32 v248, 0xffff0000, v176
v_mul_f32 v242, v242, v236
v_mul_f32 v248, v248, v236
v_cvt_pk_bf16_f32 v176, v242, v248
v_lshlrev_b32 v242, 16, v177
v_and_b32 v248, 0xffff0000, v177
v_mul_f32 v242, v242, v236
v_mul_f32 v248, v248, v236
v_cvt_pk_bf16_f32 v177, v242, v248
v_lshlrev_b32 v242, 16, v178
v_and_b32 v248, 0xffff0000, v178
v_mul_f32 v242, v242, v236
v_mul_f32 v248, v248, v236
v_cvt_pk_bf16_f32 v178, v242, v248
v_lshlrev_b32 v242, 16, v179
v_and_b32 v248, 0xffff0000, v179
v_mul_f32 v242, v242, v236
v_mul_f32 v248, v248, v236
v_cvt_pk_bf16_f32 v179, v242, v248
v_exp_f32 v248, v132
s_nop 0
v_sub_f32 v225, v225, v248
v_exp_f32 v248, v133
s_nop 0
v_sub_f32 v225, v225, v248
v_exp_f32 v248, v134
s_nop 0
v_sub_f32 v225, v225, v248
v_exp_f32 v248, v135
s_nop 0
v_sub_f32 v225, v225, v248
v_max_f32 v225, 0, v225
v_min_f32 v225, s32, v225
v_log_f32 v248, v225
v_max3_f32 v233, v132, v133, v134
v_max3_f32 v233, v233, v135, v248
v_mov_b32 v248, v233
s_nop 1
v_permlane32_swap_b32 v233, v248
s_nop 1
v_max_f32 v233, v233, v248
v_mov_b32 v248, v233
s_nop 1
v_permlane16_swap_b32 v233, v248
s_nop 1
v_max_f32 v233, v233, v248
v_ceil_f32 v233, v233
v_max_f32 v233, 0, v233
v_sub_f32 v248, 0, v233
v_exp_f32 v237, v248
s_nop 1
v_mul_f32 v225, v225, v237
v_sub_f32 v196, v196, v233
v_sub_f32 v132, v132, v233
v_sub_f32 v148, v148, v233
v_sub_f32 v197, v197, v233
v_sub_f32 v133, v133, v233
v_sub_f32 v149, v149, v233
v_sub_f32 v198, v198, v233
v_sub_f32 v134, v134, v233
v_sub_f32 v150, v150, v233
v_sub_f32 v199, v199, v233
v_sub_f32 v135, v135, v233
v_sub_f32 v151, v151, v233
v_lshlrev_b32 v242, 16, v36
v_and_b32 v248, 0xffff0000, v36
v_mul_f32 v242, v242, v237
v_mul_f32 v248, v248, v237
v_cvt_pk_bf16_f32 v36, v242, v248
v_lshlrev_b32 v242, 16, v37
v_and_b32 v248, 0xffff0000, v37
v_mul_f32 v242, v242, v237
v_mul_f32 v248, v248, v237
v_cvt_pk_bf16_f32 v37, v242, v248
v_lshlrev_b32 v242, 16, v38
v_and_b32 v248, 0xffff0000, v38
v_mul_f32 v242, v242, v237
v_mul_f32 v248, v248, v237
v_cvt_pk_bf16_f32 v38, v242, v248
v_lshlrev_b32 v242, 16, v39
v_and_b32 v248, 0xffff0000, v39
v_mul_f32 v242, v242, v237
v_mul_f32 v248, v248, v237
v_cvt_pk_bf16_f32 v39, v242, v248
v_lshlrev_b32 v242, 16, v40
v_and_b32 v248, 0xffff0000, v40
v_mul_f32 v242, v242, v237
v_mul_f32 v248, v248, v237
v_cvt_pk_bf16_f32 v40, v242, v248
v_lshlrev_b32 v242, 16, v41
v_and_b32 v248, 0xffff0000, v41
v_mul_f32 v242, v242, v237
v_mul_f32 v248, v248, v237
v_cvt_pk_bf16_f32 v41, v242, v248
v_lshlrev_b32 v242, 16, v42
v_and_b32 v248, 0xffff0000, v42
v_mul_f32 v242, v242, v237
v_mul_f32 v248, v248, v237
v_cvt_pk_bf16_f32 v42, v242, v248
v_lshlrev_b32 v242, 16, v43
v_and_b32 v248, 0xffff0000, v43
v_mul_f32 v242, v242, v237
v_mul_f32 v248, v248, v237
v_cvt_pk_bf16_f32 v43, v242, v248
v_lshlrev_b32 v242, 16, v164
v_and_b32 v248, 0xffff0000, v164
v_mul_f32 v242, v242, v237
v_mul_f32 v248, v248, v237
v_cvt_pk_bf16_f32 v164, v242, v248
v_lshlrev_b32 v242, 16, v165
v_and_b32 v248, 0xffff0000, v165
v_mul_f32 v242, v242, v237
v_mul_f32 v248, v248, v237
v_cvt_pk_bf16_f32 v165, v242, v248
v_lshlrev_b32 v242, 16, v166
v_and_b32 v248, 0xffff0000, v166
v_mul_f32 v242, v242, v237
v_mul_f32 v248, v248, v237
v_cvt_pk_bf16_f32 v166, v242, v248
v_lshlrev_b32 v242, 16, v167
v_and_b32 v248, 0xffff0000, v167
v_mul_f32 v242, v242, v237
v_mul_f32 v248, v248, v237
v_cvt_pk_bf16_f32 v167, v242, v248
v_lshlrev_b32 v242, 16, v180
v_and_b32 v248, 0xffff0000, v180
v_mul_f32 v242, v242, v237
v_mul_f32 v248, v248, v237
v_cvt_pk_bf16_f32 v180, v242, v248
v_lshlrev_b32 v242, 16, v181
v_and_b32 v248, 0xffff0000, v181
v_mul_f32 v242, v242, v237
v_mul_f32 v248, v248, v237
v_cvt_pk_bf16_f32 v181, v242, v248
v_lshlrev_b32 v242, 16, v182
v_and_b32 v248, 0xffff0000, v182
v_mul_f32 v242, v242, v237
v_mul_f32 v248, v248, v237
v_cvt_pk_bf16_f32 v182, v242, v248
v_lshlrev_b32 v242, 16, v183
v_and_b32 v248, 0xffff0000, v183
v_mul_f32 v242, v242, v237
v_mul_f32 v248, v248, v237
v_cvt_pk_bf16_f32 v183, v242, v248
v_exp_f32 v248, v136
s_nop 0
v_sub_f32 v226, v226, v248
v_exp_f32 v248, v137
s_nop 0
v_sub_f32 v226, v226, v248
v_exp_f32 v248, v138
s_nop 0
v_sub_f32 v226, v226, v248
v_exp_f32 v248, v139
s_nop 0
v_sub_f32 v226, v226, v248
v_max_f32 v226, 0, v226
v_min_f32 v226, s32, v226
v_log_f32 v248, v226
v_max3_f32 v234, v136, v137, v138
v_max3_f32 v234, v234, v139, v248
v_mov_b32 v248, v234
s_nop 1
v_permlane32_swap_b32 v234, v248
s_nop 1
v_max_f32 v234, v234, v248
v_mov_b32 v248, v234
s_nop 1
v_permlane16_swap_b32 v234, v248
s_nop 1
v_max_f32 v234, v234, v248
v_ceil_f32 v234, v234
v_max_f32 v234, 0, v234
v_sub_f32 v248, 0, v234
v_exp_f32 v238, v248
s_nop 1
v_mul_f32 v226, v226, v238
v_sub_f32 v200, v200, v234
v_sub_f32 v136, v136, v234
v_sub_f32 v152, v152, v234
v_sub_f32 v201, v201, v234
v_sub_f32 v137, v137, v234
v_sub_f32 v153, v153, v234
v_sub_f32 v202, v202, v234
v_sub_f32 v138, v138, v234
v_sub_f32 v154, v154, v234
v_sub_f32 v203, v203, v234
v_sub_f32 v139, v139, v234
v_sub_f32 v155, v155, v234
v_lshlrev_b32 v242, 16, v68
v_and_b32 v248, 0xffff0000, v68
v_mul_f32 v242, v242, v238
v_mul_f32 v248, v248, v238
v_cvt_pk_bf16_f32 v68, v242, v248
v_lshlrev_b32 v242, 16, v69
v_and_b32 v248, 0xffff0000, v69
v_mul_f32 v242, v242, v238
v_mul_f32 v248, v248, v238
v_cvt_pk_bf16_f32 v69, v242, v248
v_lshlrev_b32 v242, 16, v70
v_and_b32 v248, 0xffff0000, v70
v_mul_f32 v242, v242, v238
v_mul_f32 v248, v248, v238
v_cvt_pk_bf16_f32 v70, v242, v248
v_lshlrev_b32 v242, 16, v71
v_and_b32 v248, 0xffff0000, v71
v_mul_f32 v242, v242, v238
v_mul_f32 v248, v248, v238
v_cvt_pk_bf16_f32 v71, v242, v248
v_lshlrev_b32 v242, 16, v72
v_and_b32 v248, 0xffff0000, v72
v_mul_f32 v242, v242, v238
v_mul_f32 v248, v248, v238
v_cvt_pk_bf16_f32 v72, v242, v248
v_lshlrev_b32 v242, 16, v73
v_and_b32 v248, 0xffff0000, v73
v_mul_f32 v242, v242, v238
v_mul_f32 v248, v248, v238
v_cvt_pk_bf16_f32 v73, v242, v248
v_lshlrev_b32 v242, 16, v74
v_and_b32 v248, 0xffff0000, v74
v_mul_f32 v242, v242, v238
v_mul_f32 v248, v248, v238
v_cvt_pk_bf16_f32 v74, v242, v248
v_lshlrev_b32 v242, 16, v75
v_and_b32 v248, 0xffff0000, v75
v_mul_f32 v242, v242, v238
v_mul_f32 v248, v248, v238
v_cvt_pk_bf16_f32 v75, v242, v248
v_lshlrev_b32 v242, 16, v168
v_and_b32 v248, 0xffff0000, v168
v_mul_f32 v242, v242, v238
v_mul_f32 v248, v248, v238
v_cvt_pk_bf16_f32 v168, v242, v248
v_lshlrev_b32 v242, 16, v169
v_and_b32 v248, 0xffff0000, v169
v_mul_f32 v242, v242, v238
v_mul_f32 v248, v248, v238
v_cvt_pk_bf16_f32 v169, v242, v248
v_lshlrev_b32 v242, 16, v170
v_and_b32 v248, 0xffff0000, v170
v_mul_f32 v242, v242, v238
v_mul_f32 v248, v248, v238
v_cvt_pk_bf16_f32 v170, v242, v248
v_lshlrev_b32 v242, 16, v171
v_and_b32 v248, 0xffff0000, v171
v_mul_f32 v242, v242, v238
v_mul_f32 v248, v248, v238
v_cvt_pk_bf16_f32 v171, v242, v248
v_lshlrev_b32 v242, 16, v184
v_and_b32 v248, 0xffff0000, v184
v_mul_f32 v242, v242, v238
v_mul_f32 v248, v248, v238
v_cvt_pk_bf16_f32 v184, v242, v248
v_lshlrev_b32 v242, 16, v185
v_and_b32 v248, 0xffff0000, v185
v_mul_f32 v242, v242, v238
v_mul_f32 v248, v248, v238
v_cvt_pk_bf16_f32 v185, v242, v248
v_lshlrev_b32 v242, 16, v186
v_and_b32 v248, 0xffff0000, v186
v_mul_f32 v242, v242, v238
v_mul_f32 v248, v248, v238
v_cvt_pk_bf16_f32 v186, v242, v248
v_lshlrev_b32 v242, 16, v187
v_and_b32 v248, 0xffff0000, v187
v_mul_f32 v242, v242, v238
v_mul_f32 v248, v248, v238
v_cvt_pk_bf16_f32 v187, v242, v248
v_exp_f32 v248, v140
s_nop 0
v_sub_f32 v227, v227, v248
v_exp_f32 v248, v141
s_nop 0
v_sub_f32 v227, v227, v248
v_exp_f32 v248, v142
s_nop 0
v_sub_f32 v227, v227, v248
v_exp_f32 v248, v143
s_nop 0
v_sub_f32 v227, v227, v248
v_max_f32 v227, 0, v227
v_min_f32 v227, s32, v227
v_log_f32 v248, v227
v_max3_f32 v235, v140, v141, v142
v_max3_f32 v235, v235, v143, v248
v_mov_b32 v248, v235
s_nop 1
v_permlane32_swap_b32 v235, v248
s_nop 1
v_max_f32 v235, v235, v248
v_mov_b32 v248, v235
s_nop 1
v_permlane16_swap_b32 v235, v248
s_nop 1
v_max_f32 v235, v235, v248
v_ceil_f32 v235, v235
v_max_f32 v235, 0, v235
v_sub_f32 v248, 0, v235
v_exp_f32 v239, v248
s_nop 1
v_mul_f32 v227, v227, v239
v_sub_f32 v204, v204, v235
v_sub_f32 v140, v140, v235
v_sub_f32 v156, v156, v235
v_sub_f32 v205, v205, v235
v_sub_f32 v141, v141, v235
v_sub_f32 v157, v157, v235
v_sub_f32 v206, v206, v235
v_sub_f32 v142, v142, v235
v_sub_f32 v158, v158, v235
v_sub_f32 v207, v207, v235
v_sub_f32 v143, v143, v235
v_sub_f32 v159, v159, v235
v_lshlrev_b32 v242, 16, v100
v_and_b32 v248, 0xffff0000, v100
v_mul_f32 v242, v242, v239
v_mul_f32 v248, v248, v239
v_cvt_pk_bf16_f32 v100, v242, v248
v_lshlrev_b32 v242, 16, v101
v_and_b32 v248, 0xffff0000, v101
v_mul_f32 v242, v242, v239
v_mul_f32 v248, v248, v239
v_cvt_pk_bf16_f32 v101, v242, v248
v_lshlrev_b32 v242, 16, v102
v_and_b32 v248, 0xffff0000, v102
v_mul_f32 v242, v242, v239
v_mul_f32 v248, v248, v239
v_cvt_pk_bf16_f32 v102, v242, v248
v_lshlrev_b32 v242, 16, v103
v_and_b32 v248, 0xffff0000, v103
v_mul_f32 v242, v242, v239
v_mul_f32 v248, v248, v239
v_cvt_pk_bf16_f32 v103, v242, v248
v_lshlrev_b32 v242, 16, v104
v_and_b32 v248, 0xffff0000, v104
v_mul_f32 v242, v242, v239
v_mul_f32 v248, v248, v239
v_cvt_pk_bf16_f32 v104, v242, v248
v_lshlrev_b32 v242, 16, v105
v_and_b32 v248, 0xffff0000, v105
v_mul_f32 v242, v242, v239
v_mul_f32 v248, v248, v239
v_cvt_pk_bf16_f32 v105, v242, v248
v_lshlrev_b32 v242, 16, v106
v_and_b32 v248, 0xffff0000, v106
v_mul_f32 v242, v242, v239
v_mul_f32 v248, v248, v239
v_cvt_pk_bf16_f32 v106, v242, v248
v_lshlrev_b32 v242, 16, v107
v_and_b32 v248, 0xffff0000, v107
v_mul_f32 v242, v242, v239
v_mul_f32 v248, v248, v239
v_cvt_pk_bf16_f32 v107, v242, v248
v_lshlrev_b32 v242, 16, v172
v_and_b32 v248, 0xffff0000, v172
v_mul_f32 v242, v242, v239
v_mul_f32 v248, v248, v239
v_cvt_pk_bf16_f32 v172, v242, v248
v_lshlrev_b32 v242, 16, v173
v_and_b32 v248, 0xffff0000, v173
v_mul_f32 v242, v242, v239
v_mul_f32 v248, v248, v239
v_cvt_pk_bf16_f32 v173, v242, v248
v_lshlrev_b32 v242, 16, v174
v_and_b32 v248, 0xffff0000, v174
v_mul_f32 v242, v242, v239
v_mul_f32 v248, v248, v239
v_cvt_pk_bf16_f32 v174, v242, v248
v_lshlrev_b32 v242, 16, v175
v_and_b32 v248, 0xffff0000, v175
v_mul_f32 v242, v242, v239
v_mul_f32 v248, v248, v239
v_cvt_pk_bf16_f32 v175, v242, v248
v_lshlrev_b32 v242, 16, v188
v_and_b32 v248, 0xffff0000, v188
v_mul_f32 v242, v242, v239
v_mul_f32 v248, v248, v239
v_cvt_pk_bf16_f32 v188, v242, v248
v_lshlrev_b32 v242, 16, v189
v_and_b32 v248, 0xffff0000, v189
v_mul_f32 v242, v242, v239
v_mul_f32 v248, v248, v239
v_cvt_pk_bf16_f32 v189, v242, v248
v_lshlrev_b32 v242, 16, v190
v_and_b32 v248, 0xffff0000, v190
v_mul_f32 v242, v242, v239
v_mul_f32 v248, v248, v239
v_cvt_pk_bf16_f32 v190, v242, v248
v_lshlrev_b32 v242, 16, v191
v_and_b32 v248, 0xffff0000, v191
v_mul_f32 v242, v242, v239
v_mul_f32 v248, v248, v239
v_cvt_pk_bf16_f32 v191, v242, v248
v_exp_f32 v232, v128
v_exp_f32 v233, v129
v_exp_f32 v234, v130
v_exp_f32 v235, v131
s_nop 1
v_add_f32 v224, v224, v232
v_add_f32 v224, v224, v233
v_add_f32 v224, v224, v234
v_add_f32 v224, v224, v235
v_cvt_pk_bf16_f32 v0, v232, v233
v_cvt_pk_bf16_f32 v1, v234, v235
v_exp_f32 v232, v132
v_exp_f32 v233, v133
v_exp_f32 v234, v134
v_exp_f32 v235, v135
s_nop 1
v_add_f32 v225, v225, v232
v_add_f32 v225, v225, v233
v_add_f32 v225, v225, v234
v_add_f32 v225, v225, v235
v_cvt_pk_bf16_f32 v32, v232, v233
v_cvt_pk_bf16_f32 v33, v234, v235
v_exp_f32 v232, v136
v_exp_f32 v233, v137
v_exp_f32 v234, v138
v_exp_f32 v235, v139
s_nop 1
v_add_f32 v226, v226, v232
v_add_f32 v226, v226, v233
v_add_f32 v226, v226, v234
v_add_f32 v226, v226, v235
v_cvt_pk_bf16_f32 v64, v232, v233
v_cvt_pk_bf16_f32 v65, v234, v235
v_exp_f32 v232, v140
v_exp_f32 v233, v141
v_exp_f32 v234, v142
v_exp_f32 v235, v143
s_nop 1
v_add_f32 v227, v227, v232
v_add_f32 v227, v227, v233
v_add_f32 v227, v227, v234
v_add_f32 v227, v227, v235
v_cvt_pk_bf16_f32 v96, v232, v233
v_cvt_pk_bf16_f32 v97, v234, v235
s_branch L2_rare_common
L2_rare_site17:
s_mov_b32 s36, 17
s_branch L2_rare_t0_5_1
L2_rare_t0_5_1:
s_nop 15
s_nop 15
s_waitcnt lgkmcnt(0)
v_exp_f32 v248, v144
s_nop 0
v_sub_f32 v224, v224, v248
v_exp_f32 v248, v145
s_nop 0
v_sub_f32 v224, v224, v248
v_exp_f32 v248, v146
s_nop 0
v_sub_f32 v224, v224, v248
v_exp_f32 v248, v147
s_nop 0
v_sub_f32 v224, v224, v248
v_max_f32 v224, 0, v224
v_min_f32 v224, s32, v224
v_log_f32 v248, v224
v_max3_f32 v232, v144, v145, v146
v_max3_f32 v232, v232, v147, v248
v_mov_b32 v248, v232
s_nop 1
v_permlane32_swap_b32 v232, v248
s_nop 1
v_max_f32 v232, v232, v248
v_mov_b32 v248, v232
s_nop 1
v_permlane16_swap_b32 v232, v248
s_nop 1
v_max_f32 v232, v232, v248
v_ceil_f32 v232, v232
v_max_f32 v232, 0, v232
v_sub_f32 v248, 0, v232
v_exp_f32 v236, v248
s_nop 1
v_mul_f32 v224, v224, v236
v_sub_f32 v192, v192, v232
v_sub_f32 v128, v128, v232
v_sub_f32 v144, v144, v232
v_sub_f32 v193, v193, v232
v_sub_f32 v129, v129, v232
v_sub_f32 v145, v145, v232
v_sub_f32 v194, v194, v232
v_sub_f32 v130, v130, v232
v_sub_f32 v146, v146, v232
v_sub_f32 v195, v195, v232
v_sub_f32 v131, v131, v232
v_sub_f32 v147, v147, v232
v_lshlrev_b32 v242, 16, v4
v_and_b32 v248, 0xffff0000, v4
v_mul_f32 v242, v242, v236
v_mul_f32 v248, v248, v236
v_cvt_pk_bf16_f32 v4, v242, v248
v_lshlrev_b32 v242, 16, v5
v_and_b32 v248, 0xffff0000, v5
v_mul_f32 v242, v242, v236
v_mul_f32 v248, v248, v236
v_cvt_pk_bf16_f32 v5, v242, v248
v_lshlrev_b32 v242, 16, v6
v_and_b32 v248, 0xffff0000, v6
v_mul_f32 v242, v242, v236
v_mul_f32 v248, v248, v236
v_cvt_pk_bf16_f32 v6, v242, v248
v_lshlrev_b32 v242, 16, v7
v_and_b32 v248, 0xffff0000, v7
v_mul_f32 v242, v242, v236
v_mul_f32 v248, v248, v236
v_cvt_pk_bf16_f32 v7, v242, v248
v_lshlrev_b32 v242, 16, v8
v_and_b32 v248, 0xffff0000, v8
v_mul_f32 v242, v242, v236
v_mul_f32 v248, v248, v236
v_cvt_pk_bf16_f32 v8, v242, v248
v_lshlrev_b32 v242, 16, v9
v_and_b32 v248, 0xffff0000, v9
v_mul_f32 v242, v242, v236
v_mul_f32 v248, v248, v236
v_cvt_pk_bf16_f32 v9, v242, v248
v_lshlrev_b32 v242, 16, v10
v_and_b32 v248, 0xffff0000, v10
v_mul_f32 v242, v242, v236
v_mul_f32 v248, v248, v236
v_cvt_pk_bf16_f32 v10, v242, v248
v_lshlrev_b32 v242, 16, v11
v_and_b32 v248, 0xffff0000, v11
v_mul_f32 v242, v242, v236
v_mul_f32 v248, v248, v236
v_cvt_pk_bf16_f32 v11, v242, v248
v_lshlrev_b32 v242, 16, v160
v_and_b32 v248, 0xffff0000, v160
v_mul_f32 v242, v242, v236
v_mul_f32 v248, v248, v236
v_cvt_pk_bf16_f32 v160, v242, v248
v_lshlrev_b32 v242, 16, v161
v_and_b32 v248, 0xffff0000, v161
v_mul_f32 v242, v242, v236
v_mul_f32 v248, v248, v236
v_cvt_pk_bf16_f32 v161, v242, v248
v_lshlrev_b32 v242, 16, v162
v_and_b32 v248, 0xffff0000, v162
v_mul_f32 v242, v242, v236
v_mul_f32 v248, v248, v236
v_cvt_pk_bf16_f32 v162, v242, v248
v_lshlrev_b32 v242, 16, v163
v_and_b32 v248, 0xffff0000, v163
v_mul_f32 v242, v242, v236
v_mul_f32 v248, v248, v236
v_cvt_pk_bf16_f32 v163, v242, v248
v_lshlrev_b32 v242, 16, v176
v_and_b32 v248, 0xffff0000, v176
v_mul_f32 v242, v242, v236
v_mul_f32 v248, v248, v236
v_cvt_pk_bf16_f32 v176, v242, v248
v_lshlrev_b32 v242, 16, v177
v_and_b32 v248, 0xffff0000, v177
v_mul_f32 v242, v242, v236
v_mul_f32 v248, v248, v236
v_cvt_pk_bf16_f32 v177, v242, v248
v_lshlrev_b32 v242, 16, v178
v_and_b32 v248, 0xffff0000, v178
v_mul_f32 v242, v242, v236
v_mul_f32 v248, v248, v236
v_cvt_pk_bf16_f32 v178, v242, v248
v_lshlrev_b32 v242, 16, v179
v_and_b32 v248, 0xffff0000, v179
v_mul_f32 v242, v242, v236
v_mul_f32 v248, v248, v236
v_cvt_pk_bf16_f32 v179, v242, v248
v_lshlrev_b32 v242, 16, v0
v_and_b32 v248, 0xffff0000, v0
v_mul_f32 v242, v242, v236
v_mul_f32 v248, v248, v236
v_cvt_pk_bf16_f32 v0, v242, v248
v_lshlrev_b32 v242, 16, v1
v_and_b32 v248, 0xffff0000, v1
v_mul_f32 v242, v242, v236
v_mul_f32 v248, v248, v236
v_cvt_pk_bf16_f32 v1, v242, v248
v_exp_f32 v248, v148
s_nop 0
v_sub_f32 v225, v225, v248
v_exp_f32 v248, v149
s_nop 0
v_sub_f32 v225, v225, v248
v_exp_f32 v248, v150
s_nop 0
v_sub_f32 v225, v225, v248
v_exp_f32 v248, v151
s_nop 0
v_sub_f32 v225, v225, v248
v_max_f32 v225, 0, v225
v_min_f32 v225, s32, v225
v_log_f32 v248, v225
v_max3_f32 v233, v148, v149, v150
v_max3_f32 v233, v233, v151, v248
v_mov_b32 v248, v233
s_nop 1
v_permlane32_swap_b32 v233, v248
s_nop 1
v_max_f32 v233, v233, v248
v_mov_b32 v248, v233
s_nop 1
v_permlane16_swap_b32 v233, v248
s_nop 1
v_max_f32 v233, v233, v248
v_ceil_f32 v233, v233
v_max_f32 v233, 0, v233
v_sub_f32 v248, 0, v233
v_exp_f32 v237, v248
s_nop 1
v_mul_f32 v225, v225, v237
v_sub_f32 v196, v196, v233
v_sub_f32 v132, v132, v233
v_sub_f32 v148, v148, v233
v_sub_f32 v197, v197, v233
v_sub_f32 v133, v133, v233
v_sub_f32 v149, v149, v233
v_sub_f32 v198, v198, v233
v_sub_f32 v134, v134, v233
v_sub_f32 v150, v150, v233
v_sub_f32 v199, v199, v233
v_sub_f32 v135, v135, v233
v_sub_f32 v151, v151, v233
v_lshlrev_b32 v242, 16, v36
v_and_b32 v248, 0xffff0000, v36
v_mul_f32 v242, v242, v237
v_mul_f32 v248, v248, v237
v_cvt_pk_bf16_f32 v36, v242, v248
v_lshlrev_b32 v242, 16, v37
v_and_b32 v248, 0xffff0000, v37
v_mul_f32 v242, v242, v237
v_mul_f32 v248, v248, v237
v_cvt_pk_bf16_f32 v37, v242, v248
v_lshlrev_b32 v242, 16, v38
v_and_b32 v248, 0xffff0000, v38
v_mul_f32 v242, v242, v237
v_mul_f32 v248, v248, v237
v_cvt_pk_bf16_f32 v38, v242, v248
v_lshlrev_b32 v242, 16, v39
v_and_b32 v248, 0xffff0000, v39
v_mul_f32 v242, v242, v237
v_mul_f32 v248, v248, v237
v_cvt_pk_bf16_f32 v39, v242, v248
v_lshlrev_b32 v242, 16, v40
v_and_b32 v248, 0xffff0000, v40
v_mul_f32 v242, v242, v237
v_mul_f32 v248, v248, v237
v_cvt_pk_bf16_f32 v40, v242, v248
v_lshlrev_b32 v242, 16, v41
v_and_b32 v248, 0xffff0000, v41
v_mul_f32 v242, v242, v237
v_mul_f32 v248, v248, v237
v_cvt_pk_bf16_f32 v41, v242, v248
v_lshlrev_b32 v242, 16, v42
v_and_b32 v248, 0xffff0000, v42
v_mul_f32 v242, v242, v237
v_mul_f32 v248, v248, v237
v_cvt_pk_bf16_f32 v42, v242, v248
v_lshlrev_b32 v242, 16, v43
v_and_b32 v248, 0xffff0000, v43
v_mul_f32 v242, v242, v237
v_mul_f32 v248, v248, v237
v_cvt_pk_bf16_f32 v43, v242, v248
v_lshlrev_b32 v242, 16, v164
v_and_b32 v248, 0xffff0000, v164
v_mul_f32 v242, v242, v237
v_mul_f32 v248, v248, v237
v_cvt_pk_bf16_f32 v164, v242, v248
v_lshlrev_b32 v242, 16, v165
v_and_b32 v248, 0xffff0000, v165
v_mul_f32 v242, v242, v237
v_mul_f32 v248, v248, v237
v_cvt_pk_bf16_f32 v165, v242, v248
v_lshlrev_b32 v242, 16, v166
v_and_b32 v248, 0xffff0000, v166
v_mul_f32 v242, v242, v237
v_mul_f32 v248, v248, v237
v_cvt_pk_bf16_f32 v166, v242, v248
v_lshlrev_b32 v242, 16, v167
v_and_b32 v248, 0xffff0000, v167
v_mul_f32 v242, v242, v237
v_mul_f32 v248, v248, v237
v_cvt_pk_bf16_f32 v167, v242, v248
v_lshlrev_b32 v242, 16, v180
v_and_b32 v248, 0xffff0000, v180
v_mul_f32 v242, v242, v237
v_mul_f32 v248, v248, v237
v_cvt_pk_bf16_f32 v180, v242, v248
v_lshlrev_b32 v242, 16, v181
v_and_b32 v248, 0xffff0000, v181
v_mul_f32 v242, v242, v237
v_mul_f32 v248, v248, v237
v_cvt_pk_bf16_f32 v181, v242, v248
v_lshlrev_b32 v242, 16, v182
v_and_b32 v248, 0xffff0000, v182
v_mul_f32 v242, v242, v237
v_mul_f32 v248, v248, v237
v_cvt_pk_bf16_f32 v182, v242, v248
v_lshlrev_b32 v242, 16, v183
v_and_b32 v248, 0xffff0000, v183
v_mul_f32 v242, v242, v237
v_mul_f32 v248, v248, v237
v_cvt_pk_bf16_f32 v183, v242, v248
v_lshlrev_b32 v242, 16, v32
v_and_b32 v248, 0xffff0000, v32
v_mul_f32 v242, v242, v237
v_mul_f32 v248, v248, v237
v_cvt_pk_bf16_f32 v32, v242, v248
v_lshlrev_b32 v242, 16, v33
v_and_b32 v248, 0xffff0000, v33
v_mul_f32 v242, v242, v237
v_mul_f32 v248, v248, v237
v_cvt_pk_bf16_f32 v33, v242, v248
v_exp_f32 v248, v152
s_nop 0
v_sub_f32 v226, v226, v248
v_exp_f32 v248, v153
s_nop 0
v_sub_f32 v226, v226, v248
v_exp_f32 v248, v154
s_nop 0
v_sub_f32 v226, v226, v248
v_exp_f32 v248, v155
s_nop 0
v_sub_f32 v226, v226, v248
v_max_f32 v226, 0, v226
v_min_f32 v226, s32, v226
v_log_f32 v248, v226
v_max3_f32 v234, v152, v153, v154
v_max3_f32 v234, v234, v155, v248
v_mov_b32 v248, v234
s_nop 1
v_permlane32_swap_b32 v234, v248
s_nop 1
v_max_f32 v234, v234, v248
v_mov_b32 v248, v234
s_nop 1
v_permlane16_swap_b32 v234, v248
s_nop 1
v_max_f32 v234, v234, v248
v_ceil_f32 v234, v234
v_max_f32 v234, 0, v234
v_sub_f32 v248, 0, v234
v_exp_f32 v238, v248
s_nop 1
v_mul_f32 v226, v226, v238
v_sub_f32 v200, v200, v234
v_sub_f32 v136, v136, v234
v_sub_f32 v152, v152, v234
v_sub_f32 v201, v201, v234
v_sub_f32 v137, v137, v234
v_sub_f32 v153, v153, v234
v_sub_f32 v202, v202, v234
v_sub_f32 v138, v138, v234
v_sub_f32 v154, v154, v234
v_sub_f32 v203, v203, v234
v_sub_f32 v139, v139, v234
v_sub_f32 v155, v155, v234
v_lshlrev_b32 v242, 16, v68
v_and_b32 v248, 0xffff0000, v68
v_mul_f32 v242, v242, v238
v_mul_f32 v248, v248, v238
v_cvt_pk_bf16_f32 v68, v242, v248
v_lshlrev_b32 v242, 16, v69
v_and_b32 v248, 0xffff0000, v69
v_mul_f32 v242, v242, v238
v_mul_f32 v248, v248, v238
v_cvt_pk_bf16_f32 v69, v242, v248
v_lshlrev_b32 v242, 16, v70
v_and_b32 v248, 0xffff0000, v70
v_mul_f32 v242, v242, v238
v_mul_f32 v248, v248, v238
v_cvt_pk_bf16_f32 v70, v242, v248
v_lshlrev_b32 v242, 16, v71
v_and_b32 v248, 0xffff0000, v71
v_mul_f32 v242, v242, v238
v_mul_f32 v248, v248, v238
v_cvt_pk_bf16_f32 v71, v242, v248
v_lshlrev_b32 v242, 16, v72
v_and_b32 v248, 0xffff0000, v72
v_mul_f32 v242, v242, v238
v_mul_f32 v248, v248, v238
v_cvt_pk_bf16_f32 v72, v242, v248
v_lshlrev_b32 v242, 16, v73
v_and_b32 v248, 0xffff0000, v73
v_mul_f32 v242, v242, v238
v_mul_f32 v248, v248, v238
v_cvt_pk_bf16_f32 v73, v242, v248
v_lshlrev_b32 v242, 16, v74
v_and_b32 v248, 0xffff0000, v74
v_mul_f32 v242, v242, v238
v_mul_f32 v248, v248, v238
v_cvt_pk_bf16_f32 v74, v242, v248
v_lshlrev_b32 v242, 16, v75
v_and_b32 v248, 0xffff0000, v75
v_mul_f32 v242, v242, v238
v_mul_f32 v248, v248, v238
v_cvt_pk_bf16_f32 v75, v242, v248
v_lshlrev_b32 v242, 16, v168
v_and_b32 v248, 0xffff0000, v168
v_mul_f32 v242, v242, v238
v_mul_f32 v248, v248, v238
v_cvt_pk_bf16_f32 v168, v242, v248
v_lshlrev_b32 v242, 16, v169
v_and_b32 v248, 0xffff0000, v169
v_mul_f32 v242, v242, v238
v_mul_f32 v248, v248, v238
v_cvt_pk_bf16_f32 v169, v242, v248
v_lshlrev_b32 v242, 16, v170
v_and_b32 v248, 0xffff0000, v170
v_mul_f32 v242, v242, v238
v_mul_f32 v248, v248, v238
v_cvt_pk_bf16_f32 v170, v242, v248
v_lshlrev_b32 v242, 16, v171
v_and_b32 v248, 0xffff0000, v171
v_mul_f32 v242, v242, v238
v_mul_f32 v248, v248, v238
v_cvt_pk_bf16_f32 v171, v242, v248
v_lshlrev_b32 v242, 16, v184
v_and_b32 v248, 0xffff0000, v184
v_mul_f32 v242, v242, v238
v_mul_f32 v248, v248, v238
v_cvt_pk_bf16_f32 v184, v242, v248
v_lshlrev_b32 v242, 16, v185
v_and_b32 v248, 0xffff0000, v185
v_mul_f32 v242, v242, v238
v_mul_f32 v248, v248, v238
v_cvt_pk_bf16_f32 v185, v242, v248
v_lshlrev_b32 v242, 16, v186
v_and_b32 v248, 0xffff0000, v186
v_mul_f32 v242, v242, v238
v_mul_f32 v248, v248, v238
v_cvt_pk_bf16_f32 v186, v242, v248
v_lshlrev_b32 v242, 16, v187
v_and_b32 v248, 0xffff0000, v187
v_mul_f32 v242, v242, v238
v_mul_f32 v248, v248, v238
v_cvt_pk_bf16_f32 v187, v242, v248
v_lshlrev_b32 v242, 16, v64
v_and_b32 v248, 0xffff0000, v64
v_mul_f32 v242, v242, v238
v_mul_f32 v248, v248, v238
v_cvt_pk_bf16_f32 v64, v242, v248
v_lshlrev_b32 v242, 16, v65
v_and_b32 v248, 0xffff0000, v65
v_mul_f32 v242, v242, v238
v_mul_f32 v248, v248, v238
v_cvt_pk_bf16_f32 v65, v242, v248
v_exp_f32 v248, v156
s_nop 0
v_sub_f32 v227, v227, v248
v_exp_f32 v248, v157
s_nop 0
v_sub_f32 v227, v227, v248
v_exp_f32 v248, v158
s_nop 0
v_sub_f32 v227, v227, v248
v_exp_f32 v248, v159
s_nop 0
v_sub_f32 v227, v227, v248
v_max_f32 v227, 0, v227
v_min_f32 v227, s32, v227
v_log_f32 v248, v227
v_max3_f32 v235, v156, v157, v158
v_max3_f32 v235, v235, v159, v248
v_mov_b32 v248, v235
s_nop 1
v_permlane32_swap_b32 v235, v248
s_nop 1
v_max_f32 v235, v235, v248
v_mov_b32 v248, v235
s_nop 1
v_permlane16_swap_b32 v235, v248
s_nop 1
v_max_f32 v235, v235, v248
v_ceil_f32 v235, v235
v_max_f32 v235, 0, v235
v_sub_f32 v248, 0, v235
v_exp_f32 v239, v248
s_nop 1
v_mul_f32 v227, v227, v239
v_sub_f32 v204, v204, v235
v_sub_f32 v140, v140, v235
v_sub_f32 v156, v156, v235
v_sub_f32 v205, v205, v235
v_sub_f32 v141, v141, v235
v_sub_f32 v157, v157, v235
v_sub_f32 v206, v206, v235
v_sub_f32 v142, v142, v235
v_sub_f32 v158, v158, v235
v_sub_f32 v207, v207, v235
v_sub_f32 v143, v143, v235
v_sub_f32 v159, v159, v235
v_lshlrev_b32 v242, 16, v100
v_and_b32 v248, 0xffff0000, v100
v_mul_f32 v242, v242, v239
v_mul_f32 v248, v248, v239
v_cvt_pk_bf16_f32 v100, v242, v248
v_lshlrev_b32 v242, 16, v101
v_and_b32 v248, 0xffff0000, v101
v_mul_f32 v242, v242, v239
v_mul_f32 v248, v248, v239
v_cvt_pk_bf16_f32 v101, v242, v248
v_lshlrev_b32 v242, 16, v102
v_and_b32 v248, 0xffff0000, v102
v_mul_f32 v242, v242, v239
v_mul_f32 v248, v248, v239
v_cvt_pk_bf16_f32 v102, v242, v248
v_lshlrev_b32 v242, 16, v103
v_and_b32 v248, 0xffff0000, v103
v_mul_f32 v242, v242, v239
v_mul_f32 v248, v248, v239
v_cvt_pk_bf16_f32 v103, v242, v248
v_lshlrev_b32 v242, 16, v104
v_and_b32 v248, 0xffff0000, v104
v_mul_f32 v242, v242, v239
v_mul_f32 v248, v248, v239
v_cvt_pk_bf16_f32 v104, v242, v248
v_lshlrev_b32 v242, 16, v105
v_and_b32 v248, 0xffff0000, v105
v_mul_f32 v242, v242, v239
v_mul_f32 v248, v248, v239
v_cvt_pk_bf16_f32 v105, v242, v248
v_lshlrev_b32 v242, 16, v106
v_and_b32 v248, 0xffff0000, v106
v_mul_f32 v242, v242, v239
v_mul_f32 v248, v248, v239
v_cvt_pk_bf16_f32 v106, v242, v248
v_lshlrev_b32 v242, 16, v107
v_and_b32 v248, 0xffff0000, v107
v_mul_f32 v242, v242, v239
v_mul_f32 v248, v248, v239
v_cvt_pk_bf16_f32 v107, v242, v248
v_lshlrev_b32 v242, 16, v172
v_and_b32 v248, 0xffff0000, v172
v_mul_f32 v242, v242, v239
v_mul_f32 v248, v248, v239
v_cvt_pk_bf16_f32 v172, v242, v248
v_lshlrev_b32 v242, 16, v173
v_and_b32 v248, 0xffff0000, v173
v_mul_f32 v242, v242, v239
v_mul_f32 v248, v248, v239
v_cvt_pk_bf16_f32 v173, v242, v248
v_lshlrev_b32 v242, 16, v174
v_and_b32 v248, 0xffff0000, v174
v_mul_f32 v242, v242, v239
v_mul_f32 v248, v248, v239
v_cvt_pk_bf16_f32 v174, v242, v248
v_lshlrev_b32 v242, 16, v175
v_and_b32 v248, 0xffff0000, v175
v_mul_f32 v242, v242, v239
v_mul_f32 v248, v248, v239
v_cvt_pk_bf16_f32 v175, v242, v248
v_lshlrev_b32 v242, 16, v188
v_and_b32 v248, 0xffff0000, v188
v_mul_f32 v242, v242, v239
v_mul_f32 v248, v248, v239
v_cvt_pk_bf16_f32 v188, v242, v248
v_lshlrev_b32 v242, 16, v189
v_and_b32 v248, 0xffff0000, v189
v_mul_f32 v242, v242, v239
v_mul_f32 v248, v248, v239
v_cvt_pk_bf16_f32 v189, v242, v248
v_lshlrev_b32 v242, 16, v190
v_and_b32 v248, 0xffff0000, v190
v_mul_f32 v242, v242, v239
v_mul_f32 v248, v248, v239
v_cvt_pk_bf16_f32 v190, v242, v248
v_lshlrev_b32 v242, 16, v191
v_and_b32 v248, 0xffff0000, v191
v_mul_f32 v242, v242, v239
v_mul_f32 v248, v248, v239
v_cvt_pk_bf16_f32 v191, v242, v248
v_lshlrev_b32 v242, 16, v96
v_and_b32 v248, 0xffff0000, v96
v_mul_f32 v242, v242, v239
v_mul_f32 v248, v248, v239
v_cvt_pk_bf16_f32 v96, v242, v248
v_lshlrev_b32 v242, 16, v97
v_and_b32 v248, 0xffff0000, v97
v_mul_f32 v242, v242, v239
v_mul_f32 v248, v248, v239
v_cvt_pk_bf16_f32 v97, v242, v248
v_exp_f32 v232, v144
v_exp_f32 v233, v145
v_exp_f32 v234, v146
v_exp_f32 v235, v147
s_nop 1
v_add_f32 v224, v224, v232
v_add_f32 v224, v224, v233
v_add_f32 v224, v224, v234
v_add_f32 v224, v224, v235
v_cvt_pk_bf16_f32 v2, v232, v233
v_cvt_pk_bf16_f32 v3, v234, v235
v_exp_f32 v232, v148
v_exp_f32 v233, v149
v_exp_f32 v234, v150
v_exp_f32 v235, v151
s_nop 1
v_add_f32 v225, v225, v232
v_add_f32 v225, v225, v233
v_add_f32 v225, v225, v234
v_add_f32 v225, v225, v235
v_cvt_pk_bf16_f32 v34, v232, v233
v_cvt_pk_bf16_f32 v35, v234, v235
v_exp_f32 v232, v152
v_exp_f32 v233, v153
v_exp_f32 v234, v154
v_exp_f32 v235, v155
s_nop 1
v_add_f32 v226, v226, v232
v_add_f32 v226, v226, v233
v_add_f32 v226, v226, v234
v_add_f32 v226, v226, v235
v_cvt_pk_bf16_f32 v66, v232, v233
v_cvt_pk_bf16_f32 v67, v234, v235
v_exp_f32 v232, v156
v_exp_f32 v233, v157
v_exp_f32 v234, v158
v_exp_f32 v235, v159
s_nop 1
v_add_f32 v227, v227, v232
v_add_f32 v227, v227, v233
v_add_f32 v227, v227, v234
v_add_f32 v227, v227, v235
v_cvt_pk_bf16_f32 v98, v232, v233
v_cvt_pk_bf16_f32 v99, v234, v235
s_branch L2_rare_common
LF_hl_0:
s_mov_b32 s94, 0x10000
s_mov_b32 s3, 0x7c28000
LF_hl2_0:
v_lshlrev_b32 v241, 3, v243
buffer_load_dwordx2 v[240:241], v241, s[16:19], s3 offen sc1
s_sub_u32 s94, s94, 1
s_waitcnt vmcnt(0)
s_cbranch_scc1 LF_hlret_0
v_cmp_ne_u64_e64 s[38:39], s[98:99], v[240:241]
s_and_b64 s[38:39], s[38:39], s[96:97]
s_cbranch_scc1 LF_hl2_0
s_branch LF_hlret_0
L2_rare_common:
v_lshrrev_b32 v232, 4, v243
v_and_b32 v232, 0x30, v232
ds_bpermute_b32 v242, v232, v236 offset:0
ds_bpermute_b32 v248, v232, v236 offset:4
ds_bpermute_b32 v250, v232, v236 offset:8
ds_bpermute_b32 v251, v232, v236 offset:12
s_waitcnt lgkmcnt(0)
v_accvgpr_read_b32 v232, a0
v_accvgpr_read_b32 v233, a1
v_accvgpr_read_b32 v234, a2
v_accvgpr_read_b32 v235, a3
v_mul_f32 v232, v232, v242
v_mul_f32 v233, v233, v248
v_mul_f32 v234, v234, v250
v_mul_f32 v235, v235, v251
v_accvgpr_write_b32 a0, v232
v_accvgpr_write_b32 a1, v233
v_accvgpr_write_b32 a2, v234
v_accvgpr_write_b32 a3, v235
v_accvgpr_read_b32 v232, a16
v_accvgpr_read_b32 v233, a17
v_accvgpr_read_b32 v234, a18
v_accvgpr_read_b32 v235, a19
v_mul_f32 v232, v232, v242
v_mul_f32 v233, v233, v248
v_mul_f32 v234, v234, v250
v_mul_f32 v235, v235, v251
v_accvgpr_write_b32 a16, v232
v_accvgpr_write_b32 a17, v233
v_accvgpr_write_b32 a18, v234
v_accvgpr_write_b32 a19, v235
v_accvgpr_read_b32 v232, a32
v_accvgpr_read_b32 v233, a33
v_accvgpr_read_b32 v234, a34
v_accvgpr_read_b32 v235, a35
v_mul_f32 v232, v232, v242
v_mul_f32 v233, v233, v248
v_mul_f32 v234, v234, v250
v_mul_f32 v235, v235, v251
v_accvgpr_write_b32 a32, v232
v_accvgpr_write_b32 a33, v233
v_accvgpr_write_b32 a34, v234
v_accvgpr_write_b32 a35, v235
v_accvgpr_read_b32 v232, a48
v_accvgpr_read_b32 v233, a49
v_accvgpr_read_b32 v234, a50
v_accvgpr_read_b32 v235, a51
v_mul_f32 v232, v232, v242
v_mul_f32 v233, v233, v248
v_mul_f32 v234, v234, v250
v_mul_f32 v235, v235, v251
v_accvgpr_write_b32 a48, v232
v_accvgpr_write_b32 a49, v233
v_accvgpr_write_b32 a50, v234
v_accvgpr_write_b32 a51, v235
v_accvgpr_read_b32 v232, a64
v_accvgpr_read_b32 v233, a65
v_accvgpr_read_b32 v234, a66
v_accvgpr_read_b32 v235, a67
v_mul_f32 v232, v232, v242
v_mul_f32 v233, v233, v248
v_mul_f32 v234, v234, v250
v_mul_f32 v235, v235, v251
v_accvgpr_write_b32 a64, v232
v_accvgpr_write_b32 a65, v233
v_accvgpr_write_b32 a66, v234
v_accvgpr_write_b32 a67, v235
v_accvgpr_read_b32 v232, a80
v_accvgpr_read_b32 v233, a81
v_accvgpr_read_b32 v234, a82
v_accvgpr_read_b32 v235, a83
v_mul_f32 v232, v232, v242
v_mul_f32 v233, v233, v248
v_mul_f32 v234, v234, v250
v_mul_f32 v235, v235, v251
v_accvgpr_write_b32 a80, v232
v_accvgpr_write_b32 a81, v233
v_accvgpr_write_b32 a82, v234
v_accvgpr_write_b32 a83, v235
v_accvgpr_read_b32 v232, a96
v_accvgpr_read_b32 v233, a97
v_accvgpr_read_b32 v234, a98
v_accvgpr_read_b32 v235, a99
v_mul_f32 v232, v232, v242
v_mul_f32 v233, v233, v248
v_mul_f32 v234, v234, v250
v_mul_f32 v235, v235, v251
v_accvgpr_write_b32 a96, v232
v_accvgpr_write_b32 a97, v233
v_accvgpr_write_b32 a98, v234
v_accvgpr_write_b32 a99, v235
v_accvgpr_read_b32 v232, a112
v_accvgpr_read_b32 v233, a113
v_accvgpr_read_b32 v234, a114
v_accvgpr_read_b32 v235, a115
v_mul_f32 v232, v232, v242
v_mul_f32 v233, v233, v248
v_mul_f32 v234, v234, v250
v_mul_f32 v235, v235, v251
v_accvgpr_write_b32 a112, v232
v_accvgpr_write_b32 a113, v233
v_accvgpr_write_b32 a114, v234
v_accvgpr_write_b32 a115, v235
v_accvgpr_read_b32 v232, a128
v_accvgpr_read_b32 v233, a129
v_accvgpr_read_b32 v234, a130
v_accvgpr_read_b32 v235, a131
v_mul_f32 v232, v232, v242
v_mul_f32 v233, v233, v248
v_mul_f32 v234, v234, v250
v_mul_f32 v235, v235, v251
v_accvgpr_write_b32 a128, v232
v_accvgpr_write_b32 a129, v233
v_accvgpr_write_b32 a130, v234
v_accvgpr_write_b32 a131, v235
v_accvgpr_read_b32 v232, a144
v_accvgpr_read_b32 v233, a145
v_accvgpr_read_b32 v234, a146
v_accvgpr_read_b32 v235, a147
v_mul_f32 v232, v232, v242
v_mul_f32 v233, v233, v248
v_mul_f32 v234, v234, v250
v_mul_f32 v235, v235, v251
v_accvgpr_write_b32 a144, v232
v_accvgpr_write_b32 a145, v233
v_accvgpr_write_b32 a146, v234
v_accvgpr_write_b32 a147, v235
v_accvgpr_read_b32 v232, a160
v_accvgpr_read_b32 v233, a161
v_accvgpr_read_b32 v234, a162
v_accvgpr_read_b32 v235, a163
v_mul_f32 v232, v232, v242
v_mul_f32 v233, v233, v248
v_mul_f32 v234, v234, v250
v_mul_f32 v235, v235, v251
v_accvgpr_write_b32 a160, v232
v_accvgpr_write_b32 a161, v233
v_accvgpr_write_b32 a162, v234
v_accvgpr_write_b32 a163, v235
v_accvgpr_read_b32 v232, a176
v_accvgpr_read_b32 v233, a177
v_accvgpr_read_b32 v234, a178
v_accvgpr_read_b32 v235, a179
v_mul_f32 v232, v232, v242
v_mul_f32 v233, v233, v248
v_mul_f32 v234, v234, v250
v_mul_f32 v235, v235, v251
v_accvgpr_write_b32 a176, v232
v_accvgpr_write_b32 a177, v233
v_accvgpr_write_b32 a178, v234
v_accvgpr_write_b32 a179, v235
v_accvgpr_read_b32 v232, a192
v_accvgpr_read_b32 v233, a193
v_accvgpr_read_b32 v234, a194
v_accvgpr_read_b32 v235, a195
v_mul_f32 v232, v232, v242
v_mul_f32 v233, v233, v248
v_mul_f32 v234, v234, v250
v_mul_f32 v235, v235, v251
v_accvgpr_write_b32 a192, v232
v_accvgpr_write_b32 a193, v233
v_accvgpr_write_b32 a194, v234
v_accvgpr_write_b32 a195, v235
v_accvgpr_read_b32 v232, a208
v_accvgpr_read_b32 v233, a209
v_accvgpr_read_b32 v234, a210
v_accvgpr_read_b32 v235, a211
v_mul_f32 v232, v232, v242
v_mul_f32 v233, v233, v248
v_mul_f32 v234, v234, v250
v_mul_f32 v235, v235, v251
v_accvgpr_write_b32 a208, v232
v_accvgpr_write_b32 a209, v233
v_accvgpr_write_b32 a210, v234
v_accvgpr_write_b32 a211, v235
v_accvgpr_read_b32 v232, a224
v_accvgpr_read_b32 v233, a225
v_accvgpr_read_b32 v234, a226
v_accvgpr_read_b32 v235, a227
v_mul_f32 v232, v232, v242
v_mul_f32 v233, v233, v248
v_mul_f32 v234, v234, v250
v_mul_f32 v235, v235, v251
v_accvgpr_write_b32 a224, v232
v_accvgpr_write_b32 a225, v233
v_accvgpr_write_b32 a226, v234
v_accvgpr_write_b32 a227, v235
v_accvgpr_read_b32 v232, a240
v_accvgpr_read_b32 v233, a241
v_accvgpr_read_b32 v234, a242
v_accvgpr_read_b32 v235, a243
v_mul_f32 v232, v232, v242
v_mul_f32 v233, v233, v248
v_mul_f32 v234, v234, v250
v_mul_f32 v235, v235, v251
v_accvgpr_write_b32 a240, v232
v_accvgpr_write_b32 a241, v233
v_accvgpr_write_b32 a242, v234
v_accvgpr_write_b32 a243, v235
v_lshrrev_b32 v232, 4, v243
v_and_b32 v232, 0x30, v232
ds_bpermute_b32 v242, v232, v237 offset:0
ds_bpermute_b32 v248, v232, v237 offset:4
ds_bpermute_b32 v250, v232, v237 offset:8
ds_bpermute_b32 v251, v232, v237 offset:12
s_waitcnt lgkmcnt(0)
v_accvgpr_read_b32 v232, a4
v_accvgpr_read_b32 v233, a5
v_accvgpr_read_b32 v234, a6
v_accvgpr_read_b32 v235, a7
v_mul_f32 v232, v232, v242
v_mul_f32 v233, v233, v248
v_mul_f32 v234, v234, v250
v_mul_f32 v235, v235, v251
v_accvgpr_write_b32 a4, v232
v_accvgpr_write_b32 a5, v233
v_accvgpr_write_b32 a6, v234
v_accvgpr_write_b32 a7, v235
v_accvgpr_read_b32 v232, a20
v_accvgpr_read_b32 v233, a21
v_accvgpr_read_b32 v234, a22
v_accvgpr_read_b32 v235, a23
v_mul_f32 v232, v232, v242
v_mul_f32 v233, v233, v248
v_mul_f32 v234, v234, v250
v_mul_f32 v235, v235, v251
v_accvgpr_write_b32 a20, v232
v_accvgpr_write_b32 a21, v233
v_accvgpr_write_b32 a22, v234
v_accvgpr_write_b32 a23, v235
v_accvgpr_read_b32 v232, a36
v_accvgpr_read_b32 v233, a37
v_accvgpr_read_b32 v234, a38
v_accvgpr_read_b32 v235, a39
v_mul_f32 v232, v232, v242
v_mul_f32 v233, v233, v248
v_mul_f32 v234, v234, v250
v_mul_f32 v235, v235, v251
v_accvgpr_write_b32 a36, v232
v_accvgpr_write_b32 a37, v233
v_accvgpr_write_b32 a38, v234
v_accvgpr_write_b32 a39, v235
v_accvgpr_read_b32 v232, a52
v_accvgpr_read_b32 v233, a53
v_accvgpr_read_b32 v234, a54
v_accvgpr_read_b32 v235, a55
v_mul_f32 v232, v232, v242
v_mul_f32 v233, v233, v248
v_mul_f32 v234, v234, v250
v_mul_f32 v235, v235, v251
v_accvgpr_write_b32 a52, v232
v_accvgpr_write_b32 a53, v233
v_accvgpr_write_b32 a54, v234
v_accvgpr_write_b32 a55, v235
v_accvgpr_read_b32 v232, a68
v_accvgpr_read_b32 v233, a69
v_accvgpr_read_b32 v234, a70
v_accvgpr_read_b32 v235, a71
v_mul_f32 v232, v232, v242
v_mul_f32 v233, v233, v248
v_mul_f32 v234, v234, v250
v_mul_f32 v235, v235, v251
v_accvgpr_write_b32 a68, v232
v_accvgpr_write_b32 a69, v233
v_accvgpr_write_b32 a70, v234
v_accvgpr_write_b32 a71, v235
v_accvgpr_read_b32 v232, a84
v_accvgpr_read_b32 v233, a85
v_accvgpr_read_b32 v234, a86
v_accvgpr_read_b32 v235, a87
v_mul_f32 v232, v232, v242
v_mul_f32 v233, v233, v248
v_mul_f32 v234, v234, v250
v_mul_f32 v235, v235, v251
v_accvgpr_write_b32 a84, v232
v_accvgpr_write_b32 a85, v233
v_accvgpr_write_b32 a86, v234
v_accvgpr_write_b32 a87, v235
v_accvgpr_read_b32 v232, a100
v_accvgpr_read_b32 v233, a101
v_accvgpr_read_b32 v234, a102
v_accvgpr_read_b32 v235, a103
v_mul_f32 v232, v232, v242
v_mul_f32 v233, v233, v248
v_mul_f32 v234, v234, v250
v_mul_f32 v235, v235, v251
v_accvgpr_write_b32 a100, v232
v_accvgpr_write_b32 a101, v233
v_accvgpr_write_b32 a102, v234
v_accvgpr_write_b32 a103, v235
v_accvgpr_read_b32 v232, a116
v_accvgpr_read_b32 v233, a117
v_accvgpr_read_b32 v234, a118
v_accvgpr_read_b32 v235, a119
v_mul_f32 v232, v232, v242
v_mul_f32 v233, v233, v248
v_mul_f32 v234, v234, v250
v_mul_f32 v235, v235, v251
v_accvgpr_write_b32 a116, v232
v_accvgpr_write_b32 a117, v233
v_accvgpr_write_b32 a118, v234
v_accvgpr_write_b32 a119, v235
v_accvgpr_read_b32 v232, a132
v_accvgpr_read_b32 v233, a133
v_accvgpr_read_b32 v234, a134
v_accvgpr_read_b32 v235, a135
v_mul_f32 v232, v232, v242
v_mul_f32 v233, v233, v248
v_mul_f32 v234, v234, v250
v_mul_f32 v235, v235, v251
v_accvgpr_write_b32 a132, v232
v_accvgpr_write_b32 a133, v233
v_accvgpr_write_b32 a134, v234
v_accvgpr_write_b32 a135, v235
v_accvgpr_read_b32 v232, a148
v_accvgpr_read_b32 v233, a149
v_accvgpr_read_b32 v234, a150
v_accvgpr_read_b32 v235, a151
v_mul_f32 v232, v232, v242
v_mul_f32 v233, v233, v248
v_mul_f32 v234, v234, v250
v_mul_f32 v235, v235, v251
v_accvgpr_write_b32 a148, v232
v_accvgpr_write_b32 a149, v233
v_accvgpr_write_b32 a150, v234
v_accvgpr_write_b32 a151, v235
v_accvgpr_read_b32 v232, a164
v_accvgpr_read_b32 v233, a165
v_accvgpr_read_b32 v234, a166
v_accvgpr_read_b32 v235, a167
v_mul_f32 v232, v232, v242
v_mul_f32 v233, v233, v248
v_mul_f32 v234, v234, v250
v_mul_f32 v235, v235, v251
v_accvgpr_write_b32 a164, v232
v_accvgpr_write_b32 a165, v233
v_accvgpr_write_b32 a166, v234
v_accvgpr_write_b32 a167, v235
v_accvgpr_read_b32 v232, a180
v_accvgpr_read_b32 v233, a181
v_accvgpr_read_b32 v234, a182
v_accvgpr_read_b32 v235, a183
v_mul_f32 v232, v232, v242
v_mul_f32 v233, v233, v248
v_mul_f32 v234, v234, v250
v_mul_f32 v235, v235, v251
v_accvgpr_write_b32 a180, v232
v_accvgpr_write_b32 a181, v233
v_accvgpr_write_b32 a182, v234
v_accvgpr_write_b32 a183, v235
v_accvgpr_read_b32 v232, a196
v_accvgpr_read_b32 v233, a197
v_accvgpr_read_b32 v234, a198
v_accvgpr_read_b32 v235, a199
v_mul_f32 v232, v232, v242
v_mul_f32 v233, v233, v248
v_mul_f32 v234, v234, v250
v_mul_f32 v235, v235, v251
v_accvgpr_write_b32 a196, v232
v_accvgpr_write_b32 a197, v233
v_accvgpr_write_b32 a198, v234
v_accvgpr_write_b32 a199, v235
v_accvgpr_read_b32 v232, a212
v_accvgpr_read_b32 v233, a213
v_accvgpr_read_b32 v234, a214
v_accvgpr_read_b32 v235, a215
v_mul_f32 v232, v232, v242
v_mul_f32 v233, v233, v248
v_mul_f32 v234, v234, v250
v_mul_f32 v235, v235, v251
v_accvgpr_write_b32 a212, v232
v_accvgpr_write_b32 a213, v233
v_accvgpr_write_b32 a214, v234
v_accvgpr_write_b32 a215, v235
v_accvgpr_read_b32 v232, a228
v_accvgpr_read_b32 v233, a229
v_accvgpr_read_b32 v234, a230
v_accvgpr_read_b32 v235, a231
v_mul_f32 v232, v232, v242
v_mul_f32 v233, v233, v248
v_mul_f32 v234, v234, v250
v_mul_f32 v235, v235, v251
v_accvgpr_write_b32 a228, v232
v_accvgpr_write_b32 a229, v233
v_accvgpr_write_b32 a230, v234
v_accvgpr_write_b32 a231, v235
v_accvgpr_read_b32 v232, a244
v_accvgpr_read_b32 v233, a245
v_accvgpr_read_b32 v234, a246
v_accvgpr_read_b32 v235, a247
v_mul_f32 v232, v232, v242
v_mul_f32 v233, v233, v248
v_mul_f32 v234, v234, v250
v_mul_f32 v235, v235, v251
v_accvgpr_write_b32 a244, v232
v_accvgpr_write_b32 a245, v233
v_accvgpr_write_b32 a246, v234
v_accvgpr_write_b32 a247, v235
v_lshrrev_b32 v232, 4, v243
v_and_b32 v232, 0x30, v232
ds_bpermute_b32 v242, v232, v238 offset:0
ds_bpermute_b32 v248, v232, v238 offset:4
ds_bpermute_b32 v250, v232, v238 offset:8
ds_bpermute_b32 v251, v232, v238 offset:12
s_waitcnt lgkmcnt(0)
v_accvgpr_read_b32 v232, a8
v_accvgpr_read_b32 v233, a9
v_accvgpr_read_b32 v234, a10
v_accvgpr_read_b32 v235, a11
v_mul_f32 v232, v232, v242
v_mul_f32 v233, v233, v248
v_mul_f32 v234, v234, v250
v_mul_f32 v235, v235, v251
v_accvgpr_write_b32 a8, v232
v_accvgpr_write_b32 a9, v233
v_accvgpr_write_b32 a10, v234
v_accvgpr_write_b32 a11, v235
v_accvgpr_read_b32 v232, a24
v_accvgpr_read_b32 v233, a25
v_accvgpr_read_b32 v234, a26
v_accvgpr_read_b32 v235, a27
v_mul_f32 v232, v232, v242
v_mul_f32 v233, v233, v248
v_mul_f32 v234, v234, v250
v_mul_f32 v235, v235, v251
v_accvgpr_write_b32 a24, v232
v_accvgpr_write_b32 a25, v233
v_accvgpr_write_b32 a26, v234
v_accvgpr_write_b32 a27, v235
v_accvgpr_read_b32 v232, a40
v_accvgpr_read_b32 v233, a41
v_accvgpr_read_b32 v234, a42
v_accvgpr_read_b32 v235, a43
v_mul_f32 v232, v232, v242
v_mul_f32 v233, v233, v248
v_mul_f32 v234, v234, v250
v_mul_f32 v235, v235, v251
v_accvgpr_write_b32 a40, v232
v_accvgpr_write_b32 a41, v233
v_accvgpr_write_b32 a42, v234
v_accvgpr_write_b32 a43, v235
v_accvgpr_read_b32 v232, a56
v_accvgpr_read_b32 v233, a57
v_accvgpr_read_b32 v234, a58
v_accvgpr_read_b32 v235, a59
v_mul_f32 v232, v232, v242
v_mul_f32 v233, v233, v248
v_mul_f32 v234, v234, v250
v_mul_f32 v235, v235, v251
v_accvgpr_write_b32 a56, v232
v_accvgpr_write_b32 a57, v233
v_accvgpr_write_b32 a58, v234
v_accvgpr_write_b32 a59, v235
v_accvgpr_read_b32 v232, a72
v_accvgpr_read_b32 v233, a73
v_accvgpr_read_b32 v234, a74
v_accvgpr_read_b32 v235, a75
v_mul_f32 v232, v232, v242
v_mul_f32 v233, v233, v248
v_mul_f32 v234, v234, v250
v_mul_f32 v235, v235, v251
v_accvgpr_write_b32 a72, v232
v_accvgpr_write_b32 a73, v233
v_accvgpr_write_b32 a74, v234
v_accvgpr_write_b32 a75, v235
v_accvgpr_read_b32 v232, a88
v_accvgpr_read_b32 v233, a89
v_accvgpr_read_b32 v234, a90
v_accvgpr_read_b32 v235, a91
v_mul_f32 v232, v232, v242
v_mul_f32 v233, v233, v248
v_mul_f32 v234, v234, v250
v_mul_f32 v235, v235, v251
v_accvgpr_write_b32 a88, v232
v_accvgpr_write_b32 a89, v233
v_accvgpr_write_b32 a90, v234
v_accvgpr_write_b32 a91, v235
v_accvgpr_read_b32 v232, a104
v_accvgpr_read_b32 v233, a105
v_accvgpr_read_b32 v234, a106
v_accvgpr_read_b32 v235, a107
v_mul_f32 v232, v232, v242
v_mul_f32 v233, v233, v248
v_mul_f32 v234, v234, v250
v_mul_f32 v235, v235, v251
v_accvgpr_write_b32 a104, v232
v_accvgpr_write_b32 a105, v233
v_accvgpr_write_b32 a106, v234
v_accvgpr_write_b32 a107, v235
v_accvgpr_read_b32 v232, a120
v_accvgpr_read_b32 v233, a121
v_accvgpr_read_b32 v234, a122
v_accvgpr_read_b32 v235, a123
v_mul_f32 v232, v232, v242
v_mul_f32 v233, v233, v248
v_mul_f32 v234, v234, v250
v_mul_f32 v235, v235, v251
v_accvgpr_write_b32 a120, v232
v_accvgpr_write_b32 a121, v233
v_accvgpr_write_b32 a122, v234
v_accvgpr_write_b32 a123, v235
v_accvgpr_read_b32 v232, a136
v_accvgpr_read_b32 v233, a137
v_accvgpr_read_b32 v234, a138
v_accvgpr_read_b32 v235, a139
v_mul_f32 v232, v232, v242
v_mul_f32 v233, v233, v248
v_mul_f32 v234, v234, v250
v_mul_f32 v235, v235, v251
v_accvgpr_write_b32 a136, v232
v_accvgpr_write_b32 a137, v233
v_accvgpr_write_b32 a138, v234
v_accvgpr_write_b32 a139, v235
v_accvgpr_read_b32 v232, a152
v_accvgpr_read_b32 v233, a153
v_accvgpr_read_b32 v234, a154
v_accvgpr_read_b32 v235, a155
v_mul_f32 v232, v232, v242
v_mul_f32 v233, v233, v248
v_mul_f32 v234, v234, v250
v_mul_f32 v235, v235, v251
v_accvgpr_write_b32 a152, v232
v_accvgpr_write_b32 a153, v233
v_accvgpr_write_b32 a154, v234
v_accvgpr_write_b32 a155, v235
v_accvgpr_read_b32 v232, a168
v_accvgpr_read_b32 v233, a169
v_accvgpr_read_b32 v234, a170
v_accvgpr_read_b32 v235, a171
v_mul_f32 v232, v232, v242
v_mul_f32 v233, v233, v248
v_mul_f32 v234, v234, v250
v_mul_f32 v235, v235, v251
v_accvgpr_write_b32 a168, v232
v_accvgpr_write_b32 a169, v233
v_accvgpr_write_b32 a170, v234
v_accvgpr_write_b32 a171, v235
v_accvgpr_read_b32 v232, a184
v_accvgpr_read_b32 v233, a185
v_accvgpr_read_b32 v234, a186
v_accvgpr_read_b32 v235, a187
v_mul_f32 v232, v232, v242
v_mul_f32 v233, v233, v248
v_mul_f32 v234, v234, v250
v_mul_f32 v235, v235, v251
v_accvgpr_write_b32 a184, v232
v_accvgpr_write_b32 a185, v233
v_accvgpr_write_b32 a186, v234
v_accvgpr_write_b32 a187, v235
v_accvgpr_read_b32 v232, a200
v_accvgpr_read_b32 v233, a201
v_accvgpr_read_b32 v234, a202
v_accvgpr_read_b32 v235, a203
v_mul_f32 v232, v232, v242
v_mul_f32 v233, v233, v248
v_mul_f32 v234, v234, v250
v_mul_f32 v235, v235, v251
v_accvgpr_write_b32 a200, v232
v_accvgpr_write_b32 a201, v233
v_accvgpr_write_b32 a202, v234
v_accvgpr_write_b32 a203, v235
v_accvgpr_read_b32 v232, a216
v_accvgpr_read_b32 v233, a217
v_accvgpr_read_b32 v234, a218
v_accvgpr_read_b32 v235, a219
v_mul_f32 v232, v232, v242
v_mul_f32 v233, v233, v248
v_mul_f32 v234, v234, v250
v_mul_f32 v235, v235, v251
v_accvgpr_write_b32 a216, v232
v_accvgpr_write_b32 a217, v233
v_accvgpr_write_b32 a218, v234
v_accvgpr_write_b32 a219, v235
v_accvgpr_read_b32 v232, a232
v_accvgpr_read_b32 v233, a233
v_accvgpr_read_b32 v234, a234
v_accvgpr_read_b32 v235, a235
v_mul_f32 v232, v232, v242
v_mul_f32 v233, v233, v248
v_mul_f32 v234, v234, v250
v_mul_f32 v235, v235, v251
v_accvgpr_write_b32 a232, v232
v_accvgpr_write_b32 a233, v233
v_accvgpr_write_b32 a234, v234
v_accvgpr_write_b32 a235, v235
v_accvgpr_read_b32 v232, a248
v_accvgpr_read_b32 v233, a249
v_accvgpr_read_b32 v234, a250
v_accvgpr_read_b32 v235, a251
v_mul_f32 v232, v232, v242
v_mul_f32 v233, v233, v248
v_mul_f32 v234, v234, v250
v_mul_f32 v235, v235, v251
v_accvgpr_write_b32 a248, v232
v_accvgpr_write_b32 a249, v233
v_accvgpr_write_b32 a250, v234
v_accvgpr_write_b32 a251, v235
v_lshrrev_b32 v232, 4, v243
v_and_b32 v232, 0x30, v232
ds_bpermute_b32 v242, v232, v239 offset:0
ds_bpermute_b32 v248, v232, v239 offset:4
ds_bpermute_b32 v250, v232, v239 offset:8
ds_bpermute_b32 v251, v232, v239 offset:12
s_waitcnt lgkmcnt(0)
v_accvgpr_read_b32 v232, a12
v_accvgpr_read_b32 v233, a13
v_accvgpr_read_b32 v234, a14
v_accvgpr_read_b32 v235, a15
v_mul_f32 v232, v232, v242
v_mul_f32 v233, v233, v248
v_mul_f32 v234, v234, v250
v_mul_f32 v235, v235, v251
v_accvgpr_write_b32 a12, v232
v_accvgpr_write_b32 a13, v233
v_accvgpr_write_b32 a14, v234
v_accvgpr_write_b32 a15, v235
v_accvgpr_read_b32 v232, a28
v_accvgpr_read_b32 v233, a29
v_accvgpr_read_b32 v234, a30
v_accvgpr_read_b32 v235, a31
v_mul_f32 v232, v232, v242
v_mul_f32 v233, v233, v248
v_mul_f32 v234, v234, v250
v_mul_f32 v235, v235, v251
v_accvgpr_write_b32 a28, v232
v_accvgpr_write_b32 a29, v233
v_accvgpr_write_b32 a30, v234
v_accvgpr_write_b32 a31, v235
v_accvgpr_read_b32 v232, a44
v_accvgpr_read_b32 v233, a45
v_accvgpr_read_b32 v234, a46
v_accvgpr_read_b32 v235, a47
v_mul_f32 v232, v232, v242
v_mul_f32 v233, v233, v248
v_mul_f32 v234, v234, v250
v_mul_f32 v235, v235, v251
v_accvgpr_write_b32 a44, v232
v_accvgpr_write_b32 a45, v233
v_accvgpr_write_b32 a46, v234
v_accvgpr_write_b32 a47, v235
v_accvgpr_read_b32 v232, a60
v_accvgpr_read_b32 v233, a61
v_accvgpr_read_b32 v234, a62
v_accvgpr_read_b32 v235, a63
v_mul_f32 v232, v232, v242
v_mul_f32 v233, v233, v248
v_mul_f32 v234, v234, v250
v_mul_f32 v235, v235, v251
v_accvgpr_write_b32 a60, v232
v_accvgpr_write_b32 a61, v233
v_accvgpr_write_b32 a62, v234
v_accvgpr_write_b32 a63, v235
v_accvgpr_read_b32 v232, a76
v_accvgpr_read_b32 v233, a77
v_accvgpr_read_b32 v234, a78
v_accvgpr_read_b32 v235, a79
v_mul_f32 v232, v232, v242
v_mul_f32 v233, v233, v248
v_mul_f32 v234, v234, v250
v_mul_f32 v235, v235, v251
v_accvgpr_write_b32 a76, v232
v_accvgpr_write_b32 a77, v233
v_accvgpr_write_b32 a78, v234
v_accvgpr_write_b32 a79, v235
v_accvgpr_read_b32 v232, a92
v_accvgpr_read_b32 v233, a93
v_accvgpr_read_b32 v234, a94
v_accvgpr_read_b32 v235, a95
v_mul_f32 v232, v232, v242
v_mul_f32 v233, v233, v248
v_mul_f32 v234, v234, v250
v_mul_f32 v235, v235, v251
v_accvgpr_write_b32 a92, v232
v_accvgpr_write_b32 a93, v233
v_accvgpr_write_b32 a94, v234
v_accvgpr_write_b32 a95, v235
v_accvgpr_read_b32 v232, a108
v_accvgpr_read_b32 v233, a109
v_accvgpr_read_b32 v234, a110
v_accvgpr_read_b32 v235, a111
v_mul_f32 v232, v232, v242
v_mul_f32 v233, v233, v248
v_mul_f32 v234, v234, v250
v_mul_f32 v235, v235, v251
v_accvgpr_write_b32 a108, v232
v_accvgpr_write_b32 a109, v233
v_accvgpr_write_b32 a110, v234
v_accvgpr_write_b32 a111, v235
v_accvgpr_read_b32 v232, a124
v_accvgpr_read_b32 v233, a125
v_accvgpr_read_b32 v234, a126
v_accvgpr_read_b32 v235, a127
v_mul_f32 v232, v232, v242
v_mul_f32 v233, v233, v248
v_mul_f32 v234, v234, v250
v_mul_f32 v235, v235, v251
v_accvgpr_write_b32 a124, v232
v_accvgpr_write_b32 a125, v233
v_accvgpr_write_b32 a126, v234
v_accvgpr_write_b32 a127, v235
v_accvgpr_read_b32 v232, a140
v_accvgpr_read_b32 v233, a141
v_accvgpr_read_b32 v234, a142
v_accvgpr_read_b32 v235, a143
v_mul_f32 v232, v232, v242
v_mul_f32 v233, v233, v248
v_mul_f32 v234, v234, v250
v_mul_f32 v235, v235, v251
v_accvgpr_write_b32 a140, v232
v_accvgpr_write_b32 a141, v233
v_accvgpr_write_b32 a142, v234
v_accvgpr_write_b32 a143, v235
v_accvgpr_read_b32 v232, a156
v_accvgpr_read_b32 v233, a157
v_accvgpr_read_b32 v234, a158
v_accvgpr_read_b32 v235, a159
v_mul_f32 v232, v232, v242
v_mul_f32 v233, v233, v248
v_mul_f32 v234, v234, v250
v_mul_f32 v235, v235, v251
v_accvgpr_write_b32 a156, v232
v_accvgpr_write_b32 a157, v233
v_accvgpr_write_b32 a158, v234
v_accvgpr_write_b32 a159, v235
v_accvgpr_read_b32 v232, a172
v_accvgpr_read_b32 v233, a173
v_accvgpr_read_b32 v234, a174
v_accvgpr_read_b32 v235, a175
v_mul_f32 v232, v232, v242
v_mul_f32 v233, v233, v248
v_mul_f32 v234, v234, v250
v_mul_f32 v235, v235, v251
v_accvgpr_write_b32 a172, v232
v_accvgpr_write_b32 a173, v233
v_accvgpr_write_b32 a174, v234
v_accvgpr_write_b32 a175, v235
v_accvgpr_read_b32 v232, a188
v_accvgpr_read_b32 v233, a189
v_accvgpr_read_b32 v234, a190
v_accvgpr_read_b32 v235, a191
v_mul_f32 v232, v232, v242
v_mul_f32 v233, v233, v248
v_mul_f32 v234, v234, v250
v_mul_f32 v235, v235, v251
v_accvgpr_write_b32 a188, v232
v_accvgpr_write_b32 a189, v233
v_accvgpr_write_b32 a190, v234
v_accvgpr_write_b32 a191, v235
v_accvgpr_read_b32 v232, a204
v_accvgpr_read_b32 v233, a205
v_accvgpr_read_b32 v234, a206
v_accvgpr_read_b32 v235, a207
v_mul_f32 v232, v232, v242
v_mul_f32 v233, v233, v248
v_mul_f32 v234, v234, v250
v_mul_f32 v235, v235, v251
v_accvgpr_write_b32 a204, v232
v_accvgpr_write_b32 a205, v233
v_accvgpr_write_b32 a206, v234
v_accvgpr_write_b32 a207, v235
v_accvgpr_read_b32 v232, a220
v_accvgpr_read_b32 v233, a221
v_accvgpr_read_b32 v234, a222
v_accvgpr_read_b32 v235, a223
v_mul_f32 v232, v232, v242
v_mul_f32 v233, v233, v248
v_mul_f32 v234, v234, v250
v_mul_f32 v235, v235, v251
v_accvgpr_write_b32 a220, v232
v_accvgpr_write_b32 a221, v233
v_accvgpr_write_b32 a222, v234
v_accvgpr_write_b32 a223, v235
v_accvgpr_read_b32 v232, a236
v_accvgpr_read_b32 v233, a237
v_accvgpr_read_b32 v234, a238
v_accvgpr_read_b32 v235, a239
v_mul_f32 v232, v232, v242
v_mul_f32 v233, v233, v248
v_mul_f32 v234, v234, v250
v_mul_f32 v235, v235, v251
v_accvgpr_write_b32 a236, v232
v_accvgpr_write_b32 a237, v233
v_accvgpr_write_b32 a238, v234
v_accvgpr_write_b32 a239, v235
v_accvgpr_read_b32 v232, a252
v_accvgpr_read_b32 v233, a253
v_accvgpr_read_b32 v234, a254
v_accvgpr_read_b32 v235, a255
v_mul_f32 v232, v232, v242
v_mul_f32 v233, v233, v248
v_mul_f32 v234, v234, v250
v_mul_f32 v235, v235, v251
v_accvgpr_write_b32 a252, v232
v_accvgpr_write_b32 a253, v233
v_accvgpr_write_b32 a254, v234
v_accvgpr_write_b32 a255, v235
s_nop 3
s_cmp_eq_u32 s36, 0
s_cbranch_scc1 L2_rr0
s_cmp_eq_u32 s36, 1
s_cbranch_scc1 L2_rr1
s_cmp_eq_u32 s36, 2
s_cbranch_scc1 L2_rr2
s_cmp_eq_u32 s36, 3
s_cbranch_scc1 L2_rr3
s_cmp_eq_u32 s36, 4
s_cbranch_scc1 L2_rr4
s_cmp_eq_u32 s36, 5
s_cbranch_scc1 L2_rr5
s_cmp_eq_u32 s36, 6
s_cbranch_scc1 L2_rr6
s_cmp_eq_u32 s36, 7
s_cbranch_scc1 L2_rr7
s_cmp_eq_u32 s36, 8
s_cbranch_scc1 L2_rr8
s_cmp_eq_u32 s36, 9
s_cbranch_scc1 L2_rr9
s_cmp_eq_u32 s36, 10
s_cbranch_scc1 L2_rr10
s_cmp_eq_u32 s36, 11
s_cbranch_scc1 L2_rr11
s_cmp_eq_u32 s36, 12
s_cbranch_scc1 L2_rr12
s_cmp_eq_u32 s36, 13
s_cbranch_scc1 L2_rr13
s_cmp_eq_u32 s36, 14
s_cbranch_scc1 L2_rr14
s_cmp_eq_u32 s36, 15
s_cbranch_scc1 L2_rr15
s_cmp_eq_u32 s36, 16
s_cbranch_scc1 L2_rr16
L2_rr17:
s_waitcnt lgkmcnt(0)
s_branch L2_ret17
L2_rr16:
s_waitcnt lgkmcnt(0)
s_branch L2_ret16
L2_rr15:
s_waitcnt lgkmcnt(0)
s_branch L2_ret15
L2_rr14:
s_waitcnt lgkmcnt(0)
s_branch L2_ret14
L2_rr13:
s_waitcnt lgkmcnt(0)
s_branch L2_ret13
L2_rr12:
s_waitcnt lgkmcnt(0)
s_branch L2_ret12
L2_rr11:
s_waitcnt lgkmcnt(0)
s_branch L2_ret11
L2_rr10:
s_waitcnt lgkmcnt(0)
s_branch L2_ret10
L2_rr9:
s_waitcnt lgkmcnt(0)
s_branch L2_ret9
L2_rr8:
s_waitcnt lgkmcnt(0)
s_branch L2_ret8
L2_rr7:
s_waitcnt lgkmcnt(0)
s_branch L2_ret7
L2_rr6:
s_waitcnt lgkmcnt(0)
s_branch L2_ret6
L2_rr5:
s_waitcnt lgkmcnt(0)
s_branch L2_ret5
L2_rr4:
s_waitcnt lgkmcnt(0)
s_branch L2_ret4
L2_rr3:
s_waitcnt lgkmcnt(0)
s_branch L2_ret3
L2_rr2:
s_waitcnt lgkmcnt(0)
s_branch L2_ret2
L2_rr1:
s_waitcnt lgkmcnt(0)
s_branch L2_ret1
L2_rr0:
s_waitcnt lgkmcnt(0)
s_branch L2_ret0
LT_disp:
s_cmp_ge_i32 s36, 0
s_cbranch_scc1 LT_start
s_cmp_eq_u32 s34, 0
s_cbranch_scc1 L2_end
s_mov_b32 s41, s34
s_mul_i32 s40, s34, 6
s_add_u32 s40, s40, s37
s_add_u32 s40, s40, 42
s_cmp_lt_u32 s40, 64
s_cbranch_scc1 LE_common
s_branch L2_end
LT_start:
s_waitcnt lgkmcnt(0)
s_add_u32 s12, s4, 0x7c2a000
s_addc_u32 s13, s5, 0
s_mov_b32 s14, 0x8000
s_mov_b32 s15, 0x00020000
v_and_b32 v8, 63, v0
v_lshlrev_b32 v8, 7, v8
s_mov_b32 s91, 8192
s_mov_b32 s90, 16384
s_mov_b32 s95, 24576
v_min_u32 v9, 5248, v8
s_mov_b32 s94, 0x10000
LT_poll:
buffer_load_dwordx2 v[0:1], v8, s[12:15], 0 offen sc1
buffer_load_dwordx2 v[2:3], v8, s[12:15], s91 offen sc1
buffer_load_dwordx2 v[4:5], v8, s[12:15], s90 offen sc1
buffer_load_dwordx2 v[6:7], v9, s[12:15], s95 offen sc1
s_sub_u32 s94, s94, 1
s_waitcnt vmcnt(0)
s_cbranch_scc1 LT_poll_go
v_cmp_ne_u64 vcc, s[98:99], v[0:1]
s_nop 1
s_cbranch_vccnz LT_poll
v_cmp_ne_u64 vcc, s[98:99], v[2:3]
s_nop 1
s_cbranch_vccnz LT_poll
v_cmp_ne_u64 vcc, s[98:99], v[4:5]
s_nop 1
s_cbranch_vccnz LT_poll
v_cmp_ne_u64 vcc, s[98:99], v[6:7]
s_nop 1
s_cbranch_vccnz LT_poll
LT_poll_go:
s_add_u32 s31, s31, -22
s_add_u32 s3, s28, 409600
s_cmp_eq_u32 s36, 0
s_cselect_b32 s31, 26, s31
s_cselect_b32 s39, s39, s3
s_cselect_b32 s33, s33, 0
s_cselect_b32 s3, 0, 425984
s_add_u32 s28, s28, s3
s_add_u32 s12, s4, 0x6800000
s_addc_u32 s13, s5, 0
s_mov_b32 s14, 0x0
s_mov_b32 s15, 0x00020000
s_mov_b32 s14, s49
s_add_u32 s8, s4, 0x0
s_addc_u32 s9, s5, 0
s_mov_b32 s10, 0x4e4000
s_mov_b32 s11, 0x00020000
s_mov_b32 s40, 5111808
s_mov_b32 s44, 5115904
buffer_load_dwordx4 v[0:3], v243, s[8:11], s40 offen offset:0 sc1
buffer_load_dwordx4 v[4:7], v243, s[8:11], s40 offen offset:1024 sc1
buffer_load_dwordx4 v[8:11], v243, s[8:11], s40 offen offset:2048 sc1
buffer_load_dwordx4 v[12:15], v243, s[8:11], s40 offen offset:3072 sc1
buffer_load_dwordx4 v[16:19], v243, s[8:11], s44 offen offset:0 sc1
buffer_load_dwordx4 v[20:23], v243, s[8:11], s44 offen offset:1024 sc1
buffer_load_dwordx4 v[24:27], v243, s[8:11], s44 offen offset:2048 sc1
buffer_load_dwordx4 v[28:31], v243, s[8:11], s44 offen offset:3072 sc1
s_mov_b32 s53, 0
s_add_u32 m0, s53, 90112
s_add_u32 s54, s39, 0
buffer_load_dwordx4 v241, s[12:15], s54 offen offset:0 sc1 lds
buffer_load_dwordx4 v241, s[12:15], s54 offen offset:1024 sc1 lds
buffer_load_dwordx4 v241, s[12:15], s54 offen offset:2048 sc1 lds
buffer_load_dwordx4 v241, s[12:15], s54 offen offset:3072 sc1 lds
s_add_u32 m0, s53, 94208
s_add_u32 s54, s39, 128
buffer_load_dwordx4 v241, s[12:15], s54 offen offset:0 sc1 lds
buffer_load_dwordx4 v241, s[12:15], s54 offen offset:1024 sc1 lds
buffer_load_dwordx4 v241, s[12:15], s54 offen offset:2048 sc1 lds
buffer_load_dwordx4 v241, s[12:15], s54 offen offset:3072 sc1 lds
s_add_u32 m0, s53, 98304
s_add_u32 s54, s39, 256
buffer_load_dwordx4 v241, s[12:15], s54 offen offset:0 sc1 lds
buffer_load_dwordx4 v241, s[12:15], s54 offen offset:1024 sc1 lds
buffer_load_dwordx4 v241, s[12:15], s54 offen offset:2048 sc1 lds
buffer_load_dwordx4 v241, s[12:15], s54 offen offset:3072 sc1 lds
s_add_u32 m0, s53, 102400
s_add_u32 s54, s39, 384
buffer_load_dwordx4 v241, s[12:15], s54 offen offset:0 sc1 lds
buffer_load_dwordx4 v241, s[12:15], s54 offen offset:1024 sc1 lds
buffer_load_dwordx4 v241, s[12:15], s54 offen offset:2048 sc1 lds
buffer_load_dwordx4 v241, s[12:15], s54 offen offset:3072 sc1 lds
s_add_u32 s53, s53, 0x4000
s_and_b32 s53, s53, 0xffff
s_add_u32 m0, s53, 90112
s_add_u32 s54, s28, 0
buffer_load_dwordx4 v241, s[12:15], s54 offen offset:0 sc1 lds
buffer_load_dwordx4 v241, s[12:15], s54 offen offset:1024 sc1 lds
buffer_load_dwordx4 v241, s[12:15], s54 offen offset:2048 sc1 lds
buffer_load_dwordx4 v241, s[12:15], s54 offen offset:3072 sc1 lds
s_add_u32 m0, s53, 94208
s_add_u32 s54, s28, 128
buffer_load_dwordx4 v241, s[12:15], s54 offen offset:0 sc1 lds
buffer_load_dwordx4 v241, s[12:15], s54 offen offset:1024 sc1 lds
buffer_load_dwordx4 v241, s[12:15], s54 offen offset:2048 sc1 lds
buffer_load_dwordx4 v241, s[12:15], s54 offen offset:3072 sc1 lds
s_add_u32 m0, s53, 98304
s_add_u32 s54, s28, 256
buffer_load_dwordx4 v241, s[12:15], s54 offen offset:0 sc1 lds
buffer_load_dwordx4 v241, s[12:15], s54 offen offset:1024 sc1 lds
buffer_load_dwordx4 v241, s[12:15], s54 offen offset:2048 sc1 lds
buffer_load_dwordx4 v241, s[12:15], s54 offen offset:3072 sc1 lds
s_add_u32 m0, s53, 102400
s_add_u32 s54, s28, 384
buffer_load_dwordx4 v241, s[12:15], s54 offen offset:0 sc1 lds
buffer_load_dwordx4 v241, s[12:15], s54 offen offset:1024 sc1 lds
buffer_load_dwordx4 v241, s[12:15], s54 offen offset:2048 sc1 lds
buffer_load_dwordx4 v241, s[12:15], s54 offen offset:3072 sc1 lds
s_add_u32 s53, s53, 0x4000
s_and_b32 s53, s53, 0xffff
s_add_u32 s28, s28, 0x4000
s_add_u32 m0, s53, 90112
s_add_u32 s54, s28, 0
buffer_load_dwordx4 v241, s[12:15], s54 offen offset:0 sc1 lds
buffer_load_dwordx4 v241, s[12:15], s54 offen offset:1024 sc1 lds
buffer_load_dwordx4 v241, s[12:15], s54 offen offset:2048 sc1 lds
buffer_load_dwordx4 v241, s[12:15], s54 offen offset:3072 sc1 lds
s_add_u32 m0, s53, 94208
s_add_u32 s54, s28, 128
buffer_load_dwordx4 v241, s[12:15], s54 offen offset:0 sc1 lds
buffer_load_dwordx4 v241, s[12:15], s54 offen offset:1024 sc1 lds
buffer_load_dwordx4 v241, s[12:15], s54 offen offset:2048 sc1 lds
buffer_load_dwordx4 v241, s[12:15], s54 offen offset:3072 sc1 lds
s_add_u32 m0, s53, 98304
s_add_u32 s54, s28, 256
buffer_load_dwordx4 v241, s[12:15], s54 offen offset:0 sc1 lds
buffer_load_dwordx4 v241, s[12:15], s54 offen offset:1024 sc1 lds
buffer_load_dwordx4 v241, s[12:15], s54 offen offset:2048 sc1 lds
buffer_load_dwordx4 v241, s[12:15], s54 offen offset:3072 sc1 lds
s_add_u32 m0, s53, 102400
s_add_u32 s54, s28, 384
buffer_load_dwordx4 v241, s[12:15], s54 offen offset:0 sc1 lds
buffer_load_dwordx4 v241, s[12:15], s54 offen offset:1024 sc1 lds
buffer_load_dwordx4 v241, s[12:15], s54 offen offset:2048 sc1 lds
buffer_load_dwordx4 v241, s[12:15], s54 offen offset:3072 sc1 lds
s_add_u32 s53, s53, 0x4000
s_and_b32 s53, s53, 0xffff
s_add_u32 s28, s28, 0x4000
s_mul_i32 s35, s37, 0x600000
s_add_u32 s20, s4, 0x2000000
s_addc_u32 s21, s5, 0
s_add_u32 s20, s20, s35
s_addc_u32 s21, s21, 0
s_mov_b32 s22, 0x4e4000
s_mov_b32 s23, 0x00020000
s_add_u32 s24, s4, 0x6000000
s_addc_u32 s25, s5, 0
s_mov_b32 s26, 0x139000
s_mov_b32 s27, 0x00020000
s_lshl_b32 s48, s37, 3
s_add_u32 s48, s48, 638976
s_mov_b32 s48, 1277952
v_bfe_u32 v240, v243, 4, 3
v_lshlrev_b32 v240, 6, v240
v_bfe_u32 v242, v243, 7, 1
v_lshl_or_b32 v240, v242, 10, v240
v_bfe_u32 v242, v243, 8, 2
v_lshl_or_b32 v240, v242, 4, v240
v_bfe_u32 v242, v243, 6, 1
v_lshlrev_b32 v242, 5, v242
v_xor_b32 v240, v240, v242
v_and_b32 v246, 0x1c0, v243
v_bfe_u32 v242, v243, 9, 1
v_lshl_or_b32 v246, v242, 10, v246
v_bfe_u32 v242, v243, 8, 1
v_lshl_or_b32 v246, v242, 5, v246
v_bfe_u32 v242, v243, 4, 2
v_lshl_or_b32 v246, v242, 3, v246
v_xor_b32 v247, 32, v246
v_bfe_i32 v242, v243, 8, 1
v_and_b32 v192, s33, v242
v_and_b32 v193, s33, v242
v_and_b32 v194, s33, v242
v_and_b32 v195, s33, v242
s_add_u32 s51, s31, 0
s_mov_b32 s52, 90112
v_mov_b32 v172, 0xff800000
v_mov_b32 v173, 0
v_accvgpr_write_b32 a0, 0
v_accvgpr_write_b32 a1, 0
v_accvgpr_write_b32 a2, 0
v_accvgpr_write_b32 a3, 0
v_accvgpr_write_b32 a4, 0
v_accvgpr_write_b32 a5, 0
v_accvgpr_write_b32 a6, 0
v_accvgpr_write_b32 a7, 0
v_accvgpr_write_b32 a8, 0
v_accvgpr_write_b32 a9, 0
v_accvgpr_write_b32 a10, 0
v_accvgpr_write_b32 a11, 0
v_accvgpr_write_b32 a12, 0
v_accvgpr_write_b32 a13, 0
v_accvgpr_write_b32 a14, 0
v_accvgpr_write_b32 a15, 0
v_accvgpr_write_b32 a16, 0
v_accvgpr_write_b32 a17, 0
v_accvgpr_write_b32 a18, 0
v_accvgpr_write_b32 a19, 0
v_accvgpr_write_b32 a20, 0
v_accvgpr_write_b32 a21, 0
v_accvgpr_write_b32 a22, 0
v_accvgpr_write_b32 a23, 0
v_accvgpr_write_b32 a24, 0
v_accvgpr_write_b32 a25, 0
v_accvgpr_write_b32 a26, 0
v_accvgpr_write_b32 a27, 0
v_accvgpr_write_b32 a28, 0
v_accvgpr_write_b32 a29, 0
v_accvgpr_write_b32 a30, 0
v_accvgpr_write_b32 a31, 0
v_accvgpr_write_b32 a32, 0
v_accvgpr_write_b32 a33, 0
v_accvgpr_write_b32 a34, 0
v_accvgpr_write_b32 a35, 0
v_accvgpr_write_b32 a36, 0
v_accvgpr_write_b32 a37, 0
v_accvgpr_write_b32 a38, 0
v_accvgpr_write_b32 a39, 0
v_accvgpr_write_b32 a40, 0
v_accvgpr_write_b32 a41, 0
v_accvgpr_write_b32 a42, 0
v_accvgpr_write_b32 a43, 0
v_accvgpr_write_b32 a44, 0
v_accvgpr_write_b32 a45, 0
v_accvgpr_write_b32 a46, 0
v_accvgpr_write_b32 a47, 0
v_accvgpr_write_b32 a48, 0
v_accvgpr_write_b32 a49, 0
v_accvgpr_write_b32 a50, 0
v_accvgpr_write_b32 a51, 0
v_accvgpr_write_b32 a52, 0
v_accvgpr_write_b32 a53, 0
v_accvgpr_write_b32 a54, 0
v_accvgpr_write_b32 a55, 0
v_accvgpr_write_b32 a56, 0
v_accvgpr_write_b32 a57, 0
v_accvgpr_write_b32 a58, 0
v_accvgpr_write_b32 a59, 0
v_accvgpr_write_b32 a60, 0
v_accvgpr_write_b32 a61, 0
v_accvgpr_write_b32 a62, 0
v_accvgpr_write_b32 a63, 0
LT_loop:
s_add_u32 m0, s53, 90112
s_add_u32 s54, s28, 0
buffer_load_dwordx4 v241, s[12:15], s54 offen offset:0 sc1 lds
buffer_load_dwordx4 v241, s[12:15], s54 offen offset:1024 sc1 lds
buffer_load_dwordx4 v241, s[12:15], s54 offen offset:2048 sc1 lds
buffer_load_dwordx4 v241, s[12:15], s54 offen offset:3072 sc1 lds
s_add_u32 m0, s53, 94208
s_add_u32 s54, s28, 128
buffer_load_dwordx4 v241, s[12:15], s54 offen offset:0 sc1 lds
buffer_load_dwordx4 v241, s[12:15], s54 offen offset:1024 sc1 lds
buffer_load_dwordx4 v241, s[12:15], s54 offen offset:2048 sc1 lds
buffer_load_dwordx4 v241, s[12:15], s54 offen offset:3072 sc1 lds
s_add_u32 m0, s53, 98304
s_add_u32 s54, s28, 256
buffer_load_dwordx4 v241, s[12:15], s54 offen offset:0 sc1 lds
buffer_load_dwordx4 v241, s[12:15], s54 offen offset:1024 sc1 lds
buffer_load_dwordx4 v241, s[12:15], s54 offen offset:2048 sc1 lds
buffer_load_dwordx4 v241, s[12:15], s54 offen offset:3072 sc1 lds
s_add_u32 m0, s53, 102400
s_add_u32 s54, s28, 384
buffer_load_dwordx4 v241, s[12:15], s54 offen offset:0 sc1 lds
buffer_load_dwordx4 v241, s[12:15], s54 offen offset:1024 sc1 lds
buffer_load_dwordx4 v241, s[12:15], s54 offen offset:2048 sc1 lds
buffer_load_dwordx4 v241, s[12:15], s54 offen offset:3072 sc1 lds
s_add_u32 s53, s53, 0x4000
s_and_b32 s53, s53, 0xffff
s_add_u32 s28, s28, 0x4000
v_add_u32 v177, s52, v240
v_add_u32 v178, s52, v246
v_add_u32 v179, s52, v247
s_add_u32 s52, s52, 0x4000
s_cmp_eq_u32 s52, 155648
s_cselect_b32 s52, 90112, s52
s_waitcnt vmcnt(48)
ds_read_b128 v[32:35], v177 offset:0
ds_read_b128 v[64:67], v177 offset:2048
ds_read_b128 v[36:39], v177 offset:512
ds_read_b128 v[68:71], v177 offset:2560
ds_read_b128 v[40:43], v177 offset:4096
ds_read_b128 v[72:75], v177 offset:6144
ds_read_b128 v[44:47], v177 offset:4608
ds_read_b128 v[76:79], v177 offset:6656
ds_read_b128 v[48:51], v177 offset:8192
ds_read_b128 v[80:83], v177 offset:10240
ds_read_b128 v[52:55], v177 offset:8704
ds_read_b128 v[84:87], v177 offset:10752
ds_read_b128 v[56:59], v177 offset:12288
ds_read_b128 v[88:91], v177 offset:14336
ds_read_b128 v[60:63], v177 offset:12800
ds_read_b128 v[92:95], v177 offset:14848
s_waitcnt lgkmcnt(14)
v_mfma_f32_16x16x32_bf16 v[160:163], v[32:35], v[0:3], v[192:195]
v_mfma_f32_16x16x32_bf16 v[164:167], v[64:67], v[0:3], v[192:195]
s_waitcnt lgkmcnt(12)
v_mfma_f32_16x16x32_bf16 v[160:163], v[36:39], v[4:7], v[160:163]
v_mfma_f32_16x16x32_bf16 v[164:167], v[68:71], v[4:7], v[164:167]
s_waitcnt lgkmcnt(10)
v_mfma_f32_16x16x32_bf16 v[160:163], v[40:43], v[8:11], v[160:163]
v_mfma_f32_16x16x32_bf16 v[164:167], v[72:75], v[8:11], v[164:167]
s_waitcnt lgkmcnt(8)
v_mfma_f32_16x16x32_bf16 v[160:163], v[44:47], v[12:15], v[160:163]
v_mfma_f32_16x16x32_bf16 v[164:167], v[76:79], v[12:15], v[164:167]
s_waitcnt lgkmcnt(6)
v_mfma_f32_16x16x32_bf16 v[160:163], v[48:51], v[16:19], v[160:163]
v_mfma_f32_16x16x32_bf16 v[164:167], v[80:83], v[16:19], v[164:167]
s_waitcnt lgkmcnt(4)
v_mfma_f32_16x16x32_bf16 v[160:163], v[52:55], v[20:23], v[160:163]
v_mfma_f32_16x16x32_bf16 v[164:167], v[84:87], v[20:23], v[164:167]
s_waitcnt lgkmcnt(2)
v_mfma_f32_16x16x32_bf16 v[160:163], v[56:59], v[24:27], v[160:163]
v_mfma_f32_16x16x32_bf16 v[164:167], v[88:91], v[24:27], v[164:167]
s_waitcnt lgkmcnt(0)
v_mfma_f32_16x16x32_bf16 v[160:163], v[60:63], v[28:31], v[160:163]
v_mfma_f32_16x16x32_bf16 v[164:167], v[92:95], v[28:31], v[164:167]
ds_read_b64_tr_b16 v[96:97], v178 offset:0
ds_read_b64_tr_b16 v[98:99], v178 offset:2048
ds_read_b64_tr_b16 v[100:101], v179 offset:0
ds_read_b64_tr_b16 v[102:103], v179 offset:2048
ds_read_b64_tr_b16 v[104:105], v178 offset:512
ds_read_b64_tr_b16 v[106:107], v178 offset:2560
ds_read_b64_tr_b16 v[108:109], v179 offset:512
ds_read_b64_tr_b16 v[110:111], v179 offset:2560
ds_read_b64_tr_b16 v[112:113], v178 offset:4096
ds_read_b64_tr_b16 v[114:115], v178 offset:6144
ds_read_b64_tr_b16 v[116:117], v179 offset:4096
ds_read_b64_tr_b16 v[118:119], v179 offset:6144
ds_read_b64_tr_b16 v[120:121], v178 offset:4608
ds_read_b64_tr_b16 v[122:123], v178 offset:6656
ds_read_b64_tr_b16 v[124:125], v179 offset:4608
ds_read_b64_tr_b16 v[126:127], v179 offset:6656
ds_read_b64_tr_b16 v[128:129], v178 offset:8192
ds_read_b64_tr_b16 v[130:131], v178 offset:10240
ds_read_b64_tr_b16 v[132:133], v179 offset:8192
ds_read_b64_tr_b16 v[134:135], v179 offset:10240
ds_read_b64_tr_b16 v[136:137], v178 offset:8704
ds_read_b64_tr_b16 v[138:139], v178 offset:10752
ds_read_b64_tr_b16 v[140:141], v179 offset:8704
ds_read_b64_tr_b16 v[142:143], v179 offset:10752
ds_read_b64_tr_b16 v[144:145], v178 offset:12288
ds_read_b64_tr_b16 v[146:147], v178 offset:14336
ds_read_b64_tr_b16 v[148:149], v179 offset:12288
ds_read_b64_tr_b16 v[150:151], v179 offset:14336
ds_read_b64_tr_b16 v[152:153], v178 offset:12800
ds_read_b64_tr_b16 v[154:155], v178 offset:14848
ds_read_b64_tr_b16 v[156:157], v179 offset:12800
ds_read_b64_tr_b16 v[158:159], v179 offset:14848
v_mov_b32 v192, 0
v_mov_b32 v193, 0
v_mov_b32 v194, 0
v_mov_b32 v195, 0
s_nop 7
v_max3_f32 v175, v160, v161, v162
v_max3_f32 v175, v175, v163, v164
v_max3_f32 v175, v175, v165, v166
v_max3_f32 v175, v175, v167, v172
v_mov_b32 v176, v175
s_nop 1
v_permlane32_swap_b32 v175, v176
s_nop 1
v_max_f32 v175, v175, v176
v_mov_b32 v176, v175
s_nop 1
v_permlane16_swap_b32 v175, v176
s_nop 1
v_max_f32 v175, v175, v176
v_ceil_f32 v175, v175
v_sub_f32 v174, v172, v175
v_exp_f32 v174, v174
v_mov_b32 v172, v175
v_sub_f32 v160, v160, v172
v_sub_f32 v161, v161, v172
v_sub_f32 v162, v162, v172
v_sub_f32 v163, v163, v172
v_sub_f32 v164, v164, v172
v_sub_f32 v165, v165, v172
v_sub_f32 v166, v166, v172
v_sub_f32 v167, v167, v172
v_exp_f32 v160, v160
v_exp_f32 v161, v161
v_exp_f32 v162, v162
v_exp_f32 v163, v163
v_exp_f32 v164, v164
v_exp_f32 v165, v165
v_exp_f32 v166, v166
v_exp_f32 v167, v167
v_mul_f32 v173, v173, v174
v_cvt_pk_bf16_f32 v168, v160, v161
v_cvt_pk_bf16_f32 v169, v162, v163
v_cvt_pk_bf16_f32 v170, v164, v165
v_cvt_pk_bf16_f32 v171, v166, v167
v_cmp_neq_f32 vcc, 1.0, v174
v_add_f32 v173, v173, v160
v_add_f32 v173, v173, v161
v_add_f32 v173, v173, v162
v_add_f32 v173, v173, v163
v_add_f32 v173, v173, v164
v_add_f32 v173, v173, v165
v_add_f32 v173, v173, v166
v_add_f32 v173, v173, v167
s_cbranch_vccz LT_nors
v_lshrrev_b32 v176, 4, v243
v_and_b32 v176, 0x30, v176
ds_bpermute_b32 v188, v176, v174 offset:0
ds_bpermute_b32 v189, v176, v174 offset:4
ds_bpermute_b32 v190, v176, v174 offset:8
ds_bpermute_b32 v191, v176, v174 offset:12
s_waitcnt lgkmcnt(0)
v_accvgpr_read_b32 v180, a0
v_accvgpr_read_b32 v181, a1
v_accvgpr_read_b32 v182, a2
v_accvgpr_read_b32 v183, a3
v_accvgpr_read_b32 v184, a4
v_accvgpr_read_b32 v185, a5
v_accvgpr_read_b32 v186, a6
v_accvgpr_read_b32 v187, a7
v_mul_f32 v180, v180, v188
v_mul_f32 v181, v181, v189
v_mul_f32 v182, v182, v190
v_mul_f32 v183, v183, v191
v_mul_f32 v184, v184, v188
v_mul_f32 v185, v185, v189
v_mul_f32 v186, v186, v190
v_mul_f32 v187, v187, v191
v_accvgpr_write_b32 a0, v180
v_accvgpr_write_b32 a1, v181
v_accvgpr_write_b32 a2, v182
v_accvgpr_write_b32 a3, v183
v_accvgpr_write_b32 a4, v184
v_accvgpr_write_b32 a5, v185
v_accvgpr_write_b32 a6, v186
v_accvgpr_write_b32 a7, v187
v_accvgpr_read_b32 v180, a8
v_accvgpr_read_b32 v181, a9
v_accvgpr_read_b32 v182, a10
v_accvgpr_read_b32 v183, a11
v_accvgpr_read_b32 v184, a12
v_accvgpr_read_b32 v185, a13
v_accvgpr_read_b32 v186, a14
v_accvgpr_read_b32 v187, a15
v_mul_f32 v180, v180, v188
v_mul_f32 v181, v181, v189
v_mul_f32 v182, v182, v190
v_mul_f32 v183, v183, v191
v_mul_f32 v184, v184, v188
v_mul_f32 v185, v185, v189
v_mul_f32 v186, v186, v190
v_mul_f32 v187, v187, v191
v_accvgpr_write_b32 a8, v180
v_accvgpr_write_b32 a9, v181
v_accvgpr_write_b32 a10, v182
v_accvgpr_write_b32 a11, v183
v_accvgpr_write_b32 a12, v184
v_accvgpr_write_b32 a13, v185
v_accvgpr_write_b32 a14, v186
v_accvgpr_write_b32 a15, v187
v_accvgpr_read_b32 v180, a16
v_accvgpr_read_b32 v181, a17
v_accvgpr_read_b32 v182, a18
v_accvgpr_read_b32 v183, a19
v_accvgpr_read_b32 v184, a20
v_accvgpr_read_b32 v185, a21
v_accvgpr_read_b32 v186, a22
v_accvgpr_read_b32 v187, a23
v_mul_f32 v180, v180, v188
v_mul_f32 v181, v181, v189
v_mul_f32 v182, v182, v190
v_mul_f32 v183, v183, v191
v_mul_f32 v184, v184, v188
v_mul_f32 v185, v185, v189
v_mul_f32 v186, v186, v190
v_mul_f32 v187, v187, v191
v_accvgpr_write_b32 a16, v180
v_accvgpr_write_b32 a17, v181
v_accvgpr_write_b32 a18, v182
v_accvgpr_write_b32 a19, v183
v_accvgpr_write_b32 a20, v184
v_accvgpr_write_b32 a21, v185
v_accvgpr_write_b32 a22, v186
v_accvgpr_write_b32 a23, v187
v_accvgpr_read_b32 v180, a24
v_accvgpr_read_b32 v181, a25
v_accvgpr_read_b32 v182, a26
v_accvgpr_read_b32 v183, a27
v_accvgpr_read_b32 v184, a28
v_accvgpr_read_b32 v185, a29
v_accvgpr_read_b32 v186, a30
v_accvgpr_read_b32 v187, a31
v_mul_f32 v180, v180, v188
v_mul_f32 v181, v181, v189
v_mul_f32 v182, v182, v190
v_mul_f32 v183, v183, v191
v_mul_f32 v184, v184, v188
v_mul_f32 v185, v185, v189
v_mul_f32 v186, v186, v190
v_mul_f32 v187, v187, v191
v_accvgpr_write_b32 a24, v180
v_accvgpr_write_b32 a25, v181
v_accvgpr_write_b32 a26, v182
v_accvgpr_write_b32 a27, v183
v_accvgpr_write_b32 a28, v184
v_accvgpr_write_b32 a29, v185
v_accvgpr_write_b32 a30, v186
v_accvgpr_write_b32 a31, v187
v_accvgpr_read_b32 v180, a32
v_accvgpr_read_b32 v181, a33
v_accvgpr_read_b32 v182, a34
v_accvgpr_read_b32 v183, a35
v_accvgpr_read_b32 v184, a36
v_accvgpr_read_b32 v185, a37
v_accvgpr_read_b32 v186, a38
v_accvgpr_read_b32 v187, a39
v_mul_f32 v180, v180, v188
v_mul_f32 v181, v181, v189
v_mul_f32 v182, v182, v190
v_mul_f32 v183, v183, v191
v_mul_f32 v184, v184, v188
v_mul_f32 v185, v185, v189
v_mul_f32 v186, v186, v190
v_mul_f32 v187, v187, v191
v_accvgpr_write_b32 a32, v180
v_accvgpr_write_b32 a33, v181
v_accvgpr_write_b32 a34, v182
v_accvgpr_write_b32 a35, v183
v_accvgpr_write_b32 a36, v184
v_accvgpr_write_b32 a37, v185
v_accvgpr_write_b32 a38, v186
v_accvgpr_write_b32 a39, v187
v_accvgpr_read_b32 v180, a40
v_accvgpr_read_b32 v181, a41
v_accvgpr_read_b32 v182, a42
v_accvgpr_read_b32 v183, a43
v_accvgpr_read_b32 v184, a44
v_accvgpr_read_b32 v185, a45
v_accvgpr_read_b32 v186, a46
v_accvgpr_read_b32 v187, a47
v_mul_f32 v180, v180, v188
v_mul_f32 v181, v181, v189
v_mul_f32 v182, v182, v190
v_mul_f32 v183, v183, v191
v_mul_f32 v184, v184, v188
v_mul_f32 v185, v185, v189
v_mul_f32 v186, v186, v190
v_mul_f32 v187, v187, v191
v_accvgpr_write_b32 a40, v180
v_accvgpr_write_b32 a41, v181
v_accvgpr_write_b32 a42, v182
v_accvgpr_write_b32 a43, v183
v_accvgpr_write_b32 a44, v184
v_accvgpr_write_b32 a45, v185
v_accvgpr_write_b32 a46, v186
v_accvgpr_write_b32 a47, v187
v_accvgpr_read_b32 v180, a48
v_accvgpr_read_b32 v181, a49
v_accvgpr_read_b32 v182, a50
v_accvgpr_read_b32 v183, a51
v_accvgpr_read_b32 v184, a52
v_accvgpr_read_b32 v185, a53
v_accvgpr_read_b32 v186, a54
v_accvgpr_read_b32 v187, a55
v_mul_f32 v180, v180, v188
v_mul_f32 v181, v181, v189
v_mul_f32 v182, v182, v190
v_mul_f32 v183, v183, v191
v_mul_f32 v184, v184, v188
v_mul_f32 v185, v185, v189
v_mul_f32 v186, v186, v190
v_mul_f32 v187, v187, v191
v_accvgpr_write_b32 a48, v180
v_accvgpr_write_b32 a49, v181
v_accvgpr_write_b32 a50, v182
v_accvgpr_write_b32 a51, v183
v_accvgpr_write_b32 a52, v184
v_accvgpr_write_b32 a53, v185
v_accvgpr_write_b32 a54, v186
v_accvgpr_write_b32 a55, v187
v_accvgpr_read_b32 v180, a56
v_accvgpr_read_b32 v181, a57
v_accvgpr_read_b32 v182, a58
v_accvgpr_read_b32 v183, a59
v_accvgpr_read_b32 v184, a60
v_accvgpr_read_b32 v185, a61
v_accvgpr_read_b32 v186, a62
v_accvgpr_read_b32 v187, a63
v_mul_f32 v180, v180, v188
v_mul_f32 v181, v181, v189
v_mul_f32 v182, v182, v190
v_mul_f32 v183, v183, v191
v_mul_f32 v184, v184, v188
v_mul_f32 v185, v185, v189
v_mul_f32 v186, v186, v190
v_mul_f32 v187, v187, v191
v_accvgpr_write_b32 a56, v180
v_accvgpr_write_b32 a57, v181
v_accvgpr_write_b32 a58, v182
v_accvgpr_write_b32 a59, v183
v_accvgpr_write_b32 a60, v184
v_accvgpr_write_b32 a61, v185
v_accvgpr_write_b32 a62, v186
v_accvgpr_write_b32 a63, v187
LT_nors:
s_waitcnt lgkmcnt(0)
s_nop 1
v_mfma_f32_16x16x32_bf16 a[0:3], v[168:171], v[96:99], a[0:3]
v_mfma_f32_16x16x32_bf16 a[4:7], v[168:171], v[100:103], a[4:7]
v_mfma_f32_16x16x32_bf16 a[8:11], v[168:171], v[104:107], a[8:11]
v_mfma_f32_16x16x32_bf16 a[12:15], v[168:171], v[108:111], a[12:15]
v_mfma_f32_16x16x32_bf16 a[16:19], v[168:171], v[112:115], a[16:19]
v_mfma_f32_16x16x32_bf16 a[20:23], v[168:171], v[116:119], a[20:23]
v_mfma_f32_16x16x32_bf16 a[24:27], v[168:171], v[120:123], a[24:27]
v_mfma_f32_16x16x32_bf16 a[28:31], v[168:171], v[124:127], a[28:31]
v_mfma_f32_16x16x32_bf16 a[32:35], v[168:171], v[128:131], a[32:35]
v_mfma_f32_16x16x32_bf16 a[36:39], v[168:171], v[132:135], a[36:39]
v_mfma_f32_16x16x32_bf16 a[40:43], v[168:171], v[136:139], a[40:43]
v_mfma_f32_16x16x32_bf16 a[44:47], v[168:171], v[140:143], a[44:47]
v_mfma_f32_16x16x32_bf16 a[48:51], v[168:171], v[144:147], a[48:51]
v_mfma_f32_16x16x32_bf16 a[52:55], v[168:171], v[148:151], a[52:55]
v_mfma_f32_16x16x32_bf16 a[56:59], v[168:171], v[152:155], a[56:59]
v_mfma_f32_16x16x32_bf16 a[60:63], v[168:171], v[156:159], a[60:63]
s_sub_u32 s51, s51, 1
s_cmp_lg_u32 s51, 0
s_cbranch_scc1 LT_loop
s_nop 15
s_add_u32 s16, s4, 0x0
s_addc_u32 s17, s5, 0
s_mov_b32 s18, 0x10000000
s_mov_b32 s19, 0x00020000
s_mul_i32 s52, s37, 0x5000
s_add_u32 s52, s52, 0x1200000
s_add_u32 s53, s37, 1610
s_lshl_b32 s53, s53, 7
s_add_u32 s53, s53, 0x7c00000
s_waitcnt vmcnt(0)
s_cmp_eq_u32 s36, 0
s_cbranch_scc1 LT_merge
buffer_store_dwordx4 a[0:3], v243, s[16:19], s52 offen offset:0 sc1
buffer_store_dwordx4 a[4:7], v243, s[16:19], s52 offen offset:1024 sc1
buffer_store_dwordx4 a[8:11], v243, s[16:19], s52 offen offset:2048 sc1
buffer_store_dwordx4 a[12:15], v243, s[16:19], s52 offen offset:3072 sc1
s_add_u32 s52, s52, 4096
buffer_store_dwordx4 a[16:19], v243, s[16:19], s52 offen offset:0 sc1
buffer_store_dwordx4 a[20:23], v243, s[16:19], s52 offen offset:1024 sc1
buffer_store_dwordx4 a[24:27], v243, s[16:19], s52 offen offset:2048 sc1
buffer_store_dwordx4 a[28:31], v243, s[16:19], s52 offen offset:3072 sc1
s_add_u32 s52, s52, 4096
buffer_store_dwordx4 a[32:35], v243, s[16:19], s52 offen offset:0 sc1
buffer_store_dwordx4 a[36:39], v243, s[16:19], s52 offen offset:1024 sc1
buffer_store_dwordx4 a[40:43], v243, s[16:19], s52 offen offset:2048 sc1
buffer_store_dwordx4 a[44:47], v243, s[16:19], s52 offen offset:3072 sc1
s_add_u32 s52, s52, 4096
buffer_store_dwordx4 a[48:51], v243, s[16:19], s52 offen offset:0 sc1
buffer_store_dwordx4 a[52:55], v243, s[16:19], s52 offen offset:1024 sc1
buffer_store_dwordx4 a[56:59], v243, s[16:19], s52 offen offset:2048 sc1
buffer_store_dwordx4 a[60:63], v243, s[16:19], s52 offen offset:3072 sc1
s_add_u32 s52, s52, 4096
buffer_store_dwordx2 v[172:173], v243, s[16:19], s52 offen sc1
s_waitcnt vmcnt(0)
v_mov_b32 v176, s98
v_mov_b32 v177, s99
s_mov_b64 exec, 1
buffer_store_dwordx2 v[176:177], off, s[16:19], s53 sc1
s_mov_b64 exec, -1
s_branch L2_fin
LT_merge:
s_mov_b32 s94, 0x10000
LT_mw:
buffer_load_dwordx2 v[0:1], off, s[16:19], s53 sc1
s_sub_u32 s94, s94, 1
s_waitcnt vmcnt(0)
s_cbranch_scc1 LT_mw_go
v_cmp_ne_u64 vcc, s[98:99], v[0:1]
s_nop 1
s_cbranch_vccnz LT_mw
LT_mw_go:
buffer_load_dwordx4 v[96:99], v243, s[16:19], s52 offen offset:0 sc1
buffer_load_dwordx4 v[100:103], v243, s[16:19], s52 offen offset:1024 sc1
buffer_load_dwordx4 v[104:107], v243, s[16:19], s52 offen offset:2048 sc1
buffer_load_dwordx4 v[108:111], v243, s[16:19], s52 offen offset:3072 sc1
s_add_u32 s52, s52, 4096
buffer_load_dwordx4 v[112:115], v243, s[16:19], s52 offen offset:0 sc1
buffer_load_dwordx4 v[116:119], v243, s[16:19], s52 offen offset:1024 sc1
buffer_load_dwordx4 v[120:123], v243, s[16:19], s52 offen offset:2048 sc1
buffer_load_dwordx4 v[124:127], v243, s[16:19], s52 offen offset:3072 sc1
s_add_u32 s52, s52, 4096
buffer_load_dwordx4 v[128:131], v243, s[16:19], s52 offen offset:0 sc1
buffer_load_dwordx4 v[132:135], v243, s[16:19], s52 offen offset:1024 sc1
buffer_load_dwordx4 v[136:139], v243, s[16:19], s52 offen offset:2048 sc1
buffer_load_dwordx4 v[140:143], v243, s[16:19], s52 offen offset:3072 sc1
s_add_u32 s52, s52, 4096
buffer_load_dwordx4 v[144:147], v243, s[16:19], s52 offen offset:0 sc1
buffer_load_dwordx4 v[148:151], v243, s[16:19], s52 offen offset:1024 sc1
buffer_load_dwordx4 v[152:155], v243, s[16:19], s52 offen offset:2048 sc1
buffer_load_dwordx4 v[156:159], v243, s[16:19], s52 offen offset:3072 sc1
s_add_u32 s52, s52, 4096
buffer_load_dwordx2 v[0:1], v243, s[16:19], s52 offen sc1
v_lshrrev_b32 v176, 4, v243
v_and_b32 v176, 0x30, v176
s_waitcnt vmcnt(0)
v_max_f32 v175, v172, v0
v_sub_f32 v2, v172, v175
v_sub_f32 v3, v0, v175
v_mov_b32 v172, v175
v_exp_f32 v2, v2
v_exp_f32 v3, v3
s_nop 0
v_mul_f32 v173, v173, v2
v_fmac_f32 v173, v1, v3
ds_bpermute_b32 v4, v176, v2 offset:0
ds_bpermute_b32 v8, v176, v3 offset:0
ds_bpermute_b32 v5, v176, v2 offset:4
ds_bpermute_b32 v9, v176, v3 offset:4
ds_bpermute_b32 v6, v176, v2 offset:8
ds_bpermute_b32 v10, v176, v3 offset:8
ds_bpermute_b32 v7, v176, v2 offset:12
ds_bpermute_b32 v11, v176, v3 offset:12
s_waitcnt lgkmcnt(0)
v_accvgpr_read_b32 v180, a0
v_accvgpr_read_b32 v181, a1
v_accvgpr_read_b32 v182, a2
v_accvgpr_read_b32 v183, a3
v_accvgpr_read_b32 v184, a4
v_accvgpr_read_b32 v185, a5
v_accvgpr_read_b32 v186, a6
v_accvgpr_read_b32 v187, a7
v_mul_f32 v180, v180, v4
v_mul_f32 v181, v181, v5
v_mul_f32 v182, v182, v6
v_mul_f32 v183, v183, v7
v_mul_f32 v184, v184, v4
v_mul_f32 v185, v185, v5
v_mul_f32 v186, v186, v6
v_mul_f32 v187, v187, v7
v_fmac_f32 v180, v96, v8
v_fmac_f32 v181, v97, v9
v_fmac_f32 v182, v98, v10
v_fmac_f32 v183, v99, v11
v_fmac_f32 v184, v100, v8
v_fmac_f32 v185, v101, v9
v_fmac_f32 v186, v102, v10
v_fmac_f32 v187, v103, v11
v_cvt_pk_bf16_f32 v32, v180, v181
v_cvt_pk_bf16_f32 v33, v182, v183
v_cvt_pk_bf16_f32 v34, v184, v185
v_cvt_pk_bf16_f32 v35, v186, v187
buffer_store_dwordx4 v[32:35], v243, s[20:23], s40 offen offset:0 sc1
v_accvgpr_read_b32 v180, a8
v_accvgpr_read_b32 v181, a9
v_accvgpr_read_b32 v182, a10
v_accvgpr_read_b32 v183, a11
v_accvgpr_read_b32 v184, a12
v_accvgpr_read_b32 v185, a13
v_accvgpr_read_b32 v186, a14
v_accvgpr_read_b32 v187, a15
v_mul_f32 v180, v180, v4
v_mul_f32 v181, v181, v5
v_mul_f32 v182, v182, v6
v_mul_f32 v183, v183, v7
v_mul_f32 v184, v184, v4
v_mul_f32 v185, v185, v5
v_mul_f32 v186, v186, v6
v_mul_f32 v187, v187, v7
v_fmac_f32 v180, v104, v8
v_fmac_f32 v181, v105, v9
v_fmac_f32 v182, v106, v10
v_fmac_f32 v183, v107, v11
v_fmac_f32 v184, v108, v8
v_fmac_f32 v185, v109, v9
v_fmac_f32 v186, v110, v10
v_fmac_f32 v187, v111, v11
v_cvt_pk_bf16_f32 v36, v180, v181
v_cvt_pk_bf16_f32 v37, v182, v183
v_cvt_pk_bf16_f32 v38, v184, v185
v_cvt_pk_bf16_f32 v39, v186, v187
buffer_store_dwordx4 v[36:39], v243, s[20:23], s40 offen offset:1024 sc1
v_accvgpr_read_b32 v180, a16
v_accvgpr_read_b32 v181, a17
v_accvgpr_read_b32 v182, a18
v_accvgpr_read_b32 v183, a19
v_accvgpr_read_b32 v184, a20
v_accvgpr_read_b32 v185, a21
v_accvgpr_read_b32 v186, a22
v_accvgpr_read_b32 v187, a23
v_mul_f32 v180, v180, v4
v_mul_f32 v181, v181, v5
v_mul_f32 v182, v182, v6
v_mul_f32 v183, v183, v7
v_mul_f32 v184, v184, v4
v_mul_f32 v185, v185, v5
v_mul_f32 v186, v186, v6
v_mul_f32 v187, v187, v7
v_fmac_f32 v180, v112, v8
v_fmac_f32 v181, v113, v9
v_fmac_f32 v182, v114, v10
v_fmac_f32 v183, v115, v11
v_fmac_f32 v184, v116, v8
v_fmac_f32 v185, v117, v9
v_fmac_f32 v186, v118, v10
v_fmac_f32 v187, v119, v11
v_cvt_pk_bf16_f32 v40, v180, v181
v_cvt_pk_bf16_f32 v41, v182, v183
v_cvt_pk_bf16_f32 v42, v184, v185
v_cvt_pk_bf16_f32 v43, v186, v187
buffer_store_dwordx4 v[40:43], v243, s[20:23], s40 offen offset:2048 sc1
v_accvgpr_read_b32 v180, a24
v_accvgpr_read_b32 v181, a25
v_accvgpr_read_b32 v182, a26
v_accvgpr_read_b32 v183, a27
v_accvgpr_read_b32 v184, a28
v_accvgpr_read_b32 v185, a29
v_accvgpr_read_b32 v186, a30
v_accvgpr_read_b32 v187, a31
v_mul_f32 v180, v180, v4
v_mul_f32 v181, v181, v5
v_mul_f32 v182, v182, v6
v_mul_f32 v183, v183, v7
v_mul_f32 v184, v184, v4
v_mul_f32 v185, v185, v5
v_mul_f32 v186, v186, v6
v_mul_f32 v187, v187, v7
v_fmac_f32 v180, v120, v8
v_fmac_f32 v181, v121, v9
v_fmac_f32 v182, v122, v10
v_fmac_f32 v183, v123, v11
v_fmac_f32 v184, v124, v8
v_fmac_f32 v185, v125, v9
v_fmac_f32 v186, v126, v10
v_fmac_f32 v187, v127, v11
v_cvt_pk_bf16_f32 v44, v180, v181
v_cvt_pk_bf16_f32 v45, v182, v183
v_cvt_pk_bf16_f32 v46, v184, v185
v_cvt_pk_bf16_f32 v47, v186, v187
buffer_store_dwordx4 v[44:47], v243, s[20:23], s40 offen offset:3072 sc1
v_accvgpr_read_b32 v180, a32
v_accvgpr_read_b32 v181, a33
v_accvgpr_read_b32 v182, a34
v_accvgpr_read_b32 v183, a35
v_accvgpr_read_b32 v184, a36
v_accvgpr_read_b32 v185, a37
v_accvgpr_read_b32 v186, a38
v_accvgpr_read_b32 v187, a39
v_mul_f32 v180, v180, v4
v_mul_f32 v181, v181, v5
v_mul_f32 v182, v182, v6
v_mul_f32 v183, v183, v7
v_mul_f32 v184, v184, v4
v_mul_f32 v185, v185, v5
v_mul_f32 v186, v186, v6
v_mul_f32 v187, v187, v7
v_fmac_f32 v180, v128, v8
v_fmac_f32 v181, v129, v9
v_fmac_f32 v182, v130, v10
v_fmac_f32 v183, v131, v11
v_fmac_f32 v184, v132, v8
v_fmac_f32 v185, v133, v9
v_fmac_f32 v186, v134, v10
v_fmac_f32 v187, v135, v11
v_cvt_pk_bf16_f32 v48, v180, v181
v_cvt_pk_bf16_f32 v49, v182, v183
v_cvt_pk_bf16_f32 v50, v184, v185
v_cvt_pk_bf16_f32 v51, v186, v187
buffer_store_dwordx4 v[48:51], v243, s[20:23], s44 offen offset:0 sc1
v_accvgpr_read_b32 v180, a40
v_accvgpr_read_b32 v181, a41
v_accvgpr_read_b32 v182, a42
v_accvgpr_read_b32 v183, a43
v_accvgpr_read_b32 v184, a44
v_accvgpr_read_b32 v185, a45
v_accvgpr_read_b32 v186, a46
v_accvgpr_read_b32 v187, a47
v_mul_f32 v180, v180, v4
v_mul_f32 v181, v181, v5
v_mul_f32 v182, v182, v6
v_mul_f32 v183, v183, v7
v_mul_f32 v184, v184, v4
v_mul_f32 v185, v185, v5
v_mul_f32 v186, v186, v6
v_mul_f32 v187, v187, v7
v_fmac_f32 v180, v136, v8
v_fmac_f32 v181, v137, v9
v_fmac_f32 v182, v138, v10
v_fmac_f32 v183, v139, v11
v_fmac_f32 v184, v140, v8
v_fmac_f32 v185, v141, v9
v_fmac_f32 v186, v142, v10
v_fmac_f32 v187, v143, v11
v_cvt_pk_bf16_f32 v52, v180, v181
v_cvt_pk_bf16_f32 v53, v182, v183
v_cvt_pk_bf16_f32 v54, v184, v185
v_cvt_pk_bf16_f32 v55, v186, v187
buffer_store_dwordx4 v[52:55], v243, s[20:23], s44 offen offset:1024 sc1
v_accvgpr_read_b32 v180, a48
v_accvgpr_read_b32 v181, a49
v_accvgpr_read_b32 v182, a50
v_accvgpr_read_b32 v183, a51
v_accvgpr_read_b32 v184, a52
v_accvgpr_read_b32 v185, a53
v_accvgpr_read_b32 v186, a54
v_accvgpr_read_b32 v187, a55
v_mul_f32 v180, v180, v4
v_mul_f32 v181, v181, v5
v_mul_f32 v182, v182, v6
v_mul_f32 v183, v183, v7
v_mul_f32 v184, v184, v4
v_mul_f32 v185, v185, v5
v_mul_f32 v186, v186, v6
v_mul_f32 v187, v187, v7
v_fmac_f32 v180, v144, v8
v_fmac_f32 v181, v145, v9
v_fmac_f32 v182, v146, v10
v_fmac_f32 v183, v147, v11
v_fmac_f32 v184, v148, v8
v_fmac_f32 v185, v149, v9
v_fmac_f32 v186, v150, v10
v_fmac_f32 v187, v151, v11
v_cvt_pk_bf16_f32 v56, v180, v181
v_cvt_pk_bf16_f32 v57, v182, v183
v_cvt_pk_bf16_f32 v58, v184, v185
v_cvt_pk_bf16_f32 v59, v186, v187
buffer_store_dwordx4 v[56:59], v243, s[20:23], s44 offen offset:2048 sc1
v_accvgpr_read_b32 v180, a56
v_accvgpr_read_b32 v181, a57
v_accvgpr_read_b32 v182, a58
v_accvgpr_read_b32 v183, a59
v_accvgpr_read_b32 v184, a60
v_accvgpr_read_b32 v185, a61
v_accvgpr_read_b32 v186, a62
v_accvgpr_read_b32 v187, a63
v_mul_f32 v180, v180, v4
v_mul_f32 v181, v181, v5
v_mul_f32 v182, v182, v6
v_mul_f32 v183, v183, v7
v_mul_f32 v184, v184, v4
v_mul_f32 v185, v185, v5
v_mul_f32 v186, v186, v6
v_mul_f32 v187, v187, v7
v_fmac_f32 v180, v152, v8
v_fmac_f32 v181, v153, v9
v_fmac_f32 v182, v154, v10
v_fmac_f32 v183, v155, v11
v_fmac_f32 v184, v156, v8
v_fmac_f32 v185, v157, v9
v_fmac_f32 v186, v158, v10
v_fmac_f32 v187, v159, v11
v_cvt_pk_bf16_f32 v60, v180, v181
v_cvt_pk_bf16_f32 v61, v182, v183
v_cvt_pk_bf16_f32 v62, v184, v185
v_cvt_pk_bf16_f32 v63, v186, v187
buffer_store_dwordx4 v[60:63], v243, s[20:23], s44 offen offset:3072 sc1
v_mov_b32 v176, v173
s_nop 1
v_permlane32_swap_b32 v173, v176
s_nop 1
v_add_f32 v173, v173, v176
v_mov_b32 v176, v173
s_nop 1
v_permlane16_swap_b32 v173, v176
s_nop 1
v_add_f32 v173, v173, v176
v_lshlrev_b32 v175, 2, v243
s_mov_b64 exec, 0xffff
s_mov_b64 exec, -1
v_bfe_u32 v175, v243, 8, 1
v_mul_u32_u24 v175, 48, v175
v_lshl_add_u32 v175, s37, 3, v175
v_and_b32 v176, 0xf0, v243
v_lshl_add_u32 v175, v176, 3, v175
s_mov_b32 exec_hi, 0
buffer_store_dwordx2 v[172:173], v175, s[24:27], s48 offen sc1
s_add_u32 s16, s4, 0x7c00000
s_addc_u32 s17, s5, 0
s_mov_b32 s18, 0x40000
s_mov_b32 s19, 0x00020000
s_add_u32 s48, s37, 1248
s_mul_i32 s48, s48, 128
s_waitcnt vmcnt(0)
v_mov_b32 v176, s98
v_mov_b32 v177, s99
s_mov_b64 exec, 1
buffer_store_dwordx2 v[176:177], off, s[16:19], s48 sc1
buffer_store_dwordx2 v[176:177], off, s[16:19], s48 offset:8 sc1
s_mov_b64 exec, -1
s_branch L2_fin
LE_start:
s_cmp_ge_u32 s37, 32
s_cbranch_scc1 L2_end
v_lshrrev_b32 v1, 6, v0
s_sub_u32 s37, s37, 30
s_lshl_b32 s35, s35, 1
v_readfirstlane_b32 s41, v1
s_add_u32 s35, s35, s37
s_mul_i32 s35, s35, 3
s_add_u32 s40, s35, s41
s_cmp_ge_u32 s41, 3
s_cbranch_scc1 L2_end
LE_common:
v_and_b32 v1, 63, v0
s_sub_u32 s36, s40, 0
s_mov_b32 s54, 151
s_mul_i32 s36, s36, 151
s_mov_b32 s55, s36
s_sub_u32 s36, s40, 36
s_cselect_b32 s54, s54, 166
s_mul_i32 s36, s36, 166
s_add_u32 s36, s36, 5436
s_cmp_lt_u32 s40, 36
s_cselect_b32 s55, s55, s36
s_sub_u32 s36, s40, 42
s_cselect_b32 s54, s54, 152
s_mul_i32 s36, s36, 152
s_add_u32 s36, s36, 6432
s_cmp_lt_u32 s40, 42
s_cselect_b32 s55, s55, s36
s_sub_u32 s36, s40, 48
s_cselect_b32 s54, s54, 168
s_mul_i32 s36, s36, 168
s_add_u32 s36, s36, 7344
s_cmp_lt_u32 s40, 48
s_cselect_b32 s55, s55, s36
s_mov_b32 s42, 0
s_mov_b32 s49, 512
v_lshrrev_b32 v33, 2, v1
v_and_b32 v34, 3, v1
v_mul_u32_u24 v6, 0xa000, v33
v_lshl_add_u32 v6, v34, 4, v6
v_lshlrev_b32 v33, 2, v33
s_mul_i32 s50, s40, 655360
s_mul_i32 s48, s40, 64
s_waitcnt lgkmcnt(0)
s_add_u32 s8, s4, 0x7c31800
s_addc_u32 s9, s5, 0
s_mov_b32 s10, 0x800
s_mov_b32 s11, 0x00020000
v_and_b32 v194, 15, v0
v_lshlrev_b32 v194, 7, v194
s_mov_b32 s94, 0x10000
LE_poll0:
buffer_load_dwordx2 v[192:193], v194, s[8:11], 0 offen sc1
s_sub_u32 s94, s94, 1
s_waitcnt vmcnt(0)
s_cbranch_scc1 LE_poll0_go
v_cmp_ne_u64 vcc, s[98:99], v[192:193]
s_nop 1
s_cbranch_vccnz LE_poll0
LE_poll0_go:
s_add_u32 s8, s4, 0x7800000
s_addc_u32 s9, s5, 0
s_mov_b32 s10, 0x1000
s_mov_b32 s11, 0x00020000
s_add_u32 s12, s4, 0x8000000
s_addc_u32 s13, s5, 0
s_mov_b32 s14, 0x2800000
s_mov_b32 s15, 0x00020000
buffer_load_dword v4, v33, s[8:11], s48 offen sc1
buffer_load_dwordx4 v[192:195], v6, s[12:15], s50 offen offset:0 sc1
buffer_load_dwordx4 v[196:199], v6, s[12:15], s50 offen offset:64 sc1
buffer_load_dwordx4 v[200:203], v6, s[12:15], s50 offen offset:128 sc1
buffer_load_dwordx4 v[204:207], v6, s[12:15], s50 offen offset:192 sc1
buffer_load_dwordx4 v[208:211], v6, s[12:15], s50 offen offset:256 sc1
buffer_load_dwordx4 v[212:215], v6, s[12:15], s50 offen offset:320 sc1
buffer_load_dwordx4 v[216:219], v6, s[12:15], s50 offen offset:384 sc1
buffer_load_dwordx4 v[220:223], v6, s[12:15], s50 offen offset:448 sc1
buffer_load_dwordx4 v[224:227], v6, s[12:15], s50 offen offset:512 sc1
buffer_load_dwordx4 v[228:231], v6, s[12:15], s50 offen offset:576 sc1
buffer_load_dwordx4 v[232:235], v6, s[12:15], s50 offen offset:640 sc1
buffer_load_dwordx4 v[236:239], v6, s[12:15], s50 offen offset:704 sc1
buffer_load_dwordx4 v[240:243], v6, s[12:15], s50 offen offset:768 sc1
buffer_load_dwordx4 v[244:247], v6, s[12:15], s50 offen offset:832 sc1
buffer_load_dwordx4 v[248:251], v6, s[12:15], s50 offen offset:896 sc1
buffer_load_dwordx4 v[252:255], v6, s[12:15], s50 offen offset:960 sc1
s_add_u32 s16, s4, 0x6800000
s_addc_u32 s17, s5, 0
s_mov_b32 s18, 0x4e2000
s_mov_b32 s19, 0x00020000
s_add_u32 s20, s4, 0x7000000
s_addc_u32 s21, s5, 0
s_mov_b32 s22, 0x4e2000
s_mov_b32 s23, 0x00020000
v_lshlrev_b32 v5, 2, v34
v_and_b32 v2, 15, v1
v_lshrrev_b32 v3, 4, v1
v_mov_b32 v16, 1
v_mov_b32 v17, 4
v_and_b32 v33, 1, v2
v_lshlrev_b32 v33, 4, v33
v_lshlrev_b32 v33, v33, v16
v_mul_u32_u24 v33, 0x3f80, v33
v_lshrrev_b32 v34, 1, v2
v_cmp_eq_u32 vcc, 0, v34
s_nop 1
v_cndmask_b32 v40, 0, v33, vcc
v_cmp_eq_u32 vcc, 1, v34
s_nop 1
v_cndmask_b32 v41, 0, v33, vcc
v_cmp_eq_u32 vcc, 2, v34
s_nop 1
v_cndmask_b32 v42, 0, v33, vcc
v_cmp_eq_u32 vcc, 3, v34
s_nop 1
v_cndmask_b32 v43, 0, v33, vcc
v_cmp_eq_u32 vcc, 4, v34
s_nop 1
v_cndmask_b32 v44, 0, v33, vcc
v_cmp_eq_u32 vcc, 5, v34
s_nop 1
v_cndmask_b32 v45, 0, v33, vcc
v_cmp_eq_u32 vcc, 6, v34
s_nop 1
v_cndmask_b32 v46, 0, v33, vcc
v_cmp_eq_u32 vcc, 7, v34
s_nop 1
v_cndmask_b32 v47, 0, v33, vcc
v_lshlrev_b32 v39, 5, v2
v_lshl_add_u32 v39, v3, 3, v39
v_lshlrev_b32 v2, 4, v2
s_mul_i32 s48, s41, 21504
s_add_u32 s48, s48, 4096
v_mov_b32 v36, s48
v_lshl_add_u32 v38, v3, 2, v36
s_lshl_b32 s36, s41, 10
s_lshl_b32 s35, s55, 2
s_sub_u32 s35, s36, s35
v_mov_b32 v7, s35
v_lshlrev_b32 v35, 4, v1
v_add_u32 v68, s48, v35
v_add_u32 v35, s36, v35
v_lshlrev_b32 v33, 2, v1
v_mov_b32 v72, 0xffff
v_mov_b32 v73, 0xffff
v_mov_b32 v74, 0xffff
v_mov_b32 v75, 0xffff
v_cmp_gt_u32 vcc, s54, v33
v_mov_b32 v48, 0
s_nop 0
v_cndmask_b32 v18, 0, v16, vcc
v_add_u32 v33, 1, v33
v_cmp_gt_u32 vcc, s54, v33
v_mov_b32 v49, 0
s_nop 0
v_cndmask_b32 v19, 0, v16, vcc
v_add_u32 v33, 1, v33
v_cmp_gt_u32 vcc, s54, v33
v_mov_b32 v50, 0
s_nop 0
v_cndmask_b32 v20, 0, v16, vcc
v_add_u32 v33, 1, v33
v_cmp_gt_u32 vcc, s54, v33
v_mov_b32 v51, 0
s_nop 0
v_cndmask_b32 v21, 0, v16, vcc
LE_pass:
ds_write_b128 v35, v[48:51]
ds_write_b128 v68, v[72:75] offset:0
ds_write_b128 v68, v[72:75] offset:1024
ds_write_b128 v68, v[72:75] offset:2048
ds_write_b128 v68, v[72:75] offset:3072
ds_write_b128 v68, v[72:75] offset:4096
ds_write_b128 v68, v[72:75] offset:5120
ds_write_b128 v68, v[72:75] offset:6144
ds_write_b128 v68, v[72:75] offset:7168
ds_write_b128 v68, v[72:75] offset:8192
ds_write_b128 v68, v[72:75] offset:9216
ds_write_b128 v68, v[72:75] offset:10240
ds_write_b128 v68, v[72:75] offset:11264
ds_write_b128 v68, v[72:75] offset:12288
ds_write_b128 v68, v[72:75] offset:13312
ds_write_b128 v68, v[72:75] offset:14336
ds_write_b128 v68, v[72:75] offset:15360
ds_write_b128 v68, v[72:75] offset:16384
ds_write_b128 v68, v[72:75] offset:17408
ds_write_b128 v68, v[72:75] offset:18432
ds_write_b128 v68, v[72:75] offset:19456
v_lshl_add_u32 v32, v1, 2, v36
ds_write_b32 v32, v48 offset:20480
s_waitcnt vmcnt(16)
v_sub_u32 v32, v4, v5
s_waitcnt vmcnt(15)
v_cmpx_lt_i32 vcc, 0, v32
s_cbranch_execz LE_c
v_mad_u32_u16 v128, v192, 1, v7 op_sel:[1,0,0,0]
ds_add_u32 v128, v16
v_cmpx_lt_i32 vcc, 1, v32
v_mad_u32_u16 v129, v193, 1, v7 op_sel:[1,0,0,0]
ds_add_u32 v129, v16
v_cmpx_lt_i32 vcc, 2, v32
v_mad_u32_u16 v130, v194, 1, v7 op_sel:[1,0,0,0]
ds_add_u32 v130, v16
v_cmpx_lt_i32 vcc, 3, v32
v_mad_u32_u16 v131, v195, 1, v7 op_sel:[1,0,0,0]
ds_add_u32 v131, v16
s_waitcnt vmcnt(14)
v_cmpx_lt_i32 vcc, 16, v32
s_cbranch_execz LE_c
v_mad_u32_u16 v132, v196, 1, v7 op_sel:[1,0,0,0]
ds_add_u32 v132, v16
v_cmpx_lt_i32 vcc, 17, v32
v_mad_u32_u16 v133, v197, 1, v7 op_sel:[1,0,0,0]
ds_add_u32 v133, v16
v_cmpx_lt_i32 vcc, 18, v32
v_mad_u32_u16 v134, v198, 1, v7 op_sel:[1,0,0,0]
ds_add_u32 v134, v16
v_cmpx_lt_i32 vcc, 19, v32
v_mad_u32_u16 v135, v199, 1, v7 op_sel:[1,0,0,0]
ds_add_u32 v135, v16
s_waitcnt vmcnt(13)
v_cmpx_lt_i32 vcc, 32, v32
s_cbranch_execz LE_c
v_mad_u32_u16 v136, v200, 1, v7 op_sel:[1,0,0,0]
ds_add_u32 v136, v16
v_cmpx_lt_i32 vcc, 33, v32
v_mad_u32_u16 v137, v201, 1, v7 op_sel:[1,0,0,0]
ds_add_u32 v137, v16
v_cmpx_lt_i32 vcc, 34, v32
v_mad_u32_u16 v138, v202, 1, v7 op_sel:[1,0,0,0]
ds_add_u32 v138, v16
v_cmpx_lt_i32 vcc, 35, v32
v_mad_u32_u16 v139, v203, 1, v7 op_sel:[1,0,0,0]
ds_add_u32 v139, v16
s_waitcnt vmcnt(12)
v_cmpx_lt_i32 vcc, 48, v32
s_cbranch_execz LE_c
v_mad_u32_u16 v140, v204, 1, v7 op_sel:[1,0,0,0]
ds_add_u32 v140, v16
v_cmpx_lt_i32 vcc, 49, v32
v_mad_u32_u16 v141, v205, 1, v7 op_sel:[1,0,0,0]
ds_add_u32 v141, v16
v_cmpx_lt_i32 vcc, 50, v32
v_mad_u32_u16 v142, v206, 1, v7 op_sel:[1,0,0,0]
ds_add_u32 v142, v16
v_cmpx_lt_i32 vcc, 51, v32
v_mad_u32_u16 v143, v207, 1, v7 op_sel:[1,0,0,0]
ds_add_u32 v143, v16
s_waitcnt vmcnt(11)
v_cmpx_lt_i32 vcc, 64, v32
s_cbranch_execz LE_c
v_mad_u32_u16 v144, v208, 1, v7 op_sel:[1,0,0,0]
ds_add_u32 v144, v16
v_cmpx_lt_i32 vcc, 65, v32
v_mad_u32_u16 v145, v209, 1, v7 op_sel:[1,0,0,0]
ds_add_u32 v145, v16
v_cmpx_lt_i32 vcc, 66, v32
v_mad_u32_u16 v146, v210, 1, v7 op_sel:[1,0,0,0]
ds_add_u32 v146, v16
v_cmpx_lt_i32 vcc, 67, v32
v_mad_u32_u16 v147, v211, 1, v7 op_sel:[1,0,0,0]
ds_add_u32 v147, v16
s_waitcnt vmcnt(10)
v_cmpx_lt_i32 vcc, 80, v32
s_cbranch_execz LE_c
v_mad_u32_u16 v148, v212, 1, v7 op_sel:[1,0,0,0]
ds_add_u32 v148, v16
v_cmpx_lt_i32 vcc, 81, v32
v_mad_u32_u16 v149, v213, 1, v7 op_sel:[1,0,0,0]
ds_add_u32 v149, v16
v_cmpx_lt_i32 vcc, 82, v32
v_mad_u32_u16 v150, v214, 1, v7 op_sel:[1,0,0,0]
ds_add_u32 v150, v16
v_cmpx_lt_i32 vcc, 83, v32
v_mad_u32_u16 v151, v215, 1, v7 op_sel:[1,0,0,0]
ds_add_u32 v151, v16
s_waitcnt vmcnt(9)
v_cmpx_lt_i32 vcc, 96, v32
s_cbranch_execz LE_c
v_mad_u32_u16 v152, v216, 1, v7 op_sel:[1,0,0,0]
ds_add_u32 v152, v16
v_cmpx_lt_i32 vcc, 97, v32
v_mad_u32_u16 v153, v217, 1, v7 op_sel:[1,0,0,0]
ds_add_u32 v153, v16
v_cmpx_lt_i32 vcc, 98, v32
v_mad_u32_u16 v154, v218, 1, v7 op_sel:[1,0,0,0]
ds_add_u32 v154, v16
v_cmpx_lt_i32 vcc, 99, v32
v_mad_u32_u16 v155, v219, 1, v7 op_sel:[1,0,0,0]
ds_add_u32 v155, v16
s_waitcnt vmcnt(8)
v_cmpx_lt_i32 vcc, 112, v32
s_cbranch_execz LE_c
v_mad_u32_u16 v156, v220, 1, v7 op_sel:[1,0,0,0]
ds_add_u32 v156, v16
v_cmpx_lt_i32 vcc, 113, v32
v_mad_u32_u16 v157, v221, 1, v7 op_sel:[1,0,0,0]
ds_add_u32 v157, v16
v_cmpx_lt_i32 vcc, 114, v32
v_mad_u32_u16 v158, v222, 1, v7 op_sel:[1,0,0,0]
ds_add_u32 v158, v16
v_cmpx_lt_i32 vcc, 115, v32
v_mad_u32_u16 v159, v223, 1, v7 op_sel:[1,0,0,0]
ds_add_u32 v159, v16
s_waitcnt vmcnt(7)
v_cmpx_lt_i32 vcc, 128, v32
s_cbranch_execz LE_c
v_mad_u32_u16 v160, v224, 1, v7 op_sel:[1,0,0,0]
ds_add_u32 v160, v16
v_cmpx_lt_i32 vcc, 129, v32
v_mad_u32_u16 v161, v225, 1, v7 op_sel:[1,0,0,0]
ds_add_u32 v161, v16
v_cmpx_lt_i32 vcc, 130, v32
v_mad_u32_u16 v162, v226, 1, v7 op_sel:[1,0,0,0]
ds_add_u32 v162, v16
v_cmpx_lt_i32 vcc, 131, v32
v_mad_u32_u16 v163, v227, 1, v7 op_sel:[1,0,0,0]
ds_add_u32 v163, v16
s_waitcnt vmcnt(6)
v_cmpx_lt_i32 vcc, 144, v32
s_cbranch_execz LE_c
v_mad_u32_u16 v164, v228, 1, v7 op_sel:[1,0,0,0]
ds_add_u32 v164, v16
v_cmpx_lt_i32 vcc, 145, v32
v_mad_u32_u16 v165, v229, 1, v7 op_sel:[1,0,0,0]
ds_add_u32 v165, v16
v_cmpx_lt_i32 vcc, 146, v32
v_mad_u32_u16 v166, v230, 1, v7 op_sel:[1,0,0,0]
ds_add_u32 v166, v16
v_cmpx_lt_i32 vcc, 147, v32
v_mad_u32_u16 v167, v231, 1, v7 op_sel:[1,0,0,0]
ds_add_u32 v167, v16
s_waitcnt vmcnt(5)
v_cmpx_lt_i32 vcc, 160, v32
s_cbranch_execz LE_c
v_mad_u32_u16 v168, v232, 1, v7 op_sel:[1,0,0,0]
ds_add_u32 v168, v16
v_cmpx_lt_i32 vcc, 161, v32
v_mad_u32_u16 v169, v233, 1, v7 op_sel:[1,0,0,0]
ds_add_u32 v169, v16
v_cmpx_lt_i32 vcc, 162, v32
v_mad_u32_u16 v170, v234, 1, v7 op_sel:[1,0,0,0]
ds_add_u32 v170, v16
v_cmpx_lt_i32 vcc, 163, v32
v_mad_u32_u16 v171, v235, 1, v7 op_sel:[1,0,0,0]
ds_add_u32 v171, v16
s_waitcnt vmcnt(4)
v_cmpx_lt_i32 vcc, 176, v32
s_cbranch_execz LE_c
v_mad_u32_u16 v172, v236, 1, v7 op_sel:[1,0,0,0]
ds_add_u32 v172, v16
v_cmpx_lt_i32 vcc, 177, v32
v_mad_u32_u16 v173, v237, 1, v7 op_sel:[1,0,0,0]
ds_add_u32 v173, v16
v_cmpx_lt_i32 vcc, 178, v32
v_mad_u32_u16 v174, v238, 1, v7 op_sel:[1,0,0,0]
ds_add_u32 v174, v16
v_cmpx_lt_i32 vcc, 179, v32
v_mad_u32_u16 v175, v239, 1, v7 op_sel:[1,0,0,0]
ds_add_u32 v175, v16
s_waitcnt vmcnt(3)
v_cmpx_lt_i32 vcc, 192, v32
s_cbranch_execz LE_c
v_mad_u32_u16 v176, v240, 1, v7 op_sel:[1,0,0,0]
ds_add_u32 v176, v16
v_cmpx_lt_i32 vcc, 193, v32
v_mad_u32_u16 v177, v241, 1, v7 op_sel:[1,0,0,0]
ds_add_u32 v177, v16
v_cmpx_lt_i32 vcc, 194, v32
v_mad_u32_u16 v178, v242, 1, v7 op_sel:[1,0,0,0]
ds_add_u32 v178, v16
v_cmpx_lt_i32 vcc, 195, v32
v_mad_u32_u16 v179, v243, 1, v7 op_sel:[1,0,0,0]
ds_add_u32 v179, v16
s_waitcnt vmcnt(2)
v_cmpx_lt_i32 vcc, 208, v32
s_cbranch_execz LE_c
v_mad_u32_u16 v180, v244, 1, v7 op_sel:[1,0,0,0]
ds_add_u32 v180, v16
v_cmpx_lt_i32 vcc, 209, v32
v_mad_u32_u16 v181, v245, 1, v7 op_sel:[1,0,0,0]
ds_add_u32 v181, v16
v_cmpx_lt_i32 vcc, 210, v32
v_mad_u32_u16 v182, v246, 1, v7 op_sel:[1,0,0,0]
ds_add_u32 v182, v16
v_cmpx_lt_i32 vcc, 211, v32
v_mad_u32_u16 v183, v247, 1, v7 op_sel:[1,0,0,0]
ds_add_u32 v183, v16
s_waitcnt vmcnt(1)
v_cmpx_lt_i32 vcc, 224, v32
s_cbranch_execz LE_c
v_mad_u32_u16 v184, v248, 1, v7 op_sel:[1,0,0,0]
ds_add_u32 v184, v16
v_cmpx_lt_i32 vcc, 225, v32
v_mad_u32_u16 v185, v249, 1, v7 op_sel:[1,0,0,0]
ds_add_u32 v185, v16
v_cmpx_lt_i32 vcc, 226, v32
v_mad_u32_u16 v186, v250, 1, v7 op_sel:[1,0,0,0]
ds_add_u32 v186, v16
v_cmpx_lt_i32 vcc, 227, v32
v_mad_u32_u16 v187, v251, 1, v7 op_sel:[1,0,0,0]
ds_add_u32 v187, v16
s_waitcnt vmcnt(0)
v_cmpx_lt_i32 vcc, 240, v32
s_cbranch_execz LE_c
v_mad_u32_u16 v188, v252, 1, v7 op_sel:[1,0,0,0]
ds_add_u32 v188, v16
v_cmpx_lt_i32 vcc, 241, v32
v_mad_u32_u16 v189, v253, 1, v7 op_sel:[1,0,0,0]
ds_add_u32 v189, v16
v_cmpx_lt_i32 vcc, 242, v32
v_mad_u32_u16 v190, v254, 1, v7 op_sel:[1,0,0,0]
ds_add_u32 v190, v16
v_cmpx_lt_i32 vcc, 243, v32
v_mad_u32_u16 v191, v255, 1, v7 op_sel:[1,0,0,0]
ds_add_u32 v191, v16
LE_c:
s_mov_b64 exec, -1
ds_read_b128 v[24:27], v35
s_waitcnt lgkmcnt(0)
v_add_u32 v24, 3, v24
v_lshrrev_b32 v24, 2, v24
v_max_u32 v24, v24, v18
v_add_u32 v25, 3, v25
v_lshrrev_b32 v25, 2, v25
v_max_u32 v25, v25, v19
v_add_u32 v26, 3, v26
v_lshrrev_b32 v26, 2, v26
v_max_u32 v26, v26, v20
v_add_u32 v27, 3, v27
v_lshrrev_b32 v27, 2, v27
v_max_u32 v27, v27, v21
v_add_u32 v33, v24, v25
v_add3_u32 v33, v33, v26, v27
v_mov_b32 v64, v33
s_nop 1
v_add_u32_dpp v64, v64, v64 row_shr:1 row_mask:0xf bank_mask:0xf
s_nop 1
v_add_u32_dpp v64, v64, v64 row_shr:2 row_mask:0xf bank_mask:0xf
s_nop 1
v_add_u32_dpp v64, v64, v64 row_shr:4 row_mask:0xf bank_mask:0xf
s_nop 1
v_add_u32_dpp v64, v64, v64 row_shr:8 row_mask:0xf bank_mask:0xf
s_nop 1
v_add_u32_dpp v64, v64, v64 row_bcast:15 row_mask:0xa bank_mask:0xf
s_nop 1
v_add_u32_dpp v64, v64, v64 row_bcast:31 row_mask:0xc bank_mask:0xf
s_nop 1
v_readlane_b32 s44, v64, 63
v_sub_u32 v28, v64, v33
v_add_u32 v29, v28, v24
v_add_u32 v30, v29, v25
v_add_u32 v31, v30, v26
v_add3_u32 v33, v28, v24, -1
v_lshlrev_b32 v34, v33, v18
v_lshrrev_b32 v33, 5, v33
v_lshl_add_u32 v33, v33, 2, v36
ds_or_b32 v33, v34 offset:20480
v_lshl_add_u32 v28, v28, 4, v36
v_add3_u32 v33, v29, v25, -1
v_lshlrev_b32 v34, v33, v19
v_lshrrev_b32 v33, 5, v33
v_lshl_add_u32 v33, v33, 2, v36
ds_or_b32 v33, v34 offset:20480
v_lshl_add_u32 v29, v29, 4, v36
v_add3_u32 v33, v30, v26, -1
v_lshlrev_b32 v34, v33, v20
v_lshrrev_b32 v33, 5, v33
v_lshl_add_u32 v33, v33, 2, v36
ds_or_b32 v33, v34 offset:20480
v_lshl_add_u32 v30, v30, 4, v36
v_add3_u32 v33, v31, v27, -1
v_lshlrev_b32 v34, v33, v21
v_lshrrev_b32 v33, 5, v33
v_lshl_add_u32 v33, v33, 2, v36
ds_or_b32 v33, v34 offset:20480
v_lshl_add_u32 v31, v31, 4, v36
ds_write_b128 v35, v[28:31]
s_add_u32 s44, s44, 31
s_lshr_b32 s44, s44, 5
v_cmpx_lt_i32 vcc, 0, v32
s_cbranch_execz LE_p
ds_add_rtn_u32 v128, v128, v17
v_cmpx_lt_i32 vcc, 1, v32
ds_add_rtn_u32 v129, v129, v17
v_cmpx_lt_i32 vcc, 2, v32
ds_add_rtn_u32 v130, v130, v17
v_cmpx_lt_i32 vcc, 3, v32
ds_add_rtn_u32 v131, v131, v17
v_cmpx_lt_i32 vcc, 16, v32
s_cbranch_execz LE_p
ds_add_rtn_u32 v132, v132, v17
v_cmpx_lt_i32 vcc, 17, v32
ds_add_rtn_u32 v133, v133, v17
v_cmpx_lt_i32 vcc, 18, v32
ds_add_rtn_u32 v134, v134, v17
v_cmpx_lt_i32 vcc, 19, v32
ds_add_rtn_u32 v135, v135, v17
v_cmpx_lt_i32 vcc, 32, v32
s_cbranch_execz LE_p
ds_add_rtn_u32 v136, v136, v17
v_cmpx_lt_i32 vcc, 33, v32
ds_add_rtn_u32 v137, v137, v17
v_cmpx_lt_i32 vcc, 34, v32
ds_add_rtn_u32 v138, v138, v17
v_cmpx_lt_i32 vcc, 35, v32
ds_add_rtn_u32 v139, v139, v17
v_cmpx_lt_i32 vcc, 48, v32
s_cbranch_execz LE_p
ds_add_rtn_u32 v140, v140, v17
v_cmpx_lt_i32 vcc, 49, v32
ds_add_rtn_u32 v141, v141, v17
v_cmpx_lt_i32 vcc, 50, v32
ds_add_rtn_u32 v142, v142, v17
v_cmpx_lt_i32 vcc, 51, v32
ds_add_rtn_u32 v143, v143, v17
v_cmpx_lt_i32 vcc, 64, v32
s_cbranch_execz LE_p
ds_add_rtn_u32 v144, v144, v17
v_cmpx_lt_i32 vcc, 65, v32
ds_add_rtn_u32 v145, v145, v17
v_cmpx_lt_i32 vcc, 66, v32
ds_add_rtn_u32 v146, v146, v17
v_cmpx_lt_i32 vcc, 67, v32
ds_add_rtn_u32 v147, v147, v17
v_cmpx_lt_i32 vcc, 80, v32
s_cbranch_execz LE_p
ds_add_rtn_u32 v148, v148, v17
v_cmpx_lt_i32 vcc, 81, v32
ds_add_rtn_u32 v149, v149, v17
v_cmpx_lt_i32 vcc, 82, v32
ds_add_rtn_u32 v150, v150, v17
v_cmpx_lt_i32 vcc, 83, v32
ds_add_rtn_u32 v151, v151, v17
v_cmpx_lt_i32 vcc, 96, v32
s_cbranch_execz LE_p
ds_add_rtn_u32 v152, v152, v17
v_cmpx_lt_i32 vcc, 97, v32
ds_add_rtn_u32 v153, v153, v17
v_cmpx_lt_i32 vcc, 98, v32
ds_add_rtn_u32 v154, v154, v17
v_cmpx_lt_i32 vcc, 99, v32
ds_add_rtn_u32 v155, v155, v17
v_cmpx_lt_i32 vcc, 112, v32
s_cbranch_execz LE_p
ds_add_rtn_u32 v156, v156, v17
v_cmpx_lt_i32 vcc, 113, v32
ds_add_rtn_u32 v157, v157, v17
v_cmpx_lt_i32 vcc, 114, v32
ds_add_rtn_u32 v158, v158, v17
v_cmpx_lt_i32 vcc, 115, v32
ds_add_rtn_u32 v159, v159, v17
v_cmpx_lt_i32 vcc, 128, v32
s_cbranch_execz LE_p
ds_add_rtn_u32 v160, v160, v17
v_cmpx_lt_i32 vcc, 129, v32
ds_add_rtn_u32 v161, v161, v17
v_cmpx_lt_i32 vcc, 130, v32
ds_add_rtn_u32 v162, v162, v17
v_cmpx_lt_i32 vcc, 131, v32
ds_add_rtn_u32 v163, v163, v17
v_cmpx_lt_i32 vcc, 144, v32
s_cbranch_execz LE_p
ds_add_rtn_u32 v164, v164, v17
v_cmpx_lt_i32 vcc, 145, v32
ds_add_rtn_u32 v165, v165, v17
v_cmpx_lt_i32 vcc, 146, v32
ds_add_rtn_u32 v166, v166, v17
v_cmpx_lt_i32 vcc, 147, v32
ds_add_rtn_u32 v167, v167, v17
v_cmpx_lt_i32 vcc, 160, v32
s_cbranch_execz LE_p
ds_add_rtn_u32 v168, v168, v17
v_cmpx_lt_i32 vcc, 161, v32
ds_add_rtn_u32 v169, v169, v17
v_cmpx_lt_i32 vcc, 162, v32
ds_add_rtn_u32 v170, v170, v17
v_cmpx_lt_i32 vcc, 163, v32
ds_add_rtn_u32 v171, v171, v17
v_cmpx_lt_i32 vcc, 176, v32
s_cbranch_execz LE_p
ds_add_rtn_u32 v172, v172, v17
v_cmpx_lt_i32 vcc, 177, v32
ds_add_rtn_u32 v173, v173, v17
v_cmpx_lt_i32 vcc, 178, v32
ds_add_rtn_u32 v174, v174, v17
v_cmpx_lt_i32 vcc, 179, v32
ds_add_rtn_u32 v175, v175, v17
v_cmpx_lt_i32 vcc, 192, v32
s_cbranch_execz LE_p
ds_add_rtn_u32 v176, v176, v17
v_cmpx_lt_i32 vcc, 193, v32
ds_add_rtn_u32 v177, v177, v17
v_cmpx_lt_i32 vcc, 194, v32
ds_add_rtn_u32 v178, v178, v17
v_cmpx_lt_i32 vcc, 195, v32
ds_add_rtn_u32 v179, v179, v17
v_cmpx_lt_i32 vcc, 208, v32
s_cbranch_execz LE_p
ds_add_rtn_u32 v180, v180, v17
v_cmpx_lt_i32 vcc, 209, v32
ds_add_rtn_u32 v181, v181, v17
v_cmpx_lt_i32 vcc, 210, v32
ds_add_rtn_u32 v182, v182, v17
v_cmpx_lt_i32 vcc, 211, v32
ds_add_rtn_u32 v183, v183, v17
v_cmpx_lt_i32 vcc, 224, v32
s_cbranch_execz LE_p
ds_add_rtn_u32 v184, v184, v17
v_cmpx_lt_i32 vcc, 225, v32
ds_add_rtn_u32 v185, v185, v17
v_cmpx_lt_i32 vcc, 226, v32
ds_add_rtn_u32 v186, v186, v17
v_cmpx_lt_i32 vcc, 227, v32
ds_add_rtn_u32 v187, v187, v17
v_cmpx_lt_i32 vcc, 240, v32
s_cbranch_execz LE_p
ds_add_rtn_u32 v188, v188, v17
v_cmpx_lt_i32 vcc, 241, v32
ds_add_rtn_u32 v189, v189, v17
v_cmpx_lt_i32 vcc, 242, v32
ds_add_rtn_u32 v190, v190, v17
v_cmpx_lt_i32 vcc, 243, v32
ds_add_rtn_u32 v191, v191, v17
LE_p:
s_mov_b64 exec, -1
v_lshl_add_u32 v33, v1, 2, v36
ds_read_b32 v37, v33 offset:20480
s_waitcnt lgkmcnt(0)
v_cmpx_lt_i32 vcc, 0, v32
s_cbranch_execz LE_w
ds_write_b32 v128, v192
v_cmpx_lt_i32 vcc, 1, v32
ds_write_b32 v129, v193
v_cmpx_lt_i32 vcc, 2, v32
ds_write_b32 v130, v194
v_cmpx_lt_i32 vcc, 3, v32
ds_write_b32 v131, v195
v_cmpx_lt_i32 vcc, 16, v32
s_cbranch_execz LE_w
ds_write_b32 v132, v196
v_cmpx_lt_i32 vcc, 17, v32
ds_write_b32 v133, v197
v_cmpx_lt_i32 vcc, 18, v32
ds_write_b32 v134, v198
v_cmpx_lt_i32 vcc, 19, v32
ds_write_b32 v135, v199
v_cmpx_lt_i32 vcc, 32, v32
s_cbranch_execz LE_w
ds_write_b32 v136, v200
v_cmpx_lt_i32 vcc, 33, v32
ds_write_b32 v137, v201
v_cmpx_lt_i32 vcc, 34, v32
ds_write_b32 v138, v202
v_cmpx_lt_i32 vcc, 35, v32
ds_write_b32 v139, v203
v_cmpx_lt_i32 vcc, 48, v32
s_cbranch_execz LE_w
ds_write_b32 v140, v204
v_cmpx_lt_i32 vcc, 49, v32
ds_write_b32 v141, v205
v_cmpx_lt_i32 vcc, 50, v32
ds_write_b32 v142, v206
v_cmpx_lt_i32 vcc, 51, v32
ds_write_b32 v143, v207
v_cmpx_lt_i32 vcc, 64, v32
s_cbranch_execz LE_w
ds_write_b32 v144, v208
v_cmpx_lt_i32 vcc, 65, v32
ds_write_b32 v145, v209
v_cmpx_lt_i32 vcc, 66, v32
ds_write_b32 v146, v210
v_cmpx_lt_i32 vcc, 67, v32
ds_write_b32 v147, v211
v_cmpx_lt_i32 vcc, 80, v32
s_cbranch_execz LE_w
ds_write_b32 v148, v212
v_cmpx_lt_i32 vcc, 81, v32
ds_write_b32 v149, v213
v_cmpx_lt_i32 vcc, 82, v32
ds_write_b32 v150, v214
v_cmpx_lt_i32 vcc, 83, v32
ds_write_b32 v151, v215
v_cmpx_lt_i32 vcc, 96, v32
s_cbranch_execz LE_w
ds_write_b32 v152, v216
v_cmpx_lt_i32 vcc, 97, v32
ds_write_b32 v153, v217
v_cmpx_lt_i32 vcc, 98, v32
ds_write_b32 v154, v218
v_cmpx_lt_i32 vcc, 99, v32
ds_write_b32 v155, v219
v_cmpx_lt_i32 vcc, 112, v32
s_cbranch_execz LE_w
ds_write_b32 v156, v220
v_cmpx_lt_i32 vcc, 113, v32
ds_write_b32 v157, v221
v_cmpx_lt_i32 vcc, 114, v32
ds_write_b32 v158, v222
v_cmpx_lt_i32 vcc, 115, v32
ds_write_b32 v159, v223
v_cmpx_lt_i32 vcc, 128, v32
s_cbranch_execz LE_w
ds_write_b32 v160, v224
v_cmpx_lt_i32 vcc, 129, v32
ds_write_b32 v161, v225
v_cmpx_lt_i32 vcc, 130, v32
ds_write_b32 v162, v226
v_cmpx_lt_i32 vcc, 131, v32
ds_write_b32 v163, v227
v_cmpx_lt_i32 vcc, 144, v32
s_cbranch_execz LE_w
ds_write_b32 v164, v228
v_cmpx_lt_i32 vcc, 145, v32
ds_write_b32 v165, v229
v_cmpx_lt_i32 vcc, 146, v32
ds_write_b32 v166, v230
v_cmpx_lt_i32 vcc, 147, v32
ds_write_b32 v167, v231
v_cmpx_lt_i32 vcc, 160, v32
s_cbranch_execz LE_w
ds_write_b32 v168, v232
v_cmpx_lt_i32 vcc, 161, v32
ds_write_b32 v169, v233
v_cmpx_lt_i32 vcc, 162, v32
ds_write_b32 v170, v234
v_cmpx_lt_i32 vcc, 163, v32
ds_write_b32 v171, v235
v_cmpx_lt_i32 vcc, 176, v32
s_cbranch_execz LE_w
ds_write_b32 v172, v236
v_cmpx_lt_i32 vcc, 177, v32
ds_write_b32 v173, v237
v_cmpx_lt_i32 vcc, 178, v32
ds_write_b32 v174, v238
v_cmpx_lt_i32 vcc, 179, v32
ds_write_b32 v175, v239
v_cmpx_lt_i32 vcc, 192, v32
s_cbranch_execz LE_w
ds_write_b32 v176, v240
v_cmpx_lt_i32 vcc, 193, v32
ds_write_b32 v177, v241
v_cmpx_lt_i32 vcc, 194, v32
ds_write_b32 v178, v242
v_cmpx_lt_i32 vcc, 195, v32
ds_write_b32 v179, v243
v_cmpx_lt_i32 vcc, 208, v32
s_cbranch_execz LE_w
ds_write_b32 v180, v244
v_cmpx_lt_i32 vcc, 209, v32
ds_write_b32 v181, v245
v_cmpx_lt_i32 vcc, 210, v32
ds_write_b32 v182, v246
v_cmpx_lt_i32 vcc, 211, v32
ds_write_b32 v183, v247
v_cmpx_lt_i32 vcc, 224, v32
s_cbranch_execz LE_w
ds_write_b32 v184, v248
v_cmpx_lt_i32 vcc, 225, v32
ds_write_b32 v185, v249
v_cmpx_lt_i32 vcc, 226, v32
ds_write_b32 v186, v250
v_cmpx_lt_i32 vcc, 227, v32
ds_write_b32 v187, v251
v_cmpx_lt_i32 vcc, 240, v32
s_cbranch_execz LE_w
ds_write_b32 v188, v252
v_cmpx_lt_i32 vcc, 241, v32
ds_write_b32 v189, v253
v_cmpx_lt_i32 vcc, 242, v32
ds_write_b32 v190, v254
v_cmpx_lt_i32 vcc, 243, v32
ds_write_b32 v191, v255
LE_w:
s_mov_b64 exec, -1
s_add_u32 s8, s4, 0x7c2a000
s_addc_u32 s9, s5, 0
s_mov_b32 s10, 0x8000
s_mov_b32 s11, 0x00020000
v_and_b32 v200, 63, v0
v_lshlrev_b32 v200, 7, v200
s_mov_b32 s91, 8192
s_mov_b32 s90, 16384
s_mov_b32 s95, 24576
s_mov_b32 s94, 0x10000
LE_poll:
buffer_load_dwordx2 v[192:193], v200, s[8:11], 0 offen sc1
buffer_load_dwordx2 v[194:195], v200, s[8:11], s91 offen sc1
buffer_load_dwordx2 v[196:197], v200, s[8:11], s90 offen sc1
buffer_load_dwordx2 v[198:199], v200, s[8:11], s95 offen sc1
s_sub_u32 s94, s94, 1
s_waitcnt vmcnt(0)
s_cbranch_scc1 LE_poll_go
v_cmp_ne_u64 vcc, s[98:99], v[192:193]
s_nop 1
s_cbranch_vccnz LE_poll
v_cmp_ne_u64 vcc, s[98:99], v[194:195]
s_nop 1
s_cbranch_vccnz LE_poll
v_cmp_ne_u64 vcc, s[98:99], v[196:197]
s_nop 1
s_cbranch_vccnz LE_poll
v_cmp_ne_u64 vcc, s[98:99], v[198:199]
s_nop 1
s_cbranch_vccnz LE_poll
LE_poll_go:
s_cmp_lg_u32 s40, 0
s_cbranch_scc1 LE_nobump
s_mov_b32 s90, 89984
s_mov_b32 s10, 90112
v_mov_b32 v192, s98
v_mov_b32 v193, s99
s_mov_b64 exec, 1
buffer_store_dwordx2 v[192:193], off, s[8:11], s90 sc1
s_mov_b64 exec, -1
LE_nobump:
v_mov_b32 v34, v38
ds_read2_b32 v[52:53], v34 offset0:0 offset1:4
ds_read2_b32 v[54:55], v34 offset0:8 offset1:12
s_waitcnt lgkmcnt(0)
ds_read2_b32 v[56:57], v34 offset0:16 offset1:20
ds_read2_b32 v[58:59], v34 offset0:24 offset1:28
v_mad_u32_u16 v60, v52, s49, v2
v_mad_u32_u16 v61, v53, s49, v2
v_mad_u32_u16 v62, v54, s49, v2
v_mad_u32_u16 v63, v55, s49, v2
buffer_load_dwordx4 a[0:3], v60, s[16:19], 0 offen sc1
buffer_load_dwordx4 a[4:7], v60, s[16:19], 0 offen offset:256 sc1
buffer_load_dwordx4 a[8:11], v61, s[16:19], 0 offen sc1
buffer_load_dwordx4 a[12:15], v61, s[16:19], 0 offen offset:256 sc1
buffer_load_dwordx4 a[16:19], v62, s[16:19], 0 offen sc1
buffer_load_dwordx4 a[20:23], v62, s[16:19], 0 offen offset:256 sc1
buffer_load_dwordx4 a[24:27], v63, s[16:19], 0 offen sc1
buffer_load_dwordx4 a[28:31], v63, s[16:19], 0 offen offset:256 sc1
s_waitcnt lgkmcnt(0)
ds_read2_b32 v[52:53], v34 offset0:32 offset1:36
ds_read2_b32 v[54:55], v34 offset0:40 offset1:44
v_mad_u32_u16 v60, v56, s49, v2
v_mad_u32_u16 v61, v57, s49, v2
v_mad_u32_u16 v62, v58, s49, v2
v_mad_u32_u16 v63, v59, s49, v2
buffer_load_dwordx4 a[32:35], v60, s[16:19], 0 offen sc1
buffer_load_dwordx4 a[36:39], v60, s[16:19], 0 offen offset:256 sc1
buffer_load_dwordx4 a[40:43], v61, s[16:19], 0 offen sc1
buffer_load_dwordx4 a[44:47], v61, s[16:19], 0 offen offset:256 sc1
buffer_load_dwordx4 a[48:51], v62, s[16:19], 0 offen sc1
buffer_load_dwordx4 a[52:55], v62, s[16:19], 0 offen offset:256 sc1
buffer_load_dwordx4 a[56:59], v63, s[16:19], 0 offen sc1
buffer_load_dwordx4 a[60:63], v63, s[16:19], 0 offen offset:256 sc1
s_waitcnt lgkmcnt(0)
ds_read2_b32 v[56:57], v34 offset0:48 offset1:52
ds_read2_b32 v[58:59], v34 offset0:56 offset1:60
v_mad_u32_u16 v60, v52, s49, v2
v_mad_u32_u16 v61, v53, s49, v2
v_mad_u32_u16 v62, v54, s49, v2
v_mad_u32_u16 v63, v55, s49, v2
buffer_load_dwordx4 a[64:67], v60, s[16:19], 0 offen sc1
buffer_load_dwordx4 a[68:71], v60, s[16:19], 0 offen offset:256 sc1
buffer_load_dwordx4 a[72:75], v61, s[16:19], 0 offen sc1
buffer_load_dwordx4 a[76:79], v61, s[16:19], 0 offen offset:256 sc1
buffer_load_dwordx4 a[80:83], v62, s[16:19], 0 offen sc1
buffer_load_dwordx4 a[84:87], v62, s[16:19], 0 offen offset:256 sc1
buffer_load_dwordx4 a[88:91], v63, s[16:19], 0 offen sc1
buffer_load_dwordx4 a[92:95], v63, s[16:19], 0 offen offset:256 sc1
s_waitcnt lgkmcnt(0)
ds_read2_b32 v[52:53], v34 offset0:64 offset1:68
ds_read2_b32 v[54:55], v34 offset0:72 offset1:76
v_mad_u32_u16 v60, v56, s49, v2
v_mad_u32_u16 v61, v57, s49, v2
v_mad_u32_u16 v62, v58, s49, v2
v_mad_u32_u16 v63, v59, s49, v2
buffer_load_dwordx4 a[96:99], v60, s[16:19], 0 offen sc1
buffer_load_dwordx4 a[100:103], v60, s[16:19], 0 offen offset:256 sc1
buffer_load_dwordx4 a[104:107], v61, s[16:19], 0 offen sc1
buffer_load_dwordx4 a[108:111], v61, s[16:19], 0 offen offset:256 sc1
buffer_load_dwordx4 a[112:115], v62, s[16:19], 0 offen sc1
buffer_load_dwordx4 a[116:119], v62, s[16:19], 0 offen offset:256 sc1
buffer_load_dwordx4 a[120:123], v63, s[16:19], 0 offen sc1
buffer_load_dwordx4 a[124:127], v63, s[16:19], 0 offen offset:256 sc1
s_waitcnt lgkmcnt(0)
ds_read2_b32 v[56:57], v34 offset0:80 offset1:84
ds_read2_b32 v[58:59], v34 offset0:88 offset1:92
v_mad_u32_u16 v60, v52, s49, v2
v_mad_u32_u16 v61, v53, s49, v2
v_mad_u32_u16 v62, v54, s49, v2
v_mad_u32_u16 v63, v55, s49, v2
buffer_load_dwordx4 a[128:131], v60, s[16:19], 0 offen sc1
buffer_load_dwordx4 a[132:135], v60, s[16:19], 0 offen offset:256 sc1
buffer_load_dwordx4 a[136:139], v61, s[16:19], 0 offen sc1
buffer_load_dwordx4 a[140:143], v61, s[16:19], 0 offen offset:256 sc1
buffer_load_dwordx4 a[144:147], v62, s[16:19], 0 offen sc1
buffer_load_dwordx4 a[148:151], v62, s[16:19], 0 offen offset:256 sc1
buffer_load_dwordx4 a[152:155], v63, s[16:19], 0 offen sc1
buffer_load_dwordx4 a[156:159], v63, s[16:19], 0 offen offset:256 sc1
s_waitcnt lgkmcnt(0)
ds_read2_b32 v[52:53], v34 offset0:96 offset1:100
ds_read2_b32 v[54:55], v34 offset0:104 offset1:108
v_mad_u32_u16 v60, v56, s49, v2
v_mad_u32_u16 v61, v57, s49, v2
v_mad_u32_u16 v62, v58, s49, v2
v_mad_u32_u16 v63, v59, s49, v2
buffer_load_dwordx4 a[160:163], v60, s[16:19], 0 offen sc1
buffer_load_dwordx4 a[164:167], v60, s[16:19], 0 offen offset:256 sc1
buffer_load_dwordx4 a[168:171], v61, s[16:19], 0 offen sc1
buffer_load_dwordx4 a[172:175], v61, s[16:19], 0 offen offset:256 sc1
buffer_load_dwordx4 a[176:179], v62, s[16:19], 0 offen sc1
buffer_load_dwordx4 a[180:183], v62, s[16:19], 0 offen offset:256 sc1
buffer_load_dwordx4 a[184:187], v63, s[16:19], 0 offen sc1
buffer_load_dwordx4 a[188:191], v63, s[16:19], 0 offen offset:256 sc1
s_waitcnt lgkmcnt(0)
ds_read2_b32 v[56:57], v34 offset0:112 offset1:116
ds_read2_b32 v[58:59], v34 offset0:120 offset1:124
v_mad_u32_u16 v60, v52, s49, v2
v_mad_u32_u16 v61, v53, s49, v2
v_mad_u32_u16 v62, v54, s49, v2
v_mad_u32_u16 v63, v55, s49, v2
buffer_load_dwordx4 a[192:195], v60, s[16:19], 0 offen sc1
buffer_load_dwordx4 a[196:199], v60, s[16:19], 0 offen offset:256 sc1
buffer_load_dwordx4 a[200:203], v61, s[16:19], 0 offen sc1
buffer_load_dwordx4 a[204:207], v61, s[16:19], 0 offen offset:256 sc1
buffer_load_dwordx4 a[208:211], v62, s[16:19], 0 offen sc1
buffer_load_dwordx4 a[212:215], v62, s[16:19], 0 offen offset:256 sc1
buffer_load_dwordx4 a[216:219], v63, s[16:19], 0 offen sc1
buffer_load_dwordx4 a[220:223], v63, s[16:19], 0 offen offset:256 sc1
s_waitcnt lgkmcnt(0)
ds_read2_b32 v[52:53], v34 offset0:128 offset1:132
ds_read2_b32 v[54:55], v34 offset0:136 offset1:140
v_mad_u32_u16 v60, v56, s49, v2
v_mad_u32_u16 v61, v57, s49, v2
v_mad_u32_u16 v62, v58, s49, v2
v_mad_u32_u16 v63, v59, s49, v2
buffer_load_dwordx4 a[224:227], v60, s[16:19], 0 offen sc1
buffer_load_dwordx4 a[228:231], v60, s[16:19], 0 offen offset:256 sc1
buffer_load_dwordx4 a[232:235], v61, s[16:19], 0 offen sc1
buffer_load_dwordx4 a[236:239], v61, s[16:19], 0 offen offset:256 sc1
buffer_load_dwordx4 a[240:243], v62, s[16:19], 0 offen sc1
buffer_load_dwordx4 a[244:247], v62, s[16:19], 0 offen offset:256 sc1
buffer_load_dwordx4 a[248:251], v63, s[16:19], 0 offen sc1
buffer_load_dwordx4 a[252:255], v63, s[16:19], 0 offen offset:256 sc1
v_add_u32 v34, 512, v34
s_mov_b32 s45, 0
s_lshl_b32 s47, s55, 9
LE_loop:
v_readlane_b32 s46, v37, s45
s_add_u32 s45, s45, 1
s_waitcnt vmcnt(56)
v_mfma_f32_16x16x32_bf16 v[48:51], a[0:3], v[40:43], v[48:51]
v_mfma_f32_16x16x32_bf16 v[48:51], a[4:7], v[44:47], v[48:51]
s_bitcmp1_b32 s46, 0
s_cbranch_scc0 LE_nf0
s_cmp_eq_u32 s42, 0
s_cbranch_scc1 LE_fl0
buffer_load_dwordx2 v[66:67], v39, s[20:23], s47 offen sc1
s_waitcnt vmcnt(0)
v_lshlrev_b32 v64, 16, v66
v_and_b32 v65, 0xffff0000, v66
v_add_f32 v48, v48, v64
v_add_f32 v49, v49, v65
v_lshlrev_b32 v64, 16, v67
v_and_b32 v65, 0xffff0000, v67
v_add_f32 v50, v50, v64
v_add_f32 v51, v51, v65
LE_fl0:
s_nop 3
v_cvt_pk_bf16_f32 v64, v48, v49
v_cvt_pk_bf16_f32 v65, v50, v51
v_mov_b32 v48, 0
v_mov_b32 v49, 0
v_mov_b32 v50, 0
v_mov_b32 v51, 0
buffer_store_dwordx2 v[64:65], v39, s[20:23], s47 offen sc1
s_add_u32 s47, s47, 512
LE_nf0:
v_mfma_f32_16x16x32_bf16 v[48:51], a[8:11], v[40:43], v[48:51]
v_mfma_f32_16x16x32_bf16 v[48:51], a[12:15], v[44:47], v[48:51]
s_bitcmp1_b32 s46, 1
s_cbranch_scc0 LE_nf1
s_cmp_eq_u32 s42, 0
s_cbranch_scc1 LE_fl1
buffer_load_dwordx2 v[66:67], v39, s[20:23], s47 offen sc1
s_waitcnt vmcnt(0)
v_lshlrev_b32 v64, 16, v66
v_and_b32 v65, 0xffff0000, v66
v_add_f32 v48, v48, v64
v_add_f32 v49, v49, v65
v_lshlrev_b32 v64, 16, v67
v_and_b32 v65, 0xffff0000, v67
v_add_f32 v50, v50, v64
v_add_f32 v51, v51, v65
LE_fl1:
s_nop 3
v_cvt_pk_bf16_f32 v64, v48, v49
v_cvt_pk_bf16_f32 v65, v50, v51
v_mov_b32 v48, 0
v_mov_b32 v49, 0
v_mov_b32 v50, 0
v_mov_b32 v51, 0
buffer_store_dwordx2 v[64:65], v39, s[20:23], s47 offen sc1
s_add_u32 s47, s47, 512
LE_nf1:
v_mfma_f32_16x16x32_bf16 v[48:51], a[16:19], v[40:43], v[48:51]
v_mfma_f32_16x16x32_bf16 v[48:51], a[20:23], v[44:47], v[48:51]
s_bitcmp1_b32 s46, 2
s_cbranch_scc0 LE_nf2
s_cmp_eq_u32 s42, 0
s_cbranch_scc1 LE_fl2
buffer_load_dwordx2 v[66:67], v39, s[20:23], s47 offen sc1
s_waitcnt vmcnt(0)
v_lshlrev_b32 v64, 16, v66
v_and_b32 v65, 0xffff0000, v66
v_add_f32 v48, v48, v64
v_add_f32 v49, v49, v65
v_lshlrev_b32 v64, 16, v67
v_and_b32 v65, 0xffff0000, v67
v_add_f32 v50, v50, v64
v_add_f32 v51, v51, v65
LE_fl2:
s_nop 3
v_cvt_pk_bf16_f32 v64, v48, v49
v_cvt_pk_bf16_f32 v65, v50, v51
v_mov_b32 v48, 0
v_mov_b32 v49, 0
v_mov_b32 v50, 0
v_mov_b32 v51, 0
buffer_store_dwordx2 v[64:65], v39, s[20:23], s47 offen sc1
s_add_u32 s47, s47, 512
LE_nf2:
v_mfma_f32_16x16x32_bf16 v[48:51], a[24:27], v[40:43], v[48:51]
v_mfma_f32_16x16x32_bf16 v[48:51], a[28:31], v[44:47], v[48:51]
s_bitcmp1_b32 s46, 3
s_cbranch_scc0 LE_nf3
s_cmp_eq_u32 s42, 0
s_cbranch_scc1 LE_fl3
buffer_load_dwordx2 v[66:67], v39, s[20:23], s47 offen sc1
s_waitcnt vmcnt(0)
v_lshlrev_b32 v64, 16, v66
v_and_b32 v65, 0xffff0000, v66
v_add_f32 v48, v48, v64
v_add_f32 v49, v49, v65
v_lshlrev_b32 v64, 16, v67
v_and_b32 v65, 0xffff0000, v67
v_add_f32 v50, v50, v64
v_add_f32 v51, v51, v65
LE_fl3:
s_nop 3
v_cvt_pk_bf16_f32 v64, v48, v49
v_cvt_pk_bf16_f32 v65, v50, v51
v_mov_b32 v48, 0
v_mov_b32 v49, 0
v_mov_b32 v50, 0
v_mov_b32 v51, 0
buffer_store_dwordx2 v[64:65], v39, s[20:23], s47 offen sc1
s_add_u32 s47, s47, 512
LE_nf3:
s_waitcnt lgkmcnt(0)
ds_read2_b32 v[56:57], v34 offset0:16 offset1:20
ds_read2_b32 v[58:59], v34 offset0:24 offset1:28
v_mad_u32_u16 v60, v52, s49, v2
v_mad_u32_u16 v61, v53, s49, v2
v_mad_u32_u16 v62, v54, s49, v2
v_mad_u32_u16 v63, v55, s49, v2
buffer_load_dwordx4 a[0:3], v60, s[16:19], 0 offen sc1
buffer_load_dwordx4 a[4:7], v60, s[16:19], 0 offen offset:256 sc1
buffer_load_dwordx4 a[8:11], v61, s[16:19], 0 offen sc1
buffer_load_dwordx4 a[12:15], v61, s[16:19], 0 offen offset:256 sc1
buffer_load_dwordx4 a[16:19], v62, s[16:19], 0 offen sc1
buffer_load_dwordx4 a[20:23], v62, s[16:19], 0 offen offset:256 sc1
buffer_load_dwordx4 a[24:27], v63, s[16:19], 0 offen sc1
buffer_load_dwordx4 a[28:31], v63, s[16:19], 0 offen offset:256 sc1
s_waitcnt vmcnt(56)
v_mfma_f32_16x16x32_bf16 v[48:51], a[32:35], v[40:43], v[48:51]
v_mfma_f32_16x16x32_bf16 v[48:51], a[36:39], v[44:47], v[48:51]
s_bitcmp1_b32 s46, 4
s_cbranch_scc0 LE_nf4
s_cmp_eq_u32 s42, 0
s_cbranch_scc1 LE_fl4
buffer_load_dwordx2 v[66:67], v39, s[20:23], s47 offen sc1
s_waitcnt vmcnt(0)
v_lshlrev_b32 v64, 16, v66
v_and_b32 v65, 0xffff0000, v66
v_add_f32 v48, v48, v64
v_add_f32 v49, v49, v65
v_lshlrev_b32 v64, 16, v67
v_and_b32 v65, 0xffff0000, v67
v_add_f32 v50, v50, v64
v_add_f32 v51, v51, v65
LE_fl4:
s_nop 3
v_cvt_pk_bf16_f32 v64, v48, v49
v_cvt_pk_bf16_f32 v65, v50, v51
v_mov_b32 v48, 0
v_mov_b32 v49, 0
v_mov_b32 v50, 0
v_mov_b32 v51, 0
buffer_store_dwordx2 v[64:65], v39, s[20:23], s47 offen sc1
s_add_u32 s47, s47, 512
LE_nf4:
v_mfma_f32_16x16x32_bf16 v[48:51], a[40:43], v[40:43], v[48:51]
v_mfma_f32_16x16x32_bf16 v[48:51], a[44:47], v[44:47], v[48:51]
s_bitcmp1_b32 s46, 5
s_cbranch_scc0 LE_nf5
s_cmp_eq_u32 s42, 0
s_cbranch_scc1 LE_fl5
buffer_load_dwordx2 v[66:67], v39, s[20:23], s47 offen sc1
s_waitcnt vmcnt(0)
v_lshlrev_b32 v64, 16, v66
v_and_b32 v65, 0xffff0000, v66
v_add_f32 v48, v48, v64
v_add_f32 v49, v49, v65
v_lshlrev_b32 v64, 16, v67
v_and_b32 v65, 0xffff0000, v67
v_add_f32 v50, v50, v64
v_add_f32 v51, v51, v65
LE_fl5:
s_nop 3
v_cvt_pk_bf16_f32 v64, v48, v49
v_cvt_pk_bf16_f32 v65, v50, v51
v_mov_b32 v48, 0
v_mov_b32 v49, 0
v_mov_b32 v50, 0
v_mov_b32 v51, 0
buffer_store_dwordx2 v[64:65], v39, s[20:23], s47 offen sc1
s_add_u32 s47, s47, 512
LE_nf5:
v_mfma_f32_16x16x32_bf16 v[48:51], a[48:51], v[40:43], v[48:51]
v_mfma_f32_16x16x32_bf16 v[48:51], a[52:55], v[44:47], v[48:51]
s_bitcmp1_b32 s46, 6
s_cbranch_scc0 LE_nf6
s_cmp_eq_u32 s42, 0
s_cbranch_scc1 LE_fl6
buffer_load_dwordx2 v[66:67], v39, s[20:23], s47 offen sc1
s_waitcnt vmcnt(0)
v_lshlrev_b32 v64, 16, v66
v_and_b32 v65, 0xffff0000, v66
v_add_f32 v48, v48, v64
v_add_f32 v49, v49, v65
v_lshlrev_b32 v64, 16, v67
v_and_b32 v65, 0xffff0000, v67
v_add_f32 v50, v50, v64
v_add_f32 v51, v51, v65
LE_fl6:
s_nop 3
v_cvt_pk_bf16_f32 v64, v48, v49
v_cvt_pk_bf16_f32 v65, v50, v51
v_mov_b32 v48, 0
v_mov_b32 v49, 0
v_mov_b32 v50, 0
v_mov_b32 v51, 0
buffer_store_dwordx2 v[64:65], v39, s[20:23], s47 offen sc1
s_add_u32 s47, s47, 512
LE_nf6:
v_mfma_f32_16x16x32_bf16 v[48:51], a[56:59], v[40:43], v[48:51]
v_mfma_f32_16x16x32_bf16 v[48:51], a[60:63], v[44:47], v[48:51]
s_bitcmp1_b32 s46, 7
s_cbranch_scc0 LE_nf7
s_cmp_eq_u32 s42, 0
s_cbranch_scc1 LE_fl7
buffer_load_dwordx2 v[66:67], v39, s[20:23], s47 offen sc1
s_waitcnt vmcnt(0)
v_lshlrev_b32 v64, 16, v66
v_and_b32 v65, 0xffff0000, v66
v_add_f32 v48, v48, v64
v_add_f32 v49, v49, v65
v_lshlrev_b32 v64, 16, v67
v_and_b32 v65, 0xffff0000, v67
v_add_f32 v50, v50, v64
v_add_f32 v51, v51, v65
LE_fl7:
s_nop 3
v_cvt_pk_bf16_f32 v64, v48, v49
v_cvt_pk_bf16_f32 v65, v50, v51
v_mov_b32 v48, 0
v_mov_b32 v49, 0
v_mov_b32 v50, 0
v_mov_b32 v51, 0
buffer_store_dwordx2 v[64:65], v39, s[20:23], s47 offen sc1
s_add_u32 s47, s47, 512
LE_nf7:
s_waitcnt lgkmcnt(0)
ds_read2_b32 v[52:53], v34 offset0:32 offset1:36
ds_read2_b32 v[54:55], v34 offset0:40 offset1:44
v_mad_u32_u16 v60, v56, s49, v2
v_mad_u32_u16 v61, v57, s49, v2
v_mad_u32_u16 v62, v58, s49, v2
v_mad_u32_u16 v63, v59, s49, v2
buffer_load_dwordx4 a[32:35], v60, s[16:19], 0 offen sc1
buffer_load_dwordx4 a[36:39], v60, s[16:19], 0 offen offset:256 sc1
buffer_load_dwordx4 a[40:43], v61, s[16:19], 0 offen sc1
buffer_load_dwordx4 a[44:47], v61, s[16:19], 0 offen offset:256 sc1
buffer_load_dwordx4 a[48:51], v62, s[16:19], 0 offen sc1
buffer_load_dwordx4 a[52:55], v62, s[16:19], 0 offen offset:256 sc1
buffer_load_dwordx4 a[56:59], v63, s[16:19], 0 offen sc1
buffer_load_dwordx4 a[60:63], v63, s[16:19], 0 offen offset:256 sc1
s_waitcnt vmcnt(56)
v_mfma_f32_16x16x32_bf16 v[48:51], a[64:67], v[40:43], v[48:51]
v_mfma_f32_16x16x32_bf16 v[48:51], a[68:71], v[44:47], v[48:51]
s_bitcmp1_b32 s46, 8
s_cbranch_scc0 LE_nf8
s_cmp_eq_u32 s42, 0
s_cbranch_scc1 LE_fl8
buffer_load_dwordx2 v[66:67], v39, s[20:23], s47 offen sc1
s_waitcnt vmcnt(0)
v_lshlrev_b32 v64, 16, v66
v_and_b32 v65, 0xffff0000, v66
v_add_f32 v48, v48, v64
v_add_f32 v49, v49, v65
v_lshlrev_b32 v64, 16, v67
v_and_b32 v65, 0xffff0000, v67
v_add_f32 v50, v50, v64
v_add_f32 v51, v51, v65
LE_fl8:
s_nop 3
v_cvt_pk_bf16_f32 v64, v48, v49
v_cvt_pk_bf16_f32 v65, v50, v51
v_mov_b32 v48, 0
v_mov_b32 v49, 0
v_mov_b32 v50, 0
v_mov_b32 v51, 0
buffer_store_dwordx2 v[64:65], v39, s[20:23], s47 offen sc1
s_add_u32 s47, s47, 512
LE_nf8:
v_mfma_f32_16x16x32_bf16 v[48:51], a[72:75], v[40:43], v[48:51]
v_mfma_f32_16x16x32_bf16 v[48:51], a[76:79], v[44:47], v[48:51]
s_bitcmp1_b32 s46, 9
s_cbranch_scc0 LE_nf9
s_cmp_eq_u32 s42, 0
s_cbranch_scc1 LE_fl9
buffer_load_dwordx2 v[66:67], v39, s[20:23], s47 offen sc1
s_waitcnt vmcnt(0)
v_lshlrev_b32 v64, 16, v66
v_and_b32 v65, 0xffff0000, v66
v_add_f32 v48, v48, v64
v_add_f32 v49, v49, v65
v_lshlrev_b32 v64, 16, v67
v_and_b32 v65, 0xffff0000, v67
v_add_f32 v50, v50, v64
v_add_f32 v51, v51, v65
LE_fl9:
s_nop 3
v_cvt_pk_bf16_f32 v64, v48, v49
v_cvt_pk_bf16_f32 v65, v50, v51
v_mov_b32 v48, 0
v_mov_b32 v49, 0
v_mov_b32 v50, 0
v_mov_b32 v51, 0
buffer_store_dwordx2 v[64:65], v39, s[20:23], s47 offen sc1
s_add_u32 s47, s47, 512
LE_nf9:
v_mfma_f32_16x16x32_bf16 v[48:51], a[80:83], v[40:43], v[48:51]
v_mfma_f32_16x16x32_bf16 v[48:51], a[84:87], v[44:47], v[48:51]
s_bitcmp1_b32 s46, 10
s_cbranch_scc0 LE_nf10
s_cmp_eq_u32 s42, 0
s_cbranch_scc1 LE_fl10
buffer_load_dwordx2 v[66:67], v39, s[20:23], s47 offen sc1
s_waitcnt vmcnt(0)
v_lshlrev_b32 v64, 16, v66
v_and_b32 v65, 0xffff0000, v66
v_add_f32 v48, v48, v64
v_add_f32 v49, v49, v65
v_lshlrev_b32 v64, 16, v67
v_and_b32 v65, 0xffff0000, v67
v_add_f32 v50, v50, v64
v_add_f32 v51, v51, v65
LE_fl10:
s_nop 3
v_cvt_pk_bf16_f32 v64, v48, v49
v_cvt_pk_bf16_f32 v65, v50, v51
v_mov_b32 v48, 0
v_mov_b32 v49, 0
v_mov_b32 v50, 0
v_mov_b32 v51, 0
buffer_store_dwordx2 v[64:65], v39, s[20:23], s47 offen sc1
s_add_u32 s47, s47, 512
LE_nf10:
v_mfma_f32_16x16x32_bf16 v[48:51], a[88:91], v[40:43], v[48:51]
v_mfma_f32_16x16x32_bf16 v[48:51], a[92:95], v[44:47], v[48:51]
s_bitcmp1_b32 s46, 11
s_cbranch_scc0 LE_nf11
s_cmp_eq_u32 s42, 0
s_cbranch_scc1 LE_fl11
buffer_load_dwordx2 v[66:67], v39, s[20:23], s47 offen sc1
s_waitcnt vmcnt(0)
v_lshlrev_b32 v64, 16, v66
v_and_b32 v65, 0xffff0000, v66
v_add_f32 v48, v48, v64
v_add_f32 v49, v49, v65
v_lshlrev_b32 v64, 16, v67
v_and_b32 v65, 0xffff0000, v67
v_add_f32 v50, v50, v64
v_add_f32 v51, v51, v65
LE_fl11:
s_nop 3
v_cvt_pk_bf16_f32 v64, v48, v49
v_cvt_pk_bf16_f32 v65, v50, v51
v_mov_b32 v48, 0
v_mov_b32 v49, 0
v_mov_b32 v50, 0
v_mov_b32 v51, 0
buffer_store_dwordx2 v[64:65], v39, s[20:23], s47 offen sc1
s_add_u32 s47, s47, 512
LE_nf11:
s_waitcnt lgkmcnt(0)
ds_read2_b32 v[56:57], v34 offset0:48 offset1:52
ds_read2_b32 v[58:59], v34 offset0:56 offset1:60
v_mad_u32_u16 v60, v52, s49, v2
v_mad_u32_u16 v61, v53, s49, v2
v_mad_u32_u16 v62, v54, s49, v2
v_mad_u32_u16 v63, v55, s49, v2
buffer_load_dwordx4 a[64:67], v60, s[16:19], 0 offen sc1
buffer_load_dwordx4 a[68:71], v60, s[16:19], 0 offen offset:256 sc1
buffer_load_dwordx4 a[72:75], v61, s[16:19], 0 offen sc1
buffer_load_dwordx4 a[76:79], v61, s[16:19], 0 offen offset:256 sc1
buffer_load_dwordx4 a[80:83], v62, s[16:19], 0 offen sc1
buffer_load_dwordx4 a[84:87], v62, s[16:19], 0 offen offset:256 sc1
buffer_load_dwordx4 a[88:91], v63, s[16:19], 0 offen sc1
buffer_load_dwordx4 a[92:95], v63, s[16:19], 0 offen offset:256 sc1
s_waitcnt vmcnt(56)
v_mfma_f32_16x16x32_bf16 v[48:51], a[96:99], v[40:43], v[48:51]
v_mfma_f32_16x16x32_bf16 v[48:51], a[100:103], v[44:47], v[48:51]
s_bitcmp1_b32 s46, 12
s_cbranch_scc0 LE_nf12
s_cmp_eq_u32 s42, 0
s_cbranch_scc1 LE_fl12
buffer_load_dwordx2 v[66:67], v39, s[20:23], s47 offen sc1
s_waitcnt vmcnt(0)
v_lshlrev_b32 v64, 16, v66
v_and_b32 v65, 0xffff0000, v66
v_add_f32 v48, v48, v64
v_add_f32 v49, v49, v65
v_lshlrev_b32 v64, 16, v67
v_and_b32 v65, 0xffff0000, v67
v_add_f32 v50, v50, v64
v_add_f32 v51, v51, v65
LE_fl12:
s_nop 3
v_cvt_pk_bf16_f32 v64, v48, v49
v_cvt_pk_bf16_f32 v65, v50, v51
v_mov_b32 v48, 0
v_mov_b32 v49, 0
v_mov_b32 v50, 0
v_mov_b32 v51, 0
buffer_store_dwordx2 v[64:65], v39, s[20:23], s47 offen sc1
s_add_u32 s47, s47, 512
LE_nf12:
v_mfma_f32_16x16x32_bf16 v[48:51], a[104:107], v[40:43], v[48:51]
v_mfma_f32_16x16x32_bf16 v[48:51], a[108:111], v[44:47], v[48:51]
s_bitcmp1_b32 s46, 13
s_cbranch_scc0 LE_nf13
s_cmp_eq_u32 s42, 0
s_cbranch_scc1 LE_fl13
buffer_load_dwordx2 v[66:67], v39, s[20:23], s47 offen sc1
s_waitcnt vmcnt(0)
v_lshlrev_b32 v64, 16, v66
v_and_b32 v65, 0xffff0000, v66
v_add_f32 v48, v48, v64
v_add_f32 v49, v49, v65
v_lshlrev_b32 v64, 16, v67
v_and_b32 v65, 0xffff0000, v67
v_add_f32 v50, v50, v64
v_add_f32 v51, v51, v65
LE_fl13:
s_nop 3
v_cvt_pk_bf16_f32 v64, v48, v49
v_cvt_pk_bf16_f32 v65, v50, v51
v_mov_b32 v48, 0
v_mov_b32 v49, 0
v_mov_b32 v50, 0
v_mov_b32 v51, 0
buffer_store_dwordx2 v[64:65], v39, s[20:23], s47 offen sc1
s_add_u32 s47, s47, 512
LE_nf13:
v_mfma_f32_16x16x32_bf16 v[48:51], a[112:115], v[40:43], v[48:51]
v_mfma_f32_16x16x32_bf16 v[48:51], a[116:119], v[44:47], v[48:51]
s_bitcmp1_b32 s46, 14
s_cbranch_scc0 LE_nf14
s_cmp_eq_u32 s42, 0
s_cbranch_scc1 LE_fl14
buffer_load_dwordx2 v[66:67], v39, s[20:23], s47 offen sc1
s_waitcnt vmcnt(0)
v_lshlrev_b32 v64, 16, v66
v_and_b32 v65, 0xffff0000, v66
v_add_f32 v48, v48, v64
v_add_f32 v49, v49, v65
v_lshlrev_b32 v64, 16, v67
v_and_b32 v65, 0xffff0000, v67
v_add_f32 v50, v50, v64
v_add_f32 v51, v51, v65
LE_fl14:
s_nop 3
v_cvt_pk_bf16_f32 v64, v48, v49
v_cvt_pk_bf16_f32 v65, v50, v51
v_mov_b32 v48, 0
v_mov_b32 v49, 0
v_mov_b32 v50, 0
v_mov_b32 v51, 0
buffer_store_dwordx2 v[64:65], v39, s[20:23], s47 offen sc1
s_add_u32 s47, s47, 512
LE_nf14:
v_mfma_f32_16x16x32_bf16 v[48:51], a[120:123], v[40:43], v[48:51]
v_mfma_f32_16x16x32_bf16 v[48:51], a[124:127], v[44:47], v[48:51]
s_bitcmp1_b32 s46, 15
s_cbranch_scc0 LE_nf15
s_cmp_eq_u32 s42, 0
s_cbranch_scc1 LE_fl15
buffer_load_dwordx2 v[66:67], v39, s[20:23], s47 offen sc1
s_waitcnt vmcnt(0)
v_lshlrev_b32 v64, 16, v66
v_and_b32 v65, 0xffff0000, v66
v_add_f32 v48, v48, v64
v_add_f32 v49, v49, v65
v_lshlrev_b32 v64, 16, v67
v_and_b32 v65, 0xffff0000, v67
v_add_f32 v50, v50, v64
v_add_f32 v51, v51, v65
LE_fl15:
s_nop 3
v_cvt_pk_bf16_f32 v64, v48, v49
v_cvt_pk_bf16_f32 v65, v50, v51
v_mov_b32 v48, 0
v_mov_b32 v49, 0
v_mov_b32 v50, 0
v_mov_b32 v51, 0
buffer_store_dwordx2 v[64:65], v39, s[20:23], s47 offen sc1
s_add_u32 s47, s47, 512
LE_nf15:
s_waitcnt lgkmcnt(0)
ds_read2_b32 v[52:53], v34 offset0:64 offset1:68
ds_read2_b32 v[54:55], v34 offset0:72 offset1:76
v_mad_u32_u16 v60, v56, s49, v2
v_mad_u32_u16 v61, v57, s49, v2
v_mad_u32_u16 v62, v58, s49, v2
v_mad_u32_u16 v63, v59, s49, v2
buffer_load_dwordx4 a[96:99], v60, s[16:19], 0 offen sc1
buffer_load_dwordx4 a[100:103], v60, s[16:19], 0 offen offset:256 sc1
buffer_load_dwordx4 a[104:107], v61, s[16:19], 0 offen sc1
buffer_load_dwordx4 a[108:111], v61, s[16:19], 0 offen offset:256 sc1
buffer_load_dwordx4 a[112:115], v62, s[16:19], 0 offen sc1
buffer_load_dwordx4 a[116:119], v62, s[16:19], 0 offen offset:256 sc1
buffer_load_dwordx4 a[120:123], v63, s[16:19], 0 offen sc1
buffer_load_dwordx4 a[124:127], v63, s[16:19], 0 offen offset:256 sc1
s_waitcnt vmcnt(56)
v_mfma_f32_16x16x32_bf16 v[48:51], a[128:131], v[40:43], v[48:51]
v_mfma_f32_16x16x32_bf16 v[48:51], a[132:135], v[44:47], v[48:51]
s_bitcmp1_b32 s46, 16
s_cbranch_scc0 LE_nf16
s_cmp_eq_u32 s42, 0
s_cbranch_scc1 LE_fl16
buffer_load_dwordx2 v[66:67], v39, s[20:23], s47 offen sc1
s_waitcnt vmcnt(0)
v_lshlrev_b32 v64, 16, v66
v_and_b32 v65, 0xffff0000, v66
v_add_f32 v48, v48, v64
v_add_f32 v49, v49, v65
v_lshlrev_b32 v64, 16, v67
v_and_b32 v65, 0xffff0000, v67
v_add_f32 v50, v50, v64
v_add_f32 v51, v51, v65
LE_fl16:
s_nop 3
v_cvt_pk_bf16_f32 v64, v48, v49
v_cvt_pk_bf16_f32 v65, v50, v51
v_mov_b32 v48, 0
v_mov_b32 v49, 0
v_mov_b32 v50, 0
v_mov_b32 v51, 0
buffer_store_dwordx2 v[64:65], v39, s[20:23], s47 offen sc1
s_add_u32 s47, s47, 512
LE_nf16:
v_mfma_f32_16x16x32_bf16 v[48:51], a[136:139], v[40:43], v[48:51]
v_mfma_f32_16x16x32_bf16 v[48:51], a[140:143], v[44:47], v[48:51]
s_bitcmp1_b32 s46, 17
s_cbranch_scc0 LE_nf17
s_cmp_eq_u32 s42, 0
s_cbranch_scc1 LE_fl17
buffer_load_dwordx2 v[66:67], v39, s[20:23], s47 offen sc1
s_waitcnt vmcnt(0)
v_lshlrev_b32 v64, 16, v66
v_and_b32 v65, 0xffff0000, v66
v_add_f32 v48, v48, v64
v_add_f32 v49, v49, v65
v_lshlrev_b32 v64, 16, v67
v_and_b32 v65, 0xffff0000, v67
v_add_f32 v50, v50, v64
v_add_f32 v51, v51, v65
LE_fl17:
s_nop 3
v_cvt_pk_bf16_f32 v64, v48, v49
v_cvt_pk_bf16_f32 v65, v50, v51
v_mov_b32 v48, 0
v_mov_b32 v49, 0
v_mov_b32 v50, 0
v_mov_b32 v51, 0
buffer_store_dwordx2 v[64:65], v39, s[20:23], s47 offen sc1
s_add_u32 s47, s47, 512
LE_nf17:
v_mfma_f32_16x16x32_bf16 v[48:51], a[144:147], v[40:43], v[48:51]
v_mfma_f32_16x16x32_bf16 v[48:51], a[148:151], v[44:47], v[48:51]
s_bitcmp1_b32 s46, 18
s_cbranch_scc0 LE_nf18
s_cmp_eq_u32 s42, 0
s_cbranch_scc1 LE_fl18
buffer_load_dwordx2 v[66:67], v39, s[20:23], s47 offen sc1
s_waitcnt vmcnt(0)
v_lshlrev_b32 v64, 16, v66
v_and_b32 v65, 0xffff0000, v66
v_add_f32 v48, v48, v64
v_add_f32 v49, v49, v65
v_lshlrev_b32 v64, 16, v67
v_and_b32 v65, 0xffff0000, v67
v_add_f32 v50, v50, v64
v_add_f32 v51, v51, v65
LE_fl18:
s_nop 3
v_cvt_pk_bf16_f32 v64, v48, v49
v_cvt_pk_bf16_f32 v65, v50, v51
v_mov_b32 v48, 0
v_mov_b32 v49, 0
v_mov_b32 v50, 0
v_mov_b32 v51, 0
buffer_store_dwordx2 v[64:65], v39, s[20:23], s47 offen sc1
s_add_u32 s47, s47, 512
LE_nf18:
v_mfma_f32_16x16x32_bf16 v[48:51], a[152:155], v[40:43], v[48:51]
v_mfma_f32_16x16x32_bf16 v[48:51], a[156:159], v[44:47], v[48:51]
s_bitcmp1_b32 s46, 19
s_cbranch_scc0 LE_nf19
s_cmp_eq_u32 s42, 0
s_cbranch_scc1 LE_fl19
buffer_load_dwordx2 v[66:67], v39, s[20:23], s47 offen sc1
s_waitcnt vmcnt(0)
v_lshlrev_b32 v64, 16, v66
v_and_b32 v65, 0xffff0000, v66
v_add_f32 v48, v48, v64
v_add_f32 v49, v49, v65
v_lshlrev_b32 v64, 16, v67
v_and_b32 v65, 0xffff0000, v67
v_add_f32 v50, v50, v64
v_add_f32 v51, v51, v65
LE_fl19:
s_nop 3
v_cvt_pk_bf16_f32 v64, v48, v49
v_cvt_pk_bf16_f32 v65, v50, v51
v_mov_b32 v48, 0
v_mov_b32 v49, 0
v_mov_b32 v50, 0
v_mov_b32 v51, 0
buffer_store_dwordx2 v[64:65], v39, s[20:23], s47 offen sc1
s_add_u32 s47, s47, 512
LE_nf19:
s_waitcnt lgkmcnt(0)
ds_read2_b32 v[56:57], v34 offset0:80 offset1:84
ds_read2_b32 v[58:59], v34 offset0:88 offset1:92
v_mad_u32_u16 v60, v52, s49, v2
v_mad_u32_u16 v61, v53, s49, v2
v_mad_u32_u16 v62, v54, s49, v2
v_mad_u32_u16 v63, v55, s49, v2
buffer_load_dwordx4 a[128:131], v60, s[16:19], 0 offen sc1
buffer_load_dwordx4 a[132:135], v60, s[16:19], 0 offen offset:256 sc1
buffer_load_dwordx4 a[136:139], v61, s[16:19], 0 offen sc1
buffer_load_dwordx4 a[140:143], v61, s[16:19], 0 offen offset:256 sc1
buffer_load_dwordx4 a[144:147], v62, s[16:19], 0 offen sc1
buffer_load_dwordx4 a[148:151], v62, s[16:19], 0 offen offset:256 sc1
buffer_load_dwordx4 a[152:155], v63, s[16:19], 0 offen sc1
buffer_load_dwordx4 a[156:159], v63, s[16:19], 0 offen offset:256 sc1
s_waitcnt vmcnt(56)
v_mfma_f32_16x16x32_bf16 v[48:51], a[160:163], v[40:43], v[48:51]
v_mfma_f32_16x16x32_bf16 v[48:51], a[164:167], v[44:47], v[48:51]
s_bitcmp1_b32 s46, 20
s_cbranch_scc0 LE_nf20
s_cmp_eq_u32 s42, 0
s_cbranch_scc1 LE_fl20
buffer_load_dwordx2 v[66:67], v39, s[20:23], s47 offen sc1
s_waitcnt vmcnt(0)
v_lshlrev_b32 v64, 16, v66
v_and_b32 v65, 0xffff0000, v66
v_add_f32 v48, v48, v64
v_add_f32 v49, v49, v65
v_lshlrev_b32 v64, 16, v67
v_and_b32 v65, 0xffff0000, v67
v_add_f32 v50, v50, v64
v_add_f32 v51, v51, v65
LE_fl20:
s_nop 3
v_cvt_pk_bf16_f32 v64, v48, v49
v_cvt_pk_bf16_f32 v65, v50, v51
v_mov_b32 v48, 0
v_mov_b32 v49, 0
v_mov_b32 v50, 0
v_mov_b32 v51, 0
buffer_store_dwordx2 v[64:65], v39, s[20:23], s47 offen sc1
s_add_u32 s47, s47, 512
LE_nf20:
v_mfma_f32_16x16x32_bf16 v[48:51], a[168:171], v[40:43], v[48:51]
v_mfma_f32_16x16x32_bf16 v[48:51], a[172:175], v[44:47], v[48:51]
s_bitcmp1_b32 s46, 21
s_cbranch_scc0 LE_nf21
s_cmp_eq_u32 s42, 0
s_cbranch_scc1 LE_fl21
buffer_load_dwordx2 v[66:67], v39, s[20:23], s47 offen sc1
s_waitcnt vmcnt(0)
v_lshlrev_b32 v64, 16, v66
v_and_b32 v65, 0xffff0000, v66
v_add_f32 v48, v48, v64
v_add_f32 v49, v49, v65
v_lshlrev_b32 v64, 16, v67
v_and_b32 v65, 0xffff0000, v67
v_add_f32 v50, v50, v64
v_add_f32 v51, v51, v65
LE_fl21:
s_nop 3
v_cvt_pk_bf16_f32 v64, v48, v49
v_cvt_pk_bf16_f32 v65, v50, v51
v_mov_b32 v48, 0
v_mov_b32 v49, 0
v_mov_b32 v50, 0
v_mov_b32 v51, 0
buffer_store_dwordx2 v[64:65], v39, s[20:23], s47 offen sc1
s_add_u32 s47, s47, 512
LE_nf21:
v_mfma_f32_16x16x32_bf16 v[48:51], a[176:179], v[40:43], v[48:51]
v_mfma_f32_16x16x32_bf16 v[48:51], a[180:183], v[44:47], v[48:51]
s_bitcmp1_b32 s46, 22
s_cbranch_scc0 LE_nf22
s_cmp_eq_u32 s42, 0
s_cbranch_scc1 LE_fl22
buffer_load_dwordx2 v[66:67], v39, s[20:23], s47 offen sc1
s_waitcnt vmcnt(0)
v_lshlrev_b32 v64, 16, v66
v_and_b32 v65, 0xffff0000, v66
v_add_f32 v48, v48, v64
v_add_f32 v49, v49, v65
v_lshlrev_b32 v64, 16, v67
v_and_b32 v65, 0xffff0000, v67
v_add_f32 v50, v50, v64
v_add_f32 v51, v51, v65
LE_fl22:
s_nop 3
v_cvt_pk_bf16_f32 v64, v48, v49
v_cvt_pk_bf16_f32 v65, v50, v51
v_mov_b32 v48, 0
v_mov_b32 v49, 0
v_mov_b32 v50, 0
v_mov_b32 v51, 0
buffer_store_dwordx2 v[64:65], v39, s[20:23], s47 offen sc1
s_add_u32 s47, s47, 512
LE_nf22:
v_mfma_f32_16x16x32_bf16 v[48:51], a[184:187], v[40:43], v[48:51]
v_mfma_f32_16x16x32_bf16 v[48:51], a[188:191], v[44:47], v[48:51]
s_bitcmp1_b32 s46, 23
s_cbranch_scc0 LE_nf23
s_cmp_eq_u32 s42, 0
s_cbranch_scc1 LE_fl23
buffer_load_dwordx2 v[66:67], v39, s[20:23], s47 offen sc1
s_waitcnt vmcnt(0)
v_lshlrev_b32 v64, 16, v66
v_and_b32 v65, 0xffff0000, v66
v_add_f32 v48, v48, v64
v_add_f32 v49, v49, v65
v_lshlrev_b32 v64, 16, v67
v_and_b32 v65, 0xffff0000, v67
v_add_f32 v50, v50, v64
v_add_f32 v51, v51, v65
LE_fl23:
s_nop 3
v_cvt_pk_bf16_f32 v64, v48, v49
v_cvt_pk_bf16_f32 v65, v50, v51
v_mov_b32 v48, 0
v_mov_b32 v49, 0
v_mov_b32 v50, 0
v_mov_b32 v51, 0
buffer_store_dwordx2 v[64:65], v39, s[20:23], s47 offen sc1
s_add_u32 s47, s47, 512
LE_nf23:
s_waitcnt lgkmcnt(0)
ds_read2_b32 v[52:53], v34 offset0:96 offset1:100
ds_read2_b32 v[54:55], v34 offset0:104 offset1:108
v_mad_u32_u16 v60, v56, s49, v2
v_mad_u32_u16 v61, v57, s49, v2
v_mad_u32_u16 v62, v58, s49, v2
v_mad_u32_u16 v63, v59, s49, v2
buffer_load_dwordx4 a[160:163], v60, s[16:19], 0 offen sc1
buffer_load_dwordx4 a[164:167], v60, s[16:19], 0 offen offset:256 sc1
buffer_load_dwordx4 a[168:171], v61, s[16:19], 0 offen sc1
buffer_load_dwordx4 a[172:175], v61, s[16:19], 0 offen offset:256 sc1
buffer_load_dwordx4 a[176:179], v62, s[16:19], 0 offen sc1
buffer_load_dwordx4 a[180:183], v62, s[16:19], 0 offen offset:256 sc1
buffer_load_dwordx4 a[184:187], v63, s[16:19], 0 offen sc1
buffer_load_dwordx4 a[188:191], v63, s[16:19], 0 offen offset:256 sc1
s_waitcnt vmcnt(56)
v_mfma_f32_16x16x32_bf16 v[48:51], a[192:195], v[40:43], v[48:51]
v_mfma_f32_16x16x32_bf16 v[48:51], a[196:199], v[44:47], v[48:51]
s_bitcmp1_b32 s46, 24
s_cbranch_scc0 LE_nf24
s_cmp_eq_u32 s42, 0
s_cbranch_scc1 LE_fl24
buffer_load_dwordx2 v[66:67], v39, s[20:23], s47 offen sc1
s_waitcnt vmcnt(0)
v_lshlrev_b32 v64, 16, v66
v_and_b32 v65, 0xffff0000, v66
v_add_f32 v48, v48, v64
v_add_f32 v49, v49, v65
v_lshlrev_b32 v64, 16, v67
v_and_b32 v65, 0xffff0000, v67
v_add_f32 v50, v50, v64
v_add_f32 v51, v51, v65
LE_fl24:
s_nop 3
v_cvt_pk_bf16_f32 v64, v48, v49
v_cvt_pk_bf16_f32 v65, v50, v51
v_mov_b32 v48, 0
v_mov_b32 v49, 0
v_mov_b32 v50, 0
v_mov_b32 v51, 0
buffer_store_dwordx2 v[64:65], v39, s[20:23], s47 offen sc1
s_add_u32 s47, s47, 512
LE_nf24:
v_mfma_f32_16x16x32_bf16 v[48:51], a[200:203], v[40:43], v[48:51]
v_mfma_f32_16x16x32_bf16 v[48:51], a[204:207], v[44:47], v[48:51]
s_bitcmp1_b32 s46, 25
s_cbranch_scc0 LE_nf25
s_cmp_eq_u32 s42, 0
s_cbranch_scc1 LE_fl25
buffer_load_dwordx2 v[66:67], v39, s[20:23], s47 offen sc1
s_waitcnt vmcnt(0)
v_lshlrev_b32 v64, 16, v66
v_and_b32 v65, 0xffff0000, v66
v_add_f32 v48, v48, v64
v_add_f32 v49, v49, v65
v_lshlrev_b32 v64, 16, v67
v_and_b32 v65, 0xffff0000, v67
v_add_f32 v50, v50, v64
v_add_f32 v51, v51, v65
LE_fl25:
s_nop 3
v_cvt_pk_bf16_f32 v64, v48, v49
v_cvt_pk_bf16_f32 v65, v50, v51
v_mov_b32 v48, 0
v_mov_b32 v49, 0
v_mov_b32 v50, 0
v_mov_b32 v51, 0
buffer_store_dwordx2 v[64:65], v39, s[20:23], s47 offen sc1
s_add_u32 s47, s47, 512
LE_nf25:
v_mfma_f32_16x16x32_bf16 v[48:51], a[208:211], v[40:43], v[48:51]
v_mfma_f32_16x16x32_bf16 v[48:51], a[212:215], v[44:47], v[48:51]
s_bitcmp1_b32 s46, 26
s_cbranch_scc0 LE_nf26
s_cmp_eq_u32 s42, 0
s_cbranch_scc1 LE_fl26
buffer_load_dwordx2 v[66:67], v39, s[20:23], s47 offen sc1
s_waitcnt vmcnt(0)
v_lshlrev_b32 v64, 16, v66
v_and_b32 v65, 0xffff0000, v66
v_add_f32 v48, v48, v64
v_add_f32 v49, v49, v65
v_lshlrev_b32 v64, 16, v67
v_and_b32 v65, 0xffff0000, v67
v_add_f32 v50, v50, v64
v_add_f32 v51, v51, v65
LE_fl26:
s_nop 3
v_cvt_pk_bf16_f32 v64, v48, v49
v_cvt_pk_bf16_f32 v65, v50, v51
v_mov_b32 v48, 0
v_mov_b32 v49, 0
v_mov_b32 v50, 0
v_mov_b32 v51, 0
buffer_store_dwordx2 v[64:65], v39, s[20:23], s47 offen sc1
s_add_u32 s47, s47, 512
LE_nf26:
v_mfma_f32_16x16x32_bf16 v[48:51], a[216:219], v[40:43], v[48:51]
v_mfma_f32_16x16x32_bf16 v[48:51], a[220:223], v[44:47], v[48:51]
s_bitcmp1_b32 s46, 27
s_cbranch_scc0 LE_nf27
s_cmp_eq_u32 s42, 0
s_cbranch_scc1 LE_fl27
buffer_load_dwordx2 v[66:67], v39, s[20:23], s47 offen sc1
s_waitcnt vmcnt(0)
v_lshlrev_b32 v64, 16, v66
v_and_b32 v65, 0xffff0000, v66
v_add_f32 v48, v48, v64
v_add_f32 v49, v49, v65
v_lshlrev_b32 v64, 16, v67
v_and_b32 v65, 0xffff0000, v67
v_add_f32 v50, v50, v64
v_add_f32 v51, v51, v65
LE_fl27:
s_nop 3
v_cvt_pk_bf16_f32 v64, v48, v49
v_cvt_pk_bf16_f32 v65, v50, v51
v_mov_b32 v48, 0
v_mov_b32 v49, 0
v_mov_b32 v50, 0
v_mov_b32 v51, 0
buffer_store_dwordx2 v[64:65], v39, s[20:23], s47 offen sc1
s_add_u32 s47, s47, 512
LE_nf27:
s_waitcnt lgkmcnt(0)
ds_read2_b32 v[56:57], v34 offset0:112 offset1:116
ds_read2_b32 v[58:59], v34 offset0:120 offset1:124
v_mad_u32_u16 v60, v52, s49, v2
v_mad_u32_u16 v61, v53, s49, v2
v_mad_u32_u16 v62, v54, s49, v2
v_mad_u32_u16 v63, v55, s49, v2
buffer_load_dwordx4 a[192:195], v60, s[16:19], 0 offen sc1
buffer_load_dwordx4 a[196:199], v60, s[16:19], 0 offen offset:256 sc1
buffer_load_dwordx4 a[200:203], v61, s[16:19], 0 offen sc1
buffer_load_dwordx4 a[204:207], v61, s[16:19], 0 offen offset:256 sc1
buffer_load_dwordx4 a[208:211], v62, s[16:19], 0 offen sc1
buffer_load_dwordx4 a[212:215], v62, s[16:19], 0 offen offset:256 sc1
buffer_load_dwordx4 a[216:219], v63, s[16:19], 0 offen sc1
buffer_load_dwordx4 a[220:223], v63, s[16:19], 0 offen offset:256 sc1
s_waitcnt vmcnt(56)
v_mfma_f32_16x16x32_bf16 v[48:51], a[224:227], v[40:43], v[48:51]
v_mfma_f32_16x16x32_bf16 v[48:51], a[228:231], v[44:47], v[48:51]
s_bitcmp1_b32 s46, 28
s_cbranch_scc0 LE_nf28
s_cmp_eq_u32 s42, 0
s_cbranch_scc1 LE_fl28
buffer_load_dwordx2 v[66:67], v39, s[20:23], s47 offen sc1
s_waitcnt vmcnt(0)
v_lshlrev_b32 v64, 16, v66
v_and_b32 v65, 0xffff0000, v66
v_add_f32 v48, v48, v64
v_add_f32 v49, v49, v65
v_lshlrev_b32 v64, 16, v67
v_and_b32 v65, 0xffff0000, v67
v_add_f32 v50, v50, v64
v_add_f32 v51, v51, v65
LE_fl28:
s_nop 3
v_cvt_pk_bf16_f32 v64, v48, v49
v_cvt_pk_bf16_f32 v65, v50, v51
v_mov_b32 v48, 0
v_mov_b32 v49, 0
v_mov_b32 v50, 0
v_mov_b32 v51, 0
buffer_store_dwordx2 v[64:65], v39, s[20:23], s47 offen sc1
s_add_u32 s47, s47, 512
LE_nf28:
v_mfma_f32_16x16x32_bf16 v[48:51], a[232:235], v[40:43], v[48:51]
v_mfma_f32_16x16x32_bf16 v[48:51], a[236:239], v[44:47], v[48:51]
s_bitcmp1_b32 s46, 29
s_cbranch_scc0 LE_nf29
s_cmp_eq_u32 s42, 0
s_cbranch_scc1 LE_fl29
buffer_load_dwordx2 v[66:67], v39, s[20:23], s47 offen sc1
s_waitcnt vmcnt(0)
v_lshlrev_b32 v64, 16, v66
v_and_b32 v65, 0xffff0000, v66
v_add_f32 v48, v48, v64
v_add_f32 v49, v49, v65
v_lshlrev_b32 v64, 16, v67
v_and_b32 v65, 0xffff0000, v67
v_add_f32 v50, v50, v64
v_add_f32 v51, v51, v65
LE_fl29:
s_nop 3
v_cvt_pk_bf16_f32 v64, v48, v49
v_cvt_pk_bf16_f32 v65, v50, v51
v_mov_b32 v48, 0
v_mov_b32 v49, 0
v_mov_b32 v50, 0
v_mov_b32 v51, 0
buffer_store_dwordx2 v[64:65], v39, s[20:23], s47 offen sc1
s_add_u32 s47, s47, 512
LE_nf29:
v_mfma_f32_16x16x32_bf16 v[48:51], a[240:243], v[40:43], v[48:51]
v_mfma_f32_16x16x32_bf16 v[48:51], a[244:247], v[44:47], v[48:51]
s_bitcmp1_b32 s46, 30
s_cbranch_scc0 LE_nf30
s_cmp_eq_u32 s42, 0
s_cbranch_scc1 LE_fl30
buffer_load_dwordx2 v[66:67], v39, s[20:23], s47 offen sc1
s_waitcnt vmcnt(0)
v_lshlrev_b32 v64, 16, v66
v_and_b32 v65, 0xffff0000, v66
v_add_f32 v48, v48, v64
v_add_f32 v49, v49, v65
v_lshlrev_b32 v64, 16, v67
v_and_b32 v65, 0xffff0000, v67
v_add_f32 v50, v50, v64
v_add_f32 v51, v51, v65
LE_fl30:
s_nop 3
v_cvt_pk_bf16_f32 v64, v48, v49
v_cvt_pk_bf16_f32 v65, v50, v51
v_mov_b32 v48, 0
v_mov_b32 v49, 0
v_mov_b32 v50, 0
v_mov_b32 v51, 0
buffer_store_dwordx2 v[64:65], v39, s[20:23], s47 offen sc1
s_add_u32 s47, s47, 512
LE_nf30:
v_mfma_f32_16x16x32_bf16 v[48:51], a[248:251], v[40:43], v[48:51]
v_mfma_f32_16x16x32_bf16 v[48:51], a[252:255], v[44:47], v[48:51]
s_bitcmp1_b32 s46, 31
s_cbranch_scc0 LE_nf31
s_cmp_eq_u32 s42, 0
s_cbranch_scc1 LE_fl31
buffer_load_dwordx2 v[66:67], v39, s[20:23], s47 offen sc1
s_waitcnt vmcnt(0)
v_lshlrev_b32 v64, 16, v66
v_and_b32 v65, 0xffff0000, v66
v_add_f32 v48, v48, v64
v_add_f32 v49, v49, v65
v_lshlrev_b32 v64, 16, v67
v_and_b32 v65, 0xffff0000, v67
v_add_f32 v50, v50, v64
v_add_f32 v51, v51, v65
LE_fl31:
s_nop 3
v_cvt_pk_bf16_f32 v64, v48, v49
v_cvt_pk_bf16_f32 v65, v50, v51
v_mov_b32 v48, 0
v_mov_b32 v49, 0
v_mov_b32 v50, 0
v_mov_b32 v51, 0
buffer_store_dwordx2 v[64:65], v39, s[20:23], s47 offen sc1
s_add_u32 s47, s47, 512
LE_nf31:
s_waitcnt lgkmcnt(0)
ds_read2_b32 v[52:53], v34 offset0:128 offset1:132
ds_read2_b32 v[54:55], v34 offset0:136 offset1:140
v_mad_u32_u16 v60, v56, s49, v2
v_mad_u32_u16 v61, v57, s49, v2
v_mad_u32_u16 v62, v58, s49, v2
v_mad_u32_u16 v63, v59, s49, v2
buffer_load_dwordx4 a[224:227], v60, s[16:19], 0 offen sc1
buffer_load_dwordx4 a[228:231], v60, s[16:19], 0 offen offset:256 sc1
buffer_load_dwordx4 a[232:235], v61, s[16:19], 0 offen sc1
buffer_load_dwordx4 a[236:239], v61, s[16:19], 0 offen offset:256 sc1
buffer_load_dwordx4 a[240:243], v62, s[16:19], 0 offen sc1
buffer_load_dwordx4 a[244:247], v62, s[16:19], 0 offen offset:256 sc1
buffer_load_dwordx4 a[248:251], v63, s[16:19], 0 offen sc1
buffer_load_dwordx4 a[252:255], v63, s[16:19], 0 offen offset:256 sc1
v_add_u32 v34, 512, v34
s_cmp_lt_u32 s45, s44
s_cbranch_scc1 LE_loop
s_add_u32 s42, s42, 1
s_mul_i32 s43, s42, 256
v_cmp_lt_u32 vcc, s43, v4
s_cbranch_vccz LE_done
s_cmp_ge_u32 s42, 40
s_cbranch_scc1 LE_done
s_waitcnt vmcnt(0) lgkmcnt(0)
s_add_u32 s50, s50, 1024
v_add_u32 v5, 0x100, v5
buffer_load_dwordx4 v[192:195], v6, s[12:15], s50 offen offset:0 sc1
buffer_load_dwordx4 v[196:199], v6, s[12:15], s50 offen offset:64 sc1
buffer_load_dwordx4 v[200:203], v6, s[12:15], s50 offen offset:128 sc1
buffer_load_dwordx4 v[204:207], v6, s[12:15], s50 offen offset:192 sc1
buffer_load_dwordx4 v[208:211], v6, s[12:15], s50 offen offset:256 sc1
buffer_load_dwordx4 v[212:215], v6, s[12:15], s50 offen offset:320 sc1
buffer_load_dwordx4 v[216:219], v6, s[12:15], s50 offen offset:384 sc1
buffer_load_dwordx4 v[220:223], v6, s[12:15], s50 offen offset:448 sc1
buffer_load_dwordx4 v[224:227], v6, s[12:15], s50 offen offset:512 sc1
buffer_load_dwordx4 v[228:231], v6, s[12:15], s50 offen offset:576 sc1
buffer_load_dwordx4 v[232:235], v6, s[12:15], s50 offen offset:640 sc1
buffer_load_dwordx4 v[236:239], v6, s[12:15], s50 offen offset:704 sc1
buffer_load_dwordx4 v[240:243], v6, s[12:15], s50 offen offset:768 sc1
buffer_load_dwordx4 v[244:247], v6, s[12:15], s50 offen offset:832 sc1
buffer_load_dwordx4 v[248:251], v6, s[12:15], s50 offen offset:896 sc1
buffer_load_dwordx4 v[252:255], v6, s[12:15], s50 offen offset:960 sc1
s_branch LE_pass
LE_done:
s_add_u32 s24, s4, 0x7c00000
s_addc_u32 s25, s5, 0
s_mov_b32 s26, 0x40000
s_mov_b32 s27, 0x00020000
s_add_u32 s48, s40, 1280
s_mul_i32 s48, s48, 128
s_waitcnt vmcnt(0)
v_mov_b32 v32, s98
v_mov_b32 v33, s99
s_mov_b64 exec, 1
buffer_store_dwordx2 v[32:33], off, s[24:27], s48 sc1
s_mov_b64 exec, -1
s_branch L2_end
L2_fin:
L2_end:
s_endpgm
.section .rodata,"a"
.p2align 6
.amdhsa_kernel standalone__hybrid_graph_tf_graphgps__graph_kernel
  .amdhsa_next_free_vgpr 512
  .amdhsa_next_free_sgpr 102
  .amdhsa_accum_offset 256
  .amdhsa_group_segment_fixed_size 0
  .amdhsa_kernarg_size 96
  .amdhsa_user_sgpr_count 2
  .amdhsa_user_sgpr_kernarg_segment_ptr 1
  .amdhsa_system_sgpr_workgroup_id_x 1
.end_amdhsa_kernel
```

```asm
; @launch grid=(256,1,1) block=(256,1,1) lds=163840
.amdgcn_target "amdgcn-amd-amdhsa--gfx950"
.text
.globl standalone__hybrid_graph_tf_graphgps__graph_kernel
.p2align 8
.type standalone__hybrid_graph_tf_graphgps__graph_kernel,@function
standalone__hybrid_graph_tf_graphgps__graph_kernel:
s_getpc_b64 s[56:57]
s_load_dwordx16 s[16:31], s[0:1], 0
s_load_dwordx8 s[32:39], s[0:1], 64
s_cmp_ge_u32 s2, 256
s_cbranch_scc1 L2_end
v_lshrrev_b32 v1, 6, v0
v_and_b32 v2, 63, v0
s_lshr_b32 s3, s2, 3
s_add_u32 s3, s3, 30
s_and_b32 s3, s3, 31
v_readfirstlane_b32 s60, v1
s_lshl_b32 s5, s3, 2
s_add_u32 s5, s5, s60
s_and_b32 s56, s56, 0xffffff00
s_mov_b32 s58, L2_end-standalone__hybrid_graph_tf_graphgps__graph_kernel
s_mov_b32 s59, 0x00020000
s_and_b32 s6, s5, 15
s_lshl_b32 s6, s6, 13
v_lshlrev_b32 v10, 7, v2
buffer_load_dword v255, v10, s[56:59], s6 offen
v_and_b32 v3, 15, v2
v_lshrrev_b32 v4, 4, v2
s_and_b32 s62, s3, 7
s_mov_b64 s[14:15], 0
s_and_b32 s8, s2, 7
s_cmp_ge_u32 s3, 30
s_cbranch_scc1 LM_edge
s_mul_i32 s12, s3, 26
s_lshr_b32 s12, s12, 8
s_mul_i32 s9, s12, 10
s_sub_u32 s9, s3, s9
s_and_b32 s13, s8, 1
s_mul_i32 s13, s13, 3
s_add_u32 s13, s13, s12
s_and_b32 s12, s8, 1
s_mul_i32 s12, s12, 5
s_add_u32 s8, s8, s12
s_and_b32 s8, s8, 7
s_lshr_b32 s12, s8, 1
s_mul_i32 s12, s12, 10
s_add_u32 s12, s12, s9
s_mul_i32 s91, s12, 6
s_add_u32 s91, s91, s13
s_mov_b32 s61, 0
s_cmp_eq_u32 s12, 39
s_cbranch_scc1 LM_light
s_mul_i32 s14, s13, 3
s_min_u32 s14, s14, 14
s_lshl_b32 s9, s12, 4
s_add_u32 s14, s14, s9
s_lshl_b32 s14, s14, 13
s_cmp_eq_u32 s91, 233
s_cselect_b32 s9, 0, s13
s_cmp_lt_u32 s9, 4
s_cselect_b32 s15, 3, 2
s_lshl_b32 s15, s15, 13
s_add_u32 s15, s15, s14
v_lshlrev_b32 v16, 4, v2
s_mul_i32 s63, s60, 12288
s_mov_b32 s6, s14
s_mul_i32 s7, s60, 6144
s_add_u32 s64, s6, s7
s_add_u32 s65, s64, 4096
s_lshl_b32 s7, s60, 7
v_lshrrev_b32 v5, 3, v2
v_and_b32 v6, 7, v2
v_and_b32 v7, 2, v5
v_xor_b32 v6, v6, v7
v_lshl_add_u32 v5, v5, 9, s7
v_lshl_add_u32 v17, v6, 4, v5
v_xor_b32 v6, 4, v6
v_lshl_add_u32 v18, v6, 4, v5
v_add_u32 v18, 0xc00, v18
v_add_u32 v19, 0x1800, v17
v_add_u32 v20, 0x1800, v18
s_xor_b32 s6, s62, 0
s_lshl_b32 s66, s6, 14
s_xor_b32 s6, s62, 1
s_lshl_b32 s67, s6, 14
s_xor_b32 s6, s62, 2
s_lshl_b32 s68, s6, 14
s_xor_b32 s6, s62, 3
s_lshl_b32 s69, s6, 14
s_xor_b32 s6, s62, 4
s_lshl_b32 s70, s6, 14
s_xor_b32 s6, s62, 5
s_lshl_b32 s71, s6, 14
s_xor_b32 s6, s62, 6
s_lshl_b32 s72, s6, 14
s_xor_b32 s6, s62, 7
s_lshl_b32 s73, s6, 14
s_waitcnt lgkmcnt(0)
s_add_u32 s40, s16, 0x0
s_addc_u32 s41, s17, 0
s_mov_b32 s42, s15
s_mov_b32 s43, 0x00020000
s_add_u32 s44, s26, 0x0
s_addc_u32 s45, s27, 0
s_mov_b32 s46, 0x20000
s_mov_b32 s47, 0x00020000
buffer_load_dwordx4 v[44:47], v16, s[40:43], s64 offen offset:0
buffer_load_dwordx4 v[48:51], v16, s[40:43], s64 offen offset:1024
buffer_load_dwordx4 v[52:55], v16, s[40:43], s64 offen offset:2048
buffer_load_dwordx4 v[56:59], v16, s[40:43], s64 offen offset:3072
buffer_load_dwordx4 v[60:63], v16, s[40:43], s65 offen offset:0
buffer_load_dwordx4 v[64:67], v16, s[40:43], s65 offen offset:1024
s_add_u32 m0, s63, 0x0
s_nop 0
buffer_load_dwordx4 v17, s[44:47], s66 offen offset:0 lds
buffer_load_dwordx4 v18, s[44:47], s66 offen offset:1024 lds
buffer_load_dwordx4 v19, s[44:47], s66 offen offset:2048 lds
buffer_load_dwordx4 v20, s[44:47], s66 offen offset:3072 lds
s_add_u32 m0, s63, 0x1000
s_nop 0
buffer_load_dwordx4 v17, s[44:47], s67 offen offset:0 lds
buffer_load_dwordx4 v18, s[44:47], s67 offen offset:1024 lds
buffer_load_dwordx4 v19, s[44:47], s67 offen offset:2048 lds
buffer_load_dwordx4 v20, s[44:47], s67 offen offset:3072 lds
s_mov_b32 s98, 0x7c3ff80
s_load_dwordx2 s[98:99], s[38:39], s98
v_bfe_u32 v5, v2, 2, 3
v_xor_b32 v5, s62, v5
v_and_b32 v6, 3, v2
v_lshlrev_b32 v7, 10, v5
v_lshl_add_u32 v7, v6, 8, v7
v_add_u32 v7, 0xc000, v7
v_and_b32 v5, 1, v5
v_lshl_or_b32 v6, v5, 2, v6
v_lshrrev_b32 v5, 5, v2
s_mul_i32 s6, s60, 12
v_add3_u32 v8, v5, s6, 0
v_lshrrev_b32 v9, 4, v8
v_lshl_add_u32 v9, v9, 13, v7
v_and_b32 v8, 15, v8
v_xor_b32 v8, v8, v6
v_lshl_add_u32 v36, v8, 4, v9
v_add3_u32 v8, v5, s6, 2
v_lshrrev_b32 v9, 4, v8
v_lshl_add_u32 v9, v9, 13, v7
v_and_b32 v8, 15, v8
v_xor_b32 v8, v8, v6
v_lshl_add_u32 v37, v8, 4, v9
v_add3_u32 v8, v5, s6, 4
v_lshrrev_b32 v9, 4, v8
v_lshl_add_u32 v9, v9, 13, v7
v_and_b32 v8, 15, v8
v_xor_b32 v8, v8, v6
v_lshl_add_u32 v38, v8, 4, v9
v_add3_u32 v8, v5, s6, 6
v_lshrrev_b32 v9, 4, v8
v_lshl_add_u32 v9, v9, 13, v7
v_and_b32 v8, 15, v8
v_xor_b32 v8, v8, v6
v_lshl_add_u32 v39, v8, 4, v9
v_add3_u32 v8, v5, s6, 8
v_lshrrev_b32 v9, 4, v8
v_lshl_add_u32 v9, v9, 13, v7
v_and_b32 v8, 15, v8
v_xor_b32 v8, v8, v6
v_lshl_add_u32 v40, v8, 4, v9
v_add3_u32 v8, v5, s6, 10
v_lshrrev_b32 v9, 4, v8
v_lshl_add_u32 v9, v9, 13, v7
v_and_b32 v8, 15, v8
v_xor_b32 v8, v8, v6
v_lshl_add_u32 v41, v8, 4, v9
v_xor_b32 v5, v3, v4
v_lshlrev_b32 v5, 4, v5
v_lshl_add_u32 v5, v4, 8, v5
v_add_u32 v31, 0xc000, v5
v_xor_b32 v32, 64, v31
v_lshrrev_b32 v5, 2, v3
v_and_b32 v6, 3, v3
v_and_b32 v7, 1, v4
v_lshlrev_b32 v7, 2, v7
v_and_b32 v8, 2, v5
v_or_b32 v7, v7, v8
v_lshl_add_u32 v8, v4, 3, v5
v_lshlrev_b32 v8, 7, v8
v_add_u32 v8, s63, v8
v_and_b32 v9, 1, v6
v_lshl_add_u32 v8, v9, 3, v8
v_lshrrev_b32 v6, 1, v6
v_xor_b32 v6, v6, v7
v_xor_b32 v9, 0, v6
v_lshl_add_u32 v25, v9, 4, v8
v_xor_b32 v9, 2, v6
v_lshl_add_u32 v26, v9, 4, v8
v_xor_b32 v9, 4, v6
v_lshl_add_u32 v27, v9, 4, v8
v_xor_b32 v9, 6, v6
v_lshl_add_u32 v28, v9, 4, v8
v_lshrrev_b32 v5, 3, v2
v_and_b32 v6, 7, v2
v_lshrrev_b32 v7, 1, v5
v_xor_b32 v6, v6, v7
v_and_b32 v7, 4, v5
v_add_u32 v5, v5, v7
s_mul_i32 s6, s60, 32768
v_lshl_add_u32 v5, v5, 9, s6
v_lshl_add_u32 v21, v6, 4, v5
v_xor_b32 v6, 4, v6
v_lshl_add_u32 v22, v6, 4, v5
v_add_u32 v22, 0x1c00, v22
v_mov_b32 v23, v21
v_mov_b32 v24, v22
s_lshr_b32 s7, s62, 1
s_xor_b32 s6, s7, 0
s_lshl_b32 s74, s6, 7
s_add_u32 s75, s74, 16384
s_xor_b32 s6, s7, 1
s_lshl_b32 s76, s6, 7
s_add_u32 s77, s76, 16384
s_xor_b32 s6, s7, 2
s_lshl_b32 s78, s6, 7
s_add_u32 s79, s78, 16384
s_xor_b32 s6, s7, 3
s_lshl_b32 s80, s6, 7
s_add_u32 s81, s80, 16384
s_and_b32 s6, s62, 1
s_lshl_b32 s6, s6, 2
v_lshrrev_b32 v5, 1, v3
v_xor_b32 v5, v5, v4
v_xor_b32 v5, s6, v5
v_lshl_add_u32 v6, v3, 7, s63
v_lshl_add_u32 v29, v5, 4, v6
v_xor_b32 v30, 64, v29
s_mul_i32 s6, s60, 2
s_xor_b32 s6, s6, s62
s_lshl_b32 s6, s6, 10
s_add_u32 s6, s6, 0x12000
v_lshrrev_b32 v5, 1, v4
v_and_b32 v6, 1, v4
v_lshl_add_u32 v5, v5, 8, s6
v_lshl_add_u32 v5, v6, 3, v5
v_lshl_add_u32 v33, v3, 4, v5
v_xor_b32 v34, 0x400, v33
v_add_u32 v35, 0x12000, v16
s_mov_b32 s6, s14
s_mul_i32 s7, s60, 2048
s_add_u32 s82, s6, s7
s_add_u32 s83, s82, 8192
s_add_u32 s84, s82, 16384
s_mov_b32 s86, 0x3db8aa3b
s_mov_b32 s87, 0x3db8aa3b
s_mov_b32 s88, 0x3727c5ac
s_mov_b32 s89, 0x3b800000
s_mov_b32 s90, 0xffff0000
s_add_u32 s48, s28, 0x0
s_addc_u32 s49, s29, 0
s_mov_b32 s50, 0x20000
s_mov_b32 s51, 0x00020000
s_add_u32 s52, s38, 0x0
s_addc_u32 s53, s39, 0
s_mov_b32 s54, s15
s_mov_b32 s55, 0x00020000
s_add_u32 s56, s38, 0x6800000
s_addc_u32 s57, s39, 0
s_mov_b32 s58, s15
s_mov_b32 s59, 0x00020000
s_waitcnt vmcnt(13)
v_lshlrev_b32 v116, 16, v44
v_and_b32 v117, s90, v44
v_lshlrev_b32 v118, 16, v45
v_and_b32 v119, s90, v45
v_lshlrev_b32 v120, 16, v46
v_and_b32 v121, s90, v46
v_lshlrev_b32 v122, 16, v47
v_and_b32 v123, s90, v47
v_pk_add_f32 v[164:165], v[116:117], v[118:119]
v_pk_mul_f32 v[166:167], v[116:117], v[116:117]
v_pk_add_f32 v[44:45], v[120:121], v[122:123]
v_pk_fma_f32 v[166:167], v[118:119], v[118:119], v[166:167]
v_pk_add_f32 v[164:165], v[164:165], v[44:45]
v_pk_fma_f32 v[166:167], v[120:121], v[120:121], v[166:167]
v_add_f32 v164, v164, v165
v_pk_fma_f32 v[166:167], v[122:123], v[122:123], v[166:167]
v_add_f32 v166, v166, v167
s_waitcnt vmcnt(12)
v_lshlrev_b32 v124, 16, v48
v_and_b32 v125, s90, v48
v_lshlrev_b32 v126, 16, v49
v_and_b32 v127, s90, v49
v_lshlrev_b32 v128, 16, v50
v_and_b32 v129, s90, v50
v_lshlrev_b32 v130, 16, v51
v_and_b32 v131, s90, v51
v_pk_add_f32 v[168:169], v[124:125], v[126:127]
v_pk_mul_f32 v[170:171], v[124:125], v[124:125]
v_pk_add_f32 v[48:49], v[128:129], v[130:131]
v_pk_fma_f32 v[170:171], v[126:127], v[126:127], v[170:171]
v_pk_add_f32 v[168:169], v[168:169], v[48:49]
v_pk_fma_f32 v[170:171], v[128:129], v[128:129], v[170:171]
v_add_f32 v168, v168, v169
v_pk_fma_f32 v[170:171], v[130:131], v[130:131], v[170:171]
v_add_f32 v170, v170, v171
s_waitcnt vmcnt(11)
v_lshlrev_b32 v132, 16, v52
v_and_b32 v133, s90, v52
v_lshlrev_b32 v134, 16, v53
v_and_b32 v135, s90, v53
v_lshlrev_b32 v136, 16, v54
v_and_b32 v137, s90, v54
v_lshlrev_b32 v138, 16, v55
v_and_b32 v139, s90, v55
v_pk_add_f32 v[172:173], v[132:133], v[134:135]
v_pk_mul_f32 v[174:175], v[132:133], v[132:133]
v_pk_add_f32 v[52:53], v[136:137], v[138:139]
v_pk_fma_f32 v[174:175], v[134:135], v[134:135], v[174:175]
v_pk_add_f32 v[172:173], v[172:173], v[52:53]
v_pk_fma_f32 v[174:175], v[136:137], v[136:137], v[174:175]
v_add_f32 v172, v172, v173
v_pk_fma_f32 v[174:175], v[138:139], v[138:139], v[174:175]
v_add_f32 v174, v174, v175
s_waitcnt vmcnt(10)
v_lshlrev_b32 v140, 16, v56
v_and_b32 v141, s90, v56
v_lshlrev_b32 v142, 16, v57
v_and_b32 v143, s90, v57
v_lshlrev_b32 v144, 16, v58
v_and_b32 v145, s90, v58
v_lshlrev_b32 v146, 16, v59
v_and_b32 v147, s90, v59
v_pk_add_f32 v[176:177], v[140:141], v[142:143]
v_pk_mul_f32 v[178:179], v[140:141], v[140:141]
v_pk_add_f32 v[56:57], v[144:145], v[146:147]
v_pk_fma_f32 v[178:179], v[142:143], v[142:143], v[178:179]
v_pk_add_f32 v[176:177], v[176:177], v[56:57]
v_pk_fma_f32 v[178:179], v[144:145], v[144:145], v[178:179]
v_add_f32 v176, v176, v177
v_pk_fma_f32 v[178:179], v[146:147], v[146:147], v[178:179]
v_add_f32 v178, v178, v179
s_waitcnt vmcnt(9)
v_lshlrev_b32 v148, 16, v60
v_and_b32 v149, s90, v60
v_lshlrev_b32 v150, 16, v61
v_and_b32 v151, s90, v61
v_lshlrev_b32 v152, 16, v62
v_and_b32 v153, s90, v62
v_lshlrev_b32 v154, 16, v63
v_and_b32 v155, s90, v63
v_pk_add_f32 v[180:181], v[148:149], v[150:151]
v_pk_mul_f32 v[182:183], v[148:149], v[148:149]
v_pk_add_f32 v[60:61], v[152:153], v[154:155]
v_pk_fma_f32 v[182:183], v[150:151], v[150:151], v[182:183]
v_pk_add_f32 v[180:181], v[180:181], v[60:61]
v_pk_fma_f32 v[182:183], v[152:153], v[152:153], v[182:183]
v_add_f32 v180, v180, v181
v_pk_fma_f32 v[182:183], v[154:155], v[154:155], v[182:183]
v_add_f32 v182, v182, v183
s_waitcnt vmcnt(8)
v_lshlrev_b32 v156, 16, v64
v_and_b32 v157, s90, v64
v_lshlrev_b32 v158, 16, v65
v_and_b32 v159, s90, v65
v_lshlrev_b32 v160, 16, v66
v_and_b32 v161, s90, v66
v_lshlrev_b32 v162, 16, v67
v_and_b32 v163, s90, v67
v_pk_add_f32 v[184:185], v[156:157], v[158:159]
v_pk_mul_f32 v[186:187], v[156:157], v[156:157]
v_pk_add_f32 v[64:65], v[160:161], v[162:163]
v_pk_fma_f32 v[186:187], v[158:159], v[158:159], v[186:187]
v_pk_add_f32 v[184:185], v[184:185], v[64:65]
v_pk_fma_f32 v[186:187], v[160:161], v[160:161], v[186:187]
v_add_f32 v184, v184, v185
v_pk_fma_f32 v[186:187], v[162:163], v[162:163], v[186:187]
v_add_f32 v186, v186, v187
v_permlane16_swap_b32 v164, v166
v_permlane16_swap_b32 v168, v170
v_permlane16_swap_b32 v172, v174
v_permlane16_swap_b32 v176, v178
v_permlane16_swap_b32 v180, v182
v_permlane16_swap_b32 v184, v186
v_add_f32 v164, v164, v166
v_add_f32 v168, v168, v170
v_add_f32 v172, v172, v174
v_add_f32 v176, v176, v178
v_add_f32 v180, v180, v182
v_add_f32 v184, v184, v186
v_add_f32_dpp v165, v164, v164 row_ror:8 row_mask:0xf bank_mask:0x3
v_add_f32_dpp v165, v168, v168 row_ror:8 row_mask:0xf bank_mask:0xc
v_add_f32_dpp v173, v172, v172 row_ror:8 row_mask:0xf bank_mask:0x3
v_add_f32_dpp v173, v176, v176 row_ror:8 row_mask:0xf bank_mask:0xc
v_add_f32_dpp v181, v180, v180 row_ror:8 row_mask:0xf bank_mask:0x3
v_add_f32_dpp v181, v184, v184 row_ror:8 row_mask:0xf bank_mask:0xc
v_add_f32_dpp v166, v165, v165 row_half_mirror row_mask:0xf bank_mask:0x5
v_add_f32_dpp v166, v173, v173 row_half_mirror row_mask:0xf bank_mask:0xa
v_add_f32_dpp v182, v181, v181 row_half_mirror row_mask:0xf bank_mask:0xf
s_nop 0
v_add_f32_dpp v166, v166, v166 quad_perm:[1,0,3,2] row_mask:0xf bank_mask:0xf
v_add_f32_dpp v182, v182, v182 quad_perm:[1,0,3,2] row_mask:0xf bank_mask:0xf
s_nop 0
v_add_f32_dpp v166, v166, v166 quad_perm:[2,3,0,1] row_mask:0xf bank_mask:0xf
v_add_f32_dpp v182, v182, v182 quad_perm:[2,3,0,1] row_mask:0xf bank_mask:0xf
v_mov_b32 v167, v166
v_mov_b32 v183, v182
s_nop 0
v_permlane16_swap_b32 v167, v166
v_permlane16_swap_b32 v183, v182
v_mul_f32 v167, s89, v167
v_mul_f32 v183, s89, v183
v_mul_f32 v166, s89, v166
v_mul_f32 v182, s89, v182
v_fma_f32 v166, -v167, v167, v166
v_fma_f32 v182, -v183, v183, v182
v_cvt_pk_bf16_f32 v167, v167, v167
v_cvt_pk_bf16_f32 v183, v183, v183
v_max_f32 v166, 0, v166
v_max_f32 v182, 0, v182
v_cvt_pk_bf16_f32 v166, v166, v166
v_cvt_pk_bf16_f32 v182, v182, v182
v_and_b32 v166, s90, v166
v_and_b32 v182, s90, v182
v_add_f32 v166, s88, v166
v_add_f32 v182, s88, v182
v_cvt_pk_bf16_f32 v166, v166, v166
v_cvt_pk_bf16_f32 v182, v182, v182
v_and_b32 v166, s90, v166
v_and_b32 v182, s90, v182
v_sqrt_f32 v166, v166
v_sqrt_f32 v182, v182
v_and_b32 v167, s90, v167
v_and_b32 v183, s90, v183
v_cvt_pk_bf16_f32 v166, v166, v166
v_cvt_pk_bf16_f32 v182, v182, v182
v_and_b32 v166, s90, v166
v_and_b32 v182, s90, v182
v_rcp_f32 v166, v166
v_rcp_f32 v182, v182
v_mul_f32 v167, -v167, v166
v_mul_f32 v183, -v183, v182
s_nop 0
v_mov_b64_dpp v[164:165], v[166:167] row_newbcast:0 row_mask:0xf bank_mask:0xf
v_mov_b64_dpp v[168:169], v[166:167] row_newbcast:8 row_mask:0xf bank_mask:0xf
v_mov_b64_dpp v[172:173], v[166:167] row_newbcast:4 row_mask:0xf bank_mask:0xf
v_mov_b64_dpp v[176:177], v[166:167] row_newbcast:12 row_mask:0xf bank_mask:0xf
v_mov_b64_dpp v[180:181], v[182:183] row_newbcast:0 row_mask:0xf bank_mask:0xf
v_mov_b64_dpp v[184:185], v[182:183] row_newbcast:8 row_mask:0xf bank_mask:0xf
v_fma_f32 v116, v116, v164, v165
v_fma_f32 v117, v117, v164, v165
v_fma_f32 v118, v118, v164, v165
v_fma_f32 v119, v119, v164, v165
v_fma_f32 v120, v120, v164, v165
v_fma_f32 v121, v121, v164, v165
v_fma_f32 v122, v122, v164, v165
v_fma_f32 v123, v123, v164, v165
v_cvt_pk_bf16_f32 v44, v116, v117
v_cvt_pk_bf16_f32 v45, v118, v119
v_cvt_pk_bf16_f32 v46, v120, v121
v_cvt_pk_bf16_f32 v47, v122, v123
ds_write_b128 v36, v[44:47]
v_fma_f32 v124, v124, v168, v169
v_fma_f32 v125, v125, v168, v169
v_fma_f32 v126, v126, v168, v169
v_fma_f32 v127, v127, v168, v169
v_fma_f32 v128, v128, v168, v169
v_fma_f32 v129, v129, v168, v169
v_fma_f32 v130, v130, v168, v169
v_fma_f32 v131, v131, v168, v169
v_cvt_pk_bf16_f32 v48, v124, v125
v_cvt_pk_bf16_f32 v49, v126, v127
v_cvt_pk_bf16_f32 v50, v128, v129
v_cvt_pk_bf16_f32 v51, v130, v131
ds_write_b128 v37, v[48:51]
v_fma_f32 v132, v132, v172, v173
v_fma_f32 v133, v133, v172, v173
v_fma_f32 v134, v134, v172, v173
v_fma_f32 v135, v135, v172, v173
v_fma_f32 v136, v136, v172, v173
v_fma_f32 v137, v137, v172, v173
v_fma_f32 v138, v138, v172, v173
v_fma_f32 v139, v139, v172, v173
v_cvt_pk_bf16_f32 v52, v132, v133
v_cvt_pk_bf16_f32 v53, v134, v135
v_cvt_pk_bf16_f32 v54, v136, v137
v_cvt_pk_bf16_f32 v55, v138, v139
ds_write_b128 v38, v[52:55]
v_fma_f32 v140, v140, v176, v177
v_fma_f32 v141, v141, v176, v177
v_fma_f32 v142, v142, v176, v177
v_fma_f32 v143, v143, v176, v177
v_fma_f32 v144, v144, v176, v177
v_fma_f32 v145, v145, v176, v177
v_fma_f32 v146, v146, v176, v177
v_fma_f32 v147, v147, v176, v177
v_cvt_pk_bf16_f32 v56, v140, v141
v_cvt_pk_bf16_f32 v57, v142, v143
v_cvt_pk_bf16_f32 v58, v144, v145
v_cvt_pk_bf16_f32 v59, v146, v147
ds_write_b128 v39, v[56:59]
v_fma_f32 v148, v148, v180, v181
v_fma_f32 v149, v149, v180, v181
v_fma_f32 v150, v150, v180, v181
v_fma_f32 v151, v151, v180, v181
v_fma_f32 v152, v152, v180, v181
v_fma_f32 v153, v153, v180, v181
v_fma_f32 v154, v154, v180, v181
v_fma_f32 v155, v155, v180, v181
v_cvt_pk_bf16_f32 v60, v148, v149
v_cvt_pk_bf16_f32 v61, v150, v151
v_cvt_pk_bf16_f32 v62, v152, v153
v_cvt_pk_bf16_f32 v63, v154, v155
ds_write_b128 v40, v[60:63]
v_fma_f32 v156, v156, v184, v185
v_fma_f32 v157, v157, v184, v185
v_fma_f32 v158, v158, v184, v185
v_fma_f32 v159, v159, v184, v185
v_fma_f32 v160, v160, v184, v185
v_fma_f32 v161, v161, v184, v185
v_fma_f32 v162, v162, v184, v185
v_fma_f32 v163, v163, v184, v185
v_cvt_pk_bf16_f32 v64, v156, v157
v_cvt_pk_bf16_f32 v65, v158, v159
v_cvt_pk_bf16_f32 v66, v160, v161
v_cvt_pk_bf16_f32 v67, v162, v163
ds_write_b128 v41, v[64:67]
s_add_u32 m0, s63, 0x2000
s_nop 0
buffer_load_dwordx4 v17, s[44:47], s68 offen offset:0 lds
buffer_load_dwordx4 v18, s[44:47], s68 offen offset:1024 lds
buffer_load_dwordx4 v19, s[44:47], s68 offen offset:2048 lds
buffer_load_dwordx4 v20, s[44:47], s68 offen offset:3072 lds
s_waitcnt vmcnt(8)
ds_read_b64_tr_b16 v[164:165], v25 offset:0
ds_read_b64_tr_b16 v[166:167], v25 offset:512
ds_read_b64_tr_b16 v[168:169], v26 offset:0
ds_read_b64_tr_b16 v[170:171], v26 offset:512
ds_read_b64_tr_b16 v[172:173], v27 offset:0
ds_read_b64_tr_b16 v[174:175], v27 offset:512
s_waitcnt lgkmcnt(6)
s_barrier
ds_read_b128 v[204:207], v31 offset:0
ds_read_b128 v[208:211], v31 offset:8192
ds_read_b128 v[212:215], v31 offset:16384
s_waitcnt lgkmcnt(2)
v_mfma_f32_16x16x32_bf16 v[68:71], v[164:167], v[204:207], 0
s_waitcnt lgkmcnt(1)
v_mfma_f32_16x16x32_bf16 v[72:75], v[164:167], v[208:211], 0
s_waitcnt lgkmcnt(0)
v_mfma_f32_16x16x32_bf16 v[76:79], v[164:167], v[212:215], 0
ds_read_b64_tr_b16 v[176:177], v28 offset:0
ds_read_b64_tr_b16 v[178:179], v28 offset:512
v_mfma_f32_16x16x32_bf16 v[80:83], v[168:171], v[204:207], 0
v_mfma_f32_16x16x32_bf16 v[84:87], v[168:171], v[208:211], 0
v_mfma_f32_16x16x32_bf16 v[88:91], v[168:171], v[212:215], 0
ds_read_b128 v[216:219], v32 offset:1024
s_waitcnt vmcnt(4)
ds_read_b64_tr_b16 v[180:181], v25 offset:4096
ds_read_b64_tr_b16 v[182:183], v25 offset:4608
v_mfma_f32_16x16x32_bf16 v[92:95], v[172:175], v[204:207], 0
ds_read_b128 v[220:223], v32 offset:9216
v_mfma_f32_16x16x32_bf16 v[96:99], v[172:175], v[208:211], 0
ds_read_b128 v[224:227], v32 offset:17408
v_mfma_f32_16x16x32_bf16 v[100:103], v[172:175], v[212:215], 0
ds_read_b64_tr_b16 v[184:185], v26 offset:4096
ds_read_b64_tr_b16 v[186:187], v26 offset:4608
s_waitcnt lgkmcnt(7)
v_mfma_f32_16x16x32_bf16 v[104:107], v[176:179], v[204:207], 0
s_add_u32 m0, s63, 0x0
s_nop 0
buffer_load_dwordx4 v17, s[44:47], s69 offen offset:0 lds
buffer_load_dwordx4 v18, s[44:47], s69 offen offset:1024 lds
buffer_load_dwordx4 v19, s[44:47], s69 offen offset:2048 lds
buffer_load_dwordx4 v20, s[44:47], s69 offen offset:3072 lds
v_mfma_f32_16x16x32_bf16 v[108:111], v[176:179], v[208:211], 0
v_mfma_f32_16x16x32_bf16 v[112:115], v[176:179], v[212:215], 0
ds_read_b64_tr_b16 v[188:189], v27 offset:4096
ds_read_b64_tr_b16 v[190:191], v27 offset:4608
s_waitcnt lgkmcnt(6)
v_mfma_f32_16x16x32_bf16 v[68:71], v[180:183], v[216:219], v[68:71]
s_waitcnt lgkmcnt(5)
v_mfma_f32_16x16x32_bf16 v[72:75], v[180:183], v[220:223], v[72:75]
s_waitcnt lgkmcnt(4)
v_mfma_f32_16x16x32_bf16 v[76:79], v[180:183], v[224:227], v[76:79]
ds_read_b64_tr_b16 v[192:193], v28 offset:4096
ds_read_b64_tr_b16 v[194:195], v28 offset:4608
s_waitcnt lgkmcnt(4)
v_mfma_f32_16x16x32_bf16 v[80:83], v[184:187], v[216:219], v[80:83]
v_mfma_f32_16x16x32_bf16 v[84:87], v[184:187], v[220:223], v[84:87]
v_mfma_f32_16x16x32_bf16 v[88:91], v[184:187], v[224:227], v[88:91]
ds_read_b128 v[228:231], v31 offset:2048
s_waitcnt vmcnt(4)
ds_read_b64_tr_b16 v[196:197], v25 offset:8192
ds_read_b64_tr_b16 v[198:199], v25 offset:8704
s_waitcnt lgkmcnt(5)
v_mfma_f32_16x16x32_bf16 v[92:95], v[188:191], v[216:219], v[92:95]
ds_read_b128 v[232:235], v31 offset:10240
v_mfma_f32_16x16x32_bf16 v[96:99], v[188:191], v[220:223], v[96:99]
ds_read_b128 v[236:239], v31 offset:18432
v_mfma_f32_16x16x32_bf16 v[100:103], v[188:191], v[224:227], v[100:103]
ds_read_b64_tr_b16 v[200:201], v26 offset:8192
ds_read_b64_tr_b16 v[202:203], v26 offset:8704
s_waitcnt lgkmcnt(7)
v_mfma_f32_16x16x32_bf16 v[104:107], v[192:195], v[216:219], v[104:107]
s_add_u32 m0, s63, 0x1000
s_nop 0
buffer_load_dwordx4 v17, s[44:47], s70 offen offset:0 lds
buffer_load_dwordx4 v18, s[44:47], s70 offen offset:1024 lds
buffer_load_dwordx4 v19, s[44:47], s70 offen offset:2048 lds
buffer_load_dwordx4 v20, s[44:47], s70 offen offset:3072 lds
v_mfma_f32_16x16x32_bf16 v[108:111], v[192:195], v[220:223], v[108:111]
v_mfma_f32_16x16x32_bf16 v[112:115], v[192:195], v[224:227], v[112:115]
ds_read_b64_tr_b16 v[164:165], v27 offset:8192
ds_read_b64_tr_b16 v[166:167], v27 offset:8704
s_waitcnt lgkmcnt(6)
v_mfma_f32_16x16x32_bf16 v[68:71], v[196:199], v[228:231], v[68:71]
s_waitcnt lgkmcnt(5)
v_mfma_f32_16x16x32_bf16 v[72:75], v[196:199], v[232:235], v[72:75]
s_waitcnt lgkmcnt(4)
v_mfma_f32_16x16x32_bf16 v[76:79], v[196:199], v[236:239], v[76:79]
ds_read_b64_tr_b16 v[168:169], v28 offset:8192
ds_read_b64_tr_b16 v[170:171], v28 offset:8704
s_waitcnt lgkmcnt(4)
v_mfma_f32_16x16x32_bf16 v[80:83], v[200:203], v[228:231], v[80:83]
v_mfma_f32_16x16x32_bf16 v[84:87], v[200:203], v[232:235], v[84:87]
v_mfma_f32_16x16x32_bf16 v[88:91], v[200:203], v[236:239], v[88:91]
ds_read_b128 v[204:207], v32 offset:3072
s_waitcnt vmcnt(4)
ds_read_b64_tr_b16 v[172:173], v25 offset:0
ds_read_b64_tr_b16 v[174:175], v25 offset:512
s_waitcnt lgkmcnt(5)
v_mfma_f32_16x16x32_bf16 v[92:95], v[164:167], v[228:231], v[92:95]
ds_read_b128 v[208:211], v32 offset:11264
v_mfma_f32_16x16x32_bf16 v[96:99], v[164:167], v[232:235], v[96:99]
ds_read_b128 v[212:215], v32 offset:19456
v_mfma_f32_16x16x32_bf16 v[100:103], v[164:167], v[236:239], v[100:103]
ds_read_b64_tr_b16 v[176:177], v26 offset:0
ds_read_b64_tr_b16 v[178:179], v26 offset:512
s_waitcnt lgkmcnt(7)
v_mfma_f32_16x16x32_bf16 v[104:107], v[168:171], v[228:231], v[104:107]
s_add_u32 m0, s63, 0x2000
s_nop 0
buffer_load_dwordx4 v17, s[44:47], s71 offen offset:0 lds
buffer_load_dwordx4 v18, s[44:47], s71 offen offset:1024 lds
buffer_load_dwordx4 v19, s[44:47], s71 offen offset:2048 lds
buffer_load_dwordx4 v20, s[44:47], s71 offen offset:3072 lds
v_mfma_f32_16x16x32_bf16 v[108:111], v[168:171], v[232:235], v[108:111]
v_mfma_f32_16x16x32_bf16 v[112:115], v[168:171], v[236:239], v[112:115]
ds_read_b64_tr_b16 v[180:181], v27 offset:0
ds_read_b64_tr_b16 v[182:183], v27 offset:512
s_waitcnt lgkmcnt(6)
v_mfma_f32_16x16x32_bf16 v[68:71], v[172:175], v[204:207], v[68:71]
s_waitcnt lgkmcnt(5)
v_mfma_f32_16x16x32_bf16 v[72:75], v[172:175], v[208:211], v[72:75]
s_waitcnt lgkmcnt(4)
v_mfma_f32_16x16x32_bf16 v[76:79], v[172:175], v[212:215], v[76:79]
ds_read_b64_tr_b16 v[184:185], v28 offset:0
ds_read_b64_tr_b16 v[186:187], v28 offset:512
s_waitcnt lgkmcnt(4)
v_mfma_f32_16x16x32_bf16 v[80:83], v[176:179], v[204:207], v[80:83]
v_mfma_f32_16x16x32_bf16 v[84:87], v[176:179], v[208:211], v[84:87]
v_mfma_f32_16x16x32_bf16 v[88:91], v[176:179], v[212:215], v[88:91]
ds_read_b128 v[216:219], v31 offset:4096
s_waitcnt vmcnt(4)
ds_read_b64_tr_b16 v[188:189], v25 offset:4096
ds_read_b64_tr_b16 v[190:191], v25 offset:4608
s_waitcnt lgkmcnt(5)
v_mfma_f32_16x16x32_bf16 v[92:95], v[180:183], v[204:207], v[92:95]
ds_read_b128 v[220:223], v31 offset:12288
v_mfma_f32_16x16x32_bf16 v[96:99], v[180:183], v[208:211], v[96:99]
ds_read_b128 v[224:227], v31 offset:20480
v_mfma_f32_16x16x32_bf16 v[100:103], v[180:183], v[212:215], v[100:103]
ds_read_b64_tr_b16 v[192:193], v26 offset:4096
ds_read_b64_tr_b16 v[194:195], v26 offset:4608
s_waitcnt lgkmcnt(7)
v_mfma_f32_16x16x32_bf16 v[104:107], v[184:187], v[204:207], v[104:107]
s_add_u32 m0, s63, 0x0
s_nop 0
buffer_load_dwordx4 v17, s[44:47], s72 offen offset:0 lds
buffer_load_dwordx4 v18, s[44:47], s72 offen offset:1024 lds
buffer_load_dwordx4 v19, s[44:47], s72 offen offset:2048 lds
buffer_load_dwordx4 v20, s[44:47], s72 offen offset:3072 lds
v_mfma_f32_16x16x32_bf16 v[108:111], v[184:187], v[208:211], v[108:111]
v_mfma_f32_16x16x32_bf16 v[112:115], v[184:187], v[212:215], v[112:115]
ds_read_b64_tr_b16 v[196:197], v27 offset:4096
ds_read_b64_tr_b16 v[198:199], v27 offset:4608
s_waitcnt lgkmcnt(6)
v_mfma_f32_16x16x32_bf16 v[68:71], v[188:191], v[216:219], v[68:71]
s_waitcnt lgkmcnt(5)
v_mfma_f32_16x16x32_bf16 v[72:75], v[188:191], v[220:223], v[72:75]
s_waitcnt lgkmcnt(4)
v_mfma_f32_16x16x32_bf16 v[76:79], v[188:191], v[224:227], v[76:79]
ds_read_b64_tr_b16 v[200:201], v28 offset:4096
ds_read_b64_tr_b16 v[202:203], v28 offset:4608
s_waitcnt lgkmcnt(4)
v_mfma_f32_16x16x32_bf16 v[80:83], v[192:195], v[216:219], v[80:83]
v_mfma_f32_16x16x32_bf16 v[84:87], v[192:195], v[220:223], v[84:87]
v_mfma_f32_16x16x32_bf16 v[88:91], v[192:195], v[224:227], v[88:91]
ds_read_b128 v[228:231], v32 offset:5120
s_waitcnt vmcnt(4)
ds_read_b64_tr_b16 v[164:165], v25 offset:8192
ds_read_b64_tr_b16 v[166:167], v25 offset:8704
s_waitcnt lgkmcnt(5)
v_mfma_f32_16x16x32_bf16 v[92:95], v[196:199], v[216:219], v[92:95]
ds_read_b128 v[232:235], v32 offset:13312
v_mfma_f32_16x16x32_bf16 v[96:99], v[196:199], v[220:223], v[96:99]
ds_read_b128 v[236:239], v32 offset:21504
v_mfma_f32_16x16x32_bf16 v[100:103], v[196:199], v[224:227], v[100:103]
ds_read_b64_tr_b16 v[168:169], v26 offset:8192
ds_read_b64_tr_b16 v[170:171], v26 offset:8704
s_waitcnt lgkmcnt(7)
v_mfma_f32_16x16x32_bf16 v[104:107], v[200:203], v[216:219], v[104:107]
s_add_u32 m0, s63, 0x1000
s_nop 0
buffer_load_dwordx4 v17, s[44:47], s73 offen offset:0 lds
buffer_load_dwordx4 v18, s[44:47], s73 offen offset:1024 lds
buffer_load_dwordx4 v19, s[44:47], s73 offen offset:2048 lds
buffer_load_dwordx4 v20, s[44:47], s73 offen offset:3072 lds
v_mfma_f32_16x16x32_bf16 v[108:111], v[200:203], v[220:223], v[108:111]
v_mfma_f32_16x16x32_bf16 v[112:115], v[200:203], v[224:227], v[112:115]
ds_read_b64_tr_b16 v[172:173], v27 offset:8192
ds_read_b64_tr_b16 v[174:175], v27 offset:8704
s_waitcnt lgkmcnt(6)
v_mfma_f32_16x16x32_bf16 v[68:71], v[164:167], v[228:231], v[68:71]
s_waitcnt lgkmcnt(5)
v_mfma_f32_16x16x32_bf16 v[72:75], v[164:167], v[232:235], v[72:75]
s_waitcnt lgkmcnt(4)
v_mfma_f32_16x16x32_bf16 v[76:79], v[164:167], v[236:239], v[76:79]
ds_read_b64_tr_b16 v[176:177], v28 offset:8192
ds_read_b64_tr_b16 v[178:179], v28 offset:8704
s_waitcnt lgkmcnt(4)
v_mfma_f32_16x16x32_bf16 v[80:83], v[168:171], v[228:231], v[80:83]
v_mfma_f32_16x16x32_bf16 v[84:87], v[168:171], v[232:235], v[84:87]
v_mfma_f32_16x16x32_bf16 v[88:91], v[168:171], v[236:239], v[88:91]
ds_read_b128 v[204:207], v31 offset:6144
s_waitcnt vmcnt(4)
ds_read_b64_tr_b16 v[180:181], v25 offset:0
ds_read_b64_tr_b16 v[182:183], v25 offset:512
s_waitcnt lgkmcnt(5)
v_mfma_f32_16x16x32_bf16 v[92:95], v[172:175], v[228:231], v[92:95]
ds_read_b128 v[208:211], v31 offset:14336
v_mfma_f32_16x16x32_bf16 v[96:99], v[172:175], v[232:235], v[96:99]
ds_read_b128 v[212:215], v31 offset:22528
v_mfma_f32_16x16x32_bf16 v[100:103], v[172:175], v[236:239], v[100:103]
ds_read_b64_tr_b16 v[184:185], v26 offset:0
ds_read_b64_tr_b16 v[186:187], v26 offset:512
s_waitcnt lgkmcnt(7)
v_mfma_f32_16x16x32_bf16 v[104:107], v[176:179], v[228:231], v[104:107]
s_add_u32 m0, s63, 0x2000
s_nop 0
buffer_load_dwordx4 v21, s[48:51], s74 offen offset:0 lds
buffer_load_dwordx4 v22, s[48:51], s74 offen offset:1024 lds
buffer_load_dwordx4 v23, s[48:51], s74 offen offset:2048 lds
buffer_load_dwordx4 v24, s[48:51], s74 offen offset:3072 lds
v_mfma_f32_16x16x32_bf16 v[108:111], v[176:179], v[232:235], v[108:111]
v_mfma_f32_16x16x32_bf16 v[112:115], v[176:179], v[236:239], v[112:115]
ds_read_b64_tr_b16 v[188:189], v27 offset:0
ds_read_b64_tr_b16 v[190:191], v27 offset:512
s_waitcnt lgkmcnt(6)
v_mfma_f32_16x16x32_bf16 v[68:71], v[180:183], v[204:207], v[68:71]
s_waitcnt lgkmcnt(5)
v_mfma_f32_16x16x32_bf16 v[72:75], v[180:183], v[208:211], v[72:75]
s_waitcnt lgkmcnt(4)
v_mfma_f32_16x16x32_bf16 v[76:79], v[180:183], v[212:215], v[76:79]
ds_read_b64_tr_b16 v[192:193], v28 offset:0
ds_read_b64_tr_b16 v[194:195], v28 offset:512
s_waitcnt lgkmcnt(4)
v_mfma_f32_16x16x32_bf16 v[80:83], v[184:187], v[204:207], v[80:83]
v_mfma_f32_16x16x32_bf16 v[84:87], v[184:187], v[208:211], v[84:87]
v_mfma_f32_16x16x32_bf16 v[88:91], v[184:187], v[212:215], v[88:91]
ds_read_b128 v[216:219], v32 offset:7168
s_waitcnt vmcnt(4)
ds_read_b64_tr_b16 v[196:197], v25 offset:4096
ds_read_b64_tr_b16 v[198:199], v25 offset:4608
s_waitcnt lgkmcnt(5)
v_mfma_f32_16x16x32_bf16 v[92:95], v[188:191], v[204:207], v[92:95]
ds_read_b128 v[220:223], v32 offset:15360
v_mfma_f32_16x16x32_bf16 v[96:99], v[188:191], v[208:211], v[96:99]
ds_read_b128 v[224:227], v32 offset:23552
v_mfma_f32_16x16x32_bf16 v[100:103], v[188:191], v[212:215], v[100:103]
ds_read_b64_tr_b16 v[200:201], v26 offset:4096
ds_read_b64_tr_b16 v[202:203], v26 offset:4608
s_waitcnt lgkmcnt(7)
v_mfma_f32_16x16x32_bf16 v[104:107], v[192:195], v[204:207], v[104:107]
s_add_u32 m0, s63, 0x0
s_nop 0
buffer_load_dwordx4 v21, s[48:51], s75 offen offset:0 lds
buffer_load_dwordx4 v22, s[48:51], s75 offen offset:1024 lds
buffer_load_dwordx4 v23, s[48:51], s75 offen offset:2048 lds
buffer_load_dwordx4 v24, s[48:51], s75 offen offset:3072 lds
v_mfma_f32_16x16x32_bf16 v[108:111], v[192:195], v[208:211], v[108:111]
v_mfma_f32_16x16x32_bf16 v[112:115], v[192:195], v[212:215], v[112:115]
ds_read_b64_tr_b16 v[164:165], v27 offset:4096
ds_read_b64_tr_b16 v[166:167], v27 offset:4608
s_waitcnt lgkmcnt(6)
v_mfma_f32_16x16x32_bf16 v[68:71], v[196:199], v[216:219], v[68:71]
s_waitcnt lgkmcnt(5)
v_mfma_f32_16x16x32_bf16 v[72:75], v[196:199], v[220:223], v[72:75]
s_waitcnt lgkmcnt(4)
v_mfma_f32_16x16x32_bf16 v[76:79], v[196:199], v[224:227], v[76:79]
ds_read_b64_tr_b16 v[168:169], v28 offset:4096
ds_read_b64_tr_b16 v[170:171], v28 offset:4608
s_waitcnt lgkmcnt(4)
v_mfma_f32_16x16x32_bf16 v[80:83], v[200:203], v[216:219], v[80:83]
v_cvt_pk_bf16_f32 v68, v68, v69
v_cvt_pk_bf16_f32 v69, v70, v71
ds_write_b64 v33, v[68:69] offset:0
v_mfma_f32_16x16x32_bf16 v[84:87], v[200:203], v[220:223], v[84:87]
v_cvt_pk_bf16_f32 v72, v72, v73
v_cvt_pk_bf16_f32 v73, v74, v75
ds_write_b64 v33, v[72:73] offset:8192
v_mfma_f32_16x16x32_bf16 v[88:91], v[200:203], v[224:227], v[88:91]
v_cvt_pk_bf16_f32 v76, v76, v77
v_cvt_pk_bf16_f32 v77, v78, v79
ds_write_b64 v33, v[76:77] offset:16384
s_waitcnt lgkmcnt(5)
v_mfma_f32_16x16x32_bf16 v[92:95], v[164:167], v[216:219], v[92:95]
v_cvt_pk_bf16_f32 v80, v80, v81
v_cvt_pk_bf16_f32 v81, v82, v83
ds_write_b64 v33, v[80:81] offset:512
v_mfma_f32_16x16x32_bf16 v[96:99], v[164:167], v[220:223], v[96:99]
v_cvt_pk_bf16_f32 v84, v84, v85
v_cvt_pk_bf16_f32 v85, v86, v87
ds_write_b64 v33, v[84:85] offset:8704
v_mfma_f32_16x16x32_bf16 v[100:103], v[164:167], v[224:227], v[100:103]
v_cvt_pk_bf16_f32 v88, v88, v89
v_cvt_pk_bf16_f32 v89, v90, v91
ds_write_b64 v33, v[88:89] offset:16896
s_waitcnt lgkmcnt(6)
v_mfma_f32_16x16x32_bf16 v[104:107], v[168:171], v[216:219], v[104:107]
v_cvt_pk_bf16_f32 v92, v92, v93
v_cvt_pk_bf16_f32 v93, v94, v95
ds_write_b64 v34, v[92:93] offset:0
s_add_u32 m0, s63, 0x1000
s_nop 0
buffer_load_dwordx4 v21, s[48:51], s76 offen offset:0 lds
buffer_load_dwordx4 v22, s[48:51], s76 offen offset:1024 lds
buffer_load_dwordx4 v23, s[48:51], s76 offen offset:2048 lds
buffer_load_dwordx4 v24, s[48:51], s76 offen offset:3072 lds
v_mfma_f32_16x16x32_bf16 v[108:111], v[168:171], v[220:223], v[108:111]
v_cvt_pk_bf16_f32 v96, v96, v97
v_cvt_pk_bf16_f32 v97, v98, v99
ds_write_b64 v34, v[96:97] offset:8192
v_mfma_f32_16x16x32_bf16 v[112:115], v[168:171], v[224:227], v[112:115]
v_cvt_pk_bf16_f32 v100, v100, v101
v_cvt_pk_bf16_f32 v101, v102, v103
ds_write_b64 v34, v[100:101] offset:16384
v_cvt_pk_bf16_f32 v104, v104, v105
v_cvt_pk_bf16_f32 v105, v106, v107
ds_write_b64 v34, v[104:105] offset:512
v_cvt_pk_bf16_f32 v108, v108, v109
v_cvt_pk_bf16_f32 v109, v110, v111
ds_write_b64 v34, v[108:109] offset:8704
v_cvt_pk_bf16_f32 v112, v112, v113
v_cvt_pk_bf16_f32 v113, v114, v115
ds_write_b64 v34, v[112:113] offset:16896
s_waitcnt vmcnt(8)
ds_read_b128 v[172:175], v29 offset:8192
ds_read_b128 v[176:179], v30 offset:8192
ds_read_b128 v[180:183], v29 offset:10240
s_waitcnt lgkmcnt(3)
s_barrier
ds_read_b128 v[228:231], v35 offset:0
ds_read_b128 v[232:235], v35 offset:8192
ds_read_b128 v[236:239], v35 offset:16384
ds_read_b128 v[204:207], v35 offset:1024
ds_read_b128 v[208:211], v35 offset:9216
ds_read_b128 v[212:215], v35 offset:17408
s_waitcnt lgkmcnt(5)
v_mfma_f32_16x16x32_bf16 v[116:119], v[172:175], v[228:231], 0
s_waitcnt lgkmcnt(4)
v_mfma_f32_16x16x32_bf16 v[132:135], v[172:175], v[232:235], 0
s_waitcnt lgkmcnt(3)
v_mfma_f32_16x16x32_bf16 v[148:151], v[172:175], v[236:239], 0
ds_read_b128 v[184:187], v30 offset:10240
s_waitcnt lgkmcnt(3)
v_mfma_f32_16x16x32_bf16 v[116:119], v[176:179], v[204:207], v[116:119]
s_waitcnt lgkmcnt(2)
v_mfma_f32_16x16x32_bf16 v[132:135], v[176:179], v[208:211], v[132:135]
s_waitcnt lgkmcnt(1)
v_mfma_f32_16x16x32_bf16 v[148:151], v[176:179], v[212:215], v[148:151]
s_waitcnt vmcnt(4)
ds_read_b128 v[188:191], v29 offset:0
v_mfma_f32_16x16x32_bf16 v[120:123], v[180:183], v[228:231], 0
v_mfma_f32_16x16x32_bf16 v[136:139], v[180:183], v[232:235], 0
v_mfma_f32_16x16x32_bf16 v[152:155], v[180:183], v[236:239], 0
ds_read_b128 v[192:195], v30 offset:0
s_waitcnt lgkmcnt(2)
v_mfma_f32_16x16x32_bf16 v[120:123], v[184:187], v[204:207], v[120:123]
s_add_u32 m0, s63, 0x2000
s_nop 0
buffer_load_dwordx4 v21, s[48:51], s77 offen offset:0 lds
buffer_load_dwordx4 v22, s[48:51], s77 offen offset:1024 lds
buffer_load_dwordx4 v23, s[48:51], s77 offen offset:2048 lds
buffer_load_dwordx4 v24, s[48:51], s77 offen offset:3072 lds
v_mfma_f32_16x16x32_bf16 v[136:139], v[184:187], v[208:211], v[136:139]
v_mfma_f32_16x16x32_bf16 v[152:155], v[184:187], v[212:215], v[152:155]
ds_read_b128 v[196:199], v29 offset:2048
s_waitcnt lgkmcnt(2)
v_mfma_f32_16x16x32_bf16 v[124:127], v[188:191], v[228:231], 0
v_mfma_f32_16x16x32_bf16 v[140:143], v[188:191], v[232:235], 0
v_mfma_f32_16x16x32_bf16 v[156:159], v[188:191], v[236:239], 0
ds_read_b128 v[200:203], v30 offset:2048
s_waitcnt lgkmcnt(2)
v_mfma_f32_16x16x32_bf16 v[124:127], v[192:195], v[204:207], v[124:127]
v_mfma_f32_16x16x32_bf16 v[140:143], v[192:195], v[208:211], v[140:143]
v_mfma_f32_16x16x32_bf16 v[156:159], v[192:195], v[212:215], v[156:159]
ds_read_b128 v[216:219], v35 offset:2048
s_waitcnt vmcnt(4)
ds_read_b128 v[164:167], v29 offset:4096
s_waitcnt lgkmcnt(3)
v_mfma_f32_16x16x32_bf16 v[128:131], v[196:199], v[228:231], 0
ds_read_b128 v[220:223], v35 offset:10240
v_mfma_f32_16x16x32_bf16 v[144:147], v[196:199], v[232:235], 0
ds_read_b128 v[224:227], v35 offset:18432
v_mfma_f32_16x16x32_bf16 v[160:163], v[196:199], v[236:239], 0
ds_read_b128 v[228:231], v35 offset:3072
ds_read_b128 v[168:171], v30 offset:4096
s_waitcnt lgkmcnt(6)
v_mfma_f32_16x16x32_bf16 v[128:131], v[200:203], v[204:207], v[128:131]
ds_read_b128 v[232:235], v35 offset:11264
s_add_u32 m0, s63, 0x0
s_nop 0
buffer_load_dwordx4 v21, s[48:51], s78 offen offset:0 lds
buffer_load_dwordx4 v22, s[48:51], s78 offen offset:1024 lds
buffer_load_dwordx4 v23, s[48:51], s78 offen offset:2048 lds
buffer_load_dwordx4 v24, s[48:51], s78 offen offset:3072 lds
v_mfma_f32_16x16x32_bf16 v[144:147], v[200:203], v[208:211], v[144:147]
ds_read_b128 v[236:239], v35 offset:19456
v_mfma_f32_16x16x32_bf16 v[160:163], v[200:203], v[212:215], v[160:163]
ds_read_b128 v[172:175], v29 offset:6144
s_waitcnt lgkmcnt(7)
v_mfma_f32_16x16x32_bf16 v[116:119], v[164:167], v[216:219], v[116:119]
s_waitcnt lgkmcnt(6)
v_mfma_f32_16x16x32_bf16 v[132:135], v[164:167], v[220:223], v[132:135]
s_waitcnt lgkmcnt(5)
v_mfma_f32_16x16x32_bf16 v[148:151], v[164:167], v[224:227], v[148:151]
ds_read_b128 v[176:179], v30 offset:6144
s_waitcnt lgkmcnt(4)
v_mfma_f32_16x16x32_bf16 v[116:119], v[168:171], v[228:231], v[116:119]
s_waitcnt lgkmcnt(3)
v_mfma_f32_16x16x32_bf16 v[132:135], v[168:171], v[232:235], v[132:135]
s_waitcnt lgkmcnt(2)
v_mfma_f32_16x16x32_bf16 v[148:151], v[168:171], v[236:239], v[148:151]
s_waitcnt vmcnt(4)
ds_read_b128 v[180:183], v29 offset:8192
s_waitcnt lgkmcnt(2)
v_mfma_f32_16x16x32_bf16 v[120:123], v[172:175], v[216:219], v[120:123]
v_mfma_f32_16x16x32_bf16 v[136:139], v[172:175], v[220:223], v[136:139]
v_mfma_f32_16x16x32_bf16 v[152:155], v[172:175], v[224:227], v[152:155]
ds_read_b128 v[184:187], v30 offset:8192
s_waitcnt lgkmcnt(2)
v_mfma_f32_16x16x32_bf16 v[120:123], v[176:179], v[228:231], v[120:123]
s_add_u32 m0, s63, 0x1000
s_nop 0
buffer_load_dwordx4 v21, s[48:51], s79 offen offset:0 lds
buffer_load_dwordx4 v22, s[48:51], s79 offen offset:1024 lds
buffer_load_dwordx4 v23, s[48:51], s79 offen offset:2048 lds
buffer_load_dwordx4 v24, s[48:51], s79 offen offset:3072 lds
v_mfma_f32_16x16x32_bf16 v[136:139], v[176:179], v[232:235], v[136:139]
v_mfma_f32_16x16x32_bf16 v[152:155], v[176:179], v[236:239], v[152:155]
ds_read_b128 v[188:191], v29 offset:10240
s_waitcnt lgkmcnt(2)
v_mfma_f32_16x16x32_bf16 v[124:127], v[180:183], v[216:219], v[124:127]
v_mfma_f32_16x16x32_bf16 v[140:143], v[180:183], v[220:223], v[140:143]
v_mfma_f32_16x16x32_bf16 v[156:159], v[180:183], v[224:227], v[156:159]
ds_read_b128 v[192:195], v30 offset:10240
s_waitcnt lgkmcnt(2)
v_mfma_f32_16x16x32_bf16 v[124:127], v[184:187], v[228:231], v[124:127]
v_mfma_f32_16x16x32_bf16 v[140:143], v[184:187], v[232:235], v[140:143]
v_mfma_f32_16x16x32_bf16 v[156:159], v[184:187], v[236:239], v[156:159]
ds_read_b128 v[204:207], v35 offset:4096
s_waitcnt vmcnt(4)
ds_read_b128 v[196:199], v29 offset:0
s_waitcnt lgkmcnt(3)
v_mfma_f32_16x16x32_bf16 v[128:131], v[188:191], v[216:219], v[128:131]
ds_read_b128 v[208:211], v35 offset:12288
v_mfma_f32_16x16x32_bf16 v[144:147], v[188:191], v[220:223], v[144:147]
ds_read_b128 v[212:215], v35 offset:20480
v_mfma_f32_16x16x32_bf16 v[160:163], v[188:191], v[224:227], v[160:163]
ds_read_b128 v[216:219], v35 offset:5120
ds_read_b128 v[200:203], v30 offset:0
s_waitcnt lgkmcnt(6)
v_mfma_f32_16x16x32_bf16 v[128:131], v[192:195], v[228:231], v[128:131]
ds_read_b128 v[220:223], v35 offset:13312
s_add_u32 m0, s63, 0x2000
s_nop 0
buffer_load_dwordx4 v21, s[48:51], s80 offen offset:0 lds
buffer_load_dwordx4 v22, s[48:51], s80 offen offset:1024 lds
buffer_load_dwordx4 v23, s[48:51], s80 offen offset:2048 lds
buffer_load_dwordx4 v24, s[48:51], s80 offen offset:3072 lds
v_mfma_f32_16x16x32_bf16 v[144:147], v[192:195], v[232:235], v[144:147]
ds_read_b128 v[224:227], v35 offset:21504
v_mfma_f32_16x16x32_bf16 v[160:163], v[192:195], v[236:239], v[160:163]
ds_read_b128 v[164:167], v29 offset:2048
s_waitcnt lgkmcnt(7)
v_mfma_f32_16x16x32_bf16 v[116:119], v[196:199], v[204:207], v[116:119]
s_waitcnt lgkmcnt(6)
v_mfma_f32_16x16x32_bf16 v[132:135], v[196:199], v[208:211], v[132:135]
s_waitcnt lgkmcnt(5)
v_mfma_f32_16x16x32_bf16 v[148:151], v[196:199], v[212:215], v[148:151]
ds_read_b128 v[168:171], v30 offset:2048
s_waitcnt lgkmcnt(4)
v_mfma_f32_16x16x32_bf16 v[116:119], v[200:203], v[216:219], v[116:119]
s_waitcnt lgkmcnt(3)
v_mfma_f32_16x16x32_bf16 v[132:135], v[200:203], v[220:223], v[132:135]
s_waitcnt lgkmcnt(2)
v_mfma_f32_16x16x32_bf16 v[148:151], v[200:203], v[224:227], v[148:151]
s_waitcnt vmcnt(4)
ds_read_b128 v[172:175], v29 offset:4096
s_waitcnt lgkmcnt(2)
v_mfma_f32_16x16x32_bf16 v[120:123], v[164:167], v[204:207], v[120:123]
v_mfma_f32_16x16x32_bf16 v[136:139], v[164:167], v[208:211], v[136:139]
v_mfma_f32_16x16x32_bf16 v[152:155], v[164:167], v[212:215], v[152:155]
ds_read_b128 v[176:179], v30 offset:4096
s_waitcnt lgkmcnt(2)
v_mfma_f32_16x16x32_bf16 v[120:123], v[168:171], v[216:219], v[120:123]
s_add_u32 m0, s63, 0x0
s_nop 0
buffer_load_dwordx4 v21, s[48:51], s81 offen offset:0 lds
buffer_load_dwordx4 v22, s[48:51], s81 offen offset:1024 lds
buffer_load_dwordx4 v23, s[48:51], s81 offen offset:2048 lds
buffer_load_dwordx4 v24, s[48:51], s81 offen offset:3072 lds
v_mfma_f32_16x16x32_bf16 v[136:139], v[168:171], v[220:223], v[136:139]
buffer_store_dwordx4 v[44:47], v16, s[56:59], s64 offen offset:0 sc1
buffer_store_dwordx4 v[48:51], v16, s[56:59], s64 offen offset:1024 sc1
v_mfma_f32_16x16x32_bf16 v[152:155], v[168:171], v[224:227], v[152:155]
ds_read_b128 v[180:183], v29 offset:6144
buffer_store_dwordx4 v[52:55], v16, s[56:59], s64 offen offset:2048 sc1
s_waitcnt lgkmcnt(2)
v_mfma_f32_16x16x32_bf16 v[124:127], v[172:175], v[204:207], v[124:127]
buffer_store_dwordx4 v[56:59], v16, s[56:59], s64 offen offset:3072 sc1
buffer_store_dwordx4 v[60:63], v16, s[56:59], s65 offen offset:0 sc1
v_mfma_f32_16x16x32_bf16 v[140:143], v[172:175], v[208:211], v[140:143]
buffer_store_dwordx4 v[64:67], v16, s[56:59], s65 offen offset:1024 sc1
v_mfma_f32_16x16x32_bf16 v[156:159], v[172:175], v[212:215], v[156:159]
ds_read_b128 v[184:187], v30 offset:6144
s_waitcnt lgkmcnt(2)
v_mfma_f32_16x16x32_bf16 v[124:127], v[176:179], v[216:219], v[124:127]
v_mfma_f32_16x16x32_bf16 v[140:143], v[176:179], v[220:223], v[140:143]
v_mfma_f32_16x16x32_bf16 v[156:159], v[176:179], v[224:227], v[156:159]
ds_read_b128 v[228:231], v35 offset:6144
s_waitcnt vmcnt(10)
ds_read_b128 v[188:191], v29 offset:8192
s_waitcnt lgkmcnt(3)
v_mfma_f32_16x16x32_bf16 v[128:131], v[180:183], v[204:207], v[128:131]
ds_read_b128 v[232:235], v35 offset:14336
v_mfma_f32_16x16x32_bf16 v[144:147], v[180:183], v[208:211], v[144:147]
ds_read_b128 v[236:239], v35 offset:22528
v_mfma_f32_16x16x32_bf16 v[160:163], v[180:183], v[212:215], v[160:163]
ds_read_b128 v[204:207], v35 offset:7168
ds_read_b128 v[192:195], v30 offset:8192
s_waitcnt lgkmcnt(6)
v_mfma_f32_16x16x32_bf16 v[128:131], v[184:187], v[216:219], v[128:131]
ds_read_b128 v[208:211], v35 offset:15360
v_mfma_f32_16x16x32_bf16 v[144:147], v[184:187], v[220:223], v[144:147]
ds_read_b128 v[212:215], v35 offset:23552
v_mfma_f32_16x16x32_bf16 v[160:163], v[184:187], v[224:227], v[160:163]
ds_read_b128 v[196:199], v29 offset:10240
s_waitcnt lgkmcnt(7)
v_mfma_f32_16x16x32_bf16 v[116:119], v[188:191], v[228:231], v[116:119]
s_waitcnt lgkmcnt(6)
v_mfma_f32_16x16x32_bf16 v[132:135], v[188:191], v[232:235], v[132:135]
s_waitcnt lgkmcnt(5)
v_mfma_f32_16x16x32_bf16 v[148:151], v[188:191], v[236:239], v[148:151]
ds_read_b128 v[200:203], v30 offset:10240
s_waitcnt lgkmcnt(4)
v_mfma_f32_16x16x32_bf16 v[116:119], v[192:195], v[204:207], v[116:119]
s_waitcnt lgkmcnt(3)
v_mfma_f32_16x16x32_bf16 v[132:135], v[192:195], v[208:211], v[132:135]
s_waitcnt lgkmcnt(2)
v_mfma_f32_16x16x32_bf16 v[148:151], v[192:195], v[212:215], v[148:151]
s_waitcnt vmcnt(6)
ds_read_b128 v[164:167], v29 offset:0
s_waitcnt lgkmcnt(2)
v_mfma_f32_16x16x32_bf16 v[120:123], v[196:199], v[228:231], v[120:123]
v_mfma_f32_16x16x32_bf16 v[136:139], v[196:199], v[232:235], v[136:139]
v_mfma_f32_16x16x32_bf16 v[152:155], v[196:199], v[236:239], v[152:155]
ds_read_b128 v[168:171], v30 offset:0
s_waitcnt lgkmcnt(2)
v_mfma_f32_16x16x32_bf16 v[120:123], v[200:203], v[204:207], v[120:123]
v_mfma_f32_16x16x32_bf16 v[136:139], v[200:203], v[208:211], v[136:139]
v_mfma_f32_16x16x32_bf16 v[152:155], v[200:203], v[212:215], v[152:155]
ds_read_b128 v[172:175], v29 offset:2048
s_waitcnt lgkmcnt(2)
v_mfma_f32_16x16x32_bf16 v[124:127], v[164:167], v[228:231], v[124:127]
v_mul_f32 v116, s86, v116
v_mul_f32 v117, s86, v117
v_mul_f32 v118, s86, v118
v_mul_f32 v119, s86, v119
v_mul_f32 v120, s86, v120
v_mul_f32 v121, s86, v121
v_mul_f32 v122, s86, v122
v_mul_f32 v123, s86, v123
v_cvt_pk_bf16_f32 v116, v116, v117
v_cvt_pk_bf16_f32 v117, v118, v119
v_cvt_pk_bf16_f32 v118, v120, v121
v_cvt_pk_bf16_f32 v119, v122, v123
buffer_store_dwordx4 v[116:119], v16, s[52:55], s82 offen offset:0 sc1
v_mfma_f32_16x16x32_bf16 v[140:143], v[164:167], v[232:235], v[140:143]
v_mul_f32 v132, s86, v132
v_mul_f32 v133, s86, v133
v_mul_f32 v134, s86, v134
v_mul_f32 v135, s86, v135
v_mul_f32 v136, s86, v136
v_mul_f32 v137, s86, v137
v_mul_f32 v138, s86, v138
v_mul_f32 v139, s86, v139
v_cvt_pk_bf16_f32 v132, v132, v133
v_cvt_pk_bf16_f32 v133, v134, v135
v_cvt_pk_bf16_f32 v134, v136, v137
v_cvt_pk_bf16_f32 v135, v138, v139
buffer_store_dwordx4 v[132:135], v16, s[52:55], s83 offen offset:0 sc1
v_mfma_f32_16x16x32_bf16 v[156:159], v[164:167], v[236:239], v[156:159]
ds_read_b128 v[176:179], v30 offset:2048
v_mul_f32 v148, s86, v148
v_mul_f32 v149, s86, v149
v_mul_f32 v150, s86, v150
v_mul_f32 v151, s86, v151
v_mul_f32 v152, s86, v152
v_mul_f32 v153, s86, v153
v_mul_f32 v154, s86, v154
v_mul_f32 v155, s86, v155
v_cvt_pk_bf16_f32 v148, v148, v149
v_cvt_pk_bf16_f32 v149, v150, v151
v_cvt_pk_bf16_f32 v150, v152, v153
v_cvt_pk_bf16_f32 v151, v154, v155
buffer_store_dwordx4 v[148:151], v16, s[52:55], s84 offen offset:0 sc1
s_waitcnt lgkmcnt(2)
v_mfma_f32_16x16x32_bf16 v[124:127], v[168:171], v[204:207], v[124:127]
v_mfma_f32_16x16x32_bf16 v[140:143], v[168:171], v[208:211], v[140:143]
v_mfma_f32_16x16x32_bf16 v[156:159], v[168:171], v[212:215], v[156:159]
s_waitcnt lgkmcnt(1)
v_mfma_f32_16x16x32_bf16 v[128:131], v[172:175], v[228:231], v[128:131]
v_mfma_f32_16x16x32_bf16 v[144:147], v[172:175], v[232:235], v[144:147]
v_mfma_f32_16x16x32_bf16 v[160:163], v[172:175], v[236:239], v[160:163]
s_waitcnt lgkmcnt(0)
v_mfma_f32_16x16x32_bf16 v[128:131], v[176:179], v[204:207], v[128:131]
v_mfma_f32_16x16x32_bf16 v[144:147], v[176:179], v[208:211], v[144:147]
v_mfma_f32_16x16x32_bf16 v[160:163], v[176:179], v[212:215], v[160:163]
v_mul_f32 v124, s86, v124
v_mul_f32 v125, s86, v125
v_mul_f32 v126, s86, v126
v_mul_f32 v127, s86, v127
s_nop 1
v_mul_f32 v128, s86, v128
v_mul_f32 v129, s86, v129
v_mul_f32 v130, s86, v130
v_mul_f32 v131, s86, v131
v_cvt_pk_bf16_f32 v124, v124, v125
v_cvt_pk_bf16_f32 v125, v126, v127
v_cvt_pk_bf16_f32 v126, v128, v129
v_cvt_pk_bf16_f32 v127, v130, v131
buffer_store_dwordx4 v[124:127], v16, s[52:55], s82 offen offset:1024 sc1
v_mul_f32 v140, s86, v140
v_mul_f32 v141, s86, v141
v_mul_f32 v142, s86, v142
v_mul_f32 v143, s86, v143
v_mul_f32 v144, s86, v144
v_mul_f32 v145, s86, v145
v_mul_f32 v146, s86, v146
v_mul_f32 v147, s86, v147
v_cvt_pk_bf16_f32 v140, v140, v141
v_cvt_pk_bf16_f32 v141, v142, v143
v_cvt_pk_bf16_f32 v142, v144, v145
v_cvt_pk_bf16_f32 v143, v146, v147
buffer_store_dwordx4 v[140:143], v16, s[52:55], s83 offen offset:1024 sc1
v_mul_f32 v156, s86, v156
v_mul_f32 v157, s86, v157
v_mul_f32 v158, s86, v158
v_mul_f32 v159, s86, v159
v_mul_f32 v160, s86, v160
v_mul_f32 v161, s86, v161
v_mul_f32 v162, s86, v162
v_mul_f32 v163, s86, v163
v_cvt_pk_bf16_f32 v156, v156, v157
v_cvt_pk_bf16_f32 v157, v158, v159
v_cvt_pk_bf16_f32 v158, v160, v161
v_cvt_pk_bf16_f32 v159, v162, v163
buffer_store_dwordx4 v[156:159], v16, s[52:55], s84 offen offset:1024 sc1
L1_fin:
s_add_u32 s91, s91, 1344
s_waitcnt lgkmcnt(0)
s_add_u32 s98, s98, 0x7f4a7c15
s_addc_u32 s99, s99, 0x9e3779b9
LM_pub:
s_add_u32 s40, s38, 0x7c00000
s_addc_u32 s41, s39, 0
s_mov_b32 s42, 0x40000
s_mov_b32 s43, 0x00020000
s_lshl_b32 s6, s91, 7
s_cmp_eq_u32 s60, 0
s_cselect_b32 s6, s6, 0x70000000
s_waitcnt vmcnt(0) lgkmcnt(0)
s_barrier
v_mov_b32 v6, s98
v_mov_b32 v7, s99
s_mov_b64 exec, 1
buffer_store_dwordx2 v[6:7], off, s[40:43], s6 sc1
s_mov_b64 exec, -1
s_cmp_eq_u32 s61, 0
s_cbranch_scc1 L2_entry
s_mov_b32 s61, 0
s_sub_u32 s4, s91, 1578
s_min_u32 s6, s4, 14
s_cmp_lt_u32 s4, 6
s_cselect_b32 s6, 0, s6
s_sub_u32 s4, s4, s6
s_add_u32 s91, s4, 1600
v_lshlrev_b32 v16, 4, v2
s_mul_i32 s63, s60, 12288
s_and_b32 s6, s4, 3
s_lshl_b32 s6, s6, 6
s_mul_i32 s7, s60, 16
s_add_u32 s6, s6, s7
v_lshrrev_b32 v5, 5, v2
v_and_b32 v6, 31, v2
v_lshlrev_b32 v6, 4, v6
s_cmp_ge_u32 s4, 4
s_cselect_b64 vcc, -1, 0
v_add3_u32 v7, v5, s6, 0
v_and_b32 v8, 0x80, v7
v_bfe_u32 v9, v7, 2, 1
v_lshl_or_b32 v8, v9, 6, v8
v_bfe_u32 v9, v7, 4, 1
v_lshl_or_b32 v8, v9, 5, v8
v_and_b32 v9, 3, v7
v_lshl_or_b32 v8, v9, 3, v8
v_bfe_u32 v9, v7, 5, 2
v_lshl_or_b32 v8, v9, 1, v8
v_bfe_u32 v9, v7, 3, 1
v_or_b32 v8, v9, v8
v_cndmask_b32 v8, v8, v7, vcc
v_lshl_add_u32 v44, v8, 9, v6
v_add3_u32 v7, v5, s6, 2
v_and_b32 v8, 0x80, v7
v_bfe_u32 v9, v7, 2, 1
v_lshl_or_b32 v8, v9, 6, v8
v_bfe_u32 v9, v7, 4, 1
v_lshl_or_b32 v8, v9, 5, v8
v_and_b32 v9, 3, v7
v_lshl_or_b32 v8, v9, 3, v8
v_bfe_u32 v9, v7, 5, 2
v_lshl_or_b32 v8, v9, 1, v8
v_bfe_u32 v9, v7, 3, 1
v_or_b32 v8, v9, v8
v_cndmask_b32 v8, v8, v7, vcc
v_lshl_add_u32 v48, v8, 9, v6
v_add3_u32 v7, v5, s6, 4
v_and_b32 v8, 0x80, v7
v_bfe_u32 v9, v7, 2, 1
v_lshl_or_b32 v8, v9, 6, v8
v_bfe_u32 v9, v7, 4, 1
v_lshl_or_b32 v8, v9, 5, v8
v_and_b32 v9, 3, v7
v_lshl_or_b32 v8, v9, 3, v8
v_bfe_u32 v9, v7, 5, 2
v_lshl_or_b32 v8, v9, 1, v8
v_bfe_u32 v9, v7, 3, 1
v_or_b32 v8, v9, v8
v_cndmask_b32 v8, v8, v7, vcc
v_lshl_add_u32 v52, v8, 9, v6
v_add3_u32 v7, v5, s6, 6
v_and_b32 v8, 0x80, v7
v_bfe_u32 v9, v7, 2, 1
v_lshl_or_b32 v8, v9, 6, v8
v_bfe_u32 v9, v7, 4, 1
v_lshl_or_b32 v8, v9, 5, v8
v_and_b32 v9, 3, v7
v_lshl_or_b32 v8, v9, 3, v8
v_bfe_u32 v9, v7, 5, 2
v_lshl_or_b32 v8, v9, 1, v8
v_bfe_u32 v9, v7, 3, 1
v_or_b32 v8, v9, v8
v_cndmask_b32 v8, v8, v7, vcc
v_lshl_add_u32 v56, v8, 9, v6
v_add3_u32 v7, v5, s6, 8
v_and_b32 v8, 0x80, v7
v_bfe_u32 v9, v7, 2, 1
v_lshl_or_b32 v8, v9, 6, v8
v_bfe_u32 v9, v7, 4, 1
v_lshl_or_b32 v8, v9, 5, v8
v_and_b32 v9, 3, v7
v_lshl_or_b32 v8, v9, 3, v8
v_bfe_u32 v9, v7, 5, 2
v_lshl_or_b32 v8, v9, 1, v8
v_bfe_u32 v9, v7, 3, 1
v_or_b32 v8, v9, v8
v_cndmask_b32 v8, v8, v7, vcc
v_lshl_add_u32 v60, v8, 9, v6
v_add3_u32 v7, v5, s6, 10
v_and_b32 v8, 0x80, v7
v_bfe_u32 v9, v7, 2, 1
v_lshl_or_b32 v8, v9, 6, v8
v_bfe_u32 v9, v7, 4, 1
v_lshl_or_b32 v8, v9, 5, v8
v_and_b32 v9, 3, v7
v_lshl_or_b32 v8, v9, 3, v8
v_bfe_u32 v9, v7, 5, 2
v_lshl_or_b32 v8, v9, 1, v8
v_bfe_u32 v9, v7, 3, 1
v_or_b32 v8, v9, v8
v_cndmask_b32 v8, v8, v7, vcc
v_lshl_add_u32 v64, v8, 9, v6
v_add3_u32 v7, v5, s6, 12
v_and_b32 v8, 0x80, v7
v_bfe_u32 v9, v7, 2, 1
v_lshl_or_b32 v8, v9, 6, v8
v_bfe_u32 v9, v7, 4, 1
v_lshl_or_b32 v8, v9, 5, v8
v_and_b32 v9, 3, v7
v_lshl_or_b32 v8, v9, 3, v8
v_bfe_u32 v9, v7, 5, 2
v_lshl_or_b32 v8, v9, 1, v8
v_bfe_u32 v9, v7, 3, 1
v_or_b32 v8, v9, v8
v_cndmask_b32 v8, v8, v7, vcc
v_lshl_add_u32 v68, v8, 9, v6
v_add3_u32 v7, v5, s6, 14
v_and_b32 v8, 0x80, v7
v_bfe_u32 v9, v7, 2, 1
v_lshl_or_b32 v8, v9, 6, v8
v_bfe_u32 v9, v7, 4, 1
v_lshl_or_b32 v8, v9, 5, v8
v_and_b32 v9, 3, v7
v_lshl_or_b32 v8, v9, 3, v8
v_bfe_u32 v9, v7, 5, 2
v_lshl_or_b32 v8, v9, 1, v8
v_bfe_u32 v9, v7, 3, 1
v_or_b32 v8, v9, v8
v_cndmask_b32 v8, v8, v7, vcc
v_lshl_add_u32 v72, v8, 9, v6
s_lshl_b32 s7, s60, 7
v_lshrrev_b32 v5, 3, v2
v_and_b32 v6, 7, v2
v_and_b32 v7, 2, v5
v_xor_b32 v6, v6, v7
v_lshl_add_u32 v5, v5, 9, s7
v_lshl_add_u32 v17, v6, 4, v5
v_xor_b32 v6, 4, v6
v_lshl_add_u32 v18, v6, 4, v5
v_add_u32 v18, 0xc00, v18
v_add_u32 v19, 0x1800, v17
v_add_u32 v20, 0x1800, v18
s_xor_b32 s6, s62, 0
s_lshl_b32 s66, s6, 14
s_xor_b32 s6, s62, 1
s_lshl_b32 s67, s6, 14
s_xor_b32 s6, s62, 2
s_lshl_b32 s68, s6, 14
s_xor_b32 s6, s62, 3
s_lshl_b32 s69, s6, 14
s_xor_b32 s6, s62, 4
s_lshl_b32 s70, s6, 14
s_xor_b32 s6, s62, 5
s_lshl_b32 s71, s6, 14
s_xor_b32 s6, s62, 6
s_lshl_b32 s72, s6, 14
s_xor_b32 s6, s62, 7
s_lshl_b32 s73, s6, 14
s_waitcnt lgkmcnt(0)
s_cmp_ge_u32 s4, 4
s_cselect_b32 s6, s30, s24
s_cselect_b32 s7, s31, s25
s_add_u32 s40, s6, 0x0
s_addc_u32 s41, s7, 0
s_mov_b32 s42, 0x20000
s_mov_b32 s43, 0x00020000
s_add_u32 s44, s32, 0x0
s_addc_u32 s45, s33, 0
s_mov_b32 s46, 0x20000
s_mov_b32 s47, 0x00020000
buffer_load_dwordx4 v[44:47], v44, s[40:43], 0 offen
buffer_load_dwordx4 v[48:51], v48, s[40:43], 0 offen
buffer_load_dwordx4 v[52:55], v52, s[40:43], 0 offen
buffer_load_dwordx4 v[56:59], v56, s[40:43], 0 offen
buffer_load_dwordx4 v[60:63], v60, s[40:43], 0 offen
buffer_load_dwordx4 v[64:67], v64, s[40:43], 0 offen
buffer_load_dwordx4 v[68:71], v68, s[40:43], 0 offen
buffer_load_dwordx4 v[72:75], v72, s[40:43], 0 offen
s_add_u32 m0, s63, 0x0
s_nop 0
buffer_load_dwordx4 v17, s[44:47], s66 offen offset:0 lds
buffer_load_dwordx4 v18, s[44:47], s66 offen offset:1024 lds
buffer_load_dwordx4 v19, s[44:47], s66 offen offset:2048 lds
buffer_load_dwordx4 v20, s[44:47], s66 offen offset:3072 lds
s_add_u32 m0, s63, 0x1000
s_nop 0
buffer_load_dwordx4 v17, s[44:47], s67 offen offset:0 lds
buffer_load_dwordx4 v18, s[44:47], s67 offen offset:1024 lds
buffer_load_dwordx4 v19, s[44:47], s67 offen offset:2048 lds
buffer_load_dwordx4 v20, s[44:47], s67 offen offset:3072 lds
v_bfe_u32 v5, v2, 2, 3
v_xor_b32 v5, s62, v5
v_and_b32 v6, 3, v2
v_lshlrev_b32 v7, 10, v5
v_lshl_add_u32 v7, v6, 8, v7
v_add_u32 v7, 0xc000, v7
v_and_b32 v5, 1, v5
v_lshl_or_b32 v6, v5, 2, v6
v_lshrrev_b32 v5, 5, v2
s_mul_i32 s6, s60, 16
v_add3_u32 v8, v5, s6, 0
v_lshrrev_b32 v9, 4, v8
v_lshl_add_u32 v9, v9, 13, v7
v_and_b32 v8, 15, v8
v_xor_b32 v8, v8, v6
v_lshl_add_u32 v36, v8, 4, v9
v_add3_u32 v8, v5, s6, 2
v_lshrrev_b32 v9, 4, v8
v_lshl_add_u32 v9, v9, 13, v7
v_and_b32 v8, 15, v8
v_xor_b32 v8, v8, v6
v_lshl_add_u32 v37, v8, 4, v9
v_add3_u32 v8, v5, s6, 4
v_lshrrev_b32 v9, 4, v8
v_lshl_add_u32 v9, v9, 13, v7
v_and_b32 v8, 15, v8
v_xor_b32 v8, v8, v6
v_lshl_add_u32 v38, v8, 4, v9
v_add3_u32 v8, v5, s6, 6
v_lshrrev_b32 v9, 4, v8
v_lshl_add_u32 v9, v9, 13, v7
v_and_b32 v8, 15, v8
v_xor_b32 v8, v8, v6
v_lshl_add_u32 v39, v8, 4, v9
v_add3_u32 v8, v5, s6, 8
v_lshrrev_b32 v9, 4, v8
v_lshl_add_u32 v9, v9, 13, v7
v_and_b32 v8, 15, v8
v_xor_b32 v8, v8, v6
v_lshl_add_u32 v40, v8, 4, v9
v_add3_u32 v8, v5, s6, 10
v_lshrrev_b32 v9, 4, v8
v_lshl_add_u32 v9, v9, 13, v7
v_and_b32 v8, 15, v8
v_xor_b32 v8, v8, v6
v_lshl_add_u32 v41, v8, 4, v9
v_add3_u32 v8, v5, s6, 12
v_lshrrev_b32 v9, 4, v8
v_lshl_add_u32 v9, v9, 13, v7
v_and_b32 v8, 15, v8
v_xor_b32 v8, v8, v6
v_lshl_add_u32 v42, v8, 4, v9
v_add3_u32 v8, v5, s6, 14
v_lshrrev_b32 v9, 4, v8
v_lshl_add_u32 v9, v9, 13, v7
v_and_b32 v8, 15, v8
v_xor_b32 v8, v8, v6
v_lshl_add_u32 v43, v8, 4, v9
v_xor_b32 v5, v3, v4
v_lshlrev_b32 v5, 4, v5
v_lshl_add_u32 v5, v4, 8, v5
v_add_u32 v31, 0xc000, v5
v_xor_b32 v32, 64, v31
v_lshrrev_b32 v5, 2, v3
v_and_b32 v6, 3, v3
v_and_b32 v7, 1, v4
v_lshlrev_b32 v7, 2, v7
v_and_b32 v8, 2, v5
v_or_b32 v7, v7, v8
v_lshl_add_u32 v8, v4, 3, v5
v_lshlrev_b32 v8, 7, v8
v_add_u32 v8, s63, v8
v_xor_b32 v6, v6, v7
v_xor_b32 v9, 0, v6
v_lshl_add_u32 v25, v9, 4, v8
v_add_u32 v26, 8, v25
v_xor_b32 v9, 4, v6
v_lshl_add_u32 v27, v9, 4, v8
v_add_u32 v28, 8, v27
s_lshr_b32 s6, s4, 2
s_lshl_b32 s6, s6, 17
s_and_b32 s7, s4, 3
s_lshl_b32 s7, s7, 12
s_add_u32 s6, s6, s7
s_mul_i32 s7, s60, 32768
s_add_u32 s82, s6, s7
s_add_u32 s83, s82, 16384
s_add_u32 s52, s38, 0x1000000
s_addc_u32 s53, s39, 0
s_mov_b32 s54, 0x40000
s_mov_b32 s55, 0x00020000
s_waitcnt vmcnt(15)
ds_write_b128 v36, v[44:47]
s_waitcnt vmcnt(14)
ds_write_b128 v37, v[48:51]
s_waitcnt vmcnt(13)
ds_write_b128 v38, v[52:55]
s_waitcnt vmcnt(12)
ds_write_b128 v39, v[56:59]
s_waitcnt vmcnt(11)
ds_write_b128 v40, v[60:63]
s_waitcnt vmcnt(10)
ds_write_b128 v41, v[64:67]
s_waitcnt vmcnt(9)
ds_write_b128 v42, v[68:71]
s_waitcnt vmcnt(8)
ds_write_b128 v43, v[72:75]
s_add_u32 m0, s63, 0x2000
s_nop 0
buffer_load_dwordx4 v17, s[44:47], s68 offen offset:0 lds
buffer_load_dwordx4 v18, s[44:47], s68 offen offset:1024 lds
buffer_load_dwordx4 v19, s[44:47], s68 offen offset:2048 lds
buffer_load_dwordx4 v20, s[44:47], s68 offen offset:3072 lds
s_waitcnt vmcnt(8)
ds_read_b64_tr_b16 v[140:141], v25 offset:0
ds_read_b64_tr_b16 v[142:143], v25 offset:512
ds_read_b64_tr_b16 v[144:145], v26 offset:0
ds_read_b64_tr_b16 v[146:147], v26 offset:512
ds_read_b64_tr_b16 v[148:149], v27 offset:0
ds_read_b64_tr_b16 v[150:151], v27 offset:512
s_waitcnt lgkmcnt(6)
s_barrier
ds_read_b128 v[180:183], v31 offset:0
ds_read_b128 v[184:187], v31 offset:8192
ds_read_b128 v[188:191], v31 offset:16384
ds_read_b128 v[192:195], v31 offset:24576
s_waitcnt lgkmcnt(3)
v_mfma_f32_16x16x32_bf16 v[76:79], v[180:183], v[140:143], 0
s_waitcnt lgkmcnt(2)
v_mfma_f32_16x16x32_bf16 v[80:83], v[184:187], v[140:143], 0
s_waitcnt lgkmcnt(1)
v_mfma_f32_16x16x32_bf16 v[84:87], v[188:191], v[140:143], 0
s_waitcnt lgkmcnt(0)
v_mfma_f32_16x16x32_bf16 v[88:91], v[192:195], v[140:143], 0
ds_read_b64_tr_b16 v[152:153], v28 offset:0
ds_read_b64_tr_b16 v[154:155], v28 offset:512
v_mfma_f32_16x16x32_bf16 v[92:95], v[180:183], v[144:147], 0
v_mfma_f32_16x16x32_bf16 v[96:99], v[184:187], v[144:147], 0
v_mfma_f32_16x16x32_bf16 v[100:103], v[188:191], v[144:147], 0
v_mfma_f32_16x16x32_bf16 v[104:107], v[192:195], v[144:147], 0
ds_read_b128 v[196:199], v32 offset:1024
s_waitcnt vmcnt(4)
ds_read_b64_tr_b16 v[156:157], v25 offset:4096
ds_read_b64_tr_b16 v[158:159], v25 offset:4608
v_mfma_f32_16x16x32_bf16 v[108:111], v[180:183], v[148:151], 0
ds_read_b128 v[200:203], v32 offset:9216
v_mfma_f32_16x16x32_bf16 v[112:115], v[184:187], v[148:151], 0
ds_read_b128 v[204:207], v32 offset:17408
v_mfma_f32_16x16x32_bf16 v[116:119], v[188:191], v[148:151], 0
ds_read_b128 v[208:211], v32 offset:25600
v_mfma_f32_16x16x32_bf16 v[120:123], v[192:195], v[148:151], 0
ds_read_b64_tr_b16 v[160:161], v26 offset:4096
ds_read_b64_tr_b16 v[162:163], v26 offset:4608
s_waitcnt lgkmcnt(8)
v_mfma_f32_16x16x32_bf16 v[124:127], v[180:183], v[152:155], 0
s_add_u32 m0, s63, 0x0
s_nop 0
buffer_load_dwordx4 v17, s[44:47], s69 offen offset:0 lds
buffer_load_dwordx4 v18, s[44:47], s69 offen offset:1024 lds
buffer_load_dwordx4 v19, s[44:47], s69 offen offset:2048 lds
buffer_load_dwordx4 v20, s[44:47], s69 offen offset:3072 lds
v_mfma_f32_16x16x32_bf16 v[128:131], v[184:187], v[152:155], 0
v_mfma_f32_16x16x32_bf16 v[132:135], v[188:191], v[152:155], 0
v_mfma_f32_16x16x32_bf16 v[136:139], v[192:195], v[152:155], 0
ds_read_b64_tr_b16 v[164:165], v27 offset:4096
ds_read_b64_tr_b16 v[166:167], v27 offset:4608
s_waitcnt lgkmcnt(7)
v_mfma_f32_16x16x32_bf16 v[76:79], v[196:199], v[156:159], v[76:79]
s_waitcnt lgkmcnt(6)
v_mfma_f32_16x16x32_bf16 v[80:83], v[200:203], v[156:159], v[80:83]
s_waitcnt lgkmcnt(5)
v_mfma_f32_16x16x32_bf16 v[84:87], v[204:207], v[156:159], v[84:87]
s_waitcnt lgkmcnt(4)
v_mfma_f32_16x16x32_bf16 v[88:91], v[208:211], v[156:159], v[88:91]
ds_read_b64_tr_b16 v[168:169], v28 offset:4096
ds_read_b64_tr_b16 v[170:171], v28 offset:4608
s_waitcnt lgkmcnt(4)
v_mfma_f32_16x16x32_bf16 v[92:95], v[196:199], v[160:163], v[92:95]
v_mfma_f32_16x16x32_bf16 v[96:99], v[200:203], v[160:163], v[96:99]
v_mfma_f32_16x16x32_bf16 v[100:103], v[204:207], v[160:163], v[100:103]
v_mfma_f32_16x16x32_bf16 v[104:107], v[208:211], v[160:163], v[104:107]
ds_read_b128 v[212:215], v31 offset:2048
s_waitcnt vmcnt(4)
ds_read_b64_tr_b16 v[172:173], v25 offset:8192
ds_read_b64_tr_b16 v[174:175], v25 offset:8704
s_waitcnt lgkmcnt(5)
v_mfma_f32_16x16x32_bf16 v[108:111], v[196:199], v[164:167], v[108:111]
ds_read_b128 v[216:219], v31 offset:10240
v_mfma_f32_16x16x32_bf16 v[112:115], v[200:203], v[164:167], v[112:115]
ds_read_b128 v[220:223], v31 offset:18432
v_mfma_f32_16x16x32_bf16 v[116:119], v[204:207], v[164:167], v[116:119]
ds_read_b128 v[224:227], v31 offset:26624
v_mfma_f32_16x16x32_bf16 v[120:123], v[208:211], v[164:167], v[120:123]
ds_read_b64_tr_b16 v[176:177], v26 offset:8192
ds_read_b64_tr_b16 v[178:179], v26 offset:8704
s_waitcnt lgkmcnt(8)
v_mfma_f32_16x16x32_bf16 v[124:127], v[196:199], v[168:171], v[124:127]
s_add_u32 m0, s63, 0x1000
s_nop 0
buffer_load_dwordx4 v17, s[44:47], s70 offen offset:0 lds
buffer_load_dwordx4 v18, s[44:47], s70 offen offset:1024 lds
buffer_load_dwordx4 v19, s[44:47], s70 offen offset:2048 lds
buffer_load_dwordx4 v20, s[44:47], s70 offen offset:3072 lds
v_mfma_f32_16x16x32_bf16 v[128:131], v[200:203], v[168:171], v[128:131]
v_mfma_f32_16x16x32_bf16 v[132:135], v[204:207], v[168:171], v[132:135]
v_mfma_f32_16x16x32_bf16 v[136:139], v[208:211], v[168:171], v[136:139]
ds_read_b64_tr_b16 v[140:141], v27 offset:8192
ds_read_b64_tr_b16 v[142:143], v27 offset:8704
s_waitcnt lgkmcnt(7)
v_mfma_f32_16x16x32_bf16 v[76:79], v[212:215], v[172:175], v[76:79]
s_waitcnt lgkmcnt(6)
v_mfma_f32_16x16x32_bf16 v[80:83], v[216:219], v[172:175], v[80:83]
s_waitcnt lgkmcnt(5)
v_mfma_f32_16x16x32_bf16 v[84:87], v[220:223], v[172:175], v[84:87]
s_waitcnt lgkmcnt(4)
v_mfma_f32_16x16x32_bf16 v[88:91], v[224:227], v[172:175], v[88:91]
ds_read_b64_tr_b16 v[144:145], v28 offset:8192
ds_read_b64_tr_b16 v[146:147], v28 offset:8704
s_waitcnt lgkmcnt(4)
v_mfma_f32_16x16x32_bf16 v[92:95], v[212:215], v[176:179], v[92:95]
v_mfma_f32_16x16x32_bf16 v[96:99], v[216:219], v[176:179], v[96:99]
v_mfma_f32_16x16x32_bf16 v[100:103], v[220:223], v[176:179], v[100:103]
v_mfma_f32_16x16x32_bf16 v[104:107], v[224:227], v[176:179], v[104:107]
ds_read_b128 v[180:183], v32 offset:3072
s_waitcnt vmcnt(4)
ds_read_b64_tr_b16 v[148:149], v25 offset:0
ds_read_b64_tr_b16 v[150:151], v25 offset:512
s_waitcnt lgkmcnt(5)
v_mfma_f32_16x16x32_bf16 v[108:111], v[212:215], v[140:143], v[108:111]
ds_read_b128 v[184:187], v32 offset:11264
v_mfma_f32_16x16x32_bf16 v[112:115], v[216:219], v[140:143], v[112:115]
ds_read_b128 v[188:191], v32 offset:19456
v_mfma_f32_16x16x32_bf16 v[116:119], v[220:223], v[140:143], v[116:119]
ds_read_b128 v[192:195], v32 offset:27648
v_mfma_f32_16x16x32_bf16 v[120:123], v[224:227], v[140:143], v[120:123]
ds_read_b64_tr_b16 v[152:153], v26 offset:0
ds_read_b64_tr_b16 v[154:155], v26 offset:512
s_waitcnt lgkmcnt(8)
v_mfma_f32_16x16x32_bf16 v[124:127], v[212:215], v[144:147], v[124:127]
s_add_u32 m0, s63, 0x2000
s_nop 0
buffer_load_dwordx4 v17, s[44:47], s71 offen offset:0 lds
buffer_load_dwordx4 v18, s[44:47], s71 offen offset:1024 lds
buffer_load_dwordx4 v19, s[44:47], s71 offen offset:2048 lds
buffer_load_dwordx4 v20, s[44:47], s71 offen offset:3072 lds
v_mfma_f32_16x16x32_bf16 v[128:131], v[216:219], v[144:147], v[128:131]
v_mfma_f32_16x16x32_bf16 v[132:135], v[220:223], v[144:147], v[132:135]
v_mfma_f32_16x16x32_bf16 v[136:139], v[224:227], v[144:147], v[136:139]
ds_read_b64_tr_b16 v[156:157], v27 offset:0
ds_read_b64_tr_b16 v[158:159], v27 offset:512
s_waitcnt lgkmcnt(7)
v_mfma_f32_16x16x32_bf16 v[76:79], v[180:183], v[148:151], v[76:79]
s_waitcnt lgkmcnt(6)
v_mfma_f32_16x16x32_bf16 v[80:83], v[184:187], v[148:151], v[80:83]
s_waitcnt lgkmcnt(5)
v_mfma_f32_16x16x32_bf16 v[84:87], v[188:191], v[148:151], v[84:87]
s_waitcnt lgkmcnt(4)
v_mfma_f32_16x16x32_bf16 v[88:91], v[192:195], v[148:151], v[88:91]
ds_read_b64_tr_b16 v[160:161], v28 offset:0
ds_read_b64_tr_b16 v[162:163], v28 offset:512
s_waitcnt lgkmcnt(4)
v_mfma_f32_16x16x32_bf16 v[92:95], v[180:183], v[152:155], v[92:95]
v_mfma_f32_16x16x32_bf16 v[96:99], v[184:187], v[152:155], v[96:99]
v_mfma_f32_16x16x32_bf16 v[100:103], v[188:191], v[152:155], v[100:103]
v_mfma_f32_16x16x32_bf16 v[104:107], v[192:195], v[152:155], v[104:107]
ds_read_b128 v[196:199], v31 offset:4096
s_waitcnt vmcnt(4)
ds_read_b64_tr_b16 v[164:165], v25 offset:4096
ds_read_b64_tr_b16 v[166:167], v25 offset:4608
s_waitcnt lgkmcnt(5)
v_mfma_f32_16x16x32_bf16 v[108:111], v[180:183], v[156:159], v[108:111]
ds_read_b128 v[200:203], v31 offset:12288
v_mfma_f32_16x16x32_bf16 v[112:115], v[184:187], v[156:159], v[112:115]
ds_read_b128 v[204:207], v31 offset:20480
v_mfma_f32_16x16x32_bf16 v[116:119], v[188:191], v[156:159], v[116:119]
ds_read_b128 v[208:211], v31 offset:28672
v_mfma_f32_16x16x32_bf16 v[120:123], v[192:195], v[156:159], v[120:123]
ds_read_b64_tr_b16 v[168:169], v26 offset:4096
ds_read_b64_tr_b16 v[170:171], v26 offset:4608
s_waitcnt lgkmcnt(8)
v_mfma_f32_16x16x32_bf16 v[124:127], v[180:183], v[160:163], v[124:127]
s_add_u32 m0, s63, 0x0
s_nop 0
buffer_load_dwordx4 v17, s[44:47], s72 offen offset:0 lds
buffer_load_dwordx4 v18, s[44:47], s72 offen offset:1024 lds
buffer_load_dwordx4 v19, s[44:47], s72 offen offset:2048 lds
buffer_load_dwordx4 v20, s[44:47], s72 offen offset:3072 lds
v_mfma_f32_16x16x32_bf16 v[128:131], v[184:187], v[160:163], v[128:131]
v_mfma_f32_16x16x32_bf16 v[132:135], v[188:191], v[160:163], v[132:135]
v_mfma_f32_16x16x32_bf16 v[136:139], v[192:195], v[160:163], v[136:139]
ds_read_b64_tr_b16 v[172:173], v27 offset:4096
ds_read_b64_tr_b16 v[174:175], v27 offset:4608
s_waitcnt lgkmcnt(7)
v_mfma_f32_16x16x32_bf16 v[76:79], v[196:199], v[164:167], v[76:79]
s_waitcnt lgkmcnt(6)
v_mfma_f32_16x16x32_bf16 v[80:83], v[200:203], v[164:167], v[80:83]
s_waitcnt lgkmcnt(5)
v_mfma_f32_16x16x32_bf16 v[84:87], v[204:207], v[164:167], v[84:87]
s_waitcnt lgkmcnt(4)
v_mfma_f32_16x16x32_bf16 v[88:91], v[208:211], v[164:167], v[88:91]
ds_read_b64_tr_b16 v[176:177], v28 offset:4096
ds_read_b64_tr_b16 v[178:179], v28 offset:4608
s_waitcnt lgkmcnt(4)
v_mfma_f32_16x16x32_bf16 v[92:95], v[196:199], v[168:171], v[92:95]
v_mfma_f32_16x16x32_bf16 v[96:99], v[200:203], v[168:171], v[96:99]
v_mfma_f32_16x16x32_bf16 v[100:103], v[204:207], v[168:171], v[100:103]
v_mfma_f32_16x16x32_bf16 v[104:107], v[208:211], v[168:171], v[104:107]
ds_read_b128 v[212:215], v32 offset:5120
s_waitcnt vmcnt(4)
ds_read_b64_tr_b16 v[140:141], v25 offset:8192
ds_read_b64_tr_b16 v[142:143], v25 offset:8704
s_waitcnt lgkmcnt(5)
v_mfma_f32_16x16x32_bf16 v[108:111], v[196:199], v[172:175], v[108:111]
ds_read_b128 v[216:219], v32 offset:13312
v_mfma_f32_16x16x32_bf16 v[112:115], v[200:203], v[172:175], v[112:115]
ds_read_b128 v[220:223], v32 offset:21504
v_mfma_f32_16x16x32_bf16 v[116:119], v[204:207], v[172:175], v[116:119]
ds_read_b128 v[224:227], v32 offset:29696
v_mfma_f32_16x16x32_bf16 v[120:123], v[208:211], v[172:175], v[120:123]
ds_read_b64_tr_b16 v[144:145], v26 offset:8192
ds_read_b64_tr_b16 v[146:147], v26 offset:8704
s_waitcnt lgkmcnt(8)
v_mfma_f32_16x16x32_bf16 v[124:127], v[196:199], v[176:179], v[124:127]
s_add_u32 m0, s63, 0x1000
s_nop 0
buffer_load_dwordx4 v17, s[44:47], s73 offen offset:0 lds
buffer_load_dwordx4 v18, s[44:47], s73 offen offset:1024 lds
buffer_load_dwordx4 v19, s[44:47], s73 offen offset:2048 lds
buffer_load_dwordx4 v20, s[44:47], s73 offen offset:3072 lds
v_mfma_f32_16x16x32_bf16 v[128:131], v[200:203], v[176:179], v[128:131]
v_mfma_f32_16x16x32_bf16 v[132:135], v[204:207], v[176:179], v[132:135]
v_mfma_f32_16x16x32_bf16 v[136:139], v[208:211], v[176:179], v[136:139]
ds_read_b64_tr_b16 v[148:149], v27 offset:8192
ds_read_b64_tr_b16 v[150:151], v27 offset:8704
s_waitcnt lgkmcnt(7)
v_mfma_f32_16x16x32_bf16 v[76:79], v[212:215], v[140:143], v[76:79]
s_waitcnt lgkmcnt(6)
v_mfma_f32_16x16x32_bf16 v[80:83], v[216:219], v[140:143], v[80:83]
s_waitcnt lgkmcnt(5)
v_mfma_f32_16x16x32_bf16 v[84:87], v[220:223], v[140:143], v[84:87]
s_waitcnt lgkmcnt(4)
v_mfma_f32_16x16x32_bf16 v[88:91], v[224:227], v[140:143], v[88:91]
ds_read_b64_tr_b16 v[152:153], v28 offset:8192
ds_read_b64_tr_b16 v[154:155], v28 offset:8704
s_waitcnt lgkmcnt(4)
v_mfma_f32_16x16x32_bf16 v[92:95], v[212:215], v[144:147], v[92:95]
v_mfma_f32_16x16x32_bf16 v[96:99], v[216:219], v[144:147], v[96:99]
v_mfma_f32_16x16x32_bf16 v[100:103], v[220:223], v[144:147], v[100:103]
v_mfma_f32_16x16x32_bf16 v[104:107], v[224:227], v[144:147], v[104:107]
ds_read_b128 v[180:183], v31 offset:6144
s_waitcnt vmcnt(4)
ds_read_b64_tr_b16 v[156:157], v25 offset:0
ds_read_b64_tr_b16 v[158:159], v25 offset:512
s_waitcnt lgkmcnt(5)
v_mfma_f32_16x16x32_bf16 v[108:111], v[212:215], v[148:151], v[108:111]
ds_read_b128 v[184:187], v31 offset:14336
v_mfma_f32_16x16x32_bf16 v[112:115], v[216:219], v[148:151], v[112:115]
ds_read_b128 v[188:191], v31 offset:22528
v_mfma_f32_16x16x32_bf16 v[116:119], v[220:223], v[148:151], v[116:119]
ds_read_b128 v[192:195], v31 offset:30720
v_mfma_f32_16x16x32_bf16 v[120:123], v[224:227], v[148:151], v[120:123]
ds_read_b64_tr_b16 v[160:161], v26 offset:0
ds_read_b64_tr_b16 v[162:163], v26 offset:512
s_waitcnt lgkmcnt(8)
v_mfma_f32_16x16x32_bf16 v[124:127], v[212:215], v[152:155], v[124:127]
v_mfma_f32_16x16x32_bf16 v[128:131], v[216:219], v[152:155], v[128:131]
v_mfma_f32_16x16x32_bf16 v[132:135], v[220:223], v[152:155], v[132:135]
v_mfma_f32_16x16x32_bf16 v[136:139], v[224:227], v[152:155], v[136:139]
ds_read_b64_tr_b16 v[164:165], v27 offset:0
ds_read_b64_tr_b16 v[166:167], v27 offset:512
s_waitcnt lgkmcnt(7)
v_mfma_f32_16x16x32_bf16 v[76:79], v[180:183], v[156:159], v[76:79]
s_waitcnt lgkmcnt(6)
v_mfma_f32_16x16x32_bf16 v[80:83], v[184:187], v[156:159], v[80:83]
s_waitcnt lgkmcnt(5)
v_mfma_f32_16x16x32_bf16 v[84:87], v[188:191], v[156:159], v[84:87]
s_waitcnt lgkmcnt(4)
v_mfma_f32_16x16x32_bf16 v[88:91], v[192:195], v[156:159], v[88:91]
ds_read_b64_tr_b16 v[168:169], v28 offset:0
ds_read_b64_tr_b16 v[170:171], v28 offset:512
s_waitcnt lgkmcnt(4)
v_mfma_f32_16x16x32_bf16 v[92:95], v[180:183], v[160:163], v[92:95]
v_mfma_f32_16x16x32_bf16 v[96:99], v[184:187], v[160:163], v[96:99]
v_mfma_f32_16x16x32_bf16 v[100:103], v[188:191], v[160:163], v[100:103]
v_mfma_f32_16x16x32_bf16 v[104:107], v[192:195], v[160:163], v[104:107]
ds_read_b128 v[196:199], v32 offset:7168
s_waitcnt vmcnt(0)
ds_read_b64_tr_b16 v[172:173], v25 offset:4096
ds_read_b64_tr_b16 v[174:175], v25 offset:4608
s_waitcnt lgkmcnt(5)
v_mfma_f32_16x16x32_bf16 v[108:111], v[180:183], v[164:167], v[108:111]
ds_read_b128 v[200:203], v32 offset:15360
v_mfma_f32_16x16x32_bf16 v[112:115], v[184:187], v[164:167], v[112:115]
ds_read_b128 v[204:207], v32 offset:23552
v_mfma_f32_16x16x32_bf16 v[116:119], v[188:191], v[164:167], v[116:119]
ds_read_b128 v[208:211], v32 offset:31744
v_mfma_f32_16x16x32_bf16 v[120:123], v[192:195], v[164:167], v[120:123]
ds_read_b64_tr_b16 v[176:177], v26 offset:4096
ds_read_b64_tr_b16 v[178:179], v26 offset:4608
s_waitcnt lgkmcnt(8)
v_mfma_f32_16x16x32_bf16 v[124:127], v[180:183], v[168:171], v[124:127]
v_mfma_f32_16x16x32_bf16 v[128:131], v[184:187], v[168:171], v[128:131]
v_mfma_f32_16x16x32_bf16 v[132:135], v[188:191], v[168:171], v[132:135]
v_mfma_f32_16x16x32_bf16 v[136:139], v[192:195], v[168:171], v[136:139]
ds_read_b64_tr_b16 v[140:141], v27 offset:4096
ds_read_b64_tr_b16 v[142:143], v27 offset:4608
s_waitcnt lgkmcnt(7)
v_mfma_f32_16x16x32_bf16 v[76:79], v[196:199], v[172:175], v[76:79]
s_waitcnt lgkmcnt(6)
v_mfma_f32_16x16x32_bf16 v[80:83], v[200:203], v[172:175], v[80:83]
s_waitcnt lgkmcnt(5)
v_mfma_f32_16x16x32_bf16 v[84:87], v[204:207], v[172:175], v[84:87]
s_waitcnt lgkmcnt(4)
v_mfma_f32_16x16x32_bf16 v[88:91], v[208:211], v[172:175], v[88:91]
ds_read_b64_tr_b16 v[144:145], v28 offset:4096
ds_read_b64_tr_b16 v[146:147], v28 offset:4608
s_waitcnt lgkmcnt(4)
v_mfma_f32_16x16x32_bf16 v[92:95], v[196:199], v[176:179], v[92:95]
v_cvt_pk_bf16_f32 v76, v76, v77
v_cvt_pk_bf16_f32 v77, v78, v79
v_cvt_pk_bf16_f32 v78, v80, v81
v_cvt_pk_bf16_f32 v79, v82, v83
buffer_store_dwordx4 v[76:79], v16, s[52:55], s82 offen offset:0 sc1
v_mfma_f32_16x16x32_bf16 v[96:99], v[200:203], v[176:179], v[96:99]
v_mfma_f32_16x16x32_bf16 v[100:103], v[204:207], v[176:179], v[100:103]
v_cvt_pk_bf16_f32 v84, v84, v85
v_cvt_pk_bf16_f32 v85, v86, v87
v_cvt_pk_bf16_f32 v86, v88, v89
v_cvt_pk_bf16_f32 v87, v90, v91
buffer_store_dwordx4 v[84:87], v16, s[52:55], s82 offen offset:2048 sc1
v_mfma_f32_16x16x32_bf16 v[104:107], v[208:211], v[176:179], v[104:107]
s_waitcnt lgkmcnt(2)
v_mfma_f32_16x16x32_bf16 v[108:111], v[196:199], v[140:143], v[108:111]
v_cvt_pk_bf16_f32 v92, v92, v93
v_cvt_pk_bf16_f32 v93, v94, v95
v_cvt_pk_bf16_f32 v94, v96, v97
v_cvt_pk_bf16_f32 v95, v98, v99
buffer_store_dwordx4 v[92:95], v16, s[52:55], s82 offen offset:1024 sc1
v_mfma_f32_16x16x32_bf16 v[112:115], v[200:203], v[140:143], v[112:115]
v_mfma_f32_16x16x32_bf16 v[116:119], v[204:207], v[140:143], v[116:119]
v_cvt_pk_bf16_f32 v100, v100, v101
v_cvt_pk_bf16_f32 v101, v102, v103
v_cvt_pk_bf16_f32 v102, v104, v105
v_cvt_pk_bf16_f32 v103, v106, v107
buffer_store_dwordx4 v[100:103], v16, s[52:55], s82 offen offset:3072 sc1
v_mfma_f32_16x16x32_bf16 v[120:123], v[208:211], v[140:143], v[120:123]
s_waitcnt lgkmcnt(0)
v_mfma_f32_16x16x32_bf16 v[124:127], v[196:199], v[144:147], v[124:127]
v_cvt_pk_bf16_f32 v108, v108, v109
v_cvt_pk_bf16_f32 v109, v110, v111
v_cvt_pk_bf16_f32 v110, v112, v113
v_cvt_pk_bf16_f32 v111, v114, v115
buffer_store_dwordx4 v[108:111], v16, s[52:55], s83 offen offset:0 sc1
v_mfma_f32_16x16x32_bf16 v[128:131], v[200:203], v[144:147], v[128:131]
v_mfma_f32_16x16x32_bf16 v[132:135], v[204:207], v[144:147], v[132:135]
v_cvt_pk_bf16_f32 v116, v116, v117
v_cvt_pk_bf16_f32 v117, v118, v119
v_cvt_pk_bf16_f32 v118, v120, v121
v_cvt_pk_bf16_f32 v119, v122, v123
buffer_store_dwordx4 v[116:119], v16, s[52:55], s83 offen offset:2048 sc1
v_mfma_f32_16x16x32_bf16 v[136:139], v[208:211], v[144:147], v[136:139]
v_cvt_pk_bf16_f32 v124, v124, v125
v_cvt_pk_bf16_f32 v125, v126, v127
v_cvt_pk_bf16_f32 v126, v128, v129
v_cvt_pk_bf16_f32 v127, v130, v131
buffer_store_dwordx4 v[124:127], v16, s[52:55], s83 offen offset:1024 sc1
v_cvt_pk_bf16_f32 v132, v132, v133
v_cvt_pk_bf16_f32 v133, v134, v135
s_nop 0
v_cvt_pk_bf16_f32 v134, v136, v137
v_cvt_pk_bf16_f32 v135, v138, v139
buffer_store_dwordx4 v[132:135], v16, s[52:55], s83 offen offset:3072 sc1
s_branch LM_pub
LM_light:
s_mov_b32 s61, 1
s_waitcnt lgkmcnt(0)
s_mov_b32 s98, 0x7c3ff80
s_load_dwordx2 s[98:99], s[38:39], s98
s_branch L1_fin
LM_edge:
s_sub_u32 s4, s3, 30
s_lshl_b32 s8, s8, 1
s_add_u32 s4, s4, s8
s_add_u32 s91, s4, 240
s_cmp_ge_u32 s4, 14
s_cselect_b32 s61, 1, 0
s_mul_i32 s6, s4, 40000
v_lshlrev_b32 v5, 4, v0
v_lshlrev_b32 v6, 2, v2
v_add_u32 v6, 0x10000, v6
v_mov_b32 v7, 0
ds_write_b32 v6, v7
s_mov_b32 s66, 0
s_mov_b32 s67, 4096
s_mov_b32 s68, 8192
s_mov_b32 s69, 12288
s_mov_b32 s70, 16384
s_mov_b32 s71, 20480
s_mov_b32 s72, 24576
s_mov_b32 s73, 28672
s_mov_b32 s74, 32768
s_mov_b32 s75, 36864
s_waitcnt lgkmcnt(0)
s_add_u32 s40, s20, 0x0
s_addc_u32 s41, s21, 0
s_add_u32 s40, s40, s6
s_addc_u32 s41, s41, 0
s_mov_b32 s42, 0x9c40
s_mov_b32 s43, 0x00020000
s_add_u32 s44, s18, 0x0
s_addc_u32 s45, s19, 0
s_add_u32 s44, s44, s6
s_addc_u32 s45, s45, 0
s_mov_b32 s46, 0x9c40
s_mov_b32 s47, 0x00020000
buffer_load_dwordx4 v[16:19], v5, s[40:43], s66 offen
buffer_load_dwordx4 v[20:23], v5, s[40:43], s67 offen
buffer_load_dwordx4 v[24:27], v5, s[40:43], s68 offen
buffer_load_dwordx4 v[28:31], v5, s[40:43], s69 offen
buffer_load_dwordx4 v[32:35], v5, s[40:43], s70 offen
buffer_load_dwordx4 v[36:39], v5, s[40:43], s71 offen
buffer_load_dwordx4 v[40:43], v5, s[40:43], s72 offen
buffer_load_dwordx4 v[44:47], v5, s[40:43], s73 offen
buffer_load_dwordx4 v[48:51], v5, s[40:43], s74 offen
buffer_load_dwordx4 v[52:55], v5, s[40:43], s75 offen
buffer_load_dwordx4 v[56:59], v5, s[44:47], s66 offen
buffer_load_dwordx4 v[60:63], v5, s[44:47], s67 offen
buffer_load_dwordx4 v[64:67], v5, s[44:47], s68 offen
buffer_load_dwordx4 v[68:71], v5, s[44:47], s69 offen
buffer_load_dwordx4 v[72:75], v5, s[44:47], s70 offen
buffer_load_dwordx4 v[76:79], v5, s[44:47], s71 offen
buffer_load_dwordx4 v[80:83], v5, s[44:47], s72 offen
buffer_load_dwordx4 v[84:87], v5, s[44:47], s73 offen
buffer_load_dwordx4 v[88:91], v5, s[44:47], s74 offen
buffer_load_dwordx4 v[92:95], v5, s[44:47], s75 offen
s_mov_b32 s98, 0x7c3ff80
s_load_dwordx2 s[98:99], s[38:39], s98
s_add_u32 s48, s38, 0x8000000
s_addc_u32 s49, s39, 0
s_mov_b32 s50, 0x2800000
s_mov_b32 s51, 0x00020000
s_add_u32 s52, s38, 0x7800000
s_addc_u32 s53, s39, 0
s_mov_b32 s54, 0x1000
s_mov_b32 s55, 0x00020000
v_mov_b32 v240, 6945
v_mov_b32 v241, 0x0
v_mov_b32 v242, 6317
v_mov_b32 v243, 0x340674
v_mov_b32 v244, 6899
v_mov_b32 v245, 0xfffae6a0
v_mov_b32 v246, 6242
v_mov_b32 v247, 0x4484a0
s_mov_b32 s11, 0x10000
v_mov_b32 v7, 1
v_cmp_gt_u32 vcc, 0xc4, v0
s_mov_b64 s[12:13], vcc
s_barrier
s_waitcnt vmcnt(19)
v_cmp_le_u32 vcc, 5436, v16
s_nop 1
v_cndmask_b32 v96, v240, v242, vcc
v_cndmask_b32 v136, v241, v243, vcc
v_cmp_le_u32 vcc, 6432, v16
s_nop 1
v_cndmask_b32 v96, v96, v244, vcc
v_cndmask_b32 v136, v136, v245, vcc
v_cmp_le_u32 vcc, 7344, v16
s_nop 1
v_cndmask_b32 v96, v96, v246, vcc
v_cndmask_b32 v136, v136, v247, vcc
v_mad_u32_u24 v96, v96, v16, v136
v_lshrrev_b32 v96, 20, v96
v_lshl_add_u32 v136, v96, 2, s11
ds_add_rtn_u32 v136, v136, v7
v_cmp_le_u32 vcc, 5436, v17
s_nop 1
v_cndmask_b32 v97, v240, v242, vcc
v_cndmask_b32 v137, v241, v243, vcc
v_cmp_le_u32 vcc, 6432, v17
s_nop 1
v_cndmask_b32 v97, v97, v244, vcc
v_cndmask_b32 v137, v137, v245, vcc
v_cmp_le_u32 vcc, 7344, v17
s_nop 1
v_cndmask_b32 v97, v97, v246, vcc
v_cndmask_b32 v137, v137, v247, vcc
v_mad_u32_u24 v97, v97, v17, v137
v_lshrrev_b32 v97, 20, v97
v_lshl_add_u32 v137, v97, 2, s11
ds_add_rtn_u32 v137, v137, v7
v_cmp_le_u32 vcc, 5436, v18
s_nop 1
v_cndmask_b32 v98, v240, v242, vcc
v_cndmask_b32 v138, v241, v243, vcc
v_cmp_le_u32 vcc, 6432, v18
s_nop 1
v_cndmask_b32 v98, v98, v244, vcc
v_cndmask_b32 v138, v138, v245, vcc
v_cmp_le_u32 vcc, 7344, v18
s_nop 1
v_cndmask_b32 v98, v98, v246, vcc
v_cndmask_b32 v138, v138, v247, vcc
v_mad_u32_u24 v98, v98, v18, v138
v_lshrrev_b32 v98, 20, v98
v_lshl_add_u32 v138, v98, 2, s11
ds_add_rtn_u32 v138, v138, v7
v_cmp_le_u32 vcc, 5436, v19
s_nop 1
v_cndmask_b32 v99, v240, v242, vcc
v_cndmask_b32 v139, v241, v243, vcc
v_cmp_le_u32 vcc, 6432, v19
s_nop 1
v_cndmask_b32 v99, v99, v244, vcc
v_cndmask_b32 v139, v139, v245, vcc
v_cmp_le_u32 vcc, 7344, v19
s_nop 1
v_cndmask_b32 v99, v99, v246, vcc
v_cndmask_b32 v139, v139, v247, vcc
v_mad_u32_u24 v99, v99, v19, v139
v_lshrrev_b32 v99, 20, v99
v_lshl_add_u32 v139, v99, 2, s11
ds_add_rtn_u32 v139, v139, v7
s_waitcnt vmcnt(18)
v_cmp_le_u32 vcc, 5436, v20
s_nop 1
v_cndmask_b32 v100, v240, v242, vcc
v_cndmask_b32 v140, v241, v243, vcc
v_cmp_le_u32 vcc, 6432, v20
s_nop 1
v_cndmask_b32 v100, v100, v244, vcc
v_cndmask_b32 v140, v140, v245, vcc
v_cmp_le_u32 vcc, 7344, v20
s_nop 1
v_cndmask_b32 v100, v100, v246, vcc
v_cndmask_b32 v140, v140, v247, vcc
v_mad_u32_u24 v100, v100, v20, v140
v_lshrrev_b32 v100, 20, v100
v_lshl_add_u32 v140, v100, 2, s11
ds_add_rtn_u32 v140, v140, v7
v_cmp_le_u32 vcc, 5436, v21
s_nop 1
v_cndmask_b32 v101, v240, v242, vcc
v_cndmask_b32 v141, v241, v243, vcc
v_cmp_le_u32 vcc, 6432, v21
s_nop 1
v_cndmask_b32 v101, v101, v244, vcc
v_cndmask_b32 v141, v141, v245, vcc
v_cmp_le_u32 vcc, 7344, v21
s_nop 1
v_cndmask_b32 v101, v101, v246, vcc
v_cndmask_b32 v141, v141, v247, vcc
v_mad_u32_u24 v101, v101, v21, v141
v_lshrrev_b32 v101, 20, v101
v_lshl_add_u32 v141, v101, 2, s11
ds_add_rtn_u32 v141, v141, v7
v_cmp_le_u32 vcc, 5436, v22
s_nop 1
v_cndmask_b32 v102, v240, v242, vcc
v_cndmask_b32 v142, v241, v243, vcc
v_cmp_le_u32 vcc, 6432, v22
s_nop 1
v_cndmask_b32 v102, v102, v244, vcc
v_cndmask_b32 v142, v142, v245, vcc
v_cmp_le_u32 vcc, 7344, v22
s_nop 1
v_cndmask_b32 v102, v102, v246, vcc
v_cndmask_b32 v142, v142, v247, vcc
v_mad_u32_u24 v102, v102, v22, v142
v_lshrrev_b32 v102, 20, v102
v_lshl_add_u32 v142, v102, 2, s11
ds_add_rtn_u32 v142, v142, v7
v_cmp_le_u32 vcc, 5436, v23
s_nop 1
v_cndmask_b32 v103, v240, v242, vcc
v_cndmask_b32 v143, v241, v243, vcc
v_cmp_le_u32 vcc, 6432, v23
s_nop 1
v_cndmask_b32 v103, v103, v244, vcc
v_cndmask_b32 v143, v143, v245, vcc
v_cmp_le_u32 vcc, 7344, v23
s_nop 1
v_cndmask_b32 v103, v103, v246, vcc
v_cndmask_b32 v143, v143, v247, vcc
v_mad_u32_u24 v103, v103, v23, v143
v_lshrrev_b32 v103, 20, v103
v_lshl_add_u32 v143, v103, 2, s11
ds_add_rtn_u32 v143, v143, v7
s_waitcnt vmcnt(17)
v_cmp_le_u32 vcc, 5436, v24
s_nop 1
v_cndmask_b32 v104, v240, v242, vcc
v_cndmask_b32 v144, v241, v243, vcc
v_cmp_le_u32 vcc, 6432, v24
s_nop 1
v_cndmask_b32 v104, v104, v244, vcc
v_cndmask_b32 v144, v144, v245, vcc
v_cmp_le_u32 vcc, 7344, v24
s_nop 1
v_cndmask_b32 v104, v104, v246, vcc
v_cndmask_b32 v144, v144, v247, vcc
v_mad_u32_u24 v104, v104, v24, v144
v_lshrrev_b32 v104, 20, v104
v_lshl_add_u32 v144, v104, 2, s11
ds_add_rtn_u32 v144, v144, v7
v_cmp_le_u32 vcc, 5436, v25
s_nop 1
v_cndmask_b32 v105, v240, v242, vcc
v_cndmask_b32 v145, v241, v243, vcc
v_cmp_le_u32 vcc, 6432, v25
s_nop 1
v_cndmask_b32 v105, v105, v244, vcc
v_cndmask_b32 v145, v145, v245, vcc
v_cmp_le_u32 vcc, 7344, v25
s_nop 1
v_cndmask_b32 v105, v105, v246, vcc
v_cndmask_b32 v145, v145, v247, vcc
v_mad_u32_u24 v105, v105, v25, v145
v_lshrrev_b32 v105, 20, v105
v_lshl_add_u32 v145, v105, 2, s11
ds_add_rtn_u32 v145, v145, v7
v_cmp_le_u32 vcc, 5436, v26
s_nop 1
v_cndmask_b32 v106, v240, v242, vcc
v_cndmask_b32 v146, v241, v243, vcc
v_cmp_le_u32 vcc, 6432, v26
s_nop 1
v_cndmask_b32 v106, v106, v244, vcc
v_cndmask_b32 v146, v146, v245, vcc
v_cmp_le_u32 vcc, 7344, v26
s_nop 1
v_cndmask_b32 v106, v106, v246, vcc
v_cndmask_b32 v146, v146, v247, vcc
v_mad_u32_u24 v106, v106, v26, v146
v_lshrrev_b32 v106, 20, v106
v_lshl_add_u32 v146, v106, 2, s11
ds_add_rtn_u32 v146, v146, v7
v_cmp_le_u32 vcc, 5436, v27
s_nop 1
v_cndmask_b32 v107, v240, v242, vcc
v_cndmask_b32 v147, v241, v243, vcc
v_cmp_le_u32 vcc, 6432, v27
s_nop 1
v_cndmask_b32 v107, v107, v244, vcc
v_cndmask_b32 v147, v147, v245, vcc
v_cmp_le_u32 vcc, 7344, v27
s_nop 1
v_cndmask_b32 v107, v107, v246, vcc
v_cndmask_b32 v147, v147, v247, vcc
v_mad_u32_u24 v107, v107, v27, v147
v_lshrrev_b32 v107, 20, v107
v_lshl_add_u32 v147, v107, 2, s11
ds_add_rtn_u32 v147, v147, v7
s_waitcnt vmcnt(16)
v_cmp_le_u32 vcc, 5436, v28
s_nop 1
v_cndmask_b32 v108, v240, v242, vcc
v_cndmask_b32 v148, v241, v243, vcc
v_cmp_le_u32 vcc, 6432, v28
s_nop 1
v_cndmask_b32 v108, v108, v244, vcc
v_cndmask_b32 v148, v148, v245, vcc
v_cmp_le_u32 vcc, 7344, v28
s_nop 1
v_cndmask_b32 v108, v108, v246, vcc
v_cndmask_b32 v148, v148, v247, vcc
v_mad_u32_u24 v108, v108, v28, v148
v_lshrrev_b32 v108, 20, v108
v_lshl_add_u32 v148, v108, 2, s11
ds_add_rtn_u32 v148, v148, v7
v_cmp_le_u32 vcc, 5436, v29
s_nop 1
v_cndmask_b32 v109, v240, v242, vcc
v_cndmask_b32 v149, v241, v243, vcc
v_cmp_le_u32 vcc, 6432, v29
s_nop 1
v_cndmask_b32 v109, v109, v244, vcc
v_cndmask_b32 v149, v149, v245, vcc
v_cmp_le_u32 vcc, 7344, v29
s_nop 1
v_cndmask_b32 v109, v109, v246, vcc
v_cndmask_b32 v149, v149, v247, vcc
v_mad_u32_u24 v109, v109, v29, v149
v_lshrrev_b32 v109, 20, v109
v_lshl_add_u32 v149, v109, 2, s11
ds_add_rtn_u32 v149, v149, v7
v_cmp_le_u32 vcc, 5436, v30
s_nop 1
v_cndmask_b32 v110, v240, v242, vcc
v_cndmask_b32 v150, v241, v243, vcc
v_cmp_le_u32 vcc, 6432, v30
s_nop 1
v_cndmask_b32 v110, v110, v244, vcc
v_cndmask_b32 v150, v150, v245, vcc
v_cmp_le_u32 vcc, 7344, v30
s_nop 1
v_cndmask_b32 v110, v110, v246, vcc
v_cndmask_b32 v150, v150, v247, vcc
v_mad_u32_u24 v110, v110, v30, v150
v_lshrrev_b32 v110, 20, v110
v_lshl_add_u32 v150, v110, 2, s11
ds_add_rtn_u32 v150, v150, v7
v_cmp_le_u32 vcc, 5436, v31
s_nop 1
v_cndmask_b32 v111, v240, v242, vcc
v_cndmask_b32 v151, v241, v243, vcc
v_cmp_le_u32 vcc, 6432, v31
s_nop 1
v_cndmask_b32 v111, v111, v244, vcc
v_cndmask_b32 v151, v151, v245, vcc
v_cmp_le_u32 vcc, 7344, v31
s_nop 1
v_cndmask_b32 v111, v111, v246, vcc
v_cndmask_b32 v151, v151, v247, vcc
v_mad_u32_u24 v111, v111, v31, v151
v_lshrrev_b32 v111, 20, v111
v_lshl_add_u32 v151, v111, 2, s11
ds_add_rtn_u32 v151, v151, v7
s_waitcnt vmcnt(15)
v_cmp_le_u32 vcc, 5436, v32
s_nop 1
v_cndmask_b32 v112, v240, v242, vcc
v_cndmask_b32 v152, v241, v243, vcc
v_cmp_le_u32 vcc, 6432, v32
s_nop 1
v_cndmask_b32 v112, v112, v244, vcc
v_cndmask_b32 v152, v152, v245, vcc
v_cmp_le_u32 vcc, 7344, v32
s_nop 1
v_cndmask_b32 v112, v112, v246, vcc
v_cndmask_b32 v152, v152, v247, vcc
v_mad_u32_u24 v112, v112, v32, v152
v_lshrrev_b32 v112, 20, v112
v_lshl_add_u32 v152, v112, 2, s11
ds_add_rtn_u32 v152, v152, v7
v_cmp_le_u32 vcc, 5436, v33
s_nop 1
v_cndmask_b32 v113, v240, v242, vcc
v_cndmask_b32 v153, v241, v243, vcc
v_cmp_le_u32 vcc, 6432, v33
s_nop 1
v_cndmask_b32 v113, v113, v244, vcc
v_cndmask_b32 v153, v153, v245, vcc
v_cmp_le_u32 vcc, 7344, v33
s_nop 1
v_cndmask_b32 v113, v113, v246, vcc
v_cndmask_b32 v153, v153, v247, vcc
v_mad_u32_u24 v113, v113, v33, v153
v_lshrrev_b32 v113, 20, v113
v_lshl_add_u32 v153, v113, 2, s11
ds_add_rtn_u32 v153, v153, v7
v_cmp_le_u32 vcc, 5436, v34
s_nop 1
v_cndmask_b32 v114, v240, v242, vcc
v_cndmask_b32 v154, v241, v243, vcc
v_cmp_le_u32 vcc, 6432, v34
s_nop 1
v_cndmask_b32 v114, v114, v244, vcc
v_cndmask_b32 v154, v154, v245, vcc
v_cmp_le_u32 vcc, 7344, v34
s_nop 1
v_cndmask_b32 v114, v114, v246, vcc
v_cndmask_b32 v154, v154, v247, vcc
v_mad_u32_u24 v114, v114, v34, v154
v_lshrrev_b32 v114, 20, v114
v_lshl_add_u32 v154, v114, 2, s11
ds_add_rtn_u32 v154, v154, v7
v_cmp_le_u32 vcc, 5436, v35
s_nop 1
v_cndmask_b32 v115, v240, v242, vcc
v_cndmask_b32 v155, v241, v243, vcc
v_cmp_le_u32 vcc, 6432, v35
s_nop 1
v_cndmask_b32 v115, v115, v244, vcc
v_cndmask_b32 v155, v155, v245, vcc
v_cmp_le_u32 vcc, 7344, v35
s_nop 1
v_cndmask_b32 v115, v115, v246, vcc
v_cndmask_b32 v155, v155, v247, vcc
v_mad_u32_u24 v115, v115, v35, v155
v_lshrrev_b32 v115, 20, v115
v_lshl_add_u32 v155, v115, 2, s11
ds_add_rtn_u32 v155, v155, v7
s_waitcnt vmcnt(14)
v_cmp_le_u32 vcc, 5436, v36
s_nop 1
v_cndmask_b32 v116, v240, v242, vcc
v_cndmask_b32 v156, v241, v243, vcc
v_cmp_le_u32 vcc, 6432, v36
s_nop 1
v_cndmask_b32 v116, v116, v244, vcc
v_cndmask_b32 v156, v156, v245, vcc
v_cmp_le_u32 vcc, 7344, v36
s_nop 1
v_cndmask_b32 v116, v116, v246, vcc
v_cndmask_b32 v156, v156, v247, vcc
v_mad_u32_u24 v116, v116, v36, v156
v_lshrrev_b32 v116, 20, v116
v_lshl_add_u32 v156, v116, 2, s11
ds_add_rtn_u32 v156, v156, v7
v_cmp_le_u32 vcc, 5436, v37
s_nop 1
v_cndmask_b32 v117, v240, v242, vcc
v_cndmask_b32 v157, v241, v243, vcc
v_cmp_le_u32 vcc, 6432, v37
s_nop 1
v_cndmask_b32 v117, v117, v244, vcc
v_cndmask_b32 v157, v157, v245, vcc
v_cmp_le_u32 vcc, 7344, v37
s_nop 1
v_cndmask_b32 v117, v117, v246, vcc
v_cndmask_b32 v157, v157, v247, vcc
v_mad_u32_u24 v117, v117, v37, v157
v_lshrrev_b32 v117, 20, v117
v_lshl_add_u32 v157, v117, 2, s11
ds_add_rtn_u32 v157, v157, v7
v_cmp_le_u32 vcc, 5436, v38
s_nop 1
v_cndmask_b32 v118, v240, v242, vcc
v_cndmask_b32 v158, v241, v243, vcc
v_cmp_le_u32 vcc, 6432, v38
s_nop 1
v_cndmask_b32 v118, v118, v244, vcc
v_cndmask_b32 v158, v158, v245, vcc
v_cmp_le_u32 vcc, 7344, v38
s_nop 1
v_cndmask_b32 v118, v118, v246, vcc
v_cndmask_b32 v158, v158, v247, vcc
v_mad_u32_u24 v118, v118, v38, v158
v_lshrrev_b32 v118, 20, v118
v_lshl_add_u32 v158, v118, 2, s11
ds_add_rtn_u32 v158, v158, v7
v_cmp_le_u32 vcc, 5436, v39
s_nop 1
v_cndmask_b32 v119, v240, v242, vcc
v_cndmask_b32 v159, v241, v243, vcc
v_cmp_le_u32 vcc, 6432, v39
s_nop 1
v_cndmask_b32 v119, v119, v244, vcc
v_cndmask_b32 v159, v159, v245, vcc
v_cmp_le_u32 vcc, 7344, v39
s_nop 1
v_cndmask_b32 v119, v119, v246, vcc
v_cndmask_b32 v159, v159, v247, vcc
v_mad_u32_u24 v119, v119, v39, v159
v_lshrrev_b32 v119, 20, v119
v_lshl_add_u32 v159, v119, 2, s11
ds_add_rtn_u32 v159, v159, v7
s_waitcnt vmcnt(13)
v_cmp_le_u32 vcc, 5436, v40
s_nop 1
v_cndmask_b32 v120, v240, v242, vcc
v_cndmask_b32 v160, v241, v243, vcc
v_cmp_le_u32 vcc, 6432, v40
s_nop 1
v_cndmask_b32 v120, v120, v244, vcc
v_cndmask_b32 v160, v160, v245, vcc
v_cmp_le_u32 vcc, 7344, v40
s_nop 1
v_cndmask_b32 v120, v120, v246, vcc
v_cndmask_b32 v160, v160, v247, vcc
v_mad_u32_u24 v120, v120, v40, v160
v_lshrrev_b32 v120, 20, v120
v_lshl_add_u32 v160, v120, 2, s11
ds_add_rtn_u32 v160, v160, v7
v_cmp_le_u32 vcc, 5436, v41
s_nop 1
v_cndmask_b32 v121, v240, v242, vcc
v_cndmask_b32 v161, v241, v243, vcc
v_cmp_le_u32 vcc, 6432, v41
s_nop 1
v_cndmask_b32 v121, v121, v244, vcc
v_cndmask_b32 v161, v161, v245, vcc
v_cmp_le_u32 vcc, 7344, v41
s_nop 1
v_cndmask_b32 v121, v121, v246, vcc
v_cndmask_b32 v161, v161, v247, vcc
v_mad_u32_u24 v121, v121, v41, v161
v_lshrrev_b32 v121, 20, v121
v_lshl_add_u32 v161, v121, 2, s11
ds_add_rtn_u32 v161, v161, v7
v_cmp_le_u32 vcc, 5436, v42
s_nop 1
v_cndmask_b32 v122, v240, v242, vcc
v_cndmask_b32 v162, v241, v243, vcc
v_cmp_le_u32 vcc, 6432, v42
s_nop 1
v_cndmask_b32 v122, v122, v244, vcc
v_cndmask_b32 v162, v162, v245, vcc
v_cmp_le_u32 vcc, 7344, v42
s_nop 1
v_cndmask_b32 v122, v122, v246, vcc
v_cndmask_b32 v162, v162, v247, vcc
v_mad_u32_u24 v122, v122, v42, v162
v_lshrrev_b32 v122, 20, v122
v_lshl_add_u32 v162, v122, 2, s11
ds_add_rtn_u32 v162, v162, v7
v_cmp_le_u32 vcc, 5436, v43
s_nop 1
v_cndmask_b32 v123, v240, v242, vcc
v_cndmask_b32 v163, v241, v243, vcc
v_cmp_le_u32 vcc, 6432, v43
s_nop 1
v_cndmask_b32 v123, v123, v244, vcc
v_cndmask_b32 v163, v163, v245, vcc
v_cmp_le_u32 vcc, 7344, v43
s_nop 1
v_cndmask_b32 v123, v123, v246, vcc
v_cndmask_b32 v163, v163, v247, vcc
v_mad_u32_u24 v123, v123, v43, v163
v_lshrrev_b32 v123, 20, v123
v_lshl_add_u32 v163, v123, 2, s11
ds_add_rtn_u32 v163, v163, v7
s_waitcnt vmcnt(12)
v_cmp_le_u32 vcc, 5436, v44
s_nop 1
v_cndmask_b32 v124, v240, v242, vcc
v_cndmask_b32 v164, v241, v243, vcc
v_cmp_le_u32 vcc, 6432, v44
s_nop 1
v_cndmask_b32 v124, v124, v244, vcc
v_cndmask_b32 v164, v164, v245, vcc
v_cmp_le_u32 vcc, 7344, v44
s_nop 1
v_cndmask_b32 v124, v124, v246, vcc
v_cndmask_b32 v164, v164, v247, vcc
v_mad_u32_u24 v124, v124, v44, v164
v_lshrrev_b32 v124, 20, v124
v_lshl_add_u32 v164, v124, 2, s11
ds_add_rtn_u32 v164, v164, v7
v_cmp_le_u32 vcc, 5436, v45
s_nop 1
v_cndmask_b32 v125, v240, v242, vcc
v_cndmask_b32 v165, v241, v243, vcc
v_cmp_le_u32 vcc, 6432, v45
s_nop 1
v_cndmask_b32 v125, v125, v244, vcc
v_cndmask_b32 v165, v165, v245, vcc
v_cmp_le_u32 vcc, 7344, v45
s_nop 1
v_cndmask_b32 v125, v125, v246, vcc
v_cndmask_b32 v165, v165, v247, vcc
v_mad_u32_u24 v125, v125, v45, v165
v_lshrrev_b32 v125, 20, v125
v_lshl_add_u32 v165, v125, 2, s11
ds_add_rtn_u32 v165, v165, v7
v_cmp_le_u32 vcc, 5436, v46
s_nop 1
v_cndmask_b32 v126, v240, v242, vcc
v_cndmask_b32 v166, v241, v243, vcc
v_cmp_le_u32 vcc, 6432, v46
s_nop 1
v_cndmask_b32 v126, v126, v244, vcc
v_cndmask_b32 v166, v166, v245, vcc
v_cmp_le_u32 vcc, 7344, v46
s_nop 1
v_cndmask_b32 v126, v126, v246, vcc
v_cndmask_b32 v166, v166, v247, vcc
v_mad_u32_u24 v126, v126, v46, v166
v_lshrrev_b32 v126, 20, v126
v_lshl_add_u32 v166, v126, 2, s11
ds_add_rtn_u32 v166, v166, v7
v_cmp_le_u32 vcc, 5436, v47
s_nop 1
v_cndmask_b32 v127, v240, v242, vcc
v_cndmask_b32 v167, v241, v243, vcc
v_cmp_le_u32 vcc, 6432, v47
s_nop 1
v_cndmask_b32 v127, v127, v244, vcc
v_cndmask_b32 v167, v167, v245, vcc
v_cmp_le_u32 vcc, 7344, v47
s_nop 1
v_cndmask_b32 v127, v127, v246, vcc
v_cndmask_b32 v167, v167, v247, vcc
v_mad_u32_u24 v127, v127, v47, v167
v_lshrrev_b32 v127, 20, v127
v_lshl_add_u32 v167, v127, 2, s11
ds_add_rtn_u32 v167, v167, v7
s_waitcnt vmcnt(11)
v_cmp_le_u32 vcc, 5436, v48
s_nop 1
v_cndmask_b32 v128, v240, v242, vcc
v_cndmask_b32 v168, v241, v243, vcc
v_cmp_le_u32 vcc, 6432, v48
s_nop 1
v_cndmask_b32 v128, v128, v244, vcc
v_cndmask_b32 v168, v168, v245, vcc
v_cmp_le_u32 vcc, 7344, v48
s_nop 1
v_cndmask_b32 v128, v128, v246, vcc
v_cndmask_b32 v168, v168, v247, vcc
v_mad_u32_u24 v128, v128, v48, v168
v_lshrrev_b32 v128, 20, v128
v_lshl_add_u32 v168, v128, 2, s11
ds_add_rtn_u32 v168, v168, v7
v_cmp_le_u32 vcc, 5436, v49
s_nop 1
v_cndmask_b32 v129, v240, v242, vcc
v_cndmask_b32 v169, v241, v243, vcc
v_cmp_le_u32 vcc, 6432, v49
s_nop 1
v_cndmask_b32 v129, v129, v244, vcc
v_cndmask_b32 v169, v169, v245, vcc
v_cmp_le_u32 vcc, 7344, v49
s_nop 1
v_cndmask_b32 v129, v129, v246, vcc
v_cndmask_b32 v169, v169, v247, vcc
v_mad_u32_u24 v129, v129, v49, v169
v_lshrrev_b32 v129, 20, v129
v_lshl_add_u32 v169, v129, 2, s11
ds_add_rtn_u32 v169, v169, v7
v_cmp_le_u32 vcc, 5436, v50
s_nop 1
v_cndmask_b32 v130, v240, v242, vcc
v_cndmask_b32 v170, v241, v243, vcc
v_cmp_le_u32 vcc, 6432, v50
s_nop 1
v_cndmask_b32 v130, v130, v244, vcc
v_cndmask_b32 v170, v170, v245, vcc
v_cmp_le_u32 vcc, 7344, v50
s_nop 1
v_cndmask_b32 v130, v130, v246, vcc
v_cndmask_b32 v170, v170, v247, vcc
v_mad_u32_u24 v130, v130, v50, v170
v_lshrrev_b32 v130, 20, v130
v_lshl_add_u32 v170, v130, 2, s11
ds_add_rtn_u32 v170, v170, v7
v_cmp_le_u32 vcc, 5436, v51
s_nop 1
v_cndmask_b32 v131, v240, v242, vcc
v_cndmask_b32 v171, v241, v243, vcc
v_cmp_le_u32 vcc, 6432, v51
s_nop 1
v_cndmask_b32 v131, v131, v244, vcc
v_cndmask_b32 v171, v171, v245, vcc
v_cmp_le_u32 vcc, 7344, v51
s_nop 1
v_cndmask_b32 v131, v131, v246, vcc
v_cndmask_b32 v171, v171, v247, vcc
v_mad_u32_u24 v131, v131, v51, v171
v_lshrrev_b32 v131, 20, v131
v_lshl_add_u32 v171, v131, 2, s11
ds_add_rtn_u32 v171, v171, v7
s_waitcnt vmcnt(10)
s_mov_b64 exec, s[12:13]
v_cmp_le_u32 vcc, 5436, v52
s_nop 1
v_cndmask_b32 v132, v240, v242, vcc
v_cndmask_b32 v172, v241, v243, vcc
v_cmp_le_u32 vcc, 6432, v52
s_nop 1
v_cndmask_b32 v132, v132, v244, vcc
v_cndmask_b32 v172, v172, v245, vcc
v_cmp_le_u32 vcc, 7344, v52
s_nop 1
v_cndmask_b32 v132, v132, v246, vcc
v_cndmask_b32 v172, v172, v247, vcc
v_mad_u32_u24 v132, v132, v52, v172
v_lshrrev_b32 v132, 20, v132
v_lshl_add_u32 v172, v132, 2, s11
ds_add_rtn_u32 v172, v172, v7
v_cmp_le_u32 vcc, 5436, v53
s_nop 1
v_cndmask_b32 v133, v240, v242, vcc
v_cndmask_b32 v173, v241, v243, vcc
v_cmp_le_u32 vcc, 6432, v53
s_nop 1
v_cndmask_b32 v133, v133, v244, vcc
v_cndmask_b32 v173, v173, v245, vcc
v_cmp_le_u32 vcc, 7344, v53
s_nop 1
v_cndmask_b32 v133, v133, v246, vcc
v_cndmask_b32 v173, v173, v247, vcc
v_mad_u32_u24 v133, v133, v53, v173
v_lshrrev_b32 v133, 20, v133
v_lshl_add_u32 v173, v133, 2, s11
ds_add_rtn_u32 v173, v173, v7
v_cmp_le_u32 vcc, 5436, v54
s_nop 1
v_cndmask_b32 v134, v240, v242, vcc
v_cndmask_b32 v174, v241, v243, vcc
v_cmp_le_u32 vcc, 6432, v54
s_nop 1
v_cndmask_b32 v134, v134, v244, vcc
v_cndmask_b32 v174, v174, v245, vcc
v_cmp_le_u32 vcc, 7344, v54
s_nop 1
v_cndmask_b32 v134, v134, v246, vcc
v_cndmask_b32 v174, v174, v247, vcc
v_mad_u32_u24 v134, v134, v54, v174
v_lshrrev_b32 v134, 20, v134
v_lshl_add_u32 v174, v134, 2, s11
ds_add_rtn_u32 v174, v174, v7
v_cmp_le_u32 vcc, 5436, v55
s_nop 1
v_cndmask_b32 v135, v240, v242, vcc
v_cndmask_b32 v175, v241, v243, vcc
v_cmp_le_u32 vcc, 6432, v55
s_nop 1
v_cndmask_b32 v135, v135, v244, vcc
v_cndmask_b32 v175, v175, v245, vcc
v_cmp_le_u32 vcc, 7344, v55
s_nop 1
v_cndmask_b32 v135, v135, v246, vcc
v_cndmask_b32 v175, v175, v247, vcc
v_mad_u32_u24 v135, v135, v55, v175
v_lshrrev_b32 v135, 20, v135
v_lshl_add_u32 v175, v135, 2, s11
ds_add_rtn_u32 v175, v175, v7
s_mov_b64 exec, -1
s_waitcnt vmcnt(9) lgkmcnt(15)
v_and_b32 v8, 0xff, v136
v_lshl_or_b32 v56, v16, 18, v56
v_lshlrev_b32 v8, 2, v8
v_lshl_add_u32 v8, v96, 10, v8
ds_write_b32 v8, v56
v_and_b32 v8, 0xff, v137
v_lshl_or_b32 v57, v17, 18, v57
v_lshlrev_b32 v8, 2, v8
v_lshl_add_u32 v8, v97, 10, v8
ds_write_b32 v8, v57
v_and_b32 v8, 0xff, v138
v_lshl_or_b32 v58, v18, 18, v58
v_lshlrev_b32 v8, 2, v8
v_lshl_add_u32 v8, v98, 10, v8
ds_write_b32 v8, v58
v_and_b32 v8, 0xff, v139
v_lshl_or_b32 v59, v19, 18, v59
v_lshlrev_b32 v8, 2, v8
v_lshl_add_u32 v8, v99, 10, v8
ds_write_b32 v8, v59
s_waitcnt vmcnt(8) lgkmcnt(15)
v_and_b32 v8, 0xff, v140
v_lshl_or_b32 v60, v20, 18, v60
v_lshlrev_b32 v8, 2, v8
v_lshl_add_u32 v8, v100, 10, v8
ds_write_b32 v8, v60
v_and_b32 v8, 0xff, v141
v_lshl_or_b32 v61, v21, 18, v61
v_lshlrev_b32 v8, 2, v8
v_lshl_add_u32 v8, v101, 10, v8
ds_write_b32 v8, v61
v_and_b32 v8, 0xff, v142
v_lshl_or_b32 v62, v22, 18, v62
v_lshlrev_b32 v8, 2, v8
v_lshl_add_u32 v8, v102, 10, v8
ds_write_b32 v8, v62
v_and_b32 v8, 0xff, v143
v_lshl_or_b32 v63, v23, 18, v63
v_lshlrev_b32 v8, 2, v8
v_lshl_add_u32 v8, v103, 10, v8
ds_write_b32 v8, v63
s_waitcnt vmcnt(7) lgkmcnt(15)
v_and_b32 v8, 0xff, v144
v_lshl_or_b32 v64, v24, 18, v64
v_lshlrev_b32 v8, 2, v8
v_lshl_add_u32 v8, v104, 10, v8
ds_write_b32 v8, v64
v_and_b32 v8, 0xff, v145
v_lshl_or_b32 v65, v25, 18, v65
v_lshlrev_b32 v8, 2, v8
v_lshl_add_u32 v8, v105, 10, v8
ds_write_b32 v8, v65
v_and_b32 v8, 0xff, v146
v_lshl_or_b32 v66, v26, 18, v66
v_lshlrev_b32 v8, 2, v8
v_lshl_add_u32 v8, v106, 10, v8
ds_write_b32 v8, v66
v_and_b32 v8, 0xff, v147
v_lshl_or_b32 v67, v27, 18, v67
v_lshlrev_b32 v8, 2, v8
v_lshl_add_u32 v8, v107, 10, v8
ds_write_b32 v8, v67
s_waitcnt vmcnt(6) lgkmcnt(15)
v_and_b32 v8, 0xff, v148
v_lshl_or_b32 v68, v28, 18, v68
v_lshlrev_b32 v8, 2, v8
v_lshl_add_u32 v8, v108, 10, v8
ds_write_b32 v8, v68
v_and_b32 v8, 0xff, v149
v_lshl_or_b32 v69, v29, 18, v69
v_lshlrev_b32 v8, 2, v8
v_lshl_add_u32 v8, v109, 10, v8
ds_write_b32 v8, v69
v_and_b32 v8, 0xff, v150
v_lshl_or_b32 v70, v30, 18, v70
v_lshlrev_b32 v8, 2, v8
v_lshl_add_u32 v8, v110, 10, v8
ds_write_b32 v8, v70
v_and_b32 v8, 0xff, v151
v_lshl_or_b32 v71, v31, 18, v71
v_lshlrev_b32 v8, 2, v8
v_lshl_add_u32 v8, v111, 10, v8
ds_write_b32 v8, v71
s_waitcnt vmcnt(5) lgkmcnt(15)
v_and_b32 v8, 0xff, v152
v_lshl_or_b32 v72, v32, 18, v72
v_lshlrev_b32 v8, 2, v8
v_lshl_add_u32 v8, v112, 10, v8
ds_write_b32 v8, v72
v_and_b32 v8, 0xff, v153
v_lshl_or_b32 v73, v33, 18, v73
v_lshlrev_b32 v8, 2, v8
v_lshl_add_u32 v8, v113, 10, v8
ds_write_b32 v8, v73
v_and_b32 v8, 0xff, v154
v_lshl_or_b32 v74, v34, 18, v74
v_lshlrev_b32 v8, 2, v8
v_lshl_add_u32 v8, v114, 10, v8
ds_write_b32 v8, v74
v_and_b32 v8, 0xff, v155
v_lshl_or_b32 v75, v35, 18, v75
v_lshlrev_b32 v8, 2, v8
v_lshl_add_u32 v8, v115, 10, v8
ds_write_b32 v8, v75
s_waitcnt vmcnt(4) lgkmcnt(15)
v_and_b32 v8, 0xff, v156
v_lshl_or_b32 v76, v36, 18, v76
v_lshlrev_b32 v8, 2, v8
v_lshl_add_u32 v8, v116, 10, v8
ds_write_b32 v8, v76
v_and_b32 v8, 0xff, v157
v_lshl_or_b32 v77, v37, 18, v77
v_lshlrev_b32 v8, 2, v8
v_lshl_add_u32 v8, v117, 10, v8
ds_write_b32 v8, v77
v_and_b32 v8, 0xff, v158
v_lshl_or_b32 v78, v38, 18, v78
v_lshlrev_b32 v8, 2, v8
v_lshl_add_u32 v8, v118, 10, v8
ds_write_b32 v8, v78
v_and_b32 v8, 0xff, v159
v_lshl_or_b32 v79, v39, 18, v79
v_lshlrev_b32 v8, 2, v8
v_lshl_add_u32 v8, v119, 10, v8
ds_write_b32 v8, v79
s_waitcnt vmcnt(3) lgkmcnt(15)
v_and_b32 v8, 0xff, v160
v_lshl_or_b32 v80, v40, 18, v80
v_lshlrev_b32 v8, 2, v8
v_lshl_add_u32 v8, v120, 10, v8
ds_write_b32 v8, v80
v_and_b32 v8, 0xff, v161
v_lshl_or_b32 v81, v41, 18, v81
v_lshlrev_b32 v8, 2, v8
v_lshl_add_u32 v8, v121, 10, v8
ds_write_b32 v8, v81
v_and_b32 v8, 0xff, v162
v_lshl_or_b32 v82, v42, 18, v82
v_lshlrev_b32 v8, 2, v8
v_lshl_add_u32 v8, v122, 10, v8
ds_write_b32 v8, v82
v_and_b32 v8, 0xff, v163
v_lshl_or_b32 v83, v43, 18, v83
v_lshlrev_b32 v8, 2, v8
v_lshl_add_u32 v8, v123, 10, v8
ds_write_b32 v8, v83
s_waitcnt vmcnt(2) lgkmcnt(15)
v_and_b32 v8, 0xff, v164
v_lshl_or_b32 v84, v44, 18, v84
v_lshlrev_b32 v8, 2, v8
v_lshl_add_u32 v8, v124, 10, v8
ds_write_b32 v8, v84
v_and_b32 v8, 0xff, v165
v_lshl_or_b32 v85, v45, 18, v85
v_lshlrev_b32 v8, 2, v8
v_lshl_add_u32 v8, v125, 10, v8
ds_write_b32 v8, v85
v_and_b32 v8, 0xff, v166
v_lshl_or_b32 v86, v46, 18, v86
v_lshlrev_b32 v8, 2, v8
v_lshl_add_u32 v8, v126, 10, v8
ds_write_b32 v8, v86
v_and_b32 v8, 0xff, v167
v_lshl_or_b32 v87, v47, 18, v87
v_lshlrev_b32 v8, 2, v8
v_lshl_add_u32 v8, v127, 10, v8
ds_write_b32 v8, v87
s_waitcnt vmcnt(1) lgkmcnt(15)
v_and_b32 v8, 0xff, v168
v_lshl_or_b32 v88, v48, 18, v88
v_lshlrev_b32 v8, 2, v8
v_lshl_add_u32 v8, v128, 10, v8
ds_write_b32 v8, v88
v_and_b32 v8, 0xff, v169
v_lshl_or_b32 v89, v49, 18, v89
v_lshlrev_b32 v8, 2, v8
v_lshl_add_u32 v8, v129, 10, v8
ds_write_b32 v8, v89
v_and_b32 v8, 0xff, v170
v_lshl_or_b32 v90, v50, 18, v90
v_lshlrev_b32 v8, 2, v8
v_lshl_add_u32 v8, v130, 10, v8
ds_write_b32 v8, v90
v_and_b32 v8, 0xff, v171
v_lshl_or_b32 v91, v51, 18, v91
v_lshlrev_b32 v8, 2, v8
v_lshl_add_u32 v8, v131, 10, v8
ds_write_b32 v8, v91
s_waitcnt vmcnt(0) lgkmcnt(15)
s_mov_b64 exec, s[12:13]
v_and_b32 v8, 0xff, v172
v_lshl_or_b32 v92, v52, 18, v92
v_lshlrev_b32 v8, 2, v8
v_lshl_add_u32 v8, v132, 10, v8
ds_write_b32 v8, v92
v_and_b32 v8, 0xff, v173
v_lshl_or_b32 v93, v53, 18, v93
v_lshlrev_b32 v8, 2, v8
v_lshl_add_u32 v8, v133, 10, v8
ds_write_b32 v8, v93
v_and_b32 v8, 0xff, v174
v_lshl_or_b32 v94, v54, 18, v94
v_lshlrev_b32 v8, 2, v8
v_lshl_add_u32 v8, v134, 10, v8
ds_write_b32 v8, v94
v_and_b32 v8, 0xff, v175
v_lshl_or_b32 v95, v55, 18, v95
v_lshlrev_b32 v8, 2, v8
v_lshl_add_u32 v8, v135, 10, v8
ds_write_b32 v8, v95
s_mov_b64 exec, -1
s_waitcnt lgkmcnt(0)
s_barrier
ds_read_b32 v8, v6
s_mul_i32 s6, s60, 16384
v_lshlrev_b32 v10, 4, v2
v_add_u32 v9, s6, v10
ds_read_b128 v[176:179], v9 offset:0
ds_read_b128 v[180:183], v9 offset:1024
ds_read_b128 v[184:187], v9 offset:2048
ds_read_b128 v[188:191], v9 offset:3072
ds_read_b128 v[192:195], v9 offset:4096
ds_read_b128 v[196:199], v9 offset:5120
ds_read_b128 v[200:203], v9 offset:6144
ds_read_b128 v[204:207], v9 offset:7168
ds_read_b128 v[208:211], v9 offset:8192
ds_read_b128 v[212:215], v9 offset:9216
ds_read_b128 v[216:219], v9 offset:10240
ds_read_b128 v[220:223], v9 offset:11264
ds_read_b128 v[224:227], v9 offset:12288
ds_read_b128 v[228:231], v9 offset:13312
ds_read_b128 v[232:235], v9 offset:14336
ds_read_b128 v[236:239], v9 offset:15360
s_mul_i32 s6, s60, 10485760
s_mul_i32 s7, s4, 40960
s_add_u32 s6, s6, s7
v_lshlrev_b32 v9, 6, v2
s_lshl_b32 s8, s4, 2
s_cmp_eq_u32 s60, 0
s_cselect_b32 s8, s8, 0x7fff0000
s_waitcnt lgkmcnt(15)
buffer_store_dword v8, v9, s[52:55], s8 offen sc1
v_cmp_lt_u32 vcc, 0x100, v8
s_cbranch_vccnz L1_eslow
s_waitcnt lgkmcnt(15)
buffer_store_dwordx4 v[176:179], v10, s[48:51], s6 offen sc1
s_add_u32 s6, s6, 655360
s_waitcnt lgkmcnt(14)
buffer_store_dwordx4 v[180:183], v10, s[48:51], s6 offen sc1
s_add_u32 s6, s6, 655360
s_waitcnt lgkmcnt(13)
buffer_store_dwordx4 v[184:187], v10, s[48:51], s6 offen sc1
s_add_u32 s6, s6, 655360
s_waitcnt lgkmcnt(12)
buffer_store_dwordx4 v[188:191], v10, s[48:51], s6 offen sc1
s_add_u32 s6, s6, 655360
s_waitcnt lgkmcnt(11)
buffer_store_dwordx4 v[192:195], v10, s[48:51], s6 offen sc1
s_add_u32 s6, s6, 655360
s_waitcnt lgkmcnt(10)
buffer_store_dwordx4 v[196:199], v10, s[48:51], s6 offen sc1
s_add_u32 s6, s6, 655360
s_waitcnt lgkmcnt(9)
buffer_store_dwordx4 v[200:203], v10, s[48:51], s6 offen sc1
s_add_u32 s6, s6, 655360
s_waitcnt lgkmcnt(8)
buffer_store_dwordx4 v[204:207], v10, s[48:51], s6 offen sc1
s_add_u32 s6, s6, 655360
s_waitcnt lgkmcnt(7)
buffer_store_dwordx4 v[208:211], v10, s[48:51], s6 offen sc1
s_add_u32 s6, s6, 655360
s_waitcnt lgkmcnt(6)
buffer_store_dwordx4 v[212:215], v10, s[48:51], s6 offen sc1
s_add_u32 s6, s6, 655360
s_waitcnt lgkmcnt(5)
buffer_store_dwordx4 v[216:219], v10, s[48:51], s6 offen sc1
s_add_u32 s6, s6, 655360
s_waitcnt lgkmcnt(4)
buffer_store_dwordx4 v[220:223], v10, s[48:51], s6 offen sc1
s_add_u32 s6, s6, 655360
s_waitcnt lgkmcnt(3)
buffer_store_dwordx4 v[224:227], v10, s[48:51], s6 offen sc1
s_add_u32 s6, s6, 655360
s_waitcnt lgkmcnt(2)
buffer_store_dwordx4 v[228:231], v10, s[48:51], s6 offen sc1
s_add_u32 s6, s6, 655360
s_waitcnt lgkmcnt(1)
buffer_store_dwordx4 v[232:235], v10, s[48:51], s6 offen sc1
s_add_u32 s6, s6, 655360
s_waitcnt lgkmcnt(0)
buffer_store_dwordx4 v[236:239], v10, s[48:51], s6 offen sc1
s_add_u32 s6, s6, 655360
s_branch L1_fin
L1_eslow:
s_mov_b32 s9, 655360
v_mul_u32_u24 v96, s9, v96
v_lshl_add_u32 v96, v136, 2, v96
v_mul_u32_u24 v97, s9, v97
v_lshl_add_u32 v97, v137, 2, v97
v_mul_u32_u24 v98, s9, v98
v_lshl_add_u32 v98, v138, 2, v98
v_mul_u32_u24 v99, s9, v99
v_lshl_add_u32 v99, v139, 2, v99
v_mul_u32_u24 v100, s9, v100
v_lshl_add_u32 v100, v140, 2, v100
v_mul_u32_u24 v101, s9, v101
v_lshl_add_u32 v101, v141, 2, v101
v_mul_u32_u24 v102, s9, v102
v_lshl_add_u32 v102, v142, 2, v102
v_mul_u32_u24 v103, s9, v103
v_lshl_add_u32 v103, v143, 2, v103
v_mul_u32_u24 v104, s9, v104
v_lshl_add_u32 v104, v144, 2, v104
v_mul_u32_u24 v105, s9, v105
v_lshl_add_u32 v105, v145, 2, v105
v_mul_u32_u24 v106, s9, v106
v_lshl_add_u32 v106, v146, 2, v106
v_mul_u32_u24 v107, s9, v107
v_lshl_add_u32 v107, v147, 2, v107
v_mul_u32_u24 v108, s9, v108
v_lshl_add_u32 v108, v148, 2, v108
v_mul_u32_u24 v109, s9, v109
v_lshl_add_u32 v109, v149, 2, v109
v_mul_u32_u24 v110, s9, v110
v_lshl_add_u32 v110, v150, 2, v110
v_mul_u32_u24 v111, s9, v111
v_lshl_add_u32 v111, v151, 2, v111
v_mul_u32_u24 v112, s9, v112
v_lshl_add_u32 v112, v152, 2, v112
v_mul_u32_u24 v113, s9, v113
v_lshl_add_u32 v113, v153, 2, v113
v_mul_u32_u24 v114, s9, v114
v_lshl_add_u32 v114, v154, 2, v114
v_mul_u32_u24 v115, s9, v115
v_lshl_add_u32 v115, v155, 2, v115
v_mul_u32_u24 v116, s9, v116
v_lshl_add_u32 v116, v156, 2, v116
v_mul_u32_u24 v117, s9, v117
v_lshl_add_u32 v117, v157, 2, v117
v_mul_u32_u24 v118, s9, v118
v_lshl_add_u32 v118, v158, 2, v118
v_mul_u32_u24 v119, s9, v119
v_lshl_add_u32 v119, v159, 2, v119
v_mul_u32_u24 v120, s9, v120
v_lshl_add_u32 v120, v160, 2, v120
v_mul_u32_u24 v121, s9, v121
v_lshl_add_u32 v121, v161, 2, v121
v_mul_u32_u24 v122, s9, v122
v_lshl_add_u32 v122, v162, 2, v122
v_mul_u32_u24 v123, s9, v123
v_lshl_add_u32 v123, v163, 2, v123
v_mul_u32_u24 v124, s9, v124
v_lshl_add_u32 v124, v164, 2, v124
v_mul_u32_u24 v125, s9, v125
v_lshl_add_u32 v125, v165, 2, v125
v_mul_u32_u24 v126, s9, v126
v_lshl_add_u32 v126, v166, 2, v126
v_mul_u32_u24 v127, s9, v127
v_lshl_add_u32 v127, v167, 2, v127
v_mul_u32_u24 v128, s9, v128
v_lshl_add_u32 v128, v168, 2, v128
v_mul_u32_u24 v129, s9, v129
v_lshl_add_u32 v129, v169, 2, v129
v_mul_u32_u24 v130, s9, v130
v_lshl_add_u32 v130, v170, 2, v130
v_mul_u32_u24 v131, s9, v131
v_lshl_add_u32 v131, v171, 2, v131
v_mul_u32_u24 v132, s9, v132
v_lshl_add_u32 v132, v172, 2, v132
v_mul_u32_u24 v133, s9, v133
v_lshl_add_u32 v133, v173, 2, v133
v_mul_u32_u24 v134, s9, v134
v_lshl_add_u32 v134, v174, 2, v134
v_mul_u32_u24 v135, s9, v135
v_lshl_add_u32 v135, v175, 2, v135
buffer_store_dword v56, v96, s[48:51], s7 offen sc1
buffer_store_dword v57, v97, s[48:51], s7 offen sc1
buffer_store_dword v58, v98, s[48:51], s7 offen sc1
buffer_store_dword v59, v99, s[48:51], s7 offen sc1
buffer_store_dword v60, v100, s[48:51], s7 offen sc1
buffer_store_dword v61, v101, s[48:51], s7 offen sc1
buffer_store_dword v62, v102, s[48:51], s7 offen sc1
buffer_store_dword v63, v103, s[48:51], s7 offen sc1
buffer_store_dword v64, v104, s[48:51], s7 offen sc1
buffer_store_dword v65, v105, s[48:51], s7 offen sc1
buffer_store_dword v66, v106, s[48:51], s7 offen sc1
buffer_store_dword v67, v107, s[48:51], s7 offen sc1
buffer_store_dword v68, v108, s[48:51], s7 offen sc1
buffer_store_dword v69, v109, s[48:51], s7 offen sc1
buffer_store_dword v70, v110, s[48:51], s7 offen sc1
buffer_store_dword v71, v111, s[48:51], s7 offen sc1
buffer_store_dword v72, v112, s[48:51], s7 offen sc1
buffer_store_dword v73, v113, s[48:51], s7 offen sc1
buffer_store_dword v74, v114, s[48:51], s7 offen sc1
buffer_store_dword v75, v115, s[48:51], s7 offen sc1
buffer_store_dword v76, v116, s[48:51], s7 offen sc1
buffer_store_dword v77, v117, s[48:51], s7 offen sc1
buffer_store_dword v78, v118, s[48:51], s7 offen sc1
buffer_store_dword v79, v119, s[48:51], s7 offen sc1
buffer_store_dword v80, v120, s[48:51], s7 offen sc1
buffer_store_dword v81, v121, s[48:51], s7 offen sc1
buffer_store_dword v82, v122, s[48:51], s7 offen sc1
buffer_store_dword v83, v123, s[48:51], s7 offen sc1
buffer_store_dword v84, v124, s[48:51], s7 offen sc1
buffer_store_dword v85, v125, s[48:51], s7 offen sc1
buffer_store_dword v86, v126, s[48:51], s7 offen sc1
buffer_store_dword v87, v127, s[48:51], s7 offen sc1
buffer_store_dword v88, v128, s[48:51], s7 offen sc1
buffer_store_dword v89, v129, s[48:51], s7 offen sc1
buffer_store_dword v90, v130, s[48:51], s7 offen sc1
buffer_store_dword v91, v131, s[48:51], s7 offen sc1
s_mov_b64 exec, s[12:13]
buffer_store_dword v92, v132, s[48:51], s7 offen sc1
buffer_store_dword v93, v133, s[48:51], s7 offen sc1
buffer_store_dword v94, v134, s[48:51], s7 offen sc1
buffer_store_dword v95, v135, s[48:51], s7 offen sc1
s_mov_b64 exec, -1
s_branch L1_fin
L2_entry:
s_load_dwordx2 s[4:5], s[0:1], 88
s_load_dwordx2 s[60:61], s[0:1], 0
s_load_dwordx2 s[52:53], s[0:1], 24
s_load_dwordx2 s[56:57], s[0:1], 72
s_and_b32 s35, s2, 7
s_lshr_b32 s37, s2, 3
s_add_u32 s37, s37, 30
s_and_b32 s37, s37, 31
v_lshrrev_b32 v1, 6, v0
s_mov_b32 s36, -1
v_readfirstlane_b32 s38, v1
s_cmp_lt_u32 s37, 30
s_cbranch_scc1 L2_att
s_lshl_b32 s39, s35, 1
s_add_u32 s39, s39, s37
s_sub_u32 s39, s39, 30
s_cmp_lt_u32 s38, 3
s_cbranch_scc1 LE_start
s_cmp_ge_u32 s39, 12
s_cbranch_scc1 L2_end
s_and_b32 s36, s39, 1
s_lshr_b32 s37, s39, 1
s_mov_b32 s38, 39
v_and_b32 v0, 63, v0
s_branch L2_att2
L2_att:
s_mul_i32 s38, s37, 26
s_lshr_b32 s38, s38, 8
s_mul_i32 s39, s38, 10
s_sub_u32 s39, s37, s39
s_and_b32 s37, s35, 1
s_mul_i32 s37, s37, 3
s_add_u32 s37, s37, s38
s_and_b32 s38, s35, 1
s_mul_i32 s38, s38, 5
s_add_u32 s35, s35, s38
s_and_b32 s35, s35, 7
s_lshr_b32 s38, s35, 1
s_mul_i32 s38, s38, 10
s_add_u32 s38, s38, s39
L2_att2:
v_lshrrev_b32 v1, 6, v0
v_and_b32 v243, 63, v0
v_lshlrev_b32 v243, 4, v243
v_readfirstlane_b32 s34, v1
s_mov_b32 s50, 0xe1a06800
s_mov_b32 s51, 0x4e20ad04
s_mul_i32 s39, s37, 9
s_lshr_b64 s[50:51], s[50:51], s39
s_and_b32 s39, s50, 0x1ff
s_bfe_u32 s49, s50, 0x90009
s_sub_u32 s31, s49, s39
s_sub_u32 s31, s31, 4
s_lshl_b32 s39, s39, 14
s_lshl_b32 s49, s49, 14
s_add_u32 s28, s39, 0x4000
s_cmp_eq_u32 s37, 5
s_addc_u32 s31, s31, 0
s_cmp_eq_u32 s37, 5
s_cselect_b32 s28, s39, s28
s_cselect_b32 s39, 5111808, s39
s_cselect_b32 s49, 5120000, s49
s_cselect_b32 s33, 0xff800000, 0
s_mov_b32 s32, 0x5d800000
v_and_b32 v2, 63, v0
v_bfe_u32 v3, v2, 3, 2
v_bfe_u32 v4, v2, 2, 1
v_lshlrev_b32 v241, 12, v3
v_lshl_or_b32 v241, v4, 9, v241
v_lshl_or_b32 v241, v1, 7, v241
v_lshrrev_b32 v4, 5, v2
v_lshl_or_b32 v241, v4, 6, v241
v_and_b32 v3, 2, v3
v_and_b32 v4, 3, v2
v_xor_b32 v3, v3, v4
v_lshl_or_b32 v241, v3, 4, v241
s_cmp_eq_u32 s38, 39
s_cbranch_scc1 LT_disp
s_cmp_lt_u32 s37, 3
s_cselect_b32 s101, 1, -1
s_cselect_b32 s39, 0, 103
s_cselect_b32 s3, 0, 3
s_sub_u32 s3, s37, s3
s_mul_i32 s3, s3, 104
s_add_u32 s39, s39, s3
s_cmp_eq_u32 s37, 5
s_addc_u32 s39, s39, 0
s_lshl_b32 s101, s101, 14
s_lshl_b32 s39, s39, 14
s_add_u32 s28, s39, s101
s_mov_b32 s49, 5120000
s_mov_b32 s31, 40
s_mov_b32 s100, 5
s_lshl_b32 s30, s34, 12
s_lshl_b32 s50, s34, 13
s_add_u32 s50, s50, 0x20000
s_mov_b32 m0, s30
s_mov_b32 s6, 0x92c51840
s_mov_b32 s7, 0xfb73ea6d
s_mul_i32 s3, s37, 12
s_min_u32 s3, s3, 56
s_lshr_b64 s[6:7], s[6:7], s3
s_bfe_u32 s29, s6, 0x40008
s_bfe_u32 s7, s6, 0x40004
s_and_b32 s6, s6, 15
s_cmp_lt_u32 s37, 4
s_cselect_b32 s29, s29, 16
s_mov_b32 s94, 0
s_mov_b32 s95, 0
s_lshr_b32 s3, s6, 2
s_cmp_eq_u32 s3, s34
s_cselect_b32 s94, s6, s94
s_cselect_b32 s95, 1, s95
s_lshr_b32 s3, s7, 2
s_cmp_eq_u32 s3, s34
s_cselect_b32 s94, s7, s94
s_cselect_b32 s95, 1, s95
s_lshr_b32 s3, s29, 2
s_cmp_eq_u32 s3, s34
s_cselect_b32 s94, s29, s94
s_cselect_b32 s95, 1, s95
s_and_b32 s94, s94, 3
s_lshl_b32 s3, s38, 17
s_lshl_b32 s51, s34, 7
s_add_u32 s3, s3, s51
s_lshl_b32 s6, s6, 13
s_add_u32 s6, s6, s3
s_lshl_b32 s7, s7, 13
s_add_u32 s7, s7, s3
s_lshl_b32 s29, s29, 13
s_add_u32 s29, s29, s3
s_mov_b64 s[96:97], 0
s_lshr_b32 s3, s6, 9
s_mul_i32 s40, s3, 6945
s_mov_b32 s41, s40
s_mul_i32 s40, s3, 6317
s_add_u32 s40, s40, 0x340674
s_cmp_lt_u32 s3, 5436
s_cselect_b32 s41, s41, s40
s_mul_i32 s40, s3, 6899
s_add_u32 s40, s40, 0xfffae6a0
s_cmp_lt_u32 s3, 6432
s_cselect_b32 s41, s41, s40
s_mul_i32 s40, s3, 6242
s_add_u32 s40, s40, 0x4484a0
s_cmp_lt_u32 s3, 7344
s_cselect_b32 s41, s41, s40
s_lshr_b32 s3, s41, 20
s_bitset1_b64 s[96:97], s3
s_lshr_b32 s3, s6, 9
s_add_u32 s3, s3, 15
s_mul_i32 s40, s3, 6945
s_mov_b32 s41, s40
s_mul_i32 s40, s3, 6317
s_add_u32 s40, s40, 0x340674
s_cmp_lt_u32 s3, 5436
s_cselect_b32 s41, s41, s40
s_mul_i32 s40, s3, 6899
s_add_u32 s40, s40, 0xfffae6a0
s_cmp_lt_u32 s3, 6432
s_cselect_b32 s41, s41, s40
s_mul_i32 s40, s3, 6242
s_add_u32 s40, s40, 0x4484a0
s_cmp_lt_u32 s3, 7344
s_cselect_b32 s41, s41, s40
s_lshr_b32 s3, s41, 20
s_bitset1_b64 s[96:97], s3
s_lshr_b32 s3, s7, 9
s_mul_i32 s40, s3, 6945
s_mov_b32 s41, s40
s_mul_i32 s40, s3, 6317
s_add_u32 s40, s40, 0x340674
s_cmp_lt_u32 s3, 5436
s_cselect_b32 s41, s41, s40
s_mul_i32 s40, s3, 6899
s_add_u32 s40, s40, 0xfffae6a0
s_cmp_lt_u32 s3, 6432
s_cselect_b32 s41, s41, s40
s_mul_i32 s40, s3, 6242
s_add_u32 s40, s40, 0x4484a0
s_cmp_lt_u32 s3, 7344
s_cselect_b32 s41, s41, s40
s_lshr_b32 s3, s41, 20
s_bitset1_b64 s[96:97], s3
s_lshr_b32 s3, s7, 9
s_add_u32 s3, s3, 15
s_mul_i32 s40, s3, 6945
s_mov_b32 s41, s40
s_mul_i32 s40, s3, 6317
s_add_u32 s40, s40, 0x340674
s_cmp_lt_u32 s3, 5436
s_cselect_b32 s41, s41, s40
s_mul_i32 s40, s3, 6899
s_add_u32 s40, s40, 0xfffae6a0
s_cmp_lt_u32 s3, 6432
s_cselect_b32 s41, s41, s40
s_mul_i32 s40, s3, 6242
s_add_u32 s40, s40, 0x4484a0
s_cmp_lt_u32 s3, 7344
s_cselect_b32 s41, s41, s40
s_lshr_b32 s3, s41, 20
s_bitset1_b64 s[96:97], s3
s_lshr_b32 s3, s29, 9
s_mul_i32 s40, s3, 6945
s_mov_b32 s41, s40
s_mul_i32 s40, s3, 6317
s_add_u32 s40, s40, 0x340674
s_cmp_lt_u32 s3, 5436
s_cselect_b32 s41, s41, s40
s_mul_i32 s40, s3, 6899
s_add_u32 s40, s40, 0xfffae6a0
s_cmp_lt_u32 s3, 6432
s_cselect_b32 s41, s41, s40
s_mul_i32 s40, s3, 6242
s_add_u32 s40, s40, 0x4484a0
s_cmp_lt_u32 s3, 7344
s_cselect_b32 s41, s41, s40
s_lshr_b32 s3, s41, 20
s_bitset1_b64 s[96:97], s3
s_lshr_b32 s3, s29, 9
s_add_u32 s3, s3, 15
s_mul_i32 s40, s3, 6945
s_mov_b32 s41, s40
s_mul_i32 s40, s3, 6317
s_add_u32 s40, s40, 0x340674
s_cmp_lt_u32 s3, 5436
s_cselect_b32 s41, s41, s40
s_mul_i32 s40, s3, 6899
s_add_u32 s40, s40, 0xfffae6a0
s_cmp_lt_u32 s3, 6432
s_cselect_b32 s41, s41, s40
s_mul_i32 s40, s3, 6242
s_add_u32 s40, s40, 0x4484a0
s_cmp_lt_u32 s3, 7344
s_cselect_b32 s41, s41, s40
s_lshr_b32 s3, s41, 20
s_bitset1_b64 s[96:97], s3
s_mul_i32 s3, s38, 6
s_add_u32 s3, s3, s37
s_cmp_eq_u32 s3, 233
s_cselect_b32 s3, 0, s37
s_cmp_lt_u32 s3, 4
s_cselect_b32 s29, s29, 0x70000000
s_lshl_b32 s51, s38, 5
s_lshl_b32 s3, s34, 3
s_add_u32 s51, s51, s3
s_add_u32 s51, s51, s37
s_mul_i32 s51, s51, 128
s_add_u32 s51, s51, 0x7c00000
s_lshr_b32 s40, s39, 17
s_min_u32 s40, s40, 38
s_lshr_b32 s41, s28, 17
s_add_u32 s3, s28, s101
s_lshr_b32 s3, s3, 17
v_mov_b32 v5, s38
v_mov_b32 v6, s40
v_cmp_lt_u32 vcc, 0x7f, v243
s_nop 1
v_cndmask_b32 v5, v5, v6, vcc
v_mov_b32 v6, s41
v_cmp_lt_u32 vcc, 0xff, v243
s_nop 1
v_cndmask_b32 v5, v5, v6, vcc
v_mov_b32 v6, s3
v_cmp_lt_u32 vcc, 0x17f, v243
s_nop 1
v_cndmask_b32 v5, v5, v6, vcc
v_bfe_u32 v6, v243, 4, 3
v_min_u32 v6, 5, v6
v_mad_u32_u24 v5, v5, 6, v6
v_lshlrev_b32 v5, 7, v5
v_add_u32 v5, 0x7c2a000, v5
s_mul_i32 s3, s101, 54
s_add_u32 s3, s3, s39
s_min_u32 s41, s3, s39
s_max_u32 s3, s3, s39
s_lshr_b32 s41, s41, 17
s_min_u32 s40, s40, s41
s_mul_i32 s40, s40, 6
s_lshr_b32 s3, s3, 17
s_min_u32 s3, s3, 38
s_mul_i32 s3, s3, 6
s_add_u32 s3, s3, 5
v_lshrrev_b32 v230, 4, v243
v_add_u32 v230, s40, v230
v_min_u32 v230, s3, v230
v_lshlrev_b32 v230, 7, v230
v_add_u32 v230, 0x7c2a000, v230
s_waitcnt lgkmcnt(0)
s_add_u32 s12, s4, 0x6800000
s_addc_u32 s13, s5, 0
s_mov_b32 s14, 0x0
s_mov_b32 s15, 0x00020000
s_mov_b32 s14, s49
s_add_u32 s8, s4, 0x0
s_addc_u32 s9, s5, 0
s_mov_b32 s10, 0x4e4000
s_mov_b32 s11, 0x00020000
s_mul_i32 s35, s37, 0x600000
s_add_u32 s20, s4, 0x2000000
s_addc_u32 s21, s5, 0
s_add_u32 s20, s20, s35
s_addc_u32 s21, s21, 0
s_mov_b32 s22, 0x4e4000
s_mov_b32 s23, 0x00020000
s_add_u32 s24, s4, 0x6000000
s_addc_u32 s25, s5, 0
s_mov_b32 s26, 0x139000
s_mov_b32 s27, 0x00020000
s_lshl_b32 s35, s38, 4
s_lshl_b32 s41, s34, 2
s_add_u32 s35, s35, s41
s_lshl_b32 s40, s35, 13
s_lshl_b32 s94, s94, 13
s_add_u32 s40, s40, s94
s_xor_b32 s41, s40, 8192
s_xor_b32 s42, s40, 16384
s_xor_b32 s43, s40, 24576
s_add_u32 s44, s40, 4096
s_add_u32 s45, s41, 4096
s_add_u32 s46, s42, 4096
s_add_u32 s47, s43, 4096
s_lshl_b32 s48, s35, 10
s_lshl_b32 s35, s37, 3
s_add_u32 s48, s48, s35
v_mov_b32 v232, 0
v_mov_b32 v233, 0
v_mov_b32 v234, 0
v_mov_b32 v235, 0
v_bfe_u32 v240, v243, 4, 3
v_lshlrev_b32 v240, 6, v240
v_bfe_u32 v242, v243, 7, 1
v_lshl_or_b32 v240, v242, 10, v240
v_bfe_u32 v242, v243, 8, 2
v_lshl_or_b32 v240, v242, 4, v240
v_bfe_u32 v242, v243, 6, 1
v_lshlrev_b32 v242, 5, v242
v_xor_b32 v240, v240, v242
v_and_b32 v246, 0x1c0, v243
v_bfe_u32 v242, v243, 9, 1
v_lshl_or_b32 v246, v242, 10, v246
v_bfe_u32 v242, v243, 8, 1
v_lshl_or_b32 v246, v242, 5, v246
v_bfe_u32 v242, v243, 4, 2
v_lshl_or_b32 v246, v242, 3, v246
v_xor_b32 v247, 32, v246
v_bfe_i32 v242, v243, 8, 1
v_and_b32 v192, s33, v242
v_and_b32 v193, s33, v242
v_and_b32 v194, s33, v242
v_and_b32 v195, s33, v242
v_mfma_f32_32x32x16_bf16 a[0:15], v[232:235], v[232:235], 0
v_mfma_f32_32x32x16_bf16 a[16:31], v[232:235], v[232:235], 0
v_mfma_f32_32x32x16_bf16 a[32:47], v[232:235], v[232:235], 0
v_mfma_f32_32x32x16_bf16 a[48:63], v[232:235], v[232:235], 0
v_mfma_f32_32x32x16_bf16 a[64:79], v[232:235], v[232:235], 0
v_mfma_f32_32x32x16_bf16 a[80:95], v[232:235], v[232:235], 0
v_mfma_f32_32x32x16_bf16 a[96:111], v[232:235], v[232:235], 0
v_mfma_f32_32x32x16_bf16 a[112:127], v[232:235], v[232:235], 0
v_mfma_f32_32x32x16_bf16 a[128:143], v[232:235], v[232:235], 0
v_mfma_f32_32x32x16_bf16 a[144:159], v[232:235], v[232:235], 0
v_mfma_f32_32x32x16_bf16 a[160:175], v[232:235], v[232:235], 0
v_mfma_f32_32x32x16_bf16 a[176:191], v[232:235], v[232:235], 0
v_mfma_f32_32x32x16_bf16 a[192:207], v[232:235], v[232:235], 0
v_mfma_f32_32x32x16_bf16 a[208:223], v[232:235], v[232:235], 0
v_mfma_f32_32x32x16_bf16 a[224:239], v[232:235], v[232:235], 0
v_mfma_f32_32x32x16_bf16 a[240:255], v[232:235], v[232:235], 0
s_add_u32 s16, s4, 0x0
s_addc_u32 s17, s5, 0
s_mov_b32 s18, 0x10000000
s_mov_b32 s19, 0x00020000
s_mov_b32 s3, 0x10000
LM_pa:
buffer_load_dwordx2 v[6:7], v5, s[16:19], 0 offen sc1
s_sub_u32 s3, s3, 1
s_waitcnt vmcnt(0)
s_cbranch_scc1 LM_pa_go
v_cmp_ne_u64 vcc, s[98:99], v[6:7]
s_nop 1
s_cbranch_vccnz LM_pa
LM_pa_go:
buffer_load_dwordx4 v241, s[12:15], s39 offen offset:0 sc1 lds
buffer_load_dwordx4 v241, s[12:15], s39 offen offset:1024 sc1 lds
buffer_load_dwordx4 v241, s[12:15], s39 offen offset:2048 sc1 lds
buffer_load_dwordx4 v241, s[12:15], s39 offen offset:3072 sc1 lds
s_add_u32 m0, s30, 0x4000
s_nop 0
buffer_load_dwordx4 v241, s[12:15], s28 offen offset:0 sc1 lds
buffer_load_dwordx4 v241, s[12:15], s28 offen offset:1024 sc1 lds
buffer_load_dwordx4 v[0:3], v243, s[8:11], s40 offen offset:0 sc1
buffer_load_dwordx4 v[32:35], v243, s[8:11], s41 offen offset:0 sc1
buffer_load_dwordx4 v[64:67], v243, s[8:11], s42 offen offset:0 sc1
buffer_load_dwordx4 v[96:99], v243, s[8:11], s43 offen offset:0 sc1
buffer_load_dwordx4 v[4:7], v243, s[8:11], s40 offen offset:1024 sc1
buffer_load_dwordx4 v[36:39], v243, s[8:11], s41 offen offset:1024 sc1
buffer_load_dwordx4 v[68:71], v243, s[8:11], s42 offen offset:1024 sc1
buffer_load_dwordx4 v[100:103], v243, s[8:11], s43 offen offset:1024 sc1
buffer_load_dwordx4 v[8:11], v243, s[8:11], s40 offen offset:2048 sc1
buffer_load_dwordx4 v[40:43], v243, s[8:11], s41 offen offset:2048 sc1
buffer_load_dwordx4 v[72:75], v243, s[8:11], s42 offen offset:2048 sc1
buffer_load_dwordx4 v[104:107], v243, s[8:11], s43 offen offset:2048 sc1
buffer_load_dwordx4 v[12:15], v243, s[8:11], s40 offen offset:3072 sc1
buffer_load_dwordx4 v[44:47], v243, s[8:11], s41 offen offset:3072 sc1
buffer_load_dwordx4 v[76:79], v243, s[8:11], s42 offen offset:3072 sc1
buffer_load_dwordx4 v[108:111], v243, s[8:11], s43 offen offset:3072 sc1
buffer_load_dwordx4 v[16:19], v243, s[8:11], s44 offen offset:0 sc1
buffer_load_dwordx4 v[48:51], v243, s[8:11], s45 offen offset:0 sc1
buffer_load_dwordx4 v[80:83], v243, s[8:11], s46 offen offset:0 sc1
buffer_load_dwordx4 v[112:115], v243, s[8:11], s47 offen offset:0 sc1
buffer_load_dwordx2 v[228:229], v230, s[16:19], 0 offen sc1
s_waitcnt vmcnt(21)
s_barrier
ds_read_b128 v[208:211], v240 offset:0
ds_read_b128 v[212:215], v240 offset:2048
ds_read_b128 v[216:219], v240 offset:16384
ds_read_b128 v[220:223], v240 offset:512
s_waitcnt lgkmcnt(3)
s_waitcnt vmcnt(17)
v_mfma_f32_16x16x32_bf16 v[128:131], v[208:211], v[0:3], v[192:195]
buffer_load_dwordx4 v[20:23], v243, s[8:11], s44 offen offset:1024 sc1
v_mfma_f32_16x16x32_bf16 v[132:135], v[208:211], v[32:35], v[192:195]
v_mfma_f32_16x16x32_bf16 v[136:139], v[208:211], v[64:67], v[192:195]
v_mfma_f32_16x16x32_bf16 v[140:143], v[208:211], v[96:99], v[192:195]
ds_read_b128 v[208:211], v240 offset:2560
s_waitcnt lgkmcnt(3)
buffer_load_dwordx4 v[52:55], v243, s[8:11], s45 offen offset:1024 sc1
v_mfma_f32_16x16x32_bf16 v[144:147], v[212:215], v[0:3], v[192:195]
v_mfma_f32_16x16x32_bf16 v[148:151], v[212:215], v[32:35], v[192:195]
v_mfma_f32_16x16x32_bf16 v[152:155], v[212:215], v[64:67], v[192:195]
buffer_load_dwordx4 v[84:87], v243, s[8:11], s46 offen offset:1024 sc1
v_mfma_f32_16x16x32_bf16 v[156:159], v[212:215], v[96:99], v[192:195]
ds_read_b128 v[212:215], v240 offset:16896
s_waitcnt lgkmcnt(3)
v_mfma_f32_16x16x32_bf16 v[176:179], v[216:219], v[0:3], 0
v_mfma_f32_16x16x32_bf16 v[180:183], v[216:219], v[32:35], 0
buffer_load_dwordx4 v[116:119], v243, s[8:11], s47 offen offset:1024 sc1
v_mfma_f32_16x16x32_bf16 v[184:187], v[216:219], v[64:67], 0
v_mfma_f32_16x16x32_bf16 v[188:191], v[216:219], v[96:99], 0
ds_read_b128 v[216:219], v240 offset:4096
s_waitcnt lgkmcnt(3)
s_waitcnt vmcnt(17)
v_mfma_f32_16x16x32_bf16 v[128:131], v[220:223], v[4:7], v[128:131]
buffer_load_dwordx4 v[24:27], v243, s[8:11], s44 offen offset:2048 sc1
v_mfma_f32_16x16x32_bf16 v[132:135], v[220:223], v[36:39], v[132:135]
v_mfma_f32_16x16x32_bf16 v[136:139], v[220:223], v[68:71], v[136:139]
v_mfma_f32_16x16x32_bf16 v[140:143], v[220:223], v[100:103], v[140:143]
ds_read_b128 v[220:223], v240 offset:6144
s_waitcnt lgkmcnt(3)
buffer_load_dwordx4 v[56:59], v243, s[8:11], s45 offen offset:2048 sc1
v_mfma_f32_16x16x32_bf16 v[144:147], v[208:211], v[4:7], v[144:147]
v_mfma_f32_16x16x32_bf16 v[148:151], v[208:211], v[36:39], v[148:151]
v_mfma_f32_16x16x32_bf16 v[152:155], v[208:211], v[68:71], v[152:155]
buffer_load_dwordx4 v[88:91], v243, s[8:11], s46 offen offset:2048 sc1
v_mfma_f32_16x16x32_bf16 v[156:159], v[208:211], v[100:103], v[156:159]
ds_read_b128 v[208:211], v240 offset:20480
s_waitcnt lgkmcnt(3)
v_mfma_f32_16x16x32_bf16 v[176:179], v[212:215], v[4:7], v[176:179]
v_mfma_f32_16x16x32_bf16 v[180:183], v[212:215], v[36:39], v[180:183]
buffer_load_dwordx4 v[120:123], v243, s[8:11], s47 offen offset:2048 sc1
v_mfma_f32_16x16x32_bf16 v[184:187], v[212:215], v[68:71], v[184:187]
v_mfma_f32_16x16x32_bf16 v[188:191], v[212:215], v[100:103], v[188:191]
ds_read_b128 v[212:215], v240 offset:4608
s_waitcnt lgkmcnt(3)
s_waitcnt vmcnt(17)
v_mfma_f32_16x16x32_bf16 v[128:131], v[216:219], v[8:11], v[128:131]
buffer_load_dwordx4 v[28:31], v243, s[8:11], s44 offen offset:3072 sc1
v_mfma_f32_16x16x32_bf16 v[132:135], v[216:219], v[40:43], v[132:135]
v_mfma_f32_16x16x32_bf16 v[136:139], v[216:219], v[72:75], v[136:139]
v_mfma_f32_16x16x32_bf16 v[140:143], v[216:219], v[104:107], v[140:143]
ds_read_b128 v[216:219], v240 offset:6656
s_waitcnt lgkmcnt(3)
buffer_load_dwordx4 v[60:63], v243, s[8:11], s45 offen offset:3072 sc1
v_mfma_f32_16x16x32_bf16 v[144:147], v[220:223], v[8:11], v[144:147]
v_mfma_f32_16x16x32_bf16 v[148:151], v[220:223], v[40:43], v[148:151]
v_mfma_f32_16x16x32_bf16 v[152:155], v[220:223], v[72:75], v[152:155]
buffer_load_dwordx4 v[92:95], v243, s[8:11], s46 offen offset:3072 sc1
v_mfma_f32_16x16x32_bf16 v[156:159], v[220:223], v[104:107], v[156:159]
ds_read_b128 v[220:223], v240 offset:20992
s_waitcnt lgkmcnt(3)
v_mfma_f32_16x16x32_bf16 v[176:179], v[208:211], v[8:11], v[176:179]
v_mfma_f32_16x16x32_bf16 v[180:183], v[208:211], v[40:43], v[180:183]
buffer_load_dwordx4 v[124:127], v243, s[8:11], s47 offen offset:3072 sc1
v_mfma_f32_16x16x32_bf16 v[184:187], v[208:211], v[72:75], v[184:187]
v_mfma_f32_16x16x32_bf16 v[188:191], v[208:211], v[104:107], v[188:191]
ds_read_b128 v[208:211], v240 offset:8192
s_waitcnt lgkmcnt(3)
s_waitcnt vmcnt(17)
v_mfma_f32_16x16x32_bf16 v[128:131], v[212:215], v[12:15], v[128:131]
s_add_u32 s16, s4, 0x0
s_addc_u32 s17, s5, 0
s_mov_b32 s18, 0x10000000
v_mfma_f32_16x16x32_bf16 v[132:135], v[212:215], v[44:47], v[132:135]
buffer_load_dwordx4 v241, s[12:15], s28 offen offset:2048 sc1 lds
s_mov_b32 s19, 0x00020000
s_add_u32 s8, s60, 0x0
v_mfma_f32_16x16x32_bf16 v[136:139], v[212:215], v[76:79], v[136:139]
s_addc_u32 s9, s61, 0
s_mov_b32 s10, 0x4e2000
s_mov_b32 s11, 0x00020000
v_mfma_f32_16x16x32_bf16 v[140:143], v[212:215], v[108:111], v[140:143]
ds_read_b128 v[212:215], v240 offset:10240
s_waitcnt lgkmcnt(3)
buffer_load_dwordx4 v241, s[12:15], s28 offen offset:3072 sc1 lds
v_mfma_f32_16x16x32_bf16 v[144:147], v[216:219], v[12:15], v[144:147]
s_mov_b32 s54, 0x4e20
s_mov_b32 s55, 0x00020000
s_mov_b32 s58, 0x4e2000
v_mfma_f32_16x16x32_bf16 v[148:151], v[216:219], v[44:47], v[148:151]
s_mov_b32 s59, 0x00020000
s_lshr_b32 s48, s40, 2
s_cmp_eq_u32 s95, 1
v_mfma_f32_16x16x32_bf16 v[152:155], v[216:219], v[76:79], v[152:155]
s_cselect_b32 s40, 0x70000000, s40
s_cselect_b32 s44, 0x70000000, s44
s_cmp_lt_u32 s37, 3
v_mfma_f32_16x16x32_bf16 v[156:159], v[216:219], v[108:111], v[156:159]
ds_read_b128 v[216:219], v240 offset:24576
s_waitcnt lgkmcnt(3)
s_cselect_b32 s3, 0, 3
v_mfma_f32_16x16x32_bf16 v[176:179], v[220:223], v[12:15], v[176:179]
s_cselect_b32 s94, 0, 8
s_sub_u32 s3, s37, s3
s_lshl_b32 s38, s38, 2
v_mfma_f32_16x16x32_bf16 v[180:183], v[220:223], v[44:47], v[180:183]
s_add_u32 s38, s38, s3
s_lshl_b32 s38, s38, 10
s_add_u32 s38, s38, 0x7c00300
v_mfma_f32_16x16x32_bf16 v[184:187], v[220:223], v[76:79], v[184:187]
s_add_u32 s94, s94, s38
s_xor_b32 s95, s94, 8
s_add_u32 s49, s95, 32
v_mfma_f32_16x16x32_bf16 v[188:191], v[220:223], v[108:111], v[188:191]
ds_read_b128 v[220:223], v240 offset:8704
s_waitcnt lgkmcnt(3)
s_waitcnt vmcnt(15)
v_mfma_f32_16x16x32_bf16 v[128:131], v[208:211], v[16:19], v[128:131]
s_cmp_eq_u32 s3, 2
s_cselect_b32 s35, s38, s94
s_cselect_b32 s49, s49, s95
v_mfma_f32_16x16x32_bf16 v[132:135], v[208:211], v[48:51], v[132:135]
s_add_u32 s28, s28, s101
s_add_u32 m0, s30, 0x8000
s_nop 0
s_mov_b32 s39, 4
v_mfma_f32_16x16x32_bf16 v[136:139], v[208:211], v[80:83], v[136:139]
v_mfma_f32_16x16x32_bf16 v[140:143], v[208:211], v[112:115], v[140:143]
ds_read_b128 v[208:211], v240 offset:10752
s_waitcnt lgkmcnt(3)
buffer_load_dwordx4 v241, s[12:15], s28 offen offset:0 sc1 lds
v_mfma_f32_16x16x32_bf16 v[144:147], v[212:215], v[16:19], v[144:147]
v_mfma_f32_16x16x32_bf16 v[148:151], v[212:215], v[48:51], v[148:151]
buffer_load_dwordx4 v241, s[12:15], s28 offen offset:1024 sc1 lds
v_mfma_f32_16x16x32_bf16 v[152:155], v[212:215], v[80:83], v[152:155]
v_mfma_f32_16x16x32_bf16 v[156:159], v[212:215], v[112:115], v[156:159]
ds_read_b128 v[212:215], v240 offset:25088
s_waitcnt lgkmcnt(3)
v_mfma_f32_16x16x32_bf16 v[176:179], v[216:219], v[16:19], v[176:179]
v_mfma_f32_16x16x32_bf16 v[180:183], v[216:219], v[48:51], v[180:183]
v_mfma_f32_16x16x32_bf16 v[184:187], v[216:219], v[80:83], v[184:187]
v_mfma_f32_16x16x32_bf16 v[188:191], v[216:219], v[112:115], v[188:191]
ds_read_b128 v[216:219], v240 offset:12288
s_waitcnt lgkmcnt(3)
s_waitcnt vmcnt(12)
v_mfma_f32_16x16x32_bf16 v[128:131], v[220:223], v[20:23], v[128:131]
v_mfma_f32_16x16x32_bf16 v[132:135], v[220:223], v[52:55], v[132:135]
buffer_load_dwordx4 v241, s[12:15], s28 offen offset:2048 sc1 lds
v_mfma_f32_16x16x32_bf16 v[136:139], v[220:223], v[84:87], v[136:139]
v_mfma_f32_16x16x32_bf16 v[140:143], v[220:223], v[116:119], v[140:143]
ds_read_b128 v[220:223], v240 offset:14336
s_waitcnt lgkmcnt(3)
buffer_load_dwordx4 v241, s[12:15], s28 offen offset:3072 sc1 lds
v_mfma_f32_16x16x32_bf16 v[144:147], v[208:211], v[20:23], v[144:147]
v_mfma_f32_16x16x32_bf16 v[148:151], v[208:211], v[52:55], v[148:151]
v_mfma_f32_16x16x32_bf16 v[152:155], v[208:211], v[84:87], v[152:155]
v_mfma_f32_16x16x32_bf16 v[156:159], v[208:211], v[116:119], v[156:159]
ds_read_b128 v[208:211], v240 offset:28672
s_waitcnt lgkmcnt(3)
v_mfma_f32_16x16x32_bf16 v[176:179], v[212:215], v[20:23], v[176:179]
v_mfma_f32_16x16x32_bf16 v[180:183], v[212:215], v[52:55], v[180:183]
v_mfma_f32_16x16x32_bf16 v[184:187], v[212:215], v[84:87], v[184:187]
v_mfma_f32_16x16x32_bf16 v[188:191], v[212:215], v[116:119], v[188:191]
ds_read_b128 v[212:215], v240 offset:12800
s_waitcnt lgkmcnt(3)
s_waitcnt vmcnt(10)
v_mfma_f32_16x16x32_bf16 v[128:131], v[216:219], v[24:27], v[128:131]
v_mfma_f32_16x16x32_bf16 v[132:135], v[216:219], v[56:59], v[132:135]
s_add_u32 s28, s28, s101
s_add_u32 s30, s30, 0xc000
v_mfma_f32_16x16x32_bf16 v[136:139], v[216:219], v[88:91], v[136:139]
v_mfma_f32_16x16x32_bf16 v[140:143], v[216:219], v[120:123], v[140:143]
ds_read_b128 v[216:219], v240 offset:14848
s_waitcnt lgkmcnt(3)
v_mfma_f32_16x16x32_bf16 v[144:147], v[220:223], v[24:27], v[144:147]
v_mfma_f32_16x16x32_bf16 v[148:151], v[220:223], v[56:59], v[148:151]
v_mfma_f32_16x16x32_bf16 v[152:155], v[220:223], v[88:91], v[152:155]
v_mfma_f32_16x16x32_bf16 v[156:159], v[220:223], v[120:123], v[156:159]
ds_read_b128 v[220:223], v240 offset:29184
s_waitcnt lgkmcnt(3)
v_mfma_f32_16x16x32_bf16 v[176:179], v[208:211], v[24:27], v[176:179]
v_mfma_f32_16x16x32_bf16 v[180:183], v[208:211], v[56:59], v[180:183]
v_mfma_f32_16x16x32_bf16 v[184:187], v[208:211], v[88:91], v[184:187]
v_mfma_f32_16x16x32_bf16 v[188:191], v[208:211], v[120:123], v[188:191]
s_waitcnt lgkmcnt(2)
s_waitcnt vmcnt(6)
v_mfma_f32_16x16x32_bf16 v[128:131], v[212:215], v[28:31], v[128:131]
v_mfma_f32_16x16x32_bf16 v[132:135], v[212:215], v[60:63], v[132:135]
v_mfma_f32_16x16x32_bf16 v[136:139], v[212:215], v[92:95], v[136:139]
v_mfma_f32_16x16x32_bf16 v[140:143], v[212:215], v[124:127], v[140:143]
s_waitcnt lgkmcnt(1)
v_mfma_f32_16x16x32_bf16 v[144:147], v[216:219], v[28:31], v[144:147]
v_mfma_f32_16x16x32_bf16 v[148:151], v[216:219], v[60:63], v[148:151]
v_mfma_f32_16x16x32_bf16 v[152:155], v[216:219], v[92:95], v[152:155]
v_mfma_f32_16x16x32_bf16 v[156:159], v[216:219], v[124:127], v[156:159]
s_waitcnt lgkmcnt(0)
v_mfma_f32_16x16x32_bf16 v[176:179], v[220:223], v[28:31], v[176:179]
v_mfma_f32_16x16x32_bf16 v[180:183], v[220:223], v[60:63], v[180:183]
v_mfma_f32_16x16x32_bf16 v[184:187], v[220:223], v[92:95], v[184:187]
v_mfma_f32_16x16x32_bf16 v[188:191], v[220:223], v[124:127], v[188:191]
v_max3_f32 v248, v128, v129, v130
v_max3_f32 v249, v132, v133, v134
v_max3_f32 v250, v136, v137, v138
v_max3_f32 v251, v140, v141, v142
v_max3_f32 v248, v248, v131, v144
v_max3_f32 v249, v249, v135, v148
v_max3_f32 v250, v250, v139, v152
v_max3_f32 v251, v251, v143, v156
v_max3_f32 v248, v248, v145, v146
v_max3_f32 v249, v249, v149, v150
v_max3_f32 v250, v250, v153, v154
v_max3_f32 v251, v251, v157, v158
v_max_f32 v248, v248, v147
v_max_f32 v249, v249, v151
v_max_f32 v250, v250, v155
v_max_f32 v251, v251, v159
v_mov_b32 v232, v248
v_mov_b32 v233, v249
v_mov_b32 v234, v250
v_mov_b32 v235, v251
v_permlane32_swap_b32 v248, v232
v_permlane32_swap_b32 v249, v233
v_permlane32_swap_b32 v250, v234
v_permlane32_swap_b32 v251, v235
v_max_f32 v248, v248, v232
v_max_f32 v249, v249, v233
v_max_f32 v250, v250, v234
v_max_f32 v251, v251, v235
v_mov_b32 v232, v248
v_mov_b32 v233, v249
v_mov_b32 v234, v250
v_mov_b32 v235, v251
v_permlane16_swap_b32 v248, v232
v_permlane16_swap_b32 v249, v233
v_permlane16_swap_b32 v250, v234
v_permlane16_swap_b32 v251, v235
v_max_f32 v248, v248, v232
v_max_f32 v249, v249, v233
v_max_f32 v250, v250, v234
v_max_f32 v251, v251, v235
v_ceil_f32 v248, v248
v_ceil_f32 v249, v249
v_ceil_f32 v250, v250
v_ceil_f32 v251, v251
v_sub_f32 v128, v128, v248
v_sub_f32 v129, v129, v248
v_sub_f32 v130, v130, v248
v_sub_f32 v131, v131, v248
v_exp_f32 v128, v128
v_exp_f32 v129, v129
v_exp_f32 v130, v130
v_exp_f32 v131, v131
v_sub_f32 v192, 0, v248
v_sub_f32 v193, 0, v248
v_sub_f32 v194, 0, v248
v_sub_f32 v195, 0, v248
v_sub_f32 v132, v132, v249
v_sub_f32 v133, v133, v249
v_sub_f32 v134, v134, v249
v_sub_f32 v135, v135, v249
v_exp_f32 v132, v132
v_exp_f32 v133, v133
v_exp_f32 v134, v134
v_exp_f32 v135, v135
v_sub_f32 v196, 0, v249
v_sub_f32 v197, 0, v249
v_sub_f32 v198, 0, v249
v_sub_f32 v199, 0, v249
v_sub_f32 v136, v136, v250
v_sub_f32 v137, v137, v250
v_sub_f32 v138, v138, v250
v_sub_f32 v139, v139, v250
v_exp_f32 v136, v136
v_exp_f32 v137, v137
v_exp_f32 v138, v138
v_exp_f32 v139, v139
v_sub_f32 v200, 0, v250
v_sub_f32 v201, 0, v250
v_sub_f32 v202, 0, v250
v_sub_f32 v203, 0, v250
v_sub_f32 v140, v140, v251
v_sub_f32 v141, v141, v251
v_sub_f32 v142, v142, v251
v_sub_f32 v143, v143, v251
v_exp_f32 v140, v140
v_exp_f32 v141, v141
v_exp_f32 v142, v142
v_exp_f32 v143, v143
v_sub_f32 v204, 0, v251
v_sub_f32 v205, 0, v251
v_sub_f32 v206, 0, v251
v_sub_f32 v207, 0, v251
s_waitcnt vmcnt(4)
s_barrier
ds_read_b128 v[208:211], v240 offset:18432
ds_read_b128 v[212:215], v240 offset:18944
ds_read_b128 v[216:219], v240 offset:22528
ds_read_b128 v[220:223], v240 offset:23040
v_add_f32 v144, v144, v192
v_add_f32 v145, v145, v192
v_add_f32 v146, v146, v192
v_add_f32 v147, v147, v192
v_exp_f32 v144, v144
v_exp_f32 v145, v145
v_exp_f32 v146, v146
v_exp_f32 v147, v147
v_add_f32 v148, v148, v196
v_add_f32 v149, v149, v196
v_add_f32 v150, v150, v196
v_add_f32 v151, v151, v196
v_exp_f32 v148, v148
v_exp_f32 v149, v149
v_exp_f32 v150, v150
v_exp_f32 v151, v151
v_add_f32 v152, v152, v200
v_add_f32 v153, v153, v200
v_add_f32 v154, v154, v200
v_add_f32 v155, v155, v200
v_exp_f32 v152, v152
v_exp_f32 v153, v153
v_exp_f32 v154, v154
v_exp_f32 v155, v155
v_add_f32 v156, v156, v204
v_add_f32 v157, v157, v204
v_add_f32 v158, v158, v204
v_add_f32 v159, v159, v204
v_exp_f32 v156, v156
v_exp_f32 v157, v157
v_exp_f32 v158, v158
v_exp_f32 v159, v159
v_cvt_pk_bf16_f32 v160, v128, v129
v_cvt_pk_bf16_f32 v161, v130, v131
v_cvt_pk_bf16_f32 v164, v132, v133
v_cvt_pk_bf16_f32 v165, v134, v135
v_cvt_pk_bf16_f32 v168, v136, v137
v_cvt_pk_bf16_f32 v169, v138, v139
v_cvt_pk_bf16_f32 v172, v140, v141
v_cvt_pk_bf16_f32 v173, v142, v143
v_cvt_pk_bf16_f32 v162, v144, v145
v_cvt_pk_bf16_f32 v163, v146, v147
v_cvt_pk_bf16_f32 v166, v148, v149
v_cvt_pk_bf16_f32 v167, v150, v151
v_cvt_pk_bf16_f32 v170, v152, v153
v_cvt_pk_bf16_f32 v171, v154, v155
v_cvt_pk_bf16_f32 v174, v156, v157
v_cvt_pk_bf16_f32 v175, v158, v159
v_add_f32 v224, v128, v129
v_add_f32 v225, v132, v133
v_add_f32 v226, v136, v137
v_add_f32 v227, v140, v141
v_add_f32 v224, v224, v130
v_add_f32 v225, v225, v134
v_add_f32 v226, v226, v138
v_add_f32 v227, v227, v142
v_add_f32 v224, v224, v131
v_add_f32 v225, v225, v135
v_add_f32 v226, v226, v139
v_add_f32 v227, v227, v143
v_add_f32 v224, v224, v144
v_add_f32 v225, v225, v148
v_add_f32 v226, v226, v152
v_add_f32 v227, v227, v156
v_add_f32 v224, v224, v145
v_add_f32 v225, v225, v149
v_add_f32 v226, v226, v153
v_add_f32 v227, v227, v157
v_add_f32 v224, v224, v146
v_add_f32 v225, v225, v150
v_add_f32 v226, v226, v154
v_add_f32 v227, v227, v158
v_add_f32 v224, v224, v147
v_add_f32 v225, v225, v151
v_add_f32 v226, v226, v155
v_add_f32 v227, v227, v159
v_add_f32 v128, v176, v192
v_add_f32 v129, v177, v192
v_add_f32 v130, v178, v192
v_add_f32 v131, v179, v192
v_add_f32 v132, v180, v196
v_add_f32 v133, v181, v196
v_add_f32 v134, v182, v196
v_add_f32 v135, v183, v196
v_add_f32 v136, v184, v200
v_add_f32 v137, v185, v200
v_add_f32 v138, v186, v200
v_add_f32 v139, v187, v200
v_add_f32 v140, v188, v204
v_add_f32 v141, v189, v204
v_add_f32 v142, v190, v204
v_add_f32 v143, v191, v204
v_cmp_ne_u64 vcc, s[98:99], v[228:229]
s_nop 1
s_cbranch_vccnz LM_pb
LM_pb_ret:
s_nop 1
s_waitcnt lgkmcnt(2)
v_mfma_f32_16x16x32_bf16 v[144:147], v[208:211], v[0:3], v[192:195]
v_mfma_f32_16x16x32_bf16 v[144:147], v[212:215], v[4:7], v[144:147]
v_mfma_f32_16x16x32_bf16 v[148:151], v[208:211], v[32:35], v[196:199]
v_mfma_f32_16x16x32_bf16 v[148:151], v[212:215], v[36:39], v[148:151]
v_mfma_f32_16x16x32_bf16 v[152:155], v[208:211], v[64:67], v[200:203]
v_exp_f32 v128, v128
v_mfma_f32_16x16x32_bf16 v[152:155], v[212:215], v[68:71], v[152:155]
v_exp_f32 v129, v129
v_mfma_f32_16x16x32_bf16 v[156:159], v[208:211], v[96:99], v[204:207]
ds_read_b128 v[208:211], v240 offset:26624
v_exp_f32 v130, v130
v_mfma_f32_16x16x32_bf16 v[156:159], v[212:215], v[100:103], v[156:159]
ds_read_b128 v[212:215], v240 offset:27136
s_waitcnt lgkmcnt(2)
v_add_f32 v224, v224, v128
v_mfma_f32_16x16x32_bf16 v[144:147], v[216:219], v[8:11], v[144:147]
v_exp_f32 v131, v131
v_add_f32 v224, v224, v129
v_mfma_f32_16x16x32_bf16 v[144:147], v[220:223], v[12:15], v[144:147]
v_add_f32 v224, v224, v130
v_add_f32 v224, v224, v131
v_mfma_f32_16x16x32_bf16 v[148:151], v[216:219], v[40:43], v[148:151]
v_exp_f32 v132, v132
v_mfma_f32_16x16x32_bf16 v[148:151], v[220:223], v[44:47], v[148:151]
v_exp_f32 v133, v133
v_mfma_f32_16x16x32_bf16 v[152:155], v[216:219], v[72:75], v[152:155]
v_exp_f32 v134, v134
v_add_f32 v225, v225, v132
v_mfma_f32_16x16x32_bf16 v[152:155], v[220:223], v[76:79], v[152:155]
v_exp_f32 v135, v135
v_add_f32 v225, v225, v133
v_mfma_f32_16x16x32_bf16 v[156:159], v[216:219], v[104:107], v[156:159]
ds_read_b128 v[216:219], v240 offset:30720
v_add_f32 v225, v225, v134
v_add_f32 v225, v225, v135
v_mfma_f32_16x16x32_bf16 v[156:159], v[220:223], v[108:111], v[156:159]
ds_read_b128 v[220:223], v240 offset:31232
s_waitcnt lgkmcnt(2)
v_mfma_f32_16x16x32_bf16 v[144:147], v[208:211], v[16:19], v[144:147]
v_exp_f32 v136, v136
v_mfma_f32_16x16x32_bf16 v[144:147], v[212:215], v[20:23], v[144:147]
v_add_u32 v240, 0x8000, v240
v_exp_f32 v137, v137
v_mfma_f32_16x16x32_bf16 v[148:151], v[208:211], v[48:51], v[148:151]
v_and_b32 v240, 0x1ffff, v240
v_exp_f32 v138, v138
v_mfma_f32_16x16x32_bf16 v[148:151], v[212:215], v[52:55], v[148:151]
v_add_f32 v226, v226, v136
v_exp_f32 v139, v139
v_mfma_f32_16x16x32_bf16 v[152:155], v[208:211], v[80:83], v[152:155]
v_add_f32 v226, v226, v137
v_add_f32 v226, v226, v138
v_add_f32 v226, v226, v139
v_mfma_f32_16x16x32_bf16 v[152:155], v[212:215], v[84:87], v[152:155]
v_exp_f32 v140, v140
v_mfma_f32_16x16x32_bf16 v[156:159], v[208:211], v[112:115], v[156:159]
ds_read_b64_tr_b16 v[208:209], v246 offset:0
ds_read_b64_tr_b16 v[210:211], v246 offset:2048
v_mfma_f32_16x16x32_bf16 v[156:159], v[212:215], v[116:119], v[156:159]
ds_read_b64_tr_b16 v[212:213], v247 offset:0
s_waitcnt lgkmcnt(3)
v_mfma_f32_16x16x32_bf16 v[144:147], v[216:219], v[24:27], v[144:147]
ds_read_b64_tr_b16 v[214:215], v247 offset:2048
v_exp_f32 v141, v141
v_mfma_f32_16x16x32_bf16 v[144:147], v[220:223], v[28:31], v[144:147]
v_exp_f32 v142, v142
v_add_f32 v227, v227, v140
v_mfma_f32_16x16x32_bf16 v[148:151], v[216:219], v[56:59], v[148:151]
v_exp_f32 v143, v143
v_add_f32 v227, v227, v141
v_mfma_f32_16x16x32_bf16 v[148:151], v[220:223], v[60:63], v[148:151]
v_add_f32 v227, v227, v142
v_add_f32 v227, v227, v143
v_max3_f32 v242, v224, v225, v226
v_mfma_f32_16x16x32_bf16 v[152:155], v[216:219], v[88:91], v[152:155]
v_max_f32 v242, v242, v227
v_mfma_f32_16x16x32_bf16 v[152:155], v[220:223], v[92:95], v[152:155]
v_cmp_lt_f32 vcc, s32, v242
v_mfma_f32_16x16x32_bf16 v[156:159], v[216:219], v[120:123], v[156:159]
ds_read_b64_tr_b16 v[216:217], v246 offset:512
ds_read_b64_tr_b16 v[218:219], v246 offset:2560
v_mfma_f32_16x16x32_bf16 v[156:159], v[220:223], v[124:127], v[156:159]
ds_read_b64_tr_b16 v[220:221], v247 offset:512
s_waitcnt lgkmcnt(5)
v_mfma_f32_16x16x32_bf16 a[0:3], v[160:163], v[208:211], a[0:3]
ds_read_b64_tr_b16 v[222:223], v247 offset:2560
s_cbranch_vccnz L2_rare_site4
L2_ret4:
v_mfma_f32_16x16x32_bf16 a[4:7], v[164:167], v[208:211], a[4:7]
s_mov_b32 m0, s30
v_mfma_f32_16x16x32_bf16 a[8:11], v[168:171], v[208:211], a[8:11]
buffer_load_dwordx4 v241, s[12:15], s28 offen offset:0 sc1 lds
v_mfma_f32_16x16x32_bf16 a[12:15], v[172:175], v[208:211], a[12:15]
ds_read_b64_tr_b16 v[208:209], v246 offset:4096
s_waitcnt lgkmcnt(5)
v_mfma_f32_16x16x32_bf16 a[16:19], v[160:163], v[212:215], a[16:19]
ds_read_b64_tr_b16 v[210:211], v246 offset:6144
buffer_load_dwordx4 v241, s[12:15], s28 offen offset:1024 sc1 lds
v_mfma_f32_16x16x32_bf16 a[20:23], v[164:167], v[212:215], a[20:23]
v_mfma_f32_16x16x32_bf16 a[24:27], v[168:171], v[212:215], a[24:27]
buffer_load_dwordx4 v241, s[12:15], s28 offen offset:2048 sc1 lds
v_mfma_f32_16x16x32_bf16 a[28:31], v[172:175], v[212:215], a[28:31]
ds_read_b64_tr_b16 v[212:213], v247 offset:4096
s_waitcnt lgkmcnt(5)
v_mfma_f32_16x16x32_bf16 a[32:35], v[160:163], v[216:219], a[32:35]
ds_read_b64_tr_b16 v[214:215], v247 offset:6144
v_exp_f32 v144, v144
v_mfma_f32_16x16x32_bf16 a[36:39], v[164:167], v[216:219], a[36:39]
buffer_load_dwordx4 v241, s[12:15], s28 offen offset:3072 sc1 lds
v_exp_f32 v145, v145
v_mfma_f32_16x16x32_bf16 a[40:43], v[168:171], v[216:219], a[40:43]
v_exp_f32 v146, v146
v_add_f32 v224, v224, v144
v_mfma_f32_16x16x32_bf16 a[44:47], v[172:175], v[216:219], a[44:47]
ds_read_b64_tr_b16 v[216:217], v246 offset:4608
s_waitcnt lgkmcnt(5)
v_mfma_f32_16x16x32_bf16 a[48:51], v[160:163], v[220:223], a[48:51]
ds_read_b64_tr_b16 v[218:219], v246 offset:6656
v_exp_f32 v147, v147
v_mfma_f32_16x16x32_bf16 a[52:55], v[164:167], v[220:223], a[52:55]
v_add_f32 v224, v224, v145
v_add_f32 v224, v224, v146
v_add_f32 v224, v224, v147
v_mfma_f32_16x16x32_bf16 a[56:59], v[168:171], v[220:223], a[56:59]
v_exp_f32 v148, v148
v_mfma_f32_16x16x32_bf16 a[60:63], v[172:175], v[220:223], a[60:63]
ds_read_b64_tr_b16 v[220:221], v247 offset:4608
s_waitcnt lgkmcnt(5)
v_mfma_f32_16x16x32_bf16 a[64:67], v[160:163], v[208:211], a[64:67]
ds_read_b64_tr_b16 v[222:223], v247 offset:6656
v_exp_f32 v149, v149
v_mfma_f32_16x16x32_bf16 a[68:71], v[164:167], v[208:211], a[68:71]
s_waitcnt vmcnt(4)
s_barrier
v_mfma_f32_16x16x32_bf16 a[72:75], v[168:171], v[208:211], a[72:75]
v_exp_f32 v150, v150
v_add_f32 v225, v225, v148
v_mfma_f32_16x16x32_bf16 a[76:79], v[172:175], v[208:211], a[76:79]
ds_read_b128 v[208:211], v240 offset:0
s_waitcnt lgkmcnt(5)
v_mfma_f32_16x16x32_bf16 a[80:83], v[160:163], v[212:215], a[80:83]
v_exp_f32 v151, v151
v_add_f32 v225, v225, v149
v_mfma_f32_16x16x32_bf16 a[84:87], v[164:167], v[212:215], a[84:87]
v_add_f32 v225, v225, v150
v_add_f32 v225, v225, v151
v_mfma_f32_16x16x32_bf16 a[88:91], v[168:171], v[212:215], a[88:91]
v_exp_f32 v152, v152
v_mfma_f32_16x16x32_bf16 a[92:95], v[172:175], v[212:215], a[92:95]
ds_read_b128 v[212:215], v240 offset:512
s_waitcnt lgkmcnt(4)
v_mfma_f32_16x16x32_bf16 a[96:99], v[160:163], v[216:219], a[96:99]
v_exp_f32 v153, v153
v_mfma_f32_16x16x32_bf16 a[100:103], v[164:167], v[216:219], a[100:103]
v_cvt_pk_bf16_f32 v176, v128, v129
v_cvt_pk_bf16_f32 v177, v130, v131
v_mfma_f32_16x16x32_bf16 a[104:107], v[168:171], v[216:219], a[104:107]
v_exp_f32 v154, v154
v_add_f32 v226, v226, v152
v_mfma_f32_16x16x32_bf16 a[108:111], v[172:175], v[216:219], a[108:111]
ds_read_b128 v[216:219], v240 offset:4096
s_waitcnt lgkmcnt(3)
v_cvt_pk_bf16_f32 v180, v132, v133
v_cvt_pk_bf16_f32 v181, v134, v135
v_mfma_f32_16x16x32_bf16 a[112:115], v[160:163], v[220:223], a[112:115]
v_exp_f32 v155, v155
v_add_f32 v226, v226, v153
v_mfma_f32_16x16x32_bf16 a[116:119], v[164:167], v[220:223], a[116:119]
v_cvt_pk_bf16_f32 v184, v136, v137
v_cvt_pk_bf16_f32 v185, v138, v139
v_add_f32 v226, v226, v154
v_mfma_f32_16x16x32_bf16 a[120:123], v[168:171], v[220:223], a[120:123]
v_add_f32 v226, v226, v155
v_exp_f32 v156, v156
v_mfma_f32_16x16x32_bf16 a[124:127], v[172:175], v[220:223], a[124:127]
ds_read_b128 v[220:223], v240 offset:4608
s_waitcnt lgkmcnt(2)
v_mfma_f32_16x16x32_bf16 v[128:131], v[208:211], v[0:3], v[192:195]
v_exp_f32 v157, v157
v_mfma_f32_16x16x32_bf16 v[128:131], v[212:215], v[4:7], v[128:131]
v_cvt_pk_bf16_f32 v188, v140, v141
v_cvt_pk_bf16_f32 v189, v142, v143
v_mfma_f32_16x16x32_bf16 v[132:135], v[208:211], v[32:35], v[196:199]
v_exp_f32 v158, v158
v_add_f32 v227, v227, v156
v_mfma_f32_16x16x32_bf16 v[132:135], v[212:215], v[36:39], v[132:135]
v_exp_f32 v159, v159
v_add_f32 v227, v227, v157
v_mfma_f32_16x16x32_bf16 v[136:139], v[208:211], v[64:67], v[200:203]
v_add_f32 v227, v227, v158
v_add_f32 v227, v227, v159
v_max3_f32 v242, v224, v225, v226
v_mfma_f32_16x16x32_bf16 v[136:139], v[212:215], v[68:71], v[136:139]
v_max_f32 v242, v242, v227
v_mfma_f32_16x16x32_bf16 v[140:143], v[208:211], v[96:99], v[204:207]
ds_read_b128 v[208:211], v240 offset:8192
v_cmp_lt_f32 vcc, s32, v242
v_mfma_f32_16x16x32_bf16 v[140:143], v[212:215], v[100:103], v[140:143]
ds_read_b128 v[212:215], v240 offset:8704
s_waitcnt lgkmcnt(2)
v_mfma_f32_16x16x32_bf16 v[128:131], v[216:219], v[8:11], v[128:131]
v_mfma_f32_16x16x32_bf16 v[128:131], v[220:223], v[12:15], v[128:131]
s_cbranch_vccnz L2_rare_site5
L2_ret5:
v_cvt_pk_bf16_f32 v178, v144, v145
v_cvt_pk_bf16_f32 v179, v146, v147
v_mfma_f32_16x16x32_bf16 v[132:135], v[216:219], v[40:43], v[132:135]
v_cvt_pk_bf16_f32 v182, v148, v149
v_cvt_pk_bf16_f32 v183, v150, v151
v_cvt_pk_bf16_f32 v186, v152, v153
v_mfma_f32_16x16x32_bf16 v[132:135], v[220:223], v[44:47], v[132:135]
v_cvt_pk_bf16_f32 v187, v154, v155
v_cvt_pk_bf16_f32 v190, v156, v157
v_cvt_pk_bf16_f32 v191, v158, v159
v_mfma_f32_16x16x32_bf16 v[136:139], v[216:219], v[72:75], v[136:139]
v_mfma_f32_16x16x32_bf16 v[136:139], v[220:223], v[76:79], v[136:139]
v_mfma_f32_16x16x32_bf16 v[140:143], v[216:219], v[104:107], v[140:143]
ds_read_b128 v[216:219], v240 offset:12288
v_mfma_f32_16x16x32_bf16 v[140:143], v[220:223], v[108:111], v[140:143]
ds_read_b128 v[220:223], v240 offset:12800
s_waitcnt lgkmcnt(2)
v_mfma_f32_16x16x32_bf16 v[128:131], v[208:211], v[16:19], v[128:131]
v_mfma_f32_16x16x32_bf16 v[128:131], v[212:215], v[20:23], v[128:131]
v_mfma_f32_16x16x32_bf16 v[132:135], v[208:211], v[48:51], v[132:135]
v_mfma_f32_16x16x32_bf16 v[132:135], v[212:215], v[52:55], v[132:135]
v_mfma_f32_16x16x32_bf16 v[136:139], v[208:211], v[80:83], v[136:139]
v_mfma_f32_16x16x32_bf16 v[136:139], v[212:215], v[84:87], v[136:139]
s_sub_u32 s31, s31, 1
v_mfma_f32_16x16x32_bf16 v[140:143], v[208:211], v[112:115], v[140:143]
ds_read_b128 v[208:211], v240 offset:2048
v_mfma_f32_16x16x32_bf16 v[140:143], v[212:215], v[116:119], v[140:143]
ds_read_b128 v[212:215], v240 offset:2560
s_waitcnt lgkmcnt(2)
v_mfma_f32_16x16x32_bf16 v[128:131], v[216:219], v[24:27], v[128:131]
s_add_u32 s28, s28, s101
s_add_u32 s30, s30, 0x4000
v_mfma_f32_16x16x32_bf16 v[128:131], v[220:223], v[28:31], v[128:131]
s_and_b32 s30, s30, 0x1ffff
v_mfma_f32_16x16x32_bf16 v[132:135], v[216:219], v[56:59], v[132:135]
v_mfma_f32_16x16x32_bf16 v[132:135], v[220:223], v[60:63], v[132:135]
v_mfma_f32_16x16x32_bf16 v[136:139], v[216:219], v[88:91], v[136:139]
v_mfma_f32_16x16x32_bf16 v[136:139], v[220:223], v[92:95], v[136:139]
v_mfma_f32_16x16x32_bf16 v[140:143], v[216:219], v[120:123], v[140:143]
ds_read_b128 v[216:219], v240 offset:6144
v_mfma_f32_16x16x32_bf16 v[140:143], v[220:223], v[124:127], v[140:143]
ds_read_b128 v[220:223], v240 offset:6656
s_branch L2_loop1
.p2align 6
L2_loop:
s_waitcnt lgkmcnt(2)
v_mfma_f32_16x16x32_bf16 v[144:147], v[208:211], v[0:3], v[192:195]
v_mfma_f32_16x16x32_bf16 v[144:147], v[212:215], v[4:7], v[144:147]
v_mfma_f32_16x16x32_bf16 v[148:151], v[208:211], v[32:35], v[196:199]
v_mfma_f32_16x16x32_bf16 v[148:151], v[212:215], v[36:39], v[148:151]
v_mfma_f32_16x16x32_bf16 v[152:155], v[208:211], v[64:67], v[200:203]
v_exp_f32 v128, v128
v_mfma_f32_16x16x32_bf16 v[152:155], v[212:215], v[68:71], v[152:155]
v_exp_f32 v129, v129
v_mfma_f32_16x16x32_bf16 v[156:159], v[208:211], v[96:99], v[204:207]
ds_read_b128 v[208:211], v240 offset:26624
v_mfma_f32_16x16x32_bf16 v[156:159], v[212:215], v[100:103], v[156:159]
ds_read_b128 v[212:215], v240 offset:27136
s_waitcnt lgkmcnt(2)
v_mfma_f32_16x16x32_bf16 v[144:147], v[216:219], v[8:11], v[144:147]
v_exp_f32 v130, v130
v_mfma_f32_16x16x32_bf16 v[144:147], v[220:223], v[12:15], v[144:147]
v_add_f32 v224, v224, v128
v_mfma_f32_16x16x32_bf16 v[148:151], v[216:219], v[40:43], v[148:151]
v_exp_f32 v131, v131
v_mfma_f32_16x16x32_bf16 v[148:151], v[220:223], v[44:47], v[148:151]
v_add_f32 v224, v224, v129
v_add_f32 v224, v224, v130
v_mfma_f32_16x16x32_bf16 v[152:155], v[216:219], v[72:75], v[152:155]
v_add_f32 v224, v224, v131
v_mfma_f32_16x16x32_bf16 v[152:155], v[220:223], v[76:79], v[152:155]
v_exp_f32 v132, v132
v_mfma_f32_16x16x32_bf16 v[156:159], v[216:219], v[104:107], v[156:159]
ds_read_b128 v[216:219], v240 offset:30720
v_mfma_f32_16x16x32_bf16 v[156:159], v[220:223], v[108:111], v[156:159]
ds_read_b128 v[220:223], v240 offset:31232
s_waitcnt lgkmcnt(2)
v_mfma_f32_16x16x32_bf16 v[144:147], v[208:211], v[16:19], v[144:147]
v_exp_f32 v133, v133
v_mfma_f32_16x16x32_bf16 v[144:147], v[212:215], v[20:23], v[144:147]
v_add_u32 v240, 0x8000, v240
v_mfma_f32_16x16x32_bf16 v[148:151], v[208:211], v[48:51], v[148:151]
v_and_b32 v240, 0x1ffff, v240
v_mfma_f32_16x16x32_bf16 v[148:151], v[212:215], v[52:55], v[148:151]
v_exp_f32 v134, v134
v_mfma_f32_16x16x32_bf16 v[152:155], v[208:211], v[80:83], v[152:155]
v_add_f32 v225, v225, v132
v_mfma_f32_16x16x32_bf16 v[152:155], v[212:215], v[84:87], v[152:155]
v_exp_f32 v135, v135
v_mfma_f32_16x16x32_bf16 v[156:159], v[208:211], v[112:115], v[156:159]
ds_read_b64_tr_b16 v[208:209], v244 offset:16384
ds_read_b64_tr_b16 v[210:211], v244 offset:18432
v_mfma_f32_16x16x32_bf16 v[156:159], v[212:215], v[116:119], v[156:159]
ds_read_b64_tr_b16 v[212:213], v246 offset:0
s_waitcnt lgkmcnt(3)
v_mfma_f32_16x16x32_bf16 v[144:147], v[216:219], v[24:27], v[144:147]
ds_read_b64_tr_b16 v[214:215], v246 offset:2048
v_add_f32 v225, v225, v133
v_mfma_f32_16x16x32_bf16 v[144:147], v[220:223], v[28:31], v[144:147]
v_add_f32 v225, v225, v134
v_add_f32 v225, v225, v135
v_mfma_f32_16x16x32_bf16 v[148:151], v[216:219], v[56:59], v[148:151]
v_exp_f32 v136, v136
v_mfma_f32_16x16x32_bf16 v[148:151], v[220:223], v[60:63], v[148:151]
v_exp_f32 v137, v137
v_mfma_f32_16x16x32_bf16 v[152:155], v[216:219], v[88:91], v[152:155]
v_exp_f32 v138, v138
v_mfma_f32_16x16x32_bf16 v[152:155], v[220:223], v[92:95], v[152:155]
v_add_f32 v226, v226, v136
v_mfma_f32_16x16x32_bf16 v[156:159], v[216:219], v[120:123], v[156:159]
ds_read_b64_tr_b16 v[216:217], v245 offset:16384
ds_read_b64_tr_b16 v[218:219], v245 offset:18432
v_mfma_f32_16x16x32_bf16 v[156:159], v[220:223], v[124:127], v[156:159]
ds_read_b64_tr_b16 v[220:221], v247 offset:0
s_waitcnt lgkmcnt(3)
v_mfma_f32_16x16x32_bf16 a[0:3], v[176:179], v[208:211], a[0:3]
ds_read_b64_tr_b16 v[222:223], v247 offset:2048
v_mfma_f32_16x16x32_bf16 a[0:3], v[160:163], v[212:215], a[0:3]
v_exp_f32 v139, v139
v_mfma_f32_16x16x32_bf16 a[4:7], v[180:183], v[208:211], a[4:7]
v_add_f32 v226, v226, v137
v_add_f32 v226, v226, v138
v_mfma_f32_16x16x32_bf16 a[4:7], v[164:167], v[212:215], a[4:7]
v_add_f32 v226, v226, v139
v_mfma_f32_16x16x32_bf16 a[8:11], v[184:187], v[208:211], a[8:11]
v_exp_f32 v140, v140
v_mfma_f32_16x16x32_bf16 a[8:11], v[168:171], v[212:215], a[8:11]
v_exp_f32 v141, v141
v_mfma_f32_16x16x32_bf16 a[12:15], v[188:191], v[208:211], a[12:15]
ds_read_b64_tr_b16 v[208:209], v244 offset:16896
ds_read_b64_tr_b16 v[210:211], v244 offset:18944
v_mfma_f32_16x16x32_bf16 a[12:15], v[172:175], v[212:215], a[12:15]
ds_read_b64_tr_b16 v[212:213], v246 offset:512
s_waitcnt lgkmcnt(3)
v_mfma_f32_16x16x32_bf16 a[16:19], v[176:179], v[216:219], a[16:19]
ds_read_b64_tr_b16 v[214:215], v246 offset:2560
v_mfma_f32_16x16x32_bf16 a[16:19], v[160:163], v[220:223], a[16:19]
v_exp_f32 v142, v142
v_mfma_f32_16x16x32_bf16 a[20:23], v[180:183], v[216:219], a[20:23]
v_add_f32 v227, v227, v140
v_mfma_f32_16x16x32_bf16 a[20:23], v[164:167], v[220:223], a[20:23]
v_exp_f32 v143, v143
v_mfma_f32_16x16x32_bf16 a[24:27], v[184:187], v[216:219], a[24:27]
v_add_f32 v227, v227, v141
v_add_f32 v227, v227, v142
v_mfma_f32_16x16x32_bf16 a[24:27], v[168:171], v[220:223], a[24:27]
v_add_f32 v227, v227, v143
v_max3_f32 v242, v224, v225, v226
v_mfma_f32_16x16x32_bf16 a[28:31], v[188:191], v[216:219], a[28:31]
ds_read_b64_tr_b16 v[216:217], v245 offset:16896
ds_read_b64_tr_b16 v[218:219], v245 offset:18944
v_mfma_f32_16x16x32_bf16 a[28:31], v[172:175], v[220:223], a[28:31]
ds_read_b64_tr_b16 v[220:221], v247 offset:512
s_waitcnt lgkmcnt(3)
v_mfma_f32_16x16x32_bf16 a[32:35], v[176:179], v[208:211], a[32:35]
ds_read_b64_tr_b16 v[222:223], v247 offset:2560
v_max_f32 v242, v242, v227
v_mfma_f32_16x16x32_bf16 a[32:35], v[160:163], v[212:215], a[32:35]
v_cmp_lt_f32 vcc, s32, v242
v_mfma_f32_16x16x32_bf16 a[36:39], v[180:183], v[208:211], a[36:39]
v_mfma_f32_16x16x32_bf16 a[36:39], v[164:167], v[212:215], a[36:39]
v_mfma_f32_16x16x32_bf16 a[40:43], v[184:187], v[208:211], a[40:43]
s_mov_b32 m0, s30
s_cbranch_vccnz L2_rare_site0
L2_ret0:
v_mfma_f32_16x16x32_bf16 a[40:43], v[168:171], v[212:215], a[40:43]
buffer_load_dwordx4 v241, s[12:15], s28 offen offset:0 sc1 lds
v_mfma_f32_16x16x32_bf16 a[44:47], v[188:191], v[208:211], a[44:47]
ds_read_b64_tr_b16 v[208:209], v244 offset:20480
ds_read_b64_tr_b16 v[210:211], v244 offset:22528
v_mfma_f32_16x16x32_bf16 a[44:47], v[172:175], v[212:215], a[44:47]
ds_read_b64_tr_b16 v[212:213], v246 offset:4096
s_waitcnt lgkmcnt(3)
v_mfma_f32_16x16x32_bf16 a[48:51], v[176:179], v[216:219], a[48:51]
ds_read_b64_tr_b16 v[214:215], v246 offset:6144
v_mfma_f32_16x16x32_bf16 a[48:51], v[160:163], v[220:223], a[48:51]
buffer_load_dwordx4 v241, s[12:15], s28 offen offset:1024 sc1 lds
v_mfma_f32_16x16x32_bf16 a[52:55], v[180:183], v[216:219], a[52:55]
v_exp_f32 v144, v144
v_mfma_f32_16x16x32_bf16 a[52:55], v[164:167], v[220:223], a[52:55]
v_exp_f32 v145, v145
v_mfma_f32_16x16x32_bf16 a[56:59], v[184:187], v[216:219], a[56:59]
v_exp_f32 v146, v146
v_mfma_f32_16x16x32_bf16 a[56:59], v[168:171], v[220:223], a[56:59]
buffer_load_dwordx4 v241, s[12:15], s28 offen offset:2048 sc1 lds
v_add_f32 v224, v224, v144
v_mfma_f32_16x16x32_bf16 a[60:63], v[188:191], v[216:219], a[60:63]
ds_read_b64_tr_b16 v[216:217], v245 offset:20480
ds_read_b64_tr_b16 v[218:219], v245 offset:22528
v_mfma_f32_16x16x32_bf16 a[60:63], v[172:175], v[220:223], a[60:63]
ds_read_b64_tr_b16 v[220:221], v247 offset:4096
s_waitcnt lgkmcnt(3)
v_mfma_f32_16x16x32_bf16 a[64:67], v[176:179], v[208:211], a[64:67]
ds_read_b64_tr_b16 v[222:223], v247 offset:6144
v_mfma_f32_16x16x32_bf16 a[64:67], v[160:163], v[212:215], a[64:67]
buffer_load_dwordx4 v241, s[12:15], s28 offen offset:3072 sc1 lds
v_mfma_f32_16x16x32_bf16 a[68:71], v[180:183], v[208:211], a[68:71]
v_exp_f32 v147, v147
v_mfma_f32_16x16x32_bf16 a[68:71], v[164:167], v[212:215], a[68:71]
v_add_f32 v224, v224, v145
v_add_f32 v224, v224, v146
v_mfma_f32_16x16x32_bf16 a[72:75], v[184:187], v[208:211], a[72:75]
v_add_f32 v224, v224, v147
v_mfma_f32_16x16x32_bf16 a[72:75], v[168:171], v[212:215], a[72:75]
v_exp_f32 v148, v148
v_mfma_f32_16x16x32_bf16 a[76:79], v[188:191], v[208:211], a[76:79]
ds_read_b64_tr_b16 v[208:209], v244 offset:20992
ds_read_b64_tr_b16 v[210:211], v244 offset:23040
v_mfma_f32_16x16x32_bf16 a[76:79], v[172:175], v[212:215], a[76:79]
ds_read_b64_tr_b16 v[212:213], v246 offset:4608
s_waitcnt lgkmcnt(3)
v_mfma_f32_16x16x32_bf16 a[80:83], v[176:179], v[216:219], a[80:83]
ds_read_b64_tr_b16 v[214:215], v246 offset:6656
v_mfma_f32_16x16x32_bf16 a[80:83], v[160:163], v[220:223], a[80:83]
v_exp_f32 v149, v149
v_mfma_f32_16x16x32_bf16 a[84:87], v[180:183], v[216:219], a[84:87]
v_exp_f32 v150, v150
v_mfma_f32_16x16x32_bf16 a[84:87], v[164:167], v[220:223], a[84:87]
v_add_f32 v225, v225, v148
v_mfma_f32_16x16x32_bf16 a[88:91], v[184:187], v[216:219], a[88:91]
v_exp_f32 v151, v151
v_mfma_f32_16x16x32_bf16 a[88:91], v[168:171], v[220:223], a[88:91]
v_add_f32 v225, v225, v149
v_add_f32 v225, v225, v150
v_mfma_f32_16x16x32_bf16 a[92:95], v[188:191], v[216:219], a[92:95]
ds_read_b64_tr_b16 v[216:217], v245 offset:20992
ds_read_b64_tr_b16 v[218:219], v245 offset:23040
v_mfma_f32_16x16x32_bf16 a[92:95], v[172:175], v[220:223], a[92:95]
ds_read_b64_tr_b16 v[220:221], v247 offset:4608
s_waitcnt lgkmcnt(3)
v_mfma_f32_16x16x32_bf16 a[96:99], v[176:179], v[208:211], a[96:99]
ds_read_b64_tr_b16 v[222:223], v247 offset:6656
v_add_f32 v225, v225, v151
v_mfma_f32_16x16x32_bf16 a[96:99], v[160:163], v[212:215], a[96:99]
s_waitcnt vmcnt(4)
s_barrier
v_mfma_f32_16x16x32_bf16 a[100:103], v[180:183], v[208:211], a[100:103]
v_exp_f32 v152, v152
v_mfma_f32_16x16x32_bf16 a[100:103], v[164:167], v[212:215], a[100:103]
v_exp_f32 v153, v153
v_mfma_f32_16x16x32_bf16 a[104:107], v[184:187], v[208:211], a[104:107]
v_exp_f32 v154, v154
v_mfma_f32_16x16x32_bf16 a[104:107], v[168:171], v[212:215], a[104:107]
v_add_f32 v226, v226, v152
v_mfma_f32_16x16x32_bf16 a[108:111], v[188:191], v[208:211], a[108:111]
ds_read_b128 v[208:211], v240 offset:0
v_mfma_f32_16x16x32_bf16 a[108:111], v[172:175], v[212:215], a[108:111]
ds_read_b128 v[212:215], v240 offset:512
s_waitcnt lgkmcnt(2)
v_mfma_f32_16x16x32_bf16 a[112:115], v[176:179], v[216:219], a[112:115]
v_exp_f32 v155, v155
v_mfma_f32_16x16x32_bf16 a[112:115], v[160:163], v[220:223], a[112:115]
v_cvt_pk_bf16_f32 v176, v128, v129
v_cvt_pk_bf16_f32 v177, v130, v131
v_mfma_f32_16x16x32_bf16 a[116:119], v[180:183], v[216:219], a[116:119]
v_add_f32 v226, v226, v153
v_add_f32 v226, v226, v154
v_mfma_f32_16x16x32_bf16 a[116:119], v[164:167], v[220:223], a[116:119]
v_cvt_pk_bf16_f32 v180, v132, v133
v_cvt_pk_bf16_f32 v181, v134, v135
v_mfma_f32_16x16x32_bf16 a[120:123], v[184:187], v[216:219], a[120:123]
v_add_f32 v226, v226, v155
v_mfma_f32_16x16x32_bf16 a[120:123], v[168:171], v[220:223], a[120:123]
v_cvt_pk_bf16_f32 v184, v136, v137
v_cvt_pk_bf16_f32 v185, v138, v139
v_mfma_f32_16x16x32_bf16 a[124:127], v[188:191], v[216:219], a[124:127]
ds_read_b128 v[216:219], v240 offset:4096
v_mfma_f32_16x16x32_bf16 a[124:127], v[172:175], v[220:223], a[124:127]
ds_read_b128 v[220:223], v240 offset:4608
s_waitcnt lgkmcnt(2)
v_mfma_f32_16x16x32_bf16 v[128:131], v[208:211], v[0:3], v[192:195]
v_exp_f32 v156, v156
v_mfma_f32_16x16x32_bf16 v[128:131], v[212:215], v[4:7], v[128:131]
v_cvt_pk_bf16_f32 v188, v140, v141
v_cvt_pk_bf16_f32 v189, v142, v143
v_mfma_f32_16x16x32_bf16 v[132:135], v[208:211], v[32:35], v[196:199]
v_exp_f32 v157, v157
v_mfma_f32_16x16x32_bf16 v[132:135], v[212:215], v[36:39], v[132:135]
v_exp_f32 v158, v158
v_mfma_f32_16x16x32_bf16 v[136:139], v[208:211], v[64:67], v[200:203]
v_add_f32 v227, v227, v156
v_mfma_f32_16x16x32_bf16 v[136:139], v[212:215], v[68:71], v[136:139]
v_exp_f32 v159, v159
v_mfma_f32_16x16x32_bf16 v[140:143], v[208:211], v[96:99], v[204:207]
ds_read_b128 v[208:211], v240 offset:8192
v_add_f32 v227, v227, v157
v_mfma_f32_16x16x32_bf16 v[140:143], v[212:215], v[100:103], v[140:143]
ds_read_b128 v[212:215], v240 offset:8704
s_waitcnt lgkmcnt(2)
v_mfma_f32_16x16x32_bf16 v[128:131], v[216:219], v[8:11], v[128:131]
v_add_f32 v227, v227, v158
v_add_f32 v227, v227, v159
v_mfma_f32_16x16x32_bf16 v[128:131], v[220:223], v[12:15], v[128:131]
v_max3_f32 v242, v224, v225, v226
v_mfma_f32_16x16x32_bf16 v[132:135], v[216:219], v[40:43], v[132:135]
v_max_f32 v242, v242, v227
v_mfma_f32_16x16x32_bf16 v[132:135], v[220:223], v[44:47], v[132:135]
v_cmp_lt_f32 vcc, s32, v242
v_mfma_f32_16x16x32_bf16 v[136:139], v[216:219], v[72:75], v[136:139]
v_mfma_f32_16x16x32_bf16 v[136:139], v[220:223], v[76:79], v[136:139]
v_mfma_f32_16x16x32_bf16 v[140:143], v[216:219], v[104:107], v[140:143]
ds_read_b128 v[216:219], v240 offset:12288
s_cbranch_vccnz L2_rare_site1
L2_ret1:
v_mfma_f32_16x16x32_bf16 v[140:143], v[220:223], v[108:111], v[140:143]
ds_read_b128 v[220:223], v240 offset:12800
s_waitcnt lgkmcnt(2)
v_mfma_f32_16x16x32_bf16 v[128:131], v[208:211], v[16:19], v[128:131]
v_cvt_pk_bf16_f32 v178, v144, v145
v_cvt_pk_bf16_f32 v179, v146, v147
v_mfma_f32_16x16x32_bf16 v[128:131], v[212:215], v[20:23], v[128:131]
v_cvt_pk_bf16_f32 v182, v148, v149
v_cvt_pk_bf16_f32 v183, v150, v151
v_mfma_f32_16x16x32_bf16 v[132:135], v[208:211], v[48:51], v[132:135]
v_cvt_pk_bf16_f32 v186, v152, v153
v_cvt_pk_bf16_f32 v187, v154, v155
v_mfma_f32_16x16x32_bf16 v[132:135], v[212:215], v[52:55], v[132:135]
v_cvt_pk_bf16_f32 v190, v156, v157
v_cvt_pk_bf16_f32 v191, v158, v159
v_mfma_f32_16x16x32_bf16 v[136:139], v[208:211], v[80:83], v[136:139]
v_mfma_f32_16x16x32_bf16 v[136:139], v[212:215], v[84:87], v[136:139]
s_sub_u32 s31, s31, 1
v_mfma_f32_16x16x32_bf16 v[140:143], v[208:211], v[112:115], v[140:143]
ds_read_b128 v[208:211], v240 offset:2048
v_mfma_f32_16x16x32_bf16 v[140:143], v[212:215], v[116:119], v[140:143]
ds_read_b128 v[212:215], v240 offset:2560
s_waitcnt lgkmcnt(2)
v_mfma_f32_16x16x32_bf16 v[128:131], v[216:219], v[24:27], v[128:131]
s_add_u32 s28, s28, s101
s_add_u32 s30, s30, 0x4000
v_mfma_f32_16x16x32_bf16 v[128:131], v[220:223], v[28:31], v[128:131]
s_and_b32 s30, s30, 0x1ffff
v_mfma_f32_16x16x32_bf16 v[132:135], v[216:219], v[56:59], v[132:135]
s_cmp_eq_u32 s31, 0
v_mfma_f32_16x16x32_bf16 v[132:135], v[220:223], v[60:63], v[132:135]
v_mfma_f32_16x16x32_bf16 v[136:139], v[216:219], v[88:91], v[136:139]
v_mfma_f32_16x16x32_bf16 v[136:139], v[220:223], v[92:95], v[136:139]
v_mfma_f32_16x16x32_bf16 v[140:143], v[216:219], v[120:123], v[140:143]
ds_read_b128 v[216:219], v240 offset:6144
v_mfma_f32_16x16x32_bf16 v[140:143], v[220:223], v[124:127], v[140:143]
ds_read_b128 v[220:223], v240 offset:6656
s_cbranch_scc1 L2_x1
L2_loop1:
s_waitcnt lgkmcnt(2)
v_mfma_f32_16x16x32_bf16 v[144:147], v[208:211], v[0:3], v[192:195]
v_mfma_f32_16x16x32_bf16 v[144:147], v[212:215], v[4:7], v[144:147]
v_mfma_f32_16x16x32_bf16 v[148:151], v[208:211], v[32:35], v[196:199]
v_mfma_f32_16x16x32_bf16 v[148:151], v[212:215], v[36:39], v[148:151]
v_mfma_f32_16x16x32_bf16 v[152:155], v[208:211], v[64:67], v[200:203]
v_exp_f32 v128, v128
v_mfma_f32_16x16x32_bf16 v[152:155], v[212:215], v[68:71], v[152:155]
v_exp_f32 v129, v129
v_mfma_f32_16x16x32_bf16 v[156:159], v[208:211], v[96:99], v[204:207]
ds_read_b128 v[208:211], v240 offset:10240
v_mfma_f32_16x16x32_bf16 v[156:159], v[212:215], v[100:103], v[156:159]
ds_read_b128 v[212:215], v240 offset:10752
s_waitcnt lgkmcnt(2)
v_mfma_f32_16x16x32_bf16 v[144:147], v[216:219], v[8:11], v[144:147]
v_exp_f32 v130, v130
v_mfma_f32_16x16x32_bf16 v[144:147], v[220:223], v[12:15], v[144:147]
v_add_f32 v224, v224, v128
v_mfma_f32_16x16x32_bf16 v[148:151], v[216:219], v[40:43], v[148:151]
v_exp_f32 v131, v131
v_mfma_f32_16x16x32_bf16 v[148:151], v[220:223], v[44:47], v[148:151]
v_add_f32 v224, v224, v129
v_add_f32 v224, v224, v130
v_mfma_f32_16x16x32_bf16 v[152:155], v[216:219], v[72:75], v[152:155]
v_add_f32 v224, v224, v131
v_mfma_f32_16x16x32_bf16 v[152:155], v[220:223], v[76:79], v[152:155]
v_exp_f32 v132, v132
v_mfma_f32_16x16x32_bf16 v[156:159], v[216:219], v[104:107], v[156:159]
ds_read_b128 v[216:219], v240 offset:14336
v_mfma_f32_16x16x32_bf16 v[156:159], v[220:223], v[108:111], v[156:159]
ds_read_b128 v[220:223], v240 offset:14848
s_waitcnt lgkmcnt(2)
v_mfma_f32_16x16x32_bf16 v[144:147], v[208:211], v[16:19], v[144:147]
v_exp_f32 v133, v133
v_mfma_f32_16x16x32_bf16 v[144:147], v[212:215], v[20:23], v[144:147]
v_exp_f32 v134, v134
v_mfma_f32_16x16x32_bf16 v[148:151], v[208:211], v[48:51], v[148:151]
v_add_f32 v225, v225, v132
v_mfma_f32_16x16x32_bf16 v[148:151], v[212:215], v[52:55], v[148:151]
v_exp_f32 v135, v135
v_mfma_f32_16x16x32_bf16 v[152:155], v[208:211], v[80:83], v[152:155]
v_add_f32 v225, v225, v133
v_add_f32 v225, v225, v134
v_mfma_f32_16x16x32_bf16 v[152:155], v[212:215], v[84:87], v[152:155]
v_add_f32 v225, v225, v135
v_mfma_f32_16x16x32_bf16 v[156:159], v[208:211], v[112:115], v[156:159]
ds_read_b64_tr_b16 v[208:209], v246 offset:8192
ds_read_b64_tr_b16 v[210:211], v246 offset:10240
v_mfma_f32_16x16x32_bf16 v[156:159], v[212:215], v[116:119], v[156:159]
ds_read_b64_tr_b16 v[212:213], v246 offset:24576
s_waitcnt lgkmcnt(3)
v_mfma_f32_16x16x32_bf16 v[144:147], v[216:219], v[24:27], v[144:147]
ds_read_b64_tr_b16 v[214:215], v246 offset:26624
v_mfma_f32_16x16x32_bf16 v[144:147], v[220:223], v[28:31], v[144:147]
v_exp_f32 v136, v136
v_mfma_f32_16x16x32_bf16 v[148:151], v[216:219], v[56:59], v[148:151]
v_exp_f32 v137, v137
v_mfma_f32_16x16x32_bf16 v[148:151], v[220:223], v[60:63], v[148:151]
v_exp_f32 v138, v138
v_mfma_f32_16x16x32_bf16 v[152:155], v[216:219], v[88:91], v[152:155]
v_add_f32 v226, v226, v136
v_mfma_f32_16x16x32_bf16 v[152:155], v[220:223], v[92:95], v[152:155]
v_exp_f32 v139, v139
v_mfma_f32_16x16x32_bf16 v[156:159], v[216:219], v[120:123], v[156:159]
ds_read_b64_tr_b16 v[216:217], v247 offset:8192
ds_read_b64_tr_b16 v[218:219], v247 offset:10240
v_mfma_f32_16x16x32_bf16 v[156:159], v[220:223], v[124:127], v[156:159]
ds_read_b64_tr_b16 v[220:221], v247 offset:24576
s_waitcnt lgkmcnt(3)
v_mfma_f32_16x16x32_bf16 a[128:131], v[160:163], v[208:211], a[128:131]
ds_read_b64_tr_b16 v[222:223], v247 offset:26624
v_add_f32 v226, v226, v137
v_mfma_f32_16x16x32_bf16 a[128:131], v[176:179], v[212:215], a[128:131]
v_add_f32 v226, v226, v138
v_add_f32 v226, v226, v139
v_mfma_f32_16x16x32_bf16 a[132:135], v[164:167], v[208:211], a[132:135]
v_exp_f32 v140, v140
v_mfma_f32_16x16x32_bf16 a[132:135], v[180:183], v[212:215], a[132:135]
v_exp_f32 v141, v141
v_mfma_f32_16x16x32_bf16 a[136:139], v[168:171], v[208:211], a[136:139]
v_exp_f32 v142, v142
v_mfma_f32_16x16x32_bf16 a[136:139], v[184:187], v[212:215], a[136:139]
v_add_f32 v227, v227, v140
v_mfma_f32_16x16x32_bf16 a[140:143], v[172:175], v[208:211], a[140:143]
ds_read_b64_tr_b16 v[208:209], v246 offset:8704
ds_read_b64_tr_b16 v[210:211], v246 offset:10752
v_mfma_f32_16x16x32_bf16 a[140:143], v[188:191], v[212:215], a[140:143]
ds_read_b64_tr_b16 v[212:213], v246 offset:25088
s_waitcnt lgkmcnt(3)
v_mfma_f32_16x16x32_bf16 a[144:147], v[160:163], v[216:219], a[144:147]
ds_read_b64_tr_b16 v[214:215], v246 offset:27136
v_mfma_f32_16x16x32_bf16 a[144:147], v[176:179], v[220:223], a[144:147]
v_exp_f32 v143, v143
v_mfma_f32_16x16x32_bf16 a[148:151], v[164:167], v[216:219], a[148:151]
v_add_f32 v227, v227, v141
v_add_f32 v227, v227, v142
v_mfma_f32_16x16x32_bf16 a[148:151], v[180:183], v[220:223], a[148:151]
v_add_f32 v227, v227, v143
v_max3_f32 v242, v224, v225, v226
v_mfma_f32_16x16x32_bf16 a[152:155], v[168:171], v[216:219], a[152:155]
v_max_f32 v242, v242, v227
v_mfma_f32_16x16x32_bf16 a[152:155], v[184:187], v[220:223], a[152:155]
v_cmp_lt_f32 vcc, s32, v242
v_mfma_f32_16x16x32_bf16 a[156:159], v[172:175], v[216:219], a[156:159]
ds_read_b64_tr_b16 v[216:217], v247 offset:8704
ds_read_b64_tr_b16 v[218:219], v247 offset:10752
v_mfma_f32_16x16x32_bf16 a[156:159], v[188:191], v[220:223], a[156:159]
ds_read_b64_tr_b16 v[220:221], v247 offset:25088
s_waitcnt lgkmcnt(3)
v_mfma_f32_16x16x32_bf16 a[160:163], v[160:163], v[208:211], a[160:163]
ds_read_b64_tr_b16 v[222:223], v247 offset:27136
s_cbranch_vccnz L2_rare_site2
L2_ret2:
v_mfma_f32_16x16x32_bf16 a[160:163], v[176:179], v[212:215], a[160:163]
v_exp_f32 v144, v144
v_mfma_f32_16x16x32_bf16 a[164:167], v[164:167], v[208:211], a[164:167]
v_exp_f32 v145, v145
v_mfma_f32_16x16x32_bf16 a[164:167], v[180:183], v[212:215], a[164:167]
v_exp_f32 v146, v146
v_mfma_f32_16x16x32_bf16 a[168:171], v[168:171], v[208:211], a[168:171]
s_mov_b32 m0, s30
v_add_f32 v224, v224, v144
v_mfma_f32_16x16x32_bf16 a[168:171], v[184:187], v[212:215], a[168:171]
buffer_load_dwordx4 v241, s[12:15], s28 offen offset:0 sc1 lds
v_mfma_f32_16x16x32_bf16 a[172:175], v[172:175], v[208:211], a[172:175]
ds_read_b64_tr_b16 v[208:209], v246 offset:12288
ds_read_b64_tr_b16 v[210:211], v246 offset:14336
v_mfma_f32_16x16x32_bf16 a[172:175], v[188:191], v[212:215], a[172:175]
ds_read_b64_tr_b16 v[212:213], v246 offset:28672
s_waitcnt lgkmcnt(3)
v_mfma_f32_16x16x32_bf16 a[176:179], v[160:163], v[216:219], a[176:179]
ds_read_b64_tr_b16 v[214:215], v246 offset:30720
v_mfma_f32_16x16x32_bf16 a[176:179], v[176:179], v[220:223], a[176:179]
buffer_load_dwordx4 v241, s[12:15], s28 offen offset:1024 sc1 lds
v_mfma_f32_16x16x32_bf16 a[180:183], v[164:167], v[216:219], a[180:183]
v_exp_f32 v147, v147
v_mfma_f32_16x16x32_bf16 a[180:183], v[180:183], v[220:223], a[180:183]
v_add_f32 v224, v224, v145
v_add_f32 v224, v224, v146
v_mfma_f32_16x16x32_bf16 a[184:187], v[168:171], v[216:219], a[184:187]
v_add_f32 v224, v224, v147
v_mfma_f32_16x16x32_bf16 a[184:187], v[184:187], v[220:223], a[184:187]
buffer_load_dwordx4 v241, s[12:15], s28 offen offset:2048 sc1 lds
v_mfma_f32_16x16x32_bf16 a[188:191], v[172:175], v[216:219], a[188:191]
ds_read_b64_tr_b16 v[216:217], v247 offset:12288
ds_read_b64_tr_b16 v[218:219], v247 offset:14336
v_mfma_f32_16x16x32_bf16 a[188:191], v[188:191], v[220:223], a[188:191]
ds_read_b64_tr_b16 v[220:221], v247 offset:28672
s_waitcnt lgkmcnt(3)
v_mfma_f32_16x16x32_bf16 a[192:195], v[160:163], v[208:211], a[192:195]
ds_read_b64_tr_b16 v[222:223], v247 offset:30720
v_mfma_f32_16x16x32_bf16 a[192:195], v[176:179], v[212:215], a[192:195]
buffer_load_dwordx4 v241, s[12:15], s28 offen offset:3072 sc1 lds
v_mfma_f32_16x16x32_bf16 a[196:199], v[164:167], v[208:211], a[196:199]
v_exp_f32 v148, v148
v_mfma_f32_16x16x32_bf16 a[196:199], v[180:183], v[212:215], a[196:199]
v_exp_f32 v149, v149
v_mfma_f32_16x16x32_bf16 a[200:203], v[168:171], v[208:211], a[200:203]
v_exp_f32 v150, v150
v_mfma_f32_16x16x32_bf16 a[200:203], v[184:187], v[212:215], a[200:203]
v_add_f32 v225, v225, v148
v_mfma_f32_16x16x32_bf16 a[204:207], v[172:175], v[208:211], a[204:207]
ds_read_b64_tr_b16 v[208:209], v246 offset:12800
ds_read_b64_tr_b16 v[210:211], v246 offset:14848
v_mfma_f32_16x16x32_bf16 a[204:207], v[188:191], v[212:215], a[204:207]
ds_read_b64_tr_b16 v[212:213], v246 offset:29184
s_waitcnt lgkmcnt(3)
v_mfma_f32_16x16x32_bf16 a[208:211], v[160:163], v[216:219], a[208:211]
ds_read_b64_tr_b16 v[214:215], v246 offset:31232
v_mfma_f32_16x16x32_bf16 a[208:211], v[176:179], v[220:223], a[208:211]
v_exp_f32 v151, v151
v_mfma_f32_16x16x32_bf16 a[212:215], v[164:167], v[216:219], a[212:215]
v_add_f32 v225, v225, v149
v_add_f32 v225, v225, v150
v_mfma_f32_16x16x32_bf16 a[212:215], v[180:183], v[220:223], a[212:215]
v_add_f32 v225, v225, v151
v_mfma_f32_16x16x32_bf16 a[216:219], v[168:171], v[216:219], a[216:219]
v_exp_f32 v152, v152
v_mfma_f32_16x16x32_bf16 a[216:219], v[184:187], v[220:223], a[216:219]
v_exp_f32 v153, v153
v_mfma_f32_16x16x32_bf16 a[220:223], v[172:175], v[216:219], a[220:223]
ds_read_b64_tr_b16 v[216:217], v247 offset:12800
ds_read_b64_tr_b16 v[218:219], v247 offset:14848
v_mfma_f32_16x16x32_bf16 a[220:223], v[188:191], v[220:223], a[220:223]
ds_read_b64_tr_b16 v[220:221], v247 offset:29184
s_waitcnt lgkmcnt(3)
v_mfma_f32_16x16x32_bf16 a[224:227], v[160:163], v[208:211], a[224:227]
ds_read_b64_tr_b16 v[222:223], v247 offset:31232
v_mfma_f32_16x16x32_bf16 a[224:227], v[176:179], v[212:215], a[224:227]
s_waitcnt vmcnt(4)
s_barrier
v_mfma_f32_16x16x32_bf16 a[228:231], v[164:167], v[208:211], a[228:231]
v_exp_f32 v154, v154
v_mfma_f32_16x16x32_bf16 a[228:231], v[180:183], v[212:215], a[228:231]
v_add_f32 v226, v226, v152
v_mfma_f32_16x16x32_bf16 a[232:235], v[168:171], v[208:211], a[232:235]
v_exp_f32 v155, v155
v_mfma_f32_16x16x32_bf16 a[232:235], v[184:187], v[212:215], a[232:235]
v_add_f32 v226, v226, v153
v_add_f32 v226, v226, v154
v_mfma_f32_16x16x32_bf16 a[236:239], v[172:175], v[208:211], a[236:239]
ds_read_b128 v[208:211], v240 offset:16384
v_add_f32 v226, v226, v155
v_mfma_f32_16x16x32_bf16 a[236:239], v[188:191], v[212:215], a[236:239]
ds_read_b128 v[212:215], v240 offset:16896
s_waitcnt lgkmcnt(2)
v_mfma_f32_16x16x32_bf16 a[240:243], v[160:163], v[216:219], a[240:243]
v_exp_f32 v156, v156
v_mfma_f32_16x16x32_bf16 a[240:243], v[176:179], v[220:223], a[240:243]
v_cvt_pk_bf16_f32 v160, v128, v129
v_cvt_pk_bf16_f32 v161, v130, v131
v_mfma_f32_16x16x32_bf16 a[244:247], v[164:167], v[216:219], a[244:247]
v_exp_f32 v157, v157
v_mfma_f32_16x16x32_bf16 a[244:247], v[180:183], v[220:223], a[244:247]
v_cvt_pk_bf16_f32 v164, v132, v133
v_cvt_pk_bf16_f32 v165, v134, v135
v_mfma_f32_16x16x32_bf16 a[248:251], v[168:171], v[216:219], a[248:251]
v_exp_f32 v158, v158
v_mfma_f32_16x16x32_bf16 a[248:251], v[184:187], v[220:223], a[248:251]
v_cvt_pk_bf16_f32 v168, v136, v137
v_cvt_pk_bf16_f32 v169, v138, v139
v_mfma_f32_16x16x32_bf16 a[252:255], v[172:175], v[216:219], a[252:255]
ds_read_b128 v[216:219], v240 offset:20480
v_add_f32 v227, v227, v156
v_mfma_f32_16x16x32_bf16 a[252:255], v[188:191], v[220:223], a[252:255]
ds_read_b128 v[220:223], v240 offset:20992
s_waitcnt lgkmcnt(2)
v_mfma_f32_16x16x32_bf16 v[128:131], v[208:211], v[0:3], v[192:195]
v_exp_f32 v159, v159
v_mfma_f32_16x16x32_bf16 v[128:131], v[212:215], v[4:7], v[128:131]
v_cvt_pk_bf16_f32 v172, v140, v141
v_cvt_pk_bf16_f32 v173, v142, v143
v_mfma_f32_16x16x32_bf16 v[132:135], v[208:211], v[32:35], v[196:199]
v_add_f32 v227, v227, v157
v_add_f32 v227, v227, v158
v_mfma_f32_16x16x32_bf16 v[132:135], v[212:215], v[36:39], v[132:135]
v_add_f32 v227, v227, v159
v_max3_f32 v242, v224, v225, v226
v_mfma_f32_16x16x32_bf16 v[136:139], v[208:211], v[64:67], v[200:203]
v_max_f32 v242, v242, v227
v_mfma_f32_16x16x32_bf16 v[136:139], v[212:215], v[68:71], v[136:139]
v_cmp_lt_f32 vcc, s32, v242
v_mfma_f32_16x16x32_bf16 v[140:143], v[208:211], v[96:99], v[204:207]
ds_read_b128 v[208:211], v240 offset:24576
v_mfma_f32_16x16x32_bf16 v[140:143], v[212:215], v[100:103], v[140:143]
ds_read_b128 v[212:215], v240 offset:25088
s_waitcnt lgkmcnt(2)
v_mfma_f32_16x16x32_bf16 v[128:131], v[216:219], v[8:11], v[128:131]
v_mov_b32 v244, v246
v_mov_b32 v245, v247
v_mfma_f32_16x16x32_bf16 v[128:131], v[220:223], v[12:15], v[128:131]
v_add_u32 v246, 0x8000, v246
s_cbranch_vccnz L2_rare_site3
L2_ret3:
v_mfma_f32_16x16x32_bf16 v[132:135], v[216:219], v[40:43], v[132:135]
v_and_b32 v246, 0x1ffff, v246
v_cvt_pk_bf16_f32 v162, v144, v145
v_mfma_f32_16x16x32_bf16 v[132:135], v[220:223], v[44:47], v[132:135]
v_cvt_pk_bf16_f32 v163, v146, v147
v_cvt_pk_bf16_f32 v166, v148, v149
v_mfma_f32_16x16x32_bf16 v[136:139], v[216:219], v[72:75], v[136:139]
v_xor_b32 v247, 32, v246
v_cvt_pk_bf16_f32 v167, v150, v151
v_mfma_f32_16x16x32_bf16 v[136:139], v[220:223], v[76:79], v[136:139]
v_cvt_pk_bf16_f32 v170, v152, v153
v_cvt_pk_bf16_f32 v171, v154, v155
v_mfma_f32_16x16x32_bf16 v[140:143], v[216:219], v[104:107], v[140:143]
ds_read_b128 v[216:219], v240 offset:28672
v_cvt_pk_bf16_f32 v174, v156, v157
v_mfma_f32_16x16x32_bf16 v[140:143], v[220:223], v[108:111], v[140:143]
ds_read_b128 v[220:223], v240 offset:29184
s_waitcnt lgkmcnt(2)
v_mfma_f32_16x16x32_bf16 v[128:131], v[208:211], v[16:19], v[128:131]
v_cvt_pk_bf16_f32 v175, v158, v159
v_mfma_f32_16x16x32_bf16 v[128:131], v[212:215], v[20:23], v[128:131]
v_mfma_f32_16x16x32_bf16 v[132:135], v[208:211], v[48:51], v[132:135]
v_mfma_f32_16x16x32_bf16 v[132:135], v[212:215], v[52:55], v[132:135]
v_mfma_f32_16x16x32_bf16 v[136:139], v[208:211], v[80:83], v[136:139]
v_mfma_f32_16x16x32_bf16 v[136:139], v[212:215], v[84:87], v[136:139]
s_sub_u32 s31, s31, 1
v_mfma_f32_16x16x32_bf16 v[140:143], v[208:211], v[112:115], v[140:143]
ds_read_b128 v[208:211], v240 offset:18432
v_mfma_f32_16x16x32_bf16 v[140:143], v[212:215], v[116:119], v[140:143]
ds_read_b128 v[212:215], v240 offset:18944
s_waitcnt lgkmcnt(2)
v_mfma_f32_16x16x32_bf16 v[128:131], v[216:219], v[24:27], v[128:131]
s_add_u32 s28, s28, s101
s_add_u32 s30, s30, 0x4000
v_mfma_f32_16x16x32_bf16 v[128:131], v[220:223], v[28:31], v[128:131]
s_and_b32 s30, s30, 0x1ffff
v_mfma_f32_16x16x32_bf16 v[132:135], v[216:219], v[56:59], v[132:135]
s_cmp_eq_u32 s31, 0
v_mfma_f32_16x16x32_bf16 v[132:135], v[220:223], v[60:63], v[132:135]
v_mfma_f32_16x16x32_bf16 v[136:139], v[216:219], v[88:91], v[136:139]
v_mfma_f32_16x16x32_bf16 v[136:139], v[220:223], v[92:95], v[136:139]
v_mfma_f32_16x16x32_bf16 v[140:143], v[216:219], v[120:123], v[140:143]
ds_read_b128 v[216:219], v240 offset:22528
v_mfma_f32_16x16x32_bf16 v[140:143], v[220:223], v[124:127], v[140:143]
ds_read_b128 v[220:223], v240 offset:23040
s_cbranch_scc0 L2_loop
s_cmp_eq_u32 s100, 0
s_cbranch_scc1 L2_tail_0
s_mov_b32 s3, 0
s_branch L2_ev
L2_x1:
s_cmp_eq_u32 s100, 0
s_cbranch_scc1 L2_tail_1
s_mov_b32 s3, 1
L2_ev:
s_sub_u32 s100, s100, 1
s_mov_b32 s31, 1
v_mov_b32 v230, 0x20000
s_cmp_eq_u32 s100, 0
s_cbranch_scc1 L2_ev5
s_cmp_lg_u32 s34, 0
s_cbranch_scc1 L2_evr
s_mov_b64 exec, 1
s_cmp_eq_u32 s100, 4
s_cbranch_scc1 L2_ev1
s_cmp_eq_u32 s100, 1
s_cbranch_scc1 L2_ev4
v_cmp_eq_u64 vcc, s[98:99], v[228:229]
s_nop 1
s_bitcmp1_b32 vcc_lo, 0
s_subb_u32 s39, s39, 0
v_mov_b32 v228, s98
v_mov_b32 v229, s99
s_cmp_eq_u32 s100, 2
s_cbranch_scc1 L2_ev3
buffer_atomic_swap_x2 v[228:229], off, s[16:19], s49 offset:0 sc0 sc1
s_branch L2_evx
L2_ev1:
v_mov_b32 v228, s98
v_mov_b32 v229, s99
buffer_atomic_swap_x2 v[228:229], off, s[16:19], s95 offset:16 sc0 sc1
s_branch L2_evx
L2_ev3:
v_mov_b32 v252, s98
v_mov_b32 v253, s99
buffer_atomic_swap_x2 v[228:229], off, s[16:19], s35 offset:0 sc0 sc1
buffer_atomic_swap_x2 v[252:253], off, s[16:19], s94 offset:16 sc0 sc1
s_branch L2_evx
L2_ev4:
v_cmp_ne_u64 vcc, s[98:99], v[228:229]
s_nop 1
s_bitcmp1_b32 vcc_lo, 0
s_addc_u32 s39, s39, 0
v_cmp_ne_u64 vcc, s[98:99], v[252:253]
s_nop 1
s_bitcmp1_b32 vcc_lo, 0
s_addc_u32 s39, s39, 0
v_mov_b32 v228, s39
ds_write_b32 v230, v228
L2_evx:
s_mov_b64 exec, -1
s_branch L2_evr
L2_ev5:
ds_read_b32 v228, v230
s_waitcnt lgkmcnt(0)
v_readfirstlane_b32 s31, v228
L2_evr:
s_cmp_eq_u32 s3, 0
s_cbranch_scc1 L2_loop
s_branch L2_loop1
L2_tail_0:
s_waitcnt lgkmcnt(2)
v_add_u32 v231, s50, v243
v_mfma_f32_16x16x32_bf16 v[144:147], v[208:211], v[0:3], v[192:195]
s_mov_b32 m0, s30
ds_write_b128 v231, v[176:179] offset:0
v_mfma_f32_16x16x32_bf16 v[144:147], v[212:215], v[4:7], v[144:147]
buffer_load_dwordx4 v241, s[12:15], s28 offen offset:0 sc1 lds
ds_write_b128 v231, v[180:183] offset:1024
v_mfma_f32_16x16x32_bf16 v[148:151], v[208:211], v[32:35], v[196:199]
buffer_load_dwordx4 v241, s[12:15], s28 offen offset:1024 sc1 lds
ds_write_b128 v231, v[184:187] offset:2048
v_mfma_f32_16x16x32_bf16 v[148:151], v[212:215], v[36:39], v[148:151]
buffer_load_dwordx4 v241, s[12:15], s28 offen offset:2048 sc1 lds
ds_write_b128 v231, v[188:191] offset:3072
v_mfma_f32_16x16x32_bf16 v[152:155], v[208:211], v[64:67], v[200:203]
buffer_load_dwordx4 v241, s[12:15], s28 offen offset:3072 sc1 lds
v_add_u32 v230, 0x8000, v240
v_and_b32 v230, 0x1ffff, v230
v_mfma_f32_16x16x32_bf16 v[152:155], v[212:215], v[68:71], v[152:155]
v_exp_f32 v232, v128
v_mfma_f32_16x16x32_bf16 v[156:159], v[208:211], v[96:99], v[204:207]
ds_read_b128 v[208:211], v240 offset:26624
v_exp_f32 v233, v129
v_mfma_f32_16x16x32_bf16 v[156:159], v[212:215], v[100:103], v[156:159]
ds_read_b128 v[212:215], v240 offset:27136
s_waitcnt lgkmcnt(2)
s_and_b32 s30, s30, 0x1c000
v_mfma_f32_16x16x32_bf16 v[144:147], v[216:219], v[8:11], v[144:147]
v_exp_f32 v234, v130
v_add_f32 v224, v224, v232
v_mfma_f32_16x16x32_bf16 v[144:147], v[220:223], v[12:15], v[144:147]
v_cvt_pk_bf16_f32 v176, v232, v233
v_exp_f32 v235, v131
v_mfma_f32_16x16x32_bf16 v[148:151], v[216:219], v[40:43], v[148:151]
v_add_f32 v224, v224, v233
v_add_f32 v224, v224, v234
v_add_f32 v224, v224, v235
v_mfma_f32_16x16x32_bf16 v[148:151], v[220:223], v[44:47], v[148:151]
v_cvt_pk_bf16_f32 v177, v234, v235
v_exp_f32 v236, v132
v_mfma_f32_16x16x32_bf16 v[152:155], v[216:219], v[72:75], v[152:155]
v_exp_f32 v237, v133
s_add_u32 s28, s30, 0xc000
v_mfma_f32_16x16x32_bf16 v[152:155], v[220:223], v[76:79], v[152:155]
v_exp_f32 v238, v134
v_add_f32 v225, v225, v236
v_mfma_f32_16x16x32_bf16 v[156:159], v[216:219], v[104:107], v[156:159]
ds_read_b128 v[216:219], v240 offset:30720
v_cvt_pk_bf16_f32 v180, v236, v237
s_and_b32 s28, s28, 0x1ffff
v_mfma_f32_16x16x32_bf16 v[156:159], v[220:223], v[108:111], v[156:159]
ds_read_b128 v[220:223], v240 offset:31232
s_waitcnt lgkmcnt(2)
s_add_u32 s30, s30, 0x4000
v_mfma_f32_16x16x32_bf16 v[144:147], v[208:211], v[16:19], v[144:147]
v_exp_f32 v239, v135
v_add_f32 v225, v225, v237
v_mfma_f32_16x16x32_bf16 v[144:147], v[212:215], v[20:23], v[144:147]
s_waitcnt vmcnt(4)
s_barrier
v_add_f32 v225, v225, v238
v_mfma_f32_16x16x32_bf16 v[148:151], v[208:211], v[48:51], v[148:151]
v_add_f32 v225, v225, v239
v_cvt_pk_bf16_f32 v181, v238, v239
s_and_b32 s30, s30, 0x1ffff
v_mfma_f32_16x16x32_bf16 v[148:151], v[212:215], v[52:55], v[148:151]
v_exp_f32 v232, v136
s_mul_i32 s31, s34, 6144
v_mfma_f32_16x16x32_bf16 v[152:155], v[208:211], v[80:83], v[152:155]
v_exp_f32 v233, v137
s_add_u32 s31, s31, s30
v_mfma_f32_16x16x32_bf16 v[152:155], v[212:215], v[84:87], v[152:155]
v_exp_f32 v234, v138
v_add_f32 v226, v226, v232
v_mfma_f32_16x16x32_bf16 v[156:159], v[208:211], v[112:115], v[156:159]
ds_read_b128 v[208:211], v230 offset:0
v_cvt_pk_bf16_f32 v184, v232, v233
s_lshl_b32 s3, s34, 10
v_mfma_f32_16x16x32_bf16 v[156:159], v[212:215], v[116:119], v[156:159]
ds_read_b128 v[212:215], v230 offset:512
s_waitcnt lgkmcnt(2)
s_add_u32 s28, s28, s3
v_mfma_f32_16x16x32_bf16 v[144:147], v[216:219], v[24:27], v[144:147]
v_exp_f32 v235, v139
v_add_f32 v226, v226, v233
v_mfma_f32_16x16x32_bf16 v[144:147], v[220:223], v[28:31], v[144:147]
v_add_f32 v226, v226, v234
v_add_f32 v226, v226, v235
v_cvt_pk_bf16_f32 v185, v234, v235
v_mfma_f32_16x16x32_bf16 v[148:151], v[216:219], v[56:59], v[148:151]
v_exp_f32 v236, v140
s_add_u32 s3, s3, 24576
v_mfma_f32_16x16x32_bf16 v[148:151], v[220:223], v[60:63], v[148:151]
v_exp_f32 v237, v141
s_add_u32 s30, s30, s3
v_mfma_f32_16x16x32_bf16 v[152:155], v[216:219], v[88:91], v[152:155]
v_exp_f32 v238, v142
v_add_f32 v227, v227, v236
v_mfma_f32_16x16x32_bf16 v[152:155], v[220:223], v[92:95], v[152:155]
v_cvt_pk_bf16_f32 v188, v236, v237
v_exp_f32 v239, v143
v_mfma_f32_16x16x32_bf16 v[156:159], v[216:219], v[120:123], v[156:159]
ds_read_b128 v[216:219], v230 offset:4096
v_add_f32 v227, v227, v237
v_add_f32 v227, v227, v238
v_mfma_f32_16x16x32_bf16 v[156:159], v[220:223], v[124:127], v[156:159]
ds_read_b128 v[220:223], v230 offset:4608
s_waitcnt lgkmcnt(2)
v_add_f32 v227, v227, v239
v_cvt_pk_bf16_f32 v189, v238, v239
v_max3_f32 v242, v224, v225, v226
v_max_f32 v242, v242, v227
v_cmp_lt_f32 vcc, s32, v242
s_cbranch_vccnz L2_rare_site6
L2_ret6:
v_mfma_f32_16x16x32_bf16 v[128:131], v[208:211], v[0:3], v[192:195]
v_lshrrev_b32 v241, 4, v243
v_and_b32 v241, 0x30, v241
v_xor_b32 v241, v241, v243
v_and_b32 v228, 0x380, v243
v_mad_u32_u24 v241, v228, 3, v241
v_mfma_f32_16x16x32_bf16 v[128:131], v[212:215], v[4:7], v[128:131]
v_exp_f32 v232, v144
v_mfma_f32_16x16x32_bf16 v[132:135], v[208:211], v[32:35], v[196:199]
v_exp_f32 v233, v145
v_mfma_f32_16x16x32_bf16 v[132:135], v[212:215], v[36:39], v[132:135]
v_exp_f32 v234, v146
v_add_f32 v224, v224, v232
v_mfma_f32_16x16x32_bf16 v[136:139], v[208:211], v[64:67], v[200:203]
v_cvt_pk_bf16_f32 v178, v232, v233
v_exp_f32 v235, v147
v_mfma_f32_16x16x32_bf16 v[136:139], v[212:215], v[68:71], v[136:139]
v_add_f32 v224, v224, v233
v_add_f32 v224, v224, v234
v_add_f32 v224, v224, v235
v_mfma_f32_16x16x32_bf16 v[140:143], v[208:211], v[96:99], v[204:207]
ds_read_b128 v[208:211], v230 offset:8192
v_cvt_pk_bf16_f32 v179, v234, v235
v_mfma_f32_16x16x32_bf16 v[140:143], v[212:215], v[100:103], v[140:143]
ds_read_b128 v[212:215], v230 offset:8704
s_waitcnt lgkmcnt(2)
v_mfma_f32_16x16x32_bf16 v[128:131], v[216:219], v[8:11], v[128:131]
ds_write_b128 v231, v[160:163] offset:4096
v_exp_f32 v236, v148
v_mfma_f32_16x16x32_bf16 v[128:131], v[220:223], v[12:15], v[128:131]
ds_write_b128 v231, v[164:167] offset:5120
v_exp_f32 v237, v149
v_mfma_f32_16x16x32_bf16 v[132:135], v[216:219], v[40:43], v[132:135]
ds_write_b128 v231, v[168:171] offset:6144
v_exp_f32 v238, v150
v_mfma_f32_16x16x32_bf16 v[132:135], v[220:223], v[44:47], v[132:135]
ds_write_b128 v231, v[172:175] offset:7168
v_add_f32 v225, v225, v236
v_cvt_pk_bf16_f32 v182, v236, v237
v_mfma_f32_16x16x32_bf16 v[136:139], v[216:219], v[72:75], v[136:139]
v_exp_f32 v239, v151
v_add_f32 v225, v225, v237
v_mfma_f32_16x16x32_bf16 v[136:139], v[220:223], v[76:79], v[136:139]
v_add_f32 v225, v225, v238
v_add_f32 v225, v225, v239
v_cvt_pk_bf16_f32 v183, v238, v239
v_mfma_f32_16x16x32_bf16 v[140:143], v[216:219], v[104:107], v[140:143]
ds_read_b128 v[216:219], v230 offset:12288
v_exp_f32 v232, v152
v_mfma_f32_16x16x32_bf16 v[140:143], v[220:223], v[108:111], v[140:143]
ds_read_b128 v[220:223], v230 offset:12800
s_waitcnt lgkmcnt(2)
v_mfma_f32_16x16x32_bf16 v[128:131], v[208:211], v[16:19], v[128:131]
v_exp_f32 v233, v153
v_mfma_f32_16x16x32_bf16 v[128:131], v[212:215], v[20:23], v[128:131]
v_exp_f32 v234, v154
v_add_f32 v226, v226, v232
v_mfma_f32_16x16x32_bf16 v[132:135], v[208:211], v[48:51], v[132:135]
v_cvt_pk_bf16_f32 v186, v232, v233
v_exp_f32 v235, v155
v_mfma_f32_16x16x32_bf16 v[132:135], v[212:215], v[52:55], v[132:135]
v_add_f32 v226, v226, v233
v_add_f32 v226, v226, v234
v_add_f32 v226, v226, v235
v_mfma_f32_16x16x32_bf16 v[136:139], v[208:211], v[80:83], v[136:139]
v_cvt_pk_bf16_f32 v187, v234, v235
v_exp_f32 v236, v156
v_mfma_f32_16x16x32_bf16 v[136:139], v[212:215], v[84:87], v[136:139]
v_exp_f32 v237, v157
v_mfma_f32_16x16x32_bf16 v[140:143], v[208:211], v[112:115], v[140:143]
ds_read_b128 v[208:211], v230 offset:2048
v_exp_f32 v238, v158
v_mfma_f32_16x16x32_bf16 v[140:143], v[212:215], v[116:119], v[140:143]
ds_read_b128 v[212:215], v230 offset:2560
s_waitcnt lgkmcnt(2)
v_add_f32 v227, v227, v236
v_mfma_f32_16x16x32_bf16 v[128:131], v[216:219], v[24:27], v[128:131]
v_cvt_pk_bf16_f32 v190, v236, v237
v_exp_f32 v239, v159
v_mfma_f32_16x16x32_bf16 v[128:131], v[220:223], v[28:31], v[128:131]
v_add_f32 v227, v227, v237
v_add_f32 v227, v227, v238
v_add_f32 v227, v227, v239
v_mfma_f32_16x16x32_bf16 v[132:135], v[216:219], v[56:59], v[132:135]
v_cvt_pk_bf16_f32 v191, v238, v239
v_max3_f32 v242, v224, v225, v226
v_max_f32 v242, v242, v227
v_mfma_f32_16x16x32_bf16 v[132:135], v[220:223], v[60:63], v[132:135]
v_cmp_lt_f32 vcc, s32, v242
s_cbranch_vccnz L2_rare_site7
L2_ret7:
v_mfma_f32_16x16x32_bf16 v[136:139], v[216:219], v[88:91], v[136:139]
s_add_u32 m0, s31, 0
v_mfma_f32_16x16x32_bf16 v[136:139], v[220:223], v[92:95], v[136:139]
buffer_load_dwordx4 v241, s[8:11], s6 offen lds
s_add_u32 m0, s31, 2048
v_mfma_f32_16x16x32_bf16 v[140:143], v[216:219], v[120:123], v[140:143]
ds_read_b128 v[216:219], v230 offset:6144
buffer_load_dwordx4 v241, s[8:11], s7 offen lds
s_add_u32 m0, s31, 4096
v_mfma_f32_16x16x32_bf16 v[140:143], v[220:223], v[124:127], v[140:143]
ds_read_b128 v[220:223], v230 offset:6656
s_waitcnt lgkmcnt(2)
v_mfma_f32_16x16x32_bf16 v[144:147], v[208:211], v[0:3], v[192:195]
buffer_load_dwordx4 v241, s[8:11], s29 offen lds
s_add_u32 m0, s31, 1024
v_xor_b32 v241, 0x1040, v241
v_mfma_f32_16x16x32_bf16 v[144:147], v[212:215], v[4:7], v[144:147]
v_exp_f32 v232, v128
v_mfma_f32_16x16x32_bf16 v[148:151], v[208:211], v[32:35], v[196:199]
v_exp_f32 v233, v129
v_mfma_f32_16x16x32_bf16 v[148:151], v[212:215], v[36:39], v[148:151]
v_exp_f32 v234, v130
v_add_f32 v224, v224, v232
v_mfma_f32_16x16x32_bf16 v[152:155], v[208:211], v[64:67], v[200:203]
v_cvt_pk_bf16_f32 v160, v232, v233
v_exp_f32 v235, v131
v_mfma_f32_16x16x32_bf16 v[152:155], v[212:215], v[68:71], v[152:155]
v_add_f32 v224, v224, v233
v_add_f32 v224, v224, v234
v_add_f32 v224, v224, v235
v_mfma_f32_16x16x32_bf16 v[156:159], v[208:211], v[96:99], v[204:207]
ds_read_b128 v[208:211], v230 offset:10240
v_cvt_pk_bf16_f32 v161, v234, v235
v_mfma_f32_16x16x32_bf16 v[156:159], v[212:215], v[100:103], v[156:159]
ds_read_b128 v[212:215], v230 offset:10752
s_waitcnt lgkmcnt(2)
v_mfma_f32_16x16x32_bf16 v[144:147], v[216:219], v[8:11], v[144:147]
v_exp_f32 v236, v132
v_mfma_f32_16x16x32_bf16 v[144:147], v[220:223], v[12:15], v[144:147]
v_exp_f32 v237, v133
v_mfma_f32_16x16x32_bf16 v[148:151], v[216:219], v[40:43], v[148:151]
v_exp_f32 v238, v134
v_add_f32 v225, v225, v236
v_mfma_f32_16x16x32_bf16 v[148:151], v[220:223], v[44:47], v[148:151]
v_cvt_pk_bf16_f32 v164, v236, v237
v_exp_f32 v239, v135
v_mfma_f32_16x16x32_bf16 v[152:155], v[216:219], v[72:75], v[152:155]
v_add_f32 v225, v225, v237
v_add_f32 v225, v225, v238
v_add_f32 v225, v225, v239
v_mfma_f32_16x16x32_bf16 v[152:155], v[220:223], v[76:79], v[152:155]
v_cvt_pk_bf16_f32 v165, v238, v239
v_exp_f32 v232, v136
v_mfma_f32_16x16x32_bf16 v[156:159], v[216:219], v[104:107], v[156:159]
ds_read_b128 v[216:219], v230 offset:14336
v_exp_f32 v233, v137
v_mfma_f32_16x16x32_bf16 v[156:159], v[220:223], v[108:111], v[156:159]
ds_read_b128 v[220:223], v230 offset:14848
s_waitcnt lgkmcnt(2)
v_mfma_f32_16x16x32_bf16 v[144:147], v[208:211], v[16:19], v[144:147]
v_exp_f32 v234, v138
v_add_f32 v226, v226, v232
v_mfma_f32_16x16x32_bf16 v[144:147], v[212:215], v[20:23], v[144:147]
s_waitcnt vmcnt(3)
s_barrier
v_cvt_pk_bf16_f32 v168, v232, v233
v_mfma_f32_16x16x32_bf16 v[148:151], v[208:211], v[48:51], v[148:151]
v_exp_f32 v235, v139
v_add_f32 v226, v226, v233
v_mfma_f32_16x16x32_bf16 v[148:151], v[212:215], v[52:55], v[148:151]
v_add_f32 v226, v226, v234
v_add_f32 v226, v226, v235
v_cvt_pk_bf16_f32 v169, v234, v235
v_mfma_f32_16x16x32_bf16 v[152:155], v[208:211], v[80:83], v[152:155]
v_exp_f32 v236, v140
v_mfma_f32_16x16x32_bf16 v[152:155], v[212:215], v[84:87], v[152:155]
v_exp_f32 v237, v141
v_mfma_f32_16x16x32_bf16 v[156:159], v[208:211], v[112:115], v[156:159]
ds_read_b128 v[208:211], v230 offset:16384
v_exp_f32 v238, v142
v_mfma_f32_16x16x32_bf16 v[156:159], v[212:215], v[116:119], v[156:159]
ds_read_b128 v[212:215], v230 offset:16896
s_waitcnt lgkmcnt(2)
v_add_f32 v227, v227, v236
v_mfma_f32_16x16x32_bf16 v[144:147], v[216:219], v[24:27], v[144:147]
v_cvt_pk_bf16_f32 v172, v236, v237
v_exp_f32 v239, v143
v_mfma_f32_16x16x32_bf16 v[144:147], v[220:223], v[28:31], v[144:147]
v_add_f32 v227, v227, v237
v_add_f32 v227, v227, v238
v_add_f32 v227, v227, v239
v_mfma_f32_16x16x32_bf16 v[148:151], v[216:219], v[56:59], v[148:151]
v_cvt_pk_bf16_f32 v173, v238, v239
v_max3_f32 v242, v224, v225, v226
v_max_f32 v242, v242, v227
v_mfma_f32_16x16x32_bf16 v[148:151], v[220:223], v[60:63], v[148:151]
v_cmp_lt_f32 vcc, s32, v242
s_cbranch_vccnz L2_rare_site8
L2_ret8:
v_mfma_f32_16x16x32_bf16 v[152:155], v[216:219], v[88:91], v[152:155]
buffer_load_dwordx4 v241, s[8:11], s6 offen lds
s_add_u32 m0, s31, 3072
v_mfma_f32_16x16x32_bf16 v[152:155], v[220:223], v[92:95], v[152:155]
buffer_load_dwordx4 v241, s[8:11], s7 offen lds
s_add_u32 m0, s31, 5120
v_mfma_f32_16x16x32_bf16 v[156:159], v[216:219], v[120:123], v[156:159]
ds_read_b128 v[216:219], v230 offset:20480
buffer_load_dwordx4 v241, s[8:11], s29 offen lds
v_mfma_f32_16x16x32_bf16 v[156:159], v[220:223], v[124:127], v[156:159]
ds_read_b128 v[220:223], v230 offset:20992
s_waitcnt lgkmcnt(2)
v_mfma_f32_16x16x32_bf16 v[128:131], v[208:211], v[0:3], v[192:195]
v_mfma_f32_16x16x32_bf16 v[128:131], v[212:215], v[4:7], v[128:131]
v_exp_f32 v232, v144
v_mfma_f32_16x16x32_bf16 v[132:135], v[208:211], v[32:35], v[196:199]
v_exp_f32 v233, v145
v_mfma_f32_16x16x32_bf16 v[132:135], v[212:215], v[36:39], v[132:135]
v_exp_f32 v234, v146
v_add_f32 v224, v224, v232
v_mfma_f32_16x16x32_bf16 v[136:139], v[208:211], v[64:67], v[200:203]
v_cvt_pk_bf16_f32 v162, v232, v233
v_exp_f32 v235, v147
v_mfma_f32_16x16x32_bf16 v[136:139], v[212:215], v[68:71], v[136:139]
v_add_f32 v224, v224, v233
v_add_f32 v224, v224, v234
v_add_f32 v224, v224, v235
v_mfma_f32_16x16x32_bf16 v[140:143], v[208:211], v[96:99], v[204:207]
ds_read_b128 v[208:211], v230 offset:24576
v_cvt_pk_bf16_f32 v163, v234, v235
v_lshlrev_b32 v241, 3, v243
v_mfma_f32_16x16x32_bf16 v[140:143], v[212:215], v[100:103], v[140:143]
ds_read_b128 v[212:215], v230 offset:25088
s_waitcnt lgkmcnt(2)
s_mov_b32 s3, 0x7c28000
v_mfma_f32_16x16x32_bf16 v[128:131], v[216:219], v[8:11], v[128:131]
v_exp_f32 v236, v148
buffer_load_dwordx2 v[240:241], v241, s[16:19], s3 offen sc1
v_mfma_f32_16x16x32_bf16 v[128:131], v[220:223], v[12:15], v[128:131]
v_exp_f32 v237, v149
v_mfma_f32_16x16x32_bf16 v[132:135], v[216:219], v[40:43], v[132:135]
v_exp_f32 v238, v150
v_add_f32 v225, v225, v236
v_mfma_f32_16x16x32_bf16 v[132:135], v[220:223], v[44:47], v[132:135]
v_cvt_pk_bf16_f32 v166, v236, v237
v_exp_f32 v239, v151
v_mfma_f32_16x16x32_bf16 v[136:139], v[216:219], v[72:75], v[136:139]
v_add_f32 v225, v225, v237
v_add_f32 v225, v225, v238
v_add_f32 v225, v225, v239
v_mfma_f32_16x16x32_bf16 v[136:139], v[220:223], v[76:79], v[136:139]
v_cvt_pk_bf16_f32 v167, v238, v239
v_exp_f32 v232, v152
v_mfma_f32_16x16x32_bf16 v[140:143], v[216:219], v[104:107], v[140:143]
ds_read_b128 v[216:219], v230 offset:28672
v_exp_f32 v233, v153
v_mfma_f32_16x16x32_bf16 v[140:143], v[220:223], v[108:111], v[140:143]
ds_read_b128 v[220:223], v230 offset:29184
s_waitcnt lgkmcnt(2)
v_mfma_f32_16x16x32_bf16 v[128:131], v[208:211], v[16:19], v[128:131]
v_exp_f32 v234, v154
v_add_f32 v226, v226, v232
v_mfma_f32_16x16x32_bf16 v[128:131], v[212:215], v[20:23], v[128:131]
v_cvt_pk_bf16_f32 v170, v232, v233
v_exp_f32 v235, v155
v_mfma_f32_16x16x32_bf16 v[132:135], v[208:211], v[48:51], v[132:135]
v_add_f32 v226, v226, v233
v_add_f32 v226, v226, v234
v_add_f32 v226, v226, v235
v_mfma_f32_16x16x32_bf16 v[132:135], v[212:215], v[52:55], v[132:135]
v_cvt_pk_bf16_f32 v171, v234, v235
v_exp_f32 v236, v156
v_mfma_f32_16x16x32_bf16 v[136:139], v[208:211], v[80:83], v[136:139]
v_exp_f32 v237, v157
v_mfma_f32_16x16x32_bf16 v[136:139], v[212:215], v[84:87], v[136:139]
v_exp_f32 v238, v158
v_add_f32 v227, v227, v236
v_mfma_f32_16x16x32_bf16 v[140:143], v[208:211], v[112:115], v[140:143]
ds_read_b128 v[208:211], v230 offset:18432
v_cvt_pk_bf16_f32 v174, v236, v237
v_mfma_f32_16x16x32_bf16 v[140:143], v[212:215], v[116:119], v[140:143]
ds_read_b128 v[212:215], v230 offset:18944
s_waitcnt lgkmcnt(2)
v_mfma_f32_16x16x32_bf16 v[128:131], v[216:219], v[24:27], v[128:131]
v_exp_f32 v239, v159
v_add_f32 v227, v227, v237
v_mfma_f32_16x16x32_bf16 v[128:131], v[220:223], v[28:31], v[128:131]
v_add_f32 v227, v227, v238
v_add_f32 v227, v227, v239
v_cvt_pk_bf16_f32 v175, v238, v239
v_mfma_f32_16x16x32_bf16 v[132:135], v[216:219], v[56:59], v[132:135]
v_max3_f32 v242, v224, v225, v226
v_max_f32 v242, v242, v227
v_cmp_lt_f32 vcc, s32, v242
s_cbranch_vccnz L2_rare_site9
L2_ret9:
v_mfma_f32_16x16x32_bf16 v[132:135], v[220:223], v[60:63], v[132:135]
v_mfma_f32_16x16x32_bf16 v[136:139], v[216:219], v[88:91], v[136:139]
v_mfma_f32_16x16x32_bf16 v[136:139], v[220:223], v[92:95], v[136:139]
v_mfma_f32_16x16x32_bf16 v[140:143], v[216:219], v[120:123], v[140:143]
ds_read_b128 v[216:219], v230 offset:22528
v_mfma_f32_16x16x32_bf16 v[140:143], v[220:223], v[124:127], v[140:143]
ds_read_b128 v[220:223], v230 offset:23040
s_waitcnt lgkmcnt(2)
v_mfma_f32_16x16x32_bf16 v[144:147], v[208:211], v[0:3], v[192:195]
v_mfma_f32_16x16x32_bf16 v[144:147], v[212:215], v[4:7], v[144:147]
v_mfma_f32_16x16x32_bf16 v[148:151], v[208:211], v[32:35], v[196:199]
v_mfma_f32_16x16x32_bf16 v[148:151], v[212:215], v[36:39], v[148:151]
v_mfma_f32_16x16x32_bf16 v[152:155], v[208:211], v[64:67], v[200:203]
v_exp_f32 v232, v128
v_mfma_f32_16x16x32_bf16 v[152:155], v[212:215], v[68:71], v[152:155]
v_exp_f32 v233, v129
v_mfma_f32_16x16x32_bf16 v[156:159], v[208:211], v[96:99], v[204:207]
ds_read_b128 v[208:211], v230 offset:26624
v_exp_f32 v234, v130
v_mfma_f32_16x16x32_bf16 v[156:159], v[212:215], v[100:103], v[156:159]
ds_read_b128 v[212:215], v230 offset:27136
s_waitcnt lgkmcnt(2)
v_add_f32 v224, v224, v232
v_mfma_f32_16x16x32_bf16 v[144:147], v[216:219], v[8:11], v[144:147]
v_cvt_pk_bf16_f32 v0, v232, v233
v_exp_f32 v235, v131
v_mfma_f32_16x16x32_bf16 v[144:147], v[220:223], v[12:15], v[144:147]
ds_read_b128 v[4:7], v231 offset:0
v_add_f32 v224, v224, v233
v_add_f32 v224, v224, v234
v_mfma_f32_16x16x32_bf16 v[148:151], v[216:219], v[40:43], v[148:151]
ds_read_b128 v[36:39], v231 offset:1024
v_add_f32 v224, v224, v235
v_cvt_pk_bf16_f32 v1, v234, v235
v_mfma_f32_16x16x32_bf16 v[148:151], v[220:223], v[44:47], v[148:151]
v_exp_f32 v236, v132
v_mfma_f32_16x16x32_bf16 v[152:155], v[216:219], v[72:75], v[152:155]
v_exp_f32 v237, v133
v_mfma_f32_16x16x32_bf16 v[152:155], v[220:223], v[76:79], v[152:155]
ds_read_b128 v[68:71], v231 offset:2048
ds_read_b128 v[8:11], v231 offset:4096
v_mfma_f32_16x16x32_bf16 v[156:159], v[216:219], v[104:107], v[156:159]
ds_read_b128 v[216:219], v230 offset:30720
v_add_u32 v12, 0x8000, v244
v_and_b32 v12, 0x1ffff, v12
ds_read_b128 v[100:103], v231 offset:3072
ds_read_b128 v[40:43], v231 offset:5120
v_mfma_f32_16x16x32_bf16 v[156:159], v[220:223], v[108:111], v[156:159]
ds_read_b128 v[220:223], v230 offset:31232
s_waitcnt lgkmcnt(2)
v_add_u32 v14, 0x10000, v244
v_and_b32 v14, 0x1ffff, v14
v_mfma_f32_16x16x32_bf16 v[144:147], v[208:211], v[16:19], v[144:147]
v_xor_b32 v13, 32, v12
v_xor_b32 v15, 32, v14
v_mfma_f32_16x16x32_bf16 v[144:147], v[212:215], v[20:23], v[144:147]
ds_read_b128 v[72:75], v231 offset:6144
v_exp_f32 v238, v134
v_mfma_f32_16x16x32_bf16 v[148:151], v[208:211], v[48:51], v[148:151]
ds_read_b128 v[104:107], v231 offset:7168
v_add_f32 v225, v225, v236
v_cvt_pk_bf16_f32 v32, v236, v237
v_mfma_f32_16x16x32_bf16 v[148:151], v[212:215], v[52:55], v[148:151]
v_exp_f32 v239, v135
v_add_f32 v225, v225, v237
v_mfma_f32_16x16x32_bf16 v[152:155], v[208:211], v[80:83], v[152:155]
v_add_f32 v225, v225, v238
v_add_f32 v225, v225, v239
v_cvt_pk_bf16_f32 v33, v238, v239
v_mfma_f32_16x16x32_bf16 v[152:155], v[212:215], v[84:87], v[152:155]
v_exp_f32 v232, v136
v_mfma_f32_16x16x32_bf16 v[156:159], v[208:211], v[112:115], v[156:159]
ds_read_b64_tr_b16 v[208:209], v244 offset:16384
ds_read_b64_tr_b16 v[210:211], v244 offset:18432
v_mfma_f32_16x16x32_bf16 v[156:159], v[212:215], v[116:119], v[156:159]
ds_read_b64_tr_b16 v[212:213], v12 offset:0
s_waitcnt lgkmcnt(3)
v_mfma_f32_16x16x32_bf16 v[144:147], v[216:219], v[24:27], v[144:147]
ds_read_b64_tr_b16 v[214:215], v12 offset:2048
v_exp_f32 v233, v137
v_mfma_f32_16x16x32_bf16 v[144:147], v[220:223], v[28:31], v[144:147]
v_exp_f32 v234, v138
v_add_f32 v226, v226, v232
v_mfma_f32_16x16x32_bf16 v[148:151], v[216:219], v[56:59], v[148:151]
v_cvt_pk_bf16_f32 v64, v232, v233
v_exp_f32 v235, v139
v_mfma_f32_16x16x32_bf16 v[148:151], v[220:223], v[60:63], v[148:151]
v_add_f32 v226, v226, v233
v_add_f32 v226, v226, v234
v_add_f32 v226, v226, v235
v_mfma_f32_16x16x32_bf16 v[152:155], v[216:219], v[88:91], v[152:155]
v_cvt_pk_bf16_f32 v65, v234, v235
v_exp_f32 v236, v140
v_mfma_f32_16x16x32_bf16 v[152:155], v[220:223], v[92:95], v[152:155]
v_exp_f32 v237, v141
s_waitcnt vmcnt(0)
v_mfma_f32_16x16x32_bf16 v[156:159], v[216:219], v[120:123], v[156:159]
ds_read_b64_tr_b16 v[216:217], v12 offset:16384
ds_read_b64_tr_b16 v[218:219], v12 offset:18432
v_cmp_ne_u64_e64 s[38:39], s[98:99], v[240:241]
v_mfma_f32_16x16x32_bf16 v[156:159], v[220:223], v[124:127], v[156:159]
ds_read_b64_tr_b16 v[220:221], v14 offset:0
s_waitcnt lgkmcnt(3)
v_exp_f32 v238, v142
v_add_f32 v227, v227, v236
v_cvt_pk_bf16_f32 v96, v236, v237
v_exp_f32 v239, v143
v_add_f32 v227, v227, v237
v_add_f32 v227, v227, v238
v_add_f32 v227, v227, v239
v_cvt_pk_bf16_f32 v97, v238, v239
v_max3_f32 v242, v224, v225, v226
v_max_f32 v242, v242, v227
v_cmp_lt_f32 vcc, s32, v242
s_cbranch_vccnz L2_rare_site10
L2_ret10:
v_mfma_f32_16x16x32_bf16 a[0:3], v[4:7], v[208:211], a[0:3]
ds_read_b64_tr_b16 v[222:223], v14 offset:2048
s_and_b64 s[38:39], s[38:39], s[96:97]
s_cbranch_scc1 LF_hl_1
LF_hlret_1:
v_mfma_f32_16x16x32_bf16 a[0:3], v[8:11], v[212:215], a[0:3]
v_exp_f32 v232, v144
v_lshrrev_b32 v241, 4, v243
v_mfma_f32_16x16x32_bf16 a[4:7], v[36:39], v[208:211], a[4:7]
v_exp_f32 v233, v145
v_and_b32 v241, 0x30, v241
v_mfma_f32_16x16x32_bf16 a[4:7], v[40:43], v[212:215], a[4:7]
v_exp_f32 v234, v146
v_xor_b32 v241, v241, v243
v_mfma_f32_16x16x32_bf16 a[8:11], v[68:71], v[208:211], a[8:11]
v_add_f32 v224, v224, v232
v_cvt_pk_bf16_f32 v2, v232, v233
v_mfma_f32_16x16x32_bf16 a[8:11], v[72:75], v[212:215], a[8:11]
v_exp_f32 v235, v147
v_mfma_f32_16x16x32_bf16 a[12:15], v[100:103], v[208:211], a[12:15]
ds_read_b64_tr_b16 v[208:209], v245 offset:16384
ds_read_b64_tr_b16 v[210:211], v245 offset:18432
v_mfma_f32_16x16x32_bf16 a[12:15], v[104:107], v[212:215], a[12:15]
ds_read_b64_tr_b16 v[212:213], v13 offset:0
s_waitcnt lgkmcnt(3)
v_mfma_f32_16x16x32_bf16 a[0:3], v[176:179], v[216:219], a[0:3]
ds_read_b64_tr_b16 v[214:215], v13 offset:2048
v_add_f32 v224, v224, v233
v_mfma_f32_16x16x32_bf16 a[0:3], v[160:163], v[220:223], a[0:3]
v_add_f32 v224, v224, v234
v_add_f32 v224, v224, v235
v_mfma_f32_16x16x32_bf16 a[4:7], v[180:183], v[216:219], a[4:7]
v_cvt_pk_bf16_f32 v3, v234, v235
v_and_b32 v228, 0x380, v243
v_mad_u32_u24 v241, v228, 3, v241
v_mfma_f32_16x16x32_bf16 a[4:7], v[164:167], v[220:223], a[4:7]
v_exp_f32 v236, v148
v_add_u32 v241, 0x7000000, v241
v_mfma_f32_16x16x32_bf16 a[8:11], v[184:187], v[216:219], a[8:11]
v_exp_f32 v237, v149
v_and_b32 v110, 0x70, v243
v_mfma_f32_16x16x32_bf16 a[8:11], v[168:171], v[220:223], a[8:11]
v_exp_f32 v238, v150
v_lshlrev_b32 v110, 3, v110
v_mfma_f32_16x16x32_bf16 a[12:15], v[188:191], v[216:219], a[12:15]
ds_read_b64_tr_b16 v[216:217], v13 offset:16384
ds_read_b64_tr_b16 v[218:219], v13 offset:18432
v_add_u32 v110, 0x7c32000, v110
v_mfma_f32_16x16x32_bf16 a[12:15], v[172:175], v[220:223], a[12:15]
ds_read_b64_tr_b16 v[220:221], v15 offset:0
s_waitcnt lgkmcnt(3)
buffer_load_dwordx2 v[108:109], v110, s[16:19], 0 offen sc1
v_mfma_f32_16x16x32_bf16 a[16:19], v[4:7], v[208:211], a[16:19]
ds_read_b64_tr_b16 v[222:223], v15 offset:2048
v_add_f32 v225, v225, v236
v_mfma_f32_16x16x32_bf16 a[16:19], v[8:11], v[212:215], a[16:19]
v_cvt_pk_bf16_f32 v34, v236, v237
s_add_u32 m0, s28, 0
v_mfma_f32_16x16x32_bf16 a[20:23], v[36:39], v[208:211], a[20:23]
v_exp_f32 v239, v151
v_mfma_f32_16x16x32_bf16 a[20:23], v[40:43], v[212:215], a[20:23]
v_add_f32 v225, v225, v237
v_add_f32 v225, v225, v238
v_mfma_f32_16x16x32_bf16 a[24:27], v[68:71], v[208:211], a[24:27]
v_add_f32 v225, v225, v239
v_cvt_pk_bf16_f32 v35, v238, v239
v_mfma_f32_16x16x32_bf16 a[24:27], v[72:75], v[212:215], a[24:27]
v_exp_f32 v232, v152
v_mfma_f32_16x16x32_bf16 a[28:31], v[100:103], v[208:211], a[28:31]
ds_read_b64_tr_b16 v[208:209], v244 offset:16896
ds_read_b64_tr_b16 v[210:211], v244 offset:18944
v_mfma_f32_16x16x32_bf16 a[28:31], v[104:107], v[212:215], a[28:31]
ds_read_b64_tr_b16 v[212:213], v12 offset:512
s_waitcnt lgkmcnt(3)
v_mfma_f32_16x16x32_bf16 a[16:19], v[176:179], v[216:219], a[16:19]
ds_read_b64_tr_b16 v[214:215], v12 offset:2560
buffer_load_dwordx4 v241, s[16:19], s6 offen sc1 lds
s_add_u32 m0, s28, 8192
v_mfma_f32_16x16x32_bf16 a[16:19], v[160:163], v[220:223], a[16:19]
v_exp_f32 v233, v153
v_mfma_f32_16x16x32_bf16 a[20:23], v[180:183], v[216:219], a[20:23]
v_exp_f32 v234, v154
v_mfma_f32_16x16x32_bf16 a[20:23], v[164:167], v[220:223], a[20:23]
v_add_f32 v226, v226, v232
v_cvt_pk_bf16_f32 v66, v232, v233
v_mfma_f32_16x16x32_bf16 a[24:27], v[184:187], v[216:219], a[24:27]
v_exp_f32 v235, v155
v_mfma_f32_16x16x32_bf16 a[24:27], v[168:171], v[220:223], a[24:27]
v_add_f32 v226, v226, v233
v_add_f32 v226, v226, v234
v_mfma_f32_16x16x32_bf16 a[28:31], v[188:191], v[216:219], a[28:31]
ds_read_b64_tr_b16 v[216:217], v12 offset:16896
ds_read_b64_tr_b16 v[218:219], v12 offset:18944
v_mfma_f32_16x16x32_bf16 a[28:31], v[172:175], v[220:223], a[28:31]
ds_read_b64_tr_b16 v[220:221], v14 offset:512
s_waitcnt lgkmcnt(3)
v_mfma_f32_16x16x32_bf16 a[32:35], v[4:7], v[208:211], a[32:35]
ds_read_b64_tr_b16 v[222:223], v14 offset:2560
v_add_f32 v226, v226, v235
v_mfma_f32_16x16x32_bf16 a[32:35], v[8:11], v[212:215], a[32:35]
v_cvt_pk_bf16_f32 v67, v234, v235
buffer_load_dwordx4 v241, s[16:19], s7 offen sc1 lds
s_add_u32 m0, s30, 0
v_mfma_f32_16x16x32_bf16 a[36:39], v[36:39], v[208:211], a[36:39]
v_exp_f32 v236, v156
v_mfma_f32_16x16x32_bf16 a[36:39], v[40:43], v[212:215], a[36:39]
v_exp_f32 v237, v157
v_mfma_f32_16x16x32_bf16 a[40:43], v[68:71], v[208:211], a[40:43]
v_exp_f32 v238, v158
v_mfma_f32_16x16x32_bf16 a[40:43], v[72:75], v[212:215], a[40:43]
v_add_f32 v227, v227, v236
v_cvt_pk_bf16_f32 v98, v236, v237
v_mfma_f32_16x16x32_bf16 a[44:47], v[100:103], v[208:211], a[44:47]
ds_read_b64_tr_b16 v[208:209], v245 offset:16896
ds_read_b64_tr_b16 v[210:211], v245 offset:18944
v_mfma_f32_16x16x32_bf16 a[44:47], v[104:107], v[212:215], a[44:47]
ds_read_b64_tr_b16 v[212:213], v13 offset:512
s_waitcnt lgkmcnt(3)
v_mfma_f32_16x16x32_bf16 a[32:35], v[176:179], v[216:219], a[32:35]
ds_read_b64_tr_b16 v[214:215], v13 offset:2560
buffer_load_dwordx4 v241, s[16:19], s29 offen sc1 lds
s_add_u32 m0, s28, 4096
v_mfma_f32_16x16x32_bf16 a[32:35], v[160:163], v[220:223], a[32:35]
v_exp_f32 v239, v159
v_xor_b32 v241, 0x1040, v241
v_mfma_f32_16x16x32_bf16 a[36:39], v[180:183], v[216:219], a[36:39]
v_add_f32 v227, v227, v237
v_add_f32 v227, v227, v238
v_mfma_f32_16x16x32_bf16 a[36:39], v[164:167], v[220:223], a[36:39]
v_add_f32 v227, v227, v239
v_cvt_pk_bf16_f32 v99, v238, v239
v_mfma_f32_16x16x32_bf16 a[40:43], v[184:187], v[216:219], a[40:43]
v_max3_f32 v242, v224, v225, v226
v_max_f32 v242, v242, v227
v_mfma_f32_16x16x32_bf16 a[40:43], v[168:171], v[220:223], a[40:43]
v_cmp_lt_f32 vcc, s32, v242
s_cbranch_vccnz L2_rare_site11
L2_ret11:
v_mfma_f32_16x16x32_bf16 a[44:47], v[188:191], v[216:219], a[44:47]
ds_read_b64_tr_b16 v[216:217], v13 offset:16896
ds_read_b64_tr_b16 v[218:219], v13 offset:18944
v_mfma_f32_16x16x32_bf16 a[44:47], v[172:175], v[220:223], a[44:47]
ds_read_b64_tr_b16 v[220:221], v15 offset:512
s_waitcnt lgkmcnt(3)
v_mfma_f32_16x16x32_bf16 a[48:51], v[4:7], v[208:211], a[48:51]
ds_read_b64_tr_b16 v[222:223], v15 offset:2560
buffer_load_dwordx4 v241, s[16:19], s6 offen sc1 lds
s_add_u32 m0, s28, 12288
v_mfma_f32_16x16x32_bf16 a[48:51], v[8:11], v[212:215], a[48:51]
buffer_load_dwordx4 v241, s[16:19], s7 offen sc1 lds
s_add_u32 m0, s30, 4096
v_mfma_f32_16x16x32_bf16 a[52:55], v[36:39], v[208:211], a[52:55]
buffer_load_dwordx4 v241, s[16:19], s29 offen sc1 lds
v_mfma_f32_16x16x32_bf16 a[52:55], v[40:43], v[212:215], a[52:55]
v_mfma_f32_16x16x32_bf16 a[56:59], v[68:71], v[208:211], a[56:59]
v_mfma_f32_16x16x32_bf16 a[56:59], v[72:75], v[212:215], a[56:59]
v_mfma_f32_16x16x32_bf16 a[60:63], v[100:103], v[208:211], a[60:63]
ds_read_b64_tr_b16 v[208:209], v14 offset:16384
ds_read_b64_tr_b16 v[210:211], v14 offset:18432
v_mfma_f32_16x16x32_bf16 a[60:63], v[104:107], v[212:215], a[60:63]
ds_read_b64_tr_b16 v[212:213], v15 offset:16384
s_waitcnt lgkmcnt(3)
v_mfma_f32_16x16x32_bf16 a[48:51], v[176:179], v[216:219], a[48:51]
ds_read_b64_tr_b16 v[214:215], v15 offset:18432
v_mfma_f32_16x16x32_bf16 a[48:51], v[160:163], v[220:223], a[48:51]
v_mfma_f32_16x16x32_bf16 a[52:55], v[180:183], v[216:219], a[52:55]
v_mfma_f32_16x16x32_bf16 a[52:55], v[164:167], v[220:223], a[52:55]
v_mfma_f32_16x16x32_bf16 a[56:59], v[184:187], v[216:219], a[56:59]
v_mfma_f32_16x16x32_bf16 a[56:59], v[168:171], v[220:223], a[56:59]
v_mfma_f32_16x16x32_bf16 a[60:63], v[188:191], v[216:219], a[60:63]
ds_read_b64_tr_b16 v[216:217], v14 offset:16896
ds_read_b64_tr_b16 v[218:219], v14 offset:18944
v_mfma_f32_16x16x32_bf16 a[60:63], v[172:175], v[220:223], a[60:63]
ds_read_b64_tr_b16 v[220:221], v15 offset:16896
s_waitcnt lgkmcnt(5)
v_mfma_f32_16x16x32_bf16 a[0:3], v[0:3], v[208:211], a[0:3]
ds_read_b64_tr_b16 v[222:223], v15 offset:18944
v_bfe_u32 v242, v243, 8, 1
v_mul_u32_u24 v242, 48, v242
v_mfma_f32_16x16x32_bf16 a[4:7], v[32:35], v[208:211], a[4:7]
v_lshl_add_u32 v242, s37, 3, v242
v_and_b32 v228, 0xf0, v243
v_lshl_add_u32 v242, v228, 3, v242
v_mfma_f32_16x16x32_bf16 a[8:11], v[64:67], v[208:211], a[8:11]
v_mov_b32 v232, v224
v_mov_b32 v234, v225
v_mov_b32 v236, v226
v_mfma_f32_16x16x32_bf16 a[12:15], v[96:99], v[208:211], a[12:15]
ds_read_b64_tr_b16 v[208:209], v244 offset:20480
s_waitcnt lgkmcnt(5)
v_mov_b32 v238, v227
v_mfma_f32_16x16x32_bf16 a[16:19], v[0:3], v[212:215], a[16:19]
ds_read_b64_tr_b16 v[210:211], v244 offset:22528
v_permlane32_swap_b32 v224, v232
v_permlane32_swap_b32 v225, v234
v_mfma_f32_16x16x32_bf16 a[20:23], v[32:35], v[212:215], a[20:23]
v_permlane32_swap_b32 v226, v236
v_permlane32_swap_b32 v227, v238
v_add_f32 v224, v224, v232
v_mfma_f32_16x16x32_bf16 a[24:27], v[64:67], v[212:215], a[24:27]
v_add_f32 v225, v225, v234
v_add_f32 v226, v226, v236
v_add_f32 v227, v227, v238
v_mfma_f32_16x16x32_bf16 a[28:31], v[96:99], v[212:215], a[28:31]
ds_read_b64_tr_b16 v[212:213], v12 offset:4096
s_waitcnt lgkmcnt(5)
v_mov_b32 v232, v224
v_mfma_f32_16x16x32_bf16 a[32:35], v[0:3], v[216:219], a[32:35]
ds_read_b64_tr_b16 v[214:215], v12 offset:6144
v_mov_b32 v234, v225
v_mov_b32 v236, v226
v_mfma_f32_16x16x32_bf16 a[36:39], v[32:35], v[216:219], a[36:39]
v_mov_b32 v238, v227
v_permlane16_swap_b32 v224, v232
v_permlane16_swap_b32 v225, v234
v_mfma_f32_16x16x32_bf16 a[40:43], v[64:67], v[216:219], a[40:43]
v_permlane16_swap_b32 v226, v236
v_permlane16_swap_b32 v227, v238
v_add_f32 v233, v224, v232
v_mfma_f32_16x16x32_bf16 a[44:47], v[96:99], v[216:219], a[44:47]
ds_read_b64_tr_b16 v[216:217], v12 offset:20480
s_waitcnt lgkmcnt(5)
v_add_f32 v235, v225, v234
v_mfma_f32_16x16x32_bf16 a[48:51], v[0:3], v[220:223], a[48:51]
ds_read_b64_tr_b16 v[218:219], v12 offset:22528
v_add_f32 v237, v226, v236
v_add_f32 v239, v227, v238
v_mfma_f32_16x16x32_bf16 a[52:55], v[32:35], v[220:223], a[52:55]
v_sub_f32 v232, 0, v192
v_sub_f32 v234, 0, v196
v_sub_f32 v236, 0, v200
v_mfma_f32_16x16x32_bf16 a[56:59], v[64:67], v[220:223], a[56:59]
v_sub_f32 v238, 0, v204
v_mfma_f32_16x16x32_bf16 a[60:63], v[96:99], v[220:223], a[60:63]
ds_read_b64_tr_b16 v[220:221], v14 offset:4096
s_waitcnt lgkmcnt(3)
v_mfma_f32_16x16x32_bf16 a[64:67], v[4:7], v[208:211], a[64:67]
ds_read_b64_tr_b16 v[222:223], v14 offset:6144
v_mfma_f32_16x16x32_bf16 a[64:67], v[8:11], v[212:215], a[64:67]
s_mov_b32 exec_hi, 0
buffer_store_dwordx2 v[232:233], v242, s[24:27], s48 offen sc1
s_lshr_b32 s3, s41, 2
buffer_store_dwordx2 v[234:235], v242, s[24:27], s3 offen sc1
s_lshr_b32 s3, s42, 2
buffer_store_dwordx2 v[236:237], v242, s[24:27], s3 offen sc1
s_lshr_b32 s3, s43, 2
buffer_store_dwordx2 v[238:239], v242, s[24:27], s3 offen sc1
s_mov_b32 exec_hi, -1
v_mfma_f32_16x16x32_bf16 a[68:71], v[36:39], v[208:211], a[68:71]
v_accvgpr_read_b32 v128, a0
v_accvgpr_read_b32 v129, a1
v_accvgpr_read_b32 v130, a2
v_mfma_f32_16x16x32_bf16 a[68:71], v[40:43], v[212:215], a[68:71]
v_accvgpr_read_b32 v131, a3
v_cvt_pk_bf16_f32 v16, v128, v129
v_cvt_pk_bf16_f32 v17, v130, v131
v_mfma_f32_16x16x32_bf16 a[72:75], v[68:71], v[208:211], a[72:75]
v_accvgpr_read_b32 v136, a4
v_accvgpr_read_b32 v137, a5
v_accvgpr_read_b32 v138, a6
v_mfma_f32_16x16x32_bf16 a[72:75], v[72:75], v[212:215], a[72:75]
v_accvgpr_read_b32 v139, a7
v_cvt_pk_bf16_f32 v48, v136, v137
v_cvt_pk_bf16_f32 v49, v138, v139
v_mfma_f32_16x16x32_bf16 a[76:79], v[100:103], v[208:211], a[76:79]
ds_read_b64_tr_b16 v[208:209], v14 offset:20480
ds_read_b64_tr_b16 v[210:211], v14 offset:22528
v_accvgpr_read_b32 v144, a8
v_mfma_f32_16x16x32_bf16 a[76:79], v[104:107], v[212:215], a[76:79]
ds_read_b64_tr_b16 v[212:213], v245 offset:20480
s_waitcnt lgkmcnt(3)
v_accvgpr_read_b32 v145, a9
v_mfma_f32_16x16x32_bf16 a[64:67], v[176:179], v[216:219], a[64:67]
ds_read_b64_tr_b16 v[214:215], v245 offset:22528
v_accvgpr_read_b32 v146, a10
v_accvgpr_read_b32 v147, a11
v_mfma_f32_16x16x32_bf16 a[64:67], v[160:163], v[220:223], a[64:67]
v_cvt_pk_bf16_f32 v80, v144, v145
v_cvt_pk_bf16_f32 v81, v146, v147
v_accvgpr_read_b32 v152, a12
v_mfma_f32_16x16x32_bf16 a[68:71], v[180:183], v[216:219], a[68:71]
v_accvgpr_read_b32 v153, a13
v_accvgpr_read_b32 v154, a14
v_accvgpr_read_b32 v155, a15
v_mfma_f32_16x16x32_bf16 a[68:71], v[164:167], v[220:223], a[68:71]
v_cvt_pk_bf16_f32 v112, v152, v153
v_cvt_pk_bf16_f32 v113, v154, v155
v_accvgpr_read_b32 v132, a16
v_mfma_f32_16x16x32_bf16 a[72:75], v[184:187], v[216:219], a[72:75]
v_accvgpr_read_b32 v133, a17
v_accvgpr_read_b32 v134, a18
v_accvgpr_read_b32 v135, a19
v_mfma_f32_16x16x32_bf16 a[72:75], v[168:171], v[220:223], a[72:75]
v_cvt_pk_bf16_f32 v18, v132, v133
v_cvt_pk_bf16_f32 v19, v134, v135
buffer_store_dwordx4 v[16:19], v243, s[20:23], s40 offen offset:0 sc1
v_mfma_f32_16x16x32_bf16 a[76:79], v[188:191], v[216:219], a[76:79]
ds_read_b64_tr_b16 v[216:217], v13 offset:4096
ds_read_b64_tr_b16 v[218:219], v13 offset:6144
ds_write_b128 v231, v[16:19] offset:0
v_mfma_f32_16x16x32_bf16 a[76:79], v[172:175], v[220:223], a[76:79]
ds_read_b64_tr_b16 v[220:221], v13 offset:20480
s_waitcnt lgkmcnt(5)
v_accvgpr_read_b32 v140, a20
v_mfma_f32_16x16x32_bf16 a[64:67], v[0:3], v[208:211], a[64:67]
ds_read_b64_tr_b16 v[222:223], v13 offset:22528
v_accvgpr_read_b32 v141, a21
v_accvgpr_read_b32 v142, a22
v_mfma_f32_16x16x32_bf16 a[68:71], v[32:35], v[208:211], a[68:71]
v_accvgpr_read_b32 v143, a23
v_cvt_pk_bf16_f32 v50, v140, v141
v_cvt_pk_bf16_f32 v51, v142, v143
v_mfma_f32_16x16x32_bf16 a[72:75], v[64:67], v[208:211], a[72:75]
buffer_store_dwordx4 v[48:51], v243, s[20:23], s41 offen offset:0 sc1
v_accvgpr_read_b32 v148, a24
v_accvgpr_read_b32 v149, a25
v_mfma_f32_16x16x32_bf16 a[76:79], v[96:99], v[208:211], a[76:79]
ds_read_b64_tr_b16 v[208:209], v15 offset:4096
s_waitcnt lgkmcnt(5)
v_accvgpr_read_b32 v150, a26
v_mfma_f32_16x16x32_bf16 a[80:83], v[4:7], v[212:215], a[80:83]
ds_read_b64_tr_b16 v[210:211], v15 offset:6144
v_accvgpr_read_b32 v151, a27
v_cvt_pk_bf16_f32 v82, v148, v149
v_mfma_f32_16x16x32_bf16 a[84:87], v[36:39], v[212:215], a[84:87]
v_cvt_pk_bf16_f32 v83, v150, v151
buffer_store_dwordx4 v[80:83], v243, s[20:23], s42 offen offset:0 sc1
v_accvgpr_read_b32 v156, a28
v_mfma_f32_16x16x32_bf16 a[88:91], v[68:71], v[212:215], a[88:91]
v_accvgpr_read_b32 v157, a29
v_accvgpr_read_b32 v158, a30
v_accvgpr_read_b32 v159, a31
v_mfma_f32_16x16x32_bf16 a[92:95], v[100:103], v[212:215], a[92:95]
ds_read_b64_tr_b16 v[212:213], v15 offset:20480
s_waitcnt lgkmcnt(3)
v_cvt_pk_bf16_f32 v114, v156, v157
v_mfma_f32_16x16x32_bf16 a[80:83], v[8:11], v[216:219], a[80:83]
ds_read_b64_tr_b16 v[214:215], v15 offset:22528
v_cvt_pk_bf16_f32 v115, v158, v159
buffer_store_dwordx4 v[112:115], v243, s[20:23], s43 offen offset:0 sc1
v_mfma_f32_16x16x32_bf16 a[80:83], v[176:179], v[220:223], a[80:83]
v_accvgpr_read_b32 v128, a32
v_accvgpr_read_b32 v129, a33
v_accvgpr_read_b32 v130, a34
v_mfma_f32_16x16x32_bf16 a[84:87], v[40:43], v[216:219], a[84:87]
v_accvgpr_read_b32 v131, a35
v_cvt_pk_bf16_f32 v20, v128, v129
v_cvt_pk_bf16_f32 v21, v130, v131
v_mfma_f32_16x16x32_bf16 a[84:87], v[180:183], v[220:223], a[84:87]
v_accvgpr_read_b32 v136, a36
v_accvgpr_read_b32 v137, a37
v_accvgpr_read_b32 v138, a38
v_mfma_f32_16x16x32_bf16 a[88:91], v[72:75], v[216:219], a[88:91]
v_accvgpr_read_b32 v139, a39
v_cvt_pk_bf16_f32 v52, v136, v137
v_cvt_pk_bf16_f32 v53, v138, v139
v_mfma_f32_16x16x32_bf16 a[88:91], v[184:187], v[220:223], a[88:91]
v_accvgpr_read_b32 v144, a40
v_accvgpr_read_b32 v145, a41
v_accvgpr_read_b32 v146, a42
v_mfma_f32_16x16x32_bf16 a[92:95], v[104:107], v[216:219], a[92:95]
ds_read_b64_tr_b16 v[216:217], v244 offset:20992
ds_read_b64_tr_b16 v[218:219], v244 offset:23040
v_accvgpr_read_b32 v147, a43
v_mfma_f32_16x16x32_bf16 a[92:95], v[188:191], v[220:223], a[92:95]
ds_read_b64_tr_b16 v[220:221], v12 offset:4608
s_waitcnt lgkmcnt(3)
v_cvt_pk_bf16_f32 v84, v144, v145
v_mfma_f32_16x16x32_bf16 a[80:83], v[160:163], v[208:211], a[80:83]
ds_read_b64_tr_b16 v[222:223], v12 offset:6656
v_cvt_pk_bf16_f32 v85, v146, v147
v_accvgpr_read_b32 v152, a44
v_mfma_f32_16x16x32_bf16 a[80:83], v[0:3], v[212:215], a[80:83]
v_accvgpr_read_b32 v153, a45
v_accvgpr_read_b32 v154, a46
v_accvgpr_read_b32 v155, a47
v_mfma_f32_16x16x32_bf16 a[84:87], v[164:167], v[208:211], a[84:87]
v_cvt_pk_bf16_f32 v116, v152, v153
v_cvt_pk_bf16_f32 v117, v154, v155
v_accvgpr_read_b32 v132, a48
v_mfma_f32_16x16x32_bf16 a[84:87], v[32:35], v[212:215], a[84:87]
v_accvgpr_read_b32 v133, a49
v_accvgpr_read_b32 v134, a50
v_accvgpr_read_b32 v135, a51
v_mfma_f32_16x16x32_bf16 a[88:91], v[168:171], v[208:211], a[88:91]
v_cvt_pk_bf16_f32 v22, v132, v133
v_cvt_pk_bf16_f32 v23, v134, v135
buffer_store_dwordx4 v[20:23], v243, s[20:23], s40 offen offset:1024 sc1
v_mfma_f32_16x16x32_bf16 a[88:91], v[64:67], v[212:215], a[88:91]
ds_write_b128 v231, v[20:23] offset:1024
v_accvgpr_read_b32 v140, a52
v_accvgpr_read_b32 v141, a53
v_mfma_f32_16x16x32_bf16 a[92:95], v[172:175], v[208:211], a[92:95]
ds_read_b64_tr_b16 v[208:209], v12 offset:20992
ds_read_b64_tr_b16 v[210:211], v12 offset:23040
v_accvgpr_read_b32 v142, a54
v_mfma_f32_16x16x32_bf16 a[92:95], v[96:99], v[212:215], a[92:95]
ds_read_b64_tr_b16 v[212:213], v14 offset:4608
s_waitcnt lgkmcnt(3)
v_accvgpr_read_b32 v143, a55
v_mfma_f32_16x16x32_bf16 a[96:99], v[4:7], v[216:219], a[96:99]
ds_read_b64_tr_b16 v[214:215], v14 offset:6656
v_cvt_pk_bf16_f32 v54, v140, v141
v_cvt_pk_bf16_f32 v55, v142, v143
v_mfma_f32_16x16x32_bf16 a[96:99], v[8:11], v[220:223], a[96:99]
buffer_store_dwordx4 v[52:55], v243, s[20:23], s41 offen offset:1024 sc1
v_accvgpr_read_b32 v148, a56
v_accvgpr_read_b32 v149, a57
v_mfma_f32_16x16x32_bf16 a[100:103], v[36:39], v[216:219], a[100:103]
v_accvgpr_read_b32 v150, a58
v_accvgpr_read_b32 v151, a59
v_cvt_pk_bf16_f32 v86, v148, v149
v_mfma_f32_16x16x32_bf16 a[100:103], v[40:43], v[220:223], a[100:103]
v_cvt_pk_bf16_f32 v87, v150, v151
buffer_store_dwordx4 v[84:87], v243, s[20:23], s42 offen offset:1024 sc1
v_accvgpr_read_b32 v156, a60
v_mfma_f32_16x16x32_bf16 a[104:107], v[68:71], v[216:219], a[104:107]
v_accvgpr_read_b32 v157, a61
v_accvgpr_read_b32 v158, a62
v_accvgpr_read_b32 v159, a63
v_mfma_f32_16x16x32_bf16 a[104:107], v[72:75], v[220:223], a[104:107]
v_cvt_pk_bf16_f32 v118, v156, v157
v_cvt_pk_bf16_f32 v119, v158, v159
buffer_store_dwordx4 v[116:119], v243, s[20:23], s43 offen offset:1024 sc1
v_mfma_f32_16x16x32_bf16 a[108:111], v[100:103], v[216:219], a[108:111]
ds_read_b64_tr_b16 v[216:217], v14 offset:20992
ds_read_b64_tr_b16 v[218:219], v14 offset:23040
v_accvgpr_read_b32 v128, a64
v_mfma_f32_16x16x32_bf16 a[108:111], v[104:107], v[220:223], a[108:111]
ds_read_b64_tr_b16 v[220:221], v245 offset:20992
s_waitcnt lgkmcnt(3)
v_accvgpr_read_b32 v129, a65
v_mfma_f32_16x16x32_bf16 a[96:99], v[176:179], v[208:211], a[96:99]
ds_read_b64_tr_b16 v[222:223], v245 offset:23040
v_accvgpr_read_b32 v130, a66
v_accvgpr_read_b32 v131, a67
v_mfma_f32_16x16x32_bf16 a[96:99], v[160:163], v[212:215], a[96:99]
v_cvt_pk_bf16_f32 v24, v128, v129
v_cvt_pk_bf16_f32 v25, v130, v131
v_accvgpr_read_b32 v136, a68
v_mfma_f32_16x16x32_bf16 a[100:103], v[180:183], v[208:211], a[100:103]
v_accvgpr_read_b32 v137, a69
v_accvgpr_read_b32 v138, a70
v_accvgpr_read_b32 v139, a71
v_mfma_f32_16x16x32_bf16 a[100:103], v[164:167], v[212:215], a[100:103]
v_cvt_pk_bf16_f32 v56, v136, v137
v_cvt_pk_bf16_f32 v57, v138, v139
v_accvgpr_read_b32 v144, a72
v_mfma_f32_16x16x32_bf16 a[104:107], v[184:187], v[208:211], a[104:107]
v_accvgpr_read_b32 v145, a73
v_accvgpr_read_b32 v146, a74
v_accvgpr_read_b32 v147, a75
v_mfma_f32_16x16x32_bf16 a[104:107], v[168:171], v[212:215], a[104:107]
v_cvt_pk_bf16_f32 v88, v144, v145
v_cvt_pk_bf16_f32 v89, v146, v147
v_accvgpr_read_b32 v152, a76
v_mfma_f32_16x16x32_bf16 a[108:111], v[188:191], v[208:211], a[108:111]
ds_read_b64_tr_b16 v[208:209], v13 offset:4608
ds_read_b64_tr_b16 v[210:211], v13 offset:6656
v_accvgpr_read_b32 v153, a77
v_mfma_f32_16x16x32_bf16 a[108:111], v[172:175], v[212:215], a[108:111]
ds_read_b64_tr_b16 v[212:213], v13 offset:20992
s_waitcnt lgkmcnt(5)
v_accvgpr_read_b32 v154, a78
v_mfma_f32_16x16x32_bf16 a[96:99], v[0:3], v[216:219], a[96:99]
ds_read_b64_tr_b16 v[214:215], v13 offset:23040
v_accvgpr_read_b32 v155, a79
v_cvt_pk_bf16_f32 v120, v152, v153
v_mfma_f32_16x16x32_bf16 a[100:103], v[32:35], v[216:219], a[100:103]
v_cvt_pk_bf16_f32 v121, v154, v155
v_accvgpr_read_b32 v132, a80
v_accvgpr_read_b32 v133, a81
v_mfma_f32_16x16x32_bf16 a[104:107], v[64:67], v[216:219], a[104:107]
v_accvgpr_read_b32 v134, a82
v_accvgpr_read_b32 v135, a83
v_cvt_pk_bf16_f32 v26, v132, v133
v_mfma_f32_16x16x32_bf16 a[108:111], v[96:99], v[216:219], a[108:111]
ds_read_b64_tr_b16 v[216:217], v15 offset:4608
s_waitcnt lgkmcnt(5)
v_cvt_pk_bf16_f32 v27, v134, v135
v_mfma_f32_16x16x32_bf16 a[112:115], v[4:7], v[220:223], a[112:115]
ds_read_b64_tr_b16 v[218:219], v15 offset:6656
buffer_store_dwordx4 v[24:27], v243, s[20:23], s40 offen offset:2048 sc1
ds_write_b128 v231, v[24:27] offset:2048
v_mfma_f32_16x16x32_bf16 a[116:119], v[36:39], v[220:223], a[116:119]
v_accvgpr_read_b32 v140, a84
v_accvgpr_read_b32 v141, a85
v_accvgpr_read_b32 v142, a86
v_mfma_f32_16x16x32_bf16 a[120:123], v[68:71], v[220:223], a[120:123]
v_accvgpr_read_b32 v143, a87
v_cvt_pk_bf16_f32 v58, v140, v141
v_cvt_pk_bf16_f32 v59, v142, v143
v_mfma_f32_16x16x32_bf16 a[124:127], v[100:103], v[220:223], a[124:127]
ds_read_b64_tr_b16 v[220:221], v15 offset:20992
s_waitcnt lgkmcnt(3)
buffer_store_dwordx4 v[56:59], v243, s[20:23], s41 offen offset:2048 sc1
v_mfma_f32_16x16x32_bf16 a[112:115], v[8:11], v[208:211], a[112:115]
ds_read_b64_tr_b16 v[222:223], v15 offset:23040
v_accvgpr_read_b32 v148, a88
v_accvgpr_read_b32 v149, a89
v_mfma_f32_16x16x32_bf16 a[112:115], v[176:179], v[212:215], a[112:115]
v_accvgpr_read_b32 v150, a90
v_accvgpr_read_b32 v151, a91
v_cvt_pk_bf16_f32 v90, v148, v149
v_mfma_f32_16x16x32_bf16 a[116:119], v[40:43], v[208:211], a[116:119]
v_cvt_pk_bf16_f32 v91, v150, v151
buffer_store_dwordx4 v[88:91], v243, s[20:23], s42 offen offset:2048 sc1
v_accvgpr_read_b32 v156, a92
v_mfma_f32_16x16x32_bf16 a[116:119], v[180:183], v[212:215], a[116:119]
v_accvgpr_read_b32 v157, a93
v_accvgpr_read_b32 v158, a94
v_accvgpr_read_b32 v159, a95
v_mfma_f32_16x16x32_bf16 a[120:123], v[72:75], v[208:211], a[120:123]
v_cvt_pk_bf16_f32 v122, v156, v157
v_cvt_pk_bf16_f32 v123, v158, v159
buffer_store_dwordx4 v[120:123], v243, s[20:23], s43 offen offset:2048 sc1
v_mfma_f32_16x16x32_bf16 a[120:123], v[184:187], v[212:215], a[120:123]
v_accvgpr_read_b32 v128, a96
v_accvgpr_read_b32 v129, a97
v_mfma_f32_16x16x32_bf16 a[124:127], v[104:107], v[208:211], a[124:127]
ds_read_b64_tr_b16 v[208:209], v12 offset:8192
ds_read_b64_tr_b16 v[210:211], v12 offset:10240
v_mfma_f32_16x16x32_bf16 a[124:127], v[188:191], v[212:215], a[124:127]
ds_read_b64_tr_b16 v[212:213], v12 offset:24576
s_waitcnt lgkmcnt(3)
v_mfma_f32_16x16x32_bf16 a[112:115], v[160:163], v[216:219], a[112:115]
ds_read_b64_tr_b16 v[214:215], v12 offset:26624
v_accvgpr_read_b32 v130, a98
v_mfma_f32_16x16x32_bf16 a[112:115], v[0:3], v[220:223], a[112:115]
v_accvgpr_read_b32 v131, a99
v_cvt_pk_bf16_f32 v28, v128, v129
v_mfma_f32_16x16x32_bf16 a[116:119], v[164:167], v[216:219], a[116:119]
v_cvt_pk_bf16_f32 v29, v130, v131
v_accvgpr_read_b32 v136, a100
v_mfma_f32_16x16x32_bf16 a[116:119], v[32:35], v[220:223], a[116:119]
v_accvgpr_read_b32 v137, a101
v_accvgpr_read_b32 v138, a102
v_mfma_f32_16x16x32_bf16 a[120:123], v[168:171], v[216:219], a[120:123]
v_accvgpr_read_b32 v139, a103
v_cvt_pk_bf16_f32 v60, v136, v137
v_mfma_f32_16x16x32_bf16 a[120:123], v[64:67], v[220:223], a[120:123]
v_cvt_pk_bf16_f32 v61, v138, v139
v_accvgpr_read_b32 v144, a104
v_mfma_f32_16x16x32_bf16 a[124:127], v[172:175], v[216:219], a[124:127]
ds_read_b64_tr_b16 v[216:217], v14 offset:8192
ds_read_b64_tr_b16 v[218:219], v14 offset:10240
v_mfma_f32_16x16x32_bf16 a[124:127], v[96:99], v[220:223], a[124:127]
ds_read_b64_tr_b16 v[220:221], v14 offset:24576
s_waitcnt lgkmcnt(3)
v_mfma_f32_16x16x32_bf16 a[128:131], v[8:11], v[208:211], a[128:131]
ds_read_b64_tr_b16 v[222:223], v14 offset:26624
v_accvgpr_read_b32 v145, a105
v_mfma_f32_16x16x32_bf16 a[128:131], v[176:179], v[212:215], a[128:131]
v_accvgpr_read_b32 v146, a106
v_accvgpr_read_b32 v147, a107
v_mfma_f32_16x16x32_bf16 a[132:135], v[40:43], v[208:211], a[132:135]
v_cvt_pk_bf16_f32 v92, v144, v145
v_cvt_pk_bf16_f32 v93, v146, v147
v_mfma_f32_16x16x32_bf16 a[132:135], v[180:183], v[212:215], a[132:135]
v_accvgpr_read_b32 v152, a108
v_accvgpr_read_b32 v153, a109
v_mfma_f32_16x16x32_bf16 a[136:139], v[72:75], v[208:211], a[136:139]
v_accvgpr_read_b32 v154, a110
v_accvgpr_read_b32 v155, a111
v_mfma_f32_16x16x32_bf16 a[136:139], v[184:187], v[212:215], a[136:139]
v_cvt_pk_bf16_f32 v124, v152, v153
v_cvt_pk_bf16_f32 v125, v154, v155
v_mfma_f32_16x16x32_bf16 a[140:143], v[104:107], v[208:211], a[140:143]
ds_read_b64_tr_b16 v[208:209], v13 offset:8192
ds_read_b64_tr_b16 v[210:211], v13 offset:10240
v_mfma_f32_16x16x32_bf16 a[140:143], v[188:191], v[212:215], a[140:143]
ds_read_b64_tr_b16 v[212:213], v13 offset:24576
s_waitcnt lgkmcnt(3)
v_mfma_f32_16x16x32_bf16 a[128:131], v[160:163], v[216:219], a[128:131]
ds_read_b64_tr_b16 v[214:215], v13 offset:26624
v_accvgpr_read_b32 v132, a112
v_mfma_f32_16x16x32_bf16 a[128:131], v[0:3], v[220:223], a[128:131]
v_accvgpr_read_b32 v133, a113
v_accvgpr_read_b32 v134, a114
v_mfma_f32_16x16x32_bf16 a[132:135], v[164:167], v[216:219], a[132:135]
v_accvgpr_read_b32 v135, a115
v_cvt_pk_bf16_f32 v30, v132, v133
v_mfma_f32_16x16x32_bf16 a[132:135], v[32:35], v[220:223], a[132:135]
v_cvt_pk_bf16_f32 v31, v134, v135
buffer_store_dwordx4 v[28:31], v243, s[20:23], s40 offen offset:3072 sc1
v_mfma_f32_16x16x32_bf16 a[136:139], v[168:171], v[216:219], a[136:139]
ds_write_b128 v231, v[28:31] offset:3072
v_accvgpr_read_b32 v140, a116
v_mfma_f32_16x16x32_bf16 a[136:139], v[64:67], v[220:223], a[136:139]
v_accvgpr_read_b32 v141, a117
v_accvgpr_read_b32 v142, a118
v_mfma_f32_16x16x32_bf16 a[140:143], v[172:175], v[216:219], a[140:143]
ds_read_b64_tr_b16 v[216:217], v15 offset:8192
ds_read_b64_tr_b16 v[218:219], v15 offset:10240
v_mfma_f32_16x16x32_bf16 a[140:143], v[96:99], v[220:223], a[140:143]
ds_read_b64_tr_b16 v[220:221], v15 offset:24576
s_waitcnt lgkmcnt(3)
v_mfma_f32_16x16x32_bf16 a[144:147], v[8:11], v[208:211], a[144:147]
ds_read_b64_tr_b16 v[222:223], v15 offset:26624
v_accvgpr_read_b32 v143, a119
v_mfma_f32_16x16x32_bf16 a[144:147], v[176:179], v[212:215], a[144:147]
v_cvt_pk_bf16_f32 v62, v140, v141
v_cvt_pk_bf16_f32 v63, v142, v143
v_mfma_f32_16x16x32_bf16 a[148:151], v[40:43], v[208:211], a[148:151]
buffer_store_dwordx4 v[60:63], v243, s[20:23], s41 offen offset:3072 sc1
v_accvgpr_read_b32 v148, a120
v_mfma_f32_16x16x32_bf16 a[148:151], v[180:183], v[212:215], a[148:151]
v_accvgpr_read_b32 v149, a121
v_accvgpr_read_b32 v150, a122
v_mfma_f32_16x16x32_bf16 a[152:155], v[72:75], v[208:211], a[152:155]
v_accvgpr_read_b32 v151, a123
v_cvt_pk_bf16_f32 v94, v148, v149
v_mfma_f32_16x16x32_bf16 a[152:155], v[184:187], v[212:215], a[152:155]
v_cvt_pk_bf16_f32 v95, v150, v151
buffer_store_dwordx4 v[92:95], v243, s[20:23], s42 offen offset:3072 sc1
v_mfma_f32_16x16x32_bf16 a[156:159], v[104:107], v[208:211], a[156:159]
ds_read_b64_tr_b16 v[208:209], v12 offset:8704
ds_read_b64_tr_b16 v[210:211], v12 offset:10752
v_mfma_f32_16x16x32_bf16 a[156:159], v[188:191], v[212:215], a[156:159]
ds_read_b64_tr_b16 v[212:213], v12 offset:25088
s_waitcnt lgkmcnt(3)
v_mfma_f32_16x16x32_bf16 a[144:147], v[160:163], v[216:219], a[144:147]
ds_read_b64_tr_b16 v[214:215], v12 offset:27136
v_accvgpr_read_b32 v156, a124
v_mfma_f32_16x16x32_bf16 a[144:147], v[0:3], v[220:223], a[144:147]
v_accvgpr_read_b32 v157, a125
v_accvgpr_read_b32 v158, a126
v_mfma_f32_16x16x32_bf16 a[148:151], v[164:167], v[216:219], a[148:151]
v_accvgpr_read_b32 v159, a127
v_cvt_pk_bf16_f32 v126, v156, v157
v_mfma_f32_16x16x32_bf16 a[148:151], v[32:35], v[220:223], a[148:151]
v_cvt_pk_bf16_f32 v127, v158, v159
buffer_store_dwordx4 v[124:127], v243, s[20:23], s43 offen offset:3072 sc1
v_mfma_f32_16x16x32_bf16 a[152:155], v[168:171], v[216:219], a[152:155]
v_accvgpr_read_b32 v128, a128
v_accvgpr_read_b32 v129, a129
v_mfma_f32_16x16x32_bf16 a[152:155], v[64:67], v[220:223], a[152:155]
v_accvgpr_read_b32 v130, a130
v_accvgpr_read_b32 v131, a131
v_mfma_f32_16x16x32_bf16 a[156:159], v[172:175], v[216:219], a[156:159]
ds_read_b64_tr_b16 v[216:217], v14 offset:8704
ds_read_b64_tr_b16 v[218:219], v14 offset:10752
v_mfma_f32_16x16x32_bf16 a[156:159], v[96:99], v[220:223], a[156:159]
ds_read_b64_tr_b16 v[220:221], v14 offset:25088
s_waitcnt lgkmcnt(3)
v_mfma_f32_16x16x32_bf16 a[160:163], v[8:11], v[208:211], a[160:163]
ds_read_b64_tr_b16 v[222:223], v14 offset:27136
v_cvt_pk_bf16_f32 v16, v128, v129
v_mfma_f32_16x16x32_bf16 a[160:163], v[176:179], v[212:215], a[160:163]
v_cvt_pk_bf16_f32 v17, v130, v131
v_accvgpr_read_b32 v136, a132
v_mfma_f32_16x16x32_bf16 a[164:167], v[40:43], v[208:211], a[164:167]
v_accvgpr_read_b32 v137, a133
v_accvgpr_read_b32 v138, a134
v_mfma_f32_16x16x32_bf16 a[164:167], v[180:183], v[212:215], a[164:167]
v_accvgpr_read_b32 v139, a135
v_cvt_pk_bf16_f32 v48, v136, v137
v_mfma_f32_16x16x32_bf16 a[168:171], v[72:75], v[208:211], a[168:171]
v_cvt_pk_bf16_f32 v49, v138, v139
v_accvgpr_read_b32 v144, a136
v_mfma_f32_16x16x32_bf16 a[168:171], v[184:187], v[212:215], a[168:171]
v_accvgpr_read_b32 v145, a137
v_accvgpr_read_b32 v146, a138
v_mfma_f32_16x16x32_bf16 a[172:175], v[104:107], v[208:211], a[172:175]
ds_read_b64_tr_b16 v[208:209], v13 offset:8704
ds_read_b64_tr_b16 v[210:211], v13 offset:10752
v_mfma_f32_16x16x32_bf16 a[172:175], v[188:191], v[212:215], a[172:175]
ds_read_b64_tr_b16 v[212:213], v13 offset:25088
s_waitcnt lgkmcnt(3)
v_mfma_f32_16x16x32_bf16 a[160:163], v[160:163], v[216:219], a[160:163]
ds_read_b64_tr_b16 v[214:215], v13 offset:27136
v_accvgpr_read_b32 v147, a139
v_mfma_f32_16x16x32_bf16 a[160:163], v[0:3], v[220:223], a[160:163]
v_cvt_pk_bf16_f32 v80, v144, v145
v_cvt_pk_bf16_f32 v81, v146, v147
v_mfma_f32_16x16x32_bf16 a[164:167], v[164:167], v[216:219], a[164:167]
v_accvgpr_read_b32 v152, a140
v_accvgpr_read_b32 v153, a141
v_mfma_f32_16x16x32_bf16 a[164:167], v[32:35], v[220:223], a[164:167]
v_accvgpr_read_b32 v154, a142
v_accvgpr_read_b32 v155, a143
v_mfma_f32_16x16x32_bf16 a[168:171], v[168:171], v[216:219], a[168:171]
v_cvt_pk_bf16_f32 v112, v152, v153
v_cvt_pk_bf16_f32 v113, v154, v155
v_mfma_f32_16x16x32_bf16 a[168:171], v[64:67], v[220:223], a[168:171]
v_accvgpr_read_b32 v132, a144
v_accvgpr_read_b32 v133, a145
v_mfma_f32_16x16x32_bf16 a[172:175], v[172:175], v[216:219], a[172:175]
ds_read_b64_tr_b16 v[216:217], v15 offset:8704
ds_read_b64_tr_b16 v[218:219], v15 offset:10752
v_mfma_f32_16x16x32_bf16 a[172:175], v[96:99], v[220:223], a[172:175]
ds_read_b64_tr_b16 v[220:221], v15 offset:25088
s_waitcnt lgkmcnt(3)
v_mfma_f32_16x16x32_bf16 a[176:179], v[8:11], v[208:211], a[176:179]
ds_read_b64_tr_b16 v[222:223], v15 offset:27136
v_accvgpr_read_b32 v134, a146
v_mfma_f32_16x16x32_bf16 a[176:179], v[176:179], v[212:215], a[176:179]
v_accvgpr_read_b32 v135, a147
v_cvt_pk_bf16_f32 v18, v132, v133
v_mfma_f32_16x16x32_bf16 a[180:183], v[40:43], v[208:211], a[180:183]
v_cvt_pk_bf16_f32 v19, v134, v135
buffer_store_dwordx4 v[16:19], v243, s[20:23], s44 offen offset:0 sc1
v_mfma_f32_16x16x32_bf16 a[180:183], v[180:183], v[212:215], a[180:183]
ds_write_b128 v231, v[16:19] offset:4096
v_accvgpr_read_b32 v140, a148
v_mfma_f32_16x16x32_bf16 a[184:187], v[72:75], v[208:211], a[184:187]
v_accvgpr_read_b32 v141, a149
v_accvgpr_read_b32 v142, a150
v_mfma_f32_16x16x32_bf16 a[184:187], v[184:187], v[212:215], a[184:187]
v_accvgpr_read_b32 v143, a151
v_cvt_pk_bf16_f32 v50, v140, v141
v_mfma_f32_16x16x32_bf16 a[188:191], v[104:107], v[208:211], a[188:191]
ds_read_b64_tr_b16 v[208:209], v12 offset:12288
ds_read_b64_tr_b16 v[210:211], v12 offset:14336
v_mfma_f32_16x16x32_bf16 a[188:191], v[188:191], v[212:215], a[188:191]
ds_read_b64_tr_b16 v[212:213], v12 offset:28672
s_waitcnt lgkmcnt(3)
v_mfma_f32_16x16x32_bf16 a[176:179], v[160:163], v[216:219], a[176:179]
ds_read_b64_tr_b16 v[214:215], v12 offset:30720
v_cvt_pk_bf16_f32 v51, v142, v143
v_mfma_f32_16x16x32_bf16 a[176:179], v[0:3], v[220:223], a[176:179]
buffer_store_dwordx4 v[48:51], v243, s[20:23], s45 offen offset:0 sc1
v_accvgpr_read_b32 v148, a152
v_mfma_f32_16x16x32_bf16 a[180:183], v[164:167], v[216:219], a[180:183]
v_accvgpr_read_b32 v149, a153
v_accvgpr_read_b32 v150, a154
v_mfma_f32_16x16x32_bf16 a[180:183], v[32:35], v[220:223], a[180:183]
v_accvgpr_read_b32 v151, a155
v_cvt_pk_bf16_f32 v82, v148, v149
v_mfma_f32_16x16x32_bf16 a[184:187], v[168:171], v[216:219], a[184:187]
v_cvt_pk_bf16_f32 v83, v150, v151
buffer_store_dwordx4 v[80:83], v243, s[20:23], s46 offen offset:0 sc1
v_mfma_f32_16x16x32_bf16 a[184:187], v[64:67], v[220:223], a[184:187]
v_accvgpr_read_b32 v156, a156
v_accvgpr_read_b32 v157, a157
v_mfma_f32_16x16x32_bf16 a[188:191], v[172:175], v[216:219], a[188:191]
ds_read_b64_tr_b16 v[216:217], v14 offset:12288
ds_read_b64_tr_b16 v[218:219], v14 offset:14336
v_mfma_f32_16x16x32_bf16 a[188:191], v[96:99], v[220:223], a[188:191]
ds_read_b64_tr_b16 v[220:221], v14 offset:28672
s_waitcnt lgkmcnt(3)
v_mfma_f32_16x16x32_bf16 a[192:195], v[8:11], v[208:211], a[192:195]
ds_read_b64_tr_b16 v[222:223], v14 offset:30720
v_accvgpr_read_b32 v158, a158
v_mfma_f32_16x16x32_bf16 a[192:195], v[176:179], v[212:215], a[192:195]
v_accvgpr_read_b32 v159, a159
v_cvt_pk_bf16_f32 v114, v156, v157
v_mfma_f32_16x16x32_bf16 a[196:199], v[40:43], v[208:211], a[196:199]
v_cvt_pk_bf16_f32 v115, v158, v159
buffer_store_dwordx4 v[112:115], v243, s[20:23], s47 offen offset:0 sc1
v_mfma_f32_16x16x32_bf16 a[196:199], v[180:183], v[212:215], a[196:199]
v_accvgpr_read_b32 v128, a160
v_accvgpr_read_b32 v129, a161
v_mfma_f32_16x16x32_bf16 a[200:203], v[72:75], v[208:211], a[200:203]
v_accvgpr_read_b32 v130, a162
v_accvgpr_read_b32 v131, a163
v_mfma_f32_16x16x32_bf16 a[200:203], v[184:187], v[212:215], a[200:203]
v_cvt_pk_bf16_f32 v20, v128, v129
v_cvt_pk_bf16_f32 v21, v130, v131
v_mfma_f32_16x16x32_bf16 a[204:207], v[104:107], v[208:211], a[204:207]
ds_read_b64_tr_b16 v[208:209], v13 offset:12288
ds_read_b64_tr_b16 v[210:211], v13 offset:14336
v_mfma_f32_16x16x32_bf16 a[204:207], v[188:191], v[212:215], a[204:207]
ds_read_b64_tr_b16 v[212:213], v13 offset:28672
s_waitcnt lgkmcnt(3)
v_mfma_f32_16x16x32_bf16 a[192:195], v[160:163], v[216:219], a[192:195]
ds_read_b64_tr_b16 v[214:215], v13 offset:30720
v_accvgpr_read_b32 v136, a164
v_mfma_f32_16x16x32_bf16 a[192:195], v[0:3], v[220:223], a[192:195]
v_accvgpr_read_b32 v137, a165
v_accvgpr_read_b32 v138, a166
v_mfma_f32_16x16x32_bf16 a[196:199], v[164:167], v[216:219], a[196:199]
v_accvgpr_read_b32 v139, a167
v_cvt_pk_bf16_f32 v52, v136, v137
v_mfma_f32_16x16x32_bf16 a[196:199], v[32:35], v[220:223], a[196:199]
v_cvt_pk_bf16_f32 v53, v138, v139
v_accvgpr_read_b32 v144, a168
v_mfma_f32_16x16x32_bf16 a[200:203], v[168:171], v[216:219], a[200:203]
v_accvgpr_read_b32 v145, a169
v_accvgpr_read_b32 v146, a170
v_mfma_f32_16x16x32_bf16 a[200:203], v[64:67], v[220:223], a[200:203]
v_accvgpr_read_b32 v147, a171
v_cvt_pk_bf16_f32 v84, v144, v145
v_mfma_f32_16x16x32_bf16 a[204:207], v[172:175], v[216:219], a[204:207]
ds_read_b64_tr_b16 v[216:217], v15 offset:12288
ds_read_b64_tr_b16 v[218:219], v15 offset:14336
v_mfma_f32_16x16x32_bf16 a[204:207], v[96:99], v[220:223], a[204:207]
ds_read_b64_tr_b16 v[220:221], v15 offset:28672
s_waitcnt lgkmcnt(3)
v_mfma_f32_16x16x32_bf16 a[208:211], v[8:11], v[208:211], a[208:211]
ds_read_b64_tr_b16 v[222:223], v15 offset:30720
v_cvt_pk_bf16_f32 v85, v146, v147
v_mfma_f32_16x16x32_bf16 a[208:211], v[176:179], v[212:215], a[208:211]
v_accvgpr_read_b32 v152, a172
v_accvgpr_read_b32 v153, a173
v_mfma_f32_16x16x32_bf16 a[212:215], v[40:43], v[208:211], a[212:215]
v_accvgpr_read_b32 v154, a174
v_accvgpr_read_b32 v155, a175
v_mfma_f32_16x16x32_bf16 a[212:215], v[180:183], v[212:215], a[212:215]
v_cvt_pk_bf16_f32 v116, v152, v153
v_cvt_pk_bf16_f32 v117, v154, v155
v_mfma_f32_16x16x32_bf16 a[216:219], v[72:75], v[208:211], a[216:219]
v_accvgpr_read_b32 v132, a176
v_accvgpr_read_b32 v133, a177
v_mfma_f32_16x16x32_bf16 a[216:219], v[184:187], v[212:215], a[216:219]
v_accvgpr_read_b32 v134, a178
v_accvgpr_read_b32 v135, a179
v_mfma_f32_16x16x32_bf16 a[220:223], v[104:107], v[208:211], a[220:223]
ds_read_b64_tr_b16 v[208:209], v12 offset:12800
ds_read_b64_tr_b16 v[210:211], v12 offset:14848
v_mfma_f32_16x16x32_bf16 a[220:223], v[188:191], v[212:215], a[220:223]
ds_read_b64_tr_b16 v[212:213], v12 offset:29184
s_waitcnt lgkmcnt(3)
v_mfma_f32_16x16x32_bf16 a[208:211], v[160:163], v[216:219], a[208:211]
ds_read_b64_tr_b16 v[214:215], v12 offset:31232
v_cvt_pk_bf16_f32 v22, v132, v133
v_mfma_f32_16x16x32_bf16 a[208:211], v[0:3], v[220:223], a[208:211]
v_cvt_pk_bf16_f32 v23, v134, v135
buffer_store_dwordx4 v[20:23], v243, s[20:23], s44 offen offset:1024 sc1
v_mfma_f32_16x16x32_bf16 a[212:215], v[164:167], v[216:219], a[212:215]
ds_write_b128 v231, v[20:23] offset:5120
v_accvgpr_read_b32 v140, a180
v_mfma_f32_16x16x32_bf16 a[212:215], v[32:35], v[220:223], a[212:215]
v_accvgpr_read_b32 v141, a181
v_accvgpr_read_b32 v142, a182
v_mfma_f32_16x16x32_bf16 a[216:219], v[168:171], v[216:219], a[216:219]
v_accvgpr_read_b32 v143, a183
v_cvt_pk_bf16_f32 v54, v140, v141
v_mfma_f32_16x16x32_bf16 a[216:219], v[64:67], v[220:223], a[216:219]
v_cvt_pk_bf16_f32 v55, v142, v143
buffer_store_dwordx4 v[52:55], v243, s[20:23], s45 offen offset:1024 sc1
v_mfma_f32_16x16x32_bf16 a[220:223], v[172:175], v[216:219], a[220:223]
ds_read_b64_tr_b16 v[216:217], v14 offset:12800
ds_read_b64_tr_b16 v[218:219], v14 offset:14848
v_mfma_f32_16x16x32_bf16 a[220:223], v[96:99], v[220:223], a[220:223]
ds_read_b64_tr_b16 v[220:221], v14 offset:29184
s_waitcnt lgkmcnt(3)
v_mfma_f32_16x16x32_bf16 a[224:227], v[8:11], v[208:211], a[224:227]
ds_read_b64_tr_b16 v[222:223], v14 offset:31232
v_accvgpr_read_b32 v148, a184
v_mfma_f32_16x16x32_bf16 a[224:227], v[176:179], v[212:215], a[224:227]
v_accvgpr_read_b32 v149, a185
v_accvgpr_read_b32 v150, a186
v_mfma_f32_16x16x32_bf16 a[228:231], v[40:43], v[208:211], a[228:231]
v_accvgpr_read_b32 v151, a187
v_cvt_pk_bf16_f32 v86, v148, v149
v_mfma_f32_16x16x32_bf16 a[228:231], v[180:183], v[212:215], a[228:231]
v_cvt_pk_bf16_f32 v87, v150, v151
buffer_store_dwordx4 v[84:87], v243, s[20:23], s46 offen offset:1024 sc1
v_mfma_f32_16x16x32_bf16 a[232:235], v[72:75], v[208:211], a[232:235]
v_accvgpr_read_b32 v156, a188
v_accvgpr_read_b32 v157, a189
v_mfma_f32_16x16x32_bf16 a[232:235], v[184:187], v[212:215], a[232:235]
v_accvgpr_read_b32 v158, a190
v_accvgpr_read_b32 v159, a191
v_mfma_f32_16x16x32_bf16 a[236:239], v[104:107], v[208:211], a[236:239]
ds_read_b64_tr_b16 v[208:209], v13 offset:12800
ds_read_b64_tr_b16 v[210:211], v13 offset:14848
v_mfma_f32_16x16x32_bf16 a[236:239], v[188:191], v[212:215], a[236:239]
ds_read_b64_tr_b16 v[212:213], v13 offset:29184
s_waitcnt lgkmcnt(3)
v_mfma_f32_16x16x32_bf16 a[224:227], v[160:163], v[216:219], a[224:227]
ds_read_b64_tr_b16 v[214:215], v13 offset:31232
v_cvt_pk_bf16_f32 v118, v156, v157
v_mfma_f32_16x16x32_bf16 a[224:227], v[0:3], v[220:223], a[224:227]
v_cvt_pk_bf16_f32 v119, v158, v159
buffer_store_dwordx4 v[116:119], v243, s[20:23], s47 offen offset:1024 sc1
v_mfma_f32_16x16x32_bf16 a[228:231], v[164:167], v[216:219], a[228:231]
v_accvgpr_read_b32 v128, a192
v_accvgpr_read_b32 v129, a193
v_mfma_f32_16x16x32_bf16 a[228:231], v[32:35], v[220:223], a[228:231]
v_accvgpr_read_b32 v130, a194
v_accvgpr_read_b32 v131, a195
v_mfma_f32_16x16x32_bf16 a[232:235], v[168:171], v[216:219], a[232:235]
v_cvt_pk_bf16_f32 v24, v128, v129
v_cvt_pk_bf16_f32 v25, v130, v131
v_mfma_f32_16x16x32_bf16 a[232:235], v[64:67], v[220:223], a[232:235]
v_accvgpr_read_b32 v136, a196
v_accvgpr_read_b32 v137, a197
v_mfma_f32_16x16x32_bf16 a[236:239], v[172:175], v[216:219], a[236:239]
ds_read_b64_tr_b16 v[216:217], v15 offset:12800
ds_read_b64_tr_b16 v[218:219], v15 offset:14848
v_mfma_f32_16x16x32_bf16 a[236:239], v[96:99], v[220:223], a[236:239]
ds_read_b64_tr_b16 v[220:221], v15 offset:29184
s_waitcnt lgkmcnt(3)
v_mfma_f32_16x16x32_bf16 a[240:243], v[8:11], v[208:211], a[240:243]
ds_read_b64_tr_b16 v[222:223], v15 offset:31232
v_accvgpr_read_b32 v138, a198
v_mfma_f32_16x16x32_bf16 a[240:243], v[176:179], v[212:215], a[240:243]
v_accvgpr_read_b32 v139, a199
v_cvt_pk_bf16_f32 v56, v136, v137
v_mfma_f32_16x16x32_bf16 a[244:247], v[40:43], v[208:211], a[244:247]
v_cvt_pk_bf16_f32 v57, v138, v139
v_accvgpr_read_b32 v144, a200
v_mfma_f32_16x16x32_bf16 a[244:247], v[180:183], v[212:215], a[244:247]
v_accvgpr_read_b32 v145, a201
v_accvgpr_read_b32 v146, a202
v_mfma_f32_16x16x32_bf16 a[248:251], v[72:75], v[208:211], a[248:251]
v_accvgpr_read_b32 v147, a203
v_cvt_pk_bf16_f32 v88, v144, v145
v_mfma_f32_16x16x32_bf16 a[248:251], v[184:187], v[212:215], a[248:251]
v_cvt_pk_bf16_f32 v89, v146, v147
v_accvgpr_read_b32 v152, a204
v_mfma_f32_16x16x32_bf16 a[252:255], v[104:107], v[208:211], a[252:255]
v_accvgpr_read_b32 v153, a205
v_accvgpr_read_b32 v154, a206
v_mfma_f32_16x16x32_bf16 a[252:255], v[188:191], v[212:215], a[252:255]
s_waitcnt lgkmcnt(0)
v_accvgpr_read_b32 v155, a207
v_mfma_f32_16x16x32_bf16 a[240:243], v[160:163], v[216:219], a[240:243]
v_cvt_pk_bf16_f32 v120, v152, v153
v_cvt_pk_bf16_f32 v121, v154, v155
v_mfma_f32_16x16x32_bf16 a[240:243], v[0:3], v[220:223], a[240:243]
v_accvgpr_read_b32 v132, a208
v_accvgpr_read_b32 v133, a209
v_mfma_f32_16x16x32_bf16 a[244:247], v[164:167], v[216:219], a[244:247]
v_accvgpr_read_b32 v134, a210
v_accvgpr_read_b32 v135, a211
v_mfma_f32_16x16x32_bf16 a[244:247], v[32:35], v[220:223], a[244:247]
v_cvt_pk_bf16_f32 v26, v132, v133
v_cvt_pk_bf16_f32 v27, v134, v135
v_mfma_f32_16x16x32_bf16 a[248:251], v[168:171], v[216:219], a[248:251]
buffer_store_dwordx4 v[24:27], v243, s[20:23], s44 offen offset:2048 sc1
ds_write_b128 v231, v[24:27] offset:6144
v_mfma_f32_16x16x32_bf16 a[248:251], v[64:67], v[220:223], a[248:251]
v_accvgpr_read_b32 v140, a212
v_accvgpr_read_b32 v141, a213
v_mfma_f32_16x16x32_bf16 a[252:255], v[172:175], v[216:219], a[252:255]
v_accvgpr_read_b32 v142, a214
v_accvgpr_read_b32 v143, a215
v_mfma_f32_16x16x32_bf16 a[252:255], v[96:99], v[220:223], a[252:255]
v_cvt_pk_bf16_f32 v58, v140, v141
v_cvt_pk_bf16_f32 v59, v142, v143
buffer_store_dwordx4 v[56:59], v243, s[20:23], s45 offen offset:2048 sc1
v_accvgpr_read_b32 v148, a216
v_accvgpr_read_b32 v149, a217
v_accvgpr_read_b32 v150, a218
v_accvgpr_read_b32 v151, a219
v_cvt_pk_bf16_f32 v90, v148, v149
v_cvt_pk_bf16_f32 v91, v150, v151
buffer_store_dwordx4 v[88:91], v243, s[20:23], s46 offen offset:2048 sc1
v_accvgpr_read_b32 v156, a220
v_accvgpr_read_b32 v157, a221
v_accvgpr_read_b32 v158, a222
v_accvgpr_read_b32 v159, a223
v_cvt_pk_bf16_f32 v122, v156, v157
v_cvt_pk_bf16_f32 v123, v158, v159
buffer_store_dwordx4 v[120:123], v243, s[20:23], s47 offen offset:2048 sc1
v_accvgpr_read_b32 v128, a224
v_accvgpr_read_b32 v129, a225
v_accvgpr_read_b32 v130, a226
v_accvgpr_read_b32 v131, a227
v_cvt_pk_bf16_f32 v28, v128, v129
v_cvt_pk_bf16_f32 v29, v130, v131
v_accvgpr_read_b32 v136, a228
v_accvgpr_read_b32 v137, a229
v_accvgpr_read_b32 v138, a230
v_accvgpr_read_b32 v139, a231
v_cvt_pk_bf16_f32 v60, v136, v137
v_cvt_pk_bf16_f32 v61, v138, v139
v_accvgpr_read_b32 v144, a232
v_accvgpr_read_b32 v145, a233
v_accvgpr_read_b32 v146, a234
v_accvgpr_read_b32 v147, a235
v_cvt_pk_bf16_f32 v92, v144, v145
v_cvt_pk_bf16_f32 v93, v146, v147
v_accvgpr_read_b32 v152, a236
v_accvgpr_read_b32 v153, a237
v_accvgpr_read_b32 v154, a238
v_accvgpr_read_b32 v155, a239
v_cvt_pk_bf16_f32 v124, v152, v153
v_cvt_pk_bf16_f32 v125, v154, v155
v_accvgpr_read_b32 v132, a240
v_accvgpr_read_b32 v133, a241
v_accvgpr_read_b32 v134, a242
v_accvgpr_read_b32 v135, a243
v_cvt_pk_bf16_f32 v30, v132, v133
v_cvt_pk_bf16_f32 v31, v134, v135
buffer_store_dwordx4 v[28:31], v243, s[20:23], s44 offen offset:3072 sc1
ds_write_b128 v231, v[28:31] offset:7168
v_accvgpr_read_b32 v140, a244
v_accvgpr_read_b32 v141, a245
v_accvgpr_read_b32 v142, a246
v_accvgpr_read_b32 v143, a247
v_cvt_pk_bf16_f32 v62, v140, v141
v_cvt_pk_bf16_f32 v63, v142, v143
buffer_store_dwordx4 v[60:63], v243, s[20:23], s45 offen offset:3072 sc1
v_accvgpr_read_b32 v148, a248
v_accvgpr_read_b32 v149, a249
v_accvgpr_read_b32 v150, a250
v_accvgpr_read_b32 v151, a251
v_cvt_pk_bf16_f32 v94, v148, v149
v_cvt_pk_bf16_f32 v95, v150, v151
buffer_store_dwordx4 v[92:95], v243, s[20:23], s46 offen offset:3072 sc1
v_accvgpr_read_b32 v156, a252
v_accvgpr_read_b32 v157, a253
v_accvgpr_read_b32 v158, a254
v_accvgpr_read_b32 v159, a255
v_cvt_pk_bf16_f32 v126, v156, v157
v_cvt_pk_bf16_f32 v127, v158, v159
buffer_store_dwordx4 v[124:127], v243, s[20:23], s47 offen offset:3072 sc1
s_waitcnt vmcnt(36)
s_branch L2_F
L2_tail_1:
s_waitcnt lgkmcnt(2)
v_add_u32 v231, s50, v243
v_mfma_f32_16x16x32_bf16 v[144:147], v[208:211], v[0:3], v[192:195]
s_mov_b32 m0, s30
ds_write_b128 v231, v[160:163] offset:0
v_mfma_f32_16x16x32_bf16 v[144:147], v[212:215], v[4:7], v[144:147]
buffer_load_dwordx4 v241, s[12:15], s28 offen offset:0 sc1 lds
ds_write_b128 v231, v[164:167] offset:1024
v_mfma_f32_16x16x32_bf16 v[148:151], v[208:211], v[32:35], v[196:199]
buffer_load_dwordx4 v241, s[12:15], s28 offen offset:1024 sc1 lds
ds_write_b128 v231, v[168:171] offset:2048
v_mfma_f32_16x16x32_bf16 v[148:151], v[212:215], v[36:39], v[148:151]
buffer_load_dwordx4 v241, s[12:15], s28 offen offset:2048 sc1 lds
ds_write_b128 v231, v[172:175] offset:3072
v_mfma_f32_16x16x32_bf16 v[152:155], v[208:211], v[64:67], v[200:203]
buffer_load_dwordx4 v241, s[12:15], s28 offen offset:3072 sc1 lds
v_add_u32 v230, 0x8000, v240
v_and_b32 v230, 0x1ffff, v230
v_mfma_f32_16x16x32_bf16 v[152:155], v[212:215], v[68:71], v[152:155]
v_exp_f32 v232, v128
v_mfma_f32_16x16x32_bf16 v[156:159], v[208:211], v[96:99], v[204:207]
ds_read_b128 v[208:211], v240 offset:10240
v_exp_f32 v233, v129
v_mfma_f32_16x16x32_bf16 v[156:159], v[212:215], v[100:103], v[156:159]
ds_read_b128 v[212:215], v240 offset:10752
s_waitcnt lgkmcnt(2)
s_and_b32 s30, s30, 0x1c000
v_mfma_f32_16x16x32_bf16 v[144:147], v[216:219], v[8:11], v[144:147]
v_exp_f32 v234, v130
v_add_f32 v224, v224, v232
v_mfma_f32_16x16x32_bf16 v[144:147], v[220:223], v[12:15], v[144:147]
v_cvt_pk_bf16_f32 v160, v232, v233
v_exp_f32 v235, v131
v_mfma_f32_16x16x32_bf16 v[148:151], v[216:219], v[40:43], v[148:151]
v_add_f32 v224, v224, v233
v_add_f32 v224, v224, v234
v_add_f32 v224, v224, v235
v_mfma_f32_16x16x32_bf16 v[148:151], v[220:223], v[44:47], v[148:151]
v_cvt_pk_bf16_f32 v161, v234, v235
v_exp_f32 v236, v132
v_mfma_f32_16x16x32_bf16 v[152:155], v[216:219], v[72:75], v[152:155]
v_exp_f32 v237, v133
s_add_u32 s28, s30, 0x4000
v_mfma_f32_16x16x32_bf16 v[152:155], v[220:223], v[76:79], v[152:155]
v_exp_f32 v238, v134
v_add_f32 v225, v225, v236
v_mfma_f32_16x16x32_bf16 v[156:159], v[216:219], v[104:107], v[156:159]
ds_read_b128 v[216:219], v240 offset:14336
v_cvt_pk_bf16_f32 v164, v236, v237
s_and_b32 s28, s28, 0x1ffff
v_mfma_f32_16x16x32_bf16 v[156:159], v[220:223], v[108:111], v[156:159]
ds_read_b128 v[220:223], v240 offset:14848
s_waitcnt lgkmcnt(2)
s_add_u32 s30, s30, 0x8000
v_mfma_f32_16x16x32_bf16 v[144:147], v[208:211], v[16:19], v[144:147]
v_exp_f32 v239, v135
v_add_f32 v225, v225, v237
v_mfma_f32_16x16x32_bf16 v[144:147], v[212:215], v[20:23], v[144:147]
s_waitcnt vmcnt(4)
s_barrier
v_add_f32 v225, v225, v238
v_mfma_f32_16x16x32_bf16 v[148:151], v[208:211], v[48:51], v[148:151]
v_add_f32 v225, v225, v239
v_cvt_pk_bf16_f32 v165, v238, v239
s_and_b32 s30, s30, 0x1ffff
v_mfma_f32_16x16x32_bf16 v[148:151], v[212:215], v[52:55], v[148:151]
v_exp_f32 v232, v136
s_mul_i32 s31, s34, 6144
v_mfma_f32_16x16x32_bf16 v[152:155], v[208:211], v[80:83], v[152:155]
v_exp_f32 v233, v137
s_add_u32 s31, s31, s30
v_mfma_f32_16x16x32_bf16 v[152:155], v[212:215], v[84:87], v[152:155]
v_exp_f32 v234, v138
v_add_f32 v226, v226, v232
v_mfma_f32_16x16x32_bf16 v[156:159], v[208:211], v[112:115], v[156:159]
ds_read_b128 v[208:211], v240 offset:16384
v_cvt_pk_bf16_f32 v168, v232, v233
s_lshl_b32 s3, s34, 10
v_mfma_f32_16x16x32_bf16 v[156:159], v[212:215], v[116:119], v[156:159]
ds_read_b128 v[212:215], v240 offset:16896
s_waitcnt lgkmcnt(2)
s_add_u32 s28, s28, s3
v_mfma_f32_16x16x32_bf16 v[144:147], v[216:219], v[24:27], v[144:147]
v_exp_f32 v235, v139
v_add_f32 v226, v226, v233
v_mfma_f32_16x16x32_bf16 v[144:147], v[220:223], v[28:31], v[144:147]
v_add_f32 v226, v226, v234
v_add_f32 v226, v226, v235
v_cvt_pk_bf16_f32 v169, v234, v235
v_mfma_f32_16x16x32_bf16 v[148:151], v[216:219], v[56:59], v[148:151]
v_exp_f32 v236, v140
s_add_u32 s3, s3, 24576
v_mfma_f32_16x16x32_bf16 v[148:151], v[220:223], v[60:63], v[148:151]
v_exp_f32 v237, v141
s_add_u32 s30, s30, s3
v_mfma_f32_16x16x32_bf16 v[152:155], v[216:219], v[88:91], v[152:155]
v_exp_f32 v238, v142
v_add_f32 v227, v227, v236
v_mfma_f32_16x16x32_bf16 v[152:155], v[220:223], v[92:95], v[152:155]
v_cvt_pk_bf16_f32 v172, v236, v237
v_exp_f32 v239, v143
v_mfma_f32_16x16x32_bf16 v[156:159], v[216:219], v[120:123], v[156:159]
ds_read_b128 v[216:219], v240 offset:20480
v_add_f32 v227, v227, v237
v_add_f32 v227, v227, v238
v_mfma_f32_16x16x32_bf16 v[156:159], v[220:223], v[124:127], v[156:159]
ds_read_b128 v[220:223], v240 offset:20992
s_waitcnt lgkmcnt(2)
v_add_f32 v227, v227, v239
v_cvt_pk_bf16_f32 v173, v238, v239
v_max3_f32 v242, v224, v225, v226
v_max_f32 v242, v242, v227
v_cmp_lt_f32 vcc, s32, v242
s_cbranch_vccnz L2_rare_site12
L2_ret12:
v_mfma_f32_16x16x32_bf16 v[128:131], v[208:211], v[0:3], v[192:195]
v_lshrrev_b32 v241, 4, v243
v_and_b32 v241, 0x30, v241
v_xor_b32 v241, v241, v243
v_and_b32 v228, 0x380, v243
v_mad_u32_u24 v241, v228, 3, v241
v_mfma_f32_16x16x32_bf16 v[128:131], v[212:215], v[4:7], v[128:131]
v_exp_f32 v232, v144
v_mfma_f32_16x16x32_bf16 v[132:135], v[208:211], v[32:35], v[196:199]
v_exp_f32 v233, v145
v_mfma_f32_16x16x32_bf16 v[132:135], v[212:215], v[36:39], v[132:135]
v_exp_f32 v234, v146
v_add_f32 v224, v224, v232
v_mfma_f32_16x16x32_bf16 v[136:139], v[208:211], v[64:67], v[200:203]
v_cvt_pk_bf16_f32 v162, v232, v233
v_exp_f32 v235, v147
v_mfma_f32_16x16x32_bf16 v[136:139], v[212:215], v[68:71], v[136:139]
v_add_f32 v224, v224, v233
v_add_f32 v224, v224, v234
v_add_f32 v224, v224, v235
v_mfma_f32_16x16x32_bf16 v[140:143], v[208:211], v[96:99], v[204:207]
ds_read_b128 v[208:211], v240 offset:24576
v_cvt_pk_bf16_f32 v163, v234, v235
v_mfma_f32_16x16x32_bf16 v[140:143], v[212:215], v[100:103], v[140:143]
ds_read_b128 v[212:215], v240 offset:25088
s_waitcnt lgkmcnt(2)
v_mfma_f32_16x16x32_bf16 v[128:131], v[216:219], v[8:11], v[128:131]
ds_write_b128 v231, v[176:179] offset:4096
v_exp_f32 v236, v148
v_mfma_f32_16x16x32_bf16 v[128:131], v[220:223], v[12:15], v[128:131]
ds_write_b128 v231, v[180:183] offset:5120
v_exp_f32 v237, v149
v_mfma_f32_16x16x32_bf16 v[132:135], v[216:219], v[40:43], v[132:135]
ds_write_b128 v231, v[184:187] offset:6144
v_exp_f32 v238, v150
v_mfma_f32_16x16x32_bf16 v[132:135], v[220:223], v[44:47], v[132:135]
ds_write_b128 v231, v[188:191] offset:7168
v_add_f32 v225, v225, v236
v_cvt_pk_bf16_f32 v166, v236, v237
v_mfma_f32_16x16x32_bf16 v[136:139], v[216:219], v[72:75], v[136:139]
v_exp_f32 v239, v151
v_add_f32 v225, v225, v237
v_mfma_f32_16x16x32_bf16 v[136:139], v[220:223], v[76:79], v[136:139]
v_add_f32 v225, v225, v238
v_add_f32 v225, v225, v239
v_cvt_pk_bf16_f32 v167, v238, v239
v_mfma_f32_16x16x32_bf16 v[140:143], v[216:219], v[104:107], v[140:143]
ds_read_b128 v[216:219], v240 offset:28672
v_exp_f32 v232, v152
v_mfma_f32_16x16x32_bf16 v[140:143], v[220:223], v[108:111], v[140:143]
ds_read_b128 v[220:223], v240 offset:29184
s_waitcnt lgkmcnt(2)
v_mfma_f32_16x16x32_bf16 v[128:131], v[208:211], v[16:19], v[128:131]
v_exp_f32 v233, v153
v_mfma_f32_16x16x32_bf16 v[128:131], v[212:215], v[20:23], v[128:131]
v_exp_f32 v234, v154
v_add_f32 v226, v226, v232
v_mfma_f32_16x16x32_bf16 v[132:135], v[208:211], v[48:51], v[132:135]
v_cvt_pk_bf16_f32 v170, v232, v233
v_exp_f32 v235, v155
v_mfma_f32_16x16x32_bf16 v[132:135], v[212:215], v[52:55], v[132:135]
v_add_f32 v226, v226, v233
v_add_f32 v226, v226, v234
v_add_f32 v226, v226, v235
v_mfma_f32_16x16x32_bf16 v[136:139], v[208:211], v[80:83], v[136:139]
v_cvt_pk_bf16_f32 v171, v234, v235
v_exp_f32 v236, v156
v_mfma_f32_16x16x32_bf16 v[136:139], v[212:215], v[84:87], v[136:139]
v_exp_f32 v237, v157
v_mfma_f32_16x16x32_bf16 v[140:143], v[208:211], v[112:115], v[140:143]
ds_read_b128 v[208:211], v240 offset:18432
v_exp_f32 v238, v158
v_mfma_f32_16x16x32_bf16 v[140:143], v[212:215], v[116:119], v[140:143]
ds_read_b128 v[212:215], v240 offset:18944
s_waitcnt lgkmcnt(2)
v_add_f32 v227, v227, v236
v_mfma_f32_16x16x32_bf16 v[128:131], v[216:219], v[24:27], v[128:131]
v_cvt_pk_bf16_f32 v174, v236, v237
v_exp_f32 v239, v159
v_mfma_f32_16x16x32_bf16 v[128:131], v[220:223], v[28:31], v[128:131]
v_add_f32 v227, v227, v237
v_add_f32 v227, v227, v238
v_add_f32 v227, v227, v239
v_mfma_f32_16x16x32_bf16 v[132:135], v[216:219], v[56:59], v[132:135]
v_cvt_pk_bf16_f32 v175, v238, v239
v_max3_f32 v242, v224, v225, v226
v_max_f32 v242, v242, v227
v_mfma_f32_16x16x32_bf16 v[132:135], v[220:223], v[60:63], v[132:135]
v_cmp_lt_f32 vcc, s32, v242
s_cbranch_vccnz L2_rare_site13
L2_ret13:
v_mfma_f32_16x16x32_bf16 v[136:139], v[216:219], v[88:91], v[136:139]
s_add_u32 m0, s31, 0
v_mfma_f32_16x16x32_bf16 v[136:139], v[220:223], v[92:95], v[136:139]
buffer_load_dwordx4 v241, s[8:11], s6 offen lds
s_add_u32 m0, s31, 2048
v_mfma_f32_16x16x32_bf16 v[140:143], v[216:219], v[120:123], v[140:143]
ds_read_b128 v[216:219], v240 offset:22528
buffer_load_dwordx4 v241, s[8:11], s7 offen lds
s_add_u32 m0, s31, 4096
v_mfma_f32_16x16x32_bf16 v[140:143], v[220:223], v[124:127], v[140:143]
ds_read_b128 v[220:223], v240 offset:23040
s_waitcnt lgkmcnt(2)
v_mfma_f32_16x16x32_bf16 v[144:147], v[208:211], v[0:3], v[192:195]
buffer_load_dwordx4 v241, s[8:11], s29 offen lds
s_add_u32 m0, s31, 1024
v_xor_b32 v241, 0x1040, v241
v_mfma_f32_16x16x32_bf16 v[144:147], v[212:215], v[4:7], v[144:147]
v_exp_f32 v232, v128
v_mfma_f32_16x16x32_bf16 v[148:151], v[208:211], v[32:35], v[196:199]
v_exp_f32 v233, v129
v_mfma_f32_16x16x32_bf16 v[148:151], v[212:215], v[36:39], v[148:151]
v_exp_f32 v234, v130
v_add_f32 v224, v224, v232
v_mfma_f32_16x16x32_bf16 v[152:155], v[208:211], v[64:67], v[200:203]
v_cvt_pk_bf16_f32 v176, v232, v233
v_exp_f32 v235, v131
v_mfma_f32_16x16x32_bf16 v[152:155], v[212:215], v[68:71], v[152:155]
v_add_f32 v224, v224, v233
v_add_f32 v224, v224, v234
v_add_f32 v224, v224, v235
v_mfma_f32_16x16x32_bf16 v[156:159], v[208:211], v[96:99], v[204:207]
ds_read_b128 v[208:211], v240 offset:26624
v_cvt_pk_bf16_f32 v177, v234, v235
v_mfma_f32_16x16x32_bf16 v[156:159], v[212:215], v[100:103], v[156:159]
ds_read_b128 v[212:215], v240 offset:27136
s_waitcnt lgkmcnt(2)
v_mfma_f32_16x16x32_bf16 v[144:147], v[216:219], v[8:11], v[144:147]
v_exp_f32 v236, v132
v_mfma_f32_16x16x32_bf16 v[144:147], v[220:223], v[12:15], v[144:147]
v_exp_f32 v237, v133
v_mfma_f32_16x16x32_bf16 v[148:151], v[216:219], v[40:43], v[148:151]
v_exp_f32 v238, v134
v_add_f32 v225, v225, v236
v_mfma_f32_16x16x32_bf16 v[148:151], v[220:223], v[44:47], v[148:151]
v_cvt_pk_bf16_f32 v180, v236, v237
v_exp_f32 v239, v135
v_mfma_f32_16x16x32_bf16 v[152:155], v[216:219], v[72:75], v[152:155]
v_add_f32 v225, v225, v237
v_add_f32 v225, v225, v238
v_add_f32 v225, v225, v239
v_mfma_f32_16x16x32_bf16 v[152:155], v[220:223], v[76:79], v[152:155]
v_cvt_pk_bf16_f32 v181, v238, v239
v_exp_f32 v232, v136
v_mfma_f32_16x16x32_bf16 v[156:159], v[216:219], v[104:107], v[156:159]
ds_read_b128 v[216:219], v240 offset:30720
v_exp_f32 v233, v137
v_mfma_f32_16x16x32_bf16 v[156:159], v[220:223], v[108:111], v[156:159]
ds_read_b128 v[220:223], v240 offset:31232
s_waitcnt lgkmcnt(2)
v_mfma_f32_16x16x32_bf16 v[144:147], v[208:211], v[16:19], v[144:147]
v_exp_f32 v234, v138
v_add_f32 v226, v226, v232
v_mfma_f32_16x16x32_bf16 v[144:147], v[212:215], v[20:23], v[144:147]
s_waitcnt vmcnt(3)
s_barrier
v_cvt_pk_bf16_f32 v184, v232, v233
v_mfma_f32_16x16x32_bf16 v[148:151], v[208:211], v[48:51], v[148:151]
v_exp_f32 v235, v139
v_add_f32 v226, v226, v233
v_mfma_f32_16x16x32_bf16 v[148:151], v[212:215], v[52:55], v[148:151]
v_add_f32 v226, v226, v234
v_add_f32 v226, v226, v235
v_cvt_pk_bf16_f32 v185, v234, v235
v_mfma_f32_16x16x32_bf16 v[152:155], v[208:211], v[80:83], v[152:155]
v_exp_f32 v236, v140
v_mfma_f32_16x16x32_bf16 v[152:155], v[212:215], v[84:87], v[152:155]
v_exp_f32 v237, v141
v_mfma_f32_16x16x32_bf16 v[156:159], v[208:211], v[112:115], v[156:159]
ds_read_b128 v[208:211], v230 offset:0
v_exp_f32 v238, v142
v_mfma_f32_16x16x32_bf16 v[156:159], v[212:215], v[116:119], v[156:159]
ds_read_b128 v[212:215], v230 offset:512
s_waitcnt lgkmcnt(2)
v_add_f32 v227, v227, v236
v_mfma_f32_16x16x32_bf16 v[144:147], v[216:219], v[24:27], v[144:147]
v_cvt_pk_bf16_f32 v188, v236, v237
v_exp_f32 v239, v143
v_mfma_f32_16x16x32_bf16 v[144:147], v[220:223], v[28:31], v[144:147]
v_add_f32 v227, v227, v237
v_add_f32 v227, v227, v238
v_add_f32 v227, v227, v239
v_mfma_f32_16x16x32_bf16 v[148:151], v[216:219], v[56:59], v[148:151]
v_cvt_pk_bf16_f32 v189, v238, v239
v_max3_f32 v242, v224, v225, v226
v_max_f32 v242, v242, v227
v_mfma_f32_16x16x32_bf16 v[148:151], v[220:223], v[60:63], v[148:151]
v_cmp_lt_f32 vcc, s32, v242
s_cbranch_vccnz L2_rare_site14
L2_ret14:
v_mfma_f32_16x16x32_bf16 v[152:155], v[216:219], v[88:91], v[152:155]
buffer_load_dwordx4 v241, s[8:11], s6 offen lds
s_add_u32 m0, s31, 3072
v_mfma_f32_16x16x32_bf16 v[152:155], v[220:223], v[92:95], v[152:155]
buffer_load_dwordx4 v241, s[8:11], s7 offen lds
s_add_u32 m0, s31, 5120
v_mfma_f32_16x16x32_bf16 v[156:159], v[216:219], v[120:123], v[156:159]
ds_read_b128 v[216:219], v230 offset:4096
buffer_load_dwordx4 v241, s[8:11], s29 offen lds
v_mfma_f32_16x16x32_bf16 v[156:159], v[220:223], v[124:127], v[156:159]
ds_read_b128 v[220:223], v230 offset:4608
s_waitcnt lgkmcnt(2)
v_mfma_f32_16x16x32_bf16 v[128:131], v[208:211], v[0:3], v[192:195]
v_mfma_f32_16x16x32_bf16 v[128:131], v[212:215], v[4:7], v[128:131]
v_exp_f32 v232, v144
v_mfma_f32_16x16x32_bf16 v[132:135], v[208:211], v[32:35], v[196:199]
v_exp_f32 v233, v145
v_mfma_f32_16x16x32_bf16 v[132:135], v[212:215], v[36:39], v[132:135]
v_exp_f32 v234, v146
v_add_f32 v224, v224, v232
v_mfma_f32_16x16x32_bf16 v[136:139], v[208:211], v[64:67], v[200:203]
v_cvt_pk_bf16_f32 v178, v232, v233
v_exp_f32 v235, v147
v_mfma_f32_16x16x32_bf16 v[136:139], v[212:215], v[68:71], v[136:139]
v_add_f32 v224, v224, v233
v_add_f32 v224, v224, v234
v_add_f32 v224, v224, v235
v_mfma_f32_16x16x32_bf16 v[140:143], v[208:211], v[96:99], v[204:207]
ds_read_b128 v[208:211], v230 offset:8192
v_cvt_pk_bf16_f32 v179, v234, v235
v_lshlrev_b32 v241, 3, v243
v_mfma_f32_16x16x32_bf16 v[140:143], v[212:215], v[100:103], v[140:143]
ds_read_b128 v[212:215], v230 offset:8704
s_waitcnt lgkmcnt(2)
s_mov_b32 s3, 0x7c28000
v_mfma_f32_16x16x32_bf16 v[128:131], v[216:219], v[8:11], v[128:131]
v_exp_f32 v236, v148
buffer_load_dwordx2 v[240:241], v241, s[16:19], s3 offen sc1
v_mfma_f32_16x16x32_bf16 v[128:131], v[220:223], v[12:15], v[128:131]
v_exp_f32 v237, v149
v_mfma_f32_16x16x32_bf16 v[132:135], v[216:219], v[40:43], v[132:135]
v_exp_f32 v238, v150
v_add_f32 v225, v225, v236
v_mfma_f32_16x16x32_bf16 v[132:135], v[220:223], v[44:47], v[132:135]
v_cvt_pk_bf16_f32 v182, v236, v237
v_exp_f32 v239, v151
v_mfma_f32_16x16x32_bf16 v[136:139], v[216:219], v[72:75], v[136:139]
v_add_f32 v225, v225, v237
v_add_f32 v225, v225, v238
v_add_f32 v225, v225, v239
v_mfma_f32_16x16x32_bf16 v[136:139], v[220:223], v[76:79], v[136:139]
v_cvt_pk_bf16_f32 v183, v238, v239
v_exp_f32 v232, v152
v_mfma_f32_16x16x32_bf16 v[140:143], v[216:219], v[104:107], v[140:143]
ds_read_b128 v[216:219], v230 offset:12288
v_exp_f32 v233, v153
v_mfma_f32_16x16x32_bf16 v[140:143], v[220:223], v[108:111], v[140:143]
ds_read_b128 v[220:223], v230 offset:12800
s_waitcnt lgkmcnt(2)
v_mfma_f32_16x16x32_bf16 v[128:131], v[208:211], v[16:19], v[128:131]
v_exp_f32 v234, v154
v_add_f32 v226, v226, v232
v_mfma_f32_16x16x32_bf16 v[128:131], v[212:215], v[20:23], v[128:131]
v_cvt_pk_bf16_f32 v186, v232, v233
v_exp_f32 v235, v155
v_mfma_f32_16x16x32_bf16 v[132:135], v[208:211], v[48:51], v[132:135]
v_add_f32 v226, v226, v233
v_add_f32 v226, v226, v234
v_add_f32 v226, v226, v235
v_mfma_f32_16x16x32_bf16 v[132:135], v[212:215], v[52:55], v[132:135]
v_cvt_pk_bf16_f32 v187, v234, v235
v_exp_f32 v236, v156
v_mfma_f32_16x16x32_bf16 v[136:139], v[208:211], v[80:83], v[136:139]
v_exp_f32 v237, v157
v_mfma_f32_16x16x32_bf16 v[136:139], v[212:215], v[84:87], v[136:139]
v_exp_f32 v238, v158
v_add_f32 v227, v227, v236
v_mfma_f32_16x16x32_bf16 v[140:143], v[208:211], v[112:115], v[140:143]
ds_read_b128 v[208:211], v230 offset:2048
v_cvt_pk_bf16_f32 v190, v236, v237
v_mfma_f32_16x16x32_bf16 v[140:143], v[212:215], v[116:119], v[140:143]
ds_read_b128 v[212:215], v230 offset:2560
s_waitcnt lgkmcnt(2)
v_mfma_f32_16x16x32_bf16 v[128:131], v[216:219], v[24:27], v[128:131]
v_exp_f32 v239, v159
v_add_f32 v227, v227, v237
v_mfma_f32_16x16x32_bf16 v[128:131], v[220:223], v[28:31], v[128:131]
v_add_f32 v227, v227, v238
v_add_f32 v227, v227, v239
v_cvt_pk_bf16_f32 v191, v238, v239
v_mfma_f32_16x16x32_bf16 v[132:135], v[216:219], v[56:59], v[132:135]
v_max3_f32 v242, v224, v225, v226
v_max_f32 v242, v242, v227
v_cmp_lt_f32 vcc, s32, v242
s_cbranch_vccnz L2_rare_site15
L2_ret15:
v_mfma_f32_16x16x32_bf16 v[132:135], v[220:223], v[60:63], v[132:135]
v_mfma_f32_16x16x32_bf16 v[136:139], v[216:219], v[88:91], v[136:139]
v_mfma_f32_16x16x32_bf16 v[136:139], v[220:223], v[92:95], v[136:139]
v_mfma_f32_16x16x32_bf16 v[140:143], v[216:219], v[120:123], v[140:143]
ds_read_b128 v[216:219], v230 offset:6144
v_mfma_f32_16x16x32_bf16 v[140:143], v[220:223], v[124:127], v[140:143]
ds_read_b128 v[220:223], v230 offset:6656
s_waitcnt lgkmcnt(2)
v_mfma_f32_16x16x32_bf16 v[144:147], v[208:211], v[0:3], v[192:195]
v_mfma_f32_16x16x32_bf16 v[144:147], v[212:215], v[4:7], v[144:147]
v_mfma_f32_16x16x32_bf16 v[148:151], v[208:211], v[32:35], v[196:199]
v_mfma_f32_16x16x32_bf16 v[148:151], v[212:215], v[36:39], v[148:151]
v_mfma_f32_16x16x32_bf16 v[152:155], v[208:211], v[64:67], v[200:203]
v_exp_f32 v232, v128
v_mfma_f32_16x16x32_bf16 v[152:155], v[212:215], v[68:71], v[152:155]
v_exp_f32 v233, v129
v_mfma_f32_16x16x32_bf16 v[156:159], v[208:211], v[96:99], v[204:207]
ds_read_b128 v[208:211], v230 offset:10240
v_exp_f32 v234, v130
v_mfma_f32_16x16x32_bf16 v[156:159], v[212:215], v[100:103], v[156:159]
ds_read_b128 v[212:215], v230 offset:10752
s_waitcnt lgkmcnt(2)
v_add_f32 v224, v224, v232
v_mfma_f32_16x16x32_bf16 v[144:147], v[216:219], v[8:11], v[144:147]
v_cvt_pk_bf16_f32 v0, v232, v233
v_exp_f32 v235, v131
v_mfma_f32_16x16x32_bf16 v[144:147], v[220:223], v[12:15], v[144:147]
ds_read_b128 v[4:7], v231 offset:0
v_add_f32 v224, v224, v233
v_add_f32 v224, v224, v234
v_mfma_f32_16x16x32_bf16 v[148:151], v[216:219], v[40:43], v[148:151]
ds_read_b128 v[36:39], v231 offset:1024
v_add_f32 v224, v224, v235
v_cvt_pk_bf16_f32 v1, v234, v235
v_mfma_f32_16x16x32_bf16 v[148:151], v[220:223], v[44:47], v[148:151]
v_exp_f32 v236, v132
v_mfma_f32_16x16x32_bf16 v[152:155], v[216:219], v[72:75], v[152:155]
v_exp_f32 v237, v133
v_mfma_f32_16x16x32_bf16 v[152:155], v[220:223], v[76:79], v[152:155]
ds_read_b128 v[68:71], v231 offset:2048
ds_read_b128 v[8:11], v231 offset:4096
v_mfma_f32_16x16x32_bf16 v[156:159], v[216:219], v[104:107], v[156:159]
ds_read_b128 v[216:219], v230 offset:14336
v_add_u32 v12, 0x8000, v246
v_and_b32 v12, 0x1ffff, v12
ds_read_b128 v[100:103], v231 offset:3072
ds_read_b128 v[40:43], v231 offset:5120
v_mfma_f32_16x16x32_bf16 v[156:159], v[220:223], v[108:111], v[156:159]
ds_read_b128 v[220:223], v230 offset:14848
s_waitcnt lgkmcnt(2)
v_add_u32 v14, 0x10000, v246
v_and_b32 v14, 0x1ffff, v14
v_mfma_f32_16x16x32_bf16 v[144:147], v[208:211], v[16:19], v[144:147]
v_xor_b32 v13, 32, v12
v_xor_b32 v15, 32, v14
v_mfma_f32_16x16x32_bf16 v[144:147], v[212:215], v[20:23], v[144:147]
ds_read_b128 v[72:75], v231 offset:6144
v_exp_f32 v238, v134
v_mfma_f32_16x16x32_bf16 v[148:151], v[208:211], v[48:51], v[148:151]
ds_read_b128 v[104:107], v231 offset:7168
v_add_f32 v225, v225, v236
v_cvt_pk_bf16_f32 v32, v236, v237
v_mfma_f32_16x16x32_bf16 v[148:151], v[212:215], v[52:55], v[148:151]
v_exp_f32 v239, v135
v_add_f32 v225, v225, v237
v_mfma_f32_16x16x32_bf16 v[152:155], v[208:211], v[80:83], v[152:155]
v_add_f32 v225, v225, v238
v_add_f32 v225, v225, v239
v_cvt_pk_bf16_f32 v33, v238, v239
v_mfma_f32_16x16x32_bf16 v[152:155], v[212:215], v[84:87], v[152:155]
v_exp_f32 v232, v136
v_mfma_f32_16x16x32_bf16 v[156:159], v[208:211], v[112:115], v[156:159]
ds_read_b64_tr_b16 v[208:209], v246 offset:16384
ds_read_b64_tr_b16 v[210:211], v246 offset:18432
v_mfma_f32_16x16x32_bf16 v[156:159], v[212:215], v[116:119], v[156:159]
ds_read_b64_tr_b16 v[212:213], v12 offset:0
s_waitcnt lgkmcnt(3)
v_mfma_f32_16x16x32_bf16 v[144:147], v[216:219], v[24:27], v[144:147]
ds_read_b64_tr_b16 v[214:215], v12 offset:2048
v_exp_f32 v233, v137
v_mfma_f32_16x16x32_bf16 v[144:147], v[220:223], v[28:31], v[144:147]
v_exp_f32 v234, v138
v_add_f32 v226, v226, v232
v_mfma_f32_16x16x32_bf16 v[148:151], v[216:219], v[56:59], v[148:151]
v_cvt_pk_bf16_f32 v64, v232, v233
v_exp_f32 v235, v139
v_mfma_f32_16x16x32_bf16 v[148:151], v[220:223], v[60:63], v[148:151]
v_add_f32 v226, v226, v233
v_add_f32 v226, v226, v234
v_add_f32 v226, v226, v235
v_mfma_f32_16x16x32_bf16 v[152:155], v[216:219], v[88:91], v[152:155]
v_cvt_pk_bf16_f32 v65, v234, v235
v_exp_f32 v236, v140
v_mfma_f32_16x16x32_bf16 v[152:155], v[220:223], v[92:95], v[152:155]
v_exp_f32 v237, v141
s_waitcnt vmcnt(0)
v_mfma_f32_16x16x32_bf16 v[156:159], v[216:219], v[120:123], v[156:159]
ds_read_b64_tr_b16 v[216:217], v12 offset:16384
ds_read_b64_tr_b16 v[218:219], v12 offset:18432
v_cmp_ne_u64_e64 s[38:39], s[98:99], v[240:241]
v_mfma_f32_16x16x32_bf16 v[156:159], v[220:223], v[124:127], v[156:159]
ds_read_b64_tr_b16 v[220:221], v247 offset:16384
s_waitcnt lgkmcnt(3)
v_exp_f32 v238, v142
v_add_f32 v227, v227, v236
v_cvt_pk_bf16_f32 v96, v236, v237
v_exp_f32 v239, v143
v_add_f32 v227, v227, v237
v_add_f32 v227, v227, v238
v_add_f32 v227, v227, v239
v_cvt_pk_bf16_f32 v97, v238, v239
v_max3_f32 v242, v224, v225, v226
v_max_f32 v242, v242, v227
v_cmp_lt_f32 vcc, s32, v242
s_cbranch_vccnz L2_rare_site16
L2_ret16:
v_mfma_f32_16x16x32_bf16 a[0:3], v[8:11], v[208:211], a[0:3]
ds_read_b64_tr_b16 v[222:223], v247 offset:18432
s_and_b64 s[38:39], s[38:39], s[96:97]
s_cbranch_scc1 LF_hl_0
LF_hlret_0:
v_mfma_f32_16x16x32_bf16 a[0:3], v[160:163], v[212:215], a[0:3]
v_exp_f32 v232, v144
v_lshrrev_b32 v241, 4, v243
v_mfma_f32_16x16x32_bf16 a[4:7], v[40:43], v[208:211], a[4:7]
v_exp_f32 v233, v145
v_and_b32 v241, 0x30, v241
v_mfma_f32_16x16x32_bf16 a[4:7], v[164:167], v[212:215], a[4:7]
v_exp_f32 v234, v146
v_xor_b32 v241, v241, v243
v_mfma_f32_16x16x32_bf16 a[8:11], v[72:75], v[208:211], a[8:11]
v_add_f32 v224, v224, v232
v_cvt_pk_bf16_f32 v2, v232, v233
v_mfma_f32_16x16x32_bf16 a[8:11], v[168:171], v[212:215], a[8:11]
v_exp_f32 v235, v147
v_mfma_f32_16x16x32_bf16 a[12:15], v[104:107], v[208:211], a[12:15]
ds_read_b64_tr_b16 v[208:209], v13 offset:0
ds_read_b64_tr_b16 v[210:211], v13 offset:2048
v_mfma_f32_16x16x32_bf16 a[12:15], v[172:175], v[212:215], a[12:15]
ds_read_b64_tr_b16 v[212:213], v13 offset:16384
s_waitcnt lgkmcnt(5)
v_mfma_f32_16x16x32_bf16 a[0:3], v[176:179], v[216:219], a[0:3]
ds_read_b64_tr_b16 v[214:215], v13 offset:18432
v_add_f32 v224, v224, v233
v_mfma_f32_16x16x32_bf16 a[4:7], v[180:183], v[216:219], a[4:7]
v_add_f32 v224, v224, v234
v_add_f32 v224, v224, v235
v_mfma_f32_16x16x32_bf16 a[8:11], v[184:187], v[216:219], a[8:11]
v_cvt_pk_bf16_f32 v3, v234, v235
v_and_b32 v228, 0x380, v243
v_mad_u32_u24 v241, v228, 3, v241
v_mfma_f32_16x16x32_bf16 a[12:15], v[188:191], v[216:219], a[12:15]
ds_read_b64_tr_b16 v[216:217], v246 offset:16896
s_waitcnt lgkmcnt(5)
v_add_u32 v241, 0x7000000, v241
v_mfma_f32_16x16x32_bf16 a[16:19], v[8:11], v[220:223], a[16:19]
ds_read_b64_tr_b16 v[218:219], v246 offset:18944
v_and_b32 v110, 0x70, v243
v_lshlrev_b32 v110, 3, v110
v_mfma_f32_16x16x32_bf16 a[20:23], v[40:43], v[220:223], a[20:23]
v_exp_f32 v236, v148
v_add_u32 v110, 0x7c32000, v110
v_mfma_f32_16x16x32_bf16 a[24:27], v[72:75], v[220:223], a[24:27]
v_exp_f32 v237, v149
buffer_load_dwordx2 v[108:109], v110, s[16:19], 0 offen sc1
v_mfma_f32_16x16x32_bf16 a[28:31], v[104:107], v[220:223], a[28:31]
ds_read_b64_tr_b16 v[220:221], v12 offset:512
s_waitcnt lgkmcnt(3)
v_mfma_f32_16x16x32_bf16 a[16:19], v[160:163], v[208:211], a[16:19]
ds_read_b64_tr_b16 v[222:223], v12 offset:2560
s_add_u32 m0, s28, 0
v_mfma_f32_16x16x32_bf16 a[16:19], v[176:179], v[212:215], a[16:19]
v_exp_f32 v238, v150
v_mfma_f32_16x16x32_bf16 a[20:23], v[164:167], v[208:211], a[20:23]
v_add_f32 v225, v225, v236
v_cvt_pk_bf16_f32 v34, v236, v237
v_mfma_f32_16x16x32_bf16 a[20:23], v[180:183], v[212:215], a[20:23]
v_exp_f32 v239, v151
v_mfma_f32_16x16x32_bf16 a[24:27], v[168:171], v[208:211], a[24:27]
v_add_f32 v225, v225, v237
v_add_f32 v225, v225, v238
v_mfma_f32_16x16x32_bf16 a[24:27], v[184:187], v[212:215], a[24:27]
v_add_f32 v225, v225, v239
v_cvt_pk_bf16_f32 v35, v238, v239
v_mfma_f32_16x16x32_bf16 a[28:31], v[172:175], v[208:211], a[28:31]
ds_read_b64_tr_b16 v[208:209], v12 offset:16896
ds_read_b64_tr_b16 v[210:211], v12 offset:18944
v_mfma_f32_16x16x32_bf16 a[28:31], v[188:191], v[212:215], a[28:31]
ds_read_b64_tr_b16 v[212:213], v247 offset:16896
s_waitcnt lgkmcnt(3)
v_mfma_f32_16x16x32_bf16 a[32:35], v[8:11], v[216:219], a[32:35]
ds_read_b64_tr_b16 v[214:215], v247 offset:18944
buffer_load_dwordx4 v241, s[16:19], s6 offen sc1 lds
s_add_u32 m0, s28, 8192
v_mfma_f32_16x16x32_bf16 a[32:35], v[160:163], v[220:223], a[32:35]
v_exp_f32 v232, v152
v_mfma_f32_16x16x32_bf16 a[36:39], v[40:43], v[216:219], a[36:39]
v_exp_f32 v233, v153
v_mfma_f32_16x16x32_bf16 a[36:39], v[164:167], v[220:223], a[36:39]
v_exp_f32 v234, v154
v_mfma_f32_16x16x32_bf16 a[40:43], v[72:75], v[216:219], a[40:43]
v_add_f32 v226, v226, v232
v_cvt_pk_bf16_f32 v66, v232, v233
v_mfma_f32_16x16x32_bf16 a[40:43], v[168:171], v[220:223], a[40:43]
v_exp_f32 v235, v155
v_mfma_f32_16x16x32_bf16 a[44:47], v[104:107], v[216:219], a[44:47]
ds_read_b64_tr_b16 v[216:217], v13 offset:512
ds_read_b64_tr_b16 v[218:219], v13 offset:2560
v_mfma_f32_16x16x32_bf16 a[44:47], v[172:175], v[220:223], a[44:47]
ds_read_b64_tr_b16 v[220:221], v13 offset:16896
s_waitcnt lgkmcnt(5)
v_mfma_f32_16x16x32_bf16 a[32:35], v[176:179], v[208:211], a[32:35]
ds_read_b64_tr_b16 v[222:223], v13 offset:18944
v_add_f32 v226, v226, v233
v_mfma_f32_16x16x32_bf16 a[36:39], v[180:183], v[208:211], a[36:39]
v_add_f32 v226, v226, v234
v_add_f32 v226, v226, v235
v_mfma_f32_16x16x32_bf16 a[40:43], v[184:187], v[208:211], a[40:43]
v_cvt_pk_bf16_f32 v67, v234, v235
buffer_load_dwordx4 v241, s[16:19], s7 offen sc1 lds
s_add_u32 m0, s30, 0
v_mfma_f32_16x16x32_bf16 a[44:47], v[188:191], v[208:211], a[44:47]
ds_read_b64_tr_b16 v[208:209], v14 offset:0
s_waitcnt lgkmcnt(5)
v_mfma_f32_16x16x32_bf16 a[48:51], v[8:11], v[212:215], a[48:51]
ds_read_b64_tr_b16 v[210:211], v14 offset:2048
buffer_load_dwordx4 v241, s[16:19], s29 offen sc1 lds
s_add_u32 m0, s28, 4096
v_mfma_f32_16x16x32_bf16 a[52:55], v[40:43], v[212:215], a[52:55]
v_exp_f32 v236, v156
v_xor_b32 v241, 0x1040, v241
v_mfma_f32_16x16x32_bf16 a[56:59], v[72:75], v[212:215], a[56:59]
v_exp_f32 v237, v157
v_mfma_f32_16x16x32_bf16 a[60:63], v[104:107], v[212:215], a[60:63]
ds_read_b64_tr_b16 v[212:213], v15 offset:0
s_waitcnt lgkmcnt(3)
v_mfma_f32_16x16x32_bf16 a[48:51], v[160:163], v[216:219], a[48:51]
ds_read_b64_tr_b16 v[214:215], v15 offset:2048
buffer_load_dwordx4 v241, s[16:19], s6 offen sc1 lds
s_add_u32 m0, s28, 12288
v_mfma_f32_16x16x32_bf16 a[48:51], v[176:179], v[220:223], a[48:51]
v_exp_f32 v238, v158
v_mfma_f32_16x16x32_bf16 a[52:55], v[164:167], v[216:219], a[52:55]
v_add_f32 v227, v227, v236
v_cvt_pk_bf16_f32 v98, v236, v237
v_mfma_f32_16x16x32_bf16 a[52:55], v[180:183], v[220:223], a[52:55]
v_exp_f32 v239, v159
v_mfma_f32_16x16x32_bf16 a[56:59], v[168:171], v[216:219], a[56:59]
v_add_f32 v227, v227, v237
v_add_f32 v227, v227, v238
v_mfma_f32_16x16x32_bf16 a[56:59], v[184:187], v[220:223], a[56:59]
v_add_f32 v227, v227, v239
v_cvt_pk_bf16_f32 v99, v238, v239
v_mfma_f32_16x16x32_bf16 a[60:63], v[172:175], v[216:219], a[60:63]
ds_read_b64_tr_b16 v[216:217], v14 offset:512
ds_read_b64_tr_b16 v[218:219], v14 offset:2560
v_max3_f32 v242, v224, v225, v226
v_max_f32 v242, v242, v227
v_cmp_lt_f32 vcc, s32, v242
s_cbranch_vccnz L2_rare_site17
L2_ret17:
v_mfma_f32_16x16x32_bf16 a[60:63], v[188:191], v[220:223], a[60:63]
ds_read_b64_tr_b16 v[220:221], v15 offset:512
s_waitcnt lgkmcnt(5)
v_mfma_f32_16x16x32_bf16 a[0:3], v[0:3], v[208:211], a[0:3]
ds_read_b64_tr_b16 v[222:223], v15 offset:2560
buffer_load_dwordx4 v241, s[16:19], s7 offen sc1 lds
s_add_u32 m0, s30, 4096
v_mfma_f32_16x16x32_bf16 a[4:7], v[32:35], v[208:211], a[4:7]
buffer_load_dwordx4 v241, s[16:19], s29 offen sc1 lds
v_bfe_u32 v242, v243, 8, 1
v_mfma_f32_16x16x32_bf16 a[8:11], v[64:67], v[208:211], a[8:11]
v_mul_u32_u24 v242, 48, v242
v_lshl_add_u32 v242, s37, 3, v242
v_and_b32 v228, 0xf0, v243
v_mfma_f32_16x16x32_bf16 a[12:15], v[96:99], v[208:211], a[12:15]
ds_read_b64_tr_b16 v[208:209], v246 offset:20480
s_waitcnt lgkmcnt(5)
v_lshl_add_u32 v242, v228, 3, v242
v_mfma_f32_16x16x32_bf16 a[16:19], v[0:3], v[212:215], a[16:19]
ds_read_b64_tr_b16 v[210:211], v246 offset:22528
v_mov_b32 v232, v224
v_mov_b32 v234, v225
v_mfma_f32_16x16x32_bf16 a[20:23], v[32:35], v[212:215], a[20:23]
v_mov_b32 v236, v226
v_mov_b32 v238, v227
v_permlane32_swap_b32 v224, v232
v_mfma_f32_16x16x32_bf16 a[24:27], v[64:67], v[212:215], a[24:27]
v_permlane32_swap_b32 v225, v234
v_permlane32_swap_b32 v226, v236
v_permlane32_swap_b32 v227, v238
v_mfma_f32_16x16x32_bf16 a[28:31], v[96:99], v[212:215], a[28:31]
ds_read_b64_tr_b16 v[212:213], v12 offset:4096
s_waitcnt lgkmcnt(5)
v_add_f32 v224, v224, v232
v_mfma_f32_16x16x32_bf16 a[32:35], v[0:3], v[216:219], a[32:35]
ds_read_b64_tr_b16 v[214:215], v12 offset:6144
v_add_f32 v225, v225, v234
v_add_f32 v226, v226, v236
v_mfma_f32_16x16x32_bf16 a[36:39], v[32:35], v[216:219], a[36:39]
v_add_f32 v227, v227, v238
v_mov_b32 v232, v224
v_mov_b32 v234, v225
v_mfma_f32_16x16x32_bf16 a[40:43], v[64:67], v[216:219], a[40:43]
v_mov_b32 v236, v226
v_mov_b32 v238, v227
v_permlane16_swap_b32 v224, v232
v_mfma_f32_16x16x32_bf16 a[44:47], v[96:99], v[216:219], a[44:47]
ds_read_b64_tr_b16 v[216:217], v12 offset:20480
s_waitcnt lgkmcnt(5)
v_permlane16_swap_b32 v225, v234
v_mfma_f32_16x16x32_bf16 a[48:51], v[0:3], v[220:223], a[48:51]
ds_read_b64_tr_b16 v[218:219], v12 offset:22528
v_permlane16_swap_b32 v226, v236
v_permlane16_swap_b32 v227, v238
v_mfma_f32_16x16x32_bf16 a[52:55], v[32:35], v[220:223], a[52:55]
v_add_f32 v233, v224, v232
v_add_f32 v235, v225, v234
v_add_f32 v237, v226, v236
v_mfma_f32_16x16x32_bf16 a[56:59], v[64:67], v[220:223], a[56:59]
v_add_f32 v239, v227, v238
v_sub_f32 v232, 0, v192
v_sub_f32 v234, 0, v196
v_mfma_f32_16x16x32_bf16 a[60:63], v[96:99], v[220:223], a[60:63]
ds_read_b64_tr_b16 v[220:221], v14 offset:4096
s_waitcnt lgkmcnt(3)
v_sub_f32 v236, 0, v200
v_mfma_f32_16x16x32_bf16 a[64:67], v[8:11], v[208:211], a[64:67]
ds_read_b64_tr_b16 v[222:223], v14 offset:6144
v_sub_f32 v238, 0, v204
v_mfma_f32_16x16x32_bf16 a[64:67], v[160:163], v[212:215], a[64:67]
s_mov_b32 exec_hi, 0
buffer_store_dwordx2 v[232:233], v242, s[24:27], s48 offen sc1
s_lshr_b32 s3, s41, 2
buffer_store_dwordx2 v[234:235], v242, s[24:27], s3 offen sc1
s_lshr_b32 s3, s42, 2
buffer_store_dwordx2 v[236:237], v242, s[24:27], s3 offen sc1
s_lshr_b32 s3, s43, 2
buffer_store_dwordx2 v[238:239], v242, s[24:27], s3 offen sc1
s_mov_b32 exec_hi, -1
v_mfma_f32_16x16x32_bf16 a[68:71], v[40:43], v[208:211], a[68:71]
v_accvgpr_read_b32 v128, a0
v_accvgpr_read_b32 v129, a1
v_accvgpr_read_b32 v130, a2
v_mfma_f32_16x16x32_bf16 a[68:71], v[164:167], v[212:215], a[68:71]
v_accvgpr_read_b32 v131, a3
v_cvt_pk_bf16_f32 v16, v128, v129
v_cvt_pk_bf16_f32 v17, v130, v131
v_mfma_f32_16x16x32_bf16 a[72:75], v[72:75], v[208:211], a[72:75]
v_accvgpr_read_b32 v136, a4
v_accvgpr_read_b32 v137, a5
v_accvgpr_read_b32 v138, a6
v_mfma_f32_16x16x32_bf16 a[72:75], v[168:171], v[212:215], a[72:75]
v_accvgpr_read_b32 v139, a7
v_cvt_pk_bf16_f32 v48, v136, v137
v_cvt_pk_bf16_f32 v49, v138, v139
v_mfma_f32_16x16x32_bf16 a[76:79], v[104:107], v[208:211], a[76:79]
ds_read_b64_tr_b16 v[208:209], v247 offset:20480
ds_read_b64_tr_b16 v[210:211], v247 offset:22528
v_accvgpr_read_b32 v144, a8
v_mfma_f32_16x16x32_bf16 a[76:79], v[172:175], v[212:215], a[76:79]
ds_read_b64_tr_b16 v[212:213], v13 offset:4096
s_waitcnt lgkmcnt(3)
v_accvgpr_read_b32 v145, a9
v_mfma_f32_16x16x32_bf16 a[64:67], v[176:179], v[216:219], a[64:67]
ds_read_b64_tr_b16 v[214:215], v13 offset:6144
v_accvgpr_read_b32 v146, a10
v_accvgpr_read_b32 v147, a11
v_mfma_f32_16x16x32_bf16 a[64:67], v[0:3], v[220:223], a[64:67]
v_cvt_pk_bf16_f32 v80, v144, v145
v_cvt_pk_bf16_f32 v81, v146, v147
v_accvgpr_read_b32 v152, a12
v_mfma_f32_16x16x32_bf16 a[68:71], v[180:183], v[216:219], a[68:71]
v_accvgpr_read_b32 v153, a13
v_accvgpr_read_b32 v154, a14
v_accvgpr_read_b32 v155, a15
v_mfma_f32_16x16x32_bf16 a[68:71], v[32:35], v[220:223], a[68:71]
v_cvt_pk_bf16_f32 v112, v152, v153
v_cvt_pk_bf16_f32 v113, v154, v155
v_accvgpr_read_b32 v132, a16
v_mfma_f32_16x16x32_bf16 a[72:75], v[184:187], v[216:219], a[72:75]
v_accvgpr_read_b32 v133, a17
v_accvgpr_read_b32 v134, a18
v_accvgpr_read_b32 v135, a19
v_mfma_f32_16x16x32_bf16 a[72:75], v[64:67], v[220:223], a[72:75]
v_cvt_pk_bf16_f32 v18, v132, v133
v_cvt_pk_bf16_f32 v19, v134, v135
buffer_store_dwordx4 v[16:19], v243, s[20:23], s40 offen offset:0 sc1
v_mfma_f32_16x16x32_bf16 a[76:79], v[188:191], v[216:219], a[76:79]
ds_read_b64_tr_b16 v[216:217], v13 offset:20480
ds_read_b64_tr_b16 v[218:219], v13 offset:22528
ds_write_b128 v231, v[16:19] offset:0
v_mfma_f32_16x16x32_bf16 a[76:79], v[96:99], v[220:223], a[76:79]
ds_read_b64_tr_b16 v[220:221], v15 offset:4096
s_waitcnt lgkmcnt(3)
v_accvgpr_read_b32 v140, a20
v_mfma_f32_16x16x32_bf16 a[80:83], v[8:11], v[208:211], a[80:83]
ds_read_b64_tr_b16 v[222:223], v15 offset:6144
v_accvgpr_read_b32 v141, a21
v_accvgpr_read_b32 v142, a22
v_mfma_f32_16x16x32_bf16 a[80:83], v[160:163], v[212:215], a[80:83]
v_accvgpr_read_b32 v143, a23
v_cvt_pk_bf16_f32 v50, v140, v141
v_cvt_pk_bf16_f32 v51, v142, v143
v_mfma_f32_16x16x32_bf16 a[84:87], v[40:43], v[208:211], a[84:87]
buffer_store_dwordx4 v[48:51], v243, s[20:23], s41 offen offset:0 sc1
v_accvgpr_read_b32 v148, a24
v_accvgpr_read_b32 v149, a25
v_mfma_f32_16x16x32_bf16 a[84:87], v[164:167], v[212:215], a[84:87]
v_accvgpr_read_b32 v150, a26
v_accvgpr_read_b32 v151, a27
v_cvt_pk_bf16_f32 v82, v148, v149
v_mfma_f32_16x16x32_bf16 a[88:91], v[72:75], v[208:211], a[88:91]
v_cvt_pk_bf16_f32 v83, v150, v151
buffer_store_dwordx4 v[80:83], v243, s[20:23], s42 offen offset:0 sc1
v_accvgpr_read_b32 v156, a28
v_mfma_f32_16x16x32_bf16 a[88:91], v[168:171], v[212:215], a[88:91]
v_accvgpr_read_b32 v157, a29
v_accvgpr_read_b32 v158, a30
v_accvgpr_read_b32 v159, a31
v_mfma_f32_16x16x32_bf16 a[92:95], v[104:107], v[208:211], a[92:95]
ds_read_b64_tr_b16 v[208:209], v246 offset:20992
ds_read_b64_tr_b16 v[210:211], v246 offset:23040
v_cvt_pk_bf16_f32 v114, v156, v157
v_mfma_f32_16x16x32_bf16 a[92:95], v[172:175], v[212:215], a[92:95]
ds_read_b64_tr_b16 v[212:213], v12 offset:4608
s_waitcnt lgkmcnt(3)
v_cvt_pk_bf16_f32 v115, v158, v159
v_mfma_f32_16x16x32_bf16 a[80:83], v[176:179], v[216:219], a[80:83]
ds_read_b64_tr_b16 v[214:215], v12 offset:6656
buffer_store_dwordx4 v[112:115], v243, s[20:23], s43 offen offset:0 sc1
v_accvgpr_read_b32 v128, a32
v_mfma_f32_16x16x32_bf16 a[80:83], v[0:3], v[220:223], a[80:83]
v_accvgpr_read_b32 v129, a33
v_accvgpr_read_b32 v130, a34
v_accvgpr_read_b32 v131, a35
v_mfma_f32_16x16x32_bf16 a[84:87], v[180:183], v[216:219], a[84:87]
v_cvt_pk_bf16_f32 v20, v128, v129
v_cvt_pk_bf16_f32 v21, v130, v131
v_accvgpr_read_b32 v136, a36
v_mfma_f32_16x16x32_bf16 a[84:87], v[32:35], v[220:223], a[84:87]
v_accvgpr_read_b32 v137, a37
v_accvgpr_read_b32 v138, a38
v_accvgpr_read_b32 v139, a39
v_mfma_f32_16x16x32_bf16 a[88:91], v[184:187], v[216:219], a[88:91]
v_cvt_pk_bf16_f32 v52, v136, v137
v_cvt_pk_bf16_f32 v53, v138, v139
v_accvgpr_read_b32 v144, a40
v_mfma_f32_16x16x32_bf16 a[88:91], v[64:67], v[220:223], a[88:91]
v_accvgpr_read_b32 v145, a41
v_accvgpr_read_b32 v146, a42
v_accvgpr_read_b32 v147, a43
v_mfma_f32_16x16x32_bf16 a[92:95], v[188:191], v[216:219], a[92:95]
ds_read_b64_tr_b16 v[216:217], v12 offset:20992
ds_read_b64_tr_b16 v[218:219], v12 offset:23040
v_cvt_pk_bf16_f32 v84, v144, v145
v_mfma_f32_16x16x32_bf16 a[92:95], v[96:99], v[220:223], a[92:95]
ds_read_b64_tr_b16 v[220:221], v14 offset:4608
s_waitcnt lgkmcnt(3)
v_cvt_pk_bf16_f32 v85, v146, v147
v_mfma_f32_16x16x32_bf16 a[96:99], v[8:11], v[208:211], a[96:99]
ds_read_b64_tr_b16 v[222:223], v14 offset:6656
v_accvgpr_read_b32 v152, a44
v_accvgpr_read_b32 v153, a45
v_mfma_f32_16x16x32_bf16 a[96:99], v[160:163], v[212:215], a[96:99]
v_accvgpr_read_b32 v154, a46
v_accvgpr_read_b32 v155, a47
v_cvt_pk_bf16_f32 v116, v152, v153
v_mfma_f32_16x16x32_bf16 a[100:103], v[40:43], v[208:211], a[100:103]
v_cvt_pk_bf16_f32 v117, v154, v155
v_accvgpr_read_b32 v132, a48
v_accvgpr_read_b32 v133, a49
v_mfma_f32_16x16x32_bf16 a[100:103], v[164:167], v[212:215], a[100:103]
v_accvgpr_read_b32 v134, a50
v_accvgpr_read_b32 v135, a51
v_cvt_pk_bf16_f32 v22, v132, v133
v_mfma_f32_16x16x32_bf16 a[104:107], v[72:75], v[208:211], a[104:107]
v_cvt_pk_bf16_f32 v23, v134, v135
buffer_store_dwordx4 v[20:23], v243, s[20:23], s40 offen offset:1024 sc1
ds_write_b128 v231, v[20:23] offset:1024
v_mfma_f32_16x16x32_bf16 a[104:107], v[168:171], v[212:215], a[104:107]
v_accvgpr_read_b32 v140, a52
v_accvgpr_read_b32 v141, a53
v_accvgpr_read_b32 v142, a54
v_mfma_f32_16x16x32_bf16 a[108:111], v[104:107], v[208:211], a[108:111]
ds_read_b64_tr_b16 v[208:209], v247 offset:20992
ds_read_b64_tr_b16 v[210:211], v247 offset:23040
v_accvgpr_read_b32 v143, a55
v_mfma_f32_16x16x32_bf16 a[108:111], v[172:175], v[212:215], a[108:111]
ds_read_b64_tr_b16 v[212:213], v13 offset:4608
s_waitcnt lgkmcnt(3)
v_cvt_pk_bf16_f32 v54, v140, v141
v_mfma_f32_16x16x32_bf16 a[96:99], v[176:179], v[216:219], a[96:99]
ds_read_b64_tr_b16 v[214:215], v13 offset:6656
v_cvt_pk_bf16_f32 v55, v142, v143
buffer_store_dwordx4 v[52:55], v243, s[20:23], s41 offen offset:1024 sc1
v_mfma_f32_16x16x32_bf16 a[96:99], v[0:3], v[220:223], a[96:99]
v_accvgpr_read_b32 v148, a56
v_accvgpr_read_b32 v149, a57
v_accvgpr_read_b32 v150, a58
v_mfma_f32_16x16x32_bf16 a[100:103], v[180:183], v[216:219], a[100:103]
v_accvgpr_read_b32 v151, a59
v_cvt_pk_bf16_f32 v86, v148, v149
v_cvt_pk_bf16_f32 v87, v150, v151
v_mfma_f32_16x16x32_bf16 a[100:103], v[32:35], v[220:223], a[100:103]
buffer_store_dwordx4 v[84:87], v243, s[20:23], s42 offen offset:1024 sc1
v_accvgpr_read_b32 v156, a60
v_accvgpr_read_b32 v157, a61
v_mfma_f32_16x16x32_bf16 a[104:107], v[184:187], v[216:219], a[104:107]
v_accvgpr_read_b32 v158, a62
v_accvgpr_read_b32 v159, a63
v_cvt_pk_bf16_f32 v118, v156, v157
v_mfma_f32_16x16x32_bf16 a[104:107], v[64:67], v[220:223], a[104:107]
v_cvt_pk_bf16_f32 v119, v158, v159
buffer_store_dwordx4 v[116:119], v243, s[20:23], s43 offen offset:1024 sc1
v_accvgpr_read_b32 v128, a64
v_mfma_f32_16x16x32_bf16 a[108:111], v[188:191], v[216:219], a[108:111]
ds_read_b64_tr_b16 v[216:217], v13 offset:20992
ds_read_b64_tr_b16 v[218:219], v13 offset:23040
v_accvgpr_read_b32 v129, a65
v_mfma_f32_16x16x32_bf16 a[108:111], v[96:99], v[220:223], a[108:111]
ds_read_b64_tr_b16 v[220:221], v15 offset:4608
s_waitcnt lgkmcnt(3)
v_accvgpr_read_b32 v130, a66
v_mfma_f32_16x16x32_bf16 a[112:115], v[8:11], v[208:211], a[112:115]
ds_read_b64_tr_b16 v[222:223], v15 offset:6656
v_accvgpr_read_b32 v131, a67
v_cvt_pk_bf16_f32 v24, v128, v129
v_mfma_f32_16x16x32_bf16 a[112:115], v[160:163], v[212:215], a[112:115]
v_cvt_pk_bf16_f32 v25, v130, v131
v_accvgpr_read_b32 v136, a68
v_accvgpr_read_b32 v137, a69
v_mfma_f32_16x16x32_bf16 a[116:119], v[40:43], v[208:211], a[116:119]
v_accvgpr_read_b32 v138, a70
v_accvgpr_read_b32 v139, a71
v_cvt_pk_bf16_f32 v56, v136, v137
v_mfma_f32_16x16x32_bf16 a[116:119], v[164:167], v[212:215], a[116:119]
v_cvt_pk_bf16_f32 v57, v138, v139
v_accvgpr_read_b32 v144, a72
v_accvgpr_read_b32 v145, a73
v_mfma_f32_16x16x32_bf16 a[120:123], v[72:75], v[208:211], a[120:123]
v_accvgpr_read_b32 v146, a74
v_accvgpr_read_b32 v147, a75
v_cvt_pk_bf16_f32 v88, v144, v145
v_mfma_f32_16x16x32_bf16 a[120:123], v[168:171], v[212:215], a[120:123]
v_cvt_pk_bf16_f32 v89, v146, v147
v_accvgpr_read_b32 v152, a76
v_accvgpr_read_b32 v153, a77
v_mfma_f32_16x16x32_bf16 a[124:127], v[104:107], v[208:211], a[124:127]
ds_read_b64_tr_b16 v[208:209], v246 offset:8192
ds_read_b64_tr_b16 v[210:211], v246 offset:10240
v_accvgpr_read_b32 v154, a78
v_mfma_f32_16x16x32_bf16 a[124:127], v[172:175], v[212:215], a[124:127]
ds_read_b64_tr_b16 v[212:213], v246 offset:24576
s_waitcnt lgkmcnt(3)
v_accvgpr_read_b32 v155, a79
v_mfma_f32_16x16x32_bf16 a[112:115], v[176:179], v[216:219], a[112:115]
ds_read_b64_tr_b16 v[214:215], v246 offset:26624
v_cvt_pk_bf16_f32 v120, v152, v153
v_cvt_pk_bf16_f32 v121, v154, v155
v_mfma_f32_16x16x32_bf16 a[112:115], v[0:3], v[220:223], a[112:115]
v_accvgpr_read_b32 v132, a80
v_accvgpr_read_b32 v133, a81
v_accvgpr_read_b32 v134, a82
v_mfma_f32_16x16x32_bf16 a[116:119], v[180:183], v[216:219], a[116:119]
v_accvgpr_read_b32 v135, a83
v_cvt_pk_bf16_f32 v26, v132, v133
v_cvt_pk_bf16_f32 v27, v134, v135
v_mfma_f32_16x16x32_bf16 a[116:119], v[32:35], v[220:223], a[116:119]
buffer_store_dwordx4 v[24:27], v243, s[20:23], s40 offen offset:2048 sc1
ds_write_b128 v231, v[24:27] offset:2048
v_accvgpr_read_b32 v140, a84
v_mfma_f32_16x16x32_bf16 a[120:123], v[184:187], v[216:219], a[120:123]
v_accvgpr_read_b32 v141, a85
v_accvgpr_read_b32 v142, a86
v_accvgpr_read_b32 v143, a87
v_mfma_f32_16x16x32_bf16 a[120:123], v[64:67], v[220:223], a[120:123]
v_cvt_pk_bf16_f32 v58, v140, v141
v_cvt_pk_bf16_f32 v59, v142, v143
buffer_store_dwordx4 v[56:59], v243, s[20:23], s41 offen offset:2048 sc1
v_mfma_f32_16x16x32_bf16 a[124:127], v[188:191], v[216:219], a[124:127]
ds_read_b64_tr_b16 v[216:217], v12 offset:8192
ds_read_b64_tr_b16 v[218:219], v12 offset:10240
v_accvgpr_read_b32 v148, a88
v_mfma_f32_16x16x32_bf16 a[124:127], v[96:99], v[220:223], a[124:127]
ds_read_b64_tr_b16 v[220:221], v12 offset:24576
s_waitcnt lgkmcnt(3)
v_accvgpr_read_b32 v149, a89
v_mfma_f32_16x16x32_bf16 a[128:131], v[4:7], v[208:211], a[128:131]
ds_read_b64_tr_b16 v[222:223], v12 offset:26624
v_accvgpr_read_b32 v150, a90
v_accvgpr_read_b32 v151, a91
v_mfma_f32_16x16x32_bf16 a[128:131], v[8:11], v[212:215], a[128:131]
v_cvt_pk_bf16_f32 v90, v148, v149
v_cvt_pk_bf16_f32 v91, v150, v151
buffer_store_dwordx4 v[88:91], v243, s[20:23], s42 offen offset:2048 sc1
v_mfma_f32_16x16x32_bf16 a[132:135], v[36:39], v[208:211], a[132:135]
v_accvgpr_read_b32 v156, a92
v_accvgpr_read_b32 v157, a93
v_accvgpr_read_b32 v158, a94
v_mfma_f32_16x16x32_bf16 a[132:135], v[40:43], v[212:215], a[132:135]
v_accvgpr_read_b32 v159, a95
v_cvt_pk_bf16_f32 v122, v156, v157
v_cvt_pk_bf16_f32 v123, v158, v159
v_mfma_f32_16x16x32_bf16 a[136:139], v[68:71], v[208:211], a[136:139]
buffer_store_dwordx4 v[120:123], v243, s[20:23], s43 offen offset:2048 sc1
v_accvgpr_read_b32 v128, a96
v_mfma_f32_16x16x32_bf16 a[136:139], v[72:75], v[212:215], a[136:139]
v_accvgpr_read_b32 v129, a97
v_accvgpr_read_b32 v130, a98
v_mfma_f32_16x16x32_bf16 a[140:143], v[100:103], v[208:211], a[140:143]
ds_read_b64_tr_b16 v[208:209], v14 offset:8192
ds_read_b64_tr_b16 v[210:211], v14 offset:10240
v_mfma_f32_16x16x32_bf16 a[140:143], v[104:107], v[212:215], a[140:143]
ds_read_b64_tr_b16 v[212:213], v247 offset:8192
s_waitcnt lgkmcnt(3)
v_mfma_f32_16x16x32_bf16 a[128:131], v[160:163], v[216:219], a[128:131]
ds_read_b64_tr_b16 v[214:215], v247 offset:10240
v_accvgpr_read_b32 v131, a99
v_mfma_f32_16x16x32_bf16 a[128:131], v[176:179], v[220:223], a[128:131]
v_cvt_pk_bf16_f32 v28, v128, v129
v_cvt_pk_bf16_f32 v29, v130, v131
v_mfma_f32_16x16x32_bf16 a[132:135], v[164:167], v[216:219], a[132:135]
v_accvgpr_read_b32 v136, a100
v_accvgpr_read_b32 v137, a101
v_mfma_f32_16x16x32_bf16 a[132:135], v[180:183], v[220:223], a[132:135]
v_accvgpr_read_b32 v138, a102
v_accvgpr_read_b32 v139, a103
v_mfma_f32_16x16x32_bf16 a[136:139], v[168:171], v[216:219], a[136:139]
v_cvt_pk_bf16_f32 v60, v136, v137
v_cvt_pk_bf16_f32 v61, v138, v139
v_mfma_f32_16x16x32_bf16 a[136:139], v[184:187], v[220:223], a[136:139]
v_accvgpr_read_b32 v144, a104
v_accvgpr_read_b32 v145, a105
v_mfma_f32_16x16x32_bf16 a[140:143], v[172:175], v[216:219], a[140:143]
ds_read_b64_tr_b16 v[216:217], v247 offset:24576
ds_read_b64_tr_b16 v[218:219], v247 offset:26624
v_mfma_f32_16x16x32_bf16 a[140:143], v[188:191], v[220:223], a[140:143]
ds_read_b64_tr_b16 v[220:221], v13 offset:8192
s_waitcnt lgkmcnt(5)
v_mfma_f32_16x16x32_bf16 a[128:131], v[0:3], v[208:211], a[128:131]
ds_read_b64_tr_b16 v[222:223], v13 offset:10240
v_accvgpr_read_b32 v146, a106
v_mfma_f32_16x16x32_bf16 a[132:135], v[32:35], v[208:211], a[132:135]
v_accvgpr_read_b32 v147, a107
v_cvt_pk_bf16_f32 v92, v144, v145
v_mfma_f32_16x16x32_bf16 a[136:139], v[64:67], v[208:211], a[136:139]
v_cvt_pk_bf16_f32 v93, v146, v147
v_accvgpr_read_b32 v152, a108
v_mfma_f32_16x16x32_bf16 a[140:143], v[96:99], v[208:211], a[140:143]
ds_read_b64_tr_b16 v[208:209], v13 offset:24576
s_waitcnt lgkmcnt(5)
v_mfma_f32_16x16x32_bf16 a[144:147], v[4:7], v[212:215], a[144:147]
ds_read_b64_tr_b16 v[210:211], v13 offset:26624
v_accvgpr_read_b32 v153, a109
v_mfma_f32_16x16x32_bf16 a[148:151], v[36:39], v[212:215], a[148:151]
v_accvgpr_read_b32 v154, a110
v_accvgpr_read_b32 v155, a111
v_mfma_f32_16x16x32_bf16 a[152:155], v[68:71], v[212:215], a[152:155]
v_cvt_pk_bf16_f32 v124, v152, v153
v_cvt_pk_bf16_f32 v125, v154, v155
v_mfma_f32_16x16x32_bf16 a[156:159], v[100:103], v[212:215], a[156:159]
ds_read_b64_tr_b16 v[212:213], v15 offset:8192
s_waitcnt lgkmcnt(3)
v_mfma_f32_16x16x32_bf16 a[144:147], v[8:11], v[216:219], a[144:147]
ds_read_b64_tr_b16 v[214:215], v15 offset:10240
v_accvgpr_read_b32 v132, a112
v_mfma_f32_16x16x32_bf16 a[144:147], v[160:163], v[220:223], a[144:147]
v_accvgpr_read_b32 v133, a113
v_accvgpr_read_b32 v134, a114
v_mfma_f32_16x16x32_bf16 a[148:151], v[40:43], v[216:219], a[148:151]
v_accvgpr_read_b32 v135, a115
v_cvt_pk_bf16_f32 v30, v132, v133
v_mfma_f32_16x16x32_bf16 a[148:151], v[164:167], v[220:223], a[148:151]
v_cvt_pk_bf16_f32 v31, v134, v135
buffer_store_dwordx4 v[28:31], v243, s[20:23], s40 offen offset:3072 sc1
v_mfma_f32_16x16x32_bf16 a[152:155], v[72:75], v[216:219], a[152:155]
ds_write_b128 v231, v[28:31] offset:3072
v_accvgpr_read_b32 v140, a116
v_mfma_f32_16x16x32_bf16 a[152:155], v[168:171], v[220:223], a[152:155]
v_accvgpr_read_b32 v141, a117
v_accvgpr_read_b32 v142, a118
v_mfma_f32_16x16x32_bf16 a[156:159], v[104:107], v[216:219], a[156:159]
ds_read_b64_tr_b16 v[216:217], v246 offset:8704
ds_read_b64_tr_b16 v[218:219], v246 offset:10752
v_mfma_f32_16x16x32_bf16 a[156:159], v[172:175], v[220:223], a[156:159]
ds_read_b64_tr_b16 v[220:221], v246 offset:25088
s_waitcnt lgkmcnt(3)
v_mfma_f32_16x16x32_bf16 a[144:147], v[176:179], v[208:211], a[144:147]
ds_read_b64_tr_b16 v[222:223], v246 offset:27136
v_accvgpr_read_b32 v143, a119
v_mfma_f32_16x16x32_bf16 a[144:147], v[0:3], v[212:215], a[144:147]
v_cvt_pk_bf16_f32 v62, v140, v141
v_cvt_pk_bf16_f32 v63, v142, v143
v_mfma_f32_16x16x32_bf16 a[148:151], v[180:183], v[208:211], a[148:151]
buffer_store_dwordx4 v[60:63], v243, s[20:23], s41 offen offset:3072 sc1
v_accvgpr_read_b32 v148, a120
v_mfma_f32_16x16x32_bf16 a[148:151], v[32:35], v[212:215], a[148:151]
v_accvgpr_read_b32 v149, a121
v_accvgpr_read_b32 v150, a122
v_mfma_f32_16x16x32_bf16 a[152:155], v[184:187], v[208:211], a[152:155]
v_accvgpr_read_b32 v151, a123
v_cvt_pk_bf16_f32 v94, v148, v149
v_mfma_f32_16x16x32_bf16 a[152:155], v[64:67], v[212:215], a[152:155]
v_cvt_pk_bf16_f32 v95, v150, v151
buffer_store_dwordx4 v[92:95], v243, s[20:23], s42 offen offset:3072 sc1
v_mfma_f32_16x16x32_bf16 a[156:159], v[188:191], v[208:211], a[156:159]
ds_read_b64_tr_b16 v[208:209], v12 offset:8704
ds_read_b64_tr_b16 v[210:211], v12 offset:10752
v_mfma_f32_16x16x32_bf16 a[156:159], v[96:99], v[212:215], a[156:159]
ds_read_b64_tr_b16 v[212:213], v12 offset:25088
s_waitcnt lgkmcnt(3)
v_mfma_f32_16x16x32_bf16 a[160:163], v[4:7], v[216:219], a[160:163]
ds_read_b64_tr_b16 v[214:215], v12 offset:27136
v_accvgpr_read_b32 v156, a124
v_mfma_f32_16x16x32_bf16 a[160:163], v[8:11], v[220:223], a[160:163]
v_accvgpr_read_b32 v157, a125
v_accvgpr_read_b32 v158, a126
v_mfma_f32_16x16x32_bf16 a[164:167], v[36:39], v[216:219], a[164:167]
v_accvgpr_read_b32 v159, a127
v_cvt_pk_bf16_f32 v126, v156, v157
v_mfma_f32_16x16x32_bf16 a[164:167], v[40:43], v[220:223], a[164:167]
v_cvt_pk_bf16_f32 v127, v158, v159
buffer_store_dwordx4 v[124:127], v243, s[20:23], s43 offen offset:3072 sc1
v_mfma_f32_16x16x32_bf16 a[168:171], v[68:71], v[216:219], a[168:171]
v_accvgpr_read_b32 v128, a128
v_accvgpr_read_b32 v129, a129
v_mfma_f32_16x16x32_bf16 a[168:171], v[72:75], v[220:223], a[168:171]
v_accvgpr_read_b32 v130, a130
v_accvgpr_read_b32 v131, a131
v_mfma_f32_16x16x32_bf16 a[172:175], v[100:103], v[216:219], a[172:175]
ds_read_b64_tr_b16 v[216:217], v14 offset:8704
ds_read_b64_tr_b16 v[218:219], v14 offset:10752
v_mfma_f32_16x16x32_bf16 a[172:175], v[104:107], v[220:223], a[172:175]
ds_read_b64_tr_b16 v[220:221], v247 offset:8704
s_waitcnt lgkmcnt(3)
v_mfma_f32_16x16x32_bf16 a[160:163], v[160:163], v[208:211], a[160:163]
ds_read_b64_tr_b16 v[222:223], v247 offset:10752
v_cvt_pk_bf16_f32 v16, v128, v129
v_mfma_f32_16x16x32_bf16 a[160:163], v[176:179], v[212:215], a[160:163]
v_cvt_pk_bf16_f32 v17, v130, v131
v_accvgpr_read_b32 v136, a132
v_mfma_f32_16x16x32_bf16 a[164:167], v[164:167], v[208:211], a[164:167]
v_accvgpr_read_b32 v137, a133
v_accvgpr_read_b32 v138, a134
v_mfma_f32_16x16x32_bf16 a[164:167], v[180:183], v[212:215], a[164:167]
v_accvgpr_read_b32 v139, a135
v_cvt_pk_bf16_f32 v48, v136, v137
v_mfma_f32_16x16x32_bf16 a[168:171], v[168:171], v[208:211], a[168:171]
v_cvt_pk_bf16_f32 v49, v138, v139
v_accvgpr_read_b32 v144, a136
v_mfma_f32_16x16x32_bf16 a[168:171], v[184:187], v[212:215], a[168:171]
v_accvgpr_read_b32 v145, a137
v_accvgpr_read_b32 v146, a138
v_mfma_f32_16x16x32_bf16 a[172:175], v[172:175], v[208:211], a[172:175]
ds_read_b64_tr_b16 v[208:209], v247 offset:25088
ds_read_b64_tr_b16 v[210:211], v247 offset:27136
v_mfma_f32_16x16x32_bf16 a[172:175], v[188:191], v[212:215], a[172:175]
ds_read_b64_tr_b16 v[212:213], v13 offset:8704
s_waitcnt lgkmcnt(5)
v_mfma_f32_16x16x32_bf16 a[160:163], v[0:3], v[216:219], a[160:163]
ds_read_b64_tr_b16 v[214:215], v13 offset:10752
v_accvgpr_read_b32 v147, a139
v_mfma_f32_16x16x32_bf16 a[164:167], v[32:35], v[216:219], a[164:167]
v_cvt_pk_bf16_f32 v80, v144, v145
v_cvt_pk_bf16_f32 v81, v146, v147
v_mfma_f32_16x16x32_bf16 a[168:171], v[64:67], v[216:219], a[168:171]
v_accvgpr_read_b32 v152, a140
v_accvgpr_read_b32 v153, a141
v_mfma_f32_16x16x32_bf16 a[172:175], v[96:99], v[216:219], a[172:175]
ds_read_b64_tr_b16 v[216:217], v13 offset:25088
s_waitcnt lgkmcnt(5)
v_mfma_f32_16x16x32_bf16 a[176:179], v[4:7], v[220:223], a[176:179]
ds_read_b64_tr_b16 v[218:219], v13 offset:27136
v_accvgpr_read_b32 v154, a142
v_mfma_f32_16x16x32_bf16 a[180:183], v[36:39], v[220:223], a[180:183]
v_accvgpr_read_b32 v155, a143
v_cvt_pk_bf16_f32 v112, v152, v153
v_mfma_f32_16x16x32_bf16 a[184:187], v[68:71], v[220:223], a[184:187]
v_cvt_pk_bf16_f32 v113, v154, v155
v_accvgpr_read_b32 v132, a144
v_mfma_f32_16x16x32_bf16 a[188:191], v[100:103], v[220:223], a[188:191]
ds_read_b64_tr_b16 v[220:221], v15 offset:8704
s_waitcnt lgkmcnt(3)
v_mfma_f32_16x16x32_bf16 a[176:179], v[8:11], v[208:211], a[176:179]
ds_read_b64_tr_b16 v[222:223], v15 offset:10752
v_accvgpr_read_b32 v133, a145
v_mfma_f32_16x16x32_bf16 a[176:179], v[160:163], v[212:215], a[176:179]
v_accvgpr_read_b32 v134, a146
v_accvgpr_read_b32 v135, a147
v_mfma_f32_16x16x32_bf16 a[180:183], v[40:43], v[208:211], a[180:183]
v_cvt_pk_bf16_f32 v18, v132, v133
v_cvt_pk_bf16_f32 v19, v134, v135
v_mfma_f32_16x16x32_bf16 a[180:183], v[164:167], v[212:215], a[180:183]
buffer_store_dwordx4 v[16:19], v243, s[20:23], s44 offen offset:0 sc1
ds_write_b128 v231, v[16:19] offset:4096
v_mfma_f32_16x16x32_bf16 a[184:187], v[72:75], v[208:211], a[184:187]
v_accvgpr_read_b32 v140, a148
v_accvgpr_read_b32 v141, a149
v_mfma_f32_16x16x32_bf16 a[184:187], v[168:171], v[212:215], a[184:187]
v_accvgpr_read_b32 v142, a150
v_accvgpr_read_b32 v143, a151
v_mfma_f32_16x16x32_bf16 a[188:191], v[104:107], v[208:211], a[188:191]
ds_read_b64_tr_b16 v[208:209], v246 offset:12288
ds_read_b64_tr_b16 v[210:211], v246 offset:14336
v_mfma_f32_16x16x32_bf16 a[188:191], v[172:175], v[212:215], a[188:191]
ds_read_b64_tr_b16 v[212:213], v246 offset:28672
s_waitcnt lgkmcnt(3)
v_mfma_f32_16x16x32_bf16 a[176:179], v[176:179], v[216:219], a[176:179]
ds_read_b64_tr_b16 v[214:215], v246 offset:30720
v_cvt_pk_bf16_f32 v50, v140, v141
v_mfma_f32_16x16x32_bf16 a[176:179], v[0:3], v[220:223], a[176:179]
v_cvt_pk_bf16_f32 v51, v142, v143
buffer_store_dwordx4 v[48:51], v243, s[20:23], s45 offen offset:0 sc1
v_mfma_f32_16x16x32_bf16 a[180:183], v[180:183], v[216:219], a[180:183]
v_accvgpr_read_b32 v148, a152
v_accvgpr_read_b32 v149, a153
v_mfma_f32_16x16x32_bf16 a[180:183], v[32:35], v[220:223], a[180:183]
v_accvgpr_read_b32 v150, a154
v_accvgpr_read_b32 v151, a155
v_mfma_f32_16x16x32_bf16 a[184:187], v[184:187], v[216:219], a[184:187]
v_cvt_pk_bf16_f32 v82, v148, v149
v_cvt_pk_bf16_f32 v83, v150, v151
v_mfma_f32_16x16x32_bf16 a[184:187], v[64:67], v[220:223], a[184:187]
buffer_store_dwordx4 v[80:83], v243, s[20:23], s46 offen offset:0 sc1
v_accvgpr_read_b32 v156, a156
v_mfma_f32_16x16x32_bf16 a[188:191], v[188:191], v[216:219], a[188:191]
ds_read_b64_tr_b16 v[216:217], v12 offset:12288
ds_read_b64_tr_b16 v[218:219], v12 offset:14336
v_mfma_f32_16x16x32_bf16 a[188:191], v[96:99], v[220:223], a[188:191]
ds_read_b64_tr_b16 v[220:221], v12 offset:28672
s_waitcnt lgkmcnt(3)
v_mfma_f32_16x16x32_bf16 a[192:195], v[4:7], v[208:211], a[192:195]
ds_read_b64_tr_b16 v[222:223], v12 offset:30720
v_accvgpr_read_b32 v157, a157
v_mfma_f32_16x16x32_bf16 a[192:195], v[8:11], v[212:215], a[192:195]
v_accvgpr_read_b32 v158, a158
v_accvgpr_read_b32 v159, a159
v_mfma_f32_16x16x32_bf16 a[196:199], v[36:39], v[208:211], a[196:199]
v_cvt_pk_bf16_f32 v114, v156, v157
v_cvt_pk_bf16_f32 v115, v158, v159
v_mfma_f32_16x16x32_bf16 a[196:199], v[40:43], v[212:215], a[196:199]
buffer_store_dwordx4 v[112:115], v243, s[20:23], s47 offen offset:0 sc1
v_accvgpr_read_b32 v128, a160
v_mfma_f32_16x16x32_bf16 a[200:203], v[68:71], v[208:211], a[200:203]
v_accvgpr_read_b32 v129, a161
v_accvgpr_read_b32 v130, a162
v_mfma_f32_16x16x32_bf16 a[200:203], v[72:75], v[212:215], a[200:203]
v_accvgpr_read_b32 v131, a163
v_cvt_pk_bf16_f32 v20, v128, v129
v_mfma_f32_16x16x32_bf16 a[204:207], v[100:103], v[208:211], a[204:207]
ds_read_b64_tr_b16 v[208:209], v14 offset:12288
ds_read_b64_tr_b16 v[210:211], v14 offset:14336
v_mfma_f32_16x16x32_bf16 a[204:207], v[104:107], v[212:215], a[204:207]
ds_read_b64_tr_b16 v[212:213], v247 offset:12288
s_waitcnt lgkmcnt(3)
v_mfma_f32_16x16x32_bf16 a[192:195], v[160:163], v[216:219], a[192:195]
ds_read_b64_tr_b16 v[214:215], v247 offset:14336
v_cvt_pk_bf16_f32 v21, v130, v131
v_mfma_f32_16x16x32_bf16 a[192:195], v[176:179], v[220:223], a[192:195]
v_accvgpr_read_b32 v136, a164
v_accvgpr_read_b32 v137, a165
v_mfma_f32_16x16x32_bf16 a[196:199], v[164:167], v[216:219], a[196:199]
v_accvgpr_read_b32 v138, a166
v_accvgpr_read_b32 v139, a167
v_mfma_f32_16x16x32_bf16 a[196:199], v[180:183], v[220:223], a[196:199]
v_cvt_pk_bf16_f32 v52, v136, v137
v_cvt_pk_bf16_f32 v53, v138, v139
v_mfma_f32_16x16x32_bf16 a[200:203], v[168:171], v[216:219], a[200:203]
v_accvgpr_read_b32 v144, a168
v_accvgpr_read_b32 v145, a169
v_mfma_f32_16x16x32_bf16 a[200:203], v[184:187], v[220:223], a[200:203]
v_accvgpr_read_b32 v146, a170
v_accvgpr_read_b32 v147, a171
v_mfma_f32_16x16x32_bf16 a[204:207], v[172:175], v[216:219], a[204:207]
ds_read_b64_tr_b16 v[216:217], v247 offset:28672
ds_read_b64_tr_b16 v[218:219], v247 offset:30720
v_mfma_f32_16x16x32_bf16 a[204:207], v[188:191], v[220:223], a[204:207]
ds_read_b64_tr_b16 v[220:221], v13 offset:12288
s_waitcnt lgkmcnt(5)
v_mfma_f32_16x16x32_bf16 a[192:195], v[0:3], v[208:211], a[192:195]
ds_read_b64_tr_b16 v[222:223], v13 offset:14336
v_cvt_pk_bf16_f32 v84, v144, v145
v_mfma_f32_16x16x32_bf16 a[196:199], v[32:35], v[208:211], a[196:199]
v_cvt_pk_bf16_f32 v85, v146, v147
v_accvgpr_read_b32 v152, a172
v_mfma_f32_16x16x32_bf16 a[200:203], v[64:67], v[208:211], a[200:203]
v_accvgpr_read_b32 v153, a173
v_accvgpr_read_b32 v154, a174
v_mfma_f32_16x16x32_bf16 a[204:207], v[96:99], v[208:211], a[204:207]
ds_read_b64_tr_b16 v[208:209], v13 offset:28672
s_waitcnt lgkmcnt(5)
v_mfma_f32_16x16x32_bf16 a[208:211], v[4:7], v[212:215], a[208:211]
ds_read_b64_tr_b16 v[210:211], v13 offset:30720
v_accvgpr_read_b32 v155, a175
v_mfma_f32_16x16x32_bf16 a[212:215], v[36:39], v[212:215], a[212:215]
v_cvt_pk_bf16_f32 v116, v152, v153
v_cvt_pk_bf16_f32 v117, v154, v155
v_mfma_f32_16x16x32_bf16 a[216:219], v[68:71], v[212:215], a[216:219]
v_accvgpr_read_b32 v132, a176
v_accvgpr_read_b32 v133, a177
v_mfma_f32_16x16x32_bf16 a[220:223], v[100:103], v[212:215], a[220:223]
ds_read_b64_tr_b16 v[212:213], v15 offset:12288
s_waitcnt lgkmcnt(3)
v_mfma_f32_16x16x32_bf16 a[208:211], v[8:11], v[216:219], a[208:211]
ds_read_b64_tr_b16 v[214:215], v15 offset:14336
v_accvgpr_read_b32 v134, a178
v_mfma_f32_16x16x32_bf16 a[208:211], v[160:163], v[220:223], a[208:211]
v_accvgpr_read_b32 v135, a179
v_cvt_pk_bf16_f32 v22, v132, v133
v_mfma_f32_16x16x32_bf16 a[212:215], v[40:43], v[216:219], a[212:215]
v_cvt_pk_bf16_f32 v23, v134, v135
buffer_store_dwordx4 v[20:23], v243, s[20:23], s44 offen offset:1024 sc1
v_mfma_f32_16x16x32_bf16 a[212:215], v[164:167], v[220:223], a[212:215]
ds_write_b128 v231, v[20:23] offset:5120
v_accvgpr_read_b32 v140, a180
v_mfma_f32_16x16x32_bf16 a[216:219], v[72:75], v[216:219], a[216:219]
v_accvgpr_read_b32 v141, a181
v_accvgpr_read_b32 v142, a182
v_mfma_f32_16x16x32_bf16 a[216:219], v[168:171], v[220:223], a[216:219]
v_accvgpr_read_b32 v143, a183
v_cvt_pk_bf16_f32 v54, v140, v141
v_mfma_f32_16x16x32_bf16 a[220:223], v[104:107], v[216:219], a[220:223]
ds_read_b64_tr_b16 v[216:217], v246 offset:12800
ds_read_b64_tr_b16 v[218:219], v246 offset:14848
v_mfma_f32_16x16x32_bf16 a[220:223], v[172:175], v[220:223], a[220:223]
ds_read_b64_tr_b16 v[220:221], v246 offset:29184
s_waitcnt lgkmcnt(3)
v_mfma_f32_16x16x32_bf16 a[208:211], v[176:179], v[208:211], a[208:211]
ds_read_b64_tr_b16 v[222:223], v246 offset:31232
v_cvt_pk_bf16_f32 v55, v142, v143
v_mfma_f32_16x16x32_bf16 a[208:211], v[0:3], v[212:215], a[208:211]
buffer_store_dwordx4 v[52:55], v243, s[20:23], s45 offen offset:1024 sc1
v_accvgpr_read_b32 v148, a184
v_mfma_f32_16x16x32_bf16 a[212:215], v[180:183], v[208:211], a[212:215]
v_accvgpr_read_b32 v149, a185
v_accvgpr_read_b32 v150, a186
v_mfma_f32_16x16x32_bf16 a[212:215], v[32:35], v[212:215], a[212:215]
v_accvgpr_read_b32 v151, a187
v_cvt_pk_bf16_f32 v86, v148, v149
v_mfma_f32_16x16x32_bf16 a[216:219], v[184:187], v[208:211], a[216:219]
v_cvt_pk_bf16_f32 v87, v150, v151
buffer_store_dwordx4 v[84:87], v243, s[20:23], s46 offen offset:1024 sc1
v_mfma_f32_16x16x32_bf16 a[216:219], v[64:67], v[212:215], a[216:219]
v_accvgpr_read_b32 v156, a188
v_accvgpr_read_b32 v157, a189
v_mfma_f32_16x16x32_bf16 a[220:223], v[188:191], v[208:211], a[220:223]
ds_read_b64_tr_b16 v[208:209], v12 offset:12800
ds_read_b64_tr_b16 v[210:211], v12 offset:14848
v_mfma_f32_16x16x32_bf16 a[220:223], v[96:99], v[212:215], a[220:223]
ds_read_b64_tr_b16 v[212:213], v12 offset:29184
s_waitcnt lgkmcnt(3)
v_mfma_f32_16x16x32_bf16 a[224:227], v[4:7], v[216:219], a[224:227]
ds_read_b64_tr_b16 v[214:215], v12 offset:31232
v_accvgpr_read_b32 v158, a190
v_mfma_f32_16x16x32_bf16 a[224:227], v[8:11], v[220:223], a[224:227]
v_accvgpr_read_b32 v159, a191
v_cvt_pk_bf16_f32 v118, v156, v157
v_mfma_f32_16x16x32_bf16 a[228:231], v[36:39], v[216:219], a[228:231]
v_cvt_pk_bf16_f32 v119, v158, v159
buffer_store_dwordx4 v[116:119], v243, s[20:23], s47 offen offset:1024 sc1
v_mfma_f32_16x16x32_bf16 a[228:231], v[40:43], v[220:223], a[228:231]
v_accvgpr_read_b32 v128, a192
v_accvgpr_read_b32 v129, a193
v_mfma_f32_16x16x32_bf16 a[232:235], v[68:71], v[216:219], a[232:235]
v_accvgpr_read_b32 v130, a194
v_accvgpr_read_b32 v131, a195
v_mfma_f32_16x16x32_bf16 a[232:235], v[72:75], v[220:223], a[232:235]
v_cvt_pk_bf16_f32 v24, v128, v129
v_cvt_pk_bf16_f32 v25, v130, v131
v_mfma_f32_16x16x32_bf16 a[236:239], v[100:103], v[216:219], a[236:239]
ds_read_b64_tr_b16 v[216:217], v14 offset:12800
ds_read_b64_tr_b16 v[218:219], v14 offset:14848
v_mfma_f32_16x16x32_bf16 a[236:239], v[104:107], v[220:223], a[236:239]
ds_read_b64_tr_b16 v[220:221], v247 offset:12800
s_waitcnt lgkmcnt(3)
v_mfma_f32_16x16x32_bf16 a[224:227], v[160:163], v[208:211], a[224:227]
ds_read_b64_tr_b16 v[222:223], v247 offset:14848
v_accvgpr_read_b32 v136, a196
v_mfma_f32_16x16x32_bf16 a[224:227], v[176:179], v[212:215], a[224:227]
v_accvgpr_read_b32 v137, a197
v_accvgpr_read_b32 v138, a198
v_mfma_f32_16x16x32_bf16 a[228:231], v[164:167], v[208:211], a[228:231]
v_accvgpr_read_b32 v139, a199
v_cvt_pk_bf16_f32 v56, v136, v137
v_mfma_f32_16x16x32_bf16 a[228:231], v[180:183], v[212:215], a[228:231]
v_cvt_pk_bf16_f32 v57, v138, v139
v_accvgpr_read_b32 v144, a200
v_mfma_f32_16x16x32_bf16 a[232:235], v[168:171], v[208:211], a[232:235]
v_accvgpr_read_b32 v145, a201
v_accvgpr_read_b32 v146, a202
v_mfma_f32_16x16x32_bf16 a[232:235], v[184:187], v[212:215], a[232:235]
v_accvgpr_read_b32 v147, a203
v_cvt_pk_bf16_f32 v88, v144, v145
v_mfma_f32_16x16x32_bf16 a[236:239], v[172:175], v[208:211], a[236:239]
ds_read_b64_tr_b16 v[208:209], v247 offset:29184
ds_read_b64_tr_b16 v[210:211], v247 offset:31232
v_mfma_f32_16x16x32_bf16 a[236:239], v[188:191], v[212:215], a[236:239]
ds_read_b64_tr_b16 v[212:213], v13 offset:12800
s_waitcnt lgkmcnt(5)
v_mfma_f32_16x16x32_bf16 a[224:227], v[0:3], v[216:219], a[224:227]
ds_read_b64_tr_b16 v[214:215], v13 offset:14848
v_cvt_pk_bf16_f32 v89, v146, v147
v_mfma_f32_16x16x32_bf16 a[228:231], v[32:35], v[216:219], a[228:231]
v_accvgpr_read_b32 v152, a204
v_accvgpr_read_b32 v153, a205
v_mfma_f32_16x16x32_bf16 a[232:235], v[64:67], v[216:219], a[232:235]
v_accvgpr_read_b32 v154, a206
v_accvgpr_read_b32 v155, a207
v_mfma_f32_16x16x32_bf16 a[236:239], v[96:99], v[216:219], a[236:239]
ds_read_b64_tr_b16 v[216:217], v13 offset:29184
s_waitcnt lgkmcnt(5)
v_mfma_f32_16x16x32_bf16 a[240:243], v[4:7], v[220:223], a[240:243]
ds_read_b64_tr_b16 v[218:219], v13 offset:31232
v_cvt_pk_bf16_f32 v120, v152, v153
v_mfma_f32_16x16x32_bf16 a[244:247], v[36:39], v[220:223], a[244:247]
v_cvt_pk_bf16_f32 v121, v154, v155
v_accvgpr_read_b32 v132, a208
v_mfma_f32_16x16x32_bf16 a[248:251], v[68:71], v[220:223], a[248:251]
v_accvgpr_read_b32 v133, a209
v_accvgpr_read_b32 v134, a210
v_mfma_f32_16x16x32_bf16 a[252:255], v[100:103], v[220:223], a[252:255]
ds_read_b64_tr_b16 v[220:221], v15 offset:12800
s_waitcnt lgkmcnt(3)
v_mfma_f32_16x16x32_bf16 a[240:243], v[8:11], v[208:211], a[240:243]
ds_read_b64_tr_b16 v[222:223], v15 offset:14848
v_accvgpr_read_b32 v135, a211
v_mfma_f32_16x16x32_bf16 a[240:243], v[160:163], v[212:215], a[240:243]
v_cvt_pk_bf16_f32 v26, v132, v133
v_cvt_pk_bf16_f32 v27, v134, v135
v_mfma_f32_16x16x32_bf16 a[244:247], v[40:43], v[208:211], a[244:247]
buffer_store_dwordx4 v[24:27], v243, s[20:23], s44 offen offset:2048 sc1
ds_write_b128 v231, v[24:27] offset:6144
v_mfma_f32_16x16x32_bf16 a[244:247], v[164:167], v[212:215], a[244:247]
v_accvgpr_read_b32 v140, a212
v_accvgpr_read_b32 v141, a213
v_mfma_f32_16x16x32_bf16 a[248:251], v[72:75], v[208:211], a[248:251]
v_accvgpr_read_b32 v142, a214
v_accvgpr_read_b32 v143, a215
v_mfma_f32_16x16x32_bf16 a[248:251], v[168:171], v[212:215], a[248:251]
v_cvt_pk_bf16_f32 v58, v140, v141
v_cvt_pk_bf16_f32 v59, v142, v143
v_mfma_f32_16x16x32_bf16 a[252:255], v[104:107], v[208:211], a[252:255]
buffer_store_dwordx4 v[56:59], v243, s[20:23], s45 offen offset:2048 sc1
v_accvgpr_read_b32 v148, a216
v_mfma_f32_16x16x32_bf16 a[252:255], v[172:175], v[212:215], a[252:255]
s_waitcnt lgkmcnt(0)
v_accvgpr_read_b32 v149, a217
v_mfma_f32_16x16x32_bf16 a[240:243], v[176:179], v[216:219], a[240:243]
v_accvgpr_read_b32 v150, a218
v_accvgpr_read_b32 v151, a219
v_mfma_f32_16x16x32_bf16 a[240:243], v[0:3], v[220:223], a[240:243]
v_cvt_pk_bf16_f32 v90, v148, v149
v_cvt_pk_bf16_f32 v91, v150, v151
v_mfma_f32_16x16x32_bf16 a[244:247], v[180:183], v[216:219], a[244:247]
buffer_store_dwordx4 v[88:91], v243, s[20:23], s46 offen offset:2048 sc1
v_accvgpr_read_b32 v156, a220
v_mfma_f32_16x16x32_bf16 a[244:247], v[32:35], v[220:223], a[244:247]
v_accvgpr_read_b32 v157, a221
v_accvgpr_read_b32 v158, a222
v_mfma_f32_16x16x32_bf16 a[248:251], v[184:187], v[216:219], a[248:251]
v_accvgpr_read_b32 v159, a223
v_cvt_pk_bf16_f32 v122, v156, v157
v_mfma_f32_16x16x32_bf16 a[248:251], v[64:67], v[220:223], a[248:251]
v_cvt_pk_bf16_f32 v123, v158, v159
buffer_store_dwordx4 v[120:123], v243, s[20:23], s47 offen offset:2048 sc1
v_mfma_f32_16x16x32_bf16 a[252:255], v[188:191], v[216:219], a[252:255]
v_accvgpr_read_b32 v128, a224
v_accvgpr_read_b32 v129, a225
v_mfma_f32_16x16x32_bf16 a[252:255], v[96:99], v[220:223], a[252:255]
v_accvgpr_read_b32 v130, a226
v_accvgpr_read_b32 v131, a227
v_cvt_pk_bf16_f32 v28, v128, v129
v_cvt_pk_bf16_f32 v29, v130, v131
v_accvgpr_read_b32 v136, a228
v_accvgpr_read_b32 v137, a229
v_accvgpr_read_b32 v138, a230
v_accvgpr_read_b32 v139, a231
v_cvt_pk_bf16_f32 v60, v136, v137
v_cvt_pk_bf16_f32 v61, v138, v139
v_accvgpr_read_b32 v144, a232
v_accvgpr_read_b32 v145, a233
v_accvgpr_read_b32 v146, a234
v_accvgpr_read_b32 v147, a235
v_cvt_pk_bf16_f32 v92, v144, v145
v_cvt_pk_bf16_f32 v93, v146, v147
v_accvgpr_read_b32 v152, a236
v_accvgpr_read_b32 v153, a237
v_accvgpr_read_b32 v154, a238
v_accvgpr_read_b32 v155, a239
v_cvt_pk_bf16_f32 v124, v152, v153
v_cvt_pk_bf16_f32 v125, v154, v155
v_accvgpr_read_b32 v132, a240
v_accvgpr_read_b32 v133, a241
v_accvgpr_read_b32 v134, a242
v_accvgpr_read_b32 v135, a243
v_cvt_pk_bf16_f32 v30, v132, v133
v_cvt_pk_bf16_f32 v31, v134, v135
buffer_store_dwordx4 v[28:31], v243, s[20:23], s44 offen offset:3072 sc1
ds_write_b128 v231, v[28:31] offset:7168
v_accvgpr_read_b32 v140, a244
v_accvgpr_read_b32 v141, a245
v_accvgpr_read_b32 v142, a246
v_accvgpr_read_b32 v143, a247
v_cvt_pk_bf16_f32 v62, v140, v141
v_cvt_pk_bf16_f32 v63, v142, v143
buffer_store_dwordx4 v[60:63], v243, s[20:23], s45 offen offset:3072 sc1
v_accvgpr_read_b32 v148, a248
v_accvgpr_read_b32 v149, a249
v_accvgpr_read_b32 v150, a250
v_accvgpr_read_b32 v151, a251
v_cvt_pk_bf16_f32 v94, v148, v149
v_cvt_pk_bf16_f32 v95, v150, v151
buffer_store_dwordx4 v[92:95], v243, s[20:23], s46 offen offset:3072 sc1
v_accvgpr_read_b32 v156, a252
v_accvgpr_read_b32 v157, a253
v_accvgpr_read_b32 v158, a254
v_accvgpr_read_b32 v159, a255
v_cvt_pk_bf16_f32 v126, v156, v157
v_cvt_pk_bf16_f32 v127, v158, v159
buffer_store_dwordx4 v[124:127], v243, s[20:23], s47 offen offset:3072 sc1
s_waitcnt vmcnt(36)
s_branch L2_F
L2_F:
v_cmp_ne_u64 vcc, s[98:99], v[108:109]
s_lshl_b32 s3, s34, 15
s_add_u32 s3, s3, 0x1000000
s_cbranch_vccnz LF_wf
LF_wf_go:
v_add_u32 v240, s3, v243
v_add_u32 v241, 0x4000, v240
s_mov_b32 s32, 0x0
s_mov_b32 s33, 0x1000
s_mov_b32 s35, 0x2000
s_mov_b32 s36, 0x3000
s_mov_b32 s38, 0x20000
s_mov_b32 s39, 0x21000
s_mov_b32 s40, 0x22000
s_mov_b32 s41, 0x23000
s_lshr_b32 s42, s6, 13
s_lshr_b32 s43, s7, 13
s_lshr_b32 s44, s29, 13
v_mov_b32 v244, s42
v_mov_b32 v232, s43
v_cmp_lt_u32 vcc, 0xff, v243
v_mov_b32 v233, s44
s_nop 0
v_cndmask_b32 v244, v244, v232, vcc
v_cmp_lt_u32 vcc, 0x1ff, v243
v_and_b32 v235, 0xf0, v243
s_nop 0
v_cndmask_b32 v244, v244, v233, vcc
v_lshlrev_b32 v244, 11, v244
v_lshl_add_u32 v244, v235, 3, v244
v_lshrrev_b32 v79, 6, v244
buffer_load_ushort v79, v79, s[52:55], 0 offen
buffer_load_dwordx4 a[0:3], v240, s[16:19], s32 offen offset:0 sc1
buffer_load_dwordx4 a[4:7], v240, s[16:19], s32 offen offset:1024 sc1
buffer_load_dwordx4 a[8:11], v241, s[16:19], s32 offen offset:0 sc1
buffer_load_dwordx4 a[12:15], v241, s[16:19], s32 offen offset:1024 sc1
buffer_load_dwordx4 a[16:19], v240, s[16:19], s32 offen offset:2048 sc1
buffer_load_dwordx4 a[20:23], v240, s[16:19], s32 offen offset:3072 sc1
buffer_load_dwordx4 a[24:27], v241, s[16:19], s32 offen offset:2048 sc1
buffer_load_dwordx4 a[28:31], v241, s[16:19], s32 offen offset:3072 sc1
buffer_load_dwordx4 a[32:35], v240, s[16:19], s33 offen offset:0 sc1
buffer_load_dwordx4 a[36:39], v240, s[16:19], s33 offen offset:1024 sc1
buffer_load_dwordx4 a[40:43], v241, s[16:19], s33 offen offset:0 sc1
buffer_load_dwordx4 a[44:47], v241, s[16:19], s33 offen offset:1024 sc1
s_lshl_b32 s3, s37, 3
v_add3_u32 v244, v244, s3, 8
s_cmp_ge_u32 s29, 0x70000000
s_cselect_b32 s44, s43, s44
v_mov_b32 v46, s42
v_mov_b32 v232, s43
v_cmp_lt_u32 vcc, 0x7f, v243
v_mov_b32 v233, s44
s_nop 0
v_cndmask_b32 v46, v46, v232, vcc
v_cmp_lt_u32 vcc, 0xff, v243
v_bfe_u32 v232, v243, 4, 3
s_nop 0
v_cndmask_b32 v46, v46, v233, vcc
v_min_u32 v232, 5, v232
v_lshrrev_b32 v46, 2, v46
v_lshl_add_u32 v46, v46, 3, v232
v_lshlrev_b32 v46, 7, v46
v_add_u32 v46, 0x7c00000, v46
s_lshl_b32 s49, s34, 10
s_add_u32 s49, s49, 0x20000
s_bfe_u32 s3, s6, 0x2000f
s_lshl_b32 s3, s3, 13
s_add_u32 s3, s3, s49
v_add_u32 v76, s3, v243
s_bfe_u32 s3, s7, 0x2000f
s_lshl_b32 s3, s3, 13
s_add_u32 s3, s3, s49
v_add_u32 v77, s3, v243
s_bfe_u32 s3, s29, 0x2000f
s_lshl_b32 s3, s3, 13
s_add_u32 s3, s3, s49
v_add_u32 v78, s3, v243
s_add_u32 s3, s37, 1
s_sub_u32 s49, s3, 6
s_cselect_b32 s3, s3, s49
s_mul_i32 s3, s3, 0x600000
s_add_u32 s42, s3, 0x2000000
s_add_u32 s3, s37, 2
s_sub_u32 s49, s3, 6
s_cselect_b32 s3, s3, s49
s_mul_i32 s3, s3, 0x600000
s_add_u32 s43, s3, 0x2000000
s_add_u32 s3, s37, 3
s_sub_u32 s49, s3, 6
s_cselect_b32 s3, s3, s49
s_mul_i32 s3, s3, 0x600000
s_add_u32 s44, s3, 0x2000000
s_add_u32 s3, s37, 4
s_sub_u32 s49, s3, 6
s_cselect_b32 s3, s3, s49
s_mul_i32 s3, s3, 0x600000
s_add_u32 s45, s3, 0x2000000
s_add_u32 s3, s37, 5
s_sub_u32 s49, s3, 6
s_cselect_b32 s3, s3, s49
s_mul_i32 s3, s3, 0x600000
s_add_u32 s46, s3, 0x2000000
s_add_u32 s3, s37, 6
s_sub_u32 s49, s3, 6
s_cselect_b32 s3, s3, s49
s_mul_i32 s3, s3, 0x600000
s_add_u32 s47, s3, 0x2000000
s_mul_i32 s3, s34, 896
v_add_u32 v47, s3, v243
v_add_u32 v43, 0x1000, v47
v_lshrrev_b32 v44, 4, v243
v_and_b32 v44, 0x30, v44
v_xor_b32 v44, v44, v243
v_and_b32 v232, 0x380, v243
v_mad_u32_u24 v44, v232, 3, v44
v_xor_b32 v45, 0x1040, v44
v_bfe_u32 v232, v243, 5, 3
v_lshrrev_b32 v234, 8, v243
v_xor_b32 v232, v232, v234
v_bfe_u32 v233, v243, 4, 3
v_lshlrev_b32 v233, 7, v233
v_lshl_or_b32 v232, v232, 4, v233
v_bfe_u32 v233, v243, 7, 1
s_lshl_b32 s49, s34, 10
s_sub_u32 s3, s28, s49
v_lshl_add_u32 v74, v233, 12, v232
v_add_u32 v72, s3, v74
s_sub_u32 s3, s30, s49
v_add_u32 v74, s3, v74
v_xor_b32 v73, 64, v72
v_xor_b32 v75, 64, v74
v_lshl_add_u32 v245, v233, 10, v232
v_add_u32 v245, s31, v245
v_xor_b32 v246, 64, v245
v_add_u32 v247, s31, v243
s_add_u32 s3, s3, 0xa000
s_and_b32 s3, s3, 0x1ffff
v_add_u32 v252, s3, v243
v_add_u32 v251, s49, v252
s_lshl_b32 s49, s34, 11
s_add_u32 s3, s3, s49
s_add_u32 s3, s3, 24576
v_lshl_add_u32 v242, v243, 1, s3
v_lshl_add_u32 v250, v235, 1, s3
v_lshrrev_b32 v232, 4, v235
v_lshlrev_b32 v234, 2, v234
v_sub_u32 v232, v232, v234
v_and_b32 v233, 1, v232
v_lshlrev_b32 v233, 4, v233
v_mov_b32 v234, 0xffff
v_lshlrev_b32 v233, v233, v234
v_lshrrev_b32 v232, 1, v232
v_cmp_eq_u32 vcc, 0, v232
s_nop 1
v_cndmask_b32 v156, 0, v233, vcc
v_cmp_eq_u32 vcc, 1, v232
s_nop 1
v_cndmask_b32 v157, 0, v233, vcc
s_mov_b32 s95, 0xffff0000
s_waitcnt vmcnt(13)
v_mov_b32 v158, s98
v_mov_b32 v159, s99
s_mov_b64 exec, 1
buffer_store_dwordx2 v[158:159], off, s[16:19], s51 sc1
s_mov_b64 exec, -1
s_waitcnt lgkmcnt(0)
s_barrier
ds_read_b128 v[208:211], v72 offset:0
ds_read_b128 v[212:215], v72 offset:8192
ds_read_b128 v[216:219], v74 offset:0
ds_read_b128 v[220:223], v73 offset:0
ds_read_b128 v[224:227], v73 offset:8192
ds_read_b128 v[104:107], v245 offset:0
ds_read_b128 v[108:111], v246 offset:0
ds_read_b128 v[152:155], v245 offset:2048
s_waitcnt vmcnt(13)
v_lshlrev_b32 v79, 16, v79
ds_write_b32 v242, v79 offset:28
ds_read_b32 v253, v250 offset:28
ds_read_b32 v254, v250 offset:540
ds_read_b32 v255, v250 offset:1052
s_waitcnt vmcnt(12)
buffer_load_dwordx4 a[48:51], v240, s[16:19], s33 offen offset:2048 sc1
s_waitcnt vmcnt(12)
buffer_load_dwordx4 a[52:55], v240, s[16:19], s33 offen offset:3072 sc1
s_waitcnt vmcnt(12)
buffer_load_dwordx4 a[56:59], v241, s[16:19], s33 offen offset:2048 sc1
s_waitcnt vmcnt(12)
s_waitcnt lgkmcnt(11)
v_mfma_f32_16x16x32_bf16 v[160:163], a[0:3], v[208:211], 0
ds_read_b128 v[228:231], v75 offset:0
buffer_load_dwordx4 a[60:63], v241, s[16:19], s33 offen offset:3072 sc1
v_mfma_f32_16x16x32_bf16 v[164:167], a[4:7], v[208:211], 0
v_mfma_f32_16x16x32_bf16 v[168:171], a[8:11], v[208:211], 0
v_mfma_f32_16x16x32_bf16 v[172:175], a[12:15], v[208:211], 0
s_waitcnt vmcnt(12)
s_waitcnt lgkmcnt(11)
v_mfma_f32_16x16x32_bf16 v[176:179], a[0:3], v[212:215], 0
ds_read_b128 v[208:211], v72 offset:1024
buffer_load_dwordx4 a[64:67], v240, s[16:19], s35 offen offset:0 sc1
v_mfma_f32_16x16x32_bf16 v[180:183], a[4:7], v[212:215], 0
v_mfma_f32_16x16x32_bf16 v[184:187], a[8:11], v[212:215], 0
v_mfma_f32_16x16x32_bf16 v[188:191], a[12:15], v[212:215], 0
s_waitcnt vmcnt(12)
s_waitcnt lgkmcnt(11)
v_mfma_f32_16x16x32_bf16 v[192:195], a[0:3], v[216:219], 0
ds_read_b128 v[212:215], v72 offset:9216
buffer_load_dwordx4 a[68:71], v240, s[16:19], s35 offen offset:1024 sc1
v_mfma_f32_16x16x32_bf16 v[196:199], a[4:7], v[216:219], 0
v_mfma_f32_16x16x32_bf16 v[200:203], a[8:11], v[216:219], 0
v_mfma_f32_16x16x32_bf16 v[204:207], a[12:15], v[216:219], 0
s_waitcnt vmcnt(12)
buffer_load_dwordx4 a[72:75], v241, s[16:19], s35 offen offset:0 sc1
s_waitcnt vmcnt(12)
s_waitcnt lgkmcnt(11)
v_mfma_f32_16x16x32_bf16 v[160:163], a[16:19], v[220:223], v[160:163]
ds_read_b128 v[216:219], v74 offset:1024
buffer_load_dwordx4 a[76:79], v241, s[16:19], s35 offen offset:1024 sc1
v_mfma_f32_16x16x32_bf16 v[164:167], a[20:23], v[220:223], v[164:167]
v_mfma_f32_16x16x32_bf16 v[168:171], a[24:27], v[220:223], v[168:171]
v_mfma_f32_16x16x32_bf16 v[172:175], a[28:31], v[220:223], v[172:175]
s_waitcnt vmcnt(12)
s_waitcnt lgkmcnt(11)
v_mfma_f32_16x16x32_bf16 v[176:179], a[16:19], v[224:227], v[176:179]
ds_read_b128 v[220:223], v73 offset:1024
buffer_load_dwordx4 a[80:83], v240, s[16:19], s35 offen offset:2048 sc1
v_mfma_f32_16x16x32_bf16 v[180:183], a[20:23], v[224:227], v[180:183]
v_mfma_f32_16x16x32_bf16 v[184:187], a[24:27], v[224:227], v[184:187]
v_mfma_f32_16x16x32_bf16 v[188:191], a[28:31], v[224:227], v[188:191]
s_waitcnt vmcnt(12)
s_waitcnt lgkmcnt(4)
v_mfma_f32_16x16x32_bf16 v[192:195], a[16:19], v[228:231], v[192:195]
ds_read_b128 v[224:227], v73 offset:9216
buffer_load_dwordx4 a[84:87], v240, s[16:19], s35 offen offset:3072 sc1
v_mfma_f32_16x16x32_bf16 v[196:199], a[20:23], v[228:231], v[196:199]
v_mfma_f32_16x16x32_bf16 v[200:203], a[24:27], v[228:231], v[200:203]
v_mfma_f32_16x16x32_bf16 v[204:207], a[28:31], v[228:231], v[204:207]
s_waitcnt vmcnt(12)
buffer_load_dwordx4 a[88:91], v241, s[16:19], s35 offen offset:2048 sc1
s_waitcnt vmcnt(12)
s_waitcnt lgkmcnt(4)
v_mfma_f32_16x16x32_bf16 v[160:163], a[32:35], v[208:211], v[160:163]
ds_read_b128 v[228:231], v75 offset:1024
buffer_load_dwordx4 a[92:95], v241, s[16:19], s35 offen offset:3072 sc1
v_mfma_f32_16x16x32_bf16 v[164:167], a[36:39], v[208:211], v[164:167]
v_mfma_f32_16x16x32_bf16 v[168:171], a[40:43], v[208:211], v[168:171]
v_mfma_f32_16x16x32_bf16 v[172:175], a[44:47], v[208:211], v[172:175]
s_waitcnt lgkmcnt(4)
v_mfma_f32_16x16x32_bf16 v[176:179], a[32:35], v[212:215], v[176:179]
ds_read_b128 v[208:211], v72 offset:2048
v_mfma_f32_16x16x32_bf16 v[180:183], a[36:39], v[212:215], v[180:183]
v_mfma_f32_16x16x32_bf16 v[184:187], a[40:43], v[212:215], v[184:187]
v_mfma_f32_16x16x32_bf16 v[188:191], a[44:47], v[212:215], v[188:191]
s_waitcnt vmcnt(11)
s_waitcnt lgkmcnt(4)
v_mfma_f32_16x16x32_bf16 v[192:195], a[32:35], v[216:219], v[192:195]
ds_read_b128 v[212:215], v72 offset:10240
buffer_load_dwordx4 a[96:99], v240, s[16:19], s36 offen offset:0 sc1
v_mfma_f32_16x16x32_bf16 v[196:199], a[36:39], v[216:219], v[196:199]
v_mfma_f32_16x16x32_bf16 v[200:203], a[40:43], v[216:219], v[200:203]
v_mfma_f32_16x16x32_bf16 v[204:207], a[44:47], v[216:219], v[204:207]
s_waitcnt vmcnt(11)
buffer_load_dwordx4 a[100:103], v240, s[16:19], s36 offen offset:1024 sc1
s_waitcnt vmcnt(11)
buffer_load_dwordx4 a[104:107], v241, s[16:19], s36 offen offset:0 sc1
s_waitcnt vmcnt(11)
s_waitcnt lgkmcnt(4)
v_mfma_f32_16x16x32_bf16 v[160:163], a[48:51], v[220:223], v[160:163]
ds_read_b128 v[216:219], v74 offset:2048
buffer_load_dwordx4 a[108:111], v241, s[16:19], s36 offen offset:1024 sc1
v_mfma_f32_16x16x32_bf16 v[164:167], a[52:55], v[220:223], v[164:167]
v_mfma_f32_16x16x32_bf16 v[168:171], a[56:59], v[220:223], v[168:171]
v_mfma_f32_16x16x32_bf16 v[172:175], a[60:63], v[220:223], v[172:175]
s_waitcnt vmcnt(11)
s_waitcnt lgkmcnt(4)
v_mfma_f32_16x16x32_bf16 v[176:179], a[48:51], v[224:227], v[176:179]
ds_read_b128 v[220:223], v73 offset:2048
buffer_load_dwordx4 a[112:115], v240, s[16:19], s36 offen offset:2048 sc1
v_mfma_f32_16x16x32_bf16 v[180:183], a[52:55], v[224:227], v[180:183]
v_mfma_f32_16x16x32_bf16 v[184:187], a[56:59], v[224:227], v[184:187]
v_mfma_f32_16x16x32_bf16 v[188:191], a[60:63], v[224:227], v[188:191]
s_waitcnt vmcnt(11)
s_waitcnt lgkmcnt(4)
v_mfma_f32_16x16x32_bf16 v[192:195], a[48:51], v[228:231], v[192:195]
ds_read_b128 v[224:227], v73 offset:10240
buffer_load_dwordx4 a[116:119], v240, s[16:19], s36 offen offset:3072 sc1
v_mfma_f32_16x16x32_bf16 v[196:199], a[52:55], v[228:231], v[196:199]
v_mfma_f32_16x16x32_bf16 v[200:203], a[56:59], v[228:231], v[200:203]
v_mfma_f32_16x16x32_bf16 v[204:207], a[60:63], v[228:231], v[204:207]
s_waitcnt vmcnt(11)
buffer_load_dwordx4 a[120:123], v241, s[16:19], s36 offen offset:2048 sc1
s_waitcnt vmcnt(11)
s_waitcnt lgkmcnt(4)
v_mfma_f32_16x16x32_bf16 v[160:163], a[64:67], v[208:211], v[160:163]
ds_read_b128 v[228:231], v75 offset:2048
buffer_load_dwordx4 a[124:127], v241, s[16:19], s36 offen offset:3072 sc1
v_mfma_f32_16x16x32_bf16 v[164:167], a[68:71], v[208:211], v[164:167]
v_mfma_f32_16x16x32_bf16 v[168:171], a[72:75], v[208:211], v[168:171]
v_mfma_f32_16x16x32_bf16 v[172:175], a[76:79], v[208:211], v[172:175]
s_waitcnt vmcnt(11)
s_waitcnt lgkmcnt(4)
v_mfma_f32_16x16x32_bf16 v[176:179], a[64:67], v[212:215], v[176:179]
ds_read_b128 v[208:211], v72 offset:3072
buffer_load_dwordx4 a[128:131], v240, s[16:19], s38 offen offset:0 sc1
v_mfma_f32_16x16x32_bf16 v[180:183], a[68:71], v[212:215], v[180:183]
v_mfma_f32_16x16x32_bf16 v[184:187], a[72:75], v[212:215], v[184:187]
v_mfma_f32_16x16x32_bf16 v[188:191], a[76:79], v[212:215], v[188:191]
s_waitcnt vmcnt(11)
s_waitcnt lgkmcnt(4)
v_mfma_f32_16x16x32_bf16 v[192:195], a[64:67], v[216:219], v[192:195]
ds_read_b128 v[212:215], v72 offset:11264
buffer_load_dwordx4 a[132:135], v240, s[16:19], s38 offen offset:1024 sc1
v_mfma_f32_16x16x32_bf16 v[196:199], a[68:71], v[216:219], v[196:199]
v_mfma_f32_16x16x32_bf16 v[200:203], a[72:75], v[216:219], v[200:203]
v_mfma_f32_16x16x32_bf16 v[204:207], a[76:79], v[216:219], v[204:207]
s_waitcnt vmcnt(11)
buffer_load_dwordx4 a[136:139], v241, s[16:19], s38 offen offset:0 sc1
s_waitcnt vmcnt(11)
s_waitcnt lgkmcnt(4)
v_mfma_f32_16x16x32_bf16 v[160:163], a[80:83], v[220:223], v[160:163]
ds_read_b128 v[216:219], v74 offset:3072
buffer_load_dwordx4 a[140:143], v241, s[16:19], s38 offen offset:1024 sc1
v_mfma_f32_16x16x32_bf16 v[164:167], a[84:87], v[220:223], v[164:167]
v_mfma_f32_16x16x32_bf16 v[168:171], a[88:91], v[220:223], v[168:171]
v_mfma_f32_16x16x32_bf16 v[172:175], a[92:95], v[220:223], v[172:175]
s_waitcnt vmcnt(11)
s_waitcnt lgkmcnt(4)
v_mfma_f32_16x16x32_bf16 v[176:179], a[80:83], v[224:227], v[176:179]
ds_read_b128 v[220:223], v73 offset:3072
buffer_load_dwordx4 a[144:147], v240, s[16:19], s38 offen offset:2048 sc1
v_mfma_f32_16x16x32_bf16 v[180:183], a[84:87], v[224:227], v[180:183]
v_mfma_f32_16x16x32_bf16 v[184:187], a[88:91], v[224:227], v[184:187]
v_mfma_f32_16x16x32_bf16 v[188:191], a[92:95], v[224:227], v[188:191]
s_waitcnt vmcnt(11)
s_waitcnt lgkmcnt(4)
v_mfma_f32_16x16x32_bf16 v[192:195], a[80:83], v[228:231], v[192:195]
ds_read_b128 v[224:227], v73 offset:11264
buffer_load_dwordx4 a[148:151], v240, s[16:19], s38 offen offset:3072 sc1
v_mfma_f32_16x16x32_bf16 v[196:199], a[84:87], v[228:231], v[196:199]
v_mfma_f32_16x16x32_bf16 v[200:203], a[88:91], v[228:231], v[200:203]
v_mfma_f32_16x16x32_bf16 v[204:207], a[92:95], v[228:231], v[204:207]
s_waitcnt vmcnt(11)
buffer_load_dwordx4 a[152:155], v241, s[16:19], s38 offen offset:2048 sc1
s_waitcnt vmcnt(11)
s_waitcnt lgkmcnt(4)
v_mfma_f32_16x16x32_bf16 v[160:163], a[96:99], v[208:211], v[160:163]
ds_read_b128 v[228:231], v75 offset:3072
buffer_load_dwordx4 a[156:159], v241, s[16:19], s38 offen offset:3072 sc1
v_mfma_f32_16x16x32_bf16 v[164:167], a[100:103], v[208:211], v[164:167]
v_mfma_f32_16x16x32_bf16 v[168:171], a[104:107], v[208:211], v[168:171]
v_mfma_f32_16x16x32_bf16 v[172:175], a[108:111], v[208:211], v[172:175]
s_waitcnt vmcnt(11)
s_waitcnt lgkmcnt(4)
v_mfma_f32_16x16x32_bf16 v[176:179], a[96:99], v[212:215], v[176:179]
buffer_load_dwordx4 a[160:163], v240, s[16:19], s39 offen offset:0 sc1
v_mfma_f32_16x16x32_bf16 v[180:183], a[100:103], v[212:215], v[180:183]
v_mfma_f32_16x16x32_bf16 v[184:187], a[104:107], v[212:215], v[184:187]
v_mfma_f32_16x16x32_bf16 v[188:191], a[108:111], v[212:215], v[188:191]
s_waitcnt vmcnt(11)
s_waitcnt lgkmcnt(3)
v_mfma_f32_16x16x32_bf16 v[192:195], a[96:99], v[216:219], v[192:195]
buffer_load_dwordx4 a[164:167], v240, s[16:19], s39 offen offset:1024 sc1
v_mfma_f32_16x16x32_bf16 v[196:199], a[100:103], v[216:219], v[196:199]
v_mfma_f32_16x16x32_bf16 v[200:203], a[104:107], v[216:219], v[200:203]
v_mfma_f32_16x16x32_bf16 v[204:207], a[108:111], v[216:219], v[204:207]
s_waitcnt vmcnt(11)
buffer_load_dwordx4 a[168:171], v241, s[16:19], s39 offen offset:0 sc1
s_waitcnt vmcnt(11)
s_waitcnt lgkmcnt(2)
v_mfma_f32_16x16x32_bf16 v[160:163], a[112:115], v[220:223], v[160:163]
buffer_load_dwordx4 a[172:175], v241, s[16:19], s39 offen offset:1024 sc1
v_mfma_f32_16x16x32_bf16 v[164:167], a[116:119], v[220:223], v[164:167]
v_mfma_f32_16x16x32_bf16 v[168:171], a[120:123], v[220:223], v[168:171]
v_mfma_f32_16x16x32_bf16 v[172:175], a[124:127], v[220:223], v[172:175]
s_waitcnt vmcnt(11)
s_waitcnt lgkmcnt(1)
v_mfma_f32_16x16x32_bf16 v[176:179], a[112:115], v[224:227], v[176:179]
buffer_load_dwordx2 v[248:249], v46, s[16:19], 0 offen offset:0 sc1
v_mfma_f32_16x16x32_bf16 v[180:183], a[116:119], v[224:227], v[180:183]
v_lshlrev_b32 v234, 16, v104
v_and_b32 v235, s95, v104
v_mfma_f32_16x16x32_bf16 v[184:187], a[120:123], v[224:227], v[184:187]
v_fma_f32 v160, v160, v253, v234
v_fma_f32 v161, v161, v253, v235
v_mfma_f32_16x16x32_bf16 v[188:191], a[124:127], v[224:227], v[188:191]
v_lshlrev_b32 v236, 16, v105
v_and_b32 v237, s95, v105
s_waitcnt lgkmcnt(0)
v_mfma_f32_16x16x32_bf16 v[192:195], a[112:115], v[228:231], v[192:195]
v_fma_f32 v162, v162, v253, v236
v_fma_f32 v163, v163, v253, v237
v_mfma_f32_16x16x32_bf16 v[196:199], a[116:119], v[228:231], v[196:199]
v_lshlrev_b32 v238, 16, v106
v_and_b32 v239, s95, v106
v_mfma_f32_16x16x32_bf16 v[200:203], a[120:123], v[228:231], v[200:203]
v_fma_f32 v164, v164, v253, v238
v_fma_f32 v165, v165, v253, v239
v_mfma_f32_16x16x32_bf16 v[204:207], a[124:127], v[228:231], v[204:207]
v_lshlrev_b32 v232, 16, v107
v_and_b32 v233, s95, v107
v_fma_f32 v166, v166, v253, v232
v_fma_f32 v167, v167, v253, v233
ds_read_b128 v[104:107], v246 offset:2048
v_lshlrev_b32 v234, 16, v108
v_and_b32 v235, s95, v108
v_fma_f32 v168, v168, v253, v234
v_fma_f32 v169, v169, v253, v235
v_lshlrev_b32 v236, 16, v109
v_and_b32 v237, s95, v109
v_fma_f32 v170, v170, v253, v236
v_fma_f32 v171, v171, v253, v237
v_lshlrev_b32 v238, 16, v110
v_and_b32 v239, s95, v110
v_fma_f32 v172, v172, v253, v238
v_fma_f32 v173, v173, v253, v239
v_lshlrev_b32 v232, 16, v111
v_and_b32 v233, s95, v111
v_fma_f32 v174, v174, v253, v232
v_fma_f32 v175, v175, v253, v233
ds_read_b128 v[108:111], v245 offset:4096
s_waitcnt vmcnt(11)
buffer_load_dwordx4 a[176:179], v240, s[16:19], s39 offen offset:2048 sc1
v_lshlrev_b32 v234, 16, v152
v_and_b32 v235, s95, v152
v_fma_f32 v176, v176, v254, v234
v_fma_f32 v177, v177, v254, v235
v_lshlrev_b32 v236, 16, v153
v_and_b32 v237, s95, v153
v_fma_f32 v178, v178, v254, v236
v_fma_f32 v179, v179, v254, v237
v_lshlrev_b32 v238, 16, v154
v_and_b32 v239, s95, v154
v_fma_f32 v180, v180, v254, v238
v_fma_f32 v181, v181, v254, v239
v_lshlrev_b32 v232, 16, v155
v_and_b32 v233, s95, v155
v_fma_f32 v182, v182, v254, v232
v_fma_f32 v183, v183, v254, v233
ds_read_b128 v[152:155], v246 offset:4096
s_waitcnt lgkmcnt(2)
v_lshlrev_b32 v234, 16, v104
v_and_b32 v235, s95, v104
v_fma_f32 v184, v184, v254, v234
v_fma_f32 v185, v185, v254, v235
v_lshlrev_b32 v236, 16, v105
v_and_b32 v237, s95, v105
v_fma_f32 v186, v186, v254, v236
v_fma_f32 v187, v187, v254, v237
v_lshlrev_b32 v238, 16, v106
v_and_b32 v239, s95, v106
v_fma_f32 v188, v188, v254, v238
v_fma_f32 v189, v189, v254, v239
v_lshlrev_b32 v232, 16, v107
v_and_b32 v233, s95, v107
v_fma_f32 v190, v190, v254, v232
v_fma_f32 v191, v191, v254, v233
s_waitcnt vmcnt(11)
buffer_load_dwordx4 a[180:183], v240, s[16:19], s39 offen offset:3072 sc1
s_waitcnt lgkmcnt(1)
v_lshlrev_b32 v234, 16, v108
v_and_b32 v235, s95, v108
v_fma_f32 v192, v192, v255, v234
v_fma_f32 v193, v193, v255, v235
v_lshlrev_b32 v236, 16, v109
v_and_b32 v237, s95, v109
v_fma_f32 v194, v194, v255, v236
v_fma_f32 v195, v195, v255, v237
v_lshlrev_b32 v238, 16, v110
v_and_b32 v239, s95, v110
v_fma_f32 v196, v196, v255, v238
v_fma_f32 v197, v197, v255, v239
v_lshlrev_b32 v232, 16, v111
v_and_b32 v233, s95, v111
v_fma_f32 v198, v198, v255, v232
v_fma_f32 v199, v199, v255, v233
s_waitcnt lgkmcnt(0)
v_lshlrev_b32 v234, 16, v152
v_and_b32 v235, s95, v152
v_fma_f32 v200, v200, v255, v234
v_fma_f32 v201, v201, v255, v235
v_lshlrev_b32 v236, 16, v153
v_and_b32 v237, s95, v153
v_fma_f32 v202, v202, v255, v236
v_fma_f32 v203, v203, v255, v237
v_lshlrev_b32 v238, 16, v154
v_and_b32 v239, s95, v154
v_fma_f32 v204, v204, v255, v238
v_fma_f32 v205, v205, v255, v239
v_lshlrev_b32 v232, 16, v155
v_and_b32 v233, s95, v155
v_fma_f32 v206, v206, v255, v232
v_fma_f32 v207, v207, v255, v233
s_waitcnt vmcnt(11)
buffer_load_dwordx4 a[184:187], v241, s[16:19], s39 offen offset:2048 sc1
s_waitcnt vmcnt(11)
buffer_load_dwordx4 a[188:191], v241, s[16:19], s39 offen offset:3072 sc1
s_waitcnt vmcnt(11)
buffer_load_dwordx4 a[192:195], v240, s[16:19], s40 offen offset:0 sc1
s_waitcnt vmcnt(11)
buffer_load_dwordx4 a[196:199], v240, s[16:19], s40 offen offset:1024 sc1
s_waitcnt vmcnt(11)
buffer_load_dwordx4 a[200:203], v241, s[16:19], s40 offen offset:0 sc1
s_waitcnt vmcnt(11)
buffer_load_dwordx4 a[204:207], v241, s[16:19], s40 offen offset:1024 sc1
s_waitcnt vmcnt(11)
buffer_load_dwordx4 a[208:211], v240, s[16:19], s40 offen offset:2048 sc1
s_waitcnt vmcnt(11)
buffer_load_dwordx4 a[212:215], v240, s[16:19], s40 offen offset:3072 sc1
s_waitcnt vmcnt(11)
s_waitcnt vmcnt(10)
v_cmp_ne_u64 vcc, s[98:99], v[248:249]
s_nop 1
s_cbranch_vccnz LF_spinQ
LF_goQ:
buffer_load_dwordx4 v[128:131], v244, s[24:27], 0 offen offset:0 sc1
buffer_load_dwordx4 v[132:135], v244, s[24:27], 0 offen offset:16 sc1
s_waitcnt vmcnt(11)
buffer_load_dwordx4 v[136:139], v244, s[24:27], 0 offen offset:32 sc1
s_waitcnt vmcnt(11)
s_waitcnt vmcnt(10)
s_add_u32 s49, s6, s42
buffer_load_dwordx4 v[48:51], v47, s[16:19], s49 offen sc1
s_add_u32 s3, s6, s43
buffer_load_dwordx4 v[52:55], v47, s[16:19], s3 offen sc1
s_waitcnt vmcnt(11)
buffer_load_dwordx4 a[216:219], v241, s[16:19], s40 offen offset:2048 sc1
s_waitcnt vmcnt(11)
s_waitcnt vmcnt(10)
s_add_u32 s49, s6, s44
buffer_load_dwordx4 v[56:59], v47, s[16:19], s49 offen sc1
s_add_u32 s3, s6, s45
buffer_load_dwordx4 v[60:63], v47, s[16:19], s3 offen sc1
s_waitcnt vmcnt(11)
buffer_load_dwordx4 a[220:223], v241, s[16:19], s40 offen offset:3072 sc1
s_waitcnt vmcnt(11)
s_add_u32 s49, s6, s46
buffer_load_dwordx4 v[64:67], v47, s[16:19], s49 offen sc1
ds_read_b128 v[68:71], v76 offset:0
s_waitcnt vmcnt(11)
buffer_load_dwordx4 a[224:227], v240, s[16:19], s41 offen offset:0 sc1
s_waitcnt vmcnt(11)
s_waitcnt vmcnt(10)
s_add_u32 s49, s6, s42
buffer_load_dwordx4 v[80:83], v43, s[16:19], s49 offen sc1
s_add_u32 s3, s6, s43
buffer_load_dwordx4 v[84:87], v43, s[16:19], s3 offen sc1
s_waitcnt vmcnt(11)
buffer_load_dwordx4 a[228:231], v240, s[16:19], s41 offen offset:1024 sc1
s_waitcnt vmcnt(11)
v_max3_f32 v232, v128, v130, v132
v_max3_f32 v233, v134, v136, v138
v_max_f32 v232, v232, v233
v_subrev_f32 v232, 0x42fe0000, v232
v_sub_f32 v128, v128, v232
v_sub_f32 v130, v130, v232
v_sub_f32 v132, v132, v232
v_sub_f32 v134, v134, v232
v_sub_f32 v136, v136, v232
v_sub_f32 v138, v138, v232
v_cvt_u32_f32 v128, v128
v_cvt_u32_f32 v130, v130
v_cvt_u32_f32 v132, v132
v_cvt_u32_f32 v134, v134
v_cvt_u32_f32 v136, v136
v_cvt_u32_f32 v138, v138
v_lshlrev_b32 v234, 23, v128
v_lshlrev_b32 v235, 23, v130
v_lshlrev_b32 v236, 23, v132
v_lshlrev_b32 v237, 23, v134
v_lshlrev_b32 v238, 23, v136
v_lshlrev_b32 v239, 23, v138
v_mul_f32 v232, v234, v129
v_fmac_f32 v232, v235, v131
v_fmac_f32 v232, v236, v133
v_fmac_f32 v232, v237, v135
v_fmac_f32 v232, v238, v137
v_fmac_f32 v232, v239, v139
v_rcp_f32 v150, v232
v_mul_u32_u24 v144, 0x800080, v128
v_mul_u32_u24 v145, 0x800080, v130
v_mul_u32_u24 v146, 0x800080, v132
v_mul_u32_u24 v147, 0x800080, v134
v_mul_u32_u24 v148, 0x800080, v136
v_mul_u32_u24 v149, 0x800080, v138
ds_write_b128 v242, v[144:147]
ds_write_b96 v242, v[148:150] offset:16
ds_read_b128 v[144:147], v250 offset:0
ds_read_b128 v[148:151], v250 offset:16
ds_read_b128 v[128:131], v250 offset:512
ds_read_b128 v[132:135], v250 offset:528
ds_read_b128 v[136:139], v250 offset:1024
ds_read_b128 v[140:143], v250 offset:1040
s_waitcnt lgkmcnt(4)
v_and_b32 v0, v144, v156
v_and_b32 v1, v144, v157
v_and_b32 v2, v145, v156
v_and_b32 v3, v145, v157
v_and_b32 v4, v146, v156
v_and_b32 v5, v146, v157
v_and_b32 v6, v147, v156
v_and_b32 v7, v147, v157
v_and_b32 v8, v148, v156
v_and_b32 v9, v148, v157
v_and_b32 v10, v149, v156
v_and_b32 v11, v149, v157
v_mov_b32 v40, v150
s_waitcnt lgkmcnt(2)
v_and_b32 v12, v128, v156
v_and_b32 v13, v128, v157
v_and_b32 v14, v129, v156
v_and_b32 v15, v129, v157
v_and_b32 v16, v130, v156
v_and_b32 v17, v130, v157
v_and_b32 v18, v131, v156
v_and_b32 v19, v131, v157
v_and_b32 v20, v132, v156
v_and_b32 v21, v132, v157
v_and_b32 v22, v133, v156
v_and_b32 v23, v133, v157
v_mov_b32 v41, v134
s_waitcnt lgkmcnt(0)
v_and_b32 v24, v136, v156
v_and_b32 v25, v136, v157
v_and_b32 v26, v137, v156
v_and_b32 v27, v137, v157
v_and_b32 v28, v138, v156
v_and_b32 v29, v138, v157
v_and_b32 v30, v139, v156
v_and_b32 v31, v139, v157
v_and_b32 v32, v140, v156
v_and_b32 v33, v140, v157
v_and_b32 v34, v141, v156
v_and_b32 v35, v141, v157
v_mov_b32 v42, v142
s_waitcnt vmcnt(9)
v_swap_b32 v50, v52
v_swap_b32 v51, v53
s_nop 1
v_mfma_f32_16x16x32_bf16 v[136:139], v[48:51], v[0:3], 0
s_add_u32 s49, s6, s44
buffer_load_dwordx4 v[88:91], v43, s[16:19], s49 offen sc1
v_mfma_f32_16x16x32_bf16 v[140:143], v[52:55], v[0:3], 0
s_add_u32 s3, s6, s45
buffer_load_dwordx4 v[92:95], v43, s[16:19], s3 offen sc1
buffer_load_dwordx4 a[232:235], v241, s[16:19], s41 offen offset:0 sc1
s_waitcnt vmcnt(11)
s_add_u32 s49, s6, s46
buffer_load_dwordx4 v[96:99], v43, s[16:19], s49 offen sc1
ds_read_b128 v[100:103], v76 offset:4096
s_waitcnt vmcnt(10)
v_swap_b32 v58, v60
v_swap_b32 v59, v61
s_nop 1
v_mfma_f32_16x16x32_bf16 v[136:139], v[56:59], v[4:7], v[136:139]
buffer_load_dwordx4 a[236:239], v241, s[16:19], s41 offen offset:1024 sc1
v_mfma_f32_16x16x32_bf16 v[140:143], v[60:63], v[4:7], v[140:143]
s_waitcnt vmcnt(10)
s_add_u32 s49, s7, s42
buffer_load_dwordx4 v[112:115], v47, s[16:19], s49 offen sc1
s_add_u32 s3, s7, s43
buffer_load_dwordx4 v[116:119], v47, s[16:19], s3 offen sc1
s_waitcnt vmcnt(11)
v_swap_b32 v66, v68
v_swap_b32 v67, v69
s_nop 1
v_mfma_f32_16x16x32_bf16 v[136:139], v[64:67], v[8:11], v[136:139]
buffer_load_dwordx4 a[240:243], v240, s[16:19], s41 offen offset:2048 sc1
v_mfma_f32_16x16x32_bf16 v[140:143], v[68:71], v[8:11], v[140:143]
s_waitcnt vmcnt(11)
s_nop 4
v_mul_f32 v136, v136, v40
v_mul_f32 v137, v137, v40
v_mul_f32 v138, v138, v40
v_mul_f32 v139, v139, v40
v_mul_f32 v140, v140, v40
v_mul_f32 v141, v141, v40
v_mul_f32 v142, v142, v40
v_mul_f32 v143, v143, v40
v_cvt_pk_bf16_f32 v136, v136, v137
v_cvt_pk_bf16_f32 v137, v138, v139
v_cvt_pk_bf16_f32 v138, v140, v141
v_cvt_pk_bf16_f32 v139, v142, v143
ds_write_b128 v251, v[136:139] offset:0
s_waitcnt vmcnt(9)
v_swap_b32 v82, v84
v_swap_b32 v83, v85
s_nop 1
v_mfma_f32_16x16x32_bf16 v[128:131], v[80:83], v[0:3], 0
s_add_u32 s49, s7, s44
buffer_load_dwordx4 v[120:123], v47, s[16:19], s49 offen sc1
v_mfma_f32_16x16x32_bf16 v[132:135], v[84:87], v[0:3], 0
s_add_u32 s3, s7, s45
buffer_load_dwordx4 v[124:127], v47, s[16:19], s3 offen sc1
buffer_load_dwordx4 a[244:247], v240, s[16:19], s41 offen offset:3072 sc1
s_waitcnt vmcnt(11)
s_add_u32 s49, s7, s46
buffer_load_dwordx4 v[48:51], v47, s[16:19], s49 offen sc1
ds_read_b128 v[52:55], v77 offset:0
s_waitcnt vmcnt(10)
v_swap_b32 v90, v92
v_swap_b32 v91, v93
s_nop 1
v_mfma_f32_16x16x32_bf16 v[128:131], v[88:91], v[4:7], v[128:131]
buffer_load_dwordx4 a[248:251], v241, s[16:19], s41 offen offset:2048 sc1
v_mfma_f32_16x16x32_bf16 v[132:135], v[92:95], v[4:7], v[132:135]
s_waitcnt vmcnt(10)
s_add_u32 s49, s7, s42
buffer_load_dwordx4 v[56:59], v43, s[16:19], s49 offen sc1
s_add_u32 s3, s7, s43
buffer_load_dwordx4 v[60:63], v43, s[16:19], s3 offen sc1
s_waitcnt vmcnt(11)
s_waitcnt lgkmcnt(2)
v_swap_b32 v98, v100
v_swap_b32 v99, v101
s_nop 1
v_mfma_f32_16x16x32_bf16 v[128:131], v[96:99], v[8:11], v[128:131]
buffer_load_dwordx4 a[252:255], v241, s[16:19], s41 offen offset:3072 sc1
v_mfma_f32_16x16x32_bf16 v[132:135], v[100:103], v[8:11], v[132:135]
s_waitcnt vmcnt(11)
s_nop 4
v_mul_f32 v128, v128, v40
v_mul_f32 v129, v129, v40
v_mul_f32 v130, v130, v40
v_mul_f32 v131, v131, v40
v_mul_f32 v132, v132, v40
v_mul_f32 v133, v133, v40
v_mul_f32 v134, v134, v40
v_mul_f32 v135, v135, v40
v_cvt_pk_bf16_f32 v128, v128, v129
v_cvt_pk_bf16_f32 v129, v130, v131
v_cvt_pk_bf16_f32 v130, v132, v133
v_cvt_pk_bf16_f32 v131, v134, v135
ds_write_b128 v251, v[128:131] offset:4096
s_waitcnt lgkmcnt(0)
s_barrier
ds_read_b128 v[208:211], v252 offset:0
ds_read_b128 v[212:215], v252 offset:1024
ds_read_b128 v[216:219], v252 offset:2048
ds_read_b128 v[220:223], v252 offset:3072
ds_read_b128 v[224:227], v252 offset:4096
s_waitcnt vmcnt(9)
s_waitcnt lgkmcnt(4)
v_mfma_f32_16x16x32_bf16 v[160:163], a[128:131], v[208:211], v[160:163]
ds_read_b128 v[228:231], v252 offset:5120
v_swap_b32 v114, v116
v_mfma_f32_16x16x32_bf16 v[164:167], a[132:135], v[208:211], v[164:167]
v_swap_b32 v115, v117
s_nop 1
v_mfma_f32_16x16x32_bf16 v[136:139], v[112:115], v[12:15], 0
s_add_u32 s49, s7, s44
buffer_load_dwordx4 v[64:67], v43, s[16:19], s49 offen sc1
v_mfma_f32_16x16x32_bf16 v[140:143], v[116:119], v[12:15], 0
s_add_u32 s3, s7, s45
buffer_load_dwordx4 v[68:71], v43, s[16:19], s3 offen sc1
v_mfma_f32_16x16x32_bf16 v[168:171], a[136:139], v[208:211], v[168:171]
s_add_u32 s49, s7, s46
buffer_load_dwordx4 v[80:83], v43, s[16:19], s49 offen sc1
v_mfma_f32_16x16x32_bf16 v[172:175], a[140:143], v[208:211], v[172:175]
ds_read_b128 v[84:87], v77 offset:4096
s_waitcnt lgkmcnt(5)
v_mfma_f32_16x16x32_bf16 v[160:163], a[144:147], v[212:215], v[160:163]
ds_read_b128 v[208:211], v252 offset:6144
v_mfma_f32_16x16x32_bf16 v[164:167], a[148:151], v[212:215], v[164:167]
v_mfma_f32_16x16x32_bf16 v[168:171], a[152:155], v[212:215], v[168:171]
v_mfma_f32_16x16x32_bf16 v[172:175], a[156:159], v[212:215], v[172:175]
s_waitcnt vmcnt(11)
s_waitcnt lgkmcnt(5)
v_mfma_f32_16x16x32_bf16 v[160:163], a[160:163], v[216:219], v[160:163]
ds_read_b128 v[212:215], v252 offset:7168
v_mfma_f32_16x16x32_bf16 v[164:167], a[164:167], v[216:219], v[164:167]
v_mfma_f32_16x16x32_bf16 v[168:171], a[168:171], v[216:219], v[168:171]
v_mfma_f32_16x16x32_bf16 v[172:175], a[172:175], v[216:219], v[172:175]
s_waitcnt vmcnt(9)
s_waitcnt lgkmcnt(5)
v_mfma_f32_16x16x32_bf16 v[160:163], a[176:179], v[220:223], v[160:163]
v_swap_b32 v122, v124
v_mfma_f32_16x16x32_bf16 v[164:167], a[180:183], v[220:223], v[164:167]
v_swap_b32 v123, v125
s_nop 1
v_mfma_f32_16x16x32_bf16 v[136:139], v[120:123], v[16:19], v[136:139]
s_add_u32 s49, s29, s42
buffer_load_dwordx4 v[88:91], v47, s[16:19], s49 offen sc1
v_mfma_f32_16x16x32_bf16 v[140:143], v[124:127], v[16:19], v[140:143]
s_add_u32 s3, s29, s43
buffer_load_dwordx4 v[92:95], v47, s[16:19], s3 offen sc1
v_mfma_f32_16x16x32_bf16 v[168:171], a[184:187], v[220:223], v[168:171]
v_mfma_f32_16x16x32_bf16 v[172:175], a[188:191], v[220:223], v[172:175]
s_waitcnt lgkmcnt(4)
v_mfma_f32_16x16x32_bf16 v[160:163], a[192:195], v[224:227], v[160:163]
v_mfma_f32_16x16x32_bf16 v[164:167], a[196:199], v[224:227], v[164:167]
v_mfma_f32_16x16x32_bf16 v[168:171], a[200:203], v[224:227], v[168:171]
v_mfma_f32_16x16x32_bf16 v[172:175], a[204:207], v[224:227], v[172:175]
s_waitcnt vmcnt(10)
s_waitcnt lgkmcnt(3)
v_mfma_f32_16x16x32_bf16 v[160:163], a[208:211], v[228:231], v[160:163]
s_add_u32 s49, s29, s44
buffer_load_dwordx4 v[96:99], v47, s[16:19], s49 offen sc1
v_mfma_f32_16x16x32_bf16 v[164:167], a[212:215], v[228:231], v[164:167]
s_add_u32 s3, s29, s45
buffer_load_dwordx4 v[100:103], v47, s[16:19], s3 offen sc1
v_mfma_f32_16x16x32_bf16 v[168:171], a[216:219], v[228:231], v[168:171]
v_mfma_f32_16x16x32_bf16 v[172:175], a[220:223], v[228:231], v[172:175]
s_waitcnt vmcnt(11)
s_waitcnt lgkmcnt(1)
v_mfma_f32_16x16x32_bf16 v[160:163], a[224:227], v[208:211], v[160:163]
v_swap_b32 v50, v52
v_mfma_f32_16x16x32_bf16 v[164:167], a[228:231], v[208:211], v[164:167]
v_swap_b32 v51, v53
s_nop 1
v_mfma_f32_16x16x32_bf16 v[136:139], v[48:51], v[20:23], v[136:139]
v_mfma_f32_16x16x32_bf16 v[140:143], v[52:55], v[20:23], v[140:143]
v_mfma_f32_16x16x32_bf16 v[168:171], a[232:235], v[208:211], v[168:171]
v_mfma_f32_16x16x32_bf16 v[172:175], a[236:239], v[208:211], v[172:175]
s_waitcnt vmcnt(10)
s_add_u32 s49, s29, s46
buffer_load_dwordx4 v[112:115], v47, s[16:19], s49 offen sc1
s_add_u32 s3, s29, s47
s_cmp_lt_u32 s37, 4
s_cbranch_scc1 LF_o0
buffer_load_dwordx4 v[116:119], v47, s[16:19], s3 offen sc1
ds_read_b128 v[36:39], v78 offset:0
s_branch LF_j0
LF_o0:
s_mov_b32 s3, 0x70000000
buffer_load_dwordx4 v[36:39], v47, s[16:19], s3 offen sc1
ds_read_b128 v[116:119], v78 offset:0
LF_j0:
v_mul_f32 v136, v136, v41
v_mul_f32 v137, v137, v41
v_mul_f32 v138, v138, v41
v_mul_f32 v139, v139, v41
v_mul_f32 v140, v140, v41
v_mul_f32 v141, v141, v41
v_mul_f32 v142, v142, v41
v_mul_f32 v143, v143, v41
v_cvt_pk_bf16_f32 v136, v136, v137
v_cvt_pk_bf16_f32 v137, v138, v139
v_cvt_pk_bf16_f32 v138, v140, v141
v_cvt_pk_bf16_f32 v139, v142, v143
ds_write_b128 v251, v[136:139] offset:8192
s_waitcnt vmcnt(10)
v_swap_b32 v58, v60
v_swap_b32 v59, v61
s_nop 1
v_mfma_f32_16x16x32_bf16 v[128:131], v[56:59], v[12:15], 0
s_add_u32 s49, s29, s42
buffer_load_dwordx4 v[120:123], v43, s[16:19], s49 offen sc1
v_mfma_f32_16x16x32_bf16 v[132:135], v[60:63], v[12:15], 0
s_add_u32 s3, s29, s43
buffer_load_dwordx4 v[124:127], v43, s[16:19], s3 offen sc1
s_waitcnt vmcnt(11)
s_waitcnt lgkmcnt(2)
v_mfma_f32_16x16x32_bf16 v[160:163], a[240:243], v[212:215], v[160:163]
v_mfma_f32_16x16x32_bf16 v[164:167], a[244:247], v[212:215], v[164:167]
v_mfma_f32_16x16x32_bf16 v[168:171], a[248:251], v[212:215], v[168:171]
v_mfma_f32_16x16x32_bf16 v[172:175], a[252:255], v[212:215], v[172:175]
s_waitcnt vmcnt(9)
v_swap_b32 v66, v68
v_swap_b32 v67, v69
s_nop 1
v_mfma_f32_16x16x32_bf16 v[128:131], v[64:67], v[16:19], v[128:131]
s_add_u32 s49, s29, s44
buffer_load_dwordx4 v[48:51], v43, s[16:19], s49 offen sc1
v_mfma_f32_16x16x32_bf16 v[132:135], v[68:71], v[16:19], v[132:135]
s_add_u32 s3, s29, s45
buffer_load_dwordx4 v[52:55], v43, s[16:19], s3 offen sc1
v_cvt_pk_bf16_f32 v160, v160, v161
v_cvt_pk_bf16_f32 v161, v162, v163
v_cvt_pk_bf16_f32 v162, v164, v165
v_cvt_pk_bf16_f32 v163, v166, v167
ds_write_b128 v245, v[160:163] offset:0
v_cvt_pk_bf16_f32 v168, v168, v169
v_cvt_pk_bf16_f32 v169, v170, v171
v_cvt_pk_bf16_f32 v170, v172, v173
v_cvt_pk_bf16_f32 v171, v174, v175
ds_write_b128 v246, v[168:171] offset:0
ds_read_b128 v[164:167], v247 offset:0
ds_read_b128 v[172:175], v247 offset:1024
s_waitcnt vmcnt(10)
v_swap_b32 v82, v84
v_swap_b32 v83, v85
s_nop 1
v_mfma_f32_16x16x32_bf16 v[128:131], v[80:83], v[20:23], v[128:131]
s_add_u32 s49, s29, s46
buffer_load_dwordx4 v[56:59], v43, s[16:19], s49 offen sc1
v_mfma_f32_16x16x32_bf16 v[132:135], v[84:87], v[20:23], v[132:135]
s_add_u32 s3, s29, s47
s_cmp_lt_u32 s37, 4
s_cbranch_scc1 LF_o1
buffer_load_dwordx4 v[60:63], v43, s[16:19], s3 offen sc1
ds_read_b128 v[36:39], v78 offset:4096
s_branch LF_j1
LF_o1:
s_mov_b32 s3, 0x70000000
buffer_load_dwordx4 v[36:39], v43, s[16:19], s3 offen sc1
ds_read_b128 v[60:63], v78 offset:4096
LF_j1:
s_waitcnt lgkmcnt(2)
buffer_store_dwordx4 v[164:167], v44, s[56:59], s6 offen sc1
s_waitcnt lgkmcnt(1)
buffer_store_dwordx4 v[172:175], v45, s[56:59], s6 offen sc1
v_mul_f32 v128, v128, v41
v_mul_f32 v129, v129, v41
v_mul_f32 v130, v130, v41
v_mul_f32 v131, v131, v41
v_mul_f32 v132, v132, v41
v_mul_f32 v133, v133, v41
v_mul_f32 v134, v134, v41
v_mul_f32 v135, v135, v41
v_cvt_pk_bf16_f32 v128, v128, v129
v_cvt_pk_bf16_f32 v129, v130, v131
v_cvt_pk_bf16_f32 v130, v132, v133
v_cvt_pk_bf16_f32 v131, v134, v135
ds_write_b128 v251, v[128:131] offset:12288
s_waitcnt lgkmcnt(0)
s_barrier
ds_read_b128 v[216:219], v252 offset:8192
ds_read_b128 v[220:223], v252 offset:9216
ds_read_b128 v[224:227], v252 offset:10240
ds_read_b128 v[228:231], v252 offset:11264
ds_read_b128 v[208:211], v252 offset:12288
s_waitcnt vmcnt(12)
s_waitcnt lgkmcnt(4)
v_mfma_f32_16x16x32_bf16 v[176:179], a[128:131], v[216:219], v[176:179]
ds_read_b128 v[212:215], v252 offset:13312
v_swap_b32 v90, v92
v_mfma_f32_16x16x32_bf16 v[180:183], a[132:135], v[216:219], v[180:183]
v_swap_b32 v91, v93
s_nop 1
v_mfma_f32_16x16x32_bf16 v[136:139], v[88:91], v[24:27], 0
v_mfma_f32_16x16x32_bf16 v[140:143], v[92:95], v[24:27], 0
v_mfma_f32_16x16x32_bf16 v[184:187], a[136:139], v[216:219], v[184:187]
v_mfma_f32_16x16x32_bf16 v[188:191], a[140:143], v[216:219], v[188:191]
s_waitcnt lgkmcnt(4)
v_mfma_f32_16x16x32_bf16 v[176:179], a[144:147], v[220:223], v[176:179]
ds_read_b128 v[216:219], v252 offset:14336
v_mfma_f32_16x16x32_bf16 v[180:183], a[148:151], v[220:223], v[180:183]
v_mfma_f32_16x16x32_bf16 v[184:187], a[152:155], v[220:223], v[184:187]
v_mfma_f32_16x16x32_bf16 v[188:191], a[156:159], v[220:223], v[188:191]
s_waitcnt vmcnt(10)
s_waitcnt lgkmcnt(4)
v_mfma_f32_16x16x32_bf16 v[176:179], a[160:163], v[224:227], v[176:179]
v_swap_b32 v98, v100
v_mfma_f32_16x16x32_bf16 v[180:183], a[164:167], v[224:227], v[180:183]
v_swap_b32 v99, v101
s_nop 1
v_mfma_f32_16x16x32_bf16 v[136:139], v[96:99], v[28:31], v[136:139]
v_mfma_f32_16x16x32_bf16 v[140:143], v[100:103], v[28:31], v[140:143]
v_mfma_f32_16x16x32_bf16 v[184:187], a[168:171], v[224:227], v[184:187]
v_mfma_f32_16x16x32_bf16 v[188:191], a[172:175], v[224:227], v[188:191]
s_waitcnt lgkmcnt(3)
v_mfma_f32_16x16x32_bf16 v[176:179], a[176:179], v[228:231], v[176:179]
v_mfma_f32_16x16x32_bf16 v[180:183], a[180:183], v[228:231], v[180:183]
v_mfma_f32_16x16x32_bf16 v[184:187], a[184:187], v[228:231], v[184:187]
v_mfma_f32_16x16x32_bf16 v[188:191], a[188:191], v[228:231], v[188:191]
s_waitcnt vmcnt(8)
s_waitcnt lgkmcnt(2)
v_mfma_f32_16x16x32_bf16 v[176:179], a[192:195], v[208:211], v[176:179]
v_swap_b32 v114, v116
v_mfma_f32_16x16x32_bf16 v[180:183], a[196:199], v[208:211], v[180:183]
v_swap_b32 v115, v117
s_nop 1
v_mfma_f32_16x16x32_bf16 v[136:139], v[112:115], v[32:35], v[136:139]
v_mfma_f32_16x16x32_bf16 v[140:143], v[116:119], v[32:35], v[140:143]
v_mfma_f32_16x16x32_bf16 v[184:187], a[200:203], v[208:211], v[184:187]
v_mfma_f32_16x16x32_bf16 v[188:191], a[204:207], v[208:211], v[188:191]
s_waitcnt lgkmcnt(1)
v_mfma_f32_16x16x32_bf16 v[176:179], a[208:211], v[212:215], v[176:179]
v_mfma_f32_16x16x32_bf16 v[180:183], a[212:215], v[212:215], v[180:183]
v_mfma_f32_16x16x32_bf16 v[184:187], a[216:219], v[212:215], v[184:187]
v_mfma_f32_16x16x32_bf16 v[188:191], a[220:223], v[212:215], v[188:191]
s_waitcnt lgkmcnt(0)
v_mfma_f32_16x16x32_bf16 v[176:179], a[224:227], v[216:219], v[176:179]
v_mul_f32 v136, v136, v42
v_mul_f32 v137, v137, v42
v_mfma_f32_16x16x32_bf16 v[180:183], a[228:231], v[216:219], v[180:183]
v_mul_f32 v138, v138, v42
v_mul_f32 v139, v139, v42
v_mfma_f32_16x16x32_bf16 v[184:187], a[232:235], v[216:219], v[184:187]
v_mul_f32 v140, v140, v42
v_mul_f32 v141, v141, v42
v_mfma_f32_16x16x32_bf16 v[188:191], a[236:239], v[216:219], v[188:191]
v_mul_f32 v142, v142, v42
v_mul_f32 v143, v143, v42
v_cvt_pk_bf16_f32 v136, v136, v137
v_cvt_pk_bf16_f32 v137, v138, v139
v_cvt_pk_bf16_f32 v138, v140, v141
v_cvt_pk_bf16_f32 v139, v142, v143
ds_write_b128 v251, v[136:139] offset:16384
s_waitcnt lgkmcnt(0)
s_barrier
ds_read_b128 v[220:223], v252 offset:15360
ds_read_b128 v[224:227], v252 offset:16384
ds_read_b128 v[228:231], v252 offset:17408
ds_read_b128 v[208:211], v252 offset:18432
ds_read_b128 v[212:215], v252 offset:19456
s_waitcnt vmcnt(6)
s_waitcnt lgkmcnt(4)
v_mfma_f32_16x16x32_bf16 v[176:179], a[240:243], v[220:223], v[176:179]
v_swap_b32 v122, v124
v_mfma_f32_16x16x32_bf16 v[180:183], a[244:247], v[220:223], v[180:183]
v_swap_b32 v123, v125
s_nop 1
v_mfma_f32_16x16x32_bf16 v[128:131], v[120:123], v[24:27], 0
v_mfma_f32_16x16x32_bf16 v[132:135], v[124:127], v[24:27], 0
v_mfma_f32_16x16x32_bf16 v[184:187], a[248:251], v[220:223], v[184:187]
v_mfma_f32_16x16x32_bf16 v[188:191], a[252:255], v[220:223], v[188:191]
s_waitcnt lgkmcnt(3)
v_mfma_f32_16x16x32_bf16 v[192:195], a[128:131], v[224:227], v[192:195]
v_mfma_f32_16x16x32_bf16 v[196:199], a[132:135], v[224:227], v[196:199]
v_mfma_f32_16x16x32_bf16 v[200:203], a[136:139], v[224:227], v[200:203]
v_mfma_f32_16x16x32_bf16 v[204:207], a[140:143], v[224:227], v[204:207]
s_waitcnt vmcnt(4)
s_waitcnt lgkmcnt(2)
v_mfma_f32_16x16x32_bf16 v[192:195], a[144:147], v[228:231], v[192:195]
v_swap_b32 v50, v52
v_mfma_f32_16x16x32_bf16 v[196:199], a[148:151], v[228:231], v[196:199]
v_swap_b32 v51, v53
s_nop 1
v_mfma_f32_16x16x32_bf16 v[128:131], v[48:51], v[28:31], v[128:131]
v_cvt_pk_bf16_f32 v176, v176, v177
v_cvt_pk_bf16_f32 v177, v178, v179
v_mfma_f32_16x16x32_bf16 v[132:135], v[52:55], v[28:31], v[132:135]
v_cvt_pk_bf16_f32 v178, v180, v181
v_cvt_pk_bf16_f32 v179, v182, v183
v_mfma_f32_16x16x32_bf16 v[200:203], a[152:155], v[228:231], v[200:203]
ds_write_b128 v245, v[176:179] offset:2048
v_cvt_pk_bf16_f32 v184, v184, v185
v_mfma_f32_16x16x32_bf16 v[204:207], a[156:159], v[228:231], v[204:207]
v_cvt_pk_bf16_f32 v185, v186, v187
v_cvt_pk_bf16_f32 v186, v188, v189
s_waitcnt lgkmcnt(2)
v_mfma_f32_16x16x32_bf16 v[192:195], a[160:163], v[208:211], v[192:195]
v_cvt_pk_bf16_f32 v187, v190, v191
ds_write_b128 v246, v[184:187] offset:2048
v_mfma_f32_16x16x32_bf16 v[196:199], a[164:167], v[208:211], v[196:199]
ds_read_b128 v[180:183], v247 offset:2048
ds_read_b128 v[188:191], v247 offset:3072
v_mfma_f32_16x16x32_bf16 v[200:203], a[168:171], v[208:211], v[200:203]
v_mfma_f32_16x16x32_bf16 v[204:207], a[172:175], v[208:211], v[204:207]
s_waitcnt vmcnt(2)
s_waitcnt lgkmcnt(4)
v_mfma_f32_16x16x32_bf16 v[192:195], a[176:179], v[212:215], v[192:195]
v_swap_b32 v58, v60
v_mfma_f32_16x16x32_bf16 v[196:199], a[180:183], v[212:215], v[196:199]
v_swap_b32 v59, v61
s_nop 1
v_mfma_f32_16x16x32_bf16 v[128:131], v[56:59], v[32:35], v[128:131]
s_waitcnt lgkmcnt(1)
buffer_store_dwordx4 v[180:183], v44, s[56:59], s7 offen sc1
v_mfma_f32_16x16x32_bf16 v[132:135], v[60:63], v[32:35], v[132:135]
s_waitcnt lgkmcnt(0)
buffer_store_dwordx4 v[188:191], v45, s[56:59], s7 offen sc1
v_mfma_f32_16x16x32_bf16 v[200:203], a[184:187], v[212:215], v[200:203]
v_mfma_f32_16x16x32_bf16 v[204:207], a[188:191], v[212:215], v[204:207]
s_nop 0
v_mul_f32 v128, v128, v42
v_mul_f32 v129, v129, v42
v_mul_f32 v130, v130, v42
v_mul_f32 v131, v131, v42
v_mul_f32 v132, v132, v42
v_mul_f32 v133, v133, v42
v_mul_f32 v134, v134, v42
v_mul_f32 v135, v135, v42
v_cvt_pk_bf16_f32 v128, v128, v129
v_cvt_pk_bf16_f32 v129, v130, v131
v_cvt_pk_bf16_f32 v130, v132, v133
v_cvt_pk_bf16_f32 v131, v134, v135
ds_write_b128 v251, v[128:131] offset:20480
s_waitcnt lgkmcnt(0)
s_barrier
ds_read_b128 v[216:219], v252 offset:20480
ds_read_b128 v[220:223], v252 offset:21504
ds_read_b128 v[224:227], v252 offset:22528
ds_read_b128 v[228:231], v252 offset:23552
s_waitcnt lgkmcnt(3)
v_mfma_f32_16x16x32_bf16 v[192:195], a[192:195], v[216:219], v[192:195]
v_mfma_f32_16x16x32_bf16 v[196:199], a[196:199], v[216:219], v[196:199]
v_mfma_f32_16x16x32_bf16 v[200:203], a[200:203], v[216:219], v[200:203]
v_mfma_f32_16x16x32_bf16 v[204:207], a[204:207], v[216:219], v[204:207]
s_waitcnt lgkmcnt(2)
v_mfma_f32_16x16x32_bf16 v[192:195], a[208:211], v[220:223], v[192:195]
v_mfma_f32_16x16x32_bf16 v[196:199], a[212:215], v[220:223], v[196:199]
v_mfma_f32_16x16x32_bf16 v[200:203], a[216:219], v[220:223], v[200:203]
v_mfma_f32_16x16x32_bf16 v[204:207], a[220:223], v[220:223], v[204:207]
s_waitcnt lgkmcnt(1)
v_mfma_f32_16x16x32_bf16 v[192:195], a[224:227], v[224:227], v[192:195]
v_mfma_f32_16x16x32_bf16 v[196:199], a[228:231], v[224:227], v[196:199]
v_mfma_f32_16x16x32_bf16 v[200:203], a[232:235], v[224:227], v[200:203]
v_mfma_f32_16x16x32_bf16 v[204:207], a[236:239], v[224:227], v[204:207]
s_waitcnt lgkmcnt(0)
v_mfma_f32_16x16x32_bf16 v[192:195], a[240:243], v[228:231], v[192:195]
v_mfma_f32_16x16x32_bf16 v[196:199], a[244:247], v[228:231], v[196:199]
v_mfma_f32_16x16x32_bf16 v[200:203], a[248:251], v[228:231], v[200:203]
v_mfma_f32_16x16x32_bf16 v[204:207], a[252:255], v[228:231], v[204:207]
s_nop 4
v_cvt_pk_bf16_f32 v192, v192, v193
v_cvt_pk_bf16_f32 v193, v194, v195
v_cvt_pk_bf16_f32 v194, v196, v197
v_cvt_pk_bf16_f32 v195, v198, v199
ds_write_b128 v245, v[192:195] offset:4096
v_cvt_pk_bf16_f32 v200, v200, v201
v_cvt_pk_bf16_f32 v201, v202, v203
v_cvt_pk_bf16_f32 v202, v204, v205
v_cvt_pk_bf16_f32 v203, v206, v207
ds_write_b128 v246, v[200:203] offset:4096
ds_read_b128 v[196:199], v247 offset:4096
ds_read_b128 v[204:207], v247 offset:5120
s_waitcnt lgkmcnt(1)
buffer_store_dwordx4 v[196:199], v44, s[56:59], s29 offen sc1
s_waitcnt lgkmcnt(0)
buffer_store_dwordx4 v[204:207], v45, s[56:59], s29 offen sc1
s_branch L2_fin
LF_spinQ:
s_mov_b32 s94, 0x10000
LF_spin2Q:
buffer_load_dwordx2 v[248:249], v46, s[16:19], 0 offen offset:0 sc1
s_sub_u32 s94, s94, 1
s_waitcnt vmcnt(0)
s_cbranch_scc1 LF_spin2Q_go
v_cmp_ne_u64 vcc, s[98:99], v[248:249]
s_nop 1
s_cbranch_vccnz LF_spin2Q
LF_spin2Q_go:
s_branch LF_goQ
LF_wf:
s_mov_b32 s94, 0x10000
LF_wf2:
buffer_load_dwordx2 v[108:109], v110, s[16:19], 0 offen sc1
s_sub_u32 s94, s94, 1
s_waitcnt vmcnt(0)
s_cbranch_scc1 LF_wf2_go
v_cmp_ne_u64 vcc, s[98:99], v[108:109]
s_nop 1
s_cbranch_vccnz LF_wf2
LF_wf2_go:
s_branch LF_wf_go
LM_pb:
s_mov_b32 s3, 0x10000
LM_pb2:
buffer_load_dwordx2 v[228:229], v230, s[16:19], 0 offen sc1
s_sub_u32 s3, s3, 1
s_waitcnt vmcnt(0)
s_cbranch_scc1 LM_pb2_go
v_cmp_ne_u64 vcc, s[98:99], v[228:229]
s_nop 1
s_cbranch_vccnz LM_pb2
LM_pb2_go:
s_branch LM_pb_ret
L2_Fend:
L2_rare_site0:
s_mov_b32 s36, 0
s_branch L2_rare_0_0
L2_rare_site4:
s_mov_b32 s36, 4
s_branch L2_rare_0_0
L2_rare_0_0:
s_nop 15
s_nop 15
s_waitcnt lgkmcnt(0)
v_add_u32 v250, 0x18000, v240
v_and_b32 v250, 0x1ffff, v250
ds_read_b128 v[232:235], v250 offset:16384
s_waitcnt lgkmcnt(0)
v_mfma_f32_16x16x32_bf16 v[128:131], v[232:235], v[0:3], v[192:195]
v_mfma_f32_16x16x32_bf16 v[132:135], v[232:235], v[32:35], v[196:199]
v_mfma_f32_16x16x32_bf16 v[136:139], v[232:235], v[64:67], v[200:203]
v_mfma_f32_16x16x32_bf16 v[140:143], v[232:235], v[96:99], v[204:207]
s_nop 7
ds_read_b128 v[232:235], v250 offset:16896
s_waitcnt lgkmcnt(0)
v_mfma_f32_16x16x32_bf16 v[128:131], v[232:235], v[4:7], v[128:131]
v_mfma_f32_16x16x32_bf16 v[132:135], v[232:235], v[36:39], v[132:135]
v_mfma_f32_16x16x32_bf16 v[136:139], v[232:235], v[68:71], v[136:139]
v_mfma_f32_16x16x32_bf16 v[140:143], v[232:235], v[100:103], v[140:143]
s_nop 7
ds_read_b128 v[232:235], v250 offset:20480
s_waitcnt lgkmcnt(0)
v_mfma_f32_16x16x32_bf16 v[128:131], v[232:235], v[8:11], v[128:131]
v_mfma_f32_16x16x32_bf16 v[132:135], v[232:235], v[40:43], v[132:135]
v_mfma_f32_16x16x32_bf16 v[136:139], v[232:235], v[72:75], v[136:139]
v_mfma_f32_16x16x32_bf16 v[140:143], v[232:235], v[104:107], v[140:143]
s_nop 7
ds_read_b128 v[232:235], v250 offset:20992
s_waitcnt lgkmcnt(0)
v_mfma_f32_16x16x32_bf16 v[128:131], v[232:235], v[12:15], v[128:131]
v_mfma_f32_16x16x32_bf16 v[132:135], v[232:235], v[44:47], v[132:135]
v_mfma_f32_16x16x32_bf16 v[136:139], v[232:235], v[76:79], v[136:139]
v_mfma_f32_16x16x32_bf16 v[140:143], v[232:235], v[108:111], v[140:143]
s_nop 7
ds_read_b128 v[232:235], v250 offset:24576
s_waitcnt lgkmcnt(0)
v_mfma_f32_16x16x32_bf16 v[128:131], v[232:235], v[16:19], v[128:131]
v_mfma_f32_16x16x32_bf16 v[132:135], v[232:235], v[48:51], v[132:135]
v_mfma_f32_16x16x32_bf16 v[136:139], v[232:235], v[80:83], v[136:139]
v_mfma_f32_16x16x32_bf16 v[140:143], v[232:235], v[112:115], v[140:143]
s_nop 7
ds_read_b128 v[232:235], v250 offset:25088
s_waitcnt lgkmcnt(0)
v_mfma_f32_16x16x32_bf16 v[128:131], v[232:235], v[20:23], v[128:131]
v_mfma_f32_16x16x32_bf16 v[132:135], v[232:235], v[52:55], v[132:135]
v_mfma_f32_16x16x32_bf16 v[136:139], v[232:235], v[84:87], v[136:139]
v_mfma_f32_16x16x32_bf16 v[140:143], v[232:235], v[116:119], v[140:143]
s_nop 7
ds_read_b128 v[232:235], v250 offset:28672
s_waitcnt lgkmcnt(0)
v_mfma_f32_16x16x32_bf16 v[128:131], v[232:235], v[24:27], v[128:131]
v_mfma_f32_16x16x32_bf16 v[132:135], v[232:235], v[56:59], v[132:135]
v_mfma_f32_16x16x32_bf16 v[136:139], v[232:235], v[88:91], v[136:139]
v_mfma_f32_16x16x32_bf16 v[140:143], v[232:235], v[120:123], v[140:143]
s_nop 7
ds_read_b128 v[232:235], v250 offset:29184
s_waitcnt lgkmcnt(0)
v_mfma_f32_16x16x32_bf16 v[128:131], v[232:235], v[28:31], v[128:131]
v_mfma_f32_16x16x32_bf16 v[132:135], v[232:235], v[60:63], v[132:135]
v_mfma_f32_16x16x32_bf16 v[136:139], v[232:235], v[92:95], v[136:139]
v_mfma_f32_16x16x32_bf16 v[140:143], v[232:235], v[124:127], v[140:143]
s_nop 7
s_nop 7
v_exp_f32 v248, v128
s_nop 0
v_sub_f32 v224, v224, v248
v_exp_f32 v248, v129
s_nop 0
v_sub_f32 v224, v224, v248
v_exp_f32 v248, v130
s_nop 0
v_sub_f32 v224, v224, v248
v_exp_f32 v248, v131
s_nop 0
v_sub_f32 v224, v224, v248
v_max_f32 v224, 0, v224
v_min_f32 v224, s32, v224
v_log_f32 v248, v224
v_max3_f32 v232, v128, v129, v130
v_max3_f32 v232, v232, v131, v248
v_mov_b32 v248, v232
s_nop 1
v_permlane32_swap_b32 v232, v248
s_nop 1
v_max_f32 v232, v232, v248
v_mov_b32 v248, v232
s_nop 1
v_permlane16_swap_b32 v232, v248
s_nop 1
v_max_f32 v232, v232, v248
v_ceil_f32 v232, v232
v_max_f32 v232, 0, v232
v_sub_f32 v248, 0, v232
v_exp_f32 v236, v248
s_nop 1
v_mul_f32 v224, v224, v236
v_sub_f32 v192, v192, v232
v_sub_f32 v128, v128, v232
v_sub_f32 v144, v144, v232
v_sub_f32 v193, v193, v232
v_sub_f32 v129, v129, v232
v_sub_f32 v145, v145, v232
v_sub_f32 v194, v194, v232
v_sub_f32 v130, v130, v232
v_sub_f32 v146, v146, v232
v_sub_f32 v195, v195, v232
v_sub_f32 v131, v131, v232
v_sub_f32 v147, v147, v232
v_lshlrev_b32 v242, 16, v160
v_and_b32 v248, 0xffff0000, v160
v_mul_f32 v242, v242, v236
v_mul_f32 v248, v248, v236
v_cvt_pk_bf16_f32 v160, v242, v248
v_lshlrev_b32 v242, 16, v161
v_and_b32 v248, 0xffff0000, v161
v_mul_f32 v242, v242, v236
v_mul_f32 v248, v248, v236
v_cvt_pk_bf16_f32 v161, v242, v248
v_lshlrev_b32 v242, 16, v162
v_and_b32 v248, 0xffff0000, v162
v_mul_f32 v242, v242, v236
v_mul_f32 v248, v248, v236
v_cvt_pk_bf16_f32 v162, v242, v248
v_lshlrev_b32 v242, 16, v163
v_and_b32 v248, 0xffff0000, v163
v_mul_f32 v242, v242, v236
v_mul_f32 v248, v248, v236
v_cvt_pk_bf16_f32 v163, v242, v248
v_lshlrev_b32 v242, 16, v176
v_and_b32 v248, 0xffff0000, v176
v_mul_f32 v242, v242, v236
v_mul_f32 v248, v248, v236
v_cvt_pk_bf16_f32 v176, v242, v248
v_lshlrev_b32 v242, 16, v177
v_and_b32 v248, 0xffff0000, v177
v_mul_f32 v242, v242, v236
v_mul_f32 v248, v248, v236
v_cvt_pk_bf16_f32 v177, v242, v248
v_lshlrev_b32 v242, 16, v178
v_and_b32 v248, 0xffff0000, v178
v_mul_f32 v242, v242, v236
v_mul_f32 v248, v248, v236
v_cvt_pk_bf16_f32 v178, v242, v248
v_lshlrev_b32 v242, 16, v179
v_and_b32 v248, 0xffff0000, v179
v_mul_f32 v242, v242, v236
v_mul_f32 v248, v248, v236
v_cvt_pk_bf16_f32 v179, v242, v248
v_exp_f32 v248, v132
s_nop 0
v_sub_f32 v225, v225, v248
v_exp_f32 v248, v133
s_nop 0
v_sub_f32 v225, v225, v248
v_exp_f32 v248, v134
s_nop 0
v_sub_f32 v225, v225, v248
v_exp_f32 v248, v135
s_nop 0
v_sub_f32 v225, v225, v248
v_max_f32 v225, 0, v225
v_min_f32 v225, s32, v225
v_log_f32 v248, v225
v_max3_f32 v233, v132, v133, v134
v_max3_f32 v233, v233, v135, v248
v_mov_b32 v248, v233
s_nop 1
v_permlane32_swap_b32 v233, v248
s_nop 1
v_max_f32 v233, v233, v248
v_mov_b32 v248, v233
s_nop 1
v_permlane16_swap_b32 v233, v248
s_nop 1
v_max_f32 v233, v233, v248
v_ceil_f32 v233, v233
v_max_f32 v233, 0, v233
v_sub_f32 v248, 0, v233
v_exp_f32 v237, v248
s_nop 1
v_mul_f32 v225, v225, v237
v_sub_f32 v196, v196, v233
v_sub_f32 v132, v132, v233
v_sub_f32 v148, v148, v233
v_sub_f32 v197, v197, v233
v_sub_f32 v133, v133, v233
v_sub_f32 v149, v149, v233
v_sub_f32 v198, v198, v233
v_sub_f32 v134, v134, v233
v_sub_f32 v150, v150, v233
v_sub_f32 v199, v199, v233
v_sub_f32 v135, v135, v233
v_sub_f32 v151, v151, v233
v_lshlrev_b32 v242, 16, v164
v_and_b32 v248, 0xffff0000, v164
v_mul_f32 v242, v242, v237
v_mul_f32 v248, v248, v237
v_cvt_pk_bf16_f32 v164, v242, v248
v_lshlrev_b32 v242, 16, v165
v_and_b32 v248, 0xffff0000, v165
v_mul_f32 v242, v242, v237
v_mul_f32 v248, v248, v237
v_cvt_pk_bf16_f32 v165, v242, v248
v_lshlrev_b32 v242, 16, v166
v_and_b32 v248, 0xffff0000, v166
v_mul_f32 v242, v242, v237
v_mul_f32 v248, v248, v237
v_cvt_pk_bf16_f32 v166, v242, v248
v_lshlrev_b32 v242, 16, v167
v_and_b32 v248, 0xffff0000, v167
v_mul_f32 v242, v242, v237
v_mul_f32 v248, v248, v237
v_cvt_pk_bf16_f32 v167, v242, v248
v_lshlrev_b32 v242, 16, v180
v_and_b32 v248, 0xffff0000, v180
v_mul_f32 v242, v242, v237
v_mul_f32 v248, v248, v237
v_cvt_pk_bf16_f32 v180, v242, v248
v_lshlrev_b32 v242, 16, v181
v_and_b32 v248, 0xffff0000, v181
v_mul_f32 v242, v242, v237
v_mul_f32 v248, v248, v237
v_cvt_pk_bf16_f32 v181, v242, v248
v_lshlrev_b32 v242, 16, v182
v_and_b32 v248, 0xffff0000, v182
v_mul_f32 v242, v242, v237
v_mul_f32 v248, v248, v237
v_cvt_pk_bf16_f32 v182, v242, v248
v_lshlrev_b32 v242, 16, v183
v_and_b32 v248, 0xffff0000, v183
v_mul_f32 v242, v242, v237
v_mul_f32 v248, v248, v237
v_cvt_pk_bf16_f32 v183, v242, v248
v_exp_f32 v248, v136
s_nop 0
v_sub_f32 v226, v226, v248
v_exp_f32 v248, v137
s_nop 0
v_sub_f32 v226, v226, v248
v_exp_f32 v248, v138
s_nop 0
v_sub_f32 v226, v226, v248
v_exp_f32 v248, v139
s_nop 0
v_sub_f32 v226, v226, v248
v_max_f32 v226, 0, v226
v_min_f32 v226, s32, v226
v_log_f32 v248, v226
v_max3_f32 v234, v136, v137, v138
v_max3_f32 v234, v234, v139, v248
v_mov_b32 v248, v234
s_nop 1
v_permlane32_swap_b32 v234, v248
s_nop 1
v_max_f32 v234, v234, v248
v_mov_b32 v248, v234
s_nop 1
v_permlane16_swap_b32 v234, v248
s_nop 1
v_max_f32 v234, v234, v248
v_ceil_f32 v234, v234
v_max_f32 v234, 0, v234
v_sub_f32 v248, 0, v234
v_exp_f32 v238, v248
s_nop 1
v_mul_f32 v226, v226, v238
v_sub_f32 v200, v200, v234
v_sub_f32 v136, v136, v234
v_sub_f32 v152, v152, v234
v_sub_f32 v201, v201, v234
v_sub_f32 v137, v137, v234
v_sub_f32 v153, v153, v234
v_sub_f32 v202, v202, v234
v_sub_f32 v138, v138, v234
v_sub_f32 v154, v154, v234
v_sub_f32 v203, v203, v234
v_sub_f32 v139, v139, v234
v_sub_f32 v155, v155, v234
v_lshlrev_b32 v242, 16, v168
v_and_b32 v248, 0xffff0000, v168
v_mul_f32 v242, v242, v238
v_mul_f32 v248, v248, v238
v_cvt_pk_bf16_f32 v168, v242, v248
v_lshlrev_b32 v242, 16, v169
v_and_b32 v248, 0xffff0000, v169
v_mul_f32 v242, v242, v238
v_mul_f32 v248, v248, v238
v_cvt_pk_bf16_f32 v169, v242, v248
v_lshlrev_b32 v242, 16, v170
v_and_b32 v248, 0xffff0000, v170
v_mul_f32 v242, v242, v238
v_mul_f32 v248, v248, v238
v_cvt_pk_bf16_f32 v170, v242, v248
v_lshlrev_b32 v242, 16, v171
v_and_b32 v248, 0xffff0000, v171
v_mul_f32 v242, v242, v238
v_mul_f32 v248, v248, v238
v_cvt_pk_bf16_f32 v171, v242, v248
v_lshlrev_b32 v242, 16, v184
v_and_b32 v248, 0xffff0000, v184
v_mul_f32 v242, v242, v238
v_mul_f32 v248, v248, v238
v_cvt_pk_bf16_f32 v184, v242, v248
v_lshlrev_b32 v242, 16, v185
v_and_b32 v248, 0xffff0000, v185
v_mul_f32 v242, v242, v238
v_mul_f32 v248, v248, v238
v_cvt_pk_bf16_f32 v185, v242, v248
v_lshlrev_b32 v242, 16, v186
v_and_b32 v248, 0xffff0000, v186
v_mul_f32 v242, v242, v238
v_mul_f32 v248, v248, v238
v_cvt_pk_bf16_f32 v186, v242, v248
v_lshlrev_b32 v242, 16, v187
v_and_b32 v248, 0xffff0000, v187
v_mul_f32 v242, v242, v238
v_mul_f32 v248, v248, v238
v_cvt_pk_bf16_f32 v187, v242, v248
v_exp_f32 v248, v140
s_nop 0
v_sub_f32 v227, v227, v248
v_exp_f32 v248, v141
s_nop 0
v_sub_f32 v227, v227, v248
v_exp_f32 v248, v142
s_nop 0
v_sub_f32 v227, v227, v248
v_exp_f32 v248, v143
s_nop 0
v_sub_f32 v227, v227, v248
v_max_f32 v227, 0, v227
v_min_f32 v227, s32, v227
v_log_f32 v248, v227
v_max3_f32 v235, v140, v141, v142
v_max3_f32 v235, v235, v143, v248
v_mov_b32 v248, v235
s_nop 1
v_permlane32_swap_b32 v235, v248
s_nop 1
v_max_f32 v235, v235, v248
v_mov_b32 v248, v235
s_nop 1
v_permlane16_swap_b32 v235, v248
s_nop 1
v_max_f32 v235, v235, v248
v_ceil_f32 v235, v235
v_max_f32 v235, 0, v235
v_sub_f32 v248, 0, v235
v_exp_f32 v239, v248
s_nop 1
v_mul_f32 v227, v227, v239
v_sub_f32 v204, v204, v235
v_sub_f32 v140, v140, v235
v_sub_f32 v156, v156, v235
v_sub_f32 v205, v205, v235
v_sub_f32 v141, v141, v235
v_sub_f32 v157, v157, v235
v_sub_f32 v206, v206, v235
v_sub_f32 v142, v142, v235
v_sub_f32 v158, v158, v235
v_sub_f32 v207, v207, v235
v_sub_f32 v143, v143, v235
v_sub_f32 v159, v159, v235
v_lshlrev_b32 v242, 16, v172
v_and_b32 v248, 0xffff0000, v172
v_mul_f32 v242, v242, v239
v_mul_f32 v248, v248, v239
v_cvt_pk_bf16_f32 v172, v242, v248
v_lshlrev_b32 v242, 16, v173
v_and_b32 v248, 0xffff0000, v173
v_mul_f32 v242, v242, v239
v_mul_f32 v248, v248, v239
v_cvt_pk_bf16_f32 v173, v242, v248
v_lshlrev_b32 v242, 16, v174
v_and_b32 v248, 0xffff0000, v174
v_mul_f32 v242, v242, v239
v_mul_f32 v248, v248, v239
v_cvt_pk_bf16_f32 v174, v242, v248
v_lshlrev_b32 v242, 16, v175
v_and_b32 v248, 0xffff0000, v175
v_mul_f32 v242, v242, v239
v_mul_f32 v248, v248, v239
v_cvt_pk_bf16_f32 v175, v242, v248
v_lshlrev_b32 v242, 16, v188
v_and_b32 v248, 0xffff0000, v188
v_mul_f32 v242, v242, v239
v_mul_f32 v248, v248, v239
v_cvt_pk_bf16_f32 v188, v242, v248
v_lshlrev_b32 v242, 16, v189
v_and_b32 v248, 0xffff0000, v189
v_mul_f32 v242, v242, v239
v_mul_f32 v248, v248, v239
v_cvt_pk_bf16_f32 v189, v242, v248
v_lshlrev_b32 v242, 16, v190
v_and_b32 v248, 0xffff0000, v190
v_mul_f32 v242, v242, v239
v_mul_f32 v248, v248, v239
v_cvt_pk_bf16_f32 v190, v242, v248
v_lshlrev_b32 v242, 16, v191
v_and_b32 v248, 0xffff0000, v191
v_mul_f32 v242, v242, v239
v_mul_f32 v248, v248, v239
v_cvt_pk_bf16_f32 v191, v242, v248
v_exp_f32 v128, v128
v_exp_f32 v129, v129
v_exp_f32 v130, v130
v_exp_f32 v131, v131
s_nop 1
v_add_f32 v224, v224, v128
v_add_f32 v224, v224, v129
v_add_f32 v224, v224, v130
v_add_f32 v224, v224, v131
v_exp_f32 v132, v132
v_exp_f32 v133, v133
v_exp_f32 v134, v134
v_exp_f32 v135, v135
s_nop 1
v_add_f32 v225, v225, v132
v_add_f32 v225, v225, v133
v_add_f32 v225, v225, v134
v_add_f32 v225, v225, v135
v_exp_f32 v136, v136
v_exp_f32 v137, v137
v_exp_f32 v138, v138
v_exp_f32 v139, v139
s_nop 1
v_add_f32 v226, v226, v136
v_add_f32 v226, v226, v137
v_add_f32 v226, v226, v138
v_add_f32 v226, v226, v139
v_exp_f32 v140, v140
v_exp_f32 v141, v141
v_exp_f32 v142, v142
v_exp_f32 v143, v143
s_nop 1
v_add_f32 v227, v227, v140
v_add_f32 v227, v227, v141
v_add_f32 v227, v227, v142
v_add_f32 v227, v227, v143
s_branch L2_rare_common
L2_rare_site1:
s_mov_b32 s36, 1
s_branch L2_rare_0_1
L2_rare_site5:
s_mov_b32 s36, 5
s_branch L2_rare_0_1
L2_rare_0_1:
s_nop 15
s_nop 15
s_waitcnt lgkmcnt(0)
v_add_u32 v250, 0x18000, v240
v_and_b32 v250, 0x1ffff, v250
ds_read_b128 v[232:235], v250 offset:18432
s_waitcnt lgkmcnt(0)
v_mfma_f32_16x16x32_bf16 v[144:147], v[232:235], v[0:3], v[192:195]
v_mfma_f32_16x16x32_bf16 v[148:151], v[232:235], v[32:35], v[196:199]
v_mfma_f32_16x16x32_bf16 v[152:155], v[232:235], v[64:67], v[200:203]
v_mfma_f32_16x16x32_bf16 v[156:159], v[232:235], v[96:99], v[204:207]
s_nop 7
ds_read_b128 v[232:235], v250 offset:18944
s_waitcnt lgkmcnt(0)
v_mfma_f32_16x16x32_bf16 v[144:147], v[232:235], v[4:7], v[144:147]
v_mfma_f32_16x16x32_bf16 v[148:151], v[232:235], v[36:39], v[148:151]
v_mfma_f32_16x16x32_bf16 v[152:155], v[232:235], v[68:71], v[152:155]
v_mfma_f32_16x16x32_bf16 v[156:159], v[232:235], v[100:103], v[156:159]
s_nop 7
ds_read_b128 v[232:235], v250 offset:22528
s_waitcnt lgkmcnt(0)
v_mfma_f32_16x16x32_bf16 v[144:147], v[232:235], v[8:11], v[144:147]
v_mfma_f32_16x16x32_bf16 v[148:151], v[232:235], v[40:43], v[148:151]
v_mfma_f32_16x16x32_bf16 v[152:155], v[232:235], v[72:75], v[152:155]
v_mfma_f32_16x16x32_bf16 v[156:159], v[232:235], v[104:107], v[156:159]
s_nop 7
ds_read_b128 v[232:235], v250 offset:23040
s_waitcnt lgkmcnt(0)
v_mfma_f32_16x16x32_bf16 v[144:147], v[232:235], v[12:15], v[144:147]
v_mfma_f32_16x16x32_bf16 v[148:151], v[232:235], v[44:47], v[148:151]
v_mfma_f32_16x16x32_bf16 v[152:155], v[232:235], v[76:79], v[152:155]
v_mfma_f32_16x16x32_bf16 v[156:159], v[232:235], v[108:111], v[156:159]
s_nop 7
ds_read_b128 v[232:235], v250 offset:26624
s_waitcnt lgkmcnt(0)
v_mfma_f32_16x16x32_bf16 v[144:147], v[232:235], v[16:19], v[144:147]
v_mfma_f32_16x16x32_bf16 v[148:151], v[232:235], v[48:51], v[148:151]
v_mfma_f32_16x16x32_bf16 v[152:155], v[232:235], v[80:83], v[152:155]
v_mfma_f32_16x16x32_bf16 v[156:159], v[232:235], v[112:115], v[156:159]
s_nop 7
ds_read_b128 v[232:235], v250 offset:27136
s_waitcnt lgkmcnt(0)
v_mfma_f32_16x16x32_bf16 v[144:147], v[232:235], v[20:23], v[144:147]
v_mfma_f32_16x16x32_bf16 v[148:151], v[232:235], v[52:55], v[148:151]
v_mfma_f32_16x16x32_bf16 v[152:155], v[232:235], v[84:87], v[152:155]
v_mfma_f32_16x16x32_bf16 v[156:159], v[232:235], v[116:119], v[156:159]
s_nop 7
ds_read_b128 v[232:235], v250 offset:30720
s_waitcnt lgkmcnt(0)
v_mfma_f32_16x16x32_bf16 v[144:147], v[232:235], v[24:27], v[144:147]
v_mfma_f32_16x16x32_bf16 v[148:151], v[232:235], v[56:59], v[148:151]
v_mfma_f32_16x16x32_bf16 v[152:155], v[232:235], v[88:91], v[152:155]
v_mfma_f32_16x16x32_bf16 v[156:159], v[232:235], v[120:123], v[156:159]
s_nop 7
ds_read_b128 v[232:235], v250 offset:31232
s_waitcnt lgkmcnt(0)
v_mfma_f32_16x16x32_bf16 v[144:147], v[232:235], v[28:31], v[144:147]
v_mfma_f32_16x16x32_bf16 v[148:151], v[232:235], v[60:63], v[148:151]
v_mfma_f32_16x16x32_bf16 v[152:155], v[232:235], v[92:95], v[152:155]
v_mfma_f32_16x16x32_bf16 v[156:159], v[232:235], v[124:127], v[156:159]
s_nop 7
s_nop 7
v_exp_f32 v248, v144
s_nop 0
v_sub_f32 v224, v224, v248
v_exp_f32 v248, v145
s_nop 0
v_sub_f32 v224, v224, v248
v_exp_f32 v248, v146
s_nop 0
v_sub_f32 v224, v224, v248
v_exp_f32 v248, v147
s_nop 0
v_sub_f32 v224, v224, v248
v_max_f32 v224, 0, v224
v_min_f32 v224, s32, v224
v_log_f32 v248, v224
v_max3_f32 v232, v144, v145, v146
v_max3_f32 v232, v232, v147, v248
v_mov_b32 v248, v232
s_nop 1
v_permlane32_swap_b32 v232, v248
s_nop 1
v_max_f32 v232, v232, v248
v_mov_b32 v248, v232
s_nop 1
v_permlane16_swap_b32 v232, v248
s_nop 1
v_max_f32 v232, v232, v248
v_ceil_f32 v232, v232
v_max_f32 v232, 0, v232
v_sub_f32 v248, 0, v232
v_exp_f32 v236, v248
s_nop 1
v_mul_f32 v224, v224, v236
v_sub_f32 v192, v192, v232
v_sub_f32 v128, v128, v232
v_sub_f32 v144, v144, v232
v_sub_f32 v193, v193, v232
v_sub_f32 v129, v129, v232
v_sub_f32 v145, v145, v232
v_sub_f32 v194, v194, v232
v_sub_f32 v130, v130, v232
v_sub_f32 v146, v146, v232
v_sub_f32 v195, v195, v232
v_sub_f32 v131, v131, v232
v_sub_f32 v147, v147, v232
v_lshlrev_b32 v242, 16, v160
v_and_b32 v248, 0xffff0000, v160
v_mul_f32 v242, v242, v236
v_mul_f32 v248, v248, v236
v_cvt_pk_bf16_f32 v160, v242, v248
v_lshlrev_b32 v242, 16, v161
v_and_b32 v248, 0xffff0000, v161
v_mul_f32 v242, v242, v236
v_mul_f32 v248, v248, v236
v_cvt_pk_bf16_f32 v161, v242, v248
v_lshlrev_b32 v242, 16, v162
v_and_b32 v248, 0xffff0000, v162
v_mul_f32 v242, v242, v236
v_mul_f32 v248, v248, v236
v_cvt_pk_bf16_f32 v162, v242, v248
v_lshlrev_b32 v242, 16, v163
v_and_b32 v248, 0xffff0000, v163
v_mul_f32 v242, v242, v236
v_mul_f32 v248, v248, v236
v_cvt_pk_bf16_f32 v163, v242, v248
v_lshlrev_b32 v242, 16, v176
v_and_b32 v248, 0xffff0000, v176
v_mul_f32 v242, v242, v236
v_mul_f32 v248, v248, v236
v_cvt_pk_bf16_f32 v176, v242, v248
v_lshlrev_b32 v242, 16, v177
v_and_b32 v248, 0xffff0000, v177
v_mul_f32 v242, v242, v236
v_mul_f32 v248, v248, v236
v_cvt_pk_bf16_f32 v177, v242, v248
v_exp_f32 v248, v148
s_nop 0
v_sub_f32 v225, v225, v248
v_exp_f32 v248, v149
s_nop 0
v_sub_f32 v225, v225, v248
v_exp_f32 v248, v150
s_nop 0
v_sub_f32 v225, v225, v248
v_exp_f32 v248, v151
s_nop 0
v_sub_f32 v225, v225, v248
v_max_f32 v225, 0, v225
v_min_f32 v225, s32, v225
v_log_f32 v248, v225
v_max3_f32 v233, v148, v149, v150
v_max3_f32 v233, v233, v151, v248
v_mov_b32 v248, v233
s_nop 1
v_permlane32_swap_b32 v233, v248
s_nop 1
v_max_f32 v233, v233, v248
v_mov_b32 v248, v233
s_nop 1
v_permlane16_swap_b32 v233, v248
s_nop 1
v_max_f32 v233, v233, v248
v_ceil_f32 v233, v233
v_max_f32 v233, 0, v233
v_sub_f32 v248, 0, v233
v_exp_f32 v237, v248
s_nop 1
v_mul_f32 v225, v225, v237
v_sub_f32 v196, v196, v233
v_sub_f32 v132, v132, v233
v_sub_f32 v148, v148, v233
v_sub_f32 v197, v197, v233
v_sub_f32 v133, v133, v233
v_sub_f32 v149, v149, v233
v_sub_f32 v198, v198, v233
v_sub_f32 v134, v134, v233
v_sub_f32 v150, v150, v233
v_sub_f32 v199, v199, v233
v_sub_f32 v135, v135, v233
v_sub_f32 v151, v151, v233
v_lshlrev_b32 v242, 16, v164
v_and_b32 v248, 0xffff0000, v164
v_mul_f32 v242, v242, v237
v_mul_f32 v248, v248, v237
v_cvt_pk_bf16_f32 v164, v242, v248
v_lshlrev_b32 v242, 16, v165
v_and_b32 v248, 0xffff0000, v165
v_mul_f32 v242, v242, v237
v_mul_f32 v248, v248, v237
v_cvt_pk_bf16_f32 v165, v242, v248
v_lshlrev_b32 v242, 16, v166
v_and_b32 v248, 0xffff0000, v166
v_mul_f32 v242, v242, v237
v_mul_f32 v248, v248, v237
v_cvt_pk_bf16_f32 v166, v242, v248
v_lshlrev_b32 v242, 16, v167
v_and_b32 v248, 0xffff0000, v167
v_mul_f32 v242, v242, v237
v_mul_f32 v248, v248, v237
v_cvt_pk_bf16_f32 v167, v242, v248
v_lshlrev_b32 v242, 16, v180
v_and_b32 v248, 0xffff0000, v180
v_mul_f32 v242, v242, v237
v_mul_f32 v248, v248, v237
v_cvt_pk_bf16_f32 v180, v242, v248
v_lshlrev_b32 v242, 16, v181
v_and_b32 v248, 0xffff0000, v181
v_mul_f32 v242, v242, v237
v_mul_f32 v248, v248, v237
v_cvt_pk_bf16_f32 v181, v242, v248
v_exp_f32 v248, v152
s_nop 0
v_sub_f32 v226, v226, v248
v_exp_f32 v248, v153
s_nop 0
v_sub_f32 v226, v226, v248
v_exp_f32 v248, v154
s_nop 0
v_sub_f32 v226, v226, v248
v_exp_f32 v248, v155
s_nop 0
v_sub_f32 v226, v226, v248
v_max_f32 v226, 0, v226
v_min_f32 v226, s32, v226
v_log_f32 v248, v226
v_max3_f32 v234, v152, v153, v154
v_max3_f32 v234, v234, v155, v248
v_mov_b32 v248, v234
s_nop 1
v_permlane32_swap_b32 v234, v248
s_nop 1
v_max_f32 v234, v234, v248
v_mov_b32 v248, v234
s_nop 1
v_permlane16_swap_b32 v234, v248
s_nop 1
v_max_f32 v234, v234, v248
v_ceil_f32 v234, v234
v_max_f32 v234, 0, v234
v_sub_f32 v248, 0, v234
v_exp_f32 v238, v248
s_nop 1
v_mul_f32 v226, v226, v238
v_sub_f32 v200, v200, v234
v_sub_f32 v136, v136, v234
v_sub_f32 v152, v152, v234
v_sub_f32 v201, v201, v234
v_sub_f32 v137, v137, v234
v_sub_f32 v153, v153, v234
v_sub_f32 v202, v202, v234
v_sub_f32 v138, v138, v234
v_sub_f32 v154, v154, v234
v_sub_f32 v203, v203, v234
v_sub_f32 v139, v139, v234
v_sub_f32 v155, v155, v234
v_lshlrev_b32 v242, 16, v168
v_and_b32 v248, 0xffff0000, v168
v_mul_f32 v242, v242, v238
v_mul_f32 v248, v248, v238
v_cvt_pk_bf16_f32 v168, v242, v248
v_lshlrev_b32 v242, 16, v169
v_and_b32 v248, 0xffff0000, v169
v_mul_f32 v242, v242, v238
v_mul_f32 v248, v248, v238
v_cvt_pk_bf16_f32 v169, v242, v248
v_lshlrev_b32 v242, 16, v170
v_and_b32 v248, 0xffff0000, v170
v_mul_f32 v242, v242, v238
v_mul_f32 v248, v248, v238
v_cvt_pk_bf16_f32 v170, v242, v248
v_lshlrev_b32 v242, 16, v171
v_and_b32 v248, 0xffff0000, v171
v_mul_f32 v242, v242, v238
v_mul_f32 v248, v248, v238
v_cvt_pk_bf16_f32 v171, v242, v248
v_lshlrev_b32 v242, 16, v184
v_and_b32 v248, 0xffff0000, v184
v_mul_f32 v242, v242, v238
v_mul_f32 v248, v248, v238
v_cvt_pk_bf16_f32 v184, v242, v248
v_lshlrev_b32 v242, 16, v185
v_and_b32 v248, 0xffff0000, v185
v_mul_f32 v242, v242, v238
v_mul_f32 v248, v248, v238
v_cvt_pk_bf16_f32 v185, v242, v248
v_exp_f32 v248, v156
s_nop 0
v_sub_f32 v227, v227, v248
v_exp_f32 v248, v157
s_nop 0
v_sub_f32 v227, v227, v248
v_exp_f32 v248, v158
s_nop 0
v_sub_f32 v227, v227, v248
v_exp_f32 v248, v159
s_nop 0
v_sub_f32 v227, v227, v248
v_max_f32 v227, 0, v227
v_min_f32 v227, s32, v227
v_log_f32 v248, v227
v_max3_f32 v235, v156, v157, v158
v_max3_f32 v235, v235, v159, v248
v_mov_b32 v248, v235
s_nop 1
v_permlane32_swap_b32 v235, v248
s_nop 1
v_max_f32 v235, v235, v248
v_mov_b32 v248, v235
s_nop 1
v_permlane16_swap_b32 v235, v248
s_nop 1
v_max_f32 v235, v235, v248
v_ceil_f32 v235, v235
v_max_f32 v235, 0, v235
v_sub_f32 v248, 0, v235
v_exp_f32 v239, v248
s_nop 1
v_mul_f32 v227, v227, v239
v_sub_f32 v204, v204, v235
v_sub_f32 v140, v140, v235
v_sub_f32 v156, v156, v235
v_sub_f32 v205, v205, v235
v_sub_f32 v141, v141, v235
v_sub_f32 v157, v157, v235
v_sub_f32 v206, v206, v235
v_sub_f32 v142, v142, v235
v_sub_f32 v158, v158, v235
v_sub_f32 v207, v207, v235
v_sub_f32 v143, v143, v235
v_sub_f32 v159, v159, v235
v_lshlrev_b32 v242, 16, v172
v_and_b32 v248, 0xffff0000, v172
v_mul_f32 v242, v242, v239
v_mul_f32 v248, v248, v239
v_cvt_pk_bf16_f32 v172, v242, v248
v_lshlrev_b32 v242, 16, v173
v_and_b32 v248, 0xffff0000, v173
v_mul_f32 v242, v242, v239
v_mul_f32 v248, v248, v239
v_cvt_pk_bf16_f32 v173, v242, v248
v_lshlrev_b32 v242, 16, v174
v_and_b32 v248, 0xffff0000, v174
v_mul_f32 v242, v242, v239
v_mul_f32 v248, v248, v239
v_cvt_pk_bf16_f32 v174, v242, v248
v_lshlrev_b32 v242, 16, v175
v_and_b32 v248, 0xffff0000, v175
v_mul_f32 v242, v242, v239
v_mul_f32 v248, v248, v239
v_cvt_pk_bf16_f32 v175, v242, v248
v_lshlrev_b32 v242, 16, v188
v_and_b32 v248, 0xffff0000, v188
v_mul_f32 v242, v242, v239
v_mul_f32 v248, v248, v239
v_cvt_pk_bf16_f32 v188, v242, v248
v_lshlrev_b32 v242, 16, v189
v_and_b32 v248, 0xffff0000, v189
v_mul_f32 v242, v242, v239
v_mul_f32 v248, v248, v239
v_cvt_pk_bf16_f32 v189, v242, v248
v_exp_f32 v144, v144
v_exp_f32 v145, v145
v_exp_f32 v146, v146
v_exp_f32 v147, v147
s_nop 1
v_add_f32 v224, v224, v144
v_add_f32 v224, v224, v145
v_add_f32 v224, v224, v146
v_add_f32 v224, v224, v147
v_exp_f32 v148, v148
v_exp_f32 v149, v149
v_exp_f32 v150, v150
v_exp_f32 v151, v151
s_nop 1
v_add_f32 v225, v225, v148
v_add_f32 v225, v225, v149
v_add_f32 v225, v225, v150
v_add_f32 v225, v225, v151
v_exp_f32 v152, v152
v_exp_f32 v153, v153
v_exp_f32 v154, v154
v_exp_f32 v155, v155
s_nop 1
v_add_f32 v226, v226, v152
v_add_f32 v226, v226, v153
v_add_f32 v226, v226, v154
v_add_f32 v226, v226, v155
v_exp_f32 v156, v156
v_exp_f32 v157, v157
v_exp_f32 v158, v158
v_exp_f32 v159, v159
s_nop 1
v_add_f32 v227, v227, v156
v_add_f32 v227, v227, v157
v_add_f32 v227, v227, v158
v_add_f32 v227, v227, v159
s_branch L2_rare_common
L2_rare_site2:
s_mov_b32 s36, 2
s_branch L2_rare_1_0
L2_rare_1_0:
s_nop 15
s_nop 15
s_waitcnt lgkmcnt(0)
v_add_u32 v250, 0x0, v240
v_and_b32 v250, 0x1ffff, v250
ds_read_b128 v[232:235], v250 offset:0
s_waitcnt lgkmcnt(0)
v_mfma_f32_16x16x32_bf16 v[128:131], v[232:235], v[0:3], v[192:195]
v_mfma_f32_16x16x32_bf16 v[132:135], v[232:235], v[32:35], v[196:199]
v_mfma_f32_16x16x32_bf16 v[136:139], v[232:235], v[64:67], v[200:203]
v_mfma_f32_16x16x32_bf16 v[140:143], v[232:235], v[96:99], v[204:207]
s_nop 7
ds_read_b128 v[232:235], v250 offset:512
s_waitcnt lgkmcnt(0)
v_mfma_f32_16x16x32_bf16 v[128:131], v[232:235], v[4:7], v[128:131]
v_mfma_f32_16x16x32_bf16 v[132:135], v[232:235], v[36:39], v[132:135]
v_mfma_f32_16x16x32_bf16 v[136:139], v[232:235], v[68:71], v[136:139]
v_mfma_f32_16x16x32_bf16 v[140:143], v[232:235], v[100:103], v[140:143]
s_nop 7
ds_read_b128 v[232:235], v250 offset:4096
s_waitcnt lgkmcnt(0)
v_mfma_f32_16x16x32_bf16 v[128:131], v[232:235], v[8:11], v[128:131]
v_mfma_f32_16x16x32_bf16 v[132:135], v[232:235], v[40:43], v[132:135]
v_mfma_f32_16x16x32_bf16 v[136:139], v[232:235], v[72:75], v[136:139]
v_mfma_f32_16x16x32_bf16 v[140:143], v[232:235], v[104:107], v[140:143]
s_nop 7
ds_read_b128 v[232:235], v250 offset:4608
s_waitcnt lgkmcnt(0)
v_mfma_f32_16x16x32_bf16 v[128:131], v[232:235], v[12:15], v[128:131]
v_mfma_f32_16x16x32_bf16 v[132:135], v[232:235], v[44:47], v[132:135]
v_mfma_f32_16x16x32_bf16 v[136:139], v[232:235], v[76:79], v[136:139]
v_mfma_f32_16x16x32_bf16 v[140:143], v[232:235], v[108:111], v[140:143]
s_nop 7
ds_read_b128 v[232:235], v250 offset:8192
s_waitcnt lgkmcnt(0)
v_mfma_f32_16x16x32_bf16 v[128:131], v[232:235], v[16:19], v[128:131]
v_mfma_f32_16x16x32_bf16 v[132:135], v[232:235], v[48:51], v[132:135]
v_mfma_f32_16x16x32_bf16 v[136:139], v[232:235], v[80:83], v[136:139]
v_mfma_f32_16x16x32_bf16 v[140:143], v[232:235], v[112:115], v[140:143]
s_nop 7
ds_read_b128 v[232:235], v250 offset:8704
s_waitcnt lgkmcnt(0)
v_mfma_f32_16x16x32_bf16 v[128:131], v[232:235], v[20:23], v[128:131]
v_mfma_f32_16x16x32_bf16 v[132:135], v[232:235], v[52:55], v[132:135]
v_mfma_f32_16x16x32_bf16 v[136:139], v[232:235], v[84:87], v[136:139]
v_mfma_f32_16x16x32_bf16 v[140:143], v[232:235], v[116:119], v[140:143]
s_nop 7
ds_read_b128 v[232:235], v250 offset:12288
s_waitcnt lgkmcnt(0)
v_mfma_f32_16x16x32_bf16 v[128:131], v[232:235], v[24:27], v[128:131]
v_mfma_f32_16x16x32_bf16 v[132:135], v[232:235], v[56:59], v[132:135]
v_mfma_f32_16x16x32_bf16 v[136:139], v[232:235], v[88:91], v[136:139]
v_mfma_f32_16x16x32_bf16 v[140:143], v[232:235], v[120:123], v[140:143]
s_nop 7
ds_read_b128 v[232:235], v250 offset:12800
s_waitcnt lgkmcnt(0)
v_mfma_f32_16x16x32_bf16 v[128:131], v[232:235], v[28:31], v[128:131]
v_mfma_f32_16x16x32_bf16 v[132:135], v[232:235], v[60:63], v[132:135]
v_mfma_f32_16x16x32_bf16 v[136:139], v[232:235], v[92:95], v[136:139]
v_mfma_f32_16x16x32_bf16 v[140:143], v[232:235], v[124:127], v[140:143]
s_nop 7
s_nop 7
v_exp_f32 v248, v128
s_nop 0
v_sub_f32 v224, v224, v248
v_exp_f32 v248, v129
s_nop 0
v_sub_f32 v224, v224, v248
v_exp_f32 v248, v130
s_nop 0
v_sub_f32 v224, v224, v248
v_exp_f32 v248, v131
s_nop 0
v_sub_f32 v224, v224, v248
v_max_f32 v224, 0, v224
v_min_f32 v224, s32, v224
v_log_f32 v248, v224
v_max3_f32 v232, v128, v129, v130
v_max3_f32 v232, v232, v131, v248
v_mov_b32 v248, v232
s_nop 1
v_permlane32_swap_b32 v232, v248
s_nop 1
v_max_f32 v232, v232, v248
v_mov_b32 v248, v232
s_nop 1
v_permlane16_swap_b32 v232, v248
s_nop 1
v_max_f32 v232, v232, v248
v_ceil_f32 v232, v232
v_max_f32 v232, 0, v232
v_sub_f32 v248, 0, v232
v_exp_f32 v236, v248
s_nop 1
v_mul_f32 v224, v224, v236
v_sub_f32 v192, v192, v232
v_sub_f32 v128, v128, v232
v_sub_f32 v144, v144, v232
v_sub_f32 v193, v193, v232
v_sub_f32 v129, v129, v232
v_sub_f32 v145, v145, v232
v_sub_f32 v194, v194, v232
v_sub_f32 v130, v130, v232
v_sub_f32 v146, v146, v232
v_sub_f32 v195, v195, v232
v_sub_f32 v131, v131, v232
v_sub_f32 v147, v147, v232
v_lshlrev_b32 v242, 16, v176
v_and_b32 v248, 0xffff0000, v176
v_mul_f32 v242, v242, v236
v_mul_f32 v248, v248, v236
v_cvt_pk_bf16_f32 v176, v242, v248
v_lshlrev_b32 v242, 16, v177
v_and_b32 v248, 0xffff0000, v177
v_mul_f32 v242, v242, v236
v_mul_f32 v248, v248, v236
v_cvt_pk_bf16_f32 v177, v242, v248
v_lshlrev_b32 v242, 16, v178
v_and_b32 v248, 0xffff0000, v178
v_mul_f32 v242, v242, v236
v_mul_f32 v248, v248, v236
v_cvt_pk_bf16_f32 v178, v242, v248
v_lshlrev_b32 v242, 16, v179
v_and_b32 v248, 0xffff0000, v179
v_mul_f32 v242, v242, v236
v_mul_f32 v248, v248, v236
v_cvt_pk_bf16_f32 v179, v242, v248
v_lshlrev_b32 v242, 16, v160
v_and_b32 v248, 0xffff0000, v160
v_mul_f32 v242, v242, v236
v_mul_f32 v248, v248, v236
v_cvt_pk_bf16_f32 v160, v242, v248
v_lshlrev_b32 v242, 16, v161
v_and_b32 v248, 0xffff0000, v161
v_mul_f32 v242, v242, v236
v_mul_f32 v248, v248, v236
v_cvt_pk_bf16_f32 v161, v242, v248
v_lshlrev_b32 v242, 16, v162
v_and_b32 v248, 0xffff0000, v162
v_mul_f32 v242, v242, v236
v_mul_f32 v248, v248, v236
v_cvt_pk_bf16_f32 v162, v242, v248
v_lshlrev_b32 v242, 16, v163
v_and_b32 v248, 0xffff0000, v163
v_mul_f32 v242, v242, v236
v_mul_f32 v248, v248, v236
v_cvt_pk_bf16_f32 v163, v242, v248
v_exp_f32 v248, v132
s_nop 0
v_sub_f32 v225, v225, v248
v_exp_f32 v248, v133
s_nop 0
v_sub_f32 v225, v225, v248
v_exp_f32 v248, v134
s_nop 0
v_sub_f32 v225, v225, v248
v_exp_f32 v248, v135
s_nop 0
v_sub_f32 v225, v225, v248
v_max_f32 v225, 0, v225
v_min_f32 v225, s32, v225
v_log_f32 v248, v225
v_max3_f32 v233, v132, v133, v134
v_max3_f32 v233, v233, v135, v248
v_mov_b32 v248, v233
s_nop 1
v_permlane32_swap_b32 v233, v248
s_nop 1
v_max_f32 v233, v233, v248
v_mov_b32 v248, v233
s_nop 1
v_permlane16_swap_b32 v233, v248
s_nop 1
v_max_f32 v233, v233, v248
v_ceil_f32 v233, v233
v_max_f32 v233, 0, v233
v_sub_f32 v248, 0, v233
v_exp_f32 v237, v248
s_nop 1
v_mul_f32 v225, v225, v237
v_sub_f32 v196, v196, v233
v_sub_f32 v132, v132, v233
v_sub_f32 v148, v148, v233
v_sub_f32 v197, v197, v233
v_sub_f32 v133, v133, v233
v_sub_f32 v149, v149, v233
v_sub_f32 v198, v198, v233
v_sub_f32 v134, v134, v233
v_sub_f32 v150, v150, v233
v_sub_f32 v199, v199, v233
v_sub_f32 v135, v135, v233
v_sub_f32 v151, v151, v233
v_lshlrev_b32 v242, 16, v180
v_and_b32 v248, 0xffff0000, v180
v_mul_f32 v242, v242, v237
v_mul_f32 v248, v248, v237
v_cvt_pk_bf16_f32 v180, v242, v248
v_lshlrev_b32 v242, 16, v181
v_and_b32 v248, 0xffff0000, v181
v_mul_f32 v242, v242, v237
v_mul_f32 v248, v248, v237
v_cvt_pk_bf16_f32 v181, v242, v248
v_lshlrev_b32 v242, 16, v182
v_and_b32 v248, 0xffff0000, v182
v_mul_f32 v242, v242, v237
v_mul_f32 v248, v248, v237
v_cvt_pk_bf16_f32 v182, v242, v248
v_lshlrev_b32 v242, 16, v183
v_and_b32 v248, 0xffff0000, v183
v_mul_f32 v242, v242, v237
v_mul_f32 v248, v248, v237
v_cvt_pk_bf16_f32 v183, v242, v248
v_lshlrev_b32 v242, 16, v164
v_and_b32 v248, 0xffff0000, v164
v_mul_f32 v242, v242, v237
v_mul_f32 v248, v248, v237
v_cvt_pk_bf16_f32 v164, v242, v248
v_lshlrev_b32 v242, 16, v165
v_and_b32 v248, 0xffff0000, v165
v_mul_f32 v242, v242, v237
v_mul_f32 v248, v248, v237
v_cvt_pk_bf16_f32 v165, v242, v248
v_lshlrev_b32 v242, 16, v166
v_and_b32 v248, 0xffff0000, v166
v_mul_f32 v242, v242, v237
v_mul_f32 v248, v248, v237
v_cvt_pk_bf16_f32 v166, v242, v248
v_lshlrev_b32 v242, 16, v167
v_and_b32 v248, 0xffff0000, v167
v_mul_f32 v242, v242, v237
v_mul_f32 v248, v248, v237
v_cvt_pk_bf16_f32 v167, v242, v248
v_exp_f32 v248, v136
s_nop 0
v_sub_f32 v226, v226, v248
v_exp_f32 v248, v137
s_nop 0
v_sub_f32 v226, v226, v248
v_exp_f32 v248, v138
s_nop 0
v_sub_f32 v226, v226, v248
v_exp_f32 v248, v139
s_nop 0
v_sub_f32 v226, v226, v248
v_max_f32 v226, 0, v226
v_min_f32 v226, s32, v226
v_log_f32 v248, v226
v_max3_f32 v234, v136, v137, v138
v_max3_f32 v234, v234, v139, v248
v_mov_b32 v248, v234
s_nop 1
v_permlane32_swap_b32 v234, v248
s_nop 1
v_max_f32 v234, v234, v248
v_mov_b32 v248, v234
s_nop 1
v_permlane16_swap_b32 v234, v248
s_nop 1
v_max_f32 v234, v234, v248
v_ceil_f32 v234, v234
v_max_f32 v234, 0, v234
v_sub_f32 v248, 0, v234
v_exp_f32 v238, v248
s_nop 1
v_mul_f32 v226, v226, v238
v_sub_f32 v200, v200, v234
v_sub_f32 v136, v136, v234
v_sub_f32 v152, v152, v234
v_sub_f32 v201, v201, v234
v_sub_f32 v137, v137, v234
v_sub_f32 v153, v153, v234
v_sub_f32 v202, v202, v234
v_sub_f32 v138, v138, v234
v_sub_f32 v154, v154, v234
v_sub_f32 v203, v203, v234
v_sub_f32 v139, v139, v234
v_sub_f32 v155, v155, v234
v_lshlrev_b32 v242, 16, v184
v_and_b32 v248, 0xffff0000, v184
v_mul_f32 v242, v242, v238
v_mul_f32 v248, v248, v238
v_cvt_pk_bf16_f32 v184, v242, v248
v_lshlrev_b32 v242, 16, v185
v_and_b32 v248, 0xffff0000, v185
v_mul_f32 v242, v242, v238
v_mul_f32 v248, v248, v238
v_cvt_pk_bf16_f32 v185, v242, v248
v_lshlrev_b32 v242, 16, v186
v_and_b32 v248, 0xffff0000, v186
v_mul_f32 v242, v242, v238
v_mul_f32 v248, v248, v238
v_cvt_pk_bf16_f32 v186, v242, v248
v_lshlrev_b32 v242, 16, v187
v_and_b32 v248, 0xffff0000, v187
v_mul_f32 v242, v242, v238
v_mul_f32 v248, v248, v238
v_cvt_pk_bf16_f32 v187, v242, v248
v_lshlrev_b32 v242, 16, v168
v_and_b32 v248, 0xffff0000, v168
v_mul_f32 v242, v242, v238
v_mul_f32 v248, v248, v238
v_cvt_pk_bf16_f32 v168, v242, v248
v_lshlrev_b32 v242, 16, v169
v_and_b32 v248, 0xffff0000, v169
v_mul_f32 v242, v242, v238
v_mul_f32 v248, v248, v238
v_cvt_pk_bf16_f32 v169, v242, v248
v_lshlrev_b32 v242, 16, v170
v_and_b32 v248, 0xffff0000, v170
v_mul_f32 v242, v242, v238
v_mul_f32 v248, v248, v238
v_cvt_pk_bf16_f32 v170, v242, v248
v_lshlrev_b32 v242, 16, v171
v_and_b32 v248, 0xffff0000, v171
v_mul_f32 v242, v242, v238
v_mul_f32 v248, v248, v238
v_cvt_pk_bf16_f32 v171, v242, v248
v_exp_f32 v248, v140
s_nop 0
v_sub_f32 v227, v227, v248
v_exp_f32 v248, v141
s_nop 0
v_sub_f32 v227, v227, v248
v_exp_f32 v248, v142
s_nop 0
v_sub_f32 v227, v227, v248
v_exp_f32 v248, v143
s_nop 0
v_sub_f32 v227, v227, v248
v_max_f32 v227, 0, v227
v_min_f32 v227, s32, v227
v_log_f32 v248, v227
v_max3_f32 v235, v140, v141, v142
v_max3_f32 v235, v235, v143, v248
v_mov_b32 v248, v235
s_nop 1
v_permlane32_swap_b32 v235, v248
s_nop 1
v_max_f32 v235, v235, v248
v_mov_b32 v248, v235
s_nop 1
v_permlane16_swap_b32 v235, v248
s_nop 1
v_max_f32 v235, v235, v248
v_ceil_f32 v235, v235
v_max_f32 v235, 0, v235
v_sub_f32 v248, 0, v235
v_exp_f32 v239, v248
s_nop 1
v_mul_f32 v227, v227, v239
v_sub_f32 v204, v204, v235
v_sub_f32 v140, v140, v235
v_sub_f32 v156, v156, v235
v_sub_f32 v205, v205, v235
v_sub_f32 v141, v141, v235
v_sub_f32 v157, v157, v235
v_sub_f32 v206, v206, v235
v_sub_f32 v142, v142, v235
v_sub_f32 v158, v158, v235
v_sub_f32 v207, v207, v235
v_sub_f32 v143, v143, v235
v_sub_f32 v159, v159, v235
v_lshlrev_b32 v242, 16, v188
v_and_b32 v248, 0xffff0000, v188
v_mul_f32 v242, v242, v239
v_mul_f32 v248, v248, v239
v_cvt_pk_bf16_f32 v188, v242, v248
v_lshlrev_b32 v242, 16, v189
v_and_b32 v248, 0xffff0000, v189
v_mul_f32 v242, v242, v239
v_mul_f32 v248, v248, v239
v_cvt_pk_bf16_f32 v189, v242, v248
v_lshlrev_b32 v242, 16, v190
v_and_b32 v248, 0xffff0000, v190
v_mul_f32 v242, v242, v239
v_mul_f32 v248, v248, v239
v_cvt_pk_bf16_f32 v190, v242, v248
v_lshlrev_b32 v242, 16, v191
v_and_b32 v248, 0xffff0000, v191
v_mul_f32 v242, v242, v239
v_mul_f32 v248, v248, v239
v_cvt_pk_bf16_f32 v191, v242, v248
v_lshlrev_b32 v242, 16, v172
v_and_b32 v248, 0xffff0000, v172
v_mul_f32 v242, v242, v239
v_mul_f32 v248, v248, v239
v_cvt_pk_bf16_f32 v172, v242, v248
v_lshlrev_b32 v242, 16, v173
v_and_b32 v248, 0xffff0000, v173
v_mul_f32 v242, v242, v239
v_mul_f32 v248, v248, v239
v_cvt_pk_bf16_f32 v173, v242, v248
v_lshlrev_b32 v242, 16, v174
v_and_b32 v248, 0xffff0000, v174
v_mul_f32 v242, v242, v239
v_mul_f32 v248, v248, v239
v_cvt_pk_bf16_f32 v174, v242, v248
v_lshlrev_b32 v242, 16, v175
v_and_b32 v248, 0xffff0000, v175
v_mul_f32 v242, v242, v239
v_mul_f32 v248, v248, v239
v_cvt_pk_bf16_f32 v175, v242, v248
v_exp_f32 v128, v128
v_exp_f32 v129, v129
v_exp_f32 v130, v130
v_exp_f32 v131, v131
s_nop 1
v_add_f32 v224, v224, v128
v_add_f32 v224, v224, v129
v_add_f32 v224, v224, v130
v_add_f32 v224, v224, v131
v_exp_f32 v132, v132
v_exp_f32 v133, v133
v_exp_f32 v134, v134
v_exp_f32 v135, v135
s_nop 1
v_add_f32 v225, v225, v132
v_add_f32 v225, v225, v133
v_add_f32 v225, v225, v134
v_add_f32 v225, v225, v135
v_exp_f32 v136, v136
v_exp_f32 v137, v137
v_exp_f32 v138, v138
v_exp_f32 v139, v139
s_nop 1
v_add_f32 v226, v226, v136
v_add_f32 v226, v226, v137
v_add_f32 v226, v226, v138
v_add_f32 v226, v226, v139
v_exp_f32 v140, v140
v_exp_f32 v141, v141
v_exp_f32 v142, v142
v_exp_f32 v143, v143
s_nop 1
v_add_f32 v227, v227, v140
v_add_f32 v227, v227, v141
v_add_f32 v227, v227, v142
v_add_f32 v227, v227, v143
s_branch L2_rare_common
L2_rare_site3:
s_mov_b32 s36, 3
s_branch L2_rare_1_1
L2_rare_1_1:
s_nop 15
s_nop 15
s_waitcnt lgkmcnt(0)
v_add_u32 v250, 0x0, v240
v_and_b32 v250, 0x1ffff, v250
ds_read_b128 v[232:235], v250 offset:2048
s_waitcnt lgkmcnt(0)
v_mfma_f32_16x16x32_bf16 v[144:147], v[232:235], v[0:3], v[192:195]
v_mfma_f32_16x16x32_bf16 v[148:151], v[232:235], v[32:35], v[196:199]
v_mfma_f32_16x16x32_bf16 v[152:155], v[232:235], v[64:67], v[200:203]
v_mfma_f32_16x16x32_bf16 v[156:159], v[232:235], v[96:99], v[204:207]
s_nop 7
ds_read_b128 v[232:235], v250 offset:2560
s_waitcnt lgkmcnt(0)
v_mfma_f32_16x16x32_bf16 v[144:147], v[232:235], v[4:7], v[144:147]
v_mfma_f32_16x16x32_bf16 v[148:151], v[232:235], v[36:39], v[148:151]
v_mfma_f32_16x16x32_bf16 v[152:155], v[232:235], v[68:71], v[152:155]
v_mfma_f32_16x16x32_bf16 v[156:159], v[232:235], v[100:103], v[156:159]
s_nop 7
ds_read_b128 v[232:235], v250 offset:6144
s_waitcnt lgkmcnt(0)
v_mfma_f32_16x16x32_bf16 v[144:147], v[232:235], v[8:11], v[144:147]
v_mfma_f32_16x16x32_bf16 v[148:151], v[232:235], v[40:43], v[148:151]
v_mfma_f32_16x16x32_bf16 v[152:155], v[232:235], v[72:75], v[152:155]
v_mfma_f32_16x16x32_bf16 v[156:159], v[232:235], v[104:107], v[156:159]
s_nop 7
ds_read_b128 v[232:235], v250 offset:6656
s_waitcnt lgkmcnt(0)
v_mfma_f32_16x16x32_bf16 v[144:147], v[232:235], v[12:15], v[144:147]
v_mfma_f32_16x16x32_bf16 v[148:151], v[232:235], v[44:47], v[148:151]
v_mfma_f32_16x16x32_bf16 v[152:155], v[232:235], v[76:79], v[152:155]
v_mfma_f32_16x16x32_bf16 v[156:159], v[232:235], v[108:111], v[156:159]
s_nop 7
ds_read_b128 v[232:235], v250 offset:10240
s_waitcnt lgkmcnt(0)
v_mfma_f32_16x16x32_bf16 v[144:147], v[232:235], v[16:19], v[144:147]
v_mfma_f32_16x16x32_bf16 v[148:151], v[232:235], v[48:51], v[148:151]
v_mfma_f32_16x16x32_bf16 v[152:155], v[232:235], v[80:83], v[152:155]
v_mfma_f32_16x16x32_bf16 v[156:159], v[232:235], v[112:115], v[156:159]
s_nop 7
ds_read_b128 v[232:235], v250 offset:10752
s_waitcnt lgkmcnt(0)
v_mfma_f32_16x16x32_bf16 v[144:147], v[232:235], v[20:23], v[144:147]
v_mfma_f32_16x16x32_bf16 v[148:151], v[232:235], v[52:55], v[148:151]
v_mfma_f32_16x16x32_bf16 v[152:155], v[232:235], v[84:87], v[152:155]
v_mfma_f32_16x16x32_bf16 v[156:159], v[232:235], v[116:119], v[156:159]
s_nop 7
ds_read_b128 v[232:235], v250 offset:14336
s_waitcnt lgkmcnt(0)
v_mfma_f32_16x16x32_bf16 v[144:147], v[232:235], v[24:27], v[144:147]
v_mfma_f32_16x16x32_bf16 v[148:151], v[232:235], v[56:59], v[148:151]
v_mfma_f32_16x16x32_bf16 v[152:155], v[232:235], v[88:91], v[152:155]
v_mfma_f32_16x16x32_bf16 v[156:159], v[232:235], v[120:123], v[156:159]
s_nop 7
ds_read_b128 v[232:235], v250 offset:14848
s_waitcnt lgkmcnt(0)
v_mfma_f32_16x16x32_bf16 v[144:147], v[232:235], v[28:31], v[144:147]
v_mfma_f32_16x16x32_bf16 v[148:151], v[232:235], v[60:63], v[148:151]
v_mfma_f32_16x16x32_bf16 v[152:155], v[232:235], v[92:95], v[152:155]
v_mfma_f32_16x16x32_bf16 v[156:159], v[232:235], v[124:127], v[156:159]
s_nop 7
s_nop 7
v_exp_f32 v248, v144
s_nop 0
v_sub_f32 v224, v224, v248
v_exp_f32 v248, v145
s_nop 0
v_sub_f32 v224, v224, v248
v_exp_f32 v248, v146
s_nop 0
v_sub_f32 v224, v224, v248
v_exp_f32 v248, v147
s_nop 0
v_sub_f32 v224, v224, v248
v_max_f32 v224, 0, v224
v_min_f32 v224, s32, v224
v_log_f32 v248, v224
v_max3_f32 v232, v144, v145, v146
v_max3_f32 v232, v232, v147, v248
v_mov_b32 v248, v232
s_nop 1
v_permlane32_swap_b32 v232, v248
s_nop 1
v_max_f32 v232, v232, v248
v_mov_b32 v248, v232
s_nop 1
v_permlane16_swap_b32 v232, v248
s_nop 1
v_max_f32 v232, v232, v248
v_ceil_f32 v232, v232
v_max_f32 v232, 0, v232
v_sub_f32 v248, 0, v232
v_exp_f32 v236, v248
s_nop 1
v_mul_f32 v224, v224, v236
v_sub_f32 v192, v192, v232
v_sub_f32 v128, v128, v232
v_sub_f32 v144, v144, v232
v_sub_f32 v193, v193, v232
v_sub_f32 v129, v129, v232
v_sub_f32 v145, v145, v232
v_sub_f32 v194, v194, v232
v_sub_f32 v130, v130, v232
v_sub_f32 v146, v146, v232
v_sub_f32 v195, v195, v232
v_sub_f32 v131, v131, v232
v_sub_f32 v147, v147, v232
v_lshlrev_b32 v242, 16, v176
v_and_b32 v248, 0xffff0000, v176
v_mul_f32 v242, v242, v236
v_mul_f32 v248, v248, v236
v_cvt_pk_bf16_f32 v176, v242, v248
v_lshlrev_b32 v242, 16, v177
v_and_b32 v248, 0xffff0000, v177
v_mul_f32 v242, v242, v236
v_mul_f32 v248, v248, v236
v_cvt_pk_bf16_f32 v177, v242, v248
v_lshlrev_b32 v242, 16, v178
v_and_b32 v248, 0xffff0000, v178
v_mul_f32 v242, v242, v236
v_mul_f32 v248, v248, v236
v_cvt_pk_bf16_f32 v178, v242, v248
v_lshlrev_b32 v242, 16, v179
v_and_b32 v248, 0xffff0000, v179
v_mul_f32 v242, v242, v236
v_mul_f32 v248, v248, v236
v_cvt_pk_bf16_f32 v179, v242, v248
v_lshlrev_b32 v242, 16, v160
v_and_b32 v248, 0xffff0000, v160
v_mul_f32 v242, v242, v236
v_mul_f32 v248, v248, v236
v_cvt_pk_bf16_f32 v160, v242, v248
v_lshlrev_b32 v242, 16, v161
v_and_b32 v248, 0xffff0000, v161
v_mul_f32 v242, v242, v236
v_mul_f32 v248, v248, v236
v_cvt_pk_bf16_f32 v161, v242, v248
v_exp_f32 v248, v148
s_nop 0
v_sub_f32 v225, v225, v248
v_exp_f32 v248, v149
s_nop 0
v_sub_f32 v225, v225, v248
v_exp_f32 v248, v150
s_nop 0
v_sub_f32 v225, v225, v248
v_exp_f32 v248, v151
s_nop 0
v_sub_f32 v225, v225, v248
v_max_f32 v225, 0, v225
v_min_f32 v225, s32, v225
v_log_f32 v248, v225
v_max3_f32 v233, v148, v149, v150
v_max3_f32 v233, v233, v151, v248
v_mov_b32 v248, v233
s_nop 1
v_permlane32_swap_b32 v233, v248
s_nop 1
v_max_f32 v233, v233, v248
v_mov_b32 v248, v233
s_nop 1
v_permlane16_swap_b32 v233, v248
s_nop 1
v_max_f32 v233, v233, v248
v_ceil_f32 v233, v233
v_max_f32 v233, 0, v233
v_sub_f32 v248, 0, v233
v_exp_f32 v237, v248
s_nop 1
v_mul_f32 v225, v225, v237
v_sub_f32 v196, v196, v233
v_sub_f32 v132, v132, v233
v_sub_f32 v148, v148, v233
v_sub_f32 v197, v197, v233
v_sub_f32 v133, v133, v233
v_sub_f32 v149, v149, v233
v_sub_f32 v198, v198, v233
v_sub_f32 v134, v134, v233
v_sub_f32 v150, v150, v233
v_sub_f32 v199, v199, v233
v_sub_f32 v135, v135, v233
v_sub_f32 v151, v151, v233
v_lshlrev_b32 v242, 16, v180
v_and_b32 v248, 0xffff0000, v180
v_mul_f32 v242, v242, v237
v_mul_f32 v248, v248, v237
v_cvt_pk_bf16_f32 v180, v242, v248
v_lshlrev_b32 v242, 16, v181
v_and_b32 v248, 0xffff0000, v181
v_mul_f32 v242, v242, v237
v_mul_f32 v248, v248, v237
v_cvt_pk_bf16_f32 v181, v242, v248
v_lshlrev_b32 v242, 16, v182
v_and_b32 v248, 0xffff0000, v182
v_mul_f32 v242, v242, v237
v_mul_f32 v248, v248, v237
v_cvt_pk_bf16_f32 v182, v242, v248
v_lshlrev_b32 v242, 16, v183
v_and_b32 v248, 0xffff0000, v183
v_mul_f32 v242, v242, v237
v_mul_f32 v248, v248, v237
v_cvt_pk_bf16_f32 v183, v242, v248
v_lshlrev_b32 v242, 16, v164
v_and_b32 v248, 0xffff0000, v164
v_mul_f32 v242, v242, v237
v_mul_f32 v248, v248, v237
v_cvt_pk_bf16_f32 v164, v242, v248
v_lshlrev_b32 v242, 16, v165
v_and_b32 v248, 0xffff0000, v165
v_mul_f32 v242, v242, v237
v_mul_f32 v248, v248, v237
v_cvt_pk_bf16_f32 v165, v242, v248
v_exp_f32 v248, v152
s_nop 0
v_sub_f32 v226, v226, v248
v_exp_f32 v248, v153
s_nop 0
v_sub_f32 v226, v226, v248
v_exp_f32 v248, v154
s_nop 0
v_sub_f32 v226, v226, v248
v_exp_f32 v248, v155
s_nop 0
v_sub_f32 v226, v226, v248
v_max_f32 v226, 0, v226
v_min_f32 v226, s32, v226
v_log_f32 v248, v226
v_max3_f32 v234, v152, v153, v154
v_max3_f32 v234, v234, v155, v248
v_mov_b32 v248, v234
s_nop 1
v_permlane32_swap_b32 v234, v248
s_nop 1
v_max_f32 v234, v234, v248
v_mov_b32 v248, v234
s_nop 1
v_permlane16_swap_b32 v234, v248
s_nop 1
v_max_f32 v234, v234, v248
v_ceil_f32 v234, v234
v_max_f32 v234, 0, v234
v_sub_f32 v248, 0, v234
v_exp_f32 v238, v248
s_nop 1
v_mul_f32 v226, v226, v238
v_sub_f32 v200, v200, v234
v_sub_f32 v136, v136, v234
v_sub_f32 v152, v152, v234
v_sub_f32 v201, v201, v234
v_sub_f32 v137, v137, v234
v_sub_f32 v153, v153, v234
v_sub_f32 v202, v202, v234
v_sub_f32 v138, v138, v234
v_sub_f32 v154, v154, v234
v_sub_f32 v203, v203, v234
v_sub_f32 v139, v139, v234
v_sub_f32 v155, v155, v234
v_lshlrev_b32 v242, 16, v184
v_and_b32 v248, 0xffff0000, v184
v_mul_f32 v242, v242, v238
v_mul_f32 v248, v248, v238
v_cvt_pk_bf16_f32 v184, v242, v248
v_lshlrev_b32 v242, 16, v185
v_and_b32 v248, 0xffff0000, v185
v_mul_f32 v242, v242, v238
v_mul_f32 v248, v248, v238
v_cvt_pk_bf16_f32 v185, v242, v248
v_lshlrev_b32 v242, 16, v186
v_and_b32 v248, 0xffff0000, v186
v_mul_f32 v242, v242, v238
v_mul_f32 v248, v248, v238
v_cvt_pk_bf16_f32 v186, v242, v248
v_lshlrev_b32 v242, 16, v187
v_and_b32 v248, 0xffff0000, v187
v_mul_f32 v242, v242, v238
v_mul_f32 v248, v248, v238
v_cvt_pk_bf16_f32 v187, v242, v248
v_lshlrev_b32 v242, 16, v168
v_and_b32 v248, 0xffff0000, v168
v_mul_f32 v242, v242, v238
v_mul_f32 v248, v248, v238
v_cvt_pk_bf16_f32 v168, v242, v248
v_lshlrev_b32 v242, 16, v169
v_and_b32 v248, 0xffff0000, v169
v_mul_f32 v242, v242, v238
v_mul_f32 v248, v248, v238
v_cvt_pk_bf16_f32 v169, v242, v248
v_exp_f32 v248, v156
s_nop 0
v_sub_f32 v227, v227, v248
v_exp_f32 v248, v157
s_nop 0
v_sub_f32 v227, v227, v248
v_exp_f32 v248, v158
s_nop 0
v_sub_f32 v227, v227, v248
v_exp_f32 v248, v159
s_nop 0
v_sub_f32 v227, v227, v248
v_max_f32 v227, 0, v227
v_min_f32 v227, s32, v227
v_log_f32 v248, v227
v_max3_f32 v235, v156, v157, v158
v_max3_f32 v235, v235, v159, v248
v_mov_b32 v248, v235
s_nop 1
v_permlane32_swap_b32 v235, v248
s_nop 1
v_max_f32 v235, v235, v248
v_mov_b32 v248, v235
s_nop 1
v_permlane16_swap_b32 v235, v248
s_nop 1
v_max_f32 v235, v235, v248
v_ceil_f32 v235, v235
v_max_f32 v235, 0, v235
v_sub_f32 v248, 0, v235
v_exp_f32 v239, v248
s_nop 1
v_mul_f32 v227, v227, v239
v_sub_f32 v204, v204, v235
v_sub_f32 v140, v140, v235
v_sub_f32 v156, v156, v235
v_sub_f32 v205, v205, v235
v_sub_f32 v141, v141, v235
v_sub_f32 v157, v157, v235
v_sub_f32 v206, v206, v235
v_sub_f32 v142, v142, v235
v_sub_f32 v158, v158, v235
v_sub_f32 v207, v207, v235
v_sub_f32 v143, v143, v235
v_sub_f32 v159, v159, v235
v_lshlrev_b32 v242, 16, v188
v_and_b32 v248, 0xffff0000, v188
v_mul_f32 v242, v242, v239
v_mul_f32 v248, v248, v239
v_cvt_pk_bf16_f32 v188, v242, v248
v_lshlrev_b32 v242, 16, v189
v_and_b32 v248, 0xffff0000, v189
v_mul_f32 v242, v242, v239
v_mul_f32 v248, v248, v239
v_cvt_pk_bf16_f32 v189, v242, v248
v_lshlrev_b32 v242, 16, v190
v_and_b32 v248, 0xffff0000, v190
v_mul_f32 v242, v242, v239
v_mul_f32 v248, v248, v239
v_cvt_pk_bf16_f32 v190, v242, v248
v_lshlrev_b32 v242, 16, v191
v_and_b32 v248, 0xffff0000, v191
v_mul_f32 v242, v242, v239
v_mul_f32 v248, v248, v239
v_cvt_pk_bf16_f32 v191, v242, v248
v_lshlrev_b32 v242, 16, v172
v_and_b32 v248, 0xffff0000, v172
v_mul_f32 v242, v242, v239
v_mul_f32 v248, v248, v239
v_cvt_pk_bf16_f32 v172, v242, v248
v_lshlrev_b32 v242, 16, v173
v_and_b32 v248, 0xffff0000, v173
v_mul_f32 v242, v242, v239
v_mul_f32 v248, v248, v239
v_cvt_pk_bf16_f32 v173, v242, v248
v_exp_f32 v144, v144
v_exp_f32 v145, v145
v_exp_f32 v146, v146
v_exp_f32 v147, v147
s_nop 1
v_add_f32 v224, v224, v144
v_add_f32 v224, v224, v145
v_add_f32 v224, v224, v146
v_add_f32 v224, v224, v147
v_exp_f32 v148, v148
v_exp_f32 v149, v149
v_exp_f32 v150, v150
v_exp_f32 v151, v151
s_nop 1
v_add_f32 v225, v225, v148
v_add_f32 v225, v225, v149
v_add_f32 v225, v225, v150
v_add_f32 v225, v225, v151
v_exp_f32 v152, v152
v_exp_f32 v153, v153
v_exp_f32 v154, v154
v_exp_f32 v155, v155
s_nop 1
v_add_f32 v226, v226, v152
v_add_f32 v226, v226, v153
v_add_f32 v226, v226, v154
v_add_f32 v226, v226, v155
v_exp_f32 v156, v156
v_exp_f32 v157, v157
v_exp_f32 v158, v158
v_exp_f32 v159, v159
s_nop 1
v_add_f32 v227, v227, v156
v_add_f32 v227, v227, v157
v_add_f32 v227, v227, v158
v_add_f32 v227, v227, v159
s_branch L2_rare_common
L2_rare_site6:
s_mov_b32 s36, 6
s_branch L2_rare_t1_0_0
L2_rare_t1_0_0:
s_nop 15
s_nop 15
s_waitcnt lgkmcnt(0)
v_exp_f32 v248, v128
s_nop 0
v_sub_f32 v224, v224, v248
v_exp_f32 v248, v129
s_nop 0
v_sub_f32 v224, v224, v248
v_exp_f32 v248, v130
s_nop 0
v_sub_f32 v224, v224, v248
v_exp_f32 v248, v131
s_nop 0
v_sub_f32 v224, v224, v248
v_max_f32 v224, 0, v224
v_min_f32 v224, s32, v224
v_log_f32 v248, v224
v_max3_f32 v232, v128, v129, v130
v_max3_f32 v232, v232, v131, v248
v_mov_b32 v248, v232
s_nop 1
v_permlane32_swap_b32 v232, v248
s_nop 1
v_max_f32 v232, v232, v248
v_mov_b32 v248, v232
s_nop 1
v_permlane16_swap_b32 v232, v248
s_nop 1
v_max_f32 v232, v232, v248
v_ceil_f32 v232, v232
v_max_f32 v232, 0, v232
v_sub_f32 v248, 0, v232
v_exp_f32 v236, v248
s_nop 1
v_mul_f32 v224, v224, v236
v_sub_f32 v192, v192, v232
v_sub_f32 v128, v128, v232
v_sub_f32 v144, v144, v232
v_sub_f32 v193, v193, v232
v_sub_f32 v129, v129, v232
v_sub_f32 v145, v145, v232
v_sub_f32 v194, v194, v232
v_sub_f32 v130, v130, v232
v_sub_f32 v146, v146, v232
v_sub_f32 v195, v195, v232
v_sub_f32 v131, v131, v232
v_sub_f32 v147, v147, v232
v_lshlrev_b32 v242, 16, v160
v_and_b32 v248, 0xffff0000, v160
v_mul_f32 v242, v242, v236
v_mul_f32 v248, v248, v236
v_cvt_pk_bf16_f32 v160, v242, v248
v_lshlrev_b32 v242, 16, v161
v_and_b32 v248, 0xffff0000, v161
v_mul_f32 v242, v242, v236
v_mul_f32 v248, v248, v236
v_cvt_pk_bf16_f32 v161, v242, v248
v_lshlrev_b32 v242, 16, v162
v_and_b32 v248, 0xffff0000, v162
v_mul_f32 v242, v242, v236
v_mul_f32 v248, v248, v236
v_cvt_pk_bf16_f32 v162, v242, v248
v_lshlrev_b32 v242, 16, v163
v_and_b32 v248, 0xffff0000, v163
v_mul_f32 v242, v242, v236
v_mul_f32 v248, v248, v236
v_cvt_pk_bf16_f32 v163, v242, v248
ds_read_b64 v[250:251], v231 offset:0
s_waitcnt lgkmcnt(0)
v_lshlrev_b32 v242, 16, v250
v_and_b32 v248, 0xffff0000, v250
v_mul_f32 v242, v242, v236
v_mul_f32 v248, v248, v236
v_cvt_pk_bf16_f32 v250, v242, v248
v_lshlrev_b32 v242, 16, v251
v_and_b32 v248, 0xffff0000, v251
v_mul_f32 v242, v242, v236
v_mul_f32 v248, v248, v236
v_cvt_pk_bf16_f32 v251, v242, v248
ds_write_b64 v231, v[250:251] offset:0
s_waitcnt lgkmcnt(0)
ds_read_b64 v[250:251], v231 offset:8
s_waitcnt lgkmcnt(0)
v_lshlrev_b32 v242, 16, v250
v_and_b32 v248, 0xffff0000, v250
v_mul_f32 v242, v242, v236
v_mul_f32 v248, v248, v236
v_cvt_pk_bf16_f32 v250, v242, v248
v_lshlrev_b32 v242, 16, v251
v_and_b32 v248, 0xffff0000, v251
v_mul_f32 v242, v242, v236
v_mul_f32 v248, v248, v236
v_cvt_pk_bf16_f32 v251, v242, v248
ds_write_b64 v231, v[250:251] offset:8
s_waitcnt lgkmcnt(0)
v_exp_f32 v248, v132
s_nop 0
v_sub_f32 v225, v225, v248
v_exp_f32 v248, v133
s_nop 0
v_sub_f32 v225, v225, v248
v_exp_f32 v248, v134
s_nop 0
v_sub_f32 v225, v225, v248
v_exp_f32 v248, v135
s_nop 0
v_sub_f32 v225, v225, v248
v_max_f32 v225, 0, v225
v_min_f32 v225, s32, v225
v_log_f32 v248, v225
v_max3_f32 v233, v132, v133, v134
v_max3_f32 v233, v233, v135, v248
v_mov_b32 v248, v233
s_nop 1
v_permlane32_swap_b32 v233, v248
s_nop 1
v_max_f32 v233, v233, v248
v_mov_b32 v248, v233
s_nop 1
v_permlane16_swap_b32 v233, v248
s_nop 1
v_max_f32 v233, v233, v248
v_ceil_f32 v233, v233
v_max_f32 v233, 0, v233
v_sub_f32 v248, 0, v233
v_exp_f32 v237, v248
s_nop 1
v_mul_f32 v225, v225, v237
v_sub_f32 v196, v196, v233
v_sub_f32 v132, v132, v233
v_sub_f32 v148, v148, v233
v_sub_f32 v197, v197, v233
v_sub_f32 v133, v133, v233
v_sub_f32 v149, v149, v233
v_sub_f32 v198, v198, v233
v_sub_f32 v134, v134, v233
v_sub_f32 v150, v150, v233
v_sub_f32 v199, v199, v233
v_sub_f32 v135, v135, v233
v_sub_f32 v151, v151, v233
v_lshlrev_b32 v242, 16, v164
v_and_b32 v248, 0xffff0000, v164
v_mul_f32 v242, v242, v237
v_mul_f32 v248, v248, v237
v_cvt_pk_bf16_f32 v164, v242, v248
v_lshlrev_b32 v242, 16, v165
v_and_b32 v248, 0xffff0000, v165
v_mul_f32 v242, v242, v237
v_mul_f32 v248, v248, v237
v_cvt_pk_bf16_f32 v165, v242, v248
v_lshlrev_b32 v242, 16, v166
v_and_b32 v248, 0xffff0000, v166
v_mul_f32 v242, v242, v237
v_mul_f32 v248, v248, v237
v_cvt_pk_bf16_f32 v166, v242, v248
v_lshlrev_b32 v242, 16, v167
v_and_b32 v248, 0xffff0000, v167
v_mul_f32 v242, v242, v237
v_mul_f32 v248, v248, v237
v_cvt_pk_bf16_f32 v167, v242, v248
ds_read_b64 v[250:251], v231 offset:1024
s_waitcnt lgkmcnt(0)
v_lshlrev_b32 v242, 16, v250
v_and_b32 v248, 0xffff0000, v250
v_mul_f32 v242, v242, v237
v_mul_f32 v248, v248, v237
v_cvt_pk_bf16_f32 v250, v242, v248
v_lshlrev_b32 v242, 16, v251
v_and_b32 v248, 0xffff0000, v251
v_mul_f32 v242, v242, v237
v_mul_f32 v248, v248, v237
v_cvt_pk_bf16_f32 v251, v242, v248
ds_write_b64 v231, v[250:251] offset:1024
s_waitcnt lgkmcnt(0)
ds_read_b64 v[250:251], v231 offset:1032
s_waitcnt lgkmcnt(0)
v_lshlrev_b32 v242, 16, v250
v_and_b32 v248, 0xffff0000, v250
v_mul_f32 v242, v242, v237
v_mul_f32 v248, v248, v237
v_cvt_pk_bf16_f32 v250, v242, v248
v_lshlrev_b32 v242, 16, v251
v_and_b32 v248, 0xffff0000, v251
v_mul_f32 v242, v242, v237
v_mul_f32 v248, v248, v237
v_cvt_pk_bf16_f32 v251, v242, v248
ds_write_b64 v231, v[250:251] offset:1032
s_waitcnt lgkmcnt(0)
v_exp_f32 v248, v136
s_nop 0
v_sub_f32 v226, v226, v248
v_exp_f32 v248, v137
s_nop 0
v_sub_f32 v226, v226, v248
v_exp_f32 v248, v138
s_nop 0
v_sub_f32 v226, v226, v248
v_exp_f32 v248, v139
s_nop 0
v_sub_f32 v226, v226, v248
v_max_f32 v226, 0, v226
v_min_f32 v226, s32, v226
v_log_f32 v248, v226
v_max3_f32 v234, v136, v137, v138
v_max3_f32 v234, v234, v139, v248
v_mov_b32 v248, v234
s_nop 1
v_permlane32_swap_b32 v234, v248
s_nop 1
v_max_f32 v234, v234, v248
v_mov_b32 v248, v234
s_nop 1
v_permlane16_swap_b32 v234, v248
s_nop 1
v_max_f32 v234, v234, v248
v_ceil_f32 v234, v234
v_max_f32 v234, 0, v234
v_sub_f32 v248, 0, v234
v_exp_f32 v238, v248
s_nop 1
v_mul_f32 v226, v226, v238
v_sub_f32 v200, v200, v234
v_sub_f32 v136, v136, v234
v_sub_f32 v152, v152, v234
v_sub_f32 v201, v201, v234
v_sub_f32 v137, v137, v234
v_sub_f32 v153, v153, v234
v_sub_f32 v202, v202, v234
v_sub_f32 v138, v138, v234
v_sub_f32 v154, v154, v234
v_sub_f32 v203, v203, v234
v_sub_f32 v139, v139, v234
v_sub_f32 v155, v155, v234
v_lshlrev_b32 v242, 16, v168
v_and_b32 v248, 0xffff0000, v168
v_mul_f32 v242, v242, v238
v_mul_f32 v248, v248, v238
v_cvt_pk_bf16_f32 v168, v242, v248
v_lshlrev_b32 v242, 16, v169
v_and_b32 v248, 0xffff0000, v169
v_mul_f32 v242, v242, v238
v_mul_f32 v248, v248, v238
v_cvt_pk_bf16_f32 v169, v242, v248
v_lshlrev_b32 v242, 16, v170
v_and_b32 v248, 0xffff0000, v170
v_mul_f32 v242, v242, v238
v_mul_f32 v248, v248, v238
v_cvt_pk_bf16_f32 v170, v242, v248
v_lshlrev_b32 v242, 16, v171
v_and_b32 v248, 0xffff0000, v171
v_mul_f32 v242, v242, v238
v_mul_f32 v248, v248, v238
v_cvt_pk_bf16_f32 v171, v242, v248
ds_read_b64 v[250:251], v231 offset:2048
s_waitcnt lgkmcnt(0)
v_lshlrev_b32 v242, 16, v250
v_and_b32 v248, 0xffff0000, v250
v_mul_f32 v242, v242, v238
v_mul_f32 v248, v248, v238
v_cvt_pk_bf16_f32 v250, v242, v248
v_lshlrev_b32 v242, 16, v251
v_and_b32 v248, 0xffff0000, v251
v_mul_f32 v242, v242, v238
v_mul_f32 v248, v248, v238
v_cvt_pk_bf16_f32 v251, v242, v248
ds_write_b64 v231, v[250:251] offset:2048
s_waitcnt lgkmcnt(0)
ds_read_b64 v[250:251], v231 offset:2056
s_waitcnt lgkmcnt(0)
v_lshlrev_b32 v242, 16, v250
v_and_b32 v248, 0xffff0000, v250
v_mul_f32 v242, v242, v238
v_mul_f32 v248, v248, v238
v_cvt_pk_bf16_f32 v250, v242, v248
v_lshlrev_b32 v242, 16, v251
v_and_b32 v248, 0xffff0000, v251
v_mul_f32 v242, v242, v238
v_mul_f32 v248, v248, v238
v_cvt_pk_bf16_f32 v251, v242, v248
ds_write_b64 v231, v[250:251] offset:2056
s_waitcnt lgkmcnt(0)
v_exp_f32 v248, v140
s_nop 0
v_sub_f32 v227, v227, v248
v_exp_f32 v248, v141
s_nop 0
v_sub_f32 v227, v227, v248
v_exp_f32 v248, v142
s_nop 0
v_sub_f32 v227, v227, v248
v_exp_f32 v248, v143
s_nop 0
v_sub_f32 v227, v227, v248
v_max_f32 v227, 0, v227
v_min_f32 v227, s32, v227
v_log_f32 v248, v227
v_max3_f32 v235, v140, v141, v142
v_max3_f32 v235, v235, v143, v248
v_mov_b32 v248, v235
s_nop 1
v_permlane32_swap_b32 v235, v248
s_nop 1
v_max_f32 v235, v235, v248
v_mov_b32 v248, v235
s_nop 1
v_permlane16_swap_b32 v235, v248
s_nop 1
v_max_f32 v235, v235, v248
v_ceil_f32 v235, v235
v_max_f32 v235, 0, v235
v_sub_f32 v248, 0, v235
v_exp_f32 v239, v248
s_nop 1
v_mul_f32 v227, v227, v239
v_sub_f32 v204, v204, v235
v_sub_f32 v140, v140, v235
v_sub_f32 v156, v156, v235
v_sub_f32 v205, v205, v235
v_sub_f32 v141, v141, v235
v_sub_f32 v157, v157, v235
v_sub_f32 v206, v206, v235
v_sub_f32 v142, v142, v235
v_sub_f32 v158, v158, v235
v_sub_f32 v207, v207, v235
v_sub_f32 v143, v143, v235
v_sub_f32 v159, v159, v235
v_lshlrev_b32 v242, 16, v172
v_and_b32 v248, 0xffff0000, v172
v_mul_f32 v242, v242, v239
v_mul_f32 v248, v248, v239
v_cvt_pk_bf16_f32 v172, v242, v248
v_lshlrev_b32 v242, 16, v173
v_and_b32 v248, 0xffff0000, v173
v_mul_f32 v242, v242, v239
v_mul_f32 v248, v248, v239
v_cvt_pk_bf16_f32 v173, v242, v248
v_lshlrev_b32 v242, 16, v174
v_and_b32 v248, 0xffff0000, v174
v_mul_f32 v242, v242, v239
v_mul_f32 v248, v248, v239
v_cvt_pk_bf16_f32 v174, v242, v248
v_lshlrev_b32 v242, 16, v175
v_and_b32 v248, 0xffff0000, v175
v_mul_f32 v242, v242, v239
v_mul_f32 v248, v248, v239
v_cvt_pk_bf16_f32 v175, v242, v248
ds_read_b64 v[250:251], v231 offset:3072
s_waitcnt lgkmcnt(0)
v_lshlrev_b32 v242, 16, v250
v_and_b32 v248, 0xffff0000, v250
v_mul_f32 v242, v242, v239
v_mul_f32 v248, v248, v239
v_cvt_pk_bf16_f32 v250, v242, v248
v_lshlrev_b32 v242, 16, v251
v_and_b32 v248, 0xffff0000, v251
v_mul_f32 v242, v242, v239
v_mul_f32 v248, v248, v239
v_cvt_pk_bf16_f32 v251, v242, v248
ds_write_b64 v231, v[250:251] offset:3072
s_waitcnt lgkmcnt(0)
ds_read_b64 v[250:251], v231 offset:3080
s_waitcnt lgkmcnt(0)
v_lshlrev_b32 v242, 16, v250
v_and_b32 v248, 0xffff0000, v250
v_mul_f32 v242, v242, v239
v_mul_f32 v248, v248, v239
v_cvt_pk_bf16_f32 v250, v242, v248
v_lshlrev_b32 v242, 16, v251
v_and_b32 v248, 0xffff0000, v251
v_mul_f32 v242, v242, v239
v_mul_f32 v248, v248, v239
v_cvt_pk_bf16_f32 v251, v242, v248
ds_write_b64 v231, v[250:251] offset:3080
s_waitcnt lgkmcnt(0)
v_exp_f32 v232, v128
v_exp_f32 v233, v129
v_exp_f32 v234, v130
v_exp_f32 v235, v131
s_nop 1
v_add_f32 v224, v224, v232
v_add_f32 v224, v224, v233
v_add_f32 v224, v224, v234
v_add_f32 v224, v224, v235
v_cvt_pk_bf16_f32 v176, v232, v233
v_cvt_pk_bf16_f32 v177, v234, v235
v_exp_f32 v232, v132
v_exp_f32 v233, v133
v_exp_f32 v234, v134
v_exp_f32 v235, v135
s_nop 1
v_add_f32 v225, v225, v232
v_add_f32 v225, v225, v233
v_add_f32 v225, v225, v234
v_add_f32 v225, v225, v235
v_cvt_pk_bf16_f32 v180, v232, v233
v_cvt_pk_bf16_f32 v181, v234, v235
v_exp_f32 v232, v136
v_exp_f32 v233, v137
v_exp_f32 v234, v138
v_exp_f32 v235, v139
s_nop 1
v_add_f32 v226, v226, v232
v_add_f32 v226, v226, v233
v_add_f32 v226, v226, v234
v_add_f32 v226, v226, v235
v_cvt_pk_bf16_f32 v184, v232, v233
v_cvt_pk_bf16_f32 v185, v234, v235
v_exp_f32 v232, v140
v_exp_f32 v233, v141
v_exp_f32 v234, v142
v_exp_f32 v235, v143
s_nop 1
v_add_f32 v227, v227, v232
v_add_f32 v227, v227, v233
v_add_f32 v227, v227, v234
v_add_f32 v227, v227, v235
v_cvt_pk_bf16_f32 v188, v232, v233
v_cvt_pk_bf16_f32 v189, v234, v235
s_branch L2_rare_common
L2_rare_site7:
s_mov_b32 s36, 7
s_branch L2_rare_t1_1_1
L2_rare_t1_1_1:
s_nop 15
s_nop 15
s_waitcnt lgkmcnt(0)
v_exp_f32 v248, v144
s_nop 0
v_sub_f32 v224, v224, v248
v_exp_f32 v248, v145
s_nop 0
v_sub_f32 v224, v224, v248
v_exp_f32 v248, v146
s_nop 0
v_sub_f32 v224, v224, v248
v_exp_f32 v248, v147
s_nop 0
v_sub_f32 v224, v224, v248
v_max_f32 v224, 0, v224
v_min_f32 v224, s32, v224
v_log_f32 v248, v224
v_max3_f32 v232, v144, v145, v146
v_max3_f32 v232, v232, v147, v248
v_mov_b32 v248, v232
s_nop 1
v_permlane32_swap_b32 v232, v248
s_nop 1
v_max_f32 v232, v232, v248
v_mov_b32 v248, v232
s_nop 1
v_permlane16_swap_b32 v232, v248
s_nop 1
v_max_f32 v232, v232, v248
v_ceil_f32 v232, v232
v_max_f32 v232, 0, v232
v_sub_f32 v248, 0, v232
v_exp_f32 v236, v248
s_nop 1
v_mul_f32 v224, v224, v236
v_sub_f32 v192, v192, v232
v_sub_f32 v128, v128, v232
v_sub_f32 v144, v144, v232
v_sub_f32 v193, v193, v232
v_sub_f32 v129, v129, v232
v_sub_f32 v145, v145, v232
v_sub_f32 v194, v194, v232
v_sub_f32 v130, v130, v232
v_sub_f32 v146, v146, v232
v_sub_f32 v195, v195, v232
v_sub_f32 v131, v131, v232
v_sub_f32 v147, v147, v232
v_lshlrev_b32 v242, 16, v176
v_and_b32 v248, 0xffff0000, v176
v_mul_f32 v242, v242, v236
v_mul_f32 v248, v248, v236
v_cvt_pk_bf16_f32 v176, v242, v248
v_lshlrev_b32 v242, 16, v177
v_and_b32 v248, 0xffff0000, v177
v_mul_f32 v242, v242, v236
v_mul_f32 v248, v248, v236
v_cvt_pk_bf16_f32 v177, v242, v248
ds_read_b64 v[250:251], v231 offset:0
s_waitcnt lgkmcnt(0)
v_lshlrev_b32 v242, 16, v250
v_and_b32 v248, 0xffff0000, v250
v_mul_f32 v242, v242, v236
v_mul_f32 v248, v248, v236
v_cvt_pk_bf16_f32 v250, v242, v248
v_lshlrev_b32 v242, 16, v251
v_and_b32 v248, 0xffff0000, v251
v_mul_f32 v242, v242, v236
v_mul_f32 v248, v248, v236
v_cvt_pk_bf16_f32 v251, v242, v248
ds_write_b64 v231, v[250:251] offset:0
s_waitcnt lgkmcnt(0)
ds_read_b64 v[250:251], v231 offset:8
s_waitcnt lgkmcnt(0)
v_lshlrev_b32 v242, 16, v250
v_and_b32 v248, 0xffff0000, v250
v_mul_f32 v242, v242, v236
v_mul_f32 v248, v248, v236
v_cvt_pk_bf16_f32 v250, v242, v248
v_lshlrev_b32 v242, 16, v251
v_and_b32 v248, 0xffff0000, v251
v_mul_f32 v242, v242, v236
v_mul_f32 v248, v248, v236
v_cvt_pk_bf16_f32 v251, v242, v248
ds_write_b64 v231, v[250:251] offset:8
s_waitcnt lgkmcnt(0)
ds_read_b64 v[250:251], v231 offset:4096
s_waitcnt lgkmcnt(0)
v_lshlrev_b32 v242, 16, v250
v_and_b32 v248, 0xffff0000, v250
v_mul_f32 v242, v242, v236
v_mul_f32 v248, v248, v236
v_cvt_pk_bf16_f32 v250, v242, v248
v_lshlrev_b32 v242, 16, v251
v_and_b32 v248, 0xffff0000, v251
v_mul_f32 v242, v242, v236
v_mul_f32 v248, v248, v236
v_cvt_pk_bf16_f32 v251, v242, v248
ds_write_b64 v231, v[250:251] offset:4096
s_waitcnt lgkmcnt(0)
ds_read_b64 v[250:251], v231 offset:4104
s_waitcnt lgkmcnt(0)
v_lshlrev_b32 v242, 16, v250
v_and_b32 v248, 0xffff0000, v250
v_mul_f32 v242, v242, v236
v_mul_f32 v248, v248, v236
v_cvt_pk_bf16_f32 v250, v242, v248
v_lshlrev_b32 v242, 16, v251
v_and_b32 v248, 0xffff0000, v251
v_mul_f32 v242, v242, v236
v_mul_f32 v248, v248, v236
v_cvt_pk_bf16_f32 v251, v242, v248
ds_write_b64 v231, v[250:251] offset:4104
s_waitcnt lgkmcnt(0)
v_exp_f32 v248, v148
s_nop 0
v_sub_f32 v225, v225, v248
v_exp_f32 v248, v149
s_nop 0
v_sub_f32 v225, v225, v248
v_exp_f32 v248, v150
s_nop 0
v_sub_f32 v225, v225, v248
v_exp_f32 v248, v151
s_nop 0
v_sub_f32 v225, v225, v248
v_max_f32 v225, 0, v225
v_min_f32 v225, s32, v225
v_log_f32 v248, v225
v_max3_f32 v233, v148, v149, v150
v_max3_f32 v233, v233, v151, v248
v_mov_b32 v248, v233
s_nop 1
v_permlane32_swap_b32 v233, v248
s_nop 1
v_max_f32 v233, v233, v248
v_mov_b32 v248, v233
s_nop 1
v_permlane16_swap_b32 v233, v248
s_nop 1
v_max_f32 v233, v233, v248
v_ceil_f32 v233, v233
v_max_f32 v233, 0, v233
v_sub_f32 v248, 0, v233
v_exp_f32 v237, v248
s_nop 1
v_mul_f32 v225, v225, v237
v_sub_f32 v196, v196, v233
v_sub_f32 v132, v132, v233
v_sub_f32 v148, v148, v233
v_sub_f32 v197, v197, v233
v_sub_f32 v133, v133, v233
v_sub_f32 v149, v149, v233
v_sub_f32 v198, v198, v233
v_sub_f32 v134, v134, v233
v_sub_f32 v150, v150, v233
v_sub_f32 v199, v199, v233
v_sub_f32 v135, v135, v233
v_sub_f32 v151, v151, v233
v_lshlrev_b32 v242, 16, v180
v_and_b32 v248, 0xffff0000, v180
v_mul_f32 v242, v242, v237
v_mul_f32 v248, v248, v237
v_cvt_pk_bf16_f32 v180, v242, v248
v_lshlrev_b32 v242, 16, v181
v_and_b32 v248, 0xffff0000, v181
v_mul_f32 v242, v242, v237
v_mul_f32 v248, v248, v237
v_cvt_pk_bf16_f32 v181, v242, v248
ds_read_b64 v[250:251], v231 offset:1024
s_waitcnt lgkmcnt(0)
v_lshlrev_b32 v242, 16, v250
v_and_b32 v248, 0xffff0000, v250
v_mul_f32 v242, v242, v237
v_mul_f32 v248, v248, v237
v_cvt_pk_bf16_f32 v250, v242, v248
v_lshlrev_b32 v242, 16, v251
v_and_b32 v248, 0xffff0000, v251
v_mul_f32 v242, v242, v237
v_mul_f32 v248, v248, v237
v_cvt_pk_bf16_f32 v251, v242, v248
ds_write_b64 v231, v[250:251] offset:1024
s_waitcnt lgkmcnt(0)
ds_read_b64 v[250:251], v231 offset:1032
s_waitcnt lgkmcnt(0)
v_lshlrev_b32 v242, 16, v250
v_and_b32 v248, 0xffff0000, v250
v_mul_f32 v242, v242, v237
v_mul_f32 v248, v248, v237
v_cvt_pk_bf16_f32 v250, v242, v248
v_lshlrev_b32 v242, 16, v251
v_and_b32 v248, 0xffff0000, v251
v_mul_f32 v242, v242, v237
v_mul_f32 v248, v248, v237
v_cvt_pk_bf16_f32 v251, v242, v248
ds_write_b64 v231, v[250:251] offset:1032
s_waitcnt lgkmcnt(0)
ds_read_b64 v[250:251], v231 offset:5120
s_waitcnt lgkmcnt(0)
v_lshlrev_b32 v242, 16, v250
v_and_b32 v248, 0xffff0000, v250
v_mul_f32 v242, v242, v237
v_mul_f32 v248, v248, v237
v_cvt_pk_bf16_f32 v250, v242, v248
v_lshlrev_b32 v242, 16, v251
v_and_b32 v248, 0xffff0000, v251
v_mul_f32 v242, v242, v237
v_mul_f32 v248, v248, v237
v_cvt_pk_bf16_f32 v251, v242, v248
ds_write_b64 v231, v[250:251] offset:5120
s_waitcnt lgkmcnt(0)
ds_read_b64 v[250:251], v231 offset:5128
s_waitcnt lgkmcnt(0)
v_lshlrev_b32 v242, 16, v250
v_and_b32 v248, 0xffff0000, v250
v_mul_f32 v242, v242, v237
v_mul_f32 v248, v248, v237
v_cvt_pk_bf16_f32 v250, v242, v248
v_lshlrev_b32 v242, 16, v251
v_and_b32 v248, 0xffff0000, v251
v_mul_f32 v242, v242, v237
v_mul_f32 v248, v248, v237
v_cvt_pk_bf16_f32 v251, v242, v248
ds_write_b64 v231, v[250:251] offset:5128
s_waitcnt lgkmcnt(0)
v_exp_f32 v248, v152
s_nop 0
v_sub_f32 v226, v226, v248
v_exp_f32 v248, v153
s_nop 0
v_sub_f32 v226, v226, v248
v_exp_f32 v248, v154
s_nop 0
v_sub_f32 v226, v226, v248
v_exp_f32 v248, v155
s_nop 0
v_sub_f32 v226, v226, v248
v_max_f32 v226, 0, v226
v_min_f32 v226, s32, v226
v_log_f32 v248, v226
v_max3_f32 v234, v152, v153, v154
v_max3_f32 v234, v234, v155, v248
v_mov_b32 v248, v234
s_nop 1
v_permlane32_swap_b32 v234, v248
s_nop 1
v_max_f32 v234, v234, v248
v_mov_b32 v248, v234
s_nop 1
v_permlane16_swap_b32 v234, v248
s_nop 1
v_max_f32 v234, v234, v248
v_ceil_f32 v234, v234
v_max_f32 v234, 0, v234
v_sub_f32 v248, 0, v234
v_exp_f32 v238, v248
s_nop 1
v_mul_f32 v226, v226, v238
v_sub_f32 v200, v200, v234
v_sub_f32 v136, v136, v234
v_sub_f32 v152, v152, v234
v_sub_f32 v201, v201, v234
v_sub_f32 v137, v137, v234
v_sub_f32 v153, v153, v234
v_sub_f32 v202, v202, v234
v_sub_f32 v138, v138, v234
v_sub_f32 v154, v154, v234
v_sub_f32 v203, v203, v234
v_sub_f32 v139, v139, v234
v_sub_f32 v155, v155, v234
v_lshlrev_b32 v242, 16, v184
v_and_b32 v248, 0xffff0000, v184
v_mul_f32 v242, v242, v238
v_mul_f32 v248, v248, v238
v_cvt_pk_bf16_f32 v184, v242, v248
v_lshlrev_b32 v242, 16, v185
v_and_b32 v248, 0xffff0000, v185
v_mul_f32 v242, v242, v238
v_mul_f32 v248, v248, v238
v_cvt_pk_bf16_f32 v185, v242, v248
ds_read_b64 v[250:251], v231 offset:2048
s_waitcnt lgkmcnt(0)
v_lshlrev_b32 v242, 16, v250
v_and_b32 v248, 0xffff0000, v250
v_mul_f32 v242, v242, v238
v_mul_f32 v248, v248, v238
v_cvt_pk_bf16_f32 v250, v242, v248
v_lshlrev_b32 v242, 16, v251
v_and_b32 v248, 0xffff0000, v251
v_mul_f32 v242, v242, v238
v_mul_f32 v248, v248, v238
v_cvt_pk_bf16_f32 v251, v242, v248
ds_write_b64 v231, v[250:251] offset:2048
s_waitcnt lgkmcnt(0)
ds_read_b64 v[250:251], v231 offset:2056
s_waitcnt lgkmcnt(0)
v_lshlrev_b32 v242, 16, v250
v_and_b32 v248, 0xffff0000, v250
v_mul_f32 v242, v242, v238
v_mul_f32 v248, v248, v238
v_cvt_pk_bf16_f32 v250, v242, v248
v_lshlrev_b32 v242, 16, v251
v_and_b32 v248, 0xffff0000, v251
v_mul_f32 v242, v242, v238
v_mul_f32 v248, v248, v238
v_cvt_pk_bf16_f32 v251, v242, v248
ds_write_b64 v231, v[250:251] offset:2056
s_waitcnt lgkmcnt(0)
ds_read_b64 v[250:251], v231 offset:6144
s_waitcnt lgkmcnt(0)
v_lshlrev_b32 v242, 16, v250
v_and_b32 v248, 0xffff0000, v250
v_mul_f32 v242, v242, v238
v_mul_f32 v248, v248, v238
v_cvt_pk_bf16_f32 v250, v242, v248
v_lshlrev_b32 v242, 16, v251
v_and_b32 v248, 0xffff0000, v251
v_mul_f32 v242, v242, v238
v_mul_f32 v248, v248, v238
v_cvt_pk_bf16_f32 v251, v242, v248
ds_write_b64 v231, v[250:251] offset:6144
s_waitcnt lgkmcnt(0)
ds_read_b64 v[250:251], v231 offset:6152
s_waitcnt lgkmcnt(0)
v_lshlrev_b32 v242, 16, v250
v_and_b32 v248, 0xffff0000, v250
v_mul_f32 v242, v242, v238
v_mul_f32 v248, v248, v238
v_cvt_pk_bf16_f32 v250, v242, v248
v_lshlrev_b32 v242, 16, v251
v_and_b32 v248, 0xffff0000, v251
v_mul_f32 v242, v242, v238
v_mul_f32 v248, v248, v238
v_cvt_pk_bf16_f32 v251, v242, v248
ds_write_b64 v231, v[250:251] offset:6152
s_waitcnt lgkmcnt(0)
v_exp_f32 v248, v156
s_nop 0
v_sub_f32 v227, v227, v248
v_exp_f32 v248, v157
s_nop 0
v_sub_f32 v227, v227, v248
v_exp_f32 v248, v158
s_nop 0
v_sub_f32 v227, v227, v248
v_exp_f32 v248, v159
s_nop 0
v_sub_f32 v227, v227, v248
v_max_f32 v227, 0, v227
v_min_f32 v227, s32, v227
v_log_f32 v248, v227
v_max3_f32 v235, v156, v157, v158
v_max3_f32 v235, v235, v159, v248
v_mov_b32 v248, v235
s_nop 1
v_permlane32_swap_b32 v235, v248
s_nop 1
v_max_f32 v235, v235, v248
v_mov_b32 v248, v235
s_nop 1
v_permlane16_swap_b32 v235, v248
s_nop 1
v_max_f32 v235, v235, v248
v_ceil_f32 v235, v235
v_max_f32 v235, 0, v235
v_sub_f32 v248, 0, v235
v_exp_f32 v239, v248
s_nop 1
v_mul_f32 v227, v227, v239
v_sub_f32 v204, v204, v235
v_sub_f32 v140, v140, v235
v_sub_f32 v156, v156, v235
v_sub_f32 v205, v205, v235
v_sub_f32 v141, v141, v235
v_sub_f32 v157, v157, v235
v_sub_f32 v206, v206, v235
v_sub_f32 v142, v142, v235
v_sub_f32 v158, v158, v235
v_sub_f32 v207, v207, v235
v_sub_f32 v143, v143, v235
v_sub_f32 v159, v159, v235
v_lshlrev_b32 v242, 16, v188
v_and_b32 v248, 0xffff0000, v188
v_mul_f32 v242, v242, v239
v_mul_f32 v248, v248, v239
v_cvt_pk_bf16_f32 v188, v242, v248
v_lshlrev_b32 v242, 16, v189
v_and_b32 v248, 0xffff0000, v189
v_mul_f32 v242, v242, v239
v_mul_f32 v248, v248, v239
v_cvt_pk_bf16_f32 v189, v242, v248
ds_read_b64 v[250:251], v231 offset:3072
s_waitcnt lgkmcnt(0)
v_lshlrev_b32 v242, 16, v250
v_and_b32 v248, 0xffff0000, v250
v_mul_f32 v242, v242, v239
v_mul_f32 v248, v248, v239
v_cvt_pk_bf16_f32 v250, v242, v248
v_lshlrev_b32 v242, 16, v251
v_and_b32 v248, 0xffff0000, v251
v_mul_f32 v242, v242, v239
v_mul_f32 v248, v248, v239
v_cvt_pk_bf16_f32 v251, v242, v248
ds_write_b64 v231, v[250:251] offset:3072
s_waitcnt lgkmcnt(0)
ds_read_b64 v[250:251], v231 offset:3080
s_waitcnt lgkmcnt(0)
v_lshlrev_b32 v242, 16, v250
v_and_b32 v248, 0xffff0000, v250
v_mul_f32 v242, v242, v239
v_mul_f32 v248, v248, v239
v_cvt_pk_bf16_f32 v250, v242, v248
v_lshlrev_b32 v242, 16, v251
v_and_b32 v248, 0xffff0000, v251
v_mul_f32 v242, v242, v239
v_mul_f32 v248, v248, v239
v_cvt_pk_bf16_f32 v251, v242, v248
ds_write_b64 v231, v[250:251] offset:3080
s_waitcnt lgkmcnt(0)
ds_read_b64 v[250:251], v231 offset:7168
s_waitcnt lgkmcnt(0)
v_lshlrev_b32 v242, 16, v250
v_and_b32 v248, 0xffff0000, v250
v_mul_f32 v242, v242, v239
v_mul_f32 v248, v248, v239
v_cvt_pk_bf16_f32 v250, v242, v248
v_lshlrev_b32 v242, 16, v251
v_and_b32 v248, 0xffff0000, v251
v_mul_f32 v242, v242, v239
v_mul_f32 v248, v248, v239
v_cvt_pk_bf16_f32 v251, v242, v248
ds_write_b64 v231, v[250:251] offset:7168
s_waitcnt lgkmcnt(0)
ds_read_b64 v[250:251], v231 offset:7176
s_waitcnt lgkmcnt(0)
v_lshlrev_b32 v242, 16, v250
v_and_b32 v248, 0xffff0000, v250
v_mul_f32 v242, v242, v239
v_mul_f32 v248, v248, v239
v_cvt_pk_bf16_f32 v250, v242, v248
v_lshlrev_b32 v242, 16, v251
v_and_b32 v248, 0xffff0000, v251
v_mul_f32 v242, v242, v239
v_mul_f32 v248, v248, v239
v_cvt_pk_bf16_f32 v251, v242, v248
ds_write_b64 v231, v[250:251] offset:7176
s_waitcnt lgkmcnt(0)
v_exp_f32 v232, v144
v_exp_f32 v233, v145
v_exp_f32 v234, v146
v_exp_f32 v235, v147
s_nop 1
v_add_f32 v224, v224, v232
v_add_f32 v224, v224, v233
v_add_f32 v224, v224, v234
v_add_f32 v224, v224, v235
v_cvt_pk_bf16_f32 v178, v232, v233
v_cvt_pk_bf16_f32 v179, v234, v235
v_exp_f32 v232, v148
v_exp_f32 v233, v149
v_exp_f32 v234, v150
v_exp_f32 v235, v151
s_nop 1
v_add_f32 v225, v225, v232
v_add_f32 v225, v225, v233
v_add_f32 v225, v225, v234
v_add_f32 v225, v225, v235
v_cvt_pk_bf16_f32 v182, v232, v233
v_cvt_pk_bf16_f32 v183, v234, v235
v_exp_f32 v232, v152
v_exp_f32 v233, v153
v_exp_f32 v234, v154
v_exp_f32 v235, v155
s_nop 1
v_add_f32 v226, v226, v232
v_add_f32 v226, v226, v233
v_add_f32 v226, v226, v234
v_add_f32 v226, v226, v235
v_cvt_pk_bf16_f32 v186, v232, v233
v_cvt_pk_bf16_f32 v187, v234, v235
v_exp_f32 v232, v156
v_exp_f32 v233, v157
v_exp_f32 v234, v158
v_exp_f32 v235, v159
s_nop 1
v_add_f32 v227, v227, v232
v_add_f32 v227, v227, v233
v_add_f32 v227, v227, v234
v_add_f32 v227, v227, v235
v_cvt_pk_bf16_f32 v190, v232, v233
v_cvt_pk_bf16_f32 v191, v234, v235
s_branch L2_rare_common
L2_rare_site8:
s_mov_b32 s36, 8
s_branch L2_rare_t1_2_0
L2_rare_t1_2_0:
s_nop 15
s_nop 15
s_waitcnt lgkmcnt(0)
v_exp_f32 v248, v128
s_nop 0
v_sub_f32 v224, v224, v248
v_exp_f32 v248, v129
s_nop 0
v_sub_f32 v224, v224, v248
v_exp_f32 v248, v130
s_nop 0
v_sub_f32 v224, v224, v248
v_exp_f32 v248, v131
s_nop 0
v_sub_f32 v224, v224, v248
v_max_f32 v224, 0, v224
v_min_f32 v224, s32, v224
v_log_f32 v248, v224
v_max3_f32 v232, v128, v129, v130
v_max3_f32 v232, v232, v131, v248
v_mov_b32 v248, v232
s_nop 1
v_permlane32_swap_b32 v232, v248
s_nop 1
v_max_f32 v232, v232, v248
v_mov_b32 v248, v232
s_nop 1
v_permlane16_swap_b32 v232, v248
s_nop 1
v_max_f32 v232, v232, v248
v_ceil_f32 v232, v232
v_max_f32 v232, 0, v232
v_sub_f32 v248, 0, v232
v_exp_f32 v236, v248
s_nop 1
v_mul_f32 v224, v224, v236
v_sub_f32 v192, v192, v232
v_sub_f32 v128, v128, v232
v_sub_f32 v144, v144, v232
v_sub_f32 v193, v193, v232
v_sub_f32 v129, v129, v232
v_sub_f32 v145, v145, v232
v_sub_f32 v194, v194, v232
v_sub_f32 v130, v130, v232
v_sub_f32 v146, v146, v232
v_sub_f32 v195, v195, v232
v_sub_f32 v131, v131, v232
v_sub_f32 v147, v147, v232
v_lshlrev_b32 v242, 16, v176
v_and_b32 v248, 0xffff0000, v176
v_mul_f32 v242, v242, v236
v_mul_f32 v248, v248, v236
v_cvt_pk_bf16_f32 v176, v242, v248
v_lshlrev_b32 v242, 16, v177
v_and_b32 v248, 0xffff0000, v177
v_mul_f32 v242, v242, v236
v_mul_f32 v248, v248, v236
v_cvt_pk_bf16_f32 v177, v242, v248
v_lshlrev_b32 v242, 16, v178
v_and_b32 v248, 0xffff0000, v178
v_mul_f32 v242, v242, v236
v_mul_f32 v248, v248, v236
v_cvt_pk_bf16_f32 v178, v242, v248
v_lshlrev_b32 v242, 16, v179
v_and_b32 v248, 0xffff0000, v179
v_mul_f32 v242, v242, v236
v_mul_f32 v248, v248, v236
v_cvt_pk_bf16_f32 v179, v242, v248
ds_read_b64 v[250:251], v231 offset:0
s_waitcnt lgkmcnt(0)
v_lshlrev_b32 v242, 16, v250
v_and_b32 v248, 0xffff0000, v250
v_mul_f32 v242, v242, v236
v_mul_f32 v248, v248, v236
v_cvt_pk_bf16_f32 v250, v242, v248
v_lshlrev_b32 v242, 16, v251
v_and_b32 v248, 0xffff0000, v251
v_mul_f32 v242, v242, v236
v_mul_f32 v248, v248, v236
v_cvt_pk_bf16_f32 v251, v242, v248
ds_write_b64 v231, v[250:251] offset:0
s_waitcnt lgkmcnt(0)
ds_read_b64 v[250:251], v231 offset:8
s_waitcnt lgkmcnt(0)
v_lshlrev_b32 v242, 16, v250
v_and_b32 v248, 0xffff0000, v250
v_mul_f32 v242, v242, v236
v_mul_f32 v248, v248, v236
v_cvt_pk_bf16_f32 v250, v242, v248
v_lshlrev_b32 v242, 16, v251
v_and_b32 v248, 0xffff0000, v251
v_mul_f32 v242, v242, v236
v_mul_f32 v248, v248, v236
v_cvt_pk_bf16_f32 v251, v242, v248
ds_write_b64 v231, v[250:251] offset:8
s_waitcnt lgkmcnt(0)
ds_read_b64 v[250:251], v231 offset:4096
s_waitcnt lgkmcnt(0)
v_lshlrev_b32 v242, 16, v250
v_and_b32 v248, 0xffff0000, v250
v_mul_f32 v242, v242, v236
v_mul_f32 v248, v248, v236
v_cvt_pk_bf16_f32 v250, v242, v248
v_lshlrev_b32 v242, 16, v251
v_and_b32 v248, 0xffff0000, v251
v_mul_f32 v242, v242, v236
v_mul_f32 v248, v248, v236
v_cvt_pk_bf16_f32 v251, v242, v248
ds_write_b64 v231, v[250:251] offset:4096
s_waitcnt lgkmcnt(0)
ds_read_b64 v[250:251], v231 offset:4104
s_waitcnt lgkmcnt(0)
v_lshlrev_b32 v242, 16, v250
v_and_b32 v248, 0xffff0000, v250
v_mul_f32 v242, v242, v236
v_mul_f32 v248, v248, v236
v_cvt_pk_bf16_f32 v250, v242, v248
v_lshlrev_b32 v242, 16, v251
v_and_b32 v248, 0xffff0000, v251
v_mul_f32 v242, v242, v236
v_mul_f32 v248, v248, v236
v_cvt_pk_bf16_f32 v251, v242, v248
ds_write_b64 v231, v[250:251] offset:4104
s_waitcnt lgkmcnt(0)
v_exp_f32 v248, v132
s_nop 0
v_sub_f32 v225, v225, v248
v_exp_f32 v248, v133
s_nop 0
v_sub_f32 v225, v225, v248
v_exp_f32 v248, v134
s_nop 0
v_sub_f32 v225, v225, v248
v_exp_f32 v248, v135
s_nop 0
v_sub_f32 v225, v225, v248
v_max_f32 v225, 0, v225
v_min_f32 v225, s32, v225
v_log_f32 v248, v225
v_max3_f32 v233, v132, v133, v134
v_max3_f32 v233, v233, v135, v248
v_mov_b32 v248, v233
s_nop 1
v_permlane32_swap_b32 v233, v248
s_nop 1
v_max_f32 v233, v233, v248
v_mov_b32 v248, v233
s_nop 1
v_permlane16_swap_b32 v233, v248
s_nop 1
v_max_f32 v233, v233, v248
v_ceil_f32 v233, v233
v_max_f32 v233, 0, v233
v_sub_f32 v248, 0, v233
v_exp_f32 v237, v248
s_nop 1
v_mul_f32 v225, v225, v237
v_sub_f32 v196, v196, v233
v_sub_f32 v132, v132, v233
v_sub_f32 v148, v148, v233
v_sub_f32 v197, v197, v233
v_sub_f32 v133, v133, v233
v_sub_f32 v149, v149, v233
v_sub_f32 v198, v198, v233
v_sub_f32 v134, v134, v233
v_sub_f32 v150, v150, v233
v_sub_f32 v199, v199, v233
v_sub_f32 v135, v135, v233
v_sub_f32 v151, v151, v233
v_lshlrev_b32 v242, 16, v180
v_and_b32 v248, 0xffff0000, v180
v_mul_f32 v242, v242, v237
v_mul_f32 v248, v248, v237
v_cvt_pk_bf16_f32 v180, v242, v248
v_lshlrev_b32 v242, 16, v181
v_and_b32 v248, 0xffff0000, v181
v_mul_f32 v242, v242, v237
v_mul_f32 v248, v248, v237
v_cvt_pk_bf16_f32 v181, v242, v248
v_lshlrev_b32 v242, 16, v182
v_and_b32 v248, 0xffff0000, v182
v_mul_f32 v242, v242, v237
v_mul_f32 v248, v248, v237
v_cvt_pk_bf16_f32 v182, v242, v248
v_lshlrev_b32 v242, 16, v183
v_and_b32 v248, 0xffff0000, v183
v_mul_f32 v242, v242, v237
v_mul_f32 v248, v248, v237
v_cvt_pk_bf16_f32 v183, v242, v248
ds_read_b64 v[250:251], v231 offset:1024
s_waitcnt lgkmcnt(0)
v_lshlrev_b32 v242, 16, v250
v_and_b32 v248, 0xffff0000, v250
v_mul_f32 v242, v242, v237
v_mul_f32 v248, v248, v237
v_cvt_pk_bf16_f32 v250, v242, v248
v_lshlrev_b32 v242, 16, v251
v_and_b32 v248, 0xffff0000, v251
v_mul_f32 v242, v242, v237
v_mul_f32 v248, v248, v237
v_cvt_pk_bf16_f32 v251, v242, v248
ds_write_b64 v231, v[250:251] offset:1024
s_waitcnt lgkmcnt(0)
ds_read_b64 v[250:251], v231 offset:1032
s_waitcnt lgkmcnt(0)
v_lshlrev_b32 v242, 16, v250
v_and_b32 v248, 0xffff0000, v250
v_mul_f32 v242, v242, v237
v_mul_f32 v248, v248, v237
v_cvt_pk_bf16_f32 v250, v242, v248
v_lshlrev_b32 v242, 16, v251
v_and_b32 v248, 0xffff0000, v251
v_mul_f32 v242, v242, v237
v_mul_f32 v248, v248, v237
v_cvt_pk_bf16_f32 v251, v242, v248
ds_write_b64 v231, v[250:251] offset:1032
s_waitcnt lgkmcnt(0)
ds_read_b64 v[250:251], v231 offset:5120
s_waitcnt lgkmcnt(0)
v_lshlrev_b32 v242, 16, v250
v_and_b32 v248, 0xffff0000, v250
v_mul_f32 v242, v242, v237
v_mul_f32 v248, v248, v237
v_cvt_pk_bf16_f32 v250, v242, v248
v_lshlrev_b32 v242, 16, v251
v_and_b32 v248, 0xffff0000, v251
v_mul_f32 v242, v242, v237
v_mul_f32 v248, v248, v237
v_cvt_pk_bf16_f32 v251, v242, v248
ds_write_b64 v231, v[250:251] offset:5120
s_waitcnt lgkmcnt(0)
ds_read_b64 v[250:251], v231 offset:5128
s_waitcnt lgkmcnt(0)
v_lshlrev_b32 v242, 16, v250
v_and_b32 v248, 0xffff0000, v250
v_mul_f32 v242, v242, v237
v_mul_f32 v248, v248, v237
v_cvt_pk_bf16_f32 v250, v242, v248
v_lshlrev_b32 v242, 16, v251
v_and_b32 v248, 0xffff0000, v251
v_mul_f32 v242, v242, v237
v_mul_f32 v248, v248, v237
v_cvt_pk_bf16_f32 v251, v242, v248
ds_write_b64 v231, v[250:251] offset:5128
s_waitcnt lgkmcnt(0)
v_exp_f32 v248, v136
s_nop 0
v_sub_f32 v226, v226, v248
v_exp_f32 v248, v137
s_nop 0
v_sub_f32 v226, v226, v248
v_exp_f32 v248, v138
s_nop 0
v_sub_f32 v226, v226, v248
v_exp_f32 v248, v139
s_nop 0
v_sub_f32 v226, v226, v248
v_max_f32 v226, 0, v226
v_min_f32 v226, s32, v226
v_log_f32 v248, v226
v_max3_f32 v234, v136, v137, v138
v_max3_f32 v234, v234, v139, v248
v_mov_b32 v248, v234
s_nop 1
v_permlane32_swap_b32 v234, v248
s_nop 1
v_max_f32 v234, v234, v248
v_mov_b32 v248, v234
s_nop 1
v_permlane16_swap_b32 v234, v248
s_nop 1
v_max_f32 v234, v234, v248
v_ceil_f32 v234, v234
v_max_f32 v234, 0, v234
v_sub_f32 v248, 0, v234
v_exp_f32 v238, v248
s_nop 1
v_mul_f32 v226, v226, v238
v_sub_f32 v200, v200, v234
v_sub_f32 v136, v136, v234
v_sub_f32 v152, v152, v234
v_sub_f32 v201, v201, v234
v_sub_f32 v137, v137, v234
v_sub_f32 v153, v153, v234
v_sub_f32 v202, v202, v234
v_sub_f32 v138, v138, v234
v_sub_f32 v154, v154, v234
v_sub_f32 v203, v203, v234
v_sub_f32 v139, v139, v234
v_sub_f32 v155, v155, v234
v_lshlrev_b32 v242, 16, v184
v_and_b32 v248, 0xffff0000, v184
v_mul_f32 v242, v242, v238
v_mul_f32 v248, v248, v238
v_cvt_pk_bf16_f32 v184, v242, v248
v_lshlrev_b32 v242, 16, v185
v_and_b32 v248, 0xffff0000, v185
v_mul_f32 v242, v242, v238
v_mul_f32 v248, v248, v238
v_cvt_pk_bf16_f32 v185, v242, v248
v_lshlrev_b32 v242, 16, v186
v_and_b32 v248, 0xffff0000, v186
v_mul_f32 v242, v242, v238
v_mul_f32 v248, v248, v238
v_cvt_pk_bf16_f32 v186, v242, v248
v_lshlrev_b32 v242, 16, v187
v_and_b32 v248, 0xffff0000, v187
v_mul_f32 v242, v242, v238
v_mul_f32 v248, v248, v238
v_cvt_pk_bf16_f32 v187, v242, v248
ds_read_b64 v[250:251], v231 offset:2048
s_waitcnt lgkmcnt(0)
v_lshlrev_b32 v242, 16, v250
v_and_b32 v248, 0xffff0000, v250
v_mul_f32 v242, v242, v238
v_mul_f32 v248, v248, v238
v_cvt_pk_bf16_f32 v250, v242, v248
v_lshlrev_b32 v242, 16, v251
v_and_b32 v248, 0xffff0000, v251
v_mul_f32 v242, v242, v238
v_mul_f32 v248, v248, v238
v_cvt_pk_bf16_f32 v251, v242, v248
ds_write_b64 v231, v[250:251] offset:2048
s_waitcnt lgkmcnt(0)
ds_read_b64 v[250:251], v231 offset:2056
s_waitcnt lgkmcnt(0)
v_lshlrev_b32 v242, 16, v250
v_and_b32 v248, 0xffff0000, v250
v_mul_f32 v242, v242, v238
v_mul_f32 v248, v248, v238
v_cvt_pk_bf16_f32 v250, v242, v248
v_lshlrev_b32 v242, 16, v251
v_and_b32 v248, 0xffff0000, v251
v_mul_f32 v242, v242, v238
v_mul_f32 v248, v248, v238
v_cvt_pk_bf16_f32 v251, v242, v248
ds_write_b64 v231, v[250:251] offset:2056
s_waitcnt lgkmcnt(0)
ds_read_b64 v[250:251], v231 offset:6144
s_waitcnt lgkmcnt(0)
v_lshlrev_b32 v242, 16, v250
v_and_b32 v248, 0xffff0000, v250
v_mul_f32 v242, v242, v238
v_mul_f32 v248, v248, v238
v_cvt_pk_bf16_f32 v250, v242, v248
v_lshlrev_b32 v242, 16, v251
v_and_b32 v248, 0xffff0000, v251
v_mul_f32 v242, v242, v238
v_mul_f32 v248, v248, v238
v_cvt_pk_bf16_f32 v251, v242, v248
ds_write_b64 v231, v[250:251] offset:6144
s_waitcnt lgkmcnt(0)
ds_read_b64 v[250:251], v231 offset:6152
s_waitcnt lgkmcnt(0)
v_lshlrev_b32 v242, 16, v250
v_and_b32 v248, 0xffff0000, v250
v_mul_f32 v242, v242, v238
v_mul_f32 v248, v248, v238
v_cvt_pk_bf16_f32 v250, v242, v248
v_lshlrev_b32 v242, 16, v251
v_and_b32 v248, 0xffff0000, v251
v_mul_f32 v242, v242, v238
v_mul_f32 v248, v248, v238
v_cvt_pk_bf16_f32 v251, v242, v248
ds_write_b64 v231, v[250:251] offset:6152
s_waitcnt lgkmcnt(0)
v_exp_f32 v248, v140
s_nop 0
v_sub_f32 v227, v227, v248
v_exp_f32 v248, v141
s_nop 0
v_sub_f32 v227, v227, v248
v_exp_f32 v248, v142
s_nop 0
v_sub_f32 v227, v227, v248
v_exp_f32 v248, v143
s_nop 0
v_sub_f32 v227, v227, v248
v_max_f32 v227, 0, v227
v_min_f32 v227, s32, v227
v_log_f32 v248, v227
v_max3_f32 v235, v140, v141, v142
v_max3_f32 v235, v235, v143, v248
v_mov_b32 v248, v235
s_nop 1
v_permlane32_swap_b32 v235, v248
s_nop 1
v_max_f32 v235, v235, v248
v_mov_b32 v248, v235
s_nop 1
v_permlane16_swap_b32 v235, v248
s_nop 1
v_max_f32 v235, v235, v248
v_ceil_f32 v235, v235
v_max_f32 v235, 0, v235
v_sub_f32 v248, 0, v235
v_exp_f32 v239, v248
s_nop 1
v_mul_f32 v227, v227, v239
v_sub_f32 v204, v204, v235
v_sub_f32 v140, v140, v235
v_sub_f32 v156, v156, v235
v_sub_f32 v205, v205, v235
v_sub_f32 v141, v141, v235
v_sub_f32 v157, v157, v235
v_sub_f32 v206, v206, v235
v_sub_f32 v142, v142, v235
v_sub_f32 v158, v158, v235
v_sub_f32 v207, v207, v235
v_sub_f32 v143, v143, v235
v_sub_f32 v159, v159, v235
v_lshlrev_b32 v242, 16, v188
v_and_b32 v248, 0xffff0000, v188
v_mul_f32 v242, v242, v239
v_mul_f32 v248, v248, v239
v_cvt_pk_bf16_f32 v188, v242, v248
v_lshlrev_b32 v242, 16, v189
v_and_b32 v248, 0xffff0000, v189
v_mul_f32 v242, v242, v239
v_mul_f32 v248, v248, v239
v_cvt_pk_bf16_f32 v189, v242, v248
v_lshlrev_b32 v242, 16, v190
v_and_b32 v248, 0xffff0000, v190
v_mul_f32 v242, v242, v239
v_mul_f32 v248, v248, v239
v_cvt_pk_bf16_f32 v190, v242, v248
v_lshlrev_b32 v242, 16, v191
v_and_b32 v248, 0xffff0000, v191
v_mul_f32 v242, v242, v239
v_mul_f32 v248, v248, v239
v_cvt_pk_bf16_f32 v191, v242, v248
ds_read_b64 v[250:251], v231 offset:3072
s_waitcnt lgkmcnt(0)
v_lshlrev_b32 v242, 16, v250
v_and_b32 v248, 0xffff0000, v250
v_mul_f32 v242, v242, v239
v_mul_f32 v248, v248, v239
v_cvt_pk_bf16_f32 v250, v242, v248
v_lshlrev_b32 v242, 16, v251
v_and_b32 v248, 0xffff0000, v251
v_mul_f32 v242, v242, v239
v_mul_f32 v248, v248, v239
v_cvt_pk_bf16_f32 v251, v242, v248
ds_write_b64 v231, v[250:251] offset:3072
s_waitcnt lgkmcnt(0)
ds_read_b64 v[250:251], v231 offset:3080
s_waitcnt lgkmcnt(0)
v_lshlrev_b32 v242, 16, v250
v_and_b32 v248, 0xffff0000, v250
v_mul_f32 v242, v242, v239
v_mul_f32 v248, v248, v239
v_cvt_pk_bf16_f32 v250, v242, v248
v_lshlrev_b32 v242, 16, v251
v_and_b32 v248, 0xffff0000, v251
v_mul_f32 v242, v242, v239
v_mul_f32 v248, v248, v239
v_cvt_pk_bf16_f32 v251, v242, v248
ds_write_b64 v231, v[250:251] offset:3080
s_waitcnt lgkmcnt(0)
ds_read_b64 v[250:251], v231 offset:7168
s_waitcnt lgkmcnt(0)
v_lshlrev_b32 v242, 16, v250
v_and_b32 v248, 0xffff0000, v250
v_mul_f32 v242, v242, v239
v_mul_f32 v248, v248, v239
v_cvt_pk_bf16_f32 v250, v242, v248
v_lshlrev_b32 v242, 16, v251
v_and_b32 v248, 0xffff0000, v251
v_mul_f32 v242, v242, v239
v_mul_f32 v248, v248, v239
v_cvt_pk_bf16_f32 v251, v242, v248
ds_write_b64 v231, v[250:251] offset:7168
s_waitcnt lgkmcnt(0)
ds_read_b64 v[250:251], v231 offset:7176
s_waitcnt lgkmcnt(0)
v_lshlrev_b32 v242, 16, v250
v_and_b32 v248, 0xffff0000, v250
v_mul_f32 v242, v242, v239
v_mul_f32 v248, v248, v239
v_cvt_pk_bf16_f32 v250, v242, v248
v_lshlrev_b32 v242, 16, v251
v_and_b32 v248, 0xffff0000, v251
v_mul_f32 v242, v242, v239
v_mul_f32 v248, v248, v239
v_cvt_pk_bf16_f32 v251, v242, v248
ds_write_b64 v231, v[250:251] offset:7176
s_waitcnt lgkmcnt(0)
v_exp_f32 v232, v128
v_exp_f32 v233, v129
v_exp_f32 v234, v130
v_exp_f32 v235, v131
s_nop 1
v_add_f32 v224, v224, v232
v_add_f32 v224, v224, v233
v_add_f32 v224, v224, v234
v_add_f32 v224, v224, v235
v_cvt_pk_bf16_f32 v160, v232, v233
v_cvt_pk_bf16_f32 v161, v234, v235
v_exp_f32 v232, v132
v_exp_f32 v233, v133
v_exp_f32 v234, v134
v_exp_f32 v235, v135
s_nop 1
v_add_f32 v225, v225, v232
v_add_f32 v225, v225, v233
v_add_f32 v225, v225, v234
v_add_f32 v225, v225, v235
v_cvt_pk_bf16_f32 v164, v232, v233
v_cvt_pk_bf16_f32 v165, v234, v235
v_exp_f32 v232, v136
v_exp_f32 v233, v137
v_exp_f32 v234, v138
v_exp_f32 v235, v139
s_nop 1
v_add_f32 v226, v226, v232
v_add_f32 v226, v226, v233
v_add_f32 v226, v226, v234
v_add_f32 v226, v226, v235
v_cvt_pk_bf16_f32 v168, v232, v233
v_cvt_pk_bf16_f32 v169, v234, v235
v_exp_f32 v232, v140
v_exp_f32 v233, v141
v_exp_f32 v234, v142
v_exp_f32 v235, v143
s_nop 1
v_add_f32 v227, v227, v232
v_add_f32 v227, v227, v233
v_add_f32 v227, v227, v234
v_add_f32 v227, v227, v235
v_cvt_pk_bf16_f32 v172, v232, v233
v_cvt_pk_bf16_f32 v173, v234, v235
s_branch L2_rare_common
L2_rare_site9:
s_mov_b32 s36, 9
s_branch L2_rare_t1_3_1
L2_rare_t1_3_1:
s_nop 15
s_nop 15
s_waitcnt lgkmcnt(0)
v_exp_f32 v248, v144
s_nop 0
v_sub_f32 v224, v224, v248
v_exp_f32 v248, v145
s_nop 0
v_sub_f32 v224, v224, v248
v_exp_f32 v248, v146
s_nop 0
v_sub_f32 v224, v224, v248
v_exp_f32 v248, v147
s_nop 0
v_sub_f32 v224, v224, v248
v_max_f32 v224, 0, v224
v_min_f32 v224, s32, v224
v_log_f32 v248, v224
v_max3_f32 v232, v144, v145, v146
v_max3_f32 v232, v232, v147, v248
v_mov_b32 v248, v232
s_nop 1
v_permlane32_swap_b32 v232, v248
s_nop 1
v_max_f32 v232, v232, v248
v_mov_b32 v248, v232
s_nop 1
v_permlane16_swap_b32 v232, v248
s_nop 1
v_max_f32 v232, v232, v248
v_ceil_f32 v232, v232
v_max_f32 v232, 0, v232
v_sub_f32 v248, 0, v232
v_exp_f32 v236, v248
s_nop 1
v_mul_f32 v224, v224, v236
v_sub_f32 v192, v192, v232
v_sub_f32 v128, v128, v232
v_sub_f32 v144, v144, v232
v_sub_f32 v193, v193, v232
v_sub_f32 v129, v129, v232
v_sub_f32 v145, v145, v232
v_sub_f32 v194, v194, v232
v_sub_f32 v130, v130, v232
v_sub_f32 v146, v146, v232
v_sub_f32 v195, v195, v232
v_sub_f32 v131, v131, v232
v_sub_f32 v147, v147, v232
v_lshlrev_b32 v242, 16, v176
v_and_b32 v248, 0xffff0000, v176
v_mul_f32 v242, v242, v236
v_mul_f32 v248, v248, v236
v_cvt_pk_bf16_f32 v176, v242, v248
v_lshlrev_b32 v242, 16, v177
v_and_b32 v248, 0xffff0000, v177
v_mul_f32 v242, v242, v236
v_mul_f32 v248, v248, v236
v_cvt_pk_bf16_f32 v177, v242, v248
v_lshlrev_b32 v242, 16, v178
v_and_b32 v248, 0xffff0000, v178
v_mul_f32 v242, v242, v236
v_mul_f32 v248, v248, v236
v_cvt_pk_bf16_f32 v178, v242, v248
v_lshlrev_b32 v242, 16, v179
v_and_b32 v248, 0xffff0000, v179
v_mul_f32 v242, v242, v236
v_mul_f32 v248, v248, v236
v_cvt_pk_bf16_f32 v179, v242, v248
v_lshlrev_b32 v242, 16, v160
v_and_b32 v248, 0xffff0000, v160
v_mul_f32 v242, v242, v236
v_mul_f32 v248, v248, v236
v_cvt_pk_bf16_f32 v160, v242, v248
v_lshlrev_b32 v242, 16, v161
v_and_b32 v248, 0xffff0000, v161
v_mul_f32 v242, v242, v236
v_mul_f32 v248, v248, v236
v_cvt_pk_bf16_f32 v161, v242, v248
ds_read_b64 v[250:251], v231 offset:0
s_waitcnt lgkmcnt(0)
v_lshlrev_b32 v242, 16, v250
v_and_b32 v248, 0xffff0000, v250
v_mul_f32 v242, v242, v236
v_mul_f32 v248, v248, v236
v_cvt_pk_bf16_f32 v250, v242, v248
v_lshlrev_b32 v242, 16, v251
v_and_b32 v248, 0xffff0000, v251
v_mul_f32 v242, v242, v236
v_mul_f32 v248, v248, v236
v_cvt_pk_bf16_f32 v251, v242, v248
ds_write_b64 v231, v[250:251] offset:0
s_waitcnt lgkmcnt(0)
ds_read_b64 v[250:251], v231 offset:8
s_waitcnt lgkmcnt(0)
v_lshlrev_b32 v242, 16, v250
v_and_b32 v248, 0xffff0000, v250
v_mul_f32 v242, v242, v236
v_mul_f32 v248, v248, v236
v_cvt_pk_bf16_f32 v250, v242, v248
v_lshlrev_b32 v242, 16, v251
v_and_b32 v248, 0xffff0000, v251
v_mul_f32 v242, v242, v236
v_mul_f32 v248, v248, v236
v_cvt_pk_bf16_f32 v251, v242, v248
ds_write_b64 v231, v[250:251] offset:8
s_waitcnt lgkmcnt(0)
ds_read_b64 v[250:251], v231 offset:4096
s_waitcnt lgkmcnt(0)
v_lshlrev_b32 v242, 16, v250
v_and_b32 v248, 0xffff0000, v250
v_mul_f32 v242, v242, v236
v_mul_f32 v248, v248, v236
v_cvt_pk_bf16_f32 v250, v242, v248
v_lshlrev_b32 v242, 16, v251
v_and_b32 v248, 0xffff0000, v251
v_mul_f32 v242, v242, v236
v_mul_f32 v248, v248, v236
v_cvt_pk_bf16_f32 v251, v242, v248
ds_write_b64 v231, v[250:251] offset:4096
s_waitcnt lgkmcnt(0)
ds_read_b64 v[250:251], v231 offset:4104
s_waitcnt lgkmcnt(0)
v_lshlrev_b32 v242, 16, v250
v_and_b32 v248, 0xffff0000, v250
v_mul_f32 v242, v242, v236
v_mul_f32 v248, v248, v236
v_cvt_pk_bf16_f32 v250, v242, v248
v_lshlrev_b32 v242, 16, v251
v_and_b32 v248, 0xffff0000, v251
v_mul_f32 v242, v242, v236
v_mul_f32 v248, v248, v236
v_cvt_pk_bf16_f32 v251, v242, v248
ds_write_b64 v231, v[250:251] offset:4104
s_waitcnt lgkmcnt(0)
v_exp_f32 v248, v148
s_nop 0
v_sub_f32 v225, v225, v248
v_exp_f32 v248, v149
s_nop 0
v_sub_f32 v225, v225, v248
v_exp_f32 v248, v150
s_nop 0
v_sub_f32 v225, v225, v248
v_exp_f32 v248, v151
s_nop 0
v_sub_f32 v225, v225, v248
v_max_f32 v225, 0, v225
v_min_f32 v225, s32, v225
v_log_f32 v248, v225
v_max3_f32 v233, v148, v149, v150
v_max3_f32 v233, v233, v151, v248
v_mov_b32 v248, v233
s_nop 1
v_permlane32_swap_b32 v233, v248
s_nop 1
v_max_f32 v233, v233, v248
v_mov_b32 v248, v233
s_nop 1
v_permlane16_swap_b32 v233, v248
s_nop 1
v_max_f32 v233, v233, v248
v_ceil_f32 v233, v233
v_max_f32 v233, 0, v233
v_sub_f32 v248, 0, v233
v_exp_f32 v237, v248
s_nop 1
v_mul_f32 v225, v225, v237
v_sub_f32 v196, v196, v233
v_sub_f32 v132, v132, v233
v_sub_f32 v148, v148, v233
v_sub_f32 v197, v197, v233
v_sub_f32 v133, v133, v233
v_sub_f32 v149, v149, v233
v_sub_f32 v198, v198, v233
v_sub_f32 v134, v134, v233
v_sub_f32 v150, v150, v233
v_sub_f32 v199, v199, v233
v_sub_f32 v135, v135, v233
v_sub_f32 v151, v151, v233
v_lshlrev_b32 v242, 16, v180
v_and_b32 v248, 0xffff0000, v180
v_mul_f32 v242, v242, v237
v_mul_f32 v248, v248, v237
v_cvt_pk_bf16_f32 v180, v242, v248
v_lshlrev_b32 v242, 16, v181
v_and_b32 v248, 0xffff0000, v181
v_mul_f32 v242, v242, v237
v_mul_f32 v248, v248, v237
v_cvt_pk_bf16_f32 v181, v242, v248
v_lshlrev_b32 v242, 16, v182
v_and_b32 v248, 0xffff0000, v182
v_mul_f32 v242, v242, v237
v_mul_f32 v248, v248, v237
v_cvt_pk_bf16_f32 v182, v242, v248
v_lshlrev_b32 v242, 16, v183
v_and_b32 v248, 0xffff0000, v183
v_mul_f32 v242, v242, v237
v_mul_f32 v248, v248, v237
v_cvt_pk_bf16_f32 v183, v242, v248
v_lshlrev_b32 v242, 16, v164
v_and_b32 v248, 0xffff0000, v164
v_mul_f32 v242, v242, v237
v_mul_f32 v248, v248, v237
v_cvt_pk_bf16_f32 v164, v242, v248
v_lshlrev_b32 v242, 16, v165
v_and_b32 v248, 0xffff0000, v165
v_mul_f32 v242, v242, v237
v_mul_f32 v248, v248, v237
v_cvt_pk_bf16_f32 v165, v242, v248
ds_read_b64 v[250:251], v231 offset:1024
s_waitcnt lgkmcnt(0)
v_lshlrev_b32 v242, 16, v250
v_and_b32 v248, 0xffff0000, v250
v_mul_f32 v242, v242, v237
v_mul_f32 v248, v248, v237
v_cvt_pk_bf16_f32 v250, v242, v248
v_lshlrev_b32 v242, 16, v251
v_and_b32 v248, 0xffff0000, v251
v_mul_f32 v242, v242, v237
v_mul_f32 v248, v248, v237
v_cvt_pk_bf16_f32 v251, v242, v248
ds_write_b64 v231, v[250:251] offset:1024
s_waitcnt lgkmcnt(0)
ds_read_b64 v[250:251], v231 offset:1032
s_waitcnt lgkmcnt(0)
v_lshlrev_b32 v242, 16, v250
v_and_b32 v248, 0xffff0000, v250
v_mul_f32 v242, v242, v237
v_mul_f32 v248, v248, v237
v_cvt_pk_bf16_f32 v250, v242, v248
v_lshlrev_b32 v242, 16, v251
v_and_b32 v248, 0xffff0000, v251
v_mul_f32 v242, v242, v237
v_mul_f32 v248, v248, v237
v_cvt_pk_bf16_f32 v251, v242, v248
ds_write_b64 v231, v[250:251] offset:1032
s_waitcnt lgkmcnt(0)
ds_read_b64 v[250:251], v231 offset:5120
s_waitcnt lgkmcnt(0)
v_lshlrev_b32 v242, 16, v250
v_and_b32 v248, 0xffff0000, v250
v_mul_f32 v242, v242, v237
v_mul_f32 v248, v248, v237
v_cvt_pk_bf16_f32 v250, v242, v248
v_lshlrev_b32 v242, 16, v251
v_and_b32 v248, 0xffff0000, v251
v_mul_f32 v242, v242, v237
v_mul_f32 v248, v248, v237
v_cvt_pk_bf16_f32 v251, v242, v248
ds_write_b64 v231, v[250:251] offset:5120
s_waitcnt lgkmcnt(0)
ds_read_b64 v[250:251], v231 offset:5128
s_waitcnt lgkmcnt(0)
v_lshlrev_b32 v242, 16, v250
v_and_b32 v248, 0xffff0000, v250
v_mul_f32 v242, v242, v237
v_mul_f32 v248, v248, v237
v_cvt_pk_bf16_f32 v250, v242, v248
v_lshlrev_b32 v242, 16, v251
v_and_b32 v248, 0xffff0000, v251
v_mul_f32 v242, v242, v237
v_mul_f32 v248, v248, v237
v_cvt_pk_bf16_f32 v251, v242, v248
ds_write_b64 v231, v[250:251] offset:5128
s_waitcnt lgkmcnt(0)
v_exp_f32 v248, v152
s_nop 0
v_sub_f32 v226, v226, v248
v_exp_f32 v248, v153
s_nop 0
v_sub_f32 v226, v226, v248
v_exp_f32 v248, v154
s_nop 0
v_sub_f32 v226, v226, v248
v_exp_f32 v248, v155
s_nop 0
v_sub_f32 v226, v226, v248
v_max_f32 v226, 0, v226
v_min_f32 v226, s32, v226
v_log_f32 v248, v226
v_max3_f32 v234, v152, v153, v154
v_max3_f32 v234, v234, v155, v248
v_mov_b32 v248, v234
s_nop 1
v_permlane32_swap_b32 v234, v248
s_nop 1
v_max_f32 v234, v234, v248
v_mov_b32 v248, v234
s_nop 1
v_permlane16_swap_b32 v234, v248
s_nop 1
v_max_f32 v234, v234, v248
v_ceil_f32 v234, v234
v_max_f32 v234, 0, v234
v_sub_f32 v248, 0, v234
v_exp_f32 v238, v248
s_nop 1
v_mul_f32 v226, v226, v238
v_sub_f32 v200, v200, v234
v_sub_f32 v136, v136, v234
v_sub_f32 v152, v152, v234
v_sub_f32 v201, v201, v234
v_sub_f32 v137, v137, v234
v_sub_f32 v153, v153, v234
v_sub_f32 v202, v202, v234
v_sub_f32 v138, v138, v234
v_sub_f32 v154, v154, v234
v_sub_f32 v203, v203, v234
v_sub_f32 v139, v139, v234
v_sub_f32 v155, v155, v234
v_lshlrev_b32 v242, 16, v184
v_and_b32 v248, 0xffff0000, v184
v_mul_f32 v242, v242, v238
v_mul_f32 v248, v248, v238
v_cvt_pk_bf16_f32 v184, v242, v248
v_lshlrev_b32 v242, 16, v185
v_and_b32 v248, 0xffff0000, v185
v_mul_f32 v242, v242, v238
v_mul_f32 v248, v248, v238
v_cvt_pk_bf16_f32 v185, v242, v248
v_lshlrev_b32 v242, 16, v186
v_and_b32 v248, 0xffff0000, v186
v_mul_f32 v242, v242, v238
v_mul_f32 v248, v248, v238
v_cvt_pk_bf16_f32 v186, v242, v248
v_lshlrev_b32 v242, 16, v187
v_and_b32 v248, 0xffff0000, v187
v_mul_f32 v242, v242, v238
v_mul_f32 v248, v248, v238
v_cvt_pk_bf16_f32 v187, v242, v248
v_lshlrev_b32 v242, 16, v168
v_and_b32 v248, 0xffff0000, v168
v_mul_f32 v242, v242, v238
v_mul_f32 v248, v248, v238
v_cvt_pk_bf16_f32 v168, v242, v248
v_lshlrev_b32 v242, 16, v169
v_and_b32 v248, 0xffff0000, v169
v_mul_f32 v242, v242, v238
v_mul_f32 v248, v248, v238
v_cvt_pk_bf16_f32 v169, v242, v248
ds_read_b64 v[250:251], v231 offset:2048
s_waitcnt lgkmcnt(0)
v_lshlrev_b32 v242, 16, v250
v_and_b32 v248, 0xffff0000, v250
v_mul_f32 v242, v242, v238
v_mul_f32 v248, v248, v238
v_cvt_pk_bf16_f32 v250, v242, v248
v_lshlrev_b32 v242, 16, v251
v_and_b32 v248, 0xffff0000, v251
v_mul_f32 v242, v242, v238
v_mul_f32 v248, v248, v238
v_cvt_pk_bf16_f32 v251, v242, v248
ds_write_b64 v231, v[250:251] offset:2048
s_waitcnt lgkmcnt(0)
ds_read_b64 v[250:251], v231 offset:2056
s_waitcnt lgkmcnt(0)
v_lshlrev_b32 v242, 16, v250
v_and_b32 v248, 0xffff0000, v250
v_mul_f32 v242, v242, v238
v_mul_f32 v248, v248, v238
v_cvt_pk_bf16_f32 v250, v242, v248
v_lshlrev_b32 v242, 16, v251
v_and_b32 v248, 0xffff0000, v251
v_mul_f32 v242, v242, v238
v_mul_f32 v248, v248, v238
v_cvt_pk_bf16_f32 v251, v242, v248
ds_write_b64 v231, v[250:251] offset:2056
s_waitcnt lgkmcnt(0)
ds_read_b64 v[250:251], v231 offset:6144
s_waitcnt lgkmcnt(0)
v_lshlrev_b32 v242, 16, v250
v_and_b32 v248, 0xffff0000, v250
v_mul_f32 v242, v242, v238
v_mul_f32 v248, v248, v238
v_cvt_pk_bf16_f32 v250, v242, v248
v_lshlrev_b32 v242, 16, v251
v_and_b32 v248, 0xffff0000, v251
v_mul_f32 v242, v242, v238
v_mul_f32 v248, v248, v238
v_cvt_pk_bf16_f32 v251, v242, v248
ds_write_b64 v231, v[250:251] offset:6144
s_waitcnt lgkmcnt(0)
ds_read_b64 v[250:251], v231 offset:6152
s_waitcnt lgkmcnt(0)
v_lshlrev_b32 v242, 16, v250
v_and_b32 v248, 0xffff0000, v250
v_mul_f32 v242, v242, v238
v_mul_f32 v248, v248, v238
v_cvt_pk_bf16_f32 v250, v242, v248
v_lshlrev_b32 v242, 16, v251
v_and_b32 v248, 0xffff0000, v251
v_mul_f32 v242, v242, v238
v_mul_f32 v248, v248, v238
v_cvt_pk_bf16_f32 v251, v242, v248
ds_write_b64 v231, v[250:251] offset:6152
s_waitcnt lgkmcnt(0)
v_exp_f32 v248, v156
s_nop 0
v_sub_f32 v227, v227, v248
v_exp_f32 v248, v157
s_nop 0
v_sub_f32 v227, v227, v248
v_exp_f32 v248, v158
s_nop 0
v_sub_f32 v227, v227, v248
v_exp_f32 v248, v159
s_nop 0
v_sub_f32 v227, v227, v248
v_max_f32 v227, 0, v227
v_min_f32 v227, s32, v227
v_log_f32 v248, v227
v_max3_f32 v235, v156, v157, v158
v_max3_f32 v235, v235, v159, v248
v_mov_b32 v248, v235
s_nop 1
v_permlane32_swap_b32 v235, v248
s_nop 1
v_max_f32 v235, v235, v248
v_mov_b32 v248, v235
s_nop 1
v_permlane16_swap_b32 v235, v248
s_nop 1
v_max_f32 v235, v235, v248
v_ceil_f32 v235, v235
v_max_f32 v235, 0, v235
v_sub_f32 v248, 0, v235
v_exp_f32 v239, v248
s_nop 1
v_mul_f32 v227, v227, v239
v_sub_f32 v204, v204, v235
v_sub_f32 v140, v140, v235
v_sub_f32 v156, v156, v235
v_sub_f32 v205, v205, v235
v_sub_f32 v141, v141, v235
v_sub_f32 v157, v157, v235
v_sub_f32 v206, v206, v235
v_sub_f32 v142, v142, v235
v_sub_f32 v158, v158, v235
v_sub_f32 v207, v207, v235
v_sub_f32 v143, v143, v235
v_sub_f32 v159, v159, v235
v_lshlrev_b32 v242, 16, v188
v_and_b32 v248, 0xffff0000, v188
v_mul_f32 v242, v242, v239
v_mul_f32 v248, v248, v239
v_cvt_pk_bf16_f32 v188, v242, v248
v_lshlrev_b32 v242, 16, v189
v_and_b32 v248, 0xffff0000, v189
v_mul_f32 v242, v242, v239
v_mul_f32 v248, v248, v239
v_cvt_pk_bf16_f32 v189, v242, v248
v_lshlrev_b32 v242, 16, v190
v_and_b32 v248, 0xffff0000, v190
v_mul_f32 v242, v242, v239
v_mul_f32 v248, v248, v239
v_cvt_pk_bf16_f32 v190, v242, v248
v_lshlrev_b32 v242, 16, v191
v_and_b32 v248, 0xffff0000, v191
v_mul_f32 v242, v242, v239
v_mul_f32 v248, v248, v239
v_cvt_pk_bf16_f32 v191, v242, v248
v_lshlrev_b32 v242, 16, v172
v_and_b32 v248, 0xffff0000, v172
v_mul_f32 v242, v242, v239
v_mul_f32 v248, v248, v239
v_cvt_pk_bf16_f32 v172, v242, v248
v_lshlrev_b32 v242, 16, v173
v_and_b32 v248, 0xffff0000, v173
v_mul_f32 v242, v242, v239
v_mul_f32 v248, v248, v239
v_cvt_pk_bf16_f32 v173, v242, v248
ds_read_b64 v[250:251], v231 offset:3072
s_waitcnt lgkmcnt(0)
v_lshlrev_b32 v242, 16, v250
v_and_b32 v248, 0xffff0000, v250
v_mul_f32 v242, v242, v239
v_mul_f32 v248, v248, v239
v_cvt_pk_bf16_f32 v250, v242, v248
v_lshlrev_b32 v242, 16, v251
v_and_b32 v248, 0xffff0000, v251
v_mul_f32 v242, v242, v239
v_mul_f32 v248, v248, v239
v_cvt_pk_bf16_f32 v251, v242, v248
ds_write_b64 v231, v[250:251] offset:3072
s_waitcnt lgkmcnt(0)
ds_read_b64 v[250:251], v231 offset:3080
s_waitcnt lgkmcnt(0)
v_lshlrev_b32 v242, 16, v250
v_and_b32 v248, 0xffff0000, v250
v_mul_f32 v242, v242, v239
v_mul_f32 v248, v248, v239
v_cvt_pk_bf16_f32 v250, v242, v248
v_lshlrev_b32 v242, 16, v251
v_and_b32 v248, 0xffff0000, v251
v_mul_f32 v242, v242, v239
v_mul_f32 v248, v248, v239
v_cvt_pk_bf16_f32 v251, v242, v248
ds_write_b64 v231, v[250:251] offset:3080
s_waitcnt lgkmcnt(0)
ds_read_b64 v[250:251], v231 offset:7168
s_waitcnt lgkmcnt(0)
v_lshlrev_b32 v242, 16, v250
v_and_b32 v248, 0xffff0000, v250
v_mul_f32 v242, v242, v239
v_mul_f32 v248, v248, v239
v_cvt_pk_bf16_f32 v250, v242, v248
v_lshlrev_b32 v242, 16, v251
v_and_b32 v248, 0xffff0000, v251
v_mul_f32 v242, v242, v239
v_mul_f32 v248, v248, v239
v_cvt_pk_bf16_f32 v251, v242, v248
ds_write_b64 v231, v[250:251] offset:7168
s_waitcnt lgkmcnt(0)
ds_read_b64 v[250:251], v231 offset:7176
s_waitcnt lgkmcnt(0)
v_lshlrev_b32 v242, 16, v250
v_and_b32 v248, 0xffff0000, v250
v_mul_f32 v242, v242, v239
v_mul_f32 v248, v248, v239
v_cvt_pk_bf16_f32 v250, v242, v248
v_lshlrev_b32 v242, 16, v251
v_and_b32 v248, 0xffff0000, v251
v_mul_f32 v242, v242, v239
v_mul_f32 v248, v248, v239
v_cvt_pk_bf16_f32 v251, v242, v248
ds_write_b64 v231, v[250:251] offset:7176
s_waitcnt lgkmcnt(0)
v_exp_f32 v232, v144
v_exp_f32 v233, v145
v_exp_f32 v234, v146
v_exp_f32 v235, v147
s_nop 1
v_add_f32 v224, v224, v232
v_add_f32 v224, v224, v233
v_add_f32 v224, v224, v234
v_add_f32 v224, v224, v235
v_cvt_pk_bf16_f32 v162, v232, v233
v_cvt_pk_bf16_f32 v163, v234, v235
v_exp_f32 v232, v148
v_exp_f32 v233, v149
v_exp_f32 v234, v150
v_exp_f32 v235, v151
s_nop 1
v_add_f32 v225, v225, v232
v_add_f32 v225, v225, v233
v_add_f32 v225, v225, v234
v_add_f32 v225, v225, v235
v_cvt_pk_bf16_f32 v166, v232, v233
v_cvt_pk_bf16_f32 v167, v234, v235
v_exp_f32 v232, v152
v_exp_f32 v233, v153
v_exp_f32 v234, v154
v_exp_f32 v235, v155
s_nop 1
v_add_f32 v226, v226, v232
v_add_f32 v226, v226, v233
v_add_f32 v226, v226, v234
v_add_f32 v226, v226, v235
v_cvt_pk_bf16_f32 v170, v232, v233
v_cvt_pk_bf16_f32 v171, v234, v235
v_exp_f32 v232, v156
v_exp_f32 v233, v157
v_exp_f32 v234, v158
v_exp_f32 v235, v159
s_nop 1
v_add_f32 v227, v227, v232
v_add_f32 v227, v227, v233
v_add_f32 v227, v227, v234
v_add_f32 v227, v227, v235
v_cvt_pk_bf16_f32 v174, v232, v233
v_cvt_pk_bf16_f32 v175, v234, v235
s_branch L2_rare_common
L2_rare_site10:
s_mov_b32 s36, 10
s_branch L2_rare_t1_4_0
L2_rare_t1_4_0:
s_nop 15
s_nop 15
s_waitcnt lgkmcnt(0)
v_exp_f32 v248, v128
s_nop 0
v_sub_f32 v224, v224, v248
v_exp_f32 v248, v129
s_nop 0
v_sub_f32 v224, v224, v248
v_exp_f32 v248, v130
s_nop 0
v_sub_f32 v224, v224, v248
v_exp_f32 v248, v131
s_nop 0
v_sub_f32 v224, v224, v248
v_max_f32 v224, 0, v224
v_min_f32 v224, s32, v224
v_log_f32 v248, v224
v_max3_f32 v232, v128, v129, v130
v_max3_f32 v232, v232, v131, v248
v_mov_b32 v248, v232
s_nop 1
v_permlane32_swap_b32 v232, v248
s_nop 1
v_max_f32 v232, v232, v248
v_mov_b32 v248, v232
s_nop 1
v_permlane16_swap_b32 v232, v248
s_nop 1
v_max_f32 v232, v232, v248
v_ceil_f32 v232, v232
v_max_f32 v232, 0, v232
v_sub_f32 v248, 0, v232
v_exp_f32 v236, v248
s_nop 1
v_mul_f32 v224, v224, v236
v_sub_f32 v192, v192, v232
v_sub_f32 v128, v128, v232
v_sub_f32 v144, v144, v232
v_sub_f32 v193, v193, v232
v_sub_f32 v129, v129, v232
v_sub_f32 v145, v145, v232
v_sub_f32 v194, v194, v232
v_sub_f32 v130, v130, v232
v_sub_f32 v146, v146, v232
v_sub_f32 v195, v195, v232
v_sub_f32 v131, v131, v232
v_sub_f32 v147, v147, v232
v_lshlrev_b32 v242, 16, v4
v_and_b32 v248, 0xffff0000, v4
v_mul_f32 v242, v242, v236
v_mul_f32 v248, v248, v236
v_cvt_pk_bf16_f32 v4, v242, v248
v_lshlrev_b32 v242, 16, v5
v_and_b32 v248, 0xffff0000, v5
v_mul_f32 v242, v242, v236
v_mul_f32 v248, v248, v236
v_cvt_pk_bf16_f32 v5, v242, v248
v_lshlrev_b32 v242, 16, v6
v_and_b32 v248, 0xffff0000, v6
v_mul_f32 v242, v242, v236
v_mul_f32 v248, v248, v236
v_cvt_pk_bf16_f32 v6, v242, v248
v_lshlrev_b32 v242, 16, v7
v_and_b32 v248, 0xffff0000, v7
v_mul_f32 v242, v242, v236
v_mul_f32 v248, v248, v236
v_cvt_pk_bf16_f32 v7, v242, v248
v_lshlrev_b32 v242, 16, v8
v_and_b32 v248, 0xffff0000, v8
v_mul_f32 v242, v242, v236
v_mul_f32 v248, v248, v236
v_cvt_pk_bf16_f32 v8, v242, v248
v_lshlrev_b32 v242, 16, v9
v_and_b32 v248, 0xffff0000, v9
v_mul_f32 v242, v242, v236
v_mul_f32 v248, v248, v236
v_cvt_pk_bf16_f32 v9, v242, v248
v_lshlrev_b32 v242, 16, v10
v_and_b32 v248, 0xffff0000, v10
v_mul_f32 v242, v242, v236
v_mul_f32 v248, v248, v236
v_cvt_pk_bf16_f32 v10, v242, v248
v_lshlrev_b32 v242, 16, v11
v_and_b32 v248, 0xffff0000, v11
v_mul_f32 v242, v242, v236
v_mul_f32 v248, v248, v236
v_cvt_pk_bf16_f32 v11, v242, v248
v_lshlrev_b32 v242, 16, v176
v_and_b32 v248, 0xffff0000, v176
v_mul_f32 v242, v242, v236
v_mul_f32 v248, v248, v236
v_cvt_pk_bf16_f32 v176, v242, v248
v_lshlrev_b32 v242, 16, v177
v_and_b32 v248, 0xffff0000, v177
v_mul_f32 v242, v242, v236
v_mul_f32 v248, v248, v236
v_cvt_pk_bf16_f32 v177, v242, v248
v_lshlrev_b32 v242, 16, v178
v_and_b32 v248, 0xffff0000, v178
v_mul_f32 v242, v242, v236
v_mul_f32 v248, v248, v236
v_cvt_pk_bf16_f32 v178, v242, v248
v_lshlrev_b32 v242, 16, v179
v_and_b32 v248, 0xffff0000, v179
v_mul_f32 v242, v242, v236
v_mul_f32 v248, v248, v236
v_cvt_pk_bf16_f32 v179, v242, v248
v_lshlrev_b32 v242, 16, v160
v_and_b32 v248, 0xffff0000, v160
v_mul_f32 v242, v242, v236
v_mul_f32 v248, v248, v236
v_cvt_pk_bf16_f32 v160, v242, v248
v_lshlrev_b32 v242, 16, v161
v_and_b32 v248, 0xffff0000, v161
v_mul_f32 v242, v242, v236
v_mul_f32 v248, v248, v236
v_cvt_pk_bf16_f32 v161, v242, v248
v_lshlrev_b32 v242, 16, v162
v_and_b32 v248, 0xffff0000, v162
v_mul_f32 v242, v242, v236
v_mul_f32 v248, v248, v236
v_cvt_pk_bf16_f32 v162, v242, v248
v_lshlrev_b32 v242, 16, v163
v_and_b32 v248, 0xffff0000, v163
v_mul_f32 v242, v242, v236
v_mul_f32 v248, v248, v236
v_cvt_pk_bf16_f32 v163, v242, v248
v_exp_f32 v248, v132
s_nop 0
v_sub_f32 v225, v225, v248
v_exp_f32 v248, v133
s_nop 0
v_sub_f32 v225, v225, v248
v_exp_f32 v248, v134
s_nop 0
v_sub_f32 v225, v225, v248
v_exp_f32 v248, v135
s_nop 0
v_sub_f32 v225, v225, v248
v_max_f32 v225, 0, v225
v_min_f32 v225, s32, v225
v_log_f32 v248, v225
v_max3_f32 v233, v132, v133, v134
v_max3_f32 v233, v233, v135, v248
v_mov_b32 v248, v233
s_nop 1
v_permlane32_swap_b32 v233, v248
s_nop 1
v_max_f32 v233, v233, v248
v_mov_b32 v248, v233
s_nop 1
v_permlane16_swap_b32 v233, v248
s_nop 1
v_max_f32 v233, v233, v248
v_ceil_f32 v233, v233
v_max_f32 v233, 0, v233
v_sub_f32 v248, 0, v233
v_exp_f32 v237, v248
s_nop 1
v_mul_f32 v225, v225, v237
v_sub_f32 v196, v196, v233
v_sub_f32 v132, v132, v233
v_sub_f32 v148, v148, v233
v_sub_f32 v197, v197, v233
v_sub_f32 v133, v133, v233
v_sub_f32 v149, v149, v233
v_sub_f32 v198, v198, v233
v_sub_f32 v134, v134, v233
v_sub_f32 v150, v150, v233
v_sub_f32 v199, v199, v233
v_sub_f32 v135, v135, v233
v_sub_f32 v151, v151, v233
v_lshlrev_b32 v242, 16, v36
v_and_b32 v248, 0xffff0000, v36
v_mul_f32 v242, v242, v237
v_mul_f32 v248, v248, v237
v_cvt_pk_bf16_f32 v36, v242, v248
v_lshlrev_b32 v242, 16, v37
v_and_b32 v248, 0xffff0000, v37
v_mul_f32 v242, v242, v237
v_mul_f32 v248, v248, v237
v_cvt_pk_bf16_f32 v37, v242, v248
v_lshlrev_b32 v242, 16, v38
v_and_b32 v248, 0xffff0000, v38
v_mul_f32 v242, v242, v237
v_mul_f32 v248, v248, v237
v_cvt_pk_bf16_f32 v38, v242, v248
v_lshlrev_b32 v242, 16, v39
v_and_b32 v248, 0xffff0000, v39
v_mul_f32 v242, v242, v237
v_mul_f32 v248, v248, v237
v_cvt_pk_bf16_f32 v39, v242, v248
v_lshlrev_b32 v242, 16, v40
v_and_b32 v248, 0xffff0000, v40
v_mul_f32 v242, v242, v237
v_mul_f32 v248, v248, v237
v_cvt_pk_bf16_f32 v40, v242, v248
v_lshlrev_b32 v242, 16, v41
v_and_b32 v248, 0xffff0000, v41
v_mul_f32 v242, v242, v237
v_mul_f32 v248, v248, v237
v_cvt_pk_bf16_f32 v41, v242, v248
v_lshlrev_b32 v242, 16, v42
v_and_b32 v248, 0xffff0000, v42
v_mul_f32 v242, v242, v237
v_mul_f32 v248, v248, v237
v_cvt_pk_bf16_f32 v42, v242, v248
v_lshlrev_b32 v242, 16, v43
v_and_b32 v248, 0xffff0000, v43
v_mul_f32 v242, v242, v237
v_mul_f32 v248, v248, v237
v_cvt_pk_bf16_f32 v43, v242, v248
v_lshlrev_b32 v242, 16, v180
v_and_b32 v248, 0xffff0000, v180
v_mul_f32 v242, v242, v237
v_mul_f32 v248, v248, v237
v_cvt_pk_bf16_f32 v180, v242, v248
v_lshlrev_b32 v242, 16, v181
v_and_b32 v248, 0xffff0000, v181
v_mul_f32 v242, v242, v237
v_mul_f32 v248, v248, v237
v_cvt_pk_bf16_f32 v181, v242, v248
v_lshlrev_b32 v242, 16, v182
v_and_b32 v248, 0xffff0000, v182
v_mul_f32 v242, v242, v237
v_mul_f32 v248, v248, v237
v_cvt_pk_bf16_f32 v182, v242, v248
v_lshlrev_b32 v242, 16, v183
v_and_b32 v248, 0xffff0000, v183
v_mul_f32 v242, v242, v237
v_mul_f32 v248, v248, v237
v_cvt_pk_bf16_f32 v183, v242, v248
v_lshlrev_b32 v242, 16, v164
v_and_b32 v248, 0xffff0000, v164
v_mul_f32 v242, v242, v237
v_mul_f32 v248, v248, v237
v_cvt_pk_bf16_f32 v164, v242, v248
v_lshlrev_b32 v242, 16, v165
v_and_b32 v248, 0xffff0000, v165
v_mul_f32 v242, v242, v237
v_mul_f32 v248, v248, v237
v_cvt_pk_bf16_f32 v165, v242, v248
v_lshlrev_b32 v242, 16, v166
v_and_b32 v248, 0xffff0000, v166
v_mul_f32 v242, v242, v237
v_mul_f32 v248, v248, v237
v_cvt_pk_bf16_f32 v166, v242, v248
v_lshlrev_b32 v242, 16, v167
v_and_b32 v248, 0xffff0000, v167
v_mul_f32 v242, v242, v237
v_mul_f32 v248, v248, v237
v_cvt_pk_bf16_f32 v167, v242, v248
v_exp_f32 v248, v136
s_nop 0
v_sub_f32 v226, v226, v248
v_exp_f32 v248, v137
s_nop 0
v_sub_f32 v226, v226, v248
v_exp_f32 v248, v138
s_nop 0
v_sub_f32 v226, v226, v248
v_exp_f32 v248, v139
s_nop 0
v_sub_f32 v226, v226, v248
v_max_f32 v226, 0, v226
v_min_f32 v226, s32, v226
v_log_f32 v248, v226
v_max3_f32 v234, v136, v137, v138
v_max3_f32 v234, v234, v139, v248
v_mov_b32 v248, v234
s_nop 1
v_permlane32_swap_b32 v234, v248
s_nop 1
v_max_f32 v234, v234, v248
v_mov_b32 v248, v234
s_nop 1
v_permlane16_swap_b32 v234, v248
s_nop 1
v_max_f32 v234, v234, v248
v_ceil_f32 v234, v234
v_max_f32 v234, 0, v234
v_sub_f32 v248, 0, v234
v_exp_f32 v238, v248
s_nop 1
v_mul_f32 v226, v226, v238
v_sub_f32 v200, v200, v234
v_sub_f32 v136, v136, v234
v_sub_f32 v152, v152, v234
v_sub_f32 v201, v201, v234
v_sub_f32 v137, v137, v234
v_sub_f32 v153, v153, v234
v_sub_f32 v202, v202, v234
v_sub_f32 v138, v138, v234
v_sub_f32 v154, v154, v234
v_sub_f32 v203, v203, v234
v_sub_f32 v139, v139, v234
v_sub_f32 v155, v155, v234
v_lshlrev_b32 v242, 16, v68
v_and_b32 v248, 0xffff0000, v68
v_mul_f32 v242, v242, v238
v_mul_f32 v248, v248, v238
v_cvt_pk_bf16_f32 v68, v242, v248
v_lshlrev_b32 v242, 16, v69
v_and_b32 v248, 0xffff0000, v69
v_mul_f32 v242, v242, v238
v_mul_f32 v248, v248, v238
v_cvt_pk_bf16_f32 v69, v242, v248
v_lshlrev_b32 v242, 16, v70
v_and_b32 v248, 0xffff0000, v70
v_mul_f32 v242, v242, v238
v_mul_f32 v248, v248, v238
v_cvt_pk_bf16_f32 v70, v242, v248
v_lshlrev_b32 v242, 16, v71
v_and_b32 v248, 0xffff0000, v71
v_mul_f32 v242, v242, v238
v_mul_f32 v248, v248, v238
v_cvt_pk_bf16_f32 v71, v242, v248
v_lshlrev_b32 v242, 16, v72
v_and_b32 v248, 0xffff0000, v72
v_mul_f32 v242, v242, v238
v_mul_f32 v248, v248, v238
v_cvt_pk_bf16_f32 v72, v242, v248
v_lshlrev_b32 v242, 16, v73
v_and_b32 v248, 0xffff0000, v73
v_mul_f32 v242, v242, v238
v_mul_f32 v248, v248, v238
v_cvt_pk_bf16_f32 v73, v242, v248
v_lshlrev_b32 v242, 16, v74
v_and_b32 v248, 0xffff0000, v74
v_mul_f32 v242, v242, v238
v_mul_f32 v248, v248, v238
v_cvt_pk_bf16_f32 v74, v242, v248
v_lshlrev_b32 v242, 16, v75
v_and_b32 v248, 0xffff0000, v75
v_mul_f32 v242, v242, v238
v_mul_f32 v248, v248, v238
v_cvt_pk_bf16_f32 v75, v242, v248
v_lshlrev_b32 v242, 16, v184
v_and_b32 v248, 0xffff0000, v184
v_mul_f32 v242, v242, v238
v_mul_f32 v248, v248, v238
v_cvt_pk_bf16_f32 v184, v242, v248
v_lshlrev_b32 v242, 16, v185
v_and_b32 v248, 0xffff0000, v185
v_mul_f32 v242, v242, v238
v_mul_f32 v248, v248, v238
v_cvt_pk_bf16_f32 v185, v242, v248
v_lshlrev_b32 v242, 16, v186
v_and_b32 v248, 0xffff0000, v186
v_mul_f32 v242, v242, v238
v_mul_f32 v248, v248, v238
v_cvt_pk_bf16_f32 v186, v242, v248
v_lshlrev_b32 v242, 16, v187
v_and_b32 v248, 0xffff0000, v187
v_mul_f32 v242, v242, v238
v_mul_f32 v248, v248, v238
v_cvt_pk_bf16_f32 v187, v242, v248
v_lshlrev_b32 v242, 16, v168
v_and_b32 v248, 0xffff0000, v168
v_mul_f32 v242, v242, v238
v_mul_f32 v248, v248, v238
v_cvt_pk_bf16_f32 v168, v242, v248
v_lshlrev_b32 v242, 16, v169
v_and_b32 v248, 0xffff0000, v169
v_mul_f32 v242, v242, v238
v_mul_f32 v248, v248, v238
v_cvt_pk_bf16_f32 v169, v242, v248
v_lshlrev_b32 v242, 16, v170
v_and_b32 v248, 0xffff0000, v170
v_mul_f32 v242, v242, v238
v_mul_f32 v248, v248, v238
v_cvt_pk_bf16_f32 v170, v242, v248
v_lshlrev_b32 v242, 16, v171
v_and_b32 v248, 0xffff0000, v171
v_mul_f32 v242, v242, v238
v_mul_f32 v248, v248, v238
v_cvt_pk_bf16_f32 v171, v242, v248
v_exp_f32 v248, v140
s_nop 0
v_sub_f32 v227, v227, v248
v_exp_f32 v248, v141
s_nop 0
v_sub_f32 v227, v227, v248
v_exp_f32 v248, v142
s_nop 0
v_sub_f32 v227, v227, v248
v_exp_f32 v248, v143
s_nop 0
v_sub_f32 v227, v227, v248
v_max_f32 v227, 0, v227
v_min_f32 v227, s32, v227
v_log_f32 v248, v227
v_max3_f32 v235, v140, v141, v142
v_max3_f32 v235, v235, v143, v248
v_mov_b32 v248, v235
s_nop 1
v_permlane32_swap_b32 v235, v248
s_nop 1
v_max_f32 v235, v235, v248
v_mov_b32 v248, v235
s_nop 1
v_permlane16_swap_b32 v235, v248
s_nop 1
v_max_f32 v235, v235, v248
v_ceil_f32 v235, v235
v_max_f32 v235, 0, v235
v_sub_f32 v248, 0, v235
v_exp_f32 v239, v248
s_nop 1
v_mul_f32 v227, v227, v239
v_sub_f32 v204, v204, v235
v_sub_f32 v140, v140, v235
v_sub_f32 v156, v156, v235
v_sub_f32 v205, v205, v235
v_sub_f32 v141, v141, v235
v_sub_f32 v157, v157, v235
v_sub_f32 v206, v206, v235
v_sub_f32 v142, v142, v235
v_sub_f32 v158, v158, v235
v_sub_f32 v207, v207, v235
v_sub_f32 v143, v143, v235
v_sub_f32 v159, v159, v235
v_lshlrev_b32 v242, 16, v100
v_and_b32 v248, 0xffff0000, v100
v_mul_f32 v242, v242, v239
v_mul_f32 v248, v248, v239
v_cvt_pk_bf16_f32 v100, v242, v248
v_lshlrev_b32 v242, 16, v101
v_and_b32 v248, 0xffff0000, v101
v_mul_f32 v242, v242, v239
v_mul_f32 v248, v248, v239
v_cvt_pk_bf16_f32 v101, v242, v248
v_lshlrev_b32 v242, 16, v102
v_and_b32 v248, 0xffff0000, v102
v_mul_f32 v242, v242, v239
v_mul_f32 v248, v248, v239
v_cvt_pk_bf16_f32 v102, v242, v248
v_lshlrev_b32 v242, 16, v103
v_and_b32 v248, 0xffff0000, v103
v_mul_f32 v242, v242, v239
v_mul_f32 v248, v248, v239
v_cvt_pk_bf16_f32 v103, v242, v248
v_lshlrev_b32 v242, 16, v104
v_and_b32 v248, 0xffff0000, v104
v_mul_f32 v242, v242, v239
v_mul_f32 v248, v248, v239
v_cvt_pk_bf16_f32 v104, v242, v248
v_lshlrev_b32 v242, 16, v105
v_and_b32 v248, 0xffff0000, v105
v_mul_f32 v242, v242, v239
v_mul_f32 v248, v248, v239
v_cvt_pk_bf16_f32 v105, v242, v248
v_lshlrev_b32 v242, 16, v106
v_and_b32 v248, 0xffff0000, v106
v_mul_f32 v242, v242, v239
v_mul_f32 v248, v248, v239
v_cvt_pk_bf16_f32 v106, v242, v248
v_lshlrev_b32 v242, 16, v107
v_and_b32 v248, 0xffff0000, v107
v_mul_f32 v242, v242, v239
v_mul_f32 v248, v248, v239
v_cvt_pk_bf16_f32 v107, v242, v248
v_lshlrev_b32 v242, 16, v188
v_and_b32 v248, 0xffff0000, v188
v_mul_f32 v242, v242, v239
v_mul_f32 v248, v248, v239
v_cvt_pk_bf16_f32 v188, v242, v248
v_lshlrev_b32 v242, 16, v189
v_and_b32 v248, 0xffff0000, v189
v_mul_f32 v242, v242, v239
v_mul_f32 v248, v248, v239
v_cvt_pk_bf16_f32 v189, v242, v248
v_lshlrev_b32 v242, 16, v190
v_and_b32 v248, 0xffff0000, v190
v_mul_f32 v242, v242, v239
v_mul_f32 v248, v248, v239
v_cvt_pk_bf16_f32 v190, v242, v248
v_lshlrev_b32 v242, 16, v191
v_and_b32 v248, 0xffff0000, v191
v_mul_f32 v242, v242, v239
v_mul_f32 v248, v248, v239
v_cvt_pk_bf16_f32 v191, v242, v248
v_lshlrev_b32 v242, 16, v172
v_and_b32 v248, 0xffff0000, v172
v_mul_f32 v242, v242, v239
v_mul_f32 v248, v248, v239
v_cvt_pk_bf16_f32 v172, v242, v248
v_lshlrev_b32 v242, 16, v173
v_and_b32 v248, 0xffff0000, v173
v_mul_f32 v242, v242, v239
v_mul_f32 v248, v248, v239
v_cvt_pk_bf16_f32 v173, v242, v248
v_lshlrev_b32 v242, 16, v174
v_and_b32 v248, 0xffff0000, v174
v_mul_f32 v242, v242, v239
v_mul_f32 v248, v248, v239
v_cvt_pk_bf16_f32 v174, v242, v248
v_lshlrev_b32 v242, 16, v175
v_and_b32 v248, 0xffff0000, v175
v_mul_f32 v242, v242, v239
v_mul_f32 v248, v248, v239
v_cvt_pk_bf16_f32 v175, v242, v248
v_exp_f32 v232, v128
v_exp_f32 v233, v129
v_exp_f32 v234, v130
v_exp_f32 v235, v131
s_nop 1
v_add_f32 v224, v224, v232
v_add_f32 v224, v224, v233
v_add_f32 v224, v224, v234
v_add_f32 v224, v224, v235
v_cvt_pk_bf16_f32 v0, v232, v233
v_cvt_pk_bf16_f32 v1, v234, v235
v_exp_f32 v232, v132
v_exp_f32 v233, v133
v_exp_f32 v234, v134
v_exp_f32 v235, v135
s_nop 1
v_add_f32 v225, v225, v232
v_add_f32 v225, v225, v233
v_add_f32 v225, v225, v234
v_add_f32 v225, v225, v235
v_cvt_pk_bf16_f32 v32, v232, v233
v_cvt_pk_bf16_f32 v33, v234, v235
v_exp_f32 v232, v136
v_exp_f32 v233, v137
v_exp_f32 v234, v138
v_exp_f32 v235, v139
s_nop 1
v_add_f32 v226, v226, v232
v_add_f32 v226, v226, v233
v_add_f32 v226, v226, v234
v_add_f32 v226, v226, v235
v_cvt_pk_bf16_f32 v64, v232, v233
v_cvt_pk_bf16_f32 v65, v234, v235
v_exp_f32 v232, v140
v_exp_f32 v233, v141
v_exp_f32 v234, v142
v_exp_f32 v235, v143
s_nop 1
v_add_f32 v227, v227, v232
v_add_f32 v227, v227, v233
v_add_f32 v227, v227, v234
v_add_f32 v227, v227, v235
v_cvt_pk_bf16_f32 v96, v232, v233
v_cvt_pk_bf16_f32 v97, v234, v235
s_branch L2_rare_common
L2_rare_site11:
s_mov_b32 s36, 11
s_branch L2_rare_t1_5_1
L2_rare_t1_5_1:
s_nop 15
s_nop 15
s_waitcnt lgkmcnt(0)
v_exp_f32 v248, v144
s_nop 0
v_sub_f32 v224, v224, v248
v_exp_f32 v248, v145
s_nop 0
v_sub_f32 v224, v224, v248
v_exp_f32 v248, v146
s_nop 0
v_sub_f32 v224, v224, v248
v_exp_f32 v248, v147
s_nop 0
v_sub_f32 v224, v224, v248
v_max_f32 v224, 0, v224
v_min_f32 v224, s32, v224
v_log_f32 v248, v224
v_max3_f32 v232, v144, v145, v146
v_max3_f32 v232, v232, v147, v248
v_mov_b32 v248, v232
s_nop 1
v_permlane32_swap_b32 v232, v248
s_nop 1
v_max_f32 v232, v232, v248
v_mov_b32 v248, v232
s_nop 1
v_permlane16_swap_b32 v232, v248
s_nop 1
v_max_f32 v232, v232, v248
v_ceil_f32 v232, v232
v_max_f32 v232, 0, v232
v_sub_f32 v248, 0, v232
v_exp_f32 v236, v248
s_nop 1
v_mul_f32 v224, v224, v236
v_sub_f32 v192, v192, v232
v_sub_f32 v128, v128, v232
v_sub_f32 v144, v144, v232
v_sub_f32 v193, v193, v232
v_sub_f32 v129, v129, v232
v_sub_f32 v145, v145, v232
v_sub_f32 v194, v194, v232
v_sub_f32 v130, v130, v232
v_sub_f32 v146, v146, v232
v_sub_f32 v195, v195, v232
v_sub_f32 v131, v131, v232
v_sub_f32 v147, v147, v232
v_lshlrev_b32 v242, 16, v4
v_and_b32 v248, 0xffff0000, v4
v_mul_f32 v242, v242, v236
v_mul_f32 v248, v248, v236
v_cvt_pk_bf16_f32 v4, v242, v248
v_lshlrev_b32 v242, 16, v5
v_and_b32 v248, 0xffff0000, v5
v_mul_f32 v242, v242, v236
v_mul_f32 v248, v248, v236
v_cvt_pk_bf16_f32 v5, v242, v248
v_lshlrev_b32 v242, 16, v6
v_and_b32 v248, 0xffff0000, v6
v_mul_f32 v242, v242, v236
v_mul_f32 v248, v248, v236
v_cvt_pk_bf16_f32 v6, v242, v248
v_lshlrev_b32 v242, 16, v7
v_and_b32 v248, 0xffff0000, v7
v_mul_f32 v242, v242, v236
v_mul_f32 v248, v248, v236
v_cvt_pk_bf16_f32 v7, v242, v248
v_lshlrev_b32 v242, 16, v8
v_and_b32 v248, 0xffff0000, v8
v_mul_f32 v242, v242, v236
v_mul_f32 v248, v248, v236
v_cvt_pk_bf16_f32 v8, v242, v248
v_lshlrev_b32 v242, 16, v9
v_and_b32 v248, 0xffff0000, v9
v_mul_f32 v242, v242, v236
v_mul_f32 v248, v248, v236
v_cvt_pk_bf16_f32 v9, v242, v248
v_lshlrev_b32 v242, 16, v10
v_and_b32 v248, 0xffff0000, v10
v_mul_f32 v242, v242, v236
v_mul_f32 v248, v248, v236
v_cvt_pk_bf16_f32 v10, v242, v248
v_lshlrev_b32 v242, 16, v11
v_and_b32 v248, 0xffff0000, v11
v_mul_f32 v242, v242, v236
v_mul_f32 v248, v248, v236
v_cvt_pk_bf16_f32 v11, v242, v248
v_lshlrev_b32 v242, 16, v176
v_and_b32 v248, 0xffff0000, v176
v_mul_f32 v242, v242, v236
v_mul_f32 v248, v248, v236
v_cvt_pk_bf16_f32 v176, v242, v248
v_lshlrev_b32 v242, 16, v177
v_and_b32 v248, 0xffff0000, v177
v_mul_f32 v242, v242, v236
v_mul_f32 v248, v248, v236
v_cvt_pk_bf16_f32 v177, v242, v248
v_lshlrev_b32 v242, 16, v178
v_and_b32 v248, 0xffff0000, v178
v_mul_f32 v242, v242, v236
v_mul_f32 v248, v248, v236
v_cvt_pk_bf16_f32 v178, v242, v248
v_lshlrev_b32 v242, 16, v179
v_and_b32 v248, 0xffff0000, v179
v_mul_f32 v242, v242, v236
v_mul_f32 v248, v248, v236
v_cvt_pk_bf16_f32 v179, v242, v248
v_lshlrev_b32 v242, 16, v160
v_and_b32 v248, 0xffff0000, v160
v_mul_f32 v242, v242, v236
v_mul_f32 v248, v248, v236
v_cvt_pk_bf16_f32 v160, v242, v248
v_lshlrev_b32 v242, 16, v161
v_and_b32 v248, 0xffff0000, v161
v_mul_f32 v242, v242, v236
v_mul_f32 v248, v248, v236
v_cvt_pk_bf16_f32 v161, v242, v248
v_lshlrev_b32 v242, 16, v162
v_and_b32 v248, 0xffff0000, v162
v_mul_f32 v242, v242, v236
v_mul_f32 v248, v248, v236
v_cvt_pk_bf16_f32 v162, v242, v248
v_lshlrev_b32 v242, 16, v163
v_and_b32 v248, 0xffff0000, v163
v_mul_f32 v242, v242, v236
v_mul_f32 v248, v248, v236
v_cvt_pk_bf16_f32 v163, v242, v248
v_lshlrev_b32 v242, 16, v0
v_and_b32 v248, 0xffff0000, v0
v_mul_f32 v242, v242, v236
v_mul_f32 v248, v248, v236
v_cvt_pk_bf16_f32 v0, v242, v248
v_lshlrev_b32 v242, 16, v1
v_and_b32 v248, 0xffff0000, v1
v_mul_f32 v242, v242, v236
v_mul_f32 v248, v248, v236
v_cvt_pk_bf16_f32 v1, v242, v248
v_exp_f32 v248, v148
s_nop 0
v_sub_f32 v225, v225, v248
v_exp_f32 v248, v149
s_nop 0
v_sub_f32 v225, v225, v248
v_exp_f32 v248, v150
s_nop 0
v_sub_f32 v225, v225, v248
v_exp_f32 v248, v151
s_nop 0
v_sub_f32 v225, v225, v248
v_max_f32 v225, 0, v225
v_min_f32 v225, s32, v225
v_log_f32 v248, v225
v_max3_f32 v233, v148, v149, v150
v_max3_f32 v233, v233, v151, v248
v_mov_b32 v248, v233
s_nop 1
v_permlane32_swap_b32 v233, v248
s_nop 1
v_max_f32 v233, v233, v248
v_mov_b32 v248, v233
s_nop 1
v_permlane16_swap_b32 v233, v248
s_nop 1
v_max_f32 v233, v233, v248
v_ceil_f32 v233, v233
v_max_f32 v233, 0, v233
v_sub_f32 v248, 0, v233
v_exp_f32 v237, v248
s_nop 1
v_mul_f32 v225, v225, v237
v_sub_f32 v196, v196, v233
v_sub_f32 v132, v132, v233
v_sub_f32 v148, v148, v233
v_sub_f32 v197, v197, v233
v_sub_f32 v133, v133, v233
v_sub_f32 v149, v149, v233
v_sub_f32 v198, v198, v233
v_sub_f32 v134, v134, v233
v_sub_f32 v150, v150, v233
v_sub_f32 v199, v199, v233
v_sub_f32 v135, v135, v233
v_sub_f32 v151, v151, v233
v_lshlrev_b32 v242, 16, v36
v_and_b32 v248, 0xffff0000, v36
v_mul_f32 v242, v242, v237
v_mul_f32 v248, v248, v237
v_cvt_pk_bf16_f32 v36, v242, v248
v_lshlrev_b32 v242, 16, v37
v_and_b32 v248, 0xffff0000, v37
v_mul_f32 v242, v242, v237
v_mul_f32 v248, v248, v237
v_cvt_pk_bf16_f32 v37, v242, v248
v_lshlrev_b32 v242, 16, v38
v_and_b32 v248, 0xffff0000, v38
v_mul_f32 v242, v242, v237
v_mul_f32 v248, v248, v237
v_cvt_pk_bf16_f32 v38, v242, v248
v_lshlrev_b32 v242, 16, v39
v_and_b32 v248, 0xffff0000, v39
v_mul_f32 v242, v242, v237
v_mul_f32 v248, v248, v237
v_cvt_pk_bf16_f32 v39, v242, v248
v_lshlrev_b32 v242, 16, v40
v_and_b32 v248, 0xffff0000, v40
v_mul_f32 v242, v242, v237
v_mul_f32 v248, v248, v237
v_cvt_pk_bf16_f32 v40, v242, v248
v_lshlrev_b32 v242, 16, v41
v_and_b32 v248, 0xffff0000, v41
v_mul_f32 v242, v242, v237
v_mul_f32 v248, v248, v237
v_cvt_pk_bf16_f32 v41, v242, v248
v_lshlrev_b32 v242, 16, v42
v_and_b32 v248, 0xffff0000, v42
v_mul_f32 v242, v242, v237
v_mul_f32 v248, v248, v237
v_cvt_pk_bf16_f32 v42, v242, v248
v_lshlrev_b32 v242, 16, v43
v_and_b32 v248, 0xffff0000, v43
v_mul_f32 v242, v242, v237
v_mul_f32 v248, v248, v237
v_cvt_pk_bf16_f32 v43, v242, v248
v_lshlrev_b32 v242, 16, v180
v_and_b32 v248, 0xffff0000, v180
v_mul_f32 v242, v242, v237
v_mul_f32 v248, v248, v237
v_cvt_pk_bf16_f32 v180, v242, v248
v_lshlrev_b32 v242, 16, v181
v_and_b32 v248, 0xffff0000, v181
v_mul_f32 v242, v242, v237
v_mul_f32 v248, v248, v237
v_cvt_pk_bf16_f32 v181, v242, v248
v_lshlrev_b32 v242, 16, v182
v_and_b32 v248, 0xffff0000, v182
v_mul_f32 v242, v242, v237
v_mul_f32 v248, v248, v237
v_cvt_pk_bf16_f32 v182, v242, v248
v_lshlrev_b32 v242, 16, v183
v_and_b32 v248, 0xffff0000, v183
v_mul_f32 v242, v242, v237
v_mul_f32 v248, v248, v237
v_cvt_pk_bf16_f32 v183, v242, v248
v_lshlrev_b32 v242, 16, v164
v_and_b32 v248, 0xffff0000, v164
v_mul_f32 v242, v242, v237
v_mul_f32 v248, v248, v237
v_cvt_pk_bf16_f32 v164, v242, v248
v_lshlrev_b32 v242, 16, v165
v_and_b32 v248, 0xffff0000, v165
v_mul_f32 v242, v242, v237
v_mul_f32 v248, v248, v237
v_cvt_pk_bf16_f32 v165, v242, v248
v_lshlrev_b32 v242, 16, v166
v_and_b32 v248, 0xffff0000, v166
v_mul_f32 v242, v242, v237
v_mul_f32 v248, v248, v237
v_cvt_pk_bf16_f32 v166, v242, v248
v_lshlrev_b32 v242, 16, v167
v_and_b32 v248, 0xffff0000, v167
v_mul_f32 v242, v242, v237
v_mul_f32 v248, v248, v237
v_cvt_pk_bf16_f32 v167, v242, v248
v_lshlrev_b32 v242, 16, v32
v_and_b32 v248, 0xffff0000, v32
v_mul_f32 v242, v242, v237
v_mul_f32 v248, v248, v237
v_cvt_pk_bf16_f32 v32, v242, v248
v_lshlrev_b32 v242, 16, v33
v_and_b32 v248, 0xffff0000, v33
v_mul_f32 v242, v242, v237
v_mul_f32 v248, v248, v237
v_cvt_pk_bf16_f32 v33, v242, v248
v_exp_f32 v248, v152
s_nop 0
v_sub_f32 v226, v226, v248
v_exp_f32 v248, v153
s_nop 0
v_sub_f32 v226, v226, v248
v_exp_f32 v248, v154
s_nop 0
v_sub_f32 v226, v226, v248
v_exp_f32 v248, v155
s_nop 0
v_sub_f32 v226, v226, v248
v_max_f32 v226, 0, v226
v_min_f32 v226, s32, v226
v_log_f32 v248, v226
v_max3_f32 v234, v152, v153, v154
v_max3_f32 v234, v234, v155, v248
v_mov_b32 v248, v234
s_nop 1
v_permlane32_swap_b32 v234, v248
s_nop 1
v_max_f32 v234, v234, v248
v_mov_b32 v248, v234
s_nop 1
v_permlane16_swap_b32 v234, v248
s_nop 1
v_max_f32 v234, v234, v248
v_ceil_f32 v234, v234
v_max_f32 v234, 0, v234
v_sub_f32 v248, 0, v234
v_exp_f32 v238, v248
s_nop 1
v_mul_f32 v226, v226, v238
v_sub_f32 v200, v200, v234
v_sub_f32 v136, v136, v234
v_sub_f32 v152, v152, v234
v_sub_f32 v201, v201, v234
v_sub_f32 v137, v137, v234
v_sub_f32 v153, v153, v234
v_sub_f32 v202, v202, v234
v_sub_f32 v138, v138, v234
v_sub_f32 v154, v154, v234
v_sub_f32 v203, v203, v234
v_sub_f32 v139, v139, v234
v_sub_f32 v155, v155, v234
v_lshlrev_b32 v242, 16, v68
v_and_b32 v248, 0xffff0000, v68
v_mul_f32 v242, v242, v238
v_mul_f32 v248, v248, v238
v_cvt_pk_bf16_f32 v68, v242, v248
v_lshlrev_b32 v242, 16, v69
v_and_b32 v248, 0xffff0000, v69
v_mul_f32 v242, v242, v238
v_mul_f32 v248, v248, v238
v_cvt_pk_bf16_f32 v69, v242, v248
v_lshlrev_b32 v242, 16, v70
v_and_b32 v248, 0xffff0000, v70
v_mul_f32 v242, v242, v238
v_mul_f32 v248, v248, v238
v_cvt_pk_bf16_f32 v70, v242, v248
v_lshlrev_b32 v242, 16, v71
v_and_b32 v248, 0xffff0000, v71
v_mul_f32 v242, v242, v238
v_mul_f32 v248, v248, v238
v_cvt_pk_bf16_f32 v71, v242, v248
v_lshlrev_b32 v242, 16, v72
v_and_b32 v248, 0xffff0000, v72
v_mul_f32 v242, v242, v238
v_mul_f32 v248, v248, v238
v_cvt_pk_bf16_f32 v72, v242, v248
v_lshlrev_b32 v242, 16, v73
v_and_b32 v248, 0xffff0000, v73
v_mul_f32 v242, v242, v238
v_mul_f32 v248, v248, v238
v_cvt_pk_bf16_f32 v73, v242, v248
v_lshlrev_b32 v242, 16, v74
v_and_b32 v248, 0xffff0000, v74
v_mul_f32 v242, v242, v238
v_mul_f32 v248, v248, v238
v_cvt_pk_bf16_f32 v74, v242, v248
v_lshlrev_b32 v242, 16, v75
v_and_b32 v248, 0xffff0000, v75
v_mul_f32 v242, v242, v238
v_mul_f32 v248, v248, v238
v_cvt_pk_bf16_f32 v75, v242, v248
v_lshlrev_b32 v242, 16, v184
v_and_b32 v248, 0xffff0000, v184
v_mul_f32 v242, v242, v238
v_mul_f32 v248, v248, v238
v_cvt_pk_bf16_f32 v184, v242, v248
v_lshlrev_b32 v242, 16, v185
v_and_b32 v248, 0xffff0000, v185
v_mul_f32 v242, v242, v238
v_mul_f32 v248, v248, v238
v_cvt_pk_bf16_f32 v185, v242, v248
v_lshlrev_b32 v242, 16, v186
v_and_b32 v248, 0xffff0000, v186
v_mul_f32 v242, v242, v238
v_mul_f32 v248, v248, v238
v_cvt_pk_bf16_f32 v186, v242, v248
v_lshlrev_b32 v242, 16, v187
v_and_b32 v248, 0xffff0000, v187
v_mul_f32 v242, v242, v238
v_mul_f32 v248, v248, v238
v_cvt_pk_bf16_f32 v187, v242, v248
v_lshlrev_b32 v242, 16, v168
v_and_b32 v248, 0xffff0000, v168
v_mul_f32 v242, v242, v238
v_mul_f32 v248, v248, v238
v_cvt_pk_bf16_f32 v168, v242, v248
v_lshlrev_b32 v242, 16, v169
v_and_b32 v248, 0xffff0000, v169
v_mul_f32 v242, v242, v238
v_mul_f32 v248, v248, v238
v_cvt_pk_bf16_f32 v169, v242, v248
v_lshlrev_b32 v242, 16, v170
v_and_b32 v248, 0xffff0000, v170
v_mul_f32 v242, v242, v238
v_mul_f32 v248, v248, v238
v_cvt_pk_bf16_f32 v170, v242, v248
v_lshlrev_b32 v242, 16, v171
v_and_b32 v248, 0xffff0000, v171
v_mul_f32 v242, v242, v238
v_mul_f32 v248, v248, v238
v_cvt_pk_bf16_f32 v171, v242, v248
v_lshlrev_b32 v242, 16, v64
v_and_b32 v248, 0xffff0000, v64
v_mul_f32 v242, v242, v238
v_mul_f32 v248, v248, v238
v_cvt_pk_bf16_f32 v64, v242, v248
v_lshlrev_b32 v242, 16, v65
v_and_b32 v248, 0xffff0000, v65
v_mul_f32 v242, v242, v238
v_mul_f32 v248, v248, v238
v_cvt_pk_bf16_f32 v65, v242, v248
v_exp_f32 v248, v156
s_nop 0
v_sub_f32 v227, v227, v248
v_exp_f32 v248, v157
s_nop 0
v_sub_f32 v227, v227, v248
v_exp_f32 v248, v158
s_nop 0
v_sub_f32 v227, v227, v248
v_exp_f32 v248, v159
s_nop 0
v_sub_f32 v227, v227, v248
v_max_f32 v227, 0, v227
v_min_f32 v227, s32, v227
v_log_f32 v248, v227
v_max3_f32 v235, v156, v157, v158
v_max3_f32 v235, v235, v159, v248
v_mov_b32 v248, v235
s_nop 1
v_permlane32_swap_b32 v235, v248
s_nop 1
v_max_f32 v235, v235, v248
v_mov_b32 v248, v235
s_nop 1
v_permlane16_swap_b32 v235, v248
s_nop 1
v_max_f32 v235, v235, v248
v_ceil_f32 v235, v235
v_max_f32 v235, 0, v235
v_sub_f32 v248, 0, v235
v_exp_f32 v239, v248
s_nop 1
v_mul_f32 v227, v227, v239
v_sub_f32 v204, v204, v235
v_sub_f32 v140, v140, v235
v_sub_f32 v156, v156, v235
v_sub_f32 v205, v205, v235
v_sub_f32 v141, v141, v235
v_sub_f32 v157, v157, v235
v_sub_f32 v206, v206, v235
v_sub_f32 v142, v142, v235
v_sub_f32 v158, v158, v235
v_sub_f32 v207, v207, v235
v_sub_f32 v143, v143, v235
v_sub_f32 v159, v159, v235
v_lshlrev_b32 v242, 16, v100
v_and_b32 v248, 0xffff0000, v100
v_mul_f32 v242, v242, v239
v_mul_f32 v248, v248, v239
v_cvt_pk_bf16_f32 v100, v242, v248
v_lshlrev_b32 v242, 16, v101
v_and_b32 v248, 0xffff0000, v101
v_mul_f32 v242, v242, v239
v_mul_f32 v248, v248, v239
v_cvt_pk_bf16_f32 v101, v242, v248
v_lshlrev_b32 v242, 16, v102
v_and_b32 v248, 0xffff0000, v102
v_mul_f32 v242, v242, v239
v_mul_f32 v248, v248, v239
v_cvt_pk_bf16_f32 v102, v242, v248
v_lshlrev_b32 v242, 16, v103
v_and_b32 v248, 0xffff0000, v103
v_mul_f32 v242, v242, v239
v_mul_f32 v248, v248, v239
v_cvt_pk_bf16_f32 v103, v242, v248
v_lshlrev_b32 v242, 16, v104
v_and_b32 v248, 0xffff0000, v104
v_mul_f32 v242, v242, v239
v_mul_f32 v248, v248, v239
v_cvt_pk_bf16_f32 v104, v242, v248
v_lshlrev_b32 v242, 16, v105
v_and_b32 v248, 0xffff0000, v105
v_mul_f32 v242, v242, v239
v_mul_f32 v248, v248, v239
v_cvt_pk_bf16_f32 v105, v242, v248
v_lshlrev_b32 v242, 16, v106
v_and_b32 v248, 0xffff0000, v106
v_mul_f32 v242, v242, v239
v_mul_f32 v248, v248, v239
v_cvt_pk_bf16_f32 v106, v242, v248
v_lshlrev_b32 v242, 16, v107
v_and_b32 v248, 0xffff0000, v107
v_mul_f32 v242, v242, v239
v_mul_f32 v248, v248, v239
v_cvt_pk_bf16_f32 v107, v242, v248
v_lshlrev_b32 v242, 16, v188
v_and_b32 v248, 0xffff0000, v188
v_mul_f32 v242, v242, v239
v_mul_f32 v248, v248, v239
v_cvt_pk_bf16_f32 v188, v242, v248
v_lshlrev_b32 v242, 16, v189
v_and_b32 v248, 0xffff0000, v189
v_mul_f32 v242, v242, v239
v_mul_f32 v248, v248, v239
v_cvt_pk_bf16_f32 v189, v242, v248
v_lshlrev_b32 v242, 16, v190
v_and_b32 v248, 0xffff0000, v190
v_mul_f32 v242, v242, v239
v_mul_f32 v248, v248, v239
v_cvt_pk_bf16_f32 v190, v242, v248
v_lshlrev_b32 v242, 16, v191
v_and_b32 v248, 0xffff0000, v191
v_mul_f32 v242, v242, v239
v_mul_f32 v248, v248, v239
v_cvt_pk_bf16_f32 v191, v242, v248
v_lshlrev_b32 v242, 16, v172
v_and_b32 v248, 0xffff0000, v172
v_mul_f32 v242, v242, v239
v_mul_f32 v248, v248, v239
v_cvt_pk_bf16_f32 v172, v242, v248
v_lshlrev_b32 v242, 16, v173
v_and_b32 v248, 0xffff0000, v173
v_mul_f32 v242, v242, v239
v_mul_f32 v248, v248, v239
v_cvt_pk_bf16_f32 v173, v242, v248
v_lshlrev_b32 v242, 16, v174
v_and_b32 v248, 0xffff0000, v174
v_mul_f32 v242, v242, v239
v_mul_f32 v248, v248, v239
v_cvt_pk_bf16_f32 v174, v242, v248
v_lshlrev_b32 v242, 16, v175
v_and_b32 v248, 0xffff0000, v175
v_mul_f32 v242, v242, v239
v_mul_f32 v248, v248, v239
v_cvt_pk_bf16_f32 v175, v242, v248
v_lshlrev_b32 v242, 16, v96
v_and_b32 v248, 0xffff0000, v96
v_mul_f32 v242, v242, v239
v_mul_f32 v248, v248, v239
v_cvt_pk_bf16_f32 v96, v242, v248
v_lshlrev_b32 v242, 16, v97
v_and_b32 v248, 0xffff0000, v97
v_mul_f32 v242, v242, v239
v_mul_f32 v248, v248, v239
v_cvt_pk_bf16_f32 v97, v242, v248
v_exp_f32 v232, v144
v_exp_f32 v233, v145
v_exp_f32 v234, v146
v_exp_f32 v235, v147
s_nop 1
v_add_f32 v224, v224, v232
v_add_f32 v224, v224, v233
v_add_f32 v224, v224, v234
v_add_f32 v224, v224, v235
v_cvt_pk_bf16_f32 v2, v232, v233
v_cvt_pk_bf16_f32 v3, v234, v235
v_exp_f32 v232, v148
v_exp_f32 v233, v149
v_exp_f32 v234, v150
v_exp_f32 v235, v151
s_nop 1
v_add_f32 v225, v225, v232
v_add_f32 v225, v225, v233
v_add_f32 v225, v225, v234
v_add_f32 v225, v225, v235
v_cvt_pk_bf16_f32 v34, v232, v233
v_cvt_pk_bf16_f32 v35, v234, v235
v_exp_f32 v232, v152
v_exp_f32 v233, v153
v_exp_f32 v234, v154
v_exp_f32 v235, v155
s_nop 1
v_add_f32 v226, v226, v232
v_add_f32 v226, v226, v233
v_add_f32 v226, v226, v234
v_add_f32 v226, v226, v235
v_cvt_pk_bf16_f32 v66, v232, v233
v_cvt_pk_bf16_f32 v67, v234, v235
v_exp_f32 v232, v156
v_exp_f32 v233, v157
v_exp_f32 v234, v158
v_exp_f32 v235, v159
s_nop 1
v_add_f32 v227, v227, v232
v_add_f32 v227, v227, v233
v_add_f32 v227, v227, v234
v_add_f32 v227, v227, v235
v_cvt_pk_bf16_f32 v98, v232, v233
v_cvt_pk_bf16_f32 v99, v234, v235
s_branch L2_rare_common
LF_hl_1:
s_mov_b32 s94, 0x10000
s_mov_b32 s3, 0x7c28000
LF_hl2_1:
v_lshlrev_b32 v241, 3, v243
buffer_load_dwordx2 v[240:241], v241, s[16:19], s3 offen sc1
s_sub_u32 s94, s94, 1
s_waitcnt vmcnt(0)
s_cbranch_scc1 LF_hlret_1
v_cmp_ne_u64_e64 s[38:39], s[98:99], v[240:241]
s_and_b64 s[38:39], s[38:39], s[96:97]
s_cbranch_scc1 LF_hl2_1
s_branch LF_hlret_1
L2_rare_site12:
s_mov_b32 s36, 12
s_branch L2_rare_t0_0_0
L2_rare_t0_0_0:
s_nop 15
s_nop 15
s_waitcnt lgkmcnt(0)
v_exp_f32 v248, v128
s_nop 0
v_sub_f32 v224, v224, v248
v_exp_f32 v248, v129
s_nop 0
v_sub_f32 v224, v224, v248
v_exp_f32 v248, v130
s_nop 0
v_sub_f32 v224, v224, v248
v_exp_f32 v248, v131
s_nop 0
v_sub_f32 v224, v224, v248
v_max_f32 v224, 0, v224
v_min_f32 v224, s32, v224
v_log_f32 v248, v224
v_max3_f32 v232, v128, v129, v130
v_max3_f32 v232, v232, v131, v248
v_mov_b32 v248, v232
s_nop 1
v_permlane32_swap_b32 v232, v248
s_nop 1
v_max_f32 v232, v232, v248
v_mov_b32 v248, v232
s_nop 1
v_permlane16_swap_b32 v232, v248
s_nop 1
v_max_f32 v232, v232, v248
v_ceil_f32 v232, v232
v_max_f32 v232, 0, v232
v_sub_f32 v248, 0, v232
v_exp_f32 v236, v248
s_nop 1
v_mul_f32 v224, v224, v236
v_sub_f32 v192, v192, v232
v_sub_f32 v128, v128, v232
v_sub_f32 v144, v144, v232
v_sub_f32 v193, v193, v232
v_sub_f32 v129, v129, v232
v_sub_f32 v145, v145, v232
v_sub_f32 v194, v194, v232
v_sub_f32 v130, v130, v232
v_sub_f32 v146, v146, v232
v_sub_f32 v195, v195, v232
v_sub_f32 v131, v131, v232
v_sub_f32 v147, v147, v232
v_lshlrev_b32 v242, 16, v176
v_and_b32 v248, 0xffff0000, v176
v_mul_f32 v242, v242, v236
v_mul_f32 v248, v248, v236
v_cvt_pk_bf16_f32 v176, v242, v248
v_lshlrev_b32 v242, 16, v177
v_and_b32 v248, 0xffff0000, v177
v_mul_f32 v242, v242, v236
v_mul_f32 v248, v248, v236
v_cvt_pk_bf16_f32 v177, v242, v248
v_lshlrev_b32 v242, 16, v178
v_and_b32 v248, 0xffff0000, v178
v_mul_f32 v242, v242, v236
v_mul_f32 v248, v248, v236
v_cvt_pk_bf16_f32 v178, v242, v248
v_lshlrev_b32 v242, 16, v179
v_and_b32 v248, 0xffff0000, v179
v_mul_f32 v242, v242, v236
v_mul_f32 v248, v248, v236
v_cvt_pk_bf16_f32 v179, v242, v248
ds_read_b64 v[250:251], v231 offset:0
s_waitcnt lgkmcnt(0)
v_lshlrev_b32 v242, 16, v250
v_and_b32 v248, 0xffff0000, v250
v_mul_f32 v242, v242, v236
v_mul_f32 v248, v248, v236
v_cvt_pk_bf16_f32 v250, v242, v248
v_lshlrev_b32 v242, 16, v251
v_and_b32 v248, 0xffff0000, v251
v_mul_f32 v242, v242, v236
v_mul_f32 v248, v248, v236
v_cvt_pk_bf16_f32 v251, v242, v248
ds_write_b64 v231, v[250:251] offset:0
s_waitcnt lgkmcnt(0)
ds_read_b64 v[250:251], v231 offset:8
s_waitcnt lgkmcnt(0)
v_lshlrev_b32 v242, 16, v250
v_and_b32 v248, 0xffff0000, v250
v_mul_f32 v242, v242, v236
v_mul_f32 v248, v248, v236
v_cvt_pk_bf16_f32 v250, v242, v248
v_lshlrev_b32 v242, 16, v251
v_and_b32 v248, 0xffff0000, v251
v_mul_f32 v242, v242, v236
v_mul_f32 v248, v248, v236
v_cvt_pk_bf16_f32 v251, v242, v248
ds_write_b64 v231, v[250:251] offset:8
s_waitcnt lgkmcnt(0)
v_exp_f32 v248, v132
s_nop 0
v_sub_f32 v225, v225, v248
v_exp_f32 v248, v133
s_nop 0
v_sub_f32 v225, v225, v248
v_exp_f32 v248, v134
s_nop 0
v_sub_f32 v225, v225, v248
v_exp_f32 v248, v135
s_nop 0
v_sub_f32 v225, v225, v248
v_max_f32 v225, 0, v225
v_min_f32 v225, s32, v225
v_log_f32 v248, v225
v_max3_f32 v233, v132, v133, v134
v_max3_f32 v233, v233, v135, v248
v_mov_b32 v248, v233
s_nop 1
v_permlane32_swap_b32 v233, v248
s_nop 1
v_max_f32 v233, v233, v248
v_mov_b32 v248, v233
s_nop 1
v_permlane16_swap_b32 v233, v248
s_nop 1
v_max_f32 v233, v233, v248
v_ceil_f32 v233, v233
v_max_f32 v233, 0, v233
v_sub_f32 v248, 0, v233
v_exp_f32 v237, v248
s_nop 1
v_mul_f32 v225, v225, v237
v_sub_f32 v196, v196, v233
v_sub_f32 v132, v132, v233
v_sub_f32 v148, v148, v233
v_sub_f32 v197, v197, v233
v_sub_f32 v133, v133, v233
v_sub_f32 v149, v149, v233
v_sub_f32 v198, v198, v233
v_sub_f32 v134, v134, v233
v_sub_f32 v150, v150, v233
v_sub_f32 v199, v199, v233
v_sub_f32 v135, v135, v233
v_sub_f32 v151, v151, v233
v_lshlrev_b32 v242, 16, v180
v_and_b32 v248, 0xffff0000, v180
v_mul_f32 v242, v242, v237
v_mul_f32 v248, v248, v237
v_cvt_pk_bf16_f32 v180, v242, v248
v_lshlrev_b32 v242, 16, v181
v_and_b32 v248, 0xffff0000, v181
v_mul_f32 v242, v242, v237
v_mul_f32 v248, v248, v237
v_cvt_pk_bf16_f32 v181, v242, v248
v_lshlrev_b32 v242, 16, v182
v_and_b32 v248, 0xffff0000, v182
v_mul_f32 v242, v242, v237
v_mul_f32 v248, v248, v237
v_cvt_pk_bf16_f32 v182, v242, v248
v_lshlrev_b32 v242, 16, v183
v_and_b32 v248, 0xffff0000, v183
v_mul_f32 v242, v242, v237
v_mul_f32 v248, v248, v237
v_cvt_pk_bf16_f32 v183, v242, v248
ds_read_b64 v[250:251], v231 offset:1024
s_waitcnt lgkmcnt(0)
v_lshlrev_b32 v242, 16, v250
v_and_b32 v248, 0xffff0000, v250
v_mul_f32 v242, v242, v237
v_mul_f32 v248, v248, v237
v_cvt_pk_bf16_f32 v250, v242, v248
v_lshlrev_b32 v242, 16, v251
v_and_b32 v248, 0xffff0000, v251
v_mul_f32 v242, v242, v237
v_mul_f32 v248, v248, v237
v_cvt_pk_bf16_f32 v251, v242, v248
ds_write_b64 v231, v[250:251] offset:1024
s_waitcnt lgkmcnt(0)
ds_read_b64 v[250:251], v231 offset:1032
s_waitcnt lgkmcnt(0)
v_lshlrev_b32 v242, 16, v250
v_and_b32 v248, 0xffff0000, v250
v_mul_f32 v242, v242, v237
v_mul_f32 v248, v248, v237
v_cvt_pk_bf16_f32 v250, v242, v248
v_lshlrev_b32 v242, 16, v251
v_and_b32 v248, 0xffff0000, v251
v_mul_f32 v242, v242, v237
v_mul_f32 v248, v248, v237
v_cvt_pk_bf16_f32 v251, v242, v248
ds_write_b64 v231, v[250:251] offset:1032
s_waitcnt lgkmcnt(0)
v_exp_f32 v248, v136
s_nop 0
v_sub_f32 v226, v226, v248
v_exp_f32 v248, v137
s_nop 0
v_sub_f32 v226, v226, v248
v_exp_f32 v248, v138
s_nop 0
v_sub_f32 v226, v226, v248
v_exp_f32 v248, v139
s_nop 0
v_sub_f32 v226, v226, v248
v_max_f32 v226, 0, v226
v_min_f32 v226, s32, v226
v_log_f32 v248, v226
v_max3_f32 v234, v136, v137, v138
v_max3_f32 v234, v234, v139, v248
v_mov_b32 v248, v234
s_nop 1
v_permlane32_swap_b32 v234, v248
s_nop 1
v_max_f32 v234, v234, v248
v_mov_b32 v248, v234
s_nop 1
v_permlane16_swap_b32 v234, v248
s_nop 1
v_max_f32 v234, v234, v248
v_ceil_f32 v234, v234
v_max_f32 v234, 0, v234
v_sub_f32 v248, 0, v234
v_exp_f32 v238, v248
s_nop 1
v_mul_f32 v226, v226, v238
v_sub_f32 v200, v200, v234
v_sub_f32 v136, v136, v234
v_sub_f32 v152, v152, v234
v_sub_f32 v201, v201, v234
v_sub_f32 v137, v137, v234
v_sub_f32 v153, v153, v234
v_sub_f32 v202, v202, v234
v_sub_f32 v138, v138, v234
v_sub_f32 v154, v154, v234
v_sub_f32 v203, v203, v234
v_sub_f32 v139, v139, v234
v_sub_f32 v155, v155, v234
v_lshlrev_b32 v242, 16, v184
v_and_b32 v248, 0xffff0000, v184
v_mul_f32 v242, v242, v238
v_mul_f32 v248, v248, v238
v_cvt_pk_bf16_f32 v184, v242, v248
v_lshlrev_b32 v242, 16, v185
v_and_b32 v248, 0xffff0000, v185
v_mul_f32 v242, v242, v238
v_mul_f32 v248, v248, v238
v_cvt_pk_bf16_f32 v185, v242, v248
v_lshlrev_b32 v242, 16, v186
v_and_b32 v248, 0xffff0000, v186
v_mul_f32 v242, v242, v238
v_mul_f32 v248, v248, v238
v_cvt_pk_bf16_f32 v186, v242, v248
v_lshlrev_b32 v242, 16, v187
v_and_b32 v248, 0xffff0000, v187
v_mul_f32 v242, v242, v238
v_mul_f32 v248, v248, v238
v_cvt_pk_bf16_f32 v187, v242, v248
ds_read_b64 v[250:251], v231 offset:2048
s_waitcnt lgkmcnt(0)
v_lshlrev_b32 v242, 16, v250
v_and_b32 v248, 0xffff0000, v250
v_mul_f32 v242, v242, v238
v_mul_f32 v248, v248, v238
v_cvt_pk_bf16_f32 v250, v242, v248
v_lshlrev_b32 v242, 16, v251
v_and_b32 v248, 0xffff0000, v251
v_mul_f32 v242, v242, v238
v_mul_f32 v248, v248, v238
v_cvt_pk_bf16_f32 v251, v242, v248
ds_write_b64 v231, v[250:251] offset:2048
s_waitcnt lgkmcnt(0)
ds_read_b64 v[250:251], v231 offset:2056
s_waitcnt lgkmcnt(0)
v_lshlrev_b32 v242, 16, v250
v_and_b32 v248, 0xffff0000, v250
v_mul_f32 v242, v242, v238
v_mul_f32 v248, v248, v238
v_cvt_pk_bf16_f32 v250, v242, v248
v_lshlrev_b32 v242, 16, v251
v_and_b32 v248, 0xffff0000, v251
v_mul_f32 v242, v242, v238
v_mul_f32 v248, v248, v238
v_cvt_pk_bf16_f32 v251, v242, v248
ds_write_b64 v231, v[250:251] offset:2056
s_waitcnt lgkmcnt(0)
v_exp_f32 v248, v140
s_nop 0
v_sub_f32 v227, v227, v248
v_exp_f32 v248, v141
s_nop 0
v_sub_f32 v227, v227, v248
v_exp_f32 v248, v142
s_nop 0
v_sub_f32 v227, v227, v248
v_exp_f32 v248, v143
s_nop 0
v_sub_f32 v227, v227, v248
v_max_f32 v227, 0, v227
v_min_f32 v227, s32, v227
v_log_f32 v248, v227
v_max3_f32 v235, v140, v141, v142
v_max3_f32 v235, v235, v143, v248
v_mov_b32 v248, v235
s_nop 1
v_permlane32_swap_b32 v235, v248
s_nop 1
v_max_f32 v235, v235, v248
v_mov_b32 v248, v235
s_nop 1
v_permlane16_swap_b32 v235, v248
s_nop 1
v_max_f32 v235, v235, v248
v_ceil_f32 v235, v235
v_max_f32 v235, 0, v235
v_sub_f32 v248, 0, v235
v_exp_f32 v239, v248
s_nop 1
v_mul_f32 v227, v227, v239
v_sub_f32 v204, v204, v235
v_sub_f32 v140, v140, v235
v_sub_f32 v156, v156, v235
v_sub_f32 v205, v205, v235
v_sub_f32 v141, v141, v235
v_sub_f32 v157, v157, v235
v_sub_f32 v206, v206, v235
v_sub_f32 v142, v142, v235
v_sub_f32 v158, v158, v235
v_sub_f32 v207, v207, v235
v_sub_f32 v143, v143, v235
v_sub_f32 v159, v159, v235
v_lshlrev_b32 v242, 16, v188
v_and_b32 v248, 0xffff0000, v188
v_mul_f32 v242, v242, v239
v_mul_f32 v248, v248, v239
v_cvt_pk_bf16_f32 v188, v242, v248
v_lshlrev_b32 v242, 16, v189
v_and_b32 v248, 0xffff0000, v189
v_mul_f32 v242, v242, v239
v_mul_f32 v248, v248, v239
v_cvt_pk_bf16_f32 v189, v242, v248
v_lshlrev_b32 v242, 16, v190
v_and_b32 v248, 0xffff0000, v190
v_mul_f32 v242, v242, v239
v_mul_f32 v248, v248, v239
v_cvt_pk_bf16_f32 v190, v242, v248
v_lshlrev_b32 v242, 16, v191
v_and_b32 v248, 0xffff0000, v191
v_mul_f32 v242, v242, v239
v_mul_f32 v248, v248, v239
v_cvt_pk_bf16_f32 v191, v242, v248
ds_read_b64 v[250:251], v231 offset:3072
s_waitcnt lgkmcnt(0)
v_lshlrev_b32 v242, 16, v250
v_and_b32 v248, 0xffff0000, v250
v_mul_f32 v242, v242, v239
v_mul_f32 v248, v248, v239
v_cvt_pk_bf16_f32 v250, v242, v248
v_lshlrev_b32 v242, 16, v251
v_and_b32 v248, 0xffff0000, v251
v_mul_f32 v242, v242, v239
v_mul_f32 v248, v248, v239
v_cvt_pk_bf16_f32 v251, v242, v248
ds_write_b64 v231, v[250:251] offset:3072
s_waitcnt lgkmcnt(0)
ds_read_b64 v[250:251], v231 offset:3080
s_waitcnt lgkmcnt(0)
v_lshlrev_b32 v242, 16, v250
v_and_b32 v248, 0xffff0000, v250
v_mul_f32 v242, v242, v239
v_mul_f32 v248, v248, v239
v_cvt_pk_bf16_f32 v250, v242, v248
v_lshlrev_b32 v242, 16, v251
v_and_b32 v248, 0xffff0000, v251
v_mul_f32 v242, v242, v239
v_mul_f32 v248, v248, v239
v_cvt_pk_bf16_f32 v251, v242, v248
ds_write_b64 v231, v[250:251] offset:3080
s_waitcnt lgkmcnt(0)
v_exp_f32 v232, v128
v_exp_f32 v233, v129
v_exp_f32 v234, v130
v_exp_f32 v235, v131
s_nop 1
v_add_f32 v224, v224, v232
v_add_f32 v224, v224, v233
v_add_f32 v224, v224, v234
v_add_f32 v224, v224, v235
v_cvt_pk_bf16_f32 v160, v232, v233
v_cvt_pk_bf16_f32 v161, v234, v235
v_exp_f32 v232, v132
v_exp_f32 v233, v133
v_exp_f32 v234, v134
v_exp_f32 v235, v135
s_nop 1
v_add_f32 v225, v225, v232
v_add_f32 v225, v225, v233
v_add_f32 v225, v225, v234
v_add_f32 v225, v225, v235
v_cvt_pk_bf16_f32 v164, v232, v233
v_cvt_pk_bf16_f32 v165, v234, v235
v_exp_f32 v232, v136
v_exp_f32 v233, v137
v_exp_f32 v234, v138
v_exp_f32 v235, v139
s_nop 1
v_add_f32 v226, v226, v232
v_add_f32 v226, v226, v233
v_add_f32 v226, v226, v234
v_add_f32 v226, v226, v235
v_cvt_pk_bf16_f32 v168, v232, v233
v_cvt_pk_bf16_f32 v169, v234, v235
v_exp_f32 v232, v140
v_exp_f32 v233, v141
v_exp_f32 v234, v142
v_exp_f32 v235, v143
s_nop 1
v_add_f32 v227, v227, v232
v_add_f32 v227, v227, v233
v_add_f32 v227, v227, v234
v_add_f32 v227, v227, v235
v_cvt_pk_bf16_f32 v172, v232, v233
v_cvt_pk_bf16_f32 v173, v234, v235
s_branch L2_rare_common
L2_rare_site13:
s_mov_b32 s36, 13
s_branch L2_rare_t0_1_1
L2_rare_t0_1_1:
s_nop 15
s_nop 15
s_waitcnt lgkmcnt(0)
v_exp_f32 v248, v144
s_nop 0
v_sub_f32 v224, v224, v248
v_exp_f32 v248, v145
s_nop 0
v_sub_f32 v224, v224, v248
v_exp_f32 v248, v146
s_nop 0
v_sub_f32 v224, v224, v248
v_exp_f32 v248, v147
s_nop 0
v_sub_f32 v224, v224, v248
v_max_f32 v224, 0, v224
v_min_f32 v224, s32, v224
v_log_f32 v248, v224
v_max3_f32 v232, v144, v145, v146
v_max3_f32 v232, v232, v147, v248
v_mov_b32 v248, v232
s_nop 1
v_permlane32_swap_b32 v232, v248
s_nop 1
v_max_f32 v232, v232, v248
v_mov_b32 v248, v232
s_nop 1
v_permlane16_swap_b32 v232, v248
s_nop 1
v_max_f32 v232, v232, v248
v_ceil_f32 v232, v232
v_max_f32 v232, 0, v232
v_sub_f32 v248, 0, v232
v_exp_f32 v236, v248
s_nop 1
v_mul_f32 v224, v224, v236
v_sub_f32 v192, v192, v232
v_sub_f32 v128, v128, v232
v_sub_f32 v144, v144, v232
v_sub_f32 v193, v193, v232
v_sub_f32 v129, v129, v232
v_sub_f32 v145, v145, v232
v_sub_f32 v194, v194, v232
v_sub_f32 v130, v130, v232
v_sub_f32 v146, v146, v232
v_sub_f32 v195, v195, v232
v_sub_f32 v131, v131, v232
v_sub_f32 v147, v147, v232
v_lshlrev_b32 v242, 16, v160
v_and_b32 v248, 0xffff0000, v160
v_mul_f32 v242, v242, v236
v_mul_f32 v248, v248, v236
v_cvt_pk_bf16_f32 v160, v242, v248
v_lshlrev_b32 v242, 16, v161
v_and_b32 v248, 0xffff0000, v161
v_mul_f32 v242, v242, v236
v_mul_f32 v248, v248, v236
v_cvt_pk_bf16_f32 v161, v242, v248
ds_read_b64 v[250:251], v231 offset:0
s_waitcnt lgkmcnt(0)
v_lshlrev_b32 v242, 16, v250
v_and_b32 v248, 0xffff0000, v250
v_mul_f32 v242, v242, v236
v_mul_f32 v248, v248, v236
v_cvt_pk_bf16_f32 v250, v242, v248
v_lshlrev_b32 v242, 16, v251
v_and_b32 v248, 0xffff0000, v251
v_mul_f32 v242, v242, v236
v_mul_f32 v248, v248, v236
v_cvt_pk_bf16_f32 v251, v242, v248
ds_write_b64 v231, v[250:251] offset:0
s_waitcnt lgkmcnt(0)
ds_read_b64 v[250:251], v231 offset:8
s_waitcnt lgkmcnt(0)
v_lshlrev_b32 v242, 16, v250
v_and_b32 v248, 0xffff0000, v250
v_mul_f32 v242, v242, v236
v_mul_f32 v248, v248, v236
v_cvt_pk_bf16_f32 v250, v242, v248
v_lshlrev_b32 v242, 16, v251
v_and_b32 v248, 0xffff0000, v251
v_mul_f32 v242, v242, v236
v_mul_f32 v248, v248, v236
v_cvt_pk_bf16_f32 v251, v242, v248
ds_write_b64 v231, v[250:251] offset:8
s_waitcnt lgkmcnt(0)
ds_read_b64 v[250:251], v231 offset:4096
s_waitcnt lgkmcnt(0)
v_lshlrev_b32 v242, 16, v250
v_and_b32 v248, 0xffff0000, v250
v_mul_f32 v242, v242, v236
v_mul_f32 v248, v248, v236
v_cvt_pk_bf16_f32 v250, v242, v248
v_lshlrev_b32 v242, 16, v251
v_and_b32 v248, 0xffff0000, v251
v_mul_f32 v242, v242, v236
v_mul_f32 v248, v248, v236
v_cvt_pk_bf16_f32 v251, v242, v248
ds_write_b64 v231, v[250:251] offset:4096
s_waitcnt lgkmcnt(0)
ds_read_b64 v[250:251], v231 offset:4104
s_waitcnt lgkmcnt(0)
v_lshlrev_b32 v242, 16, v250
v_and_b32 v248, 0xffff0000, v250
v_mul_f32 v242, v242, v236
v_mul_f32 v248, v248, v236
v_cvt_pk_bf16_f32 v250, v242, v248
v_lshlrev_b32 v242, 16, v251
v_and_b32 v248, 0xffff0000, v251
v_mul_f32 v242, v242, v236
v_mul_f32 v248, v248, v236
v_cvt_pk_bf16_f32 v251, v242, v248
ds_write_b64 v231, v[250:251] offset:4104
s_waitcnt lgkmcnt(0)
v_exp_f32 v248, v148
s_nop 0
v_sub_f32 v225, v225, v248
v_exp_f32 v248, v149
s_nop 0
v_sub_f32 v225, v225, v248
v_exp_f32 v248, v150
s_nop 0
v_sub_f32 v225, v225, v248
v_exp_f32 v248, v151
s_nop 0
v_sub_f32 v225, v225, v248
v_max_f32 v225, 0, v225
v_min_f32 v225, s32, v225
v_log_f32 v248, v225
v_max3_f32 v233, v148, v149, v150
v_max3_f32 v233, v233, v151, v248
v_mov_b32 v248, v233
s_nop 1
v_permlane32_swap_b32 v233, v248
s_nop 1
v_max_f32 v233, v233, v248
v_mov_b32 v248, v233
s_nop 1
v_permlane16_swap_b32 v233, v248
s_nop 1
v_max_f32 v233, v233, v248
v_ceil_f32 v233, v233
v_max_f32 v233, 0, v233
v_sub_f32 v248, 0, v233
v_exp_f32 v237, v248
s_nop 1
v_mul_f32 v225, v225, v237
v_sub_f32 v196, v196, v233
v_sub_f32 v132, v132, v233
v_sub_f32 v148, v148, v233
v_sub_f32 v197, v197, v233
v_sub_f32 v133, v133, v233
v_sub_f32 v149, v149, v233
v_sub_f32 v198, v198, v233
v_sub_f32 v134, v134, v233
v_sub_f32 v150, v150, v233
v_sub_f32 v199, v199, v233
v_sub_f32 v135, v135, v233
v_sub_f32 v151, v151, v233
v_lshlrev_b32 v242, 16, v164
v_and_b32 v248, 0xffff0000, v164
v_mul_f32 v242, v242, v237
v_mul_f32 v248, v248, v237
v_cvt_pk_bf16_f32 v164, v242, v248
v_lshlrev_b32 v242, 16, v165
v_and_b32 v248, 0xffff0000, v165
v_mul_f32 v242, v242, v237
v_mul_f32 v248, v248, v237
v_cvt_pk_bf16_f32 v165, v242, v248
ds_read_b64 v[250:251], v231 offset:1024
s_waitcnt lgkmcnt(0)
v_lshlrev_b32 v242, 16, v250
v_and_b32 v248, 0xffff0000, v250
v_mul_f32 v242, v242, v237
v_mul_f32 v248, v248, v237
v_cvt_pk_bf16_f32 v250, v242, v248
v_lshlrev_b32 v242, 16, v251
v_and_b32 v248, 0xffff0000, v251
v_mul_f32 v242, v242, v237
v_mul_f32 v248, v248, v237
v_cvt_pk_bf16_f32 v251, v242, v248
ds_write_b64 v231, v[250:251] offset:1024
s_waitcnt lgkmcnt(0)
ds_read_b64 v[250:251], v231 offset:1032
s_waitcnt lgkmcnt(0)
v_lshlrev_b32 v242, 16, v250
v_and_b32 v248, 0xffff0000, v250
v_mul_f32 v242, v242, v237
v_mul_f32 v248, v248, v237
v_cvt_pk_bf16_f32 v250, v242, v248
v_lshlrev_b32 v242, 16, v251
v_and_b32 v248, 0xffff0000, v251
v_mul_f32 v242, v242, v237
v_mul_f32 v248, v248, v237
v_cvt_pk_bf16_f32 v251, v242, v248
ds_write_b64 v231, v[250:251] offset:1032
s_waitcnt lgkmcnt(0)
ds_read_b64 v[250:251], v231 offset:5120
s_waitcnt lgkmcnt(0)
v_lshlrev_b32 v242, 16, v250
v_and_b32 v248, 0xffff0000, v250
v_mul_f32 v242, v242, v237
v_mul_f32 v248, v248, v237
v_cvt_pk_bf16_f32 v250, v242, v248
v_lshlrev_b32 v242, 16, v251
v_and_b32 v248, 0xffff0000, v251
v_mul_f32 v242, v242, v237
v_mul_f32 v248, v248, v237
v_cvt_pk_bf16_f32 v251, v242, v248
ds_write_b64 v231, v[250:251] offset:5120
s_waitcnt lgkmcnt(0)
ds_read_b64 v[250:251], v231 offset:5128
s_waitcnt lgkmcnt(0)
v_lshlrev_b32 v242, 16, v250
v_and_b32 v248, 0xffff0000, v250
v_mul_f32 v242, v242, v237
v_mul_f32 v248, v248, v237
v_cvt_pk_bf16_f32 v250, v242, v248
v_lshlrev_b32 v242, 16, v251
v_and_b32 v248, 0xffff0000, v251
v_mul_f32 v242, v242, v237
v_mul_f32 v248, v248, v237
v_cvt_pk_bf16_f32 v251, v242, v248
ds_write_b64 v231, v[250:251] offset:5128
s_waitcnt lgkmcnt(0)
v_exp_f32 v248, v152
s_nop 0
v_sub_f32 v226, v226, v248
v_exp_f32 v248, v153
s_nop 0
v_sub_f32 v226, v226, v248
v_exp_f32 v248, v154
s_nop 0
v_sub_f32 v226, v226, v248
v_exp_f32 v248, v155
s_nop 0
v_sub_f32 v226, v226, v248
v_max_f32 v226, 0, v226
v_min_f32 v226, s32, v226
v_log_f32 v248, v226
v_max3_f32 v234, v152, v153, v154
v_max3_f32 v234, v234, v155, v248
v_mov_b32 v248, v234
s_nop 1
v_permlane32_swap_b32 v234, v248
s_nop 1
v_max_f32 v234, v234, v248
v_mov_b32 v248, v234
s_nop 1
v_permlane16_swap_b32 v234, v248
s_nop 1
v_max_f32 v234, v234, v248
v_ceil_f32 v234, v234
v_max_f32 v234, 0, v234
v_sub_f32 v248, 0, v234
v_exp_f32 v238, v248
s_nop 1
v_mul_f32 v226, v226, v238
v_sub_f32 v200, v200, v234
v_sub_f32 v136, v136, v234
v_sub_f32 v152, v152, v234
v_sub_f32 v201, v201, v234
v_sub_f32 v137, v137, v234
v_sub_f32 v153, v153, v234
v_sub_f32 v202, v202, v234
v_sub_f32 v138, v138, v234
v_sub_f32 v154, v154, v234
v_sub_f32 v203, v203, v234
v_sub_f32 v139, v139, v234
v_sub_f32 v155, v155, v234
v_lshlrev_b32 v242, 16, v168
v_and_b32 v248, 0xffff0000, v168
v_mul_f32 v242, v242, v238
v_mul_f32 v248, v248, v238
v_cvt_pk_bf16_f32 v168, v242, v248
v_lshlrev_b32 v242, 16, v169
v_and_b32 v248, 0xffff0000, v169
v_mul_f32 v242, v242, v238
v_mul_f32 v248, v248, v238
v_cvt_pk_bf16_f32 v169, v242, v248
ds_read_b64 v[250:251], v231 offset:2048
s_waitcnt lgkmcnt(0)
v_lshlrev_b32 v242, 16, v250
v_and_b32 v248, 0xffff0000, v250
v_mul_f32 v242, v242, v238
v_mul_f32 v248, v248, v238
v_cvt_pk_bf16_f32 v250, v242, v248
v_lshlrev_b32 v242, 16, v251
v_and_b32 v248, 0xffff0000, v251
v_mul_f32 v242, v242, v238
v_mul_f32 v248, v248, v238
v_cvt_pk_bf16_f32 v251, v242, v248
ds_write_b64 v231, v[250:251] offset:2048
s_waitcnt lgkmcnt(0)
ds_read_b64 v[250:251], v231 offset:2056
s_waitcnt lgkmcnt(0)
v_lshlrev_b32 v242, 16, v250
v_and_b32 v248, 0xffff0000, v250
v_mul_f32 v242, v242, v238
v_mul_f32 v248, v248, v238
v_cvt_pk_bf16_f32 v250, v242, v248
v_lshlrev_b32 v242, 16, v251
v_and_b32 v248, 0xffff0000, v251
v_mul_f32 v242, v242, v238
v_mul_f32 v248, v248, v238
v_cvt_pk_bf16_f32 v251, v242, v248
ds_write_b64 v231, v[250:251] offset:2056
s_waitcnt lgkmcnt(0)
ds_read_b64 v[250:251], v231 offset:6144
s_waitcnt lgkmcnt(0)
v_lshlrev_b32 v242, 16, v250
v_and_b32 v248, 0xffff0000, v250
v_mul_f32 v242, v242, v238
v_mul_f32 v248, v248, v238
v_cvt_pk_bf16_f32 v250, v242, v248
v_lshlrev_b32 v242, 16, v251
v_and_b32 v248, 0xffff0000, v251
v_mul_f32 v242, v242, v238
v_mul_f32 v248, v248, v238
v_cvt_pk_bf16_f32 v251, v242, v248
ds_write_b64 v231, v[250:251] offset:6144
s_waitcnt lgkmcnt(0)
ds_read_b64 v[250:251], v231 offset:6152
s_waitcnt lgkmcnt(0)
v_lshlrev_b32 v242, 16, v250
v_and_b32 v248, 0xffff0000, v250
v_mul_f32 v242, v242, v238
v_mul_f32 v248, v248, v238
v_cvt_pk_bf16_f32 v250, v242, v248
v_lshlrev_b32 v242, 16, v251
v_and_b32 v248, 0xffff0000, v251
v_mul_f32 v242, v242, v238
v_mul_f32 v248, v248, v238
v_cvt_pk_bf16_f32 v251, v242, v248
ds_write_b64 v231, v[250:251] offset:6152
s_waitcnt lgkmcnt(0)
v_exp_f32 v248, v156
s_nop 0
v_sub_f32 v227, v227, v248
v_exp_f32 v248, v157
s_nop 0
v_sub_f32 v227, v227, v248
v_exp_f32 v248, v158
s_nop 0
v_sub_f32 v227, v227, v248
v_exp_f32 v248, v159
s_nop 0
v_sub_f32 v227, v227, v248
v_max_f32 v227, 0, v227
v_min_f32 v227, s32, v227
v_log_f32 v248, v227
v_max3_f32 v235, v156, v157, v158
v_max3_f32 v235, v235, v159, v248
v_mov_b32 v248, v235
s_nop 1
v_permlane32_swap_b32 v235, v248
s_nop 1
v_max_f32 v235, v235, v248
v_mov_b32 v248, v235
s_nop 1
v_permlane16_swap_b32 v235, v248
s_nop 1
v_max_f32 v235, v235, v248
v_ceil_f32 v235, v235
v_max_f32 v235, 0, v235
v_sub_f32 v248, 0, v235
v_exp_f32 v239, v248
s_nop 1
v_mul_f32 v227, v227, v239
v_sub_f32 v204, v204, v235
v_sub_f32 v140, v140, v235
v_sub_f32 v156, v156, v235
v_sub_f32 v205, v205, v235
v_sub_f32 v141, v141, v235
v_sub_f32 v157, v157, v235
v_sub_f32 v206, v206, v235
v_sub_f32 v142, v142, v235
v_sub_f32 v158, v158, v235
v_sub_f32 v207, v207, v235
v_sub_f32 v143, v143, v235
v_sub_f32 v159, v159, v235
v_lshlrev_b32 v242, 16, v172
v_and_b32 v248, 0xffff0000, v172
v_mul_f32 v242, v242, v239
v_mul_f32 v248, v248, v239
v_cvt_pk_bf16_f32 v172, v242, v248
v_lshlrev_b32 v242, 16, v173
v_and_b32 v248, 0xffff0000, v173
v_mul_f32 v242, v242, v239
v_mul_f32 v248, v248, v239
v_cvt_pk_bf16_f32 v173, v242, v248
ds_read_b64 v[250:251], v231 offset:3072
s_waitcnt lgkmcnt(0)
v_lshlrev_b32 v242, 16, v250
v_and_b32 v248, 0xffff0000, v250
v_mul_f32 v242, v242, v239
v_mul_f32 v248, v248, v239
v_cvt_pk_bf16_f32 v250, v242, v248
v_lshlrev_b32 v242, 16, v251
v_and_b32 v248, 0xffff0000, v251
v_mul_f32 v242, v242, v239
v_mul_f32 v248, v248, v239
v_cvt_pk_bf16_f32 v251, v242, v248
ds_write_b64 v231, v[250:251] offset:3072
s_waitcnt lgkmcnt(0)
ds_read_b64 v[250:251], v231 offset:3080
s_waitcnt lgkmcnt(0)
v_lshlrev_b32 v242, 16, v250
v_and_b32 v248, 0xffff0000, v250
v_mul_f32 v242, v242, v239
v_mul_f32 v248, v248, v239
v_cvt_pk_bf16_f32 v250, v242, v248
v_lshlrev_b32 v242, 16, v251
v_and_b32 v248, 0xffff0000, v251
v_mul_f32 v242, v242, v239
v_mul_f32 v248, v248, v239
v_cvt_pk_bf16_f32 v251, v242, v248
ds_write_b64 v231, v[250:251] offset:3080
s_waitcnt lgkmcnt(0)
ds_read_b64 v[250:251], v231 offset:7168
s_waitcnt lgkmcnt(0)
v_lshlrev_b32 v242, 16, v250
v_and_b32 v248, 0xffff0000, v250
v_mul_f32 v242, v242, v239
v_mul_f32 v248, v248, v239
v_cvt_pk_bf16_f32 v250, v242, v248
v_lshlrev_b32 v242, 16, v251
v_and_b32 v248, 0xffff0000, v251
v_mul_f32 v242, v242, v239
v_mul_f32 v248, v248, v239
v_cvt_pk_bf16_f32 v251, v242, v248
ds_write_b64 v231, v[250:251] offset:7168
s_waitcnt lgkmcnt(0)
ds_read_b64 v[250:251], v231 offset:7176
s_waitcnt lgkmcnt(0)
v_lshlrev_b32 v242, 16, v250
v_and_b32 v248, 0xffff0000, v250
v_mul_f32 v242, v242, v239
v_mul_f32 v248, v248, v239
v_cvt_pk_bf16_f32 v250, v242, v248
v_lshlrev_b32 v242, 16, v251
v_and_b32 v248, 0xffff0000, v251
v_mul_f32 v242, v242, v239
v_mul_f32 v248, v248, v239
v_cvt_pk_bf16_f32 v251, v242, v248
ds_write_b64 v231, v[250:251] offset:7176
s_waitcnt lgkmcnt(0)
v_exp_f32 v232, v144
v_exp_f32 v233, v145
v_exp_f32 v234, v146
v_exp_f32 v235, v147
s_nop 1
v_add_f32 v224, v224, v232
v_add_f32 v224, v224, v233
v_add_f32 v224, v224, v234
v_add_f32 v224, v224, v235
v_cvt_pk_bf16_f32 v162, v232, v233
v_cvt_pk_bf16_f32 v163, v234, v235
v_exp_f32 v232, v148
v_exp_f32 v233, v149
v_exp_f32 v234, v150
v_exp_f32 v235, v151
s_nop 1
v_add_f32 v225, v225, v232
v_add_f32 v225, v225, v233
v_add_f32 v225, v225, v234
v_add_f32 v225, v225, v235
v_cvt_pk_bf16_f32 v166, v232, v233
v_cvt_pk_bf16_f32 v167, v234, v235
v_exp_f32 v232, v152
v_exp_f32 v233, v153
v_exp_f32 v234, v154
v_exp_f32 v235, v155
s_nop 1
v_add_f32 v226, v226, v232
v_add_f32 v226, v226, v233
v_add_f32 v226, v226, v234
v_add_f32 v226, v226, v235
v_cvt_pk_bf16_f32 v170, v232, v233
v_cvt_pk_bf16_f32 v171, v234, v235
v_exp_f32 v232, v156
v_exp_f32 v233, v157
v_exp_f32 v234, v158
v_exp_f32 v235, v159
s_nop 1
v_add_f32 v227, v227, v232
v_add_f32 v227, v227, v233
v_add_f32 v227, v227, v234
v_add_f32 v227, v227, v235
v_cvt_pk_bf16_f32 v174, v232, v233
v_cvt_pk_bf16_f32 v175, v234, v235
s_branch L2_rare_common
L2_rare_site14:
s_mov_b32 s36, 14
s_branch L2_rare_t0_2_0
L2_rare_t0_2_0:
s_nop 15
s_nop 15
s_waitcnt lgkmcnt(0)
v_exp_f32 v248, v128
s_nop 0
v_sub_f32 v224, v224, v248
v_exp_f32 v248, v129
s_nop 0
v_sub_f32 v224, v224, v248
v_exp_f32 v248, v130
s_nop 0
v_sub_f32 v224, v224, v248
v_exp_f32 v248, v131
s_nop 0
v_sub_f32 v224, v224, v248
v_max_f32 v224, 0, v224
v_min_f32 v224, s32, v224
v_log_f32 v248, v224
v_max3_f32 v232, v128, v129, v130
v_max3_f32 v232, v232, v131, v248
v_mov_b32 v248, v232
s_nop 1
v_permlane32_swap_b32 v232, v248
s_nop 1
v_max_f32 v232, v232, v248
v_mov_b32 v248, v232
s_nop 1
v_permlane16_swap_b32 v232, v248
s_nop 1
v_max_f32 v232, v232, v248
v_ceil_f32 v232, v232
v_max_f32 v232, 0, v232
v_sub_f32 v248, 0, v232
v_exp_f32 v236, v248
s_nop 1
v_mul_f32 v224, v224, v236
v_sub_f32 v192, v192, v232
v_sub_f32 v128, v128, v232
v_sub_f32 v144, v144, v232
v_sub_f32 v193, v193, v232
v_sub_f32 v129, v129, v232
v_sub_f32 v145, v145, v232
v_sub_f32 v194, v194, v232
v_sub_f32 v130, v130, v232
v_sub_f32 v146, v146, v232
v_sub_f32 v195, v195, v232
v_sub_f32 v131, v131, v232
v_sub_f32 v147, v147, v232
v_lshlrev_b32 v242, 16, v160
v_and_b32 v248, 0xffff0000, v160
v_mul_f32 v242, v242, v236
v_mul_f32 v248, v248, v236
v_cvt_pk_bf16_f32 v160, v242, v248
v_lshlrev_b32 v242, 16, v161
v_and_b32 v248, 0xffff0000, v161
v_mul_f32 v242, v242, v236
v_mul_f32 v248, v248, v236
v_cvt_pk_bf16_f32 v161, v242, v248
v_lshlrev_b32 v242, 16, v162
v_and_b32 v248, 0xffff0000, v162
v_mul_f32 v242, v242, v236
v_mul_f32 v248, v248, v236
v_cvt_pk_bf16_f32 v162, v242, v248
v_lshlrev_b32 v242, 16, v163
v_and_b32 v248, 0xffff0000, v163
v_mul_f32 v242, v242, v236
v_mul_f32 v248, v248, v236
v_cvt_pk_bf16_f32 v163, v242, v248
ds_read_b64 v[250:251], v231 offset:0
s_waitcnt lgkmcnt(0)
v_lshlrev_b32 v242, 16, v250
v_and_b32 v248, 0xffff0000, v250
v_mul_f32 v242, v242, v236
v_mul_f32 v248, v248, v236
v_cvt_pk_bf16_f32 v250, v242, v248
v_lshlrev_b32 v242, 16, v251
v_and_b32 v248, 0xffff0000, v251
v_mul_f32 v242, v242, v236
v_mul_f32 v248, v248, v236
v_cvt_pk_bf16_f32 v251, v242, v248
ds_write_b64 v231, v[250:251] offset:0
s_waitcnt lgkmcnt(0)
ds_read_b64 v[250:251], v231 offset:8
s_waitcnt lgkmcnt(0)
v_lshlrev_b32 v242, 16, v250
v_and_b32 v248, 0xffff0000, v250
v_mul_f32 v242, v242, v236
v_mul_f32 v248, v248, v236
v_cvt_pk_bf16_f32 v250, v242, v248
v_lshlrev_b32 v242, 16, v251
v_and_b32 v248, 0xffff0000, v251
v_mul_f32 v242, v242, v236
v_mul_f32 v248, v248, v236
v_cvt_pk_bf16_f32 v251, v242, v248
ds_write_b64 v231, v[250:251] offset:8
s_waitcnt lgkmcnt(0)
ds_read_b64 v[250:251], v231 offset:4096
s_waitcnt lgkmcnt(0)
v_lshlrev_b32 v242, 16, v250
v_and_b32 v248, 0xffff0000, v250
v_mul_f32 v242, v242, v236
v_mul_f32 v248, v248, v236
v_cvt_pk_bf16_f32 v250, v242, v248
v_lshlrev_b32 v242, 16, v251
v_and_b32 v248, 0xffff0000, v251
v_mul_f32 v242, v242, v236
v_mul_f32 v248, v248, v236
v_cvt_pk_bf16_f32 v251, v242, v248
ds_write_b64 v231, v[250:251] offset:4096
s_waitcnt lgkmcnt(0)
ds_read_b64 v[250:251], v231 offset:4104
s_waitcnt lgkmcnt(0)
v_lshlrev_b32 v242, 16, v250
v_and_b32 v248, 0xffff0000, v250
v_mul_f32 v242, v242, v236
v_mul_f32 v248, v248, v236
v_cvt_pk_bf16_f32 v250, v242, v248
v_lshlrev_b32 v242, 16, v251
v_and_b32 v248, 0xffff0000, v251
v_mul_f32 v242, v242, v236
v_mul_f32 v248, v248, v236
v_cvt_pk_bf16_f32 v251, v242, v248
ds_write_b64 v231, v[250:251] offset:4104
s_waitcnt lgkmcnt(0)
v_exp_f32 v248, v132
s_nop 0
v_sub_f32 v225, v225, v248
v_exp_f32 v248, v133
s_nop 0
v_sub_f32 v225, v225, v248
v_exp_f32 v248, v134
s_nop 0
v_sub_f32 v225, v225, v248
v_exp_f32 v248, v135
s_nop 0
v_sub_f32 v225, v225, v248
v_max_f32 v225, 0, v225
v_min_f32 v225, s32, v225
v_log_f32 v248, v225
v_max3_f32 v233, v132, v133, v134
v_max3_f32 v233, v233, v135, v248
v_mov_b32 v248, v233
s_nop 1
v_permlane32_swap_b32 v233, v248
s_nop 1
v_max_f32 v233, v233, v248
v_mov_b32 v248, v233
s_nop 1
v_permlane16_swap_b32 v233, v248
s_nop 1
v_max_f32 v233, v233, v248
v_ceil_f32 v233, v233
v_max_f32 v233, 0, v233
v_sub_f32 v248, 0, v233
v_exp_f32 v237, v248
s_nop 1
v_mul_f32 v225, v225, v237
v_sub_f32 v196, v196, v233
v_sub_f32 v132, v132, v233
v_sub_f32 v148, v148, v233
v_sub_f32 v197, v197, v233
v_sub_f32 v133, v133, v233
v_sub_f32 v149, v149, v233
v_sub_f32 v198, v198, v233
v_sub_f32 v134, v134, v233
v_sub_f32 v150, v150, v233
v_sub_f32 v199, v199, v233
v_sub_f32 v135, v135, v233
v_sub_f32 v151, v151, v233
v_lshlrev_b32 v242, 16, v164
v_and_b32 v248, 0xffff0000, v164
v_mul_f32 v242, v242, v237
v_mul_f32 v248, v248, v237
v_cvt_pk_bf16_f32 v164, v242, v248
v_lshlrev_b32 v242, 16, v165
v_and_b32 v248, 0xffff0000, v165
v_mul_f32 v242, v242, v237
v_mul_f32 v248, v248, v237
v_cvt_pk_bf16_f32 v165, v242, v248
v_lshlrev_b32 v242, 16, v166
v_and_b32 v248, 0xffff0000, v166
v_mul_f32 v242, v242, v237
v_mul_f32 v248, v248, v237
v_cvt_pk_bf16_f32 v166, v242, v248
v_lshlrev_b32 v242, 16, v167
v_and_b32 v248, 0xffff0000, v167
v_mul_f32 v242, v242, v237
v_mul_f32 v248, v248, v237
v_cvt_pk_bf16_f32 v167, v242, v248
ds_read_b64 v[250:251], v231 offset:1024
s_waitcnt lgkmcnt(0)
v_lshlrev_b32 v242, 16, v250
v_and_b32 v248, 0xffff0000, v250
v_mul_f32 v242, v242, v237
v_mul_f32 v248, v248, v237
v_cvt_pk_bf16_f32 v250, v242, v248
v_lshlrev_b32 v242, 16, v251
v_and_b32 v248, 0xffff0000, v251
v_mul_f32 v242, v242, v237
v_mul_f32 v248, v248, v237
v_cvt_pk_bf16_f32 v251, v242, v248
ds_write_b64 v231, v[250:251] offset:1024
s_waitcnt lgkmcnt(0)
ds_read_b64 v[250:251], v231 offset:1032
s_waitcnt lgkmcnt(0)
v_lshlrev_b32 v242, 16, v250
v_and_b32 v248, 0xffff0000, v250
v_mul_f32 v242, v242, v237
v_mul_f32 v248, v248, v237
v_cvt_pk_bf16_f32 v250, v242, v248
v_lshlrev_b32 v242, 16, v251
v_and_b32 v248, 0xffff0000, v251
v_mul_f32 v242, v242, v237
v_mul_f32 v248, v248, v237
v_cvt_pk_bf16_f32 v251, v242, v248
ds_write_b64 v231, v[250:251] offset:1032
s_waitcnt lgkmcnt(0)
ds_read_b64 v[250:251], v231 offset:5120
s_waitcnt lgkmcnt(0)
v_lshlrev_b32 v242, 16, v250
v_and_b32 v248, 0xffff0000, v250
v_mul_f32 v242, v242, v237
v_mul_f32 v248, v248, v237
v_cvt_pk_bf16_f32 v250, v242, v248
v_lshlrev_b32 v242, 16, v251
v_and_b32 v248, 0xffff0000, v251
v_mul_f32 v242, v242, v237
v_mul_f32 v248, v248, v237
v_cvt_pk_bf16_f32 v251, v242, v248
ds_write_b64 v231, v[250:251] offset:5120
s_waitcnt lgkmcnt(0)
ds_read_b64 v[250:251], v231 offset:5128
s_waitcnt lgkmcnt(0)
v_lshlrev_b32 v242, 16, v250
v_and_b32 v248, 0xffff0000, v250
v_mul_f32 v242, v242, v237
v_mul_f32 v248, v248, v237
v_cvt_pk_bf16_f32 v250, v242, v248
v_lshlrev_b32 v242, 16, v251
v_and_b32 v248, 0xffff0000, v251
v_mul_f32 v242, v242, v237
v_mul_f32 v248, v248, v237
v_cvt_pk_bf16_f32 v251, v242, v248
ds_write_b64 v231, v[250:251] offset:5128
s_waitcnt lgkmcnt(0)
v_exp_f32 v248, v136
s_nop 0
v_sub_f32 v226, v226, v248
v_exp_f32 v248, v137
s_nop 0
v_sub_f32 v226, v226, v248
v_exp_f32 v248, v138
s_nop 0
v_sub_f32 v226, v226, v248
v_exp_f32 v248, v139
s_nop 0
v_sub_f32 v226, v226, v248
v_max_f32 v226, 0, v226
v_min_f32 v226, s32, v226
v_log_f32 v248, v226
v_max3_f32 v234, v136, v137, v138
v_max3_f32 v234, v234, v139, v248
v_mov_b32 v248, v234
s_nop 1
v_permlane32_swap_b32 v234, v248
s_nop 1
v_max_f32 v234, v234, v248
v_mov_b32 v248, v234
s_nop 1
v_permlane16_swap_b32 v234, v248
s_nop 1
v_max_f32 v234, v234, v248
v_ceil_f32 v234, v234
v_max_f32 v234, 0, v234
v_sub_f32 v248, 0, v234
v_exp_f32 v238, v248
s_nop 1
v_mul_f32 v226, v226, v238
v_sub_f32 v200, v200, v234
v_sub_f32 v136, v136, v234
v_sub_f32 v152, v152, v234
v_sub_f32 v201, v201, v234
v_sub_f32 v137, v137, v234
v_sub_f32 v153, v153, v234
v_sub_f32 v202, v202, v234
v_sub_f32 v138, v138, v234
v_sub_f32 v154, v154, v234
v_sub_f32 v203, v203, v234
v_sub_f32 v139, v139, v234
v_sub_f32 v155, v155, v234
v_lshlrev_b32 v242, 16, v168
v_and_b32 v248, 0xffff0000, v168
v_mul_f32 v242, v242, v238
v_mul_f32 v248, v248, v238
v_cvt_pk_bf16_f32 v168, v242, v248
v_lshlrev_b32 v242, 16, v169
v_and_b32 v248, 0xffff0000, v169
v_mul_f32 v242, v242, v238
v_mul_f32 v248, v248, v238
v_cvt_pk_bf16_f32 v169, v242, v248
v_lshlrev_b32 v242, 16, v170
v_and_b32 v248, 0xffff0000, v170
v_mul_f32 v242, v242, v238
v_mul_f32 v248, v248, v238
v_cvt_pk_bf16_f32 v170, v242, v248
v_lshlrev_b32 v242, 16, v171
v_and_b32 v248, 0xffff0000, v171
v_mul_f32 v242, v242, v238
v_mul_f32 v248, v248, v238
v_cvt_pk_bf16_f32 v171, v242, v248
ds_read_b64 v[250:251], v231 offset:2048
s_waitcnt lgkmcnt(0)
v_lshlrev_b32 v242, 16, v250
v_and_b32 v248, 0xffff0000, v250
v_mul_f32 v242, v242, v238
v_mul_f32 v248, v248, v238
v_cvt_pk_bf16_f32 v250, v242, v248
v_lshlrev_b32 v242, 16, v251
v_and_b32 v248, 0xffff0000, v251
v_mul_f32 v242, v242, v238
v_mul_f32 v248, v248, v238
v_cvt_pk_bf16_f32 v251, v242, v248
ds_write_b64 v231, v[250:251] offset:2048
s_waitcnt lgkmcnt(0)
ds_read_b64 v[250:251], v231 offset:2056
s_waitcnt lgkmcnt(0)
v_lshlrev_b32 v242, 16, v250
v_and_b32 v248, 0xffff0000, v250
v_mul_f32 v242, v242, v238
v_mul_f32 v248, v248, v238
v_cvt_pk_bf16_f32 v250, v242, v248
v_lshlrev_b32 v242, 16, v251
v_and_b32 v248, 0xffff0000, v251
v_mul_f32 v242, v242, v238
v_mul_f32 v248, v248, v238
v_cvt_pk_bf16_f32 v251, v242, v248
ds_write_b64 v231, v[250:251] offset:2056
s_waitcnt lgkmcnt(0)
ds_read_b64 v[250:251], v231 offset:6144
s_waitcnt lgkmcnt(0)
v_lshlrev_b32 v242, 16, v250
v_and_b32 v248, 0xffff0000, v250
v_mul_f32 v242, v242, v238
v_mul_f32 v248, v248, v238
v_cvt_pk_bf16_f32 v250, v242, v248
v_lshlrev_b32 v242, 16, v251
v_and_b32 v248, 0xffff0000, v251
v_mul_f32 v242, v242, v238
v_mul_f32 v248, v248, v238
v_cvt_pk_bf16_f32 v251, v242, v248
ds_write_b64 v231, v[250:251] offset:6144
s_waitcnt lgkmcnt(0)
ds_read_b64 v[250:251], v231 offset:6152
s_waitcnt lgkmcnt(0)
v_lshlrev_b32 v242, 16, v250
v_and_b32 v248, 0xffff0000, v250
v_mul_f32 v242, v242, v238
v_mul_f32 v248, v248, v238
v_cvt_pk_bf16_f32 v250, v242, v248
v_lshlrev_b32 v242, 16, v251
v_and_b32 v248, 0xffff0000, v251
v_mul_f32 v242, v242, v238
v_mul_f32 v248, v248, v238
v_cvt_pk_bf16_f32 v251, v242, v248
ds_write_b64 v231, v[250:251] offset:6152
s_waitcnt lgkmcnt(0)
v_exp_f32 v248, v140
s_nop 0
v_sub_f32 v227, v227, v248
v_exp_f32 v248, v141
s_nop 0
v_sub_f32 v227, v227, v248
v_exp_f32 v248, v142
s_nop 0
v_sub_f32 v227, v227, v248
v_exp_f32 v248, v143
s_nop 0
v_sub_f32 v227, v227, v248
v_max_f32 v227, 0, v227
v_min_f32 v227, s32, v227
v_log_f32 v248, v227
v_max3_f32 v235, v140, v141, v142
v_max3_f32 v235, v235, v143, v248
v_mov_b32 v248, v235
s_nop 1
v_permlane32_swap_b32 v235, v248
s_nop 1
v_max_f32 v235, v235, v248
v_mov_b32 v248, v235
s_nop 1
v_permlane16_swap_b32 v235, v248
s_nop 1
v_max_f32 v235, v235, v248
v_ceil_f32 v235, v235
v_max_f32 v235, 0, v235
v_sub_f32 v248, 0, v235
v_exp_f32 v239, v248
s_nop 1
v_mul_f32 v227, v227, v239
v_sub_f32 v204, v204, v235
v_sub_f32 v140, v140, v235
v_sub_f32 v156, v156, v235
v_sub_f32 v205, v205, v235
v_sub_f32 v141, v141, v235
v_sub_f32 v157, v157, v235
v_sub_f32 v206, v206, v235
v_sub_f32 v142, v142, v235
v_sub_f32 v158, v158, v235
v_sub_f32 v207, v207, v235
v_sub_f32 v143, v143, v235
v_sub_f32 v159, v159, v235
v_lshlrev_b32 v242, 16, v172
v_and_b32 v248, 0xffff0000, v172
v_mul_f32 v242, v242, v239
v_mul_f32 v248, v248, v239
v_cvt_pk_bf16_f32 v172, v242, v248
v_lshlrev_b32 v242, 16, v173
v_and_b32 v248, 0xffff0000, v173
v_mul_f32 v242, v242, v239
v_mul_f32 v248, v248, v239
v_cvt_pk_bf16_f32 v173, v242, v248
v_lshlrev_b32 v242, 16, v174
v_and_b32 v248, 0xffff0000, v174
v_mul_f32 v242, v242, v239
v_mul_f32 v248, v248, v239
v_cvt_pk_bf16_f32 v174, v242, v248
v_lshlrev_b32 v242, 16, v175
v_and_b32 v248, 0xffff0000, v175
v_mul_f32 v242, v242, v239
v_mul_f32 v248, v248, v239
v_cvt_pk_bf16_f32 v175, v242, v248
ds_read_b64 v[250:251], v231 offset:3072
s_waitcnt lgkmcnt(0)
v_lshlrev_b32 v242, 16, v250
v_and_b32 v248, 0xffff0000, v250
v_mul_f32 v242, v242, v239
v_mul_f32 v248, v248, v239
v_cvt_pk_bf16_f32 v250, v242, v248
v_lshlrev_b32 v242, 16, v251
v_and_b32 v248, 0xffff0000, v251
v_mul_f32 v242, v242, v239
v_mul_f32 v248, v248, v239
v_cvt_pk_bf16_f32 v251, v242, v248
ds_write_b64 v231, v[250:251] offset:3072
s_waitcnt lgkmcnt(0)
ds_read_b64 v[250:251], v231 offset:3080
s_waitcnt lgkmcnt(0)
v_lshlrev_b32 v242, 16, v250
v_and_b32 v248, 0xffff0000, v250
v_mul_f32 v242, v242, v239
v_mul_f32 v248, v248, v239
v_cvt_pk_bf16_f32 v250, v242, v248
v_lshlrev_b32 v242, 16, v251
v_and_b32 v248, 0xffff0000, v251
v_mul_f32 v242, v242, v239
v_mul_f32 v248, v248, v239
v_cvt_pk_bf16_f32 v251, v242, v248
ds_write_b64 v231, v[250:251] offset:3080
s_waitcnt lgkmcnt(0)
ds_read_b64 v[250:251], v231 offset:7168
s_waitcnt lgkmcnt(0)
v_lshlrev_b32 v242, 16, v250
v_and_b32 v248, 0xffff0000, v250
v_mul_f32 v242, v242, v239
v_mul_f32 v248, v248, v239
v_cvt_pk_bf16_f32 v250, v242, v248
v_lshlrev_b32 v242, 16, v251
v_and_b32 v248, 0xffff0000, v251
v_mul_f32 v242, v242, v239
v_mul_f32 v248, v248, v239
v_cvt_pk_bf16_f32 v251, v242, v248
ds_write_b64 v231, v[250:251] offset:7168
s_waitcnt lgkmcnt(0)
ds_read_b64 v[250:251], v231 offset:7176
s_waitcnt lgkmcnt(0)
v_lshlrev_b32 v242, 16, v250
v_and_b32 v248, 0xffff0000, v250
v_mul_f32 v242, v242, v239
v_mul_f32 v248, v248, v239
v_cvt_pk_bf16_f32 v250, v242, v248
v_lshlrev_b32 v242, 16, v251
v_and_b32 v248, 0xffff0000, v251
v_mul_f32 v242, v242, v239
v_mul_f32 v248, v248, v239
v_cvt_pk_bf16_f32 v251, v242, v248
ds_write_b64 v231, v[250:251] offset:7176
s_waitcnt lgkmcnt(0)
v_exp_f32 v232, v128
v_exp_f32 v233, v129
v_exp_f32 v234, v130
v_exp_f32 v235, v131
s_nop 1
v_add_f32 v224, v224, v232
v_add_f32 v224, v224, v233
v_add_f32 v224, v224, v234
v_add_f32 v224, v224, v235
v_cvt_pk_bf16_f32 v176, v232, v233
v_cvt_pk_bf16_f32 v177, v234, v235
v_exp_f32 v232, v132
v_exp_f32 v233, v133
v_exp_f32 v234, v134
v_exp_f32 v235, v135
s_nop 1
v_add_f32 v225, v225, v232
v_add_f32 v225, v225, v233
v_add_f32 v225, v225, v234
v_add_f32 v225, v225, v235
v_cvt_pk_bf16_f32 v180, v232, v233
v_cvt_pk_bf16_f32 v181, v234, v235
v_exp_f32 v232, v136
v_exp_f32 v233, v137
v_exp_f32 v234, v138
v_exp_f32 v235, v139
s_nop 1
v_add_f32 v226, v226, v232
v_add_f32 v226, v226, v233
v_add_f32 v226, v226, v234
v_add_f32 v226, v226, v235
v_cvt_pk_bf16_f32 v184, v232, v233
v_cvt_pk_bf16_f32 v185, v234, v235
v_exp_f32 v232, v140
v_exp_f32 v233, v141
v_exp_f32 v234, v142
v_exp_f32 v235, v143
s_nop 1
v_add_f32 v227, v227, v232
v_add_f32 v227, v227, v233
v_add_f32 v227, v227, v234
v_add_f32 v227, v227, v235
v_cvt_pk_bf16_f32 v188, v232, v233
v_cvt_pk_bf16_f32 v189, v234, v235
s_branch L2_rare_common
L2_rare_site15:
s_mov_b32 s36, 15
s_branch L2_rare_t0_3_1
L2_rare_t0_3_1:
s_nop 15
s_nop 15
s_waitcnt lgkmcnt(0)
v_exp_f32 v248, v144
s_nop 0
v_sub_f32 v224, v224, v248
v_exp_f32 v248, v145
s_nop 0
v_sub_f32 v224, v224, v248
v_exp_f32 v248, v146
s_nop 0
v_sub_f32 v224, v224, v248
v_exp_f32 v248, v147
s_nop 0
v_sub_f32 v224, v224, v248
v_max_f32 v224, 0, v224
v_min_f32 v224, s32, v224
v_log_f32 v248, v224
v_max3_f32 v232, v144, v145, v146
v_max3_f32 v232, v232, v147, v248
v_mov_b32 v248, v232
s_nop 1
v_permlane32_swap_b32 v232, v248
s_nop 1
v_max_f32 v232, v232, v248
v_mov_b32 v248, v232
s_nop 1
v_permlane16_swap_b32 v232, v248
s_nop 1
v_max_f32 v232, v232, v248
v_ceil_f32 v232, v232
v_max_f32 v232, 0, v232
v_sub_f32 v248, 0, v232
v_exp_f32 v236, v248
s_nop 1
v_mul_f32 v224, v224, v236
v_sub_f32 v192, v192, v232
v_sub_f32 v128, v128, v232
v_sub_f32 v144, v144, v232
v_sub_f32 v193, v193, v232
v_sub_f32 v129, v129, v232
v_sub_f32 v145, v145, v232
v_sub_f32 v194, v194, v232
v_sub_f32 v130, v130, v232
v_sub_f32 v146, v146, v232
v_sub_f32 v195, v195, v232
v_sub_f32 v131, v131, v232
v_sub_f32 v147, v147, v232
v_lshlrev_b32 v242, 16, v160
v_and_b32 v248, 0xffff0000, v160
v_mul_f32 v242, v242, v236
v_mul_f32 v248, v248, v236
v_cvt_pk_bf16_f32 v160, v242, v248
v_lshlrev_b32 v242, 16, v161
v_and_b32 v248, 0xffff0000, v161
v_mul_f32 v242, v242, v236
v_mul_f32 v248, v248, v236
v_cvt_pk_bf16_f32 v161, v242, v248
v_lshlrev_b32 v242, 16, v162
v_and_b32 v248, 0xffff0000, v162
v_mul_f32 v242, v242, v236
v_mul_f32 v248, v248, v236
v_cvt_pk_bf16_f32 v162, v242, v248
v_lshlrev_b32 v242, 16, v163
v_and_b32 v248, 0xffff0000, v163
v_mul_f32 v242, v242, v236
v_mul_f32 v248, v248, v236
v_cvt_pk_bf16_f32 v163, v242, v248
v_lshlrev_b32 v242, 16, v176
v_and_b32 v248, 0xffff0000, v176
v_mul_f32 v242, v242, v236
v_mul_f32 v248, v248, v236
v_cvt_pk_bf16_f32 v176, v242, v248
v_lshlrev_b32 v242, 16, v177
v_and_b32 v248, 0xffff0000, v177
v_mul_f32 v242, v242, v236
v_mul_f32 v248, v248, v236
v_cvt_pk_bf16_f32 v177, v242, v248
ds_read_b64 v[250:251], v231 offset:0
s_waitcnt lgkmcnt(0)
v_lshlrev_b32 v242, 16, v250
v_and_b32 v248, 0xffff0000, v250
v_mul_f32 v242, v242, v236
v_mul_f32 v248, v248, v236
v_cvt_pk_bf16_f32 v250, v242, v248
v_lshlrev_b32 v242, 16, v251
v_and_b32 v248, 0xffff0000, v251
v_mul_f32 v242, v242, v236
v_mul_f32 v248, v248, v236
v_cvt_pk_bf16_f32 v251, v242, v248
ds_write_b64 v231, v[250:251] offset:0
s_waitcnt lgkmcnt(0)
ds_read_b64 v[250:251], v231 offset:8
s_waitcnt lgkmcnt(0)
v_lshlrev_b32 v242, 16, v250
v_and_b32 v248, 0xffff0000, v250
v_mul_f32 v242, v242, v236
v_mul_f32 v248, v248, v236
v_cvt_pk_bf16_f32 v250, v242, v248
v_lshlrev_b32 v242, 16, v251
v_and_b32 v248, 0xffff0000, v251
v_mul_f32 v242, v242, v236
v_mul_f32 v248, v248, v236
v_cvt_pk_bf16_f32 v251, v242, v248
ds_write_b64 v231, v[250:251] offset:8
s_waitcnt lgkmcnt(0)
ds_read_b64 v[250:251], v231 offset:4096
s_waitcnt lgkmcnt(0)
v_lshlrev_b32 v242, 16, v250
v_and_b32 v248, 0xffff0000, v250
v_mul_f32 v242, v242, v236
v_mul_f32 v248, v248, v236
v_cvt_pk_bf16_f32 v250, v242, v248
v_lshlrev_b32 v242, 16, v251
v_and_b32 v248, 0xffff0000, v251
v_mul_f32 v242, v242, v236
v_mul_f32 v248, v248, v236
v_cvt_pk_bf16_f32 v251, v242, v248
ds_write_b64 v231, v[250:251] offset:4096
s_waitcnt lgkmcnt(0)
ds_read_b64 v[250:251], v231 offset:4104
s_waitcnt lgkmcnt(0)
v_lshlrev_b32 v242, 16, v250
v_and_b32 v248, 0xffff0000, v250
v_mul_f32 v242, v242, v236
v_mul_f32 v248, v248, v236
v_cvt_pk_bf16_f32 v250, v242, v248
v_lshlrev_b32 v242, 16, v251
v_and_b32 v248, 0xffff0000, v251
v_mul_f32 v242, v242, v236
v_mul_f32 v248, v248, v236
v_cvt_pk_bf16_f32 v251, v242, v248
ds_write_b64 v231, v[250:251] offset:4104
s_waitcnt lgkmcnt(0)
v_exp_f32 v248, v148
s_nop 0
v_sub_f32 v225, v225, v248
v_exp_f32 v248, v149
s_nop 0
v_sub_f32 v225, v225, v248
v_exp_f32 v248, v150
s_nop 0
v_sub_f32 v225, v225, v248
v_exp_f32 v248, v151
s_nop 0
v_sub_f32 v225, v225, v248
v_max_f32 v225, 0, v225
v_min_f32 v225, s32, v225
v_log_f32 v248, v225
v_max3_f32 v233, v148, v149, v150
v_max3_f32 v233, v233, v151, v248
v_mov_b32 v248, v233
s_nop 1
v_permlane32_swap_b32 v233, v248
s_nop 1
v_max_f32 v233, v233, v248
v_mov_b32 v248, v233
s_nop 1
v_permlane16_swap_b32 v233, v248
s_nop 1
v_max_f32 v233, v233, v248
v_ceil_f32 v233, v233
v_max_f32 v233, 0, v233
v_sub_f32 v248, 0, v233
v_exp_f32 v237, v248
s_nop 1
v_mul_f32 v225, v225, v237
v_sub_f32 v196, v196, v233
v_sub_f32 v132, v132, v233
v_sub_f32 v148, v148, v233
v_sub_f32 v197, v197, v233
v_sub_f32 v133, v133, v233
v_sub_f32 v149, v149, v233
v_sub_f32 v198, v198, v233
v_sub_f32 v134, v134, v233
v_sub_f32 v150, v150, v233
v_sub_f32 v199, v199, v233
v_sub_f32 v135, v135, v233
v_sub_f32 v151, v151, v233
v_lshlrev_b32 v242, 16, v164
v_and_b32 v248, 0xffff0000, v164
v_mul_f32 v242, v242, v237
v_mul_f32 v248, v248, v237
v_cvt_pk_bf16_f32 v164, v242, v248
v_lshlrev_b32 v242, 16, v165
v_and_b32 v248, 0xffff0000, v165
v_mul_f32 v242, v242, v237
v_mul_f32 v248, v248, v237
v_cvt_pk_bf16_f32 v165, v242, v248
v_lshlrev_b32 v242, 16, v166
v_and_b32 v248, 0xffff0000, v166
v_mul_f32 v242, v242, v237
v_mul_f32 v248, v248, v237
v_cvt_pk_bf16_f32 v166, v242, v248
v_lshlrev_b32 v242, 16, v167
v_and_b32 v248, 0xffff0000, v167
v_mul_f32 v242, v242, v237
v_mul_f32 v248, v248, v237
v_cvt_pk_bf16_f32 v167, v242, v248
v_lshlrev_b32 v242, 16, v180
v_and_b32 v248, 0xffff0000, v180
v_mul_f32 v242, v242, v237
v_mul_f32 v248, v248, v237
v_cvt_pk_bf16_f32 v180, v242, v248
v_lshlrev_b32 v242, 16, v181
v_and_b32 v248, 0xffff0000, v181
v_mul_f32 v242, v242, v237
v_mul_f32 v248, v248, v237
v_cvt_pk_bf16_f32 v181, v242, v248
ds_read_b64 v[250:251], v231 offset:1024
s_waitcnt lgkmcnt(0)
v_lshlrev_b32 v242, 16, v250
v_and_b32 v248, 0xffff0000, v250
v_mul_f32 v242, v242, v237
v_mul_f32 v248, v248, v237
v_cvt_pk_bf16_f32 v250, v242, v248
v_lshlrev_b32 v242, 16, v251
v_and_b32 v248, 0xffff0000, v251
v_mul_f32 v242, v242, v237
v_mul_f32 v248, v248, v237
v_cvt_pk_bf16_f32 v251, v242, v248
ds_write_b64 v231, v[250:251] offset:1024
s_waitcnt lgkmcnt(0)
ds_read_b64 v[250:251], v231 offset:1032
s_waitcnt lgkmcnt(0)
v_lshlrev_b32 v242, 16, v250
v_and_b32 v248, 0xffff0000, v250
v_mul_f32 v242, v242, v237
v_mul_f32 v248, v248, v237
v_cvt_pk_bf16_f32 v250, v242, v248
v_lshlrev_b32 v242, 16, v251
v_and_b32 v248, 0xffff0000, v251
v_mul_f32 v242, v242, v237
v_mul_f32 v248, v248, v237
v_cvt_pk_bf16_f32 v251, v242, v248
ds_write_b64 v231, v[250:251] offset:1032
s_waitcnt lgkmcnt(0)
ds_read_b64 v[250:251], v231 offset:5120
s_waitcnt lgkmcnt(0)
v_lshlrev_b32 v242, 16, v250
v_and_b32 v248, 0xffff0000, v250
v_mul_f32 v242, v242, v237
v_mul_f32 v248, v248, v237
v_cvt_pk_bf16_f32 v250, v242, v248
v_lshlrev_b32 v242, 16, v251
v_and_b32 v248, 0xffff0000, v251
v_mul_f32 v242, v242, v237
v_mul_f32 v248, v248, v237
v_cvt_pk_bf16_f32 v251, v242, v248
ds_write_b64 v231, v[250:251] offset:5120
s_waitcnt lgkmcnt(0)
ds_read_b64 v[250:251], v231 offset:5128
s_waitcnt lgkmcnt(0)
v_lshlrev_b32 v242, 16, v250
v_and_b32 v248, 0xffff0000, v250
v_mul_f32 v242, v242, v237
v_mul_f32 v248, v248, v237
v_cvt_pk_bf16_f32 v250, v242, v248
v_lshlrev_b32 v242, 16, v251
v_and_b32 v248, 0xffff0000, v251
v_mul_f32 v242, v242, v237
v_mul_f32 v248, v248, v237
v_cvt_pk_bf16_f32 v251, v242, v248
ds_write_b64 v231, v[250:251] offset:5128
s_waitcnt lgkmcnt(0)
v_exp_f32 v248, v152
s_nop 0
v_sub_f32 v226, v226, v248
v_exp_f32 v248, v153
s_nop 0
v_sub_f32 v226, v226, v248
v_exp_f32 v248, v154
s_nop 0
v_sub_f32 v226, v226, v248
v_exp_f32 v248, v155
s_nop 0
v_sub_f32 v226, v226, v248
v_max_f32 v226, 0, v226
v_min_f32 v226, s32, v226
v_log_f32 v248, v226
v_max3_f32 v234, v152, v153, v154
v_max3_f32 v234, v234, v155, v248
v_mov_b32 v248, v234
s_nop 1
v_permlane32_swap_b32 v234, v248
s_nop 1
v_max_f32 v234, v234, v248
v_mov_b32 v248, v234
s_nop 1
v_permlane16_swap_b32 v234, v248
s_nop 1
v_max_f32 v234, v234, v248
v_ceil_f32 v234, v234
v_max_f32 v234, 0, v234
v_sub_f32 v248, 0, v234
v_exp_f32 v238, v248
s_nop 1
v_mul_f32 v226, v226, v238
v_sub_f32 v200, v200, v234
v_sub_f32 v136, v136, v234
v_sub_f32 v152, v152, v234
v_sub_f32 v201, v201, v234
v_sub_f32 v137, v137, v234
v_sub_f32 v153, v153, v234
v_sub_f32 v202, v202, v234
v_sub_f32 v138, v138, v234
v_sub_f32 v154, v154, v234
v_sub_f32 v203, v203, v234
v_sub_f32 v139, v139, v234
v_sub_f32 v155, v155, v234
v_lshlrev_b32 v242, 16, v168
v_and_b32 v248, 0xffff0000, v168
v_mul_f32 v242, v242, v238
v_mul_f32 v248, v248, v238
v_cvt_pk_bf16_f32 v168, v242, v248
v_lshlrev_b32 v242, 16, v169
v_and_b32 v248, 0xffff0000, v169
v_mul_f32 v242, v242, v238
v_mul_f32 v248, v248, v238
v_cvt_pk_bf16_f32 v169, v242, v248
v_lshlrev_b32 v242, 16, v170
v_and_b32 v248, 0xffff0000, v170
v_mul_f32 v242, v242, v238
v_mul_f32 v248, v248, v238
v_cvt_pk_bf16_f32 v170, v242, v248
v_lshlrev_b32 v242, 16, v171
v_and_b32 v248, 0xffff0000, v171
v_mul_f32 v242, v242, v238
v_mul_f32 v248, v248, v238
v_cvt_pk_bf16_f32 v171, v242, v248
v_lshlrev_b32 v242, 16, v184
v_and_b32 v248, 0xffff0000, v184
v_mul_f32 v242, v242, v238
v_mul_f32 v248, v248, v238
v_cvt_pk_bf16_f32 v184, v242, v248
v_lshlrev_b32 v242, 16, v185
v_and_b32 v248, 0xffff0000, v185
v_mul_f32 v242, v242, v238
v_mul_f32 v248, v248, v238
v_cvt_pk_bf16_f32 v185, v242, v248
ds_read_b64 v[250:251], v231 offset:2048
s_waitcnt lgkmcnt(0)
v_lshlrev_b32 v242, 16, v250
v_and_b32 v248, 0xffff0000, v250
v_mul_f32 v242, v242, v238
v_mul_f32 v248, v248, v238
v_cvt_pk_bf16_f32 v250, v242, v248
v_lshlrev_b32 v242, 16, v251
v_and_b32 v248, 0xffff0000, v251
v_mul_f32 v242, v242, v238
v_mul_f32 v248, v248, v238
v_cvt_pk_bf16_f32 v251, v242, v248
ds_write_b64 v231, v[250:251] offset:2048
s_waitcnt lgkmcnt(0)
ds_read_b64 v[250:251], v231 offset:2056
s_waitcnt lgkmcnt(0)
v_lshlrev_b32 v242, 16, v250
v_and_b32 v248, 0xffff0000, v250
v_mul_f32 v242, v242, v238
v_mul_f32 v248, v248, v238
v_cvt_pk_bf16_f32 v250, v242, v248
v_lshlrev_b32 v242, 16, v251
v_and_b32 v248, 0xffff0000, v251
v_mul_f32 v242, v242, v238
v_mul_f32 v248, v248, v238
v_cvt_pk_bf16_f32 v251, v242, v248
ds_write_b64 v231, v[250:251] offset:2056
s_waitcnt lgkmcnt(0)
ds_read_b64 v[250:251], v231 offset:6144
s_waitcnt lgkmcnt(0)
v_lshlrev_b32 v242, 16, v250
v_and_b32 v248, 0xffff0000, v250
v_mul_f32 v242, v242, v238
v_mul_f32 v248, v248, v238
v_cvt_pk_bf16_f32 v250, v242, v248
v_lshlrev_b32 v242, 16, v251
v_and_b32 v248, 0xffff0000, v251
v_mul_f32 v242, v242, v238
v_mul_f32 v248, v248, v238
v_cvt_pk_bf16_f32 v251, v242, v248
ds_write_b64 v231, v[250:251] offset:6144
s_waitcnt lgkmcnt(0)
ds_read_b64 v[250:251], v231 offset:6152
s_waitcnt lgkmcnt(0)
v_lshlrev_b32 v242, 16, v250
v_and_b32 v248, 0xffff0000, v250
v_mul_f32 v242, v242, v238
v_mul_f32 v248, v248, v238
v_cvt_pk_bf16_f32 v250, v242, v248
v_lshlrev_b32 v242, 16, v251
v_and_b32 v248, 0xffff0000, v251
v_mul_f32 v242, v242, v238
v_mul_f32 v248, v248, v238
v_cvt_pk_bf16_f32 v251, v242, v248
ds_write_b64 v231, v[250:251] offset:6152
s_waitcnt lgkmcnt(0)
v_exp_f32 v248, v156
s_nop 0
v_sub_f32 v227, v227, v248
v_exp_f32 v248, v157
s_nop 0
v_sub_f32 v227, v227, v248
v_exp_f32 v248, v158
s_nop 0
v_sub_f32 v227, v227, v248
v_exp_f32 v248, v159
s_nop 0
v_sub_f32 v227, v227, v248
v_max_f32 v227, 0, v227
v_min_f32 v227, s32, v227
v_log_f32 v248, v227
v_max3_f32 v235, v156, v157, v158
v_max3_f32 v235, v235, v159, v248
v_mov_b32 v248, v235
s_nop 1
v_permlane32_swap_b32 v235, v248
s_nop 1
v_max_f32 v235, v235, v248
v_mov_b32 v248, v235
s_nop 1
v_permlane16_swap_b32 v235, v248
s_nop 1
v_max_f32 v235, v235, v248
v_ceil_f32 v235, v235
v_max_f32 v235, 0, v235
v_sub_f32 v248, 0, v235
v_exp_f32 v239, v248
s_nop 1
v_mul_f32 v227, v227, v239
v_sub_f32 v204, v204, v235
v_sub_f32 v140, v140, v235
v_sub_f32 v156, v156, v235
v_sub_f32 v205, v205, v235
v_sub_f32 v141, v141, v235
v_sub_f32 v157, v157, v235
v_sub_f32 v206, v206, v235
v_sub_f32 v142, v142, v235
v_sub_f32 v158, v158, v235
v_sub_f32 v207, v207, v235
v_sub_f32 v143, v143, v235
v_sub_f32 v159, v159, v235
v_lshlrev_b32 v242, 16, v172
v_and_b32 v248, 0xffff0000, v172
v_mul_f32 v242, v242, v239
v_mul_f32 v248, v248, v239
v_cvt_pk_bf16_f32 v172, v242, v248
v_lshlrev_b32 v242, 16, v173
v_and_b32 v248, 0xffff0000, v173
v_mul_f32 v242, v242, v239
v_mul_f32 v248, v248, v239
v_cvt_pk_bf16_f32 v173, v242, v248
v_lshlrev_b32 v242, 16, v174
v_and_b32 v248, 0xffff0000, v174
v_mul_f32 v242, v242, v239
v_mul_f32 v248, v248, v239
v_cvt_pk_bf16_f32 v174, v242, v248
v_lshlrev_b32 v242, 16, v175
v_and_b32 v248, 0xffff0000, v175
v_mul_f32 v242, v242, v239
v_mul_f32 v248, v248, v239
v_cvt_pk_bf16_f32 v175, v242, v248
v_lshlrev_b32 v242, 16, v188
v_and_b32 v248, 0xffff0000, v188
v_mul_f32 v242, v242, v239
v_mul_f32 v248, v248, v239
v_cvt_pk_bf16_f32 v188, v242, v248
v_lshlrev_b32 v242, 16, v189
v_and_b32 v248, 0xffff0000, v189
v_mul_f32 v242, v242, v239
v_mul_f32 v248, v248, v239
v_cvt_pk_bf16_f32 v189, v242, v248
ds_read_b64 v[250:251], v231 offset:3072
s_waitcnt lgkmcnt(0)
v_lshlrev_b32 v242, 16, v250
v_and_b32 v248, 0xffff0000, v250
v_mul_f32 v242, v242, v239
v_mul_f32 v248, v248, v239
v_cvt_pk_bf16_f32 v250, v242, v248
v_lshlrev_b32 v242, 16, v251
v_and_b32 v248, 0xffff0000, v251
v_mul_f32 v242, v242, v239
v_mul_f32 v248, v248, v239
v_cvt_pk_bf16_f32 v251, v242, v248
ds_write_b64 v231, v[250:251] offset:3072
s_waitcnt lgkmcnt(0)
ds_read_b64 v[250:251], v231 offset:3080
s_waitcnt lgkmcnt(0)
v_lshlrev_b32 v242, 16, v250
v_and_b32 v248, 0xffff0000, v250
v_mul_f32 v242, v242, v239
v_mul_f32 v248, v248, v239
v_cvt_pk_bf16_f32 v250, v242, v248
v_lshlrev_b32 v242, 16, v251
v_and_b32 v248, 0xffff0000, v251
v_mul_f32 v242, v242, v239
v_mul_f32 v248, v248, v239
v_cvt_pk_bf16_f32 v251, v242, v248
ds_write_b64 v231, v[250:251] offset:3080
s_waitcnt lgkmcnt(0)
ds_read_b64 v[250:251], v231 offset:7168
s_waitcnt lgkmcnt(0)
v_lshlrev_b32 v242, 16, v250
v_and_b32 v248, 0xffff0000, v250
v_mul_f32 v242, v242, v239
v_mul_f32 v248, v248, v239
v_cvt_pk_bf16_f32 v250, v242, v248
v_lshlrev_b32 v242, 16, v251
v_and_b32 v248, 0xffff0000, v251
v_mul_f32 v242, v242, v239
v_mul_f32 v248, v248, v239
v_cvt_pk_bf16_f32 v251, v242, v248
ds_write_b64 v231, v[250:251] offset:7168
s_waitcnt lgkmcnt(0)
ds_read_b64 v[250:251], v231 offset:7176
s_waitcnt lgkmcnt(0)
v_lshlrev_b32 v242, 16, v250
v_and_b32 v248, 0xffff0000, v250
v_mul_f32 v242, v242, v239
v_mul_f32 v248, v248, v239
v_cvt_pk_bf16_f32 v250, v242, v248
v_lshlrev_b32 v242, 16, v251
v_and_b32 v248, 0xffff0000, v251
v_mul_f32 v242, v242, v239
v_mul_f32 v248, v248, v239
v_cvt_pk_bf16_f32 v251, v242, v248
ds_write_b64 v231, v[250:251] offset:7176
s_waitcnt lgkmcnt(0)
v_exp_f32 v232, v144
v_exp_f32 v233, v145
v_exp_f32 v234, v146
v_exp_f32 v235, v147
s_nop 1
v_add_f32 v224, v224, v232
v_add_f32 v224, v224, v233
v_add_f32 v224, v224, v234
v_add_f32 v224, v224, v235
v_cvt_pk_bf16_f32 v178, v232, v233
v_cvt_pk_bf16_f32 v179, v234, v235
v_exp_f32 v232, v148
v_exp_f32 v233, v149
v_exp_f32 v234, v150
v_exp_f32 v235, v151
s_nop 1
v_add_f32 v225, v225, v232
v_add_f32 v225, v225, v233
v_add_f32 v225, v225, v234
v_add_f32 v225, v225, v235
v_cvt_pk_bf16_f32 v182, v232, v233
v_cvt_pk_bf16_f32 v183, v234, v235
v_exp_f32 v232, v152
v_exp_f32 v233, v153
v_exp_f32 v234, v154
v_exp_f32 v235, v155
s_nop 1
v_add_f32 v226, v226, v232
v_add_f32 v226, v226, v233
v_add_f32 v226, v226, v234
v_add_f32 v226, v226, v235
v_cvt_pk_bf16_f32 v186, v232, v233
v_cvt_pk_bf16_f32 v187, v234, v235
v_exp_f32 v232, v156
v_exp_f32 v233, v157
v_exp_f32 v234, v158
v_exp_f32 v235, v159
s_nop 1
v_add_f32 v227, v227, v232
v_add_f32 v227, v227, v233
v_add_f32 v227, v227, v234
v_add_f32 v227, v227, v235
v_cvt_pk_bf16_f32 v190, v232, v233
v_cvt_pk_bf16_f32 v191, v234, v235
s_branch L2_rare_common
L2_rare_site16:
s_mov_b32 s36, 16
s_branch L2_rare_t0_4_0
L2_rare_t0_4_0:
s_nop 15
s_nop 15
s_waitcnt lgkmcnt(0)
v_exp_f32 v248, v128
s_nop 0
v_sub_f32 v224, v224, v248
v_exp_f32 v248, v129
s_nop 0
v_sub_f32 v224, v224, v248
v_exp_f32 v248, v130
s_nop 0
v_sub_f32 v224, v224, v248
v_exp_f32 v248, v131
s_nop 0
v_sub_f32 v224, v224, v248
v_max_f32 v224, 0, v224
v_min_f32 v224, s32, v224
v_log_f32 v248, v224
v_max3_f32 v232, v128, v129, v130
v_max3_f32 v232, v232, v131, v248
v_mov_b32 v248, v232
s_nop 1
v_permlane32_swap_b32 v232, v248
s_nop 1
v_max_f32 v232, v232, v248
v_mov_b32 v248, v232
s_nop 1
v_permlane16_swap_b32 v232, v248
s_nop 1
v_max_f32 v232, v232, v248
v_ceil_f32 v232, v232
v_max_f32 v232, 0, v232
v_sub_f32 v248, 0, v232
v_exp_f32 v236, v248
s_nop 1
v_mul_f32 v224, v224, v236
v_sub_f32 v192, v192, v232
v_sub_f32 v128, v128, v232
v_sub_f32 v144, v144, v232
v_sub_f32 v193, v193, v232
v_sub_f32 v129, v129, v232
v_sub_f32 v145, v145, v232
v_sub_f32 v194, v194, v232
v_sub_f32 v130, v130, v232
v_sub_f32 v146, v146, v232
v_sub_f32 v195, v195, v232
v_sub_f32 v131, v131, v232
v_sub_f32 v147, v147, v232
v_lshlrev_b32 v242, 16, v4
v_and_b32 v248, 0xffff0000, v4
v_mul_f32 v242, v242, v236
v_mul_f32 v248, v248, v236
v_cvt_pk_bf16_f32 v4, v242, v248
v_lshlrev_b32 v242, 16, v5
v_and_b32 v248, 0xffff0000, v5
v_mul_f32 v242, v242, v236
v_mul_f32 v248, v248, v236
v_cvt_pk_bf16_f32 v5, v242, v248
v_lshlrev_b32 v242, 16, v6
v_and_b32 v248, 0xffff0000, v6
v_mul_f32 v242, v242, v236
v_mul_f32 v248, v248, v236
v_cvt_pk_bf16_f32 v6, v242, v248
v_lshlrev_b32 v242, 16, v7
v_and_b32 v248, 0xffff0000, v7
v_mul_f32 v242, v242, v236
v_mul_f32 v248, v248, v236
v_cvt_pk_bf16_f32 v7, v242, v248
v_lshlrev_b32 v242, 16, v8
v_and_b32 v248, 0xffff0000, v8
v_mul_f32 v242, v242, v236
v_mul_f32 v248, v248, v236
v_cvt_pk_bf16_f32 v8, v242, v248
v_lshlrev_b32 v242, 16, v9
v_and_b32 v248, 0xffff0000, v9
v_mul_f32 v242, v242, v236
v_mul_f32 v248, v248, v236
v_cvt_pk_bf16_f32 v9, v242, v248
v_lshlrev_b32 v242, 16, v10
v_and_b32 v248, 0xffff0000, v10
v_mul_f32 v242, v242, v236
v_mul_f32 v248, v248, v236
v_cvt_pk_bf16_f32 v10, v242, v248
v_lshlrev_b32 v242, 16, v11
v_and_b32 v248, 0xffff0000, v11
v_mul_f32 v242, v242, v236
v_mul_f32 v248, v248, v236
v_cvt_pk_bf16_f32 v11, v242, v248
v_lshlrev_b32 v242, 16, v160
v_and_b32 v248, 0xffff0000, v160
v_mul_f32 v242, v242, v236
v_mul_f32 v248, v248, v236
v_cvt_pk_bf16_f32 v160, v242, v248
v_lshlrev_b32 v242, 16, v161
v_and_b32 v248, 0xffff0000, v161
v_mul_f32 v242, v242, v236
v_mul_f32 v248, v248, v236
v_cvt_pk_bf16_f32 v161, v242, v248
v_lshlrev_b32 v242, 16, v162
v_and_b32 v248, 0xffff0000, v162
v_mul_f32 v242, v242, v236
v_mul_f32 v248, v248, v236
v_cvt_pk_bf16_f32 v162, v242, v248
v_lshlrev_b32 v242, 16, v163
v_and_b32 v248, 0xffff0000, v163
v_mul_f32 v242, v242, v236
v_mul_f32 v248, v248, v236
v_cvt_pk_bf16_f32 v163, v242, v248
v_lshlrev_b32 v242, 16, v176
v_and_b32 v248, 0xffff0000, v176
v_mul_f32 v242, v242, v236
v_mul_f32 v248, v248, v236
v_cvt_pk_bf16_f32 v176, v242, v248
v_lshlrev_b32 v242, 16, v177
v_and_b32 v248, 0xffff0000, v177
v_mul_f32 v242, v242, v236
v_mul_f32 v248, v248, v236
v_cvt_pk_bf16_f32 v177, v242, v248
v_lshlrev_b32 v242, 16, v178
v_and_b32 v248, 0xffff0000, v178
v_mul_f32 v242, v242, v236
v_mul_f32 v248, v248, v236
v_cvt_pk_bf16_f32 v178, v242, v248
v_lshlrev_b32 v242, 16, v179
v_and_b32 v248, 0xffff0000, v179
v_mul_f32 v242, v242, v236
v_mul_f32 v248, v248, v236
v_cvt_pk_bf16_f32 v179, v242, v248
v_exp_f32 v248, v132
s_nop 0
v_sub_f32 v225, v225, v248
v_exp_f32 v248, v133
s_nop 0
v_sub_f32 v225, v225, v248
v_exp_f32 v248, v134
s_nop 0
v_sub_f32 v225, v225, v248
v_exp_f32 v248, v135
s_nop 0
v_sub_f32 v225, v225, v248
v_max_f32 v225, 0, v225
v_min_f32 v225, s32, v225
v_log_f32 v248, v225
v_max3_f32 v233, v132, v133, v134
v_max3_f32 v233, v233, v135, v248
v_mov_b32 v248, v233
s_nop 1
v_permlane32_swap_b32 v233, v248
s_nop 1
v_max_f32 v233, v233, v248
v_mov_b32 v248, v233
s_nop 1
v_permlane16_swap_b32 v233, v248
s_nop 1
v_max_f32 v233, v233, v248
v_ceil_f32 v233, v233
v_max_f32 v233, 0, v233
v_sub_f32 v248, 0, v233
v_exp_f32 v237, v248
s_nop 1
v_mul_f32 v225, v225, v237
v_sub_f32 v196, v196, v233
v_sub_f32 v132, v132, v233
v_sub_f32 v148, v148, v233
v_sub_f32 v197, v197, v233
v_sub_f32 v133, v133, v233
v_sub_f32 v149, v149, v233
v_sub_f32 v198, v198, v233
v_sub_f32 v134, v134, v233
v_sub_f32 v150, v150, v233
v_sub_f32 v199, v199, v233
v_sub_f32 v135, v135, v233
v_sub_f32 v151, v151, v233
v_lshlrev_b32 v242, 16, v36
v_and_b32 v248, 0xffff0000, v36
v_mul_f32 v242, v242, v237
v_mul_f32 v248, v248, v237
v_cvt_pk_bf16_f32 v36, v242, v248
v_lshlrev_b32 v242, 16, v37
v_and_b32 v248, 0xffff0000, v37
v_mul_f32 v242, v242, v237
v_mul_f32 v248, v248, v237
v_cvt_pk_bf16_f32 v37, v242, v248
v_lshlrev_b32 v242, 16, v38
v_and_b32 v248, 0xffff0000, v38
v_mul_f32 v242, v242, v237
v_mul_f32 v248, v248, v237
v_cvt_pk_bf16_f32 v38, v242, v248
v_lshlrev_b32 v242, 16, v39
v_and_b32 v248, 0xffff0000, v39
v_mul_f32 v242, v242, v237
v_mul_f32 v248, v248, v237
v_cvt_pk_bf16_f32 v39, v242, v248
v_lshlrev_b32 v242, 16, v40
v_and_b32 v248, 0xffff0000, v40
v_mul_f32 v242, v242, v237
v_mul_f32 v248, v248, v237
v_cvt_pk_bf16_f32 v40, v242, v248
v_lshlrev_b32 v242, 16, v41
v_and_b32 v248, 0xffff0000, v41
v_mul_f32 v242, v242, v237
v_mul_f32 v248, v248, v237
v_cvt_pk_bf16_f32 v41, v242, v248
v_lshlrev_b32 v242, 16, v42
v_and_b32 v248, 0xffff0000, v42
v_mul_f32 v242, v242, v237
v_mul_f32 v248, v248, v237
v_cvt_pk_bf16_f32 v42, v242, v248
v_lshlrev_b32 v242, 16, v43
v_and_b32 v248, 0xffff0000, v43
v_mul_f32 v242, v242, v237
v_mul_f32 v248, v248, v237
v_cvt_pk_bf16_f32 v43, v242, v248
v_lshlrev_b32 v242, 16, v164
v_and_b32 v248, 0xffff0000, v164
v_mul_f32 v242, v242, v237
v_mul_f32 v248, v248, v237
v_cvt_pk_bf16_f32 v164, v242, v248
v_lshlrev_b32 v242, 16, v165
v_and_b32 v248, 0xffff0000, v165
v_mul_f32 v242, v242, v237
v_mul_f32 v248, v248, v237
v_cvt_pk_bf16_f32 v165, v242, v248
v_lshlrev_b32 v242, 16, v166
v_and_b32 v248, 0xffff0000, v166
v_mul_f32 v242, v242, v237
v_mul_f32 v248, v248, v237
v_cvt_pk_bf16_f32 v166, v242, v248
v_lshlrev_b32 v242, 16, v167
v_and_b32 v248, 0xffff0000, v167
v_mul_f32 v242, v242, v237
v_mul_f32 v248, v248, v237
v_cvt_pk_bf16_f32 v167, v242, v248
v_lshlrev_b32 v242, 16, v180
v_and_b32 v248, 0xffff0000, v180
v_mul_f32 v242, v242, v237
v_mul_f32 v248, v248, v237
v_cvt_pk_bf16_f32 v180, v242, v248
v_lshlrev_b32 v242, 16, v181
v_and_b32 v248, 0xffff0000, v181
v_mul_f32 v242, v242, v237
v_mul_f32 v248, v248, v237
v_cvt_pk_bf16_f32 v181, v242, v248
v_lshlrev_b32 v242, 16, v182
v_and_b32 v248, 0xffff0000, v182
v_mul_f32 v242, v242, v237
v_mul_f32 v248, v248, v237
v_cvt_pk_bf16_f32 v182, v242, v248
v_lshlrev_b32 v242, 16, v183
v_and_b32 v248, 0xffff0000, v183
v_mul_f32 v242, v242, v237
v_mul_f32 v248, v248, v237
v_cvt_pk_bf16_f32 v183, v242, v248
v_exp_f32 v248, v136
s_nop 0
v_sub_f32 v226, v226, v248
v_exp_f32 v248, v137
s_nop 0
v_sub_f32 v226, v226, v248
v_exp_f32 v248, v138
s_nop 0
v_sub_f32 v226, v226, v248
v_exp_f32 v248, v139
s_nop 0
v_sub_f32 v226, v226, v248
v_max_f32 v226, 0, v226
v_min_f32 v226, s32, v226
v_log_f32 v248, v226
v_max3_f32 v234, v136, v137, v138
v_max3_f32 v234, v234, v139, v248
v_mov_b32 v248, v234
s_nop 1
v_permlane32_swap_b32 v234, v248
s_nop 1
v_max_f32 v234, v234, v248
v_mov_b32 v248, v234
s_nop 1
v_permlane16_swap_b32 v234, v248
s_nop 1
v_max_f32 v234, v234, v248
v_ceil_f32 v234, v234
v_max_f32 v234, 0, v234
v_sub_f32 v248, 0, v234
v_exp_f32 v238, v248
s_nop 1
v_mul_f32 v226, v226, v238
v_sub_f32 v200, v200, v234
v_sub_f32 v136, v136, v234
v_sub_f32 v152, v152, v234
v_sub_f32 v201, v201, v234
v_sub_f32 v137, v137, v234
v_sub_f32 v153, v153, v234
v_sub_f32 v202, v202, v234
v_sub_f32 v138, v138, v234
v_sub_f32 v154, v154, v234
v_sub_f32 v203, v203, v234
v_sub_f32 v139, v139, v234
v_sub_f32 v155, v155, v234
v_lshlrev_b32 v242, 16, v68
v_and_b32 v248, 0xffff0000, v68
v_mul_f32 v242, v242, v238
v_mul_f32 v248, v248, v238
v_cvt_pk_bf16_f32 v68, v242, v248
v_lshlrev_b32 v242, 16, v69
v_and_b32 v248, 0xffff0000, v69
v_mul_f32 v242, v242, v238
v_mul_f32 v248, v248, v238
v_cvt_pk_bf16_f32 v69, v242, v248
v_lshlrev_b32 v242, 16, v70
v_and_b32 v248, 0xffff0000, v70
v_mul_f32 v242, v242, v238
v_mul_f32 v248, v248, v238
v_cvt_pk_bf16_f32 v70, v242, v248
v_lshlrev_b32 v242, 16, v71
v_and_b32 v248, 0xffff0000, v71
v_mul_f32 v242, v242, v238
v_mul_f32 v248, v248, v238
v_cvt_pk_bf16_f32 v71, v242, v248
v_lshlrev_b32 v242, 16, v72
v_and_b32 v248, 0xffff0000, v72
v_mul_f32 v242, v242, v238
v_mul_f32 v248, v248, v238
v_cvt_pk_bf16_f32 v72, v242, v248
v_lshlrev_b32 v242, 16, v73
v_and_b32 v248, 0xffff0000, v73
v_mul_f32 v242, v242, v238
v_mul_f32 v248, v248, v238
v_cvt_pk_bf16_f32 v73, v242, v248
v_lshlrev_b32 v242, 16, v74
v_and_b32 v248, 0xffff0000, v74
v_mul_f32 v242, v242, v238
v_mul_f32 v248, v248, v238
v_cvt_pk_bf16_f32 v74, v242, v248
v_lshlrev_b32 v242, 16, v75
v_and_b32 v248, 0xffff0000, v75
v_mul_f32 v242, v242, v238
v_mul_f32 v248, v248, v238
v_cvt_pk_bf16_f32 v75, v242, v248
v_lshlrev_b32 v242, 16, v168
v_and_b32 v248, 0xffff0000, v168
v_mul_f32 v242, v242, v238
v_mul_f32 v248, v248, v238
v_cvt_pk_bf16_f32 v168, v242, v248
v_lshlrev_b32 v242, 16, v169
v_and_b32 v248, 0xffff0000, v169
v_mul_f32 v242, v242, v238
v_mul_f32 v248, v248, v238
v_cvt_pk_bf16_f32 v169, v242, v248
v_lshlrev_b32 v242, 16, v170
v_and_b32 v248, 0xffff0000, v170
v_mul_f32 v242, v242, v238
v_mul_f32 v248, v248, v238
v_cvt_pk_bf16_f32 v170, v242, v248
v_lshlrev_b32 v242, 16, v171
v_and_b32 v248, 0xffff0000, v171
v_mul_f32 v242, v242, v238
v_mul_f32 v248, v248, v238
v_cvt_pk_bf16_f32 v171, v242, v248
v_lshlrev_b32 v242, 16, v184
v_and_b32 v248, 0xffff0000, v184
v_mul_f32 v242, v242, v238
v_mul_f32 v248, v248, v238
v_cvt_pk_bf16_f32 v184, v242, v248
v_lshlrev_b32 v242, 16, v185
v_and_b32 v248, 0xffff0000, v185
v_mul_f32 v242, v242, v238
v_mul_f32 v248, v248, v238
v_cvt_pk_bf16_f32 v185, v242, v248
v_lshlrev_b32 v242, 16, v186
v_and_b32 v248, 0xffff0000, v186
v_mul_f32 v242, v242, v238
v_mul_f32 v248, v248, v238
v_cvt_pk_bf16_f32 v186, v242, v248
v_lshlrev_b32 v242, 16, v187
v_and_b32 v248, 0xffff0000, v187
v_mul_f32 v242, v242, v238
v_mul_f32 v248, v248, v238
v_cvt_pk_bf16_f32 v187, v242, v248
v_exp_f32 v248, v140
s_nop 0
v_sub_f32 v227, v227, v248
v_exp_f32 v248, v141
s_nop 0
v_sub_f32 v227, v227, v248
v_exp_f32 v248, v142
s_nop 0
v_sub_f32 v227, v227, v248
v_exp_f32 v248, v143
s_nop 0
v_sub_f32 v227, v227, v248
v_max_f32 v227, 0, v227
v_min_f32 v227, s32, v227
v_log_f32 v248, v227
v_max3_f32 v235, v140, v141, v142
v_max3_f32 v235, v235, v143, v248
v_mov_b32 v248, v235
s_nop 1
v_permlane32_swap_b32 v235, v248
s_nop 1
v_max_f32 v235, v235, v248
v_mov_b32 v248, v235
s_nop 1
v_permlane16_swap_b32 v235, v248
s_nop 1
v_max_f32 v235, v235, v248
v_ceil_f32 v235, v235
v_max_f32 v235, 0, v235
v_sub_f32 v248, 0, v235
v_exp_f32 v239, v248
s_nop 1
v_mul_f32 v227, v227, v239
v_sub_f32 v204, v204, v235
v_sub_f32 v140, v140, v235
v_sub_f32 v156, v156, v235
v_sub_f32 v205, v205, v235
v_sub_f32 v141, v141, v235
v_sub_f32 v157, v157, v235
v_sub_f32 v206, v206, v235
v_sub_f32 v142, v142, v235
v_sub_f32 v158, v158, v235
v_sub_f32 v207, v207, v235
v_sub_f32 v143, v143, v235
v_sub_f32 v159, v159, v235
v_lshlrev_b32 v242, 16, v100
v_and_b32 v248, 0xffff0000, v100
v_mul_f32 v242, v242, v239
v_mul_f32 v248, v248, v239
v_cvt_pk_bf16_f32 v100, v242, v248
v_lshlrev_b32 v242, 16, v101
v_and_b32 v248, 0xffff0000, v101
v_mul_f32 v242, v242, v239
v_mul_f32 v248, v248, v239
v_cvt_pk_bf16_f32 v101, v242, v248
v_lshlrev_b32 v242, 16, v102
v_and_b32 v248, 0xffff0000, v102
v_mul_f32 v242, v242, v239
v_mul_f32 v248, v248, v239
v_cvt_pk_bf16_f32 v102, v242, v248
v_lshlrev_b32 v242, 16, v103
v_and_b32 v248, 0xffff0000, v103
v_mul_f32 v242, v242, v239
v_mul_f32 v248, v248, v239
v_cvt_pk_bf16_f32 v103, v242, v248
v_lshlrev_b32 v242, 16, v104
v_and_b32 v248, 0xffff0000, v104
v_mul_f32 v242, v242, v239
v_mul_f32 v248, v248, v239
v_cvt_pk_bf16_f32 v104, v242, v248
v_lshlrev_b32 v242, 16, v105
v_and_b32 v248, 0xffff0000, v105
v_mul_f32 v242, v242, v239
v_mul_f32 v248, v248, v239
v_cvt_pk_bf16_f32 v105, v242, v248
v_lshlrev_b32 v242, 16, v106
v_and_b32 v248, 0xffff0000, v106
v_mul_f32 v242, v242, v239
v_mul_f32 v248, v248, v239
v_cvt_pk_bf16_f32 v106, v242, v248
v_lshlrev_b32 v242, 16, v107
v_and_b32 v248, 0xffff0000, v107
v_mul_f32 v242, v242, v239
v_mul_f32 v248, v248, v239
v_cvt_pk_bf16_f32 v107, v242, v248
v_lshlrev_b32 v242, 16, v172
v_and_b32 v248, 0xffff0000, v172
v_mul_f32 v242, v242, v239
v_mul_f32 v248, v248, v239
v_cvt_pk_bf16_f32 v172, v242, v248
v_lshlrev_b32 v242, 16, v173
v_and_b32 v248, 0xffff0000, v173
v_mul_f32 v242, v242, v239
v_mul_f32 v248, v248, v239
v_cvt_pk_bf16_f32 v173, v242, v248
v_lshlrev_b32 v242, 16, v174
v_and_b32 v248, 0xffff0000, v174
v_mul_f32 v242, v242, v239
v_mul_f32 v248, v248, v239
v_cvt_pk_bf16_f32 v174, v242, v248
v_lshlrev_b32 v242, 16, v175
v_and_b32 v248, 0xffff0000, v175
v_mul_f32 v242, v242, v239
v_mul_f32 v248, v248, v239
v_cvt_pk_bf16_f32 v175, v242, v248
v_lshlrev_b32 v242, 16, v188
v_and_b32 v248, 0xffff0000, v188
v_mul_f32 v242, v242, v239
v_mul_f32 v248, v248, v239
v_cvt_pk_bf16_f32 v188, v242, v248
v_lshlrev_b32 v242, 16, v189
v_and_b32 v248, 0xffff0000, v189
v_mul_f32 v242, v242, v239
v_mul_f32 v248, v248, v239
v_cvt_pk_bf16_f32 v189, v242, v248
v_lshlrev_b32 v242, 16, v190
v_and_b32 v248, 0xffff0000, v190
v_mul_f32 v242, v242, v239
v_mul_f32 v248, v248, v239
v_cvt_pk_bf16_f32 v190, v242, v248
v_lshlrev_b32 v242, 16, v191
v_and_b32 v248, 0xffff0000, v191
v_mul_f32 v242, v242, v239
v_mul_f32 v248, v248, v239
v_cvt_pk_bf16_f32 v191, v242, v248
v_exp_f32 v232, v128
v_exp_f32 v233, v129
v_exp_f32 v234, v130
v_exp_f32 v235, v131
s_nop 1
v_add_f32 v224, v224, v232
v_add_f32 v224, v224, v233
v_add_f32 v224, v224, v234
v_add_f32 v224, v224, v235
v_cvt_pk_bf16_f32 v0, v232, v233
v_cvt_pk_bf16_f32 v1, v234, v235
v_exp_f32 v232, v132
v_exp_f32 v233, v133
v_exp_f32 v234, v134
v_exp_f32 v235, v135
s_nop 1
v_add_f32 v225, v225, v232
v_add_f32 v225, v225, v233
v_add_f32 v225, v225, v234
v_add_f32 v225, v225, v235
v_cvt_pk_bf16_f32 v32, v232, v233
v_cvt_pk_bf16_f32 v33, v234, v235
v_exp_f32 v232, v136
v_exp_f32 v233, v137
v_exp_f32 v234, v138
v_exp_f32 v235, v139
s_nop 1
v_add_f32 v226, v226, v232
v_add_f32 v226, v226, v233
v_add_f32 v226, v226, v234
v_add_f32 v226, v226, v235
v_cvt_pk_bf16_f32 v64, v232, v233
v_cvt_pk_bf16_f32 v65, v234, v235
v_exp_f32 v232, v140
v_exp_f32 v233, v141
v_exp_f32 v234, v142
v_exp_f32 v235, v143
s_nop 1
v_add_f32 v227, v227, v232
v_add_f32 v227, v227, v233
v_add_f32 v227, v227, v234
v_add_f32 v227, v227, v235
v_cvt_pk_bf16_f32 v96, v232, v233
v_cvt_pk_bf16_f32 v97, v234, v235
s_branch L2_rare_common
L2_rare_site17:
s_mov_b32 s36, 17
s_branch L2_rare_t0_5_1
L2_rare_t0_5_1:
s_nop 15
s_nop 15
s_waitcnt lgkmcnt(0)
v_exp_f32 v248, v144
s_nop 0
v_sub_f32 v224, v224, v248
v_exp_f32 v248, v145
s_nop 0
v_sub_f32 v224, v224, v248
v_exp_f32 v248, v146
s_nop 0
v_sub_f32 v224, v224, v248
v_exp_f32 v248, v147
s_nop 0
v_sub_f32 v224, v224, v248
v_max_f32 v224, 0, v224
v_min_f32 v224, s32, v224
v_log_f32 v248, v224
v_max3_f32 v232, v144, v145, v146
v_max3_f32 v232, v232, v147, v248
v_mov_b32 v248, v232
s_nop 1
v_permlane32_swap_b32 v232, v248
s_nop 1
v_max_f32 v232, v232, v248
v_mov_b32 v248, v232
s_nop 1
v_permlane16_swap_b32 v232, v248
s_nop 1
v_max_f32 v232, v232, v248
v_ceil_f32 v232, v232
v_max_f32 v232, 0, v232
v_sub_f32 v248, 0, v232
v_exp_f32 v236, v248
s_nop 1
v_mul_f32 v224, v224, v236
v_sub_f32 v192, v192, v232
v_sub_f32 v128, v128, v232
v_sub_f32 v144, v144, v232
v_sub_f32 v193, v193, v232
v_sub_f32 v129, v129, v232
v_sub_f32 v145, v145, v232
v_sub_f32 v194, v194, v232
v_sub_f32 v130, v130, v232
v_sub_f32 v146, v146, v232
v_sub_f32 v195, v195, v232
v_sub_f32 v131, v131, v232
v_sub_f32 v147, v147, v232
v_lshlrev_b32 v242, 16, v4
v_and_b32 v248, 0xffff0000, v4
v_mul_f32 v242, v242, v236
v_mul_f32 v248, v248, v236
v_cvt_pk_bf16_f32 v4, v242, v248
v_lshlrev_b32 v242, 16, v5
v_and_b32 v248, 0xffff0000, v5
v_mul_f32 v242, v242, v236
v_mul_f32 v248, v248, v236
v_cvt_pk_bf16_f32 v5, v242, v248
v_lshlrev_b32 v242, 16, v6
v_and_b32 v248, 0xffff0000, v6
v_mul_f32 v242, v242, v236
v_mul_f32 v248, v248, v236
v_cvt_pk_bf16_f32 v6, v242, v248
v_lshlrev_b32 v242, 16, v7
v_and_b32 v248, 0xffff0000, v7
v_mul_f32 v242, v242, v236
v_mul_f32 v248, v248, v236
v_cvt_pk_bf16_f32 v7, v242, v248
v_lshlrev_b32 v242, 16, v8
v_and_b32 v248, 0xffff0000, v8
v_mul_f32 v242, v242, v236
v_mul_f32 v248, v248, v236
v_cvt_pk_bf16_f32 v8, v242, v248
v_lshlrev_b32 v242, 16, v9
v_and_b32 v248, 0xffff0000, v9
v_mul_f32 v242, v242, v236
v_mul_f32 v248, v248, v236
v_cvt_pk_bf16_f32 v9, v242, v248
v_lshlrev_b32 v242, 16, v10
v_and_b32 v248, 0xffff0000, v10
v_mul_f32 v242, v242, v236
v_mul_f32 v248, v248, v236
v_cvt_pk_bf16_f32 v10, v242, v248
v_lshlrev_b32 v242, 16, v11
v_and_b32 v248, 0xffff0000, v11
v_mul_f32 v242, v242, v236
v_mul_f32 v248, v248, v236
v_cvt_pk_bf16_f32 v11, v242, v248
v_lshlrev_b32 v242, 16, v160
v_and_b32 v248, 0xffff0000, v160
v_mul_f32 v242, v242, v236
v_mul_f32 v248, v248, v236
v_cvt_pk_bf16_f32 v160, v242, v248
v_lshlrev_b32 v242, 16, v161
v_and_b32 v248, 0xffff0000, v161
v_mul_f32 v242, v242, v236
v_mul_f32 v248, v248, v236
v_cvt_pk_bf16_f32 v161, v242, v248
v_lshlrev_b32 v242, 16, v162
v_and_b32 v248, 0xffff0000, v162
v_mul_f32 v242, v242, v236
v_mul_f32 v248, v248, v236
v_cvt_pk_bf16_f32 v162, v242, v248
v_lshlrev_b32 v242, 16, v163
v_and_b32 v248, 0xffff0000, v163
v_mul_f32 v242, v242, v236
v_mul_f32 v248, v248, v236
v_cvt_pk_bf16_f32 v163, v242, v248
v_lshlrev_b32 v242, 16, v176
v_and_b32 v248, 0xffff0000, v176
v_mul_f32 v242, v242, v236
v_mul_f32 v248, v248, v236
v_cvt_pk_bf16_f32 v176, v242, v248
v_lshlrev_b32 v242, 16, v177
v_and_b32 v248, 0xffff0000, v177
v_mul_f32 v242, v242, v236
v_mul_f32 v248, v248, v236
v_cvt_pk_bf16_f32 v177, v242, v248
v_lshlrev_b32 v242, 16, v178
v_and_b32 v248, 0xffff0000, v178
v_mul_f32 v242, v242, v236
v_mul_f32 v248, v248, v236
v_cvt_pk_bf16_f32 v178, v242, v248
v_lshlrev_b32 v242, 16, v179
v_and_b32 v248, 0xffff0000, v179
v_mul_f32 v242, v242, v236
v_mul_f32 v248, v248, v236
v_cvt_pk_bf16_f32 v179, v242, v248
v_lshlrev_b32 v242, 16, v0
v_and_b32 v248, 0xffff0000, v0
v_mul_f32 v242, v242, v236
v_mul_f32 v248, v248, v236
v_cvt_pk_bf16_f32 v0, v242, v248
v_lshlrev_b32 v242, 16, v1
v_and_b32 v248, 0xffff0000, v1
v_mul_f32 v242, v242, v236
v_mul_f32 v248, v248, v236
v_cvt_pk_bf16_f32 v1, v242, v248
v_exp_f32 v248, v148
s_nop 0
v_sub_f32 v225, v225, v248
v_exp_f32 v248, v149
s_nop 0
v_sub_f32 v225, v225, v248
v_exp_f32 v248, v150
s_nop 0
v_sub_f32 v225, v225, v248
v_exp_f32 v248, v151
s_nop 0
v_sub_f32 v225, v225, v248
v_max_f32 v225, 0, v225
v_min_f32 v225, s32, v225
v_log_f32 v248, v225
v_max3_f32 v233, v148, v149, v150
v_max3_f32 v233, v233, v151, v248
v_mov_b32 v248, v233
s_nop 1
v_permlane32_swap_b32 v233, v248
s_nop 1
v_max_f32 v233, v233, v248
v_mov_b32 v248, v233
s_nop 1
v_permlane16_swap_b32 v233, v248
s_nop 1
v_max_f32 v233, v233, v248
v_ceil_f32 v233, v233
v_max_f32 v233, 0, v233
v_sub_f32 v248, 0, v233
v_exp_f32 v237, v248
s_nop 1
v_mul_f32 v225, v225, v237
v_sub_f32 v196, v196, v233
v_sub_f32 v132, v132, v233
v_sub_f32 v148, v148, v233
v_sub_f32 v197, v197, v233
v_sub_f32 v133, v133, v233
v_sub_f32 v149, v149, v233
v_sub_f32 v198, v198, v233
v_sub_f32 v134, v134, v233
v_sub_f32 v150, v150, v233
v_sub_f32 v199, v199, v233
v_sub_f32 v135, v135, v233
v_sub_f32 v151, v151, v233
v_lshlrev_b32 v242, 16, v36
v_and_b32 v248, 0xffff0000, v36
v_mul_f32 v242, v242, v237
v_mul_f32 v248, v248, v237
v_cvt_pk_bf16_f32 v36, v242, v248
v_lshlrev_b32 v242, 16, v37
v_and_b32 v248, 0xffff0000, v37
v_mul_f32 v242, v242, v237
v_mul_f32 v248, v248, v237
v_cvt_pk_bf16_f32 v37, v242, v248
v_lshlrev_b32 v242, 16, v38
v_and_b32 v248, 0xffff0000, v38
v_mul_f32 v242, v242, v237
v_mul_f32 v248, v248, v237
v_cvt_pk_bf16_f32 v38, v242, v248
v_lshlrev_b32 v242, 16, v39
v_and_b32 v248, 0xffff0000, v39
v_mul_f32 v242, v242, v237
v_mul_f32 v248, v248, v237
v_cvt_pk_bf16_f32 v39, v242, v248
v_lshlrev_b32 v242, 16, v40
v_and_b32 v248, 0xffff0000, v40
v_mul_f32 v242, v242, v237
v_mul_f32 v248, v248, v237
v_cvt_pk_bf16_f32 v40, v242, v248
v_lshlrev_b32 v242, 16, v41
v_and_b32 v248, 0xffff0000, v41
v_mul_f32 v242, v242, v237
v_mul_f32 v248, v248, v237
v_cvt_pk_bf16_f32 v41, v242, v248
v_lshlrev_b32 v242, 16, v42
v_and_b32 v248, 0xffff0000, v42
v_mul_f32 v242, v242, v237
v_mul_f32 v248, v248, v237
v_cvt_pk_bf16_f32 v42, v242, v248
v_lshlrev_b32 v242, 16, v43
v_and_b32 v248, 0xffff0000, v43
v_mul_f32 v242, v242, v237
v_mul_f32 v248, v248, v237
v_cvt_pk_bf16_f32 v43, v242, v248
v_lshlrev_b32 v242, 16, v164
v_and_b32 v248, 0xffff0000, v164
v_mul_f32 v242, v242, v237
v_mul_f32 v248, v248, v237
v_cvt_pk_bf16_f32 v164, v242, v248
v_lshlrev_b32 v242, 16, v165
v_and_b32 v248, 0xffff0000, v165
v_mul_f32 v242, v242, v237
v_mul_f32 v248, v248, v237
v_cvt_pk_bf16_f32 v165, v242, v248
v_lshlrev_b32 v242, 16, v166
v_and_b32 v248, 0xffff0000, v166
v_mul_f32 v242, v242, v237
v_mul_f32 v248, v248, v237
v_cvt_pk_bf16_f32 v166, v242, v248
v_lshlrev_b32 v242, 16, v167
v_and_b32 v248, 0xffff0000, v167
v_mul_f32 v242, v242, v237
v_mul_f32 v248, v248, v237
v_cvt_pk_bf16_f32 v167, v242, v248
v_lshlrev_b32 v242, 16, v180
v_and_b32 v248, 0xffff0000, v180
v_mul_f32 v242, v242, v237
v_mul_f32 v248, v248, v237
v_cvt_pk_bf16_f32 v180, v242, v248
v_lshlrev_b32 v242, 16, v181
v_and_b32 v248, 0xffff0000, v181
v_mul_f32 v242, v242, v237
v_mul_f32 v248, v248, v237
v_cvt_pk_bf16_f32 v181, v242, v248
v_lshlrev_b32 v242, 16, v182
v_and_b32 v248, 0xffff0000, v182
v_mul_f32 v242, v242, v237
v_mul_f32 v248, v248, v237
v_cvt_pk_bf16_f32 v182, v242, v248
v_lshlrev_b32 v242, 16, v183
v_and_b32 v248, 0xffff0000, v183
v_mul_f32 v242, v242, v237
v_mul_f32 v248, v248, v237
v_cvt_pk_bf16_f32 v183, v242, v248
v_lshlrev_b32 v242, 16, v32
v_and_b32 v248, 0xffff0000, v32
v_mul_f32 v242, v242, v237
v_mul_f32 v248, v248, v237
v_cvt_pk_bf16_f32 v32, v242, v248
v_lshlrev_b32 v242, 16, v33
v_and_b32 v248, 0xffff0000, v33
v_mul_f32 v242, v242, v237
v_mul_f32 v248, v248, v237
v_cvt_pk_bf16_f32 v33, v242, v248
v_exp_f32 v248, v152
s_nop 0
v_sub_f32 v226, v226, v248
v_exp_f32 v248, v153
s_nop 0
v_sub_f32 v226, v226, v248
v_exp_f32 v248, v154
s_nop 0
v_sub_f32 v226, v226, v248
v_exp_f32 v248, v155
s_nop 0
v_sub_f32 v226, v226, v248
v_max_f32 v226, 0, v226
v_min_f32 v226, s32, v226
v_log_f32 v248, v226
v_max3_f32 v234, v152, v153, v154
v_max3_f32 v234, v234, v155, v248
v_mov_b32 v248, v234
s_nop 1
v_permlane32_swap_b32 v234, v248
s_nop 1
v_max_f32 v234, v234, v248
v_mov_b32 v248, v234
s_nop 1
v_permlane16_swap_b32 v234, v248
s_nop 1
v_max_f32 v234, v234, v248
v_ceil_f32 v234, v234
v_max_f32 v234, 0, v234
v_sub_f32 v248, 0, v234
v_exp_f32 v238, v248
s_nop 1
v_mul_f32 v226, v226, v238
v_sub_f32 v200, v200, v234
v_sub_f32 v136, v136, v234
v_sub_f32 v152, v152, v234
v_sub_f32 v201, v201, v234
v_sub_f32 v137, v137, v234
v_sub_f32 v153, v153, v234
v_sub_f32 v202, v202, v234
v_sub_f32 v138, v138, v234
v_sub_f32 v154, v154, v234
v_sub_f32 v203, v203, v234
v_sub_f32 v139, v139, v234
v_sub_f32 v155, v155, v234
v_lshlrev_b32 v242, 16, v68
v_and_b32 v248, 0xffff0000, v68
v_mul_f32 v242, v242, v238
v_mul_f32 v248, v248, v238
v_cvt_pk_bf16_f32 v68, v242, v248
v_lshlrev_b32 v242, 16, v69
v_and_b32 v248, 0xffff0000, v69
v_mul_f32 v242, v242, v238
v_mul_f32 v248, v248, v238
v_cvt_pk_bf16_f32 v69, v242, v248
v_lshlrev_b32 v242, 16, v70
v_and_b32 v248, 0xffff0000, v70
v_mul_f32 v242, v242, v238
v_mul_f32 v248, v248, v238
v_cvt_pk_bf16_f32 v70, v242, v248
v_lshlrev_b32 v242, 16, v71
v_and_b32 v248, 0xffff0000, v71
v_mul_f32 v242, v242, v238
v_mul_f32 v248, v248, v238
v_cvt_pk_bf16_f32 v71, v242, v248
v_lshlrev_b32 v242, 16, v72
v_and_b32 v248, 0xffff0000, v72
v_mul_f32 v242, v242, v238
v_mul_f32 v248, v248, v238
v_cvt_pk_bf16_f32 v72, v242, v248
v_lshlrev_b32 v242, 16, v73
v_and_b32 v248, 0xffff0000, v73
v_mul_f32 v242, v242, v238
v_mul_f32 v248, v248, v238
v_cvt_pk_bf16_f32 v73, v242, v248
v_lshlrev_b32 v242, 16, v74
v_and_b32 v248, 0xffff0000, v74
v_mul_f32 v242, v242, v238
v_mul_f32 v248, v248, v238
v_cvt_pk_bf16_f32 v74, v242, v248
v_lshlrev_b32 v242, 16, v75
v_and_b32 v248, 0xffff0000, v75
v_mul_f32 v242, v242, v238
v_mul_f32 v248, v248, v238
v_cvt_pk_bf16_f32 v75, v242, v248
v_lshlrev_b32 v242, 16, v168
v_and_b32 v248, 0xffff0000, v168
v_mul_f32 v242, v242, v238
v_mul_f32 v248, v248, v238
v_cvt_pk_bf16_f32 v168, v242, v248
v_lshlrev_b32 v242, 16, v169
v_and_b32 v248, 0xffff0000, v169
v_mul_f32 v242, v242, v238
v_mul_f32 v248, v248, v238
v_cvt_pk_bf16_f32 v169, v242, v248
v_lshlrev_b32 v242, 16, v170
v_and_b32 v248, 0xffff0000, v170
v_mul_f32 v242, v242, v238
v_mul_f32 v248, v248, v238
v_cvt_pk_bf16_f32 v170, v242, v248
v_lshlrev_b32 v242, 16, v171
v_and_b32 v248, 0xffff0000, v171
v_mul_f32 v242, v242, v238
v_mul_f32 v248, v248, v238
v_cvt_pk_bf16_f32 v171, v242, v248
v_lshlrev_b32 v242, 16, v184
v_and_b32 v248, 0xffff0000, v184
v_mul_f32 v242, v242, v238
v_mul_f32 v248, v248, v238
v_cvt_pk_bf16_f32 v184, v242, v248
v_lshlrev_b32 v242, 16, v185
v_and_b32 v248, 0xffff0000, v185
v_mul_f32 v242, v242, v238
v_mul_f32 v248, v248, v238
v_cvt_pk_bf16_f32 v185, v242, v248
v_lshlrev_b32 v242, 16, v186
v_and_b32 v248, 0xffff0000, v186
v_mul_f32 v242, v242, v238
v_mul_f32 v248, v248, v238
v_cvt_pk_bf16_f32 v186, v242, v248
v_lshlrev_b32 v242, 16, v187
v_and_b32 v248, 0xffff0000, v187
v_mul_f32 v242, v242, v238
v_mul_f32 v248, v248, v238
v_cvt_pk_bf16_f32 v187, v242, v248
v_lshlrev_b32 v242, 16, v64
v_and_b32 v248, 0xffff0000, v64
v_mul_f32 v242, v242, v238
v_mul_f32 v248, v248, v238
v_cvt_pk_bf16_f32 v64, v242, v248
v_lshlrev_b32 v242, 16, v65
v_and_b32 v248, 0xffff0000, v65
v_mul_f32 v242, v242, v238
v_mul_f32 v248, v248, v238
v_cvt_pk_bf16_f32 v65, v242, v248
v_exp_f32 v248, v156
s_nop 0
v_sub_f32 v227, v227, v248
v_exp_f32 v248, v157
s_nop 0
v_sub_f32 v227, v227, v248
v_exp_f32 v248, v158
s_nop 0
v_sub_f32 v227, v227, v248
v_exp_f32 v248, v159
s_nop 0
v_sub_f32 v227, v227, v248
v_max_f32 v227, 0, v227
v_min_f32 v227, s32, v227
v_log_f32 v248, v227
v_max3_f32 v235, v156, v157, v158
v_max3_f32 v235, v235, v159, v248
v_mov_b32 v248, v235
s_nop 1
v_permlane32_swap_b32 v235, v248
s_nop 1
v_max_f32 v235, v235, v248
v_mov_b32 v248, v235
s_nop 1
v_permlane16_swap_b32 v235, v248
s_nop 1
v_max_f32 v235, v235, v248
v_ceil_f32 v235, v235
v_max_f32 v235, 0, v235
v_sub_f32 v248, 0, v235
v_exp_f32 v239, v248
s_nop 1
v_mul_f32 v227, v227, v239
v_sub_f32 v204, v204, v235
v_sub_f32 v140, v140, v235
v_sub_f32 v156, v156, v235
v_sub_f32 v205, v205, v235
v_sub_f32 v141, v141, v235
v_sub_f32 v157, v157, v235
v_sub_f32 v206, v206, v235
v_sub_f32 v142, v142, v235
v_sub_f32 v158, v158, v235
v_sub_f32 v207, v207, v235
v_sub_f32 v143, v143, v235
v_sub_f32 v159, v159, v235
v_lshlrev_b32 v242, 16, v100
v_and_b32 v248, 0xffff0000, v100
v_mul_f32 v242, v242, v239
v_mul_f32 v248, v248, v239
v_cvt_pk_bf16_f32 v100, v242, v248
v_lshlrev_b32 v242, 16, v101
v_and_b32 v248, 0xffff0000, v101
v_mul_f32 v242, v242, v239
v_mul_f32 v248, v248, v239
v_cvt_pk_bf16_f32 v101, v242, v248
v_lshlrev_b32 v242, 16, v102
v_and_b32 v248, 0xffff0000, v102
v_mul_f32 v242, v242, v239
v_mul_f32 v248, v248, v239
v_cvt_pk_bf16_f32 v102, v242, v248
v_lshlrev_b32 v242, 16, v103
v_and_b32 v248, 0xffff0000, v103
v_mul_f32 v242, v242, v239
v_mul_f32 v248, v248, v239
v_cvt_pk_bf16_f32 v103, v242, v248
v_lshlrev_b32 v242, 16, v104
v_and_b32 v248, 0xffff0000, v104
v_mul_f32 v242, v242, v239
v_mul_f32 v248, v248, v239
v_cvt_pk_bf16_f32 v104, v242, v248
v_lshlrev_b32 v242, 16, v105
v_and_b32 v248, 0xffff0000, v105
v_mul_f32 v242, v242, v239
v_mul_f32 v248, v248, v239
v_cvt_pk_bf16_f32 v105, v242, v248
v_lshlrev_b32 v242, 16, v106
v_and_b32 v248, 0xffff0000, v106
v_mul_f32 v242, v242, v239
v_mul_f32 v248, v248, v239
v_cvt_pk_bf16_f32 v106, v242, v248
v_lshlrev_b32 v242, 16, v107
v_and_b32 v248, 0xffff0000, v107
v_mul_f32 v242, v242, v239
v_mul_f32 v248, v248, v239
v_cvt_pk_bf16_f32 v107, v242, v248
v_lshlrev_b32 v242, 16, v172
v_and_b32 v248, 0xffff0000, v172
v_mul_f32 v242, v242, v239
v_mul_f32 v248, v248, v239
v_cvt_pk_bf16_f32 v172, v242, v248
v_lshlrev_b32 v242, 16, v173
v_and_b32 v248, 0xffff0000, v173
v_mul_f32 v242, v242, v239
v_mul_f32 v248, v248, v239
v_cvt_pk_bf16_f32 v173, v242, v248
v_lshlrev_b32 v242, 16, v174
v_and_b32 v248, 0xffff0000, v174
v_mul_f32 v242, v242, v239
v_mul_f32 v248, v248, v239
v_cvt_pk_bf16_f32 v174, v242, v248
v_lshlrev_b32 v242, 16, v175
v_and_b32 v248, 0xffff0000, v175
v_mul_f32 v242, v242, v239
v_mul_f32 v248, v248, v239
v_cvt_pk_bf16_f32 v175, v242, v248
v_lshlrev_b32 v242, 16, v188
v_and_b32 v248, 0xffff0000, v188
v_mul_f32 v242, v242, v239
v_mul_f32 v248, v248, v239
v_cvt_pk_bf16_f32 v188, v242, v248
v_lshlrev_b32 v242, 16, v189
v_and_b32 v248, 0xffff0000, v189
v_mul_f32 v242, v242, v239
v_mul_f32 v248, v248, v239
v_cvt_pk_bf16_f32 v189, v242, v248
v_lshlrev_b32 v242, 16, v190
v_and_b32 v248, 0xffff0000, v190
v_mul_f32 v242, v242, v239
v_mul_f32 v248, v248, v239
v_cvt_pk_bf16_f32 v190, v242, v248
v_lshlrev_b32 v242, 16, v191
v_and_b32 v248, 0xffff0000, v191
v_mul_f32 v242, v242, v239
v_mul_f32 v248, v248, v239
v_cvt_pk_bf16_f32 v191, v242, v248
v_lshlrev_b32 v242, 16, v96
v_and_b32 v248, 0xffff0000, v96
v_mul_f32 v242, v242, v239
v_mul_f32 v248, v248, v239
v_cvt_pk_bf16_f32 v96, v242, v248
v_lshlrev_b32 v242, 16, v97
v_and_b32 v248, 0xffff0000, v97
v_mul_f32 v242, v242, v239
v_mul_f32 v248, v248, v239
v_cvt_pk_bf16_f32 v97, v242, v248
v_exp_f32 v232, v144
v_exp_f32 v233, v145
v_exp_f32 v234, v146
v_exp_f32 v235, v147
s_nop 1
v_add_f32 v224, v224, v232
v_add_f32 v224, v224, v233
v_add_f32 v224, v224, v234
v_add_f32 v224, v224, v235
v_cvt_pk_bf16_f32 v2, v232, v233
v_cvt_pk_bf16_f32 v3, v234, v235
v_exp_f32 v232, v148
v_exp_f32 v233, v149
v_exp_f32 v234, v150
v_exp_f32 v235, v151
s_nop 1
v_add_f32 v225, v225, v232
v_add_f32 v225, v225, v233
v_add_f32 v225, v225, v234
v_add_f32 v225, v225, v235
v_cvt_pk_bf16_f32 v34, v232, v233
v_cvt_pk_bf16_f32 v35, v234, v235
v_exp_f32 v232, v152
v_exp_f32 v233, v153
v_exp_f32 v234, v154
v_exp_f32 v235, v155
s_nop 1
v_add_f32 v226, v226, v232
v_add_f32 v226, v226, v233
v_add_f32 v226, v226, v234
v_add_f32 v226, v226, v235
v_cvt_pk_bf16_f32 v66, v232, v233
v_cvt_pk_bf16_f32 v67, v234, v235
v_exp_f32 v232, v156
v_exp_f32 v233, v157
v_exp_f32 v234, v158
v_exp_f32 v235, v159
s_nop 1
v_add_f32 v227, v227, v232
v_add_f32 v227, v227, v233
v_add_f32 v227, v227, v234
v_add_f32 v227, v227, v235
v_cvt_pk_bf16_f32 v98, v232, v233
v_cvt_pk_bf16_f32 v99, v234, v235
s_branch L2_rare_common
LF_hl_0:
s_mov_b32 s94, 0x10000
s_mov_b32 s3, 0x7c28000
LF_hl2_0:
v_lshlrev_b32 v241, 3, v243
buffer_load_dwordx2 v[240:241], v241, s[16:19], s3 offen sc1
s_sub_u32 s94, s94, 1
s_waitcnt vmcnt(0)
s_cbranch_scc1 LF_hlret_0
v_cmp_ne_u64_e64 s[38:39], s[98:99], v[240:241]
s_and_b64 s[38:39], s[38:39], s[96:97]
s_cbranch_scc1 LF_hl2_0
s_branch LF_hlret_0
L2_rare_common:
v_lshrrev_b32 v232, 4, v243
v_and_b32 v232, 0x30, v232
ds_bpermute_b32 v242, v232, v236 offset:0
ds_bpermute_b32 v248, v232, v236 offset:4
ds_bpermute_b32 v250, v232, v236 offset:8
ds_bpermute_b32 v251, v232, v236 offset:12
s_waitcnt lgkmcnt(0)
v_accvgpr_read_b32 v232, a0
v_accvgpr_read_b32 v233, a1
v_accvgpr_read_b32 v234, a2
v_accvgpr_read_b32 v235, a3
v_mul_f32 v232, v232, v242
v_mul_f32 v233, v233, v248
v_mul_f32 v234, v234, v250
v_mul_f32 v235, v235, v251
v_accvgpr_write_b32 a0, v232
v_accvgpr_write_b32 a1, v233
v_accvgpr_write_b32 a2, v234
v_accvgpr_write_b32 a3, v235
v_accvgpr_read_b32 v232, a16
v_accvgpr_read_b32 v233, a17
v_accvgpr_read_b32 v234, a18
v_accvgpr_read_b32 v235, a19
v_mul_f32 v232, v232, v242
v_mul_f32 v233, v233, v248
v_mul_f32 v234, v234, v250
v_mul_f32 v235, v235, v251
v_accvgpr_write_b32 a16, v232
v_accvgpr_write_b32 a17, v233
v_accvgpr_write_b32 a18, v234
v_accvgpr_write_b32 a19, v235
v_accvgpr_read_b32 v232, a32
v_accvgpr_read_b32 v233, a33
v_accvgpr_read_b32 v234, a34
v_accvgpr_read_b32 v235, a35
v_mul_f32 v232, v232, v242
v_mul_f32 v233, v233, v248
v_mul_f32 v234, v234, v250
v_mul_f32 v235, v235, v251
v_accvgpr_write_b32 a32, v232
v_accvgpr_write_b32 a33, v233
v_accvgpr_write_b32 a34, v234
v_accvgpr_write_b32 a35, v235
v_accvgpr_read_b32 v232, a48
v_accvgpr_read_b32 v233, a49
v_accvgpr_read_b32 v234, a50
v_accvgpr_read_b32 v235, a51
v_mul_f32 v232, v232, v242
v_mul_f32 v233, v233, v248
v_mul_f32 v234, v234, v250
v_mul_f32 v235, v235, v251
v_accvgpr_write_b32 a48, v232
v_accvgpr_write_b32 a49, v233
v_accvgpr_write_b32 a50, v234
v_accvgpr_write_b32 a51, v235
v_accvgpr_read_b32 v232, a64
v_accvgpr_read_b32 v233, a65
v_accvgpr_read_b32 v234, a66
v_accvgpr_read_b32 v235, a67
v_mul_f32 v232, v232, v242
v_mul_f32 v233, v233, v248
v_mul_f32 v234, v234, v250
v_mul_f32 v235, v235, v251
v_accvgpr_write_b32 a64, v232
v_accvgpr_write_b32 a65, v233
v_accvgpr_write_b32 a66, v234
v_accvgpr_write_b32 a67, v235
v_accvgpr_read_b32 v232, a80
v_accvgpr_read_b32 v233, a81
v_accvgpr_read_b32 v234, a82
v_accvgpr_read_b32 v235, a83
v_mul_f32 v232, v232, v242
v_mul_f32 v233, v233, v248
v_mul_f32 v234, v234, v250
v_mul_f32 v235, v235, v251
v_accvgpr_write_b32 a80, v232
v_accvgpr_write_b32 a81, v233
v_accvgpr_write_b32 a82, v234
v_accvgpr_write_b32 a83, v235
v_accvgpr_read_b32 v232, a96
v_accvgpr_read_b32 v233, a97
v_accvgpr_read_b32 v234, a98
v_accvgpr_read_b32 v235, a99
v_mul_f32 v232, v232, v242
v_mul_f32 v233, v233, v248
v_mul_f32 v234, v234, v250
v_mul_f32 v235, v235, v251
v_accvgpr_write_b32 a96, v232
v_accvgpr_write_b32 a97, v233
v_accvgpr_write_b32 a98, v234
v_accvgpr_write_b32 a99, v235
v_accvgpr_read_b32 v232, a112
v_accvgpr_read_b32 v233, a113
v_accvgpr_read_b32 v234, a114
v_accvgpr_read_b32 v235, a115
v_mul_f32 v232, v232, v242
v_mul_f32 v233, v233, v248
v_mul_f32 v234, v234, v250
v_mul_f32 v235, v235, v251
v_accvgpr_write_b32 a112, v232
v_accvgpr_write_b32 a113, v233
v_accvgpr_write_b32 a114, v234
v_accvgpr_write_b32 a115, v235
v_accvgpr_read_b32 v232, a128
v_accvgpr_read_b32 v233, a129
v_accvgpr_read_b32 v234, a130
v_accvgpr_read_b32 v235, a131
v_mul_f32 v232, v232, v242
v_mul_f32 v233, v233, v248
v_mul_f32 v234, v234, v250
v_mul_f32 v235, v235, v251
v_accvgpr_write_b32 a128, v232
v_accvgpr_write_b32 a129, v233
v_accvgpr_write_b32 a130, v234
v_accvgpr_write_b32 a131, v235
v_accvgpr_read_b32 v232, a144
v_accvgpr_read_b32 v233, a145
v_accvgpr_read_b32 v234, a146
v_accvgpr_read_b32 v235, a147
v_mul_f32 v232, v232, v242
v_mul_f32 v233, v233, v248
v_mul_f32 v234, v234, v250
v_mul_f32 v235, v235, v251
v_accvgpr_write_b32 a144, v232
v_accvgpr_write_b32 a145, v233
v_accvgpr_write_b32 a146, v234
v_accvgpr_write_b32 a147, v235
v_accvgpr_read_b32 v232, a160
v_accvgpr_read_b32 v233, a161
v_accvgpr_read_b32 v234, a162
v_accvgpr_read_b32 v235, a163
v_mul_f32 v232, v232, v242
v_mul_f32 v233, v233, v248
v_mul_f32 v234, v234, v250
v_mul_f32 v235, v235, v251
v_accvgpr_write_b32 a160, v232
v_accvgpr_write_b32 a161, v233
v_accvgpr_write_b32 a162, v234
v_accvgpr_write_b32 a163, v235
v_accvgpr_read_b32 v232, a176
v_accvgpr_read_b32 v233, a177
v_accvgpr_read_b32 v234, a178
v_accvgpr_read_b32 v235, a179
v_mul_f32 v232, v232, v242
v_mul_f32 v233, v233, v248
v_mul_f32 v234, v234, v250
v_mul_f32 v235, v235, v251
v_accvgpr_write_b32 a176, v232
v_accvgpr_write_b32 a177, v233
v_accvgpr_write_b32 a178, v234
v_accvgpr_write_b32 a179, v235
v_accvgpr_read_b32 v232, a192
v_accvgpr_read_b32 v233, a193
v_accvgpr_read_b32 v234, a194
v_accvgpr_read_b32 v235, a195
v_mul_f32 v232, v232, v242
v_mul_f32 v233, v233, v248
v_mul_f32 v234, v234, v250
v_mul_f32 v235, v235, v251
v_accvgpr_write_b32 a192, v232
v_accvgpr_write_b32 a193, v233
v_accvgpr_write_b32 a194, v234
v_accvgpr_write_b32 a195, v235
v_accvgpr_read_b32 v232, a208
v_accvgpr_read_b32 v233, a209
v_accvgpr_read_b32 v234, a210
v_accvgpr_read_b32 v235, a211
v_mul_f32 v232, v232, v242
v_mul_f32 v233, v233, v248
v_mul_f32 v234, v234, v250
v_mul_f32 v235, v235, v251
v_accvgpr_write_b32 a208, v232
v_accvgpr_write_b32 a209, v233
v_accvgpr_write_b32 a210, v234
v_accvgpr_write_b32 a211, v235
v_accvgpr_read_b32 v232, a224
v_accvgpr_read_b32 v233, a225
v_accvgpr_read_b32 v234, a226
v_accvgpr_read_b32 v235, a227
v_mul_f32 v232, v232, v242
v_mul_f32 v233, v233, v248
v_mul_f32 v234, v234, v250
v_mul_f32 v235, v235, v251
v_accvgpr_write_b32 a224, v232
v_accvgpr_write_b32 a225, v233
v_accvgpr_write_b32 a226, v234
v_accvgpr_write_b32 a227, v235
v_accvgpr_read_b32 v232, a240
v_accvgpr_read_b32 v233, a241
v_accvgpr_read_b32 v234, a242
v_accvgpr_read_b32 v235, a243
v_mul_f32 v232, v232, v242
v_mul_f32 v233, v233, v248
v_mul_f32 v234, v234, v250
v_mul_f32 v235, v235, v251
v_accvgpr_write_b32 a240, v232
v_accvgpr_write_b32 a241, v233
v_accvgpr_write_b32 a242, v234
v_accvgpr_write_b32 a243, v235
v_lshrrev_b32 v232, 4, v243
v_and_b32 v232, 0x30, v232
ds_bpermute_b32 v242, v232, v237 offset:0
ds_bpermute_b32 v248, v232, v237 offset:4
ds_bpermute_b32 v250, v232, v237 offset:8
ds_bpermute_b32 v251, v232, v237 offset:12
s_waitcnt lgkmcnt(0)
v_accvgpr_read_b32 v232, a4
v_accvgpr_read_b32 v233, a5
v_accvgpr_read_b32 v234, a6
v_accvgpr_read_b32 v235, a7
v_mul_f32 v232, v232, v242
v_mul_f32 v233, v233, v248
v_mul_f32 v234, v234, v250
v_mul_f32 v235, v235, v251
v_accvgpr_write_b32 a4, v232
v_accvgpr_write_b32 a5, v233
v_accvgpr_write_b32 a6, v234
v_accvgpr_write_b32 a7, v235
v_accvgpr_read_b32 v232, a20
v_accvgpr_read_b32 v233, a21
v_accvgpr_read_b32 v234, a22
v_accvgpr_read_b32 v235, a23
v_mul_f32 v232, v232, v242
v_mul_f32 v233, v233, v248
v_mul_f32 v234, v234, v250
v_mul_f32 v235, v235, v251
v_accvgpr_write_b32 a20, v232
v_accvgpr_write_b32 a21, v233
v_accvgpr_write_b32 a22, v234
v_accvgpr_write_b32 a23, v235
v_accvgpr_read_b32 v232, a36
v_accvgpr_read_b32 v233, a37
v_accvgpr_read_b32 v234, a38
v_accvgpr_read_b32 v235, a39
v_mul_f32 v232, v232, v242
v_mul_f32 v233, v233, v248
v_mul_f32 v234, v234, v250
v_mul_f32 v235, v235, v251
v_accvgpr_write_b32 a36, v232
v_accvgpr_write_b32 a37, v233
v_accvgpr_write_b32 a38, v234
v_accvgpr_write_b32 a39, v235
v_accvgpr_read_b32 v232, a52
v_accvgpr_read_b32 v233, a53
v_accvgpr_read_b32 v234, a54
v_accvgpr_read_b32 v235, a55
v_mul_f32 v232, v232, v242
v_mul_f32 v233, v233, v248
v_mul_f32 v234, v234, v250
v_mul_f32 v235, v235, v251
v_accvgpr_write_b32 a52, v232
v_accvgpr_write_b32 a53, v233
v_accvgpr_write_b32 a54, v234
v_accvgpr_write_b32 a55, v235
v_accvgpr_read_b32 v232, a68
v_accvgpr_read_b32 v233, a69
v_accvgpr_read_b32 v234, a70
v_accvgpr_read_b32 v235, a71
v_mul_f32 v232, v232, v242
v_mul_f32 v233, v233, v248
v_mul_f32 v234, v234, v250
v_mul_f32 v235, v235, v251
v_accvgpr_write_b32 a68, v232
v_accvgpr_write_b32 a69, v233
v_accvgpr_write_b32 a70, v234
v_accvgpr_write_b32 a71, v235
v_accvgpr_read_b32 v232, a84
v_accvgpr_read_b32 v233, a85
v_accvgpr_read_b32 v234, a86
v_accvgpr_read_b32 v235, a87
v_mul_f32 v232, v232, v242
v_mul_f32 v233, v233, v248
v_mul_f32 v234, v234, v250
v_mul_f32 v235, v235, v251
v_accvgpr_write_b32 a84, v232
v_accvgpr_write_b32 a85, v233
v_accvgpr_write_b32 a86, v234
v_accvgpr_write_b32 a87, v235
v_accvgpr_read_b32 v232, a100
v_accvgpr_read_b32 v233, a101
v_accvgpr_read_b32 v234, a102
v_accvgpr_read_b32 v235, a103
v_mul_f32 v232, v232, v242
v_mul_f32 v233, v233, v248
v_mul_f32 v234, v234, v250
v_mul_f32 v235, v235, v251
v_accvgpr_write_b32 a100, v232
v_accvgpr_write_b32 a101, v233
v_accvgpr_write_b32 a102, v234
v_accvgpr_write_b32 a103, v235
v_accvgpr_read_b32 v232, a116
v_accvgpr_read_b32 v233, a117
v_accvgpr_read_b32 v234, a118
v_accvgpr_read_b32 v235, a119
v_mul_f32 v232, v232, v242
v_mul_f32 v233, v233, v248
v_mul_f32 v234, v234, v250
v_mul_f32 v235, v235, v251
v_accvgpr_write_b32 a116, v232
v_accvgpr_write_b32 a117, v233
v_accvgpr_write_b32 a118, v234
v_accvgpr_write_b32 a119, v235
v_accvgpr_read_b32 v232, a132
v_accvgpr_read_b32 v233, a133
v_accvgpr_read_b32 v234, a134
v_accvgpr_read_b32 v235, a135
v_mul_f32 v232, v232, v242
v_mul_f32 v233, v233, v248
v_mul_f32 v234, v234, v250
v_mul_f32 v235, v235, v251
v_accvgpr_write_b32 a132, v232
v_accvgpr_write_b32 a133, v233
v_accvgpr_write_b32 a134, v234
v_accvgpr_write_b32 a135, v235
v_accvgpr_read_b32 v232, a148
v_accvgpr_read_b32 v233, a149
v_accvgpr_read_b32 v234, a150
v_accvgpr_read_b32 v235, a151
v_mul_f32 v232, v232, v242
v_mul_f32 v233, v233, v248
v_mul_f32 v234, v234, v250
v_mul_f32 v235, v235, v251
v_accvgpr_write_b32 a148, v232
v_accvgpr_write_b32 a149, v233
v_accvgpr_write_b32 a150, v234
v_accvgpr_write_b32 a151, v235
v_accvgpr_read_b32 v232, a164
v_accvgpr_read_b32 v233, a165
v_accvgpr_read_b32 v234, a166
v_accvgpr_read_b32 v235, a167
v_mul_f32 v232, v232, v242
v_mul_f32 v233, v233, v248
v_mul_f32 v234, v234, v250
v_mul_f32 v235, v235, v251
v_accvgpr_write_b32 a164, v232
v_accvgpr_write_b32 a165, v233
v_accvgpr_write_b32 a166, v234
v_accvgpr_write_b32 a167, v235
v_accvgpr_read_b32 v232, a180
v_accvgpr_read_b32 v233, a181
v_accvgpr_read_b32 v234, a182
v_accvgpr_read_b32 v235, a183
v_mul_f32 v232, v232, v242
v_mul_f32 v233, v233, v248
v_mul_f32 v234, v234, v250
v_mul_f32 v235, v235, v251
v_accvgpr_write_b32 a180, v232
v_accvgpr_write_b32 a181, v233
v_accvgpr_write_b32 a182, v234
v_accvgpr_write_b32 a183, v235
v_accvgpr_read_b32 v232, a196
v_accvgpr_read_b32 v233, a197
v_accvgpr_read_b32 v234, a198
v_accvgpr_read_b32 v235, a199
v_mul_f32 v232, v232, v242
v_mul_f32 v233, v233, v248
v_mul_f32 v234, v234, v250
v_mul_f32 v235, v235, v251
v_accvgpr_write_b32 a196, v232
v_accvgpr_write_b32 a197, v233
v_accvgpr_write_b32 a198, v234
v_accvgpr_write_b32 a199, v235
v_accvgpr_read_b32 v232, a212
v_accvgpr_read_b32 v233, a213
v_accvgpr_read_b32 v234, a214
v_accvgpr_read_b32 v235, a215
v_mul_f32 v232, v232, v242
v_mul_f32 v233, v233, v248
v_mul_f32 v234, v234, v250
v_mul_f32 v235, v235, v251
v_accvgpr_write_b32 a212, v232
v_accvgpr_write_b32 a213, v233
v_accvgpr_write_b32 a214, v234
v_accvgpr_write_b32 a215, v235
v_accvgpr_read_b32 v232, a228
v_accvgpr_read_b32 v233, a229
v_accvgpr_read_b32 v234, a230
v_accvgpr_read_b32 v235, a231
v_mul_f32 v232, v232, v242
v_mul_f32 v233, v233, v248
v_mul_f32 v234, v234, v250
v_mul_f32 v235, v235, v251
v_accvgpr_write_b32 a228, v232
v_accvgpr_write_b32 a229, v233
v_accvgpr_write_b32 a230, v234
v_accvgpr_write_b32 a231, v235
v_accvgpr_read_b32 v232, a244
v_accvgpr_read_b32 v233, a245
v_accvgpr_read_b32 v234, a246
v_accvgpr_read_b32 v235, a247
v_mul_f32 v232, v232, v242
v_mul_f32 v233, v233, v248
v_mul_f32 v234, v234, v250
v_mul_f32 v235, v235, v251
v_accvgpr_write_b32 a244, v232
v_accvgpr_write_b32 a245, v233
v_accvgpr_write_b32 a246, v234
v_accvgpr_write_b32 a247, v235
v_lshrrev_b32 v232, 4, v243
v_and_b32 v232, 0x30, v232
ds_bpermute_b32 v242, v232, v238 offset:0
ds_bpermute_b32 v248, v232, v238 offset:4
ds_bpermute_b32 v250, v232, v238 offset:8
ds_bpermute_b32 v251, v232, v238 offset:12
s_waitcnt lgkmcnt(0)
v_accvgpr_read_b32 v232, a8
v_accvgpr_read_b32 v233, a9
v_accvgpr_read_b32 v234, a10
v_accvgpr_read_b32 v235, a11
v_mul_f32 v232, v232, v242
v_mul_f32 v233, v233, v248
v_mul_f32 v234, v234, v250
v_mul_f32 v235, v235, v251
v_accvgpr_write_b32 a8, v232
v_accvgpr_write_b32 a9, v233
v_accvgpr_write_b32 a10, v234
v_accvgpr_write_b32 a11, v235
v_accvgpr_read_b32 v232, a24
v_accvgpr_read_b32 v233, a25
v_accvgpr_read_b32 v234, a26
v_accvgpr_read_b32 v235, a27
v_mul_f32 v232, v232, v242
v_mul_f32 v233, v233, v248
v_mul_f32 v234, v234, v250
v_mul_f32 v235, v235, v251
v_accvgpr_write_b32 a24, v232
v_accvgpr_write_b32 a25, v233
v_accvgpr_write_b32 a26, v234
v_accvgpr_write_b32 a27, v235
v_accvgpr_read_b32 v232, a40
v_accvgpr_read_b32 v233, a41
v_accvgpr_read_b32 v234, a42
v_accvgpr_read_b32 v235, a43
v_mul_f32 v232, v232, v242
v_mul_f32 v233, v233, v248
v_mul_f32 v234, v234, v250
v_mul_f32 v235, v235, v251
v_accvgpr_write_b32 a40, v232
v_accvgpr_write_b32 a41, v233
v_accvgpr_write_b32 a42, v234
v_accvgpr_write_b32 a43, v235
v_accvgpr_read_b32 v232, a56
v_accvgpr_read_b32 v233, a57
v_accvgpr_read_b32 v234, a58
v_accvgpr_read_b32 v235, a59
v_mul_f32 v232, v232, v242
v_mul_f32 v233, v233, v248
v_mul_f32 v234, v234, v250
v_mul_f32 v235, v235, v251
v_accvgpr_write_b32 a56, v232
v_accvgpr_write_b32 a57, v233
v_accvgpr_write_b32 a58, v234
v_accvgpr_write_b32 a59, v235
v_accvgpr_read_b32 v232, a72
v_accvgpr_read_b32 v233, a73
v_accvgpr_read_b32 v234, a74
v_accvgpr_read_b32 v235, a75
v_mul_f32 v232, v232, v242
v_mul_f32 v233, v233, v248
v_mul_f32 v234, v234, v250
v_mul_f32 v235, v235, v251
v_accvgpr_write_b32 a72, v232
v_accvgpr_write_b32 a73, v233
v_accvgpr_write_b32 a74, v234
v_accvgpr_write_b32 a75, v235
v_accvgpr_read_b32 v232, a88
v_accvgpr_read_b32 v233, a89
v_accvgpr_read_b32 v234, a90
v_accvgpr_read_b32 v235, a91
v_mul_f32 v232, v232, v242
v_mul_f32 v233, v233, v248
v_mul_f32 v234, v234, v250
v_mul_f32 v235, v235, v251
v_accvgpr_write_b32 a88, v232
v_accvgpr_write_b32 a89, v233
v_accvgpr_write_b32 a90, v234
v_accvgpr_write_b32 a91, v235
v_accvgpr_read_b32 v232, a104
v_accvgpr_read_b32 v233, a105
v_accvgpr_read_b32 v234, a106
v_accvgpr_read_b32 v235, a107
v_mul_f32 v232, v232, v242
v_mul_f32 v233, v233, v248
v_mul_f32 v234, v234, v250
v_mul_f32 v235, v235, v251
v_accvgpr_write_b32 a104, v232
v_accvgpr_write_b32 a105, v233
v_accvgpr_write_b32 a106, v234
v_accvgpr_write_b32 a107, v235
v_accvgpr_read_b32 v232, a120
v_accvgpr_read_b32 v233, a121
v_accvgpr_read_b32 v234, a122
v_accvgpr_read_b32 v235, a123
v_mul_f32 v232, v232, v242
v_mul_f32 v233, v233, v248
v_mul_f32 v234, v234, v250
v_mul_f32 v235, v235, v251
v_accvgpr_write_b32 a120, v232
v_accvgpr_write_b32 a121, v233
v_accvgpr_write_b32 a122, v234
v_accvgpr_write_b32 a123, v235
v_accvgpr_read_b32 v232, a136
v_accvgpr_read_b32 v233, a137
v_accvgpr_read_b32 v234, a138
v_accvgpr_read_b32 v235, a139
v_mul_f32 v232, v232, v242
v_mul_f32 v233, v233, v248
v_mul_f32 v234, v234, v250
v_mul_f32 v235, v235, v251
v_accvgpr_write_b32 a136, v232
v_accvgpr_write_b32 a137, v233
v_accvgpr_write_b32 a138, v234
v_accvgpr_write_b32 a139, v235
v_accvgpr_read_b32 v232, a152
v_accvgpr_read_b32 v233, a153
v_accvgpr_read_b32 v234, a154
v_accvgpr_read_b32 v235, a155
v_mul_f32 v232, v232, v242
v_mul_f32 v233, v233, v248
v_mul_f32 v234, v234, v250
v_mul_f32 v235, v235, v251
v_accvgpr_write_b32 a152, v232
v_accvgpr_write_b32 a153, v233
v_accvgpr_write_b32 a154, v234
v_accvgpr_write_b32 a155, v235
v_accvgpr_read_b32 v232, a168
v_accvgpr_read_b32 v233, a169
v_accvgpr_read_b32 v234, a170
v_accvgpr_read_b32 v235, a171
v_mul_f32 v232, v232, v242
v_mul_f32 v233, v233, v248
v_mul_f32 v234, v234, v250
v_mul_f32 v235, v235, v251
v_accvgpr_write_b32 a168, v232
v_accvgpr_write_b32 a169, v233
v_accvgpr_write_b32 a170, v234
v_accvgpr_write_b32 a171, v235
v_accvgpr_read_b32 v232, a184
v_accvgpr_read_b32 v233, a185
v_accvgpr_read_b32 v234, a186
v_accvgpr_read_b32 v235, a187
v_mul_f32 v232, v232, v242
v_mul_f32 v233, v233, v248
v_mul_f32 v234, v234, v250
v_mul_f32 v235, v235, v251
v_accvgpr_write_b32 a184, v232
v_accvgpr_write_b32 a185, v233
v_accvgpr_write_b32 a186, v234
v_accvgpr_write_b32 a187, v235
v_accvgpr_read_b32 v232, a200
v_accvgpr_read_b32 v233, a201
v_accvgpr_read_b32 v234, a202
v_accvgpr_read_b32 v235, a203
v_mul_f32 v232, v232, v242
v_mul_f32 v233, v233, v248
v_mul_f32 v234, v234, v250
v_mul_f32 v235, v235, v251
v_accvgpr_write_b32 a200, v232
v_accvgpr_write_b32 a201, v233
v_accvgpr_write_b32 a202, v234
v_accvgpr_write_b32 a203, v235
v_accvgpr_read_b32 v232, a216
v_accvgpr_read_b32 v233, a217
v_accvgpr_read_b32 v234, a218
v_accvgpr_read_b32 v235, a219
v_mul_f32 v232, v232, v242
v_mul_f32 v233, v233, v248
v_mul_f32 v234, v234, v250
v_mul_f32 v235, v235, v251
v_accvgpr_write_b32 a216, v232
v_accvgpr_write_b32 a217, v233
v_accvgpr_write_b32 a218, v234
v_accvgpr_write_b32 a219, v235
v_accvgpr_read_b32 v232, a232
v_accvgpr_read_b32 v233, a233
v_accvgpr_read_b32 v234, a234
v_accvgpr_read_b32 v235, a235
v_mul_f32 v232, v232, v242
v_mul_f32 v233, v233, v248
v_mul_f32 v234, v234, v250
v_mul_f32 v235, v235, v251
v_accvgpr_write_b32 a232, v232
v_accvgpr_write_b32 a233, v233
v_accvgpr_write_b32 a234, v234
v_accvgpr_write_b32 a235, v235
v_accvgpr_read_b32 v232, a248
v_accvgpr_read_b32 v233, a249
v_accvgpr_read_b32 v234, a250
v_accvgpr_read_b32 v235, a251
v_mul_f32 v232, v232, v242
v_mul_f32 v233, v233, v248
v_mul_f32 v234, v234, v250
v_mul_f32 v235, v235, v251
v_accvgpr_write_b32 a248, v232
v_accvgpr_write_b32 a249, v233
v_accvgpr_write_b32 a250, v234
v_accvgpr_write_b32 a251, v235
v_lshrrev_b32 v232, 4, v243
v_and_b32 v232, 0x30, v232
ds_bpermute_b32 v242, v232, v239 offset:0
ds_bpermute_b32 v248, v232, v239 offset:4
ds_bpermute_b32 v250, v232, v239 offset:8
ds_bpermute_b32 v251, v232, v239 offset:12
s_waitcnt lgkmcnt(0)
v_accvgpr_read_b32 v232, a12
v_accvgpr_read_b32 v233, a13
v_accvgpr_read_b32 v234, a14
v_accvgpr_read_b32 v235, a15
v_mul_f32 v232, v232, v242
v_mul_f32 v233, v233, v248
v_mul_f32 v234, v234, v250
v_mul_f32 v235, v235, v251
v_accvgpr_write_b32 a12, v232
v_accvgpr_write_b32 a13, v233
v_accvgpr_write_b32 a14, v234
v_accvgpr_write_b32 a15, v235
v_accvgpr_read_b32 v232, a28
v_accvgpr_read_b32 v233, a29
v_accvgpr_read_b32 v234, a30
v_accvgpr_read_b32 v235, a31
v_mul_f32 v232, v232, v242
v_mul_f32 v233, v233, v248
v_mul_f32 v234, v234, v250
v_mul_f32 v235, v235, v251
v_accvgpr_write_b32 a28, v232
v_accvgpr_write_b32 a29, v233
v_accvgpr_write_b32 a30, v234
v_accvgpr_write_b32 a31, v235
v_accvgpr_read_b32 v232, a44
v_accvgpr_read_b32 v233, a45
v_accvgpr_read_b32 v234, a46
v_accvgpr_read_b32 v235, a47
v_mul_f32 v232, v232, v242
v_mul_f32 v233, v233, v248
v_mul_f32 v234, v234, v250
v_mul_f32 v235, v235, v251
v_accvgpr_write_b32 a44, v232
v_accvgpr_write_b32 a45, v233
v_accvgpr_write_b32 a46, v234
v_accvgpr_write_b32 a47, v235
v_accvgpr_read_b32 v232, a60
v_accvgpr_read_b32 v233, a61
v_accvgpr_read_b32 v234, a62
v_accvgpr_read_b32 v235, a63
v_mul_f32 v232, v232, v242
v_mul_f32 v233, v233, v248
v_mul_f32 v234, v234, v250
v_mul_f32 v235, v235, v251
v_accvgpr_write_b32 a60, v232
v_accvgpr_write_b32 a61, v233
v_accvgpr_write_b32 a62, v234
v_accvgpr_write_b32 a63, v235
v_accvgpr_read_b32 v232, a76
v_accvgpr_read_b32 v233, a77
v_accvgpr_read_b32 v234, a78
v_accvgpr_read_b32 v235, a79
v_mul_f32 v232, v232, v242
v_mul_f32 v233, v233, v248
v_mul_f32 v234, v234, v250
v_mul_f32 v235, v235, v251
v_accvgpr_write_b32 a76, v232
v_accvgpr_write_b32 a77, v233
v_accvgpr_write_b32 a78, v234
v_accvgpr_write_b32 a79, v235
v_accvgpr_read_b32 v232, a92
v_accvgpr_read_b32 v233, a93
v_accvgpr_read_b32 v234, a94
v_accvgpr_read_b32 v235, a95
v_mul_f32 v232, v232, v242
v_mul_f32 v233, v233, v248
v_mul_f32 v234, v234, v250
v_mul_f32 v235, v235, v251
v_accvgpr_write_b32 a92, v232
v_accvgpr_write_b32 a93, v233
v_accvgpr_write_b32 a94, v234
v_accvgpr_write_b32 a95, v235
v_accvgpr_read_b32 v232, a108
v_accvgpr_read_b32 v233, a109
v_accvgpr_read_b32 v234, a110
v_accvgpr_read_b32 v235, a111
v_mul_f32 v232, v232, v242
v_mul_f32 v233, v233, v248
v_mul_f32 v234, v234, v250
v_mul_f32 v235, v235, v251
v_accvgpr_write_b32 a108, v232
v_accvgpr_write_b32 a109, v233
v_accvgpr_write_b32 a110, v234
v_accvgpr_write_b32 a111, v235
v_accvgpr_read_b32 v232, a124
v_accvgpr_read_b32 v233, a125
v_accvgpr_read_b32 v234, a126
v_accvgpr_read_b32 v235, a127
v_mul_f32 v232, v232, v242
v_mul_f32 v233, v233, v248
v_mul_f32 v234, v234, v250
v_mul_f32 v235, v235, v251
v_accvgpr_write_b32 a124, v232
v_accvgpr_write_b32 a125, v233
v_accvgpr_write_b32 a126, v234
v_accvgpr_write_b32 a127, v235
v_accvgpr_read_b32 v232, a140
v_accvgpr_read_b32 v233, a141
v_accvgpr_read_b32 v234, a142
v_accvgpr_read_b32 v235, a143
v_mul_f32 v232, v232, v242
v_mul_f32 v233, v233, v248
v_mul_f32 v234, v234, v250
v_mul_f32 v235, v235, v251
v_accvgpr_write_b32 a140, v232
v_accvgpr_write_b32 a141, v233
v_accvgpr_write_b32 a142, v234
v_accvgpr_write_b32 a143, v235
v_accvgpr_read_b32 v232, a156
v_accvgpr_read_b32 v233, a157
v_accvgpr_read_b32 v234, a158
v_accvgpr_read_b32 v235, a159
v_mul_f32 v232, v232, v242
v_mul_f32 v233, v233, v248
v_mul_f32 v234, v234, v250
v_mul_f32 v235, v235, v251
v_accvgpr_write_b32 a156, v232
v_accvgpr_write_b32 a157, v233
v_accvgpr_write_b32 a158, v234
v_accvgpr_write_b32 a159, v235
v_accvgpr_read_b32 v232, a172
v_accvgpr_read_b32 v233, a173
v_accvgpr_read_b32 v234, a174
v_accvgpr_read_b32 v235, a175
v_mul_f32 v232, v232, v242
v_mul_f32 v233, v233, v248
v_mul_f32 v234, v234, v250
v_mul_f32 v235, v235, v251
v_accvgpr_write_b32 a172, v232
v_accvgpr_write_b32 a173, v233
v_accvgpr_write_b32 a174, v234
v_accvgpr_write_b32 a175, v235
v_accvgpr_read_b32 v232, a188
v_accvgpr_read_b32 v233, a189
v_accvgpr_read_b32 v234, a190
v_accvgpr_read_b32 v235, a191
v_mul_f32 v232, v232, v242
v_mul_f32 v233, v233, v248
v_mul_f32 v234, v234, v250
v_mul_f32 v235, v235, v251
v_accvgpr_write_b32 a188, v232
v_accvgpr_write_b32 a189, v233
v_accvgpr_write_b32 a190, v234
v_accvgpr_write_b32 a191, v235
v_accvgpr_read_b32 v232, a204
v_accvgpr_read_b32 v233, a205
v_accvgpr_read_b32 v234, a206
v_accvgpr_read_b32 v235, a207
v_mul_f32 v232, v232, v242
v_mul_f32 v233, v233, v248
v_mul_f32 v234, v234, v250
v_mul_f32 v235, v235, v251
v_accvgpr_write_b32 a204, v232
v_accvgpr_write_b32 a205, v233
v_accvgpr_write_b32 a206, v234
v_accvgpr_write_b32 a207, v235
v_accvgpr_read_b32 v232, a220
v_accvgpr_read_b32 v233, a221
v_accvgpr_read_b32 v234, a222
v_accvgpr_read_b32 v235, a223
v_mul_f32 v232, v232, v242
v_mul_f32 v233, v233, v248
v_mul_f32 v234, v234, v250
v_mul_f32 v235, v235, v251
v_accvgpr_write_b32 a220, v232
v_accvgpr_write_b32 a221, v233
v_accvgpr_write_b32 a222, v234
v_accvgpr_write_b32 a223, v235
v_accvgpr_read_b32 v232, a236
v_accvgpr_read_b32 v233, a237
v_accvgpr_read_b32 v234, a238
v_accvgpr_read_b32 v235, a239
v_mul_f32 v232, v232, v242
v_mul_f32 v233, v233, v248
v_mul_f32 v234, v234, v250
v_mul_f32 v235, v235, v251
v_accvgpr_write_b32 a236, v232
v_accvgpr_write_b32 a237, v233
v_accvgpr_write_b32 a238, v234
v_accvgpr_write_b32 a239, v235
v_accvgpr_read_b32 v232, a252
v_accvgpr_read_b32 v233, a253
v_accvgpr_read_b32 v234, a254
v_accvgpr_read_b32 v235, a255
v_mul_f32 v232, v232, v242
v_mul_f32 v233, v233, v248
v_mul_f32 v234, v234, v250
v_mul_f32 v235, v235, v251
v_accvgpr_write_b32 a252, v232
v_accvgpr_write_b32 a253, v233
v_accvgpr_write_b32 a254, v234
v_accvgpr_write_b32 a255, v235
s_nop 3
s_cmp_eq_u32 s36, 0
s_cbranch_scc1 L2_rr0
s_cmp_eq_u32 s36, 1
s_cbranch_scc1 L2_rr1
s_cmp_eq_u32 s36, 2
s_cbranch_scc1 L2_rr2
s_cmp_eq_u32 s36, 3
s_cbranch_scc1 L2_rr3
s_cmp_eq_u32 s36, 4
s_cbranch_scc1 L2_rr4
s_cmp_eq_u32 s36, 5
s_cbranch_scc1 L2_rr5
s_cmp_eq_u32 s36, 6
s_cbranch_scc1 L2_rr6
s_cmp_eq_u32 s36, 7
s_cbranch_scc1 L2_rr7
s_cmp_eq_u32 s36, 8
s_cbranch_scc1 L2_rr8
s_cmp_eq_u32 s36, 9
s_cbranch_scc1 L2_rr9
s_cmp_eq_u32 s36, 10
s_cbranch_scc1 L2_rr10
s_cmp_eq_u32 s36, 11
s_cbranch_scc1 L2_rr11
s_cmp_eq_u32 s36, 12
s_cbranch_scc1 L2_rr12
s_cmp_eq_u32 s36, 13
s_cbranch_scc1 L2_rr13
s_cmp_eq_u32 s36, 14
s_cbranch_scc1 L2_rr14
s_cmp_eq_u32 s36, 15
s_cbranch_scc1 L2_rr15
s_cmp_eq_u32 s36, 16
s_cbranch_scc1 L2_rr16
L2_rr17:
s_waitcnt lgkmcnt(0)
s_branch L2_ret17
L2_rr16:
s_waitcnt lgkmcnt(0)
s_branch L2_ret16
L2_rr15:
s_waitcnt lgkmcnt(0)
s_branch L2_ret15
L2_rr14:
s_waitcnt lgkmcnt(0)
s_branch L2_ret14
L2_rr13:
s_waitcnt lgkmcnt(0)
s_branch L2_ret13
L2_rr12:
s_waitcnt lgkmcnt(0)
s_branch L2_ret12
L2_rr11:
s_waitcnt lgkmcnt(0)
s_branch L2_ret11
L2_rr10:
s_waitcnt lgkmcnt(0)
s_branch L2_ret10
L2_rr9:
s_waitcnt lgkmcnt(0)
s_branch L2_ret9
L2_rr8:
s_waitcnt lgkmcnt(0)
s_branch L2_ret8
L2_rr7:
s_waitcnt lgkmcnt(0)
s_branch L2_ret7
L2_rr6:
s_waitcnt lgkmcnt(0)
s_branch L2_ret6
L2_rr5:
s_waitcnt lgkmcnt(0)
s_branch L2_ret5
L2_rr4:
s_waitcnt lgkmcnt(0)
s_branch L2_ret4
L2_rr3:
s_waitcnt lgkmcnt(0)
s_branch L2_ret3
L2_rr2:
s_waitcnt lgkmcnt(0)
s_branch L2_ret2
L2_rr1:
s_waitcnt lgkmcnt(0)
s_branch L2_ret1
L2_rr0:
s_waitcnt lgkmcnt(0)
s_branch L2_ret0
LT_disp:
s_cmp_ge_i32 s36, 0
s_cbranch_scc1 LT_start
s_cmp_eq_u32 s34, 0
s_cbranch_scc1 L2_end
s_mov_b32 s41, s34
s_mul_i32 s40, s34, 6
s_add_u32 s40, s40, s37
s_add_u32 s40, s40, 42
s_cmp_lt_u32 s40, 64
s_cbranch_scc1 LE_common
s_branch L2_end
LT_start:
s_waitcnt lgkmcnt(0)
s_add_u32 s12, s4, 0x7c2a000
s_addc_u32 s13, s5, 0
s_mov_b32 s14, 0x8000
s_mov_b32 s15, 0x00020000
v_and_b32 v8, 63, v0
v_lshlrev_b32 v8, 7, v8
s_mov_b32 s91, 8192
s_mov_b32 s90, 16384
s_mov_b32 s95, 24576
v_min_u32 v9, 5248, v8
s_mov_b32 s94, 0x10000
LT_poll:
buffer_load_dwordx2 v[0:1], v8, s[12:15], 0 offen sc1
buffer_load_dwordx2 v[2:3], v8, s[12:15], s91 offen sc1
buffer_load_dwordx2 v[4:5], v8, s[12:15], s90 offen sc1
buffer_load_dwordx2 v[6:7], v9, s[12:15], s95 offen sc1
s_sub_u32 s94, s94, 1
s_waitcnt vmcnt(0)
s_cbranch_scc1 LT_poll_go
v_cmp_ne_u64 vcc, s[98:99], v[0:1]
s_nop 1
s_cbranch_vccnz LT_poll
v_cmp_ne_u64 vcc, s[98:99], v[2:3]
s_nop 1
s_cbranch_vccnz LT_poll
v_cmp_ne_u64 vcc, s[98:99], v[4:5]
s_nop 1
s_cbranch_vccnz LT_poll
v_cmp_ne_u64 vcc, s[98:99], v[6:7]
s_nop 1
s_cbranch_vccnz LT_poll
LT_poll_go:
s_add_u32 s31, s31, -22
s_add_u32 s3, s28, 409600
s_cmp_eq_u32 s36, 0
s_cselect_b32 s31, 26, s31
s_cselect_b32 s39, s39, s3
s_cselect_b32 s33, s33, 0
s_cselect_b32 s3, 0, 425984
s_add_u32 s28, s28, s3
s_add_u32 s12, s4, 0x6800000
s_addc_u32 s13, s5, 0
s_mov_b32 s14, 0x0
s_mov_b32 s15, 0x00020000
s_mov_b32 s14, s49
s_add_u32 s8, s4, 0x0
s_addc_u32 s9, s5, 0
s_mov_b32 s10, 0x4e4000
s_mov_b32 s11, 0x00020000
s_mov_b32 s40, 5111808
s_mov_b32 s44, 5115904
buffer_load_dwordx4 v[0:3], v243, s[8:11], s40 offen offset:0 sc1
buffer_load_dwordx4 v[4:7], v243, s[8:11], s40 offen offset:1024 sc1
buffer_load_dwordx4 v[8:11], v243, s[8:11], s40 offen offset:2048 sc1
buffer_load_dwordx4 v[12:15], v243, s[8:11], s40 offen offset:3072 sc1
buffer_load_dwordx4 v[16:19], v243, s[8:11], s44 offen offset:0 sc1
buffer_load_dwordx4 v[20:23], v243, s[8:11], s44 offen offset:1024 sc1
buffer_load_dwordx4 v[24:27], v243, s[8:11], s44 offen offset:2048 sc1
buffer_load_dwordx4 v[28:31], v243, s[8:11], s44 offen offset:3072 sc1
s_mov_b32 s53, 0
s_add_u32 m0, s53, 90112
s_add_u32 s54, s39, 0
buffer_load_dwordx4 v241, s[12:15], s54 offen offset:0 sc1 lds
buffer_load_dwordx4 v241, s[12:15], s54 offen offset:1024 sc1 lds
buffer_load_dwordx4 v241, s[12:15], s54 offen offset:2048 sc1 lds
buffer_load_dwordx4 v241, s[12:15], s54 offen offset:3072 sc1 lds
s_add_u32 m0, s53, 94208
s_add_u32 s54, s39, 128
buffer_load_dwordx4 v241, s[12:15], s54 offen offset:0 sc1 lds
buffer_load_dwordx4 v241, s[12:15], s54 offen offset:1024 sc1 lds
buffer_load_dwordx4 v241, s[12:15], s54 offen offset:2048 sc1 lds
buffer_load_dwordx4 v241, s[12:15], s54 offen offset:3072 sc1 lds
s_add_u32 m0, s53, 98304
s_add_u32 s54, s39, 256
buffer_load_dwordx4 v241, s[12:15], s54 offen offset:0 sc1 lds
buffer_load_dwordx4 v241, s[12:15], s54 offen offset:1024 sc1 lds
buffer_load_dwordx4 v241, s[12:15], s54 offen offset:2048 sc1 lds
buffer_load_dwordx4 v241, s[12:15], s54 offen offset:3072 sc1 lds
s_add_u32 m0, s53, 102400
s_add_u32 s54, s39, 384
buffer_load_dwordx4 v241, s[12:15], s54 offen offset:0 sc1 lds
buffer_load_dwordx4 v241, s[12:15], s54 offen offset:1024 sc1 lds
buffer_load_dwordx4 v241, s[12:15], s54 offen offset:2048 sc1 lds
buffer_load_dwordx4 v241, s[12:15], s54 offen offset:3072 sc1 lds
s_add_u32 s53, s53, 0x4000
s_and_b32 s53, s53, 0xffff
s_add_u32 m0, s53, 90112
s_add_u32 s54, s28, 0
buffer_load_dwordx4 v241, s[12:15], s54 offen offset:0 sc1 lds
buffer_load_dwordx4 v241, s[12:15], s54 offen offset:1024 sc1 lds
buffer_load_dwordx4 v241, s[12:15], s54 offen offset:2048 sc1 lds
buffer_load_dwordx4 v241, s[12:15], s54 offen offset:3072 sc1 lds
s_add_u32 m0, s53, 94208
s_add_u32 s54, s28, 128
buffer_load_dwordx4 v241, s[12:15], s54 offen offset:0 sc1 lds
buffer_load_dwordx4 v241, s[12:15], s54 offen offset:1024 sc1 lds
buffer_load_dwordx4 v241, s[12:15], s54 offen offset:2048 sc1 lds
buffer_load_dwordx4 v241, s[12:15], s54 offen offset:3072 sc1 lds
s_add_u32 m0, s53, 98304
s_add_u32 s54, s28, 256
buffer_load_dwordx4 v241, s[12:15], s54 offen offset:0 sc1 lds
buffer_load_dwordx4 v241, s[12:15], s54 offen offset:1024 sc1 lds
buffer_load_dwordx4 v241, s[12:15], s54 offen offset:2048 sc1 lds
buffer_load_dwordx4 v241, s[12:15], s54 offen offset:3072 sc1 lds
s_add_u32 m0, s53, 102400
s_add_u32 s54, s28, 384
buffer_load_dwordx4 v241, s[12:15], s54 offen offset:0 sc1 lds
buffer_load_dwordx4 v241, s[12:15], s54 offen offset:1024 sc1 lds
buffer_load_dwordx4 v241, s[12:15], s54 offen offset:2048 sc1 lds
buffer_load_dwordx4 v241, s[12:15], s54 offen offset:3072 sc1 lds
s_add_u32 s53, s53, 0x4000
s_and_b32 s53, s53, 0xffff
s_add_u32 s28, s28, 0x4000
s_add_u32 m0, s53, 90112
s_add_u32 s54, s28, 0
buffer_load_dwordx4 v241, s[12:15], s54 offen offset:0 sc1 lds
buffer_load_dwordx4 v241, s[12:15], s54 offen offset:1024 sc1 lds
buffer_load_dwordx4 v241, s[12:15], s54 offen offset:2048 sc1 lds
buffer_load_dwordx4 v241, s[12:15], s54 offen offset:3072 sc1 lds
s_add_u32 m0, s53, 94208
s_add_u32 s54, s28, 128
buffer_load_dwordx4 v241, s[12:15], s54 offen offset:0 sc1 lds
buffer_load_dwordx4 v241, s[12:15], s54 offen offset:1024 sc1 lds
buffer_load_dwordx4 v241, s[12:15], s54 offen offset:2048 sc1 lds
buffer_load_dwordx4 v241, s[12:15], s54 offen offset:3072 sc1 lds
s_add_u32 m0, s53, 98304
s_add_u32 s54, s28, 256
buffer_load_dwordx4 v241, s[12:15], s54 offen offset:0 sc1 lds
buffer_load_dwordx4 v241, s[12:15], s54 offen offset:1024 sc1 lds
buffer_load_dwordx4 v241, s[12:15], s54 offen offset:2048 sc1 lds
buffer_load_dwordx4 v241, s[12:15], s54 offen offset:3072 sc1 lds
s_add_u32 m0, s53, 102400
s_add_u32 s54, s28, 384
buffer_load_dwordx4 v241, s[12:15], s54 offen offset:0 sc1 lds
buffer_load_dwordx4 v241, s[12:15], s54 offen offset:1024 sc1 lds
buffer_load_dwordx4 v241, s[12:15], s54 offen offset:2048 sc1 lds
buffer_load_dwordx4 v241, s[12:15], s54 offen offset:3072 sc1 lds
s_add_u32 s53, s53, 0x4000
s_and_b32 s53, s53, 0xffff
s_add_u32 s28, s28, 0x4000
s_mul_i32 s35, s37, 0x600000
s_add_u32 s20, s4, 0x2000000
s_addc_u32 s21, s5, 0
s_add_u32 s20, s20, s35
s_addc_u32 s21, s21, 0
s_mov_b32 s22, 0x4e4000
s_mov_b32 s23, 0x00020000
s_add_u32 s24, s4, 0x6000000
s_addc_u32 s25, s5, 0
s_mov_b32 s26, 0x139000
s_mov_b32 s27, 0x00020000
s_lshl_b32 s48, s37, 3
s_add_u32 s48, s48, 638976
s_mov_b32 s48, 1277952
v_bfe_u32 v240, v243, 4, 3
v_lshlrev_b32 v240, 6, v240
v_bfe_u32 v242, v243, 7, 1
v_lshl_or_b32 v240, v242, 10, v240
v_bfe_u32 v242, v243, 8, 2
v_lshl_or_b32 v240, v242, 4, v240
v_bfe_u32 v242, v243, 6, 1
v_lshlrev_b32 v242, 5, v242
v_xor_b32 v240, v240, v242
v_and_b32 v246, 0x1c0, v243
v_bfe_u32 v242, v243, 9, 1
v_lshl_or_b32 v246, v242, 10, v246
v_bfe_u32 v242, v243, 8, 1
v_lshl_or_b32 v246, v242, 5, v246
v_bfe_u32 v242, v243, 4, 2
v_lshl_or_b32 v246, v242, 3, v246
v_xor_b32 v247, 32, v246
v_bfe_i32 v242, v243, 8, 1
v_and_b32 v192, s33, v242
v_and_b32 v193, s33, v242
v_and_b32 v194, s33, v242
v_and_b32 v195, s33, v242
s_add_u32 s51, s31, 0
s_mov_b32 s52, 90112
v_mov_b32 v172, 0xff800000
v_mov_b32 v173, 0
v_accvgpr_write_b32 a0, 0
v_accvgpr_write_b32 a1, 0
v_accvgpr_write_b32 a2, 0
v_accvgpr_write_b32 a3, 0
v_accvgpr_write_b32 a4, 0
v_accvgpr_write_b32 a5, 0
v_accvgpr_write_b32 a6, 0
v_accvgpr_write_b32 a7, 0
v_accvgpr_write_b32 a8, 0
v_accvgpr_write_b32 a9, 0
v_accvgpr_write_b32 a10, 0
v_accvgpr_write_b32 a11, 0
v_accvgpr_write_b32 a12, 0
v_accvgpr_write_b32 a13, 0
v_accvgpr_write_b32 a14, 0
v_accvgpr_write_b32 a15, 0
v_accvgpr_write_b32 a16, 0
v_accvgpr_write_b32 a17, 0
v_accvgpr_write_b32 a18, 0
v_accvgpr_write_b32 a19, 0
v_accvgpr_write_b32 a20, 0
v_accvgpr_write_b32 a21, 0
v_accvgpr_write_b32 a22, 0
v_accvgpr_write_b32 a23, 0
v_accvgpr_write_b32 a24, 0
v_accvgpr_write_b32 a25, 0
v_accvgpr_write_b32 a26, 0
v_accvgpr_write_b32 a27, 0
v_accvgpr_write_b32 a28, 0
v_accvgpr_write_b32 a29, 0
v_accvgpr_write_b32 a30, 0
v_accvgpr_write_b32 a31, 0
v_accvgpr_write_b32 a32, 0
v_accvgpr_write_b32 a33, 0
v_accvgpr_write_b32 a34, 0
v_accvgpr_write_b32 a35, 0
v_accvgpr_write_b32 a36, 0
v_accvgpr_write_b32 a37, 0
v_accvgpr_write_b32 a38, 0
v_accvgpr_write_b32 a39, 0
v_accvgpr_write_b32 a40, 0
v_accvgpr_write_b32 a41, 0
v_accvgpr_write_b32 a42, 0
v_accvgpr_write_b32 a43, 0
v_accvgpr_write_b32 a44, 0
v_accvgpr_write_b32 a45, 0
v_accvgpr_write_b32 a46, 0
v_accvgpr_write_b32 a47, 0
v_accvgpr_write_b32 a48, 0
v_accvgpr_write_b32 a49, 0
v_accvgpr_write_b32 a50, 0
v_accvgpr_write_b32 a51, 0
v_accvgpr_write_b32 a52, 0
v_accvgpr_write_b32 a53, 0
v_accvgpr_write_b32 a54, 0
v_accvgpr_write_b32 a55, 0
v_accvgpr_write_b32 a56, 0
v_accvgpr_write_b32 a57, 0
v_accvgpr_write_b32 a58, 0
v_accvgpr_write_b32 a59, 0
v_accvgpr_write_b32 a60, 0
v_accvgpr_write_b32 a61, 0
v_accvgpr_write_b32 a62, 0
v_accvgpr_write_b32 a63, 0
LT_loop:
s_add_u32 m0, s53, 90112
s_add_u32 s54, s28, 0
buffer_load_dwordx4 v241, s[12:15], s54 offen offset:0 sc1 lds
buffer_load_dwordx4 v241, s[12:15], s54 offen offset:1024 sc1 lds
buffer_load_dwordx4 v241, s[12:15], s54 offen offset:2048 sc1 lds
buffer_load_dwordx4 v241, s[12:15], s54 offen offset:3072 sc1 lds
s_add_u32 m0, s53, 94208
s_add_u32 s54, s28, 128
buffer_load_dwordx4 v241, s[12:15], s54 offen offset:0 sc1 lds
buffer_load_dwordx4 v241, s[12:15], s54 offen offset:1024 sc1 lds
buffer_load_dwordx4 v241, s[12:15], s54 offen offset:2048 sc1 lds
buffer_load_dwordx4 v241, s[12:15], s54 offen offset:3072 sc1 lds
s_add_u32 m0, s53, 98304
s_add_u32 s54, s28, 256
buffer_load_dwordx4 v241, s[12:15], s54 offen offset:0 sc1 lds
buffer_load_dwordx4 v241, s[12:15], s54 offen offset:1024 sc1 lds
buffer_load_dwordx4 v241, s[12:15], s54 offen offset:2048 sc1 lds
buffer_load_dwordx4 v241, s[12:15], s54 offen offset:3072 sc1 lds
s_add_u32 m0, s53, 102400
s_add_u32 s54, s28, 384
buffer_load_dwordx4 v241, s[12:15], s54 offen offset:0 sc1 lds
buffer_load_dwordx4 v241, s[12:15], s54 offen offset:1024 sc1 lds
buffer_load_dwordx4 v241, s[12:15], s54 offen offset:2048 sc1 lds
buffer_load_dwordx4 v241, s[12:15], s54 offen offset:3072 sc1 lds
s_add_u32 s53, s53, 0x4000
s_and_b32 s53, s53, 0xffff
s_add_u32 s28, s28, 0x4000
v_add_u32 v177, s52, v240
v_add_u32 v178, s52, v246
v_add_u32 v179, s52, v247
s_add_u32 s52, s52, 0x4000
s_cmp_eq_u32 s52, 155648
s_cselect_b32 s52, 90112, s52
s_waitcnt vmcnt(48)
ds_read_b128 v[32:35], v177 offset:0
ds_read_b128 v[64:67], v177 offset:2048
ds_read_b128 v[36:39], v177 offset:512
ds_read_b128 v[68:71], v177 offset:2560
ds_read_b128 v[40:43], v177 offset:4096
ds_read_b128 v[72:75], v177 offset:6144
ds_read_b128 v[44:47], v177 offset:4608
ds_read_b128 v[76:79], v177 offset:6656
ds_read_b128 v[48:51], v177 offset:8192
ds_read_b128 v[80:83], v177 offset:10240
ds_read_b128 v[52:55], v177 offset:8704
ds_read_b128 v[84:87], v177 offset:10752
ds_read_b128 v[56:59], v177 offset:12288
ds_read_b128 v[88:91], v177 offset:14336
ds_read_b128 v[60:63], v177 offset:12800
ds_read_b128 v[92:95], v177 offset:14848
s_waitcnt lgkmcnt(14)
v_mfma_f32_16x16x32_bf16 v[160:163], v[32:35], v[0:3], v[192:195]
v_mfma_f32_16x16x32_bf16 v[164:167], v[64:67], v[0:3], v[192:195]
s_waitcnt lgkmcnt(12)
v_mfma_f32_16x16x32_bf16 v[160:163], v[36:39], v[4:7], v[160:163]
v_mfma_f32_16x16x32_bf16 v[164:167], v[68:71], v[4:7], v[164:167]
s_waitcnt lgkmcnt(10)
v_mfma_f32_16x16x32_bf16 v[160:163], v[40:43], v[8:11], v[160:163]
v_mfma_f32_16x16x32_bf16 v[164:167], v[72:75], v[8:11], v[164:167]
s_waitcnt lgkmcnt(8)
v_mfma_f32_16x16x32_bf16 v[160:163], v[44:47], v[12:15], v[160:163]
v_mfma_f32_16x16x32_bf16 v[164:167], v[76:79], v[12:15], v[164:167]
s_waitcnt lgkmcnt(6)
v_mfma_f32_16x16x32_bf16 v[160:163], v[48:51], v[16:19], v[160:163]
v_mfma_f32_16x16x32_bf16 v[164:167], v[80:83], v[16:19], v[164:167]
s_waitcnt lgkmcnt(4)
v_mfma_f32_16x16x32_bf16 v[160:163], v[52:55], v[20:23], v[160:163]
v_mfma_f32_16x16x32_bf16 v[164:167], v[84:87], v[20:23], v[164:167]
s_waitcnt lgkmcnt(2)
v_mfma_f32_16x16x32_bf16 v[160:163], v[56:59], v[24:27], v[160:163]
v_mfma_f32_16x16x32_bf16 v[164:167], v[88:91], v[24:27], v[164:167]
s_waitcnt lgkmcnt(0)
v_mfma_f32_16x16x32_bf16 v[160:163], v[60:63], v[28:31], v[160:163]
v_mfma_f32_16x16x32_bf16 v[164:167], v[92:95], v[28:31], v[164:167]
ds_read_b64_tr_b16 v[96:97], v178 offset:0
ds_read_b64_tr_b16 v[98:99], v178 offset:2048
ds_read_b64_tr_b16 v[100:101], v179 offset:0
ds_read_b64_tr_b16 v[102:103], v179 offset:2048
ds_read_b64_tr_b16 v[104:105], v178 offset:512
ds_read_b64_tr_b16 v[106:107], v178 offset:2560
ds_read_b64_tr_b16 v[108:109], v179 offset:512
ds_read_b64_tr_b16 v[110:111], v179 offset:2560
ds_read_b64_tr_b16 v[112:113], v178 offset:4096
ds_read_b64_tr_b16 v[114:115], v178 offset:6144
ds_read_b64_tr_b16 v[116:117], v179 offset:4096
ds_read_b64_tr_b16 v[118:119], v179 offset:6144
ds_read_b64_tr_b16 v[120:121], v178 offset:4608
ds_read_b64_tr_b16 v[122:123], v178 offset:6656
ds_read_b64_tr_b16 v[124:125], v179 offset:4608
ds_read_b64_tr_b16 v[126:127], v179 offset:6656
ds_read_b64_tr_b16 v[128:129], v178 offset:8192
ds_read_b64_tr_b16 v[130:131], v178 offset:10240
ds_read_b64_tr_b16 v[132:133], v179 offset:8192
ds_read_b64_tr_b16 v[134:135], v179 offset:10240
ds_read_b64_tr_b16 v[136:137], v178 offset:8704
ds_read_b64_tr_b16 v[138:139], v178 offset:10752
ds_read_b64_tr_b16 v[140:141], v179 offset:8704
ds_read_b64_tr_b16 v[142:143], v179 offset:10752
ds_read_b64_tr_b16 v[144:145], v178 offset:12288
ds_read_b64_tr_b16 v[146:147], v178 offset:14336
ds_read_b64_tr_b16 v[148:149], v179 offset:12288
ds_read_b64_tr_b16 v[150:151], v179 offset:14336
ds_read_b64_tr_b16 v[152:153], v178 offset:12800
ds_read_b64_tr_b16 v[154:155], v178 offset:14848
ds_read_b64_tr_b16 v[156:157], v179 offset:12800
ds_read_b64_tr_b16 v[158:159], v179 offset:14848
v_mov_b32 v192, 0
v_mov_b32 v193, 0
v_mov_b32 v194, 0
v_mov_b32 v195, 0
s_nop 7
v_max3_f32 v175, v160, v161, v162
v_max3_f32 v175, v175, v163, v164
v_max3_f32 v175, v175, v165, v166
v_max3_f32 v175, v175, v167, v172
v_mov_b32 v176, v175
s_nop 1
v_permlane32_swap_b32 v175, v176
s_nop 1
v_max_f32 v175, v175, v176
v_mov_b32 v176, v175
s_nop 1
v_permlane16_swap_b32 v175, v176
s_nop 1
v_max_f32 v175, v175, v176
v_ceil_f32 v175, v175
v_sub_f32 v174, v172, v175
v_exp_f32 v174, v174
v_mov_b32 v172, v175
v_sub_f32 v160, v160, v172
v_sub_f32 v161, v161, v172
v_sub_f32 v162, v162, v172
v_sub_f32 v163, v163, v172
v_sub_f32 v164, v164, v172
v_sub_f32 v165, v165, v172
v_sub_f32 v166, v166, v172
v_sub_f32 v167, v167, v172
v_exp_f32 v160, v160
v_exp_f32 v161, v161
v_exp_f32 v162, v162
v_exp_f32 v163, v163
v_exp_f32 v164, v164
v_exp_f32 v165, v165
v_exp_f32 v166, v166
v_exp_f32 v167, v167
v_mul_f32 v173, v173, v174
v_cvt_pk_bf16_f32 v168, v160, v161
v_cvt_pk_bf16_f32 v169, v162, v163
v_cvt_pk_bf16_f32 v170, v164, v165
v_cvt_pk_bf16_f32 v171, v166, v167
v_cmp_neq_f32 vcc, 1.0, v174
v_add_f32 v173, v173, v160
v_add_f32 v173, v173, v161
v_add_f32 v173, v173, v162
v_add_f32 v173, v173, v163
v_add_f32 v173, v173, v164
v_add_f32 v173, v173, v165
v_add_f32 v173, v173, v166
v_add_f32 v173, v173, v167
s_cbranch_vccz LT_nors
v_lshrrev_b32 v176, 4, v243
v_and_b32 v176, 0x30, v176
ds_bpermute_b32 v188, v176, v174 offset:0
ds_bpermute_b32 v189, v176, v174 offset:4
ds_bpermute_b32 v190, v176, v174 offset:8
ds_bpermute_b32 v191, v176, v174 offset:12
s_waitcnt lgkmcnt(0)
v_accvgpr_read_b32 v180, a0
v_accvgpr_read_b32 v181, a1
v_accvgpr_read_b32 v182, a2
v_accvgpr_read_b32 v183, a3
v_accvgpr_read_b32 v184, a4
v_accvgpr_read_b32 v185, a5
v_accvgpr_read_b32 v186, a6
v_accvgpr_read_b32 v187, a7
v_mul_f32 v180, v180, v188
v_mul_f32 v181, v181, v189
v_mul_f32 v182, v182, v190
v_mul_f32 v183, v183, v191
v_mul_f32 v184, v184, v188
v_mul_f32 v185, v185, v189
v_mul_f32 v186, v186, v190
v_mul_f32 v187, v187, v191
v_accvgpr_write_b32 a0, v180
v_accvgpr_write_b32 a1, v181
v_accvgpr_write_b32 a2, v182
v_accvgpr_write_b32 a3, v183
v_accvgpr_write_b32 a4, v184
v_accvgpr_write_b32 a5, v185
v_accvgpr_write_b32 a6, v186
v_accvgpr_write_b32 a7, v187
v_accvgpr_read_b32 v180, a8
v_accvgpr_read_b32 v181, a9
v_accvgpr_read_b32 v182, a10
v_accvgpr_read_b32 v183, a11
v_accvgpr_read_b32 v184, a12
v_accvgpr_read_b32 v185, a13
v_accvgpr_read_b32 v186, a14
v_accvgpr_read_b32 v187, a15
v_mul_f32 v180, v180, v188
v_mul_f32 v181, v181, v189
v_mul_f32 v182, v182, v190
v_mul_f32 v183, v183, v191
v_mul_f32 v184, v184, v188
v_mul_f32 v185, v185, v189
v_mul_f32 v186, v186, v190
v_mul_f32 v187, v187, v191
v_accvgpr_write_b32 a8, v180
v_accvgpr_write_b32 a9, v181
v_accvgpr_write_b32 a10, v182
v_accvgpr_write_b32 a11, v183
v_accvgpr_write_b32 a12, v184
v_accvgpr_write_b32 a13, v185
v_accvgpr_write_b32 a14, v186
v_accvgpr_write_b32 a15, v187
v_accvgpr_read_b32 v180, a16
v_accvgpr_read_b32 v181, a17
v_accvgpr_read_b32 v182, a18
v_accvgpr_read_b32 v183, a19
v_accvgpr_read_b32 v184, a20
v_accvgpr_read_b32 v185, a21
v_accvgpr_read_b32 v186, a22
v_accvgpr_read_b32 v187, a23
v_mul_f32 v180, v180, v188
v_mul_f32 v181, v181, v189
v_mul_f32 v182, v182, v190
v_mul_f32 v183, v183, v191
v_mul_f32 v184, v184, v188
v_mul_f32 v185, v185, v189
v_mul_f32 v186, v186, v190
v_mul_f32 v187, v187, v191
v_accvgpr_write_b32 a16, v180
v_accvgpr_write_b32 a17, v181
v_accvgpr_write_b32 a18, v182
v_accvgpr_write_b32 a19, v183
v_accvgpr_write_b32 a20, v184
v_accvgpr_write_b32 a21, v185
v_accvgpr_write_b32 a22, v186
v_accvgpr_write_b32 a23, v187
v_accvgpr_read_b32 v180, a24
v_accvgpr_read_b32 v181, a25
v_accvgpr_read_b32 v182, a26
v_accvgpr_read_b32 v183, a27
v_accvgpr_read_b32 v184, a28
v_accvgpr_read_b32 v185, a29
v_accvgpr_read_b32 v186, a30
v_accvgpr_read_b32 v187, a31
v_mul_f32 v180, v180, v188
v_mul_f32 v181, v181, v189
v_mul_f32 v182, v182, v190
v_mul_f32 v183, v183, v191
v_mul_f32 v184, v184, v188
v_mul_f32 v185, v185, v189
v_mul_f32 v186, v186, v190
v_mul_f32 v187, v187, v191
v_accvgpr_write_b32 a24, v180
v_accvgpr_write_b32 a25, v181
v_accvgpr_write_b32 a26, v182
v_accvgpr_write_b32 a27, v183
v_accvgpr_write_b32 a28, v184
v_accvgpr_write_b32 a29, v185
v_accvgpr_write_b32 a30, v186
v_accvgpr_write_b32 a31, v187
v_accvgpr_read_b32 v180, a32
v_accvgpr_read_b32 v181, a33
v_accvgpr_read_b32 v182, a34
v_accvgpr_read_b32 v183, a35
v_accvgpr_read_b32 v184, a36
v_accvgpr_read_b32 v185, a37
v_accvgpr_read_b32 v186, a38
v_accvgpr_read_b32 v187, a39
v_mul_f32 v180, v180, v188
v_mul_f32 v181, v181, v189
v_mul_f32 v182, v182, v190
v_mul_f32 v183, v183, v191
v_mul_f32 v184, v184, v188
v_mul_f32 v185, v185, v189
v_mul_f32 v186, v186, v190
v_mul_f32 v187, v187, v191
v_accvgpr_write_b32 a32, v180
v_accvgpr_write_b32 a33, v181
v_accvgpr_write_b32 a34, v182
v_accvgpr_write_b32 a35, v183
v_accvgpr_write_b32 a36, v184
v_accvgpr_write_b32 a37, v185
v_accvgpr_write_b32 a38, v186
v_accvgpr_write_b32 a39, v187
v_accvgpr_read_b32 v180, a40
v_accvgpr_read_b32 v181, a41
v_accvgpr_read_b32 v182, a42
v_accvgpr_read_b32 v183, a43
v_accvgpr_read_b32 v184, a44
v_accvgpr_read_b32 v185, a45
v_accvgpr_read_b32 v186, a46
v_accvgpr_read_b32 v187, a47
v_mul_f32 v180, v180, v188
v_mul_f32 v181, v181, v189
v_mul_f32 v182, v182, v190
v_mul_f32 v183, v183, v191
v_mul_f32 v184, v184, v188
v_mul_f32 v185, v185, v189
v_mul_f32 v186, v186, v190
v_mul_f32 v187, v187, v191
v_accvgpr_write_b32 a40, v180
v_accvgpr_write_b32 a41, v181
v_accvgpr_write_b32 a42, v182
v_accvgpr_write_b32 a43, v183
v_accvgpr_write_b32 a44, v184
v_accvgpr_write_b32 a45, v185
v_accvgpr_write_b32 a46, v186
v_accvgpr_write_b32 a47, v187
v_accvgpr_read_b32 v180, a48
v_accvgpr_read_b32 v181, a49
v_accvgpr_read_b32 v182, a50
v_accvgpr_read_b32 v183, a51
v_accvgpr_read_b32 v184, a52
v_accvgpr_read_b32 v185, a53
v_accvgpr_read_b32 v186, a54
v_accvgpr_read_b32 v187, a55
v_mul_f32 v180, v180, v188
v_mul_f32 v181, v181, v189
v_mul_f32 v182, v182, v190
v_mul_f32 v183, v183, v191
v_mul_f32 v184, v184, v188
v_mul_f32 v185, v185, v189
v_mul_f32 v186, v186, v190
v_mul_f32 v187, v187, v191
v_accvgpr_write_b32 a48, v180
v_accvgpr_write_b32 a49, v181
v_accvgpr_write_b32 a50, v182
v_accvgpr_write_b32 a51, v183
v_accvgpr_write_b32 a52, v184
v_accvgpr_write_b32 a53, v185
v_accvgpr_write_b32 a54, v186
v_accvgpr_write_b32 a55, v187
v_accvgpr_read_b32 v180, a56
v_accvgpr_read_b32 v181, a57
v_accvgpr_read_b32 v182, a58
v_accvgpr_read_b32 v183, a59
v_accvgpr_read_b32 v184, a60
v_accvgpr_read_b32 v185, a61
v_accvgpr_read_b32 v186, a62
v_accvgpr_read_b32 v187, a63
v_mul_f32 v180, v180, v188
v_mul_f32 v181, v181, v189
v_mul_f32 v182, v182, v190
v_mul_f32 v183, v183, v191
v_mul_f32 v184, v184, v188
v_mul_f32 v185, v185, v189
v_mul_f32 v186, v186, v190
v_mul_f32 v187, v187, v191
v_accvgpr_write_b32 a56, v180
v_accvgpr_write_b32 a57, v181
v_accvgpr_write_b32 a58, v182
v_accvgpr_write_b32 a59, v183
v_accvgpr_write_b32 a60, v184
v_accvgpr_write_b32 a61, v185
v_accvgpr_write_b32 a62, v186
v_accvgpr_write_b32 a63, v187
LT_nors:
s_waitcnt lgkmcnt(0)
s_nop 1
v_mfma_f32_16x16x32_bf16 a[0:3], v[168:171], v[96:99], a[0:3]
v_mfma_f32_16x16x32_bf16 a[4:7], v[168:171], v[100:103], a[4:7]
v_mfma_f32_16x16x32_bf16 a[8:11], v[168:171], v[104:107], a[8:11]
v_mfma_f32_16x16x32_bf16 a[12:15], v[168:171], v[108:111], a[12:15]
v_mfma_f32_16x16x32_bf16 a[16:19], v[168:171], v[112:115], a[16:19]
v_mfma_f32_16x16x32_bf16 a[20:23], v[168:171], v[116:119], a[20:23]
v_mfma_f32_16x16x32_bf16 a[24:27], v[168:171], v[120:123], a[24:27]
v_mfma_f32_16x16x32_bf16 a[28:31], v[168:171], v[124:127], a[28:31]
v_mfma_f32_16x16x32_bf16 a[32:35], v[168:171], v[128:131], a[32:35]
v_mfma_f32_16x16x32_bf16 a[36:39], v[168:171], v[132:135], a[36:39]
v_mfma_f32_16x16x32_bf16 a[40:43], v[168:171], v[136:139], a[40:43]
v_mfma_f32_16x16x32_bf16 a[44:47], v[168:171], v[140:143], a[44:47]
v_mfma_f32_16x16x32_bf16 a[48:51], v[168:171], v[144:147], a[48:51]
v_mfma_f32_16x16x32_bf16 a[52:55], v[168:171], v[148:151], a[52:55]
v_mfma_f32_16x16x32_bf16 a[56:59], v[168:171], v[152:155], a[56:59]
v_mfma_f32_16x16x32_bf16 a[60:63], v[168:171], v[156:159], a[60:63]
s_sub_u32 s51, s51, 1
s_cmp_lg_u32 s51, 0
s_cbranch_scc1 LT_loop
s_nop 15
s_add_u32 s16, s4, 0x0
s_addc_u32 s17, s5, 0
s_mov_b32 s18, 0x10000000
s_mov_b32 s19, 0x00020000
s_mul_i32 s52, s37, 0x5000
s_add_u32 s52, s52, 0x1200000
s_add_u32 s53, s37, 1610
s_lshl_b32 s53, s53, 7
s_add_u32 s53, s53, 0x7c00000
s_waitcnt vmcnt(0)
s_cmp_eq_u32 s36, 0
s_cbranch_scc1 LT_merge
buffer_store_dwordx4 a[0:3], v243, s[16:19], s52 offen offset:0 sc1
buffer_store_dwordx4 a[4:7], v243, s[16:19], s52 offen offset:1024 sc1
buffer_store_dwordx4 a[8:11], v243, s[16:19], s52 offen offset:2048 sc1
buffer_store_dwordx4 a[12:15], v243, s[16:19], s52 offen offset:3072 sc1
s_add_u32 s52, s52, 4096
buffer_store_dwordx4 a[16:19], v243, s[16:19], s52 offen offset:0 sc1
buffer_store_dwordx4 a[20:23], v243, s[16:19], s52 offen offset:1024 sc1
buffer_store_dwordx4 a[24:27], v243, s[16:19], s52 offen offset:2048 sc1
buffer_store_dwordx4 a[28:31], v243, s[16:19], s52 offen offset:3072 sc1
s_add_u32 s52, s52, 4096
buffer_store_dwordx4 a[32:35], v243, s[16:19], s52 offen offset:0 sc1
buffer_store_dwordx4 a[36:39], v243, s[16:19], s52 offen offset:1024 sc1
buffer_store_dwordx4 a[40:43], v243, s[16:19], s52 offen offset:2048 sc1
buffer_store_dwordx4 a[44:47], v243, s[16:19], s52 offen offset:3072 sc1
s_add_u32 s52, s52, 4096
buffer_store_dwordx4 a[48:51], v243, s[16:19], s52 offen offset:0 sc1
buffer_store_dwordx4 a[52:55], v243, s[16:19], s52 offen offset:1024 sc1
buffer_store_dwordx4 a[56:59], v243, s[16:19], s52 offen offset:2048 sc1
buffer_store_dwordx4 a[60:63], v243, s[16:19], s52 offen offset:3072 sc1
s_add_u32 s52, s52, 4096
buffer_store_dwordx2 v[172:173], v243, s[16:19], s52 offen sc1
s_waitcnt vmcnt(0)
v_mov_b32 v176, s98
v_mov_b32 v177, s99
s_mov_b64 exec, 1
buffer_store_dwordx2 v[176:177], off, s[16:19], s53 sc1
s_mov_b64 exec, -1
s_branch L2_fin
LT_merge:
s_mov_b32 s94, 0x10000
LT_mw:
buffer_load_dwordx2 v[0:1], off, s[16:19], s53 sc1
s_sub_u32 s94, s94, 1
s_waitcnt vmcnt(0)
s_cbranch_scc1 LT_mw_go
v_cmp_ne_u64 vcc, s[98:99], v[0:1]
s_nop 1
s_cbranch_vccnz LT_mw
LT_mw_go:
buffer_load_dwordx4 v[96:99], v243, s[16:19], s52 offen offset:0 sc1
buffer_load_dwordx4 v[100:103], v243, s[16:19], s52 offen offset:1024 sc1
buffer_load_dwordx4 v[104:107], v243, s[16:19], s52 offen offset:2048 sc1
buffer_load_dwordx4 v[108:111], v243, s[16:19], s52 offen offset:3072 sc1
s_add_u32 s52, s52, 4096
buffer_load_dwordx4 v[112:115], v243, s[16:19], s52 offen offset:0 sc1
buffer_load_dwordx4 v[116:119], v243, s[16:19], s52 offen offset:1024 sc1
buffer_load_dwordx4 v[120:123], v243, s[16:19], s52 offen offset:2048 sc1
buffer_load_dwordx4 v[124:127], v243, s[16:19], s52 offen offset:3072 sc1
s_add_u32 s52, s52, 4096
buffer_load_dwordx4 v[128:131], v243, s[16:19], s52 offen offset:0 sc1
buffer_load_dwordx4 v[132:135], v243, s[16:19], s52 offen offset:1024 sc1
buffer_load_dwordx4 v[136:139], v243, s[16:19], s52 offen offset:2048 sc1
buffer_load_dwordx4 v[140:143], v243, s[16:19], s52 offen offset:3072 sc1
s_add_u32 s52, s52, 4096
buffer_load_dwordx4 v[144:147], v243, s[16:19], s52 offen offset:0 sc1
buffer_load_dwordx4 v[148:151], v243, s[16:19], s52 offen offset:1024 sc1
buffer_load_dwordx4 v[152:155], v243, s[16:19], s52 offen offset:2048 sc1
buffer_load_dwordx4 v[156:159], v243, s[16:19], s52 offen offset:3072 sc1
s_add_u32 s52, s52, 4096
buffer_load_dwordx2 v[0:1], v243, s[16:19], s52 offen sc1
v_lshrrev_b32 v176, 4, v243
v_and_b32 v176, 0x30, v176
s_waitcnt vmcnt(0)
v_max_f32 v175, v172, v0
v_sub_f32 v2, v172, v175
v_sub_f32 v3, v0, v175
v_mov_b32 v172, v175
v_exp_f32 v2, v2
v_exp_f32 v3, v3
s_nop 0
v_mul_f32 v173, v173, v2
v_fmac_f32 v173, v1, v3
ds_bpermute_b32 v4, v176, v2 offset:0
ds_bpermute_b32 v8, v176, v3 offset:0
ds_bpermute_b32 v5, v176, v2 offset:4
ds_bpermute_b32 v9, v176, v3 offset:4
ds_bpermute_b32 v6, v176, v2 offset:8
ds_bpermute_b32 v10, v176, v3 offset:8
ds_bpermute_b32 v7, v176, v2 offset:12
ds_bpermute_b32 v11, v176, v3 offset:12
s_waitcnt lgkmcnt(0)
v_accvgpr_read_b32 v180, a0
v_accvgpr_read_b32 v181, a1
v_accvgpr_read_b32 v182, a2
v_accvgpr_read_b32 v183, a3
v_accvgpr_read_b32 v184, a4
v_accvgpr_read_b32 v185, a5
v_accvgpr_read_b32 v186, a6
v_accvgpr_read_b32 v187, a7
v_mul_f32 v180, v180, v4
v_mul_f32 v181, v181, v5
v_mul_f32 v182, v182, v6
v_mul_f32 v183, v183, v7
v_mul_f32 v184, v184, v4
v_mul_f32 v185, v185, v5
v_mul_f32 v186, v186, v6
v_mul_f32 v187, v187, v7
v_fmac_f32 v180, v96, v8
v_fmac_f32 v181, v97, v9
v_fmac_f32 v182, v98, v10
v_fmac_f32 v183, v99, v11
v_fmac_f32 v184, v100, v8
v_fmac_f32 v185, v101, v9
v_fmac_f32 v186, v102, v10
v_fmac_f32 v187, v103, v11
v_cvt_pk_bf16_f32 v32, v180, v181
v_cvt_pk_bf16_f32 v33, v182, v183
v_cvt_pk_bf16_f32 v34, v184, v185
v_cvt_pk_bf16_f32 v35, v186, v187
buffer_store_dwordx4 v[32:35], v243, s[20:23], s40 offen offset:0 sc1
v_accvgpr_read_b32 v180, a8
v_accvgpr_read_b32 v181, a9
v_accvgpr_read_b32 v182, a10
v_accvgpr_read_b32 v183, a11
v_accvgpr_read_b32 v184, a12
v_accvgpr_read_b32 v185, a13
v_accvgpr_read_b32 v186, a14
v_accvgpr_read_b32 v187, a15
v_mul_f32 v180, v180, v4
v_mul_f32 v181, v181, v5
v_mul_f32 v182, v182, v6
v_mul_f32 v183, v183, v7
v_mul_f32 v184, v184, v4
v_mul_f32 v185, v185, v5
v_mul_f32 v186, v186, v6
v_mul_f32 v187, v187, v7
v_fmac_f32 v180, v104, v8
v_fmac_f32 v181, v105, v9
v_fmac_f32 v182, v106, v10
v_fmac_f32 v183, v107, v11
v_fmac_f32 v184, v108, v8
v_fmac_f32 v185, v109, v9
v_fmac_f32 v186, v110, v10
v_fmac_f32 v187, v111, v11
v_cvt_pk_bf16_f32 v36, v180, v181
v_cvt_pk_bf16_f32 v37, v182, v183
v_cvt_pk_bf16_f32 v38, v184, v185
v_cvt_pk_bf16_f32 v39, v186, v187
buffer_store_dwordx4 v[36:39], v243, s[20:23], s40 offen offset:1024 sc1
v_accvgpr_read_b32 v180, a16
v_accvgpr_read_b32 v181, a17
v_accvgpr_read_b32 v182, a18
v_accvgpr_read_b32 v183, a19
v_accvgpr_read_b32 v184, a20
v_accvgpr_read_b32 v185, a21
v_accvgpr_read_b32 v186, a22
v_accvgpr_read_b32 v187, a23
v_mul_f32 v180, v180, v4
v_mul_f32 v181, v181, v5
v_mul_f32 v182, v182, v6
v_mul_f32 v183, v183, v7
v_mul_f32 v184, v184, v4
v_mul_f32 v185, v185, v5
v_mul_f32 v186, v186, v6
v_mul_f32 v187, v187, v7
v_fmac_f32 v180, v112, v8
v_fmac_f32 v181, v113, v9
v_fmac_f32 v182, v114, v10
v_fmac_f32 v183, v115, v11
v_fmac_f32 v184, v116, v8
v_fmac_f32 v185, v117, v9
v_fmac_f32 v186, v118, v10
v_fmac_f32 v187, v119, v11
v_cvt_pk_bf16_f32 v40, v180, v181
v_cvt_pk_bf16_f32 v41, v182, v183
v_cvt_pk_bf16_f32 v42, v184, v185
v_cvt_pk_bf16_f32 v43, v186, v187
buffer_store_dwordx4 v[40:43], v243, s[20:23], s40 offen offset:2048 sc1
v_accvgpr_read_b32 v180, a24
v_accvgpr_read_b32 v181, a25
v_accvgpr_read_b32 v182, a26
v_accvgpr_read_b32 v183, a27
v_accvgpr_read_b32 v184, a28
v_accvgpr_read_b32 v185, a29
v_accvgpr_read_b32 v186, a30
v_accvgpr_read_b32 v187, a31
v_mul_f32 v180, v180, v4
v_mul_f32 v181, v181, v5
v_mul_f32 v182, v182, v6
v_mul_f32 v183, v183, v7
v_mul_f32 v184, v184, v4
v_mul_f32 v185, v185, v5
v_mul_f32 v186, v186, v6
v_mul_f32 v187, v187, v7
v_fmac_f32 v180, v120, v8
v_fmac_f32 v181, v121, v9
v_fmac_f32 v182, v122, v10
v_fmac_f32 v183, v123, v11
v_fmac_f32 v184, v124, v8
v_fmac_f32 v185, v125, v9
v_fmac_f32 v186, v126, v10
v_fmac_f32 v187, v127, v11
v_cvt_pk_bf16_f32 v44, v180, v181
v_cvt_pk_bf16_f32 v45, v182, v183
v_cvt_pk_bf16_f32 v46, v184, v185
v_cvt_pk_bf16_f32 v47, v186, v187
buffer_store_dwordx4 v[44:47], v243, s[20:23], s40 offen offset:3072 sc1
v_accvgpr_read_b32 v180, a32
v_accvgpr_read_b32 v181, a33
v_accvgpr_read_b32 v182, a34
v_accvgpr_read_b32 v183, a35
v_accvgpr_read_b32 v184, a36
v_accvgpr_read_b32 v185, a37
v_accvgpr_read_b32 v186, a38
v_accvgpr_read_b32 v187, a39
v_mul_f32 v180, v180, v4
v_mul_f32 v181, v181, v5
v_mul_f32 v182, v182, v6
v_mul_f32 v183, v183, v7
v_mul_f32 v184, v184, v4
v_mul_f32 v185, v185, v5
v_mul_f32 v186, v186, v6
v_mul_f32 v187, v187, v7
v_fmac_f32 v180, v128, v8
v_fmac_f32 v181, v129, v9
v_fmac_f32 v182, v130, v10
v_fmac_f32 v183, v131, v11
v_fmac_f32 v184, v132, v8
v_fmac_f32 v185, v133, v9
v_fmac_f32 v186, v134, v10
v_fmac_f32 v187, v135, v11
v_cvt_pk_bf16_f32 v48, v180, v181
v_cvt_pk_bf16_f32 v49, v182, v183
v_cvt_pk_bf16_f32 v50, v184, v185
v_cvt_pk_bf16_f32 v51, v186, v187
buffer_store_dwordx4 v[48:51], v243, s[20:23], s44 offen offset:0 sc1
v_accvgpr_read_b32 v180, a40
v_accvgpr_read_b32 v181, a41
v_accvgpr_read_b32 v182, a42
v_accvgpr_read_b32 v183, a43
v_accvgpr_read_b32 v184, a44
v_accvgpr_read_b32 v185, a45
v_accvgpr_read_b32 v186, a46
v_accvgpr_read_b32 v187, a47
v_mul_f32 v180, v180, v4
v_mul_f32 v181, v181, v5
v_mul_f32 v182, v182, v6
v_mul_f32 v183, v183, v7
v_mul_f32 v184, v184, v4
v_mul_f32 v185, v185, v5
v_mul_f32 v186, v186, v6
v_mul_f32 v187, v187, v7
v_fmac_f32 v180, v136, v8
v_fmac_f32 v181, v137, v9
v_fmac_f32 v182, v138, v10
v_fmac_f32 v183, v139, v11
v_fmac_f32 v184, v140, v8
v_fmac_f32 v185, v141, v9
v_fmac_f32 v186, v142, v10
v_fmac_f32 v187, v143, v11
v_cvt_pk_bf16_f32 v52, v180, v181
v_cvt_pk_bf16_f32 v53, v182, v183
v_cvt_pk_bf16_f32 v54, v184, v185
v_cvt_pk_bf16_f32 v55, v186, v187
buffer_store_dwordx4 v[52:55], v243, s[20:23], s44 offen offset:1024 sc1
v_accvgpr_read_b32 v180, a48
v_accvgpr_read_b32 v181, a49
v_accvgpr_read_b32 v182, a50
v_accvgpr_read_b32 v183, a51
v_accvgpr_read_b32 v184, a52
v_accvgpr_read_b32 v185, a53
v_accvgpr_read_b32 v186, a54
v_accvgpr_read_b32 v187, a55
v_mul_f32 v180, v180, v4
v_mul_f32 v181, v181, v5
v_mul_f32 v182, v182, v6
v_mul_f32 v183, v183, v7
v_mul_f32 v184, v184, v4
v_mul_f32 v185, v185, v5
v_mul_f32 v186, v186, v6
v_mul_f32 v187, v187, v7
v_fmac_f32 v180, v144, v8
v_fmac_f32 v181, v145, v9
v_fmac_f32 v182, v146, v10
v_fmac_f32 v183, v147, v11
v_fmac_f32 v184, v148, v8
v_fmac_f32 v185, v149, v9
v_fmac_f32 v186, v150, v10
v_fmac_f32 v187, v151, v11
v_cvt_pk_bf16_f32 v56, v180, v181
v_cvt_pk_bf16_f32 v57, v182, v183
v_cvt_pk_bf16_f32 v58, v184, v185
v_cvt_pk_bf16_f32 v59, v186, v187
buffer_store_dwordx4 v[56:59], v243, s[20:23], s44 offen offset:2048 sc1
v_accvgpr_read_b32 v180, a56
v_accvgpr_read_b32 v181, a57
v_accvgpr_read_b32 v182, a58
v_accvgpr_read_b32 v183, a59
v_accvgpr_read_b32 v184, a60
v_accvgpr_read_b32 v185, a61
v_accvgpr_read_b32 v186, a62
v_accvgpr_read_b32 v187, a63
v_mul_f32 v180, v180, v4
v_mul_f32 v181, v181, v5
v_mul_f32 v182, v182, v6
v_mul_f32 v183, v183, v7
v_mul_f32 v184, v184, v4
v_mul_f32 v185, v185, v5
v_mul_f32 v186, v186, v6
v_mul_f32 v187, v187, v7
v_fmac_f32 v180, v152, v8
v_fmac_f32 v181, v153, v9
v_fmac_f32 v182, v154, v10
v_fmac_f32 v183, v155, v11
v_fmac_f32 v184, v156, v8
v_fmac_f32 v185, v157, v9
v_fmac_f32 v186, v158, v10
v_fmac_f32 v187, v159, v11
v_cvt_pk_bf16_f32 v60, v180, v181
v_cvt_pk_bf16_f32 v61, v182, v183
v_cvt_pk_bf16_f32 v62, v184, v185
v_cvt_pk_bf16_f32 v63, v186, v187
buffer_store_dwordx4 v[60:63], v243, s[20:23], s44 offen offset:3072 sc1
v_mov_b32 v176, v173
s_nop 1
v_permlane32_swap_b32 v173, v176
s_nop 1
v_add_f32 v173, v173, v176
v_mov_b32 v176, v173
s_nop 1
v_permlane16_swap_b32 v173, v176
s_nop 1
v_add_f32 v173, v173, v176
v_lshlrev_b32 v175, 2, v243
s_mov_b64 exec, 0xffff
s_mov_b64 exec, -1
v_bfe_u32 v175, v243, 8, 1
v_mul_u32_u24 v175, 48, v175
v_lshl_add_u32 v175, s37, 3, v175
v_and_b32 v176, 0xf0, v243
v_lshl_add_u32 v175, v176, 3, v175
s_mov_b32 exec_hi, 0
buffer_store_dwordx2 v[172:173], v175, s[24:27], s48 offen sc1
s_add_u32 s16, s4, 0x7c00000
s_addc_u32 s17, s5, 0
s_mov_b32 s18, 0x40000
s_mov_b32 s19, 0x00020000
s_add_u32 s48, s37, 1248
s_mul_i32 s48, s48, 128
s_waitcnt vmcnt(0)
v_mov_b32 v176, s98
v_mov_b32 v177, s99
s_mov_b64 exec, 1
buffer_store_dwordx2 v[176:177], off, s[16:19], s48 sc1
buffer_store_dwordx2 v[176:177], off, s[16:19], s48 offset:8 sc1
s_mov_b64 exec, -1
s_branch L2_fin
LE_start:
s_cmp_ge_u32 s37, 32
s_cbranch_scc1 L2_end
v_lshrrev_b32 v1, 6, v0
s_sub_u32 s37, s37, 30
s_lshl_b32 s35, s35, 1
v_readfirstlane_b32 s41, v1
s_add_u32 s35, s35, s37
s_mul_i32 s35, s35, 3
s_add_u32 s40, s35, s41
s_cmp_ge_u32 s41, 3
s_cbranch_scc1 L2_end
LE_common:
v_and_b32 v1, 63, v0
s_sub_u32 s36, s40, 0
s_mov_b32 s54, 151
s_mul_i32 s36, s36, 151
s_mov_b32 s55, s36
s_sub_u32 s36, s40, 36
s_cselect_b32 s54, s54, 166
s_mul_i32 s36, s36, 166
s_add_u32 s36, s36, 5436
s_cmp_lt_u32 s40, 36
s_cselect_b32 s55, s55, s36
s_sub_u32 s36, s40, 42
s_cselect_b32 s54, s54, 152
s_mul_i32 s36, s36, 152
s_add_u32 s36, s36, 6432
s_cmp_lt_u32 s40, 42
s_cselect_b32 s55, s55, s36
s_sub_u32 s36, s40, 48
s_cselect_b32 s54, s54, 168
s_mul_i32 s36, s36, 168
s_add_u32 s36, s36, 7344
s_cmp_lt_u32 s40, 48
s_cselect_b32 s55, s55, s36
s_mov_b32 s42, 0
s_mov_b32 s49, 512
v_lshrrev_b32 v33, 2, v1
v_and_b32 v34, 3, v1
v_mul_u32_u24 v6, 0xa000, v33
v_lshl_add_u32 v6, v34, 4, v6
v_lshlrev_b32 v33, 2, v33
s_mul_i32 s50, s40, 655360
s_mul_i32 s48, s40, 64
s_waitcnt lgkmcnt(0)
s_add_u32 s8, s4, 0x7c31800
s_addc_u32 s9, s5, 0
s_mov_b32 s10, 0x800
s_mov_b32 s11, 0x00020000
v_and_b32 v194, 15, v0
v_lshlrev_b32 v194, 7, v194
s_mov_b32 s94, 0x10000
LE_poll0:
buffer_load_dwordx2 v[192:193], v194, s[8:11], 0 offen sc1
s_sub_u32 s94, s94, 1
s_waitcnt vmcnt(0)
s_cbranch_scc1 LE_poll0_go
v_cmp_ne_u64 vcc, s[98:99], v[192:193]
s_nop 1
s_cbranch_vccnz LE_poll0
LE_poll0_go:
s_add_u32 s8, s4, 0x7800000
s_addc_u32 s9, s5, 0
s_mov_b32 s10, 0x1000
s_mov_b32 s11, 0x00020000
s_add_u32 s12, s4, 0x8000000
s_addc_u32 s13, s5, 0
s_mov_b32 s14, 0x2800000
s_mov_b32 s15, 0x00020000
buffer_load_dword v4, v33, s[8:11], s48 offen sc1
buffer_load_dwordx4 v[192:195], v6, s[12:15], s50 offen offset:0 sc1
buffer_load_dwordx4 v[196:199], v6, s[12:15], s50 offen offset:64 sc1
buffer_load_dwordx4 v[200:203], v6, s[12:15], s50 offen offset:128 sc1
buffer_load_dwordx4 v[204:207], v6, s[12:15], s50 offen offset:192 sc1
buffer_load_dwordx4 v[208:211], v6, s[12:15], s50 offen offset:256 sc1
buffer_load_dwordx4 v[212:215], v6, s[12:15], s50 offen offset:320 sc1
buffer_load_dwordx4 v[216:219], v6, s[12:15], s50 offen offset:384 sc1
buffer_load_dwordx4 v[220:223], v6, s[12:15], s50 offen offset:448 sc1
buffer_load_dwordx4 v[224:227], v6, s[12:15], s50 offen offset:512 sc1
buffer_load_dwordx4 v[228:231], v6, s[12:15], s50 offen offset:576 sc1
buffer_load_dwordx4 v[232:235], v6, s[12:15], s50 offen offset:640 sc1
buffer_load_dwordx4 v[236:239], v6, s[12:15], s50 offen offset:704 sc1
buffer_load_dwordx4 v[240:243], v6, s[12:15], s50 offen offset:768 sc1
buffer_load_dwordx4 v[244:247], v6, s[12:15], s50 offen offset:832 sc1
buffer_load_dwordx4 v[248:251], v6, s[12:15], s50 offen offset:896 sc1
buffer_load_dwordx4 v[252:255], v6, s[12:15], s50 offen offset:960 sc1
s_add_u32 s16, s4, 0x6800000
s_addc_u32 s17, s5, 0
s_mov_b32 s18, 0x4e2000
s_mov_b32 s19, 0x00020000
s_add_u32 s20, s4, 0x7000000
s_addc_u32 s21, s5, 0
s_mov_b32 s22, 0x4e2000
s_mov_b32 s23, 0x00020000
v_lshlrev_b32 v5, 2, v34
v_and_b32 v2, 15, v1
v_lshrrev_b32 v3, 4, v1
v_mov_b32 v16, 1
v_mov_b32 v17, 4
v_and_b32 v33, 1, v2
v_lshlrev_b32 v33, 4, v33
v_lshlrev_b32 v33, v33, v16
v_mul_u32_u24 v33, 0x3f80, v33
v_lshrrev_b32 v34, 1, v2
v_cmp_eq_u32 vcc, 0, v34
s_nop 1
v_cndmask_b32 v40, 0, v33, vcc
v_cmp_eq_u32 vcc, 1, v34
s_nop 1
v_cndmask_b32 v41, 0, v33, vcc
v_cmp_eq_u32 vcc, 2, v34
s_nop 1
v_cndmask_b32 v42, 0, v33, vcc
v_cmp_eq_u32 vcc, 3, v34
s_nop 1
v_cndmask_b32 v43, 0, v33, vcc
v_cmp_eq_u32 vcc, 4, v34
s_nop 1
v_cndmask_b32 v44, 0, v33, vcc
v_cmp_eq_u32 vcc, 5, v34
s_nop 1
v_cndmask_b32 v45, 0, v33, vcc
v_cmp_eq_u32 vcc, 6, v34
s_nop 1
v_cndmask_b32 v46, 0, v33, vcc
v_cmp_eq_u32 vcc, 7, v34
s_nop 1
v_cndmask_b32 v47, 0, v33, vcc
v_lshlrev_b32 v39, 5, v2
v_lshl_add_u32 v39, v3, 3, v39
v_lshlrev_b32 v2, 4, v2
s_mul_i32 s48, s41, 21504
s_add_u32 s48, s48, 4096
v_mov_b32 v36, s48
v_lshl_add_u32 v38, v3, 2, v36
s_lshl_b32 s36, s41, 10
s_lshl_b32 s35, s55, 2
s_sub_u32 s35, s36, s35
v_mov_b32 v7, s35
v_lshlrev_b32 v35, 4, v1
v_add_u32 v68, s48, v35
v_add_u32 v35, s36, v35
v_lshlrev_b32 v33, 2, v1
v_mov_b32 v72, 0xffff
v_mov_b32 v73, 0xffff
v_mov_b32 v74, 0xffff
v_mov_b32 v75, 0xffff
v_cmp_gt_u32 vcc, s54, v33
v_mov_b32 v48, 0
s_nop 0
v_cndmask_b32 v18, 0, v16, vcc
v_add_u32 v33, 1, v33
v_cmp_gt_u32 vcc, s54, v33
v_mov_b32 v49, 0
s_nop 0
v_cndmask_b32 v19, 0, v16, vcc
v_add_u32 v33, 1, v33
v_cmp_gt_u32 vcc, s54, v33
v_mov_b32 v50, 0
s_nop 0
v_cndmask_b32 v20, 0, v16, vcc
v_add_u32 v33, 1, v33
v_cmp_gt_u32 vcc, s54, v33
v_mov_b32 v51, 0
s_nop 0
v_cndmask_b32 v21, 0, v16, vcc
LE_pass:
ds_write_b128 v35, v[48:51]
ds_write_b128 v68, v[72:75] offset:0
ds_write_b128 v68, v[72:75] offset:1024
ds_write_b128 v68, v[72:75] offset:2048
ds_write_b128 v68, v[72:75] offset:3072
ds_write_b128 v68, v[72:75] offset:4096
ds_write_b128 v68, v[72:75] offset:5120
ds_write_b128 v68, v[72:75] offset:6144
ds_write_b128 v68, v[72:75] offset:7168
ds_write_b128 v68, v[72:75] offset:8192
ds_write_b128 v68, v[72:75] offset:9216
ds_write_b128 v68, v[72:75] offset:10240
ds_write_b128 v68, v[72:75] offset:11264
ds_write_b128 v68, v[72:75] offset:12288
ds_write_b128 v68, v[72:75] offset:13312
ds_write_b128 v68, v[72:75] offset:14336
ds_write_b128 v68, v[72:75] offset:15360
ds_write_b128 v68, v[72:75] offset:16384
ds_write_b128 v68, v[72:75] offset:17408
ds_write_b128 v68, v[72:75] offset:18432
ds_write_b128 v68, v[72:75] offset:19456
v_lshl_add_u32 v32, v1, 2, v36
ds_write_b32 v32, v48 offset:20480
s_waitcnt vmcnt(16)
v_sub_u32 v32, v4, v5
s_waitcnt vmcnt(15)
v_cmpx_lt_i32 vcc, 0, v32
s_cbranch_execz LE_c
v_mad_u32_u16 v128, v192, 1, v7 op_sel:[1,0,0,0]
ds_add_u32 v128, v16
v_cmpx_lt_i32 vcc, 1, v32
v_mad_u32_u16 v129, v193, 1, v7 op_sel:[1,0,0,0]
ds_add_u32 v129, v16
v_cmpx_lt_i32 vcc, 2, v32
v_mad_u32_u16 v130, v194, 1, v7 op_sel:[1,0,0,0]
ds_add_u32 v130, v16
v_cmpx_lt_i32 vcc, 3, v32
v_mad_u32_u16 v131, v195, 1, v7 op_sel:[1,0,0,0]
ds_add_u32 v131, v16
s_waitcnt vmcnt(14)
v_cmpx_lt_i32 vcc, 16, v32
s_cbranch_execz LE_c
v_mad_u32_u16 v132, v196, 1, v7 op_sel:[1,0,0,0]
ds_add_u32 v132, v16
v_cmpx_lt_i32 vcc, 17, v32
v_mad_u32_u16 v133, v197, 1, v7 op_sel:[1,0,0,0]
ds_add_u32 v133, v16
v_cmpx_lt_i32 vcc, 18, v32
v_mad_u32_u16 v134, v198, 1, v7 op_sel:[1,0,0,0]
ds_add_u32 v134, v16
v_cmpx_lt_i32 vcc, 19, v32
v_mad_u32_u16 v135, v199, 1, v7 op_sel:[1,0,0,0]
ds_add_u32 v135, v16
s_waitcnt vmcnt(13)
v_cmpx_lt_i32 vcc, 32, v32
s_cbranch_execz LE_c
v_mad_u32_u16 v136, v200, 1, v7 op_sel:[1,0,0,0]
ds_add_u32 v136, v16
v_cmpx_lt_i32 vcc, 33, v32
v_mad_u32_u16 v137, v201, 1, v7 op_sel:[1,0,0,0]
ds_add_u32 v137, v16
v_cmpx_lt_i32 vcc, 34, v32
v_mad_u32_u16 v138, v202, 1, v7 op_sel:[1,0,0,0]
ds_add_u32 v138, v16
v_cmpx_lt_i32 vcc, 35, v32
v_mad_u32_u16 v139, v203, 1, v7 op_sel:[1,0,0,0]
ds_add_u32 v139, v16
s_waitcnt vmcnt(12)
v_cmpx_lt_i32 vcc, 48, v32
s_cbranch_execz LE_c
v_mad_u32_u16 v140, v204, 1, v7 op_sel:[1,0,0,0]
ds_add_u32 v140, v16
v_cmpx_lt_i32 vcc, 49, v32
v_mad_u32_u16 v141, v205, 1, v7 op_sel:[1,0,0,0]
ds_add_u32 v141, v16
v_cmpx_lt_i32 vcc, 50, v32
v_mad_u32_u16 v142, v206, 1, v7 op_sel:[1,0,0,0]
ds_add_u32 v142, v16
v_cmpx_lt_i32 vcc, 51, v32
v_mad_u32_u16 v143, v207, 1, v7 op_sel:[1,0,0,0]
ds_add_u32 v143, v16
s_waitcnt vmcnt(11)
v_cmpx_lt_i32 vcc, 64, v32
s_cbranch_execz LE_c
v_mad_u32_u16 v144, v208, 1, v7 op_sel:[1,0,0,0]
ds_add_u32 v144, v16
v_cmpx_lt_i32 vcc, 65, v32
v_mad_u32_u16 v145, v209, 1, v7 op_sel:[1,0,0,0]
ds_add_u32 v145, v16
v_cmpx_lt_i32 vcc, 66, v32
v_mad_u32_u16 v146, v210, 1, v7 op_sel:[1,0,0,0]
ds_add_u32 v146, v16
v_cmpx_lt_i32 vcc, 67, v32
v_mad_u32_u16 v147, v211, 1, v7 op_sel:[1,0,0,0]
ds_add_u32 v147, v16
s_waitcnt vmcnt(10)
v_cmpx_lt_i32 vcc, 80, v32
s_cbranch_execz LE_c
v_mad_u32_u16 v148, v212, 1, v7 op_sel:[1,0,0,0]
ds_add_u32 v148, v16
v_cmpx_lt_i32 vcc, 81, v32
v_mad_u32_u16 v149, v213, 1, v7 op_sel:[1,0,0,0]
ds_add_u32 v149, v16
v_cmpx_lt_i32 vcc, 82, v32
v_mad_u32_u16 v150, v214, 1, v7 op_sel:[1,0,0,0]
ds_add_u32 v150, v16
v_cmpx_lt_i32 vcc, 83, v32
v_mad_u32_u16 v151, v215, 1, v7 op_sel:[1,0,0,0]
ds_add_u32 v151, v16
s_waitcnt vmcnt(9)
v_cmpx_lt_i32 vcc, 96, v32
s_cbranch_execz LE_c
v_mad_u32_u16 v152, v216, 1, v7 op_sel:[1,0,0,0]
ds_add_u32 v152, v16
v_cmpx_lt_i32 vcc, 97, v32
v_mad_u32_u16 v153, v217, 1, v7 op_sel:[1,0,0,0]
ds_add_u32 v153, v16
v_cmpx_lt_i32 vcc, 98, v32
v_mad_u32_u16 v154, v218, 1, v7 op_sel:[1,0,0,0]
ds_add_u32 v154, v16
v_cmpx_lt_i32 vcc, 99, v32
v_mad_u32_u16 v155, v219, 1, v7 op_sel:[1,0,0,0]
ds_add_u32 v155, v16
s_waitcnt vmcnt(8)
v_cmpx_lt_i32 vcc, 112, v32
s_cbranch_execz LE_c
v_mad_u32_u16 v156, v220, 1, v7 op_sel:[1,0,0,0]
ds_add_u32 v156, v16
v_cmpx_lt_i32 vcc, 113, v32
v_mad_u32_u16 v157, v221, 1, v7 op_sel:[1,0,0,0]
ds_add_u32 v157, v16
v_cmpx_lt_i32 vcc, 114, v32
v_mad_u32_u16 v158, v222, 1, v7 op_sel:[1,0,0,0]
ds_add_u32 v158, v16
v_cmpx_lt_i32 vcc, 115, v32
v_mad_u32_u16 v159, v223, 1, v7 op_sel:[1,0,0,0]
ds_add_u32 v159, v16
s_waitcnt vmcnt(7)
v_cmpx_lt_i32 vcc, 128, v32
s_cbranch_execz LE_c
v_mad_u32_u16 v160, v224, 1, v7 op_sel:[1,0,0,0]
ds_add_u32 v160, v16
v_cmpx_lt_i32 vcc, 129, v32
v_mad_u32_u16 v161, v225, 1, v7 op_sel:[1,0,0,0]
ds_add_u32 v161, v16
v_cmpx_lt_i32 vcc, 130, v32
v_mad_u32_u16 v162, v226, 1, v7 op_sel:[1,0,0,0]
ds_add_u32 v162, v16
v_cmpx_lt_i32 vcc, 131, v32
v_mad_u32_u16 v163, v227, 1, v7 op_sel:[1,0,0,0]
ds_add_u32 v163, v16
s_waitcnt vmcnt(6)
v_cmpx_lt_i32 vcc, 144, v32
s_cbranch_execz LE_c
v_mad_u32_u16 v164, v228, 1, v7 op_sel:[1,0,0,0]
ds_add_u32 v164, v16
v_cmpx_lt_i32 vcc, 145, v32
v_mad_u32_u16 v165, v229, 1, v7 op_sel:[1,0,0,0]
ds_add_u32 v165, v16
v_cmpx_lt_i32 vcc, 146, v32
v_mad_u32_u16 v166, v230, 1, v7 op_sel:[1,0,0,0]
ds_add_u32 v166, v16
v_cmpx_lt_i32 vcc, 147, v32
v_mad_u32_u16 v167, v231, 1, v7 op_sel:[1,0,0,0]
ds_add_u32 v167, v16
s_waitcnt vmcnt(5)
v_cmpx_lt_i32 vcc, 160, v32
s_cbranch_execz LE_c
v_mad_u32_u16 v168, v232, 1, v7 op_sel:[1,0,0,0]
ds_add_u32 v168, v16
v_cmpx_lt_i32 vcc, 161, v32
v_mad_u32_u16 v169, v233, 1, v7 op_sel:[1,0,0,0]
ds_add_u32 v169, v16
v_cmpx_lt_i32 vcc, 162, v32
v_mad_u32_u16 v170, v234, 1, v7 op_sel:[1,0,0,0]
ds_add_u32 v170, v16
v_cmpx_lt_i32 vcc, 163, v32
v_mad_u32_u16 v171, v235, 1, v7 op_sel:[1,0,0,0]
ds_add_u32 v171, v16
s_waitcnt vmcnt(4)
v_cmpx_lt_i32 vcc, 176, v32
s_cbranch_execz LE_c
v_mad_u32_u16 v172, v236, 1, v7 op_sel:[1,0,0,0]
ds_add_u32 v172, v16
v_cmpx_lt_i32 vcc, 177, v32
v_mad_u32_u16 v173, v237, 1, v7 op_sel:[1,0,0,0]
ds_add_u32 v173, v16
v_cmpx_lt_i32 vcc, 178, v32
v_mad_u32_u16 v174, v238, 1, v7 op_sel:[1,0,0,0]
ds_add_u32 v174, v16
v_cmpx_lt_i32 vcc, 179, v32
v_mad_u32_u16 v175, v239, 1, v7 op_sel:[1,0,0,0]
ds_add_u32 v175, v16
s_waitcnt vmcnt(3)
v_cmpx_lt_i32 vcc, 192, v32
s_cbranch_execz LE_c
v_mad_u32_u16 v176, v240, 1, v7 op_sel:[1,0,0,0]
ds_add_u32 v176, v16
v_cmpx_lt_i32 vcc, 193, v32
v_mad_u32_u16 v177, v241, 1, v7 op_sel:[1,0,0,0]
ds_add_u32 v177, v16
v_cmpx_lt_i32 vcc, 194, v32
v_mad_u32_u16 v178, v242, 1, v7 op_sel:[1,0,0,0]
ds_add_u32 v178, v16
v_cmpx_lt_i32 vcc, 195, v32
v_mad_u32_u16 v179, v243, 1, v7 op_sel:[1,0,0,0]
ds_add_u32 v179, v16
s_waitcnt vmcnt(2)
v_cmpx_lt_i32 vcc, 208, v32
s_cbranch_execz LE_c
v_mad_u32_u16 v180, v244, 1, v7 op_sel:[1,0,0,0]
ds_add_u32 v180, v16
v_cmpx_lt_i32 vcc, 209, v32
v_mad_u32_u16 v181, v245, 1, v7 op_sel:[1,0,0,0]
ds_add_u32 v181, v16
v_cmpx_lt_i32 vcc, 210, v32
v_mad_u32_u16 v182, v246, 1, v7 op_sel:[1,0,0,0]
ds_add_u32 v182, v16
v_cmpx_lt_i32 vcc, 211, v32
v_mad_u32_u16 v183, v247, 1, v7 op_sel:[1,0,0,0]
ds_add_u32 v183, v16
s_waitcnt vmcnt(1)
v_cmpx_lt_i32 vcc, 224, v32
s_cbranch_execz LE_c
v_mad_u32_u16 v184, v248, 1, v7 op_sel:[1,0,0,0]
ds_add_u32 v184, v16
v_cmpx_lt_i32 vcc, 225, v32
v_mad_u32_u16 v185, v249, 1, v7 op_sel:[1,0,0,0]
ds_add_u32 v185, v16
v_cmpx_lt_i32 vcc, 226, v32
v_mad_u32_u16 v186, v250, 1, v7 op_sel:[1,0,0,0]
ds_add_u32 v186, v16
v_cmpx_lt_i32 vcc, 227, v32
v_mad_u32_u16 v187, v251, 1, v7 op_sel:[1,0,0,0]
ds_add_u32 v187, v16
s_waitcnt vmcnt(0)
v_cmpx_lt_i32 vcc, 240, v32
s_cbranch_execz LE_c
v_mad_u32_u16 v188, v252, 1, v7 op_sel:[1,0,0,0]
ds_add_u32 v188, v16
v_cmpx_lt_i32 vcc, 241, v32
v_mad_u32_u16 v189, v253, 1, v7 op_sel:[1,0,0,0]
ds_add_u32 v189, v16
v_cmpx_lt_i32 vcc, 242, v32
v_mad_u32_u16 v190, v254, 1, v7 op_sel:[1,0,0,0]
ds_add_u32 v190, v16
v_cmpx_lt_i32 vcc, 243, v32
v_mad_u32_u16 v191, v255, 1, v7 op_sel:[1,0,0,0]
ds_add_u32 v191, v16
LE_c:
s_mov_b64 exec, -1
ds_read_b128 v[24:27], v35
s_waitcnt lgkmcnt(0)
v_add_u32 v24, 3, v24
v_lshrrev_b32 v24, 2, v24
v_max_u32 v24, v24, v18
v_add_u32 v25, 3, v25
v_lshrrev_b32 v25, 2, v25
v_max_u32 v25, v25, v19
v_add_u32 v26, 3, v26
v_lshrrev_b32 v26, 2, v26
v_max_u32 v26, v26, v20
v_add_u32 v27, 3, v27
v_lshrrev_b32 v27, 2, v27
v_max_u32 v27, v27, v21
v_add_u32 v33, v24, v25
v_add3_u32 v33, v33, v26, v27
v_mov_b32 v64, v33
s_nop 1
v_add_u32_dpp v64, v64, v64 row_shr:1 row_mask:0xf bank_mask:0xf
s_nop 1
v_add_u32_dpp v64, v64, v64 row_shr:2 row_mask:0xf bank_mask:0xf
s_nop 1
v_add_u32_dpp v64, v64, v64 row_shr:4 row_mask:0xf bank_mask:0xf
s_nop 1
v_add_u32_dpp v64, v64, v64 row_shr:8 row_mask:0xf bank_mask:0xf
s_nop 1
v_add_u32_dpp v64, v64, v64 row_bcast:15 row_mask:0xa bank_mask:0xf
s_nop 1
v_add_u32_dpp v64, v64, v64 row_bcast:31 row_mask:0xc bank_mask:0xf
s_nop 1
v_readlane_b32 s44, v64, 63
v_sub_u32 v28, v64, v33
v_add_u32 v29, v28, v24
v_add_u32 v30, v29, v25
v_add_u32 v31, v30, v26
v_add3_u32 v33, v28, v24, -1
v_lshlrev_b32 v34, v33, v18
v_lshrrev_b32 v33, 5, v33
v_lshl_add_u32 v33, v33, 2, v36
ds_or_b32 v33, v34 offset:20480
v_lshl_add_u32 v28, v28, 4, v36
v_add3_u32 v33, v29, v25, -1
v_lshlrev_b32 v34, v33, v19
v_lshrrev_b32 v33, 5, v33
v_lshl_add_u32 v33, v33, 2, v36
ds_or_b32 v33, v34 offset:20480
v_lshl_add_u32 v29, v29, 4, v36
v_add3_u32 v33, v30, v26, -1
v_lshlrev_b32 v34, v33, v20
v_lshrrev_b32 v33, 5, v33
v_lshl_add_u32 v33, v33, 2, v36
ds_or_b32 v33, v34 offset:20480
v_lshl_add_u32 v30, v30, 4, v36
v_add3_u32 v33, v31, v27, -1
v_lshlrev_b32 v34, v33, v21
v_lshrrev_b32 v33, 5, v33
v_lshl_add_u32 v33, v33, 2, v36
ds_or_b32 v33, v34 offset:20480
v_lshl_add_u32 v31, v31, 4, v36
ds_write_b128 v35, v[28:31]
s_add_u32 s44, s44, 31
s_lshr_b32 s44, s44, 5
v_cmpx_lt_i32 vcc, 0, v32
s_cbranch_execz LE_p
ds_add_rtn_u32 v128, v128, v17
v_cmpx_lt_i32 vcc, 1, v32
ds_add_rtn_u32 v129, v129, v17
v_cmpx_lt_i32 vcc, 2, v32
ds_add_rtn_u32 v130, v130, v17
v_cmpx_lt_i32 vcc, 3, v32
ds_add_rtn_u32 v131, v131, v17
v_cmpx_lt_i32 vcc, 16, v32
s_cbranch_execz LE_p
ds_add_rtn_u32 v132, v132, v17
v_cmpx_lt_i32 vcc, 17, v32
ds_add_rtn_u32 v133, v133, v17
v_cmpx_lt_i32 vcc, 18, v32
ds_add_rtn_u32 v134, v134, v17
v_cmpx_lt_i32 vcc, 19, v32
ds_add_rtn_u32 v135, v135, v17
v_cmpx_lt_i32 vcc, 32, v32
s_cbranch_execz LE_p
ds_add_rtn_u32 v136, v136, v17
v_cmpx_lt_i32 vcc, 33, v32
ds_add_rtn_u32 v137, v137, v17
v_cmpx_lt_i32 vcc, 34, v32
ds_add_rtn_u32 v138, v138, v17
v_cmpx_lt_i32 vcc, 35, v32
ds_add_rtn_u32 v139, v139, v17
v_cmpx_lt_i32 vcc, 48, v32
s_cbranch_execz LE_p
ds_add_rtn_u32 v140, v140, v17
v_cmpx_lt_i32 vcc, 49, v32
ds_add_rtn_u32 v141, v141, v17
v_cmpx_lt_i32 vcc, 50, v32
ds_add_rtn_u32 v142, v142, v17
v_cmpx_lt_i32 vcc, 51, v32
ds_add_rtn_u32 v143, v143, v17
v_cmpx_lt_i32 vcc, 64, v32
s_cbranch_execz LE_p
ds_add_rtn_u32 v144, v144, v17
v_cmpx_lt_i32 vcc, 65, v32
ds_add_rtn_u32 v145, v145, v17
v_cmpx_lt_i32 vcc, 66, v32
ds_add_rtn_u32 v146, v146, v17
v_cmpx_lt_i32 vcc, 67, v32
ds_add_rtn_u32 v147, v147, v17
v_cmpx_lt_i32 vcc, 80, v32
s_cbranch_execz LE_p
ds_add_rtn_u32 v148, v148, v17
v_cmpx_lt_i32 vcc, 81, v32
ds_add_rtn_u32 v149, v149, v17
v_cmpx_lt_i32 vcc, 82, v32
ds_add_rtn_u32 v150, v150, v17
v_cmpx_lt_i32 vcc, 83, v32
ds_add_rtn_u32 v151, v151, v17
v_cmpx_lt_i32 vcc, 96, v32
s_cbranch_execz LE_p
ds_add_rtn_u32 v152, v152, v17
v_cmpx_lt_i32 vcc, 97, v32
ds_add_rtn_u32 v153, v153, v17
v_cmpx_lt_i32 vcc, 98, v32
ds_add_rtn_u32 v154, v154, v17
v_cmpx_lt_i32 vcc, 99, v32
ds_add_rtn_u32 v155, v155, v17
v_cmpx_lt_i32 vcc, 112, v32
s_cbranch_execz LE_p
ds_add_rtn_u32 v156, v156, v17
v_cmpx_lt_i32 vcc, 113, v32
ds_add_rtn_u32 v157, v157, v17
v_cmpx_lt_i32 vcc, 114, v32
ds_add_rtn_u32 v158, v158, v17
v_cmpx_lt_i32 vcc, 115, v32
ds_add_rtn_u32 v159, v159, v17
v_cmpx_lt_i32 vcc, 128, v32
s_cbranch_execz LE_p
ds_add_rtn_u32 v160, v160, v17
v_cmpx_lt_i32 vcc, 129, v32
ds_add_rtn_u32 v161, v161, v17
v_cmpx_lt_i32 vcc, 130, v32
ds_add_rtn_u32 v162, v162, v17
v_cmpx_lt_i32 vcc, 131, v32
ds_add_rtn_u32 v163, v163, v17
v_cmpx_lt_i32 vcc, 144, v32
s_cbranch_execz LE_p
ds_add_rtn_u32 v164, v164, v17
v_cmpx_lt_i32 vcc, 145, v32
ds_add_rtn_u32 v165, v165, v17
v_cmpx_lt_i32 vcc, 146, v32
ds_add_rtn_u32 v166, v166, v17
v_cmpx_lt_i32 vcc, 147, v32
ds_add_rtn_u32 v167, v167, v17
v_cmpx_lt_i32 vcc, 160, v32
s_cbranch_execz LE_p
ds_add_rtn_u32 v168, v168, v17
v_cmpx_lt_i32 vcc, 161, v32
ds_add_rtn_u32 v169, v169, v17
v_cmpx_lt_i32 vcc, 162, v32
ds_add_rtn_u32 v170, v170, v17
v_cmpx_lt_i32 vcc, 163, v32
ds_add_rtn_u32 v171, v171, v17
v_cmpx_lt_i32 vcc, 176, v32
s_cbranch_execz LE_p
ds_add_rtn_u32 v172, v172, v17
v_cmpx_lt_i32 vcc, 177, v32
ds_add_rtn_u32 v173, v173, v17
v_cmpx_lt_i32 vcc, 178, v32
ds_add_rtn_u32 v174, v174, v17
v_cmpx_lt_i32 vcc, 179, v32
ds_add_rtn_u32 v175, v175, v17
v_cmpx_lt_i32 vcc, 192, v32
s_cbranch_execz LE_p
ds_add_rtn_u32 v176, v176, v17
v_cmpx_lt_i32 vcc, 193, v32
ds_add_rtn_u32 v177, v177, v17
v_cmpx_lt_i32 vcc, 194, v32
ds_add_rtn_u32 v178, v178, v17
v_cmpx_lt_i32 vcc, 195, v32
ds_add_rtn_u32 v179, v179, v17
v_cmpx_lt_i32 vcc, 208, v32
s_cbranch_execz LE_p
ds_add_rtn_u32 v180, v180, v17
v_cmpx_lt_i32 vcc, 209, v32
ds_add_rtn_u32 v181, v181, v17
v_cmpx_lt_i32 vcc, 210, v32
ds_add_rtn_u32 v182, v182, v17
v_cmpx_lt_i32 vcc, 211, v32
ds_add_rtn_u32 v183, v183, v17
v_cmpx_lt_i32 vcc, 224, v32
s_cbranch_execz LE_p
ds_add_rtn_u32 v184, v184, v17
v_cmpx_lt_i32 vcc, 225, v32
ds_add_rtn_u32 v185, v185, v17
v_cmpx_lt_i32 vcc, 226, v32
ds_add_rtn_u32 v186, v186, v17
v_cmpx_lt_i32 vcc, 227, v32
ds_add_rtn_u32 v187, v187, v17
v_cmpx_lt_i32 vcc, 240, v32
s_cbranch_execz LE_p
ds_add_rtn_u32 v188, v188, v17
v_cmpx_lt_i32 vcc, 241, v32
ds_add_rtn_u32 v189, v189, v17
v_cmpx_lt_i32 vcc, 242, v32
ds_add_rtn_u32 v190, v190, v17
v_cmpx_lt_i32 vcc, 243, v32
ds_add_rtn_u32 v191, v191, v17
LE_p:
s_mov_b64 exec, -1
v_lshl_add_u32 v33, v1, 2, v36
ds_read_b32 v37, v33 offset:20480
s_waitcnt lgkmcnt(0)
v_cmpx_lt_i32 vcc, 0, v32
s_cbranch_execz LE_w
ds_write_b32 v128, v192
v_cmpx_lt_i32 vcc, 1, v32
ds_write_b32 v129, v193
v_cmpx_lt_i32 vcc, 2, v32
ds_write_b32 v130, v194
v_cmpx_lt_i32 vcc, 3, v32
ds_write_b32 v131, v195
v_cmpx_lt_i32 vcc, 16, v32
s_cbranch_execz LE_w
ds_write_b32 v132, v196
v_cmpx_lt_i32 vcc, 17, v32
ds_write_b32 v133, v197
v_cmpx_lt_i32 vcc, 18, v32
ds_write_b32 v134, v198
v_cmpx_lt_i32 vcc, 19, v32
ds_write_b32 v135, v199
v_cmpx_lt_i32 vcc, 32, v32
s_cbranch_execz LE_w
ds_write_b32 v136, v200
v_cmpx_lt_i32 vcc, 33, v32
ds_write_b32 v137, v201
v_cmpx_lt_i32 vcc, 34, v32
ds_write_b32 v138, v202
v_cmpx_lt_i32 vcc, 35, v32
ds_write_b32 v139, v203
v_cmpx_lt_i32 vcc, 48, v32
s_cbranch_execz LE_w
ds_write_b32 v140, v204
v_cmpx_lt_i32 vcc, 49, v32
ds_write_b32 v141, v205
v_cmpx_lt_i32 vcc, 50, v32
ds_write_b32 v142, v206
v_cmpx_lt_i32 vcc, 51, v32
ds_write_b32 v143, v207
v_cmpx_lt_i32 vcc, 64, v32
s_cbranch_execz LE_w
ds_write_b32 v144, v208
v_cmpx_lt_i32 vcc, 65, v32
ds_write_b32 v145, v209
v_cmpx_lt_i32 vcc, 66, v32
ds_write_b32 v146, v210
v_cmpx_lt_i32 vcc, 67, v32
ds_write_b32 v147, v211
v_cmpx_lt_i32 vcc, 80, v32
s_cbranch_execz LE_w
ds_write_b32 v148, v212
v_cmpx_lt_i32 vcc, 81, v32
ds_write_b32 v149, v213
v_cmpx_lt_i32 vcc, 82, v32
ds_write_b32 v150, v214
v_cmpx_lt_i32 vcc, 83, v32
ds_write_b32 v151, v215
v_cmpx_lt_i32 vcc, 96, v32
s_cbranch_execz LE_w
ds_write_b32 v152, v216
v_cmpx_lt_i32 vcc, 97, v32
ds_write_b32 v153, v217
v_cmpx_lt_i32 vcc, 98, v32
ds_write_b32 v154, v218
v_cmpx_lt_i32 vcc, 99, v32
ds_write_b32 v155, v219
v_cmpx_lt_i32 vcc, 112, v32
s_cbranch_execz LE_w
ds_write_b32 v156, v220
v_cmpx_lt_i32 vcc, 113, v32
ds_write_b32 v157, v221
v_cmpx_lt_i32 vcc, 114, v32
ds_write_b32 v158, v222
v_cmpx_lt_i32 vcc, 115, v32
ds_write_b32 v159, v223
v_cmpx_lt_i32 vcc, 128, v32
s_cbranch_execz LE_w
ds_write_b32 v160, v224
v_cmpx_lt_i32 vcc, 129, v32
ds_write_b32 v161, v225
v_cmpx_lt_i32 vcc, 130, v32
ds_write_b32 v162, v226
v_cmpx_lt_i32 vcc, 131, v32
ds_write_b32 v163, v227
v_cmpx_lt_i32 vcc, 144, v32
s_cbranch_execz LE_w
ds_write_b32 v164, v228
v_cmpx_lt_i32 vcc, 145, v32
ds_write_b32 v165, v229
v_cmpx_lt_i32 vcc, 146, v32
ds_write_b32 v166, v230
v_cmpx_lt_i32 vcc, 147, v32
ds_write_b32 v167, v231
v_cmpx_lt_i32 vcc, 160, v32
s_cbranch_execz LE_w
ds_write_b32 v168, v232
v_cmpx_lt_i32 vcc, 161, v32
ds_write_b32 v169, v233
v_cmpx_lt_i32 vcc, 162, v32
ds_write_b32 v170, v234
v_cmpx_lt_i32 vcc, 163, v32
ds_write_b32 v171, v235
v_cmpx_lt_i32 vcc, 176, v32
s_cbranch_execz LE_w
ds_write_b32 v172, v236
v_cmpx_lt_i32 vcc, 177, v32
ds_write_b32 v173, v237
v_cmpx_lt_i32 vcc, 178, v32
ds_write_b32 v174, v238
v_cmpx_lt_i32 vcc, 179, v32
ds_write_b32 v175, v239
v_cmpx_lt_i32 vcc, 192, v32
s_cbranch_execz LE_w
ds_write_b32 v176, v240
v_cmpx_lt_i32 vcc, 193, v32
ds_write_b32 v177, v241
v_cmpx_lt_i32 vcc, 194, v32
ds_write_b32 v178, v242
v_cmpx_lt_i32 vcc, 195, v32
ds_write_b32 v179, v243
v_cmpx_lt_i32 vcc, 208, v32
s_cbranch_execz LE_w
ds_write_b32 v180, v244
v_cmpx_lt_i32 vcc, 209, v32
ds_write_b32 v181, v245
v_cmpx_lt_i32 vcc, 210, v32
ds_write_b32 v182, v246
v_cmpx_lt_i32 vcc, 211, v32
ds_write_b32 v183, v247
v_cmpx_lt_i32 vcc, 224, v32
s_cbranch_execz LE_w
ds_write_b32 v184, v248
v_cmpx_lt_i32 vcc, 225, v32
ds_write_b32 v185, v249
v_cmpx_lt_i32 vcc, 226, v32
ds_write_b32 v186, v250
v_cmpx_lt_i32 vcc, 227, v32
ds_write_b32 v187, v251
v_cmpx_lt_i32 vcc, 240, v32
s_cbranch_execz LE_w
ds_write_b32 v188, v252
v_cmpx_lt_i32 vcc, 241, v32
ds_write_b32 v189, v253
v_cmpx_lt_i32 vcc, 242, v32
ds_write_b32 v190, v254
v_cmpx_lt_i32 vcc, 243, v32
ds_write_b32 v191, v255
LE_w:
s_mov_b64 exec, -1
s_add_u32 s8, s4, 0x7c2a000
s_addc_u32 s9, s5, 0
s_mov_b32 s10, 0x8000
s_mov_b32 s11, 0x00020000
v_and_b32 v200, 63, v0
v_lshlrev_b32 v200, 7, v200
s_mov_b32 s91, 8192
s_mov_b32 s90, 16384
s_mov_b32 s95, 24576
s_mov_b32 s94, 0x10000
LE_poll:
buffer_load_dwordx2 v[192:193], v200, s[8:11], 0 offen sc1
buffer_load_dwordx2 v[194:195], v200, s[8:11], s91 offen sc1
buffer_load_dwordx2 v[196:197], v200, s[8:11], s90 offen sc1
buffer_load_dwordx2 v[198:199], v200, s[8:11], s95 offen sc1
s_sub_u32 s94, s94, 1
s_waitcnt vmcnt(0)
s_cbranch_scc1 LE_poll_go
v_cmp_ne_u64 vcc, s[98:99], v[192:193]
s_nop 1
s_cbranch_vccnz LE_poll
v_cmp_ne_u64 vcc, s[98:99], v[194:195]
s_nop 1
s_cbranch_vccnz LE_poll
v_cmp_ne_u64 vcc, s[98:99], v[196:197]
s_nop 1
s_cbranch_vccnz LE_poll
v_cmp_ne_u64 vcc, s[98:99], v[198:199]
s_nop 1
s_cbranch_vccnz LE_poll
LE_poll_go:
s_cmp_lg_u32 s40, 0
s_cbranch_scc1 LE_nobump
s_mov_b32 s90, 89984
s_mov_b32 s10, 90112
v_mov_b32 v192, s98
v_mov_b32 v193, s99
s_mov_b64 exec, 1
buffer_store_dwordx2 v[192:193], off, s[8:11], s90 sc1
s_mov_b64 exec, -1
LE_nobump:
v_mov_b32 v34, v38
ds_read2_b32 v[52:53], v34 offset0:0 offset1:4
ds_read2_b32 v[54:55], v34 offset0:8 offset1:12
s_waitcnt lgkmcnt(0)
ds_read2_b32 v[56:57], v34 offset0:16 offset1:20
ds_read2_b32 v[58:59], v34 offset0:24 offset1:28
v_mad_u32_u16 v60, v52, s49, v2
v_mad_u32_u16 v61, v53, s49, v2
v_mad_u32_u16 v62, v54, s49, v2
v_mad_u32_u16 v63, v55, s49, v2
buffer_load_dwordx4 a[0:3], v60, s[16:19], 0 offen sc1
buffer_load_dwordx4 a[4:7], v60, s[16:19], 0 offen offset:256 sc1
buffer_load_dwordx4 a[8:11], v61, s[16:19], 0 offen sc1
buffer_load_dwordx4 a[12:15], v61, s[16:19], 0 offen offset:256 sc1
buffer_load_dwordx4 a[16:19], v62, s[16:19], 0 offen sc1
buffer_load_dwordx4 a[20:23], v62, s[16:19], 0 offen offset:256 sc1
buffer_load_dwordx4 a[24:27], v63, s[16:19], 0 offen sc1
buffer_load_dwordx4 a[28:31], v63, s[16:19], 0 offen offset:256 sc1
s_waitcnt lgkmcnt(0)
ds_read2_b32 v[52:53], v34 offset0:32 offset1:36
ds_read2_b32 v[54:55], v34 offset0:40 offset1:44
v_mad_u32_u16 v60, v56, s49, v2
v_mad_u32_u16 v61, v57, s49, v2
v_mad_u32_u16 v62, v58, s49, v2
v_mad_u32_u16 v63, v59, s49, v2
buffer_load_dwordx4 a[32:35], v60, s[16:19], 0 offen sc1
buffer_load_dwordx4 a[36:39], v60, s[16:19], 0 offen offset:256 sc1
buffer_load_dwordx4 a[40:43], v61, s[16:19], 0 offen sc1
buffer_load_dwordx4 a[44:47], v61, s[16:19], 0 offen offset:256 sc1
buffer_load_dwordx4 a[48:51], v62, s[16:19], 0 offen sc1
buffer_load_dwordx4 a[52:55], v62, s[16:19], 0 offen offset:256 sc1
buffer_load_dwordx4 a[56:59], v63, s[16:19], 0 offen sc1
buffer_load_dwordx4 a[60:63], v63, s[16:19], 0 offen offset:256 sc1
s_waitcnt lgkmcnt(0)
ds_read2_b32 v[56:57], v34 offset0:48 offset1:52
ds_read2_b32 v[58:59], v34 offset0:56 offset1:60
v_mad_u32_u16 v60, v52, s49, v2
v_mad_u32_u16 v61, v53, s49, v2
v_mad_u32_u16 v62, v54, s49, v2
v_mad_u32_u16 v63, v55, s49, v2
buffer_load_dwordx4 a[64:67], v60, s[16:19], 0 offen sc1
buffer_load_dwordx4 a[68:71], v60, s[16:19], 0 offen offset:256 sc1
buffer_load_dwordx4 a[72:75], v61, s[16:19], 0 offen sc1
buffer_load_dwordx4 a[76:79], v61, s[16:19], 0 offen offset:256 sc1
buffer_load_dwordx4 a[80:83], v62, s[16:19], 0 offen sc1
buffer_load_dwordx4 a[84:87], v62, s[16:19], 0 offen offset:256 sc1
buffer_load_dwordx4 a[88:91], v63, s[16:19], 0 offen sc1
buffer_load_dwordx4 a[92:95], v63, s[16:19], 0 offen offset:256 sc1
s_waitcnt lgkmcnt(0)
ds_read2_b32 v[52:53], v34 offset0:64 offset1:68
ds_read2_b32 v[54:55], v34 offset0:72 offset1:76
v_mad_u32_u16 v60, v56, s49, v2
v_mad_u32_u16 v61, v57, s49, v2
v_mad_u32_u16 v62, v58, s49, v2
v_mad_u32_u16 v63, v59, s49, v2
buffer_load_dwordx4 a[96:99], v60, s[16:19], 0 offen sc1
buffer_load_dwordx4 a[100:103], v60, s[16:19], 0 offen offset:256 sc1
buffer_load_dwordx4 a[104:107], v61, s[16:19], 0 offen sc1
buffer_load_dwordx4 a[108:111], v61, s[16:19], 0 offen offset:256 sc1
buffer_load_dwordx4 a[112:115], v62, s[16:19], 0 offen sc1
buffer_load_dwordx4 a[116:119], v62, s[16:19], 0 offen offset:256 sc1
buffer_load_dwordx4 a[120:123], v63, s[16:19], 0 offen sc1
buffer_load_dwordx4 a[124:127], v63, s[16:19], 0 offen offset:256 sc1
s_waitcnt lgkmcnt(0)
ds_read2_b32 v[56:57], v34 offset0:80 offset1:84
ds_read2_b32 v[58:59], v34 offset0:88 offset1:92
v_mad_u32_u16 v60, v52, s49, v2
v_mad_u32_u16 v61, v53, s49, v2
v_mad_u32_u16 v62, v54, s49, v2
v_mad_u32_u16 v63, v55, s49, v2
buffer_load_dwordx4 a[128:131], v60, s[16:19], 0 offen sc1
buffer_load_dwordx4 a[132:135], v60, s[16:19], 0 offen offset:256 sc1
buffer_load_dwordx4 a[136:139], v61, s[16:19], 0 offen sc1
buffer_load_dwordx4 a[140:143], v61, s[16:19], 0 offen offset:256 sc1
buffer_load_dwordx4 a[144:147], v62, s[16:19], 0 offen sc1
buffer_load_dwordx4 a[148:151], v62, s[16:19], 0 offen offset:256 sc1
buffer_load_dwordx4 a[152:155], v63, s[16:19], 0 offen sc1
buffer_load_dwordx4 a[156:159], v63, s[16:19], 0 offen offset:256 sc1
s_waitcnt lgkmcnt(0)
ds_read2_b32 v[52:53], v34 offset0:96 offset1:100
ds_read2_b32 v[54:55], v34 offset0:104 offset1:108
v_mad_u32_u16 v60, v56, s49, v2
v_mad_u32_u16 v61, v57, s49, v2
v_mad_u32_u16 v62, v58, s49, v2
v_mad_u32_u16 v63, v59, s49, v2
buffer_load_dwordx4 a[160:163], v60, s[16:19], 0 offen sc1
buffer_load_dwordx4 a[164:167], v60, s[16:19], 0 offen offset:256 sc1
buffer_load_dwordx4 a[168:171], v61, s[16:19], 0 offen sc1
buffer_load_dwordx4 a[172:175], v61, s[16:19], 0 offen offset:256 sc1
buffer_load_dwordx4 a[176:179], v62, s[16:19], 0 offen sc1
buffer_load_dwordx4 a[180:183], v62, s[16:19], 0 offen offset:256 sc1
buffer_load_dwordx4 a[184:187], v63, s[16:19], 0 offen sc1
buffer_load_dwordx4 a[188:191], v63, s[16:19], 0 offen offset:256 sc1
s_waitcnt lgkmcnt(0)
ds_read2_b32 v[56:57], v34 offset0:112 offset1:116
ds_read2_b32 v[58:59], v34 offset0:120 offset1:124
v_mad_u32_u16 v60, v52, s49, v2
v_mad_u32_u16 v61, v53, s49, v2
v_mad_u32_u16 v62, v54, s49, v2
v_mad_u32_u16 v63, v55, s49, v2
buffer_load_dwordx4 a[192:195], v60, s[16:19], 0 offen sc1
buffer_load_dwordx4 a[196:199], v60, s[16:19], 0 offen offset:256 sc1
buffer_load_dwordx4 a[200:203], v61, s[16:19], 0 offen sc1
buffer_load_dwordx4 a[204:207], v61, s[16:19], 0 offen offset:256 sc1
buffer_load_dwordx4 a[208:211], v62, s[16:19], 0 offen sc1
buffer_load_dwordx4 a[212:215], v62, s[16:19], 0 offen offset:256 sc1
buffer_load_dwordx4 a[216:219], v63, s[16:19], 0 offen sc1
buffer_load_dwordx4 a[220:223], v63, s[16:19], 0 offen offset:256 sc1
s_waitcnt lgkmcnt(0)
ds_read2_b32 v[52:53], v34 offset0:128 offset1:132
ds_read2_b32 v[54:55], v34 offset0:136 offset1:140
v_mad_u32_u16 v60, v56, s49, v2
v_mad_u32_u16 v61, v57, s49, v2
v_mad_u32_u16 v62, v58, s49, v2
v_mad_u32_u16 v63, v59, s49, v2
buffer_load_dwordx4 a[224:227], v60, s[16:19], 0 offen sc1
buffer_load_dwordx4 a[228:231], v60, s[16:19], 0 offen offset:256 sc1
buffer_load_dwordx4 a[232:235], v61, s[16:19], 0 offen sc1
buffer_load_dwordx4 a[236:239], v61, s[16:19], 0 offen offset:256 sc1
buffer_load_dwordx4 a[240:243], v62, s[16:19], 0 offen sc1
buffer_load_dwordx4 a[244:247], v62, s[16:19], 0 offen offset:256 sc1
buffer_load_dwordx4 a[248:251], v63, s[16:19], 0 offen sc1
buffer_load_dwordx4 a[252:255], v63, s[16:19], 0 offen offset:256 sc1
v_add_u32 v34, 512, v34
s_mov_b32 s45, 0
s_lshl_b32 s47, s55, 9
LE_loop:
v_readlane_b32 s46, v37, s45
s_add_u32 s45, s45, 1
s_waitcnt vmcnt(56)
v_mfma_f32_16x16x32_bf16 v[48:51], a[0:3], v[40:43], v[48:51]
v_mfma_f32_16x16x32_bf16 v[48:51], a[4:7], v[44:47], v[48:51]
s_bitcmp1_b32 s46, 0
s_cbranch_scc0 LE_nf0
s_cmp_eq_u32 s42, 0
s_cbranch_scc1 LE_fl0
buffer_load_dwordx2 v[66:67], v39, s[20:23], s47 offen sc1
s_waitcnt vmcnt(0)
v_lshlrev_b32 v64, 16, v66
v_and_b32 v65, 0xffff0000, v66
v_add_f32 v48, v48, v64
v_add_f32 v49, v49, v65
v_lshlrev_b32 v64, 16, v67
v_and_b32 v65, 0xffff0000, v67
v_add_f32 v50, v50, v64
v_add_f32 v51, v51, v65
LE_fl0:
s_nop 3
v_cvt_pk_bf16_f32 v64, v48, v49
v_cvt_pk_bf16_f32 v65, v50, v51
v_mov_b32 v48, 0
v_mov_b32 v49, 0
v_mov_b32 v50, 0
v_mov_b32 v51, 0
buffer_store_dwordx2 v[64:65], v39, s[20:23], s47 offen sc1
s_add_u32 s47, s47, 512
LE_nf0:
v_mfma_f32_16x16x32_bf16 v[48:51], a[8:11], v[40:43], v[48:51]
v_mfma_f32_16x16x32_bf16 v[48:51], a[12:15], v[44:47], v[48:51]
s_bitcmp1_b32 s46, 1
s_cbranch_scc0 LE_nf1
s_cmp_eq_u32 s42, 0
s_cbranch_scc1 LE_fl1
buffer_load_dwordx2 v[66:67], v39, s[20:23], s47 offen sc1
s_waitcnt vmcnt(0)
v_lshlrev_b32 v64, 16, v66
v_and_b32 v65, 0xffff0000, v66
v_add_f32 v48, v48, v64
v_add_f32 v49, v49, v65
v_lshlrev_b32 v64, 16, v67
v_and_b32 v65, 0xffff0000, v67
v_add_f32 v50, v50, v64
v_add_f32 v51, v51, v65
LE_fl1:
s_nop 3
v_cvt_pk_bf16_f32 v64, v48, v49
v_cvt_pk_bf16_f32 v65, v50, v51
v_mov_b32 v48, 0
v_mov_b32 v49, 0
v_mov_b32 v50, 0
v_mov_b32 v51, 0
buffer_store_dwordx2 v[64:65], v39, s[20:23], s47 offen sc1
s_add_u32 s47, s47, 512
LE_nf1:
v_mfma_f32_16x16x32_bf16 v[48:51], a[16:19], v[40:43], v[48:51]
v_mfma_f32_16x16x32_bf16 v[48:51], a[20:23], v[44:47], v[48:51]
s_bitcmp1_b32 s46, 2
s_cbranch_scc0 LE_nf2
s_cmp_eq_u32 s42, 0
s_cbranch_scc1 LE_fl2
buffer_load_dwordx2 v[66:67], v39, s[20:23], s47 offen sc1
s_waitcnt vmcnt(0)
v_lshlrev_b32 v64, 16, v66
v_and_b32 v65, 0xffff0000, v66
v_add_f32 v48, v48, v64
v_add_f32 v49, v49, v65
v_lshlrev_b32 v64, 16, v67
v_and_b32 v65, 0xffff0000, v67
v_add_f32 v50, v50, v64
v_add_f32 v51, v51, v65
LE_fl2:
s_nop 3
v_cvt_pk_bf16_f32 v64, v48, v49
v_cvt_pk_bf16_f32 v65, v50, v51
v_mov_b32 v48, 0
v_mov_b32 v49, 0
v_mov_b32 v50, 0
v_mov_b32 v51, 0
buffer_store_dwordx2 v[64:65], v39, s[20:23], s47 offen sc1
s_add_u32 s47, s47, 512
LE_nf2:
v_mfma_f32_16x16x32_bf16 v[48:51], a[24:27], v[40:43], v[48:51]
v_mfma_f32_16x16x32_bf16 v[48:51], a[28:31], v[44:47], v[48:51]
s_bitcmp1_b32 s46, 3
s_cbranch_scc0 LE_nf3
s_cmp_eq_u32 s42, 0
s_cbranch_scc1 LE_fl3
buffer_load_dwordx2 v[66:67], v39, s[20:23], s47 offen sc1
s_waitcnt vmcnt(0)
v_lshlrev_b32 v64, 16, v66
v_and_b32 v65, 0xffff0000, v66
v_add_f32 v48, v48, v64
v_add_f32 v49, v49, v65
v_lshlrev_b32 v64, 16, v67
v_and_b32 v65, 0xffff0000, v67
v_add_f32 v50, v50, v64
v_add_f32 v51, v51, v65
LE_fl3:
s_nop 3
v_cvt_pk_bf16_f32 v64, v48, v49
v_cvt_pk_bf16_f32 v65, v50, v51
v_mov_b32 v48, 0
v_mov_b32 v49, 0
v_mov_b32 v50, 0
v_mov_b32 v51, 0
buffer_store_dwordx2 v[64:65], v39, s[20:23], s47 offen sc1
s_add_u32 s47, s47, 512
LE_nf3:
s_waitcnt lgkmcnt(0)
ds_read2_b32 v[56:57], v34 offset0:16 offset1:20
ds_read2_b32 v[58:59], v34 offset0:24 offset1:28
v_mad_u32_u16 v60, v52, s49, v2
v_mad_u32_u16 v61, v53, s49, v2
v_mad_u32_u16 v62, v54, s49, v2
v_mad_u32_u16 v63, v55, s49, v2
buffer_load_dwordx4 a[0:3], v60, s[16:19], 0 offen sc1
buffer_load_dwordx4 a[4:7], v60, s[16:19], 0 offen offset:256 sc1
buffer_load_dwordx4 a[8:11], v61, s[16:19], 0 offen sc1
buffer_load_dwordx4 a[12:15], v61, s[16:19], 0 offen offset:256 sc1
buffer_load_dwordx4 a[16:19], v62, s[16:19], 0 offen sc1
buffer_load_dwordx4 a[20:23], v62, s[16:19], 0 offen offset:256 sc1
buffer_load_dwordx4 a[24:27], v63, s[16:19], 0 offen sc1
buffer_load_dwordx4 a[28:31], v63, s[16:19], 0 offen offset:256 sc1
s_waitcnt vmcnt(56)
v_mfma_f32_16x16x32_bf16 v[48:51], a[32:35], v[40:43], v[48:51]
v_mfma_f32_16x16x32_bf16 v[48:51], a[36:39], v[44:47], v[48:51]
s_bitcmp1_b32 s46, 4
s_cbranch_scc0 LE_nf4
s_cmp_eq_u32 s42, 0
s_cbranch_scc1 LE_fl4
buffer_load_dwordx2 v[66:67], v39, s[20:23], s47 offen sc1
s_waitcnt vmcnt(0)
v_lshlrev_b32 v64, 16, v66
v_and_b32 v65, 0xffff0000, v66
v_add_f32 v48, v48, v64
v_add_f32 v49, v49, v65
v_lshlrev_b32 v64, 16, v67
v_and_b32 v65, 0xffff0000, v67
v_add_f32 v50, v50, v64
v_add_f32 v51, v51, v65
LE_fl4:
s_nop 3
v_cvt_pk_bf16_f32 v64, v48, v49
v_cvt_pk_bf16_f32 v65, v50, v51
v_mov_b32 v48, 0
v_mov_b32 v49, 0
v_mov_b32 v50, 0
v_mov_b32 v51, 0
buffer_store_dwordx2 v[64:65], v39, s[20:23], s47 offen sc1
s_add_u32 s47, s47, 512
LE_nf4:
v_mfma_f32_16x16x32_bf16 v[48:51], a[40:43], v[40:43], v[48:51]
v_mfma_f32_16x16x32_bf16 v[48:51], a[44:47], v[44:47], v[48:51]
s_bitcmp1_b32 s46, 5
s_cbranch_scc0 LE_nf5
s_cmp_eq_u32 s42, 0
s_cbranch_scc1 LE_fl5
buffer_load_dwordx2 v[66:67], v39, s[20:23], s47 offen sc1
s_waitcnt vmcnt(0)
v_lshlrev_b32 v64, 16, v66
v_and_b32 v65, 0xffff0000, v66
v_add_f32 v48, v48, v64
v_add_f32 v49, v49, v65
v_lshlrev_b32 v64, 16, v67
v_and_b32 v65, 0xffff0000, v67
v_add_f32 v50, v50, v64
v_add_f32 v51, v51, v65
LE_fl5:
s_nop 3
v_cvt_pk_bf16_f32 v64, v48, v49
v_cvt_pk_bf16_f32 v65, v50, v51
v_mov_b32 v48, 0
v_mov_b32 v49, 0
v_mov_b32 v50, 0
v_mov_b32 v51, 0
buffer_store_dwordx2 v[64:65], v39, s[20:23], s47 offen sc1
s_add_u32 s47, s47, 512
LE_nf5:
v_mfma_f32_16x16x32_bf16 v[48:51], a[48:51], v[40:43], v[48:51]
v_mfma_f32_16x16x32_bf16 v[48:51], a[52:55], v[44:47], v[48:51]
s_bitcmp1_b32 s46, 6
s_cbranch_scc0 LE_nf6
s_cmp_eq_u32 s42, 0
s_cbranch_scc1 LE_fl6
buffer_load_dwordx2 v[66:67], v39, s[20:23], s47 offen sc1
s_waitcnt vmcnt(0)
v_lshlrev_b32 v64, 16, v66
v_and_b32 v65, 0xffff0000, v66
v_add_f32 v48, v48, v64
v_add_f32 v49, v49, v65
v_lshlrev_b32 v64, 16, v67
v_and_b32 v65, 0xffff0000, v67
v_add_f32 v50, v50, v64
v_add_f32 v51, v51, v65
LE_fl6:
s_nop 3
v_cvt_pk_bf16_f32 v64, v48, v49
v_cvt_pk_bf16_f32 v65, v50, v51
v_mov_b32 v48, 0
v_mov_b32 v49, 0
v_mov_b32 v50, 0
v_mov_b32 v51, 0
buffer_store_dwordx2 v[64:65], v39, s[20:23], s47 offen sc1
s_add_u32 s47, s47, 512
LE_nf6:
v_mfma_f32_16x16x32_bf16 v[48:51], a[56:59], v[40:43], v[48:51]
v_mfma_f32_16x16x32_bf16 v[48:51], a[60:63], v[44:47], v[48:51]
s_bitcmp1_b32 s46, 7
s_cbranch_scc0 LE_nf7
s_cmp_eq_u32 s42, 0
s_cbranch_scc1 LE_fl7
buffer_load_dwordx2 v[66:67], v39, s[20:23], s47 offen sc1
s_waitcnt vmcnt(0)
v_lshlrev_b32 v64, 16, v66
v_and_b32 v65, 0xffff0000, v66
v_add_f32 v48, v48, v64
v_add_f32 v49, v49, v65
v_lshlrev_b32 v64, 16, v67
v_and_b32 v65, 0xffff0000, v67
v_add_f32 v50, v50, v64
v_add_f32 v51, v51, v65
LE_fl7:
s_nop 3
v_cvt_pk_bf16_f32 v64, v48, v49
v_cvt_pk_bf16_f32 v65, v50, v51
v_mov_b32 v48, 0
v_mov_b32 v49, 0
v_mov_b32 v50, 0
v_mov_b32 v51, 0
buffer_store_dwordx2 v[64:65], v39, s[20:23], s47 offen sc1
s_add_u32 s47, s47, 512
LE_nf7:
s_waitcnt lgkmcnt(0)
ds_read2_b32 v[52:53], v34 offset0:32 offset1:36
ds_read2_b32 v[54:55], v34 offset0:40 offset1:44
v_mad_u32_u16 v60, v56, s49, v2
v_mad_u32_u16 v61, v57, s49, v2
v_mad_u32_u16 v62, v58, s49, v2
v_mad_u32_u16 v63, v59, s49, v2
buffer_load_dwordx4 a[32:35], v60, s[16:19], 0 offen sc1
buffer_load_dwordx4 a[36:39], v60, s[16:19], 0 offen offset:256 sc1
buffer_load_dwordx4 a[40:43], v61, s[16:19], 0 offen sc1
buffer_load_dwordx4 a[44:47], v61, s[16:19], 0 offen offset:256 sc1
buffer_load_dwordx4 a[48:51], v62, s[16:19], 0 offen sc1
buffer_load_dwordx4 a[52:55], v62, s[16:19], 0 offen offset:256 sc1
buffer_load_dwordx4 a[56:59], v63, s[16:19], 0 offen sc1
buffer_load_dwordx4 a[60:63], v63, s[16:19], 0 offen offset:256 sc1
s_waitcnt vmcnt(56)
v_mfma_f32_16x16x32_bf16 v[48:51], a[64:67], v[40:43], v[48:51]
v_mfma_f32_16x16x32_bf16 v[48:51], a[68:71], v[44:47], v[48:51]
s_bitcmp1_b32 s46, 8
s_cbranch_scc0 LE_nf8
s_cmp_eq_u32 s42, 0
s_cbranch_scc1 LE_fl8
buffer_load_dwordx2 v[66:67], v39, s[20:23], s47 offen sc1
s_waitcnt vmcnt(0)
v_lshlrev_b32 v64, 16, v66
v_and_b32 v65, 0xffff0000, v66
v_add_f32 v48, v48, v64
v_add_f32 v49, v49, v65
v_lshlrev_b32 v64, 16, v67
v_and_b32 v65, 0xffff0000, v67
v_add_f32 v50, v50, v64
v_add_f32 v51, v51, v65
LE_fl8:
s_nop 3
v_cvt_pk_bf16_f32 v64, v48, v49
v_cvt_pk_bf16_f32 v65, v50, v51
v_mov_b32 v48, 0
v_mov_b32 v49, 0
v_mov_b32 v50, 0
v_mov_b32 v51, 0
buffer_store_dwordx2 v[64:65], v39, s[20:23], s47 offen sc1
s_add_u32 s47, s47, 512
LE_nf8:
v_mfma_f32_16x16x32_bf16 v[48:51], a[72:75], v[40:43], v[48:51]
v_mfma_f32_16x16x32_bf16 v[48:51], a[76:79], v[44:47], v[48:51]
s_bitcmp1_b32 s46, 9
s_cbranch_scc0 LE_nf9
s_cmp_eq_u32 s42, 0
s_cbranch_scc1 LE_fl9
buffer_load_dwordx2 v[66:67], v39, s[20:23], s47 offen sc1
s_waitcnt vmcnt(0)
v_lshlrev_b32 v64, 16, v66
v_and_b32 v65, 0xffff0000, v66
v_add_f32 v48, v48, v64
v_add_f32 v49, v49, v65
v_lshlrev_b32 v64, 16, v67
v_and_b32 v65, 0xffff0000, v67
v_add_f32 v50, v50, v64
v_add_f32 v51, v51, v65
LE_fl9:
s_nop 3
v_cvt_pk_bf16_f32 v64, v48, v49
v_cvt_pk_bf16_f32 v65, v50, v51
v_mov_b32 v48, 0
v_mov_b32 v49, 0
v_mov_b32 v50, 0
v_mov_b32 v51, 0
buffer_store_dwordx2 v[64:65], v39, s[20:23], s47 offen sc1
s_add_u32 s47, s47, 512
LE_nf9:
v_mfma_f32_16x16x32_bf16 v[48:51], a[80:83], v[40:43], v[48:51]
v_mfma_f32_16x16x32_bf16 v[48:51], a[84:87], v[44:47], v[48:51]
s_bitcmp1_b32 s46, 10
s_cbranch_scc0 LE_nf10
s_cmp_eq_u32 s42, 0
s_cbranch_scc1 LE_fl10
buffer_load_dwordx2 v[66:67], v39, s[20:23], s47 offen sc1
s_waitcnt vmcnt(0)
v_lshlrev_b32 v64, 16, v66
v_and_b32 v65, 0xffff0000, v66
v_add_f32 v48, v48, v64
v_add_f32 v49, v49, v65
v_lshlrev_b32 v64, 16, v67
v_and_b32 v65, 0xffff0000, v67
v_add_f32 v50, v50, v64
v_add_f32 v51, v51, v65
LE_fl10:
s_nop 3
v_cvt_pk_bf16_f32 v64, v48, v49
v_cvt_pk_bf16_f32 v65, v50, v51
v_mov_b32 v48, 0
v_mov_b32 v49, 0
v_mov_b32 v50, 0
v_mov_b32 v51, 0
buffer_store_dwordx2 v[64:65], v39, s[20:23], s47 offen sc1
s_add_u32 s47, s47, 512
LE_nf10:
v_mfma_f32_16x16x32_bf16 v[48:51], a[88:91], v[40:43], v[48:51]
v_mfma_f32_16x16x32_bf16 v[48:51], a[92:95], v[44:47], v[48:51]
s_bitcmp1_b32 s46, 11
s_cbranch_scc0 LE_nf11
s_cmp_eq_u32 s42, 0
s_cbranch_scc1 LE_fl11
buffer_load_dwordx2 v[66:67], v39, s[20:23], s47 offen sc1
s_waitcnt vmcnt(0)
v_lshlrev_b32 v64, 16, v66
v_and_b32 v65, 0xffff0000, v66
v_add_f32 v48, v48, v64
v_add_f32 v49, v49, v65
v_lshlrev_b32 v64, 16, v67
v_and_b32 v65, 0xffff0000, v67
v_add_f32 v50, v50, v64
v_add_f32 v51, v51, v65
LE_fl11:
s_nop 3
v_cvt_pk_bf16_f32 v64, v48, v49
v_cvt_pk_bf16_f32 v65, v50, v51
v_mov_b32 v48, 0
v_mov_b32 v49, 0
v_mov_b32 v50, 0
v_mov_b32 v51, 0
buffer_store_dwordx2 v[64:65], v39, s[20:23], s47 offen sc1
s_add_u32 s47, s47, 512
LE_nf11:
s_waitcnt lgkmcnt(0)
ds_read2_b32 v[56:57], v34 offset0:48 offset1:52
ds_read2_b32 v[58:59], v34 offset0:56 offset1:60
v_mad_u32_u16 v60, v52, s49, v2
v_mad_u32_u16 v61, v53, s49, v2
v_mad_u32_u16 v62, v54, s49, v2
v_mad_u32_u16 v63, v55, s49, v2
buffer_load_dwordx4 a[64:67], v60, s[16:19], 0 offen sc1
buffer_load_dwordx4 a[68:71], v60, s[16:19], 0 offen offset:256 sc1
buffer_load_dwordx4 a[72:75], v61, s[16:19], 0 offen sc1
buffer_load_dwordx4 a[76:79], v61, s[16:19], 0 offen offset:256 sc1
buffer_load_dwordx4 a[80:83], v62, s[16:19], 0 offen sc1
buffer_load_dwordx4 a[84:87], v62, s[16:19], 0 offen offset:256 sc1
buffer_load_dwordx4 a[88:91], v63, s[16:19], 0 offen sc1
buffer_load_dwordx4 a[92:95], v63, s[16:19], 0 offen offset:256 sc1
s_waitcnt vmcnt(56)
v_mfma_f32_16x16x32_bf16 v[48:51], a[96:99], v[40:43], v[48:51]
v_mfma_f32_16x16x32_bf16 v[48:51], a[100:103], v[44:47], v[48:51]
s_bitcmp1_b32 s46, 12
s_cbranch_scc0 LE_nf12
s_cmp_eq_u32 s42, 0
s_cbranch_scc1 LE_fl12
buffer_load_dwordx2 v[66:67], v39, s[20:23], s47 offen sc1
s_waitcnt vmcnt(0)
v_lshlrev_b32 v64, 16, v66
v_and_b32 v65, 0xffff0000, v66
v_add_f32 v48, v48, v64
v_add_f32 v49, v49, v65
v_lshlrev_b32 v64, 16, v67
v_and_b32 v65, 0xffff0000, v67
v_add_f32 v50, v50, v64
v_add_f32 v51, v51, v65
LE_fl12:
s_nop 3
v_cvt_pk_bf16_f32 v64, v48, v49
v_cvt_pk_bf16_f32 v65, v50, v51
v_mov_b32 v48, 0
v_mov_b32 v49, 0
v_mov_b32 v50, 0
v_mov_b32 v51, 0
buffer_store_dwordx2 v[64:65], v39, s[20:23], s47 offen sc1
s_add_u32 s47, s47, 512
LE_nf12:
v_mfma_f32_16x16x32_bf16 v[48:51], a[104:107], v[40:43], v[48:51]
v_mfma_f32_16x16x32_bf16 v[48:51], a[108:111], v[44:47], v[48:51]
s_bitcmp1_b32 s46, 13
s_cbranch_scc0 LE_nf13
s_cmp_eq_u32 s42, 0
s_cbranch_scc1 LE_fl13
buffer_load_dwordx2 v[66:67], v39, s[20:23], s47 offen sc1
s_waitcnt vmcnt(0)
v_lshlrev_b32 v64, 16, v66
v_and_b32 v65, 0xffff0000, v66
v_add_f32 v48, v48, v64
v_add_f32 v49, v49, v65
v_lshlrev_b32 v64, 16, v67
v_and_b32 v65, 0xffff0000, v67
v_add_f32 v50, v50, v64
v_add_f32 v51, v51, v65
LE_fl13:
s_nop 3
v_cvt_pk_bf16_f32 v64, v48, v49
v_cvt_pk_bf16_f32 v65, v50, v51
v_mov_b32 v48, 0
v_mov_b32 v49, 0
v_mov_b32 v50, 0
v_mov_b32 v51, 0
buffer_store_dwordx2 v[64:65], v39, s[20:23], s47 offen sc1
s_add_u32 s47, s47, 512
LE_nf13:
v_mfma_f32_16x16x32_bf16 v[48:51], a[112:115], v[40:43], v[48:51]
v_mfma_f32_16x16x32_bf16 v[48:51], a[116:119], v[44:47], v[48:51]
s_bitcmp1_b32 s46, 14
s_cbranch_scc0 LE_nf14
s_cmp_eq_u32 s42, 0
s_cbranch_scc1 LE_fl14
buffer_load_dwordx2 v[66:67], v39, s[20:23], s47 offen sc1
s_waitcnt vmcnt(0)
v_lshlrev_b32 v64, 16, v66
v_and_b32 v65, 0xffff0000, v66
v_add_f32 v48, v48, v64
v_add_f32 v49, v49, v65
v_lshlrev_b32 v64, 16, v67
v_and_b32 v65, 0xffff0000, v67
v_add_f32 v50, v50, v64
v_add_f32 v51, v51, v65
LE_fl14:
s_nop 3
v_cvt_pk_bf16_f32 v64, v48, v49
v_cvt_pk_bf16_f32 v65, v50, v51
v_mov_b32 v48, 0
v_mov_b32 v49, 0
v_mov_b32 v50, 0
v_mov_b32 v51, 0
buffer_store_dwordx2 v[64:65], v39, s[20:23], s47 offen sc1
s_add_u32 s47, s47, 512
LE_nf14:
v_mfma_f32_16x16x32_bf16 v[48:51], a[120:123], v[40:43], v[48:51]
v_mfma_f32_16x16x32_bf16 v[48:51], a[124:127], v[44:47], v[48:51]
s_bitcmp1_b32 s46, 15
s_cbranch_scc0 LE_nf15
s_cmp_eq_u32 s42, 0
s_cbranch_scc1 LE_fl15
buffer_load_dwordx2 v[66:67], v39, s[20:23], s47 offen sc1
s_waitcnt vmcnt(0)
v_lshlrev_b32 v64, 16, v66
v_and_b32 v65, 0xffff0000, v66
v_add_f32 v48, v48, v64
v_add_f32 v49, v49, v65
v_lshlrev_b32 v64, 16, v67
v_and_b32 v65, 0xffff0000, v67
v_add_f32 v50, v50, v64
v_add_f32 v51, v51, v65
LE_fl15:
s_nop 3
v_cvt_pk_bf16_f32 v64, v48, v49
v_cvt_pk_bf16_f32 v65, v50, v51
v_mov_b32 v48, 0
v_mov_b32 v49, 0
v_mov_b32 v50, 0
v_mov_b32 v51, 0
buffer_store_dwordx2 v[64:65], v39, s[20:23], s47 offen sc1
s_add_u32 s47, s47, 512
LE_nf15:
s_waitcnt lgkmcnt(0)
ds_read2_b32 v[52:53], v34 offset0:64 offset1:68
ds_read2_b32 v[54:55], v34 offset0:72 offset1:76
v_mad_u32_u16 v60, v56, s49, v2
v_mad_u32_u16 v61, v57, s49, v2
v_mad_u32_u16 v62, v58, s49, v2
v_mad_u32_u16 v63, v59, s49, v2
buffer_load_dwordx4 a[96:99], v60, s[16:19], 0 offen sc1
buffer_load_dwordx4 a[100:103], v60, s[16:19], 0 offen offset:256 sc1
buffer_load_dwordx4 a[104:107], v61, s[16:19], 0 offen sc1
buffer_load_dwordx4 a[108:111], v61, s[16:19], 0 offen offset:256 sc1
buffer_load_dwordx4 a[112:115], v62, s[16:19], 0 offen sc1
buffer_load_dwordx4 a[116:119], v62, s[16:19], 0 offen offset:256 sc1
buffer_load_dwordx4 a[120:123], v63, s[16:19], 0 offen sc1
buffer_load_dwordx4 a[124:127], v63, s[16:19], 0 offen offset:256 sc1
s_waitcnt vmcnt(56)
v_mfma_f32_16x16x32_bf16 v[48:51], a[128:131], v[40:43], v[48:51]
v_mfma_f32_16x16x32_bf16 v[48:51], a[132:135], v[44:47], v[48:51]
s_bitcmp1_b32 s46, 16
s_cbranch_scc0 LE_nf16
s_cmp_eq_u32 s42, 0
s_cbranch_scc1 LE_fl16
buffer_load_dwordx2 v[66:67], v39, s[20:23], s47 offen sc1
s_waitcnt vmcnt(0)
v_lshlrev_b32 v64, 16, v66
v_and_b32 v65, 0xffff0000, v66
v_add_f32 v48, v48, v64
v_add_f32 v49, v49, v65
v_lshlrev_b32 v64, 16, v67
v_and_b32 v65, 0xffff0000, v67
v_add_f32 v50, v50, v64
v_add_f32 v51, v51, v65
LE_fl16:
s_nop 3
v_cvt_pk_bf16_f32 v64, v48, v49
v_cvt_pk_bf16_f32 v65, v50, v51
v_mov_b32 v48, 0
v_mov_b32 v49, 0
v_mov_b32 v50, 0
v_mov_b32 v51, 0
buffer_store_dwordx2 v[64:65], v39, s[20:23], s47 offen sc1
s_add_u32 s47, s47, 512
LE_nf16:
v_mfma_f32_16x16x32_bf16 v[48:51], a[136:139], v[40:43], v[48:51]
v_mfma_f32_16x16x32_bf16 v[48:51], a[140:143], v[44:47], v[48:51]
s_bitcmp1_b32 s46, 17
s_cbranch_scc0 LE_nf17
s_cmp_eq_u32 s42, 0
s_cbranch_scc1 LE_fl17
buffer_load_dwordx2 v[66:67], v39, s[20:23], s47 offen sc1
s_waitcnt vmcnt(0)
v_lshlrev_b32 v64, 16, v66
v_and_b32 v65, 0xffff0000, v66
v_add_f32 v48, v48, v64
v_add_f32 v49, v49, v65
v_lshlrev_b32 v64, 16, v67
v_and_b32 v65, 0xffff0000, v67
v_add_f32 v50, v50, v64
v_add_f32 v51, v51, v65
LE_fl17:
s_nop 3
v_cvt_pk_bf16_f32 v64, v48, v49
v_cvt_pk_bf16_f32 v65, v50, v51
v_mov_b32 v48, 0
v_mov_b32 v49, 0
v_mov_b32 v50, 0
v_mov_b32 v51, 0
buffer_store_dwordx2 v[64:65], v39, s[20:23], s47 offen sc1
s_add_u32 s47, s47, 512
LE_nf17:
v_mfma_f32_16x16x32_bf16 v[48:51], a[144:147], v[40:43], v[48:51]
v_mfma_f32_16x16x32_bf16 v[48:51], a[148:151], v[44:47], v[48:51]
s_bitcmp1_b32 s46, 18
s_cbranch_scc0 LE_nf18
s_cmp_eq_u32 s42, 0
s_cbranch_scc1 LE_fl18
buffer_load_dwordx2 v[66:67], v39, s[20:23], s47 offen sc1
s_waitcnt vmcnt(0)
v_lshlrev_b32 v64, 16, v66
v_and_b32 v65, 0xffff0000, v66
v_add_f32 v48, v48, v64
v_add_f32 v49, v49, v65
v_lshlrev_b32 v64, 16, v67
v_and_b32 v65, 0xffff0000, v67
v_add_f32 v50, v50, v64
v_add_f32 v51, v51, v65
LE_fl18:
s_nop 3
v_cvt_pk_bf16_f32 v64, v48, v49
v_cvt_pk_bf16_f32 v65, v50, v51
v_mov_b32 v48, 0
v_mov_b32 v49, 0
v_mov_b32 v50, 0
v_mov_b32 v51, 0
buffer_store_dwordx2 v[64:65], v39, s[20:23], s47 offen sc1
s_add_u32 s47, s47, 512
LE_nf18:
v_mfma_f32_16x16x32_bf16 v[48:51], a[152:155], v[40:43], v[48:51]
v_mfma_f32_16x16x32_bf16 v[48:51], a[156:159], v[44:47], v[48:51]
s_bitcmp1_b32 s46, 19
s_cbranch_scc0 LE_nf19
s_cmp_eq_u32 s42, 0
s_cbranch_scc1 LE_fl19
buffer_load_dwordx2 v[66:67], v39, s[20:23], s47 offen sc1
s_waitcnt vmcnt(0)
v_lshlrev_b32 v64, 16, v66
v_and_b32 v65, 0xffff0000, v66
v_add_f32 v48, v48, v64
v_add_f32 v49, v49, v65
v_lshlrev_b32 v64, 16, v67
v_and_b32 v65, 0xffff0000, v67
v_add_f32 v50, v50, v64
v_add_f32 v51, v51, v65
LE_fl19:
s_nop 3
v_cvt_pk_bf16_f32 v64, v48, v49
v_cvt_pk_bf16_f32 v65, v50, v51
v_mov_b32 v48, 0
v_mov_b32 v49, 0
v_mov_b32 v50, 0
v_mov_b32 v51, 0
buffer_store_dwordx2 v[64:65], v39, s[20:23], s47 offen sc1
s_add_u32 s47, s47, 512
LE_nf19:
s_waitcnt lgkmcnt(0)
ds_read2_b32 v[56:57], v34 offset0:80 offset1:84
ds_read2_b32 v[58:59], v34 offset0:88 offset1:92
v_mad_u32_u16 v60, v52, s49, v2
v_mad_u32_u16 v61, v53, s49, v2
v_mad_u32_u16 v62, v54, s49, v2
v_mad_u32_u16 v63, v55, s49, v2
buffer_load_dwordx4 a[128:131], v60, s[16:19], 0 offen sc1
buffer_load_dwordx4 a[132:135], v60, s[16:19], 0 offen offset:256 sc1
buffer_load_dwordx4 a[136:139], v61, s[16:19], 0 offen sc1
buffer_load_dwordx4 a[140:143], v61, s[16:19], 0 offen offset:256 sc1
buffer_load_dwordx4 a[144:147], v62, s[16:19], 0 offen sc1
buffer_load_dwordx4 a[148:151], v62, s[16:19], 0 offen offset:256 sc1
buffer_load_dwordx4 a[152:155], v63, s[16:19], 0 offen sc1
buffer_load_dwordx4 a[156:159], v63, s[16:19], 0 offen offset:256 sc1
s_waitcnt vmcnt(56)
v_mfma_f32_16x16x32_bf16 v[48:51], a[160:163], v[40:43], v[48:51]
v_mfma_f32_16x16x32_bf16 v[48:51], a[164:167], v[44:47], v[48:51]
s_bitcmp1_b32 s46, 20
s_cbranch_scc0 LE_nf20
s_cmp_eq_u32 s42, 0
s_cbranch_scc1 LE_fl20
buffer_load_dwordx2 v[66:67], v39, s[20:23], s47 offen sc1
s_waitcnt vmcnt(0)
v_lshlrev_b32 v64, 16, v66
v_and_b32 v65, 0xffff0000, v66
v_add_f32 v48, v48, v64
v_add_f32 v49, v49, v65
v_lshlrev_b32 v64, 16, v67
v_and_b32 v65, 0xffff0000, v67
v_add_f32 v50, v50, v64
v_add_f32 v51, v51, v65
LE_fl20:
s_nop 3
v_cvt_pk_bf16_f32 v64, v48, v49
v_cvt_pk_bf16_f32 v65, v50, v51
v_mov_b32 v48, 0
v_mov_b32 v49, 0
v_mov_b32 v50, 0
v_mov_b32 v51, 0
buffer_store_dwordx2 v[64:65], v39, s[20:23], s47 offen sc1
s_add_u32 s47, s47, 512
LE_nf20:
v_mfma_f32_16x16x32_bf16 v[48:51], a[168:171], v[40:43], v[48:51]
v_mfma_f32_16x16x32_bf16 v[48:51], a[172:175], v[44:47], v[48:51]
s_bitcmp1_b32 s46, 21
s_cbranch_scc0 LE_nf21
s_cmp_eq_u32 s42, 0
s_cbranch_scc1 LE_fl21
buffer_load_dwordx2 v[66:67], v39, s[20:23], s47 offen sc1
s_waitcnt vmcnt(0)
v_lshlrev_b32 v64, 16, v66
v_and_b32 v65, 0xffff0000, v66
v_add_f32 v48, v48, v64
v_add_f32 v49, v49, v65
v_lshlrev_b32 v64, 16, v67
v_and_b32 v65, 0xffff0000, v67
v_add_f32 v50, v50, v64
v_add_f32 v51, v51, v65
LE_fl21:
s_nop 3
v_cvt_pk_bf16_f32 v64, v48, v49
v_cvt_pk_bf16_f32 v65, v50, v51
v_mov_b32 v48, 0
v_mov_b32 v49, 0
v_mov_b32 v50, 0
v_mov_b32 v51, 0
buffer_store_dwordx2 v[64:65], v39, s[20:23], s47 offen sc1
s_add_u32 s47, s47, 512
LE_nf21:
v_mfma_f32_16x16x32_bf16 v[48:51], a[176:179], v[40:43], v[48:51]
v_mfma_f32_16x16x32_bf16 v[48:51], a[180:183], v[44:47], v[48:51]
s_bitcmp1_b32 s46, 22
s_cbranch_scc0 LE_nf22
s_cmp_eq_u32 s42, 0
s_cbranch_scc1 LE_fl22
buffer_load_dwordx2 v[66:67], v39, s[20:23], s47 offen sc1
s_waitcnt vmcnt(0)
v_lshlrev_b32 v64, 16, v66
v_and_b32 v65, 0xffff0000, v66
v_add_f32 v48, v48, v64
v_add_f32 v49, v49, v65
v_lshlrev_b32 v64, 16, v67
v_and_b32 v65, 0xffff0000, v67
v_add_f32 v50, v50, v64
v_add_f32 v51, v51, v65
LE_fl22:
s_nop 3
v_cvt_pk_bf16_f32 v64, v48, v49
v_cvt_pk_bf16_f32 v65, v50, v51
v_mov_b32 v48, 0
v_mov_b32 v49, 0
v_mov_b32 v50, 0
v_mov_b32 v51, 0
buffer_store_dwordx2 v[64:65], v39, s[20:23], s47 offen sc1
s_add_u32 s47, s47, 512
LE_nf22:
v_mfma_f32_16x16x32_bf16 v[48:51], a[184:187], v[40:43], v[48:51]
v_mfma_f32_16x16x32_bf16 v[48:51], a[188:191], v[44:47], v[48:51]
s_bitcmp1_b32 s46, 23
s_cbranch_scc0 LE_nf23
s_cmp_eq_u32 s42, 0
s_cbranch_scc1 LE_fl23
buffer_load_dwordx2 v[66:67], v39, s[20:23], s47 offen sc1
s_waitcnt vmcnt(0)
v_lshlrev_b32 v64, 16, v66
v_and_b32 v65, 0xffff0000, v66
v_add_f32 v48, v48, v64
v_add_f32 v49, v49, v65
v_lshlrev_b32 v64, 16, v67
v_and_b32 v65, 0xffff0000, v67
v_add_f32 v50, v50, v64
v_add_f32 v51, v51, v65
LE_fl23:
s_nop 3
v_cvt_pk_bf16_f32 v64, v48, v49
v_cvt_pk_bf16_f32 v65, v50, v51
v_mov_b32 v48, 0
v_mov_b32 v49, 0
v_mov_b32 v50, 0
v_mov_b32 v51, 0
buffer_store_dwordx2 v[64:65], v39, s[20:23], s47 offen sc1
s_add_u32 s47, s47, 512
LE_nf23:
s_waitcnt lgkmcnt(0)
ds_read2_b32 v[52:53], v34 offset0:96 offset1:100
ds_read2_b32 v[54:55], v34 offset0:104 offset1:108
v_mad_u32_u16 v60, v56, s49, v2
v_mad_u32_u16 v61, v57, s49, v2
v_mad_u32_u16 v62, v58, s49, v2
v_mad_u32_u16 v63, v59, s49, v2
buffer_load_dwordx4 a[160:163], v60, s[16:19], 0 offen sc1
buffer_load_dwordx4 a[164:167], v60, s[16:19], 0 offen offset:256 sc1
buffer_load_dwordx4 a[168:171], v61, s[16:19], 0 offen sc1
buffer_load_dwordx4 a[172:175], v61, s[16:19], 0 offen offset:256 sc1
buffer_load_dwordx4 a[176:179], v62, s[16:19], 0 offen sc1
buffer_load_dwordx4 a[180:183], v62, s[16:19], 0 offen offset:256 sc1
buffer_load_dwordx4 a[184:187], v63, s[16:19], 0 offen sc1
buffer_load_dwordx4 a[188:191], v63, s[16:19], 0 offen offset:256 sc1
s_waitcnt vmcnt(56)
v_mfma_f32_16x16x32_bf16 v[48:51], a[192:195], v[40:43], v[48:51]
v_mfma_f32_16x16x32_bf16 v[48:51], a[196:199], v[44:47], v[48:51]
s_bitcmp1_b32 s46, 24
s_cbranch_scc0 LE_nf24
s_cmp_eq_u32 s42, 0
s_cbranch_scc1 LE_fl24
buffer_load_dwordx2 v[66:67], v39, s[20:23], s47 offen sc1
s_waitcnt vmcnt(0)
v_lshlrev_b32 v64, 16, v66
v_and_b32 v65, 0xffff0000, v66
v_add_f32 v48, v48, v64
v_add_f32 v49, v49, v65
v_lshlrev_b32 v64, 16, v67
v_and_b32 v65, 0xffff0000, v67
v_add_f32 v50, v50, v64
v_add_f32 v51, v51, v65
LE_fl24:
s_nop 3
v_cvt_pk_bf16_f32 v64, v48, v49
v_cvt_pk_bf16_f32 v65, v50, v51
v_mov_b32 v48, 0
v_mov_b32 v49, 0
v_mov_b32 v50, 0
v_mov_b32 v51, 0
buffer_store_dwordx2 v[64:65], v39, s[20:23], s47 offen sc1
s_add_u32 s47, s47, 512
LE_nf24:
v_mfma_f32_16x16x32_bf16 v[48:51], a[200:203], v[40:43], v[48:51]
v_mfma_f32_16x16x32_bf16 v[48:51], a[204:207], v[44:47], v[48:51]
s_bitcmp1_b32 s46, 25
s_cbranch_scc0 LE_nf25
s_cmp_eq_u32 s42, 0
s_cbranch_scc1 LE_fl25
buffer_load_dwordx2 v[66:67], v39, s[20:23], s47 offen sc1
s_waitcnt vmcnt(0)
v_lshlrev_b32 v64, 16, v66
v_and_b32 v65, 0xffff0000, v66
v_add_f32 v48, v48, v64
v_add_f32 v49, v49, v65
v_lshlrev_b32 v64, 16, v67
v_and_b32 v65, 0xffff0000, v67
v_add_f32 v50, v50, v64
v_add_f32 v51, v51, v65
LE_fl25:
s_nop 3
v_cvt_pk_bf16_f32 v64, v48, v49
v_cvt_pk_bf16_f32 v65, v50, v51
v_mov_b32 v48, 0
v_mov_b32 v49, 0
v_mov_b32 v50, 0
v_mov_b32 v51, 0
buffer_store_dwordx2 v[64:65], v39, s[20:23], s47 offen sc1
s_add_u32 s47, s47, 512
LE_nf25:
v_mfma_f32_16x16x32_bf16 v[48:51], a[208:211], v[40:43], v[48:51]
v_mfma_f32_16x16x32_bf16 v[48:51], a[212:215], v[44:47], v[48:51]
s_bitcmp1_b32 s46, 26
s_cbranch_scc0 LE_nf26
s_cmp_eq_u32 s42, 0
s_cbranch_scc1 LE_fl26
buffer_load_dwordx2 v[66:67], v39, s[20:23], s47 offen sc1
s_waitcnt vmcnt(0)
v_lshlrev_b32 v64, 16, v66
v_and_b32 v65, 0xffff0000, v66
v_add_f32 v48, v48, v64
v_add_f32 v49, v49, v65
v_lshlrev_b32 v64, 16, v67
v_and_b32 v65, 0xffff0000, v67
v_add_f32 v50, v50, v64
v_add_f32 v51, v51, v65
LE_fl26:
s_nop 3
v_cvt_pk_bf16_f32 v64, v48, v49
v_cvt_pk_bf16_f32 v65, v50, v51
v_mov_b32 v48, 0
v_mov_b32 v49, 0
v_mov_b32 v50, 0
v_mov_b32 v51, 0
buffer_store_dwordx2 v[64:65], v39, s[20:23], s47 offen sc1
s_add_u32 s47, s47, 512
LE_nf26:
v_mfma_f32_16x16x32_bf16 v[48:51], a[216:219], v[40:43], v[48:51]
v_mfma_f32_16x16x32_bf16 v[48:51], a[220:223], v[44:47], v[48:51]
s_bitcmp1_b32 s46, 27
s_cbranch_scc0 LE_nf27
s_cmp_eq_u32 s42, 0
s_cbranch_scc1 LE_fl27
buffer_load_dwordx2 v[66:67], v39, s[20:23], s47 offen sc1
s_waitcnt vmcnt(0)
v_lshlrev_b32 v64, 16, v66
v_and_b32 v65, 0xffff0000, v66
v_add_f32 v48, v48, v64
v_add_f32 v49, v49, v65
v_lshlrev_b32 v64, 16, v67
v_and_b32 v65, 0xffff0000, v67
v_add_f32 v50, v50, v64
v_add_f32 v51, v51, v65
LE_fl27:
s_nop 3
v_cvt_pk_bf16_f32 v64, v48, v49
v_cvt_pk_bf16_f32 v65, v50, v51
v_mov_b32 v48, 0
v_mov_b32 v49, 0
v_mov_b32 v50, 0
v_mov_b32 v51, 0
buffer_store_dwordx2 v[64:65], v39, s[20:23], s47 offen sc1
s_add_u32 s47, s47, 512
LE_nf27:
s_waitcnt lgkmcnt(0)
ds_read2_b32 v[56:57], v34 offset0:112 offset1:116
ds_read2_b32 v[58:59], v34 offset0:120 offset1:124
v_mad_u32_u16 v60, v52, s49, v2
v_mad_u32_u16 v61, v53, s49, v2
v_mad_u32_u16 v62, v54, s49, v2
v_mad_u32_u16 v63, v55, s49, v2
buffer_load_dwordx4 a[192:195], v60, s[16:19], 0 offen sc1
buffer_load_dwordx4 a[196:199], v60, s[16:19], 0 offen offset:256 sc1
buffer_load_dwordx4 a[200:203], v61, s[16:19], 0 offen sc1
buffer_load_dwordx4 a[204:207], v61, s[16:19], 0 offen offset:256 sc1
buffer_load_dwordx4 a[208:211], v62, s[16:19], 0 offen sc1
buffer_load_dwordx4 a[212:215], v62, s[16:19], 0 offen offset:256 sc1
buffer_load_dwordx4 a[216:219], v63, s[16:19], 0 offen sc1
buffer_load_dwordx4 a[220:223], v63, s[16:19], 0 offen offset:256 sc1
s_waitcnt vmcnt(56)
v_mfma_f32_16x16x32_bf16 v[48:51], a[224:227], v[40:43], v[48:51]
v_mfma_f32_16x16x32_bf16 v[48:51], a[228:231], v[44:47], v[48:51]
s_bitcmp1_b32 s46, 28
s_cbranch_scc0 LE_nf28
s_cmp_eq_u32 s42, 0
s_cbranch_scc1 LE_fl28
buffer_load_dwordx2 v[66:67], v39, s[20:23], s47 offen sc1
s_waitcnt vmcnt(0)
v_lshlrev_b32 v64, 16, v66
v_and_b32 v65, 0xffff0000, v66
v_add_f32 v48, v48, v64
v_add_f32 v49, v49, v65
v_lshlrev_b32 v64, 16, v67
v_and_b32 v65, 0xffff0000, v67
v_add_f32 v50, v50, v64
v_add_f32 v51, v51, v65
LE_fl28:
s_nop 3
v_cvt_pk_bf16_f32 v64, v48, v49
v_cvt_pk_bf16_f32 v65, v50, v51
v_mov_b32 v48, 0
v_mov_b32 v49, 0
v_mov_b32 v50, 0
v_mov_b32 v51, 0
buffer_store_dwordx2 v[64:65], v39, s[20:23], s47 offen sc1
s_add_u32 s47, s47, 512
LE_nf28:
v_mfma_f32_16x16x32_bf16 v[48:51], a[232:235], v[40:43], v[48:51]
v_mfma_f32_16x16x32_bf16 v[48:51], a[236:239], v[44:47], v[48:51]
s_bitcmp1_b32 s46, 29
s_cbranch_scc0 LE_nf29
s_cmp_eq_u32 s42, 0
s_cbranch_scc1 LE_fl29
buffer_load_dwordx2 v[66:67], v39, s[20:23], s47 offen sc1
s_waitcnt vmcnt(0)
v_lshlrev_b32 v64, 16, v66
v_and_b32 v65, 0xffff0000, v66
v_add_f32 v48, v48, v64
v_add_f32 v49, v49, v65
v_lshlrev_b32 v64, 16, v67
v_and_b32 v65, 0xffff0000, v67
v_add_f32 v50, v50, v64
v_add_f32 v51, v51, v65
LE_fl29:
s_nop 3
v_cvt_pk_bf16_f32 v64, v48, v49
v_cvt_pk_bf16_f32 v65, v50, v51
v_mov_b32 v48, 0
v_mov_b32 v49, 0
v_mov_b32 v50, 0
v_mov_b32 v51, 0
buffer_store_dwordx2 v[64:65], v39, s[20:23], s47 offen sc1
s_add_u32 s47, s47, 512
LE_nf29:
v_mfma_f32_16x16x32_bf16 v[48:51], a[240:243], v[40:43], v[48:51]
v_mfma_f32_16x16x32_bf16 v[48:51], a[244:247], v[44:47], v[48:51]
s_bitcmp1_b32 s46, 30
s_cbranch_scc0 LE_nf30
s_cmp_eq_u32 s42, 0
s_cbranch_scc1 LE_fl30
buffer_load_dwordx2 v[66:67], v39, s[20:23], s47 offen sc1
s_waitcnt vmcnt(0)
v_lshlrev_b32 v64, 16, v66
v_and_b32 v65, 0xffff0000, v66
v_add_f32 v48, v48, v64
v_add_f32 v49, v49, v65
v_lshlrev_b32 v64, 16, v67
v_and_b32 v65, 0xffff0000, v67
v_add_f32 v50, v50, v64
v_add_f32 v51, v51, v65
LE_fl30:
s_nop 3
v_cvt_pk_bf16_f32 v64, v48, v49
v_cvt_pk_bf16_f32 v65, v50, v51
v_mov_b32 v48, 0
v_mov_b32 v49, 0
v_mov_b32 v50, 0
v_mov_b32 v51, 0
buffer_store_dwordx2 v[64:65], v39, s[20:23], s47 offen sc1
s_add_u32 s47, s47, 512
LE_nf30:
v_mfma_f32_16x16x32_bf16 v[48:51], a[248:251], v[40:43], v[48:51]
v_mfma_f32_16x16x32_bf16 v[48:51], a[252:255], v[44:47], v[48:51]
s_bitcmp1_b32 s46, 31
s_cbranch_scc0 LE_nf31
s_cmp_eq_u32 s42, 0
s_cbranch_scc1 LE_fl31
buffer_load_dwordx2 v[66:67], v39, s[20:23], s47 offen sc1
s_waitcnt vmcnt(0)
v_lshlrev_b32 v64, 16, v66
v_and_b32 v65, 0xffff0000, v66
v_add_f32 v48, v48, v64
v_add_f32 v49, v49, v65
v_lshlrev_b32 v64, 16, v67
v_and_b32 v65, 0xffff0000, v67
v_add_f32 v50, v50, v64
v_add_f32 v51, v51, v65
LE_fl31:
s_nop 3
v_cvt_pk_bf16_f32 v64, v48, v49
v_cvt_pk_bf16_f32 v65, v50, v51
v_mov_b32 v48, 0
v_mov_b32 v49, 0
v_mov_b32 v50, 0
v_mov_b32 v51, 0
buffer_store_dwordx2 v[64:65], v39, s[20:23], s47 offen sc1
s_add_u32 s47, s47, 512
LE_nf31:
s_waitcnt lgkmcnt(0)
ds_read2_b32 v[52:53], v34 offset0:128 offset1:132
ds_read2_b32 v[54:55], v34 offset0:136 offset1:140
v_mad_u32_u16 v60, v56, s49, v2
v_mad_u32_u16 v61, v57, s49, v2
v_mad_u32_u16 v62, v58, s49, v2
v_mad_u32_u16 v63, v59, s49, v2
buffer_load_dwordx4 a[224:227], v60, s[16:19], 0 offen sc1
buffer_load_dwordx4 a[228:231], v60, s[16:19], 0 offen offset:256 sc1
buffer_load_dwordx4 a[232:235], v61, s[16:19], 0 offen sc1
buffer_load_dwordx4 a[236:239], v61, s[16:19], 0 offen offset:256 sc1
buffer_load_dwordx4 a[240:243], v62, s[16:19], 0 offen sc1
buffer_load_dwordx4 a[244:247], v62, s[16:19], 0 offen offset:256 sc1
buffer_load_dwordx4 a[248:251], v63, s[16:19], 0 offen sc1
buffer_load_dwordx4 a[252:255], v63, s[16:19], 0 offen offset:256 sc1
v_add_u32 v34, 512, v34
s_cmp_lt_u32 s45, s44
s_cbranch_scc1 LE_loop
s_add_u32 s42, s42, 1
s_mul_i32 s43, s42, 256
v_cmp_lt_u32 vcc, s43, v4
s_cbranch_vccz LE_done
s_cmp_ge_u32 s42, 40
s_cbranch_scc1 LE_done
s_waitcnt vmcnt(0) lgkmcnt(0)
s_add_u32 s50, s50, 1024
v_add_u32 v5, 0x100, v5
buffer_load_dwordx4 v[192:195], v6, s[12:15], s50 offen offset:0 sc1
buffer_load_dwordx4 v[196:199], v6, s[12:15], s50 offen offset:64 sc1
buffer_load_dwordx4 v[200:203], v6, s[12:15], s50 offen offset:128 sc1
buffer_load_dwordx4 v[204:207], v6, s[12:15], s50 offen offset:192 sc1
buffer_load_dwordx4 v[208:211], v6, s[12:15], s50 offen offset:256 sc1
buffer_load_dwordx4 v[212:215], v6, s[12:15], s50 offen offset:320 sc1
buffer_load_dwordx4 v[216:219], v6, s[12:15], s50 offen offset:384 sc1
buffer_load_dwordx4 v[220:223], v6, s[12:15], s50 offen offset:448 sc1
buffer_load_dwordx4 v[224:227], v6, s[12:15], s50 offen offset:512 sc1
buffer_load_dwordx4 v[228:231], v6, s[12:15], s50 offen offset:576 sc1
buffer_load_dwordx4 v[232:235], v6, s[12:15], s50 offen offset:640 sc1
buffer_load_dwordx4 v[236:239], v6, s[12:15], s50 offen offset:704 sc1
buffer_load_dwordx4 v[240:243], v6, s[12:15], s50 offen offset:768 sc1
buffer_load_dwordx4 v[244:247], v6, s[12:15], s50 offen offset:832 sc1
buffer_load_dwordx4 v[248:251], v6, s[12:15], s50 offen offset:896 sc1
buffer_load_dwordx4 v[252:255], v6, s[12:15], s50 offen offset:960 sc1
s_branch LE_pass
LE_done:
s_add_u32 s24, s4, 0x7c00000
s_addc_u32 s25, s5, 0
s_mov_b32 s26, 0x40000
s_mov_b32 s27, 0x00020000
s_add_u32 s48, s40, 1280
s_mul_i32 s48, s48, 128
s_waitcnt vmcnt(0)
v_mov_b32 v32, s98
v_mov_b32 v33, s99
s_mov_b64 exec, 1
buffer_store_dwordx2 v[32:33], off, s[24:27], s48 sc1
s_mov_b64 exec, -1
s_branch L2_end
L2_fin:
L2_end:
s_endpgm
.section .rodata,"a"
.p2align 6
.amdhsa_kernel standalone__hybrid_graph_tf_graphgps__graph_kernel
  .amdhsa_next_free_vgpr 512
  .amdhsa_next_free_sgpr 102
  .amdhsa_accum_offset 256
  .amdhsa_group_segment_fixed_size 0
  .amdhsa_kernarg_size 96
  .amdhsa_user_sgpr_count 2
  .amdhsa_user_sgpr_kernarg_segment_ptr 1
  .amdhsa_system_sgpr_workgroup_id_x 1
.end_amdhsa_kernel
```

```asm
; @launch grid=(256,1,1) block=(256,1,1) lds=163840
.amdgcn_target "amdgcn-amd-amdhsa--gfx950"
.text
.globl standalone__hybrid_graph_tf_graphgps__graph_kernel
.p2align 8
.type standalone__hybrid_graph_tf_graphgps__graph_kernel,@function
standalone__hybrid_graph_tf_graphgps__graph_kernel:
s_getpc_b64 s[56:57]
s_load_dwordx16 s[16:31], s[0:1], 0
s_load_dwordx8 s[32:39], s[0:1], 64
s_cmp_ge_u32 s2, 256
s_cbranch_scc1 L2_end
v_lshrrev_b32 v1, 6, v0
v_and_b32 v2, 63, v0
s_lshr_b32 s3, s2, 3
s_add_u32 s3, s3, 30
s_and_b32 s3, s3, 31
v_readfirstlane_b32 s60, v1
s_lshl_b32 s5, s3, 2
s_add_u32 s5, s5, s60
s_and_b32 s56, s56, 0xffffff00
s_mov_b32 s58, L2_end-standalone__hybrid_graph_tf_graphgps__graph_kernel
s_mov_b32 s59, 0x00020000
s_and_b32 s6, s5, 15
s_lshl_b32 s6, s6, 13
v_lshlrev_b32 v10, 7, v2
buffer_load_dword v255, v10, s[56:59], s6 offen
v_and_b32 v3, 15, v2
v_lshrrev_b32 v4, 4, v2
s_and_b32 s62, s3, 7
s_mov_b64 s[14:15], 0
s_and_b32 s8, s2, 7
s_cmp_ge_u32 s3, 30
s_cbranch_scc1 LM_edge
s_mul_i32 s12, s3, 26
s_lshr_b32 s12, s12, 8
s_mul_i32 s9, s12, 10
s_sub_u32 s9, s3, s9
s_and_b32 s13, s8, 1
s_mul_i32 s13, s13, 3
s_add_u32 s13, s13, s12
s_and_b32 s12, s8, 1
s_mul_i32 s12, s12, 5
s_add_u32 s8, s8, s12
s_and_b32 s8, s8, 7
s_lshr_b32 s12, s8, 1
s_mul_i32 s12, s12, 10
s_add_u32 s12, s12, s9
s_mul_i32 s91, s12, 6
s_add_u32 s91, s91, s13
s_mov_b32 s61, 0
s_cmp_eq_u32 s12, 39
s_cbranch_scc1 LM_light
s_mul_i32 s14, s13, 3
s_min_u32 s14, s14, 14
s_lshl_b32 s9, s12, 4
s_add_u32 s14, s14, s9
s_lshl_b32 s14, s14, 13
s_cmp_eq_u32 s91, 233
s_cselect_b32 s9, 0, s13
s_cmp_lt_u32 s9, 4
s_cselect_b32 s15, 3, 2
s_lshl_b32 s15, s15, 13
s_add_u32 s15, s15, s14
v_lshlrev_b32 v16, 4, v2
s_mul_i32 s63, s60, 12288
s_mov_b32 s6, s14
s_mul_i32 s7, s60, 6144
s_add_u32 s64, s6, s7
s_add_u32 s65, s64, 4096
s_lshl_b32 s7, s60, 7
v_lshrrev_b32 v5, 3, v2
v_and_b32 v6, 7, v2
v_and_b32 v7, 2, v5
v_xor_b32 v6, v6, v7
v_lshl_add_u32 v5, v5, 9, s7
v_lshl_add_u32 v17, v6, 4, v5
v_xor_b32 v6, 4, v6
v_lshl_add_u32 v18, v6, 4, v5
v_add_u32 v18, 0xc00, v18
v_add_u32 v19, 0x1800, v17
v_add_u32 v20, 0x1800, v18
s_xor_b32 s6, s62, 0
s_lshl_b32 s66, s6, 14
s_xor_b32 s6, s62, 1
s_lshl_b32 s67, s6, 14
s_xor_b32 s6, s62, 2
s_lshl_b32 s68, s6, 14
s_xor_b32 s6, s62, 3
s_lshl_b32 s69, s6, 14
s_xor_b32 s6, s62, 4
s_lshl_b32 s70, s6, 14
s_xor_b32 s6, s62, 5
s_lshl_b32 s71, s6, 14
s_xor_b32 s6, s62, 6
s_lshl_b32 s72, s6, 14
s_xor_b32 s6, s62, 7
s_lshl_b32 s73, s6, 14
s_waitcnt lgkmcnt(0)
s_add_u32 s40, s16, 0x0
s_addc_u32 s41, s17, 0
s_mov_b32 s42, s15
s_mov_b32 s43, 0x00020000
s_add_u32 s44, s26, 0x0
s_addc_u32 s45, s27, 0
s_mov_b32 s46, 0x20000
s_mov_b32 s47, 0x00020000
buffer_load_dwordx4 v[44:47], v16, s[40:43], s64 offen offset:0
buffer_load_dwordx4 v[48:51], v16, s[40:43], s64 offen offset:1024
buffer_load_dwordx4 v[52:55], v16, s[40:43], s64 offen offset:2048
buffer_load_dwordx4 v[56:59], v16, s[40:43], s64 offen offset:3072
buffer_load_dwordx4 v[60:63], v16, s[40:43], s65 offen offset:0
buffer_load_dwordx4 v[64:67], v16, s[40:43], s65 offen offset:1024
s_add_u32 m0, s63, 0x0
s_nop 0
buffer_load_dwordx4 v17, s[44:47], s66 offen offset:0 lds
buffer_load_dwordx4 v18, s[44:47], s66 offen offset:1024 lds
buffer_load_dwordx4 v19, s[44:47], s66 offen offset:2048 lds
buffer_load_dwordx4 v20, s[44:47], s66 offen offset:3072 lds
s_add_u32 m0, s63, 0x1000
s_nop 0
buffer_load_dwordx4 v17, s[44:47], s67 offen offset:0 lds
buffer_load_dwordx4 v18, s[44:47], s67 offen offset:1024 lds
buffer_load_dwordx4 v19, s[44:47], s67 offen offset:2048 lds
buffer_load_dwordx4 v20, s[44:47], s67 offen offset:3072 lds
s_mov_b32 s98, 0x7c3ff80
s_load_dwordx2 s[98:99], s[38:39], s98
v_bfe_u32 v5, v2, 2, 3
v_xor_b32 v5, s62, v5
v_and_b32 v6, 3, v2
v_lshlrev_b32 v7, 10, v5
v_lshl_add_u32 v7, v6, 8, v7
v_add_u32 v7, 0xc000, v7
v_and_b32 v5, 1, v5
v_lshl_or_b32 v6, v5, 2, v6
v_lshrrev_b32 v5, 5, v2
s_mul_i32 s6, s60, 12
v_add3_u32 v8, v5, s6, 0
v_lshrrev_b32 v9, 4, v8
v_lshl_add_u32 v9, v9, 13, v7
v_and_b32 v8, 15, v8
v_xor_b32 v8, v8, v6
v_lshl_add_u32 v36, v8, 4, v9
v_add3_u32 v8, v5, s6, 2
v_lshrrev_b32 v9, 4, v8
v_lshl_add_u32 v9, v9, 13, v7
v_and_b32 v8, 15, v8
v_xor_b32 v8, v8, v6
v_lshl_add_u32 v37, v8, 4, v9
v_add3_u32 v8, v5, s6, 4
v_lshrrev_b32 v9, 4, v8
v_lshl_add_u32 v9, v9, 13, v7
v_and_b32 v8, 15, v8
v_xor_b32 v8, v8, v6
v_lshl_add_u32 v38, v8, 4, v9
v_add3_u32 v8, v5, s6, 6
v_lshrrev_b32 v9, 4, v8
v_lshl_add_u32 v9, v9, 13, v7
v_and_b32 v8, 15, v8
v_xor_b32 v8, v8, v6
v_lshl_add_u32 v39, v8, 4, v9
v_add3_u32 v8, v5, s6, 8
v_lshrrev_b32 v9, 4, v8
v_lshl_add_u32 v9, v9, 13, v7
v_and_b32 v8, 15, v8
v_xor_b32 v8, v8, v6
v_lshl_add_u32 v40, v8, 4, v9
v_add3_u32 v8, v5, s6, 10
v_lshrrev_b32 v9, 4, v8
v_lshl_add_u32 v9, v9, 13, v7
v_and_b32 v8, 15, v8
v_xor_b32 v8, v8, v6
v_lshl_add_u32 v41, v8, 4, v9
v_xor_b32 v5, v3, v4
v_lshlrev_b32 v5, 4, v5
v_lshl_add_u32 v5, v4, 8, v5
v_add_u32 v31, 0xc000, v5
v_xor_b32 v32, 64, v31
v_lshrrev_b32 v5, 2, v3
v_and_b32 v6, 3, v3
v_and_b32 v7, 1, v4
v_lshlrev_b32 v7, 2, v7
v_and_b32 v8, 2, v5
v_or_b32 v7, v7, v8
v_lshl_add_u32 v8, v4, 3, v5
v_lshlrev_b32 v8, 7, v8
v_add_u32 v8, s63, v8
v_and_b32 v9, 1, v6
v_lshl_add_u32 v8, v9, 3, v8
v_lshrrev_b32 v6, 1, v6
v_xor_b32 v6, v6, v7
v_xor_b32 v9, 0, v6
v_lshl_add_u32 v25, v9, 4, v8
v_xor_b32 v9, 2, v6
v_lshl_add_u32 v26, v9, 4, v8
v_xor_b32 v9, 4, v6
v_lshl_add_u32 v27, v9, 4, v8
v_xor_b32 v9, 6, v6
v_lshl_add_u32 v28, v9, 4, v8
v_lshrrev_b32 v5, 3, v2
v_and_b32 v6, 7, v2
v_lshrrev_b32 v7, 1, v5
v_xor_b32 v6, v6, v7
v_and_b32 v7, 4, v5
v_add_u32 v5, v5, v7
s_mul_i32 s6, s60, 32768
v_lshl_add_u32 v5, v5, 9, s6
v_lshl_add_u32 v21, v6, 4, v5
v_xor_b32 v6, 4, v6
v_lshl_add_u32 v22, v6, 4, v5
v_add_u32 v22, 0x1c00, v22
v_mov_b32 v23, v21
v_mov_b32 v24, v22
s_lshr_b32 s7, s62, 1
s_xor_b32 s6, s7, 0
s_lshl_b32 s74, s6, 7
s_add_u32 s75, s74, 16384
s_xor_b32 s6, s7, 1
s_lshl_b32 s76, s6, 7
s_add_u32 s77, s76, 16384
s_xor_b32 s6, s7, 2
s_lshl_b32 s78, s6, 7
s_add_u32 s79, s78, 16384
s_xor_b32 s6, s7, 3
s_lshl_b32 s80, s6, 7
s_add_u32 s81, s80, 16384
s_and_b32 s6, s62, 1
s_lshl_b32 s6, s6, 2
v_lshrrev_b32 v5, 1, v3
v_xor_b32 v5, v5, v4
v_xor_b32 v5, s6, v5
v_lshl_add_u32 v6, v3, 7, s63
v_lshl_add_u32 v29, v5, 4, v6
v_xor_b32 v30, 64, v29
s_mul_i32 s6, s60, 2
s_xor_b32 s6, s6, s62
s_lshl_b32 s6, s6, 10
s_add_u32 s6, s6, 0x12000
v_lshrrev_b32 v5, 1, v4
v_and_b32 v6, 1, v4
v_lshl_add_u32 v5, v5, 8, s6
v_lshl_add_u32 v5, v6, 3, v5
v_lshl_add_u32 v33, v3, 4, v5
v_xor_b32 v34, 0x400, v33
v_add_u32 v35, 0x12000, v16
s_mov_b32 s6, s14
s_mul_i32 s7, s60, 2048
s_add_u32 s82, s6, s7
s_add_u32 s83, s82, 8192
s_add_u32 s84, s82, 16384
s_mov_b32 s86, 0x3db8aa3b
s_mov_b32 s87, 0x3db8aa3b
s_mov_b32 s88, 0x3727c5ac
s_mov_b32 s89, 0x3b800000
s_mov_b32 s90, 0xffff0000
s_add_u32 s48, s28, 0x0
s_addc_u32 s49, s29, 0
s_mov_b32 s50, 0x20000
s_mov_b32 s51, 0x00020000
s_add_u32 s52, s38, 0x0
s_addc_u32 s53, s39, 0
s_mov_b32 s54, s15
s_mov_b32 s55, 0x00020000
s_add_u32 s56, s38, 0x6800000
s_addc_u32 s57, s39, 0
s_mov_b32 s58, s15
s_mov_b32 s59, 0x00020000
s_waitcnt vmcnt(13)
v_lshlrev_b32 v116, 16, v44
v_and_b32 v117, s90, v44
v_lshlrev_b32 v118, 16, v45
v_and_b32 v119, s90, v45
v_lshlrev_b32 v120, 16, v46
v_and_b32 v121, s90, v46
v_lshlrev_b32 v122, 16, v47
v_and_b32 v123, s90, v47
v_pk_add_f32 v[164:165], v[116:117], v[118:119]
v_pk_mul_f32 v[166:167], v[116:117], v[116:117]
v_pk_add_f32 v[44:45], v[120:121], v[122:123]
v_pk_fma_f32 v[166:167], v[118:119], v[118:119], v[166:167]
v_pk_add_f32 v[164:165], v[164:165], v[44:45]
v_pk_fma_f32 v[166:167], v[120:121], v[120:121], v[166:167]
v_add_f32 v164, v164, v165
v_pk_fma_f32 v[166:167], v[122:123], v[122:123], v[166:167]
v_add_f32 v166, v166, v167
s_waitcnt vmcnt(12)
v_lshlrev_b32 v124, 16, v48
v_and_b32 v125, s90, v48
v_lshlrev_b32 v126, 16, v49
v_and_b32 v127, s90, v49
v_lshlrev_b32 v128, 16, v50
v_and_b32 v129, s90, v50
v_lshlrev_b32 v130, 16, v51
v_and_b32 v131, s90, v51
v_pk_add_f32 v[168:169], v[124:125], v[126:127]
v_pk_mul_f32 v[170:171], v[124:125], v[124:125]
v_pk_add_f32 v[48:49], v[128:129], v[130:131]
v_pk_fma_f32 v[170:171], v[126:127], v[126:127], v[170:171]
v_pk_add_f32 v[168:169], v[168:169], v[48:49]
v_pk_fma_f32 v[170:171], v[128:129], v[128:129], v[170:171]
v_add_f32 v168, v168, v169
v_pk_fma_f32 v[170:171], v[130:131], v[130:131], v[170:171]
v_add_f32 v170, v170, v171
s_waitcnt vmcnt(11)
v_lshlrev_b32 v132, 16, v52
v_and_b32 v133, s90, v52
v_lshlrev_b32 v134, 16, v53
v_and_b32 v135, s90, v53
v_lshlrev_b32 v136, 16, v54
v_and_b32 v137, s90, v54
v_lshlrev_b32 v138, 16, v55
v_and_b32 v139, s90, v55
v_pk_add_f32 v[172:173], v[132:133], v[134:135]
v_pk_mul_f32 v[174:175], v[132:133], v[132:133]
v_pk_add_f32 v[52:53], v[136:137], v[138:139]
v_pk_fma_f32 v[174:175], v[134:135], v[134:135], v[174:175]
v_pk_add_f32 v[172:173], v[172:173], v[52:53]
v_pk_fma_f32 v[174:175], v[136:137], v[136:137], v[174:175]
v_add_f32 v172, v172, v173
v_pk_fma_f32 v[174:175], v[138:139], v[138:139], v[174:175]
v_add_f32 v174, v174, v175
s_waitcnt vmcnt(10)
v_lshlrev_b32 v140, 16, v56
v_and_b32 v141, s90, v56
v_lshlrev_b32 v142, 16, v57
v_and_b32 v143, s90, v57
v_lshlrev_b32 v144, 16, v58
v_and_b32 v145, s90, v58
v_lshlrev_b32 v146, 16, v59
v_and_b32 v147, s90, v59
v_pk_add_f32 v[176:177], v[140:141], v[142:143]
v_pk_mul_f32 v[178:179], v[140:141], v[140:141]
v_pk_add_f32 v[56:57], v[144:145], v[146:147]
v_pk_fma_f32 v[178:179], v[142:143], v[142:143], v[178:179]
v_pk_add_f32 v[176:177], v[176:177], v[56:57]
v_pk_fma_f32 v[178:179], v[144:145], v[144:145], v[178:179]
v_add_f32 v176, v176, v177
v_pk_fma_f32 v[178:179], v[146:147], v[146:147], v[178:179]
v_add_f32 v178, v178, v179
s_waitcnt vmcnt(9)
v_lshlrev_b32 v148, 16, v60
v_and_b32 v149, s90, v60
v_lshlrev_b32 v150, 16, v61
v_and_b32 v151, s90, v61
v_lshlrev_b32 v152, 16, v62
v_and_b32 v153, s90, v62
v_lshlrev_b32 v154, 16, v63
v_and_b32 v155, s90, v63
v_pk_add_f32 v[180:181], v[148:149], v[150:151]
v_pk_mul_f32 v[182:183], v[148:149], v[148:149]
v_pk_add_f32 v[60:61], v[152:153], v[154:155]
v_pk_fma_f32 v[182:183], v[150:151], v[150:151], v[182:183]
v_pk_add_f32 v[180:181], v[180:181], v[60:61]
v_pk_fma_f32 v[182:183], v[152:153], v[152:153], v[182:183]
v_add_f32 v180, v180, v181
v_pk_fma_f32 v[182:183], v[154:155], v[154:155], v[182:183]
v_add_f32 v182, v182, v183
s_waitcnt vmcnt(8)
v_lshlrev_b32 v156, 16, v64
v_and_b32 v157, s90, v64
v_lshlrev_b32 v158, 16, v65
v_and_b32 v159, s90, v65
v_lshlrev_b32 v160, 16, v66
v_and_b32 v161, s90, v66
v_lshlrev_b32 v162, 16, v67
v_and_b32 v163, s90, v67
v_pk_add_f32 v[184:185], v[156:157], v[158:159]
v_pk_mul_f32 v[186:187], v[156:157], v[156:157]
v_pk_add_f32 v[64:65], v[160:161], v[162:163]
v_pk_fma_f32 v[186:187], v[158:159], v[158:159], v[186:187]
v_pk_add_f32 v[184:185], v[184:185], v[64:65]
v_pk_fma_f32 v[186:187], v[160:161], v[160:161], v[186:187]
v_add_f32 v184, v184, v185
v_pk_fma_f32 v[186:187], v[162:163], v[162:163], v[186:187]
v_add_f32 v186, v186, v187
v_permlane16_swap_b32 v164, v166
v_permlane16_swap_b32 v168, v170
v_permlane16_swap_b32 v172, v174
v_permlane16_swap_b32 v176, v178
v_permlane16_swap_b32 v180, v182
v_permlane16_swap_b32 v184, v186
v_add_f32 v164, v164, v166
v_add_f32 v168, v168, v170
v_add_f32 v172, v172, v174
v_add_f32 v176, v176, v178
v_add_f32 v180, v180, v182
v_add_f32 v184, v184, v186
v_add_f32_dpp v165, v164, v164 row_ror:8 row_mask:0xf bank_mask:0x3
v_add_f32_dpp v165, v168, v168 row_ror:8 row_mask:0xf bank_mask:0xc
v_add_f32_dpp v173, v172, v172 row_ror:8 row_mask:0xf bank_mask:0x3
v_add_f32_dpp v173, v176, v176 row_ror:8 row_mask:0xf bank_mask:0xc
v_add_f32_dpp v181, v180, v180 row_ror:8 row_mask:0xf bank_mask:0x3
v_add_f32_dpp v181, v184, v184 row_ror:8 row_mask:0xf bank_mask:0xc
v_add_f32_dpp v166, v165, v165 row_half_mirror row_mask:0xf bank_mask:0x5
v_add_f32_dpp v166, v173, v173 row_half_mirror row_mask:0xf bank_mask:0xa
v_add_f32_dpp v182, v181, v181 row_half_mirror row_mask:0xf bank_mask:0xf
s_nop 0
v_add_f32_dpp v166, v166, v166 quad_perm:[1,0,3,2] row_mask:0xf bank_mask:0xf
v_add_f32_dpp v182, v182, v182 quad_perm:[1,0,3,2] row_mask:0xf bank_mask:0xf
s_nop 0
v_add_f32_dpp v166, v166, v166 quad_perm:[2,3,0,1] row_mask:0xf bank_mask:0xf
v_add_f32_dpp v182, v182, v182 quad_perm:[2,3,0,1] row_mask:0xf bank_mask:0xf
v_mov_b32 v167, v166
v_mov_b32 v183, v182
s_nop 0
v_permlane16_swap_b32 v167, v166
v_permlane16_swap_b32 v183, v182
v_mul_f32 v167, s89, v167
v_mul_f32 v183, s89, v183
v_mul_f32 v166, s89, v166
v_mul_f32 v182, s89, v182
v_fma_f32 v166, -v167, v167, v166
v_fma_f32 v182, -v183, v183, v182
v_cvt_pk_bf16_f32 v167, v167, v167
v_cvt_pk_bf16_f32 v183, v183, v183
v_max_f32 v166, 0, v166
v_max_f32 v182, 0, v182
v_cvt_pk_bf16_f32 v166, v166, v166
v_cvt_pk_bf16_f32 v182, v182, v182
v_and_b32 v166, s90, v166
v_and_b32 v182, s90, v182
v_add_f32 v166, s88, v166
v_add_f32 v182, s88, v182
v_cvt_pk_bf16_f32 v166, v166, v166
v_cvt_pk_bf16_f32 v182, v182, v182
v_and_b32 v166, s90, v166
v_and_b32 v182, s90, v182
v_sqrt_f32 v166, v166
v_sqrt_f32 v182, v182
v_and_b32 v167, s90, v167
v_and_b32 v183, s90, v183
v_cvt_pk_bf16_f32 v166, v166, v166
v_cvt_pk_bf16_f32 v182, v182, v182
v_and_b32 v166, s90, v166
v_and_b32 v182, s90, v182
v_rcp_f32 v166, v166
v_rcp_f32 v182, v182
v_mul_f32 v167, -v167, v166
v_mul_f32 v183, -v183, v182
s_nop 0
v_mov_b64_dpp v[164:165], v[166:167] row_newbcast:0 row_mask:0xf bank_mask:0xf
v_mov_b64_dpp v[168:169], v[166:167] row_newbcast:8 row_mask:0xf bank_mask:0xf
v_mov_b64_dpp v[172:173], v[166:167] row_newbcast:4 row_mask:0xf bank_mask:0xf
v_mov_b64_dpp v[176:177], v[166:167] row_newbcast:12 row_mask:0xf bank_mask:0xf
v_mov_b64_dpp v[180:181], v[182:183] row_newbcast:0 row_mask:0xf bank_mask:0xf
v_mov_b64_dpp v[184:185], v[182:183] row_newbcast:8 row_mask:0xf bank_mask:0xf
v_fma_f32 v116, v116, v164, v165
v_fma_f32 v117, v117, v164, v165
v_fma_f32 v118, v118, v164, v165
v_fma_f32 v119, v119, v164, v165
v_fma_f32 v120, v120, v164, v165
v_fma_f32 v121, v121, v164, v165
v_fma_f32 v122, v122, v164, v165
v_fma_f32 v123, v123, v164, v165
v_cvt_pk_bf16_f32 v44, v116, v117
v_cvt_pk_bf16_f32 v45, v118, v119
v_cvt_pk_bf16_f32 v46, v120, v121
v_cvt_pk_bf16_f32 v47, v122, v123
ds_write_b128 v36, v[44:47]
v_fma_f32 v124, v124, v168, v169
v_fma_f32 v125, v125, v168, v169
v_fma_f32 v126, v126, v168, v169
v_fma_f32 v127, v127, v168, v169
v_fma_f32 v128, v128, v168, v169
v_fma_f32 v129, v129, v168, v169
v_fma_f32 v130, v130, v168, v169
v_fma_f32 v131, v131, v168, v169
v_cvt_pk_bf16_f32 v48, v124, v125
v_cvt_pk_bf16_f32 v49, v126, v127
v_cvt_pk_bf16_f32 v50, v128, v129
v_cvt_pk_bf16_f32 v51, v130, v131
ds_write_b128 v37, v[48:51]
v_fma_f32 v132, v132, v172, v173
v_fma_f32 v133, v133, v172, v173
v_fma_f32 v134, v134, v172, v173
v_fma_f32 v135, v135, v172, v173
v_fma_f32 v136, v136, v172, v173
v_fma_f32 v137, v137, v172, v173
v_fma_f32 v138, v138, v172, v173
v_fma_f32 v139, v139, v172, v173
v_cvt_pk_bf16_f32 v52, v132, v133
v_cvt_pk_bf16_f32 v53, v134, v135
v_cvt_pk_bf16_f32 v54, v136, v137
v_cvt_pk_bf16_f32 v55, v138, v139
ds_write_b128 v38, v[52:55]
v_fma_f32 v140, v140, v176, v177
v_fma_f32 v141, v141, v176, v177
v_fma_f32 v142, v142, v176, v177
v_fma_f32 v143, v143, v176, v177
v_fma_f32 v144, v144, v176, v177
v_fma_f32 v145, v145, v176, v177
v_fma_f32 v146, v146, v176, v177
v_fma_f32 v147, v147, v176, v177
v_cvt_pk_bf16_f32 v56, v140, v141
v_cvt_pk_bf16_f32 v57, v142, v143
v_cvt_pk_bf16_f32 v58, v144, v145
v_cvt_pk_bf16_f32 v59, v146, v147
ds_write_b128 v39, v[56:59]
v_fma_f32 v148, v148, v180, v181
v_fma_f32 v149, v149, v180, v181
v_fma_f32 v150, v150, v180, v181
v_fma_f32 v151, v151, v180, v181
v_fma_f32 v152, v152, v180, v181
v_fma_f32 v153, v153, v180, v181
v_fma_f32 v154, v154, v180, v181
v_fma_f32 v155, v155, v180, v181
v_cvt_pk_bf16_f32 v60, v148, v149
v_cvt_pk_bf16_f32 v61, v150, v151
v_cvt_pk_bf16_f32 v62, v152, v153
v_cvt_pk_bf16_f32 v63, v154, v155
ds_write_b128 v40, v[60:63]
v_fma_f32 v156, v156, v184, v185
v_fma_f32 v157, v157, v184, v185
v_fma_f32 v158, v158, v184, v185
v_fma_f32 v159, v159, v184, v185
v_fma_f32 v160, v160, v184, v185
v_fma_f32 v161, v161, v184, v185
v_fma_f32 v162, v162, v184, v185
v_fma_f32 v163, v163, v184, v185
v_cvt_pk_bf16_f32 v64, v156, v157
v_cvt_pk_bf16_f32 v65, v158, v159
v_cvt_pk_bf16_f32 v66, v160, v161
v_cvt_pk_bf16_f32 v67, v162, v163
ds_write_b128 v41, v[64:67]
s_add_u32 m0, s63, 0x2000
s_nop 0
buffer_load_dwordx4 v17, s[44:47], s68 offen offset:0 lds
buffer_load_dwordx4 v18, s[44:47], s68 offen offset:1024 lds
buffer_load_dwordx4 v19, s[44:47], s68 offen offset:2048 lds
buffer_load_dwordx4 v20, s[44:47], s68 offen offset:3072 lds
s_waitcnt vmcnt(8)
ds_read_b64_tr_b16 v[164:165], v25 offset:0
ds_read_b64_tr_b16 v[166:167], v25 offset:512
ds_read_b64_tr_b16 v[168:169], v26 offset:0
ds_read_b64_tr_b16 v[170:171], v26 offset:512
ds_read_b64_tr_b16 v[172:173], v27 offset:0
ds_read_b64_tr_b16 v[174:175], v27 offset:512
s_waitcnt lgkmcnt(6)
s_barrier
ds_read_b128 v[204:207], v31 offset:0
ds_read_b128 v[208:211], v31 offset:8192
ds_read_b128 v[212:215], v31 offset:16384
s_waitcnt lgkmcnt(2)
v_mfma_f32_16x16x32_bf16 v[68:71], v[164:167], v[204:207], 0
s_waitcnt lgkmcnt(1)
v_mfma_f32_16x16x32_bf16 v[72:75], v[164:167], v[208:211], 0
s_waitcnt lgkmcnt(0)
v_mfma_f32_16x16x32_bf16 v[76:79], v[164:167], v[212:215], 0
ds_read_b64_tr_b16 v[176:177], v28 offset:0
ds_read_b64_tr_b16 v[178:179], v28 offset:512
v_mfma_f32_16x16x32_bf16 v[80:83], v[168:171], v[204:207], 0
v_mfma_f32_16x16x32_bf16 v[84:87], v[168:171], v[208:211], 0
v_mfma_f32_16x16x32_bf16 v[88:91], v[168:171], v[212:215], 0
ds_read_b128 v[216:219], v32 offset:1024
s_waitcnt vmcnt(4)
ds_read_b64_tr_b16 v[180:181], v25 offset:4096
ds_read_b64_tr_b16 v[182:183], v25 offset:4608
v_mfma_f32_16x16x32_bf16 v[92:95], v[172:175], v[204:207], 0
ds_read_b128 v[220:223], v32 offset:9216
v_mfma_f32_16x16x32_bf16 v[96:99], v[172:175], v[208:211], 0
ds_read_b128 v[224:227], v32 offset:17408
v_mfma_f32_16x16x32_bf16 v[100:103], v[172:175], v[212:215], 0
ds_read_b64_tr_b16 v[184:185], v26 offset:4096
ds_read_b64_tr_b16 v[186:187], v26 offset:4608
s_waitcnt lgkmcnt(7)
v_mfma_f32_16x16x32_bf16 v[104:107], v[176:179], v[204:207], 0
s_add_u32 m0, s63, 0x0
s_nop 0
buffer_load_dwordx4 v17, s[44:47], s69 offen offset:0 lds
buffer_load_dwordx4 v18, s[44:47], s69 offen offset:1024 lds
buffer_load_dwordx4 v19, s[44:47], s69 offen offset:2048 lds
buffer_load_dwordx4 v20, s[44:47], s69 offen offset:3072 lds
v_mfma_f32_16x16x32_bf16 v[108:111], v[176:179], v[208:211], 0
v_mfma_f32_16x16x32_bf16 v[112:115], v[176:179], v[212:215], 0
ds_read_b64_tr_b16 v[188:189], v27 offset:4096
ds_read_b64_tr_b16 v[190:191], v27 offset:4608
s_waitcnt lgkmcnt(6)
v_mfma_f32_16x16x32_bf16 v[68:71], v[180:183], v[216:219], v[68:71]
s_waitcnt lgkmcnt(5)
v_mfma_f32_16x16x32_bf16 v[72:75], v[180:183], v[220:223], v[72:75]
s_waitcnt lgkmcnt(4)
v_mfma_f32_16x16x32_bf16 v[76:79], v[180:183], v[224:227], v[76:79]
ds_read_b64_tr_b16 v[192:193], v28 offset:4096
ds_read_b64_tr_b16 v[194:195], v28 offset:4608
s_waitcnt lgkmcnt(4)
v_mfma_f32_16x16x32_bf16 v[80:83], v[184:187], v[216:219], v[80:83]
v_mfma_f32_16x16x32_bf16 v[84:87], v[184:187], v[220:223], v[84:87]
v_mfma_f32_16x16x32_bf16 v[88:91], v[184:187], v[224:227], v[88:91]
ds_read_b128 v[228:231], v31 offset:2048
s_waitcnt vmcnt(4)
ds_read_b64_tr_b16 v[196:197], v25 offset:8192
ds_read_b64_tr_b16 v[198:199], v25 offset:8704
s_waitcnt lgkmcnt(5)
v_mfma_f32_16x16x32_bf16 v[92:95], v[188:191], v[216:219], v[92:95]
ds_read_b128 v[232:235], v31 offset:10240
v_mfma_f32_16x16x32_bf16 v[96:99], v[188:191], v[220:223], v[96:99]
ds_read_b128 v[236:239], v31 offset:18432
v_mfma_f32_16x16x32_bf16 v[100:103], v[188:191], v[224:227], v[100:103]
ds_read_b64_tr_b16 v[200:201], v26 offset:8192
ds_read_b64_tr_b16 v[202:203], v26 offset:8704
s_waitcnt lgkmcnt(7)
v_mfma_f32_16x16x32_bf16 v[104:107], v[192:195], v[216:219], v[104:107]
s_add_u32 m0, s63, 0x1000
s_nop 0
buffer_load_dwordx4 v17, s[44:47], s70 offen offset:0 lds
buffer_load_dwordx4 v18, s[44:47], s70 offen offset:1024 lds
buffer_load_dwordx4 v19, s[44:47], s70 offen offset:2048 lds
buffer_load_dwordx4 v20, s[44:47], s70 offen offset:3072 lds
v_mfma_f32_16x16x32_bf16 v[108:111], v[192:195], v[220:223], v[108:111]
v_mfma_f32_16x16x32_bf16 v[112:115], v[192:195], v[224:227], v[112:115]
ds_read_b64_tr_b16 v[164:165], v27 offset:8192
ds_read_b64_tr_b16 v[166:167], v27 offset:8704
s_waitcnt lgkmcnt(6)
v_mfma_f32_16x16x32_bf16 v[68:71], v[196:199], v[228:231], v[68:71]
s_waitcnt lgkmcnt(5)
v_mfma_f32_16x16x32_bf16 v[72:75], v[196:199], v[232:235], v[72:75]
s_waitcnt lgkmcnt(4)
v_mfma_f32_16x16x32_bf16 v[76:79], v[196:199], v[236:239], v[76:79]
ds_read_b64_tr_b16 v[168:169], v28 offset:8192
ds_read_b64_tr_b16 v[170:171], v28 offset:8704
s_waitcnt lgkmcnt(4)
v_mfma_f32_16x16x32_bf16 v[80:83], v[200:203], v[228:231], v[80:83]
v_mfma_f32_16x16x32_bf16 v[84:87], v[200:203], v[232:235], v[84:87]
v_mfma_f32_16x16x32_bf16 v[88:91], v[200:203], v[236:239], v[88:91]
ds_read_b128 v[204:207], v32 offset:3072
s_waitcnt vmcnt(4)
ds_read_b64_tr_b16 v[172:173], v25 offset:0
ds_read_b64_tr_b16 v[174:175], v25 offset:512
s_waitcnt lgkmcnt(5)
v_mfma_f32_16x16x32_bf16 v[92:95], v[164:167], v[228:231], v[92:95]
ds_read_b128 v[208:211], v32 offset:11264
v_mfma_f32_16x16x32_bf16 v[96:99], v[164:167], v[232:235], v[96:99]
ds_read_b128 v[212:215], v32 offset:19456
v_mfma_f32_16x16x32_bf16 v[100:103], v[164:167], v[236:239], v[100:103]
ds_read_b64_tr_b16 v[176:177], v26 offset:0
ds_read_b64_tr_b16 v[178:179], v26 offset:512
s_waitcnt lgkmcnt(7)
v_mfma_f32_16x16x32_bf16 v[104:107], v[168:171], v[228:231], v[104:107]
s_add_u32 m0, s63, 0x2000
s_nop 0
buffer_load_dwordx4 v17, s[44:47], s71 offen offset:0 lds
buffer_load_dwordx4 v18, s[44:47], s71 offen offset:1024 lds
buffer_load_dwordx4 v19, s[44:47], s71 offen offset:2048 lds
buffer_load_dwordx4 v20, s[44:47], s71 offen offset:3072 lds
v_mfma_f32_16x16x32_bf16 v[108:111], v[168:171], v[232:235], v[108:111]
v_mfma_f32_16x16x32_bf16 v[112:115], v[168:171], v[236:239], v[112:115]
ds_read_b64_tr_b16 v[180:181], v27 offset:0
ds_read_b64_tr_b16 v[182:183], v27 offset:512
s_waitcnt lgkmcnt(6)
v_mfma_f32_16x16x32_bf16 v[68:71], v[172:175], v[204:207], v[68:71]
s_waitcnt lgkmcnt(5)
v_mfma_f32_16x16x32_bf16 v[72:75], v[172:175], v[208:211], v[72:75]
s_waitcnt lgkmcnt(4)
v_mfma_f32_16x16x32_bf16 v[76:79], v[172:175], v[212:215], v[76:79]
ds_read_b64_tr_b16 v[184:185], v28 offset:0
ds_read_b64_tr_b16 v[186:187], v28 offset:512
s_waitcnt lgkmcnt(4)
v_mfma_f32_16x16x32_bf16 v[80:83], v[176:179], v[204:207], v[80:83]
v_mfma_f32_16x16x32_bf16 v[84:87], v[176:179], v[208:211], v[84:87]
v_mfma_f32_16x16x32_bf16 v[88:91], v[176:179], v[212:215], v[88:91]
ds_read_b128 v[216:219], v31 offset:4096
s_waitcnt vmcnt(4)
ds_read_b64_tr_b16 v[188:189], v25 offset:4096
ds_read_b64_tr_b16 v[190:191], v25 offset:4608
s_waitcnt lgkmcnt(5)
v_mfma_f32_16x16x32_bf16 v[92:95], v[180:183], v[204:207], v[92:95]
ds_read_b128 v[220:223], v31 offset:12288
v_mfma_f32_16x16x32_bf16 v[96:99], v[180:183], v[208:211], v[96:99]
ds_read_b128 v[224:227], v31 offset:20480
v_mfma_f32_16x16x32_bf16 v[100:103], v[180:183], v[212:215], v[100:103]
ds_read_b64_tr_b16 v[192:193], v26 offset:4096
ds_read_b64_tr_b16 v[194:195], v26 offset:4608
s_waitcnt lgkmcnt(7)
v_mfma_f32_16x16x32_bf16 v[104:107], v[184:187], v[204:207], v[104:107]
s_add_u32 m0, s63, 0x0
s_nop 0
buffer_load_dwordx4 v17, s[44:47], s72 offen offset:0 lds
buffer_load_dwordx4 v18, s[44:47], s72 offen offset:1024 lds
buffer_load_dwordx4 v19, s[44:47], s72 offen offset:2048 lds
buffer_load_dwordx4 v20, s[44:47], s72 offen offset:3072 lds
v_mfma_f32_16x16x32_bf16 v[108:111], v[184:187], v[208:211], v[108:111]
v_mfma_f32_16x16x32_bf16 v[112:115], v[184:187], v[212:215], v[112:115]
ds_read_b64_tr_b16 v[196:197], v27 offset:4096
ds_read_b64_tr_b16 v[198:199], v27 offset:4608
s_waitcnt lgkmcnt(6)
v_mfma_f32_16x16x32_bf16 v[68:71], v[188:191], v[216:219], v[68:71]
s_waitcnt lgkmcnt(5)
v_mfma_f32_16x16x32_bf16 v[72:75], v[188:191], v[220:223], v[72:75]
s_waitcnt lgkmcnt(4)
v_mfma_f32_16x16x32_bf16 v[76:79], v[188:191], v[224:227], v[76:79]
ds_read_b64_tr_b16 v[200:201], v28 offset:4096
ds_read_b64_tr_b16 v[202:203], v28 offset:4608
s_waitcnt lgkmcnt(4)
v_mfma_f32_16x16x32_bf16 v[80:83], v[192:195], v[216:219], v[80:83]
v_mfma_f32_16x16x32_bf16 v[84:87], v[192:195], v[220:223], v[84:87]
v_mfma_f32_16x16x32_bf16 v[88:91], v[192:195], v[224:227], v[88:91]
ds_read_b128 v[228:231], v32 offset:5120
s_waitcnt vmcnt(4)
ds_read_b64_tr_b16 v[164:165], v25 offset:8192
ds_read_b64_tr_b16 v[166:167], v25 offset:8704
s_waitcnt lgkmcnt(5)
v_mfma_f32_16x16x32_bf16 v[92:95], v[196:199], v[216:219], v[92:95]
ds_read_b128 v[232:235], v32 offset:13312
v_mfma_f32_16x16x32_bf16 v[96:99], v[196:199], v[220:223], v[96:99]
ds_read_b128 v[236:239], v32 offset:21504
v_mfma_f32_16x16x32_bf16 v[100:103], v[196:199], v[224:227], v[100:103]
ds_read_b64_tr_b16 v[168:169], v26 offset:8192
ds_read_b64_tr_b16 v[170:171], v26 offset:8704
s_waitcnt lgkmcnt(7)
v_mfma_f32_16x16x32_bf16 v[104:107], v[200:203], v[216:219], v[104:107]
s_add_u32 m0, s63, 0x1000
s_nop 0
buffer_load_dwordx4 v17, s[44:47], s73 offen offset:0 lds
buffer_load_dwordx4 v18, s[44:47], s73 offen offset:1024 lds
buffer_load_dwordx4 v19, s[44:47], s73 offen offset:2048 lds
buffer_load_dwordx4 v20, s[44:47], s73 offen offset:3072 lds
v_mfma_f32_16x16x32_bf16 v[108:111], v[200:203], v[220:223], v[108:111]
v_mfma_f32_16x16x32_bf16 v[112:115], v[200:203], v[224:227], v[112:115]
ds_read_b64_tr_b16 v[172:173], v27 offset:8192
ds_read_b64_tr_b16 v[174:175], v27 offset:8704
s_waitcnt lgkmcnt(6)
v_mfma_f32_16x16x32_bf16 v[68:71], v[164:167], v[228:231], v[68:71]
s_waitcnt lgkmcnt(5)
v_mfma_f32_16x16x32_bf16 v[72:75], v[164:167], v[232:235], v[72:75]
s_waitcnt lgkmcnt(4)
v_mfma_f32_16x16x32_bf16 v[76:79], v[164:167], v[236:239], v[76:79]
ds_read_b64_tr_b16 v[176:177], v28 offset:8192
ds_read_b64_tr_b16 v[178:179], v28 offset:8704
s_waitcnt lgkmcnt(4)
v_mfma_f32_16x16x32_bf16 v[80:83], v[168:171], v[228:231], v[80:83]
v_mfma_f32_16x16x32_bf16 v[84:87], v[168:171], v[232:235], v[84:87]
v_mfma_f32_16x16x32_bf16 v[88:91], v[168:171], v[236:239], v[88:91]
ds_read_b128 v[204:207], v31 offset:6144
s_waitcnt vmcnt(4)
ds_read_b64_tr_b16 v[180:181], v25 offset:0
ds_read_b64_tr_b16 v[182:183], v25 offset:512
s_waitcnt lgkmcnt(5)
v_mfma_f32_16x16x32_bf16 v[92:95], v[172:175], v[228:231], v[92:95]
ds_read_b128 v[208:211], v31 offset:14336
v_mfma_f32_16x16x32_bf16 v[96:99], v[172:175], v[232:235], v[96:99]
ds_read_b128 v[212:215], v31 offset:22528
v_mfma_f32_16x16x32_bf16 v[100:103], v[172:175], v[236:239], v[100:103]
ds_read_b64_tr_b16 v[184:185], v26 offset:0
ds_read_b64_tr_b16 v[186:187], v26 offset:512
s_waitcnt lgkmcnt(7)
v_mfma_f32_16x16x32_bf16 v[104:107], v[176:179], v[228:231], v[104:107]
s_add_u32 m0, s63, 0x2000
s_nop 0
buffer_load_dwordx4 v21, s[48:51], s74 offen offset:0 lds
buffer_load_dwordx4 v22, s[48:51], s74 offen offset:1024 lds
buffer_load_dwordx4 v23, s[48:51], s74 offen offset:2048 lds
buffer_load_dwordx4 v24, s[48:51], s74 offen offset:3072 lds
v_mfma_f32_16x16x32_bf16 v[108:111], v[176:179], v[232:235], v[108:111]
v_mfma_f32_16x16x32_bf16 v[112:115], v[176:179], v[236:239], v[112:115]
ds_read_b64_tr_b16 v[188:189], v27 offset:0
ds_read_b64_tr_b16 v[190:191], v27 offset:512
s_waitcnt lgkmcnt(6)
v_mfma_f32_16x16x32_bf16 v[68:71], v[180:183], v[204:207], v[68:71]
s_waitcnt lgkmcnt(5)
v_mfma_f32_16x16x32_bf16 v[72:75], v[180:183], v[208:211], v[72:75]
s_waitcnt lgkmcnt(4)
v_mfma_f32_16x16x32_bf16 v[76:79], v[180:183], v[212:215], v[76:79]
ds_read_b64_tr_b16 v[192:193], v28 offset:0
ds_read_b64_tr_b16 v[194:195], v28 offset:512
s_waitcnt lgkmcnt(4)
v_mfma_f32_16x16x32_bf16 v[80:83], v[184:187], v[204:207], v[80:83]
v_mfma_f32_16x16x32_bf16 v[84:87], v[184:187], v[208:211], v[84:87]
v_mfma_f32_16x16x32_bf16 v[88:91], v[184:187], v[212:215], v[88:91]
ds_read_b128 v[216:219], v32 offset:7168
s_waitcnt vmcnt(4)
ds_read_b64_tr_b16 v[196:197], v25 offset:4096
ds_read_b64_tr_b16 v[198:199], v25 offset:4608
s_waitcnt lgkmcnt(5)
v_mfma_f32_16x16x32_bf16 v[92:95], v[188:191], v[204:207], v[92:95]
ds_read_b128 v[220:223], v32 offset:15360
v_mfma_f32_16x16x32_bf16 v[96:99], v[188:191], v[208:211], v[96:99]
ds_read_b128 v[224:227], v32 offset:23552
v_mfma_f32_16x16x32_bf16 v[100:103], v[188:191], v[212:215], v[100:103]
ds_read_b64_tr_b16 v[200:201], v26 offset:4096
ds_read_b64_tr_b16 v[202:203], v26 offset:4608
s_waitcnt lgkmcnt(7)
v_mfma_f32_16x16x32_bf16 v[104:107], v[192:195], v[204:207], v[104:107]
s_add_u32 m0, s63, 0x0
s_nop 0
buffer_load_dwordx4 v21, s[48:51], s75 offen offset:0 lds
buffer_load_dwordx4 v22, s[48:51], s75 offen offset:1024 lds
buffer_load_dwordx4 v23, s[48:51], s75 offen offset:2048 lds
buffer_load_dwordx4 v24, s[48:51], s75 offen offset:3072 lds
v_mfma_f32_16x16x32_bf16 v[108:111], v[192:195], v[208:211], v[108:111]
v_mfma_f32_16x16x32_bf16 v[112:115], v[192:195], v[212:215], v[112:115]
ds_read_b64_tr_b16 v[164:165], v27 offset:4096
ds_read_b64_tr_b16 v[166:167], v27 offset:4608
s_waitcnt lgkmcnt(6)
v_mfma_f32_16x16x32_bf16 v[68:71], v[196:199], v[216:219], v[68:71]
s_waitcnt lgkmcnt(5)
v_mfma_f32_16x16x32_bf16 v[72:75], v[196:199], v[220:223], v[72:75]
s_waitcnt lgkmcnt(4)
v_mfma_f32_16x16x32_bf16 v[76:79], v[196:199], v[224:227], v[76:79]
ds_read_b64_tr_b16 v[168:169], v28 offset:4096
ds_read_b64_tr_b16 v[170:171], v28 offset:4608
s_waitcnt lgkmcnt(4)
v_mfma_f32_16x16x32_bf16 v[80:83], v[200:203], v[216:219], v[80:83]
v_cvt_pk_bf16_f32 v68, v68, v69
v_cvt_pk_bf16_f32 v69, v70, v71
ds_write_b64 v33, v[68:69] offset:0
v_mfma_f32_16x16x32_bf16 v[84:87], v[200:203], v[220:223], v[84:87]
v_cvt_pk_bf16_f32 v72, v72, v73
v_cvt_pk_bf16_f32 v73, v74, v75
ds_write_b64 v33, v[72:73] offset:8192
v_mfma_f32_16x16x32_bf16 v[88:91], v[200:203], v[224:227], v[88:91]
v_cvt_pk_bf16_f32 v76, v76, v77
v_cvt_pk_bf16_f32 v77, v78, v79
ds_write_b64 v33, v[76:77] offset:16384
s_waitcnt lgkmcnt(5)
v_mfma_f32_16x16x32_bf16 v[92:95], v[164:167], v[216:219], v[92:95]
v_cvt_pk_bf16_f32 v80, v80, v81
v_cvt_pk_bf16_f32 v81, v82, v83
ds_write_b64 v33, v[80:81] offset:512
v_mfma_f32_16x16x32_bf16 v[96:99], v[164:167], v[220:223], v[96:99]
v_cvt_pk_bf16_f32 v84, v84, v85
v_cvt_pk_bf16_f32 v85, v86, v87
ds_write_b64 v33, v[84:85] offset:8704
v_mfma_f32_16x16x32_bf16 v[100:103], v[164:167], v[224:227], v[100:103]
v_cvt_pk_bf16_f32 v88, v88, v89
v_cvt_pk_bf16_f32 v89, v90, v91
ds_write_b64 v33, v[88:89] offset:16896
s_waitcnt lgkmcnt(6)
v_mfma_f32_16x16x32_bf16 v[104:107], v[168:171], v[216:219], v[104:107]
v_cvt_pk_bf16_f32 v92, v92, v93
v_cvt_pk_bf16_f32 v93, v94, v95
ds_write_b64 v34, v[92:93] offset:0
s_add_u32 m0, s63, 0x1000
s_nop 0
buffer_load_dwordx4 v21, s[48:51], s76 offen offset:0 lds
buffer_load_dwordx4 v22, s[48:51], s76 offen offset:1024 lds
buffer_load_dwordx4 v23, s[48:51], s76 offen offset:2048 lds
buffer_load_dwordx4 v24, s[48:51], s76 offen offset:3072 lds
v_mfma_f32_16x16x32_bf16 v[108:111], v[168:171], v[220:223], v[108:111]
v_cvt_pk_bf16_f32 v96, v96, v97
v_cvt_pk_bf16_f32 v97, v98, v99
ds_write_b64 v34, v[96:97] offset:8192
v_mfma_f32_16x16x32_bf16 v[112:115], v[168:171], v[224:227], v[112:115]
v_cvt_pk_bf16_f32 v100, v100, v101
v_cvt_pk_bf16_f32 v101, v102, v103
ds_write_b64 v34, v[100:101] offset:16384
v_cvt_pk_bf16_f32 v104, v104, v105
v_cvt_pk_bf16_f32 v105, v106, v107
ds_write_b64 v34, v[104:105] offset:512
v_cvt_pk_bf16_f32 v108, v108, v109
v_cvt_pk_bf16_f32 v109, v110, v111
ds_write_b64 v34, v[108:109] offset:8704
v_cvt_pk_bf16_f32 v112, v112, v113
v_cvt_pk_bf16_f32 v113, v114, v115
ds_write_b64 v34, v[112:113] offset:16896
s_waitcnt vmcnt(8)
ds_read_b128 v[172:175], v29 offset:8192
ds_read_b128 v[176:179], v30 offset:8192
ds_read_b128 v[180:183], v29 offset:10240
s_waitcnt lgkmcnt(3)
s_barrier
ds_read_b128 v[228:231], v35 offset:0
ds_read_b128 v[232:235], v35 offset:8192
ds_read_b128 v[236:239], v35 offset:16384
ds_read_b128 v[204:207], v35 offset:1024
ds_read_b128 v[208:211], v35 offset:9216
ds_read_b128 v[212:215], v35 offset:17408
s_waitcnt lgkmcnt(5)
v_mfma_f32_16x16x32_bf16 v[116:119], v[172:175], v[228:231], 0
s_waitcnt lgkmcnt(4)
v_mfma_f32_16x16x32_bf16 v[132:135], v[172:175], v[232:235], 0
s_waitcnt lgkmcnt(3)
v_mfma_f32_16x16x32_bf16 v[148:151], v[172:175], v[236:239], 0
ds_read_b128 v[184:187], v30 offset:10240
s_waitcnt lgkmcnt(3)
v_mfma_f32_16x16x32_bf16 v[116:119], v[176:179], v[204:207], v[116:119]
s_waitcnt lgkmcnt(2)
v_mfma_f32_16x16x32_bf16 v[132:135], v[176:179], v[208:211], v[132:135]
s_waitcnt lgkmcnt(1)
v_mfma_f32_16x16x32_bf16 v[148:151], v[176:179], v[212:215], v[148:151]
s_waitcnt vmcnt(4)
ds_read_b128 v[188:191], v29 offset:0
v_mfma_f32_16x16x32_bf16 v[120:123], v[180:183], v[228:231], 0
v_mfma_f32_16x16x32_bf16 v[136:139], v[180:183], v[232:235], 0
v_mfma_f32_16x16x32_bf16 v[152:155], v[180:183], v[236:239], 0
ds_read_b128 v[192:195], v30 offset:0
s_waitcnt lgkmcnt(2)
v_mfma_f32_16x16x32_bf16 v[120:123], v[184:187], v[204:207], v[120:123]
s_add_u32 m0, s63, 0x2000
s_nop 0
buffer_load_dwordx4 v21, s[48:51], s77 offen offset:0 lds
buffer_load_dwordx4 v22, s[48:51], s77 offen offset:1024 lds
buffer_load_dwordx4 v23, s[48:51], s77 offen offset:2048 lds
buffer_load_dwordx4 v24, s[48:51], s77 offen offset:3072 lds
v_mfma_f32_16x16x32_bf16 v[136:139], v[184:187], v[208:211], v[136:139]
v_mfma_f32_16x16x32_bf16 v[152:155], v[184:187], v[212:215], v[152:155]
ds_read_b128 v[196:199], v29 offset:2048
s_waitcnt lgkmcnt(2)
v_mfma_f32_16x16x32_bf16 v[124:127], v[188:191], v[228:231], 0
v_mfma_f32_16x16x32_bf16 v[140:143], v[188:191], v[232:235], 0
v_mfma_f32_16x16x32_bf16 v[156:159], v[188:191], v[236:239], 0
ds_read_b128 v[200:203], v30 offset:2048
s_waitcnt lgkmcnt(2)
v_mfma_f32_16x16x32_bf16 v[124:127], v[192:195], v[204:207], v[124:127]
v_mfma_f32_16x16x32_bf16 v[140:143], v[192:195], v[208:211], v[140:143]
v_mfma_f32_16x16x32_bf16 v[156:159], v[192:195], v[212:215], v[156:159]
ds_read_b128 v[216:219], v35 offset:2048
s_waitcnt vmcnt(4)
ds_read_b128 v[164:167], v29 offset:4096
s_waitcnt lgkmcnt(3)
v_mfma_f32_16x16x32_bf16 v[128:131], v[196:199], v[228:231], 0
ds_read_b128 v[220:223], v35 offset:10240
v_mfma_f32_16x16x32_bf16 v[144:147], v[196:199], v[232:235], 0
ds_read_b128 v[224:227], v35 offset:18432
v_mfma_f32_16x16x32_bf16 v[160:163], v[196:199], v[236:239], 0
ds_read_b128 v[228:231], v35 offset:3072
ds_read_b128 v[168:171], v30 offset:4096
s_waitcnt lgkmcnt(6)
v_mfma_f32_16x16x32_bf16 v[128:131], v[200:203], v[204:207], v[128:131]
ds_read_b128 v[232:235], v35 offset:11264
s_add_u32 m0, s63, 0x0
s_nop 0
buffer_load_dwordx4 v21, s[48:51], s78 offen offset:0 lds
buffer_load_dwordx4 v22, s[48:51], s78 offen offset:1024 lds
buffer_load_dwordx4 v23, s[48:51], s78 offen offset:2048 lds
buffer_load_dwordx4 v24, s[48:51], s78 offen offset:3072 lds
v_mfma_f32_16x16x32_bf16 v[144:147], v[200:203], v[208:211], v[144:147]
ds_read_b128 v[236:239], v35 offset:19456
v_mfma_f32_16x16x32_bf16 v[160:163], v[200:203], v[212:215], v[160:163]
ds_read_b128 v[172:175], v29 offset:6144
s_waitcnt lgkmcnt(7)
v_mfma_f32_16x16x32_bf16 v[116:119], v[164:167], v[216:219], v[116:119]
s_waitcnt lgkmcnt(6)
v_mfma_f32_16x16x32_bf16 v[132:135], v[164:167], v[220:223], v[132:135]
s_waitcnt lgkmcnt(5)
v_mfma_f32_16x16x32_bf16 v[148:151], v[164:167], v[224:227], v[148:151]
ds_read_b128 v[176:179], v30 offset:6144
s_waitcnt lgkmcnt(4)
v_mfma_f32_16x16x32_bf16 v[116:119], v[168:171], v[228:231], v[116:119]
s_waitcnt lgkmcnt(3)
v_mfma_f32_16x16x32_bf16 v[132:135], v[168:171], v[232:235], v[132:135]
s_waitcnt lgkmcnt(2)
v_mfma_f32_16x16x32_bf16 v[148:151], v[168:171], v[236:239], v[148:151]
s_waitcnt vmcnt(4)
ds_read_b128 v[180:183], v29 offset:8192
s_waitcnt lgkmcnt(2)
v_mfma_f32_16x16x32_bf16 v[120:123], v[172:175], v[216:219], v[120:123]
v_mfma_f32_16x16x32_bf16 v[136:139], v[172:175], v[220:223], v[136:139]
v_mfma_f32_16x16x32_bf16 v[152:155], v[172:175], v[224:227], v[152:155]
ds_read_b128 v[184:187], v30 offset:8192
s_waitcnt lgkmcnt(2)
v_mfma_f32_16x16x32_bf16 v[120:123], v[176:179], v[228:231], v[120:123]
s_add_u32 m0, s63, 0x1000
s_nop 0
buffer_load_dwordx4 v21, s[48:51], s79 offen offset:0 lds
buffer_load_dwordx4 v22, s[48:51], s79 offen offset:1024 lds
buffer_load_dwordx4 v23, s[48:51], s79 offen offset:2048 lds
buffer_load_dwordx4 v24, s[48:51], s79 offen offset:3072 lds
v_mfma_f32_16x16x32_bf16 v[136:139], v[176:179], v[232:235], v[136:139]
v_mfma_f32_16x16x32_bf16 v[152:155], v[176:179], v[236:239], v[152:155]
ds_read_b128 v[188:191], v29 offset:10240
s_waitcnt lgkmcnt(2)
v_mfma_f32_16x16x32_bf16 v[124:127], v[180:183], v[216:219], v[124:127]
v_mfma_f32_16x16x32_bf16 v[140:143], v[180:183], v[220:223], v[140:143]
v_mfma_f32_16x16x32_bf16 v[156:159], v[180:183], v[224:227], v[156:159]
ds_read_b128 v[192:195], v30 offset:10240
s_waitcnt lgkmcnt(2)
v_mfma_f32_16x16x32_bf16 v[124:127], v[184:187], v[228:231], v[124:127]
v_mfma_f32_16x16x32_bf16 v[140:143], v[184:187], v[232:235], v[140:143]
v_mfma_f32_16x16x32_bf16 v[156:159], v[184:187], v[236:239], v[156:159]
ds_read_b128 v[204:207], v35 offset:4096
s_waitcnt vmcnt(4)
ds_read_b128 v[196:199], v29 offset:0
s_waitcnt lgkmcnt(3)
v_mfma_f32_16x16x32_bf16 v[128:131], v[188:191], v[216:219], v[128:131]
ds_read_b128 v[208:211], v35 offset:12288
v_mfma_f32_16x16x32_bf16 v[144:147], v[188:191], v[220:223], v[144:147]
ds_read_b128 v[212:215], v35 offset:20480
v_mfma_f32_16x16x32_bf16 v[160:163], v[188:191], v[224:227], v[160:163]
ds_read_b128 v[216:219], v35 offset:5120
ds_read_b128 v[200:203], v30 offset:0
s_waitcnt lgkmcnt(6)
v_mfma_f32_16x16x32_bf16 v[128:131], v[192:195], v[228:231], v[128:131]
ds_read_b128 v[220:223], v35 offset:13312
s_add_u32 m0, s63, 0x2000
s_nop 0
buffer_load_dwordx4 v21, s[48:51], s80 offen offset:0 lds
buffer_load_dwordx4 v22, s[48:51], s80 offen offset:1024 lds
buffer_load_dwordx4 v23, s[48:51], s80 offen offset:2048 lds
buffer_load_dwordx4 v24, s[48:51], s80 offen offset:3072 lds
v_mfma_f32_16x16x32_bf16 v[144:147], v[192:195], v[232:235], v[144:147]
ds_read_b128 v[224:227], v35 offset:21504
v_mfma_f32_16x16x32_bf16 v[160:163], v[192:195], v[236:239], v[160:163]
ds_read_b128 v[164:167], v29 offset:2048
s_waitcnt lgkmcnt(7)
v_mfma_f32_16x16x32_bf16 v[116:119], v[196:199], v[204:207], v[116:119]
s_waitcnt lgkmcnt(6)
v_mfma_f32_16x16x32_bf16 v[132:135], v[196:199], v[208:211], v[132:135]
s_waitcnt lgkmcnt(5)
v_mfma_f32_16x16x32_bf16 v[148:151], v[196:199], v[212:215], v[148:151]
ds_read_b128 v[168:171], v30 offset:2048
s_waitcnt lgkmcnt(4)
v_mfma_f32_16x16x32_bf16 v[116:119], v[200:203], v[216:219], v[116:119]
s_waitcnt lgkmcnt(3)
v_mfma_f32_16x16x32_bf16 v[132:135], v[200:203], v[220:223], v[132:135]
s_waitcnt lgkmcnt(2)
v_mfma_f32_16x16x32_bf16 v[148:151], v[200:203], v[224:227], v[148:151]
s_waitcnt vmcnt(4)
ds_read_b128 v[172:175], v29 offset:4096
s_waitcnt lgkmcnt(2)
v_mfma_f32_16x16x32_bf16 v[120:123], v[164:167], v[204:207], v[120:123]
v_mfma_f32_16x16x32_bf16 v[136:139], v[164:167], v[208:211], v[136:139]
v_mfma_f32_16x16x32_bf16 v[152:155], v[164:167], v[212:215], v[152:155]
ds_read_b128 v[176:179], v30 offset:4096
s_waitcnt lgkmcnt(2)
v_mfma_f32_16x16x32_bf16 v[120:123], v[168:171], v[216:219], v[120:123]
s_add_u32 m0, s63, 0x0
s_nop 0
buffer_load_dwordx4 v21, s[48:51], s81 offen offset:0 lds
buffer_load_dwordx4 v22, s[48:51], s81 offen offset:1024 lds
buffer_load_dwordx4 v23, s[48:51], s81 offen offset:2048 lds
buffer_load_dwordx4 v24, s[48:51], s81 offen offset:3072 lds
v_mfma_f32_16x16x32_bf16 v[136:139], v[168:171], v[220:223], v[136:139]
buffer_store_dwordx4 v[44:47], v16, s[56:59], s64 offen offset:0 sc1
buffer_store_dwordx4 v[48:51], v16, s[56:59], s64 offen offset:1024 sc1
v_mfma_f32_16x16x32_bf16 v[152:155], v[168:171], v[224:227], v[152:155]
ds_read_b128 v[180:183], v29 offset:6144
buffer_store_dwordx4 v[52:55], v16, s[56:59], s64 offen offset:2048 sc1
s_waitcnt lgkmcnt(2)
v_mfma_f32_16x16x32_bf16 v[124:127], v[172:175], v[204:207], v[124:127]
buffer_store_dwordx4 v[56:59], v16, s[56:59], s64 offen offset:3072 sc1
buffer_store_dwordx4 v[60:63], v16, s[56:59], s65 offen offset:0 sc1
v_mfma_f32_16x16x32_bf16 v[140:143], v[172:175], v[208:211], v[140:143]
buffer_store_dwordx4 v[64:67], v16, s[56:59], s65 offen offset:1024 sc1
v_mfma_f32_16x16x32_bf16 v[156:159], v[172:175], v[212:215], v[156:159]
ds_read_b128 v[184:187], v30 offset:6144
s_waitcnt lgkmcnt(2)
v_mfma_f32_16x16x32_bf16 v[124:127], v[176:179], v[216:219], v[124:127]
v_mfma_f32_16x16x32_bf16 v[140:143], v[176:179], v[220:223], v[140:143]
v_mfma_f32_16x16x32_bf16 v[156:159], v[176:179], v[224:227], v[156:159]
ds_read_b128 v[228:231], v35 offset:6144
s_waitcnt vmcnt(10)
ds_read_b128 v[188:191], v29 offset:8192
s_waitcnt lgkmcnt(3)
v_mfma_f32_16x16x32_bf16 v[128:131], v[180:183], v[204:207], v[128:131]
ds_read_b128 v[232:235], v35 offset:14336
v_mfma_f32_16x16x32_bf16 v[144:147], v[180:183], v[208:211], v[144:147]
ds_read_b128 v[236:239], v35 offset:22528
v_mfma_f32_16x16x32_bf16 v[160:163], v[180:183], v[212:215], v[160:163]
ds_read_b128 v[204:207], v35 offset:7168
ds_read_b128 v[192:195], v30 offset:8192
s_waitcnt lgkmcnt(6)
v_mfma_f32_16x16x32_bf16 v[128:131], v[184:187], v[216:219], v[128:131]
ds_read_b128 v[208:211], v35 offset:15360
v_mfma_f32_16x16x32_bf16 v[144:147], v[184:187], v[220:223], v[144:147]
ds_read_b128 v[212:215], v35 offset:23552
v_mfma_f32_16x16x32_bf16 v[160:163], v[184:187], v[224:227], v[160:163]
ds_read_b128 v[196:199], v29 offset:10240
s_waitcnt lgkmcnt(7)
v_mfma_f32_16x16x32_bf16 v[116:119], v[188:191], v[228:231], v[116:119]
s_waitcnt lgkmcnt(6)
v_mfma_f32_16x16x32_bf16 v[132:135], v[188:191], v[232:235], v[132:135]
s_waitcnt lgkmcnt(5)
v_mfma_f32_16x16x32_bf16 v[148:151], v[188:191], v[236:239], v[148:151]
ds_read_b128 v[200:203], v30 offset:10240
s_waitcnt lgkmcnt(4)
v_mfma_f32_16x16x32_bf16 v[116:119], v[192:195], v[204:207], v[116:119]
s_waitcnt lgkmcnt(3)
v_mfma_f32_16x16x32_bf16 v[132:135], v[192:195], v[208:211], v[132:135]
s_waitcnt lgkmcnt(2)
v_mfma_f32_16x16x32_bf16 v[148:151], v[192:195], v[212:215], v[148:151]
s_waitcnt vmcnt(6)
ds_read_b128 v[164:167], v29 offset:0
s_waitcnt lgkmcnt(2)
v_mfma_f32_16x16x32_bf16 v[120:123], v[196:199], v[228:231], v[120:123]
v_mfma_f32_16x16x32_bf16 v[136:139], v[196:199], v[232:235], v[136:139]
v_mfma_f32_16x16x32_bf16 v[152:155], v[196:199], v[236:239], v[152:155]
ds_read_b128 v[168:171], v30 offset:0
s_waitcnt lgkmcnt(2)
v_mfma_f32_16x16x32_bf16 v[120:123], v[200:203], v[204:207], v[120:123]
v_mfma_f32_16x16x32_bf16 v[136:139], v[200:203], v[208:211], v[136:139]
v_mfma_f32_16x16x32_bf16 v[152:155], v[200:203], v[212:215], v[152:155]
ds_read_b128 v[172:175], v29 offset:2048
s_waitcnt lgkmcnt(2)
v_mfma_f32_16x16x32_bf16 v[124:127], v[164:167], v[228:231], v[124:127]
v_mul_f32 v116, s86, v116
v_mul_f32 v117, s86, v117
v_mul_f32 v118, s86, v118
v_mul_f32 v119, s86, v119
v_mul_f32 v120, s86, v120
v_mul_f32 v121, s86, v121
v_mul_f32 v122, s86, v122
v_mul_f32 v123, s86, v123
v_cvt_pk_bf16_f32 v116, v116, v117
v_cvt_pk_bf16_f32 v117, v118, v119
v_cvt_pk_bf16_f32 v118, v120, v121
v_cvt_pk_bf16_f32 v119, v122, v123
buffer_store_dwordx4 v[116:119], v16, s[52:55], s82 offen offset:0 sc1
v_mfma_f32_16x16x32_bf16 v[140:143], v[164:167], v[232:235], v[140:143]
v_mul_f32 v132, s86, v132
v_mul_f32 v133, s86, v133
v_mul_f32 v134, s86, v134
v_mul_f32 v135, s86, v135
v_mul_f32 v136, s86, v136
v_mul_f32 v137, s86, v137
v_mul_f32 v138, s86, v138
v_mul_f32 v139, s86, v139
v_cvt_pk_bf16_f32 v132, v132, v133
v_cvt_pk_bf16_f32 v133, v134, v135
v_cvt_pk_bf16_f32 v134, v136, v137
v_cvt_pk_bf16_f32 v135, v138, v139
buffer_store_dwordx4 v[132:135], v16, s[52:55], s83 offen offset:0 sc1
v_mfma_f32_16x16x32_bf16 v[156:159], v[164:167], v[236:239], v[156:159]
ds_read_b128 v[176:179], v30 offset:2048
v_mul_f32 v148, s86, v148
v_mul_f32 v149, s86, v149
v_mul_f32 v150, s86, v150
v_mul_f32 v151, s86, v151
v_mul_f32 v152, s86, v152
v_mul_f32 v153, s86, v153
v_mul_f32 v154, s86, v154
v_mul_f32 v155, s86, v155
v_cvt_pk_bf16_f32 v148, v148, v149
v_cvt_pk_bf16_f32 v149, v150, v151
v_cvt_pk_bf16_f32 v150, v152, v153
v_cvt_pk_bf16_f32 v151, v154, v155
buffer_store_dwordx4 v[148:151], v16, s[52:55], s84 offen offset:0 sc1
s_waitcnt lgkmcnt(2)
v_mfma_f32_16x16x32_bf16 v[124:127], v[168:171], v[204:207], v[124:127]
v_mfma_f32_16x16x32_bf16 v[140:143], v[168:171], v[208:211], v[140:143]
v_mfma_f32_16x16x32_bf16 v[156:159], v[168:171], v[212:215], v[156:159]
s_waitcnt lgkmcnt(1)
v_mfma_f32_16x16x32_bf16 v[128:131], v[172:175], v[228:231], v[128:131]
v_mfma_f32_16x16x32_bf16 v[144:147], v[172:175], v[232:235], v[144:147]
v_mfma_f32_16x16x32_bf16 v[160:163], v[172:175], v[236:239], v[160:163]
s_waitcnt lgkmcnt(0)
v_mfma_f32_16x16x32_bf16 v[128:131], v[176:179], v[204:207], v[128:131]
v_mfma_f32_16x16x32_bf16 v[144:147], v[176:179], v[208:211], v[144:147]
v_mfma_f32_16x16x32_bf16 v[160:163], v[176:179], v[212:215], v[160:163]
v_mul_f32 v124, s86, v124
v_mul_f32 v125, s86, v125
v_mul_f32 v126, s86, v126
v_mul_f32 v127, s86, v127
s_nop 1
v_mul_f32 v128, s86, v128
v_mul_f32 v129, s86, v129
v_mul_f32 v130, s86, v130
v_mul_f32 v131, s86, v131
v_cvt_pk_bf16_f32 v124, v124, v125
v_cvt_pk_bf16_f32 v125, v126, v127
v_cvt_pk_bf16_f32 v126, v128, v129
v_cvt_pk_bf16_f32 v127, v130, v131
buffer_store_dwordx4 v[124:127], v16, s[52:55], s82 offen offset:1024 sc1
v_mul_f32 v140, s86, v140
v_mul_f32 v141, s86, v141
v_mul_f32 v142, s86, v142
v_mul_f32 v143, s86, v143
v_mul_f32 v144, s86, v144
v_mul_f32 v145, s86, v145
v_mul_f32 v146, s86, v146
v_mul_f32 v147, s86, v147
v_cvt_pk_bf16_f32 v140, v140, v141
v_cvt_pk_bf16_f32 v141, v142, v143
v_cvt_pk_bf16_f32 v142, v144, v145
v_cvt_pk_bf16_f32 v143, v146, v147
buffer_store_dwordx4 v[140:143], v16, s[52:55], s83 offen offset:1024 sc1
v_mul_f32 v156, s86, v156
v_mul_f32 v157, s86, v157
v_mul_f32 v158, s86, v158
v_mul_f32 v159, s86, v159
v_mul_f32 v160, s86, v160
v_mul_f32 v161, s86, v161
v_mul_f32 v162, s86, v162
v_mul_f32 v163, s86, v163
v_cvt_pk_bf16_f32 v156, v156, v157
v_cvt_pk_bf16_f32 v157, v158, v159
v_cvt_pk_bf16_f32 v158, v160, v161
v_cvt_pk_bf16_f32 v159, v162, v163
buffer_store_dwordx4 v[156:159], v16, s[52:55], s84 offen offset:1024 sc1
L1_fin:
s_add_u32 s91, s91, 1344
s_waitcnt lgkmcnt(0)
s_add_u32 s98, s98, 0x7f4a7c15
s_addc_u32 s99, s99, 0x9e3779b9
LM_pub:
s_add_u32 s40, s38, 0x7c00000
s_addc_u32 s41, s39, 0
s_mov_b32 s42, 0x40000
s_mov_b32 s43, 0x00020000
s_lshl_b32 s6, s91, 7
s_cmp_eq_u32 s60, 0
s_cselect_b32 s6, s6, 0x70000000
s_waitcnt vmcnt(0) lgkmcnt(0)
s_barrier
v_mov_b32 v6, s98
v_mov_b32 v7, s99
s_mov_b64 exec, 1
buffer_store_dwordx2 v[6:7], off, s[40:43], s6 sc1
s_mov_b64 exec, -1
s_cmp_eq_u32 s61, 0
s_cbranch_scc1 L2_entry
s_mov_b32 s61, 0
s_sub_u32 s4, s91, 1578
s_min_u32 s6, s4, 14
s_cmp_lt_u32 s4, 6
s_cselect_b32 s6, 0, s6
s_sub_u32 s4, s4, s6
s_add_u32 s91, s4, 1600
v_lshlrev_b32 v16, 4, v2
s_mul_i32 s63, s60, 12288
s_and_b32 s6, s4, 3
s_lshl_b32 s6, s6, 6
s_mul_i32 s7, s60, 16
s_add_u32 s6, s6, s7
v_lshrrev_b32 v5, 5, v2
v_and_b32 v6, 31, v2
v_lshlrev_b32 v6, 4, v6
s_cmp_ge_u32 s4, 4
s_cselect_b64 vcc, -1, 0
v_add3_u32 v7, v5, s6, 0
v_and_b32 v8, 0x80, v7
v_bfe_u32 v9, v7, 2, 1
v_lshl_or_b32 v8, v9, 6, v8
v_bfe_u32 v9, v7, 4, 1
v_lshl_or_b32 v8, v9, 5, v8
v_and_b32 v9, 3, v7
v_lshl_or_b32 v8, v9, 3, v8
v_bfe_u32 v9, v7, 5, 2
v_lshl_or_b32 v8, v9, 1, v8
v_bfe_u32 v9, v7, 3, 1
v_or_b32 v8, v9, v8
v_cndmask_b32 v8, v8, v7, vcc
v_lshl_add_u32 v44, v8, 9, v6
v_add3_u32 v7, v5, s6, 2
v_and_b32 v8, 0x80, v7
v_bfe_u32 v9, v7, 2, 1
v_lshl_or_b32 v8, v9, 6, v8
v_bfe_u32 v9, v7, 4, 1
v_lshl_or_b32 v8, v9, 5, v8
v_and_b32 v9, 3, v7
v_lshl_or_b32 v8, v9, 3, v8
v_bfe_u32 v9, v7, 5, 2
v_lshl_or_b32 v8, v9, 1, v8
v_bfe_u32 v9, v7, 3, 1
v_or_b32 v8, v9, v8
v_cndmask_b32 v8, v8, v7, vcc
v_lshl_add_u32 v48, v8, 9, v6
v_add3_u32 v7, v5, s6, 4
v_and_b32 v8, 0x80, v7
v_bfe_u32 v9, v7, 2, 1
v_lshl_or_b32 v8, v9, 6, v8
v_bfe_u32 v9, v7, 4, 1
v_lshl_or_b32 v8, v9, 5, v8
v_and_b32 v9, 3, v7
v_lshl_or_b32 v8, v9, 3, v8
v_bfe_u32 v9, v7, 5, 2
v_lshl_or_b32 v8, v9, 1, v8
v_bfe_u32 v9, v7, 3, 1
v_or_b32 v8, v9, v8
v_cndmask_b32 v8, v8, v7, vcc
v_lshl_add_u32 v52, v8, 9, v6
v_add3_u32 v7, v5, s6, 6
v_and_b32 v8, 0x80, v7
v_bfe_u32 v9, v7, 2, 1
v_lshl_or_b32 v8, v9, 6, v8
v_bfe_u32 v9, v7, 4, 1
v_lshl_or_b32 v8, v9, 5, v8
v_and_b32 v9, 3, v7
v_lshl_or_b32 v8, v9, 3, v8
v_bfe_u32 v9, v7, 5, 2
v_lshl_or_b32 v8, v9, 1, v8
v_bfe_u32 v9, v7, 3, 1
v_or_b32 v8, v9, v8
v_cndmask_b32 v8, v8, v7, vcc
v_lshl_add_u32 v56, v8, 9, v6
v_add3_u32 v7, v5, s6, 8
v_and_b32 v8, 0x80, v7
v_bfe_u32 v9, v7, 2, 1
v_lshl_or_b32 v8, v9, 6, v8
v_bfe_u32 v9, v7, 4, 1
v_lshl_or_b32 v8, v9, 5, v8
v_and_b32 v9, 3, v7
v_lshl_or_b32 v8, v9, 3, v8
v_bfe_u32 v9, v7, 5, 2
v_lshl_or_b32 v8, v9, 1, v8
v_bfe_u32 v9, v7, 3, 1
v_or_b32 v8, v9, v8
v_cndmask_b32 v8, v8, v7, vcc
v_lshl_add_u32 v60, v8, 9, v6
v_add3_u32 v7, v5, s6, 10
v_and_b32 v8, 0x80, v7
v_bfe_u32 v9, v7, 2, 1
v_lshl_or_b32 v8, v9, 6, v8
v_bfe_u32 v9, v7, 4, 1
v_lshl_or_b32 v8, v9, 5, v8
v_and_b32 v9, 3, v7
v_lshl_or_b32 v8, v9, 3, v8
v_bfe_u32 v9, v7, 5, 2
v_lshl_or_b32 v8, v9, 1, v8
v_bfe_u32 v9, v7, 3, 1
v_or_b32 v8, v9, v8
v_cndmask_b32 v8, v8, v7, vcc
v_lshl_add_u32 v64, v8, 9, v6
v_add3_u32 v7, v5, s6, 12
v_and_b32 v8, 0x80, v7
v_bfe_u32 v9, v7, 2, 1
v_lshl_or_b32 v8, v9, 6, v8
v_bfe_u32 v9, v7, 4, 1
v_lshl_or_b32 v8, v9, 5, v8
v_and_b32 v9, 3, v7
v_lshl_or_b32 v8, v9, 3, v8
v_bfe_u32 v9, v7, 5, 2
v_lshl_or_b32 v8, v9, 1, v8
v_bfe_u32 v9, v7, 3, 1
v_or_b32 v8, v9, v8
v_cndmask_b32 v8, v8, v7, vcc
v_lshl_add_u32 v68, v8, 9, v6
v_add3_u32 v7, v5, s6, 14
v_and_b32 v8, 0x80, v7
v_bfe_u32 v9, v7, 2, 1
v_lshl_or_b32 v8, v9, 6, v8
v_bfe_u32 v9, v7, 4, 1
v_lshl_or_b32 v8, v9, 5, v8
v_and_b32 v9, 3, v7
v_lshl_or_b32 v8, v9, 3, v8
v_bfe_u32 v9, v7, 5, 2
v_lshl_or_b32 v8, v9, 1, v8
v_bfe_u32 v9, v7, 3, 1
v_or_b32 v8, v9, v8
v_cndmask_b32 v8, v8, v7, vcc
v_lshl_add_u32 v72, v8, 9, v6
s_lshl_b32 s7, s60, 7
v_lshrrev_b32 v5, 3, v2
v_and_b32 v6, 7, v2
v_and_b32 v7, 2, v5
v_xor_b32 v6, v6, v7
v_lshl_add_u32 v5, v5, 9, s7
v_lshl_add_u32 v17, v6, 4, v5
v_xor_b32 v6, 4, v6
v_lshl_add_u32 v18, v6, 4, v5
v_add_u32 v18, 0xc00, v18
v_add_u32 v19, 0x1800, v17
v_add_u32 v20, 0x1800, v18
s_xor_b32 s6, s62, 0
s_lshl_b32 s66, s6, 14
s_xor_b32 s6, s62, 1
s_lshl_b32 s67, s6, 14
s_xor_b32 s6, s62, 2
s_lshl_b32 s68, s6, 14
s_xor_b32 s6, s62, 3
s_lshl_b32 s69, s6, 14
s_xor_b32 s6, s62, 4
s_lshl_b32 s70, s6, 14
s_xor_b32 s6, s62, 5
s_lshl_b32 s71, s6, 14
s_xor_b32 s6, s62, 6
s_lshl_b32 s72, s6, 14
s_xor_b32 s6, s62, 7
s_lshl_b32 s73, s6, 14
s_waitcnt lgkmcnt(0)
s_cmp_ge_u32 s4, 4
s_cselect_b32 s6, s30, s24
s_cselect_b32 s7, s31, s25
s_add_u32 s40, s6, 0x0
s_addc_u32 s41, s7, 0
s_mov_b32 s42, 0x20000
s_mov_b32 s43, 0x00020000
s_add_u32 s44, s32, 0x0
s_addc_u32 s45, s33, 0
s_mov_b32 s46, 0x20000
s_mov_b32 s47, 0x00020000
buffer_load_dwordx4 v[44:47], v44, s[40:43], 0 offen
buffer_load_dwordx4 v[48:51], v48, s[40:43], 0 offen
buffer_load_dwordx4 v[52:55], v52, s[40:43], 0 offen
buffer_load_dwordx4 v[56:59], v56, s[40:43], 0 offen
buffer_load_dwordx4 v[60:63], v60, s[40:43], 0 offen
buffer_load_dwordx4 v[64:67], v64, s[40:43], 0 offen
buffer_load_dwordx4 v[68:71], v68, s[40:43], 0 offen
buffer_load_dwordx4 v[72:75], v72, s[40:43], 0 offen
s_add_u32 m0, s63, 0x0
s_nop 0
buffer_load_dwordx4 v17, s[44:47], s66 offen offset:0 lds
buffer_load_dwordx4 v18, s[44:47], s66 offen offset:1024 lds
buffer_load_dwordx4 v19, s[44:47], s66 offen offset:2048 lds
buffer_load_dwordx4 v20, s[44:47], s66 offen offset:3072 lds
s_add_u32 m0, s63, 0x1000
s_nop 0
buffer_load_dwordx4 v17, s[44:47], s67 offen offset:0 lds
buffer_load_dwordx4 v18, s[44:47], s67 offen offset:1024 lds
buffer_load_dwordx4 v19, s[44:47], s67 offen offset:2048 lds
buffer_load_dwordx4 v20, s[44:47], s67 offen offset:3072 lds
v_bfe_u32 v5, v2, 2, 3
v_xor_b32 v5, s62, v5
v_and_b32 v6, 3, v2
v_lshlrev_b32 v7, 10, v5
v_lshl_add_u32 v7, v6, 8, v7
v_add_u32 v7, 0xc000, v7
v_and_b32 v5, 1, v5
v_lshl_or_b32 v6, v5, 2, v6
v_lshrrev_b32 v5, 5, v2
s_mul_i32 s6, s60, 16
v_add3_u32 v8, v5, s6, 0
v_lshrrev_b32 v9, 4, v8
v_lshl_add_u32 v9, v9, 13, v7
v_and_b32 v8, 15, v8
v_xor_b32 v8, v8, v6
v_lshl_add_u32 v36, v8, 4, v9
v_add3_u32 v8, v5, s6, 2
v_lshrrev_b32 v9, 4, v8
v_lshl_add_u32 v9, v9, 13, v7
v_and_b32 v8, 15, v8
v_xor_b32 v8, v8, v6
v_lshl_add_u32 v37, v8, 4, v9
v_add3_u32 v8, v5, s6, 4
v_lshrrev_b32 v9, 4, v8
v_lshl_add_u32 v9, v9, 13, v7
v_and_b32 v8, 15, v8
v_xor_b32 v8, v8, v6
v_lshl_add_u32 v38, v8, 4, v9
v_add3_u32 v8, v5, s6, 6
v_lshrrev_b32 v9, 4, v8
v_lshl_add_u32 v9, v9, 13, v7
v_and_b32 v8, 15, v8
v_xor_b32 v8, v8, v6
v_lshl_add_u32 v39, v8, 4, v9
v_add3_u32 v8, v5, s6, 8
v_lshrrev_b32 v9, 4, v8
v_lshl_add_u32 v9, v9, 13, v7
v_and_b32 v8, 15, v8
v_xor_b32 v8, v8, v6
v_lshl_add_u32 v40, v8, 4, v9
v_add3_u32 v8, v5, s6, 10
v_lshrrev_b32 v9, 4, v8
v_lshl_add_u32 v9, v9, 13, v7
v_and_b32 v8, 15, v8
v_xor_b32 v8, v8, v6
v_lshl_add_u32 v41, v8, 4, v9
v_add3_u32 v8, v5, s6, 12
v_lshrrev_b32 v9, 4, v8
v_lshl_add_u32 v9, v9, 13, v7
v_and_b32 v8, 15, v8
v_xor_b32 v8, v8, v6
v_lshl_add_u32 v42, v8, 4, v9
v_add3_u32 v8, v5, s6, 14
v_lshrrev_b32 v9, 4, v8
v_lshl_add_u32 v9, v9, 13, v7
v_and_b32 v8, 15, v8
v_xor_b32 v8, v8, v6
v_lshl_add_u32 v43, v8, 4, v9
v_xor_b32 v5, v3, v4
v_lshlrev_b32 v5, 4, v5
v_lshl_add_u32 v5, v4, 8, v5
v_add_u32 v31, 0xc000, v5
v_xor_b32 v32, 64, v31
v_lshrrev_b32 v5, 2, v3
v_and_b32 v6, 3, v3
v_and_b32 v7, 1, v4
v_lshlrev_b32 v7, 2, v7
v_and_b32 v8, 2, v5
v_or_b32 v7, v7, v8
v_lshl_add_u32 v8, v4, 3, v5
v_lshlrev_b32 v8, 7, v8
v_add_u32 v8, s63, v8
v_xor_b32 v6, v6, v7
v_xor_b32 v9, 0, v6
v_lshl_add_u32 v25, v9, 4, v8
v_add_u32 v26, 8, v25
v_xor_b32 v9, 4, v6
v_lshl_add_u32 v27, v9, 4, v8
v_add_u32 v28, 8, v27
s_lshr_b32 s6, s4, 2
s_lshl_b32 s6, s6, 17
s_and_b32 s7, s4, 3
s_lshl_b32 s7, s7, 12
s_add_u32 s6, s6, s7
s_mul_i32 s7, s60, 32768
s_add_u32 s82, s6, s7
s_add_u32 s83, s82, 16384
s_add_u32 s52, s38, 0x1000000
s_addc_u32 s53, s39, 0
s_mov_b32 s54, 0x40000
s_mov_b32 s55, 0x00020000
s_waitcnt vmcnt(15)
ds_write_b128 v36, v[44:47]
s_waitcnt vmcnt(14)
ds_write_b128 v37, v[48:51]
s_waitcnt vmcnt(13)
ds_write_b128 v38, v[52:55]
s_waitcnt vmcnt(12)
ds_write_b128 v39, v[56:59]
s_waitcnt vmcnt(11)
ds_write_b128 v40, v[60:63]
s_waitcnt vmcnt(10)
ds_write_b128 v41, v[64:67]
s_waitcnt vmcnt(9)
ds_write_b128 v42, v[68:71]
s_waitcnt vmcnt(8)
ds_write_b128 v43, v[72:75]
s_add_u32 m0, s63, 0x2000
s_nop 0
buffer_load_dwordx4 v17, s[44:47], s68 offen offset:0 lds
buffer_load_dwordx4 v18, s[44:47], s68 offen offset:1024 lds
buffer_load_dwordx4 v19, s[44:47], s68 offen offset:2048 lds
buffer_load_dwordx4 v20, s[44:47], s68 offen offset:3072 lds
s_waitcnt vmcnt(8)
ds_read_b64_tr_b16 v[140:141], v25 offset:0
ds_read_b64_tr_b16 v[142:143], v25 offset:512
ds_read_b64_tr_b16 v[144:145], v26 offset:0
ds_read_b64_tr_b16 v[146:147], v26 offset:512
ds_read_b64_tr_b16 v[148:149], v27 offset:0
ds_read_b64_tr_b16 v[150:151], v27 offset:512
s_waitcnt lgkmcnt(6)
s_barrier
ds_read_b128 v[180:183], v31 offset:0
ds_read_b128 v[184:187], v31 offset:8192
ds_read_b128 v[188:191], v31 offset:16384
ds_read_b128 v[192:195], v31 offset:24576
s_waitcnt lgkmcnt(3)
v_mfma_f32_16x16x32_bf16 v[76:79], v[180:183], v[140:143], 0
s_waitcnt lgkmcnt(2)
v_mfma_f32_16x16x32_bf16 v[80:83], v[184:187], v[140:143], 0
s_waitcnt lgkmcnt(1)
v_mfma_f32_16x16x32_bf16 v[84:87], v[188:191], v[140:143], 0
s_waitcnt lgkmcnt(0)
v_mfma_f32_16x16x32_bf16 v[88:91], v[192:195], v[140:143], 0
ds_read_b64_tr_b16 v[152:153], v28 offset:0
ds_read_b64_tr_b16 v[154:155], v28 offset:512
v_mfma_f32_16x16x32_bf16 v[92:95], v[180:183], v[144:147], 0
v_mfma_f32_16x16x32_bf16 v[96:99], v[184:187], v[144:147], 0
v_mfma_f32_16x16x32_bf16 v[100:103], v[188:191], v[144:147], 0
v_mfma_f32_16x16x32_bf16 v[104:107], v[192:195], v[144:147], 0
ds_read_b128 v[196:199], v32 offset:1024
s_waitcnt vmcnt(4)
ds_read_b64_tr_b16 v[156:157], v25 offset:4096
ds_read_b64_tr_b16 v[158:159], v25 offset:4608
v_mfma_f32_16x16x32_bf16 v[108:111], v[180:183], v[148:151], 0
ds_read_b128 v[200:203], v32 offset:9216
v_mfma_f32_16x16x32_bf16 v[112:115], v[184:187], v[148:151], 0
ds_read_b128 v[204:207], v32 offset:17408
v_mfma_f32_16x16x32_bf16 v[116:119], v[188:191], v[148:151], 0
ds_read_b128 v[208:211], v32 offset:25600
v_mfma_f32_16x16x32_bf16 v[120:123], v[192:195], v[148:151], 0
ds_read_b64_tr_b16 v[160:161], v26 offset:4096
ds_read_b64_tr_b16 v[162:163], v26 offset:4608
s_waitcnt lgkmcnt(8)
v_mfma_f32_16x16x32_bf16 v[124:127], v[180:183], v[152:155], 0
s_add_u32 m0, s63, 0x0
s_nop 0
buffer_load_dwordx4 v17, s[44:47], s69 offen offset:0 lds
buffer_load_dwordx4 v18, s[44:47], s69 offen offset:1024 lds
buffer_load_dwordx4 v19, s[44:47], s69 offen offset:2048 lds
buffer_load_dwordx4 v20, s[44:47], s69 offen offset:3072 lds
v_mfma_f32_16x16x32_bf16 v[128:131], v[184:187], v[152:155], 0
v_mfma_f32_16x16x32_bf16 v[132:135], v[188:191], v[152:155], 0
v_mfma_f32_16x16x32_bf16 v[136:139], v[192:195], v[152:155], 0
ds_read_b64_tr_b16 v[164:165], v27 offset:4096
ds_read_b64_tr_b16 v[166:167], v27 offset:4608
s_waitcnt lgkmcnt(7)
v_mfma_f32_16x16x32_bf16 v[76:79], v[196:199], v[156:159], v[76:79]
s_waitcnt lgkmcnt(6)
v_mfma_f32_16x16x32_bf16 v[80:83], v[200:203], v[156:159], v[80:83]
s_waitcnt lgkmcnt(5)
v_mfma_f32_16x16x32_bf16 v[84:87], v[204:207], v[156:159], v[84:87]
s_waitcnt lgkmcnt(4)
v_mfma_f32_16x16x32_bf16 v[88:91], v[208:211], v[156:159], v[88:91]
ds_read_b64_tr_b16 v[168:169], v28 offset:4096
ds_read_b64_tr_b16 v[170:171], v28 offset:4608
s_waitcnt lgkmcnt(4)
v_mfma_f32_16x16x32_bf16 v[92:95], v[196:199], v[160:163], v[92:95]
v_mfma_f32_16x16x32_bf16 v[96:99], v[200:203], v[160:163], v[96:99]
v_mfma_f32_16x16x32_bf16 v[100:103], v[204:207], v[160:163], v[100:103]
v_mfma_f32_16x16x32_bf16 v[104:107], v[208:211], v[160:163], v[104:107]
ds_read_b128 v[212:215], v31 offset:2048
s_waitcnt vmcnt(4)
ds_read_b64_tr_b16 v[172:173], v25 offset:8192
ds_read_b64_tr_b16 v[174:175], v25 offset:8704
s_waitcnt lgkmcnt(5)
v_mfma_f32_16x16x32_bf16 v[108:111], v[196:199], v[164:167], v[108:111]
ds_read_b128 v[216:219], v31 offset:10240
v_mfma_f32_16x16x32_bf16 v[112:115], v[200:203], v[164:167], v[112:115]
ds_read_b128 v[220:223], v31 offset:18432
v_mfma_f32_16x16x32_bf16 v[116:119], v[204:207], v[164:167], v[116:119]
ds_read_b128 v[224:227], v31 offset:26624
v_mfma_f32_16x16x32_bf16 v[120:123], v[208:211], v[164:167], v[120:123]
ds_read_b64_tr_b16 v[176:177], v26 offset:8192
ds_read_b64_tr_b16 v[178:179], v26 offset:8704
s_waitcnt lgkmcnt(8)
v_mfma_f32_16x16x32_bf16 v[124:127], v[196:199], v[168:171], v[124:127]
s_add_u32 m0, s63, 0x1000
s_nop 0
buffer_load_dwordx4 v17, s[44:47], s70 offen offset:0 lds
buffer_load_dwordx4 v18, s[44:47], s70 offen offset:1024 lds
buffer_load_dwordx4 v19, s[44:47], s70 offen offset:2048 lds
buffer_load_dwordx4 v20, s[44:47], s70 offen offset:3072 lds
v_mfma_f32_16x16x32_bf16 v[128:131], v[200:203], v[168:171], v[128:131]
v_mfma_f32_16x16x32_bf16 v[132:135], v[204:207], v[168:171], v[132:135]
v_mfma_f32_16x16x32_bf16 v[136:139], v[208:211], v[168:171], v[136:139]
ds_read_b64_tr_b16 v[140:141], v27 offset:8192
ds_read_b64_tr_b16 v[142:143], v27 offset:8704
s_waitcnt lgkmcnt(7)
v_mfma_f32_16x16x32_bf16 v[76:79], v[212:215], v[172:175], v[76:79]
s_waitcnt lgkmcnt(6)
v_mfma_f32_16x16x32_bf16 v[80:83], v[216:219], v[172:175], v[80:83]
s_waitcnt lgkmcnt(5)
v_mfma_f32_16x16x32_bf16 v[84:87], v[220:223], v[172:175], v[84:87]
s_waitcnt lgkmcnt(4)
v_mfma_f32_16x16x32_bf16 v[88:91], v[224:227], v[172:175], v[88:91]
ds_read_b64_tr_b16 v[144:145], v28 offset:8192
ds_read_b64_tr_b16 v[146:147], v28 offset:8704
s_waitcnt lgkmcnt(4)
v_mfma_f32_16x16x32_bf16 v[92:95], v[212:215], v[176:179], v[92:95]
v_mfma_f32_16x16x32_bf16 v[96:99], v[216:219], v[176:179], v[96:99]
v_mfma_f32_16x16x32_bf16 v[100:103], v[220:223], v[176:179], v[100:103]
v_mfma_f32_16x16x32_bf16 v[104:107], v[224:227], v[176:179], v[104:107]
ds_read_b128 v[180:183], v32 offset:3072
s_waitcnt vmcnt(4)
ds_read_b64_tr_b16 v[148:149], v25 offset:0
ds_read_b64_tr_b16 v[150:151], v25 offset:512
s_waitcnt lgkmcnt(5)
v_mfma_f32_16x16x32_bf16 v[108:111], v[212:215], v[140:143], v[108:111]
ds_read_b128 v[184:187], v32 offset:11264
v_mfma_f32_16x16x32_bf16 v[112:115], v[216:219], v[140:143], v[112:115]
ds_read_b128 v[188:191], v32 offset:19456
v_mfma_f32_16x16x32_bf16 v[116:119], v[220:223], v[140:143], v[116:119]
ds_read_b128 v[192:195], v32 offset:27648
v_mfma_f32_16x16x32_bf16 v[120:123], v[224:227], v[140:143], v[120:123]
ds_read_b64_tr_b16 v[152:153], v26 offset:0
ds_read_b64_tr_b16 v[154:155], v26 offset:512
s_waitcnt lgkmcnt(8)
v_mfma_f32_16x16x32_bf16 v[124:127], v[212:215], v[144:147], v[124:127]
s_add_u32 m0, s63, 0x2000
s_nop 0
buffer_load_dwordx4 v17, s[44:47], s71 offen offset:0 lds
buffer_load_dwordx4 v18, s[44:47], s71 offen offset:1024 lds
buffer_load_dwordx4 v19, s[44:47], s71 offen offset:2048 lds
buffer_load_dwordx4 v20, s[44:47], s71 offen offset:3072 lds
v_mfma_f32_16x16x32_bf16 v[128:131], v[216:219], v[144:147], v[128:131]
v_mfma_f32_16x16x32_bf16 v[132:135], v[220:223], v[144:147], v[132:135]
v_mfma_f32_16x16x32_bf16 v[136:139], v[224:227], v[144:147], v[136:139]
ds_read_b64_tr_b16 v[156:157], v27 offset:0
ds_read_b64_tr_b16 v[158:159], v27 offset:512
s_waitcnt lgkmcnt(7)
v_mfma_f32_16x16x32_bf16 v[76:79], v[180:183], v[148:151], v[76:79]
s_waitcnt lgkmcnt(6)
v_mfma_f32_16x16x32_bf16 v[80:83], v[184:187], v[148:151], v[80:83]
s_waitcnt lgkmcnt(5)
v_mfma_f32_16x16x32_bf16 v[84:87], v[188:191], v[148:151], v[84:87]
s_waitcnt lgkmcnt(4)
v_mfma_f32_16x16x32_bf16 v[88:91], v[192:195], v[148:151], v[88:91]
ds_read_b64_tr_b16 v[160:161], v28 offset:0
ds_read_b64_tr_b16 v[162:163], v28 offset:512
s_waitcnt lgkmcnt(4)
v_mfma_f32_16x16x32_bf16 v[92:95], v[180:183], v[152:155], v[92:95]
v_mfma_f32_16x16x32_bf16 v[96:99], v[184:187], v[152:155], v[96:99]
v_mfma_f32_16x16x32_bf16 v[100:103], v[188:191], v[152:155], v[100:103]
v_mfma_f32_16x16x32_bf16 v[104:107], v[192:195], v[152:155], v[104:107]
ds_read_b128 v[196:199], v31 offset:4096
s_waitcnt vmcnt(4)
ds_read_b64_tr_b16 v[164:165], v25 offset:4096
ds_read_b64_tr_b16 v[166:167], v25 offset:4608
s_waitcnt lgkmcnt(5)
v_mfma_f32_16x16x32_bf16 v[108:111], v[180:183], v[156:159], v[108:111]
ds_read_b128 v[200:203], v31 offset:12288
v_mfma_f32_16x16x32_bf16 v[112:115], v[184:187], v[156:159], v[112:115]
ds_read_b128 v[204:207], v31 offset:20480
v_mfma_f32_16x16x32_bf16 v[116:119], v[188:191], v[156:159], v[116:119]
ds_read_b128 v[208:211], v31 offset:28672
v_mfma_f32_16x16x32_bf16 v[120:123], v[192:195], v[156:159], v[120:123]
ds_read_b64_tr_b16 v[168:169], v26 offset:4096
ds_read_b64_tr_b16 v[170:171], v26 offset:4608
s_waitcnt lgkmcnt(8)
v_mfma_f32_16x16x32_bf16 v[124:127], v[180:183], v[160:163], v[124:127]
s_add_u32 m0, s63, 0x0
s_nop 0
buffer_load_dwordx4 v17, s[44:47], s72 offen offset:0 lds
buffer_load_dwordx4 v18, s[44:47], s72 offen offset:1024 lds
buffer_load_dwordx4 v19, s[44:47], s72 offen offset:2048 lds
buffer_load_dwordx4 v20, s[44:47], s72 offen offset:3072 lds
v_mfma_f32_16x16x32_bf16 v[128:131], v[184:187], v[160:163], v[128:131]
v_mfma_f32_16x16x32_bf16 v[132:135], v[188:191], v[160:163], v[132:135]
v_mfma_f32_16x16x32_bf16 v[136:139], v[192:195], v[160:163], v[136:139]
ds_read_b64_tr_b16 v[172:173], v27 offset:4096
ds_read_b64_tr_b16 v[174:175], v27 offset:4608
s_waitcnt lgkmcnt(7)
v_mfma_f32_16x16x32_bf16 v[76:79], v[196:199], v[164:167], v[76:79]
s_waitcnt lgkmcnt(6)
v_mfma_f32_16x16x32_bf16 v[80:83], v[200:203], v[164:167], v[80:83]
s_waitcnt lgkmcnt(5)
v_mfma_f32_16x16x32_bf16 v[84:87], v[204:207], v[164:167], v[84:87]
s_waitcnt lgkmcnt(4)
v_mfma_f32_16x16x32_bf16 v[88:91], v[208:211], v[164:167], v[88:91]
ds_read_b64_tr_b16 v[176:177], v28 offset:4096
ds_read_b64_tr_b16 v[178:179], v28 offset:4608
s_waitcnt lgkmcnt(4)
v_mfma_f32_16x16x32_bf16 v[92:95], v[196:199], v[168:171], v[92:95]
v_mfma_f32_16x16x32_bf16 v[96:99], v[200:203], v[168:171], v[96:99]
v_mfma_f32_16x16x32_bf16 v[100:103], v[204:207], v[168:171], v[100:103]
v_mfma_f32_16x16x32_bf16 v[104:107], v[208:211], v[168:171], v[104:107]
ds_read_b128 v[212:215], v32 offset:5120
s_waitcnt vmcnt(4)
ds_read_b64_tr_b16 v[140:141], v25 offset:8192
ds_read_b64_tr_b16 v[142:143], v25 offset:8704
s_waitcnt lgkmcnt(5)
v_mfma_f32_16x16x32_bf16 v[108:111], v[196:199], v[172:175], v[108:111]
ds_read_b128 v[216:219], v32 offset:13312
v_mfma_f32_16x16x32_bf16 v[112:115], v[200:203], v[172:175], v[112:115]
ds_read_b128 v[220:223], v32 offset:21504
v_mfma_f32_16x16x32_bf16 v[116:119], v[204:207], v[172:175], v[116:119]
ds_read_b128 v[224:227], v32 offset:29696
v_mfma_f32_16x16x32_bf16 v[120:123], v[208:211], v[172:175], v[120:123]
ds_read_b64_tr_b16 v[144:145], v26 offset:8192
ds_read_b64_tr_b16 v[146:147], v26 offset:8704
s_waitcnt lgkmcnt(8)
v_mfma_f32_16x16x32_bf16 v[124:127], v[196:199], v[176:179], v[124:127]
s_add_u32 m0, s63, 0x1000
s_nop 0
buffer_load_dwordx4 v17, s[44:47], s73 offen offset:0 lds
buffer_load_dwordx4 v18, s[44:47], s73 offen offset:1024 lds
buffer_load_dwordx4 v19, s[44:47], s73 offen offset:2048 lds
buffer_load_dwordx4 v20, s[44:47], s73 offen offset:3072 lds
v_mfma_f32_16x16x32_bf16 v[128:131], v[200:203], v[176:179], v[128:131]
v_mfma_f32_16x16x32_bf16 v[132:135], v[204:207], v[176:179], v[132:135]
v_mfma_f32_16x16x32_bf16 v[136:139], v[208:211], v[176:179], v[136:139]
ds_read_b64_tr_b16 v[148:149], v27 offset:8192
ds_read_b64_tr_b16 v[150:151], v27 offset:8704
s_waitcnt lgkmcnt(7)
v_mfma_f32_16x16x32_bf16 v[76:79], v[212:215], v[140:143], v[76:79]
s_waitcnt lgkmcnt(6)
v_mfma_f32_16x16x32_bf16 v[80:83], v[216:219], v[140:143], v[80:83]
s_waitcnt lgkmcnt(5)
v_mfma_f32_16x16x32_bf16 v[84:87], v[220:223], v[140:143], v[84:87]
s_waitcnt lgkmcnt(4)
v_mfma_f32_16x16x32_bf16 v[88:91], v[224:227], v[140:143], v[88:91]
ds_read_b64_tr_b16 v[152:153], v28 offset:8192
ds_read_b64_tr_b16 v[154:155], v28 offset:8704
s_waitcnt lgkmcnt(4)
v_mfma_f32_16x16x32_bf16 v[92:95], v[212:215], v[144:147], v[92:95]
v_mfma_f32_16x16x32_bf16 v[96:99], v[216:219], v[144:147], v[96:99]
v_mfma_f32_16x16x32_bf16 v[100:103], v[220:223], v[144:147], v[100:103]
v_mfma_f32_16x16x32_bf16 v[104:107], v[224:227], v[144:147], v[104:107]
ds_read_b128 v[180:183], v31 offset:6144
s_waitcnt vmcnt(4)
ds_read_b64_tr_b16 v[156:157], v25 offset:0
ds_read_b64_tr_b16 v[158:159], v25 offset:512
s_waitcnt lgkmcnt(5)
v_mfma_f32_16x16x32_bf16 v[108:111], v[212:215], v[148:151], v[108:111]
ds_read_b128 v[184:187], v31 offset:14336
v_mfma_f32_16x16x32_bf16 v[112:115], v[216:219], v[148:151], v[112:115]
ds_read_b128 v[188:191], v31 offset:22528
v_mfma_f32_16x16x32_bf16 v[116:119], v[220:223], v[148:151], v[116:119]
ds_read_b128 v[192:195], v31 offset:30720
v_mfma_f32_16x16x32_bf16 v[120:123], v[224:227], v[148:151], v[120:123]
ds_read_b64_tr_b16 v[160:161], v26 offset:0
ds_read_b64_tr_b16 v[162:163], v26 offset:512
s_waitcnt lgkmcnt(8)
v_mfma_f32_16x16x32_bf16 v[124:127], v[212:215], v[152:155], v[124:127]
v_mfma_f32_16x16x32_bf16 v[128:131], v[216:219], v[152:155], v[128:131]
v_mfma_f32_16x16x32_bf16 v[132:135], v[220:223], v[152:155], v[132:135]
v_mfma_f32_16x16x32_bf16 v[136:139], v[224:227], v[152:155], v[136:139]
ds_read_b64_tr_b16 v[164:165], v27 offset:0
ds_read_b64_tr_b16 v[166:167], v27 offset:512
s_waitcnt lgkmcnt(7)
v_mfma_f32_16x16x32_bf16 v[76:79], v[180:183], v[156:159], v[76:79]
s_waitcnt lgkmcnt(6)
v_mfma_f32_16x16x32_bf16 v[80:83], v[184:187], v[156:159], v[80:83]
s_waitcnt lgkmcnt(5)
v_mfma_f32_16x16x32_bf16 v[84:87], v[188:191], v[156:159], v[84:87]
s_waitcnt lgkmcnt(4)
v_mfma_f32_16x16x32_bf16 v[88:91], v[192:195], v[156:159], v[88:91]
ds_read_b64_tr_b16 v[168:169], v28 offset:0
ds_read_b64_tr_b16 v[170:171], v28 offset:512
s_waitcnt lgkmcnt(4)
v_mfma_f32_16x16x32_bf16 v[92:95], v[180:183], v[160:163], v[92:95]
v_mfma_f32_16x16x32_bf16 v[96:99], v[184:187], v[160:163], v[96:99]
v_mfma_f32_16x16x32_bf16 v[100:103], v[188:191], v[160:163], v[100:103]
v_mfma_f32_16x16x32_bf16 v[104:107], v[192:195], v[160:163], v[104:107]
ds_read_b128 v[196:199], v32 offset:7168
s_waitcnt vmcnt(0)
ds_read_b64_tr_b16 v[172:173], v25 offset:4096
ds_read_b64_tr_b16 v[174:175], v25 offset:4608
s_waitcnt lgkmcnt(5)
v_mfma_f32_16x16x32_bf16 v[108:111], v[180:183], v[164:167], v[108:111]
ds_read_b128 v[200:203], v32 offset:15360
v_mfma_f32_16x16x32_bf16 v[112:115], v[184:187], v[164:167], v[112:115]
ds_read_b128 v[204:207], v32 offset:23552
v_mfma_f32_16x16x32_bf16 v[116:119], v[188:191], v[164:167], v[116:119]
ds_read_b128 v[208:211], v32 offset:31744
v_mfma_f32_16x16x32_bf16 v[120:123], v[192:195], v[164:167], v[120:123]
ds_read_b64_tr_b16 v[176:177], v26 offset:4096
ds_read_b64_tr_b16 v[178:179], v26 offset:4608
s_waitcnt lgkmcnt(8)
v_mfma_f32_16x16x32_bf16 v[124:127], v[180:183], v[168:171], v[124:127]
v_mfma_f32_16x16x32_bf16 v[128:131], v[184:187], v[168:171], v[128:131]
v_mfma_f32_16x16x32_bf16 v[132:135], v[188:191], v[168:171], v[132:135]
v_mfma_f32_16x16x32_bf16 v[136:139], v[192:195], v[168:171], v[136:139]
ds_read_b64_tr_b16 v[140:141], v27 offset:4096
ds_read_b64_tr_b16 v[142:143], v27 offset:4608
s_waitcnt lgkmcnt(7)
v_mfma_f32_16x16x32_bf16 v[76:79], v[196:199], v[172:175], v[76:79]
s_waitcnt lgkmcnt(6)
v_mfma_f32_16x16x32_bf16 v[80:83], v[200:203], v[172:175], v[80:83]
s_waitcnt lgkmcnt(5)
v_mfma_f32_16x16x32_bf16 v[84:87], v[204:207], v[172:175], v[84:87]
s_waitcnt lgkmcnt(4)
v_mfma_f32_16x16x32_bf16 v[88:91], v[208:211], v[172:175], v[88:91]
ds_read_b64_tr_b16 v[144:145], v28 offset:4096
ds_read_b64_tr_b16 v[146:147], v28 offset:4608
s_waitcnt lgkmcnt(4)
v_mfma_f32_16x16x32_bf16 v[92:95], v[196:199], v[176:179], v[92:95]
v_cvt_pk_bf16_f32 v76, v76, v77
v_cvt_pk_bf16_f32 v77, v78, v79
v_cvt_pk_bf16_f32 v78, v80, v81
v_cvt_pk_bf16_f32 v79, v82, v83
buffer_store_dwordx4 v[76:79], v16, s[52:55], s82 offen offset:0 sc1
v_mfma_f32_16x16x32_bf16 v[96:99], v[200:203], v[176:179], v[96:99]
v_mfma_f32_16x16x32_bf16 v[100:103], v[204:207], v[176:179], v[100:103]
v_cvt_pk_bf16_f32 v84, v84, v85
v_cvt_pk_bf16_f32 v85, v86, v87
v_cvt_pk_bf16_f32 v86, v88, v89
v_cvt_pk_bf16_f32 v87, v90, v91
buffer_store_dwordx4 v[84:87], v16, s[52:55], s82 offen offset:2048 sc1
v_mfma_f32_16x16x32_bf16 v[104:107], v[208:211], v[176:179], v[104:107]
s_waitcnt lgkmcnt(2)
v_mfma_f32_16x16x32_bf16 v[108:111], v[196:199], v[140:143], v[108:111]
v_cvt_pk_bf16_f32 v92, v92, v93
v_cvt_pk_bf16_f32 v93, v94, v95
v_cvt_pk_bf16_f32 v94, v96, v97
v_cvt_pk_bf16_f32 v95, v98, v99
buffer_store_dwordx4 v[92:95], v16, s[52:55], s82 offen offset:1024 sc1
v_mfma_f32_16x16x32_bf16 v[112:115], v[200:203], v[140:143], v[112:115]
v_mfma_f32_16x16x32_bf16 v[116:119], v[204:207], v[140:143], v[116:119]
v_cvt_pk_bf16_f32 v100, v100, v101
v_cvt_pk_bf16_f32 v101, v102, v103
v_cvt_pk_bf16_f32 v102, v104, v105
v_cvt_pk_bf16_f32 v103, v106, v107
buffer_store_dwordx4 v[100:103], v16, s[52:55], s82 offen offset:3072 sc1
v_mfma_f32_16x16x32_bf16 v[120:123], v[208:211], v[140:143], v[120:123]
s_waitcnt lgkmcnt(0)
v_mfma_f32_16x16x32_bf16 v[124:127], v[196:199], v[144:147], v[124:127]
v_cvt_pk_bf16_f32 v108, v108, v109
v_cvt_pk_bf16_f32 v109, v110, v111
v_cvt_pk_bf16_f32 v110, v112, v113
v_cvt_pk_bf16_f32 v111, v114, v115
buffer_store_dwordx4 v[108:111], v16, s[52:55], s83 offen offset:0 sc1
v_mfma_f32_16x16x32_bf16 v[128:131], v[200:203], v[144:147], v[128:131]
v_mfma_f32_16x16x32_bf16 v[132:135], v[204:207], v[144:147], v[132:135]
v_cvt_pk_bf16_f32 v116, v116, v117
v_cvt_pk_bf16_f32 v117, v118, v119
v_cvt_pk_bf16_f32 v118, v120, v121
v_cvt_pk_bf16_f32 v119, v122, v123
buffer_store_dwordx4 v[116:119], v16, s[52:55], s83 offen offset:2048 sc1
v_mfma_f32_16x16x32_bf16 v[136:139], v[208:211], v[144:147], v[136:139]
v_cvt_pk_bf16_f32 v124, v124, v125
v_cvt_pk_bf16_f32 v125, v126, v127
v_cvt_pk_bf16_f32 v126, v128, v129
v_cvt_pk_bf16_f32 v127, v130, v131
buffer_store_dwordx4 v[124:127], v16, s[52:55], s83 offen offset:1024 sc1
v_cvt_pk_bf16_f32 v132, v132, v133
v_cvt_pk_bf16_f32 v133, v134, v135
s_nop 0
v_cvt_pk_bf16_f32 v134, v136, v137
v_cvt_pk_bf16_f32 v135, v138, v139
buffer_store_dwordx4 v[132:135], v16, s[52:55], s83 offen offset:3072 sc1
s_branch LM_pub
LM_light:
s_mov_b32 s61, 1
s_waitcnt lgkmcnt(0)
s_mov_b32 s98, 0x7c3ff80
s_load_dwordx2 s[98:99], s[38:39], s98
s_branch L1_fin
LM_edge:
s_sub_u32 s4, s3, 30
s_lshl_b32 s8, s8, 1
s_add_u32 s4, s4, s8
s_add_u32 s91, s4, 240
s_cmp_ge_u32 s4, 14
s_cselect_b32 s61, 1, 0
s_mul_i32 s6, s4, 40000
v_lshlrev_b32 v5, 4, v0
v_lshlrev_b32 v6, 2, v2
v_add_u32 v6, 0x10000, v6
v_mov_b32 v7, 0
ds_write_b32 v6, v7
s_mov_b32 s66, 0
s_mov_b32 s67, 4096
s_mov_b32 s68, 8192
s_mov_b32 s69, 12288
s_mov_b32 s70, 16384
s_mov_b32 s71, 20480
s_mov_b32 s72, 24576
s_mov_b32 s73, 28672
s_mov_b32 s74, 32768
s_mov_b32 s75, 36864
s_waitcnt lgkmcnt(0)
s_add_u32 s40, s20, 0x0
s_addc_u32 s41, s21, 0
s_add_u32 s40, s40, s6
s_addc_u32 s41, s41, 0
s_mov_b32 s42, 0x9c40
s_mov_b32 s43, 0x00020000
s_add_u32 s44, s18, 0x0
s_addc_u32 s45, s19, 0
s_add_u32 s44, s44, s6
s_addc_u32 s45, s45, 0
s_mov_b32 s46, 0x9c40
s_mov_b32 s47, 0x00020000
buffer_load_dwordx4 v[16:19], v5, s[40:43], s66 offen
buffer_load_dwordx4 v[20:23], v5, s[40:43], s67 offen
buffer_load_dwordx4 v[24:27], v5, s[40:43], s68 offen
buffer_load_dwordx4 v[28:31], v5, s[40:43], s69 offen
buffer_load_dwordx4 v[32:35], v5, s[40:43], s70 offen
buffer_load_dwordx4 v[36:39], v5, s[40:43], s71 offen
buffer_load_dwordx4 v[40:43], v5, s[40:43], s72 offen
buffer_load_dwordx4 v[44:47], v5, s[40:43], s73 offen
buffer_load_dwordx4 v[48:51], v5, s[40:43], s74 offen
buffer_load_dwordx4 v[52:55], v5, s[40:43], s75 offen
buffer_load_dwordx4 v[56:59], v5, s[44:47], s66 offen
buffer_load_dwordx4 v[60:63], v5, s[44:47], s67 offen
buffer_load_dwordx4 v[64:67], v5, s[44:47], s68 offen
buffer_load_dwordx4 v[68:71], v5, s[44:47], s69 offen
buffer_load_dwordx4 v[72:75], v5, s[44:47], s70 offen
buffer_load_dwordx4 v[76:79], v5, s[44:47], s71 offen
buffer_load_dwordx4 v[80:83], v5, s[44:47], s72 offen
buffer_load_dwordx4 v[84:87], v5, s[44:47], s73 offen
buffer_load_dwordx4 v[88:91], v5, s[44:47], s74 offen
buffer_load_dwordx4 v[92:95], v5, s[44:47], s75 offen
s_mov_b32 s98, 0x7c3ff80
s_load_dwordx2 s[98:99], s[38:39], s98
s_add_u32 s48, s38, 0x8000000
s_addc_u32 s49, s39, 0
s_mov_b32 s50, 0x2800000
s_mov_b32 s51, 0x00020000
s_add_u32 s52, s38, 0x7800000
s_addc_u32 s53, s39, 0
s_mov_b32 s54, 0x1000
s_mov_b32 s55, 0x00020000
v_mov_b32 v240, 6945
v_mov_b32 v241, 0x0
v_mov_b32 v242, 6317
v_mov_b32 v243, 0x340674
v_mov_b32 v244, 6899
v_mov_b32 v245, 0xfffae6a0
v_mov_b32 v246, 6242
v_mov_b32 v247, 0x4484a0
s_mov_b32 s11, 0x10000
v_mov_b32 v7, 1
v_cmp_gt_u32 vcc, 0xc4, v0
s_mov_b64 s[12:13], vcc
s_barrier
s_waitcnt vmcnt(19)
v_cmp_le_u32 vcc, 5436, v16
s_nop 1
v_cndmask_b32 v96, v240, v242, vcc
v_cndmask_b32 v136, v241, v243, vcc
v_cmp_le_u32 vcc, 6432, v16
s_nop 1
v_cndmask_b32 v96, v96, v244, vcc
v_cndmask_b32 v136, v136, v245, vcc
v_cmp_le_u32 vcc, 7344, v16
s_nop 1
v_cndmask_b32 v96, v96, v246, vcc
v_cndmask_b32 v136, v136, v247, vcc
v_mad_u32_u24 v96, v96, v16, v136
v_lshrrev_b32 v96, 20, v96
v_lshl_add_u32 v136, v96, 2, s11
ds_add_rtn_u32 v136, v136, v7
v_cmp_le_u32 vcc, 5436, v17
s_nop 1
v_cndmask_b32 v97, v240, v242, vcc
v_cndmask_b32 v137, v241, v243, vcc
v_cmp_le_u32 vcc, 6432, v17
s_nop 1
v_cndmask_b32 v97, v97, v244, vcc
v_cndmask_b32 v137, v137, v245, vcc
v_cmp_le_u32 vcc, 7344, v17
s_nop 1
v_cndmask_b32 v97, v97, v246, vcc
v_cndmask_b32 v137, v137, v247, vcc
v_mad_u32_u24 v97, v97, v17, v137
v_lshrrev_b32 v97, 20, v97
v_lshl_add_u32 v137, v97, 2, s11
ds_add_rtn_u32 v137, v137, v7
v_cmp_le_u32 vcc, 5436, v18
s_nop 1
v_cndmask_b32 v98, v240, v242, vcc
v_cndmask_b32 v138, v241, v243, vcc
v_cmp_le_u32 vcc, 6432, v18
s_nop 1
v_cndmask_b32 v98, v98, v244, vcc
v_cndmask_b32 v138, v138, v245, vcc
v_cmp_le_u32 vcc, 7344, v18
s_nop 1
v_cndmask_b32 v98, v98, v246, vcc
v_cndmask_b32 v138, v138, v247, vcc
v_mad_u32_u24 v98, v98, v18, v138
v_lshrrev_b32 v98, 20, v98
v_lshl_add_u32 v138, v98, 2, s11
ds_add_rtn_u32 v138, v138, v7
v_cmp_le_u32 vcc, 5436, v19
s_nop 1
v_cndmask_b32 v99, v240, v242, vcc
v_cndmask_b32 v139, v241, v243, vcc
v_cmp_le_u32 vcc, 6432, v19
s_nop 1
v_cndmask_b32 v99, v99, v244, vcc
v_cndmask_b32 v139, v139, v245, vcc
v_cmp_le_u32 vcc, 7344, v19
s_nop 1
v_cndmask_b32 v99, v99, v246, vcc
v_cndmask_b32 v139, v139, v247, vcc
v_mad_u32_u24 v99, v99, v19, v139
v_lshrrev_b32 v99, 20, v99
v_lshl_add_u32 v139, v99, 2, s11
ds_add_rtn_u32 v139, v139, v7
s_waitcnt vmcnt(18)
v_cmp_le_u32 vcc, 5436, v20
s_nop 1
v_cndmask_b32 v100, v240, v242, vcc
v_cndmask_b32 v140, v241, v243, vcc
v_cmp_le_u32 vcc, 6432, v20
s_nop 1
v_cndmask_b32 v100, v100, v244, vcc
v_cndmask_b32 v140, v140, v245, vcc
v_cmp_le_u32 vcc, 7344, v20
s_nop 1
v_cndmask_b32 v100, v100, v246, vcc
v_cndmask_b32 v140, v140, v247, vcc
v_mad_u32_u24 v100, v100, v20, v140
v_lshrrev_b32 v100, 20, v100
v_lshl_add_u32 v140, v100, 2, s11
ds_add_rtn_u32 v140, v140, v7
v_cmp_le_u32 vcc, 5436, v21
s_nop 1
v_cndmask_b32 v101, v240, v242, vcc
v_cndmask_b32 v141, v241, v243, vcc
v_cmp_le_u32 vcc, 6432, v21
s_nop 1
v_cndmask_b32 v101, v101, v244, vcc
v_cndmask_b32 v141, v141, v245, vcc
v_cmp_le_u32 vcc, 7344, v21
s_nop 1
v_cndmask_b32 v101, v101, v246, vcc
v_cndmask_b32 v141, v141, v247, vcc
v_mad_u32_u24 v101, v101, v21, v141
v_lshrrev_b32 v101, 20, v101
v_lshl_add_u32 v141, v101, 2, s11
ds_add_rtn_u32 v141, v141, v7
v_cmp_le_u32 vcc, 5436, v22
s_nop 1
v_cndmask_b32 v102, v240, v242, vcc
v_cndmask_b32 v142, v241, v243, vcc
v_cmp_le_u32 vcc, 6432, v22
s_nop 1
v_cndmask_b32 v102, v102, v244, vcc
v_cndmask_b32 v142, v142, v245, vcc
v_cmp_le_u32 vcc, 7344, v22
s_nop 1
v_cndmask_b32 v102, v102, v246, vcc
v_cndmask_b32 v142, v142, v247, vcc
v_mad_u32_u24 v102, v102, v22, v142
v_lshrrev_b32 v102, 20, v102
v_lshl_add_u32 v142, v102, 2, s11
ds_add_rtn_u32 v142, v142, v7
v_cmp_le_u32 vcc, 5436, v23
s_nop 1
v_cndmask_b32 v103, v240, v242, vcc
v_cndmask_b32 v143, v241, v243, vcc
v_cmp_le_u32 vcc, 6432, v23
s_nop 1
v_cndmask_b32 v103, v103, v244, vcc
v_cndmask_b32 v143, v143, v245, vcc
v_cmp_le_u32 vcc, 7344, v23
s_nop 1
v_cndmask_b32 v103, v103, v246, vcc
v_cndmask_b32 v143, v143, v247, vcc
v_mad_u32_u24 v103, v103, v23, v143
v_lshrrev_b32 v103, 20, v103
v_lshl_add_u32 v143, v103, 2, s11
ds_add_rtn_u32 v143, v143, v7
s_waitcnt vmcnt(17)
v_cmp_le_u32 vcc, 5436, v24
s_nop 1
v_cndmask_b32 v104, v240, v242, vcc
v_cndmask_b32 v144, v241, v243, vcc
v_cmp_le_u32 vcc, 6432, v24
s_nop 1
v_cndmask_b32 v104, v104, v244, vcc
v_cndmask_b32 v144, v144, v245, vcc
v_cmp_le_u32 vcc, 7344, v24
s_nop 1
v_cndmask_b32 v104, v104, v246, vcc
v_cndmask_b32 v144, v144, v247, vcc
v_mad_u32_u24 v104, v104, v24, v144
v_lshrrev_b32 v104, 20, v104
v_lshl_add_u32 v144, v104, 2, s11
ds_add_rtn_u32 v144, v144, v7
v_cmp_le_u32 vcc, 5436, v25
s_nop 1
v_cndmask_b32 v105, v240, v242, vcc
v_cndmask_b32 v145, v241, v243, vcc
v_cmp_le_u32 vcc, 6432, v25
s_nop 1
v_cndmask_b32 v105, v105, v244, vcc
v_cndmask_b32 v145, v145, v245, vcc
v_cmp_le_u32 vcc, 7344, v25
s_nop 1
v_cndmask_b32 v105, v105, v246, vcc
v_cndmask_b32 v145, v145, v247, vcc
v_mad_u32_u24 v105, v105, v25, v145
v_lshrrev_b32 v105, 20, v105
v_lshl_add_u32 v145, v105, 2, s11
ds_add_rtn_u32 v145, v145, v7
v_cmp_le_u32 vcc, 5436, v26
s_nop 1
v_cndmask_b32 v106, v240, v242, vcc
v_cndmask_b32 v146, v241, v243, vcc
v_cmp_le_u32 vcc, 6432, v26
s_nop 1
v_cndmask_b32 v106, v106, v244, vcc
v_cndmask_b32 v146, v146, v245, vcc
v_cmp_le_u32 vcc, 7344, v26
s_nop 1
v_cndmask_b32 v106, v106, v246, vcc
v_cndmask_b32 v146, v146, v247, vcc
v_mad_u32_u24 v106, v106, v26, v146
v_lshrrev_b32 v106, 20, v106
v_lshl_add_u32 v146, v106, 2, s11
ds_add_rtn_u32 v146, v146, v7
v_cmp_le_u32 vcc, 5436, v27
s_nop 1
v_cndmask_b32 v107, v240, v242, vcc
v_cndmask_b32 v147, v241, v243, vcc
v_cmp_le_u32 vcc, 6432, v27
s_nop 1
v_cndmask_b32 v107, v107, v244, vcc
v_cndmask_b32 v147, v147, v245, vcc
v_cmp_le_u32 vcc, 7344, v27
s_nop 1
v_cndmask_b32 v107, v107, v246, vcc
v_cndmask_b32 v147, v147, v247, vcc
v_mad_u32_u24 v107, v107, v27, v147
v_lshrrev_b32 v107, 20, v107
v_lshl_add_u32 v147, v107, 2, s11
ds_add_rtn_u32 v147, v147, v7
s_waitcnt vmcnt(16)
v_cmp_le_u32 vcc, 5436, v28
s_nop 1
v_cndmask_b32 v108, v240, v242, vcc
v_cndmask_b32 v148, v241, v243, vcc
v_cmp_le_u32 vcc, 6432, v28
s_nop 1
v_cndmask_b32 v108, v108, v244, vcc
v_cndmask_b32 v148, v148, v245, vcc
v_cmp_le_u32 vcc, 7344, v28
s_nop 1
v_cndmask_b32 v108, v108, v246, vcc
v_cndmask_b32 v148, v148, v247, vcc
v_mad_u32_u24 v108, v108, v28, v148
v_lshrrev_b32 v108, 20, v108
v_lshl_add_u32 v148, v108, 2, s11
ds_add_rtn_u32 v148, v148, v7
v_cmp_le_u32 vcc, 5436, v29
s_nop 1
v_cndmask_b32 v109, v240, v242, vcc
v_cndmask_b32 v149, v241, v243, vcc
v_cmp_le_u32 vcc, 6432, v29
s_nop 1
v_cndmask_b32 v109, v109, v244, vcc
v_cndmask_b32 v149, v149, v245, vcc
v_cmp_le_u32 vcc, 7344, v29
s_nop 1
v_cndmask_b32 v109, v109, v246, vcc
v_cndmask_b32 v149, v149, v247, vcc
v_mad_u32_u24 v109, v109, v29, v149
v_lshrrev_b32 v109, 20, v109
v_lshl_add_u32 v149, v109, 2, s11
ds_add_rtn_u32 v149, v149, v7
v_cmp_le_u32 vcc, 5436, v30
s_nop 1
v_cndmask_b32 v110, v240, v242, vcc
v_cndmask_b32 v150, v241, v243, vcc
v_cmp_le_u32 vcc, 6432, v30
s_nop 1
v_cndmask_b32 v110, v110, v244, vcc
v_cndmask_b32 v150, v150, v245, vcc
v_cmp_le_u32 vcc, 7344, v30
s_nop 1
v_cndmask_b32 v110, v110, v246, vcc
v_cndmask_b32 v150, v150, v247, vcc
v_mad_u32_u24 v110, v110, v30, v150
v_lshrrev_b32 v110, 20, v110
v_lshl_add_u32 v150, v110, 2, s11
ds_add_rtn_u32 v150, v150, v7
v_cmp_le_u32 vcc, 5436, v31
s_nop 1
v_cndmask_b32 v111, v240, v242, vcc
v_cndmask_b32 v151, v241, v243, vcc
v_cmp_le_u32 vcc, 6432, v31
s_nop 1
v_cndmask_b32 v111, v111, v244, vcc
v_cndmask_b32 v151, v151, v245, vcc
v_cmp_le_u32 vcc, 7344, v31
s_nop 1
v_cndmask_b32 v111, v111, v246, vcc
v_cndmask_b32 v151, v151, v247, vcc
v_mad_u32_u24 v111, v111, v31, v151
v_lshrrev_b32 v111, 20, v111
v_lshl_add_u32 v151, v111, 2, s11
ds_add_rtn_u32 v151, v151, v7
s_waitcnt vmcnt(15)
v_cmp_le_u32 vcc, 5436, v32
s_nop 1
v_cndmask_b32 v112, v240, v242, vcc
v_cndmask_b32 v152, v241, v243, vcc
v_cmp_le_u32 vcc, 6432, v32
s_nop 1
v_cndmask_b32 v112, v112, v244, vcc
v_cndmask_b32 v152, v152, v245, vcc
v_cmp_le_u32 vcc, 7344, v32
s_nop 1
v_cndmask_b32 v112, v112, v246, vcc
v_cndmask_b32 v152, v152, v247, vcc
v_mad_u32_u24 v112, v112, v32, v152
v_lshrrev_b32 v112, 20, v112
v_lshl_add_u32 v152, v112, 2, s11
ds_add_rtn_u32 v152, v152, v7
v_cmp_le_u32 vcc, 5436, v33
s_nop 1
v_cndmask_b32 v113, v240, v242, vcc
v_cndmask_b32 v153, v241, v243, vcc
v_cmp_le_u32 vcc, 6432, v33
s_nop 1
v_cndmask_b32 v113, v113, v244, vcc
v_cndmask_b32 v153, v153, v245, vcc
v_cmp_le_u32 vcc, 7344, v33
s_nop 1
v_cndmask_b32 v113, v113, v246, vcc
v_cndmask_b32 v153, v153, v247, vcc
v_mad_u32_u24 v113, v113, v33, v153
v_lshrrev_b32 v113, 20, v113
v_lshl_add_u32 v153, v113, 2, s11
ds_add_rtn_u32 v153, v153, v7
v_cmp_le_u32 vcc, 5436, v34
s_nop 1
v_cndmask_b32 v114, v240, v242, vcc
v_cndmask_b32 v154, v241, v243, vcc
v_cmp_le_u32 vcc, 6432, v34
s_nop 1
v_cndmask_b32 v114, v114, v244, vcc
v_cndmask_b32 v154, v154, v245, vcc
v_cmp_le_u32 vcc, 7344, v34
s_nop 1
v_cndmask_b32 v114, v114, v246, vcc
v_cndmask_b32 v154, v154, v247, vcc
v_mad_u32_u24 v114, v114, v34, v154
v_lshrrev_b32 v114, 20, v114
v_lshl_add_u32 v154, v114, 2, s11
ds_add_rtn_u32 v154, v154, v7
v_cmp_le_u32 vcc, 5436, v35
s_nop 1
v_cndmask_b32 v115, v240, v242, vcc
v_cndmask_b32 v155, v241, v243, vcc
v_cmp_le_u32 vcc, 6432, v35
s_nop 1
v_cndmask_b32 v115, v115, v244, vcc
v_cndmask_b32 v155, v155, v245, vcc
v_cmp_le_u32 vcc, 7344, v35
s_nop 1
v_cndmask_b32 v115, v115, v246, vcc
v_cndmask_b32 v155, v155, v247, vcc
v_mad_u32_u24 v115, v115, v35, v155
v_lshrrev_b32 v115, 20, v115
v_lshl_add_u32 v155, v115, 2, s11
ds_add_rtn_u32 v155, v155, v7
s_waitcnt vmcnt(14)
v_cmp_le_u32 vcc, 5436, v36
s_nop 1
v_cndmask_b32 v116, v240, v242, vcc
v_cndmask_b32 v156, v241, v243, vcc
v_cmp_le_u32 vcc, 6432, v36
s_nop 1
v_cndmask_b32 v116, v116, v244, vcc
v_cndmask_b32 v156, v156, v245, vcc
v_cmp_le_u32 vcc, 7344, v36
s_nop 1
v_cndmask_b32 v116, v116, v246, vcc
v_cndmask_b32 v156, v156, v247, vcc
v_mad_u32_u24 v116, v116, v36, v156
v_lshrrev_b32 v116, 20, v116
v_lshl_add_u32 v156, v116, 2, s11
ds_add_rtn_u32 v156, v156, v7
v_cmp_le_u32 vcc, 5436, v37
s_nop 1
v_cndmask_b32 v117, v240, v242, vcc
v_cndmask_b32 v157, v241, v243, vcc
v_cmp_le_u32 vcc, 6432, v37
s_nop 1
v_cndmask_b32 v117, v117, v244, vcc
v_cndmask_b32 v157, v157, v245, vcc
v_cmp_le_u32 vcc, 7344, v37
s_nop 1
v_cndmask_b32 v117, v117, v246, vcc
v_cndmask_b32 v157, v157, v247, vcc
v_mad_u32_u24 v117, v117, v37, v157
v_lshrrev_b32 v117, 20, v117
v_lshl_add_u32 v157, v117, 2, s11
ds_add_rtn_u32 v157, v157, v7
v_cmp_le_u32 vcc, 5436, v38
s_nop 1
v_cndmask_b32 v118, v240, v242, vcc
v_cndmask_b32 v158, v241, v243, vcc
v_cmp_le_u32 vcc, 6432, v38
s_nop 1
v_cndmask_b32 v118, v118, v244, vcc
v_cndmask_b32 v158, v158, v245, vcc
v_cmp_le_u32 vcc, 7344, v38
s_nop 1
v_cndmask_b32 v118, v118, v246, vcc
v_cndmask_b32 v158, v158, v247, vcc
v_mad_u32_u24 v118, v118, v38, v158
v_lshrrev_b32 v118, 20, v118
v_lshl_add_u32 v158, v118, 2, s11
ds_add_rtn_u32 v158, v158, v7
v_cmp_le_u32 vcc, 5436, v39
s_nop 1
v_cndmask_b32 v119, v240, v242, vcc
v_cndmask_b32 v159, v241, v243, vcc
v_cmp_le_u32 vcc, 6432, v39
s_nop 1
v_cndmask_b32 v119, v119, v244, vcc
v_cndmask_b32 v159, v159, v245, vcc
v_cmp_le_u32 vcc, 7344, v39
s_nop 1
v_cndmask_b32 v119, v119, v246, vcc
v_cndmask_b32 v159, v159, v247, vcc
v_mad_u32_u24 v119, v119, v39, v159
v_lshrrev_b32 v119, 20, v119
v_lshl_add_u32 v159, v119, 2, s11
ds_add_rtn_u32 v159, v159, v7
s_waitcnt vmcnt(13)
v_cmp_le_u32 vcc, 5436, v40
s_nop 1
v_cndmask_b32 v120, v240, v242, vcc
v_cndmask_b32 v160, v241, v243, vcc
v_cmp_le_u32 vcc, 6432, v40
s_nop 1
v_cndmask_b32 v120, v120, v244, vcc
v_cndmask_b32 v160, v160, v245, vcc
v_cmp_le_u32 vcc, 7344, v40
s_nop 1
v_cndmask_b32 v120, v120, v246, vcc
v_cndmask_b32 v160, v160, v247, vcc
v_mad_u32_u24 v120, v120, v40, v160
v_lshrrev_b32 v120, 20, v120
v_lshl_add_u32 v160, v120, 2, s11
ds_add_rtn_u32 v160, v160, v7
v_cmp_le_u32 vcc, 5436, v41
s_nop 1
v_cndmask_b32 v121, v240, v242, vcc
v_cndmask_b32 v161, v241, v243, vcc
v_cmp_le_u32 vcc, 6432, v41
s_nop 1
v_cndmask_b32 v121, v121, v244, vcc
v_cndmask_b32 v161, v161, v245, vcc
v_cmp_le_u32 vcc, 7344, v41
s_nop 1
v_cndmask_b32 v121, v121, v246, vcc
v_cndmask_b32 v161, v161, v247, vcc
v_mad_u32_u24 v121, v121, v41, v161
v_lshrrev_b32 v121, 20, v121
v_lshl_add_u32 v161, v121, 2, s11
ds_add_rtn_u32 v161, v161, v7
v_cmp_le_u32 vcc, 5436, v42
s_nop 1
v_cndmask_b32 v122, v240, v242, vcc
v_cndmask_b32 v162, v241, v243, vcc
v_cmp_le_u32 vcc, 6432, v42
s_nop 1
v_cndmask_b32 v122, v122, v244, vcc
v_cndmask_b32 v162, v162, v245, vcc
v_cmp_le_u32 vcc, 7344, v42
s_nop 1
v_cndmask_b32 v122, v122, v246, vcc
v_cndmask_b32 v162, v162, v247, vcc
v_mad_u32_u24 v122, v122, v42, v162
v_lshrrev_b32 v122, 20, v122
v_lshl_add_u32 v162, v122, 2, s11
ds_add_rtn_u32 v162, v162, v7
v_cmp_le_u32 vcc, 5436, v43
s_nop 1
v_cndmask_b32 v123, v240, v242, vcc
v_cndmask_b32 v163, v241, v243, vcc
v_cmp_le_u32 vcc, 6432, v43
s_nop 1
v_cndmask_b32 v123, v123, v244, vcc
v_cndmask_b32 v163, v163, v245, vcc
v_cmp_le_u32 vcc, 7344, v43
s_nop 1
v_cndmask_b32 v123, v123, v246, vcc
v_cndmask_b32 v163, v163, v247, vcc
v_mad_u32_u24 v123, v123, v43, v163
v_lshrrev_b32 v123, 20, v123
v_lshl_add_u32 v163, v123, 2, s11
ds_add_rtn_u32 v163, v163, v7
s_waitcnt vmcnt(12)
v_cmp_le_u32 vcc, 5436, v44
s_nop 1
v_cndmask_b32 v124, v240, v242, vcc
v_cndmask_b32 v164, v241, v243, vcc
v_cmp_le_u32 vcc, 6432, v44
s_nop 1
v_cndmask_b32 v124, v124, v244, vcc
v_cndmask_b32 v164, v164, v245, vcc
v_cmp_le_u32 vcc, 7344, v44
s_nop 1
v_cndmask_b32 v124, v124, v246, vcc
v_cndmask_b32 v164, v164, v247, vcc
v_mad_u32_u24 v124, v124, v44, v164
v_lshrrev_b32 v124, 20, v124
v_lshl_add_u32 v164, v124, 2, s11
ds_add_rtn_u32 v164, v164, v7
v_cmp_le_u32 vcc, 5436, v45
s_nop 1
v_cndmask_b32 v125, v240, v242, vcc
v_cndmask_b32 v165, v241, v243, vcc
v_cmp_le_u32 vcc, 6432, v45
s_nop 1
v_cndmask_b32 v125, v125, v244, vcc
v_cndmask_b32 v165, v165, v245, vcc
v_cmp_le_u32 vcc, 7344, v45
s_nop 1
v_cndmask_b32 v125, v125, v246, vcc
v_cndmask_b32 v165, v165, v247, vcc
v_mad_u32_u24 v125, v125, v45, v165
v_lshrrev_b32 v125, 20, v125
v_lshl_add_u32 v165, v125, 2, s11
ds_add_rtn_u32 v165, v165, v7
v_cmp_le_u32 vcc, 5436, v46
s_nop 1
v_cndmask_b32 v126, v240, v242, vcc
v_cndmask_b32 v166, v241, v243, vcc
v_cmp_le_u32 vcc, 6432, v46
s_nop 1
v_cndmask_b32 v126, v126, v244, vcc
v_cndmask_b32 v166, v166, v245, vcc
v_cmp_le_u32 vcc, 7344, v46
s_nop 1
v_cndmask_b32 v126, v126, v246, vcc
v_cndmask_b32 v166, v166, v247, vcc
v_mad_u32_u24 v126, v126, v46, v166
v_lshrrev_b32 v126, 20, v126
v_lshl_add_u32 v166, v126, 2, s11
ds_add_rtn_u32 v166, v166, v7
v_cmp_le_u32 vcc, 5436, v47
s_nop 1
v_cndmask_b32 v127, v240, v242, vcc
v_cndmask_b32 v167, v241, v243, vcc
v_cmp_le_u32 vcc, 6432, v47
s_nop 1
v_cndmask_b32 v127, v127, v244, vcc
v_cndmask_b32 v167, v167, v245, vcc
v_cmp_le_u32 vcc, 7344, v47
s_nop 1
v_cndmask_b32 v127, v127, v246, vcc
v_cndmask_b32 v167, v167, v247, vcc
v_mad_u32_u24 v127, v127, v47, v167
v_lshrrev_b32 v127, 20, v127
v_lshl_add_u32 v167, v127, 2, s11
ds_add_rtn_u32 v167, v167, v7
s_waitcnt vmcnt(11)
v_cmp_le_u32 vcc, 5436, v48
s_nop 1
v_cndmask_b32 v128, v240, v242, vcc
v_cndmask_b32 v168, v241, v243, vcc
v_cmp_le_u32 vcc, 6432, v48
s_nop 1
v_cndmask_b32 v128, v128, v244, vcc
v_cndmask_b32 v168, v168, v245, vcc
v_cmp_le_u32 vcc, 7344, v48
s_nop 1
v_cndmask_b32 v128, v128, v246, vcc
v_cndmask_b32 v168, v168, v247, vcc
v_mad_u32_u24 v128, v128, v48, v168
v_lshrrev_b32 v128, 20, v128
v_lshl_add_u32 v168, v128, 2, s11
ds_add_rtn_u32 v168, v168, v7
v_cmp_le_u32 vcc, 5436, v49
s_nop 1
v_cndmask_b32 v129, v240, v242, vcc
v_cndmask_b32 v169, v241, v243, vcc
v_cmp_le_u32 vcc, 6432, v49
s_nop 1
v_cndmask_b32 v129, v129, v244, vcc
v_cndmask_b32 v169, v169, v245, vcc
v_cmp_le_u32 vcc, 7344, v49
s_nop 1
v_cndmask_b32 v129, v129, v246, vcc
v_cndmask_b32 v169, v169, v247, vcc
v_mad_u32_u24 v129, v129, v49, v169
v_lshrrev_b32 v129, 20, v129
v_lshl_add_u32 v169, v129, 2, s11
ds_add_rtn_u32 v169, v169, v7
v_cmp_le_u32 vcc, 5436, v50
s_nop 1
v_cndmask_b32 v130, v240, v242, vcc
v_cndmask_b32 v170, v241, v243, vcc
v_cmp_le_u32 vcc, 6432, v50
s_nop 1
v_cndmask_b32 v130, v130, v244, vcc
v_cndmask_b32 v170, v170, v245, vcc
v_cmp_le_u32 vcc, 7344, v50
s_nop 1
v_cndmask_b32 v130, v130, v246, vcc
v_cndmask_b32 v170, v170, v247, vcc
v_mad_u32_u24 v130, v130, v50, v170
v_lshrrev_b32 v130, 20, v130
v_lshl_add_u32 v170, v130, 2, s11
ds_add_rtn_u32 v170, v170, v7
v_cmp_le_u32 vcc, 5436, v51
s_nop 1
v_cndmask_b32 v131, v240, v242, vcc
v_cndmask_b32 v171, v241, v243, vcc
v_cmp_le_u32 vcc, 6432, v51
s_nop 1
v_cndmask_b32 v131, v131, v244, vcc
v_cndmask_b32 v171, v171, v245, vcc
v_cmp_le_u32 vcc, 7344, v51
s_nop 1
v_cndmask_b32 v131, v131, v246, vcc
v_cndmask_b32 v171, v171, v247, vcc
v_mad_u32_u24 v131, v131, v51, v171
v_lshrrev_b32 v131, 20, v131
v_lshl_add_u32 v171, v131, 2, s11
ds_add_rtn_u32 v171, v171, v7
s_waitcnt vmcnt(10)
s_mov_b64 exec, s[12:13]
v_cmp_le_u32 vcc, 5436, v52
s_nop 1
v_cndmask_b32 v132, v240, v242, vcc
v_cndmask_b32 v172, v241, v243, vcc
v_cmp_le_u32 vcc, 6432, v52
s_nop 1
v_cndmask_b32 v132, v132, v244, vcc
v_cndmask_b32 v172, v172, v245, vcc
v_cmp_le_u32 vcc, 7344, v52
s_nop 1
v_cndmask_b32 v132, v132, v246, vcc
v_cndmask_b32 v172, v172, v247, vcc
v_mad_u32_u24 v132, v132, v52, v172
v_lshrrev_b32 v132, 20, v132
v_lshl_add_u32 v172, v132, 2, s11
ds_add_rtn_u32 v172, v172, v7
v_cmp_le_u32 vcc, 5436, v53
s_nop 1
v_cndmask_b32 v133, v240, v242, vcc
v_cndmask_b32 v173, v241, v243, vcc
v_cmp_le_u32 vcc, 6432, v53
s_nop 1
v_cndmask_b32 v133, v133, v244, vcc
v_cndmask_b32 v173, v173, v245, vcc
v_cmp_le_u32 vcc, 7344, v53
s_nop 1
v_cndmask_b32 v133, v133, v246, vcc
v_cndmask_b32 v173, v173, v247, vcc
v_mad_u32_u24 v133, v133, v53, v173
v_lshrrev_b32 v133, 20, v133
v_lshl_add_u32 v173, v133, 2, s11
ds_add_rtn_u32 v173, v173, v7
v_cmp_le_u32 vcc, 5436, v54
s_nop 1
v_cndmask_b32 v134, v240, v242, vcc
v_cndmask_b32 v174, v241, v243, vcc
v_cmp_le_u32 vcc, 6432, v54
s_nop 1
v_cndmask_b32 v134, v134, v244, vcc
v_cndmask_b32 v174, v174, v245, vcc
v_cmp_le_u32 vcc, 7344, v54
s_nop 1
v_cndmask_b32 v134, v134, v246, vcc
v_cndmask_b32 v174, v174, v247, vcc
v_mad_u32_u24 v134, v134, v54, v174
v_lshrrev_b32 v134, 20, v134
v_lshl_add_u32 v174, v134, 2, s11
ds_add_rtn_u32 v174, v174, v7
v_cmp_le_u32 vcc, 5436, v55
s_nop 1
v_cndmask_b32 v135, v240, v242, vcc
v_cndmask_b32 v175, v241, v243, vcc
v_cmp_le_u32 vcc, 6432, v55
s_nop 1
v_cndmask_b32 v135, v135, v244, vcc
v_cndmask_b32 v175, v175, v245, vcc
v_cmp_le_u32 vcc, 7344, v55
s_nop 1
v_cndmask_b32 v135, v135, v246, vcc
v_cndmask_b32 v175, v175, v247, vcc
v_mad_u32_u24 v135, v135, v55, v175
v_lshrrev_b32 v135, 20, v135
v_lshl_add_u32 v175, v135, 2, s11
ds_add_rtn_u32 v175, v175, v7
s_mov_b64 exec, -1
s_waitcnt vmcnt(9) lgkmcnt(15)
v_and_b32 v8, 0xff, v136
v_lshl_or_b32 v56, v16, 18, v56
v_lshlrev_b32 v8, 2, v8
v_lshl_add_u32 v8, v96, 10, v8
ds_write_b32 v8, v56
v_and_b32 v8, 0xff, v137
v_lshl_or_b32 v57, v17, 18, v57
v_lshlrev_b32 v8, 2, v8
v_lshl_add_u32 v8, v97, 10, v8
ds_write_b32 v8, v57
v_and_b32 v8, 0xff, v138
v_lshl_or_b32 v58, v18, 18, v58
v_lshlrev_b32 v8, 2, v8
v_lshl_add_u32 v8, v98, 10, v8
ds_write_b32 v8, v58
v_and_b32 v8, 0xff, v139
v_lshl_or_b32 v59, v19, 18, v59
v_lshlrev_b32 v8, 2, v8
v_lshl_add_u32 v8, v99, 10, v8
ds_write_b32 v8, v59
s_waitcnt vmcnt(8) lgkmcnt(15)
v_and_b32 v8, 0xff, v140
v_lshl_or_b32 v60, v20, 18, v60
v_lshlrev_b32 v8, 2, v8
v_lshl_add_u32 v8, v100, 10, v8
ds_write_b32 v8, v60
v_and_b32 v8, 0xff, v141
v_lshl_or_b32 v61, v21, 18, v61
v_lshlrev_b32 v8, 2, v8
v_lshl_add_u32 v8, v101, 10, v8
ds_write_b32 v8, v61
v_and_b32 v8, 0xff, v142
v_lshl_or_b32 v62, v22, 18, v62
v_lshlrev_b32 v8, 2, v8
v_lshl_add_u32 v8, v102, 10, v8
ds_write_b32 v8, v62
v_and_b32 v8, 0xff, v143
v_lshl_or_b32 v63, v23, 18, v63
v_lshlrev_b32 v8, 2, v8
v_lshl_add_u32 v8, v103, 10, v8
ds_write_b32 v8, v63
s_waitcnt vmcnt(7) lgkmcnt(15)
v_and_b32 v8, 0xff, v144
v_lshl_or_b32 v64, v24, 18, v64
v_lshlrev_b32 v8, 2, v8
v_lshl_add_u32 v8, v104, 10, v8
ds_write_b32 v8, v64
v_and_b32 v8, 0xff, v145
v_lshl_or_b32 v65, v25, 18, v65
v_lshlrev_b32 v8, 2, v8
v_lshl_add_u32 v8, v105, 10, v8
ds_write_b32 v8, v65
v_and_b32 v8, 0xff, v146
v_lshl_or_b32 v66, v26, 18, v66
v_lshlrev_b32 v8, 2, v8
v_lshl_add_u32 v8, v106, 10, v8
ds_write_b32 v8, v66
v_and_b32 v8, 0xff, v147
v_lshl_or_b32 v67, v27, 18, v67
v_lshlrev_b32 v8, 2, v8
v_lshl_add_u32 v8, v107, 10, v8
ds_write_b32 v8, v67
s_waitcnt vmcnt(6) lgkmcnt(15)
v_and_b32 v8, 0xff, v148
v_lshl_or_b32 v68, v28, 18, v68
v_lshlrev_b32 v8, 2, v8
v_lshl_add_u32 v8, v108, 10, v8
ds_write_b32 v8, v68
v_and_b32 v8, 0xff, v149
v_lshl_or_b32 v69, v29, 18, v69
v_lshlrev_b32 v8, 2, v8
v_lshl_add_u32 v8, v109, 10, v8
ds_write_b32 v8, v69
v_and_b32 v8, 0xff, v150
v_lshl_or_b32 v70, v30, 18, v70
v_lshlrev_b32 v8, 2, v8
v_lshl_add_u32 v8, v110, 10, v8
ds_write_b32 v8, v70
v_and_b32 v8, 0xff, v151
v_lshl_or_b32 v71, v31, 18, v71
v_lshlrev_b32 v8, 2, v8
v_lshl_add_u32 v8, v111, 10, v8
ds_write_b32 v8, v71
s_waitcnt vmcnt(5) lgkmcnt(15)
v_and_b32 v8, 0xff, v152
v_lshl_or_b32 v72, v32, 18, v72
v_lshlrev_b32 v8, 2, v8
v_lshl_add_u32 v8, v112, 10, v8
ds_write_b32 v8, v72
v_and_b32 v8, 0xff, v153
v_lshl_or_b32 v73, v33, 18, v73
v_lshlrev_b32 v8, 2, v8
v_lshl_add_u32 v8, v113, 10, v8
ds_write_b32 v8, v73
v_and_b32 v8, 0xff, v154
v_lshl_or_b32 v74, v34, 18, v74
v_lshlrev_b32 v8, 2, v8
v_lshl_add_u32 v8, v114, 10, v8
ds_write_b32 v8, v74
v_and_b32 v8, 0xff, v155
v_lshl_or_b32 v75, v35, 18, v75
v_lshlrev_b32 v8, 2, v8
v_lshl_add_u32 v8, v115, 10, v8
ds_write_b32 v8, v75
s_waitcnt vmcnt(4) lgkmcnt(15)
v_and_b32 v8, 0xff, v156
v_lshl_or_b32 v76, v36, 18, v76
v_lshlrev_b32 v8, 2, v8
v_lshl_add_u32 v8, v116, 10, v8
ds_write_b32 v8, v76
v_and_b32 v8, 0xff, v157
v_lshl_or_b32 v77, v37, 18, v77
v_lshlrev_b32 v8, 2, v8
v_lshl_add_u32 v8, v117, 10, v8
ds_write_b32 v8, v77
v_and_b32 v8, 0xff, v158
v_lshl_or_b32 v78, v38, 18, v78
v_lshlrev_b32 v8, 2, v8
v_lshl_add_u32 v8, v118, 10, v8
ds_write_b32 v8, v78
v_and_b32 v8, 0xff, v159
v_lshl_or_b32 v79, v39, 18, v79
v_lshlrev_b32 v8, 2, v8
v_lshl_add_u32 v8, v119, 10, v8
ds_write_b32 v8, v79
s_waitcnt vmcnt(3) lgkmcnt(15)
v_and_b32 v8, 0xff, v160
v_lshl_or_b32 v80, v40, 18, v80
v_lshlrev_b32 v8, 2, v8
v_lshl_add_u32 v8, v120, 10, v8
ds_write_b32 v8, v80
v_and_b32 v8, 0xff, v161
v_lshl_or_b32 v81, v41, 18, v81
v_lshlrev_b32 v8, 2, v8
v_lshl_add_u32 v8, v121, 10, v8
ds_write_b32 v8, v81
v_and_b32 v8, 0xff, v162
v_lshl_or_b32 v82, v42, 18, v82
v_lshlrev_b32 v8, 2, v8
v_lshl_add_u32 v8, v122, 10, v8
ds_write_b32 v8, v82
v_and_b32 v8, 0xff, v163
v_lshl_or_b32 v83, v43, 18, v83
v_lshlrev_b32 v8, 2, v8
v_lshl_add_u32 v8, v123, 10, v8
ds_write_b32 v8, v83
s_waitcnt vmcnt(2) lgkmcnt(15)
v_and_b32 v8, 0xff, v164
v_lshl_or_b32 v84, v44, 18, v84
v_lshlrev_b32 v8, 2, v8
v_lshl_add_u32 v8, v124, 10, v8
ds_write_b32 v8, v84
v_and_b32 v8, 0xff, v165
v_lshl_or_b32 v85, v45, 18, v85
v_lshlrev_b32 v8, 2, v8
v_lshl_add_u32 v8, v125, 10, v8
ds_write_b32 v8, v85
v_and_b32 v8, 0xff, v166
v_lshl_or_b32 v86, v46, 18, v86
v_lshlrev_b32 v8, 2, v8
v_lshl_add_u32 v8, v126, 10, v8
ds_write_b32 v8, v86
v_and_b32 v8, 0xff, v167
v_lshl_or_b32 v87, v47, 18, v87
v_lshlrev_b32 v8, 2, v8
v_lshl_add_u32 v8, v127, 10, v8
ds_write_b32 v8, v87
s_waitcnt vmcnt(1) lgkmcnt(15)
v_and_b32 v8, 0xff, v168
v_lshl_or_b32 v88, v48, 18, v88
v_lshlrev_b32 v8, 2, v8
v_lshl_add_u32 v8, v128, 10, v8
ds_write_b32 v8, v88
v_and_b32 v8, 0xff, v169
v_lshl_or_b32 v89, v49, 18, v89
v_lshlrev_b32 v8, 2, v8
v_lshl_add_u32 v8, v129, 10, v8
ds_write_b32 v8, v89
v_and_b32 v8, 0xff, v170
v_lshl_or_b32 v90, v50, 18, v90
v_lshlrev_b32 v8, 2, v8
v_lshl_add_u32 v8, v130, 10, v8
ds_write_b32 v8, v90
v_and_b32 v8, 0xff, v171
v_lshl_or_b32 v91, v51, 18, v91
v_lshlrev_b32 v8, 2, v8
v_lshl_add_u32 v8, v131, 10, v8
ds_write_b32 v8, v91
s_waitcnt vmcnt(0) lgkmcnt(15)
s_mov_b64 exec, s[12:13]
v_and_b32 v8, 0xff, v172
v_lshl_or_b32 v92, v52, 18, v92
v_lshlrev_b32 v8, 2, v8
v_lshl_add_u32 v8, v132, 10, v8
ds_write_b32 v8, v92
v_and_b32 v8, 0xff, v173
v_lshl_or_b32 v93, v53, 18, v93
v_lshlrev_b32 v8, 2, v8
v_lshl_add_u32 v8, v133, 10, v8
ds_write_b32 v8, v93
v_and_b32 v8, 0xff, v174
v_lshl_or_b32 v94, v54, 18, v94
v_lshlrev_b32 v8, 2, v8
v_lshl_add_u32 v8, v134, 10, v8
ds_write_b32 v8, v94
v_and_b32 v8, 0xff, v175
v_lshl_or_b32 v95, v55, 18, v95
v_lshlrev_b32 v8, 2, v8
v_lshl_add_u32 v8, v135, 10, v8
ds_write_b32 v8, v95
s_mov_b64 exec, -1
s_waitcnt lgkmcnt(0)
s_barrier
ds_read_b32 v8, v6
s_mul_i32 s6, s60, 16384
v_lshlrev_b32 v10, 4, v2
v_add_u32 v9, s6, v10
ds_read_b128 v[176:179], v9 offset:0
ds_read_b128 v[180:183], v9 offset:1024
ds_read_b128 v[184:187], v9 offset:2048
ds_read_b128 v[188:191], v9 offset:3072
ds_read_b128 v[192:195], v9 offset:4096
ds_read_b128 v[196:199], v9 offset:5120
ds_read_b128 v[200:203], v9 offset:6144
ds_read_b128 v[204:207], v9 offset:7168
ds_read_b128 v[208:211], v9 offset:8192
ds_read_b128 v[212:215], v9 offset:9216
ds_read_b128 v[216:219], v9 offset:10240
ds_read_b128 v[220:223], v9 offset:11264
ds_read_b128 v[224:227], v9 offset:12288
ds_read_b128 v[228:231], v9 offset:13312
ds_read_b128 v[232:235], v9 offset:14336
ds_read_b128 v[236:239], v9 offset:15360
s_mul_i32 s6, s60, 10485760
s_mul_i32 s7, s4, 40960
s_add_u32 s6, s6, s7
v_lshlrev_b32 v9, 6, v2
s_lshl_b32 s8, s4, 2
s_cmp_eq_u32 s60, 0
s_cselect_b32 s8, s8, 0x7fff0000
s_waitcnt lgkmcnt(15)
buffer_store_dword v8, v9, s[52:55], s8 offen sc1
v_cmp_lt_u32 vcc, 0x100, v8
s_cbranch_vccnz L1_eslow
s_waitcnt lgkmcnt(15)
buffer_store_dwordx4 v[176:179], v10, s[48:51], s6 offen sc1
s_add_u32 s6, s6, 655360
s_waitcnt lgkmcnt(14)
buffer_store_dwordx4 v[180:183], v10, s[48:51], s6 offen sc1
s_add_u32 s6, s6, 655360
s_waitcnt lgkmcnt(13)
buffer_store_dwordx4 v[184:187], v10, s[48:51], s6 offen sc1
s_add_u32 s6, s6, 655360
s_waitcnt lgkmcnt(12)
buffer_store_dwordx4 v[188:191], v10, s[48:51], s6 offen sc1
s_add_u32 s6, s6, 655360
s_waitcnt lgkmcnt(11)
buffer_store_dwordx4 v[192:195], v10, s[48:51], s6 offen sc1
s_add_u32 s6, s6, 655360
s_waitcnt lgkmcnt(10)
buffer_store_dwordx4 v[196:199], v10, s[48:51], s6 offen sc1
s_add_u32 s6, s6, 655360
s_waitcnt lgkmcnt(9)
buffer_store_dwordx4 v[200:203], v10, s[48:51], s6 offen sc1
s_add_u32 s6, s6, 655360
s_waitcnt lgkmcnt(8)
buffer_store_dwordx4 v[204:207], v10, s[48:51], s6 offen sc1
s_add_u32 s6, s6, 655360
s_waitcnt lgkmcnt(7)
buffer_store_dwordx4 v[208:211], v10, s[48:51], s6 offen sc1
s_add_u32 s6, s6, 655360
s_waitcnt lgkmcnt(6)
buffer_store_dwordx4 v[212:215], v10, s[48:51], s6 offen sc1
s_add_u32 s6, s6, 655360
s_waitcnt lgkmcnt(5)
buffer_store_dwordx4 v[216:219], v10, s[48:51], s6 offen sc1
s_add_u32 s6, s6, 655360
s_waitcnt lgkmcnt(4)
buffer_store_dwordx4 v[220:223], v10, s[48:51], s6 offen sc1
s_add_u32 s6, s6, 655360
s_waitcnt lgkmcnt(3)
buffer_store_dwordx4 v[224:227], v10, s[48:51], s6 offen sc1
s_add_u32 s6, s6, 655360
s_waitcnt lgkmcnt(2)
buffer_store_dwordx4 v[228:231], v10, s[48:51], s6 offen sc1
s_add_u32 s6, s6, 655360
s_waitcnt lgkmcnt(1)
buffer_store_dwordx4 v[232:235], v10, s[48:51], s6 offen sc1
s_add_u32 s6, s6, 655360
s_waitcnt lgkmcnt(0)
buffer_store_dwordx4 v[236:239], v10, s[48:51], s6 offen sc1
s_add_u32 s6, s6, 655360
s_branch L1_fin
L1_eslow:
s_mov_b32 s9, 655360
v_mul_u32_u24 v96, s9, v96
v_lshl_add_u32 v96, v136, 2, v96
v_mul_u32_u24 v97, s9, v97
v_lshl_add_u32 v97, v137, 2, v97
v_mul_u32_u24 v98, s9, v98
v_lshl_add_u32 v98, v138, 2, v98
v_mul_u32_u24 v99, s9, v99
v_lshl_add_u32 v99, v139, 2, v99
v_mul_u32_u24 v100, s9, v100
v_lshl_add_u32 v100, v140, 2, v100
v_mul_u32_u24 v101, s9, v101
v_lshl_add_u32 v101, v141, 2, v101
v_mul_u32_u24 v102, s9, v102
v_lshl_add_u32 v102, v142, 2, v102
v_mul_u32_u24 v103, s9, v103
v_lshl_add_u32 v103, v143, 2, v103
v_mul_u32_u24 v104, s9, v104
v_lshl_add_u32 v104, v144, 2, v104
v_mul_u32_u24 v105, s9, v105
v_lshl_add_u32 v105, v145, 2, v105
v_mul_u32_u24 v106, s9, v106
v_lshl_add_u32 v106, v146, 2, v106
v_mul_u32_u24 v107, s9, v107
v_lshl_add_u32 v107, v147, 2, v107
v_mul_u32_u24 v108, s9, v108
v_lshl_add_u32 v108, v148, 2, v108
v_mul_u32_u24 v109, s9, v109
v_lshl_add_u32 v109, v149, 2, v109
v_mul_u32_u24 v110, s9, v110
v_lshl_add_u32 v110, v150, 2, v110
v_mul_u32_u24 v111, s9, v111
v_lshl_add_u32 v111, v151, 2, v111
v_mul_u32_u24 v112, s9, v112
v_lshl_add_u32 v112, v152, 2, v112
v_mul_u32_u24 v113, s9, v113
v_lshl_add_u32 v113, v153, 2, v113
v_mul_u32_u24 v114, s9, v114
v_lshl_add_u32 v114, v154, 2, v114
v_mul_u32_u24 v115, s9, v115
v_lshl_add_u32 v115, v155, 2, v115
v_mul_u32_u24 v116, s9, v116
v_lshl_add_u32 v116, v156, 2, v116
v_mul_u32_u24 v117, s9, v117
v_lshl_add_u32 v117, v157, 2, v117
v_mul_u32_u24 v118, s9, v118
v_lshl_add_u32 v118, v158, 2, v118
v_mul_u32_u24 v119, s9, v119
v_lshl_add_u32 v119, v159, 2, v119
v_mul_u32_u24 v120, s9, v120
v_lshl_add_u32 v120, v160, 2, v120
v_mul_u32_u24 v121, s9, v121
v_lshl_add_u32 v121, v161, 2, v121
v_mul_u32_u24 v122, s9, v122
v_lshl_add_u32 v122, v162, 2, v122
v_mul_u32_u24 v123, s9, v123
v_lshl_add_u32 v123, v163, 2, v123
v_mul_u32_u24 v124, s9, v124
v_lshl_add_u32 v124, v164, 2, v124
v_mul_u32_u24 v125, s9, v125
v_lshl_add_u32 v125, v165, 2, v125
v_mul_u32_u24 v126, s9, v126
v_lshl_add_u32 v126, v166, 2, v126
v_mul_u32_u24 v127, s9, v127
v_lshl_add_u32 v127, v167, 2, v127
v_mul_u32_u24 v128, s9, v128
v_lshl_add_u32 v128, v168, 2, v128
v_mul_u32_u24 v129, s9, v129
v_lshl_add_u32 v129, v169, 2, v129
v_mul_u32_u24 v130, s9, v130
v_lshl_add_u32 v130, v170, 2, v130
v_mul_u32_u24 v131, s9, v131
v_lshl_add_u32 v131, v171, 2, v131
v_mul_u32_u24 v132, s9, v132
v_lshl_add_u32 v132, v172, 2, v132
v_mul_u32_u24 v133, s9, v133
v_lshl_add_u32 v133, v173, 2, v133
v_mul_u32_u24 v134, s9, v134
v_lshl_add_u32 v134, v174, 2, v134
v_mul_u32_u24 v135, s9, v135
v_lshl_add_u32 v135, v175, 2, v135
buffer_store_dword v56, v96, s[48:51], s7 offen sc1
buffer_store_dword v57, v97, s[48:51], s7 offen sc1
buffer_store_dword v58, v98, s[48:51], s7 offen sc1
buffer_store_dword v59, v99, s[48:51], s7 offen sc1
buffer_store_dword v60, v100, s[48:51], s7 offen sc1
buffer_store_dword v61, v101, s[48:51], s7 offen sc1
buffer_store_dword v62, v102, s[48:51], s7 offen sc1
buffer_store_dword v63, v103, s[48:51], s7 offen sc1
buffer_store_dword v64, v104, s[48:51], s7 offen sc1
buffer_store_dword v65, v105, s[48:51], s7 offen sc1
buffer_store_dword v66, v106, s[48:51], s7 offen sc1
buffer_store_dword v67, v107, s[48:51], s7 offen sc1
buffer_store_dword v68, v108, s[48:51], s7 offen sc1
buffer_store_dword v69, v109, s[48:51], s7 offen sc1
buffer_store_dword v70, v110, s[48:51], s7 offen sc1
buffer_store_dword v71, v111, s[48:51], s7 offen sc1
buffer_store_dword v72, v112, s[48:51], s7 offen sc1
buffer_store_dword v73, v113, s[48:51], s7 offen sc1
buffer_store_dword v74, v114, s[48:51], s7 offen sc1
buffer_store_dword v75, v115, s[48:51], s7 offen sc1
buffer_store_dword v76, v116, s[48:51], s7 offen sc1
buffer_store_dword v77, v117, s[48:51], s7 offen sc1
buffer_store_dword v78, v118, s[48:51], s7 offen sc1
buffer_store_dword v79, v119, s[48:51], s7 offen sc1
buffer_store_dword v80, v120, s[48:51], s7 offen sc1
buffer_store_dword v81, v121, s[48:51], s7 offen sc1
buffer_store_dword v82, v122, s[48:51], s7 offen sc1
buffer_store_dword v83, v123, s[48:51], s7 offen sc1
buffer_store_dword v84, v124, s[48:51], s7 offen sc1
buffer_store_dword v85, v125, s[48:51], s7 offen sc1
buffer_store_dword v86, v126, s[48:51], s7 offen sc1
buffer_store_dword v87, v127, s[48:51], s7 offen sc1
buffer_store_dword v88, v128, s[48:51], s7 offen sc1
buffer_store_dword v89, v129, s[48:51], s7 offen sc1
buffer_store_dword v90, v130, s[48:51], s7 offen sc1
buffer_store_dword v91, v131, s[48:51], s7 offen sc1
s_mov_b64 exec, s[12:13]
buffer_store_dword v92, v132, s[48:51], s7 offen sc1
buffer_store_dword v93, v133, s[48:51], s7 offen sc1
buffer_store_dword v94, v134, s[48:51], s7 offen sc1
buffer_store_dword v95, v135, s[48:51], s7 offen sc1
s_mov_b64 exec, -1
s_branch L1_fin
L2_entry:
s_load_dwordx2 s[4:5], s[0:1], 88
s_load_dwordx2 s[60:61], s[0:1], 0
s_load_dwordx2 s[52:53], s[0:1], 24
s_load_dwordx2 s[56:57], s[0:1], 72
s_and_b32 s35, s2, 7
s_lshr_b32 s37, s2, 3
s_add_u32 s37, s37, 30
s_and_b32 s37, s37, 31
v_lshrrev_b32 v1, 6, v0
s_mov_b32 s36, -1
v_readfirstlane_b32 s38, v1
s_cmp_lt_u32 s37, 30
s_cbranch_scc1 L2_att
s_lshl_b32 s39, s35, 1
s_add_u32 s39, s39, s37
s_sub_u32 s39, s39, 30
s_cmp_lt_u32 s38, 3
s_cbranch_scc1 LE_start
s_cmp_ge_u32 s39, 12
s_cbranch_scc1 L2_end
s_and_b32 s36, s39, 1
s_lshr_b32 s37, s39, 1
s_mov_b32 s38, 39
v_and_b32 v0, 63, v0
s_branch L2_att2
L2_att:
s_mul_i32 s38, s37, 26
s_lshr_b32 s38, s38, 8
s_mul_i32 s39, s38, 10
s_sub_u32 s39, s37, s39
s_and_b32 s37, s35, 1
s_mul_i32 s37, s37, 3
s_add_u32 s37, s37, s38
s_and_b32 s38, s35, 1
s_mul_i32 s38, s38, 5
s_add_u32 s35, s35, s38
s_and_b32 s35, s35, 7
s_lshr_b32 s38, s35, 1
s_mul_i32 s38, s38, 10
s_add_u32 s38, s38, s39
L2_att2:
v_lshrrev_b32 v1, 6, v0
v_and_b32 v243, 63, v0
v_lshlrev_b32 v243, 4, v243
v_readfirstlane_b32 s34, v1
s_mov_b32 s50, 0xe1a06800
s_mov_b32 s51, 0x4e20ad04
s_mul_i32 s39, s37, 9
s_lshr_b64 s[50:51], s[50:51], s39
s_and_b32 s39, s50, 0x1ff
s_bfe_u32 s49, s50, 0x90009
s_sub_u32 s31, s49, s39
s_sub_u32 s31, s31, 4
s_lshl_b32 s39, s39, 14
s_lshl_b32 s49, s49, 14
s_add_u32 s28, s39, 0x4000
s_cmp_eq_u32 s37, 5
s_addc_u32 s31, s31, 0
s_cmp_eq_u32 s37, 5
s_cselect_b32 s28, s39, s28
s_cselect_b32 s39, 5111808, s39
s_cselect_b32 s49, 5120000, s49
s_cselect_b32 s33, 0xff800000, 0
s_mov_b32 s32, 0x5d800000
v_and_b32 v2, 63, v0
v_bfe_u32 v3, v2, 3, 2
v_bfe_u32 v4, v2, 2, 1
v_lshlrev_b32 v241, 12, v3
v_lshl_or_b32 v241, v4, 9, v241
v_lshl_or_b32 v241, v1, 7, v241
v_lshrrev_b32 v4, 5, v2
v_lshl_or_b32 v241, v4, 6, v241
v_and_b32 v3, 2, v3
v_and_b32 v4, 3, v2
v_xor_b32 v3, v3, v4
v_lshl_or_b32 v241, v3, 4, v241
s_cmp_eq_u32 s38, 39
s_cbranch_scc1 LT_disp
s_cmp_lt_u32 s37, 3
s_cselect_b32 s101, 1, -1
s_cselect_b32 s39, 0, 103
s_cselect_b32 s3, 0, 3
s_sub_u32 s3, s37, s3
s_mul_i32 s3, s3, 104
s_add_u32 s39, s39, s3
s_cmp_eq_u32 s37, 5
s_addc_u32 s39, s39, 0
s_lshl_b32 s101, s101, 14
s_lshl_b32 s39, s39, 14
s_add_u32 s28, s39, s101
s_mov_b32 s49, 5120000
s_mov_b32 s31, 40
s_mov_b32 s100, 5
s_lshl_b32 s30, s34, 12
s_lshl_b32 s50, s34, 13
s_add_u32 s50, s50, 0x20000
s_mov_b32 m0, s30
s_mov_b32 s6, 0x92c51840
s_mov_b32 s7, 0xfb73ea6d
s_mul_i32 s3, s37, 12
s_min_u32 s3, s3, 56
s_lshr_b64 s[6:7], s[6:7], s3
s_bfe_u32 s29, s6, 0x40008
s_bfe_u32 s7, s6, 0x40004
s_and_b32 s6, s6, 15
s_cmp_lt_u32 s37, 4
s_cselect_b32 s29, s29, 16
s_mov_b32 s94, 0
s_mov_b32 s95, 0
s_lshr_b32 s3, s6, 2
s_cmp_eq_u32 s3, s34
s_cselect_b32 s94, s6, s94
s_cselect_b32 s95, 1, s95
s_lshr_b32 s3, s7, 2
s_cmp_eq_u32 s3, s34
s_cselect_b32 s94, s7, s94
s_cselect_b32 s95, 1, s95
s_lshr_b32 s3, s29, 2
s_cmp_eq_u32 s3, s34
s_cselect_b32 s94, s29, s94
s_cselect_b32 s95, 1, s95
s_and_b32 s94, s94, 3
s_lshl_b32 s3, s38, 17
s_lshl_b32 s51, s34, 7
s_add_u32 s3, s3, s51
s_lshl_b32 s6, s6, 13
s_add_u32 s6, s6, s3
s_lshl_b32 s7, s7, 13
s_add_u32 s7, s7, s3
s_lshl_b32 s29, s29, 13
s_add_u32 s29, s29, s3
s_mov_b64 s[96:97], 0
s_lshr_b32 s3, s6, 9
s_mul_i32 s40, s3, 6945
s_mov_b32 s41, s40
s_mul_i32 s40, s3, 6317
s_add_u32 s40, s40, 0x340674
s_cmp_lt_u32 s3, 5436
s_cselect_b32 s41, s41, s40
s_mul_i32 s40, s3, 6899
s_add_u32 s40, s40, 0xfffae6a0
s_cmp_lt_u32 s3, 6432
s_cselect_b32 s41, s41, s40
s_mul_i32 s40, s3, 6242
s_add_u32 s40, s40, 0x4484a0
s_cmp_lt_u32 s3, 7344
s_cselect_b32 s41, s41, s40
s_lshr_b32 s3, s41, 20
s_bitset1_b64 s[96:97], s3
s_lshr_b32 s3, s6, 9
s_add_u32 s3, s3, 15
s_mul_i32 s40, s3, 6945
s_mov_b32 s41, s40
s_mul_i32 s40, s3, 6317
s_add_u32 s40, s40, 0x340674
s_cmp_lt_u32 s3, 5436
s_cselect_b32 s41, s41, s40
s_mul_i32 s40, s3, 6899
s_add_u32 s40, s40, 0xfffae6a0
s_cmp_lt_u32 s3, 6432
s_cselect_b32 s41, s41, s40
s_mul_i32 s40, s3, 6242
s_add_u32 s40, s40, 0x4484a0
s_cmp_lt_u32 s3, 7344
s_cselect_b32 s41, s41, s40
s_lshr_b32 s3, s41, 20
s_bitset1_b64 s[96:97], s3
s_lshr_b32 s3, s7, 9
s_mul_i32 s40, s3, 6945
s_mov_b32 s41, s40
s_mul_i32 s40, s3, 6317
s_add_u32 s40, s40, 0x340674
s_cmp_lt_u32 s3, 5436
s_cselect_b32 s41, s41, s40
s_mul_i32 s40, s3, 6899
s_add_u32 s40, s40, 0xfffae6a0
s_cmp_lt_u32 s3, 6432
s_cselect_b32 s41, s41, s40
s_mul_i32 s40, s3, 6242
s_add_u32 s40, s40, 0x4484a0
s_cmp_lt_u32 s3, 7344
s_cselect_b32 s41, s41, s40
s_lshr_b32 s3, s41, 20
s_bitset1_b64 s[96:97], s3
s_lshr_b32 s3, s7, 9
s_add_u32 s3, s3, 15
s_mul_i32 s40, s3, 6945
s_mov_b32 s41, s40
s_mul_i32 s40, s3, 6317
s_add_u32 s40, s40, 0x340674
s_cmp_lt_u32 s3, 5436
s_cselect_b32 s41, s41, s40
s_mul_i32 s40, s3, 6899
s_add_u32 s40, s40, 0xfffae6a0
s_cmp_lt_u32 s3, 6432
s_cselect_b32 s41, s41, s40
s_mul_i32 s40, s3, 6242
s_add_u32 s40, s40, 0x4484a0
s_cmp_lt_u32 s3, 7344
s_cselect_b32 s41, s41, s40
s_lshr_b32 s3, s41, 20
s_bitset1_b64 s[96:97], s3
s_lshr_b32 s3, s29, 9
s_mul_i32 s40, s3, 6945
s_mov_b32 s41, s40
s_mul_i32 s40, s3, 6317
s_add_u32 s40, s40, 0x340674
s_cmp_lt_u32 s3, 5436
s_cselect_b32 s41, s41, s40
s_mul_i32 s40, s3, 6899
s_add_u32 s40, s40, 0xfffae6a0
s_cmp_lt_u32 s3, 6432
s_cselect_b32 s41, s41, s40
s_mul_i32 s40, s3, 6242
s_add_u32 s40, s40, 0x4484a0
s_cmp_lt_u32 s3, 7344
s_cselect_b32 s41, s41, s40
s_lshr_b32 s3, s41, 20
s_bitset1_b64 s[96:97], s3
s_lshr_b32 s3, s29, 9
s_add_u32 s3, s3, 15
s_mul_i32 s40, s3, 6945
s_mov_b32 s41, s40
s_mul_i32 s40, s3, 6317
s_add_u32 s40, s40, 0x340674
s_cmp_lt_u32 s3, 5436
s_cselect_b32 s41, s41, s40
s_mul_i32 s40, s3, 6899
s_add_u32 s40, s40, 0xfffae6a0
s_cmp_lt_u32 s3, 6432
s_cselect_b32 s41, s41, s40
s_mul_i32 s40, s3, 6242
s_add_u32 s40, s40, 0x4484a0
s_cmp_lt_u32 s3, 7344
s_cselect_b32 s41, s41, s40
s_lshr_b32 s3, s41, 20
s_bitset1_b64 s[96:97], s3
s_mul_i32 s3, s38, 6
s_add_u32 s3, s3, s37
s_cmp_eq_u32 s3, 233
s_cselect_b32 s3, 0, s37
s_cmp_lt_u32 s3, 4
s_cselect_b32 s29, s29, 0x70000000
s_lshl_b32 s51, s38, 5
s_lshl_b32 s3, s34, 3
s_add_u32 s51, s51, s3
s_add_u32 s51, s51, s37
s_mul_i32 s51, s51, 128
s_add_u32 s51, s51, 0x7c00000
s_lshr_b32 s40, s39, 17
s_min_u32 s40, s40, 38
s_lshr_b32 s41, s28, 17
s_add_u32 s3, s28, s101
s_lshr_b32 s3, s3, 17
v_mov_b32 v5, s38
v_mov_b32 v6, s40
v_cmp_lt_u32 vcc, 0x7f, v243
s_nop 1
v_cndmask_b32 v5, v5, v6, vcc
v_mov_b32 v6, s41
v_cmp_lt_u32 vcc, 0xff, v243
s_nop 1
v_cndmask_b32 v5, v5, v6, vcc
v_mov_b32 v6, s3
v_cmp_lt_u32 vcc, 0x17f, v243
s_nop 1
v_cndmask_b32 v5, v5, v6, vcc
v_bfe_u32 v6, v243, 4, 3
v_min_u32 v6, 5, v6
v_mad_u32_u24 v5, v5, 6, v6
v_lshlrev_b32 v5, 7, v5
v_add_u32 v5, 0x7c2a000, v5
s_mul_i32 s3, s101, 54
s_add_u32 s3, s3, s39
s_min_u32 s41, s3, s39
s_max_u32 s3, s3, s39
s_lshr_b32 s41, s41, 17
s_min_u32 s40, s40, s41
s_mul_i32 s40, s40, 6
s_lshr_b32 s3, s3, 17
s_min_u32 s3, s3, 38
s_mul_i32 s3, s3, 6
s_add_u32 s3, s3, 5
v_lshrrev_b32 v230, 4, v243
v_add_u32 v230, s40, v230
v_min_u32 v230, s3, v230
v_lshlrev_b32 v230, 7, v230
v_add_u32 v230, 0x7c2a000, v230
s_waitcnt lgkmcnt(0)
s_add_u32 s12, s4, 0x6800000
s_addc_u32 s13, s5, 0
s_mov_b32 s14, 0x0
s_mov_b32 s15, 0x00020000
s_mov_b32 s14, s49
s_add_u32 s8, s4, 0x0
s_addc_u32 s9, s5, 0
s_mov_b32 s10, 0x4e4000
s_mov_b32 s11, 0x00020000
s_mul_i32 s35, s37, 0x600000
s_add_u32 s20, s4, 0x2000000
s_addc_u32 s21, s5, 0
s_add_u32 s20, s20, s35
s_addc_u32 s21, s21, 0
s_mov_b32 s22, 0x4e4000
s_mov_b32 s23, 0x00020000
s_add_u32 s24, s4, 0x6000000
s_addc_u32 s25, s5, 0
s_mov_b32 s26, 0x139000
s_mov_b32 s27, 0x00020000
s_lshl_b32 s35, s38, 4
s_lshl_b32 s41, s34, 2
s_add_u32 s35, s35, s41
s_lshl_b32 s40, s35, 13
s_lshl_b32 s94, s94, 13
s_add_u32 s40, s40, s94
s_xor_b32 s41, s40, 8192
s_xor_b32 s42, s40, 16384
s_xor_b32 s43, s40, 24576
s_add_u32 s44, s40, 4096
s_add_u32 s45, s41, 4096
s_add_u32 s46, s42, 4096
s_add_u32 s47, s43, 4096
s_lshl_b32 s48, s35, 10
s_lshl_b32 s35, s37, 3
s_add_u32 s48, s48, s35
v_mov_b32 v232, 0
v_mov_b32 v233, 0
v_mov_b32 v234, 0
v_mov_b32 v235, 0
v_bfe_u32 v240, v243, 4, 3
v_lshlrev_b32 v240, 6, v240
v_bfe_u32 v242, v243, 7, 1
v_lshl_or_b32 v240, v242, 10, v240
v_bfe_u32 v242, v243, 8, 2
v_lshl_or_b32 v240, v242, 4, v240
v_bfe_u32 v242, v243, 6, 1
v_lshlrev_b32 v242, 5, v242
v_xor_b32 v240, v240, v242
v_and_b32 v246, 0x1c0, v243
v_bfe_u32 v242, v243, 9, 1
v_lshl_or_b32 v246, v242, 10, v246
v_bfe_u32 v242, v243, 8, 1
v_lshl_or_b32 v246, v242, 5, v246
v_bfe_u32 v242, v243, 4, 2
v_lshl_or_b32 v246, v242, 3, v246
v_xor_b32 v247, 32, v246
v_bfe_i32 v242, v243, 8, 1
v_and_b32 v192, s33, v242
v_and_b32 v193, s33, v242
v_and_b32 v194, s33, v242
v_and_b32 v195, s33, v242
v_mfma_f32_32x32x16_bf16 a[0:15], v[232:235], v[232:235], 0
v_mfma_f32_32x32x16_bf16 a[16:31], v[232:235], v[232:235], 0
v_mfma_f32_32x32x16_bf16 a[32:47], v[232:235], v[232:235], 0
v_mfma_f32_32x32x16_bf16 a[48:63], v[232:235], v[232:235], 0
v_mfma_f32_32x32x16_bf16 a[64:79], v[232:235], v[232:235], 0
v_mfma_f32_32x32x16_bf16 a[80:95], v[232:235], v[232:235], 0
v_mfma_f32_32x32x16_bf16 a[96:111], v[232:235], v[232:235], 0
v_mfma_f32_32x32x16_bf16 a[112:127], v[232:235], v[232:235], 0
v_mfma_f32_32x32x16_bf16 a[128:143], v[232:235], v[232:235], 0
v_mfma_f32_32x32x16_bf16 a[144:159], v[232:235], v[232:235], 0
v_mfma_f32_32x32x16_bf16 a[160:175], v[232:235], v[232:235], 0
v_mfma_f32_32x32x16_bf16 a[176:191], v[232:235], v[232:235], 0
v_mfma_f32_32x32x16_bf16 a[192:207], v[232:235], v[232:235], 0
v_mfma_f32_32x32x16_bf16 a[208:223], v[232:235], v[232:235], 0
v_mfma_f32_32x32x16_bf16 a[224:239], v[232:235], v[232:235], 0
v_mfma_f32_32x32x16_bf16 a[240:255], v[232:235], v[232:235], 0
s_add_u32 s16, s4, 0x0
s_addc_u32 s17, s5, 0
s_mov_b32 s18, 0x10000000
s_mov_b32 s19, 0x00020000
s_mov_b32 s3, 0x10000
LM_pa:
buffer_load_dwordx2 v[6:7], v5, s[16:19], 0 offen sc1
s_sub_u32 s3, s3, 1
s_waitcnt vmcnt(0)
s_cbranch_scc1 LM_pa_go
v_cmp_ne_u64 vcc, s[98:99], v[6:7]
s_nop 1
s_cbranch_vccnz LM_pa
LM_pa_go:
buffer_load_dwordx4 v241, s[12:15], s39 offen offset:0 sc1 lds
buffer_load_dwordx4 v241, s[12:15], s39 offen offset:1024 sc1 lds
buffer_load_dwordx4 v241, s[12:15], s39 offen offset:2048 sc1 lds
buffer_load_dwordx4 v241, s[12:15], s39 offen offset:3072 sc1 lds
s_add_u32 m0, s30, 0x4000
s_nop 0
buffer_load_dwordx4 v241, s[12:15], s28 offen offset:0 sc1 lds
buffer_load_dwordx4 v241, s[12:15], s28 offen offset:1024 sc1 lds
buffer_load_dwordx4 v[0:3], v243, s[8:11], s40 offen offset:0 sc1
buffer_load_dwordx4 v[32:35], v243, s[8:11], s41 offen offset:0 sc1
buffer_load_dwordx4 v[64:67], v243, s[8:11], s42 offen offset:0 sc1
buffer_load_dwordx4 v[96:99], v243, s[8:11], s43 offen offset:0 sc1
buffer_load_dwordx4 v[4:7], v243, s[8:11], s40 offen offset:1024 sc1
buffer_load_dwordx4 v[36:39], v243, s[8:11], s41 offen offset:1024 sc1
buffer_load_dwordx4 v[68:71], v243, s[8:11], s42 offen offset:1024 sc1
buffer_load_dwordx4 v[100:103], v243, s[8:11], s43 offen offset:1024 sc1
buffer_load_dwordx4 v[8:11], v243, s[8:11], s40 offen offset:2048 sc1
buffer_load_dwordx4 v[40:43], v243, s[8:11], s41 offen offset:2048 sc1
buffer_load_dwordx4 v[72:75], v243, s[8:11], s42 offen offset:2048 sc1
buffer_load_dwordx4 v[104:107], v243, s[8:11], s43 offen offset:2048 sc1
buffer_load_dwordx4 v[12:15], v243, s[8:11], s40 offen offset:3072 sc1
buffer_load_dwordx4 v[44:47], v243, s[8:11], s41 offen offset:3072 sc1
buffer_load_dwordx4 v[76:79], v243, s[8:11], s42 offen offset:3072 sc1
buffer_load_dwordx4 v[108:111], v243, s[8:11], s43 offen offset:3072 sc1
buffer_load_dwordx4 v[16:19], v243, s[8:11], s44 offen offset:0 sc1
buffer_load_dwordx4 v[48:51], v243, s[8:11], s45 offen offset:0 sc1
buffer_load_dwordx4 v[80:83], v243, s[8:11], s46 offen offset:0 sc1
buffer_load_dwordx4 v[112:115], v243, s[8:11], s47 offen offset:0 sc1
buffer_load_dwordx2 v[228:229], v230, s[16:19], 0 offen sc1
s_waitcnt vmcnt(21)
s_barrier
ds_read_b128 v[208:211], v240 offset:0
ds_read_b128 v[212:215], v240 offset:2048
ds_read_b128 v[216:219], v240 offset:16384
ds_read_b128 v[220:223], v240 offset:512
s_waitcnt lgkmcnt(3)
s_waitcnt vmcnt(17)
v_mfma_f32_16x16x32_bf16 v[128:131], v[208:211], v[0:3], v[192:195]
buffer_load_dwordx4 v[20:23], v243, s[8:11], s44 offen offset:1024 sc1
v_mfma_f32_16x16x32_bf16 v[132:135], v[208:211], v[32:35], v[192:195]
v_mfma_f32_16x16x32_bf16 v[136:139], v[208:211], v[64:67], v[192:195]
v_mfma_f32_16x16x32_bf16 v[140:143], v[208:211], v[96:99], v[192:195]
ds_read_b128 v[208:211], v240 offset:2560
s_waitcnt lgkmcnt(3)
buffer_load_dwordx4 v[52:55], v243, s[8:11], s45 offen offset:1024 sc1
v_mfma_f32_16x16x32_bf16 v[144:147], v[212:215], v[0:3], v[192:195]
v_mfma_f32_16x16x32_bf16 v[148:151], v[212:215], v[32:35], v[192:195]
v_mfma_f32_16x16x32_bf16 v[152:155], v[212:215], v[64:67], v[192:195]
buffer_load_dwordx4 v[84:87], v243, s[8:11], s46 offen offset:1024 sc1
v_mfma_f32_16x16x32_bf16 v[156:159], v[212:215], v[96:99], v[192:195]
ds_read_b128 v[212:215], v240 offset:16896
s_waitcnt lgkmcnt(3)
v_mfma_f32_16x16x32_bf16 v[176:179], v[216:219], v[0:3], 0
v_mfma_f32_16x16x32_bf16 v[180:183], v[216:219], v[32:35], 0
buffer_load_dwordx4 v[116:119], v243, s[8:11], s47 offen offset:1024 sc1
v_mfma_f32_16x16x32_bf16 v[184:187], v[216:219], v[64:67], 0
v_mfma_f32_16x16x32_bf16 v[188:191], v[216:219], v[96:99], 0
ds_read_b128 v[216:219], v240 offset:4096
s_waitcnt lgkmcnt(3)
s_waitcnt vmcnt(17)
v_mfma_f32_16x16x32_bf16 v[128:131], v[220:223], v[4:7], v[128:131]
buffer_load_dwordx4 v[24:27], v243, s[8:11], s44 offen offset:2048 sc1
v_mfma_f32_16x16x32_bf16 v[132:135], v[220:223], v[36:39], v[132:135]
v_mfma_f32_16x16x32_bf16 v[136:139], v[220:223], v[68:71], v[136:139]
v_mfma_f32_16x16x32_bf16 v[140:143], v[220:223], v[100:103], v[140:143]
ds_read_b128 v[220:223], v240 offset:6144
s_waitcnt lgkmcnt(3)
buffer_load_dwordx4 v[56:59], v243, s[8:11], s45 offen offset:2048 sc1
v_mfma_f32_16x16x32_bf16 v[144:147], v[208:211], v[4:7], v[144:147]
v_mfma_f32_16x16x32_bf16 v[148:151], v[208:211], v[36:39], v[148:151]
v_mfma_f32_16x16x32_bf16 v[152:155], v[208:211], v[68:71], v[152:155]
buffer_load_dwordx4 v[88:91], v243, s[8:11], s46 offen offset:2048 sc1
v_mfma_f32_16x16x32_bf16 v[156:159], v[208:211], v[100:103], v[156:159]
ds_read_b128 v[208:211], v240 offset:20480
s_waitcnt lgkmcnt(3)
v_mfma_f32_16x16x32_bf16 v[176:179], v[212:215], v[4:7], v[176:179]
v_mfma_f32_16x16x32_bf16 v[180:183], v[212:215], v[36:39], v[180:183]
buffer_load_dwordx4 v[120:123], v243, s[8:11], s47 offen offset:2048 sc1
v_mfma_f32_16x16x32_bf16 v[184:187], v[212:215], v[68:71], v[184:187]
v_mfma_f32_16x16x32_bf16 v[188:191], v[212:215], v[100:103], v[188:191]
ds_read_b128 v[212:215], v240 offset:4608
s_waitcnt lgkmcnt(3)
s_waitcnt vmcnt(17)
v_mfma_f32_16x16x32_bf16 v[128:131], v[216:219], v[8:11], v[128:131]
buffer_load_dwordx4 v[28:31], v243, s[8:11], s44 offen offset:3072 sc1
v_mfma_f32_16x16x32_bf16 v[132:135], v[216:219], v[40:43], v[132:135]
v_mfma_f32_16x16x32_bf16 v[136:139], v[216:219], v[72:75], v[136:139]
v_mfma_f32_16x16x32_bf16 v[140:143], v[216:219], v[104:107], v[140:143]
ds_read_b128 v[216:219], v240 offset:6656
s_waitcnt lgkmcnt(3)
buffer_load_dwordx4 v[60:63], v243, s[8:11], s45 offen offset:3072 sc1
v_mfma_f32_16x16x32_bf16 v[144:147], v[220:223], v[8:11], v[144:147]
v_mfma_f32_16x16x32_bf16 v[148:151], v[220:223], v[40:43], v[148:151]
v_mfma_f32_16x16x32_bf16 v[152:155], v[220:223], v[72:75], v[152:155]
buffer_load_dwordx4 v[92:95], v243, s[8:11], s46 offen offset:3072 sc1
v_mfma_f32_16x16x32_bf16 v[156:159], v[220:223], v[104:107], v[156:159]
ds_read_b128 v[220:223], v240 offset:20992
s_waitcnt lgkmcnt(3)
v_mfma_f32_16x16x32_bf16 v[176:179], v[208:211], v[8:11], v[176:179]
v_mfma_f32_16x16x32_bf16 v[180:183], v[208:211], v[40:43], v[180:183]
buffer_load_dwordx4 v[124:127], v243, s[8:11], s47 offen offset:3072 sc1
v_mfma_f32_16x16x32_bf16 v[184:187], v[208:211], v[72:75], v[184:187]
v_mfma_f32_16x16x32_bf16 v[188:191], v[208:211], v[104:107], v[188:191]
ds_read_b128 v[208:211], v240 offset:8192
s_waitcnt lgkmcnt(3)
s_waitcnt vmcnt(17)
v_mfma_f32_16x16x32_bf16 v[128:131], v[212:215], v[12:15], v[128:131]
s_add_u32 s16, s4, 0x0
s_addc_u32 s17, s5, 0
s_mov_b32 s18, 0x10000000
v_mfma_f32_16x16x32_bf16 v[132:135], v[212:215], v[44:47], v[132:135]
buffer_load_dwordx4 v241, s[12:15], s28 offen offset:2048 sc1 lds
s_mov_b32 s19, 0x00020000
s_add_u32 s8, s60, 0x0
v_mfma_f32_16x16x32_bf16 v[136:139], v[212:215], v[76:79], v[136:139]
s_addc_u32 s9, s61, 0
s_mov_b32 s10, 0x4e2000
s_mov_b32 s11, 0x00020000
v_mfma_f32_16x16x32_bf16 v[140:143], v[212:215], v[108:111], v[140:143]
ds_read_b128 v[212:215], v240 offset:10240
s_waitcnt lgkmcnt(3)
buffer_load_dwordx4 v241, s[12:15], s28 offen offset:3072 sc1 lds
v_mfma_f32_16x16x32_bf16 v[144:147], v[216:219], v[12:15], v[144:147]
s_mov_b32 s54, 0x4e20
s_mov_b32 s55, 0x00020000
s_mov_b32 s58, 0x4e2000
v_mfma_f32_16x16x32_bf16 v[148:151], v[216:219], v[44:47], v[148:151]
s_mov_b32 s59, 0x00020000
s_lshr_b32 s48, s40, 2
s_cmp_eq_u32 s95, 1
v_mfma_f32_16x16x32_bf16 v[152:155], v[216:219], v[76:79], v[152:155]
s_cselect_b32 s40, 0x70000000, s40
s_cselect_b32 s44, 0x70000000, s44
s_cmp_lt_u32 s37, 3
v_mfma_f32_16x16x32_bf16 v[156:159], v[216:219], v[108:111], v[156:159]
ds_read_b128 v[216:219], v240 offset:24576
s_waitcnt lgkmcnt(3)
s_cselect_b32 s3, 0, 3
v_mfma_f32_16x16x32_bf16 v[176:179], v[220:223], v[12:15], v[176:179]
s_cselect_b32 s94, 0, 8
s_sub_u32 s3, s37, s3
s_lshl_b32 s38, s38, 2
v_mfma_f32_16x16x32_bf16 v[180:183], v[220:223], v[44:47], v[180:183]
s_add_u32 s38, s38, s3
s_lshl_b32 s38, s38, 10
s_add_u32 s38, s38, 0x7c00300
v_mfma_f32_16x16x32_bf16 v[184:187], v[220:223], v[76:79], v[184:187]
s_add_u32 s94, s94, s38
s_xor_b32 s95, s94, 8
s_add_u32 s49, s95, 32
v_mfma_f32_16x16x32_bf16 v[188:191], v[220:223], v[108:111], v[188:191]
ds_read_b128 v[220:223], v240 offset:8704
s_waitcnt lgkmcnt(3)
s_waitcnt vmcnt(15)
v_mfma_f32_16x16x32_bf16 v[128:131], v[208:211], v[16:19], v[128:131]
s_cmp_eq_u32 s3, 2
s_cselect_b32 s35, s38, s94
s_cselect_b32 s49, s49, s95
v_mfma_f32_16x16x32_bf16 v[132:135], v[208:211], v[48:51], v[132:135]
s_add_u32 s28, s28, s101
s_add_u32 m0, s30, 0x8000
s_nop 0
s_mov_b32 s39, 4
v_mfma_f32_16x16x32_bf16 v[136:139], v[208:211], v[80:83], v[136:139]
v_mfma_f32_16x16x32_bf16 v[140:143], v[208:211], v[112:115], v[140:143]
ds_read_b128 v[208:211], v240 offset:10752
s_waitcnt lgkmcnt(3)
buffer_load_dwordx4 v241, s[12:15], s28 offen offset:0 sc1 lds
v_mfma_f32_16x16x32_bf16 v[144:147], v[212:215], v[16:19], v[144:147]
v_mfma_f32_16x16x32_bf16 v[148:151], v[212:215], v[48:51], v[148:151]
buffer_load_dwordx4 v241, s[12:15], s28 offen offset:1024 sc1 lds
v_mfma_f32_16x16x32_bf16 v[152:155], v[212:215], v[80:83], v[152:155]
v_mfma_f32_16x16x32_bf16 v[156:159], v[212:215], v[112:115], v[156:159]
ds_read_b128 v[212:215], v240 offset:25088
s_waitcnt lgkmcnt(3)
v_mfma_f32_16x16x32_bf16 v[176:179], v[216:219], v[16:19], v[176:179]
v_mfma_f32_16x16x32_bf16 v[180:183], v[216:219], v[48:51], v[180:183]
v_mfma_f32_16x16x32_bf16 v[184:187], v[216:219], v[80:83], v[184:187]
v_mfma_f32_16x16x32_bf16 v[188:191], v[216:219], v[112:115], v[188:191]
ds_read_b128 v[216:219], v240 offset:12288
s_waitcnt lgkmcnt(3)
s_waitcnt vmcnt(12)
v_mfma_f32_16x16x32_bf16 v[128:131], v[220:223], v[20:23], v[128:131]
v_mfma_f32_16x16x32_bf16 v[132:135], v[220:223], v[52:55], v[132:135]
buffer_load_dwordx4 v241, s[12:15], s28 offen offset:2048 sc1 lds
v_mfma_f32_16x16x32_bf16 v[136:139], v[220:223], v[84:87], v[136:139]
v_mfma_f32_16x16x32_bf16 v[140:143], v[220:223], v[116:119], v[140:143]
ds_read_b128 v[220:223], v240 offset:14336
s_waitcnt lgkmcnt(3)
buffer_load_dwordx4 v241, s[12:15], s28 offen offset:3072 sc1 lds
v_mfma_f32_16x16x32_bf16 v[144:147], v[208:211], v[20:23], v[144:147]
v_mfma_f32_16x16x32_bf16 v[148:151], v[208:211], v[52:55], v[148:151]
v_mfma_f32_16x16x32_bf16 v[152:155], v[208:211], v[84:87], v[152:155]
v_mfma_f32_16x16x32_bf16 v[156:159], v[208:211], v[116:119], v[156:159]
ds_read_b128 v[208:211], v240 offset:28672
s_waitcnt lgkmcnt(3)
v_mfma_f32_16x16x32_bf16 v[176:179], v[212:215], v[20:23], v[176:179]
v_mfma_f32_16x16x32_bf16 v[180:183], v[212:215], v[52:55], v[180:183]
v_mfma_f32_16x16x32_bf16 v[184:187], v[212:215], v[84:87], v[184:187]
v_mfma_f32_16x16x32_bf16 v[188:191], v[212:215], v[116:119], v[188:191]
ds_read_b128 v[212:215], v240 offset:12800
s_waitcnt lgkmcnt(3)
s_waitcnt vmcnt(10)
v_mfma_f32_16x16x32_bf16 v[128:131], v[216:219], v[24:27], v[128:131]
v_mfma_f32_16x16x32_bf16 v[132:135], v[216:219], v[56:59], v[132:135]
s_add_u32 s28, s28, s101
s_add_u32 s30, s30, 0xc000
v_mfma_f32_16x16x32_bf16 v[136:139], v[216:219], v[88:91], v[136:139]
v_mfma_f32_16x16x32_bf16 v[140:143], v[216:219], v[120:123], v[140:143]
ds_read_b128 v[216:219], v240 offset:14848
s_waitcnt lgkmcnt(3)
v_mfma_f32_16x16x32_bf16 v[144:147], v[220:223], v[24:27], v[144:147]
v_mfma_f32_16x16x32_bf16 v[148:151], v[220:223], v[56:59], v[148:151]
v_mfma_f32_16x16x32_bf16 v[152:155], v[220:223], v[88:91], v[152:155]
v_mfma_f32_16x16x32_bf16 v[156:159], v[220:223], v[120:123], v[156:159]
ds_read_b128 v[220:223], v240 offset:29184
s_waitcnt lgkmcnt(3)
v_mfma_f32_16x16x32_bf16 v[176:179], v[208:211], v[24:27], v[176:179]
v_mfma_f32_16x16x32_bf16 v[180:183], v[208:211], v[56:59], v[180:183]
v_mfma_f32_16x16x32_bf16 v[184:187], v[208:211], v[88:91], v[184:187]
v_mfma_f32_16x16x32_bf16 v[188:191], v[208:211], v[120:123], v[188:191]
s_waitcnt lgkmcnt(2)
s_waitcnt vmcnt(6)
v_mfma_f32_16x16x32_bf16 v[128:131], v[212:215], v[28:31], v[128:131]
v_mfma_f32_16x16x32_bf16 v[132:135], v[212:215], v[60:63], v[132:135]
v_mfma_f32_16x16x32_bf16 v[136:139], v[212:215], v[92:95], v[136:139]
v_mfma_f32_16x16x32_bf16 v[140:143], v[212:215], v[124:127], v[140:143]
s_waitcnt lgkmcnt(1)
v_mfma_f32_16x16x32_bf16 v[144:147], v[216:219], v[28:31], v[144:147]
v_mfma_f32_16x16x32_bf16 v[148:151], v[216:219], v[60:63], v[148:151]
v_mfma_f32_16x16x32_bf16 v[152:155], v[216:219], v[92:95], v[152:155]
v_mfma_f32_16x16x32_bf16 v[156:159], v[216:219], v[124:127], v[156:159]
s_waitcnt lgkmcnt(0)
v_mfma_f32_16x16x32_bf16 v[176:179], v[220:223], v[28:31], v[176:179]
v_mfma_f32_16x16x32_bf16 v[180:183], v[220:223], v[60:63], v[180:183]
v_mfma_f32_16x16x32_bf16 v[184:187], v[220:223], v[92:95], v[184:187]
v_mfma_f32_16x16x32_bf16 v[188:191], v[220:223], v[124:127], v[188:191]
v_max3_f32 v248, v128, v129, v130
v_max3_f32 v249, v132, v133, v134
v_max3_f32 v250, v136, v137, v138
v_max3_f32 v251, v140, v141, v142
v_max3_f32 v248, v248, v131, v144
v_max3_f32 v249, v249, v135, v148
v_max3_f32 v250, v250, v139, v152
v_max3_f32 v251, v251, v143, v156
v_max3_f32 v248, v248, v145, v146
v_max3_f32 v249, v249, v149, v150
v_max3_f32 v250, v250, v153, v154
v_max3_f32 v251, v251, v157, v158
v_max_f32 v248, v248, v147
v_max_f32 v249, v249, v151
v_max_f32 v250, v250, v155
v_max_f32 v251, v251, v159
v_mov_b32 v232, v248
v_mov_b32 v233, v249
v_mov_b32 v234, v250
v_mov_b32 v235, v251
v_permlane32_swap_b32 v248, v232
v_permlane32_swap_b32 v249, v233
v_permlane32_swap_b32 v250, v234
v_permlane32_swap_b32 v251, v235
v_max_f32 v248, v248, v232
v_max_f32 v249, v249, v233
v_max_f32 v250, v250, v234
v_max_f32 v251, v251, v235
v_mov_b32 v232, v248
v_mov_b32 v233, v249
v_mov_b32 v234, v250
v_mov_b32 v235, v251
v_permlane16_swap_b32 v248, v232
v_permlane16_swap_b32 v249, v233
v_permlane16_swap_b32 v250, v234
v_permlane16_swap_b32 v251, v235
v_max_f32 v248, v248, v232
v_max_f32 v249, v249, v233
v_max_f32 v250, v250, v234
v_max_f32 v251, v251, v235
v_ceil_f32 v248, v248
v_ceil_f32 v249, v249
v_ceil_f32 v250, v250
v_ceil_f32 v251, v251
v_sub_f32 v128, v128, v248
v_sub_f32 v129, v129, v248
v_sub_f32 v130, v130, v248
v_sub_f32 v131, v131, v248
v_exp_f32 v128, v128
v_exp_f32 v129, v129
v_exp_f32 v130, v130
v_exp_f32 v131, v131
v_sub_f32 v192, 0, v248
v_sub_f32 v193, 0, v248
v_sub_f32 v194, 0, v248
v_sub_f32 v195, 0, v248
v_sub_f32 v132, v132, v249
v_sub_f32 v133, v133, v249
v_sub_f32 v134, v134, v249
v_sub_f32 v135, v135, v249
v_exp_f32 v132, v132
v_exp_f32 v133, v133
v_exp_f32 v134, v134
v_exp_f32 v135, v135
v_sub_f32 v196, 0, v249
v_sub_f32 v197, 0, v249
v_sub_f32 v198, 0, v249
v_sub_f32 v199, 0, v249
v_sub_f32 v136, v136, v250
v_sub_f32 v137, v137, v250
v_sub_f32 v138, v138, v250
v_sub_f32 v139, v139, v250
v_exp_f32 v136, v136
v_exp_f32 v137, v137
v_exp_f32 v138, v138
v_exp_f32 v139, v139
v_sub_f32 v200, 0, v250
v_sub_f32 v201, 0, v250
v_sub_f32 v202, 0, v250
v_sub_f32 v203, 0, v250
v_sub_f32 v140, v140, v251
v_sub_f32 v141, v141, v251
v_sub_f32 v142, v142, v251
v_sub_f32 v143, v143, v251
v_exp_f32 v140, v140
v_exp_f32 v141, v141
v_exp_f32 v142, v142
v_exp_f32 v143, v143
v_sub_f32 v204, 0, v251
v_sub_f32 v205, 0, v251
v_sub_f32 v206, 0, v251
v_sub_f32 v207, 0, v251
s_waitcnt vmcnt(4)
s_barrier
ds_read_b128 v[208:211], v240 offset:18432
ds_read_b128 v[212:215], v240 offset:18944
ds_read_b128 v[216:219], v240 offset:22528
ds_read_b128 v[220:223], v240 offset:23040
v_add_f32 v144, v144, v192
v_add_f32 v145, v145, v192
v_add_f32 v146, v146, v192
v_add_f32 v147, v147, v192
v_exp_f32 v144, v144
v_exp_f32 v145, v145
v_exp_f32 v146, v146
v_exp_f32 v147, v147
v_add_f32 v148, v148, v196
v_add_f32 v149, v149, v196
v_add_f32 v150, v150, v196
v_add_f32 v151, v151, v196
v_exp_f32 v148, v148
v_exp_f32 v149, v149
v_exp_f32 v150, v150
v_exp_f32 v151, v151
v_add_f32 v152, v152, v200
v_add_f32 v153, v153, v200
v_add_f32 v154, v154, v200
v_add_f32 v155, v155, v200
v_exp_f32 v152, v152
v_exp_f32 v153, v153
v_exp_f32 v154, v154
v_exp_f32 v155, v155
v_add_f32 v156, v156, v204
v_add_f32 v157, v157, v204
v_add_f32 v158, v158, v204
v_add_f32 v159, v159, v204
v_exp_f32 v156, v156
v_exp_f32 v157, v157
v_exp_f32 v158, v158
v_exp_f32 v159, v159
v_cvt_pk_bf16_f32 v160, v128, v129
v_cvt_pk_bf16_f32 v161, v130, v131
v_cvt_pk_bf16_f32 v164, v132, v133
v_cvt_pk_bf16_f32 v165, v134, v135
v_cvt_pk_bf16_f32 v168, v136, v137
v_cvt_pk_bf16_f32 v169, v138, v139
v_cvt_pk_bf16_f32 v172, v140, v141
v_cvt_pk_bf16_f32 v173, v142, v143
v_cvt_pk_bf16_f32 v162, v144, v145
v_cvt_pk_bf16_f32 v163, v146, v147
v_cvt_pk_bf16_f32 v166, v148, v149
v_cvt_pk_bf16_f32 v167, v150, v151
v_cvt_pk_bf16_f32 v170, v152, v153
v_cvt_pk_bf16_f32 v171, v154, v155
v_cvt_pk_bf16_f32 v174, v156, v157
v_cvt_pk_bf16_f32 v175, v158, v159
v_add_f32 v224, v128, v129
v_add_f32 v225, v132, v133
v_add_f32 v226, v136, v137
v_add_f32 v227, v140, v141
v_add_f32 v224, v224, v130
v_add_f32 v225, v225, v134
v_add_f32 v226, v226, v138
v_add_f32 v227, v227, v142
v_add_f32 v224, v224, v131
v_add_f32 v225, v225, v135
v_add_f32 v226, v226, v139
v_add_f32 v227, v227, v143
v_add_f32 v224, v224, v144
v_add_f32 v225, v225, v148
v_add_f32 v226, v226, v152
v_add_f32 v227, v227, v156
v_add_f32 v224, v224, v145
v_add_f32 v225, v225, v149
v_add_f32 v226, v226, v153
v_add_f32 v227, v227, v157
v_add_f32 v224, v224, v146
v_add_f32 v225, v225, v150
v_add_f32 v226, v226, v154
v_add_f32 v227, v227, v158
v_add_f32 v224, v224, v147
v_add_f32 v225, v225, v151
v_add_f32 v226, v226, v155
v_add_f32 v227, v227, v159
v_add_f32 v128, v176, v192
v_add_f32 v129, v177, v192
v_add_f32 v130, v178, v192
v_add_f32 v131, v179, v192
v_add_f32 v132, v180, v196
v_add_f32 v133, v181, v196
v_add_f32 v134, v182, v196
v_add_f32 v135, v183, v196
v_add_f32 v136, v184, v200
v_add_f32 v137, v185, v200
v_add_f32 v138, v186, v200
v_add_f32 v139, v187, v200
v_add_f32 v140, v188, v204
v_add_f32 v141, v189, v204
v_add_f32 v142, v190, v204
v_add_f32 v143, v191, v204
v_cmp_ne_u64 vcc, s[98:99], v[228:229]
s_nop 1
s_cbranch_vccnz LM_pb
LM_pb_ret:
s_nop 1
s_waitcnt lgkmcnt(2)
v_mfma_f32_16x16x32_bf16 v[144:147], v[208:211], v[0:3], v[192:195]
v_mfma_f32_16x16x32_bf16 v[144:147], v[212:215], v[4:7], v[144:147]
v_mfma_f32_16x16x32_bf16 v[148:151], v[208:211], v[32:35], v[196:199]
v_mfma_f32_16x16x32_bf16 v[148:151], v[212:215], v[36:39], v[148:151]
v_mfma_f32_16x16x32_bf16 v[152:155], v[208:211], v[64:67], v[200:203]
v_exp_f32 v128, v128
v_mfma_f32_16x16x32_bf16 v[152:155], v[212:215], v[68:71], v[152:155]
v_exp_f32 v129, v129
v_mfma_f32_16x16x32_bf16 v[156:159], v[208:211], v[96:99], v[204:207]
ds_read_b128 v[208:211], v240 offset:26624
v_exp_f32 v130, v130
v_mfma_f32_16x16x32_bf16 v[156:159], v[212:215], v[100:103], v[156:159]
ds_read_b128 v[212:215], v240 offset:27136
s_waitcnt lgkmcnt(2)
v_add_f32 v224, v224, v128
v_mfma_f32_16x16x32_bf16 v[144:147], v[216:219], v[8:11], v[144:147]
v_exp_f32 v131, v131
v_add_f32 v224, v224, v129
v_mfma_f32_16x16x32_bf16 v[144:147], v[220:223], v[12:15], v[144:147]
v_add_f32 v224, v224, v130
v_add_f32 v224, v224, v131
v_mfma_f32_16x16x32_bf16 v[148:151], v[216:219], v[40:43], v[148:151]
v_exp_f32 v132, v132
v_mfma_f32_16x16x32_bf16 v[148:151], v[220:223], v[44:47], v[148:151]
v_exp_f32 v133, v133
v_mfma_f32_16x16x32_bf16 v[152:155], v[216:219], v[72:75], v[152:155]
v_exp_f32 v134, v134
v_add_f32 v225, v225, v132
v_mfma_f32_16x16x32_bf16 v[152:155], v[220:223], v[76:79], v[152:155]
v_exp_f32 v135, v135
v_add_f32 v225, v225, v133
v_mfma_f32_16x16x32_bf16 v[156:159], v[216:219], v[104:107], v[156:159]
ds_read_b128 v[216:219], v240 offset:30720
v_add_f32 v225, v225, v134
v_add_f32 v225, v225, v135
v_mfma_f32_16x16x32_bf16 v[156:159], v[220:223], v[108:111], v[156:159]
ds_read_b128 v[220:223], v240 offset:31232
s_waitcnt lgkmcnt(2)
v_mfma_f32_16x16x32_bf16 v[144:147], v[208:211], v[16:19], v[144:147]
v_exp_f32 v136, v136
v_mfma_f32_16x16x32_bf16 v[144:147], v[212:215], v[20:23], v[144:147]
v_add_u32 v240, 0x8000, v240
v_exp_f32 v137, v137
v_mfma_f32_16x16x32_bf16 v[148:151], v[208:211], v[48:51], v[148:151]
v_and_b32 v240, 0x1ffff, v240
v_exp_f32 v138, v138
v_mfma_f32_16x16x32_bf16 v[148:151], v[212:215], v[52:55], v[148:151]
v_add_f32 v226, v226, v136
v_exp_f32 v139, v139
v_mfma_f32_16x16x32_bf16 v[152:155], v[208:211], v[80:83], v[152:155]
v_add_f32 v226, v226, v137
v_add_f32 v226, v226, v138
v_add_f32 v226, v226, v139
v_mfma_f32_16x16x32_bf16 v[152:155], v[212:215], v[84:87], v[152:155]
v_exp_f32 v140, v140
v_mfma_f32_16x16x32_bf16 v[156:159], v[208:211], v[112:115], v[156:159]
ds_read_b64_tr_b16 v[208:209], v246 offset:0
ds_read_b64_tr_b16 v[210:211], v246 offset:2048
v_mfma_f32_16x16x32_bf16 v[156:159], v[212:215], v[116:119], v[156:159]
ds_read_b64_tr_b16 v[212:213], v247 offset:0
s_waitcnt lgkmcnt(3)
v_mfma_f32_16x16x32_bf16 v[144:147], v[216:219], v[24:27], v[144:147]
ds_read_b64_tr_b16 v[214:215], v247 offset:2048
v_exp_f32 v141, v141
v_mfma_f32_16x16x32_bf16 v[144:147], v[220:223], v[28:31], v[144:147]
v_exp_f32 v142, v142
v_add_f32 v227, v227, v140
v_mfma_f32_16x16x32_bf16 v[148:151], v[216:219], v[56:59], v[148:151]
v_exp_f32 v143, v143
v_add_f32 v227, v227, v141
v_mfma_f32_16x16x32_bf16 v[148:151], v[220:223], v[60:63], v[148:151]
v_add_f32 v227, v227, v142
v_add_f32 v227, v227, v143
v_max3_f32 v242, v224, v225, v226
v_mfma_f32_16x16x32_bf16 v[152:155], v[216:219], v[88:91], v[152:155]
v_max_f32 v242, v242, v227
v_mfma_f32_16x16x32_bf16 v[152:155], v[220:223], v[92:95], v[152:155]
v_cmp_lt_f32 vcc, s32, v242
v_mfma_f32_16x16x32_bf16 v[156:159], v[216:219], v[120:123], v[156:159]
ds_read_b64_tr_b16 v[216:217], v246 offset:512
ds_read_b64_tr_b16 v[218:219], v246 offset:2560
v_mfma_f32_16x16x32_bf16 v[156:159], v[220:223], v[124:127], v[156:159]
ds_read_b64_tr_b16 v[220:221], v247 offset:512
s_waitcnt lgkmcnt(5)
v_mfma_f32_16x16x32_bf16 a[0:3], v[160:163], v[208:211], a[0:3]
ds_read_b64_tr_b16 v[222:223], v247 offset:2560
s_cbranch_vccnz L2_rare_site4
L2_ret4:
v_mfma_f32_16x16x32_bf16 a[4:7], v[164:167], v[208:211], a[4:7]
s_mov_b32 m0, s30
v_mfma_f32_16x16x32_bf16 a[8:11], v[168:171], v[208:211], a[8:11]
buffer_load_dwordx4 v241, s[12:15], s28 offen offset:0 sc1 lds
v_mfma_f32_16x16x32_bf16 a[12:15], v[172:175], v[208:211], a[12:15]
ds_read_b64_tr_b16 v[208:209], v246 offset:4096
s_waitcnt lgkmcnt(5)
v_mfma_f32_16x16x32_bf16 a[16:19], v[160:163], v[212:215], a[16:19]
ds_read_b64_tr_b16 v[210:211], v246 offset:6144
buffer_load_dwordx4 v241, s[12:15], s28 offen offset:1024 sc1 lds
v_mfma_f32_16x16x32_bf16 a[20:23], v[164:167], v[212:215], a[20:23]
v_mfma_f32_16x16x32_bf16 a[24:27], v[168:171], v[212:215], a[24:27]
buffer_load_dwordx4 v241, s[12:15], s28 offen offset:2048 sc1 lds
v_mfma_f32_16x16x32_bf16 a[28:31], v[172:175], v[212:215], a[28:31]
ds_read_b64_tr_b16 v[212:213], v247 offset:4096
s_waitcnt lgkmcnt(5)
v_mfma_f32_16x16x32_bf16 a[32:35], v[160:163], v[216:219], a[32:35]
ds_read_b64_tr_b16 v[214:215], v247 offset:6144
v_exp_f32 v144, v144
v_mfma_f32_16x16x32_bf16 a[36:39], v[164:167], v[216:219], a[36:39]
buffer_load_dwordx4 v241, s[12:15], s28 offen offset:3072 sc1 lds
v_exp_f32 v145, v145
v_mfma_f32_16x16x32_bf16 a[40:43], v[168:171], v[216:219], a[40:43]
v_exp_f32 v146, v146
v_add_f32 v224, v224, v144
v_mfma_f32_16x16x32_bf16 a[44:47], v[172:175], v[216:219], a[44:47]
ds_read_b64_tr_b16 v[216:217], v246 offset:4608
s_waitcnt lgkmcnt(5)
v_mfma_f32_16x16x32_bf16 a[48:51], v[160:163], v[220:223], a[48:51]
ds_read_b64_tr_b16 v[218:219], v246 offset:6656
v_exp_f32 v147, v147
v_mfma_f32_16x16x32_bf16 a[52:55], v[164:167], v[220:223], a[52:55]
v_add_f32 v224, v224, v145
v_add_f32 v224, v224, v146
v_add_f32 v224, v224, v147
v_mfma_f32_16x16x32_bf16 a[56:59], v[168:171], v[220:223], a[56:59]
v_exp_f32 v148, v148
v_mfma_f32_16x16x32_bf16 a[60:63], v[172:175], v[220:223], a[60:63]
ds_read_b64_tr_b16 v[220:221], v247 offset:4608
s_waitcnt lgkmcnt(5)
v_mfma_f32_16x16x32_bf16 a[64:67], v[160:163], v[208:211], a[64:67]
ds_read_b64_tr_b16 v[222:223], v247 offset:6656
v_exp_f32 v149, v149
v_mfma_f32_16x16x32_bf16 a[68:71], v[164:167], v[208:211], a[68:71]
s_waitcnt vmcnt(4)
s_barrier
v_mfma_f32_16x16x32_bf16 a[72:75], v[168:171], v[208:211], a[72:75]
v_exp_f32 v150, v150
v_add_f32 v225, v225, v148
v_mfma_f32_16x16x32_bf16 a[76:79], v[172:175], v[208:211], a[76:79]
ds_read_b128 v[208:211], v240 offset:0
s_waitcnt lgkmcnt(5)
v_mfma_f32_16x16x32_bf16 a[80:83], v[160:163], v[212:215], a[80:83]
v_exp_f32 v151, v151
v_add_f32 v225, v225, v149
v_mfma_f32_16x16x32_bf16 a[84:87], v[164:167], v[212:215], a[84:87]
v_add_f32 v225, v225, v150
v_add_f32 v225, v225, v151
v_mfma_f32_16x16x32_bf16 a[88:91], v[168:171], v[212:215], a[88:91]
v_exp_f32 v152, v152
v_mfma_f32_16x16x32_bf16 a[92:95], v[172:175], v[212:215], a[92:95]
ds_read_b128 v[212:215], v240 offset:512
s_waitcnt lgkmcnt(4)
v_mfma_f32_16x16x32_bf16 a[96:99], v[160:163], v[216:219], a[96:99]
v_exp_f32 v153, v153
v_mfma_f32_16x16x32_bf16 a[100:103], v[164:167], v[216:219], a[100:103]
v_cvt_pk_bf16_f32 v176, v128, v129
v_cvt_pk_bf16_f32 v177, v130, v131
v_mfma_f32_16x16x32_bf16 a[104:107], v[168:171], v[216:219], a[104:107]
v_exp_f32 v154, v154
v_add_f32 v226, v226, v152
v_mfma_f32_16x16x32_bf16 a[108:111], v[172:175], v[216:219], a[108:111]
ds_read_b128 v[216:219], v240 offset:4096
s_waitcnt lgkmcnt(3)
v_cvt_pk_bf16_f32 v180, v132, v133
v_cvt_pk_bf16_f32 v181, v134, v135
v_mfma_f32_16x16x32_bf16 a[112:115], v[160:163], v[220:223], a[112:115]
v_exp_f32 v155, v155
v_add_f32 v226, v226, v153
v_mfma_f32_16x16x32_bf16 a[116:119], v[164:167], v[220:223], a[116:119]
v_cvt_pk_bf16_f32 v184, v136, v137
v_cvt_pk_bf16_f32 v185, v138, v139
v_add_f32 v226, v226, v154
v_mfma_f32_16x16x32_bf16 a[120:123], v[168:171], v[220:223], a[120:123]
v_add_f32 v226, v226, v155
v_exp_f32 v156, v156
v_mfma_f32_16x16x32_bf16 a[124:127], v[172:175], v[220:223], a[124:127]
ds_read_b128 v[220:223], v240 offset:4608
s_waitcnt lgkmcnt(2)
v_mfma_f32_16x16x32_bf16 v[128:131], v[208:211], v[0:3], v[192:195]
v_exp_f32 v157, v157
v_mfma_f32_16x16x32_bf16 v[128:131], v[212:215], v[4:7], v[128:131]
v_cvt_pk_bf16_f32 v188, v140, v141
v_cvt_pk_bf16_f32 v189, v142, v143
v_mfma_f32_16x16x32_bf16 v[132:135], v[208:211], v[32:35], v[196:199]
v_exp_f32 v158, v158
v_add_f32 v227, v227, v156
v_mfma_f32_16x16x32_bf16 v[132:135], v[212:215], v[36:39], v[132:135]
v_exp_f32 v159, v159
v_add_f32 v227, v227, v157
v_mfma_f32_16x16x32_bf16 v[136:139], v[208:211], v[64:67], v[200:203]
v_add_f32 v227, v227, v158
v_add_f32 v227, v227, v159
v_max3_f32 v242, v224, v225, v226
v_mfma_f32_16x16x32_bf16 v[136:139], v[212:215], v[68:71], v[136:139]
v_max_f32 v242, v242, v227
v_mfma_f32_16x16x32_bf16 v[140:143], v[208:211], v[96:99], v[204:207]
ds_read_b128 v[208:211], v240 offset:8192
v_cmp_lt_f32 vcc, s32, v242
v_mfma_f32_16x16x32_bf16 v[140:143], v[212:215], v[100:103], v[140:143]
ds_read_b128 v[212:215], v240 offset:8704
s_waitcnt lgkmcnt(2)
v_mfma_f32_16x16x32_bf16 v[128:131], v[216:219], v[8:11], v[128:131]
v_mfma_f32_16x16x32_bf16 v[128:131], v[220:223], v[12:15], v[128:131]
s_cbranch_vccnz L2_rare_site5
L2_ret5:
v_cvt_pk_bf16_f32 v178, v144, v145
v_cvt_pk_bf16_f32 v179, v146, v147
v_mfma_f32_16x16x32_bf16 v[132:135], v[216:219], v[40:43], v[132:135]
v_cvt_pk_bf16_f32 v182, v148, v149
v_cvt_pk_bf16_f32 v183, v150, v151
v_cvt_pk_bf16_f32 v186, v152, v153
v_mfma_f32_16x16x32_bf16 v[132:135], v[220:223], v[44:47], v[132:135]
v_cvt_pk_bf16_f32 v187, v154, v155
v_cvt_pk_bf16_f32 v190, v156, v157
v_cvt_pk_bf16_f32 v191, v158, v159
v_mfma_f32_16x16x32_bf16 v[136:139], v[216:219], v[72:75], v[136:139]
v_mfma_f32_16x16x32_bf16 v[136:139], v[220:223], v[76:79], v[136:139]
v_mfma_f32_16x16x32_bf16 v[140:143], v[216:219], v[104:107], v[140:143]
ds_read_b128 v[216:219], v240 offset:12288
v_mfma_f32_16x16x32_bf16 v[140:143], v[220:223], v[108:111], v[140:143]
ds_read_b128 v[220:223], v240 offset:12800
s_waitcnt lgkmcnt(2)
v_mfma_f32_16x16x32_bf16 v[128:131], v[208:211], v[16:19], v[128:131]
v_mfma_f32_16x16x32_bf16 v[128:131], v[212:215], v[20:23], v[128:131]
v_mfma_f32_16x16x32_bf16 v[132:135], v[208:211], v[48:51], v[132:135]
v_mfma_f32_16x16x32_bf16 v[132:135], v[212:215], v[52:55], v[132:135]
v_mfma_f32_16x16x32_bf16 v[136:139], v[208:211], v[80:83], v[136:139]
v_mfma_f32_16x16x32_bf16 v[136:139], v[212:215], v[84:87], v[136:139]
s_sub_u32 s31, s31, 1
v_mfma_f32_16x16x32_bf16 v[140:143], v[208:211], v[112:115], v[140:143]
ds_read_b128 v[208:211], v240 offset:2048
v_mfma_f32_16x16x32_bf16 v[140:143], v[212:215], v[116:119], v[140:143]
ds_read_b128 v[212:215], v240 offset:2560
s_waitcnt lgkmcnt(2)
v_mfma_f32_16x16x32_bf16 v[128:131], v[216:219], v[24:27], v[128:131]
s_add_u32 s28, s28, s101
s_add_u32 s30, s30, 0x4000
v_mfma_f32_16x16x32_bf16 v[128:131], v[220:223], v[28:31], v[128:131]
s_and_b32 s30, s30, 0x1ffff
v_mfma_f32_16x16x32_bf16 v[132:135], v[216:219], v[56:59], v[132:135]
v_mfma_f32_16x16x32_bf16 v[132:135], v[220:223], v[60:63], v[132:135]
v_mfma_f32_16x16x32_bf16 v[136:139], v[216:219], v[88:91], v[136:139]
v_mfma_f32_16x16x32_bf16 v[136:139], v[220:223], v[92:95], v[136:139]
v_mfma_f32_16x16x32_bf16 v[140:143], v[216:219], v[120:123], v[140:143]
ds_read_b128 v[216:219], v240 offset:6144
v_mfma_f32_16x16x32_bf16 v[140:143], v[220:223], v[124:127], v[140:143]
ds_read_b128 v[220:223], v240 offset:6656
s_branch L2_loop1
.p2align 6
L2_loop:
s_waitcnt lgkmcnt(2)
v_mfma_f32_16x16x32_bf16 v[144:147], v[208:211], v[0:3], v[192:195]
v_mfma_f32_16x16x32_bf16 v[144:147], v[212:215], v[4:7], v[144:147]
v_mfma_f32_16x16x32_bf16 v[148:151], v[208:211], v[32:35], v[196:199]
v_mfma_f32_16x16x32_bf16 v[148:151], v[212:215], v[36:39], v[148:151]
v_mfma_f32_16x16x32_bf16 v[152:155], v[208:211], v[64:67], v[200:203]
v_exp_f32 v128, v128
v_mfma_f32_16x16x32_bf16 v[152:155], v[212:215], v[68:71], v[152:155]
v_exp_f32 v129, v129
v_mfma_f32_16x16x32_bf16 v[156:159], v[208:211], v[96:99], v[204:207]
ds_read_b128 v[208:211], v240 offset:26624
v_mfma_f32_16x16x32_bf16 v[156:159], v[212:215], v[100:103], v[156:159]
ds_read_b128 v[212:215], v240 offset:27136
s_waitcnt lgkmcnt(2)
v_mfma_f32_16x16x32_bf16 v[144:147], v[216:219], v[8:11], v[144:147]
v_exp_f32 v130, v130
v_mfma_f32_16x16x32_bf16 v[144:147], v[220:223], v[12:15], v[144:147]
v_add_f32 v224, v224, v128
v_mfma_f32_16x16x32_bf16 v[148:151], v[216:219], v[40:43], v[148:151]
v_exp_f32 v131, v131
v_mfma_f32_16x16x32_bf16 v[148:151], v[220:223], v[44:47], v[148:151]
v_add_f32 v224, v224, v129
v_add_f32 v224, v224, v130
v_mfma_f32_16x16x32_bf16 v[152:155], v[216:219], v[72:75], v[152:155]
v_add_f32 v224, v224, v131
v_mfma_f32_16x16x32_bf16 v[152:155], v[220:223], v[76:79], v[152:155]
v_exp_f32 v132, v132
v_mfma_f32_16x16x32_bf16 v[156:159], v[216:219], v[104:107], v[156:159]
ds_read_b128 v[216:219], v240 offset:30720
v_mfma_f32_16x16x32_bf16 v[156:159], v[220:223], v[108:111], v[156:159]
ds_read_b128 v[220:223], v240 offset:31232
s_waitcnt lgkmcnt(2)
v_mfma_f32_16x16x32_bf16 v[144:147], v[208:211], v[16:19], v[144:147]
v_exp_f32 v133, v133
v_mfma_f32_16x16x32_bf16 v[144:147], v[212:215], v[20:23], v[144:147]
v_add_u32 v240, 0x8000, v240
v_mfma_f32_16x16x32_bf16 v[148:151], v[208:211], v[48:51], v[148:151]
v_and_b32 v240, 0x1ffff, v240
v_mfma_f32_16x16x32_bf16 v[148:151], v[212:215], v[52:55], v[148:151]
v_exp_f32 v134, v134
v_mfma_f32_16x16x32_bf16 v[152:155], v[208:211], v[80:83], v[152:155]
v_add_f32 v225, v225, v132
v_mfma_f32_16x16x32_bf16 v[152:155], v[212:215], v[84:87], v[152:155]
v_exp_f32 v135, v135
v_mfma_f32_16x16x32_bf16 v[156:159], v[208:211], v[112:115], v[156:159]
ds_read_b64_tr_b16 v[208:209], v244 offset:16384
ds_read_b64_tr_b16 v[210:211], v244 offset:18432
v_mfma_f32_16x16x32_bf16 v[156:159], v[212:215], v[116:119], v[156:159]
ds_read_b64_tr_b16 v[212:213], v246 offset:0
s_waitcnt lgkmcnt(3)
v_mfma_f32_16x16x32_bf16 v[144:147], v[216:219], v[24:27], v[144:147]
ds_read_b64_tr_b16 v[214:215], v246 offset:2048
v_add_f32 v225, v225, v133
v_mfma_f32_16x16x32_bf16 v[144:147], v[220:223], v[28:31], v[144:147]
v_add_f32 v225, v225, v134
v_add_f32 v225, v225, v135
v_mfma_f32_16x16x32_bf16 v[148:151], v[216:219], v[56:59], v[148:151]
v_exp_f32 v136, v136
v_mfma_f32_16x16x32_bf16 v[148:151], v[220:223], v[60:63], v[148:151]
v_exp_f32 v137, v137
v_mfma_f32_16x16x32_bf16 v[152:155], v[216:219], v[88:91], v[152:155]
v_exp_f32 v138, v138
v_mfma_f32_16x16x32_bf16 v[152:155], v[220:223], v[92:95], v[152:155]
v_add_f32 v226, v226, v136
v_mfma_f32_16x16x32_bf16 v[156:159], v[216:219], v[120:123], v[156:159]
ds_read_b64_tr_b16 v[216:217], v245 offset:16384
ds_read_b64_tr_b16 v[218:219], v245 offset:18432
v_mfma_f32_16x16x32_bf16 v[156:159], v[220:223], v[124:127], v[156:159]
ds_read_b64_tr_b16 v[220:221], v247 offset:0
s_waitcnt lgkmcnt(3)
v_mfma_f32_16x16x32_bf16 a[0:3], v[176:179], v[208:211], a[0:3]
ds_read_b64_tr_b16 v[222:223], v247 offset:2048
v_mfma_f32_16x16x32_bf16 a[0:3], v[160:163], v[212:215], a[0:3]
v_exp_f32 v139, v139
v_mfma_f32_16x16x32_bf16 a[4:7], v[180:183], v[208:211], a[4:7]
v_add_f32 v226, v226, v137
v_add_f32 v226, v226, v138
v_mfma_f32_16x16x32_bf16 a[4:7], v[164:167], v[212:215], a[4:7]
v_add_f32 v226, v226, v139
v_mfma_f32_16x16x32_bf16 a[8:11], v[184:187], v[208:211], a[8:11]
v_exp_f32 v140, v140
v_mfma_f32_16x16x32_bf16 a[8:11], v[168:171], v[212:215], a[8:11]
v_exp_f32 v141, v141
v_mfma_f32_16x16x32_bf16 a[12:15], v[188:191], v[208:211], a[12:15]
ds_read_b64_tr_b16 v[208:209], v244 offset:16896
ds_read_b64_tr_b16 v[210:211], v244 offset:18944
v_mfma_f32_16x16x32_bf16 a[12:15], v[172:175], v[212:215], a[12:15]
ds_read_b64_tr_b16 v[212:213], v246 offset:512
s_waitcnt lgkmcnt(3)
v_mfma_f32_16x16x32_bf16 a[16:19], v[176:179], v[216:219], a[16:19]
ds_read_b64_tr_b16 v[214:215], v246 offset:2560
v_mfma_f32_16x16x32_bf16 a[16:19], v[160:163], v[220:223], a[16:19]
v_exp_f32 v142, v142
v_mfma_f32_16x16x32_bf16 a[20:23], v[180:183], v[216:219], a[20:23]
v_add_f32 v227, v227, v140
v_mfma_f32_16x16x32_bf16 a[20:23], v[164:167], v[220:223], a[20:23]
v_exp_f32 v143, v143
v_mfma_f32_16x16x32_bf16 a[24:27], v[184:187], v[216:219], a[24:27]
v_add_f32 v227, v227, v141
v_add_f32 v227, v227, v142
v_mfma_f32_16x16x32_bf16 a[24:27], v[168:171], v[220:223], a[24:27]
v_add_f32 v227, v227, v143
v_max3_f32 v242, v224, v225, v226
v_mfma_f32_16x16x32_bf16 a[28:31], v[188:191], v[216:219], a[28:31]
ds_read_b64_tr_b16 v[216:217], v245 offset:16896
ds_read_b64_tr_b16 v[218:219], v245 offset:18944
v_mfma_f32_16x16x32_bf16 a[28:31], v[172:175], v[220:223], a[28:31]
ds_read_b64_tr_b16 v[220:221], v247 offset:512
s_waitcnt lgkmcnt(3)
v_mfma_f32_16x16x32_bf16 a[32:35], v[176:179], v[208:211], a[32:35]
ds_read_b64_tr_b16 v[222:223], v247 offset:2560
v_max_f32 v242, v242, v227
v_mfma_f32_16x16x32_bf16 a[32:35], v[160:163], v[212:215], a[32:35]
v_cmp_lt_f32 vcc, s32, v242
v_mfma_f32_16x16x32_bf16 a[36:39], v[180:183], v[208:211], a[36:39]
v_mfma_f32_16x16x32_bf16 a[36:39], v[164:167], v[212:215], a[36:39]
v_mfma_f32_16x16x32_bf16 a[40:43], v[184:187], v[208:211], a[40:43]
s_mov_b32 m0, s30
s_cbranch_vccnz L2_rare_site0
L2_ret0:
v_mfma_f32_16x16x32_bf16 a[40:43], v[168:171], v[212:215], a[40:43]
buffer_load_dwordx4 v241, s[12:15], s28 offen offset:0 sc1 lds
v_mfma_f32_16x16x32_bf16 a[44:47], v[188:191], v[208:211], a[44:47]
ds_read_b64_tr_b16 v[208:209], v244 offset:20480
ds_read_b64_tr_b16 v[210:211], v244 offset:22528
v_mfma_f32_16x16x32_bf16 a[44:47], v[172:175], v[212:215], a[44:47]
ds_read_b64_tr_b16 v[212:213], v246 offset:4096
s_waitcnt lgkmcnt(3)
v_mfma_f32_16x16x32_bf16 a[48:51], v[176:179], v[216:219], a[48:51]
ds_read_b64_tr_b16 v[214:215], v246 offset:6144
v_mfma_f32_16x16x32_bf16 a[48:51], v[160:163], v[220:223], a[48:51]
buffer_load_dwordx4 v241, s[12:15], s28 offen offset:1024 sc1 lds
v_mfma_f32_16x16x32_bf16 a[52:55], v[180:183], v[216:219], a[52:55]
v_exp_f32 v144, v144
v_mfma_f32_16x16x32_bf16 a[52:55], v[164:167], v[220:223], a[52:55]
v_exp_f32 v145, v145
v_mfma_f32_16x16x32_bf16 a[56:59], v[184:187], v[216:219], a[56:59]
v_exp_f32 v146, v146
v_mfma_f32_16x16x32_bf16 a[56:59], v[168:171], v[220:223], a[56:59]
buffer_load_dwordx4 v241, s[12:15], s28 offen offset:2048 sc1 lds
v_add_f32 v224, v224, v144
v_mfma_f32_16x16x32_bf16 a[60:63], v[188:191], v[216:219], a[60:63]
ds_read_b64_tr_b16 v[216:217], v245 offset:20480
ds_read_b64_tr_b16 v[218:219], v245 offset:22528
v_mfma_f32_16x16x32_bf16 a[60:63], v[172:175], v[220:223], a[60:63]
ds_read_b64_tr_b16 v[220:221], v247 offset:4096
s_waitcnt lgkmcnt(3)
v_mfma_f32_16x16x32_bf16 a[64:67], v[176:179], v[208:211], a[64:67]
ds_read_b64_tr_b16 v[222:223], v247 offset:6144
v_mfma_f32_16x16x32_bf16 a[64:67], v[160:163], v[212:215], a[64:67]
buffer_load_dwordx4 v241, s[12:15], s28 offen offset:3072 sc1 lds
v_mfma_f32_16x16x32_bf16 a[68:71], v[180:183], v[208:211], a[68:71]
v_exp_f32 v147, v147
v_mfma_f32_16x16x32_bf16 a[68:71], v[164:167], v[212:215], a[68:71]
v_add_f32 v224, v224, v145
v_add_f32 v224, v224, v146
v_mfma_f32_16x16x32_bf16 a[72:75], v[184:187], v[208:211], a[72:75]
v_add_f32 v224, v224, v147
v_mfma_f32_16x16x32_bf16 a[72:75], v[168:171], v[212:215], a[72:75]
v_exp_f32 v148, v148
v_mfma_f32_16x16x32_bf16 a[76:79], v[188:191], v[208:211], a[76:79]
ds_read_b64_tr_b16 v[208:209], v244 offset:20992
ds_read_b64_tr_b16 v[210:211], v244 offset:23040
v_mfma_f32_16x16x32_bf16 a[76:79], v[172:175], v[212:215], a[76:79]
ds_read_b64_tr_b16 v[212:213], v246 offset:4608
s_waitcnt lgkmcnt(3)
v_mfma_f32_16x16x32_bf16 a[80:83], v[176:179], v[216:219], a[80:83]
ds_read_b64_tr_b16 v[214:215], v246 offset:6656
v_mfma_f32_16x16x32_bf16 a[80:83], v[160:163], v[220:223], a[80:83]
v_exp_f32 v149, v149
v_mfma_f32_16x16x32_bf16 a[84:87], v[180:183], v[216:219], a[84:87]
v_exp_f32 v150, v150
v_mfma_f32_16x16x32_bf16 a[84:87], v[164:167], v[220:223], a[84:87]
v_add_f32 v225, v225, v148
v_mfma_f32_16x16x32_bf16 a[88:91], v[184:187], v[216:219], a[88:91]
v_exp_f32 v151, v151
v_mfma_f32_16x16x32_bf16 a[88:91], v[168:171], v[220:223], a[88:91]
v_add_f32 v225, v225, v149
v_add_f32 v225, v225, v150
v_mfma_f32_16x16x32_bf16 a[92:95], v[188:191], v[216:219], a[92:95]
ds_read_b64_tr_b16 v[216:217], v245 offset:20992
ds_read_b64_tr_b16 v[218:219], v245 offset:23040
v_mfma_f32_16x16x32_bf16 a[92:95], v[172:175], v[220:223], a[92:95]
ds_read_b64_tr_b16 v[220:221], v247 offset:4608
s_waitcnt lgkmcnt(3)
v_mfma_f32_16x16x32_bf16 a[96:99], v[176:179], v[208:211], a[96:99]
ds_read_b64_tr_b16 v[222:223], v247 offset:6656
v_add_f32 v225, v225, v151
v_mfma_f32_16x16x32_bf16 a[96:99], v[160:163], v[212:215], a[96:99]
s_waitcnt vmcnt(4)
s_barrier
v_mfma_f32_16x16x32_bf16 a[100:103], v[180:183], v[208:211], a[100:103]
v_exp_f32 v152, v152
v_mfma_f32_16x16x32_bf16 a[100:103], v[164:167], v[212:215], a[100:103]
v_exp_f32 v153, v153
v_mfma_f32_16x16x32_bf16 a[104:107], v[184:187], v[208:211], a[104:107]
v_exp_f32 v154, v154
v_mfma_f32_16x16x32_bf16 a[104:107], v[168:171], v[212:215], a[104:107]
v_add_f32 v226, v226, v152
v_mfma_f32_16x16x32_bf16 a[108:111], v[188:191], v[208:211], a[108:111]
ds_read_b128 v[208:211], v240 offset:0
v_mfma_f32_16x16x32_bf16 a[108:111], v[172:175], v[212:215], a[108:111]
ds_read_b128 v[212:215], v240 offset:512
s_waitcnt lgkmcnt(2)
v_mfma_f32_16x16x32_bf16 a[112:115], v[176:179], v[216:219], a[112:115]
v_exp_f32 v155, v155
v_mfma_f32_16x16x32_bf16 a[112:115], v[160:163], v[220:223], a[112:115]
v_cvt_pk_bf16_f32 v176, v128, v129
v_cvt_pk_bf16_f32 v177, v130, v131
v_mfma_f32_16x16x32_bf16 a[116:119], v[180:183], v[216:219], a[116:119]
v_add_f32 v226, v226, v153
v_add_f32 v226, v226, v154
v_mfma_f32_16x16x32_bf16 a[116:119], v[164:167], v[220:223], a[116:119]
v_cvt_pk_bf16_f32 v180, v132, v133
v_cvt_pk_bf16_f32 v181, v134, v135
v_mfma_f32_16x16x32_bf16 a[120:123], v[184:187], v[216:219], a[120:123]
v_add_f32 v226, v226, v155
v_mfma_f32_16x16x32_bf16 a[120:123], v[168:171], v[220:223], a[120:123]
v_cvt_pk_bf16_f32 v184, v136, v137
v_cvt_pk_bf16_f32 v185, v138, v139
v_mfma_f32_16x16x32_bf16 a[124:127], v[188:191], v[216:219], a[124:127]
ds_read_b128 v[216:219], v240 offset:4096
v_mfma_f32_16x16x32_bf16 a[124:127], v[172:175], v[220:223], a[124:127]
ds_read_b128 v[220:223], v240 offset:4608
s_waitcnt lgkmcnt(2)
v_mfma_f32_16x16x32_bf16 v[128:131], v[208:211], v[0:3], v[192:195]
v_exp_f32 v156, v156
v_mfma_f32_16x16x32_bf16 v[128:131], v[212:215], v[4:7], v[128:131]
v_cvt_pk_bf16_f32 v188, v140, v141
v_cvt_pk_bf16_f32 v189, v142, v143
v_mfma_f32_16x16x32_bf16 v[132:135], v[208:211], v[32:35], v[196:199]
v_exp_f32 v157, v157
v_mfma_f32_16x16x32_bf16 v[132:135], v[212:215], v[36:39], v[132:135]
v_exp_f32 v158, v158
v_mfma_f32_16x16x32_bf16 v[136:139], v[208:211], v[64:67], v[200:203]
v_add_f32 v227, v227, v156
v_mfma_f32_16x16x32_bf16 v[136:139], v[212:215], v[68:71], v[136:139]
v_exp_f32 v159, v159
v_mfma_f32_16x16x32_bf16 v[140:143], v[208:211], v[96:99], v[204:207]
ds_read_b128 v[208:211], v240 offset:8192
v_add_f32 v227, v227, v157
v_mfma_f32_16x16x32_bf16 v[140:143], v[212:215], v[100:103], v[140:143]
ds_read_b128 v[212:215], v240 offset:8704
s_waitcnt lgkmcnt(2)
v_mfma_f32_16x16x32_bf16 v[128:131], v[216:219], v[8:11], v[128:131]
v_add_f32 v227, v227, v158
v_add_f32 v227, v227, v159
v_mfma_f32_16x16x32_bf16 v[128:131], v[220:223], v[12:15], v[128:131]
v_max3_f32 v242, v224, v225, v226
v_mfma_f32_16x16x32_bf16 v[132:135], v[216:219], v[40:43], v[132:135]
v_max_f32 v242, v242, v227
v_mfma_f32_16x16x32_bf16 v[132:135], v[220:223], v[44:47], v[132:135]
v_cmp_lt_f32 vcc, s32, v242
v_mfma_f32_16x16x32_bf16 v[136:139], v[216:219], v[72:75], v[136:139]
v_mfma_f32_16x16x32_bf16 v[136:139], v[220:223], v[76:79], v[136:139]
v_mfma_f32_16x16x32_bf16 v[140:143], v[216:219], v[104:107], v[140:143]
ds_read_b128 v[216:219], v240 offset:12288
s_cbranch_vccnz L2_rare_site1
L2_ret1:
v_mfma_f32_16x16x32_bf16 v[140:143], v[220:223], v[108:111], v[140:143]
ds_read_b128 v[220:223], v240 offset:12800
s_waitcnt lgkmcnt(2)
v_mfma_f32_16x16x32_bf16 v[128:131], v[208:211], v[16:19], v[128:131]
v_cvt_pk_bf16_f32 v178, v144, v145
v_cvt_pk_bf16_f32 v179, v146, v147
v_mfma_f32_16x16x32_bf16 v[128:131], v[212:215], v[20:23], v[128:131]
v_cvt_pk_bf16_f32 v182, v148, v149
v_cvt_pk_bf16_f32 v183, v150, v151
v_mfma_f32_16x16x32_bf16 v[132:135], v[208:211], v[48:51], v[132:135]
v_cvt_pk_bf16_f32 v186, v152, v153
v_cvt_pk_bf16_f32 v187, v154, v155
v_mfma_f32_16x16x32_bf16 v[132:135], v[212:215], v[52:55], v[132:135]
v_cvt_pk_bf16_f32 v190, v156, v157
v_cvt_pk_bf16_f32 v191, v158, v159
v_mfma_f32_16x16x32_bf16 v[136:139], v[208:211], v[80:83], v[136:139]
v_mfma_f32_16x16x32_bf16 v[136:139], v[212:215], v[84:87], v[136:139]
s_sub_u32 s31, s31, 1
v_mfma_f32_16x16x32_bf16 v[140:143], v[208:211], v[112:115], v[140:143]
ds_read_b128 v[208:211], v240 offset:2048
v_mfma_f32_16x16x32_bf16 v[140:143], v[212:215], v[116:119], v[140:143]
ds_read_b128 v[212:215], v240 offset:2560
s_waitcnt lgkmcnt(2)
v_mfma_f32_16x16x32_bf16 v[128:131], v[216:219], v[24:27], v[128:131]
s_add_u32 s28, s28, s101
s_add_u32 s30, s30, 0x4000
v_mfma_f32_16x16x32_bf16 v[128:131], v[220:223], v[28:31], v[128:131]
s_and_b32 s30, s30, 0x1ffff
v_mfma_f32_16x16x32_bf16 v[132:135], v[216:219], v[56:59], v[132:135]
s_cmp_eq_u32 s31, 0
v_mfma_f32_16x16x32_bf16 v[132:135], v[220:223], v[60:63], v[132:135]
v_mfma_f32_16x16x32_bf16 v[136:139], v[216:219], v[88:91], v[136:139]
v_mfma_f32_16x16x32_bf16 v[136:139], v[220:223], v[92:95], v[136:139]
v_mfma_f32_16x16x32_bf16 v[140:143], v[216:219], v[120:123], v[140:143]
ds_read_b128 v[216:219], v240 offset:6144
v_mfma_f32_16x16x32_bf16 v[140:143], v[220:223], v[124:127], v[140:143]
ds_read_b128 v[220:223], v240 offset:6656
s_cbranch_scc1 L2_x1
L2_loop1:
s_waitcnt lgkmcnt(2)
v_mfma_f32_16x16x32_bf16 v[144:147], v[208:211], v[0:3], v[192:195]
v_mfma_f32_16x16x32_bf16 v[144:147], v[212:215], v[4:7], v[144:147]
v_mfma_f32_16x16x32_bf16 v[148:151], v[208:211], v[32:35], v[196:199]
v_mfma_f32_16x16x32_bf16 v[148:151], v[212:215], v[36:39], v[148:151]
v_mfma_f32_16x16x32_bf16 v[152:155], v[208:211], v[64:67], v[200:203]
v_exp_f32 v128, v128
v_mfma_f32_16x16x32_bf16 v[152:155], v[212:215], v[68:71], v[152:155]
v_exp_f32 v129, v129
v_mfma_f32_16x16x32_bf16 v[156:159], v[208:211], v[96:99], v[204:207]
ds_read_b128 v[208:211], v240 offset:10240
v_mfma_f32_16x16x32_bf16 v[156:159], v[212:215], v[100:103], v[156:159]
ds_read_b128 v[212:215], v240 offset:10752
s_waitcnt lgkmcnt(2)
v_mfma_f32_16x16x32_bf16 v[144:147], v[216:219], v[8:11], v[144:147]
v_exp_f32 v130, v130
v_mfma_f32_16x16x32_bf16 v[144:147], v[220:223], v[12:15], v[144:147]
v_add_f32 v224, v224, v128
v_mfma_f32_16x16x32_bf16 v[148:151], v[216:219], v[40:43], v[148:151]
v_exp_f32 v131, v131
v_mfma_f32_16x16x32_bf16 v[148:151], v[220:223], v[44:47], v[148:151]
v_add_f32 v224, v224, v129
v_add_f32 v224, v224, v130
v_mfma_f32_16x16x32_bf16 v[152:155], v[216:219], v[72:75], v[152:155]
v_add_f32 v224, v224, v131
v_mfma_f32_16x16x32_bf16 v[152:155], v[220:223], v[76:79], v[152:155]
v_exp_f32 v132, v132
v_mfma_f32_16x16x32_bf16 v[156:159], v[216:219], v[104:107], v[156:159]
ds_read_b128 v[216:219], v240 offset:14336
v_mfma_f32_16x16x32_bf16 v[156:159], v[220:223], v[108:111], v[156:159]
ds_read_b128 v[220:223], v240 offset:14848
s_waitcnt lgkmcnt(2)
v_mfma_f32_16x16x32_bf16 v[144:147], v[208:211], v[16:19], v[144:147]
v_exp_f32 v133, v133
v_mfma_f32_16x16x32_bf16 v[144:147], v[212:215], v[20:23], v[144:147]
v_exp_f32 v134, v134
v_mfma_f32_16x16x32_bf16 v[148:151], v[208:211], v[48:51], v[148:151]
v_add_f32 v225, v225, v132
v_mfma_f32_16x16x32_bf16 v[148:151], v[212:215], v[52:55], v[148:151]
v_exp_f32 v135, v135
v_mfma_f32_16x16x32_bf16 v[152:155], v[208:211], v[80:83], v[152:155]
v_add_f32 v225, v225, v133
v_add_f32 v225, v225, v134
v_mfma_f32_16x16x32_bf16 v[152:155], v[212:215], v[84:87], v[152:155]
v_add_f32 v225, v225, v135
v_mfma_f32_16x16x32_bf16 v[156:159], v[208:211], v[112:115], v[156:159]
ds_read_b64_tr_b16 v[208:209], v246 offset:8192
ds_read_b64_tr_b16 v[210:211], v246 offset:10240
v_mfma_f32_16x16x32_bf16 v[156:159], v[212:215], v[116:119], v[156:159]
ds_read_b64_tr_b16 v[212:213], v246 offset:24576
s_waitcnt lgkmcnt(3)
v_mfma_f32_16x16x32_bf16 v[144:147], v[216:219], v[24:27], v[144:147]
ds_read_b64_tr_b16 v[214:215], v246 offset:26624
v_mfma_f32_16x16x32_bf16 v[144:147], v[220:223], v[28:31], v[144:147]
v_exp_f32 v136, v136
v_mfma_f32_16x16x32_bf16 v[148:151], v[216:219], v[56:59], v[148:151]
v_exp_f32 v137, v137
v_mfma_f32_16x16x32_bf16 v[148:151], v[220:223], v[60:63], v[148:151]
v_exp_f32 v138, v138
v_mfma_f32_16x16x32_bf16 v[152:155], v[216:219], v[88:91], v[152:155]
v_add_f32 v226, v226, v136
v_mfma_f32_16x16x32_bf16 v[152:155], v[220:223], v[92:95], v[152:155]
v_exp_f32 v139, v139
v_mfma_f32_16x16x32_bf16 v[156:159], v[216:219], v[120:123], v[156:159]
ds_read_b64_tr_b16 v[216:217], v247 offset:8192
ds_read_b64_tr_b16 v[218:219], v247 offset:10240
v_mfma_f32_16x16x32_bf16 v[156:159], v[220:223], v[124:127], v[156:159]
ds_read_b64_tr_b16 v[220:221], v247 offset:24576
s_waitcnt lgkmcnt(3)
v_mfma_f32_16x16x32_bf16 a[128:131], v[160:163], v[208:211], a[128:131]
ds_read_b64_tr_b16 v[222:223], v247 offset:26624
v_add_f32 v226, v226, v137
v_mfma_f32_16x16x32_bf16 a[128:131], v[176:179], v[212:215], a[128:131]
v_add_f32 v226, v226, v138
v_add_f32 v226, v226, v139
v_mfma_f32_16x16x32_bf16 a[132:135], v[164:167], v[208:211], a[132:135]
v_exp_f32 v140, v140
v_mfma_f32_16x16x32_bf16 a[132:135], v[180:183], v[212:215], a[132:135]
v_exp_f32 v141, v141
v_mfma_f32_16x16x32_bf16 a[136:139], v[168:171], v[208:211], a[136:139]
v_exp_f32 v142, v142
v_mfma_f32_16x16x32_bf16 a[136:139], v[184:187], v[212:215], a[136:139]
v_add_f32 v227, v227, v140
v_mfma_f32_16x16x32_bf16 a[140:143], v[172:175], v[208:211], a[140:143]
ds_read_b64_tr_b16 v[208:209], v246 offset:8704
ds_read_b64_tr_b16 v[210:211], v246 offset:10752
v_mfma_f32_16x16x32_bf16 a[140:143], v[188:191], v[212:215], a[140:143]
ds_read_b64_tr_b16 v[212:213], v246 offset:25088
s_waitcnt lgkmcnt(3)
v_mfma_f32_16x16x32_bf16 a[144:147], v[160:163], v[216:219], a[144:147]
ds_read_b64_tr_b16 v[214:215], v246 offset:27136
v_mfma_f32_16x16x32_bf16 a[144:147], v[176:179], v[220:223], a[144:147]
v_exp_f32 v143, v143
v_mfma_f32_16x16x32_bf16 a[148:151], v[164:167], v[216:219], a[148:151]
v_add_f32 v227, v227, v141
v_add_f32 v227, v227, v142
v_mfma_f32_16x16x32_bf16 a[148:151], v[180:183], v[220:223], a[148:151]
v_add_f32 v227, v227, v143
v_max3_f32 v242, v224, v225, v226
v_mfma_f32_16x16x32_bf16 a[152:155], v[168:171], v[216:219], a[152:155]
v_max_f32 v242, v242, v227
v_mfma_f32_16x16x32_bf16 a[152:155], v[184:187], v[220:223], a[152:155]
v_cmp_lt_f32 vcc, s32, v242
v_mfma_f32_16x16x32_bf16 a[156:159], v[172:175], v[216:219], a[156:159]
ds_read_b64_tr_b16 v[216:217], v247 offset:8704
ds_read_b64_tr_b16 v[218:219], v247 offset:10752
v_mfma_f32_16x16x32_bf16 a[156:159], v[188:191], v[220:223], a[156:159]
ds_read_b64_tr_b16 v[220:221], v247 offset:25088
s_waitcnt lgkmcnt(3)
v_mfma_f32_16x16x32_bf16 a[160:163], v[160:163], v[208:211], a[160:163]
ds_read_b64_tr_b16 v[222:223], v247 offset:27136
s_cbranch_vccnz L2_rare_site2
L2_ret2:
v_mfma_f32_16x16x32_bf16 a[160:163], v[176:179], v[212:215], a[160:163]
v_exp_f32 v144, v144
v_mfma_f32_16x16x32_bf16 a[164:167], v[164:167], v[208:211], a[164:167]
v_exp_f32 v145, v145
v_mfma_f32_16x16x32_bf16 a[164:167], v[180:183], v[212:215], a[164:167]
v_exp_f32 v146, v146
v_mfma_f32_16x16x32_bf16 a[168:171], v[168:171], v[208:211], a[168:171]
s_mov_b32 m0, s30
v_add_f32 v224, v224, v144
v_mfma_f32_16x16x32_bf16 a[168:171], v[184:187], v[212:215], a[168:171]
buffer_load_dwordx4 v241, s[12:15], s28 offen offset:0 sc1 lds
v_mfma_f32_16x16x32_bf16 a[172:175], v[172:175], v[208:211], a[172:175]
ds_read_b64_tr_b16 v[208:209], v246 offset:12288
ds_read_b64_tr_b16 v[210:211], v246 offset:14336
v_mfma_f32_16x16x32_bf16 a[172:175], v[188:191], v[212:215], a[172:175]
ds_read_b64_tr_b16 v[212:213], v246 offset:28672
s_waitcnt lgkmcnt(3)
v_mfma_f32_16x16x32_bf16 a[176:179], v[160:163], v[216:219], a[176:179]
ds_read_b64_tr_b16 v[214:215], v246 offset:30720
v_mfma_f32_16x16x32_bf16 a[176:179], v[176:179], v[220:223], a[176:179]
buffer_load_dwordx4 v241, s[12:15], s28 offen offset:1024 sc1 lds
v_mfma_f32_16x16x32_bf16 a[180:183], v[164:167], v[216:219], a[180:183]
v_exp_f32 v147, v147
v_mfma_f32_16x16x32_bf16 a[180:183], v[180:183], v[220:223], a[180:183]
v_add_f32 v224, v224, v145
v_add_f32 v224, v224, v146
v_mfma_f32_16x16x32_bf16 a[184:187], v[168:171], v[216:219], a[184:187]
v_add_f32 v224, v224, v147
v_mfma_f32_16x16x32_bf16 a[184:187], v[184:187], v[220:223], a[184:187]
buffer_load_dwordx4 v241, s[12:15], s28 offen offset:2048 sc1 lds
v_mfma_f32_16x16x32_bf16 a[188:191], v[172:175], v[216:219], a[188:191]
ds_read_b64_tr_b16 v[216:217], v247 offset:12288
ds_read_b64_tr_b16 v[218:219], v247 offset:14336
v_mfma_f32_16x16x32_bf16 a[188:191], v[188:191], v[220:223], a[188:191]
ds_read_b64_tr_b16 v[220:221], v247 offset:28672
s_waitcnt lgkmcnt(3)
v_mfma_f32_16x16x32_bf16 a[192:195], v[160:163], v[208:211], a[192:195]
ds_read_b64_tr_b16 v[222:223], v247 offset:30720
v_mfma_f32_16x16x32_bf16 a[192:195], v[176:179], v[212:215], a[192:195]
buffer_load_dwordx4 v241, s[12:15], s28 offen offset:3072 sc1 lds
v_mfma_f32_16x16x32_bf16 a[196:199], v[164:167], v[208:211], a[196:199]
v_exp_f32 v148, v148
v_mfma_f32_16x16x32_bf16 a[196:199], v[180:183], v[212:215], a[196:199]
v_exp_f32 v149, v149
v_mfma_f32_16x16x32_bf16 a[200:203], v[168:171], v[208:211], a[200:203]
v_exp_f32 v150, v150
v_mfma_f32_16x16x32_bf16 a[200:203], v[184:187], v[212:215], a[200:203]
v_add_f32 v225, v225, v148
v_mfma_f32_16x16x32_bf16 a[204:207], v[172:175], v[208:211], a[204:207]
ds_read_b64_tr_b16 v[208:209], v246 offset:12800
ds_read_b64_tr_b16 v[210:211], v246 offset:14848
v_mfma_f32_16x16x32_bf16 a[204:207], v[188:191], v[212:215], a[204:207]
ds_read_b64_tr_b16 v[212:213], v246 offset:29184
s_waitcnt lgkmcnt(3)
v_mfma_f32_16x16x32_bf16 a[208:211], v[160:163], v[216:219], a[208:211]
ds_read_b64_tr_b16 v[214:215], v246 offset:31232
v_mfma_f32_16x16x32_bf16 a[208:211], v[176:179], v[220:223], a[208:211]
v_exp_f32 v151, v151
v_mfma_f32_16x16x32_bf16 a[212:215], v[164:167], v[216:219], a[212:215]
v_add_f32 v225, v225, v149
v_add_f32 v225, v225, v150
v_mfma_f32_16x16x32_bf16 a[212:215], v[180:183], v[220:223], a[212:215]
v_add_f32 v225, v225, v151
v_mfma_f32_16x16x32_bf16 a[216:219], v[168:171], v[216:219], a[216:219]
v_exp_f32 v152, v152
v_mfma_f32_16x16x32_bf16 a[216:219], v[184:187], v[220:223], a[216:219]
v_exp_f32 v153, v153
v_mfma_f32_16x16x32_bf16 a[220:223], v[172:175], v[216:219], a[220:223]
ds_read_b64_tr_b16 v[216:217], v247 offset:12800
ds_read_b64_tr_b16 v[218:219], v247 offset:14848
v_mfma_f32_16x16x32_bf16 a[220:223], v[188:191], v[220:223], a[220:223]
ds_read_b64_tr_b16 v[220:221], v247 offset:29184
s_waitcnt lgkmcnt(3)
v_mfma_f32_16x16x32_bf16 a[224:227], v[160:163], v[208:211], a[224:227]
ds_read_b64_tr_b16 v[222:223], v247 offset:31232
v_mfma_f32_16x16x32_bf16 a[224:227], v[176:179], v[212:215], a[224:227]
s_waitcnt vmcnt(4)
s_barrier
v_mfma_f32_16x16x32_bf16 a[228:231], v[164:167], v[208:211], a[228:231]
v_exp_f32 v154, v154
v_mfma_f32_16x16x32_bf16 a[228:231], v[180:183], v[212:215], a[228:231]
v_add_f32 v226, v226, v152
v_mfma_f32_16x16x32_bf16 a[232:235], v[168:171], v[208:211], a[232:235]
v_exp_f32 v155, v155
v_mfma_f32_16x16x32_bf16 a[232:235], v[184:187], v[212:215], a[232:235]
v_add_f32 v226, v226, v153
v_add_f32 v226, v226, v154
v_mfma_f32_16x16x32_bf16 a[236:239], v[172:175], v[208:211], a[236:239]
ds_read_b128 v[208:211], v240 offset:16384
v_add_f32 v226, v226, v155
v_mfma_f32_16x16x32_bf16 a[236:239], v[188:191], v[212:215], a[236:239]
ds_read_b128 v[212:215], v240 offset:16896
s_waitcnt lgkmcnt(2)
v_mfma_f32_16x16x32_bf16 a[240:243], v[160:163], v[216:219], a[240:243]
v_exp_f32 v156, v156
v_mfma_f32_16x16x32_bf16 a[240:243], v[176:179], v[220:223], a[240:243]
v_cvt_pk_bf16_f32 v160, v128, v129
v_cvt_pk_bf16_f32 v161, v130, v131
v_mfma_f32_16x16x32_bf16 a[244:247], v[164:167], v[216:219], a[244:247]
v_exp_f32 v157, v157
v_mfma_f32_16x16x32_bf16 a[244:247], v[180:183], v[220:223], a[244:247]
v_cvt_pk_bf16_f32 v164, v132, v133
v_cvt_pk_bf16_f32 v165, v134, v135
v_mfma_f32_16x16x32_bf16 a[248:251], v[168:171], v[216:219], a[248:251]
v_exp_f32 v158, v158
v_mfma_f32_16x16x32_bf16 a[248:251], v[184:187], v[220:223], a[248:251]
v_cvt_pk_bf16_f32 v168, v136, v137
v_cvt_pk_bf16_f32 v169, v138, v139
v_mfma_f32_16x16x32_bf16 a[252:255], v[172:175], v[216:219], a[252:255]
ds_read_b128 v[216:219], v240 offset:20480
v_add_f32 v227, v227, v156
v_mfma_f32_16x16x32_bf16 a[252:255], v[188:191], v[220:223], a[252:255]
ds_read_b128 v[220:223], v240 offset:20992
s_waitcnt lgkmcnt(2)
v_mfma_f32_16x16x32_bf16 v[128:131], v[208:211], v[0:3], v[192:195]
v_exp_f32 v159, v159
v_mfma_f32_16x16x32_bf16 v[128:131], v[212:215], v[4:7], v[128:131]
v_cvt_pk_bf16_f32 v172, v140, v141
v_cvt_pk_bf16_f32 v173, v142, v143
v_mfma_f32_16x16x32_bf16 v[132:135], v[208:211], v[32:35], v[196:199]
v_add_f32 v227, v227, v157
v_add_f32 v227, v227, v158
v_mfma_f32_16x16x32_bf16 v[132:135], v[212:215], v[36:39], v[132:135]
v_add_f32 v227, v227, v159
v_max3_f32 v242, v224, v225, v226
v_mfma_f32_16x16x32_bf16 v[136:139], v[208:211], v[64:67], v[200:203]
v_max_f32 v242, v242, v227
v_mfma_f32_16x16x32_bf16 v[136:139], v[212:215], v[68:71], v[136:139]
v_cmp_lt_f32 vcc, s32, v242
v_mfma_f32_16x16x32_bf16 v[140:143], v[208:211], v[96:99], v[204:207]
ds_read_b128 v[208:211], v240 offset:24576
v_mfma_f32_16x16x32_bf16 v[140:143], v[212:215], v[100:103], v[140:143]
ds_read_b128 v[212:215], v240 offset:25088
s_waitcnt lgkmcnt(2)
v_mfma_f32_16x16x32_bf16 v[128:131], v[216:219], v[8:11], v[128:131]
v_mov_b32 v244, v246
v_mov_b32 v245, v247
v_mfma_f32_16x16x32_bf16 v[128:131], v[220:223], v[12:15], v[128:131]
v_add_u32 v246, 0x8000, v246
s_cbranch_vccnz L2_rare_site3
L2_ret3:
v_mfma_f32_16x16x32_bf16 v[132:135], v[216:219], v[40:43], v[132:135]
v_and_b32 v246, 0x1ffff, v246
v_cvt_pk_bf16_f32 v162, v144, v145
v_mfma_f32_16x16x32_bf16 v[132:135], v[220:223], v[44:47], v[132:135]
v_cvt_pk_bf16_f32 v163, v146, v147
v_cvt_pk_bf16_f32 v166, v148, v149
v_mfma_f32_16x16x32_bf16 v[136:139], v[216:219], v[72:75], v[136:139]
v_xor_b32 v247, 32, v246
v_cvt_pk_bf16_f32 v167, v150, v151
v_mfma_f32_16x16x32_bf16 v[136:139], v[220:223], v[76:79], v[136:139]
v_cvt_pk_bf16_f32 v170, v152, v153
v_cvt_pk_bf16_f32 v171, v154, v155
v_mfma_f32_16x16x32_bf16 v[140:143], v[216:219], v[104:107], v[140:143]
ds_read_b128 v[216:219], v240 offset:28672
v_cvt_pk_bf16_f32 v174, v156, v157
v_mfma_f32_16x16x32_bf16 v[140:143], v[220:223], v[108:111], v[140:143]
ds_read_b128 v[220:223], v240 offset:29184
s_waitcnt lgkmcnt(2)
v_mfma_f32_16x16x32_bf16 v[128:131], v[208:211], v[16:19], v[128:131]
v_cvt_pk_bf16_f32 v175, v158, v159
v_mfma_f32_16x16x32_bf16 v[128:131], v[212:215], v[20:23], v[128:131]
v_mfma_f32_16x16x32_bf16 v[132:135], v[208:211], v[48:51], v[132:135]
v_mfma_f32_16x16x32_bf16 v[132:135], v[212:215], v[52:55], v[132:135]
v_mfma_f32_16x16x32_bf16 v[136:139], v[208:211], v[80:83], v[136:139]
v_mfma_f32_16x16x32_bf16 v[136:139], v[212:215], v[84:87], v[136:139]
s_sub_u32 s31, s31, 1
v_mfma_f32_16x16x32_bf16 v[140:143], v[208:211], v[112:115], v[140:143]
ds_read_b128 v[208:211], v240 offset:18432
v_mfma_f32_16x16x32_bf16 v[140:143], v[212:215], v[116:119], v[140:143]
ds_read_b128 v[212:215], v240 offset:18944
s_waitcnt lgkmcnt(2)
v_mfma_f32_16x16x32_bf16 v[128:131], v[216:219], v[24:27], v[128:131]
s_add_u32 s28, s28, s101
s_add_u32 s30, s30, 0x4000
v_mfma_f32_16x16x32_bf16 v[128:131], v[220:223], v[28:31], v[128:131]
s_and_b32 s30, s30, 0x1ffff
v_mfma_f32_16x16x32_bf16 v[132:135], v[216:219], v[56:59], v[132:135]
s_cmp_eq_u32 s31, 0
v_mfma_f32_16x16x32_bf16 v[132:135], v[220:223], v[60:63], v[132:135]
v_mfma_f32_16x16x32_bf16 v[136:139], v[216:219], v[88:91], v[136:139]
v_mfma_f32_16x16x32_bf16 v[136:139], v[220:223], v[92:95], v[136:139]
v_mfma_f32_16x16x32_bf16 v[140:143], v[216:219], v[120:123], v[140:143]
ds_read_b128 v[216:219], v240 offset:22528
v_mfma_f32_16x16x32_bf16 v[140:143], v[220:223], v[124:127], v[140:143]
ds_read_b128 v[220:223], v240 offset:23040
s_cbranch_scc0 L2_loop
s_cmp_eq_u32 s100, 0
s_cbranch_scc1 L2_tail_0
s_mov_b32 s3, 0
s_branch L2_ev
L2_x1:
s_cmp_eq_u32 s100, 0
s_cbranch_scc1 L2_tail_1
s_mov_b32 s3, 1
L2_ev:
s_sub_u32 s100, s100, 1
s_mov_b32 s31, 1
v_mov_b32 v230, 0x20000
s_cmp_eq_u32 s100, 0
s_cbranch_scc1 L2_ev5
s_cmp_lg_u32 s34, 0
s_cbranch_scc1 L2_evr
s_mov_b64 exec, 1
s_cmp_eq_u32 s100, 4
s_cbranch_scc1 L2_ev1
s_cmp_eq_u32 s100, 1
s_cbranch_scc1 L2_ev4
v_cmp_eq_u64 vcc, s[98:99], v[228:229]
s_nop 1
s_bitcmp1_b32 vcc_lo, 0
s_subb_u32 s39, s39, 0
v_mov_b32 v228, s98
v_mov_b32 v229, s99
s_cmp_eq_u32 s100, 2
s_cbranch_scc1 L2_ev3
buffer_atomic_swap_x2 v[228:229], off, s[16:19], s49 offset:0 sc0 sc1
s_branch L2_evx
L2_ev1:
v_mov_b32 v228, s98
v_mov_b32 v229, s99
buffer_atomic_swap_x2 v[228:229], off, s[16:19], s95 offset:16 sc0 sc1
s_branch L2_evx
L2_ev3:
v_mov_b32 v252, s98
v_mov_b32 v253, s99
buffer_atomic_swap_x2 v[228:229], off, s[16:19], s35 offset:0 sc0 sc1
buffer_atomic_swap_x2 v[252:253], off, s[16:19], s94 offset:16 sc0 sc1
s_branch L2_evx
L2_ev4:
v_cmp_ne_u64 vcc, s[98:99], v[228:229]
s_nop 1
s_bitcmp1_b32 vcc_lo, 0
s_addc_u32 s39, s39, 0
v_cmp_ne_u64 vcc, s[98:99], v[252:253]
s_nop 1
s_bitcmp1_b32 vcc_lo, 0
s_addc_u32 s39, s39, 0
v_mov_b32 v228, s39
ds_write_b32 v230, v228
L2_evx:
s_mov_b64 exec, -1
s_branch L2_evr
L2_ev5:
ds_read_b32 v228, v230
s_waitcnt lgkmcnt(0)
v_readfirstlane_b32 s31, v228
L2_evr:
s_cmp_eq_u32 s3, 0
s_cbranch_scc1 L2_loop
s_branch L2_loop1
L2_tail_0:
s_waitcnt lgkmcnt(2)
v_add_u32 v231, s50, v243
v_mfma_f32_16x16x32_bf16 v[144:147], v[208:211], v[0:3], v[192:195]
s_mov_b32 m0, s30
ds_write_b128 v231, v[176:179] offset:0
v_mfma_f32_16x16x32_bf16 v[144:147], v[212:215], v[4:7], v[144:147]
buffer_load_dwordx4 v241, s[12:15], s28 offen offset:0 sc1 lds
ds_write_b128 v231, v[180:183] offset:1024
v_mfma_f32_16x16x32_bf16 v[148:151], v[208:211], v[32:35], v[196:199]
buffer_load_dwordx4 v241, s[12:15], s28 offen offset:1024 sc1 lds
ds_write_b128 v231, v[184:187] offset:2048
v_mfma_f32_16x16x32_bf16 v[148:151], v[212:215], v[36:39], v[148:151]
buffer_load_dwordx4 v241, s[12:15], s28 offen offset:2048 sc1 lds
ds_write_b128 v231, v[188:191] offset:3072
v_mfma_f32_16x16x32_bf16 v[152:155], v[208:211], v[64:67], v[200:203]
buffer_load_dwordx4 v241, s[12:15], s28 offen offset:3072 sc1 lds
v_add_u32 v230, 0x8000, v240
v_and_b32 v230, 0x1ffff, v230
v_mfma_f32_16x16x32_bf16 v[152:155], v[212:215], v[68:71], v[152:155]
v_exp_f32 v232, v128
v_mfma_f32_16x16x32_bf16 v[156:159], v[208:211], v[96:99], v[204:207]
ds_read_b128 v[208:211], v240 offset:26624
v_exp_f32 v233, v129
v_mfma_f32_16x16x32_bf16 v[156:159], v[212:215], v[100:103], v[156:159]
ds_read_b128 v[212:215], v240 offset:27136
s_waitcnt lgkmcnt(2)
s_and_b32 s30, s30, 0x1c000
v_mfma_f32_16x16x32_bf16 v[144:147], v[216:219], v[8:11], v[144:147]
v_exp_f32 v234, v130
v_add_f32 v224, v224, v232
v_mfma_f32_16x16x32_bf16 v[144:147], v[220:223], v[12:15], v[144:147]
v_cvt_pk_bf16_f32 v176, v232, v233
v_exp_f32 v235, v131
v_mfma_f32_16x16x32_bf16 v[148:151], v[216:219], v[40:43], v[148:151]
v_add_f32 v224, v224, v233
v_add_f32 v224, v224, v234
v_add_f32 v224, v224, v235
v_mfma_f32_16x16x32_bf16 v[148:151], v[220:223], v[44:47], v[148:151]
v_cvt_pk_bf16_f32 v177, v234, v235
v_exp_f32 v236, v132
v_mfma_f32_16x16x32_bf16 v[152:155], v[216:219], v[72:75], v[152:155]
v_exp_f32 v237, v133
s_add_u32 s28, s30, 0xc000
v_mfma_f32_16x16x32_bf16 v[152:155], v[220:223], v[76:79], v[152:155]
v_exp_f32 v238, v134
v_add_f32 v225, v225, v236
v_mfma_f32_16x16x32_bf16 v[156:159], v[216:219], v[104:107], v[156:159]
ds_read_b128 v[216:219], v240 offset:30720
v_cvt_pk_bf16_f32 v180, v236, v237
s_and_b32 s28, s28, 0x1ffff
v_mfma_f32_16x16x32_bf16 v[156:159], v[220:223], v[108:111], v[156:159]
ds_read_b128 v[220:223], v240 offset:31232
s_waitcnt lgkmcnt(2)
s_add_u32 s30, s30, 0x4000
v_mfma_f32_16x16x32_bf16 v[144:147], v[208:211], v[16:19], v[144:147]
v_exp_f32 v239, v135
v_add_f32 v225, v225, v237
v_mfma_f32_16x16x32_bf16 v[144:147], v[212:215], v[20:23], v[144:147]
s_waitcnt vmcnt(4)
s_barrier
v_add_f32 v225, v225, v238
v_mfma_f32_16x16x32_bf16 v[148:151], v[208:211], v[48:51], v[148:151]
v_add_f32 v225, v225, v239
v_cvt_pk_bf16_f32 v181, v238, v239
s_and_b32 s30, s30, 0x1ffff
v_mfma_f32_16x16x32_bf16 v[148:151], v[212:215], v[52:55], v[148:151]
v_exp_f32 v232, v136
s_mul_i32 s31, s34, 6144
v_mfma_f32_16x16x32_bf16 v[152:155], v[208:211], v[80:83], v[152:155]
v_exp_f32 v233, v137
s_add_u32 s31, s31, s30
v_mfma_f32_16x16x32_bf16 v[152:155], v[212:215], v[84:87], v[152:155]
v_exp_f32 v234, v138
v_add_f32 v226, v226, v232
v_mfma_f32_16x16x32_bf16 v[156:159], v[208:211], v[112:115], v[156:159]
ds_read_b128 v[208:211], v230 offset:0
v_cvt_pk_bf16_f32 v184, v232, v233
s_lshl_b32 s3, s34, 10
v_mfma_f32_16x16x32_bf16 v[156:159], v[212:215], v[116:119], v[156:159]
ds_read_b128 v[212:215], v230 offset:512
s_waitcnt lgkmcnt(2)
s_add_u32 s28, s28, s3
v_mfma_f32_16x16x32_bf16 v[144:147], v[216:219], v[24:27], v[144:147]
v_exp_f32 v235, v139
v_add_f32 v226, v226, v233
v_mfma_f32_16x16x32_bf16 v[144:147], v[220:223], v[28:31], v[144:147]
v_add_f32 v226, v226, v234
v_add_f32 v226, v226, v235
v_cvt_pk_bf16_f32 v185, v234, v235
v_mfma_f32_16x16x32_bf16 v[148:151], v[216:219], v[56:59], v[148:151]
v_exp_f32 v236, v140
s_add_u32 s3, s3, 24576
v_mfma_f32_16x16x32_bf16 v[148:151], v[220:223], v[60:63], v[148:151]
v_exp_f32 v237, v141
s_add_u32 s30, s30, s3
v_mfma_f32_16x16x32_bf16 v[152:155], v[216:219], v[88:91], v[152:155]
v_exp_f32 v238, v142
v_add_f32 v227, v227, v236
v_mfma_f32_16x16x32_bf16 v[152:155], v[220:223], v[92:95], v[152:155]
v_cvt_pk_bf16_f32 v188, v236, v237
v_exp_f32 v239, v143
v_mfma_f32_16x16x32_bf16 v[156:159], v[216:219], v[120:123], v[156:159]
ds_read_b128 v[216:219], v230 offset:4096
v_add_f32 v227, v227, v237
v_add_f32 v227, v227, v238
v_mfma_f32_16x16x32_bf16 v[156:159], v[220:223], v[124:127], v[156:159]
ds_read_b128 v[220:223], v230 offset:4608
s_waitcnt lgkmcnt(2)
v_add_f32 v227, v227, v239
v_cvt_pk_bf16_f32 v189, v238, v239
v_max3_f32 v242, v224, v225, v226
v_max_f32 v242, v242, v227
v_cmp_lt_f32 vcc, s32, v242
s_cbranch_vccnz L2_rare_site6
L2_ret6:
v_mfma_f32_16x16x32_bf16 v[128:131], v[208:211], v[0:3], v[192:195]
v_lshrrev_b32 v241, 4, v243
v_and_b32 v241, 0x30, v241
v_xor_b32 v241, v241, v243
v_and_b32 v228, 0x380, v243
v_mad_u32_u24 v241, v228, 3, v241
v_mfma_f32_16x16x32_bf16 v[128:131], v[212:215], v[4:7], v[128:131]
v_exp_f32 v232, v144
v_mfma_f32_16x16x32_bf16 v[132:135], v[208:211], v[32:35], v[196:199]
v_exp_f32 v233, v145
v_mfma_f32_16x16x32_bf16 v[132:135], v[212:215], v[36:39], v[132:135]
v_exp_f32 v234, v146
v_add_f32 v224, v224, v232
v_mfma_f32_16x16x32_bf16 v[136:139], v[208:211], v[64:67], v[200:203]
v_cvt_pk_bf16_f32 v178, v232, v233
v_exp_f32 v235, v147
v_mfma_f32_16x16x32_bf16 v[136:139], v[212:215], v[68:71], v[136:139]
v_add_f32 v224, v224, v233
v_add_f32 v224, v224, v234
v_add_f32 v224, v224, v235
v_mfma_f32_16x16x32_bf16 v[140:143], v[208:211], v[96:99], v[204:207]
ds_read_b128 v[208:211], v230 offset:8192
v_cvt_pk_bf16_f32 v179, v234, v235
v_mfma_f32_16x16x32_bf16 v[140:143], v[212:215], v[100:103], v[140:143]
ds_read_b128 v[212:215], v230 offset:8704
s_waitcnt lgkmcnt(2)
v_mfma_f32_16x16x32_bf16 v[128:131], v[216:219], v[8:11], v[128:131]
ds_write_b128 v231, v[160:163] offset:4096
v_exp_f32 v236, v148
v_mfma_f32_16x16x32_bf16 v[128:131], v[220:223], v[12:15], v[128:131]
ds_write_b128 v231, v[164:167] offset:5120
v_exp_f32 v237, v149
v_mfma_f32_16x16x32_bf16 v[132:135], v[216:219], v[40:43], v[132:135]
ds_write_b128 v231, v[168:171] offset:6144
v_exp_f32 v238, v150
v_mfma_f32_16x16x32_bf16 v[132:135], v[220:223], v[44:47], v[132:135]
ds_write_b128 v231, v[172:175] offset:7168
v_add_f32 v225, v225, v236
v_cvt_pk_bf16_f32 v182, v236, v237
v_mfma_f32_16x16x32_bf16 v[136:139], v[216:219], v[72:75], v[136:139]
v_exp_f32 v239, v151
v_add_f32 v225, v225, v237
v_mfma_f32_16x16x32_bf16 v[136:139], v[220:223], v[76:79], v[136:139]
v_add_f32 v225, v225, v238
v_add_f32 v225, v225, v239
v_cvt_pk_bf16_f32 v183, v238, v239
v_mfma_f32_16x16x32_bf16 v[140:143], v[216:219], v[104:107], v[140:143]
ds_read_b128 v[216:219], v230 offset:12288
v_exp_f32 v232, v152
v_mfma_f32_16x16x32_bf16 v[140:143], v[220:223], v[108:111], v[140:143]
ds_read_b128 v[220:223], v230 offset:12800
s_waitcnt lgkmcnt(2)
v_mfma_f32_16x16x32_bf16 v[128:131], v[208:211], v[16:19], v[128:131]
v_exp_f32 v233, v153
v_mfma_f32_16x16x32_bf16 v[128:131], v[212:215], v[20:23], v[128:131]
v_exp_f32 v234, v154
v_add_f32 v226, v226, v232
v_mfma_f32_16x16x32_bf16 v[132:135], v[208:211], v[48:51], v[132:135]
v_cvt_pk_bf16_f32 v186, v232, v233
v_exp_f32 v235, v155
v_mfma_f32_16x16x32_bf16 v[132:135], v[212:215], v[52:55], v[132:135]
v_add_f32 v226, v226, v233
v_add_f32 v226, v226, v234
v_add_f32 v226, v226, v235
v_mfma_f32_16x16x32_bf16 v[136:139], v[208:211], v[80:83], v[136:139]
v_cvt_pk_bf16_f32 v187, v234, v235
v_exp_f32 v236, v156
v_mfma_f32_16x16x32_bf16 v[136:139], v[212:215], v[84:87], v[136:139]
v_exp_f32 v237, v157
v_mfma_f32_16x16x32_bf16 v[140:143], v[208:211], v[112:115], v[140:143]
ds_read_b128 v[208:211], v230 offset:2048
v_exp_f32 v238, v158
v_mfma_f32_16x16x32_bf16 v[140:143], v[212:215], v[116:119], v[140:143]
ds_read_b128 v[212:215], v230 offset:2560
s_waitcnt lgkmcnt(2)
v_add_f32 v227, v227, v236
v_mfma_f32_16x16x32_bf16 v[128:131], v[216:219], v[24:27], v[128:131]
v_cvt_pk_bf16_f32 v190, v236, v237
v_exp_f32 v239, v159
v_mfma_f32_16x16x32_bf16 v[128:131], v[220:223], v[28:31], v[128:131]
v_add_f32 v227, v227, v237
v_add_f32 v227, v227, v238
v_add_f32 v227, v227, v239
v_mfma_f32_16x16x32_bf16 v[132:135], v[216:219], v[56:59], v[132:135]
v_cvt_pk_bf16_f32 v191, v238, v239
v_max3_f32 v242, v224, v225, v226
v_max_f32 v242, v242, v227
v_mfma_f32_16x16x32_bf16 v[132:135], v[220:223], v[60:63], v[132:135]
v_cmp_lt_f32 vcc, s32, v242
s_cbranch_vccnz L2_rare_site7
L2_ret7:
v_mfma_f32_16x16x32_bf16 v[136:139], v[216:219], v[88:91], v[136:139]
s_add_u32 m0, s31, 0
v_mfma_f32_16x16x32_bf16 v[136:139], v[220:223], v[92:95], v[136:139]
buffer_load_dwordx4 v241, s[8:11], s6 offen lds
s_add_u32 m0, s31, 2048
v_mfma_f32_16x16x32_bf16 v[140:143], v[216:219], v[120:123], v[140:143]
ds_read_b128 v[216:219], v230 offset:6144
buffer_load_dwordx4 v241, s[8:11], s7 offen lds
s_add_u32 m0, s31, 4096
v_mfma_f32_16x16x32_bf16 v[140:143], v[220:223], v[124:127], v[140:143]
ds_read_b128 v[220:223], v230 offset:6656
s_waitcnt lgkmcnt(2)
v_mfma_f32_16x16x32_bf16 v[144:147], v[208:211], v[0:3], v[192:195]
buffer_load_dwordx4 v241, s[8:11], s29 offen lds
s_add_u32 m0, s31, 1024
v_xor_b32 v241, 0x1040, v241
v_mfma_f32_16x16x32_bf16 v[144:147], v[212:215], v[4:7], v[144:147]
v_exp_f32 v232, v128
v_mfma_f32_16x16x32_bf16 v[148:151], v[208:211], v[32:35], v[196:199]
v_exp_f32 v233, v129
v_mfma_f32_16x16x32_bf16 v[148:151], v[212:215], v[36:39], v[148:151]
v_exp_f32 v234, v130
v_add_f32 v224, v224, v232
v_mfma_f32_16x16x32_bf16 v[152:155], v[208:211], v[64:67], v[200:203]
v_cvt_pk_bf16_f32 v160, v232, v233
v_exp_f32 v235, v131
v_mfma_f32_16x16x32_bf16 v[152:155], v[212:215], v[68:71], v[152:155]
v_add_f32 v224, v224, v233
v_add_f32 v224, v224, v234
v_add_f32 v224, v224, v235
v_mfma_f32_16x16x32_bf16 v[156:159], v[208:211], v[96:99], v[204:207]
ds_read_b128 v[208:211], v230 offset:10240
v_cvt_pk_bf16_f32 v161, v234, v235
v_mfma_f32_16x16x32_bf16 v[156:159], v[212:215], v[100:103], v[156:159]
ds_read_b128 v[212:215], v230 offset:10752
s_waitcnt lgkmcnt(2)
v_mfma_f32_16x16x32_bf16 v[144:147], v[216:219], v[8:11], v[144:147]
v_exp_f32 v236, v132
v_mfma_f32_16x16x32_bf16 v[144:147], v[220:223], v[12:15], v[144:147]
v_exp_f32 v237, v133
v_mfma_f32_16x16x32_bf16 v[148:151], v[216:219], v[40:43], v[148:151]
v_exp_f32 v238, v134
v_add_f32 v225, v225, v236
v_mfma_f32_16x16x32_bf16 v[148:151], v[220:223], v[44:47], v[148:151]
v_cvt_pk_bf16_f32 v164, v236, v237
v_exp_f32 v239, v135
v_mfma_f32_16x16x32_bf16 v[152:155], v[216:219], v[72:75], v[152:155]
v_add_f32 v225, v225, v237
v_add_f32 v225, v225, v238
v_add_f32 v225, v225, v239
v_mfma_f32_16x16x32_bf16 v[152:155], v[220:223], v[76:79], v[152:155]
v_cvt_pk_bf16_f32 v165, v238, v239
v_exp_f32 v232, v136
v_mfma_f32_16x16x32_bf16 v[156:159], v[216:219], v[104:107], v[156:159]
ds_read_b128 v[216:219], v230 offset:14336
v_exp_f32 v233, v137
v_mfma_f32_16x16x32_bf16 v[156:159], v[220:223], v[108:111], v[156:159]
ds_read_b128 v[220:223], v230 offset:14848
s_waitcnt lgkmcnt(2)
v_mfma_f32_16x16x32_bf16 v[144:147], v[208:211], v[16:19], v[144:147]
v_exp_f32 v234, v138
v_add_f32 v226, v226, v232
v_mfma_f32_16x16x32_bf16 v[144:147], v[212:215], v[20:23], v[144:147]
s_waitcnt vmcnt(3)
s_barrier
v_cvt_pk_bf16_f32 v168, v232, v233
v_mfma_f32_16x16x32_bf16 v[148:151], v[208:211], v[48:51], v[148:151]
v_exp_f32 v235, v139
v_add_f32 v226, v226, v233
v_mfma_f32_16x16x32_bf16 v[148:151], v[212:215], v[52:55], v[148:151]
v_add_f32 v226, v226, v234
v_add_f32 v226, v226, v235
v_cvt_pk_bf16_f32 v169, v234, v235
v_mfma_f32_16x16x32_bf16 v[152:155], v[208:211], v[80:83], v[152:155]
v_exp_f32 v236, v140
v_mfma_f32_16x16x32_bf16 v[152:155], v[212:215], v[84:87], v[152:155]
v_exp_f32 v237, v141
v_mfma_f32_16x16x32_bf16 v[156:159], v[208:211], v[112:115], v[156:159]
ds_read_b128 v[208:211], v230 offset:16384
v_exp_f32 v238, v142
v_mfma_f32_16x16x32_bf16 v[156:159], v[212:215], v[116:119], v[156:159]
ds_read_b128 v[212:215], v230 offset:16896
s_waitcnt lgkmcnt(2)
v_add_f32 v227, v227, v236
v_mfma_f32_16x16x32_bf16 v[144:147], v[216:219], v[24:27], v[144:147]
v_cvt_pk_bf16_f32 v172, v236, v237
v_exp_f32 v239, v143
v_mfma_f32_16x16x32_bf16 v[144:147], v[220:223], v[28:31], v[144:147]
v_add_f32 v227, v227, v237
v_add_f32 v227, v227, v238
v_add_f32 v227, v227, v239
v_mfma_f32_16x16x32_bf16 v[148:151], v[216:219], v[56:59], v[148:151]
v_cvt_pk_bf16_f32 v173, v238, v239
v_max3_f32 v242, v224, v225, v226
v_max_f32 v242, v242, v227
v_mfma_f32_16x16x32_bf16 v[148:151], v[220:223], v[60:63], v[148:151]
v_cmp_lt_f32 vcc, s32, v242
s_cbranch_vccnz L2_rare_site8
L2_ret8:
v_mfma_f32_16x16x32_bf16 v[152:155], v[216:219], v[88:91], v[152:155]
buffer_load_dwordx4 v241, s[8:11], s6 offen lds
s_add_u32 m0, s31, 3072
v_mfma_f32_16x16x32_bf16 v[152:155], v[220:223], v[92:95], v[152:155]
buffer_load_dwordx4 v241, s[8:11], s7 offen lds
s_add_u32 m0, s31, 5120
v_mfma_f32_16x16x32_bf16 v[156:159], v[216:219], v[120:123], v[156:159]
ds_read_b128 v[216:219], v230 offset:20480
buffer_load_dwordx4 v241, s[8:11], s29 offen lds
v_mfma_f32_16x16x32_bf16 v[156:159], v[220:223], v[124:127], v[156:159]
ds_read_b128 v[220:223], v230 offset:20992
s_waitcnt lgkmcnt(2)
v_mfma_f32_16x16x32_bf16 v[128:131], v[208:211], v[0:3], v[192:195]
v_mfma_f32_16x16x32_bf16 v[128:131], v[212:215], v[4:7], v[128:131]
v_exp_f32 v232, v144
v_mfma_f32_16x16x32_bf16 v[132:135], v[208:211], v[32:35], v[196:199]
v_exp_f32 v233, v145
v_mfma_f32_16x16x32_bf16 v[132:135], v[212:215], v[36:39], v[132:135]
v_exp_f32 v234, v146
v_add_f32 v224, v224, v232
v_mfma_f32_16x16x32_bf16 v[136:139], v[208:211], v[64:67], v[200:203]
v_cvt_pk_bf16_f32 v162, v232, v233
v_exp_f32 v235, v147
v_mfma_f32_16x16x32_bf16 v[136:139], v[212:215], v[68:71], v[136:139]
v_add_f32 v224, v224, v233
v_add_f32 v224, v224, v234
v_add_f32 v224, v224, v235
v_mfma_f32_16x16x32_bf16 v[140:143], v[208:211], v[96:99], v[204:207]
ds_read_b128 v[208:211], v230 offset:24576
v_cvt_pk_bf16_f32 v163, v234, v235
v_lshlrev_b32 v241, 3, v243
v_mfma_f32_16x16x32_bf16 v[140:143], v[212:215], v[100:103], v[140:143]
ds_read_b128 v[212:215], v230 offset:25088
s_waitcnt lgkmcnt(2)
s_mov_b32 s3, 0x7c28000
v_mfma_f32_16x16x32_bf16 v[128:131], v[216:219], v[8:11], v[128:131]
v_exp_f32 v236, v148
buffer_load_dwordx2 v[240:241], v241, s[16:19], s3 offen sc1
v_mfma_f32_16x16x32_bf16 v[128:131], v[220:223], v[12:15], v[128:131]
v_exp_f32 v237, v149
v_mfma_f32_16x16x32_bf16 v[132:135], v[216:219], v[40:43], v[132:135]
v_exp_f32 v238, v150
v_add_f32 v225, v225, v236
v_mfma_f32_16x16x32_bf16 v[132:135], v[220:223], v[44:47], v[132:135]
v_cvt_pk_bf16_f32 v166, v236, v237
v_exp_f32 v239, v151
v_mfma_f32_16x16x32_bf16 v[136:139], v[216:219], v[72:75], v[136:139]
v_add_f32 v225, v225, v237
v_add_f32 v225, v225, v238
v_add_f32 v225, v225, v239
v_mfma_f32_16x16x32_bf16 v[136:139], v[220:223], v[76:79], v[136:139]
v_cvt_pk_bf16_f32 v167, v238, v239
v_exp_f32 v232, v152
v_mfma_f32_16x16x32_bf16 v[140:143], v[216:219], v[104:107], v[140:143]
ds_read_b128 v[216:219], v230 offset:28672
v_exp_f32 v233, v153
v_mfma_f32_16x16x32_bf16 v[140:143], v[220:223], v[108:111], v[140:143]
ds_read_b128 v[220:223], v230 offset:29184
s_waitcnt lgkmcnt(2)
v_mfma_f32_16x16x32_bf16 v[128:131], v[208:211], v[16:19], v[128:131]
v_exp_f32 v234, v154
v_add_f32 v226, v226, v232
v_mfma_f32_16x16x32_bf16 v[128:131], v[212:215], v[20:23], v[128:131]
v_cvt_pk_bf16_f32 v170, v232, v233
v_exp_f32 v235, v155
v_mfma_f32_16x16x32_bf16 v[132:135], v[208:211], v[48:51], v[132:135]
v_add_f32 v226, v226, v233
v_add_f32 v226, v226, v234
v_add_f32 v226, v226, v235
v_mfma_f32_16x16x32_bf16 v[132:135], v[212:215], v[52:55], v[132:135]
v_cvt_pk_bf16_f32 v171, v234, v235
v_exp_f32 v236, v156
v_mfma_f32_16x16x32_bf16 v[136:139], v[208:211], v[80:83], v[136:139]
v_exp_f32 v237, v157
v_mfma_f32_16x16x32_bf16 v[136:139], v[212:215], v[84:87], v[136:139]
v_exp_f32 v238, v158
v_add_f32 v227, v227, v236
v_mfma_f32_16x16x32_bf16 v[140:143], v[208:211], v[112:115], v[140:143]
ds_read_b128 v[208:211], v230 offset:18432
v_cvt_pk_bf16_f32 v174, v236, v237
v_mfma_f32_16x16x32_bf16 v[140:143], v[212:215], v[116:119], v[140:143]
ds_read_b128 v[212:215], v230 offset:18944
s_waitcnt lgkmcnt(2)
v_mfma_f32_16x16x32_bf16 v[128:131], v[216:219], v[24:27], v[128:131]
v_exp_f32 v239, v159
v_add_f32 v227, v227, v237
v_mfma_f32_16x16x32_bf16 v[128:131], v[220:223], v[28:31], v[128:131]
v_add_f32 v227, v227, v238
v_add_f32 v227, v227, v239
v_cvt_pk_bf16_f32 v175, v238, v239
v_mfma_f32_16x16x32_bf16 v[132:135], v[216:219], v[56:59], v[132:135]
v_max3_f32 v242, v224, v225, v226
v_max_f32 v242, v242, v227
v_cmp_lt_f32 vcc, s32, v242
s_cbranch_vccnz L2_rare_site9
L2_ret9:
v_mfma_f32_16x16x32_bf16 v[132:135], v[220:223], v[60:63], v[132:135]
v_mfma_f32_16x16x32_bf16 v[136:139], v[216:219], v[88:91], v[136:139]
v_mfma_f32_16x16x32_bf16 v[136:139], v[220:223], v[92:95], v[136:139]
v_mfma_f32_16x16x32_bf16 v[140:143], v[216:219], v[120:123], v[140:143]
ds_read_b128 v[216:219], v230 offset:22528
v_mfma_f32_16x16x32_bf16 v[140:143], v[220:223], v[124:127], v[140:143]
ds_read_b128 v[220:223], v230 offset:23040
s_waitcnt lgkmcnt(2)
v_mfma_f32_16x16x32_bf16 v[144:147], v[208:211], v[0:3], v[192:195]
v_mfma_f32_16x16x32_bf16 v[144:147], v[212:215], v[4:7], v[144:147]
v_mfma_f32_16x16x32_bf16 v[148:151], v[208:211], v[32:35], v[196:199]
v_mfma_f32_16x16x32_bf16 v[148:151], v[212:215], v[36:39], v[148:151]
v_mfma_f32_16x16x32_bf16 v[152:155], v[208:211], v[64:67], v[200:203]
v_exp_f32 v232, v128
v_mfma_f32_16x16x32_bf16 v[152:155], v[212:215], v[68:71], v[152:155]
v_exp_f32 v233, v129
v_mfma_f32_16x16x32_bf16 v[156:159], v[208:211], v[96:99], v[204:207]
ds_read_b128 v[208:211], v230 offset:26624
v_exp_f32 v234, v130
v_mfma_f32_16x16x32_bf16 v[156:159], v[212:215], v[100:103], v[156:159]
ds_read_b128 v[212:215], v230 offset:27136
s_waitcnt lgkmcnt(2)
v_add_f32 v224, v224, v232
v_mfma_f32_16x16x32_bf16 v[144:147], v[216:219], v[8:11], v[144:147]
v_cvt_pk_bf16_f32 v0, v232, v233
v_exp_f32 v235, v131
v_mfma_f32_16x16x32_bf16 v[144:147], v[220:223], v[12:15], v[144:147]
ds_read_b128 v[4:7], v231 offset:0
v_add_f32 v224, v224, v233
v_add_f32 v224, v224, v234
v_mfma_f32_16x16x32_bf16 v[148:151], v[216:219], v[40:43], v[148:151]
ds_read_b128 v[36:39], v231 offset:1024
v_add_f32 v224, v224, v235
v_cvt_pk_bf16_f32 v1, v234, v235
v_mfma_f32_16x16x32_bf16 v[148:151], v[220:223], v[44:47], v[148:151]
v_exp_f32 v236, v132
v_mfma_f32_16x16x32_bf16 v[152:155], v[216:219], v[72:75], v[152:155]
v_exp_f32 v237, v133
v_mfma_f32_16x16x32_bf16 v[152:155], v[220:223], v[76:79], v[152:155]
ds_read_b128 v[68:71], v231 offset:2048
ds_read_b128 v[8:11], v231 offset:4096
v_mfma_f32_16x16x32_bf16 v[156:159], v[216:219], v[104:107], v[156:159]
ds_read_b128 v[216:219], v230 offset:30720
v_add_u32 v12, 0x8000, v244
v_and_b32 v12, 0x1ffff, v12
ds_read_b128 v[100:103], v231 offset:3072
ds_read_b128 v[40:43], v231 offset:5120
v_mfma_f32_16x16x32_bf16 v[156:159], v[220:223], v[108:111], v[156:159]
ds_read_b128 v[220:223], v230 offset:31232
s_waitcnt lgkmcnt(2)
v_add_u32 v14, 0x10000, v244
v_and_b32 v14, 0x1ffff, v14
v_mfma_f32_16x16x32_bf16 v[144:147], v[208:211], v[16:19], v[144:147]
v_xor_b32 v13, 32, v12
v_xor_b32 v15, 32, v14
v_mfma_f32_16x16x32_bf16 v[144:147], v[212:215], v[20:23], v[144:147]
ds_read_b128 v[72:75], v231 offset:6144
v_exp_f32 v238, v134
v_mfma_f32_16x16x32_bf16 v[148:151], v[208:211], v[48:51], v[148:151]
ds_read_b128 v[104:107], v231 offset:7168
v_add_f32 v225, v225, v236
v_cvt_pk_bf16_f32 v32, v236, v237
v_mfma_f32_16x16x32_bf16 v[148:151], v[212:215], v[52:55], v[148:151]
v_exp_f32 v239, v135
v_add_f32 v225, v225, v237
v_mfma_f32_16x16x32_bf16 v[152:155], v[208:211], v[80:83], v[152:155]
v_add_f32 v225, v225, v238
v_add_f32 v225, v225, v239
v_cvt_pk_bf16_f32 v33, v238, v239
v_mfma_f32_16x16x32_bf16 v[152:155], v[212:215], v[84:87], v[152:155]
v_exp_f32 v232, v136
v_mfma_f32_16x16x32_bf16 v[156:159], v[208:211], v[112:115], v[156:159]
ds_read_b64_tr_b16 v[208:209], v244 offset:16384
ds_read_b64_tr_b16 v[210:211], v244 offset:18432
v_mfma_f32_16x16x32_bf16 v[156:159], v[212:215], v[116:119], v[156:159]
ds_read_b64_tr_b16 v[212:213], v12 offset:0
s_waitcnt lgkmcnt(3)
v_mfma_f32_16x16x32_bf16 v[144:147], v[216:219], v[24:27], v[144:147]
ds_read_b64_tr_b16 v[214:215], v12 offset:2048
v_exp_f32 v233, v137
v_mfma_f32_16x16x32_bf16 v[144:147], v[220:223], v[28:31], v[144:147]
v_exp_f32 v234, v138
v_add_f32 v226, v226, v232
v_mfma_f32_16x16x32_bf16 v[148:151], v[216:219], v[56:59], v[148:151]
v_cvt_pk_bf16_f32 v64, v232, v233
v_exp_f32 v235, v139
v_mfma_f32_16x16x32_bf16 v[148:151], v[220:223], v[60:63], v[148:151]
v_add_f32 v226, v226, v233
v_add_f32 v226, v226, v234
v_add_f32 v226, v226, v235
v_mfma_f32_16x16x32_bf16 v[152:155], v[216:219], v[88:91], v[152:155]
v_cvt_pk_bf16_f32 v65, v234, v235
v_exp_f32 v236, v140
v_mfma_f32_16x16x32_bf16 v[152:155], v[220:223], v[92:95], v[152:155]
v_exp_f32 v237, v141
s_waitcnt vmcnt(0)
v_mfma_f32_16x16x32_bf16 v[156:159], v[216:219], v[120:123], v[156:159]
ds_read_b64_tr_b16 v[216:217], v12 offset:16384
ds_read_b64_tr_b16 v[218:219], v12 offset:18432
v_cmp_ne_u64_e64 s[38:39], s[98:99], v[240:241]
v_mfma_f32_16x16x32_bf16 v[156:159], v[220:223], v[124:127], v[156:159]
ds_read_b64_tr_b16 v[220:221], v14 offset:0
s_waitcnt lgkmcnt(3)
v_exp_f32 v238, v142
v_add_f32 v227, v227, v236
v_cvt_pk_bf16_f32 v96, v236, v237
v_exp_f32 v239, v143
v_add_f32 v227, v227, v237
v_add_f32 v227, v227, v238
v_add_f32 v227, v227, v239
v_cvt_pk_bf16_f32 v97, v238, v239
v_max3_f32 v242, v224, v225, v226
v_max_f32 v242, v242, v227
v_cmp_lt_f32 vcc, s32, v242
s_cbranch_vccnz L2_rare_site10
L2_ret10:
v_mfma_f32_16x16x32_bf16 a[0:3], v[4:7], v[208:211], a[0:3]
ds_read_b64_tr_b16 v[222:223], v14 offset:2048
s_and_b64 s[38:39], s[38:39], s[96:97]
s_cbranch_scc1 LF_hl_1
LF_hlret_1:
v_mfma_f32_16x16x32_bf16 a[0:3], v[8:11], v[212:215], a[0:3]
v_exp_f32 v232, v144
v_lshrrev_b32 v241, 4, v243
v_mfma_f32_16x16x32_bf16 a[4:7], v[36:39], v[208:211], a[4:7]
v_exp_f32 v233, v145
v_and_b32 v241, 0x30, v241
v_mfma_f32_16x16x32_bf16 a[4:7], v[40:43], v[212:215], a[4:7]
v_exp_f32 v234, v146
v_xor_b32 v241, v241, v243
v_mfma_f32_16x16x32_bf16 a[8:11], v[68:71], v[208:211], a[8:11]
v_add_f32 v224, v224, v232
v_cvt_pk_bf16_f32 v2, v232, v233
v_mfma_f32_16x16x32_bf16 a[8:11], v[72:75], v[212:215], a[8:11]
v_exp_f32 v235, v147
v_mfma_f32_16x16x32_bf16 a[12:15], v[100:103], v[208:211], a[12:15]
ds_read_b64_tr_b16 v[208:209], v245 offset:16384
ds_read_b64_tr_b16 v[210:211], v245 offset:18432
v_mfma_f32_16x16x32_bf16 a[12:15], v[104:107], v[212:215], a[12:15]
ds_read_b64_tr_b16 v[212:213], v13 offset:0
s_waitcnt lgkmcnt(3)
v_mfma_f32_16x16x32_bf16 a[0:3], v[176:179], v[216:219], a[0:3]
ds_read_b64_tr_b16 v[214:215], v13 offset:2048
v_add_f32 v224, v224, v233
v_mfma_f32_16x16x32_bf16 a[0:3], v[160:163], v[220:223], a[0:3]
v_add_f32 v224, v224, v234
v_add_f32 v224, v224, v235
v_mfma_f32_16x16x32_bf16 a[4:7], v[180:183], v[216:219], a[4:7]
v_cvt_pk_bf16_f32 v3, v234, v235
v_and_b32 v228, 0x380, v243
v_mad_u32_u24 v241, v228, 3, v241
v_mfma_f32_16x16x32_bf16 a[4:7], v[164:167], v[220:223], a[4:7]
v_exp_f32 v236, v148
v_add_u32 v241, 0x7000000, v241
v_mfma_f32_16x16x32_bf16 a[8:11], v[184:187], v[216:219], a[8:11]
v_exp_f32 v237, v149
v_and_b32 v110, 0x70, v243
v_mfma_f32_16x16x32_bf16 a[8:11], v[168:171], v[220:223], a[8:11]
v_exp_f32 v238, v150
v_lshlrev_b32 v110, 3, v110
v_mfma_f32_16x16x32_bf16 a[12:15], v[188:191], v[216:219], a[12:15]
ds_read_b64_tr_b16 v[216:217], v13 offset:16384
ds_read_b64_tr_b16 v[218:219], v13 offset:18432
v_add_u32 v110, 0x7c32000, v110
v_mfma_f32_16x16x32_bf16 a[12:15], v[172:175], v[220:223], a[12:15]
ds_read_b64_tr_b16 v[220:221], v15 offset:0
s_waitcnt lgkmcnt(3)
buffer_load_dwordx2 v[108:109], v110, s[16:19], 0 offen sc1
v_mfma_f32_16x16x32_bf16 a[16:19], v[4:7], v[208:211], a[16:19]
ds_read_b64_tr_b16 v[222:223], v15 offset:2048
v_add_f32 v225, v225, v236
v_mfma_f32_16x16x32_bf16 a[16:19], v[8:11], v[212:215], a[16:19]
v_cvt_pk_bf16_f32 v34, v236, v237
s_add_u32 m0, s28, 0
v_mfma_f32_16x16x32_bf16 a[20:23], v[36:39], v[208:211], a[20:23]
v_exp_f32 v239, v151
v_mfma_f32_16x16x32_bf16 a[20:23], v[40:43], v[212:215], a[20:23]
v_add_f32 v225, v225, v237
v_add_f32 v225, v225, v238
v_mfma_f32_16x16x32_bf16 a[24:27], v[68:71], v[208:211], a[24:27]
v_add_f32 v225, v225, v239
v_cvt_pk_bf16_f32 v35, v238, v239
v_mfma_f32_16x16x32_bf16 a[24:27], v[72:75], v[212:215], a[24:27]
v_exp_f32 v232, v152
v_mfma_f32_16x16x32_bf16 a[28:31], v[100:103], v[208:211], a[28:31]
ds_read_b64_tr_b16 v[208:209], v244 offset:16896
ds_read_b64_tr_b16 v[210:211], v244 offset:18944
v_mfma_f32_16x16x32_bf16 a[28:31], v[104:107], v[212:215], a[28:31]
ds_read_b64_tr_b16 v[212:213], v12 offset:512
s_waitcnt lgkmcnt(3)
v_mfma_f32_16x16x32_bf16 a[16:19], v[176:179], v[216:219], a[16:19]
ds_read_b64_tr_b16 v[214:215], v12 offset:2560
buffer_load_dwordx4 v241, s[16:19], s6 offen sc1 lds
s_add_u32 m0, s28, 8192
v_mfma_f32_16x16x32_bf16 a[16:19], v[160:163], v[220:223], a[16:19]
v_exp_f32 v233, v153
v_mfma_f32_16x16x32_bf16 a[20:23], v[180:183], v[216:219], a[20:23]
v_exp_f32 v234, v154
v_mfma_f32_16x16x32_bf16 a[20:23], v[164:167], v[220:223], a[20:23]
v_add_f32 v226, v226, v232
v_cvt_pk_bf16_f32 v66, v232, v233
v_mfma_f32_16x16x32_bf16 a[24:27], v[184:187], v[216:219], a[24:27]
v_exp_f32 v235, v155
v_mfma_f32_16x16x32_bf16 a[24:27], v[168:171], v[220:223], a[24:27]
v_add_f32 v226, v226, v233
v_add_f32 v226, v226, v234
v_mfma_f32_16x16x32_bf16 a[28:31], v[188:191], v[216:219], a[28:31]
ds_read_b64_tr_b16 v[216:217], v12 offset:16896
ds_read_b64_tr_b16 v[218:219], v12 offset:18944
v_mfma_f32_16x16x32_bf16 a[28:31], v[172:175], v[220:223], a[28:31]
ds_read_b64_tr_b16 v[220:221], v14 offset:512
s_waitcnt lgkmcnt(3)
v_mfma_f32_16x16x32_bf16 a[32:35], v[4:7], v[208:211], a[32:35]
ds_read_b64_tr_b16 v[222:223], v14 offset:2560
v_add_f32 v226, v226, v235
v_mfma_f32_16x16x32_bf16 a[32:35], v[8:11], v[212:215], a[32:35]
v_cvt_pk_bf16_f32 v67, v234, v235
buffer_load_dwordx4 v241, s[16:19], s7 offen sc1 lds
s_add_u32 m0, s30, 0
v_mfma_f32_16x16x32_bf16 a[36:39], v[36:39], v[208:211], a[36:39]
v_exp_f32 v236, v156
v_mfma_f32_16x16x32_bf16 a[36:39], v[40:43], v[212:215], a[36:39]
v_exp_f32 v237, v157
v_mfma_f32_16x16x32_bf16 a[40:43], v[68:71], v[208:211], a[40:43]
v_exp_f32 v238, v158
v_mfma_f32_16x16x32_bf16 a[40:43], v[72:75], v[212:215], a[40:43]
v_add_f32 v227, v227, v236
v_cvt_pk_bf16_f32 v98, v236, v237
v_mfma_f32_16x16x32_bf16 a[44:47], v[100:103], v[208:211], a[44:47]
ds_read_b64_tr_b16 v[208:209], v245 offset:16896
ds_read_b64_tr_b16 v[210:211], v245 offset:18944
v_mfma_f32_16x16x32_bf16 a[44:47], v[104:107], v[212:215], a[44:47]
ds_read_b64_tr_b16 v[212:213], v13 offset:512
s_waitcnt lgkmcnt(3)
v_mfma_f32_16x16x32_bf16 a[32:35], v[176:179], v[216:219], a[32:35]
ds_read_b64_tr_b16 v[214:215], v13 offset:2560
buffer_load_dwordx4 v241, s[16:19], s29 offen sc1 lds
s_add_u32 m0, s28, 4096
v_mfma_f32_16x16x32_bf16 a[32:35], v[160:163], v[220:223], a[32:35]
v_exp_f32 v239, v159
v_xor_b32 v241, 0x1040, v241
v_mfma_f32_16x16x32_bf16 a[36:39], v[180:183], v[216:219], a[36:39]
v_add_f32 v227, v227, v237
v_add_f32 v227, v227, v238
v_mfma_f32_16x16x32_bf16 a[36:39], v[164:167], v[220:223], a[36:39]
v_add_f32 v227, v227, v239
v_cvt_pk_bf16_f32 v99, v238, v239
v_mfma_f32_16x16x32_bf16 a[40:43], v[184:187], v[216:219], a[40:43]
v_max3_f32 v242, v224, v225, v226
v_max_f32 v242, v242, v227
v_mfma_f32_16x16x32_bf16 a[40:43], v[168:171], v[220:223], a[40:43]
v_cmp_lt_f32 vcc, s32, v242
s_cbranch_vccnz L2_rare_site11
L2_ret11:
v_mfma_f32_16x16x32_bf16 a[44:47], v[188:191], v[216:219], a[44:47]
ds_read_b64_tr_b16 v[216:217], v13 offset:16896
ds_read_b64_tr_b16 v[218:219], v13 offset:18944
v_mfma_f32_16x16x32_bf16 a[44:47], v[172:175], v[220:223], a[44:47]
ds_read_b64_tr_b16 v[220:221], v15 offset:512
s_waitcnt lgkmcnt(3)
v_mfma_f32_16x16x32_bf16 a[48:51], v[4:7], v[208:211], a[48:51]
ds_read_b64_tr_b16 v[222:223], v15 offset:2560
buffer_load_dwordx4 v241, s[16:19], s6 offen sc1 lds
s_add_u32 m0, s28, 12288
v_mfma_f32_16x16x32_bf16 a[48:51], v[8:11], v[212:215], a[48:51]
buffer_load_dwordx4 v241, s[16:19], s7 offen sc1 lds
s_add_u32 m0, s30, 4096
v_mfma_f32_16x16x32_bf16 a[52:55], v[36:39], v[208:211], a[52:55]
buffer_load_dwordx4 v241, s[16:19], s29 offen sc1 lds
v_mfma_f32_16x16x32_bf16 a[52:55], v[40:43], v[212:215], a[52:55]
v_mfma_f32_16x16x32_bf16 a[56:59], v[68:71], v[208:211], a[56:59]
v_mfma_f32_16x16x32_bf16 a[56:59], v[72:75], v[212:215], a[56:59]
v_mfma_f32_16x16x32_bf16 a[60:63], v[100:103], v[208:211], a[60:63]
ds_read_b64_tr_b16 v[208:209], v14 offset:16384
ds_read_b64_tr_b16 v[210:211], v14 offset:18432
v_mfma_f32_16x16x32_bf16 a[60:63], v[104:107], v[212:215], a[60:63]
ds_read_b64_tr_b16 v[212:213], v15 offset:16384
s_waitcnt lgkmcnt(3)
v_mfma_f32_16x16x32_bf16 a[48:51], v[176:179], v[216:219], a[48:51]
ds_read_b64_tr_b16 v[214:215], v15 offset:18432
v_mfma_f32_16x16x32_bf16 a[48:51], v[160:163], v[220:223], a[48:51]
v_mfma_f32_16x16x32_bf16 a[52:55], v[180:183], v[216:219], a[52:55]
v_mfma_f32_16x16x32_bf16 a[52:55], v[164:167], v[220:223], a[52:55]
v_mfma_f32_16x16x32_bf16 a[56:59], v[184:187], v[216:219], a[56:59]
v_mfma_f32_16x16x32_bf16 a[56:59], v[168:171], v[220:223], a[56:59]
v_mfma_f32_16x16x32_bf16 a[60:63], v[188:191], v[216:219], a[60:63]
ds_read_b64_tr_b16 v[216:217], v14 offset:16896
ds_read_b64_tr_b16 v[218:219], v14 offset:18944
v_mfma_f32_16x16x32_bf16 a[60:63], v[172:175], v[220:223], a[60:63]
ds_read_b64_tr_b16 v[220:221], v15 offset:16896
s_waitcnt lgkmcnt(5)
v_mfma_f32_16x16x32_bf16 a[0:3], v[0:3], v[208:211], a[0:3]
ds_read_b64_tr_b16 v[222:223], v15 offset:18944
v_bfe_u32 v242, v243, 8, 1
v_mul_u32_u24 v242, 48, v242
v_mfma_f32_16x16x32_bf16 a[4:7], v[32:35], v[208:211], a[4:7]
v_lshl_add_u32 v242, s37, 3, v242
v_and_b32 v228, 0xf0, v243
v_lshl_add_u32 v242, v228, 3, v242
v_mfma_f32_16x16x32_bf16 a[8:11], v[64:67], v[208:211], a[8:11]
v_mov_b32 v232, v224
v_mov_b32 v234, v225
v_mov_b32 v236, v226
v_mfma_f32_16x16x32_bf16 a[12:15], v[96:99], v[208:211], a[12:15]
ds_read_b64_tr_b16 v[208:209], v244 offset:20480
s_waitcnt lgkmcnt(5)
v_mov_b32 v238, v227
v_mfma_f32_16x16x32_bf16 a[16:19], v[0:3], v[212:215], a[16:19]
ds_read_b64_tr_b16 v[210:211], v244 offset:22528
v_permlane32_swap_b32 v224, v232
v_permlane32_swap_b32 v225, v234
v_mfma_f32_16x16x32_bf16 a[20:23], v[32:35], v[212:215], a[20:23]
v_permlane32_swap_b32 v226, v236
v_permlane32_swap_b32 v227, v238
v_add_f32 v224, v224, v232
v_mfma_f32_16x16x32_bf16 a[24:27], v[64:67], v[212:215], a[24:27]
v_add_f32 v225, v225, v234
v_add_f32 v226, v226, v236
v_add_f32 v227, v227, v238
v_mfma_f32_16x16x32_bf16 a[28:31], v[96:99], v[212:215], a[28:31]
ds_read_b64_tr_b16 v[212:213], v12 offset:4096
s_waitcnt lgkmcnt(5)
v_mov_b32 v232, v224
v_mfma_f32_16x16x32_bf16 a[32:35], v[0:3], v[216:219], a[32:35]
ds_read_b64_tr_b16 v[214:215], v12 offset:6144
v_mov_b32 v234, v225
v_mov_b32 v236, v226
v_mfma_f32_16x16x32_bf16 a[36:39], v[32:35], v[216:219], a[36:39]
v_mov_b32 v238, v227
v_permlane16_swap_b32 v224, v232
v_permlane16_swap_b32 v225, v234
v_mfma_f32_16x16x32_bf16 a[40:43], v[64:67], v[216:219], a[40:43]
v_permlane16_swap_b32 v226, v236
v_permlane16_swap_b32 v227, v238
v_add_f32 v233, v224, v232
v_mfma_f32_16x16x32_bf16 a[44:47], v[96:99], v[216:219], a[44:47]
ds_read_b64_tr_b16 v[216:217], v12 offset:20480
s_waitcnt lgkmcnt(5)
v_add_f32 v235, v225, v234
v_mfma_f32_16x16x32_bf16 a[48:51], v[0:3], v[220:223], a[48:51]
ds_read_b64_tr_b16 v[218:219], v12 offset:22528
v_add_f32 v237, v226, v236
v_add_f32 v239, v227, v238
v_mfma_f32_16x16x32_bf16 a[52:55], v[32:35], v[220:223], a[52:55]
v_sub_f32 v232, 0, v192
v_sub_f32 v234, 0, v196
v_sub_f32 v236, 0, v200
v_mfma_f32_16x16x32_bf16 a[56:59], v[64:67], v[220:223], a[56:59]
v_sub_f32 v238, 0, v204
v_mfma_f32_16x16x32_bf16 a[60:63], v[96:99], v[220:223], a[60:63]
ds_read_b64_tr_b16 v[220:221], v14 offset:4096
s_waitcnt lgkmcnt(3)
v_mfma_f32_16x16x32_bf16 a[64:67], v[4:7], v[208:211], a[64:67]
ds_read_b64_tr_b16 v[222:223], v14 offset:6144
v_mfma_f32_16x16x32_bf16 a[64:67], v[8:11], v[212:215], a[64:67]
s_mov_b32 exec_hi, 0
buffer_store_dwordx2 v[232:233], v242, s[24:27], s48 offen sc1
s_lshr_b32 s3, s41, 2
buffer_store_dwordx2 v[234:235], v242, s[24:27], s3 offen sc1
s_lshr_b32 s3, s42, 2
buffer_store_dwordx2 v[236:237], v242, s[24:27], s3 offen sc1
s_lshr_b32 s3, s43, 2
buffer_store_dwordx2 v[238:239], v242, s[24:27], s3 offen sc1
s_mov_b32 exec_hi, -1
v_mfma_f32_16x16x32_bf16 a[68:71], v[36:39], v[208:211], a[68:71]
v_accvgpr_read_b32 v128, a0
v_accvgpr_read_b32 v129, a1
v_accvgpr_read_b32 v130, a2
v_mfma_f32_16x16x32_bf16 a[68:71], v[40:43], v[212:215], a[68:71]
v_accvgpr_read_b32 v131, a3
v_cvt_pk_bf16_f32 v16, v128, v129
v_cvt_pk_bf16_f32 v17, v130, v131
v_mfma_f32_16x16x32_bf16 a[72:75], v[68:71], v[208:211], a[72:75]
v_accvgpr_read_b32 v136, a4
v_accvgpr_read_b32 v137, a5
v_accvgpr_read_b32 v138, a6
v_mfma_f32_16x16x32_bf16 a[72:75], v[72:75], v[212:215], a[72:75]
v_accvgpr_read_b32 v139, a7
v_cvt_pk_bf16_f32 v48, v136, v137
v_cvt_pk_bf16_f32 v49, v138, v139
v_mfma_f32_16x16x32_bf16 a[76:79], v[100:103], v[208:211], a[76:79]
ds_read_b64_tr_b16 v[208:209], v14 offset:20480
ds_read_b64_tr_b16 v[210:211], v14 offset:22528
v_accvgpr_read_b32 v144, a8
v_mfma_f32_16x16x32_bf16 a[76:79], v[104:107], v[212:215], a[76:79]
ds_read_b64_tr_b16 v[212:213], v245 offset:20480
s_waitcnt lgkmcnt(3)
v_accvgpr_read_b32 v145, a9
v_mfma_f32_16x16x32_bf16 a[64:67], v[176:179], v[216:219], a[64:67]
ds_read_b64_tr_b16 v[214:215], v245 offset:22528
v_accvgpr_read_b32 v146, a10
v_accvgpr_read_b32 v147, a11
v_mfma_f32_16x16x32_bf16 a[64:67], v[160:163], v[220:223], a[64:67]
v_cvt_pk_bf16_f32 v80, v144, v145
v_cvt_pk_bf16_f32 v81, v146, v147
v_accvgpr_read_b32 v152, a12
v_mfma_f32_16x16x32_bf16 a[68:71], v[180:183], v[216:219], a[68:71]
v_accvgpr_read_b32 v153, a13
v_accvgpr_read_b32 v154, a14
v_accvgpr_read_b32 v155, a15
v_mfma_f32_16x16x32_bf16 a[68:71], v[164:167], v[220:223], a[68:71]
v_cvt_pk_bf16_f32 v112, v152, v153
v_cvt_pk_bf16_f32 v113, v154, v155
v_accvgpr_read_b32 v132, a16
v_mfma_f32_16x16x32_bf16 a[72:75], v[184:187], v[216:219], a[72:75]
v_accvgpr_read_b32 v133, a17
v_accvgpr_read_b32 v134, a18
v_accvgpr_read_b32 v135, a19
v_mfma_f32_16x16x32_bf16 a[72:75], v[168:171], v[220:223], a[72:75]
v_cvt_pk_bf16_f32 v18, v132, v133
v_cvt_pk_bf16_f32 v19, v134, v135
buffer_store_dwordx4 v[16:19], v243, s[20:23], s40 offen offset:0 sc1
v_mfma_f32_16x16x32_bf16 a[76:79], v[188:191], v[216:219], a[76:79]
ds_read_b64_tr_b16 v[216:217], v13 offset:4096
ds_read_b64_tr_b16 v[218:219], v13 offset:6144
ds_write_b128 v231, v[16:19] offset:0
v_mfma_f32_16x16x32_bf16 a[76:79], v[172:175], v[220:223], a[76:79]
ds_read_b64_tr_b16 v[220:221], v13 offset:20480
s_waitcnt lgkmcnt(5)
v_accvgpr_read_b32 v140, a20
v_mfma_f32_16x16x32_bf16 a[64:67], v[0:3], v[208:211], a[64:67]
ds_read_b64_tr_b16 v[222:223], v13 offset:22528
v_accvgpr_read_b32 v141, a21
v_accvgpr_read_b32 v142, a22
v_mfma_f32_16x16x32_bf16 a[68:71], v[32:35], v[208:211], a[68:71]
v_accvgpr_read_b32 v143, a23
v_cvt_pk_bf16_f32 v50, v140, v141
v_cvt_pk_bf16_f32 v51, v142, v143
v_mfma_f32_16x16x32_bf16 a[72:75], v[64:67], v[208:211], a[72:75]
buffer_store_dwordx4 v[48:51], v243, s[20:23], s41 offen offset:0 sc1
v_accvgpr_read_b32 v148, a24
v_accvgpr_read_b32 v149, a25
v_mfma_f32_16x16x32_bf16 a[76:79], v[96:99], v[208:211], a[76:79]
ds_read_b64_tr_b16 v[208:209], v15 offset:4096
s_waitcnt lgkmcnt(5)
v_accvgpr_read_b32 v150, a26
v_mfma_f32_16x16x32_bf16 a[80:83], v[4:7], v[212:215], a[80:83]
ds_read_b64_tr_b16 v[210:211], v15 offset:6144
v_accvgpr_read_b32 v151, a27
v_cvt_pk_bf16_f32 v82, v148, v149
v_mfma_f32_16x16x32_bf16 a[84:87], v[36:39], v[212:215], a[84:87]
v_cvt_pk_bf16_f32 v83, v150, v151
buffer_store_dwordx4 v[80:83], v243, s[20:23], s42 offen offset:0 sc1
v_accvgpr_read_b32 v156, a28
v_mfma_f32_16x16x32_bf16 a[88:91], v[68:71], v[212:215], a[88:91]
v_accvgpr_read_b32 v157, a29
v_accvgpr_read_b32 v158, a30
v_accvgpr_read_b32 v159, a31
v_mfma_f32_16x16x32_bf16 a[92:95], v[100:103], v[212:215], a[92:95]
ds_read_b64_tr_b16 v[212:213], v15 offset:20480
s_waitcnt lgkmcnt(3)
v_cvt_pk_bf16_f32 v114, v156, v157
v_mfma_f32_16x16x32_bf16 a[80:83], v[8:11], v[216:219], a[80:83]
ds_read_b64_tr_b16 v[214:215], v15 offset:22528
v_cvt_pk_bf16_f32 v115, v158, v159
buffer_store_dwordx4 v[112:115], v243, s[20:23], s43 offen offset:0 sc1
v_mfma_f32_16x16x32_bf16 a[80:83], v[176:179], v[220:223], a[80:83]
v_accvgpr_read_b32 v128, a32
v_accvgpr_read_b32 v129, a33
v_accvgpr_read_b32 v130, a34
v_mfma_f32_16x16x32_bf16 a[84:87], v[40:43], v[216:219], a[84:87]
v_accvgpr_read_b32 v131, a35
v_cvt_pk_bf16_f32 v20, v128, v129
v_cvt_pk_bf16_f32 v21, v130, v131
v_mfma_f32_16x16x32_bf16 a[84:87], v[180:183], v[220:223], a[84:87]
v_accvgpr_read_b32 v136, a36
v_accvgpr_read_b32 v137, a37
v_accvgpr_read_b32 v138, a38
v_mfma_f32_16x16x32_bf16 a[88:91], v[72:75], v[216:219], a[88:91]
v_accvgpr_read_b32 v139, a39
v_cvt_pk_bf16_f32 v52, v136, v137
v_cvt_pk_bf16_f32 v53, v138, v139
v_mfma_f32_16x16x32_bf16 a[88:91], v[184:187], v[220:223], a[88:91]
v_accvgpr_read_b32 v144, a40
v_accvgpr_read_b32 v145, a41
v_accvgpr_read_b32 v146, a42
v_mfma_f32_16x16x32_bf16 a[92:95], v[104:107], v[216:219], a[92:95]
ds_read_b64_tr_b16 v[216:217], v244 offset:20992
ds_read_b64_tr_b16 v[218:219], v244 offset:23040
v_accvgpr_read_b32 v147, a43
v_mfma_f32_16x16x32_bf16 a[92:95], v[188:191], v[220:223], a[92:95]
ds_read_b64_tr_b16 v[220:221], v12 offset:4608
s_waitcnt lgkmcnt(3)
v_cvt_pk_bf16_f32 v84, v144, v145
v_mfma_f32_16x16x32_bf16 a[80:83], v[160:163], v[208:211], a[80:83]
ds_read_b64_tr_b16 v[222:223], v12 offset:6656
v_cvt_pk_bf16_f32 v85, v146, v147
v_accvgpr_read_b32 v152, a44
v_mfma_f32_16x16x32_bf16 a[80:83], v[0:3], v[212:215], a[80:83]
v_accvgpr_read_b32 v153, a45
v_accvgpr_read_b32 v154, a46
v_accvgpr_read_b32 v155, a47
v_mfma_f32_16x16x32_bf16 a[84:87], v[164:167], v[208:211], a[84:87]
v_cvt_pk_bf16_f32 v116, v152, v153
v_cvt_pk_bf16_f32 v117, v154, v155
v_accvgpr_read_b32 v132, a48
v_mfma_f32_16x16x32_bf16 a[84:87], v[32:35], v[212:215], a[84:87]
v_accvgpr_read_b32 v133, a49
v_accvgpr_read_b32 v134, a50
v_accvgpr_read_b32 v135, a51
v_mfma_f32_16x16x32_bf16 a[88:91], v[168:171], v[208:211], a[88:91]
v_cvt_pk_bf16_f32 v22, v132, v133
v_cvt_pk_bf16_f32 v23, v134, v135
buffer_store_dwordx4 v[20:23], v243, s[20:23], s40 offen offset:1024 sc1
v_mfma_f32_16x16x32_bf16 a[88:91], v[64:67], v[212:215], a[88:91]
ds_write_b128 v231, v[20:23] offset:1024
v_accvgpr_read_b32 v140, a52
v_accvgpr_read_b32 v141, a53
v_mfma_f32_16x16x32_bf16 a[92:95], v[172:175], v[208:211], a[92:95]
ds_read_b64_tr_b16 v[208:209], v12 offset:20992
ds_read_b64_tr_b16 v[210:211], v12 offset:23040
v_accvgpr_read_b32 v142, a54
v_mfma_f32_16x16x32_bf16 a[92:95], v[96:99], v[212:215], a[92:95]
ds_read_b64_tr_b16 v[212:213], v14 offset:4608
s_waitcnt lgkmcnt(3)
v_accvgpr_read_b32 v143, a55
v_mfma_f32_16x16x32_bf16 a[96:99], v[4:7], v[216:219], a[96:99]
ds_read_b64_tr_b16 v[214:215], v14 offset:6656
v_cvt_pk_bf16_f32 v54, v140, v141
v_cvt_pk_bf16_f32 v55, v142, v143
v_mfma_f32_16x16x32_bf16 a[96:99], v[8:11], v[220:223], a[96:99]
buffer_store_dwordx4 v[52:55], v243, s[20:23], s41 offen offset:1024 sc1
v_accvgpr_read_b32 v148, a56
v_accvgpr_read_b32 v149, a57
v_mfma_f32_16x16x32_bf16 a[100:103], v[36:39], v[216:219], a[100:103]
v_accvgpr_read_b32 v150, a58
v_accvgpr_read_b32 v151, a59
v_cvt_pk_bf16_f32 v86, v148, v149
v_mfma_f32_16x16x32_bf16 a[100:103], v[40:43], v[220:223], a[100:103]
v_cvt_pk_bf16_f32 v87, v150, v151
buffer_store_dwordx4 v[84:87], v243, s[20:23], s42 offen offset:1024 sc1
v_accvgpr_read_b32 v156, a60
v_mfma_f32_16x16x32_bf16 a[104:107], v[68:71], v[216:219], a[104:107]
v_accvgpr_read_b32 v157, a61
v_accvgpr_read_b32 v158, a62
v_accvgpr_read_b32 v159, a63
v_mfma_f32_16x16x32_bf16 a[104:107], v[72:75], v[220:223], a[104:107]
v_cvt_pk_bf16_f32 v118, v156, v157
v_cvt_pk_bf16_f32 v119, v158, v159
buffer_store_dwordx4 v[116:119], v243, s[20:23], s43 offen offset:1024 sc1
v_mfma_f32_16x16x32_bf16 a[108:111], v[100:103], v[216:219], a[108:111]
ds_read_b64_tr_b16 v[216:217], v14 offset:20992
ds_read_b64_tr_b16 v[218:219], v14 offset:23040
v_accvgpr_read_b32 v128, a64
v_mfma_f32_16x16x32_bf16 a[108:111], v[104:107], v[220:223], a[108:111]
ds_read_b64_tr_b16 v[220:221], v245 offset:20992
s_waitcnt lgkmcnt(3)
v_accvgpr_read_b32 v129, a65
v_mfma_f32_16x16x32_bf16 a[96:99], v[176:179], v[208:211], a[96:99]
ds_read_b64_tr_b16 v[222:223], v245 offset:23040
v_accvgpr_read_b32 v130, a66
v_accvgpr_read_b32 v131, a67
v_mfma_f32_16x16x32_bf16 a[96:99], v[160:163], v[212:215], a[96:99]
v_cvt_pk_bf16_f32 v24, v128, v129
v_cvt_pk_bf16_f32 v25, v130, v131
v_accvgpr_read_b32 v136, a68
v_mfma_f32_16x16x32_bf16 a[100:103], v[180:183], v[208:211], a[100:103]
v_accvgpr_read_b32 v137, a69
v_accvgpr_read_b32 v138, a70
v_accvgpr_read_b32 v139, a71
v_mfma_f32_16x16x32_bf16 a[100:103], v[164:167], v[212:215], a[100:103]
v_cvt_pk_bf16_f32 v56, v136, v137
v_cvt_pk_bf16_f32 v57, v138, v139
v_accvgpr_read_b32 v144, a72
v_mfma_f32_16x16x32_bf16 a[104:107], v[184:187], v[208:211], a[104:107]
v_accvgpr_read_b32 v145, a73
v_accvgpr_read_b32 v146, a74
v_accvgpr_read_b32 v147, a75
v_mfma_f32_16x16x32_bf16 a[104:107], v[168:171], v[212:215], a[104:107]
v_cvt_pk_bf16_f32 v88, v144, v145
v_cvt_pk_bf16_f32 v89, v146, v147
v_accvgpr_read_b32 v152, a76
v_mfma_f32_16x16x32_bf16 a[108:111], v[188:191], v[208:211], a[108:111]
ds_read_b64_tr_b16 v[208:209], v13 offset:4608
ds_read_b64_tr_b16 v[210:211], v13 offset:6656
v_accvgpr_read_b32 v153, a77
v_mfma_f32_16x16x32_bf16 a[108:111], v[172:175], v[212:215], a[108:111]
ds_read_b64_tr_b16 v[212:213], v13 offset:20992
s_waitcnt lgkmcnt(5)
v_accvgpr_read_b32 v154, a78
v_mfma_f32_16x16x32_bf16 a[96:99], v[0:3], v[216:219], a[96:99]
ds_read_b64_tr_b16 v[214:215], v13 offset:23040
v_accvgpr_read_b32 v155, a79
v_cvt_pk_bf16_f32 v120, v152, v153
v_mfma_f32_16x16x32_bf16 a[100:103], v[32:35], v[216:219], a[100:103]
v_cvt_pk_bf16_f32 v121, v154, v155
v_accvgpr_read_b32 v132, a80
v_accvgpr_read_b32 v133, a81
v_mfma_f32_16x16x32_bf16 a[104:107], v[64:67], v[216:219], a[104:107]
v_accvgpr_read_b32 v134, a82
v_accvgpr_read_b32 v135, a83
v_cvt_pk_bf16_f32 v26, v132, v133
v_mfma_f32_16x16x32_bf16 a[108:111], v[96:99], v[216:219], a[108:111]
ds_read_b64_tr_b16 v[216:217], v15 offset:4608
s_waitcnt lgkmcnt(5)
v_cvt_pk_bf16_f32 v27, v134, v135
v_mfma_f32_16x16x32_bf16 a[112:115], v[4:7], v[220:223], a[112:115]
ds_read_b64_tr_b16 v[218:219], v15 offset:6656
buffer_store_dwordx4 v[24:27], v243, s[20:23], s40 offen offset:2048 sc1
ds_write_b128 v231, v[24:27] offset:2048
v_mfma_f32_16x16x32_bf16 a[116:119], v[36:39], v[220:223], a[116:119]
v_accvgpr_read_b32 v140, a84
v_accvgpr_read_b32 v141, a85
v_accvgpr_read_b32 v142, a86
v_mfma_f32_16x16x32_bf16 a[120:123], v[68:71], v[220:223], a[120:123]
v_accvgpr_read_b32 v143, a87
v_cvt_pk_bf16_f32 v58, v140, v141
v_cvt_pk_bf16_f32 v59, v142, v143
v_mfma_f32_16x16x32_bf16 a[124:127], v[100:103], v[220:223], a[124:127]
ds_read_b64_tr_b16 v[220:221], v15 offset:20992
s_waitcnt lgkmcnt(3)
buffer_store_dwordx4 v[56:59], v243, s[20:23], s41 offen offset:2048 sc1
v_mfma_f32_16x16x32_bf16 a[112:115], v[8:11], v[208:211], a[112:115]
ds_read_b64_tr_b16 v[222:223], v15 offset:23040
v_accvgpr_read_b32 v148, a88
v_accvgpr_read_b32 v149, a89
v_mfma_f32_16x16x32_bf16 a[112:115], v[176:179], v[212:215], a[112:115]
v_accvgpr_read_b32 v150, a90
v_accvgpr_read_b32 v151, a91
v_cvt_pk_bf16_f32 v90, v148, v149
v_mfma_f32_16x16x32_bf16 a[116:119], v[40:43], v[208:211], a[116:119]
v_cvt_pk_bf16_f32 v91, v150, v151
buffer_store_dwordx4 v[88:91], v243, s[20:23], s42 offen offset:2048 sc1
v_accvgpr_read_b32 v156, a92
v_mfma_f32_16x16x32_bf16 a[116:119], v[180:183], v[212:215], a[116:119]
v_accvgpr_read_b32 v157, a93
v_accvgpr_read_b32 v158, a94
v_accvgpr_read_b32 v159, a95
v_mfma_f32_16x16x32_bf16 a[120:123], v[72:75], v[208:211], a[120:123]
v_cvt_pk_bf16_f32 v122, v156, v157
v_cvt_pk_bf16_f32 v123, v158, v159
buffer_store_dwordx4 v[120:123], v243, s[20:23], s43 offen offset:2048 sc1
v_mfma_f32_16x16x32_bf16 a[120:123], v[184:187], v[212:215], a[120:123]
v_accvgpr_read_b32 v128, a96
v_accvgpr_read_b32 v129, a97
v_mfma_f32_16x16x32_bf16 a[124:127], v[104:107], v[208:211], a[124:127]
ds_read_b64_tr_b16 v[208:209], v12 offset:8192
ds_read_b64_tr_b16 v[210:211], v12 offset:10240
v_mfma_f32_16x16x32_bf16 a[124:127], v[188:191], v[212:215], a[124:127]
ds_read_b64_tr_b16 v[212:213], v12 offset:24576
s_waitcnt lgkmcnt(3)
v_mfma_f32_16x16x32_bf16 a[112:115], v[160:163], v[216:219], a[112:115]
ds_read_b64_tr_b16 v[214:215], v12 offset:26624
v_accvgpr_read_b32 v130, a98
v_mfma_f32_16x16x32_bf16 a[112:115], v[0:3], v[220:223], a[112:115]
v_accvgpr_read_b32 v131, a99
v_cvt_pk_bf16_f32 v28, v128, v129
v_mfma_f32_16x16x32_bf16 a[116:119], v[164:167], v[216:219], a[116:119]
v_cvt_pk_bf16_f32 v29, v130, v131
v_accvgpr_read_b32 v136, a100
v_mfma_f32_16x16x32_bf16 a[116:119], v[32:35], v[220:223], a[116:119]
v_accvgpr_read_b32 v137, a101
v_accvgpr_read_b32 v138, a102
v_mfma_f32_16x16x32_bf16 a[120:123], v[168:171], v[216:219], a[120:123]
v_accvgpr_read_b32 v139, a103
v_cvt_pk_bf16_f32 v60, v136, v137
v_mfma_f32_16x16x32_bf16 a[120:123], v[64:67], v[220:223], a[120:123]
v_cvt_pk_bf16_f32 v61, v138, v139
v_accvgpr_read_b32 v144, a104
v_mfma_f32_16x16x32_bf16 a[124:127], v[172:175], v[216:219], a[124:127]
ds_read_b64_tr_b16 v[216:217], v14 offset:8192
ds_read_b64_tr_b16 v[218:219], v14 offset:10240
v_mfma_f32_16x16x32_bf16 a[124:127], v[96:99], v[220:223], a[124:127]
ds_read_b64_tr_b16 v[220:221], v14 offset:24576
s_waitcnt lgkmcnt(3)
v_mfma_f32_16x16x32_bf16 a[128:131], v[8:11], v[208:211], a[128:131]
ds_read_b64_tr_b16 v[222:223], v14 offset:26624
v_accvgpr_read_b32 v145, a105
v_mfma_f32_16x16x32_bf16 a[128:131], v[176:179], v[212:215], a[128:131]
v_accvgpr_read_b32 v146, a106
v_accvgpr_read_b32 v147, a107
v_mfma_f32_16x16x32_bf16 a[132:135], v[40:43], v[208:211], a[132:135]
v_cvt_pk_bf16_f32 v92, v144, v145
v_cvt_pk_bf16_f32 v93, v146, v147
v_mfma_f32_16x16x32_bf16 a[132:135], v[180:183], v[212:215], a[132:135]
v_accvgpr_read_b32 v152, a108
v_accvgpr_read_b32 v153, a109
v_mfma_f32_16x16x32_bf16 a[136:139], v[72:75], v[208:211], a[136:139]
v_accvgpr_read_b32 v154, a110
v_accvgpr_read_b32 v155, a111
v_mfma_f32_16x16x32_bf16 a[136:139], v[184:187], v[212:215], a[136:139]
v_cvt_pk_bf16_f32 v124, v152, v153
v_cvt_pk_bf16_f32 v125, v154, v155
v_mfma_f32_16x16x32_bf16 a[140:143], v[104:107], v[208:211], a[140:143]
ds_read_b64_tr_b16 v[208:209], v13 offset:8192
ds_read_b64_tr_b16 v[210:211], v13 offset:10240
v_mfma_f32_16x16x32_bf16 a[140:143], v[188:191], v[212:215], a[140:143]
ds_read_b64_tr_b16 v[212:213], v13 offset:24576
s_waitcnt lgkmcnt(3)
v_mfma_f32_16x16x32_bf16 a[128:131], v[160:163], v[216:219], a[128:131]
ds_read_b64_tr_b16 v[214:215], v13 offset:26624
v_accvgpr_read_b32 v132, a112
v_mfma_f32_16x16x32_bf16 a[128:131], v[0:3], v[220:223], a[128:131]
v_accvgpr_read_b32 v133, a113
v_accvgpr_read_b32 v134, a114
v_mfma_f32_16x16x32_bf16 a[132:135], v[164:167], v[216:219], a[132:135]
v_accvgpr_read_b32 v135, a115
v_cvt_pk_bf16_f32 v30, v132, v133
v_mfma_f32_16x16x32_bf16 a[132:135], v[32:35], v[220:223], a[132:135]
v_cvt_pk_bf16_f32 v31, v134, v135
buffer_store_dwordx4 v[28:31], v243, s[20:23], s40 offen offset:3072 sc1
v_mfma_f32_16x16x32_bf16 a[136:139], v[168:171], v[216:219], a[136:139]
ds_write_b128 v231, v[28:31] offset:3072
v_accvgpr_read_b32 v140, a116
v_mfma_f32_16x16x32_bf16 a[136:139], v[64:67], v[220:223], a[136:139]
v_accvgpr_read_b32 v141, a117
v_accvgpr_read_b32 v142, a118
v_mfma_f32_16x16x32_bf16 a[140:143], v[172:175], v[216:219], a[140:143]
ds_read_b64_tr_b16 v[216:217], v15 offset:8192
ds_read_b64_tr_b16 v[218:219], v15 offset:10240
v_mfma_f32_16x16x32_bf16 a[140:143], v[96:99], v[220:223], a[140:143]
ds_read_b64_tr_b16 v[220:221], v15 offset:24576
s_waitcnt lgkmcnt(3)
v_mfma_f32_16x16x32_bf16 a[144:147], v[8:11], v[208:211], a[144:147]
ds_read_b64_tr_b16 v[222:223], v15 offset:26624
v_accvgpr_read_b32 v143, a119
v_mfma_f32_16x16x32_bf16 a[144:147], v[176:179], v[212:215], a[144:147]
v_cvt_pk_bf16_f32 v62, v140, v141
v_cvt_pk_bf16_f32 v63, v142, v143
v_mfma_f32_16x16x32_bf16 a[148:151], v[40:43], v[208:211], a[148:151]
buffer_store_dwordx4 v[60:63], v243, s[20:23], s41 offen offset:3072 sc1
v_accvgpr_read_b32 v148, a120
v_mfma_f32_16x16x32_bf16 a[148:151], v[180:183], v[212:215], a[148:151]
v_accvgpr_read_b32 v149, a121
v_accvgpr_read_b32 v150, a122
v_mfma_f32_16x16x32_bf16 a[152:155], v[72:75], v[208:211], a[152:155]
v_accvgpr_read_b32 v151, a123
v_cvt_pk_bf16_f32 v94, v148, v149
v_mfma_f32_16x16x32_bf16 a[152:155], v[184:187], v[212:215], a[152:155]
v_cvt_pk_bf16_f32 v95, v150, v151
buffer_store_dwordx4 v[92:95], v243, s[20:23], s42 offen offset:3072 sc1
v_mfma_f32_16x16x32_bf16 a[156:159], v[104:107], v[208:211], a[156:159]
ds_read_b64_tr_b16 v[208:209], v12 offset:8704
ds_read_b64_tr_b16 v[210:211], v12 offset:10752
v_mfma_f32_16x16x32_bf16 a[156:159], v[188:191], v[212:215], a[156:159]
ds_read_b64_tr_b16 v[212:213], v12 offset:25088
s_waitcnt lgkmcnt(3)
v_mfma_f32_16x16x32_bf16 a[144:147], v[160:163], v[216:219], a[144:147]
ds_read_b64_tr_b16 v[214:215], v12 offset:27136
v_accvgpr_read_b32 v156, a124
v_mfma_f32_16x16x32_bf16 a[144:147], v[0:3], v[220:223], a[144:147]
v_accvgpr_read_b32 v157, a125
v_accvgpr_read_b32 v158, a126
v_mfma_f32_16x16x32_bf16 a[148:151], v[164:167], v[216:219], a[148:151]
v_accvgpr_read_b32 v159, a127
v_cvt_pk_bf16_f32 v126, v156, v157
v_mfma_f32_16x16x32_bf16 a[148:151], v[32:35], v[220:223], a[148:151]
v_cvt_pk_bf16_f32 v127, v158, v159
buffer_store_dwordx4 v[124:127], v243, s[20:23], s43 offen offset:3072 sc1
v_mfma_f32_16x16x32_bf16 a[152:155], v[168:171], v[216:219], a[152:155]
v_accvgpr_read_b32 v128, a128
v_accvgpr_read_b32 v129, a129
v_mfma_f32_16x16x32_bf16 a[152:155], v[64:67], v[220:223], a[152:155]
v_accvgpr_read_b32 v130, a130
v_accvgpr_read_b32 v131, a131
v_mfma_f32_16x16x32_bf16 a[156:159], v[172:175], v[216:219], a[156:159]
ds_read_b64_tr_b16 v[216:217], v14 offset:8704
ds_read_b64_tr_b16 v[218:219], v14 offset:10752
v_mfma_f32_16x16x32_bf16 a[156:159], v[96:99], v[220:223], a[156:159]
ds_read_b64_tr_b16 v[220:221], v14 offset:25088
s_waitcnt lgkmcnt(3)
v_mfma_f32_16x16x32_bf16 a[160:163], v[8:11], v[208:211], a[160:163]
ds_read_b64_tr_b16 v[222:223], v14 offset:27136
v_cvt_pk_bf16_f32 v16, v128, v129
v_mfma_f32_16x16x32_bf16 a[160:163], v[176:179], v[212:215], a[160:163]
v_cvt_pk_bf16_f32 v17, v130, v131
v_accvgpr_read_b32 v136, a132
v_mfma_f32_16x16x32_bf16 a[164:167], v[40:43], v[208:211], a[164:167]
v_accvgpr_read_b32 v137, a133
v_accvgpr_read_b32 v138, a134
v_mfma_f32_16x16x32_bf16 a[164:167], v[180:183], v[212:215], a[164:167]
v_accvgpr_read_b32 v139, a135
v_cvt_pk_bf16_f32 v48, v136, v137
v_mfma_f32_16x16x32_bf16 a[168:171], v[72:75], v[208:211], a[168:171]
v_cvt_pk_bf16_f32 v49, v138, v139
v_accvgpr_read_b32 v144, a136
v_mfma_f32_16x16x32_bf16 a[168:171], v[184:187], v[212:215], a[168:171]
v_accvgpr_read_b32 v145, a137
v_accvgpr_read_b32 v146, a138
v_mfma_f32_16x16x32_bf16 a[172:175], v[104:107], v[208:211], a[172:175]
ds_read_b64_tr_b16 v[208:209], v13 offset:8704
ds_read_b64_tr_b16 v[210:211], v13 offset:10752
v_mfma_f32_16x16x32_bf16 a[172:175], v[188:191], v[212:215], a[172:175]
ds_read_b64_tr_b16 v[212:213], v13 offset:25088
s_waitcnt lgkmcnt(3)
v_mfma_f32_16x16x32_bf16 a[160:163], v[160:163], v[216:219], a[160:163]
ds_read_b64_tr_b16 v[214:215], v13 offset:27136
v_accvgpr_read_b32 v147, a139
v_mfma_f32_16x16x32_bf16 a[160:163], v[0:3], v[220:223], a[160:163]
v_cvt_pk_bf16_f32 v80, v144, v145
v_cvt_pk_bf16_f32 v81, v146, v147
v_mfma_f32_16x16x32_bf16 a[164:167], v[164:167], v[216:219], a[164:167]
v_accvgpr_read_b32 v152, a140
v_accvgpr_read_b32 v153, a141
v_mfma_f32_16x16x32_bf16 a[164:167], v[32:35], v[220:223], a[164:167]
v_accvgpr_read_b32 v154, a142
v_accvgpr_read_b32 v155, a143
v_mfma_f32_16x16x32_bf16 a[168:171], v[168:171], v[216:219], a[168:171]
v_cvt_pk_bf16_f32 v112, v152, v153
v_cvt_pk_bf16_f32 v113, v154, v155
v_mfma_f32_16x16x32_bf16 a[168:171], v[64:67], v[220:223], a[168:171]
v_accvgpr_read_b32 v132, a144
v_accvgpr_read_b32 v133, a145
v_mfma_f32_16x16x32_bf16 a[172:175], v[172:175], v[216:219], a[172:175]
ds_read_b64_tr_b16 v[216:217], v15 offset:8704
ds_read_b64_tr_b16 v[218:219], v15 offset:10752
v_mfma_f32_16x16x32_bf16 a[172:175], v[96:99], v[220:223], a[172:175]
ds_read_b64_tr_b16 v[220:221], v15 offset:25088
s_waitcnt lgkmcnt(3)
v_mfma_f32_16x16x32_bf16 a[176:179], v[8:11], v[208:211], a[176:179]
ds_read_b64_tr_b16 v[222:223], v15 offset:27136
v_accvgpr_read_b32 v134, a146
v_mfma_f32_16x16x32_bf16 a[176:179], v[176:179], v[212:215], a[176:179]
v_accvgpr_read_b32 v135, a147
v_cvt_pk_bf16_f32 v18, v132, v133
v_mfma_f32_16x16x32_bf16 a[180:183], v[40:43], v[208:211], a[180:183]
v_cvt_pk_bf16_f32 v19, v134, v135
buffer_store_dwordx4 v[16:19], v243, s[20:23], s44 offen offset:0 sc1
v_mfma_f32_16x16x32_bf16 a[180:183], v[180:183], v[212:215], a[180:183]
ds_write_b128 v231, v[16:19] offset:4096
v_accvgpr_read_b32 v140, a148
v_mfma_f32_16x16x32_bf16 a[184:187], v[72:75], v[208:211], a[184:187]
v_accvgpr_read_b32 v141, a149
v_accvgpr_read_b32 v142, a150
v_mfma_f32_16x16x32_bf16 a[184:187], v[184:187], v[212:215], a[184:187]
v_accvgpr_read_b32 v143, a151
v_cvt_pk_bf16_f32 v50, v140, v141
v_mfma_f32_16x16x32_bf16 a[188:191], v[104:107], v[208:211], a[188:191]
ds_read_b64_tr_b16 v[208:209], v12 offset:12288
ds_read_b64_tr_b16 v[210:211], v12 offset:14336
v_mfma_f32_16x16x32_bf16 a[188:191], v[188:191], v[212:215], a[188:191]
ds_read_b64_tr_b16 v[212:213], v12 offset:28672
s_waitcnt lgkmcnt(3)
v_mfma_f32_16x16x32_bf16 a[176:179], v[160:163], v[216:219], a[176:179]
ds_read_b64_tr_b16 v[214:215], v12 offset:30720
v_cvt_pk_bf16_f32 v51, v142, v143
v_mfma_f32_16x16x32_bf16 a[176:179], v[0:3], v[220:223], a[176:179]
buffer_store_dwordx4 v[48:51], v243, s[20:23], s45 offen offset:0 sc1
v_accvgpr_read_b32 v148, a152
v_mfma_f32_16x16x32_bf16 a[180:183], v[164:167], v[216:219], a[180:183]
v_accvgpr_read_b32 v149, a153
v_accvgpr_read_b32 v150, a154
v_mfma_f32_16x16x32_bf16 a[180:183], v[32:35], v[220:223], a[180:183]
v_accvgpr_read_b32 v151, a155
v_cvt_pk_bf16_f32 v82, v148, v149
v_mfma_f32_16x16x32_bf16 a[184:187], v[168:171], v[216:219], a[184:187]
v_cvt_pk_bf16_f32 v83, v150, v151
buffer_store_dwordx4 v[80:83], v243, s[20:23], s46 offen offset:0 sc1
v_mfma_f32_16x16x32_bf16 a[184:187], v[64:67], v[220:223], a[184:187]
v_accvgpr_read_b32 v156, a156
v_accvgpr_read_b32 v157, a157
v_mfma_f32_16x16x32_bf16 a[188:191], v[172:175], v[216:219], a[188:191]
ds_read_b64_tr_b16 v[216:217], v14 offset:12288
ds_read_b64_tr_b16 v[218:219], v14 offset:14336
v_mfma_f32_16x16x32_bf16 a[188:191], v[96:99], v[220:223], a[188:191]
ds_read_b64_tr_b16 v[220:221], v14 offset:28672
s_waitcnt lgkmcnt(3)
v_mfma_f32_16x16x32_bf16 a[192:195], v[8:11], v[208:211], a[192:195]
ds_read_b64_tr_b16 v[222:223], v14 offset:30720
v_accvgpr_read_b32 v158, a158
v_mfma_f32_16x16x32_bf16 a[192:195], v[176:179], v[212:215], a[192:195]
v_accvgpr_read_b32 v159, a159
v_cvt_pk_bf16_f32 v114, v156, v157
v_mfma_f32_16x16x32_bf16 a[196:199], v[40:43], v[208:211], a[196:199]
v_cvt_pk_bf16_f32 v115, v158, v159
buffer_store_dwordx4 v[112:115], v243, s[20:23], s47 offen offset:0 sc1
v_mfma_f32_16x16x32_bf16 a[196:199], v[180:183], v[212:215], a[196:199]
v_accvgpr_read_b32 v128, a160
v_accvgpr_read_b32 v129, a161
v_mfma_f32_16x16x32_bf16 a[200:203], v[72:75], v[208:211], a[200:203]
v_accvgpr_read_b32 v130, a162
v_accvgpr_read_b32 v131, a163
v_mfma_f32_16x16x32_bf16 a[200:203], v[184:187], v[212:215], a[200:203]
v_cvt_pk_bf16_f32 v20, v128, v129
v_cvt_pk_bf16_f32 v21, v130, v131
v_mfma_f32_16x16x32_bf16 a[204:207], v[104:107], v[208:211], a[204:207]
ds_read_b64_tr_b16 v[208:209], v13 offset:12288
ds_read_b64_tr_b16 v[210:211], v13 offset:14336
v_mfma_f32_16x16x32_bf16 a[204:207], v[188:191], v[212:215], a[204:207]
ds_read_b64_tr_b16 v[212:213], v13 offset:28672
s_waitcnt lgkmcnt(3)
v_mfma_f32_16x16x32_bf16 a[192:195], v[160:163], v[216:219], a[192:195]
ds_read_b64_tr_b16 v[214:215], v13 offset:30720
v_accvgpr_read_b32 v136, a164
v_mfma_f32_16x16x32_bf16 a[192:195], v[0:3], v[220:223], a[192:195]
v_accvgpr_read_b32 v137, a165
v_accvgpr_read_b32 v138, a166
v_mfma_f32_16x16x32_bf16 a[196:199], v[164:167], v[216:219], a[196:199]
v_accvgpr_read_b32 v139, a167
v_cvt_pk_bf16_f32 v52, v136, v137
v_mfma_f32_16x16x32_bf16 a[196:199], v[32:35], v[220:223], a[196:199]
v_cvt_pk_bf16_f32 v53, v138, v139
v_accvgpr_read_b32 v144, a168
v_mfma_f32_16x16x32_bf16 a[200:203], v[168:171], v[216:219], a[200:203]
v_accvgpr_read_b32 v145, a169
v_accvgpr_read_b32 v146, a170
v_mfma_f32_16x16x32_bf16 a[200:203], v[64:67], v[220:223], a[200:203]
v_accvgpr_read_b32 v147, a171
v_cvt_pk_bf16_f32 v84, v144, v145
v_mfma_f32_16x16x32_bf16 a[204:207], v[172:175], v[216:219], a[204:207]
ds_read_b64_tr_b16 v[216:217], v15 offset:12288
ds_read_b64_tr_b16 v[218:219], v15 offset:14336
v_mfma_f32_16x16x32_bf16 a[204:207], v[96:99], v[220:223], a[204:207]
ds_read_b64_tr_b16 v[220:221], v15 offset:28672
s_waitcnt lgkmcnt(3)
v_mfma_f32_16x16x32_bf16 a[208:211], v[8:11], v[208:211], a[208:211]
ds_read_b64_tr_b16 v[222:223], v15 offset:30720
v_cvt_pk_bf16_f32 v85, v146, v147
v_mfma_f32_16x16x32_bf16 a[208:211], v[176:179], v[212:215], a[208:211]
v_accvgpr_read_b32 v152, a172
v_accvgpr_read_b32 v153, a173
v_mfma_f32_16x16x32_bf16 a[212:215], v[40:43], v[208:211], a[212:215]
v_accvgpr_read_b32 v154, a174
v_accvgpr_read_b32 v155, a175
v_mfma_f32_16x16x32_bf16 a[212:215], v[180:183], v[212:215], a[212:215]
v_cvt_pk_bf16_f32 v116, v152, v153
v_cvt_pk_bf16_f32 v117, v154, v155
v_mfma_f32_16x16x32_bf16 a[216:219], v[72:75], v[208:211], a[216:219]
v_accvgpr_read_b32 v132, a176
v_accvgpr_read_b32 v133, a177
v_mfma_f32_16x16x32_bf16 a[216:219], v[184:187], v[212:215], a[216:219]
v_accvgpr_read_b32 v134, a178
v_accvgpr_read_b32 v135, a179
v_mfma_f32_16x16x32_bf16 a[220:223], v[104:107], v[208:211], a[220:223]
ds_read_b64_tr_b16 v[208:209], v12 offset:12800
ds_read_b64_tr_b16 v[210:211], v12 offset:14848
v_mfma_f32_16x16x32_bf16 a[220:223], v[188:191], v[212:215], a[220:223]
ds_read_b64_tr_b16 v[212:213], v12 offset:29184
s_waitcnt lgkmcnt(3)
v_mfma_f32_16x16x32_bf16 a[208:211], v[160:163], v[216:219], a[208:211]
ds_read_b64_tr_b16 v[214:215], v12 offset:31232
v_cvt_pk_bf16_f32 v22, v132, v133
v_mfma_f32_16x16x32_bf16 a[208:211], v[0:3], v[220:223], a[208:211]
v_cvt_pk_bf16_f32 v23, v134, v135
buffer_store_dwordx4 v[20:23], v243, s[20:23], s44 offen offset:1024 sc1
v_mfma_f32_16x16x32_bf16 a[212:215], v[164:167], v[216:219], a[212:215]
ds_write_b128 v231, v[20:23] offset:5120
v_accvgpr_read_b32 v140, a180
v_mfma_f32_16x16x32_bf16 a[212:215], v[32:35], v[220:223], a[212:215]
v_accvgpr_read_b32 v141, a181
v_accvgpr_read_b32 v142, a182
v_mfma_f32_16x16x32_bf16 a[216:219], v[168:171], v[216:219], a[216:219]
v_accvgpr_read_b32 v143, a183
v_cvt_pk_bf16_f32 v54, v140, v141
v_mfma_f32_16x16x32_bf16 a[216:219], v[64:67], v[220:223], a[216:219]
v_cvt_pk_bf16_f32 v55, v142, v143
buffer_store_dwordx4 v[52:55], v243, s[20:23], s45 offen offset:1024 sc1
v_mfma_f32_16x16x32_bf16 a[220:223], v[172:175], v[216:219], a[220:223]
ds_read_b64_tr_b16 v[216:217], v14 offset:12800
ds_read_b64_tr_b16 v[218:219], v14 offset:14848
v_mfma_f32_16x16x32_bf16 a[220:223], v[96:99], v[220:223], a[220:223]
ds_read_b64_tr_b16 v[220:221], v14 offset:29184
s_waitcnt lgkmcnt(3)
v_mfma_f32_16x16x32_bf16 a[224:227], v[8:11], v[208:211], a[224:227]
ds_read_b64_tr_b16 v[222:223], v14 offset:31232
v_accvgpr_read_b32 v148, a184
v_mfma_f32_16x16x32_bf16 a[224:227], v[176:179], v[212:215], a[224:227]
v_accvgpr_read_b32 v149, a185
v_accvgpr_read_b32 v150, a186
v_mfma_f32_16x16x32_bf16 a[228:231], v[40:43], v[208:211], a[228:231]
v_accvgpr_read_b32 v151, a187
v_cvt_pk_bf16_f32 v86, v148, v149
v_mfma_f32_16x16x32_bf16 a[228:231], v[180:183], v[212:215], a[228:231]
v_cvt_pk_bf16_f32 v87, v150, v151
buffer_store_dwordx4 v[84:87], v243, s[20:23], s46 offen offset:1024 sc1
v_mfma_f32_16x16x32_bf16 a[232:235], v[72:75], v[208:211], a[232:235]
v_accvgpr_read_b32 v156, a188
v_accvgpr_read_b32 v157, a189
v_mfma_f32_16x16x32_bf16 a[232:235], v[184:187], v[212:215], a[232:235]
v_accvgpr_read_b32 v158, a190
v_accvgpr_read_b32 v159, a191
v_mfma_f32_16x16x32_bf16 a[236:239], v[104:107], v[208:211], a[236:239]
ds_read_b64_tr_b16 v[208:209], v13 offset:12800
ds_read_b64_tr_b16 v[210:211], v13 offset:14848
v_mfma_f32_16x16x32_bf16 a[236:239], v[188:191], v[212:215], a[236:239]
ds_read_b64_tr_b16 v[212:213], v13 offset:29184
s_waitcnt lgkmcnt(3)
v_mfma_f32_16x16x32_bf16 a[224:227], v[160:163], v[216:219], a[224:227]
ds_read_b64_tr_b16 v[214:215], v13 offset:31232
v_cvt_pk_bf16_f32 v118, v156, v157
v_mfma_f32_16x16x32_bf16 a[224:227], v[0:3], v[220:223], a[224:227]
v_cvt_pk_bf16_f32 v119, v158, v159
buffer_store_dwordx4 v[116:119], v243, s[20:23], s47 offen offset:1024 sc1
v_mfma_f32_16x16x32_bf16 a[228:231], v[164:167], v[216:219], a[228:231]
v_accvgpr_read_b32 v128, a192
v_accvgpr_read_b32 v129, a193
v_mfma_f32_16x16x32_bf16 a[228:231], v[32:35], v[220:223], a[228:231]
v_accvgpr_read_b32 v130, a194
v_accvgpr_read_b32 v131, a195
v_mfma_f32_16x16x32_bf16 a[232:235], v[168:171], v[216:219], a[232:235]
v_cvt_pk_bf16_f32 v24, v128, v129
v_cvt_pk_bf16_f32 v25, v130, v131
v_mfma_f32_16x16x32_bf16 a[232:235], v[64:67], v[220:223], a[232:235]
v_accvgpr_read_b32 v136, a196
v_accvgpr_read_b32 v137, a197
v_mfma_f32_16x16x32_bf16 a[236:239], v[172:175], v[216:219], a[236:239]
ds_read_b64_tr_b16 v[216:217], v15 offset:12800
ds_read_b64_tr_b16 v[218:219], v15 offset:14848
v_mfma_f32_16x16x32_bf16 a[236:239], v[96:99], v[220:223], a[236:239]
ds_read_b64_tr_b16 v[220:221], v15 offset:29184
s_waitcnt lgkmcnt(3)
v_mfma_f32_16x16x32_bf16 a[240:243], v[8:11], v[208:211], a[240:243]
ds_read_b64_tr_b16 v[222:223], v15 offset:31232
v_accvgpr_read_b32 v138, a198
v_mfma_f32_16x16x32_bf16 a[240:243], v[176:179], v[212:215], a[240:243]
v_accvgpr_read_b32 v139, a199
v_cvt_pk_bf16_f32 v56, v136, v137
v_mfma_f32_16x16x32_bf16 a[244:247], v[40:43], v[208:211], a[244:247]
v_cvt_pk_bf16_f32 v57, v138, v139
v_accvgpr_read_b32 v144, a200
v_mfma_f32_16x16x32_bf16 a[244:247], v[180:183], v[212:215], a[244:247]
v_accvgpr_read_b32 v145, a201
v_accvgpr_read_b32 v146, a202
v_mfma_f32_16x16x32_bf16 a[248:251], v[72:75], v[208:211], a[248:251]
v_accvgpr_read_b32 v147, a203
v_cvt_pk_bf16_f32 v88, v144, v145
v_mfma_f32_16x16x32_bf16 a[248:251], v[184:187], v[212:215], a[248:251]
v_cvt_pk_bf16_f32 v89, v146, v147
v_accvgpr_read_b32 v152, a204
v_mfma_f32_16x16x32_bf16 a[252:255], v[104:107], v[208:211], a[252:255]
v_accvgpr_read_b32 v153, a205
v_accvgpr_read_b32 v154, a206
v_mfma_f32_16x16x32_bf16 a[252:255], v[188:191], v[212:215], a[252:255]
s_waitcnt lgkmcnt(0)
v_accvgpr_read_b32 v155, a207
v_mfma_f32_16x16x32_bf16 a[240:243], v[160:163], v[216:219], a[240:243]
v_cvt_pk_bf16_f32 v120, v152, v153
v_cvt_pk_bf16_f32 v121, v154, v155
v_mfma_f32_16x16x32_bf16 a[240:243], v[0:3], v[220:223], a[240:243]
v_accvgpr_read_b32 v132, a208
v_accvgpr_read_b32 v133, a209
v_mfma_f32_16x16x32_bf16 a[244:247], v[164:167], v[216:219], a[244:247]
v_accvgpr_read_b32 v134, a210
v_accvgpr_read_b32 v135, a211
v_mfma_f32_16x16x32_bf16 a[244:247], v[32:35], v[220:223], a[244:247]
v_cvt_pk_bf16_f32 v26, v132, v133
v_cvt_pk_bf16_f32 v27, v134, v135
v_mfma_f32_16x16x32_bf16 a[248:251], v[168:171], v[216:219], a[248:251]
buffer_store_dwordx4 v[24:27], v243, s[20:23], s44 offen offset:2048 sc1
ds_write_b128 v231, v[24:27] offset:6144
v_mfma_f32_16x16x32_bf16 a[248:251], v[64:67], v[220:223], a[248:251]
v_accvgpr_read_b32 v140, a212
v_accvgpr_read_b32 v141, a213
v_mfma_f32_16x16x32_bf16 a[252:255], v[172:175], v[216:219], a[252:255]
v_accvgpr_read_b32 v142, a214
v_accvgpr_read_b32 v143, a215
v_mfma_f32_16x16x32_bf16 a[252:255], v[96:99], v[220:223], a[252:255]
v_cvt_pk_bf16_f32 v58, v140, v141
v_cvt_pk_bf16_f32 v59, v142, v143
buffer_store_dwordx4 v[56:59], v243, s[20:23], s45 offen offset:2048 sc1
v_accvgpr_read_b32 v148, a216
v_accvgpr_read_b32 v149, a217
v_accvgpr_read_b32 v150, a218
v_accvgpr_read_b32 v151, a219
v_cvt_pk_bf16_f32 v90, v148, v149
v_cvt_pk_bf16_f32 v91, v150, v151
buffer_store_dwordx4 v[88:91], v243, s[20:23], s46 offen offset:2048 sc1
v_accvgpr_read_b32 v156, a220
v_accvgpr_read_b32 v157, a221
v_accvgpr_read_b32 v158, a222
v_accvgpr_read_b32 v159, a223
v_cvt_pk_bf16_f32 v122, v156, v157
v_cvt_pk_bf16_f32 v123, v158, v159
buffer_store_dwordx4 v[120:123], v243, s[20:23], s47 offen offset:2048 sc1
v_accvgpr_read_b32 v128, a224
v_accvgpr_read_b32 v129, a225
v_accvgpr_read_b32 v130, a226
v_accvgpr_read_b32 v131, a227
v_cvt_pk_bf16_f32 v28, v128, v129
v_cvt_pk_bf16_f32 v29, v130, v131
v_accvgpr_read_b32 v136, a228
v_accvgpr_read_b32 v137, a229
v_accvgpr_read_b32 v138, a230
v_accvgpr_read_b32 v139, a231
v_cvt_pk_bf16_f32 v60, v136, v137
v_cvt_pk_bf16_f32 v61, v138, v139
v_accvgpr_read_b32 v144, a232
v_accvgpr_read_b32 v145, a233
v_accvgpr_read_b32 v146, a234
v_accvgpr_read_b32 v147, a235
v_cvt_pk_bf16_f32 v92, v144, v145
v_cvt_pk_bf16_f32 v93, v146, v147
v_accvgpr_read_b32 v152, a236
v_accvgpr_read_b32 v153, a237
v_accvgpr_read_b32 v154, a238
v_accvgpr_read_b32 v155, a239
v_cvt_pk_bf16_f32 v124, v152, v153
v_cvt_pk_bf16_f32 v125, v154, v155
v_accvgpr_read_b32 v132, a240
v_accvgpr_read_b32 v133, a241
v_accvgpr_read_b32 v134, a242
v_accvgpr_read_b32 v135, a243
v_cvt_pk_bf16_f32 v30, v132, v133
v_cvt_pk_bf16_f32 v31, v134, v135
buffer_store_dwordx4 v[28:31], v243, s[20:23], s44 offen offset:3072 sc1
ds_write_b128 v231, v[28:31] offset:7168
v_accvgpr_read_b32 v140, a244
v_accvgpr_read_b32 v141, a245
v_accvgpr_read_b32 v142, a246
v_accvgpr_read_b32 v143, a247
v_cvt_pk_bf16_f32 v62, v140, v141
v_cvt_pk_bf16_f32 v63, v142, v143
buffer_store_dwordx4 v[60:63], v243, s[20:23], s45 offen offset:3072 sc1
v_accvgpr_read_b32 v148, a248
v_accvgpr_read_b32 v149, a249
v_accvgpr_read_b32 v150, a250
v_accvgpr_read_b32 v151, a251
v_cvt_pk_bf16_f32 v94, v148, v149
v_cvt_pk_bf16_f32 v95, v150, v151
buffer_store_dwordx4 v[92:95], v243, s[20:23], s46 offen offset:3072 sc1
v_accvgpr_read_b32 v156, a252
v_accvgpr_read_b32 v157, a253
v_accvgpr_read_b32 v158, a254
v_accvgpr_read_b32 v159, a255
v_cvt_pk_bf16_f32 v126, v156, v157
v_cvt_pk_bf16_f32 v127, v158, v159
buffer_store_dwordx4 v[124:127], v243, s[20:23], s47 offen offset:3072 sc1
s_waitcnt vmcnt(36)
s_branch L2_F
L2_tail_1:
s_waitcnt lgkmcnt(2)
v_add_u32 v231, s50, v243
v_mfma_f32_16x16x32_bf16 v[144:147], v[208:211], v[0:3], v[192:195]
s_mov_b32 m0, s30
ds_write_b128 v231, v[160:163] offset:0
v_mfma_f32_16x16x32_bf16 v[144:147], v[212:215], v[4:7], v[144:147]
buffer_load_dwordx4 v241, s[12:15], s28 offen offset:0 sc1 lds
ds_write_b128 v231, v[164:167] offset:1024
v_mfma_f32_16x16x32_bf16 v[148:151], v[208:211], v[32:35], v[196:199]
buffer_load_dwordx4 v241, s[12:15], s28 offen offset:1024 sc1 lds
ds_write_b128 v231, v[168:171] offset:2048
v_mfma_f32_16x16x32_bf16 v[148:151], v[212:215], v[36:39], v[148:151]
buffer_load_dwordx4 v241, s[12:15], s28 offen offset:2048 sc1 lds
ds_write_b128 v231, v[172:175] offset:3072
v_mfma_f32_16x16x32_bf16 v[152:155], v[208:211], v[64:67], v[200:203]
buffer_load_dwordx4 v241, s[12:15], s28 offen offset:3072 sc1 lds
v_add_u32 v230, 0x8000, v240
v_and_b32 v230, 0x1ffff, v230
v_mfma_f32_16x16x32_bf16 v[152:155], v[212:215], v[68:71], v[152:155]
v_exp_f32 v232, v128
v_mfma_f32_16x16x32_bf16 v[156:159], v[208:211], v[96:99], v[204:207]
ds_read_b128 v[208:211], v240 offset:10240
v_exp_f32 v233, v129
v_mfma_f32_16x16x32_bf16 v[156:159], v[212:215], v[100:103], v[156:159]
ds_read_b128 v[212:215], v240 offset:10752
s_waitcnt lgkmcnt(2)
s_and_b32 s30, s30, 0x1c000
v_mfma_f32_16x16x32_bf16 v[144:147], v[216:219], v[8:11], v[144:147]
v_exp_f32 v234, v130
v_add_f32 v224, v224, v232
v_mfma_f32_16x16x32_bf16 v[144:147], v[220:223], v[12:15], v[144:147]
v_cvt_pk_bf16_f32 v160, v232, v233
v_exp_f32 v235, v131
v_mfma_f32_16x16x32_bf16 v[148:151], v[216:219], v[40:43], v[148:151]
v_add_f32 v224, v224, v233
v_add_f32 v224, v224, v234
v_add_f32 v224, v224, v235
v_mfma_f32_16x16x32_bf16 v[148:151], v[220:223], v[44:47], v[148:151]
v_cvt_pk_bf16_f32 v161, v234, v235
v_exp_f32 v236, v132
v_mfma_f32_16x16x32_bf16 v[152:155], v[216:219], v[72:75], v[152:155]
v_exp_f32 v237, v133
s_add_u32 s28, s30, 0x4000
v_mfma_f32_16x16x32_bf16 v[152:155], v[220:223], v[76:79], v[152:155]
v_exp_f32 v238, v134
v_add_f32 v225, v225, v236
v_mfma_f32_16x16x32_bf16 v[156:159], v[216:219], v[104:107], v[156:159]
ds_read_b128 v[216:219], v240 offset:14336
v_cvt_pk_bf16_f32 v164, v236, v237
s_and_b32 s28, s28, 0x1ffff
v_mfma_f32_16x16x32_bf16 v[156:159], v[220:223], v[108:111], v[156:159]
ds_read_b128 v[220:223], v240 offset:14848
s_waitcnt lgkmcnt(2)
s_add_u32 s30, s30, 0x8000
v_mfma_f32_16x16x32_bf16 v[144:147], v[208:211], v[16:19], v[144:147]
v_exp_f32 v239, v135
v_add_f32 v225, v225, v237
v_mfma_f32_16x16x32_bf16 v[144:147], v[212:215], v[20:23], v[144:147]
s_waitcnt vmcnt(4)
s_barrier
v_add_f32 v225, v225, v238
v_mfma_f32_16x16x32_bf16 v[148:151], v[208:211], v[48:51], v[148:151]
v_add_f32 v225, v225, v239
v_cvt_pk_bf16_f32 v165, v238, v239
s_and_b32 s30, s30, 0x1ffff
v_mfma_f32_16x16x32_bf16 v[148:151], v[212:215], v[52:55], v[148:151]
v_exp_f32 v232, v136
s_mul_i32 s31, s34, 6144
v_mfma_f32_16x16x32_bf16 v[152:155], v[208:211], v[80:83], v[152:155]
v_exp_f32 v233, v137
s_add_u32 s31, s31, s30
v_mfma_f32_16x16x32_bf16 v[152:155], v[212:215], v[84:87], v[152:155]
v_exp_f32 v234, v138
v_add_f32 v226, v226, v232
v_mfma_f32_16x16x32_bf16 v[156:159], v[208:211], v[112:115], v[156:159]
ds_read_b128 v[208:211], v240 offset:16384
v_cvt_pk_bf16_f32 v168, v232, v233
s_lshl_b32 s3, s34, 10
v_mfma_f32_16x16x32_bf16 v[156:159], v[212:215], v[116:119], v[156:159]
ds_read_b128 v[212:215], v240 offset:16896
s_waitcnt lgkmcnt(2)
s_add_u32 s28, s28, s3
v_mfma_f32_16x16x32_bf16 v[144:147], v[216:219], v[24:27], v[144:147]
v_exp_f32 v235, v139
v_add_f32 v226, v226, v233
v_mfma_f32_16x16x32_bf16 v[144:147], v[220:223], v[28:31], v[144:147]
v_add_f32 v226, v226, v234
v_add_f32 v226, v226, v235
v_cvt_pk_bf16_f32 v169, v234, v235
v_mfma_f32_16x16x32_bf16 v[148:151], v[216:219], v[56:59], v[148:151]
v_exp_f32 v236, v140
s_add_u32 s3, s3, 24576
v_mfma_f32_16x16x32_bf16 v[148:151], v[220:223], v[60:63], v[148:151]
v_exp_f32 v237, v141
s_add_u32 s30, s30, s3
v_mfma_f32_16x16x32_bf16 v[152:155], v[216:219], v[88:91], v[152:155]
v_exp_f32 v238, v142
v_add_f32 v227, v227, v236
v_mfma_f32_16x16x32_bf16 v[152:155], v[220:223], v[92:95], v[152:155]
v_cvt_pk_bf16_f32 v172, v236, v237
v_exp_f32 v239, v143
v_mfma_f32_16x16x32_bf16 v[156:159], v[216:219], v[120:123], v[156:159]
ds_read_b128 v[216:219], v240 offset:20480
v_add_f32 v227, v227, v237
v_add_f32 v227, v227, v238
v_mfma_f32_16x16x32_bf16 v[156:159], v[220:223], v[124:127], v[156:159]
ds_read_b128 v[220:223], v240 offset:20992
s_waitcnt lgkmcnt(2)
v_add_f32 v227, v227, v239
v_cvt_pk_bf16_f32 v173, v238, v239
v_max3_f32 v242, v224, v225, v226
v_max_f32 v242, v242, v227
v_cmp_lt_f32 vcc, s32, v242
s_cbranch_vccnz L2_rare_site12
L2_ret12:
v_mfma_f32_16x16x32_bf16 v[128:131], v[208:211], v[0:3], v[192:195]
v_lshrrev_b32 v241, 4, v243
v_and_b32 v241, 0x30, v241
v_xor_b32 v241, v241, v243
v_and_b32 v228, 0x380, v243
v_mad_u32_u24 v241, v228, 3, v241
v_mfma_f32_16x16x32_bf16 v[128:131], v[212:215], v[4:7], v[128:131]
v_exp_f32 v232, v144
v_mfma_f32_16x16x32_bf16 v[132:135], v[208:211], v[32:35], v[196:199]
v_exp_f32 v233, v145
v_mfma_f32_16x16x32_bf16 v[132:135], v[212:215], v[36:39], v[132:135]
v_exp_f32 v234, v146
v_add_f32 v224, v224, v232
v_mfma_f32_16x16x32_bf16 v[136:139], v[208:211], v[64:67], v[200:203]
v_cvt_pk_bf16_f32 v162, v232, v233
v_exp_f32 v235, v147
v_mfma_f32_16x16x32_bf16 v[136:139], v[212:215], v[68:71], v[136:139]
v_add_f32 v224, v224, v233
v_add_f32 v224, v224, v234
v_add_f32 v224, v224, v235
v_mfma_f32_16x16x32_bf16 v[140:143], v[208:211], v[96:99], v[204:207]
ds_read_b128 v[208:211], v240 offset:24576
v_cvt_pk_bf16_f32 v163, v234, v235
v_mfma_f32_16x16x32_bf16 v[140:143], v[212:215], v[100:103], v[140:143]
ds_read_b128 v[212:215], v240 offset:25088
s_waitcnt lgkmcnt(2)
v_mfma_f32_16x16x32_bf16 v[128:131], v[216:219], v[8:11], v[128:131]
ds_write_b128 v231, v[176:179] offset:4096
v_exp_f32 v236, v148
v_mfma_f32_16x16x32_bf16 v[128:131], v[220:223], v[12:15], v[128:131]
ds_write_b128 v231, v[180:183] offset:5120
v_exp_f32 v237, v149
v_mfma_f32_16x16x32_bf16 v[132:135], v[216:219], v[40:43], v[132:135]
ds_write_b128 v231, v[184:187] offset:6144
v_exp_f32 v238, v150
v_mfma_f32_16x16x32_bf16 v[132:135], v[220:223], v[44:47], v[132:135]
ds_write_b128 v231, v[188:191] offset:7168
v_add_f32 v225, v225, v236
v_cvt_pk_bf16_f32 v166, v236, v237
v_mfma_f32_16x16x32_bf16 v[136:139], v[216:219], v[72:75], v[136:139]
v_exp_f32 v239, v151
v_add_f32 v225, v225, v237
v_mfma_f32_16x16x32_bf16 v[136:139], v[220:223], v[76:79], v[136:139]
v_add_f32 v225, v225, v238
v_add_f32 v225, v225, v239
v_cvt_pk_bf16_f32 v167, v238, v239
v_mfma_f32_16x16x32_bf16 v[140:143], v[216:219], v[104:107], v[140:143]
ds_read_b128 v[216:219], v240 offset:28672
v_exp_f32 v232, v152
v_mfma_f32_16x16x32_bf16 v[140:143], v[220:223], v[108:111], v[140:143]
ds_read_b128 v[220:223], v240 offset:29184
s_waitcnt lgkmcnt(2)
v_mfma_f32_16x16x32_bf16 v[128:131], v[208:211], v[16:19], v[128:131]
v_exp_f32 v233, v153
v_mfma_f32_16x16x32_bf16 v[128:131], v[212:215], v[20:23], v[128:131]
v_exp_f32 v234, v154
v_add_f32 v226, v226, v232
v_mfma_f32_16x16x32_bf16 v[132:135], v[208:211], v[48:51], v[132:135]
v_cvt_pk_bf16_f32 v170, v232, v233
v_exp_f32 v235, v155
v_mfma_f32_16x16x32_bf16 v[132:135], v[212:215], v[52:55], v[132:135]
v_add_f32 v226, v226, v233
v_add_f32 v226, v226, v234
v_add_f32 v226, v226, v235
v_mfma_f32_16x16x32_bf16 v[136:139], v[208:211], v[80:83], v[136:139]
v_cvt_pk_bf16_f32 v171, v234, v235
v_exp_f32 v236, v156
v_mfma_f32_16x16x32_bf16 v[136:139], v[212:215], v[84:87], v[136:139]
v_exp_f32 v237, v157
v_mfma_f32_16x16x32_bf16 v[140:143], v[208:211], v[112:115], v[140:143]
ds_read_b128 v[208:211], v240 offset:18432
v_exp_f32 v238, v158
v_mfma_f32_16x16x32_bf16 v[140:143], v[212:215], v[116:119], v[140:143]
ds_read_b128 v[212:215], v240 offset:18944
s_waitcnt lgkmcnt(2)
v_add_f32 v227, v227, v236
v_mfma_f32_16x16x32_bf16 v[128:131], v[216:219], v[24:27], v[128:131]
v_cvt_pk_bf16_f32 v174, v236, v237
v_exp_f32 v239, v159
v_mfma_f32_16x16x32_bf16 v[128:131], v[220:223], v[28:31], v[128:131]
v_add_f32 v227, v227, v237
v_add_f32 v227, v227, v238
v_add_f32 v227, v227, v239
v_mfma_f32_16x16x32_bf16 v[132:135], v[216:219], v[56:59], v[132:135]
v_cvt_pk_bf16_f32 v175, v238, v239
v_max3_f32 v242, v224, v225, v226
v_max_f32 v242, v242, v227
v_mfma_f32_16x16x32_bf16 v[132:135], v[220:223], v[60:63], v[132:135]
v_cmp_lt_f32 vcc, s32, v242
s_cbranch_vccnz L2_rare_site13
L2_ret13:
v_mfma_f32_16x16x32_bf16 v[136:139], v[216:219], v[88:91], v[136:139]
s_add_u32 m0, s31, 0
v_mfma_f32_16x16x32_bf16 v[136:139], v[220:223], v[92:95], v[136:139]
buffer_load_dwordx4 v241, s[8:11], s6 offen lds
s_add_u32 m0, s31, 2048
v_mfma_f32_16x16x32_bf16 v[140:143], v[216:219], v[120:123], v[140:143]
ds_read_b128 v[216:219], v240 offset:22528
buffer_load_dwordx4 v241, s[8:11], s7 offen lds
s_add_u32 m0, s31, 4096
v_mfma_f32_16x16x32_bf16 v[140:143], v[220:223], v[124:127], v[140:143]
ds_read_b128 v[220:223], v240 offset:23040
s_waitcnt lgkmcnt(2)
v_mfma_f32_16x16x32_bf16 v[144:147], v[208:211], v[0:3], v[192:195]
buffer_load_dwordx4 v241, s[8:11], s29 offen lds
s_add_u32 m0, s31, 1024
v_xor_b32 v241, 0x1040, v241
v_mfma_f32_16x16x32_bf16 v[144:147], v[212:215], v[4:7], v[144:147]
v_exp_f32 v232, v128
v_mfma_f32_16x16x32_bf16 v[148:151], v[208:211], v[32:35], v[196:199]
v_exp_f32 v233, v129
v_mfma_f32_16x16x32_bf16 v[148:151], v[212:215], v[36:39], v[148:151]
v_exp_f32 v234, v130
v_add_f32 v224, v224, v232
v_mfma_f32_16x16x32_bf16 v[152:155], v[208:211], v[64:67], v[200:203]
v_cvt_pk_bf16_f32 v176, v232, v233
v_exp_f32 v235, v131
v_mfma_f32_16x16x32_bf16 v[152:155], v[212:215], v[68:71], v[152:155]
v_add_f32 v224, v224, v233
v_add_f32 v224, v224, v234
v_add_f32 v224, v224, v235
v_mfma_f32_16x16x32_bf16 v[156:159], v[208:211], v[96:99], v[204:207]
ds_read_b128 v[208:211], v240 offset:26624
v_cvt_pk_bf16_f32 v177, v234, v235
v_mfma_f32_16x16x32_bf16 v[156:159], v[212:215], v[100:103], v[156:159]
ds_read_b128 v[212:215], v240 offset:27136
s_waitcnt lgkmcnt(2)
v_mfma_f32_16x16x32_bf16 v[144:147], v[216:219], v[8:11], v[144:147]
v_exp_f32 v236, v132
v_mfma_f32_16x16x32_bf16 v[144:147], v[220:223], v[12:15], v[144:147]
v_exp_f32 v237, v133
v_mfma_f32_16x16x32_bf16 v[148:151], v[216:219], v[40:43], v[148:151]
v_exp_f32 v238, v134
v_add_f32 v225, v225, v236
v_mfma_f32_16x16x32_bf16 v[148:151], v[220:223], v[44:47], v[148:151]
v_cvt_pk_bf16_f32 v180, v236, v237
v_exp_f32 v239, v135
v_mfma_f32_16x16x32_bf16 v[152:155], v[216:219], v[72:75], v[152:155]
v_add_f32 v225, v225, v237
v_add_f32 v225, v225, v238
v_add_f32 v225, v225, v239
v_mfma_f32_16x16x32_bf16 v[152:155], v[220:223], v[76:79], v[152:155]
v_cvt_pk_bf16_f32 v181, v238, v239
v_exp_f32 v232, v136
v_mfma_f32_16x16x32_bf16 v[156:159], v[216:219], v[104:107], v[156:159]
ds_read_b128 v[216:219], v240 offset:30720
v_exp_f32 v233, v137
v_mfma_f32_16x16x32_bf16 v[156:159], v[220:223], v[108:111], v[156:159]
ds_read_b128 v[220:223], v240 offset:31232
s_waitcnt lgkmcnt(2)
v_mfma_f32_16x16x32_bf16 v[144:147], v[208:211], v[16:19], v[144:147]
v_exp_f32 v234, v138
v_add_f32 v226, v226, v232
v_mfma_f32_16x16x32_bf16 v[144:147], v[212:215], v[20:23], v[144:147]
s_waitcnt vmcnt(3)
s_barrier
v_cvt_pk_bf16_f32 v184, v232, v233
v_mfma_f32_16x16x32_bf16 v[148:151], v[208:211], v[48:51], v[148:151]
v_exp_f32 v235, v139
v_add_f32 v226, v226, v233
v_mfma_f32_16x16x32_bf16 v[148:151], v[212:215], v[52:55], v[148:151]
v_add_f32 v226, v226, v234
v_add_f32 v226, v226, v235
v_cvt_pk_bf16_f32 v185, v234, v235
v_mfma_f32_16x16x32_bf16 v[152:155], v[208:211], v[80:83], v[152:155]
v_exp_f32 v236, v140
v_mfma_f32_16x16x32_bf16 v[152:155], v[212:215], v[84:87], v[152:155]
v_exp_f32 v237, v141
v_mfma_f32_16x16x32_bf16 v[156:159], v[208:211], v[112:115], v[156:159]
ds_read_b128 v[208:211], v230 offset:0
v_exp_f32 v238, v142
v_mfma_f32_16x16x32_bf16 v[156:159], v[212:215], v[116:119], v[156:159]
ds_read_b128 v[212:215], v230 offset:512
s_waitcnt lgkmcnt(2)
v_add_f32 v227, v227, v236
v_mfma_f32_16x16x32_bf16 v[144:147], v[216:219], v[24:27], v[144:147]
v_cvt_pk_bf16_f32 v188, v236, v237
v_exp_f32 v239, v143
v_mfma_f32_16x16x32_bf16 v[144:147], v[220:223], v[28:31], v[144:147]
v_add_f32 v227, v227, v237
v_add_f32 v227, v227, v238
v_add_f32 v227, v227, v239
v_mfma_f32_16x16x32_bf16 v[148:151], v[216:219], v[56:59], v[148:151]
v_cvt_pk_bf16_f32 v189, v238, v239
v_max3_f32 v242, v224, v225, v226
v_max_f32 v242, v242, v227
v_mfma_f32_16x16x32_bf16 v[148:151], v[220:223], v[60:63], v[148:151]
v_cmp_lt_f32 vcc, s32, v242
s_cbranch_vccnz L2_rare_site14
L2_ret14:
v_mfma_f32_16x16x32_bf16 v[152:155], v[216:219], v[88:91], v[152:155]
buffer_load_dwordx4 v241, s[8:11], s6 offen lds
s_add_u32 m0, s31, 3072
v_mfma_f32_16x16x32_bf16 v[152:155], v[220:223], v[92:95], v[152:155]
buffer_load_dwordx4 v241, s[8:11], s7 offen lds
s_add_u32 m0, s31, 5120
v_mfma_f32_16x16x32_bf16 v[156:159], v[216:219], v[120:123], v[156:159]
ds_read_b128 v[216:219], v230 offset:4096
buffer_load_dwordx4 v241, s[8:11], s29 offen lds
v_mfma_f32_16x16x32_bf16 v[156:159], v[220:223], v[124:127], v[156:159]
ds_read_b128 v[220:223], v230 offset:4608
s_waitcnt lgkmcnt(2)
v_mfma_f32_16x16x32_bf16 v[128:131], v[208:211], v[0:3], v[192:195]
v_mfma_f32_16x16x32_bf16 v[128:131], v[212:215], v[4:7], v[128:131]
v_exp_f32 v232, v144
v_mfma_f32_16x16x32_bf16 v[132:135], v[208:211], v[32:35], v[196:199]
v_exp_f32 v233, v145
v_mfma_f32_16x16x32_bf16 v[132:135], v[212:215], v[36:39], v[132:135]
v_exp_f32 v234, v146
v_add_f32 v224, v224, v232
v_mfma_f32_16x16x32_bf16 v[136:139], v[208:211], v[64:67], v[200:203]
v_cvt_pk_bf16_f32 v178, v232, v233
v_exp_f32 v235, v147
v_mfma_f32_16x16x32_bf16 v[136:139], v[212:215], v[68:71], v[136:139]
v_add_f32 v224, v224, v233
v_add_f32 v224, v224, v234
v_add_f32 v224, v224, v235
v_mfma_f32_16x16x32_bf16 v[140:143], v[208:211], v[96:99], v[204:207]
ds_read_b128 v[208:211], v230 offset:8192
v_cvt_pk_bf16_f32 v179, v234, v235
v_lshlrev_b32 v241, 3, v243
v_mfma_f32_16x16x32_bf16 v[140:143], v[212:215], v[100:103], v[140:143]
ds_read_b128 v[212:215], v230 offset:8704
s_waitcnt lgkmcnt(2)
s_mov_b32 s3, 0x7c28000
v_mfma_f32_16x16x32_bf16 v[128:131], v[216:219], v[8:11], v[128:131]
v_exp_f32 v236, v148
buffer_load_dwordx2 v[240:241], v241, s[16:19], s3 offen sc1
v_mfma_f32_16x16x32_bf16 v[128:131], v[220:223], v[12:15], v[128:131]
v_exp_f32 v237, v149
v_mfma_f32_16x16x32_bf16 v[132:135], v[216:219], v[40:43], v[132:135]
v_exp_f32 v238, v150
v_add_f32 v225, v225, v236
v_mfma_f32_16x16x32_bf16 v[132:135], v[220:223], v[44:47], v[132:135]
v_cvt_pk_bf16_f32 v182, v236, v237
v_exp_f32 v239, v151
v_mfma_f32_16x16x32_bf16 v[136:139], v[216:219], v[72:75], v[136:139]
v_add_f32 v225, v225, v237
v_add_f32 v225, v225, v238
v_add_f32 v225, v225, v239
v_mfma_f32_16x16x32_bf16 v[136:139], v[220:223], v[76:79], v[136:139]
v_cvt_pk_bf16_f32 v183, v238, v239
v_exp_f32 v232, v152
v_mfma_f32_16x16x32_bf16 v[140:143], v[216:219], v[104:107], v[140:143]
ds_read_b128 v[216:219], v230 offset:12288
v_exp_f32 v233, v153
v_mfma_f32_16x16x32_bf16 v[140:143], v[220:223], v[108:111], v[140:143]
ds_read_b128 v[220:223], v230 offset:12800
s_waitcnt lgkmcnt(2)
v_mfma_f32_16x16x32_bf16 v[128:131], v[208:211], v[16:19], v[128:131]
v_exp_f32 v234, v154
v_add_f32 v226, v226, v232
v_mfma_f32_16x16x32_bf16 v[128:131], v[212:215], v[20:23], v[128:131]
v_cvt_pk_bf16_f32 v186, v232, v233
v_exp_f32 v235, v155
v_mfma_f32_16x16x32_bf16 v[132:135], v[208:211], v[48:51], v[132:135]
v_add_f32 v226, v226, v233
v_add_f32 v226, v226, v234
v_add_f32 v226, v226, v235
v_mfma_f32_16x16x32_bf16 v[132:135], v[212:215], v[52:55], v[132:135]
v_cvt_pk_bf16_f32 v187, v234, v235
v_exp_f32 v236, v156
v_mfma_f32_16x16x32_bf16 v[136:139], v[208:211], v[80:83], v[136:139]
v_exp_f32 v237, v157
v_mfma_f32_16x16x32_bf16 v[136:139], v[212:215], v[84:87], v[136:139]
v_exp_f32 v238, v158
v_add_f32 v227, v227, v236
v_mfma_f32_16x16x32_bf16 v[140:143], v[208:211], v[112:115], v[140:143]
ds_read_b128 v[208:211], v230 offset:2048
v_cvt_pk_bf16_f32 v190, v236, v237
v_mfma_f32_16x16x32_bf16 v[140:143], v[212:215], v[116:119], v[140:143]
ds_read_b128 v[212:215], v230 offset:2560
s_waitcnt lgkmcnt(2)
v_mfma_f32_16x16x32_bf16 v[128:131], v[216:219], v[24:27], v[128:131]
v_exp_f32 v239, v159
v_add_f32 v227, v227, v237
v_mfma_f32_16x16x32_bf16 v[128:131], v[220:223], v[28:31], v[128:131]
v_add_f32 v227, v227, v238
v_add_f32 v227, v227, v239
v_cvt_pk_bf16_f32 v191, v238, v239
v_mfma_f32_16x16x32_bf16 v[132:135], v[216:219], v[56:59], v[132:135]
v_max3_f32 v242, v224, v225, v226
v_max_f32 v242, v242, v227
v_cmp_lt_f32 vcc, s32, v242
s_cbranch_vccnz L2_rare_site15
L2_ret15:
v_mfma_f32_16x16x32_bf16 v[132:135], v[220:223], v[60:63], v[132:135]
v_mfma_f32_16x16x32_bf16 v[136:139], v[216:219], v[88:91], v[136:139]
v_mfma_f32_16x16x32_bf16 v[136:139], v[220:223], v[92:95], v[136:139]
v_mfma_f32_16x16x32_bf16 v[140:143], v[216:219], v[120:123], v[140:143]
ds_read_b128 v[216:219], v230 offset:6144
v_mfma_f32_16x16x32_bf16 v[140:143], v[220:223], v[124:127], v[140:143]
ds_read_b128 v[220:223], v230 offset:6656
s_waitcnt lgkmcnt(2)
v_mfma_f32_16x16x32_bf16 v[144:147], v[208:211], v[0:3], v[192:195]
v_mfma_f32_16x16x32_bf16 v[144:147], v[212:215], v[4:7], v[144:147]
v_mfma_f32_16x16x32_bf16 v[148:151], v[208:211], v[32:35], v[196:199]
v_mfma_f32_16x16x32_bf16 v[148:151], v[212:215], v[36:39], v[148:151]
v_mfma_f32_16x16x32_bf16 v[152:155], v[208:211], v[64:67], v[200:203]
v_exp_f32 v232, v128
v_mfma_f32_16x16x32_bf16 v[152:155], v[212:215], v[68:71], v[152:155]
v_exp_f32 v233, v129
v_mfma_f32_16x16x32_bf16 v[156:159], v[208:211], v[96:99], v[204:207]
ds_read_b128 v[208:211], v230 offset:10240
v_exp_f32 v234, v130
v_mfma_f32_16x16x32_bf16 v[156:159], v[212:215], v[100:103], v[156:159]
ds_read_b128 v[212:215], v230 offset:10752
s_waitcnt lgkmcnt(2)
v_add_f32 v224, v224, v232
v_mfma_f32_16x16x32_bf16 v[144:147], v[216:219], v[8:11], v[144:147]
v_cvt_pk_bf16_f32 v0, v232, v233
v_exp_f32 v235, v131
v_mfma_f32_16x16x32_bf16 v[144:147], v[220:223], v[12:15], v[144:147]
ds_read_b128 v[4:7], v231 offset:0
v_add_f32 v224, v224, v233
v_add_f32 v224, v224, v234
v_mfma_f32_16x16x32_bf16 v[148:151], v[216:219], v[40:43], v[148:151]
ds_read_b128 v[36:39], v231 offset:1024
v_add_f32 v224, v224, v235
v_cvt_pk_bf16_f32 v1, v234, v235
v_mfma_f32_16x16x32_bf16 v[148:151], v[220:223], v[44:47], v[148:151]
v_exp_f32 v236, v132
v_mfma_f32_16x16x32_bf16 v[152:155], v[216:219], v[72:75], v[152:155]
v_exp_f32 v237, v133
v_mfma_f32_16x16x32_bf16 v[152:155], v[220:223], v[76:79], v[152:155]
ds_read_b128 v[68:71], v231 offset:2048
ds_read_b128 v[8:11], v231 offset:4096
v_mfma_f32_16x16x32_bf16 v[156:159], v[216:219], v[104:107], v[156:159]
ds_read_b128 v[216:219], v230 offset:14336
v_add_u32 v12, 0x8000, v246
v_and_b32 v12, 0x1ffff, v12
ds_read_b128 v[100:103], v231 offset:3072
ds_read_b128 v[40:43], v231 offset:5120
v_mfma_f32_16x16x32_bf16 v[156:159], v[220:223], v[108:111], v[156:159]
ds_read_b128 v[220:223], v230 offset:14848
s_waitcnt lgkmcnt(2)
v_add_u32 v14, 0x10000, v246
v_and_b32 v14, 0x1ffff, v14
v_mfma_f32_16x16x32_bf16 v[144:147], v[208:211], v[16:19], v[144:147]
v_xor_b32 v13, 32, v12
v_xor_b32 v15, 32, v14
v_mfma_f32_16x16x32_bf16 v[144:147], v[212:215], v[20:23], v[144:147]
ds_read_b128 v[72:75], v231 offset:6144
v_exp_f32 v238, v134
v_mfma_f32_16x16x32_bf16 v[148:151], v[208:211], v[48:51], v[148:151]
ds_read_b128 v[104:107], v231 offset:7168
v_add_f32 v225, v225, v236
v_cvt_pk_bf16_f32 v32, v236, v237
v_mfma_f32_16x16x32_bf16 v[148:151], v[212:215], v[52:55], v[148:151]
v_exp_f32 v239, v135
v_add_f32 v225, v225, v237
v_mfma_f32_16x16x32_bf16 v[152:155], v[208:211], v[80:83], v[152:155]
v_add_f32 v225, v225, v238
v_add_f32 v225, v225, v239
v_cvt_pk_bf16_f32 v33, v238, v239
v_mfma_f32_16x16x32_bf16 v[152:155], v[212:215], v[84:87], v[152:155]
v_exp_f32 v232, v136
v_mfma_f32_16x16x32_bf16 v[156:159], v[208:211], v[112:115], v[156:159]
ds_read_b64_tr_b16 v[208:209], v246 offset:16384
ds_read_b64_tr_b16 v[210:211], v246 offset:18432
v_mfma_f32_16x16x32_bf16 v[156:159], v[212:215], v[116:119], v[156:159]
ds_read_b64_tr_b16 v[212:213], v12 offset:0
s_waitcnt lgkmcnt(3)
v_mfma_f32_16x16x32_bf16 v[144:147], v[216:219], v[24:27], v[144:147]
ds_read_b64_tr_b16 v[214:215], v12 offset:2048
v_exp_f32 v233, v137
v_mfma_f32_16x16x32_bf16 v[144:147], v[220:223], v[28:31], v[144:147]
v_exp_f32 v234, v138
v_add_f32 v226, v226, v232
v_mfma_f32_16x16x32_bf16 v[148:151], v[216:219], v[56:59], v[148:151]
v_cvt_pk_bf16_f32 v64, v232, v233
v_exp_f32 v235, v139
v_mfma_f32_16x16x32_bf16 v[148:151], v[220:223], v[60:63], v[148:151]
v_add_f32 v226, v226, v233
v_add_f32 v226, v226, v234
v_add_f32 v226, v226, v235
v_mfma_f32_16x16x32_bf16 v[152:155], v[216:219], v[88:91], v[152:155]
v_cvt_pk_bf16_f32 v65, v234, v235
v_exp_f32 v236, v140
v_mfma_f32_16x16x32_bf16 v[152:155], v[220:223], v[92:95], v[152:155]
v_exp_f32 v237, v141
s_waitcnt vmcnt(0)
v_mfma_f32_16x16x32_bf16 v[156:159], v[216:219], v[120:123], v[156:159]
ds_read_b64_tr_b16 v[216:217], v12 offset:16384
ds_read_b64_tr_b16 v[218:219], v12 offset:18432
v_cmp_ne_u64_e64 s[38:39], s[98:99], v[240:241]
v_mfma_f32_16x16x32_bf16 v[156:159], v[220:223], v[124:127], v[156:159]
ds_read_b64_tr_b16 v[220:221], v247 offset:16384
s_waitcnt lgkmcnt(3)
v_exp_f32 v238, v142
v_add_f32 v227, v227, v236
v_cvt_pk_bf16_f32 v96, v236, v237
v_exp_f32 v239, v143
v_add_f32 v227, v227, v237
v_add_f32 v227, v227, v238
v_add_f32 v227, v227, v239
v_cvt_pk_bf16_f32 v97, v238, v239
v_max3_f32 v242, v224, v225, v226
v_max_f32 v242, v242, v227
v_cmp_lt_f32 vcc, s32, v242
s_cbranch_vccnz L2_rare_site16
L2_ret16:
v_mfma_f32_16x16x32_bf16 a[0:3], v[8:11], v[208:211], a[0:3]
ds_read_b64_tr_b16 v[222:223], v247 offset:18432
s_and_b64 s[38:39], s[38:39], s[96:97]
s_cbranch_scc1 LF_hl_0
LF_hlret_0:
v_mfma_f32_16x16x32_bf16 a[0:3], v[160:163], v[212:215], a[0:3]
v_exp_f32 v232, v144
v_lshrrev_b32 v241, 4, v243
v_mfma_f32_16x16x32_bf16 a[4:7], v[40:43], v[208:211], a[4:7]
v_exp_f32 v233, v145
v_and_b32 v241, 0x30, v241
v_mfma_f32_16x16x32_bf16 a[4:7], v[164:167], v[212:215], a[4:7]
v_exp_f32 v234, v146
v_xor_b32 v241, v241, v243
v_mfma_f32_16x16x32_bf16 a[8:11], v[72:75], v[208:211], a[8:11]
v_add_f32 v224, v224, v232
v_cvt_pk_bf16_f32 v2, v232, v233
v_mfma_f32_16x16x32_bf16 a[8:11], v[168:171], v[212:215], a[8:11]
v_exp_f32 v235, v147
v_mfma_f32_16x16x32_bf16 a[12:15], v[104:107], v[208:211], a[12:15]
ds_read_b64_tr_b16 v[208:209], v13 offset:0
ds_read_b64_tr_b16 v[210:211], v13 offset:2048
v_mfma_f32_16x16x32_bf16 a[12:15], v[172:175], v[212:215], a[12:15]
ds_read_b64_tr_b16 v[212:213], v13 offset:16384
s_waitcnt lgkmcnt(5)
v_mfma_f32_16x16x32_bf16 a[0:3], v[176:179], v[216:219], a[0:3]
ds_read_b64_tr_b16 v[214:215], v13 offset:18432
v_add_f32 v224, v224, v233
v_mfma_f32_16x16x32_bf16 a[4:7], v[180:183], v[216:219], a[4:7]
v_add_f32 v224, v224, v234
v_add_f32 v224, v224, v235
v_mfma_f32_16x16x32_bf16 a[8:11], v[184:187], v[216:219], a[8:11]
v_cvt_pk_bf16_f32 v3, v234, v235
v_and_b32 v228, 0x380, v243
v_mad_u32_u24 v241, v228, 3, v241
v_mfma_f32_16x16x32_bf16 a[12:15], v[188:191], v[216:219], a[12:15]
ds_read_b64_tr_b16 v[216:217], v246 offset:16896
s_waitcnt lgkmcnt(5)
v_add_u32 v241, 0x7000000, v241
v_mfma_f32_16x16x32_bf16 a[16:19], v[8:11], v[220:223], a[16:19]
ds_read_b64_tr_b16 v[218:219], v246 offset:18944
v_and_b32 v110, 0x70, v243
v_lshlrev_b32 v110, 3, v110
v_mfma_f32_16x16x32_bf16 a[20:23], v[40:43], v[220:223], a[20:23]
v_exp_f32 v236, v148
v_add_u32 v110, 0x7c32000, v110
v_mfma_f32_16x16x32_bf16 a[24:27], v[72:75], v[220:223], a[24:27]
v_exp_f32 v237, v149
buffer_load_dwordx2 v[108:109], v110, s[16:19], 0 offen sc1
v_mfma_f32_16x16x32_bf16 a[28:31], v[104:107], v[220:223], a[28:31]
ds_read_b64_tr_b16 v[220:221], v12 offset:512
s_waitcnt lgkmcnt(3)
v_mfma_f32_16x16x32_bf16 a[16:19], v[160:163], v[208:211], a[16:19]
ds_read_b64_tr_b16 v[222:223], v12 offset:2560
s_add_u32 m0, s28, 0
v_mfma_f32_16x16x32_bf16 a[16:19], v[176:179], v[212:215], a[16:19]
v_exp_f32 v238, v150
v_mfma_f32_16x16x32_bf16 a[20:23], v[164:167], v[208:211], a[20:23]
v_add_f32 v225, v225, v236
v_cvt_pk_bf16_f32 v34, v236, v237
v_mfma_f32_16x16x32_bf16 a[20:23], v[180:183], v[212:215], a[20:23]
v_exp_f32 v239, v151
v_mfma_f32_16x16x32_bf16 a[24:27], v[168:171], v[208:211], a[24:27]
v_add_f32 v225, v225, v237
v_add_f32 v225, v225, v238
v_mfma_f32_16x16x32_bf16 a[24:27], v[184:187], v[212:215], a[24:27]
v_add_f32 v225, v225, v239
v_cvt_pk_bf16_f32 v35, v238, v239
v_mfma_f32_16x16x32_bf16 a[28:31], v[172:175], v[208:211], a[28:31]
ds_read_b64_tr_b16 v[208:209], v12 offset:16896
ds_read_b64_tr_b16 v[210:211], v12 offset:18944
v_mfma_f32_16x16x32_bf16 a[28:31], v[188:191], v[212:215], a[28:31]
ds_read_b64_tr_b16 v[212:213], v247 offset:16896
s_waitcnt lgkmcnt(3)
v_mfma_f32_16x16x32_bf16 a[32:35], v[8:11], v[216:219], a[32:35]
ds_read_b64_tr_b16 v[214:215], v247 offset:18944
buffer_load_dwordx4 v241, s[16:19], s6 offen sc1 lds
s_add_u32 m0, s28, 8192
v_mfma_f32_16x16x32_bf16 a[32:35], v[160:163], v[220:223], a[32:35]
v_exp_f32 v232, v152
v_mfma_f32_16x16x32_bf16 a[36:39], v[40:43], v[216:219], a[36:39]
v_exp_f32 v233, v153
v_mfma_f32_16x16x32_bf16 a[36:39], v[164:167], v[220:223], a[36:39]
v_exp_f32 v234, v154
v_mfma_f32_16x16x32_bf16 a[40:43], v[72:75], v[216:219], a[40:43]
v_add_f32 v226, v226, v232
v_cvt_pk_bf16_f32 v66, v232, v233
v_mfma_f32_16x16x32_bf16 a[40:43], v[168:171], v[220:223], a[40:43]
v_exp_f32 v235, v155
v_mfma_f32_16x16x32_bf16 a[44:47], v[104:107], v[216:219], a[44:47]
ds_read_b64_tr_b16 v[216:217], v13 offset:512
ds_read_b64_tr_b16 v[218:219], v13 offset:2560
v_mfma_f32_16x16x32_bf16 a[44:47], v[172:175], v[220:223], a[44:47]
ds_read_b64_tr_b16 v[220:221], v13 offset:16896
s_waitcnt lgkmcnt(5)
v_mfma_f32_16x16x32_bf16 a[32:35], v[176:179], v[208:211], a[32:35]
ds_read_b64_tr_b16 v[222:223], v13 offset:18944
v_add_f32 v226, v226, v233
v_mfma_f32_16x16x32_bf16 a[36:39], v[180:183], v[208:211], a[36:39]
v_add_f32 v226, v226, v234
v_add_f32 v226, v226, v235
v_mfma_f32_16x16x32_bf16 a[40:43], v[184:187], v[208:211], a[40:43]
v_cvt_pk_bf16_f32 v67, v234, v235
buffer_load_dwordx4 v241, s[16:19], s7 offen sc1 lds
s_add_u32 m0, s30, 0
v_mfma_f32_16x16x32_bf16 a[44:47], v[188:191], v[208:211], a[44:47]
ds_read_b64_tr_b16 v[208:209], v14 offset:0
s_waitcnt lgkmcnt(5)
v_mfma_f32_16x16x32_bf16 a[48:51], v[8:11], v[212:215], a[48:51]
ds_read_b64_tr_b16 v[210:211], v14 offset:2048
buffer_load_dwordx4 v241, s[16:19], s29 offen sc1 lds
s_add_u32 m0, s28, 4096
v_mfma_f32_16x16x32_bf16 a[52:55], v[40:43], v[212:215], a[52:55]
v_exp_f32 v236, v156
v_xor_b32 v241, 0x1040, v241
v_mfma_f32_16x16x32_bf16 a[56:59], v[72:75], v[212:215], a[56:59]
v_exp_f32 v237, v157
v_mfma_f32_16x16x32_bf16 a[60:63], v[104:107], v[212:215], a[60:63]
ds_read_b64_tr_b16 v[212:213], v15 offset:0
s_waitcnt lgkmcnt(3)
v_mfma_f32_16x16x32_bf16 a[48:51], v[160:163], v[216:219], a[48:51]
ds_read_b64_tr_b16 v[214:215], v15 offset:2048
buffer_load_dwordx4 v241, s[16:19], s6 offen sc1 lds
s_add_u32 m0, s28, 12288
v_mfma_f32_16x16x32_bf16 a[48:51], v[176:179], v[220:223], a[48:51]
v_exp_f32 v238, v158
v_mfma_f32_16x16x32_bf16 a[52:55], v[164:167], v[216:219], a[52:55]
v_add_f32 v227, v227, v236
v_cvt_pk_bf16_f32 v98, v236, v237
v_mfma_f32_16x16x32_bf16 a[52:55], v[180:183], v[220:223], a[52:55]
v_exp_f32 v239, v159
v_mfma_f32_16x16x32_bf16 a[56:59], v[168:171], v[216:219], a[56:59]
v_add_f32 v227, v227, v237
v_add_f32 v227, v227, v238
v_mfma_f32_16x16x32_bf16 a[56:59], v[184:187], v[220:223], a[56:59]
v_add_f32 v227, v227, v239
v_cvt_pk_bf16_f32 v99, v238, v239
v_mfma_f32_16x16x32_bf16 a[60:63], v[172:175], v[216:219], a[60:63]
ds_read_b64_tr_b16 v[216:217], v14 offset:512
ds_read_b64_tr_b16 v[218:219], v14 offset:2560
v_max3_f32 v242, v224, v225, v226
v_max_f32 v242, v242, v227
v_cmp_lt_f32 vcc, s32, v242
s_cbranch_vccnz L2_rare_site17
L2_ret17:
v_mfma_f32_16x16x32_bf16 a[60:63], v[188:191], v[220:223], a[60:63]
ds_read_b64_tr_b16 v[220:221], v15 offset:512
s_waitcnt lgkmcnt(5)
v_mfma_f32_16x16x32_bf16 a[0:3], v[0:3], v[208:211], a[0:3]
ds_read_b64_tr_b16 v[222:223], v15 offset:2560
buffer_load_dwordx4 v241, s[16:19], s7 offen sc1 lds
s_add_u32 m0, s30, 4096
v_mfma_f32_16x16x32_bf16 a[4:7], v[32:35], v[208:211], a[4:7]
buffer_load_dwordx4 v241, s[16:19], s29 offen sc1 lds
v_bfe_u32 v242, v243, 8, 1
v_mfma_f32_16x16x32_bf16 a[8:11], v[64:67], v[208:211], a[8:11]
v_mul_u32_u24 v242, 48, v242
v_lshl_add_u32 v242, s37, 3, v242
v_and_b32 v228, 0xf0, v243
v_mfma_f32_16x16x32_bf16 a[12:15], v[96:99], v[208:211], a[12:15]
ds_read_b64_tr_b16 v[208:209], v246 offset:20480
s_waitcnt lgkmcnt(5)
v_lshl_add_u32 v242, v228, 3, v242
v_mfma_f32_16x16x32_bf16 a[16:19], v[0:3], v[212:215], a[16:19]
ds_read_b64_tr_b16 v[210:211], v246 offset:22528
v_mov_b32 v232, v224
v_mov_b32 v234, v225
v_mfma_f32_16x16x32_bf16 a[20:23], v[32:35], v[212:215], a[20:23]
v_mov_b32 v236, v226
v_mov_b32 v238, v227
v_permlane32_swap_b32 v224, v232
v_mfma_f32_16x16x32_bf16 a[24:27], v[64:67], v[212:215], a[24:27]
v_permlane32_swap_b32 v225, v234
v_permlane32_swap_b32 v226, v236
v_permlane32_swap_b32 v227, v238
v_mfma_f32_16x16x32_bf16 a[28:31], v[96:99], v[212:215], a[28:31]
ds_read_b64_tr_b16 v[212:213], v12 offset:4096
s_waitcnt lgkmcnt(5)
v_add_f32 v224, v224, v232
v_mfma_f32_16x16x32_bf16 a[32:35], v[0:3], v[216:219], a[32:35]
ds_read_b64_tr_b16 v[214:215], v12 offset:6144
v_add_f32 v225, v225, v234
v_add_f32 v226, v226, v236
v_mfma_f32_16x16x32_bf16 a[36:39], v[32:35], v[216:219], a[36:39]
v_add_f32 v227, v227, v238
v_mov_b32 v232, v224
v_mov_b32 v234, v225
v_mfma_f32_16x16x32_bf16 a[40:43], v[64:67], v[216:219], a[40:43]
v_mov_b32 v236, v226
v_mov_b32 v238, v227
v_permlane16_swap_b32 v224, v232
v_mfma_f32_16x16x32_bf16 a[44:47], v[96:99], v[216:219], a[44:47]
ds_read_b64_tr_b16 v[216:217], v12 offset:20480
s_waitcnt lgkmcnt(5)
v_permlane16_swap_b32 v225, v234
v_mfma_f32_16x16x32_bf16 a[48:51], v[0:3], v[220:223], a[48:51]
ds_read_b64_tr_b16 v[218:219], v12 offset:22528
v_permlane16_swap_b32 v226, v236
v_permlane16_swap_b32 v227, v238
v_mfma_f32_16x16x32_bf16 a[52:55], v[32:35], v[220:223], a[52:55]
v_add_f32 v233, v224, v232
v_add_f32 v235, v225, v234
v_add_f32 v237, v226, v236
v_mfma_f32_16x16x32_bf16 a[56:59], v[64:67], v[220:223], a[56:59]
v_add_f32 v239, v227, v238
v_sub_f32 v232, 0, v192
v_sub_f32 v234, 0, v196
v_mfma_f32_16x16x32_bf16 a[60:63], v[96:99], v[220:223], a[60:63]
ds_read_b64_tr_b16 v[220:221], v14 offset:4096
s_waitcnt lgkmcnt(3)
v_sub_f32 v236, 0, v200
v_mfma_f32_16x16x32_bf16 a[64:67], v[8:11], v[208:211], a[64:67]
ds_read_b64_tr_b16 v[222:223], v14 offset:6144
v_sub_f32 v238, 0, v204
v_mfma_f32_16x16x32_bf16 a[64:67], v[160:163], v[212:215], a[64:67]
s_mov_b32 exec_hi, 0
buffer_store_dwordx2 v[232:233], v242, s[24:27], s48 offen sc1
s_lshr_b32 s3, s41, 2
buffer_store_dwordx2 v[234:235], v242, s[24:27], s3 offen sc1
s_lshr_b32 s3, s42, 2
buffer_store_dwordx2 v[236:237], v242, s[24:27], s3 offen sc1
s_lshr_b32 s3, s43, 2
buffer_store_dwordx2 v[238:239], v242, s[24:27], s3 offen sc1
s_mov_b32 exec_hi, -1
v_mfma_f32_16x16x32_bf16 a[68:71], v[40:43], v[208:211], a[68:71]
v_accvgpr_read_b32 v128, a0
v_accvgpr_read_b32 v129, a1
v_accvgpr_read_b32 v130, a2
v_mfma_f32_16x16x32_bf16 a[68:71], v[164:167], v[212:215], a[68:71]
v_accvgpr_read_b32 v131, a3
v_cvt_pk_bf16_f32 v16, v128, v129
v_cvt_pk_bf16_f32 v17, v130, v131
v_mfma_f32_16x16x32_bf16 a[72:75], v[72:75], v[208:211], a[72:75]
v_accvgpr_read_b32 v136, a4
v_accvgpr_read_b32 v137, a5
v_accvgpr_read_b32 v138, a6
v_mfma_f32_16x16x32_bf16 a[72:75], v[168:171], v[212:215], a[72:75]
v_accvgpr_read_b32 v139, a7
v_cvt_pk_bf16_f32 v48, v136, v137
v_cvt_pk_bf16_f32 v49, v138, v139
v_mfma_f32_16x16x32_bf16 a[76:79], v[104:107], v[208:211], a[76:79]
ds_read_b64_tr_b16 v[208:209], v247 offset:20480
ds_read_b64_tr_b16 v[210:211], v247 offset:22528
v_accvgpr_read_b32 v144, a8
v_mfma_f32_16x16x32_bf16 a[76:79], v[172:175], v[212:215], a[76:79]
ds_read_b64_tr_b16 v[212:213], v13 offset:4096
s_waitcnt lgkmcnt(3)
v_accvgpr_read_b32 v145, a9
v_mfma_f32_16x16x32_bf16 a[64:67], v[176:179], v[216:219], a[64:67]
ds_read_b64_tr_b16 v[214:215], v13 offset:6144
v_accvgpr_read_b32 v146, a10
v_accvgpr_read_b32 v147, a11
v_mfma_f32_16x16x32_bf16 a[64:67], v[0:3], v[220:223], a[64:67]
v_cvt_pk_bf16_f32 v80, v144, v145
v_cvt_pk_bf16_f32 v81, v146, v147
v_accvgpr_read_b32 v152, a12
v_mfma_f32_16x16x32_bf16 a[68:71], v[180:183], v[216:219], a[68:71]
v_accvgpr_read_b32 v153, a13
v_accvgpr_read_b32 v154, a14
v_accvgpr_read_b32 v155, a15
v_mfma_f32_16x16x32_bf16 a[68:71], v[32:35], v[220:223], a[68:71]
v_cvt_pk_bf16_f32 v112, v152, v153
v_cvt_pk_bf16_f32 v113, v154, v155
v_accvgpr_read_b32 v132, a16
v_mfma_f32_16x16x32_bf16 a[72:75], v[184:187], v[216:219], a[72:75]
v_accvgpr_read_b32 v133, a17
v_accvgpr_read_b32 v134, a18
v_accvgpr_read_b32 v135, a19
v_mfma_f32_16x16x32_bf16 a[72:75], v[64:67], v[220:223], a[72:75]
v_cvt_pk_bf16_f32 v18, v132, v133
v_cvt_pk_bf16_f32 v19, v134, v135
buffer_store_dwordx4 v[16:19], v243, s[20:23], s40 offen offset:0 sc1
v_mfma_f32_16x16x32_bf16 a[76:79], v[188:191], v[216:219], a[76:79]
ds_read_b64_tr_b16 v[216:217], v13 offset:20480
ds_read_b64_tr_b16 v[218:219], v13 offset:22528
ds_write_b128 v231, v[16:19] offset:0
v_mfma_f32_16x16x32_bf16 a[76:79], v[96:99], v[220:223], a[76:79]
ds_read_b64_tr_b16 v[220:221], v15 offset:4096
s_waitcnt lgkmcnt(3)
v_accvgpr_read_b32 v140, a20
v_mfma_f32_16x16x32_bf16 a[80:83], v[8:11], v[208:211], a[80:83]
ds_read_b64_tr_b16 v[222:223], v15 offset:6144
v_accvgpr_read_b32 v141, a21
v_accvgpr_read_b32 v142, a22
v_mfma_f32_16x16x32_bf16 a[80:83], v[160:163], v[212:215], a[80:83]
v_accvgpr_read_b32 v143, a23
v_cvt_pk_bf16_f32 v50, v140, v141
v_cvt_pk_bf16_f32 v51, v142, v143
v_mfma_f32_16x16x32_bf16 a[84:87], v[40:43], v[208:211], a[84:87]
buffer_store_dwordx4 v[48:51], v243, s[20:23], s41 offen offset:0 sc1
v_accvgpr_read_b32 v148, a24
v_accvgpr_read_b32 v149, a25
v_mfma_f32_16x16x32_bf16 a[84:87], v[164:167], v[212:215], a[84:87]
v_accvgpr_read_b32 v150, a26
v_accvgpr_read_b32 v151, a27
v_cvt_pk_bf16_f32 v82, v148, v149
v_mfma_f32_16x16x32_bf16 a[88:91], v[72:75], v[208:211], a[88:91]
v_cvt_pk_bf16_f32 v83, v150, v151
buffer_store_dwordx4 v[80:83], v243, s[20:23], s42 offen offset:0 sc1
v_accvgpr_read_b32 v156, a28
v_mfma_f32_16x16x32_bf16 a[88:91], v[168:171], v[212:215], a[88:91]
v_accvgpr_read_b32 v157, a29
v_accvgpr_read_b32 v158, a30
v_accvgpr_read_b32 v159, a31
v_mfma_f32_16x16x32_bf16 a[92:95], v[104:107], v[208:211], a[92:95]
ds_read_b64_tr_b16 v[208:209], v246 offset:20992
ds_read_b64_tr_b16 v[210:211], v246 offset:23040
v_cvt_pk_bf16_f32 v114, v156, v157
v_mfma_f32_16x16x32_bf16 a[92:95], v[172:175], v[212:215], a[92:95]
ds_read_b64_tr_b16 v[212:213], v12 offset:4608
s_waitcnt lgkmcnt(3)
v_cvt_pk_bf16_f32 v115, v158, v159
v_mfma_f32_16x16x32_bf16 a[80:83], v[176:179], v[216:219], a[80:83]
ds_read_b64_tr_b16 v[214:215], v12 offset:6656
buffer_store_dwordx4 v[112:115], v243, s[20:23], s43 offen offset:0 sc1
v_accvgpr_read_b32 v128, a32
v_mfma_f32_16x16x32_bf16 a[80:83], v[0:3], v[220:223], a[80:83]
v_accvgpr_read_b32 v129, a33
v_accvgpr_read_b32 v130, a34
v_accvgpr_read_b32 v131, a35
v_mfma_f32_16x16x32_bf16 a[84:87], v[180:183], v[216:219], a[84:87]
v_cvt_pk_bf16_f32 v20, v128, v129
v_cvt_pk_bf16_f32 v21, v130, v131
v_accvgpr_read_b32 v136, a36
v_mfma_f32_16x16x32_bf16 a[84:87], v[32:35], v[220:223], a[84:87]
v_accvgpr_read_b32 v137, a37
v_accvgpr_read_b32 v138, a38
v_accvgpr_read_b32 v139, a39
v_mfma_f32_16x16x32_bf16 a[88:91], v[184:187], v[216:219], a[88:91]
v_cvt_pk_bf16_f32 v52, v136, v137
v_cvt_pk_bf16_f32 v53, v138, v139
v_accvgpr_read_b32 v144, a40
v_mfma_f32_16x16x32_bf16 a[88:91], v[64:67], v[220:223], a[88:91]
v_accvgpr_read_b32 v145, a41
v_accvgpr_read_b32 v146, a42
v_accvgpr_read_b32 v147, a43
v_mfma_f32_16x16x32_bf16 a[92:95], v[188:191], v[216:219], a[92:95]
ds_read_b64_tr_b16 v[216:217], v12 offset:20992
ds_read_b64_tr_b16 v[218:219], v12 offset:23040
v_cvt_pk_bf16_f32 v84, v144, v145
v_mfma_f32_16x16x32_bf16 a[92:95], v[96:99], v[220:223], a[92:95]
ds_read_b64_tr_b16 v[220:221], v14 offset:4608
s_waitcnt lgkmcnt(3)
v_cvt_pk_bf16_f32 v85, v146, v147
v_mfma_f32_16x16x32_bf16 a[96:99], v[8:11], v[208:211], a[96:99]
ds_read_b64_tr_b16 v[222:223], v14 offset:6656
v_accvgpr_read_b32 v152, a44
v_accvgpr_read_b32 v153, a45
v_mfma_f32_16x16x32_bf16 a[96:99], v[160:163], v[212:215], a[96:99]
v_accvgpr_read_b32 v154, a46
v_accvgpr_read_b32 v155, a47
v_cvt_pk_bf16_f32 v116, v152, v153
v_mfma_f32_16x16x32_bf16 a[100:103], v[40:43], v[208:211], a[100:103]
v_cvt_pk_bf16_f32 v117, v154, v155
v_accvgpr_read_b32 v132, a48
v_accvgpr_read_b32 v133, a49
v_mfma_f32_16x16x32_bf16 a[100:103], v[164:167], v[212:215], a[100:103]
v_accvgpr_read_b32 v134, a50
v_accvgpr_read_b32 v135, a51
v_cvt_pk_bf16_f32 v22, v132, v133
v_mfma_f32_16x16x32_bf16 a[104:107], v[72:75], v[208:211], a[104:107]
v_cvt_pk_bf16_f32 v23, v134, v135
buffer_store_dwordx4 v[20:23], v243, s[20:23], s40 offen offset:1024 sc1
ds_write_b128 v231, v[20:23] offset:1024
v_mfma_f32_16x16x32_bf16 a[104:107], v[168:171], v[212:215], a[104:107]
v_accvgpr_read_b32 v140, a52
v_accvgpr_read_b32 v141, a53
v_accvgpr_read_b32 v142, a54
v_mfma_f32_16x16x32_bf16 a[108:111], v[104:107], v[208:211], a[108:111]
ds_read_b64_tr_b16 v[208:209], v247 offset:20992
ds_read_b64_tr_b16 v[210:211], v247 offset:23040
v_accvgpr_read_b32 v143, a55
v_mfma_f32_16x16x32_bf16 a[108:111], v[172:175], v[212:215], a[108:111]
ds_read_b64_tr_b16 v[212:213], v13 offset:4608
s_waitcnt lgkmcnt(3)
v_cvt_pk_bf16_f32 v54, v140, v141
v_mfma_f32_16x16x32_bf16 a[96:99], v[176:179], v[216:219], a[96:99]
ds_read_b64_tr_b16 v[214:215], v13 offset:6656
v_cvt_pk_bf16_f32 v55, v142, v143
buffer_store_dwordx4 v[52:55], v243, s[20:23], s41 offen offset:1024 sc1
v_mfma_f32_16x16x32_bf16 a[96:99], v[0:3], v[220:223], a[96:99]
v_accvgpr_read_b32 v148, a56
v_accvgpr_read_b32 v149, a57
v_accvgpr_read_b32 v150, a58
v_mfma_f32_16x16x32_bf16 a[100:103], v[180:183], v[216:219], a[100:103]
v_accvgpr_read_b32 v151, a59
v_cvt_pk_bf16_f32 v86, v148, v149
v_cvt_pk_bf16_f32 v87, v150, v151
v_mfma_f32_16x16x32_bf16 a[100:103], v[32:35], v[220:223], a[100:103]
buffer_store_dwordx4 v[84:87], v243, s[20:23], s42 offen offset:1024 sc1
v_accvgpr_read_b32 v156, a60
v_accvgpr_read_b32 v157, a61
v_mfma_f32_16x16x32_bf16 a[104:107], v[184:187], v[216:219], a[104:107]
v_accvgpr_read_b32 v158, a62
v_accvgpr_read_b32 v159, a63
v_cvt_pk_bf16_f32 v118, v156, v157
v_mfma_f32_16x16x32_bf16 a[104:107], v[64:67], v[220:223], a[104:107]
v_cvt_pk_bf16_f32 v119, v158, v159
buffer_store_dwordx4 v[116:119], v243, s[20:23], s43 offen offset:1024 sc1
v_accvgpr_read_b32 v128, a64
v_mfma_f32_16x16x32_bf16 a[108:111], v[188:191], v[216:219], a[108:111]
ds_read_b64_tr_b16 v[216:217], v13 offset:20992
ds_read_b64_tr_b16 v[218:219], v13 offset:23040
v_accvgpr_read_b32 v129, a65
v_mfma_f32_16x16x32_bf16 a[108:111], v[96:99], v[220:223], a[108:111]
ds_read_b64_tr_b16 v[220:221], v15 offset:4608
s_waitcnt lgkmcnt(3)
v_accvgpr_read_b32 v130, a66
v_mfma_f32_16x16x32_bf16 a[112:115], v[8:11], v[208:211], a[112:115]
ds_read_b64_tr_b16 v[222:223], v15 offset:6656
v_accvgpr_read_b32 v131, a67
v_cvt_pk_bf16_f32 v24, v128, v129
v_mfma_f32_16x16x32_bf16 a[112:115], v[160:163], v[212:215], a[112:115]
v_cvt_pk_bf16_f32 v25, v130, v131
v_accvgpr_read_b32 v136, a68
v_accvgpr_read_b32 v137, a69
v_mfma_f32_16x16x32_bf16 a[116:119], v[40:43], v[208:211], a[116:119]
v_accvgpr_read_b32 v138, a70
v_accvgpr_read_b32 v139, a71
v_cvt_pk_bf16_f32 v56, v136, v137
v_mfma_f32_16x16x32_bf16 a[116:119], v[164:167], v[212:215], a[116:119]
v_cvt_pk_bf16_f32 v57, v138, v139
v_accvgpr_read_b32 v144, a72
v_accvgpr_read_b32 v145, a73
v_mfma_f32_16x16x32_bf16 a[120:123], v[72:75], v[208:211], a[120:123]
v_accvgpr_read_b32 v146, a74
v_accvgpr_read_b32 v147, a75
v_cvt_pk_bf16_f32 v88, v144, v145
v_mfma_f32_16x16x32_bf16 a[120:123], v[168:171], v[212:215], a[120:123]
v_cvt_pk_bf16_f32 v89, v146, v147
v_accvgpr_read_b32 v152, a76
v_accvgpr_read_b32 v153, a77
v_mfma_f32_16x16x32_bf16 a[124:127], v[104:107], v[208:211], a[124:127]
ds_read_b64_tr_b16 v[208:209], v246 offset:8192
ds_read_b64_tr_b16 v[210:211], v246 offset:10240
v_accvgpr_read_b32 v154, a78
v_mfma_f32_16x16x32_bf16 a[124:127], v[172:175], v[212:215], a[124:127]
ds_read_b64_tr_b16 v[212:213], v246 offset:24576
s_waitcnt lgkmcnt(3)
v_accvgpr_read_b32 v155, a79
v_mfma_f32_16x16x32_bf16 a[112:115], v[176:179], v[216:219], a[112:115]
ds_read_b64_tr_b16 v[214:215], v246 offset:26624
v_cvt_pk_bf16_f32 v120, v152, v153
v_cvt_pk_bf16_f32 v121, v154, v155
v_mfma_f32_16x16x32_bf16 a[112:115], v[0:3], v[220:223], a[112:115]
v_accvgpr_read_b32 v132, a80
v_accvgpr_read_b32 v133, a81
v_accvgpr_read_b32 v134, a82
v_mfma_f32_16x16x32_bf16 a[116:119], v[180:183], v[216:219], a[116:119]
v_accvgpr_read_b32 v135, a83
v_cvt_pk_bf16_f32 v26, v132, v133
v_cvt_pk_bf16_f32 v27, v134, v135
v_mfma_f32_16x16x32_bf16 a[116:119], v[32:35], v[220:223], a[116:119]
buffer_store_dwordx4 v[24:27], v243, s[20:23], s40 offen offset:2048 sc1
ds_write_b128 v231, v[24:27] offset:2048
v_accvgpr_read_b32 v140, a84
v_mfma_f32_16x16x32_bf16 a[120:123], v[184:187], v[216:219], a[120:123]
v_accvgpr_read_b32 v141, a85
v_accvgpr_read_b32 v142, a86
v_accvgpr_read_b32 v143, a87
v_mfma_f32_16x16x32_bf16 a[120:123], v[64:67], v[220:223], a[120:123]
v_cvt_pk_bf16_f32 v58, v140, v141
v_cvt_pk_bf16_f32 v59, v142, v143
buffer_store_dwordx4 v[56:59], v243, s[20:23], s41 offen offset:2048 sc1
v_mfma_f32_16x16x32_bf16 a[124:127], v[188:191], v[216:219], a[124:127]
ds_read_b64_tr_b16 v[216:217], v12 offset:8192
ds_read_b64_tr_b16 v[218:219], v12 offset:10240
v_accvgpr_read_b32 v148, a88
v_mfma_f32_16x16x32_bf16 a[124:127], v[96:99], v[220:223], a[124:127]
ds_read_b64_tr_b16 v[220:221], v12 offset:24576
s_waitcnt lgkmcnt(3)
v_accvgpr_read_b32 v149, a89
v_mfma_f32_16x16x32_bf16 a[128:131], v[4:7], v[208:211], a[128:131]
ds_read_b64_tr_b16 v[222:223], v12 offset:26624
v_accvgpr_read_b32 v150, a90
v_accvgpr_read_b32 v151, a91
v_mfma_f32_16x16x32_bf16 a[128:131], v[8:11], v[212:215], a[128:131]
v_cvt_pk_bf16_f32 v90, v148, v149
v_cvt_pk_bf16_f32 v91, v150, v151
buffer_store_dwordx4 v[88:91], v243, s[20:23], s42 offen offset:2048 sc1
v_mfma_f32_16x16x32_bf16 a[132:135], v[36:39], v[208:211], a[132:135]
v_accvgpr_read_b32 v156, a92
v_accvgpr_read_b32 v157, a93
v_accvgpr_read_b32 v158, a94
v_mfma_f32_16x16x32_bf16 a[132:135], v[40:43], v[212:215], a[132:135]
v_accvgpr_read_b32 v159, a95
v_cvt_pk_bf16_f32 v122, v156, v157
v_cvt_pk_bf16_f32 v123, v158, v159
v_mfma_f32_16x16x32_bf16 a[136:139], v[68:71], v[208:211], a[136:139]
buffer_store_dwordx4 v[120:123], v243, s[20:23], s43 offen offset:2048 sc1
v_accvgpr_read_b32 v128, a96
v_mfma_f32_16x16x32_bf16 a[136:139], v[72:75], v[212:215], a[136:139]
v_accvgpr_read_b32 v129, a97
v_accvgpr_read_b32 v130, a98
v_mfma_f32_16x16x32_bf16 a[140:143], v[100:103], v[208:211], a[140:143]
ds_read_b64_tr_b16 v[208:209], v14 offset:8192
ds_read_b64_tr_b16 v[210:211], v14 offset:10240
v_mfma_f32_16x16x32_bf16 a[140:143], v[104:107], v[212:215], a[140:143]
ds_read_b64_tr_b16 v[212:213], v247 offset:8192
s_waitcnt lgkmcnt(3)
v_mfma_f32_16x16x32_bf16 a[128:131], v[160:163], v[216:219], a[128:131]
ds_read_b64_tr_b16 v[214:215], v247 offset:10240
v_accvgpr_read_b32 v131, a99
v_mfma_f32_16x16x32_bf16 a[128:131], v[176:179], v[220:223], a[128:131]
v_cvt_pk_bf16_f32 v28, v128, v129
v_cvt_pk_bf16_f32 v29, v130, v131
v_mfma_f32_16x16x32_bf16 a[132:135], v[164:167], v[216:219], a[132:135]
v_accvgpr_read_b32 v136, a100
v_accvgpr_read_b32 v137, a101
v_mfma_f32_16x16x32_bf16 a[132:135], v[180:183], v[220:223], a[132:135]
v_accvgpr_read_b32 v138, a102
v_accvgpr_read_b32 v139, a103
v_mfma_f32_16x16x32_bf16 a[136:139], v[168:171], v[216:219], a[136:139]
v_cvt_pk_bf16_f32 v60, v136, v137
v_cvt_pk_bf16_f32 v61, v138, v139
v_mfma_f32_16x16x32_bf16 a[136:139], v[184:187], v[220:223], a[136:139]
v_accvgpr_read_b32 v144, a104
v_accvgpr_read_b32 v145, a105
v_mfma_f32_16x16x32_bf16 a[140:143], v[172:175], v[216:219], a[140:143]
ds_read_b64_tr_b16 v[216:217], v247 offset:24576
ds_read_b64_tr_b16 v[218:219], v247 offset:26624
v_mfma_f32_16x16x32_bf16 a[140:143], v[188:191], v[220:223], a[140:143]
ds_read_b64_tr_b16 v[220:221], v13 offset:8192
s_waitcnt lgkmcnt(5)
v_mfma_f32_16x16x32_bf16 a[128:131], v[0:3], v[208:211], a[128:131]
ds_read_b64_tr_b16 v[222:223], v13 offset:10240
v_accvgpr_read_b32 v146, a106
v_mfma_f32_16x16x32_bf16 a[132:135], v[32:35], v[208:211], a[132:135]
v_accvgpr_read_b32 v147, a107
v_cvt_pk_bf16_f32 v92, v144, v145
v_mfma_f32_16x16x32_bf16 a[136:139], v[64:67], v[208:211], a[136:139]
v_cvt_pk_bf16_f32 v93, v146, v147
v_accvgpr_read_b32 v152, a108
v_mfma_f32_16x16x32_bf16 a[140:143], v[96:99], v[208:211], a[140:143]
ds_read_b64_tr_b16 v[208:209], v13 offset:24576
s_waitcnt lgkmcnt(5)
v_mfma_f32_16x16x32_bf16 a[144:147], v[4:7], v[212:215], a[144:147]
ds_read_b64_tr_b16 v[210:211], v13 offset:26624
v_accvgpr_read_b32 v153, a109
v_mfma_f32_16x16x32_bf16 a[148:151], v[36:39], v[212:215], a[148:151]
v_accvgpr_read_b32 v154, a110
v_accvgpr_read_b32 v155, a111
v_mfma_f32_16x16x32_bf16 a[152:155], v[68:71], v[212:215], a[152:155]
v_cvt_pk_bf16_f32 v124, v152, v153
v_cvt_pk_bf16_f32 v125, v154, v155
v_mfma_f32_16x16x32_bf16 a[156:159], v[100:103], v[212:215], a[156:159]
ds_read_b64_tr_b16 v[212:213], v15 offset:8192
s_waitcnt lgkmcnt(3)
v_mfma_f32_16x16x32_bf16 a[144:147], v[8:11], v[216:219], a[144:147]
ds_read_b64_tr_b16 v[214:215], v15 offset:10240
v_accvgpr_read_b32 v132, a112
v_mfma_f32_16x16x32_bf16 a[144:147], v[160:163], v[220:223], a[144:147]
v_accvgpr_read_b32 v133, a113
v_accvgpr_read_b32 v134, a114
v_mfma_f32_16x16x32_bf16 a[148:151], v[40:43], v[216:219], a[148:151]
v_accvgpr_read_b32 v135, a115
v_cvt_pk_bf16_f32 v30, v132, v133
v_mfma_f32_16x16x32_bf16 a[148:151], v[164:167], v[220:223], a[148:151]
v_cvt_pk_bf16_f32 v31, v134, v135
buffer_store_dwordx4 v[28:31], v243, s[20:23], s40 offen offset:3072 sc1
v_mfma_f32_16x16x32_bf16 a[152:155], v[72:75], v[216:219], a[152:155]
ds_write_b128 v231, v[28:31] offset:3072
v_accvgpr_read_b32 v140, a116
v_mfma_f32_16x16x32_bf16 a[152:155], v[168:171], v[220:223], a[152:155]
v_accvgpr_read_b32 v141, a117
v_accvgpr_read_b32 v142, a118
v_mfma_f32_16x16x32_bf16 a[156:159], v[104:107], v[216:219], a[156:159]
ds_read_b64_tr_b16 v[216:217], v246 offset:8704
ds_read_b64_tr_b16 v[218:219], v246 offset:10752
v_mfma_f32_16x16x32_bf16 a[156:159], v[172:175], v[220:223], a[156:159]
ds_read_b64_tr_b16 v[220:221], v246 offset:25088
s_waitcnt lgkmcnt(3)
v_mfma_f32_16x16x32_bf16 a[144:147], v[176:179], v[208:211], a[144:147]
ds_read_b64_tr_b16 v[222:223], v246 offset:27136
v_accvgpr_read_b32 v143, a119
v_mfma_f32_16x16x32_bf16 a[144:147], v[0:3], v[212:215], a[144:147]
v_cvt_pk_bf16_f32 v62, v140, v141
v_cvt_pk_bf16_f32 v63, v142, v143
v_mfma_f32_16x16x32_bf16 a[148:151], v[180:183], v[208:211], a[148:151]
buffer_store_dwordx4 v[60:63], v243, s[20:23], s41 offen offset:3072 sc1
v_accvgpr_read_b32 v148, a120
v_mfma_f32_16x16x32_bf16 a[148:151], v[32:35], v[212:215], a[148:151]
v_accvgpr_read_b32 v149, a121
v_accvgpr_read_b32 v150, a122
v_mfma_f32_16x16x32_bf16 a[152:155], v[184:187], v[208:211], a[152:155]
v_accvgpr_read_b32 v151, a123
v_cvt_pk_bf16_f32 v94, v148, v149
v_mfma_f32_16x16x32_bf16 a[152:155], v[64:67], v[212:215], a[152:155]
v_cvt_pk_bf16_f32 v95, v150, v151
buffer_store_dwordx4 v[92:95], v243, s[20:23], s42 offen offset:3072 sc1
v_mfma_f32_16x16x32_bf16 a[156:159], v[188:191], v[208:211], a[156:159]
ds_read_b64_tr_b16 v[208:209], v12 offset:8704
ds_read_b64_tr_b16 v[210:211], v12 offset:10752
v_mfma_f32_16x16x32_bf16 a[156:159], v[96:99], v[212:215], a[156:159]
ds_read_b64_tr_b16 v[212:213], v12 offset:25088
s_waitcnt lgkmcnt(3)
v_mfma_f32_16x16x32_bf16 a[160:163], v[4:7], v[216:219], a[160:163]
ds_read_b64_tr_b16 v[214:215], v12 offset:27136
v_accvgpr_read_b32 v156, a124
v_mfma_f32_16x16x32_bf16 a[160:163], v[8:11], v[220:223], a[160:163]
v_accvgpr_read_b32 v157, a125
v_accvgpr_read_b32 v158, a126
v_mfma_f32_16x16x32_bf16 a[164:167], v[36:39], v[216:219], a[164:167]
v_accvgpr_read_b32 v159, a127
v_cvt_pk_bf16_f32 v126, v156, v157
v_mfma_f32_16x16x32_bf16 a[164:167], v[40:43], v[220:223], a[164:167]
v_cvt_pk_bf16_f32 v127, v158, v159
buffer_store_dwordx4 v[124:127], v243, s[20:23], s43 offen offset:3072 sc1
v_mfma_f32_16x16x32_bf16 a[168:171], v[68:71], v[216:219], a[168:171]
v_accvgpr_read_b32 v128, a128
v_accvgpr_read_b32 v129, a129
v_mfma_f32_16x16x32_bf16 a[168:171], v[72:75], v[220:223], a[168:171]
v_accvgpr_read_b32 v130, a130
v_accvgpr_read_b32 v131, a131
v_mfma_f32_16x16x32_bf16 a[172:175], v[100:103], v[216:219], a[172:175]
ds_read_b64_tr_b16 v[216:217], v14 offset:8704
ds_read_b64_tr_b16 v[218:219], v14 offset:10752
v_mfma_f32_16x16x32_bf16 a[172:175], v[104:107], v[220:223], a[172:175]
ds_read_b64_tr_b16 v[220:221], v247 offset:8704
s_waitcnt lgkmcnt(3)
v_mfma_f32_16x16x32_bf16 a[160:163], v[160:163], v[208:211], a[160:163]
ds_read_b64_tr_b16 v[222:223], v247 offset:10752
v_cvt_pk_bf16_f32 v16, v128, v129
v_mfma_f32_16x16x32_bf16 a[160:163], v[176:179], v[212:215], a[160:163]
v_cvt_pk_bf16_f32 v17, v130, v131
v_accvgpr_read_b32 v136, a132
v_mfma_f32_16x16x32_bf16 a[164:167], v[164:167], v[208:211], a[164:167]
v_accvgpr_read_b32 v137, a133
v_accvgpr_read_b32 v138, a134
v_mfma_f32_16x16x32_bf16 a[164:167], v[180:183], v[212:215], a[164:167]
v_accvgpr_read_b32 v139, a135
v_cvt_pk_bf16_f32 v48, v136, v137
v_mfma_f32_16x16x32_bf16 a[168:171], v[168:171], v[208:211], a[168:171]
v_cvt_pk_bf16_f32 v49, v138, v139
v_accvgpr_read_b32 v144, a136
v_mfma_f32_16x16x32_bf16 a[168:171], v[184:187], v[212:215], a[168:171]
v_accvgpr_read_b32 v145, a137
v_accvgpr_read_b32 v146, a138
v_mfma_f32_16x16x32_bf16 a[172:175], v[172:175], v[208:211], a[172:175]
ds_read_b64_tr_b16 v[208:209], v247 offset:25088
ds_read_b64_tr_b16 v[210:211], v247 offset:27136
v_mfma_f32_16x16x32_bf16 a[172:175], v[188:191], v[212:215], a[172:175]
ds_read_b64_tr_b16 v[212:213], v13 offset:8704
s_waitcnt lgkmcnt(5)
v_mfma_f32_16x16x32_bf16 a[160:163], v[0:3], v[216:219], a[160:163]
ds_read_b64_tr_b16 v[214:215], v13 offset:10752
v_accvgpr_read_b32 v147, a139
v_mfma_f32_16x16x32_bf16 a[164:167], v[32:35], v[216:219], a[164:167]
v_cvt_pk_bf16_f32 v80, v144, v145
v_cvt_pk_bf16_f32 v81, v146, v147
v_mfma_f32_16x16x32_bf16 a[168:171], v[64:67], v[216:219], a[168:171]
v_accvgpr_read_b32 v152, a140
v_accvgpr_read_b32 v153, a141
v_mfma_f32_16x16x32_bf16 a[172:175], v[96:99], v[216:219], a[172:175]
ds_read_b64_tr_b16 v[216:217], v13 offset:25088
s_waitcnt lgkmcnt(5)
v_mfma_f32_16x16x32_bf16 a[176:179], v[4:7], v[220:223], a[176:179]
ds_read_b64_tr_b16 v[218:219], v13 offset:27136
v_accvgpr_read_b32 v154, a142
v_mfma_f32_16x16x32_bf16 a[180:183], v[36:39], v[220:223], a[180:183]
v_accvgpr_read_b32 v155, a143
v_cvt_pk_bf16_f32 v112, v152, v153
v_mfma_f32_16x16x32_bf16 a[184:187], v[68:71], v[220:223], a[184:187]
v_cvt_pk_bf16_f32 v113, v154, v155
v_accvgpr_read_b32 v132, a144
v_mfma_f32_16x16x32_bf16 a[188:191], v[100:103], v[220:223], a[188:191]
ds_read_b64_tr_b16 v[220:221], v15 offset:8704
s_waitcnt lgkmcnt(3)
v_mfma_f32_16x16x32_bf16 a[176:179], v[8:11], v[208:211], a[176:179]
ds_read_b64_tr_b16 v[222:223], v15 offset:10752
v_accvgpr_read_b32 v133, a145
v_mfma_f32_16x16x32_bf16 a[176:179], v[160:163], v[212:215], a[176:179]
v_accvgpr_read_b32 v134, a146
v_accvgpr_read_b32 v135, a147
v_mfma_f32_16x16x32_bf16 a[180:183], v[40:43], v[208:211], a[180:183]
v_cvt_pk_bf16_f32 v18, v132, v133
v_cvt_pk_bf16_f32 v19, v134, v135
v_mfma_f32_16x16x32_bf16 a[180:183], v[164:167], v[212:215], a[180:183]
buffer_store_dwordx4 v[16:19], v243, s[20:23], s44 offen offset:0 sc1
ds_write_b128 v231, v[16:19] offset:4096
v_mfma_f32_16x16x32_bf16 a[184:187], v[72:75], v[208:211], a[184:187]
v_accvgpr_read_b32 v140, a148
v_accvgpr_read_b32 v141, a149
v_mfma_f32_16x16x32_bf16 a[184:187], v[168:171], v[212:215], a[184:187]
v_accvgpr_read_b32 v142, a150
v_accvgpr_read_b32 v143, a151
v_mfma_f32_16x16x32_bf16 a[188:191], v[104:107], v[208:211], a[188:191]
ds_read_b64_tr_b16 v[208:209], v246 offset:12288
ds_read_b64_tr_b16 v[210:211], v246 offset:14336
v_mfma_f32_16x16x32_bf16 a[188:191], v[172:175], v[212:215], a[188:191]
ds_read_b64_tr_b16 v[212:213], v246 offset:28672
s_waitcnt lgkmcnt(3)
v_mfma_f32_16x16x32_bf16 a[176:179], v[176:179], v[216:219], a[176:179]
ds_read_b64_tr_b16 v[214:215], v246 offset:30720
v_cvt_pk_bf16_f32 v50, v140, v141
v_mfma_f32_16x16x32_bf16 a[176:179], v[0:3], v[220:223], a[176:179]
v_cvt_pk_bf16_f32 v51, v142, v143
buffer_store_dwordx4 v[48:51], v243, s[20:23], s45 offen offset:0 sc1
v_mfma_f32_16x16x32_bf16 a[180:183], v[180:183], v[216:219], a[180:183]
v_accvgpr_read_b32 v148, a152
v_accvgpr_read_b32 v149, a153
v_mfma_f32_16x16x32_bf16 a[180:183], v[32:35], v[220:223], a[180:183]
v_accvgpr_read_b32 v150, a154
v_accvgpr_read_b32 v151, a155
v_mfma_f32_16x16x32_bf16 a[184:187], v[184:187], v[216:219], a[184:187]
v_cvt_pk_bf16_f32 v82, v148, v149
v_cvt_pk_bf16_f32 v83, v150, v151
v_mfma_f32_16x16x32_bf16 a[184:187], v[64:67], v[220:223], a[184:187]
buffer_store_dwordx4 v[80:83], v243, s[20:23], s46 offen offset:0 sc1
v_accvgpr_read_b32 v156, a156
v_mfma_f32_16x16x32_bf16 a[188:191], v[188:191], v[216:219], a[188:191]
ds_read_b64_tr_b16 v[216:217], v12 offset:12288
ds_read_b64_tr_b16 v[218:219], v12 offset:14336
v_mfma_f32_16x16x32_bf16 a[188:191], v[96:99], v[220:223], a[188:191]
ds_read_b64_tr_b16 v[220:221], v12 offset:28672
s_waitcnt lgkmcnt(3)
v_mfma_f32_16x16x32_bf16 a[192:195], v[4:7], v[208:211], a[192:195]
ds_read_b64_tr_b16 v[222:223], v12 offset:30720
v_accvgpr_read_b32 v157, a157
v_mfma_f32_16x16x32_bf16 a[192:195], v[8:11], v[212:215], a[192:195]
v_accvgpr_read_b32 v158, a158
v_accvgpr_read_b32 v159, a159
v_mfma_f32_16x16x32_bf16 a[196:199], v[36:39], v[208:211], a[196:199]
v_cvt_pk_bf16_f32 v114, v156, v157
v_cvt_pk_bf16_f32 v115, v158, v159
v_mfma_f32_16x16x32_bf16 a[196:199], v[40:43], v[212:215], a[196:199]
buffer_store_dwordx4 v[112:115], v243, s[20:23], s47 offen offset:0 sc1
v_accvgpr_read_b32 v128, a160
v_mfma_f32_16x16x32_bf16 a[200:203], v[68:71], v[208:211], a[200:203]
v_accvgpr_read_b32 v129, a161
v_accvgpr_read_b32 v130, a162
v_mfma_f32_16x16x32_bf16 a[200:203], v[72:75], v[212:215], a[200:203]
v_accvgpr_read_b32 v131, a163
v_cvt_pk_bf16_f32 v20, v128, v129
v_mfma_f32_16x16x32_bf16 a[204:207], v[100:103], v[208:211], a[204:207]
ds_read_b64_tr_b16 v[208:209], v14 offset:12288
ds_read_b64_tr_b16 v[210:211], v14 offset:14336
v_mfma_f32_16x16x32_bf16 a[204:207], v[104:107], v[212:215], a[204:207]
ds_read_b64_tr_b16 v[212:213], v247 offset:12288
s_waitcnt lgkmcnt(3)
v_mfma_f32_16x16x32_bf16 a[192:195], v[160:163], v[216:219], a[192:195]
ds_read_b64_tr_b16 v[214:215], v247 offset:14336
v_cvt_pk_bf16_f32 v21, v130, v131
v_mfma_f32_16x16x32_bf16 a[192:195], v[176:179], v[220:223], a[192:195]
v_accvgpr_read_b32 v136, a164
v_accvgpr_read_b32 v137, a165
v_mfma_f32_16x16x32_bf16 a[196:199], v[164:167], v[216:219], a[196:199]
v_accvgpr_read_b32 v138, a166
v_accvgpr_read_b32 v139, a167
v_mfma_f32_16x16x32_bf16 a[196:199], v[180:183], v[220:223], a[196:199]
v_cvt_pk_bf16_f32 v52, v136, v137
v_cvt_pk_bf16_f32 v53, v138, v139
v_mfma_f32_16x16x32_bf16 a[200:203], v[168:171], v[216:219], a[200:203]
v_accvgpr_read_b32 v144, a168
v_accvgpr_read_b32 v145, a169
v_mfma_f32_16x16x32_bf16 a[200:203], v[184:187], v[220:223], a[200:203]
v_accvgpr_read_b32 v146, a170
v_accvgpr_read_b32 v147, a171
v_mfma_f32_16x16x32_bf16 a[204:207], v[172:175], v[216:219], a[204:207]
ds_read_b64_tr_b16 v[216:217], v247 offset:28672
ds_read_b64_tr_b16 v[218:219], v247 offset:30720
v_mfma_f32_16x16x32_bf16 a[204:207], v[188:191], v[220:223], a[204:207]
ds_read_b64_tr_b16 v[220:221], v13 offset:12288
s_waitcnt lgkmcnt(5)
v_mfma_f32_16x16x32_bf16 a[192:195], v[0:3], v[208:211], a[192:195]
ds_read_b64_tr_b16 v[222:223], v13 offset:14336
v_cvt_pk_bf16_f32 v84, v144, v145
v_mfma_f32_16x16x32_bf16 a[196:199], v[32:35], v[208:211], a[196:199]
v_cvt_pk_bf16_f32 v85, v146, v147
v_accvgpr_read_b32 v152, a172
v_mfma_f32_16x16x32_bf16 a[200:203], v[64:67], v[208:211], a[200:203]
v_accvgpr_read_b32 v153, a173
v_accvgpr_read_b32 v154, a174
v_mfma_f32_16x16x32_bf16 a[204:207], v[96:99], v[208:211], a[204:207]
ds_read_b64_tr_b16 v[208:209], v13 offset:28672
s_waitcnt lgkmcnt(5)
v_mfma_f32_16x16x32_bf16 a[208:211], v[4:7], v[212:215], a[208:211]
ds_read_b64_tr_b16 v[210:211], v13 offset:30720
v_accvgpr_read_b32 v155, a175
v_mfma_f32_16x16x32_bf16 a[212:215], v[36:39], v[212:215], a[212:215]
v_cvt_pk_bf16_f32 v116, v152, v153
v_cvt_pk_bf16_f32 v117, v154, v155
v_mfma_f32_16x16x32_bf16 a[216:219], v[68:71], v[212:215], a[216:219]
v_accvgpr_read_b32 v132, a176
v_accvgpr_read_b32 v133, a177
v_mfma_f32_16x16x32_bf16 a[220:223], v[100:103], v[212:215], a[220:223]
ds_read_b64_tr_b16 v[212:213], v15 offset:12288
s_waitcnt lgkmcnt(3)
v_mfma_f32_16x16x32_bf16 a[208:211], v[8:11], v[216:219], a[208:211]
ds_read_b64_tr_b16 v[214:215], v15 offset:14336
v_accvgpr_read_b32 v134, a178
v_mfma_f32_16x16x32_bf16 a[208:211], v[160:163], v[220:223], a[208:211]
v_accvgpr_read_b32 v135, a179
v_cvt_pk_bf16_f32 v22, v132, v133
v_mfma_f32_16x16x32_bf16 a[212:215], v[40:43], v[216:219], a[212:215]
v_cvt_pk_bf16_f32 v23, v134, v135
buffer_store_dwordx4 v[20:23], v243, s[20:23], s44 offen offset:1024 sc1
v_mfma_f32_16x16x32_bf16 a[212:215], v[164:167], v[220:223], a[212:215]
ds_write_b128 v231, v[20:23] offset:5120
v_accvgpr_read_b32 v140, a180
v_mfma_f32_16x16x32_bf16 a[216:219], v[72:75], v[216:219], a[216:219]
v_accvgpr_read_b32 v141, a181
v_accvgpr_read_b32 v142, a182
v_mfma_f32_16x16x32_bf16 a[216:219], v[168:171], v[220:223], a[216:219]
v_accvgpr_read_b32 v143, a183
v_cvt_pk_bf16_f32 v54, v140, v141
v_mfma_f32_16x16x32_bf16 a[220:223], v[104:107], v[216:219], a[220:223]
ds_read_b64_tr_b16 v[216:217], v246 offset:12800
ds_read_b64_tr_b16 v[218:219], v246 offset:14848
v_mfma_f32_16x16x32_bf16 a[220:223], v[172:175], v[220:223], a[220:223]
ds_read_b64_tr_b16 v[220:221], v246 offset:29184
s_waitcnt lgkmcnt(3)
v_mfma_f32_16x16x32_bf16 a[208:211], v[176:179], v[208:211], a[208:211]
ds_read_b64_tr_b16 v[222:223], v246 offset:31232
v_cvt_pk_bf16_f32 v55, v142, v143
v_mfma_f32_16x16x32_bf16 a[208:211], v[0:3], v[212:215], a[208:211]
buffer_store_dwordx4 v[52:55], v243, s[20:23], s45 offen offset:1024 sc1
v_accvgpr_read_b32 v148, a184
v_mfma_f32_16x16x32_bf16 a[212:215], v[180:183], v[208:211], a[212:215]
v_accvgpr_read_b32 v149, a185
v_accvgpr_read_b32 v150, a186
v_mfma_f32_16x16x32_bf16 a[212:215], v[32:35], v[212:215], a[212:215]
v_accvgpr_read_b32 v151, a187
v_cvt_pk_bf16_f32 v86, v148, v149
v_mfma_f32_16x16x32_bf16 a[216:219], v[184:187], v[208:211], a[216:219]
v_cvt_pk_bf16_f32 v87, v150, v151
buffer_store_dwordx4 v[84:87], v243, s[20:23], s46 offen offset:1024 sc1
v_mfma_f32_16x16x32_bf16 a[216:219], v[64:67], v[212:215], a[216:219]
v_accvgpr_read_b32 v156, a188
v_accvgpr_read_b32 v157, a189
v_mfma_f32_16x16x32_bf16 a[220:223], v[188:191], v[208:211], a[220:223]
ds_read_b64_tr_b16 v[208:209], v12 offset:12800
ds_read_b64_tr_b16 v[210:211], v12 offset:14848
v_mfma_f32_16x16x32_bf16 a[220:223], v[96:99], v[212:215], a[220:223]
ds_read_b64_tr_b16 v[212:213], v12 offset:29184
s_waitcnt lgkmcnt(3)
v_mfma_f32_16x16x32_bf16 a[224:227], v[4:7], v[216:219], a[224:227]
ds_read_b64_tr_b16 v[214:215], v12 offset:31232
v_accvgpr_read_b32 v158, a190
v_mfma_f32_16x16x32_bf16 a[224:227], v[8:11], v[220:223], a[224:227]
v_accvgpr_read_b32 v159, a191
v_cvt_pk_bf16_f32 v118, v156, v157
v_mfma_f32_16x16x32_bf16 a[228:231], v[36:39], v[216:219], a[228:231]
v_cvt_pk_bf16_f32 v119, v158, v159
buffer_store_dwordx4 v[116:119], v243, s[20:23], s47 offen offset:1024 sc1
v_mfma_f32_16x16x32_bf16 a[228:231], v[40:43], v[220:223], a[228:231]
v_accvgpr_read_b32 v128, a192
v_accvgpr_read_b32 v129, a193
v_mfma_f32_16x16x32_bf16 a[232:235], v[68:71], v[216:219], a[232:235]
v_accvgpr_read_b32 v130, a194
v_accvgpr_read_b32 v131, a195
v_mfma_f32_16x16x32_bf16 a[232:235], v[72:75], v[220:223], a[232:235]
v_cvt_pk_bf16_f32 v24, v128, v129
v_cvt_pk_bf16_f32 v25, v130, v131
v_mfma_f32_16x16x32_bf16 a[236:239], v[100:103], v[216:219], a[236:239]
ds_read_b64_tr_b16 v[216:217], v14 offset:12800
ds_read_b64_tr_b16 v[218:219], v14 offset:14848
v_mfma_f32_16x16x32_bf16 a[236:239], v[104:107], v[220:223], a[236:239]
ds_read_b64_tr_b16 v[220:221], v247 offset:12800
s_waitcnt lgkmcnt(3)
v_mfma_f32_16x16x32_bf16 a[224:227], v[160:163], v[208:211], a[224:227]
ds_read_b64_tr_b16 v[222:223], v247 offset:14848
v_accvgpr_read_b32 v136, a196
v_mfma_f32_16x16x32_bf16 a[224:227], v[176:179], v[212:215], a[224:227]
v_accvgpr_read_b32 v137, a197
v_accvgpr_read_b32 v138, a198
v_mfma_f32_16x16x32_bf16 a[228:231], v[164:167], v[208:211], a[228:231]
v_accvgpr_read_b32 v139, a199
v_cvt_pk_bf16_f32 v56, v136, v137
v_mfma_f32_16x16x32_bf16 a[228:231], v[180:183], v[212:215], a[228:231]
v_cvt_pk_bf16_f32 v57, v138, v139
v_accvgpr_read_b32 v144, a200
v_mfma_f32_16x16x32_bf16 a[232:235], v[168:171], v[208:211], a[232:235]
v_accvgpr_read_b32 v145, a201
v_accvgpr_read_b32 v146, a202
v_mfma_f32_16x16x32_bf16 a[232:235], v[184:187], v[212:215], a[232:235]
v_accvgpr_read_b32 v147, a203
v_cvt_pk_bf16_f32 v88, v144, v145
v_mfma_f32_16x16x32_bf16 a[236:239], v[172:175], v[208:211], a[236:239]
ds_read_b64_tr_b16 v[208:209], v247 offset:29184
ds_read_b64_tr_b16 v[210:211], v247 offset:31232
v_mfma_f32_16x16x32_bf16 a[236:239], v[188:191], v[212:215], a[236:239]
ds_read_b64_tr_b16 v[212:213], v13 offset:12800
s_waitcnt lgkmcnt(5)
v_mfma_f32_16x16x32_bf16 a[224:227], v[0:3], v[216:219], a[224:227]
ds_read_b64_tr_b16 v[214:215], v13 offset:14848
v_cvt_pk_bf16_f32 v89, v146, v147
v_mfma_f32_16x16x32_bf16 a[228:231], v[32:35], v[216:219], a[228:231]
v_accvgpr_read_b32 v152, a204
v_accvgpr_read_b32 v153, a205
v_mfma_f32_16x16x32_bf16 a[232:235], v[64:67], v[216:219], a[232:235]
v_accvgpr_read_b32 v154, a206
v_accvgpr_read_b32 v155, a207
v_mfma_f32_16x16x32_bf16 a[236:239], v[96:99], v[216:219], a[236:239]
ds_read_b64_tr_b16 v[216:217], v13 offset:29184
s_waitcnt lgkmcnt(5)
v_mfma_f32_16x16x32_bf16 a[240:243], v[4:7], v[220:223], a[240:243]
ds_read_b64_tr_b16 v[218:219], v13 offset:31232
v_cvt_pk_bf16_f32 v120, v152, v153
v_mfma_f32_16x16x32_bf16 a[244:247], v[36:39], v[220:223], a[244:247]
v_cvt_pk_bf16_f32 v121, v154, v155
v_accvgpr_read_b32 v132, a208
v_mfma_f32_16x16x32_bf16 a[248:251], v[68:71], v[220:223], a[248:251]
v_accvgpr_read_b32 v133, a209
v_accvgpr_read_b32 v134, a210
v_mfma_f32_16x16x32_bf16 a[252:255], v[100:103], v[220:223], a[252:255]
ds_read_b64_tr_b16 v[220:221], v15 offset:12800
s_waitcnt lgkmcnt(3)
v_mfma_f32_16x16x32_bf16 a[240:243], v[8:11], v[208:211], a[240:243]
ds_read_b64_tr_b16 v[222:223], v15 offset:14848
v_accvgpr_read_b32 v135, a211
v_mfma_f32_16x16x32_bf16 a[240:243], v[160:163], v[212:215], a[240:243]
v_cvt_pk_bf16_f32 v26, v132, v133
v_cvt_pk_bf16_f32 v27, v134, v135
v_mfma_f32_16x16x32_bf16 a[244:247], v[40:43], v[208:211], a[244:247]
buffer_store_dwordx4 v[24:27], v243, s[20:23], s44 offen offset:2048 sc1
ds_write_b128 v231, v[24:27] offset:6144
v_mfma_f32_16x16x32_bf16 a[244:247], v[164:167], v[212:215], a[244:247]
v_accvgpr_read_b32 v140, a212
v_accvgpr_read_b32 v141, a213
v_mfma_f32_16x16x32_bf16 a[248:251], v[72:75], v[208:211], a[248:251]
v_accvgpr_read_b32 v142, a214
v_accvgpr_read_b32 v143, a215
v_mfma_f32_16x16x32_bf16 a[248:251], v[168:171], v[212:215], a[248:251]
v_cvt_pk_bf16_f32 v58, v140, v141
v_cvt_pk_bf16_f32 v59, v142, v143
v_mfma_f32_16x16x32_bf16 a[252:255], v[104:107], v[208:211], a[252:255]
buffer_store_dwordx4 v[56:59], v243, s[20:23], s45 offen offset:2048 sc1
v_accvgpr_read_b32 v148, a216
v_mfma_f32_16x16x32_bf16 a[252:255], v[172:175], v[212:215], a[252:255]
s_waitcnt lgkmcnt(0)
v_accvgpr_read_b32 v149, a217
v_mfma_f32_16x16x32_bf16 a[240:243], v[176:179], v[216:219], a[240:243]
v_accvgpr_read_b32 v150, a218
v_accvgpr_read_b32 v151, a219
v_mfma_f32_16x16x32_bf16 a[240:243], v[0:3], v[220:223], a[240:243]
v_cvt_pk_bf16_f32 v90, v148, v149
v_cvt_pk_bf16_f32 v91, v150, v151
v_mfma_f32_16x16x32_bf16 a[244:247], v[180:183], v[216:219], a[244:247]
buffer_store_dwordx4 v[88:91], v243, s[20:23], s46 offen offset:2048 sc1
v_accvgpr_read_b32 v156, a220
v_mfma_f32_16x16x32_bf16 a[244:247], v[32:35], v[220:223], a[244:247]
v_accvgpr_read_b32 v157, a221
v_accvgpr_read_b32 v158, a222
v_mfma_f32_16x16x32_bf16 a[248:251], v[184:187], v[216:219], a[248:251]
v_accvgpr_read_b32 v159, a223
v_cvt_pk_bf16_f32 v122, v156, v157
v_mfma_f32_16x16x32_bf16 a[248:251], v[64:67], v[220:223], a[248:251]
v_cvt_pk_bf16_f32 v123, v158, v159
buffer_store_dwordx4 v[120:123], v243, s[20:23], s47 offen offset:2048 sc1
v_mfma_f32_16x16x32_bf16 a[252:255], v[188:191], v[216:219], a[252:255]
v_accvgpr_read_b32 v128, a224
v_accvgpr_read_b32 v129, a225
v_mfma_f32_16x16x32_bf16 a[252:255], v[96:99], v[220:223], a[252:255]
v_accvgpr_read_b32 v130, a226
v_accvgpr_read_b32 v131, a227
v_cvt_pk_bf16_f32 v28, v128, v129
v_cvt_pk_bf16_f32 v29, v130, v131
v_accvgpr_read_b32 v136, a228
v_accvgpr_read_b32 v137, a229
v_accvgpr_read_b32 v138, a230
v_accvgpr_read_b32 v139, a231
v_cvt_pk_bf16_f32 v60, v136, v137
v_cvt_pk_bf16_f32 v61, v138, v139
v_accvgpr_read_b32 v144, a232
v_accvgpr_read_b32 v145, a233
v_accvgpr_read_b32 v146, a234
v_accvgpr_read_b32 v147, a235
v_cvt_pk_bf16_f32 v92, v144, v145
v_cvt_pk_bf16_f32 v93, v146, v147
v_accvgpr_read_b32 v152, a236
v_accvgpr_read_b32 v153, a237
v_accvgpr_read_b32 v154, a238
v_accvgpr_read_b32 v155, a239
v_cvt_pk_bf16_f32 v124, v152, v153
v_cvt_pk_bf16_f32 v125, v154, v155
v_accvgpr_read_b32 v132, a240
v_accvgpr_read_b32 v133, a241
v_accvgpr_read_b32 v134, a242
v_accvgpr_read_b32 v135, a243
v_cvt_pk_bf16_f32 v30, v132, v133
v_cvt_pk_bf16_f32 v31, v134, v135
buffer_store_dwordx4 v[28:31], v243, s[20:23], s44 offen offset:3072 sc1
ds_write_b128 v231, v[28:31] offset:7168
v_accvgpr_read_b32 v140, a244
v_accvgpr_read_b32 v141, a245
v_accvgpr_read_b32 v142, a246
v_accvgpr_read_b32 v143, a247
v_cvt_pk_bf16_f32 v62, v140, v141
v_cvt_pk_bf16_f32 v63, v142, v143
buffer_store_dwordx4 v[60:63], v243, s[20:23], s45 offen offset:3072 sc1
v_accvgpr_read_b32 v148, a248
v_accvgpr_read_b32 v149, a249
v_accvgpr_read_b32 v150, a250
v_accvgpr_read_b32 v151, a251
v_cvt_pk_bf16_f32 v94, v148, v149
v_cvt_pk_bf16_f32 v95, v150, v151
buffer_store_dwordx4 v[92:95], v243, s[20:23], s46 offen offset:3072 sc1
v_accvgpr_read_b32 v156, a252
v_accvgpr_read_b32 v157, a253
v_accvgpr_read_b32 v158, a254
v_accvgpr_read_b32 v159, a255
v_cvt_pk_bf16_f32 v126, v156, v157
v_cvt_pk_bf16_f32 v127, v158, v159
buffer_store_dwordx4 v[124:127], v243, s[20:23], s47 offen offset:3072 sc1
s_waitcnt vmcnt(36)
s_branch L2_F
L2_F:
v_cmp_ne_u64 vcc, s[98:99], v[108:109]
s_lshl_b32 s3, s34, 15
s_add_u32 s3, s3, 0x1000000
s_cbranch_vccnz LF_wf
LF_wf_go:
v_add_u32 v240, s3, v243
v_add_u32 v241, 0x4000, v240
s_mov_b32 s32, 0x0
s_mov_b32 s33, 0x1000
s_mov_b32 s35, 0x2000
s_mov_b32 s36, 0x3000
s_mov_b32 s38, 0x20000
s_mov_b32 s39, 0x21000
s_mov_b32 s40, 0x22000
s_mov_b32 s41, 0x23000
s_lshr_b32 s42, s6, 13
s_lshr_b32 s43, s7, 13
s_lshr_b32 s44, s29, 13
v_mov_b32 v244, s42
v_mov_b32 v232, s43
v_cmp_lt_u32 vcc, 0xff, v243
v_mov_b32 v233, s44
s_nop 0
v_cndmask_b32 v244, v244, v232, vcc
v_cmp_lt_u32 vcc, 0x1ff, v243
v_and_b32 v235, 0xf0, v243
s_nop 0
v_cndmask_b32 v244, v244, v233, vcc
v_lshlrev_b32 v244, 11, v244
v_lshl_add_u32 v244, v235, 3, v244
v_lshrrev_b32 v79, 6, v244
buffer_load_ushort v79, v79, s[52:55], 0 offen
buffer_load_dwordx4 a[0:3], v240, s[16:19], s32 offen offset:0 sc1
buffer_load_dwordx4 a[4:7], v240, s[16:19], s32 offen offset:1024 sc1
buffer_load_dwordx4 a[8:11], v241, s[16:19], s32 offen offset:0 sc1
buffer_load_dwordx4 a[12:15], v241, s[16:19], s32 offen offset:1024 sc1
buffer_load_dwordx4 a[16:19], v240, s[16:19], s32 offen offset:2048 sc1
buffer_load_dwordx4 a[20:23], v240, s[16:19], s32 offen offset:3072 sc1
buffer_load_dwordx4 a[24:27], v241, s[16:19], s32 offen offset:2048 sc1
buffer_load_dwordx4 a[28:31], v241, s[16:19], s32 offen offset:3072 sc1
buffer_load_dwordx4 a[32:35], v240, s[16:19], s33 offen offset:0 sc1
buffer_load_dwordx4 a[36:39], v240, s[16:19], s33 offen offset:1024 sc1
buffer_load_dwordx4 a[40:43], v241, s[16:19], s33 offen offset:0 sc1
buffer_load_dwordx4 a[44:47], v241, s[16:19], s33 offen offset:1024 sc1
s_lshl_b32 s3, s37, 3
v_add3_u32 v244, v244, s3, 8
s_cmp_ge_u32 s29, 0x70000000
s_cselect_b32 s44, s43, s44
v_mov_b32 v46, s42
v_mov_b32 v232, s43
v_cmp_lt_u32 vcc, 0x7f, v243
v_mov_b32 v233, s44
s_nop 0
v_cndmask_b32 v46, v46, v232, vcc
v_cmp_lt_u32 vcc, 0xff, v243
v_bfe_u32 v232, v243, 4, 3
s_nop 0
v_cndmask_b32 v46, v46, v233, vcc
v_min_u32 v232, 5, v232
v_lshrrev_b32 v46, 2, v46
v_lshl_add_u32 v46, v46, 3, v232
v_lshlrev_b32 v46, 7, v46
v_add_u32 v46, 0x7c00000, v46
s_lshl_b32 s49, s34, 10
s_add_u32 s49, s49, 0x20000
s_bfe_u32 s3, s6, 0x2000f
s_lshl_b32 s3, s3, 13
s_add_u32 s3, s3, s49
v_add_u32 v76, s3, v243
s_bfe_u32 s3, s7, 0x2000f
s_lshl_b32 s3, s3, 13
s_add_u32 s3, s3, s49
v_add_u32 v77, s3, v243
s_bfe_u32 s3, s29, 0x2000f
s_lshl_b32 s3, s3, 13
s_add_u32 s3, s3, s49
v_add_u32 v78, s3, v243
s_add_u32 s3, s37, 1
s_sub_u32 s49, s3, 6
s_cselect_b32 s3, s3, s49
s_mul_i32 s3, s3, 0x600000
s_add_u32 s42, s3, 0x2000000
s_add_u32 s3, s37, 2
s_sub_u32 s49, s3, 6
s_cselect_b32 s3, s3, s49
s_mul_i32 s3, s3, 0x600000
s_add_u32 s43, s3, 0x2000000
s_add_u32 s3, s37, 3
s_sub_u32 s49, s3, 6
s_cselect_b32 s3, s3, s49
s_mul_i32 s3, s3, 0x600000
s_add_u32 s44, s3, 0x2000000
s_add_u32 s3, s37, 4
s_sub_u32 s49, s3, 6
s_cselect_b32 s3, s3, s49
s_mul_i32 s3, s3, 0x600000
s_add_u32 s45, s3, 0x2000000
s_add_u32 s3, s37, 5
s_sub_u32 s49, s3, 6
s_cselect_b32 s3, s3, s49
s_mul_i32 s3, s3, 0x600000
s_add_u32 s46, s3, 0x2000000
s_add_u32 s3, s37, 6
s_sub_u32 s49, s3, 6
s_cselect_b32 s3, s3, s49
s_mul_i32 s3, s3, 0x600000
s_add_u32 s47, s3, 0x2000000
s_mul_i32 s3, s34, 896
v_add_u32 v47, s3, v243
v_add_u32 v43, 0x1000, v47
v_lshrrev_b32 v44, 4, v243
v_and_b32 v44, 0x30, v44
v_xor_b32 v44, v44, v243
v_and_b32 v232, 0x380, v243
v_mad_u32_u24 v44, v232, 3, v44
v_xor_b32 v45, 0x1040, v44
v_bfe_u32 v232, v243, 5, 3
v_lshrrev_b32 v234, 8, v243
v_xor_b32 v232, v232, v234
v_bfe_u32 v233, v243, 4, 3
v_lshlrev_b32 v233, 7, v233
v_lshl_or_b32 v232, v232, 4, v233
v_bfe_u32 v233, v243, 7, 1
s_lshl_b32 s49, s34, 10
s_sub_u32 s3, s28, s49
v_lshl_add_u32 v74, v233, 12, v232
v_add_u32 v72, s3, v74
s_sub_u32 s3, s30, s49
v_add_u32 v74, s3, v74
v_xor_b32 v73, 64, v72
v_xor_b32 v75, 64, v74
v_lshl_add_u32 v245, v233, 10, v232
v_add_u32 v245, s31, v245
v_xor_b32 v246, 64, v245
v_add_u32 v247, s31, v243
s_add_u32 s3, s3, 0xa000
s_and_b32 s3, s3, 0x1ffff
v_add_u32 v252, s3, v243
v_add_u32 v251, s49, v252
s_lshl_b32 s49, s34, 11
s_add_u32 s3, s3, s49
s_add_u32 s3, s3, 24576
v_lshl_add_u32 v242, v243, 1, s3
v_lshl_add_u32 v250, v235, 1, s3
v_lshrrev_b32 v232, 4, v235
v_lshlrev_b32 v234, 2, v234
v_sub_u32 v232, v232, v234
v_and_b32 v233, 1, v232
v_lshlrev_b32 v233, 4, v233
v_mov_b32 v234, 0xffff
v_lshlrev_b32 v233, v233, v234
v_lshrrev_b32 v232, 1, v232
v_cmp_eq_u32 vcc, 0, v232
s_nop 1
v_cndmask_b32 v156, 0, v233, vcc
v_cmp_eq_u32 vcc, 1, v232
s_nop 1
v_cndmask_b32 v157, 0, v233, vcc
s_mov_b32 s95, 0xffff0000
s_waitcnt vmcnt(13)
v_mov_b32 v158, s98
v_mov_b32 v159, s99
s_mov_b64 exec, 1
buffer_store_dwordx2 v[158:159], off, s[16:19], s51 sc1
s_mov_b64 exec, -1
s_waitcnt lgkmcnt(0)
s_barrier
ds_read_b128 v[208:211], v72 offset:0
ds_read_b128 v[212:215], v72 offset:8192
ds_read_b128 v[216:219], v74 offset:0
ds_read_b128 v[220:223], v73 offset:0
ds_read_b128 v[224:227], v73 offset:8192
ds_read_b128 v[104:107], v245 offset:0
ds_read_b128 v[108:111], v246 offset:0
ds_read_b128 v[152:155], v245 offset:2048
s_waitcnt vmcnt(13)
v_lshlrev_b32 v79, 16, v79
ds_write_b32 v242, v79 offset:28
ds_read_b32 v253, v250 offset:28
ds_read_b32 v254, v250 offset:540
ds_read_b32 v255, v250 offset:1052
s_waitcnt vmcnt(12)
buffer_load_dwordx4 a[48:51], v240, s[16:19], s33 offen offset:2048 sc1
s_waitcnt vmcnt(12)
buffer_load_dwordx4 a[52:55], v240, s[16:19], s33 offen offset:3072 sc1
s_waitcnt vmcnt(12)
buffer_load_dwordx4 a[56:59], v241, s[16:19], s33 offen offset:2048 sc1
s_waitcnt vmcnt(12)
s_waitcnt lgkmcnt(11)
v_mfma_f32_16x16x32_bf16 v[160:163], a[0:3], v[208:211], 0
ds_read_b128 v[228:231], v75 offset:0
buffer_load_dwordx4 a[60:63], v241, s[16:19], s33 offen offset:3072 sc1
v_mfma_f32_16x16x32_bf16 v[164:167], a[4:7], v[208:211], 0
v_mfma_f32_16x16x32_bf16 v[168:171], a[8:11], v[208:211], 0
v_mfma_f32_16x16x32_bf16 v[172:175], a[12:15], v[208:211], 0
s_waitcnt vmcnt(12)
s_waitcnt lgkmcnt(11)
v_mfma_f32_16x16x32_bf16 v[176:179], a[0:3], v[212:215], 0
ds_read_b128 v[208:211], v72 offset:1024
buffer_load_dwordx4 a[64:67], v240, s[16:19], s35 offen offset:0 sc1
v_mfma_f32_16x16x32_bf16 v[180:183], a[4:7], v[212:215], 0
v_mfma_f32_16x16x32_bf16 v[184:187], a[8:11], v[212:215], 0
v_mfma_f32_16x16x32_bf16 v[188:191], a[12:15], v[212:215], 0
s_waitcnt vmcnt(12)
s_waitcnt lgkmcnt(11)
v_mfma_f32_16x16x32_bf16 v[192:195], a[0:3], v[216:219], 0
ds_read_b128 v[212:215], v72 offset:9216
buffer_load_dwordx4 a[68:71], v240, s[16:19], s35 offen offset:1024 sc1
v_mfma_f32_16x16x32_bf16 v[196:199], a[4:7], v[216:219], 0
v_mfma_f32_16x16x32_bf16 v[200:203], a[8:11], v[216:219], 0
v_mfma_f32_16x16x32_bf16 v[204:207], a[12:15], v[216:219], 0
s_waitcnt vmcnt(12)
buffer_load_dwordx4 a[72:75], v241, s[16:19], s35 offen offset:0 sc1
s_waitcnt vmcnt(12)
s_waitcnt lgkmcnt(11)
v_mfma_f32_16x16x32_bf16 v[160:163], a[16:19], v[220:223], v[160:163]
ds_read_b128 v[216:219], v74 offset:1024
buffer_load_dwordx4 a[76:79], v241, s[16:19], s35 offen offset:1024 sc1
v_mfma_f32_16x16x32_bf16 v[164:167], a[20:23], v[220:223], v[164:167]
v_mfma_f32_16x16x32_bf16 v[168:171], a[24:27], v[220:223], v[168:171]
v_mfma_f32_16x16x32_bf16 v[172:175], a[28:31], v[220:223], v[172:175]
s_waitcnt vmcnt(12)
s_waitcnt lgkmcnt(11)
v_mfma_f32_16x16x32_bf16 v[176:179], a[16:19], v[224:227], v[176:179]
ds_read_b128 v[220:223], v73 offset:1024
buffer_load_dwordx4 a[80:83], v240, s[16:19], s35 offen offset:2048 sc1
v_mfma_f32_16x16x32_bf16 v[180:183], a[20:23], v[224:227], v[180:183]
v_mfma_f32_16x16x32_bf16 v[184:187], a[24:27], v[224:227], v[184:187]
v_mfma_f32_16x16x32_bf16 v[188:191], a[28:31], v[224:227], v[188:191]
s_waitcnt vmcnt(12)
s_waitcnt lgkmcnt(4)
v_mfma_f32_16x16x32_bf16 v[192:195], a[16:19], v[228:231], v[192:195]
ds_read_b128 v[224:227], v73 offset:9216
buffer_load_dwordx4 a[84:87], v240, s[16:19], s35 offen offset:3072 sc1
v_mfma_f32_16x16x32_bf16 v[196:199], a[20:23], v[228:231], v[196:199]
v_mfma_f32_16x16x32_bf16 v[200:203], a[24:27], v[228:231], v[200:203]
v_mfma_f32_16x16x32_bf16 v[204:207], a[28:31], v[228:231], v[204:207]
s_waitcnt vmcnt(12)
buffer_load_dwordx4 a[88:91], v241, s[16:19], s35 offen offset:2048 sc1
s_waitcnt vmcnt(12)
s_waitcnt lgkmcnt(4)
v_mfma_f32_16x16x32_bf16 v[160:163], a[32:35], v[208:211], v[160:163]
ds_read_b128 v[228:231], v75 offset:1024
buffer_load_dwordx4 a[92:95], v241, s[16:19], s35 offen offset:3072 sc1
v_mfma_f32_16x16x32_bf16 v[164:167], a[36:39], v[208:211], v[164:167]
v_mfma_f32_16x16x32_bf16 v[168:171], a[40:43], v[208:211], v[168:171]
v_mfma_f32_16x16x32_bf16 v[172:175], a[44:47], v[208:211], v[172:175]
s_waitcnt lgkmcnt(4)
v_mfma_f32_16x16x32_bf16 v[176:179], a[32:35], v[212:215], v[176:179]
ds_read_b128 v[208:211], v72 offset:2048
v_mfma_f32_16x16x32_bf16 v[180:183], a[36:39], v[212:215], v[180:183]
v_mfma_f32_16x16x32_bf16 v[184:187], a[40:43], v[212:215], v[184:187]
v_mfma_f32_16x16x32_bf16 v[188:191], a[44:47], v[212:215], v[188:191]
s_waitcnt vmcnt(11)
s_waitcnt lgkmcnt(4)
v_mfma_f32_16x16x32_bf16 v[192:195], a[32:35], v[216:219], v[192:195]
ds_read_b128 v[212:215], v72 offset:10240
buffer_load_dwordx2 v[248:249], v46, s[16:19], 0 offen offset:0 sc1
v_mfma_f32_16x16x32_bf16 v[196:199], a[36:39], v[216:219], v[196:199]
v_mfma_f32_16x16x32_bf16 v[200:203], a[40:43], v[216:219], v[200:203]
v_mfma_f32_16x16x32_bf16 v[204:207], a[44:47], v[216:219], v[204:207]
s_waitcnt vmcnt(11)
buffer_load_dwordx4 a[96:99], v240, s[16:19], s36 offen offset:0 sc1
s_waitcnt vmcnt(11)
buffer_load_dwordx4 a[100:103], v240, s[16:19], s36 offen offset:1024 sc1
s_waitcnt vmcnt(11)
s_waitcnt lgkmcnt(4)
v_mfma_f32_16x16x32_bf16 v[160:163], a[48:51], v[220:223], v[160:163]
ds_read_b128 v[216:219], v74 offset:2048
buffer_load_dwordx4 a[104:107], v241, s[16:19], s36 offen offset:0 sc1
v_mfma_f32_16x16x32_bf16 v[164:167], a[52:55], v[220:223], v[164:167]
v_mfma_f32_16x16x32_bf16 v[168:171], a[56:59], v[220:223], v[168:171]
v_mfma_f32_16x16x32_bf16 v[172:175], a[60:63], v[220:223], v[172:175]
s_waitcnt vmcnt(11)
s_waitcnt lgkmcnt(4)
v_mfma_f32_16x16x32_bf16 v[176:179], a[48:51], v[224:227], v[176:179]
ds_read_b128 v[220:223], v73 offset:2048
buffer_load_dwordx4 a[108:111], v241, s[16:19], s36 offen offset:1024 sc1
v_mfma_f32_16x16x32_bf16 v[180:183], a[52:55], v[224:227], v[180:183]
v_mfma_f32_16x16x32_bf16 v[184:187], a[56:59], v[224:227], v[184:187]
v_mfma_f32_16x16x32_bf16 v[188:191], a[60:63], v[224:227], v[188:191]
s_waitcnt vmcnt(11)
s_waitcnt lgkmcnt(4)
v_mfma_f32_16x16x32_bf16 v[192:195], a[48:51], v[228:231], v[192:195]
ds_read_b128 v[224:227], v73 offset:10240
buffer_load_dwordx4 a[112:115], v240, s[16:19], s36 offen offset:2048 sc1
v_mfma_f32_16x16x32_bf16 v[196:199], a[52:55], v[228:231], v[196:199]
v_mfma_f32_16x16x32_bf16 v[200:203], a[56:59], v[228:231], v[200:203]
v_mfma_f32_16x16x32_bf16 v[204:207], a[60:63], v[228:231], v[204:207]
s_waitcnt vmcnt(11)
buffer_load_dwordx4 a[116:119], v240, s[16:19], s36 offen offset:3072 sc1
s_waitcnt vmcnt(11)
s_waitcnt lgkmcnt(4)
v_mfma_f32_16x16x32_bf16 v[160:163], a[64:67], v[208:211], v[160:163]
ds_read_b128 v[228:231], v75 offset:2048
buffer_load_dwordx4 a[120:123], v241, s[16:19], s36 offen offset:2048 sc1
v_mfma_f32_16x16x32_bf16 v[164:167], a[68:71], v[208:211], v[164:167]
v_mfma_f32_16x16x32_bf16 v[168:171], a[72:75], v[208:211], v[168:171]
v_mfma_f32_16x16x32_bf16 v[172:175], a[76:79], v[208:211], v[172:175]
s_waitcnt vmcnt(11)
s_waitcnt lgkmcnt(4)
v_mfma_f32_16x16x32_bf16 v[176:179], a[64:67], v[212:215], v[176:179]
ds_read_b128 v[208:211], v72 offset:3072
buffer_load_dwordx4 a[124:127], v241, s[16:19], s36 offen offset:3072 sc1
v_mfma_f32_16x16x32_bf16 v[180:183], a[68:71], v[212:215], v[180:183]
v_mfma_f32_16x16x32_bf16 v[184:187], a[72:75], v[212:215], v[184:187]
v_mfma_f32_16x16x32_bf16 v[188:191], a[76:79], v[212:215], v[188:191]
s_waitcnt vmcnt(11)
s_waitcnt lgkmcnt(4)
v_mfma_f32_16x16x32_bf16 v[192:195], a[64:67], v[216:219], v[192:195]
ds_read_b128 v[212:215], v72 offset:11264
v_mfma_f32_16x16x32_bf16 v[196:199], a[68:71], v[216:219], v[196:199]
v_mfma_f32_16x16x32_bf16 v[200:203], a[72:75], v[216:219], v[200:203]
v_mfma_f32_16x16x32_bf16 v[204:207], a[76:79], v[216:219], v[204:207]
s_waitcnt vmcnt(10)
s_waitcnt vmcnt(9)
s_waitcnt lgkmcnt(4)
v_mfma_f32_16x16x32_bf16 v[160:163], a[80:83], v[220:223], v[160:163]
ds_read_b128 v[216:219], v74 offset:3072
v_mfma_f32_16x16x32_bf16 v[164:167], a[84:87], v[220:223], v[164:167]
v_mfma_f32_16x16x32_bf16 v[168:171], a[88:91], v[220:223], v[168:171]
v_mfma_f32_16x16x32_bf16 v[172:175], a[92:95], v[220:223], v[172:175]
s_waitcnt vmcnt(8)
s_waitcnt lgkmcnt(4)
v_mfma_f32_16x16x32_bf16 v[176:179], a[80:83], v[224:227], v[176:179]
ds_read_b128 v[220:223], v73 offset:3072
v_cmp_ne_u64 vcc, s[98:99], v[248:249]
s_nop 1
s_cbranch_vccnz LF_spinQ
LF_goQ:
v_mfma_f32_16x16x32_bf16 v[180:183], a[84:87], v[224:227], v[180:183]
buffer_load_dwordx4 v[128:131], v244, s[24:27], 0 offen offset:0 sc1
v_mfma_f32_16x16x32_bf16 v[184:187], a[88:91], v[224:227], v[184:187]
buffer_load_dwordx4 v[132:135], v244, s[24:27], 0 offen offset:16 sc1
v_mfma_f32_16x16x32_bf16 v[188:191], a[92:95], v[224:227], v[188:191]
buffer_load_dwordx4 v[136:139], v244, s[24:27], 0 offen offset:32 sc1
s_waitcnt vmcnt(10)
s_waitcnt lgkmcnt(4)
v_mfma_f32_16x16x32_bf16 v[192:195], a[80:83], v[228:231], v[192:195]
ds_read_b128 v[224:227], v73 offset:11264
s_add_u32 s49, s6, s42
buffer_load_dwordx4 v[48:51], v47, s[16:19], s49 offen sc1
v_mfma_f32_16x16x32_bf16 v[196:199], a[84:87], v[228:231], v[196:199]
s_add_u32 s3, s6, s43
buffer_load_dwordx4 v[52:55], v47, s[16:19], s3 offen sc1
v_mfma_f32_16x16x32_bf16 v[200:203], a[88:91], v[228:231], v[200:203]
v_mfma_f32_16x16x32_bf16 v[204:207], a[92:95], v[228:231], v[204:207]
s_waitcnt vmcnt(11)
buffer_load_dwordx4 a[128:131], v240, s[16:19], s38 offen offset:0 sc1
s_waitcnt vmcnt(11)
buffer_load_dwordx4 a[132:135], v240, s[16:19], s38 offen offset:1024 sc1
s_waitcnt vmcnt(11)
s_waitcnt lgkmcnt(4)
v_mfma_f32_16x16x32_bf16 v[160:163], a[96:99], v[208:211], v[160:163]
ds_read_b128 v[228:231], v75 offset:3072
v_mfma_f32_16x16x32_bf16 v[164:167], a[100:103], v[208:211], v[164:167]
v_mfma_f32_16x16x32_bf16 v[168:171], a[104:107], v[208:211], v[168:171]
v_mfma_f32_16x16x32_bf16 v[172:175], a[108:111], v[208:211], v[172:175]
s_waitcnt vmcnt(10)
s_waitcnt lgkmcnt(4)
v_mfma_f32_16x16x32_bf16 v[176:179], a[96:99], v[212:215], v[176:179]
s_add_u32 s49, s6, s44
buffer_load_dwordx4 v[56:59], v47, s[16:19], s49 offen sc1
v_mfma_f32_16x16x32_bf16 v[180:183], a[100:103], v[212:215], v[180:183]
s_add_u32 s3, s6, s45
buffer_load_dwordx4 v[60:63], v47, s[16:19], s3 offen sc1
v_mfma_f32_16x16x32_bf16 v[184:187], a[104:107], v[212:215], v[184:187]
v_mfma_f32_16x16x32_bf16 v[188:191], a[108:111], v[212:215], v[188:191]
s_waitcnt vmcnt(11)
s_waitcnt lgkmcnt(3)
v_mfma_f32_16x16x32_bf16 v[192:195], a[96:99], v[216:219], v[192:195]
buffer_load_dwordx4 a[136:139], v241, s[16:19], s38 offen offset:0 sc1
v_mfma_f32_16x16x32_bf16 v[196:199], a[100:103], v[216:219], v[196:199]
v_mfma_f32_16x16x32_bf16 v[200:203], a[104:107], v[216:219], v[200:203]
v_mfma_f32_16x16x32_bf16 v[204:207], a[108:111], v[216:219], v[204:207]
s_waitcnt vmcnt(11)
buffer_load_dwordx4 a[140:143], v241, s[16:19], s38 offen offset:1024 sc1
s_waitcnt vmcnt(11)
s_waitcnt lgkmcnt(2)
v_mfma_f32_16x16x32_bf16 v[160:163], a[112:115], v[220:223], v[160:163]
s_add_u32 s49, s6, s46
buffer_load_dwordx4 v[64:67], v47, s[16:19], s49 offen sc1
v_mfma_f32_16x16x32_bf16 v[164:167], a[116:119], v[220:223], v[164:167]
ds_read_b128 v[68:71], v76 offset:0
v_mfma_f32_16x16x32_bf16 v[168:171], a[120:123], v[220:223], v[168:171]
v_mfma_f32_16x16x32_bf16 v[172:175], a[124:127], v[220:223], v[172:175]
s_waitcnt lgkmcnt(2)
v_mfma_f32_16x16x32_bf16 v[176:179], a[112:115], v[224:227], v[176:179]
v_lshlrev_b32 v234, 16, v104
v_and_b32 v235, s95, v104
v_mfma_f32_16x16x32_bf16 v[180:183], a[116:119], v[224:227], v[180:183]
v_fma_f32 v160, v160, v253, v234
v_fma_f32 v161, v161, v253, v235
v_mfma_f32_16x16x32_bf16 v[184:187], a[120:123], v[224:227], v[184:187]
v_lshlrev_b32 v236, 16, v105
v_and_b32 v237, s95, v105
v_mfma_f32_16x16x32_bf16 v[188:191], a[124:127], v[224:227], v[188:191]
v_fma_f32 v162, v162, v253, v236
v_fma_f32 v163, v163, v253, v237
s_waitcnt lgkmcnt(1)
v_mfma_f32_16x16x32_bf16 v[192:195], a[112:115], v[228:231], v[192:195]
v_lshlrev_b32 v238, 16, v106
v_and_b32 v239, s95, v106
v_mfma_f32_16x16x32_bf16 v[196:199], a[116:119], v[228:231], v[196:199]
v_fma_f32 v164, v164, v253, v238
v_fma_f32 v165, v165, v253, v239
v_mfma_f32_16x16x32_bf16 v[200:203], a[120:123], v[228:231], v[200:203]
v_lshlrev_b32 v232, 16, v107
v_and_b32 v233, s95, v107
v_mfma_f32_16x16x32_bf16 v[204:207], a[124:127], v[228:231], v[204:207]
v_fma_f32 v166, v166, v253, v232
v_fma_f32 v167, v167, v253, v233
ds_read_b128 v[104:107], v246 offset:2048
v_lshlrev_b32 v234, 16, v108
v_and_b32 v235, s95, v108
v_fma_f32 v168, v168, v253, v234
v_fma_f32 v169, v169, v253, v235
v_lshlrev_b32 v236, 16, v109
v_and_b32 v237, s95, v109
v_fma_f32 v170, v170, v253, v236
v_fma_f32 v171, v171, v253, v237
v_lshlrev_b32 v238, 16, v110
v_and_b32 v239, s95, v110
v_fma_f32 v172, v172, v253, v238
v_fma_f32 v173, v173, v253, v239
v_lshlrev_b32 v232, 16, v111
v_and_b32 v233, s95, v111
v_fma_f32 v174, v174, v253, v232
v_fma_f32 v175, v175, v253, v233
ds_read_b128 v[108:111], v245 offset:4096
s_waitcnt vmcnt(11)
buffer_load_dwordx4 a[144:147], v240, s[16:19], s38 offen offset:2048 sc1
v_lshlrev_b32 v234, 16, v152
v_and_b32 v235, s95, v152
v_fma_f32 v176, v176, v254, v234
v_fma_f32 v177, v177, v254, v235
v_lshlrev_b32 v236, 16, v153
v_and_b32 v237, s95, v153
v_fma_f32 v178, v178, v254, v236
v_fma_f32 v179, v179, v254, v237
v_lshlrev_b32 v238, 16, v154
v_and_b32 v239, s95, v154
v_fma_f32 v180, v180, v254, v238
v_fma_f32 v181, v181, v254, v239
v_lshlrev_b32 v232, 16, v155
v_and_b32 v233, s95, v155
v_fma_f32 v182, v182, v254, v232
v_fma_f32 v183, v183, v254, v233
ds_read_b128 v[152:155], v246 offset:4096
s_waitcnt lgkmcnt(2)
v_lshlrev_b32 v234, 16, v104
v_and_b32 v235, s95, v104
v_fma_f32 v184, v184, v254, v234
v_fma_f32 v185, v185, v254, v235
v_lshlrev_b32 v236, 16, v105
v_and_b32 v237, s95, v105
v_fma_f32 v186, v186, v254, v236
v_fma_f32 v187, v187, v254, v237
v_lshlrev_b32 v238, 16, v106
v_and_b32 v239, s95, v106
v_fma_f32 v188, v188, v254, v238
v_fma_f32 v189, v189, v254, v239
v_lshlrev_b32 v232, 16, v107
v_and_b32 v233, s95, v107
v_fma_f32 v190, v190, v254, v232
v_fma_f32 v191, v191, v254, v233
s_waitcnt vmcnt(11)
buffer_load_dwordx4 a[148:151], v240, s[16:19], s38 offen offset:3072 sc1
s_waitcnt lgkmcnt(1)
v_lshlrev_b32 v234, 16, v108
v_and_b32 v235, s95, v108
v_fma_f32 v192, v192, v255, v234
v_fma_f32 v193, v193, v255, v235
v_lshlrev_b32 v236, 16, v109
v_and_b32 v237, s95, v109
v_fma_f32 v194, v194, v255, v236
v_fma_f32 v195, v195, v255, v237
v_lshlrev_b32 v238, 16, v110
v_and_b32 v239, s95, v110
v_fma_f32 v196, v196, v255, v238
v_fma_f32 v197, v197, v255, v239
v_lshlrev_b32 v232, 16, v111
v_and_b32 v233, s95, v111
v_fma_f32 v198, v198, v255, v232
v_fma_f32 v199, v199, v255, v233
s_waitcnt lgkmcnt(0)
v_lshlrev_b32 v234, 16, v152
v_and_b32 v235, s95, v152
v_fma_f32 v200, v200, v255, v234
v_fma_f32 v201, v201, v255, v235
v_lshlrev_b32 v236, 16, v153
v_and_b32 v237, s95, v153
v_fma_f32 v202, v202, v255, v236
v_fma_f32 v203, v203, v255, v237
v_lshlrev_b32 v238, 16, v154
v_and_b32 v239, s95, v154
v_fma_f32 v204, v204, v255, v238
v_fma_f32 v205, v205, v255, v239
v_lshlrev_b32 v232, 16, v155
v_and_b32 v233, s95, v155
v_fma_f32 v206, v206, v255, v232
v_fma_f32 v207, v207, v255, v233
s_waitcnt vmcnt(11)
v_max3_f32 v232, v128, v130, v132
v_max3_f32 v233, v134, v136, v138
v_max_f32 v232, v232, v233
v_subrev_f32 v232, 0x42fe0000, v232
v_sub_f32 v128, v128, v232
v_sub_f32 v130, v130, v232
v_sub_f32 v132, v132, v232
v_sub_f32 v134, v134, v232
v_sub_f32 v136, v136, v232
v_sub_f32 v138, v138, v232
v_cvt_u32_f32 v128, v128
v_cvt_u32_f32 v130, v130
v_cvt_u32_f32 v132, v132
v_cvt_u32_f32 v134, v134
v_cvt_u32_f32 v136, v136
v_cvt_u32_f32 v138, v138
v_lshlrev_b32 v234, 23, v128
v_lshlrev_b32 v235, 23, v130
v_lshlrev_b32 v236, 23, v132
v_lshlrev_b32 v237, 23, v134
v_lshlrev_b32 v238, 23, v136
v_lshlrev_b32 v239, 23, v138
v_mul_f32 v232, v234, v129
v_fmac_f32 v232, v235, v131
v_fmac_f32 v232, v236, v133
v_fmac_f32 v232, v237, v135
v_fmac_f32 v232, v238, v137
v_fmac_f32 v232, v239, v139
v_rcp_f32 v150, v232
v_mul_u32_u24 v144, 0x800080, v128
v_mul_u32_u24 v145, 0x800080, v130
v_mul_u32_u24 v146, 0x800080, v132
v_mul_u32_u24 v147, 0x800080, v134
v_mul_u32_u24 v148, 0x800080, v136
v_mul_u32_u24 v149, 0x800080, v138
ds_write_b128 v242, v[144:147]
ds_write_b96 v242, v[148:150] offset:16
ds_read_b128 v[144:147], v250 offset:0
ds_read_b128 v[148:151], v250 offset:16
ds_read_b128 v[128:131], v250 offset:512
ds_read_b128 v[132:135], v250 offset:528
ds_read_b128 v[136:139], v250 offset:1024
ds_read_b128 v[140:143], v250 offset:1040
s_waitcnt lgkmcnt(4)
v_and_b32 v0, v144, v156
v_and_b32 v1, v144, v157
v_and_b32 v2, v145, v156
v_and_b32 v3, v145, v157
v_and_b32 v4, v146, v156
v_and_b32 v5, v146, v157
v_and_b32 v6, v147, v156
v_and_b32 v7, v147, v157
v_and_b32 v8, v148, v156
v_and_b32 v9, v148, v157
v_and_b32 v10, v149, v156
v_and_b32 v11, v149, v157
v_mov_b32 v40, v150
s_waitcnt lgkmcnt(2)
v_and_b32 v12, v128, v156
v_and_b32 v13, v128, v157
v_and_b32 v14, v129, v156
v_and_b32 v15, v129, v157
v_and_b32 v16, v130, v156
v_and_b32 v17, v130, v157
v_and_b32 v18, v131, v156
v_and_b32 v19, v131, v157
v_and_b32 v20, v132, v156
v_and_b32 v21, v132, v157
v_and_b32 v22, v133, v156
v_and_b32 v23, v133, v157
v_mov_b32 v41, v134
s_waitcnt lgkmcnt(0)
v_and_b32 v24, v136, v156
v_and_b32 v25, v136, v157
v_and_b32 v26, v137, v156
v_and_b32 v27, v137, v157
v_and_b32 v28, v138, v156
v_and_b32 v29, v138, v157
v_and_b32 v30, v139, v156
v_and_b32 v31, v139, v157
v_and_b32 v32, v140, v156
v_and_b32 v33, v140, v157
v_and_b32 v34, v141, v156
v_and_b32 v35, v141, v157
v_mov_b32 v42, v142
s_waitcnt vmcnt(9)
v_swap_b32 v50, v52
v_swap_b32 v51, v53
s_nop 1
v_mfma_f32_16x16x32_bf16 v[136:139], v[48:51], v[0:3], 0
s_add_u32 s49, s6, s42
buffer_load_dwordx4 v[80:83], v43, s[16:19], s49 offen sc1
v_mfma_f32_16x16x32_bf16 v[140:143], v[52:55], v[0:3], 0
s_add_u32 s3, s6, s43
buffer_load_dwordx4 v[84:87], v43, s[16:19], s3 offen sc1
buffer_load_dwordx4 a[152:155], v241, s[16:19], s38 offen offset:2048 sc1
s_waitcnt vmcnt(11)
buffer_load_dwordx4 a[156:159], v241, s[16:19], s38 offen offset:3072 sc1
s_waitcnt vmcnt(11)
s_waitcnt vmcnt(9)
v_swap_b32 v58, v60
v_swap_b32 v59, v61
s_nop 1
v_mfma_f32_16x16x32_bf16 v[136:139], v[56:59], v[4:7], v[136:139]
s_add_u32 s49, s6, s44
buffer_load_dwordx4 v[88:91], v43, s[16:19], s49 offen sc1
v_mfma_f32_16x16x32_bf16 v[140:143], v[60:63], v[4:7], v[140:143]
s_add_u32 s3, s6, s45
buffer_load_dwordx4 v[92:95], v43, s[16:19], s3 offen sc1
buffer_load_dwordx4 a[160:163], v240, s[16:19], s39 offen offset:0 sc1
s_waitcnt vmcnt(11)
buffer_load_dwordx4 a[164:167], v240, s[16:19], s39 offen offset:1024 sc1
s_waitcnt vmcnt(11)
s_add_u32 s49, s6, s46
buffer_load_dwordx4 v[96:99], v43, s[16:19], s49 offen sc1
ds_read_b128 v[100:103], v76 offset:4096
s_waitcnt vmcnt(11)
v_swap_b32 v66, v68
v_swap_b32 v67, v69
s_nop 1
v_mfma_f32_16x16x32_bf16 v[136:139], v[64:67], v[8:11], v[136:139]
buffer_load_dwordx4 a[168:171], v241, s[16:19], s39 offen offset:0 sc1
v_mfma_f32_16x16x32_bf16 v[140:143], v[68:71], v[8:11], v[140:143]
s_waitcnt vmcnt(11)
buffer_load_dwordx4 a[172:175], v241, s[16:19], s39 offen offset:1024 sc1
s_nop 3
v_mul_f32 v136, v136, v40
v_mul_f32 v137, v137, v40
v_mul_f32 v138, v138, v40
v_mul_f32 v139, v139, v40
v_mul_f32 v140, v140, v40
v_mul_f32 v141, v141, v40
v_mul_f32 v142, v142, v40
v_mul_f32 v143, v143, v40
v_cvt_pk_bf16_f32 v136, v136, v137
v_cvt_pk_bf16_f32 v137, v138, v139
v_cvt_pk_bf16_f32 v138, v140, v141
v_cvt_pk_bf16_f32 v139, v142, v143
ds_write_b128 v251, v[136:139] offset:0
s_waitcnt vmcnt(11)
s_waitcnt vmcnt(9)
v_swap_b32 v82, v84
v_swap_b32 v83, v85
s_nop 1
v_mfma_f32_16x16x32_bf16 v[128:131], v[80:83], v[0:3], 0
s_add_u32 s49, s7, s42
buffer_load_dwordx4 v[112:115], v47, s[16:19], s49 offen sc1
v_mfma_f32_16x16x32_bf16 v[132:135], v[84:87], v[0:3], 0
s_add_u32 s3, s7, s43
buffer_load_dwordx4 v[116:119], v47, s[16:19], s3 offen sc1
buffer_load_dwordx4 a[176:179], v240, s[16:19], s39 offen offset:2048 sc1
s_waitcnt vmcnt(11)
buffer_load_dwordx4 a[180:183], v240, s[16:19], s39 offen offset:3072 sc1
s_waitcnt vmcnt(11)
s_waitcnt vmcnt(9)
v_swap_b32 v90, v92
v_swap_b32 v91, v93
s_nop 1
v_mfma_f32_16x16x32_bf16 v[128:131], v[88:91], v[4:7], v[128:131]
s_add_u32 s49, s7, s44
buffer_load_dwordx4 v[120:123], v47, s[16:19], s49 offen sc1
v_mfma_f32_16x16x32_bf16 v[132:135], v[92:95], v[4:7], v[132:135]
s_add_u32 s3, s7, s45
buffer_load_dwordx4 v[124:127], v47, s[16:19], s3 offen sc1
buffer_load_dwordx4 a[184:187], v241, s[16:19], s39 offen offset:2048 sc1
s_waitcnt vmcnt(11)
buffer_load_dwordx4 a[188:191], v241, s[16:19], s39 offen offset:3072 sc1
s_waitcnt vmcnt(11)
s_add_u32 s49, s7, s46
buffer_load_dwordx4 v[48:51], v47, s[16:19], s49 offen sc1
ds_read_b128 v[52:55], v77 offset:0
s_waitcnt vmcnt(11)
s_waitcnt lgkmcnt(2)
v_swap_b32 v98, v100
v_swap_b32 v99, v101
s_nop 1
v_mfma_f32_16x16x32_bf16 v[128:131], v[96:99], v[8:11], v[128:131]
buffer_load_dwordx4 a[192:195], v240, s[16:19], s40 offen offset:0 sc1
v_mfma_f32_16x16x32_bf16 v[132:135], v[100:103], v[8:11], v[132:135]
s_waitcnt vmcnt(11)
buffer_load_dwordx4 a[196:199], v240, s[16:19], s40 offen offset:1024 sc1
s_nop 3
v_mul_f32 v128, v128, v40
v_mul_f32 v129, v129, v40
v_mul_f32 v130, v130, v40
v_mul_f32 v131, v131, v40
v_mul_f32 v132, v132, v40
v_mul_f32 v133, v133, v40
v_mul_f32 v134, v134, v40
v_mul_f32 v135, v135, v40
v_cvt_pk_bf16_f32 v128, v128, v129
v_cvt_pk_bf16_f32 v129, v130, v131
v_cvt_pk_bf16_f32 v130, v132, v133
v_cvt_pk_bf16_f32 v131, v134, v135
ds_write_b128 v251, v[128:131] offset:4096
s_waitcnt vmcnt(11)
s_waitcnt lgkmcnt(0)
s_barrier
ds_read_b128 v[208:211], v252 offset:0
ds_read_b128 v[212:215], v252 offset:1024
ds_read_b128 v[216:219], v252 offset:2048
ds_read_b128 v[220:223], v252 offset:3072
ds_read_b128 v[224:227], v252 offset:4096
s_waitcnt vmcnt(9)
s_waitcnt lgkmcnt(4)
v_mfma_f32_16x16x32_bf16 v[160:163], a[128:131], v[208:211], v[160:163]
ds_read_b128 v[228:231], v252 offset:5120
v_swap_b32 v114, v116
v_mfma_f32_16x16x32_bf16 v[164:167], a[132:135], v[208:211], v[164:167]
v_swap_b32 v115, v117
s_nop 1
v_mfma_f32_16x16x32_bf16 v[136:139], v[112:115], v[12:15], 0
s_add_u32 s49, s7, s42
buffer_load_dwordx4 v[56:59], v43, s[16:19], s49 offen sc1
v_mfma_f32_16x16x32_bf16 v[140:143], v[116:119], v[12:15], 0
s_add_u32 s3, s7, s43
buffer_load_dwordx4 v[60:63], v43, s[16:19], s3 offen sc1
v_mfma_f32_16x16x32_bf16 v[168:171], a[136:139], v[208:211], v[168:171]
buffer_load_dwordx4 a[200:203], v241, s[16:19], s40 offen offset:0 sc1
v_mfma_f32_16x16x32_bf16 v[172:175], a[140:143], v[208:211], v[172:175]
s_waitcnt lgkmcnt(4)
v_mfma_f32_16x16x32_bf16 v[160:163], a[144:147], v[212:215], v[160:163]
v_mfma_f32_16x16x32_bf16 v[164:167], a[148:151], v[212:215], v[164:167]
v_mfma_f32_16x16x32_bf16 v[168:171], a[152:155], v[212:215], v[168:171]
v_mfma_f32_16x16x32_bf16 v[172:175], a[156:159], v[212:215], v[172:175]
s_waitcnt vmcnt(11)
s_waitcnt lgkmcnt(3)
v_mfma_f32_16x16x32_bf16 v[160:163], a[160:163], v[216:219], v[160:163]
buffer_load_dwordx4 a[204:207], v241, s[16:19], s40 offen offset:1024 sc1
v_mfma_f32_16x16x32_bf16 v[164:167], a[164:167], v[216:219], v[164:167]
v_mfma_f32_16x16x32_bf16 v[168:171], a[168:171], v[216:219], v[168:171]
v_mfma_f32_16x16x32_bf16 v[172:175], a[172:175], v[216:219], v[172:175]
s_waitcnt vmcnt(11)
s_waitcnt vmcnt(9)
v_swap_b32 v122, v124
v_swap_b32 v123, v125
s_nop 1
v_mfma_f32_16x16x32_bf16 v[136:139], v[120:123], v[16:19], v[136:139]
s_add_u32 s49, s7, s44
buffer_load_dwordx4 v[64:67], v43, s[16:19], s49 offen sc1
v_mfma_f32_16x16x32_bf16 v[140:143], v[124:127], v[16:19], v[140:143]
s_add_u32 s3, s7, s45
buffer_load_dwordx4 v[68:71], v43, s[16:19], s3 offen sc1
buffer_load_dwordx4 a[208:211], v240, s[16:19], s40 offen offset:2048 sc1
s_waitcnt vmcnt(11)
buffer_load_dwordx4 a[212:215], v240, s[16:19], s40 offen offset:3072 sc1
s_waitcnt vmcnt(11)
s_waitcnt lgkmcnt(2)
v_mfma_f32_16x16x32_bf16 v[160:163], a[176:179], v[220:223], v[160:163]
s_add_u32 s49, s7, s46
buffer_load_dwordx4 v[80:83], v43, s[16:19], s49 offen sc1
v_mfma_f32_16x16x32_bf16 v[164:167], a[180:183], v[220:223], v[164:167]
ds_read_b128 v[84:87], v77 offset:4096
v_mfma_f32_16x16x32_bf16 v[168:171], a[184:187], v[220:223], v[168:171]
v_mfma_f32_16x16x32_bf16 v[172:175], a[188:191], v[220:223], v[172:175]
s_waitcnt vmcnt(11)
v_swap_b32 v50, v52
v_swap_b32 v51, v53
s_nop 1
v_mfma_f32_16x16x32_bf16 v[136:139], v[48:51], v[20:23], v[136:139]
buffer_load_dwordx4 a[216:219], v241, s[16:19], s40 offen offset:2048 sc1
v_mfma_f32_16x16x32_bf16 v[140:143], v[52:55], v[20:23], v[140:143]
s_waitcnt vmcnt(11)
buffer_load_dwordx4 a[220:223], v241, s[16:19], s40 offen offset:3072 sc1
s_nop 3
v_mul_f32 v136, v136, v41
v_mul_f32 v137, v137, v41
v_mul_f32 v138, v138, v41
v_mul_f32 v139, v139, v41
v_mul_f32 v140, v140, v41
v_mul_f32 v141, v141, v41
v_mul_f32 v142, v142, v41
v_mul_f32 v143, v143, v41
v_cvt_pk_bf16_f32 v136, v136, v137
v_cvt_pk_bf16_f32 v137, v138, v139
v_cvt_pk_bf16_f32 v138, v140, v141
v_cvt_pk_bf16_f32 v139, v142, v143
ds_write_b128 v251, v[136:139] offset:8192
s_waitcnt vmcnt(11)
s_waitcnt vmcnt(9)
v_swap_b32 v58, v60
v_swap_b32 v59, v61
s_nop 1
v_mfma_f32_16x16x32_bf16 v[128:131], v[56:59], v[12:15], 0
s_add_u32 s49, s29, s42
buffer_load_dwordx4 v[88:91], v47, s[16:19], s49 offen sc1
v_mfma_f32_16x16x32_bf16 v[132:135], v[60:63], v[12:15], 0
s_add_u32 s3, s29, s43
buffer_load_dwordx4 v[92:95], v47, s[16:19], s3 offen sc1
buffer_load_dwordx4 a[224:227], v240, s[16:19], s41 offen offset:0 sc1
s_waitcnt vmcnt(11)
buffer_load_dwordx4 a[228:231], v240, s[16:19], s41 offen offset:1024 sc1
s_waitcnt vmcnt(11)
s_waitcnt lgkmcnt(3)
v_mfma_f32_16x16x32_bf16 v[160:163], a[192:195], v[224:227], v[160:163]
buffer_load_dwordx4 a[232:235], v241, s[16:19], s41 offen offset:0 sc1
v_mfma_f32_16x16x32_bf16 v[164:167], a[196:199], v[224:227], v[164:167]
v_mfma_f32_16x16x32_bf16 v[168:171], a[200:203], v[224:227], v[168:171]
v_mfma_f32_16x16x32_bf16 v[172:175], a[204:207], v[224:227], v[172:175]
s_waitcnt vmcnt(10)
v_swap_b32 v66, v68
v_swap_b32 v67, v69
s_nop 1
v_mfma_f32_16x16x32_bf16 v[128:131], v[64:67], v[16:19], v[128:131]
buffer_load_dwordx4 a[236:239], v241, s[16:19], s41 offen offset:1024 sc1
v_mfma_f32_16x16x32_bf16 v[132:135], v[68:71], v[16:19], v[132:135]
s_waitcnt vmcnt(10)
s_add_u32 s49, s29, s44
buffer_load_dwordx4 v[96:99], v47, s[16:19], s49 offen sc1
s_add_u32 s3, s29, s45
buffer_load_dwordx4 v[100:103], v47, s[16:19], s3 offen sc1
s_waitcnt vmcnt(11)
buffer_load_dwordx4 a[240:243], v240, s[16:19], s41 offen offset:2048 sc1
s_waitcnt vmcnt(11)
s_waitcnt lgkmcnt(1)
v_swap_b32 v82, v84
v_swap_b32 v83, v85
s_nop 1
v_mfma_f32_16x16x32_bf16 v[128:131], v[80:83], v[20:23], v[128:131]
buffer_load_dwordx4 a[244:247], v240, s[16:19], s41 offen offset:3072 sc1
v_mfma_f32_16x16x32_bf16 v[132:135], v[84:87], v[20:23], v[132:135]
s_waitcnt vmcnt(11)
buffer_load_dwordx4 a[248:251], v241, s[16:19], s41 offen offset:2048 sc1
s_nop 3
v_mul_f32 v128, v128, v41
v_mul_f32 v129, v129, v41
v_mul_f32 v130, v130, v41
v_mul_f32 v131, v131, v41
v_mul_f32 v132, v132, v41
v_mul_f32 v133, v133, v41
v_mul_f32 v134, v134, v41
v_mul_f32 v135, v135, v41
v_cvt_pk_bf16_f32 v128, v128, v129
v_cvt_pk_bf16_f32 v129, v130, v131
v_cvt_pk_bf16_f32 v130, v132, v133
v_cvt_pk_bf16_f32 v131, v134, v135
ds_write_b128 v251, v[128:131] offset:12288
s_waitcnt vmcnt(11)
v_mfma_f32_16x16x32_bf16 v[160:163], a[208:211], v[228:231], v[160:163]
buffer_load_dwordx4 a[252:255], v241, s[16:19], s41 offen offset:3072 sc1
v_mfma_f32_16x16x32_bf16 v[164:167], a[212:215], v[228:231], v[164:167]
v_mfma_f32_16x16x32_bf16 v[168:171], a[216:219], v[228:231], v[168:171]
v_mfma_f32_16x16x32_bf16 v[172:175], a[220:223], v[228:231], v[172:175]
s_waitcnt lgkmcnt(0)
s_barrier
ds_read_b128 v[208:211], v252 offset:8192
ds_read_b128 v[212:215], v252 offset:9216
ds_read_b128 v[216:219], v252 offset:10240
ds_read_b128 v[220:223], v252 offset:11264
ds_read_b128 v[224:227], v252 offset:12288
s_waitcnt vmcnt(10)
s_waitcnt lgkmcnt(4)
v_mfma_f32_16x16x32_bf16 v[176:179], a[128:131], v[208:211], v[176:179]
ds_read_b128 v[228:231], v252 offset:6144
v_swap_b32 v90, v92
v_mfma_f32_16x16x32_bf16 v[180:183], a[132:135], v[208:211], v[180:183]
v_swap_b32 v91, v93
s_nop 1
v_mfma_f32_16x16x32_bf16 v[136:139], v[88:91], v[24:27], 0
s_add_u32 s49, s29, s46
buffer_load_dwordx4 v[112:115], v47, s[16:19], s49 offen sc1
v_mfma_f32_16x16x32_bf16 v[140:143], v[92:95], v[24:27], 0
s_add_u32 s3, s29, s47
s_cmp_lt_u32 s37, 4
s_cbranch_scc1 LF_o0
buffer_load_dwordx4 v[116:119], v47, s[16:19], s3 offen sc1
ds_read_b128 v[36:39], v78 offset:0
s_branch LF_j0
LF_o0:
s_mov_b32 s3, 0x70000000
buffer_load_dwordx4 v[36:39], v47, s[16:19], s3 offen sc1
ds_read_b128 v[116:119], v78 offset:0
LF_j0:
v_mfma_f32_16x16x32_bf16 v[184:187], a[136:139], v[208:211], v[184:187]
v_mfma_f32_16x16x32_bf16 v[188:191], a[140:143], v[208:211], v[188:191]
s_waitcnt lgkmcnt(5)
v_mfma_f32_16x16x32_bf16 v[176:179], a[144:147], v[212:215], v[176:179]
ds_read_b128 v[208:211], v252 offset:13312
v_mfma_f32_16x16x32_bf16 v[180:183], a[148:151], v[212:215], v[180:183]
v_mfma_f32_16x16x32_bf16 v[184:187], a[152:155], v[212:215], v[184:187]
v_mfma_f32_16x16x32_bf16 v[188:191], a[156:159], v[212:215], v[188:191]
s_waitcnt vmcnt(11)
s_waitcnt lgkmcnt(5)
v_mfma_f32_16x16x32_bf16 v[176:179], a[160:163], v[216:219], v[176:179]
ds_read_b128 v[212:215], v252 offset:14336
v_mfma_f32_16x16x32_bf16 v[180:183], a[164:167], v[216:219], v[180:183]
v_mfma_f32_16x16x32_bf16 v[184:187], a[168:171], v[216:219], v[184:187]
v_mfma_f32_16x16x32_bf16 v[188:191], a[172:175], v[216:219], v[188:191]
s_waitcnt vmcnt(10)
s_waitcnt lgkmcnt(5)
v_mfma_f32_16x16x32_bf16 v[176:179], a[176:179], v[220:223], v[176:179]
ds_read_b128 v[216:219], v252 offset:7168
s_add_u32 s49, s29, s42
buffer_load_dwordx4 v[120:123], v43, s[16:19], s49 offen sc1
v_mfma_f32_16x16x32_bf16 v[180:183], a[180:183], v[220:223], v[180:183]
s_add_u32 s3, s29, s43
buffer_load_dwordx4 v[124:127], v43, s[16:19], s3 offen sc1
v_mfma_f32_16x16x32_bf16 v[184:187], a[184:187], v[220:223], v[184:187]
v_mfma_f32_16x16x32_bf16 v[188:191], a[188:191], v[220:223], v[188:191]
s_waitcnt vmcnt(11)
s_waitcnt lgkmcnt(5)
v_mfma_f32_16x16x32_bf16 v[176:179], a[192:195], v[224:227], v[176:179]
ds_read_b128 v[220:223], v252 offset:15360
v_mfma_f32_16x16x32_bf16 v[180:183], a[196:199], v[224:227], v[180:183]
v_mfma_f32_16x16x32_bf16 v[184:187], a[200:203], v[224:227], v[184:187]
v_mfma_f32_16x16x32_bf16 v[188:191], a[204:207], v[224:227], v[188:191]
s_waitcnt vmcnt(10)
s_waitcnt lgkmcnt(5)
v_mfma_f32_16x16x32_bf16 v[160:163], a[224:227], v[228:231], v[160:163]
s_add_u32 s49, s29, s44
buffer_load_dwordx4 v[48:51], v43, s[16:19], s49 offen sc1
v_mfma_f32_16x16x32_bf16 v[164:167], a[228:231], v[228:231], v[164:167]
s_add_u32 s3, s29, s45
buffer_load_dwordx4 v[52:55], v43, s[16:19], s3 offen sc1
v_mfma_f32_16x16x32_bf16 v[168:171], a[232:235], v[228:231], v[168:171]
v_mfma_f32_16x16x32_bf16 v[172:175], a[236:239], v[228:231], v[172:175]
s_waitcnt vmcnt(10)
s_waitcnt lgkmcnt(3)
v_mfma_f32_16x16x32_bf16 v[176:179], a[208:211], v[208:211], v[176:179]
v_swap_b32 v98, v100
v_mfma_f32_16x16x32_bf16 v[180:183], a[212:215], v[208:211], v[180:183]
v_swap_b32 v99, v101
s_nop 1
v_mfma_f32_16x16x32_bf16 v[136:139], v[96:99], v[28:31], v[136:139]
s_add_u32 s49, s29, s46
buffer_load_dwordx4 v[56:59], v43, s[16:19], s49 offen sc1
v_mfma_f32_16x16x32_bf16 v[140:143], v[100:103], v[28:31], v[140:143]
s_add_u32 s3, s29, s47
s_cmp_lt_u32 s37, 4
s_cbranch_scc1 LF_o1
buffer_load_dwordx4 v[60:63], v43, s[16:19], s3 offen sc1
ds_read_b128 v[36:39], v78 offset:4096
s_branch LF_j1
LF_o1:
s_mov_b32 s3, 0x70000000
buffer_load_dwordx4 v[36:39], v43, s[16:19], s3 offen sc1
ds_read_b128 v[60:63], v78 offset:4096
LF_j1:
v_mfma_f32_16x16x32_bf16 v[184:187], a[216:219], v[208:211], v[184:187]
v_mfma_f32_16x16x32_bf16 v[188:191], a[220:223], v[208:211], v[188:191]
s_waitcnt lgkmcnt(3)
v_mfma_f32_16x16x32_bf16 v[176:179], a[224:227], v[212:215], v[176:179]
v_mfma_f32_16x16x32_bf16 v[180:183], a[228:231], v[212:215], v[180:183]
v_mfma_f32_16x16x32_bf16 v[184:187], a[232:235], v[212:215], v[184:187]
v_mfma_f32_16x16x32_bf16 v[188:191], a[236:239], v[212:215], v[188:191]
s_waitcnt vmcnt(11)
s_waitcnt vmcnt(10)
s_waitcnt vmcnt(9)
s_waitcnt vmcnt(8)
s_waitcnt lgkmcnt(2)
v_mfma_f32_16x16x32_bf16 v[160:163], a[240:243], v[216:219], v[160:163]
v_mfma_f32_16x16x32_bf16 v[164:167], a[244:247], v[216:219], v[164:167]
v_mfma_f32_16x16x32_bf16 v[168:171], a[248:251], v[216:219], v[168:171]
v_mfma_f32_16x16x32_bf16 v[172:175], a[252:255], v[216:219], v[172:175]
s_waitcnt vmcnt(6)
s_waitcnt lgkmcnt(1)
v_mfma_f32_16x16x32_bf16 v[176:179], a[240:243], v[220:223], v[176:179]
v_swap_b32 v114, v116
v_mfma_f32_16x16x32_bf16 v[180:183], a[244:247], v[220:223], v[180:183]
v_swap_b32 v115, v117
s_nop 1
v_mfma_f32_16x16x32_bf16 v[136:139], v[112:115], v[32:35], v[136:139]
v_cvt_pk_bf16_f32 v160, v160, v161
v_cvt_pk_bf16_f32 v161, v162, v163
v_mfma_f32_16x16x32_bf16 v[140:143], v[116:119], v[32:35], v[140:143]
v_cvt_pk_bf16_f32 v162, v164, v165
v_cvt_pk_bf16_f32 v163, v166, v167
v_mfma_f32_16x16x32_bf16 v[184:187], a[248:251], v[220:223], v[184:187]
ds_write_b128 v245, v[160:163] offset:0
v_cvt_pk_bf16_f32 v168, v168, v169
v_mfma_f32_16x16x32_bf16 v[188:191], a[252:255], v[220:223], v[188:191]
v_cvt_pk_bf16_f32 v169, v170, v171
v_cvt_pk_bf16_f32 v170, v172, v173
v_cvt_pk_bf16_f32 v171, v174, v175
ds_write_b128 v246, v[168:171] offset:0
ds_read_b128 v[164:167], v247 offset:0
ds_read_b128 v[172:175], v247 offset:1024
v_mul_f32 v136, v136, v42
v_mul_f32 v137, v137, v42
v_mul_f32 v138, v138, v42
v_mul_f32 v139, v139, v42
v_mul_f32 v140, v140, v42
v_mul_f32 v141, v141, v42
v_mul_f32 v142, v142, v42
v_mul_f32 v143, v143, v42
v_cvt_pk_bf16_f32 v136, v136, v137
v_cvt_pk_bf16_f32 v137, v138, v139
v_cvt_pk_bf16_f32 v138, v140, v141
v_cvt_pk_bf16_f32 v139, v142, v143
ds_write_b128 v251, v[136:139] offset:16384
s_waitcnt lgkmcnt(0)
s_barrier
ds_read_b128 v[224:227], v252 offset:16384
ds_read_b128 v[228:231], v252 offset:17408
ds_read_b128 v[208:211], v252 offset:18432
ds_read_b128 v[212:215], v252 offset:19456
s_waitcnt vmcnt(4)
s_waitcnt lgkmcnt(3)
v_mfma_f32_16x16x32_bf16 v[192:195], a[128:131], v[224:227], v[192:195]
v_swap_b32 v122, v124
v_mfma_f32_16x16x32_bf16 v[196:199], a[132:135], v[224:227], v[196:199]
v_swap_b32 v123, v125
s_nop 1
v_mfma_f32_16x16x32_bf16 v[128:131], v[120:123], v[24:27], 0
buffer_store_dwordx4 v[164:167], v44, s[56:59], s6 offen sc1
v_mfma_f32_16x16x32_bf16 v[132:135], v[124:127], v[24:27], 0
buffer_store_dwordx4 v[172:175], v45, s[56:59], s6 offen sc1
v_mfma_f32_16x16x32_bf16 v[200:203], a[136:139], v[224:227], v[200:203]
v_cvt_pk_bf16_f32 v176, v176, v177
v_cvt_pk_bf16_f32 v177, v178, v179
v_mfma_f32_16x16x32_bf16 v[204:207], a[140:143], v[224:227], v[204:207]
v_cvt_pk_bf16_f32 v178, v180, v181
v_cvt_pk_bf16_f32 v179, v182, v183
s_waitcnt lgkmcnt(2)
v_mfma_f32_16x16x32_bf16 v[192:195], a[144:147], v[228:231], v[192:195]
ds_write_b128 v245, v[176:179] offset:2048
v_cvt_pk_bf16_f32 v184, v184, v185
v_mfma_f32_16x16x32_bf16 v[196:199], a[148:151], v[228:231], v[196:199]
v_cvt_pk_bf16_f32 v185, v186, v187
v_cvt_pk_bf16_f32 v186, v188, v189
v_mfma_f32_16x16x32_bf16 v[200:203], a[152:155], v[228:231], v[200:203]
v_cvt_pk_bf16_f32 v187, v190, v191
ds_write_b128 v246, v[184:187] offset:2048
v_mfma_f32_16x16x32_bf16 v[204:207], a[156:159], v[228:231], v[204:207]
ds_read_b128 v[180:183], v247 offset:2048
ds_read_b128 v[188:191], v247 offset:3072
s_waitcnt vmcnt(4)
s_waitcnt lgkmcnt(5)
v_mfma_f32_16x16x32_bf16 v[192:195], a[160:163], v[208:211], v[192:195]
v_swap_b32 v50, v52
v_mfma_f32_16x16x32_bf16 v[196:199], a[164:167], v[208:211], v[196:199]
v_swap_b32 v51, v53
s_nop 1
v_mfma_f32_16x16x32_bf16 v[128:131], v[48:51], v[28:31], v[128:131]
s_waitcnt lgkmcnt(1)
buffer_store_dwordx4 v[180:183], v44, s[56:59], s7 offen sc1
v_mfma_f32_16x16x32_bf16 v[132:135], v[52:55], v[28:31], v[132:135]
s_waitcnt lgkmcnt(0)
buffer_store_dwordx4 v[188:191], v45, s[56:59], s7 offen sc1
v_mfma_f32_16x16x32_bf16 v[200:203], a[168:171], v[208:211], v[200:203]
v_mfma_f32_16x16x32_bf16 v[204:207], a[172:175], v[208:211], v[204:207]
v_mfma_f32_16x16x32_bf16 v[192:195], a[176:179], v[212:215], v[192:195]
v_mfma_f32_16x16x32_bf16 v[196:199], a[180:183], v[212:215], v[196:199]
v_mfma_f32_16x16x32_bf16 v[200:203], a[184:187], v[212:215], v[200:203]
v_mfma_f32_16x16x32_bf16 v[204:207], a[188:191], v[212:215], v[204:207]
s_waitcnt vmcnt(4)
v_swap_b32 v58, v60
v_swap_b32 v59, v61
s_nop 1
v_mfma_f32_16x16x32_bf16 v[128:131], v[56:59], v[32:35], v[128:131]
v_mfma_f32_16x16x32_bf16 v[132:135], v[60:63], v[32:35], v[132:135]
s_nop 6
v_mul_f32 v128, v128, v42
v_mul_f32 v129, v129, v42
v_mul_f32 v130, v130, v42
v_mul_f32 v131, v131, v42
v_mul_f32 v132, v132, v42
v_mul_f32 v133, v133, v42
v_mul_f32 v134, v134, v42
v_mul_f32 v135, v135, v42
v_cvt_pk_bf16_f32 v128, v128, v129
v_cvt_pk_bf16_f32 v129, v130, v131
v_cvt_pk_bf16_f32 v130, v132, v133
v_cvt_pk_bf16_f32 v131, v134, v135
ds_write_b128 v251, v[128:131] offset:20480
s_waitcnt lgkmcnt(0)
s_barrier
ds_read_b128 v[216:219], v252 offset:20480
ds_read_b128 v[220:223], v252 offset:21504
ds_read_b128 v[224:227], v252 offset:22528
ds_read_b128 v[228:231], v252 offset:23552
s_waitcnt lgkmcnt(3)
v_mfma_f32_16x16x32_bf16 v[192:195], a[192:195], v[216:219], v[192:195]
v_mfma_f32_16x16x32_bf16 v[196:199], a[196:199], v[216:219], v[196:199]
v_mfma_f32_16x16x32_bf16 v[200:203], a[200:203], v[216:219], v[200:203]
v_mfma_f32_16x16x32_bf16 v[204:207], a[204:207], v[216:219], v[204:207]
s_waitcnt lgkmcnt(2)
v_mfma_f32_16x16x32_bf16 v[192:195], a[208:211], v[220:223], v[192:195]
v_mfma_f32_16x16x32_bf16 v[196:199], a[212:215], v[220:223], v[196:199]
v_mfma_f32_16x16x32_bf16 v[200:203], a[216:219], v[220:223], v[200:203]
v_mfma_f32_16x16x32_bf16 v[204:207], a[220:223], v[220:223], v[204:207]
s_waitcnt lgkmcnt(1)
v_mfma_f32_16x16x32_bf16 v[192:195], a[224:227], v[224:227], v[192:195]
v_mfma_f32_16x16x32_bf16 v[196:199], a[228:231], v[224:227], v[196:199]
v_mfma_f32_16x16x32_bf16 v[200:203], a[232:235], v[224:227], v[200:203]
v_mfma_f32_16x16x32_bf16 v[204:207], a[236:239], v[224:227], v[204:207]
s_waitcnt lgkmcnt(0)
v_mfma_f32_16x16x32_bf16 v[192:195], a[240:243], v[228:231], v[192:195]
v_mfma_f32_16x16x32_bf16 v[196:199], a[244:247], v[228:231], v[196:199]
v_mfma_f32_16x16x32_bf16 v[200:203], a[248:251], v[228:231], v[200:203]
v_mfma_f32_16x16x32_bf16 v[204:207], a[252:255], v[228:231], v[204:207]
s_nop 4
v_cvt_pk_bf16_f32 v192, v192, v193
v_cvt_pk_bf16_f32 v193, v194, v195
v_cvt_pk_bf16_f32 v194, v196, v197
v_cvt_pk_bf16_f32 v195, v198, v199
ds_write_b128 v245, v[192:195] offset:4096
v_cvt_pk_bf16_f32 v200, v200, v201
v_cvt_pk_bf16_f32 v201, v202, v203
v_cvt_pk_bf16_f32 v202, v204, v205
v_cvt_pk_bf16_f32 v203, v206, v207
ds_write_b128 v246, v[200:203] offset:4096
ds_read_b128 v[196:199], v247 offset:4096
ds_read_b128 v[204:207], v247 offset:5120
s_waitcnt lgkmcnt(1)
buffer_store_dwordx4 v[196:199], v44, s[56:59], s29 offen sc1
s_waitcnt lgkmcnt(0)
buffer_store_dwordx4 v[204:207], v45, s[56:59], s29 offen sc1
s_branch L2_fin
LF_spinQ:
s_mov_b32 s94, 0x10000
LF_spin2Q:
buffer_load_dwordx2 v[248:249], v46, s[16:19], 0 offen offset:0 sc1
s_sub_u32 s94, s94, 1
s_waitcnt vmcnt(0)
s_cbranch_scc1 LF_spin2Q_go
v_cmp_ne_u64 vcc, s[98:99], v[248:249]
s_nop 1
s_cbranch_vccnz LF_spin2Q
LF_spin2Q_go:
s_branch LF_goQ
LF_wf:
s_mov_b32 s94, 0x10000
LF_wf2:
buffer_load_dwordx2 v[108:109], v110, s[16:19], 0 offen sc1
s_sub_u32 s94, s94, 1
s_waitcnt vmcnt(0)
s_cbranch_scc1 LF_wf2_go
v_cmp_ne_u64 vcc, s[98:99], v[108:109]
s_nop 1
s_cbranch_vccnz LF_wf2
LF_wf2_go:
s_branch LF_wf_go
LM_pb:
s_mov_b32 s3, 0x10000
LM_pb2:
buffer_load_dwordx2 v[228:229], v230, s[16:19], 0 offen sc1
s_sub_u32 s3, s3, 1
s_waitcnt vmcnt(0)
s_cbranch_scc1 LM_pb2_go
v_cmp_ne_u64 vcc, s[98:99], v[228:229]
s_nop 1
s_cbranch_vccnz LM_pb2
LM_pb2_go:
s_branch LM_pb_ret
L2_Fend:
L2_rare_site0:
s_mov_b32 s36, 0
s_branch L2_rare_0_0
L2_rare_site4:
s_mov_b32 s36, 4
s_branch L2_rare_0_0
L2_rare_0_0:
s_nop 15
s_nop 15
s_waitcnt lgkmcnt(0)
v_add_u32 v250, 0x18000, v240
v_and_b32 v250, 0x1ffff, v250
ds_read_b128 v[232:235], v250 offset:16384
s_waitcnt lgkmcnt(0)
v_mfma_f32_16x16x32_bf16 v[128:131], v[232:235], v[0:3], v[192:195]
v_mfma_f32_16x16x32_bf16 v[132:135], v[232:235], v[32:35], v[196:199]
v_mfma_f32_16x16x32_bf16 v[136:139], v[232:235], v[64:67], v[200:203]
v_mfma_f32_16x16x32_bf16 v[140:143], v[232:235], v[96:99], v[204:207]
s_nop 7
ds_read_b128 v[232:235], v250 offset:16896
s_waitcnt lgkmcnt(0)
v_mfma_f32_16x16x32_bf16 v[128:131], v[232:235], v[4:7], v[128:131]
v_mfma_f32_16x16x32_bf16 v[132:135], v[232:235], v[36:39], v[132:135]
v_mfma_f32_16x16x32_bf16 v[136:139], v[232:235], v[68:71], v[136:139]
v_mfma_f32_16x16x32_bf16 v[140:143], v[232:235], v[100:103], v[140:143]
s_nop 7
ds_read_b128 v[232:235], v250 offset:20480
s_waitcnt lgkmcnt(0)
v_mfma_f32_16x16x32_bf16 v[128:131], v[232:235], v[8:11], v[128:131]
v_mfma_f32_16x16x32_bf16 v[132:135], v[232:235], v[40:43], v[132:135]
v_mfma_f32_16x16x32_bf16 v[136:139], v[232:235], v[72:75], v[136:139]
v_mfma_f32_16x16x32_bf16 v[140:143], v[232:235], v[104:107], v[140:143]
s_nop 7
ds_read_b128 v[232:235], v250 offset:20992
s_waitcnt lgkmcnt(0)
v_mfma_f32_16x16x32_bf16 v[128:131], v[232:235], v[12:15], v[128:131]
v_mfma_f32_16x16x32_bf16 v[132:135], v[232:235], v[44:47], v[132:135]
v_mfma_f32_16x16x32_bf16 v[136:139], v[232:235], v[76:79], v[136:139]
v_mfma_f32_16x16x32_bf16 v[140:143], v[232:235], v[108:111], v[140:143]
s_nop 7
ds_read_b128 v[232:235], v250 offset:24576
s_waitcnt lgkmcnt(0)
v_mfma_f32_16x16x32_bf16 v[128:131], v[232:235], v[16:19], v[128:131]
v_mfma_f32_16x16x32_bf16 v[132:135], v[232:235], v[48:51], v[132:135]
v_mfma_f32_16x16x32_bf16 v[136:139], v[232:235], v[80:83], v[136:139]
v_mfma_f32_16x16x32_bf16 v[140:143], v[232:235], v[112:115], v[140:143]
s_nop 7
ds_read_b128 v[232:235], v250 offset:25088
s_waitcnt lgkmcnt(0)
v_mfma_f32_16x16x32_bf16 v[128:131], v[232:235], v[20:23], v[128:131]
v_mfma_f32_16x16x32_bf16 v[132:135], v[232:235], v[52:55], v[132:135]
v_mfma_f32_16x16x32_bf16 v[136:139], v[232:235], v[84:87], v[136:139]
v_mfma_f32_16x16x32_bf16 v[140:143], v[232:235], v[116:119], v[140:143]
s_nop 7
ds_read_b128 v[232:235], v250 offset:28672
s_waitcnt lgkmcnt(0)
v_mfma_f32_16x16x32_bf16 v[128:131], v[232:235], v[24:27], v[128:131]
v_mfma_f32_16x16x32_bf16 v[132:135], v[232:235], v[56:59], v[132:135]
v_mfma_f32_16x16x32_bf16 v[136:139], v[232:235], v[88:91], v[136:139]
v_mfma_f32_16x16x32_bf16 v[140:143], v[232:235], v[120:123], v[140:143]
s_nop 7
ds_read_b128 v[232:235], v250 offset:29184
s_waitcnt lgkmcnt(0)
v_mfma_f32_16x16x32_bf16 v[128:131], v[232:235], v[28:31], v[128:131]
v_mfma_f32_16x16x32_bf16 v[132:135], v[232:235], v[60:63], v[132:135]
v_mfma_f32_16x16x32_bf16 v[136:139], v[232:235], v[92:95], v[136:139]
v_mfma_f32_16x16x32_bf16 v[140:143], v[232:235], v[124:127], v[140:143]
s_nop 7
s_nop 7
v_exp_f32 v248, v128
s_nop 0
v_sub_f32 v224, v224, v248
v_exp_f32 v248, v129
s_nop 0
v_sub_f32 v224, v224, v248
v_exp_f32 v248, v130
s_nop 0
v_sub_f32 v224, v224, v248
v_exp_f32 v248, v131
s_nop 0
v_sub_f32 v224, v224, v248
v_max_f32 v224, 0, v224
v_min_f32 v224, s32, v224
v_log_f32 v248, v224
v_max3_f32 v232, v128, v129, v130
v_max3_f32 v232, v232, v131, v248
v_mov_b32 v248, v232
s_nop 1
v_permlane32_swap_b32 v232, v248
s_nop 1
v_max_f32 v232, v232, v248
v_mov_b32 v248, v232
s_nop 1
v_permlane16_swap_b32 v232, v248
s_nop 1
v_max_f32 v232, v232, v248
v_ceil_f32 v232, v232
v_max_f32 v232, 0, v232
v_sub_f32 v248, 0, v232
v_exp_f32 v236, v248
s_nop 1
v_mul_f32 v224, v224, v236
v_sub_f32 v192, v192, v232
v_sub_f32 v128, v128, v232
v_sub_f32 v144, v144, v232
v_sub_f32 v193, v193, v232
v_sub_f32 v129, v129, v232
v_sub_f32 v145, v145, v232
v_sub_f32 v194, v194, v232
v_sub_f32 v130, v130, v232
v_sub_f32 v146, v146, v232
v_sub_f32 v195, v195, v232
v_sub_f32 v131, v131, v232
v_sub_f32 v147, v147, v232
v_lshlrev_b32 v242, 16, v160
v_and_b32 v248, 0xffff0000, v160
v_mul_f32 v242, v242, v236
v_mul_f32 v248, v248, v236
v_cvt_pk_bf16_f32 v160, v242, v248
v_lshlrev_b32 v242, 16, v161
v_and_b32 v248, 0xffff0000, v161
v_mul_f32 v242, v242, v236
v_mul_f32 v248, v248, v236
v_cvt_pk_bf16_f32 v161, v242, v248
v_lshlrev_b32 v242, 16, v162
v_and_b32 v248, 0xffff0000, v162
v_mul_f32 v242, v242, v236
v_mul_f32 v248, v248, v236
v_cvt_pk_bf16_f32 v162, v242, v248
v_lshlrev_b32 v242, 16, v163
v_and_b32 v248, 0xffff0000, v163
v_mul_f32 v242, v242, v236
v_mul_f32 v248, v248, v236
v_cvt_pk_bf16_f32 v163, v242, v248
v_lshlrev_b32 v242, 16, v176
v_and_b32 v248, 0xffff0000, v176
v_mul_f32 v242, v242, v236
v_mul_f32 v248, v248, v236
v_cvt_pk_bf16_f32 v176, v242, v248
v_lshlrev_b32 v242, 16, v177
v_and_b32 v248, 0xffff0000, v177
v_mul_f32 v242, v242, v236
v_mul_f32 v248, v248, v236
v_cvt_pk_bf16_f32 v177, v242, v248
v_lshlrev_b32 v242, 16, v178
v_and_b32 v248, 0xffff0000, v178
v_mul_f32 v242, v242, v236
v_mul_f32 v248, v248, v236
v_cvt_pk_bf16_f32 v178, v242, v248
v_lshlrev_b32 v242, 16, v179
v_and_b32 v248, 0xffff0000, v179
v_mul_f32 v242, v242, v236
v_mul_f32 v248, v248, v236
v_cvt_pk_bf16_f32 v179, v242, v248
v_exp_f32 v248, v132
s_nop 0
v_sub_f32 v225, v225, v248
v_exp_f32 v248, v133
s_nop 0
v_sub_f32 v225, v225, v248
v_exp_f32 v248, v134
s_nop 0
v_sub_f32 v225, v225, v248
v_exp_f32 v248, v135
s_nop 0
v_sub_f32 v225, v225, v248
v_max_f32 v225, 0, v225
v_min_f32 v225, s32, v225
v_log_f32 v248, v225
v_max3_f32 v233, v132, v133, v134
v_max3_f32 v233, v233, v135, v248
v_mov_b32 v248, v233
s_nop 1
v_permlane32_swap_b32 v233, v248
s_nop 1
v_max_f32 v233, v233, v248
v_mov_b32 v248, v233
s_nop 1
v_permlane16_swap_b32 v233, v248
s_nop 1
v_max_f32 v233, v233, v248
v_ceil_f32 v233, v233
v_max_f32 v233, 0, v233
v_sub_f32 v248, 0, v233
v_exp_f32 v237, v248
s_nop 1
v_mul_f32 v225, v225, v237
v_sub_f32 v196, v196, v233
v_sub_f32 v132, v132, v233
v_sub_f32 v148, v148, v233
v_sub_f32 v197, v197, v233
v_sub_f32 v133, v133, v233
v_sub_f32 v149, v149, v233
v_sub_f32 v198, v198, v233
v_sub_f32 v134, v134, v233
v_sub_f32 v150, v150, v233
v_sub_f32 v199, v199, v233
v_sub_f32 v135, v135, v233
v_sub_f32 v151, v151, v233
v_lshlrev_b32 v242, 16, v164
v_and_b32 v248, 0xffff0000, v164
v_mul_f32 v242, v242, v237
v_mul_f32 v248, v248, v237
v_cvt_pk_bf16_f32 v164, v242, v248
v_lshlrev_b32 v242, 16, v165
v_and_b32 v248, 0xffff0000, v165
v_mul_f32 v242, v242, v237
v_mul_f32 v248, v248, v237
v_cvt_pk_bf16_f32 v165, v242, v248
v_lshlrev_b32 v242, 16, v166
v_and_b32 v248, 0xffff0000, v166
v_mul_f32 v242, v242, v237
v_mul_f32 v248, v248, v237
v_cvt_pk_bf16_f32 v166, v242, v248
v_lshlrev_b32 v242, 16, v167
v_and_b32 v248, 0xffff0000, v167
v_mul_f32 v242, v242, v237
v_mul_f32 v248, v248, v237
v_cvt_pk_bf16_f32 v167, v242, v248
v_lshlrev_b32 v242, 16, v180
v_and_b32 v248, 0xffff0000, v180
v_mul_f32 v242, v242, v237
v_mul_f32 v248, v248, v237
v_cvt_pk_bf16_f32 v180, v242, v248
v_lshlrev_b32 v242, 16, v181
v_and_b32 v248, 0xffff0000, v181
v_mul_f32 v242, v242, v237
v_mul_f32 v248, v248, v237
v_cvt_pk_bf16_f32 v181, v242, v248
v_lshlrev_b32 v242, 16, v182
v_and_b32 v248, 0xffff0000, v182
v_mul_f32 v242, v242, v237
v_mul_f32 v248, v248, v237
v_cvt_pk_bf16_f32 v182, v242, v248
v_lshlrev_b32 v242, 16, v183
v_and_b32 v248, 0xffff0000, v183
v_mul_f32 v242, v242, v237
v_mul_f32 v248, v248, v237
v_cvt_pk_bf16_f32 v183, v242, v248
v_exp_f32 v248, v136
s_nop 0
v_sub_f32 v226, v226, v248
v_exp_f32 v248, v137
s_nop 0
v_sub_f32 v226, v226, v248
v_exp_f32 v248, v138
s_nop 0
v_sub_f32 v226, v226, v248
v_exp_f32 v248, v139
s_nop 0
v_sub_f32 v226, v226, v248
v_max_f32 v226, 0, v226
v_min_f32 v226, s32, v226
v_log_f32 v248, v226
v_max3_f32 v234, v136, v137, v138
v_max3_f32 v234, v234, v139, v248
v_mov_b32 v248, v234
s_nop 1
v_permlane32_swap_b32 v234, v248
s_nop 1
v_max_f32 v234, v234, v248
v_mov_b32 v248, v234
s_nop 1
v_permlane16_swap_b32 v234, v248
s_nop 1
v_max_f32 v234, v234, v248
v_ceil_f32 v234, v234
v_max_f32 v234, 0, v234
v_sub_f32 v248, 0, v234
v_exp_f32 v238, v248
s_nop 1
v_mul_f32 v226, v226, v238
v_sub_f32 v200, v200, v234
v_sub_f32 v136, v136, v234
v_sub_f32 v152, v152, v234
v_sub_f32 v201, v201, v234
v_sub_f32 v137, v137, v234
v_sub_f32 v153, v153, v234
v_sub_f32 v202, v202, v234
v_sub_f32 v138, v138, v234
v_sub_f32 v154, v154, v234
v_sub_f32 v203, v203, v234
v_sub_f32 v139, v139, v234
v_sub_f32 v155, v155, v234
v_lshlrev_b32 v242, 16, v168
v_and_b32 v248, 0xffff0000, v168
v_mul_f32 v242, v242, v238
v_mul_f32 v248, v248, v238
v_cvt_pk_bf16_f32 v168, v242, v248
v_lshlrev_b32 v242, 16, v169
v_and_b32 v248, 0xffff0000, v169
v_mul_f32 v242, v242, v238
v_mul_f32 v248, v248, v238
v_cvt_pk_bf16_f32 v169, v242, v248
v_lshlrev_b32 v242, 16, v170
v_and_b32 v248, 0xffff0000, v170
v_mul_f32 v242, v242, v238
v_mul_f32 v248, v248, v238
v_cvt_pk_bf16_f32 v170, v242, v248
v_lshlrev_b32 v242, 16, v171
v_and_b32 v248, 0xffff0000, v171
v_mul_f32 v242, v242, v238
v_mul_f32 v248, v248, v238
v_cvt_pk_bf16_f32 v171, v242, v248
v_lshlrev_b32 v242, 16, v184
v_and_b32 v248, 0xffff0000, v184
v_mul_f32 v242, v242, v238
v_mul_f32 v248, v248, v238
v_cvt_pk_bf16_f32 v184, v242, v248
v_lshlrev_b32 v242, 16, v185
v_and_b32 v248, 0xffff0000, v185
v_mul_f32 v242, v242, v238
v_mul_f32 v248, v248, v238
v_cvt_pk_bf16_f32 v185, v242, v248
v_lshlrev_b32 v242, 16, v186
v_and_b32 v248, 0xffff0000, v186
v_mul_f32 v242, v242, v238
v_mul_f32 v248, v248, v238
v_cvt_pk_bf16_f32 v186, v242, v248
v_lshlrev_b32 v242, 16, v187
v_and_b32 v248, 0xffff0000, v187
v_mul_f32 v242, v242, v238
v_mul_f32 v248, v248, v238
v_cvt_pk_bf16_f32 v187, v242, v248
v_exp_f32 v248, v140
s_nop 0
v_sub_f32 v227, v227, v248
v_exp_f32 v248, v141
s_nop 0
v_sub_f32 v227, v227, v248
v_exp_f32 v248, v142
s_nop 0
v_sub_f32 v227, v227, v248
v_exp_f32 v248, v143
s_nop 0
v_sub_f32 v227, v227, v248
v_max_f32 v227, 0, v227
v_min_f32 v227, s32, v227
v_log_f32 v248, v227
v_max3_f32 v235, v140, v141, v142
v_max3_f32 v235, v235, v143, v248
v_mov_b32 v248, v235
s_nop 1
v_permlane32_swap_b32 v235, v248
s_nop 1
v_max_f32 v235, v235, v248
v_mov_b32 v248, v235
s_nop 1
v_permlane16_swap_b32 v235, v248
s_nop 1
v_max_f32 v235, v235, v248
v_ceil_f32 v235, v235
v_max_f32 v235, 0, v235
v_sub_f32 v248, 0, v235
v_exp_f32 v239, v248
s_nop 1
v_mul_f32 v227, v227, v239
v_sub_f32 v204, v204, v235
v_sub_f32 v140, v140, v235
v_sub_f32 v156, v156, v235
v_sub_f32 v205, v205, v235
v_sub_f32 v141, v141, v235
v_sub_f32 v157, v157, v235
v_sub_f32 v206, v206, v235
v_sub_f32 v142, v142, v235
v_sub_f32 v158, v158, v235
v_sub_f32 v207, v207, v235
v_sub_f32 v143, v143, v235
v_sub_f32 v159, v159, v235
v_lshlrev_b32 v242, 16, v172
v_and_b32 v248, 0xffff0000, v172
v_mul_f32 v242, v242, v239
v_mul_f32 v248, v248, v239
v_cvt_pk_bf16_f32 v172, v242, v248
v_lshlrev_b32 v242, 16, v173
v_and_b32 v248, 0xffff0000, v173
v_mul_f32 v242, v242, v239
v_mul_f32 v248, v248, v239
v_cvt_pk_bf16_f32 v173, v242, v248
v_lshlrev_b32 v242, 16, v174
v_and_b32 v248, 0xffff0000, v174
v_mul_f32 v242, v242, v239
v_mul_f32 v248, v248, v239
v_cvt_pk_bf16_f32 v174, v242, v248
v_lshlrev_b32 v242, 16, v175
v_and_b32 v248, 0xffff0000, v175
v_mul_f32 v242, v242, v239
v_mul_f32 v248, v248, v239
v_cvt_pk_bf16_f32 v175, v242, v248
v_lshlrev_b32 v242, 16, v188
v_and_b32 v248, 0xffff0000, v188
v_mul_f32 v242, v242, v239
v_mul_f32 v248, v248, v239
v_cvt_pk_bf16_f32 v188, v242, v248
v_lshlrev_b32 v242, 16, v189
v_and_b32 v248, 0xffff0000, v189
v_mul_f32 v242, v242, v239
v_mul_f32 v248, v248, v239
v_cvt_pk_bf16_f32 v189, v242, v248
v_lshlrev_b32 v242, 16, v190
v_and_b32 v248, 0xffff0000, v190
v_mul_f32 v242, v242, v239
v_mul_f32 v248, v248, v239
v_cvt_pk_bf16_f32 v190, v242, v248
v_lshlrev_b32 v242, 16, v191
v_and_b32 v248, 0xffff0000, v191
v_mul_f32 v242, v242, v239
v_mul_f32 v248, v248, v239
v_cvt_pk_bf16_f32 v191, v242, v248
v_exp_f32 v128, v128
v_exp_f32 v129, v129
v_exp_f32 v130, v130
v_exp_f32 v131, v131
s_nop 1
v_add_f32 v224, v224, v128
v_add_f32 v224, v224, v129
v_add_f32 v224, v224, v130
v_add_f32 v224, v224, v131
v_exp_f32 v132, v132
v_exp_f32 v133, v133
v_exp_f32 v134, v134
v_exp_f32 v135, v135
s_nop 1
v_add_f32 v225, v225, v132
v_add_f32 v225, v225, v133
v_add_f32 v225, v225, v134
v_add_f32 v225, v225, v135
v_exp_f32 v136, v136
v_exp_f32 v137, v137
v_exp_f32 v138, v138
v_exp_f32 v139, v139
s_nop 1
v_add_f32 v226, v226, v136
v_add_f32 v226, v226, v137
v_add_f32 v226, v226, v138
v_add_f32 v226, v226, v139
v_exp_f32 v140, v140
v_exp_f32 v141, v141
v_exp_f32 v142, v142
v_exp_f32 v143, v143
s_nop 1
v_add_f32 v227, v227, v140
v_add_f32 v227, v227, v141
v_add_f32 v227, v227, v142
v_add_f32 v227, v227, v143
s_branch L2_rare_common
L2_rare_site1:
s_mov_b32 s36, 1
s_branch L2_rare_0_1
L2_rare_site5:
s_mov_b32 s36, 5
s_branch L2_rare_0_1
L2_rare_0_1:
s_nop 15
s_nop 15
s_waitcnt lgkmcnt(0)
v_add_u32 v250, 0x18000, v240
v_and_b32 v250, 0x1ffff, v250
ds_read_b128 v[232:235], v250 offset:18432
s_waitcnt lgkmcnt(0)
v_mfma_f32_16x16x32_bf16 v[144:147], v[232:235], v[0:3], v[192:195]
v_mfma_f32_16x16x32_bf16 v[148:151], v[232:235], v[32:35], v[196:199]
v_mfma_f32_16x16x32_bf16 v[152:155], v[232:235], v[64:67], v[200:203]
v_mfma_f32_16x16x32_bf16 v[156:159], v[232:235], v[96:99], v[204:207]
s_nop 7
ds_read_b128 v[232:235], v250 offset:18944
s_waitcnt lgkmcnt(0)
v_mfma_f32_16x16x32_bf16 v[144:147], v[232:235], v[4:7], v[144:147]
v_mfma_f32_16x16x32_bf16 v[148:151], v[232:235], v[36:39], v[148:151]
v_mfma_f32_16x16x32_bf16 v[152:155], v[232:235], v[68:71], v[152:155]
v_mfma_f32_16x16x32_bf16 v[156:159], v[232:235], v[100:103], v[156:159]
s_nop 7
ds_read_b128 v[232:235], v250 offset:22528
s_waitcnt lgkmcnt(0)
v_mfma_f32_16x16x32_bf16 v[144:147], v[232:235], v[8:11], v[144:147]
v_mfma_f32_16x16x32_bf16 v[148:151], v[232:235], v[40:43], v[148:151]
v_mfma_f32_16x16x32_bf16 v[152:155], v[232:235], v[72:75], v[152:155]
v_mfma_f32_16x16x32_bf16 v[156:159], v[232:235], v[104:107], v[156:159]
s_nop 7
ds_read_b128 v[232:235], v250 offset:23040
s_waitcnt lgkmcnt(0)
v_mfma_f32_16x16x32_bf16 v[144:147], v[232:235], v[12:15], v[144:147]
v_mfma_f32_16x16x32_bf16 v[148:151], v[232:235], v[44:47], v[148:151]
v_mfma_f32_16x16x32_bf16 v[152:155], v[232:235], v[76:79], v[152:155]
v_mfma_f32_16x16x32_bf16 v[156:159], v[232:235], v[108:111], v[156:159]
s_nop 7
ds_read_b128 v[232:235], v250 offset:26624
s_waitcnt lgkmcnt(0)
v_mfma_f32_16x16x32_bf16 v[144:147], v[232:235], v[16:19], v[144:147]
v_mfma_f32_16x16x32_bf16 v[148:151], v[232:235], v[48:51], v[148:151]
v_mfma_f32_16x16x32_bf16 v[152:155], v[232:235], v[80:83], v[152:155]
v_mfma_f32_16x16x32_bf16 v[156:159], v[232:235], v[112:115], v[156:159]
s_nop 7
ds_read_b128 v[232:235], v250 offset:27136
s_waitcnt lgkmcnt(0)
v_mfma_f32_16x16x32_bf16 v[144:147], v[232:235], v[20:23], v[144:147]
v_mfma_f32_16x16x32_bf16 v[148:151], v[232:235], v[52:55], v[148:151]
v_mfma_f32_16x16x32_bf16 v[152:155], v[232:235], v[84:87], v[152:155]
v_mfma_f32_16x16x32_bf16 v[156:159], v[232:235], v[116:119], v[156:159]
s_nop 7
ds_read_b128 v[232:235], v250 offset:30720
s_waitcnt lgkmcnt(0)
v_mfma_f32_16x16x32_bf16 v[144:147], v[232:235], v[24:27], v[144:147]
v_mfma_f32_16x16x32_bf16 v[148:151], v[232:235], v[56:59], v[148:151]
v_mfma_f32_16x16x32_bf16 v[152:155], v[232:235], v[88:91], v[152:155]
v_mfma_f32_16x16x32_bf16 v[156:159], v[232:235], v[120:123], v[156:159]
s_nop 7
ds_read_b128 v[232:235], v250 offset:31232
s_waitcnt lgkmcnt(0)
v_mfma_f32_16x16x32_bf16 v[144:147], v[232:235], v[28:31], v[144:147]
v_mfma_f32_16x16x32_bf16 v[148:151], v[232:235], v[60:63], v[148:151]
v_mfma_f32_16x16x32_bf16 v[152:155], v[232:235], v[92:95], v[152:155]
v_mfma_f32_16x16x32_bf16 v[156:159], v[232:235], v[124:127], v[156:159]
s_nop 7
s_nop 7
v_exp_f32 v248, v144
s_nop 0
v_sub_f32 v224, v224, v248
v_exp_f32 v248, v145
s_nop 0
v_sub_f32 v224, v224, v248
v_exp_f32 v248, v146
s_nop 0
v_sub_f32 v224, v224, v248
v_exp_f32 v248, v147
s_nop 0
v_sub_f32 v224, v224, v248
v_max_f32 v224, 0, v224
v_min_f32 v224, s32, v224
v_log_f32 v248, v224
v_max3_f32 v232, v144, v145, v146
v_max3_f32 v232, v232, v147, v248
v_mov_b32 v248, v232
s_nop 1
v_permlane32_swap_b32 v232, v248
s_nop 1
v_max_f32 v232, v232, v248
v_mov_b32 v248, v232
s_nop 1
v_permlane16_swap_b32 v232, v248
s_nop 1
v_max_f32 v232, v232, v248
v_ceil_f32 v232, v232
v_max_f32 v232, 0, v232
v_sub_f32 v248, 0, v232
v_exp_f32 v236, v248
s_nop 1
v_mul_f32 v224, v224, v236
v_sub_f32 v192, v192, v232
v_sub_f32 v128, v128, v232
v_sub_f32 v144, v144, v232
v_sub_f32 v193, v193, v232
v_sub_f32 v129, v129, v232
v_sub_f32 v145, v145, v232
v_sub_f32 v194, v194, v232
v_sub_f32 v130, v130, v232
v_sub_f32 v146, v146, v232
v_sub_f32 v195, v195, v232
v_sub_f32 v131, v131, v232
v_sub_f32 v147, v147, v232
v_lshlrev_b32 v242, 16, v160
v_and_b32 v248, 0xffff0000, v160
v_mul_f32 v242, v242, v236
v_mul_f32 v248, v248, v236
v_cvt_pk_bf16_f32 v160, v242, v248
v_lshlrev_b32 v242, 16, v161
v_and_b32 v248, 0xffff0000, v161
v_mul_f32 v242, v242, v236
v_mul_f32 v248, v248, v236
v_cvt_pk_bf16_f32 v161, v242, v248
v_lshlrev_b32 v242, 16, v162
v_and_b32 v248, 0xffff0000, v162
v_mul_f32 v242, v242, v236
v_mul_f32 v248, v248, v236
v_cvt_pk_bf16_f32 v162, v242, v248
v_lshlrev_b32 v242, 16, v163
v_and_b32 v248, 0xffff0000, v163
v_mul_f32 v242, v242, v236
v_mul_f32 v248, v248, v236
v_cvt_pk_bf16_f32 v163, v242, v248
v_lshlrev_b32 v242, 16, v176
v_and_b32 v248, 0xffff0000, v176
v_mul_f32 v242, v242, v236
v_mul_f32 v248, v248, v236
v_cvt_pk_bf16_f32 v176, v242, v248
v_lshlrev_b32 v242, 16, v177
v_and_b32 v248, 0xffff0000, v177
v_mul_f32 v242, v242, v236
v_mul_f32 v248, v248, v236
v_cvt_pk_bf16_f32 v177, v242, v248
v_exp_f32 v248, v148
s_nop 0
v_sub_f32 v225, v225, v248
v_exp_f32 v248, v149
s_nop 0
v_sub_f32 v225, v225, v248
v_exp_f32 v248, v150
s_nop 0
v_sub_f32 v225, v225, v248
v_exp_f32 v248, v151
s_nop 0
v_sub_f32 v225, v225, v248
v_max_f32 v225, 0, v225
v_min_f32 v225, s32, v225
v_log_f32 v248, v225
v_max3_f32 v233, v148, v149, v150
v_max3_f32 v233, v233, v151, v248
v_mov_b32 v248, v233
s_nop 1
v_permlane32_swap_b32 v233, v248
s_nop 1
v_max_f32 v233, v233, v248
v_mov_b32 v248, v233
s_nop 1
v_permlane16_swap_b32 v233, v248
s_nop 1
v_max_f32 v233, v233, v248
v_ceil_f32 v233, v233
v_max_f32 v233, 0, v233
v_sub_f32 v248, 0, v233
v_exp_f32 v237, v248
s_nop 1
v_mul_f32 v225, v225, v237
v_sub_f32 v196, v196, v233
v_sub_f32 v132, v132, v233
v_sub_f32 v148, v148, v233
v_sub_f32 v197, v197, v233
v_sub_f32 v133, v133, v233
v_sub_f32 v149, v149, v233
v_sub_f32 v198, v198, v233
v_sub_f32 v134, v134, v233
v_sub_f32 v150, v150, v233
v_sub_f32 v199, v199, v233
v_sub_f32 v135, v135, v233
v_sub_f32 v151, v151, v233
v_lshlrev_b32 v242, 16, v164
v_and_b32 v248, 0xffff0000, v164
v_mul_f32 v242, v242, v237
v_mul_f32 v248, v248, v237
v_cvt_pk_bf16_f32 v164, v242, v248
v_lshlrev_b32 v242, 16, v165
v_and_b32 v248, 0xffff0000, v165
v_mul_f32 v242, v242, v237
v_mul_f32 v248, v248, v237
v_cvt_pk_bf16_f32 v165, v242, v248
v_lshlrev_b32 v242, 16, v166
v_and_b32 v248, 0xffff0000, v166
v_mul_f32 v242, v242, v237
v_mul_f32 v248, v248, v237
v_cvt_pk_bf16_f32 v166, v242, v248
v_lshlrev_b32 v242, 16, v167
v_and_b32 v248, 0xffff0000, v167
v_mul_f32 v242, v242, v237
v_mul_f32 v248, v248, v237
v_cvt_pk_bf16_f32 v167, v242, v248
v_lshlrev_b32 v242, 16, v180
v_and_b32 v248, 0xffff0000, v180
v_mul_f32 v242, v242, v237
v_mul_f32 v248, v248, v237
v_cvt_pk_bf16_f32 v180, v242, v248
v_lshlrev_b32 v242, 16, v181
v_and_b32 v248, 0xffff0000, v181
v_mul_f32 v242, v242, v237
v_mul_f32 v248, v248, v237
v_cvt_pk_bf16_f32 v181, v242, v248
v_exp_f32 v248, v152
s_nop 0
v_sub_f32 v226, v226, v248
v_exp_f32 v248, v153
s_nop 0
v_sub_f32 v226, v226, v248
v_exp_f32 v248, v154
s_nop 0
v_sub_f32 v226, v226, v248
v_exp_f32 v248, v155
s_nop 0
v_sub_f32 v226, v226, v248
v_max_f32 v226, 0, v226
v_min_f32 v226, s32, v226
v_log_f32 v248, v226
v_max3_f32 v234, v152, v153, v154
v_max3_f32 v234, v234, v155, v248
v_mov_b32 v248, v234
s_nop 1
v_permlane32_swap_b32 v234, v248
s_nop 1
v_max_f32 v234, v234, v248
v_mov_b32 v248, v234
s_nop 1
v_permlane16_swap_b32 v234, v248
s_nop 1
v_max_f32 v234, v234, v248
v_ceil_f32 v234, v234
v_max_f32 v234, 0, v234
v_sub_f32 v248, 0, v234
v_exp_f32 v238, v248
s_nop 1
v_mul_f32 v226, v226, v238
v_sub_f32 v200, v200, v234
v_sub_f32 v136, v136, v234
v_sub_f32 v152, v152, v234
v_sub_f32 v201, v201, v234
v_sub_f32 v137, v137, v234
v_sub_f32 v153, v153, v234
v_sub_f32 v202, v202, v234
v_sub_f32 v138, v138, v234
v_sub_f32 v154, v154, v234
v_sub_f32 v203, v203, v234
v_sub_f32 v139, v139, v234
v_sub_f32 v155, v155, v234
v_lshlrev_b32 v242, 16, v168
v_and_b32 v248, 0xffff0000, v168
v_mul_f32 v242, v242, v238
v_mul_f32 v248, v248, v238
v_cvt_pk_bf16_f32 v168, v242, v248
v_lshlrev_b32 v242, 16, v169
v_and_b32 v248, 0xffff0000, v169
v_mul_f32 v242, v242, v238
v_mul_f32 v248, v248, v238
v_cvt_pk_bf16_f32 v169, v242, v248
v_lshlrev_b32 v242, 16, v170
v_and_b32 v248, 0xffff0000, v170
v_mul_f32 v242, v242, v238
v_mul_f32 v248, v248, v238
v_cvt_pk_bf16_f32 v170, v242, v248
v_lshlrev_b32 v242, 16, v171
v_and_b32 v248, 0xffff0000, v171
v_mul_f32 v242, v242, v238
v_mul_f32 v248, v248, v238
v_cvt_pk_bf16_f32 v171, v242, v248
v_lshlrev_b32 v242, 16, v184
v_and_b32 v248, 0xffff0000, v184
v_mul_f32 v242, v242, v238
v_mul_f32 v248, v248, v238
v_cvt_pk_bf16_f32 v184, v242, v248
v_lshlrev_b32 v242, 16, v185
v_and_b32 v248, 0xffff0000, v185
v_mul_f32 v242, v242, v238
v_mul_f32 v248, v248, v238
v_cvt_pk_bf16_f32 v185, v242, v248
v_exp_f32 v248, v156
s_nop 0
v_sub_f32 v227, v227, v248
v_exp_f32 v248, v157
s_nop 0
v_sub_f32 v227, v227, v248
v_exp_f32 v248, v158
s_nop 0
v_sub_f32 v227, v227, v248
v_exp_f32 v248, v159
s_nop 0
v_sub_f32 v227, v227, v248
v_max_f32 v227, 0, v227
v_min_f32 v227, s32, v227
v_log_f32 v248, v227
v_max3_f32 v235, v156, v157, v158
v_max3_f32 v235, v235, v159, v248
v_mov_b32 v248, v235
s_nop 1
v_permlane32_swap_b32 v235, v248
s_nop 1
v_max_f32 v235, v235, v248
v_mov_b32 v248, v235
s_nop 1
v_permlane16_swap_b32 v235, v248
s_nop 1
v_max_f32 v235, v235, v248
v_ceil_f32 v235, v235
v_max_f32 v235, 0, v235
v_sub_f32 v248, 0, v235
v_exp_f32 v239, v248
s_nop 1
v_mul_f32 v227, v227, v239
v_sub_f32 v204, v204, v235
v_sub_f32 v140, v140, v235
v_sub_f32 v156, v156, v235
v_sub_f32 v205, v205, v235
v_sub_f32 v141, v141, v235
v_sub_f32 v157, v157, v235
v_sub_f32 v206, v206, v235
v_sub_f32 v142, v142, v235
v_sub_f32 v158, v158, v235
v_sub_f32 v207, v207, v235
v_sub_f32 v143, v143, v235
v_sub_f32 v159, v159, v235
v_lshlrev_b32 v242, 16, v172
v_and_b32 v248, 0xffff0000, v172
v_mul_f32 v242, v242, v239
v_mul_f32 v248, v248, v239
v_cvt_pk_bf16_f32 v172, v242, v248
v_lshlrev_b32 v242, 16, v173
v_and_b32 v248, 0xffff0000, v173
v_mul_f32 v242, v242, v239
v_mul_f32 v248, v248, v239
v_cvt_pk_bf16_f32 v173, v242, v248
v_lshlrev_b32 v242, 16, v174
v_and_b32 v248, 0xffff0000, v174
v_mul_f32 v242, v242, v239
v_mul_f32 v248, v248, v239
v_cvt_pk_bf16_f32 v174, v242, v248
v_lshlrev_b32 v242, 16, v175
v_and_b32 v248, 0xffff0000, v175
v_mul_f32 v242, v242, v239
v_mul_f32 v248, v248, v239
v_cvt_pk_bf16_f32 v175, v242, v248
v_lshlrev_b32 v242, 16, v188
v_and_b32 v248, 0xffff0000, v188
v_mul_f32 v242, v242, v239
v_mul_f32 v248, v248, v239
v_cvt_pk_bf16_f32 v188, v242, v248
v_lshlrev_b32 v242, 16, v189
v_and_b32 v248, 0xffff0000, v189
v_mul_f32 v242, v242, v239
v_mul_f32 v248, v248, v239
v_cvt_pk_bf16_f32 v189, v242, v248
v_exp_f32 v144, v144
v_exp_f32 v145, v145
v_exp_f32 v146, v146
v_exp_f32 v147, v147
s_nop 1
v_add_f32 v224, v224, v144
v_add_f32 v224, v224, v145
v_add_f32 v224, v224, v146
v_add_f32 v224, v224, v147
v_exp_f32 v148, v148
v_exp_f32 v149, v149
v_exp_f32 v150, v150
v_exp_f32 v151, v151
s_nop 1
v_add_f32 v225, v225, v148
v_add_f32 v225, v225, v149
v_add_f32 v225, v225, v150
v_add_f32 v225, v225, v151
v_exp_f32 v152, v152
v_exp_f32 v153, v153
v_exp_f32 v154, v154
v_exp_f32 v155, v155
s_nop 1
v_add_f32 v226, v226, v152
v_add_f32 v226, v226, v153
v_add_f32 v226, v226, v154
v_add_f32 v226, v226, v155
v_exp_f32 v156, v156
v_exp_f32 v157, v157
v_exp_f32 v158, v158
v_exp_f32 v159, v159
s_nop 1
v_add_f32 v227, v227, v156
v_add_f32 v227, v227, v157
v_add_f32 v227, v227, v158
v_add_f32 v227, v227, v159
s_branch L2_rare_common
L2_rare_site2:
s_mov_b32 s36, 2
s_branch L2_rare_1_0
L2_rare_1_0:
s_nop 15
s_nop 15
s_waitcnt lgkmcnt(0)
v_add_u32 v250, 0x0, v240
v_and_b32 v250, 0x1ffff, v250
ds_read_b128 v[232:235], v250 offset:0
s_waitcnt lgkmcnt(0)
v_mfma_f32_16x16x32_bf16 v[128:131], v[232:235], v[0:3], v[192:195]
v_mfma_f32_16x16x32_bf16 v[132:135], v[232:235], v[32:35], v[196:199]
v_mfma_f32_16x16x32_bf16 v[136:139], v[232:235], v[64:67], v[200:203]
v_mfma_f32_16x16x32_bf16 v[140:143], v[232:235], v[96:99], v[204:207]
s_nop 7
ds_read_b128 v[232:235], v250 offset:512
s_waitcnt lgkmcnt(0)
v_mfma_f32_16x16x32_bf16 v[128:131], v[232:235], v[4:7], v[128:131]
v_mfma_f32_16x16x32_bf16 v[132:135], v[232:235], v[36:39], v[132:135]
v_mfma_f32_16x16x32_bf16 v[136:139], v[232:235], v[68:71], v[136:139]
v_mfma_f32_16x16x32_bf16 v[140:143], v[232:235], v[100:103], v[140:143]
s_nop 7
ds_read_b128 v[232:235], v250 offset:4096
s_waitcnt lgkmcnt(0)
v_mfma_f32_16x16x32_bf16 v[128:131], v[232:235], v[8:11], v[128:131]
v_mfma_f32_16x16x32_bf16 v[132:135], v[232:235], v[40:43], v[132:135]
v_mfma_f32_16x16x32_bf16 v[136:139], v[232:235], v[72:75], v[136:139]
v_mfma_f32_16x16x32_bf16 v[140:143], v[232:235], v[104:107], v[140:143]
s_nop 7
ds_read_b128 v[232:235], v250 offset:4608
s_waitcnt lgkmcnt(0)
v_mfma_f32_16x16x32_bf16 v[128:131], v[232:235], v[12:15], v[128:131]
v_mfma_f32_16x16x32_bf16 v[132:135], v[232:235], v[44:47], v[132:135]
v_mfma_f32_16x16x32_bf16 v[136:139], v[232:235], v[76:79], v[136:139]
v_mfma_f32_16x16x32_bf16 v[140:143], v[232:235], v[108:111], v[140:143]
s_nop 7
ds_read_b128 v[232:235], v250 offset:8192
s_waitcnt lgkmcnt(0)
v_mfma_f32_16x16x32_bf16 v[128:131], v[232:235], v[16:19], v[128:131]
v_mfma_f32_16x16x32_bf16 v[132:135], v[232:235], v[48:51], v[132:135]
v_mfma_f32_16x16x32_bf16 v[136:139], v[232:235], v[80:83], v[136:139]
v_mfma_f32_16x16x32_bf16 v[140:143], v[232:235], v[112:115], v[140:143]
s_nop 7
ds_read_b128 v[232:235], v250 offset:8704
s_waitcnt lgkmcnt(0)
v_mfma_f32_16x16x32_bf16 v[128:131], v[232:235], v[20:23], v[128:131]
v_mfma_f32_16x16x32_bf16 v[132:135], v[232:235], v[52:55], v[132:135]
v_mfma_f32_16x16x32_bf16 v[136:139], v[232:235], v[84:87], v[136:139]
v_mfma_f32_16x16x32_bf16 v[140:143], v[232:235], v[116:119], v[140:143]
s_nop 7
ds_read_b128 v[232:235], v250 offset:12288
s_waitcnt lgkmcnt(0)
v_mfma_f32_16x16x32_bf16 v[128:131], v[232:235], v[24:27], v[128:131]
v_mfma_f32_16x16x32_bf16 v[132:135], v[232:235], v[56:59], v[132:135]
v_mfma_f32_16x16x32_bf16 v[136:139], v[232:235], v[88:91], v[136:139]
v_mfma_f32_16x16x32_bf16 v[140:143], v[232:235], v[120:123], v[140:143]
s_nop 7
ds_read_b128 v[232:235], v250 offset:12800
s_waitcnt lgkmcnt(0)
v_mfma_f32_16x16x32_bf16 v[128:131], v[232:235], v[28:31], v[128:131]
v_mfma_f32_16x16x32_bf16 v[132:135], v[232:235], v[60:63], v[132:135]
v_mfma_f32_16x16x32_bf16 v[136:139], v[232:235], v[92:95], v[136:139]
v_mfma_f32_16x16x32_bf16 v[140:143], v[232:235], v[124:127], v[140:143]
s_nop 7
s_nop 7
v_exp_f32 v248, v128
s_nop 0
v_sub_f32 v224, v224, v248
v_exp_f32 v248, v129
s_nop 0
v_sub_f32 v224, v224, v248
v_exp_f32 v248, v130
s_nop 0
v_sub_f32 v224, v224, v248
v_exp_f32 v248, v131
s_nop 0
v_sub_f32 v224, v224, v248
v_max_f32 v224, 0, v224
v_min_f32 v224, s32, v224
v_log_f32 v248, v224
v_max3_f32 v232, v128, v129, v130
v_max3_f32 v232, v232, v131, v248
v_mov_b32 v248, v232
s_nop 1
v_permlane32_swap_b32 v232, v248
s_nop 1
v_max_f32 v232, v232, v248
v_mov_b32 v248, v232
s_nop 1
v_permlane16_swap_b32 v232, v248
s_nop 1
v_max_f32 v232, v232, v248
v_ceil_f32 v232, v232
v_max_f32 v232, 0, v232
v_sub_f32 v248, 0, v232
v_exp_f32 v236, v248
s_nop 1
v_mul_f32 v224, v224, v236
v_sub_f32 v192, v192, v232
v_sub_f32 v128, v128, v232
v_sub_f32 v144, v144, v232
v_sub_f32 v193, v193, v232
v_sub_f32 v129, v129, v232
v_sub_f32 v145, v145, v232
v_sub_f32 v194, v194, v232
v_sub_f32 v130, v130, v232
v_sub_f32 v146, v146, v232
v_sub_f32 v195, v195, v232
v_sub_f32 v131, v131, v232
v_sub_f32 v147, v147, v232
v_lshlrev_b32 v242, 16, v176
v_and_b32 v248, 0xffff0000, v176
v_mul_f32 v242, v242, v236
v_mul_f32 v248, v248, v236
v_cvt_pk_bf16_f32 v176, v242, v248
v_lshlrev_b32 v242, 16, v177
v_and_b32 v248, 0xffff0000, v177
v_mul_f32 v242, v242, v236
v_mul_f32 v248, v248, v236
v_cvt_pk_bf16_f32 v177, v242, v248
v_lshlrev_b32 v242, 16, v178
v_and_b32 v248, 0xffff0000, v178
v_mul_f32 v242, v242, v236
v_mul_f32 v248, v248, v236
v_cvt_pk_bf16_f32 v178, v242, v248
v_lshlrev_b32 v242, 16, v179
v_and_b32 v248, 0xffff0000, v179
v_mul_f32 v242, v242, v236
v_mul_f32 v248, v248, v236
v_cvt_pk_bf16_f32 v179, v242, v248
v_lshlrev_b32 v242, 16, v160
v_and_b32 v248, 0xffff0000, v160
v_mul_f32 v242, v242, v236
v_mul_f32 v248, v248, v236
v_cvt_pk_bf16_f32 v160, v242, v248
v_lshlrev_b32 v242, 16, v161
v_and_b32 v248, 0xffff0000, v161
v_mul_f32 v242, v242, v236
v_mul_f32 v248, v248, v236
v_cvt_pk_bf16_f32 v161, v242, v248
v_lshlrev_b32 v242, 16, v162
v_and_b32 v248, 0xffff0000, v162
v_mul_f32 v242, v242, v236
v_mul_f32 v248, v248, v236
v_cvt_pk_bf16_f32 v162, v242, v248
v_lshlrev_b32 v242, 16, v163
v_and_b32 v248, 0xffff0000, v163
v_mul_f32 v242, v242, v236
v_mul_f32 v248, v248, v236
v_cvt_pk_bf16_f32 v163, v242, v248
v_exp_f32 v248, v132
s_nop 0
v_sub_f32 v225, v225, v248
v_exp_f32 v248, v133
s_nop 0
v_sub_f32 v225, v225, v248
v_exp_f32 v248, v134
s_nop 0
v_sub_f32 v225, v225, v248
v_exp_f32 v248, v135
s_nop 0
v_sub_f32 v225, v225, v248
v_max_f32 v225, 0, v225
v_min_f32 v225, s32, v225
v_log_f32 v248, v225
v_max3_f32 v233, v132, v133, v134
v_max3_f32 v233, v233, v135, v248
v_mov_b32 v248, v233
s_nop 1
v_permlane32_swap_b32 v233, v248
s_nop 1
v_max_f32 v233, v233, v248
v_mov_b32 v248, v233
s_nop 1
v_permlane16_swap_b32 v233, v248
s_nop 1
v_max_f32 v233, v233, v248
v_ceil_f32 v233, v233
v_max_f32 v233, 0, v233
v_sub_f32 v248, 0, v233
v_exp_f32 v237, v248
s_nop 1
v_mul_f32 v225, v225, v237
v_sub_f32 v196, v196, v233
v_sub_f32 v132, v132, v233
v_sub_f32 v148, v148, v233
v_sub_f32 v197, v197, v233
v_sub_f32 v133, v133, v233
v_sub_f32 v149, v149, v233
v_sub_f32 v198, v198, v233
v_sub_f32 v134, v134, v233
v_sub_f32 v150, v150, v233
v_sub_f32 v199, v199, v233
v_sub_f32 v135, v135, v233
v_sub_f32 v151, v151, v233
v_lshlrev_b32 v242, 16, v180
v_and_b32 v248, 0xffff0000, v180
v_mul_f32 v242, v242, v237
v_mul_f32 v248, v248, v237
v_cvt_pk_bf16_f32 v180, v242, v248
v_lshlrev_b32 v242, 16, v181
v_and_b32 v248, 0xffff0000, v181
v_mul_f32 v242, v242, v237
v_mul_f32 v248, v248, v237
v_cvt_pk_bf16_f32 v181, v242, v248
v_lshlrev_b32 v242, 16, v182
v_and_b32 v248, 0xffff0000, v182
v_mul_f32 v242, v242, v237
v_mul_f32 v248, v248, v237
v_cvt_pk_bf16_f32 v182, v242, v248
v_lshlrev_b32 v242, 16, v183
v_and_b32 v248, 0xffff0000, v183
v_mul_f32 v242, v242, v237
v_mul_f32 v248, v248, v237
v_cvt_pk_bf16_f32 v183, v242, v248
v_lshlrev_b32 v242, 16, v164
v_and_b32 v248, 0xffff0000, v164
v_mul_f32 v242, v242, v237
v_mul_f32 v248, v248, v237
v_cvt_pk_bf16_f32 v164, v242, v248
v_lshlrev_b32 v242, 16, v165
v_and_b32 v248, 0xffff0000, v165
v_mul_f32 v242, v242, v237
v_mul_f32 v248, v248, v237
v_cvt_pk_bf16_f32 v165, v242, v248
v_lshlrev_b32 v242, 16, v166
v_and_b32 v248, 0xffff0000, v166
v_mul_f32 v242, v242, v237
v_mul_f32 v248, v248, v237
v_cvt_pk_bf16_f32 v166, v242, v248
v_lshlrev_b32 v242, 16, v167
v_and_b32 v248, 0xffff0000, v167
v_mul_f32 v242, v242, v237
v_mul_f32 v248, v248, v237
v_cvt_pk_bf16_f32 v167, v242, v248
v_exp_f32 v248, v136
s_nop 0
v_sub_f32 v226, v226, v248
v_exp_f32 v248, v137
s_nop 0
v_sub_f32 v226, v226, v248
v_exp_f32 v248, v138
s_nop 0
v_sub_f32 v226, v226, v248
v_exp_f32 v248, v139
s_nop 0
v_sub_f32 v226, v226, v248
v_max_f32 v226, 0, v226
v_min_f32 v226, s32, v226
v_log_f32 v248, v226
v_max3_f32 v234, v136, v137, v138
v_max3_f32 v234, v234, v139, v248
v_mov_b32 v248, v234
s_nop 1
v_permlane32_swap_b32 v234, v248
s_nop 1
v_max_f32 v234, v234, v248
v_mov_b32 v248, v234
s_nop 1
v_permlane16_swap_b32 v234, v248
s_nop 1
v_max_f32 v234, v234, v248
v_ceil_f32 v234, v234
v_max_f32 v234, 0, v234
v_sub_f32 v248, 0, v234
v_exp_f32 v238, v248
s_nop 1
v_mul_f32 v226, v226, v238
v_sub_f32 v200, v200, v234
v_sub_f32 v136, v136, v234
v_sub_f32 v152, v152, v234
v_sub_f32 v201, v201, v234
v_sub_f32 v137, v137, v234
v_sub_f32 v153, v153, v234
v_sub_f32 v202, v202, v234
v_sub_f32 v138, v138, v234
v_sub_f32 v154, v154, v234
v_sub_f32 v203, v203, v234
v_sub_f32 v139, v139, v234
v_sub_f32 v155, v155, v234
v_lshlrev_b32 v242, 16, v184
v_and_b32 v248, 0xffff0000, v184
v_mul_f32 v242, v242, v238
v_mul_f32 v248, v248, v238
v_cvt_pk_bf16_f32 v184, v242, v248
v_lshlrev_b32 v242, 16, v185
v_and_b32 v248, 0xffff0000, v185
v_mul_f32 v242, v242, v238
v_mul_f32 v248, v248, v238
v_cvt_pk_bf16_f32 v185, v242, v248
v_lshlrev_b32 v242, 16, v186
v_and_b32 v248, 0xffff0000, v186
v_mul_f32 v242, v242, v238
v_mul_f32 v248, v248, v238
v_cvt_pk_bf16_f32 v186, v242, v248
v_lshlrev_b32 v242, 16, v187
v_and_b32 v248, 0xffff0000, v187
v_mul_f32 v242, v242, v238
v_mul_f32 v248, v248, v238
v_cvt_pk_bf16_f32 v187, v242, v248
v_lshlrev_b32 v242, 16, v168
v_and_b32 v248, 0xffff0000, v168
v_mul_f32 v242, v242, v238
v_mul_f32 v248, v248, v238
v_cvt_pk_bf16_f32 v168, v242, v248
v_lshlrev_b32 v242, 16, v169
v_and_b32 v248, 0xffff0000, v169
v_mul_f32 v242, v242, v238
v_mul_f32 v248, v248, v238
v_cvt_pk_bf16_f32 v169, v242, v248
v_lshlrev_b32 v242, 16, v170
v_and_b32 v248, 0xffff0000, v170
v_mul_f32 v242, v242, v238
v_mul_f32 v248, v248, v238
v_cvt_pk_bf16_f32 v170, v242, v248
v_lshlrev_b32 v242, 16, v171
v_and_b32 v248, 0xffff0000, v171
v_mul_f32 v242, v242, v238
v_mul_f32 v248, v248, v238
v_cvt_pk_bf16_f32 v171, v242, v248
v_exp_f32 v248, v140
s_nop 0
v_sub_f32 v227, v227, v248
v_exp_f32 v248, v141
s_nop 0
v_sub_f32 v227, v227, v248
v_exp_f32 v248, v142
s_nop 0
v_sub_f32 v227, v227, v248
v_exp_f32 v248, v143
s_nop 0
v_sub_f32 v227, v227, v248
v_max_f32 v227, 0, v227
v_min_f32 v227, s32, v227
v_log_f32 v248, v227
v_max3_f32 v235, v140, v141, v142
v_max3_f32 v235, v235, v143, v248
v_mov_b32 v248, v235
s_nop 1
v_permlane32_swap_b32 v235, v248
s_nop 1
v_max_f32 v235, v235, v248
v_mov_b32 v248, v235
s_nop 1
v_permlane16_swap_b32 v235, v248
s_nop 1
v_max_f32 v235, v235, v248
v_ceil_f32 v235, v235
v_max_f32 v235, 0, v235
v_sub_f32 v248, 0, v235
v_exp_f32 v239, v248
s_nop 1
v_mul_f32 v227, v227, v239
v_sub_f32 v204, v204, v235
v_sub_f32 v140, v140, v235
v_sub_f32 v156, v156, v235
v_sub_f32 v205, v205, v235
v_sub_f32 v141, v141, v235
v_sub_f32 v157, v157, v235
v_sub_f32 v206, v206, v235
v_sub_f32 v142, v142, v235
v_sub_f32 v158, v158, v235
v_sub_f32 v207, v207, v235
v_sub_f32 v143, v143, v235
v_sub_f32 v159, v159, v235
v_lshlrev_b32 v242, 16, v188
v_and_b32 v248, 0xffff0000, v188
v_mul_f32 v242, v242, v239
v_mul_f32 v248, v248, v239
v_cvt_pk_bf16_f32 v188, v242, v248
v_lshlrev_b32 v242, 16, v189
v_and_b32 v248, 0xffff0000, v189
v_mul_f32 v242, v242, v239
v_mul_f32 v248, v248, v239
v_cvt_pk_bf16_f32 v189, v242, v248
v_lshlrev_b32 v242, 16, v190
v_and_b32 v248, 0xffff0000, v190
v_mul_f32 v242, v242, v239
v_mul_f32 v248, v248, v239
v_cvt_pk_bf16_f32 v190, v242, v248
v_lshlrev_b32 v242, 16, v191
v_and_b32 v248, 0xffff0000, v191
v_mul_f32 v242, v242, v239
v_mul_f32 v248, v248, v239
v_cvt_pk_bf16_f32 v191, v242, v248
v_lshlrev_b32 v242, 16, v172
v_and_b32 v248, 0xffff0000, v172
v_mul_f32 v242, v242, v239
v_mul_f32 v248, v248, v239
v_cvt_pk_bf16_f32 v172, v242, v248
v_lshlrev_b32 v242, 16, v173
v_and_b32 v248, 0xffff0000, v173
v_mul_f32 v242, v242, v239
v_mul_f32 v248, v248, v239
v_cvt_pk_bf16_f32 v173, v242, v248
v_lshlrev_b32 v242, 16, v174
v_and_b32 v248, 0xffff0000, v174
v_mul_f32 v242, v242, v239
v_mul_f32 v248, v248, v239
v_cvt_pk_bf16_f32 v174, v242, v248
v_lshlrev_b32 v242, 16, v175
v_and_b32 v248, 0xffff0000, v175
v_mul_f32 v242, v242, v239
v_mul_f32 v248, v248, v239
v_cvt_pk_bf16_f32 v175, v242, v248
v_exp_f32 v128, v128
v_exp_f32 v129, v129
v_exp_f32 v130, v130
v_exp_f32 v131, v131
s_nop 1
v_add_f32 v224, v224, v128
v_add_f32 v224, v224, v129
v_add_f32 v224, v224, v130
v_add_f32 v224, v224, v131
v_exp_f32 v132, v132
v_exp_f32 v133, v133
v_exp_f32 v134, v134
v_exp_f32 v135, v135
s_nop 1
v_add_f32 v225, v225, v132
v_add_f32 v225, v225, v133
v_add_f32 v225, v225, v134
v_add_f32 v225, v225, v135
v_exp_f32 v136, v136
v_exp_f32 v137, v137
v_exp_f32 v138, v138
v_exp_f32 v139, v139
s_nop 1
v_add_f32 v226, v226, v136
v_add_f32 v226, v226, v137
v_add_f32 v226, v226, v138
v_add_f32 v226, v226, v139
v_exp_f32 v140, v140
v_exp_f32 v141, v141
v_exp_f32 v142, v142
v_exp_f32 v143, v143
s_nop 1
v_add_f32 v227, v227, v140
v_add_f32 v227, v227, v141
v_add_f32 v227, v227, v142
v_add_f32 v227, v227, v143
s_branch L2_rare_common
L2_rare_site3:
s_mov_b32 s36, 3
s_branch L2_rare_1_1
L2_rare_1_1:
s_nop 15
s_nop 15
s_waitcnt lgkmcnt(0)
v_add_u32 v250, 0x0, v240
v_and_b32 v250, 0x1ffff, v250
ds_read_b128 v[232:235], v250 offset:2048
s_waitcnt lgkmcnt(0)
v_mfma_f32_16x16x32_bf16 v[144:147], v[232:235], v[0:3], v[192:195]
v_mfma_f32_16x16x32_bf16 v[148:151], v[232:235], v[32:35], v[196:199]
v_mfma_f32_16x16x32_bf16 v[152:155], v[232:235], v[64:67], v[200:203]
v_mfma_f32_16x16x32_bf16 v[156:159], v[232:235], v[96:99], v[204:207]
s_nop 7
ds_read_b128 v[232:235], v250 offset:2560
s_waitcnt lgkmcnt(0)
v_mfma_f32_16x16x32_bf16 v[144:147], v[232:235], v[4:7], v[144:147]
v_mfma_f32_16x16x32_bf16 v[148:151], v[232:235], v[36:39], v[148:151]
v_mfma_f32_16x16x32_bf16 v[152:155], v[232:235], v[68:71], v[152:155]
v_mfma_f32_16x16x32_bf16 v[156:159], v[232:235], v[100:103], v[156:159]
s_nop 7
ds_read_b128 v[232:235], v250 offset:6144
s_waitcnt lgkmcnt(0)
v_mfma_f32_16x16x32_bf16 v[144:147], v[232:235], v[8:11], v[144:147]
v_mfma_f32_16x16x32_bf16 v[148:151], v[232:235], v[40:43], v[148:151]
v_mfma_f32_16x16x32_bf16 v[152:155], v[232:235], v[72:75], v[152:155]
v_mfma_f32_16x16x32_bf16 v[156:159], v[232:235], v[104:107], v[156:159]
s_nop 7
ds_read_b128 v[232:235], v250 offset:6656
s_waitcnt lgkmcnt(0)
v_mfma_f32_16x16x32_bf16 v[144:147], v[232:235], v[12:15], v[144:147]
v_mfma_f32_16x16x32_bf16 v[148:151], v[232:235], v[44:47], v[148:151]
v_mfma_f32_16x16x32_bf16 v[152:155], v[232:235], v[76:79], v[152:155]
v_mfma_f32_16x16x32_bf16 v[156:159], v[232:235], v[108:111], v[156:159]
s_nop 7
ds_read_b128 v[232:235], v250 offset:10240
s_waitcnt lgkmcnt(0)
v_mfma_f32_16x16x32_bf16 v[144:147], v[232:235], v[16:19], v[144:147]
v_mfma_f32_16x16x32_bf16 v[148:151], v[232:235], v[48:51], v[148:151]
v_mfma_f32_16x16x32_bf16 v[152:155], v[232:235], v[80:83], v[152:155]
v_mfma_f32_16x16x32_bf16 v[156:159], v[232:235], v[112:115], v[156:159]
s_nop 7
ds_read_b128 v[232:235], v250 offset:10752
s_waitcnt lgkmcnt(0)
v_mfma_f32_16x16x32_bf16 v[144:147], v[232:235], v[20:23], v[144:147]
v_mfma_f32_16x16x32_bf16 v[148:151], v[232:235], v[52:55], v[148:151]
v_mfma_f32_16x16x32_bf16 v[152:155], v[232:235], v[84:87], v[152:155]
v_mfma_f32_16x16x32_bf16 v[156:159], v[232:235], v[116:119], v[156:159]
s_nop 7
ds_read_b128 v[232:235], v250 offset:14336
s_waitcnt lgkmcnt(0)
v_mfma_f32_16x16x32_bf16 v[144:147], v[232:235], v[24:27], v[144:147]
v_mfma_f32_16x16x32_bf16 v[148:151], v[232:235], v[56:59], v[148:151]
v_mfma_f32_16x16x32_bf16 v[152:155], v[232:235], v[88:91], v[152:155]
v_mfma_f32_16x16x32_bf16 v[156:159], v[232:235], v[120:123], v[156:159]
s_nop 7
ds_read_b128 v[232:235], v250 offset:14848
s_waitcnt lgkmcnt(0)
v_mfma_f32_16x16x32_bf16 v[144:147], v[232:235], v[28:31], v[144:147]
v_mfma_f32_16x16x32_bf16 v[148:151], v[232:235], v[60:63], v[148:151]
v_mfma_f32_16x16x32_bf16 v[152:155], v[232:235], v[92:95], v[152:155]
v_mfma_f32_16x16x32_bf16 v[156:159], v[232:235], v[124:127], v[156:159]
s_nop 7
s_nop 7
v_exp_f32 v248, v144
s_nop 0
v_sub_f32 v224, v224, v248
v_exp_f32 v248, v145
s_nop 0
v_sub_f32 v224, v224, v248
v_exp_f32 v248, v146
s_nop 0
v_sub_f32 v224, v224, v248
v_exp_f32 v248, v147
s_nop 0
v_sub_f32 v224, v224, v248
v_max_f32 v224, 0, v224
v_min_f32 v224, s32, v224
v_log_f32 v248, v224
v_max3_f32 v232, v144, v145, v146
v_max3_f32 v232, v232, v147, v248
v_mov_b32 v248, v232
s_nop 1
v_permlane32_swap_b32 v232, v248
s_nop 1
v_max_f32 v232, v232, v248
v_mov_b32 v248, v232
s_nop 1
v_permlane16_swap_b32 v232, v248
s_nop 1
v_max_f32 v232, v232, v248
v_ceil_f32 v232, v232
v_max_f32 v232, 0, v232
v_sub_f32 v248, 0, v232
v_exp_f32 v236, v248
s_nop 1
v_mul_f32 v224, v224, v236
v_sub_f32 v192, v192, v232
v_sub_f32 v128, v128, v232
v_sub_f32 v144, v144, v232
v_sub_f32 v193, v193, v232
v_sub_f32 v129, v129, v232
v_sub_f32 v145, v145, v232
v_sub_f32 v194, v194, v232
v_sub_f32 v130, v130, v232
v_sub_f32 v146, v146, v232
v_sub_f32 v195, v195, v232
v_sub_f32 v131, v131, v232
v_sub_f32 v147, v147, v232
v_lshlrev_b32 v242, 16, v176
v_and_b32 v248, 0xffff0000, v176
v_mul_f32 v242, v242, v236
v_mul_f32 v248, v248, v236
v_cvt_pk_bf16_f32 v176, v242, v248
v_lshlrev_b32 v242, 16, v177
v_and_b32 v248, 0xffff0000, v177
v_mul_f32 v242, v242, v236
v_mul_f32 v248, v248, v236
v_cvt_pk_bf16_f32 v177, v242, v248
v_lshlrev_b32 v242, 16, v178
v_and_b32 v248, 0xffff0000, v178
v_mul_f32 v242, v242, v236
v_mul_f32 v248, v248, v236
v_cvt_pk_bf16_f32 v178, v242, v248
v_lshlrev_b32 v242, 16, v179
v_and_b32 v248, 0xffff0000, v179
v_mul_f32 v242, v242, v236
v_mul_f32 v248, v248, v236
v_cvt_pk_bf16_f32 v179, v242, v248
v_lshlrev_b32 v242, 16, v160
v_and_b32 v248, 0xffff0000, v160
v_mul_f32 v242, v242, v236
v_mul_f32 v248, v248, v236
v_cvt_pk_bf16_f32 v160, v242, v248
v_lshlrev_b32 v242, 16, v161
v_and_b32 v248, 0xffff0000, v161
v_mul_f32 v242, v242, v236
v_mul_f32 v248, v248, v236
v_cvt_pk_bf16_f32 v161, v242, v248
v_exp_f32 v248, v148
s_nop 0
v_sub_f32 v225, v225, v248
v_exp_f32 v248, v149
s_nop 0
v_sub_f32 v225, v225, v248
v_exp_f32 v248, v150
s_nop 0
v_sub_f32 v225, v225, v248
v_exp_f32 v248, v151
s_nop 0
v_sub_f32 v225, v225, v248
v_max_f32 v225, 0, v225
v_min_f32 v225, s32, v225
v_log_f32 v248, v225
v_max3_f32 v233, v148, v149, v150
v_max3_f32 v233, v233, v151, v248
v_mov_b32 v248, v233
s_nop 1
v_permlane32_swap_b32 v233, v248
s_nop 1
v_max_f32 v233, v233, v248
v_mov_b32 v248, v233
s_nop 1
v_permlane16_swap_b32 v233, v248
s_nop 1
v_max_f32 v233, v233, v248
v_ceil_f32 v233, v233
v_max_f32 v233, 0, v233
v_sub_f32 v248, 0, v233
v_exp_f32 v237, v248
s_nop 1
v_mul_f32 v225, v225, v237
v_sub_f32 v196, v196, v233
v_sub_f32 v132, v132, v233
v_sub_f32 v148, v148, v233
v_sub_f32 v197, v197, v233
v_sub_f32 v133, v133, v233
v_sub_f32 v149, v149, v233
v_sub_f32 v198, v198, v233
v_sub_f32 v134, v134, v233
v_sub_f32 v150, v150, v233
v_sub_f32 v199, v199, v233
v_sub_f32 v135, v135, v233
v_sub_f32 v151, v151, v233
v_lshlrev_b32 v242, 16, v180
v_and_b32 v248, 0xffff0000, v180
v_mul_f32 v242, v242, v237
v_mul_f32 v248, v248, v237
v_cvt_pk_bf16_f32 v180, v242, v248
v_lshlrev_b32 v242, 16, v181
v_and_b32 v248, 0xffff0000, v181
v_mul_f32 v242, v242, v237
v_mul_f32 v248, v248, v237
v_cvt_pk_bf16_f32 v181, v242, v248
v_lshlrev_b32 v242, 16, v182
v_and_b32 v248, 0xffff0000, v182
v_mul_f32 v242, v242, v237
v_mul_f32 v248, v248, v237
v_cvt_pk_bf16_f32 v182, v242, v248
v_lshlrev_b32 v242, 16, v183
v_and_b32 v248, 0xffff0000, v183
v_mul_f32 v242, v242, v237
v_mul_f32 v248, v248, v237
v_cvt_pk_bf16_f32 v183, v242, v248
v_lshlrev_b32 v242, 16, v164
v_and_b32 v248, 0xffff0000, v164
v_mul_f32 v242, v242, v237
v_mul_f32 v248, v248, v237
v_cvt_pk_bf16_f32 v164, v242, v248
v_lshlrev_b32 v242, 16, v165
v_and_b32 v248, 0xffff0000, v165
v_mul_f32 v242, v242, v237
v_mul_f32 v248, v248, v237
v_cvt_pk_bf16_f32 v165, v242, v248
v_exp_f32 v248, v152
s_nop 0
v_sub_f32 v226, v226, v248
v_exp_f32 v248, v153
s_nop 0
v_sub_f32 v226, v226, v248
v_exp_f32 v248, v154
s_nop 0
v_sub_f32 v226, v226, v248
v_exp_f32 v248, v155
s_nop 0
v_sub_f32 v226, v226, v248
v_max_f32 v226, 0, v226
v_min_f32 v226, s32, v226
v_log_f32 v248, v226
v_max3_f32 v234, v152, v153, v154
v_max3_f32 v234, v234, v155, v248
v_mov_b32 v248, v234
s_nop 1
v_permlane32_swap_b32 v234, v248
s_nop 1
v_max_f32 v234, v234, v248
v_mov_b32 v248, v234
s_nop 1
v_permlane16_swap_b32 v234, v248
s_nop 1
v_max_f32 v234, v234, v248
v_ceil_f32 v234, v234
v_max_f32 v234, 0, v234
v_sub_f32 v248, 0, v234
v_exp_f32 v238, v248
s_nop 1
v_mul_f32 v226, v226, v238
v_sub_f32 v200, v200, v234
v_sub_f32 v136, v136, v234
v_sub_f32 v152, v152, v234
v_sub_f32 v201, v201, v234
v_sub_f32 v137, v137, v234
v_sub_f32 v153, v153, v234
v_sub_f32 v202, v202, v234
v_sub_f32 v138, v138, v234
v_sub_f32 v154, v154, v234
v_sub_f32 v203, v203, v234
v_sub_f32 v139, v139, v234
v_sub_f32 v155, v155, v234
v_lshlrev_b32 v242, 16, v184
v_and_b32 v248, 0xffff0000, v184
v_mul_f32 v242, v242, v238
v_mul_f32 v248, v248, v238
v_cvt_pk_bf16_f32 v184, v242, v248
v_lshlrev_b32 v242, 16, v185
v_and_b32 v248, 0xffff0000, v185
v_mul_f32 v242, v242, v238
v_mul_f32 v248, v248, v238
v_cvt_pk_bf16_f32 v185, v242, v248
v_lshlrev_b32 v242, 16, v186
v_and_b32 v248, 0xffff0000, v186
v_mul_f32 v242, v242, v238
v_mul_f32 v248, v248, v238
v_cvt_pk_bf16_f32 v186, v242, v248
v_lshlrev_b32 v242, 16, v187
v_and_b32 v248, 0xffff0000, v187
v_mul_f32 v242, v242, v238
v_mul_f32 v248, v248, v238
v_cvt_pk_bf16_f32 v187, v242, v248
v_lshlrev_b32 v242, 16, v168
v_and_b32 v248, 0xffff0000, v168
v_mul_f32 v242, v242, v238
v_mul_f32 v248, v248, v238
v_cvt_pk_bf16_f32 v168, v242, v248
v_lshlrev_b32 v242, 16, v169
v_and_b32 v248, 0xffff0000, v169
v_mul_f32 v242, v242, v238
v_mul_f32 v248, v248, v238
v_cvt_pk_bf16_f32 v169, v242, v248
v_exp_f32 v248, v156
s_nop 0
v_sub_f32 v227, v227, v248
v_exp_f32 v248, v157
s_nop 0
v_sub_f32 v227, v227, v248
v_exp_f32 v248, v158
s_nop 0
v_sub_f32 v227, v227, v248
v_exp_f32 v248, v159
s_nop 0
v_sub_f32 v227, v227, v248
v_max_f32 v227, 0, v227
v_min_f32 v227, s32, v227
v_log_f32 v248, v227
v_max3_f32 v235, v156, v157, v158
v_max3_f32 v235, v235, v159, v248
v_mov_b32 v248, v235
s_nop 1
v_permlane32_swap_b32 v235, v248
s_nop 1
v_max_f32 v235, v235, v248
v_mov_b32 v248, v235
s_nop 1
v_permlane16_swap_b32 v235, v248
s_nop 1
v_max_f32 v235, v235, v248
v_ceil_f32 v235, v235
v_max_f32 v235, 0, v235
v_sub_f32 v248, 0, v235
v_exp_f32 v239, v248
s_nop 1
v_mul_f32 v227, v227, v239
v_sub_f32 v204, v204, v235
v_sub_f32 v140, v140, v235
v_sub_f32 v156, v156, v235
v_sub_f32 v205, v205, v235
v_sub_f32 v141, v141, v235
v_sub_f32 v157, v157, v235
v_sub_f32 v206, v206, v235
v_sub_f32 v142, v142, v235
v_sub_f32 v158, v158, v235
v_sub_f32 v207, v207, v235
v_sub_f32 v143, v143, v235
v_sub_f32 v159, v159, v235
v_lshlrev_b32 v242, 16, v188
v_and_b32 v248, 0xffff0000, v188
v_mul_f32 v242, v242, v239
v_mul_f32 v248, v248, v239
v_cvt_pk_bf16_f32 v188, v242, v248
v_lshlrev_b32 v242, 16, v189
v_and_b32 v248, 0xffff0000, v189
v_mul_f32 v242, v242, v239
v_mul_f32 v248, v248, v239
v_cvt_pk_bf16_f32 v189, v242, v248
v_lshlrev_b32 v242, 16, v190
v_and_b32 v248, 0xffff0000, v190
v_mul_f32 v242, v242, v239
v_mul_f32 v248, v248, v239
v_cvt_pk_bf16_f32 v190, v242, v248
v_lshlrev_b32 v242, 16, v191
v_and_b32 v248, 0xffff0000, v191
v_mul_f32 v242, v242, v239
v_mul_f32 v248, v248, v239
v_cvt_pk_bf16_f32 v191, v242, v248
v_lshlrev_b32 v242, 16, v172
v_and_b32 v248, 0xffff0000, v172
v_mul_f32 v242, v242, v239
v_mul_f32 v248, v248, v239
v_cvt_pk_bf16_f32 v172, v242, v248
v_lshlrev_b32 v242, 16, v173
v_and_b32 v248, 0xffff0000, v173
v_mul_f32 v242, v242, v239
v_mul_f32 v248, v248, v239
v_cvt_pk_bf16_f32 v173, v242, v248
v_exp_f32 v144, v144
v_exp_f32 v145, v145
v_exp_f32 v146, v146
v_exp_f32 v147, v147
s_nop 1
v_add_f32 v224, v224, v144
v_add_f32 v224, v224, v145
v_add_f32 v224, v224, v146
v_add_f32 v224, v224, v147
v_exp_f32 v148, v148
v_exp_f32 v149, v149
v_exp_f32 v150, v150
v_exp_f32 v151, v151
s_nop 1
v_add_f32 v225, v225, v148
v_add_f32 v225, v225, v149
v_add_f32 v225, v225, v150
v_add_f32 v225, v225, v151
v_exp_f32 v152, v152
v_exp_f32 v153, v153
v_exp_f32 v154, v154
v_exp_f32 v155, v155
s_nop 1
v_add_f32 v226, v226, v152
v_add_f32 v226, v226, v153
v_add_f32 v226, v226, v154
v_add_f32 v226, v226, v155
v_exp_f32 v156, v156
v_exp_f32 v157, v157
v_exp_f32 v158, v158
v_exp_f32 v159, v159
s_nop 1
v_add_f32 v227, v227, v156
v_add_f32 v227, v227, v157
v_add_f32 v227, v227, v158
v_add_f32 v227, v227, v159
s_branch L2_rare_common
L2_rare_site6:
s_mov_b32 s36, 6
s_branch L2_rare_t1_0_0
L2_rare_t1_0_0:
s_nop 15
s_nop 15
s_waitcnt lgkmcnt(0)
v_exp_f32 v248, v128
s_nop 0
v_sub_f32 v224, v224, v248
v_exp_f32 v248, v129
s_nop 0
v_sub_f32 v224, v224, v248
v_exp_f32 v248, v130
s_nop 0
v_sub_f32 v224, v224, v248
v_exp_f32 v248, v131
s_nop 0
v_sub_f32 v224, v224, v248
v_max_f32 v224, 0, v224
v_min_f32 v224, s32, v224
v_log_f32 v248, v224
v_max3_f32 v232, v128, v129, v130
v_max3_f32 v232, v232, v131, v248
v_mov_b32 v248, v232
s_nop 1
v_permlane32_swap_b32 v232, v248
s_nop 1
v_max_f32 v232, v232, v248
v_mov_b32 v248, v232
s_nop 1
v_permlane16_swap_b32 v232, v248
s_nop 1
v_max_f32 v232, v232, v248
v_ceil_f32 v232, v232
v_max_f32 v232, 0, v232
v_sub_f32 v248, 0, v232
v_exp_f32 v236, v248
s_nop 1
v_mul_f32 v224, v224, v236
v_sub_f32 v192, v192, v232
v_sub_f32 v128, v128, v232
v_sub_f32 v144, v144, v232
v_sub_f32 v193, v193, v232
v_sub_f32 v129, v129, v232
v_sub_f32 v145, v145, v232
v_sub_f32 v194, v194, v232
v_sub_f32 v130, v130, v232
v_sub_f32 v146, v146, v232
v_sub_f32 v195, v195, v232
v_sub_f32 v131, v131, v232
v_sub_f32 v147, v147, v232
v_lshlrev_b32 v242, 16, v160
v_and_b32 v248, 0xffff0000, v160
v_mul_f32 v242, v242, v236
v_mul_f32 v248, v248, v236
v_cvt_pk_bf16_f32 v160, v242, v248
v_lshlrev_b32 v242, 16, v161
v_and_b32 v248, 0xffff0000, v161
v_mul_f32 v242, v242, v236
v_mul_f32 v248, v248, v236
v_cvt_pk_bf16_f32 v161, v242, v248
v_lshlrev_b32 v242, 16, v162
v_and_b32 v248, 0xffff0000, v162
v_mul_f32 v242, v242, v236
v_mul_f32 v248, v248, v236
v_cvt_pk_bf16_f32 v162, v242, v248
v_lshlrev_b32 v242, 16, v163
v_and_b32 v248, 0xffff0000, v163
v_mul_f32 v242, v242, v236
v_mul_f32 v248, v248, v236
v_cvt_pk_bf16_f32 v163, v242, v248
ds_read_b64 v[250:251], v231 offset:0
s_waitcnt lgkmcnt(0)
v_lshlrev_b32 v242, 16, v250
v_and_b32 v248, 0xffff0000, v250
v_mul_f32 v242, v242, v236
v_mul_f32 v248, v248, v236
v_cvt_pk_bf16_f32 v250, v242, v248
v_lshlrev_b32 v242, 16, v251
v_and_b32 v248, 0xffff0000, v251
v_mul_f32 v242, v242, v236
v_mul_f32 v248, v248, v236
v_cvt_pk_bf16_f32 v251, v242, v248
ds_write_b64 v231, v[250:251] offset:0
s_waitcnt lgkmcnt(0)
ds_read_b64 v[250:251], v231 offset:8
s_waitcnt lgkmcnt(0)
v_lshlrev_b32 v242, 16, v250
v_and_b32 v248, 0xffff0000, v250
v_mul_f32 v242, v242, v236
v_mul_f32 v248, v248, v236
v_cvt_pk_bf16_f32 v250, v242, v248
v_lshlrev_b32 v242, 16, v251
v_and_b32 v248, 0xffff0000, v251
v_mul_f32 v242, v242, v236
v_mul_f32 v248, v248, v236
v_cvt_pk_bf16_f32 v251, v242, v248
ds_write_b64 v231, v[250:251] offset:8
s_waitcnt lgkmcnt(0)
v_exp_f32 v248, v132
s_nop 0
v_sub_f32 v225, v225, v248
v_exp_f32 v248, v133
s_nop 0
v_sub_f32 v225, v225, v248
v_exp_f32 v248, v134
s_nop 0
v_sub_f32 v225, v225, v248
v_exp_f32 v248, v135
s_nop 0
v_sub_f32 v225, v225, v248
v_max_f32 v225, 0, v225
v_min_f32 v225, s32, v225
v_log_f32 v248, v225
v_max3_f32 v233, v132, v133, v134
v_max3_f32 v233, v233, v135, v248
v_mov_b32 v248, v233
s_nop 1
v_permlane32_swap_b32 v233, v248
s_nop 1
v_max_f32 v233, v233, v248
v_mov_b32 v248, v233
s_nop 1
v_permlane16_swap_b32 v233, v248
s_nop 1
v_max_f32 v233, v233, v248
v_ceil_f32 v233, v233
v_max_f32 v233, 0, v233
v_sub_f32 v248, 0, v233
v_exp_f32 v237, v248
s_nop 1
v_mul_f32 v225, v225, v237
v_sub_f32 v196, v196, v233
v_sub_f32 v132, v132, v233
v_sub_f32 v148, v148, v233
v_sub_f32 v197, v197, v233
v_sub_f32 v133, v133, v233
v_sub_f32 v149, v149, v233
v_sub_f32 v198, v198, v233
v_sub_f32 v134, v134, v233
v_sub_f32 v150, v150, v233
v_sub_f32 v199, v199, v233
v_sub_f32 v135, v135, v233
v_sub_f32 v151, v151, v233
v_lshlrev_b32 v242, 16, v164
v_and_b32 v248, 0xffff0000, v164
v_mul_f32 v242, v242, v237
v_mul_f32 v248, v248, v237
v_cvt_pk_bf16_f32 v164, v242, v248
v_lshlrev_b32 v242, 16, v165
v_and_b32 v248, 0xffff0000, v165
v_mul_f32 v242, v242, v237
v_mul_f32 v248, v248, v237
v_cvt_pk_bf16_f32 v165, v242, v248
v_lshlrev_b32 v242, 16, v166
v_and_b32 v248, 0xffff0000, v166
v_mul_f32 v242, v242, v237
v_mul_f32 v248, v248, v237
v_cvt_pk_bf16_f32 v166, v242, v248
v_lshlrev_b32 v242, 16, v167
v_and_b32 v248, 0xffff0000, v167
v_mul_f32 v242, v242, v237
v_mul_f32 v248, v248, v237
v_cvt_pk_bf16_f32 v167, v242, v248
ds_read_b64 v[250:251], v231 offset:1024
s_waitcnt lgkmcnt(0)
v_lshlrev_b32 v242, 16, v250
v_and_b32 v248, 0xffff0000, v250
v_mul_f32 v242, v242, v237
v_mul_f32 v248, v248, v237
v_cvt_pk_bf16_f32 v250, v242, v248
v_lshlrev_b32 v242, 16, v251
v_and_b32 v248, 0xffff0000, v251
v_mul_f32 v242, v242, v237
v_mul_f32 v248, v248, v237
v_cvt_pk_bf16_f32 v251, v242, v248
ds_write_b64 v231, v[250:251] offset:1024
s_waitcnt lgkmcnt(0)
ds_read_b64 v[250:251], v231 offset:1032
s_waitcnt lgkmcnt(0)
v_lshlrev_b32 v242, 16, v250
v_and_b32 v248, 0xffff0000, v250
v_mul_f32 v242, v242, v237
v_mul_f32 v248, v248, v237
v_cvt_pk_bf16_f32 v250, v242, v248
v_lshlrev_b32 v242, 16, v251
v_and_b32 v248, 0xffff0000, v251
v_mul_f32 v242, v242, v237
v_mul_f32 v248, v248, v237
v_cvt_pk_bf16_f32 v251, v242, v248
ds_write_b64 v231, v[250:251] offset:1032
s_waitcnt lgkmcnt(0)
v_exp_f32 v248, v136
s_nop 0
v_sub_f32 v226, v226, v248
v_exp_f32 v248, v137
s_nop 0
v_sub_f32 v226, v226, v248
v_exp_f32 v248, v138
s_nop 0
v_sub_f32 v226, v226, v248
v_exp_f32 v248, v139
s_nop 0
v_sub_f32 v226, v226, v248
v_max_f32 v226, 0, v226
v_min_f32 v226, s32, v226
v_log_f32 v248, v226
v_max3_f32 v234, v136, v137, v138
v_max3_f32 v234, v234, v139, v248
v_mov_b32 v248, v234
s_nop 1
v_permlane32_swap_b32 v234, v248
s_nop 1
v_max_f32 v234, v234, v248
v_mov_b32 v248, v234
s_nop 1
v_permlane16_swap_b32 v234, v248
s_nop 1
v_max_f32 v234, v234, v248
v_ceil_f32 v234, v234
v_max_f32 v234, 0, v234
v_sub_f32 v248, 0, v234
v_exp_f32 v238, v248
s_nop 1
v_mul_f32 v226, v226, v238
v_sub_f32 v200, v200, v234
v_sub_f32 v136, v136, v234
v_sub_f32 v152, v152, v234
v_sub_f32 v201, v201, v234
v_sub_f32 v137, v137, v234
v_sub_f32 v153, v153, v234
v_sub_f32 v202, v202, v234
v_sub_f32 v138, v138, v234
v_sub_f32 v154, v154, v234
v_sub_f32 v203, v203, v234
v_sub_f32 v139, v139, v234
v_sub_f32 v155, v155, v234
v_lshlrev_b32 v242, 16, v168
v_and_b32 v248, 0xffff0000, v168
v_mul_f32 v242, v242, v238
v_mul_f32 v248, v248, v238
v_cvt_pk_bf16_f32 v168, v242, v248
v_lshlrev_b32 v242, 16, v169
v_and_b32 v248, 0xffff0000, v169
v_mul_f32 v242, v242, v238
v_mul_f32 v248, v248, v238
v_cvt_pk_bf16_f32 v169, v242, v248
v_lshlrev_b32 v242, 16, v170
v_and_b32 v248, 0xffff0000, v170
v_mul_f32 v242, v242, v238
v_mul_f32 v248, v248, v238
v_cvt_pk_bf16_f32 v170, v242, v248
v_lshlrev_b32 v242, 16, v171
v_and_b32 v248, 0xffff0000, v171
v_mul_f32 v242, v242, v238
v_mul_f32 v248, v248, v238
v_cvt_pk_bf16_f32 v171, v242, v248
ds_read_b64 v[250:251], v231 offset:2048
s_waitcnt lgkmcnt(0)
v_lshlrev_b32 v242, 16, v250
v_and_b32 v248, 0xffff0000, v250
v_mul_f32 v242, v242, v238
v_mul_f32 v248, v248, v238
v_cvt_pk_bf16_f32 v250, v242, v248
v_lshlrev_b32 v242, 16, v251
v_and_b32 v248, 0xffff0000, v251
v_mul_f32 v242, v242, v238
v_mul_f32 v248, v248, v238
v_cvt_pk_bf16_f32 v251, v242, v248
ds_write_b64 v231, v[250:251] offset:2048
s_waitcnt lgkmcnt(0)
ds_read_b64 v[250:251], v231 offset:2056
s_waitcnt lgkmcnt(0)
v_lshlrev_b32 v242, 16, v250
v_and_b32 v248, 0xffff0000, v250
v_mul_f32 v242, v242, v238
v_mul_f32 v248, v248, v238
v_cvt_pk_bf16_f32 v250, v242, v248
v_lshlrev_b32 v242, 16, v251
v_and_b32 v248, 0xffff0000, v251
v_mul_f32 v242, v242, v238
v_mul_f32 v248, v248, v238
v_cvt_pk_bf16_f32 v251, v242, v248
ds_write_b64 v231, v[250:251] offset:2056
s_waitcnt lgkmcnt(0)
v_exp_f32 v248, v140
s_nop 0
v_sub_f32 v227, v227, v248
v_exp_f32 v248, v141
s_nop 0
v_sub_f32 v227, v227, v248
v_exp_f32 v248, v142
s_nop 0
v_sub_f32 v227, v227, v248
v_exp_f32 v248, v143
s_nop 0
v_sub_f32 v227, v227, v248
v_max_f32 v227, 0, v227
v_min_f32 v227, s32, v227
v_log_f32 v248, v227
v_max3_f32 v235, v140, v141, v142
v_max3_f32 v235, v235, v143, v248
v_mov_b32 v248, v235
s_nop 1
v_permlane32_swap_b32 v235, v248
s_nop 1
v_max_f32 v235, v235, v248
v_mov_b32 v248, v235
s_nop 1
v_permlane16_swap_b32 v235, v248
s_nop 1
v_max_f32 v235, v235, v248
v_ceil_f32 v235, v235
v_max_f32 v235, 0, v235
v_sub_f32 v248, 0, v235
v_exp_f32 v239, v248
s_nop 1
v_mul_f32 v227, v227, v239
v_sub_f32 v204, v204, v235
v_sub_f32 v140, v140, v235
v_sub_f32 v156, v156, v235
v_sub_f32 v205, v205, v235
v_sub_f32 v141, v141, v235
v_sub_f32 v157, v157, v235
v_sub_f32 v206, v206, v235
v_sub_f32 v142, v142, v235
v_sub_f32 v158, v158, v235
v_sub_f32 v207, v207, v235
v_sub_f32 v143, v143, v235
v_sub_f32 v159, v159, v235
v_lshlrev_b32 v242, 16, v172
v_and_b32 v248, 0xffff0000, v172
v_mul_f32 v242, v242, v239
v_mul_f32 v248, v248, v239
v_cvt_pk_bf16_f32 v172, v242, v248
v_lshlrev_b32 v242, 16, v173
v_and_b32 v248, 0xffff0000, v173
v_mul_f32 v242, v242, v239
v_mul_f32 v248, v248, v239
v_cvt_pk_bf16_f32 v173, v242, v248
v_lshlrev_b32 v242, 16, v174
v_and_b32 v248, 0xffff0000, v174
v_mul_f32 v242, v242, v239
v_mul_f32 v248, v248, v239
v_cvt_pk_bf16_f32 v174, v242, v248
v_lshlrev_b32 v242, 16, v175
v_and_b32 v248, 0xffff0000, v175
v_mul_f32 v242, v242, v239
v_mul_f32 v248, v248, v239
v_cvt_pk_bf16_f32 v175, v242, v248
ds_read_b64 v[250:251], v231 offset:3072
s_waitcnt lgkmcnt(0)
v_lshlrev_b32 v242, 16, v250
v_and_b32 v248, 0xffff0000, v250
v_mul_f32 v242, v242, v239
v_mul_f32 v248, v248, v239
v_cvt_pk_bf16_f32 v250, v242, v248
v_lshlrev_b32 v242, 16, v251
v_and_b32 v248, 0xffff0000, v251
v_mul_f32 v242, v242, v239
v_mul_f32 v248, v248, v239
v_cvt_pk_bf16_f32 v251, v242, v248
ds_write_b64 v231, v[250:251] offset:3072
s_waitcnt lgkmcnt(0)
ds_read_b64 v[250:251], v231 offset:3080
s_waitcnt lgkmcnt(0)
v_lshlrev_b32 v242, 16, v250
v_and_b32 v248, 0xffff0000, v250
v_mul_f32 v242, v242, v239
v_mul_f32 v248, v248, v239
v_cvt_pk_bf16_f32 v250, v242, v248
v_lshlrev_b32 v242, 16, v251
v_and_b32 v248, 0xffff0000, v251
v_mul_f32 v242, v242, v239
v_mul_f32 v248, v248, v239
v_cvt_pk_bf16_f32 v251, v242, v248
ds_write_b64 v231, v[250:251] offset:3080
s_waitcnt lgkmcnt(0)
v_exp_f32 v232, v128
v_exp_f32 v233, v129
v_exp_f32 v234, v130
v_exp_f32 v235, v131
s_nop 1
v_add_f32 v224, v224, v232
v_add_f32 v224, v224, v233
v_add_f32 v224, v224, v234
v_add_f32 v224, v224, v235
v_cvt_pk_bf16_f32 v176, v232, v233
v_cvt_pk_bf16_f32 v177, v234, v235
v_exp_f32 v232, v132
v_exp_f32 v233, v133
v_exp_f32 v234, v134
v_exp_f32 v235, v135
s_nop 1
v_add_f32 v225, v225, v232
v_add_f32 v225, v225, v233
v_add_f32 v225, v225, v234
v_add_f32 v225, v225, v235
v_cvt_pk_bf16_f32 v180, v232, v233
v_cvt_pk_bf16_f32 v181, v234, v235
v_exp_f32 v232, v136
v_exp_f32 v233, v137
v_exp_f32 v234, v138
v_exp_f32 v235, v139
s_nop 1
v_add_f32 v226, v226, v232
v_add_f32 v226, v226, v233
v_add_f32 v226, v226, v234
v_add_f32 v226, v226, v235
v_cvt_pk_bf16_f32 v184, v232, v233
v_cvt_pk_bf16_f32 v185, v234, v235
v_exp_f32 v232, v140
v_exp_f32 v233, v141
v_exp_f32 v234, v142
v_exp_f32 v235, v143
s_nop 1
v_add_f32 v227, v227, v232
v_add_f32 v227, v227, v233
v_add_f32 v227, v227, v234
v_add_f32 v227, v227, v235
v_cvt_pk_bf16_f32 v188, v232, v233
v_cvt_pk_bf16_f32 v189, v234, v235
s_branch L2_rare_common
L2_rare_site7:
s_mov_b32 s36, 7
s_branch L2_rare_t1_1_1
L2_rare_t1_1_1:
s_nop 15
s_nop 15
s_waitcnt lgkmcnt(0)
v_exp_f32 v248, v144
s_nop 0
v_sub_f32 v224, v224, v248
v_exp_f32 v248, v145
s_nop 0
v_sub_f32 v224, v224, v248
v_exp_f32 v248, v146
s_nop 0
v_sub_f32 v224, v224, v248
v_exp_f32 v248, v147
s_nop 0
v_sub_f32 v224, v224, v248
v_max_f32 v224, 0, v224
v_min_f32 v224, s32, v224
v_log_f32 v248, v224
v_max3_f32 v232, v144, v145, v146
v_max3_f32 v232, v232, v147, v248
v_mov_b32 v248, v232
s_nop 1
v_permlane32_swap_b32 v232, v248
s_nop 1
v_max_f32 v232, v232, v248
v_mov_b32 v248, v232
s_nop 1
v_permlane16_swap_b32 v232, v248
s_nop 1
v_max_f32 v232, v232, v248
v_ceil_f32 v232, v232
v_max_f32 v232, 0, v232
v_sub_f32 v248, 0, v232
v_exp_f32 v236, v248
s_nop 1
v_mul_f32 v224, v224, v236
v_sub_f32 v192, v192, v232
v_sub_f32 v128, v128, v232
v_sub_f32 v144, v144, v232
v_sub_f32 v193, v193, v232
v_sub_f32 v129, v129, v232
v_sub_f32 v145, v145, v232
v_sub_f32 v194, v194, v232
v_sub_f32 v130, v130, v232
v_sub_f32 v146, v146, v232
v_sub_f32 v195, v195, v232
v_sub_f32 v131, v131, v232
v_sub_f32 v147, v147, v232
v_lshlrev_b32 v242, 16, v176
v_and_b32 v248, 0xffff0000, v176
v_mul_f32 v242, v242, v236
v_mul_f32 v248, v248, v236
v_cvt_pk_bf16_f32 v176, v242, v248
v_lshlrev_b32 v242, 16, v177
v_and_b32 v248, 0xffff0000, v177
v_mul_f32 v242, v242, v236
v_mul_f32 v248, v248, v236
v_cvt_pk_bf16_f32 v177, v242, v248
ds_read_b64 v[250:251], v231 offset:0
s_waitcnt lgkmcnt(0)
v_lshlrev_b32 v242, 16, v250
v_and_b32 v248, 0xffff0000, v250
v_mul_f32 v242, v242, v236
v_mul_f32 v248, v248, v236
v_cvt_pk_bf16_f32 v250, v242, v248
v_lshlrev_b32 v242, 16, v251
v_and_b32 v248, 0xffff0000, v251
v_mul_f32 v242, v242, v236
v_mul_f32 v248, v248, v236
v_cvt_pk_bf16_f32 v251, v242, v248
ds_write_b64 v231, v[250:251] offset:0
s_waitcnt lgkmcnt(0)
ds_read_b64 v[250:251], v231 offset:8
s_waitcnt lgkmcnt(0)
v_lshlrev_b32 v242, 16, v250
v_and_b32 v248, 0xffff0000, v250
v_mul_f32 v242, v242, v236
v_mul_f32 v248, v248, v236
v_cvt_pk_bf16_f32 v250, v242, v248
v_lshlrev_b32 v242, 16, v251
v_and_b32 v248, 0xffff0000, v251
v_mul_f32 v242, v242, v236
v_mul_f32 v248, v248, v236
v_cvt_pk_bf16_f32 v251, v242, v248
ds_write_b64 v231, v[250:251] offset:8
s_waitcnt lgkmcnt(0)
ds_read_b64 v[250:251], v231 offset:4096
s_waitcnt lgkmcnt(0)
v_lshlrev_b32 v242, 16, v250
v_and_b32 v248, 0xffff0000, v250
v_mul_f32 v242, v242, v236
v_mul_f32 v248, v248, v236
v_cvt_pk_bf16_f32 v250, v242, v248
v_lshlrev_b32 v242, 16, v251
v_and_b32 v248, 0xffff0000, v251
v_mul_f32 v242, v242, v236
v_mul_f32 v248, v248, v236
v_cvt_pk_bf16_f32 v251, v242, v248
ds_write_b64 v231, v[250:251] offset:4096
s_waitcnt lgkmcnt(0)
ds_read_b64 v[250:251], v231 offset:4104
s_waitcnt lgkmcnt(0)
v_lshlrev_b32 v242, 16, v250
v_and_b32 v248, 0xffff0000, v250
v_mul_f32 v242, v242, v236
v_mul_f32 v248, v248, v236
v_cvt_pk_bf16_f32 v250, v242, v248
v_lshlrev_b32 v242, 16, v251
v_and_b32 v248, 0xffff0000, v251
v_mul_f32 v242, v242, v236
v_mul_f32 v248, v248, v236
v_cvt_pk_bf16_f32 v251, v242, v248
ds_write_b64 v231, v[250:251] offset:4104
s_waitcnt lgkmcnt(0)
v_exp_f32 v248, v148
s_nop 0
v_sub_f32 v225, v225, v248
v_exp_f32 v248, v149
s_nop 0
v_sub_f32 v225, v225, v248
v_exp_f32 v248, v150
s_nop 0
v_sub_f32 v225, v225, v248
v_exp_f32 v248, v151
s_nop 0
v_sub_f32 v225, v225, v248
v_max_f32 v225, 0, v225
v_min_f32 v225, s32, v225
v_log_f32 v248, v225
v_max3_f32 v233, v148, v149, v150
v_max3_f32 v233, v233, v151, v248
v_mov_b32 v248, v233
s_nop 1
v_permlane32_swap_b32 v233, v248
s_nop 1
v_max_f32 v233, v233, v248
v_mov_b32 v248, v233
s_nop 1
v_permlane16_swap_b32 v233, v248
s_nop 1
v_max_f32 v233, v233, v248
v_ceil_f32 v233, v233
v_max_f32 v233, 0, v233
v_sub_f32 v248, 0, v233
v_exp_f32 v237, v248
s_nop 1
v_mul_f32 v225, v225, v237
v_sub_f32 v196, v196, v233
v_sub_f32 v132, v132, v233
v_sub_f32 v148, v148, v233
v_sub_f32 v197, v197, v233
v_sub_f32 v133, v133, v233
v_sub_f32 v149, v149, v233
v_sub_f32 v198, v198, v233
v_sub_f32 v134, v134, v233
v_sub_f32 v150, v150, v233
v_sub_f32 v199, v199, v233
v_sub_f32 v135, v135, v233
v_sub_f32 v151, v151, v233
v_lshlrev_b32 v242, 16, v180
v_and_b32 v248, 0xffff0000, v180
v_mul_f32 v242, v242, v237
v_mul_f32 v248, v248, v237
v_cvt_pk_bf16_f32 v180, v242, v248
v_lshlrev_b32 v242, 16, v181
v_and_b32 v248, 0xffff0000, v181
v_mul_f32 v242, v242, v237
v_mul_f32 v248, v248, v237
v_cvt_pk_bf16_f32 v181, v242, v248
ds_read_b64 v[250:251], v231 offset:1024
s_waitcnt lgkmcnt(0)
v_lshlrev_b32 v242, 16, v250
v_and_b32 v248, 0xffff0000, v250
v_mul_f32 v242, v242, v237
v_mul_f32 v248, v248, v237
v_cvt_pk_bf16_f32 v250, v242, v248
v_lshlrev_b32 v242, 16, v251
v_and_b32 v248, 0xffff0000, v251
v_mul_f32 v242, v242, v237
v_mul_f32 v248, v248, v237
v_cvt_pk_bf16_f32 v251, v242, v248
ds_write_b64 v231, v[250:251] offset:1024
s_waitcnt lgkmcnt(0)
ds_read_b64 v[250:251], v231 offset:1032
s_waitcnt lgkmcnt(0)
v_lshlrev_b32 v242, 16, v250
v_and_b32 v248, 0xffff0000, v250
v_mul_f32 v242, v242, v237
v_mul_f32 v248, v248, v237
v_cvt_pk_bf16_f32 v250, v242, v248
v_lshlrev_b32 v242, 16, v251
v_and_b32 v248, 0xffff0000, v251
v_mul_f32 v242, v242, v237
v_mul_f32 v248, v248, v237
v_cvt_pk_bf16_f32 v251, v242, v248
ds_write_b64 v231, v[250:251] offset:1032
s_waitcnt lgkmcnt(0)
ds_read_b64 v[250:251], v231 offset:5120
s_waitcnt lgkmcnt(0)
v_lshlrev_b32 v242, 16, v250
v_and_b32 v248, 0xffff0000, v250
v_mul_f32 v242, v242, v237
v_mul_f32 v248, v248, v237
v_cvt_pk_bf16_f32 v250, v242, v248
v_lshlrev_b32 v242, 16, v251
v_and_b32 v248, 0xffff0000, v251
v_mul_f32 v242, v242, v237
v_mul_f32 v248, v248, v237
v_cvt_pk_bf16_f32 v251, v242, v248
ds_write_b64 v231, v[250:251] offset:5120
s_waitcnt lgkmcnt(0)
ds_read_b64 v[250:251], v231 offset:5128
s_waitcnt lgkmcnt(0)
v_lshlrev_b32 v242, 16, v250
v_and_b32 v248, 0xffff0000, v250
v_mul_f32 v242, v242, v237
v_mul_f32 v248, v248, v237
v_cvt_pk_bf16_f32 v250, v242, v248
v_lshlrev_b32 v242, 16, v251
v_and_b32 v248, 0xffff0000, v251
v_mul_f32 v242, v242, v237
v_mul_f32 v248, v248, v237
v_cvt_pk_bf16_f32 v251, v242, v248
ds_write_b64 v231, v[250:251] offset:5128
s_waitcnt lgkmcnt(0)
v_exp_f32 v248, v152
s_nop 0
v_sub_f32 v226, v226, v248
v_exp_f32 v248, v153
s_nop 0
v_sub_f32 v226, v226, v248
v_exp_f32 v248, v154
s_nop 0
v_sub_f32 v226, v226, v248
v_exp_f32 v248, v155
s_nop 0
v_sub_f32 v226, v226, v248
v_max_f32 v226, 0, v226
v_min_f32 v226, s32, v226
v_log_f32 v248, v226
v_max3_f32 v234, v152, v153, v154
v_max3_f32 v234, v234, v155, v248
v_mov_b32 v248, v234
s_nop 1
v_permlane32_swap_b32 v234, v248
s_nop 1
v_max_f32 v234, v234, v248
v_mov_b32 v248, v234
s_nop 1
v_permlane16_swap_b32 v234, v248
s_nop 1
v_max_f32 v234, v234, v248
v_ceil_f32 v234, v234
v_max_f32 v234, 0, v234
v_sub_f32 v248, 0, v234
v_exp_f32 v238, v248
s_nop 1
v_mul_f32 v226, v226, v238
v_sub_f32 v200, v200, v234
v_sub_f32 v136, v136, v234
v_sub_f32 v152, v152, v234
v_sub_f32 v201, v201, v234
v_sub_f32 v137, v137, v234
v_sub_f32 v153, v153, v234
v_sub_f32 v202, v202, v234
v_sub_f32 v138, v138, v234
v_sub_f32 v154, v154, v234
v_sub_f32 v203, v203, v234
v_sub_f32 v139, v139, v234
v_sub_f32 v155, v155, v234
v_lshlrev_b32 v242, 16, v184
v_and_b32 v248, 0xffff0000, v184
v_mul_f32 v242, v242, v238
v_mul_f32 v248, v248, v238
v_cvt_pk_bf16_f32 v184, v242, v248
v_lshlrev_b32 v242, 16, v185
v_and_b32 v248, 0xffff0000, v185
v_mul_f32 v242, v242, v238
v_mul_f32 v248, v248, v238
v_cvt_pk_bf16_f32 v185, v242, v248
ds_read_b64 v[250:251], v231 offset:2048
s_waitcnt lgkmcnt(0)
v_lshlrev_b32 v242, 16, v250
v_and_b32 v248, 0xffff0000, v250
v_mul_f32 v242, v242, v238
v_mul_f32 v248, v248, v238
v_cvt_pk_bf16_f32 v250, v242, v248
v_lshlrev_b32 v242, 16, v251
v_and_b32 v248, 0xffff0000, v251
v_mul_f32 v242, v242, v238
v_mul_f32 v248, v248, v238
v_cvt_pk_bf16_f32 v251, v242, v248
ds_write_b64 v231, v[250:251] offset:2048
s_waitcnt lgkmcnt(0)
ds_read_b64 v[250:251], v231 offset:2056
s_waitcnt lgkmcnt(0)
v_lshlrev_b32 v242, 16, v250
v_and_b32 v248, 0xffff0000, v250
v_mul_f32 v242, v242, v238
v_mul_f32 v248, v248, v238
v_cvt_pk_bf16_f32 v250, v242, v248
v_lshlrev_b32 v242, 16, v251
v_and_b32 v248, 0xffff0000, v251
v_mul_f32 v242, v242, v238
v_mul_f32 v248, v248, v238
v_cvt_pk_bf16_f32 v251, v242, v248
ds_write_b64 v231, v[250:251] offset:2056
s_waitcnt lgkmcnt(0)
ds_read_b64 v[250:251], v231 offset:6144
s_waitcnt lgkmcnt(0)
v_lshlrev_b32 v242, 16, v250
v_and_b32 v248, 0xffff0000, v250
v_mul_f32 v242, v242, v238
v_mul_f32 v248, v248, v238
v_cvt_pk_bf16_f32 v250, v242, v248
v_lshlrev_b32 v242, 16, v251
v_and_b32 v248, 0xffff0000, v251
v_mul_f32 v242, v242, v238
v_mul_f32 v248, v248, v238
v_cvt_pk_bf16_f32 v251, v242, v248
ds_write_b64 v231, v[250:251] offset:6144
s_waitcnt lgkmcnt(0)
ds_read_b64 v[250:251], v231 offset:6152
s_waitcnt lgkmcnt(0)
v_lshlrev_b32 v242, 16, v250
v_and_b32 v248, 0xffff0000, v250
v_mul_f32 v242, v242, v238
v_mul_f32 v248, v248, v238
v_cvt_pk_bf16_f32 v250, v242, v248
v_lshlrev_b32 v242, 16, v251
v_and_b32 v248, 0xffff0000, v251
v_mul_f32 v242, v242, v238
v_mul_f32 v248, v248, v238
v_cvt_pk_bf16_f32 v251, v242, v248
ds_write_b64 v231, v[250:251] offset:6152
s_waitcnt lgkmcnt(0)
v_exp_f32 v248, v156
s_nop 0
v_sub_f32 v227, v227, v248
v_exp_f32 v248, v157
s_nop 0
v_sub_f32 v227, v227, v248
v_exp_f32 v248, v158
s_nop 0
v_sub_f32 v227, v227, v248
v_exp_f32 v248, v159
s_nop 0
v_sub_f32 v227, v227, v248
v_max_f32 v227, 0, v227
v_min_f32 v227, s32, v227
v_log_f32 v248, v227
v_max3_f32 v235, v156, v157, v158
v_max3_f32 v235, v235, v159, v248
v_mov_b32 v248, v235
s_nop 1
v_permlane32_swap_b32 v235, v248
s_nop 1
v_max_f32 v235, v235, v248
v_mov_b32 v248, v235
s_nop 1
v_permlane16_swap_b32 v235, v248
s_nop 1
v_max_f32 v235, v235, v248
v_ceil_f32 v235, v235
v_max_f32 v235, 0, v235
v_sub_f32 v248, 0, v235
v_exp_f32 v239, v248
s_nop 1
v_mul_f32 v227, v227, v239
v_sub_f32 v204, v204, v235
v_sub_f32 v140, v140, v235
v_sub_f32 v156, v156, v235
v_sub_f32 v205, v205, v235
v_sub_f32 v141, v141, v235
v_sub_f32 v157, v157, v235
v_sub_f32 v206, v206, v235
v_sub_f32 v142, v142, v235
v_sub_f32 v158, v158, v235
v_sub_f32 v207, v207, v235
v_sub_f32 v143, v143, v235
v_sub_f32 v159, v159, v235
v_lshlrev_b32 v242, 16, v188
v_and_b32 v248, 0xffff0000, v188
v_mul_f32 v242, v242, v239
v_mul_f32 v248, v248, v239
v_cvt_pk_bf16_f32 v188, v242, v248
v_lshlrev_b32 v242, 16, v189
v_and_b32 v248, 0xffff0000, v189
v_mul_f32 v242, v242, v239
v_mul_f32 v248, v248, v239
v_cvt_pk_bf16_f32 v189, v242, v248
ds_read_b64 v[250:251], v231 offset:3072
s_waitcnt lgkmcnt(0)
v_lshlrev_b32 v242, 16, v250
v_and_b32 v248, 0xffff0000, v250
v_mul_f32 v242, v242, v239
v_mul_f32 v248, v248, v239
v_cvt_pk_bf16_f32 v250, v242, v248
v_lshlrev_b32 v242, 16, v251
v_and_b32 v248, 0xffff0000, v251
v_mul_f32 v242, v242, v239
v_mul_f32 v248, v248, v239
v_cvt_pk_bf16_f32 v251, v242, v248
ds_write_b64 v231, v[250:251] offset:3072
s_waitcnt lgkmcnt(0)
ds_read_b64 v[250:251], v231 offset:3080
s_waitcnt lgkmcnt(0)
v_lshlrev_b32 v242, 16, v250
v_and_b32 v248, 0xffff0000, v250
v_mul_f32 v242, v242, v239
v_mul_f32 v248, v248, v239
v_cvt_pk_bf16_f32 v250, v242, v248
v_lshlrev_b32 v242, 16, v251
v_and_b32 v248, 0xffff0000, v251
v_mul_f32 v242, v242, v239
v_mul_f32 v248, v248, v239
v_cvt_pk_bf16_f32 v251, v242, v248
ds_write_b64 v231, v[250:251] offset:3080
s_waitcnt lgkmcnt(0)
ds_read_b64 v[250:251], v231 offset:7168
s_waitcnt lgkmcnt(0)
v_lshlrev_b32 v242, 16, v250
v_and_b32 v248, 0xffff0000, v250
v_mul_f32 v242, v242, v239
v_mul_f32 v248, v248, v239
v_cvt_pk_bf16_f32 v250, v242, v248
v_lshlrev_b32 v242, 16, v251
v_and_b32 v248, 0xffff0000, v251
v_mul_f32 v242, v242, v239
v_mul_f32 v248, v248, v239
v_cvt_pk_bf16_f32 v251, v242, v248
ds_write_b64 v231, v[250:251] offset:7168
s_waitcnt lgkmcnt(0)
ds_read_b64 v[250:251], v231 offset:7176
s_waitcnt lgkmcnt(0)
v_lshlrev_b32 v242, 16, v250
v_and_b32 v248, 0xffff0000, v250
v_mul_f32 v242, v242, v239
v_mul_f32 v248, v248, v239
v_cvt_pk_bf16_f32 v250, v242, v248
v_lshlrev_b32 v242, 16, v251
v_and_b32 v248, 0xffff0000, v251
v_mul_f32 v242, v242, v239
v_mul_f32 v248, v248, v239
v_cvt_pk_bf16_f32 v251, v242, v248
ds_write_b64 v231, v[250:251] offset:7176
s_waitcnt lgkmcnt(0)
v_exp_f32 v232, v144
v_exp_f32 v233, v145
v_exp_f32 v234, v146
v_exp_f32 v235, v147
s_nop 1
v_add_f32 v224, v224, v232
v_add_f32 v224, v224, v233
v_add_f32 v224, v224, v234
v_add_f32 v224, v224, v235
v_cvt_pk_bf16_f32 v178, v232, v233
v_cvt_pk_bf16_f32 v179, v234, v235
v_exp_f32 v232, v148
v_exp_f32 v233, v149
v_exp_f32 v234, v150
v_exp_f32 v235, v151
s_nop 1
v_add_f32 v225, v225, v232
v_add_f32 v225, v225, v233
v_add_f32 v225, v225, v234
v_add_f32 v225, v225, v235
v_cvt_pk_bf16_f32 v182, v232, v233
v_cvt_pk_bf16_f32 v183, v234, v235
v_exp_f32 v232, v152
v_exp_f32 v233, v153
v_exp_f32 v234, v154
v_exp_f32 v235, v155
s_nop 1
v_add_f32 v226, v226, v232
v_add_f32 v226, v226, v233
v_add_f32 v226, v226, v234
v_add_f32 v226, v226, v235
v_cvt_pk_bf16_f32 v186, v232, v233
v_cvt_pk_bf16_f32 v187, v234, v235
v_exp_f32 v232, v156
v_exp_f32 v233, v157
v_exp_f32 v234, v158
v_exp_f32 v235, v159
s_nop 1
v_add_f32 v227, v227, v232
v_add_f32 v227, v227, v233
v_add_f32 v227, v227, v234
v_add_f32 v227, v227, v235
v_cvt_pk_bf16_f32 v190, v232, v233
v_cvt_pk_bf16_f32 v191, v234, v235
s_branch L2_rare_common
L2_rare_site8:
s_mov_b32 s36, 8
s_branch L2_rare_t1_2_0
L2_rare_t1_2_0:
s_nop 15
s_nop 15
s_waitcnt lgkmcnt(0)
v_exp_f32 v248, v128
s_nop 0
v_sub_f32 v224, v224, v248
v_exp_f32 v248, v129
s_nop 0
v_sub_f32 v224, v224, v248
v_exp_f32 v248, v130
s_nop 0
v_sub_f32 v224, v224, v248
v_exp_f32 v248, v131
s_nop 0
v_sub_f32 v224, v224, v248
v_max_f32 v224, 0, v224
v_min_f32 v224, s32, v224
v_log_f32 v248, v224
v_max3_f32 v232, v128, v129, v130
v_max3_f32 v232, v232, v131, v248
v_mov_b32 v248, v232
s_nop 1
v_permlane32_swap_b32 v232, v248
s_nop 1
v_max_f32 v232, v232, v248
v_mov_b32 v248, v232
s_nop 1
v_permlane16_swap_b32 v232, v248
s_nop 1
v_max_f32 v232, v232, v248
v_ceil_f32 v232, v232
v_max_f32 v232, 0, v232
v_sub_f32 v248, 0, v232
v_exp_f32 v236, v248
s_nop 1
v_mul_f32 v224, v224, v236
v_sub_f32 v192, v192, v232
v_sub_f32 v128, v128, v232
v_sub_f32 v144, v144, v232
v_sub_f32 v193, v193, v232
v_sub_f32 v129, v129, v232
v_sub_f32 v145, v145, v232
v_sub_f32 v194, v194, v232
v_sub_f32 v130, v130, v232
v_sub_f32 v146, v146, v232
v_sub_f32 v195, v195, v232
v_sub_f32 v131, v131, v232
v_sub_f32 v147, v147, v232
v_lshlrev_b32 v242, 16, v176
v_and_b32 v248, 0xffff0000, v176
v_mul_f32 v242, v242, v236
v_mul_f32 v248, v248, v236
v_cvt_pk_bf16_f32 v176, v242, v248
v_lshlrev_b32 v242, 16, v177
v_and_b32 v248, 0xffff0000, v177
v_mul_f32 v242, v242, v236
v_mul_f32 v248, v248, v236
v_cvt_pk_bf16_f32 v177, v242, v248
v_lshlrev_b32 v242, 16, v178
v_and_b32 v248, 0xffff0000, v178
v_mul_f32 v242, v242, v236
v_mul_f32 v248, v248, v236
v_cvt_pk_bf16_f32 v178, v242, v248
v_lshlrev_b32 v242, 16, v179
v_and_b32 v248, 0xffff0000, v179
v_mul_f32 v242, v242, v236
v_mul_f32 v248, v248, v236
v_cvt_pk_bf16_f32 v179, v242, v248
ds_read_b64 v[250:251], v231 offset:0
s_waitcnt lgkmcnt(0)
v_lshlrev_b32 v242, 16, v250
v_and_b32 v248, 0xffff0000, v250
v_mul_f32 v242, v242, v236
v_mul_f32 v248, v248, v236
v_cvt_pk_bf16_f32 v250, v242, v248
v_lshlrev_b32 v242, 16, v251
v_and_b32 v248, 0xffff0000, v251
v_mul_f32 v242, v242, v236
v_mul_f32 v248, v248, v236
v_cvt_pk_bf16_f32 v251, v242, v248
ds_write_b64 v231, v[250:251] offset:0
s_waitcnt lgkmcnt(0)
ds_read_b64 v[250:251], v231 offset:8
s_waitcnt lgkmcnt(0)
v_lshlrev_b32 v242, 16, v250
v_and_b32 v248, 0xffff0000, v250
v_mul_f32 v242, v242, v236
v_mul_f32 v248, v248, v236
v_cvt_pk_bf16_f32 v250, v242, v248
v_lshlrev_b32 v242, 16, v251
v_and_b32 v248, 0xffff0000, v251
v_mul_f32 v242, v242, v236
v_mul_f32 v248, v248, v236
v_cvt_pk_bf16_f32 v251, v242, v248
ds_write_b64 v231, v[250:251] offset:8
s_waitcnt lgkmcnt(0)
ds_read_b64 v[250:251], v231 offset:4096
s_waitcnt lgkmcnt(0)
v_lshlrev_b32 v242, 16, v250
v_and_b32 v248, 0xffff0000, v250
v_mul_f32 v242, v242, v236
v_mul_f32 v248, v248, v236
v_cvt_pk_bf16_f32 v250, v242, v248
v_lshlrev_b32 v242, 16, v251
v_and_b32 v248, 0xffff0000, v251
v_mul_f32 v242, v242, v236
v_mul_f32 v248, v248, v236
v_cvt_pk_bf16_f32 v251, v242, v248
ds_write_b64 v231, v[250:251] offset:4096
s_waitcnt lgkmcnt(0)
ds_read_b64 v[250:251], v231 offset:4104
s_waitcnt lgkmcnt(0)
v_lshlrev_b32 v242, 16, v250
v_and_b32 v248, 0xffff0000, v250
v_mul_f32 v242, v242, v236
v_mul_f32 v248, v248, v236
v_cvt_pk_bf16_f32 v250, v242, v248
v_lshlrev_b32 v242, 16, v251
v_and_b32 v248, 0xffff0000, v251
v_mul_f32 v242, v242, v236
v_mul_f32 v248, v248, v236
v_cvt_pk_bf16_f32 v251, v242, v248
ds_write_b64 v231, v[250:251] offset:4104
s_waitcnt lgkmcnt(0)
v_exp_f32 v248, v132
s_nop 0
v_sub_f32 v225, v225, v248
v_exp_f32 v248, v133
s_nop 0
v_sub_f32 v225, v225, v248
v_exp_f32 v248, v134
s_nop 0
v_sub_f32 v225, v225, v248
v_exp_f32 v248, v135
s_nop 0
v_sub_f32 v225, v225, v248
v_max_f32 v225, 0, v225
v_min_f32 v225, s32, v225
v_log_f32 v248, v225
v_max3_f32 v233, v132, v133, v134
v_max3_f32 v233, v233, v135, v248
v_mov_b32 v248, v233
s_nop 1
v_permlane32_swap_b32 v233, v248
s_nop 1
v_max_f32 v233, v233, v248
v_mov_b32 v248, v233
s_nop 1
v_permlane16_swap_b32 v233, v248
s_nop 1
v_max_f32 v233, v233, v248
v_ceil_f32 v233, v233
v_max_f32 v233, 0, v233
v_sub_f32 v248, 0, v233
v_exp_f32 v237, v248
s_nop 1
v_mul_f32 v225, v225, v237
v_sub_f32 v196, v196, v233
v_sub_f32 v132, v132, v233
v_sub_f32 v148, v148, v233
v_sub_f32 v197, v197, v233
v_sub_f32 v133, v133, v233
v_sub_f32 v149, v149, v233
v_sub_f32 v198, v198, v233
v_sub_f32 v134, v134, v233
v_sub_f32 v150, v150, v233
v_sub_f32 v199, v199, v233
v_sub_f32 v135, v135, v233
v_sub_f32 v151, v151, v233
v_lshlrev_b32 v242, 16, v180
v_and_b32 v248, 0xffff0000, v180
v_mul_f32 v242, v242, v237
v_mul_f32 v248, v248, v237
v_cvt_pk_bf16_f32 v180, v242, v248
v_lshlrev_b32 v242, 16, v181
v_and_b32 v248, 0xffff0000, v181
v_mul_f32 v242, v242, v237
v_mul_f32 v248, v248, v237
v_cvt_pk_bf16_f32 v181, v242, v248
v_lshlrev_b32 v242, 16, v182
v_and_b32 v248, 0xffff0000, v182
v_mul_f32 v242, v242, v237
v_mul_f32 v248, v248, v237
v_cvt_pk_bf16_f32 v182, v242, v248
v_lshlrev_b32 v242, 16, v183
v_and_b32 v248, 0xffff0000, v183
v_mul_f32 v242, v242, v237
v_mul_f32 v248, v248, v237
v_cvt_pk_bf16_f32 v183, v242, v248
ds_read_b64 v[250:251], v231 offset:1024
s_waitcnt lgkmcnt(0)
v_lshlrev_b32 v242, 16, v250
v_and_b32 v248, 0xffff0000, v250
v_mul_f32 v242, v242, v237
v_mul_f32 v248, v248, v237
v_cvt_pk_bf16_f32 v250, v242, v248
v_lshlrev_b32 v242, 16, v251
v_and_b32 v248, 0xffff0000, v251
v_mul_f32 v242, v242, v237
v_mul_f32 v248, v248, v237
v_cvt_pk_bf16_f32 v251, v242, v248
ds_write_b64 v231, v[250:251] offset:1024
s_waitcnt lgkmcnt(0)
ds_read_b64 v[250:251], v231 offset:1032
s_waitcnt lgkmcnt(0)
v_lshlrev_b32 v242, 16, v250
v_and_b32 v248, 0xffff0000, v250
v_mul_f32 v242, v242, v237
v_mul_f32 v248, v248, v237
v_cvt_pk_bf16_f32 v250, v242, v248
v_lshlrev_b32 v242, 16, v251
v_and_b32 v248, 0xffff0000, v251
v_mul_f32 v242, v242, v237
v_mul_f32 v248, v248, v237
v_cvt_pk_bf16_f32 v251, v242, v248
ds_write_b64 v231, v[250:251] offset:1032
s_waitcnt lgkmcnt(0)
ds_read_b64 v[250:251], v231 offset:5120
s_waitcnt lgkmcnt(0)
v_lshlrev_b32 v242, 16, v250
v_and_b32 v248, 0xffff0000, v250
v_mul_f32 v242, v242, v237
v_mul_f32 v248, v248, v237
v_cvt_pk_bf16_f32 v250, v242, v248
v_lshlrev_b32 v242, 16, v251
v_and_b32 v248, 0xffff0000, v251
v_mul_f32 v242, v242, v237
v_mul_f32 v248, v248, v237
v_cvt_pk_bf16_f32 v251, v242, v248
ds_write_b64 v231, v[250:251] offset:5120
s_waitcnt lgkmcnt(0)
ds_read_b64 v[250:251], v231 offset:5128
s_waitcnt lgkmcnt(0)
v_lshlrev_b32 v242, 16, v250
v_and_b32 v248, 0xffff0000, v250
v_mul_f32 v242, v242, v237
v_mul_f32 v248, v248, v237
v_cvt_pk_bf16_f32 v250, v242, v248
v_lshlrev_b32 v242, 16, v251
v_and_b32 v248, 0xffff0000, v251
v_mul_f32 v242, v242, v237
v_mul_f32 v248, v248, v237
v_cvt_pk_bf16_f32 v251, v242, v248
ds_write_b64 v231, v[250:251] offset:5128
s_waitcnt lgkmcnt(0)
v_exp_f32 v248, v136
s_nop 0
v_sub_f32 v226, v226, v248
v_exp_f32 v248, v137
s_nop 0
v_sub_f32 v226, v226, v248
v_exp_f32 v248, v138
s_nop 0
v_sub_f32 v226, v226, v248
v_exp_f32 v248, v139
s_nop 0
v_sub_f32 v226, v226, v248
v_max_f32 v226, 0, v226
v_min_f32 v226, s32, v226
v_log_f32 v248, v226
v_max3_f32 v234, v136, v137, v138
v_max3_f32 v234, v234, v139, v248
v_mov_b32 v248, v234
s_nop 1
v_permlane32_swap_b32 v234, v248
s_nop 1
v_max_f32 v234, v234, v248
v_mov_b32 v248, v234
s_nop 1
v_permlane16_swap_b32 v234, v248
s_nop 1
v_max_f32 v234, v234, v248
v_ceil_f32 v234, v234
v_max_f32 v234, 0, v234
v_sub_f32 v248, 0, v234
v_exp_f32 v238, v248
s_nop 1
v_mul_f32 v226, v226, v238
v_sub_f32 v200, v200, v234
v_sub_f32 v136, v136, v234
v_sub_f32 v152, v152, v234
v_sub_f32 v201, v201, v234
v_sub_f32 v137, v137, v234
v_sub_f32 v153, v153, v234
v_sub_f32 v202, v202, v234
v_sub_f32 v138, v138, v234
v_sub_f32 v154, v154, v234
v_sub_f32 v203, v203, v234
v_sub_f32 v139, v139, v234
v_sub_f32 v155, v155, v234
v_lshlrev_b32 v242, 16, v184
v_and_b32 v248, 0xffff0000, v184
v_mul_f32 v242, v242, v238
v_mul_f32 v248, v248, v238
v_cvt_pk_bf16_f32 v184, v242, v248
v_lshlrev_b32 v242, 16, v185
v_and_b32 v248, 0xffff0000, v185
v_mul_f32 v242, v242, v238
v_mul_f32 v248, v248, v238
v_cvt_pk_bf16_f32 v185, v242, v248
v_lshlrev_b32 v242, 16, v186
v_and_b32 v248, 0xffff0000, v186
v_mul_f32 v242, v242, v238
v_mul_f32 v248, v248, v238
v_cvt_pk_bf16_f32 v186, v242, v248
v_lshlrev_b32 v242, 16, v187
v_and_b32 v248, 0xffff0000, v187
v_mul_f32 v242, v242, v238
v_mul_f32 v248, v248, v238
v_cvt_pk_bf16_f32 v187, v242, v248
ds_read_b64 v[250:251], v231 offset:2048
s_waitcnt lgkmcnt(0)
v_lshlrev_b32 v242, 16, v250
v_and_b32 v248, 0xffff0000, v250
v_mul_f32 v242, v242, v238
v_mul_f32 v248, v248, v238
v_cvt_pk_bf16_f32 v250, v242, v248
v_lshlrev_b32 v242, 16, v251
v_and_b32 v248, 0xffff0000, v251
v_mul_f32 v242, v242, v238
v_mul_f32 v248, v248, v238
v_cvt_pk_bf16_f32 v251, v242, v248
ds_write_b64 v231, v[250:251] offset:2048
s_waitcnt lgkmcnt(0)
ds_read_b64 v[250:251], v231 offset:2056
s_waitcnt lgkmcnt(0)
v_lshlrev_b32 v242, 16, v250
v_and_b32 v248, 0xffff0000, v250
v_mul_f32 v242, v242, v238
v_mul_f32 v248, v248, v238
v_cvt_pk_bf16_f32 v250, v242, v248
v_lshlrev_b32 v242, 16, v251
v_and_b32 v248, 0xffff0000, v251
v_mul_f32 v242, v242, v238
v_mul_f32 v248, v248, v238
v_cvt_pk_bf16_f32 v251, v242, v248
ds_write_b64 v231, v[250:251] offset:2056
s_waitcnt lgkmcnt(0)
ds_read_b64 v[250:251], v231 offset:6144
s_waitcnt lgkmcnt(0)
v_lshlrev_b32 v242, 16, v250
v_and_b32 v248, 0xffff0000, v250
v_mul_f32 v242, v242, v238
v_mul_f32 v248, v248, v238
v_cvt_pk_bf16_f32 v250, v242, v248
v_lshlrev_b32 v242, 16, v251
v_and_b32 v248, 0xffff0000, v251
v_mul_f32 v242, v242, v238
v_mul_f32 v248, v248, v238
v_cvt_pk_bf16_f32 v251, v242, v248
ds_write_b64 v231, v[250:251] offset:6144
s_waitcnt lgkmcnt(0)
ds_read_b64 v[250:251], v231 offset:6152
s_waitcnt lgkmcnt(0)
v_lshlrev_b32 v242, 16, v250
v_and_b32 v248, 0xffff0000, v250
v_mul_f32 v242, v242, v238
v_mul_f32 v248, v248, v238
v_cvt_pk_bf16_f32 v250, v242, v248
v_lshlrev_b32 v242, 16, v251
v_and_b32 v248, 0xffff0000, v251
v_mul_f32 v242, v242, v238
v_mul_f32 v248, v248, v238
v_cvt_pk_bf16_f32 v251, v242, v248
ds_write_b64 v231, v[250:251] offset:6152
s_waitcnt lgkmcnt(0)
v_exp_f32 v248, v140
s_nop 0
v_sub_f32 v227, v227, v248
v_exp_f32 v248, v141
s_nop 0
v_sub_f32 v227, v227, v248
v_exp_f32 v248, v142
s_nop 0
v_sub_f32 v227, v227, v248
v_exp_f32 v248, v143
s_nop 0
v_sub_f32 v227, v227, v248
v_max_f32 v227, 0, v227
v_min_f32 v227, s32, v227
v_log_f32 v248, v227
v_max3_f32 v235, v140, v141, v142
v_max3_f32 v235, v235, v143, v248
v_mov_b32 v248, v235
s_nop 1
v_permlane32_swap_b32 v235, v248
s_nop 1
v_max_f32 v235, v235, v248
v_mov_b32 v248, v235
s_nop 1
v_permlane16_swap_b32 v235, v248
s_nop 1
v_max_f32 v235, v235, v248
v_ceil_f32 v235, v235
v_max_f32 v235, 0, v235
v_sub_f32 v248, 0, v235
v_exp_f32 v239, v248
s_nop 1
v_mul_f32 v227, v227, v239
v_sub_f32 v204, v204, v235
v_sub_f32 v140, v140, v235
v_sub_f32 v156, v156, v235
v_sub_f32 v205, v205, v235
v_sub_f32 v141, v141, v235
v_sub_f32 v157, v157, v235
v_sub_f32 v206, v206, v235
v_sub_f32 v142, v142, v235
v_sub_f32 v158, v158, v235
v_sub_f32 v207, v207, v235
v_sub_f32 v143, v143, v235
v_sub_f32 v159, v159, v235
v_lshlrev_b32 v242, 16, v188
v_and_b32 v248, 0xffff0000, v188
v_mul_f32 v242, v242, v239
v_mul_f32 v248, v248, v239
v_cvt_pk_bf16_f32 v188, v242, v248
v_lshlrev_b32 v242, 16, v189
v_and_b32 v248, 0xffff0000, v189
v_mul_f32 v242, v242, v239
v_mul_f32 v248, v248, v239
v_cvt_pk_bf16_f32 v189, v242, v248
v_lshlrev_b32 v242, 16, v190
v_and_b32 v248, 0xffff0000, v190
v_mul_f32 v242, v242, v239
v_mul_f32 v248, v248, v239
v_cvt_pk_bf16_f32 v190, v242, v248
v_lshlrev_b32 v242, 16, v191
v_and_b32 v248, 0xffff0000, v191
v_mul_f32 v242, v242, v239
v_mul_f32 v248, v248, v239
v_cvt_pk_bf16_f32 v191, v242, v248
ds_read_b64 v[250:251], v231 offset:3072
s_waitcnt lgkmcnt(0)
v_lshlrev_b32 v242, 16, v250
v_and_b32 v248, 0xffff0000, v250
v_mul_f32 v242, v242, v239
v_mul_f32 v248, v248, v239
v_cvt_pk_bf16_f32 v250, v242, v248
v_lshlrev_b32 v242, 16, v251
v_and_b32 v248, 0xffff0000, v251
v_mul_f32 v242, v242, v239
v_mul_f32 v248, v248, v239
v_cvt_pk_bf16_f32 v251, v242, v248
ds_write_b64 v231, v[250:251] offset:3072
s_waitcnt lgkmcnt(0)
ds_read_b64 v[250:251], v231 offset:3080
s_waitcnt lgkmcnt(0)
v_lshlrev_b32 v242, 16, v250
v_and_b32 v248, 0xffff0000, v250
v_mul_f32 v242, v242, v239
v_mul_f32 v248, v248, v239
v_cvt_pk_bf16_f32 v250, v242, v248
v_lshlrev_b32 v242, 16, v251
v_and_b32 v248, 0xffff0000, v251
v_mul_f32 v242, v242, v239
v_mul_f32 v248, v248, v239
v_cvt_pk_bf16_f32 v251, v242, v248
ds_write_b64 v231, v[250:251] offset:3080
s_waitcnt lgkmcnt(0)
ds_read_b64 v[250:251], v231 offset:7168
s_waitcnt lgkmcnt(0)
v_lshlrev_b32 v242, 16, v250
v_and_b32 v248, 0xffff0000, v250
v_mul_f32 v242, v242, v239
v_mul_f32 v248, v248, v239
v_cvt_pk_bf16_f32 v250, v242, v248
v_lshlrev_b32 v242, 16, v251
v_and_b32 v248, 0xffff0000, v251
v_mul_f32 v242, v242, v239
v_mul_f32 v248, v248, v239
v_cvt_pk_bf16_f32 v251, v242, v248
ds_write_b64 v231, v[250:251] offset:7168
s_waitcnt lgkmcnt(0)
ds_read_b64 v[250:251], v231 offset:7176
s_waitcnt lgkmcnt(0)
v_lshlrev_b32 v242, 16, v250
v_and_b32 v248, 0xffff0000, v250
v_mul_f32 v242, v242, v239
v_mul_f32 v248, v248, v239
v_cvt_pk_bf16_f32 v250, v242, v248
v_lshlrev_b32 v242, 16, v251
v_and_b32 v248, 0xffff0000, v251
v_mul_f32 v242, v242, v239
v_mul_f32 v248, v248, v239
v_cvt_pk_bf16_f32 v251, v242, v248
ds_write_b64 v231, v[250:251] offset:7176
s_waitcnt lgkmcnt(0)
v_exp_f32 v232, v128
v_exp_f32 v233, v129
v_exp_f32 v234, v130
v_exp_f32 v235, v131
s_nop 1
v_add_f32 v224, v224, v232
v_add_f32 v224, v224, v233
v_add_f32 v224, v224, v234
v_add_f32 v224, v224, v235
v_cvt_pk_bf16_f32 v160, v232, v233
v_cvt_pk_bf16_f32 v161, v234, v235
v_exp_f32 v232, v132
v_exp_f32 v233, v133
v_exp_f32 v234, v134
v_exp_f32 v235, v135
s_nop 1
v_add_f32 v225, v225, v232
v_add_f32 v225, v225, v233
v_add_f32 v225, v225, v234
v_add_f32 v225, v225, v235
v_cvt_pk_bf16_f32 v164, v232, v233
v_cvt_pk_bf16_f32 v165, v234, v235
v_exp_f32 v232, v136
v_exp_f32 v233, v137
v_exp_f32 v234, v138
v_exp_f32 v235, v139
s_nop 1
v_add_f32 v226, v226, v232
v_add_f32 v226, v226, v233
v_add_f32 v226, v226, v234
v_add_f32 v226, v226, v235
v_cvt_pk_bf16_f32 v168, v232, v233
v_cvt_pk_bf16_f32 v169, v234, v235
v_exp_f32 v232, v140
v_exp_f32 v233, v141
v_exp_f32 v234, v142
v_exp_f32 v235, v143
s_nop 1
v_add_f32 v227, v227, v232
v_add_f32 v227, v227, v233
v_add_f32 v227, v227, v234
v_add_f32 v227, v227, v235
v_cvt_pk_bf16_f32 v172, v232, v233
v_cvt_pk_bf16_f32 v173, v234, v235
s_branch L2_rare_common
L2_rare_site9:
s_mov_b32 s36, 9
s_branch L2_rare_t1_3_1
L2_rare_t1_3_1:
s_nop 15
s_nop 15
s_waitcnt lgkmcnt(0)
v_exp_f32 v248, v144
s_nop 0
v_sub_f32 v224, v224, v248
v_exp_f32 v248, v145
s_nop 0
v_sub_f32 v224, v224, v248
v_exp_f32 v248, v146
s_nop 0
v_sub_f32 v224, v224, v248
v_exp_f32 v248, v147
s_nop 0
v_sub_f32 v224, v224, v248
v_max_f32 v224, 0, v224
v_min_f32 v224, s32, v224
v_log_f32 v248, v224
v_max3_f32 v232, v144, v145, v146
v_max3_f32 v232, v232, v147, v248
v_mov_b32 v248, v232
s_nop 1
v_permlane32_swap_b32 v232, v248
s_nop 1
v_max_f32 v232, v232, v248
v_mov_b32 v248, v232
s_nop 1
v_permlane16_swap_b32 v232, v248
s_nop 1
v_max_f32 v232, v232, v248
v_ceil_f32 v232, v232
v_max_f32 v232, 0, v232
v_sub_f32 v248, 0, v232
v_exp_f32 v236, v248
s_nop 1
v_mul_f32 v224, v224, v236
v_sub_f32 v192, v192, v232
v_sub_f32 v128, v128, v232
v_sub_f32 v144, v144, v232
v_sub_f32 v193, v193, v232
v_sub_f32 v129, v129, v232
v_sub_f32 v145, v145, v232
v_sub_f32 v194, v194, v232
v_sub_f32 v130, v130, v232
v_sub_f32 v146, v146, v232
v_sub_f32 v195, v195, v232
v_sub_f32 v131, v131, v232
v_sub_f32 v147, v147, v232
v_lshlrev_b32 v242, 16, v176
v_and_b32 v248, 0xffff0000, v176
v_mul_f32 v242, v242, v236
v_mul_f32 v248, v248, v236
v_cvt_pk_bf16_f32 v176, v242, v248
v_lshlrev_b32 v242, 16, v177
v_and_b32 v248, 0xffff0000, v177
v_mul_f32 v242, v242, v236
v_mul_f32 v248, v248, v236
v_cvt_pk_bf16_f32 v177, v242, v248
v_lshlrev_b32 v242, 16, v178
v_and_b32 v248, 0xffff0000, v178
v_mul_f32 v242, v242, v236
v_mul_f32 v248, v248, v236
v_cvt_pk_bf16_f32 v178, v242, v248
v_lshlrev_b32 v242, 16, v179
v_and_b32 v248, 0xffff0000, v179
v_mul_f32 v242, v242, v236
v_mul_f32 v248, v248, v236
v_cvt_pk_bf16_f32 v179, v242, v248
v_lshlrev_b32 v242, 16, v160
v_and_b32 v248, 0xffff0000, v160
v_mul_f32 v242, v242, v236
v_mul_f32 v248, v248, v236
v_cvt_pk_bf16_f32 v160, v242, v248
v_lshlrev_b32 v242, 16, v161
v_and_b32 v248, 0xffff0000, v161
v_mul_f32 v242, v242, v236
v_mul_f32 v248, v248, v236
v_cvt_pk_bf16_f32 v161, v242, v248
ds_read_b64 v[250:251], v231 offset:0
s_waitcnt lgkmcnt(0)
v_lshlrev_b32 v242, 16, v250
v_and_b32 v248, 0xffff0000, v250
v_mul_f32 v242, v242, v236
v_mul_f32 v248, v248, v236
v_cvt_pk_bf16_f32 v250, v242, v248
v_lshlrev_b32 v242, 16, v251
v_and_b32 v248, 0xffff0000, v251
v_mul_f32 v242, v242, v236
v_mul_f32 v248, v248, v236
v_cvt_pk_bf16_f32 v251, v242, v248
ds_write_b64 v231, v[250:251] offset:0
s_waitcnt lgkmcnt(0)
ds_read_b64 v[250:251], v231 offset:8
s_waitcnt lgkmcnt(0)
v_lshlrev_b32 v242, 16, v250
v_and_b32 v248, 0xffff0000, v250
v_mul_f32 v242, v242, v236
v_mul_f32 v248, v248, v236
v_cvt_pk_bf16_f32 v250, v242, v248
v_lshlrev_b32 v242, 16, v251
v_and_b32 v248, 0xffff0000, v251
v_mul_f32 v242, v242, v236
v_mul_f32 v248, v248, v236
v_cvt_pk_bf16_f32 v251, v242, v248
ds_write_b64 v231, v[250:251] offset:8
s_waitcnt lgkmcnt(0)
ds_read_b64 v[250:251], v231 offset:4096
s_waitcnt lgkmcnt(0)
v_lshlrev_b32 v242, 16, v250
v_and_b32 v248, 0xffff0000, v250
v_mul_f32 v242, v242, v236
v_mul_f32 v248, v248, v236
v_cvt_pk_bf16_f32 v250, v242, v248
v_lshlrev_b32 v242, 16, v251
v_and_b32 v248, 0xffff0000, v251
v_mul_f32 v242, v242, v236
v_mul_f32 v248, v248, v236
v_cvt_pk_bf16_f32 v251, v242, v248
ds_write_b64 v231, v[250:251] offset:4096
s_waitcnt lgkmcnt(0)
ds_read_b64 v[250:251], v231 offset:4104
s_waitcnt lgkmcnt(0)
v_lshlrev_b32 v242, 16, v250
v_and_b32 v248, 0xffff0000, v250
v_mul_f32 v242, v242, v236
v_mul_f32 v248, v248, v236
v_cvt_pk_bf16_f32 v250, v242, v248
v_lshlrev_b32 v242, 16, v251
v_and_b32 v248, 0xffff0000, v251
v_mul_f32 v242, v242, v236
v_mul_f32 v248, v248, v236
v_cvt_pk_bf16_f32 v251, v242, v248
ds_write_b64 v231, v[250:251] offset:4104
s_waitcnt lgkmcnt(0)
v_exp_f32 v248, v148
s_nop 0
v_sub_f32 v225, v225, v248
v_exp_f32 v248, v149
s_nop 0
v_sub_f32 v225, v225, v248
v_exp_f32 v248, v150
s_nop 0
v_sub_f32 v225, v225, v248
v_exp_f32 v248, v151
s_nop 0
v_sub_f32 v225, v225, v248
v_max_f32 v225, 0, v225
v_min_f32 v225, s32, v225
v_log_f32 v248, v225
v_max3_f32 v233, v148, v149, v150
v_max3_f32 v233, v233, v151, v248
v_mov_b32 v248, v233
s_nop 1
v_permlane32_swap_b32 v233, v248
s_nop 1
v_max_f32 v233, v233, v248
v_mov_b32 v248, v233
s_nop 1
v_permlane16_swap_b32 v233, v248
s_nop 1
v_max_f32 v233, v233, v248
v_ceil_f32 v233, v233
v_max_f32 v233, 0, v233
v_sub_f32 v248, 0, v233
v_exp_f32 v237, v248
s_nop 1
v_mul_f32 v225, v225, v237
v_sub_f32 v196, v196, v233
v_sub_f32 v132, v132, v233
v_sub_f32 v148, v148, v233
v_sub_f32 v197, v197, v233
v_sub_f32 v133, v133, v233
v_sub_f32 v149, v149, v233
v_sub_f32 v198, v198, v233
v_sub_f32 v134, v134, v233
v_sub_f32 v150, v150, v233
v_sub_f32 v199, v199, v233
v_sub_f32 v135, v135, v233
v_sub_f32 v151, v151, v233
v_lshlrev_b32 v242, 16, v180
v_and_b32 v248, 0xffff0000, v180
v_mul_f32 v242, v242, v237
v_mul_f32 v248, v248, v237
v_cvt_pk_bf16_f32 v180, v242, v248
v_lshlrev_b32 v242, 16, v181
v_and_b32 v248, 0xffff0000, v181
v_mul_f32 v242, v242, v237
v_mul_f32 v248, v248, v237
v_cvt_pk_bf16_f32 v181, v242, v248
v_lshlrev_b32 v242, 16, v182
v_and_b32 v248, 0xffff0000, v182
v_mul_f32 v242, v242, v237
v_mul_f32 v248, v248, v237
v_cvt_pk_bf16_f32 v182, v242, v248
v_lshlrev_b32 v242, 16, v183
v_and_b32 v248, 0xffff0000, v183
v_mul_f32 v242, v242, v237
v_mul_f32 v248, v248, v237
v_cvt_pk_bf16_f32 v183, v242, v248
v_lshlrev_b32 v242, 16, v164
v_and_b32 v248, 0xffff0000, v164
v_mul_f32 v242, v242, v237
v_mul_f32 v248, v248, v237
v_cvt_pk_bf16_f32 v164, v242, v248
v_lshlrev_b32 v242, 16, v165
v_and_b32 v248, 0xffff0000, v165
v_mul_f32 v242, v242, v237
v_mul_f32 v248, v248, v237
v_cvt_pk_bf16_f32 v165, v242, v248
ds_read_b64 v[250:251], v231 offset:1024
s_waitcnt lgkmcnt(0)
v_lshlrev_b32 v242, 16, v250
v_and_b32 v248, 0xffff0000, v250
v_mul_f32 v242, v242, v237
v_mul_f32 v248, v248, v237
v_cvt_pk_bf16_f32 v250, v242, v248
v_lshlrev_b32 v242, 16, v251
v_and_b32 v248, 0xffff0000, v251
v_mul_f32 v242, v242, v237
v_mul_f32 v248, v248, v237
v_cvt_pk_bf16_f32 v251, v242, v248
ds_write_b64 v231, v[250:251] offset:1024
s_waitcnt lgkmcnt(0)
ds_read_b64 v[250:251], v231 offset:1032
s_waitcnt lgkmcnt(0)
v_lshlrev_b32 v242, 16, v250
v_and_b32 v248, 0xffff0000, v250
v_mul_f32 v242, v242, v237
v_mul_f32 v248, v248, v237
v_cvt_pk_bf16_f32 v250, v242, v248
v_lshlrev_b32 v242, 16, v251
v_and_b32 v248, 0xffff0000, v251
v_mul_f32 v242, v242, v237
v_mul_f32 v248, v248, v237
v_cvt_pk_bf16_f32 v251, v242, v248
ds_write_b64 v231, v[250:251] offset:1032
s_waitcnt lgkmcnt(0)
ds_read_b64 v[250:251], v231 offset:5120
s_waitcnt lgkmcnt(0)
v_lshlrev_b32 v242, 16, v250
v_and_b32 v248, 0xffff0000, v250
v_mul_f32 v242, v242, v237
v_mul_f32 v248, v248, v237
v_cvt_pk_bf16_f32 v250, v242, v248
v_lshlrev_b32 v242, 16, v251
v_and_b32 v248, 0xffff0000, v251
v_mul_f32 v242, v242, v237
v_mul_f32 v248, v248, v237
v_cvt_pk_bf16_f32 v251, v242, v248
ds_write_b64 v231, v[250:251] offset:5120
s_waitcnt lgkmcnt(0)
ds_read_b64 v[250:251], v231 offset:5128
s_waitcnt lgkmcnt(0)
v_lshlrev_b32 v242, 16, v250
v_and_b32 v248, 0xffff0000, v250
v_mul_f32 v242, v242, v237
v_mul_f32 v248, v248, v237
v_cvt_pk_bf16_f32 v250, v242, v248
v_lshlrev_b32 v242, 16, v251
v_and_b32 v248, 0xffff0000, v251
v_mul_f32 v242, v242, v237
v_mul_f32 v248, v248, v237
v_cvt_pk_bf16_f32 v251, v242, v248
ds_write_b64 v231, v[250:251] offset:5128
s_waitcnt lgkmcnt(0)
v_exp_f32 v248, v152
s_nop 0
v_sub_f32 v226, v226, v248
v_exp_f32 v248, v153
s_nop 0
v_sub_f32 v226, v226, v248
v_exp_f32 v248, v154
s_nop 0
v_sub_f32 v226, v226, v248
v_exp_f32 v248, v155
s_nop 0
v_sub_f32 v226, v226, v248
v_max_f32 v226, 0, v226
v_min_f32 v226, s32, v226
v_log_f32 v248, v226
v_max3_f32 v234, v152, v153, v154
v_max3_f32 v234, v234, v155, v248
v_mov_b32 v248, v234
s_nop 1
v_permlane32_swap_b32 v234, v248
s_nop 1
v_max_f32 v234, v234, v248
v_mov_b32 v248, v234
s_nop 1
v_permlane16_swap_b32 v234, v248
s_nop 1
v_max_f32 v234, v234, v248
v_ceil_f32 v234, v234
v_max_f32 v234, 0, v234
v_sub_f32 v248, 0, v234
v_exp_f32 v238, v248
s_nop 1
v_mul_f32 v226, v226, v238
v_sub_f32 v200, v200, v234
v_sub_f32 v136, v136, v234
v_sub_f32 v152, v152, v234
v_sub_f32 v201, v201, v234
v_sub_f32 v137, v137, v234
v_sub_f32 v153, v153, v234
v_sub_f32 v202, v202, v234
v_sub_f32 v138, v138, v234
v_sub_f32 v154, v154, v234
v_sub_f32 v203, v203, v234
v_sub_f32 v139, v139, v234
v_sub_f32 v155, v155, v234
v_lshlrev_b32 v242, 16, v184
v_and_b32 v248, 0xffff0000, v184
v_mul_f32 v242, v242, v238
v_mul_f32 v248, v248, v238
v_cvt_pk_bf16_f32 v184, v242, v248
v_lshlrev_b32 v242, 16, v185
v_and_b32 v248, 0xffff0000, v185
v_mul_f32 v242, v242, v238
v_mul_f32 v248, v248, v238
v_cvt_pk_bf16_f32 v185, v242, v248
v_lshlrev_b32 v242, 16, v186
v_and_b32 v248, 0xffff0000, v186
v_mul_f32 v242, v242, v238
v_mul_f32 v248, v248, v238
v_cvt_pk_bf16_f32 v186, v242, v248
v_lshlrev_b32 v242, 16, v187
v_and_b32 v248, 0xffff0000, v187
v_mul_f32 v242, v242, v238
v_mul_f32 v248, v248, v238
v_cvt_pk_bf16_f32 v187, v242, v248
v_lshlrev_b32 v242, 16, v168
v_and_b32 v248, 0xffff0000, v168
v_mul_f32 v242, v242, v238
v_mul_f32 v248, v248, v238
v_cvt_pk_bf16_f32 v168, v242, v248
v_lshlrev_b32 v242, 16, v169
v_and_b32 v248, 0xffff0000, v169
v_mul_f32 v242, v242, v238
v_mul_f32 v248, v248, v238
v_cvt_pk_bf16_f32 v169, v242, v248
ds_read_b64 v[250:251], v231 offset:2048
s_waitcnt lgkmcnt(0)
v_lshlrev_b32 v242, 16, v250
v_and_b32 v248, 0xffff0000, v250
v_mul_f32 v242, v242, v238
v_mul_f32 v248, v248, v238
v_cvt_pk_bf16_f32 v250, v242, v248
v_lshlrev_b32 v242, 16, v251
v_and_b32 v248, 0xffff0000, v251
v_mul_f32 v242, v242, v238
v_mul_f32 v248, v248, v238
v_cvt_pk_bf16_f32 v251, v242, v248
ds_write_b64 v231, v[250:251] offset:2048
s_waitcnt lgkmcnt(0)
ds_read_b64 v[250:251], v231 offset:2056
s_waitcnt lgkmcnt(0)
v_lshlrev_b32 v242, 16, v250
v_and_b32 v248, 0xffff0000, v250
v_mul_f32 v242, v242, v238
v_mul_f32 v248, v248, v238
v_cvt_pk_bf16_f32 v250, v242, v248
v_lshlrev_b32 v242, 16, v251
v_and_b32 v248, 0xffff0000, v251
v_mul_f32 v242, v242, v238
v_mul_f32 v248, v248, v238
v_cvt_pk_bf16_f32 v251, v242, v248
ds_write_b64 v231, v[250:251] offset:2056
s_waitcnt lgkmcnt(0)
ds_read_b64 v[250:251], v231 offset:6144
s_waitcnt lgkmcnt(0)
v_lshlrev_b32 v242, 16, v250
v_and_b32 v248, 0xffff0000, v250
v_mul_f32 v242, v242, v238
v_mul_f32 v248, v248, v238
v_cvt_pk_bf16_f32 v250, v242, v248
v_lshlrev_b32 v242, 16, v251
v_and_b32 v248, 0xffff0000, v251
v_mul_f32 v242, v242, v238
v_mul_f32 v248, v248, v238
v_cvt_pk_bf16_f32 v251, v242, v248
ds_write_b64 v231, v[250:251] offset:6144
s_waitcnt lgkmcnt(0)
ds_read_b64 v[250:251], v231 offset:6152
s_waitcnt lgkmcnt(0)
v_lshlrev_b32 v242, 16, v250
v_and_b32 v248, 0xffff0000, v250
v_mul_f32 v242, v242, v238
v_mul_f32 v248, v248, v238
v_cvt_pk_bf16_f32 v250, v242, v248
v_lshlrev_b32 v242, 16, v251
v_and_b32 v248, 0xffff0000, v251
v_mul_f32 v242, v242, v238
v_mul_f32 v248, v248, v238
v_cvt_pk_bf16_f32 v251, v242, v248
ds_write_b64 v231, v[250:251] offset:6152
s_waitcnt lgkmcnt(0)
v_exp_f32 v248, v156
s_nop 0
v_sub_f32 v227, v227, v248
v_exp_f32 v248, v157
s_nop 0
v_sub_f32 v227, v227, v248
v_exp_f32 v248, v158
s_nop 0
v_sub_f32 v227, v227, v248
v_exp_f32 v248, v159
s_nop 0
v_sub_f32 v227, v227, v248
v_max_f32 v227, 0, v227
v_min_f32 v227, s32, v227
v_log_f32 v248, v227
v_max3_f32 v235, v156, v157, v158
v_max3_f32 v235, v235, v159, v248
v_mov_b32 v248, v235
s_nop 1
v_permlane32_swap_b32 v235, v248
s_nop 1
v_max_f32 v235, v235, v248
v_mov_b32 v248, v235
s_nop 1
v_permlane16_swap_b32 v235, v248
s_nop 1
v_max_f32 v235, v235, v248
v_ceil_f32 v235, v235
v_max_f32 v235, 0, v235
v_sub_f32 v248, 0, v235
v_exp_f32 v239, v248
s_nop 1
v_mul_f32 v227, v227, v239
v_sub_f32 v204, v204, v235
v_sub_f32 v140, v140, v235
v_sub_f32 v156, v156, v235
v_sub_f32 v205, v205, v235
v_sub_f32 v141, v141, v235
v_sub_f32 v157, v157, v235
v_sub_f32 v206, v206, v235
v_sub_f32 v142, v142, v235
v_sub_f32 v158, v158, v235
v_sub_f32 v207, v207, v235
v_sub_f32 v143, v143, v235
v_sub_f32 v159, v159, v235
v_lshlrev_b32 v242, 16, v188
v_and_b32 v248, 0xffff0000, v188
v_mul_f32 v242, v242, v239
v_mul_f32 v248, v248, v239
v_cvt_pk_bf16_f32 v188, v242, v248
v_lshlrev_b32 v242, 16, v189
v_and_b32 v248, 0xffff0000, v189
v_mul_f32 v242, v242, v239
v_mul_f32 v248, v248, v239
v_cvt_pk_bf16_f32 v189, v242, v248
v_lshlrev_b32 v242, 16, v190
v_and_b32 v248, 0xffff0000, v190
v_mul_f32 v242, v242, v239
v_mul_f32 v248, v248, v239
v_cvt_pk_bf16_f32 v190, v242, v248
v_lshlrev_b32 v242, 16, v191
v_and_b32 v248, 0xffff0000, v191
v_mul_f32 v242, v242, v239
v_mul_f32 v248, v248, v239
v_cvt_pk_bf16_f32 v191, v242, v248
v_lshlrev_b32 v242, 16, v172
v_and_b32 v248, 0xffff0000, v172
v_mul_f32 v242, v242, v239
v_mul_f32 v248, v248, v239
v_cvt_pk_bf16_f32 v172, v242, v248
v_lshlrev_b32 v242, 16, v173
v_and_b32 v248, 0xffff0000, v173
v_mul_f32 v242, v242, v239
v_mul_f32 v248, v248, v239
v_cvt_pk_bf16_f32 v173, v242, v248
ds_read_b64 v[250:251], v231 offset:3072
s_waitcnt lgkmcnt(0)
v_lshlrev_b32 v242, 16, v250
v_and_b32 v248, 0xffff0000, v250
v_mul_f32 v242, v242, v239
v_mul_f32 v248, v248, v239
v_cvt_pk_bf16_f32 v250, v242, v248
v_lshlrev_b32 v242, 16, v251
v_and_b32 v248, 0xffff0000, v251
v_mul_f32 v242, v242, v239
v_mul_f32 v248, v248, v239
v_cvt_pk_bf16_f32 v251, v242, v248
ds_write_b64 v231, v[250:251] offset:3072
s_waitcnt lgkmcnt(0)
ds_read_b64 v[250:251], v231 offset:3080
s_waitcnt lgkmcnt(0)
v_lshlrev_b32 v242, 16, v250
v_and_b32 v248, 0xffff0000, v250
v_mul_f32 v242, v242, v239
v_mul_f32 v248, v248, v239
v_cvt_pk_bf16_f32 v250, v242, v248
v_lshlrev_b32 v242, 16, v251
v_and_b32 v248, 0xffff0000, v251
v_mul_f32 v242, v242, v239
v_mul_f32 v248, v248, v239
v_cvt_pk_bf16_f32 v251, v242, v248
ds_write_b64 v231, v[250:251] offset:3080
s_waitcnt lgkmcnt(0)
ds_read_b64 v[250:251], v231 offset:7168
s_waitcnt lgkmcnt(0)
v_lshlrev_b32 v242, 16, v250
v_and_b32 v248, 0xffff0000, v250
v_mul_f32 v242, v242, v239
v_mul_f32 v248, v248, v239
v_cvt_pk_bf16_f32 v250, v242, v248
v_lshlrev_b32 v242, 16, v251
v_and_b32 v248, 0xffff0000, v251
v_mul_f32 v242, v242, v239
v_mul_f32 v248, v248, v239
v_cvt_pk_bf16_f32 v251, v242, v248
ds_write_b64 v231, v[250:251] offset:7168
s_waitcnt lgkmcnt(0)
ds_read_b64 v[250:251], v231 offset:7176
s_waitcnt lgkmcnt(0)
v_lshlrev_b32 v242, 16, v250
v_and_b32 v248, 0xffff0000, v250
v_mul_f32 v242, v242, v239
v_mul_f32 v248, v248, v239
v_cvt_pk_bf16_f32 v250, v242, v248
v_lshlrev_b32 v242, 16, v251
v_and_b32 v248, 0xffff0000, v251
v_mul_f32 v242, v242, v239
v_mul_f32 v248, v248, v239
v_cvt_pk_bf16_f32 v251, v242, v248
ds_write_b64 v231, v[250:251] offset:7176
s_waitcnt lgkmcnt(0)
v_exp_f32 v232, v144
v_exp_f32 v233, v145
v_exp_f32 v234, v146
v_exp_f32 v235, v147
s_nop 1
v_add_f32 v224, v224, v232
v_add_f32 v224, v224, v233
v_add_f32 v224, v224, v234
v_add_f32 v224, v224, v235
v_cvt_pk_bf16_f32 v162, v232, v233
v_cvt_pk_bf16_f32 v163, v234, v235
v_exp_f32 v232, v148
v_exp_f32 v233, v149
v_exp_f32 v234, v150
v_exp_f32 v235, v151
s_nop 1
v_add_f32 v225, v225, v232
v_add_f32 v225, v225, v233
v_add_f32 v225, v225, v234
v_add_f32 v225, v225, v235
v_cvt_pk_bf16_f32 v166, v232, v233
v_cvt_pk_bf16_f32 v167, v234, v235
v_exp_f32 v232, v152
v_exp_f32 v233, v153
v_exp_f32 v234, v154
v_exp_f32 v235, v155
s_nop 1
v_add_f32 v226, v226, v232
v_add_f32 v226, v226, v233
v_add_f32 v226, v226, v234
v_add_f32 v226, v226, v235
v_cvt_pk_bf16_f32 v170, v232, v233
v_cvt_pk_bf16_f32 v171, v234, v235
v_exp_f32 v232, v156
v_exp_f32 v233, v157
v_exp_f32 v234, v158
v_exp_f32 v235, v159
s_nop 1
v_add_f32 v227, v227, v232
v_add_f32 v227, v227, v233
v_add_f32 v227, v227, v234
v_add_f32 v227, v227, v235
v_cvt_pk_bf16_f32 v174, v232, v233
v_cvt_pk_bf16_f32 v175, v234, v235
s_branch L2_rare_common
L2_rare_site10:
s_mov_b32 s36, 10
s_branch L2_rare_t1_4_0
L2_rare_t1_4_0:
s_nop 15
s_nop 15
s_waitcnt lgkmcnt(0)
v_exp_f32 v248, v128
s_nop 0
v_sub_f32 v224, v224, v248
v_exp_f32 v248, v129
s_nop 0
v_sub_f32 v224, v224, v248
v_exp_f32 v248, v130
s_nop 0
v_sub_f32 v224, v224, v248
v_exp_f32 v248, v131
s_nop 0
v_sub_f32 v224, v224, v248
v_max_f32 v224, 0, v224
v_min_f32 v224, s32, v224
v_log_f32 v248, v224
v_max3_f32 v232, v128, v129, v130
v_max3_f32 v232, v232, v131, v248
v_mov_b32 v248, v232
s_nop 1
v_permlane32_swap_b32 v232, v248
s_nop 1
v_max_f32 v232, v232, v248
v_mov_b32 v248, v232
s_nop 1
v_permlane16_swap_b32 v232, v248
s_nop 1
v_max_f32 v232, v232, v248
v_ceil_f32 v232, v232
v_max_f32 v232, 0, v232
v_sub_f32 v248, 0, v232
v_exp_f32 v236, v248
s_nop 1
v_mul_f32 v224, v224, v236
v_sub_f32 v192, v192, v232
v_sub_f32 v128, v128, v232
v_sub_f32 v144, v144, v232
v_sub_f32 v193, v193, v232
v_sub_f32 v129, v129, v232
v_sub_f32 v145, v145, v232
v_sub_f32 v194, v194, v232
v_sub_f32 v130, v130, v232
v_sub_f32 v146, v146, v232
v_sub_f32 v195, v195, v232
v_sub_f32 v131, v131, v232
v_sub_f32 v147, v147, v232
v_lshlrev_b32 v242, 16, v4
v_and_b32 v248, 0xffff0000, v4
v_mul_f32 v242, v242, v236
v_mul_f32 v248, v248, v236
v_cvt_pk_bf16_f32 v4, v242, v248
v_lshlrev_b32 v242, 16, v5
v_and_b32 v248, 0xffff0000, v5
v_mul_f32 v242, v242, v236
v_mul_f32 v248, v248, v236
v_cvt_pk_bf16_f32 v5, v242, v248
v_lshlrev_b32 v242, 16, v6
v_and_b32 v248, 0xffff0000, v6
v_mul_f32 v242, v242, v236
v_mul_f32 v248, v248, v236
v_cvt_pk_bf16_f32 v6, v242, v248
v_lshlrev_b32 v242, 16, v7
v_and_b32 v248, 0xffff0000, v7
v_mul_f32 v242, v242, v236
v_mul_f32 v248, v248, v236
v_cvt_pk_bf16_f32 v7, v242, v248
v_lshlrev_b32 v242, 16, v8
v_and_b32 v248, 0xffff0000, v8
v_mul_f32 v242, v242, v236
v_mul_f32 v248, v248, v236
v_cvt_pk_bf16_f32 v8, v242, v248
v_lshlrev_b32 v242, 16, v9
v_and_b32 v248, 0xffff0000, v9
v_mul_f32 v242, v242, v236
v_mul_f32 v248, v248, v236
v_cvt_pk_bf16_f32 v9, v242, v248
v_lshlrev_b32 v242, 16, v10
v_and_b32 v248, 0xffff0000, v10
v_mul_f32 v242, v242, v236
v_mul_f32 v248, v248, v236
v_cvt_pk_bf16_f32 v10, v242, v248
v_lshlrev_b32 v242, 16, v11
v_and_b32 v248, 0xffff0000, v11
v_mul_f32 v242, v242, v236
v_mul_f32 v248, v248, v236
v_cvt_pk_bf16_f32 v11, v242, v248
v_lshlrev_b32 v242, 16, v176
v_and_b32 v248, 0xffff0000, v176
v_mul_f32 v242, v242, v236
v_mul_f32 v248, v248, v236
v_cvt_pk_bf16_f32 v176, v242, v248
v_lshlrev_b32 v242, 16, v177
v_and_b32 v248, 0xffff0000, v177
v_mul_f32 v242, v242, v236
v_mul_f32 v248, v248, v236
v_cvt_pk_bf16_f32 v177, v242, v248
v_lshlrev_b32 v242, 16, v178
v_and_b32 v248, 0xffff0000, v178
v_mul_f32 v242, v242, v236
v_mul_f32 v248, v248, v236
v_cvt_pk_bf16_f32 v178, v242, v248
v_lshlrev_b32 v242, 16, v179
v_and_b32 v248, 0xffff0000, v179
v_mul_f32 v242, v242, v236
v_mul_f32 v248, v248, v236
v_cvt_pk_bf16_f32 v179, v242, v248
v_lshlrev_b32 v242, 16, v160
v_and_b32 v248, 0xffff0000, v160
v_mul_f32 v242, v242, v236
v_mul_f32 v248, v248, v236
v_cvt_pk_bf16_f32 v160, v242, v248
v_lshlrev_b32 v242, 16, v161
v_and_b32 v248, 0xffff0000, v161
v_mul_f32 v242, v242, v236
v_mul_f32 v248, v248, v236
v_cvt_pk_bf16_f32 v161, v242, v248
v_lshlrev_b32 v242, 16, v162
v_and_b32 v248, 0xffff0000, v162
v_mul_f32 v242, v242, v236
v_mul_f32 v248, v248, v236
v_cvt_pk_bf16_f32 v162, v242, v248
v_lshlrev_b32 v242, 16, v163
v_and_b32 v248, 0xffff0000, v163
v_mul_f32 v242, v242, v236
v_mul_f32 v248, v248, v236
v_cvt_pk_bf16_f32 v163, v242, v248
v_exp_f32 v248, v132
s_nop 0
v_sub_f32 v225, v225, v248
v_exp_f32 v248, v133
s_nop 0
v_sub_f32 v225, v225, v248
v_exp_f32 v248, v134
s_nop 0
v_sub_f32 v225, v225, v248
v_exp_f32 v248, v135
s_nop 0
v_sub_f32 v225, v225, v248
v_max_f32 v225, 0, v225
v_min_f32 v225, s32, v225
v_log_f32 v248, v225
v_max3_f32 v233, v132, v133, v134
v_max3_f32 v233, v233, v135, v248
v_mov_b32 v248, v233
s_nop 1
v_permlane32_swap_b32 v233, v248
s_nop 1
v_max_f32 v233, v233, v248
v_mov_b32 v248, v233
s_nop 1
v_permlane16_swap_b32 v233, v248
s_nop 1
v_max_f32 v233, v233, v248
v_ceil_f32 v233, v233
v_max_f32 v233, 0, v233
v_sub_f32 v248, 0, v233
v_exp_f32 v237, v248
s_nop 1
v_mul_f32 v225, v225, v237
v_sub_f32 v196, v196, v233
v_sub_f32 v132, v132, v233
v_sub_f32 v148, v148, v233
v_sub_f32 v197, v197, v233
v_sub_f32 v133, v133, v233
v_sub_f32 v149, v149, v233
v_sub_f32 v198, v198, v233
v_sub_f32 v134, v134, v233
v_sub_f32 v150, v150, v233
v_sub_f32 v199, v199, v233
v_sub_f32 v135, v135, v233
v_sub_f32 v151, v151, v233
v_lshlrev_b32 v242, 16, v36
v_and_b32 v248, 0xffff0000, v36
v_mul_f32 v242, v242, v237
v_mul_f32 v248, v248, v237
v_cvt_pk_bf16_f32 v36, v242, v248
v_lshlrev_b32 v242, 16, v37
v_and_b32 v248, 0xffff0000, v37
v_mul_f32 v242, v242, v237
v_mul_f32 v248, v248, v237
v_cvt_pk_bf16_f32 v37, v242, v248
v_lshlrev_b32 v242, 16, v38
v_and_b32 v248, 0xffff0000, v38
v_mul_f32 v242, v242, v237
v_mul_f32 v248, v248, v237
v_cvt_pk_bf16_f32 v38, v242, v248
v_lshlrev_b32 v242, 16, v39
v_and_b32 v248, 0xffff0000, v39
v_mul_f32 v242, v242, v237
v_mul_f32 v248, v248, v237
v_cvt_pk_bf16_f32 v39, v242, v248
v_lshlrev_b32 v242, 16, v40
v_and_b32 v248, 0xffff0000, v40
v_mul_f32 v242, v242, v237
v_mul_f32 v248, v248, v237
v_cvt_pk_bf16_f32 v40, v242, v248
v_lshlrev_b32 v242, 16, v41
v_and_b32 v248, 0xffff0000, v41
v_mul_f32 v242, v242, v237
v_mul_f32 v248, v248, v237
v_cvt_pk_bf16_f32 v41, v242, v248
v_lshlrev_b32 v242, 16, v42
v_and_b32 v248, 0xffff0000, v42
v_mul_f32 v242, v242, v237
v_mul_f32 v248, v248, v237
v_cvt_pk_bf16_f32 v42, v242, v248
v_lshlrev_b32 v242, 16, v43
v_and_b32 v248, 0xffff0000, v43
v_mul_f32 v242, v242, v237
v_mul_f32 v248, v248, v237
v_cvt_pk_bf16_f32 v43, v242, v248
v_lshlrev_b32 v242, 16, v180
v_and_b32 v248, 0xffff0000, v180
v_mul_f32 v242, v242, v237
v_mul_f32 v248, v248, v237
v_cvt_pk_bf16_f32 v180, v242, v248
v_lshlrev_b32 v242, 16, v181
v_and_b32 v248, 0xffff0000, v181
v_mul_f32 v242, v242, v237
v_mul_f32 v248, v248, v237
v_cvt_pk_bf16_f32 v181, v242, v248
v_lshlrev_b32 v242, 16, v182
v_and_b32 v248, 0xffff0000, v182
v_mul_f32 v242, v242, v237
v_mul_f32 v248, v248, v237
v_cvt_pk_bf16_f32 v182, v242, v248
v_lshlrev_b32 v242, 16, v183
v_and_b32 v248, 0xffff0000, v183
v_mul_f32 v242, v242, v237
v_mul_f32 v248, v248, v237
v_cvt_pk_bf16_f32 v183, v242, v248
v_lshlrev_b32 v242, 16, v164
v_and_b32 v248, 0xffff0000, v164
v_mul_f32 v242, v242, v237
v_mul_f32 v248, v248, v237
v_cvt_pk_bf16_f32 v164, v242, v248
v_lshlrev_b32 v242, 16, v165
v_and_b32 v248, 0xffff0000, v165
v_mul_f32 v242, v242, v237
v_mul_f32 v248, v248, v237
v_cvt_pk_bf16_f32 v165, v242, v248
v_lshlrev_b32 v242, 16, v166
v_and_b32 v248, 0xffff0000, v166
v_mul_f32 v242, v242, v237
v_mul_f32 v248, v248, v237
v_cvt_pk_bf16_f32 v166, v242, v248
v_lshlrev_b32 v242, 16, v167
v_and_b32 v248, 0xffff0000, v167
v_mul_f32 v242, v242, v237
v_mul_f32 v248, v248, v237
v_cvt_pk_bf16_f32 v167, v242, v248
v_exp_f32 v248, v136
s_nop 0
v_sub_f32 v226, v226, v248
v_exp_f32 v248, v137
s_nop 0
v_sub_f32 v226, v226, v248
v_exp_f32 v248, v138
s_nop 0
v_sub_f32 v226, v226, v248
v_exp_f32 v248, v139
s_nop 0
v_sub_f32 v226, v226, v248
v_max_f32 v226, 0, v226
v_min_f32 v226, s32, v226
v_log_f32 v248, v226
v_max3_f32 v234, v136, v137, v138
v_max3_f32 v234, v234, v139, v248
v_mov_b32 v248, v234
s_nop 1
v_permlane32_swap_b32 v234, v248
s_nop 1
v_max_f32 v234, v234, v248
v_mov_b32 v248, v234
s_nop 1
v_permlane16_swap_b32 v234, v248
s_nop 1
v_max_f32 v234, v234, v248
v_ceil_f32 v234, v234
v_max_f32 v234, 0, v234
v_sub_f32 v248, 0, v234
v_exp_f32 v238, v248
s_nop 1
v_mul_f32 v226, v226, v238
v_sub_f32 v200, v200, v234
v_sub_f32 v136, v136, v234
v_sub_f32 v152, v152, v234
v_sub_f32 v201, v201, v234
v_sub_f32 v137, v137, v234
v_sub_f32 v153, v153, v234
v_sub_f32 v202, v202, v234
v_sub_f32 v138, v138, v234
v_sub_f32 v154, v154, v234
v_sub_f32 v203, v203, v234
v_sub_f32 v139, v139, v234
v_sub_f32 v155, v155, v234
v_lshlrev_b32 v242, 16, v68
v_and_b32 v248, 0xffff0000, v68
v_mul_f32 v242, v242, v238
v_mul_f32 v248, v248, v238
v_cvt_pk_bf16_f32 v68, v242, v248
v_lshlrev_b32 v242, 16, v69
v_and_b32 v248, 0xffff0000, v69
v_mul_f32 v242, v242, v238
v_mul_f32 v248, v248, v238
v_cvt_pk_bf16_f32 v69, v242, v248
v_lshlrev_b32 v242, 16, v70
v_and_b32 v248, 0xffff0000, v70
v_mul_f32 v242, v242, v238
v_mul_f32 v248, v248, v238
v_cvt_pk_bf16_f32 v70, v242, v248
v_lshlrev_b32 v242, 16, v71
v_and_b32 v248, 0xffff0000, v71
v_mul_f32 v242, v242, v238
v_mul_f32 v248, v248, v238
v_cvt_pk_bf16_f32 v71, v242, v248
v_lshlrev_b32 v242, 16, v72
v_and_b32 v248, 0xffff0000, v72
v_mul_f32 v242, v242, v238
v_mul_f32 v248, v248, v238
v_cvt_pk_bf16_f32 v72, v242, v248
v_lshlrev_b32 v242, 16, v73
v_and_b32 v248, 0xffff0000, v73
v_mul_f32 v242, v242, v238
v_mul_f32 v248, v248, v238
v_cvt_pk_bf16_f32 v73, v242, v248
v_lshlrev_b32 v242, 16, v74
v_and_b32 v248, 0xffff0000, v74
v_mul_f32 v242, v242, v238
v_mul_f32 v248, v248, v238
v_cvt_pk_bf16_f32 v74, v242, v248
v_lshlrev_b32 v242, 16, v75
v_and_b32 v248, 0xffff0000, v75
v_mul_f32 v242, v242, v238
v_mul_f32 v248, v248, v238
v_cvt_pk_bf16_f32 v75, v242, v248
v_lshlrev_b32 v242, 16, v184
v_and_b32 v248, 0xffff0000, v184
v_mul_f32 v242, v242, v238
v_mul_f32 v248, v248, v238
v_cvt_pk_bf16_f32 v184, v242, v248
v_lshlrev_b32 v242, 16, v185
v_and_b32 v248, 0xffff0000, v185
v_mul_f32 v242, v242, v238
v_mul_f32 v248, v248, v238
v_cvt_pk_bf16_f32 v185, v242, v248
v_lshlrev_b32 v242, 16, v186
v_and_b32 v248, 0xffff0000, v186
v_mul_f32 v242, v242, v238
v_mul_f32 v248, v248, v238
v_cvt_pk_bf16_f32 v186, v242, v248
v_lshlrev_b32 v242, 16, v187
v_and_b32 v248, 0xffff0000, v187
v_mul_f32 v242, v242, v238
v_mul_f32 v248, v248, v238
v_cvt_pk_bf16_f32 v187, v242, v248
v_lshlrev_b32 v242, 16, v168
v_and_b32 v248, 0xffff0000, v168
v_mul_f32 v242, v242, v238
v_mul_f32 v248, v248, v238
v_cvt_pk_bf16_f32 v168, v242, v248
v_lshlrev_b32 v242, 16, v169
v_and_b32 v248, 0xffff0000, v169
v_mul_f32 v242, v242, v238
v_mul_f32 v248, v248, v238
v_cvt_pk_bf16_f32 v169, v242, v248
v_lshlrev_b32 v242, 16, v170
v_and_b32 v248, 0xffff0000, v170
v_mul_f32 v242, v242, v238
v_mul_f32 v248, v248, v238
v_cvt_pk_bf16_f32 v170, v242, v248
v_lshlrev_b32 v242, 16, v171
v_and_b32 v248, 0xffff0000, v171
v_mul_f32 v242, v242, v238
v_mul_f32 v248, v248, v238
v_cvt_pk_bf16_f32 v171, v242, v248
v_exp_f32 v248, v140
s_nop 0
v_sub_f32 v227, v227, v248
v_exp_f32 v248, v141
s_nop 0
v_sub_f32 v227, v227, v248
v_exp_f32 v248, v142
s_nop 0
v_sub_f32 v227, v227, v248
v_exp_f32 v248, v143
s_nop 0
v_sub_f32 v227, v227, v248
v_max_f32 v227, 0, v227
v_min_f32 v227, s32, v227
v_log_f32 v248, v227
v_max3_f32 v235, v140, v141, v142
v_max3_f32 v235, v235, v143, v248
v_mov_b32 v248, v235
s_nop 1
v_permlane32_swap_b32 v235, v248
s_nop 1
v_max_f32 v235, v235, v248
v_mov_b32 v248, v235
s_nop 1
v_permlane16_swap_b32 v235, v248
s_nop 1
v_max_f32 v235, v235, v248
v_ceil_f32 v235, v235
v_max_f32 v235, 0, v235
v_sub_f32 v248, 0, v235
v_exp_f32 v239, v248
s_nop 1
v_mul_f32 v227, v227, v239
v_sub_f32 v204, v204, v235
v_sub_f32 v140, v140, v235
v_sub_f32 v156, v156, v235
v_sub_f32 v205, v205, v235
v_sub_f32 v141, v141, v235
v_sub_f32 v157, v157, v235
v_sub_f32 v206, v206, v235
v_sub_f32 v142, v142, v235
v_sub_f32 v158, v158, v235
v_sub_f32 v207, v207, v235
v_sub_f32 v143, v143, v235
v_sub_f32 v159, v159, v235
v_lshlrev_b32 v242, 16, v100
v_and_b32 v248, 0xffff0000, v100
v_mul_f32 v242, v242, v239
v_mul_f32 v248, v248, v239
v_cvt_pk_bf16_f32 v100, v242, v248
v_lshlrev_b32 v242, 16, v101
v_and_b32 v248, 0xffff0000, v101
v_mul_f32 v242, v242, v239
v_mul_f32 v248, v248, v239
v_cvt_pk_bf16_f32 v101, v242, v248
v_lshlrev_b32 v242, 16, v102
v_and_b32 v248, 0xffff0000, v102
v_mul_f32 v242, v242, v239
v_mul_f32 v248, v248, v239
v_cvt_pk_bf16_f32 v102, v242, v248
v_lshlrev_b32 v242, 16, v103
v_and_b32 v248, 0xffff0000, v103
v_mul_f32 v242, v242, v239
v_mul_f32 v248, v248, v239
v_cvt_pk_bf16_f32 v103, v242, v248
v_lshlrev_b32 v242, 16, v104
v_and_b32 v248, 0xffff0000, v104
v_mul_f32 v242, v242, v239
v_mul_f32 v248, v248, v239
v_cvt_pk_bf16_f32 v104, v242, v248
v_lshlrev_b32 v242, 16, v105
v_and_b32 v248, 0xffff0000, v105
v_mul_f32 v242, v242, v239
v_mul_f32 v248, v248, v239
v_cvt_pk_bf16_f32 v105, v242, v248
v_lshlrev_b32 v242, 16, v106
v_and_b32 v248, 0xffff0000, v106
v_mul_f32 v242, v242, v239
v_mul_f32 v248, v248, v239
v_cvt_pk_bf16_f32 v106, v242, v248
v_lshlrev_b32 v242, 16, v107
v_and_b32 v248, 0xffff0000, v107
v_mul_f32 v242, v242, v239
v_mul_f32 v248, v248, v239
v_cvt_pk_bf16_f32 v107, v242, v248
v_lshlrev_b32 v242, 16, v188
v_and_b32 v248, 0xffff0000, v188
v_mul_f32 v242, v242, v239
v_mul_f32 v248, v248, v239
v_cvt_pk_bf16_f32 v188, v242, v248
v_lshlrev_b32 v242, 16, v189
v_and_b32 v248, 0xffff0000, v189
v_mul_f32 v242, v242, v239
v_mul_f32 v248, v248, v239
v_cvt_pk_bf16_f32 v189, v242, v248
v_lshlrev_b32 v242, 16, v190
v_and_b32 v248, 0xffff0000, v190
v_mul_f32 v242, v242, v239
v_mul_f32 v248, v248, v239
v_cvt_pk_bf16_f32 v190, v242, v248
v_lshlrev_b32 v242, 16, v191
v_and_b32 v248, 0xffff0000, v191
v_mul_f32 v242, v242, v239
v_mul_f32 v248, v248, v239
v_cvt_pk_bf16_f32 v191, v242, v248
v_lshlrev_b32 v242, 16, v172
v_and_b32 v248, 0xffff0000, v172
v_mul_f32 v242, v242, v239
v_mul_f32 v248, v248, v239
v_cvt_pk_bf16_f32 v172, v242, v248
v_lshlrev_b32 v242, 16, v173
v_and_b32 v248, 0xffff0000, v173
v_mul_f32 v242, v242, v239
v_mul_f32 v248, v248, v239
v_cvt_pk_bf16_f32 v173, v242, v248
v_lshlrev_b32 v242, 16, v174
v_and_b32 v248, 0xffff0000, v174
v_mul_f32 v242, v242, v239
v_mul_f32 v248, v248, v239
v_cvt_pk_bf16_f32 v174, v242, v248
v_lshlrev_b32 v242, 16, v175
v_and_b32 v248, 0xffff0000, v175
v_mul_f32 v242, v242, v239
v_mul_f32 v248, v248, v239
v_cvt_pk_bf16_f32 v175, v242, v248
v_exp_f32 v232, v128
v_exp_f32 v233, v129
v_exp_f32 v234, v130
v_exp_f32 v235, v131
s_nop 1
v_add_f32 v224, v224, v232
v_add_f32 v224, v224, v233
v_add_f32 v224, v224, v234
v_add_f32 v224, v224, v235
v_cvt_pk_bf16_f32 v0, v232, v233
v_cvt_pk_bf16_f32 v1, v234, v235
v_exp_f32 v232, v132
v_exp_f32 v233, v133
v_exp_f32 v234, v134
v_exp_f32 v235, v135
s_nop 1
v_add_f32 v225, v225, v232
v_add_f32 v225, v225, v233
v_add_f32 v225, v225, v234
v_add_f32 v225, v225, v235
v_cvt_pk_bf16_f32 v32, v232, v233
v_cvt_pk_bf16_f32 v33, v234, v235
v_exp_f32 v232, v136
v_exp_f32 v233, v137
v_exp_f32 v234, v138
v_exp_f32 v235, v139
s_nop 1
v_add_f32 v226, v226, v232
v_add_f32 v226, v226, v233
v_add_f32 v226, v226, v234
v_add_f32 v226, v226, v235
v_cvt_pk_bf16_f32 v64, v232, v233
v_cvt_pk_bf16_f32 v65, v234, v235
v_exp_f32 v232, v140
v_exp_f32 v233, v141
v_exp_f32 v234, v142
v_exp_f32 v235, v143
s_nop 1
v_add_f32 v227, v227, v232
v_add_f32 v227, v227, v233
v_add_f32 v227, v227, v234
v_add_f32 v227, v227, v235
v_cvt_pk_bf16_f32 v96, v232, v233
v_cvt_pk_bf16_f32 v97, v234, v235
s_branch L2_rare_common
L2_rare_site11:
s_mov_b32 s36, 11
s_branch L2_rare_t1_5_1
L2_rare_t1_5_1:
s_nop 15
s_nop 15
s_waitcnt lgkmcnt(0)
v_exp_f32 v248, v144
s_nop 0
v_sub_f32 v224, v224, v248
v_exp_f32 v248, v145
s_nop 0
v_sub_f32 v224, v224, v248
v_exp_f32 v248, v146
s_nop 0
v_sub_f32 v224, v224, v248
v_exp_f32 v248, v147
s_nop 0
v_sub_f32 v224, v224, v248
v_max_f32 v224, 0, v224
v_min_f32 v224, s32, v224
v_log_f32 v248, v224
v_max3_f32 v232, v144, v145, v146
v_max3_f32 v232, v232, v147, v248
v_mov_b32 v248, v232
s_nop 1
v_permlane32_swap_b32 v232, v248
s_nop 1
v_max_f32 v232, v232, v248
v_mov_b32 v248, v232
s_nop 1
v_permlane16_swap_b32 v232, v248
s_nop 1
v_max_f32 v232, v232, v248
v_ceil_f32 v232, v232
v_max_f32 v232, 0, v232
v_sub_f32 v248, 0, v232
v_exp_f32 v236, v248
s_nop 1
v_mul_f32 v224, v224, v236
v_sub_f32 v192, v192, v232
v_sub_f32 v128, v128, v232
v_sub_f32 v144, v144, v232
v_sub_f32 v193, v193, v232
v_sub_f32 v129, v129, v232
v_sub_f32 v145, v145, v232
v_sub_f32 v194, v194, v232
v_sub_f32 v130, v130, v232
v_sub_f32 v146, v146, v232
v_sub_f32 v195, v195, v232
v_sub_f32 v131, v131, v232
v_sub_f32 v147, v147, v232
v_lshlrev_b32 v242, 16, v4
v_and_b32 v248, 0xffff0000, v4
v_mul_f32 v242, v242, v236
v_mul_f32 v248, v248, v236
v_cvt_pk_bf16_f32 v4, v242, v248
v_lshlrev_b32 v242, 16, v5
v_and_b32 v248, 0xffff0000, v5
v_mul_f32 v242, v242, v236
v_mul_f32 v248, v248, v236
v_cvt_pk_bf16_f32 v5, v242, v248
v_lshlrev_b32 v242, 16, v6
v_and_b32 v248, 0xffff0000, v6
v_mul_f32 v242, v242, v236
v_mul_f32 v248, v248, v236
v_cvt_pk_bf16_f32 v6, v242, v248
v_lshlrev_b32 v242, 16, v7
v_and_b32 v248, 0xffff0000, v7
v_mul_f32 v242, v242, v236
v_mul_f32 v248, v248, v236
v_cvt_pk_bf16_f32 v7, v242, v248
v_lshlrev_b32 v242, 16, v8
v_and_b32 v248, 0xffff0000, v8
v_mul_f32 v242, v242, v236
v_mul_f32 v248, v248, v236
v_cvt_pk_bf16_f32 v8, v242, v248
v_lshlrev_b32 v242, 16, v9
v_and_b32 v248, 0xffff0000, v9
v_mul_f32 v242, v242, v236
v_mul_f32 v248, v248, v236
v_cvt_pk_bf16_f32 v9, v242, v248
v_lshlrev_b32 v242, 16, v10
v_and_b32 v248, 0xffff0000, v10
v_mul_f32 v242, v242, v236
v_mul_f32 v248, v248, v236
v_cvt_pk_bf16_f32 v10, v242, v248
v_lshlrev_b32 v242, 16, v11
v_and_b32 v248, 0xffff0000, v11
v_mul_f32 v242, v242, v236
v_mul_f32 v248, v248, v236
v_cvt_pk_bf16_f32 v11, v242, v248
v_lshlrev_b32 v242, 16, v176
v_and_b32 v248, 0xffff0000, v176
v_mul_f32 v242, v242, v236
v_mul_f32 v248, v248, v236
v_cvt_pk_bf16_f32 v176, v242, v248
v_lshlrev_b32 v242, 16, v177
v_and_b32 v248, 0xffff0000, v177
v_mul_f32 v242, v242, v236
v_mul_f32 v248, v248, v236
v_cvt_pk_bf16_f32 v177, v242, v248
v_lshlrev_b32 v242, 16, v178
v_and_b32 v248, 0xffff0000, v178
v_mul_f32 v242, v242, v236
v_mul_f32 v248, v248, v236
v_cvt_pk_bf16_f32 v178, v242, v248
v_lshlrev_b32 v242, 16, v179
v_and_b32 v248, 0xffff0000, v179
v_mul_f32 v242, v242, v236
v_mul_f32 v248, v248, v236
v_cvt_pk_bf16_f32 v179, v242, v248
v_lshlrev_b32 v242, 16, v160
v_and_b32 v248, 0xffff0000, v160
v_mul_f32 v242, v242, v236
v_mul_f32 v248, v248, v236
v_cvt_pk_bf16_f32 v160, v242, v248
v_lshlrev_b32 v242, 16, v161
v_and_b32 v248, 0xffff0000, v161
v_mul_f32 v242, v242, v236
v_mul_f32 v248, v248, v236
v_cvt_pk_bf16_f32 v161, v242, v248
v_lshlrev_b32 v242, 16, v162
v_and_b32 v248, 0xffff0000, v162
v_mul_f32 v242, v242, v236
v_mul_f32 v248, v248, v236
v_cvt_pk_bf16_f32 v162, v242, v248
v_lshlrev_b32 v242, 16, v163
v_and_b32 v248, 0xffff0000, v163
v_mul_f32 v242, v242, v236
v_mul_f32 v248, v248, v236
v_cvt_pk_bf16_f32 v163, v242, v248
v_lshlrev_b32 v242, 16, v0
v_and_b32 v248, 0xffff0000, v0
v_mul_f32 v242, v242, v236
v_mul_f32 v248, v248, v236
v_cvt_pk_bf16_f32 v0, v242, v248
v_lshlrev_b32 v242, 16, v1
v_and_b32 v248, 0xffff0000, v1
v_mul_f32 v242, v242, v236
v_mul_f32 v248, v248, v236
v_cvt_pk_bf16_f32 v1, v242, v248
v_exp_f32 v248, v148
s_nop 0
v_sub_f32 v225, v225, v248
v_exp_f32 v248, v149
s_nop 0
v_sub_f32 v225, v225, v248
v_exp_f32 v248, v150
s_nop 0
v_sub_f32 v225, v225, v248
v_exp_f32 v248, v151
s_nop 0
v_sub_f32 v225, v225, v248
v_max_f32 v225, 0, v225
v_min_f32 v225, s32, v225
v_log_f32 v248, v225
v_max3_f32 v233, v148, v149, v150
v_max3_f32 v233, v233, v151, v248
v_mov_b32 v248, v233
s_nop 1
v_permlane32_swap_b32 v233, v248
s_nop 1
v_max_f32 v233, v233, v248
v_mov_b32 v248, v233
s_nop 1
v_permlane16_swap_b32 v233, v248
s_nop 1
v_max_f32 v233, v233, v248
v_ceil_f32 v233, v233
v_max_f32 v233, 0, v233
v_sub_f32 v248, 0, v233
v_exp_f32 v237, v248
s_nop 1
v_mul_f32 v225, v225, v237
v_sub_f32 v196, v196, v233
v_sub_f32 v132, v132, v233
v_sub_f32 v148, v148, v233
v_sub_f32 v197, v197, v233
v_sub_f32 v133, v133, v233
v_sub_f32 v149, v149, v233
v_sub_f32 v198, v198, v233
v_sub_f32 v134, v134, v233
v_sub_f32 v150, v150, v233
v_sub_f32 v199, v199, v233
v_sub_f32 v135, v135, v233
v_sub_f32 v151, v151, v233
v_lshlrev_b32 v242, 16, v36
v_and_b32 v248, 0xffff0000, v36
v_mul_f32 v242, v242, v237
v_mul_f32 v248, v248, v237
v_cvt_pk_bf16_f32 v36, v242, v248
v_lshlrev_b32 v242, 16, v37
v_and_b32 v248, 0xffff0000, v37
v_mul_f32 v242, v242, v237
v_mul_f32 v248, v248, v237
v_cvt_pk_bf16_f32 v37, v242, v248
v_lshlrev_b32 v242, 16, v38
v_and_b32 v248, 0xffff0000, v38
v_mul_f32 v242, v242, v237
v_mul_f32 v248, v248, v237
v_cvt_pk_bf16_f32 v38, v242, v248
v_lshlrev_b32 v242, 16, v39
v_and_b32 v248, 0xffff0000, v39
v_mul_f32 v242, v242, v237
v_mul_f32 v248, v248, v237
v_cvt_pk_bf16_f32 v39, v242, v248
v_lshlrev_b32 v242, 16, v40
v_and_b32 v248, 0xffff0000, v40
v_mul_f32 v242, v242, v237
v_mul_f32 v248, v248, v237
v_cvt_pk_bf16_f32 v40, v242, v248
v_lshlrev_b32 v242, 16, v41
v_and_b32 v248, 0xffff0000, v41
v_mul_f32 v242, v242, v237
v_mul_f32 v248, v248, v237
v_cvt_pk_bf16_f32 v41, v242, v248
v_lshlrev_b32 v242, 16, v42
v_and_b32 v248, 0xffff0000, v42
v_mul_f32 v242, v242, v237
v_mul_f32 v248, v248, v237
v_cvt_pk_bf16_f32 v42, v242, v248
v_lshlrev_b32 v242, 16, v43
v_and_b32 v248, 0xffff0000, v43
v_mul_f32 v242, v242, v237
v_mul_f32 v248, v248, v237
v_cvt_pk_bf16_f32 v43, v242, v248
v_lshlrev_b32 v242, 16, v180
v_and_b32 v248, 0xffff0000, v180
v_mul_f32 v242, v242, v237
v_mul_f32 v248, v248, v237
v_cvt_pk_bf16_f32 v180, v242, v248
v_lshlrev_b32 v242, 16, v181
v_and_b32 v248, 0xffff0000, v181
v_mul_f32 v242, v242, v237
v_mul_f32 v248, v248, v237
v_cvt_pk_bf16_f32 v181, v242, v248
v_lshlrev_b32 v242, 16, v182
v_and_b32 v248, 0xffff0000, v182
v_mul_f32 v242, v242, v237
v_mul_f32 v248, v248, v237
v_cvt_pk_bf16_f32 v182, v242, v248
v_lshlrev_b32 v242, 16, v183
v_and_b32 v248, 0xffff0000, v183
v_mul_f32 v242, v242, v237
v_mul_f32 v248, v248, v237
v_cvt_pk_bf16_f32 v183, v242, v248
v_lshlrev_b32 v242, 16, v164
v_and_b32 v248, 0xffff0000, v164
v_mul_f32 v242, v242, v237
v_mul_f32 v248, v248, v237
v_cvt_pk_bf16_f32 v164, v242, v248
v_lshlrev_b32 v242, 16, v165
v_and_b32 v248, 0xffff0000, v165
v_mul_f32 v242, v242, v237
v_mul_f32 v248, v248, v237
v_cvt_pk_bf16_f32 v165, v242, v248
v_lshlrev_b32 v242, 16, v166
v_and_b32 v248, 0xffff0000, v166
v_mul_f32 v242, v242, v237
v_mul_f32 v248, v248, v237
v_cvt_pk_bf16_f32 v166, v242, v248
v_lshlrev_b32 v242, 16, v167
v_and_b32 v248, 0xffff0000, v167
v_mul_f32 v242, v242, v237
v_mul_f32 v248, v248, v237
v_cvt_pk_bf16_f32 v167, v242, v248
v_lshlrev_b32 v242, 16, v32
v_and_b32 v248, 0xffff0000, v32
v_mul_f32 v242, v242, v237
v_mul_f32 v248, v248, v237
v_cvt_pk_bf16_f32 v32, v242, v248
v_lshlrev_b32 v242, 16, v33
v_and_b32 v248, 0xffff0000, v33
v_mul_f32 v242, v242, v237
v_mul_f32 v248, v248, v237
v_cvt_pk_bf16_f32 v33, v242, v248
v_exp_f32 v248, v152
s_nop 0
v_sub_f32 v226, v226, v248
v_exp_f32 v248, v153
s_nop 0
v_sub_f32 v226, v226, v248
v_exp_f32 v248, v154
s_nop 0
v_sub_f32 v226, v226, v248
v_exp_f32 v248, v155
s_nop 0
v_sub_f32 v226, v226, v248
v_max_f32 v226, 0, v226
v_min_f32 v226, s32, v226
v_log_f32 v248, v226
v_max3_f32 v234, v152, v153, v154
v_max3_f32 v234, v234, v155, v248
v_mov_b32 v248, v234
s_nop 1
v_permlane32_swap_b32 v234, v248
s_nop 1
v_max_f32 v234, v234, v248
v_mov_b32 v248, v234
s_nop 1
v_permlane16_swap_b32 v234, v248
s_nop 1
v_max_f32 v234, v234, v248
v_ceil_f32 v234, v234
v_max_f32 v234, 0, v234
v_sub_f32 v248, 0, v234
v_exp_f32 v238, v248
s_nop 1
v_mul_f32 v226, v226, v238
v_sub_f32 v200, v200, v234
v_sub_f32 v136, v136, v234
v_sub_f32 v152, v152, v234
v_sub_f32 v201, v201, v234
v_sub_f32 v137, v137, v234
v_sub_f32 v153, v153, v234
v_sub_f32 v202, v202, v234
v_sub_f32 v138, v138, v234
v_sub_f32 v154, v154, v234
v_sub_f32 v203, v203, v234
v_sub_f32 v139, v139, v234
v_sub_f32 v155, v155, v234
v_lshlrev_b32 v242, 16, v68
v_and_b32 v248, 0xffff0000, v68
v_mul_f32 v242, v242, v238
v_mul_f32 v248, v248, v238
v_cvt_pk_bf16_f32 v68, v242, v248
v_lshlrev_b32 v242, 16, v69
v_and_b32 v248, 0xffff0000, v69
v_mul_f32 v242, v242, v238
v_mul_f32 v248, v248, v238
v_cvt_pk_bf16_f32 v69, v242, v248
v_lshlrev_b32 v242, 16, v70
v_and_b32 v248, 0xffff0000, v70
v_mul_f32 v242, v242, v238
v_mul_f32 v248, v248, v238
v_cvt_pk_bf16_f32 v70, v242, v248
v_lshlrev_b32 v242, 16, v71
v_and_b32 v248, 0xffff0000, v71
v_mul_f32 v242, v242, v238
v_mul_f32 v248, v248, v238
v_cvt_pk_bf16_f32 v71, v242, v248
v_lshlrev_b32 v242, 16, v72
v_and_b32 v248, 0xffff0000, v72
v_mul_f32 v242, v242, v238
v_mul_f32 v248, v248, v238
v_cvt_pk_bf16_f32 v72, v242, v248
v_lshlrev_b32 v242, 16, v73
v_and_b32 v248, 0xffff0000, v73
v_mul_f32 v242, v242, v238
v_mul_f32 v248, v248, v238
v_cvt_pk_bf16_f32 v73, v242, v248
v_lshlrev_b32 v242, 16, v74
v_and_b32 v248, 0xffff0000, v74
v_mul_f32 v242, v242, v238
v_mul_f32 v248, v248, v238
v_cvt_pk_bf16_f32 v74, v242, v248
v_lshlrev_b32 v242, 16, v75
v_and_b32 v248, 0xffff0000, v75
v_mul_f32 v242, v242, v238
v_mul_f32 v248, v248, v238
v_cvt_pk_bf16_f32 v75, v242, v248
v_lshlrev_b32 v242, 16, v184
v_and_b32 v248, 0xffff0000, v184
v_mul_f32 v242, v242, v238
v_mul_f32 v248, v248, v238
v_cvt_pk_bf16_f32 v184, v242, v248
v_lshlrev_b32 v242, 16, v185
v_and_b32 v248, 0xffff0000, v185
v_mul_f32 v242, v242, v238
v_mul_f32 v248, v248, v238
v_cvt_pk_bf16_f32 v185, v242, v248
v_lshlrev_b32 v242, 16, v186
v_and_b32 v248, 0xffff0000, v186
v_mul_f32 v242, v242, v238
v_mul_f32 v248, v248, v238
v_cvt_pk_bf16_f32 v186, v242, v248
v_lshlrev_b32 v242, 16, v187
v_and_b32 v248, 0xffff0000, v187
v_mul_f32 v242, v242, v238
v_mul_f32 v248, v248, v238
v_cvt_pk_bf16_f32 v187, v242, v248
v_lshlrev_b32 v242, 16, v168
v_and_b32 v248, 0xffff0000, v168
v_mul_f32 v242, v242, v238
v_mul_f32 v248, v248, v238
v_cvt_pk_bf16_f32 v168, v242, v248
v_lshlrev_b32 v242, 16, v169
v_and_b32 v248, 0xffff0000, v169
v_mul_f32 v242, v242, v238
v_mul_f32 v248, v248, v238
v_cvt_pk_bf16_f32 v169, v242, v248
v_lshlrev_b32 v242, 16, v170
v_and_b32 v248, 0xffff0000, v170
v_mul_f32 v242, v242, v238
v_mul_f32 v248, v248, v238
v_cvt_pk_bf16_f32 v170, v242, v248
v_lshlrev_b32 v242, 16, v171
v_and_b32 v248, 0xffff0000, v171
v_mul_f32 v242, v242, v238
v_mul_f32 v248, v248, v238
v_cvt_pk_bf16_f32 v171, v242, v248
v_lshlrev_b32 v242, 16, v64
v_and_b32 v248, 0xffff0000, v64
v_mul_f32 v242, v242, v238
v_mul_f32 v248, v248, v238
v_cvt_pk_bf16_f32 v64, v242, v248
v_lshlrev_b32 v242, 16, v65
v_and_b32 v248, 0xffff0000, v65
v_mul_f32 v242, v242, v238
v_mul_f32 v248, v248, v238
v_cvt_pk_bf16_f32 v65, v242, v248
v_exp_f32 v248, v156
s_nop 0
v_sub_f32 v227, v227, v248
v_exp_f32 v248, v157
s_nop 0
v_sub_f32 v227, v227, v248
v_exp_f32 v248, v158
s_nop 0
v_sub_f32 v227, v227, v248
v_exp_f32 v248, v159
s_nop 0
v_sub_f32 v227, v227, v248
v_max_f32 v227, 0, v227
v_min_f32 v227, s32, v227
v_log_f32 v248, v227
v_max3_f32 v235, v156, v157, v158
v_max3_f32 v235, v235, v159, v248
v_mov_b32 v248, v235
s_nop 1
v_permlane32_swap_b32 v235, v248
s_nop 1
v_max_f32 v235, v235, v248
v_mov_b32 v248, v235
s_nop 1
v_permlane16_swap_b32 v235, v248
s_nop 1
v_max_f32 v235, v235, v248
v_ceil_f32 v235, v235
v_max_f32 v235, 0, v235
v_sub_f32 v248, 0, v235
v_exp_f32 v239, v248
s_nop 1
v_mul_f32 v227, v227, v239
v_sub_f32 v204, v204, v235
v_sub_f32 v140, v140, v235
v_sub_f32 v156, v156, v235
v_sub_f32 v205, v205, v235
v_sub_f32 v141, v141, v235
v_sub_f32 v157, v157, v235
v_sub_f32 v206, v206, v235
v_sub_f32 v142, v142, v235
v_sub_f32 v158, v158, v235
v_sub_f32 v207, v207, v235
v_sub_f32 v143, v143, v235
v_sub_f32 v159, v159, v235
v_lshlrev_b32 v242, 16, v100
v_and_b32 v248, 0xffff0000, v100
v_mul_f32 v242, v242, v239
v_mul_f32 v248, v248, v239
v_cvt_pk_bf16_f32 v100, v242, v248
v_lshlrev_b32 v242, 16, v101
v_and_b32 v248, 0xffff0000, v101
v_mul_f32 v242, v242, v239
v_mul_f32 v248, v248, v239
v_cvt_pk_bf16_f32 v101, v242, v248
v_lshlrev_b32 v242, 16, v102
v_and_b32 v248, 0xffff0000, v102
v_mul_f32 v242, v242, v239
v_mul_f32 v248, v248, v239
v_cvt_pk_bf16_f32 v102, v242, v248
v_lshlrev_b32 v242, 16, v103
v_and_b32 v248, 0xffff0000, v103
v_mul_f32 v242, v242, v239
v_mul_f32 v248, v248, v239
v_cvt_pk_bf16_f32 v103, v242, v248
v_lshlrev_b32 v242, 16, v104
v_and_b32 v248, 0xffff0000, v104
v_mul_f32 v242, v242, v239
v_mul_f32 v248, v248, v239
v_cvt_pk_bf16_f32 v104, v242, v248
v_lshlrev_b32 v242, 16, v105
v_and_b32 v248, 0xffff0000, v105
v_mul_f32 v242, v242, v239
v_mul_f32 v248, v248, v239
v_cvt_pk_bf16_f32 v105, v242, v248
v_lshlrev_b32 v242, 16, v106
v_and_b32 v248, 0xffff0000, v106
v_mul_f32 v242, v242, v239
v_mul_f32 v248, v248, v239
v_cvt_pk_bf16_f32 v106, v242, v248
v_lshlrev_b32 v242, 16, v107
v_and_b32 v248, 0xffff0000, v107
v_mul_f32 v242, v242, v239
v_mul_f32 v248, v248, v239
v_cvt_pk_bf16_f32 v107, v242, v248
v_lshlrev_b32 v242, 16, v188
v_and_b32 v248, 0xffff0000, v188
v_mul_f32 v242, v242, v239
v_mul_f32 v248, v248, v239
v_cvt_pk_bf16_f32 v188, v242, v248
v_lshlrev_b32 v242, 16, v189
v_and_b32 v248, 0xffff0000, v189
v_mul_f32 v242, v242, v239
v_mul_f32 v248, v248, v239
v_cvt_pk_bf16_f32 v189, v242, v248
v_lshlrev_b32 v242, 16, v190
v_and_b32 v248, 0xffff0000, v190
v_mul_f32 v242, v242, v239
v_mul_f32 v248, v248, v239
v_cvt_pk_bf16_f32 v190, v242, v248
v_lshlrev_b32 v242, 16, v191
v_and_b32 v248, 0xffff0000, v191
v_mul_f32 v242, v242, v239
v_mul_f32 v248, v248, v239
v_cvt_pk_bf16_f32 v191, v242, v248
v_lshlrev_b32 v242, 16, v172
v_and_b32 v248, 0xffff0000, v172
v_mul_f32 v242, v242, v239
v_mul_f32 v248, v248, v239
v_cvt_pk_bf16_f32 v172, v242, v248
v_lshlrev_b32 v242, 16, v173
v_and_b32 v248, 0xffff0000, v173
v_mul_f32 v242, v242, v239
v_mul_f32 v248, v248, v239
v_cvt_pk_bf16_f32 v173, v242, v248
v_lshlrev_b32 v242, 16, v174
v_and_b32 v248, 0xffff0000, v174
v_mul_f32 v242, v242, v239
v_mul_f32 v248, v248, v239
v_cvt_pk_bf16_f32 v174, v242, v248
v_lshlrev_b32 v242, 16, v175
v_and_b32 v248, 0xffff0000, v175
v_mul_f32 v242, v242, v239
v_mul_f32 v248, v248, v239
v_cvt_pk_bf16_f32 v175, v242, v248
v_lshlrev_b32 v242, 16, v96
v_and_b32 v248, 0xffff0000, v96
v_mul_f32 v242, v242, v239
v_mul_f32 v248, v248, v239
v_cvt_pk_bf16_f32 v96, v242, v248
v_lshlrev_b32 v242, 16, v97
v_and_b32 v248, 0xffff0000, v97
v_mul_f32 v242, v242, v239
v_mul_f32 v248, v248, v239
v_cvt_pk_bf16_f32 v97, v242, v248
v_exp_f32 v232, v144
v_exp_f32 v233, v145
v_exp_f32 v234, v146
v_exp_f32 v235, v147
s_nop 1
v_add_f32 v224, v224, v232
v_add_f32 v224, v224, v233
v_add_f32 v224, v224, v234
v_add_f32 v224, v224, v235
v_cvt_pk_bf16_f32 v2, v232, v233
v_cvt_pk_bf16_f32 v3, v234, v235
v_exp_f32 v232, v148
v_exp_f32 v233, v149
v_exp_f32 v234, v150
v_exp_f32 v235, v151
s_nop 1
v_add_f32 v225, v225, v232
v_add_f32 v225, v225, v233
v_add_f32 v225, v225, v234
v_add_f32 v225, v225, v235
v_cvt_pk_bf16_f32 v34, v232, v233
v_cvt_pk_bf16_f32 v35, v234, v235
v_exp_f32 v232, v152
v_exp_f32 v233, v153
v_exp_f32 v234, v154
v_exp_f32 v235, v155
s_nop 1
v_add_f32 v226, v226, v232
v_add_f32 v226, v226, v233
v_add_f32 v226, v226, v234
v_add_f32 v226, v226, v235
v_cvt_pk_bf16_f32 v66, v232, v233
v_cvt_pk_bf16_f32 v67, v234, v235
v_exp_f32 v232, v156
v_exp_f32 v233, v157
v_exp_f32 v234, v158
v_exp_f32 v235, v159
s_nop 1
v_add_f32 v227, v227, v232
v_add_f32 v227, v227, v233
v_add_f32 v227, v227, v234
v_add_f32 v227, v227, v235
v_cvt_pk_bf16_f32 v98, v232, v233
v_cvt_pk_bf16_f32 v99, v234, v235
s_branch L2_rare_common
LF_hl_1:
s_mov_b32 s94, 0x10000
s_mov_b32 s3, 0x7c28000
LF_hl2_1:
v_lshlrev_b32 v241, 3, v243
buffer_load_dwordx2 v[240:241], v241, s[16:19], s3 offen sc1
s_sub_u32 s94, s94, 1
s_waitcnt vmcnt(0)
s_cbranch_scc1 LF_hlret_1
v_cmp_ne_u64_e64 s[38:39], s[98:99], v[240:241]
s_and_b64 s[38:39], s[38:39], s[96:97]
s_cbranch_scc1 LF_hl2_1
s_branch LF_hlret_1
L2_rare_site12:
s_mov_b32 s36, 12
s_branch L2_rare_t0_0_0
L2_rare_t0_0_0:
s_nop 15
s_nop 15
s_waitcnt lgkmcnt(0)
v_exp_f32 v248, v128
s_nop 0
v_sub_f32 v224, v224, v248
v_exp_f32 v248, v129
s_nop 0
v_sub_f32 v224, v224, v248
v_exp_f32 v248, v130
s_nop 0
v_sub_f32 v224, v224, v248
v_exp_f32 v248, v131
s_nop 0
v_sub_f32 v224, v224, v248
v_max_f32 v224, 0, v224
v_min_f32 v224, s32, v224
v_log_f32 v248, v224
v_max3_f32 v232, v128, v129, v130
v_max3_f32 v232, v232, v131, v248
v_mov_b32 v248, v232
s_nop 1
v_permlane32_swap_b32 v232, v248
s_nop 1
v_max_f32 v232, v232, v248
v_mov_b32 v248, v232
s_nop 1
v_permlane16_swap_b32 v232, v248
s_nop 1
v_max_f32 v232, v232, v248
v_ceil_f32 v232, v232
v_max_f32 v232, 0, v232
v_sub_f32 v248, 0, v232
v_exp_f32 v236, v248
s_nop 1
v_mul_f32 v224, v224, v236
v_sub_f32 v192, v192, v232
v_sub_f32 v128, v128, v232
v_sub_f32 v144, v144, v232
v_sub_f32 v193, v193, v232
v_sub_f32 v129, v129, v232
v_sub_f32 v145, v145, v232
v_sub_f32 v194, v194, v232
v_sub_f32 v130, v130, v232
v_sub_f32 v146, v146, v232
v_sub_f32 v195, v195, v232
v_sub_f32 v131, v131, v232
v_sub_f32 v147, v147, v232
v_lshlrev_b32 v242, 16, v176
v_and_b32 v248, 0xffff0000, v176
v_mul_f32 v242, v242, v236
v_mul_f32 v248, v248, v236
v_cvt_pk_bf16_f32 v176, v242, v248
v_lshlrev_b32 v242, 16, v177
v_and_b32 v248, 0xffff0000, v177
v_mul_f32 v242, v242, v236
v_mul_f32 v248, v248, v236
v_cvt_pk_bf16_f32 v177, v242, v248
v_lshlrev_b32 v242, 16, v178
v_and_b32 v248, 0xffff0000, v178
v_mul_f32 v242, v242, v236
v_mul_f32 v248, v248, v236
v_cvt_pk_bf16_f32 v178, v242, v248
v_lshlrev_b32 v242, 16, v179
v_and_b32 v248, 0xffff0000, v179
v_mul_f32 v242, v242, v236
v_mul_f32 v248, v248, v236
v_cvt_pk_bf16_f32 v179, v242, v248
ds_read_b64 v[250:251], v231 offset:0
s_waitcnt lgkmcnt(0)
v_lshlrev_b32 v242, 16, v250
v_and_b32 v248, 0xffff0000, v250
v_mul_f32 v242, v242, v236
v_mul_f32 v248, v248, v236
v_cvt_pk_bf16_f32 v250, v242, v248
v_lshlrev_b32 v242, 16, v251
v_and_b32 v248, 0xffff0000, v251
v_mul_f32 v242, v242, v236
v_mul_f32 v248, v248, v236
v_cvt_pk_bf16_f32 v251, v242, v248
ds_write_b64 v231, v[250:251] offset:0
s_waitcnt lgkmcnt(0)
ds_read_b64 v[250:251], v231 offset:8
s_waitcnt lgkmcnt(0)
v_lshlrev_b32 v242, 16, v250
v_and_b32 v248, 0xffff0000, v250
v_mul_f32 v242, v242, v236
v_mul_f32 v248, v248, v236
v_cvt_pk_bf16_f32 v250, v242, v248
v_lshlrev_b32 v242, 16, v251
v_and_b32 v248, 0xffff0000, v251
v_mul_f32 v242, v242, v236
v_mul_f32 v248, v248, v236
v_cvt_pk_bf16_f32 v251, v242, v248
ds_write_b64 v231, v[250:251] offset:8
s_waitcnt lgkmcnt(0)
v_exp_f32 v248, v132
s_nop 0
v_sub_f32 v225, v225, v248
v_exp_f32 v248, v133
s_nop 0
v_sub_f32 v225, v225, v248
v_exp_f32 v248, v134
s_nop 0
v_sub_f32 v225, v225, v248
v_exp_f32 v248, v135
s_nop 0
v_sub_f32 v225, v225, v248
v_max_f32 v225, 0, v225
v_min_f32 v225, s32, v225
v_log_f32 v248, v225
v_max3_f32 v233, v132, v133, v134
v_max3_f32 v233, v233, v135, v248
v_mov_b32 v248, v233
s_nop 1
v_permlane32_swap_b32 v233, v248
s_nop 1
v_max_f32 v233, v233, v248
v_mov_b32 v248, v233
s_nop 1
v_permlane16_swap_b32 v233, v248
s_nop 1
v_max_f32 v233, v233, v248
v_ceil_f32 v233, v233
v_max_f32 v233, 0, v233
v_sub_f32 v248, 0, v233
v_exp_f32 v237, v248
s_nop 1
v_mul_f32 v225, v225, v237
v_sub_f32 v196, v196, v233
v_sub_f32 v132, v132, v233
v_sub_f32 v148, v148, v233
v_sub_f32 v197, v197, v233
v_sub_f32 v133, v133, v233
v_sub_f32 v149, v149, v233
v_sub_f32 v198, v198, v233
v_sub_f32 v134, v134, v233
v_sub_f32 v150, v150, v233
v_sub_f32 v199, v199, v233
v_sub_f32 v135, v135, v233
v_sub_f32 v151, v151, v233
v_lshlrev_b32 v242, 16, v180
v_and_b32 v248, 0xffff0000, v180
v_mul_f32 v242, v242, v237
v_mul_f32 v248, v248, v237
v_cvt_pk_bf16_f32 v180, v242, v248
v_lshlrev_b32 v242, 16, v181
v_and_b32 v248, 0xffff0000, v181
v_mul_f32 v242, v242, v237
v_mul_f32 v248, v248, v237
v_cvt_pk_bf16_f32 v181, v242, v248
v_lshlrev_b32 v242, 16, v182
v_and_b32 v248, 0xffff0000, v182
v_mul_f32 v242, v242, v237
v_mul_f32 v248, v248, v237
v_cvt_pk_bf16_f32 v182, v242, v248
v_lshlrev_b32 v242, 16, v183
v_and_b32 v248, 0xffff0000, v183
v_mul_f32 v242, v242, v237
v_mul_f32 v248, v248, v237
v_cvt_pk_bf16_f32 v183, v242, v248
ds_read_b64 v[250:251], v231 offset:1024
s_waitcnt lgkmcnt(0)
v_lshlrev_b32 v242, 16, v250
v_and_b32 v248, 0xffff0000, v250
v_mul_f32 v242, v242, v237
v_mul_f32 v248, v248, v237
v_cvt_pk_bf16_f32 v250, v242, v248
v_lshlrev_b32 v242, 16, v251
v_and_b32 v248, 0xffff0000, v251
v_mul_f32 v242, v242, v237
v_mul_f32 v248, v248, v237
v_cvt_pk_bf16_f32 v251, v242, v248
ds_write_b64 v231, v[250:251] offset:1024
s_waitcnt lgkmcnt(0)
ds_read_b64 v[250:251], v231 offset:1032
s_waitcnt lgkmcnt(0)
v_lshlrev_b32 v242, 16, v250
v_and_b32 v248, 0xffff0000, v250
v_mul_f32 v242, v242, v237
v_mul_f32 v248, v248, v237
v_cvt_pk_bf16_f32 v250, v242, v248
v_lshlrev_b32 v242, 16, v251
v_and_b32 v248, 0xffff0000, v251
v_mul_f32 v242, v242, v237
v_mul_f32 v248, v248, v237
v_cvt_pk_bf16_f32 v251, v242, v248
ds_write_b64 v231, v[250:251] offset:1032
s_waitcnt lgkmcnt(0)
v_exp_f32 v248, v136
s_nop 0
v_sub_f32 v226, v226, v248
v_exp_f32 v248, v137
s_nop 0
v_sub_f32 v226, v226, v248
v_exp_f32 v248, v138
s_nop 0
v_sub_f32 v226, v226, v248
v_exp_f32 v248, v139
s_nop 0
v_sub_f32 v226, v226, v248
v_max_f32 v226, 0, v226
v_min_f32 v226, s32, v226
v_log_f32 v248, v226
v_max3_f32 v234, v136, v137, v138
v_max3_f32 v234, v234, v139, v248
v_mov_b32 v248, v234
s_nop 1
v_permlane32_swap_b32 v234, v248
s_nop 1
v_max_f32 v234, v234, v248
v_mov_b32 v248, v234
s_nop 1
v_permlane16_swap_b32 v234, v248
s_nop 1
v_max_f32 v234, v234, v248
v_ceil_f32 v234, v234
v_max_f32 v234, 0, v234
v_sub_f32 v248, 0, v234
v_exp_f32 v238, v248
s_nop 1
v_mul_f32 v226, v226, v238
v_sub_f32 v200, v200, v234
v_sub_f32 v136, v136, v234
v_sub_f32 v152, v152, v234
v_sub_f32 v201, v201, v234
v_sub_f32 v137, v137, v234
v_sub_f32 v153, v153, v234
v_sub_f32 v202, v202, v234
v_sub_f32 v138, v138, v234
v_sub_f32 v154, v154, v234
v_sub_f32 v203, v203, v234
v_sub_f32 v139, v139, v234
v_sub_f32 v155, v155, v234
v_lshlrev_b32 v242, 16, v184
v_and_b32 v248, 0xffff0000, v184
v_mul_f32 v242, v242, v238
v_mul_f32 v248, v248, v238
v_cvt_pk_bf16_f32 v184, v242, v248
v_lshlrev_b32 v242, 16, v185
v_and_b32 v248, 0xffff0000, v185
v_mul_f32 v242, v242, v238
v_mul_f32 v248, v248, v238
v_cvt_pk_bf16_f32 v185, v242, v248
v_lshlrev_b32 v242, 16, v186
v_and_b32 v248, 0xffff0000, v186
v_mul_f32 v242, v242, v238
v_mul_f32 v248, v248, v238
v_cvt_pk_bf16_f32 v186, v242, v248
v_lshlrev_b32 v242, 16, v187
v_and_b32 v248, 0xffff0000, v187
v_mul_f32 v242, v242, v238
v_mul_f32 v248, v248, v238
v_cvt_pk_bf16_f32 v187, v242, v248
ds_read_b64 v[250:251], v231 offset:2048
s_waitcnt lgkmcnt(0)
v_lshlrev_b32 v242, 16, v250
v_and_b32 v248, 0xffff0000, v250
v_mul_f32 v242, v242, v238
v_mul_f32 v248, v248, v238
v_cvt_pk_bf16_f32 v250, v242, v248
v_lshlrev_b32 v242, 16, v251
v_and_b32 v248, 0xffff0000, v251
v_mul_f32 v242, v242, v238
v_mul_f32 v248, v248, v238
v_cvt_pk_bf16_f32 v251, v242, v248
ds_write_b64 v231, v[250:251] offset:2048
s_waitcnt lgkmcnt(0)
ds_read_b64 v[250:251], v231 offset:2056
s_waitcnt lgkmcnt(0)
v_lshlrev_b32 v242, 16, v250
v_and_b32 v248, 0xffff0000, v250
v_mul_f32 v242, v242, v238
v_mul_f32 v248, v248, v238
v_cvt_pk_bf16_f32 v250, v242, v248
v_lshlrev_b32 v242, 16, v251
v_and_b32 v248, 0xffff0000, v251
v_mul_f32 v242, v242, v238
v_mul_f32 v248, v248, v238
v_cvt_pk_bf16_f32 v251, v242, v248
ds_write_b64 v231, v[250:251] offset:2056
s_waitcnt lgkmcnt(0)
v_exp_f32 v248, v140
s_nop 0
v_sub_f32 v227, v227, v248
v_exp_f32 v248, v141
s_nop 0
v_sub_f32 v227, v227, v248
v_exp_f32 v248, v142
s_nop 0
v_sub_f32 v227, v227, v248
v_exp_f32 v248, v143
s_nop 0
v_sub_f32 v227, v227, v248
v_max_f32 v227, 0, v227
v_min_f32 v227, s32, v227
v_log_f32 v248, v227
v_max3_f32 v235, v140, v141, v142
v_max3_f32 v235, v235, v143, v248
v_mov_b32 v248, v235
s_nop 1
v_permlane32_swap_b32 v235, v248
s_nop 1
v_max_f32 v235, v235, v248
v_mov_b32 v248, v235
s_nop 1
v_permlane16_swap_b32 v235, v248
s_nop 1
v_max_f32 v235, v235, v248
v_ceil_f32 v235, v235
v_max_f32 v235, 0, v235
v_sub_f32 v248, 0, v235
v_exp_f32 v239, v248
s_nop 1
v_mul_f32 v227, v227, v239
v_sub_f32 v204, v204, v235
v_sub_f32 v140, v140, v235
v_sub_f32 v156, v156, v235
v_sub_f32 v205, v205, v235
v_sub_f32 v141, v141, v235
v_sub_f32 v157, v157, v235
v_sub_f32 v206, v206, v235
v_sub_f32 v142, v142, v235
v_sub_f32 v158, v158, v235
v_sub_f32 v207, v207, v235
v_sub_f32 v143, v143, v235
v_sub_f32 v159, v159, v235
v_lshlrev_b32 v242, 16, v188
v_and_b32 v248, 0xffff0000, v188
v_mul_f32 v242, v242, v239
v_mul_f32 v248, v248, v239
v_cvt_pk_bf16_f32 v188, v242, v248
v_lshlrev_b32 v242, 16, v189
v_and_b32 v248, 0xffff0000, v189
v_mul_f32 v242, v242, v239
v_mul_f32 v248, v248, v239
v_cvt_pk_bf16_f32 v189, v242, v248
v_lshlrev_b32 v242, 16, v190
v_and_b32 v248, 0xffff0000, v190
v_mul_f32 v242, v242, v239
v_mul_f32 v248, v248, v239
v_cvt_pk_bf16_f32 v190, v242, v248
v_lshlrev_b32 v242, 16, v191
v_and_b32 v248, 0xffff0000, v191
v_mul_f32 v242, v242, v239
v_mul_f32 v248, v248, v239
v_cvt_pk_bf16_f32 v191, v242, v248
ds_read_b64 v[250:251], v231 offset:3072
s_waitcnt lgkmcnt(0)
v_lshlrev_b32 v242, 16, v250
v_and_b32 v248, 0xffff0000, v250
v_mul_f32 v242, v242, v239
v_mul_f32 v248, v248, v239
v_cvt_pk_bf16_f32 v250, v242, v248
v_lshlrev_b32 v242, 16, v251
v_and_b32 v248, 0xffff0000, v251
v_mul_f32 v242, v242, v239
v_mul_f32 v248, v248, v239
v_cvt_pk_bf16_f32 v251, v242, v248
ds_write_b64 v231, v[250:251] offset:3072
s_waitcnt lgkmcnt(0)
ds_read_b64 v[250:251], v231 offset:3080
s_waitcnt lgkmcnt(0)
v_lshlrev_b32 v242, 16, v250
v_and_b32 v248, 0xffff0000, v250
v_mul_f32 v242, v242, v239
v_mul_f32 v248, v248, v239
v_cvt_pk_bf16_f32 v250, v242, v248
v_lshlrev_b32 v242, 16, v251
v_and_b32 v248, 0xffff0000, v251
v_mul_f32 v242, v242, v239
v_mul_f32 v248, v248, v239
v_cvt_pk_bf16_f32 v251, v242, v248
ds_write_b64 v231, v[250:251] offset:3080
s_waitcnt lgkmcnt(0)
v_exp_f32 v232, v128
v_exp_f32 v233, v129
v_exp_f32 v234, v130
v_exp_f32 v235, v131
s_nop 1
v_add_f32 v224, v224, v232
v_add_f32 v224, v224, v233
v_add_f32 v224, v224, v234
v_add_f32 v224, v224, v235
v_cvt_pk_bf16_f32 v160, v232, v233
v_cvt_pk_bf16_f32 v161, v234, v235
v_exp_f32 v232, v132
v_exp_f32 v233, v133
v_exp_f32 v234, v134
v_exp_f32 v235, v135
s_nop 1
v_add_f32 v225, v225, v232
v_add_f32 v225, v225, v233
v_add_f32 v225, v225, v234
v_add_f32 v225, v225, v235
v_cvt_pk_bf16_f32 v164, v232, v233
v_cvt_pk_bf16_f32 v165, v234, v235
v_exp_f32 v232, v136
v_exp_f32 v233, v137
v_exp_f32 v234, v138
v_exp_f32 v235, v139
s_nop 1
v_add_f32 v226, v226, v232
v_add_f32 v226, v226, v233
v_add_f32 v226, v226, v234
v_add_f32 v226, v226, v235
v_cvt_pk_bf16_f32 v168, v232, v233
v_cvt_pk_bf16_f32 v169, v234, v235
v_exp_f32 v232, v140
v_exp_f32 v233, v141
v_exp_f32 v234, v142
v_exp_f32 v235, v143
s_nop 1
v_add_f32 v227, v227, v232
v_add_f32 v227, v227, v233
v_add_f32 v227, v227, v234
v_add_f32 v227, v227, v235
v_cvt_pk_bf16_f32 v172, v232, v233
v_cvt_pk_bf16_f32 v173, v234, v235
s_branch L2_rare_common
L2_rare_site13:
s_mov_b32 s36, 13
s_branch L2_rare_t0_1_1
L2_rare_t0_1_1:
s_nop 15
s_nop 15
s_waitcnt lgkmcnt(0)
v_exp_f32 v248, v144
s_nop 0
v_sub_f32 v224, v224, v248
v_exp_f32 v248, v145
s_nop 0
v_sub_f32 v224, v224, v248
v_exp_f32 v248, v146
s_nop 0
v_sub_f32 v224, v224, v248
v_exp_f32 v248, v147
s_nop 0
v_sub_f32 v224, v224, v248
v_max_f32 v224, 0, v224
v_min_f32 v224, s32, v224
v_log_f32 v248, v224
v_max3_f32 v232, v144, v145, v146
v_max3_f32 v232, v232, v147, v248
v_mov_b32 v248, v232
s_nop 1
v_permlane32_swap_b32 v232, v248
s_nop 1
v_max_f32 v232, v232, v248
v_mov_b32 v248, v232
s_nop 1
v_permlane16_swap_b32 v232, v248
s_nop 1
v_max_f32 v232, v232, v248
v_ceil_f32 v232, v232
v_max_f32 v232, 0, v232
v_sub_f32 v248, 0, v232
v_exp_f32 v236, v248
s_nop 1
v_mul_f32 v224, v224, v236
v_sub_f32 v192, v192, v232
v_sub_f32 v128, v128, v232
v_sub_f32 v144, v144, v232
v_sub_f32 v193, v193, v232
v_sub_f32 v129, v129, v232
v_sub_f32 v145, v145, v232
v_sub_f32 v194, v194, v232
v_sub_f32 v130, v130, v232
v_sub_f32 v146, v146, v232
v_sub_f32 v195, v195, v232
v_sub_f32 v131, v131, v232
v_sub_f32 v147, v147, v232
v_lshlrev_b32 v242, 16, v160
v_and_b32 v248, 0xffff0000, v160
v_mul_f32 v242, v242, v236
v_mul_f32 v248, v248, v236
v_cvt_pk_bf16_f32 v160, v242, v248
v_lshlrev_b32 v242, 16, v161
v_and_b32 v248, 0xffff0000, v161
v_mul_f32 v242, v242, v236
v_mul_f32 v248, v248, v236
v_cvt_pk_bf16_f32 v161, v242, v248
ds_read_b64 v[250:251], v231 offset:0
s_waitcnt lgkmcnt(0)
v_lshlrev_b32 v242, 16, v250
v_and_b32 v248, 0xffff0000, v250
v_mul_f32 v242, v242, v236
v_mul_f32 v248, v248, v236
v_cvt_pk_bf16_f32 v250, v242, v248
v_lshlrev_b32 v242, 16, v251
v_and_b32 v248, 0xffff0000, v251
v_mul_f32 v242, v242, v236
v_mul_f32 v248, v248, v236
v_cvt_pk_bf16_f32 v251, v242, v248
ds_write_b64 v231, v[250:251] offset:0
s_waitcnt lgkmcnt(0)
ds_read_b64 v[250:251], v231 offset:8
s_waitcnt lgkmcnt(0)
v_lshlrev_b32 v242, 16, v250
v_and_b32 v248, 0xffff0000, v250
v_mul_f32 v242, v242, v236
v_mul_f32 v248, v248, v236
v_cvt_pk_bf16_f32 v250, v242, v248
v_lshlrev_b32 v242, 16, v251
v_and_b32 v248, 0xffff0000, v251
v_mul_f32 v242, v242, v236
v_mul_f32 v248, v248, v236
v_cvt_pk_bf16_f32 v251, v242, v248
ds_write_b64 v231, v[250:251] offset:8
s_waitcnt lgkmcnt(0)
ds_read_b64 v[250:251], v231 offset:4096
s_waitcnt lgkmcnt(0)
v_lshlrev_b32 v242, 16, v250
v_and_b32 v248, 0xffff0000, v250
v_mul_f32 v242, v242, v236
v_mul_f32 v248, v248, v236
v_cvt_pk_bf16_f32 v250, v242, v248
v_lshlrev_b32 v242, 16, v251
v_and_b32 v248, 0xffff0000, v251
v_mul_f32 v242, v242, v236
v_mul_f32 v248, v248, v236
v_cvt_pk_bf16_f32 v251, v242, v248
ds_write_b64 v231, v[250:251] offset:4096
s_waitcnt lgkmcnt(0)
ds_read_b64 v[250:251], v231 offset:4104
s_waitcnt lgkmcnt(0)
v_lshlrev_b32 v242, 16, v250
v_and_b32 v248, 0xffff0000, v250
v_mul_f32 v242, v242, v236
v_mul_f32 v248, v248, v236
v_cvt_pk_bf16_f32 v250, v242, v248
v_lshlrev_b32 v242, 16, v251
v_and_b32 v248, 0xffff0000, v251
v_mul_f32 v242, v242, v236
v_mul_f32 v248, v248, v236
v_cvt_pk_bf16_f32 v251, v242, v248
ds_write_b64 v231, v[250:251] offset:4104
s_waitcnt lgkmcnt(0)
v_exp_f32 v248, v148
s_nop 0
v_sub_f32 v225, v225, v248
v_exp_f32 v248, v149
s_nop 0
v_sub_f32 v225, v225, v248
v_exp_f32 v248, v150
s_nop 0
v_sub_f32 v225, v225, v248
v_exp_f32 v248, v151
s_nop 0
v_sub_f32 v225, v225, v248
v_max_f32 v225, 0, v225
v_min_f32 v225, s32, v225
v_log_f32 v248, v225
v_max3_f32 v233, v148, v149, v150
v_max3_f32 v233, v233, v151, v248
v_mov_b32 v248, v233
s_nop 1
v_permlane32_swap_b32 v233, v248
s_nop 1
v_max_f32 v233, v233, v248
v_mov_b32 v248, v233
s_nop 1
v_permlane16_swap_b32 v233, v248
s_nop 1
v_max_f32 v233, v233, v248
v_ceil_f32 v233, v233
v_max_f32 v233, 0, v233
v_sub_f32 v248, 0, v233
v_exp_f32 v237, v248
s_nop 1
v_mul_f32 v225, v225, v237
v_sub_f32 v196, v196, v233
v_sub_f32 v132, v132, v233
v_sub_f32 v148, v148, v233
v_sub_f32 v197, v197, v233
v_sub_f32 v133, v133, v233
v_sub_f32 v149, v149, v233
v_sub_f32 v198, v198, v233
v_sub_f32 v134, v134, v233
v_sub_f32 v150, v150, v233
v_sub_f32 v199, v199, v233
v_sub_f32 v135, v135, v233
v_sub_f32 v151, v151, v233
v_lshlrev_b32 v242, 16, v164
v_and_b32 v248, 0xffff0000, v164
v_mul_f32 v242, v242, v237
v_mul_f32 v248, v248, v237
v_cvt_pk_bf16_f32 v164, v242, v248
v_lshlrev_b32 v242, 16, v165
v_and_b32 v248, 0xffff0000, v165
v_mul_f32 v242, v242, v237
v_mul_f32 v248, v248, v237
v_cvt_pk_bf16_f32 v165, v242, v248
ds_read_b64 v[250:251], v231 offset:1024
s_waitcnt lgkmcnt(0)
v_lshlrev_b32 v242, 16, v250
v_and_b32 v248, 0xffff0000, v250
v_mul_f32 v242, v242, v237
v_mul_f32 v248, v248, v237
v_cvt_pk_bf16_f32 v250, v242, v248
v_lshlrev_b32 v242, 16, v251
v_and_b32 v248, 0xffff0000, v251
v_mul_f32 v242, v242, v237
v_mul_f32 v248, v248, v237
v_cvt_pk_bf16_f32 v251, v242, v248
ds_write_b64 v231, v[250:251] offset:1024
s_waitcnt lgkmcnt(0)
ds_read_b64 v[250:251], v231 offset:1032
s_waitcnt lgkmcnt(0)
v_lshlrev_b32 v242, 16, v250
v_and_b32 v248, 0xffff0000, v250
v_mul_f32 v242, v242, v237
v_mul_f32 v248, v248, v237
v_cvt_pk_bf16_f32 v250, v242, v248
v_lshlrev_b32 v242, 16, v251
v_and_b32 v248, 0xffff0000, v251
v_mul_f32 v242, v242, v237
v_mul_f32 v248, v248, v237
v_cvt_pk_bf16_f32 v251, v242, v248
ds_write_b64 v231, v[250:251] offset:1032
s_waitcnt lgkmcnt(0)
ds_read_b64 v[250:251], v231 offset:5120
s_waitcnt lgkmcnt(0)
v_lshlrev_b32 v242, 16, v250
v_and_b32 v248, 0xffff0000, v250
v_mul_f32 v242, v242, v237
v_mul_f32 v248, v248, v237
v_cvt_pk_bf16_f32 v250, v242, v248
v_lshlrev_b32 v242, 16, v251
v_and_b32 v248, 0xffff0000, v251
v_mul_f32 v242, v242, v237
v_mul_f32 v248, v248, v237
v_cvt_pk_bf16_f32 v251, v242, v248
ds_write_b64 v231, v[250:251] offset:5120
s_waitcnt lgkmcnt(0)
ds_read_b64 v[250:251], v231 offset:5128
s_waitcnt lgkmcnt(0)
v_lshlrev_b32 v242, 16, v250
v_and_b32 v248, 0xffff0000, v250
v_mul_f32 v242, v242, v237
v_mul_f32 v248, v248, v237
v_cvt_pk_bf16_f32 v250, v242, v248
v_lshlrev_b32 v242, 16, v251
v_and_b32 v248, 0xffff0000, v251
v_mul_f32 v242, v242, v237
v_mul_f32 v248, v248, v237
v_cvt_pk_bf16_f32 v251, v242, v248
ds_write_b64 v231, v[250:251] offset:5128
s_waitcnt lgkmcnt(0)
v_exp_f32 v248, v152
s_nop 0
v_sub_f32 v226, v226, v248
v_exp_f32 v248, v153
s_nop 0
v_sub_f32 v226, v226, v248
v_exp_f32 v248, v154
s_nop 0
v_sub_f32 v226, v226, v248
v_exp_f32 v248, v155
s_nop 0
v_sub_f32 v226, v226, v248
v_max_f32 v226, 0, v226
v_min_f32 v226, s32, v226
v_log_f32 v248, v226
v_max3_f32 v234, v152, v153, v154
v_max3_f32 v234, v234, v155, v248
v_mov_b32 v248, v234
s_nop 1
v_permlane32_swap_b32 v234, v248
s_nop 1
v_max_f32 v234, v234, v248
v_mov_b32 v248, v234
s_nop 1
v_permlane16_swap_b32 v234, v248
s_nop 1
v_max_f32 v234, v234, v248
v_ceil_f32 v234, v234
v_max_f32 v234, 0, v234
v_sub_f32 v248, 0, v234
v_exp_f32 v238, v248
s_nop 1
v_mul_f32 v226, v226, v238
v_sub_f32 v200, v200, v234
v_sub_f32 v136, v136, v234
v_sub_f32 v152, v152, v234
v_sub_f32 v201, v201, v234
v_sub_f32 v137, v137, v234
v_sub_f32 v153, v153, v234
v_sub_f32 v202, v202, v234
v_sub_f32 v138, v138, v234
v_sub_f32 v154, v154, v234
v_sub_f32 v203, v203, v234
v_sub_f32 v139, v139, v234
v_sub_f32 v155, v155, v234
v_lshlrev_b32 v242, 16, v168
v_and_b32 v248, 0xffff0000, v168
v_mul_f32 v242, v242, v238
v_mul_f32 v248, v248, v238
v_cvt_pk_bf16_f32 v168, v242, v248
v_lshlrev_b32 v242, 16, v169
v_and_b32 v248, 0xffff0000, v169
v_mul_f32 v242, v242, v238
v_mul_f32 v248, v248, v238
v_cvt_pk_bf16_f32 v169, v242, v248
ds_read_b64 v[250:251], v231 offset:2048
s_waitcnt lgkmcnt(0)
v_lshlrev_b32 v242, 16, v250
v_and_b32 v248, 0xffff0000, v250
v_mul_f32 v242, v242, v238
v_mul_f32 v248, v248, v238
v_cvt_pk_bf16_f32 v250, v242, v248
v_lshlrev_b32 v242, 16, v251
v_and_b32 v248, 0xffff0000, v251
v_mul_f32 v242, v242, v238
v_mul_f32 v248, v248, v238
v_cvt_pk_bf16_f32 v251, v242, v248
ds_write_b64 v231, v[250:251] offset:2048
s_waitcnt lgkmcnt(0)
ds_read_b64 v[250:251], v231 offset:2056
s_waitcnt lgkmcnt(0)
v_lshlrev_b32 v242, 16, v250
v_and_b32 v248, 0xffff0000, v250
v_mul_f32 v242, v242, v238
v_mul_f32 v248, v248, v238
v_cvt_pk_bf16_f32 v250, v242, v248
v_lshlrev_b32 v242, 16, v251
v_and_b32 v248, 0xffff0000, v251
v_mul_f32 v242, v242, v238
v_mul_f32 v248, v248, v238
v_cvt_pk_bf16_f32 v251, v242, v248
ds_write_b64 v231, v[250:251] offset:2056
s_waitcnt lgkmcnt(0)
ds_read_b64 v[250:251], v231 offset:6144
s_waitcnt lgkmcnt(0)
v_lshlrev_b32 v242, 16, v250
v_and_b32 v248, 0xffff0000, v250
v_mul_f32 v242, v242, v238
v_mul_f32 v248, v248, v238
v_cvt_pk_bf16_f32 v250, v242, v248
v_lshlrev_b32 v242, 16, v251
v_and_b32 v248, 0xffff0000, v251
v_mul_f32 v242, v242, v238
v_mul_f32 v248, v248, v238
v_cvt_pk_bf16_f32 v251, v242, v248
ds_write_b64 v231, v[250:251] offset:6144
s_waitcnt lgkmcnt(0)
ds_read_b64 v[250:251], v231 offset:6152
s_waitcnt lgkmcnt(0)
v_lshlrev_b32 v242, 16, v250
v_and_b32 v248, 0xffff0000, v250
v_mul_f32 v242, v242, v238
v_mul_f32 v248, v248, v238
v_cvt_pk_bf16_f32 v250, v242, v248
v_lshlrev_b32 v242, 16, v251
v_and_b32 v248, 0xffff0000, v251
v_mul_f32 v242, v242, v238
v_mul_f32 v248, v248, v238
v_cvt_pk_bf16_f32 v251, v242, v248
ds_write_b64 v231, v[250:251] offset:6152
s_waitcnt lgkmcnt(0)
v_exp_f32 v248, v156
s_nop 0
v_sub_f32 v227, v227, v248
v_exp_f32 v248, v157
s_nop 0
v_sub_f32 v227, v227, v248
v_exp_f32 v248, v158
s_nop 0
v_sub_f32 v227, v227, v248
v_exp_f32 v248, v159
s_nop 0
v_sub_f32 v227, v227, v248
v_max_f32 v227, 0, v227
v_min_f32 v227, s32, v227
v_log_f32 v248, v227
v_max3_f32 v235, v156, v157, v158
v_max3_f32 v235, v235, v159, v248
v_mov_b32 v248, v235
s_nop 1
v_permlane32_swap_b32 v235, v248
s_nop 1
v_max_f32 v235, v235, v248
v_mov_b32 v248, v235
s_nop 1
v_permlane16_swap_b32 v235, v248
s_nop 1
v_max_f32 v235, v235, v248
v_ceil_f32 v235, v235
v_max_f32 v235, 0, v235
v_sub_f32 v248, 0, v235
v_exp_f32 v239, v248
s_nop 1
v_mul_f32 v227, v227, v239
v_sub_f32 v204, v204, v235
v_sub_f32 v140, v140, v235
v_sub_f32 v156, v156, v235
v_sub_f32 v205, v205, v235
v_sub_f32 v141, v141, v235
v_sub_f32 v157, v157, v235
v_sub_f32 v206, v206, v235
v_sub_f32 v142, v142, v235
v_sub_f32 v158, v158, v235
v_sub_f32 v207, v207, v235
v_sub_f32 v143, v143, v235
v_sub_f32 v159, v159, v235
v_lshlrev_b32 v242, 16, v172
v_and_b32 v248, 0xffff0000, v172
v_mul_f32 v242, v242, v239
v_mul_f32 v248, v248, v239
v_cvt_pk_bf16_f32 v172, v242, v248
v_lshlrev_b32 v242, 16, v173
v_and_b32 v248, 0xffff0000, v173
v_mul_f32 v242, v242, v239
v_mul_f32 v248, v248, v239
v_cvt_pk_bf16_f32 v173, v242, v248
ds_read_b64 v[250:251], v231 offset:3072
s_waitcnt lgkmcnt(0)
v_lshlrev_b32 v242, 16, v250
v_and_b32 v248, 0xffff0000, v250
v_mul_f32 v242, v242, v239
v_mul_f32 v248, v248, v239
v_cvt_pk_bf16_f32 v250, v242, v248
v_lshlrev_b32 v242, 16, v251
v_and_b32 v248, 0xffff0000, v251
v_mul_f32 v242, v242, v239
v_mul_f32 v248, v248, v239
v_cvt_pk_bf16_f32 v251, v242, v248
ds_write_b64 v231, v[250:251] offset:3072
s_waitcnt lgkmcnt(0)
ds_read_b64 v[250:251], v231 offset:3080
s_waitcnt lgkmcnt(0)
v_lshlrev_b32 v242, 16, v250
v_and_b32 v248, 0xffff0000, v250
v_mul_f32 v242, v242, v239
v_mul_f32 v248, v248, v239
v_cvt_pk_bf16_f32 v250, v242, v248
v_lshlrev_b32 v242, 16, v251
v_and_b32 v248, 0xffff0000, v251
v_mul_f32 v242, v242, v239
v_mul_f32 v248, v248, v239
v_cvt_pk_bf16_f32 v251, v242, v248
ds_write_b64 v231, v[250:251] offset:3080
s_waitcnt lgkmcnt(0)
ds_read_b64 v[250:251], v231 offset:7168
s_waitcnt lgkmcnt(0)
v_lshlrev_b32 v242, 16, v250
v_and_b32 v248, 0xffff0000, v250
v_mul_f32 v242, v242, v239
v_mul_f32 v248, v248, v239
v_cvt_pk_bf16_f32 v250, v242, v248
v_lshlrev_b32 v242, 16, v251
v_and_b32 v248, 0xffff0000, v251
v_mul_f32 v242, v242, v239
v_mul_f32 v248, v248, v239
v_cvt_pk_bf16_f32 v251, v242, v248
ds_write_b64 v231, v[250:251] offset:7168
s_waitcnt lgkmcnt(0)
ds_read_b64 v[250:251], v231 offset:7176
s_waitcnt lgkmcnt(0)
v_lshlrev_b32 v242, 16, v250
v_and_b32 v248, 0xffff0000, v250
v_mul_f32 v242, v242, v239
v_mul_f32 v248, v248, v239
v_cvt_pk_bf16_f32 v250, v242, v248
v_lshlrev_b32 v242, 16, v251
v_and_b32 v248, 0xffff0000, v251
v_mul_f32 v242, v242, v239
v_mul_f32 v248, v248, v239
v_cvt_pk_bf16_f32 v251, v242, v248
ds_write_b64 v231, v[250:251] offset:7176
s_waitcnt lgkmcnt(0)
v_exp_f32 v232, v144
v_exp_f32 v233, v145
v_exp_f32 v234, v146
v_exp_f32 v235, v147
s_nop 1
v_add_f32 v224, v224, v232
v_add_f32 v224, v224, v233
v_add_f32 v224, v224, v234
v_add_f32 v224, v224, v235
v_cvt_pk_bf16_f32 v162, v232, v233
v_cvt_pk_bf16_f32 v163, v234, v235
v_exp_f32 v232, v148
v_exp_f32 v233, v149
v_exp_f32 v234, v150
v_exp_f32 v235, v151
s_nop 1
v_add_f32 v225, v225, v232
v_add_f32 v225, v225, v233
v_add_f32 v225, v225, v234
v_add_f32 v225, v225, v235
v_cvt_pk_bf16_f32 v166, v232, v233
v_cvt_pk_bf16_f32 v167, v234, v235
v_exp_f32 v232, v152
v_exp_f32 v233, v153
v_exp_f32 v234, v154
v_exp_f32 v235, v155
s_nop 1
v_add_f32 v226, v226, v232
v_add_f32 v226, v226, v233
v_add_f32 v226, v226, v234
v_add_f32 v226, v226, v235
v_cvt_pk_bf16_f32 v170, v232, v233
v_cvt_pk_bf16_f32 v171, v234, v235
v_exp_f32 v232, v156
v_exp_f32 v233, v157
v_exp_f32 v234, v158
v_exp_f32 v235, v159
s_nop 1
v_add_f32 v227, v227, v232
v_add_f32 v227, v227, v233
v_add_f32 v227, v227, v234
v_add_f32 v227, v227, v235
v_cvt_pk_bf16_f32 v174, v232, v233
v_cvt_pk_bf16_f32 v175, v234, v235
s_branch L2_rare_common
L2_rare_site14:
s_mov_b32 s36, 14
s_branch L2_rare_t0_2_0
L2_rare_t0_2_0:
s_nop 15
s_nop 15
s_waitcnt lgkmcnt(0)
v_exp_f32 v248, v128
s_nop 0
v_sub_f32 v224, v224, v248
v_exp_f32 v248, v129
s_nop 0
v_sub_f32 v224, v224, v248
v_exp_f32 v248, v130
s_nop 0
v_sub_f32 v224, v224, v248
v_exp_f32 v248, v131
s_nop 0
v_sub_f32 v224, v224, v248
v_max_f32 v224, 0, v224
v_min_f32 v224, s32, v224
v_log_f32 v248, v224
v_max3_f32 v232, v128, v129, v130
v_max3_f32 v232, v232, v131, v248
v_mov_b32 v248, v232
s_nop 1
v_permlane32_swap_b32 v232, v248
s_nop 1
v_max_f32 v232, v232, v248
v_mov_b32 v248, v232
s_nop 1
v_permlane16_swap_b32 v232, v248
s_nop 1
v_max_f32 v232, v232, v248
v_ceil_f32 v232, v232
v_max_f32 v232, 0, v232
v_sub_f32 v248, 0, v232
v_exp_f32 v236, v248
s_nop 1
v_mul_f32 v224, v224, v236
v_sub_f32 v192, v192, v232
v_sub_f32 v128, v128, v232
v_sub_f32 v144, v144, v232
v_sub_f32 v193, v193, v232
v_sub_f32 v129, v129, v232
v_sub_f32 v145, v145, v232
v_sub_f32 v194, v194, v232
v_sub_f32 v130, v130, v232
v_sub_f32 v146, v146, v232
v_sub_f32 v195, v195, v232
v_sub_f32 v131, v131, v232
v_sub_f32 v147, v147, v232
v_lshlrev_b32 v242, 16, v160
v_and_b32 v248, 0xffff0000, v160
v_mul_f32 v242, v242, v236
v_mul_f32 v248, v248, v236
v_cvt_pk_bf16_f32 v160, v242, v248
v_lshlrev_b32 v242, 16, v161
v_and_b32 v248, 0xffff0000, v161
v_mul_f32 v242, v242, v236
v_mul_f32 v248, v248, v236
v_cvt_pk_bf16_f32 v161, v242, v248
v_lshlrev_b32 v242, 16, v162
v_and_b32 v248, 0xffff0000, v162
v_mul_f32 v242, v242, v236
v_mul_f32 v248, v248, v236
v_cvt_pk_bf16_f32 v162, v242, v248
v_lshlrev_b32 v242, 16, v163
v_and_b32 v248, 0xffff0000, v163
v_mul_f32 v242, v242, v236
v_mul_f32 v248, v248, v236
v_cvt_pk_bf16_f32 v163, v242, v248
ds_read_b64 v[250:251], v231 offset:0
s_waitcnt lgkmcnt(0)
v_lshlrev_b32 v242, 16, v250
v_and_b32 v248, 0xffff0000, v250
v_mul_f32 v242, v242, v236
v_mul_f32 v248, v248, v236
v_cvt_pk_bf16_f32 v250, v242, v248
v_lshlrev_b32 v242, 16, v251
v_and_b32 v248, 0xffff0000, v251
v_mul_f32 v242, v242, v236
v_mul_f32 v248, v248, v236
v_cvt_pk_bf16_f32 v251, v242, v248
ds_write_b64 v231, v[250:251] offset:0
s_waitcnt lgkmcnt(0)
ds_read_b64 v[250:251], v231 offset:8
s_waitcnt lgkmcnt(0)
v_lshlrev_b32 v242, 16, v250
v_and_b32 v248, 0xffff0000, v250
v_mul_f32 v242, v242, v236
v_mul_f32 v248, v248, v236
v_cvt_pk_bf16_f32 v250, v242, v248
v_lshlrev_b32 v242, 16, v251
v_and_b32 v248, 0xffff0000, v251
v_mul_f32 v242, v242, v236
v_mul_f32 v248, v248, v236
v_cvt_pk_bf16_f32 v251, v242, v248
ds_write_b64 v231, v[250:251] offset:8
s_waitcnt lgkmcnt(0)
ds_read_b64 v[250:251], v231 offset:4096
s_waitcnt lgkmcnt(0)
v_lshlrev_b32 v242, 16, v250
v_and_b32 v248, 0xffff0000, v250
v_mul_f32 v242, v242, v236
v_mul_f32 v248, v248, v236
v_cvt_pk_bf16_f32 v250, v242, v248
v_lshlrev_b32 v242, 16, v251
v_and_b32 v248, 0xffff0000, v251
v_mul_f32 v242, v242, v236
v_mul_f32 v248, v248, v236
v_cvt_pk_bf16_f32 v251, v242, v248
ds_write_b64 v231, v[250:251] offset:4096
s_waitcnt lgkmcnt(0)
ds_read_b64 v[250:251], v231 offset:4104
s_waitcnt lgkmcnt(0)
v_lshlrev_b32 v242, 16, v250
v_and_b32 v248, 0xffff0000, v250
v_mul_f32 v242, v242, v236
v_mul_f32 v248, v248, v236
v_cvt_pk_bf16_f32 v250, v242, v248
v_lshlrev_b32 v242, 16, v251
v_and_b32 v248, 0xffff0000, v251
v_mul_f32 v242, v242, v236
v_mul_f32 v248, v248, v236
v_cvt_pk_bf16_f32 v251, v242, v248
ds_write_b64 v231, v[250:251] offset:4104
s_waitcnt lgkmcnt(0)
v_exp_f32 v248, v132
s_nop 0
v_sub_f32 v225, v225, v248
v_exp_f32 v248, v133
s_nop 0
v_sub_f32 v225, v225, v248
v_exp_f32 v248, v134
s_nop 0
v_sub_f32 v225, v225, v248
v_exp_f32 v248, v135
s_nop 0
v_sub_f32 v225, v225, v248
v_max_f32 v225, 0, v225
v_min_f32 v225, s32, v225
v_log_f32 v248, v225
v_max3_f32 v233, v132, v133, v134
v_max3_f32 v233, v233, v135, v248
v_mov_b32 v248, v233
s_nop 1
v_permlane32_swap_b32 v233, v248
s_nop 1
v_max_f32 v233, v233, v248
v_mov_b32 v248, v233
s_nop 1
v_permlane16_swap_b32 v233, v248
s_nop 1
v_max_f32 v233, v233, v248
v_ceil_f32 v233, v233
v_max_f32 v233, 0, v233
v_sub_f32 v248, 0, v233
v_exp_f32 v237, v248
s_nop 1
v_mul_f32 v225, v225, v237
v_sub_f32 v196, v196, v233
v_sub_f32 v132, v132, v233
v_sub_f32 v148, v148, v233
v_sub_f32 v197, v197, v233
v_sub_f32 v133, v133, v233
v_sub_f32 v149, v149, v233
v_sub_f32 v198, v198, v233
v_sub_f32 v134, v134, v233
v_sub_f32 v150, v150, v233
v_sub_f32 v199, v199, v233
v_sub_f32 v135, v135, v233
v_sub_f32 v151, v151, v233
v_lshlrev_b32 v242, 16, v164
v_and_b32 v248, 0xffff0000, v164
v_mul_f32 v242, v242, v237
v_mul_f32 v248, v248, v237
v_cvt_pk_bf16_f32 v164, v242, v248
v_lshlrev_b32 v242, 16, v165
v_and_b32 v248, 0xffff0000, v165
v_mul_f32 v242, v242, v237
v_mul_f32 v248, v248, v237
v_cvt_pk_bf16_f32 v165, v242, v248
v_lshlrev_b32 v242, 16, v166
v_and_b32 v248, 0xffff0000, v166
v_mul_f32 v242, v242, v237
v_mul_f32 v248, v248, v237
v_cvt_pk_bf16_f32 v166, v242, v248
v_lshlrev_b32 v242, 16, v167
v_and_b32 v248, 0xffff0000, v167
v_mul_f32 v242, v242, v237
v_mul_f32 v248, v248, v237
v_cvt_pk_bf16_f32 v167, v242, v248
ds_read_b64 v[250:251], v231 offset:1024
s_waitcnt lgkmcnt(0)
v_lshlrev_b32 v242, 16, v250
v_and_b32 v248, 0xffff0000, v250
v_mul_f32 v242, v242, v237
v_mul_f32 v248, v248, v237
v_cvt_pk_bf16_f32 v250, v242, v248
v_lshlrev_b32 v242, 16, v251
v_and_b32 v248, 0xffff0000, v251
v_mul_f32 v242, v242, v237
v_mul_f32 v248, v248, v237
v_cvt_pk_bf16_f32 v251, v242, v248
ds_write_b64 v231, v[250:251] offset:1024
s_waitcnt lgkmcnt(0)
ds_read_b64 v[250:251], v231 offset:1032
s_waitcnt lgkmcnt(0)
v_lshlrev_b32 v242, 16, v250
v_and_b32 v248, 0xffff0000, v250
v_mul_f32 v242, v242, v237
v_mul_f32 v248, v248, v237
v_cvt_pk_bf16_f32 v250, v242, v248
v_lshlrev_b32 v242, 16, v251
v_and_b32 v248, 0xffff0000, v251
v_mul_f32 v242, v242, v237
v_mul_f32 v248, v248, v237
v_cvt_pk_bf16_f32 v251, v242, v248
ds_write_b64 v231, v[250:251] offset:1032
s_waitcnt lgkmcnt(0)
ds_read_b64 v[250:251], v231 offset:5120
s_waitcnt lgkmcnt(0)
v_lshlrev_b32 v242, 16, v250
v_and_b32 v248, 0xffff0000, v250
v_mul_f32 v242, v242, v237
v_mul_f32 v248, v248, v237
v_cvt_pk_bf16_f32 v250, v242, v248
v_lshlrev_b32 v242, 16, v251
v_and_b32 v248, 0xffff0000, v251
v_mul_f32 v242, v242, v237
v_mul_f32 v248, v248, v237
v_cvt_pk_bf16_f32 v251, v242, v248
ds_write_b64 v231, v[250:251] offset:5120
s_waitcnt lgkmcnt(0)
ds_read_b64 v[250:251], v231 offset:5128
s_waitcnt lgkmcnt(0)
v_lshlrev_b32 v242, 16, v250
v_and_b32 v248, 0xffff0000, v250
v_mul_f32 v242, v242, v237
v_mul_f32 v248, v248, v237
v_cvt_pk_bf16_f32 v250, v242, v248
v_lshlrev_b32 v242, 16, v251
v_and_b32 v248, 0xffff0000, v251
v_mul_f32 v242, v242, v237
v_mul_f32 v248, v248, v237
v_cvt_pk_bf16_f32 v251, v242, v248
ds_write_b64 v231, v[250:251] offset:5128
s_waitcnt lgkmcnt(0)
v_exp_f32 v248, v136
s_nop 0
v_sub_f32 v226, v226, v248
v_exp_f32 v248, v137
s_nop 0
v_sub_f32 v226, v226, v248
v_exp_f32 v248, v138
s_nop 0
v_sub_f32 v226, v226, v248
v_exp_f32 v248, v139
s_nop 0
v_sub_f32 v226, v226, v248
v_max_f32 v226, 0, v226
v_min_f32 v226, s32, v226
v_log_f32 v248, v226
v_max3_f32 v234, v136, v137, v138
v_max3_f32 v234, v234, v139, v248
v_mov_b32 v248, v234
s_nop 1
v_permlane32_swap_b32 v234, v248
s_nop 1
v_max_f32 v234, v234, v248
v_mov_b32 v248, v234
s_nop 1
v_permlane16_swap_b32 v234, v248
s_nop 1
v_max_f32 v234, v234, v248
v_ceil_f32 v234, v234
v_max_f32 v234, 0, v234
v_sub_f32 v248, 0, v234
v_exp_f32 v238, v248
s_nop 1
v_mul_f32 v226, v226, v238
v_sub_f32 v200, v200, v234
v_sub_f32 v136, v136, v234
v_sub_f32 v152, v152, v234
v_sub_f32 v201, v201, v234
v_sub_f32 v137, v137, v234
v_sub_f32 v153, v153, v234
v_sub_f32 v202, v202, v234
v_sub_f32 v138, v138, v234
v_sub_f32 v154, v154, v234
v_sub_f32 v203, v203, v234
v_sub_f32 v139, v139, v234
v_sub_f32 v155, v155, v234
v_lshlrev_b32 v242, 16, v168
v_and_b32 v248, 0xffff0000, v168
v_mul_f32 v242, v242, v238
v_mul_f32 v248, v248, v238
v_cvt_pk_bf16_f32 v168, v242, v248
v_lshlrev_b32 v242, 16, v169
v_and_b32 v248, 0xffff0000, v169
v_mul_f32 v242, v242, v238
v_mul_f32 v248, v248, v238
v_cvt_pk_bf16_f32 v169, v242, v248
v_lshlrev_b32 v242, 16, v170
v_and_b32 v248, 0xffff0000, v170
v_mul_f32 v242, v242, v238
v_mul_f32 v248, v248, v238
v_cvt_pk_bf16_f32 v170, v242, v248
v_lshlrev_b32 v242, 16, v171
v_and_b32 v248, 0xffff0000, v171
v_mul_f32 v242, v242, v238
v_mul_f32 v248, v248, v238
v_cvt_pk_bf16_f32 v171, v242, v248
ds_read_b64 v[250:251], v231 offset:2048
s_waitcnt lgkmcnt(0)
v_lshlrev_b32 v242, 16, v250
v_and_b32 v248, 0xffff0000, v250
v_mul_f32 v242, v242, v238
v_mul_f32 v248, v248, v238
v_cvt_pk_bf16_f32 v250, v242, v248
v_lshlrev_b32 v242, 16, v251
v_and_b32 v248, 0xffff0000, v251
v_mul_f32 v242, v242, v238
v_mul_f32 v248, v248, v238
v_cvt_pk_bf16_f32 v251, v242, v248
ds_write_b64 v231, v[250:251] offset:2048
s_waitcnt lgkmcnt(0)
ds_read_b64 v[250:251], v231 offset:2056
s_waitcnt lgkmcnt(0)
v_lshlrev_b32 v242, 16, v250
v_and_b32 v248, 0xffff0000, v250
v_mul_f32 v242, v242, v238
v_mul_f32 v248, v248, v238
v_cvt_pk_bf16_f32 v250, v242, v248
v_lshlrev_b32 v242, 16, v251
v_and_b32 v248, 0xffff0000, v251
v_mul_f32 v242, v242, v238
v_mul_f32 v248, v248, v238
v_cvt_pk_bf16_f32 v251, v242, v248
ds_write_b64 v231, v[250:251] offset:2056
s_waitcnt lgkmcnt(0)
ds_read_b64 v[250:251], v231 offset:6144
s_waitcnt lgkmcnt(0)
v_lshlrev_b32 v242, 16, v250
v_and_b32 v248, 0xffff0000, v250
v_mul_f32 v242, v242, v238
v_mul_f32 v248, v248, v238
v_cvt_pk_bf16_f32 v250, v242, v248
v_lshlrev_b32 v242, 16, v251
v_and_b32 v248, 0xffff0000, v251
v_mul_f32 v242, v242, v238
v_mul_f32 v248, v248, v238
v_cvt_pk_bf16_f32 v251, v242, v248
ds_write_b64 v231, v[250:251] offset:6144
s_waitcnt lgkmcnt(0)
ds_read_b64 v[250:251], v231 offset:6152
s_waitcnt lgkmcnt(0)
v_lshlrev_b32 v242, 16, v250
v_and_b32 v248, 0xffff0000, v250
v_mul_f32 v242, v242, v238
v_mul_f32 v248, v248, v238
v_cvt_pk_bf16_f32 v250, v242, v248
v_lshlrev_b32 v242, 16, v251
v_and_b32 v248, 0xffff0000, v251
v_mul_f32 v242, v242, v238
v_mul_f32 v248, v248, v238
v_cvt_pk_bf16_f32 v251, v242, v248
ds_write_b64 v231, v[250:251] offset:6152
s_waitcnt lgkmcnt(0)
v_exp_f32 v248, v140
s_nop 0
v_sub_f32 v227, v227, v248
v_exp_f32 v248, v141
s_nop 0
v_sub_f32 v227, v227, v248
v_exp_f32 v248, v142
s_nop 0
v_sub_f32 v227, v227, v248
v_exp_f32 v248, v143
s_nop 0
v_sub_f32 v227, v227, v248
v_max_f32 v227, 0, v227
v_min_f32 v227, s32, v227
v_log_f32 v248, v227
v_max3_f32 v235, v140, v141, v142
v_max3_f32 v235, v235, v143, v248
v_mov_b32 v248, v235
s_nop 1
v_permlane32_swap_b32 v235, v248
s_nop 1
v_max_f32 v235, v235, v248
v_mov_b32 v248, v235
s_nop 1
v_permlane16_swap_b32 v235, v248
s_nop 1
v_max_f32 v235, v235, v248
v_ceil_f32 v235, v235
v_max_f32 v235, 0, v235
v_sub_f32 v248, 0, v235
v_exp_f32 v239, v248
s_nop 1
v_mul_f32 v227, v227, v239
v_sub_f32 v204, v204, v235
v_sub_f32 v140, v140, v235
v_sub_f32 v156, v156, v235
v_sub_f32 v205, v205, v235
v_sub_f32 v141, v141, v235
v_sub_f32 v157, v157, v235
v_sub_f32 v206, v206, v235
v_sub_f32 v142, v142, v235
v_sub_f32 v158, v158, v235
v_sub_f32 v207, v207, v235
v_sub_f32 v143, v143, v235
v_sub_f32 v159, v159, v235
v_lshlrev_b32 v242, 16, v172
v_and_b32 v248, 0xffff0000, v172
v_mul_f32 v242, v242, v239
v_mul_f32 v248, v248, v239
v_cvt_pk_bf16_f32 v172, v242, v248
v_lshlrev_b32 v242, 16, v173
v_and_b32 v248, 0xffff0000, v173
v_mul_f32 v242, v242, v239
v_mul_f32 v248, v248, v239
v_cvt_pk_bf16_f32 v173, v242, v248
v_lshlrev_b32 v242, 16, v174
v_and_b32 v248, 0xffff0000, v174
v_mul_f32 v242, v242, v239
v_mul_f32 v248, v248, v239
v_cvt_pk_bf16_f32 v174, v242, v248
v_lshlrev_b32 v242, 16, v175
v_and_b32 v248, 0xffff0000, v175
v_mul_f32 v242, v242, v239
v_mul_f32 v248, v248, v239
v_cvt_pk_bf16_f32 v175, v242, v248
ds_read_b64 v[250:251], v231 offset:3072
s_waitcnt lgkmcnt(0)
v_lshlrev_b32 v242, 16, v250
v_and_b32 v248, 0xffff0000, v250
v_mul_f32 v242, v242, v239
v_mul_f32 v248, v248, v239
v_cvt_pk_bf16_f32 v250, v242, v248
v_lshlrev_b32 v242, 16, v251
v_and_b32 v248, 0xffff0000, v251
v_mul_f32 v242, v242, v239
v_mul_f32 v248, v248, v239
v_cvt_pk_bf16_f32 v251, v242, v248
ds_write_b64 v231, v[250:251] offset:3072
s_waitcnt lgkmcnt(0)
ds_read_b64 v[250:251], v231 offset:3080
s_waitcnt lgkmcnt(0)
v_lshlrev_b32 v242, 16, v250
v_and_b32 v248, 0xffff0000, v250
v_mul_f32 v242, v242, v239
v_mul_f32 v248, v248, v239
v_cvt_pk_bf16_f32 v250, v242, v248
v_lshlrev_b32 v242, 16, v251
v_and_b32 v248, 0xffff0000, v251
v_mul_f32 v242, v242, v239
v_mul_f32 v248, v248, v239
v_cvt_pk_bf16_f32 v251, v242, v248
ds_write_b64 v231, v[250:251] offset:3080
s_waitcnt lgkmcnt(0)
ds_read_b64 v[250:251], v231 offset:7168
s_waitcnt lgkmcnt(0)
v_lshlrev_b32 v242, 16, v250
v_and_b32 v248, 0xffff0000, v250
v_mul_f32 v242, v242, v239
v_mul_f32 v248, v248, v239
v_cvt_pk_bf16_f32 v250, v242, v248
v_lshlrev_b32 v242, 16, v251
v_and_b32 v248, 0xffff0000, v251
v_mul_f32 v242, v242, v239
v_mul_f32 v248, v248, v239
v_cvt_pk_bf16_f32 v251, v242, v248
ds_write_b64 v231, v[250:251] offset:7168
s_waitcnt lgkmcnt(0)
ds_read_b64 v[250:251], v231 offset:7176
s_waitcnt lgkmcnt(0)
v_lshlrev_b32 v242, 16, v250
v_and_b32 v248, 0xffff0000, v250
v_mul_f32 v242, v242, v239
v_mul_f32 v248, v248, v239
v_cvt_pk_bf16_f32 v250, v242, v248
v_lshlrev_b32 v242, 16, v251
v_and_b32 v248, 0xffff0000, v251
v_mul_f32 v242, v242, v239
v_mul_f32 v248, v248, v239
v_cvt_pk_bf16_f32 v251, v242, v248
ds_write_b64 v231, v[250:251] offset:7176
s_waitcnt lgkmcnt(0)
v_exp_f32 v232, v128
v_exp_f32 v233, v129
v_exp_f32 v234, v130
v_exp_f32 v235, v131
s_nop 1
v_add_f32 v224, v224, v232
v_add_f32 v224, v224, v233
v_add_f32 v224, v224, v234
v_add_f32 v224, v224, v235
v_cvt_pk_bf16_f32 v176, v232, v233
v_cvt_pk_bf16_f32 v177, v234, v235
v_exp_f32 v232, v132
v_exp_f32 v233, v133
v_exp_f32 v234, v134
v_exp_f32 v235, v135
s_nop 1
v_add_f32 v225, v225, v232
v_add_f32 v225, v225, v233
v_add_f32 v225, v225, v234
v_add_f32 v225, v225, v235
v_cvt_pk_bf16_f32 v180, v232, v233
v_cvt_pk_bf16_f32 v181, v234, v235
v_exp_f32 v232, v136
v_exp_f32 v233, v137
v_exp_f32 v234, v138
v_exp_f32 v235, v139
s_nop 1
v_add_f32 v226, v226, v232
v_add_f32 v226, v226, v233
v_add_f32 v226, v226, v234
v_add_f32 v226, v226, v235
v_cvt_pk_bf16_f32 v184, v232, v233
v_cvt_pk_bf16_f32 v185, v234, v235
v_exp_f32 v232, v140
v_exp_f32 v233, v141
v_exp_f32 v234, v142
v_exp_f32 v235, v143
s_nop 1
v_add_f32 v227, v227, v232
v_add_f32 v227, v227, v233
v_add_f32 v227, v227, v234
v_add_f32 v227, v227, v235
v_cvt_pk_bf16_f32 v188, v232, v233
v_cvt_pk_bf16_f32 v189, v234, v235
s_branch L2_rare_common
L2_rare_site15:
s_mov_b32 s36, 15
s_branch L2_rare_t0_3_1
L2_rare_t0_3_1:
s_nop 15
s_nop 15
s_waitcnt lgkmcnt(0)
v_exp_f32 v248, v144
s_nop 0
v_sub_f32 v224, v224, v248
v_exp_f32 v248, v145
s_nop 0
v_sub_f32 v224, v224, v248
v_exp_f32 v248, v146
s_nop 0
v_sub_f32 v224, v224, v248
v_exp_f32 v248, v147
s_nop 0
v_sub_f32 v224, v224, v248
v_max_f32 v224, 0, v224
v_min_f32 v224, s32, v224
v_log_f32 v248, v224
v_max3_f32 v232, v144, v145, v146
v_max3_f32 v232, v232, v147, v248
v_mov_b32 v248, v232
s_nop 1
v_permlane32_swap_b32 v232, v248
s_nop 1
v_max_f32 v232, v232, v248
v_mov_b32 v248, v232
s_nop 1
v_permlane16_swap_b32 v232, v248
s_nop 1
v_max_f32 v232, v232, v248
v_ceil_f32 v232, v232
v_max_f32 v232, 0, v232
v_sub_f32 v248, 0, v232
v_exp_f32 v236, v248
s_nop 1
v_mul_f32 v224, v224, v236
v_sub_f32 v192, v192, v232
v_sub_f32 v128, v128, v232
v_sub_f32 v144, v144, v232
v_sub_f32 v193, v193, v232
v_sub_f32 v129, v129, v232
v_sub_f32 v145, v145, v232
v_sub_f32 v194, v194, v232
v_sub_f32 v130, v130, v232
v_sub_f32 v146, v146, v232
v_sub_f32 v195, v195, v232
v_sub_f32 v131, v131, v232
v_sub_f32 v147, v147, v232
v_lshlrev_b32 v242, 16, v160
v_and_b32 v248, 0xffff0000, v160
v_mul_f32 v242, v242, v236
v_mul_f32 v248, v248, v236
v_cvt_pk_bf16_f32 v160, v242, v248
v_lshlrev_b32 v242, 16, v161
v_and_b32 v248, 0xffff0000, v161
v_mul_f32 v242, v242, v236
v_mul_f32 v248, v248, v236
v_cvt_pk_bf16_f32 v161, v242, v248
v_lshlrev_b32 v242, 16, v162
v_and_b32 v248, 0xffff0000, v162
v_mul_f32 v242, v242, v236
v_mul_f32 v248, v248, v236
v_cvt_pk_bf16_f32 v162, v242, v248
v_lshlrev_b32 v242, 16, v163
v_and_b32 v248, 0xffff0000, v163
v_mul_f32 v242, v242, v236
v_mul_f32 v248, v248, v236
v_cvt_pk_bf16_f32 v163, v242, v248
v_lshlrev_b32 v242, 16, v176
v_and_b32 v248, 0xffff0000, v176
v_mul_f32 v242, v242, v236
v_mul_f32 v248, v248, v236
v_cvt_pk_bf16_f32 v176, v242, v248
v_lshlrev_b32 v242, 16, v177
v_and_b32 v248, 0xffff0000, v177
v_mul_f32 v242, v242, v236
v_mul_f32 v248, v248, v236
v_cvt_pk_bf16_f32 v177, v242, v248
ds_read_b64 v[250:251], v231 offset:0
s_waitcnt lgkmcnt(0)
v_lshlrev_b32 v242, 16, v250
v_and_b32 v248, 0xffff0000, v250
v_mul_f32 v242, v242, v236
v_mul_f32 v248, v248, v236
v_cvt_pk_bf16_f32 v250, v242, v248
v_lshlrev_b32 v242, 16, v251
v_and_b32 v248, 0xffff0000, v251
v_mul_f32 v242, v242, v236
v_mul_f32 v248, v248, v236
v_cvt_pk_bf16_f32 v251, v242, v248
ds_write_b64 v231, v[250:251] offset:0
s_waitcnt lgkmcnt(0)
ds_read_b64 v[250:251], v231 offset:8
s_waitcnt lgkmcnt(0)
v_lshlrev_b32 v242, 16, v250
v_and_b32 v248, 0xffff0000, v250
v_mul_f32 v242, v242, v236
v_mul_f32 v248, v248, v236
v_cvt_pk_bf16_f32 v250, v242, v248
v_lshlrev_b32 v242, 16, v251
v_and_b32 v248, 0xffff0000, v251
v_mul_f32 v242, v242, v236
v_mul_f32 v248, v248, v236
v_cvt_pk_bf16_f32 v251, v242, v248
ds_write_b64 v231, v[250:251] offset:8
s_waitcnt lgkmcnt(0)
ds_read_b64 v[250:251], v231 offset:4096
s_waitcnt lgkmcnt(0)
v_lshlrev_b32 v242, 16, v250
v_and_b32 v248, 0xffff0000, v250
v_mul_f32 v242, v242, v236
v_mul_f32 v248, v248, v236
v_cvt_pk_bf16_f32 v250, v242, v248
v_lshlrev_b32 v242, 16, v251
v_and_b32 v248, 0xffff0000, v251
v_mul_f32 v242, v242, v236
v_mul_f32 v248, v248, v236
v_cvt_pk_bf16_f32 v251, v242, v248
ds_write_b64 v231, v[250:251] offset:4096
s_waitcnt lgkmcnt(0)
ds_read_b64 v[250:251], v231 offset:4104
s_waitcnt lgkmcnt(0)
v_lshlrev_b32 v242, 16, v250
v_and_b32 v248, 0xffff0000, v250
v_mul_f32 v242, v242, v236
v_mul_f32 v248, v248, v236
v_cvt_pk_bf16_f32 v250, v242, v248
v_lshlrev_b32 v242, 16, v251
v_and_b32 v248, 0xffff0000, v251
v_mul_f32 v242, v242, v236
v_mul_f32 v248, v248, v236
v_cvt_pk_bf16_f32 v251, v242, v248
ds_write_b64 v231, v[250:251] offset:4104
s_waitcnt lgkmcnt(0)
v_exp_f32 v248, v148
s_nop 0
v_sub_f32 v225, v225, v248
v_exp_f32 v248, v149
s_nop 0
v_sub_f32 v225, v225, v248
v_exp_f32 v248, v150
s_nop 0
v_sub_f32 v225, v225, v248
v_exp_f32 v248, v151
s_nop 0
v_sub_f32 v225, v225, v248
v_max_f32 v225, 0, v225
v_min_f32 v225, s32, v225
v_log_f32 v248, v225
v_max3_f32 v233, v148, v149, v150
v_max3_f32 v233, v233, v151, v248
v_mov_b32 v248, v233
s_nop 1
v_permlane32_swap_b32 v233, v248
s_nop 1
v_max_f32 v233, v233, v248
v_mov_b32 v248, v233
s_nop 1
v_permlane16_swap_b32 v233, v248
s_nop 1
v_max_f32 v233, v233, v248
v_ceil_f32 v233, v233
v_max_f32 v233, 0, v233
v_sub_f32 v248, 0, v233
v_exp_f32 v237, v248
s_nop 1
v_mul_f32 v225, v225, v237
v_sub_f32 v196, v196, v233
v_sub_f32 v132, v132, v233
v_sub_f32 v148, v148, v233
v_sub_f32 v197, v197, v233
v_sub_f32 v133, v133, v233
v_sub_f32 v149, v149, v233
v_sub_f32 v198, v198, v233
v_sub_f32 v134, v134, v233
v_sub_f32 v150, v150, v233
v_sub_f32 v199, v199, v233
v_sub_f32 v135, v135, v233
v_sub_f32 v151, v151, v233
v_lshlrev_b32 v242, 16, v164
v_and_b32 v248, 0xffff0000, v164
v_mul_f32 v242, v242, v237
v_mul_f32 v248, v248, v237
v_cvt_pk_bf16_f32 v164, v242, v248
v_lshlrev_b32 v242, 16, v165
v_and_b32 v248, 0xffff0000, v165
v_mul_f32 v242, v242, v237
v_mul_f32 v248, v248, v237
v_cvt_pk_bf16_f32 v165, v242, v248
v_lshlrev_b32 v242, 16, v166
v_and_b32 v248, 0xffff0000, v166
v_mul_f32 v242, v242, v237
v_mul_f32 v248, v248, v237
v_cvt_pk_bf16_f32 v166, v242, v248
v_lshlrev_b32 v242, 16, v167
v_and_b32 v248, 0xffff0000, v167
v_mul_f32 v242, v242, v237
v_mul_f32 v248, v248, v237
v_cvt_pk_bf16_f32 v167, v242, v248
v_lshlrev_b32 v242, 16, v180
v_and_b32 v248, 0xffff0000, v180
v_mul_f32 v242, v242, v237
v_mul_f32 v248, v248, v237
v_cvt_pk_bf16_f32 v180, v242, v248
v_lshlrev_b32 v242, 16, v181
v_and_b32 v248, 0xffff0000, v181
v_mul_f32 v242, v242, v237
v_mul_f32 v248, v248, v237
v_cvt_pk_bf16_f32 v181, v242, v248
ds_read_b64 v[250:251], v231 offset:1024
s_waitcnt lgkmcnt(0)
v_lshlrev_b32 v242, 16, v250
v_and_b32 v248, 0xffff0000, v250
v_mul_f32 v242, v242, v237
v_mul_f32 v248, v248, v237
v_cvt_pk_bf16_f32 v250, v242, v248
v_lshlrev_b32 v242, 16, v251
v_and_b32 v248, 0xffff0000, v251
v_mul_f32 v242, v242, v237
v_mul_f32 v248, v248, v237
v_cvt_pk_bf16_f32 v251, v242, v248
ds_write_b64 v231, v[250:251] offset:1024
s_waitcnt lgkmcnt(0)
ds_read_b64 v[250:251], v231 offset:1032
s_waitcnt lgkmcnt(0)
v_lshlrev_b32 v242, 16, v250
v_and_b32 v248, 0xffff0000, v250
v_mul_f32 v242, v242, v237
v_mul_f32 v248, v248, v237
v_cvt_pk_bf16_f32 v250, v242, v248
v_lshlrev_b32 v242, 16, v251
v_and_b32 v248, 0xffff0000, v251
v_mul_f32 v242, v242, v237
v_mul_f32 v248, v248, v237
v_cvt_pk_bf16_f32 v251, v242, v248
ds_write_b64 v231, v[250:251] offset:1032
s_waitcnt lgkmcnt(0)
ds_read_b64 v[250:251], v231 offset:5120
s_waitcnt lgkmcnt(0)
v_lshlrev_b32 v242, 16, v250
v_and_b32 v248, 0xffff0000, v250
v_mul_f32 v242, v242, v237
v_mul_f32 v248, v248, v237
v_cvt_pk_bf16_f32 v250, v242, v248
v_lshlrev_b32 v242, 16, v251
v_and_b32 v248, 0xffff0000, v251
v_mul_f32 v242, v242, v237
v_mul_f32 v248, v248, v237
v_cvt_pk_bf16_f32 v251, v242, v248
ds_write_b64 v231, v[250:251] offset:5120
s_waitcnt lgkmcnt(0)
ds_read_b64 v[250:251], v231 offset:5128
s_waitcnt lgkmcnt(0)
v_lshlrev_b32 v242, 16, v250
v_and_b32 v248, 0xffff0000, v250
v_mul_f32 v242, v242, v237
v_mul_f32 v248, v248, v237
v_cvt_pk_bf16_f32 v250, v242, v248
v_lshlrev_b32 v242, 16, v251
v_and_b32 v248, 0xffff0000, v251
v_mul_f32 v242, v242, v237
v_mul_f32 v248, v248, v237
v_cvt_pk_bf16_f32 v251, v242, v248
ds_write_b64 v231, v[250:251] offset:5128
s_waitcnt lgkmcnt(0)
v_exp_f32 v248, v152
s_nop 0
v_sub_f32 v226, v226, v248
v_exp_f32 v248, v153
s_nop 0
v_sub_f32 v226, v226, v248
v_exp_f32 v248, v154
s_nop 0
v_sub_f32 v226, v226, v248
v_exp_f32 v248, v155
s_nop 0
v_sub_f32 v226, v226, v248
v_max_f32 v226, 0, v226
v_min_f32 v226, s32, v226
v_log_f32 v248, v226
v_max3_f32 v234, v152, v153, v154
v_max3_f32 v234, v234, v155, v248
v_mov_b32 v248, v234
s_nop 1
v_permlane32_swap_b32 v234, v248
s_nop 1
v_max_f32 v234, v234, v248
v_mov_b32 v248, v234
s_nop 1
v_permlane16_swap_b32 v234, v248
s_nop 1
v_max_f32 v234, v234, v248
v_ceil_f32 v234, v234
v_max_f32 v234, 0, v234
v_sub_f32 v248, 0, v234
v_exp_f32 v238, v248
s_nop 1
v_mul_f32 v226, v226, v238
v_sub_f32 v200, v200, v234
v_sub_f32 v136, v136, v234
v_sub_f32 v152, v152, v234
v_sub_f32 v201, v201, v234
v_sub_f32 v137, v137, v234
v_sub_f32 v153, v153, v234
v_sub_f32 v202, v202, v234
v_sub_f32 v138, v138, v234
v_sub_f32 v154, v154, v234
v_sub_f32 v203, v203, v234
v_sub_f32 v139, v139, v234
v_sub_f32 v155, v155, v234
v_lshlrev_b32 v242, 16, v168
v_and_b32 v248, 0xffff0000, v168
v_mul_f32 v242, v242, v238
v_mul_f32 v248, v248, v238
v_cvt_pk_bf16_f32 v168, v242, v248
v_lshlrev_b32 v242, 16, v169
v_and_b32 v248, 0xffff0000, v169
v_mul_f32 v242, v242, v238
v_mul_f32 v248, v248, v238
v_cvt_pk_bf16_f32 v169, v242, v248
v_lshlrev_b32 v242, 16, v170
v_and_b32 v248, 0xffff0000, v170
v_mul_f32 v242, v242, v238
v_mul_f32 v248, v248, v238
v_cvt_pk_bf16_f32 v170, v242, v248
v_lshlrev_b32 v242, 16, v171
v_and_b32 v248, 0xffff0000, v171
v_mul_f32 v242, v242, v238
v_mul_f32 v248, v248, v238
v_cvt_pk_bf16_f32 v171, v242, v248
v_lshlrev_b32 v242, 16, v184
v_and_b32 v248, 0xffff0000, v184
v_mul_f32 v242, v242, v238
v_mul_f32 v248, v248, v238
v_cvt_pk_bf16_f32 v184, v242, v248
v_lshlrev_b32 v242, 16, v185
v_and_b32 v248, 0xffff0000, v185
v_mul_f32 v242, v242, v238
v_mul_f32 v248, v248, v238
v_cvt_pk_bf16_f32 v185, v242, v248
ds_read_b64 v[250:251], v231 offset:2048
s_waitcnt lgkmcnt(0)
v_lshlrev_b32 v242, 16, v250
v_and_b32 v248, 0xffff0000, v250
v_mul_f32 v242, v242, v238
v_mul_f32 v248, v248, v238
v_cvt_pk_bf16_f32 v250, v242, v248
v_lshlrev_b32 v242, 16, v251
v_and_b32 v248, 0xffff0000, v251
v_mul_f32 v242, v242, v238
v_mul_f32 v248, v248, v238
v_cvt_pk_bf16_f32 v251, v242, v248
ds_write_b64 v231, v[250:251] offset:2048
s_waitcnt lgkmcnt(0)
ds_read_b64 v[250:251], v231 offset:2056
s_waitcnt lgkmcnt(0)
v_lshlrev_b32 v242, 16, v250
v_and_b32 v248, 0xffff0000, v250
v_mul_f32 v242, v242, v238
v_mul_f32 v248, v248, v238
v_cvt_pk_bf16_f32 v250, v242, v248
v_lshlrev_b32 v242, 16, v251
v_and_b32 v248, 0xffff0000, v251
v_mul_f32 v242, v242, v238
v_mul_f32 v248, v248, v238
v_cvt_pk_bf16_f32 v251, v242, v248
ds_write_b64 v231, v[250:251] offset:2056
s_waitcnt lgkmcnt(0)
ds_read_b64 v[250:251], v231 offset:6144
s_waitcnt lgkmcnt(0)
v_lshlrev_b32 v242, 16, v250
v_and_b32 v248, 0xffff0000, v250
v_mul_f32 v242, v242, v238
v_mul_f32 v248, v248, v238
v_cvt_pk_bf16_f32 v250, v242, v248
v_lshlrev_b32 v242, 16, v251
v_and_b32 v248, 0xffff0000, v251
v_mul_f32 v242, v242, v238
v_mul_f32 v248, v248, v238
v_cvt_pk_bf16_f32 v251, v242, v248
ds_write_b64 v231, v[250:251] offset:6144
s_waitcnt lgkmcnt(0)
ds_read_b64 v[250:251], v231 offset:6152
s_waitcnt lgkmcnt(0)
v_lshlrev_b32 v242, 16, v250
v_and_b32 v248, 0xffff0000, v250
v_mul_f32 v242, v242, v238
v_mul_f32 v248, v248, v238
v_cvt_pk_bf16_f32 v250, v242, v248
v_lshlrev_b32 v242, 16, v251
v_and_b32 v248, 0xffff0000, v251
v_mul_f32 v242, v242, v238
v_mul_f32 v248, v248, v238
v_cvt_pk_bf16_f32 v251, v242, v248
ds_write_b64 v231, v[250:251] offset:6152
s_waitcnt lgkmcnt(0)
v_exp_f32 v248, v156
s_nop 0
v_sub_f32 v227, v227, v248
v_exp_f32 v248, v157
s_nop 0
v_sub_f32 v227, v227, v248
v_exp_f32 v248, v158
s_nop 0
v_sub_f32 v227, v227, v248
v_exp_f32 v248, v159
s_nop 0
v_sub_f32 v227, v227, v248
v_max_f32 v227, 0, v227
v_min_f32 v227, s32, v227
v_log_f32 v248, v227
v_max3_f32 v235, v156, v157, v158
v_max3_f32 v235, v235, v159, v248
v_mov_b32 v248, v235
s_nop 1
v_permlane32_swap_b32 v235, v248
s_nop 1
v_max_f32 v235, v235, v248
v_mov_b32 v248, v235
s_nop 1
v_permlane16_swap_b32 v235, v248
s_nop 1
v_max_f32 v235, v235, v248
v_ceil_f32 v235, v235
v_max_f32 v235, 0, v235
v_sub_f32 v248, 0, v235
v_exp_f32 v239, v248
s_nop 1
v_mul_f32 v227, v227, v239
v_sub_f32 v204, v204, v235
v_sub_f32 v140, v140, v235
v_sub_f32 v156, v156, v235
v_sub_f32 v205, v205, v235
v_sub_f32 v141, v141, v235
v_sub_f32 v157, v157, v235
v_sub_f32 v206, v206, v235
v_sub_f32 v142, v142, v235
v_sub_f32 v158, v158, v235
v_sub_f32 v207, v207, v235
v_sub_f32 v143, v143, v235
v_sub_f32 v159, v159, v235
v_lshlrev_b32 v242, 16, v172
v_and_b32 v248, 0xffff0000, v172
v_mul_f32 v242, v242, v239
v_mul_f32 v248, v248, v239
v_cvt_pk_bf16_f32 v172, v242, v248
v_lshlrev_b32 v242, 16, v173
v_and_b32 v248, 0xffff0000, v173
v_mul_f32 v242, v242, v239
v_mul_f32 v248, v248, v239
v_cvt_pk_bf16_f32 v173, v242, v248
v_lshlrev_b32 v242, 16, v174
v_and_b32 v248, 0xffff0000, v174
v_mul_f32 v242, v242, v239
v_mul_f32 v248, v248, v239
v_cvt_pk_bf16_f32 v174, v242, v248
v_lshlrev_b32 v242, 16, v175
v_and_b32 v248, 0xffff0000, v175
v_mul_f32 v242, v242, v239
v_mul_f32 v248, v248, v239
v_cvt_pk_bf16_f32 v175, v242, v248
v_lshlrev_b32 v242, 16, v188
v_and_b32 v248, 0xffff0000, v188
v_mul_f32 v242, v242, v239
v_mul_f32 v248, v248, v239
v_cvt_pk_bf16_f32 v188, v242, v248
v_lshlrev_b32 v242, 16, v189
v_and_b32 v248, 0xffff0000, v189
v_mul_f32 v242, v242, v239
v_mul_f32 v248, v248, v239
v_cvt_pk_bf16_f32 v189, v242, v248
ds_read_b64 v[250:251], v231 offset:3072
s_waitcnt lgkmcnt(0)
v_lshlrev_b32 v242, 16, v250
v_and_b32 v248, 0xffff0000, v250
v_mul_f32 v242, v242, v239
v_mul_f32 v248, v248, v239
v_cvt_pk_bf16_f32 v250, v242, v248
v_lshlrev_b32 v242, 16, v251
v_and_b32 v248, 0xffff0000, v251
v_mul_f32 v242, v242, v239
v_mul_f32 v248, v248, v239
v_cvt_pk_bf16_f32 v251, v242, v248
ds_write_b64 v231, v[250:251] offset:3072
s_waitcnt lgkmcnt(0)
ds_read_b64 v[250:251], v231 offset:3080
s_waitcnt lgkmcnt(0)
v_lshlrev_b32 v242, 16, v250
v_and_b32 v248, 0xffff0000, v250
v_mul_f32 v242, v242, v239
v_mul_f32 v248, v248, v239
v_cvt_pk_bf16_f32 v250, v242, v248
v_lshlrev_b32 v242, 16, v251
v_and_b32 v248, 0xffff0000, v251
v_mul_f32 v242, v242, v239
v_mul_f32 v248, v248, v239
v_cvt_pk_bf16_f32 v251, v242, v248
ds_write_b64 v231, v[250:251] offset:3080
s_waitcnt lgkmcnt(0)
ds_read_b64 v[250:251], v231 offset:7168
s_waitcnt lgkmcnt(0)
v_lshlrev_b32 v242, 16, v250
v_and_b32 v248, 0xffff0000, v250
v_mul_f32 v242, v242, v239
v_mul_f32 v248, v248, v239
v_cvt_pk_bf16_f32 v250, v242, v248
v_lshlrev_b32 v242, 16, v251
v_and_b32 v248, 0xffff0000, v251
v_mul_f32 v242, v242, v239
v_mul_f32 v248, v248, v239
v_cvt_pk_bf16_f32 v251, v242, v248
ds_write_b64 v231, v[250:251] offset:7168
s_waitcnt lgkmcnt(0)
ds_read_b64 v[250:251], v231 offset:7176
s_waitcnt lgkmcnt(0)
v_lshlrev_b32 v242, 16, v250
v_and_b32 v248, 0xffff0000, v250
v_mul_f32 v242, v242, v239
v_mul_f32 v248, v248, v239
v_cvt_pk_bf16_f32 v250, v242, v248
v_lshlrev_b32 v242, 16, v251
v_and_b32 v248, 0xffff0000, v251
v_mul_f32 v242, v242, v239
v_mul_f32 v248, v248, v239
v_cvt_pk_bf16_f32 v251, v242, v248
ds_write_b64 v231, v[250:251] offset:7176
s_waitcnt lgkmcnt(0)
v_exp_f32 v232, v144
v_exp_f32 v233, v145
v_exp_f32 v234, v146
v_exp_f32 v235, v147
s_nop 1
v_add_f32 v224, v224, v232
v_add_f32 v224, v224, v233
v_add_f32 v224, v224, v234
v_add_f32 v224, v224, v235
v_cvt_pk_bf16_f32 v178, v232, v233
v_cvt_pk_bf16_f32 v179, v234, v235
v_exp_f32 v232, v148
v_exp_f32 v233, v149
v_exp_f32 v234, v150
v_exp_f32 v235, v151
s_nop 1
v_add_f32 v225, v225, v232
v_add_f32 v225, v225, v233
v_add_f32 v225, v225, v234
v_add_f32 v225, v225, v235
v_cvt_pk_bf16_f32 v182, v232, v233
v_cvt_pk_bf16_f32 v183, v234, v235
v_exp_f32 v232, v152
v_exp_f32 v233, v153
v_exp_f32 v234, v154
v_exp_f32 v235, v155
s_nop 1
v_add_f32 v226, v226, v232
v_add_f32 v226, v226, v233
v_add_f32 v226, v226, v234
v_add_f32 v226, v226, v235
v_cvt_pk_bf16_f32 v186, v232, v233
v_cvt_pk_bf16_f32 v187, v234, v235
v_exp_f32 v232, v156
v_exp_f32 v233, v157
v_exp_f32 v234, v158
v_exp_f32 v235, v159
s_nop 1
v_add_f32 v227, v227, v232
v_add_f32 v227, v227, v233
v_add_f32 v227, v227, v234
v_add_f32 v227, v227, v235
v_cvt_pk_bf16_f32 v190, v232, v233
v_cvt_pk_bf16_f32 v191, v234, v235
s_branch L2_rare_common
L2_rare_site16:
s_mov_b32 s36, 16
s_branch L2_rare_t0_4_0
L2_rare_t0_4_0:
s_nop 15
s_nop 15
s_waitcnt lgkmcnt(0)
v_exp_f32 v248, v128
s_nop 0
v_sub_f32 v224, v224, v248
v_exp_f32 v248, v129
s_nop 0
v_sub_f32 v224, v224, v248
v_exp_f32 v248, v130
s_nop 0
v_sub_f32 v224, v224, v248
v_exp_f32 v248, v131
s_nop 0
v_sub_f32 v224, v224, v248
v_max_f32 v224, 0, v224
v_min_f32 v224, s32, v224
v_log_f32 v248, v224
v_max3_f32 v232, v128, v129, v130
v_max3_f32 v232, v232, v131, v248
v_mov_b32 v248, v232
s_nop 1
v_permlane32_swap_b32 v232, v248
s_nop 1
v_max_f32 v232, v232, v248
v_mov_b32 v248, v232
s_nop 1
v_permlane16_swap_b32 v232, v248
s_nop 1
v_max_f32 v232, v232, v248
v_ceil_f32 v232, v232
v_max_f32 v232, 0, v232
v_sub_f32 v248, 0, v232
v_exp_f32 v236, v248
s_nop 1
v_mul_f32 v224, v224, v236
v_sub_f32 v192, v192, v232
v_sub_f32 v128, v128, v232
v_sub_f32 v144, v144, v232
v_sub_f32 v193, v193, v232
v_sub_f32 v129, v129, v232
v_sub_f32 v145, v145, v232
v_sub_f32 v194, v194, v232
v_sub_f32 v130, v130, v232
v_sub_f32 v146, v146, v232
v_sub_f32 v195, v195, v232
v_sub_f32 v131, v131, v232
v_sub_f32 v147, v147, v232
v_lshlrev_b32 v242, 16, v4
v_and_b32 v248, 0xffff0000, v4
v_mul_f32 v242, v242, v236
v_mul_f32 v248, v248, v236
v_cvt_pk_bf16_f32 v4, v242, v248
v_lshlrev_b32 v242, 16, v5
v_and_b32 v248, 0xffff0000, v5
v_mul_f32 v242, v242, v236
v_mul_f32 v248, v248, v236
v_cvt_pk_bf16_f32 v5, v242, v248
v_lshlrev_b32 v242, 16, v6
v_and_b32 v248, 0xffff0000, v6
v_mul_f32 v242, v242, v236
v_mul_f32 v248, v248, v236
v_cvt_pk_bf16_f32 v6, v242, v248
v_lshlrev_b32 v242, 16, v7
v_and_b32 v248, 0xffff0000, v7
v_mul_f32 v242, v242, v236
v_mul_f32 v248, v248, v236
v_cvt_pk_bf16_f32 v7, v242, v248
v_lshlrev_b32 v242, 16, v8
v_and_b32 v248, 0xffff0000, v8
v_mul_f32 v242, v242, v236
v_mul_f32 v248, v248, v236
v_cvt_pk_bf16_f32 v8, v242, v248
v_lshlrev_b32 v242, 16, v9
v_and_b32 v248, 0xffff0000, v9
v_mul_f32 v242, v242, v236
v_mul_f32 v248, v248, v236
v_cvt_pk_bf16_f32 v9, v242, v248
v_lshlrev_b32 v242, 16, v10
v_and_b32 v248, 0xffff0000, v10
v_mul_f32 v242, v242, v236
v_mul_f32 v248, v248, v236
v_cvt_pk_bf16_f32 v10, v242, v248
v_lshlrev_b32 v242, 16, v11
v_and_b32 v248, 0xffff0000, v11
v_mul_f32 v242, v242, v236
v_mul_f32 v248, v248, v236
v_cvt_pk_bf16_f32 v11, v242, v248
v_lshlrev_b32 v242, 16, v160
v_and_b32 v248, 0xffff0000, v160
v_mul_f32 v242, v242, v236
v_mul_f32 v248, v248, v236
v_cvt_pk_bf16_f32 v160, v242, v248
v_lshlrev_b32 v242, 16, v161
v_and_b32 v248, 0xffff0000, v161
v_mul_f32 v242, v242, v236
v_mul_f32 v248, v248, v236
v_cvt_pk_bf16_f32 v161, v242, v248
v_lshlrev_b32 v242, 16, v162
v_and_b32 v248, 0xffff0000, v162
v_mul_f32 v242, v242, v236
v_mul_f32 v248, v248, v236
v_cvt_pk_bf16_f32 v162, v242, v248
v_lshlrev_b32 v242, 16, v163
v_and_b32 v248, 0xffff0000, v163
v_mul_f32 v242, v242, v236
v_mul_f32 v248, v248, v236
v_cvt_pk_bf16_f32 v163, v242, v248
v_lshlrev_b32 v242, 16, v176
v_and_b32 v248, 0xffff0000, v176
v_mul_f32 v242, v242, v236
v_mul_f32 v248, v248, v236
v_cvt_pk_bf16_f32 v176, v242, v248
v_lshlrev_b32 v242, 16, v177
v_and_b32 v248, 0xffff0000, v177
v_mul_f32 v242, v242, v236
v_mul_f32 v248, v248, v236
v_cvt_pk_bf16_f32 v177, v242, v248
v_lshlrev_b32 v242, 16, v178
v_and_b32 v248, 0xffff0000, v178
v_mul_f32 v242, v242, v236
v_mul_f32 v248, v248, v236
v_cvt_pk_bf16_f32 v178, v242, v248
v_lshlrev_b32 v242, 16, v179
v_and_b32 v248, 0xffff0000, v179
v_mul_f32 v242, v242, v236
v_mul_f32 v248, v248, v236
v_cvt_pk_bf16_f32 v179, v242, v248
v_exp_f32 v248, v132
s_nop 0
v_sub_f32 v225, v225, v248
v_exp_f32 v248, v133
s_nop 0
v_sub_f32 v225, v225, v248
v_exp_f32 v248, v134
s_nop 0
v_sub_f32 v225, v225, v248
v_exp_f32 v248, v135
s_nop 0
v_sub_f32 v225, v225, v248
v_max_f32 v225, 0, v225
v_min_f32 v225, s32, v225
v_log_f32 v248, v225
v_max3_f32 v233, v132, v133, v134
v_max3_f32 v233, v233, v135, v248
v_mov_b32 v248, v233
s_nop 1
v_permlane32_swap_b32 v233, v248
s_nop 1
v_max_f32 v233, v233, v248
v_mov_b32 v248, v233
s_nop 1
v_permlane16_swap_b32 v233, v248
s_nop 1
v_max_f32 v233, v233, v248
v_ceil_f32 v233, v233
v_max_f32 v233, 0, v233
v_sub_f32 v248, 0, v233
v_exp_f32 v237, v248
s_nop 1
v_mul_f32 v225, v225, v237
v_sub_f32 v196, v196, v233
v_sub_f32 v132, v132, v233
v_sub_f32 v148, v148, v233
v_sub_f32 v197, v197, v233
v_sub_f32 v133, v133, v233
v_sub_f32 v149, v149, v233
v_sub_f32 v198, v198, v233
v_sub_f32 v134, v134, v233
v_sub_f32 v150, v150, v233
v_sub_f32 v199, v199, v233
v_sub_f32 v135, v135, v233
v_sub_f32 v151, v151, v233
v_lshlrev_b32 v242, 16, v36
v_and_b32 v248, 0xffff0000, v36
v_mul_f32 v242, v242, v237
v_mul_f32 v248, v248, v237
v_cvt_pk_bf16_f32 v36, v242, v248
v_lshlrev_b32 v242, 16, v37
v_and_b32 v248, 0xffff0000, v37
v_mul_f32 v242, v242, v237
v_mul_f32 v248, v248, v237
v_cvt_pk_bf16_f32 v37, v242, v248
v_lshlrev_b32 v242, 16, v38
v_and_b32 v248, 0xffff0000, v38
v_mul_f32 v242, v242, v237
v_mul_f32 v248, v248, v237
v_cvt_pk_bf16_f32 v38, v242, v248
v_lshlrev_b32 v242, 16, v39
v_and_b32 v248, 0xffff0000, v39
v_mul_f32 v242, v242, v237
v_mul_f32 v248, v248, v237
v_cvt_pk_bf16_f32 v39, v242, v248
v_lshlrev_b32 v242, 16, v40
v_and_b32 v248, 0xffff0000, v40
v_mul_f32 v242, v242, v237
v_mul_f32 v248, v248, v237
v_cvt_pk_bf16_f32 v40, v242, v248
v_lshlrev_b32 v242, 16, v41
v_and_b32 v248, 0xffff0000, v41
v_mul_f32 v242, v242, v237
v_mul_f32 v248, v248, v237
v_cvt_pk_bf16_f32 v41, v242, v248
v_lshlrev_b32 v242, 16, v42
v_and_b32 v248, 0xffff0000, v42
v_mul_f32 v242, v242, v237
v_mul_f32 v248, v248, v237
v_cvt_pk_bf16_f32 v42, v242, v248
v_lshlrev_b32 v242, 16, v43
v_and_b32 v248, 0xffff0000, v43
v_mul_f32 v242, v242, v237
v_mul_f32 v248, v248, v237
v_cvt_pk_bf16_f32 v43, v242, v248
v_lshlrev_b32 v242, 16, v164
v_and_b32 v248, 0xffff0000, v164
v_mul_f32 v242, v242, v237
v_mul_f32 v248, v248, v237
v_cvt_pk_bf16_f32 v164, v242, v248
v_lshlrev_b32 v242, 16, v165
v_and_b32 v248, 0xffff0000, v165
v_mul_f32 v242, v242, v237
v_mul_f32 v248, v248, v237
v_cvt_pk_bf16_f32 v165, v242, v248
v_lshlrev_b32 v242, 16, v166
v_and_b32 v248, 0xffff0000, v166
v_mul_f32 v242, v242, v237
v_mul_f32 v248, v248, v237
v_cvt_pk_bf16_f32 v166, v242, v248
v_lshlrev_b32 v242, 16, v167
v_and_b32 v248, 0xffff0000, v167
v_mul_f32 v242, v242, v237
v_mul_f32 v248, v248, v237
v_cvt_pk_bf16_f32 v167, v242, v248
v_lshlrev_b32 v242, 16, v180
v_and_b32 v248, 0xffff0000, v180
v_mul_f32 v242, v242, v237
v_mul_f32 v248, v248, v237
v_cvt_pk_bf16_f32 v180, v242, v248
v_lshlrev_b32 v242, 16, v181
v_and_b32 v248, 0xffff0000, v181
v_mul_f32 v242, v242, v237
v_mul_f32 v248, v248, v237
v_cvt_pk_bf16_f32 v181, v242, v248
v_lshlrev_b32 v242, 16, v182
v_and_b32 v248, 0xffff0000, v182
v_mul_f32 v242, v242, v237
v_mul_f32 v248, v248, v237
v_cvt_pk_bf16_f32 v182, v242, v248
v_lshlrev_b32 v242, 16, v183
v_and_b32 v248, 0xffff0000, v183
v_mul_f32 v242, v242, v237
v_mul_f32 v248, v248, v237
v_cvt_pk_bf16_f32 v183, v242, v248
v_exp_f32 v248, v136
s_nop 0
v_sub_f32 v226, v226, v248
v_exp_f32 v248, v137
s_nop 0
v_sub_f32 v226, v226, v248
v_exp_f32 v248, v138
s_nop 0
v_sub_f32 v226, v226, v248
v_exp_f32 v248, v139
s_nop 0
v_sub_f32 v226, v226, v248
v_max_f32 v226, 0, v226
v_min_f32 v226, s32, v226
v_log_f32 v248, v226
v_max3_f32 v234, v136, v137, v138
v_max3_f32 v234, v234, v139, v248
v_mov_b32 v248, v234
s_nop 1
v_permlane32_swap_b32 v234, v248
s_nop 1
v_max_f32 v234, v234, v248
v_mov_b32 v248, v234
s_nop 1
v_permlane16_swap_b32 v234, v248
s_nop 1
v_max_f32 v234, v234, v248
v_ceil_f32 v234, v234
v_max_f32 v234, 0, v234
v_sub_f32 v248, 0, v234
v_exp_f32 v238, v248
s_nop 1
v_mul_f32 v226, v226, v238
v_sub_f32 v200, v200, v234
v_sub_f32 v136, v136, v234
v_sub_f32 v152, v152, v234
v_sub_f32 v201, v201, v234
v_sub_f32 v137, v137, v234
v_sub_f32 v153, v153, v234
v_sub_f32 v202, v202, v234
v_sub_f32 v138, v138, v234
v_sub_f32 v154, v154, v234
v_sub_f32 v203, v203, v234
v_sub_f32 v139, v139, v234
v_sub_f32 v155, v155, v234
v_lshlrev_b32 v242, 16, v68
v_and_b32 v248, 0xffff0000, v68
v_mul_f32 v242, v242, v238
v_mul_f32 v248, v248, v238
v_cvt_pk_bf16_f32 v68, v242, v248
v_lshlrev_b32 v242, 16, v69
v_and_b32 v248, 0xffff0000, v69
v_mul_f32 v242, v242, v238
v_mul_f32 v248, v248, v238
v_cvt_pk_bf16_f32 v69, v242, v248
v_lshlrev_b32 v242, 16, v70
v_and_b32 v248, 0xffff0000, v70
v_mul_f32 v242, v242, v238
v_mul_f32 v248, v248, v238
v_cvt_pk_bf16_f32 v70, v242, v248
v_lshlrev_b32 v242, 16, v71
v_and_b32 v248, 0xffff0000, v71
v_mul_f32 v242, v242, v238
v_mul_f32 v248, v248, v238
v_cvt_pk_bf16_f32 v71, v242, v248
v_lshlrev_b32 v242, 16, v72
v_and_b32 v248, 0xffff0000, v72
v_mul_f32 v242, v242, v238
v_mul_f32 v248, v248, v238
v_cvt_pk_bf16_f32 v72, v242, v248
v_lshlrev_b32 v242, 16, v73
v_and_b32 v248, 0xffff0000, v73
v_mul_f32 v242, v242, v238
v_mul_f32 v248, v248, v238
v_cvt_pk_bf16_f32 v73, v242, v248
v_lshlrev_b32 v242, 16, v74
v_and_b32 v248, 0xffff0000, v74
v_mul_f32 v242, v242, v238
v_mul_f32 v248, v248, v238
v_cvt_pk_bf16_f32 v74, v242, v248
v_lshlrev_b32 v242, 16, v75
v_and_b32 v248, 0xffff0000, v75
v_mul_f32 v242, v242, v238
v_mul_f32 v248, v248, v238
v_cvt_pk_bf16_f32 v75, v242, v248
v_lshlrev_b32 v242, 16, v168
v_and_b32 v248, 0xffff0000, v168
v_mul_f32 v242, v242, v238
v_mul_f32 v248, v248, v238
v_cvt_pk_bf16_f32 v168, v242, v248
v_lshlrev_b32 v242, 16, v169
v_and_b32 v248, 0xffff0000, v169
v_mul_f32 v242, v242, v238
v_mul_f32 v248, v248, v238
v_cvt_pk_bf16_f32 v169, v242, v248
v_lshlrev_b32 v242, 16, v170
v_and_b32 v248, 0xffff0000, v170
v_mul_f32 v242, v242, v238
v_mul_f32 v248, v248, v238
v_cvt_pk_bf16_f32 v170, v242, v248
v_lshlrev_b32 v242, 16, v171
v_and_b32 v248, 0xffff0000, v171
v_mul_f32 v242, v242, v238
v_mul_f32 v248, v248, v238
v_cvt_pk_bf16_f32 v171, v242, v248
v_lshlrev_b32 v242, 16, v184
v_and_b32 v248, 0xffff0000, v184
v_mul_f32 v242, v242, v238
v_mul_f32 v248, v248, v238
v_cvt_pk_bf16_f32 v184, v242, v248
v_lshlrev_b32 v242, 16, v185
v_and_b32 v248, 0xffff0000, v185
v_mul_f32 v242, v242, v238
v_mul_f32 v248, v248, v238
v_cvt_pk_bf16_f32 v185, v242, v248
v_lshlrev_b32 v242, 16, v186
v_and_b32 v248, 0xffff0000, v186
v_mul_f32 v242, v242, v238
v_mul_f32 v248, v248, v238
v_cvt_pk_bf16_f32 v186, v242, v248
v_lshlrev_b32 v242, 16, v187
v_and_b32 v248, 0xffff0000, v187
v_mul_f32 v242, v242, v238
v_mul_f32 v248, v248, v238
v_cvt_pk_bf16_f32 v187, v242, v248
v_exp_f32 v248, v140
s_nop 0
v_sub_f32 v227, v227, v248
v_exp_f32 v248, v141
s_nop 0
v_sub_f32 v227, v227, v248
v_exp_f32 v248, v142
s_nop 0
v_sub_f32 v227, v227, v248
v_exp_f32 v248, v143
s_nop 0
v_sub_f32 v227, v227, v248
v_max_f32 v227, 0, v227
v_min_f32 v227, s32, v227
v_log_f32 v248, v227
v_max3_f32 v235, v140, v141, v142
v_max3_f32 v235, v235, v143, v248
v_mov_b32 v248, v235
s_nop 1
v_permlane32_swap_b32 v235, v248
s_nop 1
v_max_f32 v235, v235, v248
v_mov_b32 v248, v235
s_nop 1
v_permlane16_swap_b32 v235, v248
s_nop 1
v_max_f32 v235, v235, v248
v_ceil_f32 v235, v235
v_max_f32 v235, 0, v235
v_sub_f32 v248, 0, v235
v_exp_f32 v239, v248
s_nop 1
v_mul_f32 v227, v227, v239
v_sub_f32 v204, v204, v235
v_sub_f32 v140, v140, v235
v_sub_f32 v156, v156, v235
v_sub_f32 v205, v205, v235
v_sub_f32 v141, v141, v235
v_sub_f32 v157, v157, v235
v_sub_f32 v206, v206, v235
v_sub_f32 v142, v142, v235
v_sub_f32 v158, v158, v235
v_sub_f32 v207, v207, v235
v_sub_f32 v143, v143, v235
v_sub_f32 v159, v159, v235
v_lshlrev_b32 v242, 16, v100
v_and_b32 v248, 0xffff0000, v100
v_mul_f32 v242, v242, v239
v_mul_f32 v248, v248, v239
v_cvt_pk_bf16_f32 v100, v242, v248
v_lshlrev_b32 v242, 16, v101
v_and_b32 v248, 0xffff0000, v101
v_mul_f32 v242, v242, v239
v_mul_f32 v248, v248, v239
v_cvt_pk_bf16_f32 v101, v242, v248
v_lshlrev_b32 v242, 16, v102
v_and_b32 v248, 0xffff0000, v102
v_mul_f32 v242, v242, v239
v_mul_f32 v248, v248, v239
v_cvt_pk_bf16_f32 v102, v242, v248
v_lshlrev_b32 v242, 16, v103
v_and_b32 v248, 0xffff0000, v103
v_mul_f32 v242, v242, v239
v_mul_f32 v248, v248, v239
v_cvt_pk_bf16_f32 v103, v242, v248
v_lshlrev_b32 v242, 16, v104
v_and_b32 v248, 0xffff0000, v104
v_mul_f32 v242, v242, v239
v_mul_f32 v248, v248, v239
v_cvt_pk_bf16_f32 v104, v242, v248
v_lshlrev_b32 v242, 16, v105
v_and_b32 v248, 0xffff0000, v105
v_mul_f32 v242, v242, v239
v_mul_f32 v248, v248, v239
v_cvt_pk_bf16_f32 v105, v242, v248
v_lshlrev_b32 v242, 16, v106
v_and_b32 v248, 0xffff0000, v106
v_mul_f32 v242, v242, v239
v_mul_f32 v248, v248, v239
v_cvt_pk_bf16_f32 v106, v242, v248
v_lshlrev_b32 v242, 16, v107
v_and_b32 v248, 0xffff0000, v107
v_mul_f32 v242, v242, v239
v_mul_f32 v248, v248, v239
v_cvt_pk_bf16_f32 v107, v242, v248
v_lshlrev_b32 v242, 16, v172
v_and_b32 v248, 0xffff0000, v172
v_mul_f32 v242, v242, v239
v_mul_f32 v248, v248, v239
v_cvt_pk_bf16_f32 v172, v242, v248
v_lshlrev_b32 v242, 16, v173
v_and_b32 v248, 0xffff0000, v173
v_mul_f32 v242, v242, v239
v_mul_f32 v248, v248, v239
v_cvt_pk_bf16_f32 v173, v242, v248
v_lshlrev_b32 v242, 16, v174
v_and_b32 v248, 0xffff0000, v174
v_mul_f32 v242, v242, v239
v_mul_f32 v248, v248, v239
v_cvt_pk_bf16_f32 v174, v242, v248
v_lshlrev_b32 v242, 16, v175
v_and_b32 v248, 0xffff0000, v175
v_mul_f32 v242, v242, v239
v_mul_f32 v248, v248, v239
v_cvt_pk_bf16_f32 v175, v242, v248
v_lshlrev_b32 v242, 16, v188
v_and_b32 v248, 0xffff0000, v188
v_mul_f32 v242, v242, v239
v_mul_f32 v248, v248, v239
v_cvt_pk_bf16_f32 v188, v242, v248
v_lshlrev_b32 v242, 16, v189
v_and_b32 v248, 0xffff0000, v189
v_mul_f32 v242, v242, v239
v_mul_f32 v248, v248, v239
v_cvt_pk_bf16_f32 v189, v242, v248
v_lshlrev_b32 v242, 16, v190
v_and_b32 v248, 0xffff0000, v190
v_mul_f32 v242, v242, v239
v_mul_f32 v248, v248, v239
v_cvt_pk_bf16_f32 v190, v242, v248
v_lshlrev_b32 v242, 16, v191
v_and_b32 v248, 0xffff0000, v191
v_mul_f32 v242, v242, v239
v_mul_f32 v248, v248, v239
v_cvt_pk_bf16_f32 v191, v242, v248
v_exp_f32 v232, v128
v_exp_f32 v233, v129
v_exp_f32 v234, v130
v_exp_f32 v235, v131
s_nop 1
v_add_f32 v224, v224, v232
v_add_f32 v224, v224, v233
v_add_f32 v224, v224, v234
v_add_f32 v224, v224, v235
v_cvt_pk_bf16_f32 v0, v232, v233
v_cvt_pk_bf16_f32 v1, v234, v235
v_exp_f32 v232, v132
v_exp_f32 v233, v133
v_exp_f32 v234, v134
v_exp_f32 v235, v135
s_nop 1
v_add_f32 v225, v225, v232
v_add_f32 v225, v225, v233
v_add_f32 v225, v225, v234
v_add_f32 v225, v225, v235
v_cvt_pk_bf16_f32 v32, v232, v233
v_cvt_pk_bf16_f32 v33, v234, v235
v_exp_f32 v232, v136
v_exp_f32 v233, v137
v_exp_f32 v234, v138
v_exp_f32 v235, v139
s_nop 1
v_add_f32 v226, v226, v232
v_add_f32 v226, v226, v233
v_add_f32 v226, v226, v234
v_add_f32 v226, v226, v235
v_cvt_pk_bf16_f32 v64, v232, v233
v_cvt_pk_bf16_f32 v65, v234, v235
v_exp_f32 v232, v140
v_exp_f32 v233, v141
v_exp_f32 v234, v142
v_exp_f32 v235, v143
s_nop 1
v_add_f32 v227, v227, v232
v_add_f32 v227, v227, v233
v_add_f32 v227, v227, v234
v_add_f32 v227, v227, v235
v_cvt_pk_bf16_f32 v96, v232, v233
v_cvt_pk_bf16_f32 v97, v234, v235
s_branch L2_rare_common
L2_rare_site17:
s_mov_b32 s36, 17
s_branch L2_rare_t0_5_1
L2_rare_t0_5_1:
s_nop 15
s_nop 15
s_waitcnt lgkmcnt(0)
v_exp_f32 v248, v144
s_nop 0
v_sub_f32 v224, v224, v248
v_exp_f32 v248, v145
s_nop 0
v_sub_f32 v224, v224, v248
v_exp_f32 v248, v146
s_nop 0
v_sub_f32 v224, v224, v248
v_exp_f32 v248, v147
s_nop 0
v_sub_f32 v224, v224, v248
v_max_f32 v224, 0, v224
v_min_f32 v224, s32, v224
v_log_f32 v248, v224
v_max3_f32 v232, v144, v145, v146
v_max3_f32 v232, v232, v147, v248
v_mov_b32 v248, v232
s_nop 1
v_permlane32_swap_b32 v232, v248
s_nop 1
v_max_f32 v232, v232, v248
v_mov_b32 v248, v232
s_nop 1
v_permlane16_swap_b32 v232, v248
s_nop 1
v_max_f32 v232, v232, v248
v_ceil_f32 v232, v232
v_max_f32 v232, 0, v232
v_sub_f32 v248, 0, v232
v_exp_f32 v236, v248
s_nop 1
v_mul_f32 v224, v224, v236
v_sub_f32 v192, v192, v232
v_sub_f32 v128, v128, v232
v_sub_f32 v144, v144, v232
v_sub_f32 v193, v193, v232
v_sub_f32 v129, v129, v232
v_sub_f32 v145, v145, v232
v_sub_f32 v194, v194, v232
v_sub_f32 v130, v130, v232
v_sub_f32 v146, v146, v232
v_sub_f32 v195, v195, v232
v_sub_f32 v131, v131, v232
v_sub_f32 v147, v147, v232
v_lshlrev_b32 v242, 16, v4
v_and_b32 v248, 0xffff0000, v4
v_mul_f32 v242, v242, v236
v_mul_f32 v248, v248, v236
v_cvt_pk_bf16_f32 v4, v242, v248
v_lshlrev_b32 v242, 16, v5
v_and_b32 v248, 0xffff0000, v5
v_mul_f32 v242, v242, v236
v_mul_f32 v248, v248, v236
v_cvt_pk_bf16_f32 v5, v242, v248
v_lshlrev_b32 v242, 16, v6
v_and_b32 v248, 0xffff0000, v6
v_mul_f32 v242, v242, v236
v_mul_f32 v248, v248, v236
v_cvt_pk_bf16_f32 v6, v242, v248
v_lshlrev_b32 v242, 16, v7
v_and_b32 v248, 0xffff0000, v7
v_mul_f32 v242, v242, v236
v_mul_f32 v248, v248, v236
v_cvt_pk_bf16_f32 v7, v242, v248
v_lshlrev_b32 v242, 16, v8
v_and_b32 v248, 0xffff0000, v8
v_mul_f32 v242, v242, v236
v_mul_f32 v248, v248, v236
v_cvt_pk_bf16_f32 v8, v242, v248
v_lshlrev_b32 v242, 16, v9
v_and_b32 v248, 0xffff0000, v9
v_mul_f32 v242, v242, v236
v_mul_f32 v248, v248, v236
v_cvt_pk_bf16_f32 v9, v242, v248
v_lshlrev_b32 v242, 16, v10
v_and_b32 v248, 0xffff0000, v10
v_mul_f32 v242, v242, v236
v_mul_f32 v248, v248, v236
v_cvt_pk_bf16_f32 v10, v242, v248
v_lshlrev_b32 v242, 16, v11
v_and_b32 v248, 0xffff0000, v11
v_mul_f32 v242, v242, v236
v_mul_f32 v248, v248, v236
v_cvt_pk_bf16_f32 v11, v242, v248
v_lshlrev_b32 v242, 16, v160
v_and_b32 v248, 0xffff0000, v160
v_mul_f32 v242, v242, v236
v_mul_f32 v248, v248, v236
v_cvt_pk_bf16_f32 v160, v242, v248
v_lshlrev_b32 v242, 16, v161
v_and_b32 v248, 0xffff0000, v161
v_mul_f32 v242, v242, v236
v_mul_f32 v248, v248, v236
v_cvt_pk_bf16_f32 v161, v242, v248
v_lshlrev_b32 v242, 16, v162
v_and_b32 v248, 0xffff0000, v162
v_mul_f32 v242, v242, v236
v_mul_f32 v248, v248, v236
v_cvt_pk_bf16_f32 v162, v242, v248
v_lshlrev_b32 v242, 16, v163
v_and_b32 v248, 0xffff0000, v163
v_mul_f32 v242, v242, v236
v_mul_f32 v248, v248, v236
v_cvt_pk_bf16_f32 v163, v242, v248
v_lshlrev_b32 v242, 16, v176
v_and_b32 v248, 0xffff0000, v176
v_mul_f32 v242, v242, v236
v_mul_f32 v248, v248, v236
v_cvt_pk_bf16_f32 v176, v242, v248
v_lshlrev_b32 v242, 16, v177
v_and_b32 v248, 0xffff0000, v177
v_mul_f32 v242, v242, v236
v_mul_f32 v248, v248, v236
v_cvt_pk_bf16_f32 v177, v242, v248
v_lshlrev_b32 v242, 16, v178
v_and_b32 v248, 0xffff0000, v178
v_mul_f32 v242, v242, v236
v_mul_f32 v248, v248, v236
v_cvt_pk_bf16_f32 v178, v242, v248
v_lshlrev_b32 v242, 16, v179
v_and_b32 v248, 0xffff0000, v179
v_mul_f32 v242, v242, v236
v_mul_f32 v248, v248, v236
v_cvt_pk_bf16_f32 v179, v242, v248
v_lshlrev_b32 v242, 16, v0
v_and_b32 v248, 0xffff0000, v0
v_mul_f32 v242, v242, v236
v_mul_f32 v248, v248, v236
v_cvt_pk_bf16_f32 v0, v242, v248
v_lshlrev_b32 v242, 16, v1
v_and_b32 v248, 0xffff0000, v1
v_mul_f32 v242, v242, v236
v_mul_f32 v248, v248, v236
v_cvt_pk_bf16_f32 v1, v242, v248
v_exp_f32 v248, v148
s_nop 0
v_sub_f32 v225, v225, v248
v_exp_f32 v248, v149
s_nop 0
v_sub_f32 v225, v225, v248
v_exp_f32 v248, v150
s_nop 0
v_sub_f32 v225, v225, v248
v_exp_f32 v248, v151
s_nop 0
v_sub_f32 v225, v225, v248
v_max_f32 v225, 0, v225
v_min_f32 v225, s32, v225
v_log_f32 v248, v225
v_max3_f32 v233, v148, v149, v150
v_max3_f32 v233, v233, v151, v248
v_mov_b32 v248, v233
s_nop 1
v_permlane32_swap_b32 v233, v248
s_nop 1
v_max_f32 v233, v233, v248
v_mov_b32 v248, v233
s_nop 1
v_permlane16_swap_b32 v233, v248
s_nop 1
v_max_f32 v233, v233, v248
v_ceil_f32 v233, v233
v_max_f32 v233, 0, v233
v_sub_f32 v248, 0, v233
v_exp_f32 v237, v248
s_nop 1
v_mul_f32 v225, v225, v237
v_sub_f32 v196, v196, v233
v_sub_f32 v132, v132, v233
v_sub_f32 v148, v148, v233
v_sub_f32 v197, v197, v233
v_sub_f32 v133, v133, v233
v_sub_f32 v149, v149, v233
v_sub_f32 v198, v198, v233
v_sub_f32 v134, v134, v233
v_sub_f32 v150, v150, v233
v_sub_f32 v199, v199, v233
v_sub_f32 v135, v135, v233
v_sub_f32 v151, v151, v233
v_lshlrev_b32 v242, 16, v36
v_and_b32 v248, 0xffff0000, v36
v_mul_f32 v242, v242, v237
v_mul_f32 v248, v248, v237
v_cvt_pk_bf16_f32 v36, v242, v248
v_lshlrev_b32 v242, 16, v37
v_and_b32 v248, 0xffff0000, v37
v_mul_f32 v242, v242, v237
v_mul_f32 v248, v248, v237
v_cvt_pk_bf16_f32 v37, v242, v248
v_lshlrev_b32 v242, 16, v38
v_and_b32 v248, 0xffff0000, v38
v_mul_f32 v242, v242, v237
v_mul_f32 v248, v248, v237
v_cvt_pk_bf16_f32 v38, v242, v248
v_lshlrev_b32 v242, 16, v39
v_and_b32 v248, 0xffff0000, v39
v_mul_f32 v242, v242, v237
v_mul_f32 v248, v248, v237
v_cvt_pk_bf16_f32 v39, v242, v248
v_lshlrev_b32 v242, 16, v40
v_and_b32 v248, 0xffff0000, v40
v_mul_f32 v242, v242, v237
v_mul_f32 v248, v248, v237
v_cvt_pk_bf16_f32 v40, v242, v248
v_lshlrev_b32 v242, 16, v41
v_and_b32 v248, 0xffff0000, v41
v_mul_f32 v242, v242, v237
v_mul_f32 v248, v248, v237
v_cvt_pk_bf16_f32 v41, v242, v248
v_lshlrev_b32 v242, 16, v42
v_and_b32 v248, 0xffff0000, v42
v_mul_f32 v242, v242, v237
v_mul_f32 v248, v248, v237
v_cvt_pk_bf16_f32 v42, v242, v248
v_lshlrev_b32 v242, 16, v43
v_and_b32 v248, 0xffff0000, v43
v_mul_f32 v242, v242, v237
v_mul_f32 v248, v248, v237
v_cvt_pk_bf16_f32 v43, v242, v248
v_lshlrev_b32 v242, 16, v164
v_and_b32 v248, 0xffff0000, v164
v_mul_f32 v242, v242, v237
v_mul_f32 v248, v248, v237
v_cvt_pk_bf16_f32 v164, v242, v248
v_lshlrev_b32 v242, 16, v165
v_and_b32 v248, 0xffff0000, v165
v_mul_f32 v242, v242, v237
v_mul_f32 v248, v248, v237
v_cvt_pk_bf16_f32 v165, v242, v248
v_lshlrev_b32 v242, 16, v166
v_and_b32 v248, 0xffff0000, v166
v_mul_f32 v242, v242, v237
v_mul_f32 v248, v248, v237
v_cvt_pk_bf16_f32 v166, v242, v248
v_lshlrev_b32 v242, 16, v167
v_and_b32 v248, 0xffff0000, v167
v_mul_f32 v242, v242, v237
v_mul_f32 v248, v248, v237
v_cvt_pk_bf16_f32 v167, v242, v248
v_lshlrev_b32 v242, 16, v180
v_and_b32 v248, 0xffff0000, v180
v_mul_f32 v242, v242, v237
v_mul_f32 v248, v248, v237
v_cvt_pk_bf16_f32 v180, v242, v248
v_lshlrev_b32 v242, 16, v181
v_and_b32 v248, 0xffff0000, v181
v_mul_f32 v242, v242, v237
v_mul_f32 v248, v248, v237
v_cvt_pk_bf16_f32 v181, v242, v248
v_lshlrev_b32 v242, 16, v182
v_and_b32 v248, 0xffff0000, v182
v_mul_f32 v242, v242, v237
v_mul_f32 v248, v248, v237
v_cvt_pk_bf16_f32 v182, v242, v248
v_lshlrev_b32 v242, 16, v183
v_and_b32 v248, 0xffff0000, v183
v_mul_f32 v242, v242, v237
v_mul_f32 v248, v248, v237
v_cvt_pk_bf16_f32 v183, v242, v248
v_lshlrev_b32 v242, 16, v32
v_and_b32 v248, 0xffff0000, v32
v_mul_f32 v242, v242, v237
v_mul_f32 v248, v248, v237
v_cvt_pk_bf16_f32 v32, v242, v248
v_lshlrev_b32 v242, 16, v33
v_and_b32 v248, 0xffff0000, v33
v_mul_f32 v242, v242, v237
v_mul_f32 v248, v248, v237
v_cvt_pk_bf16_f32 v33, v242, v248
v_exp_f32 v248, v152
s_nop 0
v_sub_f32 v226, v226, v248
v_exp_f32 v248, v153
s_nop 0
v_sub_f32 v226, v226, v248
v_exp_f32 v248, v154
s_nop 0
v_sub_f32 v226, v226, v248
v_exp_f32 v248, v155
s_nop 0
v_sub_f32 v226, v226, v248
v_max_f32 v226, 0, v226
v_min_f32 v226, s32, v226
v_log_f32 v248, v226
v_max3_f32 v234, v152, v153, v154
v_max3_f32 v234, v234, v155, v248
v_mov_b32 v248, v234
s_nop 1
v_permlane32_swap_b32 v234, v248
s_nop 1
v_max_f32 v234, v234, v248
v_mov_b32 v248, v234
s_nop 1
v_permlane16_swap_b32 v234, v248
s_nop 1
v_max_f32 v234, v234, v248
v_ceil_f32 v234, v234
v_max_f32 v234, 0, v234
v_sub_f32 v248, 0, v234
v_exp_f32 v238, v248
s_nop 1
v_mul_f32 v226, v226, v238
v_sub_f32 v200, v200, v234
v_sub_f32 v136, v136, v234
v_sub_f32 v152, v152, v234
v_sub_f32 v201, v201, v234
v_sub_f32 v137, v137, v234
v_sub_f32 v153, v153, v234
v_sub_f32 v202, v202, v234
v_sub_f32 v138, v138, v234
v_sub_f32 v154, v154, v234
v_sub_f32 v203, v203, v234
v_sub_f32 v139, v139, v234
v_sub_f32 v155, v155, v234
v_lshlrev_b32 v242, 16, v68
v_and_b32 v248, 0xffff0000, v68
v_mul_f32 v242, v242, v238
v_mul_f32 v248, v248, v238
v_cvt_pk_bf16_f32 v68, v242, v248
v_lshlrev_b32 v242, 16, v69
v_and_b32 v248, 0xffff0000, v69
v_mul_f32 v242, v242, v238
v_mul_f32 v248, v248, v238
v_cvt_pk_bf16_f32 v69, v242, v248
v_lshlrev_b32 v242, 16, v70
v_and_b32 v248, 0xffff0000, v70
v_mul_f32 v242, v242, v238
v_mul_f32 v248, v248, v238
v_cvt_pk_bf16_f32 v70, v242, v248
v_lshlrev_b32 v242, 16, v71
v_and_b32 v248, 0xffff0000, v71
v_mul_f32 v242, v242, v238
v_mul_f32 v248, v248, v238
v_cvt_pk_bf16_f32 v71, v242, v248
v_lshlrev_b32 v242, 16, v72
v_and_b32 v248, 0xffff0000, v72
v_mul_f32 v242, v242, v238
v_mul_f32 v248, v248, v238
v_cvt_pk_bf16_f32 v72, v242, v248
v_lshlrev_b32 v242, 16, v73
v_and_b32 v248, 0xffff0000, v73
v_mul_f32 v242, v242, v238
v_mul_f32 v248, v248, v238
v_cvt_pk_bf16_f32 v73, v242, v248
v_lshlrev_b32 v242, 16, v74
v_and_b32 v248, 0xffff0000, v74
v_mul_f32 v242, v242, v238
v_mul_f32 v248, v248, v238
v_cvt_pk_bf16_f32 v74, v242, v248
v_lshlrev_b32 v242, 16, v75
v_and_b32 v248, 0xffff0000, v75
v_mul_f32 v242, v242, v238
v_mul_f32 v248, v248, v238
v_cvt_pk_bf16_f32 v75, v242, v248
v_lshlrev_b32 v242, 16, v168
v_and_b32 v248, 0xffff0000, v168
v_mul_f32 v242, v242, v238
v_mul_f32 v248, v248, v238
v_cvt_pk_bf16_f32 v168, v242, v248
v_lshlrev_b32 v242, 16, v169
v_and_b32 v248, 0xffff0000, v169
v_mul_f32 v242, v242, v238
v_mul_f32 v248, v248, v238
v_cvt_pk_bf16_f32 v169, v242, v248
v_lshlrev_b32 v242, 16, v170
v_and_b32 v248, 0xffff0000, v170
v_mul_f32 v242, v242, v238
v_mul_f32 v248, v248, v238
v_cvt_pk_bf16_f32 v170, v242, v248
v_lshlrev_b32 v242, 16, v171
v_and_b32 v248, 0xffff0000, v171
v_mul_f32 v242, v242, v238
v_mul_f32 v248, v248, v238
v_cvt_pk_bf16_f32 v171, v242, v248
v_lshlrev_b32 v242, 16, v184
v_and_b32 v248, 0xffff0000, v184
v_mul_f32 v242, v242, v238
v_mul_f32 v248, v248, v238
v_cvt_pk_bf16_f32 v184, v242, v248
v_lshlrev_b32 v242, 16, v185
v_and_b32 v248, 0xffff0000, v185
v_mul_f32 v242, v242, v238
v_mul_f32 v248, v248, v238
v_cvt_pk_bf16_f32 v185, v242, v248
v_lshlrev_b32 v242, 16, v186
v_and_b32 v248, 0xffff0000, v186
v_mul_f32 v242, v242, v238
v_mul_f32 v248, v248, v238
v_cvt_pk_bf16_f32 v186, v242, v248
v_lshlrev_b32 v242, 16, v187
v_and_b32 v248, 0xffff0000, v187
v_mul_f32 v242, v242, v238
v_mul_f32 v248, v248, v238
v_cvt_pk_bf16_f32 v187, v242, v248
v_lshlrev_b32 v242, 16, v64
v_and_b32 v248, 0xffff0000, v64
v_mul_f32 v242, v242, v238
v_mul_f32 v248, v248, v238
v_cvt_pk_bf16_f32 v64, v242, v248
v_lshlrev_b32 v242, 16, v65
v_and_b32 v248, 0xffff0000, v65
v_mul_f32 v242, v242, v238
v_mul_f32 v248, v248, v238
v_cvt_pk_bf16_f32 v65, v242, v248
v_exp_f32 v248, v156
s_nop 0
v_sub_f32 v227, v227, v248
v_exp_f32 v248, v157
s_nop 0
v_sub_f32 v227, v227, v248
v_exp_f32 v248, v158
s_nop 0
v_sub_f32 v227, v227, v248
v_exp_f32 v248, v159
s_nop 0
v_sub_f32 v227, v227, v248
v_max_f32 v227, 0, v227
v_min_f32 v227, s32, v227
v_log_f32 v248, v227
v_max3_f32 v235, v156, v157, v158
v_max3_f32 v235, v235, v159, v248
v_mov_b32 v248, v235
s_nop 1
v_permlane32_swap_b32 v235, v248
s_nop 1
v_max_f32 v235, v235, v248
v_mov_b32 v248, v235
s_nop 1
v_permlane16_swap_b32 v235, v248
s_nop 1
v_max_f32 v235, v235, v248
v_ceil_f32 v235, v235
v_max_f32 v235, 0, v235
v_sub_f32 v248, 0, v235
v_exp_f32 v239, v248
s_nop 1
v_mul_f32 v227, v227, v239
v_sub_f32 v204, v204, v235
v_sub_f32 v140, v140, v235
v_sub_f32 v156, v156, v235
v_sub_f32 v205, v205, v235
v_sub_f32 v141, v141, v235
v_sub_f32 v157, v157, v235
v_sub_f32 v206, v206, v235
v_sub_f32 v142, v142, v235
v_sub_f32 v158, v158, v235
v_sub_f32 v207, v207, v235
v_sub_f32 v143, v143, v235
v_sub_f32 v159, v159, v235
v_lshlrev_b32 v242, 16, v100
v_and_b32 v248, 0xffff0000, v100
v_mul_f32 v242, v242, v239
v_mul_f32 v248, v248, v239
v_cvt_pk_bf16_f32 v100, v242, v248
v_lshlrev_b32 v242, 16, v101
v_and_b32 v248, 0xffff0000, v101
v_mul_f32 v242, v242, v239
v_mul_f32 v248, v248, v239
v_cvt_pk_bf16_f32 v101, v242, v248
v_lshlrev_b32 v242, 16, v102
v_and_b32 v248, 0xffff0000, v102
v_mul_f32 v242, v242, v239
v_mul_f32 v248, v248, v239
v_cvt_pk_bf16_f32 v102, v242, v248
v_lshlrev_b32 v242, 16, v103
v_and_b32 v248, 0xffff0000, v103
v_mul_f32 v242, v242, v239
v_mul_f32 v248, v248, v239
v_cvt_pk_bf16_f32 v103, v242, v248
v_lshlrev_b32 v242, 16, v104
v_and_b32 v248, 0xffff0000, v104
v_mul_f32 v242, v242, v239
v_mul_f32 v248, v248, v239
v_cvt_pk_bf16_f32 v104, v242, v248
v_lshlrev_b32 v242, 16, v105
v_and_b32 v248, 0xffff0000, v105
v_mul_f32 v242, v242, v239
v_mul_f32 v248, v248, v239
v_cvt_pk_bf16_f32 v105, v242, v248
v_lshlrev_b32 v242, 16, v106
v_and_b32 v248, 0xffff0000, v106
v_mul_f32 v242, v242, v239
v_mul_f32 v248, v248, v239
v_cvt_pk_bf16_f32 v106, v242, v248
v_lshlrev_b32 v242, 16, v107
v_and_b32 v248, 0xffff0000, v107
v_mul_f32 v242, v242, v239
v_mul_f32 v248, v248, v239
v_cvt_pk_bf16_f32 v107, v242, v248
v_lshlrev_b32 v242, 16, v172
v_and_b32 v248, 0xffff0000, v172
v_mul_f32 v242, v242, v239
v_mul_f32 v248, v248, v239
v_cvt_pk_bf16_f32 v172, v242, v248
v_lshlrev_b32 v242, 16, v173
v_and_b32 v248, 0xffff0000, v173
v_mul_f32 v242, v242, v239
v_mul_f32 v248, v248, v239
v_cvt_pk_bf16_f32 v173, v242, v248
v_lshlrev_b32 v242, 16, v174
v_and_b32 v248, 0xffff0000, v174
v_mul_f32 v242, v242, v239
v_mul_f32 v248, v248, v239
v_cvt_pk_bf16_f32 v174, v242, v248
v_lshlrev_b32 v242, 16, v175
v_and_b32 v248, 0xffff0000, v175
v_mul_f32 v242, v242, v239
v_mul_f32 v248, v248, v239
v_cvt_pk_bf16_f32 v175, v242, v248
v_lshlrev_b32 v242, 16, v188
v_and_b32 v248, 0xffff0000, v188
v_mul_f32 v242, v242, v239
v_mul_f32 v248, v248, v239
v_cvt_pk_bf16_f32 v188, v242, v248
v_lshlrev_b32 v242, 16, v189
v_and_b32 v248, 0xffff0000, v189
v_mul_f32 v242, v242, v239
v_mul_f32 v248, v248, v239
v_cvt_pk_bf16_f32 v189, v242, v248
v_lshlrev_b32 v242, 16, v190
v_and_b32 v248, 0xffff0000, v190
v_mul_f32 v242, v242, v239
v_mul_f32 v248, v248, v239
v_cvt_pk_bf16_f32 v190, v242, v248
v_lshlrev_b32 v242, 16, v191
v_and_b32 v248, 0xffff0000, v191
v_mul_f32 v242, v242, v239
v_mul_f32 v248, v248, v239
v_cvt_pk_bf16_f32 v191, v242, v248
v_lshlrev_b32 v242, 16, v96
v_and_b32 v248, 0xffff0000, v96
v_mul_f32 v242, v242, v239
v_mul_f32 v248, v248, v239
v_cvt_pk_bf16_f32 v96, v242, v248
v_lshlrev_b32 v242, 16, v97
v_and_b32 v248, 0xffff0000, v97
v_mul_f32 v242, v242, v239
v_mul_f32 v248, v248, v239
v_cvt_pk_bf16_f32 v97, v242, v248
v_exp_f32 v232, v144
v_exp_f32 v233, v145
v_exp_f32 v234, v146
v_exp_f32 v235, v147
s_nop 1
v_add_f32 v224, v224, v232
v_add_f32 v224, v224, v233
v_add_f32 v224, v224, v234
v_add_f32 v224, v224, v235
v_cvt_pk_bf16_f32 v2, v232, v233
v_cvt_pk_bf16_f32 v3, v234, v235
v_exp_f32 v232, v148
v_exp_f32 v233, v149
v_exp_f32 v234, v150
v_exp_f32 v235, v151
s_nop 1
v_add_f32 v225, v225, v232
v_add_f32 v225, v225, v233
v_add_f32 v225, v225, v234
v_add_f32 v225, v225, v235
v_cvt_pk_bf16_f32 v34, v232, v233
v_cvt_pk_bf16_f32 v35, v234, v235
v_exp_f32 v232, v152
v_exp_f32 v233, v153
v_exp_f32 v234, v154
v_exp_f32 v235, v155
s_nop 1
v_add_f32 v226, v226, v232
v_add_f32 v226, v226, v233
v_add_f32 v226, v226, v234
v_add_f32 v226, v226, v235
v_cvt_pk_bf16_f32 v66, v232, v233
v_cvt_pk_bf16_f32 v67, v234, v235
v_exp_f32 v232, v156
v_exp_f32 v233, v157
v_exp_f32 v234, v158
v_exp_f32 v235, v159
s_nop 1
v_add_f32 v227, v227, v232
v_add_f32 v227, v227, v233
v_add_f32 v227, v227, v234
v_add_f32 v227, v227, v235
v_cvt_pk_bf16_f32 v98, v232, v233
v_cvt_pk_bf16_f32 v99, v234, v235
s_branch L2_rare_common
LF_hl_0:
s_mov_b32 s94, 0x10000
s_mov_b32 s3, 0x7c28000
LF_hl2_0:
v_lshlrev_b32 v241, 3, v243
buffer_load_dwordx2 v[240:241], v241, s[16:19], s3 offen sc1
s_sub_u32 s94, s94, 1
s_waitcnt vmcnt(0)
s_cbranch_scc1 LF_hlret_0
v_cmp_ne_u64_e64 s[38:39], s[98:99], v[240:241]
s_and_b64 s[38:39], s[38:39], s[96:97]
s_cbranch_scc1 LF_hl2_0
s_branch LF_hlret_0
L2_rare_common:
v_lshrrev_b32 v232, 4, v243
v_and_b32 v232, 0x30, v232
ds_bpermute_b32 v242, v232, v236 offset:0
ds_bpermute_b32 v248, v232, v236 offset:4
ds_bpermute_b32 v250, v232, v236 offset:8
ds_bpermute_b32 v251, v232, v236 offset:12
s_waitcnt lgkmcnt(0)
v_accvgpr_read_b32 v232, a0
v_accvgpr_read_b32 v233, a1
v_accvgpr_read_b32 v234, a2
v_accvgpr_read_b32 v235, a3
v_mul_f32 v232, v232, v242
v_mul_f32 v233, v233, v248
v_mul_f32 v234, v234, v250
v_mul_f32 v235, v235, v251
v_accvgpr_write_b32 a0, v232
v_accvgpr_write_b32 a1, v233
v_accvgpr_write_b32 a2, v234
v_accvgpr_write_b32 a3, v235
v_accvgpr_read_b32 v232, a16
v_accvgpr_read_b32 v233, a17
v_accvgpr_read_b32 v234, a18
v_accvgpr_read_b32 v235, a19
v_mul_f32 v232, v232, v242
v_mul_f32 v233, v233, v248
v_mul_f32 v234, v234, v250
v_mul_f32 v235, v235, v251
v_accvgpr_write_b32 a16, v232
v_accvgpr_write_b32 a17, v233
v_accvgpr_write_b32 a18, v234
v_accvgpr_write_b32 a19, v235
v_accvgpr_read_b32 v232, a32
v_accvgpr_read_b32 v233, a33
v_accvgpr_read_b32 v234, a34
v_accvgpr_read_b32 v235, a35
v_mul_f32 v232, v232, v242
v_mul_f32 v233, v233, v248
v_mul_f32 v234, v234, v250
v_mul_f32 v235, v235, v251
v_accvgpr_write_b32 a32, v232
v_accvgpr_write_b32 a33, v233
v_accvgpr_write_b32 a34, v234
v_accvgpr_write_b32 a35, v235
v_accvgpr_read_b32 v232, a48
v_accvgpr_read_b32 v233, a49
v_accvgpr_read_b32 v234, a50
v_accvgpr_read_b32 v235, a51
v_mul_f32 v232, v232, v242
v_mul_f32 v233, v233, v248
v_mul_f32 v234, v234, v250
v_mul_f32 v235, v235, v251
v_accvgpr_write_b32 a48, v232
v_accvgpr_write_b32 a49, v233
v_accvgpr_write_b32 a50, v234
v_accvgpr_write_b32 a51, v235
v_accvgpr_read_b32 v232, a64
v_accvgpr_read_b32 v233, a65
v_accvgpr_read_b32 v234, a66
v_accvgpr_read_b32 v235, a67
v_mul_f32 v232, v232, v242
v_mul_f32 v233, v233, v248
v_mul_f32 v234, v234, v250
v_mul_f32 v235, v235, v251
v_accvgpr_write_b32 a64, v232
v_accvgpr_write_b32 a65, v233
v_accvgpr_write_b32 a66, v234
v_accvgpr_write_b32 a67, v235
v_accvgpr_read_b32 v232, a80
v_accvgpr_read_b32 v233, a81
v_accvgpr_read_b32 v234, a82
v_accvgpr_read_b32 v235, a83
v_mul_f32 v232, v232, v242
v_mul_f32 v233, v233, v248
v_mul_f32 v234, v234, v250
v_mul_f32 v235, v235, v251
v_accvgpr_write_b32 a80, v232
v_accvgpr_write_b32 a81, v233
v_accvgpr_write_b32 a82, v234
v_accvgpr_write_b32 a83, v235
v_accvgpr_read_b32 v232, a96
v_accvgpr_read_b32 v233, a97
v_accvgpr_read_b32 v234, a98
v_accvgpr_read_b32 v235, a99
v_mul_f32 v232, v232, v242
v_mul_f32 v233, v233, v248
v_mul_f32 v234, v234, v250
v_mul_f32 v235, v235, v251
v_accvgpr_write_b32 a96, v232
v_accvgpr_write_b32 a97, v233
v_accvgpr_write_b32 a98, v234
v_accvgpr_write_b32 a99, v235
v_accvgpr_read_b32 v232, a112
v_accvgpr_read_b32 v233, a113
v_accvgpr_read_b32 v234, a114
v_accvgpr_read_b32 v235, a115
v_mul_f32 v232, v232, v242
v_mul_f32 v233, v233, v248
v_mul_f32 v234, v234, v250
v_mul_f32 v235, v235, v251
v_accvgpr_write_b32 a112, v232
v_accvgpr_write_b32 a113, v233
v_accvgpr_write_b32 a114, v234
v_accvgpr_write_b32 a115, v235
v_accvgpr_read_b32 v232, a128
v_accvgpr_read_b32 v233, a129
v_accvgpr_read_b32 v234, a130
v_accvgpr_read_b32 v235, a131
v_mul_f32 v232, v232, v242
v_mul_f32 v233, v233, v248
v_mul_f32 v234, v234, v250
v_mul_f32 v235, v235, v251
v_accvgpr_write_b32 a128, v232
v_accvgpr_write_b32 a129, v233
v_accvgpr_write_b32 a130, v234
v_accvgpr_write_b32 a131, v235
v_accvgpr_read_b32 v232, a144
v_accvgpr_read_b32 v233, a145
v_accvgpr_read_b32 v234, a146
v_accvgpr_read_b32 v235, a147
v_mul_f32 v232, v232, v242
v_mul_f32 v233, v233, v248
v_mul_f32 v234, v234, v250
v_mul_f32 v235, v235, v251
v_accvgpr_write_b32 a144, v232
v_accvgpr_write_b32 a145, v233
v_accvgpr_write_b32 a146, v234
v_accvgpr_write_b32 a147, v235
v_accvgpr_read_b32 v232, a160
v_accvgpr_read_b32 v233, a161
v_accvgpr_read_b32 v234, a162
v_accvgpr_read_b32 v235, a163
v_mul_f32 v232, v232, v242
v_mul_f32 v233, v233, v248
v_mul_f32 v234, v234, v250
v_mul_f32 v235, v235, v251
v_accvgpr_write_b32 a160, v232
v_accvgpr_write_b32 a161, v233
v_accvgpr_write_b32 a162, v234
v_accvgpr_write_b32 a163, v235
v_accvgpr_read_b32 v232, a176
v_accvgpr_read_b32 v233, a177
v_accvgpr_read_b32 v234, a178
v_accvgpr_read_b32 v235, a179
v_mul_f32 v232, v232, v242
v_mul_f32 v233, v233, v248
v_mul_f32 v234, v234, v250
v_mul_f32 v235, v235, v251
v_accvgpr_write_b32 a176, v232
v_accvgpr_write_b32 a177, v233
v_accvgpr_write_b32 a178, v234
v_accvgpr_write_b32 a179, v235
v_accvgpr_read_b32 v232, a192
v_accvgpr_read_b32 v233, a193
v_accvgpr_read_b32 v234, a194
v_accvgpr_read_b32 v235, a195
v_mul_f32 v232, v232, v242
v_mul_f32 v233, v233, v248
v_mul_f32 v234, v234, v250
v_mul_f32 v235, v235, v251
v_accvgpr_write_b32 a192, v232
v_accvgpr_write_b32 a193, v233
v_accvgpr_write_b32 a194, v234
v_accvgpr_write_b32 a195, v235
v_accvgpr_read_b32 v232, a208
v_accvgpr_read_b32 v233, a209
v_accvgpr_read_b32 v234, a210
v_accvgpr_read_b32 v235, a211
v_mul_f32 v232, v232, v242
v_mul_f32 v233, v233, v248
v_mul_f32 v234, v234, v250
v_mul_f32 v235, v235, v251
v_accvgpr_write_b32 a208, v232
v_accvgpr_write_b32 a209, v233
v_accvgpr_write_b32 a210, v234
v_accvgpr_write_b32 a211, v235
v_accvgpr_read_b32 v232, a224
v_accvgpr_read_b32 v233, a225
v_accvgpr_read_b32 v234, a226
v_accvgpr_read_b32 v235, a227
v_mul_f32 v232, v232, v242
v_mul_f32 v233, v233, v248
v_mul_f32 v234, v234, v250
v_mul_f32 v235, v235, v251
v_accvgpr_write_b32 a224, v232
v_accvgpr_write_b32 a225, v233
v_accvgpr_write_b32 a226, v234
v_accvgpr_write_b32 a227, v235
v_accvgpr_read_b32 v232, a240
v_accvgpr_read_b32 v233, a241
v_accvgpr_read_b32 v234, a242
v_accvgpr_read_b32 v235, a243
v_mul_f32 v232, v232, v242
v_mul_f32 v233, v233, v248
v_mul_f32 v234, v234, v250
v_mul_f32 v235, v235, v251
v_accvgpr_write_b32 a240, v232
v_accvgpr_write_b32 a241, v233
v_accvgpr_write_b32 a242, v234
v_accvgpr_write_b32 a243, v235
v_lshrrev_b32 v232, 4, v243
v_and_b32 v232, 0x30, v232
ds_bpermute_b32 v242, v232, v237 offset:0
ds_bpermute_b32 v248, v232, v237 offset:4
ds_bpermute_b32 v250, v232, v237 offset:8
ds_bpermute_b32 v251, v232, v237 offset:12
s_waitcnt lgkmcnt(0)
v_accvgpr_read_b32 v232, a4
v_accvgpr_read_b32 v233, a5
v_accvgpr_read_b32 v234, a6
v_accvgpr_read_b32 v235, a7
v_mul_f32 v232, v232, v242
v_mul_f32 v233, v233, v248
v_mul_f32 v234, v234, v250
v_mul_f32 v235, v235, v251
v_accvgpr_write_b32 a4, v232
v_accvgpr_write_b32 a5, v233
v_accvgpr_write_b32 a6, v234
v_accvgpr_write_b32 a7, v235
v_accvgpr_read_b32 v232, a20
v_accvgpr_read_b32 v233, a21
v_accvgpr_read_b32 v234, a22
v_accvgpr_read_b32 v235, a23
v_mul_f32 v232, v232, v242
v_mul_f32 v233, v233, v248
v_mul_f32 v234, v234, v250
v_mul_f32 v235, v235, v251
v_accvgpr_write_b32 a20, v232
v_accvgpr_write_b32 a21, v233
v_accvgpr_write_b32 a22, v234
v_accvgpr_write_b32 a23, v235
v_accvgpr_read_b32 v232, a36
v_accvgpr_read_b32 v233, a37
v_accvgpr_read_b32 v234, a38
v_accvgpr_read_b32 v235, a39
v_mul_f32 v232, v232, v242
v_mul_f32 v233, v233, v248
v_mul_f32 v234, v234, v250
v_mul_f32 v235, v235, v251
v_accvgpr_write_b32 a36, v232
v_accvgpr_write_b32 a37, v233
v_accvgpr_write_b32 a38, v234
v_accvgpr_write_b32 a39, v235
v_accvgpr_read_b32 v232, a52
v_accvgpr_read_b32 v233, a53
v_accvgpr_read_b32 v234, a54
v_accvgpr_read_b32 v235, a55
v_mul_f32 v232, v232, v242
v_mul_f32 v233, v233, v248
v_mul_f32 v234, v234, v250
v_mul_f32 v235, v235, v251
v_accvgpr_write_b32 a52, v232
v_accvgpr_write_b32 a53, v233
v_accvgpr_write_b32 a54, v234
v_accvgpr_write_b32 a55, v235
v_accvgpr_read_b32 v232, a68
v_accvgpr_read_b32 v233, a69
v_accvgpr_read_b32 v234, a70
v_accvgpr_read_b32 v235, a71
v_mul_f32 v232, v232, v242
v_mul_f32 v233, v233, v248
v_mul_f32 v234, v234, v250
v_mul_f32 v235, v235, v251
v_accvgpr_write_b32 a68, v232
v_accvgpr_write_b32 a69, v233
v_accvgpr_write_b32 a70, v234
v_accvgpr_write_b32 a71, v235
v_accvgpr_read_b32 v232, a84
v_accvgpr_read_b32 v233, a85
v_accvgpr_read_b32 v234, a86
v_accvgpr_read_b32 v235, a87
v_mul_f32 v232, v232, v242
v_mul_f32 v233, v233, v248
v_mul_f32 v234, v234, v250
v_mul_f32 v235, v235, v251
v_accvgpr_write_b32 a84, v232
v_accvgpr_write_b32 a85, v233
v_accvgpr_write_b32 a86, v234
v_accvgpr_write_b32 a87, v235
v_accvgpr_read_b32 v232, a100
v_accvgpr_read_b32 v233, a101
v_accvgpr_read_b32 v234, a102
v_accvgpr_read_b32 v235, a103
v_mul_f32 v232, v232, v242
v_mul_f32 v233, v233, v248
v_mul_f32 v234, v234, v250
v_mul_f32 v235, v235, v251
v_accvgpr_write_b32 a100, v232
v_accvgpr_write_b32 a101, v233
v_accvgpr_write_b32 a102, v234
v_accvgpr_write_b32 a103, v235
v_accvgpr_read_b32 v232, a116
v_accvgpr_read_b32 v233, a117
v_accvgpr_read_b32 v234, a118
v_accvgpr_read_b32 v235, a119
v_mul_f32 v232, v232, v242
v_mul_f32 v233, v233, v248
v_mul_f32 v234, v234, v250
v_mul_f32 v235, v235, v251
v_accvgpr_write_b32 a116, v232
v_accvgpr_write_b32 a117, v233
v_accvgpr_write_b32 a118, v234
v_accvgpr_write_b32 a119, v235
v_accvgpr_read_b32 v232, a132
v_accvgpr_read_b32 v233, a133
v_accvgpr_read_b32 v234, a134
v_accvgpr_read_b32 v235, a135
v_mul_f32 v232, v232, v242
v_mul_f32 v233, v233, v248
v_mul_f32 v234, v234, v250
v_mul_f32 v235, v235, v251
v_accvgpr_write_b32 a132, v232
v_accvgpr_write_b32 a133, v233
v_accvgpr_write_b32 a134, v234
v_accvgpr_write_b32 a135, v235
v_accvgpr_read_b32 v232, a148
v_accvgpr_read_b32 v233, a149
v_accvgpr_read_b32 v234, a150
v_accvgpr_read_b32 v235, a151
v_mul_f32 v232, v232, v242
v_mul_f32 v233, v233, v248
v_mul_f32 v234, v234, v250
v_mul_f32 v235, v235, v251
v_accvgpr_write_b32 a148, v232
v_accvgpr_write_b32 a149, v233
v_accvgpr_write_b32 a150, v234
v_accvgpr_write_b32 a151, v235
v_accvgpr_read_b32 v232, a164
v_accvgpr_read_b32 v233, a165
v_accvgpr_read_b32 v234, a166
v_accvgpr_read_b32 v235, a167
v_mul_f32 v232, v232, v242
v_mul_f32 v233, v233, v248
v_mul_f32 v234, v234, v250
v_mul_f32 v235, v235, v251
v_accvgpr_write_b32 a164, v232
v_accvgpr_write_b32 a165, v233
v_accvgpr_write_b32 a166, v234
v_accvgpr_write_b32 a167, v235
v_accvgpr_read_b32 v232, a180
v_accvgpr_read_b32 v233, a181
v_accvgpr_read_b32 v234, a182
v_accvgpr_read_b32 v235, a183
v_mul_f32 v232, v232, v242
v_mul_f32 v233, v233, v248
v_mul_f32 v234, v234, v250
v_mul_f32 v235, v235, v251
v_accvgpr_write_b32 a180, v232
v_accvgpr_write_b32 a181, v233
v_accvgpr_write_b32 a182, v234
v_accvgpr_write_b32 a183, v235
v_accvgpr_read_b32 v232, a196
v_accvgpr_read_b32 v233, a197
v_accvgpr_read_b32 v234, a198
v_accvgpr_read_b32 v235, a199
v_mul_f32 v232, v232, v242
v_mul_f32 v233, v233, v248
v_mul_f32 v234, v234, v250
v_mul_f32 v235, v235, v251
v_accvgpr_write_b32 a196, v232
v_accvgpr_write_b32 a197, v233
v_accvgpr_write_b32 a198, v234
v_accvgpr_write_b32 a199, v235
v_accvgpr_read_b32 v232, a212
v_accvgpr_read_b32 v233, a213
v_accvgpr_read_b32 v234, a214
v_accvgpr_read_b32 v235, a215
v_mul_f32 v232, v232, v242
v_mul_f32 v233, v233, v248
v_mul_f32 v234, v234, v250
v_mul_f32 v235, v235, v251
v_accvgpr_write_b32 a212, v232
v_accvgpr_write_b32 a213, v233
v_accvgpr_write_b32 a214, v234
v_accvgpr_write_b32 a215, v235
v_accvgpr_read_b32 v232, a228
v_accvgpr_read_b32 v233, a229
v_accvgpr_read_b32 v234, a230
v_accvgpr_read_b32 v235, a231
v_mul_f32 v232, v232, v242
v_mul_f32 v233, v233, v248
v_mul_f32 v234, v234, v250
v_mul_f32 v235, v235, v251
v_accvgpr_write_b32 a228, v232
v_accvgpr_write_b32 a229, v233
v_accvgpr_write_b32 a230, v234
v_accvgpr_write_b32 a231, v235
v_accvgpr_read_b32 v232, a244
v_accvgpr_read_b32 v233, a245
v_accvgpr_read_b32 v234, a246
v_accvgpr_read_b32 v235, a247
v_mul_f32 v232, v232, v242
v_mul_f32 v233, v233, v248
v_mul_f32 v234, v234, v250
v_mul_f32 v235, v235, v251
v_accvgpr_write_b32 a244, v232
v_accvgpr_write_b32 a245, v233
v_accvgpr_write_b32 a246, v234
v_accvgpr_write_b32 a247, v235
v_lshrrev_b32 v232, 4, v243
v_and_b32 v232, 0x30, v232
ds_bpermute_b32 v242, v232, v238 offset:0
ds_bpermute_b32 v248, v232, v238 offset:4
ds_bpermute_b32 v250, v232, v238 offset:8
ds_bpermute_b32 v251, v232, v238 offset:12
s_waitcnt lgkmcnt(0)
v_accvgpr_read_b32 v232, a8
v_accvgpr_read_b32 v233, a9
v_accvgpr_read_b32 v234, a10
v_accvgpr_read_b32 v235, a11
v_mul_f32 v232, v232, v242
v_mul_f32 v233, v233, v248
v_mul_f32 v234, v234, v250
v_mul_f32 v235, v235, v251
v_accvgpr_write_b32 a8, v232
v_accvgpr_write_b32 a9, v233
v_accvgpr_write_b32 a10, v234
v_accvgpr_write_b32 a11, v235
v_accvgpr_read_b32 v232, a24
v_accvgpr_read_b32 v233, a25
v_accvgpr_read_b32 v234, a26
v_accvgpr_read_b32 v235, a27
v_mul_f32 v232, v232, v242
v_mul_f32 v233, v233, v248
v_mul_f32 v234, v234, v250
v_mul_f32 v235, v235, v251
v_accvgpr_write_b32 a24, v232
v_accvgpr_write_b32 a25, v233
v_accvgpr_write_b32 a26, v234
v_accvgpr_write_b32 a27, v235
v_accvgpr_read_b32 v232, a40
v_accvgpr_read_b32 v233, a41
v_accvgpr_read_b32 v234, a42
v_accvgpr_read_b32 v235, a43
v_mul_f32 v232, v232, v242
v_mul_f32 v233, v233, v248
v_mul_f32 v234, v234, v250
v_mul_f32 v235, v235, v251
v_accvgpr_write_b32 a40, v232
v_accvgpr_write_b32 a41, v233
v_accvgpr_write_b32 a42, v234
v_accvgpr_write_b32 a43, v235
v_accvgpr_read_b32 v232, a56
v_accvgpr_read_b32 v233, a57
v_accvgpr_read_b32 v234, a58
v_accvgpr_read_b32 v235, a59
v_mul_f32 v232, v232, v242
v_mul_f32 v233, v233, v248
v_mul_f32 v234, v234, v250
v_mul_f32 v235, v235, v251
v_accvgpr_write_b32 a56, v232
v_accvgpr_write_b32 a57, v233
v_accvgpr_write_b32 a58, v234
v_accvgpr_write_b32 a59, v235
v_accvgpr_read_b32 v232, a72
v_accvgpr_read_b32 v233, a73
v_accvgpr_read_b32 v234, a74
v_accvgpr_read_b32 v235, a75
v_mul_f32 v232, v232, v242
v_mul_f32 v233, v233, v248
v_mul_f32 v234, v234, v250
v_mul_f32 v235, v235, v251
v_accvgpr_write_b32 a72, v232
v_accvgpr_write_b32 a73, v233
v_accvgpr_write_b32 a74, v234
v_accvgpr_write_b32 a75, v235
v_accvgpr_read_b32 v232, a88
v_accvgpr_read_b32 v233, a89
v_accvgpr_read_b32 v234, a90
v_accvgpr_read_b32 v235, a91
v_mul_f32 v232, v232, v242
v_mul_f32 v233, v233, v248
v_mul_f32 v234, v234, v250
v_mul_f32 v235, v235, v251
v_accvgpr_write_b32 a88, v232
v_accvgpr_write_b32 a89, v233
v_accvgpr_write_b32 a90, v234
v_accvgpr_write_b32 a91, v235
v_accvgpr_read_b32 v232, a104
v_accvgpr_read_b32 v233, a105
v_accvgpr_read_b32 v234, a106
v_accvgpr_read_b32 v235, a107
v_mul_f32 v232, v232, v242
v_mul_f32 v233, v233, v248
v_mul_f32 v234, v234, v250
v_mul_f32 v235, v235, v251
v_accvgpr_write_b32 a104, v232
v_accvgpr_write_b32 a105, v233
v_accvgpr_write_b32 a106, v234
v_accvgpr_write_b32 a107, v235
v_accvgpr_read_b32 v232, a120
v_accvgpr_read_b32 v233, a121
v_accvgpr_read_b32 v234, a122
v_accvgpr_read_b32 v235, a123
v_mul_f32 v232, v232, v242
v_mul_f32 v233, v233, v248
v_mul_f32 v234, v234, v250
v_mul_f32 v235, v235, v251
v_accvgpr_write_b32 a120, v232
v_accvgpr_write_b32 a121, v233
v_accvgpr_write_b32 a122, v234
v_accvgpr_write_b32 a123, v235
v_accvgpr_read_b32 v232, a136
v_accvgpr_read_b32 v233, a137
v_accvgpr_read_b32 v234, a138
v_accvgpr_read_b32 v235, a139
v_mul_f32 v232, v232, v242
v_mul_f32 v233, v233, v248
v_mul_f32 v234, v234, v250
v_mul_f32 v235, v235, v251
v_accvgpr_write_b32 a136, v232
v_accvgpr_write_b32 a137, v233
v_accvgpr_write_b32 a138, v234
v_accvgpr_write_b32 a139, v235
v_accvgpr_read_b32 v232, a152
v_accvgpr_read_b32 v233, a153
v_accvgpr_read_b32 v234, a154
v_accvgpr_read_b32 v235, a155
v_mul_f32 v232, v232, v242
v_mul_f32 v233, v233, v248
v_mul_f32 v234, v234, v250
v_mul_f32 v235, v235, v251
v_accvgpr_write_b32 a152, v232
v_accvgpr_write_b32 a153, v233
v_accvgpr_write_b32 a154, v234
v_accvgpr_write_b32 a155, v235
v_accvgpr_read_b32 v232, a168
v_accvgpr_read_b32 v233, a169
v_accvgpr_read_b32 v234, a170
v_accvgpr_read_b32 v235, a171
v_mul_f32 v232, v232, v242
v_mul_f32 v233, v233, v248
v_mul_f32 v234, v234, v250
v_mul_f32 v235, v235, v251
v_accvgpr_write_b32 a168, v232
v_accvgpr_write_b32 a169, v233
v_accvgpr_write_b32 a170, v234
v_accvgpr_write_b32 a171, v235
v_accvgpr_read_b32 v232, a184
v_accvgpr_read_b32 v233, a185
v_accvgpr_read_b32 v234, a186
v_accvgpr_read_b32 v235, a187
v_mul_f32 v232, v232, v242
v_mul_f32 v233, v233, v248
v_mul_f32 v234, v234, v250
v_mul_f32 v235, v235, v251
v_accvgpr_write_b32 a184, v232
v_accvgpr_write_b32 a185, v233
v_accvgpr_write_b32 a186, v234
v_accvgpr_write_b32 a187, v235
v_accvgpr_read_b32 v232, a200
v_accvgpr_read_b32 v233, a201
v_accvgpr_read_b32 v234, a202
v_accvgpr_read_b32 v235, a203
v_mul_f32 v232, v232, v242
v_mul_f32 v233, v233, v248
v_mul_f32 v234, v234, v250
v_mul_f32 v235, v235, v251
v_accvgpr_write_b32 a200, v232
v_accvgpr_write_b32 a201, v233
v_accvgpr_write_b32 a202, v234
v_accvgpr_write_b32 a203, v235
v_accvgpr_read_b32 v232, a216
v_accvgpr_read_b32 v233, a217
v_accvgpr_read_b32 v234, a218
v_accvgpr_read_b32 v235, a219
v_mul_f32 v232, v232, v242
v_mul_f32 v233, v233, v248
v_mul_f32 v234, v234, v250
v_mul_f32 v235, v235, v251
v_accvgpr_write_b32 a216, v232
v_accvgpr_write_b32 a217, v233
v_accvgpr_write_b32 a218, v234
v_accvgpr_write_b32 a219, v235
v_accvgpr_read_b32 v232, a232
v_accvgpr_read_b32 v233, a233
v_accvgpr_read_b32 v234, a234
v_accvgpr_read_b32 v235, a235
v_mul_f32 v232, v232, v242
v_mul_f32 v233, v233, v248
v_mul_f32 v234, v234, v250
v_mul_f32 v235, v235, v251
v_accvgpr_write_b32 a232, v232
v_accvgpr_write_b32 a233, v233
v_accvgpr_write_b32 a234, v234
v_accvgpr_write_b32 a235, v235
v_accvgpr_read_b32 v232, a248
v_accvgpr_read_b32 v233, a249
v_accvgpr_read_b32 v234, a250
v_accvgpr_read_b32 v235, a251
v_mul_f32 v232, v232, v242
v_mul_f32 v233, v233, v248
v_mul_f32 v234, v234, v250
v_mul_f32 v235, v235, v251
v_accvgpr_write_b32 a248, v232
v_accvgpr_write_b32 a249, v233
v_accvgpr_write_b32 a250, v234
v_accvgpr_write_b32 a251, v235
v_lshrrev_b32 v232, 4, v243
v_and_b32 v232, 0x30, v232
ds_bpermute_b32 v242, v232, v239 offset:0
ds_bpermute_b32 v248, v232, v239 offset:4
ds_bpermute_b32 v250, v232, v239 offset:8
ds_bpermute_b32 v251, v232, v239 offset:12
s_waitcnt lgkmcnt(0)
v_accvgpr_read_b32 v232, a12
v_accvgpr_read_b32 v233, a13
v_accvgpr_read_b32 v234, a14
v_accvgpr_read_b32 v235, a15
v_mul_f32 v232, v232, v242
v_mul_f32 v233, v233, v248
v_mul_f32 v234, v234, v250
v_mul_f32 v235, v235, v251
v_accvgpr_write_b32 a12, v232
v_accvgpr_write_b32 a13, v233
v_accvgpr_write_b32 a14, v234
v_accvgpr_write_b32 a15, v235
v_accvgpr_read_b32 v232, a28
v_accvgpr_read_b32 v233, a29
v_accvgpr_read_b32 v234, a30
v_accvgpr_read_b32 v235, a31
v_mul_f32 v232, v232, v242
v_mul_f32 v233, v233, v248
v_mul_f32 v234, v234, v250
v_mul_f32 v235, v235, v251
v_accvgpr_write_b32 a28, v232
v_accvgpr_write_b32 a29, v233
v_accvgpr_write_b32 a30, v234
v_accvgpr_write_b32 a31, v235
v_accvgpr_read_b32 v232, a44
v_accvgpr_read_b32 v233, a45
v_accvgpr_read_b32 v234, a46
v_accvgpr_read_b32 v235, a47
v_mul_f32 v232, v232, v242
v_mul_f32 v233, v233, v248
v_mul_f32 v234, v234, v250
v_mul_f32 v235, v235, v251
v_accvgpr_write_b32 a44, v232
v_accvgpr_write_b32 a45, v233
v_accvgpr_write_b32 a46, v234
v_accvgpr_write_b32 a47, v235
v_accvgpr_read_b32 v232, a60
v_accvgpr_read_b32 v233, a61
v_accvgpr_read_b32 v234, a62
v_accvgpr_read_b32 v235, a63
v_mul_f32 v232, v232, v242
v_mul_f32 v233, v233, v248
v_mul_f32 v234, v234, v250
v_mul_f32 v235, v235, v251
v_accvgpr_write_b32 a60, v232
v_accvgpr_write_b32 a61, v233
v_accvgpr_write_b32 a62, v234
v_accvgpr_write_b32 a63, v235
v_accvgpr_read_b32 v232, a76
v_accvgpr_read_b32 v233, a77
v_accvgpr_read_b32 v234, a78
v_accvgpr_read_b32 v235, a79
v_mul_f32 v232, v232, v242
v_mul_f32 v233, v233, v248
v_mul_f32 v234, v234, v250
v_mul_f32 v235, v235, v251
v_accvgpr_write_b32 a76, v232
v_accvgpr_write_b32 a77, v233
v_accvgpr_write_b32 a78, v234
v_accvgpr_write_b32 a79, v235
v_accvgpr_read_b32 v232, a92
v_accvgpr_read_b32 v233, a93
v_accvgpr_read_b32 v234, a94
v_accvgpr_read_b32 v235, a95
v_mul_f32 v232, v232, v242
v_mul_f32 v233, v233, v248
v_mul_f32 v234, v234, v250
v_mul_f32 v235, v235, v251
v_accvgpr_write_b32 a92, v232
v_accvgpr_write_b32 a93, v233
v_accvgpr_write_b32 a94, v234
v_accvgpr_write_b32 a95, v235
v_accvgpr_read_b32 v232, a108
v_accvgpr_read_b32 v233, a109
v_accvgpr_read_b32 v234, a110
v_accvgpr_read_b32 v235, a111
v_mul_f32 v232, v232, v242
v_mul_f32 v233, v233, v248
v_mul_f32 v234, v234, v250
v_mul_f32 v235, v235, v251
v_accvgpr_write_b32 a108, v232
v_accvgpr_write_b32 a109, v233
v_accvgpr_write_b32 a110, v234
v_accvgpr_write_b32 a111, v235
v_accvgpr_read_b32 v232, a124
v_accvgpr_read_b32 v233, a125
v_accvgpr_read_b32 v234, a126
v_accvgpr_read_b32 v235, a127
v_mul_f32 v232, v232, v242
v_mul_f32 v233, v233, v248
v_mul_f32 v234, v234, v250
v_mul_f32 v235, v235, v251
v_accvgpr_write_b32 a124, v232
v_accvgpr_write_b32 a125, v233
v_accvgpr_write_b32 a126, v234
v_accvgpr_write_b32 a127, v235
v_accvgpr_read_b32 v232, a140
v_accvgpr_read_b32 v233, a141
v_accvgpr_read_b32 v234, a142
v_accvgpr_read_b32 v235, a143
v_mul_f32 v232, v232, v242
v_mul_f32 v233, v233, v248
v_mul_f32 v234, v234, v250
v_mul_f32 v235, v235, v251
v_accvgpr_write_b32 a140, v232
v_accvgpr_write_b32 a141, v233
v_accvgpr_write_b32 a142, v234
v_accvgpr_write_b32 a143, v235
v_accvgpr_read_b32 v232, a156
v_accvgpr_read_b32 v233, a157
v_accvgpr_read_b32 v234, a158
v_accvgpr_read_b32 v235, a159
v_mul_f32 v232, v232, v242
v_mul_f32 v233, v233, v248
v_mul_f32 v234, v234, v250
v_mul_f32 v235, v235, v251
v_accvgpr_write_b32 a156, v232
v_accvgpr_write_b32 a157, v233
v_accvgpr_write_b32 a158, v234
v_accvgpr_write_b32 a159, v235
v_accvgpr_read_b32 v232, a172
v_accvgpr_read_b32 v233, a173
v_accvgpr_read_b32 v234, a174
v_accvgpr_read_b32 v235, a175
v_mul_f32 v232, v232, v242
v_mul_f32 v233, v233, v248
v_mul_f32 v234, v234, v250
v_mul_f32 v235, v235, v251
v_accvgpr_write_b32 a172, v232
v_accvgpr_write_b32 a173, v233
v_accvgpr_write_b32 a174, v234
v_accvgpr_write_b32 a175, v235
v_accvgpr_read_b32 v232, a188
v_accvgpr_read_b32 v233, a189
v_accvgpr_read_b32 v234, a190
v_accvgpr_read_b32 v235, a191
v_mul_f32 v232, v232, v242
v_mul_f32 v233, v233, v248
v_mul_f32 v234, v234, v250
v_mul_f32 v235, v235, v251
v_accvgpr_write_b32 a188, v232
v_accvgpr_write_b32 a189, v233
v_accvgpr_write_b32 a190, v234
v_accvgpr_write_b32 a191, v235
v_accvgpr_read_b32 v232, a204
v_accvgpr_read_b32 v233, a205
v_accvgpr_read_b32 v234, a206
v_accvgpr_read_b32 v235, a207
v_mul_f32 v232, v232, v242
v_mul_f32 v233, v233, v248
v_mul_f32 v234, v234, v250
v_mul_f32 v235, v235, v251
v_accvgpr_write_b32 a204, v232
v_accvgpr_write_b32 a205, v233
v_accvgpr_write_b32 a206, v234
v_accvgpr_write_b32 a207, v235
v_accvgpr_read_b32 v232, a220
v_accvgpr_read_b32 v233, a221
v_accvgpr_read_b32 v234, a222
v_accvgpr_read_b32 v235, a223
v_mul_f32 v232, v232, v242
v_mul_f32 v233, v233, v248
v_mul_f32 v234, v234, v250
v_mul_f32 v235, v235, v251
v_accvgpr_write_b32 a220, v232
v_accvgpr_write_b32 a221, v233
v_accvgpr_write_b32 a222, v234
v_accvgpr_write_b32 a223, v235
v_accvgpr_read_b32 v232, a236
v_accvgpr_read_b32 v233, a237
v_accvgpr_read_b32 v234, a238
v_accvgpr_read_b32 v235, a239
v_mul_f32 v232, v232, v242
v_mul_f32 v233, v233, v248
v_mul_f32 v234, v234, v250
v_mul_f32 v235, v235, v251
v_accvgpr_write_b32 a236, v232
v_accvgpr_write_b32 a237, v233
v_accvgpr_write_b32 a238, v234
v_accvgpr_write_b32 a239, v235
v_accvgpr_read_b32 v232, a252
v_accvgpr_read_b32 v233, a253
v_accvgpr_read_b32 v234, a254
v_accvgpr_read_b32 v235, a255
v_mul_f32 v232, v232, v242
v_mul_f32 v233, v233, v248
v_mul_f32 v234, v234, v250
v_mul_f32 v235, v235, v251
v_accvgpr_write_b32 a252, v232
v_accvgpr_write_b32 a253, v233
v_accvgpr_write_b32 a254, v234
v_accvgpr_write_b32 a255, v235
s_nop 3
s_cmp_eq_u32 s36, 0
s_cbranch_scc1 L2_rr0
s_cmp_eq_u32 s36, 1
s_cbranch_scc1 L2_rr1
s_cmp_eq_u32 s36, 2
s_cbranch_scc1 L2_rr2
s_cmp_eq_u32 s36, 3
s_cbranch_scc1 L2_rr3
s_cmp_eq_u32 s36, 4
s_cbranch_scc1 L2_rr4
s_cmp_eq_u32 s36, 5
s_cbranch_scc1 L2_rr5
s_cmp_eq_u32 s36, 6
s_cbranch_scc1 L2_rr6
s_cmp_eq_u32 s36, 7
s_cbranch_scc1 L2_rr7
s_cmp_eq_u32 s36, 8
s_cbranch_scc1 L2_rr8
s_cmp_eq_u32 s36, 9
s_cbranch_scc1 L2_rr9
s_cmp_eq_u32 s36, 10
s_cbranch_scc1 L2_rr10
s_cmp_eq_u32 s36, 11
s_cbranch_scc1 L2_rr11
s_cmp_eq_u32 s36, 12
s_cbranch_scc1 L2_rr12
s_cmp_eq_u32 s36, 13
s_cbranch_scc1 L2_rr13
s_cmp_eq_u32 s36, 14
s_cbranch_scc1 L2_rr14
s_cmp_eq_u32 s36, 15
s_cbranch_scc1 L2_rr15
s_cmp_eq_u32 s36, 16
s_cbranch_scc1 L2_rr16
L2_rr17:
s_waitcnt lgkmcnt(0)
s_branch L2_ret17
L2_rr16:
s_waitcnt lgkmcnt(0)
s_branch L2_ret16
L2_rr15:
s_waitcnt lgkmcnt(0)
s_branch L2_ret15
L2_rr14:
s_waitcnt lgkmcnt(0)
s_branch L2_ret14
L2_rr13:
s_waitcnt lgkmcnt(0)
s_branch L2_ret13
L2_rr12:
s_waitcnt lgkmcnt(0)
s_branch L2_ret12
L2_rr11:
s_waitcnt lgkmcnt(0)
s_branch L2_ret11
L2_rr10:
s_waitcnt lgkmcnt(0)
s_branch L2_ret10
L2_rr9:
s_waitcnt lgkmcnt(0)
s_branch L2_ret9
L2_rr8:
s_waitcnt lgkmcnt(0)
s_branch L2_ret8
L2_rr7:
s_waitcnt lgkmcnt(0)
s_branch L2_ret7
L2_rr6:
s_waitcnt lgkmcnt(0)
s_branch L2_ret6
L2_rr5:
s_waitcnt lgkmcnt(0)
s_branch L2_ret5
L2_rr4:
s_waitcnt lgkmcnt(0)
s_branch L2_ret4
L2_rr3:
s_waitcnt lgkmcnt(0)
s_branch L2_ret3
L2_rr2:
s_waitcnt lgkmcnt(0)
s_branch L2_ret2
L2_rr1:
s_waitcnt lgkmcnt(0)
s_branch L2_ret1
L2_rr0:
s_waitcnt lgkmcnt(0)
s_branch L2_ret0
LT_disp:
s_cmp_ge_i32 s36, 0
s_cbranch_scc1 LT_start
s_cmp_eq_u32 s34, 0
s_cbranch_scc1 L2_end
s_mov_b32 s41, s34
s_mul_i32 s40, s34, 6
s_add_u32 s40, s40, s37
s_add_u32 s40, s40, 42
s_cmp_lt_u32 s40, 64
s_cbranch_scc1 LE_common
s_branch L2_end
LT_start:
s_waitcnt lgkmcnt(0)
s_add_u32 s12, s4, 0x7c2a000
s_addc_u32 s13, s5, 0
s_mov_b32 s14, 0x8000
s_mov_b32 s15, 0x00020000
v_and_b32 v8, 63, v0
v_lshlrev_b32 v8, 7, v8
s_mov_b32 s91, 8192
s_mov_b32 s90, 16384
s_mov_b32 s95, 24576
v_min_u32 v9, 5248, v8
s_mov_b32 s94, 0x10000
LT_poll:
buffer_load_dwordx2 v[0:1], v8, s[12:15], 0 offen sc1
buffer_load_dwordx2 v[2:3], v8, s[12:15], s91 offen sc1
buffer_load_dwordx2 v[4:5], v8, s[12:15], s90 offen sc1
buffer_load_dwordx2 v[6:7], v9, s[12:15], s95 offen sc1
s_sub_u32 s94, s94, 1
s_waitcnt vmcnt(0)
s_cbranch_scc1 LT_poll_go
v_cmp_ne_u64 vcc, s[98:99], v[0:1]
s_nop 1
s_cbranch_vccnz LT_poll
v_cmp_ne_u64 vcc, s[98:99], v[2:3]
s_nop 1
s_cbranch_vccnz LT_poll
v_cmp_ne_u64 vcc, s[98:99], v[4:5]
s_nop 1
s_cbranch_vccnz LT_poll
v_cmp_ne_u64 vcc, s[98:99], v[6:7]
s_nop 1
s_cbranch_vccnz LT_poll
LT_poll_go:
s_add_u32 s31, s31, -22
s_add_u32 s3, s28, 409600
s_cmp_eq_u32 s36, 0
s_cselect_b32 s31, 26, s31
s_cselect_b32 s39, s39, s3
s_cselect_b32 s33, s33, 0
s_cselect_b32 s3, 0, 425984
s_add_u32 s28, s28, s3
s_add_u32 s12, s4, 0x6800000
s_addc_u32 s13, s5, 0
s_mov_b32 s14, 0x0
s_mov_b32 s15, 0x00020000
s_mov_b32 s14, s49
s_add_u32 s8, s4, 0x0
s_addc_u32 s9, s5, 0
s_mov_b32 s10, 0x4e4000
s_mov_b32 s11, 0x00020000
s_mov_b32 s40, 5111808
s_mov_b32 s44, 5115904
buffer_load_dwordx4 v[0:3], v243, s[8:11], s40 offen offset:0 sc1
buffer_load_dwordx4 v[4:7], v243, s[8:11], s40 offen offset:1024 sc1
buffer_load_dwordx4 v[8:11], v243, s[8:11], s40 offen offset:2048 sc1
buffer_load_dwordx4 v[12:15], v243, s[8:11], s40 offen offset:3072 sc1
buffer_load_dwordx4 v[16:19], v243, s[8:11], s44 offen offset:0 sc1
buffer_load_dwordx4 v[20:23], v243, s[8:11], s44 offen offset:1024 sc1
buffer_load_dwordx4 v[24:27], v243, s[8:11], s44 offen offset:2048 sc1
buffer_load_dwordx4 v[28:31], v243, s[8:11], s44 offen offset:3072 sc1
s_mov_b32 s53, 0
s_add_u32 m0, s53, 90112
s_add_u32 s54, s39, 0
buffer_load_dwordx4 v241, s[12:15], s54 offen offset:0 sc1 lds
buffer_load_dwordx4 v241, s[12:15], s54 offen offset:1024 sc1 lds
buffer_load_dwordx4 v241, s[12:15], s54 offen offset:2048 sc1 lds
buffer_load_dwordx4 v241, s[12:15], s54 offen offset:3072 sc1 lds
s_add_u32 m0, s53, 94208
s_add_u32 s54, s39, 128
buffer_load_dwordx4 v241, s[12:15], s54 offen offset:0 sc1 lds
buffer_load_dwordx4 v241, s[12:15], s54 offen offset:1024 sc1 lds
buffer_load_dwordx4 v241, s[12:15], s54 offen offset:2048 sc1 lds
buffer_load_dwordx4 v241, s[12:15], s54 offen offset:3072 sc1 lds
s_add_u32 m0, s53, 98304
s_add_u32 s54, s39, 256
buffer_load_dwordx4 v241, s[12:15], s54 offen offset:0 sc1 lds
buffer_load_dwordx4 v241, s[12:15], s54 offen offset:1024 sc1 lds
buffer_load_dwordx4 v241, s[12:15], s54 offen offset:2048 sc1 lds
buffer_load_dwordx4 v241, s[12:15], s54 offen offset:3072 sc1 lds
s_add_u32 m0, s53, 102400
s_add_u32 s54, s39, 384
buffer_load_dwordx4 v241, s[12:15], s54 offen offset:0 sc1 lds
buffer_load_dwordx4 v241, s[12:15], s54 offen offset:1024 sc1 lds
buffer_load_dwordx4 v241, s[12:15], s54 offen offset:2048 sc1 lds
buffer_load_dwordx4 v241, s[12:15], s54 offen offset:3072 sc1 lds
s_add_u32 s53, s53, 0x4000
s_and_b32 s53, s53, 0xffff
s_add_u32 m0, s53, 90112
s_add_u32 s54, s28, 0
buffer_load_dwordx4 v241, s[12:15], s54 offen offset:0 sc1 lds
buffer_load_dwordx4 v241, s[12:15], s54 offen offset:1024 sc1 lds
buffer_load_dwordx4 v241, s[12:15], s54 offen offset:2048 sc1 lds
buffer_load_dwordx4 v241, s[12:15], s54 offen offset:3072 sc1 lds
s_add_u32 m0, s53, 94208
s_add_u32 s54, s28, 128
buffer_load_dwordx4 v241, s[12:15], s54 offen offset:0 sc1 lds
buffer_load_dwordx4 v241, s[12:15], s54 offen offset:1024 sc1 lds
buffer_load_dwordx4 v241, s[12:15], s54 offen offset:2048 sc1 lds
buffer_load_dwordx4 v241, s[12:15], s54 offen offset:3072 sc1 lds
s_add_u32 m0, s53, 98304
s_add_u32 s54, s28, 256
buffer_load_dwordx4 v241, s[12:15], s54 offen offset:0 sc1 lds
buffer_load_dwordx4 v241, s[12:15], s54 offen offset:1024 sc1 lds
buffer_load_dwordx4 v241, s[12:15], s54 offen offset:2048 sc1 lds
buffer_load_dwordx4 v241, s[12:15], s54 offen offset:3072 sc1 lds
s_add_u32 m0, s53, 102400
s_add_u32 s54, s28, 384
buffer_load_dwordx4 v241, s[12:15], s54 offen offset:0 sc1 lds
buffer_load_dwordx4 v241, s[12:15], s54 offen offset:1024 sc1 lds
buffer_load_dwordx4 v241, s[12:15], s54 offen offset:2048 sc1 lds
buffer_load_dwordx4 v241, s[12:15], s54 offen offset:3072 sc1 lds
s_add_u32 s53, s53, 0x4000
s_and_b32 s53, s53, 0xffff
s_add_u32 s28, s28, 0x4000
s_add_u32 m0, s53, 90112
s_add_u32 s54, s28, 0
buffer_load_dwordx4 v241, s[12:15], s54 offen offset:0 sc1 lds
buffer_load_dwordx4 v241, s[12:15], s54 offen offset:1024 sc1 lds
buffer_load_dwordx4 v241, s[12:15], s54 offen offset:2048 sc1 lds
buffer_load_dwordx4 v241, s[12:15], s54 offen offset:3072 sc1 lds
s_add_u32 m0, s53, 94208
s_add_u32 s54, s28, 128
buffer_load_dwordx4 v241, s[12:15], s54 offen offset:0 sc1 lds
buffer_load_dwordx4 v241, s[12:15], s54 offen offset:1024 sc1 lds
buffer_load_dwordx4 v241, s[12:15], s54 offen offset:2048 sc1 lds
buffer_load_dwordx4 v241, s[12:15], s54 offen offset:3072 sc1 lds
s_add_u32 m0, s53, 98304
s_add_u32 s54, s28, 256
buffer_load_dwordx4 v241, s[12:15], s54 offen offset:0 sc1 lds
buffer_load_dwordx4 v241, s[12:15], s54 offen offset:1024 sc1 lds
buffer_load_dwordx4 v241, s[12:15], s54 offen offset:2048 sc1 lds
buffer_load_dwordx4 v241, s[12:15], s54 offen offset:3072 sc1 lds
s_add_u32 m0, s53, 102400
s_add_u32 s54, s28, 384
buffer_load_dwordx4 v241, s[12:15], s54 offen offset:0 sc1 lds
buffer_load_dwordx4 v241, s[12:15], s54 offen offset:1024 sc1 lds
buffer_load_dwordx4 v241, s[12:15], s54 offen offset:2048 sc1 lds
buffer_load_dwordx4 v241, s[12:15], s54 offen offset:3072 sc1 lds
s_add_u32 s53, s53, 0x4000
s_and_b32 s53, s53, 0xffff
s_add_u32 s28, s28, 0x4000
s_mul_i32 s35, s37, 0x600000
s_add_u32 s20, s4, 0x2000000
s_addc_u32 s21, s5, 0
s_add_u32 s20, s20, s35
s_addc_u32 s21, s21, 0
s_mov_b32 s22, 0x4e4000
s_mov_b32 s23, 0x00020000
s_add_u32 s24, s4, 0x6000000
s_addc_u32 s25, s5, 0
s_mov_b32 s26, 0x139000
s_mov_b32 s27, 0x00020000
s_lshl_b32 s48, s37, 3
s_add_u32 s48, s48, 638976
s_mov_b32 s48, 1277952
v_bfe_u32 v240, v243, 4, 3
v_lshlrev_b32 v240, 6, v240
v_bfe_u32 v242, v243, 7, 1
v_lshl_or_b32 v240, v242, 10, v240
v_bfe_u32 v242, v243, 8, 2
v_lshl_or_b32 v240, v242, 4, v240
v_bfe_u32 v242, v243, 6, 1
v_lshlrev_b32 v242, 5, v242
v_xor_b32 v240, v240, v242
v_and_b32 v246, 0x1c0, v243
v_bfe_u32 v242, v243, 9, 1
v_lshl_or_b32 v246, v242, 10, v246
v_bfe_u32 v242, v243, 8, 1
v_lshl_or_b32 v246, v242, 5, v246
v_bfe_u32 v242, v243, 4, 2
v_lshl_or_b32 v246, v242, 3, v246
v_xor_b32 v247, 32, v246
v_bfe_i32 v242, v243, 8, 1
v_and_b32 v192, s33, v242
v_and_b32 v193, s33, v242
v_and_b32 v194, s33, v242
v_and_b32 v195, s33, v242
s_add_u32 s51, s31, 0
s_mov_b32 s52, 90112
v_mov_b32 v172, 0xff800000
v_mov_b32 v173, 0
v_accvgpr_write_b32 a0, 0
v_accvgpr_write_b32 a1, 0
v_accvgpr_write_b32 a2, 0
v_accvgpr_write_b32 a3, 0
v_accvgpr_write_b32 a4, 0
v_accvgpr_write_b32 a5, 0
v_accvgpr_write_b32 a6, 0
v_accvgpr_write_b32 a7, 0
v_accvgpr_write_b32 a8, 0
v_accvgpr_write_b32 a9, 0
v_accvgpr_write_b32 a10, 0
v_accvgpr_write_b32 a11, 0
v_accvgpr_write_b32 a12, 0
v_accvgpr_write_b32 a13, 0
v_accvgpr_write_b32 a14, 0
v_accvgpr_write_b32 a15, 0
v_accvgpr_write_b32 a16, 0
v_accvgpr_write_b32 a17, 0
v_accvgpr_write_b32 a18, 0
v_accvgpr_write_b32 a19, 0
v_accvgpr_write_b32 a20, 0
v_accvgpr_write_b32 a21, 0
v_accvgpr_write_b32 a22, 0
v_accvgpr_write_b32 a23, 0
v_accvgpr_write_b32 a24, 0
v_accvgpr_write_b32 a25, 0
v_accvgpr_write_b32 a26, 0
v_accvgpr_write_b32 a27, 0
v_accvgpr_write_b32 a28, 0
v_accvgpr_write_b32 a29, 0
v_accvgpr_write_b32 a30, 0
v_accvgpr_write_b32 a31, 0
v_accvgpr_write_b32 a32, 0
v_accvgpr_write_b32 a33, 0
v_accvgpr_write_b32 a34, 0
v_accvgpr_write_b32 a35, 0
v_accvgpr_write_b32 a36, 0
v_accvgpr_write_b32 a37, 0
v_accvgpr_write_b32 a38, 0
v_accvgpr_write_b32 a39, 0
v_accvgpr_write_b32 a40, 0
v_accvgpr_write_b32 a41, 0
v_accvgpr_write_b32 a42, 0
v_accvgpr_write_b32 a43, 0
v_accvgpr_write_b32 a44, 0
v_accvgpr_write_b32 a45, 0
v_accvgpr_write_b32 a46, 0
v_accvgpr_write_b32 a47, 0
v_accvgpr_write_b32 a48, 0
v_accvgpr_write_b32 a49, 0
v_accvgpr_write_b32 a50, 0
v_accvgpr_write_b32 a51, 0
v_accvgpr_write_b32 a52, 0
v_accvgpr_write_b32 a53, 0
v_accvgpr_write_b32 a54, 0
v_accvgpr_write_b32 a55, 0
v_accvgpr_write_b32 a56, 0
v_accvgpr_write_b32 a57, 0
v_accvgpr_write_b32 a58, 0
v_accvgpr_write_b32 a59, 0
v_accvgpr_write_b32 a60, 0
v_accvgpr_write_b32 a61, 0
v_accvgpr_write_b32 a62, 0
v_accvgpr_write_b32 a63, 0
LT_loop:
s_add_u32 m0, s53, 90112
s_add_u32 s54, s28, 0
buffer_load_dwordx4 v241, s[12:15], s54 offen offset:0 sc1 lds
buffer_load_dwordx4 v241, s[12:15], s54 offen offset:1024 sc1 lds
buffer_load_dwordx4 v241, s[12:15], s54 offen offset:2048 sc1 lds
buffer_load_dwordx4 v241, s[12:15], s54 offen offset:3072 sc1 lds
s_add_u32 m0, s53, 94208
s_add_u32 s54, s28, 128
buffer_load_dwordx4 v241, s[12:15], s54 offen offset:0 sc1 lds
buffer_load_dwordx4 v241, s[12:15], s54 offen offset:1024 sc1 lds
buffer_load_dwordx4 v241, s[12:15], s54 offen offset:2048 sc1 lds
buffer_load_dwordx4 v241, s[12:15], s54 offen offset:3072 sc1 lds
s_add_u32 m0, s53, 98304
s_add_u32 s54, s28, 256
buffer_load_dwordx4 v241, s[12:15], s54 offen offset:0 sc1 lds
buffer_load_dwordx4 v241, s[12:15], s54 offen offset:1024 sc1 lds
buffer_load_dwordx4 v241, s[12:15], s54 offen offset:2048 sc1 lds
buffer_load_dwordx4 v241, s[12:15], s54 offen offset:3072 sc1 lds
s_add_u32 m0, s53, 102400
s_add_u32 s54, s28, 384
buffer_load_dwordx4 v241, s[12:15], s54 offen offset:0 sc1 lds
buffer_load_dwordx4 v241, s[12:15], s54 offen offset:1024 sc1 lds
buffer_load_dwordx4 v241, s[12:15], s54 offen offset:2048 sc1 lds
buffer_load_dwordx4 v241, s[12:15], s54 offen offset:3072 sc1 lds
s_add_u32 s53, s53, 0x4000
s_and_b32 s53, s53, 0xffff
s_add_u32 s28, s28, 0x4000
v_add_u32 v177, s52, v240
v_add_u32 v178, s52, v246
v_add_u32 v179, s52, v247
s_add_u32 s52, s52, 0x4000
s_cmp_eq_u32 s52, 155648
s_cselect_b32 s52, 90112, s52
s_waitcnt vmcnt(48)
ds_read_b128 v[32:35], v177 offset:0
ds_read_b128 v[64:67], v177 offset:2048
ds_read_b128 v[36:39], v177 offset:512
ds_read_b128 v[68:71], v177 offset:2560
ds_read_b128 v[40:43], v177 offset:4096
ds_read_b128 v[72:75], v177 offset:6144
ds_read_b128 v[44:47], v177 offset:4608
ds_read_b128 v[76:79], v177 offset:6656
ds_read_b128 v[48:51], v177 offset:8192
ds_read_b128 v[80:83], v177 offset:10240
ds_read_b128 v[52:55], v177 offset:8704
ds_read_b128 v[84:87], v177 offset:10752
ds_read_b128 v[56:59], v177 offset:12288
ds_read_b128 v[88:91], v177 offset:14336
ds_read_b128 v[60:63], v177 offset:12800
ds_read_b128 v[92:95], v177 offset:14848
s_waitcnt lgkmcnt(14)
v_mfma_f32_16x16x32_bf16 v[160:163], v[32:35], v[0:3], v[192:195]
v_mfma_f32_16x16x32_bf16 v[164:167], v[64:67], v[0:3], v[192:195]
s_waitcnt lgkmcnt(12)
v_mfma_f32_16x16x32_bf16 v[160:163], v[36:39], v[4:7], v[160:163]
v_mfma_f32_16x16x32_bf16 v[164:167], v[68:71], v[4:7], v[164:167]
s_waitcnt lgkmcnt(10)
v_mfma_f32_16x16x32_bf16 v[160:163], v[40:43], v[8:11], v[160:163]
v_mfma_f32_16x16x32_bf16 v[164:167], v[72:75], v[8:11], v[164:167]
s_waitcnt lgkmcnt(8)
v_mfma_f32_16x16x32_bf16 v[160:163], v[44:47], v[12:15], v[160:163]
v_mfma_f32_16x16x32_bf16 v[164:167], v[76:79], v[12:15], v[164:167]
s_waitcnt lgkmcnt(6)
v_mfma_f32_16x16x32_bf16 v[160:163], v[48:51], v[16:19], v[160:163]
v_mfma_f32_16x16x32_bf16 v[164:167], v[80:83], v[16:19], v[164:167]
s_waitcnt lgkmcnt(4)
v_mfma_f32_16x16x32_bf16 v[160:163], v[52:55], v[20:23], v[160:163]
v_mfma_f32_16x16x32_bf16 v[164:167], v[84:87], v[20:23], v[164:167]
s_waitcnt lgkmcnt(2)
v_mfma_f32_16x16x32_bf16 v[160:163], v[56:59], v[24:27], v[160:163]
v_mfma_f32_16x16x32_bf16 v[164:167], v[88:91], v[24:27], v[164:167]
s_waitcnt lgkmcnt(0)
v_mfma_f32_16x16x32_bf16 v[160:163], v[60:63], v[28:31], v[160:163]
v_mfma_f32_16x16x32_bf16 v[164:167], v[92:95], v[28:31], v[164:167]
ds_read_b64_tr_b16 v[96:97], v178 offset:0
ds_read_b64_tr_b16 v[98:99], v178 offset:2048
ds_read_b64_tr_b16 v[100:101], v179 offset:0
ds_read_b64_tr_b16 v[102:103], v179 offset:2048
ds_read_b64_tr_b16 v[104:105], v178 offset:512
ds_read_b64_tr_b16 v[106:107], v178 offset:2560
ds_read_b64_tr_b16 v[108:109], v179 offset:512
ds_read_b64_tr_b16 v[110:111], v179 offset:2560
ds_read_b64_tr_b16 v[112:113], v178 offset:4096
ds_read_b64_tr_b16 v[114:115], v178 offset:6144
ds_read_b64_tr_b16 v[116:117], v179 offset:4096
ds_read_b64_tr_b16 v[118:119], v179 offset:6144
ds_read_b64_tr_b16 v[120:121], v178 offset:4608
ds_read_b64_tr_b16 v[122:123], v178 offset:6656
ds_read_b64_tr_b16 v[124:125], v179 offset:4608
ds_read_b64_tr_b16 v[126:127], v179 offset:6656
ds_read_b64_tr_b16 v[128:129], v178 offset:8192
ds_read_b64_tr_b16 v[130:131], v178 offset:10240
ds_read_b64_tr_b16 v[132:133], v179 offset:8192
ds_read_b64_tr_b16 v[134:135], v179 offset:10240
ds_read_b64_tr_b16 v[136:137], v178 offset:8704
ds_read_b64_tr_b16 v[138:139], v178 offset:10752
ds_read_b64_tr_b16 v[140:141], v179 offset:8704
ds_read_b64_tr_b16 v[142:143], v179 offset:10752
ds_read_b64_tr_b16 v[144:145], v178 offset:12288
ds_read_b64_tr_b16 v[146:147], v178 offset:14336
ds_read_b64_tr_b16 v[148:149], v179 offset:12288
ds_read_b64_tr_b16 v[150:151], v179 offset:14336
ds_read_b64_tr_b16 v[152:153], v178 offset:12800
ds_read_b64_tr_b16 v[154:155], v178 offset:14848
ds_read_b64_tr_b16 v[156:157], v179 offset:12800
ds_read_b64_tr_b16 v[158:159], v179 offset:14848
v_mov_b32 v192, 0
v_mov_b32 v193, 0
v_mov_b32 v194, 0
v_mov_b32 v195, 0
s_nop 7
v_max3_f32 v175, v160, v161, v162
v_max3_f32 v175, v175, v163, v164
v_max3_f32 v175, v175, v165, v166
v_max3_f32 v175, v175, v167, v172
v_mov_b32 v176, v175
s_nop 1
v_permlane32_swap_b32 v175, v176
s_nop 1
v_max_f32 v175, v175, v176
v_mov_b32 v176, v175
s_nop 1
v_permlane16_swap_b32 v175, v176
s_nop 1
v_max_f32 v175, v175, v176
v_ceil_f32 v175, v175
v_sub_f32 v174, v172, v175
v_exp_f32 v174, v174
v_mov_b32 v172, v175
v_sub_f32 v160, v160, v172
v_sub_f32 v161, v161, v172
v_sub_f32 v162, v162, v172
v_sub_f32 v163, v163, v172
v_sub_f32 v164, v164, v172
v_sub_f32 v165, v165, v172
v_sub_f32 v166, v166, v172
v_sub_f32 v167, v167, v172
v_exp_f32 v160, v160
v_exp_f32 v161, v161
v_exp_f32 v162, v162
v_exp_f32 v163, v163
v_exp_f32 v164, v164
v_exp_f32 v165, v165
v_exp_f32 v166, v166
v_exp_f32 v167, v167
v_mul_f32 v173, v173, v174
v_cvt_pk_bf16_f32 v168, v160, v161
v_cvt_pk_bf16_f32 v169, v162, v163
v_cvt_pk_bf16_f32 v170, v164, v165
v_cvt_pk_bf16_f32 v171, v166, v167
v_cmp_neq_f32 vcc, 1.0, v174
v_add_f32 v173, v173, v160
v_add_f32 v173, v173, v161
v_add_f32 v173, v173, v162
v_add_f32 v173, v173, v163
v_add_f32 v173, v173, v164
v_add_f32 v173, v173, v165
v_add_f32 v173, v173, v166
v_add_f32 v173, v173, v167
s_cbranch_vccz LT_nors
v_lshrrev_b32 v176, 4, v243
v_and_b32 v176, 0x30, v176
ds_bpermute_b32 v188, v176, v174 offset:0
ds_bpermute_b32 v189, v176, v174 offset:4
ds_bpermute_b32 v190, v176, v174 offset:8
ds_bpermute_b32 v191, v176, v174 offset:12
s_waitcnt lgkmcnt(0)
v_accvgpr_read_b32 v180, a0
v_accvgpr_read_b32 v181, a1
v_accvgpr_read_b32 v182, a2
v_accvgpr_read_b32 v183, a3
v_accvgpr_read_b32 v184, a4
v_accvgpr_read_b32 v185, a5
v_accvgpr_read_b32 v186, a6
v_accvgpr_read_b32 v187, a7
v_mul_f32 v180, v180, v188
v_mul_f32 v181, v181, v189
v_mul_f32 v182, v182, v190
v_mul_f32 v183, v183, v191
v_mul_f32 v184, v184, v188
v_mul_f32 v185, v185, v189
v_mul_f32 v186, v186, v190
v_mul_f32 v187, v187, v191
v_accvgpr_write_b32 a0, v180
v_accvgpr_write_b32 a1, v181
v_accvgpr_write_b32 a2, v182
v_accvgpr_write_b32 a3, v183
v_accvgpr_write_b32 a4, v184
v_accvgpr_write_b32 a5, v185
v_accvgpr_write_b32 a6, v186
v_accvgpr_write_b32 a7, v187
v_accvgpr_read_b32 v180, a8
v_accvgpr_read_b32 v181, a9
v_accvgpr_read_b32 v182, a10
v_accvgpr_read_b32 v183, a11
v_accvgpr_read_b32 v184, a12
v_accvgpr_read_b32 v185, a13
v_accvgpr_read_b32 v186, a14
v_accvgpr_read_b32 v187, a15
v_mul_f32 v180, v180, v188
v_mul_f32 v181, v181, v189
v_mul_f32 v182, v182, v190
v_mul_f32 v183, v183, v191
v_mul_f32 v184, v184, v188
v_mul_f32 v185, v185, v189
v_mul_f32 v186, v186, v190
v_mul_f32 v187, v187, v191
v_accvgpr_write_b32 a8, v180
v_accvgpr_write_b32 a9, v181
v_accvgpr_write_b32 a10, v182
v_accvgpr_write_b32 a11, v183
v_accvgpr_write_b32 a12, v184
v_accvgpr_write_b32 a13, v185
v_accvgpr_write_b32 a14, v186
v_accvgpr_write_b32 a15, v187
v_accvgpr_read_b32 v180, a16
v_accvgpr_read_b32 v181, a17
v_accvgpr_read_b32 v182, a18
v_accvgpr_read_b32 v183, a19
v_accvgpr_read_b32 v184, a20
v_accvgpr_read_b32 v185, a21
v_accvgpr_read_b32 v186, a22
v_accvgpr_read_b32 v187, a23
v_mul_f32 v180, v180, v188
v_mul_f32 v181, v181, v189
v_mul_f32 v182, v182, v190
v_mul_f32 v183, v183, v191
v_mul_f32 v184, v184, v188
v_mul_f32 v185, v185, v189
v_mul_f32 v186, v186, v190
v_mul_f32 v187, v187, v191
v_accvgpr_write_b32 a16, v180
v_accvgpr_write_b32 a17, v181
v_accvgpr_write_b32 a18, v182
v_accvgpr_write_b32 a19, v183
v_accvgpr_write_b32 a20, v184
v_accvgpr_write_b32 a21, v185
v_accvgpr_write_b32 a22, v186
v_accvgpr_write_b32 a23, v187
v_accvgpr_read_b32 v180, a24
v_accvgpr_read_b32 v181, a25
v_accvgpr_read_b32 v182, a26
v_accvgpr_read_b32 v183, a27
v_accvgpr_read_b32 v184, a28
v_accvgpr_read_b32 v185, a29
v_accvgpr_read_b32 v186, a30
v_accvgpr_read_b32 v187, a31
v_mul_f32 v180, v180, v188
v_mul_f32 v181, v181, v189
v_mul_f32 v182, v182, v190
v_mul_f32 v183, v183, v191
v_mul_f32 v184, v184, v188
v_mul_f32 v185, v185, v189
v_mul_f32 v186, v186, v190
v_mul_f32 v187, v187, v191
v_accvgpr_write_b32 a24, v180
v_accvgpr_write_b32 a25, v181
v_accvgpr_write_b32 a26, v182
v_accvgpr_write_b32 a27, v183
v_accvgpr_write_b32 a28, v184
v_accvgpr_write_b32 a29, v185
v_accvgpr_write_b32 a30, v186
v_accvgpr_write_b32 a31, v187
v_accvgpr_read_b32 v180, a32
v_accvgpr_read_b32 v181, a33
v_accvgpr_read_b32 v182, a34
v_accvgpr_read_b32 v183, a35
v_accvgpr_read_b32 v184, a36
v_accvgpr_read_b32 v185, a37
v_accvgpr_read_b32 v186, a38
v_accvgpr_read_b32 v187, a39
v_mul_f32 v180, v180, v188
v_mul_f32 v181, v181, v189
v_mul_f32 v182, v182, v190
v_mul_f32 v183, v183, v191
v_mul_f32 v184, v184, v188
v_mul_f32 v185, v185, v189
v_mul_f32 v186, v186, v190
v_mul_f32 v187, v187, v191
v_accvgpr_write_b32 a32, v180
v_accvgpr_write_b32 a33, v181
v_accvgpr_write_b32 a34, v182
v_accvgpr_write_b32 a35, v183
v_accvgpr_write_b32 a36, v184
v_accvgpr_write_b32 a37, v185
v_accvgpr_write_b32 a38, v186
v_accvgpr_write_b32 a39, v187
v_accvgpr_read_b32 v180, a40
v_accvgpr_read_b32 v181, a41
v_accvgpr_read_b32 v182, a42
v_accvgpr_read_b32 v183, a43
v_accvgpr_read_b32 v184, a44
v_accvgpr_read_b32 v185, a45
v_accvgpr_read_b32 v186, a46
v_accvgpr_read_b32 v187, a47
v_mul_f32 v180, v180, v188
v_mul_f32 v181, v181, v189
v_mul_f32 v182, v182, v190
v_mul_f32 v183, v183, v191
v_mul_f32 v184, v184, v188
v_mul_f32 v185, v185, v189
v_mul_f32 v186, v186, v190
v_mul_f32 v187, v187, v191
v_accvgpr_write_b32 a40, v180
v_accvgpr_write_b32 a41, v181
v_accvgpr_write_b32 a42, v182
v_accvgpr_write_b32 a43, v183
v_accvgpr_write_b32 a44, v184
v_accvgpr_write_b32 a45, v185
v_accvgpr_write_b32 a46, v186
v_accvgpr_write_b32 a47, v187
v_accvgpr_read_b32 v180, a48
v_accvgpr_read_b32 v181, a49
v_accvgpr_read_b32 v182, a50
v_accvgpr_read_b32 v183, a51
v_accvgpr_read_b32 v184, a52
v_accvgpr_read_b32 v185, a53
v_accvgpr_read_b32 v186, a54
v_accvgpr_read_b32 v187, a55
v_mul_f32 v180, v180, v188
v_mul_f32 v181, v181, v189
v_mul_f32 v182, v182, v190
v_mul_f32 v183, v183, v191
v_mul_f32 v184, v184, v188
v_mul_f32 v185, v185, v189
v_mul_f32 v186, v186, v190
v_mul_f32 v187, v187, v191
v_accvgpr_write_b32 a48, v180
v_accvgpr_write_b32 a49, v181
v_accvgpr_write_b32 a50, v182
v_accvgpr_write_b32 a51, v183
v_accvgpr_write_b32 a52, v184
v_accvgpr_write_b32 a53, v185
v_accvgpr_write_b32 a54, v186
v_accvgpr_write_b32 a55, v187
v_accvgpr_read_b32 v180, a56
v_accvgpr_read_b32 v181, a57
v_accvgpr_read_b32 v182, a58
v_accvgpr_read_b32 v183, a59
v_accvgpr_read_b32 v184, a60
v_accvgpr_read_b32 v185, a61
v_accvgpr_read_b32 v186, a62
v_accvgpr_read_b32 v187, a63
v_mul_f32 v180, v180, v188
v_mul_f32 v181, v181, v189
v_mul_f32 v182, v182, v190
v_mul_f32 v183, v183, v191
v_mul_f32 v184, v184, v188
v_mul_f32 v185, v185, v189
v_mul_f32 v186, v186, v190
v_mul_f32 v187, v187, v191
v_accvgpr_write_b32 a56, v180
v_accvgpr_write_b32 a57, v181
v_accvgpr_write_b32 a58, v182
v_accvgpr_write_b32 a59, v183
v_accvgpr_write_b32 a60, v184
v_accvgpr_write_b32 a61, v185
v_accvgpr_write_b32 a62, v186
v_accvgpr_write_b32 a63, v187
LT_nors:
s_waitcnt lgkmcnt(0)
s_nop 1
v_mfma_f32_16x16x32_bf16 a[0:3], v[168:171], v[96:99], a[0:3]
v_mfma_f32_16x16x32_bf16 a[4:7], v[168:171], v[100:103], a[4:7]
v_mfma_f32_16x16x32_bf16 a[8:11], v[168:171], v[104:107], a[8:11]
v_mfma_f32_16x16x32_bf16 a[12:15], v[168:171], v[108:111], a[12:15]
v_mfma_f32_16x16x32_bf16 a[16:19], v[168:171], v[112:115], a[16:19]
v_mfma_f32_16x16x32_bf16 a[20:23], v[168:171], v[116:119], a[20:23]
v_mfma_f32_16x16x32_bf16 a[24:27], v[168:171], v[120:123], a[24:27]
v_mfma_f32_16x16x32_bf16 a[28:31], v[168:171], v[124:127], a[28:31]
v_mfma_f32_16x16x32_bf16 a[32:35], v[168:171], v[128:131], a[32:35]
v_mfma_f32_16x16x32_bf16 a[36:39], v[168:171], v[132:135], a[36:39]
v_mfma_f32_16x16x32_bf16 a[40:43], v[168:171], v[136:139], a[40:43]
v_mfma_f32_16x16x32_bf16 a[44:47], v[168:171], v[140:143], a[44:47]
v_mfma_f32_16x16x32_bf16 a[48:51], v[168:171], v[144:147], a[48:51]
v_mfma_f32_16x16x32_bf16 a[52:55], v[168:171], v[148:151], a[52:55]
v_mfma_f32_16x16x32_bf16 a[56:59], v[168:171], v[152:155], a[56:59]
v_mfma_f32_16x16x32_bf16 a[60:63], v[168:171], v[156:159], a[60:63]
s_sub_u32 s51, s51, 1
s_cmp_lg_u32 s51, 0
s_cbranch_scc1 LT_loop
s_nop 15
s_add_u32 s16, s4, 0x0
s_addc_u32 s17, s5, 0
s_mov_b32 s18, 0x10000000
s_mov_b32 s19, 0x00020000
s_mul_i32 s52, s37, 0x5000
s_add_u32 s52, s52, 0x1200000
s_add_u32 s53, s37, 1610
s_lshl_b32 s53, s53, 7
s_add_u32 s53, s53, 0x7c00000
s_waitcnt vmcnt(0)
s_cmp_eq_u32 s36, 0
s_cbranch_scc1 LT_merge
buffer_store_dwordx4 a[0:3], v243, s[16:19], s52 offen offset:0 sc1
buffer_store_dwordx4 a[4:7], v243, s[16:19], s52 offen offset:1024 sc1
buffer_store_dwordx4 a[8:11], v243, s[16:19], s52 offen offset:2048 sc1
buffer_store_dwordx4 a[12:15], v243, s[16:19], s52 offen offset:3072 sc1
s_add_u32 s52, s52, 4096
buffer_store_dwordx4 a[16:19], v243, s[16:19], s52 offen offset:0 sc1
buffer_store_dwordx4 a[20:23], v243, s[16:19], s52 offen offset:1024 sc1
buffer_store_dwordx4 a[24:27], v243, s[16:19], s52 offen offset:2048 sc1
buffer_store_dwordx4 a[28:31], v243, s[16:19], s52 offen offset:3072 sc1
s_add_u32 s52, s52, 4096
buffer_store_dwordx4 a[32:35], v243, s[16:19], s52 offen offset:0 sc1
buffer_store_dwordx4 a[36:39], v243, s[16:19], s52 offen offset:1024 sc1
buffer_store_dwordx4 a[40:43], v243, s[16:19], s52 offen offset:2048 sc1
buffer_store_dwordx4 a[44:47], v243, s[16:19], s52 offen offset:3072 sc1
s_add_u32 s52, s52, 4096
buffer_store_dwordx4 a[48:51], v243, s[16:19], s52 offen offset:0 sc1
buffer_store_dwordx4 a[52:55], v243, s[16:19], s52 offen offset:1024 sc1
buffer_store_dwordx4 a[56:59], v243, s[16:19], s52 offen offset:2048 sc1
buffer_store_dwordx4 a[60:63], v243, s[16:19], s52 offen offset:3072 sc1
s_add_u32 s52, s52, 4096
buffer_store_dwordx2 v[172:173], v243, s[16:19], s52 offen sc1
s_waitcnt vmcnt(0)
v_mov_b32 v176, s98
v_mov_b32 v177, s99
s_mov_b64 exec, 1
buffer_store_dwordx2 v[176:177], off, s[16:19], s53 sc1
s_mov_b64 exec, -1
s_branch L2_fin
LT_merge:
s_mov_b32 s94, 0x10000
LT_mw:
buffer_load_dwordx2 v[0:1], off, s[16:19], s53 sc1
s_sub_u32 s94, s94, 1
s_waitcnt vmcnt(0)
s_cbranch_scc1 LT_mw_go
v_cmp_ne_u64 vcc, s[98:99], v[0:1]
s_nop 1
s_cbranch_vccnz LT_mw
LT_mw_go:
buffer_load_dwordx4 v[96:99], v243, s[16:19], s52 offen offset:0 sc1
buffer_load_dwordx4 v[100:103], v243, s[16:19], s52 offen offset:1024 sc1
buffer_load_dwordx4 v[104:107], v243, s[16:19], s52 offen offset:2048 sc1
buffer_load_dwordx4 v[108:111], v243, s[16:19], s52 offen offset:3072 sc1
s_add_u32 s52, s52, 4096
buffer_load_dwordx4 v[112:115], v243, s[16:19], s52 offen offset:0 sc1
buffer_load_dwordx4 v[116:119], v243, s[16:19], s52 offen offset:1024 sc1
buffer_load_dwordx4 v[120:123], v243, s[16:19], s52 offen offset:2048 sc1
buffer_load_dwordx4 v[124:127], v243, s[16:19], s52 offen offset:3072 sc1
s_add_u32 s52, s52, 4096
buffer_load_dwordx4 v[128:131], v243, s[16:19], s52 offen offset:0 sc1
buffer_load_dwordx4 v[132:135], v243, s[16:19], s52 offen offset:1024 sc1
buffer_load_dwordx4 v[136:139], v243, s[16:19], s52 offen offset:2048 sc1
buffer_load_dwordx4 v[140:143], v243, s[16:19], s52 offen offset:3072 sc1
s_add_u32 s52, s52, 4096
buffer_load_dwordx4 v[144:147], v243, s[16:19], s52 offen offset:0 sc1
buffer_load_dwordx4 v[148:151], v243, s[16:19], s52 offen offset:1024 sc1
buffer_load_dwordx4 v[152:155], v243, s[16:19], s52 offen offset:2048 sc1
buffer_load_dwordx4 v[156:159], v243, s[16:19], s52 offen offset:3072 sc1
s_add_u32 s52, s52, 4096
buffer_load_dwordx2 v[0:1], v243, s[16:19], s52 offen sc1
v_lshrrev_b32 v176, 4, v243
v_and_b32 v176, 0x30, v176
s_waitcnt vmcnt(0)
v_max_f32 v175, v172, v0
v_sub_f32 v2, v172, v175
v_sub_f32 v3, v0, v175
v_mov_b32 v172, v175
v_exp_f32 v2, v2
v_exp_f32 v3, v3
s_nop 0
v_mul_f32 v173, v173, v2
v_fmac_f32 v173, v1, v3
ds_bpermute_b32 v4, v176, v2 offset:0
ds_bpermute_b32 v8, v176, v3 offset:0
ds_bpermute_b32 v5, v176, v2 offset:4
ds_bpermute_b32 v9, v176, v3 offset:4
ds_bpermute_b32 v6, v176, v2 offset:8
ds_bpermute_b32 v10, v176, v3 offset:8
ds_bpermute_b32 v7, v176, v2 offset:12
ds_bpermute_b32 v11, v176, v3 offset:12
s_waitcnt lgkmcnt(0)
v_accvgpr_read_b32 v180, a0
v_accvgpr_read_b32 v181, a1
v_accvgpr_read_b32 v182, a2
v_accvgpr_read_b32 v183, a3
v_accvgpr_read_b32 v184, a4
v_accvgpr_read_b32 v185, a5
v_accvgpr_read_b32 v186, a6
v_accvgpr_read_b32 v187, a7
v_mul_f32 v180, v180, v4
v_mul_f32 v181, v181, v5
v_mul_f32 v182, v182, v6
v_mul_f32 v183, v183, v7
v_mul_f32 v184, v184, v4
v_mul_f32 v185, v185, v5
v_mul_f32 v186, v186, v6
v_mul_f32 v187, v187, v7
v_fmac_f32 v180, v96, v8
v_fmac_f32 v181, v97, v9
v_fmac_f32 v182, v98, v10
v_fmac_f32 v183, v99, v11
v_fmac_f32 v184, v100, v8
v_fmac_f32 v185, v101, v9
v_fmac_f32 v186, v102, v10
v_fmac_f32 v187, v103, v11
v_cvt_pk_bf16_f32 v32, v180, v181
v_cvt_pk_bf16_f32 v33, v182, v183
v_cvt_pk_bf16_f32 v34, v184, v185
v_cvt_pk_bf16_f32 v35, v186, v187
buffer_store_dwordx4 v[32:35], v243, s[20:23], s40 offen offset:0 sc1
v_accvgpr_read_b32 v180, a8
v_accvgpr_read_b32 v181, a9
v_accvgpr_read_b32 v182, a10
v_accvgpr_read_b32 v183, a11
v_accvgpr_read_b32 v184, a12
v_accvgpr_read_b32 v185, a13
v_accvgpr_read_b32 v186, a14
v_accvgpr_read_b32 v187, a15
v_mul_f32 v180, v180, v4
v_mul_f32 v181, v181, v5
v_mul_f32 v182, v182, v6
v_mul_f32 v183, v183, v7
v_mul_f32 v184, v184, v4
v_mul_f32 v185, v185, v5
v_mul_f32 v186, v186, v6
v_mul_f32 v187, v187, v7
v_fmac_f32 v180, v104, v8
v_fmac_f32 v181, v105, v9
v_fmac_f32 v182, v106, v10
v_fmac_f32 v183, v107, v11
v_fmac_f32 v184, v108, v8
v_fmac_f32 v185, v109, v9
v_fmac_f32 v186, v110, v10
v_fmac_f32 v187, v111, v11
v_cvt_pk_bf16_f32 v36, v180, v181
v_cvt_pk_bf16_f32 v37, v182, v183
v_cvt_pk_bf16_f32 v38, v184, v185
v_cvt_pk_bf16_f32 v39, v186, v187
buffer_store_dwordx4 v[36:39], v243, s[20:23], s40 offen offset:1024 sc1
v_accvgpr_read_b32 v180, a16
v_accvgpr_read_b32 v181, a17
v_accvgpr_read_b32 v182, a18
v_accvgpr_read_b32 v183, a19
v_accvgpr_read_b32 v184, a20
v_accvgpr_read_b32 v185, a21
v_accvgpr_read_b32 v186, a22
v_accvgpr_read_b32 v187, a23
v_mul_f32 v180, v180, v4
v_mul_f32 v181, v181, v5
v_mul_f32 v182, v182, v6
v_mul_f32 v183, v183, v7
v_mul_f32 v184, v184, v4
v_mul_f32 v185, v185, v5
v_mul_f32 v186, v186, v6
v_mul_f32 v187, v187, v7
v_fmac_f32 v180, v112, v8
v_fmac_f32 v181, v113, v9
v_fmac_f32 v182, v114, v10
v_fmac_f32 v183, v115, v11
v_fmac_f32 v184, v116, v8
v_fmac_f32 v185, v117, v9
v_fmac_f32 v186, v118, v10
v_fmac_f32 v187, v119, v11
v_cvt_pk_bf16_f32 v40, v180, v181
v_cvt_pk_bf16_f32 v41, v182, v183
v_cvt_pk_bf16_f32 v42, v184, v185
v_cvt_pk_bf16_f32 v43, v186, v187
buffer_store_dwordx4 v[40:43], v243, s[20:23], s40 offen offset:2048 sc1
v_accvgpr_read_b32 v180, a24
v_accvgpr_read_b32 v181, a25
v_accvgpr_read_b32 v182, a26
v_accvgpr_read_b32 v183, a27
v_accvgpr_read_b32 v184, a28
v_accvgpr_read_b32 v185, a29
v_accvgpr_read_b32 v186, a30
v_accvgpr_read_b32 v187, a31
v_mul_f32 v180, v180, v4
v_mul_f32 v181, v181, v5
v_mul_f32 v182, v182, v6
v_mul_f32 v183, v183, v7
v_mul_f32 v184, v184, v4
v_mul_f32 v185, v185, v5
v_mul_f32 v186, v186, v6
v_mul_f32 v187, v187, v7
v_fmac_f32 v180, v120, v8
v_fmac_f32 v181, v121, v9
v_fmac_f32 v182, v122, v10
v_fmac_f32 v183, v123, v11
v_fmac_f32 v184, v124, v8
v_fmac_f32 v185, v125, v9
v_fmac_f32 v186, v126, v10
v_fmac_f32 v187, v127, v11
v_cvt_pk_bf16_f32 v44, v180, v181
v_cvt_pk_bf16_f32 v45, v182, v183
v_cvt_pk_bf16_f32 v46, v184, v185
v_cvt_pk_bf16_f32 v47, v186, v187
buffer_store_dwordx4 v[44:47], v243, s[20:23], s40 offen offset:3072 sc1
v_accvgpr_read_b32 v180, a32
v_accvgpr_read_b32 v181, a33
v_accvgpr_read_b32 v182, a34
v_accvgpr_read_b32 v183, a35
v_accvgpr_read_b32 v184, a36
v_accvgpr_read_b32 v185, a37
v_accvgpr_read_b32 v186, a38
v_accvgpr_read_b32 v187, a39
v_mul_f32 v180, v180, v4
v_mul_f32 v181, v181, v5
v_mul_f32 v182, v182, v6
v_mul_f32 v183, v183, v7
v_mul_f32 v184, v184, v4
v_mul_f32 v185, v185, v5
v_mul_f32 v186, v186, v6
v_mul_f32 v187, v187, v7
v_fmac_f32 v180, v128, v8
v_fmac_f32 v181, v129, v9
v_fmac_f32 v182, v130, v10
v_fmac_f32 v183, v131, v11
v_fmac_f32 v184, v132, v8
v_fmac_f32 v185, v133, v9
v_fmac_f32 v186, v134, v10
v_fmac_f32 v187, v135, v11
v_cvt_pk_bf16_f32 v48, v180, v181
v_cvt_pk_bf16_f32 v49, v182, v183
v_cvt_pk_bf16_f32 v50, v184, v185
v_cvt_pk_bf16_f32 v51, v186, v187
buffer_store_dwordx4 v[48:51], v243, s[20:23], s44 offen offset:0 sc1
v_accvgpr_read_b32 v180, a40
v_accvgpr_read_b32 v181, a41
v_accvgpr_read_b32 v182, a42
v_accvgpr_read_b32 v183, a43
v_accvgpr_read_b32 v184, a44
v_accvgpr_read_b32 v185, a45
v_accvgpr_read_b32 v186, a46
v_accvgpr_read_b32 v187, a47
v_mul_f32 v180, v180, v4
v_mul_f32 v181, v181, v5
v_mul_f32 v182, v182, v6
v_mul_f32 v183, v183, v7
v_mul_f32 v184, v184, v4
v_mul_f32 v185, v185, v5
v_mul_f32 v186, v186, v6
v_mul_f32 v187, v187, v7
v_fmac_f32 v180, v136, v8
v_fmac_f32 v181, v137, v9
v_fmac_f32 v182, v138, v10
v_fmac_f32 v183, v139, v11
v_fmac_f32 v184, v140, v8
v_fmac_f32 v185, v141, v9
v_fmac_f32 v186, v142, v10
v_fmac_f32 v187, v143, v11
v_cvt_pk_bf16_f32 v52, v180, v181
v_cvt_pk_bf16_f32 v53, v182, v183
v_cvt_pk_bf16_f32 v54, v184, v185
v_cvt_pk_bf16_f32 v55, v186, v187
buffer_store_dwordx4 v[52:55], v243, s[20:23], s44 offen offset:1024 sc1
v_accvgpr_read_b32 v180, a48
v_accvgpr_read_b32 v181, a49
v_accvgpr_read_b32 v182, a50
v_accvgpr_read_b32 v183, a51
v_accvgpr_read_b32 v184, a52
v_accvgpr_read_b32 v185, a53
v_accvgpr_read_b32 v186, a54
v_accvgpr_read_b32 v187, a55
v_mul_f32 v180, v180, v4
v_mul_f32 v181, v181, v5
v_mul_f32 v182, v182, v6
v_mul_f32 v183, v183, v7
v_mul_f32 v184, v184, v4
v_mul_f32 v185, v185, v5
v_mul_f32 v186, v186, v6
v_mul_f32 v187, v187, v7
v_fmac_f32 v180, v144, v8
v_fmac_f32 v181, v145, v9
v_fmac_f32 v182, v146, v10
v_fmac_f32 v183, v147, v11
v_fmac_f32 v184, v148, v8
v_fmac_f32 v185, v149, v9
v_fmac_f32 v186, v150, v10
v_fmac_f32 v187, v151, v11
v_cvt_pk_bf16_f32 v56, v180, v181
v_cvt_pk_bf16_f32 v57, v182, v183
v_cvt_pk_bf16_f32 v58, v184, v185
v_cvt_pk_bf16_f32 v59, v186, v187
buffer_store_dwordx4 v[56:59], v243, s[20:23], s44 offen offset:2048 sc1
v_accvgpr_read_b32 v180, a56
v_accvgpr_read_b32 v181, a57
v_accvgpr_read_b32 v182, a58
v_accvgpr_read_b32 v183, a59
v_accvgpr_read_b32 v184, a60
v_accvgpr_read_b32 v185, a61
v_accvgpr_read_b32 v186, a62
v_accvgpr_read_b32 v187, a63
v_mul_f32 v180, v180, v4
v_mul_f32 v181, v181, v5
v_mul_f32 v182, v182, v6
v_mul_f32 v183, v183, v7
v_mul_f32 v184, v184, v4
v_mul_f32 v185, v185, v5
v_mul_f32 v186, v186, v6
v_mul_f32 v187, v187, v7
v_fmac_f32 v180, v152, v8
v_fmac_f32 v181, v153, v9
v_fmac_f32 v182, v154, v10
v_fmac_f32 v183, v155, v11
v_fmac_f32 v184, v156, v8
v_fmac_f32 v185, v157, v9
v_fmac_f32 v186, v158, v10
v_fmac_f32 v187, v159, v11
v_cvt_pk_bf16_f32 v60, v180, v181
v_cvt_pk_bf16_f32 v61, v182, v183
v_cvt_pk_bf16_f32 v62, v184, v185
v_cvt_pk_bf16_f32 v63, v186, v187
buffer_store_dwordx4 v[60:63], v243, s[20:23], s44 offen offset:3072 sc1
v_mov_b32 v176, v173
s_nop 1
v_permlane32_swap_b32 v173, v176
s_nop 1
v_add_f32 v173, v173, v176
v_mov_b32 v176, v173
s_nop 1
v_permlane16_swap_b32 v173, v176
s_nop 1
v_add_f32 v173, v173, v176
v_lshlrev_b32 v175, 2, v243
s_mov_b64 exec, 0xffff
s_mov_b64 exec, -1
v_bfe_u32 v175, v243, 8, 1
v_mul_u32_u24 v175, 48, v175
v_lshl_add_u32 v175, s37, 3, v175
v_and_b32 v176, 0xf0, v243
v_lshl_add_u32 v175, v176, 3, v175
s_mov_b32 exec_hi, 0
buffer_store_dwordx2 v[172:173], v175, s[24:27], s48 offen sc1
s_add_u32 s16, s4, 0x7c00000
s_addc_u32 s17, s5, 0
s_mov_b32 s18, 0x40000
s_mov_b32 s19, 0x00020000
s_add_u32 s48, s37, 1248
s_mul_i32 s48, s48, 128
s_waitcnt vmcnt(0)
v_mov_b32 v176, s98
v_mov_b32 v177, s99
s_mov_b64 exec, 1
buffer_store_dwordx2 v[176:177], off, s[16:19], s48 sc1
buffer_store_dwordx2 v[176:177], off, s[16:19], s48 offset:8 sc1
s_mov_b64 exec, -1
s_branch L2_fin
LE_start:
s_cmp_ge_u32 s37, 32
s_cbranch_scc1 L2_end
v_lshrrev_b32 v1, 6, v0
s_sub_u32 s37, s37, 30
s_lshl_b32 s35, s35, 1
v_readfirstlane_b32 s41, v1
s_add_u32 s35, s35, s37
s_mul_i32 s35, s35, 3
s_add_u32 s40, s35, s41
s_cmp_ge_u32 s41, 3
s_cbranch_scc1 L2_end
LE_common:
v_and_b32 v1, 63, v0
s_sub_u32 s36, s40, 0
s_mov_b32 s54, 151
s_mul_i32 s36, s36, 151
s_mov_b32 s55, s36
s_sub_u32 s36, s40, 36
s_cselect_b32 s54, s54, 166
s_mul_i32 s36, s36, 166
s_add_u32 s36, s36, 5436
s_cmp_lt_u32 s40, 36
s_cselect_b32 s55, s55, s36
s_sub_u32 s36, s40, 42
s_cselect_b32 s54, s54, 152
s_mul_i32 s36, s36, 152
s_add_u32 s36, s36, 6432
s_cmp_lt_u32 s40, 42
s_cselect_b32 s55, s55, s36
s_sub_u32 s36, s40, 48
s_cselect_b32 s54, s54, 168
s_mul_i32 s36, s36, 168
s_add_u32 s36, s36, 7344
s_cmp_lt_u32 s40, 48
s_cselect_b32 s55, s55, s36
s_mov_b32 s42, 0
s_mov_b32 s49, 512
v_lshrrev_b32 v33, 2, v1
v_and_b32 v34, 3, v1
v_mul_u32_u24 v6, 0xa000, v33
v_lshl_add_u32 v6, v34, 4, v6
v_lshlrev_b32 v33, 2, v33
s_mul_i32 s50, s40, 655360
s_mul_i32 s48, s40, 64
s_waitcnt lgkmcnt(0)
s_add_u32 s8, s4, 0x7c31800
s_addc_u32 s9, s5, 0
s_mov_b32 s10, 0x800
s_mov_b32 s11, 0x00020000
v_and_b32 v194, 15, v0
v_lshlrev_b32 v194, 7, v194
s_mov_b32 s94, 0x10000
LE_poll0:
buffer_load_dwordx2 v[192:193], v194, s[8:11], 0 offen sc1
s_sub_u32 s94, s94, 1
s_waitcnt vmcnt(0)
s_cbranch_scc1 LE_poll0_go
v_cmp_ne_u64 vcc, s[98:99], v[192:193]
s_nop 1
s_cbranch_vccnz LE_poll0
LE_poll0_go:
s_add_u32 s8, s4, 0x7800000
s_addc_u32 s9, s5, 0
s_mov_b32 s10, 0x1000
s_mov_b32 s11, 0x00020000
s_add_u32 s12, s4, 0x8000000
s_addc_u32 s13, s5, 0
s_mov_b32 s14, 0x2800000
s_mov_b32 s15, 0x00020000
buffer_load_dword v4, v33, s[8:11], s48 offen sc1
buffer_load_dwordx4 v[192:195], v6, s[12:15], s50 offen offset:0 sc1
buffer_load_dwordx4 v[196:199], v6, s[12:15], s50 offen offset:64 sc1
buffer_load_dwordx4 v[200:203], v6, s[12:15], s50 offen offset:128 sc1
buffer_load_dwordx4 v[204:207], v6, s[12:15], s50 offen offset:192 sc1
buffer_load_dwordx4 v[208:211], v6, s[12:15], s50 offen offset:256 sc1
buffer_load_dwordx4 v[212:215], v6, s[12:15], s50 offen offset:320 sc1
buffer_load_dwordx4 v[216:219], v6, s[12:15], s50 offen offset:384 sc1
buffer_load_dwordx4 v[220:223], v6, s[12:15], s50 offen offset:448 sc1
buffer_load_dwordx4 v[224:227], v6, s[12:15], s50 offen offset:512 sc1
buffer_load_dwordx4 v[228:231], v6, s[12:15], s50 offen offset:576 sc1
buffer_load_dwordx4 v[232:235], v6, s[12:15], s50 offen offset:640 sc1
buffer_load_dwordx4 v[236:239], v6, s[12:15], s50 offen offset:704 sc1
buffer_load_dwordx4 v[240:243], v6, s[12:15], s50 offen offset:768 sc1
buffer_load_dwordx4 v[244:247], v6, s[12:15], s50 offen offset:832 sc1
buffer_load_dwordx4 v[248:251], v6, s[12:15], s50 offen offset:896 sc1
buffer_load_dwordx4 v[252:255], v6, s[12:15], s50 offen offset:960 sc1
s_add_u32 s16, s4, 0x6800000
s_addc_u32 s17, s5, 0
s_mov_b32 s18, 0x4e2000
s_mov_b32 s19, 0x00020000
s_add_u32 s20, s4, 0x7000000
s_addc_u32 s21, s5, 0
s_mov_b32 s22, 0x4e2000
s_mov_b32 s23, 0x00020000
v_lshlrev_b32 v5, 2, v34
v_and_b32 v2, 15, v1
v_lshrrev_b32 v3, 4, v1
v_mov_b32 v16, 1
v_mov_b32 v17, 4
v_and_b32 v33, 1, v2
v_lshlrev_b32 v33, 4, v33
v_lshlrev_b32 v33, v33, v16
v_mul_u32_u24 v33, 0x3f80, v33
v_lshrrev_b32 v34, 1, v2
v_cmp_eq_u32 vcc, 0, v34
s_nop 1
v_cndmask_b32 v40, 0, v33, vcc
v_cmp_eq_u32 vcc, 1, v34
s_nop 1
v_cndmask_b32 v41, 0, v33, vcc
v_cmp_eq_u32 vcc, 2, v34
s_nop 1
v_cndmask_b32 v42, 0, v33, vcc
v_cmp_eq_u32 vcc, 3, v34
s_nop 1
v_cndmask_b32 v43, 0, v33, vcc
v_cmp_eq_u32 vcc, 4, v34
s_nop 1
v_cndmask_b32 v44, 0, v33, vcc
v_cmp_eq_u32 vcc, 5, v34
s_nop 1
v_cndmask_b32 v45, 0, v33, vcc
v_cmp_eq_u32 vcc, 6, v34
s_nop 1
v_cndmask_b32 v46, 0, v33, vcc
v_cmp_eq_u32 vcc, 7, v34
s_nop 1
v_cndmask_b32 v47, 0, v33, vcc
v_lshlrev_b32 v39, 5, v2
v_lshl_add_u32 v39, v3, 3, v39
v_lshlrev_b32 v2, 4, v2
s_mul_i32 s48, s41, 21504
s_add_u32 s48, s48, 4096
v_mov_b32 v36, s48
v_lshl_add_u32 v38, v3, 2, v36
s_lshl_b32 s36, s41, 10
s_lshl_b32 s35, s55, 2
s_sub_u32 s35, s36, s35
v_mov_b32 v7, s35
v_lshlrev_b32 v35, 4, v1
v_add_u32 v68, s48, v35
v_add_u32 v35, s36, v35
v_lshlrev_b32 v33, 2, v1
v_mov_b32 v72, 0xffff
v_mov_b32 v73, 0xffff
v_mov_b32 v74, 0xffff
v_mov_b32 v75, 0xffff
v_cmp_gt_u32 vcc, s54, v33
v_mov_b32 v48, 0
s_nop 0
v_cndmask_b32 v18, 0, v16, vcc
v_add_u32 v33, 1, v33
v_cmp_gt_u32 vcc, s54, v33
v_mov_b32 v49, 0
s_nop 0
v_cndmask_b32 v19, 0, v16, vcc
v_add_u32 v33, 1, v33
v_cmp_gt_u32 vcc, s54, v33
v_mov_b32 v50, 0
s_nop 0
v_cndmask_b32 v20, 0, v16, vcc
v_add_u32 v33, 1, v33
v_cmp_gt_u32 vcc, s54, v33
v_mov_b32 v51, 0
s_nop 0
v_cndmask_b32 v21, 0, v16, vcc
LE_pass:
ds_write_b128 v35, v[48:51]
ds_write_b128 v68, v[72:75] offset:0
ds_write_b128 v68, v[72:75] offset:1024
ds_write_b128 v68, v[72:75] offset:2048
ds_write_b128 v68, v[72:75] offset:3072
ds_write_b128 v68, v[72:75] offset:4096
ds_write_b128 v68, v[72:75] offset:5120
ds_write_b128 v68, v[72:75] offset:6144
ds_write_b128 v68, v[72:75] offset:7168
ds_write_b128 v68, v[72:75] offset:8192
ds_write_b128 v68, v[72:75] offset:9216
ds_write_b128 v68, v[72:75] offset:10240
ds_write_b128 v68, v[72:75] offset:11264
ds_write_b128 v68, v[72:75] offset:12288
ds_write_b128 v68, v[72:75] offset:13312
ds_write_b128 v68, v[72:75] offset:14336
ds_write_b128 v68, v[72:75] offset:15360
ds_write_b128 v68, v[72:75] offset:16384
ds_write_b128 v68, v[72:75] offset:17408
ds_write_b128 v68, v[72:75] offset:18432
ds_write_b128 v68, v[72:75] offset:19456
v_lshl_add_u32 v32, v1, 2, v36
ds_write_b32 v32, v48 offset:20480
s_waitcnt vmcnt(16)
v_sub_u32 v32, v4, v5
s_waitcnt vmcnt(15)
v_cmpx_lt_i32 vcc, 0, v32
s_cbranch_execz LE_c
v_mad_u32_u16 v128, v192, 1, v7 op_sel:[1,0,0,0]
ds_add_u32 v128, v16
v_cmpx_lt_i32 vcc, 1, v32
v_mad_u32_u16 v129, v193, 1, v7 op_sel:[1,0,0,0]
ds_add_u32 v129, v16
v_cmpx_lt_i32 vcc, 2, v32
v_mad_u32_u16 v130, v194, 1, v7 op_sel:[1,0,0,0]
ds_add_u32 v130, v16
v_cmpx_lt_i32 vcc, 3, v32
v_mad_u32_u16 v131, v195, 1, v7 op_sel:[1,0,0,0]
ds_add_u32 v131, v16
s_waitcnt vmcnt(14)
v_cmpx_lt_i32 vcc, 16, v32
s_cbranch_execz LE_c
v_mad_u32_u16 v132, v196, 1, v7 op_sel:[1,0,0,0]
ds_add_u32 v132, v16
v_cmpx_lt_i32 vcc, 17, v32
v_mad_u32_u16 v133, v197, 1, v7 op_sel:[1,0,0,0]
ds_add_u32 v133, v16
v_cmpx_lt_i32 vcc, 18, v32
v_mad_u32_u16 v134, v198, 1, v7 op_sel:[1,0,0,0]
ds_add_u32 v134, v16
v_cmpx_lt_i32 vcc, 19, v32
v_mad_u32_u16 v135, v199, 1, v7 op_sel:[1,0,0,0]
ds_add_u32 v135, v16
s_waitcnt vmcnt(13)
v_cmpx_lt_i32 vcc, 32, v32
s_cbranch_execz LE_c
v_mad_u32_u16 v136, v200, 1, v7 op_sel:[1,0,0,0]
ds_add_u32 v136, v16
v_cmpx_lt_i32 vcc, 33, v32
v_mad_u32_u16 v137, v201, 1, v7 op_sel:[1,0,0,0]
ds_add_u32 v137, v16
v_cmpx_lt_i32 vcc, 34, v32
v_mad_u32_u16 v138, v202, 1, v7 op_sel:[1,0,0,0]
ds_add_u32 v138, v16
v_cmpx_lt_i32 vcc, 35, v32
v_mad_u32_u16 v139, v203, 1, v7 op_sel:[1,0,0,0]
ds_add_u32 v139, v16
s_waitcnt vmcnt(12)
v_cmpx_lt_i32 vcc, 48, v32
s_cbranch_execz LE_c
v_mad_u32_u16 v140, v204, 1, v7 op_sel:[1,0,0,0]
ds_add_u32 v140, v16
v_cmpx_lt_i32 vcc, 49, v32
v_mad_u32_u16 v141, v205, 1, v7 op_sel:[1,0,0,0]
ds_add_u32 v141, v16
v_cmpx_lt_i32 vcc, 50, v32
v_mad_u32_u16 v142, v206, 1, v7 op_sel:[1,0,0,0]
ds_add_u32 v142, v16
v_cmpx_lt_i32 vcc, 51, v32
v_mad_u32_u16 v143, v207, 1, v7 op_sel:[1,0,0,0]
ds_add_u32 v143, v16
s_waitcnt vmcnt(11)
v_cmpx_lt_i32 vcc, 64, v32
s_cbranch_execz LE_c
v_mad_u32_u16 v144, v208, 1, v7 op_sel:[1,0,0,0]
ds_add_u32 v144, v16
v_cmpx_lt_i32 vcc, 65, v32
v_mad_u32_u16 v145, v209, 1, v7 op_sel:[1,0,0,0]
ds_add_u32 v145, v16
v_cmpx_lt_i32 vcc, 66, v32
v_mad_u32_u16 v146, v210, 1, v7 op_sel:[1,0,0,0]
ds_add_u32 v146, v16
v_cmpx_lt_i32 vcc, 67, v32
v_mad_u32_u16 v147, v211, 1, v7 op_sel:[1,0,0,0]
ds_add_u32 v147, v16
s_waitcnt vmcnt(10)
v_cmpx_lt_i32 vcc, 80, v32
s_cbranch_execz LE_c
v_mad_u32_u16 v148, v212, 1, v7 op_sel:[1,0,0,0]
ds_add_u32 v148, v16
v_cmpx_lt_i32 vcc, 81, v32
v_mad_u32_u16 v149, v213, 1, v7 op_sel:[1,0,0,0]
ds_add_u32 v149, v16
v_cmpx_lt_i32 vcc, 82, v32
v_mad_u32_u16 v150, v214, 1, v7 op_sel:[1,0,0,0]
ds_add_u32 v150, v16
v_cmpx_lt_i32 vcc, 83, v32
v_mad_u32_u16 v151, v215, 1, v7 op_sel:[1,0,0,0]
ds_add_u32 v151, v16
s_waitcnt vmcnt(9)
v_cmpx_lt_i32 vcc, 96, v32
s_cbranch_execz LE_c
v_mad_u32_u16 v152, v216, 1, v7 op_sel:[1,0,0,0]
ds_add_u32 v152, v16
v_cmpx_lt_i32 vcc, 97, v32
v_mad_u32_u16 v153, v217, 1, v7 op_sel:[1,0,0,0]
ds_add_u32 v153, v16
v_cmpx_lt_i32 vcc, 98, v32
v_mad_u32_u16 v154, v218, 1, v7 op_sel:[1,0,0,0]
ds_add_u32 v154, v16
v_cmpx_lt_i32 vcc, 99, v32
v_mad_u32_u16 v155, v219, 1, v7 op_sel:[1,0,0,0]
ds_add_u32 v155, v16
s_waitcnt vmcnt(8)
v_cmpx_lt_i32 vcc, 112, v32
s_cbranch_execz LE_c
v_mad_u32_u16 v156, v220, 1, v7 op_sel:[1,0,0,0]
ds_add_u32 v156, v16
v_cmpx_lt_i32 vcc, 113, v32
v_mad_u32_u16 v157, v221, 1, v7 op_sel:[1,0,0,0]
ds_add_u32 v157, v16
v_cmpx_lt_i32 vcc, 114, v32
v_mad_u32_u16 v158, v222, 1, v7 op_sel:[1,0,0,0]
ds_add_u32 v158, v16
v_cmpx_lt_i32 vcc, 115, v32
v_mad_u32_u16 v159, v223, 1, v7 op_sel:[1,0,0,0]
ds_add_u32 v159, v16
s_waitcnt vmcnt(7)
v_cmpx_lt_i32 vcc, 128, v32
s_cbranch_execz LE_c
v_mad_u32_u16 v160, v224, 1, v7 op_sel:[1,0,0,0]
ds_add_u32 v160, v16
v_cmpx_lt_i32 vcc, 129, v32
v_mad_u32_u16 v161, v225, 1, v7 op_sel:[1,0,0,0]
ds_add_u32 v161, v16
v_cmpx_lt_i32 vcc, 130, v32
v_mad_u32_u16 v162, v226, 1, v7 op_sel:[1,0,0,0]
ds_add_u32 v162, v16
v_cmpx_lt_i32 vcc, 131, v32
v_mad_u32_u16 v163, v227, 1, v7 op_sel:[1,0,0,0]
ds_add_u32 v163, v16
s_waitcnt vmcnt(6)
v_cmpx_lt_i32 vcc, 144, v32
s_cbranch_execz LE_c
v_mad_u32_u16 v164, v228, 1, v7 op_sel:[1,0,0,0]
ds_add_u32 v164, v16
v_cmpx_lt_i32 vcc, 145, v32
v_mad_u32_u16 v165, v229, 1, v7 op_sel:[1,0,0,0]
ds_add_u32 v165, v16
v_cmpx_lt_i32 vcc, 146, v32
v_mad_u32_u16 v166, v230, 1, v7 op_sel:[1,0,0,0]
ds_add_u32 v166, v16
v_cmpx_lt_i32 vcc, 147, v32
v_mad_u32_u16 v167, v231, 1, v7 op_sel:[1,0,0,0]
ds_add_u32 v167, v16
s_waitcnt vmcnt(5)
v_cmpx_lt_i32 vcc, 160, v32
s_cbranch_execz LE_c
v_mad_u32_u16 v168, v232, 1, v7 op_sel:[1,0,0,0]
ds_add_u32 v168, v16
v_cmpx_lt_i32 vcc, 161, v32
v_mad_u32_u16 v169, v233, 1, v7 op_sel:[1,0,0,0]
ds_add_u32 v169, v16
v_cmpx_lt_i32 vcc, 162, v32
v_mad_u32_u16 v170, v234, 1, v7 op_sel:[1,0,0,0]
ds_add_u32 v170, v16
v_cmpx_lt_i32 vcc, 163, v32
v_mad_u32_u16 v171, v235, 1, v7 op_sel:[1,0,0,0]
ds_add_u32 v171, v16
s_waitcnt vmcnt(4)
v_cmpx_lt_i32 vcc, 176, v32
s_cbranch_execz LE_c
v_mad_u32_u16 v172, v236, 1, v7 op_sel:[1,0,0,0]
ds_add_u32 v172, v16
v_cmpx_lt_i32 vcc, 177, v32
v_mad_u32_u16 v173, v237, 1, v7 op_sel:[1,0,0,0]
ds_add_u32 v173, v16
v_cmpx_lt_i32 vcc, 178, v32
v_mad_u32_u16 v174, v238, 1, v7 op_sel:[1,0,0,0]
ds_add_u32 v174, v16
v_cmpx_lt_i32 vcc, 179, v32
v_mad_u32_u16 v175, v239, 1, v7 op_sel:[1,0,0,0]
ds_add_u32 v175, v16
s_waitcnt vmcnt(3)
v_cmpx_lt_i32 vcc, 192, v32
s_cbranch_execz LE_c
v_mad_u32_u16 v176, v240, 1, v7 op_sel:[1,0,0,0]
ds_add_u32 v176, v16
v_cmpx_lt_i32 vcc, 193, v32
v_mad_u32_u16 v177, v241, 1, v7 op_sel:[1,0,0,0]
ds_add_u32 v177, v16
v_cmpx_lt_i32 vcc, 194, v32
v_mad_u32_u16 v178, v242, 1, v7 op_sel:[1,0,0,0]
ds_add_u32 v178, v16
v_cmpx_lt_i32 vcc, 195, v32
v_mad_u32_u16 v179, v243, 1, v7 op_sel:[1,0,0,0]
ds_add_u32 v179, v16
s_waitcnt vmcnt(2)
v_cmpx_lt_i32 vcc, 208, v32
s_cbranch_execz LE_c
v_mad_u32_u16 v180, v244, 1, v7 op_sel:[1,0,0,0]
ds_add_u32 v180, v16
v_cmpx_lt_i32 vcc, 209, v32
v_mad_u32_u16 v181, v245, 1, v7 op_sel:[1,0,0,0]
ds_add_u32 v181, v16
v_cmpx_lt_i32 vcc, 210, v32
v_mad_u32_u16 v182, v246, 1, v7 op_sel:[1,0,0,0]
ds_add_u32 v182, v16
v_cmpx_lt_i32 vcc, 211, v32
v_mad_u32_u16 v183, v247, 1, v7 op_sel:[1,0,0,0]
ds_add_u32 v183, v16
s_waitcnt vmcnt(1)
v_cmpx_lt_i32 vcc, 224, v32
s_cbranch_execz LE_c
v_mad_u32_u16 v184, v248, 1, v7 op_sel:[1,0,0,0]
ds_add_u32 v184, v16
v_cmpx_lt_i32 vcc, 225, v32
v_mad_u32_u16 v185, v249, 1, v7 op_sel:[1,0,0,0]
ds_add_u32 v185, v16
v_cmpx_lt_i32 vcc, 226, v32
v_mad_u32_u16 v186, v250, 1, v7 op_sel:[1,0,0,0]
ds_add_u32 v186, v16
v_cmpx_lt_i32 vcc, 227, v32
v_mad_u32_u16 v187, v251, 1, v7 op_sel:[1,0,0,0]
ds_add_u32 v187, v16
s_waitcnt vmcnt(0)
v_cmpx_lt_i32 vcc, 240, v32
s_cbranch_execz LE_c
v_mad_u32_u16 v188, v252, 1, v7 op_sel:[1,0,0,0]
ds_add_u32 v188, v16
v_cmpx_lt_i32 vcc, 241, v32
v_mad_u32_u16 v189, v253, 1, v7 op_sel:[1,0,0,0]
ds_add_u32 v189, v16
v_cmpx_lt_i32 vcc, 242, v32
v_mad_u32_u16 v190, v254, 1, v7 op_sel:[1,0,0,0]
ds_add_u32 v190, v16
v_cmpx_lt_i32 vcc, 243, v32
v_mad_u32_u16 v191, v255, 1, v7 op_sel:[1,0,0,0]
ds_add_u32 v191, v16
LE_c:
s_mov_b64 exec, -1
ds_read_b128 v[24:27], v35
s_waitcnt lgkmcnt(0)
v_add_u32 v24, 3, v24
v_lshrrev_b32 v24, 2, v24
v_max_u32 v24, v24, v18
v_add_u32 v25, 3, v25
v_lshrrev_b32 v25, 2, v25
v_max_u32 v25, v25, v19
v_add_u32 v26, 3, v26
v_lshrrev_b32 v26, 2, v26
v_max_u32 v26, v26, v20
v_add_u32 v27, 3, v27
v_lshrrev_b32 v27, 2, v27
v_max_u32 v27, v27, v21
v_add_u32 v33, v24, v25
v_add3_u32 v33, v33, v26, v27
v_mov_b32 v64, v33
s_nop 1
v_add_u32_dpp v64, v64, v64 row_shr:1 row_mask:0xf bank_mask:0xf
s_nop 1
v_add_u32_dpp v64, v64, v64 row_shr:2 row_mask:0xf bank_mask:0xf
s_nop 1
v_add_u32_dpp v64, v64, v64 row_shr:4 row_mask:0xf bank_mask:0xf
s_nop 1
v_add_u32_dpp v64, v64, v64 row_shr:8 row_mask:0xf bank_mask:0xf
s_nop 1
v_add_u32_dpp v64, v64, v64 row_bcast:15 row_mask:0xa bank_mask:0xf
s_nop 1
v_add_u32_dpp v64, v64, v64 row_bcast:31 row_mask:0xc bank_mask:0xf
s_nop 1
v_readlane_b32 s44, v64, 63
v_sub_u32 v28, v64, v33
v_add_u32 v29, v28, v24
v_add_u32 v30, v29, v25
v_add_u32 v31, v30, v26
v_add3_u32 v33, v28, v24, -1
v_lshlrev_b32 v34, v33, v18
v_lshrrev_b32 v33, 5, v33
v_lshl_add_u32 v33, v33, 2, v36
ds_or_b32 v33, v34 offset:20480
v_lshl_add_u32 v28, v28, 4, v36
v_add3_u32 v33, v29, v25, -1
v_lshlrev_b32 v34, v33, v19
v_lshrrev_b32 v33, 5, v33
v_lshl_add_u32 v33, v33, 2, v36
ds_or_b32 v33, v34 offset:20480
v_lshl_add_u32 v29, v29, 4, v36
v_add3_u32 v33, v30, v26, -1
v_lshlrev_b32 v34, v33, v20
v_lshrrev_b32 v33, 5, v33
v_lshl_add_u32 v33, v33, 2, v36
ds_or_b32 v33, v34 offset:20480
v_lshl_add_u32 v30, v30, 4, v36
v_add3_u32 v33, v31, v27, -1
v_lshlrev_b32 v34, v33, v21
v_lshrrev_b32 v33, 5, v33
v_lshl_add_u32 v33, v33, 2, v36
ds_or_b32 v33, v34 offset:20480
v_lshl_add_u32 v31, v31, 4, v36
ds_write_b128 v35, v[28:31]
s_add_u32 s44, s44, 31
s_lshr_b32 s44, s44, 5
v_cmpx_lt_i32 vcc, 0, v32
s_cbranch_execz LE_p
ds_add_rtn_u32 v128, v128, v17
v_cmpx_lt_i32 vcc, 1, v32
ds_add_rtn_u32 v129, v129, v17
v_cmpx_lt_i32 vcc, 2, v32
ds_add_rtn_u32 v130, v130, v17
v_cmpx_lt_i32 vcc, 3, v32
ds_add_rtn_u32 v131, v131, v17
v_cmpx_lt_i32 vcc, 16, v32
s_cbranch_execz LE_p
ds_add_rtn_u32 v132, v132, v17
v_cmpx_lt_i32 vcc, 17, v32
ds_add_rtn_u32 v133, v133, v17
v_cmpx_lt_i32 vcc, 18, v32
ds_add_rtn_u32 v134, v134, v17
v_cmpx_lt_i32 vcc, 19, v32
ds_add_rtn_u32 v135, v135, v17
v_cmpx_lt_i32 vcc, 32, v32
s_cbranch_execz LE_p
ds_add_rtn_u32 v136, v136, v17
v_cmpx_lt_i32 vcc, 33, v32
ds_add_rtn_u32 v137, v137, v17
v_cmpx_lt_i32 vcc, 34, v32
ds_add_rtn_u32 v138, v138, v17
v_cmpx_lt_i32 vcc, 35, v32
ds_add_rtn_u32 v139, v139, v17
v_cmpx_lt_i32 vcc, 48, v32
s_cbranch_execz LE_p
ds_add_rtn_u32 v140, v140, v17
v_cmpx_lt_i32 vcc, 49, v32
ds_add_rtn_u32 v141, v141, v17
v_cmpx_lt_i32 vcc, 50, v32
ds_add_rtn_u32 v142, v142, v17
v_cmpx_lt_i32 vcc, 51, v32
ds_add_rtn_u32 v143, v143, v17
v_cmpx_lt_i32 vcc, 64, v32
s_cbranch_execz LE_p
ds_add_rtn_u32 v144, v144, v17
v_cmpx_lt_i32 vcc, 65, v32
ds_add_rtn_u32 v145, v145, v17
v_cmpx_lt_i32 vcc, 66, v32
ds_add_rtn_u32 v146, v146, v17
v_cmpx_lt_i32 vcc, 67, v32
ds_add_rtn_u32 v147, v147, v17
v_cmpx_lt_i32 vcc, 80, v32
s_cbranch_execz LE_p
ds_add_rtn_u32 v148, v148, v17
v_cmpx_lt_i32 vcc, 81, v32
ds_add_rtn_u32 v149, v149, v17
v_cmpx_lt_i32 vcc, 82, v32
ds_add_rtn_u32 v150, v150, v17
v_cmpx_lt_i32 vcc, 83, v32
ds_add_rtn_u32 v151, v151, v17
v_cmpx_lt_i32 vcc, 96, v32
s_cbranch_execz LE_p
ds_add_rtn_u32 v152, v152, v17
v_cmpx_lt_i32 vcc, 97, v32
ds_add_rtn_u32 v153, v153, v17
v_cmpx_lt_i32 vcc, 98, v32
ds_add_rtn_u32 v154, v154, v17
v_cmpx_lt_i32 vcc, 99, v32
ds_add_rtn_u32 v155, v155, v17
v_cmpx_lt_i32 vcc, 112, v32
s_cbranch_execz LE_p
ds_add_rtn_u32 v156, v156, v17
v_cmpx_lt_i32 vcc, 113, v32
ds_add_rtn_u32 v157, v157, v17
v_cmpx_lt_i32 vcc, 114, v32
ds_add_rtn_u32 v158, v158, v17
v_cmpx_lt_i32 vcc, 115, v32
ds_add_rtn_u32 v159, v159, v17
v_cmpx_lt_i32 vcc, 128, v32
s_cbranch_execz LE_p
ds_add_rtn_u32 v160, v160, v17
v_cmpx_lt_i32 vcc, 129, v32
ds_add_rtn_u32 v161, v161, v17
v_cmpx_lt_i32 vcc, 130, v32
ds_add_rtn_u32 v162, v162, v17
v_cmpx_lt_i32 vcc, 131, v32
ds_add_rtn_u32 v163, v163, v17
v_cmpx_lt_i32 vcc, 144, v32
s_cbranch_execz LE_p
ds_add_rtn_u32 v164, v164, v17
v_cmpx_lt_i32 vcc, 145, v32
ds_add_rtn_u32 v165, v165, v17
v_cmpx_lt_i32 vcc, 146, v32
ds_add_rtn_u32 v166, v166, v17
v_cmpx_lt_i32 vcc, 147, v32
ds_add_rtn_u32 v167, v167, v17
v_cmpx_lt_i32 vcc, 160, v32
s_cbranch_execz LE_p
ds_add_rtn_u32 v168, v168, v17
v_cmpx_lt_i32 vcc, 161, v32
ds_add_rtn_u32 v169, v169, v17
v_cmpx_lt_i32 vcc, 162, v32
ds_add_rtn_u32 v170, v170, v17
v_cmpx_lt_i32 vcc, 163, v32
ds_add_rtn_u32 v171, v171, v17
v_cmpx_lt_i32 vcc, 176, v32
s_cbranch_execz LE_p
ds_add_rtn_u32 v172, v172, v17
v_cmpx_lt_i32 vcc, 177, v32
ds_add_rtn_u32 v173, v173, v17
v_cmpx_lt_i32 vcc, 178, v32
ds_add_rtn_u32 v174, v174, v17
v_cmpx_lt_i32 vcc, 179, v32
ds_add_rtn_u32 v175, v175, v17
v_cmpx_lt_i32 vcc, 192, v32
s_cbranch_execz LE_p
ds_add_rtn_u32 v176, v176, v17
v_cmpx_lt_i32 vcc, 193, v32
ds_add_rtn_u32 v177, v177, v17
v_cmpx_lt_i32 vcc, 194, v32
ds_add_rtn_u32 v178, v178, v17
v_cmpx_lt_i32 vcc, 195, v32
ds_add_rtn_u32 v179, v179, v17
v_cmpx_lt_i32 vcc, 208, v32
s_cbranch_execz LE_p
ds_add_rtn_u32 v180, v180, v17
v_cmpx_lt_i32 vcc, 209, v32
ds_add_rtn_u32 v181, v181, v17
v_cmpx_lt_i32 vcc, 210, v32
ds_add_rtn_u32 v182, v182, v17
v_cmpx_lt_i32 vcc, 211, v32
ds_add_rtn_u32 v183, v183, v17
v_cmpx_lt_i32 vcc, 224, v32
s_cbranch_execz LE_p
ds_add_rtn_u32 v184, v184, v17
v_cmpx_lt_i32 vcc, 225, v32
ds_add_rtn_u32 v185, v185, v17
v_cmpx_lt_i32 vcc, 226, v32
ds_add_rtn_u32 v186, v186, v17
v_cmpx_lt_i32 vcc, 227, v32
ds_add_rtn_u32 v187, v187, v17
v_cmpx_lt_i32 vcc, 240, v32
s_cbranch_execz LE_p
ds_add_rtn_u32 v188, v188, v17
v_cmpx_lt_i32 vcc, 241, v32
ds_add_rtn_u32 v189, v189, v17
v_cmpx_lt_i32 vcc, 242, v32
ds_add_rtn_u32 v190, v190, v17
v_cmpx_lt_i32 vcc, 243, v32
ds_add_rtn_u32 v191, v191, v17
LE_p:
s_mov_b64 exec, -1
v_lshl_add_u32 v33, v1, 2, v36
ds_read_b32 v37, v33 offset:20480
s_waitcnt lgkmcnt(0)
v_cmpx_lt_i32 vcc, 0, v32
s_cbranch_execz LE_w
ds_write_b32 v128, v192
v_cmpx_lt_i32 vcc, 1, v32
ds_write_b32 v129, v193
v_cmpx_lt_i32 vcc, 2, v32
ds_write_b32 v130, v194
v_cmpx_lt_i32 vcc, 3, v32
ds_write_b32 v131, v195
v_cmpx_lt_i32 vcc, 16, v32
s_cbranch_execz LE_w
ds_write_b32 v132, v196
v_cmpx_lt_i32 vcc, 17, v32
ds_write_b32 v133, v197
v_cmpx_lt_i32 vcc, 18, v32
ds_write_b32 v134, v198
v_cmpx_lt_i32 vcc, 19, v32
ds_write_b32 v135, v199
v_cmpx_lt_i32 vcc, 32, v32
s_cbranch_execz LE_w
ds_write_b32 v136, v200
v_cmpx_lt_i32 vcc, 33, v32
ds_write_b32 v137, v201
v_cmpx_lt_i32 vcc, 34, v32
ds_write_b32 v138, v202
v_cmpx_lt_i32 vcc, 35, v32
ds_write_b32 v139, v203
v_cmpx_lt_i32 vcc, 48, v32
s_cbranch_execz LE_w
ds_write_b32 v140, v204
v_cmpx_lt_i32 vcc, 49, v32
ds_write_b32 v141, v205
v_cmpx_lt_i32 vcc, 50, v32
ds_write_b32 v142, v206
v_cmpx_lt_i32 vcc, 51, v32
ds_write_b32 v143, v207
v_cmpx_lt_i32 vcc, 64, v32
s_cbranch_execz LE_w
ds_write_b32 v144, v208
v_cmpx_lt_i32 vcc, 65, v32
ds_write_b32 v145, v209
v_cmpx_lt_i32 vcc, 66, v32
ds_write_b32 v146, v210
v_cmpx_lt_i32 vcc, 67, v32
ds_write_b32 v147, v211
v_cmpx_lt_i32 vcc, 80, v32
s_cbranch_execz LE_w
ds_write_b32 v148, v212
v_cmpx_lt_i32 vcc, 81, v32
ds_write_b32 v149, v213
v_cmpx_lt_i32 vcc, 82, v32
ds_write_b32 v150, v214
v_cmpx_lt_i32 vcc, 83, v32
ds_write_b32 v151, v215
v_cmpx_lt_i32 vcc, 96, v32
s_cbranch_execz LE_w
ds_write_b32 v152, v216
v_cmpx_lt_i32 vcc, 97, v32
ds_write_b32 v153, v217
v_cmpx_lt_i32 vcc, 98, v32
ds_write_b32 v154, v218
v_cmpx_lt_i32 vcc, 99, v32
ds_write_b32 v155, v219
v_cmpx_lt_i32 vcc, 112, v32
s_cbranch_execz LE_w
ds_write_b32 v156, v220
v_cmpx_lt_i32 vcc, 113, v32
ds_write_b32 v157, v221
v_cmpx_lt_i32 vcc, 114, v32
ds_write_b32 v158, v222
v_cmpx_lt_i32 vcc, 115, v32
ds_write_b32 v159, v223
v_cmpx_lt_i32 vcc, 128, v32
s_cbranch_execz LE_w
ds_write_b32 v160, v224
v_cmpx_lt_i32 vcc, 129, v32
ds_write_b32 v161, v225
v_cmpx_lt_i32 vcc, 130, v32
ds_write_b32 v162, v226
v_cmpx_lt_i32 vcc, 131, v32
ds_write_b32 v163, v227
v_cmpx_lt_i32 vcc, 144, v32
s_cbranch_execz LE_w
ds_write_b32 v164, v228
v_cmpx_lt_i32 vcc, 145, v32
ds_write_b32 v165, v229
v_cmpx_lt_i32 vcc, 146, v32
ds_write_b32 v166, v230
v_cmpx_lt_i32 vcc, 147, v32
ds_write_b32 v167, v231
v_cmpx_lt_i32 vcc, 160, v32
s_cbranch_execz LE_w
ds_write_b32 v168, v232
v_cmpx_lt_i32 vcc, 161, v32
ds_write_b32 v169, v233
v_cmpx_lt_i32 vcc, 162, v32
ds_write_b32 v170, v234
v_cmpx_lt_i32 vcc, 163, v32
ds_write_b32 v171, v235
v_cmpx_lt_i32 vcc, 176, v32
s_cbranch_execz LE_w
ds_write_b32 v172, v236
v_cmpx_lt_i32 vcc, 177, v32
ds_write_b32 v173, v237
v_cmpx_lt_i32 vcc, 178, v32
ds_write_b32 v174, v238
v_cmpx_lt_i32 vcc, 179, v32
ds_write_b32 v175, v239
v_cmpx_lt_i32 vcc, 192, v32
s_cbranch_execz LE_w
ds_write_b32 v176, v240
v_cmpx_lt_i32 vcc, 193, v32
ds_write_b32 v177, v241
v_cmpx_lt_i32 vcc, 194, v32
ds_write_b32 v178, v242
v_cmpx_lt_i32 vcc, 195, v32
ds_write_b32 v179, v243
v_cmpx_lt_i32 vcc, 208, v32
s_cbranch_execz LE_w
ds_write_b32 v180, v244
v_cmpx_lt_i32 vcc, 209, v32
ds_write_b32 v181, v245
v_cmpx_lt_i32 vcc, 210, v32
ds_write_b32 v182, v246
v_cmpx_lt_i32 vcc, 211, v32
ds_write_b32 v183, v247
v_cmpx_lt_i32 vcc, 224, v32
s_cbranch_execz LE_w
ds_write_b32 v184, v248
v_cmpx_lt_i32 vcc, 225, v32
ds_write_b32 v185, v249
v_cmpx_lt_i32 vcc, 226, v32
ds_write_b32 v186, v250
v_cmpx_lt_i32 vcc, 227, v32
ds_write_b32 v187, v251
v_cmpx_lt_i32 vcc, 240, v32
s_cbranch_execz LE_w
ds_write_b32 v188, v252
v_cmpx_lt_i32 vcc, 241, v32
ds_write_b32 v189, v253
v_cmpx_lt_i32 vcc, 242, v32
ds_write_b32 v190, v254
v_cmpx_lt_i32 vcc, 243, v32
ds_write_b32 v191, v255
LE_w:
s_mov_b64 exec, -1
s_add_u32 s8, s4, 0x7c2a000
s_addc_u32 s9, s5, 0
s_mov_b32 s10, 0x8000
s_mov_b32 s11, 0x00020000
v_and_b32 v200, 63, v0
v_lshlrev_b32 v200, 7, v200
s_mov_b32 s91, 8192
s_mov_b32 s90, 16384
s_mov_b32 s95, 24576
s_mov_b32 s94, 0x10000
LE_poll:
buffer_load_dwordx2 v[192:193], v200, s[8:11], 0 offen sc1
buffer_load_dwordx2 v[194:195], v200, s[8:11], s91 offen sc1
buffer_load_dwordx2 v[196:197], v200, s[8:11], s90 offen sc1
buffer_load_dwordx2 v[198:199], v200, s[8:11], s95 offen sc1
s_sub_u32 s94, s94, 1
s_waitcnt vmcnt(0)
s_cbranch_scc1 LE_poll_go
v_cmp_ne_u64 vcc, s[98:99], v[192:193]
s_nop 1
s_cbranch_vccnz LE_poll
v_cmp_ne_u64 vcc, s[98:99], v[194:195]
s_nop 1
s_cbranch_vccnz LE_poll
v_cmp_ne_u64 vcc, s[98:99], v[196:197]
s_nop 1
s_cbranch_vccnz LE_poll
v_cmp_ne_u64 vcc, s[98:99], v[198:199]
s_nop 1
s_cbranch_vccnz LE_poll
LE_poll_go:
s_cmp_lg_u32 s40, 0
s_cbranch_scc1 LE_nobump
s_mov_b32 s90, 89984
s_mov_b32 s10, 90112
v_mov_b32 v192, s98
v_mov_b32 v193, s99
s_mov_b64 exec, 1
buffer_store_dwordx2 v[192:193], off, s[8:11], s90 sc1
s_mov_b64 exec, -1
LE_nobump:
v_mov_b32 v34, v38
ds_read2_b32 v[52:53], v34 offset0:0 offset1:4
ds_read2_b32 v[54:55], v34 offset0:8 offset1:12
s_waitcnt lgkmcnt(0)
ds_read2_b32 v[56:57], v34 offset0:16 offset1:20
ds_read2_b32 v[58:59], v34 offset0:24 offset1:28
v_mad_u32_u16 v60, v52, s49, v2
v_mad_u32_u16 v61, v53, s49, v2
v_mad_u32_u16 v62, v54, s49, v2
v_mad_u32_u16 v63, v55, s49, v2
buffer_load_dwordx4 a[0:3], v60, s[16:19], 0 offen sc1
buffer_load_dwordx4 a[4:7], v60, s[16:19], 0 offen offset:256 sc1
buffer_load_dwordx4 a[8:11], v61, s[16:19], 0 offen sc1
buffer_load_dwordx4 a[12:15], v61, s[16:19], 0 offen offset:256 sc1
buffer_load_dwordx4 a[16:19], v62, s[16:19], 0 offen sc1
buffer_load_dwordx4 a[20:23], v62, s[16:19], 0 offen offset:256 sc1
buffer_load_dwordx4 a[24:27], v63, s[16:19], 0 offen sc1
buffer_load_dwordx4 a[28:31], v63, s[16:19], 0 offen offset:256 sc1
s_waitcnt lgkmcnt(0)
ds_read2_b32 v[52:53], v34 offset0:32 offset1:36
ds_read2_b32 v[54:55], v34 offset0:40 offset1:44
v_mad_u32_u16 v60, v56, s49, v2
v_mad_u32_u16 v61, v57, s49, v2
v_mad_u32_u16 v62, v58, s49, v2
v_mad_u32_u16 v63, v59, s49, v2
buffer_load_dwordx4 a[32:35], v60, s[16:19], 0 offen sc1
buffer_load_dwordx4 a[36:39], v60, s[16:19], 0 offen offset:256 sc1
buffer_load_dwordx4 a[40:43], v61, s[16:19], 0 offen sc1
buffer_load_dwordx4 a[44:47], v61, s[16:19], 0 offen offset:256 sc1
buffer_load_dwordx4 a[48:51], v62, s[16:19], 0 offen sc1
buffer_load_dwordx4 a[52:55], v62, s[16:19], 0 offen offset:256 sc1
buffer_load_dwordx4 a[56:59], v63, s[16:19], 0 offen sc1
buffer_load_dwordx4 a[60:63], v63, s[16:19], 0 offen offset:256 sc1
s_waitcnt lgkmcnt(0)
ds_read2_b32 v[56:57], v34 offset0:48 offset1:52
ds_read2_b32 v[58:59], v34 offset0:56 offset1:60
v_mad_u32_u16 v60, v52, s49, v2
v_mad_u32_u16 v61, v53, s49, v2
v_mad_u32_u16 v62, v54, s49, v2
v_mad_u32_u16 v63, v55, s49, v2
buffer_load_dwordx4 a[64:67], v60, s[16:19], 0 offen sc1
buffer_load_dwordx4 a[68:71], v60, s[16:19], 0 offen offset:256 sc1
buffer_load_dwordx4 a[72:75], v61, s[16:19], 0 offen sc1
buffer_load_dwordx4 a[76:79], v61, s[16:19], 0 offen offset:256 sc1
buffer_load_dwordx4 a[80:83], v62, s[16:19], 0 offen sc1
buffer_load_dwordx4 a[84:87], v62, s[16:19], 0 offen offset:256 sc1
buffer_load_dwordx4 a[88:91], v63, s[16:19], 0 offen sc1
buffer_load_dwordx4 a[92:95], v63, s[16:19], 0 offen offset:256 sc1
s_waitcnt lgkmcnt(0)
ds_read2_b32 v[52:53], v34 offset0:64 offset1:68
ds_read2_b32 v[54:55], v34 offset0:72 offset1:76
v_mad_u32_u16 v60, v56, s49, v2
v_mad_u32_u16 v61, v57, s49, v2
v_mad_u32_u16 v62, v58, s49, v2
v_mad_u32_u16 v63, v59, s49, v2
buffer_load_dwordx4 a[96:99], v60, s[16:19], 0 offen sc1
buffer_load_dwordx4 a[100:103], v60, s[16:19], 0 offen offset:256 sc1
buffer_load_dwordx4 a[104:107], v61, s[16:19], 0 offen sc1
buffer_load_dwordx4 a[108:111], v61, s[16:19], 0 offen offset:256 sc1
buffer_load_dwordx4 a[112:115], v62, s[16:19], 0 offen sc1
buffer_load_dwordx4 a[116:119], v62, s[16:19], 0 offen offset:256 sc1
buffer_load_dwordx4 a[120:123], v63, s[16:19], 0 offen sc1
buffer_load_dwordx4 a[124:127], v63, s[16:19], 0 offen offset:256 sc1
s_waitcnt lgkmcnt(0)
ds_read2_b32 v[56:57], v34 offset0:80 offset1:84
ds_read2_b32 v[58:59], v34 offset0:88 offset1:92
v_mad_u32_u16 v60, v52, s49, v2
v_mad_u32_u16 v61, v53, s49, v2
v_mad_u32_u16 v62, v54, s49, v2
v_mad_u32_u16 v63, v55, s49, v2
buffer_load_dwordx4 a[128:131], v60, s[16:19], 0 offen sc1
buffer_load_dwordx4 a[132:135], v60, s[16:19], 0 offen offset:256 sc1
buffer_load_dwordx4 a[136:139], v61, s[16:19], 0 offen sc1
buffer_load_dwordx4 a[140:143], v61, s[16:19], 0 offen offset:256 sc1
buffer_load_dwordx4 a[144:147], v62, s[16:19], 0 offen sc1
buffer_load_dwordx4 a[148:151], v62, s[16:19], 0 offen offset:256 sc1
buffer_load_dwordx4 a[152:155], v63, s[16:19], 0 offen sc1
buffer_load_dwordx4 a[156:159], v63, s[16:19], 0 offen offset:256 sc1
s_waitcnt lgkmcnt(0)
ds_read2_b32 v[52:53], v34 offset0:96 offset1:100
ds_read2_b32 v[54:55], v34 offset0:104 offset1:108
v_mad_u32_u16 v60, v56, s49, v2
v_mad_u32_u16 v61, v57, s49, v2
v_mad_u32_u16 v62, v58, s49, v2
v_mad_u32_u16 v63, v59, s49, v2
buffer_load_dwordx4 a[160:163], v60, s[16:19], 0 offen sc1
buffer_load_dwordx4 a[164:167], v60, s[16:19], 0 offen offset:256 sc1
buffer_load_dwordx4 a[168:171], v61, s[16:19], 0 offen sc1
buffer_load_dwordx4 a[172:175], v61, s[16:19], 0 offen offset:256 sc1
buffer_load_dwordx4 a[176:179], v62, s[16:19], 0 offen sc1
buffer_load_dwordx4 a[180:183], v62, s[16:19], 0 offen offset:256 sc1
buffer_load_dwordx4 a[184:187], v63, s[16:19], 0 offen sc1
buffer_load_dwordx4 a[188:191], v63, s[16:19], 0 offen offset:256 sc1
s_waitcnt lgkmcnt(0)
ds_read2_b32 v[56:57], v34 offset0:112 offset1:116
ds_read2_b32 v[58:59], v34 offset0:120 offset1:124
v_mad_u32_u16 v60, v52, s49, v2
v_mad_u32_u16 v61, v53, s49, v2
v_mad_u32_u16 v62, v54, s49, v2
v_mad_u32_u16 v63, v55, s49, v2
buffer_load_dwordx4 a[192:195], v60, s[16:19], 0 offen sc1
buffer_load_dwordx4 a[196:199], v60, s[16:19], 0 offen offset:256 sc1
buffer_load_dwordx4 a[200:203], v61, s[16:19], 0 offen sc1
buffer_load_dwordx4 a[204:207], v61, s[16:19], 0 offen offset:256 sc1
buffer_load_dwordx4 a[208:211], v62, s[16:19], 0 offen sc1
buffer_load_dwordx4 a[212:215], v62, s[16:19], 0 offen offset:256 sc1
buffer_load_dwordx4 a[216:219], v63, s[16:19], 0 offen sc1
buffer_load_dwordx4 a[220:223], v63, s[16:19], 0 offen offset:256 sc1
s_waitcnt lgkmcnt(0)
ds_read2_b32 v[52:53], v34 offset0:128 offset1:132
ds_read2_b32 v[54:55], v34 offset0:136 offset1:140
v_mad_u32_u16 v60, v56, s49, v2
v_mad_u32_u16 v61, v57, s49, v2
v_mad_u32_u16 v62, v58, s49, v2
v_mad_u32_u16 v63, v59, s49, v2
buffer_load_dwordx4 a[224:227], v60, s[16:19], 0 offen sc1
buffer_load_dwordx4 a[228:231], v60, s[16:19], 0 offen offset:256 sc1
buffer_load_dwordx4 a[232:235], v61, s[16:19], 0 offen sc1
buffer_load_dwordx4 a[236:239], v61, s[16:19], 0 offen offset:256 sc1
buffer_load_dwordx4 a[240:243], v62, s[16:19], 0 offen sc1
buffer_load_dwordx4 a[244:247], v62, s[16:19], 0 offen offset:256 sc1
buffer_load_dwordx4 a[248:251], v63, s[16:19], 0 offen sc1
buffer_load_dwordx4 a[252:255], v63, s[16:19], 0 offen offset:256 sc1
v_add_u32 v34, 512, v34
s_mov_b32 s45, 0
s_lshl_b32 s47, s55, 9
LE_loop:
v_readlane_b32 s46, v37, s45
s_add_u32 s45, s45, 1
s_waitcnt vmcnt(56)
v_mfma_f32_16x16x32_bf16 v[48:51], a[0:3], v[40:43], v[48:51]
v_mfma_f32_16x16x32_bf16 v[48:51], a[4:7], v[44:47], v[48:51]
s_bitcmp1_b32 s46, 0
s_cbranch_scc0 LE_nf0
s_cmp_eq_u32 s42, 0
s_cbranch_scc1 LE_fl0
buffer_load_dwordx2 v[66:67], v39, s[20:23], s47 offen sc1
s_waitcnt vmcnt(0)
v_lshlrev_b32 v64, 16, v66
v_and_b32 v65, 0xffff0000, v66
v_add_f32 v48, v48, v64
v_add_f32 v49, v49, v65
v_lshlrev_b32 v64, 16, v67
v_and_b32 v65, 0xffff0000, v67
v_add_f32 v50, v50, v64
v_add_f32 v51, v51, v65
LE_fl0:
s_nop 3
v_cvt_pk_bf16_f32 v64, v48, v49
v_cvt_pk_bf16_f32 v65, v50, v51
v_mov_b32 v48, 0
v_mov_b32 v49, 0
v_mov_b32 v50, 0
v_mov_b32 v51, 0
buffer_store_dwordx2 v[64:65], v39, s[20:23], s47 offen sc1
s_add_u32 s47, s47, 512
LE_nf0:
v_mfma_f32_16x16x32_bf16 v[48:51], a[8:11], v[40:43], v[48:51]
v_mfma_f32_16x16x32_bf16 v[48:51], a[12:15], v[44:47], v[48:51]
s_bitcmp1_b32 s46, 1
s_cbranch_scc0 LE_nf1
s_cmp_eq_u32 s42, 0
s_cbranch_scc1 LE_fl1
buffer_load_dwordx2 v[66:67], v39, s[20:23], s47 offen sc1
s_waitcnt vmcnt(0)
v_lshlrev_b32 v64, 16, v66
v_and_b32 v65, 0xffff0000, v66
v_add_f32 v48, v48, v64
v_add_f32 v49, v49, v65
v_lshlrev_b32 v64, 16, v67
v_and_b32 v65, 0xffff0000, v67
v_add_f32 v50, v50, v64
v_add_f32 v51, v51, v65
LE_fl1:
s_nop 3
v_cvt_pk_bf16_f32 v64, v48, v49
v_cvt_pk_bf16_f32 v65, v50, v51
v_mov_b32 v48, 0
v_mov_b32 v49, 0
v_mov_b32 v50, 0
v_mov_b32 v51, 0
buffer_store_dwordx2 v[64:65], v39, s[20:23], s47 offen sc1
s_add_u32 s47, s47, 512
LE_nf1:
v_mfma_f32_16x16x32_bf16 v[48:51], a[16:19], v[40:43], v[48:51]
v_mfma_f32_16x16x32_bf16 v[48:51], a[20:23], v[44:47], v[48:51]
s_bitcmp1_b32 s46, 2
s_cbranch_scc0 LE_nf2
s_cmp_eq_u32 s42, 0
s_cbranch_scc1 LE_fl2
buffer_load_dwordx2 v[66:67], v39, s[20:23], s47 offen sc1
s_waitcnt vmcnt(0)
v_lshlrev_b32 v64, 16, v66
v_and_b32 v65, 0xffff0000, v66
v_add_f32 v48, v48, v64
v_add_f32 v49, v49, v65
v_lshlrev_b32 v64, 16, v67
v_and_b32 v65, 0xffff0000, v67
v_add_f32 v50, v50, v64
v_add_f32 v51, v51, v65
LE_fl2:
s_nop 3
v_cvt_pk_bf16_f32 v64, v48, v49
v_cvt_pk_bf16_f32 v65, v50, v51
v_mov_b32 v48, 0
v_mov_b32 v49, 0
v_mov_b32 v50, 0
v_mov_b32 v51, 0
buffer_store_dwordx2 v[64:65], v39, s[20:23], s47 offen sc1
s_add_u32 s47, s47, 512
LE_nf2:
v_mfma_f32_16x16x32_bf16 v[48:51], a[24:27], v[40:43], v[48:51]
v_mfma_f32_16x16x32_bf16 v[48:51], a[28:31], v[44:47], v[48:51]
s_bitcmp1_b32 s46, 3
s_cbranch_scc0 LE_nf3
s_cmp_eq_u32 s42, 0
s_cbranch_scc1 LE_fl3
buffer_load_dwordx2 v[66:67], v39, s[20:23], s47 offen sc1
s_waitcnt vmcnt(0)
v_lshlrev_b32 v64, 16, v66
v_and_b32 v65, 0xffff0000, v66
v_add_f32 v48, v48, v64
v_add_f32 v49, v49, v65
v_lshlrev_b32 v64, 16, v67
v_and_b32 v65, 0xffff0000, v67
v_add_f32 v50, v50, v64
v_add_f32 v51, v51, v65
LE_fl3:
s_nop 3
v_cvt_pk_bf16_f32 v64, v48, v49
v_cvt_pk_bf16_f32 v65, v50, v51
v_mov_b32 v48, 0
v_mov_b32 v49, 0
v_mov_b32 v50, 0
v_mov_b32 v51, 0
buffer_store_dwordx2 v[64:65], v39, s[20:23], s47 offen sc1
s_add_u32 s47, s47, 512
LE_nf3:
s_waitcnt lgkmcnt(0)
ds_read2_b32 v[56:57], v34 offset0:16 offset1:20
ds_read2_b32 v[58:59], v34 offset0:24 offset1:28
v_mad_u32_u16 v60, v52, s49, v2
v_mad_u32_u16 v61, v53, s49, v2
v_mad_u32_u16 v62, v54, s49, v2
v_mad_u32_u16 v63, v55, s49, v2
buffer_load_dwordx4 a[0:3], v60, s[16:19], 0 offen sc1
buffer_load_dwordx4 a[4:7], v60, s[16:19], 0 offen offset:256 sc1
buffer_load_dwordx4 a[8:11], v61, s[16:19], 0 offen sc1
buffer_load_dwordx4 a[12:15], v61, s[16:19], 0 offen offset:256 sc1
buffer_load_dwordx4 a[16:19], v62, s[16:19], 0 offen sc1
buffer_load_dwordx4 a[20:23], v62, s[16:19], 0 offen offset:256 sc1
buffer_load_dwordx4 a[24:27], v63, s[16:19], 0 offen sc1
buffer_load_dwordx4 a[28:31], v63, s[16:19], 0 offen offset:256 sc1
s_waitcnt vmcnt(56)
v_mfma_f32_16x16x32_bf16 v[48:51], a[32:35], v[40:43], v[48:51]
v_mfma_f32_16x16x32_bf16 v[48:51], a[36:39], v[44:47], v[48:51]
s_bitcmp1_b32 s46, 4
s_cbranch_scc0 LE_nf4
s_cmp_eq_u32 s42, 0
s_cbranch_scc1 LE_fl4
buffer_load_dwordx2 v[66:67], v39, s[20:23], s47 offen sc1
s_waitcnt vmcnt(0)
v_lshlrev_b32 v64, 16, v66
v_and_b32 v65, 0xffff0000, v66
v_add_f32 v48, v48, v64
v_add_f32 v49, v49, v65
v_lshlrev_b32 v64, 16, v67
v_and_b32 v65, 0xffff0000, v67
v_add_f32 v50, v50, v64
v_add_f32 v51, v51, v65
LE_fl4:
s_nop 3
v_cvt_pk_bf16_f32 v64, v48, v49
v_cvt_pk_bf16_f32 v65, v50, v51
v_mov_b32 v48, 0
v_mov_b32 v49, 0
v_mov_b32 v50, 0
v_mov_b32 v51, 0
buffer_store_dwordx2 v[64:65], v39, s[20:23], s47 offen sc1
s_add_u32 s47, s47, 512
LE_nf4:
v_mfma_f32_16x16x32_bf16 v[48:51], a[40:43], v[40:43], v[48:51]
v_mfma_f32_16x16x32_bf16 v[48:51], a[44:47], v[44:47], v[48:51]
s_bitcmp1_b32 s46, 5
s_cbranch_scc0 LE_nf5
s_cmp_eq_u32 s42, 0
s_cbranch_scc1 LE_fl5
buffer_load_dwordx2 v[66:67], v39, s[20:23], s47 offen sc1
s_waitcnt vmcnt(0)
v_lshlrev_b32 v64, 16, v66
v_and_b32 v65, 0xffff0000, v66
v_add_f32 v48, v48, v64
v_add_f32 v49, v49, v65
v_lshlrev_b32 v64, 16, v67
v_and_b32 v65, 0xffff0000, v67
v_add_f32 v50, v50, v64
v_add_f32 v51, v51, v65
LE_fl5:
s_nop 3
v_cvt_pk_bf16_f32 v64, v48, v49
v_cvt_pk_bf16_f32 v65, v50, v51
v_mov_b32 v48, 0
v_mov_b32 v49, 0
v_mov_b32 v50, 0
v_mov_b32 v51, 0
buffer_store_dwordx2 v[64:65], v39, s[20:23], s47 offen sc1
s_add_u32 s47, s47, 512
LE_nf5:
v_mfma_f32_16x16x32_bf16 v[48:51], a[48:51], v[40:43], v[48:51]
v_mfma_f32_16x16x32_bf16 v[48:51], a[52:55], v[44:47], v[48:51]
s_bitcmp1_b32 s46, 6
s_cbranch_scc0 LE_nf6
s_cmp_eq_u32 s42, 0
s_cbranch_scc1 LE_fl6
buffer_load_dwordx2 v[66:67], v39, s[20:23], s47 offen sc1
s_waitcnt vmcnt(0)
v_lshlrev_b32 v64, 16, v66
v_and_b32 v65, 0xffff0000, v66
v_add_f32 v48, v48, v64
v_add_f32 v49, v49, v65
v_lshlrev_b32 v64, 16, v67
v_and_b32 v65, 0xffff0000, v67
v_add_f32 v50, v50, v64
v_add_f32 v51, v51, v65
LE_fl6:
s_nop 3
v_cvt_pk_bf16_f32 v64, v48, v49
v_cvt_pk_bf16_f32 v65, v50, v51
v_mov_b32 v48, 0
v_mov_b32 v49, 0
v_mov_b32 v50, 0
v_mov_b32 v51, 0
buffer_store_dwordx2 v[64:65], v39, s[20:23], s47 offen sc1
s_add_u32 s47, s47, 512
LE_nf6:
v_mfma_f32_16x16x32_bf16 v[48:51], a[56:59], v[40:43], v[48:51]
v_mfma_f32_16x16x32_bf16 v[48:51], a[60:63], v[44:47], v[48:51]
s_bitcmp1_b32 s46, 7
s_cbranch_scc0 LE_nf7
s_cmp_eq_u32 s42, 0
s_cbranch_scc1 LE_fl7
buffer_load_dwordx2 v[66:67], v39, s[20:23], s47 offen sc1
s_waitcnt vmcnt(0)
v_lshlrev_b32 v64, 16, v66
v_and_b32 v65, 0xffff0000, v66
v_add_f32 v48, v48, v64
v_add_f32 v49, v49, v65
v_lshlrev_b32 v64, 16, v67
v_and_b32 v65, 0xffff0000, v67
v_add_f32 v50, v50, v64
v_add_f32 v51, v51, v65
LE_fl7:
s_nop 3
v_cvt_pk_bf16_f32 v64, v48, v49
v_cvt_pk_bf16_f32 v65, v50, v51
v_mov_b32 v48, 0
v_mov_b32 v49, 0
v_mov_b32 v50, 0
v_mov_b32 v51, 0
buffer_store_dwordx2 v[64:65], v39, s[20:23], s47 offen sc1
s_add_u32 s47, s47, 512
LE_nf7:
s_waitcnt lgkmcnt(0)
ds_read2_b32 v[52:53], v34 offset0:32 offset1:36
ds_read2_b32 v[54:55], v34 offset0:40 offset1:44
v_mad_u32_u16 v60, v56, s49, v2
v_mad_u32_u16 v61, v57, s49, v2
v_mad_u32_u16 v62, v58, s49, v2
v_mad_u32_u16 v63, v59, s49, v2
buffer_load_dwordx4 a[32:35], v60, s[16:19], 0 offen sc1
buffer_load_dwordx4 a[36:39], v60, s[16:19], 0 offen offset:256 sc1
buffer_load_dwordx4 a[40:43], v61, s[16:19], 0 offen sc1
buffer_load_dwordx4 a[44:47], v61, s[16:19], 0 offen offset:256 sc1
buffer_load_dwordx4 a[48:51], v62, s[16:19], 0 offen sc1
buffer_load_dwordx4 a[52:55], v62, s[16:19], 0 offen offset:256 sc1
buffer_load_dwordx4 a[56:59], v63, s[16:19], 0 offen sc1
buffer_load_dwordx4 a[60:63], v63, s[16:19], 0 offen offset:256 sc1
s_waitcnt vmcnt(56)
v_mfma_f32_16x16x32_bf16 v[48:51], a[64:67], v[40:43], v[48:51]
v_mfma_f32_16x16x32_bf16 v[48:51], a[68:71], v[44:47], v[48:51]
s_bitcmp1_b32 s46, 8
s_cbranch_scc0 LE_nf8
s_cmp_eq_u32 s42, 0
s_cbranch_scc1 LE_fl8
buffer_load_dwordx2 v[66:67], v39, s[20:23], s47 offen sc1
s_waitcnt vmcnt(0)
v_lshlrev_b32 v64, 16, v66
v_and_b32 v65, 0xffff0000, v66
v_add_f32 v48, v48, v64
v_add_f32 v49, v49, v65
v_lshlrev_b32 v64, 16, v67
v_and_b32 v65, 0xffff0000, v67
v_add_f32 v50, v50, v64
v_add_f32 v51, v51, v65
LE_fl8:
s_nop 3
v_cvt_pk_bf16_f32 v64, v48, v49
v_cvt_pk_bf16_f32 v65, v50, v51
v_mov_b32 v48, 0
v_mov_b32 v49, 0
v_mov_b32 v50, 0
v_mov_b32 v51, 0
buffer_store_dwordx2 v[64:65], v39, s[20:23], s47 offen sc1
s_add_u32 s47, s47, 512
LE_nf8:
v_mfma_f32_16x16x32_bf16 v[48:51], a[72:75], v[40:43], v[48:51]
v_mfma_f32_16x16x32_bf16 v[48:51], a[76:79], v[44:47], v[48:51]
s_bitcmp1_b32 s46, 9
s_cbranch_scc0 LE_nf9
s_cmp_eq_u32 s42, 0
s_cbranch_scc1 LE_fl9
buffer_load_dwordx2 v[66:67], v39, s[20:23], s47 offen sc1
s_waitcnt vmcnt(0)
v_lshlrev_b32 v64, 16, v66
v_and_b32 v65, 0xffff0000, v66
v_add_f32 v48, v48, v64
v_add_f32 v49, v49, v65
v_lshlrev_b32 v64, 16, v67
v_and_b32 v65, 0xffff0000, v67
v_add_f32 v50, v50, v64
v_add_f32 v51, v51, v65
LE_fl9:
s_nop 3
v_cvt_pk_bf16_f32 v64, v48, v49
v_cvt_pk_bf16_f32 v65, v50, v51
v_mov_b32 v48, 0
v_mov_b32 v49, 0
v_mov_b32 v50, 0
v_mov_b32 v51, 0
buffer_store_dwordx2 v[64:65], v39, s[20:23], s47 offen sc1
s_add_u32 s47, s47, 512
LE_nf9:
v_mfma_f32_16x16x32_bf16 v[48:51], a[80:83], v[40:43], v[48:51]
v_mfma_f32_16x16x32_bf16 v[48:51], a[84:87], v[44:47], v[48:51]
s_bitcmp1_b32 s46, 10
s_cbranch_scc0 LE_nf10
s_cmp_eq_u32 s42, 0
s_cbranch_scc1 LE_fl10
buffer_load_dwordx2 v[66:67], v39, s[20:23], s47 offen sc1
s_waitcnt vmcnt(0)
v_lshlrev_b32 v64, 16, v66
v_and_b32 v65, 0xffff0000, v66
v_add_f32 v48, v48, v64
v_add_f32 v49, v49, v65
v_lshlrev_b32 v64, 16, v67
v_and_b32 v65, 0xffff0000, v67
v_add_f32 v50, v50, v64
v_add_f32 v51, v51, v65
LE_fl10:
s_nop 3
v_cvt_pk_bf16_f32 v64, v48, v49
v_cvt_pk_bf16_f32 v65, v50, v51
v_mov_b32 v48, 0
v_mov_b32 v49, 0
v_mov_b32 v50, 0
v_mov_b32 v51, 0
buffer_store_dwordx2 v[64:65], v39, s[20:23], s47 offen sc1
s_add_u32 s47, s47, 512
LE_nf10:
v_mfma_f32_16x16x32_bf16 v[48:51], a[88:91], v[40:43], v[48:51]
v_mfma_f32_16x16x32_bf16 v[48:51], a[92:95], v[44:47], v[48:51]
s_bitcmp1_b32 s46, 11
s_cbranch_scc0 LE_nf11
s_cmp_eq_u32 s42, 0
s_cbranch_scc1 LE_fl11
buffer_load_dwordx2 v[66:67], v39, s[20:23], s47 offen sc1
s_waitcnt vmcnt(0)
v_lshlrev_b32 v64, 16, v66
v_and_b32 v65, 0xffff0000, v66
v_add_f32 v48, v48, v64
v_add_f32 v49, v49, v65
v_lshlrev_b32 v64, 16, v67
v_and_b32 v65, 0xffff0000, v67
v_add_f32 v50, v50, v64
v_add_f32 v51, v51, v65
LE_fl11:
s_nop 3
v_cvt_pk_bf16_f32 v64, v48, v49
v_cvt_pk_bf16_f32 v65, v50, v51
v_mov_b32 v48, 0
v_mov_b32 v49, 0
v_mov_b32 v50, 0
v_mov_b32 v51, 0
buffer_store_dwordx2 v[64:65], v39, s[20:23], s47 offen sc1
s_add_u32 s47, s47, 512
LE_nf11:
s_waitcnt lgkmcnt(0)
ds_read2_b32 v[56:57], v34 offset0:48 offset1:52
ds_read2_b32 v[58:59], v34 offset0:56 offset1:60
v_mad_u32_u16 v60, v52, s49, v2
v_mad_u32_u16 v61, v53, s49, v2
v_mad_u32_u16 v62, v54, s49, v2
v_mad_u32_u16 v63, v55, s49, v2
buffer_load_dwordx4 a[64:67], v60, s[16:19], 0 offen sc1
buffer_load_dwordx4 a[68:71], v60, s[16:19], 0 offen offset:256 sc1
buffer_load_dwordx4 a[72:75], v61, s[16:19], 0 offen sc1
buffer_load_dwordx4 a[76:79], v61, s[16:19], 0 offen offset:256 sc1
buffer_load_dwordx4 a[80:83], v62, s[16:19], 0 offen sc1
buffer_load_dwordx4 a[84:87], v62, s[16:19], 0 offen offset:256 sc1
buffer_load_dwordx4 a[88:91], v63, s[16:19], 0 offen sc1
buffer_load_dwordx4 a[92:95], v63, s[16:19], 0 offen offset:256 sc1
s_waitcnt vmcnt(56)
v_mfma_f32_16x16x32_bf16 v[48:51], a[96:99], v[40:43], v[48:51]
v_mfma_f32_16x16x32_bf16 v[48:51], a[100:103], v[44:47], v[48:51]
s_bitcmp1_b32 s46, 12
s_cbranch_scc0 LE_nf12
s_cmp_eq_u32 s42, 0
s_cbranch_scc1 LE_fl12
buffer_load_dwordx2 v[66:67], v39, s[20:23], s47 offen sc1
s_waitcnt vmcnt(0)
v_lshlrev_b32 v64, 16, v66
v_and_b32 v65, 0xffff0000, v66
v_add_f32 v48, v48, v64
v_add_f32 v49, v49, v65
v_lshlrev_b32 v64, 16, v67
v_and_b32 v65, 0xffff0000, v67
v_add_f32 v50, v50, v64
v_add_f32 v51, v51, v65
LE_fl12:
s_nop 3
v_cvt_pk_bf16_f32 v64, v48, v49
v_cvt_pk_bf16_f32 v65, v50, v51
v_mov_b32 v48, 0
v_mov_b32 v49, 0
v_mov_b32 v50, 0
v_mov_b32 v51, 0
buffer_store_dwordx2 v[64:65], v39, s[20:23], s47 offen sc1
s_add_u32 s47, s47, 512
LE_nf12:
v_mfma_f32_16x16x32_bf16 v[48:51], a[104:107], v[40:43], v[48:51]
v_mfma_f32_16x16x32_bf16 v[48:51], a[108:111], v[44:47], v[48:51]
s_bitcmp1_b32 s46, 13
s_cbranch_scc0 LE_nf13
s_cmp_eq_u32 s42, 0
s_cbranch_scc1 LE_fl13
buffer_load_dwordx2 v[66:67], v39, s[20:23], s47 offen sc1
s_waitcnt vmcnt(0)
v_lshlrev_b32 v64, 16, v66
v_and_b32 v65, 0xffff0000, v66
v_add_f32 v48, v48, v64
v_add_f32 v49, v49, v65
v_lshlrev_b32 v64, 16, v67
v_and_b32 v65, 0xffff0000, v67
v_add_f32 v50, v50, v64
v_add_f32 v51, v51, v65
LE_fl13:
s_nop 3
v_cvt_pk_bf16_f32 v64, v48, v49
v_cvt_pk_bf16_f32 v65, v50, v51
v_mov_b32 v48, 0
v_mov_b32 v49, 0
v_mov_b32 v50, 0
v_mov_b32 v51, 0
buffer_store_dwordx2 v[64:65], v39, s[20:23], s47 offen sc1
s_add_u32 s47, s47, 512
LE_nf13:
v_mfma_f32_16x16x32_bf16 v[48:51], a[112:115], v[40:43], v[48:51]
v_mfma_f32_16x16x32_bf16 v[48:51], a[116:119], v[44:47], v[48:51]
s_bitcmp1_b32 s46, 14
s_cbranch_scc0 LE_nf14
s_cmp_eq_u32 s42, 0
s_cbranch_scc1 LE_fl14
buffer_load_dwordx2 v[66:67], v39, s[20:23], s47 offen sc1
s_waitcnt vmcnt(0)
v_lshlrev_b32 v64, 16, v66
v_and_b32 v65, 0xffff0000, v66
v_add_f32 v48, v48, v64
v_add_f32 v49, v49, v65
v_lshlrev_b32 v64, 16, v67
v_and_b32 v65, 0xffff0000, v67
v_add_f32 v50, v50, v64
v_add_f32 v51, v51, v65
LE_fl14:
s_nop 3
v_cvt_pk_bf16_f32 v64, v48, v49
v_cvt_pk_bf16_f32 v65, v50, v51
v_mov_b32 v48, 0
v_mov_b32 v49, 0
v_mov_b32 v50, 0
v_mov_b32 v51, 0
buffer_store_dwordx2 v[64:65], v39, s[20:23], s47 offen sc1
s_add_u32 s47, s47, 512
LE_nf14:
v_mfma_f32_16x16x32_bf16 v[48:51], a[120:123], v[40:43], v[48:51]
v_mfma_f32_16x16x32_bf16 v[48:51], a[124:127], v[44:47], v[48:51]
s_bitcmp1_b32 s46, 15
s_cbranch_scc0 LE_nf15
s_cmp_eq_u32 s42, 0
s_cbranch_scc1 LE_fl15
buffer_load_dwordx2 v[66:67], v39, s[20:23], s47 offen sc1
s_waitcnt vmcnt(0)
v_lshlrev_b32 v64, 16, v66
v_and_b32 v65, 0xffff0000, v66
v_add_f32 v48, v48, v64
v_add_f32 v49, v49, v65
v_lshlrev_b32 v64, 16, v67
v_and_b32 v65, 0xffff0000, v67
v_add_f32 v50, v50, v64
v_add_f32 v51, v51, v65
LE_fl15:
s_nop 3
v_cvt_pk_bf16_f32 v64, v48, v49
v_cvt_pk_bf16_f32 v65, v50, v51
v_mov_b32 v48, 0
v_mov_b32 v49, 0
v_mov_b32 v50, 0
v_mov_b32 v51, 0
buffer_store_dwordx2 v[64:65], v39, s[20:23], s47 offen sc1
s_add_u32 s47, s47, 512
LE_nf15:
s_waitcnt lgkmcnt(0)
ds_read2_b32 v[52:53], v34 offset0:64 offset1:68
ds_read2_b32 v[54:55], v34 offset0:72 offset1:76
v_mad_u32_u16 v60, v56, s49, v2
v_mad_u32_u16 v61, v57, s49, v2
v_mad_u32_u16 v62, v58, s49, v2
v_mad_u32_u16 v63, v59, s49, v2
buffer_load_dwordx4 a[96:99], v60, s[16:19], 0 offen sc1
buffer_load_dwordx4 a[100:103], v60, s[16:19], 0 offen offset:256 sc1
buffer_load_dwordx4 a[104:107], v61, s[16:19], 0 offen sc1
buffer_load_dwordx4 a[108:111], v61, s[16:19], 0 offen offset:256 sc1
buffer_load_dwordx4 a[112:115], v62, s[16:19], 0 offen sc1
buffer_load_dwordx4 a[116:119], v62, s[16:19], 0 offen offset:256 sc1
buffer_load_dwordx4 a[120:123], v63, s[16:19], 0 offen sc1
buffer_load_dwordx4 a[124:127], v63, s[16:19], 0 offen offset:256 sc1
s_waitcnt vmcnt(56)
v_mfma_f32_16x16x32_bf16 v[48:51], a[128:131], v[40:43], v[48:51]
v_mfma_f32_16x16x32_bf16 v[48:51], a[132:135], v[44:47], v[48:51]
s_bitcmp1_b32 s46, 16
s_cbranch_scc0 LE_nf16
s_cmp_eq_u32 s42, 0
s_cbranch_scc1 LE_fl16
buffer_load_dwordx2 v[66:67], v39, s[20:23], s47 offen sc1
s_waitcnt vmcnt(0)
v_lshlrev_b32 v64, 16, v66
v_and_b32 v65, 0xffff0000, v66
v_add_f32 v48, v48, v64
v_add_f32 v49, v49, v65
v_lshlrev_b32 v64, 16, v67
v_and_b32 v65, 0xffff0000, v67
v_add_f32 v50, v50, v64
v_add_f32 v51, v51, v65
LE_fl16:
s_nop 3
v_cvt_pk_bf16_f32 v64, v48, v49
v_cvt_pk_bf16_f32 v65, v50, v51
v_mov_b32 v48, 0
v_mov_b32 v49, 0
v_mov_b32 v50, 0
v_mov_b32 v51, 0
buffer_store_dwordx2 v[64:65], v39, s[20:23], s47 offen sc1
s_add_u32 s47, s47, 512
LE_nf16:
v_mfma_f32_16x16x32_bf16 v[48:51], a[136:139], v[40:43], v[48:51]
v_mfma_f32_16x16x32_bf16 v[48:51], a[140:143], v[44:47], v[48:51]
s_bitcmp1_b32 s46, 17
s_cbranch_scc0 LE_nf17
s_cmp_eq_u32 s42, 0
s_cbranch_scc1 LE_fl17
buffer_load_dwordx2 v[66:67], v39, s[20:23], s47 offen sc1
s_waitcnt vmcnt(0)
v_lshlrev_b32 v64, 16, v66
v_and_b32 v65, 0xffff0000, v66
v_add_f32 v48, v48, v64
v_add_f32 v49, v49, v65
v_lshlrev_b32 v64, 16, v67
v_and_b32 v65, 0xffff0000, v67
v_add_f32 v50, v50, v64
v_add_f32 v51, v51, v65
LE_fl17:
s_nop 3
v_cvt_pk_bf16_f32 v64, v48, v49
v_cvt_pk_bf16_f32 v65, v50, v51
v_mov_b32 v48, 0
v_mov_b32 v49, 0
v_mov_b32 v50, 0
v_mov_b32 v51, 0
buffer_store_dwordx2 v[64:65], v39, s[20:23], s47 offen sc1
s_add_u32 s47, s47, 512
LE_nf17:
v_mfma_f32_16x16x32_bf16 v[48:51], a[144:147], v[40:43], v[48:51]
v_mfma_f32_16x16x32_bf16 v[48:51], a[148:151], v[44:47], v[48:51]
s_bitcmp1_b32 s46, 18
s_cbranch_scc0 LE_nf18
s_cmp_eq_u32 s42, 0
s_cbranch_scc1 LE_fl18
buffer_load_dwordx2 v[66:67], v39, s[20:23], s47 offen sc1
s_waitcnt vmcnt(0)
v_lshlrev_b32 v64, 16, v66
v_and_b32 v65, 0xffff0000, v66
v_add_f32 v48, v48, v64
v_add_f32 v49, v49, v65
v_lshlrev_b32 v64, 16, v67
v_and_b32 v65, 0xffff0000, v67
v_add_f32 v50, v50, v64
v_add_f32 v51, v51, v65
LE_fl18:
s_nop 3
v_cvt_pk_bf16_f32 v64, v48, v49
v_cvt_pk_bf16_f32 v65, v50, v51
v_mov_b32 v48, 0
v_mov_b32 v49, 0
v_mov_b32 v50, 0
v_mov_b32 v51, 0
buffer_store_dwordx2 v[64:65], v39, s[20:23], s47 offen sc1
s_add_u32 s47, s47, 512
LE_nf18:
v_mfma_f32_16x16x32_bf16 v[48:51], a[152:155], v[40:43], v[48:51]
v_mfma_f32_16x16x32_bf16 v[48:51], a[156:159], v[44:47], v[48:51]
s_bitcmp1_b32 s46, 19
s_cbranch_scc0 LE_nf19
s_cmp_eq_u32 s42, 0
s_cbranch_scc1 LE_fl19
buffer_load_dwordx2 v[66:67], v39, s[20:23], s47 offen sc1
s_waitcnt vmcnt(0)
v_lshlrev_b32 v64, 16, v66
v_and_b32 v65, 0xffff0000, v66
v_add_f32 v48, v48, v64
v_add_f32 v49, v49, v65
v_lshlrev_b32 v64, 16, v67
v_and_b32 v65, 0xffff0000, v67
v_add_f32 v50, v50, v64
v_add_f32 v51, v51, v65
LE_fl19:
s_nop 3
v_cvt_pk_bf16_f32 v64, v48, v49
v_cvt_pk_bf16_f32 v65, v50, v51
v_mov_b32 v48, 0
v_mov_b32 v49, 0
v_mov_b32 v50, 0
v_mov_b32 v51, 0
buffer_store_dwordx2 v[64:65], v39, s[20:23], s47 offen sc1
s_add_u32 s47, s47, 512
LE_nf19:
s_waitcnt lgkmcnt(0)
ds_read2_b32 v[56:57], v34 offset0:80 offset1:84
ds_read2_b32 v[58:59], v34 offset0:88 offset1:92
v_mad_u32_u16 v60, v52, s49, v2
v_mad_u32_u16 v61, v53, s49, v2
v_mad_u32_u16 v62, v54, s49, v2
v_mad_u32_u16 v63, v55, s49, v2
buffer_load_dwordx4 a[128:131], v60, s[16:19], 0 offen sc1
buffer_load_dwordx4 a[132:135], v60, s[16:19], 0 offen offset:256 sc1
buffer_load_dwordx4 a[136:139], v61, s[16:19], 0 offen sc1
buffer_load_dwordx4 a[140:143], v61, s[16:19], 0 offen offset:256 sc1
buffer_load_dwordx4 a[144:147], v62, s[16:19], 0 offen sc1
buffer_load_dwordx4 a[148:151], v62, s[16:19], 0 offen offset:256 sc1
buffer_load_dwordx4 a[152:155], v63, s[16:19], 0 offen sc1
buffer_load_dwordx4 a[156:159], v63, s[16:19], 0 offen offset:256 sc1
s_waitcnt vmcnt(56)
v_mfma_f32_16x16x32_bf16 v[48:51], a[160:163], v[40:43], v[48:51]
v_mfma_f32_16x16x32_bf16 v[48:51], a[164:167], v[44:47], v[48:51]
s_bitcmp1_b32 s46, 20
s_cbranch_scc0 LE_nf20
s_cmp_eq_u32 s42, 0
s_cbranch_scc1 LE_fl20
buffer_load_dwordx2 v[66:67], v39, s[20:23], s47 offen sc1
s_waitcnt vmcnt(0)
v_lshlrev_b32 v64, 16, v66
v_and_b32 v65, 0xffff0000, v66
v_add_f32 v48, v48, v64
v_add_f32 v49, v49, v65
v_lshlrev_b32 v64, 16, v67
v_and_b32 v65, 0xffff0000, v67
v_add_f32 v50, v50, v64
v_add_f32 v51, v51, v65
LE_fl20:
s_nop 3
v_cvt_pk_bf16_f32 v64, v48, v49
v_cvt_pk_bf16_f32 v65, v50, v51
v_mov_b32 v48, 0
v_mov_b32 v49, 0
v_mov_b32 v50, 0
v_mov_b32 v51, 0
buffer_store_dwordx2 v[64:65], v39, s[20:23], s47 offen sc1
s_add_u32 s47, s47, 512
LE_nf20:
v_mfma_f32_16x16x32_bf16 v[48:51], a[168:171], v[40:43], v[48:51]
v_mfma_f32_16x16x32_bf16 v[48:51], a[172:175], v[44:47], v[48:51]
s_bitcmp1_b32 s46, 21
s_cbranch_scc0 LE_nf21
s_cmp_eq_u32 s42, 0
s_cbranch_scc1 LE_fl21
buffer_load_dwordx2 v[66:67], v39, s[20:23], s47 offen sc1
s_waitcnt vmcnt(0)
v_lshlrev_b32 v64, 16, v66
v_and_b32 v65, 0xffff0000, v66
v_add_f32 v48, v48, v64
v_add_f32 v49, v49, v65
v_lshlrev_b32 v64, 16, v67
v_and_b32 v65, 0xffff0000, v67
v_add_f32 v50, v50, v64
v_add_f32 v51, v51, v65
LE_fl21:
s_nop 3
v_cvt_pk_bf16_f32 v64, v48, v49
v_cvt_pk_bf16_f32 v65, v50, v51
v_mov_b32 v48, 0
v_mov_b32 v49, 0
v_mov_b32 v50, 0
v_mov_b32 v51, 0
buffer_store_dwordx2 v[64:65], v39, s[20:23], s47 offen sc1
s_add_u32 s47, s47, 512
LE_nf21:
v_mfma_f32_16x16x32_bf16 v[48:51], a[176:179], v[40:43], v[48:51]
v_mfma_f32_16x16x32_bf16 v[48:51], a[180:183], v[44:47], v[48:51]
s_bitcmp1_b32 s46, 22
s_cbranch_scc0 LE_nf22
s_cmp_eq_u32 s42, 0
s_cbranch_scc1 LE_fl22
buffer_load_dwordx2 v[66:67], v39, s[20:23], s47 offen sc1
s_waitcnt vmcnt(0)
v_lshlrev_b32 v64, 16, v66
v_and_b32 v65, 0xffff0000, v66
v_add_f32 v48, v48, v64
v_add_f32 v49, v49, v65
v_lshlrev_b32 v64, 16, v67
v_and_b32 v65, 0xffff0000, v67
v_add_f32 v50, v50, v64
v_add_f32 v51, v51, v65
LE_fl22:
s_nop 3
v_cvt_pk_bf16_f32 v64, v48, v49
v_cvt_pk_bf16_f32 v65, v50, v51
v_mov_b32 v48, 0
v_mov_b32 v49, 0
v_mov_b32 v50, 0
v_mov_b32 v51, 0
buffer_store_dwordx2 v[64:65], v39, s[20:23], s47 offen sc1
s_add_u32 s47, s47, 512
LE_nf22:
v_mfma_f32_16x16x32_bf16 v[48:51], a[184:187], v[40:43], v[48:51]
v_mfma_f32_16x16x32_bf16 v[48:51], a[188:191], v[44:47], v[48:51]
s_bitcmp1_b32 s46, 23
s_cbranch_scc0 LE_nf23
s_cmp_eq_u32 s42, 0
s_cbranch_scc1 LE_fl23
buffer_load_dwordx2 v[66:67], v39, s[20:23], s47 offen sc1
s_waitcnt vmcnt(0)
v_lshlrev_b32 v64, 16, v66
v_and_b32 v65, 0xffff0000, v66
v_add_f32 v48, v48, v64
v_add_f32 v49, v49, v65
v_lshlrev_b32 v64, 16, v67
v_and_b32 v65, 0xffff0000, v67
v_add_f32 v50, v50, v64
v_add_f32 v51, v51, v65
LE_fl23:
s_nop 3
v_cvt_pk_bf16_f32 v64, v48, v49
v_cvt_pk_bf16_f32 v65, v50, v51
v_mov_b32 v48, 0
v_mov_b32 v49, 0
v_mov_b32 v50, 0
v_mov_b32 v51, 0
buffer_store_dwordx2 v[64:65], v39, s[20:23], s47 offen sc1
s_add_u32 s47, s47, 512
LE_nf23:
s_waitcnt lgkmcnt(0)
ds_read2_b32 v[52:53], v34 offset0:96 offset1:100
ds_read2_b32 v[54:55], v34 offset0:104 offset1:108
v_mad_u32_u16 v60, v56, s49, v2
v_mad_u32_u16 v61, v57, s49, v2
v_mad_u32_u16 v62, v58, s49, v2
v_mad_u32_u16 v63, v59, s49, v2
buffer_load_dwordx4 a[160:163], v60, s[16:19], 0 offen sc1
buffer_load_dwordx4 a[164:167], v60, s[16:19], 0 offen offset:256 sc1
buffer_load_dwordx4 a[168:171], v61, s[16:19], 0 offen sc1
buffer_load_dwordx4 a[172:175], v61, s[16:19], 0 offen offset:256 sc1
buffer_load_dwordx4 a[176:179], v62, s[16:19], 0 offen sc1
buffer_load_dwordx4 a[180:183], v62, s[16:19], 0 offen offset:256 sc1
buffer_load_dwordx4 a[184:187], v63, s[16:19], 0 offen sc1
buffer_load_dwordx4 a[188:191], v63, s[16:19], 0 offen offset:256 sc1
s_waitcnt vmcnt(56)
v_mfma_f32_16x16x32_bf16 v[48:51], a[192:195], v[40:43], v[48:51]
v_mfma_f32_16x16x32_bf16 v[48:51], a[196:199], v[44:47], v[48:51]
s_bitcmp1_b32 s46, 24
s_cbranch_scc0 LE_nf24
s_cmp_eq_u32 s42, 0
s_cbranch_scc1 LE_fl24
buffer_load_dwordx2 v[66:67], v39, s[20:23], s47 offen sc1
s_waitcnt vmcnt(0)
v_lshlrev_b32 v64, 16, v66
v_and_b32 v65, 0xffff0000, v66
v_add_f32 v48, v48, v64
v_add_f32 v49, v49, v65
v_lshlrev_b32 v64, 16, v67
v_and_b32 v65, 0xffff0000, v67
v_add_f32 v50, v50, v64
v_add_f32 v51, v51, v65
LE_fl24:
s_nop 3
v_cvt_pk_bf16_f32 v64, v48, v49
v_cvt_pk_bf16_f32 v65, v50, v51
v_mov_b32 v48, 0
v_mov_b32 v49, 0
v_mov_b32 v50, 0
v_mov_b32 v51, 0
buffer_store_dwordx2 v[64:65], v39, s[20:23], s47 offen sc1
s_add_u32 s47, s47, 512
LE_nf24:
v_mfma_f32_16x16x32_bf16 v[48:51], a[200:203], v[40:43], v[48:51]
v_mfma_f32_16x16x32_bf16 v[48:51], a[204:207], v[44:47], v[48:51]
s_bitcmp1_b32 s46, 25
s_cbranch_scc0 LE_nf25
s_cmp_eq_u32 s42, 0
s_cbranch_scc1 LE_fl25
buffer_load_dwordx2 v[66:67], v39, s[20:23], s47 offen sc1
s_waitcnt vmcnt(0)
v_lshlrev_b32 v64, 16, v66
v_and_b32 v65, 0xffff0000, v66
v_add_f32 v48, v48, v64
v_add_f32 v49, v49, v65
v_lshlrev_b32 v64, 16, v67
v_and_b32 v65, 0xffff0000, v67
v_add_f32 v50, v50, v64
v_add_f32 v51, v51, v65
LE_fl25:
s_nop 3
v_cvt_pk_bf16_f32 v64, v48, v49
v_cvt_pk_bf16_f32 v65, v50, v51
v_mov_b32 v48, 0
v_mov_b32 v49, 0
v_mov_b32 v50, 0
v_mov_b32 v51, 0
buffer_store_dwordx2 v[64:65], v39, s[20:23], s47 offen sc1
s_add_u32 s47, s47, 512
LE_nf25:
v_mfma_f32_16x16x32_bf16 v[48:51], a[208:211], v[40:43], v[48:51]
v_mfma_f32_16x16x32_bf16 v[48:51], a[212:215], v[44:47], v[48:51]
s_bitcmp1_b32 s46, 26
s_cbranch_scc0 LE_nf26
s_cmp_eq_u32 s42, 0
s_cbranch_scc1 LE_fl26
buffer_load_dwordx2 v[66:67], v39, s[20:23], s47 offen sc1
s_waitcnt vmcnt(0)
v_lshlrev_b32 v64, 16, v66
v_and_b32 v65, 0xffff0000, v66
v_add_f32 v48, v48, v64
v_add_f32 v49, v49, v65
v_lshlrev_b32 v64, 16, v67
v_and_b32 v65, 0xffff0000, v67
v_add_f32 v50, v50, v64
v_add_f32 v51, v51, v65
LE_fl26:
s_nop 3
v_cvt_pk_bf16_f32 v64, v48, v49
v_cvt_pk_bf16_f32 v65, v50, v51
v_mov_b32 v48, 0
v_mov_b32 v49, 0
v_mov_b32 v50, 0
v_mov_b32 v51, 0
buffer_store_dwordx2 v[64:65], v39, s[20:23], s47 offen sc1
s_add_u32 s47, s47, 512
LE_nf26:
v_mfma_f32_16x16x32_bf16 v[48:51], a[216:219], v[40:43], v[48:51]
v_mfma_f32_16x16x32_bf16 v[48:51], a[220:223], v[44:47], v[48:51]
s_bitcmp1_b32 s46, 27
s_cbranch_scc0 LE_nf27
s_cmp_eq_u32 s42, 0
s_cbranch_scc1 LE_fl27
buffer_load_dwordx2 v[66:67], v39, s[20:23], s47 offen sc1
s_waitcnt vmcnt(0)
v_lshlrev_b32 v64, 16, v66
v_and_b32 v65, 0xffff0000, v66
v_add_f32 v48, v48, v64
v_add_f32 v49, v49, v65
v_lshlrev_b32 v64, 16, v67
v_and_b32 v65, 0xffff0000, v67
v_add_f32 v50, v50, v64
v_add_f32 v51, v51, v65
LE_fl27:
s_nop 3
v_cvt_pk_bf16_f32 v64, v48, v49
v_cvt_pk_bf16_f32 v65, v50, v51
v_mov_b32 v48, 0
v_mov_b32 v49, 0
v_mov_b32 v50, 0
v_mov_b32 v51, 0
buffer_store_dwordx2 v[64:65], v39, s[20:23], s47 offen sc1
s_add_u32 s47, s47, 512
LE_nf27:
s_waitcnt lgkmcnt(0)
ds_read2_b32 v[56:57], v34 offset0:112 offset1:116
ds_read2_b32 v[58:59], v34 offset0:120 offset1:124
v_mad_u32_u16 v60, v52, s49, v2
v_mad_u32_u16 v61, v53, s49, v2
v_mad_u32_u16 v62, v54, s49, v2
v_mad_u32_u16 v63, v55, s49, v2
buffer_load_dwordx4 a[192:195], v60, s[16:19], 0 offen sc1
buffer_load_dwordx4 a[196:199], v60, s[16:19], 0 offen offset:256 sc1
buffer_load_dwordx4 a[200:203], v61, s[16:19], 0 offen sc1
buffer_load_dwordx4 a[204:207], v61, s[16:19], 0 offen offset:256 sc1
buffer_load_dwordx4 a[208:211], v62, s[16:19], 0 offen sc1
buffer_load_dwordx4 a[212:215], v62, s[16:19], 0 offen offset:256 sc1
buffer_load_dwordx4 a[216:219], v63, s[16:19], 0 offen sc1
buffer_load_dwordx4 a[220:223], v63, s[16:19], 0 offen offset:256 sc1
s_waitcnt vmcnt(56)
v_mfma_f32_16x16x32_bf16 v[48:51], a[224:227], v[40:43], v[48:51]
v_mfma_f32_16x16x32_bf16 v[48:51], a[228:231], v[44:47], v[48:51]
s_bitcmp1_b32 s46, 28
s_cbranch_scc0 LE_nf28
s_cmp_eq_u32 s42, 0
s_cbranch_scc1 LE_fl28
buffer_load_dwordx2 v[66:67], v39, s[20:23], s47 offen sc1
s_waitcnt vmcnt(0)
v_lshlrev_b32 v64, 16, v66
v_and_b32 v65, 0xffff0000, v66
v_add_f32 v48, v48, v64
v_add_f32 v49, v49, v65
v_lshlrev_b32 v64, 16, v67
v_and_b32 v65, 0xffff0000, v67
v_add_f32 v50, v50, v64
v_add_f32 v51, v51, v65
LE_fl28:
s_nop 3
v_cvt_pk_bf16_f32 v64, v48, v49
v_cvt_pk_bf16_f32 v65, v50, v51
v_mov_b32 v48, 0
v_mov_b32 v49, 0
v_mov_b32 v50, 0
v_mov_b32 v51, 0
buffer_store_dwordx2 v[64:65], v39, s[20:23], s47 offen sc1
s_add_u32 s47, s47, 512
LE_nf28:
v_mfma_f32_16x16x32_bf16 v[48:51], a[232:235], v[40:43], v[48:51]
v_mfma_f32_16x16x32_bf16 v[48:51], a[236:239], v[44:47], v[48:51]
s_bitcmp1_b32 s46, 29
s_cbranch_scc0 LE_nf29
s_cmp_eq_u32 s42, 0
s_cbranch_scc1 LE_fl29
buffer_load_dwordx2 v[66:67], v39, s[20:23], s47 offen sc1
s_waitcnt vmcnt(0)
v_lshlrev_b32 v64, 16, v66
v_and_b32 v65, 0xffff0000, v66
v_add_f32 v48, v48, v64
v_add_f32 v49, v49, v65
v_lshlrev_b32 v64, 16, v67
v_and_b32 v65, 0xffff0000, v67
v_add_f32 v50, v50, v64
v_add_f32 v51, v51, v65
LE_fl29:
s_nop 3
v_cvt_pk_bf16_f32 v64, v48, v49
v_cvt_pk_bf16_f32 v65, v50, v51
v_mov_b32 v48, 0
v_mov_b32 v49, 0
v_mov_b32 v50, 0
v_mov_b32 v51, 0
buffer_store_dwordx2 v[64:65], v39, s[20:23], s47 offen sc1
s_add_u32 s47, s47, 512
LE_nf29:
v_mfma_f32_16x16x32_bf16 v[48:51], a[240:243], v[40:43], v[48:51]
v_mfma_f32_16x16x32_bf16 v[48:51], a[244:247], v[44:47], v[48:51]
s_bitcmp1_b32 s46, 30
s_cbranch_scc0 LE_nf30
s_cmp_eq_u32 s42, 0
s_cbranch_scc1 LE_fl30
buffer_load_dwordx2 v[66:67], v39, s[20:23], s47 offen sc1
s_waitcnt vmcnt(0)
v_lshlrev_b32 v64, 16, v66
v_and_b32 v65, 0xffff0000, v66
v_add_f32 v48, v48, v64
v_add_f32 v49, v49, v65
v_lshlrev_b32 v64, 16, v67
v_and_b32 v65, 0xffff0000, v67
v_add_f32 v50, v50, v64
v_add_f32 v51, v51, v65
LE_fl30:
s_nop 3
v_cvt_pk_bf16_f32 v64, v48, v49
v_cvt_pk_bf16_f32 v65, v50, v51
v_mov_b32 v48, 0
v_mov_b32 v49, 0
v_mov_b32 v50, 0
v_mov_b32 v51, 0
buffer_store_dwordx2 v[64:65], v39, s[20:23], s47 offen sc1
s_add_u32 s47, s47, 512
LE_nf30:
v_mfma_f32_16x16x32_bf16 v[48:51], a[248:251], v[40:43], v[48:51]
v_mfma_f32_16x16x32_bf16 v[48:51], a[252:255], v[44:47], v[48:51]
s_bitcmp1_b32 s46, 31
s_cbranch_scc0 LE_nf31
s_cmp_eq_u32 s42, 0
s_cbranch_scc1 LE_fl31
buffer_load_dwordx2 v[66:67], v39, s[20:23], s47 offen sc1
s_waitcnt vmcnt(0)
v_lshlrev_b32 v64, 16, v66
v_and_b32 v65, 0xffff0000, v66
v_add_f32 v48, v48, v64
v_add_f32 v49, v49, v65
v_lshlrev_b32 v64, 16, v67
v_and_b32 v65, 0xffff0000, v67
v_add_f32 v50, v50, v64
v_add_f32 v51, v51, v65
LE_fl31:
s_nop 3
v_cvt_pk_bf16_f32 v64, v48, v49
v_cvt_pk_bf16_f32 v65, v50, v51
v_mov_b32 v48, 0
v_mov_b32 v49, 0
v_mov_b32 v50, 0
v_mov_b32 v51, 0
buffer_store_dwordx2 v[64:65], v39, s[20:23], s47 offen sc1
s_add_u32 s47, s47, 512
LE_nf31:
s_waitcnt lgkmcnt(0)
ds_read2_b32 v[52:53], v34 offset0:128 offset1:132
ds_read2_b32 v[54:55], v34 offset0:136 offset1:140
v_mad_u32_u16 v60, v56, s49, v2
v_mad_u32_u16 v61, v57, s49, v2
v_mad_u32_u16 v62, v58, s49, v2
v_mad_u32_u16 v63, v59, s49, v2
buffer_load_dwordx4 a[224:227], v60, s[16:19], 0 offen sc1
buffer_load_dwordx4 a[228:231], v60, s[16:19], 0 offen offset:256 sc1
buffer_load_dwordx4 a[232:235], v61, s[16:19], 0 offen sc1
buffer_load_dwordx4 a[236:239], v61, s[16:19], 0 offen offset:256 sc1
buffer_load_dwordx4 a[240:243], v62, s[16:19], 0 offen sc1
buffer_load_dwordx4 a[244:247], v62, s[16:19], 0 offen offset:256 sc1
buffer_load_dwordx4 a[248:251], v63, s[16:19], 0 offen sc1
buffer_load_dwordx4 a[252:255], v63, s[16:19], 0 offen offset:256 sc1
v_add_u32 v34, 512, v34
s_cmp_lt_u32 s45, s44
s_cbranch_scc1 LE_loop
s_add_u32 s42, s42, 1
s_mul_i32 s43, s42, 256
v_cmp_lt_u32 vcc, s43, v4
s_cbranch_vccz LE_done
s_cmp_ge_u32 s42, 40
s_cbranch_scc1 LE_done
s_waitcnt vmcnt(0) lgkmcnt(0)
s_add_u32 s50, s50, 1024
v_add_u32 v5, 0x100, v5
buffer_load_dwordx4 v[192:195], v6, s[12:15], s50 offen offset:0 sc1
buffer_load_dwordx4 v[196:199], v6, s[12:15], s50 offen offset:64 sc1
buffer_load_dwordx4 v[200:203], v6, s[12:15], s50 offen offset:128 sc1
buffer_load_dwordx4 v[204:207], v6, s[12:15], s50 offen offset:192 sc1
buffer_load_dwordx4 v[208:211], v6, s[12:15], s50 offen offset:256 sc1
buffer_load_dwordx4 v[212:215], v6, s[12:15], s50 offen offset:320 sc1
buffer_load_dwordx4 v[216:219], v6, s[12:15], s50 offen offset:384 sc1
buffer_load_dwordx4 v[220:223], v6, s[12:15], s50 offen offset:448 sc1
buffer_load_dwordx4 v[224:227], v6, s[12:15], s50 offen offset:512 sc1
buffer_load_dwordx4 v[228:231], v6, s[12:15], s50 offen offset:576 sc1
buffer_load_dwordx4 v[232:235], v6, s[12:15], s50 offen offset:640 sc1
buffer_load_dwordx4 v[236:239], v6, s[12:15], s50 offen offset:704 sc1
buffer_load_dwordx4 v[240:243], v6, s[12:15], s50 offen offset:768 sc1
buffer_load_dwordx4 v[244:247], v6, s[12:15], s50 offen offset:832 sc1
buffer_load_dwordx4 v[248:251], v6, s[12:15], s50 offen offset:896 sc1
buffer_load_dwordx4 v[252:255], v6, s[12:15], s50 offen offset:960 sc1
s_branch LE_pass
LE_done:
s_add_u32 s24, s4, 0x7c00000
s_addc_u32 s25, s5, 0
s_mov_b32 s26, 0x40000
s_mov_b32 s27, 0x00020000
s_add_u32 s48, s40, 1280
s_mul_i32 s48, s48, 128
s_waitcnt vmcnt(0)
v_mov_b32 v32, s98
v_mov_b32 v33, s99
s_mov_b64 exec, 1
buffer_store_dwordx2 v[32:33], off, s[24:27], s48 sc1
s_mov_b64 exec, -1
s_branch L2_end
L2_fin:
L2_end:
s_endpgm
.section .rodata,"a"
.p2align 6
.amdhsa_kernel standalone__hybrid_graph_tf_graphgps__graph_kernel
  .amdhsa_next_free_vgpr 512
  .amdhsa_next_free_sgpr 102
  .amdhsa_accum_offset 256
  .amdhsa_group_segment_fixed_size 0
  .amdhsa_kernarg_size 96
  .amdhsa_user_sgpr_count 2
  .amdhsa_user_sgpr_kernarg_segment_ptr 1
  .amdhsa_system_sgpr_workgroup_id_x 1
.end_amdhsa_kernel
```

```asm
; @launch grid=(256,1,1) block=(256,1,1) lds=163840
.amdgcn_target "amdgcn-amd-amdhsa--gfx950"
.text
.globl standalone__hybrid_graph_tf_graphgps__graph_kernel
.p2align 8
.type standalone__hybrid_graph_tf_graphgps__graph_kernel,@function
standalone__hybrid_graph_tf_graphgps__graph_kernel:
s_getpc_b64 s[56:57]
s_load_dwordx16 s[16:31], s[0:1], 0
s_load_dwordx8 s[32:39], s[0:1], 64
s_cmp_ge_u32 s2, 256
s_cbranch_scc1 L2_end
v_lshrrev_b32 v1, 6, v0
v_and_b32 v2, 63, v0
s_lshr_b32 s3, s2, 3
s_add_u32 s3, s3, 30
s_and_b32 s3, s3, 31
v_readfirstlane_b32 s60, v1
s_lshl_b32 s5, s3, 2
s_add_u32 s5, s5, s60
s_and_b32 s56, s56, 0xffffff00
s_mov_b32 s58, L2_hot-standalone__hybrid_graph_tf_graphgps__graph_kernel
s_mov_b32 s59, 0x00020000
s_and_b32 s6, s5, 15
s_lshl_b32 s6, s6, 13
s_cmp_lt_u32 s5, 32
s_cselect_b32 s6, s6, 0x7fff0000
v_lshlrev_b32 v10, 7, v2
buffer_load_dword v255, v10, s[56:59], s6 offen
v_and_b32 v3, 15, v2
v_lshrrev_b32 v4, 4, v2
s_and_b32 s62, s3, 7
s_mov_b64 s[14:15], 0
s_and_b32 s8, s2, 7
s_cmp_ge_u32 s3, 30
s_cbranch_scc1 LM_edge
s_mul_i32 s12, s3, 26
s_lshr_b32 s12, s12, 8
s_mul_i32 s9, s12, 10
s_sub_u32 s9, s3, s9
s_and_b32 s13, s8, 1
s_mul_i32 s13, s13, 3
s_add_u32 s13, s13, s12
s_and_b32 s12, s8, 1
s_mul_i32 s12, s12, 5
s_add_u32 s8, s8, s12
s_and_b32 s8, s8, 7
s_lshr_b32 s12, s8, 1
s_mul_i32 s12, s12, 10
s_add_u32 s12, s12, s9
s_mul_i32 s91, s12, 6
s_add_u32 s91, s91, s13
s_mov_b32 s61, 0
s_cmp_eq_u32 s12, 39
s_cbranch_scc1 LM_light
s_mul_i32 s14, s13, 3
s_min_u32 s14, s14, 14
s_lshl_b32 s9, s12, 4
s_add_u32 s14, s14, s9
s_lshl_b32 s14, s14, 13
s_cmp_eq_u32 s91, 233
s_cselect_b32 s9, 0, s13
s_cmp_lt_u32 s9, 4
s_cselect_b32 s15, 3, 2
s_lshl_b32 s15, s15, 13
s_add_u32 s15, s15, s14
v_lshlrev_b32 v16, 4, v2
s_mul_i32 s63, s60, 12288
s_mov_b32 s6, s14
s_mul_i32 s7, s60, 6144
s_add_u32 s64, s6, s7
s_add_u32 s65, s64, 4096
s_lshl_b32 s7, s60, 7
v_lshrrev_b32 v5, 3, v2
v_and_b32 v6, 7, v2
v_and_b32 v7, 2, v5
v_xor_b32 v6, v6, v7
v_lshl_add_u32 v5, v5, 9, s7
v_lshl_add_u32 v17, v6, 4, v5
v_xor_b32 v6, 4, v6
v_lshl_add_u32 v18, v6, 4, v5
v_add_u32 v18, 0xc00, v18
v_add_u32 v19, 0x1800, v17
v_add_u32 v20, 0x1800, v18
s_xor_b32 s6, s62, 0
s_lshl_b32 s66, s6, 14
s_xor_b32 s6, s62, 1
s_lshl_b32 s67, s6, 14
s_xor_b32 s6, s62, 2
s_lshl_b32 s68, s6, 14
s_xor_b32 s6, s62, 3
s_lshl_b32 s69, s6, 14
s_xor_b32 s6, s62, 4
s_lshl_b32 s70, s6, 14
s_xor_b32 s6, s62, 5
s_lshl_b32 s71, s6, 14
s_xor_b32 s6, s62, 6
s_lshl_b32 s72, s6, 14
s_xor_b32 s6, s62, 7
s_lshl_b32 s73, s6, 14
s_waitcnt lgkmcnt(0)
s_add_u32 s40, s16, 0x0
s_addc_u32 s41, s17, 0
s_mov_b32 s42, s15
s_mov_b32 s43, 0x00020000
s_add_u32 s44, s26, 0x0
s_addc_u32 s45, s27, 0
s_mov_b32 s46, 0x20000
s_mov_b32 s47, 0x00020000
buffer_load_dwordx4 v[44:47], v16, s[40:43], s64 offen offset:0
buffer_load_dwordx4 v[48:51], v16, s[40:43], s64 offen offset:1024
buffer_load_dwordx4 v[52:55], v16, s[40:43], s64 offen offset:2048
buffer_load_dwordx4 v[56:59], v16, s[40:43], s64 offen offset:3072
buffer_load_dwordx4 v[60:63], v16, s[40:43], s65 offen offset:0
buffer_load_dwordx4 v[64:67], v16, s[40:43], s65 offen offset:1024
s_add_u32 m0, s63, 0x0
s_nop 0
buffer_load_dwordx4 v17, s[44:47], s66 offen offset:0 lds
buffer_load_dwordx4 v18, s[44:47], s66 offen offset:1024 lds
buffer_load_dwordx4 v19, s[44:47], s66 offen offset:2048 lds
buffer_load_dwordx4 v20, s[44:47], s66 offen offset:3072 lds
s_add_u32 m0, s63, 0x1000
s_nop 0
buffer_load_dwordx4 v17, s[44:47], s67 offen offset:0 lds
buffer_load_dwordx4 v18, s[44:47], s67 offen offset:1024 lds
buffer_load_dwordx4 v19, s[44:47], s67 offen offset:2048 lds
buffer_load_dwordx4 v20, s[44:47], s67 offen offset:3072 lds
s_mov_b32 s98, 0x7c3ff80
s_load_dwordx2 s[98:99], s[38:39], s98
v_bfe_u32 v5, v2, 2, 3
v_xor_b32 v5, s62, v5
v_and_b32 v6, 3, v2
v_lshlrev_b32 v7, 10, v5
v_lshl_add_u32 v7, v6, 8, v7
v_add_u32 v7, 0xc000, v7
v_and_b32 v5, 1, v5
v_lshl_or_b32 v6, v5, 2, v6
v_lshrrev_b32 v5, 5, v2
s_mul_i32 s6, s60, 12
v_add3_u32 v8, v5, s6, 0
v_lshrrev_b32 v9, 4, v8
v_lshl_add_u32 v9, v9, 13, v7
v_and_b32 v8, 15, v8
v_xor_b32 v8, v8, v6
v_lshl_add_u32 v36, v8, 4, v9
v_add3_u32 v8, v5, s6, 2
v_lshrrev_b32 v9, 4, v8
v_lshl_add_u32 v9, v9, 13, v7
v_and_b32 v8, 15, v8
v_xor_b32 v8, v8, v6
v_lshl_add_u32 v37, v8, 4, v9
v_add3_u32 v8, v5, s6, 4
v_lshrrev_b32 v9, 4, v8
v_lshl_add_u32 v9, v9, 13, v7
v_and_b32 v8, 15, v8
v_xor_b32 v8, v8, v6
v_lshl_add_u32 v38, v8, 4, v9
v_add3_u32 v8, v5, s6, 6
v_lshrrev_b32 v9, 4, v8
v_lshl_add_u32 v9, v9, 13, v7
v_and_b32 v8, 15, v8
v_xor_b32 v8, v8, v6
v_lshl_add_u32 v39, v8, 4, v9
v_add3_u32 v8, v5, s6, 8
v_lshrrev_b32 v9, 4, v8
v_lshl_add_u32 v9, v9, 13, v7
v_and_b32 v8, 15, v8
v_xor_b32 v8, v8, v6
v_lshl_add_u32 v40, v8, 4, v9
v_add3_u32 v8, v5, s6, 10
v_lshrrev_b32 v9, 4, v8
v_lshl_add_u32 v9, v9, 13, v7
v_and_b32 v8, 15, v8
v_xor_b32 v8, v8, v6
v_lshl_add_u32 v41, v8, 4, v9
v_xor_b32 v5, v3, v4
v_lshlrev_b32 v5, 4, v5
v_lshl_add_u32 v5, v4, 8, v5
v_add_u32 v31, 0xc000, v5
v_xor_b32 v32, 64, v31
v_lshrrev_b32 v5, 2, v3
v_and_b32 v6, 3, v3
v_and_b32 v7, 1, v4
v_lshlrev_b32 v7, 2, v7
v_and_b32 v8, 2, v5
v_or_b32 v7, v7, v8
v_lshl_add_u32 v8, v4, 3, v5
v_lshlrev_b32 v8, 7, v8
v_add_u32 v8, s63, v8
v_and_b32 v9, 1, v6
v_lshl_add_u32 v8, v9, 3, v8
v_lshrrev_b32 v6, 1, v6
v_xor_b32 v6, v6, v7
v_xor_b32 v9, 0, v6
v_lshl_add_u32 v25, v9, 4, v8
v_xor_b32 v9, 2, v6
v_lshl_add_u32 v26, v9, 4, v8
v_xor_b32 v9, 4, v6
v_lshl_add_u32 v27, v9, 4, v8
v_xor_b32 v9, 6, v6
v_lshl_add_u32 v28, v9, 4, v8
v_lshrrev_b32 v5, 3, v2
v_and_b32 v6, 7, v2
v_lshrrev_b32 v7, 1, v5
v_xor_b32 v6, v6, v7
v_and_b32 v7, 4, v5
v_add_u32 v5, v5, v7
s_mul_i32 s6, s60, 32768
v_lshl_add_u32 v5, v5, 9, s6
v_lshl_add_u32 v21, v6, 4, v5
v_xor_b32 v6, 4, v6
v_lshl_add_u32 v22, v6, 4, v5
v_add_u32 v22, 0x1c00, v22
v_mov_b32 v23, v21
v_mov_b32 v24, v22
s_lshr_b32 s7, s62, 1
s_xor_b32 s6, s7, 0
s_lshl_b32 s74, s6, 7
s_add_u32 s75, s74, 16384
s_xor_b32 s6, s7, 1
s_lshl_b32 s76, s6, 7
s_add_u32 s77, s76, 16384
s_xor_b32 s6, s7, 2
s_lshl_b32 s78, s6, 7
s_add_u32 s79, s78, 16384
s_xor_b32 s6, s7, 3
s_lshl_b32 s80, s6, 7
s_add_u32 s81, s80, 16384
s_and_b32 s6, s62, 1
s_lshl_b32 s6, s6, 2
v_lshrrev_b32 v5, 1, v3
v_xor_b32 v5, v5, v4
v_xor_b32 v5, s6, v5
v_lshl_add_u32 v6, v3, 7, s63
v_lshl_add_u32 v29, v5, 4, v6
v_xor_b32 v30, 64, v29
s_mul_i32 s6, s60, 2
s_xor_b32 s6, s6, s62
s_lshl_b32 s6, s6, 10
s_add_u32 s6, s6, 0x12000
v_lshrrev_b32 v5, 1, v4
v_and_b32 v6, 1, v4
v_lshl_add_u32 v5, v5, 8, s6
v_lshl_add_u32 v5, v6, 3, v5
v_lshl_add_u32 v33, v3, 4, v5
v_xor_b32 v34, 0x400, v33
v_add_u32 v35, 0x12000, v16
s_mov_b32 s6, s14
s_mul_i32 s7, s60, 2048
s_add_u32 s82, s6, s7
s_add_u32 s83, s82, 8192
s_add_u32 s84, s82, 16384
s_mov_b32 s86, 0x3db8aa3b
s_mov_b32 s87, 0x3db8aa3b
s_mov_b32 s88, 0x3727c5ac
s_mov_b32 s89, 0x3b800000
s_mov_b32 s90, 0xffff0000
s_add_u32 s48, s28, 0x0
s_addc_u32 s49, s29, 0
s_mov_b32 s50, 0x20000
s_mov_b32 s51, 0x00020000
s_add_u32 s52, s38, 0x0
s_addc_u32 s53, s39, 0
s_mov_b32 s54, s15
s_mov_b32 s55, 0x00020000
s_add_u32 s56, s38, 0x6800000
s_addc_u32 s57, s39, 0
s_mov_b32 s58, s15
s_mov_b32 s59, 0x00020000
s_waitcnt vmcnt(13)
v_lshlrev_b32 v116, 16, v44
v_and_b32 v117, s90, v44
v_lshlrev_b32 v118, 16, v45
v_and_b32 v119, s90, v45
v_lshlrev_b32 v120, 16, v46
v_and_b32 v121, s90, v46
v_lshlrev_b32 v122, 16, v47
v_and_b32 v123, s90, v47
v_pk_add_f32 v[164:165], v[116:117], v[118:119]
v_pk_mul_f32 v[166:167], v[116:117], v[116:117]
v_pk_add_f32 v[44:45], v[120:121], v[122:123]
v_pk_fma_f32 v[166:167], v[118:119], v[118:119], v[166:167]
v_pk_add_f32 v[164:165], v[164:165], v[44:45]
v_pk_fma_f32 v[166:167], v[120:121], v[120:121], v[166:167]
v_add_f32 v164, v164, v165
v_pk_fma_f32 v[166:167], v[122:123], v[122:123], v[166:167]
v_add_f32 v166, v166, v167
s_waitcnt vmcnt(12)
v_lshlrev_b32 v124, 16, v48
v_and_b32 v125, s90, v48
v_lshlrev_b32 v126, 16, v49
v_and_b32 v127, s90, v49
v_lshlrev_b32 v128, 16, v50
v_and_b32 v129, s90, v50
v_lshlrev_b32 v130, 16, v51
v_and_b32 v131, s90, v51
v_pk_add_f32 v[168:169], v[124:125], v[126:127]
v_pk_mul_f32 v[170:171], v[124:125], v[124:125]
v_pk_add_f32 v[48:49], v[128:129], v[130:131]
v_pk_fma_f32 v[170:171], v[126:127], v[126:127], v[170:171]
v_pk_add_f32 v[168:169], v[168:169], v[48:49]
v_pk_fma_f32 v[170:171], v[128:129], v[128:129], v[170:171]
v_add_f32 v168, v168, v169
v_pk_fma_f32 v[170:171], v[130:131], v[130:131], v[170:171]
v_add_f32 v170, v170, v171
s_waitcnt vmcnt(11)
v_lshlrev_b32 v132, 16, v52
v_and_b32 v133, s90, v52
v_lshlrev_b32 v134, 16, v53
v_and_b32 v135, s90, v53
v_lshlrev_b32 v136, 16, v54
v_and_b32 v137, s90, v54
v_lshlrev_b32 v138, 16, v55
v_and_b32 v139, s90, v55
v_pk_add_f32 v[172:173], v[132:133], v[134:135]
v_pk_mul_f32 v[174:175], v[132:133], v[132:133]
v_pk_add_f32 v[52:53], v[136:137], v[138:139]
v_pk_fma_f32 v[174:175], v[134:135], v[134:135], v[174:175]
v_pk_add_f32 v[172:173], v[172:173], v[52:53]
v_pk_fma_f32 v[174:175], v[136:137], v[136:137], v[174:175]
v_add_f32 v172, v172, v173
v_pk_fma_f32 v[174:175], v[138:139], v[138:139], v[174:175]
v_add_f32 v174, v174, v175
s_waitcnt vmcnt(10)
v_lshlrev_b32 v140, 16, v56
v_and_b32 v141, s90, v56
v_lshlrev_b32 v142, 16, v57
v_and_b32 v143, s90, v57
v_lshlrev_b32 v144, 16, v58
v_and_b32 v145, s90, v58
v_lshlrev_b32 v146, 16, v59
v_and_b32 v147, s90, v59
v_pk_add_f32 v[176:177], v[140:141], v[142:143]
v_pk_mul_f32 v[178:179], v[140:141], v[140:141]
v_pk_add_f32 v[56:57], v[144:145], v[146:147]
v_pk_fma_f32 v[178:179], v[142:143], v[142:143], v[178:179]
v_pk_add_f32 v[176:177], v[176:177], v[56:57]
v_pk_fma_f32 v[178:179], v[144:145], v[144:145], v[178:179]
v_add_f32 v176, v176, v177
v_pk_fma_f32 v[178:179], v[146:147], v[146:147], v[178:179]
v_add_f32 v178, v178, v179
s_waitcnt vmcnt(9)
v_lshlrev_b32 v148, 16, v60
v_and_b32 v149, s90, v60
v_lshlrev_b32 v150, 16, v61
v_and_b32 v151, s90, v61
v_lshlrev_b32 v152, 16, v62
v_and_b32 v153, s90, v62
v_lshlrev_b32 v154, 16, v63
v_and_b32 v155, s90, v63
v_pk_add_f32 v[180:181], v[148:149], v[150:151]
v_pk_mul_f32 v[182:183], v[148:149], v[148:149]
v_pk_add_f32 v[60:61], v[152:153], v[154:155]
v_pk_fma_f32 v[182:183], v[150:151], v[150:151], v[182:183]
v_pk_add_f32 v[180:181], v[180:181], v[60:61]
v_pk_fma_f32 v[182:183], v[152:153], v[152:153], v[182:183]
v_add_f32 v180, v180, v181
v_pk_fma_f32 v[182:183], v[154:155], v[154:155], v[182:183]
v_add_f32 v182, v182, v183
s_waitcnt vmcnt(8)
v_lshlrev_b32 v156, 16, v64
v_and_b32 v157, s90, v64
v_lshlrev_b32 v158, 16, v65
v_and_b32 v159, s90, v65
v_lshlrev_b32 v160, 16, v66
v_and_b32 v161, s90, v66
v_lshlrev_b32 v162, 16, v67
v_and_b32 v163, s90, v67
v_pk_add_f32 v[184:185], v[156:157], v[158:159]
v_pk_mul_f32 v[186:187], v[156:157], v[156:157]
v_pk_add_f32 v[64:65], v[160:161], v[162:163]
v_pk_fma_f32 v[186:187], v[158:159], v[158:159], v[186:187]
v_pk_add_f32 v[184:185], v[184:185], v[64:65]
v_pk_fma_f32 v[186:187], v[160:161], v[160:161], v[186:187]
v_add_f32 v184, v184, v185
v_pk_fma_f32 v[186:187], v[162:163], v[162:163], v[186:187]
v_add_f32 v186, v186, v187
v_permlane16_swap_b32 v164, v166
v_permlane16_swap_b32 v168, v170
v_permlane16_swap_b32 v172, v174
v_permlane16_swap_b32 v176, v178
v_permlane16_swap_b32 v180, v182
v_permlane16_swap_b32 v184, v186
v_add_f32 v164, v164, v166
v_add_f32 v168, v168, v170
v_add_f32 v172, v172, v174
v_add_f32 v176, v176, v178
v_add_f32 v180, v180, v182
v_add_f32 v184, v184, v186
v_add_f32_dpp v165, v164, v164 row_ror:8 row_mask:0xf bank_mask:0x3
v_add_f32_dpp v165, v168, v168 row_ror:8 row_mask:0xf bank_mask:0xc
v_add_f32_dpp v173, v172, v172 row_ror:8 row_mask:0xf bank_mask:0x3
v_add_f32_dpp v173, v176, v176 row_ror:8 row_mask:0xf bank_mask:0xc
v_add_f32_dpp v181, v180, v180 row_ror:8 row_mask:0xf bank_mask:0x3
v_add_f32_dpp v181, v184, v184 row_ror:8 row_mask:0xf bank_mask:0xc
v_add_f32_dpp v166, v165, v165 row_half_mirror row_mask:0xf bank_mask:0x5
v_add_f32_dpp v166, v173, v173 row_half_mirror row_mask:0xf bank_mask:0xa
v_add_f32_dpp v182, v181, v181 row_half_mirror row_mask:0xf bank_mask:0xf
s_nop 0
v_add_f32_dpp v166, v166, v166 quad_perm:[1,0,3,2] row_mask:0xf bank_mask:0xf
v_add_f32_dpp v182, v182, v182 quad_perm:[1,0,3,2] row_mask:0xf bank_mask:0xf
s_nop 0
v_add_f32_dpp v166, v166, v166 quad_perm:[2,3,0,1] row_mask:0xf bank_mask:0xf
v_add_f32_dpp v182, v182, v182 quad_perm:[2,3,0,1] row_mask:0xf bank_mask:0xf
v_mov_b32 v167, v166
v_mov_b32 v183, v182
s_nop 0
v_permlane16_swap_b32 v167, v166
v_permlane16_swap_b32 v183, v182
v_mul_f32 v167, s89, v167
v_mul_f32 v183, s89, v183
v_mul_f32 v166, s89, v166
v_mul_f32 v182, s89, v182
v_fma_f32 v166, -v167, v167, v166
v_fma_f32 v182, -v183, v183, v182
v_cvt_pk_bf16_f32 v167, v167, v167
v_cvt_pk_bf16_f32 v183, v183, v183
v_max_f32 v166, 0, v166
v_max_f32 v182, 0, v182
v_cvt_pk_bf16_f32 v166, v166, v166
v_cvt_pk_bf16_f32 v182, v182, v182
v_and_b32 v166, s90, v166
v_and_b32 v182, s90, v182
v_add_f32 v166, s88, v166
v_add_f32 v182, s88, v182
v_cvt_pk_bf16_f32 v166, v166, v166
v_cvt_pk_bf16_f32 v182, v182, v182
v_and_b32 v166, s90, v166
v_and_b32 v182, s90, v182
v_sqrt_f32 v166, v166
v_sqrt_f32 v182, v182
v_and_b32 v167, s90, v167
v_and_b32 v183, s90, v183
v_cvt_pk_bf16_f32 v166, v166, v166
v_cvt_pk_bf16_f32 v182, v182, v182
v_and_b32 v166, s90, v166
v_and_b32 v182, s90, v182
v_rcp_f32 v166, v166
v_rcp_f32 v182, v182
v_mul_f32 v167, -v167, v166
v_mul_f32 v183, -v183, v182
s_nop 0
v_mov_b64_dpp v[164:165], v[166:167] row_newbcast:0 row_mask:0xf bank_mask:0xf
v_mov_b64_dpp v[168:169], v[166:167] row_newbcast:8 row_mask:0xf bank_mask:0xf
v_mov_b64_dpp v[172:173], v[166:167] row_newbcast:4 row_mask:0xf bank_mask:0xf
v_mov_b64_dpp v[176:177], v[166:167] row_newbcast:12 row_mask:0xf bank_mask:0xf
v_mov_b64_dpp v[180:181], v[182:183] row_newbcast:0 row_mask:0xf bank_mask:0xf
v_mov_b64_dpp v[184:185], v[182:183] row_newbcast:8 row_mask:0xf bank_mask:0xf
v_fma_f32 v116, v116, v164, v165
v_fma_f32 v117, v117, v164, v165
v_fma_f32 v118, v118, v164, v165
v_fma_f32 v119, v119, v164, v165
v_fma_f32 v120, v120, v164, v165
v_fma_f32 v121, v121, v164, v165
v_fma_f32 v122, v122, v164, v165
v_fma_f32 v123, v123, v164, v165
v_cvt_pk_bf16_f32 v44, v116, v117
v_cvt_pk_bf16_f32 v45, v118, v119
v_cvt_pk_bf16_f32 v46, v120, v121
v_cvt_pk_bf16_f32 v47, v122, v123
ds_write_b128 v36, v[44:47]
v_fma_f32 v124, v124, v168, v169
v_fma_f32 v125, v125, v168, v169
v_fma_f32 v126, v126, v168, v169
v_fma_f32 v127, v127, v168, v169
v_fma_f32 v128, v128, v168, v169
v_fma_f32 v129, v129, v168, v169
v_fma_f32 v130, v130, v168, v169
v_fma_f32 v131, v131, v168, v169
v_cvt_pk_bf16_f32 v48, v124, v125
v_cvt_pk_bf16_f32 v49, v126, v127
v_cvt_pk_bf16_f32 v50, v128, v129
v_cvt_pk_bf16_f32 v51, v130, v131
ds_write_b128 v37, v[48:51]
v_fma_f32 v132, v132, v172, v173
v_fma_f32 v133, v133, v172, v173
v_fma_f32 v134, v134, v172, v173
v_fma_f32 v135, v135, v172, v173
v_fma_f32 v136, v136, v172, v173
v_fma_f32 v137, v137, v172, v173
v_fma_f32 v138, v138, v172, v173
v_fma_f32 v139, v139, v172, v173
v_cvt_pk_bf16_f32 v52, v132, v133
v_cvt_pk_bf16_f32 v53, v134, v135
v_cvt_pk_bf16_f32 v54, v136, v137
v_cvt_pk_bf16_f32 v55, v138, v139
ds_write_b128 v38, v[52:55]
v_fma_f32 v140, v140, v176, v177
v_fma_f32 v141, v141, v176, v177
v_fma_f32 v142, v142, v176, v177
v_fma_f32 v143, v143, v176, v177
v_fma_f32 v144, v144, v176, v177
v_fma_f32 v145, v145, v176, v177
v_fma_f32 v146, v146, v176, v177
v_fma_f32 v147, v147, v176, v177
v_cvt_pk_bf16_f32 v56, v140, v141
v_cvt_pk_bf16_f32 v57, v142, v143
v_cvt_pk_bf16_f32 v58, v144, v145
v_cvt_pk_bf16_f32 v59, v146, v147
ds_write_b128 v39, v[56:59]
v_fma_f32 v148, v148, v180, v181
v_fma_f32 v149, v149, v180, v181
v_fma_f32 v150, v150, v180, v181
v_fma_f32 v151, v151, v180, v181
v_fma_f32 v152, v152, v180, v181
v_fma_f32 v153, v153, v180, v181
v_fma_f32 v154, v154, v180, v181
v_fma_f32 v155, v155, v180, v181
v_cvt_pk_bf16_f32 v60, v148, v149
v_cvt_pk_bf16_f32 v61, v150, v151
v_cvt_pk_bf16_f32 v62, v152, v153
v_cvt_pk_bf16_f32 v63, v154, v155
ds_write_b128 v40, v[60:63]
v_fma_f32 v156, v156, v184, v185
v_fma_f32 v157, v157, v184, v185
v_fma_f32 v158, v158, v184, v185
v_fma_f32 v159, v159, v184, v185
v_fma_f32 v160, v160, v184, v185
v_fma_f32 v161, v161, v184, v185
v_fma_f32 v162, v162, v184, v185
v_fma_f32 v163, v163, v184, v185
v_cvt_pk_bf16_f32 v64, v156, v157
v_cvt_pk_bf16_f32 v65, v158, v159
v_cvt_pk_bf16_f32 v66, v160, v161
v_cvt_pk_bf16_f32 v67, v162, v163
ds_write_b128 v41, v[64:67]
s_add_u32 m0, s63, 0x2000
s_nop 0
buffer_load_dwordx4 v17, s[44:47], s68 offen offset:0 lds
buffer_load_dwordx4 v18, s[44:47], s68 offen offset:1024 lds
buffer_load_dwordx4 v19, s[44:47], s68 offen offset:2048 lds
buffer_load_dwordx4 v20, s[44:47], s68 offen offset:3072 lds
s_waitcnt vmcnt(8)
ds_read_b64_tr_b16 v[164:165], v25 offset:0
ds_read_b64_tr_b16 v[166:167], v25 offset:512
ds_read_b64_tr_b16 v[168:169], v26 offset:0
ds_read_b64_tr_b16 v[170:171], v26 offset:512
ds_read_b64_tr_b16 v[172:173], v27 offset:0
ds_read_b64_tr_b16 v[174:175], v27 offset:512
s_waitcnt lgkmcnt(6)
s_barrier
ds_read_b128 v[204:207], v31 offset:0
ds_read_b128 v[208:211], v31 offset:8192
ds_read_b128 v[212:215], v31 offset:16384
s_waitcnt lgkmcnt(2)
v_mfma_f32_16x16x32_bf16 v[68:71], v[164:167], v[204:207], 0
s_waitcnt lgkmcnt(1)
v_mfma_f32_16x16x32_bf16 v[72:75], v[164:167], v[208:211], 0
s_waitcnt lgkmcnt(0)
v_mfma_f32_16x16x32_bf16 v[76:79], v[164:167], v[212:215], 0
ds_read_b64_tr_b16 v[176:177], v28 offset:0
ds_read_b64_tr_b16 v[178:179], v28 offset:512
v_mfma_f32_16x16x32_bf16 v[80:83], v[168:171], v[204:207], 0
v_mfma_f32_16x16x32_bf16 v[84:87], v[168:171], v[208:211], 0
v_mfma_f32_16x16x32_bf16 v[88:91], v[168:171], v[212:215], 0
ds_read_b128 v[216:219], v32 offset:1024
s_waitcnt vmcnt(4)
ds_read_b64_tr_b16 v[180:181], v25 offset:4096
ds_read_b64_tr_b16 v[182:183], v25 offset:4608
v_mfma_f32_16x16x32_bf16 v[92:95], v[172:175], v[204:207], 0
ds_read_b128 v[220:223], v32 offset:9216
v_mfma_f32_16x16x32_bf16 v[96:99], v[172:175], v[208:211], 0
ds_read_b128 v[224:227], v32 offset:17408
v_mfma_f32_16x16x32_bf16 v[100:103], v[172:175], v[212:215], 0
ds_read_b64_tr_b16 v[184:185], v26 offset:4096
ds_read_b64_tr_b16 v[186:187], v26 offset:4608
s_waitcnt lgkmcnt(7)
v_mfma_f32_16x16x32_bf16 v[104:107], v[176:179], v[204:207], 0
s_add_u32 m0, s63, 0x0
s_nop 0
buffer_load_dwordx4 v17, s[44:47], s69 offen offset:0 lds
buffer_load_dwordx4 v18, s[44:47], s69 offen offset:1024 lds
buffer_load_dwordx4 v19, s[44:47], s69 offen offset:2048 lds
buffer_load_dwordx4 v20, s[44:47], s69 offen offset:3072 lds
v_mfma_f32_16x16x32_bf16 v[108:111], v[176:179], v[208:211], 0
v_mfma_f32_16x16x32_bf16 v[112:115], v[176:179], v[212:215], 0
ds_read_b64_tr_b16 v[188:189], v27 offset:4096
ds_read_b64_tr_b16 v[190:191], v27 offset:4608
s_waitcnt lgkmcnt(6)
v_mfma_f32_16x16x32_bf16 v[68:71], v[180:183], v[216:219], v[68:71]
s_waitcnt lgkmcnt(5)
v_mfma_f32_16x16x32_bf16 v[72:75], v[180:183], v[220:223], v[72:75]
s_waitcnt lgkmcnt(4)
v_mfma_f32_16x16x32_bf16 v[76:79], v[180:183], v[224:227], v[76:79]
ds_read_b64_tr_b16 v[192:193], v28 offset:4096
ds_read_b64_tr_b16 v[194:195], v28 offset:4608
s_waitcnt lgkmcnt(4)
v_mfma_f32_16x16x32_bf16 v[80:83], v[184:187], v[216:219], v[80:83]
v_mfma_f32_16x16x32_bf16 v[84:87], v[184:187], v[220:223], v[84:87]
v_mfma_f32_16x16x32_bf16 v[88:91], v[184:187], v[224:227], v[88:91]
ds_read_b128 v[228:231], v31 offset:2048
s_waitcnt vmcnt(4)
ds_read_b64_tr_b16 v[196:197], v25 offset:8192
ds_read_b64_tr_b16 v[198:199], v25 offset:8704
s_waitcnt lgkmcnt(5)
v_mfma_f32_16x16x32_bf16 v[92:95], v[188:191], v[216:219], v[92:95]
ds_read_b128 v[232:235], v31 offset:10240
v_mfma_f32_16x16x32_bf16 v[96:99], v[188:191], v[220:223], v[96:99]
ds_read_b128 v[236:239], v31 offset:18432
v_mfma_f32_16x16x32_bf16 v[100:103], v[188:191], v[224:227], v[100:103]
ds_read_b64_tr_b16 v[200:201], v26 offset:8192
ds_read_b64_tr_b16 v[202:203], v26 offset:8704
s_waitcnt lgkmcnt(7)
v_mfma_f32_16x16x32_bf16 v[104:107], v[192:195], v[216:219], v[104:107]
s_add_u32 m0, s63, 0x1000
s_nop 0
buffer_load_dwordx4 v17, s[44:47], s70 offen offset:0 lds
buffer_load_dwordx4 v18, s[44:47], s70 offen offset:1024 lds
buffer_load_dwordx4 v19, s[44:47], s70 offen offset:2048 lds
buffer_load_dwordx4 v20, s[44:47], s70 offen offset:3072 lds
v_mfma_f32_16x16x32_bf16 v[108:111], v[192:195], v[220:223], v[108:111]
v_mfma_f32_16x16x32_bf16 v[112:115], v[192:195], v[224:227], v[112:115]
ds_read_b64_tr_b16 v[164:165], v27 offset:8192
ds_read_b64_tr_b16 v[166:167], v27 offset:8704
s_waitcnt lgkmcnt(6)
v_mfma_f32_16x16x32_bf16 v[68:71], v[196:199], v[228:231], v[68:71]
s_waitcnt lgkmcnt(5)
v_mfma_f32_16x16x32_bf16 v[72:75], v[196:199], v[232:235], v[72:75]
s_waitcnt lgkmcnt(4)
v_mfma_f32_16x16x32_bf16 v[76:79], v[196:199], v[236:239], v[76:79]
ds_read_b64_tr_b16 v[168:169], v28 offset:8192
ds_read_b64_tr_b16 v[170:171], v28 offset:8704
s_waitcnt lgkmcnt(4)
v_mfma_f32_16x16x32_bf16 v[80:83], v[200:203], v[228:231], v[80:83]
v_mfma_f32_16x16x32_bf16 v[84:87], v[200:203], v[232:235], v[84:87]
v_mfma_f32_16x16x32_bf16 v[88:91], v[200:203], v[236:239], v[88:91]
ds_read_b128 v[204:207], v32 offset:3072
s_waitcnt vmcnt(4)
ds_read_b64_tr_b16 v[172:173], v25 offset:0
ds_read_b64_tr_b16 v[174:175], v25 offset:512
s_waitcnt lgkmcnt(5)
v_mfma_f32_16x16x32_bf16 v[92:95], v[164:167], v[228:231], v[92:95]
ds_read_b128 v[208:211], v32 offset:11264
v_mfma_f32_16x16x32_bf16 v[96:99], v[164:167], v[232:235], v[96:99]
ds_read_b128 v[212:215], v32 offset:19456
v_mfma_f32_16x16x32_bf16 v[100:103], v[164:167], v[236:239], v[100:103]
ds_read_b64_tr_b16 v[176:177], v26 offset:0
ds_read_b64_tr_b16 v[178:179], v26 offset:512
s_waitcnt lgkmcnt(7)
v_mfma_f32_16x16x32_bf16 v[104:107], v[168:171], v[228:231], v[104:107]
s_add_u32 m0, s63, 0x2000
s_nop 0
buffer_load_dwordx4 v17, s[44:47], s71 offen offset:0 lds
buffer_load_dwordx4 v18, s[44:47], s71 offen offset:1024 lds
buffer_load_dwordx4 v19, s[44:47], s71 offen offset:2048 lds
buffer_load_dwordx4 v20, s[44:47], s71 offen offset:3072 lds
v_mfma_f32_16x16x32_bf16 v[108:111], v[168:171], v[232:235], v[108:111]
v_mfma_f32_16x16x32_bf16 v[112:115], v[168:171], v[236:239], v[112:115]
ds_read_b64_tr_b16 v[180:181], v27 offset:0
ds_read_b64_tr_b16 v[182:183], v27 offset:512
s_waitcnt lgkmcnt(6)
v_mfma_f32_16x16x32_bf16 v[68:71], v[172:175], v[204:207], v[68:71]
s_waitcnt lgkmcnt(5)
v_mfma_f32_16x16x32_bf16 v[72:75], v[172:175], v[208:211], v[72:75]
s_waitcnt lgkmcnt(4)
v_mfma_f32_16x16x32_bf16 v[76:79], v[172:175], v[212:215], v[76:79]
ds_read_b64_tr_b16 v[184:185], v28 offset:0
ds_read_b64_tr_b16 v[186:187], v28 offset:512
s_waitcnt lgkmcnt(4)
v_mfma_f32_16x16x32_bf16 v[80:83], v[176:179], v[204:207], v[80:83]
v_mfma_f32_16x16x32_bf16 v[84:87], v[176:179], v[208:211], v[84:87]
v_mfma_f32_16x16x32_bf16 v[88:91], v[176:179], v[212:215], v[88:91]
ds_read_b128 v[216:219], v31 offset:4096
s_waitcnt vmcnt(4)
ds_read_b64_tr_b16 v[188:189], v25 offset:4096
ds_read_b64_tr_b16 v[190:191], v25 offset:4608
s_waitcnt lgkmcnt(5)
v_mfma_f32_16x16x32_bf16 v[92:95], v[180:183], v[204:207], v[92:95]
ds_read_b128 v[220:223], v31 offset:12288
v_mfma_f32_16x16x32_bf16 v[96:99], v[180:183], v[208:211], v[96:99]
ds_read_b128 v[224:227], v31 offset:20480
v_mfma_f32_16x16x32_bf16 v[100:103], v[180:183], v[212:215], v[100:103]
ds_read_b64_tr_b16 v[192:193], v26 offset:4096
ds_read_b64_tr_b16 v[194:195], v26 offset:4608
s_waitcnt lgkmcnt(7)
v_mfma_f32_16x16x32_bf16 v[104:107], v[184:187], v[204:207], v[104:107]
s_add_u32 m0, s63, 0x0
s_nop 0
buffer_load_dwordx4 v17, s[44:47], s72 offen offset:0 lds
buffer_load_dwordx4 v18, s[44:47], s72 offen offset:1024 lds
buffer_load_dwordx4 v19, s[44:47], s72 offen offset:2048 lds
buffer_load_dwordx4 v20, s[44:47], s72 offen offset:3072 lds
v_mfma_f32_16x16x32_bf16 v[108:111], v[184:187], v[208:211], v[108:111]
v_mfma_f32_16x16x32_bf16 v[112:115], v[184:187], v[212:215], v[112:115]
ds_read_b64_tr_b16 v[196:197], v27 offset:4096
ds_read_b64_tr_b16 v[198:199], v27 offset:4608
s_waitcnt lgkmcnt(6)
v_mfma_f32_16x16x32_bf16 v[68:71], v[188:191], v[216:219], v[68:71]
s_waitcnt lgkmcnt(5)
v_mfma_f32_16x16x32_bf16 v[72:75], v[188:191], v[220:223], v[72:75]
s_waitcnt lgkmcnt(4)
v_mfma_f32_16x16x32_bf16 v[76:79], v[188:191], v[224:227], v[76:79]
ds_read_b64_tr_b16 v[200:201], v28 offset:4096
ds_read_b64_tr_b16 v[202:203], v28 offset:4608
s_waitcnt lgkmcnt(4)
v_mfma_f32_16x16x32_bf16 v[80:83], v[192:195], v[216:219], v[80:83]
v_mfma_f32_16x16x32_bf16 v[84:87], v[192:195], v[220:223], v[84:87]
v_mfma_f32_16x16x32_bf16 v[88:91], v[192:195], v[224:227], v[88:91]
ds_read_b128 v[228:231], v32 offset:5120
s_waitcnt vmcnt(4)
ds_read_b64_tr_b16 v[164:165], v25 offset:8192
ds_read_b64_tr_b16 v[166:167], v25 offset:8704
s_waitcnt lgkmcnt(5)
v_mfma_f32_16x16x32_bf16 v[92:95], v[196:199], v[216:219], v[92:95]
ds_read_b128 v[232:235], v32 offset:13312
v_mfma_f32_16x16x32_bf16 v[96:99], v[196:199], v[220:223], v[96:99]
ds_read_b128 v[236:239], v32 offset:21504
v_mfma_f32_16x16x32_bf16 v[100:103], v[196:199], v[224:227], v[100:103]
ds_read_b64_tr_b16 v[168:169], v26 offset:8192
ds_read_b64_tr_b16 v[170:171], v26 offset:8704
s_waitcnt lgkmcnt(7)
v_mfma_f32_16x16x32_bf16 v[104:107], v[200:203], v[216:219], v[104:107]
s_add_u32 m0, s63, 0x1000
s_nop 0
buffer_load_dwordx4 v17, s[44:47], s73 offen offset:0 lds
buffer_load_dwordx4 v18, s[44:47], s73 offen offset:1024 lds
buffer_load_dwordx4 v19, s[44:47], s73 offen offset:2048 lds
buffer_load_dwordx4 v20, s[44:47], s73 offen offset:3072 lds
v_mfma_f32_16x16x32_bf16 v[108:111], v[200:203], v[220:223], v[108:111]
v_mfma_f32_16x16x32_bf16 v[112:115], v[200:203], v[224:227], v[112:115]
ds_read_b64_tr_b16 v[172:173], v27 offset:8192
ds_read_b64_tr_b16 v[174:175], v27 offset:8704
s_waitcnt lgkmcnt(6)
v_mfma_f32_16x16x32_bf16 v[68:71], v[164:167], v[228:231], v[68:71]
s_waitcnt lgkmcnt(5)
v_mfma_f32_16x16x32_bf16 v[72:75], v[164:167], v[232:235], v[72:75]
s_waitcnt lgkmcnt(4)
v_mfma_f32_16x16x32_bf16 v[76:79], v[164:167], v[236:239], v[76:79]
ds_read_b64_tr_b16 v[176:177], v28 offset:8192
ds_read_b64_tr_b16 v[178:179], v28 offset:8704
s_waitcnt lgkmcnt(4)
v_mfma_f32_16x16x32_bf16 v[80:83], v[168:171], v[228:231], v[80:83]
v_mfma_f32_16x16x32_bf16 v[84:87], v[168:171], v[232:235], v[84:87]
v_mfma_f32_16x16x32_bf16 v[88:91], v[168:171], v[236:239], v[88:91]
ds_read_b128 v[204:207], v31 offset:6144
s_waitcnt vmcnt(4)
ds_read_b64_tr_b16 v[180:181], v25 offset:0
ds_read_b64_tr_b16 v[182:183], v25 offset:512
s_waitcnt lgkmcnt(5)
v_mfma_f32_16x16x32_bf16 v[92:95], v[172:175], v[228:231], v[92:95]
ds_read_b128 v[208:211], v31 offset:14336
v_mfma_f32_16x16x32_bf16 v[96:99], v[172:175], v[232:235], v[96:99]
ds_read_b128 v[212:215], v31 offset:22528
v_mfma_f32_16x16x32_bf16 v[100:103], v[172:175], v[236:239], v[100:103]
ds_read_b64_tr_b16 v[184:185], v26 offset:0
ds_read_b64_tr_b16 v[186:187], v26 offset:512
s_waitcnt lgkmcnt(7)
v_mfma_f32_16x16x32_bf16 v[104:107], v[176:179], v[228:231], v[104:107]
s_add_u32 m0, s63, 0x2000
s_nop 0
buffer_load_dwordx4 v21, s[48:51], s74 offen offset:0 lds
buffer_load_dwordx4 v22, s[48:51], s74 offen offset:1024 lds
buffer_load_dwordx4 v23, s[48:51], s74 offen offset:2048 lds
buffer_load_dwordx4 v24, s[48:51], s74 offen offset:3072 lds
v_mfma_f32_16x16x32_bf16 v[108:111], v[176:179], v[232:235], v[108:111]
v_mfma_f32_16x16x32_bf16 v[112:115], v[176:179], v[236:239], v[112:115]
ds_read_b64_tr_b16 v[188:189], v27 offset:0
ds_read_b64_tr_b16 v[190:191], v27 offset:512
s_waitcnt lgkmcnt(6)
v_mfma_f32_16x16x32_bf16 v[68:71], v[180:183], v[204:207], v[68:71]
s_waitcnt lgkmcnt(5)
v_mfma_f32_16x16x32_bf16 v[72:75], v[180:183], v[208:211], v[72:75]
s_waitcnt lgkmcnt(4)
v_mfma_f32_16x16x32_bf16 v[76:79], v[180:183], v[212:215], v[76:79]
ds_read_b64_tr_b16 v[192:193], v28 offset:0
ds_read_b64_tr_b16 v[194:195], v28 offset:512
s_waitcnt lgkmcnt(4)
v_mfma_f32_16x16x32_bf16 v[80:83], v[184:187], v[204:207], v[80:83]
v_mfma_f32_16x16x32_bf16 v[84:87], v[184:187], v[208:211], v[84:87]
v_mfma_f32_16x16x32_bf16 v[88:91], v[184:187], v[212:215], v[88:91]
ds_read_b128 v[216:219], v32 offset:7168
s_waitcnt vmcnt(4)
ds_read_b64_tr_b16 v[196:197], v25 offset:4096
ds_read_b64_tr_b16 v[198:199], v25 offset:4608
s_waitcnt lgkmcnt(5)
v_mfma_f32_16x16x32_bf16 v[92:95], v[188:191], v[204:207], v[92:95]
ds_read_b128 v[220:223], v32 offset:15360
v_mfma_f32_16x16x32_bf16 v[96:99], v[188:191], v[208:211], v[96:99]
ds_read_b128 v[224:227], v32 offset:23552
v_mfma_f32_16x16x32_bf16 v[100:103], v[188:191], v[212:215], v[100:103]
ds_read_b64_tr_b16 v[200:201], v26 offset:4096
ds_read_b64_tr_b16 v[202:203], v26 offset:4608
s_waitcnt lgkmcnt(7)
v_mfma_f32_16x16x32_bf16 v[104:107], v[192:195], v[204:207], v[104:107]
s_add_u32 m0, s63, 0x0
s_nop 0
buffer_load_dwordx4 v21, s[48:51], s75 offen offset:0 lds
buffer_load_dwordx4 v22, s[48:51], s75 offen offset:1024 lds
buffer_load_dwordx4 v23, s[48:51], s75 offen offset:2048 lds
buffer_load_dwordx4 v24, s[48:51], s75 offen offset:3072 lds
v_mfma_f32_16x16x32_bf16 v[108:111], v[192:195], v[208:211], v[108:111]
v_mfma_f32_16x16x32_bf16 v[112:115], v[192:195], v[212:215], v[112:115]
ds_read_b64_tr_b16 v[164:165], v27 offset:4096
ds_read_b64_tr_b16 v[166:167], v27 offset:4608
s_waitcnt lgkmcnt(6)
v_mfma_f32_16x16x32_bf16 v[68:71], v[196:199], v[216:219], v[68:71]
s_waitcnt lgkmcnt(5)
v_mfma_f32_16x16x32_bf16 v[72:75], v[196:199], v[220:223], v[72:75]
s_waitcnt lgkmcnt(4)
v_mfma_f32_16x16x32_bf16 v[76:79], v[196:199], v[224:227], v[76:79]
ds_read_b64_tr_b16 v[168:169], v28 offset:4096
ds_read_b64_tr_b16 v[170:171], v28 offset:4608
s_waitcnt lgkmcnt(4)
v_mfma_f32_16x16x32_bf16 v[80:83], v[200:203], v[216:219], v[80:83]
v_cvt_pk_bf16_f32 v68, v68, v69
v_cvt_pk_bf16_f32 v69, v70, v71
ds_write_b64 v33, v[68:69] offset:0
v_mfma_f32_16x16x32_bf16 v[84:87], v[200:203], v[220:223], v[84:87]
v_cvt_pk_bf16_f32 v72, v72, v73
v_cvt_pk_bf16_f32 v73, v74, v75
ds_write_b64 v33, v[72:73] offset:8192
v_mfma_f32_16x16x32_bf16 v[88:91], v[200:203], v[224:227], v[88:91]
v_cvt_pk_bf16_f32 v76, v76, v77
v_cvt_pk_bf16_f32 v77, v78, v79
ds_write_b64 v33, v[76:77] offset:16384
s_waitcnt lgkmcnt(5)
v_mfma_f32_16x16x32_bf16 v[92:95], v[164:167], v[216:219], v[92:95]
v_cvt_pk_bf16_f32 v80, v80, v81
v_cvt_pk_bf16_f32 v81, v82, v83
ds_write_b64 v33, v[80:81] offset:512
v_mfma_f32_16x16x32_bf16 v[96:99], v[164:167], v[220:223], v[96:99]
v_cvt_pk_bf16_f32 v84, v84, v85
v_cvt_pk_bf16_f32 v85, v86, v87
ds_write_b64 v33, v[84:85] offset:8704
v_mfma_f32_16x16x32_bf16 v[100:103], v[164:167], v[224:227], v[100:103]
v_cvt_pk_bf16_f32 v88, v88, v89
v_cvt_pk_bf16_f32 v89, v90, v91
ds_write_b64 v33, v[88:89] offset:16896
s_waitcnt lgkmcnt(6)
v_mfma_f32_16x16x32_bf16 v[104:107], v[168:171], v[216:219], v[104:107]
v_cvt_pk_bf16_f32 v92, v92, v93
v_cvt_pk_bf16_f32 v93, v94, v95
ds_write_b64 v34, v[92:93] offset:0
s_add_u32 m0, s63, 0x1000
s_nop 0
buffer_load_dwordx4 v21, s[48:51], s76 offen offset:0 lds
buffer_load_dwordx4 v22, s[48:51], s76 offen offset:1024 lds
buffer_load_dwordx4 v23, s[48:51], s76 offen offset:2048 lds
buffer_load_dwordx4 v24, s[48:51], s76 offen offset:3072 lds
v_mfma_f32_16x16x32_bf16 v[108:111], v[168:171], v[220:223], v[108:111]
v_cvt_pk_bf16_f32 v96, v96, v97
v_cvt_pk_bf16_f32 v97, v98, v99
ds_write_b64 v34, v[96:97] offset:8192
v_mfma_f32_16x16x32_bf16 v[112:115], v[168:171], v[224:227], v[112:115]
v_cvt_pk_bf16_f32 v100, v100, v101
v_cvt_pk_bf16_f32 v101, v102, v103
ds_write_b64 v34, v[100:101] offset:16384
v_cvt_pk_bf16_f32 v104, v104, v105
v_cvt_pk_bf16_f32 v105, v106, v107
ds_write_b64 v34, v[104:105] offset:512
v_cvt_pk_bf16_f32 v108, v108, v109
v_cvt_pk_bf16_f32 v109, v110, v111
ds_write_b64 v34, v[108:109] offset:8704
v_cvt_pk_bf16_f32 v112, v112, v113
v_cvt_pk_bf16_f32 v113, v114, v115
ds_write_b64 v34, v[112:113] offset:16896
s_waitcnt vmcnt(8)
ds_read_b128 v[172:175], v29 offset:8192
ds_read_b128 v[176:179], v30 offset:8192
ds_read_b128 v[180:183], v29 offset:10240
s_waitcnt lgkmcnt(3)
s_barrier
ds_read_b128 v[228:231], v35 offset:0
ds_read_b128 v[232:235], v35 offset:8192
ds_read_b128 v[236:239], v35 offset:16384
ds_read_b128 v[204:207], v35 offset:1024
ds_read_b128 v[208:211], v35 offset:9216
ds_read_b128 v[212:215], v35 offset:17408
s_waitcnt lgkmcnt(5)
v_mfma_f32_16x16x32_bf16 v[116:119], v[172:175], v[228:231], 0
s_waitcnt lgkmcnt(4)
v_mfma_f32_16x16x32_bf16 v[132:135], v[172:175], v[232:235], 0
s_waitcnt lgkmcnt(3)
v_mfma_f32_16x16x32_bf16 v[148:151], v[172:175], v[236:239], 0
ds_read_b128 v[184:187], v30 offset:10240
s_waitcnt lgkmcnt(3)
v_mfma_f32_16x16x32_bf16 v[116:119], v[176:179], v[204:207], v[116:119]
s_waitcnt lgkmcnt(2)
v_mfma_f32_16x16x32_bf16 v[132:135], v[176:179], v[208:211], v[132:135]
s_waitcnt lgkmcnt(1)
v_mfma_f32_16x16x32_bf16 v[148:151], v[176:179], v[212:215], v[148:151]
s_waitcnt vmcnt(4)
ds_read_b128 v[188:191], v29 offset:0
v_mfma_f32_16x16x32_bf16 v[120:123], v[180:183], v[228:231], 0
v_mfma_f32_16x16x32_bf16 v[136:139], v[180:183], v[232:235], 0
v_mfma_f32_16x16x32_bf16 v[152:155], v[180:183], v[236:239], 0
ds_read_b128 v[192:195], v30 offset:0
s_waitcnt lgkmcnt(2)
v_mfma_f32_16x16x32_bf16 v[120:123], v[184:187], v[204:207], v[120:123]
s_add_u32 m0, s63, 0x2000
s_nop 0
buffer_load_dwordx4 v21, s[48:51], s77 offen offset:0 lds
buffer_load_dwordx4 v22, s[48:51], s77 offen offset:1024 lds
buffer_load_dwordx4 v23, s[48:51], s77 offen offset:2048 lds
buffer_load_dwordx4 v24, s[48:51], s77 offen offset:3072 lds
v_mfma_f32_16x16x32_bf16 v[136:139], v[184:187], v[208:211], v[136:139]
v_mfma_f32_16x16x32_bf16 v[152:155], v[184:187], v[212:215], v[152:155]
ds_read_b128 v[196:199], v29 offset:2048
s_waitcnt lgkmcnt(2)
v_mfma_f32_16x16x32_bf16 v[124:127], v[188:191], v[228:231], 0
v_mfma_f32_16x16x32_bf16 v[140:143], v[188:191], v[232:235], 0
v_mfma_f32_16x16x32_bf16 v[156:159], v[188:191], v[236:239], 0
ds_read_b128 v[200:203], v30 offset:2048
s_waitcnt lgkmcnt(2)
v_mfma_f32_16x16x32_bf16 v[124:127], v[192:195], v[204:207], v[124:127]
v_mfma_f32_16x16x32_bf16 v[140:143], v[192:195], v[208:211], v[140:143]
v_mfma_f32_16x16x32_bf16 v[156:159], v[192:195], v[212:215], v[156:159]
ds_read_b128 v[216:219], v35 offset:2048
s_waitcnt vmcnt(4)
ds_read_b128 v[164:167], v29 offset:4096
s_waitcnt lgkmcnt(3)
v_mfma_f32_16x16x32_bf16 v[128:131], v[196:199], v[228:231], 0
ds_read_b128 v[220:223], v35 offset:10240
v_mfma_f32_16x16x32_bf16 v[144:147], v[196:199], v[232:235], 0
ds_read_b128 v[224:227], v35 offset:18432
v_mfma_f32_16x16x32_bf16 v[160:163], v[196:199], v[236:239], 0
ds_read_b128 v[228:231], v35 offset:3072
ds_read_b128 v[168:171], v30 offset:4096
s_waitcnt lgkmcnt(6)
v_mfma_f32_16x16x32_bf16 v[128:131], v[200:203], v[204:207], v[128:131]
ds_read_b128 v[232:235], v35 offset:11264
s_add_u32 m0, s63, 0x0
s_nop 0
buffer_load_dwordx4 v21, s[48:51], s78 offen offset:0 lds
buffer_load_dwordx4 v22, s[48:51], s78 offen offset:1024 lds
buffer_load_dwordx4 v23, s[48:51], s78 offen offset:2048 lds
buffer_load_dwordx4 v24, s[48:51], s78 offen offset:3072 lds
v_mfma_f32_16x16x32_bf16 v[144:147], v[200:203], v[208:211], v[144:147]
ds_read_b128 v[236:239], v35 offset:19456
v_mfma_f32_16x16x32_bf16 v[160:163], v[200:203], v[212:215], v[160:163]
ds_read_b128 v[172:175], v29 offset:6144
s_waitcnt lgkmcnt(7)
v_mfma_f32_16x16x32_bf16 v[116:119], v[164:167], v[216:219], v[116:119]
s_waitcnt lgkmcnt(6)
v_mfma_f32_16x16x32_bf16 v[132:135], v[164:167], v[220:223], v[132:135]
s_waitcnt lgkmcnt(5)
v_mfma_f32_16x16x32_bf16 v[148:151], v[164:167], v[224:227], v[148:151]
ds_read_b128 v[176:179], v30 offset:6144
s_waitcnt lgkmcnt(4)
v_mfma_f32_16x16x32_bf16 v[116:119], v[168:171], v[228:231], v[116:119]
s_waitcnt lgkmcnt(3)
v_mfma_f32_16x16x32_bf16 v[132:135], v[168:171], v[232:235], v[132:135]
s_waitcnt lgkmcnt(2)
v_mfma_f32_16x16x32_bf16 v[148:151], v[168:171], v[236:239], v[148:151]
s_waitcnt vmcnt(4)
ds_read_b128 v[180:183], v29 offset:8192
s_waitcnt lgkmcnt(2)
v_mfma_f32_16x16x32_bf16 v[120:123], v[172:175], v[216:219], v[120:123]
v_mfma_f32_16x16x32_bf16 v[136:139], v[172:175], v[220:223], v[136:139]
v_mfma_f32_16x16x32_bf16 v[152:155], v[172:175], v[224:227], v[152:155]
ds_read_b128 v[184:187], v30 offset:8192
s_waitcnt lgkmcnt(2)
v_mfma_f32_16x16x32_bf16 v[120:123], v[176:179], v[228:231], v[120:123]
s_add_u32 m0, s63, 0x1000
s_nop 0
buffer_load_dwordx4 v21, s[48:51], s79 offen offset:0 lds
buffer_load_dwordx4 v22, s[48:51], s79 offen offset:1024 lds
buffer_load_dwordx4 v23, s[48:51], s79 offen offset:2048 lds
buffer_load_dwordx4 v24, s[48:51], s79 offen offset:3072 lds
v_mfma_f32_16x16x32_bf16 v[136:139], v[176:179], v[232:235], v[136:139]
v_mfma_f32_16x16x32_bf16 v[152:155], v[176:179], v[236:239], v[152:155]
ds_read_b128 v[188:191], v29 offset:10240
s_waitcnt lgkmcnt(2)
v_mfma_f32_16x16x32_bf16 v[124:127], v[180:183], v[216:219], v[124:127]
v_mfma_f32_16x16x32_bf16 v[140:143], v[180:183], v[220:223], v[140:143]
v_mfma_f32_16x16x32_bf16 v[156:159], v[180:183], v[224:227], v[156:159]
ds_read_b128 v[192:195], v30 offset:10240
s_waitcnt lgkmcnt(2)
v_mfma_f32_16x16x32_bf16 v[124:127], v[184:187], v[228:231], v[124:127]
v_mfma_f32_16x16x32_bf16 v[140:143], v[184:187], v[232:235], v[140:143]
v_mfma_f32_16x16x32_bf16 v[156:159], v[184:187], v[236:239], v[156:159]
ds_read_b128 v[204:207], v35 offset:4096
s_waitcnt vmcnt(4)
ds_read_b128 v[196:199], v29 offset:0
s_waitcnt lgkmcnt(3)
v_mfma_f32_16x16x32_bf16 v[128:131], v[188:191], v[216:219], v[128:131]
ds_read_b128 v[208:211], v35 offset:12288
v_mfma_f32_16x16x32_bf16 v[144:147], v[188:191], v[220:223], v[144:147]
ds_read_b128 v[212:215], v35 offset:20480
v_mfma_f32_16x16x32_bf16 v[160:163], v[188:191], v[224:227], v[160:163]
ds_read_b128 v[216:219], v35 offset:5120
ds_read_b128 v[200:203], v30 offset:0
s_waitcnt lgkmcnt(6)
v_mfma_f32_16x16x32_bf16 v[128:131], v[192:195], v[228:231], v[128:131]
ds_read_b128 v[220:223], v35 offset:13312
s_add_u32 m0, s63, 0x2000
s_nop 0
buffer_load_dwordx4 v21, s[48:51], s80 offen offset:0 lds
buffer_load_dwordx4 v22, s[48:51], s80 offen offset:1024 lds
buffer_load_dwordx4 v23, s[48:51], s80 offen offset:2048 lds
buffer_load_dwordx4 v24, s[48:51], s80 offen offset:3072 lds
v_mfma_f32_16x16x32_bf16 v[144:147], v[192:195], v[232:235], v[144:147]
ds_read_b128 v[224:227], v35 offset:21504
v_mfma_f32_16x16x32_bf16 v[160:163], v[192:195], v[236:239], v[160:163]
ds_read_b128 v[164:167], v29 offset:2048
s_waitcnt lgkmcnt(7)
v_mfma_f32_16x16x32_bf16 v[116:119], v[196:199], v[204:207], v[116:119]
s_waitcnt lgkmcnt(6)
v_mfma_f32_16x16x32_bf16 v[132:135], v[196:199], v[208:211], v[132:135]
s_waitcnt lgkmcnt(5)
v_mfma_f32_16x16x32_bf16 v[148:151], v[196:199], v[212:215], v[148:151]
ds_read_b128 v[168:171], v30 offset:2048
s_waitcnt lgkmcnt(4)
v_mfma_f32_16x16x32_bf16 v[116:119], v[200:203], v[216:219], v[116:119]
s_waitcnt lgkmcnt(3)
v_mfma_f32_16x16x32_bf16 v[132:135], v[200:203], v[220:223], v[132:135]
s_waitcnt lgkmcnt(2)
v_mfma_f32_16x16x32_bf16 v[148:151], v[200:203], v[224:227], v[148:151]
s_waitcnt vmcnt(4)
ds_read_b128 v[172:175], v29 offset:4096
s_waitcnt lgkmcnt(2)
v_mfma_f32_16x16x32_bf16 v[120:123], v[164:167], v[204:207], v[120:123]
v_mfma_f32_16x16x32_bf16 v[136:139], v[164:167], v[208:211], v[136:139]
v_mfma_f32_16x16x32_bf16 v[152:155], v[164:167], v[212:215], v[152:155]
ds_read_b128 v[176:179], v30 offset:4096
s_waitcnt lgkmcnt(2)
v_mfma_f32_16x16x32_bf16 v[120:123], v[168:171], v[216:219], v[120:123]
s_add_u32 m0, s63, 0x0
s_nop 0
buffer_load_dwordx4 v21, s[48:51], s81 offen offset:0 lds
buffer_load_dwordx4 v22, s[48:51], s81 offen offset:1024 lds
buffer_load_dwordx4 v23, s[48:51], s81 offen offset:2048 lds
buffer_load_dwordx4 v24, s[48:51], s81 offen offset:3072 lds
v_mfma_f32_16x16x32_bf16 v[136:139], v[168:171], v[220:223], v[136:139]
buffer_store_dwordx4 v[44:47], v16, s[56:59], s64 offen offset:0 sc1
buffer_store_dwordx4 v[48:51], v16, s[56:59], s64 offen offset:1024 sc1
v_mfma_f32_16x16x32_bf16 v[152:155], v[168:171], v[224:227], v[152:155]
ds_read_b128 v[180:183], v29 offset:6144
buffer_store_dwordx4 v[52:55], v16, s[56:59], s64 offen offset:2048 sc1
s_waitcnt lgkmcnt(2)
v_mfma_f32_16x16x32_bf16 v[124:127], v[172:175], v[204:207], v[124:127]
buffer_store_dwordx4 v[56:59], v16, s[56:59], s64 offen offset:3072 sc1
buffer_store_dwordx4 v[60:63], v16, s[56:59], s65 offen offset:0 sc1
v_mfma_f32_16x16x32_bf16 v[140:143], v[172:175], v[208:211], v[140:143]
buffer_store_dwordx4 v[64:67], v16, s[56:59], s65 offen offset:1024 sc1
v_mfma_f32_16x16x32_bf16 v[156:159], v[172:175], v[212:215], v[156:159]
ds_read_b128 v[184:187], v30 offset:6144
s_waitcnt lgkmcnt(2)
v_mfma_f32_16x16x32_bf16 v[124:127], v[176:179], v[216:219], v[124:127]
v_mfma_f32_16x16x32_bf16 v[140:143], v[176:179], v[220:223], v[140:143]
v_mfma_f32_16x16x32_bf16 v[156:159], v[176:179], v[224:227], v[156:159]
ds_read_b128 v[228:231], v35 offset:6144
s_waitcnt vmcnt(10)
ds_read_b128 v[188:191], v29 offset:8192
s_waitcnt lgkmcnt(3)
v_mfma_f32_16x16x32_bf16 v[128:131], v[180:183], v[204:207], v[128:131]
ds_read_b128 v[232:235], v35 offset:14336
v_mfma_f32_16x16x32_bf16 v[144:147], v[180:183], v[208:211], v[144:147]
ds_read_b128 v[236:239], v35 offset:22528
v_mfma_f32_16x16x32_bf16 v[160:163], v[180:183], v[212:215], v[160:163]
ds_read_b128 v[204:207], v35 offset:7168
ds_read_b128 v[192:195], v30 offset:8192
s_waitcnt lgkmcnt(6)
v_mfma_f32_16x16x32_bf16 v[128:131], v[184:187], v[216:219], v[128:131]
ds_read_b128 v[208:211], v35 offset:15360
v_mfma_f32_16x16x32_bf16 v[144:147], v[184:187], v[220:223], v[144:147]
ds_read_b128 v[212:215], v35 offset:23552
v_mfma_f32_16x16x32_bf16 v[160:163], v[184:187], v[224:227], v[160:163]
ds_read_b128 v[196:199], v29 offset:10240
s_waitcnt lgkmcnt(7)
v_mfma_f32_16x16x32_bf16 v[116:119], v[188:191], v[228:231], v[116:119]
s_waitcnt lgkmcnt(6)
v_mfma_f32_16x16x32_bf16 v[132:135], v[188:191], v[232:235], v[132:135]
s_waitcnt lgkmcnt(5)
v_mfma_f32_16x16x32_bf16 v[148:151], v[188:191], v[236:239], v[148:151]
ds_read_b128 v[200:203], v30 offset:10240
s_waitcnt lgkmcnt(4)
v_mfma_f32_16x16x32_bf16 v[116:119], v[192:195], v[204:207], v[116:119]
s_waitcnt lgkmcnt(3)
v_mfma_f32_16x16x32_bf16 v[132:135], v[192:195], v[208:211], v[132:135]
s_waitcnt lgkmcnt(2)
v_mfma_f32_16x16x32_bf16 v[148:151], v[192:195], v[212:215], v[148:151]
s_waitcnt vmcnt(6)
ds_read_b128 v[164:167], v29 offset:0
s_waitcnt lgkmcnt(2)
v_mfma_f32_16x16x32_bf16 v[120:123], v[196:199], v[228:231], v[120:123]
v_mfma_f32_16x16x32_bf16 v[136:139], v[196:199], v[232:235], v[136:139]
v_mfma_f32_16x16x32_bf16 v[152:155], v[196:199], v[236:239], v[152:155]
ds_read_b128 v[168:171], v30 offset:0
s_waitcnt lgkmcnt(2)
v_mfma_f32_16x16x32_bf16 v[120:123], v[200:203], v[204:207], v[120:123]
v_mfma_f32_16x16x32_bf16 v[136:139], v[200:203], v[208:211], v[136:139]
v_mfma_f32_16x16x32_bf16 v[152:155], v[200:203], v[212:215], v[152:155]
ds_read_b128 v[172:175], v29 offset:2048
s_waitcnt lgkmcnt(2)
v_mfma_f32_16x16x32_bf16 v[124:127], v[164:167], v[228:231], v[124:127]
v_mul_f32 v116, s86, v116
v_mul_f32 v117, s86, v117
v_mul_f32 v118, s86, v118
v_mul_f32 v119, s86, v119
v_mul_f32 v120, s86, v120
v_mul_f32 v121, s86, v121
v_mul_f32 v122, s86, v122
v_mul_f32 v123, s86, v123
v_cvt_pk_bf16_f32 v116, v116, v117
v_cvt_pk_bf16_f32 v117, v118, v119
v_cvt_pk_bf16_f32 v118, v120, v121
v_cvt_pk_bf16_f32 v119, v122, v123
buffer_store_dwordx4 v[116:119], v16, s[52:55], s82 offen offset:0 sc1
v_mfma_f32_16x16x32_bf16 v[140:143], v[164:167], v[232:235], v[140:143]
v_mul_f32 v132, s86, v132
v_mul_f32 v133, s86, v133
v_mul_f32 v134, s86, v134
v_mul_f32 v135, s86, v135
v_mul_f32 v136, s86, v136
v_mul_f32 v137, s86, v137
v_mul_f32 v138, s86, v138
v_mul_f32 v139, s86, v139
v_cvt_pk_bf16_f32 v132, v132, v133
v_cvt_pk_bf16_f32 v133, v134, v135
v_cvt_pk_bf16_f32 v134, v136, v137
v_cvt_pk_bf16_f32 v135, v138, v139
buffer_store_dwordx4 v[132:135], v16, s[52:55], s83 offen offset:0 sc1
v_mfma_f32_16x16x32_bf16 v[156:159], v[164:167], v[236:239], v[156:159]
ds_read_b128 v[176:179], v30 offset:2048
v_mul_f32 v148, s86, v148
v_mul_f32 v149, s86, v149
v_mul_f32 v150, s86, v150
v_mul_f32 v151, s86, v151
v_mul_f32 v152, s86, v152
v_mul_f32 v153, s86, v153
v_mul_f32 v154, s86, v154
v_mul_f32 v155, s86, v155
v_cvt_pk_bf16_f32 v148, v148, v149
v_cvt_pk_bf16_f32 v149, v150, v151
v_cvt_pk_bf16_f32 v150, v152, v153
v_cvt_pk_bf16_f32 v151, v154, v155
buffer_store_dwordx4 v[148:151], v16, s[52:55], s84 offen offset:0 sc1
s_waitcnt lgkmcnt(2)
v_mfma_f32_16x16x32_bf16 v[124:127], v[168:171], v[204:207], v[124:127]
v_mfma_f32_16x16x32_bf16 v[140:143], v[168:171], v[208:211], v[140:143]
v_mfma_f32_16x16x32_bf16 v[156:159], v[168:171], v[212:215], v[156:159]
s_waitcnt lgkmcnt(1)
v_mfma_f32_16x16x32_bf16 v[128:131], v[172:175], v[228:231], v[128:131]
v_mfma_f32_16x16x32_bf16 v[144:147], v[172:175], v[232:235], v[144:147]
v_mfma_f32_16x16x32_bf16 v[160:163], v[172:175], v[236:239], v[160:163]
s_waitcnt lgkmcnt(0)
v_mfma_f32_16x16x32_bf16 v[128:131], v[176:179], v[204:207], v[128:131]
v_mfma_f32_16x16x32_bf16 v[144:147], v[176:179], v[208:211], v[144:147]
v_mfma_f32_16x16x32_bf16 v[160:163], v[176:179], v[212:215], v[160:163]
v_mul_f32 v124, s86, v124
v_mul_f32 v125, s86, v125
v_mul_f32 v126, s86, v126
v_mul_f32 v127, s86, v127
s_nop 1
v_mul_f32 v128, s86, v128
v_mul_f32 v129, s86, v129
v_mul_f32 v130, s86, v130
v_mul_f32 v131, s86, v131
v_cvt_pk_bf16_f32 v124, v124, v125
v_cvt_pk_bf16_f32 v125, v126, v127
v_cvt_pk_bf16_f32 v126, v128, v129
v_cvt_pk_bf16_f32 v127, v130, v131
buffer_store_dwordx4 v[124:127], v16, s[52:55], s82 offen offset:1024 sc1
v_mul_f32 v140, s86, v140
v_mul_f32 v141, s86, v141
v_mul_f32 v142, s86, v142
v_mul_f32 v143, s86, v143
v_mul_f32 v144, s86, v144
v_mul_f32 v145, s86, v145
v_mul_f32 v146, s86, v146
v_mul_f32 v147, s86, v147
v_cvt_pk_bf16_f32 v140, v140, v141
v_cvt_pk_bf16_f32 v141, v142, v143
v_cvt_pk_bf16_f32 v142, v144, v145
v_cvt_pk_bf16_f32 v143, v146, v147
buffer_store_dwordx4 v[140:143], v16, s[52:55], s83 offen offset:1024 sc1
v_mul_f32 v156, s86, v156
v_mul_f32 v157, s86, v157
v_mul_f32 v158, s86, v158
v_mul_f32 v159, s86, v159
v_mul_f32 v160, s86, v160
v_mul_f32 v161, s86, v161
v_mul_f32 v162, s86, v162
v_mul_f32 v163, s86, v163
v_cvt_pk_bf16_f32 v156, v156, v157
v_cvt_pk_bf16_f32 v157, v158, v159
v_cvt_pk_bf16_f32 v158, v160, v161
v_cvt_pk_bf16_f32 v159, v162, v163
buffer_store_dwordx4 v[156:159], v16, s[52:55], s84 offen offset:1024 sc1
L1_fin:
s_add_u32 s91, s91, 1344
s_waitcnt lgkmcnt(0)
s_add_u32 s98, s98, 0x7f4a7c15
s_addc_u32 s99, s99, 0x9e3779b9
LM_pub:
s_add_u32 s40, s38, 0x7c00000
s_addc_u32 s41, s39, 0
s_mov_b32 s42, 0x40000
s_mov_b32 s43, 0x00020000
s_lshl_b32 s6, s91, 7
s_cmp_eq_u32 s60, 0
s_cselect_b32 s6, s6, 0x70000000
s_waitcnt vmcnt(0) lgkmcnt(0)
s_barrier
v_mov_b32 v6, s98
v_mov_b32 v7, s99
s_mov_b64 exec, 1
buffer_store_dwordx2 v[6:7], off, s[40:43], s6 sc1
s_mov_b64 exec, -1
s_cmp_eq_u32 s61, 0
s_cbranch_scc1 L2_entry
s_mov_b32 s61, 0
s_sub_u32 s4, s91, 1578
s_min_u32 s6, s4, 14
s_cmp_lt_u32 s4, 6
s_cselect_b32 s6, 0, s6
s_sub_u32 s4, s4, s6
s_add_u32 s91, s4, 1600
v_lshlrev_b32 v16, 4, v2
s_mul_i32 s63, s60, 12288
s_and_b32 s6, s4, 3
s_lshl_b32 s6, s6, 6
s_mul_i32 s7, s60, 16
s_add_u32 s6, s6, s7
v_lshrrev_b32 v5, 5, v2
v_and_b32 v6, 31, v2
v_lshlrev_b32 v6, 4, v6
s_cmp_ge_u32 s4, 4
s_cselect_b64 vcc, -1, 0
v_add3_u32 v7, v5, s6, 0
v_and_b32 v8, 0x80, v7
v_bfe_u32 v9, v7, 2, 1
v_lshl_or_b32 v8, v9, 6, v8
v_bfe_u32 v9, v7, 4, 1
v_lshl_or_b32 v8, v9, 5, v8
v_and_b32 v9, 3, v7
v_lshl_or_b32 v8, v9, 3, v8
v_bfe_u32 v9, v7, 5, 2
v_lshl_or_b32 v8, v9, 1, v8
v_bfe_u32 v9, v7, 3, 1
v_or_b32 v8, v9, v8
v_cndmask_b32 v8, v8, v7, vcc
v_lshl_add_u32 v44, v8, 9, v6
v_add3_u32 v7, v5, s6, 2
v_and_b32 v8, 0x80, v7
v_bfe_u32 v9, v7, 2, 1
v_lshl_or_b32 v8, v9, 6, v8
v_bfe_u32 v9, v7, 4, 1
v_lshl_or_b32 v8, v9, 5, v8
v_and_b32 v9, 3, v7
v_lshl_or_b32 v8, v9, 3, v8
v_bfe_u32 v9, v7, 5, 2
v_lshl_or_b32 v8, v9, 1, v8
v_bfe_u32 v9, v7, 3, 1
v_or_b32 v8, v9, v8
v_cndmask_b32 v8, v8, v7, vcc
v_lshl_add_u32 v48, v8, 9, v6
v_add3_u32 v7, v5, s6, 4
v_and_b32 v8, 0x80, v7
v_bfe_u32 v9, v7, 2, 1
v_lshl_or_b32 v8, v9, 6, v8
v_bfe_u32 v9, v7, 4, 1
v_lshl_or_b32 v8, v9, 5, v8
v_and_b32 v9, 3, v7
v_lshl_or_b32 v8, v9, 3, v8
v_bfe_u32 v9, v7, 5, 2
v_lshl_or_b32 v8, v9, 1, v8
v_bfe_u32 v9, v7, 3, 1
v_or_b32 v8, v9, v8
v_cndmask_b32 v8, v8, v7, vcc
v_lshl_add_u32 v52, v8, 9, v6
v_add3_u32 v7, v5, s6, 6
v_and_b32 v8, 0x80, v7
v_bfe_u32 v9, v7, 2, 1
v_lshl_or_b32 v8, v9, 6, v8
v_bfe_u32 v9, v7, 4, 1
v_lshl_or_b32 v8, v9, 5, v8
v_and_b32 v9, 3, v7
v_lshl_or_b32 v8, v9, 3, v8
v_bfe_u32 v9, v7, 5, 2
v_lshl_or_b32 v8, v9, 1, v8
v_bfe_u32 v9, v7, 3, 1
v_or_b32 v8, v9, v8
v_cndmask_b32 v8, v8, v7, vcc
v_lshl_add_u32 v56, v8, 9, v6
v_add3_u32 v7, v5, s6, 8
v_and_b32 v8, 0x80, v7
v_bfe_u32 v9, v7, 2, 1
v_lshl_or_b32 v8, v9, 6, v8
v_bfe_u32 v9, v7, 4, 1
v_lshl_or_b32 v8, v9, 5, v8
v_and_b32 v9, 3, v7
v_lshl_or_b32 v8, v9, 3, v8
v_bfe_u32 v9, v7, 5, 2
v_lshl_or_b32 v8, v9, 1, v8
v_bfe_u32 v9, v7, 3, 1
v_or_b32 v8, v9, v8
v_cndmask_b32 v8, v8, v7, vcc
v_lshl_add_u32 v60, v8, 9, v6
v_add3_u32 v7, v5, s6, 10
v_and_b32 v8, 0x80, v7
v_bfe_u32 v9, v7, 2, 1
v_lshl_or_b32 v8, v9, 6, v8
v_bfe_u32 v9, v7, 4, 1
v_lshl_or_b32 v8, v9, 5, v8
v_and_b32 v9, 3, v7
v_lshl_or_b32 v8, v9, 3, v8
v_bfe_u32 v9, v7, 5, 2
v_lshl_or_b32 v8, v9, 1, v8
v_bfe_u32 v9, v7, 3, 1
v_or_b32 v8, v9, v8
v_cndmask_b32 v8, v8, v7, vcc
v_lshl_add_u32 v64, v8, 9, v6
v_add3_u32 v7, v5, s6, 12
v_and_b32 v8, 0x80, v7
v_bfe_u32 v9, v7, 2, 1
v_lshl_or_b32 v8, v9, 6, v8
v_bfe_u32 v9, v7, 4, 1
v_lshl_or_b32 v8, v9, 5, v8
v_and_b32 v9, 3, v7
v_lshl_or_b32 v8, v9, 3, v8
v_bfe_u32 v9, v7, 5, 2
v_lshl_or_b32 v8, v9, 1, v8
v_bfe_u32 v9, v7, 3, 1
v_or_b32 v8, v9, v8
v_cndmask_b32 v8, v8, v7, vcc
v_lshl_add_u32 v68, v8, 9, v6
v_add3_u32 v7, v5, s6, 14
v_and_b32 v8, 0x80, v7
v_bfe_u32 v9, v7, 2, 1
v_lshl_or_b32 v8, v9, 6, v8
v_bfe_u32 v9, v7, 4, 1
v_lshl_or_b32 v8, v9, 5, v8
v_and_b32 v9, 3, v7
v_lshl_or_b32 v8, v9, 3, v8
v_bfe_u32 v9, v7, 5, 2
v_lshl_or_b32 v8, v9, 1, v8
v_bfe_u32 v9, v7, 3, 1
v_or_b32 v8, v9, v8
v_cndmask_b32 v8, v8, v7, vcc
v_lshl_add_u32 v72, v8, 9, v6
s_lshl_b32 s7, s60, 7
v_lshrrev_b32 v5, 3, v2
v_and_b32 v6, 7, v2
v_and_b32 v7, 2, v5
v_xor_b32 v6, v6, v7
v_lshl_add_u32 v5, v5, 9, s7
v_lshl_add_u32 v17, v6, 4, v5
v_xor_b32 v6, 4, v6
v_lshl_add_u32 v18, v6, 4, v5
v_add_u32 v18, 0xc00, v18
v_add_u32 v19, 0x1800, v17
v_add_u32 v20, 0x1800, v18
s_xor_b32 s6, s62, 0
s_lshl_b32 s66, s6, 14
s_xor_b32 s6, s62, 1
s_lshl_b32 s67, s6, 14
s_xor_b32 s6, s62, 2
s_lshl_b32 s68, s6, 14
s_xor_b32 s6, s62, 3
s_lshl_b32 s69, s6, 14
s_xor_b32 s6, s62, 4
s_lshl_b32 s70, s6, 14
s_xor_b32 s6, s62, 5
s_lshl_b32 s71, s6, 14
s_xor_b32 s6, s62, 6
s_lshl_b32 s72, s6, 14
s_xor_b32 s6, s62, 7
s_lshl_b32 s73, s6, 14
s_waitcnt lgkmcnt(0)
s_cmp_ge_u32 s4, 4
s_cselect_b32 s6, s30, s24
s_cselect_b32 s7, s31, s25
s_add_u32 s40, s6, 0x0
s_addc_u32 s41, s7, 0
s_mov_b32 s42, 0x20000
s_mov_b32 s43, 0x00020000
s_add_u32 s44, s32, 0x0
s_addc_u32 s45, s33, 0
s_mov_b32 s46, 0x20000
s_mov_b32 s47, 0x00020000
buffer_load_dwordx4 v[44:47], v44, s[40:43], 0 offen
buffer_load_dwordx4 v[48:51], v48, s[40:43], 0 offen
buffer_load_dwordx4 v[52:55], v52, s[40:43], 0 offen
buffer_load_dwordx4 v[56:59], v56, s[40:43], 0 offen
buffer_load_dwordx4 v[60:63], v60, s[40:43], 0 offen
buffer_load_dwordx4 v[64:67], v64, s[40:43], 0 offen
buffer_load_dwordx4 v[68:71], v68, s[40:43], 0 offen
buffer_load_dwordx4 v[72:75], v72, s[40:43], 0 offen
s_add_u32 m0, s63, 0x0
s_nop 0
buffer_load_dwordx4 v17, s[44:47], s66 offen offset:0 lds
buffer_load_dwordx4 v18, s[44:47], s66 offen offset:1024 lds
buffer_load_dwordx4 v19, s[44:47], s66 offen offset:2048 lds
buffer_load_dwordx4 v20, s[44:47], s66 offen offset:3072 lds
s_add_u32 m0, s63, 0x1000
s_nop 0
buffer_load_dwordx4 v17, s[44:47], s67 offen offset:0 lds
buffer_load_dwordx4 v18, s[44:47], s67 offen offset:1024 lds
buffer_load_dwordx4 v19, s[44:47], s67 offen offset:2048 lds
buffer_load_dwordx4 v20, s[44:47], s67 offen offset:3072 lds
v_bfe_u32 v5, v2, 2, 3
v_xor_b32 v5, s62, v5
v_and_b32 v6, 3, v2
v_lshlrev_b32 v7, 10, v5
v_lshl_add_u32 v7, v6, 8, v7
v_add_u32 v7, 0xc000, v7
v_and_b32 v5, 1, v5
v_lshl_or_b32 v6, v5, 2, v6
v_lshrrev_b32 v5, 5, v2
s_mul_i32 s6, s60, 16
v_add3_u32 v8, v5, s6, 0
v_lshrrev_b32 v9, 4, v8
v_lshl_add_u32 v9, v9, 13, v7
v_and_b32 v8, 15, v8
v_xor_b32 v8, v8, v6
v_lshl_add_u32 v36, v8, 4, v9
v_add3_u32 v8, v5, s6, 2
v_lshrrev_b32 v9, 4, v8
v_lshl_add_u32 v9, v9, 13, v7
v_and_b32 v8, 15, v8
v_xor_b32 v8, v8, v6
v_lshl_add_u32 v37, v8, 4, v9
v_add3_u32 v8, v5, s6, 4
v_lshrrev_b32 v9, 4, v8
v_lshl_add_u32 v9, v9, 13, v7
v_and_b32 v8, 15, v8
v_xor_b32 v8, v8, v6
v_lshl_add_u32 v38, v8, 4, v9
v_add3_u32 v8, v5, s6, 6
v_lshrrev_b32 v9, 4, v8
v_lshl_add_u32 v9, v9, 13, v7
v_and_b32 v8, 15, v8
v_xor_b32 v8, v8, v6
v_lshl_add_u32 v39, v8, 4, v9
v_add3_u32 v8, v5, s6, 8
v_lshrrev_b32 v9, 4, v8
v_lshl_add_u32 v9, v9, 13, v7
v_and_b32 v8, 15, v8
v_xor_b32 v8, v8, v6
v_lshl_add_u32 v40, v8, 4, v9
v_add3_u32 v8, v5, s6, 10
v_lshrrev_b32 v9, 4, v8
v_lshl_add_u32 v9, v9, 13, v7
v_and_b32 v8, 15, v8
v_xor_b32 v8, v8, v6
v_lshl_add_u32 v41, v8, 4, v9
v_add3_u32 v8, v5, s6, 12
v_lshrrev_b32 v9, 4, v8
v_lshl_add_u32 v9, v9, 13, v7
v_and_b32 v8, 15, v8
v_xor_b32 v8, v8, v6
v_lshl_add_u32 v42, v8, 4, v9
v_add3_u32 v8, v5, s6, 14
v_lshrrev_b32 v9, 4, v8
v_lshl_add_u32 v9, v9, 13, v7
v_and_b32 v8, 15, v8
v_xor_b32 v8, v8, v6
v_lshl_add_u32 v43, v8, 4, v9
v_xor_b32 v5, v3, v4
v_lshlrev_b32 v5, 4, v5
v_lshl_add_u32 v5, v4, 8, v5
v_add_u32 v31, 0xc000, v5
v_xor_b32 v32, 64, v31
v_lshrrev_b32 v5, 2, v3
v_and_b32 v6, 3, v3
v_and_b32 v7, 1, v4
v_lshlrev_b32 v7, 2, v7
v_and_b32 v8, 2, v5
v_or_b32 v7, v7, v8
v_lshl_add_u32 v8, v4, 3, v5
v_lshlrev_b32 v8, 7, v8
v_add_u32 v8, s63, v8
v_xor_b32 v6, v6, v7
v_xor_b32 v9, 0, v6
v_lshl_add_u32 v25, v9, 4, v8
v_add_u32 v26, 8, v25
v_xor_b32 v9, 4, v6
v_lshl_add_u32 v27, v9, 4, v8
v_add_u32 v28, 8, v27
s_lshr_b32 s6, s4, 2
s_lshl_b32 s6, s6, 17
s_and_b32 s7, s4, 3
s_lshl_b32 s7, s7, 12
s_add_u32 s6, s6, s7
s_mul_i32 s7, s60, 32768
s_add_u32 s82, s6, s7
s_add_u32 s83, s82, 16384
s_add_u32 s52, s38, 0x1000000
s_addc_u32 s53, s39, 0
s_mov_b32 s54, 0x40000
s_mov_b32 s55, 0x00020000
s_waitcnt vmcnt(15)
ds_write_b128 v36, v[44:47]
s_waitcnt vmcnt(14)
ds_write_b128 v37, v[48:51]
s_waitcnt vmcnt(13)
ds_write_b128 v38, v[52:55]
s_waitcnt vmcnt(12)
ds_write_b128 v39, v[56:59]
s_waitcnt vmcnt(11)
ds_write_b128 v40, v[60:63]
s_waitcnt vmcnt(10)
ds_write_b128 v41, v[64:67]
s_waitcnt vmcnt(9)
ds_write_b128 v42, v[68:71]
s_waitcnt vmcnt(8)
ds_write_b128 v43, v[72:75]
s_add_u32 m0, s63, 0x2000
s_nop 0
buffer_load_dwordx4 v17, s[44:47], s68 offen offset:0 lds
buffer_load_dwordx4 v18, s[44:47], s68 offen offset:1024 lds
buffer_load_dwordx4 v19, s[44:47], s68 offen offset:2048 lds
buffer_load_dwordx4 v20, s[44:47], s68 offen offset:3072 lds
s_waitcnt vmcnt(8)
ds_read_b64_tr_b16 v[140:141], v25 offset:0
ds_read_b64_tr_b16 v[142:143], v25 offset:512
ds_read_b64_tr_b16 v[144:145], v26 offset:0
ds_read_b64_tr_b16 v[146:147], v26 offset:512
ds_read_b64_tr_b16 v[148:149], v27 offset:0
ds_read_b64_tr_b16 v[150:151], v27 offset:512
s_waitcnt lgkmcnt(6)
s_barrier
ds_read_b128 v[180:183], v31 offset:0
ds_read_b128 v[184:187], v31 offset:8192
ds_read_b128 v[188:191], v31 offset:16384
ds_read_b128 v[192:195], v31 offset:24576
s_waitcnt lgkmcnt(3)
v_mfma_f32_16x16x32_bf16 v[76:79], v[180:183], v[140:143], 0
s_waitcnt lgkmcnt(2)
v_mfma_f32_16x16x32_bf16 v[80:83], v[184:187], v[140:143], 0
s_waitcnt lgkmcnt(1)
v_mfma_f32_16x16x32_bf16 v[84:87], v[188:191], v[140:143], 0
s_waitcnt lgkmcnt(0)
v_mfma_f32_16x16x32_bf16 v[88:91], v[192:195], v[140:143], 0
ds_read_b64_tr_b16 v[152:153], v28 offset:0
ds_read_b64_tr_b16 v[154:155], v28 offset:512
v_mfma_f32_16x16x32_bf16 v[92:95], v[180:183], v[144:147], 0
v_mfma_f32_16x16x32_bf16 v[96:99], v[184:187], v[144:147], 0
v_mfma_f32_16x16x32_bf16 v[100:103], v[188:191], v[144:147], 0
v_mfma_f32_16x16x32_bf16 v[104:107], v[192:195], v[144:147], 0
ds_read_b128 v[196:199], v32 offset:1024
s_waitcnt vmcnt(4)
ds_read_b64_tr_b16 v[156:157], v25 offset:4096
ds_read_b64_tr_b16 v[158:159], v25 offset:4608
v_mfma_f32_16x16x32_bf16 v[108:111], v[180:183], v[148:151], 0
ds_read_b128 v[200:203], v32 offset:9216
v_mfma_f32_16x16x32_bf16 v[112:115], v[184:187], v[148:151], 0
ds_read_b128 v[204:207], v32 offset:17408
v_mfma_f32_16x16x32_bf16 v[116:119], v[188:191], v[148:151], 0
ds_read_b128 v[208:211], v32 offset:25600
v_mfma_f32_16x16x32_bf16 v[120:123], v[192:195], v[148:151], 0
ds_read_b64_tr_b16 v[160:161], v26 offset:4096
ds_read_b64_tr_b16 v[162:163], v26 offset:4608
s_waitcnt lgkmcnt(8)
v_mfma_f32_16x16x32_bf16 v[124:127], v[180:183], v[152:155], 0
s_add_u32 m0, s63, 0x0
s_nop 0
buffer_load_dwordx4 v17, s[44:47], s69 offen offset:0 lds
buffer_load_dwordx4 v18, s[44:47], s69 offen offset:1024 lds
buffer_load_dwordx4 v19, s[44:47], s69 offen offset:2048 lds
buffer_load_dwordx4 v20, s[44:47], s69 offen offset:3072 lds
v_mfma_f32_16x16x32_bf16 v[128:131], v[184:187], v[152:155], 0
v_mfma_f32_16x16x32_bf16 v[132:135], v[188:191], v[152:155], 0
v_mfma_f32_16x16x32_bf16 v[136:139], v[192:195], v[152:155], 0
ds_read_b64_tr_b16 v[164:165], v27 offset:4096
ds_read_b64_tr_b16 v[166:167], v27 offset:4608
s_waitcnt lgkmcnt(7)
v_mfma_f32_16x16x32_bf16 v[76:79], v[196:199], v[156:159], v[76:79]
s_waitcnt lgkmcnt(6)
v_mfma_f32_16x16x32_bf16 v[80:83], v[200:203], v[156:159], v[80:83]
s_waitcnt lgkmcnt(5)
v_mfma_f32_16x16x32_bf16 v[84:87], v[204:207], v[156:159], v[84:87]
s_waitcnt lgkmcnt(4)
v_mfma_f32_16x16x32_bf16 v[88:91], v[208:211], v[156:159], v[88:91]
ds_read_b64_tr_b16 v[168:169], v28 offset:4096
ds_read_b64_tr_b16 v[170:171], v28 offset:4608
s_waitcnt lgkmcnt(4)
v_mfma_f32_16x16x32_bf16 v[92:95], v[196:199], v[160:163], v[92:95]
v_mfma_f32_16x16x32_bf16 v[96:99], v[200:203], v[160:163], v[96:99]
v_mfma_f32_16x16x32_bf16 v[100:103], v[204:207], v[160:163], v[100:103]
v_mfma_f32_16x16x32_bf16 v[104:107], v[208:211], v[160:163], v[104:107]
ds_read_b128 v[212:215], v31 offset:2048
s_waitcnt vmcnt(4)
ds_read_b64_tr_b16 v[172:173], v25 offset:8192
ds_read_b64_tr_b16 v[174:175], v25 offset:8704
s_waitcnt lgkmcnt(5)
v_mfma_f32_16x16x32_bf16 v[108:111], v[196:199], v[164:167], v[108:111]
ds_read_b128 v[216:219], v31 offset:10240
v_mfma_f32_16x16x32_bf16 v[112:115], v[200:203], v[164:167], v[112:115]
ds_read_b128 v[220:223], v31 offset:18432
v_mfma_f32_16x16x32_bf16 v[116:119], v[204:207], v[164:167], v[116:119]
ds_read_b128 v[224:227], v31 offset:26624
v_mfma_f32_16x16x32_bf16 v[120:123], v[208:211], v[164:167], v[120:123]
ds_read_b64_tr_b16 v[176:177], v26 offset:8192
ds_read_b64_tr_b16 v[178:179], v26 offset:8704
s_waitcnt lgkmcnt(8)
v_mfma_f32_16x16x32_bf16 v[124:127], v[196:199], v[168:171], v[124:127]
s_add_u32 m0, s63, 0x1000
s_nop 0
buffer_load_dwordx4 v17, s[44:47], s70 offen offset:0 lds
buffer_load_dwordx4 v18, s[44:47], s70 offen offset:1024 lds
buffer_load_dwordx4 v19, s[44:47], s70 offen offset:2048 lds
buffer_load_dwordx4 v20, s[44:47], s70 offen offset:3072 lds
v_mfma_f32_16x16x32_bf16 v[128:131], v[200:203], v[168:171], v[128:131]
v_mfma_f32_16x16x32_bf16 v[132:135], v[204:207], v[168:171], v[132:135]
v_mfma_f32_16x16x32_bf16 v[136:139], v[208:211], v[168:171], v[136:139]
ds_read_b64_tr_b16 v[140:141], v27 offset:8192
ds_read_b64_tr_b16 v[142:143], v27 offset:8704
s_waitcnt lgkmcnt(7)
v_mfma_f32_16x16x32_bf16 v[76:79], v[212:215], v[172:175], v[76:79]
s_waitcnt lgkmcnt(6)
v_mfma_f32_16x16x32_bf16 v[80:83], v[216:219], v[172:175], v[80:83]
s_waitcnt lgkmcnt(5)
v_mfma_f32_16x16x32_bf16 v[84:87], v[220:223], v[172:175], v[84:87]
s_waitcnt lgkmcnt(4)
v_mfma_f32_16x16x32_bf16 v[88:91], v[224:227], v[172:175], v[88:91]
ds_read_b64_tr_b16 v[144:145], v28 offset:8192
ds_read_b64_tr_b16 v[146:147], v28 offset:8704
s_waitcnt lgkmcnt(4)
v_mfma_f32_16x16x32_bf16 v[92:95], v[212:215], v[176:179], v[92:95]
v_mfma_f32_16x16x32_bf16 v[96:99], v[216:219], v[176:179], v[96:99]
v_mfma_f32_16x16x32_bf16 v[100:103], v[220:223], v[176:179], v[100:103]
v_mfma_f32_16x16x32_bf16 v[104:107], v[224:227], v[176:179], v[104:107]
ds_read_b128 v[180:183], v32 offset:3072
s_waitcnt vmcnt(4)
ds_read_b64_tr_b16 v[148:149], v25 offset:0
ds_read_b64_tr_b16 v[150:151], v25 offset:512
s_waitcnt lgkmcnt(5)
v_mfma_f32_16x16x32_bf16 v[108:111], v[212:215], v[140:143], v[108:111]
ds_read_b128 v[184:187], v32 offset:11264
v_mfma_f32_16x16x32_bf16 v[112:115], v[216:219], v[140:143], v[112:115]
ds_read_b128 v[188:191], v32 offset:19456
v_mfma_f32_16x16x32_bf16 v[116:119], v[220:223], v[140:143], v[116:119]
ds_read_b128 v[192:195], v32 offset:27648
v_mfma_f32_16x16x32_bf16 v[120:123], v[224:227], v[140:143], v[120:123]
ds_read_b64_tr_b16 v[152:153], v26 offset:0
ds_read_b64_tr_b16 v[154:155], v26 offset:512
s_waitcnt lgkmcnt(8)
v_mfma_f32_16x16x32_bf16 v[124:127], v[212:215], v[144:147], v[124:127]
s_add_u32 m0, s63, 0x2000
s_nop 0
buffer_load_dwordx4 v17, s[44:47], s71 offen offset:0 lds
buffer_load_dwordx4 v18, s[44:47], s71 offen offset:1024 lds
buffer_load_dwordx4 v19, s[44:47], s71 offen offset:2048 lds
buffer_load_dwordx4 v20, s[44:47], s71 offen offset:3072 lds
v_mfma_f32_16x16x32_bf16 v[128:131], v[216:219], v[144:147], v[128:131]
v_mfma_f32_16x16x32_bf16 v[132:135], v[220:223], v[144:147], v[132:135]
v_mfma_f32_16x16x32_bf16 v[136:139], v[224:227], v[144:147], v[136:139]
ds_read_b64_tr_b16 v[156:157], v27 offset:0
ds_read_b64_tr_b16 v[158:159], v27 offset:512
s_waitcnt lgkmcnt(7)
v_mfma_f32_16x16x32_bf16 v[76:79], v[180:183], v[148:151], v[76:79]
s_waitcnt lgkmcnt(6)
v_mfma_f32_16x16x32_bf16 v[80:83], v[184:187], v[148:151], v[80:83]
s_waitcnt lgkmcnt(5)
v_mfma_f32_16x16x32_bf16 v[84:87], v[188:191], v[148:151], v[84:87]
s_waitcnt lgkmcnt(4)
v_mfma_f32_16x16x32_bf16 v[88:91], v[192:195], v[148:151], v[88:91]
ds_read_b64_tr_b16 v[160:161], v28 offset:0
ds_read_b64_tr_b16 v[162:163], v28 offset:512
s_waitcnt lgkmcnt(4)
v_mfma_f32_16x16x32_bf16 v[92:95], v[180:183], v[152:155], v[92:95]
v_mfma_f32_16x16x32_bf16 v[96:99], v[184:187], v[152:155], v[96:99]
v_mfma_f32_16x16x32_bf16 v[100:103], v[188:191], v[152:155], v[100:103]
v_mfma_f32_16x16x32_bf16 v[104:107], v[192:195], v[152:155], v[104:107]
ds_read_b128 v[196:199], v31 offset:4096
s_waitcnt vmcnt(4)
ds_read_b64_tr_b16 v[164:165], v25 offset:4096
ds_read_b64_tr_b16 v[166:167], v25 offset:4608
s_waitcnt lgkmcnt(5)
v_mfma_f32_16x16x32_bf16 v[108:111], v[180:183], v[156:159], v[108:111]
ds_read_b128 v[200:203], v31 offset:12288
v_mfma_f32_16x16x32_bf16 v[112:115], v[184:187], v[156:159], v[112:115]
ds_read_b128 v[204:207], v31 offset:20480
v_mfma_f32_16x16x32_bf16 v[116:119], v[188:191], v[156:159], v[116:119]
ds_read_b128 v[208:211], v31 offset:28672
v_mfma_f32_16x16x32_bf16 v[120:123], v[192:195], v[156:159], v[120:123]
ds_read_b64_tr_b16 v[168:169], v26 offset:4096
ds_read_b64_tr_b16 v[170:171], v26 offset:4608
s_waitcnt lgkmcnt(8)
v_mfma_f32_16x16x32_bf16 v[124:127], v[180:183], v[160:163], v[124:127]
s_add_u32 m0, s63, 0x0
s_nop 0
buffer_load_dwordx4 v17, s[44:47], s72 offen offset:0 lds
buffer_load_dwordx4 v18, s[44:47], s72 offen offset:1024 lds
buffer_load_dwordx4 v19, s[44:47], s72 offen offset:2048 lds
buffer_load_dwordx4 v20, s[44:47], s72 offen offset:3072 lds
v_mfma_f32_16x16x32_bf16 v[128:131], v[184:187], v[160:163], v[128:131]
v_mfma_f32_16x16x32_bf16 v[132:135], v[188:191], v[160:163], v[132:135]
v_mfma_f32_16x16x32_bf16 v[136:139], v[192:195], v[160:163], v[136:139]
ds_read_b64_tr_b16 v[172:173], v27 offset:4096
ds_read_b64_tr_b16 v[174:175], v27 offset:4608
s_waitcnt lgkmcnt(7)
v_mfma_f32_16x16x32_bf16 v[76:79], v[196:199], v[164:167], v[76:79]
s_waitcnt lgkmcnt(6)
v_mfma_f32_16x16x32_bf16 v[80:83], v[200:203], v[164:167], v[80:83]
s_waitcnt lgkmcnt(5)
v_mfma_f32_16x16x32_bf16 v[84:87], v[204:207], v[164:167], v[84:87]
s_waitcnt lgkmcnt(4)
v_mfma_f32_16x16x32_bf16 v[88:91], v[208:211], v[164:167], v[88:91]
ds_read_b64_tr_b16 v[176:177], v28 offset:4096
ds_read_b64_tr_b16 v[178:179], v28 offset:4608
s_waitcnt lgkmcnt(4)
v_mfma_f32_16x16x32_bf16 v[92:95], v[196:199], v[168:171], v[92:95]
v_mfma_f32_16x16x32_bf16 v[96:99], v[200:203], v[168:171], v[96:99]
v_mfma_f32_16x16x32_bf16 v[100:103], v[204:207], v[168:171], v[100:103]
v_mfma_f32_16x16x32_bf16 v[104:107], v[208:211], v[168:171], v[104:107]
ds_read_b128 v[212:215], v32 offset:5120
s_waitcnt vmcnt(4)
ds_read_b64_tr_b16 v[140:141], v25 offset:8192
ds_read_b64_tr_b16 v[142:143], v25 offset:8704
s_waitcnt lgkmcnt(5)
v_mfma_f32_16x16x32_bf16 v[108:111], v[196:199], v[172:175], v[108:111]
ds_read_b128 v[216:219], v32 offset:13312
v_mfma_f32_16x16x32_bf16 v[112:115], v[200:203], v[172:175], v[112:115]
ds_read_b128 v[220:223], v32 offset:21504
v_mfma_f32_16x16x32_bf16 v[116:119], v[204:207], v[172:175], v[116:119]
ds_read_b128 v[224:227], v32 offset:29696
v_mfma_f32_16x16x32_bf16 v[120:123], v[208:211], v[172:175], v[120:123]
ds_read_b64_tr_b16 v[144:145], v26 offset:8192
ds_read_b64_tr_b16 v[146:147], v26 offset:8704
s_waitcnt lgkmcnt(8)
v_mfma_f32_16x16x32_bf16 v[124:127], v[196:199], v[176:179], v[124:127]
s_add_u32 m0, s63, 0x1000
s_nop 0
buffer_load_dwordx4 v17, s[44:47], s73 offen offset:0 lds
buffer_load_dwordx4 v18, s[44:47], s73 offen offset:1024 lds
buffer_load_dwordx4 v19, s[44:47], s73 offen offset:2048 lds
buffer_load_dwordx4 v20, s[44:47], s73 offen offset:3072 lds
v_mfma_f32_16x16x32_bf16 v[128:131], v[200:203], v[176:179], v[128:131]
v_mfma_f32_16x16x32_bf16 v[132:135], v[204:207], v[176:179], v[132:135]
v_mfma_f32_16x16x32_bf16 v[136:139], v[208:211], v[176:179], v[136:139]
ds_read_b64_tr_b16 v[148:149], v27 offset:8192
ds_read_b64_tr_b16 v[150:151], v27 offset:8704
s_waitcnt lgkmcnt(7)
v_mfma_f32_16x16x32_bf16 v[76:79], v[212:215], v[140:143], v[76:79]
s_waitcnt lgkmcnt(6)
v_mfma_f32_16x16x32_bf16 v[80:83], v[216:219], v[140:143], v[80:83]
s_waitcnt lgkmcnt(5)
v_mfma_f32_16x16x32_bf16 v[84:87], v[220:223], v[140:143], v[84:87]
s_waitcnt lgkmcnt(4)
v_mfma_f32_16x16x32_bf16 v[88:91], v[224:227], v[140:143], v[88:91]
ds_read_b64_tr_b16 v[152:153], v28 offset:8192
ds_read_b64_tr_b16 v[154:155], v28 offset:8704
s_waitcnt lgkmcnt(4)
v_mfma_f32_16x16x32_bf16 v[92:95], v[212:215], v[144:147], v[92:95]
v_mfma_f32_16x16x32_bf16 v[96:99], v[216:219], v[144:147], v[96:99]
v_mfma_f32_16x16x32_bf16 v[100:103], v[220:223], v[144:147], v[100:103]
v_mfma_f32_16x16x32_bf16 v[104:107], v[224:227], v[144:147], v[104:107]
ds_read_b128 v[180:183], v31 offset:6144
s_waitcnt vmcnt(4)
ds_read_b64_tr_b16 v[156:157], v25 offset:0
ds_read_b64_tr_b16 v[158:159], v25 offset:512
s_waitcnt lgkmcnt(5)
v_mfma_f32_16x16x32_bf16 v[108:111], v[212:215], v[148:151], v[108:111]
ds_read_b128 v[184:187], v31 offset:14336
v_mfma_f32_16x16x32_bf16 v[112:115], v[216:219], v[148:151], v[112:115]
ds_read_b128 v[188:191], v31 offset:22528
v_mfma_f32_16x16x32_bf16 v[116:119], v[220:223], v[148:151], v[116:119]
ds_read_b128 v[192:195], v31 offset:30720
v_mfma_f32_16x16x32_bf16 v[120:123], v[224:227], v[148:151], v[120:123]
ds_read_b64_tr_b16 v[160:161], v26 offset:0
ds_read_b64_tr_b16 v[162:163], v26 offset:512
s_waitcnt lgkmcnt(8)
v_mfma_f32_16x16x32_bf16 v[124:127], v[212:215], v[152:155], v[124:127]
v_mfma_f32_16x16x32_bf16 v[128:131], v[216:219], v[152:155], v[128:131]
v_mfma_f32_16x16x32_bf16 v[132:135], v[220:223], v[152:155], v[132:135]
v_mfma_f32_16x16x32_bf16 v[136:139], v[224:227], v[152:155], v[136:139]
ds_read_b64_tr_b16 v[164:165], v27 offset:0
ds_read_b64_tr_b16 v[166:167], v27 offset:512
s_waitcnt lgkmcnt(7)
v_mfma_f32_16x16x32_bf16 v[76:79], v[180:183], v[156:159], v[76:79]
s_waitcnt lgkmcnt(6)
v_mfma_f32_16x16x32_bf16 v[80:83], v[184:187], v[156:159], v[80:83]
s_waitcnt lgkmcnt(5)
v_mfma_f32_16x16x32_bf16 v[84:87], v[188:191], v[156:159], v[84:87]
s_waitcnt lgkmcnt(4)
v_mfma_f32_16x16x32_bf16 v[88:91], v[192:195], v[156:159], v[88:91]
ds_read_b64_tr_b16 v[168:169], v28 offset:0
ds_read_b64_tr_b16 v[170:171], v28 offset:512
s_waitcnt lgkmcnt(4)
v_mfma_f32_16x16x32_bf16 v[92:95], v[180:183], v[160:163], v[92:95]
v_mfma_f32_16x16x32_bf16 v[96:99], v[184:187], v[160:163], v[96:99]
v_mfma_f32_16x16x32_bf16 v[100:103], v[188:191], v[160:163], v[100:103]
v_mfma_f32_16x16x32_bf16 v[104:107], v[192:195], v[160:163], v[104:107]
ds_read_b128 v[196:199], v32 offset:7168
s_waitcnt vmcnt(0)
ds_read_b64_tr_b16 v[172:173], v25 offset:4096
ds_read_b64_tr_b16 v[174:175], v25 offset:4608
s_waitcnt lgkmcnt(5)
v_mfma_f32_16x16x32_bf16 v[108:111], v[180:183], v[164:167], v[108:111]
ds_read_b128 v[200:203], v32 offset:15360
v_mfma_f32_16x16x32_bf16 v[112:115], v[184:187], v[164:167], v[112:115]
ds_read_b128 v[204:207], v32 offset:23552
v_mfma_f32_16x16x32_bf16 v[116:119], v[188:191], v[164:167], v[116:119]
ds_read_b128 v[208:211], v32 offset:31744
v_mfma_f32_16x16x32_bf16 v[120:123], v[192:195], v[164:167], v[120:123]
ds_read_b64_tr_b16 v[176:177], v26 offset:4096
ds_read_b64_tr_b16 v[178:179], v26 offset:4608
s_waitcnt lgkmcnt(8)
v_mfma_f32_16x16x32_bf16 v[124:127], v[180:183], v[168:171], v[124:127]
v_mfma_f32_16x16x32_bf16 v[128:131], v[184:187], v[168:171], v[128:131]
v_mfma_f32_16x16x32_bf16 v[132:135], v[188:191], v[168:171], v[132:135]
v_mfma_f32_16x16x32_bf16 v[136:139], v[192:195], v[168:171], v[136:139]
ds_read_b64_tr_b16 v[140:141], v27 offset:4096
ds_read_b64_tr_b16 v[142:143], v27 offset:4608
s_waitcnt lgkmcnt(7)
v_mfma_f32_16x16x32_bf16 v[76:79], v[196:199], v[172:175], v[76:79]
s_waitcnt lgkmcnt(6)
v_mfma_f32_16x16x32_bf16 v[80:83], v[200:203], v[172:175], v[80:83]
s_waitcnt lgkmcnt(5)
v_mfma_f32_16x16x32_bf16 v[84:87], v[204:207], v[172:175], v[84:87]
s_waitcnt lgkmcnt(4)
v_mfma_f32_16x16x32_bf16 v[88:91], v[208:211], v[172:175], v[88:91]
ds_read_b64_tr_b16 v[144:145], v28 offset:4096
ds_read_b64_tr_b16 v[146:147], v28 offset:4608
s_waitcnt lgkmcnt(4)
v_mfma_f32_16x16x32_bf16 v[92:95], v[196:199], v[176:179], v[92:95]
v_cvt_pk_bf16_f32 v76, v76, v77
v_cvt_pk_bf16_f32 v77, v78, v79
v_cvt_pk_bf16_f32 v78, v80, v81
v_cvt_pk_bf16_f32 v79, v82, v83
buffer_store_dwordx4 v[76:79], v16, s[52:55], s82 offen offset:0 sc1
v_mfma_f32_16x16x32_bf16 v[96:99], v[200:203], v[176:179], v[96:99]
v_mfma_f32_16x16x32_bf16 v[100:103], v[204:207], v[176:179], v[100:103]
v_cvt_pk_bf16_f32 v84, v84, v85
v_cvt_pk_bf16_f32 v85, v86, v87
v_cvt_pk_bf16_f32 v86, v88, v89
v_cvt_pk_bf16_f32 v87, v90, v91
buffer_store_dwordx4 v[84:87], v16, s[52:55], s82 offen offset:2048 sc1
v_mfma_f32_16x16x32_bf16 v[104:107], v[208:211], v[176:179], v[104:107]
s_waitcnt lgkmcnt(2)
v_mfma_f32_16x16x32_bf16 v[108:111], v[196:199], v[140:143], v[108:111]
v_cvt_pk_bf16_f32 v92, v92, v93
v_cvt_pk_bf16_f32 v93, v94, v95
v_cvt_pk_bf16_f32 v94, v96, v97
v_cvt_pk_bf16_f32 v95, v98, v99
buffer_store_dwordx4 v[92:95], v16, s[52:55], s82 offen offset:1024 sc1
v_mfma_f32_16x16x32_bf16 v[112:115], v[200:203], v[140:143], v[112:115]
v_mfma_f32_16x16x32_bf16 v[116:119], v[204:207], v[140:143], v[116:119]
v_cvt_pk_bf16_f32 v100, v100, v101
v_cvt_pk_bf16_f32 v101, v102, v103
v_cvt_pk_bf16_f32 v102, v104, v105
v_cvt_pk_bf16_f32 v103, v106, v107
buffer_store_dwordx4 v[100:103], v16, s[52:55], s82 offen offset:3072 sc1
v_mfma_f32_16x16x32_bf16 v[120:123], v[208:211], v[140:143], v[120:123]
s_waitcnt lgkmcnt(0)
v_mfma_f32_16x16x32_bf16 v[124:127], v[196:199], v[144:147], v[124:127]
v_cvt_pk_bf16_f32 v108, v108, v109
v_cvt_pk_bf16_f32 v109, v110, v111
v_cvt_pk_bf16_f32 v110, v112, v113
v_cvt_pk_bf16_f32 v111, v114, v115
buffer_store_dwordx4 v[108:111], v16, s[52:55], s83 offen offset:0 sc1
v_mfma_f32_16x16x32_bf16 v[128:131], v[200:203], v[144:147], v[128:131]
v_mfma_f32_16x16x32_bf16 v[132:135], v[204:207], v[144:147], v[132:135]
v_cvt_pk_bf16_f32 v116, v116, v117
v_cvt_pk_bf16_f32 v117, v118, v119
v_cvt_pk_bf16_f32 v118, v120, v121
v_cvt_pk_bf16_f32 v119, v122, v123
buffer_store_dwordx4 v[116:119], v16, s[52:55], s83 offen offset:2048 sc1
v_mfma_f32_16x16x32_bf16 v[136:139], v[208:211], v[144:147], v[136:139]
v_cvt_pk_bf16_f32 v124, v124, v125
v_cvt_pk_bf16_f32 v125, v126, v127
v_cvt_pk_bf16_f32 v126, v128, v129
v_cvt_pk_bf16_f32 v127, v130, v131
buffer_store_dwordx4 v[124:127], v16, s[52:55], s83 offen offset:1024 sc1
v_cvt_pk_bf16_f32 v132, v132, v133
v_cvt_pk_bf16_f32 v133, v134, v135
s_nop 0
v_cvt_pk_bf16_f32 v134, v136, v137
v_cvt_pk_bf16_f32 v135, v138, v139
buffer_store_dwordx4 v[132:135], v16, s[52:55], s83 offen offset:3072 sc1
s_branch LM_pub
LM_light:
s_mov_b32 s61, 1
s_waitcnt lgkmcnt(0)
s_mov_b32 s98, 0x7c3ff80
s_load_dwordx2 s[98:99], s[38:39], s98
s_branch L1_fin
LM_edge:
s_sub_u32 s4, s3, 30
s_lshl_b32 s8, s8, 1
s_add_u32 s4, s4, s8
s_add_u32 s91, s4, 240
s_cmp_ge_u32 s4, 14
s_cselect_b32 s61, 1, 0
s_mul_i32 s6, s4, 40000
v_lshlrev_b32 v5, 4, v0
v_lshlrev_b32 v6, 2, v2
v_add_u32 v6, 0x10000, v6
v_mov_b32 v7, 0
ds_write_b32 v6, v7
s_mov_b32 s66, 0
s_mov_b32 s67, 4096
s_mov_b32 s68, 8192
s_mov_b32 s69, 12288
s_mov_b32 s70, 16384
s_mov_b32 s71, 20480
s_mov_b32 s72, 24576
s_mov_b32 s73, 28672
s_mov_b32 s74, 32768
s_mov_b32 s75, 36864
s_waitcnt lgkmcnt(0)
s_add_u32 s40, s20, 0x0
s_addc_u32 s41, s21, 0
s_add_u32 s40, s40, s6
s_addc_u32 s41, s41, 0
s_mov_b32 s42, 0x9c40
s_mov_b32 s43, 0x00020000
s_add_u32 s44, s18, 0x0
s_addc_u32 s45, s19, 0
s_add_u32 s44, s44, s6
s_addc_u32 s45, s45, 0
s_mov_b32 s46, 0x9c40
s_mov_b32 s47, 0x00020000
buffer_load_dwordx4 v[16:19], v5, s[40:43], s66 offen
buffer_load_dwordx4 v[20:23], v5, s[40:43], s67 offen
buffer_load_dwordx4 v[24:27], v5, s[40:43], s68 offen
buffer_load_dwordx4 v[28:31], v5, s[40:43], s69 offen
buffer_load_dwordx4 v[32:35], v5, s[40:43], s70 offen
buffer_load_dwordx4 v[36:39], v5, s[40:43], s71 offen
buffer_load_dwordx4 v[40:43], v5, s[40:43], s72 offen
buffer_load_dwordx4 v[44:47], v5, s[40:43], s73 offen
buffer_load_dwordx4 v[48:51], v5, s[40:43], s74 offen
buffer_load_dwordx4 v[52:55], v5, s[40:43], s75 offen
buffer_load_dwordx4 v[56:59], v5, s[44:47], s66 offen
buffer_load_dwordx4 v[60:63], v5, s[44:47], s67 offen
buffer_load_dwordx4 v[64:67], v5, s[44:47], s68 offen
buffer_load_dwordx4 v[68:71], v5, s[44:47], s69 offen
buffer_load_dwordx4 v[72:75], v5, s[44:47], s70 offen
buffer_load_dwordx4 v[76:79], v5, s[44:47], s71 offen
buffer_load_dwordx4 v[80:83], v5, s[44:47], s72 offen
buffer_load_dwordx4 v[84:87], v5, s[44:47], s73 offen
buffer_load_dwordx4 v[88:91], v5, s[44:47], s74 offen
buffer_load_dwordx4 v[92:95], v5, s[44:47], s75 offen
s_mov_b32 s98, 0x7c3ff80
s_load_dwordx2 s[98:99], s[38:39], s98
s_add_u32 s48, s38, 0x8000000
s_addc_u32 s49, s39, 0
s_mov_b32 s50, 0x2800000
s_mov_b32 s51, 0x00020000
s_add_u32 s52, s38, 0x7800000
s_addc_u32 s53, s39, 0
s_mov_b32 s54, 0x1000
s_mov_b32 s55, 0x00020000
v_mov_b32 v240, 6945
v_mov_b32 v241, 0x0
v_mov_b32 v242, 6317
v_mov_b32 v243, 0x340674
v_mov_b32 v244, 6899
v_mov_b32 v245, 0xfffae6a0
v_mov_b32 v246, 6242
v_mov_b32 v247, 0x4484a0
s_mov_b32 s11, 0x10000
v_mov_b32 v7, 1
v_cmp_gt_u32 vcc, 0xc4, v0
s_mov_b64 s[12:13], vcc
s_barrier
s_waitcnt vmcnt(19)
v_cmp_le_u32 vcc, 5436, v16
s_nop 1
v_cndmask_b32 v96, v240, v242, vcc
v_cndmask_b32 v136, v241, v243, vcc
v_cmp_le_u32 vcc, 6432, v16
s_nop 1
v_cndmask_b32 v96, v96, v244, vcc
v_cndmask_b32 v136, v136, v245, vcc
v_cmp_le_u32 vcc, 7344, v16
s_nop 1
v_cndmask_b32 v96, v96, v246, vcc
v_cndmask_b32 v136, v136, v247, vcc
v_mad_u32_u24 v96, v96, v16, v136
v_lshrrev_b32 v96, 20, v96
v_lshl_add_u32 v136, v96, 2, s11
ds_add_rtn_u32 v136, v136, v7
v_cmp_le_u32 vcc, 5436, v17
s_nop 1
v_cndmask_b32 v97, v240, v242, vcc
v_cndmask_b32 v137, v241, v243, vcc
v_cmp_le_u32 vcc, 6432, v17
s_nop 1
v_cndmask_b32 v97, v97, v244, vcc
v_cndmask_b32 v137, v137, v245, vcc
v_cmp_le_u32 vcc, 7344, v17
s_nop 1
v_cndmask_b32 v97, v97, v246, vcc
v_cndmask_b32 v137, v137, v247, vcc
v_mad_u32_u24 v97, v97, v17, v137
v_lshrrev_b32 v97, 20, v97
v_lshl_add_u32 v137, v97, 2, s11
ds_add_rtn_u32 v137, v137, v7
v_cmp_le_u32 vcc, 5436, v18
s_nop 1
v_cndmask_b32 v98, v240, v242, vcc
v_cndmask_b32 v138, v241, v243, vcc
v_cmp_le_u32 vcc, 6432, v18
s_nop 1
v_cndmask_b32 v98, v98, v244, vcc
v_cndmask_b32 v138, v138, v245, vcc
v_cmp_le_u32 vcc, 7344, v18
s_nop 1
v_cndmask_b32 v98, v98, v246, vcc
v_cndmask_b32 v138, v138, v247, vcc
v_mad_u32_u24 v98, v98, v18, v138
v_lshrrev_b32 v98, 20, v98
v_lshl_add_u32 v138, v98, 2, s11
ds_add_rtn_u32 v138, v138, v7
v_cmp_le_u32 vcc, 5436, v19
s_nop 1
v_cndmask_b32 v99, v240, v242, vcc
v_cndmask_b32 v139, v241, v243, vcc
v_cmp_le_u32 vcc, 6432, v19
s_nop 1
v_cndmask_b32 v99, v99, v244, vcc
v_cndmask_b32 v139, v139, v245, vcc
v_cmp_le_u32 vcc, 7344, v19
s_nop 1
v_cndmask_b32 v99, v99, v246, vcc
v_cndmask_b32 v139, v139, v247, vcc
v_mad_u32_u24 v99, v99, v19, v139
v_lshrrev_b32 v99, 20, v99
v_lshl_add_u32 v139, v99, 2, s11
ds_add_rtn_u32 v139, v139, v7
s_waitcnt vmcnt(18)
v_cmp_le_u32 vcc, 5436, v20
s_nop 1
v_cndmask_b32 v100, v240, v242, vcc
v_cndmask_b32 v140, v241, v243, vcc
v_cmp_le_u32 vcc, 6432, v20
s_nop 1
v_cndmask_b32 v100, v100, v244, vcc
v_cndmask_b32 v140, v140, v245, vcc
v_cmp_le_u32 vcc, 7344, v20
s_nop 1
v_cndmask_b32 v100, v100, v246, vcc
v_cndmask_b32 v140, v140, v247, vcc
v_mad_u32_u24 v100, v100, v20, v140
v_lshrrev_b32 v100, 20, v100
v_lshl_add_u32 v140, v100, 2, s11
ds_add_rtn_u32 v140, v140, v7
v_cmp_le_u32 vcc, 5436, v21
s_nop 1
v_cndmask_b32 v101, v240, v242, vcc
v_cndmask_b32 v141, v241, v243, vcc
v_cmp_le_u32 vcc, 6432, v21
s_nop 1
v_cndmask_b32 v101, v101, v244, vcc
v_cndmask_b32 v141, v141, v245, vcc
v_cmp_le_u32 vcc, 7344, v21
s_nop 1
v_cndmask_b32 v101, v101, v246, vcc
v_cndmask_b32 v141, v141, v247, vcc
v_mad_u32_u24 v101, v101, v21, v141
v_lshrrev_b32 v101, 20, v101
v_lshl_add_u32 v141, v101, 2, s11
ds_add_rtn_u32 v141, v141, v7
v_cmp_le_u32 vcc, 5436, v22
s_nop 1
v_cndmask_b32 v102, v240, v242, vcc
v_cndmask_b32 v142, v241, v243, vcc
v_cmp_le_u32 vcc, 6432, v22
s_nop 1
v_cndmask_b32 v102, v102, v244, vcc
v_cndmask_b32 v142, v142, v245, vcc
v_cmp_le_u32 vcc, 7344, v22
s_nop 1
v_cndmask_b32 v102, v102, v246, vcc
v_cndmask_b32 v142, v142, v247, vcc
v_mad_u32_u24 v102, v102, v22, v142
v_lshrrev_b32 v102, 20, v102
v_lshl_add_u32 v142, v102, 2, s11
ds_add_rtn_u32 v142, v142, v7
v_cmp_le_u32 vcc, 5436, v23
s_nop 1
v_cndmask_b32 v103, v240, v242, vcc
v_cndmask_b32 v143, v241, v243, vcc
v_cmp_le_u32 vcc, 6432, v23
s_nop 1
v_cndmask_b32 v103, v103, v244, vcc
v_cndmask_b32 v143, v143, v245, vcc
v_cmp_le_u32 vcc, 7344, v23
s_nop 1
v_cndmask_b32 v103, v103, v246, vcc
v_cndmask_b32 v143, v143, v247, vcc
v_mad_u32_u24 v103, v103, v23, v143
v_lshrrev_b32 v103, 20, v103
v_lshl_add_u32 v143, v103, 2, s11
ds_add_rtn_u32 v143, v143, v7
s_waitcnt vmcnt(17)
v_cmp_le_u32 vcc, 5436, v24
s_nop 1
v_cndmask_b32 v104, v240, v242, vcc
v_cndmask_b32 v144, v241, v243, vcc
v_cmp_le_u32 vcc, 6432, v24
s_nop 1
v_cndmask_b32 v104, v104, v244, vcc
v_cndmask_b32 v144, v144, v245, vcc
v_cmp_le_u32 vcc, 7344, v24
s_nop 1
v_cndmask_b32 v104, v104, v246, vcc
v_cndmask_b32 v144, v144, v247, vcc
v_mad_u32_u24 v104, v104, v24, v144
v_lshrrev_b32 v104, 20, v104
v_lshl_add_u32 v144, v104, 2, s11
ds_add_rtn_u32 v144, v144, v7
v_cmp_le_u32 vcc, 5436, v25
s_nop 1
v_cndmask_b32 v105, v240, v242, vcc
v_cndmask_b32 v145, v241, v243, vcc
v_cmp_le_u32 vcc, 6432, v25
s_nop 1
v_cndmask_b32 v105, v105, v244, vcc
v_cndmask_b32 v145, v145, v245, vcc
v_cmp_le_u32 vcc, 7344, v25
s_nop 1
v_cndmask_b32 v105, v105, v246, vcc
v_cndmask_b32 v145, v145, v247, vcc
v_mad_u32_u24 v105, v105, v25, v145
v_lshrrev_b32 v105, 20, v105
v_lshl_add_u32 v145, v105, 2, s11
ds_add_rtn_u32 v145, v145, v7
v_cmp_le_u32 vcc, 5436, v26
s_nop 1
v_cndmask_b32 v106, v240, v242, vcc
v_cndmask_b32 v146, v241, v243, vcc
v_cmp_le_u32 vcc, 6432, v26
s_nop 1
v_cndmask_b32 v106, v106, v244, vcc
v_cndmask_b32 v146, v146, v245, vcc
v_cmp_le_u32 vcc, 7344, v26
s_nop 1
v_cndmask_b32 v106, v106, v246, vcc
v_cndmask_b32 v146, v146, v247, vcc
v_mad_u32_u24 v106, v106, v26, v146
v_lshrrev_b32 v106, 20, v106
v_lshl_add_u32 v146, v106, 2, s11
ds_add_rtn_u32 v146, v146, v7
v_cmp_le_u32 vcc, 5436, v27
s_nop 1
v_cndmask_b32 v107, v240, v242, vcc
v_cndmask_b32 v147, v241, v243, vcc
v_cmp_le_u32 vcc, 6432, v27
s_nop 1
v_cndmask_b32 v107, v107, v244, vcc
v_cndmask_b32 v147, v147, v245, vcc
v_cmp_le_u32 vcc, 7344, v27
s_nop 1
v_cndmask_b32 v107, v107, v246, vcc
v_cndmask_b32 v147, v147, v247, vcc
v_mad_u32_u24 v107, v107, v27, v147
v_lshrrev_b32 v107, 20, v107
v_lshl_add_u32 v147, v107, 2, s11
ds_add_rtn_u32 v147, v147, v7
s_waitcnt vmcnt(16)
v_cmp_le_u32 vcc, 5436, v28
s_nop 1
v_cndmask_b32 v108, v240, v242, vcc
v_cndmask_b32 v148, v241, v243, vcc
v_cmp_le_u32 vcc, 6432, v28
s_nop 1
v_cndmask_b32 v108, v108, v244, vcc
v_cndmask_b32 v148, v148, v245, vcc
v_cmp_le_u32 vcc, 7344, v28
s_nop 1
v_cndmask_b32 v108, v108, v246, vcc
v_cndmask_b32 v148, v148, v247, vcc
v_mad_u32_u24 v108, v108, v28, v148
v_lshrrev_b32 v108, 20, v108
v_lshl_add_u32 v148, v108, 2, s11
ds_add_rtn_u32 v148, v148, v7
v_cmp_le_u32 vcc, 5436, v29
s_nop 1
v_cndmask_b32 v109, v240, v242, vcc
v_cndmask_b32 v149, v241, v243, vcc
v_cmp_le_u32 vcc, 6432, v29
s_nop 1
v_cndmask_b32 v109, v109, v244, vcc
v_cndmask_b32 v149, v149, v245, vcc
v_cmp_le_u32 vcc, 7344, v29
s_nop 1
v_cndmask_b32 v109, v109, v246, vcc
v_cndmask_b32 v149, v149, v247, vcc
v_mad_u32_u24 v109, v109, v29, v149
v_lshrrev_b32 v109, 20, v109
v_lshl_add_u32 v149, v109, 2, s11
ds_add_rtn_u32 v149, v149, v7
v_cmp_le_u32 vcc, 5436, v30
s_nop 1
v_cndmask_b32 v110, v240, v242, vcc
v_cndmask_b32 v150, v241, v243, vcc
v_cmp_le_u32 vcc, 6432, v30
s_nop 1
v_cndmask_b32 v110, v110, v244, vcc
v_cndmask_b32 v150, v150, v245, vcc
v_cmp_le_u32 vcc, 7344, v30
s_nop 1
v_cndmask_b32 v110, v110, v246, vcc
v_cndmask_b32 v150, v150, v247, vcc
v_mad_u32_u24 v110, v110, v30, v150
v_lshrrev_b32 v110, 20, v110
v_lshl_add_u32 v150, v110, 2, s11
ds_add_rtn_u32 v150, v150, v7
v_cmp_le_u32 vcc, 5436, v31
s_nop 1
v_cndmask_b32 v111, v240, v242, vcc
v_cndmask_b32 v151, v241, v243, vcc
v_cmp_le_u32 vcc, 6432, v31
s_nop 1
v_cndmask_b32 v111, v111, v244, vcc
v_cndmask_b32 v151, v151, v245, vcc
v_cmp_le_u32 vcc, 7344, v31
s_nop 1
v_cndmask_b32 v111, v111, v246, vcc
v_cndmask_b32 v151, v151, v247, vcc
v_mad_u32_u24 v111, v111, v31, v151
v_lshrrev_b32 v111, 20, v111
v_lshl_add_u32 v151, v111, 2, s11
ds_add_rtn_u32 v151, v151, v7
s_waitcnt vmcnt(15)
v_cmp_le_u32 vcc, 5436, v32
s_nop 1
v_cndmask_b32 v112, v240, v242, vcc
v_cndmask_b32 v152, v241, v243, vcc
v_cmp_le_u32 vcc, 6432, v32
s_nop 1
v_cndmask_b32 v112, v112, v244, vcc
v_cndmask_b32 v152, v152, v245, vcc
v_cmp_le_u32 vcc, 7344, v32
s_nop 1
v_cndmask_b32 v112, v112, v246, vcc
v_cndmask_b32 v152, v152, v247, vcc
v_mad_u32_u24 v112, v112, v32, v152
v_lshrrev_b32 v112, 20, v112
v_lshl_add_u32 v152, v112, 2, s11
ds_add_rtn_u32 v152, v152, v7
v_cmp_le_u32 vcc, 5436, v33
s_nop 1
v_cndmask_b32 v113, v240, v242, vcc
v_cndmask_b32 v153, v241, v243, vcc
v_cmp_le_u32 vcc, 6432, v33
s_nop 1
v_cndmask_b32 v113, v113, v244, vcc
v_cndmask_b32 v153, v153, v245, vcc
v_cmp_le_u32 vcc, 7344, v33
s_nop 1
v_cndmask_b32 v113, v113, v246, vcc
v_cndmask_b32 v153, v153, v247, vcc
v_mad_u32_u24 v113, v113, v33, v153
v_lshrrev_b32 v113, 20, v113
v_lshl_add_u32 v153, v113, 2, s11
ds_add_rtn_u32 v153, v153, v7
v_cmp_le_u32 vcc, 5436, v34
s_nop 1
v_cndmask_b32 v114, v240, v242, vcc
v_cndmask_b32 v154, v241, v243, vcc
v_cmp_le_u32 vcc, 6432, v34
s_nop 1
v_cndmask_b32 v114, v114, v244, vcc
v_cndmask_b32 v154, v154, v245, vcc
v_cmp_le_u32 vcc, 7344, v34
s_nop 1
v_cndmask_b32 v114, v114, v246, vcc
v_cndmask_b32 v154, v154, v247, vcc
v_mad_u32_u24 v114, v114, v34, v154
v_lshrrev_b32 v114, 20, v114
v_lshl_add_u32 v154, v114, 2, s11
ds_add_rtn_u32 v154, v154, v7
v_cmp_le_u32 vcc, 5436, v35
s_nop 1
v_cndmask_b32 v115, v240, v242, vcc
v_cndmask_b32 v155, v241, v243, vcc
v_cmp_le_u32 vcc, 6432, v35
s_nop 1
v_cndmask_b32 v115, v115, v244, vcc
v_cndmask_b32 v155, v155, v245, vcc
v_cmp_le_u32 vcc, 7344, v35
s_nop 1
v_cndmask_b32 v115, v115, v246, vcc
v_cndmask_b32 v155, v155, v247, vcc
v_mad_u32_u24 v115, v115, v35, v155
v_lshrrev_b32 v115, 20, v115
v_lshl_add_u32 v155, v115, 2, s11
ds_add_rtn_u32 v155, v155, v7
s_waitcnt vmcnt(14)
v_cmp_le_u32 vcc, 5436, v36
s_nop 1
v_cndmask_b32 v116, v240, v242, vcc
v_cndmask_b32 v156, v241, v243, vcc
v_cmp_le_u32 vcc, 6432, v36
s_nop 1
v_cndmask_b32 v116, v116, v244, vcc
v_cndmask_b32 v156, v156, v245, vcc
v_cmp_le_u32 vcc, 7344, v36
s_nop 1
v_cndmask_b32 v116, v116, v246, vcc
v_cndmask_b32 v156, v156, v247, vcc
v_mad_u32_u24 v116, v116, v36, v156
v_lshrrev_b32 v116, 20, v116
v_lshl_add_u32 v156, v116, 2, s11
ds_add_rtn_u32 v156, v156, v7
v_cmp_le_u32 vcc, 5436, v37
s_nop 1
v_cndmask_b32 v117, v240, v242, vcc
v_cndmask_b32 v157, v241, v243, vcc
v_cmp_le_u32 vcc, 6432, v37
s_nop 1
v_cndmask_b32 v117, v117, v244, vcc
v_cndmask_b32 v157, v157, v245, vcc
v_cmp_le_u32 vcc, 7344, v37
s_nop 1
v_cndmask_b32 v117, v117, v246, vcc
v_cndmask_b32 v157, v157, v247, vcc
v_mad_u32_u24 v117, v117, v37, v157
v_lshrrev_b32 v117, 20, v117
v_lshl_add_u32 v157, v117, 2, s11
ds_add_rtn_u32 v157, v157, v7
v_cmp_le_u32 vcc, 5436, v38
s_nop 1
v_cndmask_b32 v118, v240, v242, vcc
v_cndmask_b32 v158, v241, v243, vcc
v_cmp_le_u32 vcc, 6432, v38
s_nop 1
v_cndmask_b32 v118, v118, v244, vcc
v_cndmask_b32 v158, v158, v245, vcc
v_cmp_le_u32 vcc, 7344, v38
s_nop 1
v_cndmask_b32 v118, v118, v246, vcc
v_cndmask_b32 v158, v158, v247, vcc
v_mad_u32_u24 v118, v118, v38, v158
v_lshrrev_b32 v118, 20, v118
v_lshl_add_u32 v158, v118, 2, s11
ds_add_rtn_u32 v158, v158, v7
v_cmp_le_u32 vcc, 5436, v39
s_nop 1
v_cndmask_b32 v119, v240, v242, vcc
v_cndmask_b32 v159, v241, v243, vcc
v_cmp_le_u32 vcc, 6432, v39
s_nop 1
v_cndmask_b32 v119, v119, v244, vcc
v_cndmask_b32 v159, v159, v245, vcc
v_cmp_le_u32 vcc, 7344, v39
s_nop 1
v_cndmask_b32 v119, v119, v246, vcc
v_cndmask_b32 v159, v159, v247, vcc
v_mad_u32_u24 v119, v119, v39, v159
v_lshrrev_b32 v119, 20, v119
v_lshl_add_u32 v159, v119, 2, s11
ds_add_rtn_u32 v159, v159, v7
s_waitcnt vmcnt(13)
v_cmp_le_u32 vcc, 5436, v40
s_nop 1
v_cndmask_b32 v120, v240, v242, vcc
v_cndmask_b32 v160, v241, v243, vcc
v_cmp_le_u32 vcc, 6432, v40
s_nop 1
v_cndmask_b32 v120, v120, v244, vcc
v_cndmask_b32 v160, v160, v245, vcc
v_cmp_le_u32 vcc, 7344, v40
s_nop 1
v_cndmask_b32 v120, v120, v246, vcc
v_cndmask_b32 v160, v160, v247, vcc
v_mad_u32_u24 v120, v120, v40, v160
v_lshrrev_b32 v120, 20, v120
v_lshl_add_u32 v160, v120, 2, s11
ds_add_rtn_u32 v160, v160, v7
v_cmp_le_u32 vcc, 5436, v41
s_nop 1
v_cndmask_b32 v121, v240, v242, vcc
v_cndmask_b32 v161, v241, v243, vcc
v_cmp_le_u32 vcc, 6432, v41
s_nop 1
v_cndmask_b32 v121, v121, v244, vcc
v_cndmask_b32 v161, v161, v245, vcc
v_cmp_le_u32 vcc, 7344, v41
s_nop 1
v_cndmask_b32 v121, v121, v246, vcc
v_cndmask_b32 v161, v161, v247, vcc
v_mad_u32_u24 v121, v121, v41, v161
v_lshrrev_b32 v121, 20, v121
v_lshl_add_u32 v161, v121, 2, s11
ds_add_rtn_u32 v161, v161, v7
v_cmp_le_u32 vcc, 5436, v42
s_nop 1
v_cndmask_b32 v122, v240, v242, vcc
v_cndmask_b32 v162, v241, v243, vcc
v_cmp_le_u32 vcc, 6432, v42
s_nop 1
v_cndmask_b32 v122, v122, v244, vcc
v_cndmask_b32 v162, v162, v245, vcc
v_cmp_le_u32 vcc, 7344, v42
s_nop 1
v_cndmask_b32 v122, v122, v246, vcc
v_cndmask_b32 v162, v162, v247, vcc
v_mad_u32_u24 v122, v122, v42, v162
v_lshrrev_b32 v122, 20, v122
v_lshl_add_u32 v162, v122, 2, s11
ds_add_rtn_u32 v162, v162, v7
v_cmp_le_u32 vcc, 5436, v43
s_nop 1
v_cndmask_b32 v123, v240, v242, vcc
v_cndmask_b32 v163, v241, v243, vcc
v_cmp_le_u32 vcc, 6432, v43
s_nop 1
v_cndmask_b32 v123, v123, v244, vcc
v_cndmask_b32 v163, v163, v245, vcc
v_cmp_le_u32 vcc, 7344, v43
s_nop 1
v_cndmask_b32 v123, v123, v246, vcc
v_cndmask_b32 v163, v163, v247, vcc
v_mad_u32_u24 v123, v123, v43, v163
v_lshrrev_b32 v123, 20, v123
v_lshl_add_u32 v163, v123, 2, s11
ds_add_rtn_u32 v163, v163, v7
s_waitcnt vmcnt(12)
v_cmp_le_u32 vcc, 5436, v44
s_nop 1
v_cndmask_b32 v124, v240, v242, vcc
v_cndmask_b32 v164, v241, v243, vcc
v_cmp_le_u32 vcc, 6432, v44
s_nop 1
v_cndmask_b32 v124, v124, v244, vcc
v_cndmask_b32 v164, v164, v245, vcc
v_cmp_le_u32 vcc, 7344, v44
s_nop 1
v_cndmask_b32 v124, v124, v246, vcc
v_cndmask_b32 v164, v164, v247, vcc
v_mad_u32_u24 v124, v124, v44, v164
v_lshrrev_b32 v124, 20, v124
v_lshl_add_u32 v164, v124, 2, s11
ds_add_rtn_u32 v164, v164, v7
v_cmp_le_u32 vcc, 5436, v45
s_nop 1
v_cndmask_b32 v125, v240, v242, vcc
v_cndmask_b32 v165, v241, v243, vcc
v_cmp_le_u32 vcc, 6432, v45
s_nop 1
v_cndmask_b32 v125, v125, v244, vcc
v_cndmask_b32 v165, v165, v245, vcc
v_cmp_le_u32 vcc, 7344, v45
s_nop 1
v_cndmask_b32 v125, v125, v246, vcc
v_cndmask_b32 v165, v165, v247, vcc
v_mad_u32_u24 v125, v125, v45, v165
v_lshrrev_b32 v125, 20, v125
v_lshl_add_u32 v165, v125, 2, s11
ds_add_rtn_u32 v165, v165, v7
v_cmp_le_u32 vcc, 5436, v46
s_nop 1
v_cndmask_b32 v126, v240, v242, vcc
v_cndmask_b32 v166, v241, v243, vcc
v_cmp_le_u32 vcc, 6432, v46
s_nop 1
v_cndmask_b32 v126, v126, v244, vcc
v_cndmask_b32 v166, v166, v245, vcc
v_cmp_le_u32 vcc, 7344, v46
s_nop 1
v_cndmask_b32 v126, v126, v246, vcc
v_cndmask_b32 v166, v166, v247, vcc
v_mad_u32_u24 v126, v126, v46, v166
v_lshrrev_b32 v126, 20, v126
v_lshl_add_u32 v166, v126, 2, s11
ds_add_rtn_u32 v166, v166, v7
v_cmp_le_u32 vcc, 5436, v47
s_nop 1
v_cndmask_b32 v127, v240, v242, vcc
v_cndmask_b32 v167, v241, v243, vcc
v_cmp_le_u32 vcc, 6432, v47
s_nop 1
v_cndmask_b32 v127, v127, v244, vcc
v_cndmask_b32 v167, v167, v245, vcc
v_cmp_le_u32 vcc, 7344, v47
s_nop 1
v_cndmask_b32 v127, v127, v246, vcc
v_cndmask_b32 v167, v167, v247, vcc
v_mad_u32_u24 v127, v127, v47, v167
v_lshrrev_b32 v127, 20, v127
v_lshl_add_u32 v167, v127, 2, s11
ds_add_rtn_u32 v167, v167, v7
s_waitcnt vmcnt(11)
v_cmp_le_u32 vcc, 5436, v48
s_nop 1
v_cndmask_b32 v128, v240, v242, vcc
v_cndmask_b32 v168, v241, v243, vcc
v_cmp_le_u32 vcc, 6432, v48
s_nop 1
v_cndmask_b32 v128, v128, v244, vcc
v_cndmask_b32 v168, v168, v245, vcc
v_cmp_le_u32 vcc, 7344, v48
s_nop 1
v_cndmask_b32 v128, v128, v246, vcc
v_cndmask_b32 v168, v168, v247, vcc
v_mad_u32_u24 v128, v128, v48, v168
v_lshrrev_b32 v128, 20, v128
v_lshl_add_u32 v168, v128, 2, s11
ds_add_rtn_u32 v168, v168, v7
v_cmp_le_u32 vcc, 5436, v49
s_nop 1
v_cndmask_b32 v129, v240, v242, vcc
v_cndmask_b32 v169, v241, v243, vcc
v_cmp_le_u32 vcc, 6432, v49
s_nop 1
v_cndmask_b32 v129, v129, v244, vcc
v_cndmask_b32 v169, v169, v245, vcc
v_cmp_le_u32 vcc, 7344, v49
s_nop 1
v_cndmask_b32 v129, v129, v246, vcc
v_cndmask_b32 v169, v169, v247, vcc
v_mad_u32_u24 v129, v129, v49, v169
v_lshrrev_b32 v129, 20, v129
v_lshl_add_u32 v169, v129, 2, s11
ds_add_rtn_u32 v169, v169, v7
v_cmp_le_u32 vcc, 5436, v50
s_nop 1
v_cndmask_b32 v130, v240, v242, vcc
v_cndmask_b32 v170, v241, v243, vcc
v_cmp_le_u32 vcc, 6432, v50
s_nop 1
v_cndmask_b32 v130, v130, v244, vcc
v_cndmask_b32 v170, v170, v245, vcc
v_cmp_le_u32 vcc, 7344, v50
s_nop 1
v_cndmask_b32 v130, v130, v246, vcc
v_cndmask_b32 v170, v170, v247, vcc
v_mad_u32_u24 v130, v130, v50, v170
v_lshrrev_b32 v130, 20, v130
v_lshl_add_u32 v170, v130, 2, s11
ds_add_rtn_u32 v170, v170, v7
v_cmp_le_u32 vcc, 5436, v51
s_nop 1
v_cndmask_b32 v131, v240, v242, vcc
v_cndmask_b32 v171, v241, v243, vcc
v_cmp_le_u32 vcc, 6432, v51
s_nop 1
v_cndmask_b32 v131, v131, v244, vcc
v_cndmask_b32 v171, v171, v245, vcc
v_cmp_le_u32 vcc, 7344, v51
s_nop 1
v_cndmask_b32 v131, v131, v246, vcc
v_cndmask_b32 v171, v171, v247, vcc
v_mad_u32_u24 v131, v131, v51, v171
v_lshrrev_b32 v131, 20, v131
v_lshl_add_u32 v171, v131, 2, s11
ds_add_rtn_u32 v171, v171, v7
s_waitcnt vmcnt(10)
s_mov_b64 exec, s[12:13]
v_cmp_le_u32 vcc, 5436, v52
s_nop 1
v_cndmask_b32 v132, v240, v242, vcc
v_cndmask_b32 v172, v241, v243, vcc
v_cmp_le_u32 vcc, 6432, v52
s_nop 1
v_cndmask_b32 v132, v132, v244, vcc
v_cndmask_b32 v172, v172, v245, vcc
v_cmp_le_u32 vcc, 7344, v52
s_nop 1
v_cndmask_b32 v132, v132, v246, vcc
v_cndmask_b32 v172, v172, v247, vcc
v_mad_u32_u24 v132, v132, v52, v172
v_lshrrev_b32 v132, 20, v132
v_lshl_add_u32 v172, v132, 2, s11
ds_add_rtn_u32 v172, v172, v7
v_cmp_le_u32 vcc, 5436, v53
s_nop 1
v_cndmask_b32 v133, v240, v242, vcc
v_cndmask_b32 v173, v241, v243, vcc
v_cmp_le_u32 vcc, 6432, v53
s_nop 1
v_cndmask_b32 v133, v133, v244, vcc
v_cndmask_b32 v173, v173, v245, vcc
v_cmp_le_u32 vcc, 7344, v53
s_nop 1
v_cndmask_b32 v133, v133, v246, vcc
v_cndmask_b32 v173, v173, v247, vcc
v_mad_u32_u24 v133, v133, v53, v173
v_lshrrev_b32 v133, 20, v133
v_lshl_add_u32 v173, v133, 2, s11
ds_add_rtn_u32 v173, v173, v7
v_cmp_le_u32 vcc, 5436, v54
s_nop 1
v_cndmask_b32 v134, v240, v242, vcc
v_cndmask_b32 v174, v241, v243, vcc
v_cmp_le_u32 vcc, 6432, v54
s_nop 1
v_cndmask_b32 v134, v134, v244, vcc
v_cndmask_b32 v174, v174, v245, vcc
v_cmp_le_u32 vcc, 7344, v54
s_nop 1
v_cndmask_b32 v134, v134, v246, vcc
v_cndmask_b32 v174, v174, v247, vcc
v_mad_u32_u24 v134, v134, v54, v174
v_lshrrev_b32 v134, 20, v134
v_lshl_add_u32 v174, v134, 2, s11
ds_add_rtn_u32 v174, v174, v7
v_cmp_le_u32 vcc, 5436, v55
s_nop 1
v_cndmask_b32 v135, v240, v242, vcc
v_cndmask_b32 v175, v241, v243, vcc
v_cmp_le_u32 vcc, 6432, v55
s_nop 1
v_cndmask_b32 v135, v135, v244, vcc
v_cndmask_b32 v175, v175, v245, vcc
v_cmp_le_u32 vcc, 7344, v55
s_nop 1
v_cndmask_b32 v135, v135, v246, vcc
v_cndmask_b32 v175, v175, v247, vcc
v_mad_u32_u24 v135, v135, v55, v175
v_lshrrev_b32 v135, 20, v135
v_lshl_add_u32 v175, v135, 2, s11
ds_add_rtn_u32 v175, v175, v7
s_mov_b64 exec, -1
s_waitcnt vmcnt(9) lgkmcnt(15)
v_and_b32 v8, 0xff, v136
v_lshl_or_b32 v56, v16, 18, v56
v_lshlrev_b32 v8, 2, v8
v_lshl_add_u32 v8, v96, 10, v8
ds_write_b32 v8, v56
v_and_b32 v8, 0xff, v137
v_lshl_or_b32 v57, v17, 18, v57
v_lshlrev_b32 v8, 2, v8
v_lshl_add_u32 v8, v97, 10, v8
ds_write_b32 v8, v57
v_and_b32 v8, 0xff, v138
v_lshl_or_b32 v58, v18, 18, v58
v_lshlrev_b32 v8, 2, v8
v_lshl_add_u32 v8, v98, 10, v8
ds_write_b32 v8, v58
v_and_b32 v8, 0xff, v139
v_lshl_or_b32 v59, v19, 18, v59
v_lshlrev_b32 v8, 2, v8
v_lshl_add_u32 v8, v99, 10, v8
ds_write_b32 v8, v59
s_waitcnt vmcnt(8) lgkmcnt(15)
v_and_b32 v8, 0xff, v140
v_lshl_or_b32 v60, v20, 18, v60
v_lshlrev_b32 v8, 2, v8
v_lshl_add_u32 v8, v100, 10, v8
ds_write_b32 v8, v60
v_and_b32 v8, 0xff, v141
v_lshl_or_b32 v61, v21, 18, v61
v_lshlrev_b32 v8, 2, v8
v_lshl_add_u32 v8, v101, 10, v8
ds_write_b32 v8, v61
v_and_b32 v8, 0xff, v142
v_lshl_or_b32 v62, v22, 18, v62
v_lshlrev_b32 v8, 2, v8
v_lshl_add_u32 v8, v102, 10, v8
ds_write_b32 v8, v62
v_and_b32 v8, 0xff, v143
v_lshl_or_b32 v63, v23, 18, v63
v_lshlrev_b32 v8, 2, v8
v_lshl_add_u32 v8, v103, 10, v8
ds_write_b32 v8, v63
s_waitcnt vmcnt(7) lgkmcnt(15)
v_and_b32 v8, 0xff, v144
v_lshl_or_b32 v64, v24, 18, v64
v_lshlrev_b32 v8, 2, v8
v_lshl_add_u32 v8, v104, 10, v8
ds_write_b32 v8, v64
v_and_b32 v8, 0xff, v145
v_lshl_or_b32 v65, v25, 18, v65
v_lshlrev_b32 v8, 2, v8
v_lshl_add_u32 v8, v105, 10, v8
ds_write_b32 v8, v65
v_and_b32 v8, 0xff, v146
v_lshl_or_b32 v66, v26, 18, v66
v_lshlrev_b32 v8, 2, v8
v_lshl_add_u32 v8, v106, 10, v8
ds_write_b32 v8, v66
v_and_b32 v8, 0xff, v147
v_lshl_or_b32 v67, v27, 18, v67
v_lshlrev_b32 v8, 2, v8
v_lshl_add_u32 v8, v107, 10, v8
ds_write_b32 v8, v67
s_waitcnt vmcnt(6) lgkmcnt(15)
v_and_b32 v8, 0xff, v148
v_lshl_or_b32 v68, v28, 18, v68
v_lshlrev_b32 v8, 2, v8
v_lshl_add_u32 v8, v108, 10, v8
ds_write_b32 v8, v68
v_and_b32 v8, 0xff, v149
v_lshl_or_b32 v69, v29, 18, v69
v_lshlrev_b32 v8, 2, v8
v_lshl_add_u32 v8, v109, 10, v8
ds_write_b32 v8, v69
v_and_b32 v8, 0xff, v150
v_lshl_or_b32 v70, v30, 18, v70
v_lshlrev_b32 v8, 2, v8
v_lshl_add_u32 v8, v110, 10, v8
ds_write_b32 v8, v70
v_and_b32 v8, 0xff, v151
v_lshl_or_b32 v71, v31, 18, v71
v_lshlrev_b32 v8, 2, v8
v_lshl_add_u32 v8, v111, 10, v8
ds_write_b32 v8, v71
s_waitcnt vmcnt(5) lgkmcnt(15)
v_and_b32 v8, 0xff, v152
v_lshl_or_b32 v72, v32, 18, v72
v_lshlrev_b32 v8, 2, v8
v_lshl_add_u32 v8, v112, 10, v8
ds_write_b32 v8, v72
v_and_b32 v8, 0xff, v153
v_lshl_or_b32 v73, v33, 18, v73
v_lshlrev_b32 v8, 2, v8
v_lshl_add_u32 v8, v113, 10, v8
ds_write_b32 v8, v73
v_and_b32 v8, 0xff, v154
v_lshl_or_b32 v74, v34, 18, v74
v_lshlrev_b32 v8, 2, v8
v_lshl_add_u32 v8, v114, 10, v8
ds_write_b32 v8, v74
v_and_b32 v8, 0xff, v155
v_lshl_or_b32 v75, v35, 18, v75
v_lshlrev_b32 v8, 2, v8
v_lshl_add_u32 v8, v115, 10, v8
ds_write_b32 v8, v75
s_waitcnt vmcnt(4) lgkmcnt(15)
v_and_b32 v8, 0xff, v156
v_lshl_or_b32 v76, v36, 18, v76
v_lshlrev_b32 v8, 2, v8
v_lshl_add_u32 v8, v116, 10, v8
ds_write_b32 v8, v76
v_and_b32 v8, 0xff, v157
v_lshl_or_b32 v77, v37, 18, v77
v_lshlrev_b32 v8, 2, v8
v_lshl_add_u32 v8, v117, 10, v8
ds_write_b32 v8, v77
v_and_b32 v8, 0xff, v158
v_lshl_or_b32 v78, v38, 18, v78
v_lshlrev_b32 v8, 2, v8
v_lshl_add_u32 v8, v118, 10, v8
ds_write_b32 v8, v78
v_and_b32 v8, 0xff, v159
v_lshl_or_b32 v79, v39, 18, v79
v_lshlrev_b32 v8, 2, v8
v_lshl_add_u32 v8, v119, 10, v8
ds_write_b32 v8, v79
s_waitcnt vmcnt(3) lgkmcnt(15)
v_and_b32 v8, 0xff, v160
v_lshl_or_b32 v80, v40, 18, v80
v_lshlrev_b32 v8, 2, v8
v_lshl_add_u32 v8, v120, 10, v8
ds_write_b32 v8, v80
v_and_b32 v8, 0xff, v161
v_lshl_or_b32 v81, v41, 18, v81
v_lshlrev_b32 v8, 2, v8
v_lshl_add_u32 v8, v121, 10, v8
ds_write_b32 v8, v81
v_and_b32 v8, 0xff, v162
v_lshl_or_b32 v82, v42, 18, v82
v_lshlrev_b32 v8, 2, v8
v_lshl_add_u32 v8, v122, 10, v8
ds_write_b32 v8, v82
v_and_b32 v8, 0xff, v163
v_lshl_or_b32 v83, v43, 18, v83
v_lshlrev_b32 v8, 2, v8
v_lshl_add_u32 v8, v123, 10, v8
ds_write_b32 v8, v83
s_waitcnt vmcnt(2) lgkmcnt(15)
v_and_b32 v8, 0xff, v164
v_lshl_or_b32 v84, v44, 18, v84
v_lshlrev_b32 v8, 2, v8
v_lshl_add_u32 v8, v124, 10, v8
ds_write_b32 v8, v84
v_and_b32 v8, 0xff, v165
v_lshl_or_b32 v85, v45, 18, v85
v_lshlrev_b32 v8, 2, v8
v_lshl_add_u32 v8, v125, 10, v8
ds_write_b32 v8, v85
v_and_b32 v8, 0xff, v166
v_lshl_or_b32 v86, v46, 18, v86
v_lshlrev_b32 v8, 2, v8
v_lshl_add_u32 v8, v126, 10, v8
ds_write_b32 v8, v86
v_and_b32 v8, 0xff, v167
v_lshl_or_b32 v87, v47, 18, v87
v_lshlrev_b32 v8, 2, v8
v_lshl_add_u32 v8, v127, 10, v8
ds_write_b32 v8, v87
s_waitcnt vmcnt(1) lgkmcnt(15)
v_and_b32 v8, 0xff, v168
v_lshl_or_b32 v88, v48, 18, v88
v_lshlrev_b32 v8, 2, v8
v_lshl_add_u32 v8, v128, 10, v8
ds_write_b32 v8, v88
v_and_b32 v8, 0xff, v169
v_lshl_or_b32 v89, v49, 18, v89
v_lshlrev_b32 v8, 2, v8
v_lshl_add_u32 v8, v129, 10, v8
ds_write_b32 v8, v89
v_and_b32 v8, 0xff, v170
v_lshl_or_b32 v90, v50, 18, v90
v_lshlrev_b32 v8, 2, v8
v_lshl_add_u32 v8, v130, 10, v8
ds_write_b32 v8, v90
v_and_b32 v8, 0xff, v171
v_lshl_or_b32 v91, v51, 18, v91
v_lshlrev_b32 v8, 2, v8
v_lshl_add_u32 v8, v131, 10, v8
ds_write_b32 v8, v91
s_waitcnt vmcnt(0) lgkmcnt(15)
s_mov_b64 exec, s[12:13]
v_and_b32 v8, 0xff, v172
v_lshl_or_b32 v92, v52, 18, v92
v_lshlrev_b32 v8, 2, v8
v_lshl_add_u32 v8, v132, 10, v8
ds_write_b32 v8, v92
v_and_b32 v8, 0xff, v173
v_lshl_or_b32 v93, v53, 18, v93
v_lshlrev_b32 v8, 2, v8
v_lshl_add_u32 v8, v133, 10, v8
ds_write_b32 v8, v93
v_and_b32 v8, 0xff, v174
v_lshl_or_b32 v94, v54, 18, v94
v_lshlrev_b32 v8, 2, v8
v_lshl_add_u32 v8, v134, 10, v8
ds_write_b32 v8, v94
v_and_b32 v8, 0xff, v175
v_lshl_or_b32 v95, v55, 18, v95
v_lshlrev_b32 v8, 2, v8
v_lshl_add_u32 v8, v135, 10, v8
ds_write_b32 v8, v95
s_mov_b64 exec, -1
s_waitcnt lgkmcnt(0)
s_barrier
ds_read_b32 v8, v6
s_mul_i32 s6, s60, 16384
v_lshlrev_b32 v10, 4, v2
v_add_u32 v9, s6, v10
ds_read_b128 v[176:179], v9 offset:0
ds_read_b128 v[180:183], v9 offset:1024
ds_read_b128 v[184:187], v9 offset:2048
ds_read_b128 v[188:191], v9 offset:3072
ds_read_b128 v[192:195], v9 offset:4096
ds_read_b128 v[196:199], v9 offset:5120
ds_read_b128 v[200:203], v9 offset:6144
ds_read_b128 v[204:207], v9 offset:7168
ds_read_b128 v[208:211], v9 offset:8192
ds_read_b128 v[212:215], v9 offset:9216
ds_read_b128 v[216:219], v9 offset:10240
ds_read_b128 v[220:223], v9 offset:11264
ds_read_b128 v[224:227], v9 offset:12288
ds_read_b128 v[228:231], v9 offset:13312
ds_read_b128 v[232:235], v9 offset:14336
ds_read_b128 v[236:239], v9 offset:15360
s_mul_i32 s6, s60, 10485760
s_mul_i32 s7, s4, 40960
s_add_u32 s6, s6, s7
v_lshlrev_b32 v9, 6, v2
s_lshl_b32 s8, s4, 2
s_cmp_eq_u32 s60, 0
s_cselect_b32 s8, s8, 0x7fff0000
s_waitcnt lgkmcnt(15)
buffer_store_dword v8, v9, s[52:55], s8 offen sc1
v_cmp_lt_u32 vcc, 0x100, v8
s_cbranch_vccnz L1_eslow
s_waitcnt lgkmcnt(15)
buffer_store_dwordx4 v[176:179], v10, s[48:51], s6 offen sc1
s_add_u32 s6, s6, 655360
s_waitcnt lgkmcnt(14)
buffer_store_dwordx4 v[180:183], v10, s[48:51], s6 offen sc1
s_add_u32 s6, s6, 655360
s_waitcnt lgkmcnt(13)
buffer_store_dwordx4 v[184:187], v10, s[48:51], s6 offen sc1
s_add_u32 s6, s6, 655360
s_waitcnt lgkmcnt(12)
buffer_store_dwordx4 v[188:191], v10, s[48:51], s6 offen sc1
s_add_u32 s6, s6, 655360
s_waitcnt lgkmcnt(11)
buffer_store_dwordx4 v[192:195], v10, s[48:51], s6 offen sc1
s_add_u32 s6, s6, 655360
s_waitcnt lgkmcnt(10)
buffer_store_dwordx4 v[196:199], v10, s[48:51], s6 offen sc1
s_add_u32 s6, s6, 655360
s_waitcnt lgkmcnt(9)
buffer_store_dwordx4 v[200:203], v10, s[48:51], s6 offen sc1
s_add_u32 s6, s6, 655360
s_waitcnt lgkmcnt(8)
buffer_store_dwordx4 v[204:207], v10, s[48:51], s6 offen sc1
s_add_u32 s6, s6, 655360
s_waitcnt lgkmcnt(7)
buffer_store_dwordx4 v[208:211], v10, s[48:51], s6 offen sc1
s_add_u32 s6, s6, 655360
s_waitcnt lgkmcnt(6)
buffer_store_dwordx4 v[212:215], v10, s[48:51], s6 offen sc1
s_add_u32 s6, s6, 655360
s_waitcnt lgkmcnt(5)
buffer_store_dwordx4 v[216:219], v10, s[48:51], s6 offen sc1
s_add_u32 s6, s6, 655360
s_waitcnt lgkmcnt(4)
buffer_store_dwordx4 v[220:223], v10, s[48:51], s6 offen sc1
s_add_u32 s6, s6, 655360
s_waitcnt lgkmcnt(3)
buffer_store_dwordx4 v[224:227], v10, s[48:51], s6 offen sc1
s_add_u32 s6, s6, 655360
s_waitcnt lgkmcnt(2)
buffer_store_dwordx4 v[228:231], v10, s[48:51], s6 offen sc1
s_add_u32 s6, s6, 655360
s_waitcnt lgkmcnt(1)
buffer_store_dwordx4 v[232:235], v10, s[48:51], s6 offen sc1
s_add_u32 s6, s6, 655360
s_waitcnt lgkmcnt(0)
buffer_store_dwordx4 v[236:239], v10, s[48:51], s6 offen sc1
s_add_u32 s6, s6, 655360
s_branch L1_fin
L1_eslow:
s_mov_b32 s9, 655360
v_mul_u32_u24 v96, s9, v96
v_lshl_add_u32 v96, v136, 2, v96
v_mul_u32_u24 v97, s9, v97
v_lshl_add_u32 v97, v137, 2, v97
v_mul_u32_u24 v98, s9, v98
v_lshl_add_u32 v98, v138, 2, v98
v_mul_u32_u24 v99, s9, v99
v_lshl_add_u32 v99, v139, 2, v99
v_mul_u32_u24 v100, s9, v100
v_lshl_add_u32 v100, v140, 2, v100
v_mul_u32_u24 v101, s9, v101
v_lshl_add_u32 v101, v141, 2, v101
v_mul_u32_u24 v102, s9, v102
v_lshl_add_u32 v102, v142, 2, v102
v_mul_u32_u24 v103, s9, v103
v_lshl_add_u32 v103, v143, 2, v103
v_mul_u32_u24 v104, s9, v104
v_lshl_add_u32 v104, v144, 2, v104
v_mul_u32_u24 v105, s9, v105
v_lshl_add_u32 v105, v145, 2, v105
v_mul_u32_u24 v106, s9, v106
v_lshl_add_u32 v106, v146, 2, v106
v_mul_u32_u24 v107, s9, v107
v_lshl_add_u32 v107, v147, 2, v107
v_mul_u32_u24 v108, s9, v108
v_lshl_add_u32 v108, v148, 2, v108
v_mul_u32_u24 v109, s9, v109
v_lshl_add_u32 v109, v149, 2, v109
v_mul_u32_u24 v110, s9, v110
v_lshl_add_u32 v110, v150, 2, v110
v_mul_u32_u24 v111, s9, v111
v_lshl_add_u32 v111, v151, 2, v111
v_mul_u32_u24 v112, s9, v112
v_lshl_add_u32 v112, v152, 2, v112
v_mul_u32_u24 v113, s9, v113
v_lshl_add_u32 v113, v153, 2, v113
v_mul_u32_u24 v114, s9, v114
v_lshl_add_u32 v114, v154, 2, v114
v_mul_u32_u24 v115, s9, v115
v_lshl_add_u32 v115, v155, 2, v115
v_mul_u32_u24 v116, s9, v116
v_lshl_add_u32 v116, v156, 2, v116
v_mul_u32_u24 v117, s9, v117
v_lshl_add_u32 v117, v157, 2, v117
v_mul_u32_u24 v118, s9, v118
v_lshl_add_u32 v118, v158, 2, v118
v_mul_u32_u24 v119, s9, v119
v_lshl_add_u32 v119, v159, 2, v119
v_mul_u32_u24 v120, s9, v120
v_lshl_add_u32 v120, v160, 2, v120
v_mul_u32_u24 v121, s9, v121
v_lshl_add_u32 v121, v161, 2, v121
v_mul_u32_u24 v122, s9, v122
v_lshl_add_u32 v122, v162, 2, v122
v_mul_u32_u24 v123, s9, v123
v_lshl_add_u32 v123, v163, 2, v123
v_mul_u32_u24 v124, s9, v124
v_lshl_add_u32 v124, v164, 2, v124
v_mul_u32_u24 v125, s9, v125
v_lshl_add_u32 v125, v165, 2, v125
v_mul_u32_u24 v126, s9, v126
v_lshl_add_u32 v126, v166, 2, v126
v_mul_u32_u24 v127, s9, v127
v_lshl_add_u32 v127, v167, 2, v127
v_mul_u32_u24 v128, s9, v128
v_lshl_add_u32 v128, v168, 2, v128
v_mul_u32_u24 v129, s9, v129
v_lshl_add_u32 v129, v169, 2, v129
v_mul_u32_u24 v130, s9, v130
v_lshl_add_u32 v130, v170, 2, v130
v_mul_u32_u24 v131, s9, v131
v_lshl_add_u32 v131, v171, 2, v131
v_mul_u32_u24 v132, s9, v132
v_lshl_add_u32 v132, v172, 2, v132
v_mul_u32_u24 v133, s9, v133
v_lshl_add_u32 v133, v173, 2, v133
v_mul_u32_u24 v134, s9, v134
v_lshl_add_u32 v134, v174, 2, v134
v_mul_u32_u24 v135, s9, v135
v_lshl_add_u32 v135, v175, 2, v135
buffer_store_dword v56, v96, s[48:51], s7 offen sc1
buffer_store_dword v57, v97, s[48:51], s7 offen sc1
buffer_store_dword v58, v98, s[48:51], s7 offen sc1
buffer_store_dword v59, v99, s[48:51], s7 offen sc1
buffer_store_dword v60, v100, s[48:51], s7 offen sc1
buffer_store_dword v61, v101, s[48:51], s7 offen sc1
buffer_store_dword v62, v102, s[48:51], s7 offen sc1
buffer_store_dword v63, v103, s[48:51], s7 offen sc1
buffer_store_dword v64, v104, s[48:51], s7 offen sc1
buffer_store_dword v65, v105, s[48:51], s7 offen sc1
buffer_store_dword v66, v106, s[48:51], s7 offen sc1
buffer_store_dword v67, v107, s[48:51], s7 offen sc1
buffer_store_dword v68, v108, s[48:51], s7 offen sc1
buffer_store_dword v69, v109, s[48:51], s7 offen sc1
buffer_store_dword v70, v110, s[48:51], s7 offen sc1
buffer_store_dword v71, v111, s[48:51], s7 offen sc1
buffer_store_dword v72, v112, s[48:51], s7 offen sc1
buffer_store_dword v73, v113, s[48:51], s7 offen sc1
buffer_store_dword v74, v114, s[48:51], s7 offen sc1
buffer_store_dword v75, v115, s[48:51], s7 offen sc1
buffer_store_dword v76, v116, s[48:51], s7 offen sc1
buffer_store_dword v77, v117, s[48:51], s7 offen sc1
buffer_store_dword v78, v118, s[48:51], s7 offen sc1
buffer_store_dword v79, v119, s[48:51], s7 offen sc1
buffer_store_dword v80, v120, s[48:51], s7 offen sc1
buffer_store_dword v81, v121, s[48:51], s7 offen sc1
buffer_store_dword v82, v122, s[48:51], s7 offen sc1
buffer_store_dword v83, v123, s[48:51], s7 offen sc1
buffer_store_dword v84, v124, s[48:51], s7 offen sc1
buffer_store_dword v85, v125, s[48:51], s7 offen sc1
buffer_store_dword v86, v126, s[48:51], s7 offen sc1
buffer_store_dword v87, v127, s[48:51], s7 offen sc1
buffer_store_dword v88, v128, s[48:51], s7 offen sc1
buffer_store_dword v89, v129, s[48:51], s7 offen sc1
buffer_store_dword v90, v130, s[48:51], s7 offen sc1
buffer_store_dword v91, v131, s[48:51], s7 offen sc1
s_mov_b64 exec, s[12:13]
buffer_store_dword v92, v132, s[48:51], s7 offen sc1
buffer_store_dword v93, v133, s[48:51], s7 offen sc1
buffer_store_dword v94, v134, s[48:51], s7 offen sc1
buffer_store_dword v95, v135, s[48:51], s7 offen sc1
s_mov_b64 exec, -1
s_branch L1_fin
L2_entry:
s_load_dwordx2 s[4:5], s[0:1], 88
s_load_dwordx2 s[60:61], s[0:1], 0
s_load_dwordx2 s[52:53], s[0:1], 24
s_load_dwordx2 s[56:57], s[0:1], 72
s_and_b32 s35, s2, 7
s_lshr_b32 s37, s2, 3
s_add_u32 s37, s37, 30
s_and_b32 s37, s37, 31
v_lshrrev_b32 v1, 6, v0
s_mov_b32 s36, -1
v_readfirstlane_b32 s38, v1
s_cmp_lt_u32 s37, 30
s_cbranch_scc1 L2_att
s_lshl_b32 s39, s35, 1
s_add_u32 s39, s39, s37
s_sub_u32 s39, s39, 30
s_cmp_lt_u32 s38, 3
s_cbranch_scc1 LE_start
s_cmp_ge_u32 s39, 12
s_cbranch_scc1 L2_end
s_and_b32 s36, s39, 1
s_lshr_b32 s37, s39, 1
s_mov_b32 s38, 39
v_and_b32 v0, 63, v0
s_branch L2_att2
L2_att:
s_mul_i32 s38, s37, 26
s_lshr_b32 s38, s38, 8
s_mul_i32 s39, s38, 10
s_sub_u32 s39, s37, s39
s_and_b32 s37, s35, 1
s_mul_i32 s37, s37, 3
s_add_u32 s37, s37, s38
s_and_b32 s38, s35, 1
s_mul_i32 s38, s38, 5
s_add_u32 s35, s35, s38
s_and_b32 s35, s35, 7
s_lshr_b32 s38, s35, 1
s_mul_i32 s38, s38, 10
s_add_u32 s38, s38, s39
L2_att2:
v_lshrrev_b32 v1, 6, v0
v_and_b32 v243, 63, v0
v_lshlrev_b32 v243, 4, v243
v_readfirstlane_b32 s34, v1
s_mov_b32 s50, 0xe1a06800
s_mov_b32 s51, 0x4e20ad04
s_mul_i32 s39, s37, 9
s_lshr_b64 s[50:51], s[50:51], s39
s_and_b32 s39, s50, 0x1ff
s_bfe_u32 s49, s50, 0x90009
s_sub_u32 s31, s49, s39
s_sub_u32 s31, s31, 4
s_lshl_b32 s39, s39, 14
s_lshl_b32 s49, s49, 14
s_add_u32 s28, s39, 0x4000
s_cmp_eq_u32 s37, 5
s_addc_u32 s31, s31, 0
s_cmp_eq_u32 s37, 5
s_cselect_b32 s28, s39, s28
s_cselect_b32 s39, 5111808, s39
s_cselect_b32 s49, 5120000, s49
s_cselect_b32 s33, 0xff800000, 0
s_mov_b32 s32, 0x5d800000
v_and_b32 v2, 63, v0
v_bfe_u32 v3, v2, 3, 2
v_bfe_u32 v4, v2, 2, 1
v_lshlrev_b32 v241, 12, v3
v_lshl_or_b32 v241, v4, 9, v241
v_lshl_or_b32 v241, v1, 7, v241
v_lshrrev_b32 v4, 5, v2
v_lshl_or_b32 v241, v4, 6, v241
v_and_b32 v3, 2, v3
v_and_b32 v4, 3, v2
v_xor_b32 v3, v3, v4
v_lshl_or_b32 v241, v3, 4, v241
s_cmp_eq_u32 s38, 39
s_cbranch_scc1 LT_disp
s_cmp_lt_u32 s37, 3
s_cselect_b32 s101, 1, -1
s_cselect_b32 s39, 0, 103
s_cselect_b32 s3, 0, 3
s_sub_u32 s3, s37, s3
s_mul_i32 s3, s3, 104
s_add_u32 s39, s39, s3
s_cmp_eq_u32 s37, 5
s_addc_u32 s39, s39, 0
s_lshl_b32 s101, s101, 14
s_lshl_b32 s39, s39, 14
s_add_u32 s28, s39, s101
s_mov_b32 s49, 5120000
s_mov_b32 s31, 40
s_mov_b32 s100, 5
s_lshl_b32 s30, s34, 12
s_lshl_b32 s50, s34, 13
s_add_u32 s50, s50, 0x20000
s_mov_b32 m0, s30
s_cmp_lt_u32 s37, 3
s_mov_b32 s40, 0x4682d124
s_cselect_b32 s40, s40, 0xc003fdb0
s_cselect_b32 s41, 11, 15
s_cselect_b32 s3, 0, 36
s_lshl_b32 s94, s37, 2
s_add_u32 s94, s94, s34
s_mul_i32 s94, s94, 3
s_sub_u32 s3, s94, s3
s_lshr_b64 s[40:41], s[40:41], s3
s_and_b32 s94, s40, 3
s_bfe_u32 s95, s40, 0x10002
s_mov_b32 s6, 0x92c51840
s_mov_b32 s7, 0xfb73ea6d
s_mul_i32 s3, s37, 12
s_min_u32 s3, s3, 56
s_lshr_b64 s[6:7], s[6:7], s3
s_bfe_u32 s29, s6, 0x40008
s_bfe_u32 s7, s6, 0x40004
s_and_b32 s6, s6, 15
s_cmp_lt_u32 s37, 4
s_cselect_b32 s29, s29, 16
s_lshl_b32 s3, s38, 17
s_lshl_b32 s51, s34, 7
s_add_u32 s3, s3, s51
s_lshl_b32 s6, s6, 13
s_add_u32 s6, s6, s3
s_lshl_b32 s7, s7, 13
s_add_u32 s7, s7, s3
s_lshl_b32 s29, s29, 13
s_add_u32 s29, s29, s3
s_mov_b64 s[96:97], 0
s_lshr_b32 s3, s6, 9
s_mul_i32 s90, s3, 6945
s_mov_b32 s91, s90
s_mul_i32 s90, s3, 6317
s_add_u32 s90, s90, 0x340674
s_cmp_lt_u32 s3, 5436
s_cselect_b32 s91, s91, s90
s_mul_i32 s90, s3, 6899
s_add_u32 s90, s90, 0xfffae6a0
s_cmp_lt_u32 s3, 6432
s_cselect_b32 s91, s91, s90
s_mul_i32 s90, s3, 6242
s_add_u32 s90, s90, 0x4484a0
s_cmp_lt_u32 s3, 7344
s_cselect_b32 s91, s91, s90
s_lshr_b32 s3, s91, 20
s_bitset1_b64 s[96:97], s3
s_lshr_b32 s3, s6, 9
s_add_u32 s3, s3, 15
s_mul_i32 s90, s3, 6945
s_mov_b32 s91, s90
s_mul_i32 s90, s3, 6317
s_add_u32 s90, s90, 0x340674
s_cmp_lt_u32 s3, 5436
s_cselect_b32 s91, s91, s90
s_mul_i32 s90, s3, 6899
s_add_u32 s90, s90, 0xfffae6a0
s_cmp_lt_u32 s3, 6432
s_cselect_b32 s91, s91, s90
s_mul_i32 s90, s3, 6242
s_add_u32 s90, s90, 0x4484a0
s_cmp_lt_u32 s3, 7344
s_cselect_b32 s91, s91, s90
s_lshr_b32 s3, s91, 20
s_bitset1_b64 s[96:97], s3
s_lshr_b32 s3, s7, 9
s_mul_i32 s90, s3, 6945
s_mov_b32 s91, s90
s_mul_i32 s90, s3, 6317
s_add_u32 s90, s90, 0x340674
s_cmp_lt_u32 s3, 5436
s_cselect_b32 s91, s91, s90
s_mul_i32 s90, s3, 6899
s_add_u32 s90, s90, 0xfffae6a0
s_cmp_lt_u32 s3, 6432
s_cselect_b32 s91, s91, s90
s_mul_i32 s90, s3, 6242
s_add_u32 s90, s90, 0x4484a0
s_cmp_lt_u32 s3, 7344
s_cselect_b32 s91, s91, s90
s_lshr_b32 s3, s91, 20
s_bitset1_b64 s[96:97], s3
s_lshr_b32 s3, s7, 9
s_add_u32 s3, s3, 15
s_mul_i32 s90, s3, 6945
s_mov_b32 s91, s90
s_mul_i32 s90, s3, 6317
s_add_u32 s90, s90, 0x340674
s_cmp_lt_u32 s3, 5436
s_cselect_b32 s91, s91, s90
s_mul_i32 s90, s3, 6899
s_add_u32 s90, s90, 0xfffae6a0
s_cmp_lt_u32 s3, 6432
s_cselect_b32 s91, s91, s90
s_mul_i32 s90, s3, 6242
s_add_u32 s90, s90, 0x4484a0
s_cmp_lt_u32 s3, 7344
s_cselect_b32 s91, s91, s90
s_lshr_b32 s3, s91, 20
s_bitset1_b64 s[96:97], s3
s_lshr_b32 s3, s29, 9
s_mul_i32 s90, s3, 6945
s_mov_b32 s91, s90
s_mul_i32 s90, s3, 6317
s_add_u32 s90, s90, 0x340674
s_cmp_lt_u32 s3, 5436
s_cselect_b32 s91, s91, s90
s_mul_i32 s90, s3, 6899
s_add_u32 s90, s90, 0xfffae6a0
s_cmp_lt_u32 s3, 6432
s_cselect_b32 s91, s91, s90
s_mul_i32 s90, s3, 6242
s_add_u32 s90, s90, 0x4484a0
s_cmp_lt_u32 s3, 7344
s_cselect_b32 s91, s91, s90
s_lshr_b32 s3, s91, 20
s_bitset1_b64 s[96:97], s3
s_lshr_b32 s3, s29, 9
s_add_u32 s3, s3, 15
s_mul_i32 s90, s3, 6945
s_mov_b32 s91, s90
s_mul_i32 s90, s3, 6317
s_add_u32 s90, s90, 0x340674
s_cmp_lt_u32 s3, 5436
s_cselect_b32 s91, s91, s90
s_mul_i32 s90, s3, 6899
s_add_u32 s90, s90, 0xfffae6a0
s_cmp_lt_u32 s3, 6432
s_cselect_b32 s91, s91, s90
s_mul_i32 s90, s3, 6242
s_add_u32 s90, s90, 0x4484a0
s_cmp_lt_u32 s3, 7344
s_cselect_b32 s91, s91, s90
s_lshr_b32 s3, s91, 20
s_bitset1_b64 s[96:97], s3
s_mul_i32 s3, s38, 6
s_add_u32 s3, s3, s37
s_cmp_eq_u32 s3, 233
s_cselect_b32 s3, 0, s37
s_cmp_lt_u32 s3, 4
s_cselect_b32 s29, s29, 0x70000000
s_lshl_b32 s51, s38, 5
s_lshl_b32 s3, s34, 3
s_add_u32 s51, s51, s3
s_add_u32 s51, s51, s37
s_mul_i32 s51, s51, 128
s_add_u32 s51, s51, 0x7c00000
s_lshr_b32 s40, s39, 17
s_min_u32 s40, s40, 38
s_lshr_b32 s41, s28, 17
s_add_u32 s3, s28, s101
s_lshr_b32 s3, s3, 17
v_mov_b32 v5, s38
v_mov_b32 v6, s40
v_cmp_lt_u32 vcc, 0x7f, v243
s_nop 1
v_cndmask_b32 v5, v5, v6, vcc
v_mov_b32 v6, s41
v_cmp_lt_u32 vcc, 0xff, v243
s_nop 1
v_cndmask_b32 v5, v5, v6, vcc
v_mov_b32 v6, s3
v_cmp_lt_u32 vcc, 0x17f, v243
s_nop 1
v_cndmask_b32 v5, v5, v6, vcc
v_bfe_u32 v6, v243, 4, 3
v_min_u32 v6, 5, v6
v_mad_u32_u24 v5, v5, 6, v6
v_lshlrev_b32 v5, 7, v5
v_add_u32 v5, 0x7c2a000, v5
s_mul_i32 s3, s101, 54
s_add_u32 s3, s3, s39
s_min_u32 s41, s3, s39
s_max_u32 s3, s3, s39
s_lshr_b32 s41, s41, 17
s_min_u32 s40, s40, s41
s_mul_i32 s40, s40, 6
s_lshr_b32 s3, s3, 17
s_min_u32 s3, s3, 38
s_mul_i32 s3, s3, 6
s_add_u32 s3, s3, 5
v_lshrrev_b32 v230, 4, v243
v_add_u32 v230, s40, v230
v_min_u32 v230, s3, v230
v_lshlrev_b32 v230, 7, v230
v_add_u32 v230, 0x7c2a000, v230
s_waitcnt lgkmcnt(0)
s_add_u32 s12, s4, 0x6800000
s_addc_u32 s13, s5, 0
s_mov_b32 s14, 0x0
s_mov_b32 s15, 0x00020000
s_mov_b32 s14, s49
s_add_u32 s8, s4, 0x0
s_addc_u32 s9, s5, 0
s_mov_b32 s10, 0x4e4000
s_mov_b32 s11, 0x00020000
s_mul_i32 s35, s37, 0x600000
s_add_u32 s20, s4, 0x2000000
s_addc_u32 s21, s5, 0
s_add_u32 s20, s20, s35
s_addc_u32 s21, s21, 0
s_mov_b32 s22, 0x4e4000
s_mov_b32 s23, 0x00020000
s_add_u32 s24, s4, 0x6000000
s_addc_u32 s25, s5, 0
s_mov_b32 s26, 0x139000
s_mov_b32 s27, 0x00020000
s_lshl_b32 s35, s38, 4
s_lshl_b32 s41, s34, 2
s_add_u32 s35, s35, s41
s_lshl_b32 s40, s35, 13
s_lshl_b32 s94, s94, 13
s_add_u32 s40, s40, s94
s_xor_b32 s41, s40, 8192
s_xor_b32 s42, s40, 16384
s_xor_b32 s43, s40, 24576
s_add_u32 s44, s40, 4096
s_add_u32 s45, s41, 4096
s_add_u32 s46, s42, 4096
s_add_u32 s47, s43, 4096
s_lshl_b32 s48, s35, 10
s_lshl_b32 s35, s37, 3
s_add_u32 s48, s48, s35
v_mov_b32 v232, 0
v_mov_b32 v233, 0
v_mov_b32 v234, 0
v_mov_b32 v235, 0
v_bfe_u32 v240, v243, 4, 3
v_lshlrev_b32 v240, 6, v240
v_bfe_u32 v242, v243, 7, 1
v_lshl_or_b32 v240, v242, 10, v240
v_bfe_u32 v242, v243, 8, 2
v_lshl_or_b32 v240, v242, 4, v240
v_bfe_u32 v242, v243, 6, 1
v_lshlrev_b32 v242, 5, v242
v_xor_b32 v240, v240, v242
v_and_b32 v246, 0x1c0, v243
v_bfe_u32 v242, v243, 9, 1
v_lshl_or_b32 v246, v242, 10, v246
v_bfe_u32 v242, v243, 8, 1
v_lshl_or_b32 v246, v242, 5, v246
v_bfe_u32 v242, v243, 4, 2
v_lshl_or_b32 v246, v242, 3, v246
v_xor_b32 v247, 32, v246
v_bfe_i32 v242, v243, 8, 1
v_and_b32 v192, s33, v242
v_and_b32 v193, s33, v242
v_and_b32 v194, s33, v242
v_and_b32 v195, s33, v242
v_mfma_f32_32x32x16_bf16 a[0:15], v[232:235], v[232:235], 0
v_mfma_f32_32x32x16_bf16 a[16:31], v[232:235], v[232:235], 0
v_mfma_f32_32x32x16_bf16 a[32:47], v[232:235], v[232:235], 0
v_mfma_f32_32x32x16_bf16 a[48:63], v[232:235], v[232:235], 0
v_mfma_f32_32x32x16_bf16 a[64:79], v[232:235], v[232:235], 0
v_mfma_f32_32x32x16_bf16 a[80:95], v[232:235], v[232:235], 0
v_mfma_f32_32x32x16_bf16 a[96:111], v[232:235], v[232:235], 0
v_mfma_f32_32x32x16_bf16 a[112:127], v[232:235], v[232:235], 0
v_mfma_f32_32x32x16_bf16 a[128:143], v[232:235], v[232:235], 0
v_mfma_f32_32x32x16_bf16 a[144:159], v[232:235], v[232:235], 0
v_mfma_f32_32x32x16_bf16 a[160:175], v[232:235], v[232:235], 0
v_mfma_f32_32x32x16_bf16 a[176:191], v[232:235], v[232:235], 0
v_mfma_f32_32x32x16_bf16 a[192:207], v[232:235], v[232:235], 0
v_mfma_f32_32x32x16_bf16 a[208:223], v[232:235], v[232:235], 0
v_mfma_f32_32x32x16_bf16 a[224:239], v[232:235], v[232:235], 0
v_mfma_f32_32x32x16_bf16 a[240:255], v[232:235], v[232:235], 0
s_add_u32 s16, s4, 0x0
s_addc_u32 s17, s5, 0
s_mov_b32 s18, 0x10000000
s_mov_b32 s19, 0x00020000
s_mov_b32 s3, 0x10000
LM_pa:
buffer_load_dwordx2 v[6:7], v5, s[16:19], 0 offen sc1
s_sub_u32 s3, s3, 1
s_waitcnt vmcnt(0)
s_cbranch_scc1 LM_pa_go
v_cmp_ne_u64 vcc, s[98:99], v[6:7]
s_nop 1
s_cbranch_vccnz LM_pa
LM_pa_go:
buffer_load_dwordx4 v241, s[12:15], s39 offen offset:0 sc1 lds
buffer_load_dwordx4 v241, s[12:15], s39 offen offset:1024 sc1 lds
buffer_load_dwordx4 v241, s[12:15], s39 offen offset:2048 sc1 lds
buffer_load_dwordx4 v241, s[12:15], s39 offen offset:3072 sc1 lds
s_add_u32 m0, s30, 0x4000
s_nop 0
buffer_load_dwordx4 v241, s[12:15], s28 offen offset:0 sc1 lds
buffer_load_dwordx4 v241, s[12:15], s28 offen offset:1024 sc1 lds
buffer_load_dwordx4 v[0:3], v243, s[8:11], s40 offen offset:0 sc1
buffer_load_dwordx4 v[32:35], v243, s[8:11], s41 offen offset:0 sc1
buffer_load_dwordx4 v[64:67], v243, s[8:11], s42 offen offset:0 sc1
buffer_load_dwordx4 v[96:99], v243, s[8:11], s43 offen offset:0 sc1
buffer_load_dwordx4 v[4:7], v243, s[8:11], s40 offen offset:1024 sc1
buffer_load_dwordx4 v[36:39], v243, s[8:11], s41 offen offset:1024 sc1
buffer_load_dwordx4 v[68:71], v243, s[8:11], s42 offen offset:1024 sc1
buffer_load_dwordx4 v[100:103], v243, s[8:11], s43 offen offset:1024 sc1
buffer_load_dwordx4 v[8:11], v243, s[8:11], s40 offen offset:2048 sc1
buffer_load_dwordx4 v[40:43], v243, s[8:11], s41 offen offset:2048 sc1
buffer_load_dwordx4 v[72:75], v243, s[8:11], s42 offen offset:2048 sc1
buffer_load_dwordx4 v[104:107], v243, s[8:11], s43 offen offset:2048 sc1
buffer_load_dwordx4 v[12:15], v243, s[8:11], s40 offen offset:3072 sc1
buffer_load_dwordx4 v[44:47], v243, s[8:11], s41 offen offset:3072 sc1
buffer_load_dwordx4 v[76:79], v243, s[8:11], s42 offen offset:3072 sc1
buffer_load_dwordx4 v[108:111], v243, s[8:11], s43 offen offset:3072 sc1
buffer_load_dwordx4 v[16:19], v243, s[8:11], s44 offen offset:0 sc1
buffer_load_dwordx4 v[48:51], v243, s[8:11], s45 offen offset:0 sc1
buffer_load_dwordx4 v[80:83], v243, s[8:11], s46 offen offset:0 sc1
buffer_load_dwordx4 v[112:115], v243, s[8:11], s47 offen offset:0 sc1
buffer_load_dwordx2 v[228:229], v230, s[16:19], 0 offen sc1
s_waitcnt vmcnt(21)
s_barrier
ds_read_b128 v[208:211], v240 offset:0
ds_read_b128 v[212:215], v240 offset:2048
ds_read_b128 v[216:219], v240 offset:16384
ds_read_b128 v[220:223], v240 offset:512
s_waitcnt lgkmcnt(3)
s_waitcnt vmcnt(17)
v_mfma_f32_16x16x32_bf16 v[128:131], v[208:211], v[0:3], v[192:195]
buffer_load_dwordx4 v[20:23], v243, s[8:11], s44 offen offset:1024 sc1
v_mfma_f32_16x16x32_bf16 v[132:135], v[208:211], v[32:35], v[192:195]
v_mfma_f32_16x16x32_bf16 v[136:139], v[208:211], v[64:67], v[192:195]
v_mfma_f32_16x16x32_bf16 v[140:143], v[208:211], v[96:99], v[192:195]
ds_read_b128 v[208:211], v240 offset:2560
s_waitcnt lgkmcnt(3)
buffer_load_dwordx4 v[52:55], v243, s[8:11], s45 offen offset:1024 sc1
v_mfma_f32_16x16x32_bf16 v[144:147], v[212:215], v[0:3], v[192:195]
v_mfma_f32_16x16x32_bf16 v[148:151], v[212:215], v[32:35], v[192:195]
v_mfma_f32_16x16x32_bf16 v[152:155], v[212:215], v[64:67], v[192:195]
buffer_load_dwordx4 v[84:87], v243, s[8:11], s46 offen offset:1024 sc1
v_mfma_f32_16x16x32_bf16 v[156:159], v[212:215], v[96:99], v[192:195]
ds_read_b128 v[212:215], v240 offset:16896
s_waitcnt lgkmcnt(3)
v_mfma_f32_16x16x32_bf16 v[176:179], v[216:219], v[0:3], 0
v_mfma_f32_16x16x32_bf16 v[180:183], v[216:219], v[32:35], 0
buffer_load_dwordx4 v[116:119], v243, s[8:11], s47 offen offset:1024 sc1
v_mfma_f32_16x16x32_bf16 v[184:187], v[216:219], v[64:67], 0
v_mfma_f32_16x16x32_bf16 v[188:191], v[216:219], v[96:99], 0
ds_read_b128 v[216:219], v240 offset:4096
s_waitcnt lgkmcnt(3)
s_waitcnt vmcnt(17)
v_mfma_f32_16x16x32_bf16 v[128:131], v[220:223], v[4:7], v[128:131]
buffer_load_dwordx4 v[24:27], v243, s[8:11], s44 offen offset:2048 sc1
v_mfma_f32_16x16x32_bf16 v[132:135], v[220:223], v[36:39], v[132:135]
v_mfma_f32_16x16x32_bf16 v[136:139], v[220:223], v[68:71], v[136:139]
v_mfma_f32_16x16x32_bf16 v[140:143], v[220:223], v[100:103], v[140:143]
ds_read_b128 v[220:223], v240 offset:6144
s_waitcnt lgkmcnt(3)
buffer_load_dwordx4 v[56:59], v243, s[8:11], s45 offen offset:2048 sc1
v_mfma_f32_16x16x32_bf16 v[144:147], v[208:211], v[4:7], v[144:147]
v_mfma_f32_16x16x32_bf16 v[148:151], v[208:211], v[36:39], v[148:151]
v_mfma_f32_16x16x32_bf16 v[152:155], v[208:211], v[68:71], v[152:155]
buffer_load_dwordx4 v[88:91], v243, s[8:11], s46 offen offset:2048 sc1
v_mfma_f32_16x16x32_bf16 v[156:159], v[208:211], v[100:103], v[156:159]
ds_read_b128 v[208:211], v240 offset:20480
s_waitcnt lgkmcnt(3)
v_mfma_f32_16x16x32_bf16 v[176:179], v[212:215], v[4:7], v[176:179]
v_mfma_f32_16x16x32_bf16 v[180:183], v[212:215], v[36:39], v[180:183]
buffer_load_dwordx4 v[120:123], v243, s[8:11], s47 offen offset:2048 sc1
v_mfma_f32_16x16x32_bf16 v[184:187], v[212:215], v[68:71], v[184:187]
v_mfma_f32_16x16x32_bf16 v[188:191], v[212:215], v[100:103], v[188:191]
ds_read_b128 v[212:215], v240 offset:4608
s_waitcnt lgkmcnt(3)
s_waitcnt vmcnt(17)
v_mfma_f32_16x16x32_bf16 v[128:131], v[216:219], v[8:11], v[128:131]
buffer_load_dwordx4 v[28:31], v243, s[8:11], s44 offen offset:3072 sc1
v_mfma_f32_16x16x32_bf16 v[132:135], v[216:219], v[40:43], v[132:135]
v_mfma_f32_16x16x32_bf16 v[136:139], v[216:219], v[72:75], v[136:139]
v_mfma_f32_16x16x32_bf16 v[140:143], v[216:219], v[104:107], v[140:143]
ds_read_b128 v[216:219], v240 offset:6656
s_waitcnt lgkmcnt(3)
buffer_load_dwordx4 v[60:63], v243, s[8:11], s45 offen offset:3072 sc1
v_mfma_f32_16x16x32_bf16 v[144:147], v[220:223], v[8:11], v[144:147]
v_mfma_f32_16x16x32_bf16 v[148:151], v[220:223], v[40:43], v[148:151]
v_mfma_f32_16x16x32_bf16 v[152:155], v[220:223], v[72:75], v[152:155]
buffer_load_dwordx4 v[92:95], v243, s[8:11], s46 offen offset:3072 sc1
v_mfma_f32_16x16x32_bf16 v[156:159], v[220:223], v[104:107], v[156:159]
ds_read_b128 v[220:223], v240 offset:20992
s_waitcnt lgkmcnt(3)
v_mfma_f32_16x16x32_bf16 v[176:179], v[208:211], v[8:11], v[176:179]
v_mfma_f32_16x16x32_bf16 v[180:183], v[208:211], v[40:43], v[180:183]
buffer_load_dwordx4 v[124:127], v243, s[8:11], s47 offen offset:3072 sc1
v_mfma_f32_16x16x32_bf16 v[184:187], v[208:211], v[72:75], v[184:187]
v_mfma_f32_16x16x32_bf16 v[188:191], v[208:211], v[104:107], v[188:191]
ds_read_b128 v[208:211], v240 offset:8192
s_waitcnt lgkmcnt(3)
s_waitcnt vmcnt(17)
v_mfma_f32_16x16x32_bf16 v[128:131], v[212:215], v[12:15], v[128:131]
s_add_u32 s16, s4, 0x0
s_addc_u32 s17, s5, 0
s_mov_b32 s18, 0x10000000
v_mfma_f32_16x16x32_bf16 v[132:135], v[212:215], v[44:47], v[132:135]
buffer_load_dwordx4 v241, s[12:15], s28 offen offset:2048 sc1 lds
s_mov_b32 s19, 0x00020000
s_add_u32 s8, s60, 0x0
v_mfma_f32_16x16x32_bf16 v[136:139], v[212:215], v[76:79], v[136:139]
s_addc_u32 s9, s61, 0
s_mov_b32 s10, 0x4e2000
s_mov_b32 s11, 0x00020000
v_mfma_f32_16x16x32_bf16 v[140:143], v[212:215], v[108:111], v[140:143]
ds_read_b128 v[212:215], v240 offset:10240
s_waitcnt lgkmcnt(3)
buffer_load_dwordx4 v241, s[12:15], s28 offen offset:3072 sc1 lds
v_mfma_f32_16x16x32_bf16 v[144:147], v[216:219], v[12:15], v[144:147]
s_mov_b32 s54, 0x4e20
s_mov_b32 s55, 0x00020000
s_mov_b32 s58, 0x4e2000
v_mfma_f32_16x16x32_bf16 v[148:151], v[216:219], v[44:47], v[148:151]
s_mov_b32 s59, 0x00020000
s_lshr_b32 s48, s40, 2
s_cmp_eq_u32 s95, 1
v_mfma_f32_16x16x32_bf16 v[152:155], v[216:219], v[76:79], v[152:155]
s_cselect_b32 s40, 0x70000000, s40
s_cselect_b32 s44, 0x70000000, s44
s_cmp_lt_u32 s37, 3
v_mfma_f32_16x16x32_bf16 v[156:159], v[216:219], v[108:111], v[156:159]
ds_read_b128 v[216:219], v240 offset:24576
s_waitcnt lgkmcnt(3)
s_cselect_b32 s3, 0, 3
v_mfma_f32_16x16x32_bf16 v[176:179], v[220:223], v[12:15], v[176:179]
s_cselect_b32 s94, 0, 8
s_sub_u32 s3, s37, s3
s_lshl_b32 s38, s38, 2
v_mfma_f32_16x16x32_bf16 v[180:183], v[220:223], v[44:47], v[180:183]
s_add_u32 s38, s38, s3
s_lshl_b32 s38, s38, 10
s_add_u32 s38, s38, 0x7c00300
v_mfma_f32_16x16x32_bf16 v[184:187], v[220:223], v[76:79], v[184:187]
s_add_u32 s94, s94, s38
s_xor_b32 s95, s94, 8
s_add_u32 s49, s95, 32
v_mfma_f32_16x16x32_bf16 v[188:191], v[220:223], v[108:111], v[188:191]
ds_read_b128 v[220:223], v240 offset:8704
s_waitcnt lgkmcnt(3)
s_waitcnt vmcnt(15)
v_mfma_f32_16x16x32_bf16 v[128:131], v[208:211], v[16:19], v[128:131]
s_cmp_eq_u32 s3, 2
s_cselect_b32 s35, s38, s94
s_cselect_b32 s49, s49, s95
v_mfma_f32_16x16x32_bf16 v[132:135], v[208:211], v[48:51], v[132:135]
s_add_u32 s28, s28, s101
s_add_u32 m0, s30, 0x8000
s_nop 0
s_mov_b32 s39, 4
v_mfma_f32_16x16x32_bf16 v[136:139], v[208:211], v[80:83], v[136:139]
v_mfma_f32_16x16x32_bf16 v[140:143], v[208:211], v[112:115], v[140:143]
ds_read_b128 v[208:211], v240 offset:10752
s_waitcnt lgkmcnt(3)
buffer_load_dwordx4 v241, s[12:15], s28 offen offset:0 sc1 lds
v_mfma_f32_16x16x32_bf16 v[144:147], v[212:215], v[16:19], v[144:147]
v_mfma_f32_16x16x32_bf16 v[148:151], v[212:215], v[48:51], v[148:151]
buffer_load_dwordx4 v241, s[12:15], s28 offen offset:1024 sc1 lds
v_mfma_f32_16x16x32_bf16 v[152:155], v[212:215], v[80:83], v[152:155]
v_mfma_f32_16x16x32_bf16 v[156:159], v[212:215], v[112:115], v[156:159]
ds_read_b128 v[212:215], v240 offset:25088
s_waitcnt lgkmcnt(3)
v_mfma_f32_16x16x32_bf16 v[176:179], v[216:219], v[16:19], v[176:179]
v_mfma_f32_16x16x32_bf16 v[180:183], v[216:219], v[48:51], v[180:183]
v_mfma_f32_16x16x32_bf16 v[184:187], v[216:219], v[80:83], v[184:187]
v_mfma_f32_16x16x32_bf16 v[188:191], v[216:219], v[112:115], v[188:191]
ds_read_b128 v[216:219], v240 offset:12288
s_waitcnt lgkmcnt(3)
s_waitcnt vmcnt(12)
v_mfma_f32_16x16x32_bf16 v[128:131], v[220:223], v[20:23], v[128:131]
v_mfma_f32_16x16x32_bf16 v[132:135], v[220:223], v[52:55], v[132:135]
buffer_load_dwordx4 v241, s[12:15], s28 offen offset:2048 sc1 lds
v_mfma_f32_16x16x32_bf16 v[136:139], v[220:223], v[84:87], v[136:139]
v_mfma_f32_16x16x32_bf16 v[140:143], v[220:223], v[116:119], v[140:143]
ds_read_b128 v[220:223], v240 offset:14336
s_waitcnt lgkmcnt(3)
buffer_load_dwordx4 v241, s[12:15], s28 offen offset:3072 sc1 lds
v_mfma_f32_16x16x32_bf16 v[144:147], v[208:211], v[20:23], v[144:147]
v_mfma_f32_16x16x32_bf16 v[148:151], v[208:211], v[52:55], v[148:151]
v_mfma_f32_16x16x32_bf16 v[152:155], v[208:211], v[84:87], v[152:155]
v_mfma_f32_16x16x32_bf16 v[156:159], v[208:211], v[116:119], v[156:159]
ds_read_b128 v[208:211], v240 offset:28672
s_waitcnt lgkmcnt(3)
v_mfma_f32_16x16x32_bf16 v[176:179], v[212:215], v[20:23], v[176:179]
v_mfma_f32_16x16x32_bf16 v[180:183], v[212:215], v[52:55], v[180:183]
v_mfma_f32_16x16x32_bf16 v[184:187], v[212:215], v[84:87], v[184:187]
v_mfma_f32_16x16x32_bf16 v[188:191], v[212:215], v[116:119], v[188:191]
ds_read_b128 v[212:215], v240 offset:12800
s_waitcnt lgkmcnt(3)
s_waitcnt vmcnt(10)
v_mfma_f32_16x16x32_bf16 v[128:131], v[216:219], v[24:27], v[128:131]
v_mfma_f32_16x16x32_bf16 v[132:135], v[216:219], v[56:59], v[132:135]
s_add_u32 s28, s28, s101
s_add_u32 s30, s30, 0xc000
v_mfma_f32_16x16x32_bf16 v[136:139], v[216:219], v[88:91], v[136:139]
v_mfma_f32_16x16x32_bf16 v[140:143], v[216:219], v[120:123], v[140:143]
ds_read_b128 v[216:219], v240 offset:14848
s_waitcnt lgkmcnt(3)
v_mfma_f32_16x16x32_bf16 v[144:147], v[220:223], v[24:27], v[144:147]
v_mfma_f32_16x16x32_bf16 v[148:151], v[220:223], v[56:59], v[148:151]
v_mfma_f32_16x16x32_bf16 v[152:155], v[220:223], v[88:91], v[152:155]
v_mfma_f32_16x16x32_bf16 v[156:159], v[220:223], v[120:123], v[156:159]
ds_read_b128 v[220:223], v240 offset:29184
s_waitcnt lgkmcnt(3)
v_mfma_f32_16x16x32_bf16 v[176:179], v[208:211], v[24:27], v[176:179]
v_mfma_f32_16x16x32_bf16 v[180:183], v[208:211], v[56:59], v[180:183]
v_mfma_f32_16x16x32_bf16 v[184:187], v[208:211], v[88:91], v[184:187]
v_mfma_f32_16x16x32_bf16 v[188:191], v[208:211], v[120:123], v[188:191]
s_waitcnt lgkmcnt(2)
s_waitcnt vmcnt(6)
v_mfma_f32_16x16x32_bf16 v[128:131], v[212:215], v[28:31], v[128:131]
v_mfma_f32_16x16x32_bf16 v[132:135], v[212:215], v[60:63], v[132:135]
v_mfma_f32_16x16x32_bf16 v[136:139], v[212:215], v[92:95], v[136:139]
v_mfma_f32_16x16x32_bf16 v[140:143], v[212:215], v[124:127], v[140:143]
s_waitcnt lgkmcnt(1)
v_mfma_f32_16x16x32_bf16 v[144:147], v[216:219], v[28:31], v[144:147]
v_mfma_f32_16x16x32_bf16 v[148:151], v[216:219], v[60:63], v[148:151]
v_mfma_f32_16x16x32_bf16 v[152:155], v[216:219], v[92:95], v[152:155]
v_mfma_f32_16x16x32_bf16 v[156:159], v[216:219], v[124:127], v[156:159]
s_waitcnt lgkmcnt(0)
v_mfma_f32_16x16x32_bf16 v[176:179], v[220:223], v[28:31], v[176:179]
v_mfma_f32_16x16x32_bf16 v[180:183], v[220:223], v[60:63], v[180:183]
v_mfma_f32_16x16x32_bf16 v[184:187], v[220:223], v[92:95], v[184:187]
v_mfma_f32_16x16x32_bf16 v[188:191], v[220:223], v[124:127], v[188:191]
v_max3_f32 v248, v128, v129, v130
v_max3_f32 v249, v132, v133, v134
v_max3_f32 v250, v136, v137, v138
v_max3_f32 v251, v140, v141, v142
v_max3_f32 v248, v248, v131, v144
v_max3_f32 v249, v249, v135, v148
v_max3_f32 v250, v250, v139, v152
v_max3_f32 v251, v251, v143, v156
v_max3_f32 v248, v248, v145, v146
v_max3_f32 v249, v249, v149, v150
v_max3_f32 v250, v250, v153, v154
v_max3_f32 v251, v251, v157, v158
v_max_f32 v248, v248, v147
v_max_f32 v249, v249, v151
v_max_f32 v250, v250, v155
v_max_f32 v251, v251, v159
v_mov_b32 v232, v248
v_mov_b32 v233, v249
v_mov_b32 v234, v250
v_mov_b32 v235, v251
v_permlane32_swap_b32 v248, v232
v_permlane32_swap_b32 v249, v233
v_permlane32_swap_b32 v250, v234
v_permlane32_swap_b32 v251, v235
v_max_f32 v248, v248, v232
v_max_f32 v249, v249, v233
v_max_f32 v250, v250, v234
v_max_f32 v251, v251, v235
v_mov_b32 v232, v248
v_mov_b32 v233, v249
v_mov_b32 v234, v250
v_mov_b32 v235, v251
v_permlane16_swap_b32 v248, v232
v_permlane16_swap_b32 v249, v233
v_permlane16_swap_b32 v250, v234
v_permlane16_swap_b32 v251, v235
v_max_f32 v248, v248, v232
v_max_f32 v249, v249, v233
v_max_f32 v250, v250, v234
v_max_f32 v251, v251, v235
v_ceil_f32 v248, v248
v_ceil_f32 v249, v249
v_ceil_f32 v250, v250
v_ceil_f32 v251, v251
v_sub_f32 v128, v128, v248
v_sub_f32 v129, v129, v248
v_sub_f32 v130, v130, v248
v_sub_f32 v131, v131, v248
v_exp_f32 v128, v128
v_exp_f32 v129, v129
v_exp_f32 v130, v130
v_exp_f32 v131, v131
v_sub_f32 v192, 0, v248
v_sub_f32 v193, 0, v248
v_sub_f32 v194, 0, v248
v_sub_f32 v195, 0, v248
v_sub_f32 v132, v132, v249
v_sub_f32 v133, v133, v249
v_sub_f32 v134, v134, v249
v_sub_f32 v135, v135, v249
v_exp_f32 v132, v132
v_exp_f32 v133, v133
v_exp_f32 v134, v134
v_exp_f32 v135, v135
v_sub_f32 v196, 0, v249
v_sub_f32 v197, 0, v249
v_sub_f32 v198, 0, v249
v_sub_f32 v199, 0, v249
v_sub_f32 v136, v136, v250
v_sub_f32 v137, v137, v250
v_sub_f32 v138, v138, v250
v_sub_f32 v139, v139, v250
v_exp_f32 v136, v136
v_exp_f32 v137, v137
v_exp_f32 v138, v138
v_exp_f32 v139, v139
v_sub_f32 v200, 0, v250
v_sub_f32 v201, 0, v250
v_sub_f32 v202, 0, v250
v_sub_f32 v203, 0, v250
v_sub_f32 v140, v140, v251
v_sub_f32 v141, v141, v251
v_sub_f32 v142, v142, v251
v_sub_f32 v143, v143, v251
v_exp_f32 v140, v140
v_exp_f32 v141, v141
v_exp_f32 v142, v142
v_exp_f32 v143, v143
v_sub_f32 v204, 0, v251
v_sub_f32 v205, 0, v251
v_sub_f32 v206, 0, v251
v_sub_f32 v207, 0, v251
s_waitcnt vmcnt(4)
s_barrier
ds_read_b128 v[208:211], v240 offset:18432
ds_read_b128 v[212:215], v240 offset:18944
ds_read_b128 v[216:219], v240 offset:22528
ds_read_b128 v[220:223], v240 offset:23040
v_add_f32 v144, v144, v192
v_add_f32 v145, v145, v192
v_add_f32 v146, v146, v192
v_add_f32 v147, v147, v192
v_exp_f32 v144, v144
v_exp_f32 v145, v145
v_exp_f32 v146, v146
v_exp_f32 v147, v147
v_add_f32 v148, v148, v196
v_add_f32 v149, v149, v196
v_add_f32 v150, v150, v196
v_add_f32 v151, v151, v196
v_exp_f32 v148, v148
v_exp_f32 v149, v149
v_exp_f32 v150, v150
v_exp_f32 v151, v151
v_add_f32 v152, v152, v200
v_add_f32 v153, v153, v200
v_add_f32 v154, v154, v200
v_add_f32 v155, v155, v200
v_exp_f32 v152, v152
v_exp_f32 v153, v153
v_exp_f32 v154, v154
v_exp_f32 v155, v155
v_add_f32 v156, v156, v204
v_add_f32 v157, v157, v204
v_add_f32 v158, v158, v204
v_add_f32 v159, v159, v204
v_exp_f32 v156, v156
v_exp_f32 v157, v157
v_exp_f32 v158, v158
v_exp_f32 v159, v159
v_cvt_pk_bf16_f32 v160, v128, v129
v_cvt_pk_bf16_f32 v161, v130, v131
v_cvt_pk_bf16_f32 v164, v132, v133
v_cvt_pk_bf16_f32 v165, v134, v135
v_cvt_pk_bf16_f32 v168, v136, v137
v_cvt_pk_bf16_f32 v169, v138, v139
v_cvt_pk_bf16_f32 v172, v140, v141
v_cvt_pk_bf16_f32 v173, v142, v143
v_cvt_pk_bf16_f32 v162, v144, v145
v_cvt_pk_bf16_f32 v163, v146, v147
v_cvt_pk_bf16_f32 v166, v148, v149
v_cvt_pk_bf16_f32 v167, v150, v151
v_cvt_pk_bf16_f32 v170, v152, v153
v_cvt_pk_bf16_f32 v171, v154, v155
v_cvt_pk_bf16_f32 v174, v156, v157
v_cvt_pk_bf16_f32 v175, v158, v159
v_add_f32 v224, v128, v129
v_add_f32 v225, v132, v133
v_add_f32 v226, v136, v137
v_add_f32 v227, v140, v141
v_add_f32 v224, v224, v130
v_add_f32 v225, v225, v134
v_add_f32 v226, v226, v138
v_add_f32 v227, v227, v142
v_add_f32 v224, v224, v131
v_add_f32 v225, v225, v135
v_add_f32 v226, v226, v139
v_add_f32 v227, v227, v143
v_add_f32 v224, v224, v144
v_add_f32 v225, v225, v148
v_add_f32 v226, v226, v152
v_add_f32 v227, v227, v156
v_add_f32 v224, v224, v145
v_add_f32 v225, v225, v149
v_add_f32 v226, v226, v153
v_add_f32 v227, v227, v157
v_add_f32 v224, v224, v146
v_add_f32 v225, v225, v150
v_add_f32 v226, v226, v154
v_add_f32 v227, v227, v158
v_add_f32 v224, v224, v147
v_add_f32 v225, v225, v151
v_add_f32 v226, v226, v155
v_add_f32 v227, v227, v159
v_add_f32 v128, v176, v192
v_add_f32 v129, v177, v192
v_add_f32 v130, v178, v192
v_add_f32 v131, v179, v192
v_add_f32 v132, v180, v196
v_add_f32 v133, v181, v196
v_add_f32 v134, v182, v196
v_add_f32 v135, v183, v196
v_add_f32 v136, v184, v200
v_add_f32 v137, v185, v200
v_add_f32 v138, v186, v200
v_add_f32 v139, v187, v200
v_add_f32 v140, v188, v204
v_add_f32 v141, v189, v204
v_add_f32 v142, v190, v204
v_add_f32 v143, v191, v204
v_cmp_ne_u64 vcc, s[98:99], v[228:229]
s_nop 1
s_cbranch_vccnz LM_pb
LM_pb_ret:
s_nop 1
s_waitcnt lgkmcnt(2)
v_mfma_f32_16x16x32_bf16 v[144:147], v[208:211], v[0:3], v[192:195]
v_mfma_f32_16x16x32_bf16 v[144:147], v[212:215], v[4:7], v[144:147]
v_mfma_f32_16x16x32_bf16 v[148:151], v[208:211], v[32:35], v[196:199]
v_mfma_f32_16x16x32_bf16 v[148:151], v[212:215], v[36:39], v[148:151]
v_mfma_f32_16x16x32_bf16 v[152:155], v[208:211], v[64:67], v[200:203]
v_exp_f32 v128, v128
v_mfma_f32_16x16x32_bf16 v[152:155], v[212:215], v[68:71], v[152:155]
v_exp_f32 v129, v129
v_mfma_f32_16x16x32_bf16 v[156:159], v[208:211], v[96:99], v[204:207]
ds_read_b128 v[208:211], v240 offset:26624
v_exp_f32 v130, v130
v_mfma_f32_16x16x32_bf16 v[156:159], v[212:215], v[100:103], v[156:159]
ds_read_b128 v[212:215], v240 offset:27136
s_waitcnt lgkmcnt(2)
v_add_f32 v224, v224, v128
v_mfma_f32_16x16x32_bf16 v[144:147], v[216:219], v[8:11], v[144:147]
v_exp_f32 v131, v131
v_add_f32 v224, v224, v129
v_mfma_f32_16x16x32_bf16 v[144:147], v[220:223], v[12:15], v[144:147]
v_add_f32 v224, v224, v130
v_add_f32 v224, v224, v131
v_mfma_f32_16x16x32_bf16 v[148:151], v[216:219], v[40:43], v[148:151]
v_exp_f32 v132, v132
v_mfma_f32_16x16x32_bf16 v[148:151], v[220:223], v[44:47], v[148:151]
v_exp_f32 v133, v133
v_mfma_f32_16x16x32_bf16 v[152:155], v[216:219], v[72:75], v[152:155]
v_exp_f32 v134, v134
v_add_f32 v225, v225, v132
v_mfma_f32_16x16x32_bf16 v[152:155], v[220:223], v[76:79], v[152:155]
v_exp_f32 v135, v135
v_add_f32 v225, v225, v133
v_mfma_f32_16x16x32_bf16 v[156:159], v[216:219], v[104:107], v[156:159]
ds_read_b128 v[216:219], v240 offset:30720
v_add_f32 v225, v225, v134
v_add_f32 v225, v225, v135
v_mfma_f32_16x16x32_bf16 v[156:159], v[220:223], v[108:111], v[156:159]
ds_read_b128 v[220:223], v240 offset:31232
s_waitcnt lgkmcnt(2)
v_mfma_f32_16x16x32_bf16 v[144:147], v[208:211], v[16:19], v[144:147]
v_exp_f32 v136, v136
v_mfma_f32_16x16x32_bf16 v[144:147], v[212:215], v[20:23], v[144:147]
v_add_u32 v240, 0x8000, v240
v_exp_f32 v137, v137
v_mfma_f32_16x16x32_bf16 v[148:151], v[208:211], v[48:51], v[148:151]
v_and_b32 v240, 0x1ffff, v240
v_exp_f32 v138, v138
v_mfma_f32_16x16x32_bf16 v[148:151], v[212:215], v[52:55], v[148:151]
v_add_f32 v226, v226, v136
v_exp_f32 v139, v139
v_mfma_f32_16x16x32_bf16 v[152:155], v[208:211], v[80:83], v[152:155]
v_add_f32 v226, v226, v137
v_add_f32 v226, v226, v138
v_add_f32 v226, v226, v139
v_mfma_f32_16x16x32_bf16 v[152:155], v[212:215], v[84:87], v[152:155]
v_exp_f32 v140, v140
v_mfma_f32_16x16x32_bf16 v[156:159], v[208:211], v[112:115], v[156:159]
ds_read_b64_tr_b16 v[208:209], v246 offset:0
ds_read_b64_tr_b16 v[210:211], v246 offset:2048
v_mfma_f32_16x16x32_bf16 v[156:159], v[212:215], v[116:119], v[156:159]
ds_read_b64_tr_b16 v[212:213], v247 offset:0
s_waitcnt lgkmcnt(3)
v_mfma_f32_16x16x32_bf16 v[144:147], v[216:219], v[24:27], v[144:147]
ds_read_b64_tr_b16 v[214:215], v247 offset:2048
v_exp_f32 v141, v141
v_mfma_f32_16x16x32_bf16 v[144:147], v[220:223], v[28:31], v[144:147]
v_exp_f32 v142, v142
v_add_f32 v227, v227, v140
v_mfma_f32_16x16x32_bf16 v[148:151], v[216:219], v[56:59], v[148:151]
v_exp_f32 v143, v143
v_add_f32 v227, v227, v141
v_mfma_f32_16x16x32_bf16 v[148:151], v[220:223], v[60:63], v[148:151]
v_add_f32 v227, v227, v142
v_add_f32 v227, v227, v143
v_max3_f32 v242, v224, v225, v226
v_mfma_f32_16x16x32_bf16 v[152:155], v[216:219], v[88:91], v[152:155]
v_max_f32 v242, v242, v227
v_mfma_f32_16x16x32_bf16 v[152:155], v[220:223], v[92:95], v[152:155]
v_cmp_lt_f32 vcc, s32, v242
v_mfma_f32_16x16x32_bf16 v[156:159], v[216:219], v[120:123], v[156:159]
ds_read_b64_tr_b16 v[216:217], v246 offset:512
ds_read_b64_tr_b16 v[218:219], v246 offset:2560
v_mfma_f32_16x16x32_bf16 v[156:159], v[220:223], v[124:127], v[156:159]
ds_read_b64_tr_b16 v[220:221], v247 offset:512
s_waitcnt lgkmcnt(5)
v_mfma_f32_16x16x32_bf16 a[0:3], v[160:163], v[208:211], a[0:3]
ds_read_b64_tr_b16 v[222:223], v247 offset:2560
s_cbranch_vccnz L2_rare_site4
L2_ret4:
v_mfma_f32_16x16x32_bf16 a[4:7], v[164:167], v[208:211], a[4:7]
s_mov_b32 m0, s30
v_mfma_f32_16x16x32_bf16 a[8:11], v[168:171], v[208:211], a[8:11]
buffer_load_dwordx4 v241, s[12:15], s28 offen offset:0 sc1 lds
v_mfma_f32_16x16x32_bf16 a[12:15], v[172:175], v[208:211], a[12:15]
ds_read_b64_tr_b16 v[208:209], v246 offset:4096
s_waitcnt lgkmcnt(5)
v_mfma_f32_16x16x32_bf16 a[16:19], v[160:163], v[212:215], a[16:19]
ds_read_b64_tr_b16 v[210:211], v246 offset:6144
buffer_load_dwordx4 v241, s[12:15], s28 offen offset:1024 sc1 lds
v_mfma_f32_16x16x32_bf16 a[20:23], v[164:167], v[212:215], a[20:23]
v_mfma_f32_16x16x32_bf16 a[24:27], v[168:171], v[212:215], a[24:27]
buffer_load_dwordx4 v241, s[12:15], s28 offen offset:2048 sc1 lds
v_mfma_f32_16x16x32_bf16 a[28:31], v[172:175], v[212:215], a[28:31]
ds_read_b64_tr_b16 v[212:213], v247 offset:4096
s_waitcnt lgkmcnt(5)
v_mfma_f32_16x16x32_bf16 a[32:35], v[160:163], v[216:219], a[32:35]
ds_read_b64_tr_b16 v[214:215], v247 offset:6144
v_exp_f32 v144, v144
v_mfma_f32_16x16x32_bf16 a[36:39], v[164:167], v[216:219], a[36:39]
buffer_load_dwordx4 v241, s[12:15], s28 offen offset:3072 sc1 lds
v_exp_f32 v145, v145
v_mfma_f32_16x16x32_bf16 a[40:43], v[168:171], v[216:219], a[40:43]
v_exp_f32 v146, v146
v_add_f32 v224, v224, v144
v_mfma_f32_16x16x32_bf16 a[44:47], v[172:175], v[216:219], a[44:47]
ds_read_b64_tr_b16 v[216:217], v246 offset:4608
s_waitcnt lgkmcnt(5)
v_mfma_f32_16x16x32_bf16 a[48:51], v[160:163], v[220:223], a[48:51]
ds_read_b64_tr_b16 v[218:219], v246 offset:6656
v_exp_f32 v147, v147
v_mfma_f32_16x16x32_bf16 a[52:55], v[164:167], v[220:223], a[52:55]
v_add_f32 v224, v224, v145
v_add_f32 v224, v224, v146
v_add_f32 v224, v224, v147
v_mfma_f32_16x16x32_bf16 a[56:59], v[168:171], v[220:223], a[56:59]
v_exp_f32 v148, v148
v_mfma_f32_16x16x32_bf16 a[60:63], v[172:175], v[220:223], a[60:63]
ds_read_b64_tr_b16 v[220:221], v247 offset:4608
s_waitcnt lgkmcnt(5)
v_mfma_f32_16x16x32_bf16 a[64:67], v[160:163], v[208:211], a[64:67]
ds_read_b64_tr_b16 v[222:223], v247 offset:6656
v_exp_f32 v149, v149
v_mfma_f32_16x16x32_bf16 a[68:71], v[164:167], v[208:211], a[68:71]
s_waitcnt vmcnt(4)
s_barrier
v_mfma_f32_16x16x32_bf16 a[72:75], v[168:171], v[208:211], a[72:75]
v_exp_f32 v150, v150
v_add_f32 v225, v225, v148
v_mfma_f32_16x16x32_bf16 a[76:79], v[172:175], v[208:211], a[76:79]
ds_read_b128 v[208:211], v240 offset:0
s_waitcnt lgkmcnt(5)
v_mfma_f32_16x16x32_bf16 a[80:83], v[160:163], v[212:215], a[80:83]
v_exp_f32 v151, v151
v_add_f32 v225, v225, v149
v_mfma_f32_16x16x32_bf16 a[84:87], v[164:167], v[212:215], a[84:87]
v_add_f32 v225, v225, v150
v_add_f32 v225, v225, v151
v_mfma_f32_16x16x32_bf16 a[88:91], v[168:171], v[212:215], a[88:91]
v_exp_f32 v152, v152
v_mfma_f32_16x16x32_bf16 a[92:95], v[172:175], v[212:215], a[92:95]
ds_read_b128 v[212:215], v240 offset:512
s_waitcnt lgkmcnt(4)
v_mfma_f32_16x16x32_bf16 a[96:99], v[160:163], v[216:219], a[96:99]
v_exp_f32 v153, v153
v_mfma_f32_16x16x32_bf16 a[100:103], v[164:167], v[216:219], a[100:103]
v_cvt_pk_bf16_f32 v176, v128, v129
v_cvt_pk_bf16_f32 v177, v130, v131
v_mfma_f32_16x16x32_bf16 a[104:107], v[168:171], v[216:219], a[104:107]
v_exp_f32 v154, v154
v_add_f32 v226, v226, v152
v_mfma_f32_16x16x32_bf16 a[108:111], v[172:175], v[216:219], a[108:111]
ds_read_b128 v[216:219], v240 offset:4096
s_waitcnt lgkmcnt(3)
v_cvt_pk_bf16_f32 v180, v132, v133
v_cvt_pk_bf16_f32 v181, v134, v135
v_mfma_f32_16x16x32_bf16 a[112:115], v[160:163], v[220:223], a[112:115]
v_exp_f32 v155, v155
v_add_f32 v226, v226, v153
v_mfma_f32_16x16x32_bf16 a[116:119], v[164:167], v[220:223], a[116:119]
v_cvt_pk_bf16_f32 v184, v136, v137
v_cvt_pk_bf16_f32 v185, v138, v139
v_add_f32 v226, v226, v154
v_mfma_f32_16x16x32_bf16 a[120:123], v[168:171], v[220:223], a[120:123]
v_add_f32 v226, v226, v155
v_exp_f32 v156, v156
v_mfma_f32_16x16x32_bf16 a[124:127], v[172:175], v[220:223], a[124:127]
ds_read_b128 v[220:223], v240 offset:4608
s_waitcnt lgkmcnt(2)
v_mfma_f32_16x16x32_bf16 v[128:131], v[208:211], v[0:3], v[192:195]
v_exp_f32 v157, v157
v_mfma_f32_16x16x32_bf16 v[128:131], v[212:215], v[4:7], v[128:131]
v_cvt_pk_bf16_f32 v188, v140, v141
v_cvt_pk_bf16_f32 v189, v142, v143
v_mfma_f32_16x16x32_bf16 v[132:135], v[208:211], v[32:35], v[196:199]
v_exp_f32 v158, v158
v_add_f32 v227, v227, v156
v_mfma_f32_16x16x32_bf16 v[132:135], v[212:215], v[36:39], v[132:135]
v_exp_f32 v159, v159
v_add_f32 v227, v227, v157
v_mfma_f32_16x16x32_bf16 v[136:139], v[208:211], v[64:67], v[200:203]
v_add_f32 v227, v227, v158
v_add_f32 v227, v227, v159
v_max3_f32 v242, v224, v225, v226
v_mfma_f32_16x16x32_bf16 v[136:139], v[212:215], v[68:71], v[136:139]
v_max_f32 v242, v242, v227
v_mfma_f32_16x16x32_bf16 v[140:143], v[208:211], v[96:99], v[204:207]
ds_read_b128 v[208:211], v240 offset:8192
v_cmp_lt_f32 vcc, s32, v242
v_mfma_f32_16x16x32_bf16 v[140:143], v[212:215], v[100:103], v[140:143]
ds_read_b128 v[212:215], v240 offset:8704
s_waitcnt lgkmcnt(2)
v_mfma_f32_16x16x32_bf16 v[128:131], v[216:219], v[8:11], v[128:131]
v_mfma_f32_16x16x32_bf16 v[128:131], v[220:223], v[12:15], v[128:131]
s_cbranch_vccnz L2_rare_site5
L2_ret5:
v_cvt_pk_bf16_f32 v178, v144, v145
v_cvt_pk_bf16_f32 v179, v146, v147
v_mfma_f32_16x16x32_bf16 v[132:135], v[216:219], v[40:43], v[132:135]
v_cvt_pk_bf16_f32 v182, v148, v149
v_cvt_pk_bf16_f32 v183, v150, v151
v_cvt_pk_bf16_f32 v186, v152, v153
v_mfma_f32_16x16x32_bf16 v[132:135], v[220:223], v[44:47], v[132:135]
v_cvt_pk_bf16_f32 v187, v154, v155
v_cvt_pk_bf16_f32 v190, v156, v157
v_cvt_pk_bf16_f32 v191, v158, v159
v_mfma_f32_16x16x32_bf16 v[136:139], v[216:219], v[72:75], v[136:139]
v_mfma_f32_16x16x32_bf16 v[136:139], v[220:223], v[76:79], v[136:139]
v_mfma_f32_16x16x32_bf16 v[140:143], v[216:219], v[104:107], v[140:143]
ds_read_b128 v[216:219], v240 offset:12288
v_mfma_f32_16x16x32_bf16 v[140:143], v[220:223], v[108:111], v[140:143]
ds_read_b128 v[220:223], v240 offset:12800
s_waitcnt lgkmcnt(2)
v_mfma_f32_16x16x32_bf16 v[128:131], v[208:211], v[16:19], v[128:131]
v_mfma_f32_16x16x32_bf16 v[128:131], v[212:215], v[20:23], v[128:131]
v_mfma_f32_16x16x32_bf16 v[132:135], v[208:211], v[48:51], v[132:135]
v_mfma_f32_16x16x32_bf16 v[132:135], v[212:215], v[52:55], v[132:135]
v_mfma_f32_16x16x32_bf16 v[136:139], v[208:211], v[80:83], v[136:139]
v_mfma_f32_16x16x32_bf16 v[136:139], v[212:215], v[84:87], v[136:139]
s_sub_u32 s31, s31, 1
v_mfma_f32_16x16x32_bf16 v[140:143], v[208:211], v[112:115], v[140:143]
ds_read_b128 v[208:211], v240 offset:2048
v_mfma_f32_16x16x32_bf16 v[140:143], v[212:215], v[116:119], v[140:143]
ds_read_b128 v[212:215], v240 offset:2560
s_waitcnt lgkmcnt(2)
v_mfma_f32_16x16x32_bf16 v[128:131], v[216:219], v[24:27], v[128:131]
s_add_u32 s28, s28, s101
s_add_u32 s30, s30, 0x4000
v_mfma_f32_16x16x32_bf16 v[128:131], v[220:223], v[28:31], v[128:131]
s_and_b32 s30, s30, 0x1ffff
v_mfma_f32_16x16x32_bf16 v[132:135], v[216:219], v[56:59], v[132:135]
v_mfma_f32_16x16x32_bf16 v[132:135], v[220:223], v[60:63], v[132:135]
v_mfma_f32_16x16x32_bf16 v[136:139], v[216:219], v[88:91], v[136:139]
v_mfma_f32_16x16x32_bf16 v[136:139], v[220:223], v[92:95], v[136:139]
v_mfma_f32_16x16x32_bf16 v[140:143], v[216:219], v[120:123], v[140:143]
ds_read_b128 v[216:219], v240 offset:6144
v_mfma_f32_16x16x32_bf16 v[140:143], v[220:223], v[124:127], v[140:143]
ds_read_b128 v[220:223], v240 offset:6656
s_branch L2_loop1
.p2align 6
L2_loop:
s_waitcnt lgkmcnt(2)
v_mfma_f32_16x16x32_bf16 v[144:147], v[208:211], v[0:3], v[192:195]
v_mfma_f32_16x16x32_bf16 v[144:147], v[212:215], v[4:7], v[144:147]
v_mfma_f32_16x16x32_bf16 v[148:151], v[208:211], v[32:35], v[196:199]
v_mfma_f32_16x16x32_bf16 v[148:151], v[212:215], v[36:39], v[148:151]
v_mfma_f32_16x16x32_bf16 v[152:155], v[208:211], v[64:67], v[200:203]
v_exp_f32 v128, v128
v_mfma_f32_16x16x32_bf16 v[152:155], v[212:215], v[68:71], v[152:155]
v_exp_f32 v129, v129
v_mfma_f32_16x16x32_bf16 v[156:159], v[208:211], v[96:99], v[204:207]
ds_read_b128 v[208:211], v240 offset:26624
v_mfma_f32_16x16x32_bf16 v[156:159], v[212:215], v[100:103], v[156:159]
ds_read_b128 v[212:215], v240 offset:27136
s_waitcnt lgkmcnt(2)
v_mfma_f32_16x16x32_bf16 v[144:147], v[216:219], v[8:11], v[144:147]
v_exp_f32 v130, v130
v_mfma_f32_16x16x32_bf16 v[144:147], v[220:223], v[12:15], v[144:147]
v_add_f32 v224, v224, v128
v_mfma_f32_16x16x32_bf16 v[148:151], v[216:219], v[40:43], v[148:151]
v_exp_f32 v131, v131
v_mfma_f32_16x16x32_bf16 v[148:151], v[220:223], v[44:47], v[148:151]
v_add_f32 v224, v224, v129
v_add_f32 v224, v224, v130
v_mfma_f32_16x16x32_bf16 v[152:155], v[216:219], v[72:75], v[152:155]
v_add_f32 v224, v224, v131
v_mfma_f32_16x16x32_bf16 v[152:155], v[220:223], v[76:79], v[152:155]
v_exp_f32 v132, v132
v_mfma_f32_16x16x32_bf16 v[156:159], v[216:219], v[104:107], v[156:159]
ds_read_b128 v[216:219], v240 offset:30720
v_mfma_f32_16x16x32_bf16 v[156:159], v[220:223], v[108:111], v[156:159]
ds_read_b128 v[220:223], v240 offset:31232
s_waitcnt lgkmcnt(2)
v_mfma_f32_16x16x32_bf16 v[144:147], v[208:211], v[16:19], v[144:147]
v_exp_f32 v133, v133
v_mfma_f32_16x16x32_bf16 v[144:147], v[212:215], v[20:23], v[144:147]
v_add_u32 v240, 0x8000, v240
v_mfma_f32_16x16x32_bf16 v[148:151], v[208:211], v[48:51], v[148:151]
v_and_b32 v240, 0x1ffff, v240
v_mfma_f32_16x16x32_bf16 v[148:151], v[212:215], v[52:55], v[148:151]
v_exp_f32 v134, v134
v_mfma_f32_16x16x32_bf16 v[152:155], v[208:211], v[80:83], v[152:155]
v_add_f32 v225, v225, v132
v_mfma_f32_16x16x32_bf16 v[152:155], v[212:215], v[84:87], v[152:155]
v_exp_f32 v135, v135
v_mfma_f32_16x16x32_bf16 v[156:159], v[208:211], v[112:115], v[156:159]
ds_read_b64_tr_b16 v[208:209], v244 offset:16384
ds_read_b64_tr_b16 v[210:211], v244 offset:18432
v_mfma_f32_16x16x32_bf16 v[156:159], v[212:215], v[116:119], v[156:159]
ds_read_b64_tr_b16 v[212:213], v246 offset:0
s_waitcnt lgkmcnt(3)
v_mfma_f32_16x16x32_bf16 v[144:147], v[216:219], v[24:27], v[144:147]
ds_read_b64_tr_b16 v[214:215], v246 offset:2048
v_add_f32 v225, v225, v133
v_mfma_f32_16x16x32_bf16 v[144:147], v[220:223], v[28:31], v[144:147]
v_add_f32 v225, v225, v134
v_add_f32 v225, v225, v135
v_mfma_f32_16x16x32_bf16 v[148:151], v[216:219], v[56:59], v[148:151]
v_exp_f32 v136, v136
v_mfma_f32_16x16x32_bf16 v[148:151], v[220:223], v[60:63], v[148:151]
v_exp_f32 v137, v137
v_mfma_f32_16x16x32_bf16 v[152:155], v[216:219], v[88:91], v[152:155]
v_exp_f32 v138, v138
v_mfma_f32_16x16x32_bf16 v[152:155], v[220:223], v[92:95], v[152:155]
v_add_f32 v226, v226, v136
v_mfma_f32_16x16x32_bf16 v[156:159], v[216:219], v[120:123], v[156:159]
ds_read_b64_tr_b16 v[216:217], v245 offset:16384
ds_read_b64_tr_b16 v[218:219], v245 offset:18432
v_mfma_f32_16x16x32_bf16 v[156:159], v[220:223], v[124:127], v[156:159]
ds_read_b64_tr_b16 v[220:221], v247 offset:0
s_waitcnt lgkmcnt(3)
v_mfma_f32_16x16x32_bf16 a[0:3], v[176:179], v[208:211], a[0:3]
ds_read_b64_tr_b16 v[222:223], v247 offset:2048
v_mfma_f32_16x16x32_bf16 a[0:3], v[160:163], v[212:215], a[0:3]
v_exp_f32 v139, v139
v_mfma_f32_16x16x32_bf16 a[4:7], v[180:183], v[208:211], a[4:7]
v_add_f32 v226, v226, v137
v_add_f32 v226, v226, v138
v_mfma_f32_16x16x32_bf16 a[4:7], v[164:167], v[212:215], a[4:7]
v_add_f32 v226, v226, v139
v_mfma_f32_16x16x32_bf16 a[8:11], v[184:187], v[208:211], a[8:11]
v_exp_f32 v140, v140
v_mfma_f32_16x16x32_bf16 a[8:11], v[168:171], v[212:215], a[8:11]
v_exp_f32 v141, v141
v_mfma_f32_16x16x32_bf16 a[12:15], v[188:191], v[208:211], a[12:15]
ds_read_b64_tr_b16 v[208:209], v244 offset:16896
ds_read_b64_tr_b16 v[210:211], v244 offset:18944
v_mfma_f32_16x16x32_bf16 a[12:15], v[172:175], v[212:215], a[12:15]
ds_read_b64_tr_b16 v[212:213], v246 offset:512
s_waitcnt lgkmcnt(3)
v_mfma_f32_16x16x32_bf16 a[16:19], v[176:179], v[216:219], a[16:19]
ds_read_b64_tr_b16 v[214:215], v246 offset:2560
v_mfma_f32_16x16x32_bf16 a[16:19], v[160:163], v[220:223], a[16:19]
v_exp_f32 v142, v142
v_mfma_f32_16x16x32_bf16 a[20:23], v[180:183], v[216:219], a[20:23]
v_add_f32 v227, v227, v140
v_mfma_f32_16x16x32_bf16 a[20:23], v[164:167], v[220:223], a[20:23]
v_exp_f32 v143, v143
v_mfma_f32_16x16x32_bf16 a[24:27], v[184:187], v[216:219], a[24:27]
v_add_f32 v227, v227, v141
v_add_f32 v227, v227, v142
v_mfma_f32_16x16x32_bf16 a[24:27], v[168:171], v[220:223], a[24:27]
v_add_f32 v227, v227, v143
v_max3_f32 v242, v224, v225, v226
v_mfma_f32_16x16x32_bf16 a[28:31], v[188:191], v[216:219], a[28:31]
ds_read_b64_tr_b16 v[216:217], v245 offset:16896
ds_read_b64_tr_b16 v[218:219], v245 offset:18944
v_mfma_f32_16x16x32_bf16 a[28:31], v[172:175], v[220:223], a[28:31]
ds_read_b64_tr_b16 v[220:221], v247 offset:512
s_waitcnt lgkmcnt(3)
v_mfma_f32_16x16x32_bf16 a[32:35], v[176:179], v[208:211], a[32:35]
ds_read_b64_tr_b16 v[222:223], v247 offset:2560
v_max_f32 v242, v242, v227
v_mfma_f32_16x16x32_bf16 a[32:35], v[160:163], v[212:215], a[32:35]
v_cmp_lt_f32 vcc, s32, v242
v_mfma_f32_16x16x32_bf16 a[36:39], v[180:183], v[208:211], a[36:39]
v_mfma_f32_16x16x32_bf16 a[36:39], v[164:167], v[212:215], a[36:39]
v_mfma_f32_16x16x32_bf16 a[40:43], v[184:187], v[208:211], a[40:43]
s_mov_b32 m0, s30
s_cbranch_vccnz L2_rare_site0
L2_ret0:
v_mfma_f32_16x16x32_bf16 a[40:43], v[168:171], v[212:215], a[40:43]
buffer_load_dwordx4 v241, s[12:15], s28 offen offset:0 sc1 lds
v_mfma_f32_16x16x32_bf16 a[44:47], v[188:191], v[208:211], a[44:47]
ds_read_b64_tr_b16 v[208:209], v244 offset:20480
ds_read_b64_tr_b16 v[210:211], v244 offset:22528
v_mfma_f32_16x16x32_bf16 a[44:47], v[172:175], v[212:215], a[44:47]
ds_read_b64_tr_b16 v[212:213], v246 offset:4096
s_waitcnt lgkmcnt(3)
v_mfma_f32_16x16x32_bf16 a[48:51], v[176:179], v[216:219], a[48:51]
ds_read_b64_tr_b16 v[214:215], v246 offset:6144
v_mfma_f32_16x16x32_bf16 a[48:51], v[160:163], v[220:223], a[48:51]
buffer_load_dwordx4 v241, s[12:15], s28 offen offset:1024 sc1 lds
v_mfma_f32_16x16x32_bf16 a[52:55], v[180:183], v[216:219], a[52:55]
v_exp_f32 v144, v144
v_mfma_f32_16x16x32_bf16 a[52:55], v[164:167], v[220:223], a[52:55]
v_exp_f32 v145, v145
v_mfma_f32_16x16x32_bf16 a[56:59], v[184:187], v[216:219], a[56:59]
v_exp_f32 v146, v146
v_mfma_f32_16x16x32_bf16 a[56:59], v[168:171], v[220:223], a[56:59]
buffer_load_dwordx4 v241, s[12:15], s28 offen offset:2048 sc1 lds
v_add_f32 v224, v224, v144
v_mfma_f32_16x16x32_bf16 a[60:63], v[188:191], v[216:219], a[60:63]
ds_read_b64_tr_b16 v[216:217], v245 offset:20480
ds_read_b64_tr_b16 v[218:219], v245 offset:22528
v_mfma_f32_16x16x32_bf16 a[60:63], v[172:175], v[220:223], a[60:63]
ds_read_b64_tr_b16 v[220:221], v247 offset:4096
s_waitcnt lgkmcnt(3)
v_mfma_f32_16x16x32_bf16 a[64:67], v[176:179], v[208:211], a[64:67]
ds_read_b64_tr_b16 v[222:223], v247 offset:6144
v_mfma_f32_16x16x32_bf16 a[64:67], v[160:163], v[212:215], a[64:67]
buffer_load_dwordx4 v241, s[12:15], s28 offen offset:3072 sc1 lds
v_mfma_f32_16x16x32_bf16 a[68:71], v[180:183], v[208:211], a[68:71]
v_exp_f32 v147, v147
v_mfma_f32_16x16x32_bf16 a[68:71], v[164:167], v[212:215], a[68:71]
v_add_f32 v224, v224, v145
v_add_f32 v224, v224, v146
v_mfma_f32_16x16x32_bf16 a[72:75], v[184:187], v[208:211], a[72:75]
v_add_f32 v224, v224, v147
v_mfma_f32_16x16x32_bf16 a[72:75], v[168:171], v[212:215], a[72:75]
v_exp_f32 v148, v148
v_mfma_f32_16x16x32_bf16 a[76:79], v[188:191], v[208:211], a[76:79]
ds_read_b64_tr_b16 v[208:209], v244 offset:20992
ds_read_b64_tr_b16 v[210:211], v244 offset:23040
v_mfma_f32_16x16x32_bf16 a[76:79], v[172:175], v[212:215], a[76:79]
ds_read_b64_tr_b16 v[212:213], v246 offset:4608
s_waitcnt lgkmcnt(3)
v_mfma_f32_16x16x32_bf16 a[80:83], v[176:179], v[216:219], a[80:83]
ds_read_b64_tr_b16 v[214:215], v246 offset:6656
v_mfma_f32_16x16x32_bf16 a[80:83], v[160:163], v[220:223], a[80:83]
v_exp_f32 v149, v149
v_mfma_f32_16x16x32_bf16 a[84:87], v[180:183], v[216:219], a[84:87]
v_exp_f32 v150, v150
v_mfma_f32_16x16x32_bf16 a[84:87], v[164:167], v[220:223], a[84:87]
v_add_f32 v225, v225, v148
v_mfma_f32_16x16x32_bf16 a[88:91], v[184:187], v[216:219], a[88:91]
v_exp_f32 v151, v151
v_mfma_f32_16x16x32_bf16 a[88:91], v[168:171], v[220:223], a[88:91]
v_add_f32 v225, v225, v149
v_add_f32 v225, v225, v150
v_mfma_f32_16x16x32_bf16 a[92:95], v[188:191], v[216:219], a[92:95]
ds_read_b64_tr_b16 v[216:217], v245 offset:20992
ds_read_b64_tr_b16 v[218:219], v245 offset:23040
v_mfma_f32_16x16x32_bf16 a[92:95], v[172:175], v[220:223], a[92:95]
ds_read_b64_tr_b16 v[220:221], v247 offset:4608
s_waitcnt lgkmcnt(3)
v_mfma_f32_16x16x32_bf16 a[96:99], v[176:179], v[208:211], a[96:99]
ds_read_b64_tr_b16 v[222:223], v247 offset:6656
v_add_f32 v225, v225, v151
v_mfma_f32_16x16x32_bf16 a[96:99], v[160:163], v[212:215], a[96:99]
s_waitcnt vmcnt(4)
s_barrier
v_mfma_f32_16x16x32_bf16 a[100:103], v[180:183], v[208:211], a[100:103]
v_exp_f32 v152, v152
v_mfma_f32_16x16x32_bf16 a[100:103], v[164:167], v[212:215], a[100:103]
v_exp_f32 v153, v153
v_mfma_f32_16x16x32_bf16 a[104:107], v[184:187], v[208:211], a[104:107]
v_exp_f32 v154, v154
v_mfma_f32_16x16x32_bf16 a[104:107], v[168:171], v[212:215], a[104:107]
v_add_f32 v226, v226, v152
v_mfma_f32_16x16x32_bf16 a[108:111], v[188:191], v[208:211], a[108:111]
ds_read_b128 v[208:211], v240 offset:0
v_mfma_f32_16x16x32_bf16 a[108:111], v[172:175], v[212:215], a[108:111]
ds_read_b128 v[212:215], v240 offset:512
s_waitcnt lgkmcnt(2)
v_mfma_f32_16x16x32_bf16 a[112:115], v[176:179], v[216:219], a[112:115]
v_exp_f32 v155, v155
v_mfma_f32_16x16x32_bf16 a[112:115], v[160:163], v[220:223], a[112:115]
v_cvt_pk_bf16_f32 v176, v128, v129
v_cvt_pk_bf16_f32 v177, v130, v131
v_mfma_f32_16x16x32_bf16 a[116:119], v[180:183], v[216:219], a[116:119]
v_add_f32 v226, v226, v153
v_add_f32 v226, v226, v154
v_mfma_f32_16x16x32_bf16 a[116:119], v[164:167], v[220:223], a[116:119]
v_cvt_pk_bf16_f32 v180, v132, v133
v_cvt_pk_bf16_f32 v181, v134, v135
v_mfma_f32_16x16x32_bf16 a[120:123], v[184:187], v[216:219], a[120:123]
v_add_f32 v226, v226, v155
v_mfma_f32_16x16x32_bf16 a[120:123], v[168:171], v[220:223], a[120:123]
v_cvt_pk_bf16_f32 v184, v136, v137
v_cvt_pk_bf16_f32 v185, v138, v139
v_mfma_f32_16x16x32_bf16 a[124:127], v[188:191], v[216:219], a[124:127]
ds_read_b128 v[216:219], v240 offset:4096
v_mfma_f32_16x16x32_bf16 a[124:127], v[172:175], v[220:223], a[124:127]
ds_read_b128 v[220:223], v240 offset:4608
s_waitcnt lgkmcnt(2)
v_mfma_f32_16x16x32_bf16 v[128:131], v[208:211], v[0:3], v[192:195]
v_exp_f32 v156, v156
v_mfma_f32_16x16x32_bf16 v[128:131], v[212:215], v[4:7], v[128:131]
v_cvt_pk_bf16_f32 v188, v140, v141
v_cvt_pk_bf16_f32 v189, v142, v143
v_mfma_f32_16x16x32_bf16 v[132:135], v[208:211], v[32:35], v[196:199]
v_exp_f32 v157, v157
v_mfma_f32_16x16x32_bf16 v[132:135], v[212:215], v[36:39], v[132:135]
v_exp_f32 v158, v158
v_mfma_f32_16x16x32_bf16 v[136:139], v[208:211], v[64:67], v[200:203]
v_add_f32 v227, v227, v156
v_mfma_f32_16x16x32_bf16 v[136:139], v[212:215], v[68:71], v[136:139]
v_exp_f32 v159, v159
v_mfma_f32_16x16x32_bf16 v[140:143], v[208:211], v[96:99], v[204:207]
ds_read_b128 v[208:211], v240 offset:8192
v_add_f32 v227, v227, v157
v_mfma_f32_16x16x32_bf16 v[140:143], v[212:215], v[100:103], v[140:143]
ds_read_b128 v[212:215], v240 offset:8704
s_waitcnt lgkmcnt(2)
v_mfma_f32_16x16x32_bf16 v[128:131], v[216:219], v[8:11], v[128:131]
v_add_f32 v227, v227, v158
v_add_f32 v227, v227, v159
v_mfma_f32_16x16x32_bf16 v[128:131], v[220:223], v[12:15], v[128:131]
v_max3_f32 v242, v224, v225, v226
v_mfma_f32_16x16x32_bf16 v[132:135], v[216:219], v[40:43], v[132:135]
v_max_f32 v242, v242, v227
v_mfma_f32_16x16x32_bf16 v[132:135], v[220:223], v[44:47], v[132:135]
v_cmp_lt_f32 vcc, s32, v242
v_mfma_f32_16x16x32_bf16 v[136:139], v[216:219], v[72:75], v[136:139]
v_mfma_f32_16x16x32_bf16 v[136:139], v[220:223], v[76:79], v[136:139]
v_mfma_f32_16x16x32_bf16 v[140:143], v[216:219], v[104:107], v[140:143]
ds_read_b128 v[216:219], v240 offset:12288
s_cbranch_vccnz L2_rare_site1
L2_ret1:
v_mfma_f32_16x16x32_bf16 v[140:143], v[220:223], v[108:111], v[140:143]
ds_read_b128 v[220:223], v240 offset:12800
s_waitcnt lgkmcnt(2)
v_mfma_f32_16x16x32_bf16 v[128:131], v[208:211], v[16:19], v[128:131]
v_cvt_pk_bf16_f32 v178, v144, v145
v_cvt_pk_bf16_f32 v179, v146, v147
v_mfma_f32_16x16x32_bf16 v[128:131], v[212:215], v[20:23], v[128:131]
v_cvt_pk_bf16_f32 v182, v148, v149
v_cvt_pk_bf16_f32 v183, v150, v151
v_mfma_f32_16x16x32_bf16 v[132:135], v[208:211], v[48:51], v[132:135]
v_cvt_pk_bf16_f32 v186, v152, v153
v_cvt_pk_bf16_f32 v187, v154, v155
v_mfma_f32_16x16x32_bf16 v[132:135], v[212:215], v[52:55], v[132:135]
v_cvt_pk_bf16_f32 v190, v156, v157
v_cvt_pk_bf16_f32 v191, v158, v159
v_mfma_f32_16x16x32_bf16 v[136:139], v[208:211], v[80:83], v[136:139]
v_mfma_f32_16x16x32_bf16 v[136:139], v[212:215], v[84:87], v[136:139]
s_sub_u32 s31, s31, 1
v_mfma_f32_16x16x32_bf16 v[140:143], v[208:211], v[112:115], v[140:143]
ds_read_b128 v[208:211], v240 offset:2048
v_mfma_f32_16x16x32_bf16 v[140:143], v[212:215], v[116:119], v[140:143]
ds_read_b128 v[212:215], v240 offset:2560
s_waitcnt lgkmcnt(2)
v_mfma_f32_16x16x32_bf16 v[128:131], v[216:219], v[24:27], v[128:131]
s_add_u32 s28, s28, s101
s_add_u32 s30, s30, 0x4000
v_mfma_f32_16x16x32_bf16 v[128:131], v[220:223], v[28:31], v[128:131]
s_and_b32 s30, s30, 0x1ffff
v_mfma_f32_16x16x32_bf16 v[132:135], v[216:219], v[56:59], v[132:135]
s_cmp_eq_u32 s31, 0
v_mfma_f32_16x16x32_bf16 v[132:135], v[220:223], v[60:63], v[132:135]
v_mfma_f32_16x16x32_bf16 v[136:139], v[216:219], v[88:91], v[136:139]
v_mfma_f32_16x16x32_bf16 v[136:139], v[220:223], v[92:95], v[136:139]
v_mfma_f32_16x16x32_bf16 v[140:143], v[216:219], v[120:123], v[140:143]
ds_read_b128 v[216:219], v240 offset:6144
v_mfma_f32_16x16x32_bf16 v[140:143], v[220:223], v[124:127], v[140:143]
ds_read_b128 v[220:223], v240 offset:6656
s_cbranch_scc1 L2_x1
L2_loop1:
s_waitcnt lgkmcnt(2)
v_mfma_f32_16x16x32_bf16 v[144:147], v[208:211], v[0:3], v[192:195]
v_mfma_f32_16x16x32_bf16 v[144:147], v[212:215], v[4:7], v[144:147]
v_mfma_f32_16x16x32_bf16 v[148:151], v[208:211], v[32:35], v[196:199]
v_mfma_f32_16x16x32_bf16 v[148:151], v[212:215], v[36:39], v[148:151]
v_mfma_f32_16x16x32_bf16 v[152:155], v[208:211], v[64:67], v[200:203]
v_exp_f32 v128, v128
v_mfma_f32_16x16x32_bf16 v[152:155], v[212:215], v[68:71], v[152:155]
v_exp_f32 v129, v129
v_mfma_f32_16x16x32_bf16 v[156:159], v[208:211], v[96:99], v[204:207]
ds_read_b128 v[208:211], v240 offset:10240
v_mfma_f32_16x16x32_bf16 v[156:159], v[212:215], v[100:103], v[156:159]
ds_read_b128 v[212:215], v240 offset:10752
s_waitcnt lgkmcnt(2)
v_mfma_f32_16x16x32_bf16 v[144:147], v[216:219], v[8:11], v[144:147]
v_exp_f32 v130, v130
v_mfma_f32_16x16x32_bf16 v[144:147], v[220:223], v[12:15], v[144:147]
v_add_f32 v224, v224, v128
v_mfma_f32_16x16x32_bf16 v[148:151], v[216:219], v[40:43], v[148:151]
v_exp_f32 v131, v131
v_mfma_f32_16x16x32_bf16 v[148:151], v[220:223], v[44:47], v[148:151]
v_add_f32 v224, v224, v129
v_add_f32 v224, v224, v130
v_mfma_f32_16x16x32_bf16 v[152:155], v[216:219], v[72:75], v[152:155]
v_add_f32 v224, v224, v131
v_mfma_f32_16x16x32_bf16 v[152:155], v[220:223], v[76:79], v[152:155]
v_exp_f32 v132, v132
v_mfma_f32_16x16x32_bf16 v[156:159], v[216:219], v[104:107], v[156:159]
ds_read_b128 v[216:219], v240 offset:14336
v_mfma_f32_16x16x32_bf16 v[156:159], v[220:223], v[108:111], v[156:159]
ds_read_b128 v[220:223], v240 offset:14848
s_waitcnt lgkmcnt(2)
v_mfma_f32_16x16x32_bf16 v[144:147], v[208:211], v[16:19], v[144:147]
v_exp_f32 v133, v133
v_mfma_f32_16x16x32_bf16 v[144:147], v[212:215], v[20:23], v[144:147]
v_exp_f32 v134, v134
v_mfma_f32_16x16x32_bf16 v[148:151], v[208:211], v[48:51], v[148:151]
v_add_f32 v225, v225, v132
v_mfma_f32_16x16x32_bf16 v[148:151], v[212:215], v[52:55], v[148:151]
v_exp_f32 v135, v135
v_mfma_f32_16x16x32_bf16 v[152:155], v[208:211], v[80:83], v[152:155]
v_add_f32 v225, v225, v133
v_add_f32 v225, v225, v134
v_mfma_f32_16x16x32_bf16 v[152:155], v[212:215], v[84:87], v[152:155]
v_add_f32 v225, v225, v135
v_mfma_f32_16x16x32_bf16 v[156:159], v[208:211], v[112:115], v[156:159]
ds_read_b64_tr_b16 v[208:209], v246 offset:8192
ds_read_b64_tr_b16 v[210:211], v246 offset:10240
v_mfma_f32_16x16x32_bf16 v[156:159], v[212:215], v[116:119], v[156:159]
ds_read_b64_tr_b16 v[212:213], v246 offset:24576
s_waitcnt lgkmcnt(3)
v_mfma_f32_16x16x32_bf16 v[144:147], v[216:219], v[24:27], v[144:147]
ds_read_b64_tr_b16 v[214:215], v246 offset:26624
v_mfma_f32_16x16x32_bf16 v[144:147], v[220:223], v[28:31], v[144:147]
v_exp_f32 v136, v136
v_mfma_f32_16x16x32_bf16 v[148:151], v[216:219], v[56:59], v[148:151]
v_exp_f32 v137, v137
v_mfma_f32_16x16x32_bf16 v[148:151], v[220:223], v[60:63], v[148:151]
v_exp_f32 v138, v138
v_mfma_f32_16x16x32_bf16 v[152:155], v[216:219], v[88:91], v[152:155]
v_add_f32 v226, v226, v136
v_mfma_f32_16x16x32_bf16 v[152:155], v[220:223], v[92:95], v[152:155]
v_exp_f32 v139, v139
v_mfma_f32_16x16x32_bf16 v[156:159], v[216:219], v[120:123], v[156:159]
ds_read_b64_tr_b16 v[216:217], v247 offset:8192
ds_read_b64_tr_b16 v[218:219], v247 offset:10240
v_mfma_f32_16x16x32_bf16 v[156:159], v[220:223], v[124:127], v[156:159]
ds_read_b64_tr_b16 v[220:221], v247 offset:24576
s_waitcnt lgkmcnt(3)
v_mfma_f32_16x16x32_bf16 a[128:131], v[160:163], v[208:211], a[128:131]
ds_read_b64_tr_b16 v[222:223], v247 offset:26624
v_add_f32 v226, v226, v137
v_mfma_f32_16x16x32_bf16 a[128:131], v[176:179], v[212:215], a[128:131]
v_add_f32 v226, v226, v138
v_add_f32 v226, v226, v139
v_mfma_f32_16x16x32_bf16 a[132:135], v[164:167], v[208:211], a[132:135]
v_exp_f32 v140, v140
v_mfma_f32_16x16x32_bf16 a[132:135], v[180:183], v[212:215], a[132:135]
v_exp_f32 v141, v141
v_mfma_f32_16x16x32_bf16 a[136:139], v[168:171], v[208:211], a[136:139]
v_exp_f32 v142, v142
v_mfma_f32_16x16x32_bf16 a[136:139], v[184:187], v[212:215], a[136:139]
v_add_f32 v227, v227, v140
v_mfma_f32_16x16x32_bf16 a[140:143], v[172:175], v[208:211], a[140:143]
ds_read_b64_tr_b16 v[208:209], v246 offset:8704
ds_read_b64_tr_b16 v[210:211], v246 offset:10752
v_mfma_f32_16x16x32_bf16 a[140:143], v[188:191], v[212:215], a[140:143]
ds_read_b64_tr_b16 v[212:213], v246 offset:25088
s_waitcnt lgkmcnt(3)
v_mfma_f32_16x16x32_bf16 a[144:147], v[160:163], v[216:219], a[144:147]
ds_read_b64_tr_b16 v[214:215], v246 offset:27136
v_mfma_f32_16x16x32_bf16 a[144:147], v[176:179], v[220:223], a[144:147]
v_exp_f32 v143, v143
v_mfma_f32_16x16x32_bf16 a[148:151], v[164:167], v[216:219], a[148:151]
v_add_f32 v227, v227, v141
v_add_f32 v227, v227, v142
v_mfma_f32_16x16x32_bf16 a[148:151], v[180:183], v[220:223], a[148:151]
v_add_f32 v227, v227, v143
v_max3_f32 v242, v224, v225, v226
v_mfma_f32_16x16x32_bf16 a[152:155], v[168:171], v[216:219], a[152:155]
v_max_f32 v242, v242, v227
v_mfma_f32_16x16x32_bf16 a[152:155], v[184:187], v[220:223], a[152:155]
v_cmp_lt_f32 vcc, s32, v242
v_mfma_f32_16x16x32_bf16 a[156:159], v[172:175], v[216:219], a[156:159]
ds_read_b64_tr_b16 v[216:217], v247 offset:8704
ds_read_b64_tr_b16 v[218:219], v247 offset:10752
v_mfma_f32_16x16x32_bf16 a[156:159], v[188:191], v[220:223], a[156:159]
ds_read_b64_tr_b16 v[220:221], v247 offset:25088
s_waitcnt lgkmcnt(3)
v_mfma_f32_16x16x32_bf16 a[160:163], v[160:163], v[208:211], a[160:163]
ds_read_b64_tr_b16 v[222:223], v247 offset:27136
s_cbranch_vccnz L2_rare_site2
L2_ret2:
v_mfma_f32_16x16x32_bf16 a[160:163], v[176:179], v[212:215], a[160:163]
v_exp_f32 v144, v144
v_mfma_f32_16x16x32_bf16 a[164:167], v[164:167], v[208:211], a[164:167]
v_exp_f32 v145, v145
v_mfma_f32_16x16x32_bf16 a[164:167], v[180:183], v[212:215], a[164:167]
v_exp_f32 v146, v146
v_mfma_f32_16x16x32_bf16 a[168:171], v[168:171], v[208:211], a[168:171]
s_mov_b32 m0, s30
v_add_f32 v224, v224, v144
v_mfma_f32_16x16x32_bf16 a[168:171], v[184:187], v[212:215], a[168:171]
buffer_load_dwordx4 v241, s[12:15], s28 offen offset:0 sc1 lds
v_mfma_f32_16x16x32_bf16 a[172:175], v[172:175], v[208:211], a[172:175]
ds_read_b64_tr_b16 v[208:209], v246 offset:12288
ds_read_b64_tr_b16 v[210:211], v246 offset:14336
v_mfma_f32_16x16x32_bf16 a[172:175], v[188:191], v[212:215], a[172:175]
ds_read_b64_tr_b16 v[212:213], v246 offset:28672
s_waitcnt lgkmcnt(3)
v_mfma_f32_16x16x32_bf16 a[176:179], v[160:163], v[216:219], a[176:179]
ds_read_b64_tr_b16 v[214:215], v246 offset:30720
v_mfma_f32_16x16x32_bf16 a[176:179], v[176:179], v[220:223], a[176:179]
buffer_load_dwordx4 v241, s[12:15], s28 offen offset:1024 sc1 lds
v_mfma_f32_16x16x32_bf16 a[180:183], v[164:167], v[216:219], a[180:183]
v_exp_f32 v147, v147
v_mfma_f32_16x16x32_bf16 a[180:183], v[180:183], v[220:223], a[180:183]
v_add_f32 v224, v224, v145
v_add_f32 v224, v224, v146
v_mfma_f32_16x16x32_bf16 a[184:187], v[168:171], v[216:219], a[184:187]
v_add_f32 v224, v224, v147
v_mfma_f32_16x16x32_bf16 a[184:187], v[184:187], v[220:223], a[184:187]
buffer_load_dwordx4 v241, s[12:15], s28 offen offset:2048 sc1 lds
v_mfma_f32_16x16x32_bf16 a[188:191], v[172:175], v[216:219], a[188:191]
ds_read_b64_tr_b16 v[216:217], v247 offset:12288
ds_read_b64_tr_b16 v[218:219], v247 offset:14336
v_mfma_f32_16x16x32_bf16 a[188:191], v[188:191], v[220:223], a[188:191]
ds_read_b64_tr_b16 v[220:221], v247 offset:28672
s_waitcnt lgkmcnt(3)
v_mfma_f32_16x16x32_bf16 a[192:195], v[160:163], v[208:211], a[192:195]
ds_read_b64_tr_b16 v[222:223], v247 offset:30720
v_mfma_f32_16x16x32_bf16 a[192:195], v[176:179], v[212:215], a[192:195]
buffer_load_dwordx4 v241, s[12:15], s28 offen offset:3072 sc1 lds
v_mfma_f32_16x16x32_bf16 a[196:199], v[164:167], v[208:211], a[196:199]
v_exp_f32 v148, v148
v_mfma_f32_16x16x32_bf16 a[196:199], v[180:183], v[212:215], a[196:199]
v_exp_f32 v149, v149
v_mfma_f32_16x16x32_bf16 a[200:203], v[168:171], v[208:211], a[200:203]
v_exp_f32 v150, v150
v_mfma_f32_16x16x32_bf16 a[200:203], v[184:187], v[212:215], a[200:203]
v_add_f32 v225, v225, v148
v_mfma_f32_16x16x32_bf16 a[204:207], v[172:175], v[208:211], a[204:207]
ds_read_b64_tr_b16 v[208:209], v246 offset:12800
ds_read_b64_tr_b16 v[210:211], v246 offset:14848
v_mfma_f32_16x16x32_bf16 a[204:207], v[188:191], v[212:215], a[204:207]
ds_read_b64_tr_b16 v[212:213], v246 offset:29184
s_waitcnt lgkmcnt(3)
v_mfma_f32_16x16x32_bf16 a[208:211], v[160:163], v[216:219], a[208:211]
ds_read_b64_tr_b16 v[214:215], v246 offset:31232
v_mfma_f32_16x16x32_bf16 a[208:211], v[176:179], v[220:223], a[208:211]
v_exp_f32 v151, v151
v_mfma_f32_16x16x32_bf16 a[212:215], v[164:167], v[216:219], a[212:215]
v_add_f32 v225, v225, v149
v_add_f32 v225, v225, v150
v_mfma_f32_16x16x32_bf16 a[212:215], v[180:183], v[220:223], a[212:215]
v_add_f32 v225, v225, v151
v_mfma_f32_16x16x32_bf16 a[216:219], v[168:171], v[216:219], a[216:219]
v_exp_f32 v152, v152
v_mfma_f32_16x16x32_bf16 a[216:219], v[184:187], v[220:223], a[216:219]
v_exp_f32 v153, v153
v_mfma_f32_16x16x32_bf16 a[220:223], v[172:175], v[216:219], a[220:223]
ds_read_b64_tr_b16 v[216:217], v247 offset:12800
ds_read_b64_tr_b16 v[218:219], v247 offset:14848
v_mfma_f32_16x16x32_bf16 a[220:223], v[188:191], v[220:223], a[220:223]
ds_read_b64_tr_b16 v[220:221], v247 offset:29184
s_waitcnt lgkmcnt(3)
v_mfma_f32_16x16x32_bf16 a[224:227], v[160:163], v[208:211], a[224:227]
ds_read_b64_tr_b16 v[222:223], v247 offset:31232
v_mfma_f32_16x16x32_bf16 a[224:227], v[176:179], v[212:215], a[224:227]
s_waitcnt vmcnt(4)
s_barrier
v_mfma_f32_16x16x32_bf16 a[228:231], v[164:167], v[208:211], a[228:231]
v_exp_f32 v154, v154
v_mfma_f32_16x16x32_bf16 a[228:231], v[180:183], v[212:215], a[228:231]
v_add_f32 v226, v226, v152
v_mfma_f32_16x16x32_bf16 a[232:235], v[168:171], v[208:211], a[232:235]
v_exp_f32 v155, v155
v_mfma_f32_16x16x32_bf16 a[232:235], v[184:187], v[212:215], a[232:235]
v_add_f32 v226, v226, v153
v_add_f32 v226, v226, v154
v_mfma_f32_16x16x32_bf16 a[236:239], v[172:175], v[208:211], a[236:239]
ds_read_b128 v[208:211], v240 offset:16384
v_add_f32 v226, v226, v155
v_mfma_f32_16x16x32_bf16 a[236:239], v[188:191], v[212:215], a[236:239]
ds_read_b128 v[212:215], v240 offset:16896
s_waitcnt lgkmcnt(2)
v_mfma_f32_16x16x32_bf16 a[240:243], v[160:163], v[216:219], a[240:243]
v_exp_f32 v156, v156
v_mfma_f32_16x16x32_bf16 a[240:243], v[176:179], v[220:223], a[240:243]
v_cvt_pk_bf16_f32 v160, v128, v129
v_cvt_pk_bf16_f32 v161, v130, v131
v_mfma_f32_16x16x32_bf16 a[244:247], v[164:167], v[216:219], a[244:247]
v_exp_f32 v157, v157
v_mfma_f32_16x16x32_bf16 a[244:247], v[180:183], v[220:223], a[244:247]
v_cvt_pk_bf16_f32 v164, v132, v133
v_cvt_pk_bf16_f32 v165, v134, v135
v_mfma_f32_16x16x32_bf16 a[248:251], v[168:171], v[216:219], a[248:251]
v_exp_f32 v158, v158
v_mfma_f32_16x16x32_bf16 a[248:251], v[184:187], v[220:223], a[248:251]
v_cvt_pk_bf16_f32 v168, v136, v137
v_cvt_pk_bf16_f32 v169, v138, v139
v_mfma_f32_16x16x32_bf16 a[252:255], v[172:175], v[216:219], a[252:255]
ds_read_b128 v[216:219], v240 offset:20480
v_add_f32 v227, v227, v156
v_mfma_f32_16x16x32_bf16 a[252:255], v[188:191], v[220:223], a[252:255]
ds_read_b128 v[220:223], v240 offset:20992
s_waitcnt lgkmcnt(2)
v_mfma_f32_16x16x32_bf16 v[128:131], v[208:211], v[0:3], v[192:195]
v_exp_f32 v159, v159
v_mfma_f32_16x16x32_bf16 v[128:131], v[212:215], v[4:7], v[128:131]
v_cvt_pk_bf16_f32 v172, v140, v141
v_cvt_pk_bf16_f32 v173, v142, v143
v_mfma_f32_16x16x32_bf16 v[132:135], v[208:211], v[32:35], v[196:199]
v_add_f32 v227, v227, v157
v_add_f32 v227, v227, v158
v_mfma_f32_16x16x32_bf16 v[132:135], v[212:215], v[36:39], v[132:135]
v_add_f32 v227, v227, v159
v_max3_f32 v242, v224, v225, v226
v_mfma_f32_16x16x32_bf16 v[136:139], v[208:211], v[64:67], v[200:203]
v_max_f32 v242, v242, v227
v_mfma_f32_16x16x32_bf16 v[136:139], v[212:215], v[68:71], v[136:139]
v_cmp_lt_f32 vcc, s32, v242
v_mfma_f32_16x16x32_bf16 v[140:143], v[208:211], v[96:99], v[204:207]
ds_read_b128 v[208:211], v240 offset:24576
v_mfma_f32_16x16x32_bf16 v[140:143], v[212:215], v[100:103], v[140:143]
ds_read_b128 v[212:215], v240 offset:25088
s_waitcnt lgkmcnt(2)
v_mfma_f32_16x16x32_bf16 v[128:131], v[216:219], v[8:11], v[128:131]
v_mov_b32 v244, v246
v_mov_b32 v245, v247
v_mfma_f32_16x16x32_bf16 v[128:131], v[220:223], v[12:15], v[128:131]
v_add_u32 v246, 0x8000, v246
s_cbranch_vccnz L2_rare_site3
L2_ret3:
v_mfma_f32_16x16x32_bf16 v[132:135], v[216:219], v[40:43], v[132:135]
v_and_b32 v246, 0x1ffff, v246
v_cvt_pk_bf16_f32 v162, v144, v145
v_mfma_f32_16x16x32_bf16 v[132:135], v[220:223], v[44:47], v[132:135]
v_cvt_pk_bf16_f32 v163, v146, v147
v_cvt_pk_bf16_f32 v166, v148, v149
v_mfma_f32_16x16x32_bf16 v[136:139], v[216:219], v[72:75], v[136:139]
v_xor_b32 v247, 32, v246
v_cvt_pk_bf16_f32 v167, v150, v151
v_mfma_f32_16x16x32_bf16 v[136:139], v[220:223], v[76:79], v[136:139]
v_cvt_pk_bf16_f32 v170, v152, v153
v_cvt_pk_bf16_f32 v171, v154, v155
v_mfma_f32_16x16x32_bf16 v[140:143], v[216:219], v[104:107], v[140:143]
ds_read_b128 v[216:219], v240 offset:28672
v_cvt_pk_bf16_f32 v174, v156, v157
v_mfma_f32_16x16x32_bf16 v[140:143], v[220:223], v[108:111], v[140:143]
ds_read_b128 v[220:223], v240 offset:29184
s_waitcnt lgkmcnt(2)
v_mfma_f32_16x16x32_bf16 v[128:131], v[208:211], v[16:19], v[128:131]
v_cvt_pk_bf16_f32 v175, v158, v159
v_mfma_f32_16x16x32_bf16 v[128:131], v[212:215], v[20:23], v[128:131]
v_mfma_f32_16x16x32_bf16 v[132:135], v[208:211], v[48:51], v[132:135]
v_mfma_f32_16x16x32_bf16 v[132:135], v[212:215], v[52:55], v[132:135]
v_mfma_f32_16x16x32_bf16 v[136:139], v[208:211], v[80:83], v[136:139]
v_mfma_f32_16x16x32_bf16 v[136:139], v[212:215], v[84:87], v[136:139]
s_sub_u32 s31, s31, 1
v_mfma_f32_16x16x32_bf16 v[140:143], v[208:211], v[112:115], v[140:143]
ds_read_b128 v[208:211], v240 offset:18432
v_mfma_f32_16x16x32_bf16 v[140:143], v[212:215], v[116:119], v[140:143]
ds_read_b128 v[212:215], v240 offset:18944
s_waitcnt lgkmcnt(2)
v_mfma_f32_16x16x32_bf16 v[128:131], v[216:219], v[24:27], v[128:131]
s_add_u32 s28, s28, s101
s_add_u32 s30, s30, 0x4000
v_mfma_f32_16x16x32_bf16 v[128:131], v[220:223], v[28:31], v[128:131]
s_and_b32 s30, s30, 0x1ffff
v_mfma_f32_16x16x32_bf16 v[132:135], v[216:219], v[56:59], v[132:135]
s_cmp_eq_u32 s31, 0
v_mfma_f32_16x16x32_bf16 v[132:135], v[220:223], v[60:63], v[132:135]
v_mfma_f32_16x16x32_bf16 v[136:139], v[216:219], v[88:91], v[136:139]
v_mfma_f32_16x16x32_bf16 v[136:139], v[220:223], v[92:95], v[136:139]
v_mfma_f32_16x16x32_bf16 v[140:143], v[216:219], v[120:123], v[140:143]
ds_read_b128 v[216:219], v240 offset:22528
v_mfma_f32_16x16x32_bf16 v[140:143], v[220:223], v[124:127], v[140:143]
ds_read_b128 v[220:223], v240 offset:23040
s_cbranch_scc0 L2_loop
s_cmp_eq_u32 s100, 0
s_cbranch_scc1 L2_tail_0
s_mov_b32 s3, 0
s_branch L2_ev
L2_x1:
s_cmp_eq_u32 s100, 0
s_cbranch_scc1 L2_tail_1
s_mov_b32 s3, 1
L2_ev:
s_sub_u32 s100, s100, 1
s_mov_b32 s31, 1
v_mov_b32 v230, 0x20000
s_cmp_eq_u32 s100, 0
s_cbranch_scc1 L2_ev5
s_cmp_lg_u32 s34, 0
s_cbranch_scc1 L2_evr
s_mov_b64 exec, 1
s_cmp_eq_u32 s100, 4
s_cbranch_scc1 L2_ev1
s_cmp_eq_u32 s100, 1
s_cbranch_scc1 L2_ev4
v_cmp_eq_u64 vcc, s[98:99], v[228:229]
s_nop 1
s_bitcmp1_b32 vcc_lo, 0
s_subb_u32 s39, s39, 0
v_mov_b32 v228, s98
v_mov_b32 v229, s99
s_cmp_eq_u32 s100, 2
s_cbranch_scc1 L2_ev3
buffer_atomic_swap_x2 v[228:229], off, s[16:19], s49 offset:0 sc0 sc1
s_branch L2_evx
L2_ev1:
v_mov_b32 v228, s98
v_mov_b32 v229, s99
buffer_atomic_swap_x2 v[228:229], off, s[16:19], s95 offset:16 sc0 sc1
s_branch L2_evx
L2_ev3:
v_mov_b32 v252, s98
v_mov_b32 v253, s99
buffer_atomic_swap_x2 v[228:229], off, s[16:19], s35 offset:0 sc0 sc1
buffer_atomic_swap_x2 v[252:253], off, s[16:19], s94 offset:16 sc0 sc1
s_branch L2_evx
L2_ev4:
v_cmp_ne_u64 vcc, s[98:99], v[228:229]
s_nop 1
s_bitcmp1_b32 vcc_lo, 0
s_addc_u32 s39, s39, 0
v_cmp_ne_u64 vcc, s[98:99], v[252:253]
s_nop 1
s_bitcmp1_b32 vcc_lo, 0
s_addc_u32 s39, s39, 0
v_mov_b32 v228, s39
ds_write_b32 v230, v228
L2_evx:
s_mov_b64 exec, -1
s_branch L2_evr
L2_ev5:
ds_read_b32 v228, v230
s_waitcnt lgkmcnt(0)
v_readfirstlane_b32 s31, v228
L2_evr:
s_cmp_eq_u32 s3, 0
s_cbranch_scc1 L2_loop
s_branch L2_loop1
L2_tail_0:
s_waitcnt lgkmcnt(2)
v_add_u32 v231, s50, v243
v_mfma_f32_16x16x32_bf16 v[144:147], v[208:211], v[0:3], v[192:195]
s_mov_b32 m0, s30
ds_write_b128 v231, v[176:179] offset:0
v_mfma_f32_16x16x32_bf16 v[144:147], v[212:215], v[4:7], v[144:147]
buffer_load_dwordx4 v241, s[12:15], s28 offen offset:0 sc1 lds
ds_write_b128 v231, v[180:183] offset:1024
v_mfma_f32_16x16x32_bf16 v[148:151], v[208:211], v[32:35], v[196:199]
buffer_load_dwordx4 v241, s[12:15], s28 offen offset:1024 sc1 lds
ds_write_b128 v231, v[184:187] offset:2048
v_mfma_f32_16x16x32_bf16 v[148:151], v[212:215], v[36:39], v[148:151]
buffer_load_dwordx4 v241, s[12:15], s28 offen offset:2048 sc1 lds
ds_write_b128 v231, v[188:191] offset:3072
v_mfma_f32_16x16x32_bf16 v[152:155], v[208:211], v[64:67], v[200:203]
buffer_load_dwordx4 v241, s[12:15], s28 offen offset:3072 sc1 lds
v_add_u32 v230, 0x8000, v240
v_and_b32 v230, 0x1ffff, v230
v_mfma_f32_16x16x32_bf16 v[152:155], v[212:215], v[68:71], v[152:155]
v_exp_f32 v232, v128
v_mfma_f32_16x16x32_bf16 v[156:159], v[208:211], v[96:99], v[204:207]
ds_read_b128 v[208:211], v240 offset:26624
v_exp_f32 v233, v129
v_mfma_f32_16x16x32_bf16 v[156:159], v[212:215], v[100:103], v[156:159]
ds_read_b128 v[212:215], v240 offset:27136
s_waitcnt lgkmcnt(2)
s_and_b32 s30, s30, 0x1c000
v_mfma_f32_16x16x32_bf16 v[144:147], v[216:219], v[8:11], v[144:147]
v_exp_f32 v234, v130
v_add_f32 v224, v224, v232
v_mfma_f32_16x16x32_bf16 v[144:147], v[220:223], v[12:15], v[144:147]
v_cvt_pk_bf16_f32 v176, v232, v233
v_exp_f32 v235, v131
v_mfma_f32_16x16x32_bf16 v[148:151], v[216:219], v[40:43], v[148:151]
v_add_f32 v224, v224, v233
v_add_f32 v224, v224, v234
v_add_f32 v224, v224, v235
v_mfma_f32_16x16x32_bf16 v[148:151], v[220:223], v[44:47], v[148:151]
v_cvt_pk_bf16_f32 v177, v234, v235
v_exp_f32 v236, v132
v_mfma_f32_16x16x32_bf16 v[152:155], v[216:219], v[72:75], v[152:155]
v_exp_f32 v237, v133
s_add_u32 s28, s30, 0xc000
v_mfma_f32_16x16x32_bf16 v[152:155], v[220:223], v[76:79], v[152:155]
v_exp_f32 v238, v134
v_add_f32 v225, v225, v236
v_mfma_f32_16x16x32_bf16 v[156:159], v[216:219], v[104:107], v[156:159]
ds_read_b128 v[216:219], v240 offset:30720
v_cvt_pk_bf16_f32 v180, v236, v237
s_and_b32 s28, s28, 0x1ffff
v_mfma_f32_16x16x32_bf16 v[156:159], v[220:223], v[108:111], v[156:159]
ds_read_b128 v[220:223], v240 offset:31232
s_waitcnt lgkmcnt(2)
s_add_u32 s30, s30, 0x4000
v_mfma_f32_16x16x32_bf16 v[144:147], v[208:211], v[16:19], v[144:147]
v_exp_f32 v239, v135
v_add_f32 v225, v225, v237
v_mfma_f32_16x16x32_bf16 v[144:147], v[212:215], v[20:23], v[144:147]
s_waitcnt vmcnt(4)
s_barrier
v_add_f32 v225, v225, v238
v_mfma_f32_16x16x32_bf16 v[148:151], v[208:211], v[48:51], v[148:151]
v_add_f32 v225, v225, v239
v_cvt_pk_bf16_f32 v181, v238, v239
s_and_b32 s30, s30, 0x1ffff
v_mfma_f32_16x16x32_bf16 v[148:151], v[212:215], v[52:55], v[148:151]
v_exp_f32 v232, v136
s_mul_i32 s31, s34, 6144
v_mfma_f32_16x16x32_bf16 v[152:155], v[208:211], v[80:83], v[152:155]
v_exp_f32 v233, v137
s_add_u32 s31, s31, s30
v_mfma_f32_16x16x32_bf16 v[152:155], v[212:215], v[84:87], v[152:155]
v_exp_f32 v234, v138
v_add_f32 v226, v226, v232
v_mfma_f32_16x16x32_bf16 v[156:159], v[208:211], v[112:115], v[156:159]
ds_read_b128 v[208:211], v230 offset:0
v_cvt_pk_bf16_f32 v184, v232, v233
s_lshl_b32 s3, s34, 10
v_mfma_f32_16x16x32_bf16 v[156:159], v[212:215], v[116:119], v[156:159]
ds_read_b128 v[212:215], v230 offset:512
s_waitcnt lgkmcnt(2)
s_add_u32 s28, s28, s3
v_mfma_f32_16x16x32_bf16 v[144:147], v[216:219], v[24:27], v[144:147]
v_exp_f32 v235, v139
v_add_f32 v226, v226, v233
v_mfma_f32_16x16x32_bf16 v[144:147], v[220:223], v[28:31], v[144:147]
v_add_f32 v226, v226, v234
v_add_f32 v226, v226, v235
v_cvt_pk_bf16_f32 v185, v234, v235
v_mfma_f32_16x16x32_bf16 v[148:151], v[216:219], v[56:59], v[148:151]
v_exp_f32 v236, v140
s_add_u32 s3, s3, 24576
v_mfma_f32_16x16x32_bf16 v[148:151], v[220:223], v[60:63], v[148:151]
v_exp_f32 v237, v141
s_add_u32 s30, s30, s3
v_mfma_f32_16x16x32_bf16 v[152:155], v[216:219], v[88:91], v[152:155]
v_exp_f32 v238, v142
v_add_f32 v227, v227, v236
v_mfma_f32_16x16x32_bf16 v[152:155], v[220:223], v[92:95], v[152:155]
v_cvt_pk_bf16_f32 v188, v236, v237
v_exp_f32 v239, v143
v_mfma_f32_16x16x32_bf16 v[156:159], v[216:219], v[120:123], v[156:159]
ds_read_b128 v[216:219], v230 offset:4096
v_add_f32 v227, v227, v237
v_add_f32 v227, v227, v238
v_mfma_f32_16x16x32_bf16 v[156:159], v[220:223], v[124:127], v[156:159]
ds_read_b128 v[220:223], v230 offset:4608
s_waitcnt lgkmcnt(2)
v_add_f32 v227, v227, v239
v_cvt_pk_bf16_f32 v189, v238, v239
v_max3_f32 v242, v224, v225, v226
v_max_f32 v242, v242, v227
v_cmp_lt_f32 vcc, s32, v242
s_cbranch_vccnz L2_rare_site6
L2_ret6:
v_mfma_f32_16x16x32_bf16 v[128:131], v[208:211], v[0:3], v[192:195]
v_lshrrev_b32 v241, 4, v243
v_and_b32 v241, 0x30, v241
v_xor_b32 v241, v241, v243
v_and_b32 v228, 0x380, v243
v_mad_u32_u24 v241, v228, 3, v241
v_mfma_f32_16x16x32_bf16 v[128:131], v[212:215], v[4:7], v[128:131]
v_exp_f32 v232, v144
v_mfma_f32_16x16x32_bf16 v[132:135], v[208:211], v[32:35], v[196:199]
v_exp_f32 v233, v145
v_mfma_f32_16x16x32_bf16 v[132:135], v[212:215], v[36:39], v[132:135]
v_exp_f32 v234, v146
v_add_f32 v224, v224, v232
v_mfma_f32_16x16x32_bf16 v[136:139], v[208:211], v[64:67], v[200:203]
v_cvt_pk_bf16_f32 v178, v232, v233
v_exp_f32 v235, v147
v_mfma_f32_16x16x32_bf16 v[136:139], v[212:215], v[68:71], v[136:139]
v_add_f32 v224, v224, v233
v_add_f32 v224, v224, v234
v_add_f32 v224, v224, v235
v_mfma_f32_16x16x32_bf16 v[140:143], v[208:211], v[96:99], v[204:207]
ds_read_b128 v[208:211], v230 offset:8192
v_cvt_pk_bf16_f32 v179, v234, v235
v_mfma_f32_16x16x32_bf16 v[140:143], v[212:215], v[100:103], v[140:143]
ds_read_b128 v[212:215], v230 offset:8704
s_waitcnt lgkmcnt(2)
v_mfma_f32_16x16x32_bf16 v[128:131], v[216:219], v[8:11], v[128:131]
ds_write_b128 v231, v[160:163] offset:4096
v_exp_f32 v236, v148
v_mfma_f32_16x16x32_bf16 v[128:131], v[220:223], v[12:15], v[128:131]
ds_write_b128 v231, v[164:167] offset:5120
v_exp_f32 v237, v149
v_mfma_f32_16x16x32_bf16 v[132:135], v[216:219], v[40:43], v[132:135]
ds_write_b128 v231, v[168:171] offset:6144
v_exp_f32 v238, v150
v_mfma_f32_16x16x32_bf16 v[132:135], v[220:223], v[44:47], v[132:135]
ds_write_b128 v231, v[172:175] offset:7168
v_add_f32 v225, v225, v236
v_cvt_pk_bf16_f32 v182, v236, v237
v_mfma_f32_16x16x32_bf16 v[136:139], v[216:219], v[72:75], v[136:139]
v_exp_f32 v239, v151
v_add_f32 v225, v225, v237
v_mfma_f32_16x16x32_bf16 v[136:139], v[220:223], v[76:79], v[136:139]
v_add_f32 v225, v225, v238
v_add_f32 v225, v225, v239
v_cvt_pk_bf16_f32 v183, v238, v239
v_mfma_f32_16x16x32_bf16 v[140:143], v[216:219], v[104:107], v[140:143]
ds_read_b128 v[216:219], v230 offset:12288
v_exp_f32 v232, v152
v_mfma_f32_16x16x32_bf16 v[140:143], v[220:223], v[108:111], v[140:143]
ds_read_b128 v[220:223], v230 offset:12800
s_waitcnt lgkmcnt(2)
v_mfma_f32_16x16x32_bf16 v[128:131], v[208:211], v[16:19], v[128:131]
v_exp_f32 v233, v153
v_mfma_f32_16x16x32_bf16 v[128:131], v[212:215], v[20:23], v[128:131]
v_exp_f32 v234, v154
v_add_f32 v226, v226, v232
v_mfma_f32_16x16x32_bf16 v[132:135], v[208:211], v[48:51], v[132:135]
v_cvt_pk_bf16_f32 v186, v232, v233
v_exp_f32 v235, v155
v_mfma_f32_16x16x32_bf16 v[132:135], v[212:215], v[52:55], v[132:135]
v_add_f32 v226, v226, v233
v_add_f32 v226, v226, v234
v_add_f32 v226, v226, v235
v_mfma_f32_16x16x32_bf16 v[136:139], v[208:211], v[80:83], v[136:139]
v_cvt_pk_bf16_f32 v187, v234, v235
v_exp_f32 v236, v156
v_mfma_f32_16x16x32_bf16 v[136:139], v[212:215], v[84:87], v[136:139]
v_exp_f32 v237, v157
v_mfma_f32_16x16x32_bf16 v[140:143], v[208:211], v[112:115], v[140:143]
ds_read_b128 v[208:211], v230 offset:2048
v_exp_f32 v238, v158
v_mfma_f32_16x16x32_bf16 v[140:143], v[212:215], v[116:119], v[140:143]
ds_read_b128 v[212:215], v230 offset:2560
s_waitcnt lgkmcnt(2)
v_add_f32 v227, v227, v236
v_mfma_f32_16x16x32_bf16 v[128:131], v[216:219], v[24:27], v[128:131]
v_cvt_pk_bf16_f32 v190, v236, v237
v_exp_f32 v239, v159
v_mfma_f32_16x16x32_bf16 v[128:131], v[220:223], v[28:31], v[128:131]
v_add_f32 v227, v227, v237
v_add_f32 v227, v227, v238
v_add_f32 v227, v227, v239
v_mfma_f32_16x16x32_bf16 v[132:135], v[216:219], v[56:59], v[132:135]
v_cvt_pk_bf16_f32 v191, v238, v239
v_max3_f32 v242, v224, v225, v226
v_max_f32 v242, v242, v227
v_mfma_f32_16x16x32_bf16 v[132:135], v[220:223], v[60:63], v[132:135]
v_cmp_lt_f32 vcc, s32, v242
s_cbranch_vccnz L2_rare_site7
L2_ret7:
v_mfma_f32_16x16x32_bf16 v[136:139], v[216:219], v[88:91], v[136:139]
s_add_u32 m0, s31, 0
v_mfma_f32_16x16x32_bf16 v[136:139], v[220:223], v[92:95], v[136:139]
buffer_load_dwordx4 v241, s[8:11], s6 offen lds
s_add_u32 m0, s31, 2048
v_mfma_f32_16x16x32_bf16 v[140:143], v[216:219], v[120:123], v[140:143]
ds_read_b128 v[216:219], v230 offset:6144
buffer_load_dwordx4 v241, s[8:11], s7 offen lds
s_add_u32 m0, s31, 4096
v_mfma_f32_16x16x32_bf16 v[140:143], v[220:223], v[124:127], v[140:143]
ds_read_b128 v[220:223], v230 offset:6656
s_waitcnt lgkmcnt(2)
v_mfma_f32_16x16x32_bf16 v[144:147], v[208:211], v[0:3], v[192:195]
buffer_load_dwordx4 v241, s[8:11], s29 offen lds
s_add_u32 m0, s31, 1024
v_xor_b32 v241, 0x1040, v241
v_mfma_f32_16x16x32_bf16 v[144:147], v[212:215], v[4:7], v[144:147]
v_exp_f32 v232, v128
v_mfma_f32_16x16x32_bf16 v[148:151], v[208:211], v[32:35], v[196:199]
v_exp_f32 v233, v129
v_mfma_f32_16x16x32_bf16 v[148:151], v[212:215], v[36:39], v[148:151]
v_exp_f32 v234, v130
v_add_f32 v224, v224, v232
v_mfma_f32_16x16x32_bf16 v[152:155], v[208:211], v[64:67], v[200:203]
v_cvt_pk_bf16_f32 v160, v232, v233
v_exp_f32 v235, v131
v_mfma_f32_16x16x32_bf16 v[152:155], v[212:215], v[68:71], v[152:155]
v_add_f32 v224, v224, v233
v_add_f32 v224, v224, v234
v_add_f32 v224, v224, v235
v_mfma_f32_16x16x32_bf16 v[156:159], v[208:211], v[96:99], v[204:207]
ds_read_b128 v[208:211], v230 offset:10240
v_cvt_pk_bf16_f32 v161, v234, v235
v_mfma_f32_16x16x32_bf16 v[156:159], v[212:215], v[100:103], v[156:159]
ds_read_b128 v[212:215], v230 offset:10752
s_waitcnt lgkmcnt(2)
v_mfma_f32_16x16x32_bf16 v[144:147], v[216:219], v[8:11], v[144:147]
v_exp_f32 v236, v132
v_mfma_f32_16x16x32_bf16 v[144:147], v[220:223], v[12:15], v[144:147]
v_exp_f32 v237, v133
v_mfma_f32_16x16x32_bf16 v[148:151], v[216:219], v[40:43], v[148:151]
v_exp_f32 v238, v134
v_add_f32 v225, v225, v236
v_mfma_f32_16x16x32_bf16 v[148:151], v[220:223], v[44:47], v[148:151]
v_cvt_pk_bf16_f32 v164, v236, v237
v_exp_f32 v239, v135
v_mfma_f32_16x16x32_bf16 v[152:155], v[216:219], v[72:75], v[152:155]
v_add_f32 v225, v225, v237
v_add_f32 v225, v225, v238
v_add_f32 v225, v225, v239
v_mfma_f32_16x16x32_bf16 v[152:155], v[220:223], v[76:79], v[152:155]
v_cvt_pk_bf16_f32 v165, v238, v239
v_exp_f32 v232, v136
v_mfma_f32_16x16x32_bf16 v[156:159], v[216:219], v[104:107], v[156:159]
ds_read_b128 v[216:219], v230 offset:14336
v_exp_f32 v233, v137
v_mfma_f32_16x16x32_bf16 v[156:159], v[220:223], v[108:111], v[156:159]
ds_read_b128 v[220:223], v230 offset:14848
s_waitcnt lgkmcnt(2)
v_mfma_f32_16x16x32_bf16 v[144:147], v[208:211], v[16:19], v[144:147]
v_exp_f32 v234, v138
v_add_f32 v226, v226, v232
v_mfma_f32_16x16x32_bf16 v[144:147], v[212:215], v[20:23], v[144:147]
s_waitcnt vmcnt(3)
s_barrier
v_cvt_pk_bf16_f32 v168, v232, v233
v_mfma_f32_16x16x32_bf16 v[148:151], v[208:211], v[48:51], v[148:151]
v_exp_f32 v235, v139
v_add_f32 v226, v226, v233
v_mfma_f32_16x16x32_bf16 v[148:151], v[212:215], v[52:55], v[148:151]
v_add_f32 v226, v226, v234
v_add_f32 v226, v226, v235
v_cvt_pk_bf16_f32 v169, v234, v235
v_mfma_f32_16x16x32_bf16 v[152:155], v[208:211], v[80:83], v[152:155]
v_exp_f32 v236, v140
v_mfma_f32_16x16x32_bf16 v[152:155], v[212:215], v[84:87], v[152:155]
v_exp_f32 v237, v141
v_mfma_f32_16x16x32_bf16 v[156:159], v[208:211], v[112:115], v[156:159]
ds_read_b128 v[208:211], v230 offset:16384
v_exp_f32 v238, v142
v_mfma_f32_16x16x32_bf16 v[156:159], v[212:215], v[116:119], v[156:159]
ds_read_b128 v[212:215], v230 offset:16896
s_waitcnt lgkmcnt(2)
v_add_f32 v227, v227, v236
v_mfma_f32_16x16x32_bf16 v[144:147], v[216:219], v[24:27], v[144:147]
v_cvt_pk_bf16_f32 v172, v236, v237
v_exp_f32 v239, v143
v_mfma_f32_16x16x32_bf16 v[144:147], v[220:223], v[28:31], v[144:147]
v_add_f32 v227, v227, v237
v_add_f32 v227, v227, v238
v_add_f32 v227, v227, v239
v_mfma_f32_16x16x32_bf16 v[148:151], v[216:219], v[56:59], v[148:151]
v_cvt_pk_bf16_f32 v173, v238, v239
v_max3_f32 v242, v224, v225, v226
v_max_f32 v242, v242, v227
v_mfma_f32_16x16x32_bf16 v[148:151], v[220:223], v[60:63], v[148:151]
v_cmp_lt_f32 vcc, s32, v242
s_cbranch_vccnz L2_rare_site8
L2_ret8:
v_mfma_f32_16x16x32_bf16 v[152:155], v[216:219], v[88:91], v[152:155]
buffer_load_dwordx4 v241, s[8:11], s6 offen lds
s_add_u32 m0, s31, 3072
v_mfma_f32_16x16x32_bf16 v[152:155], v[220:223], v[92:95], v[152:155]
buffer_load_dwordx4 v241, s[8:11], s7 offen lds
s_add_u32 m0, s31, 5120
v_mfma_f32_16x16x32_bf16 v[156:159], v[216:219], v[120:123], v[156:159]
ds_read_b128 v[216:219], v230 offset:20480
buffer_load_dwordx4 v241, s[8:11], s29 offen lds
v_mfma_f32_16x16x32_bf16 v[156:159], v[220:223], v[124:127], v[156:159]
ds_read_b128 v[220:223], v230 offset:20992
s_waitcnt lgkmcnt(2)
v_mfma_f32_16x16x32_bf16 v[128:131], v[208:211], v[0:3], v[192:195]
v_mfma_f32_16x16x32_bf16 v[128:131], v[212:215], v[4:7], v[128:131]
v_exp_f32 v232, v144
v_mfma_f32_16x16x32_bf16 v[132:135], v[208:211], v[32:35], v[196:199]
v_exp_f32 v233, v145
v_mfma_f32_16x16x32_bf16 v[132:135], v[212:215], v[36:39], v[132:135]
v_exp_f32 v234, v146
v_add_f32 v224, v224, v232
v_mfma_f32_16x16x32_bf16 v[136:139], v[208:211], v[64:67], v[200:203]
v_cvt_pk_bf16_f32 v162, v232, v233
v_exp_f32 v235, v147
v_mfma_f32_16x16x32_bf16 v[136:139], v[212:215], v[68:71], v[136:139]
v_add_f32 v224, v224, v233
v_add_f32 v224, v224, v234
v_add_f32 v224, v224, v235
v_mfma_f32_16x16x32_bf16 v[140:143], v[208:211], v[96:99], v[204:207]
ds_read_b128 v[208:211], v230 offset:24576
v_cvt_pk_bf16_f32 v163, v234, v235
v_lshlrev_b32 v241, 3, v243
v_mfma_f32_16x16x32_bf16 v[140:143], v[212:215], v[100:103], v[140:143]
ds_read_b128 v[212:215], v230 offset:25088
s_waitcnt lgkmcnt(2)
s_mov_b32 s3, 0x7c28000
v_mfma_f32_16x16x32_bf16 v[128:131], v[216:219], v[8:11], v[128:131]
v_exp_f32 v236, v148
buffer_load_dwordx2 v[240:241], v241, s[16:19], s3 offen sc1
v_mfma_f32_16x16x32_bf16 v[128:131], v[220:223], v[12:15], v[128:131]
v_exp_f32 v237, v149
v_mfma_f32_16x16x32_bf16 v[132:135], v[216:219], v[40:43], v[132:135]
v_exp_f32 v238, v150
v_add_f32 v225, v225, v236
v_mfma_f32_16x16x32_bf16 v[132:135], v[220:223], v[44:47], v[132:135]
v_cvt_pk_bf16_f32 v166, v236, v237
v_exp_f32 v239, v151
v_mfma_f32_16x16x32_bf16 v[136:139], v[216:219], v[72:75], v[136:139]
v_add_f32 v225, v225, v237
v_add_f32 v225, v225, v238
v_add_f32 v225, v225, v239
v_mfma_f32_16x16x32_bf16 v[136:139], v[220:223], v[76:79], v[136:139]
v_cvt_pk_bf16_f32 v167, v238, v239
v_exp_f32 v232, v152
v_mfma_f32_16x16x32_bf16 v[140:143], v[216:219], v[104:107], v[140:143]
ds_read_b128 v[216:219], v230 offset:28672
v_exp_f32 v233, v153
v_mfma_f32_16x16x32_bf16 v[140:143], v[220:223], v[108:111], v[140:143]
ds_read_b128 v[220:223], v230 offset:29184
s_waitcnt lgkmcnt(2)
v_mfma_f32_16x16x32_bf16 v[128:131], v[208:211], v[16:19], v[128:131]
v_exp_f32 v234, v154
v_add_f32 v226, v226, v232
v_mfma_f32_16x16x32_bf16 v[128:131], v[212:215], v[20:23], v[128:131]
v_cvt_pk_bf16_f32 v170, v232, v233
v_exp_f32 v235, v155
v_mfma_f32_16x16x32_bf16 v[132:135], v[208:211], v[48:51], v[132:135]
v_add_f32 v226, v226, v233
v_add_f32 v226, v226, v234
v_add_f32 v226, v226, v235
v_mfma_f32_16x16x32_bf16 v[132:135], v[212:215], v[52:55], v[132:135]
v_cvt_pk_bf16_f32 v171, v234, v235
v_exp_f32 v236, v156
v_mfma_f32_16x16x32_bf16 v[136:139], v[208:211], v[80:83], v[136:139]
v_exp_f32 v237, v157
v_mfma_f32_16x16x32_bf16 v[136:139], v[212:215], v[84:87], v[136:139]
v_exp_f32 v238, v158
v_add_f32 v227, v227, v236
v_mfma_f32_16x16x32_bf16 v[140:143], v[208:211], v[112:115], v[140:143]
ds_read_b128 v[208:211], v230 offset:18432
v_cvt_pk_bf16_f32 v174, v236, v237
v_mfma_f32_16x16x32_bf16 v[140:143], v[212:215], v[116:119], v[140:143]
ds_read_b128 v[212:215], v230 offset:18944
s_waitcnt lgkmcnt(2)
v_mfma_f32_16x16x32_bf16 v[128:131], v[216:219], v[24:27], v[128:131]
v_exp_f32 v239, v159
v_add_f32 v227, v227, v237
v_mfma_f32_16x16x32_bf16 v[128:131], v[220:223], v[28:31], v[128:131]
v_add_f32 v227, v227, v238
v_add_f32 v227, v227, v239
v_cvt_pk_bf16_f32 v175, v238, v239
v_mfma_f32_16x16x32_bf16 v[132:135], v[216:219], v[56:59], v[132:135]
v_max3_f32 v242, v224, v225, v226
v_max_f32 v242, v242, v227
v_cmp_lt_f32 vcc, s32, v242
s_cbranch_vccnz L2_rare_site9
L2_ret9:
v_mfma_f32_16x16x32_bf16 v[132:135], v[220:223], v[60:63], v[132:135]
v_mfma_f32_16x16x32_bf16 v[136:139], v[216:219], v[88:91], v[136:139]
v_mfma_f32_16x16x32_bf16 v[136:139], v[220:223], v[92:95], v[136:139]
v_mfma_f32_16x16x32_bf16 v[140:143], v[216:219], v[120:123], v[140:143]
ds_read_b128 v[216:219], v230 offset:22528
v_mfma_f32_16x16x32_bf16 v[140:143], v[220:223], v[124:127], v[140:143]
ds_read_b128 v[220:223], v230 offset:23040
s_waitcnt lgkmcnt(2)
v_mfma_f32_16x16x32_bf16 v[144:147], v[208:211], v[0:3], v[192:195]
v_mfma_f32_16x16x32_bf16 v[144:147], v[212:215], v[4:7], v[144:147]
v_mfma_f32_16x16x32_bf16 v[148:151], v[208:211], v[32:35], v[196:199]
v_mfma_f32_16x16x32_bf16 v[148:151], v[212:215], v[36:39], v[148:151]
v_mfma_f32_16x16x32_bf16 v[152:155], v[208:211], v[64:67], v[200:203]
v_exp_f32 v232, v128
v_mfma_f32_16x16x32_bf16 v[152:155], v[212:215], v[68:71], v[152:155]
v_exp_f32 v233, v129
v_mfma_f32_16x16x32_bf16 v[156:159], v[208:211], v[96:99], v[204:207]
ds_read_b128 v[208:211], v230 offset:26624
v_exp_f32 v234, v130
v_mfma_f32_16x16x32_bf16 v[156:159], v[212:215], v[100:103], v[156:159]
ds_read_b128 v[212:215], v230 offset:27136
s_waitcnt lgkmcnt(2)
v_add_f32 v224, v224, v232
v_mfma_f32_16x16x32_bf16 v[144:147], v[216:219], v[8:11], v[144:147]
v_cvt_pk_bf16_f32 v0, v232, v233
v_exp_f32 v235, v131
v_mfma_f32_16x16x32_bf16 v[144:147], v[220:223], v[12:15], v[144:147]
ds_read_b128 v[4:7], v231 offset:0
v_add_f32 v224, v224, v233
v_add_f32 v224, v224, v234
v_mfma_f32_16x16x32_bf16 v[148:151], v[216:219], v[40:43], v[148:151]
ds_read_b128 v[36:39], v231 offset:1024
v_add_f32 v224, v224, v235
v_cvt_pk_bf16_f32 v1, v234, v235
v_mfma_f32_16x16x32_bf16 v[148:151], v[220:223], v[44:47], v[148:151]
v_exp_f32 v236, v132
v_mfma_f32_16x16x32_bf16 v[152:155], v[216:219], v[72:75], v[152:155]
v_exp_f32 v237, v133
v_mfma_f32_16x16x32_bf16 v[152:155], v[220:223], v[76:79], v[152:155]
ds_read_b128 v[68:71], v231 offset:2048
ds_read_b128 v[8:11], v231 offset:4096
v_mfma_f32_16x16x32_bf16 v[156:159], v[216:219], v[104:107], v[156:159]
ds_read_b128 v[216:219], v230 offset:30720
v_add_u32 v12, 0x8000, v244
v_and_b32 v12, 0x1ffff, v12
ds_read_b128 v[100:103], v231 offset:3072
ds_read_b128 v[40:43], v231 offset:5120
v_mfma_f32_16x16x32_bf16 v[156:159], v[220:223], v[108:111], v[156:159]
ds_read_b128 v[220:223], v230 offset:31232
s_waitcnt lgkmcnt(2)
v_add_u32 v14, 0x10000, v244
v_and_b32 v14, 0x1ffff, v14
v_mfma_f32_16x16x32_bf16 v[144:147], v[208:211], v[16:19], v[144:147]
v_xor_b32 v13, 32, v12
v_xor_b32 v15, 32, v14
v_mfma_f32_16x16x32_bf16 v[144:147], v[212:215], v[20:23], v[144:147]
ds_read_b128 v[72:75], v231 offset:6144
v_exp_f32 v238, v134
v_mfma_f32_16x16x32_bf16 v[148:151], v[208:211], v[48:51], v[148:151]
ds_read_b128 v[104:107], v231 offset:7168
v_add_f32 v225, v225, v236
v_cvt_pk_bf16_f32 v32, v236, v237
v_mfma_f32_16x16x32_bf16 v[148:151], v[212:215], v[52:55], v[148:151]
v_exp_f32 v239, v135
v_add_f32 v225, v225, v237
v_mfma_f32_16x16x32_bf16 v[152:155], v[208:211], v[80:83], v[152:155]
v_add_f32 v225, v225, v238
v_add_f32 v225, v225, v239
v_cvt_pk_bf16_f32 v33, v238, v239
v_mfma_f32_16x16x32_bf16 v[152:155], v[212:215], v[84:87], v[152:155]
v_exp_f32 v232, v136
v_mfma_f32_16x16x32_bf16 v[156:159], v[208:211], v[112:115], v[156:159]
ds_read_b64_tr_b16 v[208:209], v244 offset:16384
ds_read_b64_tr_b16 v[210:211], v244 offset:18432
v_mfma_f32_16x16x32_bf16 v[156:159], v[212:215], v[116:119], v[156:159]
ds_read_b64_tr_b16 v[212:213], v12 offset:0
s_waitcnt lgkmcnt(3)
v_mfma_f32_16x16x32_bf16 v[144:147], v[216:219], v[24:27], v[144:147]
ds_read_b64_tr_b16 v[214:215], v12 offset:2048
v_exp_f32 v233, v137
v_mfma_f32_16x16x32_bf16 v[144:147], v[220:223], v[28:31], v[144:147]
v_exp_f32 v234, v138
v_add_f32 v226, v226, v232
v_mfma_f32_16x16x32_bf16 v[148:151], v[216:219], v[56:59], v[148:151]
v_cvt_pk_bf16_f32 v64, v232, v233
v_exp_f32 v235, v139
v_mfma_f32_16x16x32_bf16 v[148:151], v[220:223], v[60:63], v[148:151]
v_add_f32 v226, v226, v233
v_add_f32 v226, v226, v234
v_add_f32 v226, v226, v235
v_mfma_f32_16x16x32_bf16 v[152:155], v[216:219], v[88:91], v[152:155]
v_cvt_pk_bf16_f32 v65, v234, v235
v_exp_f32 v236, v140
v_mfma_f32_16x16x32_bf16 v[152:155], v[220:223], v[92:95], v[152:155]
v_exp_f32 v237, v141
s_waitcnt vmcnt(0)
v_mfma_f32_16x16x32_bf16 v[156:159], v[216:219], v[120:123], v[156:159]
ds_read_b64_tr_b16 v[216:217], v12 offset:16384
ds_read_b64_tr_b16 v[218:219], v12 offset:18432
v_cmp_ne_u64_e64 s[38:39], s[98:99], v[240:241]
v_mfma_f32_16x16x32_bf16 v[156:159], v[220:223], v[124:127], v[156:159]
ds_read_b64_tr_b16 v[220:221], v14 offset:0
s_waitcnt lgkmcnt(3)
v_exp_f32 v238, v142
v_add_f32 v227, v227, v236
v_cvt_pk_bf16_f32 v96, v236, v237
v_exp_f32 v239, v143
v_add_f32 v227, v227, v237
v_add_f32 v227, v227, v238
v_add_f32 v227, v227, v239
v_cvt_pk_bf16_f32 v97, v238, v239
v_max3_f32 v242, v224, v225, v226
v_max_f32 v242, v242, v227
v_cmp_lt_f32 vcc, s32, v242
s_cbranch_vccnz L2_rare_site10
L2_ret10:
v_mfma_f32_16x16x32_bf16 a[0:3], v[4:7], v[208:211], a[0:3]
ds_read_b64_tr_b16 v[222:223], v14 offset:2048
s_and_b64 s[38:39], s[38:39], s[96:97]
s_cbranch_scc1 LF_hl_1
LF_hlret_1:
v_mfma_f32_16x16x32_bf16 a[0:3], v[8:11], v[212:215], a[0:3]
v_exp_f32 v232, v144
v_lshrrev_b32 v241, 4, v243
v_mfma_f32_16x16x32_bf16 a[4:7], v[36:39], v[208:211], a[4:7]
v_exp_f32 v233, v145
v_and_b32 v241, 0x30, v241
v_mfma_f32_16x16x32_bf16 a[4:7], v[40:43], v[212:215], a[4:7]
v_exp_f32 v234, v146
v_xor_b32 v241, v241, v243
v_mfma_f32_16x16x32_bf16 a[8:11], v[68:71], v[208:211], a[8:11]
v_add_f32 v224, v224, v232
v_cvt_pk_bf16_f32 v2, v232, v233
v_mfma_f32_16x16x32_bf16 a[8:11], v[72:75], v[212:215], a[8:11]
v_exp_f32 v235, v147
v_mfma_f32_16x16x32_bf16 a[12:15], v[100:103], v[208:211], a[12:15]
ds_read_b64_tr_b16 v[208:209], v245 offset:16384
ds_read_b64_tr_b16 v[210:211], v245 offset:18432
v_mfma_f32_16x16x32_bf16 a[12:15], v[104:107], v[212:215], a[12:15]
ds_read_b64_tr_b16 v[212:213], v13 offset:0
s_waitcnt lgkmcnt(3)
v_mfma_f32_16x16x32_bf16 a[0:3], v[176:179], v[216:219], a[0:3]
ds_read_b64_tr_b16 v[214:215], v13 offset:2048
v_add_f32 v224, v224, v233
v_mfma_f32_16x16x32_bf16 a[0:3], v[160:163], v[220:223], a[0:3]
v_add_f32 v224, v224, v234
v_add_f32 v224, v224, v235
v_mfma_f32_16x16x32_bf16 a[4:7], v[180:183], v[216:219], a[4:7]
v_cvt_pk_bf16_f32 v3, v234, v235
v_and_b32 v228, 0x380, v243
v_mad_u32_u24 v241, v228, 3, v241
v_mfma_f32_16x16x32_bf16 a[4:7], v[164:167], v[220:223], a[4:7]
v_exp_f32 v236, v148
v_add_u32 v241, 0x7000000, v241
v_mfma_f32_16x16x32_bf16 a[8:11], v[184:187], v[216:219], a[8:11]
v_exp_f32 v237, v149
v_and_b32 v110, 0x70, v243
v_mfma_f32_16x16x32_bf16 a[8:11], v[168:171], v[220:223], a[8:11]
v_exp_f32 v238, v150
v_lshlrev_b32 v110, 3, v110
v_mfma_f32_16x16x32_bf16 a[12:15], v[188:191], v[216:219], a[12:15]
ds_read_b64_tr_b16 v[216:217], v13 offset:16384
ds_read_b64_tr_b16 v[218:219], v13 offset:18432
v_add_u32 v110, 0x7c32000, v110
v_mfma_f32_16x16x32_bf16 a[12:15], v[172:175], v[220:223], a[12:15]
ds_read_b64_tr_b16 v[220:221], v15 offset:0
s_waitcnt lgkmcnt(3)
buffer_load_dwordx2 v[108:109], v110, s[16:19], 0 offen sc1
v_mfma_f32_16x16x32_bf16 a[16:19], v[4:7], v[208:211], a[16:19]
ds_read_b64_tr_b16 v[222:223], v15 offset:2048
v_add_f32 v225, v225, v236
v_mfma_f32_16x16x32_bf16 a[16:19], v[8:11], v[212:215], a[16:19]
v_cvt_pk_bf16_f32 v34, v236, v237
s_add_u32 m0, s28, 0
v_mfma_f32_16x16x32_bf16 a[20:23], v[36:39], v[208:211], a[20:23]
v_exp_f32 v239, v151
v_mfma_f32_16x16x32_bf16 a[20:23], v[40:43], v[212:215], a[20:23]
v_add_f32 v225, v225, v237
v_add_f32 v225, v225, v238
v_mfma_f32_16x16x32_bf16 a[24:27], v[68:71], v[208:211], a[24:27]
v_add_f32 v225, v225, v239
v_cvt_pk_bf16_f32 v35, v238, v239
v_mfma_f32_16x16x32_bf16 a[24:27], v[72:75], v[212:215], a[24:27]
v_exp_f32 v232, v152
v_mfma_f32_16x16x32_bf16 a[28:31], v[100:103], v[208:211], a[28:31]
ds_read_b64_tr_b16 v[208:209], v244 offset:16896
ds_read_b64_tr_b16 v[210:211], v244 offset:18944
v_mfma_f32_16x16x32_bf16 a[28:31], v[104:107], v[212:215], a[28:31]
ds_read_b64_tr_b16 v[212:213], v12 offset:512
s_waitcnt lgkmcnt(3)
v_mfma_f32_16x16x32_bf16 a[16:19], v[176:179], v[216:219], a[16:19]
ds_read_b64_tr_b16 v[214:215], v12 offset:2560
buffer_load_dwordx4 v241, s[16:19], s6 offen sc1 lds
s_add_u32 m0, s28, 8192
v_mfma_f32_16x16x32_bf16 a[16:19], v[160:163], v[220:223], a[16:19]
v_exp_f32 v233, v153
v_mfma_f32_16x16x32_bf16 a[20:23], v[180:183], v[216:219], a[20:23]
v_exp_f32 v234, v154
v_mfma_f32_16x16x32_bf16 a[20:23], v[164:167], v[220:223], a[20:23]
v_add_f32 v226, v226, v232
v_cvt_pk_bf16_f32 v66, v232, v233
v_mfma_f32_16x16x32_bf16 a[24:27], v[184:187], v[216:219], a[24:27]
v_exp_f32 v235, v155
v_mfma_f32_16x16x32_bf16 a[24:27], v[168:171], v[220:223], a[24:27]
v_add_f32 v226, v226, v233
v_add_f32 v226, v226, v234
v_mfma_f32_16x16x32_bf16 a[28:31], v[188:191], v[216:219], a[28:31]
ds_read_b64_tr_b16 v[216:217], v12 offset:16896
ds_read_b64_tr_b16 v[218:219], v12 offset:18944
v_mfma_f32_16x16x32_bf16 a[28:31], v[172:175], v[220:223], a[28:31]
ds_read_b64_tr_b16 v[220:221], v14 offset:512
s_waitcnt lgkmcnt(3)
v_mfma_f32_16x16x32_bf16 a[32:35], v[4:7], v[208:211], a[32:35]
ds_read_b64_tr_b16 v[222:223], v14 offset:2560
v_add_f32 v226, v226, v235
v_mfma_f32_16x16x32_bf16 a[32:35], v[8:11], v[212:215], a[32:35]
v_cvt_pk_bf16_f32 v67, v234, v235
buffer_load_dwordx4 v241, s[16:19], s7 offen sc1 lds
s_add_u32 m0, s30, 0
v_mfma_f32_16x16x32_bf16 a[36:39], v[36:39], v[208:211], a[36:39]
v_exp_f32 v236, v156
v_mfma_f32_16x16x32_bf16 a[36:39], v[40:43], v[212:215], a[36:39]
v_exp_f32 v237, v157
v_mfma_f32_16x16x32_bf16 a[40:43], v[68:71], v[208:211], a[40:43]
v_exp_f32 v238, v158
v_mfma_f32_16x16x32_bf16 a[40:43], v[72:75], v[212:215], a[40:43]
v_add_f32 v227, v227, v236
v_cvt_pk_bf16_f32 v98, v236, v237
v_mfma_f32_16x16x32_bf16 a[44:47], v[100:103], v[208:211], a[44:47]
ds_read_b64_tr_b16 v[208:209], v245 offset:16896
ds_read_b64_tr_b16 v[210:211], v245 offset:18944
v_mfma_f32_16x16x32_bf16 a[44:47], v[104:107], v[212:215], a[44:47]
ds_read_b64_tr_b16 v[212:213], v13 offset:512
s_waitcnt lgkmcnt(3)
v_mfma_f32_16x16x32_bf16 a[32:35], v[176:179], v[216:219], a[32:35]
ds_read_b64_tr_b16 v[214:215], v13 offset:2560
buffer_load_dwordx4 v241, s[16:19], s29 offen sc1 lds
s_add_u32 m0, s28, 4096
v_mfma_f32_16x16x32_bf16 a[32:35], v[160:163], v[220:223], a[32:35]
v_exp_f32 v239, v159
v_xor_b32 v241, 0x1040, v241
v_mfma_f32_16x16x32_bf16 a[36:39], v[180:183], v[216:219], a[36:39]
v_add_f32 v227, v227, v237
v_add_f32 v227, v227, v238
v_mfma_f32_16x16x32_bf16 a[36:39], v[164:167], v[220:223], a[36:39]
v_add_f32 v227, v227, v239
v_cvt_pk_bf16_f32 v99, v238, v239
v_mfma_f32_16x16x32_bf16 a[40:43], v[184:187], v[216:219], a[40:43]
v_max3_f32 v242, v224, v225, v226
v_max_f32 v242, v242, v227
v_mfma_f32_16x16x32_bf16 a[40:43], v[168:171], v[220:223], a[40:43]
v_cmp_lt_f32 vcc, s32, v242
s_cbranch_vccnz L2_rare_site11
L2_ret11:
v_mfma_f32_16x16x32_bf16 a[44:47], v[188:191], v[216:219], a[44:47]
ds_read_b64_tr_b16 v[216:217], v13 offset:16896
ds_read_b64_tr_b16 v[218:219], v13 offset:18944
v_mfma_f32_16x16x32_bf16 a[44:47], v[172:175], v[220:223], a[44:47]
ds_read_b64_tr_b16 v[220:221], v15 offset:512
s_waitcnt lgkmcnt(3)
v_mfma_f32_16x16x32_bf16 a[48:51], v[4:7], v[208:211], a[48:51]
ds_read_b64_tr_b16 v[222:223], v15 offset:2560
buffer_load_dwordx4 v241, s[16:19], s6 offen sc1 lds
s_add_u32 m0, s28, 12288
v_mfma_f32_16x16x32_bf16 a[48:51], v[8:11], v[212:215], a[48:51]
buffer_load_dwordx4 v241, s[16:19], s7 offen sc1 lds
s_add_u32 m0, s30, 4096
v_mfma_f32_16x16x32_bf16 a[52:55], v[36:39], v[208:211], a[52:55]
buffer_load_dwordx4 v241, s[16:19], s29 offen sc1 lds
v_mfma_f32_16x16x32_bf16 a[52:55], v[40:43], v[212:215], a[52:55]
v_mfma_f32_16x16x32_bf16 a[56:59], v[68:71], v[208:211], a[56:59]
v_mfma_f32_16x16x32_bf16 a[56:59], v[72:75], v[212:215], a[56:59]
v_mfma_f32_16x16x32_bf16 a[60:63], v[100:103], v[208:211], a[60:63]
ds_read_b64_tr_b16 v[208:209], v14 offset:16384
ds_read_b64_tr_b16 v[210:211], v14 offset:18432
v_mfma_f32_16x16x32_bf16 a[60:63], v[104:107], v[212:215], a[60:63]
ds_read_b64_tr_b16 v[212:213], v15 offset:16384
s_waitcnt lgkmcnt(3)
v_mfma_f32_16x16x32_bf16 a[48:51], v[176:179], v[216:219], a[48:51]
ds_read_b64_tr_b16 v[214:215], v15 offset:18432
v_mfma_f32_16x16x32_bf16 a[48:51], v[160:163], v[220:223], a[48:51]
v_mfma_f32_16x16x32_bf16 a[52:55], v[180:183], v[216:219], a[52:55]
v_mfma_f32_16x16x32_bf16 a[52:55], v[164:167], v[220:223], a[52:55]
v_mfma_f32_16x16x32_bf16 a[56:59], v[184:187], v[216:219], a[56:59]
v_mfma_f32_16x16x32_bf16 a[56:59], v[168:171], v[220:223], a[56:59]
v_mfma_f32_16x16x32_bf16 a[60:63], v[188:191], v[216:219], a[60:63]
ds_read_b64_tr_b16 v[216:217], v14 offset:16896
ds_read_b64_tr_b16 v[218:219], v14 offset:18944
v_mfma_f32_16x16x32_bf16 a[60:63], v[172:175], v[220:223], a[60:63]
ds_read_b64_tr_b16 v[220:221], v15 offset:16896
s_waitcnt lgkmcnt(5)
v_mfma_f32_16x16x32_bf16 a[0:3], v[0:3], v[208:211], a[0:3]
ds_read_b64_tr_b16 v[222:223], v15 offset:18944
v_bfe_u32 v242, v243, 8, 1
v_mul_u32_u24 v242, 48, v242
v_mfma_f32_16x16x32_bf16 a[4:7], v[32:35], v[208:211], a[4:7]
v_lshl_add_u32 v242, s37, 3, v242
v_and_b32 v228, 0xf0, v243
v_lshl_add_u32 v242, v228, 3, v242
v_mfma_f32_16x16x32_bf16 a[8:11], v[64:67], v[208:211], a[8:11]
v_mov_b32 v232, v224
v_mov_b32 v234, v225
v_mov_b32 v236, v226
v_mfma_f32_16x16x32_bf16 a[12:15], v[96:99], v[208:211], a[12:15]
ds_read_b64_tr_b16 v[208:209], v244 offset:20480
s_waitcnt lgkmcnt(5)
v_mov_b32 v238, v227
v_mfma_f32_16x16x32_bf16 a[16:19], v[0:3], v[212:215], a[16:19]
ds_read_b64_tr_b16 v[210:211], v244 offset:22528
v_permlane32_swap_b32 v224, v232
v_permlane32_swap_b32 v225, v234
v_mfma_f32_16x16x32_bf16 a[20:23], v[32:35], v[212:215], a[20:23]
v_permlane32_swap_b32 v226, v236
v_permlane32_swap_b32 v227, v238
v_add_f32 v224, v224, v232
v_mfma_f32_16x16x32_bf16 a[24:27], v[64:67], v[212:215], a[24:27]
v_add_f32 v225, v225, v234
v_add_f32 v226, v226, v236
v_add_f32 v227, v227, v238
v_mfma_f32_16x16x32_bf16 a[28:31], v[96:99], v[212:215], a[28:31]
ds_read_b64_tr_b16 v[212:213], v12 offset:4096
s_waitcnt lgkmcnt(5)
v_mov_b32 v232, v224
v_mfma_f32_16x16x32_bf16 a[32:35], v[0:3], v[216:219], a[32:35]
ds_read_b64_tr_b16 v[214:215], v12 offset:6144
v_mov_b32 v234, v225
v_mov_b32 v236, v226
v_mfma_f32_16x16x32_bf16 a[36:39], v[32:35], v[216:219], a[36:39]
v_mov_b32 v238, v227
v_permlane16_swap_b32 v224, v232
v_permlane16_swap_b32 v225, v234
v_mfma_f32_16x16x32_bf16 a[40:43], v[64:67], v[216:219], a[40:43]
v_permlane16_swap_b32 v226, v236
v_permlane16_swap_b32 v227, v238
v_add_f32 v233, v224, v232
v_mfma_f32_16x16x32_bf16 a[44:47], v[96:99], v[216:219], a[44:47]
ds_read_b64_tr_b16 v[216:217], v12 offset:20480
s_waitcnt lgkmcnt(5)
v_add_f32 v235, v225, v234
v_mfma_f32_16x16x32_bf16 a[48:51], v[0:3], v[220:223], a[48:51]
ds_read_b64_tr_b16 v[218:219], v12 offset:22528
v_add_f32 v237, v226, v236
v_add_f32 v239, v227, v238
v_mfma_f32_16x16x32_bf16 a[52:55], v[32:35], v[220:223], a[52:55]
v_sub_f32 v232, 0, v192
v_sub_f32 v234, 0, v196
v_sub_f32 v236, 0, v200
v_mfma_f32_16x16x32_bf16 a[56:59], v[64:67], v[220:223], a[56:59]
v_sub_f32 v238, 0, v204
v_mfma_f32_16x16x32_bf16 a[60:63], v[96:99], v[220:223], a[60:63]
ds_read_b64_tr_b16 v[220:221], v14 offset:4096
s_waitcnt lgkmcnt(3)
v_mfma_f32_16x16x32_bf16 a[64:67], v[4:7], v[208:211], a[64:67]
ds_read_b64_tr_b16 v[222:223], v14 offset:6144
v_mfma_f32_16x16x32_bf16 a[64:67], v[8:11], v[212:215], a[64:67]
s_mov_b32 exec_hi, 0
buffer_store_dwordx2 v[232:233], v242, s[24:27], s48 offen sc1
s_lshr_b32 s3, s41, 2
buffer_store_dwordx2 v[234:235], v242, s[24:27], s3 offen sc1
s_lshr_b32 s3, s42, 2
buffer_store_dwordx2 v[236:237], v242, s[24:27], s3 offen sc1
s_lshr_b32 s3, s43, 2
buffer_store_dwordx2 v[238:239], v242, s[24:27], s3 offen sc1
s_mov_b32 exec_hi, -1
v_mfma_f32_16x16x32_bf16 a[68:71], v[36:39], v[208:211], a[68:71]
v_accvgpr_read_b32 v128, a0
v_accvgpr_read_b32 v129, a1
v_accvgpr_read_b32 v130, a2
v_mfma_f32_16x16x32_bf16 a[68:71], v[40:43], v[212:215], a[68:71]
v_accvgpr_read_b32 v131, a3
v_cvt_pk_bf16_f32 v16, v128, v129
v_cvt_pk_bf16_f32 v17, v130, v131
v_mfma_f32_16x16x32_bf16 a[72:75], v[68:71], v[208:211], a[72:75]
v_accvgpr_read_b32 v136, a4
v_accvgpr_read_b32 v137, a5
v_accvgpr_read_b32 v138, a6
v_mfma_f32_16x16x32_bf16 a[72:75], v[72:75], v[212:215], a[72:75]
v_accvgpr_read_b32 v139, a7
v_cvt_pk_bf16_f32 v48, v136, v137
v_cvt_pk_bf16_f32 v49, v138, v139
v_mfma_f32_16x16x32_bf16 a[76:79], v[100:103], v[208:211], a[76:79]
ds_read_b64_tr_b16 v[208:209], v14 offset:20480
ds_read_b64_tr_b16 v[210:211], v14 offset:22528
v_accvgpr_read_b32 v144, a8
v_mfma_f32_16x16x32_bf16 a[76:79], v[104:107], v[212:215], a[76:79]
ds_read_b64_tr_b16 v[212:213], v245 offset:20480
s_waitcnt lgkmcnt(3)
v_accvgpr_read_b32 v145, a9
v_mfma_f32_16x16x32_bf16 a[64:67], v[176:179], v[216:219], a[64:67]
ds_read_b64_tr_b16 v[214:215], v245 offset:22528
v_accvgpr_read_b32 v146, a10
v_accvgpr_read_b32 v147, a11
v_mfma_f32_16x16x32_bf16 a[64:67], v[160:163], v[220:223], a[64:67]
v_cvt_pk_bf16_f32 v80, v144, v145
v_cvt_pk_bf16_f32 v81, v146, v147
v_accvgpr_read_b32 v152, a12
v_mfma_f32_16x16x32_bf16 a[68:71], v[180:183], v[216:219], a[68:71]
v_accvgpr_read_b32 v153, a13
v_accvgpr_read_b32 v154, a14
v_accvgpr_read_b32 v155, a15
v_mfma_f32_16x16x32_bf16 a[68:71], v[164:167], v[220:223], a[68:71]
v_cvt_pk_bf16_f32 v112, v152, v153
v_cvt_pk_bf16_f32 v113, v154, v155
v_accvgpr_read_b32 v132, a16
v_mfma_f32_16x16x32_bf16 a[72:75], v[184:187], v[216:219], a[72:75]
v_accvgpr_read_b32 v133, a17
v_accvgpr_read_b32 v134, a18
v_accvgpr_read_b32 v135, a19
v_mfma_f32_16x16x32_bf16 a[72:75], v[168:171], v[220:223], a[72:75]
v_cvt_pk_bf16_f32 v18, v132, v133
v_cvt_pk_bf16_f32 v19, v134, v135
buffer_store_dwordx4 v[16:19], v243, s[20:23], s40 offen offset:0 sc1
v_mfma_f32_16x16x32_bf16 a[76:79], v[188:191], v[216:219], a[76:79]
ds_read_b64_tr_b16 v[216:217], v13 offset:4096
ds_read_b64_tr_b16 v[218:219], v13 offset:6144
ds_write_b128 v231, v[16:19] offset:0
v_mfma_f32_16x16x32_bf16 a[76:79], v[172:175], v[220:223], a[76:79]
ds_read_b64_tr_b16 v[220:221], v13 offset:20480
s_waitcnt lgkmcnt(5)
v_accvgpr_read_b32 v140, a20
v_mfma_f32_16x16x32_bf16 a[64:67], v[0:3], v[208:211], a[64:67]
ds_read_b64_tr_b16 v[222:223], v13 offset:22528
v_accvgpr_read_b32 v141, a21
v_accvgpr_read_b32 v142, a22
v_mfma_f32_16x16x32_bf16 a[68:71], v[32:35], v[208:211], a[68:71]
v_accvgpr_read_b32 v143, a23
v_cvt_pk_bf16_f32 v50, v140, v141
v_cvt_pk_bf16_f32 v51, v142, v143
v_mfma_f32_16x16x32_bf16 a[72:75], v[64:67], v[208:211], a[72:75]
buffer_store_dwordx4 v[48:51], v243, s[20:23], s41 offen offset:0 sc1
v_accvgpr_read_b32 v148, a24
v_accvgpr_read_b32 v149, a25
v_mfma_f32_16x16x32_bf16 a[76:79], v[96:99], v[208:211], a[76:79]
ds_read_b64_tr_b16 v[208:209], v15 offset:4096
s_waitcnt lgkmcnt(5)
v_accvgpr_read_b32 v150, a26
v_mfma_f32_16x16x32_bf16 a[80:83], v[4:7], v[212:215], a[80:83]
ds_read_b64_tr_b16 v[210:211], v15 offset:6144
v_accvgpr_read_b32 v151, a27
v_cvt_pk_bf16_f32 v82, v148, v149
v_mfma_f32_16x16x32_bf16 a[84:87], v[36:39], v[212:215], a[84:87]
v_cvt_pk_bf16_f32 v83, v150, v151
buffer_store_dwordx4 v[80:83], v243, s[20:23], s42 offen offset:0 sc1
v_accvgpr_read_b32 v156, a28
v_mfma_f32_16x16x32_bf16 a[88:91], v[68:71], v[212:215], a[88:91]
v_accvgpr_read_b32 v157, a29
v_accvgpr_read_b32 v158, a30
v_accvgpr_read_b32 v159, a31
v_mfma_f32_16x16x32_bf16 a[92:95], v[100:103], v[212:215], a[92:95]
ds_read_b64_tr_b16 v[212:213], v15 offset:20480
s_waitcnt lgkmcnt(3)
v_cvt_pk_bf16_f32 v114, v156, v157
v_mfma_f32_16x16x32_bf16 a[80:83], v[8:11], v[216:219], a[80:83]
ds_read_b64_tr_b16 v[214:215], v15 offset:22528
v_cvt_pk_bf16_f32 v115, v158, v159
buffer_store_dwordx4 v[112:115], v243, s[20:23], s43 offen offset:0 sc1
v_mfma_f32_16x16x32_bf16 a[80:83], v[176:179], v[220:223], a[80:83]
v_accvgpr_read_b32 v128, a32
v_accvgpr_read_b32 v129, a33
v_accvgpr_read_b32 v130, a34
v_mfma_f32_16x16x32_bf16 a[84:87], v[40:43], v[216:219], a[84:87]
v_accvgpr_read_b32 v131, a35
v_cvt_pk_bf16_f32 v20, v128, v129
v_cvt_pk_bf16_f32 v21, v130, v131
v_mfma_f32_16x16x32_bf16 a[84:87], v[180:183], v[220:223], a[84:87]
v_accvgpr_read_b32 v136, a36
v_accvgpr_read_b32 v137, a37
v_accvgpr_read_b32 v138, a38
v_mfma_f32_16x16x32_bf16 a[88:91], v[72:75], v[216:219], a[88:91]
v_accvgpr_read_b32 v139, a39
v_cvt_pk_bf16_f32 v52, v136, v137
v_cvt_pk_bf16_f32 v53, v138, v139
v_mfma_f32_16x16x32_bf16 a[88:91], v[184:187], v[220:223], a[88:91]
v_accvgpr_read_b32 v144, a40
v_accvgpr_read_b32 v145, a41
v_accvgpr_read_b32 v146, a42
v_mfma_f32_16x16x32_bf16 a[92:95], v[104:107], v[216:219], a[92:95]
ds_read_b64_tr_b16 v[216:217], v244 offset:20992
ds_read_b64_tr_b16 v[218:219], v244 offset:23040
v_accvgpr_read_b32 v147, a43
v_mfma_f32_16x16x32_bf16 a[92:95], v[188:191], v[220:223], a[92:95]
ds_read_b64_tr_b16 v[220:221], v12 offset:4608
s_waitcnt lgkmcnt(3)
v_cvt_pk_bf16_f32 v84, v144, v145
v_mfma_f32_16x16x32_bf16 a[80:83], v[160:163], v[208:211], a[80:83]
ds_read_b64_tr_b16 v[222:223], v12 offset:6656
v_cvt_pk_bf16_f32 v85, v146, v147
v_accvgpr_read_b32 v152, a44
v_mfma_f32_16x16x32_bf16 a[80:83], v[0:3], v[212:215], a[80:83]
v_accvgpr_read_b32 v153, a45
v_accvgpr_read_b32 v154, a46
v_accvgpr_read_b32 v155, a47
v_mfma_f32_16x16x32_bf16 a[84:87], v[164:167], v[208:211], a[84:87]
v_cvt_pk_bf16_f32 v116, v152, v153
v_cvt_pk_bf16_f32 v117, v154, v155
v_accvgpr_read_b32 v132, a48
v_mfma_f32_16x16x32_bf16 a[84:87], v[32:35], v[212:215], a[84:87]
v_accvgpr_read_b32 v133, a49
v_accvgpr_read_b32 v134, a50
v_accvgpr_read_b32 v135, a51
v_mfma_f32_16x16x32_bf16 a[88:91], v[168:171], v[208:211], a[88:91]
v_cvt_pk_bf16_f32 v22, v132, v133
v_cvt_pk_bf16_f32 v23, v134, v135
buffer_store_dwordx4 v[20:23], v243, s[20:23], s40 offen offset:1024 sc1
v_mfma_f32_16x16x32_bf16 a[88:91], v[64:67], v[212:215], a[88:91]
ds_write_b128 v231, v[20:23] offset:1024
v_accvgpr_read_b32 v140, a52
v_accvgpr_read_b32 v141, a53
v_mfma_f32_16x16x32_bf16 a[92:95], v[172:175], v[208:211], a[92:95]
ds_read_b64_tr_b16 v[208:209], v12 offset:20992
ds_read_b64_tr_b16 v[210:211], v12 offset:23040
v_accvgpr_read_b32 v142, a54
v_mfma_f32_16x16x32_bf16 a[92:95], v[96:99], v[212:215], a[92:95]
ds_read_b64_tr_b16 v[212:213], v14 offset:4608
s_waitcnt lgkmcnt(3)
v_accvgpr_read_b32 v143, a55
v_mfma_f32_16x16x32_bf16 a[96:99], v[4:7], v[216:219], a[96:99]
ds_read_b64_tr_b16 v[214:215], v14 offset:6656
v_cvt_pk_bf16_f32 v54, v140, v141
v_cvt_pk_bf16_f32 v55, v142, v143
v_mfma_f32_16x16x32_bf16 a[96:99], v[8:11], v[220:223], a[96:99]
buffer_store_dwordx4 v[52:55], v243, s[20:23], s41 offen offset:1024 sc1
v_accvgpr_read_b32 v148, a56
v_accvgpr_read_b32 v149, a57
v_mfma_f32_16x16x32_bf16 a[100:103], v[36:39], v[216:219], a[100:103]
v_accvgpr_read_b32 v150, a58
v_accvgpr_read_b32 v151, a59
v_cvt_pk_bf16_f32 v86, v148, v149
v_mfma_f32_16x16x32_bf16 a[100:103], v[40:43], v[220:223], a[100:103]
v_cvt_pk_bf16_f32 v87, v150, v151
buffer_store_dwordx4 v[84:87], v243, s[20:23], s42 offen offset:1024 sc1
v_accvgpr_read_b32 v156, a60
v_mfma_f32_16x16x32_bf16 a[104:107], v[68:71], v[216:219], a[104:107]
v_accvgpr_read_b32 v157, a61
v_accvgpr_read_b32 v158, a62
v_accvgpr_read_b32 v159, a63
v_mfma_f32_16x16x32_bf16 a[104:107], v[72:75], v[220:223], a[104:107]
v_cvt_pk_bf16_f32 v118, v156, v157
v_cvt_pk_bf16_f32 v119, v158, v159
buffer_store_dwordx4 v[116:119], v243, s[20:23], s43 offen offset:1024 sc1
v_mfma_f32_16x16x32_bf16 a[108:111], v[100:103], v[216:219], a[108:111]
ds_read_b64_tr_b16 v[216:217], v14 offset:20992
ds_read_b64_tr_b16 v[218:219], v14 offset:23040
v_accvgpr_read_b32 v128, a64
v_mfma_f32_16x16x32_bf16 a[108:111], v[104:107], v[220:223], a[108:111]
ds_read_b64_tr_b16 v[220:221], v245 offset:20992
s_waitcnt lgkmcnt(3)
v_accvgpr_read_b32 v129, a65
v_mfma_f32_16x16x32_bf16 a[96:99], v[176:179], v[208:211], a[96:99]
ds_read_b64_tr_b16 v[222:223], v245 offset:23040
v_accvgpr_read_b32 v130, a66
v_accvgpr_read_b32 v131, a67
v_mfma_f32_16x16x32_bf16 a[96:99], v[160:163], v[212:215], a[96:99]
v_cvt_pk_bf16_f32 v24, v128, v129
v_cvt_pk_bf16_f32 v25, v130, v131
v_accvgpr_read_b32 v136, a68
v_mfma_f32_16x16x32_bf16 a[100:103], v[180:183], v[208:211], a[100:103]
v_accvgpr_read_b32 v137, a69
v_accvgpr_read_b32 v138, a70
v_accvgpr_read_b32 v139, a71
v_mfma_f32_16x16x32_bf16 a[100:103], v[164:167], v[212:215], a[100:103]
v_cvt_pk_bf16_f32 v56, v136, v137
v_cvt_pk_bf16_f32 v57, v138, v139
v_accvgpr_read_b32 v144, a72
v_mfma_f32_16x16x32_bf16 a[104:107], v[184:187], v[208:211], a[104:107]
v_accvgpr_read_b32 v145, a73
v_accvgpr_read_b32 v146, a74
v_accvgpr_read_b32 v147, a75
v_mfma_f32_16x16x32_bf16 a[104:107], v[168:171], v[212:215], a[104:107]
v_cvt_pk_bf16_f32 v88, v144, v145
v_cvt_pk_bf16_f32 v89, v146, v147
v_accvgpr_read_b32 v152, a76
v_mfma_f32_16x16x32_bf16 a[108:111], v[188:191], v[208:211], a[108:111]
ds_read_b64_tr_b16 v[208:209], v13 offset:4608
ds_read_b64_tr_b16 v[210:211], v13 offset:6656
v_accvgpr_read_b32 v153, a77
v_mfma_f32_16x16x32_bf16 a[108:111], v[172:175], v[212:215], a[108:111]
ds_read_b64_tr_b16 v[212:213], v13 offset:20992
s_waitcnt lgkmcnt(5)
v_accvgpr_read_b32 v154, a78
v_mfma_f32_16x16x32_bf16 a[96:99], v[0:3], v[216:219], a[96:99]
ds_read_b64_tr_b16 v[214:215], v13 offset:23040
v_accvgpr_read_b32 v155, a79
v_cvt_pk_bf16_f32 v120, v152, v153
v_mfma_f32_16x16x32_bf16 a[100:103], v[32:35], v[216:219], a[100:103]
v_cvt_pk_bf16_f32 v121, v154, v155
v_accvgpr_read_b32 v132, a80
v_accvgpr_read_b32 v133, a81
v_mfma_f32_16x16x32_bf16 a[104:107], v[64:67], v[216:219], a[104:107]
v_accvgpr_read_b32 v134, a82
v_accvgpr_read_b32 v135, a83
v_cvt_pk_bf16_f32 v26, v132, v133
v_mfma_f32_16x16x32_bf16 a[108:111], v[96:99], v[216:219], a[108:111]
ds_read_b64_tr_b16 v[216:217], v15 offset:4608
s_waitcnt lgkmcnt(5)
v_cvt_pk_bf16_f32 v27, v134, v135
v_mfma_f32_16x16x32_bf16 a[112:115], v[4:7], v[220:223], a[112:115]
ds_read_b64_tr_b16 v[218:219], v15 offset:6656
buffer_store_dwordx4 v[24:27], v243, s[20:23], s40 offen offset:2048 sc1
ds_write_b128 v231, v[24:27] offset:2048
v_mfma_f32_16x16x32_bf16 a[116:119], v[36:39], v[220:223], a[116:119]
v_accvgpr_read_b32 v140, a84
v_accvgpr_read_b32 v141, a85
v_accvgpr_read_b32 v142, a86
v_mfma_f32_16x16x32_bf16 a[120:123], v[68:71], v[220:223], a[120:123]
v_accvgpr_read_b32 v143, a87
v_cvt_pk_bf16_f32 v58, v140, v141
v_cvt_pk_bf16_f32 v59, v142, v143
v_mfma_f32_16x16x32_bf16 a[124:127], v[100:103], v[220:223], a[124:127]
ds_read_b64_tr_b16 v[220:221], v15 offset:20992
s_waitcnt lgkmcnt(3)
buffer_store_dwordx4 v[56:59], v243, s[20:23], s41 offen offset:2048 sc1
v_mfma_f32_16x16x32_bf16 a[112:115], v[8:11], v[208:211], a[112:115]
ds_read_b64_tr_b16 v[222:223], v15 offset:23040
v_accvgpr_read_b32 v148, a88
v_accvgpr_read_b32 v149, a89
v_mfma_f32_16x16x32_bf16 a[112:115], v[176:179], v[212:215], a[112:115]
v_accvgpr_read_b32 v150, a90
v_accvgpr_read_b32 v151, a91
v_cvt_pk_bf16_f32 v90, v148, v149
v_mfma_f32_16x16x32_bf16 a[116:119], v[40:43], v[208:211], a[116:119]
v_cvt_pk_bf16_f32 v91, v150, v151
buffer_store_dwordx4 v[88:91], v243, s[20:23], s42 offen offset:2048 sc1
v_accvgpr_read_b32 v156, a92
v_mfma_f32_16x16x32_bf16 a[116:119], v[180:183], v[212:215], a[116:119]
v_accvgpr_read_b32 v157, a93
v_accvgpr_read_b32 v158, a94
v_accvgpr_read_b32 v159, a95
v_mfma_f32_16x16x32_bf16 a[120:123], v[72:75], v[208:211], a[120:123]
v_cvt_pk_bf16_f32 v122, v156, v157
v_cvt_pk_bf16_f32 v123, v158, v159
buffer_store_dwordx4 v[120:123], v243, s[20:23], s43 offen offset:2048 sc1
v_mfma_f32_16x16x32_bf16 a[120:123], v[184:187], v[212:215], a[120:123]
v_accvgpr_read_b32 v128, a96
v_accvgpr_read_b32 v129, a97
v_mfma_f32_16x16x32_bf16 a[124:127], v[104:107], v[208:211], a[124:127]
ds_read_b64_tr_b16 v[208:209], v12 offset:8192
ds_read_b64_tr_b16 v[210:211], v12 offset:10240
v_mfma_f32_16x16x32_bf16 a[124:127], v[188:191], v[212:215], a[124:127]
ds_read_b64_tr_b16 v[212:213], v12 offset:24576
s_waitcnt lgkmcnt(3)
v_mfma_f32_16x16x32_bf16 a[112:115], v[160:163], v[216:219], a[112:115]
ds_read_b64_tr_b16 v[214:215], v12 offset:26624
v_accvgpr_read_b32 v130, a98
v_mfma_f32_16x16x32_bf16 a[112:115], v[0:3], v[220:223], a[112:115]
v_accvgpr_read_b32 v131, a99
v_cvt_pk_bf16_f32 v28, v128, v129
v_mfma_f32_16x16x32_bf16 a[116:119], v[164:167], v[216:219], a[116:119]
v_cvt_pk_bf16_f32 v29, v130, v131
v_accvgpr_read_b32 v136, a100
v_mfma_f32_16x16x32_bf16 a[116:119], v[32:35], v[220:223], a[116:119]
v_accvgpr_read_b32 v137, a101
v_accvgpr_read_b32 v138, a102
v_mfma_f32_16x16x32_bf16 a[120:123], v[168:171], v[216:219], a[120:123]
v_accvgpr_read_b32 v139, a103
v_cvt_pk_bf16_f32 v60, v136, v137
v_mfma_f32_16x16x32_bf16 a[120:123], v[64:67], v[220:223], a[120:123]
v_cvt_pk_bf16_f32 v61, v138, v139
v_accvgpr_read_b32 v144, a104
v_mfma_f32_16x16x32_bf16 a[124:127], v[172:175], v[216:219], a[124:127]
ds_read_b64_tr_b16 v[216:217], v14 offset:8192
ds_read_b64_tr_b16 v[218:219], v14 offset:10240
v_mfma_f32_16x16x32_bf16 a[124:127], v[96:99], v[220:223], a[124:127]
ds_read_b64_tr_b16 v[220:221], v14 offset:24576
s_waitcnt lgkmcnt(3)
v_mfma_f32_16x16x32_bf16 a[128:131], v[8:11], v[208:211], a[128:131]
ds_read_b64_tr_b16 v[222:223], v14 offset:26624
v_accvgpr_read_b32 v145, a105
v_mfma_f32_16x16x32_bf16 a[128:131], v[176:179], v[212:215], a[128:131]
v_accvgpr_read_b32 v146, a106
v_accvgpr_read_b32 v147, a107
v_mfma_f32_16x16x32_bf16 a[132:135], v[40:43], v[208:211], a[132:135]
v_cvt_pk_bf16_f32 v92, v144, v145
v_cvt_pk_bf16_f32 v93, v146, v147
v_mfma_f32_16x16x32_bf16 a[132:135], v[180:183], v[212:215], a[132:135]
v_accvgpr_read_b32 v152, a108
v_accvgpr_read_b32 v153, a109
v_mfma_f32_16x16x32_bf16 a[136:139], v[72:75], v[208:211], a[136:139]
v_accvgpr_read_b32 v154, a110
v_accvgpr_read_b32 v155, a111
v_mfma_f32_16x16x32_bf16 a[136:139], v[184:187], v[212:215], a[136:139]
v_cvt_pk_bf16_f32 v124, v152, v153
v_cvt_pk_bf16_f32 v125, v154, v155
v_mfma_f32_16x16x32_bf16 a[140:143], v[104:107], v[208:211], a[140:143]
ds_read_b64_tr_b16 v[208:209], v13 offset:8192
ds_read_b64_tr_b16 v[210:211], v13 offset:10240
v_mfma_f32_16x16x32_bf16 a[140:143], v[188:191], v[212:215], a[140:143]
ds_read_b64_tr_b16 v[212:213], v13 offset:24576
s_waitcnt lgkmcnt(3)
v_mfma_f32_16x16x32_bf16 a[128:131], v[160:163], v[216:219], a[128:131]
ds_read_b64_tr_b16 v[214:215], v13 offset:26624
v_accvgpr_read_b32 v132, a112
v_mfma_f32_16x16x32_bf16 a[128:131], v[0:3], v[220:223], a[128:131]
v_accvgpr_read_b32 v133, a113
v_accvgpr_read_b32 v134, a114
v_mfma_f32_16x16x32_bf16 a[132:135], v[164:167], v[216:219], a[132:135]
v_accvgpr_read_b32 v135, a115
v_cvt_pk_bf16_f32 v30, v132, v133
v_mfma_f32_16x16x32_bf16 a[132:135], v[32:35], v[220:223], a[132:135]
v_cvt_pk_bf16_f32 v31, v134, v135
buffer_store_dwordx4 v[28:31], v243, s[20:23], s40 offen offset:3072 sc1
v_mfma_f32_16x16x32_bf16 a[136:139], v[168:171], v[216:219], a[136:139]
ds_write_b128 v231, v[28:31] offset:3072
v_accvgpr_read_b32 v140, a116
v_mfma_f32_16x16x32_bf16 a[136:139], v[64:67], v[220:223], a[136:139]
v_accvgpr_read_b32 v141, a117
v_accvgpr_read_b32 v142, a118
v_mfma_f32_16x16x32_bf16 a[140:143], v[172:175], v[216:219], a[140:143]
ds_read_b64_tr_b16 v[216:217], v15 offset:8192
ds_read_b64_tr_b16 v[218:219], v15 offset:10240
v_mfma_f32_16x16x32_bf16 a[140:143], v[96:99], v[220:223], a[140:143]
ds_read_b64_tr_b16 v[220:221], v15 offset:24576
s_waitcnt lgkmcnt(3)
v_mfma_f32_16x16x32_bf16 a[144:147], v[8:11], v[208:211], a[144:147]
ds_read_b64_tr_b16 v[222:223], v15 offset:26624
v_accvgpr_read_b32 v143, a119
v_mfma_f32_16x16x32_bf16 a[144:147], v[176:179], v[212:215], a[144:147]
v_cvt_pk_bf16_f32 v62, v140, v141
v_cvt_pk_bf16_f32 v63, v142, v143
v_mfma_f32_16x16x32_bf16 a[148:151], v[40:43], v[208:211], a[148:151]
buffer_store_dwordx4 v[60:63], v243, s[20:23], s41 offen offset:3072 sc1
v_accvgpr_read_b32 v148, a120
v_mfma_f32_16x16x32_bf16 a[148:151], v[180:183], v[212:215], a[148:151]
v_accvgpr_read_b32 v149, a121
v_accvgpr_read_b32 v150, a122
v_mfma_f32_16x16x32_bf16 a[152:155], v[72:75], v[208:211], a[152:155]
v_accvgpr_read_b32 v151, a123
v_cvt_pk_bf16_f32 v94, v148, v149
v_mfma_f32_16x16x32_bf16 a[152:155], v[184:187], v[212:215], a[152:155]
v_cvt_pk_bf16_f32 v95, v150, v151
buffer_store_dwordx4 v[92:95], v243, s[20:23], s42 offen offset:3072 sc1
v_mfma_f32_16x16x32_bf16 a[156:159], v[104:107], v[208:211], a[156:159]
ds_read_b64_tr_b16 v[208:209], v12 offset:8704
ds_read_b64_tr_b16 v[210:211], v12 offset:10752
v_mfma_f32_16x16x32_bf16 a[156:159], v[188:191], v[212:215], a[156:159]
ds_read_b64_tr_b16 v[212:213], v12 offset:25088
s_waitcnt lgkmcnt(3)
v_mfma_f32_16x16x32_bf16 a[144:147], v[160:163], v[216:219], a[144:147]
ds_read_b64_tr_b16 v[214:215], v12 offset:27136
v_accvgpr_read_b32 v156, a124
v_mfma_f32_16x16x32_bf16 a[144:147], v[0:3], v[220:223], a[144:147]
v_accvgpr_read_b32 v157, a125
v_accvgpr_read_b32 v158, a126
v_mfma_f32_16x16x32_bf16 a[148:151], v[164:167], v[216:219], a[148:151]
v_accvgpr_read_b32 v159, a127
v_cvt_pk_bf16_f32 v126, v156, v157
v_mfma_f32_16x16x32_bf16 a[148:151], v[32:35], v[220:223], a[148:151]
v_cvt_pk_bf16_f32 v127, v158, v159
buffer_store_dwordx4 v[124:127], v243, s[20:23], s43 offen offset:3072 sc1
v_mfma_f32_16x16x32_bf16 a[152:155], v[168:171], v[216:219], a[152:155]
v_accvgpr_read_b32 v128, a128
v_accvgpr_read_b32 v129, a129
v_mfma_f32_16x16x32_bf16 a[152:155], v[64:67], v[220:223], a[152:155]
v_accvgpr_read_b32 v130, a130
v_accvgpr_read_b32 v131, a131
v_mfma_f32_16x16x32_bf16 a[156:159], v[172:175], v[216:219], a[156:159]
ds_read_b64_tr_b16 v[216:217], v14 offset:8704
ds_read_b64_tr_b16 v[218:219], v14 offset:10752
v_mfma_f32_16x16x32_bf16 a[156:159], v[96:99], v[220:223], a[156:159]
ds_read_b64_tr_b16 v[220:221], v14 offset:25088
s_waitcnt lgkmcnt(3)
v_mfma_f32_16x16x32_bf16 a[160:163], v[8:11], v[208:211], a[160:163]
ds_read_b64_tr_b16 v[222:223], v14 offset:27136
v_cvt_pk_bf16_f32 v16, v128, v129
v_mfma_f32_16x16x32_bf16 a[160:163], v[176:179], v[212:215], a[160:163]
v_cvt_pk_bf16_f32 v17, v130, v131
v_accvgpr_read_b32 v136, a132
v_mfma_f32_16x16x32_bf16 a[164:167], v[40:43], v[208:211], a[164:167]
v_accvgpr_read_b32 v137, a133
v_accvgpr_read_b32 v138, a134
v_mfma_f32_16x16x32_bf16 a[164:167], v[180:183], v[212:215], a[164:167]
v_accvgpr_read_b32 v139, a135
v_cvt_pk_bf16_f32 v48, v136, v137
v_mfma_f32_16x16x32_bf16 a[168:171], v[72:75], v[208:211], a[168:171]
v_cvt_pk_bf16_f32 v49, v138, v139
v_accvgpr_read_b32 v144, a136
v_mfma_f32_16x16x32_bf16 a[168:171], v[184:187], v[212:215], a[168:171]
v_accvgpr_read_b32 v145, a137
v_accvgpr_read_b32 v146, a138
v_mfma_f32_16x16x32_bf16 a[172:175], v[104:107], v[208:211], a[172:175]
ds_read_b64_tr_b16 v[208:209], v13 offset:8704
ds_read_b64_tr_b16 v[210:211], v13 offset:10752
v_mfma_f32_16x16x32_bf16 a[172:175], v[188:191], v[212:215], a[172:175]
ds_read_b64_tr_b16 v[212:213], v13 offset:25088
s_waitcnt lgkmcnt(3)
v_mfma_f32_16x16x32_bf16 a[160:163], v[160:163], v[216:219], a[160:163]
ds_read_b64_tr_b16 v[214:215], v13 offset:27136
v_accvgpr_read_b32 v147, a139
v_mfma_f32_16x16x32_bf16 a[160:163], v[0:3], v[220:223], a[160:163]
v_cvt_pk_bf16_f32 v80, v144, v145
v_cvt_pk_bf16_f32 v81, v146, v147
v_mfma_f32_16x16x32_bf16 a[164:167], v[164:167], v[216:219], a[164:167]
v_accvgpr_read_b32 v152, a140
v_accvgpr_read_b32 v153, a141
v_mfma_f32_16x16x32_bf16 a[164:167], v[32:35], v[220:223], a[164:167]
v_accvgpr_read_b32 v154, a142
v_accvgpr_read_b32 v155, a143
v_mfma_f32_16x16x32_bf16 a[168:171], v[168:171], v[216:219], a[168:171]
v_cvt_pk_bf16_f32 v112, v152, v153
v_cvt_pk_bf16_f32 v113, v154, v155
v_mfma_f32_16x16x32_bf16 a[168:171], v[64:67], v[220:223], a[168:171]
v_accvgpr_read_b32 v132, a144
v_accvgpr_read_b32 v133, a145
v_mfma_f32_16x16x32_bf16 a[172:175], v[172:175], v[216:219], a[172:175]
ds_read_b64_tr_b16 v[216:217], v15 offset:8704
ds_read_b64_tr_b16 v[218:219], v15 offset:10752
v_mfma_f32_16x16x32_bf16 a[172:175], v[96:99], v[220:223], a[172:175]
ds_read_b64_tr_b16 v[220:221], v15 offset:25088
s_waitcnt lgkmcnt(3)
v_mfma_f32_16x16x32_bf16 a[176:179], v[8:11], v[208:211], a[176:179]
ds_read_b64_tr_b16 v[222:223], v15 offset:27136
v_accvgpr_read_b32 v134, a146
v_mfma_f32_16x16x32_bf16 a[176:179], v[176:179], v[212:215], a[176:179]
v_accvgpr_read_b32 v135, a147
v_cvt_pk_bf16_f32 v18, v132, v133
v_mfma_f32_16x16x32_bf16 a[180:183], v[40:43], v[208:211], a[180:183]
v_cvt_pk_bf16_f32 v19, v134, v135
buffer_store_dwordx4 v[16:19], v243, s[20:23], s44 offen offset:0 sc1
v_mfma_f32_16x16x32_bf16 a[180:183], v[180:183], v[212:215], a[180:183]
ds_write_b128 v231, v[16:19] offset:4096
v_accvgpr_read_b32 v140, a148
v_mfma_f32_16x16x32_bf16 a[184:187], v[72:75], v[208:211], a[184:187]
v_accvgpr_read_b32 v141, a149
v_accvgpr_read_b32 v142, a150
v_mfma_f32_16x16x32_bf16 a[184:187], v[184:187], v[212:215], a[184:187]
v_accvgpr_read_b32 v143, a151
v_cvt_pk_bf16_f32 v50, v140, v141
v_mfma_f32_16x16x32_bf16 a[188:191], v[104:107], v[208:211], a[188:191]
ds_read_b64_tr_b16 v[208:209], v12 offset:12288
ds_read_b64_tr_b16 v[210:211], v12 offset:14336
v_mfma_f32_16x16x32_bf16 a[188:191], v[188:191], v[212:215], a[188:191]
ds_read_b64_tr_b16 v[212:213], v12 offset:28672
s_waitcnt lgkmcnt(3)
v_mfma_f32_16x16x32_bf16 a[176:179], v[160:163], v[216:219], a[176:179]
ds_read_b64_tr_b16 v[214:215], v12 offset:30720
v_cvt_pk_bf16_f32 v51, v142, v143
v_mfma_f32_16x16x32_bf16 a[176:179], v[0:3], v[220:223], a[176:179]
buffer_store_dwordx4 v[48:51], v243, s[20:23], s45 offen offset:0 sc1
v_accvgpr_read_b32 v148, a152
v_mfma_f32_16x16x32_bf16 a[180:183], v[164:167], v[216:219], a[180:183]
v_accvgpr_read_b32 v149, a153
v_accvgpr_read_b32 v150, a154
v_mfma_f32_16x16x32_bf16 a[180:183], v[32:35], v[220:223], a[180:183]
v_accvgpr_read_b32 v151, a155
v_cvt_pk_bf16_f32 v82, v148, v149
v_mfma_f32_16x16x32_bf16 a[184:187], v[168:171], v[216:219], a[184:187]
v_cvt_pk_bf16_f32 v83, v150, v151
buffer_store_dwordx4 v[80:83], v243, s[20:23], s46 offen offset:0 sc1
v_mfma_f32_16x16x32_bf16 a[184:187], v[64:67], v[220:223], a[184:187]
v_accvgpr_read_b32 v156, a156
v_accvgpr_read_b32 v157, a157
v_mfma_f32_16x16x32_bf16 a[188:191], v[172:175], v[216:219], a[188:191]
ds_read_b64_tr_b16 v[216:217], v14 offset:12288
ds_read_b64_tr_b16 v[218:219], v14 offset:14336
v_mfma_f32_16x16x32_bf16 a[188:191], v[96:99], v[220:223], a[188:191]
ds_read_b64_tr_b16 v[220:221], v14 offset:28672
s_waitcnt lgkmcnt(3)
v_mfma_f32_16x16x32_bf16 a[192:195], v[8:11], v[208:211], a[192:195]
ds_read_b64_tr_b16 v[222:223], v14 offset:30720
v_accvgpr_read_b32 v158, a158
v_mfma_f32_16x16x32_bf16 a[192:195], v[176:179], v[212:215], a[192:195]
v_accvgpr_read_b32 v159, a159
v_cvt_pk_bf16_f32 v114, v156, v157
v_mfma_f32_16x16x32_bf16 a[196:199], v[40:43], v[208:211], a[196:199]
v_cvt_pk_bf16_f32 v115, v158, v159
buffer_store_dwordx4 v[112:115], v243, s[20:23], s47 offen offset:0 sc1
v_mfma_f32_16x16x32_bf16 a[196:199], v[180:183], v[212:215], a[196:199]
v_accvgpr_read_b32 v128, a160
v_accvgpr_read_b32 v129, a161
v_mfma_f32_16x16x32_bf16 a[200:203], v[72:75], v[208:211], a[200:203]
v_accvgpr_read_b32 v130, a162
v_accvgpr_read_b32 v131, a163
v_mfma_f32_16x16x32_bf16 a[200:203], v[184:187], v[212:215], a[200:203]
v_cvt_pk_bf16_f32 v20, v128, v129
v_cvt_pk_bf16_f32 v21, v130, v131
v_mfma_f32_16x16x32_bf16 a[204:207], v[104:107], v[208:211], a[204:207]
ds_read_b64_tr_b16 v[208:209], v13 offset:12288
ds_read_b64_tr_b16 v[210:211], v13 offset:14336
v_mfma_f32_16x16x32_bf16 a[204:207], v[188:191], v[212:215], a[204:207]
ds_read_b64_tr_b16 v[212:213], v13 offset:28672
s_waitcnt lgkmcnt(3)
v_mfma_f32_16x16x32_bf16 a[192:195], v[160:163], v[216:219], a[192:195]
ds_read_b64_tr_b16 v[214:215], v13 offset:30720
v_accvgpr_read_b32 v136, a164
v_mfma_f32_16x16x32_bf16 a[192:195], v[0:3], v[220:223], a[192:195]
v_accvgpr_read_b32 v137, a165
v_accvgpr_read_b32 v138, a166
v_mfma_f32_16x16x32_bf16 a[196:199], v[164:167], v[216:219], a[196:199]
v_accvgpr_read_b32 v139, a167
v_cvt_pk_bf16_f32 v52, v136, v137
v_mfma_f32_16x16x32_bf16 a[196:199], v[32:35], v[220:223], a[196:199]
v_cvt_pk_bf16_f32 v53, v138, v139
v_accvgpr_read_b32 v144, a168
v_mfma_f32_16x16x32_bf16 a[200:203], v[168:171], v[216:219], a[200:203]
v_accvgpr_read_b32 v145, a169
v_accvgpr_read_b32 v146, a170
v_mfma_f32_16x16x32_bf16 a[200:203], v[64:67], v[220:223], a[200:203]
v_accvgpr_read_b32 v147, a171
v_cvt_pk_bf16_f32 v84, v144, v145
v_mfma_f32_16x16x32_bf16 a[204:207], v[172:175], v[216:219], a[204:207]
ds_read_b64_tr_b16 v[216:217], v15 offset:12288
ds_read_b64_tr_b16 v[218:219], v15 offset:14336
v_mfma_f32_16x16x32_bf16 a[204:207], v[96:99], v[220:223], a[204:207]
ds_read_b64_tr_b16 v[220:221], v15 offset:28672
s_waitcnt lgkmcnt(3)
v_mfma_f32_16x16x32_bf16 a[208:211], v[8:11], v[208:211], a[208:211]
ds_read_b64_tr_b16 v[222:223], v15 offset:30720
v_cvt_pk_bf16_f32 v85, v146, v147
v_mfma_f32_16x16x32_bf16 a[208:211], v[176:179], v[212:215], a[208:211]
v_accvgpr_read_b32 v152, a172
v_accvgpr_read_b32 v153, a173
v_mfma_f32_16x16x32_bf16 a[212:215], v[40:43], v[208:211], a[212:215]
v_accvgpr_read_b32 v154, a174
v_accvgpr_read_b32 v155, a175
v_mfma_f32_16x16x32_bf16 a[212:215], v[180:183], v[212:215], a[212:215]
v_cvt_pk_bf16_f32 v116, v152, v153
v_cvt_pk_bf16_f32 v117, v154, v155
v_mfma_f32_16x16x32_bf16 a[216:219], v[72:75], v[208:211], a[216:219]
v_accvgpr_read_b32 v132, a176
v_accvgpr_read_b32 v133, a177
v_mfma_f32_16x16x32_bf16 a[216:219], v[184:187], v[212:215], a[216:219]
v_accvgpr_read_b32 v134, a178
v_accvgpr_read_b32 v135, a179
v_mfma_f32_16x16x32_bf16 a[220:223], v[104:107], v[208:211], a[220:223]
ds_read_b64_tr_b16 v[208:209], v12 offset:12800
ds_read_b64_tr_b16 v[210:211], v12 offset:14848
v_mfma_f32_16x16x32_bf16 a[220:223], v[188:191], v[212:215], a[220:223]
ds_read_b64_tr_b16 v[212:213], v12 offset:29184
s_waitcnt lgkmcnt(3)
v_mfma_f32_16x16x32_bf16 a[208:211], v[160:163], v[216:219], a[208:211]
ds_read_b64_tr_b16 v[214:215], v12 offset:31232
v_cvt_pk_bf16_f32 v22, v132, v133
v_mfma_f32_16x16x32_bf16 a[208:211], v[0:3], v[220:223], a[208:211]
v_cvt_pk_bf16_f32 v23, v134, v135
buffer_store_dwordx4 v[20:23], v243, s[20:23], s44 offen offset:1024 sc1
v_mfma_f32_16x16x32_bf16 a[212:215], v[164:167], v[216:219], a[212:215]
ds_write_b128 v231, v[20:23] offset:5120
v_accvgpr_read_b32 v140, a180
v_mfma_f32_16x16x32_bf16 a[212:215], v[32:35], v[220:223], a[212:215]
v_accvgpr_read_b32 v141, a181
v_accvgpr_read_b32 v142, a182
v_mfma_f32_16x16x32_bf16 a[216:219], v[168:171], v[216:219], a[216:219]
v_accvgpr_read_b32 v143, a183
v_cvt_pk_bf16_f32 v54, v140, v141
v_mfma_f32_16x16x32_bf16 a[216:219], v[64:67], v[220:223], a[216:219]
v_cvt_pk_bf16_f32 v55, v142, v143
buffer_store_dwordx4 v[52:55], v243, s[20:23], s45 offen offset:1024 sc1
v_mfma_f32_16x16x32_bf16 a[220:223], v[172:175], v[216:219], a[220:223]
ds_read_b64_tr_b16 v[216:217], v14 offset:12800
ds_read_b64_tr_b16 v[218:219], v14 offset:14848
v_mfma_f32_16x16x32_bf16 a[220:223], v[96:99], v[220:223], a[220:223]
ds_read_b64_tr_b16 v[220:221], v14 offset:29184
s_waitcnt lgkmcnt(3)
v_mfma_f32_16x16x32_bf16 a[224:227], v[8:11], v[208:211], a[224:227]
ds_read_b64_tr_b16 v[222:223], v14 offset:31232
v_accvgpr_read_b32 v148, a184
v_mfma_f32_16x16x32_bf16 a[224:227], v[176:179], v[212:215], a[224:227]
v_accvgpr_read_b32 v149, a185
v_accvgpr_read_b32 v150, a186
v_mfma_f32_16x16x32_bf16 a[228:231], v[40:43], v[208:211], a[228:231]
v_accvgpr_read_b32 v151, a187
v_cvt_pk_bf16_f32 v86, v148, v149
v_mfma_f32_16x16x32_bf16 a[228:231], v[180:183], v[212:215], a[228:231]
v_cvt_pk_bf16_f32 v87, v150, v151
buffer_store_dwordx4 v[84:87], v243, s[20:23], s46 offen offset:1024 sc1
v_mfma_f32_16x16x32_bf16 a[232:235], v[72:75], v[208:211], a[232:235]
v_accvgpr_read_b32 v156, a188
v_accvgpr_read_b32 v157, a189
v_mfma_f32_16x16x32_bf16 a[232:235], v[184:187], v[212:215], a[232:235]
v_accvgpr_read_b32 v158, a190
v_accvgpr_read_b32 v159, a191
v_mfma_f32_16x16x32_bf16 a[236:239], v[104:107], v[208:211], a[236:239]
ds_read_b64_tr_b16 v[208:209], v13 offset:12800
ds_read_b64_tr_b16 v[210:211], v13 offset:14848
v_mfma_f32_16x16x32_bf16 a[236:239], v[188:191], v[212:215], a[236:239]
ds_read_b64_tr_b16 v[212:213], v13 offset:29184
s_waitcnt lgkmcnt(3)
v_mfma_f32_16x16x32_bf16 a[224:227], v[160:163], v[216:219], a[224:227]
ds_read_b64_tr_b16 v[214:215], v13 offset:31232
v_cvt_pk_bf16_f32 v118, v156, v157
v_mfma_f32_16x16x32_bf16 a[224:227], v[0:3], v[220:223], a[224:227]
v_cvt_pk_bf16_f32 v119, v158, v159
buffer_store_dwordx4 v[116:119], v243, s[20:23], s47 offen offset:1024 sc1
v_mfma_f32_16x16x32_bf16 a[228:231], v[164:167], v[216:219], a[228:231]
v_accvgpr_read_b32 v128, a192
v_accvgpr_read_b32 v129, a193
v_mfma_f32_16x16x32_bf16 a[228:231], v[32:35], v[220:223], a[228:231]
v_accvgpr_read_b32 v130, a194
v_accvgpr_read_b32 v131, a195
v_mfma_f32_16x16x32_bf16 a[232:235], v[168:171], v[216:219], a[232:235]
v_cvt_pk_bf16_f32 v24, v128, v129
v_cvt_pk_bf16_f32 v25, v130, v131
v_mfma_f32_16x16x32_bf16 a[232:235], v[64:67], v[220:223], a[232:235]
v_accvgpr_read_b32 v136, a196
v_accvgpr_read_b32 v137, a197
v_mfma_f32_16x16x32_bf16 a[236:239], v[172:175], v[216:219], a[236:239]
ds_read_b64_tr_b16 v[216:217], v15 offset:12800
ds_read_b64_tr_b16 v[218:219], v15 offset:14848
v_mfma_f32_16x16x32_bf16 a[236:239], v[96:99], v[220:223], a[236:239]
ds_read_b64_tr_b16 v[220:221], v15 offset:29184
s_waitcnt lgkmcnt(3)
v_mfma_f32_16x16x32_bf16 a[240:243], v[8:11], v[208:211], a[240:243]
ds_read_b64_tr_b16 v[222:223], v15 offset:31232
v_accvgpr_read_b32 v138, a198
v_mfma_f32_16x16x32_bf16 a[240:243], v[176:179], v[212:215], a[240:243]
v_accvgpr_read_b32 v139, a199
v_cvt_pk_bf16_f32 v56, v136, v137
v_mfma_f32_16x16x32_bf16 a[244:247], v[40:43], v[208:211], a[244:247]
v_cvt_pk_bf16_f32 v57, v138, v139
v_accvgpr_read_b32 v144, a200
v_mfma_f32_16x16x32_bf16 a[244:247], v[180:183], v[212:215], a[244:247]
v_accvgpr_read_b32 v145, a201
v_accvgpr_read_b32 v146, a202
v_mfma_f32_16x16x32_bf16 a[248:251], v[72:75], v[208:211], a[248:251]
v_accvgpr_read_b32 v147, a203
v_cvt_pk_bf16_f32 v88, v144, v145
v_mfma_f32_16x16x32_bf16 a[248:251], v[184:187], v[212:215], a[248:251]
v_cvt_pk_bf16_f32 v89, v146, v147
v_accvgpr_read_b32 v152, a204
v_mfma_f32_16x16x32_bf16 a[252:255], v[104:107], v[208:211], a[252:255]
v_accvgpr_read_b32 v153, a205
v_accvgpr_read_b32 v154, a206
v_mfma_f32_16x16x32_bf16 a[252:255], v[188:191], v[212:215], a[252:255]
s_waitcnt lgkmcnt(0)
v_accvgpr_read_b32 v155, a207
v_mfma_f32_16x16x32_bf16 a[240:243], v[160:163], v[216:219], a[240:243]
v_cvt_pk_bf16_f32 v120, v152, v153
v_cvt_pk_bf16_f32 v121, v154, v155
v_mfma_f32_16x16x32_bf16 a[240:243], v[0:3], v[220:223], a[240:243]
v_accvgpr_read_b32 v132, a208
v_accvgpr_read_b32 v133, a209
v_mfma_f32_16x16x32_bf16 a[244:247], v[164:167], v[216:219], a[244:247]
v_accvgpr_read_b32 v134, a210
v_accvgpr_read_b32 v135, a211
v_mfma_f32_16x16x32_bf16 a[244:247], v[32:35], v[220:223], a[244:247]
v_cvt_pk_bf16_f32 v26, v132, v133
v_cvt_pk_bf16_f32 v27, v134, v135
v_mfma_f32_16x16x32_bf16 a[248:251], v[168:171], v[216:219], a[248:251]
buffer_store_dwordx4 v[24:27], v243, s[20:23], s44 offen offset:2048 sc1
ds_write_b128 v231, v[24:27] offset:6144
v_mfma_f32_16x16x32_bf16 a[248:251], v[64:67], v[220:223], a[248:251]
v_accvgpr_read_b32 v140, a212
v_accvgpr_read_b32 v141, a213
v_mfma_f32_16x16x32_bf16 a[252:255], v[172:175], v[216:219], a[252:255]
v_accvgpr_read_b32 v142, a214
v_accvgpr_read_b32 v143, a215
v_mfma_f32_16x16x32_bf16 a[252:255], v[96:99], v[220:223], a[252:255]
v_cvt_pk_bf16_f32 v58, v140, v141
v_cvt_pk_bf16_f32 v59, v142, v143
buffer_store_dwordx4 v[56:59], v243, s[20:23], s45 offen offset:2048 sc1
v_accvgpr_read_b32 v148, a216
v_accvgpr_read_b32 v149, a217
v_accvgpr_read_b32 v150, a218
v_accvgpr_read_b32 v151, a219
v_cvt_pk_bf16_f32 v90, v148, v149
v_cvt_pk_bf16_f32 v91, v150, v151
buffer_store_dwordx4 v[88:91], v243, s[20:23], s46 offen offset:2048 sc1
v_accvgpr_read_b32 v156, a220
v_accvgpr_read_b32 v157, a221
v_accvgpr_read_b32 v158, a222
v_accvgpr_read_b32 v159, a223
v_cvt_pk_bf16_f32 v122, v156, v157
v_cvt_pk_bf16_f32 v123, v158, v159
buffer_store_dwordx4 v[120:123], v243, s[20:23], s47 offen offset:2048 sc1
v_accvgpr_read_b32 v128, a224
v_accvgpr_read_b32 v129, a225
v_accvgpr_read_b32 v130, a226
v_accvgpr_read_b32 v131, a227
v_cvt_pk_bf16_f32 v28, v128, v129
v_cvt_pk_bf16_f32 v29, v130, v131
v_accvgpr_read_b32 v136, a228
v_accvgpr_read_b32 v137, a229
v_accvgpr_read_b32 v138, a230
v_accvgpr_read_b32 v139, a231
v_cvt_pk_bf16_f32 v60, v136, v137
v_cvt_pk_bf16_f32 v61, v138, v139
v_accvgpr_read_b32 v144, a232
v_accvgpr_read_b32 v145, a233
v_accvgpr_read_b32 v146, a234
v_accvgpr_read_b32 v147, a235
v_cvt_pk_bf16_f32 v92, v144, v145
v_cvt_pk_bf16_f32 v93, v146, v147
v_accvgpr_read_b32 v152, a236
v_accvgpr_read_b32 v153, a237
v_accvgpr_read_b32 v154, a238
v_accvgpr_read_b32 v155, a239
v_cvt_pk_bf16_f32 v124, v152, v153
v_cvt_pk_bf16_f32 v125, v154, v155
v_accvgpr_read_b32 v132, a240
v_accvgpr_read_b32 v133, a241
v_accvgpr_read_b32 v134, a242
v_accvgpr_read_b32 v135, a243
v_cvt_pk_bf16_f32 v30, v132, v133
v_cvt_pk_bf16_f32 v31, v134, v135
buffer_store_dwordx4 v[28:31], v243, s[20:23], s44 offen offset:3072 sc1
ds_write_b128 v231, v[28:31] offset:7168
v_accvgpr_read_b32 v140, a244
v_accvgpr_read_b32 v141, a245
v_accvgpr_read_b32 v142, a246
v_accvgpr_read_b32 v143, a247
v_cvt_pk_bf16_f32 v62, v140, v141
v_cvt_pk_bf16_f32 v63, v142, v143
buffer_store_dwordx4 v[60:63], v243, s[20:23], s45 offen offset:3072 sc1
v_accvgpr_read_b32 v148, a248
v_accvgpr_read_b32 v149, a249
v_accvgpr_read_b32 v150, a250
v_accvgpr_read_b32 v151, a251
v_cvt_pk_bf16_f32 v94, v148, v149
v_cvt_pk_bf16_f32 v95, v150, v151
buffer_store_dwordx4 v[92:95], v243, s[20:23], s46 offen offset:3072 sc1
v_accvgpr_read_b32 v156, a252
v_accvgpr_read_b32 v157, a253
v_accvgpr_read_b32 v158, a254
v_accvgpr_read_b32 v159, a255
v_cvt_pk_bf16_f32 v126, v156, v157
v_cvt_pk_bf16_f32 v127, v158, v159
buffer_store_dwordx4 v[124:127], v243, s[20:23], s47 offen offset:3072 sc1
s_waitcnt vmcnt(36)
s_branch L2_F
L2_tail_1:
s_waitcnt lgkmcnt(2)
v_add_u32 v231, s50, v243
v_mfma_f32_16x16x32_bf16 v[144:147], v[208:211], v[0:3], v[192:195]
s_mov_b32 m0, s30
ds_write_b128 v231, v[160:163] offset:0
v_mfma_f32_16x16x32_bf16 v[144:147], v[212:215], v[4:7], v[144:147]
buffer_load_dwordx4 v241, s[12:15], s28 offen offset:0 sc1 lds
ds_write_b128 v231, v[164:167] offset:1024
v_mfma_f32_16x16x32_bf16 v[148:151], v[208:211], v[32:35], v[196:199]
buffer_load_dwordx4 v241, s[12:15], s28 offen offset:1024 sc1 lds
ds_write_b128 v231, v[168:171] offset:2048
v_mfma_f32_16x16x32_bf16 v[148:151], v[212:215], v[36:39], v[148:151]
buffer_load_dwordx4 v241, s[12:15], s28 offen offset:2048 sc1 lds
ds_write_b128 v231, v[172:175] offset:3072
v_mfma_f32_16x16x32_bf16 v[152:155], v[208:211], v[64:67], v[200:203]
buffer_load_dwordx4 v241, s[12:15], s28 offen offset:3072 sc1 lds
v_add_u32 v230, 0x8000, v240
v_and_b32 v230, 0x1ffff, v230
v_mfma_f32_16x16x32_bf16 v[152:155], v[212:215], v[68:71], v[152:155]
v_exp_f32 v232, v128
v_mfma_f32_16x16x32_bf16 v[156:159], v[208:211], v[96:99], v[204:207]
ds_read_b128 v[208:211], v240 offset:10240
v_exp_f32 v233, v129
v_mfma_f32_16x16x32_bf16 v[156:159], v[212:215], v[100:103], v[156:159]
ds_read_b128 v[212:215], v240 offset:10752
s_waitcnt lgkmcnt(2)
s_and_b32 s30, s30, 0x1c000
v_mfma_f32_16x16x32_bf16 v[144:147], v[216:219], v[8:11], v[144:147]
v_exp_f32 v234, v130
v_add_f32 v224, v224, v232
v_mfma_f32_16x16x32_bf16 v[144:147], v[220:223], v[12:15], v[144:147]
v_cvt_pk_bf16_f32 v160, v232, v233
v_exp_f32 v235, v131
v_mfma_f32_16x16x32_bf16 v[148:151], v[216:219], v[40:43], v[148:151]
v_add_f32 v224, v224, v233
v_add_f32 v224, v224, v234
v_add_f32 v224, v224, v235
v_mfma_f32_16x16x32_bf16 v[148:151], v[220:223], v[44:47], v[148:151]
v_cvt_pk_bf16_f32 v161, v234, v235
v_exp_f32 v236, v132
v_mfma_f32_16x16x32_bf16 v[152:155], v[216:219], v[72:75], v[152:155]
v_exp_f32 v237, v133
s_add_u32 s28, s30, 0x4000
v_mfma_f32_16x16x32_bf16 v[152:155], v[220:223], v[76:79], v[152:155]
v_exp_f32 v238, v134
v_add_f32 v225, v225, v236
v_mfma_f32_16x16x32_bf16 v[156:159], v[216:219], v[104:107], v[156:159]
ds_read_b128 v[216:219], v240 offset:14336
v_cvt_pk_bf16_f32 v164, v236, v237
s_and_b32 s28, s28, 0x1ffff
v_mfma_f32_16x16x32_bf16 v[156:159], v[220:223], v[108:111], v[156:159]
ds_read_b128 v[220:223], v240 offset:14848
s_waitcnt lgkmcnt(2)
s_add_u32 s30, s30, 0x8000
v_mfma_f32_16x16x32_bf16 v[144:147], v[208:211], v[16:19], v[144:147]
v_exp_f32 v239, v135
v_add_f32 v225, v225, v237
v_mfma_f32_16x16x32_bf16 v[144:147], v[212:215], v[20:23], v[144:147]
s_waitcnt vmcnt(4)
s_barrier
v_add_f32 v225, v225, v238
v_mfma_f32_16x16x32_bf16 v[148:151], v[208:211], v[48:51], v[148:151]
v_add_f32 v225, v225, v239
v_cvt_pk_bf16_f32 v165, v238, v239
s_and_b32 s30, s30, 0x1ffff
v_mfma_f32_16x16x32_bf16 v[148:151], v[212:215], v[52:55], v[148:151]
v_exp_f32 v232, v136
s_mul_i32 s31, s34, 6144
v_mfma_f32_16x16x32_bf16 v[152:155], v[208:211], v[80:83], v[152:155]
v_exp_f32 v233, v137
s_add_u32 s31, s31, s30
v_mfma_f32_16x16x32_bf16 v[152:155], v[212:215], v[84:87], v[152:155]
v_exp_f32 v234, v138
v_add_f32 v226, v226, v232
v_mfma_f32_16x16x32_bf16 v[156:159], v[208:211], v[112:115], v[156:159]
ds_read_b128 v[208:211], v240 offset:16384
v_cvt_pk_bf16_f32 v168, v232, v233
s_lshl_b32 s3, s34, 10
v_mfma_f32_16x16x32_bf16 v[156:159], v[212:215], v[116:119], v[156:159]
ds_read_b128 v[212:215], v240 offset:16896
s_waitcnt lgkmcnt(2)
s_add_u32 s28, s28, s3
v_mfma_f32_16x16x32_bf16 v[144:147], v[216:219], v[24:27], v[144:147]
v_exp_f32 v235, v139
v_add_f32 v226, v226, v233
v_mfma_f32_16x16x32_bf16 v[144:147], v[220:223], v[28:31], v[144:147]
v_add_f32 v226, v226, v234
v_add_f32 v226, v226, v235
v_cvt_pk_bf16_f32 v169, v234, v235
v_mfma_f32_16x16x32_bf16 v[148:151], v[216:219], v[56:59], v[148:151]
v_exp_f32 v236, v140
s_add_u32 s3, s3, 24576
v_mfma_f32_16x16x32_bf16 v[148:151], v[220:223], v[60:63], v[148:151]
v_exp_f32 v237, v141
s_add_u32 s30, s30, s3
v_mfma_f32_16x16x32_bf16 v[152:155], v[216:219], v[88:91], v[152:155]
v_exp_f32 v238, v142
v_add_f32 v227, v227, v236
v_mfma_f32_16x16x32_bf16 v[152:155], v[220:223], v[92:95], v[152:155]
v_cvt_pk_bf16_f32 v172, v236, v237
v_exp_f32 v239, v143
v_mfma_f32_16x16x32_bf16 v[156:159], v[216:219], v[120:123], v[156:159]
ds_read_b128 v[216:219], v240 offset:20480
v_add_f32 v227, v227, v237
v_add_f32 v227, v227, v238
v_mfma_f32_16x16x32_bf16 v[156:159], v[220:223], v[124:127], v[156:159]
ds_read_b128 v[220:223], v240 offset:20992
s_waitcnt lgkmcnt(2)
v_add_f32 v227, v227, v239
v_cvt_pk_bf16_f32 v173, v238, v239
v_max3_f32 v242, v224, v225, v226
v_max_f32 v242, v242, v227
v_cmp_lt_f32 vcc, s32, v242
s_cbranch_vccnz L2_rare_site12
L2_ret12:
v_mfma_f32_16x16x32_bf16 v[128:131], v[208:211], v[0:3], v[192:195]
v_lshrrev_b32 v241, 4, v243
v_and_b32 v241, 0x30, v241
v_xor_b32 v241, v241, v243
v_and_b32 v228, 0x380, v243
v_mad_u32_u24 v241, v228, 3, v241
v_mfma_f32_16x16x32_bf16 v[128:131], v[212:215], v[4:7], v[128:131]
v_exp_f32 v232, v144
v_mfma_f32_16x16x32_bf16 v[132:135], v[208:211], v[32:35], v[196:199]
v_exp_f32 v233, v145
v_mfma_f32_16x16x32_bf16 v[132:135], v[212:215], v[36:39], v[132:135]
v_exp_f32 v234, v146
v_add_f32 v224, v224, v232
v_mfma_f32_16x16x32_bf16 v[136:139], v[208:211], v[64:67], v[200:203]
v_cvt_pk_bf16_f32 v162, v232, v233
v_exp_f32 v235, v147
v_mfma_f32_16x16x32_bf16 v[136:139], v[212:215], v[68:71], v[136:139]
v_add_f32 v224, v224, v233
v_add_f32 v224, v224, v234
v_add_f32 v224, v224, v235
v_mfma_f32_16x16x32_bf16 v[140:143], v[208:211], v[96:99], v[204:207]
ds_read_b128 v[208:211], v240 offset:24576
v_cvt_pk_bf16_f32 v163, v234, v235
v_mfma_f32_16x16x32_bf16 v[140:143], v[212:215], v[100:103], v[140:143]
ds_read_b128 v[212:215], v240 offset:25088
s_waitcnt lgkmcnt(2)
v_mfma_f32_16x16x32_bf16 v[128:131], v[216:219], v[8:11], v[128:131]
ds_write_b128 v231, v[176:179] offset:4096
v_exp_f32 v236, v148
v_mfma_f32_16x16x32_bf16 v[128:131], v[220:223], v[12:15], v[128:131]
ds_write_b128 v231, v[180:183] offset:5120
v_exp_f32 v237, v149
v_mfma_f32_16x16x32_bf16 v[132:135], v[216:219], v[40:43], v[132:135]
ds_write_b128 v231, v[184:187] offset:6144
v_exp_f32 v238, v150
v_mfma_f32_16x16x32_bf16 v[132:135], v[220:223], v[44:47], v[132:135]
ds_write_b128 v231, v[188:191] offset:7168
v_add_f32 v225, v225, v236
v_cvt_pk_bf16_f32 v166, v236, v237
v_mfma_f32_16x16x32_bf16 v[136:139], v[216:219], v[72:75], v[136:139]
v_exp_f32 v239, v151
v_add_f32 v225, v225, v237
v_mfma_f32_16x16x32_bf16 v[136:139], v[220:223], v[76:79], v[136:139]
v_add_f32 v225, v225, v238
v_add_f32 v225, v225, v239
v_cvt_pk_bf16_f32 v167, v238, v239
v_mfma_f32_16x16x32_bf16 v[140:143], v[216:219], v[104:107], v[140:143]
ds_read_b128 v[216:219], v240 offset:28672
v_exp_f32 v232, v152
v_mfma_f32_16x16x32_bf16 v[140:143], v[220:223], v[108:111], v[140:143]
ds_read_b128 v[220:223], v240 offset:29184
s_waitcnt lgkmcnt(2)
v_mfma_f32_16x16x32_bf16 v[128:131], v[208:211], v[16:19], v[128:131]
v_exp_f32 v233, v153
v_mfma_f32_16x16x32_bf16 v[128:131], v[212:215], v[20:23], v[128:131]
v_exp_f32 v234, v154
v_add_f32 v226, v226, v232
v_mfma_f32_16x16x32_bf16 v[132:135], v[208:211], v[48:51], v[132:135]
v_cvt_pk_bf16_f32 v170, v232, v233
v_exp_f32 v235, v155
v_mfma_f32_16x16x32_bf16 v[132:135], v[212:215], v[52:55], v[132:135]
v_add_f32 v226, v226, v233
v_add_f32 v226, v226, v234
v_add_f32 v226, v226, v235
v_mfma_f32_16x16x32_bf16 v[136:139], v[208:211], v[80:83], v[136:139]
v_cvt_pk_bf16_f32 v171, v234, v235
v_exp_f32 v236, v156
v_mfma_f32_16x16x32_bf16 v[136:139], v[212:215], v[84:87], v[136:139]
v_exp_f32 v237, v157
v_mfma_f32_16x16x32_bf16 v[140:143], v[208:211], v[112:115], v[140:143]
ds_read_b128 v[208:211], v240 offset:18432
v_exp_f32 v238, v158
v_mfma_f32_16x16x32_bf16 v[140:143], v[212:215], v[116:119], v[140:143]
ds_read_b128 v[212:215], v240 offset:18944
s_waitcnt lgkmcnt(2)
v_add_f32 v227, v227, v236
v_mfma_f32_16x16x32_bf16 v[128:131], v[216:219], v[24:27], v[128:131]
v_cvt_pk_bf16_f32 v174, v236, v237
v_exp_f32 v239, v159
v_mfma_f32_16x16x32_bf16 v[128:131], v[220:223], v[28:31], v[128:131]
v_add_f32 v227, v227, v237
v_add_f32 v227, v227, v238
v_add_f32 v227, v227, v239
v_mfma_f32_16x16x32_bf16 v[132:135], v[216:219], v[56:59], v[132:135]
v_cvt_pk_bf16_f32 v175, v238, v239
v_max3_f32 v242, v224, v225, v226
v_max_f32 v242, v242, v227
v_mfma_f32_16x16x32_bf16 v[132:135], v[220:223], v[60:63], v[132:135]
v_cmp_lt_f32 vcc, s32, v242
s_cbranch_vccnz L2_rare_site13
L2_ret13:
v_mfma_f32_16x16x32_bf16 v[136:139], v[216:219], v[88:91], v[136:139]
s_add_u32 m0, s31, 0
v_mfma_f32_16x16x32_bf16 v[136:139], v[220:223], v[92:95], v[136:139]
buffer_load_dwordx4 v241, s[8:11], s6 offen lds
s_add_u32 m0, s31, 2048
v_mfma_f32_16x16x32_bf16 v[140:143], v[216:219], v[120:123], v[140:143]
ds_read_b128 v[216:219], v240 offset:22528
buffer_load_dwordx4 v241, s[8:11], s7 offen lds
s_add_u32 m0, s31, 4096
v_mfma_f32_16x16x32_bf16 v[140:143], v[220:223], v[124:127], v[140:143]
ds_read_b128 v[220:223], v240 offset:23040
s_waitcnt lgkmcnt(2)
v_mfma_f32_16x16x32_bf16 v[144:147], v[208:211], v[0:3], v[192:195]
buffer_load_dwordx4 v241, s[8:11], s29 offen lds
s_add_u32 m0, s31, 1024
v_xor_b32 v241, 0x1040, v241
v_mfma_f32_16x16x32_bf16 v[144:147], v[212:215], v[4:7], v[144:147]
v_exp_f32 v232, v128
v_mfma_f32_16x16x32_bf16 v[148:151], v[208:211], v[32:35], v[196:199]
v_exp_f32 v233, v129
v_mfma_f32_16x16x32_bf16 v[148:151], v[212:215], v[36:39], v[148:151]
v_exp_f32 v234, v130
v_add_f32 v224, v224, v232
v_mfma_f32_16x16x32_bf16 v[152:155], v[208:211], v[64:67], v[200:203]
v_cvt_pk_bf16_f32 v176, v232, v233
v_exp_f32 v235, v131
v_mfma_f32_16x16x32_bf16 v[152:155], v[212:215], v[68:71], v[152:155]
v_add_f32 v224, v224, v233
v_add_f32 v224, v224, v234
v_add_f32 v224, v224, v235
v_mfma_f32_16x16x32_bf16 v[156:159], v[208:211], v[96:99], v[204:207]
ds_read_b128 v[208:211], v240 offset:26624
v_cvt_pk_bf16_f32 v177, v234, v235
v_mfma_f32_16x16x32_bf16 v[156:159], v[212:215], v[100:103], v[156:159]
ds_read_b128 v[212:215], v240 offset:27136
s_waitcnt lgkmcnt(2)
v_mfma_f32_16x16x32_bf16 v[144:147], v[216:219], v[8:11], v[144:147]
v_exp_f32 v236, v132
v_mfma_f32_16x16x32_bf16 v[144:147], v[220:223], v[12:15], v[144:147]
v_exp_f32 v237, v133
v_mfma_f32_16x16x32_bf16 v[148:151], v[216:219], v[40:43], v[148:151]
v_exp_f32 v238, v134
v_add_f32 v225, v225, v236
v_mfma_f32_16x16x32_bf16 v[148:151], v[220:223], v[44:47], v[148:151]
v_cvt_pk_bf16_f32 v180, v236, v237
v_exp_f32 v239, v135
v_mfma_f32_16x16x32_bf16 v[152:155], v[216:219], v[72:75], v[152:155]
v_add_f32 v225, v225, v237
v_add_f32 v225, v225, v238
v_add_f32 v225, v225, v239
v_mfma_f32_16x16x32_bf16 v[152:155], v[220:223], v[76:79], v[152:155]
v_cvt_pk_bf16_f32 v181, v238, v239
v_exp_f32 v232, v136
v_mfma_f32_16x16x32_bf16 v[156:159], v[216:219], v[104:107], v[156:159]
ds_read_b128 v[216:219], v240 offset:30720
v_exp_f32 v233, v137
v_mfma_f32_16x16x32_bf16 v[156:159], v[220:223], v[108:111], v[156:159]
ds_read_b128 v[220:223], v240 offset:31232
s_waitcnt lgkmcnt(2)
v_mfma_f32_16x16x32_bf16 v[144:147], v[208:211], v[16:19], v[144:147]
v_exp_f32 v234, v138
v_add_f32 v226, v226, v232
v_mfma_f32_16x16x32_bf16 v[144:147], v[212:215], v[20:23], v[144:147]
s_waitcnt vmcnt(3)
s_barrier
v_cvt_pk_bf16_f32 v184, v232, v233
v_mfma_f32_16x16x32_bf16 v[148:151], v[208:211], v[48:51], v[148:151]
v_exp_f32 v235, v139
v_add_f32 v226, v226, v233
v_mfma_f32_16x16x32_bf16 v[148:151], v[212:215], v[52:55], v[148:151]
v_add_f32 v226, v226, v234
v_add_f32 v226, v226, v235
v_cvt_pk_bf16_f32 v185, v234, v235
v_mfma_f32_16x16x32_bf16 v[152:155], v[208:211], v[80:83], v[152:155]
v_exp_f32 v236, v140
v_mfma_f32_16x16x32_bf16 v[152:155], v[212:215], v[84:87], v[152:155]
v_exp_f32 v237, v141
v_mfma_f32_16x16x32_bf16 v[156:159], v[208:211], v[112:115], v[156:159]
ds_read_b128 v[208:211], v230 offset:0
v_exp_f32 v238, v142
v_mfma_f32_16x16x32_bf16 v[156:159], v[212:215], v[116:119], v[156:159]
ds_read_b128 v[212:215], v230 offset:512
s_waitcnt lgkmcnt(2)
v_add_f32 v227, v227, v236
v_mfma_f32_16x16x32_bf16 v[144:147], v[216:219], v[24:27], v[144:147]
v_cvt_pk_bf16_f32 v188, v236, v237
v_exp_f32 v239, v143
v_mfma_f32_16x16x32_bf16 v[144:147], v[220:223], v[28:31], v[144:147]
v_add_f32 v227, v227, v237
v_add_f32 v227, v227, v238
v_add_f32 v227, v227, v239
v_mfma_f32_16x16x32_bf16 v[148:151], v[216:219], v[56:59], v[148:151]
v_cvt_pk_bf16_f32 v189, v238, v239
v_max3_f32 v242, v224, v225, v226
v_max_f32 v242, v242, v227
v_mfma_f32_16x16x32_bf16 v[148:151], v[220:223], v[60:63], v[148:151]
v_cmp_lt_f32 vcc, s32, v242
s_cbranch_vccnz L2_rare_site14
L2_ret14:
v_mfma_f32_16x16x32_bf16 v[152:155], v[216:219], v[88:91], v[152:155]
buffer_load_dwordx4 v241, s[8:11], s6 offen lds
s_add_u32 m0, s31, 3072
v_mfma_f32_16x16x32_bf16 v[152:155], v[220:223], v[92:95], v[152:155]
buffer_load_dwordx4 v241, s[8:11], s7 offen lds
s_add_u32 m0, s31, 5120
v_mfma_f32_16x16x32_bf16 v[156:159], v[216:219], v[120:123], v[156:159]
ds_read_b128 v[216:219], v230 offset:4096
buffer_load_dwordx4 v241, s[8:11], s29 offen lds
v_mfma_f32_16x16x32_bf16 v[156:159], v[220:223], v[124:127], v[156:159]
ds_read_b128 v[220:223], v230 offset:4608
s_waitcnt lgkmcnt(2)
v_mfma_f32_16x16x32_bf16 v[128:131], v[208:211], v[0:3], v[192:195]
v_mfma_f32_16x16x32_bf16 v[128:131], v[212:215], v[4:7], v[128:131]
v_exp_f32 v232, v144
v_mfma_f32_16x16x32_bf16 v[132:135], v[208:211], v[32:35], v[196:199]
v_exp_f32 v233, v145
v_mfma_f32_16x16x32_bf16 v[132:135], v[212:215], v[36:39], v[132:135]
v_exp_f32 v234, v146
v_add_f32 v224, v224, v232
v_mfma_f32_16x16x32_bf16 v[136:139], v[208:211], v[64:67], v[200:203]
v_cvt_pk_bf16_f32 v178, v232, v233
v_exp_f32 v235, v147
v_mfma_f32_16x16x32_bf16 v[136:139], v[212:215], v[68:71], v[136:139]
v_add_f32 v224, v224, v233
v_add_f32 v224, v224, v234
v_add_f32 v224, v224, v235
v_mfma_f32_16x16x32_bf16 v[140:143], v[208:211], v[96:99], v[204:207]
ds_read_b128 v[208:211], v230 offset:8192
v_cvt_pk_bf16_f32 v179, v234, v235
v_lshlrev_b32 v241, 3, v243
v_mfma_f32_16x16x32_bf16 v[140:143], v[212:215], v[100:103], v[140:143]
ds_read_b128 v[212:215], v230 offset:8704
s_waitcnt lgkmcnt(2)
s_mov_b32 s3, 0x7c28000
v_mfma_f32_16x16x32_bf16 v[128:131], v[216:219], v[8:11], v[128:131]
v_exp_f32 v236, v148
buffer_load_dwordx2 v[240:241], v241, s[16:19], s3 offen sc1
v_mfma_f32_16x16x32_bf16 v[128:131], v[220:223], v[12:15], v[128:131]
v_exp_f32 v237, v149
v_mfma_f32_16x16x32_bf16 v[132:135], v[216:219], v[40:43], v[132:135]
v_exp_f32 v238, v150
v_add_f32 v225, v225, v236
v_mfma_f32_16x16x32_bf16 v[132:135], v[220:223], v[44:47], v[132:135]
v_cvt_pk_bf16_f32 v182, v236, v237
v_exp_f32 v239, v151
v_mfma_f32_16x16x32_bf16 v[136:139], v[216:219], v[72:75], v[136:139]
v_add_f32 v225, v225, v237
v_add_f32 v225, v225, v238
v_add_f32 v225, v225, v239
v_mfma_f32_16x16x32_bf16 v[136:139], v[220:223], v[76:79], v[136:139]
v_cvt_pk_bf16_f32 v183, v238, v239
v_exp_f32 v232, v152
v_mfma_f32_16x16x32_bf16 v[140:143], v[216:219], v[104:107], v[140:143]
ds_read_b128 v[216:219], v230 offset:12288
v_exp_f32 v233, v153
v_mfma_f32_16x16x32_bf16 v[140:143], v[220:223], v[108:111], v[140:143]
ds_read_b128 v[220:223], v230 offset:12800
s_waitcnt lgkmcnt(2)
v_mfma_f32_16x16x32_bf16 v[128:131], v[208:211], v[16:19], v[128:131]
v_exp_f32 v234, v154
v_add_f32 v226, v226, v232
v_mfma_f32_16x16x32_bf16 v[128:131], v[212:215], v[20:23], v[128:131]
v_cvt_pk_bf16_f32 v186, v232, v233
v_exp_f32 v235, v155
v_mfma_f32_16x16x32_bf16 v[132:135], v[208:211], v[48:51], v[132:135]
v_add_f32 v226, v226, v233
v_add_f32 v226, v226, v234
v_add_f32 v226, v226, v235
v_mfma_f32_16x16x32_bf16 v[132:135], v[212:215], v[52:55], v[132:135]
v_cvt_pk_bf16_f32 v187, v234, v235
v_exp_f32 v236, v156
v_mfma_f32_16x16x32_bf16 v[136:139], v[208:211], v[80:83], v[136:139]
v_exp_f32 v237, v157
v_mfma_f32_16x16x32_bf16 v[136:139], v[212:215], v[84:87], v[136:139]
v_exp_f32 v238, v158
v_add_f32 v227, v227, v236
v_mfma_f32_16x16x32_bf16 v[140:143], v[208:211], v[112:115], v[140:143]
ds_read_b128 v[208:211], v230 offset:2048
v_cvt_pk_bf16_f32 v190, v236, v237
v_mfma_f32_16x16x32_bf16 v[140:143], v[212:215], v[116:119], v[140:143]
ds_read_b128 v[212:215], v230 offset:2560
s_waitcnt lgkmcnt(2)
v_mfma_f32_16x16x32_bf16 v[128:131], v[216:219], v[24:27], v[128:131]
v_exp_f32 v239, v159
v_add_f32 v227, v227, v237
v_mfma_f32_16x16x32_bf16 v[128:131], v[220:223], v[28:31], v[128:131]
v_add_f32 v227, v227, v238
v_add_f32 v227, v227, v239
v_cvt_pk_bf16_f32 v191, v238, v239
v_mfma_f32_16x16x32_bf16 v[132:135], v[216:219], v[56:59], v[132:135]
v_max3_f32 v242, v224, v225, v226
v_max_f32 v242, v242, v227
v_cmp_lt_f32 vcc, s32, v242
s_cbranch_vccnz L2_rare_site15
L2_ret15:
v_mfma_f32_16x16x32_bf16 v[132:135], v[220:223], v[60:63], v[132:135]
v_mfma_f32_16x16x32_bf16 v[136:139], v[216:219], v[88:91], v[136:139]
v_mfma_f32_16x16x32_bf16 v[136:139], v[220:223], v[92:95], v[136:139]
v_mfma_f32_16x16x32_bf16 v[140:143], v[216:219], v[120:123], v[140:143]
ds_read_b128 v[216:219], v230 offset:6144
v_mfma_f32_16x16x32_bf16 v[140:143], v[220:223], v[124:127], v[140:143]
ds_read_b128 v[220:223], v230 offset:6656
s_waitcnt lgkmcnt(2)
v_mfma_f32_16x16x32_bf16 v[144:147], v[208:211], v[0:3], v[192:195]
v_mfma_f32_16x16x32_bf16 v[144:147], v[212:215], v[4:7], v[144:147]
v_mfma_f32_16x16x32_bf16 v[148:151], v[208:211], v[32:35], v[196:199]
v_mfma_f32_16x16x32_bf16 v[148:151], v[212:215], v[36:39], v[148:151]
v_mfma_f32_16x16x32_bf16 v[152:155], v[208:211], v[64:67], v[200:203]
v_exp_f32 v232, v128
v_mfma_f32_16x16x32_bf16 v[152:155], v[212:215], v[68:71], v[152:155]
v_exp_f32 v233, v129
v_mfma_f32_16x16x32_bf16 v[156:159], v[208:211], v[96:99], v[204:207]
ds_read_b128 v[208:211], v230 offset:10240
v_exp_f32 v234, v130
v_mfma_f32_16x16x32_bf16 v[156:159], v[212:215], v[100:103], v[156:159]
ds_read_b128 v[212:215], v230 offset:10752
s_waitcnt lgkmcnt(2)
v_add_f32 v224, v224, v232
v_mfma_f32_16x16x32_bf16 v[144:147], v[216:219], v[8:11], v[144:147]
v_cvt_pk_bf16_f32 v0, v232, v233
v_exp_f32 v235, v131
v_mfma_f32_16x16x32_bf16 v[144:147], v[220:223], v[12:15], v[144:147]
ds_read_b128 v[4:7], v231 offset:0
v_add_f32 v224, v224, v233
v_add_f32 v224, v224, v234
v_mfma_f32_16x16x32_bf16 v[148:151], v[216:219], v[40:43], v[148:151]
ds_read_b128 v[36:39], v231 offset:1024
v_add_f32 v224, v224, v235
v_cvt_pk_bf16_f32 v1, v234, v235
v_mfma_f32_16x16x32_bf16 v[148:151], v[220:223], v[44:47], v[148:151]
v_exp_f32 v236, v132
v_mfma_f32_16x16x32_bf16 v[152:155], v[216:219], v[72:75], v[152:155]
v_exp_f32 v237, v133
v_mfma_f32_16x16x32_bf16 v[152:155], v[220:223], v[76:79], v[152:155]
ds_read_b128 v[68:71], v231 offset:2048
ds_read_b128 v[8:11], v231 offset:4096
v_mfma_f32_16x16x32_bf16 v[156:159], v[216:219], v[104:107], v[156:159]
ds_read_b128 v[216:219], v230 offset:14336
v_add_u32 v12, 0x8000, v246
v_and_b32 v12, 0x1ffff, v12
ds_read_b128 v[100:103], v231 offset:3072
ds_read_b128 v[40:43], v231 offset:5120
v_mfma_f32_16x16x32_bf16 v[156:159], v[220:223], v[108:111], v[156:159]
ds_read_b128 v[220:223], v230 offset:14848
s_waitcnt lgkmcnt(2)
v_add_u32 v14, 0x10000, v246
v_and_b32 v14, 0x1ffff, v14
v_mfma_f32_16x16x32_bf16 v[144:147], v[208:211], v[16:19], v[144:147]
v_xor_b32 v13, 32, v12
v_xor_b32 v15, 32, v14
v_mfma_f32_16x16x32_bf16 v[144:147], v[212:215], v[20:23], v[144:147]
ds_read_b128 v[72:75], v231 offset:6144
v_exp_f32 v238, v134
v_mfma_f32_16x16x32_bf16 v[148:151], v[208:211], v[48:51], v[148:151]
ds_read_b128 v[104:107], v231 offset:7168
v_add_f32 v225, v225, v236
v_cvt_pk_bf16_f32 v32, v236, v237
v_mfma_f32_16x16x32_bf16 v[148:151], v[212:215], v[52:55], v[148:151]
v_exp_f32 v239, v135
v_add_f32 v225, v225, v237
v_mfma_f32_16x16x32_bf16 v[152:155], v[208:211], v[80:83], v[152:155]
v_add_f32 v225, v225, v238
v_add_f32 v225, v225, v239
v_cvt_pk_bf16_f32 v33, v238, v239
v_mfma_f32_16x16x32_bf16 v[152:155], v[212:215], v[84:87], v[152:155]
v_exp_f32 v232, v136
v_mfma_f32_16x16x32_bf16 v[156:159], v[208:211], v[112:115], v[156:159]
ds_read_b64_tr_b16 v[208:209], v246 offset:16384
ds_read_b64_tr_b16 v[210:211], v246 offset:18432
v_mfma_f32_16x16x32_bf16 v[156:159], v[212:215], v[116:119], v[156:159]
ds_read_b64_tr_b16 v[212:213], v12 offset:0
s_waitcnt lgkmcnt(3)
v_mfma_f32_16x16x32_bf16 v[144:147], v[216:219], v[24:27], v[144:147]
ds_read_b64_tr_b16 v[214:215], v12 offset:2048
v_exp_f32 v233, v137
v_mfma_f32_16x16x32_bf16 v[144:147], v[220:223], v[28:31], v[144:147]
v_exp_f32 v234, v138
v_add_f32 v226, v226, v232
v_mfma_f32_16x16x32_bf16 v[148:151], v[216:219], v[56:59], v[148:151]
v_cvt_pk_bf16_f32 v64, v232, v233
v_exp_f32 v235, v139
v_mfma_f32_16x16x32_bf16 v[148:151], v[220:223], v[60:63], v[148:151]
v_add_f32 v226, v226, v233
v_add_f32 v226, v226, v234
v_add_f32 v226, v226, v235
v_mfma_f32_16x16x32_bf16 v[152:155], v[216:219], v[88:91], v[152:155]
v_cvt_pk_bf16_f32 v65, v234, v235
v_exp_f32 v236, v140
v_mfma_f32_16x16x32_bf16 v[152:155], v[220:223], v[92:95], v[152:155]
v_exp_f32 v237, v141
s_waitcnt vmcnt(0)
v_mfma_f32_16x16x32_bf16 v[156:159], v[216:219], v[120:123], v[156:159]
ds_read_b64_tr_b16 v[216:217], v12 offset:16384
ds_read_b64_tr_b16 v[218:219], v12 offset:18432
v_cmp_ne_u64_e64 s[38:39], s[98:99], v[240:241]
v_mfma_f32_16x16x32_bf16 v[156:159], v[220:223], v[124:127], v[156:159]
ds_read_b64_tr_b16 v[220:221], v247 offset:16384
s_waitcnt lgkmcnt(3)
v_exp_f32 v238, v142
v_add_f32 v227, v227, v236
v_cvt_pk_bf16_f32 v96, v236, v237
v_exp_f32 v239, v143
v_add_f32 v227, v227, v237
v_add_f32 v227, v227, v238
v_add_f32 v227, v227, v239
v_cvt_pk_bf16_f32 v97, v238, v239
v_max3_f32 v242, v224, v225, v226
v_max_f32 v242, v242, v227
v_cmp_lt_f32 vcc, s32, v242
s_cbranch_vccnz L2_rare_site16
L2_ret16:
v_mfma_f32_16x16x32_bf16 a[0:3], v[8:11], v[208:211], a[0:3]
ds_read_b64_tr_b16 v[222:223], v247 offset:18432
s_and_b64 s[38:39], s[38:39], s[96:97]
s_cbranch_scc1 LF_hl_0
LF_hlret_0:
v_mfma_f32_16x16x32_bf16 a[0:3], v[160:163], v[212:215], a[0:3]
v_exp_f32 v232, v144
v_lshrrev_b32 v241, 4, v243
v_mfma_f32_16x16x32_bf16 a[4:7], v[40:43], v[208:211], a[4:7]
v_exp_f32 v233, v145
v_and_b32 v241, 0x30, v241
v_mfma_f32_16x16x32_bf16 a[4:7], v[164:167], v[212:215], a[4:7]
v_exp_f32 v234, v146
v_xor_b32 v241, v241, v243
v_mfma_f32_16x16x32_bf16 a[8:11], v[72:75], v[208:211], a[8:11]
v_add_f32 v224, v224, v232
v_cvt_pk_bf16_f32 v2, v232, v233
v_mfma_f32_16x16x32_bf16 a[8:11], v[168:171], v[212:215], a[8:11]
v_exp_f32 v235, v147
v_mfma_f32_16x16x32_bf16 a[12:15], v[104:107], v[208:211], a[12:15]
ds_read_b64_tr_b16 v[208:209], v13 offset:0
ds_read_b64_tr_b16 v[210:211], v13 offset:2048
v_mfma_f32_16x16x32_bf16 a[12:15], v[172:175], v[212:215], a[12:15]
ds_read_b64_tr_b16 v[212:213], v13 offset:16384
s_waitcnt lgkmcnt(5)
v_mfma_f32_16x16x32_bf16 a[0:3], v[176:179], v[216:219], a[0:3]
ds_read_b64_tr_b16 v[214:215], v13 offset:18432
v_add_f32 v224, v224, v233
v_mfma_f32_16x16x32_bf16 a[4:7], v[180:183], v[216:219], a[4:7]
v_add_f32 v224, v224, v234
v_add_f32 v224, v224, v235
v_mfma_f32_16x16x32_bf16 a[8:11], v[184:187], v[216:219], a[8:11]
v_cvt_pk_bf16_f32 v3, v234, v235
v_and_b32 v228, 0x380, v243
v_mad_u32_u24 v241, v228, 3, v241
v_mfma_f32_16x16x32_bf16 a[12:15], v[188:191], v[216:219], a[12:15]
ds_read_b64_tr_b16 v[216:217], v246 offset:16896
s_waitcnt lgkmcnt(5)
v_add_u32 v241, 0x7000000, v241
v_mfma_f32_16x16x32_bf16 a[16:19], v[8:11], v[220:223], a[16:19]
ds_read_b64_tr_b16 v[218:219], v246 offset:18944
v_and_b32 v110, 0x70, v243
v_lshlrev_b32 v110, 3, v110
v_mfma_f32_16x16x32_bf16 a[20:23], v[40:43], v[220:223], a[20:23]
v_exp_f32 v236, v148
v_add_u32 v110, 0x7c32000, v110
v_mfma_f32_16x16x32_bf16 a[24:27], v[72:75], v[220:223], a[24:27]
v_exp_f32 v237, v149
buffer_load_dwordx2 v[108:109], v110, s[16:19], 0 offen sc1
v_mfma_f32_16x16x32_bf16 a[28:31], v[104:107], v[220:223], a[28:31]
ds_read_b64_tr_b16 v[220:221], v12 offset:512
s_waitcnt lgkmcnt(3)
v_mfma_f32_16x16x32_bf16 a[16:19], v[160:163], v[208:211], a[16:19]
ds_read_b64_tr_b16 v[222:223], v12 offset:2560
s_add_u32 m0, s28, 0
v_mfma_f32_16x16x32_bf16 a[16:19], v[176:179], v[212:215], a[16:19]
v_exp_f32 v238, v150
v_mfma_f32_16x16x32_bf16 a[20:23], v[164:167], v[208:211], a[20:23]
v_add_f32 v225, v225, v236
v_cvt_pk_bf16_f32 v34, v236, v237
v_mfma_f32_16x16x32_bf16 a[20:23], v[180:183], v[212:215], a[20:23]
v_exp_f32 v239, v151
v_mfma_f32_16x16x32_bf16 a[24:27], v[168:171], v[208:211], a[24:27]
v_add_f32 v225, v225, v237
v_add_f32 v225, v225, v238
v_mfma_f32_16x16x32_bf16 a[24:27], v[184:187], v[212:215], a[24:27]
v_add_f32 v225, v225, v239
v_cvt_pk_bf16_f32 v35, v238, v239
v_mfma_f32_16x16x32_bf16 a[28:31], v[172:175], v[208:211], a[28:31]
ds_read_b64_tr_b16 v[208:209], v12 offset:16896
ds_read_b64_tr_b16 v[210:211], v12 offset:18944
v_mfma_f32_16x16x32_bf16 a[28:31], v[188:191], v[212:215], a[28:31]
ds_read_b64_tr_b16 v[212:213], v247 offset:16896
s_waitcnt lgkmcnt(3)
v_mfma_f32_16x16x32_bf16 a[32:35], v[8:11], v[216:219], a[32:35]
ds_read_b64_tr_b16 v[214:215], v247 offset:18944
buffer_load_dwordx4 v241, s[16:19], s6 offen sc1 lds
s_add_u32 m0, s28, 8192
v_mfma_f32_16x16x32_bf16 a[32:35], v[160:163], v[220:223], a[32:35]
v_exp_f32 v232, v152
v_mfma_f32_16x16x32_bf16 a[36:39], v[40:43], v[216:219], a[36:39]
v_exp_f32 v233, v153
v_mfma_f32_16x16x32_bf16 a[36:39], v[164:167], v[220:223], a[36:39]
v_exp_f32 v234, v154
v_mfma_f32_16x16x32_bf16 a[40:43], v[72:75], v[216:219], a[40:43]
v_add_f32 v226, v226, v232
v_cvt_pk_bf16_f32 v66, v232, v233
v_mfma_f32_16x16x32_bf16 a[40:43], v[168:171], v[220:223], a[40:43]
v_exp_f32 v235, v155
v_mfma_f32_16x16x32_bf16 a[44:47], v[104:107], v[216:219], a[44:47]
ds_read_b64_tr_b16 v[216:217], v13 offset:512
ds_read_b64_tr_b16 v[218:219], v13 offset:2560
v_mfma_f32_16x16x32_bf16 a[44:47], v[172:175], v[220:223], a[44:47]
ds_read_b64_tr_b16 v[220:221], v13 offset:16896
s_waitcnt lgkmcnt(5)
v_mfma_f32_16x16x32_bf16 a[32:35], v[176:179], v[208:211], a[32:35]
ds_read_b64_tr_b16 v[222:223], v13 offset:18944
v_add_f32 v226, v226, v233
v_mfma_f32_16x16x32_bf16 a[36:39], v[180:183], v[208:211], a[36:39]
v_add_f32 v226, v226, v234
v_add_f32 v226, v226, v235
v_mfma_f32_16x16x32_bf16 a[40:43], v[184:187], v[208:211], a[40:43]
v_cvt_pk_bf16_f32 v67, v234, v235
buffer_load_dwordx4 v241, s[16:19], s7 offen sc1 lds
s_add_u32 m0, s30, 0
v_mfma_f32_16x16x32_bf16 a[44:47], v[188:191], v[208:211], a[44:47]
ds_read_b64_tr_b16 v[208:209], v14 offset:0
s_waitcnt lgkmcnt(5)
v_mfma_f32_16x16x32_bf16 a[48:51], v[8:11], v[212:215], a[48:51]
ds_read_b64_tr_b16 v[210:211], v14 offset:2048
buffer_load_dwordx4 v241, s[16:19], s29 offen sc1 lds
s_add_u32 m0, s28, 4096
v_mfma_f32_16x16x32_bf16 a[52:55], v[40:43], v[212:215], a[52:55]
v_exp_f32 v236, v156
v_xor_b32 v241, 0x1040, v241
v_mfma_f32_16x16x32_bf16 a[56:59], v[72:75], v[212:215], a[56:59]
v_exp_f32 v237, v157
v_mfma_f32_16x16x32_bf16 a[60:63], v[104:107], v[212:215], a[60:63]
ds_read_b64_tr_b16 v[212:213], v15 offset:0
s_waitcnt lgkmcnt(3)
v_mfma_f32_16x16x32_bf16 a[48:51], v[160:163], v[216:219], a[48:51]
ds_read_b64_tr_b16 v[214:215], v15 offset:2048
buffer_load_dwordx4 v241, s[16:19], s6 offen sc1 lds
s_add_u32 m0, s28, 12288
v_mfma_f32_16x16x32_bf16 a[48:51], v[176:179], v[220:223], a[48:51]
v_exp_f32 v238, v158
v_mfma_f32_16x16x32_bf16 a[52:55], v[164:167], v[216:219], a[52:55]
v_add_f32 v227, v227, v236
v_cvt_pk_bf16_f32 v98, v236, v237
v_mfma_f32_16x16x32_bf16 a[52:55], v[180:183], v[220:223], a[52:55]
v_exp_f32 v239, v159
v_mfma_f32_16x16x32_bf16 a[56:59], v[168:171], v[216:219], a[56:59]
v_add_f32 v227, v227, v237
v_add_f32 v227, v227, v238
v_mfma_f32_16x16x32_bf16 a[56:59], v[184:187], v[220:223], a[56:59]
v_add_f32 v227, v227, v239
v_cvt_pk_bf16_f32 v99, v238, v239
v_mfma_f32_16x16x32_bf16 a[60:63], v[172:175], v[216:219], a[60:63]
ds_read_b64_tr_b16 v[216:217], v14 offset:512
ds_read_b64_tr_b16 v[218:219], v14 offset:2560
v_max3_f32 v242, v224, v225, v226
v_max_f32 v242, v242, v227
v_cmp_lt_f32 vcc, s32, v242
s_cbranch_vccnz L2_rare_site17
L2_ret17:
v_mfma_f32_16x16x32_bf16 a[60:63], v[188:191], v[220:223], a[60:63]
ds_read_b64_tr_b16 v[220:221], v15 offset:512
s_waitcnt lgkmcnt(5)
v_mfma_f32_16x16x32_bf16 a[0:3], v[0:3], v[208:211], a[0:3]
ds_read_b64_tr_b16 v[222:223], v15 offset:2560
buffer_load_dwordx4 v241, s[16:19], s7 offen sc1 lds
s_add_u32 m0, s30, 4096
v_mfma_f32_16x16x32_bf16 a[4:7], v[32:35], v[208:211], a[4:7]
buffer_load_dwordx4 v241, s[16:19], s29 offen sc1 lds
v_bfe_u32 v242, v243, 8, 1
v_mfma_f32_16x16x32_bf16 a[8:11], v[64:67], v[208:211], a[8:11]
v_mul_u32_u24 v242, 48, v242
v_lshl_add_u32 v242, s37, 3, v242
v_and_b32 v228, 0xf0, v243
v_mfma_f32_16x16x32_bf16 a[12:15], v[96:99], v[208:211], a[12:15]
ds_read_b64_tr_b16 v[208:209], v246 offset:20480
s_waitcnt lgkmcnt(5)
v_lshl_add_u32 v242, v228, 3, v242
v_mfma_f32_16x16x32_bf16 a[16:19], v[0:3], v[212:215], a[16:19]
ds_read_b64_tr_b16 v[210:211], v246 offset:22528
v_mov_b32 v232, v224
v_mov_b32 v234, v225
v_mfma_f32_16x16x32_bf16 a[20:23], v[32:35], v[212:215], a[20:23]
v_mov_b32 v236, v226
v_mov_b32 v238, v227
v_permlane32_swap_b32 v224, v232
v_mfma_f32_16x16x32_bf16 a[24:27], v[64:67], v[212:215], a[24:27]
v_permlane32_swap_b32 v225, v234
v_permlane32_swap_b32 v226, v236
v_permlane32_swap_b32 v227, v238
v_mfma_f32_16x16x32_bf16 a[28:31], v[96:99], v[212:215], a[28:31]
ds_read_b64_tr_b16 v[212:213], v12 offset:4096
s_waitcnt lgkmcnt(5)
v_add_f32 v224, v224, v232
v_mfma_f32_16x16x32_bf16 a[32:35], v[0:3], v[216:219], a[32:35]
ds_read_b64_tr_b16 v[214:215], v12 offset:6144
v_add_f32 v225, v225, v234
v_add_f32 v226, v226, v236
v_mfma_f32_16x16x32_bf16 a[36:39], v[32:35], v[216:219], a[36:39]
v_add_f32 v227, v227, v238
v_mov_b32 v232, v224
v_mov_b32 v234, v225
v_mfma_f32_16x16x32_bf16 a[40:43], v[64:67], v[216:219], a[40:43]
v_mov_b32 v236, v226
v_mov_b32 v238, v227
v_permlane16_swap_b32 v224, v232
v_mfma_f32_16x16x32_bf16 a[44:47], v[96:99], v[216:219], a[44:47]
ds_read_b64_tr_b16 v[216:217], v12 offset:20480
s_waitcnt lgkmcnt(5)
v_permlane16_swap_b32 v225, v234
v_mfma_f32_16x16x32_bf16 a[48:51], v[0:3], v[220:223], a[48:51]
ds_read_b64_tr_b16 v[218:219], v12 offset:22528
v_permlane16_swap_b32 v226, v236
v_permlane16_swap_b32 v227, v238
v_mfma_f32_16x16x32_bf16 a[52:55], v[32:35], v[220:223], a[52:55]
v_add_f32 v233, v224, v232
v_add_f32 v235, v225, v234
v_add_f32 v237, v226, v236
v_mfma_f32_16x16x32_bf16 a[56:59], v[64:67], v[220:223], a[56:59]
v_add_f32 v239, v227, v238
v_sub_f32 v232, 0, v192
v_sub_f32 v234, 0, v196
v_mfma_f32_16x16x32_bf16 a[60:63], v[96:99], v[220:223], a[60:63]
ds_read_b64_tr_b16 v[220:221], v14 offset:4096
s_waitcnt lgkmcnt(3)
v_sub_f32 v236, 0, v200
v_mfma_f32_16x16x32_bf16 a[64:67], v[8:11], v[208:211], a[64:67]
ds_read_b64_tr_b16 v[222:223], v14 offset:6144
v_sub_f32 v238, 0, v204
v_mfma_f32_16x16x32_bf16 a[64:67], v[160:163], v[212:215], a[64:67]
s_mov_b32 exec_hi, 0
buffer_store_dwordx2 v[232:233], v242, s[24:27], s48 offen sc1
s_lshr_b32 s3, s41, 2
buffer_store_dwordx2 v[234:235], v242, s[24:27], s3 offen sc1
s_lshr_b32 s3, s42, 2
buffer_store_dwordx2 v[236:237], v242, s[24:27], s3 offen sc1
s_lshr_b32 s3, s43, 2
buffer_store_dwordx2 v[238:239], v242, s[24:27], s3 offen sc1
s_mov_b32 exec_hi, -1
v_mfma_f32_16x16x32_bf16 a[68:71], v[40:43], v[208:211], a[68:71]
v_accvgpr_read_b32 v128, a0
v_accvgpr_read_b32 v129, a1
v_accvgpr_read_b32 v130, a2
v_mfma_f32_16x16x32_bf16 a[68:71], v[164:167], v[212:215], a[68:71]
v_accvgpr_read_b32 v131, a3
v_cvt_pk_bf16_f32 v16, v128, v129
v_cvt_pk_bf16_f32 v17, v130, v131
v_mfma_f32_16x16x32_bf16 a[72:75], v[72:75], v[208:211], a[72:75]
v_accvgpr_read_b32 v136, a4
v_accvgpr_read_b32 v137, a5
v_accvgpr_read_b32 v138, a6
v_mfma_f32_16x16x32_bf16 a[72:75], v[168:171], v[212:215], a[72:75]
v_accvgpr_read_b32 v139, a7
v_cvt_pk_bf16_f32 v48, v136, v137
v_cvt_pk_bf16_f32 v49, v138, v139
v_mfma_f32_16x16x32_bf16 a[76:79], v[104:107], v[208:211], a[76:79]
ds_read_b64_tr_b16 v[208:209], v247 offset:20480
ds_read_b64_tr_b16 v[210:211], v247 offset:22528
v_accvgpr_read_b32 v144, a8
v_mfma_f32_16x16x32_bf16 a[76:79], v[172:175], v[212:215], a[76:79]
ds_read_b64_tr_b16 v[212:213], v13 offset:4096
s_waitcnt lgkmcnt(3)
v_accvgpr_read_b32 v145, a9
v_mfma_f32_16x16x32_bf16 a[64:67], v[176:179], v[216:219], a[64:67]
ds_read_b64_tr_b16 v[214:215], v13 offset:6144
v_accvgpr_read_b32 v146, a10
v_accvgpr_read_b32 v147, a11
v_mfma_f32_16x16x32_bf16 a[64:67], v[0:3], v[220:223], a[64:67]
v_cvt_pk_bf16_f32 v80, v144, v145
v_cvt_pk_bf16_f32 v81, v146, v147
v_accvgpr_read_b32 v152, a12
v_mfma_f32_16x16x32_bf16 a[68:71], v[180:183], v[216:219], a[68:71]
v_accvgpr_read_b32 v153, a13
v_accvgpr_read_b32 v154, a14
v_accvgpr_read_b32 v155, a15
v_mfma_f32_16x16x32_bf16 a[68:71], v[32:35], v[220:223], a[68:71]
v_cvt_pk_bf16_f32 v112, v152, v153
v_cvt_pk_bf16_f32 v113, v154, v155
v_accvgpr_read_b32 v132, a16
v_mfma_f32_16x16x32_bf16 a[72:75], v[184:187], v[216:219], a[72:75]
v_accvgpr_read_b32 v133, a17
v_accvgpr_read_b32 v134, a18
v_accvgpr_read_b32 v135, a19
v_mfma_f32_16x16x32_bf16 a[72:75], v[64:67], v[220:223], a[72:75]
v_cvt_pk_bf16_f32 v18, v132, v133
v_cvt_pk_bf16_f32 v19, v134, v135
buffer_store_dwordx4 v[16:19], v243, s[20:23], s40 offen offset:0 sc1
v_mfma_f32_16x16x32_bf16 a[76:79], v[188:191], v[216:219], a[76:79]
ds_read_b64_tr_b16 v[216:217], v13 offset:20480
ds_read_b64_tr_b16 v[218:219], v13 offset:22528
ds_write_b128 v231, v[16:19] offset:0
v_mfma_f32_16x16x32_bf16 a[76:79], v[96:99], v[220:223], a[76:79]
ds_read_b64_tr_b16 v[220:221], v15 offset:4096
s_waitcnt lgkmcnt(3)
v_accvgpr_read_b32 v140, a20
v_mfma_f32_16x16x32_bf16 a[80:83], v[8:11], v[208:211], a[80:83]
ds_read_b64_tr_b16 v[222:223], v15 offset:6144
v_accvgpr_read_b32 v141, a21
v_accvgpr_read_b32 v142, a22
v_mfma_f32_16x16x32_bf16 a[80:83], v[160:163], v[212:215], a[80:83]
v_accvgpr_read_b32 v143, a23
v_cvt_pk_bf16_f32 v50, v140, v141
v_cvt_pk_bf16_f32 v51, v142, v143
v_mfma_f32_16x16x32_bf16 a[84:87], v[40:43], v[208:211], a[84:87]
buffer_store_dwordx4 v[48:51], v243, s[20:23], s41 offen offset:0 sc1
v_accvgpr_read_b32 v148, a24
v_accvgpr_read_b32 v149, a25
v_mfma_f32_16x16x32_bf16 a[84:87], v[164:167], v[212:215], a[84:87]
v_accvgpr_read_b32 v150, a26
v_accvgpr_read_b32 v151, a27
v_cvt_pk_bf16_f32 v82, v148, v149
v_mfma_f32_16x16x32_bf16 a[88:91], v[72:75], v[208:211], a[88:91]
v_cvt_pk_bf16_f32 v83, v150, v151
buffer_store_dwordx4 v[80:83], v243, s[20:23], s42 offen offset:0 sc1
v_accvgpr_read_b32 v156, a28
v_mfma_f32_16x16x32_bf16 a[88:91], v[168:171], v[212:215], a[88:91]
v_accvgpr_read_b32 v157, a29
v_accvgpr_read_b32 v158, a30
v_accvgpr_read_b32 v159, a31
v_mfma_f32_16x16x32_bf16 a[92:95], v[104:107], v[208:211], a[92:95]
ds_read_b64_tr_b16 v[208:209], v246 offset:20992
ds_read_b64_tr_b16 v[210:211], v246 offset:23040
v_cvt_pk_bf16_f32 v114, v156, v157
v_mfma_f32_16x16x32_bf16 a[92:95], v[172:175], v[212:215], a[92:95]
ds_read_b64_tr_b16 v[212:213], v12 offset:4608
s_waitcnt lgkmcnt(3)
v_cvt_pk_bf16_f32 v115, v158, v159
v_mfma_f32_16x16x32_bf16 a[80:83], v[176:179], v[216:219], a[80:83]
ds_read_b64_tr_b16 v[214:215], v12 offset:6656
buffer_store_dwordx4 v[112:115], v243, s[20:23], s43 offen offset:0 sc1
v_accvgpr_read_b32 v128, a32
v_mfma_f32_16x16x32_bf16 a[80:83], v[0:3], v[220:223], a[80:83]
v_accvgpr_read_b32 v129, a33
v_accvgpr_read_b32 v130, a34
v_accvgpr_read_b32 v131, a35
v_mfma_f32_16x16x32_bf16 a[84:87], v[180:183], v[216:219], a[84:87]
v_cvt_pk_bf16_f32 v20, v128, v129
v_cvt_pk_bf16_f32 v21, v130, v131
v_accvgpr_read_b32 v136, a36
v_mfma_f32_16x16x32_bf16 a[84:87], v[32:35], v[220:223], a[84:87]
v_accvgpr_read_b32 v137, a37
v_accvgpr_read_b32 v138, a38
v_accvgpr_read_b32 v139, a39
v_mfma_f32_16x16x32_bf16 a[88:91], v[184:187], v[216:219], a[88:91]
v_cvt_pk_bf16_f32 v52, v136, v137
v_cvt_pk_bf16_f32 v53, v138, v139
v_accvgpr_read_b32 v144, a40
v_mfma_f32_16x16x32_bf16 a[88:91], v[64:67], v[220:223], a[88:91]
v_accvgpr_read_b32 v145, a41
v_accvgpr_read_b32 v146, a42
v_accvgpr_read_b32 v147, a43
v_mfma_f32_16x16x32_bf16 a[92:95], v[188:191], v[216:219], a[92:95]
ds_read_b64_tr_b16 v[216:217], v12 offset:20992
ds_read_b64_tr_b16 v[218:219], v12 offset:23040
v_cvt_pk_bf16_f32 v84, v144, v145
v_mfma_f32_16x16x32_bf16 a[92:95], v[96:99], v[220:223], a[92:95]
ds_read_b64_tr_b16 v[220:221], v14 offset:4608
s_waitcnt lgkmcnt(3)
v_cvt_pk_bf16_f32 v85, v146, v147
v_mfma_f32_16x16x32_bf16 a[96:99], v[8:11], v[208:211], a[96:99]
ds_read_b64_tr_b16 v[222:223], v14 offset:6656
v_accvgpr_read_b32 v152, a44
v_accvgpr_read_b32 v153, a45
v_mfma_f32_16x16x32_bf16 a[96:99], v[160:163], v[212:215], a[96:99]
v_accvgpr_read_b32 v154, a46
v_accvgpr_read_b32 v155, a47
v_cvt_pk_bf16_f32 v116, v152, v153
v_mfma_f32_16x16x32_bf16 a[100:103], v[40:43], v[208:211], a[100:103]
v_cvt_pk_bf16_f32 v117, v154, v155
v_accvgpr_read_b32 v132, a48
v_accvgpr_read_b32 v133, a49
v_mfma_f32_16x16x32_bf16 a[100:103], v[164:167], v[212:215], a[100:103]
v_accvgpr_read_b32 v134, a50
v_accvgpr_read_b32 v135, a51
v_cvt_pk_bf16_f32 v22, v132, v133
v_mfma_f32_16x16x32_bf16 a[104:107], v[72:75], v[208:211], a[104:107]
v_cvt_pk_bf16_f32 v23, v134, v135
buffer_store_dwordx4 v[20:23], v243, s[20:23], s40 offen offset:1024 sc1
ds_write_b128 v231, v[20:23] offset:1024
v_mfma_f32_16x16x32_bf16 a[104:107], v[168:171], v[212:215], a[104:107]
v_accvgpr_read_b32 v140, a52
v_accvgpr_read_b32 v141, a53
v_accvgpr_read_b32 v142, a54
v_mfma_f32_16x16x32_bf16 a[108:111], v[104:107], v[208:211], a[108:111]
ds_read_b64_tr_b16 v[208:209], v247 offset:20992
ds_read_b64_tr_b16 v[210:211], v247 offset:23040
v_accvgpr_read_b32 v143, a55
v_mfma_f32_16x16x32_bf16 a[108:111], v[172:175], v[212:215], a[108:111]
ds_read_b64_tr_b16 v[212:213], v13 offset:4608
s_waitcnt lgkmcnt(3)
v_cvt_pk_bf16_f32 v54, v140, v141
v_mfma_f32_16x16x32_bf16 a[96:99], v[176:179], v[216:219], a[96:99]
ds_read_b64_tr_b16 v[214:215], v13 offset:6656
v_cvt_pk_bf16_f32 v55, v142, v143
buffer_store_dwordx4 v[52:55], v243, s[20:23], s41 offen offset:1024 sc1
v_mfma_f32_16x16x32_bf16 a[96:99], v[0:3], v[220:223], a[96:99]
v_accvgpr_read_b32 v148, a56
v_accvgpr_read_b32 v149, a57
v_accvgpr_read_b32 v150, a58
v_mfma_f32_16x16x32_bf16 a[100:103], v[180:183], v[216:219], a[100:103]
v_accvgpr_read_b32 v151, a59
v_cvt_pk_bf16_f32 v86, v148, v149
v_cvt_pk_bf16_f32 v87, v150, v151
v_mfma_f32_16x16x32_bf16 a[100:103], v[32:35], v[220:223], a[100:103]
buffer_store_dwordx4 v[84:87], v243, s[20:23], s42 offen offset:1024 sc1
v_accvgpr_read_b32 v156, a60
v_accvgpr_read_b32 v157, a61
v_mfma_f32_16x16x32_bf16 a[104:107], v[184:187], v[216:219], a[104:107]
v_accvgpr_read_b32 v158, a62
v_accvgpr_read_b32 v159, a63
v_cvt_pk_bf16_f32 v118, v156, v157
v_mfma_f32_16x16x32_bf16 a[104:107], v[64:67], v[220:223], a[104:107]
v_cvt_pk_bf16_f32 v119, v158, v159
buffer_store_dwordx4 v[116:119], v243, s[20:23], s43 offen offset:1024 sc1
v_accvgpr_read_b32 v128, a64
v_mfma_f32_16x16x32_bf16 a[108:111], v[188:191], v[216:219], a[108:111]
ds_read_b64_tr_b16 v[216:217], v13 offset:20992
ds_read_b64_tr_b16 v[218:219], v13 offset:23040
v_accvgpr_read_b32 v129, a65
v_mfma_f32_16x16x32_bf16 a[108:111], v[96:99], v[220:223], a[108:111]
ds_read_b64_tr_b16 v[220:221], v15 offset:4608
s_waitcnt lgkmcnt(3)
v_accvgpr_read_b32 v130, a66
v_mfma_f32_16x16x32_bf16 a[112:115], v[8:11], v[208:211], a[112:115]
ds_read_b64_tr_b16 v[222:223], v15 offset:6656
v_accvgpr_read_b32 v131, a67
v_cvt_pk_bf16_f32 v24, v128, v129
v_mfma_f32_16x16x32_bf16 a[112:115], v[160:163], v[212:215], a[112:115]
v_cvt_pk_bf16_f32 v25, v130, v131
v_accvgpr_read_b32 v136, a68
v_accvgpr_read_b32 v137, a69
v_mfma_f32_16x16x32_bf16 a[116:119], v[40:43], v[208:211], a[116:119]
v_accvgpr_read_b32 v138, a70
v_accvgpr_read_b32 v139, a71
v_cvt_pk_bf16_f32 v56, v136, v137
v_mfma_f32_16x16x32_bf16 a[116:119], v[164:167], v[212:215], a[116:119]
v_cvt_pk_bf16_f32 v57, v138, v139
v_accvgpr_read_b32 v144, a72
v_accvgpr_read_b32 v145, a73
v_mfma_f32_16x16x32_bf16 a[120:123], v[72:75], v[208:211], a[120:123]
v_accvgpr_read_b32 v146, a74
v_accvgpr_read_b32 v147, a75
v_cvt_pk_bf16_f32 v88, v144, v145
v_mfma_f32_16x16x32_bf16 a[120:123], v[168:171], v[212:215], a[120:123]
v_cvt_pk_bf16_f32 v89, v146, v147
v_accvgpr_read_b32 v152, a76
v_accvgpr_read_b32 v153, a77
v_mfma_f32_16x16x32_bf16 a[124:127], v[104:107], v[208:211], a[124:127]
ds_read_b64_tr_b16 v[208:209], v246 offset:8192
ds_read_b64_tr_b16 v[210:211], v246 offset:10240
v_accvgpr_read_b32 v154, a78
v_mfma_f32_16x16x32_bf16 a[124:127], v[172:175], v[212:215], a[124:127]
ds_read_b64_tr_b16 v[212:213], v246 offset:24576
s_waitcnt lgkmcnt(3)
v_accvgpr_read_b32 v155, a79
v_mfma_f32_16x16x32_bf16 a[112:115], v[176:179], v[216:219], a[112:115]
ds_read_b64_tr_b16 v[214:215], v246 offset:26624
v_cvt_pk_bf16_f32 v120, v152, v153
v_cvt_pk_bf16_f32 v121, v154, v155
v_mfma_f32_16x16x32_bf16 a[112:115], v[0:3], v[220:223], a[112:115]
v_accvgpr_read_b32 v132, a80
v_accvgpr_read_b32 v133, a81
v_accvgpr_read_b32 v134, a82
v_mfma_f32_16x16x32_bf16 a[116:119], v[180:183], v[216:219], a[116:119]
v_accvgpr_read_b32 v135, a83
v_cvt_pk_bf16_f32 v26, v132, v133
v_cvt_pk_bf16_f32 v27, v134, v135
v_mfma_f32_16x16x32_bf16 a[116:119], v[32:35], v[220:223], a[116:119]
buffer_store_dwordx4 v[24:27], v243, s[20:23], s40 offen offset:2048 sc1
ds_write_b128 v231, v[24:27] offset:2048
v_accvgpr_read_b32 v140, a84
v_mfma_f32_16x16x32_bf16 a[120:123], v[184:187], v[216:219], a[120:123]
v_accvgpr_read_b32 v141, a85
v_accvgpr_read_b32 v142, a86
v_accvgpr_read_b32 v143, a87
v_mfma_f32_16x16x32_bf16 a[120:123], v[64:67], v[220:223], a[120:123]
v_cvt_pk_bf16_f32 v58, v140, v141
v_cvt_pk_bf16_f32 v59, v142, v143
buffer_store_dwordx4 v[56:59], v243, s[20:23], s41 offen offset:2048 sc1
v_mfma_f32_16x16x32_bf16 a[124:127], v[188:191], v[216:219], a[124:127]
ds_read_b64_tr_b16 v[216:217], v12 offset:8192
ds_read_b64_tr_b16 v[218:219], v12 offset:10240
v_accvgpr_read_b32 v148, a88
v_mfma_f32_16x16x32_bf16 a[124:127], v[96:99], v[220:223], a[124:127]
ds_read_b64_tr_b16 v[220:221], v12 offset:24576
s_waitcnt lgkmcnt(3)
v_accvgpr_read_b32 v149, a89
v_mfma_f32_16x16x32_bf16 a[128:131], v[4:7], v[208:211], a[128:131]
ds_read_b64_tr_b16 v[222:223], v12 offset:26624
v_accvgpr_read_b32 v150, a90
v_accvgpr_read_b32 v151, a91
v_mfma_f32_16x16x32_bf16 a[128:131], v[8:11], v[212:215], a[128:131]
v_cvt_pk_bf16_f32 v90, v148, v149
v_cvt_pk_bf16_f32 v91, v150, v151
buffer_store_dwordx4 v[88:91], v243, s[20:23], s42 offen offset:2048 sc1
v_mfma_f32_16x16x32_bf16 a[132:135], v[36:39], v[208:211], a[132:135]
v_accvgpr_read_b32 v156, a92
v_accvgpr_read_b32 v157, a93
v_accvgpr_read_b32 v158, a94
v_mfma_f32_16x16x32_bf16 a[132:135], v[40:43], v[212:215], a[132:135]
v_accvgpr_read_b32 v159, a95
v_cvt_pk_bf16_f32 v122, v156, v157
v_cvt_pk_bf16_f32 v123, v158, v159
v_mfma_f32_16x16x32_bf16 a[136:139], v[68:71], v[208:211], a[136:139]
buffer_store_dwordx4 v[120:123], v243, s[20:23], s43 offen offset:2048 sc1
v_accvgpr_read_b32 v128, a96
v_mfma_f32_16x16x32_bf16 a[136:139], v[72:75], v[212:215], a[136:139]
v_accvgpr_read_b32 v129, a97
v_accvgpr_read_b32 v130, a98
v_mfma_f32_16x16x32_bf16 a[140:143], v[100:103], v[208:211], a[140:143]
ds_read_b64_tr_b16 v[208:209], v14 offset:8192
ds_read_b64_tr_b16 v[210:211], v14 offset:10240
v_mfma_f32_16x16x32_bf16 a[140:143], v[104:107], v[212:215], a[140:143]
ds_read_b64_tr_b16 v[212:213], v247 offset:8192
s_waitcnt lgkmcnt(3)
v_mfma_f32_16x16x32_bf16 a[128:131], v[160:163], v[216:219], a[128:131]
ds_read_b64_tr_b16 v[214:215], v247 offset:10240
v_accvgpr_read_b32 v131, a99
v_mfma_f32_16x16x32_bf16 a[128:131], v[176:179], v[220:223], a[128:131]
v_cvt_pk_bf16_f32 v28, v128, v129
v_cvt_pk_bf16_f32 v29, v130, v131
v_mfma_f32_16x16x32_bf16 a[132:135], v[164:167], v[216:219], a[132:135]
v_accvgpr_read_b32 v136, a100
v_accvgpr_read_b32 v137, a101
v_mfma_f32_16x16x32_bf16 a[132:135], v[180:183], v[220:223], a[132:135]
v_accvgpr_read_b32 v138, a102
v_accvgpr_read_b32 v139, a103
v_mfma_f32_16x16x32_bf16 a[136:139], v[168:171], v[216:219], a[136:139]
v_cvt_pk_bf16_f32 v60, v136, v137
v_cvt_pk_bf16_f32 v61, v138, v139
v_mfma_f32_16x16x32_bf16 a[136:139], v[184:187], v[220:223], a[136:139]
v_accvgpr_read_b32 v144, a104
v_accvgpr_read_b32 v145, a105
v_mfma_f32_16x16x32_bf16 a[140:143], v[172:175], v[216:219], a[140:143]
ds_read_b64_tr_b16 v[216:217], v247 offset:24576
ds_read_b64_tr_b16 v[218:219], v247 offset:26624
v_mfma_f32_16x16x32_bf16 a[140:143], v[188:191], v[220:223], a[140:143]
ds_read_b64_tr_b16 v[220:221], v13 offset:8192
s_waitcnt lgkmcnt(5)
v_mfma_f32_16x16x32_bf16 a[128:131], v[0:3], v[208:211], a[128:131]
ds_read_b64_tr_b16 v[222:223], v13 offset:10240
v_accvgpr_read_b32 v146, a106
v_mfma_f32_16x16x32_bf16 a[132:135], v[32:35], v[208:211], a[132:135]
v_accvgpr_read_b32 v147, a107
v_cvt_pk_bf16_f32 v92, v144, v145
v_mfma_f32_16x16x32_bf16 a[136:139], v[64:67], v[208:211], a[136:139]
v_cvt_pk_bf16_f32 v93, v146, v147
v_accvgpr_read_b32 v152, a108
v_mfma_f32_16x16x32_bf16 a[140:143], v[96:99], v[208:211], a[140:143]
ds_read_b64_tr_b16 v[208:209], v13 offset:24576
s_waitcnt lgkmcnt(5)
v_mfma_f32_16x16x32_bf16 a[144:147], v[4:7], v[212:215], a[144:147]
ds_read_b64_tr_b16 v[210:211], v13 offset:26624
v_accvgpr_read_b32 v153, a109
v_mfma_f32_16x16x32_bf16 a[148:151], v[36:39], v[212:215], a[148:151]
v_accvgpr_read_b32 v154, a110
v_accvgpr_read_b32 v155, a111
v_mfma_f32_16x16x32_bf16 a[152:155], v[68:71], v[212:215], a[152:155]
v_cvt_pk_bf16_f32 v124, v152, v153
v_cvt_pk_bf16_f32 v125, v154, v155
v_mfma_f32_16x16x32_bf16 a[156:159], v[100:103], v[212:215], a[156:159]
ds_read_b64_tr_b16 v[212:213], v15 offset:8192
s_waitcnt lgkmcnt(3)
v_mfma_f32_16x16x32_bf16 a[144:147], v[8:11], v[216:219], a[144:147]
ds_read_b64_tr_b16 v[214:215], v15 offset:10240
v_accvgpr_read_b32 v132, a112
v_mfma_f32_16x16x32_bf16 a[144:147], v[160:163], v[220:223], a[144:147]
v_accvgpr_read_b32 v133, a113
v_accvgpr_read_b32 v134, a114
v_mfma_f32_16x16x32_bf16 a[148:151], v[40:43], v[216:219], a[148:151]
v_accvgpr_read_b32 v135, a115
v_cvt_pk_bf16_f32 v30, v132, v133
v_mfma_f32_16x16x32_bf16 a[148:151], v[164:167], v[220:223], a[148:151]
v_cvt_pk_bf16_f32 v31, v134, v135
buffer_store_dwordx4 v[28:31], v243, s[20:23], s40 offen offset:3072 sc1
v_mfma_f32_16x16x32_bf16 a[152:155], v[72:75], v[216:219], a[152:155]
ds_write_b128 v231, v[28:31] offset:3072
v_accvgpr_read_b32 v140, a116
v_mfma_f32_16x16x32_bf16 a[152:155], v[168:171], v[220:223], a[152:155]
v_accvgpr_read_b32 v141, a117
v_accvgpr_read_b32 v142, a118
v_mfma_f32_16x16x32_bf16 a[156:159], v[104:107], v[216:219], a[156:159]
ds_read_b64_tr_b16 v[216:217], v246 offset:8704
ds_read_b64_tr_b16 v[218:219], v246 offset:10752
v_mfma_f32_16x16x32_bf16 a[156:159], v[172:175], v[220:223], a[156:159]
ds_read_b64_tr_b16 v[220:221], v246 offset:25088
s_waitcnt lgkmcnt(3)
v_mfma_f32_16x16x32_bf16 a[144:147], v[176:179], v[208:211], a[144:147]
ds_read_b64_tr_b16 v[222:223], v246 offset:27136
v_accvgpr_read_b32 v143, a119
v_mfma_f32_16x16x32_bf16 a[144:147], v[0:3], v[212:215], a[144:147]
v_cvt_pk_bf16_f32 v62, v140, v141
v_cvt_pk_bf16_f32 v63, v142, v143
v_mfma_f32_16x16x32_bf16 a[148:151], v[180:183], v[208:211], a[148:151]
buffer_store_dwordx4 v[60:63], v243, s[20:23], s41 offen offset:3072 sc1
v_accvgpr_read_b32 v148, a120
v_mfma_f32_16x16x32_bf16 a[148:151], v[32:35], v[212:215], a[148:151]
v_accvgpr_read_b32 v149, a121
v_accvgpr_read_b32 v150, a122
v_mfma_f32_16x16x32_bf16 a[152:155], v[184:187], v[208:211], a[152:155]
v_accvgpr_read_b32 v151, a123
v_cvt_pk_bf16_f32 v94, v148, v149
v_mfma_f32_16x16x32_bf16 a[152:155], v[64:67], v[212:215], a[152:155]
v_cvt_pk_bf16_f32 v95, v150, v151
buffer_store_dwordx4 v[92:95], v243, s[20:23], s42 offen offset:3072 sc1
v_mfma_f32_16x16x32_bf16 a[156:159], v[188:191], v[208:211], a[156:159]
ds_read_b64_tr_b16 v[208:209], v12 offset:8704
ds_read_b64_tr_b16 v[210:211], v12 offset:10752
v_mfma_f32_16x16x32_bf16 a[156:159], v[96:99], v[212:215], a[156:159]
ds_read_b64_tr_b16 v[212:213], v12 offset:25088
s_waitcnt lgkmcnt(3)
v_mfma_f32_16x16x32_bf16 a[160:163], v[4:7], v[216:219], a[160:163]
ds_read_b64_tr_b16 v[214:215], v12 offset:27136
v_accvgpr_read_b32 v156, a124
v_mfma_f32_16x16x32_bf16 a[160:163], v[8:11], v[220:223], a[160:163]
v_accvgpr_read_b32 v157, a125
v_accvgpr_read_b32 v158, a126
v_mfma_f32_16x16x32_bf16 a[164:167], v[36:39], v[216:219], a[164:167]
v_accvgpr_read_b32 v159, a127
v_cvt_pk_bf16_f32 v126, v156, v157
v_mfma_f32_16x16x32_bf16 a[164:167], v[40:43], v[220:223], a[164:167]
v_cvt_pk_bf16_f32 v127, v158, v159
buffer_store_dwordx4 v[124:127], v243, s[20:23], s43 offen offset:3072 sc1
v_mfma_f32_16x16x32_bf16 a[168:171], v[68:71], v[216:219], a[168:171]
v_accvgpr_read_b32 v128, a128
v_accvgpr_read_b32 v129, a129
v_mfma_f32_16x16x32_bf16 a[168:171], v[72:75], v[220:223], a[168:171]
v_accvgpr_read_b32 v130, a130
v_accvgpr_read_b32 v131, a131
v_mfma_f32_16x16x32_bf16 a[172:175], v[100:103], v[216:219], a[172:175]
ds_read_b64_tr_b16 v[216:217], v14 offset:8704
ds_read_b64_tr_b16 v[218:219], v14 offset:10752
v_mfma_f32_16x16x32_bf16 a[172:175], v[104:107], v[220:223], a[172:175]
ds_read_b64_tr_b16 v[220:221], v247 offset:8704
s_waitcnt lgkmcnt(3)
v_mfma_f32_16x16x32_bf16 a[160:163], v[160:163], v[208:211], a[160:163]
ds_read_b64_tr_b16 v[222:223], v247 offset:10752
v_cvt_pk_bf16_f32 v16, v128, v129
v_mfma_f32_16x16x32_bf16 a[160:163], v[176:179], v[212:215], a[160:163]
v_cvt_pk_bf16_f32 v17, v130, v131
v_accvgpr_read_b32 v136, a132
v_mfma_f32_16x16x32_bf16 a[164:167], v[164:167], v[208:211], a[164:167]
v_accvgpr_read_b32 v137, a133
v_accvgpr_read_b32 v138, a134
v_mfma_f32_16x16x32_bf16 a[164:167], v[180:183], v[212:215], a[164:167]
v_accvgpr_read_b32 v139, a135
v_cvt_pk_bf16_f32 v48, v136, v137
v_mfma_f32_16x16x32_bf16 a[168:171], v[168:171], v[208:211], a[168:171]
v_cvt_pk_bf16_f32 v49, v138, v139
v_accvgpr_read_b32 v144, a136
v_mfma_f32_16x16x32_bf16 a[168:171], v[184:187], v[212:215], a[168:171]
v_accvgpr_read_b32 v145, a137
v_accvgpr_read_b32 v146, a138
v_mfma_f32_16x16x32_bf16 a[172:175], v[172:175], v[208:211], a[172:175]
ds_read_b64_tr_b16 v[208:209], v247 offset:25088
ds_read_b64_tr_b16 v[210:211], v247 offset:27136
v_mfma_f32_16x16x32_bf16 a[172:175], v[188:191], v[212:215], a[172:175]
ds_read_b64_tr_b16 v[212:213], v13 offset:8704
s_waitcnt lgkmcnt(5)
v_mfma_f32_16x16x32_bf16 a[160:163], v[0:3], v[216:219], a[160:163]
ds_read_b64_tr_b16 v[214:215], v13 offset:10752
v_accvgpr_read_b32 v147, a139
v_mfma_f32_16x16x32_bf16 a[164:167], v[32:35], v[216:219], a[164:167]
v_cvt_pk_bf16_f32 v80, v144, v145
v_cvt_pk_bf16_f32 v81, v146, v147
v_mfma_f32_16x16x32_bf16 a[168:171], v[64:67], v[216:219], a[168:171]
v_accvgpr_read_b32 v152, a140
v_accvgpr_read_b32 v153, a141
v_mfma_f32_16x16x32_bf16 a[172:175], v[96:99], v[216:219], a[172:175]
ds_read_b64_tr_b16 v[216:217], v13 offset:25088
s_waitcnt lgkmcnt(5)
v_mfma_f32_16x16x32_bf16 a[176:179], v[4:7], v[220:223], a[176:179]
ds_read_b64_tr_b16 v[218:219], v13 offset:27136
v_accvgpr_read_b32 v154, a142
v_mfma_f32_16x16x32_bf16 a[180:183], v[36:39], v[220:223], a[180:183]
v_accvgpr_read_b32 v155, a143
v_cvt_pk_bf16_f32 v112, v152, v153
v_mfma_f32_16x16x32_bf16 a[184:187], v[68:71], v[220:223], a[184:187]
v_cvt_pk_bf16_f32 v113, v154, v155
v_accvgpr_read_b32 v132, a144
v_mfma_f32_16x16x32_bf16 a[188:191], v[100:103], v[220:223], a[188:191]
ds_read_b64_tr_b16 v[220:221], v15 offset:8704
s_waitcnt lgkmcnt(3)
v_mfma_f32_16x16x32_bf16 a[176:179], v[8:11], v[208:211], a[176:179]
ds_read_b64_tr_b16 v[222:223], v15 offset:10752
v_accvgpr_read_b32 v133, a145
v_mfma_f32_16x16x32_bf16 a[176:179], v[160:163], v[212:215], a[176:179]
v_accvgpr_read_b32 v134, a146
v_accvgpr_read_b32 v135, a147
v_mfma_f32_16x16x32_bf16 a[180:183], v[40:43], v[208:211], a[180:183]
v_cvt_pk_bf16_f32 v18, v132, v133
v_cvt_pk_bf16_f32 v19, v134, v135
v_mfma_f32_16x16x32_bf16 a[180:183], v[164:167], v[212:215], a[180:183]
buffer_store_dwordx4 v[16:19], v243, s[20:23], s44 offen offset:0 sc1
ds_write_b128 v231, v[16:19] offset:4096
v_mfma_f32_16x16x32_bf16 a[184:187], v[72:75], v[208:211], a[184:187]
v_accvgpr_read_b32 v140, a148
v_accvgpr_read_b32 v141, a149
v_mfma_f32_16x16x32_bf16 a[184:187], v[168:171], v[212:215], a[184:187]
v_accvgpr_read_b32 v142, a150
v_accvgpr_read_b32 v143, a151
v_mfma_f32_16x16x32_bf16 a[188:191], v[104:107], v[208:211], a[188:191]
ds_read_b64_tr_b16 v[208:209], v246 offset:12288
ds_read_b64_tr_b16 v[210:211], v246 offset:14336
v_mfma_f32_16x16x32_bf16 a[188:191], v[172:175], v[212:215], a[188:191]
ds_read_b64_tr_b16 v[212:213], v246 offset:28672
s_waitcnt lgkmcnt(3)
v_mfma_f32_16x16x32_bf16 a[176:179], v[176:179], v[216:219], a[176:179]
ds_read_b64_tr_b16 v[214:215], v246 offset:30720
v_cvt_pk_bf16_f32 v50, v140, v141
v_mfma_f32_16x16x32_bf16 a[176:179], v[0:3], v[220:223], a[176:179]
v_cvt_pk_bf16_f32 v51, v142, v143
buffer_store_dwordx4 v[48:51], v243, s[20:23], s45 offen offset:0 sc1
v_mfma_f32_16x16x32_bf16 a[180:183], v[180:183], v[216:219], a[180:183]
v_accvgpr_read_b32 v148, a152
v_accvgpr_read_b32 v149, a153
v_mfma_f32_16x16x32_bf16 a[180:183], v[32:35], v[220:223], a[180:183]
v_accvgpr_read_b32 v150, a154
v_accvgpr_read_b32 v151, a155
v_mfma_f32_16x16x32_bf16 a[184:187], v[184:187], v[216:219], a[184:187]
v_cvt_pk_bf16_f32 v82, v148, v149
v_cvt_pk_bf16_f32 v83, v150, v151
v_mfma_f32_16x16x32_bf16 a[184:187], v[64:67], v[220:223], a[184:187]
buffer_store_dwordx4 v[80:83], v243, s[20:23], s46 offen offset:0 sc1
v_accvgpr_read_b32 v156, a156
v_mfma_f32_16x16x32_bf16 a[188:191], v[188:191], v[216:219], a[188:191]
ds_read_b64_tr_b16 v[216:217], v12 offset:12288
ds_read_b64_tr_b16 v[218:219], v12 offset:14336
v_mfma_f32_16x16x32_bf16 a[188:191], v[96:99], v[220:223], a[188:191]
ds_read_b64_tr_b16 v[220:221], v12 offset:28672
s_waitcnt lgkmcnt(3)
v_mfma_f32_16x16x32_bf16 a[192:195], v[4:7], v[208:211], a[192:195]
ds_read_b64_tr_b16 v[222:223], v12 offset:30720
v_accvgpr_read_b32 v157, a157
v_mfma_f32_16x16x32_bf16 a[192:195], v[8:11], v[212:215], a[192:195]
v_accvgpr_read_b32 v158, a158
v_accvgpr_read_b32 v159, a159
v_mfma_f32_16x16x32_bf16 a[196:199], v[36:39], v[208:211], a[196:199]
v_cvt_pk_bf16_f32 v114, v156, v157
v_cvt_pk_bf16_f32 v115, v158, v159
v_mfma_f32_16x16x32_bf16 a[196:199], v[40:43], v[212:215], a[196:199]
buffer_store_dwordx4 v[112:115], v243, s[20:23], s47 offen offset:0 sc1
v_accvgpr_read_b32 v128, a160
v_mfma_f32_16x16x32_bf16 a[200:203], v[68:71], v[208:211], a[200:203]
v_accvgpr_read_b32 v129, a161
v_accvgpr_read_b32 v130, a162
v_mfma_f32_16x16x32_bf16 a[200:203], v[72:75], v[212:215], a[200:203]
v_accvgpr_read_b32 v131, a163
v_cvt_pk_bf16_f32 v20, v128, v129
v_mfma_f32_16x16x32_bf16 a[204:207], v[100:103], v[208:211], a[204:207]
ds_read_b64_tr_b16 v[208:209], v14 offset:12288
ds_read_b64_tr_b16 v[210:211], v14 offset:14336
v_mfma_f32_16x16x32_bf16 a[204:207], v[104:107], v[212:215], a[204:207]
ds_read_b64_tr_b16 v[212:213], v247 offset:12288
s_waitcnt lgkmcnt(3)
v_mfma_f32_16x16x32_bf16 a[192:195], v[160:163], v[216:219], a[192:195]
ds_read_b64_tr_b16 v[214:215], v247 offset:14336
v_cvt_pk_bf16_f32 v21, v130, v131
v_mfma_f32_16x16x32_bf16 a[192:195], v[176:179], v[220:223], a[192:195]
v_accvgpr_read_b32 v136, a164
v_accvgpr_read_b32 v137, a165
v_mfma_f32_16x16x32_bf16 a[196:199], v[164:167], v[216:219], a[196:199]
v_accvgpr_read_b32 v138, a166
v_accvgpr_read_b32 v139, a167
v_mfma_f32_16x16x32_bf16 a[196:199], v[180:183], v[220:223], a[196:199]
v_cvt_pk_bf16_f32 v52, v136, v137
v_cvt_pk_bf16_f32 v53, v138, v139
v_mfma_f32_16x16x32_bf16 a[200:203], v[168:171], v[216:219], a[200:203]
v_accvgpr_read_b32 v144, a168
v_accvgpr_read_b32 v145, a169
v_mfma_f32_16x16x32_bf16 a[200:203], v[184:187], v[220:223], a[200:203]
v_accvgpr_read_b32 v146, a170
v_accvgpr_read_b32 v147, a171
v_mfma_f32_16x16x32_bf16 a[204:207], v[172:175], v[216:219], a[204:207]
ds_read_b64_tr_b16 v[216:217], v247 offset:28672
ds_read_b64_tr_b16 v[218:219], v247 offset:30720
v_mfma_f32_16x16x32_bf16 a[204:207], v[188:191], v[220:223], a[204:207]
ds_read_b64_tr_b16 v[220:221], v13 offset:12288
s_waitcnt lgkmcnt(5)
v_mfma_f32_16x16x32_bf16 a[192:195], v[0:3], v[208:211], a[192:195]
ds_read_b64_tr_b16 v[222:223], v13 offset:14336
v_cvt_pk_bf16_f32 v84, v144, v145
v_mfma_f32_16x16x32_bf16 a[196:199], v[32:35], v[208:211], a[196:199]
v_cvt_pk_bf16_f32 v85, v146, v147
v_accvgpr_read_b32 v152, a172
v_mfma_f32_16x16x32_bf16 a[200:203], v[64:67], v[208:211], a[200:203]
v_accvgpr_read_b32 v153, a173
v_accvgpr_read_b32 v154, a174
v_mfma_f32_16x16x32_bf16 a[204:207], v[96:99], v[208:211], a[204:207]
ds_read_b64_tr_b16 v[208:209], v13 offset:28672
s_waitcnt lgkmcnt(5)
v_mfma_f32_16x16x32_bf16 a[208:211], v[4:7], v[212:215], a[208:211]
ds_read_b64_tr_b16 v[210:211], v13 offset:30720
v_accvgpr_read_b32 v155, a175
v_mfma_f32_16x16x32_bf16 a[212:215], v[36:39], v[212:215], a[212:215]
v_cvt_pk_bf16_f32 v116, v152, v153
v_cvt_pk_bf16_f32 v117, v154, v155
v_mfma_f32_16x16x32_bf16 a[216:219], v[68:71], v[212:215], a[216:219]
v_accvgpr_read_b32 v132, a176
v_accvgpr_read_b32 v133, a177
v_mfma_f32_16x16x32_bf16 a[220:223], v[100:103], v[212:215], a[220:223]
ds_read_b64_tr_b16 v[212:213], v15 offset:12288
s_waitcnt lgkmcnt(3)
v_mfma_f32_16x16x32_bf16 a[208:211], v[8:11], v[216:219], a[208:211]
ds_read_b64_tr_b16 v[214:215], v15 offset:14336
v_accvgpr_read_b32 v134, a178
v_mfma_f32_16x16x32_bf16 a[208:211], v[160:163], v[220:223], a[208:211]
v_accvgpr_read_b32 v135, a179
v_cvt_pk_bf16_f32 v22, v132, v133
v_mfma_f32_16x16x32_bf16 a[212:215], v[40:43], v[216:219], a[212:215]
v_cvt_pk_bf16_f32 v23, v134, v135
buffer_store_dwordx4 v[20:23], v243, s[20:23], s44 offen offset:1024 sc1
v_mfma_f32_16x16x32_bf16 a[212:215], v[164:167], v[220:223], a[212:215]
ds_write_b128 v231, v[20:23] offset:5120
v_accvgpr_read_b32 v140, a180
v_mfma_f32_16x16x32_bf16 a[216:219], v[72:75], v[216:219], a[216:219]
v_accvgpr_read_b32 v141, a181
v_accvgpr_read_b32 v142, a182
v_mfma_f32_16x16x32_bf16 a[216:219], v[168:171], v[220:223], a[216:219]
v_accvgpr_read_b32 v143, a183
v_cvt_pk_bf16_f32 v54, v140, v141
v_mfma_f32_16x16x32_bf16 a[220:223], v[104:107], v[216:219], a[220:223]
ds_read_b64_tr_b16 v[216:217], v246 offset:12800
ds_read_b64_tr_b16 v[218:219], v246 offset:14848
v_mfma_f32_16x16x32_bf16 a[220:223], v[172:175], v[220:223], a[220:223]
ds_read_b64_tr_b16 v[220:221], v246 offset:29184
s_waitcnt lgkmcnt(3)
v_mfma_f32_16x16x32_bf16 a[208:211], v[176:179], v[208:211], a[208:211]
ds_read_b64_tr_b16 v[222:223], v246 offset:31232
v_cvt_pk_bf16_f32 v55, v142, v143
v_mfma_f32_16x16x32_bf16 a[208:211], v[0:3], v[212:215], a[208:211]
buffer_store_dwordx4 v[52:55], v243, s[20:23], s45 offen offset:1024 sc1
v_accvgpr_read_b32 v148, a184
v_mfma_f32_16x16x32_bf16 a[212:215], v[180:183], v[208:211], a[212:215]
v_accvgpr_read_b32 v149, a185
v_accvgpr_read_b32 v150, a186
v_mfma_f32_16x16x32_bf16 a[212:215], v[32:35], v[212:215], a[212:215]
v_accvgpr_read_b32 v151, a187
v_cvt_pk_bf16_f32 v86, v148, v149
v_mfma_f32_16x16x32_bf16 a[216:219], v[184:187], v[208:211], a[216:219]
v_cvt_pk_bf16_f32 v87, v150, v151
buffer_store_dwordx4 v[84:87], v243, s[20:23], s46 offen offset:1024 sc1
v_mfma_f32_16x16x32_bf16 a[216:219], v[64:67], v[212:215], a[216:219]
v_accvgpr_read_b32 v156, a188
v_accvgpr_read_b32 v157, a189
v_mfma_f32_16x16x32_bf16 a[220:223], v[188:191], v[208:211], a[220:223]
ds_read_b64_tr_b16 v[208:209], v12 offset:12800
ds_read_b64_tr_b16 v[210:211], v12 offset:14848
v_mfma_f32_16x16x32_bf16 a[220:223], v[96:99], v[212:215], a[220:223]
ds_read_b64_tr_b16 v[212:213], v12 offset:29184
s_waitcnt lgkmcnt(3)
v_mfma_f32_16x16x32_bf16 a[224:227], v[4:7], v[216:219], a[224:227]
ds_read_b64_tr_b16 v[214:215], v12 offset:31232
v_accvgpr_read_b32 v158, a190
v_mfma_f32_16x16x32_bf16 a[224:227], v[8:11], v[220:223], a[224:227]
v_accvgpr_read_b32 v159, a191
v_cvt_pk_bf16_f32 v118, v156, v157
v_mfma_f32_16x16x32_bf16 a[228:231], v[36:39], v[216:219], a[228:231]
v_cvt_pk_bf16_f32 v119, v158, v159
buffer_store_dwordx4 v[116:119], v243, s[20:23], s47 offen offset:1024 sc1
v_mfma_f32_16x16x32_bf16 a[228:231], v[40:43], v[220:223], a[228:231]
v_accvgpr_read_b32 v128, a192
v_accvgpr_read_b32 v129, a193
v_mfma_f32_16x16x32_bf16 a[232:235], v[68:71], v[216:219], a[232:235]
v_accvgpr_read_b32 v130, a194
v_accvgpr_read_b32 v131, a195
v_mfma_f32_16x16x32_bf16 a[232:235], v[72:75], v[220:223], a[232:235]
v_cvt_pk_bf16_f32 v24, v128, v129
v_cvt_pk_bf16_f32 v25, v130, v131
v_mfma_f32_16x16x32_bf16 a[236:239], v[100:103], v[216:219], a[236:239]
ds_read_b64_tr_b16 v[216:217], v14 offset:12800
ds_read_b64_tr_b16 v[218:219], v14 offset:14848
v_mfma_f32_16x16x32_bf16 a[236:239], v[104:107], v[220:223], a[236:239]
ds_read_b64_tr_b16 v[220:221], v247 offset:12800
s_waitcnt lgkmcnt(3)
v_mfma_f32_16x16x32_bf16 a[224:227], v[160:163], v[208:211], a[224:227]
ds_read_b64_tr_b16 v[222:223], v247 offset:14848
v_accvgpr_read_b32 v136, a196
v_mfma_f32_16x16x32_bf16 a[224:227], v[176:179], v[212:215], a[224:227]
v_accvgpr_read_b32 v137, a197
v_accvgpr_read_b32 v138, a198
v_mfma_f32_16x16x32_bf16 a[228:231], v[164:167], v[208:211], a[228:231]
v_accvgpr_read_b32 v139, a199
v_cvt_pk_bf16_f32 v56, v136, v137
v_mfma_f32_16x16x32_bf16 a[228:231], v[180:183], v[212:215], a[228:231]
v_cvt_pk_bf16_f32 v57, v138, v139
v_accvgpr_read_b32 v144, a200
v_mfma_f32_16x16x32_bf16 a[232:235], v[168:171], v[208:211], a[232:235]
v_accvgpr_read_b32 v145, a201
v_accvgpr_read_b32 v146, a202
v_mfma_f32_16x16x32_bf16 a[232:235], v[184:187], v[212:215], a[232:235]
v_accvgpr_read_b32 v147, a203
v_cvt_pk_bf16_f32 v88, v144, v145
v_mfma_f32_16x16x32_bf16 a[236:239], v[172:175], v[208:211], a[236:239]
ds_read_b64_tr_b16 v[208:209], v247 offset:29184
ds_read_b64_tr_b16 v[210:211], v247 offset:31232
v_mfma_f32_16x16x32_bf16 a[236:239], v[188:191], v[212:215], a[236:239]
ds_read_b64_tr_b16 v[212:213], v13 offset:12800
s_waitcnt lgkmcnt(5)
v_mfma_f32_16x16x32_bf16 a[224:227], v[0:3], v[216:219], a[224:227]
ds_read_b64_tr_b16 v[214:215], v13 offset:14848
v_cvt_pk_bf16_f32 v89, v146, v147
v_mfma_f32_16x16x32_bf16 a[228:231], v[32:35], v[216:219], a[228:231]
v_accvgpr_read_b32 v152, a204
v_accvgpr_read_b32 v153, a205
v_mfma_f32_16x16x32_bf16 a[232:235], v[64:67], v[216:219], a[232:235]
v_accvgpr_read_b32 v154, a206
v_accvgpr_read_b32 v155, a207
v_mfma_f32_16x16x32_bf16 a[236:239], v[96:99], v[216:219], a[236:239]
ds_read_b64_tr_b16 v[216:217], v13 offset:29184
s_waitcnt lgkmcnt(5)
v_mfma_f32_16x16x32_bf16 a[240:243], v[4:7], v[220:223], a[240:243]
ds_read_b64_tr_b16 v[218:219], v13 offset:31232
v_cvt_pk_bf16_f32 v120, v152, v153
v_mfma_f32_16x16x32_bf16 a[244:247], v[36:39], v[220:223], a[244:247]
v_cvt_pk_bf16_f32 v121, v154, v155
v_accvgpr_read_b32 v132, a208
v_mfma_f32_16x16x32_bf16 a[248:251], v[68:71], v[220:223], a[248:251]
v_accvgpr_read_b32 v133, a209
v_accvgpr_read_b32 v134, a210
v_mfma_f32_16x16x32_bf16 a[252:255], v[100:103], v[220:223], a[252:255]
ds_read_b64_tr_b16 v[220:221], v15 offset:12800
s_waitcnt lgkmcnt(3)
v_mfma_f32_16x16x32_bf16 a[240:243], v[8:11], v[208:211], a[240:243]
ds_read_b64_tr_b16 v[222:223], v15 offset:14848
v_accvgpr_read_b32 v135, a211
v_mfma_f32_16x16x32_bf16 a[240:243], v[160:163], v[212:215], a[240:243]
v_cvt_pk_bf16_f32 v26, v132, v133
v_cvt_pk_bf16_f32 v27, v134, v135
v_mfma_f32_16x16x32_bf16 a[244:247], v[40:43], v[208:211], a[244:247]
buffer_store_dwordx4 v[24:27], v243, s[20:23], s44 offen offset:2048 sc1
ds_write_b128 v231, v[24:27] offset:6144
v_mfma_f32_16x16x32_bf16 a[244:247], v[164:167], v[212:215], a[244:247]
v_accvgpr_read_b32 v140, a212
v_accvgpr_read_b32 v141, a213
v_mfma_f32_16x16x32_bf16 a[248:251], v[72:75], v[208:211], a[248:251]
v_accvgpr_read_b32 v142, a214
v_accvgpr_read_b32 v143, a215
v_mfma_f32_16x16x32_bf16 a[248:251], v[168:171], v[212:215], a[248:251]
v_cvt_pk_bf16_f32 v58, v140, v141
v_cvt_pk_bf16_f32 v59, v142, v143
v_mfma_f32_16x16x32_bf16 a[252:255], v[104:107], v[208:211], a[252:255]
buffer_store_dwordx4 v[56:59], v243, s[20:23], s45 offen offset:2048 sc1
v_accvgpr_read_b32 v148, a216
v_mfma_f32_16x16x32_bf16 a[252:255], v[172:175], v[212:215], a[252:255]
s_waitcnt lgkmcnt(0)
v_accvgpr_read_b32 v149, a217
v_mfma_f32_16x16x32_bf16 a[240:243], v[176:179], v[216:219], a[240:243]
v_accvgpr_read_b32 v150, a218
v_accvgpr_read_b32 v151, a219
v_mfma_f32_16x16x32_bf16 a[240:243], v[0:3], v[220:223], a[240:243]
v_cvt_pk_bf16_f32 v90, v148, v149
v_cvt_pk_bf16_f32 v91, v150, v151
v_mfma_f32_16x16x32_bf16 a[244:247], v[180:183], v[216:219], a[244:247]
buffer_store_dwordx4 v[88:91], v243, s[20:23], s46 offen offset:2048 sc1
v_accvgpr_read_b32 v156, a220
v_mfma_f32_16x16x32_bf16 a[244:247], v[32:35], v[220:223], a[244:247]
v_accvgpr_read_b32 v157, a221
v_accvgpr_read_b32 v158, a222
v_mfma_f32_16x16x32_bf16 a[248:251], v[184:187], v[216:219], a[248:251]
v_accvgpr_read_b32 v159, a223
v_cvt_pk_bf16_f32 v122, v156, v157
v_mfma_f32_16x16x32_bf16 a[248:251], v[64:67], v[220:223], a[248:251]
v_cvt_pk_bf16_f32 v123, v158, v159
buffer_store_dwordx4 v[120:123], v243, s[20:23], s47 offen offset:2048 sc1
v_mfma_f32_16x16x32_bf16 a[252:255], v[188:191], v[216:219], a[252:255]
v_accvgpr_read_b32 v128, a224
v_accvgpr_read_b32 v129, a225
v_mfma_f32_16x16x32_bf16 a[252:255], v[96:99], v[220:223], a[252:255]
v_accvgpr_read_b32 v130, a226
v_accvgpr_read_b32 v131, a227
v_cvt_pk_bf16_f32 v28, v128, v129
v_cvt_pk_bf16_f32 v29, v130, v131
v_accvgpr_read_b32 v136, a228
v_accvgpr_read_b32 v137, a229
v_accvgpr_read_b32 v138, a230
v_accvgpr_read_b32 v139, a231
v_cvt_pk_bf16_f32 v60, v136, v137
v_cvt_pk_bf16_f32 v61, v138, v139
v_accvgpr_read_b32 v144, a232
v_accvgpr_read_b32 v145, a233
v_accvgpr_read_b32 v146, a234
v_accvgpr_read_b32 v147, a235
v_cvt_pk_bf16_f32 v92, v144, v145
v_cvt_pk_bf16_f32 v93, v146, v147
v_accvgpr_read_b32 v152, a236
v_accvgpr_read_b32 v153, a237
v_accvgpr_read_b32 v154, a238
v_accvgpr_read_b32 v155, a239
v_cvt_pk_bf16_f32 v124, v152, v153
v_cvt_pk_bf16_f32 v125, v154, v155
v_accvgpr_read_b32 v132, a240
v_accvgpr_read_b32 v133, a241
v_accvgpr_read_b32 v134, a242
v_accvgpr_read_b32 v135, a243
v_cvt_pk_bf16_f32 v30, v132, v133
v_cvt_pk_bf16_f32 v31, v134, v135
buffer_store_dwordx4 v[28:31], v243, s[20:23], s44 offen offset:3072 sc1
ds_write_b128 v231, v[28:31] offset:7168
v_accvgpr_read_b32 v140, a244
v_accvgpr_read_b32 v141, a245
v_accvgpr_read_b32 v142, a246
v_accvgpr_read_b32 v143, a247
v_cvt_pk_bf16_f32 v62, v140, v141
v_cvt_pk_bf16_f32 v63, v142, v143
buffer_store_dwordx4 v[60:63], v243, s[20:23], s45 offen offset:3072 sc1
v_accvgpr_read_b32 v148, a248
v_accvgpr_read_b32 v149, a249
v_accvgpr_read_b32 v150, a250
v_accvgpr_read_b32 v151, a251
v_cvt_pk_bf16_f32 v94, v148, v149
v_cvt_pk_bf16_f32 v95, v150, v151
buffer_store_dwordx4 v[92:95], v243, s[20:23], s46 offen offset:3072 sc1
v_accvgpr_read_b32 v156, a252
v_accvgpr_read_b32 v157, a253
v_accvgpr_read_b32 v158, a254
v_accvgpr_read_b32 v159, a255
v_cvt_pk_bf16_f32 v126, v156, v157
v_cvt_pk_bf16_f32 v127, v158, v159
buffer_store_dwordx4 v[124:127], v243, s[20:23], s47 offen offset:3072 sc1
s_waitcnt vmcnt(36)
s_branch L2_F
L2_F:
v_cmp_ne_u64 vcc, s[98:99], v[108:109]
s_lshl_b32 s3, s34, 15
s_add_u32 s3, s3, 0x1000000
s_cbranch_vccnz LF_wf
LF_wf_go:
v_add_u32 v240, s3, v243
v_add_u32 v241, 0x4000, v240
s_mov_b32 s32, 0x0
s_mov_b32 s33, 0x1000
s_mov_b32 s35, 0x2000
s_mov_b32 s36, 0x3000
s_mov_b32 s38, 0x20000
s_mov_b32 s39, 0x21000
s_mov_b32 s40, 0x22000
s_mov_b32 s41, 0x23000
s_lshr_b32 s42, s6, 13
s_lshr_b32 s43, s7, 13
s_lshr_b32 s44, s29, 13
v_mov_b32 v244, s42
v_mov_b32 v232, s43
v_cmp_lt_u32 vcc, 0xff, v243
v_mov_b32 v233, s44
s_nop 0
v_cndmask_b32 v244, v244, v232, vcc
v_cmp_lt_u32 vcc, 0x1ff, v243
v_and_b32 v235, 0xf0, v243
s_nop 0
v_cndmask_b32 v244, v244, v233, vcc
v_lshlrev_b32 v244, 11, v244
v_lshl_add_u32 v244, v235, 3, v244
v_lshrrev_b32 v79, 6, v244
buffer_load_ushort v79, v79, s[52:55], 0 offen
buffer_load_dwordx4 a[0:3], v240, s[16:19], s32 offen offset:0 sc1
buffer_load_dwordx4 a[4:7], v240, s[16:19], s32 offen offset:1024 sc1
buffer_load_dwordx4 a[8:11], v241, s[16:19], s32 offen offset:0 sc1
buffer_load_dwordx4 a[12:15], v241, s[16:19], s32 offen offset:1024 sc1
buffer_load_dwordx4 a[16:19], v240, s[16:19], s32 offen offset:2048 sc1
buffer_load_dwordx4 a[20:23], v240, s[16:19], s32 offen offset:3072 sc1
buffer_load_dwordx4 a[24:27], v241, s[16:19], s32 offen offset:2048 sc1
buffer_load_dwordx4 a[28:31], v241, s[16:19], s32 offen offset:3072 sc1
buffer_load_dwordx4 a[32:35], v240, s[16:19], s33 offen offset:0 sc1
buffer_load_dwordx4 a[36:39], v240, s[16:19], s33 offen offset:1024 sc1
buffer_load_dwordx4 a[40:43], v241, s[16:19], s33 offen offset:0 sc1
buffer_load_dwordx4 a[44:47], v241, s[16:19], s33 offen offset:1024 sc1
s_lshl_b32 s3, s37, 3
v_add3_u32 v244, v244, s3, 8
s_cmp_ge_u32 s29, 0x70000000
s_cselect_b32 s44, s43, s44
v_mov_b32 v46, s42
v_mov_b32 v232, s43
v_lshrrev_b32 v233, 7, v243
v_cmp_lt_u32_e64 vcc, 0, v233
s_nop 1
v_cndmask_b32_e64 v46, v46, v232, vcc
v_cmp_lt_u32_e64 vcc, 1, v233
v_mov_b32 v233, s44
v_bfe_u32 v232, v243, 4, 3
v_cndmask_b32_e64 v46, v46, v233, vcc
v_min_u32 v232, 5, v232
v_lshrrev_b32 v46, 2, v46
v_lshl_add_u32 v46, v46, 3, v232
v_lshlrev_b32 v46, 7, v46
v_add_u32 v46, 0x7c00000, v46
s_lshl_b32 s49, s34, 10
s_add_u32 s49, s49, 0x20000
s_bfe_u32 s3, s6, 0x2000f
s_lshl_b32 s3, s3, 13
s_add_u32 s3, s3, s49
v_add_u32 v76, s3, v243
s_bfe_u32 s3, s7, 0x2000f
s_lshl_b32 s3, s3, 13
s_add_u32 s3, s3, s49
v_add_u32 v77, s3, v243
s_bfe_u32 s3, s29, 0x2000f
s_lshl_b32 s3, s3, 13
s_add_u32 s3, s3, s49
v_add_u32 v78, s3, v243
s_add_u32 s3, s37, 1
s_sub_u32 s49, s3, 6
s_cselect_b32 s3, s3, s49
s_mul_i32 s3, s3, 0x600000
s_add_u32 s42, s3, 0x2000000
s_add_u32 s3, s37, 2
s_sub_u32 s49, s3, 6
s_cselect_b32 s3, s3, s49
s_mul_i32 s3, s3, 0x600000
s_add_u32 s43, s3, 0x2000000
s_add_u32 s3, s37, 3
s_sub_u32 s49, s3, 6
s_cselect_b32 s3, s3, s49
s_mul_i32 s3, s3, 0x600000
s_add_u32 s44, s3, 0x2000000
s_add_u32 s3, s37, 4
s_sub_u32 s49, s3, 6
s_cselect_b32 s3, s3, s49
s_mul_i32 s3, s3, 0x600000
s_add_u32 s45, s3, 0x2000000
s_add_u32 s3, s37, 5
s_sub_u32 s49, s3, 6
s_cselect_b32 s3, s3, s49
s_mul_i32 s3, s3, 0x600000
s_add_u32 s46, s3, 0x2000000
s_add_u32 s3, s37, 6
s_sub_u32 s49, s3, 6
s_cselect_b32 s3, s3, s49
s_mul_i32 s3, s3, 0x600000
s_add_u32 s47, s3, 0x2000000
s_mul_i32 s3, s34, 896
v_add_u32 v47, s3, v243
v_add_u32 v43, 0x1000, v47
v_lshrrev_b32 v44, 4, v243
v_and_b32 v44, 0x30, v44
v_xor_b32 v44, v44, v243
v_and_b32 v232, 0x380, v243
v_mad_u32_u24 v44, v232, 3, v44
v_xor_b32 v45, 0x1040, v44
v_bfe_u32 v232, v243, 5, 3
v_lshrrev_b32 v234, 8, v243
v_xor_b32 v232, v232, v234
v_bfe_u32 v233, v243, 4, 3
v_lshlrev_b32 v233, 7, v233
v_lshl_or_b32 v232, v232, 4, v233
v_bfe_u32 v233, v243, 7, 1
s_lshl_b32 s49, s34, 10
s_sub_u32 s3, s28, s49
v_lshl_add_u32 v74, v233, 12, v232
v_add_u32 v72, s3, v74
s_sub_u32 s3, s30, s49
v_add_u32 v74, s3, v74
v_xor_b32 v73, 64, v72
v_xor_b32 v75, 64, v74
v_lshl_add_u32 v245, v233, 10, v232
v_add_u32 v245, s31, v245
v_xor_b32 v246, 64, v245
v_add_u32 v247, s31, v243
s_add_u32 s3, s3, 0xa000
s_and_b32 s3, s3, 0x1ffff
v_add_u32 v252, s3, v243
v_add_u32 v251, s49, v252
s_lshl_b32 s49, s34, 11
s_add_u32 s3, s3, s49
s_add_u32 s3, s3, 24576
v_lshl_add_u32 v242, v243, 1, s3
v_lshl_add_u32 v250, v235, 1, s3
v_lshrrev_b32 v232, 4, v235
v_lshlrev_b32 v234, 2, v234
v_sub_u32 v232, v232, v234
v_and_b32 v233, 1, v232
v_lshlrev_b32 v233, 4, v233
v_mov_b32 v234, 0xffff
v_lshlrev_b32 v233, v233, v234
v_lshrrev_b32 v232, 1, v232
v_cmp_eq_u32 vcc, 0, v232
s_nop 1
v_cndmask_b32 v156, 0, v233, vcc
v_cmp_eq_u32 vcc, 1, v232
s_nop 1
v_cndmask_b32 v157, 0, v233, vcc
s_mov_b32 s95, 0xffff0000
s_waitcnt vmcnt(13)
v_mov_b32 v158, s98
v_mov_b32 v159, s99
s_mov_b64 exec, 1
buffer_store_dwordx2 v[158:159], off, s[16:19], s51 sc1
s_mov_b64 exec, -1
s_waitcnt lgkmcnt(0)
s_barrier
ds_read_b128 v[208:211], v72 offset:0
ds_read_b128 v[212:215], v72 offset:8192
ds_read_b128 v[216:219], v74 offset:0
ds_read_b128 v[220:223], v73 offset:0
ds_read_b128 v[224:227], v73 offset:8192
ds_read_b128 v[104:107], v245 offset:0
ds_read_b128 v[108:111], v246 offset:0
ds_read_b128 v[152:155], v245 offset:2048
s_waitcnt vmcnt(13)
v_lshlrev_b32 v79, 16, v79
ds_write_b32 v242, v79 offset:28
ds_read_b32 v253, v250 offset:28
ds_read_b32 v254, v250 offset:540
ds_read_b32 v255, v250 offset:1052
s_waitcnt vmcnt(12)
buffer_load_dwordx4 a[48:51], v240, s[16:19], s33 offen offset:2048 sc1
s_waitcnt vmcnt(12)
buffer_load_dwordx4 a[52:55], v240, s[16:19], s33 offen offset:3072 sc1
s_waitcnt vmcnt(12)
buffer_load_dwordx4 a[56:59], v241, s[16:19], s33 offen offset:2048 sc1
s_waitcnt vmcnt(12)
s_waitcnt lgkmcnt(11)
v_mfma_f32_16x16x32_bf16 v[160:163], a[0:3], v[208:211], 0
ds_read_b128 v[228:231], v75 offset:0
buffer_load_dwordx4 a[60:63], v241, s[16:19], s33 offen offset:3072 sc1
v_mfma_f32_16x16x32_bf16 v[164:167], a[4:7], v[208:211], 0
v_mfma_f32_16x16x32_bf16 v[168:171], a[8:11], v[208:211], 0
v_mfma_f32_16x16x32_bf16 v[172:175], a[12:15], v[208:211], 0
s_waitcnt vmcnt(12)
s_waitcnt lgkmcnt(11)
v_mfma_f32_16x16x32_bf16 v[176:179], a[0:3], v[212:215], 0
ds_read_b128 v[208:211], v72 offset:1024
buffer_load_dwordx4 a[64:67], v240, s[16:19], s35 offen offset:0 sc1
v_mfma_f32_16x16x32_bf16 v[180:183], a[4:7], v[212:215], 0
v_mfma_f32_16x16x32_bf16 v[184:187], a[8:11], v[212:215], 0
v_mfma_f32_16x16x32_bf16 v[188:191], a[12:15], v[212:215], 0
s_waitcnt vmcnt(12)
s_waitcnt lgkmcnt(11)
v_mfma_f32_16x16x32_bf16 v[192:195], a[0:3], v[216:219], 0
ds_read_b128 v[212:215], v72 offset:9216
buffer_load_dwordx4 a[68:71], v240, s[16:19], s35 offen offset:1024 sc1
v_mfma_f32_16x16x32_bf16 v[196:199], a[4:7], v[216:219], 0
v_mfma_f32_16x16x32_bf16 v[200:203], a[8:11], v[216:219], 0
v_mfma_f32_16x16x32_bf16 v[204:207], a[12:15], v[216:219], 0
s_waitcnt vmcnt(12)
buffer_load_dwordx4 a[72:75], v241, s[16:19], s35 offen offset:0 sc1
s_waitcnt vmcnt(12)
s_waitcnt lgkmcnt(11)
v_mfma_f32_16x16x32_bf16 v[160:163], a[16:19], v[220:223], v[160:163]
ds_read_b128 v[216:219], v74 offset:1024
buffer_load_dwordx4 a[76:79], v241, s[16:19], s35 offen offset:1024 sc1
v_mfma_f32_16x16x32_bf16 v[164:167], a[20:23], v[220:223], v[164:167]
v_mfma_f32_16x16x32_bf16 v[168:171], a[24:27], v[220:223], v[168:171]
v_mfma_f32_16x16x32_bf16 v[172:175], a[28:31], v[220:223], v[172:175]
s_waitcnt vmcnt(12)
s_waitcnt lgkmcnt(11)
v_mfma_f32_16x16x32_bf16 v[176:179], a[16:19], v[224:227], v[176:179]
ds_read_b128 v[220:223], v73 offset:1024
buffer_load_dwordx4 a[80:83], v240, s[16:19], s35 offen offset:2048 sc1
v_mfma_f32_16x16x32_bf16 v[180:183], a[20:23], v[224:227], v[180:183]
v_mfma_f32_16x16x32_bf16 v[184:187], a[24:27], v[224:227], v[184:187]
v_mfma_f32_16x16x32_bf16 v[188:191], a[28:31], v[224:227], v[188:191]
s_waitcnt vmcnt(12)
s_waitcnt lgkmcnt(4)
v_mfma_f32_16x16x32_bf16 v[192:195], a[16:19], v[228:231], v[192:195]
ds_read_b128 v[224:227], v73 offset:9216
buffer_load_dwordx4 a[84:87], v240, s[16:19], s35 offen offset:3072 sc1
v_mfma_f32_16x16x32_bf16 v[196:199], a[20:23], v[228:231], v[196:199]
v_mfma_f32_16x16x32_bf16 v[200:203], a[24:27], v[228:231], v[200:203]
v_mfma_f32_16x16x32_bf16 v[204:207], a[28:31], v[228:231], v[204:207]
s_waitcnt vmcnt(12)
buffer_load_dwordx4 a[88:91], v241, s[16:19], s35 offen offset:2048 sc1
s_waitcnt vmcnt(12)
s_waitcnt lgkmcnt(4)
v_mfma_f32_16x16x32_bf16 v[160:163], a[32:35], v[208:211], v[160:163]
ds_read_b128 v[228:231], v75 offset:1024
buffer_load_dwordx4 a[92:95], v241, s[16:19], s35 offen offset:3072 sc1
v_mfma_f32_16x16x32_bf16 v[164:167], a[36:39], v[208:211], v[164:167]
v_mfma_f32_16x16x32_bf16 v[168:171], a[40:43], v[208:211], v[168:171]
v_mfma_f32_16x16x32_bf16 v[172:175], a[44:47], v[208:211], v[172:175]
s_waitcnt lgkmcnt(4)
v_mfma_f32_16x16x32_bf16 v[176:179], a[32:35], v[212:215], v[176:179]
ds_read_b128 v[208:211], v72 offset:2048
v_mfma_f32_16x16x32_bf16 v[180:183], a[36:39], v[212:215], v[180:183]
v_mfma_f32_16x16x32_bf16 v[184:187], a[40:43], v[212:215], v[184:187]
v_mfma_f32_16x16x32_bf16 v[188:191], a[44:47], v[212:215], v[188:191]
s_waitcnt vmcnt(11)
s_waitcnt lgkmcnt(4)
v_mfma_f32_16x16x32_bf16 v[192:195], a[32:35], v[216:219], v[192:195]
ds_read_b128 v[212:215], v72 offset:10240
buffer_load_dwordx2 v[248:249], v46, s[16:19], 0 offen offset:0 sc1
v_mfma_f32_16x16x32_bf16 v[196:199], a[36:39], v[216:219], v[196:199]
v_mfma_f32_16x16x32_bf16 v[200:203], a[40:43], v[216:219], v[200:203]
v_mfma_f32_16x16x32_bf16 v[204:207], a[44:47], v[216:219], v[204:207]
s_waitcnt vmcnt(11)
buffer_load_dwordx4 a[96:99], v240, s[16:19], s36 offen offset:0 sc1
s_waitcnt vmcnt(11)
buffer_load_dwordx4 a[100:103], v240, s[16:19], s36 offen offset:1024 sc1
s_waitcnt vmcnt(11)
s_waitcnt lgkmcnt(4)
v_mfma_f32_16x16x32_bf16 v[160:163], a[48:51], v[220:223], v[160:163]
ds_read_b128 v[216:219], v74 offset:2048
buffer_load_dwordx4 a[104:107], v241, s[16:19], s36 offen offset:0 sc1
v_mfma_f32_16x16x32_bf16 v[164:167], a[52:55], v[220:223], v[164:167]
v_mfma_f32_16x16x32_bf16 v[168:171], a[56:59], v[220:223], v[168:171]
v_mfma_f32_16x16x32_bf16 v[172:175], a[60:63], v[220:223], v[172:175]
s_waitcnt vmcnt(11)
s_waitcnt lgkmcnt(4)
v_mfma_f32_16x16x32_bf16 v[176:179], a[48:51], v[224:227], v[176:179]
ds_read_b128 v[220:223], v73 offset:2048
buffer_load_dwordx4 a[108:111], v241, s[16:19], s36 offen offset:1024 sc1
v_mfma_f32_16x16x32_bf16 v[180:183], a[52:55], v[224:227], v[180:183]
v_mfma_f32_16x16x32_bf16 v[184:187], a[56:59], v[224:227], v[184:187]
v_mfma_f32_16x16x32_bf16 v[188:191], a[60:63], v[224:227], v[188:191]
s_waitcnt vmcnt(11)
s_waitcnt lgkmcnt(4)
v_mfma_f32_16x16x32_bf16 v[192:195], a[48:51], v[228:231], v[192:195]
ds_read_b128 v[224:227], v73 offset:10240
buffer_load_dwordx4 a[112:115], v240, s[16:19], s36 offen offset:2048 sc1
v_mfma_f32_16x16x32_bf16 v[196:199], a[52:55], v[228:231], v[196:199]
v_mfma_f32_16x16x32_bf16 v[200:203], a[56:59], v[228:231], v[200:203]
v_mfma_f32_16x16x32_bf16 v[204:207], a[60:63], v[228:231], v[204:207]
s_waitcnt vmcnt(11)
buffer_load_dwordx4 a[116:119], v240, s[16:19], s36 offen offset:3072 sc1
s_waitcnt vmcnt(11)
s_waitcnt lgkmcnt(4)
v_mfma_f32_16x16x32_bf16 v[160:163], a[64:67], v[208:211], v[160:163]
ds_read_b128 v[228:231], v75 offset:2048
buffer_load_dwordx4 a[120:123], v241, s[16:19], s36 offen offset:2048 sc1
v_mfma_f32_16x16x32_bf16 v[164:167], a[68:71], v[208:211], v[164:167]
v_mfma_f32_16x16x32_bf16 v[168:171], a[72:75], v[208:211], v[168:171]
v_mfma_f32_16x16x32_bf16 v[172:175], a[76:79], v[208:211], v[172:175]
s_waitcnt vmcnt(11)
s_waitcnt lgkmcnt(4)
v_mfma_f32_16x16x32_bf16 v[176:179], a[64:67], v[212:215], v[176:179]
ds_read_b128 v[208:211], v72 offset:3072
buffer_load_dwordx4 a[124:127], v241, s[16:19], s36 offen offset:3072 sc1
v_mfma_f32_16x16x32_bf16 v[180:183], a[68:71], v[212:215], v[180:183]
v_mfma_f32_16x16x32_bf16 v[184:187], a[72:75], v[212:215], v[184:187]
v_mfma_f32_16x16x32_bf16 v[188:191], a[76:79], v[212:215], v[188:191]
s_waitcnt vmcnt(11)
s_waitcnt lgkmcnt(4)
v_mfma_f32_16x16x32_bf16 v[192:195], a[64:67], v[216:219], v[192:195]
ds_read_b128 v[212:215], v72 offset:11264
v_mfma_f32_16x16x32_bf16 v[196:199], a[68:71], v[216:219], v[196:199]
v_mfma_f32_16x16x32_bf16 v[200:203], a[72:75], v[216:219], v[200:203]
v_mfma_f32_16x16x32_bf16 v[204:207], a[76:79], v[216:219], v[204:207]
s_waitcnt vmcnt(10)
s_waitcnt vmcnt(9)
s_waitcnt lgkmcnt(4)
v_mfma_f32_16x16x32_bf16 v[160:163], a[80:83], v[220:223], v[160:163]
ds_read_b128 v[216:219], v74 offset:3072
v_mfma_f32_16x16x32_bf16 v[164:167], a[84:87], v[220:223], v[164:167]
v_mfma_f32_16x16x32_bf16 v[168:171], a[88:91], v[220:223], v[168:171]
v_mfma_f32_16x16x32_bf16 v[172:175], a[92:95], v[220:223], v[172:175]
s_waitcnt vmcnt(8)
s_waitcnt lgkmcnt(4)
v_mfma_f32_16x16x32_bf16 v[176:179], a[80:83], v[224:227], v[176:179]
ds_read_b128 v[220:223], v73 offset:3072
v_cmp_ne_u64 vcc, s[98:99], v[248:249]
s_nop 1
s_cbranch_vccnz LF_spinQ
LF_goQ:
v_mfma_f32_16x16x32_bf16 v[180:183], a[84:87], v[224:227], v[180:183]
buffer_load_dwordx4 v[128:131], v244, s[24:27], 0 offen offset:0 sc1
v_mfma_f32_16x16x32_bf16 v[184:187], a[88:91], v[224:227], v[184:187]
buffer_load_dwordx4 v[132:135], v244, s[24:27], 0 offen offset:16 sc1
v_mfma_f32_16x16x32_bf16 v[188:191], a[92:95], v[224:227], v[188:191]
buffer_load_dwordx4 v[136:139], v244, s[24:27], 0 offen offset:32 sc1
s_waitcnt vmcnt(10)
s_waitcnt lgkmcnt(4)
v_mfma_f32_16x16x32_bf16 v[192:195], a[80:83], v[228:231], v[192:195]
ds_read_b128 v[224:227], v73 offset:11264
s_add_u32 s49, s6, s42
buffer_load_dwordx4 v[48:51], v47, s[16:19], s49 offen sc1
v_mfma_f32_16x16x32_bf16 v[196:199], a[84:87], v[228:231], v[196:199]
s_add_u32 s3, s6, s43
buffer_load_dwordx4 v[52:55], v47, s[16:19], s3 offen sc1
v_mfma_f32_16x16x32_bf16 v[200:203], a[88:91], v[228:231], v[200:203]
v_mfma_f32_16x16x32_bf16 v[204:207], a[92:95], v[228:231], v[204:207]
s_waitcnt vmcnt(11)
buffer_load_dwordx4 a[128:131], v240, s[16:19], s38 offen offset:0 sc1
s_waitcnt vmcnt(11)
buffer_load_dwordx4 a[132:135], v240, s[16:19], s38 offen offset:1024 sc1
s_waitcnt vmcnt(11)
s_waitcnt lgkmcnt(4)
v_mfma_f32_16x16x32_bf16 v[160:163], a[96:99], v[208:211], v[160:163]
ds_read_b128 v[228:231], v75 offset:3072
v_mfma_f32_16x16x32_bf16 v[164:167], a[100:103], v[208:211], v[164:167]
v_mfma_f32_16x16x32_bf16 v[168:171], a[104:107], v[208:211], v[168:171]
v_mfma_f32_16x16x32_bf16 v[172:175], a[108:111], v[208:211], v[172:175]
s_waitcnt vmcnt(10)
s_waitcnt lgkmcnt(4)
v_mfma_f32_16x16x32_bf16 v[176:179], a[96:99], v[212:215], v[176:179]
s_add_u32 s49, s6, s44
buffer_load_dwordx4 v[56:59], v47, s[16:19], s49 offen sc1
v_mfma_f32_16x16x32_bf16 v[180:183], a[100:103], v[212:215], v[180:183]
s_add_u32 s3, s6, s45
buffer_load_dwordx4 v[60:63], v47, s[16:19], s3 offen sc1
v_mfma_f32_16x16x32_bf16 v[184:187], a[104:107], v[212:215], v[184:187]
v_mfma_f32_16x16x32_bf16 v[188:191], a[108:111], v[212:215], v[188:191]
s_waitcnt vmcnt(11)
s_waitcnt lgkmcnt(3)
v_mfma_f32_16x16x32_bf16 v[192:195], a[96:99], v[216:219], v[192:195]
buffer_load_dwordx4 a[136:139], v241, s[16:19], s38 offen offset:0 sc1
v_mfma_f32_16x16x32_bf16 v[196:199], a[100:103], v[216:219], v[196:199]
v_mfma_f32_16x16x32_bf16 v[200:203], a[104:107], v[216:219], v[200:203]
v_mfma_f32_16x16x32_bf16 v[204:207], a[108:111], v[216:219], v[204:207]
s_waitcnt vmcnt(11)
buffer_load_dwordx4 a[140:143], v241, s[16:19], s38 offen offset:1024 sc1
s_waitcnt vmcnt(11)
s_waitcnt lgkmcnt(2)
v_mfma_f32_16x16x32_bf16 v[160:163], a[112:115], v[220:223], v[160:163]
s_add_u32 s49, s6, s46
buffer_load_dwordx4 v[64:67], v47, s[16:19], s49 offen sc1
v_mfma_f32_16x16x32_bf16 v[164:167], a[116:119], v[220:223], v[164:167]
ds_read_b128 v[68:71], v76 offset:0
v_mfma_f32_16x16x32_bf16 v[168:171], a[120:123], v[220:223], v[168:171]
v_mfma_f32_16x16x32_bf16 v[172:175], a[124:127], v[220:223], v[172:175]
s_waitcnt lgkmcnt(2)
v_mfma_f32_16x16x32_bf16 v[176:179], a[112:115], v[224:227], v[176:179]
v_lshlrev_b32 v234, 16, v104
v_and_b32 v235, s95, v104
v_mfma_f32_16x16x32_bf16 v[180:183], a[116:119], v[224:227], v[180:183]
v_fma_f32 v160, v160, v253, v234
v_fma_f32 v161, v161, v253, v235
v_mfma_f32_16x16x32_bf16 v[184:187], a[120:123], v[224:227], v[184:187]
v_lshlrev_b32 v236, 16, v105
v_and_b32 v237, s95, v105
v_mfma_f32_16x16x32_bf16 v[188:191], a[124:127], v[224:227], v[188:191]
v_fma_f32 v162, v162, v253, v236
v_fma_f32 v163, v163, v253, v237
s_waitcnt lgkmcnt(1)
v_mfma_f32_16x16x32_bf16 v[192:195], a[112:115], v[228:231], v[192:195]
v_lshlrev_b32 v238, 16, v106
v_and_b32 v239, s95, v106
v_mfma_f32_16x16x32_bf16 v[196:199], a[116:119], v[228:231], v[196:199]
v_fma_f32 v164, v164, v253, v238
v_fma_f32 v165, v165, v253, v239
v_mfma_f32_16x16x32_bf16 v[200:203], a[120:123], v[228:231], v[200:203]
v_lshlrev_b32 v232, 16, v107
v_and_b32 v233, s95, v107
v_mfma_f32_16x16x32_bf16 v[204:207], a[124:127], v[228:231], v[204:207]
v_fma_f32 v166, v166, v253, v232
v_fma_f32 v167, v167, v253, v233
ds_read_b128 v[104:107], v246 offset:2048
v_lshlrev_b32 v234, 16, v108
v_and_b32 v235, s95, v108
v_fma_f32 v168, v168, v253, v234
v_fma_f32 v169, v169, v253, v235
v_lshlrev_b32 v236, 16, v109
v_and_b32 v237, s95, v109
v_fma_f32 v170, v170, v253, v236
v_fma_f32 v171, v171, v253, v237
v_lshlrev_b32 v238, 16, v110
v_and_b32 v239, s95, v110
v_fma_f32 v172, v172, v253, v238
v_fma_f32 v173, v173, v253, v239
v_lshlrev_b32 v232, 16, v111
v_and_b32 v233, s95, v111
v_fma_f32 v174, v174, v253, v232
v_fma_f32 v175, v175, v253, v233
ds_read_b128 v[108:111], v245 offset:4096
s_waitcnt vmcnt(11)
buffer_load_dwordx4 a[144:147], v240, s[16:19], s38 offen offset:2048 sc1
v_lshlrev_b32 v234, 16, v152
v_and_b32 v235, s95, v152
v_fma_f32 v176, v176, v254, v234
v_fma_f32 v177, v177, v254, v235
v_lshlrev_b32 v236, 16, v153
v_and_b32 v237, s95, v153
v_fma_f32 v178, v178, v254, v236
v_fma_f32 v179, v179, v254, v237
v_lshlrev_b32 v238, 16, v154
v_and_b32 v239, s95, v154
v_fma_f32 v180, v180, v254, v238
v_fma_f32 v181, v181, v254, v239
v_lshlrev_b32 v232, 16, v155
v_and_b32 v233, s95, v155
v_fma_f32 v182, v182, v254, v232
v_fma_f32 v183, v183, v254, v233
ds_read_b128 v[152:155], v246 offset:4096
s_waitcnt lgkmcnt(2)
v_lshlrev_b32 v234, 16, v104
v_and_b32 v235, s95, v104
v_fma_f32 v184, v184, v254, v234
v_fma_f32 v185, v185, v254, v235
v_lshlrev_b32 v236, 16, v105
v_and_b32 v237, s95, v105
v_fma_f32 v186, v186, v254, v236
v_fma_f32 v187, v187, v254, v237
v_lshlrev_b32 v238, 16, v106
v_and_b32 v239, s95, v106
v_fma_f32 v188, v188, v254, v238
v_fma_f32 v189, v189, v254, v239
v_lshlrev_b32 v232, 16, v107
v_and_b32 v233, s95, v107
v_fma_f32 v190, v190, v254, v232
v_fma_f32 v191, v191, v254, v233
s_waitcnt vmcnt(11)
buffer_load_dwordx4 a[148:151], v240, s[16:19], s38 offen offset:3072 sc1
s_waitcnt lgkmcnt(1)
v_lshlrev_b32 v234, 16, v108
v_and_b32 v235, s95, v108
v_fma_f32 v192, v192, v255, v234
v_fma_f32 v193, v193, v255, v235
v_lshlrev_b32 v236, 16, v109
v_and_b32 v237, s95, v109
v_fma_f32 v194, v194, v255, v236
v_fma_f32 v195, v195, v255, v237
v_lshlrev_b32 v238, 16, v110
v_and_b32 v239, s95, v110
v_fma_f32 v196, v196, v255, v238
v_fma_f32 v197, v197, v255, v239
v_lshlrev_b32 v232, 16, v111
v_and_b32 v233, s95, v111
v_fma_f32 v198, v198, v255, v232
v_fma_f32 v199, v199, v255, v233
s_waitcnt lgkmcnt(0)
v_lshlrev_b32 v234, 16, v152
v_and_b32 v235, s95, v152
v_fma_f32 v200, v200, v255, v234
v_fma_f32 v201, v201, v255, v235
v_lshlrev_b32 v236, 16, v153
v_and_b32 v237, s95, v153
v_fma_f32 v202, v202, v255, v236
v_fma_f32 v203, v203, v255, v237
v_lshlrev_b32 v238, 16, v154
v_and_b32 v239, s95, v154
v_fma_f32 v204, v204, v255, v238
v_fma_f32 v205, v205, v255, v239
v_lshlrev_b32 v232, 16, v155
v_and_b32 v233, s95, v155
v_fma_f32 v206, v206, v255, v232
v_fma_f32 v207, v207, v255, v233
s_waitcnt vmcnt(11)
v_max3_f32 v232, v128, v130, v132
v_max3_f32 v233, v134, v136, v138
v_max_f32 v232, v232, v233
v_subrev_f32 v232, 0x42fe0000, v232
v_sub_f32 v128, v128, v232
v_sub_f32 v130, v130, v232
v_sub_f32 v132, v132, v232
v_sub_f32 v134, v134, v232
v_sub_f32 v136, v136, v232
v_sub_f32 v138, v138, v232
v_cvt_u32_f32 v128, v128
v_cvt_u32_f32 v130, v130
v_cvt_u32_f32 v132, v132
v_cvt_u32_f32 v134, v134
v_cvt_u32_f32 v136, v136
v_cvt_u32_f32 v138, v138
v_lshlrev_b32 v234, 23, v128
v_lshlrev_b32 v235, 23, v130
v_lshlrev_b32 v236, 23, v132
v_lshlrev_b32 v237, 23, v134
v_lshlrev_b32 v238, 23, v136
v_lshlrev_b32 v239, 23, v138
v_mul_f32 v232, v234, v129
v_fmac_f32 v232, v235, v131
v_fmac_f32 v232, v236, v133
v_fmac_f32 v232, v237, v135
v_fmac_f32 v232, v238, v137
v_fmac_f32 v232, v239, v139
v_rcp_f32 v150, v232
v_mul_u32_u24 v144, 0x800080, v128
v_mul_u32_u24 v145, 0x800080, v130
v_mul_u32_u24 v146, 0x800080, v132
v_mul_u32_u24 v147, 0x800080, v134
v_mul_u32_u24 v148, 0x800080, v136
v_mul_u32_u24 v149, 0x800080, v138
ds_write_b128 v242, v[144:147]
ds_write_b96 v242, v[148:150] offset:16
ds_read_b128 v[144:147], v250 offset:0
ds_read_b128 v[148:151], v250 offset:16
ds_read_b128 v[128:131], v250 offset:512
ds_read_b128 v[132:135], v250 offset:528
ds_read_b128 v[136:139], v250 offset:1024
ds_read_b128 v[140:143], v250 offset:1040
s_waitcnt lgkmcnt(4)
v_and_b32 v0, v144, v156
v_and_b32 v1, v144, v157
v_and_b32 v2, v145, v156
v_and_b32 v3, v145, v157
v_and_b32 v4, v146, v156
v_and_b32 v5, v146, v157
v_and_b32 v6, v147, v156
v_and_b32 v7, v147, v157
v_and_b32 v8, v148, v156
v_and_b32 v9, v148, v157
v_and_b32 v10, v149, v156
v_and_b32 v11, v149, v157
v_mov_b32 v40, v150
s_waitcnt lgkmcnt(2)
v_and_b32 v12, v128, v156
v_and_b32 v13, v128, v157
v_and_b32 v14, v129, v156
v_and_b32 v15, v129, v157
v_and_b32 v16, v130, v156
v_and_b32 v17, v130, v157
v_and_b32 v18, v131, v156
v_and_b32 v19, v131, v157
v_and_b32 v20, v132, v156
v_and_b32 v21, v132, v157
v_and_b32 v22, v133, v156
v_and_b32 v23, v133, v157
v_mov_b32 v41, v134
s_waitcnt lgkmcnt(0)
v_and_b32 v24, v136, v156
v_and_b32 v25, v136, v157
v_and_b32 v26, v137, v156
v_and_b32 v27, v137, v157
v_and_b32 v28, v138, v156
v_and_b32 v29, v138, v157
v_and_b32 v30, v139, v156
v_and_b32 v31, v139, v157
v_and_b32 v32, v140, v156
v_and_b32 v33, v140, v157
v_and_b32 v34, v141, v156
v_and_b32 v35, v141, v157
v_mov_b32 v42, v142
s_waitcnt vmcnt(9)
v_swap_b32 v50, v52
v_swap_b32 v51, v53
s_nop 1
v_mfma_f32_16x16x32_bf16 v[136:139], v[48:51], v[0:3], 0
s_add_u32 s49, s6, s42
buffer_load_dwordx4 v[80:83], v43, s[16:19], s49 offen sc1
v_mfma_f32_16x16x32_bf16 v[140:143], v[52:55], v[0:3], 0
s_add_u32 s3, s6, s43
buffer_load_dwordx4 v[84:87], v43, s[16:19], s3 offen sc1
buffer_load_dwordx4 a[152:155], v241, s[16:19], s38 offen offset:2048 sc1
s_waitcnt vmcnt(11)
buffer_load_dwordx4 a[156:159], v241, s[16:19], s38 offen offset:3072 sc1
s_waitcnt vmcnt(11)
s_waitcnt vmcnt(9)
v_swap_b32 v58, v60
v_swap_b32 v59, v61
s_nop 1
v_mfma_f32_16x16x32_bf16 v[136:139], v[56:59], v[4:7], v[136:139]
s_add_u32 s49, s6, s44
buffer_load_dwordx4 v[88:91], v43, s[16:19], s49 offen sc1
v_mfma_f32_16x16x32_bf16 v[140:143], v[60:63], v[4:7], v[140:143]
s_add_u32 s3, s6, s45
buffer_load_dwordx4 v[92:95], v43, s[16:19], s3 offen sc1
buffer_load_dwordx4 a[160:163], v240, s[16:19], s39 offen offset:0 sc1
s_waitcnt vmcnt(11)
buffer_load_dwordx4 a[164:167], v240, s[16:19], s39 offen offset:1024 sc1
s_waitcnt vmcnt(11)
s_add_u32 s49, s6, s46
buffer_load_dwordx4 v[96:99], v43, s[16:19], s49 offen sc1
ds_read_b128 v[100:103], v76 offset:4096
s_waitcnt vmcnt(11)
v_swap_b32 v66, v68
v_swap_b32 v67, v69
s_nop 1
v_mfma_f32_16x16x32_bf16 v[136:139], v[64:67], v[8:11], v[136:139]
buffer_load_dwordx4 a[168:171], v241, s[16:19], s39 offen offset:0 sc1
v_mfma_f32_16x16x32_bf16 v[140:143], v[68:71], v[8:11], v[140:143]
s_waitcnt vmcnt(11)
buffer_load_dwordx4 a[172:175], v241, s[16:19], s39 offen offset:1024 sc1
s_nop 3
v_mul_f32 v136, v136, v40
v_mul_f32 v137, v137, v40
v_mul_f32 v138, v138, v40
v_mul_f32 v139, v139, v40
v_mul_f32 v140, v140, v40
v_mul_f32 v141, v141, v40
v_mul_f32 v142, v142, v40
v_mul_f32 v143, v143, v40
v_cvt_pk_bf16_f32 v136, v136, v137
v_cvt_pk_bf16_f32 v137, v138, v139
v_cvt_pk_bf16_f32 v138, v140, v141
v_cvt_pk_bf16_f32 v139, v142, v143
ds_write_b128 v251, v[136:139] offset:0
s_waitcnt vmcnt(11)
s_waitcnt vmcnt(9)
v_swap_b32 v82, v84
v_swap_b32 v83, v85
s_nop 1
v_mfma_f32_16x16x32_bf16 v[128:131], v[80:83], v[0:3], 0
s_add_u32 s49, s7, s42
buffer_load_dwordx4 v[112:115], v47, s[16:19], s49 offen sc1
v_mfma_f32_16x16x32_bf16 v[132:135], v[84:87], v[0:3], 0
s_add_u32 s3, s7, s43
buffer_load_dwordx4 v[116:119], v47, s[16:19], s3 offen sc1
buffer_load_dwordx4 a[176:179], v240, s[16:19], s39 offen offset:2048 sc1
s_waitcnt vmcnt(11)
buffer_load_dwordx4 a[180:183], v240, s[16:19], s39 offen offset:3072 sc1
s_waitcnt vmcnt(11)
s_waitcnt vmcnt(9)
v_swap_b32 v90, v92
v_swap_b32 v91, v93
s_nop 1
v_mfma_f32_16x16x32_bf16 v[128:131], v[88:91], v[4:7], v[128:131]
s_add_u32 s49, s7, s44
buffer_load_dwordx4 v[120:123], v47, s[16:19], s49 offen sc1
v_mfma_f32_16x16x32_bf16 v[132:135], v[92:95], v[4:7], v[132:135]
s_add_u32 s3, s7, s45
buffer_load_dwordx4 v[124:127], v47, s[16:19], s3 offen sc1
buffer_load_dwordx4 a[184:187], v241, s[16:19], s39 offen offset:2048 sc1
s_waitcnt vmcnt(11)
buffer_load_dwordx4 a[188:191], v241, s[16:19], s39 offen offset:3072 sc1
s_waitcnt vmcnt(11)
s_add_u32 s49, s7, s46
buffer_load_dwordx4 v[48:51], v47, s[16:19], s49 offen sc1
ds_read_b128 v[52:55], v77 offset:0
s_waitcnt vmcnt(11)
s_waitcnt lgkmcnt(2)
v_swap_b32 v98, v100
v_swap_b32 v99, v101
s_nop 1
v_mfma_f32_16x16x32_bf16 v[128:131], v[96:99], v[8:11], v[128:131]
buffer_load_dwordx4 a[192:195], v240, s[16:19], s40 offen offset:0 sc1
v_mfma_f32_16x16x32_bf16 v[132:135], v[100:103], v[8:11], v[132:135]
s_waitcnt vmcnt(11)
buffer_load_dwordx4 a[196:199], v240, s[16:19], s40 offen offset:1024 sc1
s_nop 3
v_mul_f32 v128, v128, v40
v_mul_f32 v129, v129, v40
v_mul_f32 v130, v130, v40
v_mul_f32 v131, v131, v40
v_mul_f32 v132, v132, v40
v_mul_f32 v133, v133, v40
v_mul_f32 v134, v134, v40
v_mul_f32 v135, v135, v40
v_cvt_pk_bf16_f32 v128, v128, v129
v_cvt_pk_bf16_f32 v129, v130, v131
v_cvt_pk_bf16_f32 v130, v132, v133
v_cvt_pk_bf16_f32 v131, v134, v135
ds_write_b128 v251, v[128:131] offset:4096
s_waitcnt vmcnt(11)
s_waitcnt lgkmcnt(0)
s_barrier
ds_read_b128 v[208:211], v252 offset:0
ds_read_b128 v[212:215], v252 offset:1024
ds_read_b128 v[216:219], v252 offset:2048
ds_read_b128 v[220:223], v252 offset:3072
ds_read_b128 v[224:227], v252 offset:4096
s_waitcnt vmcnt(9)
s_waitcnt lgkmcnt(4)
v_mfma_f32_16x16x32_bf16 v[160:163], a[128:131], v[208:211], v[160:163]
ds_read_b128 v[228:231], v252 offset:5120
v_swap_b32 v114, v116
v_mfma_f32_16x16x32_bf16 v[164:167], a[132:135], v[208:211], v[164:167]
v_swap_b32 v115, v117
s_nop 1
v_mfma_f32_16x16x32_bf16 v[136:139], v[112:115], v[12:15], 0
s_add_u32 s49, s7, s42
buffer_load_dwordx4 v[56:59], v43, s[16:19], s49 offen sc1
v_mfma_f32_16x16x32_bf16 v[140:143], v[116:119], v[12:15], 0
s_add_u32 s3, s7, s43
buffer_load_dwordx4 v[60:63], v43, s[16:19], s3 offen sc1
v_mfma_f32_16x16x32_bf16 v[168:171], a[136:139], v[208:211], v[168:171]
buffer_load_dwordx4 a[200:203], v241, s[16:19], s40 offen offset:0 sc1
v_mfma_f32_16x16x32_bf16 v[172:175], a[140:143], v[208:211], v[172:175]
s_waitcnt lgkmcnt(4)
v_mfma_f32_16x16x32_bf16 v[160:163], a[144:147], v[212:215], v[160:163]
v_mfma_f32_16x16x32_bf16 v[164:167], a[148:151], v[212:215], v[164:167]
v_mfma_f32_16x16x32_bf16 v[168:171], a[152:155], v[212:215], v[168:171]
v_mfma_f32_16x16x32_bf16 v[172:175], a[156:159], v[212:215], v[172:175]
s_waitcnt vmcnt(11)
s_waitcnt lgkmcnt(3)
v_mfma_f32_16x16x32_bf16 v[160:163], a[160:163], v[216:219], v[160:163]
buffer_load_dwordx4 a[204:207], v241, s[16:19], s40 offen offset:1024 sc1
v_mfma_f32_16x16x32_bf16 v[164:167], a[164:167], v[216:219], v[164:167]
v_mfma_f32_16x16x32_bf16 v[168:171], a[168:171], v[216:219], v[168:171]
v_mfma_f32_16x16x32_bf16 v[172:175], a[172:175], v[216:219], v[172:175]
s_waitcnt vmcnt(11)
s_waitcnt vmcnt(9)
v_swap_b32 v122, v124
v_swap_b32 v123, v125
s_nop 1
v_mfma_f32_16x16x32_bf16 v[136:139], v[120:123], v[16:19], v[136:139]
s_add_u32 s49, s7, s44
buffer_load_dwordx4 v[64:67], v43, s[16:19], s49 offen sc1
v_mfma_f32_16x16x32_bf16 v[140:143], v[124:127], v[16:19], v[140:143]
s_add_u32 s3, s7, s45
buffer_load_dwordx4 v[68:71], v43, s[16:19], s3 offen sc1
buffer_load_dwordx4 a[208:211], v240, s[16:19], s40 offen offset:2048 sc1
s_waitcnt vmcnt(11)
buffer_load_dwordx4 a[212:215], v240, s[16:19], s40 offen offset:3072 sc1
s_waitcnt vmcnt(11)
s_waitcnt lgkmcnt(2)
v_mfma_f32_16x16x32_bf16 v[160:163], a[176:179], v[220:223], v[160:163]
s_add_u32 s49, s7, s46
buffer_load_dwordx4 v[80:83], v43, s[16:19], s49 offen sc1
v_mfma_f32_16x16x32_bf16 v[164:167], a[180:183], v[220:223], v[164:167]
ds_read_b128 v[84:87], v77 offset:4096
v_mfma_f32_16x16x32_bf16 v[168:171], a[184:187], v[220:223], v[168:171]
v_mfma_f32_16x16x32_bf16 v[172:175], a[188:191], v[220:223], v[172:175]
s_waitcnt vmcnt(11)
v_swap_b32 v50, v52
v_swap_b32 v51, v53
s_nop 1
v_mfma_f32_16x16x32_bf16 v[136:139], v[48:51], v[20:23], v[136:139]
buffer_load_dwordx4 a[216:219], v241, s[16:19], s40 offen offset:2048 sc1
v_mfma_f32_16x16x32_bf16 v[140:143], v[52:55], v[20:23], v[140:143]
s_waitcnt vmcnt(11)
buffer_load_dwordx4 a[220:223], v241, s[16:19], s40 offen offset:3072 sc1
s_nop 3
v_mul_f32 v136, v136, v41
v_mul_f32 v137, v137, v41
v_mul_f32 v138, v138, v41
v_mul_f32 v139, v139, v41
v_mul_f32 v140, v140, v41
v_mul_f32 v141, v141, v41
v_mul_f32 v142, v142, v41
v_mul_f32 v143, v143, v41
v_cvt_pk_bf16_f32 v136, v136, v137
v_cvt_pk_bf16_f32 v137, v138, v139
v_cvt_pk_bf16_f32 v138, v140, v141
v_cvt_pk_bf16_f32 v139, v142, v143
ds_write_b128 v251, v[136:139] offset:8192
s_waitcnt vmcnt(11)
s_waitcnt vmcnt(9)
v_swap_b32 v58, v60
v_swap_b32 v59, v61
s_nop 1
v_mfma_f32_16x16x32_bf16 v[128:131], v[56:59], v[12:15], 0
s_add_u32 s49, s29, s42
buffer_load_dwordx4 v[88:91], v47, s[16:19], s49 offen sc1
v_mfma_f32_16x16x32_bf16 v[132:135], v[60:63], v[12:15], 0
s_add_u32 s3, s29, s43
buffer_load_dwordx4 v[92:95], v47, s[16:19], s3 offen sc1
buffer_load_dwordx4 a[224:227], v240, s[16:19], s41 offen offset:0 sc1
s_waitcnt vmcnt(11)
buffer_load_dwordx4 a[228:231], v240, s[16:19], s41 offen offset:1024 sc1
s_waitcnt vmcnt(11)
s_waitcnt lgkmcnt(3)
v_mfma_f32_16x16x32_bf16 v[160:163], a[192:195], v[224:227], v[160:163]
buffer_load_dwordx4 a[232:235], v241, s[16:19], s41 offen offset:0 sc1
v_mfma_f32_16x16x32_bf16 v[164:167], a[196:199], v[224:227], v[164:167]
v_mfma_f32_16x16x32_bf16 v[168:171], a[200:203], v[224:227], v[168:171]
v_mfma_f32_16x16x32_bf16 v[172:175], a[204:207], v[224:227], v[172:175]
s_waitcnt vmcnt(10)
v_swap_b32 v66, v68
v_swap_b32 v67, v69
s_nop 1
v_mfma_f32_16x16x32_bf16 v[128:131], v[64:67], v[16:19], v[128:131]
buffer_load_dwordx4 a[236:239], v241, s[16:19], s41 offen offset:1024 sc1
v_mfma_f32_16x16x32_bf16 v[132:135], v[68:71], v[16:19], v[132:135]
s_waitcnt vmcnt(10)
s_add_u32 s49, s29, s44
buffer_load_dwordx4 v[96:99], v47, s[16:19], s49 offen sc1
s_add_u32 s3, s29, s45
buffer_load_dwordx4 v[100:103], v47, s[16:19], s3 offen sc1
s_waitcnt vmcnt(11)
buffer_load_dwordx4 a[240:243], v240, s[16:19], s41 offen offset:2048 sc1
s_waitcnt vmcnt(11)
s_waitcnt lgkmcnt(1)
v_swap_b32 v82, v84
v_swap_b32 v83, v85
s_nop 1
v_mfma_f32_16x16x32_bf16 v[128:131], v[80:83], v[20:23], v[128:131]
buffer_load_dwordx4 a[244:247], v240, s[16:19], s41 offen offset:3072 sc1
v_mfma_f32_16x16x32_bf16 v[132:135], v[84:87], v[20:23], v[132:135]
s_waitcnt vmcnt(11)
buffer_load_dwordx4 a[248:251], v241, s[16:19], s41 offen offset:2048 sc1
s_nop 3
v_mul_f32 v128, v128, v41
v_mul_f32 v129, v129, v41
v_mul_f32 v130, v130, v41
v_mul_f32 v131, v131, v41
v_mul_f32 v132, v132, v41
v_mul_f32 v133, v133, v41
v_mul_f32 v134, v134, v41
v_mul_f32 v135, v135, v41
v_cvt_pk_bf16_f32 v128, v128, v129
v_cvt_pk_bf16_f32 v129, v130, v131
v_cvt_pk_bf16_f32 v130, v132, v133
v_cvt_pk_bf16_f32 v131, v134, v135
ds_write_b128 v251, v[128:131] offset:12288
s_waitcnt vmcnt(11)
v_mfma_f32_16x16x32_bf16 v[160:163], a[208:211], v[228:231], v[160:163]
buffer_load_dwordx4 a[252:255], v241, s[16:19], s41 offen offset:3072 sc1
v_mfma_f32_16x16x32_bf16 v[164:167], a[212:215], v[228:231], v[164:167]
v_mfma_f32_16x16x32_bf16 v[168:171], a[216:219], v[228:231], v[168:171]
v_mfma_f32_16x16x32_bf16 v[172:175], a[220:223], v[228:231], v[172:175]
s_waitcnt lgkmcnt(0)
s_barrier
ds_read_b128 v[208:211], v252 offset:8192
ds_read_b128 v[212:215], v252 offset:9216
ds_read_b128 v[216:219], v252 offset:10240
ds_read_b128 v[220:223], v252 offset:11264
ds_read_b128 v[224:227], v252 offset:12288
s_waitcnt vmcnt(10)
s_waitcnt lgkmcnt(4)
v_mfma_f32_16x16x32_bf16 v[176:179], a[128:131], v[208:211], v[176:179]
ds_read_b128 v[228:231], v252 offset:6144
v_swap_b32 v90, v92
v_mfma_f32_16x16x32_bf16 v[180:183], a[132:135], v[208:211], v[180:183]
v_swap_b32 v91, v93
s_nop 1
v_mfma_f32_16x16x32_bf16 v[136:139], v[88:91], v[24:27], 0
s_add_u32 s49, s29, s46
buffer_load_dwordx4 v[112:115], v47, s[16:19], s49 offen sc1
v_mfma_f32_16x16x32_bf16 v[140:143], v[92:95], v[24:27], 0
s_add_u32 s3, s29, s47
s_cmp_lt_u32 s37, 4
s_cbranch_scc1 LF_o0
buffer_load_dwordx4 v[116:119], v47, s[16:19], s3 offen sc1
ds_read_b128 v[36:39], v78 offset:0
s_branch LF_j0
LF_o0:
s_mov_b32 s3, 0x70000000
buffer_load_dwordx4 v[36:39], v47, s[16:19], s3 offen sc1
ds_read_b128 v[116:119], v78 offset:0
LF_j0:
v_mfma_f32_16x16x32_bf16 v[184:187], a[136:139], v[208:211], v[184:187]
v_mfma_f32_16x16x32_bf16 v[188:191], a[140:143], v[208:211], v[188:191]
s_waitcnt lgkmcnt(5)
v_mfma_f32_16x16x32_bf16 v[176:179], a[144:147], v[212:215], v[176:179]
ds_read_b128 v[208:211], v252 offset:13312
v_mfma_f32_16x16x32_bf16 v[180:183], a[148:151], v[212:215], v[180:183]
v_mfma_f32_16x16x32_bf16 v[184:187], a[152:155], v[212:215], v[184:187]
v_mfma_f32_16x16x32_bf16 v[188:191], a[156:159], v[212:215], v[188:191]
s_waitcnt vmcnt(11)
s_waitcnt lgkmcnt(5)
v_mfma_f32_16x16x32_bf16 v[176:179], a[160:163], v[216:219], v[176:179]
ds_read_b128 v[212:215], v252 offset:14336
v_mfma_f32_16x16x32_bf16 v[180:183], a[164:167], v[216:219], v[180:183]
v_mfma_f32_16x16x32_bf16 v[184:187], a[168:171], v[216:219], v[184:187]
v_mfma_f32_16x16x32_bf16 v[188:191], a[172:175], v[216:219], v[188:191]
s_waitcnt vmcnt(10)
s_waitcnt lgkmcnt(5)
v_mfma_f32_16x16x32_bf16 v[176:179], a[176:179], v[220:223], v[176:179]
ds_read_b128 v[216:219], v252 offset:7168
s_add_u32 s49, s29, s42
buffer_load_dwordx4 v[120:123], v43, s[16:19], s49 offen sc1
v_mfma_f32_16x16x32_bf16 v[180:183], a[180:183], v[220:223], v[180:183]
s_add_u32 s3, s29, s43
buffer_load_dwordx4 v[124:127], v43, s[16:19], s3 offen sc1
v_mfma_f32_16x16x32_bf16 v[184:187], a[184:187], v[220:223], v[184:187]
v_mfma_f32_16x16x32_bf16 v[188:191], a[188:191], v[220:223], v[188:191]
s_waitcnt vmcnt(11)
s_waitcnt lgkmcnt(5)
v_mfma_f32_16x16x32_bf16 v[176:179], a[192:195], v[224:227], v[176:179]
ds_read_b128 v[220:223], v252 offset:15360
v_mfma_f32_16x16x32_bf16 v[180:183], a[196:199], v[224:227], v[180:183]
v_mfma_f32_16x16x32_bf16 v[184:187], a[200:203], v[224:227], v[184:187]
v_mfma_f32_16x16x32_bf16 v[188:191], a[204:207], v[224:227], v[188:191]
s_waitcnt vmcnt(10)
s_waitcnt lgkmcnt(5)
v_mfma_f32_16x16x32_bf16 v[160:163], a[224:227], v[228:231], v[160:163]
s_add_u32 s49, s29, s44
buffer_load_dwordx4 v[48:51], v43, s[16:19], s49 offen sc1
v_mfma_f32_16x16x32_bf16 v[164:167], a[228:231], v[228:231], v[164:167]
s_add_u32 s3, s29, s45
buffer_load_dwordx4 v[52:55], v43, s[16:19], s3 offen sc1
v_mfma_f32_16x16x32_bf16 v[168:171], a[232:235], v[228:231], v[168:171]
v_mfma_f32_16x16x32_bf16 v[172:175], a[236:239], v[228:231], v[172:175]
s_waitcnt vmcnt(10)
s_waitcnt lgkmcnt(3)
v_mfma_f32_16x16x32_bf16 v[176:179], a[208:211], v[208:211], v[176:179]
v_swap_b32 v98, v100
v_mfma_f32_16x16x32_bf16 v[180:183], a[212:215], v[208:211], v[180:183]
v_swap_b32 v99, v101
s_nop 1
v_mfma_f32_16x16x32_bf16 v[136:139], v[96:99], v[28:31], v[136:139]
s_add_u32 s49, s29, s46
buffer_load_dwordx4 v[56:59], v43, s[16:19], s49 offen sc1
v_mfma_f32_16x16x32_bf16 v[140:143], v[100:103], v[28:31], v[140:143]
s_add_u32 s3, s29, s47
s_cmp_lt_u32 s37, 4
s_cbranch_scc1 LF_o1
buffer_load_dwordx4 v[60:63], v43, s[16:19], s3 offen sc1
ds_read_b128 v[36:39], v78 offset:4096
s_branch LF_j1
LF_o1:
s_mov_b32 s3, 0x70000000
buffer_load_dwordx4 v[36:39], v43, s[16:19], s3 offen sc1
ds_read_b128 v[60:63], v78 offset:4096
LF_j1:
v_mfma_f32_16x16x32_bf16 v[184:187], a[216:219], v[208:211], v[184:187]
v_mfma_f32_16x16x32_bf16 v[188:191], a[220:223], v[208:211], v[188:191]
s_waitcnt lgkmcnt(3)
v_mfma_f32_16x16x32_bf16 v[176:179], a[224:227], v[212:215], v[176:179]
v_mfma_f32_16x16x32_bf16 v[180:183], a[228:231], v[212:215], v[180:183]
v_mfma_f32_16x16x32_bf16 v[184:187], a[232:235], v[212:215], v[184:187]
v_mfma_f32_16x16x32_bf16 v[188:191], a[236:239], v[212:215], v[188:191]
s_waitcnt vmcnt(11)
s_waitcnt vmcnt(10)
s_waitcnt vmcnt(9)
s_waitcnt vmcnt(8)
s_waitcnt lgkmcnt(2)
v_mfma_f32_16x16x32_bf16 v[160:163], a[240:243], v[216:219], v[160:163]
v_mfma_f32_16x16x32_bf16 v[164:167], a[244:247], v[216:219], v[164:167]
v_mfma_f32_16x16x32_bf16 v[168:171], a[248:251], v[216:219], v[168:171]
v_mfma_f32_16x16x32_bf16 v[172:175], a[252:255], v[216:219], v[172:175]
s_waitcnt vmcnt(6)
s_waitcnt lgkmcnt(1)
v_mfma_f32_16x16x32_bf16 v[176:179], a[240:243], v[220:223], v[176:179]
v_swap_b32 v114, v116
v_mfma_f32_16x16x32_bf16 v[180:183], a[244:247], v[220:223], v[180:183]
v_swap_b32 v115, v117
s_nop 1
v_mfma_f32_16x16x32_bf16 v[136:139], v[112:115], v[32:35], v[136:139]
v_cvt_pk_bf16_f32 v160, v160, v161
v_cvt_pk_bf16_f32 v161, v162, v163
v_mfma_f32_16x16x32_bf16 v[140:143], v[116:119], v[32:35], v[140:143]
v_cvt_pk_bf16_f32 v162, v164, v165
v_cvt_pk_bf16_f32 v163, v166, v167
v_mfma_f32_16x16x32_bf16 v[184:187], a[248:251], v[220:223], v[184:187]
ds_write_b128 v245, v[160:163] offset:0
v_cvt_pk_bf16_f32 v168, v168, v169
v_mfma_f32_16x16x32_bf16 v[188:191], a[252:255], v[220:223], v[188:191]
v_cvt_pk_bf16_f32 v169, v170, v171
v_cvt_pk_bf16_f32 v170, v172, v173
v_cvt_pk_bf16_f32 v171, v174, v175
ds_write_b128 v246, v[168:171] offset:0
ds_read_b128 v[164:167], v247 offset:0
ds_read_b128 v[172:175], v247 offset:1024
v_mul_f32 v136, v136, v42
v_mul_f32 v137, v137, v42
v_mul_f32 v138, v138, v42
v_mul_f32 v139, v139, v42
v_mul_f32 v140, v140, v42
v_mul_f32 v141, v141, v42
v_mul_f32 v142, v142, v42
v_mul_f32 v143, v143, v42
v_cvt_pk_bf16_f32 v136, v136, v137
v_cvt_pk_bf16_f32 v137, v138, v139
v_cvt_pk_bf16_f32 v138, v140, v141
v_cvt_pk_bf16_f32 v139, v142, v143
ds_write_b128 v251, v[136:139] offset:16384
s_waitcnt lgkmcnt(0)
s_barrier
ds_read_b128 v[224:227], v252 offset:16384
ds_read_b128 v[228:231], v252 offset:17408
ds_read_b128 v[208:211], v252 offset:18432
ds_read_b128 v[212:215], v252 offset:19456
s_waitcnt vmcnt(4)
s_waitcnt lgkmcnt(3)
v_mfma_f32_16x16x32_bf16 v[192:195], a[128:131], v[224:227], v[192:195]
v_swap_b32 v122, v124
v_mfma_f32_16x16x32_bf16 v[196:199], a[132:135], v[224:227], v[196:199]
v_swap_b32 v123, v125
s_nop 1
v_mfma_f32_16x16x32_bf16 v[128:131], v[120:123], v[24:27], 0
buffer_store_dwordx4 v[164:167], v44, s[56:59], s6 offen sc1
v_mfma_f32_16x16x32_bf16 v[132:135], v[124:127], v[24:27], 0
buffer_store_dwordx4 v[172:175], v45, s[56:59], s6 offen sc1
v_mfma_f32_16x16x32_bf16 v[200:203], a[136:139], v[224:227], v[200:203]
v_cvt_pk_bf16_f32 v176, v176, v177
v_cvt_pk_bf16_f32 v177, v178, v179
v_mfma_f32_16x16x32_bf16 v[204:207], a[140:143], v[224:227], v[204:207]
v_cvt_pk_bf16_f32 v178, v180, v181
v_cvt_pk_bf16_f32 v179, v182, v183
s_waitcnt lgkmcnt(2)
v_mfma_f32_16x16x32_bf16 v[192:195], a[144:147], v[228:231], v[192:195]
ds_write_b128 v245, v[176:179] offset:2048
v_cvt_pk_bf16_f32 v184, v184, v185
v_mfma_f32_16x16x32_bf16 v[196:199], a[148:151], v[228:231], v[196:199]
v_cvt_pk_bf16_f32 v185, v186, v187
v_cvt_pk_bf16_f32 v186, v188, v189
v_mfma_f32_16x16x32_bf16 v[200:203], a[152:155], v[228:231], v[200:203]
v_cvt_pk_bf16_f32 v187, v190, v191
ds_write_b128 v246, v[184:187] offset:2048
v_mfma_f32_16x16x32_bf16 v[204:207], a[156:159], v[228:231], v[204:207]
ds_read_b128 v[180:183], v247 offset:2048
ds_read_b128 v[188:191], v247 offset:3072
s_waitcnt vmcnt(4)
s_waitcnt lgkmcnt(5)
v_mfma_f32_16x16x32_bf16 v[192:195], a[160:163], v[208:211], v[192:195]
v_swap_b32 v50, v52
v_mfma_f32_16x16x32_bf16 v[196:199], a[164:167], v[208:211], v[196:199]
v_swap_b32 v51, v53
s_nop 1
v_mfma_f32_16x16x32_bf16 v[128:131], v[48:51], v[28:31], v[128:131]
s_waitcnt lgkmcnt(1)
buffer_store_dwordx4 v[180:183], v44, s[56:59], s7 offen sc1
v_mfma_f32_16x16x32_bf16 v[132:135], v[52:55], v[28:31], v[132:135]
s_waitcnt lgkmcnt(0)
buffer_store_dwordx4 v[188:191], v45, s[56:59], s7 offen sc1
v_mfma_f32_16x16x32_bf16 v[200:203], a[168:171], v[208:211], v[200:203]
v_mfma_f32_16x16x32_bf16 v[204:207], a[172:175], v[208:211], v[204:207]
v_mfma_f32_16x16x32_bf16 v[192:195], a[176:179], v[212:215], v[192:195]
v_mfma_f32_16x16x32_bf16 v[196:199], a[180:183], v[212:215], v[196:199]
v_mfma_f32_16x16x32_bf16 v[200:203], a[184:187], v[212:215], v[200:203]
v_mfma_f32_16x16x32_bf16 v[204:207], a[188:191], v[212:215], v[204:207]
s_waitcnt vmcnt(4)
v_swap_b32 v58, v60
v_swap_b32 v59, v61
s_nop 1
v_mfma_f32_16x16x32_bf16 v[128:131], v[56:59], v[32:35], v[128:131]
v_mfma_f32_16x16x32_bf16 v[132:135], v[60:63], v[32:35], v[132:135]
s_nop 6
v_mul_f32 v128, v128, v42
v_mul_f32 v129, v129, v42
v_mul_f32 v130, v130, v42
v_mul_f32 v131, v131, v42
v_mul_f32 v132, v132, v42
v_mul_f32 v133, v133, v42
v_mul_f32 v134, v134, v42
v_mul_f32 v135, v135, v42
v_cvt_pk_bf16_f32 v128, v128, v129
v_cvt_pk_bf16_f32 v129, v130, v131
v_cvt_pk_bf16_f32 v130, v132, v133
v_cvt_pk_bf16_f32 v131, v134, v135
ds_write_b128 v251, v[128:131] offset:20480
s_waitcnt lgkmcnt(0)
s_barrier
ds_read_b128 v[216:219], v252 offset:20480
ds_read_b128 v[220:223], v252 offset:21504
ds_read_b128 v[224:227], v252 offset:22528
ds_read_b128 v[228:231], v252 offset:23552
s_waitcnt lgkmcnt(3)
v_mfma_f32_16x16x32_bf16 v[192:195], a[192:195], v[216:219], v[192:195]
v_mfma_f32_16x16x32_bf16 v[196:199], a[196:199], v[216:219], v[196:199]
v_mfma_f32_16x16x32_bf16 v[200:203], a[200:203], v[216:219], v[200:203]
v_mfma_f32_16x16x32_bf16 v[204:207], a[204:207], v[216:219], v[204:207]
s_waitcnt lgkmcnt(2)
v_mfma_f32_16x16x32_bf16 v[192:195], a[208:211], v[220:223], v[192:195]
v_mfma_f32_16x16x32_bf16 v[196:199], a[212:215], v[220:223], v[196:199]
v_mfma_f32_16x16x32_bf16 v[200:203], a[216:219], v[220:223], v[200:203]
v_mfma_f32_16x16x32_bf16 v[204:207], a[220:223], v[220:223], v[204:207]
s_waitcnt lgkmcnt(1)
v_mfma_f32_16x16x32_bf16 v[192:195], a[224:227], v[224:227], v[192:195]
v_mfma_f32_16x16x32_bf16 v[196:199], a[228:231], v[224:227], v[196:199]
v_mfma_f32_16x16x32_bf16 v[200:203], a[232:235], v[224:227], v[200:203]
v_mfma_f32_16x16x32_bf16 v[204:207], a[236:239], v[224:227], v[204:207]
s_waitcnt lgkmcnt(0)
v_mfma_f32_16x16x32_bf16 v[192:195], a[240:243], v[228:231], v[192:195]
v_mfma_f32_16x16x32_bf16 v[196:199], a[244:247], v[228:231], v[196:199]
v_mfma_f32_16x16x32_bf16 v[200:203], a[248:251], v[228:231], v[200:203]
v_mfma_f32_16x16x32_bf16 v[204:207], a[252:255], v[228:231], v[204:207]
s_nop 4
v_cvt_pk_bf16_f32 v192, v192, v193
v_cvt_pk_bf16_f32 v193, v194, v195
v_cvt_pk_bf16_f32 v194, v196, v197
v_cvt_pk_bf16_f32 v195, v198, v199
ds_write_b128 v245, v[192:195] offset:4096
v_cvt_pk_bf16_f32 v200, v200, v201
v_cvt_pk_bf16_f32 v201, v202, v203
v_cvt_pk_bf16_f32 v202, v204, v205
v_cvt_pk_bf16_f32 v203, v206, v207
ds_write_b128 v246, v[200:203] offset:4096
ds_read_b128 v[196:199], v247 offset:4096
ds_read_b128 v[204:207], v247 offset:5120
s_waitcnt lgkmcnt(1)
buffer_store_dwordx4 v[196:199], v44, s[56:59], s29 offen sc1
s_waitcnt lgkmcnt(0)
buffer_store_dwordx4 v[204:207], v45, s[56:59], s29 offen sc1
s_branch L2_fin
LF_spinQ:
s_mov_b32 s94, 0x10000
LF_spin2Q:
buffer_load_dwordx2 v[248:249], v46, s[16:19], 0 offen offset:0 sc1
s_sub_u32 s94, s94, 1
s_waitcnt vmcnt(0)
s_cbranch_scc1 LF_spin2Q_go
v_cmp_ne_u64 vcc, s[98:99], v[248:249]
s_nop 1
s_cbranch_vccnz LF_spin2Q
LF_spin2Q_go:
s_branch LF_goQ
LF_wf:
s_mov_b32 s94, 0x10000
LF_wf2:
buffer_load_dwordx2 v[108:109], v110, s[16:19], 0 offen sc1
s_sub_u32 s94, s94, 1
s_waitcnt vmcnt(0)
s_cbranch_scc1 LF_wf2_go
v_cmp_ne_u64 vcc, s[98:99], v[108:109]
s_nop 1
s_cbranch_vccnz LF_wf2
LF_wf2_go:
s_branch LF_wf_go
LM_pb:
s_mov_b32 s3, 0x10000
LM_pb2:
buffer_load_dwordx2 v[228:229], v230, s[16:19], 0 offen sc1
s_sub_u32 s3, s3, 1
s_waitcnt vmcnt(0)
s_cbranch_scc1 LM_pb2_go
v_cmp_ne_u64 vcc, s[98:99], v[228:229]
s_nop 1
s_cbranch_vccnz LM_pb2
LM_pb2_go:
s_branch LM_pb_ret
L2_Fend:
LT_disp:
s_cmp_ge_i32 s36, 0
s_cbranch_scc1 LT_start
s_cmp_eq_u32 s34, 0
s_cbranch_scc1 L2_end
s_mov_b32 s41, s34
s_mul_i32 s40, s34, 6
s_add_u32 s40, s40, s37
s_add_u32 s40, s40, 42
s_cmp_lt_u32 s40, 64
s_cbranch_scc1 LE_common
s_branch L2_end
LT_start:
s_waitcnt lgkmcnt(0)
s_add_u32 s12, s4, 0x7c2a000
s_addc_u32 s13, s5, 0
s_mov_b32 s14, 0x8000
s_mov_b32 s15, 0x00020000
v_and_b32 v8, 63, v0
v_lshlrev_b32 v8, 7, v8
s_mov_b32 s91, 8192
s_mov_b32 s90, 16384
s_mov_b32 s95, 24576
v_min_u32 v9, 5248, v8
s_mov_b32 s94, 0x10000
LT_poll:
buffer_load_dwordx2 v[0:1], v8, s[12:15], 0 offen sc1
buffer_load_dwordx2 v[2:3], v8, s[12:15], s91 offen sc1
buffer_load_dwordx2 v[4:5], v8, s[12:15], s90 offen sc1
buffer_load_dwordx2 v[6:7], v9, s[12:15], s95 offen sc1
s_sub_u32 s94, s94, 1
s_waitcnt vmcnt(0)
s_cbranch_scc1 LT_poll_go
v_cmp_ne_u64 vcc, s[98:99], v[0:1]
s_nop 1
s_cbranch_vccnz LT_poll
v_cmp_ne_u64 vcc, s[98:99], v[2:3]
s_nop 1
s_cbranch_vccnz LT_poll
v_cmp_ne_u64 vcc, s[98:99], v[4:5]
s_nop 1
s_cbranch_vccnz LT_poll
v_cmp_ne_u64 vcc, s[98:99], v[6:7]
s_nop 1
s_cbranch_vccnz LT_poll
LT_poll_go:
s_add_u32 s31, s31, -22
s_add_u32 s3, s28, 409600
s_cmp_eq_u32 s36, 0
s_cselect_b32 s31, 26, s31
s_cselect_b32 s39, s39, s3
s_cselect_b32 s33, s33, 0
s_cselect_b32 s3, 0, 425984
s_add_u32 s28, s28, s3
s_add_u32 s12, s4, 0x6800000
s_addc_u32 s13, s5, 0
s_mov_b32 s14, 0x0
s_mov_b32 s15, 0x00020000
s_mov_b32 s14, s49
s_add_u32 s8, s4, 0x0
s_addc_u32 s9, s5, 0
s_mov_b32 s10, 0x4e4000
s_mov_b32 s11, 0x00020000
s_mov_b32 s40, 5111808
s_mov_b32 s44, 5115904
buffer_load_dwordx4 v[0:3], v243, s[8:11], s40 offen offset:0 sc1
buffer_load_dwordx4 v[4:7], v243, s[8:11], s40 offen offset:1024 sc1
buffer_load_dwordx4 v[8:11], v243, s[8:11], s40 offen offset:2048 sc1
buffer_load_dwordx4 v[12:15], v243, s[8:11], s40 offen offset:3072 sc1
buffer_load_dwordx4 v[16:19], v243, s[8:11], s44 offen offset:0 sc1
buffer_load_dwordx4 v[20:23], v243, s[8:11], s44 offen offset:1024 sc1
buffer_load_dwordx4 v[24:27], v243, s[8:11], s44 offen offset:2048 sc1
buffer_load_dwordx4 v[28:31], v243, s[8:11], s44 offen offset:3072 sc1
s_mov_b32 s53, 0
s_add_u32 m0, s53, 90112
s_add_u32 s54, s39, 0
buffer_load_dwordx4 v241, s[12:15], s54 offen offset:0 sc1 lds
buffer_load_dwordx4 v241, s[12:15], s54 offen offset:1024 sc1 lds
buffer_load_dwordx4 v241, s[12:15], s54 offen offset:2048 sc1 lds
buffer_load_dwordx4 v241, s[12:15], s54 offen offset:3072 sc1 lds
s_add_u32 m0, s53, 94208
s_add_u32 s54, s39, 128
buffer_load_dwordx4 v241, s[12:15], s54 offen offset:0 sc1 lds
buffer_load_dwordx4 v241, s[12:15], s54 offen offset:1024 sc1 lds
buffer_load_dwordx4 v241, s[12:15], s54 offen offset:2048 sc1 lds
buffer_load_dwordx4 v241, s[12:15], s54 offen offset:3072 sc1 lds
s_add_u32 m0, s53, 98304
s_add_u32 s54, s39, 256
buffer_load_dwordx4 v241, s[12:15], s54 offen offset:0 sc1 lds
buffer_load_dwordx4 v241, s[12:15], s54 offen offset:1024 sc1 lds
buffer_load_dwordx4 v241, s[12:15], s54 offen offset:2048 sc1 lds
buffer_load_dwordx4 v241, s[12:15], s54 offen offset:3072 sc1 lds
s_add_u32 m0, s53, 102400
s_add_u32 s54, s39, 384
buffer_load_dwordx4 v241, s[12:15], s54 offen offset:0 sc1 lds
buffer_load_dwordx4 v241, s[12:15], s54 offen offset:1024 sc1 lds
buffer_load_dwordx4 v241, s[12:15], s54 offen offset:2048 sc1 lds
buffer_load_dwordx4 v241, s[12:15], s54 offen offset:3072 sc1 lds
s_add_u32 s53, s53, 0x4000
s_and_b32 s53, s53, 0xffff
s_add_u32 m0, s53, 90112
s_add_u32 s54, s28, 0
buffer_load_dwordx4 v241, s[12:15], s54 offen offset:0 sc1 lds
buffer_load_dwordx4 v241, s[12:15], s54 offen offset:1024 sc1 lds
buffer_load_dwordx4 v241, s[12:15], s54 offen offset:2048 sc1 lds
buffer_load_dwordx4 v241, s[12:15], s54 offen offset:3072 sc1 lds
s_add_u32 m0, s53, 94208
s_add_u32 s54, s28, 128
buffer_load_dwordx4 v241, s[12:15], s54 offen offset:0 sc1 lds
buffer_load_dwordx4 v241, s[12:15], s54 offen offset:1024 sc1 lds
buffer_load_dwordx4 v241, s[12:15], s54 offen offset:2048 sc1 lds
buffer_load_dwordx4 v241, s[12:15], s54 offen offset:3072 sc1 lds
s_add_u32 m0, s53, 98304
s_add_u32 s54, s28, 256
buffer_load_dwordx4 v241, s[12:15], s54 offen offset:0 sc1 lds
buffer_load_dwordx4 v241, s[12:15], s54 offen offset:1024 sc1 lds
buffer_load_dwordx4 v241, s[12:15], s54 offen offset:2048 sc1 lds
buffer_load_dwordx4 v241, s[12:15], s54 offen offset:3072 sc1 lds
s_add_u32 m0, s53, 102400
s_add_u32 s54, s28, 384
buffer_load_dwordx4 v241, s[12:15], s54 offen offset:0 sc1 lds
buffer_load_dwordx4 v241, s[12:15], s54 offen offset:1024 sc1 lds
buffer_load_dwordx4 v241, s[12:15], s54 offen offset:2048 sc1 lds
buffer_load_dwordx4 v241, s[12:15], s54 offen offset:3072 sc1 lds
s_add_u32 s53, s53, 0x4000
s_and_b32 s53, s53, 0xffff
s_add_u32 s28, s28, 0x4000
s_add_u32 m0, s53, 90112
s_add_u32 s54, s28, 0
buffer_load_dwordx4 v241, s[12:15], s54 offen offset:0 sc1 lds
buffer_load_dwordx4 v241, s[12:15], s54 offen offset:1024 sc1 lds
buffer_load_dwordx4 v241, s[12:15], s54 offen offset:2048 sc1 lds
buffer_load_dwordx4 v241, s[12:15], s54 offen offset:3072 sc1 lds
s_add_u32 m0, s53, 94208
s_add_u32 s54, s28, 128
buffer_load_dwordx4 v241, s[12:15], s54 offen offset:0 sc1 lds
buffer_load_dwordx4 v241, s[12:15], s54 offen offset:1024 sc1 lds
buffer_load_dwordx4 v241, s[12:15], s54 offen offset:2048 sc1 lds
buffer_load_dwordx4 v241, s[12:15], s54 offen offset:3072 sc1 lds
s_add_u32 m0, s53, 98304
s_add_u32 s54, s28, 256
buffer_load_dwordx4 v241, s[12:15], s54 offen offset:0 sc1 lds
buffer_load_dwordx4 v241, s[12:15], s54 offen offset:1024 sc1 lds
buffer_load_dwordx4 v241, s[12:15], s54 offen offset:2048 sc1 lds
buffer_load_dwordx4 v241, s[12:15], s54 offen offset:3072 sc1 lds
s_add_u32 m0, s53, 102400
s_add_u32 s54, s28, 384
buffer_load_dwordx4 v241, s[12:15], s54 offen offset:0 sc1 lds
buffer_load_dwordx4 v241, s[12:15], s54 offen offset:1024 sc1 lds
buffer_load_dwordx4 v241, s[12:15], s54 offen offset:2048 sc1 lds
buffer_load_dwordx4 v241, s[12:15], s54 offen offset:3072 sc1 lds
s_add_u32 s53, s53, 0x4000
s_and_b32 s53, s53, 0xffff
s_add_u32 s28, s28, 0x4000
s_mul_i32 s35, s37, 0x600000
s_add_u32 s20, s4, 0x2000000
s_addc_u32 s21, s5, 0
s_add_u32 s20, s20, s35
s_addc_u32 s21, s21, 0
s_mov_b32 s22, 0x4e4000
s_mov_b32 s23, 0x00020000
s_add_u32 s24, s4, 0x6000000
s_addc_u32 s25, s5, 0
s_mov_b32 s26, 0x139000
s_mov_b32 s27, 0x00020000
s_lshl_b32 s48, s37, 3
s_add_u32 s48, s48, 638976
s_mov_b32 s48, 1277952
v_bfe_u32 v240, v243, 4, 3
v_lshlrev_b32 v240, 6, v240
v_bfe_u32 v242, v243, 7, 1
v_lshl_or_b32 v240, v242, 10, v240
v_bfe_u32 v242, v243, 8, 2
v_lshl_or_b32 v240, v242, 4, v240
v_bfe_u32 v242, v243, 6, 1
v_lshlrev_b32 v242, 5, v242
v_xor_b32 v240, v240, v242
v_and_b32 v246, 0x1c0, v243
v_bfe_u32 v242, v243, 9, 1
v_lshl_or_b32 v246, v242, 10, v246
v_bfe_u32 v242, v243, 8, 1
v_lshl_or_b32 v246, v242, 5, v246
v_bfe_u32 v242, v243, 4, 2
v_lshl_or_b32 v246, v242, 3, v246
v_xor_b32 v247, 32, v246
v_bfe_i32 v242, v243, 8, 1
v_and_b32 v192, s33, v242
v_and_b32 v193, s33, v242
v_and_b32 v194, s33, v242
v_and_b32 v195, s33, v242
s_add_u32 s51, s31, 0
s_mov_b32 s52, 90112
v_mov_b32 v172, 0xff800000
v_mov_b32 v173, 0
v_accvgpr_write_b32 a0, 0
v_accvgpr_write_b32 a1, 0
v_accvgpr_write_b32 a2, 0
v_accvgpr_write_b32 a3, 0
v_accvgpr_write_b32 a4, 0
v_accvgpr_write_b32 a5, 0
v_accvgpr_write_b32 a6, 0
v_accvgpr_write_b32 a7, 0
v_accvgpr_write_b32 a8, 0
v_accvgpr_write_b32 a9, 0
v_accvgpr_write_b32 a10, 0
v_accvgpr_write_b32 a11, 0
v_accvgpr_write_b32 a12, 0
v_accvgpr_write_b32 a13, 0
v_accvgpr_write_b32 a14, 0
v_accvgpr_write_b32 a15, 0
v_accvgpr_write_b32 a16, 0
v_accvgpr_write_b32 a17, 0
v_accvgpr_write_b32 a18, 0
v_accvgpr_write_b32 a19, 0
v_accvgpr_write_b32 a20, 0
v_accvgpr_write_b32 a21, 0
v_accvgpr_write_b32 a22, 0
v_accvgpr_write_b32 a23, 0
v_accvgpr_write_b32 a24, 0
v_accvgpr_write_b32 a25, 0
v_accvgpr_write_b32 a26, 0
v_accvgpr_write_b32 a27, 0
v_accvgpr_write_b32 a28, 0
v_accvgpr_write_b32 a29, 0
v_accvgpr_write_b32 a30, 0
v_accvgpr_write_b32 a31, 0
v_accvgpr_write_b32 a32, 0
v_accvgpr_write_b32 a33, 0
v_accvgpr_write_b32 a34, 0
v_accvgpr_write_b32 a35, 0
v_accvgpr_write_b32 a36, 0
v_accvgpr_write_b32 a37, 0
v_accvgpr_write_b32 a38, 0
v_accvgpr_write_b32 a39, 0
v_accvgpr_write_b32 a40, 0
v_accvgpr_write_b32 a41, 0
v_accvgpr_write_b32 a42, 0
v_accvgpr_write_b32 a43, 0
v_accvgpr_write_b32 a44, 0
v_accvgpr_write_b32 a45, 0
v_accvgpr_write_b32 a46, 0
v_accvgpr_write_b32 a47, 0
v_accvgpr_write_b32 a48, 0
v_accvgpr_write_b32 a49, 0
v_accvgpr_write_b32 a50, 0
v_accvgpr_write_b32 a51, 0
v_accvgpr_write_b32 a52, 0
v_accvgpr_write_b32 a53, 0
v_accvgpr_write_b32 a54, 0
v_accvgpr_write_b32 a55, 0
v_accvgpr_write_b32 a56, 0
v_accvgpr_write_b32 a57, 0
v_accvgpr_write_b32 a58, 0
v_accvgpr_write_b32 a59, 0
v_accvgpr_write_b32 a60, 0
v_accvgpr_write_b32 a61, 0
v_accvgpr_write_b32 a62, 0
v_accvgpr_write_b32 a63, 0
LT_loop:
s_add_u32 m0, s53, 90112
s_add_u32 s54, s28, 0
buffer_load_dwordx4 v241, s[12:15], s54 offen offset:0 sc1 lds
buffer_load_dwordx4 v241, s[12:15], s54 offen offset:1024 sc1 lds
buffer_load_dwordx4 v241, s[12:15], s54 offen offset:2048 sc1 lds
buffer_load_dwordx4 v241, s[12:15], s54 offen offset:3072 sc1 lds
s_add_u32 m0, s53, 94208
s_add_u32 s54, s28, 128
buffer_load_dwordx4 v241, s[12:15], s54 offen offset:0 sc1 lds
buffer_load_dwordx4 v241, s[12:15], s54 offen offset:1024 sc1 lds
buffer_load_dwordx4 v241, s[12:15], s54 offen offset:2048 sc1 lds
buffer_load_dwordx4 v241, s[12:15], s54 offen offset:3072 sc1 lds
s_add_u32 m0, s53, 98304
s_add_u32 s54, s28, 256
buffer_load_dwordx4 v241, s[12:15], s54 offen offset:0 sc1 lds
buffer_load_dwordx4 v241, s[12:15], s54 offen offset:1024 sc1 lds
buffer_load_dwordx4 v241, s[12:15], s54 offen offset:2048 sc1 lds
buffer_load_dwordx4 v241, s[12:15], s54 offen offset:3072 sc1 lds
s_add_u32 m0, s53, 102400
s_add_u32 s54, s28, 384
buffer_load_dwordx4 v241, s[12:15], s54 offen offset:0 sc1 lds
buffer_load_dwordx4 v241, s[12:15], s54 offen offset:1024 sc1 lds
buffer_load_dwordx4 v241, s[12:15], s54 offen offset:2048 sc1 lds
buffer_load_dwordx4 v241, s[12:15], s54 offen offset:3072 sc1 lds
s_add_u32 s53, s53, 0x4000
s_and_b32 s53, s53, 0xffff
s_add_u32 s28, s28, 0x4000
v_add_u32 v177, s52, v240
v_add_u32 v178, s52, v246
v_add_u32 v179, s52, v247
s_add_u32 s52, s52, 0x4000
s_cmp_eq_u32 s52, 155648
s_cselect_b32 s52, 90112, s52
s_waitcnt vmcnt(48)
ds_read_b128 v[32:35], v177 offset:0
ds_read_b128 v[64:67], v177 offset:2048
ds_read_b128 v[36:39], v177 offset:512
ds_read_b128 v[68:71], v177 offset:2560
ds_read_b128 v[40:43], v177 offset:4096
ds_read_b128 v[72:75], v177 offset:6144
ds_read_b128 v[44:47], v177 offset:4608
ds_read_b128 v[76:79], v177 offset:6656
ds_read_b128 v[48:51], v177 offset:8192
ds_read_b128 v[80:83], v177 offset:10240
ds_read_b128 v[52:55], v177 offset:8704
ds_read_b128 v[84:87], v177 offset:10752
ds_read_b128 v[56:59], v177 offset:12288
ds_read_b128 v[88:91], v177 offset:14336
ds_read_b128 v[60:63], v177 offset:12800
ds_read_b128 v[92:95], v177 offset:14848
s_waitcnt lgkmcnt(14)
v_mfma_f32_16x16x32_bf16 v[160:163], v[32:35], v[0:3], v[192:195]
v_mfma_f32_16x16x32_bf16 v[164:167], v[64:67], v[0:3], v[192:195]
s_waitcnt lgkmcnt(12)
v_mfma_f32_16x16x32_bf16 v[160:163], v[36:39], v[4:7], v[160:163]
v_mfma_f32_16x16x32_bf16 v[164:167], v[68:71], v[4:7], v[164:167]
s_waitcnt lgkmcnt(10)
v_mfma_f32_16x16x32_bf16 v[160:163], v[40:43], v[8:11], v[160:163]
v_mfma_f32_16x16x32_bf16 v[164:167], v[72:75], v[8:11], v[164:167]
s_waitcnt lgkmcnt(8)
v_mfma_f32_16x16x32_bf16 v[160:163], v[44:47], v[12:15], v[160:163]
v_mfma_f32_16x16x32_bf16 v[164:167], v[76:79], v[12:15], v[164:167]
s_waitcnt lgkmcnt(6)
v_mfma_f32_16x16x32_bf16 v[160:163], v[48:51], v[16:19], v[160:163]
v_mfma_f32_16x16x32_bf16 v[164:167], v[80:83], v[16:19], v[164:167]
s_waitcnt lgkmcnt(4)
v_mfma_f32_16x16x32_bf16 v[160:163], v[52:55], v[20:23], v[160:163]
v_mfma_f32_16x16x32_bf16 v[164:167], v[84:87], v[20:23], v[164:167]
s_waitcnt lgkmcnt(2)
v_mfma_f32_16x16x32_bf16 v[160:163], v[56:59], v[24:27], v[160:163]
v_mfma_f32_16x16x32_bf16 v[164:167], v[88:91], v[24:27], v[164:167]
s_waitcnt lgkmcnt(0)
v_mfma_f32_16x16x32_bf16 v[160:163], v[60:63], v[28:31], v[160:163]
v_mfma_f32_16x16x32_bf16 v[164:167], v[92:95], v[28:31], v[164:167]
ds_read_b64_tr_b16 v[96:97], v178 offset:0
ds_read_b64_tr_b16 v[98:99], v178 offset:2048
ds_read_b64_tr_b16 v[100:101], v179 offset:0
ds_read_b64_tr_b16 v[102:103], v179 offset:2048
ds_read_b64_tr_b16 v[104:105], v178 offset:512
ds_read_b64_tr_b16 v[106:107], v178 offset:2560
ds_read_b64_tr_b16 v[108:109], v179 offset:512
ds_read_b64_tr_b16 v[110:111], v179 offset:2560
ds_read_b64_tr_b16 v[112:113], v178 offset:4096
ds_read_b64_tr_b16 v[114:115], v178 offset:6144
ds_read_b64_tr_b16 v[116:117], v179 offset:4096
ds_read_b64_tr_b16 v[118:119], v179 offset:6144
ds_read_b64_tr_b16 v[120:121], v178 offset:4608
ds_read_b64_tr_b16 v[122:123], v178 offset:6656
ds_read_b64_tr_b16 v[124:125], v179 offset:4608
ds_read_b64_tr_b16 v[126:127], v179 offset:6656
ds_read_b64_tr_b16 v[128:129], v178 offset:8192
ds_read_b64_tr_b16 v[130:131], v178 offset:10240
ds_read_b64_tr_b16 v[132:133], v179 offset:8192
ds_read_b64_tr_b16 v[134:135], v179 offset:10240
ds_read_b64_tr_b16 v[136:137], v178 offset:8704
ds_read_b64_tr_b16 v[138:139], v178 offset:10752
ds_read_b64_tr_b16 v[140:141], v179 offset:8704
ds_read_b64_tr_b16 v[142:143], v179 offset:10752
ds_read_b64_tr_b16 v[144:145], v178 offset:12288
ds_read_b64_tr_b16 v[146:147], v178 offset:14336
ds_read_b64_tr_b16 v[148:149], v179 offset:12288
ds_read_b64_tr_b16 v[150:151], v179 offset:14336
ds_read_b64_tr_b16 v[152:153], v178 offset:12800
ds_read_b64_tr_b16 v[154:155], v178 offset:14848
ds_read_b64_tr_b16 v[156:157], v179 offset:12800
ds_read_b64_tr_b16 v[158:159], v179 offset:14848
v_mov_b32 v192, 0
v_mov_b32 v193, 0
v_mov_b32 v194, 0
v_mov_b32 v195, 0
s_nop 7
v_max3_f32 v175, v160, v161, v162
v_max3_f32 v175, v175, v163, v164
v_max3_f32 v175, v175, v165, v166
v_max3_f32 v175, v175, v167, v172
v_mov_b32 v176, v175
s_nop 1
v_permlane32_swap_b32 v175, v176
s_nop 1
v_max_f32 v175, v175, v176
v_mov_b32 v176, v175
s_nop 1
v_permlane16_swap_b32 v175, v176
s_nop 1
v_max_f32 v175, v175, v176
v_ceil_f32 v175, v175
v_sub_f32 v174, v172, v175
v_exp_f32 v174, v174
v_mov_b32 v172, v175
v_sub_f32 v160, v160, v172
v_sub_f32 v161, v161, v172
v_sub_f32 v162, v162, v172
v_sub_f32 v163, v163, v172
v_sub_f32 v164, v164, v172
v_sub_f32 v165, v165, v172
v_sub_f32 v166, v166, v172
v_sub_f32 v167, v167, v172
v_exp_f32 v160, v160
v_exp_f32 v161, v161
v_exp_f32 v162, v162
v_exp_f32 v163, v163
v_exp_f32 v164, v164
v_exp_f32 v165, v165
v_exp_f32 v166, v166
v_exp_f32 v167, v167
v_mul_f32 v173, v173, v174
v_cvt_pk_bf16_f32 v168, v160, v161
v_cvt_pk_bf16_f32 v169, v162, v163
v_cvt_pk_bf16_f32 v170, v164, v165
v_cvt_pk_bf16_f32 v171, v166, v167
v_cmp_neq_f32 vcc, 1.0, v174
v_add_f32 v173, v173, v160
v_add_f32 v173, v173, v161
v_add_f32 v173, v173, v162
v_add_f32 v173, v173, v163
v_add_f32 v173, v173, v164
v_add_f32 v173, v173, v165
v_add_f32 v173, v173, v166
v_add_f32 v173, v173, v167
s_cbranch_vccz LT_nors
v_lshrrev_b32 v176, 4, v243
v_and_b32 v176, 0x30, v176
ds_bpermute_b32 v188, v176, v174 offset:0
ds_bpermute_b32 v189, v176, v174 offset:4
ds_bpermute_b32 v190, v176, v174 offset:8
ds_bpermute_b32 v191, v176, v174 offset:12
s_waitcnt lgkmcnt(0)
v_accvgpr_read_b32 v180, a0
v_accvgpr_read_b32 v181, a1
v_accvgpr_read_b32 v182, a2
v_accvgpr_read_b32 v183, a3
v_accvgpr_read_b32 v184, a4
v_accvgpr_read_b32 v185, a5
v_accvgpr_read_b32 v186, a6
v_accvgpr_read_b32 v187, a7
v_mul_f32 v180, v180, v188
v_mul_f32 v181, v181, v189
v_mul_f32 v182, v182, v190
v_mul_f32 v183, v183, v191
v_mul_f32 v184, v184, v188
v_mul_f32 v185, v185, v189
v_mul_f32 v186, v186, v190
v_mul_f32 v187, v187, v191
v_accvgpr_write_b32 a0, v180
v_accvgpr_write_b32 a1, v181
v_accvgpr_write_b32 a2, v182
v_accvgpr_write_b32 a3, v183
v_accvgpr_write_b32 a4, v184
v_accvgpr_write_b32 a5, v185
v_accvgpr_write_b32 a6, v186
v_accvgpr_write_b32 a7, v187
v_accvgpr_read_b32 v180, a8
v_accvgpr_read_b32 v181, a9
v_accvgpr_read_b32 v182, a10
v_accvgpr_read_b32 v183, a11
v_accvgpr_read_b32 v184, a12
v_accvgpr_read_b32 v185, a13
v_accvgpr_read_b32 v186, a14
v_accvgpr_read_b32 v187, a15
v_mul_f32 v180, v180, v188
v_mul_f32 v181, v181, v189
v_mul_f32 v182, v182, v190
v_mul_f32 v183, v183, v191
v_mul_f32 v184, v184, v188
v_mul_f32 v185, v185, v189
v_mul_f32 v186, v186, v190
v_mul_f32 v187, v187, v191
v_accvgpr_write_b32 a8, v180
v_accvgpr_write_b32 a9, v181
v_accvgpr_write_b32 a10, v182
v_accvgpr_write_b32 a11, v183
v_accvgpr_write_b32 a12, v184
v_accvgpr_write_b32 a13, v185
v_accvgpr_write_b32 a14, v186
v_accvgpr_write_b32 a15, v187
v_accvgpr_read_b32 v180, a16
v_accvgpr_read_b32 v181, a17
v_accvgpr_read_b32 v182, a18
v_accvgpr_read_b32 v183, a19
v_accvgpr_read_b32 v184, a20
v_accvgpr_read_b32 v185, a21
v_accvgpr_read_b32 v186, a22
v_accvgpr_read_b32 v187, a23
v_mul_f32 v180, v180, v188
v_mul_f32 v181, v181, v189
v_mul_f32 v182, v182, v190
v_mul_f32 v183, v183, v191
v_mul_f32 v184, v184, v188
v_mul_f32 v185, v185, v189
v_mul_f32 v186, v186, v190
v_mul_f32 v187, v187, v191
v_accvgpr_write_b32 a16, v180
v_accvgpr_write_b32 a17, v181
v_accvgpr_write_b32 a18, v182
v_accvgpr_write_b32 a19, v183
v_accvgpr_write_b32 a20, v184
v_accvgpr_write_b32 a21, v185
v_accvgpr_write_b32 a22, v186
v_accvgpr_write_b32 a23, v187
v_accvgpr_read_b32 v180, a24
v_accvgpr_read_b32 v181, a25
v_accvgpr_read_b32 v182, a26
v_accvgpr_read_b32 v183, a27
v_accvgpr_read_b32 v184, a28
v_accvgpr_read_b32 v185, a29
v_accvgpr_read_b32 v186, a30
v_accvgpr_read_b32 v187, a31
v_mul_f32 v180, v180, v188
v_mul_f32 v181, v181, v189
v_mul_f32 v182, v182, v190
v_mul_f32 v183, v183, v191
v_mul_f32 v184, v184, v188
v_mul_f32 v185, v185, v189
v_mul_f32 v186, v186, v190
v_mul_f32 v187, v187, v191
v_accvgpr_write_b32 a24, v180
v_accvgpr_write_b32 a25, v181
v_accvgpr_write_b32 a26, v182
v_accvgpr_write_b32 a27, v183
v_accvgpr_write_b32 a28, v184
v_accvgpr_write_b32 a29, v185
v_accvgpr_write_b32 a30, v186
v_accvgpr_write_b32 a31, v187
v_accvgpr_read_b32 v180, a32
v_accvgpr_read_b32 v181, a33
v_accvgpr_read_b32 v182, a34
v_accvgpr_read_b32 v183, a35
v_accvgpr_read_b32 v184, a36
v_accvgpr_read_b32 v185, a37
v_accvgpr_read_b32 v186, a38
v_accvgpr_read_b32 v187, a39
v_mul_f32 v180, v180, v188
v_mul_f32 v181, v181, v189
v_mul_f32 v182, v182, v190
v_mul_f32 v183, v183, v191
v_mul_f32 v184, v184, v188
v_mul_f32 v185, v185, v189
v_mul_f32 v186, v186, v190
v_mul_f32 v187, v187, v191
v_accvgpr_write_b32 a32, v180
v_accvgpr_write_b32 a33, v181
v_accvgpr_write_b32 a34, v182
v_accvgpr_write_b32 a35, v183
v_accvgpr_write_b32 a36, v184
v_accvgpr_write_b32 a37, v185
v_accvgpr_write_b32 a38, v186
v_accvgpr_write_b32 a39, v187
v_accvgpr_read_b32 v180, a40
v_accvgpr_read_b32 v181, a41
v_accvgpr_read_b32 v182, a42
v_accvgpr_read_b32 v183, a43
v_accvgpr_read_b32 v184, a44
v_accvgpr_read_b32 v185, a45
v_accvgpr_read_b32 v186, a46
v_accvgpr_read_b32 v187, a47
v_mul_f32 v180, v180, v188
v_mul_f32 v181, v181, v189
v_mul_f32 v182, v182, v190
v_mul_f32 v183, v183, v191
v_mul_f32 v184, v184, v188
v_mul_f32 v185, v185, v189
v_mul_f32 v186, v186, v190
v_mul_f32 v187, v187, v191
v_accvgpr_write_b32 a40, v180
v_accvgpr_write_b32 a41, v181
v_accvgpr_write_b32 a42, v182
v_accvgpr_write_b32 a43, v183
v_accvgpr_write_b32 a44, v184
v_accvgpr_write_b32 a45, v185
v_accvgpr_write_b32 a46, v186
v_accvgpr_write_b32 a47, v187
v_accvgpr_read_b32 v180, a48
v_accvgpr_read_b32 v181, a49
v_accvgpr_read_b32 v182, a50
v_accvgpr_read_b32 v183, a51
v_accvgpr_read_b32 v184, a52
v_accvgpr_read_b32 v185, a53
v_accvgpr_read_b32 v186, a54
v_accvgpr_read_b32 v187, a55
v_mul_f32 v180, v180, v188
v_mul_f32 v181, v181, v189
v_mul_f32 v182, v182, v190
v_mul_f32 v183, v183, v191
v_mul_f32 v184, v184, v188
v_mul_f32 v185, v185, v189
v_mul_f32 v186, v186, v190
v_mul_f32 v187, v187, v191
v_accvgpr_write_b32 a48, v180
v_accvgpr_write_b32 a49, v181
v_accvgpr_write_b32 a50, v182
v_accvgpr_write_b32 a51, v183
v_accvgpr_write_b32 a52, v184
v_accvgpr_write_b32 a53, v185
v_accvgpr_write_b32 a54, v186
v_accvgpr_write_b32 a55, v187
v_accvgpr_read_b32 v180, a56
v_accvgpr_read_b32 v181, a57
v_accvgpr_read_b32 v182, a58
v_accvgpr_read_b32 v183, a59
v_accvgpr_read_b32 v184, a60
v_accvgpr_read_b32 v185, a61
v_accvgpr_read_b32 v186, a62
v_accvgpr_read_b32 v187, a63
v_mul_f32 v180, v180, v188
v_mul_f32 v181, v181, v189
v_mul_f32 v182, v182, v190
v_mul_f32 v183, v183, v191
v_mul_f32 v184, v184, v188
v_mul_f32 v185, v185, v189
v_mul_f32 v186, v186, v190
v_mul_f32 v187, v187, v191
v_accvgpr_write_b32 a56, v180
v_accvgpr_write_b32 a57, v181
v_accvgpr_write_b32 a58, v182
v_accvgpr_write_b32 a59, v183
v_accvgpr_write_b32 a60, v184
v_accvgpr_write_b32 a61, v185
v_accvgpr_write_b32 a62, v186
v_accvgpr_write_b32 a63, v187
LT_nors:
s_waitcnt lgkmcnt(0)
s_nop 1
v_mfma_f32_16x16x32_bf16 a[0:3], v[168:171], v[96:99], a[0:3]
v_mfma_f32_16x16x32_bf16 a[4:7], v[168:171], v[100:103], a[4:7]
v_mfma_f32_16x16x32_bf16 a[8:11], v[168:171], v[104:107], a[8:11]
v_mfma_f32_16x16x32_bf16 a[12:15], v[168:171], v[108:111], a[12:15]
v_mfma_f32_16x16x32_bf16 a[16:19], v[168:171], v[112:115], a[16:19]
v_mfma_f32_16x16x32_bf16 a[20:23], v[168:171], v[116:119], a[20:23]
v_mfma_f32_16x16x32_bf16 a[24:27], v[168:171], v[120:123], a[24:27]
v_mfma_f32_16x16x32_bf16 a[28:31], v[168:171], v[124:127], a[28:31]
v_mfma_f32_16x16x32_bf16 a[32:35], v[168:171], v[128:131], a[32:35]
v_mfma_f32_16x16x32_bf16 a[36:39], v[168:171], v[132:135], a[36:39]
v_mfma_f32_16x16x32_bf16 a[40:43], v[168:171], v[136:139], a[40:43]
v_mfma_f32_16x16x32_bf16 a[44:47], v[168:171], v[140:143], a[44:47]
v_mfma_f32_16x16x32_bf16 a[48:51], v[168:171], v[144:147], a[48:51]
v_mfma_f32_16x16x32_bf16 a[52:55], v[168:171], v[148:151], a[52:55]
v_mfma_f32_16x16x32_bf16 a[56:59], v[168:171], v[152:155], a[56:59]
v_mfma_f32_16x16x32_bf16 a[60:63], v[168:171], v[156:159], a[60:63]
s_sub_u32 s51, s51, 1
s_cmp_lg_u32 s51, 0
s_cbranch_scc1 LT_loop
s_nop 15
s_add_u32 s16, s4, 0x0
s_addc_u32 s17, s5, 0
s_mov_b32 s18, 0x10000000
s_mov_b32 s19, 0x00020000
s_mul_i32 s52, s37, 0x5000
s_add_u32 s52, s52, 0x1200000
s_add_u32 s53, s37, 1610
s_lshl_b32 s53, s53, 7
s_add_u32 s53, s53, 0x7c00000
s_waitcnt vmcnt(0)
s_cmp_eq_u32 s36, 0
s_cbranch_scc1 LT_merge
buffer_store_dwordx4 a[0:3], v243, s[16:19], s52 offen offset:0 sc1
buffer_store_dwordx4 a[4:7], v243, s[16:19], s52 offen offset:1024 sc1
buffer_store_dwordx4 a[8:11], v243, s[16:19], s52 offen offset:2048 sc1
buffer_store_dwordx4 a[12:15], v243, s[16:19], s52 offen offset:3072 sc1
s_add_u32 s52, s52, 4096
buffer_store_dwordx4 a[16:19], v243, s[16:19], s52 offen offset:0 sc1
buffer_store_dwordx4 a[20:23], v243, s[16:19], s52 offen offset:1024 sc1
buffer_store_dwordx4 a[24:27], v243, s[16:19], s52 offen offset:2048 sc1
buffer_store_dwordx4 a[28:31], v243, s[16:19], s52 offen offset:3072 sc1
s_add_u32 s52, s52, 4096
buffer_store_dwordx4 a[32:35], v243, s[16:19], s52 offen offset:0 sc1
buffer_store_dwordx4 a[36:39], v243, s[16:19], s52 offen offset:1024 sc1
buffer_store_dwordx4 a[40:43], v243, s[16:19], s52 offen offset:2048 sc1
buffer_store_dwordx4 a[44:47], v243, s[16:19], s52 offen offset:3072 sc1
s_add_u32 s52, s52, 4096
buffer_store_dwordx4 a[48:51], v243, s[16:19], s52 offen offset:0 sc1
buffer_store_dwordx4 a[52:55], v243, s[16:19], s52 offen offset:1024 sc1
buffer_store_dwordx4 a[56:59], v243, s[16:19], s52 offen offset:2048 sc1
buffer_store_dwordx4 a[60:63], v243, s[16:19], s52 offen offset:3072 sc1
s_add_u32 s52, s52, 4096
buffer_store_dwordx2 v[172:173], v243, s[16:19], s52 offen sc1
s_waitcnt vmcnt(0)
v_mov_b32 v176, s98
v_mov_b32 v177, s99
s_mov_b64 exec, 1
buffer_store_dwordx2 v[176:177], off, s[16:19], s53 sc1
s_mov_b64 exec, -1
s_branch L2_fin
LT_merge:
s_mov_b32 s94, 0x10000
LT_mw:
buffer_load_dwordx2 v[0:1], off, s[16:19], s53 sc1
s_sub_u32 s94, s94, 1
s_waitcnt vmcnt(0)
s_cbranch_scc1 LT_mw_go
v_cmp_ne_u64 vcc, s[98:99], v[0:1]
s_nop 1
s_cbranch_vccnz LT_mw
LT_mw_go:
buffer_load_dwordx4 v[96:99], v243, s[16:19], s52 offen offset:0 sc1
buffer_load_dwordx4 v[100:103], v243, s[16:19], s52 offen offset:1024 sc1
buffer_load_dwordx4 v[104:107], v243, s[16:19], s52 offen offset:2048 sc1
buffer_load_dwordx4 v[108:111], v243, s[16:19], s52 offen offset:3072 sc1
s_add_u32 s52, s52, 4096
buffer_load_dwordx4 v[112:115], v243, s[16:19], s52 offen offset:0 sc1
buffer_load_dwordx4 v[116:119], v243, s[16:19], s52 offen offset:1024 sc1
buffer_load_dwordx4 v[120:123], v243, s[16:19], s52 offen offset:2048 sc1
buffer_load_dwordx4 v[124:127], v243, s[16:19], s52 offen offset:3072 sc1
s_add_u32 s52, s52, 4096
buffer_load_dwordx4 v[128:131], v243, s[16:19], s52 offen offset:0 sc1
buffer_load_dwordx4 v[132:135], v243, s[16:19], s52 offen offset:1024 sc1
buffer_load_dwordx4 v[136:139], v243, s[16:19], s52 offen offset:2048 sc1
buffer_load_dwordx4 v[140:143], v243, s[16:19], s52 offen offset:3072 sc1
s_add_u32 s52, s52, 4096
buffer_load_dwordx4 v[144:147], v243, s[16:19], s52 offen offset:0 sc1
buffer_load_dwordx4 v[148:151], v243, s[16:19], s52 offen offset:1024 sc1
buffer_load_dwordx4 v[152:155], v243, s[16:19], s52 offen offset:2048 sc1
buffer_load_dwordx4 v[156:159], v243, s[16:19], s52 offen offset:3072 sc1
s_add_u32 s52, s52, 4096
buffer_load_dwordx2 v[0:1], v243, s[16:19], s52 offen sc1
v_lshrrev_b32 v176, 4, v243
v_and_b32 v176, 0x30, v176
s_waitcnt vmcnt(0)
v_max_f32 v175, v172, v0
v_sub_f32 v2, v172, v175
v_sub_f32 v3, v0, v175
v_mov_b32 v172, v175
v_exp_f32 v2, v2
v_exp_f32 v3, v3
s_nop 0
v_mul_f32 v173, v173, v2
v_fmac_f32 v173, v1, v3
ds_bpermute_b32 v4, v176, v2 offset:0
ds_bpermute_b32 v8, v176, v3 offset:0
ds_bpermute_b32 v5, v176, v2 offset:4
ds_bpermute_b32 v9, v176, v3 offset:4
ds_bpermute_b32 v6, v176, v2 offset:8
ds_bpermute_b32 v10, v176, v3 offset:8
ds_bpermute_b32 v7, v176, v2 offset:12
ds_bpermute_b32 v11, v176, v3 offset:12
s_waitcnt lgkmcnt(0)
v_accvgpr_read_b32 v180, a0
v_accvgpr_read_b32 v181, a1
v_accvgpr_read_b32 v182, a2
v_accvgpr_read_b32 v183, a3
v_accvgpr_read_b32 v184, a4
v_accvgpr_read_b32 v185, a5
v_accvgpr_read_b32 v186, a6
v_accvgpr_read_b32 v187, a7
v_mul_f32 v180, v180, v4
v_mul_f32 v181, v181, v5
v_mul_f32 v182, v182, v6
v_mul_f32 v183, v183, v7
v_mul_f32 v184, v184, v4
v_mul_f32 v185, v185, v5
v_mul_f32 v186, v186, v6
v_mul_f32 v187, v187, v7
v_fmac_f32 v180, v96, v8
v_fmac_f32 v181, v97, v9
v_fmac_f32 v182, v98, v10
v_fmac_f32 v183, v99, v11
v_fmac_f32 v184, v100, v8
v_fmac_f32 v185, v101, v9
v_fmac_f32 v186, v102, v10
v_fmac_f32 v187, v103, v11
v_cvt_pk_bf16_f32 v32, v180, v181
v_cvt_pk_bf16_f32 v33, v182, v183
v_cvt_pk_bf16_f32 v34, v184, v185
v_cvt_pk_bf16_f32 v35, v186, v187
buffer_store_dwordx4 v[32:35], v243, s[20:23], s40 offen offset:0 sc1
v_accvgpr_read_b32 v180, a8
v_accvgpr_read_b32 v181, a9
v_accvgpr_read_b32 v182, a10
v_accvgpr_read_b32 v183, a11
v_accvgpr_read_b32 v184, a12
v_accvgpr_read_b32 v185, a13
v_accvgpr_read_b32 v186, a14
v_accvgpr_read_b32 v187, a15
v_mul_f32 v180, v180, v4
v_mul_f32 v181, v181, v5
v_mul_f32 v182, v182, v6
v_mul_f32 v183, v183, v7
v_mul_f32 v184, v184, v4
v_mul_f32 v185, v185, v5
v_mul_f32 v186, v186, v6
v_mul_f32 v187, v187, v7
v_fmac_f32 v180, v104, v8
v_fmac_f32 v181, v105, v9
v_fmac_f32 v182, v106, v10
v_fmac_f32 v183, v107, v11
v_fmac_f32 v184, v108, v8
v_fmac_f32 v185, v109, v9
v_fmac_f32 v186, v110, v10
v_fmac_f32 v187, v111, v11
v_cvt_pk_bf16_f32 v36, v180, v181
v_cvt_pk_bf16_f32 v37, v182, v183
v_cvt_pk_bf16_f32 v38, v184, v185
v_cvt_pk_bf16_f32 v39, v186, v187
buffer_store_dwordx4 v[36:39], v243, s[20:23], s40 offen offset:1024 sc1
v_accvgpr_read_b32 v180, a16
v_accvgpr_read_b32 v181, a17
v_accvgpr_read_b32 v182, a18
v_accvgpr_read_b32 v183, a19
v_accvgpr_read_b32 v184, a20
v_accvgpr_read_b32 v185, a21
v_accvgpr_read_b32 v186, a22
v_accvgpr_read_b32 v187, a23
v_mul_f32 v180, v180, v4
v_mul_f32 v181, v181, v5
v_mul_f32 v182, v182, v6
v_mul_f32 v183, v183, v7
v_mul_f32 v184, v184, v4
v_mul_f32 v185, v185, v5
v_mul_f32 v186, v186, v6
v_mul_f32 v187, v187, v7
v_fmac_f32 v180, v112, v8
v_fmac_f32 v181, v113, v9
v_fmac_f32 v182, v114, v10
v_fmac_f32 v183, v115, v11
v_fmac_f32 v184, v116, v8
v_fmac_f32 v185, v117, v9
v_fmac_f32 v186, v118, v10
v_fmac_f32 v187, v119, v11
v_cvt_pk_bf16_f32 v40, v180, v181
v_cvt_pk_bf16_f32 v41, v182, v183
v_cvt_pk_bf16_f32 v42, v184, v185
v_cvt_pk_bf16_f32 v43, v186, v187
buffer_store_dwordx4 v[40:43], v243, s[20:23], s40 offen offset:2048 sc1
v_accvgpr_read_b32 v180, a24
v_accvgpr_read_b32 v181, a25
v_accvgpr_read_b32 v182, a26
v_accvgpr_read_b32 v183, a27
v_accvgpr_read_b32 v184, a28
v_accvgpr_read_b32 v185, a29
v_accvgpr_read_b32 v186, a30
v_accvgpr_read_b32 v187, a31
v_mul_f32 v180, v180, v4
v_mul_f32 v181, v181, v5
v_mul_f32 v182, v182, v6
v_mul_f32 v183, v183, v7
v_mul_f32 v184, v184, v4
v_mul_f32 v185, v185, v5
v_mul_f32 v186, v186, v6
v_mul_f32 v187, v187, v7
v_fmac_f32 v180, v120, v8
v_fmac_f32 v181, v121, v9
v_fmac_f32 v182, v122, v10
v_fmac_f32 v183, v123, v11
v_fmac_f32 v184, v124, v8
v_fmac_f32 v185, v125, v9
v_fmac_f32 v186, v126, v10
v_fmac_f32 v187, v127, v11
v_cvt_pk_bf16_f32 v44, v180, v181
v_cvt_pk_bf16_f32 v45, v182, v183
v_cvt_pk_bf16_f32 v46, v184, v185
v_cvt_pk_bf16_f32 v47, v186, v187
buffer_store_dwordx4 v[44:47], v243, s[20:23], s40 offen offset:3072 sc1
v_accvgpr_read_b32 v180, a32
v_accvgpr_read_b32 v181, a33
v_accvgpr_read_b32 v182, a34
v_accvgpr_read_b32 v183, a35
v_accvgpr_read_b32 v184, a36
v_accvgpr_read_b32 v185, a37
v_accvgpr_read_b32 v186, a38
v_accvgpr_read_b32 v187, a39
v_mul_f32 v180, v180, v4
v_mul_f32 v181, v181, v5
v_mul_f32 v182, v182, v6
v_mul_f32 v183, v183, v7
v_mul_f32 v184, v184, v4
v_mul_f32 v185, v185, v5
v_mul_f32 v186, v186, v6
v_mul_f32 v187, v187, v7
v_fmac_f32 v180, v128, v8
v_fmac_f32 v181, v129, v9
v_fmac_f32 v182, v130, v10
v_fmac_f32 v183, v131, v11
v_fmac_f32 v184, v132, v8
v_fmac_f32 v185, v133, v9
v_fmac_f32 v186, v134, v10
v_fmac_f32 v187, v135, v11
v_cvt_pk_bf16_f32 v48, v180, v181
v_cvt_pk_bf16_f32 v49, v182, v183
v_cvt_pk_bf16_f32 v50, v184, v185
v_cvt_pk_bf16_f32 v51, v186, v187
buffer_store_dwordx4 v[48:51], v243, s[20:23], s44 offen offset:0 sc1
v_accvgpr_read_b32 v180, a40
v_accvgpr_read_b32 v181, a41
v_accvgpr_read_b32 v182, a42
v_accvgpr_read_b32 v183, a43
v_accvgpr_read_b32 v184, a44
v_accvgpr_read_b32 v185, a45
v_accvgpr_read_b32 v186, a46
v_accvgpr_read_b32 v187, a47
v_mul_f32 v180, v180, v4
v_mul_f32 v181, v181, v5
v_mul_f32 v182, v182, v6
v_mul_f32 v183, v183, v7
v_mul_f32 v184, v184, v4
v_mul_f32 v185, v185, v5
v_mul_f32 v186, v186, v6
v_mul_f32 v187, v187, v7
v_fmac_f32 v180, v136, v8
v_fmac_f32 v181, v137, v9
v_fmac_f32 v182, v138, v10
v_fmac_f32 v183, v139, v11
v_fmac_f32 v184, v140, v8
v_fmac_f32 v185, v141, v9
v_fmac_f32 v186, v142, v10
v_fmac_f32 v187, v143, v11
v_cvt_pk_bf16_f32 v52, v180, v181
v_cvt_pk_bf16_f32 v53, v182, v183
v_cvt_pk_bf16_f32 v54, v184, v185
v_cvt_pk_bf16_f32 v55, v186, v187
buffer_store_dwordx4 v[52:55], v243, s[20:23], s44 offen offset:1024 sc1
v_accvgpr_read_b32 v180, a48
v_accvgpr_read_b32 v181, a49
v_accvgpr_read_b32 v182, a50
v_accvgpr_read_b32 v183, a51
v_accvgpr_read_b32 v184, a52
v_accvgpr_read_b32 v185, a53
v_accvgpr_read_b32 v186, a54
v_accvgpr_read_b32 v187, a55
v_mul_f32 v180, v180, v4
v_mul_f32 v181, v181, v5
v_mul_f32 v182, v182, v6
v_mul_f32 v183, v183, v7
v_mul_f32 v184, v184, v4
v_mul_f32 v185, v185, v5
v_mul_f32 v186, v186, v6
v_mul_f32 v187, v187, v7
v_fmac_f32 v180, v144, v8
v_fmac_f32 v181, v145, v9
v_fmac_f32 v182, v146, v10
v_fmac_f32 v183, v147, v11
v_fmac_f32 v184, v148, v8
v_fmac_f32 v185, v149, v9
v_fmac_f32 v186, v150, v10
v_fmac_f32 v187, v151, v11
v_cvt_pk_bf16_f32 v56, v180, v181
v_cvt_pk_bf16_f32 v57, v182, v183
v_cvt_pk_bf16_f32 v58, v184, v185
v_cvt_pk_bf16_f32 v59, v186, v187
buffer_store_dwordx4 v[56:59], v243, s[20:23], s44 offen offset:2048 sc1
v_accvgpr_read_b32 v180, a56
v_accvgpr_read_b32 v181, a57
v_accvgpr_read_b32 v182, a58
v_accvgpr_read_b32 v183, a59
v_accvgpr_read_b32 v184, a60
v_accvgpr_read_b32 v185, a61
v_accvgpr_read_b32 v186, a62
v_accvgpr_read_b32 v187, a63
v_mul_f32 v180, v180, v4
v_mul_f32 v181, v181, v5
v_mul_f32 v182, v182, v6
v_mul_f32 v183, v183, v7
v_mul_f32 v184, v184, v4
v_mul_f32 v185, v185, v5
v_mul_f32 v186, v186, v6
v_mul_f32 v187, v187, v7
v_fmac_f32 v180, v152, v8
v_fmac_f32 v181, v153, v9
v_fmac_f32 v182, v154, v10
v_fmac_f32 v183, v155, v11
v_fmac_f32 v184, v156, v8
v_fmac_f32 v185, v157, v9
v_fmac_f32 v186, v158, v10
v_fmac_f32 v187, v159, v11
v_cvt_pk_bf16_f32 v60, v180, v181
v_cvt_pk_bf16_f32 v61, v182, v183
v_cvt_pk_bf16_f32 v62, v184, v185
v_cvt_pk_bf16_f32 v63, v186, v187
buffer_store_dwordx4 v[60:63], v243, s[20:23], s44 offen offset:3072 sc1
v_mov_b32 v176, v173
s_nop 1
v_permlane32_swap_b32 v173, v176
s_nop 1
v_add_f32 v173, v173, v176
v_mov_b32 v176, v173
s_nop 1
v_permlane16_swap_b32 v173, v176
s_nop 1
v_add_f32 v173, v173, v176
v_lshlrev_b32 v175, 2, v243
s_mov_b64 exec, 0xffff
s_mov_b64 exec, -1
v_bfe_u32 v175, v243, 8, 1
v_mul_u32_u24 v175, 48, v175
v_lshl_add_u32 v175, s37, 3, v175
v_and_b32 v176, 0xf0, v243
v_lshl_add_u32 v175, v176, 3, v175
s_mov_b32 exec_hi, 0
buffer_store_dwordx2 v[172:173], v175, s[24:27], s48 offen sc1
s_add_u32 s16, s4, 0x7c00000
s_addc_u32 s17, s5, 0
s_mov_b32 s18, 0x40000
s_mov_b32 s19, 0x00020000
s_add_u32 s48, s37, 1248
s_mul_i32 s48, s48, 128
s_waitcnt vmcnt(0)
v_mov_b32 v176, s98
v_mov_b32 v177, s99
s_mov_b64 exec, 1
buffer_store_dwordx2 v[176:177], off, s[16:19], s48 sc1
buffer_store_dwordx2 v[176:177], off, s[16:19], s48 offset:8 sc1
s_mov_b64 exec, -1
s_branch L2_fin
LE_start:
s_cmp_ge_u32 s37, 32
s_cbranch_scc1 L2_end
v_lshrrev_b32 v1, 6, v0
s_sub_u32 s37, s37, 30
s_lshl_b32 s35, s35, 1
v_readfirstlane_b32 s41, v1
s_add_u32 s35, s35, s37
s_mul_i32 s35, s35, 3
s_add_u32 s40, s35, s41
s_cmp_ge_u32 s41, 3
s_cbranch_scc1 L2_end
LE_common:
v_and_b32 v1, 63, v0
s_sub_u32 s36, s40, 0
s_mov_b32 s54, 151
s_mul_i32 s36, s36, 151
s_mov_b32 s55, s36
s_sub_u32 s36, s40, 36
s_cselect_b32 s54, s54, 166
s_mul_i32 s36, s36, 166
s_add_u32 s36, s36, 5436
s_cmp_lt_u32 s40, 36
s_cselect_b32 s55, s55, s36
s_sub_u32 s36, s40, 42
s_cselect_b32 s54, s54, 152
s_mul_i32 s36, s36, 152
s_add_u32 s36, s36, 6432
s_cmp_lt_u32 s40, 42
s_cselect_b32 s55, s55, s36
s_sub_u32 s36, s40, 48
s_cselect_b32 s54, s54, 168
s_mul_i32 s36, s36, 168
s_add_u32 s36, s36, 7344
s_cmp_lt_u32 s40, 48
s_cselect_b32 s55, s55, s36
s_mov_b32 s42, 0
s_mov_b32 s49, 512
v_lshrrev_b32 v33, 2, v1
v_and_b32 v34, 3, v1
v_mul_u32_u24 v6, 0xa000, v33
v_lshl_add_u32 v6, v34, 4, v6
v_lshlrev_b32 v33, 2, v33
s_mul_i32 s50, s40, 655360
s_mul_i32 s48, s40, 64
s_waitcnt lgkmcnt(0)
s_add_u32 s8, s4, 0x7c31800
s_addc_u32 s9, s5, 0
s_mov_b32 s10, 0x800
s_mov_b32 s11, 0x00020000
v_and_b32 v194, 15, v0
v_lshlrev_b32 v194, 7, v194
s_mov_b32 s94, 0x10000
LE_poll0:
buffer_load_dwordx2 v[192:193], v194, s[8:11], 0 offen sc1
s_sub_u32 s94, s94, 1
s_waitcnt vmcnt(0)
s_cbranch_scc1 LE_poll0_go
v_cmp_ne_u64 vcc, s[98:99], v[192:193]
s_nop 1
s_cbranch_vccnz LE_poll0
LE_poll0_go:
s_add_u32 s8, s4, 0x7800000
s_addc_u32 s9, s5, 0
s_mov_b32 s10, 0x1000
s_mov_b32 s11, 0x00020000
s_add_u32 s12, s4, 0x8000000
s_addc_u32 s13, s5, 0
s_mov_b32 s14, 0x2800000
s_mov_b32 s15, 0x00020000
buffer_load_dword v4, v33, s[8:11], s48 offen sc1
buffer_load_dwordx4 v[192:195], v6, s[12:15], s50 offen offset:0 sc1
buffer_load_dwordx4 v[196:199], v6, s[12:15], s50 offen offset:64 sc1
buffer_load_dwordx4 v[200:203], v6, s[12:15], s50 offen offset:128 sc1
buffer_load_dwordx4 v[204:207], v6, s[12:15], s50 offen offset:192 sc1
buffer_load_dwordx4 v[208:211], v6, s[12:15], s50 offen offset:256 sc1
buffer_load_dwordx4 v[212:215], v6, s[12:15], s50 offen offset:320 sc1
buffer_load_dwordx4 v[216:219], v6, s[12:15], s50 offen offset:384 sc1
buffer_load_dwordx4 v[220:223], v6, s[12:15], s50 offen offset:448 sc1
buffer_load_dwordx4 v[224:227], v6, s[12:15], s50 offen offset:512 sc1
buffer_load_dwordx4 v[228:231], v6, s[12:15], s50 offen offset:576 sc1
buffer_load_dwordx4 v[232:235], v6, s[12:15], s50 offen offset:640 sc1
buffer_load_dwordx4 v[236:239], v6, s[12:15], s50 offen offset:704 sc1
buffer_load_dwordx4 v[240:243], v6, s[12:15], s50 offen offset:768 sc1
buffer_load_dwordx4 v[244:247], v6, s[12:15], s50 offen offset:832 sc1
buffer_load_dwordx4 v[248:251], v6, s[12:15], s50 offen offset:896 sc1
buffer_load_dwordx4 v[252:255], v6, s[12:15], s50 offen offset:960 sc1
s_add_u32 s16, s4, 0x6800000
s_addc_u32 s17, s5, 0
s_mov_b32 s18, 0x4e2000
s_mov_b32 s19, 0x00020000
s_add_u32 s20, s4, 0x7000000
s_addc_u32 s21, s5, 0
s_mov_b32 s22, 0x4e2000
s_mov_b32 s23, 0x00020000
v_lshlrev_b32 v5, 2, v34
v_and_b32 v2, 15, v1
v_lshrrev_b32 v3, 4, v1
v_mov_b32 v16, 1
v_mov_b32 v17, 4
v_and_b32 v33, 1, v2
v_lshlrev_b32 v33, 4, v33
v_lshlrev_b32 v33, v33, v16
v_mul_u32_u24 v33, 0x3f80, v33
v_lshrrev_b32 v34, 1, v2
v_cmp_eq_u32 vcc, 0, v34
s_nop 1
v_cndmask_b32 v40, 0, v33, vcc
v_cmp_eq_u32 vcc, 1, v34
s_nop 1
v_cndmask_b32 v41, 0, v33, vcc
v_cmp_eq_u32 vcc, 2, v34
s_nop 1
v_cndmask_b32 v42, 0, v33, vcc
v_cmp_eq_u32 vcc, 3, v34
s_nop 1
v_cndmask_b32 v43, 0, v33, vcc
v_cmp_eq_u32 vcc, 4, v34
s_nop 1
v_cndmask_b32 v44, 0, v33, vcc
v_cmp_eq_u32 vcc, 5, v34
s_nop 1
v_cndmask_b32 v45, 0, v33, vcc
v_cmp_eq_u32 vcc, 6, v34
s_nop 1
v_cndmask_b32 v46, 0, v33, vcc
v_cmp_eq_u32 vcc, 7, v34
s_nop 1
v_cndmask_b32 v47, 0, v33, vcc
v_lshlrev_b32 v39, 5, v2
v_lshl_add_u32 v39, v3, 3, v39
v_lshlrev_b32 v2, 4, v2
s_mul_i32 s48, s41, 21504
s_add_u32 s48, s48, 4096
v_mov_b32 v36, s48
v_lshl_add_u32 v38, v3, 2, v36
s_lshl_b32 s36, s41, 10
s_lshl_b32 s35, s55, 2
s_sub_u32 s35, s36, s35
v_mov_b32 v7, s35
v_lshlrev_b32 v35, 4, v1
v_add_u32 v68, s48, v35
v_add_u32 v35, s36, v35
v_lshlrev_b32 v33, 2, v1
v_mov_b32 v72, 0xffff
v_mov_b32 v73, 0xffff
v_mov_b32 v74, 0xffff
v_mov_b32 v75, 0xffff
v_cmp_gt_u32 vcc, s54, v33
v_mov_b32 v48, 0
s_nop 0
v_cndmask_b32 v18, 0, v16, vcc
v_add_u32 v33, 1, v33
v_cmp_gt_u32 vcc, s54, v33
v_mov_b32 v49, 0
s_nop 0
v_cndmask_b32 v19, 0, v16, vcc
v_add_u32 v33, 1, v33
v_cmp_gt_u32 vcc, s54, v33
v_mov_b32 v50, 0
s_nop 0
v_cndmask_b32 v20, 0, v16, vcc
v_add_u32 v33, 1, v33
v_cmp_gt_u32 vcc, s54, v33
v_mov_b32 v51, 0
s_nop 0
v_cndmask_b32 v21, 0, v16, vcc
LE_pass:
ds_write_b128 v35, v[48:51]
ds_write_b128 v68, v[72:75] offset:0
ds_write_b128 v68, v[72:75] offset:1024
ds_write_b128 v68, v[72:75] offset:2048
ds_write_b128 v68, v[72:75] offset:3072
ds_write_b128 v68, v[72:75] offset:4096
ds_write_b128 v68, v[72:75] offset:5120
ds_write_b128 v68, v[72:75] offset:6144
ds_write_b128 v68, v[72:75] offset:7168
ds_write_b128 v68, v[72:75] offset:8192
ds_write_b128 v68, v[72:75] offset:9216
ds_write_b128 v68, v[72:75] offset:10240
ds_write_b128 v68, v[72:75] offset:11264
ds_write_b128 v68, v[72:75] offset:12288
ds_write_b128 v68, v[72:75] offset:13312
ds_write_b128 v68, v[72:75] offset:14336
ds_write_b128 v68, v[72:75] offset:15360
ds_write_b128 v68, v[72:75] offset:16384
ds_write_b128 v68, v[72:75] offset:17408
ds_write_b128 v68, v[72:75] offset:18432
ds_write_b128 v68, v[72:75] offset:19456
v_lshl_add_u32 v32, v1, 2, v36
ds_write_b32 v32, v48 offset:20480
s_waitcnt vmcnt(16)
v_sub_u32 v32, v4, v5
s_waitcnt vmcnt(15)
v_cmpx_lt_i32 vcc, 0, v32
s_cbranch_execz LE_c
v_mad_u32_u16 v128, v192, 1, v7 op_sel:[1,0,0,0]
ds_add_u32 v128, v16
v_cmpx_lt_i32 vcc, 1, v32
v_mad_u32_u16 v129, v193, 1, v7 op_sel:[1,0,0,0]
ds_add_u32 v129, v16
v_cmpx_lt_i32 vcc, 2, v32
v_mad_u32_u16 v130, v194, 1, v7 op_sel:[1,0,0,0]
ds_add_u32 v130, v16
v_cmpx_lt_i32 vcc, 3, v32
v_mad_u32_u16 v131, v195, 1, v7 op_sel:[1,0,0,0]
ds_add_u32 v131, v16
s_waitcnt vmcnt(14)
v_cmpx_lt_i32 vcc, 16, v32
s_cbranch_execz LE_c
v_mad_u32_u16 v132, v196, 1, v7 op_sel:[1,0,0,0]
ds_add_u32 v132, v16
v_cmpx_lt_i32 vcc, 17, v32
v_mad_u32_u16 v133, v197, 1, v7 op_sel:[1,0,0,0]
ds_add_u32 v133, v16
v_cmpx_lt_i32 vcc, 18, v32
v_mad_u32_u16 v134, v198, 1, v7 op_sel:[1,0,0,0]
ds_add_u32 v134, v16
v_cmpx_lt_i32 vcc, 19, v32
v_mad_u32_u16 v135, v199, 1, v7 op_sel:[1,0,0,0]
ds_add_u32 v135, v16
s_waitcnt vmcnt(13)
v_cmpx_lt_i32 vcc, 32, v32
s_cbranch_execz LE_c
v_mad_u32_u16 v136, v200, 1, v7 op_sel:[1,0,0,0]
ds_add_u32 v136, v16
v_cmpx_lt_i32 vcc, 33, v32
v_mad_u32_u16 v137, v201, 1, v7 op_sel:[1,0,0,0]
ds_add_u32 v137, v16
v_cmpx_lt_i32 vcc, 34, v32
v_mad_u32_u16 v138, v202, 1, v7 op_sel:[1,0,0,0]
ds_add_u32 v138, v16
v_cmpx_lt_i32 vcc, 35, v32
v_mad_u32_u16 v139, v203, 1, v7 op_sel:[1,0,0,0]
ds_add_u32 v139, v16
s_waitcnt vmcnt(12)
v_cmpx_lt_i32 vcc, 48, v32
s_cbranch_execz LE_c
v_mad_u32_u16 v140, v204, 1, v7 op_sel:[1,0,0,0]
ds_add_u32 v140, v16
v_cmpx_lt_i32 vcc, 49, v32
v_mad_u32_u16 v141, v205, 1, v7 op_sel:[1,0,0,0]
ds_add_u32 v141, v16
v_cmpx_lt_i32 vcc, 50, v32
v_mad_u32_u16 v142, v206, 1, v7 op_sel:[1,0,0,0]
ds_add_u32 v142, v16
v_cmpx_lt_i32 vcc, 51, v32
v_mad_u32_u16 v143, v207, 1, v7 op_sel:[1,0,0,0]
ds_add_u32 v143, v16
s_waitcnt vmcnt(11)
v_cmpx_lt_i32 vcc, 64, v32
s_cbranch_execz LE_c
v_mad_u32_u16 v144, v208, 1, v7 op_sel:[1,0,0,0]
ds_add_u32 v144, v16
v_cmpx_lt_i32 vcc, 65, v32
v_mad_u32_u16 v145, v209, 1, v7 op_sel:[1,0,0,0]
ds_add_u32 v145, v16
v_cmpx_lt_i32 vcc, 66, v32
v_mad_u32_u16 v146, v210, 1, v7 op_sel:[1,0,0,0]
ds_add_u32 v146, v16
v_cmpx_lt_i32 vcc, 67, v32
v_mad_u32_u16 v147, v211, 1, v7 op_sel:[1,0,0,0]
ds_add_u32 v147, v16
s_waitcnt vmcnt(10)
v_cmpx_lt_i32 vcc, 80, v32
s_cbranch_execz LE_c
v_mad_u32_u16 v148, v212, 1, v7 op_sel:[1,0,0,0]
ds_add_u32 v148, v16
v_cmpx_lt_i32 vcc, 81, v32
v_mad_u32_u16 v149, v213, 1, v7 op_sel:[1,0,0,0]
ds_add_u32 v149, v16
v_cmpx_lt_i32 vcc, 82, v32
v_mad_u32_u16 v150, v214, 1, v7 op_sel:[1,0,0,0]
ds_add_u32 v150, v16
v_cmpx_lt_i32 vcc, 83, v32
v_mad_u32_u16 v151, v215, 1, v7 op_sel:[1,0,0,0]
ds_add_u32 v151, v16
s_waitcnt vmcnt(9)
v_cmpx_lt_i32 vcc, 96, v32
s_cbranch_execz LE_c
v_mad_u32_u16 v152, v216, 1, v7 op_sel:[1,0,0,0]
ds_add_u32 v152, v16
v_cmpx_lt_i32 vcc, 97, v32
v_mad_u32_u16 v153, v217, 1, v7 op_sel:[1,0,0,0]
ds_add_u32 v153, v16
v_cmpx_lt_i32 vcc, 98, v32
v_mad_u32_u16 v154, v218, 1, v7 op_sel:[1,0,0,0]
ds_add_u32 v154, v16
v_cmpx_lt_i32 vcc, 99, v32
v_mad_u32_u16 v155, v219, 1, v7 op_sel:[1,0,0,0]
ds_add_u32 v155, v16
s_waitcnt vmcnt(8)
v_cmpx_lt_i32 vcc, 112, v32
s_cbranch_execz LE_c
v_mad_u32_u16 v156, v220, 1, v7 op_sel:[1,0,0,0]
ds_add_u32 v156, v16
v_cmpx_lt_i32 vcc, 113, v32
v_mad_u32_u16 v157, v221, 1, v7 op_sel:[1,0,0,0]
ds_add_u32 v157, v16
v_cmpx_lt_i32 vcc, 114, v32
v_mad_u32_u16 v158, v222, 1, v7 op_sel:[1,0,0,0]
ds_add_u32 v158, v16
v_cmpx_lt_i32 vcc, 115, v32
v_mad_u32_u16 v159, v223, 1, v7 op_sel:[1,0,0,0]
ds_add_u32 v159, v16
s_waitcnt vmcnt(7)
v_cmpx_lt_i32 vcc, 128, v32
s_cbranch_execz LE_c
v_mad_u32_u16 v160, v224, 1, v7 op_sel:[1,0,0,0]
ds_add_u32 v160, v16
v_cmpx_lt_i32 vcc, 129, v32
v_mad_u32_u16 v161, v225, 1, v7 op_sel:[1,0,0,0]
ds_add_u32 v161, v16
v_cmpx_lt_i32 vcc, 130, v32
v_mad_u32_u16 v162, v226, 1, v7 op_sel:[1,0,0,0]
ds_add_u32 v162, v16
v_cmpx_lt_i32 vcc, 131, v32
v_mad_u32_u16 v163, v227, 1, v7 op_sel:[1,0,0,0]
ds_add_u32 v163, v16
s_waitcnt vmcnt(6)
v_cmpx_lt_i32 vcc, 144, v32
s_cbranch_execz LE_c
v_mad_u32_u16 v164, v228, 1, v7 op_sel:[1,0,0,0]
ds_add_u32 v164, v16
v_cmpx_lt_i32 vcc, 145, v32
v_mad_u32_u16 v165, v229, 1, v7 op_sel:[1,0,0,0]
ds_add_u32 v165, v16
v_cmpx_lt_i32 vcc, 146, v32
v_mad_u32_u16 v166, v230, 1, v7 op_sel:[1,0,0,0]
ds_add_u32 v166, v16
v_cmpx_lt_i32 vcc, 147, v32
v_mad_u32_u16 v167, v231, 1, v7 op_sel:[1,0,0,0]
ds_add_u32 v167, v16
s_waitcnt vmcnt(5)
v_cmpx_lt_i32 vcc, 160, v32
s_cbranch_execz LE_c
v_mad_u32_u16 v168, v232, 1, v7 op_sel:[1,0,0,0]
ds_add_u32 v168, v16
v_cmpx_lt_i32 vcc, 161, v32
v_mad_u32_u16 v169, v233, 1, v7 op_sel:[1,0,0,0]
ds_add_u32 v169, v16
v_cmpx_lt_i32 vcc, 162, v32
v_mad_u32_u16 v170, v234, 1, v7 op_sel:[1,0,0,0]
ds_add_u32 v170, v16
v_cmpx_lt_i32 vcc, 163, v32
v_mad_u32_u16 v171, v235, 1, v7 op_sel:[1,0,0,0]
ds_add_u32 v171, v16
s_waitcnt vmcnt(4)
v_cmpx_lt_i32 vcc, 176, v32
s_cbranch_execz LE_c
v_mad_u32_u16 v172, v236, 1, v7 op_sel:[1,0,0,0]
ds_add_u32 v172, v16
v_cmpx_lt_i32 vcc, 177, v32
v_mad_u32_u16 v173, v237, 1, v7 op_sel:[1,0,0,0]
ds_add_u32 v173, v16
v_cmpx_lt_i32 vcc, 178, v32
v_mad_u32_u16 v174, v238, 1, v7 op_sel:[1,0,0,0]
ds_add_u32 v174, v16
v_cmpx_lt_i32 vcc, 179, v32
v_mad_u32_u16 v175, v239, 1, v7 op_sel:[1,0,0,0]
ds_add_u32 v175, v16
s_waitcnt vmcnt(3)
v_cmpx_lt_i32 vcc, 192, v32
s_cbranch_execz LE_c
v_mad_u32_u16 v176, v240, 1, v7 op_sel:[1,0,0,0]
ds_add_u32 v176, v16
v_cmpx_lt_i32 vcc, 193, v32
v_mad_u32_u16 v177, v241, 1, v7 op_sel:[1,0,0,0]
ds_add_u32 v177, v16
v_cmpx_lt_i32 vcc, 194, v32
v_mad_u32_u16 v178, v242, 1, v7 op_sel:[1,0,0,0]
ds_add_u32 v178, v16
v_cmpx_lt_i32 vcc, 195, v32
v_mad_u32_u16 v179, v243, 1, v7 op_sel:[1,0,0,0]
ds_add_u32 v179, v16
s_waitcnt vmcnt(2)
v_cmpx_lt_i32 vcc, 208, v32
s_cbranch_execz LE_c
v_mad_u32_u16 v180, v244, 1, v7 op_sel:[1,0,0,0]
ds_add_u32 v180, v16
v_cmpx_lt_i32 vcc, 209, v32
v_mad_u32_u16 v181, v245, 1, v7 op_sel:[1,0,0,0]
ds_add_u32 v181, v16
v_cmpx_lt_i32 vcc, 210, v32
v_mad_u32_u16 v182, v246, 1, v7 op_sel:[1,0,0,0]
ds_add_u32 v182, v16
v_cmpx_lt_i32 vcc, 211, v32
v_mad_u32_u16 v183, v247, 1, v7 op_sel:[1,0,0,0]
ds_add_u32 v183, v16
s_waitcnt vmcnt(1)
v_cmpx_lt_i32 vcc, 224, v32
s_cbranch_execz LE_c
v_mad_u32_u16 v184, v248, 1, v7 op_sel:[1,0,0,0]
ds_add_u32 v184, v16
v_cmpx_lt_i32 vcc, 225, v32
v_mad_u32_u16 v185, v249, 1, v7 op_sel:[1,0,0,0]
ds_add_u32 v185, v16
v_cmpx_lt_i32 vcc, 226, v32
v_mad_u32_u16 v186, v250, 1, v7 op_sel:[1,0,0,0]
ds_add_u32 v186, v16
v_cmpx_lt_i32 vcc, 227, v32
v_mad_u32_u16 v187, v251, 1, v7 op_sel:[1,0,0,0]
ds_add_u32 v187, v16
s_waitcnt vmcnt(0)
v_cmpx_lt_i32 vcc, 240, v32
s_cbranch_execz LE_c
v_mad_u32_u16 v188, v252, 1, v7 op_sel:[1,0,0,0]
ds_add_u32 v188, v16
v_cmpx_lt_i32 vcc, 241, v32
v_mad_u32_u16 v189, v253, 1, v7 op_sel:[1,0,0,0]
ds_add_u32 v189, v16
v_cmpx_lt_i32 vcc, 242, v32
v_mad_u32_u16 v190, v254, 1, v7 op_sel:[1,0,0,0]
ds_add_u32 v190, v16
v_cmpx_lt_i32 vcc, 243, v32
v_mad_u32_u16 v191, v255, 1, v7 op_sel:[1,0,0,0]
ds_add_u32 v191, v16
LE_c:
s_mov_b64 exec, -1
ds_read_b128 v[24:27], v35
s_waitcnt lgkmcnt(0)
v_add_u32 v24, 3, v24
v_lshrrev_b32 v24, 2, v24
v_max_u32 v24, v24, v18
v_add_u32 v25, 3, v25
v_lshrrev_b32 v25, 2, v25
v_max_u32 v25, v25, v19
v_add_u32 v26, 3, v26
v_lshrrev_b32 v26, 2, v26
v_max_u32 v26, v26, v20
v_add_u32 v27, 3, v27
v_lshrrev_b32 v27, 2, v27
v_max_u32 v27, v27, v21
v_add_u32 v33, v24, v25
v_add3_u32 v33, v33, v26, v27
v_mov_b32 v64, v33
s_nop 1
v_add_u32_dpp v64, v64, v64 row_shr:1 row_mask:0xf bank_mask:0xf
s_nop 1
v_add_u32_dpp v64, v64, v64 row_shr:2 row_mask:0xf bank_mask:0xf
s_nop 1
v_add_u32_dpp v64, v64, v64 row_shr:4 row_mask:0xf bank_mask:0xf
s_nop 1
v_add_u32_dpp v64, v64, v64 row_shr:8 row_mask:0xf bank_mask:0xf
s_nop 1
v_add_u32_dpp v64, v64, v64 row_bcast:15 row_mask:0xa bank_mask:0xf
s_nop 1
v_add_u32_dpp v64, v64, v64 row_bcast:31 row_mask:0xc bank_mask:0xf
s_nop 1
v_readlane_b32 s44, v64, 63
v_sub_u32 v28, v64, v33
v_add_u32 v29, v28, v24
v_add_u32 v30, v29, v25
v_add_u32 v31, v30, v26
v_add3_u32 v33, v28, v24, -1
v_lshlrev_b32 v34, v33, v18
v_lshrrev_b32 v33, 5, v33
v_lshl_add_u32 v33, v33, 2, v36
ds_or_b32 v33, v34 offset:20480
v_lshl_add_u32 v28, v28, 4, v36
v_add3_u32 v33, v29, v25, -1
v_lshlrev_b32 v34, v33, v19
v_lshrrev_b32 v33, 5, v33
v_lshl_add_u32 v33, v33, 2, v36
ds_or_b32 v33, v34 offset:20480
v_lshl_add_u32 v29, v29, 4, v36
v_add3_u32 v33, v30, v26, -1
v_lshlrev_b32 v34, v33, v20
v_lshrrev_b32 v33, 5, v33
v_lshl_add_u32 v33, v33, 2, v36
ds_or_b32 v33, v34 offset:20480
v_lshl_add_u32 v30, v30, 4, v36
v_add3_u32 v33, v31, v27, -1
v_lshlrev_b32 v34, v33, v21
v_lshrrev_b32 v33, 5, v33
v_lshl_add_u32 v33, v33, 2, v36
ds_or_b32 v33, v34 offset:20480
v_lshl_add_u32 v31, v31, 4, v36
ds_write_b128 v35, v[28:31]
s_add_u32 s44, s44, 31
s_lshr_b32 s44, s44, 5
v_cmpx_lt_i32 vcc, 0, v32
s_cbranch_execz LE_p
ds_add_rtn_u32 v128, v128, v17
v_cmpx_lt_i32 vcc, 1, v32
ds_add_rtn_u32 v129, v129, v17
v_cmpx_lt_i32 vcc, 2, v32
ds_add_rtn_u32 v130, v130, v17
v_cmpx_lt_i32 vcc, 3, v32
ds_add_rtn_u32 v131, v131, v17
v_cmpx_lt_i32 vcc, 16, v32
s_cbranch_execz LE_p
ds_add_rtn_u32 v132, v132, v17
v_cmpx_lt_i32 vcc, 17, v32
ds_add_rtn_u32 v133, v133, v17
v_cmpx_lt_i32 vcc, 18, v32
ds_add_rtn_u32 v134, v134, v17
v_cmpx_lt_i32 vcc, 19, v32
ds_add_rtn_u32 v135, v135, v17
v_cmpx_lt_i32 vcc, 32, v32
s_cbranch_execz LE_p
ds_add_rtn_u32 v136, v136, v17
v_cmpx_lt_i32 vcc, 33, v32
ds_add_rtn_u32 v137, v137, v17
v_cmpx_lt_i32 vcc, 34, v32
ds_add_rtn_u32 v138, v138, v17
v_cmpx_lt_i32 vcc, 35, v32
ds_add_rtn_u32 v139, v139, v17
v_cmpx_lt_i32 vcc, 48, v32
s_cbranch_execz LE_p
ds_add_rtn_u32 v140, v140, v17
v_cmpx_lt_i32 vcc, 49, v32
ds_add_rtn_u32 v141, v141, v17
v_cmpx_lt_i32 vcc, 50, v32
ds_add_rtn_u32 v142, v142, v17
v_cmpx_lt_i32 vcc, 51, v32
ds_add_rtn_u32 v143, v143, v17
v_cmpx_lt_i32 vcc, 64, v32
s_cbranch_execz LE_p
ds_add_rtn_u32 v144, v144, v17
v_cmpx_lt_i32 vcc, 65, v32
ds_add_rtn_u32 v145, v145, v17
v_cmpx_lt_i32 vcc, 66, v32
ds_add_rtn_u32 v146, v146, v17
v_cmpx_lt_i32 vcc, 67, v32
ds_add_rtn_u32 v147, v147, v17
v_cmpx_lt_i32 vcc, 80, v32
s_cbranch_execz LE_p
ds_add_rtn_u32 v148, v148, v17
v_cmpx_lt_i32 vcc, 81, v32
ds_add_rtn_u32 v149, v149, v17
v_cmpx_lt_i32 vcc, 82, v32
ds_add_rtn_u32 v150, v150, v17
v_cmpx_lt_i32 vcc, 83, v32
ds_add_rtn_u32 v151, v151, v17
v_cmpx_lt_i32 vcc, 96, v32
s_cbranch_execz LE_p
ds_add_rtn_u32 v152, v152, v17
v_cmpx_lt_i32 vcc, 97, v32
ds_add_rtn_u32 v153, v153, v17
v_cmpx_lt_i32 vcc, 98, v32
ds_add_rtn_u32 v154, v154, v17
v_cmpx_lt_i32 vcc, 99, v32
ds_add_rtn_u32 v155, v155, v17
v_cmpx_lt_i32 vcc, 112, v32
s_cbranch_execz LE_p
ds_add_rtn_u32 v156, v156, v17
v_cmpx_lt_i32 vcc, 113, v32
ds_add_rtn_u32 v157, v157, v17
v_cmpx_lt_i32 vcc, 114, v32
ds_add_rtn_u32 v158, v158, v17
v_cmpx_lt_i32 vcc, 115, v32
ds_add_rtn_u32 v159, v159, v17
v_cmpx_lt_i32 vcc, 128, v32
s_cbranch_execz LE_p
ds_add_rtn_u32 v160, v160, v17
v_cmpx_lt_i32 vcc, 129, v32
ds_add_rtn_u32 v161, v161, v17
v_cmpx_lt_i32 vcc, 130, v32
ds_add_rtn_u32 v162, v162, v17
v_cmpx_lt_i32 vcc, 131, v32
ds_add_rtn_u32 v163, v163, v17
v_cmpx_lt_i32 vcc, 144, v32
s_cbranch_execz LE_p
ds_add_rtn_u32 v164, v164, v17
v_cmpx_lt_i32 vcc, 145, v32
ds_add_rtn_u32 v165, v165, v17
v_cmpx_lt_i32 vcc, 146, v32
ds_add_rtn_u32 v166, v166, v17
v_cmpx_lt_i32 vcc, 147, v32
ds_add_rtn_u32 v167, v167, v17
v_cmpx_lt_i32 vcc, 160, v32
s_cbranch_execz LE_p
ds_add_rtn_u32 v168, v168, v17
v_cmpx_lt_i32 vcc, 161, v32
ds_add_rtn_u32 v169, v169, v17
v_cmpx_lt_i32 vcc, 162, v32
ds_add_rtn_u32 v170, v170, v17
v_cmpx_lt_i32 vcc, 163, v32
ds_add_rtn_u32 v171, v171, v17
v_cmpx_lt_i32 vcc, 176, v32
s_cbranch_execz LE_p
ds_add_rtn_u32 v172, v172, v17
v_cmpx_lt_i32 vcc, 177, v32
ds_add_rtn_u32 v173, v173, v17
v_cmpx_lt_i32 vcc, 178, v32
ds_add_rtn_u32 v174, v174, v17
v_cmpx_lt_i32 vcc, 179, v32
ds_add_rtn_u32 v175, v175, v17
v_cmpx_lt_i32 vcc, 192, v32
s_cbranch_execz LE_p
ds_add_rtn_u32 v176, v176, v17
v_cmpx_lt_i32 vcc, 193, v32
ds_add_rtn_u32 v177, v177, v17
v_cmpx_lt_i32 vcc, 194, v32
ds_add_rtn_u32 v178, v178, v17
v_cmpx_lt_i32 vcc, 195, v32
ds_add_rtn_u32 v179, v179, v17
v_cmpx_lt_i32 vcc, 208, v32
s_cbranch_execz LE_p
ds_add_rtn_u32 v180, v180, v17
v_cmpx_lt_i32 vcc, 209, v32
ds_add_rtn_u32 v181, v181, v17
v_cmpx_lt_i32 vcc, 210, v32
ds_add_rtn_u32 v182, v182, v17
v_cmpx_lt_i32 vcc, 211, v32
ds_add_rtn_u32 v183, v183, v17
v_cmpx_lt_i32 vcc, 224, v32
s_cbranch_execz LE_p
ds_add_rtn_u32 v184, v184, v17
v_cmpx_lt_i32 vcc, 225, v32
ds_add_rtn_u32 v185, v185, v17
v_cmpx_lt_i32 vcc, 226, v32
ds_add_rtn_u32 v186, v186, v17
v_cmpx_lt_i32 vcc, 227, v32
ds_add_rtn_u32 v187, v187, v17
v_cmpx_lt_i32 vcc, 240, v32
s_cbranch_execz LE_p
ds_add_rtn_u32 v188, v188, v17
v_cmpx_lt_i32 vcc, 241, v32
ds_add_rtn_u32 v189, v189, v17
v_cmpx_lt_i32 vcc, 242, v32
ds_add_rtn_u32 v190, v190, v17
v_cmpx_lt_i32 vcc, 243, v32
ds_add_rtn_u32 v191, v191, v17
LE_p:
s_mov_b64 exec, -1
v_lshl_add_u32 v33, v1, 2, v36
ds_read_b32 v37, v33 offset:20480
s_waitcnt lgkmcnt(0)
v_cmpx_lt_i32 vcc, 0, v32
s_cbranch_execz LE_w
ds_write_b32 v128, v192
v_cmpx_lt_i32 vcc, 1, v32
ds_write_b32 v129, v193
v_cmpx_lt_i32 vcc, 2, v32
ds_write_b32 v130, v194
v_cmpx_lt_i32 vcc, 3, v32
ds_write_b32 v131, v195
v_cmpx_lt_i32 vcc, 16, v32
s_cbranch_execz LE_w
ds_write_b32 v132, v196
v_cmpx_lt_i32 vcc, 17, v32
ds_write_b32 v133, v197
v_cmpx_lt_i32 vcc, 18, v32
ds_write_b32 v134, v198
v_cmpx_lt_i32 vcc, 19, v32
ds_write_b32 v135, v199
v_cmpx_lt_i32 vcc, 32, v32
s_cbranch_execz LE_w
ds_write_b32 v136, v200
v_cmpx_lt_i32 vcc, 33, v32
ds_write_b32 v137, v201
v_cmpx_lt_i32 vcc, 34, v32
ds_write_b32 v138, v202
v_cmpx_lt_i32 vcc, 35, v32
ds_write_b32 v139, v203
v_cmpx_lt_i32 vcc, 48, v32
s_cbranch_execz LE_w
ds_write_b32 v140, v204
v_cmpx_lt_i32 vcc, 49, v32
ds_write_b32 v141, v205
v_cmpx_lt_i32 vcc, 50, v32
ds_write_b32 v142, v206
v_cmpx_lt_i32 vcc, 51, v32
ds_write_b32 v143, v207
v_cmpx_lt_i32 vcc, 64, v32
s_cbranch_execz LE_w
ds_write_b32 v144, v208
v_cmpx_lt_i32 vcc, 65, v32
ds_write_b32 v145, v209
v_cmpx_lt_i32 vcc, 66, v32
ds_write_b32 v146, v210
v_cmpx_lt_i32 vcc, 67, v32
ds_write_b32 v147, v211
v_cmpx_lt_i32 vcc, 80, v32
s_cbranch_execz LE_w
ds_write_b32 v148, v212
v_cmpx_lt_i32 vcc, 81, v32
ds_write_b32 v149, v213
v_cmpx_lt_i32 vcc, 82, v32
ds_write_b32 v150, v214
v_cmpx_lt_i32 vcc, 83, v32
ds_write_b32 v151, v215
v_cmpx_lt_i32 vcc, 96, v32
s_cbranch_execz LE_w
ds_write_b32 v152, v216
v_cmpx_lt_i32 vcc, 97, v32
ds_write_b32 v153, v217
v_cmpx_lt_i32 vcc, 98, v32
ds_write_b32 v154, v218
v_cmpx_lt_i32 vcc, 99, v32
ds_write_b32 v155, v219
v_cmpx_lt_i32 vcc, 112, v32
s_cbranch_execz LE_w
ds_write_b32 v156, v220
v_cmpx_lt_i32 vcc, 113, v32
ds_write_b32 v157, v221
v_cmpx_lt_i32 vcc, 114, v32
ds_write_b32 v158, v222
v_cmpx_lt_i32 vcc, 115, v32
ds_write_b32 v159, v223
v_cmpx_lt_i32 vcc, 128, v32
s_cbranch_execz LE_w
ds_write_b32 v160, v224
v_cmpx_lt_i32 vcc, 129, v32
ds_write_b32 v161, v225
v_cmpx_lt_i32 vcc, 130, v32
ds_write_b32 v162, v226
v_cmpx_lt_i32 vcc, 131, v32
ds_write_b32 v163, v227
v_cmpx_lt_i32 vcc, 144, v32
s_cbranch_execz LE_w
ds_write_b32 v164, v228
v_cmpx_lt_i32 vcc, 145, v32
ds_write_b32 v165, v229
v_cmpx_lt_i32 vcc, 146, v32
ds_write_b32 v166, v230
v_cmpx_lt_i32 vcc, 147, v32
ds_write_b32 v167, v231
v_cmpx_lt_i32 vcc, 160, v32
s_cbranch_execz LE_w
ds_write_b32 v168, v232
v_cmpx_lt_i32 vcc, 161, v32
ds_write_b32 v169, v233
v_cmpx_lt_i32 vcc, 162, v32
ds_write_b32 v170, v234
v_cmpx_lt_i32 vcc, 163, v32
ds_write_b32 v171, v235
v_cmpx_lt_i32 vcc, 176, v32
s_cbranch_execz LE_w
ds_write_b32 v172, v236
v_cmpx_lt_i32 vcc, 177, v32
ds_write_b32 v173, v237
v_cmpx_lt_i32 vcc, 178, v32
ds_write_b32 v174, v238
v_cmpx_lt_i32 vcc, 179, v32
ds_write_b32 v175, v239
v_cmpx_lt_i32 vcc, 192, v32
s_cbranch_execz LE_w
ds_write_b32 v176, v240
v_cmpx_lt_i32 vcc, 193, v32
ds_write_b32 v177, v241
v_cmpx_lt_i32 vcc, 194, v32
ds_write_b32 v178, v242
v_cmpx_lt_i32 vcc, 195, v32
ds_write_b32 v179, v243
v_cmpx_lt_i32 vcc, 208, v32
s_cbranch_execz LE_w
ds_write_b32 v180, v244
v_cmpx_lt_i32 vcc, 209, v32
ds_write_b32 v181, v245
v_cmpx_lt_i32 vcc, 210, v32
ds_write_b32 v182, v246
v_cmpx_lt_i32 vcc, 211, v32
ds_write_b32 v183, v247
v_cmpx_lt_i32 vcc, 224, v32
s_cbranch_execz LE_w
ds_write_b32 v184, v248
v_cmpx_lt_i32 vcc, 225, v32
ds_write_b32 v185, v249
v_cmpx_lt_i32 vcc, 226, v32
ds_write_b32 v186, v250
v_cmpx_lt_i32 vcc, 227, v32
ds_write_b32 v187, v251
v_cmpx_lt_i32 vcc, 240, v32
s_cbranch_execz LE_w
ds_write_b32 v188, v252
v_cmpx_lt_i32 vcc, 241, v32
ds_write_b32 v189, v253
v_cmpx_lt_i32 vcc, 242, v32
ds_write_b32 v190, v254
v_cmpx_lt_i32 vcc, 243, v32
ds_write_b32 v191, v255
LE_w:
s_mov_b64 exec, -1
s_add_u32 s8, s4, 0x7c2a000
s_addc_u32 s9, s5, 0
s_mov_b32 s10, 0x8000
s_mov_b32 s11, 0x00020000
v_and_b32 v200, 63, v0
v_lshlrev_b32 v200, 7, v200
s_mov_b32 s91, 8192
s_mov_b32 s90, 16384
s_mov_b32 s95, 24576
s_mov_b32 s94, 0x10000
LE_poll:
buffer_load_dwordx2 v[192:193], v200, s[8:11], 0 offen sc1
buffer_load_dwordx2 v[194:195], v200, s[8:11], s91 offen sc1
buffer_load_dwordx2 v[196:197], v200, s[8:11], s90 offen sc1
buffer_load_dwordx2 v[198:199], v200, s[8:11], s95 offen sc1
s_sub_u32 s94, s94, 1
s_waitcnt vmcnt(0)
s_cbranch_scc1 LE_poll_go
v_cmp_ne_u64 vcc, s[98:99], v[192:193]
s_nop 1
s_cbranch_vccnz LE_poll
v_cmp_ne_u64 vcc, s[98:99], v[194:195]
s_nop 1
s_cbranch_vccnz LE_poll
v_cmp_ne_u64 vcc, s[98:99], v[196:197]
s_nop 1
s_cbranch_vccnz LE_poll
v_cmp_ne_u64 vcc, s[98:99], v[198:199]
s_nop 1
s_cbranch_vccnz LE_poll
LE_poll_go:
s_cmp_lg_u32 s40, 0
s_cbranch_scc1 LE_nobump
s_mov_b32 s90, 89984
s_mov_b32 s10, 90112
v_mov_b32 v192, s98
v_mov_b32 v193, s99
s_mov_b64 exec, 1
buffer_store_dwordx2 v[192:193], off, s[8:11], s90 sc1
s_mov_b64 exec, -1
LE_nobump:
v_mov_b32 v34, v38
ds_read2_b32 v[52:53], v34 offset0:0 offset1:4
ds_read2_b32 v[54:55], v34 offset0:8 offset1:12
s_waitcnt lgkmcnt(0)
ds_read2_b32 v[56:57], v34 offset0:16 offset1:20
ds_read2_b32 v[58:59], v34 offset0:24 offset1:28
v_mad_u32_u16 v60, v52, s49, v2
v_mad_u32_u16 v61, v53, s49, v2
v_mad_u32_u16 v62, v54, s49, v2
v_mad_u32_u16 v63, v55, s49, v2
buffer_load_dwordx4 a[0:3], v60, s[16:19], 0 offen sc1
buffer_load_dwordx4 a[4:7], v60, s[16:19], 0 offen offset:256 sc1
buffer_load_dwordx4 a[8:11], v61, s[16:19], 0 offen sc1
buffer_load_dwordx4 a[12:15], v61, s[16:19], 0 offen offset:256 sc1
buffer_load_dwordx4 a[16:19], v62, s[16:19], 0 offen sc1
buffer_load_dwordx4 a[20:23], v62, s[16:19], 0 offen offset:256 sc1
buffer_load_dwordx4 a[24:27], v63, s[16:19], 0 offen sc1
buffer_load_dwordx4 a[28:31], v63, s[16:19], 0 offen offset:256 sc1
s_waitcnt lgkmcnt(0)
ds_read2_b32 v[52:53], v34 offset0:32 offset1:36
ds_read2_b32 v[54:55], v34 offset0:40 offset1:44
v_mad_u32_u16 v60, v56, s49, v2
v_mad_u32_u16 v61, v57, s49, v2
v_mad_u32_u16 v62, v58, s49, v2
v_mad_u32_u16 v63, v59, s49, v2
buffer_load_dwordx4 a[32:35], v60, s[16:19], 0 offen sc1
buffer_load_dwordx4 a[36:39], v60, s[16:19], 0 offen offset:256 sc1
buffer_load_dwordx4 a[40:43], v61, s[16:19], 0 offen sc1
buffer_load_dwordx4 a[44:47], v61, s[16:19], 0 offen offset:256 sc1
buffer_load_dwordx4 a[48:51], v62, s[16:19], 0 offen sc1
buffer_load_dwordx4 a[52:55], v62, s[16:19], 0 offen offset:256 sc1
buffer_load_dwordx4 a[56:59], v63, s[16:19], 0 offen sc1
buffer_load_dwordx4 a[60:63], v63, s[16:19], 0 offen offset:256 sc1
s_waitcnt lgkmcnt(0)
ds_read2_b32 v[56:57], v34 offset0:48 offset1:52
ds_read2_b32 v[58:59], v34 offset0:56 offset1:60
v_mad_u32_u16 v60, v52, s49, v2
v_mad_u32_u16 v61, v53, s49, v2
v_mad_u32_u16 v62, v54, s49, v2
v_mad_u32_u16 v63, v55, s49, v2
buffer_load_dwordx4 a[64:67], v60, s[16:19], 0 offen sc1
buffer_load_dwordx4 a[68:71], v60, s[16:19], 0 offen offset:256 sc1
buffer_load_dwordx4 a[72:75], v61, s[16:19], 0 offen sc1
buffer_load_dwordx4 a[76:79], v61, s[16:19], 0 offen offset:256 sc1
buffer_load_dwordx4 a[80:83], v62, s[16:19], 0 offen sc1
buffer_load_dwordx4 a[84:87], v62, s[16:19], 0 offen offset:256 sc1
buffer_load_dwordx4 a[88:91], v63, s[16:19], 0 offen sc1
buffer_load_dwordx4 a[92:95], v63, s[16:19], 0 offen offset:256 sc1
s_waitcnt lgkmcnt(0)
ds_read2_b32 v[52:53], v34 offset0:64 offset1:68
ds_read2_b32 v[54:55], v34 offset0:72 offset1:76
v_mad_u32_u16 v60, v56, s49, v2
v_mad_u32_u16 v61, v57, s49, v2
v_mad_u32_u16 v62, v58, s49, v2
v_mad_u32_u16 v63, v59, s49, v2
buffer_load_dwordx4 a[96:99], v60, s[16:19], 0 offen sc1
buffer_load_dwordx4 a[100:103], v60, s[16:19], 0 offen offset:256 sc1
buffer_load_dwordx4 a[104:107], v61, s[16:19], 0 offen sc1
buffer_load_dwordx4 a[108:111], v61, s[16:19], 0 offen offset:256 sc1
buffer_load_dwordx4 a[112:115], v62, s[16:19], 0 offen sc1
buffer_load_dwordx4 a[116:119], v62, s[16:19], 0 offen offset:256 sc1
buffer_load_dwordx4 a[120:123], v63, s[16:19], 0 offen sc1
buffer_load_dwordx4 a[124:127], v63, s[16:19], 0 offen offset:256 sc1
s_waitcnt lgkmcnt(0)
ds_read2_b32 v[56:57], v34 offset0:80 offset1:84
ds_read2_b32 v[58:59], v34 offset0:88 offset1:92
v_mad_u32_u16 v60, v52, s49, v2
v_mad_u32_u16 v61, v53, s49, v2
v_mad_u32_u16 v62, v54, s49, v2
v_mad_u32_u16 v63, v55, s49, v2
buffer_load_dwordx4 a[128:131], v60, s[16:19], 0 offen sc1
buffer_load_dwordx4 a[132:135], v60, s[16:19], 0 offen offset:256 sc1
buffer_load_dwordx4 a[136:139], v61, s[16:19], 0 offen sc1
buffer_load_dwordx4 a[140:143], v61, s[16:19], 0 offen offset:256 sc1
buffer_load_dwordx4 a[144:147], v62, s[16:19], 0 offen sc1
buffer_load_dwordx4 a[148:151], v62, s[16:19], 0 offen offset:256 sc1
buffer_load_dwordx4 a[152:155], v63, s[16:19], 0 offen sc1
buffer_load_dwordx4 a[156:159], v63, s[16:19], 0 offen offset:256 sc1
s_waitcnt lgkmcnt(0)
ds_read2_b32 v[52:53], v34 offset0:96 offset1:100
ds_read2_b32 v[54:55], v34 offset0:104 offset1:108
v_mad_u32_u16 v60, v56, s49, v2
v_mad_u32_u16 v61, v57, s49, v2
v_mad_u32_u16 v62, v58, s49, v2
v_mad_u32_u16 v63, v59, s49, v2
buffer_load_dwordx4 a[160:163], v60, s[16:19], 0 offen sc1
buffer_load_dwordx4 a[164:167], v60, s[16:19], 0 offen offset:256 sc1
buffer_load_dwordx4 a[168:171], v61, s[16:19], 0 offen sc1
buffer_load_dwordx4 a[172:175], v61, s[16:19], 0 offen offset:256 sc1
buffer_load_dwordx4 a[176:179], v62, s[16:19], 0 offen sc1
buffer_load_dwordx4 a[180:183], v62, s[16:19], 0 offen offset:256 sc1
buffer_load_dwordx4 a[184:187], v63, s[16:19], 0 offen sc1
buffer_load_dwordx4 a[188:191], v63, s[16:19], 0 offen offset:256 sc1
s_waitcnt lgkmcnt(0)
ds_read2_b32 v[56:57], v34 offset0:112 offset1:116
ds_read2_b32 v[58:59], v34 offset0:120 offset1:124
v_mad_u32_u16 v60, v52, s49, v2
v_mad_u32_u16 v61, v53, s49, v2
v_mad_u32_u16 v62, v54, s49, v2
v_mad_u32_u16 v63, v55, s49, v2
buffer_load_dwordx4 a[192:195], v60, s[16:19], 0 offen sc1
buffer_load_dwordx4 a[196:199], v60, s[16:19], 0 offen offset:256 sc1
buffer_load_dwordx4 a[200:203], v61, s[16:19], 0 offen sc1
buffer_load_dwordx4 a[204:207], v61, s[16:19], 0 offen offset:256 sc1
buffer_load_dwordx4 a[208:211], v62, s[16:19], 0 offen sc1
buffer_load_dwordx4 a[212:215], v62, s[16:19], 0 offen offset:256 sc1
buffer_load_dwordx4 a[216:219], v63, s[16:19], 0 offen sc1
buffer_load_dwordx4 a[220:223], v63, s[16:19], 0 offen offset:256 sc1
s_waitcnt lgkmcnt(0)
ds_read2_b32 v[52:53], v34 offset0:128 offset1:132
ds_read2_b32 v[54:55], v34 offset0:136 offset1:140
v_mad_u32_u16 v60, v56, s49, v2
v_mad_u32_u16 v61, v57, s49, v2
v_mad_u32_u16 v62, v58, s49, v2
v_mad_u32_u16 v63, v59, s49, v2
buffer_load_dwordx4 a[224:227], v60, s[16:19], 0 offen sc1
buffer_load_dwordx4 a[228:231], v60, s[16:19], 0 offen offset:256 sc1
buffer_load_dwordx4 a[232:235], v61, s[16:19], 0 offen sc1
buffer_load_dwordx4 a[236:239], v61, s[16:19], 0 offen offset:256 sc1
buffer_load_dwordx4 a[240:243], v62, s[16:19], 0 offen sc1
buffer_load_dwordx4 a[244:247], v62, s[16:19], 0 offen offset:256 sc1
buffer_load_dwordx4 a[248:251], v63, s[16:19], 0 offen sc1
buffer_load_dwordx4 a[252:255], v63, s[16:19], 0 offen offset:256 sc1
v_add_u32 v34, 512, v34
s_mov_b32 s45, 0
s_lshl_b32 s47, s55, 9
LE_loop:
v_readlane_b32 s46, v37, s45
s_add_u32 s45, s45, 1
s_waitcnt vmcnt(56)
v_mfma_f32_16x16x32_bf16 v[48:51], a[0:3], v[40:43], v[48:51]
v_mfma_f32_16x16x32_bf16 v[48:51], a[4:7], v[44:47], v[48:51]
s_bitcmp1_b32 s46, 0
s_cbranch_scc0 LE_nf0
s_cmp_eq_u32 s42, 0
s_cbranch_scc1 LE_fl0
buffer_load_dwordx2 v[66:67], v39, s[20:23], s47 offen sc1
s_waitcnt vmcnt(0)
v_lshlrev_b32 v64, 16, v66
v_and_b32 v65, 0xffff0000, v66
v_add_f32 v48, v48, v64
v_add_f32 v49, v49, v65
v_lshlrev_b32 v64, 16, v67
v_and_b32 v65, 0xffff0000, v67
v_add_f32 v50, v50, v64
v_add_f32 v51, v51, v65
LE_fl0:
s_nop 3
v_cvt_pk_bf16_f32 v64, v48, v49
v_cvt_pk_bf16_f32 v65, v50, v51
v_mov_b32 v48, 0
v_mov_b32 v49, 0
v_mov_b32 v50, 0
v_mov_b32 v51, 0
buffer_store_dwordx2 v[64:65], v39, s[20:23], s47 offen sc1
s_add_u32 s47, s47, 512
LE_nf0:
v_mfma_f32_16x16x32_bf16 v[48:51], a[8:11], v[40:43], v[48:51]
v_mfma_f32_16x16x32_bf16 v[48:51], a[12:15], v[44:47], v[48:51]
s_bitcmp1_b32 s46, 1
s_cbranch_scc0 LE_nf1
s_cmp_eq_u32 s42, 0
s_cbranch_scc1 LE_fl1
buffer_load_dwordx2 v[66:67], v39, s[20:23], s47 offen sc1
s_waitcnt vmcnt(0)
v_lshlrev_b32 v64, 16, v66
v_and_b32 v65, 0xffff0000, v66
v_add_f32 v48, v48, v64
v_add_f32 v49, v49, v65
v_lshlrev_b32 v64, 16, v67
v_and_b32 v65, 0xffff0000, v67
v_add_f32 v50, v50, v64
v_add_f32 v51, v51, v65
LE_fl1:
s_nop 3
v_cvt_pk_bf16_f32 v64, v48, v49
v_cvt_pk_bf16_f32 v65, v50, v51
v_mov_b32 v48, 0
v_mov_b32 v49, 0
v_mov_b32 v50, 0
v_mov_b32 v51, 0
buffer_store_dwordx2 v[64:65], v39, s[20:23], s47 offen sc1
s_add_u32 s47, s47, 512
LE_nf1:
v_mfma_f32_16x16x32_bf16 v[48:51], a[16:19], v[40:43], v[48:51]
v_mfma_f32_16x16x32_bf16 v[48:51], a[20:23], v[44:47], v[48:51]
s_bitcmp1_b32 s46, 2
s_cbranch_scc0 LE_nf2
s_cmp_eq_u32 s42, 0
s_cbranch_scc1 LE_fl2
buffer_load_dwordx2 v[66:67], v39, s[20:23], s47 offen sc1
s_waitcnt vmcnt(0)
v_lshlrev_b32 v64, 16, v66
v_and_b32 v65, 0xffff0000, v66
v_add_f32 v48, v48, v64
v_add_f32 v49, v49, v65
v_lshlrev_b32 v64, 16, v67
v_and_b32 v65, 0xffff0000, v67
v_add_f32 v50, v50, v64
v_add_f32 v51, v51, v65
LE_fl2:
s_nop 3
v_cvt_pk_bf16_f32 v64, v48, v49
v_cvt_pk_bf16_f32 v65, v50, v51
v_mov_b32 v48, 0
v_mov_b32 v49, 0
v_mov_b32 v50, 0
v_mov_b32 v51, 0
buffer_store_dwordx2 v[64:65], v39, s[20:23], s47 offen sc1
s_add_u32 s47, s47, 512
LE_nf2:
v_mfma_f32_16x16x32_bf16 v[48:51], a[24:27], v[40:43], v[48:51]
v_mfma_f32_16x16x32_bf16 v[48:51], a[28:31], v[44:47], v[48:51]
s_bitcmp1_b32 s46, 3
s_cbranch_scc0 LE_nf3
s_cmp_eq_u32 s42, 0
s_cbranch_scc1 LE_fl3
buffer_load_dwordx2 v[66:67], v39, s[20:23], s47 offen sc1
s_waitcnt vmcnt(0)
v_lshlrev_b32 v64, 16, v66
v_and_b32 v65, 0xffff0000, v66
v_add_f32 v48, v48, v64
v_add_f32 v49, v49, v65
v_lshlrev_b32 v64, 16, v67
v_and_b32 v65, 0xffff0000, v67
v_add_f32 v50, v50, v64
v_add_f32 v51, v51, v65
LE_fl3:
s_nop 3
v_cvt_pk_bf16_f32 v64, v48, v49
v_cvt_pk_bf16_f32 v65, v50, v51
v_mov_b32 v48, 0
v_mov_b32 v49, 0
v_mov_b32 v50, 0
v_mov_b32 v51, 0
buffer_store_dwordx2 v[64:65], v39, s[20:23], s47 offen sc1
s_add_u32 s47, s47, 512
LE_nf3:
s_waitcnt lgkmcnt(0)
ds_read2_b32 v[56:57], v34 offset0:16 offset1:20
ds_read2_b32 v[58:59], v34 offset0:24 offset1:28
v_mad_u32_u16 v60, v52, s49, v2
v_mad_u32_u16 v61, v53, s49, v2
v_mad_u32_u16 v62, v54, s49, v2
v_mad_u32_u16 v63, v55, s49, v2
buffer_load_dwordx4 a[0:3], v60, s[16:19], 0 offen sc1
buffer_load_dwordx4 a[4:7], v60, s[16:19], 0 offen offset:256 sc1
buffer_load_dwordx4 a[8:11], v61, s[16:19], 0 offen sc1
buffer_load_dwordx4 a[12:15], v61, s[16:19], 0 offen offset:256 sc1
buffer_load_dwordx4 a[16:19], v62, s[16:19], 0 offen sc1
buffer_load_dwordx4 a[20:23], v62, s[16:19], 0 offen offset:256 sc1
buffer_load_dwordx4 a[24:27], v63, s[16:19], 0 offen sc1
buffer_load_dwordx4 a[28:31], v63, s[16:19], 0 offen offset:256 sc1
s_waitcnt vmcnt(56)
v_mfma_f32_16x16x32_bf16 v[48:51], a[32:35], v[40:43], v[48:51]
v_mfma_f32_16x16x32_bf16 v[48:51], a[36:39], v[44:47], v[48:51]
s_bitcmp1_b32 s46, 4
s_cbranch_scc0 LE_nf4
s_cmp_eq_u32 s42, 0
s_cbranch_scc1 LE_fl4
buffer_load_dwordx2 v[66:67], v39, s[20:23], s47 offen sc1
s_waitcnt vmcnt(0)
v_lshlrev_b32 v64, 16, v66
v_and_b32 v65, 0xffff0000, v66
v_add_f32 v48, v48, v64
v_add_f32 v49, v49, v65
v_lshlrev_b32 v64, 16, v67
v_and_b32 v65, 0xffff0000, v67
v_add_f32 v50, v50, v64
v_add_f32 v51, v51, v65
LE_fl4:
s_nop 3
v_cvt_pk_bf16_f32 v64, v48, v49
v_cvt_pk_bf16_f32 v65, v50, v51
v_mov_b32 v48, 0
v_mov_b32 v49, 0
v_mov_b32 v50, 0
v_mov_b32 v51, 0
buffer_store_dwordx2 v[64:65], v39, s[20:23], s47 offen sc1
s_add_u32 s47, s47, 512
LE_nf4:
v_mfma_f32_16x16x32_bf16 v[48:51], a[40:43], v[40:43], v[48:51]
v_mfma_f32_16x16x32_bf16 v[48:51], a[44:47], v[44:47], v[48:51]
s_bitcmp1_b32 s46, 5
s_cbranch_scc0 LE_nf5
s_cmp_eq_u32 s42, 0
s_cbranch_scc1 LE_fl5
buffer_load_dwordx2 v[66:67], v39, s[20:23], s47 offen sc1
s_waitcnt vmcnt(0)
v_lshlrev_b32 v64, 16, v66
v_and_b32 v65, 0xffff0000, v66
v_add_f32 v48, v48, v64
v_add_f32 v49, v49, v65
v_lshlrev_b32 v64, 16, v67
v_and_b32 v65, 0xffff0000, v67
v_add_f32 v50, v50, v64
v_add_f32 v51, v51, v65
LE_fl5:
s_nop 3
v_cvt_pk_bf16_f32 v64, v48, v49
v_cvt_pk_bf16_f32 v65, v50, v51
v_mov_b32 v48, 0
v_mov_b32 v49, 0
v_mov_b32 v50, 0
v_mov_b32 v51, 0
buffer_store_dwordx2 v[64:65], v39, s[20:23], s47 offen sc1
s_add_u32 s47, s47, 512
LE_nf5:
v_mfma_f32_16x16x32_bf16 v[48:51], a[48:51], v[40:43], v[48:51]
v_mfma_f32_16x16x32_bf16 v[48:51], a[52:55], v[44:47], v[48:51]
s_bitcmp1_b32 s46, 6
s_cbranch_scc0 LE_nf6
s_cmp_eq_u32 s42, 0
s_cbranch_scc1 LE_fl6
buffer_load_dwordx2 v[66:67], v39, s[20:23], s47 offen sc1
s_waitcnt vmcnt(0)
v_lshlrev_b32 v64, 16, v66
v_and_b32 v65, 0xffff0000, v66
v_add_f32 v48, v48, v64
v_add_f32 v49, v49, v65
v_lshlrev_b32 v64, 16, v67
v_and_b32 v65, 0xffff0000, v67
v_add_f32 v50, v50, v64
v_add_f32 v51, v51, v65
LE_fl6:
s_nop 3
v_cvt_pk_bf16_f32 v64, v48, v49
v_cvt_pk_bf16_f32 v65, v50, v51
v_mov_b32 v48, 0
v_mov_b32 v49, 0
v_mov_b32 v50, 0
v_mov_b32 v51, 0
buffer_store_dwordx2 v[64:65], v39, s[20:23], s47 offen sc1
s_add_u32 s47, s47, 512
LE_nf6:
v_mfma_f32_16x16x32_bf16 v[48:51], a[56:59], v[40:43], v[48:51]
v_mfma_f32_16x16x32_bf16 v[48:51], a[60:63], v[44:47], v[48:51]
s_bitcmp1_b32 s46, 7
s_cbranch_scc0 LE_nf7
s_cmp_eq_u32 s42, 0
s_cbranch_scc1 LE_fl7
buffer_load_dwordx2 v[66:67], v39, s[20:23], s47 offen sc1
s_waitcnt vmcnt(0)
v_lshlrev_b32 v64, 16, v66
v_and_b32 v65, 0xffff0000, v66
v_add_f32 v48, v48, v64
v_add_f32 v49, v49, v65
v_lshlrev_b32 v64, 16, v67
v_and_b32 v65, 0xffff0000, v67
v_add_f32 v50, v50, v64
v_add_f32 v51, v51, v65
LE_fl7:
s_nop 3
v_cvt_pk_bf16_f32 v64, v48, v49
v_cvt_pk_bf16_f32 v65, v50, v51
v_mov_b32 v48, 0
v_mov_b32 v49, 0
v_mov_b32 v50, 0
v_mov_b32 v51, 0
buffer_store_dwordx2 v[64:65], v39, s[20:23], s47 offen sc1
s_add_u32 s47, s47, 512
LE_nf7:
s_waitcnt lgkmcnt(0)
ds_read2_b32 v[52:53], v34 offset0:32 offset1:36
ds_read2_b32 v[54:55], v34 offset0:40 offset1:44
v_mad_u32_u16 v60, v56, s49, v2
v_mad_u32_u16 v61, v57, s49, v2
v_mad_u32_u16 v62, v58, s49, v2
v_mad_u32_u16 v63, v59, s49, v2
buffer_load_dwordx4 a[32:35], v60, s[16:19], 0 offen sc1
buffer_load_dwordx4 a[36:39], v60, s[16:19], 0 offen offset:256 sc1
buffer_load_dwordx4 a[40:43], v61, s[16:19], 0 offen sc1
buffer_load_dwordx4 a[44:47], v61, s[16:19], 0 offen offset:256 sc1
buffer_load_dwordx4 a[48:51], v62, s[16:19], 0 offen sc1
buffer_load_dwordx4 a[52:55], v62, s[16:19], 0 offen offset:256 sc1
buffer_load_dwordx4 a[56:59], v63, s[16:19], 0 offen sc1
buffer_load_dwordx4 a[60:63], v63, s[16:19], 0 offen offset:256 sc1
s_waitcnt vmcnt(56)
v_mfma_f32_16x16x32_bf16 v[48:51], a[64:67], v[40:43], v[48:51]
v_mfma_f32_16x16x32_bf16 v[48:51], a[68:71], v[44:47], v[48:51]
s_bitcmp1_b32 s46, 8
s_cbranch_scc0 LE_nf8
s_cmp_eq_u32 s42, 0
s_cbranch_scc1 LE_fl8
buffer_load_dwordx2 v[66:67], v39, s[20:23], s47 offen sc1
s_waitcnt vmcnt(0)
v_lshlrev_b32 v64, 16, v66
v_and_b32 v65, 0xffff0000, v66
v_add_f32 v48, v48, v64
v_add_f32 v49, v49, v65
v_lshlrev_b32 v64, 16, v67
v_and_b32 v65, 0xffff0000, v67
v_add_f32 v50, v50, v64
v_add_f32 v51, v51, v65
LE_fl8:
s_nop 3
v_cvt_pk_bf16_f32 v64, v48, v49
v_cvt_pk_bf16_f32 v65, v50, v51
v_mov_b32 v48, 0
v_mov_b32 v49, 0
v_mov_b32 v50, 0
v_mov_b32 v51, 0
buffer_store_dwordx2 v[64:65], v39, s[20:23], s47 offen sc1
s_add_u32 s47, s47, 512
LE_nf8:
v_mfma_f32_16x16x32_bf16 v[48:51], a[72:75], v[40:43], v[48:51]
v_mfma_f32_16x16x32_bf16 v[48:51], a[76:79], v[44:47], v[48:51]
s_bitcmp1_b32 s46, 9
s_cbranch_scc0 LE_nf9
s_cmp_eq_u32 s42, 0
s_cbranch_scc1 LE_fl9
buffer_load_dwordx2 v[66:67], v39, s[20:23], s47 offen sc1
s_waitcnt vmcnt(0)
v_lshlrev_b32 v64, 16, v66
v_and_b32 v65, 0xffff0000, v66
v_add_f32 v48, v48, v64
v_add_f32 v49, v49, v65
v_lshlrev_b32 v64, 16, v67
v_and_b32 v65, 0xffff0000, v67
v_add_f32 v50, v50, v64
v_add_f32 v51, v51, v65
LE_fl9:
s_nop 3
v_cvt_pk_bf16_f32 v64, v48, v49
v_cvt_pk_bf16_f32 v65, v50, v51
v_mov_b32 v48, 0
v_mov_b32 v49, 0
v_mov_b32 v50, 0
v_mov_b32 v51, 0
buffer_store_dwordx2 v[64:65], v39, s[20:23], s47 offen sc1
s_add_u32 s47, s47, 512
LE_nf9:
v_mfma_f32_16x16x32_bf16 v[48:51], a[80:83], v[40:43], v[48:51]
v_mfma_f32_16x16x32_bf16 v[48:51], a[84:87], v[44:47], v[48:51]
s_bitcmp1_b32 s46, 10
s_cbranch_scc0 LE_nf10
s_cmp_eq_u32 s42, 0
s_cbranch_scc1 LE_fl10
buffer_load_dwordx2 v[66:67], v39, s[20:23], s47 offen sc1
s_waitcnt vmcnt(0)
v_lshlrev_b32 v64, 16, v66
v_and_b32 v65, 0xffff0000, v66
v_add_f32 v48, v48, v64
v_add_f32 v49, v49, v65
v_lshlrev_b32 v64, 16, v67
v_and_b32 v65, 0xffff0000, v67
v_add_f32 v50, v50, v64
v_add_f32 v51, v51, v65
LE_fl10:
s_nop 3
v_cvt_pk_bf16_f32 v64, v48, v49
v_cvt_pk_bf16_f32 v65, v50, v51
v_mov_b32 v48, 0
v_mov_b32 v49, 0
v_mov_b32 v50, 0
v_mov_b32 v51, 0
buffer_store_dwordx2 v[64:65], v39, s[20:23], s47 offen sc1
s_add_u32 s47, s47, 512
LE_nf10:
v_mfma_f32_16x16x32_bf16 v[48:51], a[88:91], v[40:43], v[48:51]
v_mfma_f32_16x16x32_bf16 v[48:51], a[92:95], v[44:47], v[48:51]
s_bitcmp1_b32 s46, 11
s_cbranch_scc0 LE_nf11
s_cmp_eq_u32 s42, 0
s_cbranch_scc1 LE_fl11
buffer_load_dwordx2 v[66:67], v39, s[20:23], s47 offen sc1
s_waitcnt vmcnt(0)
v_lshlrev_b32 v64, 16, v66
v_and_b32 v65, 0xffff0000, v66
v_add_f32 v48, v48, v64
v_add_f32 v49, v49, v65
v_lshlrev_b32 v64, 16, v67
v_and_b32 v65, 0xffff0000, v67
v_add_f32 v50, v50, v64
v_add_f32 v51, v51, v65
LE_fl11:
s_nop 3
v_cvt_pk_bf16_f32 v64, v48, v49
v_cvt_pk_bf16_f32 v65, v50, v51
v_mov_b32 v48, 0
v_mov_b32 v49, 0
v_mov_b32 v50, 0
v_mov_b32 v51, 0
buffer_store_dwordx2 v[64:65], v39, s[20:23], s47 offen sc1
s_add_u32 s47, s47, 512
LE_nf11:
s_waitcnt lgkmcnt(0)
ds_read2_b32 v[56:57], v34 offset0:48 offset1:52
ds_read2_b32 v[58:59], v34 offset0:56 offset1:60
v_mad_u32_u16 v60, v52, s49, v2
v_mad_u32_u16 v61, v53, s49, v2
v_mad_u32_u16 v62, v54, s49, v2
v_mad_u32_u16 v63, v55, s49, v2
buffer_load_dwordx4 a[64:67], v60, s[16:19], 0 offen sc1
buffer_load_dwordx4 a[68:71], v60, s[16:19], 0 offen offset:256 sc1
buffer_load_dwordx4 a[72:75], v61, s[16:19], 0 offen sc1
buffer_load_dwordx4 a[76:79], v61, s[16:19], 0 offen offset:256 sc1
buffer_load_dwordx4 a[80:83], v62, s[16:19], 0 offen sc1
buffer_load_dwordx4 a[84:87], v62, s[16:19], 0 offen offset:256 sc1
buffer_load_dwordx4 a[88:91], v63, s[16:19], 0 offen sc1
buffer_load_dwordx4 a[92:95], v63, s[16:19], 0 offen offset:256 sc1
s_waitcnt vmcnt(56)
v_mfma_f32_16x16x32_bf16 v[48:51], a[96:99], v[40:43], v[48:51]
v_mfma_f32_16x16x32_bf16 v[48:51], a[100:103], v[44:47], v[48:51]
s_bitcmp1_b32 s46, 12
s_cbranch_scc0 LE_nf12
s_cmp_eq_u32 s42, 0
s_cbranch_scc1 LE_fl12
buffer_load_dwordx2 v[66:67], v39, s[20:23], s47 offen sc1
s_waitcnt vmcnt(0)
v_lshlrev_b32 v64, 16, v66
v_and_b32 v65, 0xffff0000, v66
v_add_f32 v48, v48, v64
v_add_f32 v49, v49, v65
v_lshlrev_b32 v64, 16, v67
v_and_b32 v65, 0xffff0000, v67
v_add_f32 v50, v50, v64
v_add_f32 v51, v51, v65
LE_fl12:
s_nop 3
v_cvt_pk_bf16_f32 v64, v48, v49
v_cvt_pk_bf16_f32 v65, v50, v51
v_mov_b32 v48, 0
v_mov_b32 v49, 0
v_mov_b32 v50, 0
v_mov_b32 v51, 0
buffer_store_dwordx2 v[64:65], v39, s[20:23], s47 offen sc1
s_add_u32 s47, s47, 512
LE_nf12:
v_mfma_f32_16x16x32_bf16 v[48:51], a[104:107], v[40:43], v[48:51]
v_mfma_f32_16x16x32_bf16 v[48:51], a[108:111], v[44:47], v[48:51]
s_bitcmp1_b32 s46, 13
s_cbranch_scc0 LE_nf13
s_cmp_eq_u32 s42, 0
s_cbranch_scc1 LE_fl13
buffer_load_dwordx2 v[66:67], v39, s[20:23], s47 offen sc1
s_waitcnt vmcnt(0)
v_lshlrev_b32 v64, 16, v66
v_and_b32 v65, 0xffff0000, v66
v_add_f32 v48, v48, v64
v_add_f32 v49, v49, v65
v_lshlrev_b32 v64, 16, v67
v_and_b32 v65, 0xffff0000, v67
v_add_f32 v50, v50, v64
v_add_f32 v51, v51, v65
LE_fl13:
s_nop 3
v_cvt_pk_bf16_f32 v64, v48, v49
v_cvt_pk_bf16_f32 v65, v50, v51
v_mov_b32 v48, 0
v_mov_b32 v49, 0
v_mov_b32 v50, 0
v_mov_b32 v51, 0
buffer_store_dwordx2 v[64:65], v39, s[20:23], s47 offen sc1
s_add_u32 s47, s47, 512
LE_nf13:
v_mfma_f32_16x16x32_bf16 v[48:51], a[112:115], v[40:43], v[48:51]
v_mfma_f32_16x16x32_bf16 v[48:51], a[116:119], v[44:47], v[48:51]
s_bitcmp1_b32 s46, 14
s_cbranch_scc0 LE_nf14
s_cmp_eq_u32 s42, 0
s_cbranch_scc1 LE_fl14
buffer_load_dwordx2 v[66:67], v39, s[20:23], s47 offen sc1
s_waitcnt vmcnt(0)
v_lshlrev_b32 v64, 16, v66
v_and_b32 v65, 0xffff0000, v66
v_add_f32 v48, v48, v64
v_add_f32 v49, v49, v65
v_lshlrev_b32 v64, 16, v67
v_and_b32 v65, 0xffff0000, v67
v_add_f32 v50, v50, v64
v_add_f32 v51, v51, v65
LE_fl14:
s_nop 3
v_cvt_pk_bf16_f32 v64, v48, v49
v_cvt_pk_bf16_f32 v65, v50, v51
v_mov_b32 v48, 0
v_mov_b32 v49, 0
v_mov_b32 v50, 0
v_mov_b32 v51, 0
buffer_store_dwordx2 v[64:65], v39, s[20:23], s47 offen sc1
s_add_u32 s47, s47, 512
LE_nf14:
v_mfma_f32_16x16x32_bf16 v[48:51], a[120:123], v[40:43], v[48:51]
v_mfma_f32_16x16x32_bf16 v[48:51], a[124:127], v[44:47], v[48:51]
s_bitcmp1_b32 s46, 15
s_cbranch_scc0 LE_nf15
s_cmp_eq_u32 s42, 0
s_cbranch_scc1 LE_fl15
buffer_load_dwordx2 v[66:67], v39, s[20:23], s47 offen sc1
s_waitcnt vmcnt(0)
v_lshlrev_b32 v64, 16, v66
v_and_b32 v65, 0xffff0000, v66
v_add_f32 v48, v48, v64
v_add_f32 v49, v49, v65
v_lshlrev_b32 v64, 16, v67
v_and_b32 v65, 0xffff0000, v67
v_add_f32 v50, v50, v64
v_add_f32 v51, v51, v65
LE_fl15:
s_nop 3
v_cvt_pk_bf16_f32 v64, v48, v49
v_cvt_pk_bf16_f32 v65, v50, v51
v_mov_b32 v48, 0
v_mov_b32 v49, 0
v_mov_b32 v50, 0
v_mov_b32 v51, 0
buffer_store_dwordx2 v[64:65], v39, s[20:23], s47 offen sc1
s_add_u32 s47, s47, 512
LE_nf15:
s_waitcnt lgkmcnt(0)
ds_read2_b32 v[52:53], v34 offset0:64 offset1:68
ds_read2_b32 v[54:55], v34 offset0:72 offset1:76
v_mad_u32_u16 v60, v56, s49, v2
v_mad_u32_u16 v61, v57, s49, v2
v_mad_u32_u16 v62, v58, s49, v2
v_mad_u32_u16 v63, v59, s49, v2
buffer_load_dwordx4 a[96:99], v60, s[16:19], 0 offen sc1
buffer_load_dwordx4 a[100:103], v60, s[16:19], 0 offen offset:256 sc1
buffer_load_dwordx4 a[104:107], v61, s[16:19], 0 offen sc1
buffer_load_dwordx4 a[108:111], v61, s[16:19], 0 offen offset:256 sc1
buffer_load_dwordx4 a[112:115], v62, s[16:19], 0 offen sc1
buffer_load_dwordx4 a[116:119], v62, s[16:19], 0 offen offset:256 sc1
buffer_load_dwordx4 a[120:123], v63, s[16:19], 0 offen sc1
buffer_load_dwordx4 a[124:127], v63, s[16:19], 0 offen offset:256 sc1
s_waitcnt vmcnt(56)
v_mfma_f32_16x16x32_bf16 v[48:51], a[128:131], v[40:43], v[48:51]
v_mfma_f32_16x16x32_bf16 v[48:51], a[132:135], v[44:47], v[48:51]
s_bitcmp1_b32 s46, 16
s_cbranch_scc0 LE_nf16
s_cmp_eq_u32 s42, 0
s_cbranch_scc1 LE_fl16
buffer_load_dwordx2 v[66:67], v39, s[20:23], s47 offen sc1
s_waitcnt vmcnt(0)
v_lshlrev_b32 v64, 16, v66
v_and_b32 v65, 0xffff0000, v66
v_add_f32 v48, v48, v64
v_add_f32 v49, v49, v65
v_lshlrev_b32 v64, 16, v67
v_and_b32 v65, 0xffff0000, v67
v_add_f32 v50, v50, v64
v_add_f32 v51, v51, v65
LE_fl16:
s_nop 3
v_cvt_pk_bf16_f32 v64, v48, v49
v_cvt_pk_bf16_f32 v65, v50, v51
v_mov_b32 v48, 0
v_mov_b32 v49, 0
v_mov_b32 v50, 0
v_mov_b32 v51, 0
buffer_store_dwordx2 v[64:65], v39, s[20:23], s47 offen sc1
s_add_u32 s47, s47, 512
LE_nf16:
v_mfma_f32_16x16x32_bf16 v[48:51], a[136:139], v[40:43], v[48:51]
v_mfma_f32_16x16x32_bf16 v[48:51], a[140:143], v[44:47], v[48:51]
s_bitcmp1_b32 s46, 17
s_cbranch_scc0 LE_nf17
s_cmp_eq_u32 s42, 0
s_cbranch_scc1 LE_fl17
buffer_load_dwordx2 v[66:67], v39, s[20:23], s47 offen sc1
s_waitcnt vmcnt(0)
v_lshlrev_b32 v64, 16, v66
v_and_b32 v65, 0xffff0000, v66
v_add_f32 v48, v48, v64
v_add_f32 v49, v49, v65
v_lshlrev_b32 v64, 16, v67
v_and_b32 v65, 0xffff0000, v67
v_add_f32 v50, v50, v64
v_add_f32 v51, v51, v65
LE_fl17:
s_nop 3
v_cvt_pk_bf16_f32 v64, v48, v49
v_cvt_pk_bf16_f32 v65, v50, v51
v_mov_b32 v48, 0
v_mov_b32 v49, 0
v_mov_b32 v50, 0
v_mov_b32 v51, 0
buffer_store_dwordx2 v[64:65], v39, s[20:23], s47 offen sc1
s_add_u32 s47, s47, 512
LE_nf17:
v_mfma_f32_16x16x32_bf16 v[48:51], a[144:147], v[40:43], v[48:51]
v_mfma_f32_16x16x32_bf16 v[48:51], a[148:151], v[44:47], v[48:51]
s_bitcmp1_b32 s46, 18
s_cbranch_scc0 LE_nf18
s_cmp_eq_u32 s42, 0
s_cbranch_scc1 LE_fl18
buffer_load_dwordx2 v[66:67], v39, s[20:23], s47 offen sc1
s_waitcnt vmcnt(0)
v_lshlrev_b32 v64, 16, v66
v_and_b32 v65, 0xffff0000, v66
v_add_f32 v48, v48, v64
v_add_f32 v49, v49, v65
v_lshlrev_b32 v64, 16, v67
v_and_b32 v65, 0xffff0000, v67
v_add_f32 v50, v50, v64
v_add_f32 v51, v51, v65
LE_fl18:
s_nop 3
v_cvt_pk_bf16_f32 v64, v48, v49
v_cvt_pk_bf16_f32 v65, v50, v51
v_mov_b32 v48, 0
v_mov_b32 v49, 0
v_mov_b32 v50, 0
v_mov_b32 v51, 0
buffer_store_dwordx2 v[64:65], v39, s[20:23], s47 offen sc1
s_add_u32 s47, s47, 512
LE_nf18:
v_mfma_f32_16x16x32_bf16 v[48:51], a[152:155], v[40:43], v[48:51]
v_mfma_f32_16x16x32_bf16 v[48:51], a[156:159], v[44:47], v[48:51]
s_bitcmp1_b32 s46, 19
s_cbranch_scc0 LE_nf19
s_cmp_eq_u32 s42, 0
s_cbranch_scc1 LE_fl19
buffer_load_dwordx2 v[66:67], v39, s[20:23], s47 offen sc1
s_waitcnt vmcnt(0)
v_lshlrev_b32 v64, 16, v66
v_and_b32 v65, 0xffff0000, v66
v_add_f32 v48, v48, v64
v_add_f32 v49, v49, v65
v_lshlrev_b32 v64, 16, v67
v_and_b32 v65, 0xffff0000, v67
v_add_f32 v50, v50, v64
v_add_f32 v51, v51, v65
LE_fl19:
s_nop 3
v_cvt_pk_bf16_f32 v64, v48, v49
v_cvt_pk_bf16_f32 v65, v50, v51
v_mov_b32 v48, 0
v_mov_b32 v49, 0
v_mov_b32 v50, 0
v_mov_b32 v51, 0
buffer_store_dwordx2 v[64:65], v39, s[20:23], s47 offen sc1
s_add_u32 s47, s47, 512
LE_nf19:
s_waitcnt lgkmcnt(0)
ds_read2_b32 v[56:57], v34 offset0:80 offset1:84
ds_read2_b32 v[58:59], v34 offset0:88 offset1:92
v_mad_u32_u16 v60, v52, s49, v2
v_mad_u32_u16 v61, v53, s49, v2
v_mad_u32_u16 v62, v54, s49, v2
v_mad_u32_u16 v63, v55, s49, v2
buffer_load_dwordx4 a[128:131], v60, s[16:19], 0 offen sc1
buffer_load_dwordx4 a[132:135], v60, s[16:19], 0 offen offset:256 sc1
buffer_load_dwordx4 a[136:139], v61, s[16:19], 0 offen sc1
buffer_load_dwordx4 a[140:143], v61, s[16:19], 0 offen offset:256 sc1
buffer_load_dwordx4 a[144:147], v62, s[16:19], 0 offen sc1
buffer_load_dwordx4 a[148:151], v62, s[16:19], 0 offen offset:256 sc1
buffer_load_dwordx4 a[152:155], v63, s[16:19], 0 offen sc1
buffer_load_dwordx4 a[156:159], v63, s[16:19], 0 offen offset:256 sc1
s_waitcnt vmcnt(56)
v_mfma_f32_16x16x32_bf16 v[48:51], a[160:163], v[40:43], v[48:51]
v_mfma_f32_16x16x32_bf16 v[48:51], a[164:167], v[44:47], v[48:51]
s_bitcmp1_b32 s46, 20
s_cbranch_scc0 LE_nf20
s_cmp_eq_u32 s42, 0
s_cbranch_scc1 LE_fl20
buffer_load_dwordx2 v[66:67], v39, s[20:23], s47 offen sc1
s_waitcnt vmcnt(0)
v_lshlrev_b32 v64, 16, v66
v_and_b32 v65, 0xffff0000, v66
v_add_f32 v48, v48, v64
v_add_f32 v49, v49, v65
v_lshlrev_b32 v64, 16, v67
v_and_b32 v65, 0xffff0000, v67
v_add_f32 v50, v50, v64
v_add_f32 v51, v51, v65
LE_fl20:
s_nop 3
v_cvt_pk_bf16_f32 v64, v48, v49
v_cvt_pk_bf16_f32 v65, v50, v51
v_mov_b32 v48, 0
v_mov_b32 v49, 0
v_mov_b32 v50, 0
v_mov_b32 v51, 0
buffer_store_dwordx2 v[64:65], v39, s[20:23], s47 offen sc1
s_add_u32 s47, s47, 512
LE_nf20:
v_mfma_f32_16x16x32_bf16 v[48:51], a[168:171], v[40:43], v[48:51]
v_mfma_f32_16x16x32_bf16 v[48:51], a[172:175], v[44:47], v[48:51]
s_bitcmp1_b32 s46, 21
s_cbranch_scc0 LE_nf21
s_cmp_eq_u32 s42, 0
s_cbranch_scc1 LE_fl21
buffer_load_dwordx2 v[66:67], v39, s[20:23], s47 offen sc1
s_waitcnt vmcnt(0)
v_lshlrev_b32 v64, 16, v66
v_and_b32 v65, 0xffff0000, v66
v_add_f32 v48, v48, v64
v_add_f32 v49, v49, v65
v_lshlrev_b32 v64, 16, v67
v_and_b32 v65, 0xffff0000, v67
v_add_f32 v50, v50, v64
v_add_f32 v51, v51, v65
LE_fl21:
s_nop 3
v_cvt_pk_bf16_f32 v64, v48, v49
v_cvt_pk_bf16_f32 v65, v50, v51
v_mov_b32 v48, 0
v_mov_b32 v49, 0
v_mov_b32 v50, 0
v_mov_b32 v51, 0
buffer_store_dwordx2 v[64:65], v39, s[20:23], s47 offen sc1
s_add_u32 s47, s47, 512
LE_nf21:
v_mfma_f32_16x16x32_bf16 v[48:51], a[176:179], v[40:43], v[48:51]
v_mfma_f32_16x16x32_bf16 v[48:51], a[180:183], v[44:47], v[48:51]
s_bitcmp1_b32 s46, 22
s_cbranch_scc0 LE_nf22
s_cmp_eq_u32 s42, 0
s_cbranch_scc1 LE_fl22
buffer_load_dwordx2 v[66:67], v39, s[20:23], s47 offen sc1
s_waitcnt vmcnt(0)
v_lshlrev_b32 v64, 16, v66
v_and_b32 v65, 0xffff0000, v66
v_add_f32 v48, v48, v64
v_add_f32 v49, v49, v65
v_lshlrev_b32 v64, 16, v67
v_and_b32 v65, 0xffff0000, v67
v_add_f32 v50, v50, v64
v_add_f32 v51, v51, v65
LE_fl22:
s_nop 3
v_cvt_pk_bf16_f32 v64, v48, v49
v_cvt_pk_bf16_f32 v65, v50, v51
v_mov_b32 v48, 0
v_mov_b32 v49, 0
v_mov_b32 v50, 0
v_mov_b32 v51, 0
buffer_store_dwordx2 v[64:65], v39, s[20:23], s47 offen sc1
s_add_u32 s47, s47, 512
LE_nf22:
v_mfma_f32_16x16x32_bf16 v[48:51], a[184:187], v[40:43], v[48:51]
v_mfma_f32_16x16x32_bf16 v[48:51], a[188:191], v[44:47], v[48:51]
s_bitcmp1_b32 s46, 23
s_cbranch_scc0 LE_nf23
s_cmp_eq_u32 s42, 0
s_cbranch_scc1 LE_fl23
buffer_load_dwordx2 v[66:67], v39, s[20:23], s47 offen sc1
s_waitcnt vmcnt(0)
v_lshlrev_b32 v64, 16, v66
v_and_b32 v65, 0xffff0000, v66
v_add_f32 v48, v48, v64
v_add_f32 v49, v49, v65
v_lshlrev_b32 v64, 16, v67
v_and_b32 v65, 0xffff0000, v67
v_add_f32 v50, v50, v64
v_add_f32 v51, v51, v65
LE_fl23:
s_nop 3
v_cvt_pk_bf16_f32 v64, v48, v49
v_cvt_pk_bf16_f32 v65, v50, v51
v_mov_b32 v48, 0
v_mov_b32 v49, 0
v_mov_b32 v50, 0
v_mov_b32 v51, 0
buffer_store_dwordx2 v[64:65], v39, s[20:23], s47 offen sc1
s_add_u32 s47, s47, 512
LE_nf23:
s_waitcnt lgkmcnt(0)
ds_read2_b32 v[52:53], v34 offset0:96 offset1:100
ds_read2_b32 v[54:55], v34 offset0:104 offset1:108
v_mad_u32_u16 v60, v56, s49, v2
v_mad_u32_u16 v61, v57, s49, v2
v_mad_u32_u16 v62, v58, s49, v2
v_mad_u32_u16 v63, v59, s49, v2
buffer_load_dwordx4 a[160:163], v60, s[16:19], 0 offen sc1
buffer_load_dwordx4 a[164:167], v60, s[16:19], 0 offen offset:256 sc1
buffer_load_dwordx4 a[168:171], v61, s[16:19], 0 offen sc1
buffer_load_dwordx4 a[172:175], v61, s[16:19], 0 offen offset:256 sc1
buffer_load_dwordx4 a[176:179], v62, s[16:19], 0 offen sc1
buffer_load_dwordx4 a[180:183], v62, s[16:19], 0 offen offset:256 sc1
buffer_load_dwordx4 a[184:187], v63, s[16:19], 0 offen sc1
buffer_load_dwordx4 a[188:191], v63, s[16:19], 0 offen offset:256 sc1
s_waitcnt vmcnt(56)
v_mfma_f32_16x16x32_bf16 v[48:51], a[192:195], v[40:43], v[48:51]
v_mfma_f32_16x16x32_bf16 v[48:51], a[196:199], v[44:47], v[48:51]
s_bitcmp1_b32 s46, 24
s_cbranch_scc0 LE_nf24
s_cmp_eq_u32 s42, 0
s_cbranch_scc1 LE_fl24
buffer_load_dwordx2 v[66:67], v39, s[20:23], s47 offen sc1
s_waitcnt vmcnt(0)
v_lshlrev_b32 v64, 16, v66
v_and_b32 v65, 0xffff0000, v66
v_add_f32 v48, v48, v64
v_add_f32 v49, v49, v65
v_lshlrev_b32 v64, 16, v67
v_and_b32 v65, 0xffff0000, v67
v_add_f32 v50, v50, v64
v_add_f32 v51, v51, v65
LE_fl24:
s_nop 3
v_cvt_pk_bf16_f32 v64, v48, v49
v_cvt_pk_bf16_f32 v65, v50, v51
v_mov_b32 v48, 0
v_mov_b32 v49, 0
v_mov_b32 v50, 0
v_mov_b32 v51, 0
buffer_store_dwordx2 v[64:65], v39, s[20:23], s47 offen sc1
s_add_u32 s47, s47, 512
LE_nf24:
v_mfma_f32_16x16x32_bf16 v[48:51], a[200:203], v[40:43], v[48:51]
v_mfma_f32_16x16x32_bf16 v[48:51], a[204:207], v[44:47], v[48:51]
s_bitcmp1_b32 s46, 25
s_cbranch_scc0 LE_nf25
s_cmp_eq_u32 s42, 0
s_cbranch_scc1 LE_fl25
buffer_load_dwordx2 v[66:67], v39, s[20:23], s47 offen sc1
s_waitcnt vmcnt(0)
v_lshlrev_b32 v64, 16, v66
v_and_b32 v65, 0xffff0000, v66
v_add_f32 v48, v48, v64
v_add_f32 v49, v49, v65
v_lshlrev_b32 v64, 16, v67
v_and_b32 v65, 0xffff0000, v67
v_add_f32 v50, v50, v64
v_add_f32 v51, v51, v65
LE_fl25:
s_nop 3
v_cvt_pk_bf16_f32 v64, v48, v49
v_cvt_pk_bf16_f32 v65, v50, v51
v_mov_b32 v48, 0
v_mov_b32 v49, 0
v_mov_b32 v50, 0
v_mov_b32 v51, 0
buffer_store_dwordx2 v[64:65], v39, s[20:23], s47 offen sc1
s_add_u32 s47, s47, 512
LE_nf25:
v_mfma_f32_16x16x32_bf16 v[48:51], a[208:211], v[40:43], v[48:51]
v_mfma_f32_16x16x32_bf16 v[48:51], a[212:215], v[44:47], v[48:51]
s_bitcmp1_b32 s46, 26
s_cbranch_scc0 LE_nf26
s_cmp_eq_u32 s42, 0
s_cbranch_scc1 LE_fl26
buffer_load_dwordx2 v[66:67], v39, s[20:23], s47 offen sc1
s_waitcnt vmcnt(0)
v_lshlrev_b32 v64, 16, v66
v_and_b32 v65, 0xffff0000, v66
v_add_f32 v48, v48, v64
v_add_f32 v49, v49, v65
v_lshlrev_b32 v64, 16, v67
v_and_b32 v65, 0xffff0000, v67
v_add_f32 v50, v50, v64
v_add_f32 v51, v51, v65
LE_fl26:
s_nop 3
v_cvt_pk_bf16_f32 v64, v48, v49
v_cvt_pk_bf16_f32 v65, v50, v51
v_mov_b32 v48, 0
v_mov_b32 v49, 0
v_mov_b32 v50, 0
v_mov_b32 v51, 0
buffer_store_dwordx2 v[64:65], v39, s[20:23], s47 offen sc1
s_add_u32 s47, s47, 512
LE_nf26:
v_mfma_f32_16x16x32_bf16 v[48:51], a[216:219], v[40:43], v[48:51]
v_mfma_f32_16x16x32_bf16 v[48:51], a[220:223], v[44:47], v[48:51]
s_bitcmp1_b32 s46, 27
s_cbranch_scc0 LE_nf27
s_cmp_eq_u32 s42, 0
s_cbranch_scc1 LE_fl27
buffer_load_dwordx2 v[66:67], v39, s[20:23], s47 offen sc1
s_waitcnt vmcnt(0)
v_lshlrev_b32 v64, 16, v66
v_and_b32 v65, 0xffff0000, v66
v_add_f32 v48, v48, v64
v_add_f32 v49, v49, v65
v_lshlrev_b32 v64, 16, v67
v_and_b32 v65, 0xffff0000, v67
v_add_f32 v50, v50, v64
v_add_f32 v51, v51, v65
LE_fl27:
s_nop 3
v_cvt_pk_bf16_f32 v64, v48, v49
v_cvt_pk_bf16_f32 v65, v50, v51
v_mov_b32 v48, 0
v_mov_b32 v49, 0
v_mov_b32 v50, 0
v_mov_b32 v51, 0
buffer_store_dwordx2 v[64:65], v39, s[20:23], s47 offen sc1
s_add_u32 s47, s47, 512
LE_nf27:
s_waitcnt lgkmcnt(0)
ds_read2_b32 v[56:57], v34 offset0:112 offset1:116
ds_read2_b32 v[58:59], v34 offset0:120 offset1:124
v_mad_u32_u16 v60, v52, s49, v2
v_mad_u32_u16 v61, v53, s49, v2
v_mad_u32_u16 v62, v54, s49, v2
v_mad_u32_u16 v63, v55, s49, v2
buffer_load_dwordx4 a[192:195], v60, s[16:19], 0 offen sc1
buffer_load_dwordx4 a[196:199], v60, s[16:19], 0 offen offset:256 sc1
buffer_load_dwordx4 a[200:203], v61, s[16:19], 0 offen sc1
buffer_load_dwordx4 a[204:207], v61, s[16:19], 0 offen offset:256 sc1
buffer_load_dwordx4 a[208:211], v62, s[16:19], 0 offen sc1
buffer_load_dwordx4 a[212:215], v62, s[16:19], 0 offen offset:256 sc1
buffer_load_dwordx4 a[216:219], v63, s[16:19], 0 offen sc1
buffer_load_dwordx4 a[220:223], v63, s[16:19], 0 offen offset:256 sc1
s_waitcnt vmcnt(56)
v_mfma_f32_16x16x32_bf16 v[48:51], a[224:227], v[40:43], v[48:51]
v_mfma_f32_16x16x32_bf16 v[48:51], a[228:231], v[44:47], v[48:51]
s_bitcmp1_b32 s46, 28
s_cbranch_scc0 LE_nf28
s_cmp_eq_u32 s42, 0
s_cbranch_scc1 LE_fl28
buffer_load_dwordx2 v[66:67], v39, s[20:23], s47 offen sc1
s_waitcnt vmcnt(0)
v_lshlrev_b32 v64, 16, v66
v_and_b32 v65, 0xffff0000, v66
v_add_f32 v48, v48, v64
v_add_f32 v49, v49, v65
v_lshlrev_b32 v64, 16, v67
v_and_b32 v65, 0xffff0000, v67
v_add_f32 v50, v50, v64
v_add_f32 v51, v51, v65
LE_fl28:
s_nop 3
v_cvt_pk_bf16_f32 v64, v48, v49
v_cvt_pk_bf16_f32 v65, v50, v51
v_mov_b32 v48, 0
v_mov_b32 v49, 0
v_mov_b32 v50, 0
v_mov_b32 v51, 0
buffer_store_dwordx2 v[64:65], v39, s[20:23], s47 offen sc1
s_add_u32 s47, s47, 512
LE_nf28:
v_mfma_f32_16x16x32_bf16 v[48:51], a[232:235], v[40:43], v[48:51]
v_mfma_f32_16x16x32_bf16 v[48:51], a[236:239], v[44:47], v[48:51]
s_bitcmp1_b32 s46, 29
s_cbranch_scc0 LE_nf29
s_cmp_eq_u32 s42, 0
s_cbranch_scc1 LE_fl29
buffer_load_dwordx2 v[66:67], v39, s[20:23], s47 offen sc1
s_waitcnt vmcnt(0)
v_lshlrev_b32 v64, 16, v66
v_and_b32 v65, 0xffff0000, v66
v_add_f32 v48, v48, v64
v_add_f32 v49, v49, v65
v_lshlrev_b32 v64, 16, v67
v_and_b32 v65, 0xffff0000, v67
v_add_f32 v50, v50, v64
v_add_f32 v51, v51, v65
LE_fl29:
s_nop 3
v_cvt_pk_bf16_f32 v64, v48, v49
v_cvt_pk_bf16_f32 v65, v50, v51
v_mov_b32 v48, 0
v_mov_b32 v49, 0
v_mov_b32 v50, 0
v_mov_b32 v51, 0
buffer_store_dwordx2 v[64:65], v39, s[20:23], s47 offen sc1
s_add_u32 s47, s47, 512
LE_nf29:
v_mfma_f32_16x16x32_bf16 v[48:51], a[240:243], v[40:43], v[48:51]
v_mfma_f32_16x16x32_bf16 v[48:51], a[244:247], v[44:47], v[48:51]
s_bitcmp1_b32 s46, 30
s_cbranch_scc0 LE_nf30
s_cmp_eq_u32 s42, 0
s_cbranch_scc1 LE_fl30
buffer_load_dwordx2 v[66:67], v39, s[20:23], s47 offen sc1
s_waitcnt vmcnt(0)
v_lshlrev_b32 v64, 16, v66
v_and_b32 v65, 0xffff0000, v66
v_add_f32 v48, v48, v64
v_add_f32 v49, v49, v65
v_lshlrev_b32 v64, 16, v67
v_and_b32 v65, 0xffff0000, v67
v_add_f32 v50, v50, v64
v_add_f32 v51, v51, v65
LE_fl30:
s_nop 3
v_cvt_pk_bf16_f32 v64, v48, v49
v_cvt_pk_bf16_f32 v65, v50, v51
v_mov_b32 v48, 0
v_mov_b32 v49, 0
v_mov_b32 v50, 0
v_mov_b32 v51, 0
buffer_store_dwordx2 v[64:65], v39, s[20:23], s47 offen sc1
s_add_u32 s47, s47, 512
LE_nf30:
v_mfma_f32_16x16x32_bf16 v[48:51], a[248:251], v[40:43], v[48:51]
v_mfma_f32_16x16x32_bf16 v[48:51], a[252:255], v[44:47], v[48:51]
s_bitcmp1_b32 s46, 31
s_cbranch_scc0 LE_nf31
s_cmp_eq_u32 s42, 0
s_cbranch_scc1 LE_fl31
buffer_load_dwordx2 v[66:67], v39, s[20:23], s47 offen sc1
s_waitcnt vmcnt(0)
v_lshlrev_b32 v64, 16, v66
v_and_b32 v65, 0xffff0000, v66
v_add_f32 v48, v48, v64
v_add_f32 v49, v49, v65
v_lshlrev_b32 v64, 16, v67
v_and_b32 v65, 0xffff0000, v67
v_add_f32 v50, v50, v64
v_add_f32 v51, v51, v65
LE_fl31:
s_nop 3
v_cvt_pk_bf16_f32 v64, v48, v49
v_cvt_pk_bf16_f32 v65, v50, v51
v_mov_b32 v48, 0
v_mov_b32 v49, 0
v_mov_b32 v50, 0
v_mov_b32 v51, 0
buffer_store_dwordx2 v[64:65], v39, s[20:23], s47 offen sc1
s_add_u32 s47, s47, 512
LE_nf31:
s_waitcnt lgkmcnt(0)
ds_read2_b32 v[52:53], v34 offset0:128 offset1:132
ds_read2_b32 v[54:55], v34 offset0:136 offset1:140
v_mad_u32_u16 v60, v56, s49, v2
v_mad_u32_u16 v61, v57, s49, v2
v_mad_u32_u16 v62, v58, s49, v2
v_mad_u32_u16 v63, v59, s49, v2
buffer_load_dwordx4 a[224:227], v60, s[16:19], 0 offen sc1
buffer_load_dwordx4 a[228:231], v60, s[16:19], 0 offen offset:256 sc1
buffer_load_dwordx4 a[232:235], v61, s[16:19], 0 offen sc1
buffer_load_dwordx4 a[236:239], v61, s[16:19], 0 offen offset:256 sc1
buffer_load_dwordx4 a[240:243], v62, s[16:19], 0 offen sc1
buffer_load_dwordx4 a[244:247], v62, s[16:19], 0 offen offset:256 sc1
buffer_load_dwordx4 a[248:251], v63, s[16:19], 0 offen sc1
buffer_load_dwordx4 a[252:255], v63, s[16:19], 0 offen offset:256 sc1
v_add_u32 v34, 512, v34
s_cmp_lt_u32 s45, s44
s_cbranch_scc1 LE_loop
s_add_u32 s42, s42, 1
s_mul_i32 s43, s42, 256
v_cmp_lt_u32 vcc, s43, v4
s_cbranch_vccz LE_done
s_cmp_ge_u32 s42, 40
s_cbranch_scc1 LE_done
s_waitcnt vmcnt(0) lgkmcnt(0)
s_add_u32 s50, s50, 1024
v_add_u32 v5, 0x100, v5
buffer_load_dwordx4 v[192:195], v6, s[12:15], s50 offen offset:0 sc1
buffer_load_dwordx4 v[196:199], v6, s[12:15], s50 offen offset:64 sc1
buffer_load_dwordx4 v[200:203], v6, s[12:15], s50 offen offset:128 sc1
buffer_load_dwordx4 v[204:207], v6, s[12:15], s50 offen offset:192 sc1
buffer_load_dwordx4 v[208:211], v6, s[12:15], s50 offen offset:256 sc1
buffer_load_dwordx4 v[212:215], v6, s[12:15], s50 offen offset:320 sc1
buffer_load_dwordx4 v[216:219], v6, s[12:15], s50 offen offset:384 sc1
buffer_load_dwordx4 v[220:223], v6, s[12:15], s50 offen offset:448 sc1
buffer_load_dwordx4 v[224:227], v6, s[12:15], s50 offen offset:512 sc1
buffer_load_dwordx4 v[228:231], v6, s[12:15], s50 offen offset:576 sc1
buffer_load_dwordx4 v[232:235], v6, s[12:15], s50 offen offset:640 sc1
buffer_load_dwordx4 v[236:239], v6, s[12:15], s50 offen offset:704 sc1
buffer_load_dwordx4 v[240:243], v6, s[12:15], s50 offen offset:768 sc1
buffer_load_dwordx4 v[244:247], v6, s[12:15], s50 offen offset:832 sc1
buffer_load_dwordx4 v[248:251], v6, s[12:15], s50 offen offset:896 sc1
buffer_load_dwordx4 v[252:255], v6, s[12:15], s50 offen offset:960 sc1
s_branch LE_pass
LE_done:
s_add_u32 s24, s4, 0x7c00000
s_addc_u32 s25, s5, 0
s_mov_b32 s26, 0x40000
s_mov_b32 s27, 0x00020000
s_add_u32 s48, s40, 1280
s_mul_i32 s48, s48, 128
s_waitcnt vmcnt(0)
v_mov_b32 v32, s98
v_mov_b32 v33, s99
s_mov_b64 exec, 1
buffer_store_dwordx2 v[32:33], off, s[24:27], s48 sc1
s_mov_b64 exec, -1
s_branch L2_end
L2_fin:
L2_end:
s_endpgm
L2_hot:
L2_rare_site0:
s_mov_b32 s36, 0
s_branch L2_rare_0_0
L2_rare_site4:
s_mov_b32 s36, 4
s_branch L2_rare_0_0
L2_rare_0_0:
s_nop 15
s_nop 15
s_waitcnt lgkmcnt(0)
v_add_u32 v250, 0x18000, v240
v_and_b32 v250, 0x1ffff, v250
ds_read_b128 v[232:235], v250 offset:16384
s_waitcnt lgkmcnt(0)
v_mfma_f32_16x16x32_bf16 v[128:131], v[232:235], v[0:3], v[192:195]
v_mfma_f32_16x16x32_bf16 v[132:135], v[232:235], v[32:35], v[196:199]
v_mfma_f32_16x16x32_bf16 v[136:139], v[232:235], v[64:67], v[200:203]
v_mfma_f32_16x16x32_bf16 v[140:143], v[232:235], v[96:99], v[204:207]
s_nop 7
ds_read_b128 v[232:235], v250 offset:16896
s_waitcnt lgkmcnt(0)
v_mfma_f32_16x16x32_bf16 v[128:131], v[232:235], v[4:7], v[128:131]
v_mfma_f32_16x16x32_bf16 v[132:135], v[232:235], v[36:39], v[132:135]
v_mfma_f32_16x16x32_bf16 v[136:139], v[232:235], v[68:71], v[136:139]
v_mfma_f32_16x16x32_bf16 v[140:143], v[232:235], v[100:103], v[140:143]
s_nop 7
ds_read_b128 v[232:235], v250 offset:20480
s_waitcnt lgkmcnt(0)
v_mfma_f32_16x16x32_bf16 v[128:131], v[232:235], v[8:11], v[128:131]
v_mfma_f32_16x16x32_bf16 v[132:135], v[232:235], v[40:43], v[132:135]
v_mfma_f32_16x16x32_bf16 v[136:139], v[232:235], v[72:75], v[136:139]
v_mfma_f32_16x16x32_bf16 v[140:143], v[232:235], v[104:107], v[140:143]
s_nop 7
ds_read_b128 v[232:235], v250 offset:20992
s_waitcnt lgkmcnt(0)
v_mfma_f32_16x16x32_bf16 v[128:131], v[232:235], v[12:15], v[128:131]
v_mfma_f32_16x16x32_bf16 v[132:135], v[232:235], v[44:47], v[132:135]
v_mfma_f32_16x16x32_bf16 v[136:139], v[232:235], v[76:79], v[136:139]
v_mfma_f32_16x16x32_bf16 v[140:143], v[232:235], v[108:111], v[140:143]
s_nop 7
ds_read_b128 v[232:235], v250 offset:24576
s_waitcnt lgkmcnt(0)
v_mfma_f32_16x16x32_bf16 v[128:131], v[232:235], v[16:19], v[128:131]
v_mfma_f32_16x16x32_bf16 v[132:135], v[232:235], v[48:51], v[132:135]
v_mfma_f32_16x16x32_bf16 v[136:139], v[232:235], v[80:83], v[136:139]
v_mfma_f32_16x16x32_bf16 v[140:143], v[232:235], v[112:115], v[140:143]
s_nop 7
ds_read_b128 v[232:235], v250 offset:25088
s_waitcnt lgkmcnt(0)
v_mfma_f32_16x16x32_bf16 v[128:131], v[232:235], v[20:23], v[128:131]
v_mfma_f32_16x16x32_bf16 v[132:135], v[232:235], v[52:55], v[132:135]
v_mfma_f32_16x16x32_bf16 v[136:139], v[232:235], v[84:87], v[136:139]
v_mfma_f32_16x16x32_bf16 v[140:143], v[232:235], v[116:119], v[140:143]
s_nop 7
ds_read_b128 v[232:235], v250 offset:28672
s_waitcnt lgkmcnt(0)
v_mfma_f32_16x16x32_bf16 v[128:131], v[232:235], v[24:27], v[128:131]
v_mfma_f32_16x16x32_bf16 v[132:135], v[232:235], v[56:59], v[132:135]
v_mfma_f32_16x16x32_bf16 v[136:139], v[232:235], v[88:91], v[136:139]
v_mfma_f32_16x16x32_bf16 v[140:143], v[232:235], v[120:123], v[140:143]
s_nop 7
ds_read_b128 v[232:235], v250 offset:29184
s_waitcnt lgkmcnt(0)
v_mfma_f32_16x16x32_bf16 v[128:131], v[232:235], v[28:31], v[128:131]
v_mfma_f32_16x16x32_bf16 v[132:135], v[232:235], v[60:63], v[132:135]
v_mfma_f32_16x16x32_bf16 v[136:139], v[232:235], v[92:95], v[136:139]
v_mfma_f32_16x16x32_bf16 v[140:143], v[232:235], v[124:127], v[140:143]
s_nop 7
s_nop 7
v_exp_f32 v248, v128
s_nop 0
v_sub_f32 v224, v224, v248
v_exp_f32 v248, v129
s_nop 0
v_sub_f32 v224, v224, v248
v_exp_f32 v248, v130
s_nop 0
v_sub_f32 v224, v224, v248
v_exp_f32 v248, v131
s_nop 0
v_sub_f32 v224, v224, v248
v_max_f32 v224, 0, v224
v_min_f32 v224, s32, v224
v_log_f32 v248, v224
v_max3_f32 v232, v128, v129, v130
v_max3_f32 v232, v232, v131, v248
v_mov_b32 v248, v232
s_nop 1
v_permlane32_swap_b32 v232, v248
s_nop 1
v_max_f32 v232, v232, v248
v_mov_b32 v248, v232
s_nop 1
v_permlane16_swap_b32 v232, v248
s_nop 1
v_max_f32 v232, v232, v248
v_ceil_f32 v232, v232
v_max_f32 v232, 0, v232
v_sub_f32 v248, 0, v232
v_exp_f32 v236, v248
s_nop 1
v_mul_f32 v224, v224, v236
v_sub_f32 v192, v192, v232
v_sub_f32 v128, v128, v232
v_sub_f32 v144, v144, v232
v_sub_f32 v193, v193, v232
v_sub_f32 v129, v129, v232
v_sub_f32 v145, v145, v232
v_sub_f32 v194, v194, v232
v_sub_f32 v130, v130, v232
v_sub_f32 v146, v146, v232
v_sub_f32 v195, v195, v232
v_sub_f32 v131, v131, v232
v_sub_f32 v147, v147, v232
v_lshlrev_b32 v242, 16, v160
v_and_b32 v248, 0xffff0000, v160
v_mul_f32 v242, v242, v236
v_mul_f32 v248, v248, v236
v_cvt_pk_bf16_f32 v160, v242, v248
v_lshlrev_b32 v242, 16, v161
v_and_b32 v248, 0xffff0000, v161
v_mul_f32 v242, v242, v236
v_mul_f32 v248, v248, v236
v_cvt_pk_bf16_f32 v161, v242, v248
v_lshlrev_b32 v242, 16, v162
v_and_b32 v248, 0xffff0000, v162
v_mul_f32 v242, v242, v236
v_mul_f32 v248, v248, v236
v_cvt_pk_bf16_f32 v162, v242, v248
v_lshlrev_b32 v242, 16, v163
v_and_b32 v248, 0xffff0000, v163
v_mul_f32 v242, v242, v236
v_mul_f32 v248, v248, v236
v_cvt_pk_bf16_f32 v163, v242, v248
v_lshlrev_b32 v242, 16, v176
v_and_b32 v248, 0xffff0000, v176
v_mul_f32 v242, v242, v236
v_mul_f32 v248, v248, v236
v_cvt_pk_bf16_f32 v176, v242, v248
v_lshlrev_b32 v242, 16, v177
v_and_b32 v248, 0xffff0000, v177
v_mul_f32 v242, v242, v236
v_mul_f32 v248, v248, v236
v_cvt_pk_bf16_f32 v177, v242, v248
v_lshlrev_b32 v242, 16, v178
v_and_b32 v248, 0xffff0000, v178
v_mul_f32 v242, v242, v236
v_mul_f32 v248, v248, v236
v_cvt_pk_bf16_f32 v178, v242, v248
v_lshlrev_b32 v242, 16, v179
v_and_b32 v248, 0xffff0000, v179
v_mul_f32 v242, v242, v236
v_mul_f32 v248, v248, v236
v_cvt_pk_bf16_f32 v179, v242, v248
v_exp_f32 v248, v132
s_nop 0
v_sub_f32 v225, v225, v248
v_exp_f32 v248, v133
s_nop 0
v_sub_f32 v225, v225, v248
v_exp_f32 v248, v134
s_nop 0
v_sub_f32 v225, v225, v248
v_exp_f32 v248, v135
s_nop 0
v_sub_f32 v225, v225, v248
v_max_f32 v225, 0, v225
v_min_f32 v225, s32, v225
v_log_f32 v248, v225
v_max3_f32 v233, v132, v133, v134
v_max3_f32 v233, v233, v135, v248
v_mov_b32 v248, v233
s_nop 1
v_permlane32_swap_b32 v233, v248
s_nop 1
v_max_f32 v233, v233, v248
v_mov_b32 v248, v233
s_nop 1
v_permlane16_swap_b32 v233, v248
s_nop 1
v_max_f32 v233, v233, v248
v_ceil_f32 v233, v233
v_max_f32 v233, 0, v233
v_sub_f32 v248, 0, v233
v_exp_f32 v237, v248
s_nop 1
v_mul_f32 v225, v225, v237
v_sub_f32 v196, v196, v233
v_sub_f32 v132, v132, v233
v_sub_f32 v148, v148, v233
v_sub_f32 v197, v197, v233
v_sub_f32 v133, v133, v233
v_sub_f32 v149, v149, v233
v_sub_f32 v198, v198, v233
v_sub_f32 v134, v134, v233
v_sub_f32 v150, v150, v233
v_sub_f32 v199, v199, v233
v_sub_f32 v135, v135, v233
v_sub_f32 v151, v151, v233
v_lshlrev_b32 v242, 16, v164
v_and_b32 v248, 0xffff0000, v164
v_mul_f32 v242, v242, v237
v_mul_f32 v248, v248, v237
v_cvt_pk_bf16_f32 v164, v242, v248
v_lshlrev_b32 v242, 16, v165
v_and_b32 v248, 0xffff0000, v165
v_mul_f32 v242, v242, v237
v_mul_f32 v248, v248, v237
v_cvt_pk_bf16_f32 v165, v242, v248
v_lshlrev_b32 v242, 16, v166
v_and_b32 v248, 0xffff0000, v166
v_mul_f32 v242, v242, v237
v_mul_f32 v248, v248, v237
v_cvt_pk_bf16_f32 v166, v242, v248
v_lshlrev_b32 v242, 16, v167
v_and_b32 v248, 0xffff0000, v167
v_mul_f32 v242, v242, v237
v_mul_f32 v248, v248, v237
v_cvt_pk_bf16_f32 v167, v242, v248
v_lshlrev_b32 v242, 16, v180
v_and_b32 v248, 0xffff0000, v180
v_mul_f32 v242, v242, v237
v_mul_f32 v248, v248, v237
v_cvt_pk_bf16_f32 v180, v242, v248
v_lshlrev_b32 v242, 16, v181
v_and_b32 v248, 0xffff0000, v181
v_mul_f32 v242, v242, v237
v_mul_f32 v248, v248, v237
v_cvt_pk_bf16_f32 v181, v242, v248
v_lshlrev_b32 v242, 16, v182
v_and_b32 v248, 0xffff0000, v182
v_mul_f32 v242, v242, v237
v_mul_f32 v248, v248, v237
v_cvt_pk_bf16_f32 v182, v242, v248
v_lshlrev_b32 v242, 16, v183
v_and_b32 v248, 0xffff0000, v183
v_mul_f32 v242, v242, v237
v_mul_f32 v248, v248, v237
v_cvt_pk_bf16_f32 v183, v242, v248
v_exp_f32 v248, v136
s_nop 0
v_sub_f32 v226, v226, v248
v_exp_f32 v248, v137
s_nop 0
v_sub_f32 v226, v226, v248
v_exp_f32 v248, v138
s_nop 0
v_sub_f32 v226, v226, v248
v_exp_f32 v248, v139
s_nop 0
v_sub_f32 v226, v226, v248
v_max_f32 v226, 0, v226
v_min_f32 v226, s32, v226
v_log_f32 v248, v226
v_max3_f32 v234, v136, v137, v138
v_max3_f32 v234, v234, v139, v248
v_mov_b32 v248, v234
s_nop 1
v_permlane32_swap_b32 v234, v248
s_nop 1
v_max_f32 v234, v234, v248
v_mov_b32 v248, v234
s_nop 1
v_permlane16_swap_b32 v234, v248
s_nop 1
v_max_f32 v234, v234, v248
v_ceil_f32 v234, v234
v_max_f32 v234, 0, v234
v_sub_f32 v248, 0, v234
v_exp_f32 v238, v248
s_nop 1
v_mul_f32 v226, v226, v238
v_sub_f32 v200, v200, v234
v_sub_f32 v136, v136, v234
v_sub_f32 v152, v152, v234
v_sub_f32 v201, v201, v234
v_sub_f32 v137, v137, v234
v_sub_f32 v153, v153, v234
v_sub_f32 v202, v202, v234
v_sub_f32 v138, v138, v234
v_sub_f32 v154, v154, v234
v_sub_f32 v203, v203, v234
v_sub_f32 v139, v139, v234
v_sub_f32 v155, v155, v234
v_lshlrev_b32 v242, 16, v168
v_and_b32 v248, 0xffff0000, v168
v_mul_f32 v242, v242, v238
v_mul_f32 v248, v248, v238
v_cvt_pk_bf16_f32 v168, v242, v248
v_lshlrev_b32 v242, 16, v169
v_and_b32 v248, 0xffff0000, v169
v_mul_f32 v242, v242, v238
v_mul_f32 v248, v248, v238
v_cvt_pk_bf16_f32 v169, v242, v248
v_lshlrev_b32 v242, 16, v170
v_and_b32 v248, 0xffff0000, v170
v_mul_f32 v242, v242, v238
v_mul_f32 v248, v248, v238
v_cvt_pk_bf16_f32 v170, v242, v248
v_lshlrev_b32 v242, 16, v171
v_and_b32 v248, 0xffff0000, v171
v_mul_f32 v242, v242, v238
v_mul_f32 v248, v248, v238
v_cvt_pk_bf16_f32 v171, v242, v248
v_lshlrev_b32 v242, 16, v184
v_and_b32 v248, 0xffff0000, v184
v_mul_f32 v242, v242, v238
v_mul_f32 v248, v248, v238
v_cvt_pk_bf16_f32 v184, v242, v248
v_lshlrev_b32 v242, 16, v185
v_and_b32 v248, 0xffff0000, v185
v_mul_f32 v242, v242, v238
v_mul_f32 v248, v248, v238
v_cvt_pk_bf16_f32 v185, v242, v248
v_lshlrev_b32 v242, 16, v186
v_and_b32 v248, 0xffff0000, v186
v_mul_f32 v242, v242, v238
v_mul_f32 v248, v248, v238
v_cvt_pk_bf16_f32 v186, v242, v248
v_lshlrev_b32 v242, 16, v187
v_and_b32 v248, 0xffff0000, v187
v_mul_f32 v242, v242, v238
v_mul_f32 v248, v248, v238
v_cvt_pk_bf16_f32 v187, v242, v248
v_exp_f32 v248, v140
s_nop 0
v_sub_f32 v227, v227, v248
v_exp_f32 v248, v141
s_nop 0
v_sub_f32 v227, v227, v248
v_exp_f32 v248, v142
s_nop 0
v_sub_f32 v227, v227, v248
v_exp_f32 v248, v143
s_nop 0
v_sub_f32 v227, v227, v248
v_max_f32 v227, 0, v227
v_min_f32 v227, s32, v227
v_log_f32 v248, v227
v_max3_f32 v235, v140, v141, v142
v_max3_f32 v235, v235, v143, v248
v_mov_b32 v248, v235
s_nop 1
v_permlane32_swap_b32 v235, v248
s_nop 1
v_max_f32 v235, v235, v248
v_mov_b32 v248, v235
s_nop 1
v_permlane16_swap_b32 v235, v248
s_nop 1
v_max_f32 v235, v235, v248
v_ceil_f32 v235, v235
v_max_f32 v235, 0, v235
v_sub_f32 v248, 0, v235
v_exp_f32 v239, v248
s_nop 1
v_mul_f32 v227, v227, v239
v_sub_f32 v204, v204, v235
v_sub_f32 v140, v140, v235
v_sub_f32 v156, v156, v235
v_sub_f32 v205, v205, v235
v_sub_f32 v141, v141, v235
v_sub_f32 v157, v157, v235
v_sub_f32 v206, v206, v235
v_sub_f32 v142, v142, v235
v_sub_f32 v158, v158, v235
v_sub_f32 v207, v207, v235
v_sub_f32 v143, v143, v235
v_sub_f32 v159, v159, v235
v_lshlrev_b32 v242, 16, v172
v_and_b32 v248, 0xffff0000, v172
v_mul_f32 v242, v242, v239
v_mul_f32 v248, v248, v239
v_cvt_pk_bf16_f32 v172, v242, v248
v_lshlrev_b32 v242, 16, v173
v_and_b32 v248, 0xffff0000, v173
v_mul_f32 v242, v242, v239
v_mul_f32 v248, v248, v239
v_cvt_pk_bf16_f32 v173, v242, v248
v_lshlrev_b32 v242, 16, v174
v_and_b32 v248, 0xffff0000, v174
v_mul_f32 v242, v242, v239
v_mul_f32 v248, v248, v239
v_cvt_pk_bf16_f32 v174, v242, v248
v_lshlrev_b32 v242, 16, v175
v_and_b32 v248, 0xffff0000, v175
v_mul_f32 v242, v242, v239
v_mul_f32 v248, v248, v239
v_cvt_pk_bf16_f32 v175, v242, v248
v_lshlrev_b32 v242, 16, v188
v_and_b32 v248, 0xffff0000, v188
v_mul_f32 v242, v242, v239
v_mul_f32 v248, v248, v239
v_cvt_pk_bf16_f32 v188, v242, v248
v_lshlrev_b32 v242, 16, v189
v_and_b32 v248, 0xffff0000, v189
v_mul_f32 v242, v242, v239
v_mul_f32 v248, v248, v239
v_cvt_pk_bf16_f32 v189, v242, v248
v_lshlrev_b32 v242, 16, v190
v_and_b32 v248, 0xffff0000, v190
v_mul_f32 v242, v242, v239
v_mul_f32 v248, v248, v239
v_cvt_pk_bf16_f32 v190, v242, v248
v_lshlrev_b32 v242, 16, v191
v_and_b32 v248, 0xffff0000, v191
v_mul_f32 v242, v242, v239
v_mul_f32 v248, v248, v239
v_cvt_pk_bf16_f32 v191, v242, v248
v_exp_f32 v128, v128
v_exp_f32 v129, v129
v_exp_f32 v130, v130
v_exp_f32 v131, v131
s_nop 1
v_add_f32 v224, v224, v128
v_add_f32 v224, v224, v129
v_add_f32 v224, v224, v130
v_add_f32 v224, v224, v131
v_exp_f32 v132, v132
v_exp_f32 v133, v133
v_exp_f32 v134, v134
v_exp_f32 v135, v135
s_nop 1
v_add_f32 v225, v225, v132
v_add_f32 v225, v225, v133
v_add_f32 v225, v225, v134
v_add_f32 v225, v225, v135
v_exp_f32 v136, v136
v_exp_f32 v137, v137
v_exp_f32 v138, v138
v_exp_f32 v139, v139
s_nop 1
v_add_f32 v226, v226, v136
v_add_f32 v226, v226, v137
v_add_f32 v226, v226, v138
v_add_f32 v226, v226, v139
v_exp_f32 v140, v140
v_exp_f32 v141, v141
v_exp_f32 v142, v142
v_exp_f32 v143, v143
s_nop 1
v_add_f32 v227, v227, v140
v_add_f32 v227, v227, v141
v_add_f32 v227, v227, v142
v_add_f32 v227, v227, v143
s_branch L2_rare_common
L2_rare_site1:
s_mov_b32 s36, 1
s_branch L2_rare_0_1
L2_rare_site5:
s_mov_b32 s36, 5
s_branch L2_rare_0_1
L2_rare_0_1:
s_nop 15
s_nop 15
s_waitcnt lgkmcnt(0)
v_add_u32 v250, 0x18000, v240
v_and_b32 v250, 0x1ffff, v250
ds_read_b128 v[232:235], v250 offset:18432
s_waitcnt lgkmcnt(0)
v_mfma_f32_16x16x32_bf16 v[144:147], v[232:235], v[0:3], v[192:195]
v_mfma_f32_16x16x32_bf16 v[148:151], v[232:235], v[32:35], v[196:199]
v_mfma_f32_16x16x32_bf16 v[152:155], v[232:235], v[64:67], v[200:203]
v_mfma_f32_16x16x32_bf16 v[156:159], v[232:235], v[96:99], v[204:207]
s_nop 7
ds_read_b128 v[232:235], v250 offset:18944
s_waitcnt lgkmcnt(0)
v_mfma_f32_16x16x32_bf16 v[144:147], v[232:235], v[4:7], v[144:147]
v_mfma_f32_16x16x32_bf16 v[148:151], v[232:235], v[36:39], v[148:151]
v_mfma_f32_16x16x32_bf16 v[152:155], v[232:235], v[68:71], v[152:155]
v_mfma_f32_16x16x32_bf16 v[156:159], v[232:235], v[100:103], v[156:159]
s_nop 7
ds_read_b128 v[232:235], v250 offset:22528
s_waitcnt lgkmcnt(0)
v_mfma_f32_16x16x32_bf16 v[144:147], v[232:235], v[8:11], v[144:147]
v_mfma_f32_16x16x32_bf16 v[148:151], v[232:235], v[40:43], v[148:151]
v_mfma_f32_16x16x32_bf16 v[152:155], v[232:235], v[72:75], v[152:155]
v_mfma_f32_16x16x32_bf16 v[156:159], v[232:235], v[104:107], v[156:159]
s_nop 7
ds_read_b128 v[232:235], v250 offset:23040
s_waitcnt lgkmcnt(0)
v_mfma_f32_16x16x32_bf16 v[144:147], v[232:235], v[12:15], v[144:147]
v_mfma_f32_16x16x32_bf16 v[148:151], v[232:235], v[44:47], v[148:151]
v_mfma_f32_16x16x32_bf16 v[152:155], v[232:235], v[76:79], v[152:155]
v_mfma_f32_16x16x32_bf16 v[156:159], v[232:235], v[108:111], v[156:159]
s_nop 7
ds_read_b128 v[232:235], v250 offset:26624
s_waitcnt lgkmcnt(0)
v_mfma_f32_16x16x32_bf16 v[144:147], v[232:235], v[16:19], v[144:147]
v_mfma_f32_16x16x32_bf16 v[148:151], v[232:235], v[48:51], v[148:151]
v_mfma_f32_16x16x32_bf16 v[152:155], v[232:235], v[80:83], v[152:155]
v_mfma_f32_16x16x32_bf16 v[156:159], v[232:235], v[112:115], v[156:159]
s_nop 7
ds_read_b128 v[232:235], v250 offset:27136
s_waitcnt lgkmcnt(0)
v_mfma_f32_16x16x32_bf16 v[144:147], v[232:235], v[20:23], v[144:147]
v_mfma_f32_16x16x32_bf16 v[148:151], v[232:235], v[52:55], v[148:151]
v_mfma_f32_16x16x32_bf16 v[152:155], v[232:235], v[84:87], v[152:155]
v_mfma_f32_16x16x32_bf16 v[156:159], v[232:235], v[116:119], v[156:159]
s_nop 7
ds_read_b128 v[232:235], v250 offset:30720
s_waitcnt lgkmcnt(0)
v_mfma_f32_16x16x32_bf16 v[144:147], v[232:235], v[24:27], v[144:147]
v_mfma_f32_16x16x32_bf16 v[148:151], v[232:235], v[56:59], v[148:151]
v_mfma_f32_16x16x32_bf16 v[152:155], v[232:235], v[88:91], v[152:155]
v_mfma_f32_16x16x32_bf16 v[156:159], v[232:235], v[120:123], v[156:159]
s_nop 7
ds_read_b128 v[232:235], v250 offset:31232
s_waitcnt lgkmcnt(0)
v_mfma_f32_16x16x32_bf16 v[144:147], v[232:235], v[28:31], v[144:147]
v_mfma_f32_16x16x32_bf16 v[148:151], v[232:235], v[60:63], v[148:151]
v_mfma_f32_16x16x32_bf16 v[152:155], v[232:235], v[92:95], v[152:155]
v_mfma_f32_16x16x32_bf16 v[156:159], v[232:235], v[124:127], v[156:159]
s_nop 7
s_nop 7
v_exp_f32 v248, v144
s_nop 0
v_sub_f32 v224, v224, v248
v_exp_f32 v248, v145
s_nop 0
v_sub_f32 v224, v224, v248
v_exp_f32 v248, v146
s_nop 0
v_sub_f32 v224, v224, v248
v_exp_f32 v248, v147
s_nop 0
v_sub_f32 v224, v224, v248
v_max_f32 v224, 0, v224
v_min_f32 v224, s32, v224
v_log_f32 v248, v224
v_max3_f32 v232, v144, v145, v146
v_max3_f32 v232, v232, v147, v248
v_mov_b32 v248, v232
s_nop 1
v_permlane32_swap_b32 v232, v248
s_nop 1
v_max_f32 v232, v232, v248
v_mov_b32 v248, v232
s_nop 1
v_permlane16_swap_b32 v232, v248
s_nop 1
v_max_f32 v232, v232, v248
v_ceil_f32 v232, v232
v_max_f32 v232, 0, v232
v_sub_f32 v248, 0, v232
v_exp_f32 v236, v248
s_nop 1
v_mul_f32 v224, v224, v236
v_sub_f32 v192, v192, v232
v_sub_f32 v144, v144, v232
v_sub_f32 v128, v128, v232
v_sub_f32 v193, v193, v232
v_sub_f32 v145, v145, v232
v_sub_f32 v129, v129, v232
v_sub_f32 v194, v194, v232
v_sub_f32 v146, v146, v232
v_sub_f32 v130, v130, v232
v_sub_f32 v195, v195, v232
v_sub_f32 v147, v147, v232
v_sub_f32 v131, v131, v232
v_lshlrev_b32 v242, 16, v160
v_and_b32 v248, 0xffff0000, v160
v_mul_f32 v242, v242, v236
v_mul_f32 v248, v248, v236
v_cvt_pk_bf16_f32 v160, v242, v248
v_lshlrev_b32 v242, 16, v161
v_and_b32 v248, 0xffff0000, v161
v_mul_f32 v242, v242, v236
v_mul_f32 v248, v248, v236
v_cvt_pk_bf16_f32 v161, v242, v248
v_lshlrev_b32 v242, 16, v162
v_and_b32 v248, 0xffff0000, v162
v_mul_f32 v242, v242, v236
v_mul_f32 v248, v248, v236
v_cvt_pk_bf16_f32 v162, v242, v248
v_lshlrev_b32 v242, 16, v163
v_and_b32 v248, 0xffff0000, v163
v_mul_f32 v242, v242, v236
v_mul_f32 v248, v248, v236
v_cvt_pk_bf16_f32 v163, v242, v248
v_lshlrev_b32 v242, 16, v176
v_and_b32 v248, 0xffff0000, v176
v_mul_f32 v242, v242, v236
v_mul_f32 v248, v248, v236
v_cvt_pk_bf16_f32 v176, v242, v248
v_lshlrev_b32 v242, 16, v177
v_and_b32 v248, 0xffff0000, v177
v_mul_f32 v242, v242, v236
v_mul_f32 v248, v248, v236
v_cvt_pk_bf16_f32 v177, v242, v248
v_exp_f32 v248, v148
s_nop 0
v_sub_f32 v225, v225, v248
v_exp_f32 v248, v149
s_nop 0
v_sub_f32 v225, v225, v248
v_exp_f32 v248, v150
s_nop 0
v_sub_f32 v225, v225, v248
v_exp_f32 v248, v151
s_nop 0
v_sub_f32 v225, v225, v248
v_max_f32 v225, 0, v225
v_min_f32 v225, s32, v225
v_log_f32 v248, v225
v_max3_f32 v233, v148, v149, v150
v_max3_f32 v233, v233, v151, v248
v_mov_b32 v248, v233
s_nop 1
v_permlane32_swap_b32 v233, v248
s_nop 1
v_max_f32 v233, v233, v248
v_mov_b32 v248, v233
s_nop 1
v_permlane16_swap_b32 v233, v248
s_nop 1
v_max_f32 v233, v233, v248
v_ceil_f32 v233, v233
v_max_f32 v233, 0, v233
v_sub_f32 v248, 0, v233
v_exp_f32 v237, v248
s_nop 1
v_mul_f32 v225, v225, v237
v_sub_f32 v196, v196, v233
v_sub_f32 v148, v148, v233
v_sub_f32 v132, v132, v233
v_sub_f32 v197, v197, v233
v_sub_f32 v149, v149, v233
v_sub_f32 v133, v133, v233
v_sub_f32 v198, v198, v233
v_sub_f32 v150, v150, v233
v_sub_f32 v134, v134, v233
v_sub_f32 v199, v199, v233
v_sub_f32 v151, v151, v233
v_sub_f32 v135, v135, v233
v_lshlrev_b32 v242, 16, v164
v_and_b32 v248, 0xffff0000, v164
v_mul_f32 v242, v242, v237
v_mul_f32 v248, v248, v237
v_cvt_pk_bf16_f32 v164, v242, v248
v_lshlrev_b32 v242, 16, v165
v_and_b32 v248, 0xffff0000, v165
v_mul_f32 v242, v242, v237
v_mul_f32 v248, v248, v237
v_cvt_pk_bf16_f32 v165, v242, v248
v_lshlrev_b32 v242, 16, v166
v_and_b32 v248, 0xffff0000, v166
v_mul_f32 v242, v242, v237
v_mul_f32 v248, v248, v237
v_cvt_pk_bf16_f32 v166, v242, v248
v_lshlrev_b32 v242, 16, v167
v_and_b32 v248, 0xffff0000, v167
v_mul_f32 v242, v242, v237
v_mul_f32 v248, v248, v237
v_cvt_pk_bf16_f32 v167, v242, v248
v_lshlrev_b32 v242, 16, v180
v_and_b32 v248, 0xffff0000, v180
v_mul_f32 v242, v242, v237
v_mul_f32 v248, v248, v237
v_cvt_pk_bf16_f32 v180, v242, v248
v_lshlrev_b32 v242, 16, v181
v_and_b32 v248, 0xffff0000, v181
v_mul_f32 v242, v242, v237
v_mul_f32 v248, v248, v237
v_cvt_pk_bf16_f32 v181, v242, v248
v_exp_f32 v248, v152
s_nop 0
v_sub_f32 v226, v226, v248
v_exp_f32 v248, v153
s_nop 0
v_sub_f32 v226, v226, v248
v_exp_f32 v248, v154
s_nop 0
v_sub_f32 v226, v226, v248
v_exp_f32 v248, v155
s_nop 0
v_sub_f32 v226, v226, v248
v_max_f32 v226, 0, v226
v_min_f32 v226, s32, v226
v_log_f32 v248, v226
v_max3_f32 v234, v152, v153, v154
v_max3_f32 v234, v234, v155, v248
v_mov_b32 v248, v234
s_nop 1
v_permlane32_swap_b32 v234, v248
s_nop 1
v_max_f32 v234, v234, v248
v_mov_b32 v248, v234
s_nop 1
v_permlane16_swap_b32 v234, v248
s_nop 1
v_max_f32 v234, v234, v248
v_ceil_f32 v234, v234
v_max_f32 v234, 0, v234
v_sub_f32 v248, 0, v234
v_exp_f32 v238, v248
s_nop 1
v_mul_f32 v226, v226, v238
v_sub_f32 v200, v200, v234
v_sub_f32 v152, v152, v234
v_sub_f32 v136, v136, v234
v_sub_f32 v201, v201, v234
v_sub_f32 v153, v153, v234
v_sub_f32 v137, v137, v234
v_sub_f32 v202, v202, v234
v_sub_f32 v154, v154, v234
v_sub_f32 v138, v138, v234
v_sub_f32 v203, v203, v234
v_sub_f32 v155, v155, v234
v_sub_f32 v139, v139, v234
v_lshlrev_b32 v242, 16, v168
v_and_b32 v248, 0xffff0000, v168
v_mul_f32 v242, v242, v238
v_mul_f32 v248, v248, v238
v_cvt_pk_bf16_f32 v168, v242, v248
v_lshlrev_b32 v242, 16, v169
v_and_b32 v248, 0xffff0000, v169
v_mul_f32 v242, v242, v238
v_mul_f32 v248, v248, v238
v_cvt_pk_bf16_f32 v169, v242, v248
v_lshlrev_b32 v242, 16, v170
v_and_b32 v248, 0xffff0000, v170
v_mul_f32 v242, v242, v238
v_mul_f32 v248, v248, v238
v_cvt_pk_bf16_f32 v170, v242, v248
v_lshlrev_b32 v242, 16, v171
v_and_b32 v248, 0xffff0000, v171
v_mul_f32 v242, v242, v238
v_mul_f32 v248, v248, v238
v_cvt_pk_bf16_f32 v171, v242, v248
v_lshlrev_b32 v242, 16, v184
v_and_b32 v248, 0xffff0000, v184
v_mul_f32 v242, v242, v238
v_mul_f32 v248, v248, v238
v_cvt_pk_bf16_f32 v184, v242, v248
v_lshlrev_b32 v242, 16, v185
v_and_b32 v248, 0xffff0000, v185
v_mul_f32 v242, v242, v238
v_mul_f32 v248, v248, v238
v_cvt_pk_bf16_f32 v185, v242, v248
v_exp_f32 v248, v156
s_nop 0
v_sub_f32 v227, v227, v248
v_exp_f32 v248, v157
s_nop 0
v_sub_f32 v227, v227, v248
v_exp_f32 v248, v158
s_nop 0
v_sub_f32 v227, v227, v248
v_exp_f32 v248, v159
s_nop 0
v_sub_f32 v227, v227, v248
v_max_f32 v227, 0, v227
v_min_f32 v227, s32, v227
v_log_f32 v248, v227
v_max3_f32 v235, v156, v157, v158
v_max3_f32 v235, v235, v159, v248
v_mov_b32 v248, v235
s_nop 1
v_permlane32_swap_b32 v235, v248
s_nop 1
v_max_f32 v235, v235, v248
v_mov_b32 v248, v235
s_nop 1
v_permlane16_swap_b32 v235, v248
s_nop 1
v_max_f32 v235, v235, v248
v_ceil_f32 v235, v235
v_max_f32 v235, 0, v235
v_sub_f32 v248, 0, v235
v_exp_f32 v239, v248
s_nop 1
v_mul_f32 v227, v227, v239
v_sub_f32 v204, v204, v235
v_sub_f32 v156, v156, v235
v_sub_f32 v140, v140, v235
v_sub_f32 v205, v205, v235
v_sub_f32 v157, v157, v235
v_sub_f32 v141, v141, v235
v_sub_f32 v206, v206, v235
v_sub_f32 v158, v158, v235
v_sub_f32 v142, v142, v235
v_sub_f32 v207, v207, v235
v_sub_f32 v159, v159, v235
v_sub_f32 v143, v143, v235
v_lshlrev_b32 v242, 16, v172
v_and_b32 v248, 0xffff0000, v172
v_mul_f32 v242, v242, v239
v_mul_f32 v248, v248, v239
v_cvt_pk_bf16_f32 v172, v242, v248
v_lshlrev_b32 v242, 16, v173
v_and_b32 v248, 0xffff0000, v173
v_mul_f32 v242, v242, v239
v_mul_f32 v248, v248, v239
v_cvt_pk_bf16_f32 v173, v242, v248
v_lshlrev_b32 v242, 16, v174
v_and_b32 v248, 0xffff0000, v174
v_mul_f32 v242, v242, v239
v_mul_f32 v248, v248, v239
v_cvt_pk_bf16_f32 v174, v242, v248
v_lshlrev_b32 v242, 16, v175
v_and_b32 v248, 0xffff0000, v175
v_mul_f32 v242, v242, v239
v_mul_f32 v248, v248, v239
v_cvt_pk_bf16_f32 v175, v242, v248
v_lshlrev_b32 v242, 16, v188
v_and_b32 v248, 0xffff0000, v188
v_mul_f32 v242, v242, v239
v_mul_f32 v248, v248, v239
v_cvt_pk_bf16_f32 v188, v242, v248
v_lshlrev_b32 v242, 16, v189
v_and_b32 v248, 0xffff0000, v189
v_mul_f32 v242, v242, v239
v_mul_f32 v248, v248, v239
v_cvt_pk_bf16_f32 v189, v242, v248
v_exp_f32 v144, v144
v_exp_f32 v145, v145
v_exp_f32 v146, v146
v_exp_f32 v147, v147
s_nop 1
v_add_f32 v224, v224, v144
v_add_f32 v224, v224, v145
v_add_f32 v224, v224, v146
v_add_f32 v224, v224, v147
v_exp_f32 v148, v148
v_exp_f32 v149, v149
v_exp_f32 v150, v150
v_exp_f32 v151, v151
s_nop 1
v_add_f32 v225, v225, v148
v_add_f32 v225, v225, v149
v_add_f32 v225, v225, v150
v_add_f32 v225, v225, v151
v_exp_f32 v152, v152
v_exp_f32 v153, v153
v_exp_f32 v154, v154
v_exp_f32 v155, v155
s_nop 1
v_add_f32 v226, v226, v152
v_add_f32 v226, v226, v153
v_add_f32 v226, v226, v154
v_add_f32 v226, v226, v155
v_exp_f32 v156, v156
v_exp_f32 v157, v157
v_exp_f32 v158, v158
v_exp_f32 v159, v159
s_nop 1
v_add_f32 v227, v227, v156
v_add_f32 v227, v227, v157
v_add_f32 v227, v227, v158
v_add_f32 v227, v227, v159
s_branch L2_rare_common
L2_rare_site2:
s_mov_b32 s36, 2
s_branch L2_rare_1_0
L2_rare_1_0:
s_nop 15
s_nop 15
s_waitcnt lgkmcnt(0)
v_add_u32 v250, 0x0, v240
v_and_b32 v250, 0x1ffff, v250
ds_read_b128 v[232:235], v250 offset:0
s_waitcnt lgkmcnt(0)
v_mfma_f32_16x16x32_bf16 v[128:131], v[232:235], v[0:3], v[192:195]
v_mfma_f32_16x16x32_bf16 v[132:135], v[232:235], v[32:35], v[196:199]
v_mfma_f32_16x16x32_bf16 v[136:139], v[232:235], v[64:67], v[200:203]
v_mfma_f32_16x16x32_bf16 v[140:143], v[232:235], v[96:99], v[204:207]
s_nop 7
ds_read_b128 v[232:235], v250 offset:512
s_waitcnt lgkmcnt(0)
v_mfma_f32_16x16x32_bf16 v[128:131], v[232:235], v[4:7], v[128:131]
v_mfma_f32_16x16x32_bf16 v[132:135], v[232:235], v[36:39], v[132:135]
v_mfma_f32_16x16x32_bf16 v[136:139], v[232:235], v[68:71], v[136:139]
v_mfma_f32_16x16x32_bf16 v[140:143], v[232:235], v[100:103], v[140:143]
s_nop 7
ds_read_b128 v[232:235], v250 offset:4096
s_waitcnt lgkmcnt(0)
v_mfma_f32_16x16x32_bf16 v[128:131], v[232:235], v[8:11], v[128:131]
v_mfma_f32_16x16x32_bf16 v[132:135], v[232:235], v[40:43], v[132:135]
v_mfma_f32_16x16x32_bf16 v[136:139], v[232:235], v[72:75], v[136:139]
v_mfma_f32_16x16x32_bf16 v[140:143], v[232:235], v[104:107], v[140:143]
s_nop 7
ds_read_b128 v[232:235], v250 offset:4608
s_waitcnt lgkmcnt(0)
v_mfma_f32_16x16x32_bf16 v[128:131], v[232:235], v[12:15], v[128:131]
v_mfma_f32_16x16x32_bf16 v[132:135], v[232:235], v[44:47], v[132:135]
v_mfma_f32_16x16x32_bf16 v[136:139], v[232:235], v[76:79], v[136:139]
v_mfma_f32_16x16x32_bf16 v[140:143], v[232:235], v[108:111], v[140:143]
s_nop 7
ds_read_b128 v[232:235], v250 offset:8192
s_waitcnt lgkmcnt(0)
v_mfma_f32_16x16x32_bf16 v[128:131], v[232:235], v[16:19], v[128:131]
v_mfma_f32_16x16x32_bf16 v[132:135], v[232:235], v[48:51], v[132:135]
v_mfma_f32_16x16x32_bf16 v[136:139], v[232:235], v[80:83], v[136:139]
v_mfma_f32_16x16x32_bf16 v[140:143], v[232:235], v[112:115], v[140:143]
s_nop 7
ds_read_b128 v[232:235], v250 offset:8704
s_waitcnt lgkmcnt(0)
v_mfma_f32_16x16x32_bf16 v[128:131], v[232:235], v[20:23], v[128:131]
v_mfma_f32_16x16x32_bf16 v[132:135], v[232:235], v[52:55], v[132:135]
v_mfma_f32_16x16x32_bf16 v[136:139], v[232:235], v[84:87], v[136:139]
v_mfma_f32_16x16x32_bf16 v[140:143], v[232:235], v[116:119], v[140:143]
s_nop 7
ds_read_b128 v[232:235], v250 offset:12288
s_waitcnt lgkmcnt(0)
v_mfma_f32_16x16x32_bf16 v[128:131], v[232:235], v[24:27], v[128:131]
v_mfma_f32_16x16x32_bf16 v[132:135], v[232:235], v[56:59], v[132:135]
v_mfma_f32_16x16x32_bf16 v[136:139], v[232:235], v[88:91], v[136:139]
v_mfma_f32_16x16x32_bf16 v[140:143], v[232:235], v[120:123], v[140:143]
s_nop 7
ds_read_b128 v[232:235], v250 offset:12800
s_waitcnt lgkmcnt(0)
v_mfma_f32_16x16x32_bf16 v[128:131], v[232:235], v[28:31], v[128:131]
v_mfma_f32_16x16x32_bf16 v[132:135], v[232:235], v[60:63], v[132:135]
v_mfma_f32_16x16x32_bf16 v[136:139], v[232:235], v[92:95], v[136:139]
v_mfma_f32_16x16x32_bf16 v[140:143], v[232:235], v[124:127], v[140:143]
s_nop 7
s_nop 7
v_exp_f32 v248, v128
s_nop 0
v_sub_f32 v224, v224, v248
v_exp_f32 v248, v129
s_nop 0
v_sub_f32 v224, v224, v248
v_exp_f32 v248, v130
s_nop 0
v_sub_f32 v224, v224, v248
v_exp_f32 v248, v131
s_nop 0
v_sub_f32 v224, v224, v248
v_max_f32 v224, 0, v224
v_min_f32 v224, s32, v224
v_log_f32 v248, v224
v_max3_f32 v232, v128, v129, v130
v_max3_f32 v232, v232, v131, v248
v_mov_b32 v248, v232
s_nop 1
v_permlane32_swap_b32 v232, v248
s_nop 1
v_max_f32 v232, v232, v248
v_mov_b32 v248, v232
s_nop 1
v_permlane16_swap_b32 v232, v248
s_nop 1
v_max_f32 v232, v232, v248
v_ceil_f32 v232, v232
v_max_f32 v232, 0, v232
v_sub_f32 v248, 0, v232
v_exp_f32 v236, v248
s_nop 1
v_mul_f32 v224, v224, v236
v_sub_f32 v192, v192, v232
v_sub_f32 v128, v128, v232
v_sub_f32 v144, v144, v232
v_sub_f32 v193, v193, v232
v_sub_f32 v129, v129, v232
v_sub_f32 v145, v145, v232
v_sub_f32 v194, v194, v232
v_sub_f32 v130, v130, v232
v_sub_f32 v146, v146, v232
v_sub_f32 v195, v195, v232
v_sub_f32 v131, v131, v232
v_sub_f32 v147, v147, v232
v_lshlrev_b32 v242, 16, v176
v_and_b32 v248, 0xffff0000, v176
v_mul_f32 v242, v242, v236
v_mul_f32 v248, v248, v236
v_cvt_pk_bf16_f32 v176, v242, v248
v_lshlrev_b32 v242, 16, v177
v_and_b32 v248, 0xffff0000, v177
v_mul_f32 v242, v242, v236
v_mul_f32 v248, v248, v236
v_cvt_pk_bf16_f32 v177, v242, v248
v_lshlrev_b32 v242, 16, v178
v_and_b32 v248, 0xffff0000, v178
v_mul_f32 v242, v242, v236
v_mul_f32 v248, v248, v236
v_cvt_pk_bf16_f32 v178, v242, v248
v_lshlrev_b32 v242, 16, v179
v_and_b32 v248, 0xffff0000, v179
v_mul_f32 v242, v242, v236
v_mul_f32 v248, v248, v236
v_cvt_pk_bf16_f32 v179, v242, v248
v_lshlrev_b32 v242, 16, v160
v_and_b32 v248, 0xffff0000, v160
v_mul_f32 v242, v242, v236
v_mul_f32 v248, v248, v236
v_cvt_pk_bf16_f32 v160, v242, v248
v_lshlrev_b32 v242, 16, v161
v_and_b32 v248, 0xffff0000, v161
v_mul_f32 v242, v242, v236
v_mul_f32 v248, v248, v236
v_cvt_pk_bf16_f32 v161, v242, v248
v_lshlrev_b32 v242, 16, v162
v_and_b32 v248, 0xffff0000, v162
v_mul_f32 v242, v242, v236
v_mul_f32 v248, v248, v236
v_cvt_pk_bf16_f32 v162, v242, v248
v_lshlrev_b32 v242, 16, v163
v_and_b32 v248, 0xffff0000, v163
v_mul_f32 v242, v242, v236
v_mul_f32 v248, v248, v236
v_cvt_pk_bf16_f32 v163, v242, v248
v_exp_f32 v248, v132
s_nop 0
v_sub_f32 v225, v225, v248
v_exp_f32 v248, v133
s_nop 0
v_sub_f32 v225, v225, v248
v_exp_f32 v248, v134
s_nop 0
v_sub_f32 v225, v225, v248
v_exp_f32 v248, v135
s_nop 0
v_sub_f32 v225, v225, v248
v_max_f32 v225, 0, v225
v_min_f32 v225, s32, v225
v_log_f32 v248, v225
v_max3_f32 v233, v132, v133, v134
v_max3_f32 v233, v233, v135, v248
v_mov_b32 v248, v233
s_nop 1
v_permlane32_swap_b32 v233, v248
s_nop 1
v_max_f32 v233, v233, v248
v_mov_b32 v248, v233
s_nop 1
v_permlane16_swap_b32 v233, v248
s_nop 1
v_max_f32 v233, v233, v248
v_ceil_f32 v233, v233
v_max_f32 v233, 0, v233
v_sub_f32 v248, 0, v233
v_exp_f32 v237, v248
s_nop 1
v_mul_f32 v225, v225, v237
v_sub_f32 v196, v196, v233
v_sub_f32 v132, v132, v233
v_sub_f32 v148, v148, v233
v_sub_f32 v197, v197, v233
v_sub_f32 v133, v133, v233
v_sub_f32 v149, v149, v233
v_sub_f32 v198, v198, v233
v_sub_f32 v134, v134, v233
v_sub_f32 v150, v150, v233
v_sub_f32 v199, v199, v233
v_sub_f32 v135, v135, v233
v_sub_f32 v151, v151, v233
v_lshlrev_b32 v242, 16, v180
v_and_b32 v248, 0xffff0000, v180
v_mul_f32 v242, v242, v237
v_mul_f32 v248, v248, v237
v_cvt_pk_bf16_f32 v180, v242, v248
v_lshlrev_b32 v242, 16, v181
v_and_b32 v248, 0xffff0000, v181
v_mul_f32 v242, v242, v237
v_mul_f32 v248, v248, v237
v_cvt_pk_bf16_f32 v181, v242, v248
v_lshlrev_b32 v242, 16, v182
v_and_b32 v248, 0xffff0000, v182
v_mul_f32 v242, v242, v237
v_mul_f32 v248, v248, v237
v_cvt_pk_bf16_f32 v182, v242, v248
v_lshlrev_b32 v242, 16, v183
v_and_b32 v248, 0xffff0000, v183
v_mul_f32 v242, v242, v237
v_mul_f32 v248, v248, v237
v_cvt_pk_bf16_f32 v183, v242, v248
v_lshlrev_b32 v242, 16, v164
v_and_b32 v248, 0xffff0000, v164
v_mul_f32 v242, v242, v237
v_mul_f32 v248, v248, v237
v_cvt_pk_bf16_f32 v164, v242, v248
v_lshlrev_b32 v242, 16, v165
v_and_b32 v248, 0xffff0000, v165
v_mul_f32 v242, v242, v237
v_mul_f32 v248, v248, v237
v_cvt_pk_bf16_f32 v165, v242, v248
v_lshlrev_b32 v242, 16, v166
v_and_b32 v248, 0xffff0000, v166
v_mul_f32 v242, v242, v237
v_mul_f32 v248, v248, v237
v_cvt_pk_bf16_f32 v166, v242, v248
v_lshlrev_b32 v242, 16, v167
v_and_b32 v248, 0xffff0000, v167
v_mul_f32 v242, v242, v237
v_mul_f32 v248, v248, v237
v_cvt_pk_bf16_f32 v167, v242, v248
v_exp_f32 v248, v136
s_nop 0
v_sub_f32 v226, v226, v248
v_exp_f32 v248, v137
s_nop 0
v_sub_f32 v226, v226, v248
v_exp_f32 v248, v138
s_nop 0
v_sub_f32 v226, v226, v248
v_exp_f32 v248, v139
s_nop 0
v_sub_f32 v226, v226, v248
v_max_f32 v226, 0, v226
v_min_f32 v226, s32, v226
v_log_f32 v248, v226
v_max3_f32 v234, v136, v137, v138
v_max3_f32 v234, v234, v139, v248
v_mov_b32 v248, v234
s_nop 1
v_permlane32_swap_b32 v234, v248
s_nop 1
v_max_f32 v234, v234, v248
v_mov_b32 v248, v234
s_nop 1
v_permlane16_swap_b32 v234, v248
s_nop 1
v_max_f32 v234, v234, v248
v_ceil_f32 v234, v234
v_max_f32 v234, 0, v234
v_sub_f32 v248, 0, v234
v_exp_f32 v238, v248
s_nop 1
v_mul_f32 v226, v226, v238
v_sub_f32 v200, v200, v234
v_sub_f32 v136, v136, v234
v_sub_f32 v152, v152, v234
v_sub_f32 v201, v201, v234
v_sub_f32 v137, v137, v234
v_sub_f32 v153, v153, v234
v_sub_f32 v202, v202, v234
v_sub_f32 v138, v138, v234
v_sub_f32 v154, v154, v234
v_sub_f32 v203, v203, v234
v_sub_f32 v139, v139, v234
v_sub_f32 v155, v155, v234
v_lshlrev_b32 v242, 16, v184
v_and_b32 v248, 0xffff0000, v184
v_mul_f32 v242, v242, v238
v_mul_f32 v248, v248, v238
v_cvt_pk_bf16_f32 v184, v242, v248
v_lshlrev_b32 v242, 16, v185
v_and_b32 v248, 0xffff0000, v185
v_mul_f32 v242, v242, v238
v_mul_f32 v248, v248, v238
v_cvt_pk_bf16_f32 v185, v242, v248
v_lshlrev_b32 v242, 16, v186
v_and_b32 v248, 0xffff0000, v186
v_mul_f32 v242, v242, v238
v_mul_f32 v248, v248, v238
v_cvt_pk_bf16_f32 v186, v242, v248
v_lshlrev_b32 v242, 16, v187
v_and_b32 v248, 0xffff0000, v187
v_mul_f32 v242, v242, v238
v_mul_f32 v248, v248, v238
v_cvt_pk_bf16_f32 v187, v242, v248
v_lshlrev_b32 v242, 16, v168
v_and_b32 v248, 0xffff0000, v168
v_mul_f32 v242, v242, v238
v_mul_f32 v248, v248, v238
v_cvt_pk_bf16_f32 v168, v242, v248
v_lshlrev_b32 v242, 16, v169
v_and_b32 v248, 0xffff0000, v169
v_mul_f32 v242, v242, v238
v_mul_f32 v248, v248, v238
v_cvt_pk_bf16_f32 v169, v242, v248
v_lshlrev_b32 v242, 16, v170
v_and_b32 v248, 0xffff0000, v170
v_mul_f32 v242, v242, v238
v_mul_f32 v248, v248, v238
v_cvt_pk_bf16_f32 v170, v242, v248
v_lshlrev_b32 v242, 16, v171
v_and_b32 v248, 0xffff0000, v171
v_mul_f32 v242, v242, v238
v_mul_f32 v248, v248, v238
v_cvt_pk_bf16_f32 v171, v242, v248
v_exp_f32 v248, v140
s_nop 0
v_sub_f32 v227, v227, v248
v_exp_f32 v248, v141
s_nop 0
v_sub_f32 v227, v227, v248
v_exp_f32 v248, v142
s_nop 0
v_sub_f32 v227, v227, v248
v_exp_f32 v248, v143
s_nop 0
v_sub_f32 v227, v227, v248
v_max_f32 v227, 0, v227
v_min_f32 v227, s32, v227
v_log_f32 v248, v227
v_max3_f32 v235, v140, v141, v142
v_max3_f32 v235, v235, v143, v248
v_mov_b32 v248, v235
s_nop 1
v_permlane32_swap_b32 v235, v248
s_nop 1
v_max_f32 v235, v235, v248
v_mov_b32 v248, v235
s_nop 1
v_permlane16_swap_b32 v235, v248
s_nop 1
v_max_f32 v235, v235, v248
v_ceil_f32 v235, v235
v_max_f32 v235, 0, v235
v_sub_f32 v248, 0, v235
v_exp_f32 v239, v248
s_nop 1
v_mul_f32 v227, v227, v239
v_sub_f32 v204, v204, v235
v_sub_f32 v140, v140, v235
v_sub_f32 v156, v156, v235
v_sub_f32 v205, v205, v235
v_sub_f32 v141, v141, v235
v_sub_f32 v157, v157, v235
v_sub_f32 v206, v206, v235
v_sub_f32 v142, v142, v235
v_sub_f32 v158, v158, v235
v_sub_f32 v207, v207, v235
v_sub_f32 v143, v143, v235
v_sub_f32 v159, v159, v235
v_lshlrev_b32 v242, 16, v188
v_and_b32 v248, 0xffff0000, v188
v_mul_f32 v242, v242, v239
v_mul_f32 v248, v248, v239
v_cvt_pk_bf16_f32 v188, v242, v248
v_lshlrev_b32 v242, 16, v189
v_and_b32 v248, 0xffff0000, v189
v_mul_f32 v242, v242, v239
v_mul_f32 v248, v248, v239
v_cvt_pk_bf16_f32 v189, v242, v248
v_lshlrev_b32 v242, 16, v190
v_and_b32 v248, 0xffff0000, v190
v_mul_f32 v242, v242, v239
v_mul_f32 v248, v248, v239
v_cvt_pk_bf16_f32 v190, v242, v248
v_lshlrev_b32 v242, 16, v191
v_and_b32 v248, 0xffff0000, v191
v_mul_f32 v242, v242, v239
v_mul_f32 v248, v248, v239
v_cvt_pk_bf16_f32 v191, v242, v248
v_lshlrev_b32 v242, 16, v172
v_and_b32 v248, 0xffff0000, v172
v_mul_f32 v242, v242, v239
v_mul_f32 v248, v248, v239
v_cvt_pk_bf16_f32 v172, v242, v248
v_lshlrev_b32 v242, 16, v173
v_and_b32 v248, 0xffff0000, v173
v_mul_f32 v242, v242, v239
v_mul_f32 v248, v248, v239
v_cvt_pk_bf16_f32 v173, v242, v248
v_lshlrev_b32 v242, 16, v174
v_and_b32 v248, 0xffff0000, v174
v_mul_f32 v242, v242, v239
v_mul_f32 v248, v248, v239
v_cvt_pk_bf16_f32 v174, v242, v248
v_lshlrev_b32 v242, 16, v175
v_and_b32 v248, 0xffff0000, v175
v_mul_f32 v242, v242, v239
v_mul_f32 v248, v248, v239
v_cvt_pk_bf16_f32 v175, v242, v248
v_exp_f32 v128, v128
v_exp_f32 v129, v129
v_exp_f32 v130, v130
v_exp_f32 v131, v131
s_nop 1
v_add_f32 v224, v224, v128
v_add_f32 v224, v224, v129
v_add_f32 v224, v224, v130
v_add_f32 v224, v224, v131
v_exp_f32 v132, v132
v_exp_f32 v133, v133
v_exp_f32 v134, v134
v_exp_f32 v135, v135
s_nop 1
v_add_f32 v225, v225, v132
v_add_f32 v225, v225, v133
v_add_f32 v225, v225, v134
v_add_f32 v225, v225, v135
v_exp_f32 v136, v136
v_exp_f32 v137, v137
v_exp_f32 v138, v138
v_exp_f32 v139, v139
s_nop 1
v_add_f32 v226, v226, v136
v_add_f32 v226, v226, v137
v_add_f32 v226, v226, v138
v_add_f32 v226, v226, v139
v_exp_f32 v140, v140
v_exp_f32 v141, v141
v_exp_f32 v142, v142
v_exp_f32 v143, v143
s_nop 1
v_add_f32 v227, v227, v140
v_add_f32 v227, v227, v141
v_add_f32 v227, v227, v142
v_add_f32 v227, v227, v143
s_branch L2_rare_common
L2_rare_site3:
s_mov_b32 s36, 3
s_branch L2_rare_1_1
L2_rare_1_1:
s_nop 15
s_nop 15
s_waitcnt lgkmcnt(0)
v_add_u32 v250, 0x0, v240
v_and_b32 v250, 0x1ffff, v250
ds_read_b128 v[232:235], v250 offset:2048
s_waitcnt lgkmcnt(0)
v_mfma_f32_16x16x32_bf16 v[144:147], v[232:235], v[0:3], v[192:195]
v_mfma_f32_16x16x32_bf16 v[148:151], v[232:235], v[32:35], v[196:199]
v_mfma_f32_16x16x32_bf16 v[152:155], v[232:235], v[64:67], v[200:203]
v_mfma_f32_16x16x32_bf16 v[156:159], v[232:235], v[96:99], v[204:207]
s_nop 7
ds_read_b128 v[232:235], v250 offset:2560
s_waitcnt lgkmcnt(0)
v_mfma_f32_16x16x32_bf16 v[144:147], v[232:235], v[4:7], v[144:147]
v_mfma_f32_16x16x32_bf16 v[148:151], v[232:235], v[36:39], v[148:151]
v_mfma_f32_16x16x32_bf16 v[152:155], v[232:235], v[68:71], v[152:155]
v_mfma_f32_16x16x32_bf16 v[156:159], v[232:235], v[100:103], v[156:159]
s_nop 7
ds_read_b128 v[232:235], v250 offset:6144
s_waitcnt lgkmcnt(0)
v_mfma_f32_16x16x32_bf16 v[144:147], v[232:235], v[8:11], v[144:147]
v_mfma_f32_16x16x32_bf16 v[148:151], v[232:235], v[40:43], v[148:151]
v_mfma_f32_16x16x32_bf16 v[152:155], v[232:235], v[72:75], v[152:155]
v_mfma_f32_16x16x32_bf16 v[156:159], v[232:235], v[104:107], v[156:159]
s_nop 7
ds_read_b128 v[232:235], v250 offset:6656
s_waitcnt lgkmcnt(0)
v_mfma_f32_16x16x32_bf16 v[144:147], v[232:235], v[12:15], v[144:147]
v_mfma_f32_16x16x32_bf16 v[148:151], v[232:235], v[44:47], v[148:151]
v_mfma_f32_16x16x32_bf16 v[152:155], v[232:235], v[76:79], v[152:155]
v_mfma_f32_16x16x32_bf16 v[156:159], v[232:235], v[108:111], v[156:159]
s_nop 7
ds_read_b128 v[232:235], v250 offset:10240
s_waitcnt lgkmcnt(0)
v_mfma_f32_16x16x32_bf16 v[144:147], v[232:235], v[16:19], v[144:147]
v_mfma_f32_16x16x32_bf16 v[148:151], v[232:235], v[48:51], v[148:151]
v_mfma_f32_16x16x32_bf16 v[152:155], v[232:235], v[80:83], v[152:155]
v_mfma_f32_16x16x32_bf16 v[156:159], v[232:235], v[112:115], v[156:159]
s_nop 7
ds_read_b128 v[232:235], v250 offset:10752
s_waitcnt lgkmcnt(0)
v_mfma_f32_16x16x32_bf16 v[144:147], v[232:235], v[20:23], v[144:147]
v_mfma_f32_16x16x32_bf16 v[148:151], v[232:235], v[52:55], v[148:151]
v_mfma_f32_16x16x32_bf16 v[152:155], v[232:235], v[84:87], v[152:155]
v_mfma_f32_16x16x32_bf16 v[156:159], v[232:235], v[116:119], v[156:159]
s_nop 7
ds_read_b128 v[232:235], v250 offset:14336
s_waitcnt lgkmcnt(0)
v_mfma_f32_16x16x32_bf16 v[144:147], v[232:235], v[24:27], v[144:147]
v_mfma_f32_16x16x32_bf16 v[148:151], v[232:235], v[56:59], v[148:151]
v_mfma_f32_16x16x32_bf16 v[152:155], v[232:235], v[88:91], v[152:155]
v_mfma_f32_16x16x32_bf16 v[156:159], v[232:235], v[120:123], v[156:159]
s_nop 7
ds_read_b128 v[232:235], v250 offset:14848
s_waitcnt lgkmcnt(0)
v_mfma_f32_16x16x32_bf16 v[144:147], v[232:235], v[28:31], v[144:147]
v_mfma_f32_16x16x32_bf16 v[148:151], v[232:235], v[60:63], v[148:151]
v_mfma_f32_16x16x32_bf16 v[152:155], v[232:235], v[92:95], v[152:155]
v_mfma_f32_16x16x32_bf16 v[156:159], v[232:235], v[124:127], v[156:159]
s_nop 7
s_nop 7
v_exp_f32 v248, v144
s_nop 0
v_sub_f32 v224, v224, v248
v_exp_f32 v248, v145
s_nop 0
v_sub_f32 v224, v224, v248
v_exp_f32 v248, v146
s_nop 0
v_sub_f32 v224, v224, v248
v_exp_f32 v248, v147
s_nop 0
v_sub_f32 v224, v224, v248
v_max_f32 v224, 0, v224
v_min_f32 v224, s32, v224
v_log_f32 v248, v224
v_max3_f32 v232, v144, v145, v146
v_max3_f32 v232, v232, v147, v248
v_mov_b32 v248, v232
s_nop 1
v_permlane32_swap_b32 v232, v248
s_nop 1
v_max_f32 v232, v232, v248
v_mov_b32 v248, v232
s_nop 1
v_permlane16_swap_b32 v232, v248
s_nop 1
v_max_f32 v232, v232, v248
v_ceil_f32 v232, v232
v_max_f32 v232, 0, v232
v_sub_f32 v248, 0, v232
v_exp_f32 v236, v248
s_nop 1
v_mul_f32 v224, v224, v236
v_sub_f32 v192, v192, v232
v_sub_f32 v144, v144, v232
v_sub_f32 v128, v128, v232
v_sub_f32 v193, v193, v232
v_sub_f32 v145, v145, v232
v_sub_f32 v129, v129, v232
v_sub_f32 v194, v194, v232
v_sub_f32 v146, v146, v232
v_sub_f32 v130, v130, v232
v_sub_f32 v195, v195, v232
v_sub_f32 v147, v147, v232
v_sub_f32 v131, v131, v232
v_lshlrev_b32 v242, 16, v176
v_and_b32 v248, 0xffff0000, v176
v_mul_f32 v242, v242, v236
v_mul_f32 v248, v248, v236
v_cvt_pk_bf16_f32 v176, v242, v248
v_lshlrev_b32 v242, 16, v177
v_and_b32 v248, 0xffff0000, v177
v_mul_f32 v242, v242, v236
v_mul_f32 v248, v248, v236
v_cvt_pk_bf16_f32 v177, v242, v248
v_lshlrev_b32 v242, 16, v178
v_and_b32 v248, 0xffff0000, v178
v_mul_f32 v242, v242, v236
v_mul_f32 v248, v248, v236
v_cvt_pk_bf16_f32 v178, v242, v248
v_lshlrev_b32 v242, 16, v179
v_and_b32 v248, 0xffff0000, v179
v_mul_f32 v242, v242, v236
v_mul_f32 v248, v248, v236
v_cvt_pk_bf16_f32 v179, v242, v248
v_lshlrev_b32 v242, 16, v160
v_and_b32 v248, 0xffff0000, v160
v_mul_f32 v242, v242, v236
v_mul_f32 v248, v248, v236
v_cvt_pk_bf16_f32 v160, v242, v248
v_lshlrev_b32 v242, 16, v161
v_and_b32 v248, 0xffff0000, v161
v_mul_f32 v242, v242, v236
v_mul_f32 v248, v248, v236
v_cvt_pk_bf16_f32 v161, v242, v248
v_exp_f32 v248, v148
s_nop 0
v_sub_f32 v225, v225, v248
v_exp_f32 v248, v149
s_nop 0
v_sub_f32 v225, v225, v248
v_exp_f32 v248, v150
s_nop 0
v_sub_f32 v225, v225, v248
v_exp_f32 v248, v151
s_nop 0
v_sub_f32 v225, v225, v248
v_max_f32 v225, 0, v225
v_min_f32 v225, s32, v225
v_log_f32 v248, v225
v_max3_f32 v233, v148, v149, v150
v_max3_f32 v233, v233, v151, v248
v_mov_b32 v248, v233
s_nop 1
v_permlane32_swap_b32 v233, v248
s_nop 1
v_max_f32 v233, v233, v248
v_mov_b32 v248, v233
s_nop 1
v_permlane16_swap_b32 v233, v248
s_nop 1
v_max_f32 v233, v233, v248
v_ceil_f32 v233, v233
v_max_f32 v233, 0, v233
v_sub_f32 v248, 0, v233
v_exp_f32 v237, v248
s_nop 1
v_mul_f32 v225, v225, v237
v_sub_f32 v196, v196, v233
v_sub_f32 v148, v148, v233
v_sub_f32 v132, v132, v233
v_sub_f32 v197, v197, v233
v_sub_f32 v149, v149, v233
v_sub_f32 v133, v133, v233
v_sub_f32 v198, v198, v233
v_sub_f32 v150, v150, v233
v_sub_f32 v134, v134, v233
v_sub_f32 v199, v199, v233
v_sub_f32 v151, v151, v233
v_sub_f32 v135, v135, v233
v_lshlrev_b32 v242, 16, v180
v_and_b32 v248, 0xffff0000, v180
v_mul_f32 v242, v242, v237
v_mul_f32 v248, v248, v237
v_cvt_pk_bf16_f32 v180, v242, v248
v_lshlrev_b32 v242, 16, v181
v_and_b32 v248, 0xffff0000, v181
v_mul_f32 v242, v242, v237
v_mul_f32 v248, v248, v237
v_cvt_pk_bf16_f32 v181, v242, v248
v_lshlrev_b32 v242, 16, v182
v_and_b32 v248, 0xffff0000, v182
v_mul_f32 v242, v242, v237
v_mul_f32 v248, v248, v237
v_cvt_pk_bf16_f32 v182, v242, v248
v_lshlrev_b32 v242, 16, v183
v_and_b32 v248, 0xffff0000, v183
v_mul_f32 v242, v242, v237
v_mul_f32 v248, v248, v237
v_cvt_pk_bf16_f32 v183, v242, v248
v_lshlrev_b32 v242, 16, v164
v_and_b32 v248, 0xffff0000, v164
v_mul_f32 v242, v242, v237
v_mul_f32 v248, v248, v237
v_cvt_pk_bf16_f32 v164, v242, v248
v_lshlrev_b32 v242, 16, v165
v_and_b32 v248, 0xffff0000, v165
v_mul_f32 v242, v242, v237
v_mul_f32 v248, v248, v237
v_cvt_pk_bf16_f32 v165, v242, v248
v_exp_f32 v248, v152
s_nop 0
v_sub_f32 v226, v226, v248
v_exp_f32 v248, v153
s_nop 0
v_sub_f32 v226, v226, v248
v_exp_f32 v248, v154
s_nop 0
v_sub_f32 v226, v226, v248
v_exp_f32 v248, v155
s_nop 0
v_sub_f32 v226, v226, v248
v_max_f32 v226, 0, v226
v_min_f32 v226, s32, v226
v_log_f32 v248, v226
v_max3_f32 v234, v152, v153, v154
v_max3_f32 v234, v234, v155, v248
v_mov_b32 v248, v234
s_nop 1
v_permlane32_swap_b32 v234, v248
s_nop 1
v_max_f32 v234, v234, v248
v_mov_b32 v248, v234
s_nop 1
v_permlane16_swap_b32 v234, v248
s_nop 1
v_max_f32 v234, v234, v248
v_ceil_f32 v234, v234
v_max_f32 v234, 0, v234
v_sub_f32 v248, 0, v234
v_exp_f32 v238, v248
s_nop 1
v_mul_f32 v226, v226, v238
v_sub_f32 v200, v200, v234
v_sub_f32 v152, v152, v234
v_sub_f32 v136, v136, v234
v_sub_f32 v201, v201, v234
v_sub_f32 v153, v153, v234
v_sub_f32 v137, v137, v234
v_sub_f32 v202, v202, v234
v_sub_f32 v154, v154, v234
v_sub_f32 v138, v138, v234
v_sub_f32 v203, v203, v234
v_sub_f32 v155, v155, v234
v_sub_f32 v139, v139, v234
v_lshlrev_b32 v242, 16, v184
v_and_b32 v248, 0xffff0000, v184
v_mul_f32 v242, v242, v238
v_mul_f32 v248, v248, v238
v_cvt_pk_bf16_f32 v184, v242, v248
v_lshlrev_b32 v242, 16, v185
v_and_b32 v248, 0xffff0000, v185
v_mul_f32 v242, v242, v238
v_mul_f32 v248, v248, v238
v_cvt_pk_bf16_f32 v185, v242, v248
v_lshlrev_b32 v242, 16, v186
v_and_b32 v248, 0xffff0000, v186
v_mul_f32 v242, v242, v238
v_mul_f32 v248, v248, v238
v_cvt_pk_bf16_f32 v186, v242, v248
v_lshlrev_b32 v242, 16, v187
v_and_b32 v248, 0xffff0000, v187
v_mul_f32 v242, v242, v238
v_mul_f32 v248, v248, v238
v_cvt_pk_bf16_f32 v187, v242, v248
v_lshlrev_b32 v242, 16, v168
v_and_b32 v248, 0xffff0000, v168
v_mul_f32 v242, v242, v238
v_mul_f32 v248, v248, v238
v_cvt_pk_bf16_f32 v168, v242, v248
v_lshlrev_b32 v242, 16, v169
v_and_b32 v248, 0xffff0000, v169
v_mul_f32 v242, v242, v238
v_mul_f32 v248, v248, v238
v_cvt_pk_bf16_f32 v169, v242, v248
v_exp_f32 v248, v156
s_nop 0
v_sub_f32 v227, v227, v248
v_exp_f32 v248, v157
s_nop 0
v_sub_f32 v227, v227, v248
v_exp_f32 v248, v158
s_nop 0
v_sub_f32 v227, v227, v248
v_exp_f32 v248, v159
s_nop 0
v_sub_f32 v227, v227, v248
v_max_f32 v227, 0, v227
v_min_f32 v227, s32, v227
v_log_f32 v248, v227
v_max3_f32 v235, v156, v157, v158
v_max3_f32 v235, v235, v159, v248
v_mov_b32 v248, v235
s_nop 1
v_permlane32_swap_b32 v235, v248
s_nop 1
v_max_f32 v235, v235, v248
v_mov_b32 v248, v235
s_nop 1
v_permlane16_swap_b32 v235, v248
s_nop 1
v_max_f32 v235, v235, v248
v_ceil_f32 v235, v235
v_max_f32 v235, 0, v235
v_sub_f32 v248, 0, v235
v_exp_f32 v239, v248
s_nop 1
v_mul_f32 v227, v227, v239
v_sub_f32 v204, v204, v235
v_sub_f32 v156, v156, v235
v_sub_f32 v140, v140, v235
v_sub_f32 v205, v205, v235
v_sub_f32 v157, v157, v235
v_sub_f32 v141, v141, v235
v_sub_f32 v206, v206, v235
v_sub_f32 v158, v158, v235
v_sub_f32 v142, v142, v235
v_sub_f32 v207, v207, v235
v_sub_f32 v159, v159, v235
v_sub_f32 v143, v143, v235
v_lshlrev_b32 v242, 16, v188
v_and_b32 v248, 0xffff0000, v188
v_mul_f32 v242, v242, v239
v_mul_f32 v248, v248, v239
v_cvt_pk_bf16_f32 v188, v242, v248
v_lshlrev_b32 v242, 16, v189
v_and_b32 v248, 0xffff0000, v189
v_mul_f32 v242, v242, v239
v_mul_f32 v248, v248, v239
v_cvt_pk_bf16_f32 v189, v242, v248
v_lshlrev_b32 v242, 16, v190
v_and_b32 v248, 0xffff0000, v190
v_mul_f32 v242, v242, v239
v_mul_f32 v248, v248, v239
v_cvt_pk_bf16_f32 v190, v242, v248
v_lshlrev_b32 v242, 16, v191
v_and_b32 v248, 0xffff0000, v191
v_mul_f32 v242, v242, v239
v_mul_f32 v248, v248, v239
v_cvt_pk_bf16_f32 v191, v242, v248
v_lshlrev_b32 v242, 16, v172
v_and_b32 v248, 0xffff0000, v172
v_mul_f32 v242, v242, v239
v_mul_f32 v248, v248, v239
v_cvt_pk_bf16_f32 v172, v242, v248
v_lshlrev_b32 v242, 16, v173
v_and_b32 v248, 0xffff0000, v173
v_mul_f32 v242, v242, v239
v_mul_f32 v248, v248, v239
v_cvt_pk_bf16_f32 v173, v242, v248
v_exp_f32 v144, v144
v_exp_f32 v145, v145
v_exp_f32 v146, v146
v_exp_f32 v147, v147
s_nop 1
v_add_f32 v224, v224, v144
v_add_f32 v224, v224, v145
v_add_f32 v224, v224, v146
v_add_f32 v224, v224, v147
v_exp_f32 v148, v148
v_exp_f32 v149, v149
v_exp_f32 v150, v150
v_exp_f32 v151, v151
s_nop 1
v_add_f32 v225, v225, v148
v_add_f32 v225, v225, v149
v_add_f32 v225, v225, v150
v_add_f32 v225, v225, v151
v_exp_f32 v152, v152
v_exp_f32 v153, v153
v_exp_f32 v154, v154
v_exp_f32 v155, v155
s_nop 1
v_add_f32 v226, v226, v152
v_add_f32 v226, v226, v153
v_add_f32 v226, v226, v154
v_add_f32 v226, v226, v155
v_exp_f32 v156, v156
v_exp_f32 v157, v157
v_exp_f32 v158, v158
v_exp_f32 v159, v159
s_nop 1
v_add_f32 v227, v227, v156
v_add_f32 v227, v227, v157
v_add_f32 v227, v227, v158
v_add_f32 v227, v227, v159
s_branch L2_rare_common
L2_rare_site6:
s_mov_b32 s36, 6
s_branch L2_rare_t1_0_0
L2_rare_t1_0_0:
s_nop 15
s_nop 15
s_waitcnt lgkmcnt(0)
v_exp_f32 v248, v128
s_nop 0
v_sub_f32 v224, v224, v248
v_exp_f32 v248, v129
s_nop 0
v_sub_f32 v224, v224, v248
v_exp_f32 v248, v130
s_nop 0
v_sub_f32 v224, v224, v248
v_exp_f32 v248, v131
s_nop 0
v_sub_f32 v224, v224, v248
v_max_f32 v224, 0, v224
v_min_f32 v224, s32, v224
v_log_f32 v248, v224
v_max3_f32 v232, v128, v129, v130
v_max3_f32 v232, v232, v131, v248
v_mov_b32 v248, v232
s_nop 1
v_permlane32_swap_b32 v232, v248
s_nop 1
v_max_f32 v232, v232, v248
v_mov_b32 v248, v232
s_nop 1
v_permlane16_swap_b32 v232, v248
s_nop 1
v_max_f32 v232, v232, v248
v_ceil_f32 v232, v232
v_max_f32 v232, 0, v232
v_sub_f32 v248, 0, v232
v_exp_f32 v236, v248
s_nop 1
v_mul_f32 v224, v224, v236
v_sub_f32 v192, v192, v232
v_sub_f32 v128, v128, v232
v_sub_f32 v144, v144, v232
v_sub_f32 v193, v193, v232
v_sub_f32 v129, v129, v232
v_sub_f32 v145, v145, v232
v_sub_f32 v194, v194, v232
v_sub_f32 v130, v130, v232
v_sub_f32 v146, v146, v232
v_sub_f32 v195, v195, v232
v_sub_f32 v131, v131, v232
v_sub_f32 v147, v147, v232
v_lshlrev_b32 v242, 16, v160
v_and_b32 v248, 0xffff0000, v160
v_mul_f32 v242, v242, v236
v_mul_f32 v248, v248, v236
v_cvt_pk_bf16_f32 v160, v242, v248
v_lshlrev_b32 v242, 16, v161
v_and_b32 v248, 0xffff0000, v161
v_mul_f32 v242, v242, v236
v_mul_f32 v248, v248, v236
v_cvt_pk_bf16_f32 v161, v242, v248
v_lshlrev_b32 v242, 16, v162
v_and_b32 v248, 0xffff0000, v162
v_mul_f32 v242, v242, v236
v_mul_f32 v248, v248, v236
v_cvt_pk_bf16_f32 v162, v242, v248
v_lshlrev_b32 v242, 16, v163
v_and_b32 v248, 0xffff0000, v163
v_mul_f32 v242, v242, v236
v_mul_f32 v248, v248, v236
v_cvt_pk_bf16_f32 v163, v242, v248
ds_read_b64 v[250:251], v231 offset:0
s_waitcnt lgkmcnt(0)
v_lshlrev_b32 v242, 16, v250
v_and_b32 v248, 0xffff0000, v250
v_mul_f32 v242, v242, v236
v_mul_f32 v248, v248, v236
v_cvt_pk_bf16_f32 v250, v242, v248
v_lshlrev_b32 v242, 16, v251
v_and_b32 v248, 0xffff0000, v251
v_mul_f32 v242, v242, v236
v_mul_f32 v248, v248, v236
v_cvt_pk_bf16_f32 v251, v242, v248
ds_write_b64 v231, v[250:251] offset:0
s_waitcnt lgkmcnt(0)
ds_read_b64 v[250:251], v231 offset:8
s_waitcnt lgkmcnt(0)
v_lshlrev_b32 v242, 16, v250
v_and_b32 v248, 0xffff0000, v250
v_mul_f32 v242, v242, v236
v_mul_f32 v248, v248, v236
v_cvt_pk_bf16_f32 v250, v242, v248
v_lshlrev_b32 v242, 16, v251
v_and_b32 v248, 0xffff0000, v251
v_mul_f32 v242, v242, v236
v_mul_f32 v248, v248, v236
v_cvt_pk_bf16_f32 v251, v242, v248
ds_write_b64 v231, v[250:251] offset:8
s_waitcnt lgkmcnt(0)
v_exp_f32 v248, v132
s_nop 0
v_sub_f32 v225, v225, v248
v_exp_f32 v248, v133
s_nop 0
v_sub_f32 v225, v225, v248
v_exp_f32 v248, v134
s_nop 0
v_sub_f32 v225, v225, v248
v_exp_f32 v248, v135
s_nop 0
v_sub_f32 v225, v225, v248
v_max_f32 v225, 0, v225
v_min_f32 v225, s32, v225
v_log_f32 v248, v225
v_max3_f32 v233, v132, v133, v134
v_max3_f32 v233, v233, v135, v248
v_mov_b32 v248, v233
s_nop 1
v_permlane32_swap_b32 v233, v248
s_nop 1
v_max_f32 v233, v233, v248
v_mov_b32 v248, v233
s_nop 1
v_permlane16_swap_b32 v233, v248
s_nop 1
v_max_f32 v233, v233, v248
v_ceil_f32 v233, v233
v_max_f32 v233, 0, v233
v_sub_f32 v248, 0, v233
v_exp_f32 v237, v248
s_nop 1
v_mul_f32 v225, v225, v237
v_sub_f32 v196, v196, v233
v_sub_f32 v132, v132, v233
v_sub_f32 v148, v148, v233
v_sub_f32 v197, v197, v233
v_sub_f32 v133, v133, v233
v_sub_f32 v149, v149, v233
v_sub_f32 v198, v198, v233
v_sub_f32 v134, v134, v233
v_sub_f32 v150, v150, v233
v_sub_f32 v199, v199, v233
v_sub_f32 v135, v135, v233
v_sub_f32 v151, v151, v233
v_lshlrev_b32 v242, 16, v164
v_and_b32 v248, 0xffff0000, v164
v_mul_f32 v242, v242, v237
v_mul_f32 v248, v248, v237
v_cvt_pk_bf16_f32 v164, v242, v248
v_lshlrev_b32 v242, 16, v165
v_and_b32 v248, 0xffff0000, v165
v_mul_f32 v242, v242, v237
v_mul_f32 v248, v248, v237
v_cvt_pk_bf16_f32 v165, v242, v248
v_lshlrev_b32 v242, 16, v166
v_and_b32 v248, 0xffff0000, v166
v_mul_f32 v242, v242, v237
v_mul_f32 v248, v248, v237
v_cvt_pk_bf16_f32 v166, v242, v248
v_lshlrev_b32 v242, 16, v167
v_and_b32 v248, 0xffff0000, v167
v_mul_f32 v242, v242, v237
v_mul_f32 v248, v248, v237
v_cvt_pk_bf16_f32 v167, v242, v248
ds_read_b64 v[250:251], v231 offset:1024
s_waitcnt lgkmcnt(0)
v_lshlrev_b32 v242, 16, v250
v_and_b32 v248, 0xffff0000, v250
v_mul_f32 v242, v242, v237
v_mul_f32 v248, v248, v237
v_cvt_pk_bf16_f32 v250, v242, v248
v_lshlrev_b32 v242, 16, v251
v_and_b32 v248, 0xffff0000, v251
v_mul_f32 v242, v242, v237
v_mul_f32 v248, v248, v237
v_cvt_pk_bf16_f32 v251, v242, v248
ds_write_b64 v231, v[250:251] offset:1024
s_waitcnt lgkmcnt(0)
ds_read_b64 v[250:251], v231 offset:1032
s_waitcnt lgkmcnt(0)
v_lshlrev_b32 v242, 16, v250
v_and_b32 v248, 0xffff0000, v250
v_mul_f32 v242, v242, v237
v_mul_f32 v248, v248, v237
v_cvt_pk_bf16_f32 v250, v242, v248
v_lshlrev_b32 v242, 16, v251
v_and_b32 v248, 0xffff0000, v251
v_mul_f32 v242, v242, v237
v_mul_f32 v248, v248, v237
v_cvt_pk_bf16_f32 v251, v242, v248
ds_write_b64 v231, v[250:251] offset:1032
s_waitcnt lgkmcnt(0)
v_exp_f32 v248, v136
s_nop 0
v_sub_f32 v226, v226, v248
v_exp_f32 v248, v137
s_nop 0
v_sub_f32 v226, v226, v248
v_exp_f32 v248, v138
s_nop 0
v_sub_f32 v226, v226, v248
v_exp_f32 v248, v139
s_nop 0
v_sub_f32 v226, v226, v248
v_max_f32 v226, 0, v226
v_min_f32 v226, s32, v226
v_log_f32 v248, v226
v_max3_f32 v234, v136, v137, v138
v_max3_f32 v234, v234, v139, v248
v_mov_b32 v248, v234
s_nop 1
v_permlane32_swap_b32 v234, v248
s_nop 1
v_max_f32 v234, v234, v248
v_mov_b32 v248, v234
s_nop 1
v_permlane16_swap_b32 v234, v248
s_nop 1
v_max_f32 v234, v234, v248
v_ceil_f32 v234, v234
v_max_f32 v234, 0, v234
v_sub_f32 v248, 0, v234
v_exp_f32 v238, v248
s_nop 1
v_mul_f32 v226, v226, v238
v_sub_f32 v200, v200, v234
v_sub_f32 v136, v136, v234
v_sub_f32 v152, v152, v234
v_sub_f32 v201, v201, v234
v_sub_f32 v137, v137, v234
v_sub_f32 v153, v153, v234
v_sub_f32 v202, v202, v234
v_sub_f32 v138, v138, v234
v_sub_f32 v154, v154, v234
v_sub_f32 v203, v203, v234
v_sub_f32 v139, v139, v234
v_sub_f32 v155, v155, v234
v_lshlrev_b32 v242, 16, v168
v_and_b32 v248, 0xffff0000, v168
v_mul_f32 v242, v242, v238
v_mul_f32 v248, v248, v238
v_cvt_pk_bf16_f32 v168, v242, v248
v_lshlrev_b32 v242, 16, v169
v_and_b32 v248, 0xffff0000, v169
v_mul_f32 v242, v242, v238
v_mul_f32 v248, v248, v238
v_cvt_pk_bf16_f32 v169, v242, v248
v_lshlrev_b32 v242, 16, v170
v_and_b32 v248, 0xffff0000, v170
v_mul_f32 v242, v242, v238
v_mul_f32 v248, v248, v238
v_cvt_pk_bf16_f32 v170, v242, v248
v_lshlrev_b32 v242, 16, v171
v_and_b32 v248, 0xffff0000, v171
v_mul_f32 v242, v242, v238
v_mul_f32 v248, v248, v238
v_cvt_pk_bf16_f32 v171, v242, v248
ds_read_b64 v[250:251], v231 offset:2048
s_waitcnt lgkmcnt(0)
v_lshlrev_b32 v242, 16, v250
v_and_b32 v248, 0xffff0000, v250
v_mul_f32 v242, v242, v238
v_mul_f32 v248, v248, v238
v_cvt_pk_bf16_f32 v250, v242, v248
v_lshlrev_b32 v242, 16, v251
v_and_b32 v248, 0xffff0000, v251
v_mul_f32 v242, v242, v238
v_mul_f32 v248, v248, v238
v_cvt_pk_bf16_f32 v251, v242, v248
ds_write_b64 v231, v[250:251] offset:2048
s_waitcnt lgkmcnt(0)
ds_read_b64 v[250:251], v231 offset:2056
s_waitcnt lgkmcnt(0)
v_lshlrev_b32 v242, 16, v250
v_and_b32 v248, 0xffff0000, v250
v_mul_f32 v242, v242, v238
v_mul_f32 v248, v248, v238
v_cvt_pk_bf16_f32 v250, v242, v248
v_lshlrev_b32 v242, 16, v251
v_and_b32 v248, 0xffff0000, v251
v_mul_f32 v242, v242, v238
v_mul_f32 v248, v248, v238
v_cvt_pk_bf16_f32 v251, v242, v248
ds_write_b64 v231, v[250:251] offset:2056
s_waitcnt lgkmcnt(0)
v_exp_f32 v248, v140
s_nop 0
v_sub_f32 v227, v227, v248
v_exp_f32 v248, v141
s_nop 0
v_sub_f32 v227, v227, v248
v_exp_f32 v248, v142
s_nop 0
v_sub_f32 v227, v227, v248
v_exp_f32 v248, v143
s_nop 0
v_sub_f32 v227, v227, v248
v_max_f32 v227, 0, v227
v_min_f32 v227, s32, v227
v_log_f32 v248, v227
v_max3_f32 v235, v140, v141, v142
v_max3_f32 v235, v235, v143, v248
v_mov_b32 v248, v235
s_nop 1
v_permlane32_swap_b32 v235, v248
s_nop 1
v_max_f32 v235, v235, v248
v_mov_b32 v248, v235
s_nop 1
v_permlane16_swap_b32 v235, v248
s_nop 1
v_max_f32 v235, v235, v248
v_ceil_f32 v235, v235
v_max_f32 v235, 0, v235
v_sub_f32 v248, 0, v235
v_exp_f32 v239, v248
s_nop 1
v_mul_f32 v227, v227, v239
v_sub_f32 v204, v204, v235
v_sub_f32 v140, v140, v235
v_sub_f32 v156, v156, v235
v_sub_f32 v205, v205, v235
v_sub_f32 v141, v141, v235
v_sub_f32 v157, v157, v235
v_sub_f32 v206, v206, v235
v_sub_f32 v142, v142, v235
v_sub_f32 v158, v158, v235
v_sub_f32 v207, v207, v235
v_sub_f32 v143, v143, v235
v_sub_f32 v159, v159, v235
v_lshlrev_b32 v242, 16, v172
v_and_b32 v248, 0xffff0000, v172
v_mul_f32 v242, v242, v239
v_mul_f32 v248, v248, v239
v_cvt_pk_bf16_f32 v172, v242, v248
v_lshlrev_b32 v242, 16, v173
v_and_b32 v248, 0xffff0000, v173
v_mul_f32 v242, v242, v239
v_mul_f32 v248, v248, v239
v_cvt_pk_bf16_f32 v173, v242, v248
v_lshlrev_b32 v242, 16, v174
v_and_b32 v248, 0xffff0000, v174
v_mul_f32 v242, v242, v239
v_mul_f32 v248, v248, v239
v_cvt_pk_bf16_f32 v174, v242, v248
v_lshlrev_b32 v242, 16, v175
v_and_b32 v248, 0xffff0000, v175
v_mul_f32 v242, v242, v239
v_mul_f32 v248, v248, v239
v_cvt_pk_bf16_f32 v175, v242, v248
ds_read_b64 v[250:251], v231 offset:3072
s_waitcnt lgkmcnt(0)
v_lshlrev_b32 v242, 16, v250
v_and_b32 v248, 0xffff0000, v250
v_mul_f32 v242, v242, v239
v_mul_f32 v248, v248, v239
v_cvt_pk_bf16_f32 v250, v242, v248
v_lshlrev_b32 v242, 16, v251
v_and_b32 v248, 0xffff0000, v251
v_mul_f32 v242, v242, v239
v_mul_f32 v248, v248, v239
v_cvt_pk_bf16_f32 v251, v242, v248
ds_write_b64 v231, v[250:251] offset:3072
s_waitcnt lgkmcnt(0)
ds_read_b64 v[250:251], v231 offset:3080
s_waitcnt lgkmcnt(0)
v_lshlrev_b32 v242, 16, v250
v_and_b32 v248, 0xffff0000, v250
v_mul_f32 v242, v242, v239
v_mul_f32 v248, v248, v239
v_cvt_pk_bf16_f32 v250, v242, v248
v_lshlrev_b32 v242, 16, v251
v_and_b32 v248, 0xffff0000, v251
v_mul_f32 v242, v242, v239
v_mul_f32 v248, v248, v239
v_cvt_pk_bf16_f32 v251, v242, v248
ds_write_b64 v231, v[250:251] offset:3080
s_waitcnt lgkmcnt(0)
v_exp_f32 v232, v128
v_exp_f32 v233, v129
v_exp_f32 v234, v130
v_exp_f32 v235, v131
s_nop 1
v_add_f32 v224, v224, v232
v_add_f32 v224, v224, v233
v_add_f32 v224, v224, v234
v_add_f32 v224, v224, v235
v_cvt_pk_bf16_f32 v176, v232, v233
v_cvt_pk_bf16_f32 v177, v234, v235
v_exp_f32 v232, v132
v_exp_f32 v233, v133
v_exp_f32 v234, v134
v_exp_f32 v235, v135
s_nop 1
v_add_f32 v225, v225, v232
v_add_f32 v225, v225, v233
v_add_f32 v225, v225, v234
v_add_f32 v225, v225, v235
v_cvt_pk_bf16_f32 v180, v232, v233
v_cvt_pk_bf16_f32 v181, v234, v235
v_exp_f32 v232, v136
v_exp_f32 v233, v137
v_exp_f32 v234, v138
v_exp_f32 v235, v139
s_nop 1
v_add_f32 v226, v226, v232
v_add_f32 v226, v226, v233
v_add_f32 v226, v226, v234
v_add_f32 v226, v226, v235
v_cvt_pk_bf16_f32 v184, v232, v233
v_cvt_pk_bf16_f32 v185, v234, v235
v_exp_f32 v232, v140
v_exp_f32 v233, v141
v_exp_f32 v234, v142
v_exp_f32 v235, v143
s_nop 1
v_add_f32 v227, v227, v232
v_add_f32 v227, v227, v233
v_add_f32 v227, v227, v234
v_add_f32 v227, v227, v235
v_cvt_pk_bf16_f32 v188, v232, v233
v_cvt_pk_bf16_f32 v189, v234, v235
s_branch L2_rare_common
L2_rare_site7:
s_mov_b32 s36, 7
s_branch L2_rare_t1_1_1
L2_rare_t1_1_1:
s_nop 15
s_nop 15
s_waitcnt lgkmcnt(0)
v_exp_f32 v248, v144
s_nop 0
v_sub_f32 v224, v224, v248
v_exp_f32 v248, v145
s_nop 0
v_sub_f32 v224, v224, v248
v_exp_f32 v248, v146
s_nop 0
v_sub_f32 v224, v224, v248
v_exp_f32 v248, v147
s_nop 0
v_sub_f32 v224, v224, v248
v_max_f32 v224, 0, v224
v_min_f32 v224, s32, v224
v_log_f32 v248, v224
v_max3_f32 v232, v144, v145, v146
v_max3_f32 v232, v232, v147, v248
v_mov_b32 v248, v232
s_nop 1
v_permlane32_swap_b32 v232, v248
s_nop 1
v_max_f32 v232, v232, v248
v_mov_b32 v248, v232
s_nop 1
v_permlane16_swap_b32 v232, v248
s_nop 1
v_max_f32 v232, v232, v248
v_ceil_f32 v232, v232
v_max_f32 v232, 0, v232
v_sub_f32 v248, 0, v232
v_exp_f32 v236, v248
s_nop 1
v_mul_f32 v224, v224, v236
v_sub_f32 v192, v192, v232
v_sub_f32 v144, v144, v232
v_sub_f32 v128, v128, v232
v_sub_f32 v193, v193, v232
v_sub_f32 v145, v145, v232
v_sub_f32 v129, v129, v232
v_sub_f32 v194, v194, v232
v_sub_f32 v146, v146, v232
v_sub_f32 v130, v130, v232
v_sub_f32 v195, v195, v232
v_sub_f32 v147, v147, v232
v_sub_f32 v131, v131, v232
v_lshlrev_b32 v242, 16, v176
v_and_b32 v248, 0xffff0000, v176
v_mul_f32 v242, v242, v236
v_mul_f32 v248, v248, v236
v_cvt_pk_bf16_f32 v176, v242, v248
v_lshlrev_b32 v242, 16, v177
v_and_b32 v248, 0xffff0000, v177
v_mul_f32 v242, v242, v236
v_mul_f32 v248, v248, v236
v_cvt_pk_bf16_f32 v177, v242, v248
ds_read_b64 v[250:251], v231 offset:0
s_waitcnt lgkmcnt(0)
v_lshlrev_b32 v242, 16, v250
v_and_b32 v248, 0xffff0000, v250
v_mul_f32 v242, v242, v236
v_mul_f32 v248, v248, v236
v_cvt_pk_bf16_f32 v250, v242, v248
v_lshlrev_b32 v242, 16, v251
v_and_b32 v248, 0xffff0000, v251
v_mul_f32 v242, v242, v236
v_mul_f32 v248, v248, v236
v_cvt_pk_bf16_f32 v251, v242, v248
ds_write_b64 v231, v[250:251] offset:0
s_waitcnt lgkmcnt(0)
ds_read_b64 v[250:251], v231 offset:8
s_waitcnt lgkmcnt(0)
v_lshlrev_b32 v242, 16, v250
v_and_b32 v248, 0xffff0000, v250
v_mul_f32 v242, v242, v236
v_mul_f32 v248, v248, v236
v_cvt_pk_bf16_f32 v250, v242, v248
v_lshlrev_b32 v242, 16, v251
v_and_b32 v248, 0xffff0000, v251
v_mul_f32 v242, v242, v236
v_mul_f32 v248, v248, v236
v_cvt_pk_bf16_f32 v251, v242, v248
ds_write_b64 v231, v[250:251] offset:8
s_waitcnt lgkmcnt(0)
ds_read_b64 v[250:251], v231 offset:4096
s_waitcnt lgkmcnt(0)
v_lshlrev_b32 v242, 16, v250
v_and_b32 v248, 0xffff0000, v250
v_mul_f32 v242, v242, v236
v_mul_f32 v248, v248, v236
v_cvt_pk_bf16_f32 v250, v242, v248
v_lshlrev_b32 v242, 16, v251
v_and_b32 v248, 0xffff0000, v251
v_mul_f32 v242, v242, v236
v_mul_f32 v248, v248, v236
v_cvt_pk_bf16_f32 v251, v242, v248
ds_write_b64 v231, v[250:251] offset:4096
s_waitcnt lgkmcnt(0)
ds_read_b64 v[250:251], v231 offset:4104
s_waitcnt lgkmcnt(0)
v_lshlrev_b32 v242, 16, v250
v_and_b32 v248, 0xffff0000, v250
v_mul_f32 v242, v242, v236
v_mul_f32 v248, v248, v236
v_cvt_pk_bf16_f32 v250, v242, v248
v_lshlrev_b32 v242, 16, v251
v_and_b32 v248, 0xffff0000, v251
v_mul_f32 v242, v242, v236
v_mul_f32 v248, v248, v236
v_cvt_pk_bf16_f32 v251, v242, v248
ds_write_b64 v231, v[250:251] offset:4104
s_waitcnt lgkmcnt(0)
v_exp_f32 v248, v148
s_nop 0
v_sub_f32 v225, v225, v248
v_exp_f32 v248, v149
s_nop 0
v_sub_f32 v225, v225, v248
v_exp_f32 v248, v150
s_nop 0
v_sub_f32 v225, v225, v248
v_exp_f32 v248, v151
s_nop 0
v_sub_f32 v225, v225, v248
v_max_f32 v225, 0, v225
v_min_f32 v225, s32, v225
v_log_f32 v248, v225
v_max3_f32 v233, v148, v149, v150
v_max3_f32 v233, v233, v151, v248
v_mov_b32 v248, v233
s_nop 1
v_permlane32_swap_b32 v233, v248
s_nop 1
v_max_f32 v233, v233, v248
v_mov_b32 v248, v233
s_nop 1
v_permlane16_swap_b32 v233, v248
s_nop 1
v_max_f32 v233, v233, v248
v_ceil_f32 v233, v233
v_max_f32 v233, 0, v233
v_sub_f32 v248, 0, v233
v_exp_f32 v237, v248
s_nop 1
v_mul_f32 v225, v225, v237
v_sub_f32 v196, v196, v233
v_sub_f32 v148, v148, v233
v_sub_f32 v132, v132, v233
v_sub_f32 v197, v197, v233
v_sub_f32 v149, v149, v233
v_sub_f32 v133, v133, v233
v_sub_f32 v198, v198, v233
v_sub_f32 v150, v150, v233
v_sub_f32 v134, v134, v233
v_sub_f32 v199, v199, v233
v_sub_f32 v151, v151, v233
v_sub_f32 v135, v135, v233
v_lshlrev_b32 v242, 16, v180
v_and_b32 v248, 0xffff0000, v180
v_mul_f32 v242, v242, v237
v_mul_f32 v248, v248, v237
v_cvt_pk_bf16_f32 v180, v242, v248
v_lshlrev_b32 v242, 16, v181
v_and_b32 v248, 0xffff0000, v181
v_mul_f32 v242, v242, v237
v_mul_f32 v248, v248, v237
v_cvt_pk_bf16_f32 v181, v242, v248
ds_read_b64 v[250:251], v231 offset:1024
s_waitcnt lgkmcnt(0)
v_lshlrev_b32 v242, 16, v250
v_and_b32 v248, 0xffff0000, v250
v_mul_f32 v242, v242, v237
v_mul_f32 v248, v248, v237
v_cvt_pk_bf16_f32 v250, v242, v248
v_lshlrev_b32 v242, 16, v251
v_and_b32 v248, 0xffff0000, v251
v_mul_f32 v242, v242, v237
v_mul_f32 v248, v248, v237
v_cvt_pk_bf16_f32 v251, v242, v248
ds_write_b64 v231, v[250:251] offset:1024
s_waitcnt lgkmcnt(0)
ds_read_b64 v[250:251], v231 offset:1032
s_waitcnt lgkmcnt(0)
v_lshlrev_b32 v242, 16, v250
v_and_b32 v248, 0xffff0000, v250
v_mul_f32 v242, v242, v237
v_mul_f32 v248, v248, v237
v_cvt_pk_bf16_f32 v250, v242, v248
v_lshlrev_b32 v242, 16, v251
v_and_b32 v248, 0xffff0000, v251
v_mul_f32 v242, v242, v237
v_mul_f32 v248, v248, v237
v_cvt_pk_bf16_f32 v251, v242, v248
ds_write_b64 v231, v[250:251] offset:1032
s_waitcnt lgkmcnt(0)
ds_read_b64 v[250:251], v231 offset:5120
s_waitcnt lgkmcnt(0)
v_lshlrev_b32 v242, 16, v250
v_and_b32 v248, 0xffff0000, v250
v_mul_f32 v242, v242, v237
v_mul_f32 v248, v248, v237
v_cvt_pk_bf16_f32 v250, v242, v248
v_lshlrev_b32 v242, 16, v251
v_and_b32 v248, 0xffff0000, v251
v_mul_f32 v242, v242, v237
v_mul_f32 v248, v248, v237
v_cvt_pk_bf16_f32 v251, v242, v248
ds_write_b64 v231, v[250:251] offset:5120
s_waitcnt lgkmcnt(0)
ds_read_b64 v[250:251], v231 offset:5128
s_waitcnt lgkmcnt(0)
v_lshlrev_b32 v242, 16, v250
v_and_b32 v248, 0xffff0000, v250
v_mul_f32 v242, v242, v237
v_mul_f32 v248, v248, v237
v_cvt_pk_bf16_f32 v250, v242, v248
v_lshlrev_b32 v242, 16, v251
v_and_b32 v248, 0xffff0000, v251
v_mul_f32 v242, v242, v237
v_mul_f32 v248, v248, v237
v_cvt_pk_bf16_f32 v251, v242, v248
ds_write_b64 v231, v[250:251] offset:5128
s_waitcnt lgkmcnt(0)
v_exp_f32 v248, v152
s_nop 0
v_sub_f32 v226, v226, v248
v_exp_f32 v248, v153
s_nop 0
v_sub_f32 v226, v226, v248
v_exp_f32 v248, v154
s_nop 0
v_sub_f32 v226, v226, v248
v_exp_f32 v248, v155
s_nop 0
v_sub_f32 v226, v226, v248
v_max_f32 v226, 0, v226
v_min_f32 v226, s32, v226
v_log_f32 v248, v226
v_max3_f32 v234, v152, v153, v154
v_max3_f32 v234, v234, v155, v248
v_mov_b32 v248, v234
s_nop 1
v_permlane32_swap_b32 v234, v248
s_nop 1
v_max_f32 v234, v234, v248
v_mov_b32 v248, v234
s_nop 1
v_permlane16_swap_b32 v234, v248
s_nop 1
v_max_f32 v234, v234, v248
v_ceil_f32 v234, v234
v_max_f32 v234, 0, v234
v_sub_f32 v248, 0, v234
v_exp_f32 v238, v248
s_nop 1
v_mul_f32 v226, v226, v238
v_sub_f32 v200, v200, v234
v_sub_f32 v152, v152, v234
v_sub_f32 v136, v136, v234
v_sub_f32 v201, v201, v234
v_sub_f32 v153, v153, v234
v_sub_f32 v137, v137, v234
v_sub_f32 v202, v202, v234
v_sub_f32 v154, v154, v234
v_sub_f32 v138, v138, v234
v_sub_f32 v203, v203, v234
v_sub_f32 v155, v155, v234
v_sub_f32 v139, v139, v234
v_lshlrev_b32 v242, 16, v184
v_and_b32 v248, 0xffff0000, v184
v_mul_f32 v242, v242, v238
v_mul_f32 v248, v248, v238
v_cvt_pk_bf16_f32 v184, v242, v248
v_lshlrev_b32 v242, 16, v185
v_and_b32 v248, 0xffff0000, v185
v_mul_f32 v242, v242, v238
v_mul_f32 v248, v248, v238
v_cvt_pk_bf16_f32 v185, v242, v248
ds_read_b64 v[250:251], v231 offset:2048
s_waitcnt lgkmcnt(0)
v_lshlrev_b32 v242, 16, v250
v_and_b32 v248, 0xffff0000, v250
v_mul_f32 v242, v242, v238
v_mul_f32 v248, v248, v238
v_cvt_pk_bf16_f32 v250, v242, v248
v_lshlrev_b32 v242, 16, v251
v_and_b32 v248, 0xffff0000, v251
v_mul_f32 v242, v242, v238
v_mul_f32 v248, v248, v238
v_cvt_pk_bf16_f32 v251, v242, v248
ds_write_b64 v231, v[250:251] offset:2048
s_waitcnt lgkmcnt(0)
ds_read_b64 v[250:251], v231 offset:2056
s_waitcnt lgkmcnt(0)
v_lshlrev_b32 v242, 16, v250
v_and_b32 v248, 0xffff0000, v250
v_mul_f32 v242, v242, v238
v_mul_f32 v248, v248, v238
v_cvt_pk_bf16_f32 v250, v242, v248
v_lshlrev_b32 v242, 16, v251
v_and_b32 v248, 0xffff0000, v251
v_mul_f32 v242, v242, v238
v_mul_f32 v248, v248, v238
v_cvt_pk_bf16_f32 v251, v242, v248
ds_write_b64 v231, v[250:251] offset:2056
s_waitcnt lgkmcnt(0)
ds_read_b64 v[250:251], v231 offset:6144
s_waitcnt lgkmcnt(0)
v_lshlrev_b32 v242, 16, v250
v_and_b32 v248, 0xffff0000, v250
v_mul_f32 v242, v242, v238
v_mul_f32 v248, v248, v238
v_cvt_pk_bf16_f32 v250, v242, v248
v_lshlrev_b32 v242, 16, v251
v_and_b32 v248, 0xffff0000, v251
v_mul_f32 v242, v242, v238
v_mul_f32 v248, v248, v238
v_cvt_pk_bf16_f32 v251, v242, v248
ds_write_b64 v231, v[250:251] offset:6144
s_waitcnt lgkmcnt(0)
ds_read_b64 v[250:251], v231 offset:6152
s_waitcnt lgkmcnt(0)
v_lshlrev_b32 v242, 16, v250
v_and_b32 v248, 0xffff0000, v250
v_mul_f32 v242, v242, v238
v_mul_f32 v248, v248, v238
v_cvt_pk_bf16_f32 v250, v242, v248
v_lshlrev_b32 v242, 16, v251
v_and_b32 v248, 0xffff0000, v251
v_mul_f32 v242, v242, v238
v_mul_f32 v248, v248, v238
v_cvt_pk_bf16_f32 v251, v242, v248
ds_write_b64 v231, v[250:251] offset:6152
s_waitcnt lgkmcnt(0)
v_exp_f32 v248, v156
s_nop 0
v_sub_f32 v227, v227, v248
v_exp_f32 v248, v157
s_nop 0
v_sub_f32 v227, v227, v248
v_exp_f32 v248, v158
s_nop 0
v_sub_f32 v227, v227, v248
v_exp_f32 v248, v159
s_nop 0
v_sub_f32 v227, v227, v248
v_max_f32 v227, 0, v227
v_min_f32 v227, s32, v227
v_log_f32 v248, v227
v_max3_f32 v235, v156, v157, v158
v_max3_f32 v235, v235, v159, v248
v_mov_b32 v248, v235
s_nop 1
v_permlane32_swap_b32 v235, v248
s_nop 1
v_max_f32 v235, v235, v248
v_mov_b32 v248, v235
s_nop 1
v_permlane16_swap_b32 v235, v248
s_nop 1
v_max_f32 v235, v235, v248
v_ceil_f32 v235, v235
v_max_f32 v235, 0, v235
v_sub_f32 v248, 0, v235
v_exp_f32 v239, v248
s_nop 1
v_mul_f32 v227, v227, v239
v_sub_f32 v204, v204, v235
v_sub_f32 v156, v156, v235
v_sub_f32 v140, v140, v235
v_sub_f32 v205, v205, v235
v_sub_f32 v157, v157, v235
v_sub_f32 v141, v141, v235
v_sub_f32 v206, v206, v235
v_sub_f32 v158, v158, v235
v_sub_f32 v142, v142, v235
v_sub_f32 v207, v207, v235
v_sub_f32 v159, v159, v235
v_sub_f32 v143, v143, v235
v_lshlrev_b32 v242, 16, v188
v_and_b32 v248, 0xffff0000, v188
v_mul_f32 v242, v242, v239
v_mul_f32 v248, v248, v239
v_cvt_pk_bf16_f32 v188, v242, v248
v_lshlrev_b32 v242, 16, v189
v_and_b32 v248, 0xffff0000, v189
v_mul_f32 v242, v242, v239
v_mul_f32 v248, v248, v239
v_cvt_pk_bf16_f32 v189, v242, v248
ds_read_b64 v[250:251], v231 offset:3072
s_waitcnt lgkmcnt(0)
v_lshlrev_b32 v242, 16, v250
v_and_b32 v248, 0xffff0000, v250
v_mul_f32 v242, v242, v239
v_mul_f32 v248, v248, v239
v_cvt_pk_bf16_f32 v250, v242, v248
v_lshlrev_b32 v242, 16, v251
v_and_b32 v248, 0xffff0000, v251
v_mul_f32 v242, v242, v239
v_mul_f32 v248, v248, v239
v_cvt_pk_bf16_f32 v251, v242, v248
ds_write_b64 v231, v[250:251] offset:3072
s_waitcnt lgkmcnt(0)
ds_read_b64 v[250:251], v231 offset:3080
s_waitcnt lgkmcnt(0)
v_lshlrev_b32 v242, 16, v250
v_and_b32 v248, 0xffff0000, v250
v_mul_f32 v242, v242, v239
v_mul_f32 v248, v248, v239
v_cvt_pk_bf16_f32 v250, v242, v248
v_lshlrev_b32 v242, 16, v251
v_and_b32 v248, 0xffff0000, v251
v_mul_f32 v242, v242, v239
v_mul_f32 v248, v248, v239
v_cvt_pk_bf16_f32 v251, v242, v248
ds_write_b64 v231, v[250:251] offset:3080
s_waitcnt lgkmcnt(0)
ds_read_b64 v[250:251], v231 offset:7168
s_waitcnt lgkmcnt(0)
v_lshlrev_b32 v242, 16, v250
v_and_b32 v248, 0xffff0000, v250
v_mul_f32 v242, v242, v239
v_mul_f32 v248, v248, v239
v_cvt_pk_bf16_f32 v250, v242, v248
v_lshlrev_b32 v242, 16, v251
v_and_b32 v248, 0xffff0000, v251
v_mul_f32 v242, v242, v239
v_mul_f32 v248, v248, v239
v_cvt_pk_bf16_f32 v251, v242, v248
ds_write_b64 v231, v[250:251] offset:7168
s_waitcnt lgkmcnt(0)
ds_read_b64 v[250:251], v231 offset:7176
s_waitcnt lgkmcnt(0)
v_lshlrev_b32 v242, 16, v250
v_and_b32 v248, 0xffff0000, v250
v_mul_f32 v242, v242, v239
v_mul_f32 v248, v248, v239
v_cvt_pk_bf16_f32 v250, v242, v248
v_lshlrev_b32 v242, 16, v251
v_and_b32 v248, 0xffff0000, v251
v_mul_f32 v242, v242, v239
v_mul_f32 v248, v248, v239
v_cvt_pk_bf16_f32 v251, v242, v248
ds_write_b64 v231, v[250:251] offset:7176
s_waitcnt lgkmcnt(0)
v_exp_f32 v232, v144
v_exp_f32 v233, v145
v_exp_f32 v234, v146
v_exp_f32 v235, v147
s_nop 1
v_add_f32 v224, v224, v232
v_add_f32 v224, v224, v233
v_add_f32 v224, v224, v234
v_add_f32 v224, v224, v235
v_cvt_pk_bf16_f32 v178, v232, v233
v_cvt_pk_bf16_f32 v179, v234, v235
v_exp_f32 v232, v148
v_exp_f32 v233, v149
v_exp_f32 v234, v150
v_exp_f32 v235, v151
s_nop 1
v_add_f32 v225, v225, v232
v_add_f32 v225, v225, v233
v_add_f32 v225, v225, v234
v_add_f32 v225, v225, v235
v_cvt_pk_bf16_f32 v182, v232, v233
v_cvt_pk_bf16_f32 v183, v234, v235
v_exp_f32 v232, v152
v_exp_f32 v233, v153
v_exp_f32 v234, v154
v_exp_f32 v235, v155
s_nop 1
v_add_f32 v226, v226, v232
v_add_f32 v226, v226, v233
v_add_f32 v226, v226, v234
v_add_f32 v226, v226, v235
v_cvt_pk_bf16_f32 v186, v232, v233
v_cvt_pk_bf16_f32 v187, v234, v235
v_exp_f32 v232, v156
v_exp_f32 v233, v157
v_exp_f32 v234, v158
v_exp_f32 v235, v159
s_nop 1
v_add_f32 v227, v227, v232
v_add_f32 v227, v227, v233
v_add_f32 v227, v227, v234
v_add_f32 v227, v227, v235
v_cvt_pk_bf16_f32 v190, v232, v233
v_cvt_pk_bf16_f32 v191, v234, v235
s_branch L2_rare_common
L2_rare_site8:
s_mov_b32 s36, 8
s_branch L2_rare_t1_2_0
L2_rare_t1_2_0:
s_nop 15
s_nop 15
s_waitcnt lgkmcnt(0)
v_exp_f32 v248, v128
s_nop 0
v_sub_f32 v224, v224, v248
v_exp_f32 v248, v129
s_nop 0
v_sub_f32 v224, v224, v248
v_exp_f32 v248, v130
s_nop 0
v_sub_f32 v224, v224, v248
v_exp_f32 v248, v131
s_nop 0
v_sub_f32 v224, v224, v248
v_max_f32 v224, 0, v224
v_min_f32 v224, s32, v224
v_log_f32 v248, v224
v_max3_f32 v232, v128, v129, v130
v_max3_f32 v232, v232, v131, v248
v_mov_b32 v248, v232
s_nop 1
v_permlane32_swap_b32 v232, v248
s_nop 1
v_max_f32 v232, v232, v248
v_mov_b32 v248, v232
s_nop 1
v_permlane16_swap_b32 v232, v248
s_nop 1
v_max_f32 v232, v232, v248
v_ceil_f32 v232, v232
v_max_f32 v232, 0, v232
v_sub_f32 v248, 0, v232
v_exp_f32 v236, v248
s_nop 1
v_mul_f32 v224, v224, v236
v_sub_f32 v192, v192, v232
v_sub_f32 v128, v128, v232
v_sub_f32 v144, v144, v232
v_sub_f32 v193, v193, v232
v_sub_f32 v129, v129, v232
v_sub_f32 v145, v145, v232
v_sub_f32 v194, v194, v232
v_sub_f32 v130, v130, v232
v_sub_f32 v146, v146, v232
v_sub_f32 v195, v195, v232
v_sub_f32 v131, v131, v232
v_sub_f32 v147, v147, v232
v_lshlrev_b32 v242, 16, v176
v_and_b32 v248, 0xffff0000, v176
v_mul_f32 v242, v242, v236
v_mul_f32 v248, v248, v236
v_cvt_pk_bf16_f32 v176, v242, v248
v_lshlrev_b32 v242, 16, v177
v_and_b32 v248, 0xffff0000, v177
v_mul_f32 v242, v242, v236
v_mul_f32 v248, v248, v236
v_cvt_pk_bf16_f32 v177, v242, v248
v_lshlrev_b32 v242, 16, v178
v_and_b32 v248, 0xffff0000, v178
v_mul_f32 v242, v242, v236
v_mul_f32 v248, v248, v236
v_cvt_pk_bf16_f32 v178, v242, v248
v_lshlrev_b32 v242, 16, v179
v_and_b32 v248, 0xffff0000, v179
v_mul_f32 v242, v242, v236
v_mul_f32 v248, v248, v236
v_cvt_pk_bf16_f32 v179, v242, v248
ds_read_b64 v[250:251], v231 offset:0
s_waitcnt lgkmcnt(0)
v_lshlrev_b32 v242, 16, v250
v_and_b32 v248, 0xffff0000, v250
v_mul_f32 v242, v242, v236
v_mul_f32 v248, v248, v236
v_cvt_pk_bf16_f32 v250, v242, v248
v_lshlrev_b32 v242, 16, v251
v_and_b32 v248, 0xffff0000, v251
v_mul_f32 v242, v242, v236
v_mul_f32 v248, v248, v236
v_cvt_pk_bf16_f32 v251, v242, v248
ds_write_b64 v231, v[250:251] offset:0
s_waitcnt lgkmcnt(0)
ds_read_b64 v[250:251], v231 offset:8
s_waitcnt lgkmcnt(0)
v_lshlrev_b32 v242, 16, v250
v_and_b32 v248, 0xffff0000, v250
v_mul_f32 v242, v242, v236
v_mul_f32 v248, v248, v236
v_cvt_pk_bf16_f32 v250, v242, v248
v_lshlrev_b32 v242, 16, v251
v_and_b32 v248, 0xffff0000, v251
v_mul_f32 v242, v242, v236
v_mul_f32 v248, v248, v236
v_cvt_pk_bf16_f32 v251, v242, v248
ds_write_b64 v231, v[250:251] offset:8
s_waitcnt lgkmcnt(0)
ds_read_b64 v[250:251], v231 offset:4096
s_waitcnt lgkmcnt(0)
v_lshlrev_b32 v242, 16, v250
v_and_b32 v248, 0xffff0000, v250
v_mul_f32 v242, v242, v236
v_mul_f32 v248, v248, v236
v_cvt_pk_bf16_f32 v250, v242, v248
v_lshlrev_b32 v242, 16, v251
v_and_b32 v248, 0xffff0000, v251
v_mul_f32 v242, v242, v236
v_mul_f32 v248, v248, v236
v_cvt_pk_bf16_f32 v251, v242, v248
ds_write_b64 v231, v[250:251] offset:4096
s_waitcnt lgkmcnt(0)
ds_read_b64 v[250:251], v231 offset:4104
s_waitcnt lgkmcnt(0)
v_lshlrev_b32 v242, 16, v250
v_and_b32 v248, 0xffff0000, v250
v_mul_f32 v242, v242, v236
v_mul_f32 v248, v248, v236
v_cvt_pk_bf16_f32 v250, v242, v248
v_lshlrev_b32 v242, 16, v251
v_and_b32 v248, 0xffff0000, v251
v_mul_f32 v242, v242, v236
v_mul_f32 v248, v248, v236
v_cvt_pk_bf16_f32 v251, v242, v248
ds_write_b64 v231, v[250:251] offset:4104
s_waitcnt lgkmcnt(0)
v_exp_f32 v248, v132
s_nop 0
v_sub_f32 v225, v225, v248
v_exp_f32 v248, v133
s_nop 0
v_sub_f32 v225, v225, v248
v_exp_f32 v248, v134
s_nop 0
v_sub_f32 v225, v225, v248
v_exp_f32 v248, v135
s_nop 0
v_sub_f32 v225, v225, v248
v_max_f32 v225, 0, v225
v_min_f32 v225, s32, v225
v_log_f32 v248, v225
v_max3_f32 v233, v132, v133, v134
v_max3_f32 v233, v233, v135, v248
v_mov_b32 v248, v233
s_nop 1
v_permlane32_swap_b32 v233, v248
s_nop 1
v_max_f32 v233, v233, v248
v_mov_b32 v248, v233
s_nop 1
v_permlane16_swap_b32 v233, v248
s_nop 1
v_max_f32 v233, v233, v248
v_ceil_f32 v233, v233
v_max_f32 v233, 0, v233
v_sub_f32 v248, 0, v233
v_exp_f32 v237, v248
s_nop 1
v_mul_f32 v225, v225, v237
v_sub_f32 v196, v196, v233
v_sub_f32 v132, v132, v233
v_sub_f32 v148, v148, v233
v_sub_f32 v197, v197, v233
v_sub_f32 v133, v133, v233
v_sub_f32 v149, v149, v233
v_sub_f32 v198, v198, v233
v_sub_f32 v134, v134, v233
v_sub_f32 v150, v150, v233
v_sub_f32 v199, v199, v233
v_sub_f32 v135, v135, v233
v_sub_f32 v151, v151, v233
v_lshlrev_b32 v242, 16, v180
v_and_b32 v248, 0xffff0000, v180
v_mul_f32 v242, v242, v237
v_mul_f32 v248, v248, v237
v_cvt_pk_bf16_f32 v180, v242, v248
v_lshlrev_b32 v242, 16, v181
v_and_b32 v248, 0xffff0000, v181
v_mul_f32 v242, v242, v237
v_mul_f32 v248, v248, v237
v_cvt_pk_bf16_f32 v181, v242, v248
v_lshlrev_b32 v242, 16, v182
v_and_b32 v248, 0xffff0000, v182
v_mul_f32 v242, v242, v237
v_mul_f32 v248, v248, v237
v_cvt_pk_bf16_f32 v182, v242, v248
v_lshlrev_b32 v242, 16, v183
v_and_b32 v248, 0xffff0000, v183
v_mul_f32 v242, v242, v237
v_mul_f32 v248, v248, v237
v_cvt_pk_bf16_f32 v183, v242, v248
ds_read_b64 v[250:251], v231 offset:1024
s_waitcnt lgkmcnt(0)
v_lshlrev_b32 v242, 16, v250
v_and_b32 v248, 0xffff0000, v250
v_mul_f32 v242, v242, v237
v_mul_f32 v248, v248, v237
v_cvt_pk_bf16_f32 v250, v242, v248
v_lshlrev_b32 v242, 16, v251
v_and_b32 v248, 0xffff0000, v251
v_mul_f32 v242, v242, v237
v_mul_f32 v248, v248, v237
v_cvt_pk_bf16_f32 v251, v242, v248
ds_write_b64 v231, v[250:251] offset:1024
s_waitcnt lgkmcnt(0)
ds_read_b64 v[250:251], v231 offset:1032
s_waitcnt lgkmcnt(0)
v_lshlrev_b32 v242, 16, v250
v_and_b32 v248, 0xffff0000, v250
v_mul_f32 v242, v242, v237
v_mul_f32 v248, v248, v237
v_cvt_pk_bf16_f32 v250, v242, v248
v_lshlrev_b32 v242, 16, v251
v_and_b32 v248, 0xffff0000, v251
v_mul_f32 v242, v242, v237
v_mul_f32 v248, v248, v237
v_cvt_pk_bf16_f32 v251, v242, v248
ds_write_b64 v231, v[250:251] offset:1032
s_waitcnt lgkmcnt(0)
ds_read_b64 v[250:251], v231 offset:5120
s_waitcnt lgkmcnt(0)
v_lshlrev_b32 v242, 16, v250
v_and_b32 v248, 0xffff0000, v250
v_mul_f32 v242, v242, v237
v_mul_f32 v248, v248, v237
v_cvt_pk_bf16_f32 v250, v242, v248
v_lshlrev_b32 v242, 16, v251
v_and_b32 v248, 0xffff0000, v251
v_mul_f32 v242, v242, v237
v_mul_f32 v248, v248, v237
v_cvt_pk_bf16_f32 v251, v242, v248
ds_write_b64 v231, v[250:251] offset:5120
s_waitcnt lgkmcnt(0)
ds_read_b64 v[250:251], v231 offset:5128
s_waitcnt lgkmcnt(0)
v_lshlrev_b32 v242, 16, v250
v_and_b32 v248, 0xffff0000, v250
v_mul_f32 v242, v242, v237
v_mul_f32 v248, v248, v237
v_cvt_pk_bf16_f32 v250, v242, v248
v_lshlrev_b32 v242, 16, v251
v_and_b32 v248, 0xffff0000, v251
v_mul_f32 v242, v242, v237
v_mul_f32 v248, v248, v237
v_cvt_pk_bf16_f32 v251, v242, v248
ds_write_b64 v231, v[250:251] offset:5128
s_waitcnt lgkmcnt(0)
v_exp_f32 v248, v136
s_nop 0
v_sub_f32 v226, v226, v248
v_exp_f32 v248, v137
s_nop 0
v_sub_f32 v226, v226, v248
v_exp_f32 v248, v138
s_nop 0
v_sub_f32 v226, v226, v248
v_exp_f32 v248, v139
s_nop 0
v_sub_f32 v226, v226, v248
v_max_f32 v226, 0, v226
v_min_f32 v226, s32, v226
v_log_f32 v248, v226
v_max3_f32 v234, v136, v137, v138
v_max3_f32 v234, v234, v139, v248
v_mov_b32 v248, v234
s_nop 1
v_permlane32_swap_b32 v234, v248
s_nop 1
v_max_f32 v234, v234, v248
v_mov_b32 v248, v234
s_nop 1
v_permlane16_swap_b32 v234, v248
s_nop 1
v_max_f32 v234, v234, v248
v_ceil_f32 v234, v234
v_max_f32 v234, 0, v234
v_sub_f32 v248, 0, v234
v_exp_f32 v238, v248
s_nop 1
v_mul_f32 v226, v226, v238
v_sub_f32 v200, v200, v234
v_sub_f32 v136, v136, v234
v_sub_f32 v152, v152, v234
v_sub_f32 v201, v201, v234
v_sub_f32 v137, v137, v234
v_sub_f32 v153, v153, v234
v_sub_f32 v202, v202, v234
v_sub_f32 v138, v138, v234
v_sub_f32 v154, v154, v234
v_sub_f32 v203, v203, v234
v_sub_f32 v139, v139, v234
v_sub_f32 v155, v155, v234
v_lshlrev_b32 v242, 16, v184
v_and_b32 v248, 0xffff0000, v184
v_mul_f32 v242, v242, v238
v_mul_f32 v248, v248, v238
v_cvt_pk_bf16_f32 v184, v242, v248
v_lshlrev_b32 v242, 16, v185
v_and_b32 v248, 0xffff0000, v185
v_mul_f32 v242, v242, v238
v_mul_f32 v248, v248, v238
v_cvt_pk_bf16_f32 v185, v242, v248
v_lshlrev_b32 v242, 16, v186
v_and_b32 v248, 0xffff0000, v186
v_mul_f32 v242, v242, v238
v_mul_f32 v248, v248, v238
v_cvt_pk_bf16_f32 v186, v242, v248
v_lshlrev_b32 v242, 16, v187
v_and_b32 v248, 0xffff0000, v187
v_mul_f32 v242, v242, v238
v_mul_f32 v248, v248, v238
v_cvt_pk_bf16_f32 v187, v242, v248
ds_read_b64 v[250:251], v231 offset:2048
s_waitcnt lgkmcnt(0)
v_lshlrev_b32 v242, 16, v250
v_and_b32 v248, 0xffff0000, v250
v_mul_f32 v242, v242, v238
v_mul_f32 v248, v248, v238
v_cvt_pk_bf16_f32 v250, v242, v248
v_lshlrev_b32 v242, 16, v251
v_and_b32 v248, 0xffff0000, v251
v_mul_f32 v242, v242, v238
v_mul_f32 v248, v248, v238
v_cvt_pk_bf16_f32 v251, v242, v248
ds_write_b64 v231, v[250:251] offset:2048
s_waitcnt lgkmcnt(0)
ds_read_b64 v[250:251], v231 offset:2056
s_waitcnt lgkmcnt(0)
v_lshlrev_b32 v242, 16, v250
v_and_b32 v248, 0xffff0000, v250
v_mul_f32 v242, v242, v238
v_mul_f32 v248, v248, v238
v_cvt_pk_bf16_f32 v250, v242, v248
v_lshlrev_b32 v242, 16, v251
v_and_b32 v248, 0xffff0000, v251
v_mul_f32 v242, v242, v238
v_mul_f32 v248, v248, v238
v_cvt_pk_bf16_f32 v251, v242, v248
ds_write_b64 v231, v[250:251] offset:2056
s_waitcnt lgkmcnt(0)
ds_read_b64 v[250:251], v231 offset:6144
s_waitcnt lgkmcnt(0)
v_lshlrev_b32 v242, 16, v250
v_and_b32 v248, 0xffff0000, v250
v_mul_f32 v242, v242, v238
v_mul_f32 v248, v248, v238
v_cvt_pk_bf16_f32 v250, v242, v248
v_lshlrev_b32 v242, 16, v251
v_and_b32 v248, 0xffff0000, v251
v_mul_f32 v242, v242, v238
v_mul_f32 v248, v248, v238
v_cvt_pk_bf16_f32 v251, v242, v248
ds_write_b64 v231, v[250:251] offset:6144
s_waitcnt lgkmcnt(0)
ds_read_b64 v[250:251], v231 offset:6152
s_waitcnt lgkmcnt(0)
v_lshlrev_b32 v242, 16, v250
v_and_b32 v248, 0xffff0000, v250
v_mul_f32 v242, v242, v238
v_mul_f32 v248, v248, v238
v_cvt_pk_bf16_f32 v250, v242, v248
v_lshlrev_b32 v242, 16, v251
v_and_b32 v248, 0xffff0000, v251
v_mul_f32 v242, v242, v238
v_mul_f32 v248, v248, v238
v_cvt_pk_bf16_f32 v251, v242, v248
ds_write_b64 v231, v[250:251] offset:6152
s_waitcnt lgkmcnt(0)
v_exp_f32 v248, v140
s_nop 0
v_sub_f32 v227, v227, v248
v_exp_f32 v248, v141
s_nop 0
v_sub_f32 v227, v227, v248
v_exp_f32 v248, v142
s_nop 0
v_sub_f32 v227, v227, v248
v_exp_f32 v248, v143
s_nop 0
v_sub_f32 v227, v227, v248
v_max_f32 v227, 0, v227
v_min_f32 v227, s32, v227
v_log_f32 v248, v227
v_max3_f32 v235, v140, v141, v142
v_max3_f32 v235, v235, v143, v248
v_mov_b32 v248, v235
s_nop 1
v_permlane32_swap_b32 v235, v248
s_nop 1
v_max_f32 v235, v235, v248
v_mov_b32 v248, v235
s_nop 1
v_permlane16_swap_b32 v235, v248
s_nop 1
v_max_f32 v235, v235, v248
v_ceil_f32 v235, v235
v_max_f32 v235, 0, v235
v_sub_f32 v248, 0, v235
v_exp_f32 v239, v248
s_nop 1
v_mul_f32 v227, v227, v239
v_sub_f32 v204, v204, v235
v_sub_f32 v140, v140, v235
v_sub_f32 v156, v156, v235
v_sub_f32 v205, v205, v235
v_sub_f32 v141, v141, v235
v_sub_f32 v157, v157, v235
v_sub_f32 v206, v206, v235
v_sub_f32 v142, v142, v235
v_sub_f32 v158, v158, v235
v_sub_f32 v207, v207, v235
v_sub_f32 v143, v143, v235
v_sub_f32 v159, v159, v235
v_lshlrev_b32 v242, 16, v188
v_and_b32 v248, 0xffff0000, v188
v_mul_f32 v242, v242, v239
v_mul_f32 v248, v248, v239
v_cvt_pk_bf16_f32 v188, v242, v248
v_lshlrev_b32 v242, 16, v189
v_and_b32 v248, 0xffff0000, v189
v_mul_f32 v242, v242, v239
v_mul_f32 v248, v248, v239
v_cvt_pk_bf16_f32 v189, v242, v248
v_lshlrev_b32 v242, 16, v190
v_and_b32 v248, 0xffff0000, v190
v_mul_f32 v242, v242, v239
v_mul_f32 v248, v248, v239
v_cvt_pk_bf16_f32 v190, v242, v248
v_lshlrev_b32 v242, 16, v191
v_and_b32 v248, 0xffff0000, v191
v_mul_f32 v242, v242, v239
v_mul_f32 v248, v248, v239
v_cvt_pk_bf16_f32 v191, v242, v248
ds_read_b64 v[250:251], v231 offset:3072
s_waitcnt lgkmcnt(0)
v_lshlrev_b32 v242, 16, v250
v_and_b32 v248, 0xffff0000, v250
v_mul_f32 v242, v242, v239
v_mul_f32 v248, v248, v239
v_cvt_pk_bf16_f32 v250, v242, v248
v_lshlrev_b32 v242, 16, v251
v_and_b32 v248, 0xffff0000, v251
v_mul_f32 v242, v242, v239
v_mul_f32 v248, v248, v239
v_cvt_pk_bf16_f32 v251, v242, v248
ds_write_b64 v231, v[250:251] offset:3072
s_waitcnt lgkmcnt(0)
ds_read_b64 v[250:251], v231 offset:3080
s_waitcnt lgkmcnt(0)
v_lshlrev_b32 v242, 16, v250
v_and_b32 v248, 0xffff0000, v250
v_mul_f32 v242, v242, v239
v_mul_f32 v248, v248, v239
v_cvt_pk_bf16_f32 v250, v242, v248
v_lshlrev_b32 v242, 16, v251
v_and_b32 v248, 0xffff0000, v251
v_mul_f32 v242, v242, v239
v_mul_f32 v248, v248, v239
v_cvt_pk_bf16_f32 v251, v242, v248
ds_write_b64 v231, v[250:251] offset:3080
s_waitcnt lgkmcnt(0)
ds_read_b64 v[250:251], v231 offset:7168
s_waitcnt lgkmcnt(0)
v_lshlrev_b32 v242, 16, v250
v_and_b32 v248, 0xffff0000, v250
v_mul_f32 v242, v242, v239
v_mul_f32 v248, v248, v239
v_cvt_pk_bf16_f32 v250, v242, v248
v_lshlrev_b32 v242, 16, v251
v_and_b32 v248, 0xffff0000, v251
v_mul_f32 v242, v242, v239
v_mul_f32 v248, v248, v239
v_cvt_pk_bf16_f32 v251, v242, v248
ds_write_b64 v231, v[250:251] offset:7168
s_waitcnt lgkmcnt(0)
ds_read_b64 v[250:251], v231 offset:7176
s_waitcnt lgkmcnt(0)
v_lshlrev_b32 v242, 16, v250
v_and_b32 v248, 0xffff0000, v250
v_mul_f32 v242, v242, v239
v_mul_f32 v248, v248, v239
v_cvt_pk_bf16_f32 v250, v242, v248
v_lshlrev_b32 v242, 16, v251
v_and_b32 v248, 0xffff0000, v251
v_mul_f32 v242, v242, v239
v_mul_f32 v248, v248, v239
v_cvt_pk_bf16_f32 v251, v242, v248
ds_write_b64 v231, v[250:251] offset:7176
s_waitcnt lgkmcnt(0)
v_exp_f32 v232, v128
v_exp_f32 v233, v129
v_exp_f32 v234, v130
v_exp_f32 v235, v131
s_nop 1
v_add_f32 v224, v224, v232
v_add_f32 v224, v224, v233
v_add_f32 v224, v224, v234
v_add_f32 v224, v224, v235
v_cvt_pk_bf16_f32 v160, v232, v233
v_cvt_pk_bf16_f32 v161, v234, v235
v_exp_f32 v232, v132
v_exp_f32 v233, v133
v_exp_f32 v234, v134
v_exp_f32 v235, v135
s_nop 1
v_add_f32 v225, v225, v232
v_add_f32 v225, v225, v233
v_add_f32 v225, v225, v234
v_add_f32 v225, v225, v235
v_cvt_pk_bf16_f32 v164, v232, v233
v_cvt_pk_bf16_f32 v165, v234, v235
v_exp_f32 v232, v136
v_exp_f32 v233, v137
v_exp_f32 v234, v138
v_exp_f32 v235, v139
s_nop 1
v_add_f32 v226, v226, v232
v_add_f32 v226, v226, v233
v_add_f32 v226, v226, v234
v_add_f32 v226, v226, v235
v_cvt_pk_bf16_f32 v168, v232, v233
v_cvt_pk_bf16_f32 v169, v234, v235
v_exp_f32 v232, v140
v_exp_f32 v233, v141
v_exp_f32 v234, v142
v_exp_f32 v235, v143
s_nop 1
v_add_f32 v227, v227, v232
v_add_f32 v227, v227, v233
v_add_f32 v227, v227, v234
v_add_f32 v227, v227, v235
v_cvt_pk_bf16_f32 v172, v232, v233
v_cvt_pk_bf16_f32 v173, v234, v235
s_branch L2_rare_common
L2_rare_site9:
s_mov_b32 s36, 9
s_branch L2_rare_t1_3_1
L2_rare_t1_3_1:
s_nop 15
s_nop 15
s_waitcnt lgkmcnt(0)
v_exp_f32 v248, v144
s_nop 0
v_sub_f32 v224, v224, v248
v_exp_f32 v248, v145
s_nop 0
v_sub_f32 v224, v224, v248
v_exp_f32 v248, v146
s_nop 0
v_sub_f32 v224, v224, v248
v_exp_f32 v248, v147
s_nop 0
v_sub_f32 v224, v224, v248
v_max_f32 v224, 0, v224
v_min_f32 v224, s32, v224
v_log_f32 v248, v224
v_max3_f32 v232, v144, v145, v146
v_max3_f32 v232, v232, v147, v248
v_mov_b32 v248, v232
s_nop 1
v_permlane32_swap_b32 v232, v248
s_nop 1
v_max_f32 v232, v232, v248
v_mov_b32 v248, v232
s_nop 1
v_permlane16_swap_b32 v232, v248
s_nop 1
v_max_f32 v232, v232, v248
v_ceil_f32 v232, v232
v_max_f32 v232, 0, v232
v_sub_f32 v248, 0, v232
v_exp_f32 v236, v248
s_nop 1
v_mul_f32 v224, v224, v236
v_sub_f32 v192, v192, v232
v_sub_f32 v144, v144, v232
v_sub_f32 v128, v128, v232
v_sub_f32 v193, v193, v232
v_sub_f32 v145, v145, v232
v_sub_f32 v129, v129, v232
v_sub_f32 v194, v194, v232
v_sub_f32 v146, v146, v232
v_sub_f32 v130, v130, v232
v_sub_f32 v195, v195, v232
v_sub_f32 v147, v147, v232
v_sub_f32 v131, v131, v232
v_lshlrev_b32 v242, 16, v176
v_and_b32 v248, 0xffff0000, v176
v_mul_f32 v242, v242, v236
v_mul_f32 v248, v248, v236
v_cvt_pk_bf16_f32 v176, v242, v248
v_lshlrev_b32 v242, 16, v177
v_and_b32 v248, 0xffff0000, v177
v_mul_f32 v242, v242, v236
v_mul_f32 v248, v248, v236
v_cvt_pk_bf16_f32 v177, v242, v248
v_lshlrev_b32 v242, 16, v178
v_and_b32 v248, 0xffff0000, v178
v_mul_f32 v242, v242, v236
v_mul_f32 v248, v248, v236
v_cvt_pk_bf16_f32 v178, v242, v248
v_lshlrev_b32 v242, 16, v179
v_and_b32 v248, 0xffff0000, v179
v_mul_f32 v242, v242, v236
v_mul_f32 v248, v248, v236
v_cvt_pk_bf16_f32 v179, v242, v248
v_lshlrev_b32 v242, 16, v160
v_and_b32 v248, 0xffff0000, v160
v_mul_f32 v242, v242, v236
v_mul_f32 v248, v248, v236
v_cvt_pk_bf16_f32 v160, v242, v248
v_lshlrev_b32 v242, 16, v161
v_and_b32 v248, 0xffff0000, v161
v_mul_f32 v242, v242, v236
v_mul_f32 v248, v248, v236
v_cvt_pk_bf16_f32 v161, v242, v248
ds_read_b64 v[250:251], v231 offset:0
s_waitcnt lgkmcnt(0)
v_lshlrev_b32 v242, 16, v250
v_and_b32 v248, 0xffff0000, v250
v_mul_f32 v242, v242, v236
v_mul_f32 v248, v248, v236
v_cvt_pk_bf16_f32 v250, v242, v248
v_lshlrev_b32 v242, 16, v251
v_and_b32 v248, 0xffff0000, v251
v_mul_f32 v242, v242, v236
v_mul_f32 v248, v248, v236
v_cvt_pk_bf16_f32 v251, v242, v248
ds_write_b64 v231, v[250:251] offset:0
s_waitcnt lgkmcnt(0)
ds_read_b64 v[250:251], v231 offset:8
s_waitcnt lgkmcnt(0)
v_lshlrev_b32 v242, 16, v250
v_and_b32 v248, 0xffff0000, v250
v_mul_f32 v242, v242, v236
v_mul_f32 v248, v248, v236
v_cvt_pk_bf16_f32 v250, v242, v248
v_lshlrev_b32 v242, 16, v251
v_and_b32 v248, 0xffff0000, v251
v_mul_f32 v242, v242, v236
v_mul_f32 v248, v248, v236
v_cvt_pk_bf16_f32 v251, v242, v248
ds_write_b64 v231, v[250:251] offset:8
s_waitcnt lgkmcnt(0)
ds_read_b64 v[250:251], v231 offset:4096
s_waitcnt lgkmcnt(0)
v_lshlrev_b32 v242, 16, v250
v_and_b32 v248, 0xffff0000, v250
v_mul_f32 v242, v242, v236
v_mul_f32 v248, v248, v236
v_cvt_pk_bf16_f32 v250, v242, v248
v_lshlrev_b32 v242, 16, v251
v_and_b32 v248, 0xffff0000, v251
v_mul_f32 v242, v242, v236
v_mul_f32 v248, v248, v236
v_cvt_pk_bf16_f32 v251, v242, v248
ds_write_b64 v231, v[250:251] offset:4096
s_waitcnt lgkmcnt(0)
ds_read_b64 v[250:251], v231 offset:4104
s_waitcnt lgkmcnt(0)
v_lshlrev_b32 v242, 16, v250
v_and_b32 v248, 0xffff0000, v250
v_mul_f32 v242, v242, v236
v_mul_f32 v248, v248, v236
v_cvt_pk_bf16_f32 v250, v242, v248
v_lshlrev_b32 v242, 16, v251
v_and_b32 v248, 0xffff0000, v251
v_mul_f32 v242, v242, v236
v_mul_f32 v248, v248, v236
v_cvt_pk_bf16_f32 v251, v242, v248
ds_write_b64 v231, v[250:251] offset:4104
s_waitcnt lgkmcnt(0)
v_exp_f32 v248, v148
s_nop 0
v_sub_f32 v225, v225, v248
v_exp_f32 v248, v149
s_nop 0
v_sub_f32 v225, v225, v248
v_exp_f32 v248, v150
s_nop 0
v_sub_f32 v225, v225, v248
v_exp_f32 v248, v151
s_nop 0
v_sub_f32 v225, v225, v248
v_max_f32 v225, 0, v225
v_min_f32 v225, s32, v225
v_log_f32 v248, v225
v_max3_f32 v233, v148, v149, v150
v_max3_f32 v233, v233, v151, v248
v_mov_b32 v248, v233
s_nop 1
v_permlane32_swap_b32 v233, v248
s_nop 1
v_max_f32 v233, v233, v248
v_mov_b32 v248, v233
s_nop 1
v_permlane16_swap_b32 v233, v248
s_nop 1
v_max_f32 v233, v233, v248
v_ceil_f32 v233, v233
v_max_f32 v233, 0, v233
v_sub_f32 v248, 0, v233
v_exp_f32 v237, v248
s_nop 1
v_mul_f32 v225, v225, v237
v_sub_f32 v196, v196, v233
v_sub_f32 v148, v148, v233
v_sub_f32 v132, v132, v233
v_sub_f32 v197, v197, v233
v_sub_f32 v149, v149, v233
v_sub_f32 v133, v133, v233
v_sub_f32 v198, v198, v233
v_sub_f32 v150, v150, v233
v_sub_f32 v134, v134, v233
v_sub_f32 v199, v199, v233
v_sub_f32 v151, v151, v233
v_sub_f32 v135, v135, v233
v_lshlrev_b32 v242, 16, v180
v_and_b32 v248, 0xffff0000, v180
v_mul_f32 v242, v242, v237
v_mul_f32 v248, v248, v237
v_cvt_pk_bf16_f32 v180, v242, v248
v_lshlrev_b32 v242, 16, v181
v_and_b32 v248, 0xffff0000, v181
v_mul_f32 v242, v242, v237
v_mul_f32 v248, v248, v237
v_cvt_pk_bf16_f32 v181, v242, v248
v_lshlrev_b32 v242, 16, v182
v_and_b32 v248, 0xffff0000, v182
v_mul_f32 v242, v242, v237
v_mul_f32 v248, v248, v237
v_cvt_pk_bf16_f32 v182, v242, v248
v_lshlrev_b32 v242, 16, v183
v_and_b32 v248, 0xffff0000, v183
v_mul_f32 v242, v242, v237
v_mul_f32 v248, v248, v237
v_cvt_pk_bf16_f32 v183, v242, v248
v_lshlrev_b32 v242, 16, v164
v_and_b32 v248, 0xffff0000, v164
v_mul_f32 v242, v242, v237
v_mul_f32 v248, v248, v237
v_cvt_pk_bf16_f32 v164, v242, v248
v_lshlrev_b32 v242, 16, v165
v_and_b32 v248, 0xffff0000, v165
v_mul_f32 v242, v242, v237
v_mul_f32 v248, v248, v237
v_cvt_pk_bf16_f32 v165, v242, v248
ds_read_b64 v[250:251], v231 offset:1024
s_waitcnt lgkmcnt(0)
v_lshlrev_b32 v242, 16, v250
v_and_b32 v248, 0xffff0000, v250
v_mul_f32 v242, v242, v237
v_mul_f32 v248, v248, v237
v_cvt_pk_bf16_f32 v250, v242, v248
v_lshlrev_b32 v242, 16, v251
v_and_b32 v248, 0xffff0000, v251
v_mul_f32 v242, v242, v237
v_mul_f32 v248, v248, v237
v_cvt_pk_bf16_f32 v251, v242, v248
ds_write_b64 v231, v[250:251] offset:1024
s_waitcnt lgkmcnt(0)
ds_read_b64 v[250:251], v231 offset:1032
s_waitcnt lgkmcnt(0)
v_lshlrev_b32 v242, 16, v250
v_and_b32 v248, 0xffff0000, v250
v_mul_f32 v242, v242, v237
v_mul_f32 v248, v248, v237
v_cvt_pk_bf16_f32 v250, v242, v248
v_lshlrev_b32 v242, 16, v251
v_and_b32 v248, 0xffff0000, v251
v_mul_f32 v242, v242, v237
v_mul_f32 v248, v248, v237
v_cvt_pk_bf16_f32 v251, v242, v248
ds_write_b64 v231, v[250:251] offset:1032
s_waitcnt lgkmcnt(0)
ds_read_b64 v[250:251], v231 offset:5120
s_waitcnt lgkmcnt(0)
v_lshlrev_b32 v242, 16, v250
v_and_b32 v248, 0xffff0000, v250
v_mul_f32 v242, v242, v237
v_mul_f32 v248, v248, v237
v_cvt_pk_bf16_f32 v250, v242, v248
v_lshlrev_b32 v242, 16, v251
v_and_b32 v248, 0xffff0000, v251
v_mul_f32 v242, v242, v237
v_mul_f32 v248, v248, v237
v_cvt_pk_bf16_f32 v251, v242, v248
ds_write_b64 v231, v[250:251] offset:5120
s_waitcnt lgkmcnt(0)
ds_read_b64 v[250:251], v231 offset:5128
s_waitcnt lgkmcnt(0)
v_lshlrev_b32 v242, 16, v250
v_and_b32 v248, 0xffff0000, v250
v_mul_f32 v242, v242, v237
v_mul_f32 v248, v248, v237
v_cvt_pk_bf16_f32 v250, v242, v248
v_lshlrev_b32 v242, 16, v251
v_and_b32 v248, 0xffff0000, v251
v_mul_f32 v242, v242, v237
v_mul_f32 v248, v248, v237
v_cvt_pk_bf16_f32 v251, v242, v248
ds_write_b64 v231, v[250:251] offset:5128
s_waitcnt lgkmcnt(0)
v_exp_f32 v248, v152
s_nop 0
v_sub_f32 v226, v226, v248
v_exp_f32 v248, v153
s_nop 0
v_sub_f32 v226, v226, v248
v_exp_f32 v248, v154
s_nop 0
v_sub_f32 v226, v226, v248
v_exp_f32 v248, v155
s_nop 0
v_sub_f32 v226, v226, v248
v_max_f32 v226, 0, v226
v_min_f32 v226, s32, v226
v_log_f32 v248, v226
v_max3_f32 v234, v152, v153, v154
v_max3_f32 v234, v234, v155, v248
v_mov_b32 v248, v234
s_nop 1
v_permlane32_swap_b32 v234, v248
s_nop 1
v_max_f32 v234, v234, v248
v_mov_b32 v248, v234
s_nop 1
v_permlane16_swap_b32 v234, v248
s_nop 1
v_max_f32 v234, v234, v248
v_ceil_f32 v234, v234
v_max_f32 v234, 0, v234
v_sub_f32 v248, 0, v234
v_exp_f32 v238, v248
s_nop 1
v_mul_f32 v226, v226, v238
v_sub_f32 v200, v200, v234
v_sub_f32 v152, v152, v234
v_sub_f32 v136, v136, v234
v_sub_f32 v201, v201, v234
v_sub_f32 v153, v153, v234
v_sub_f32 v137, v137, v234
v_sub_f32 v202, v202, v234
v_sub_f32 v154, v154, v234
v_sub_f32 v138, v138, v234
v_sub_f32 v203, v203, v234
v_sub_f32 v155, v155, v234
v_sub_f32 v139, v139, v234
v_lshlrev_b32 v242, 16, v184
v_and_b32 v248, 0xffff0000, v184
v_mul_f32 v242, v242, v238
v_mul_f32 v248, v248, v238
v_cvt_pk_bf16_f32 v184, v242, v248
v_lshlrev_b32 v242, 16, v185
v_and_b32 v248, 0xffff0000, v185
v_mul_f32 v242, v242, v238
v_mul_f32 v248, v248, v238
v_cvt_pk_bf16_f32 v185, v242, v248
v_lshlrev_b32 v242, 16, v186
v_and_b32 v248, 0xffff0000, v186
v_mul_f32 v242, v242, v238
v_mul_f32 v248, v248, v238
v_cvt_pk_bf16_f32 v186, v242, v248
v_lshlrev_b32 v242, 16, v187
v_and_b32 v248, 0xffff0000, v187
v_mul_f32 v242, v242, v238
v_mul_f32 v248, v248, v238
v_cvt_pk_bf16_f32 v187, v242, v248
v_lshlrev_b32 v242, 16, v168
v_and_b32 v248, 0xffff0000, v168
v_mul_f32 v242, v242, v238
v_mul_f32 v248, v248, v238
v_cvt_pk_bf16_f32 v168, v242, v248
v_lshlrev_b32 v242, 16, v169
v_and_b32 v248, 0xffff0000, v169
v_mul_f32 v242, v242, v238
v_mul_f32 v248, v248, v238
v_cvt_pk_bf16_f32 v169, v242, v248
ds_read_b64 v[250:251], v231 offset:2048
s_waitcnt lgkmcnt(0)
v_lshlrev_b32 v242, 16, v250
v_and_b32 v248, 0xffff0000, v250
v_mul_f32 v242, v242, v238
v_mul_f32 v248, v248, v238
v_cvt_pk_bf16_f32 v250, v242, v248
v_lshlrev_b32 v242, 16, v251
v_and_b32 v248, 0xffff0000, v251
v_mul_f32 v242, v242, v238
v_mul_f32 v248, v248, v238
v_cvt_pk_bf16_f32 v251, v242, v248
ds_write_b64 v231, v[250:251] offset:2048
s_waitcnt lgkmcnt(0)
ds_read_b64 v[250:251], v231 offset:2056
s_waitcnt lgkmcnt(0)
v_lshlrev_b32 v242, 16, v250
v_and_b32 v248, 0xffff0000, v250
v_mul_f32 v242, v242, v238
v_mul_f32 v248, v248, v238
v_cvt_pk_bf16_f32 v250, v242, v248
v_lshlrev_b32 v242, 16, v251
v_and_b32 v248, 0xffff0000, v251
v_mul_f32 v242, v242, v238
v_mul_f32 v248, v248, v238
v_cvt_pk_bf16_f32 v251, v242, v248
ds_write_b64 v231, v[250:251] offset:2056
s_waitcnt lgkmcnt(0)
ds_read_b64 v[250:251], v231 offset:6144
s_waitcnt lgkmcnt(0)
v_lshlrev_b32 v242, 16, v250
v_and_b32 v248, 0xffff0000, v250
v_mul_f32 v242, v242, v238
v_mul_f32 v248, v248, v238
v_cvt_pk_bf16_f32 v250, v242, v248
v_lshlrev_b32 v242, 16, v251
v_and_b32 v248, 0xffff0000, v251
v_mul_f32 v242, v242, v238
v_mul_f32 v248, v248, v238
v_cvt_pk_bf16_f32 v251, v242, v248
ds_write_b64 v231, v[250:251] offset:6144
s_waitcnt lgkmcnt(0)
ds_read_b64 v[250:251], v231 offset:6152
s_waitcnt lgkmcnt(0)
v_lshlrev_b32 v242, 16, v250
v_and_b32 v248, 0xffff0000, v250
v_mul_f32 v242, v242, v238
v_mul_f32 v248, v248, v238
v_cvt_pk_bf16_f32 v250, v242, v248
v_lshlrev_b32 v242, 16, v251
v_and_b32 v248, 0xffff0000, v251
v_mul_f32 v242, v242, v238
v_mul_f32 v248, v248, v238
v_cvt_pk_bf16_f32 v251, v242, v248
ds_write_b64 v231, v[250:251] offset:6152
s_waitcnt lgkmcnt(0)
v_exp_f32 v248, v156
s_nop 0
v_sub_f32 v227, v227, v248
v_exp_f32 v248, v157
s_nop 0
v_sub_f32 v227, v227, v248
v_exp_f32 v248, v158
s_nop 0
v_sub_f32 v227, v227, v248
v_exp_f32 v248, v159
s_nop 0
v_sub_f32 v227, v227, v248
v_max_f32 v227, 0, v227
v_min_f32 v227, s32, v227
v_log_f32 v248, v227
v_max3_f32 v235, v156, v157, v158
v_max3_f32 v235, v235, v159, v248
v_mov_b32 v248, v235
s_nop 1
v_permlane32_swap_b32 v235, v248
s_nop 1
v_max_f32 v235, v235, v248
v_mov_b32 v248, v235
s_nop 1
v_permlane16_swap_b32 v235, v248
s_nop 1
v_max_f32 v235, v235, v248
v_ceil_f32 v235, v235
v_max_f32 v235, 0, v235
v_sub_f32 v248, 0, v235
v_exp_f32 v239, v248
s_nop 1
v_mul_f32 v227, v227, v239
v_sub_f32 v204, v204, v235
v_sub_f32 v156, v156, v235
v_sub_f32 v140, v140, v235
v_sub_f32 v205, v205, v235
v_sub_f32 v157, v157, v235
v_sub_f32 v141, v141, v235
v_sub_f32 v206, v206, v235
v_sub_f32 v158, v158, v235
v_sub_f32 v142, v142, v235
v_sub_f32 v207, v207, v235
v_sub_f32 v159, v159, v235
v_sub_f32 v143, v143, v235
v_lshlrev_b32 v242, 16, v188
v_and_b32 v248, 0xffff0000, v188
v_mul_f32 v242, v242, v239
v_mul_f32 v248, v248, v239
v_cvt_pk_bf16_f32 v188, v242, v248
v_lshlrev_b32 v242, 16, v189
v_and_b32 v248, 0xffff0000, v189
v_mul_f32 v242, v242, v239
v_mul_f32 v248, v248, v239
v_cvt_pk_bf16_f32 v189, v242, v248
v_lshlrev_b32 v242, 16, v190
v_and_b32 v248, 0xffff0000, v190
v_mul_f32 v242, v242, v239
v_mul_f32 v248, v248, v239
v_cvt_pk_bf16_f32 v190, v242, v248
v_lshlrev_b32 v242, 16, v191
v_and_b32 v248, 0xffff0000, v191
v_mul_f32 v242, v242, v239
v_mul_f32 v248, v248, v239
v_cvt_pk_bf16_f32 v191, v242, v248
v_lshlrev_b32 v242, 16, v172
v_and_b32 v248, 0xffff0000, v172
v_mul_f32 v242, v242, v239
v_mul_f32 v248, v248, v239
v_cvt_pk_bf16_f32 v172, v242, v248
v_lshlrev_b32 v242, 16, v173
v_and_b32 v248, 0xffff0000, v173
v_mul_f32 v242, v242, v239
v_mul_f32 v248, v248, v239
v_cvt_pk_bf16_f32 v173, v242, v248
ds_read_b64 v[250:251], v231 offset:3072
s_waitcnt lgkmcnt(0)
v_lshlrev_b32 v242, 16, v250
v_and_b32 v248, 0xffff0000, v250
v_mul_f32 v242, v242, v239
v_mul_f32 v248, v248, v239
v_cvt_pk_bf16_f32 v250, v242, v248
v_lshlrev_b32 v242, 16, v251
v_and_b32 v248, 0xffff0000, v251
v_mul_f32 v242, v242, v239
v_mul_f32 v248, v248, v239
v_cvt_pk_bf16_f32 v251, v242, v248
ds_write_b64 v231, v[250:251] offset:3072
s_waitcnt lgkmcnt(0)
ds_read_b64 v[250:251], v231 offset:3080
s_waitcnt lgkmcnt(0)
v_lshlrev_b32 v242, 16, v250
v_and_b32 v248, 0xffff0000, v250
v_mul_f32 v242, v242, v239
v_mul_f32 v248, v248, v239
v_cvt_pk_bf16_f32 v250, v242, v248
v_lshlrev_b32 v242, 16, v251
v_and_b32 v248, 0xffff0000, v251
v_mul_f32 v242, v242, v239
v_mul_f32 v248, v248, v239
v_cvt_pk_bf16_f32 v251, v242, v248
ds_write_b64 v231, v[250:251] offset:3080
s_waitcnt lgkmcnt(0)
ds_read_b64 v[250:251], v231 offset:7168
s_waitcnt lgkmcnt(0)
v_lshlrev_b32 v242, 16, v250
v_and_b32 v248, 0xffff0000, v250
v_mul_f32 v242, v242, v239
v_mul_f32 v248, v248, v239
v_cvt_pk_bf16_f32 v250, v242, v248
v_lshlrev_b32 v242, 16, v251
v_and_b32 v248, 0xffff0000, v251
v_mul_f32 v242, v242, v239
v_mul_f32 v248, v248, v239
v_cvt_pk_bf16_f32 v251, v242, v248
ds_write_b64 v231, v[250:251] offset:7168
s_waitcnt lgkmcnt(0)
ds_read_b64 v[250:251], v231 offset:7176
s_waitcnt lgkmcnt(0)
v_lshlrev_b32 v242, 16, v250
v_and_b32 v248, 0xffff0000, v250
v_mul_f32 v242, v242, v239
v_mul_f32 v248, v248, v239
v_cvt_pk_bf16_f32 v250, v242, v248
v_lshlrev_b32 v242, 16, v251
v_and_b32 v248, 0xffff0000, v251
v_mul_f32 v242, v242, v239
v_mul_f32 v248, v248, v239
v_cvt_pk_bf16_f32 v251, v242, v248
ds_write_b64 v231, v[250:251] offset:7176
s_waitcnt lgkmcnt(0)
v_exp_f32 v232, v144
v_exp_f32 v233, v145
v_exp_f32 v234, v146
v_exp_f32 v235, v147
s_nop 1
v_add_f32 v224, v224, v232
v_add_f32 v224, v224, v233
v_add_f32 v224, v224, v234
v_add_f32 v224, v224, v235
v_cvt_pk_bf16_f32 v162, v232, v233
v_cvt_pk_bf16_f32 v163, v234, v235
v_exp_f32 v232, v148
v_exp_f32 v233, v149
v_exp_f32 v234, v150
v_exp_f32 v235, v151
s_nop 1
v_add_f32 v225, v225, v232
v_add_f32 v225, v225, v233
v_add_f32 v225, v225, v234
v_add_f32 v225, v225, v235
v_cvt_pk_bf16_f32 v166, v232, v233
v_cvt_pk_bf16_f32 v167, v234, v235
v_exp_f32 v232, v152
v_exp_f32 v233, v153
v_exp_f32 v234, v154
v_exp_f32 v235, v155
s_nop 1
v_add_f32 v226, v226, v232
v_add_f32 v226, v226, v233
v_add_f32 v226, v226, v234
v_add_f32 v226, v226, v235
v_cvt_pk_bf16_f32 v170, v232, v233
v_cvt_pk_bf16_f32 v171, v234, v235
v_exp_f32 v232, v156
v_exp_f32 v233, v157
v_exp_f32 v234, v158
v_exp_f32 v235, v159
s_nop 1
v_add_f32 v227, v227, v232
v_add_f32 v227, v227, v233
v_add_f32 v227, v227, v234
v_add_f32 v227, v227, v235
v_cvt_pk_bf16_f32 v174, v232, v233
v_cvt_pk_bf16_f32 v175, v234, v235
s_branch L2_rare_common
L2_rare_site10:
s_mov_b32 s36, 10
s_branch L2_rare_t1_4_0
L2_rare_t1_4_0:
s_nop 15
s_nop 15
s_waitcnt lgkmcnt(0)
v_exp_f32 v248, v128
s_nop 0
v_sub_f32 v224, v224, v248
v_exp_f32 v248, v129
s_nop 0
v_sub_f32 v224, v224, v248
v_exp_f32 v248, v130
s_nop 0
v_sub_f32 v224, v224, v248
v_exp_f32 v248, v131
s_nop 0
v_sub_f32 v224, v224, v248
v_max_f32 v224, 0, v224
v_min_f32 v224, s32, v224
v_log_f32 v248, v224
v_max3_f32 v232, v128, v129, v130
v_max3_f32 v232, v232, v131, v248
v_mov_b32 v248, v232
s_nop 1
v_permlane32_swap_b32 v232, v248
s_nop 1
v_max_f32 v232, v232, v248
v_mov_b32 v248, v232
s_nop 1
v_permlane16_swap_b32 v232, v248
s_nop 1
v_max_f32 v232, v232, v248
v_ceil_f32 v232, v232
v_max_f32 v232, 0, v232
v_sub_f32 v248, 0, v232
v_exp_f32 v236, v248
s_nop 1
v_mul_f32 v224, v224, v236
v_sub_f32 v192, v192, v232
v_sub_f32 v128, v128, v232
v_sub_f32 v144, v144, v232
v_sub_f32 v193, v193, v232
v_sub_f32 v129, v129, v232
v_sub_f32 v145, v145, v232
v_sub_f32 v194, v194, v232
v_sub_f32 v130, v130, v232
v_sub_f32 v146, v146, v232
v_sub_f32 v195, v195, v232
v_sub_f32 v131, v131, v232
v_sub_f32 v147, v147, v232
v_lshlrev_b32 v242, 16, v4
v_and_b32 v248, 0xffff0000, v4
v_mul_f32 v242, v242, v236
v_mul_f32 v248, v248, v236
v_cvt_pk_bf16_f32 v4, v242, v248
v_lshlrev_b32 v242, 16, v5
v_and_b32 v248, 0xffff0000, v5
v_mul_f32 v242, v242, v236
v_mul_f32 v248, v248, v236
v_cvt_pk_bf16_f32 v5, v242, v248
v_lshlrev_b32 v242, 16, v6
v_and_b32 v248, 0xffff0000, v6
v_mul_f32 v242, v242, v236
v_mul_f32 v248, v248, v236
v_cvt_pk_bf16_f32 v6, v242, v248
v_lshlrev_b32 v242, 16, v7
v_and_b32 v248, 0xffff0000, v7
v_mul_f32 v242, v242, v236
v_mul_f32 v248, v248, v236
v_cvt_pk_bf16_f32 v7, v242, v248
v_lshlrev_b32 v242, 16, v8
v_and_b32 v248, 0xffff0000, v8
v_mul_f32 v242, v242, v236
v_mul_f32 v248, v248, v236
v_cvt_pk_bf16_f32 v8, v242, v248
v_lshlrev_b32 v242, 16, v9
v_and_b32 v248, 0xffff0000, v9
v_mul_f32 v242, v242, v236
v_mul_f32 v248, v248, v236
v_cvt_pk_bf16_f32 v9, v242, v248
v_lshlrev_b32 v242, 16, v10
v_and_b32 v248, 0xffff0000, v10
v_mul_f32 v242, v242, v236
v_mul_f32 v248, v248, v236
v_cvt_pk_bf16_f32 v10, v242, v248
v_lshlrev_b32 v242, 16, v11
v_and_b32 v248, 0xffff0000, v11
v_mul_f32 v242, v242, v236
v_mul_f32 v248, v248, v236
v_cvt_pk_bf16_f32 v11, v242, v248
v_lshlrev_b32 v242, 16, v176
v_and_b32 v248, 0xffff0000, v176
v_mul_f32 v242, v242, v236
v_mul_f32 v248, v248, v236
v_cvt_pk_bf16_f32 v176, v242, v248
v_lshlrev_b32 v242, 16, v177
v_and_b32 v248, 0xffff0000, v177
v_mul_f32 v242, v242, v236
v_mul_f32 v248, v248, v236
v_cvt_pk_bf16_f32 v177, v242, v248
v_lshlrev_b32 v242, 16, v178
v_and_b32 v248, 0xffff0000, v178
v_mul_f32 v242, v242, v236
v_mul_f32 v248, v248, v236
v_cvt_pk_bf16_f32 v178, v242, v248
v_lshlrev_b32 v242, 16, v179
v_and_b32 v248, 0xffff0000, v179
v_mul_f32 v242, v242, v236
v_mul_f32 v248, v248, v236
v_cvt_pk_bf16_f32 v179, v242, v248
v_lshlrev_b32 v242, 16, v160
v_and_b32 v248, 0xffff0000, v160
v_mul_f32 v242, v242, v236
v_mul_f32 v248, v248, v236
v_cvt_pk_bf16_f32 v160, v242, v248
v_lshlrev_b32 v242, 16, v161
v_and_b32 v248, 0xffff0000, v161
v_mul_f32 v242, v242, v236
v_mul_f32 v248, v248, v236
v_cvt_pk_bf16_f32 v161, v242, v248
v_lshlrev_b32 v242, 16, v162
v_and_b32 v248, 0xffff0000, v162
v_mul_f32 v242, v242, v236
v_mul_f32 v248, v248, v236
v_cvt_pk_bf16_f32 v162, v242, v248
v_lshlrev_b32 v242, 16, v163
v_and_b32 v248, 0xffff0000, v163
v_mul_f32 v242, v242, v236
v_mul_f32 v248, v248, v236
v_cvt_pk_bf16_f32 v163, v242, v248
v_exp_f32 v248, v132
s_nop 0
v_sub_f32 v225, v225, v248
v_exp_f32 v248, v133
s_nop 0
v_sub_f32 v225, v225, v248
v_exp_f32 v248, v134
s_nop 0
v_sub_f32 v225, v225, v248
v_exp_f32 v248, v135
s_nop 0
v_sub_f32 v225, v225, v248
v_max_f32 v225, 0, v225
v_min_f32 v225, s32, v225
v_log_f32 v248, v225
v_max3_f32 v233, v132, v133, v134
v_max3_f32 v233, v233, v135, v248
v_mov_b32 v248, v233
s_nop 1
v_permlane32_swap_b32 v233, v248
s_nop 1
v_max_f32 v233, v233, v248
v_mov_b32 v248, v233
s_nop 1
v_permlane16_swap_b32 v233, v248
s_nop 1
v_max_f32 v233, v233, v248
v_ceil_f32 v233, v233
v_max_f32 v233, 0, v233
v_sub_f32 v248, 0, v233
v_exp_f32 v237, v248
s_nop 1
v_mul_f32 v225, v225, v237
v_sub_f32 v196, v196, v233
v_sub_f32 v132, v132, v233
v_sub_f32 v148, v148, v233
v_sub_f32 v197, v197, v233
v_sub_f32 v133, v133, v233
v_sub_f32 v149, v149, v233
v_sub_f32 v198, v198, v233
v_sub_f32 v134, v134, v233
v_sub_f32 v150, v150, v233
v_sub_f32 v199, v199, v233
v_sub_f32 v135, v135, v233
v_sub_f32 v151, v151, v233
v_lshlrev_b32 v242, 16, v36
v_and_b32 v248, 0xffff0000, v36
v_mul_f32 v242, v242, v237
v_mul_f32 v248, v248, v237
v_cvt_pk_bf16_f32 v36, v242, v248
v_lshlrev_b32 v242, 16, v37
v_and_b32 v248, 0xffff0000, v37
v_mul_f32 v242, v242, v237
v_mul_f32 v248, v248, v237
v_cvt_pk_bf16_f32 v37, v242, v248
v_lshlrev_b32 v242, 16, v38
v_and_b32 v248, 0xffff0000, v38
v_mul_f32 v242, v242, v237
v_mul_f32 v248, v248, v237
v_cvt_pk_bf16_f32 v38, v242, v248
v_lshlrev_b32 v242, 16, v39
v_and_b32 v248, 0xffff0000, v39
v_mul_f32 v242, v242, v237
v_mul_f32 v248, v248, v237
v_cvt_pk_bf16_f32 v39, v242, v248
v_lshlrev_b32 v242, 16, v40
v_and_b32 v248, 0xffff0000, v40
v_mul_f32 v242, v242, v237
v_mul_f32 v248, v248, v237
v_cvt_pk_bf16_f32 v40, v242, v248
v_lshlrev_b32 v242, 16, v41
v_and_b32 v248, 0xffff0000, v41
v_mul_f32 v242, v242, v237
v_mul_f32 v248, v248, v237
v_cvt_pk_bf16_f32 v41, v242, v248
v_lshlrev_b32 v242, 16, v42
v_and_b32 v248, 0xffff0000, v42
v_mul_f32 v242, v242, v237
v_mul_f32 v248, v248, v237
v_cvt_pk_bf16_f32 v42, v242, v248
v_lshlrev_b32 v242, 16, v43
v_and_b32 v248, 0xffff0000, v43
v_mul_f32 v242, v242, v237
v_mul_f32 v248, v248, v237
v_cvt_pk_bf16_f32 v43, v242, v248
v_lshlrev_b32 v242, 16, v180
v_and_b32 v248, 0xffff0000, v180
v_mul_f32 v242, v242, v237
v_mul_f32 v248, v248, v237
v_cvt_pk_bf16_f32 v180, v242, v248
v_lshlrev_b32 v242, 16, v181
v_and_b32 v248, 0xffff0000, v181
v_mul_f32 v242, v242, v237
v_mul_f32 v248, v248, v237
v_cvt_pk_bf16_f32 v181, v242, v248
v_lshlrev_b32 v242, 16, v182
v_and_b32 v248, 0xffff0000, v182
v_mul_f32 v242, v242, v237
v_mul_f32 v248, v248, v237
v_cvt_pk_bf16_f32 v182, v242, v248
v_lshlrev_b32 v242, 16, v183
v_and_b32 v248, 0xffff0000, v183
v_mul_f32 v242, v242, v237
v_mul_f32 v248, v248, v237
v_cvt_pk_bf16_f32 v183, v242, v248
v_lshlrev_b32 v242, 16, v164
v_and_b32 v248, 0xffff0000, v164
v_mul_f32 v242, v242, v237
v_mul_f32 v248, v248, v237
v_cvt_pk_bf16_f32 v164, v242, v248
v_lshlrev_b32 v242, 16, v165
v_and_b32 v248, 0xffff0000, v165
v_mul_f32 v242, v242, v237
v_mul_f32 v248, v248, v237
v_cvt_pk_bf16_f32 v165, v242, v248
v_lshlrev_b32 v242, 16, v166
v_and_b32 v248, 0xffff0000, v166
v_mul_f32 v242, v242, v237
v_mul_f32 v248, v248, v237
v_cvt_pk_bf16_f32 v166, v242, v248
v_lshlrev_b32 v242, 16, v167
v_and_b32 v248, 0xffff0000, v167
v_mul_f32 v242, v242, v237
v_mul_f32 v248, v248, v237
v_cvt_pk_bf16_f32 v167, v242, v248
v_exp_f32 v248, v136
s_nop 0
v_sub_f32 v226, v226, v248
v_exp_f32 v248, v137
s_nop 0
v_sub_f32 v226, v226, v248
v_exp_f32 v248, v138
s_nop 0
v_sub_f32 v226, v226, v248
v_exp_f32 v248, v139
s_nop 0
v_sub_f32 v226, v226, v248
v_max_f32 v226, 0, v226
v_min_f32 v226, s32, v226
v_log_f32 v248, v226
v_max3_f32 v234, v136, v137, v138
v_max3_f32 v234, v234, v139, v248
v_mov_b32 v248, v234
s_nop 1
v_permlane32_swap_b32 v234, v248
s_nop 1
v_max_f32 v234, v234, v248
v_mov_b32 v248, v234
s_nop 1
v_permlane16_swap_b32 v234, v248
s_nop 1
v_max_f32 v234, v234, v248
v_ceil_f32 v234, v234
v_max_f32 v234, 0, v234
v_sub_f32 v248, 0, v234
v_exp_f32 v238, v248
s_nop 1
v_mul_f32 v226, v226, v238
v_sub_f32 v200, v200, v234
v_sub_f32 v136, v136, v234
v_sub_f32 v152, v152, v234
v_sub_f32 v201, v201, v234
v_sub_f32 v137, v137, v234
v_sub_f32 v153, v153, v234
v_sub_f32 v202, v202, v234
v_sub_f32 v138, v138, v234
v_sub_f32 v154, v154, v234
v_sub_f32 v203, v203, v234
v_sub_f32 v139, v139, v234
v_sub_f32 v155, v155, v234
v_lshlrev_b32 v242, 16, v68
v_and_b32 v248, 0xffff0000, v68
v_mul_f32 v242, v242, v238
v_mul_f32 v248, v248, v238
v_cvt_pk_bf16_f32 v68, v242, v248
v_lshlrev_b32 v242, 16, v69
v_and_b32 v248, 0xffff0000, v69
v_mul_f32 v242, v242, v238
v_mul_f32 v248, v248, v238
v_cvt_pk_bf16_f32 v69, v242, v248
v_lshlrev_b32 v242, 16, v70
v_and_b32 v248, 0xffff0000, v70
v_mul_f32 v242, v242, v238
v_mul_f32 v248, v248, v238
v_cvt_pk_bf16_f32 v70, v242, v248
v_lshlrev_b32 v242, 16, v71
v_and_b32 v248, 0xffff0000, v71
v_mul_f32 v242, v242, v238
v_mul_f32 v248, v248, v238
v_cvt_pk_bf16_f32 v71, v242, v248
v_lshlrev_b32 v242, 16, v72
v_and_b32 v248, 0xffff0000, v72
v_mul_f32 v242, v242, v238
v_mul_f32 v248, v248, v238
v_cvt_pk_bf16_f32 v72, v242, v248
v_lshlrev_b32 v242, 16, v73
v_and_b32 v248, 0xffff0000, v73
v_mul_f32 v242, v242, v238
v_mul_f32 v248, v248, v238
v_cvt_pk_bf16_f32 v73, v242, v248
v_lshlrev_b32 v242, 16, v74
v_and_b32 v248, 0xffff0000, v74
v_mul_f32 v242, v242, v238
v_mul_f32 v248, v248, v238
v_cvt_pk_bf16_f32 v74, v242, v248
v_lshlrev_b32 v242, 16, v75
v_and_b32 v248, 0xffff0000, v75
v_mul_f32 v242, v242, v238
v_mul_f32 v248, v248, v238
v_cvt_pk_bf16_f32 v75, v242, v248
v_lshlrev_b32 v242, 16, v184
v_and_b32 v248, 0xffff0000, v184
v_mul_f32 v242, v242, v238
v_mul_f32 v248, v248, v238
v_cvt_pk_bf16_f32 v184, v242, v248
v_lshlrev_b32 v242, 16, v185
v_and_b32 v248, 0xffff0000, v185
v_mul_f32 v242, v242, v238
v_mul_f32 v248, v248, v238
v_cvt_pk_bf16_f32 v185, v242, v248
v_lshlrev_b32 v242, 16, v186
v_and_b32 v248, 0xffff0000, v186
v_mul_f32 v242, v242, v238
v_mul_f32 v248, v248, v238
v_cvt_pk_bf16_f32 v186, v242, v248
v_lshlrev_b32 v242, 16, v187
v_and_b32 v248, 0xffff0000, v187
v_mul_f32 v242, v242, v238
v_mul_f32 v248, v248, v238
v_cvt_pk_bf16_f32 v187, v242, v248
v_lshlrev_b32 v242, 16, v168
v_and_b32 v248, 0xffff0000, v168
v_mul_f32 v242, v242, v238
v_mul_f32 v248, v248, v238
v_cvt_pk_bf16_f32 v168, v242, v248
v_lshlrev_b32 v242, 16, v169
v_and_b32 v248, 0xffff0000, v169
v_mul_f32 v242, v242, v238
v_mul_f32 v248, v248, v238
v_cvt_pk_bf16_f32 v169, v242, v248
v_lshlrev_b32 v242, 16, v170
v_and_b32 v248, 0xffff0000, v170
v_mul_f32 v242, v242, v238
v_mul_f32 v248, v248, v238
v_cvt_pk_bf16_f32 v170, v242, v248
v_lshlrev_b32 v242, 16, v171
v_and_b32 v248, 0xffff0000, v171
v_mul_f32 v242, v242, v238
v_mul_f32 v248, v248, v238
v_cvt_pk_bf16_f32 v171, v242, v248
v_exp_f32 v248, v140
s_nop 0
v_sub_f32 v227, v227, v248
v_exp_f32 v248, v141
s_nop 0
v_sub_f32 v227, v227, v248
v_exp_f32 v248, v142
s_nop 0
v_sub_f32 v227, v227, v248
v_exp_f32 v248, v143
s_nop 0
v_sub_f32 v227, v227, v248
v_max_f32 v227, 0, v227
v_min_f32 v227, s32, v227
v_log_f32 v248, v227
v_max3_f32 v235, v140, v141, v142
v_max3_f32 v235, v235, v143, v248
v_mov_b32 v248, v235
s_nop 1
v_permlane32_swap_b32 v235, v248
s_nop 1
v_max_f32 v235, v235, v248
v_mov_b32 v248, v235
s_nop 1
v_permlane16_swap_b32 v235, v248
s_nop 1
v_max_f32 v235, v235, v248
v_ceil_f32 v235, v235
v_max_f32 v235, 0, v235
v_sub_f32 v248, 0, v235
v_exp_f32 v239, v248
s_nop 1
v_mul_f32 v227, v227, v239
v_sub_f32 v204, v204, v235
v_sub_f32 v140, v140, v235
v_sub_f32 v156, v156, v235
v_sub_f32 v205, v205, v235
v_sub_f32 v141, v141, v235
v_sub_f32 v157, v157, v235
v_sub_f32 v206, v206, v235
v_sub_f32 v142, v142, v235
v_sub_f32 v158, v158, v235
v_sub_f32 v207, v207, v235
v_sub_f32 v143, v143, v235
v_sub_f32 v159, v159, v235
v_lshlrev_b32 v242, 16, v100
v_and_b32 v248, 0xffff0000, v100
v_mul_f32 v242, v242, v239
v_mul_f32 v248, v248, v239
v_cvt_pk_bf16_f32 v100, v242, v248
v_lshlrev_b32 v242, 16, v101
v_and_b32 v248, 0xffff0000, v101
v_mul_f32 v242, v242, v239
v_mul_f32 v248, v248, v239
v_cvt_pk_bf16_f32 v101, v242, v248
v_lshlrev_b32 v242, 16, v102
v_and_b32 v248, 0xffff0000, v102
v_mul_f32 v242, v242, v239
v_mul_f32 v248, v248, v239
v_cvt_pk_bf16_f32 v102, v242, v248
v_lshlrev_b32 v242, 16, v103
v_and_b32 v248, 0xffff0000, v103
v_mul_f32 v242, v242, v239
v_mul_f32 v248, v248, v239
v_cvt_pk_bf16_f32 v103, v242, v248
v_lshlrev_b32 v242, 16, v104
v_and_b32 v248, 0xffff0000, v104
v_mul_f32 v242, v242, v239
v_mul_f32 v248, v248, v239
v_cvt_pk_bf16_f32 v104, v242, v248
v_lshlrev_b32 v242, 16, v105
v_and_b32 v248, 0xffff0000, v105
v_mul_f32 v242, v242, v239
v_mul_f32 v248, v248, v239
v_cvt_pk_bf16_f32 v105, v242, v248
v_lshlrev_b32 v242, 16, v106
v_and_b32 v248, 0xffff0000, v106
v_mul_f32 v242, v242, v239
v_mul_f32 v248, v248, v239
v_cvt_pk_bf16_f32 v106, v242, v248
v_lshlrev_b32 v242, 16, v107
v_and_b32 v248, 0xffff0000, v107
v_mul_f32 v242, v242, v239
v_mul_f32 v248, v248, v239
v_cvt_pk_bf16_f32 v107, v242, v248
v_lshlrev_b32 v242, 16, v188
v_and_b32 v248, 0xffff0000, v188
v_mul_f32 v242, v242, v239
v_mul_f32 v248, v248, v239
v_cvt_pk_bf16_f32 v188, v242, v248
v_lshlrev_b32 v242, 16, v189
v_and_b32 v248, 0xffff0000, v189
v_mul_f32 v242, v242, v239
v_mul_f32 v248, v248, v239
v_cvt_pk_bf16_f32 v189, v242, v248
v_lshlrev_b32 v242, 16, v190
v_and_b32 v248, 0xffff0000, v190
v_mul_f32 v242, v242, v239
v_mul_f32 v248, v248, v239
v_cvt_pk_bf16_f32 v190, v242, v248
v_lshlrev_b32 v242, 16, v191
v_and_b32 v248, 0xffff0000, v191
v_mul_f32 v242, v242, v239
v_mul_f32 v248, v248, v239
v_cvt_pk_bf16_f32 v191, v242, v248
v_lshlrev_b32 v242, 16, v172
v_and_b32 v248, 0xffff0000, v172
v_mul_f32 v242, v242, v239
v_mul_f32 v248, v248, v239
v_cvt_pk_bf16_f32 v172, v242, v248
v_lshlrev_b32 v242, 16, v173
v_and_b32 v248, 0xffff0000, v173
v_mul_f32 v242, v242, v239
v_mul_f32 v248, v248, v239
v_cvt_pk_bf16_f32 v173, v242, v248
v_lshlrev_b32 v242, 16, v174
v_and_b32 v248, 0xffff0000, v174
v_mul_f32 v242, v242, v239
v_mul_f32 v248, v248, v239
v_cvt_pk_bf16_f32 v174, v242, v248
v_lshlrev_b32 v242, 16, v175
v_and_b32 v248, 0xffff0000, v175
v_mul_f32 v242, v242, v239
v_mul_f32 v248, v248, v239
v_cvt_pk_bf16_f32 v175, v242, v248
v_exp_f32 v232, v128
v_exp_f32 v233, v129
v_exp_f32 v234, v130
v_exp_f32 v235, v131
s_nop 1
v_add_f32 v224, v224, v232
v_add_f32 v224, v224, v233
v_add_f32 v224, v224, v234
v_add_f32 v224, v224, v235
v_cvt_pk_bf16_f32 v0, v232, v233
v_cvt_pk_bf16_f32 v1, v234, v235
v_exp_f32 v232, v132
v_exp_f32 v233, v133
v_exp_f32 v234, v134
v_exp_f32 v235, v135
s_nop 1
v_add_f32 v225, v225, v232
v_add_f32 v225, v225, v233
v_add_f32 v225, v225, v234
v_add_f32 v225, v225, v235
v_cvt_pk_bf16_f32 v32, v232, v233
v_cvt_pk_bf16_f32 v33, v234, v235
v_exp_f32 v232, v136
v_exp_f32 v233, v137
v_exp_f32 v234, v138
v_exp_f32 v235, v139
s_nop 1
v_add_f32 v226, v226, v232
v_add_f32 v226, v226, v233
v_add_f32 v226, v226, v234
v_add_f32 v226, v226, v235
v_cvt_pk_bf16_f32 v64, v232, v233
v_cvt_pk_bf16_f32 v65, v234, v235
v_exp_f32 v232, v140
v_exp_f32 v233, v141
v_exp_f32 v234, v142
v_exp_f32 v235, v143
s_nop 1
v_add_f32 v227, v227, v232
v_add_f32 v227, v227, v233
v_add_f32 v227, v227, v234
v_add_f32 v227, v227, v235
v_cvt_pk_bf16_f32 v96, v232, v233
v_cvt_pk_bf16_f32 v97, v234, v235
s_branch L2_rare_common
L2_rare_site11:
s_mov_b32 s36, 11
s_branch L2_rare_t1_5_1
L2_rare_t1_5_1:
s_nop 15
s_nop 15
s_waitcnt lgkmcnt(0)
v_exp_f32 v248, v144
s_nop 0
v_sub_f32 v224, v224, v248
v_exp_f32 v248, v145
s_nop 0
v_sub_f32 v224, v224, v248
v_exp_f32 v248, v146
s_nop 0
v_sub_f32 v224, v224, v248
v_exp_f32 v248, v147
s_nop 0
v_sub_f32 v224, v224, v248
v_max_f32 v224, 0, v224
v_min_f32 v224, s32, v224
v_log_f32 v248, v224
v_max3_f32 v232, v144, v145, v146
v_max3_f32 v232, v232, v147, v248
v_mov_b32 v248, v232
s_nop 1
v_permlane32_swap_b32 v232, v248
s_nop 1
v_max_f32 v232, v232, v248
v_mov_b32 v248, v232
s_nop 1
v_permlane16_swap_b32 v232, v248
s_nop 1
v_max_f32 v232, v232, v248
v_ceil_f32 v232, v232
v_max_f32 v232, 0, v232
v_sub_f32 v248, 0, v232
v_exp_f32 v236, v248
s_nop 1
v_mul_f32 v224, v224, v236
v_sub_f32 v192, v192, v232
v_sub_f32 v144, v144, v232
v_sub_f32 v128, v128, v232
v_sub_f32 v193, v193, v232
v_sub_f32 v145, v145, v232
v_sub_f32 v129, v129, v232
v_sub_f32 v194, v194, v232
v_sub_f32 v146, v146, v232
v_sub_f32 v130, v130, v232
v_sub_f32 v195, v195, v232
v_sub_f32 v147, v147, v232
v_sub_f32 v131, v131, v232
v_lshlrev_b32 v242, 16, v4
v_and_b32 v248, 0xffff0000, v4
v_mul_f32 v242, v242, v236
v_mul_f32 v248, v248, v236
v_cvt_pk_bf16_f32 v4, v242, v248
v_lshlrev_b32 v242, 16, v5
v_and_b32 v248, 0xffff0000, v5
v_mul_f32 v242, v242, v236
v_mul_f32 v248, v248, v236
v_cvt_pk_bf16_f32 v5, v242, v248
v_lshlrev_b32 v242, 16, v6
v_and_b32 v248, 0xffff0000, v6
v_mul_f32 v242, v242, v236
v_mul_f32 v248, v248, v236
v_cvt_pk_bf16_f32 v6, v242, v248
v_lshlrev_b32 v242, 16, v7
v_and_b32 v248, 0xffff0000, v7
v_mul_f32 v242, v242, v236
v_mul_f32 v248, v248, v236
v_cvt_pk_bf16_f32 v7, v242, v248
v_lshlrev_b32 v242, 16, v8
v_and_b32 v248, 0xffff0000, v8
v_mul_f32 v242, v242, v236
v_mul_f32 v248, v248, v236
v_cvt_pk_bf16_f32 v8, v242, v248
v_lshlrev_b32 v242, 16, v9
v_and_b32 v248, 0xffff0000, v9
v_mul_f32 v242, v242, v236
v_mul_f32 v248, v248, v236
v_cvt_pk_bf16_f32 v9, v242, v248
v_lshlrev_b32 v242, 16, v10
v_and_b32 v248, 0xffff0000, v10
v_mul_f32 v242, v242, v236
v_mul_f32 v248, v248, v236
v_cvt_pk_bf16_f32 v10, v242, v248
v_lshlrev_b32 v242, 16, v11
v_and_b32 v248, 0xffff0000, v11
v_mul_f32 v242, v242, v236
v_mul_f32 v248, v248, v236
v_cvt_pk_bf16_f32 v11, v242, v248
v_lshlrev_b32 v242, 16, v176
v_and_b32 v248, 0xffff0000, v176
v_mul_f32 v242, v242, v236
v_mul_f32 v248, v248, v236
v_cvt_pk_bf16_f32 v176, v242, v248
v_lshlrev_b32 v242, 16, v177
v_and_b32 v248, 0xffff0000, v177
v_mul_f32 v242, v242, v236
v_mul_f32 v248, v248, v236
v_cvt_pk_bf16_f32 v177, v242, v248
v_lshlrev_b32 v242, 16, v178
v_and_b32 v248, 0xffff0000, v178
v_mul_f32 v242, v242, v236
v_mul_f32 v248, v248, v236
v_cvt_pk_bf16_f32 v178, v242, v248
v_lshlrev_b32 v242, 16, v179
v_and_b32 v248, 0xffff0000, v179
v_mul_f32 v242, v242, v236
v_mul_f32 v248, v248, v236
v_cvt_pk_bf16_f32 v179, v242, v248
v_lshlrev_b32 v242, 16, v160
v_and_b32 v248, 0xffff0000, v160
v_mul_f32 v242, v242, v236
v_mul_f32 v248, v248, v236
v_cvt_pk_bf16_f32 v160, v242, v248
v_lshlrev_b32 v242, 16, v161
v_and_b32 v248, 0xffff0000, v161
v_mul_f32 v242, v242, v236
v_mul_f32 v248, v248, v236
v_cvt_pk_bf16_f32 v161, v242, v248
v_lshlrev_b32 v242, 16, v162
v_and_b32 v248, 0xffff0000, v162
v_mul_f32 v242, v242, v236
v_mul_f32 v248, v248, v236
v_cvt_pk_bf16_f32 v162, v242, v248
v_lshlrev_b32 v242, 16, v163
v_and_b32 v248, 0xffff0000, v163
v_mul_f32 v242, v242, v236
v_mul_f32 v248, v248, v236
v_cvt_pk_bf16_f32 v163, v242, v248
v_lshlrev_b32 v242, 16, v0
v_and_b32 v248, 0xffff0000, v0
v_mul_f32 v242, v242, v236
v_mul_f32 v248, v248, v236
v_cvt_pk_bf16_f32 v0, v242, v248
v_lshlrev_b32 v242, 16, v1
v_and_b32 v248, 0xffff0000, v1
v_mul_f32 v242, v242, v236
v_mul_f32 v248, v248, v236
v_cvt_pk_bf16_f32 v1, v242, v248
v_exp_f32 v248, v148
s_nop 0
v_sub_f32 v225, v225, v248
v_exp_f32 v248, v149
s_nop 0
v_sub_f32 v225, v225, v248
v_exp_f32 v248, v150
s_nop 0
v_sub_f32 v225, v225, v248
v_exp_f32 v248, v151
s_nop 0
v_sub_f32 v225, v225, v248
v_max_f32 v225, 0, v225
v_min_f32 v225, s32, v225
v_log_f32 v248, v225
v_max3_f32 v233, v148, v149, v150
v_max3_f32 v233, v233, v151, v248
v_mov_b32 v248, v233
s_nop 1
v_permlane32_swap_b32 v233, v248
s_nop 1
v_max_f32 v233, v233, v248
v_mov_b32 v248, v233
s_nop 1
v_permlane16_swap_b32 v233, v248
s_nop 1
v_max_f32 v233, v233, v248
v_ceil_f32 v233, v233
v_max_f32 v233, 0, v233
v_sub_f32 v248, 0, v233
v_exp_f32 v237, v248
s_nop 1
v_mul_f32 v225, v225, v237
v_sub_f32 v196, v196, v233
v_sub_f32 v148, v148, v233
v_sub_f32 v132, v132, v233
v_sub_f32 v197, v197, v233
v_sub_f32 v149, v149, v233
v_sub_f32 v133, v133, v233
v_sub_f32 v198, v198, v233
v_sub_f32 v150, v150, v233
v_sub_f32 v134, v134, v233
v_sub_f32 v199, v199, v233
v_sub_f32 v151, v151, v233
v_sub_f32 v135, v135, v233
v_lshlrev_b32 v242, 16, v36
v_and_b32 v248, 0xffff0000, v36
v_mul_f32 v242, v242, v237
v_mul_f32 v248, v248, v237
v_cvt_pk_bf16_f32 v36, v242, v248
v_lshlrev_b32 v242, 16, v37
v_and_b32 v248, 0xffff0000, v37
v_mul_f32 v242, v242, v237
v_mul_f32 v248, v248, v237
v_cvt_pk_bf16_f32 v37, v242, v248
v_lshlrev_b32 v242, 16, v38
v_and_b32 v248, 0xffff0000, v38
v_mul_f32 v242, v242, v237
v_mul_f32 v248, v248, v237
v_cvt_pk_bf16_f32 v38, v242, v248
v_lshlrev_b32 v242, 16, v39
v_and_b32 v248, 0xffff0000, v39
v_mul_f32 v242, v242, v237
v_mul_f32 v248, v248, v237
v_cvt_pk_bf16_f32 v39, v242, v248
v_lshlrev_b32 v242, 16, v40
v_and_b32 v248, 0xffff0000, v40
v_mul_f32 v242, v242, v237
v_mul_f32 v248, v248, v237
v_cvt_pk_bf16_f32 v40, v242, v248
v_lshlrev_b32 v242, 16, v41
v_and_b32 v248, 0xffff0000, v41
v_mul_f32 v242, v242, v237
v_mul_f32 v248, v248, v237
v_cvt_pk_bf16_f32 v41, v242, v248
v_lshlrev_b32 v242, 16, v42
v_and_b32 v248, 0xffff0000, v42
v_mul_f32 v242, v242, v237
v_mul_f32 v248, v248, v237
v_cvt_pk_bf16_f32 v42, v242, v248
v_lshlrev_b32 v242, 16, v43
v_and_b32 v248, 0xffff0000, v43
v_mul_f32 v242, v242, v237
v_mul_f32 v248, v248, v237
v_cvt_pk_bf16_f32 v43, v242, v248
v_lshlrev_b32 v242, 16, v180
v_and_b32 v248, 0xffff0000, v180
v_mul_f32 v242, v242, v237
v_mul_f32 v248, v248, v237
v_cvt_pk_bf16_f32 v180, v242, v248
v_lshlrev_b32 v242, 16, v181
v_and_b32 v248, 0xffff0000, v181
v_mul_f32 v242, v242, v237
v_mul_f32 v248, v248, v237
v_cvt_pk_bf16_f32 v181, v242, v248
v_lshlrev_b32 v242, 16, v182
v_and_b32 v248, 0xffff0000, v182
v_mul_f32 v242, v242, v237
v_mul_f32 v248, v248, v237
v_cvt_pk_bf16_f32 v182, v242, v248
v_lshlrev_b32 v242, 16, v183
v_and_b32 v248, 0xffff0000, v183
v_mul_f32 v242, v242, v237
v_mul_f32 v248, v248, v237
v_cvt_pk_bf16_f32 v183, v242, v248
v_lshlrev_b32 v242, 16, v164
v_and_b32 v248, 0xffff0000, v164
v_mul_f32 v242, v242, v237
v_mul_f32 v248, v248, v237
v_cvt_pk_bf16_f32 v164, v242, v248
v_lshlrev_b32 v242, 16, v165
v_and_b32 v248, 0xffff0000, v165
v_mul_f32 v242, v242, v237
v_mul_f32 v248, v248, v237
v_cvt_pk_bf16_f32 v165, v242, v248
v_lshlrev_b32 v242, 16, v166
v_and_b32 v248, 0xffff0000, v166
v_mul_f32 v242, v242, v237
v_mul_f32 v248, v248, v237
v_cvt_pk_bf16_f32 v166, v242, v248
v_lshlrev_b32 v242, 16, v167
v_and_b32 v248, 0xffff0000, v167
v_mul_f32 v242, v242, v237
v_mul_f32 v248, v248, v237
v_cvt_pk_bf16_f32 v167, v242, v248
v_lshlrev_b32 v242, 16, v32
v_and_b32 v248, 0xffff0000, v32
v_mul_f32 v242, v242, v237
v_mul_f32 v248, v248, v237
v_cvt_pk_bf16_f32 v32, v242, v248
v_lshlrev_b32 v242, 16, v33
v_and_b32 v248, 0xffff0000, v33
v_mul_f32 v242, v242, v237
v_mul_f32 v248, v248, v237
v_cvt_pk_bf16_f32 v33, v242, v248
v_exp_f32 v248, v152
s_nop 0
v_sub_f32 v226, v226, v248
v_exp_f32 v248, v153
s_nop 0
v_sub_f32 v226, v226, v248
v_exp_f32 v248, v154
s_nop 0
v_sub_f32 v226, v226, v248
v_exp_f32 v248, v155
s_nop 0
v_sub_f32 v226, v226, v248
v_max_f32 v226, 0, v226
v_min_f32 v226, s32, v226
v_log_f32 v248, v226
v_max3_f32 v234, v152, v153, v154
v_max3_f32 v234, v234, v155, v248
v_mov_b32 v248, v234
s_nop 1
v_permlane32_swap_b32 v234, v248
s_nop 1
v_max_f32 v234, v234, v248
v_mov_b32 v248, v234
s_nop 1
v_permlane16_swap_b32 v234, v248
s_nop 1
v_max_f32 v234, v234, v248
v_ceil_f32 v234, v234
v_max_f32 v234, 0, v234
v_sub_f32 v248, 0, v234
v_exp_f32 v238, v248
s_nop 1
v_mul_f32 v226, v226, v238
v_sub_f32 v200, v200, v234
v_sub_f32 v152, v152, v234
v_sub_f32 v136, v136, v234
v_sub_f32 v201, v201, v234
v_sub_f32 v153, v153, v234
v_sub_f32 v137, v137, v234
v_sub_f32 v202, v202, v234
v_sub_f32 v154, v154, v234
v_sub_f32 v138, v138, v234
v_sub_f32 v203, v203, v234
v_sub_f32 v155, v155, v234
v_sub_f32 v139, v139, v234
v_lshlrev_b32 v242, 16, v68
v_and_b32 v248, 0xffff0000, v68
v_mul_f32 v242, v242, v238
v_mul_f32 v248, v248, v238
v_cvt_pk_bf16_f32 v68, v242, v248
v_lshlrev_b32 v242, 16, v69
v_and_b32 v248, 0xffff0000, v69
v_mul_f32 v242, v242, v238
v_mul_f32 v248, v248, v238
v_cvt_pk_bf16_f32 v69, v242, v248
v_lshlrev_b32 v242, 16, v70
v_and_b32 v248, 0xffff0000, v70
v_mul_f32 v242, v242, v238
v_mul_f32 v248, v248, v238
v_cvt_pk_bf16_f32 v70, v242, v248
v_lshlrev_b32 v242, 16, v71
v_and_b32 v248, 0xffff0000, v71
v_mul_f32 v242, v242, v238
v_mul_f32 v248, v248, v238
v_cvt_pk_bf16_f32 v71, v242, v248
v_lshlrev_b32 v242, 16, v72
v_and_b32 v248, 0xffff0000, v72
v_mul_f32 v242, v242, v238
v_mul_f32 v248, v248, v238
v_cvt_pk_bf16_f32 v72, v242, v248
v_lshlrev_b32 v242, 16, v73
v_and_b32 v248, 0xffff0000, v73
v_mul_f32 v242, v242, v238
v_mul_f32 v248, v248, v238
v_cvt_pk_bf16_f32 v73, v242, v248
v_lshlrev_b32 v242, 16, v74
v_and_b32 v248, 0xffff0000, v74
v_mul_f32 v242, v242, v238
v_mul_f32 v248, v248, v238
v_cvt_pk_bf16_f32 v74, v242, v248
v_lshlrev_b32 v242, 16, v75
v_and_b32 v248, 0xffff0000, v75
v_mul_f32 v242, v242, v238
v_mul_f32 v248, v248, v238
v_cvt_pk_bf16_f32 v75, v242, v248
v_lshlrev_b32 v242, 16, v184
v_and_b32 v248, 0xffff0000, v184
v_mul_f32 v242, v242, v238
v_mul_f32 v248, v248, v238
v_cvt_pk_bf16_f32 v184, v242, v248
v_lshlrev_b32 v242, 16, v185
v_and_b32 v248, 0xffff0000, v185
v_mul_f32 v242, v242, v238
v_mul_f32 v248, v248, v238
v_cvt_pk_bf16_f32 v185, v242, v248
v_lshlrev_b32 v242, 16, v186
v_and_b32 v248, 0xffff0000, v186
v_mul_f32 v242, v242, v238
v_mul_f32 v248, v248, v238
v_cvt_pk_bf16_f32 v186, v242, v248
v_lshlrev_b32 v242, 16, v187
v_and_b32 v248, 0xffff0000, v187
v_mul_f32 v242, v242, v238
v_mul_f32 v248, v248, v238
v_cvt_pk_bf16_f32 v187, v242, v248
v_lshlrev_b32 v242, 16, v168
v_and_b32 v248, 0xffff0000, v168
v_mul_f32 v242, v242, v238
v_mul_f32 v248, v248, v238
v_cvt_pk_bf16_f32 v168, v242, v248
v_lshlrev_b32 v242, 16, v169
v_and_b32 v248, 0xffff0000, v169
v_mul_f32 v242, v242, v238
v_mul_f32 v248, v248, v238
v_cvt_pk_bf16_f32 v169, v242, v248
v_lshlrev_b32 v242, 16, v170
v_and_b32 v248, 0xffff0000, v170
v_mul_f32 v242, v242, v238
v_mul_f32 v248, v248, v238
v_cvt_pk_bf16_f32 v170, v242, v248
v_lshlrev_b32 v242, 16, v171
v_and_b32 v248, 0xffff0000, v171
v_mul_f32 v242, v242, v238
v_mul_f32 v248, v248, v238
v_cvt_pk_bf16_f32 v171, v242, v248
v_lshlrev_b32 v242, 16, v64
v_and_b32 v248, 0xffff0000, v64
v_mul_f32 v242, v242, v238
v_mul_f32 v248, v248, v238
v_cvt_pk_bf16_f32 v64, v242, v248
v_lshlrev_b32 v242, 16, v65
v_and_b32 v248, 0xffff0000, v65
v_mul_f32 v242, v242, v238
v_mul_f32 v248, v248, v238
v_cvt_pk_bf16_f32 v65, v242, v248
v_exp_f32 v248, v156
s_nop 0
v_sub_f32 v227, v227, v248
v_exp_f32 v248, v157
s_nop 0
v_sub_f32 v227, v227, v248
v_exp_f32 v248, v158
s_nop 0
v_sub_f32 v227, v227, v248
v_exp_f32 v248, v159
s_nop 0
v_sub_f32 v227, v227, v248
v_max_f32 v227, 0, v227
v_min_f32 v227, s32, v227
v_log_f32 v248, v227
v_max3_f32 v235, v156, v157, v158
v_max3_f32 v235, v235, v159, v248
v_mov_b32 v248, v235
s_nop 1
v_permlane32_swap_b32 v235, v248
s_nop 1
v_max_f32 v235, v235, v248
v_mov_b32 v248, v235
s_nop 1
v_permlane16_swap_b32 v235, v248
s_nop 1
v_max_f32 v235, v235, v248
v_ceil_f32 v235, v235
v_max_f32 v235, 0, v235
v_sub_f32 v248, 0, v235
v_exp_f32 v239, v248
s_nop 1
v_mul_f32 v227, v227, v239
v_sub_f32 v204, v204, v235
v_sub_f32 v156, v156, v235
v_sub_f32 v140, v140, v235
v_sub_f32 v205, v205, v235
v_sub_f32 v157, v157, v235
v_sub_f32 v141, v141, v235
v_sub_f32 v206, v206, v235
v_sub_f32 v158, v158, v235
v_sub_f32 v142, v142, v235
v_sub_f32 v207, v207, v235
v_sub_f32 v159, v159, v235
v_sub_f32 v143, v143, v235
v_lshlrev_b32 v242, 16, v100
v_and_b32 v248, 0xffff0000, v100
v_mul_f32 v242, v242, v239
v_mul_f32 v248, v248, v239
v_cvt_pk_bf16_f32 v100, v242, v248
v_lshlrev_b32 v242, 16, v101
v_and_b32 v248, 0xffff0000, v101
v_mul_f32 v242, v242, v239
v_mul_f32 v248, v248, v239
v_cvt_pk_bf16_f32 v101, v242, v248
v_lshlrev_b32 v242, 16, v102
v_and_b32 v248, 0xffff0000, v102
v_mul_f32 v242, v242, v239
v_mul_f32 v248, v248, v239
v_cvt_pk_bf16_f32 v102, v242, v248
v_lshlrev_b32 v242, 16, v103
v_and_b32 v248, 0xffff0000, v103
v_mul_f32 v242, v242, v239
v_mul_f32 v248, v248, v239
v_cvt_pk_bf16_f32 v103, v242, v248
v_lshlrev_b32 v242, 16, v104
v_and_b32 v248, 0xffff0000, v104
v_mul_f32 v242, v242, v239
v_mul_f32 v248, v248, v239
v_cvt_pk_bf16_f32 v104, v242, v248
v_lshlrev_b32 v242, 16, v105
v_and_b32 v248, 0xffff0000, v105
v_mul_f32 v242, v242, v239
v_mul_f32 v248, v248, v239
v_cvt_pk_bf16_f32 v105, v242, v248
v_lshlrev_b32 v242, 16, v106
v_and_b32 v248, 0xffff0000, v106
v_mul_f32 v242, v242, v239
v_mul_f32 v248, v248, v239
v_cvt_pk_bf16_f32 v106, v242, v248
v_lshlrev_b32 v242, 16, v107
v_and_b32 v248, 0xffff0000, v107
v_mul_f32 v242, v242, v239
v_mul_f32 v248, v248, v239
v_cvt_pk_bf16_f32 v107, v242, v248
v_lshlrev_b32 v242, 16, v188
v_and_b32 v248, 0xffff0000, v188
v_mul_f32 v242, v242, v239
v_mul_f32 v248, v248, v239
v_cvt_pk_bf16_f32 v188, v242, v248
v_lshlrev_b32 v242, 16, v189
v_and_b32 v248, 0xffff0000, v189
v_mul_f32 v242, v242, v239
v_mul_f32 v248, v248, v239
v_cvt_pk_bf16_f32 v189, v242, v248
v_lshlrev_b32 v242, 16, v190
v_and_b32 v248, 0xffff0000, v190
v_mul_f32 v242, v242, v239
v_mul_f32 v248, v248, v239
v_cvt_pk_bf16_f32 v190, v242, v248
v_lshlrev_b32 v242, 16, v191
v_and_b32 v248, 0xffff0000, v191
v_mul_f32 v242, v242, v239
v_mul_f32 v248, v248, v239
v_cvt_pk_bf16_f32 v191, v242, v248
v_lshlrev_b32 v242, 16, v172
v_and_b32 v248, 0xffff0000, v172
v_mul_f32 v242, v242, v239
v_mul_f32 v248, v248, v239
v_cvt_pk_bf16_f32 v172, v242, v248
v_lshlrev_b32 v242, 16, v173
v_and_b32 v248, 0xffff0000, v173
v_mul_f32 v242, v242, v239
v_mul_f32 v248, v248, v239
v_cvt_pk_bf16_f32 v173, v242, v248
v_lshlrev_b32 v242, 16, v174
v_and_b32 v248, 0xffff0000, v174
v_mul_f32 v242, v242, v239
v_mul_f32 v248, v248, v239
v_cvt_pk_bf16_f32 v174, v242, v248
v_lshlrev_b32 v242, 16, v175
v_and_b32 v248, 0xffff0000, v175
v_mul_f32 v242, v242, v239
v_mul_f32 v248, v248, v239
v_cvt_pk_bf16_f32 v175, v242, v248
v_lshlrev_b32 v242, 16, v96
v_and_b32 v248, 0xffff0000, v96
v_mul_f32 v242, v242, v239
v_mul_f32 v248, v248, v239
v_cvt_pk_bf16_f32 v96, v242, v248
v_lshlrev_b32 v242, 16, v97
v_and_b32 v248, 0xffff0000, v97
v_mul_f32 v242, v242, v239
v_mul_f32 v248, v248, v239
v_cvt_pk_bf16_f32 v97, v242, v248
v_exp_f32 v232, v144
v_exp_f32 v233, v145
v_exp_f32 v234, v146
v_exp_f32 v235, v147
s_nop 1
v_add_f32 v224, v224, v232
v_add_f32 v224, v224, v233
v_add_f32 v224, v224, v234
v_add_f32 v224, v224, v235
v_cvt_pk_bf16_f32 v2, v232, v233
v_cvt_pk_bf16_f32 v3, v234, v235
v_exp_f32 v232, v148
v_exp_f32 v233, v149
v_exp_f32 v234, v150
v_exp_f32 v235, v151
s_nop 1
v_add_f32 v225, v225, v232
v_add_f32 v225, v225, v233
v_add_f32 v225, v225, v234
v_add_f32 v225, v225, v235
v_cvt_pk_bf16_f32 v34, v232, v233
v_cvt_pk_bf16_f32 v35, v234, v235
v_exp_f32 v232, v152
v_exp_f32 v233, v153
v_exp_f32 v234, v154
v_exp_f32 v235, v155
s_nop 1
v_add_f32 v226, v226, v232
v_add_f32 v226, v226, v233
v_add_f32 v226, v226, v234
v_add_f32 v226, v226, v235
v_cvt_pk_bf16_f32 v66, v232, v233
v_cvt_pk_bf16_f32 v67, v234, v235
v_exp_f32 v232, v156
v_exp_f32 v233, v157
v_exp_f32 v234, v158
v_exp_f32 v235, v159
s_nop 1
v_add_f32 v227, v227, v232
v_add_f32 v227, v227, v233
v_add_f32 v227, v227, v234
v_add_f32 v227, v227, v235
v_cvt_pk_bf16_f32 v98, v232, v233
v_cvt_pk_bf16_f32 v99, v234, v235
s_branch L2_rare_common
LF_hl_1:
s_mov_b32 s94, 0x10000
s_mov_b32 s3, 0x7c28000
LF_hl2_1:
v_lshlrev_b32 v241, 3, v243
buffer_load_dwordx2 v[240:241], v241, s[16:19], s3 offen sc1
s_sub_u32 s94, s94, 1
s_waitcnt vmcnt(0)
s_cbranch_scc1 LF_hlret_1
v_cmp_ne_u64_e64 s[38:39], s[98:99], v[240:241]
s_and_b64 s[38:39], s[38:39], s[96:97]
s_cbranch_scc1 LF_hl2_1
s_branch LF_hlret_1
L2_rare_site12:
s_mov_b32 s36, 12
s_branch L2_rare_t0_0_0
L2_rare_t0_0_0:
s_nop 15
s_nop 15
s_waitcnt lgkmcnt(0)
v_exp_f32 v248, v128
s_nop 0
v_sub_f32 v224, v224, v248
v_exp_f32 v248, v129
s_nop 0
v_sub_f32 v224, v224, v248
v_exp_f32 v248, v130
s_nop 0
v_sub_f32 v224, v224, v248
v_exp_f32 v248, v131
s_nop 0
v_sub_f32 v224, v224, v248
v_max_f32 v224, 0, v224
v_min_f32 v224, s32, v224
v_log_f32 v248, v224
v_max3_f32 v232, v128, v129, v130
v_max3_f32 v232, v232, v131, v248
v_mov_b32 v248, v232
s_nop 1
v_permlane32_swap_b32 v232, v248
s_nop 1
v_max_f32 v232, v232, v248
v_mov_b32 v248, v232
s_nop 1
v_permlane16_swap_b32 v232, v248
s_nop 1
v_max_f32 v232, v232, v248
v_ceil_f32 v232, v232
v_max_f32 v232, 0, v232
v_sub_f32 v248, 0, v232
v_exp_f32 v236, v248
s_nop 1
v_mul_f32 v224, v224, v236
v_sub_f32 v192, v192, v232
v_sub_f32 v128, v128, v232
v_sub_f32 v144, v144, v232
v_sub_f32 v193, v193, v232
v_sub_f32 v129, v129, v232
v_sub_f32 v145, v145, v232
v_sub_f32 v194, v194, v232
v_sub_f32 v130, v130, v232
v_sub_f32 v146, v146, v232
v_sub_f32 v195, v195, v232
v_sub_f32 v131, v131, v232
v_sub_f32 v147, v147, v232
v_lshlrev_b32 v242, 16, v176
v_and_b32 v248, 0xffff0000, v176
v_mul_f32 v242, v242, v236
v_mul_f32 v248, v248, v236
v_cvt_pk_bf16_f32 v176, v242, v248
v_lshlrev_b32 v242, 16, v177
v_and_b32 v248, 0xffff0000, v177
v_mul_f32 v242, v242, v236
v_mul_f32 v248, v248, v236
v_cvt_pk_bf16_f32 v177, v242, v248
v_lshlrev_b32 v242, 16, v178
v_and_b32 v248, 0xffff0000, v178
v_mul_f32 v242, v242, v236
v_mul_f32 v248, v248, v236
v_cvt_pk_bf16_f32 v178, v242, v248
v_lshlrev_b32 v242, 16, v179
v_and_b32 v248, 0xffff0000, v179
v_mul_f32 v242, v242, v236
v_mul_f32 v248, v248, v236
v_cvt_pk_bf16_f32 v179, v242, v248
ds_read_b64 v[250:251], v231 offset:0
s_waitcnt lgkmcnt(0)
v_lshlrev_b32 v242, 16, v250
v_and_b32 v248, 0xffff0000, v250
v_mul_f32 v242, v242, v236
v_mul_f32 v248, v248, v236
v_cvt_pk_bf16_f32 v250, v242, v248
v_lshlrev_b32 v242, 16, v251
v_and_b32 v248, 0xffff0000, v251
v_mul_f32 v242, v242, v236
v_mul_f32 v248, v248, v236
v_cvt_pk_bf16_f32 v251, v242, v248
ds_write_b64 v231, v[250:251] offset:0
s_waitcnt lgkmcnt(0)
ds_read_b64 v[250:251], v231 offset:8
s_waitcnt lgkmcnt(0)
v_lshlrev_b32 v242, 16, v250
v_and_b32 v248, 0xffff0000, v250
v_mul_f32 v242, v242, v236
v_mul_f32 v248, v248, v236
v_cvt_pk_bf16_f32 v250, v242, v248
v_lshlrev_b32 v242, 16, v251
v_and_b32 v248, 0xffff0000, v251
v_mul_f32 v242, v242, v236
v_mul_f32 v248, v248, v236
v_cvt_pk_bf16_f32 v251, v242, v248
ds_write_b64 v231, v[250:251] offset:8
s_waitcnt lgkmcnt(0)
v_exp_f32 v248, v132
s_nop 0
v_sub_f32 v225, v225, v248
v_exp_f32 v248, v133
s_nop 0
v_sub_f32 v225, v225, v248
v_exp_f32 v248, v134
s_nop 0
v_sub_f32 v225, v225, v248
v_exp_f32 v248, v135
s_nop 0
v_sub_f32 v225, v225, v248
v_max_f32 v225, 0, v225
v_min_f32 v225, s32, v225
v_log_f32 v248, v225
v_max3_f32 v233, v132, v133, v134
v_max3_f32 v233, v233, v135, v248
v_mov_b32 v248, v233
s_nop 1
v_permlane32_swap_b32 v233, v248
s_nop 1
v_max_f32 v233, v233, v248
v_mov_b32 v248, v233
s_nop 1
v_permlane16_swap_b32 v233, v248
s_nop 1
v_max_f32 v233, v233, v248
v_ceil_f32 v233, v233
v_max_f32 v233, 0, v233
v_sub_f32 v248, 0, v233
v_exp_f32 v237, v248
s_nop 1
v_mul_f32 v225, v225, v237
v_sub_f32 v196, v196, v233
v_sub_f32 v132, v132, v233
v_sub_f32 v148, v148, v233
v_sub_f32 v197, v197, v233
v_sub_f32 v133, v133, v233
v_sub_f32 v149, v149, v233
v_sub_f32 v198, v198, v233
v_sub_f32 v134, v134, v233
v_sub_f32 v150, v150, v233
v_sub_f32 v199, v199, v233
v_sub_f32 v135, v135, v233
v_sub_f32 v151, v151, v233
v_lshlrev_b32 v242, 16, v180
v_and_b32 v248, 0xffff0000, v180
v_mul_f32 v242, v242, v237
v_mul_f32 v248, v248, v237
v_cvt_pk_bf16_f32 v180, v242, v248
v_lshlrev_b32 v242, 16, v181
v_and_b32 v248, 0xffff0000, v181
v_mul_f32 v242, v242, v237
v_mul_f32 v248, v248, v237
v_cvt_pk_bf16_f32 v181, v242, v248
v_lshlrev_b32 v242, 16, v182
v_and_b32 v248, 0xffff0000, v182
v_mul_f32 v242, v242, v237
v_mul_f32 v248, v248, v237
v_cvt_pk_bf16_f32 v182, v242, v248
v_lshlrev_b32 v242, 16, v183
v_and_b32 v248, 0xffff0000, v183
v_mul_f32 v242, v242, v237
v_mul_f32 v248, v248, v237
v_cvt_pk_bf16_f32 v183, v242, v248
ds_read_b64 v[250:251], v231 offset:1024
s_waitcnt lgkmcnt(0)
v_lshlrev_b32 v242, 16, v250
v_and_b32 v248, 0xffff0000, v250
v_mul_f32 v242, v242, v237
v_mul_f32 v248, v248, v237
v_cvt_pk_bf16_f32 v250, v242, v248
v_lshlrev_b32 v242, 16, v251
v_and_b32 v248, 0xffff0000, v251
v_mul_f32 v242, v242, v237
v_mul_f32 v248, v248, v237
v_cvt_pk_bf16_f32 v251, v242, v248
ds_write_b64 v231, v[250:251] offset:1024
s_waitcnt lgkmcnt(0)
ds_read_b64 v[250:251], v231 offset:1032
s_waitcnt lgkmcnt(0)
v_lshlrev_b32 v242, 16, v250
v_and_b32 v248, 0xffff0000, v250
v_mul_f32 v242, v242, v237
v_mul_f32 v248, v248, v237
v_cvt_pk_bf16_f32 v250, v242, v248
v_lshlrev_b32 v242, 16, v251
v_and_b32 v248, 0xffff0000, v251
v_mul_f32 v242, v242, v237
v_mul_f32 v248, v248, v237
v_cvt_pk_bf16_f32 v251, v242, v248
ds_write_b64 v231, v[250:251] offset:1032
s_waitcnt lgkmcnt(0)
v_exp_f32 v248, v136
s_nop 0
v_sub_f32 v226, v226, v248
v_exp_f32 v248, v137
s_nop 0
v_sub_f32 v226, v226, v248
v_exp_f32 v248, v138
s_nop 0
v_sub_f32 v226, v226, v248
v_exp_f32 v248, v139
s_nop 0
v_sub_f32 v226, v226, v248
v_max_f32 v226, 0, v226
v_min_f32 v226, s32, v226
v_log_f32 v248, v226
v_max3_f32 v234, v136, v137, v138
v_max3_f32 v234, v234, v139, v248
v_mov_b32 v248, v234
s_nop 1
v_permlane32_swap_b32 v234, v248
s_nop 1
v_max_f32 v234, v234, v248
v_mov_b32 v248, v234
s_nop 1
v_permlane16_swap_b32 v234, v248
s_nop 1
v_max_f32 v234, v234, v248
v_ceil_f32 v234, v234
v_max_f32 v234, 0, v234
v_sub_f32 v248, 0, v234
v_exp_f32 v238, v248
s_nop 1
v_mul_f32 v226, v226, v238
v_sub_f32 v200, v200, v234
v_sub_f32 v136, v136, v234
v_sub_f32 v152, v152, v234
v_sub_f32 v201, v201, v234
v_sub_f32 v137, v137, v234
v_sub_f32 v153, v153, v234
v_sub_f32 v202, v202, v234
v_sub_f32 v138, v138, v234
v_sub_f32 v154, v154, v234
v_sub_f32 v203, v203, v234
v_sub_f32 v139, v139, v234
v_sub_f32 v155, v155, v234
v_lshlrev_b32 v242, 16, v184
v_and_b32 v248, 0xffff0000, v184
v_mul_f32 v242, v242, v238
v_mul_f32 v248, v248, v238
v_cvt_pk_bf16_f32 v184, v242, v248
v_lshlrev_b32 v242, 16, v185
v_and_b32 v248, 0xffff0000, v185
v_mul_f32 v242, v242, v238
v_mul_f32 v248, v248, v238
v_cvt_pk_bf16_f32 v185, v242, v248
v_lshlrev_b32 v242, 16, v186
v_and_b32 v248, 0xffff0000, v186
v_mul_f32 v242, v242, v238
v_mul_f32 v248, v248, v238
v_cvt_pk_bf16_f32 v186, v242, v248
v_lshlrev_b32 v242, 16, v187
v_and_b32 v248, 0xffff0000, v187
v_mul_f32 v242, v242, v238
v_mul_f32 v248, v248, v238
v_cvt_pk_bf16_f32 v187, v242, v248
ds_read_b64 v[250:251], v231 offset:2048
s_waitcnt lgkmcnt(0)
v_lshlrev_b32 v242, 16, v250
v_and_b32 v248, 0xffff0000, v250
v_mul_f32 v242, v242, v238
v_mul_f32 v248, v248, v238
v_cvt_pk_bf16_f32 v250, v242, v248
v_lshlrev_b32 v242, 16, v251
v_and_b32 v248, 0xffff0000, v251
v_mul_f32 v242, v242, v238
v_mul_f32 v248, v248, v238
v_cvt_pk_bf16_f32 v251, v242, v248
ds_write_b64 v231, v[250:251] offset:2048
s_waitcnt lgkmcnt(0)
ds_read_b64 v[250:251], v231 offset:2056
s_waitcnt lgkmcnt(0)
v_lshlrev_b32 v242, 16, v250
v_and_b32 v248, 0xffff0000, v250
v_mul_f32 v242, v242, v238
v_mul_f32 v248, v248, v238
v_cvt_pk_bf16_f32 v250, v242, v248
v_lshlrev_b32 v242, 16, v251
v_and_b32 v248, 0xffff0000, v251
v_mul_f32 v242, v242, v238
v_mul_f32 v248, v248, v238
v_cvt_pk_bf16_f32 v251, v242, v248
ds_write_b64 v231, v[250:251] offset:2056
s_waitcnt lgkmcnt(0)
v_exp_f32 v248, v140
s_nop 0
v_sub_f32 v227, v227, v248
v_exp_f32 v248, v141
s_nop 0
v_sub_f32 v227, v227, v248
v_exp_f32 v248, v142
s_nop 0
v_sub_f32 v227, v227, v248
v_exp_f32 v248, v143
s_nop 0
v_sub_f32 v227, v227, v248
v_max_f32 v227, 0, v227
v_min_f32 v227, s32, v227
v_log_f32 v248, v227
v_max3_f32 v235, v140, v141, v142
v_max3_f32 v235, v235, v143, v248
v_mov_b32 v248, v235
s_nop 1
v_permlane32_swap_b32 v235, v248
s_nop 1
v_max_f32 v235, v235, v248
v_mov_b32 v248, v235
s_nop 1
v_permlane16_swap_b32 v235, v248
s_nop 1
v_max_f32 v235, v235, v248
v_ceil_f32 v235, v235
v_max_f32 v235, 0, v235
v_sub_f32 v248, 0, v235
v_exp_f32 v239, v248
s_nop 1
v_mul_f32 v227, v227, v239
v_sub_f32 v204, v204, v235
v_sub_f32 v140, v140, v235
v_sub_f32 v156, v156, v235
v_sub_f32 v205, v205, v235
v_sub_f32 v141, v141, v235
v_sub_f32 v157, v157, v235
v_sub_f32 v206, v206, v235
v_sub_f32 v142, v142, v235
v_sub_f32 v158, v158, v235
v_sub_f32 v207, v207, v235
v_sub_f32 v143, v143, v235
v_sub_f32 v159, v159, v235
v_lshlrev_b32 v242, 16, v188
v_and_b32 v248, 0xffff0000, v188
v_mul_f32 v242, v242, v239
v_mul_f32 v248, v248, v239
v_cvt_pk_bf16_f32 v188, v242, v248
v_lshlrev_b32 v242, 16, v189
v_and_b32 v248, 0xffff0000, v189
v_mul_f32 v242, v242, v239
v_mul_f32 v248, v248, v239
v_cvt_pk_bf16_f32 v189, v242, v248
v_lshlrev_b32 v242, 16, v190
v_and_b32 v248, 0xffff0000, v190
v_mul_f32 v242, v242, v239
v_mul_f32 v248, v248, v239
v_cvt_pk_bf16_f32 v190, v242, v248
v_lshlrev_b32 v242, 16, v191
v_and_b32 v248, 0xffff0000, v191
v_mul_f32 v242, v242, v239
v_mul_f32 v248, v248, v239
v_cvt_pk_bf16_f32 v191, v242, v248
ds_read_b64 v[250:251], v231 offset:3072
s_waitcnt lgkmcnt(0)
v_lshlrev_b32 v242, 16, v250
v_and_b32 v248, 0xffff0000, v250
v_mul_f32 v242, v242, v239
v_mul_f32 v248, v248, v239
v_cvt_pk_bf16_f32 v250, v242, v248
v_lshlrev_b32 v242, 16, v251
v_and_b32 v248, 0xffff0000, v251
v_mul_f32 v242, v242, v239
v_mul_f32 v248, v248, v239
v_cvt_pk_bf16_f32 v251, v242, v248
ds_write_b64 v231, v[250:251] offset:3072
s_waitcnt lgkmcnt(0)
ds_read_b64 v[250:251], v231 offset:3080
s_waitcnt lgkmcnt(0)
v_lshlrev_b32 v242, 16, v250
v_and_b32 v248, 0xffff0000, v250
v_mul_f32 v242, v242, v239
v_mul_f32 v248, v248, v239
v_cvt_pk_bf16_f32 v250, v242, v248
v_lshlrev_b32 v242, 16, v251
v_and_b32 v248, 0xffff0000, v251
v_mul_f32 v242, v242, v239
v_mul_f32 v248, v248, v239
v_cvt_pk_bf16_f32 v251, v242, v248
ds_write_b64 v231, v[250:251] offset:3080
s_waitcnt lgkmcnt(0)
v_exp_f32 v232, v128
v_exp_f32 v233, v129
v_exp_f32 v234, v130
v_exp_f32 v235, v131
s_nop 1
v_add_f32 v224, v224, v232
v_add_f32 v224, v224, v233
v_add_f32 v224, v224, v234
v_add_f32 v224, v224, v235
v_cvt_pk_bf16_f32 v160, v232, v233
v_cvt_pk_bf16_f32 v161, v234, v235
v_exp_f32 v232, v132
v_exp_f32 v233, v133
v_exp_f32 v234, v134
v_exp_f32 v235, v135
s_nop 1
v_add_f32 v225, v225, v232
v_add_f32 v225, v225, v233
v_add_f32 v225, v225, v234
v_add_f32 v225, v225, v235
v_cvt_pk_bf16_f32 v164, v232, v233
v_cvt_pk_bf16_f32 v165, v234, v235
v_exp_f32 v232, v136
v_exp_f32 v233, v137
v_exp_f32 v234, v138
v_exp_f32 v235, v139
s_nop 1
v_add_f32 v226, v226, v232
v_add_f32 v226, v226, v233
v_add_f32 v226, v226, v234
v_add_f32 v226, v226, v235
v_cvt_pk_bf16_f32 v168, v232, v233
v_cvt_pk_bf16_f32 v169, v234, v235
v_exp_f32 v232, v140
v_exp_f32 v233, v141
v_exp_f32 v234, v142
v_exp_f32 v235, v143
s_nop 1
v_add_f32 v227, v227, v232
v_add_f32 v227, v227, v233
v_add_f32 v227, v227, v234
v_add_f32 v227, v227, v235
v_cvt_pk_bf16_f32 v172, v232, v233
v_cvt_pk_bf16_f32 v173, v234, v235
s_branch L2_rare_common
L2_rare_site13:
s_mov_b32 s36, 13
s_branch L2_rare_t0_1_1
L2_rare_t0_1_1:
s_nop 15
s_nop 15
s_waitcnt lgkmcnt(0)
v_exp_f32 v248, v144
s_nop 0
v_sub_f32 v224, v224, v248
v_exp_f32 v248, v145
s_nop 0
v_sub_f32 v224, v224, v248
v_exp_f32 v248, v146
s_nop 0
v_sub_f32 v224, v224, v248
v_exp_f32 v248, v147
s_nop 0
v_sub_f32 v224, v224, v248
v_max_f32 v224, 0, v224
v_min_f32 v224, s32, v224
v_log_f32 v248, v224
v_max3_f32 v232, v144, v145, v146
v_max3_f32 v232, v232, v147, v248
v_mov_b32 v248, v232
s_nop 1
v_permlane32_swap_b32 v232, v248
s_nop 1
v_max_f32 v232, v232, v248
v_mov_b32 v248, v232
s_nop 1
v_permlane16_swap_b32 v232, v248
s_nop 1
v_max_f32 v232, v232, v248
v_ceil_f32 v232, v232
v_max_f32 v232, 0, v232
v_sub_f32 v248, 0, v232
v_exp_f32 v236, v248
s_nop 1
v_mul_f32 v224, v224, v236
v_sub_f32 v192, v192, v232
v_sub_f32 v144, v144, v232
v_sub_f32 v128, v128, v232
v_sub_f32 v193, v193, v232
v_sub_f32 v145, v145, v232
v_sub_f32 v129, v129, v232
v_sub_f32 v194, v194, v232
v_sub_f32 v146, v146, v232
v_sub_f32 v130, v130, v232
v_sub_f32 v195, v195, v232
v_sub_f32 v147, v147, v232
v_sub_f32 v131, v131, v232
v_lshlrev_b32 v242, 16, v160
v_and_b32 v248, 0xffff0000, v160
v_mul_f32 v242, v242, v236
v_mul_f32 v248, v248, v236
v_cvt_pk_bf16_f32 v160, v242, v248
v_lshlrev_b32 v242, 16, v161
v_and_b32 v248, 0xffff0000, v161
v_mul_f32 v242, v242, v236
v_mul_f32 v248, v248, v236
v_cvt_pk_bf16_f32 v161, v242, v248
ds_read_b64 v[250:251], v231 offset:0
s_waitcnt lgkmcnt(0)
v_lshlrev_b32 v242, 16, v250
v_and_b32 v248, 0xffff0000, v250
v_mul_f32 v242, v242, v236
v_mul_f32 v248, v248, v236
v_cvt_pk_bf16_f32 v250, v242, v248
v_lshlrev_b32 v242, 16, v251
v_and_b32 v248, 0xffff0000, v251
v_mul_f32 v242, v242, v236
v_mul_f32 v248, v248, v236
v_cvt_pk_bf16_f32 v251, v242, v248
ds_write_b64 v231, v[250:251] offset:0
s_waitcnt lgkmcnt(0)
ds_read_b64 v[250:251], v231 offset:8
s_waitcnt lgkmcnt(0)
v_lshlrev_b32 v242, 16, v250
v_and_b32 v248, 0xffff0000, v250
v_mul_f32 v242, v242, v236
v_mul_f32 v248, v248, v236
v_cvt_pk_bf16_f32 v250, v242, v248
v_lshlrev_b32 v242, 16, v251
v_and_b32 v248, 0xffff0000, v251
v_mul_f32 v242, v242, v236
v_mul_f32 v248, v248, v236
v_cvt_pk_bf16_f32 v251, v242, v248
ds_write_b64 v231, v[250:251] offset:8
s_waitcnt lgkmcnt(0)
ds_read_b64 v[250:251], v231 offset:4096
s_waitcnt lgkmcnt(0)
v_lshlrev_b32 v242, 16, v250
v_and_b32 v248, 0xffff0000, v250
v_mul_f32 v242, v242, v236
v_mul_f32 v248, v248, v236
v_cvt_pk_bf16_f32 v250, v242, v248
v_lshlrev_b32 v242, 16, v251
v_and_b32 v248, 0xffff0000, v251
v_mul_f32 v242, v242, v236
v_mul_f32 v248, v248, v236
v_cvt_pk_bf16_f32 v251, v242, v248
ds_write_b64 v231, v[250:251] offset:4096
s_waitcnt lgkmcnt(0)
ds_read_b64 v[250:251], v231 offset:4104
s_waitcnt lgkmcnt(0)
v_lshlrev_b32 v242, 16, v250
v_and_b32 v248, 0xffff0000, v250
v_mul_f32 v242, v242, v236
v_mul_f32 v248, v248, v236
v_cvt_pk_bf16_f32 v250, v242, v248
v_lshlrev_b32 v242, 16, v251
v_and_b32 v248, 0xffff0000, v251
v_mul_f32 v242, v242, v236
v_mul_f32 v248, v248, v236
v_cvt_pk_bf16_f32 v251, v242, v248
ds_write_b64 v231, v[250:251] offset:4104
s_waitcnt lgkmcnt(0)
v_exp_f32 v248, v148
s_nop 0
v_sub_f32 v225, v225, v248
v_exp_f32 v248, v149
s_nop 0
v_sub_f32 v225, v225, v248
v_exp_f32 v248, v150
s_nop 0
v_sub_f32 v225, v225, v248
v_exp_f32 v248, v151
s_nop 0
v_sub_f32 v225, v225, v248
v_max_f32 v225, 0, v225
v_min_f32 v225, s32, v225
v_log_f32 v248, v225
v_max3_f32 v233, v148, v149, v150
v_max3_f32 v233, v233, v151, v248
v_mov_b32 v248, v233
s_nop 1
v_permlane32_swap_b32 v233, v248
s_nop 1
v_max_f32 v233, v233, v248
v_mov_b32 v248, v233
s_nop 1
v_permlane16_swap_b32 v233, v248
s_nop 1
v_max_f32 v233, v233, v248
v_ceil_f32 v233, v233
v_max_f32 v233, 0, v233
v_sub_f32 v248, 0, v233
v_exp_f32 v237, v248
s_nop 1
v_mul_f32 v225, v225, v237
v_sub_f32 v196, v196, v233
v_sub_f32 v148, v148, v233
v_sub_f32 v132, v132, v233
v_sub_f32 v197, v197, v233
v_sub_f32 v149, v149, v233
v_sub_f32 v133, v133, v233
v_sub_f32 v198, v198, v233
v_sub_f32 v150, v150, v233
v_sub_f32 v134, v134, v233
v_sub_f32 v199, v199, v233
v_sub_f32 v151, v151, v233
v_sub_f32 v135, v135, v233
v_lshlrev_b32 v242, 16, v164
v_and_b32 v248, 0xffff0000, v164
v_mul_f32 v242, v242, v237
v_mul_f32 v248, v248, v237
v_cvt_pk_bf16_f32 v164, v242, v248
v_lshlrev_b32 v242, 16, v165
v_and_b32 v248, 0xffff0000, v165
v_mul_f32 v242, v242, v237
v_mul_f32 v248, v248, v237
v_cvt_pk_bf16_f32 v165, v242, v248
ds_read_b64 v[250:251], v231 offset:1024
s_waitcnt lgkmcnt(0)
v_lshlrev_b32 v242, 16, v250
v_and_b32 v248, 0xffff0000, v250
v_mul_f32 v242, v242, v237
v_mul_f32 v248, v248, v237
v_cvt_pk_bf16_f32 v250, v242, v248
v_lshlrev_b32 v242, 16, v251
v_and_b32 v248, 0xffff0000, v251
v_mul_f32 v242, v242, v237
v_mul_f32 v248, v248, v237
v_cvt_pk_bf16_f32 v251, v242, v248
ds_write_b64 v231, v[250:251] offset:1024
s_waitcnt lgkmcnt(0)
ds_read_b64 v[250:251], v231 offset:1032
s_waitcnt lgkmcnt(0)
v_lshlrev_b32 v242, 16, v250
v_and_b32 v248, 0xffff0000, v250
v_mul_f32 v242, v242, v237
v_mul_f32 v248, v248, v237
v_cvt_pk_bf16_f32 v250, v242, v248
v_lshlrev_b32 v242, 16, v251
v_and_b32 v248, 0xffff0000, v251
v_mul_f32 v242, v242, v237
v_mul_f32 v248, v248, v237
v_cvt_pk_bf16_f32 v251, v242, v248
ds_write_b64 v231, v[250:251] offset:1032
s_waitcnt lgkmcnt(0)
ds_read_b64 v[250:251], v231 offset:5120
s_waitcnt lgkmcnt(0)
v_lshlrev_b32 v242, 16, v250
v_and_b32 v248, 0xffff0000, v250
v_mul_f32 v242, v242, v237
v_mul_f32 v248, v248, v237
v_cvt_pk_bf16_f32 v250, v242, v248
v_lshlrev_b32 v242, 16, v251
v_and_b32 v248, 0xffff0000, v251
v_mul_f32 v242, v242, v237
v_mul_f32 v248, v248, v237
v_cvt_pk_bf16_f32 v251, v242, v248
ds_write_b64 v231, v[250:251] offset:5120
s_waitcnt lgkmcnt(0)
ds_read_b64 v[250:251], v231 offset:5128
s_waitcnt lgkmcnt(0)
v_lshlrev_b32 v242, 16, v250
v_and_b32 v248, 0xffff0000, v250
v_mul_f32 v242, v242, v237
v_mul_f32 v248, v248, v237
v_cvt_pk_bf16_f32 v250, v242, v248
v_lshlrev_b32 v242, 16, v251
v_and_b32 v248, 0xffff0000, v251
v_mul_f32 v242, v242, v237
v_mul_f32 v248, v248, v237
v_cvt_pk_bf16_f32 v251, v242, v248
ds_write_b64 v231, v[250:251] offset:5128
s_waitcnt lgkmcnt(0)
v_exp_f32 v248, v152
s_nop 0
v_sub_f32 v226, v226, v248
v_exp_f32 v248, v153
s_nop 0
v_sub_f32 v226, v226, v248
v_exp_f32 v248, v154
s_nop 0
v_sub_f32 v226, v226, v248
v_exp_f32 v248, v155
s_nop 0
v_sub_f32 v226, v226, v248
v_max_f32 v226, 0, v226
v_min_f32 v226, s32, v226
v_log_f32 v248, v226
v_max3_f32 v234, v152, v153, v154
v_max3_f32 v234, v234, v155, v248
v_mov_b32 v248, v234
s_nop 1
v_permlane32_swap_b32 v234, v248
s_nop 1
v_max_f32 v234, v234, v248
v_mov_b32 v248, v234
s_nop 1
v_permlane16_swap_b32 v234, v248
s_nop 1
v_max_f32 v234, v234, v248
v_ceil_f32 v234, v234
v_max_f32 v234, 0, v234
v_sub_f32 v248, 0, v234
v_exp_f32 v238, v248
s_nop 1
v_mul_f32 v226, v226, v238
v_sub_f32 v200, v200, v234
v_sub_f32 v152, v152, v234
v_sub_f32 v136, v136, v234
v_sub_f32 v201, v201, v234
v_sub_f32 v153, v153, v234
v_sub_f32 v137, v137, v234
v_sub_f32 v202, v202, v234
v_sub_f32 v154, v154, v234
v_sub_f32 v138, v138, v234
v_sub_f32 v203, v203, v234
v_sub_f32 v155, v155, v234
v_sub_f32 v139, v139, v234
v_lshlrev_b32 v242, 16, v168
v_and_b32 v248, 0xffff0000, v168
v_mul_f32 v242, v242, v238
v_mul_f32 v248, v248, v238
v_cvt_pk_bf16_f32 v168, v242, v248
v_lshlrev_b32 v242, 16, v169
v_and_b32 v248, 0xffff0000, v169
v_mul_f32 v242, v242, v238
v_mul_f32 v248, v248, v238
v_cvt_pk_bf16_f32 v169, v242, v248
ds_read_b64 v[250:251], v231 offset:2048
s_waitcnt lgkmcnt(0)
v_lshlrev_b32 v242, 16, v250
v_and_b32 v248, 0xffff0000, v250
v_mul_f32 v242, v242, v238
v_mul_f32 v248, v248, v238
v_cvt_pk_bf16_f32 v250, v242, v248
v_lshlrev_b32 v242, 16, v251
v_and_b32 v248, 0xffff0000, v251
v_mul_f32 v242, v242, v238
v_mul_f32 v248, v248, v238
v_cvt_pk_bf16_f32 v251, v242, v248
ds_write_b64 v231, v[250:251] offset:2048
s_waitcnt lgkmcnt(0)
ds_read_b64 v[250:251], v231 offset:2056
s_waitcnt lgkmcnt(0)
v_lshlrev_b32 v242, 16, v250
v_and_b32 v248, 0xffff0000, v250
v_mul_f32 v242, v242, v238
v_mul_f32 v248, v248, v238
v_cvt_pk_bf16_f32 v250, v242, v248
v_lshlrev_b32 v242, 16, v251
v_and_b32 v248, 0xffff0000, v251
v_mul_f32 v242, v242, v238
v_mul_f32 v248, v248, v238
v_cvt_pk_bf16_f32 v251, v242, v248
ds_write_b64 v231, v[250:251] offset:2056
s_waitcnt lgkmcnt(0)
ds_read_b64 v[250:251], v231 offset:6144
s_waitcnt lgkmcnt(0)
v_lshlrev_b32 v242, 16, v250
v_and_b32 v248, 0xffff0000, v250
v_mul_f32 v242, v242, v238
v_mul_f32 v248, v248, v238
v_cvt_pk_bf16_f32 v250, v242, v248
v_lshlrev_b32 v242, 16, v251
v_and_b32 v248, 0xffff0000, v251
v_mul_f32 v242, v242, v238
v_mul_f32 v248, v248, v238
v_cvt_pk_bf16_f32 v251, v242, v248
ds_write_b64 v231, v[250:251] offset:6144
s_waitcnt lgkmcnt(0)
ds_read_b64 v[250:251], v231 offset:6152
s_waitcnt lgkmcnt(0)
v_lshlrev_b32 v242, 16, v250
v_and_b32 v248, 0xffff0000, v250
v_mul_f32 v242, v242, v238
v_mul_f32 v248, v248, v238
v_cvt_pk_bf16_f32 v250, v242, v248
v_lshlrev_b32 v242, 16, v251
v_and_b32 v248, 0xffff0000, v251
v_mul_f32 v242, v242, v238
v_mul_f32 v248, v248, v238
v_cvt_pk_bf16_f32 v251, v242, v248
ds_write_b64 v231, v[250:251] offset:6152
s_waitcnt lgkmcnt(0)
v_exp_f32 v248, v156
s_nop 0
v_sub_f32 v227, v227, v248
v_exp_f32 v248, v157
s_nop 0
v_sub_f32 v227, v227, v248
v_exp_f32 v248, v158
s_nop 0
v_sub_f32 v227, v227, v248
v_exp_f32 v248, v159
s_nop 0
v_sub_f32 v227, v227, v248
v_max_f32 v227, 0, v227
v_min_f32 v227, s32, v227
v_log_f32 v248, v227
v_max3_f32 v235, v156, v157, v158
v_max3_f32 v235, v235, v159, v248
v_mov_b32 v248, v235
s_nop 1
v_permlane32_swap_b32 v235, v248
s_nop 1
v_max_f32 v235, v235, v248
v_mov_b32 v248, v235
s_nop 1
v_permlane16_swap_b32 v235, v248
s_nop 1
v_max_f32 v235, v235, v248
v_ceil_f32 v235, v235
v_max_f32 v235, 0, v235
v_sub_f32 v248, 0, v235
v_exp_f32 v239, v248
s_nop 1
v_mul_f32 v227, v227, v239
v_sub_f32 v204, v204, v235
v_sub_f32 v156, v156, v235
v_sub_f32 v140, v140, v235
v_sub_f32 v205, v205, v235
v_sub_f32 v157, v157, v235
v_sub_f32 v141, v141, v235
v_sub_f32 v206, v206, v235
v_sub_f32 v158, v158, v235
v_sub_f32 v142, v142, v235
v_sub_f32 v207, v207, v235
v_sub_f32 v159, v159, v235
v_sub_f32 v143, v143, v235
v_lshlrev_b32 v242, 16, v172
v_and_b32 v248, 0xffff0000, v172
v_mul_f32 v242, v242, v239
v_mul_f32 v248, v248, v239
v_cvt_pk_bf16_f32 v172, v242, v248
v_lshlrev_b32 v242, 16, v173
v_and_b32 v248, 0xffff0000, v173
v_mul_f32 v242, v242, v239
v_mul_f32 v248, v248, v239
v_cvt_pk_bf16_f32 v173, v242, v248
ds_read_b64 v[250:251], v231 offset:3072
s_waitcnt lgkmcnt(0)
v_lshlrev_b32 v242, 16, v250
v_and_b32 v248, 0xffff0000, v250
v_mul_f32 v242, v242, v239
v_mul_f32 v248, v248, v239
v_cvt_pk_bf16_f32 v250, v242, v248
v_lshlrev_b32 v242, 16, v251
v_and_b32 v248, 0xffff0000, v251
v_mul_f32 v242, v242, v239
v_mul_f32 v248, v248, v239
v_cvt_pk_bf16_f32 v251, v242, v248
ds_write_b64 v231, v[250:251] offset:3072
s_waitcnt lgkmcnt(0)
ds_read_b64 v[250:251], v231 offset:3080
s_waitcnt lgkmcnt(0)
v_lshlrev_b32 v242, 16, v250
v_and_b32 v248, 0xffff0000, v250
v_mul_f32 v242, v242, v239
v_mul_f32 v248, v248, v239
v_cvt_pk_bf16_f32 v250, v242, v248
v_lshlrev_b32 v242, 16, v251
v_and_b32 v248, 0xffff0000, v251
v_mul_f32 v242, v242, v239
v_mul_f32 v248, v248, v239
v_cvt_pk_bf16_f32 v251, v242, v248
ds_write_b64 v231, v[250:251] offset:3080
s_waitcnt lgkmcnt(0)
ds_read_b64 v[250:251], v231 offset:7168
s_waitcnt lgkmcnt(0)
v_lshlrev_b32 v242, 16, v250
v_and_b32 v248, 0xffff0000, v250
v_mul_f32 v242, v242, v239
v_mul_f32 v248, v248, v239
v_cvt_pk_bf16_f32 v250, v242, v248
v_lshlrev_b32 v242, 16, v251
v_and_b32 v248, 0xffff0000, v251
v_mul_f32 v242, v242, v239
v_mul_f32 v248, v248, v239
v_cvt_pk_bf16_f32 v251, v242, v248
ds_write_b64 v231, v[250:251] offset:7168
s_waitcnt lgkmcnt(0)
ds_read_b64 v[250:251], v231 offset:7176
s_waitcnt lgkmcnt(0)
v_lshlrev_b32 v242, 16, v250
v_and_b32 v248, 0xffff0000, v250
v_mul_f32 v242, v242, v239
v_mul_f32 v248, v248, v239
v_cvt_pk_bf16_f32 v250, v242, v248
v_lshlrev_b32 v242, 16, v251
v_and_b32 v248, 0xffff0000, v251
v_mul_f32 v242, v242, v239
v_mul_f32 v248, v248, v239
v_cvt_pk_bf16_f32 v251, v242, v248
ds_write_b64 v231, v[250:251] offset:7176
s_waitcnt lgkmcnt(0)
v_exp_f32 v232, v144
v_exp_f32 v233, v145
v_exp_f32 v234, v146
v_exp_f32 v235, v147
s_nop 1
v_add_f32 v224, v224, v232
v_add_f32 v224, v224, v233
v_add_f32 v224, v224, v234
v_add_f32 v224, v224, v235
v_cvt_pk_bf16_f32 v162, v232, v233
v_cvt_pk_bf16_f32 v163, v234, v235
v_exp_f32 v232, v148
v_exp_f32 v233, v149
v_exp_f32 v234, v150
v_exp_f32 v235, v151
s_nop 1
v_add_f32 v225, v225, v232
v_add_f32 v225, v225, v233
v_add_f32 v225, v225, v234
v_add_f32 v225, v225, v235
v_cvt_pk_bf16_f32 v166, v232, v233
v_cvt_pk_bf16_f32 v167, v234, v235
v_exp_f32 v232, v152
v_exp_f32 v233, v153
v_exp_f32 v234, v154
v_exp_f32 v235, v155
s_nop 1
v_add_f32 v226, v226, v232
v_add_f32 v226, v226, v233
v_add_f32 v226, v226, v234
v_add_f32 v226, v226, v235
v_cvt_pk_bf16_f32 v170, v232, v233
v_cvt_pk_bf16_f32 v171, v234, v235
v_exp_f32 v232, v156
v_exp_f32 v233, v157
v_exp_f32 v234, v158
v_exp_f32 v235, v159
s_nop 1
v_add_f32 v227, v227, v232
v_add_f32 v227, v227, v233
v_add_f32 v227, v227, v234
v_add_f32 v227, v227, v235
v_cvt_pk_bf16_f32 v174, v232, v233
v_cvt_pk_bf16_f32 v175, v234, v235
s_branch L2_rare_common
L2_rare_site14:
s_mov_b32 s36, 14
s_branch L2_rare_t0_2_0
L2_rare_t0_2_0:
s_nop 15
s_nop 15
s_waitcnt lgkmcnt(0)
v_exp_f32 v248, v128
s_nop 0
v_sub_f32 v224, v224, v248
v_exp_f32 v248, v129
s_nop 0
v_sub_f32 v224, v224, v248
v_exp_f32 v248, v130
s_nop 0
v_sub_f32 v224, v224, v248
v_exp_f32 v248, v131
s_nop 0
v_sub_f32 v224, v224, v248
v_max_f32 v224, 0, v224
v_min_f32 v224, s32, v224
v_log_f32 v248, v224
v_max3_f32 v232, v128, v129, v130
v_max3_f32 v232, v232, v131, v248
v_mov_b32 v248, v232
s_nop 1
v_permlane32_swap_b32 v232, v248
s_nop 1
v_max_f32 v232, v232, v248
v_mov_b32 v248, v232
s_nop 1
v_permlane16_swap_b32 v232, v248
s_nop 1
v_max_f32 v232, v232, v248
v_ceil_f32 v232, v232
v_max_f32 v232, 0, v232
v_sub_f32 v248, 0, v232
v_exp_f32 v236, v248
s_nop 1
v_mul_f32 v224, v224, v236
v_sub_f32 v192, v192, v232
v_sub_f32 v128, v128, v232
v_sub_f32 v144, v144, v232
v_sub_f32 v193, v193, v232
v_sub_f32 v129, v129, v232
v_sub_f32 v145, v145, v232
v_sub_f32 v194, v194, v232
v_sub_f32 v130, v130, v232
v_sub_f32 v146, v146, v232
v_sub_f32 v195, v195, v232
v_sub_f32 v131, v131, v232
v_sub_f32 v147, v147, v232
v_lshlrev_b32 v242, 16, v160
v_and_b32 v248, 0xffff0000, v160
v_mul_f32 v242, v242, v236
v_mul_f32 v248, v248, v236
v_cvt_pk_bf16_f32 v160, v242, v248
v_lshlrev_b32 v242, 16, v161
v_and_b32 v248, 0xffff0000, v161
v_mul_f32 v242, v242, v236
v_mul_f32 v248, v248, v236
v_cvt_pk_bf16_f32 v161, v242, v248
v_lshlrev_b32 v242, 16, v162
v_and_b32 v248, 0xffff0000, v162
v_mul_f32 v242, v242, v236
v_mul_f32 v248, v248, v236
v_cvt_pk_bf16_f32 v162, v242, v248
v_lshlrev_b32 v242, 16, v163
v_and_b32 v248, 0xffff0000, v163
v_mul_f32 v242, v242, v236
v_mul_f32 v248, v248, v236
v_cvt_pk_bf16_f32 v163, v242, v248
ds_read_b64 v[250:251], v231 offset:0
s_waitcnt lgkmcnt(0)
v_lshlrev_b32 v242, 16, v250
v_and_b32 v248, 0xffff0000, v250
v_mul_f32 v242, v242, v236
v_mul_f32 v248, v248, v236
v_cvt_pk_bf16_f32 v250, v242, v248
v_lshlrev_b32 v242, 16, v251
v_and_b32 v248, 0xffff0000, v251
v_mul_f32 v242, v242, v236
v_mul_f32 v248, v248, v236
v_cvt_pk_bf16_f32 v251, v242, v248
ds_write_b64 v231, v[250:251] offset:0
s_waitcnt lgkmcnt(0)
ds_read_b64 v[250:251], v231 offset:8
s_waitcnt lgkmcnt(0)
v_lshlrev_b32 v242, 16, v250
v_and_b32 v248, 0xffff0000, v250
v_mul_f32 v242, v242, v236
v_mul_f32 v248, v248, v236
v_cvt_pk_bf16_f32 v250, v242, v248
v_lshlrev_b32 v242, 16, v251
v_and_b32 v248, 0xffff0000, v251
v_mul_f32 v242, v242, v236
v_mul_f32 v248, v248, v236
v_cvt_pk_bf16_f32 v251, v242, v248
ds_write_b64 v231, v[250:251] offset:8
s_waitcnt lgkmcnt(0)
ds_read_b64 v[250:251], v231 offset:4096
s_waitcnt lgkmcnt(0)
v_lshlrev_b32 v242, 16, v250
v_and_b32 v248, 0xffff0000, v250
v_mul_f32 v242, v242, v236
v_mul_f32 v248, v248, v236
v_cvt_pk_bf16_f32 v250, v242, v248
v_lshlrev_b32 v242, 16, v251
v_and_b32 v248, 0xffff0000, v251
v_mul_f32 v242, v242, v236
v_mul_f32 v248, v248, v236
v_cvt_pk_bf16_f32 v251, v242, v248
ds_write_b64 v231, v[250:251] offset:4096
s_waitcnt lgkmcnt(0)
ds_read_b64 v[250:251], v231 offset:4104
s_waitcnt lgkmcnt(0)
v_lshlrev_b32 v242, 16, v250
v_and_b32 v248, 0xffff0000, v250
v_mul_f32 v242, v242, v236
v_mul_f32 v248, v248, v236
v_cvt_pk_bf16_f32 v250, v242, v248
v_lshlrev_b32 v242, 16, v251
v_and_b32 v248, 0xffff0000, v251
v_mul_f32 v242, v242, v236
v_mul_f32 v248, v248, v236
v_cvt_pk_bf16_f32 v251, v242, v248
ds_write_b64 v231, v[250:251] offset:4104
s_waitcnt lgkmcnt(0)
v_exp_f32 v248, v132
s_nop 0
v_sub_f32 v225, v225, v248
v_exp_f32 v248, v133
s_nop 0
v_sub_f32 v225, v225, v248
v_exp_f32 v248, v134
s_nop 0
v_sub_f32 v225, v225, v248
v_exp_f32 v248, v135
s_nop 0
v_sub_f32 v225, v225, v248
v_max_f32 v225, 0, v225
v_min_f32 v225, s32, v225
v_log_f32 v248, v225
v_max3_f32 v233, v132, v133, v134
v_max3_f32 v233, v233, v135, v248
v_mov_b32 v248, v233
s_nop 1
v_permlane32_swap_b32 v233, v248
s_nop 1
v_max_f32 v233, v233, v248
v_mov_b32 v248, v233
s_nop 1
v_permlane16_swap_b32 v233, v248
s_nop 1
v_max_f32 v233, v233, v248
v_ceil_f32 v233, v233
v_max_f32 v233, 0, v233
v_sub_f32 v248, 0, v233
v_exp_f32 v237, v248
s_nop 1
v_mul_f32 v225, v225, v237
v_sub_f32 v196, v196, v233
v_sub_f32 v132, v132, v233
v_sub_f32 v148, v148, v233
v_sub_f32 v197, v197, v233
v_sub_f32 v133, v133, v233
v_sub_f32 v149, v149, v233
v_sub_f32 v198, v198, v233
v_sub_f32 v134, v134, v233
v_sub_f32 v150, v150, v233
v_sub_f32 v199, v199, v233
v_sub_f32 v135, v135, v233
v_sub_f32 v151, v151, v233
v_lshlrev_b32 v242, 16, v164
v_and_b32 v248, 0xffff0000, v164
v_mul_f32 v242, v242, v237
v_mul_f32 v248, v248, v237
v_cvt_pk_bf16_f32 v164, v242, v248
v_lshlrev_b32 v242, 16, v165
v_and_b32 v248, 0xffff0000, v165
v_mul_f32 v242, v242, v237
v_mul_f32 v248, v248, v237
v_cvt_pk_bf16_f32 v165, v242, v248
v_lshlrev_b32 v242, 16, v166
v_and_b32 v248, 0xffff0000, v166
v_mul_f32 v242, v242, v237
v_mul_f32 v248, v248, v237
v_cvt_pk_bf16_f32 v166, v242, v248
v_lshlrev_b32 v242, 16, v167
v_and_b32 v248, 0xffff0000, v167
v_mul_f32 v242, v242, v237
v_mul_f32 v248, v248, v237
v_cvt_pk_bf16_f32 v167, v242, v248
ds_read_b64 v[250:251], v231 offset:1024
s_waitcnt lgkmcnt(0)
v_lshlrev_b32 v242, 16, v250
v_and_b32 v248, 0xffff0000, v250
v_mul_f32 v242, v242, v237
v_mul_f32 v248, v248, v237
v_cvt_pk_bf16_f32 v250, v242, v248
v_lshlrev_b32 v242, 16, v251
v_and_b32 v248, 0xffff0000, v251
v_mul_f32 v242, v242, v237
v_mul_f32 v248, v248, v237
v_cvt_pk_bf16_f32 v251, v242, v248
ds_write_b64 v231, v[250:251] offset:1024
s_waitcnt lgkmcnt(0)
ds_read_b64 v[250:251], v231 offset:1032
s_waitcnt lgkmcnt(0)
v_lshlrev_b32 v242, 16, v250
v_and_b32 v248, 0xffff0000, v250
v_mul_f32 v242, v242, v237
v_mul_f32 v248, v248, v237
v_cvt_pk_bf16_f32 v250, v242, v248
v_lshlrev_b32 v242, 16, v251
v_and_b32 v248, 0xffff0000, v251
v_mul_f32 v242, v242, v237
v_mul_f32 v248, v248, v237
v_cvt_pk_bf16_f32 v251, v242, v248
ds_write_b64 v231, v[250:251] offset:1032
s_waitcnt lgkmcnt(0)
ds_read_b64 v[250:251], v231 offset:5120
s_waitcnt lgkmcnt(0)
v_lshlrev_b32 v242, 16, v250
v_and_b32 v248, 0xffff0000, v250
v_mul_f32 v242, v242, v237
v_mul_f32 v248, v248, v237
v_cvt_pk_bf16_f32 v250, v242, v248
v_lshlrev_b32 v242, 16, v251
v_and_b32 v248, 0xffff0000, v251
v_mul_f32 v242, v242, v237
v_mul_f32 v248, v248, v237
v_cvt_pk_bf16_f32 v251, v242, v248
ds_write_b64 v231, v[250:251] offset:5120
s_waitcnt lgkmcnt(0)
ds_read_b64 v[250:251], v231 offset:5128
s_waitcnt lgkmcnt(0)
v_lshlrev_b32 v242, 16, v250
v_and_b32 v248, 0xffff0000, v250
v_mul_f32 v242, v242, v237
v_mul_f32 v248, v248, v237
v_cvt_pk_bf16_f32 v250, v242, v248
v_lshlrev_b32 v242, 16, v251
v_and_b32 v248, 0xffff0000, v251
v_mul_f32 v242, v242, v237
v_mul_f32 v248, v248, v237
v_cvt_pk_bf16_f32 v251, v242, v248
ds_write_b64 v231, v[250:251] offset:5128
s_waitcnt lgkmcnt(0)
v_exp_f32 v248, v136
s_nop 0
v_sub_f32 v226, v226, v248
v_exp_f32 v248, v137
s_nop 0
v_sub_f32 v226, v226, v248
v_exp_f32 v248, v138
s_nop 0
v_sub_f32 v226, v226, v248
v_exp_f32 v248, v139
s_nop 0
v_sub_f32 v226, v226, v248
v_max_f32 v226, 0, v226
v_min_f32 v226, s32, v226
v_log_f32 v248, v226
v_max3_f32 v234, v136, v137, v138
v_max3_f32 v234, v234, v139, v248
v_mov_b32 v248, v234
s_nop 1
v_permlane32_swap_b32 v234, v248
s_nop 1
v_max_f32 v234, v234, v248
v_mov_b32 v248, v234
s_nop 1
v_permlane16_swap_b32 v234, v248
s_nop 1
v_max_f32 v234, v234, v248
v_ceil_f32 v234, v234
v_max_f32 v234, 0, v234
v_sub_f32 v248, 0, v234
v_exp_f32 v238, v248
s_nop 1
v_mul_f32 v226, v226, v238
v_sub_f32 v200, v200, v234
v_sub_f32 v136, v136, v234
v_sub_f32 v152, v152, v234
v_sub_f32 v201, v201, v234
v_sub_f32 v137, v137, v234
v_sub_f32 v153, v153, v234
v_sub_f32 v202, v202, v234
v_sub_f32 v138, v138, v234
v_sub_f32 v154, v154, v234
v_sub_f32 v203, v203, v234
v_sub_f32 v139, v139, v234
v_sub_f32 v155, v155, v234
v_lshlrev_b32 v242, 16, v168
v_and_b32 v248, 0xffff0000, v168
v_mul_f32 v242, v242, v238
v_mul_f32 v248, v248, v238
v_cvt_pk_bf16_f32 v168, v242, v248
v_lshlrev_b32 v242, 16, v169
v_and_b32 v248, 0xffff0000, v169
v_mul_f32 v242, v242, v238
v_mul_f32 v248, v248, v238
v_cvt_pk_bf16_f32 v169, v242, v248
v_lshlrev_b32 v242, 16, v170
v_and_b32 v248, 0xffff0000, v170
v_mul_f32 v242, v242, v238
v_mul_f32 v248, v248, v238
v_cvt_pk_bf16_f32 v170, v242, v248
v_lshlrev_b32 v242, 16, v171
v_and_b32 v248, 0xffff0000, v171
v_mul_f32 v242, v242, v238
v_mul_f32 v248, v248, v238
v_cvt_pk_bf16_f32 v171, v242, v248
ds_read_b64 v[250:251], v231 offset:2048
s_waitcnt lgkmcnt(0)
v_lshlrev_b32 v242, 16, v250
v_and_b32 v248, 0xffff0000, v250
v_mul_f32 v242, v242, v238
v_mul_f32 v248, v248, v238
v_cvt_pk_bf16_f32 v250, v242, v248
v_lshlrev_b32 v242, 16, v251
v_and_b32 v248, 0xffff0000, v251
v_mul_f32 v242, v242, v238
v_mul_f32 v248, v248, v238
v_cvt_pk_bf16_f32 v251, v242, v248
ds_write_b64 v231, v[250:251] offset:2048
s_waitcnt lgkmcnt(0)
ds_read_b64 v[250:251], v231 offset:2056
s_waitcnt lgkmcnt(0)
v_lshlrev_b32 v242, 16, v250
v_and_b32 v248, 0xffff0000, v250
v_mul_f32 v242, v242, v238
v_mul_f32 v248, v248, v238
v_cvt_pk_bf16_f32 v250, v242, v248
v_lshlrev_b32 v242, 16, v251
v_and_b32 v248, 0xffff0000, v251
v_mul_f32 v242, v242, v238
v_mul_f32 v248, v248, v238
v_cvt_pk_bf16_f32 v251, v242, v248
ds_write_b64 v231, v[250:251] offset:2056
s_waitcnt lgkmcnt(0)
ds_read_b64 v[250:251], v231 offset:6144
s_waitcnt lgkmcnt(0)
v_lshlrev_b32 v242, 16, v250
v_and_b32 v248, 0xffff0000, v250
v_mul_f32 v242, v242, v238
v_mul_f32 v248, v248, v238
v_cvt_pk_bf16_f32 v250, v242, v248
v_lshlrev_b32 v242, 16, v251
v_and_b32 v248, 0xffff0000, v251
v_mul_f32 v242, v242, v238
v_mul_f32 v248, v248, v238
v_cvt_pk_bf16_f32 v251, v242, v248
ds_write_b64 v231, v[250:251] offset:6144
s_waitcnt lgkmcnt(0)
ds_read_b64 v[250:251], v231 offset:6152
s_waitcnt lgkmcnt(0)
v_lshlrev_b32 v242, 16, v250
v_and_b32 v248, 0xffff0000, v250
v_mul_f32 v242, v242, v238
v_mul_f32 v248, v248, v238
v_cvt_pk_bf16_f32 v250, v242, v248
v_lshlrev_b32 v242, 16, v251
v_and_b32 v248, 0xffff0000, v251
v_mul_f32 v242, v242, v238
v_mul_f32 v248, v248, v238
v_cvt_pk_bf16_f32 v251, v242, v248
ds_write_b64 v231, v[250:251] offset:6152
s_waitcnt lgkmcnt(0)
v_exp_f32 v248, v140
s_nop 0
v_sub_f32 v227, v227, v248
v_exp_f32 v248, v141
s_nop 0
v_sub_f32 v227, v227, v248
v_exp_f32 v248, v142
s_nop 0
v_sub_f32 v227, v227, v248
v_exp_f32 v248, v143
s_nop 0
v_sub_f32 v227, v227, v248
v_max_f32 v227, 0, v227
v_min_f32 v227, s32, v227
v_log_f32 v248, v227
v_max3_f32 v235, v140, v141, v142
v_max3_f32 v235, v235, v143, v248
v_mov_b32 v248, v235
s_nop 1
v_permlane32_swap_b32 v235, v248
s_nop 1
v_max_f32 v235, v235, v248
v_mov_b32 v248, v235
s_nop 1
v_permlane16_swap_b32 v235, v248
s_nop 1
v_max_f32 v235, v235, v248
v_ceil_f32 v235, v235
v_max_f32 v235, 0, v235
v_sub_f32 v248, 0, v235
v_exp_f32 v239, v248
s_nop 1
v_mul_f32 v227, v227, v239
v_sub_f32 v204, v204, v235
v_sub_f32 v140, v140, v235
v_sub_f32 v156, v156, v235
v_sub_f32 v205, v205, v235
v_sub_f32 v141, v141, v235
v_sub_f32 v157, v157, v235
v_sub_f32 v206, v206, v235
v_sub_f32 v142, v142, v235
v_sub_f32 v158, v158, v235
v_sub_f32 v207, v207, v235
v_sub_f32 v143, v143, v235
v_sub_f32 v159, v159, v235
v_lshlrev_b32 v242, 16, v172
v_and_b32 v248, 0xffff0000, v172
v_mul_f32 v242, v242, v239
v_mul_f32 v248, v248, v239
v_cvt_pk_bf16_f32 v172, v242, v248
v_lshlrev_b32 v242, 16, v173
v_and_b32 v248, 0xffff0000, v173
v_mul_f32 v242, v242, v239
v_mul_f32 v248, v248, v239
v_cvt_pk_bf16_f32 v173, v242, v248
v_lshlrev_b32 v242, 16, v174
v_and_b32 v248, 0xffff0000, v174
v_mul_f32 v242, v242, v239
v_mul_f32 v248, v248, v239
v_cvt_pk_bf16_f32 v174, v242, v248
v_lshlrev_b32 v242, 16, v175
v_and_b32 v248, 0xffff0000, v175
v_mul_f32 v242, v242, v239
v_mul_f32 v248, v248, v239
v_cvt_pk_bf16_f32 v175, v242, v248
ds_read_b64 v[250:251], v231 offset:3072
s_waitcnt lgkmcnt(0)
v_lshlrev_b32 v242, 16, v250
v_and_b32 v248, 0xffff0000, v250
v_mul_f32 v242, v242, v239
v_mul_f32 v248, v248, v239
v_cvt_pk_bf16_f32 v250, v242, v248
v_lshlrev_b32 v242, 16, v251
v_and_b32 v248, 0xffff0000, v251
v_mul_f32 v242, v242, v239
v_mul_f32 v248, v248, v239
v_cvt_pk_bf16_f32 v251, v242, v248
ds_write_b64 v231, v[250:251] offset:3072
s_waitcnt lgkmcnt(0)
ds_read_b64 v[250:251], v231 offset:3080
s_waitcnt lgkmcnt(0)
v_lshlrev_b32 v242, 16, v250
v_and_b32 v248, 0xffff0000, v250
v_mul_f32 v242, v242, v239
v_mul_f32 v248, v248, v239
v_cvt_pk_bf16_f32 v250, v242, v248
v_lshlrev_b32 v242, 16, v251
v_and_b32 v248, 0xffff0000, v251
v_mul_f32 v242, v242, v239
v_mul_f32 v248, v248, v239
v_cvt_pk_bf16_f32 v251, v242, v248
ds_write_b64 v231, v[250:251] offset:3080
s_waitcnt lgkmcnt(0)
ds_read_b64 v[250:251], v231 offset:7168
s_waitcnt lgkmcnt(0)
v_lshlrev_b32 v242, 16, v250
v_and_b32 v248, 0xffff0000, v250
v_mul_f32 v242, v242, v239
v_mul_f32 v248, v248, v239
v_cvt_pk_bf16_f32 v250, v242, v248
v_lshlrev_b32 v242, 16, v251
v_and_b32 v248, 0xffff0000, v251
v_mul_f32 v242, v242, v239
v_mul_f32 v248, v248, v239
v_cvt_pk_bf16_f32 v251, v242, v248
ds_write_b64 v231, v[250:251] offset:7168
s_waitcnt lgkmcnt(0)
ds_read_b64 v[250:251], v231 offset:7176
s_waitcnt lgkmcnt(0)
v_lshlrev_b32 v242, 16, v250
v_and_b32 v248, 0xffff0000, v250
v_mul_f32 v242, v242, v239
v_mul_f32 v248, v248, v239
v_cvt_pk_bf16_f32 v250, v242, v248
v_lshlrev_b32 v242, 16, v251
v_and_b32 v248, 0xffff0000, v251
v_mul_f32 v242, v242, v239
v_mul_f32 v248, v248, v239
v_cvt_pk_bf16_f32 v251, v242, v248
ds_write_b64 v231, v[250:251] offset:7176
s_waitcnt lgkmcnt(0)
v_exp_f32 v232, v128
v_exp_f32 v233, v129
v_exp_f32 v234, v130
v_exp_f32 v235, v131
s_nop 1
v_add_f32 v224, v224, v232
v_add_f32 v224, v224, v233
v_add_f32 v224, v224, v234
v_add_f32 v224, v224, v235
v_cvt_pk_bf16_f32 v176, v232, v233
v_cvt_pk_bf16_f32 v177, v234, v235
v_exp_f32 v232, v132
v_exp_f32 v233, v133
v_exp_f32 v234, v134
v_exp_f32 v235, v135
s_nop 1
v_add_f32 v225, v225, v232
v_add_f32 v225, v225, v233
v_add_f32 v225, v225, v234
v_add_f32 v225, v225, v235
v_cvt_pk_bf16_f32 v180, v232, v233
v_cvt_pk_bf16_f32 v181, v234, v235
v_exp_f32 v232, v136
v_exp_f32 v233, v137
v_exp_f32 v234, v138
v_exp_f32 v235, v139
s_nop 1
v_add_f32 v226, v226, v232
v_add_f32 v226, v226, v233
v_add_f32 v226, v226, v234
v_add_f32 v226, v226, v235
v_cvt_pk_bf16_f32 v184, v232, v233
v_cvt_pk_bf16_f32 v185, v234, v235
v_exp_f32 v232, v140
v_exp_f32 v233, v141
v_exp_f32 v234, v142
v_exp_f32 v235, v143
s_nop 1
v_add_f32 v227, v227, v232
v_add_f32 v227, v227, v233
v_add_f32 v227, v227, v234
v_add_f32 v227, v227, v235
v_cvt_pk_bf16_f32 v188, v232, v233
v_cvt_pk_bf16_f32 v189, v234, v235
s_branch L2_rare_common
L2_rare_site15:
s_mov_b32 s36, 15
s_branch L2_rare_t0_3_1
L2_rare_t0_3_1:
s_nop 15
s_nop 15
s_waitcnt lgkmcnt(0)
v_exp_f32 v248, v144
s_nop 0
v_sub_f32 v224, v224, v248
v_exp_f32 v248, v145
s_nop 0
v_sub_f32 v224, v224, v248
v_exp_f32 v248, v146
s_nop 0
v_sub_f32 v224, v224, v248
v_exp_f32 v248, v147
s_nop 0
v_sub_f32 v224, v224, v248
v_max_f32 v224, 0, v224
v_min_f32 v224, s32, v224
v_log_f32 v248, v224
v_max3_f32 v232, v144, v145, v146
v_max3_f32 v232, v232, v147, v248
v_mov_b32 v248, v232
s_nop 1
v_permlane32_swap_b32 v232, v248
s_nop 1
v_max_f32 v232, v232, v248
v_mov_b32 v248, v232
s_nop 1
v_permlane16_swap_b32 v232, v248
s_nop 1
v_max_f32 v232, v232, v248
v_ceil_f32 v232, v232
v_max_f32 v232, 0, v232
v_sub_f32 v248, 0, v232
v_exp_f32 v236, v248
s_nop 1
v_mul_f32 v224, v224, v236
v_sub_f32 v192, v192, v232
v_sub_f32 v144, v144, v232
v_sub_f32 v128, v128, v232
v_sub_f32 v193, v193, v232
v_sub_f32 v145, v145, v232
v_sub_f32 v129, v129, v232
v_sub_f32 v194, v194, v232
v_sub_f32 v146, v146, v232
v_sub_f32 v130, v130, v232
v_sub_f32 v195, v195, v232
v_sub_f32 v147, v147, v232
v_sub_f32 v131, v131, v232
v_lshlrev_b32 v242, 16, v160
v_and_b32 v248, 0xffff0000, v160
v_mul_f32 v242, v242, v236
v_mul_f32 v248, v248, v236
v_cvt_pk_bf16_f32 v160, v242, v248
v_lshlrev_b32 v242, 16, v161
v_and_b32 v248, 0xffff0000, v161
v_mul_f32 v242, v242, v236
v_mul_f32 v248, v248, v236
v_cvt_pk_bf16_f32 v161, v242, v248
v_lshlrev_b32 v242, 16, v162
v_and_b32 v248, 0xffff0000, v162
v_mul_f32 v242, v242, v236
v_mul_f32 v248, v248, v236
v_cvt_pk_bf16_f32 v162, v242, v248
v_lshlrev_b32 v242, 16, v163
v_and_b32 v248, 0xffff0000, v163
v_mul_f32 v242, v242, v236
v_mul_f32 v248, v248, v236
v_cvt_pk_bf16_f32 v163, v242, v248
v_lshlrev_b32 v242, 16, v176
v_and_b32 v248, 0xffff0000, v176
v_mul_f32 v242, v242, v236
v_mul_f32 v248, v248, v236
v_cvt_pk_bf16_f32 v176, v242, v248
v_lshlrev_b32 v242, 16, v177
v_and_b32 v248, 0xffff0000, v177
v_mul_f32 v242, v242, v236
v_mul_f32 v248, v248, v236
v_cvt_pk_bf16_f32 v177, v242, v248
ds_read_b64 v[250:251], v231 offset:0
s_waitcnt lgkmcnt(0)
v_lshlrev_b32 v242, 16, v250
v_and_b32 v248, 0xffff0000, v250
v_mul_f32 v242, v242, v236
v_mul_f32 v248, v248, v236
v_cvt_pk_bf16_f32 v250, v242, v248
v_lshlrev_b32 v242, 16, v251
v_and_b32 v248, 0xffff0000, v251
v_mul_f32 v242, v242, v236
v_mul_f32 v248, v248, v236
v_cvt_pk_bf16_f32 v251, v242, v248
ds_write_b64 v231, v[250:251] offset:0
s_waitcnt lgkmcnt(0)
ds_read_b64 v[250:251], v231 offset:8
s_waitcnt lgkmcnt(0)
v_lshlrev_b32 v242, 16, v250
v_and_b32 v248, 0xffff0000, v250
v_mul_f32 v242, v242, v236
v_mul_f32 v248, v248, v236
v_cvt_pk_bf16_f32 v250, v242, v248
v_lshlrev_b32 v242, 16, v251
v_and_b32 v248, 0xffff0000, v251
v_mul_f32 v242, v242, v236
v_mul_f32 v248, v248, v236
v_cvt_pk_bf16_f32 v251, v242, v248
ds_write_b64 v231, v[250:251] offset:8
s_waitcnt lgkmcnt(0)
ds_read_b64 v[250:251], v231 offset:4096
s_waitcnt lgkmcnt(0)
v_lshlrev_b32 v242, 16, v250
v_and_b32 v248, 0xffff0000, v250
v_mul_f32 v242, v242, v236
v_mul_f32 v248, v248, v236
v_cvt_pk_bf16_f32 v250, v242, v248
v_lshlrev_b32 v242, 16, v251
v_and_b32 v248, 0xffff0000, v251
v_mul_f32 v242, v242, v236
v_mul_f32 v248, v248, v236
v_cvt_pk_bf16_f32 v251, v242, v248
ds_write_b64 v231, v[250:251] offset:4096
s_waitcnt lgkmcnt(0)
ds_read_b64 v[250:251], v231 offset:4104
s_waitcnt lgkmcnt(0)
v_lshlrev_b32 v242, 16, v250
v_and_b32 v248, 0xffff0000, v250
v_mul_f32 v242, v242, v236
v_mul_f32 v248, v248, v236
v_cvt_pk_bf16_f32 v250, v242, v248
v_lshlrev_b32 v242, 16, v251
v_and_b32 v248, 0xffff0000, v251
v_mul_f32 v242, v242, v236
v_mul_f32 v248, v248, v236
v_cvt_pk_bf16_f32 v251, v242, v248
ds_write_b64 v231, v[250:251] offset:4104
s_waitcnt lgkmcnt(0)
v_exp_f32 v248, v148
s_nop 0
v_sub_f32 v225, v225, v248
v_exp_f32 v248, v149
s_nop 0
v_sub_f32 v225, v225, v248
v_exp_f32 v248, v150
s_nop 0
v_sub_f32 v225, v225, v248
v_exp_f32 v248, v151
s_nop 0
v_sub_f32 v225, v225, v248
v_max_f32 v225, 0, v225
v_min_f32 v225, s32, v225
v_log_f32 v248, v225
v_max3_f32 v233, v148, v149, v150
v_max3_f32 v233, v233, v151, v248
v_mov_b32 v248, v233
s_nop 1
v_permlane32_swap_b32 v233, v248
s_nop 1
v_max_f32 v233, v233, v248
v_mov_b32 v248, v233
s_nop 1
v_permlane16_swap_b32 v233, v248
s_nop 1
v_max_f32 v233, v233, v248
v_ceil_f32 v233, v233
v_max_f32 v233, 0, v233
v_sub_f32 v248, 0, v233
v_exp_f32 v237, v248
s_nop 1
v_mul_f32 v225, v225, v237
v_sub_f32 v196, v196, v233
v_sub_f32 v148, v148, v233
v_sub_f32 v132, v132, v233
v_sub_f32 v197, v197, v233
v_sub_f32 v149, v149, v233
v_sub_f32 v133, v133, v233
v_sub_f32 v198, v198, v233
v_sub_f32 v150, v150, v233
v_sub_f32 v134, v134, v233
v_sub_f32 v199, v199, v233
v_sub_f32 v151, v151, v233
v_sub_f32 v135, v135, v233
v_lshlrev_b32 v242, 16, v164
v_and_b32 v248, 0xffff0000, v164
v_mul_f32 v242, v242, v237
v_mul_f32 v248, v248, v237
v_cvt_pk_bf16_f32 v164, v242, v248
v_lshlrev_b32 v242, 16, v165
v_and_b32 v248, 0xffff0000, v165
v_mul_f32 v242, v242, v237
v_mul_f32 v248, v248, v237
v_cvt_pk_bf16_f32 v165, v242, v248
v_lshlrev_b32 v242, 16, v166
v_and_b32 v248, 0xffff0000, v166
v_mul_f32 v242, v242, v237
v_mul_f32 v248, v248, v237
v_cvt_pk_bf16_f32 v166, v242, v248
v_lshlrev_b32 v242, 16, v167
v_and_b32 v248, 0xffff0000, v167
v_mul_f32 v242, v242, v237
v_mul_f32 v248, v248, v237
v_cvt_pk_bf16_f32 v167, v242, v248
v_lshlrev_b32 v242, 16, v180
v_and_b32 v248, 0xffff0000, v180
v_mul_f32 v242, v242, v237
v_mul_f32 v248, v248, v237
v_cvt_pk_bf16_f32 v180, v242, v248
v_lshlrev_b32 v242, 16, v181
v_and_b32 v248, 0xffff0000, v181
v_mul_f32 v242, v242, v237
v_mul_f32 v248, v248, v237
v_cvt_pk_bf16_f32 v181, v242, v248
ds_read_b64 v[250:251], v231 offset:1024
s_waitcnt lgkmcnt(0)
v_lshlrev_b32 v242, 16, v250
v_and_b32 v248, 0xffff0000, v250
v_mul_f32 v242, v242, v237
v_mul_f32 v248, v248, v237
v_cvt_pk_bf16_f32 v250, v242, v248
v_lshlrev_b32 v242, 16, v251
v_and_b32 v248, 0xffff0000, v251
v_mul_f32 v242, v242, v237
v_mul_f32 v248, v248, v237
v_cvt_pk_bf16_f32 v251, v242, v248
ds_write_b64 v231, v[250:251] offset:1024
s_waitcnt lgkmcnt(0)
ds_read_b64 v[250:251], v231 offset:1032
s_waitcnt lgkmcnt(0)
v_lshlrev_b32 v242, 16, v250
v_and_b32 v248, 0xffff0000, v250
v_mul_f32 v242, v242, v237
v_mul_f32 v248, v248, v237
v_cvt_pk_bf16_f32 v250, v242, v248
v_lshlrev_b32 v242, 16, v251
v_and_b32 v248, 0xffff0000, v251
v_mul_f32 v242, v242, v237
v_mul_f32 v248, v248, v237
v_cvt_pk_bf16_f32 v251, v242, v248
ds_write_b64 v231, v[250:251] offset:1032
s_waitcnt lgkmcnt(0)
ds_read_b64 v[250:251], v231 offset:5120
s_waitcnt lgkmcnt(0)
v_lshlrev_b32 v242, 16, v250
v_and_b32 v248, 0xffff0000, v250
v_mul_f32 v242, v242, v237
v_mul_f32 v248, v248, v237
v_cvt_pk_bf16_f32 v250, v242, v248
v_lshlrev_b32 v242, 16, v251
v_and_b32 v248, 0xffff0000, v251
v_mul_f32 v242, v242, v237
v_mul_f32 v248, v248, v237
v_cvt_pk_bf16_f32 v251, v242, v248
ds_write_b64 v231, v[250:251] offset:5120
s_waitcnt lgkmcnt(0)
ds_read_b64 v[250:251], v231 offset:5128
s_waitcnt lgkmcnt(0)
v_lshlrev_b32 v242, 16, v250
v_and_b32 v248, 0xffff0000, v250
v_mul_f32 v242, v242, v237
v_mul_f32 v248, v248, v237
v_cvt_pk_bf16_f32 v250, v242, v248
v_lshlrev_b32 v242, 16, v251
v_and_b32 v248, 0xffff0000, v251
v_mul_f32 v242, v242, v237
v_mul_f32 v248, v248, v237
v_cvt_pk_bf16_f32 v251, v242, v248
ds_write_b64 v231, v[250:251] offset:5128
s_waitcnt lgkmcnt(0)
v_exp_f32 v248, v152
s_nop 0
v_sub_f32 v226, v226, v248
v_exp_f32 v248, v153
s_nop 0
v_sub_f32 v226, v226, v248
v_exp_f32 v248, v154
s_nop 0
v_sub_f32 v226, v226, v248
v_exp_f32 v248, v155
s_nop 0
v_sub_f32 v226, v226, v248
v_max_f32 v226, 0, v226
v_min_f32 v226, s32, v226
v_log_f32 v248, v226
v_max3_f32 v234, v152, v153, v154
v_max3_f32 v234, v234, v155, v248
v_mov_b32 v248, v234
s_nop 1
v_permlane32_swap_b32 v234, v248
s_nop 1
v_max_f32 v234, v234, v248
v_mov_b32 v248, v234
s_nop 1
v_permlane16_swap_b32 v234, v248
s_nop 1
v_max_f32 v234, v234, v248
v_ceil_f32 v234, v234
v_max_f32 v234, 0, v234
v_sub_f32 v248, 0, v234
v_exp_f32 v238, v248
s_nop 1
v_mul_f32 v226, v226, v238
v_sub_f32 v200, v200, v234
v_sub_f32 v152, v152, v234
v_sub_f32 v136, v136, v234
v_sub_f32 v201, v201, v234
v_sub_f32 v153, v153, v234
v_sub_f32 v137, v137, v234
v_sub_f32 v202, v202, v234
v_sub_f32 v154, v154, v234
v_sub_f32 v138, v138, v234
v_sub_f32 v203, v203, v234
v_sub_f32 v155, v155, v234
v_sub_f32 v139, v139, v234
v_lshlrev_b32 v242, 16, v168
v_and_b32 v248, 0xffff0000, v168
v_mul_f32 v242, v242, v238
v_mul_f32 v248, v248, v238
v_cvt_pk_bf16_f32 v168, v242, v248
v_lshlrev_b32 v242, 16, v169
v_and_b32 v248, 0xffff0000, v169
v_mul_f32 v242, v242, v238
v_mul_f32 v248, v248, v238
v_cvt_pk_bf16_f32 v169, v242, v248
v_lshlrev_b32 v242, 16, v170
v_and_b32 v248, 0xffff0000, v170
v_mul_f32 v242, v242, v238
v_mul_f32 v248, v248, v238
v_cvt_pk_bf16_f32 v170, v242, v248
v_lshlrev_b32 v242, 16, v171
v_and_b32 v248, 0xffff0000, v171
v_mul_f32 v242, v242, v238
v_mul_f32 v248, v248, v238
v_cvt_pk_bf16_f32 v171, v242, v248
v_lshlrev_b32 v242, 16, v184
v_and_b32 v248, 0xffff0000, v184
v_mul_f32 v242, v242, v238
v_mul_f32 v248, v248, v238
v_cvt_pk_bf16_f32 v184, v242, v248
v_lshlrev_b32 v242, 16, v185
v_and_b32 v248, 0xffff0000, v185
v_mul_f32 v242, v242, v238
v_mul_f32 v248, v248, v238
v_cvt_pk_bf16_f32 v185, v242, v248
ds_read_b64 v[250:251], v231 offset:2048
s_waitcnt lgkmcnt(0)
v_lshlrev_b32 v242, 16, v250
v_and_b32 v248, 0xffff0000, v250
v_mul_f32 v242, v242, v238
v_mul_f32 v248, v248, v238
v_cvt_pk_bf16_f32 v250, v242, v248
v_lshlrev_b32 v242, 16, v251
v_and_b32 v248, 0xffff0000, v251
v_mul_f32 v242, v242, v238
v_mul_f32 v248, v248, v238
v_cvt_pk_bf16_f32 v251, v242, v248
ds_write_b64 v231, v[250:251] offset:2048
s_waitcnt lgkmcnt(0)
ds_read_b64 v[250:251], v231 offset:2056
s_waitcnt lgkmcnt(0)
v_lshlrev_b32 v242, 16, v250
v_and_b32 v248, 0xffff0000, v250
v_mul_f32 v242, v242, v238
v_mul_f32 v248, v248, v238
v_cvt_pk_bf16_f32 v250, v242, v248
v_lshlrev_b32 v242, 16, v251
v_and_b32 v248, 0xffff0000, v251
v_mul_f32 v242, v242, v238
v_mul_f32 v248, v248, v238
v_cvt_pk_bf16_f32 v251, v242, v248
ds_write_b64 v231, v[250:251] offset:2056
s_waitcnt lgkmcnt(0)
ds_read_b64 v[250:251], v231 offset:6144
s_waitcnt lgkmcnt(0)
v_lshlrev_b32 v242, 16, v250
v_and_b32 v248, 0xffff0000, v250
v_mul_f32 v242, v242, v238
v_mul_f32 v248, v248, v238
v_cvt_pk_bf16_f32 v250, v242, v248
v_lshlrev_b32 v242, 16, v251
v_and_b32 v248, 0xffff0000, v251
v_mul_f32 v242, v242, v238
v_mul_f32 v248, v248, v238
v_cvt_pk_bf16_f32 v251, v242, v248
ds_write_b64 v231, v[250:251] offset:6144
s_waitcnt lgkmcnt(0)
ds_read_b64 v[250:251], v231 offset:6152
s_waitcnt lgkmcnt(0)
v_lshlrev_b32 v242, 16, v250
v_and_b32 v248, 0xffff0000, v250
v_mul_f32 v242, v242, v238
v_mul_f32 v248, v248, v238
v_cvt_pk_bf16_f32 v250, v242, v248
v_lshlrev_b32 v242, 16, v251
v_and_b32 v248, 0xffff0000, v251
v_mul_f32 v242, v242, v238
v_mul_f32 v248, v248, v238
v_cvt_pk_bf16_f32 v251, v242, v248
ds_write_b64 v231, v[250:251] offset:6152
s_waitcnt lgkmcnt(0)
v_exp_f32 v248, v156
s_nop 0
v_sub_f32 v227, v227, v248
v_exp_f32 v248, v157
s_nop 0
v_sub_f32 v227, v227, v248
v_exp_f32 v248, v158
s_nop 0
v_sub_f32 v227, v227, v248
v_exp_f32 v248, v159
s_nop 0
v_sub_f32 v227, v227, v248
v_max_f32 v227, 0, v227
v_min_f32 v227, s32, v227
v_log_f32 v248, v227
v_max3_f32 v235, v156, v157, v158
v_max3_f32 v235, v235, v159, v248
v_mov_b32 v248, v235
s_nop 1
v_permlane32_swap_b32 v235, v248
s_nop 1
v_max_f32 v235, v235, v248
v_mov_b32 v248, v235
s_nop 1
v_permlane16_swap_b32 v235, v248
s_nop 1
v_max_f32 v235, v235, v248
v_ceil_f32 v235, v235
v_max_f32 v235, 0, v235
v_sub_f32 v248, 0, v235
v_exp_f32 v239, v248
s_nop 1
v_mul_f32 v227, v227, v239
v_sub_f32 v204, v204, v235
v_sub_f32 v156, v156, v235
v_sub_f32 v140, v140, v235
v_sub_f32 v205, v205, v235
v_sub_f32 v157, v157, v235
v_sub_f32 v141, v141, v235
v_sub_f32 v206, v206, v235
v_sub_f32 v158, v158, v235
v_sub_f32 v142, v142, v235
v_sub_f32 v207, v207, v235
v_sub_f32 v159, v159, v235
v_sub_f32 v143, v143, v235
v_lshlrev_b32 v242, 16, v172
v_and_b32 v248, 0xffff0000, v172
v_mul_f32 v242, v242, v239
v_mul_f32 v248, v248, v239
v_cvt_pk_bf16_f32 v172, v242, v248
v_lshlrev_b32 v242, 16, v173
v_and_b32 v248, 0xffff0000, v173
v_mul_f32 v242, v242, v239
v_mul_f32 v248, v248, v239
v_cvt_pk_bf16_f32 v173, v242, v248
v_lshlrev_b32 v242, 16, v174
v_and_b32 v248, 0xffff0000, v174
v_mul_f32 v242, v242, v239
v_mul_f32 v248, v248, v239
v_cvt_pk_bf16_f32 v174, v242, v248
v_lshlrev_b32 v242, 16, v175
v_and_b32 v248, 0xffff0000, v175
v_mul_f32 v242, v242, v239
v_mul_f32 v248, v248, v239
v_cvt_pk_bf16_f32 v175, v242, v248
v_lshlrev_b32 v242, 16, v188
v_and_b32 v248, 0xffff0000, v188
v_mul_f32 v242, v242, v239
v_mul_f32 v248, v248, v239
v_cvt_pk_bf16_f32 v188, v242, v248
v_lshlrev_b32 v242, 16, v189
v_and_b32 v248, 0xffff0000, v189
v_mul_f32 v242, v242, v239
v_mul_f32 v248, v248, v239
v_cvt_pk_bf16_f32 v189, v242, v248
ds_read_b64 v[250:251], v231 offset:3072
s_waitcnt lgkmcnt(0)
v_lshlrev_b32 v242, 16, v250
v_and_b32 v248, 0xffff0000, v250
v_mul_f32 v242, v242, v239
v_mul_f32 v248, v248, v239
v_cvt_pk_bf16_f32 v250, v242, v248
v_lshlrev_b32 v242, 16, v251
v_and_b32 v248, 0xffff0000, v251
v_mul_f32 v242, v242, v239
v_mul_f32 v248, v248, v239
v_cvt_pk_bf16_f32 v251, v242, v248
ds_write_b64 v231, v[250:251] offset:3072
s_waitcnt lgkmcnt(0)
ds_read_b64 v[250:251], v231 offset:3080
s_waitcnt lgkmcnt(0)
v_lshlrev_b32 v242, 16, v250
v_and_b32 v248, 0xffff0000, v250
v_mul_f32 v242, v242, v239
v_mul_f32 v248, v248, v239
v_cvt_pk_bf16_f32 v250, v242, v248
v_lshlrev_b32 v242, 16, v251
v_and_b32 v248, 0xffff0000, v251
v_mul_f32 v242, v242, v239
v_mul_f32 v248, v248, v239
v_cvt_pk_bf16_f32 v251, v242, v248
ds_write_b64 v231, v[250:251] offset:3080
s_waitcnt lgkmcnt(0)
ds_read_b64 v[250:251], v231 offset:7168
s_waitcnt lgkmcnt(0)
v_lshlrev_b32 v242, 16, v250
v_and_b32 v248, 0xffff0000, v250
v_mul_f32 v242, v242, v239
v_mul_f32 v248, v248, v239
v_cvt_pk_bf16_f32 v250, v242, v248
v_lshlrev_b32 v242, 16, v251
v_and_b32 v248, 0xffff0000, v251
v_mul_f32 v242, v242, v239
v_mul_f32 v248, v248, v239
v_cvt_pk_bf16_f32 v251, v242, v248
ds_write_b64 v231, v[250:251] offset:7168
s_waitcnt lgkmcnt(0)
ds_read_b64 v[250:251], v231 offset:7176
s_waitcnt lgkmcnt(0)
v_lshlrev_b32 v242, 16, v250
v_and_b32 v248, 0xffff0000, v250
v_mul_f32 v242, v242, v239
v_mul_f32 v248, v248, v239
v_cvt_pk_bf16_f32 v250, v242, v248
v_lshlrev_b32 v242, 16, v251
v_and_b32 v248, 0xffff0000, v251
v_mul_f32 v242, v242, v239
v_mul_f32 v248, v248, v239
v_cvt_pk_bf16_f32 v251, v242, v248
ds_write_b64 v231, v[250:251] offset:7176
s_waitcnt lgkmcnt(0)
v_exp_f32 v232, v144
v_exp_f32 v233, v145
v_exp_f32 v234, v146
v_exp_f32 v235, v147
s_nop 1
v_add_f32 v224, v224, v232
v_add_f32 v224, v224, v233
v_add_f32 v224, v224, v234
v_add_f32 v224, v224, v235
v_cvt_pk_bf16_f32 v178, v232, v233
v_cvt_pk_bf16_f32 v179, v234, v235
v_exp_f32 v232, v148
v_exp_f32 v233, v149
v_exp_f32 v234, v150
v_exp_f32 v235, v151
s_nop 1
v_add_f32 v225, v225, v232
v_add_f32 v225, v225, v233
v_add_f32 v225, v225, v234
v_add_f32 v225, v225, v235
v_cvt_pk_bf16_f32 v182, v232, v233
v_cvt_pk_bf16_f32 v183, v234, v235
v_exp_f32 v232, v152
v_exp_f32 v233, v153
v_exp_f32 v234, v154
v_exp_f32 v235, v155
s_nop 1
v_add_f32 v226, v226, v232
v_add_f32 v226, v226, v233
v_add_f32 v226, v226, v234
v_add_f32 v226, v226, v235
v_cvt_pk_bf16_f32 v186, v232, v233
v_cvt_pk_bf16_f32 v187, v234, v235
v_exp_f32 v232, v156
v_exp_f32 v233, v157
v_exp_f32 v234, v158
v_exp_f32 v235, v159
s_nop 1
v_add_f32 v227, v227, v232
v_add_f32 v227, v227, v233
v_add_f32 v227, v227, v234
v_add_f32 v227, v227, v235
v_cvt_pk_bf16_f32 v190, v232, v233
v_cvt_pk_bf16_f32 v191, v234, v235
s_branch L2_rare_common
L2_rare_site16:
s_mov_b32 s36, 16
s_branch L2_rare_t0_4_0
L2_rare_t0_4_0:
s_nop 15
s_nop 15
s_waitcnt lgkmcnt(0)
v_exp_f32 v248, v128
s_nop 0
v_sub_f32 v224, v224, v248
v_exp_f32 v248, v129
s_nop 0
v_sub_f32 v224, v224, v248
v_exp_f32 v248, v130
s_nop 0
v_sub_f32 v224, v224, v248
v_exp_f32 v248, v131
s_nop 0
v_sub_f32 v224, v224, v248
v_max_f32 v224, 0, v224
v_min_f32 v224, s32, v224
v_log_f32 v248, v224
v_max3_f32 v232, v128, v129, v130
v_max3_f32 v232, v232, v131, v248
v_mov_b32 v248, v232
s_nop 1
v_permlane32_swap_b32 v232, v248
s_nop 1
v_max_f32 v232, v232, v248
v_mov_b32 v248, v232
s_nop 1
v_permlane16_swap_b32 v232, v248
s_nop 1
v_max_f32 v232, v232, v248
v_ceil_f32 v232, v232
v_max_f32 v232, 0, v232
v_sub_f32 v248, 0, v232
v_exp_f32 v236, v248
s_nop 1
v_mul_f32 v224, v224, v236
v_sub_f32 v192, v192, v232
v_sub_f32 v128, v128, v232
v_sub_f32 v144, v144, v232
v_sub_f32 v193, v193, v232
v_sub_f32 v129, v129, v232
v_sub_f32 v145, v145, v232
v_sub_f32 v194, v194, v232
v_sub_f32 v130, v130, v232
v_sub_f32 v146, v146, v232
v_sub_f32 v195, v195, v232
v_sub_f32 v131, v131, v232
v_sub_f32 v147, v147, v232
v_lshlrev_b32 v242, 16, v4
v_and_b32 v248, 0xffff0000, v4
v_mul_f32 v242, v242, v236
v_mul_f32 v248, v248, v236
v_cvt_pk_bf16_f32 v4, v242, v248
v_lshlrev_b32 v242, 16, v5
v_and_b32 v248, 0xffff0000, v5
v_mul_f32 v242, v242, v236
v_mul_f32 v248, v248, v236
v_cvt_pk_bf16_f32 v5, v242, v248
v_lshlrev_b32 v242, 16, v6
v_and_b32 v248, 0xffff0000, v6
v_mul_f32 v242, v242, v236
v_mul_f32 v248, v248, v236
v_cvt_pk_bf16_f32 v6, v242, v248
v_lshlrev_b32 v242, 16, v7
v_and_b32 v248, 0xffff0000, v7
v_mul_f32 v242, v242, v236
v_mul_f32 v248, v248, v236
v_cvt_pk_bf16_f32 v7, v242, v248
v_lshlrev_b32 v242, 16, v8
v_and_b32 v248, 0xffff0000, v8
v_mul_f32 v242, v242, v236
v_mul_f32 v248, v248, v236
v_cvt_pk_bf16_f32 v8, v242, v248
v_lshlrev_b32 v242, 16, v9
v_and_b32 v248, 0xffff0000, v9
v_mul_f32 v242, v242, v236
v_mul_f32 v248, v248, v236
v_cvt_pk_bf16_f32 v9, v242, v248
v_lshlrev_b32 v242, 16, v10
v_and_b32 v248, 0xffff0000, v10
v_mul_f32 v242, v242, v236
v_mul_f32 v248, v248, v236
v_cvt_pk_bf16_f32 v10, v242, v248
v_lshlrev_b32 v242, 16, v11
v_and_b32 v248, 0xffff0000, v11
v_mul_f32 v242, v242, v236
v_mul_f32 v248, v248, v236
v_cvt_pk_bf16_f32 v11, v242, v248
v_lshlrev_b32 v242, 16, v160
v_and_b32 v248, 0xffff0000, v160
v_mul_f32 v242, v242, v236
v_mul_f32 v248, v248, v236
v_cvt_pk_bf16_f32 v160, v242, v248
v_lshlrev_b32 v242, 16, v161
v_and_b32 v248, 0xffff0000, v161
v_mul_f32 v242, v242, v236
v_mul_f32 v248, v248, v236
v_cvt_pk_bf16_f32 v161, v242, v248
v_lshlrev_b32 v242, 16, v162
v_and_b32 v248, 0xffff0000, v162
v_mul_f32 v242, v242, v236
v_mul_f32 v248, v248, v236
v_cvt_pk_bf16_f32 v162, v242, v248
v_lshlrev_b32 v242, 16, v163
v_and_b32 v248, 0xffff0000, v163
v_mul_f32 v242, v242, v236
v_mul_f32 v248, v248, v236
v_cvt_pk_bf16_f32 v163, v242, v248
v_lshlrev_b32 v242, 16, v176
v_and_b32 v248, 0xffff0000, v176
v_mul_f32 v242, v242, v236
v_mul_f32 v248, v248, v236
v_cvt_pk_bf16_f32 v176, v242, v248
v_lshlrev_b32 v242, 16, v177
v_and_b32 v248, 0xffff0000, v177
v_mul_f32 v242, v242, v236
v_mul_f32 v248, v248, v236
v_cvt_pk_bf16_f32 v177, v242, v248
v_lshlrev_b32 v242, 16, v178
v_and_b32 v248, 0xffff0000, v178
v_mul_f32 v242, v242, v236
v_mul_f32 v248, v248, v236
v_cvt_pk_bf16_f32 v178, v242, v248
v_lshlrev_b32 v242, 16, v179
v_and_b32 v248, 0xffff0000, v179
v_mul_f32 v242, v242, v236
v_mul_f32 v248, v248, v236
v_cvt_pk_bf16_f32 v179, v242, v248
v_exp_f32 v248, v132
s_nop 0
v_sub_f32 v225, v225, v248
v_exp_f32 v248, v133
s_nop 0
v_sub_f32 v225, v225, v248
v_exp_f32 v248, v134
s_nop 0
v_sub_f32 v225, v225, v248
v_exp_f32 v248, v135
s_nop 0
v_sub_f32 v225, v225, v248
v_max_f32 v225, 0, v225
v_min_f32 v225, s32, v225
v_log_f32 v248, v225
v_max3_f32 v233, v132, v133, v134
v_max3_f32 v233, v233, v135, v248
v_mov_b32 v248, v233
s_nop 1
v_permlane32_swap_b32 v233, v248
s_nop 1
v_max_f32 v233, v233, v248
v_mov_b32 v248, v233
s_nop 1
v_permlane16_swap_b32 v233, v248
s_nop 1
v_max_f32 v233, v233, v248
v_ceil_f32 v233, v233
v_max_f32 v233, 0, v233
v_sub_f32 v248, 0, v233
v_exp_f32 v237, v248
s_nop 1
v_mul_f32 v225, v225, v237
v_sub_f32 v196, v196, v233
v_sub_f32 v132, v132, v233
v_sub_f32 v148, v148, v233
v_sub_f32 v197, v197, v233
v_sub_f32 v133, v133, v233
v_sub_f32 v149, v149, v233
v_sub_f32 v198, v198, v233
v_sub_f32 v134, v134, v233
v_sub_f32 v150, v150, v233
v_sub_f32 v199, v199, v233
v_sub_f32 v135, v135, v233
v_sub_f32 v151, v151, v233
v_lshlrev_b32 v242, 16, v36
v_and_b32 v248, 0xffff0000, v36
v_mul_f32 v242, v242, v237
v_mul_f32 v248, v248, v237
v_cvt_pk_bf16_f32 v36, v242, v248
v_lshlrev_b32 v242, 16, v37
v_and_b32 v248, 0xffff0000, v37
v_mul_f32 v242, v242, v237
v_mul_f32 v248, v248, v237
v_cvt_pk_bf16_f32 v37, v242, v248
v_lshlrev_b32 v242, 16, v38
v_and_b32 v248, 0xffff0000, v38
v_mul_f32 v242, v242, v237
v_mul_f32 v248, v248, v237
v_cvt_pk_bf16_f32 v38, v242, v248
v_lshlrev_b32 v242, 16, v39
v_and_b32 v248, 0xffff0000, v39
v_mul_f32 v242, v242, v237
v_mul_f32 v248, v248, v237
v_cvt_pk_bf16_f32 v39, v242, v248
v_lshlrev_b32 v242, 16, v40
v_and_b32 v248, 0xffff0000, v40
v_mul_f32 v242, v242, v237
v_mul_f32 v248, v248, v237
v_cvt_pk_bf16_f32 v40, v242, v248
v_lshlrev_b32 v242, 16, v41
v_and_b32 v248, 0xffff0000, v41
v_mul_f32 v242, v242, v237
v_mul_f32 v248, v248, v237
v_cvt_pk_bf16_f32 v41, v242, v248
v_lshlrev_b32 v242, 16, v42
v_and_b32 v248, 0xffff0000, v42
v_mul_f32 v242, v242, v237
v_mul_f32 v248, v248, v237
v_cvt_pk_bf16_f32 v42, v242, v248
v_lshlrev_b32 v242, 16, v43
v_and_b32 v248, 0xffff0000, v43
v_mul_f32 v242, v242, v237
v_mul_f32 v248, v248, v237
v_cvt_pk_bf16_f32 v43, v242, v248
v_lshlrev_b32 v242, 16, v164
v_and_b32 v248, 0xffff0000, v164
v_mul_f32 v242, v242, v237
v_mul_f32 v248, v248, v237
v_cvt_pk_bf16_f32 v164, v242, v248
v_lshlrev_b32 v242, 16, v165
v_and_b32 v248, 0xffff0000, v165
v_mul_f32 v242, v242, v237
v_mul_f32 v248, v248, v237
v_cvt_pk_bf16_f32 v165, v242, v248
v_lshlrev_b32 v242, 16, v166
v_and_b32 v248, 0xffff0000, v166
v_mul_f32 v242, v242, v237
v_mul_f32 v248, v248, v237
v_cvt_pk_bf16_f32 v166, v242, v248
v_lshlrev_b32 v242, 16, v167
v_and_b32 v248, 0xffff0000, v167
v_mul_f32 v242, v242, v237
v_mul_f32 v248, v248, v237
v_cvt_pk_bf16_f32 v167, v242, v248
v_lshlrev_b32 v242, 16, v180
v_and_b32 v248, 0xffff0000, v180
v_mul_f32 v242, v242, v237
v_mul_f32 v248, v248, v237
v_cvt_pk_bf16_f32 v180, v242, v248
v_lshlrev_b32 v242, 16, v181
v_and_b32 v248, 0xffff0000, v181
v_mul_f32 v242, v242, v237
v_mul_f32 v248, v248, v237
v_cvt_pk_bf16_f32 v181, v242, v248
v_lshlrev_b32 v242, 16, v182
v_and_b32 v248, 0xffff0000, v182
v_mul_f32 v242, v242, v237
v_mul_f32 v248, v248, v237
v_cvt_pk_bf16_f32 v182, v242, v248
v_lshlrev_b32 v242, 16, v183
v_and_b32 v248, 0xffff0000, v183
v_mul_f32 v242, v242, v237
v_mul_f32 v248, v248, v237
v_cvt_pk_bf16_f32 v183, v242, v248
v_exp_f32 v248, v136
s_nop 0
v_sub_f32 v226, v226, v248
v_exp_f32 v248, v137
s_nop 0
v_sub_f32 v226, v226, v248
v_exp_f32 v248, v138
s_nop 0
v_sub_f32 v226, v226, v248
v_exp_f32 v248, v139
s_nop 0
v_sub_f32 v226, v226, v248
v_max_f32 v226, 0, v226
v_min_f32 v226, s32, v226
v_log_f32 v248, v226
v_max3_f32 v234, v136, v137, v138
v_max3_f32 v234, v234, v139, v248
v_mov_b32 v248, v234
s_nop 1
v_permlane32_swap_b32 v234, v248
s_nop 1
v_max_f32 v234, v234, v248
v_mov_b32 v248, v234
s_nop 1
v_permlane16_swap_b32 v234, v248
s_nop 1
v_max_f32 v234, v234, v248
v_ceil_f32 v234, v234
v_max_f32 v234, 0, v234
v_sub_f32 v248, 0, v234
v_exp_f32 v238, v248
s_nop 1
v_mul_f32 v226, v226, v238
v_sub_f32 v200, v200, v234
v_sub_f32 v136, v136, v234
v_sub_f32 v152, v152, v234
v_sub_f32 v201, v201, v234
v_sub_f32 v137, v137, v234
v_sub_f32 v153, v153, v234
v_sub_f32 v202, v202, v234
v_sub_f32 v138, v138, v234
v_sub_f32 v154, v154, v234
v_sub_f32 v203, v203, v234
v_sub_f32 v139, v139, v234
v_sub_f32 v155, v155, v234
v_lshlrev_b32 v242, 16, v68
v_and_b32 v248, 0xffff0000, v68
v_mul_f32 v242, v242, v238
v_mul_f32 v248, v248, v238
v_cvt_pk_bf16_f32 v68, v242, v248
v_lshlrev_b32 v242, 16, v69
v_and_b32 v248, 0xffff0000, v69
v_mul_f32 v242, v242, v238
v_mul_f32 v248, v248, v238
v_cvt_pk_bf16_f32 v69, v242, v248
v_lshlrev_b32 v242, 16, v70
v_and_b32 v248, 0xffff0000, v70
v_mul_f32 v242, v242, v238
v_mul_f32 v248, v248, v238
v_cvt_pk_bf16_f32 v70, v242, v248
v_lshlrev_b32 v242, 16, v71
v_and_b32 v248, 0xffff0000, v71
v_mul_f32 v242, v242, v238
v_mul_f32 v248, v248, v238
v_cvt_pk_bf16_f32 v71, v242, v248
v_lshlrev_b32 v242, 16, v72
v_and_b32 v248, 0xffff0000, v72
v_mul_f32 v242, v242, v238
v_mul_f32 v248, v248, v238
v_cvt_pk_bf16_f32 v72, v242, v248
v_lshlrev_b32 v242, 16, v73
v_and_b32 v248, 0xffff0000, v73
v_mul_f32 v242, v242, v238
v_mul_f32 v248, v248, v238
v_cvt_pk_bf16_f32 v73, v242, v248
v_lshlrev_b32 v242, 16, v74
v_and_b32 v248, 0xffff0000, v74
v_mul_f32 v242, v242, v238
v_mul_f32 v248, v248, v238
v_cvt_pk_bf16_f32 v74, v242, v248
v_lshlrev_b32 v242, 16, v75
v_and_b32 v248, 0xffff0000, v75
v_mul_f32 v242, v242, v238
v_mul_f32 v248, v248, v238
v_cvt_pk_bf16_f32 v75, v242, v248
v_lshlrev_b32 v242, 16, v168
v_and_b32 v248, 0xffff0000, v168
v_mul_f32 v242, v242, v238
v_mul_f32 v248, v248, v238
v_cvt_pk_bf16_f32 v168, v242, v248
v_lshlrev_b32 v242, 16, v169
v_and_b32 v248, 0xffff0000, v169
v_mul_f32 v242, v242, v238
v_mul_f32 v248, v248, v238
v_cvt_pk_bf16_f32 v169, v242, v248
v_lshlrev_b32 v242, 16, v170
v_and_b32 v248, 0xffff0000, v170
v_mul_f32 v242, v242, v238
v_mul_f32 v248, v248, v238
v_cvt_pk_bf16_f32 v170, v242, v248
v_lshlrev_b32 v242, 16, v171
v_and_b32 v248, 0xffff0000, v171
v_mul_f32 v242, v242, v238
v_mul_f32 v248, v248, v238
v_cvt_pk_bf16_f32 v171, v242, v248
v_lshlrev_b32 v242, 16, v184
v_and_b32 v248, 0xffff0000, v184
v_mul_f32 v242, v242, v238
v_mul_f32 v248, v248, v238
v_cvt_pk_bf16_f32 v184, v242, v248
v_lshlrev_b32 v242, 16, v185
v_and_b32 v248, 0xffff0000, v185
v_mul_f32 v242, v242, v238
v_mul_f32 v248, v248, v238
v_cvt_pk_bf16_f32 v185, v242, v248
v_lshlrev_b32 v242, 16, v186
v_and_b32 v248, 0xffff0000, v186
v_mul_f32 v242, v242, v238
v_mul_f32 v248, v248, v238
v_cvt_pk_bf16_f32 v186, v242, v248
v_lshlrev_b32 v242, 16, v187
v_and_b32 v248, 0xffff0000, v187
v_mul_f32 v242, v242, v238
v_mul_f32 v248, v248, v238
v_cvt_pk_bf16_f32 v187, v242, v248
v_exp_f32 v248, v140
s_nop 0
v_sub_f32 v227, v227, v248
v_exp_f32 v248, v141
s_nop 0
v_sub_f32 v227, v227, v248
v_exp_f32 v248, v142
s_nop 0
v_sub_f32 v227, v227, v248
v_exp_f32 v248, v143
s_nop 0
v_sub_f32 v227, v227, v248
v_max_f32 v227, 0, v227
v_min_f32 v227, s32, v227
v_log_f32 v248, v227
v_max3_f32 v235, v140, v141, v142
v_max3_f32 v235, v235, v143, v248
v_mov_b32 v248, v235
s_nop 1
v_permlane32_swap_b32 v235, v248
s_nop 1
v_max_f32 v235, v235, v248
v_mov_b32 v248, v235
s_nop 1
v_permlane16_swap_b32 v235, v248
s_nop 1
v_max_f32 v235, v235, v248
v_ceil_f32 v235, v235
v_max_f32 v235, 0, v235
v_sub_f32 v248, 0, v235
v_exp_f32 v239, v248
s_nop 1
v_mul_f32 v227, v227, v239
v_sub_f32 v204, v204, v235
v_sub_f32 v140, v140, v235
v_sub_f32 v156, v156, v235
v_sub_f32 v205, v205, v235
v_sub_f32 v141, v141, v235
v_sub_f32 v157, v157, v235
v_sub_f32 v206, v206, v235
v_sub_f32 v142, v142, v235
v_sub_f32 v158, v158, v235
v_sub_f32 v207, v207, v235
v_sub_f32 v143, v143, v235
v_sub_f32 v159, v159, v235
v_lshlrev_b32 v242, 16, v100
v_and_b32 v248, 0xffff0000, v100
v_mul_f32 v242, v242, v239
v_mul_f32 v248, v248, v239
v_cvt_pk_bf16_f32 v100, v242, v248
v_lshlrev_b32 v242, 16, v101
v_and_b32 v248, 0xffff0000, v101
v_mul_f32 v242, v242, v239
v_mul_f32 v248, v248, v239
v_cvt_pk_bf16_f32 v101, v242, v248
v_lshlrev_b32 v242, 16, v102
v_and_b32 v248, 0xffff0000, v102
v_mul_f32 v242, v242, v239
v_mul_f32 v248, v248, v239
v_cvt_pk_bf16_f32 v102, v242, v248
v_lshlrev_b32 v242, 16, v103
v_and_b32 v248, 0xffff0000, v103
v_mul_f32 v242, v242, v239
v_mul_f32 v248, v248, v239
v_cvt_pk_bf16_f32 v103, v242, v248
v_lshlrev_b32 v242, 16, v104
v_and_b32 v248, 0xffff0000, v104
v_mul_f32 v242, v242, v239
v_mul_f32 v248, v248, v239
v_cvt_pk_bf16_f32 v104, v242, v248
v_lshlrev_b32 v242, 16, v105
v_and_b32 v248, 0xffff0000, v105
v_mul_f32 v242, v242, v239
v_mul_f32 v248, v248, v239
v_cvt_pk_bf16_f32 v105, v242, v248
v_lshlrev_b32 v242, 16, v106
v_and_b32 v248, 0xffff0000, v106
v_mul_f32 v242, v242, v239
v_mul_f32 v248, v248, v239
v_cvt_pk_bf16_f32 v106, v242, v248
v_lshlrev_b32 v242, 16, v107
v_and_b32 v248, 0xffff0000, v107
v_mul_f32 v242, v242, v239
v_mul_f32 v248, v248, v239
v_cvt_pk_bf16_f32 v107, v242, v248
v_lshlrev_b32 v242, 16, v172
v_and_b32 v248, 0xffff0000, v172
v_mul_f32 v242, v242, v239
v_mul_f32 v248, v248, v239
v_cvt_pk_bf16_f32 v172, v242, v248
v_lshlrev_b32 v242, 16, v173
v_and_b32 v248, 0xffff0000, v173
v_mul_f32 v242, v242, v239
v_mul_f32 v248, v248, v239
v_cvt_pk_bf16_f32 v173, v242, v248
v_lshlrev_b32 v242, 16, v174
v_and_b32 v248, 0xffff0000, v174
v_mul_f32 v242, v242, v239
v_mul_f32 v248, v248, v239
v_cvt_pk_bf16_f32 v174, v242, v248
v_lshlrev_b32 v242, 16, v175
v_and_b32 v248, 0xffff0000, v175
v_mul_f32 v242, v242, v239
v_mul_f32 v248, v248, v239
v_cvt_pk_bf16_f32 v175, v242, v248
v_lshlrev_b32 v242, 16, v188
v_and_b32 v248, 0xffff0000, v188
v_mul_f32 v242, v242, v239
v_mul_f32 v248, v248, v239
v_cvt_pk_bf16_f32 v188, v242, v248
v_lshlrev_b32 v242, 16, v189
v_and_b32 v248, 0xffff0000, v189
v_mul_f32 v242, v242, v239
v_mul_f32 v248, v248, v239
v_cvt_pk_bf16_f32 v189, v242, v248
v_lshlrev_b32 v242, 16, v190
v_and_b32 v248, 0xffff0000, v190
v_mul_f32 v242, v242, v239
v_mul_f32 v248, v248, v239
v_cvt_pk_bf16_f32 v190, v242, v248
v_lshlrev_b32 v242, 16, v191
v_and_b32 v248, 0xffff0000, v191
v_mul_f32 v242, v242, v239
v_mul_f32 v248, v248, v239
v_cvt_pk_bf16_f32 v191, v242, v248
v_exp_f32 v232, v128
v_exp_f32 v233, v129
v_exp_f32 v234, v130
v_exp_f32 v235, v131
s_nop 1
v_add_f32 v224, v224, v232
v_add_f32 v224, v224, v233
v_add_f32 v224, v224, v234
v_add_f32 v224, v224, v235
v_cvt_pk_bf16_f32 v0, v232, v233
v_cvt_pk_bf16_f32 v1, v234, v235
v_exp_f32 v232, v132
v_exp_f32 v233, v133
v_exp_f32 v234, v134
v_exp_f32 v235, v135
s_nop 1
v_add_f32 v225, v225, v232
v_add_f32 v225, v225, v233
v_add_f32 v225, v225, v234
v_add_f32 v225, v225, v235
v_cvt_pk_bf16_f32 v32, v232, v233
v_cvt_pk_bf16_f32 v33, v234, v235
v_exp_f32 v232, v136
v_exp_f32 v233, v137
v_exp_f32 v234, v138
v_exp_f32 v235, v139
s_nop 1
v_add_f32 v226, v226, v232
v_add_f32 v226, v226, v233
v_add_f32 v226, v226, v234
v_add_f32 v226, v226, v235
v_cvt_pk_bf16_f32 v64, v232, v233
v_cvt_pk_bf16_f32 v65, v234, v235
v_exp_f32 v232, v140
v_exp_f32 v233, v141
v_exp_f32 v234, v142
v_exp_f32 v235, v143
s_nop 1
v_add_f32 v227, v227, v232
v_add_f32 v227, v227, v233
v_add_f32 v227, v227, v234
v_add_f32 v227, v227, v235
v_cvt_pk_bf16_f32 v96, v232, v233
v_cvt_pk_bf16_f32 v97, v234, v235
s_branch L2_rare_common
L2_rare_site17:
s_mov_b32 s36, 17
s_branch L2_rare_t0_5_1
L2_rare_t0_5_1:
s_nop 15
s_nop 15
s_waitcnt lgkmcnt(0)
v_exp_f32 v248, v144
s_nop 0
v_sub_f32 v224, v224, v248
v_exp_f32 v248, v145
s_nop 0
v_sub_f32 v224, v224, v248
v_exp_f32 v248, v146
s_nop 0
v_sub_f32 v224, v224, v248
v_exp_f32 v248, v147
s_nop 0
v_sub_f32 v224, v224, v248
v_max_f32 v224, 0, v224
v_min_f32 v224, s32, v224
v_log_f32 v248, v224
v_max3_f32 v232, v144, v145, v146
v_max3_f32 v232, v232, v147, v248
v_mov_b32 v248, v232
s_nop 1
v_permlane32_swap_b32 v232, v248
s_nop 1
v_max_f32 v232, v232, v248
v_mov_b32 v248, v232
s_nop 1
v_permlane16_swap_b32 v232, v248
s_nop 1
v_max_f32 v232, v232, v248
v_ceil_f32 v232, v232
v_max_f32 v232, 0, v232
v_sub_f32 v248, 0, v232
v_exp_f32 v236, v248
s_nop 1
v_mul_f32 v224, v224, v236
v_sub_f32 v192, v192, v232
v_sub_f32 v144, v144, v232
v_sub_f32 v128, v128, v232
v_sub_f32 v193, v193, v232
v_sub_f32 v145, v145, v232
v_sub_f32 v129, v129, v232
v_sub_f32 v194, v194, v232
v_sub_f32 v146, v146, v232
v_sub_f32 v130, v130, v232
v_sub_f32 v195, v195, v232
v_sub_f32 v147, v147, v232
v_sub_f32 v131, v131, v232
v_lshlrev_b32 v242, 16, v4
v_and_b32 v248, 0xffff0000, v4
v_mul_f32 v242, v242, v236
v_mul_f32 v248, v248, v236
v_cvt_pk_bf16_f32 v4, v242, v248
v_lshlrev_b32 v242, 16, v5
v_and_b32 v248, 0xffff0000, v5
v_mul_f32 v242, v242, v236
v_mul_f32 v248, v248, v236
v_cvt_pk_bf16_f32 v5, v242, v248
v_lshlrev_b32 v242, 16, v6
v_and_b32 v248, 0xffff0000, v6
v_mul_f32 v242, v242, v236
v_mul_f32 v248, v248, v236
v_cvt_pk_bf16_f32 v6, v242, v248
v_lshlrev_b32 v242, 16, v7
v_and_b32 v248, 0xffff0000, v7
v_mul_f32 v242, v242, v236
v_mul_f32 v248, v248, v236
v_cvt_pk_bf16_f32 v7, v242, v248
v_lshlrev_b32 v242, 16, v8
v_and_b32 v248, 0xffff0000, v8
v_mul_f32 v242, v242, v236
v_mul_f32 v248, v248, v236
v_cvt_pk_bf16_f32 v8, v242, v248
v_lshlrev_b32 v242, 16, v9
v_and_b32 v248, 0xffff0000, v9
v_mul_f32 v242, v242, v236
v_mul_f32 v248, v248, v236
v_cvt_pk_bf16_f32 v9, v242, v248
v_lshlrev_b32 v242, 16, v10
v_and_b32 v248, 0xffff0000, v10
v_mul_f32 v242, v242, v236
v_mul_f32 v248, v248, v236
v_cvt_pk_bf16_f32 v10, v242, v248
v_lshlrev_b32 v242, 16, v11
v_and_b32 v248, 0xffff0000, v11
v_mul_f32 v242, v242, v236
v_mul_f32 v248, v248, v236
v_cvt_pk_bf16_f32 v11, v242, v248
v_lshlrev_b32 v242, 16, v160
v_and_b32 v248, 0xffff0000, v160
v_mul_f32 v242, v242, v236
v_mul_f32 v248, v248, v236
v_cvt_pk_bf16_f32 v160, v242, v248
v_lshlrev_b32 v242, 16, v161
v_and_b32 v248, 0xffff0000, v161
v_mul_f32 v242, v242, v236
v_mul_f32 v248, v248, v236
v_cvt_pk_bf16_f32 v161, v242, v248
v_lshlrev_b32 v242, 16, v162
v_and_b32 v248, 0xffff0000, v162
v_mul_f32 v242, v242, v236
v_mul_f32 v248, v248, v236
v_cvt_pk_bf16_f32 v162, v242, v248
v_lshlrev_b32 v242, 16, v163
v_and_b32 v248, 0xffff0000, v163
v_mul_f32 v242, v242, v236
v_mul_f32 v248, v248, v236
v_cvt_pk_bf16_f32 v163, v242, v248
v_lshlrev_b32 v242, 16, v176
v_and_b32 v248, 0xffff0000, v176
v_mul_f32 v242, v242, v236
v_mul_f32 v248, v248, v236
v_cvt_pk_bf16_f32 v176, v242, v248
v_lshlrev_b32 v242, 16, v177
v_and_b32 v248, 0xffff0000, v177
v_mul_f32 v242, v242, v236
v_mul_f32 v248, v248, v236
v_cvt_pk_bf16_f32 v177, v242, v248
v_lshlrev_b32 v242, 16, v178
v_and_b32 v248, 0xffff0000, v178
v_mul_f32 v242, v242, v236
v_mul_f32 v248, v248, v236
v_cvt_pk_bf16_f32 v178, v242, v248
v_lshlrev_b32 v242, 16, v179
v_and_b32 v248, 0xffff0000, v179
v_mul_f32 v242, v242, v236
v_mul_f32 v248, v248, v236
v_cvt_pk_bf16_f32 v179, v242, v248
v_lshlrev_b32 v242, 16, v0
v_and_b32 v248, 0xffff0000, v0
v_mul_f32 v242, v242, v236
v_mul_f32 v248, v248, v236
v_cvt_pk_bf16_f32 v0, v242, v248
v_lshlrev_b32 v242, 16, v1
v_and_b32 v248, 0xffff0000, v1
v_mul_f32 v242, v242, v236
v_mul_f32 v248, v248, v236
v_cvt_pk_bf16_f32 v1, v242, v248
v_exp_f32 v248, v148
s_nop 0
v_sub_f32 v225, v225, v248
v_exp_f32 v248, v149
s_nop 0
v_sub_f32 v225, v225, v248
v_exp_f32 v248, v150
s_nop 0
v_sub_f32 v225, v225, v248
v_exp_f32 v248, v151
s_nop 0
v_sub_f32 v225, v225, v248
v_max_f32 v225, 0, v225
v_min_f32 v225, s32, v225
v_log_f32 v248, v225
v_max3_f32 v233, v148, v149, v150
v_max3_f32 v233, v233, v151, v248
v_mov_b32 v248, v233
s_nop 1
v_permlane32_swap_b32 v233, v248
s_nop 1
v_max_f32 v233, v233, v248
v_mov_b32 v248, v233
s_nop 1
v_permlane16_swap_b32 v233, v248
s_nop 1
v_max_f32 v233, v233, v248
v_ceil_f32 v233, v233
v_max_f32 v233, 0, v233
v_sub_f32 v248, 0, v233
v_exp_f32 v237, v248
s_nop 1
v_mul_f32 v225, v225, v237
v_sub_f32 v196, v196, v233
v_sub_f32 v148, v148, v233
v_sub_f32 v132, v132, v233
v_sub_f32 v197, v197, v233
v_sub_f32 v149, v149, v233
v_sub_f32 v133, v133, v233
v_sub_f32 v198, v198, v233
v_sub_f32 v150, v150, v233
v_sub_f32 v134, v134, v233
v_sub_f32 v199, v199, v233
v_sub_f32 v151, v151, v233
v_sub_f32 v135, v135, v233
v_lshlrev_b32 v242, 16, v36
v_and_b32 v248, 0xffff0000, v36
v_mul_f32 v242, v242, v237
v_mul_f32 v248, v248, v237
v_cvt_pk_bf16_f32 v36, v242, v248
v_lshlrev_b32 v242, 16, v37
v_and_b32 v248, 0xffff0000, v37
v_mul_f32 v242, v242, v237
v_mul_f32 v248, v248, v237
v_cvt_pk_bf16_f32 v37, v242, v248
v_lshlrev_b32 v242, 16, v38
v_and_b32 v248, 0xffff0000, v38
v_mul_f32 v242, v242, v237
v_mul_f32 v248, v248, v237
v_cvt_pk_bf16_f32 v38, v242, v248
v_lshlrev_b32 v242, 16, v39
v_and_b32 v248, 0xffff0000, v39
v_mul_f32 v242, v242, v237
v_mul_f32 v248, v248, v237
v_cvt_pk_bf16_f32 v39, v242, v248
v_lshlrev_b32 v242, 16, v40
v_and_b32 v248, 0xffff0000, v40
v_mul_f32 v242, v242, v237
v_mul_f32 v248, v248, v237
v_cvt_pk_bf16_f32 v40, v242, v248
v_lshlrev_b32 v242, 16, v41
v_and_b32 v248, 0xffff0000, v41
v_mul_f32 v242, v242, v237
v_mul_f32 v248, v248, v237
v_cvt_pk_bf16_f32 v41, v242, v248
v_lshlrev_b32 v242, 16, v42
v_and_b32 v248, 0xffff0000, v42
v_mul_f32 v242, v242, v237
v_mul_f32 v248, v248, v237
v_cvt_pk_bf16_f32 v42, v242, v248
v_lshlrev_b32 v242, 16, v43
v_and_b32 v248, 0xffff0000, v43
v_mul_f32 v242, v242, v237
v_mul_f32 v248, v248, v237
v_cvt_pk_bf16_f32 v43, v242, v248
v_lshlrev_b32 v242, 16, v164
v_and_b32 v248, 0xffff0000, v164
v_mul_f32 v242, v242, v237
v_mul_f32 v248, v248, v237
v_cvt_pk_bf16_f32 v164, v242, v248
v_lshlrev_b32 v242, 16, v165
v_and_b32 v248, 0xffff0000, v165
v_mul_f32 v242, v242, v237
v_mul_f32 v248, v248, v237
v_cvt_pk_bf16_f32 v165, v242, v248
v_lshlrev_b32 v242, 16, v166
v_and_b32 v248, 0xffff0000, v166
v_mul_f32 v242, v242, v237
v_mul_f32 v248, v248, v237
v_cvt_pk_bf16_f32 v166, v242, v248
v_lshlrev_b32 v242, 16, v167
v_and_b32 v248, 0xffff0000, v167
v_mul_f32 v242, v242, v237
v_mul_f32 v248, v248, v237
v_cvt_pk_bf16_f32 v167, v242, v248
v_lshlrev_b32 v242, 16, v180
v_and_b32 v248, 0xffff0000, v180
v_mul_f32 v242, v242, v237
v_mul_f32 v248, v248, v237
v_cvt_pk_bf16_f32 v180, v242, v248
v_lshlrev_b32 v242, 16, v181
v_and_b32 v248, 0xffff0000, v181
v_mul_f32 v242, v242, v237
v_mul_f32 v248, v248, v237
v_cvt_pk_bf16_f32 v181, v242, v248
v_lshlrev_b32 v242, 16, v182
v_and_b32 v248, 0xffff0000, v182
v_mul_f32 v242, v242, v237
v_mul_f32 v248, v248, v237
v_cvt_pk_bf16_f32 v182, v242, v248
v_lshlrev_b32 v242, 16, v183
v_and_b32 v248, 0xffff0000, v183
v_mul_f32 v242, v242, v237
v_mul_f32 v248, v248, v237
v_cvt_pk_bf16_f32 v183, v242, v248
v_lshlrev_b32 v242, 16, v32
v_and_b32 v248, 0xffff0000, v32
v_mul_f32 v242, v242, v237
v_mul_f32 v248, v248, v237
v_cvt_pk_bf16_f32 v32, v242, v248
v_lshlrev_b32 v242, 16, v33
v_and_b32 v248, 0xffff0000, v33
v_mul_f32 v242, v242, v237
v_mul_f32 v248, v248, v237
v_cvt_pk_bf16_f32 v33, v242, v248
v_exp_f32 v248, v152
s_nop 0
v_sub_f32 v226, v226, v248
v_exp_f32 v248, v153
s_nop 0
v_sub_f32 v226, v226, v248
v_exp_f32 v248, v154
s_nop 0
v_sub_f32 v226, v226, v248
v_exp_f32 v248, v155
s_nop 0
v_sub_f32 v226, v226, v248
v_max_f32 v226, 0, v226
v_min_f32 v226, s32, v226
v_log_f32 v248, v226
v_max3_f32 v234, v152, v153, v154
v_max3_f32 v234, v234, v155, v248
v_mov_b32 v248, v234
s_nop 1
v_permlane32_swap_b32 v234, v248
s_nop 1
v_max_f32 v234, v234, v248
v_mov_b32 v248, v234
s_nop 1
v_permlane16_swap_b32 v234, v248
s_nop 1
v_max_f32 v234, v234, v248
v_ceil_f32 v234, v234
v_max_f32 v234, 0, v234
v_sub_f32 v248, 0, v234
v_exp_f32 v238, v248
s_nop 1
v_mul_f32 v226, v226, v238
v_sub_f32 v200, v200, v234
v_sub_f32 v152, v152, v234
v_sub_f32 v136, v136, v234
v_sub_f32 v201, v201, v234
v_sub_f32 v153, v153, v234
v_sub_f32 v137, v137, v234
v_sub_f32 v202, v202, v234
v_sub_f32 v154, v154, v234
v_sub_f32 v138, v138, v234
v_sub_f32 v203, v203, v234
v_sub_f32 v155, v155, v234
v_sub_f32 v139, v139, v234
v_lshlrev_b32 v242, 16, v68
v_and_b32 v248, 0xffff0000, v68
v_mul_f32 v242, v242, v238
v_mul_f32 v248, v248, v238
v_cvt_pk_bf16_f32 v68, v242, v248
v_lshlrev_b32 v242, 16, v69
v_and_b32 v248, 0xffff0000, v69
v_mul_f32 v242, v242, v238
v_mul_f32 v248, v248, v238
v_cvt_pk_bf16_f32 v69, v242, v248
v_lshlrev_b32 v242, 16, v70
v_and_b32 v248, 0xffff0000, v70
v_mul_f32 v242, v242, v238
v_mul_f32 v248, v248, v238
v_cvt_pk_bf16_f32 v70, v242, v248
v_lshlrev_b32 v242, 16, v71
v_and_b32 v248, 0xffff0000, v71
v_mul_f32 v242, v242, v238
v_mul_f32 v248, v248, v238
v_cvt_pk_bf16_f32 v71, v242, v248
v_lshlrev_b32 v242, 16, v72
v_and_b32 v248, 0xffff0000, v72
v_mul_f32 v242, v242, v238
v_mul_f32 v248, v248, v238
v_cvt_pk_bf16_f32 v72, v242, v248
v_lshlrev_b32 v242, 16, v73
v_and_b32 v248, 0xffff0000, v73
v_mul_f32 v242, v242, v238
v_mul_f32 v248, v248, v238
v_cvt_pk_bf16_f32 v73, v242, v248
v_lshlrev_b32 v242, 16, v74
v_and_b32 v248, 0xffff0000, v74
v_mul_f32 v242, v242, v238
v_mul_f32 v248, v248, v238
v_cvt_pk_bf16_f32 v74, v242, v248
v_lshlrev_b32 v242, 16, v75
v_and_b32 v248, 0xffff0000, v75
v_mul_f32 v242, v242, v238
v_mul_f32 v248, v248, v238
v_cvt_pk_bf16_f32 v75, v242, v248
v_lshlrev_b32 v242, 16, v168
v_and_b32 v248, 0xffff0000, v168
v_mul_f32 v242, v242, v238
v_mul_f32 v248, v248, v238
v_cvt_pk_bf16_f32 v168, v242, v248
v_lshlrev_b32 v242, 16, v169
v_and_b32 v248, 0xffff0000, v169
v_mul_f32 v242, v242, v238
v_mul_f32 v248, v248, v238
v_cvt_pk_bf16_f32 v169, v242, v248
v_lshlrev_b32 v242, 16, v170
v_and_b32 v248, 0xffff0000, v170
v_mul_f32 v242, v242, v238
v_mul_f32 v248, v248, v238
v_cvt_pk_bf16_f32 v170, v242, v248
v_lshlrev_b32 v242, 16, v171
v_and_b32 v248, 0xffff0000, v171
v_mul_f32 v242, v242, v238
v_mul_f32 v248, v248, v238
v_cvt_pk_bf16_f32 v171, v242, v248
v_lshlrev_b32 v242, 16, v184
v_and_b32 v248, 0xffff0000, v184
v_mul_f32 v242, v242, v238
v_mul_f32 v248, v248, v238
v_cvt_pk_bf16_f32 v184, v242, v248
v_lshlrev_b32 v242, 16, v185
v_and_b32 v248, 0xffff0000, v185
v_mul_f32 v242, v242, v238
v_mul_f32 v248, v248, v238
v_cvt_pk_bf16_f32 v185, v242, v248
v_lshlrev_b32 v242, 16, v186
v_and_b32 v248, 0xffff0000, v186
v_mul_f32 v242, v242, v238
v_mul_f32 v248, v248, v238
v_cvt_pk_bf16_f32 v186, v242, v248
v_lshlrev_b32 v242, 16, v187
v_and_b32 v248, 0xffff0000, v187
v_mul_f32 v242, v242, v238
v_mul_f32 v248, v248, v238
v_cvt_pk_bf16_f32 v187, v242, v248
v_lshlrev_b32 v242, 16, v64
v_and_b32 v248, 0xffff0000, v64
v_mul_f32 v242, v242, v238
v_mul_f32 v248, v248, v238
v_cvt_pk_bf16_f32 v64, v242, v248
v_lshlrev_b32 v242, 16, v65
v_and_b32 v248, 0xffff0000, v65
v_mul_f32 v242, v242, v238
v_mul_f32 v248, v248, v238
v_cvt_pk_bf16_f32 v65, v242, v248
v_exp_f32 v248, v156
s_nop 0
v_sub_f32 v227, v227, v248
v_exp_f32 v248, v157
s_nop 0
v_sub_f32 v227, v227, v248
v_exp_f32 v248, v158
s_nop 0
v_sub_f32 v227, v227, v248
v_exp_f32 v248, v159
s_nop 0
v_sub_f32 v227, v227, v248
v_max_f32 v227, 0, v227
v_min_f32 v227, s32, v227
v_log_f32 v248, v227
v_max3_f32 v235, v156, v157, v158
v_max3_f32 v235, v235, v159, v248
v_mov_b32 v248, v235
s_nop 1
v_permlane32_swap_b32 v235, v248
s_nop 1
v_max_f32 v235, v235, v248
v_mov_b32 v248, v235
s_nop 1
v_permlane16_swap_b32 v235, v248
s_nop 1
v_max_f32 v235, v235, v248
v_ceil_f32 v235, v235
v_max_f32 v235, 0, v235
v_sub_f32 v248, 0, v235
v_exp_f32 v239, v248
s_nop 1
v_mul_f32 v227, v227, v239
v_sub_f32 v204, v204, v235
v_sub_f32 v156, v156, v235
v_sub_f32 v140, v140, v235
v_sub_f32 v205, v205, v235
v_sub_f32 v157, v157, v235
v_sub_f32 v141, v141, v235
v_sub_f32 v206, v206, v235
v_sub_f32 v158, v158, v235
v_sub_f32 v142, v142, v235
v_sub_f32 v207, v207, v235
v_sub_f32 v159, v159, v235
v_sub_f32 v143, v143, v235
v_lshlrev_b32 v242, 16, v100
v_and_b32 v248, 0xffff0000, v100
v_mul_f32 v242, v242, v239
v_mul_f32 v248, v248, v239
v_cvt_pk_bf16_f32 v100, v242, v248
v_lshlrev_b32 v242, 16, v101
v_and_b32 v248, 0xffff0000, v101
v_mul_f32 v242, v242, v239
v_mul_f32 v248, v248, v239
v_cvt_pk_bf16_f32 v101, v242, v248
v_lshlrev_b32 v242, 16, v102
v_and_b32 v248, 0xffff0000, v102
v_mul_f32 v242, v242, v239
v_mul_f32 v248, v248, v239
v_cvt_pk_bf16_f32 v102, v242, v248
v_lshlrev_b32 v242, 16, v103
v_and_b32 v248, 0xffff0000, v103
v_mul_f32 v242, v242, v239
v_mul_f32 v248, v248, v239
v_cvt_pk_bf16_f32 v103, v242, v248
v_lshlrev_b32 v242, 16, v104
v_and_b32 v248, 0xffff0000, v104
v_mul_f32 v242, v242, v239
v_mul_f32 v248, v248, v239
v_cvt_pk_bf16_f32 v104, v242, v248
v_lshlrev_b32 v242, 16, v105
v_and_b32 v248, 0xffff0000, v105
v_mul_f32 v242, v242, v239
v_mul_f32 v248, v248, v239
v_cvt_pk_bf16_f32 v105, v242, v248
v_lshlrev_b32 v242, 16, v106
v_and_b32 v248, 0xffff0000, v106
v_mul_f32 v242, v242, v239
v_mul_f32 v248, v248, v239
v_cvt_pk_bf16_f32 v106, v242, v248
v_lshlrev_b32 v242, 16, v107
v_and_b32 v248, 0xffff0000, v107
v_mul_f32 v242, v242, v239
v_mul_f32 v248, v248, v239
v_cvt_pk_bf16_f32 v107, v242, v248
v_lshlrev_b32 v242, 16, v172
v_and_b32 v248, 0xffff0000, v172
v_mul_f32 v242, v242, v239
v_mul_f32 v248, v248, v239
v_cvt_pk_bf16_f32 v172, v242, v248
v_lshlrev_b32 v242, 16, v173
v_and_b32 v248, 0xffff0000, v173
v_mul_f32 v242, v242, v239
v_mul_f32 v248, v248, v239
v_cvt_pk_bf16_f32 v173, v242, v248
v_lshlrev_b32 v242, 16, v174
v_and_b32 v248, 0xffff0000, v174
v_mul_f32 v242, v242, v239
v_mul_f32 v248, v248, v239
v_cvt_pk_bf16_f32 v174, v242, v248
v_lshlrev_b32 v242, 16, v175
v_and_b32 v248, 0xffff0000, v175
v_mul_f32 v242, v242, v239
v_mul_f32 v248, v248, v239
v_cvt_pk_bf16_f32 v175, v242, v248
v_lshlrev_b32 v242, 16, v188
v_and_b32 v248, 0xffff0000, v188
v_mul_f32 v242, v242, v239
v_mul_f32 v248, v248, v239
v_cvt_pk_bf16_f32 v188, v242, v248
v_lshlrev_b32 v242, 16, v189
v_and_b32 v248, 0xffff0000, v189
v_mul_f32 v242, v242, v239
v_mul_f32 v248, v248, v239
v_cvt_pk_bf16_f32 v189, v242, v248
v_lshlrev_b32 v242, 16, v190
v_and_b32 v248, 0xffff0000, v190
v_mul_f32 v242, v242, v239
v_mul_f32 v248, v248, v239
v_cvt_pk_bf16_f32 v190, v242, v248
v_lshlrev_b32 v242, 16, v191
v_and_b32 v248, 0xffff0000, v191
v_mul_f32 v242, v242, v239
v_mul_f32 v248, v248, v239
v_cvt_pk_bf16_f32 v191, v242, v248
v_lshlrev_b32 v242, 16, v96
v_and_b32 v248, 0xffff0000, v96
v_mul_f32 v242, v242, v239
v_mul_f32 v248, v248, v239
v_cvt_pk_bf16_f32 v96, v242, v248
v_lshlrev_b32 v242, 16, v97
v_and_b32 v248, 0xffff0000, v97
v_mul_f32 v242, v242, v239
v_mul_f32 v248, v248, v239
v_cvt_pk_bf16_f32 v97, v242, v248
v_exp_f32 v232, v144
v_exp_f32 v233, v145
v_exp_f32 v234, v146
v_exp_f32 v235, v147
s_nop 1
v_add_f32 v224, v224, v232
v_add_f32 v224, v224, v233
v_add_f32 v224, v224, v234
v_add_f32 v224, v224, v235
v_cvt_pk_bf16_f32 v2, v232, v233
v_cvt_pk_bf16_f32 v3, v234, v235
v_exp_f32 v232, v148
v_exp_f32 v233, v149
v_exp_f32 v234, v150
v_exp_f32 v235, v151
s_nop 1
v_add_f32 v225, v225, v232
v_add_f32 v225, v225, v233
v_add_f32 v225, v225, v234
v_add_f32 v225, v225, v235
v_cvt_pk_bf16_f32 v34, v232, v233
v_cvt_pk_bf16_f32 v35, v234, v235
v_exp_f32 v232, v152
v_exp_f32 v233, v153
v_exp_f32 v234, v154
v_exp_f32 v235, v155
s_nop 1
v_add_f32 v226, v226, v232
v_add_f32 v226, v226, v233
v_add_f32 v226, v226, v234
v_add_f32 v226, v226, v235
v_cvt_pk_bf16_f32 v66, v232, v233
v_cvt_pk_bf16_f32 v67, v234, v235
v_exp_f32 v232, v156
v_exp_f32 v233, v157
v_exp_f32 v234, v158
v_exp_f32 v235, v159
s_nop 1
v_add_f32 v227, v227, v232
v_add_f32 v227, v227, v233
v_add_f32 v227, v227, v234
v_add_f32 v227, v227, v235
v_cvt_pk_bf16_f32 v98, v232, v233
v_cvt_pk_bf16_f32 v99, v234, v235
s_branch L2_rare_common
LF_hl_0:
s_mov_b32 s94, 0x10000
s_mov_b32 s3, 0x7c28000
LF_hl2_0:
v_lshlrev_b32 v241, 3, v243
buffer_load_dwordx2 v[240:241], v241, s[16:19], s3 offen sc1
s_sub_u32 s94, s94, 1
s_waitcnt vmcnt(0)
s_cbranch_scc1 LF_hlret_0
v_cmp_ne_u64_e64 s[38:39], s[98:99], v[240:241]
s_and_b64 s[38:39], s[38:39], s[96:97]
s_cbranch_scc1 LF_hl2_0
s_branch LF_hlret_0
L2_rare_common:
v_lshrrev_b32 v232, 4, v243
v_and_b32 v232, 0x30, v232
ds_bpermute_b32 v242, v232, v236 offset:0
ds_bpermute_b32 v248, v232, v236 offset:4
ds_bpermute_b32 v250, v232, v236 offset:8
ds_bpermute_b32 v251, v232, v236 offset:12
s_waitcnt lgkmcnt(0)
v_accvgpr_read_b32 v232, a0
v_accvgpr_read_b32 v233, a1
v_accvgpr_read_b32 v234, a2
v_accvgpr_read_b32 v235, a3
v_mul_f32 v232, v232, v242
v_mul_f32 v233, v233, v248
v_mul_f32 v234, v234, v250
v_mul_f32 v235, v235, v251
v_accvgpr_write_b32 a0, v232
v_accvgpr_write_b32 a1, v233
v_accvgpr_write_b32 a2, v234
v_accvgpr_write_b32 a3, v235
v_accvgpr_read_b32 v232, a16
v_accvgpr_read_b32 v233, a17
v_accvgpr_read_b32 v234, a18
v_accvgpr_read_b32 v235, a19
v_mul_f32 v232, v232, v242
v_mul_f32 v233, v233, v248
v_mul_f32 v234, v234, v250
v_mul_f32 v235, v235, v251
v_accvgpr_write_b32 a16, v232
v_accvgpr_write_b32 a17, v233
v_accvgpr_write_b32 a18, v234
v_accvgpr_write_b32 a19, v235
v_accvgpr_read_b32 v232, a32
v_accvgpr_read_b32 v233, a33
v_accvgpr_read_b32 v234, a34
v_accvgpr_read_b32 v235, a35
v_mul_f32 v232, v232, v242
v_mul_f32 v233, v233, v248
v_mul_f32 v234, v234, v250
v_mul_f32 v235, v235, v251
v_accvgpr_write_b32 a32, v232
v_accvgpr_write_b32 a33, v233
v_accvgpr_write_b32 a34, v234
v_accvgpr_write_b32 a35, v235
v_accvgpr_read_b32 v232, a48
v_accvgpr_read_b32 v233, a49
v_accvgpr_read_b32 v234, a50
v_accvgpr_read_b32 v235, a51
v_mul_f32 v232, v232, v242
v_mul_f32 v233, v233, v248
v_mul_f32 v234, v234, v250
v_mul_f32 v235, v235, v251
v_accvgpr_write_b32 a48, v232
v_accvgpr_write_b32 a49, v233
v_accvgpr_write_b32 a50, v234
v_accvgpr_write_b32 a51, v235
v_accvgpr_read_b32 v232, a64
v_accvgpr_read_b32 v233, a65
v_accvgpr_read_b32 v234, a66
v_accvgpr_read_b32 v235, a67
v_mul_f32 v232, v232, v242
v_mul_f32 v233, v233, v248
v_mul_f32 v234, v234, v250
v_mul_f32 v235, v235, v251
v_accvgpr_write_b32 a64, v232
v_accvgpr_write_b32 a65, v233
v_accvgpr_write_b32 a66, v234
v_accvgpr_write_b32 a67, v235
v_accvgpr_read_b32 v232, a80
v_accvgpr_read_b32 v233, a81
v_accvgpr_read_b32 v234, a82
v_accvgpr_read_b32 v235, a83
v_mul_f32 v232, v232, v242
v_mul_f32 v233, v233, v248
v_mul_f32 v234, v234, v250
v_mul_f32 v235, v235, v251
v_accvgpr_write_b32 a80, v232
v_accvgpr_write_b32 a81, v233
v_accvgpr_write_b32 a82, v234
v_accvgpr_write_b32 a83, v235
v_accvgpr_read_b32 v232, a96
v_accvgpr_read_b32 v233, a97
v_accvgpr_read_b32 v234, a98
v_accvgpr_read_b32 v235, a99
v_mul_f32 v232, v232, v242
v_mul_f32 v233, v233, v248
v_mul_f32 v234, v234, v250
v_mul_f32 v235, v235, v251
v_accvgpr_write_b32 a96, v232
v_accvgpr_write_b32 a97, v233
v_accvgpr_write_b32 a98, v234
v_accvgpr_write_b32 a99, v235
v_accvgpr_read_b32 v232, a112
v_accvgpr_read_b32 v233, a113
v_accvgpr_read_b32 v234, a114
v_accvgpr_read_b32 v235, a115
v_mul_f32 v232, v232, v242
v_mul_f32 v233, v233, v248
v_mul_f32 v234, v234, v250
v_mul_f32 v235, v235, v251
v_accvgpr_write_b32 a112, v232
v_accvgpr_write_b32 a113, v233
v_accvgpr_write_b32 a114, v234
v_accvgpr_write_b32 a115, v235
v_accvgpr_read_b32 v232, a128
v_accvgpr_read_b32 v233, a129
v_accvgpr_read_b32 v234, a130
v_accvgpr_read_b32 v235, a131
v_mul_f32 v232, v232, v242
v_mul_f32 v233, v233, v248
v_mul_f32 v234, v234, v250
v_mul_f32 v235, v235, v251
v_accvgpr_write_b32 a128, v232
v_accvgpr_write_b32 a129, v233
v_accvgpr_write_b32 a130, v234
v_accvgpr_write_b32 a131, v235
v_accvgpr_read_b32 v232, a144
v_accvgpr_read_b32 v233, a145
v_accvgpr_read_b32 v234, a146
v_accvgpr_read_b32 v235, a147
v_mul_f32 v232, v232, v242
v_mul_f32 v233, v233, v248
v_mul_f32 v234, v234, v250
v_mul_f32 v235, v235, v251
v_accvgpr_write_b32 a144, v232
v_accvgpr_write_b32 a145, v233
v_accvgpr_write_b32 a146, v234
v_accvgpr_write_b32 a147, v235
v_accvgpr_read_b32 v232, a160
v_accvgpr_read_b32 v233, a161
v_accvgpr_read_b32 v234, a162
v_accvgpr_read_b32 v235, a163
v_mul_f32 v232, v232, v242
v_mul_f32 v233, v233, v248
v_mul_f32 v234, v234, v250
v_mul_f32 v235, v235, v251
v_accvgpr_write_b32 a160, v232
v_accvgpr_write_b32 a161, v233
v_accvgpr_write_b32 a162, v234
v_accvgpr_write_b32 a163, v235
v_accvgpr_read_b32 v232, a176
v_accvgpr_read_b32 v233, a177
v_accvgpr_read_b32 v234, a178
v_accvgpr_read_b32 v235, a179
v_mul_f32 v232, v232, v242
v_mul_f32 v233, v233, v248
v_mul_f32 v234, v234, v250
v_mul_f32 v235, v235, v251
v_accvgpr_write_b32 a176, v232
v_accvgpr_write_b32 a177, v233
v_accvgpr_write_b32 a178, v234
v_accvgpr_write_b32 a179, v235
v_accvgpr_read_b32 v232, a192
v_accvgpr_read_b32 v233, a193
v_accvgpr_read_b32 v234, a194
v_accvgpr_read_b32 v235, a195
v_mul_f32 v232, v232, v242
v_mul_f32 v233, v233, v248
v_mul_f32 v234, v234, v250
v_mul_f32 v235, v235, v251
v_accvgpr_write_b32 a192, v232
v_accvgpr_write_b32 a193, v233
v_accvgpr_write_b32 a194, v234
v_accvgpr_write_b32 a195, v235
v_accvgpr_read_b32 v232, a208
v_accvgpr_read_b32 v233, a209
v_accvgpr_read_b32 v234, a210
v_accvgpr_read_b32 v235, a211
v_mul_f32 v232, v232, v242
v_mul_f32 v233, v233, v248
v_mul_f32 v234, v234, v250
v_mul_f32 v235, v235, v251
v_accvgpr_write_b32 a208, v232
v_accvgpr_write_b32 a209, v233
v_accvgpr_write_b32 a210, v234
v_accvgpr_write_b32 a211, v235
v_accvgpr_read_b32 v232, a224
v_accvgpr_read_b32 v233, a225
v_accvgpr_read_b32 v234, a226
v_accvgpr_read_b32 v235, a227
v_mul_f32 v232, v232, v242
v_mul_f32 v233, v233, v248
v_mul_f32 v234, v234, v250
v_mul_f32 v235, v235, v251
v_accvgpr_write_b32 a224, v232
v_accvgpr_write_b32 a225, v233
v_accvgpr_write_b32 a226, v234
v_accvgpr_write_b32 a227, v235
v_accvgpr_read_b32 v232, a240
v_accvgpr_read_b32 v233, a241
v_accvgpr_read_b32 v234, a242
v_accvgpr_read_b32 v235, a243
v_mul_f32 v232, v232, v242
v_mul_f32 v233, v233, v248
v_mul_f32 v234, v234, v250
v_mul_f32 v235, v235, v251
v_accvgpr_write_b32 a240, v232
v_accvgpr_write_b32 a241, v233
v_accvgpr_write_b32 a242, v234
v_accvgpr_write_b32 a243, v235
v_lshrrev_b32 v232, 4, v243
v_and_b32 v232, 0x30, v232
ds_bpermute_b32 v242, v232, v237 offset:0
ds_bpermute_b32 v248, v232, v237 offset:4
ds_bpermute_b32 v250, v232, v237 offset:8
ds_bpermute_b32 v251, v232, v237 offset:12
s_waitcnt lgkmcnt(0)
v_accvgpr_read_b32 v232, a4
v_accvgpr_read_b32 v233, a5
v_accvgpr_read_b32 v234, a6
v_accvgpr_read_b32 v235, a7
v_mul_f32 v232, v232, v242
v_mul_f32 v233, v233, v248
v_mul_f32 v234, v234, v250
v_mul_f32 v235, v235, v251
v_accvgpr_write_b32 a4, v232
v_accvgpr_write_b32 a5, v233
v_accvgpr_write_b32 a6, v234
v_accvgpr_write_b32 a7, v235
v_accvgpr_read_b32 v232, a20
v_accvgpr_read_b32 v233, a21
v_accvgpr_read_b32 v234, a22
v_accvgpr_read_b32 v235, a23
v_mul_f32 v232, v232, v242
v_mul_f32 v233, v233, v248
v_mul_f32 v234, v234, v250
v_mul_f32 v235, v235, v251
v_accvgpr_write_b32 a20, v232
v_accvgpr_write_b32 a21, v233
v_accvgpr_write_b32 a22, v234
v_accvgpr_write_b32 a23, v235
v_accvgpr_read_b32 v232, a36
v_accvgpr_read_b32 v233, a37
v_accvgpr_read_b32 v234, a38
v_accvgpr_read_b32 v235, a39
v_mul_f32 v232, v232, v242
v_mul_f32 v233, v233, v248
v_mul_f32 v234, v234, v250
v_mul_f32 v235, v235, v251
v_accvgpr_write_b32 a36, v232
v_accvgpr_write_b32 a37, v233
v_accvgpr_write_b32 a38, v234
v_accvgpr_write_b32 a39, v235
v_accvgpr_read_b32 v232, a52
v_accvgpr_read_b32 v233, a53
v_accvgpr_read_b32 v234, a54
v_accvgpr_read_b32 v235, a55
v_mul_f32 v232, v232, v242
v_mul_f32 v233, v233, v248
v_mul_f32 v234, v234, v250
v_mul_f32 v235, v235, v251
v_accvgpr_write_b32 a52, v232
v_accvgpr_write_b32 a53, v233
v_accvgpr_write_b32 a54, v234
v_accvgpr_write_b32 a55, v235
v_accvgpr_read_b32 v232, a68
v_accvgpr_read_b32 v233, a69
v_accvgpr_read_b32 v234, a70
v_accvgpr_read_b32 v235, a71
v_mul_f32 v232, v232, v242
v_mul_f32 v233, v233, v248
v_mul_f32 v234, v234, v250
v_mul_f32 v235, v235, v251
v_accvgpr_write_b32 a68, v232
v_accvgpr_write_b32 a69, v233
v_accvgpr_write_b32 a70, v234
v_accvgpr_write_b32 a71, v235
v_accvgpr_read_b32 v232, a84
v_accvgpr_read_b32 v233, a85
v_accvgpr_read_b32 v234, a86
v_accvgpr_read_b32 v235, a87
v_mul_f32 v232, v232, v242
v_mul_f32 v233, v233, v248
v_mul_f32 v234, v234, v250
v_mul_f32 v235, v235, v251
v_accvgpr_write_b32 a84, v232
v_accvgpr_write_b32 a85, v233
v_accvgpr_write_b32 a86, v234
v_accvgpr_write_b32 a87, v235
v_accvgpr_read_b32 v232, a100
v_accvgpr_read_b32 v233, a101
v_accvgpr_read_b32 v234, a102
v_accvgpr_read_b32 v235, a103
v_mul_f32 v232, v232, v242
v_mul_f32 v233, v233, v248
v_mul_f32 v234, v234, v250
v_mul_f32 v235, v235, v251
v_accvgpr_write_b32 a100, v232
v_accvgpr_write_b32 a101, v233
v_accvgpr_write_b32 a102, v234
v_accvgpr_write_b32 a103, v235
v_accvgpr_read_b32 v232, a116
v_accvgpr_read_b32 v233, a117
v_accvgpr_read_b32 v234, a118
v_accvgpr_read_b32 v235, a119
v_mul_f32 v232, v232, v242
v_mul_f32 v233, v233, v248
v_mul_f32 v234, v234, v250
v_mul_f32 v235, v235, v251
v_accvgpr_write_b32 a116, v232
v_accvgpr_write_b32 a117, v233
v_accvgpr_write_b32 a118, v234
v_accvgpr_write_b32 a119, v235
v_accvgpr_read_b32 v232, a132
v_accvgpr_read_b32 v233, a133
v_accvgpr_read_b32 v234, a134
v_accvgpr_read_b32 v235, a135
v_mul_f32 v232, v232, v242
v_mul_f32 v233, v233, v248
v_mul_f32 v234, v234, v250
v_mul_f32 v235, v235, v251
v_accvgpr_write_b32 a132, v232
v_accvgpr_write_b32 a133, v233
v_accvgpr_write_b32 a134, v234
v_accvgpr_write_b32 a135, v235
v_accvgpr_read_b32 v232, a148
v_accvgpr_read_b32 v233, a149
v_accvgpr_read_b32 v234, a150
v_accvgpr_read_b32 v235, a151
v_mul_f32 v232, v232, v242
v_mul_f32 v233, v233, v248
v_mul_f32 v234, v234, v250
v_mul_f32 v235, v235, v251
v_accvgpr_write_b32 a148, v232
v_accvgpr_write_b32 a149, v233
v_accvgpr_write_b32 a150, v234
v_accvgpr_write_b32 a151, v235
v_accvgpr_read_b32 v232, a164
v_accvgpr_read_b32 v233, a165
v_accvgpr_read_b32 v234, a166
v_accvgpr_read_b32 v235, a167
v_mul_f32 v232, v232, v242
v_mul_f32 v233, v233, v248
v_mul_f32 v234, v234, v250
v_mul_f32 v235, v235, v251
v_accvgpr_write_b32 a164, v232
v_accvgpr_write_b32 a165, v233
v_accvgpr_write_b32 a166, v234
v_accvgpr_write_b32 a167, v235
v_accvgpr_read_b32 v232, a180
v_accvgpr_read_b32 v233, a181
v_accvgpr_read_b32 v234, a182
v_accvgpr_read_b32 v235, a183
v_mul_f32 v232, v232, v242
v_mul_f32 v233, v233, v248
v_mul_f32 v234, v234, v250
v_mul_f32 v235, v235, v251
v_accvgpr_write_b32 a180, v232
v_accvgpr_write_b32 a181, v233
v_accvgpr_write_b32 a182, v234
v_accvgpr_write_b32 a183, v235
v_accvgpr_read_b32 v232, a196
v_accvgpr_read_b32 v233, a197
v_accvgpr_read_b32 v234, a198
v_accvgpr_read_b32 v235, a199
v_mul_f32 v232, v232, v242
v_mul_f32 v233, v233, v248
v_mul_f32 v234, v234, v250
v_mul_f32 v235, v235, v251
v_accvgpr_write_b32 a196, v232
v_accvgpr_write_b32 a197, v233
v_accvgpr_write_b32 a198, v234
v_accvgpr_write_b32 a199, v235
v_accvgpr_read_b32 v232, a212
v_accvgpr_read_b32 v233, a213
v_accvgpr_read_b32 v234, a214
v_accvgpr_read_b32 v235, a215
v_mul_f32 v232, v232, v242
v_mul_f32 v233, v233, v248
v_mul_f32 v234, v234, v250
v_mul_f32 v235, v235, v251
v_accvgpr_write_b32 a212, v232
v_accvgpr_write_b32 a213, v233
v_accvgpr_write_b32 a214, v234
v_accvgpr_write_b32 a215, v235
v_accvgpr_read_b32 v232, a228
v_accvgpr_read_b32 v233, a229
v_accvgpr_read_b32 v234, a230
v_accvgpr_read_b32 v235, a231
v_mul_f32 v232, v232, v242
v_mul_f32 v233, v233, v248
v_mul_f32 v234, v234, v250
v_mul_f32 v235, v235, v251
v_accvgpr_write_b32 a228, v232
v_accvgpr_write_b32 a229, v233
v_accvgpr_write_b32 a230, v234
v_accvgpr_write_b32 a231, v235
v_accvgpr_read_b32 v232, a244
v_accvgpr_read_b32 v233, a245
v_accvgpr_read_b32 v234, a246
v_accvgpr_read_b32 v235, a247
v_mul_f32 v232, v232, v242
v_mul_f32 v233, v233, v248
v_mul_f32 v234, v234, v250
v_mul_f32 v235, v235, v251
v_accvgpr_write_b32 a244, v232
v_accvgpr_write_b32 a245, v233
v_accvgpr_write_b32 a246, v234
v_accvgpr_write_b32 a247, v235
v_lshrrev_b32 v232, 4, v243
v_and_b32 v232, 0x30, v232
ds_bpermute_b32 v242, v232, v238 offset:0
ds_bpermute_b32 v248, v232, v238 offset:4
ds_bpermute_b32 v250, v232, v238 offset:8
ds_bpermute_b32 v251, v232, v238 offset:12
s_waitcnt lgkmcnt(0)
v_accvgpr_read_b32 v232, a8
v_accvgpr_read_b32 v233, a9
v_accvgpr_read_b32 v234, a10
v_accvgpr_read_b32 v235, a11
v_mul_f32 v232, v232, v242
v_mul_f32 v233, v233, v248
v_mul_f32 v234, v234, v250
v_mul_f32 v235, v235, v251
v_accvgpr_write_b32 a8, v232
v_accvgpr_write_b32 a9, v233
v_accvgpr_write_b32 a10, v234
v_accvgpr_write_b32 a11, v235
v_accvgpr_read_b32 v232, a24
v_accvgpr_read_b32 v233, a25
v_accvgpr_read_b32 v234, a26
v_accvgpr_read_b32 v235, a27
v_mul_f32 v232, v232, v242
v_mul_f32 v233, v233, v248
v_mul_f32 v234, v234, v250
v_mul_f32 v235, v235, v251
v_accvgpr_write_b32 a24, v232
v_accvgpr_write_b32 a25, v233
v_accvgpr_write_b32 a26, v234
v_accvgpr_write_b32 a27, v235
v_accvgpr_read_b32 v232, a40
v_accvgpr_read_b32 v233, a41
v_accvgpr_read_b32 v234, a42
v_accvgpr_read_b32 v235, a43
v_mul_f32 v232, v232, v242
v_mul_f32 v233, v233, v248
v_mul_f32 v234, v234, v250
v_mul_f32 v235, v235, v251
v_accvgpr_write_b32 a40, v232
v_accvgpr_write_b32 a41, v233
v_accvgpr_write_b32 a42, v234
v_accvgpr_write_b32 a43, v235
v_accvgpr_read_b32 v232, a56
v_accvgpr_read_b32 v233, a57
v_accvgpr_read_b32 v234, a58
v_accvgpr_read_b32 v235, a59
v_mul_f32 v232, v232, v242
v_mul_f32 v233, v233, v248
v_mul_f32 v234, v234, v250
v_mul_f32 v235, v235, v251
v_accvgpr_write_b32 a56, v232
v_accvgpr_write_b32 a57, v233
v_accvgpr_write_b32 a58, v234
v_accvgpr_write_b32 a59, v235
v_accvgpr_read_b32 v232, a72
v_accvgpr_read_b32 v233, a73
v_accvgpr_read_b32 v234, a74
v_accvgpr_read_b32 v235, a75
v_mul_f32 v232, v232, v242
v_mul_f32 v233, v233, v248
v_mul_f32 v234, v234, v250
v_mul_f32 v235, v235, v251
v_accvgpr_write_b32 a72, v232
v_accvgpr_write_b32 a73, v233
v_accvgpr_write_b32 a74, v234
v_accvgpr_write_b32 a75, v235
v_accvgpr_read_b32 v232, a88
v_accvgpr_read_b32 v233, a89
v_accvgpr_read_b32 v234, a90
v_accvgpr_read_b32 v235, a91
v_mul_f32 v232, v232, v242
v_mul_f32 v233, v233, v248
v_mul_f32 v234, v234, v250
v_mul_f32 v235, v235, v251
v_accvgpr_write_b32 a88, v232
v_accvgpr_write_b32 a89, v233
v_accvgpr_write_b32 a90, v234
v_accvgpr_write_b32 a91, v235
v_accvgpr_read_b32 v232, a104
v_accvgpr_read_b32 v233, a105
v_accvgpr_read_b32 v234, a106
v_accvgpr_read_b32 v235, a107
v_mul_f32 v232, v232, v242
v_mul_f32 v233, v233, v248
v_mul_f32 v234, v234, v250
v_mul_f32 v235, v235, v251
v_accvgpr_write_b32 a104, v232
v_accvgpr_write_b32 a105, v233
v_accvgpr_write_b32 a106, v234
v_accvgpr_write_b32 a107, v235
v_accvgpr_read_b32 v232, a120
v_accvgpr_read_b32 v233, a121
v_accvgpr_read_b32 v234, a122
v_accvgpr_read_b32 v235, a123
v_mul_f32 v232, v232, v242
v_mul_f32 v233, v233, v248
v_mul_f32 v234, v234, v250
v_mul_f32 v235, v235, v251
v_accvgpr_write_b32 a120, v232
v_accvgpr_write_b32 a121, v233
v_accvgpr_write_b32 a122, v234
v_accvgpr_write_b32 a123, v235
v_accvgpr_read_b32 v232, a136
v_accvgpr_read_b32 v233, a137
v_accvgpr_read_b32 v234, a138
v_accvgpr_read_b32 v235, a139
v_mul_f32 v232, v232, v242
v_mul_f32 v233, v233, v248
v_mul_f32 v234, v234, v250
v_mul_f32 v235, v235, v251
v_accvgpr_write_b32 a136, v232
v_accvgpr_write_b32 a137, v233
v_accvgpr_write_b32 a138, v234
v_accvgpr_write_b32 a139, v235
v_accvgpr_read_b32 v232, a152
v_accvgpr_read_b32 v233, a153
v_accvgpr_read_b32 v234, a154
v_accvgpr_read_b32 v235, a155
v_mul_f32 v232, v232, v242
v_mul_f32 v233, v233, v248
v_mul_f32 v234, v234, v250
v_mul_f32 v235, v235, v251
v_accvgpr_write_b32 a152, v232
v_accvgpr_write_b32 a153, v233
v_accvgpr_write_b32 a154, v234
v_accvgpr_write_b32 a155, v235
v_accvgpr_read_b32 v232, a168
v_accvgpr_read_b32 v233, a169
v_accvgpr_read_b32 v234, a170
v_accvgpr_read_b32 v235, a171
v_mul_f32 v232, v232, v242
v_mul_f32 v233, v233, v248
v_mul_f32 v234, v234, v250
v_mul_f32 v235, v235, v251
v_accvgpr_write_b32 a168, v232
v_accvgpr_write_b32 a169, v233
v_accvgpr_write_b32 a170, v234
v_accvgpr_write_b32 a171, v235
v_accvgpr_read_b32 v232, a184
v_accvgpr_read_b32 v233, a185
v_accvgpr_read_b32 v234, a186
v_accvgpr_read_b32 v235, a187
v_mul_f32 v232, v232, v242
v_mul_f32 v233, v233, v248
v_mul_f32 v234, v234, v250
v_mul_f32 v235, v235, v251
v_accvgpr_write_b32 a184, v232
v_accvgpr_write_b32 a185, v233
v_accvgpr_write_b32 a186, v234
v_accvgpr_write_b32 a187, v235
v_accvgpr_read_b32 v232, a200
v_accvgpr_read_b32 v233, a201
v_accvgpr_read_b32 v234, a202
v_accvgpr_read_b32 v235, a203
v_mul_f32 v232, v232, v242
v_mul_f32 v233, v233, v248
v_mul_f32 v234, v234, v250
v_mul_f32 v235, v235, v251
v_accvgpr_write_b32 a200, v232
v_accvgpr_write_b32 a201, v233
v_accvgpr_write_b32 a202, v234
v_accvgpr_write_b32 a203, v235
v_accvgpr_read_b32 v232, a216
v_accvgpr_read_b32 v233, a217
v_accvgpr_read_b32 v234, a218
v_accvgpr_read_b32 v235, a219
v_mul_f32 v232, v232, v242
v_mul_f32 v233, v233, v248
v_mul_f32 v234, v234, v250
v_mul_f32 v235, v235, v251
v_accvgpr_write_b32 a216, v232
v_accvgpr_write_b32 a217, v233
v_accvgpr_write_b32 a218, v234
v_accvgpr_write_b32 a219, v235
v_accvgpr_read_b32 v232, a232
v_accvgpr_read_b32 v233, a233
v_accvgpr_read_b32 v234, a234
v_accvgpr_read_b32 v235, a235
v_mul_f32 v232, v232, v242
v_mul_f32 v233, v233, v248
v_mul_f32 v234, v234, v250
v_mul_f32 v235, v235, v251
v_accvgpr_write_b32 a232, v232
v_accvgpr_write_b32 a233, v233
v_accvgpr_write_b32 a234, v234
v_accvgpr_write_b32 a235, v235
v_accvgpr_read_b32 v232, a248
v_accvgpr_read_b32 v233, a249
v_accvgpr_read_b32 v234, a250
v_accvgpr_read_b32 v235, a251
v_mul_f32 v232, v232, v242
v_mul_f32 v233, v233, v248
v_mul_f32 v234, v234, v250
v_mul_f32 v235, v235, v251
v_accvgpr_write_b32 a248, v232
v_accvgpr_write_b32 a249, v233
v_accvgpr_write_b32 a250, v234
v_accvgpr_write_b32 a251, v235
v_lshrrev_b32 v232, 4, v243
v_and_b32 v232, 0x30, v232
ds_bpermute_b32 v242, v232, v239 offset:0
ds_bpermute_b32 v248, v232, v239 offset:4
ds_bpermute_b32 v250, v232, v239 offset:8
ds_bpermute_b32 v251, v232, v239 offset:12
s_waitcnt lgkmcnt(0)
v_accvgpr_read_b32 v232, a12
v_accvgpr_read_b32 v233, a13
v_accvgpr_read_b32 v234, a14
v_accvgpr_read_b32 v235, a15
v_mul_f32 v232, v232, v242
v_mul_f32 v233, v233, v248
v_mul_f32 v234, v234, v250
v_mul_f32 v235, v235, v251
v_accvgpr_write_b32 a12, v232
v_accvgpr_write_b32 a13, v233
v_accvgpr_write_b32 a14, v234
v_accvgpr_write_b32 a15, v235
v_accvgpr_read_b32 v232, a28
v_accvgpr_read_b32 v233, a29
v_accvgpr_read_b32 v234, a30
v_accvgpr_read_b32 v235, a31
v_mul_f32 v232, v232, v242
v_mul_f32 v233, v233, v248
v_mul_f32 v234, v234, v250
v_mul_f32 v235, v235, v251
v_accvgpr_write_b32 a28, v232
v_accvgpr_write_b32 a29, v233
v_accvgpr_write_b32 a30, v234
v_accvgpr_write_b32 a31, v235
v_accvgpr_read_b32 v232, a44
v_accvgpr_read_b32 v233, a45
v_accvgpr_read_b32 v234, a46
v_accvgpr_read_b32 v235, a47
v_mul_f32 v232, v232, v242
v_mul_f32 v233, v233, v248
v_mul_f32 v234, v234, v250
v_mul_f32 v235, v235, v251
v_accvgpr_write_b32 a44, v232
v_accvgpr_write_b32 a45, v233
v_accvgpr_write_b32 a46, v234
v_accvgpr_write_b32 a47, v235
v_accvgpr_read_b32 v232, a60
v_accvgpr_read_b32 v233, a61
v_accvgpr_read_b32 v234, a62
v_accvgpr_read_b32 v235, a63
v_mul_f32 v232, v232, v242
v_mul_f32 v233, v233, v248
v_mul_f32 v234, v234, v250
v_mul_f32 v235, v235, v251
v_accvgpr_write_b32 a60, v232
v_accvgpr_write_b32 a61, v233
v_accvgpr_write_b32 a62, v234
v_accvgpr_write_b32 a63, v235
v_accvgpr_read_b32 v232, a76
v_accvgpr_read_b32 v233, a77
v_accvgpr_read_b32 v234, a78
v_accvgpr_read_b32 v235, a79
v_mul_f32 v232, v232, v242
v_mul_f32 v233, v233, v248
v_mul_f32 v234, v234, v250
v_mul_f32 v235, v235, v251
v_accvgpr_write_b32 a76, v232
v_accvgpr_write_b32 a77, v233
v_accvgpr_write_b32 a78, v234
v_accvgpr_write_b32 a79, v235
v_accvgpr_read_b32 v232, a92
v_accvgpr_read_b32 v233, a93
v_accvgpr_read_b32 v234, a94
v_accvgpr_read_b32 v235, a95
v_mul_f32 v232, v232, v242
v_mul_f32 v233, v233, v248
v_mul_f32 v234, v234, v250
v_mul_f32 v235, v235, v251
v_accvgpr_write_b32 a92, v232
v_accvgpr_write_b32 a93, v233
v_accvgpr_write_b32 a94, v234
v_accvgpr_write_b32 a95, v235
v_accvgpr_read_b32 v232, a108
v_accvgpr_read_b32 v233, a109
v_accvgpr_read_b32 v234, a110
v_accvgpr_read_b32 v235, a111
v_mul_f32 v232, v232, v242
v_mul_f32 v233, v233, v248
v_mul_f32 v234, v234, v250
v_mul_f32 v235, v235, v251
v_accvgpr_write_b32 a108, v232
v_accvgpr_write_b32 a109, v233
v_accvgpr_write_b32 a110, v234
v_accvgpr_write_b32 a111, v235
v_accvgpr_read_b32 v232, a124
v_accvgpr_read_b32 v233, a125
v_accvgpr_read_b32 v234, a126
v_accvgpr_read_b32 v235, a127
v_mul_f32 v232, v232, v242
v_mul_f32 v233, v233, v248
v_mul_f32 v234, v234, v250
v_mul_f32 v235, v235, v251
v_accvgpr_write_b32 a124, v232
v_accvgpr_write_b32 a125, v233
v_accvgpr_write_b32 a126, v234
v_accvgpr_write_b32 a127, v235
v_accvgpr_read_b32 v232, a140
v_accvgpr_read_b32 v233, a141
v_accvgpr_read_b32 v234, a142
v_accvgpr_read_b32 v235, a143
v_mul_f32 v232, v232, v242
v_mul_f32 v233, v233, v248
v_mul_f32 v234, v234, v250
v_mul_f32 v235, v235, v251
v_accvgpr_write_b32 a140, v232
v_accvgpr_write_b32 a141, v233
v_accvgpr_write_b32 a142, v234
v_accvgpr_write_b32 a143, v235
v_accvgpr_read_b32 v232, a156
v_accvgpr_read_b32 v233, a157
v_accvgpr_read_b32 v234, a158
v_accvgpr_read_b32 v235, a159
v_mul_f32 v232, v232, v242
v_mul_f32 v233, v233, v248
v_mul_f32 v234, v234, v250
v_mul_f32 v235, v235, v251
v_accvgpr_write_b32 a156, v232
v_accvgpr_write_b32 a157, v233
v_accvgpr_write_b32 a158, v234
v_accvgpr_write_b32 a159, v235
v_accvgpr_read_b32 v232, a172
v_accvgpr_read_b32 v233, a173
v_accvgpr_read_b32 v234, a174
v_accvgpr_read_b32 v235, a175
v_mul_f32 v232, v232, v242
v_mul_f32 v233, v233, v248
v_mul_f32 v234, v234, v250
v_mul_f32 v235, v235, v251
v_accvgpr_write_b32 a172, v232
v_accvgpr_write_b32 a173, v233
v_accvgpr_write_b32 a174, v234
v_accvgpr_write_b32 a175, v235
v_accvgpr_read_b32 v232, a188
v_accvgpr_read_b32 v233, a189
v_accvgpr_read_b32 v234, a190
v_accvgpr_read_b32 v235, a191
v_mul_f32 v232, v232, v242
v_mul_f32 v233, v233, v248
v_mul_f32 v234, v234, v250
v_mul_f32 v235, v235, v251
v_accvgpr_write_b32 a188, v232
v_accvgpr_write_b32 a189, v233
v_accvgpr_write_b32 a190, v234
v_accvgpr_write_b32 a191, v235
v_accvgpr_read_b32 v232, a204
v_accvgpr_read_b32 v233, a205
v_accvgpr_read_b32 v234, a206
v_accvgpr_read_b32 v235, a207
v_mul_f32 v232, v232, v242
v_mul_f32 v233, v233, v248
v_mul_f32 v234, v234, v250
v_mul_f32 v235, v235, v251
v_accvgpr_write_b32 a204, v232
v_accvgpr_write_b32 a205, v233
v_accvgpr_write_b32 a206, v234
v_accvgpr_write_b32 a207, v235
v_accvgpr_read_b32 v232, a220
v_accvgpr_read_b32 v233, a221
v_accvgpr_read_b32 v234, a222
v_accvgpr_read_b32 v235, a223
v_mul_f32 v232, v232, v242
v_mul_f32 v233, v233, v248
v_mul_f32 v234, v234, v250
v_mul_f32 v235, v235, v251
v_accvgpr_write_b32 a220, v232
v_accvgpr_write_b32 a221, v233
v_accvgpr_write_b32 a222, v234
v_accvgpr_write_b32 a223, v235
v_accvgpr_read_b32 v232, a236
v_accvgpr_read_b32 v233, a237
v_accvgpr_read_b32 v234, a238
v_accvgpr_read_b32 v235, a239
v_mul_f32 v232, v232, v242
v_mul_f32 v233, v233, v248
v_mul_f32 v234, v234, v250
v_mul_f32 v235, v235, v251
v_accvgpr_write_b32 a236, v232
v_accvgpr_write_b32 a237, v233
v_accvgpr_write_b32 a238, v234
v_accvgpr_write_b32 a239, v235
v_accvgpr_read_b32 v232, a252
v_accvgpr_read_b32 v233, a253
v_accvgpr_read_b32 v234, a254
v_accvgpr_read_b32 v235, a255
v_mul_f32 v232, v232, v242
v_mul_f32 v233, v233, v248
v_mul_f32 v234, v234, v250
v_mul_f32 v235, v235, v251
v_accvgpr_write_b32 a252, v232
v_accvgpr_write_b32 a253, v233
v_accvgpr_write_b32 a254, v234
v_accvgpr_write_b32 a255, v235
s_nop 3
s_cmp_eq_u32 s36, 0
s_cbranch_scc1 L2_rr0
s_cmp_eq_u32 s36, 1
s_cbranch_scc1 L2_rr1
s_cmp_eq_u32 s36, 2
s_cbranch_scc1 L2_rr2
s_cmp_eq_u32 s36, 3
s_cbranch_scc1 L2_rr3
s_cmp_eq_u32 s36, 4
s_cbranch_scc1 L2_rr4
s_cmp_eq_u32 s36, 5
s_cbranch_scc1 L2_rr5
s_cmp_eq_u32 s36, 6
s_cbranch_scc1 L2_rr6
s_cmp_eq_u32 s36, 7
s_cbranch_scc1 L2_rr7
s_cmp_eq_u32 s36, 8
s_cbranch_scc1 L2_rr8
s_cmp_eq_u32 s36, 9
s_cbranch_scc1 L2_rr9
s_cmp_eq_u32 s36, 10
s_cbranch_scc1 L2_rr10
s_cmp_eq_u32 s36, 11
s_cbranch_scc1 L2_rr11
s_cmp_eq_u32 s36, 12
s_cbranch_scc1 L2_rr12
s_cmp_eq_u32 s36, 13
s_cbranch_scc1 L2_rr13
s_cmp_eq_u32 s36, 14
s_cbranch_scc1 L2_rr14
s_cmp_eq_u32 s36, 15
s_cbranch_scc1 L2_rr15
s_cmp_eq_u32 s36, 16
s_cbranch_scc1 L2_rr16
L2_rr17:
s_waitcnt lgkmcnt(0)
s_branch L2_ret17
L2_rr16:
s_waitcnt lgkmcnt(0)
s_branch L2_ret16
L2_rr15:
s_waitcnt lgkmcnt(0)
s_branch L2_ret15
L2_rr14:
s_waitcnt lgkmcnt(0)
s_branch L2_ret14
L2_rr13:
s_waitcnt lgkmcnt(0)
s_branch L2_ret13
L2_rr12:
s_waitcnt lgkmcnt(0)
s_branch L2_ret12
L2_rr11:
s_waitcnt lgkmcnt(0)
s_branch L2_ret11
L2_rr10:
s_waitcnt lgkmcnt(0)
s_branch L2_ret10
L2_rr9:
s_waitcnt lgkmcnt(0)
s_branch L2_ret9
L2_rr8:
s_waitcnt lgkmcnt(0)
s_branch L2_ret8
L2_rr7:
s_waitcnt lgkmcnt(0)
s_branch L2_ret7
L2_rr6:
s_waitcnt lgkmcnt(0)
s_branch L2_ret6
L2_rr5:
s_waitcnt lgkmcnt(0)
s_branch L2_ret5
L2_rr4:
s_waitcnt lgkmcnt(0)
s_branch L2_ret4
L2_rr3:
s_waitcnt lgkmcnt(0)
s_branch L2_ret3
L2_rr2:
s_waitcnt lgkmcnt(0)
s_branch L2_ret2
L2_rr1:
s_waitcnt lgkmcnt(0)
s_branch L2_ret1
L2_rr0:
s_waitcnt lgkmcnt(0)
s_branch L2_ret0
s_endpgm
.section .rodata,"a"
.p2align 6
.amdhsa_kernel standalone__hybrid_graph_tf_graphgps__graph_kernel
  .amdhsa_next_free_vgpr 512
  .amdhsa_next_free_sgpr 102
  .amdhsa_accum_offset 256
  .amdhsa_group_segment_fixed_size 0
  .amdhsa_kernarg_size 96
  .amdhsa_user_sgpr_count 2
  .amdhsa_user_sgpr_kernarg_segment_ptr 1
  .amdhsa_system_sgpr_workgroup_id_x 1
.end_amdhsa_kernel
```

```asm
; @launch grid=(256,1,1) block=(256,1,1) lds=163840
.amdgcn_target "amdgcn-amd-amdhsa--gfx950"
.text
.globl standalone__hybrid_graph_tf_graphgps__graph_kernel
.p2align 8
.type standalone__hybrid_graph_tf_graphgps__graph_kernel,@function
standalone__hybrid_graph_tf_graphgps__graph_kernel:
s_getpc_b64 s[56:57]
s_load_dwordx16 s[16:31], s[0:1], 0
s_load_dwordx8 s[32:39], s[0:1], 64
s_cmp_ge_u32 s2, 256
s_cbranch_scc1 L2_end
v_lshrrev_b32 v1, 6, v0
v_and_b32 v2, 63, v0
s_lshr_b32 s3, s2, 3
s_add_u32 s3, s3, 30
s_and_b32 s3, s3, 31
v_readfirstlane_b32 s60, v1
s_lshl_b32 s5, s3, 2
s_add_u32 s5, s5, s60
s_and_b32 s56, s56, 0xffffff00
s_mov_b32 s58, L2_hot-standalone__hybrid_graph_tf_graphgps__graph_kernel
s_mov_b32 s59, 0x00020000
s_and_b32 s6, s5, 15
s_lshl_b32 s6, s6, 13
s_cmp_lt_u32 s5, 32
s_cselect_b32 s6, s6, 0x7fff0000
v_lshlrev_b32 v10, 7, v2
buffer_load_dword v255, v10, s[56:59], s6 offen
v_and_b32 v3, 15, v2
v_lshrrev_b32 v4, 4, v2
s_and_b32 s62, s3, 7
s_mov_b64 s[14:15], 0
s_and_b32 s8, s2, 7
s_cmp_ge_u32 s3, 30
s_cbranch_scc1 LM_edge
s_mul_i32 s12, s3, 26
s_lshr_b32 s12, s12, 8
s_mul_i32 s9, s12, 10
s_sub_u32 s9, s3, s9
s_and_b32 s13, s8, 1
s_mul_i32 s13, s13, 3
s_add_u32 s13, s13, s12
s_and_b32 s12, s8, 1
s_mul_i32 s12, s12, 5
s_add_u32 s8, s8, s12
s_and_b32 s8, s8, 7
s_lshr_b32 s12, s8, 1
s_mul_i32 s12, s12, 10
s_add_u32 s12, s12, s9
s_mul_i32 s91, s12, 6
s_add_u32 s91, s91, s13
s_mov_b32 s61, 0
s_cmp_eq_u32 s12, 39
s_cbranch_scc1 LM_light
s_mul_i32 s14, s13, 3
s_min_u32 s14, s14, 14
s_lshl_b32 s9, s12, 4
s_add_u32 s14, s14, s9
s_lshl_b32 s14, s14, 13
s_cmp_eq_u32 s91, 233
s_cselect_b32 s9, 0, s13
s_cmp_lt_u32 s9, 4
s_cselect_b32 s15, 3, 2
s_lshl_b32 s15, s15, 13
s_add_u32 s15, s15, s14
v_lshlrev_b32 v16, 4, v2
s_mul_i32 s63, s60, 12288
s_mov_b32 s6, s14
s_mul_i32 s7, s60, 6144
s_add_u32 s64, s6, s7
s_add_u32 s65, s64, 4096
s_lshl_b32 s7, s60, 7
v_lshrrev_b32 v5, 3, v2
v_and_b32 v6, 7, v2
v_and_b32 v7, 2, v5
v_xor_b32 v6, v6, v7
v_lshl_add_u32 v5, v5, 9, s7
v_lshl_add_u32 v17, v6, 4, v5
v_xor_b32 v6, 4, v6
v_lshl_add_u32 v18, v6, 4, v5
v_add_u32 v18, 0xc00, v18
v_add_u32 v19, 0x1800, v17
v_add_u32 v20, 0x1800, v18
s_xor_b32 s6, s62, 0
s_lshl_b32 s66, s6, 14
s_xor_b32 s6, s62, 1
s_lshl_b32 s67, s6, 14
s_xor_b32 s6, s62, 2
s_lshl_b32 s68, s6, 14
s_xor_b32 s6, s62, 3
s_lshl_b32 s69, s6, 14
s_xor_b32 s6, s62, 4
s_lshl_b32 s70, s6, 14
s_xor_b32 s6, s62, 5
s_lshl_b32 s71, s6, 14
s_xor_b32 s6, s62, 6
s_lshl_b32 s72, s6, 14
s_xor_b32 s6, s62, 7
s_lshl_b32 s73, s6, 14
s_waitcnt lgkmcnt(0)
s_add_u32 s40, s16, 0x0
s_addc_u32 s41, s17, 0
s_mov_b32 s42, s15
s_mov_b32 s43, 0x00020000
s_add_u32 s44, s26, 0x0
s_addc_u32 s45, s27, 0
s_mov_b32 s46, 0x20000
s_mov_b32 s47, 0x00020000
buffer_load_dwordx4 v[44:47], v16, s[40:43], s64 offen offset:0
buffer_load_dwordx4 v[48:51], v16, s[40:43], s64 offen offset:1024
buffer_load_dwordx4 v[52:55], v16, s[40:43], s64 offen offset:2048
buffer_load_dwordx4 v[56:59], v16, s[40:43], s64 offen offset:3072
buffer_load_dwordx4 v[60:63], v16, s[40:43], s65 offen offset:0
buffer_load_dwordx4 v[64:67], v16, s[40:43], s65 offen offset:1024
s_add_u32 m0, s63, 0x0
s_nop 0
buffer_load_dwordx4 v17, s[44:47], s66 offen offset:0 lds
buffer_load_dwordx4 v18, s[44:47], s66 offen offset:1024 lds
buffer_load_dwordx4 v19, s[44:47], s66 offen offset:2048 lds
buffer_load_dwordx4 v20, s[44:47], s66 offen offset:3072 lds
s_add_u32 m0, s63, 0x1000
s_nop 0
buffer_load_dwordx4 v17, s[44:47], s67 offen offset:0 lds
buffer_load_dwordx4 v18, s[44:47], s67 offen offset:1024 lds
buffer_load_dwordx4 v19, s[44:47], s67 offen offset:2048 lds
buffer_load_dwordx4 v20, s[44:47], s67 offen offset:3072 lds
s_mov_b32 s98, 0x7c3ff80
s_load_dwordx2 s[98:99], s[38:39], s98
v_bfe_u32 v5, v2, 2, 3
v_xor_b32 v5, s62, v5
v_and_b32 v6, 3, v2
v_lshlrev_b32 v7, 10, v5
v_lshl_add_u32 v7, v6, 8, v7
v_add_u32 v7, 0xc000, v7
v_and_b32 v5, 1, v5
v_lshl_or_b32 v6, v5, 2, v6
v_lshrrev_b32 v5, 5, v2
s_mul_i32 s6, s60, 12
v_add3_u32 v8, v5, s6, 0
v_lshrrev_b32 v9, 4, v8
v_lshl_add_u32 v9, v9, 13, v7
v_and_b32 v8, 15, v8
v_xor_b32 v8, v8, v6
v_lshl_add_u32 v36, v8, 4, v9
v_add3_u32 v8, v5, s6, 2
v_lshrrev_b32 v9, 4, v8
v_lshl_add_u32 v9, v9, 13, v7
v_and_b32 v8, 15, v8
v_xor_b32 v8, v8, v6
v_lshl_add_u32 v37, v8, 4, v9
v_add3_u32 v8, v5, s6, 4
v_lshrrev_b32 v9, 4, v8
v_lshl_add_u32 v9, v9, 13, v7
v_and_b32 v8, 15, v8
v_xor_b32 v8, v8, v6
v_lshl_add_u32 v38, v8, 4, v9
v_add3_u32 v8, v5, s6, 6
v_lshrrev_b32 v9, 4, v8
v_lshl_add_u32 v9, v9, 13, v7
v_and_b32 v8, 15, v8
v_xor_b32 v8, v8, v6
v_lshl_add_u32 v39, v8, 4, v9
v_add3_u32 v8, v5, s6, 8
v_lshrrev_b32 v9, 4, v8
v_lshl_add_u32 v9, v9, 13, v7
v_and_b32 v8, 15, v8
v_xor_b32 v8, v8, v6
v_lshl_add_u32 v40, v8, 4, v9
v_add3_u32 v8, v5, s6, 10
v_lshrrev_b32 v9, 4, v8
v_lshl_add_u32 v9, v9, 13, v7
v_and_b32 v8, 15, v8
v_xor_b32 v8, v8, v6
v_lshl_add_u32 v41, v8, 4, v9
v_xor_b32 v5, v3, v4
v_lshlrev_b32 v5, 4, v5
v_lshl_add_u32 v5, v4, 8, v5
v_add_u32 v31, 0xc000, v5
v_xor_b32 v32, 64, v31
v_lshrrev_b32 v5, 2, v3
v_and_b32 v6, 3, v3
v_and_b32 v7, 1, v4
v_lshlrev_b32 v7, 2, v7
v_and_b32 v8, 2, v5
v_or_b32 v7, v7, v8
v_lshl_add_u32 v8, v4, 3, v5
v_lshlrev_b32 v8, 7, v8
v_add_u32 v8, s63, v8
v_and_b32 v9, 1, v6
v_lshl_add_u32 v8, v9, 3, v8
v_lshrrev_b32 v6, 1, v6
v_xor_b32 v6, v6, v7
v_xor_b32 v9, 0, v6
v_lshl_add_u32 v25, v9, 4, v8
v_xor_b32 v9, 2, v6
v_lshl_add_u32 v26, v9, 4, v8
v_xor_b32 v9, 4, v6
v_lshl_add_u32 v27, v9, 4, v8
v_xor_b32 v9, 6, v6
v_lshl_add_u32 v28, v9, 4, v8
v_lshrrev_b32 v5, 3, v2
v_and_b32 v6, 7, v2
v_lshrrev_b32 v7, 1, v5
v_xor_b32 v6, v6, v7
v_and_b32 v7, 4, v5
v_add_u32 v5, v5, v7
s_mul_i32 s6, s60, 32768
v_lshl_add_u32 v5, v5, 9, s6
v_lshl_add_u32 v21, v6, 4, v5
v_xor_b32 v6, 4, v6
v_lshl_add_u32 v22, v6, 4, v5
v_add_u32 v22, 0x1c00, v22
v_mov_b32 v23, v21
v_mov_b32 v24, v22
s_lshr_b32 s7, s62, 1
s_xor_b32 s6, s7, 0
s_lshl_b32 s74, s6, 7
s_add_u32 s75, s74, 16384
s_xor_b32 s6, s7, 1
s_lshl_b32 s76, s6, 7
s_add_u32 s77, s76, 16384
s_xor_b32 s6, s7, 2
s_lshl_b32 s78, s6, 7
s_add_u32 s79, s78, 16384
s_xor_b32 s6, s7, 3
s_lshl_b32 s80, s6, 7
s_add_u32 s81, s80, 16384
s_and_b32 s6, s62, 1
s_lshl_b32 s6, s6, 2
v_lshrrev_b32 v5, 1, v3
v_xor_b32 v5, v5, v4
v_xor_b32 v5, s6, v5
v_lshl_add_u32 v6, v3, 7, s63
v_lshl_add_u32 v29, v5, 4, v6
v_xor_b32 v30, 64, v29
s_mul_i32 s6, s60, 2
s_xor_b32 s6, s6, s62
s_lshl_b32 s6, s6, 10
s_add_u32 s6, s6, 0x12000
v_lshrrev_b32 v5, 1, v4
v_and_b32 v6, 1, v4
v_lshl_add_u32 v5, v5, 8, s6
v_lshl_add_u32 v5, v6, 3, v5
v_lshl_add_u32 v33, v3, 4, v5
v_xor_b32 v34, 0x400, v33
v_add_u32 v35, 0x12000, v16
s_mov_b32 s6, s14
s_mul_i32 s7, s60, 2048
s_add_u32 s82, s6, s7
s_add_u32 s83, s82, 8192
s_add_u32 s84, s82, 16384
s_mov_b32 s86, 0x3db8aa3b
s_mov_b32 s87, 0x3db8aa3b
s_mov_b32 s88, 0x3727c5ac
s_mov_b32 s89, 0x3b800000
s_mov_b32 s90, 0xffff0000
s_add_u32 s48, s28, 0x0
s_addc_u32 s49, s29, 0
s_mov_b32 s50, 0x20000
s_mov_b32 s51, 0x00020000
s_add_u32 s52, s38, 0x0
s_addc_u32 s53, s39, 0
s_mov_b32 s54, s15
s_mov_b32 s55, 0x00020000
s_add_u32 s56, s38, 0x6800000
s_addc_u32 s57, s39, 0
s_mov_b32 s58, s15
s_mov_b32 s59, 0x00020000
s_waitcnt vmcnt(13)
v_lshlrev_b32 v116, 16, v44
v_and_b32 v117, s90, v44
v_lshlrev_b32 v118, 16, v45
v_and_b32 v119, s90, v45
v_lshlrev_b32 v120, 16, v46
v_and_b32 v121, s90, v46
v_lshlrev_b32 v122, 16, v47
v_and_b32 v123, s90, v47
v_pk_add_f32 v[164:165], v[116:117], v[118:119]
v_pk_mul_f32 v[166:167], v[116:117], v[116:117]
v_pk_add_f32 v[44:45], v[120:121], v[122:123]
v_pk_fma_f32 v[166:167], v[118:119], v[118:119], v[166:167]
v_pk_add_f32 v[164:165], v[164:165], v[44:45]
v_pk_fma_f32 v[166:167], v[120:121], v[120:121], v[166:167]
v_add_f32 v164, v164, v165
v_pk_fma_f32 v[166:167], v[122:123], v[122:123], v[166:167]
v_add_f32 v166, v166, v167
s_waitcnt vmcnt(12)
v_lshlrev_b32 v124, 16, v48
v_and_b32 v125, s90, v48
v_lshlrev_b32 v126, 16, v49
v_and_b32 v127, s90, v49
v_lshlrev_b32 v128, 16, v50
v_and_b32 v129, s90, v50
v_lshlrev_b32 v130, 16, v51
v_and_b32 v131, s90, v51
v_pk_add_f32 v[168:169], v[124:125], v[126:127]
v_pk_mul_f32 v[170:171], v[124:125], v[124:125]
v_pk_add_f32 v[48:49], v[128:129], v[130:131]
v_pk_fma_f32 v[170:171], v[126:127], v[126:127], v[170:171]
v_pk_add_f32 v[168:169], v[168:169], v[48:49]
v_pk_fma_f32 v[170:171], v[128:129], v[128:129], v[170:171]
v_add_f32 v168, v168, v169
v_pk_fma_f32 v[170:171], v[130:131], v[130:131], v[170:171]
v_add_f32 v170, v170, v171
s_waitcnt vmcnt(11)
v_lshlrev_b32 v132, 16, v52
v_and_b32 v133, s90, v52
v_lshlrev_b32 v134, 16, v53
v_and_b32 v135, s90, v53
v_lshlrev_b32 v136, 16, v54
v_and_b32 v137, s90, v54
v_lshlrev_b32 v138, 16, v55
v_and_b32 v139, s90, v55
v_pk_add_f32 v[172:173], v[132:133], v[134:135]
v_pk_mul_f32 v[174:175], v[132:133], v[132:133]
v_pk_add_f32 v[52:53], v[136:137], v[138:139]
v_pk_fma_f32 v[174:175], v[134:135], v[134:135], v[174:175]
v_pk_add_f32 v[172:173], v[172:173], v[52:53]
v_pk_fma_f32 v[174:175], v[136:137], v[136:137], v[174:175]
v_add_f32 v172, v172, v173
v_pk_fma_f32 v[174:175], v[138:139], v[138:139], v[174:175]
v_add_f32 v174, v174, v175
s_waitcnt vmcnt(10)
v_lshlrev_b32 v140, 16, v56
v_and_b32 v141, s90, v56
v_lshlrev_b32 v142, 16, v57
v_and_b32 v143, s90, v57
v_lshlrev_b32 v144, 16, v58
v_and_b32 v145, s90, v58
v_lshlrev_b32 v146, 16, v59
v_and_b32 v147, s90, v59
v_pk_add_f32 v[176:177], v[140:141], v[142:143]
v_pk_mul_f32 v[178:179], v[140:141], v[140:141]
v_pk_add_f32 v[56:57], v[144:145], v[146:147]
v_pk_fma_f32 v[178:179], v[142:143], v[142:143], v[178:179]
v_pk_add_f32 v[176:177], v[176:177], v[56:57]
v_pk_fma_f32 v[178:179], v[144:145], v[144:145], v[178:179]
v_add_f32 v176, v176, v177
v_pk_fma_f32 v[178:179], v[146:147], v[146:147], v[178:179]
v_add_f32 v178, v178, v179
s_waitcnt vmcnt(9)
v_lshlrev_b32 v148, 16, v60
v_and_b32 v149, s90, v60
v_lshlrev_b32 v150, 16, v61
v_and_b32 v151, s90, v61
v_lshlrev_b32 v152, 16, v62
v_and_b32 v153, s90, v62
v_lshlrev_b32 v154, 16, v63
v_and_b32 v155, s90, v63
v_pk_add_f32 v[180:181], v[148:149], v[150:151]
v_pk_mul_f32 v[182:183], v[148:149], v[148:149]
v_pk_add_f32 v[60:61], v[152:153], v[154:155]
v_pk_fma_f32 v[182:183], v[150:151], v[150:151], v[182:183]
v_pk_add_f32 v[180:181], v[180:181], v[60:61]
v_pk_fma_f32 v[182:183], v[152:153], v[152:153], v[182:183]
v_add_f32 v180, v180, v181
v_pk_fma_f32 v[182:183], v[154:155], v[154:155], v[182:183]
v_add_f32 v182, v182, v183
s_waitcnt vmcnt(8)
v_lshlrev_b32 v156, 16, v64
v_and_b32 v157, s90, v64
v_lshlrev_b32 v158, 16, v65
v_and_b32 v159, s90, v65
v_lshlrev_b32 v160, 16, v66
v_and_b32 v161, s90, v66
v_lshlrev_b32 v162, 16, v67
v_and_b32 v163, s90, v67
v_pk_add_f32 v[184:185], v[156:157], v[158:159]
v_pk_mul_f32 v[186:187], v[156:157], v[156:157]
v_pk_add_f32 v[64:65], v[160:161], v[162:163]
v_pk_fma_f32 v[186:187], v[158:159], v[158:159], v[186:187]
v_pk_add_f32 v[184:185], v[184:185], v[64:65]
v_pk_fma_f32 v[186:187], v[160:161], v[160:161], v[186:187]
v_add_f32 v184, v184, v185
v_pk_fma_f32 v[186:187], v[162:163], v[162:163], v[186:187]
v_add_f32 v186, v186, v187
v_permlane16_swap_b32 v164, v166
v_permlane16_swap_b32 v168, v170
v_permlane16_swap_b32 v172, v174
v_permlane16_swap_b32 v176, v178
v_permlane16_swap_b32 v180, v182
v_permlane16_swap_b32 v184, v186
v_add_f32 v164, v164, v166
v_add_f32 v168, v168, v170
v_add_f32 v172, v172, v174
v_add_f32 v176, v176, v178
v_add_f32 v180, v180, v182
v_add_f32 v184, v184, v186
v_add_f32_dpp v165, v164, v164 row_ror:8 row_mask:0xf bank_mask:0x3
v_add_f32_dpp v165, v168, v168 row_ror:8 row_mask:0xf bank_mask:0xc
v_add_f32_dpp v173, v172, v172 row_ror:8 row_mask:0xf bank_mask:0x3
v_add_f32_dpp v173, v176, v176 row_ror:8 row_mask:0xf bank_mask:0xc
v_add_f32_dpp v181, v180, v180 row_ror:8 row_mask:0xf bank_mask:0x3
v_add_f32_dpp v181, v184, v184 row_ror:8 row_mask:0xf bank_mask:0xc
v_add_f32_dpp v166, v165, v165 row_half_mirror row_mask:0xf bank_mask:0x5
v_add_f32_dpp v166, v173, v173 row_half_mirror row_mask:0xf bank_mask:0xa
v_add_f32_dpp v182, v181, v181 row_half_mirror row_mask:0xf bank_mask:0xf
s_nop 0
v_add_f32_dpp v166, v166, v166 quad_perm:[1,0,3,2] row_mask:0xf bank_mask:0xf
v_add_f32_dpp v182, v182, v182 quad_perm:[1,0,3,2] row_mask:0xf bank_mask:0xf
s_nop 0
v_add_f32_dpp v166, v166, v166 quad_perm:[2,3,0,1] row_mask:0xf bank_mask:0xf
v_add_f32_dpp v182, v182, v182 quad_perm:[2,3,0,1] row_mask:0xf bank_mask:0xf
v_mov_b32 v167, v166
v_mov_b32 v183, v182
s_nop 0
v_permlane16_swap_b32 v167, v166
v_permlane16_swap_b32 v183, v182
v_mul_f32 v167, s89, v167
v_mul_f32 v183, s89, v183
v_mul_f32 v166, s89, v166
v_mul_f32 v182, s89, v182
v_fma_f32 v166, -v167, v167, v166
v_fma_f32 v182, -v183, v183, v182
v_max_f32 v166, 0, v166
v_max_f32 v182, 0, v182
v_cvt_pk_bf16_f32 v166, v166, v166
v_cvt_pk_bf16_f32 v182, v182, v182
v_and_b32 v166, s90, v166
v_and_b32 v182, s90, v182
v_add_f32 v166, s88, v166
v_add_f32 v182, s88, v182
v_cvt_pk_bf16_f32 v166, v166, v166
v_cvt_pk_bf16_f32 v182, v182, v182
v_and_b32 v166, s90, v166
v_and_b32 v182, s90, v182
v_sqrt_f32 v166, v166
v_sqrt_f32 v182, v182
s_nop 0
s_nop 0
v_cvt_pk_bf16_f32 v166, v166, v166
v_cvt_pk_bf16_f32 v182, v182, v182
v_and_b32 v166, s90, v166
v_and_b32 v182, s90, v182
v_rcp_f32 v166, v166
v_rcp_f32 v182, v182
v_mul_f32 v167, -v167, v166
v_mul_f32 v183, -v183, v182
s_nop 0
v_mov_b64_dpp v[164:165], v[166:167] row_newbcast:0 row_mask:0xf bank_mask:0xf
v_mov_b64_dpp v[168:169], v[166:167] row_newbcast:8 row_mask:0xf bank_mask:0xf
v_mov_b64_dpp v[172:173], v[166:167] row_newbcast:4 row_mask:0xf bank_mask:0xf
v_mov_b64_dpp v[176:177], v[166:167] row_newbcast:12 row_mask:0xf bank_mask:0xf
v_mov_b64_dpp v[180:181], v[182:183] row_newbcast:0 row_mask:0xf bank_mask:0xf
v_mov_b64_dpp v[184:185], v[182:183] row_newbcast:8 row_mask:0xf bank_mask:0xf
v_fma_f32 v116, v116, v164, v165
v_fma_f32 v117, v117, v164, v165
v_fma_f32 v118, v118, v164, v165
v_fma_f32 v119, v119, v164, v165
v_fma_f32 v120, v120, v164, v165
v_fma_f32 v121, v121, v164, v165
v_fma_f32 v122, v122, v164, v165
v_fma_f32 v123, v123, v164, v165
v_cvt_pk_bf16_f32 v44, v116, v117
v_cvt_pk_bf16_f32 v45, v118, v119
v_cvt_pk_bf16_f32 v46, v120, v121
v_cvt_pk_bf16_f32 v47, v122, v123
ds_write_b128 v36, v[44:47]
v_fma_f32 v124, v124, v168, v169
v_fma_f32 v125, v125, v168, v169
v_fma_f32 v126, v126, v168, v169
v_fma_f32 v127, v127, v168, v169
v_fma_f32 v128, v128, v168, v169
v_fma_f32 v129, v129, v168, v169
v_fma_f32 v130, v130, v168, v169
v_fma_f32 v131, v131, v168, v169
v_cvt_pk_bf16_f32 v48, v124, v125
v_cvt_pk_bf16_f32 v49, v126, v127
v_cvt_pk_bf16_f32 v50, v128, v129
v_cvt_pk_bf16_f32 v51, v130, v131
ds_write_b128 v37, v[48:51]
v_fma_f32 v132, v132, v172, v173
v_fma_f32 v133, v133, v172, v173
v_fma_f32 v134, v134, v172, v173
v_fma_f32 v135, v135, v172, v173
v_fma_f32 v136, v136, v172, v173
v_fma_f32 v137, v137, v172, v173
v_fma_f32 v138, v138, v172, v173
v_fma_f32 v139, v139, v172, v173
v_cvt_pk_bf16_f32 v52, v132, v133
v_cvt_pk_bf16_f32 v53, v134, v135
v_cvt_pk_bf16_f32 v54, v136, v137
v_cvt_pk_bf16_f32 v55, v138, v139
ds_write_b128 v38, v[52:55]
v_fma_f32 v140, v140, v176, v177
v_fma_f32 v141, v141, v176, v177
v_fma_f32 v142, v142, v176, v177
v_fma_f32 v143, v143, v176, v177
v_fma_f32 v144, v144, v176, v177
v_fma_f32 v145, v145, v176, v177
v_fma_f32 v146, v146, v176, v177
v_fma_f32 v147, v147, v176, v177
v_cvt_pk_bf16_f32 v56, v140, v141
v_cvt_pk_bf16_f32 v57, v142, v143
v_cvt_pk_bf16_f32 v58, v144, v145
v_cvt_pk_bf16_f32 v59, v146, v147
ds_write_b128 v39, v[56:59]
v_fma_f32 v148, v148, v180, v181
v_fma_f32 v149, v149, v180, v181
v_fma_f32 v150, v150, v180, v181
v_fma_f32 v151, v151, v180, v181
v_fma_f32 v152, v152, v180, v181
v_fma_f32 v153, v153, v180, v181
v_fma_f32 v154, v154, v180, v181
v_fma_f32 v155, v155, v180, v181
v_cvt_pk_bf16_f32 v60, v148, v149
v_cvt_pk_bf16_f32 v61, v150, v151
v_cvt_pk_bf16_f32 v62, v152, v153
v_cvt_pk_bf16_f32 v63, v154, v155
ds_write_b128 v40, v[60:63]
v_fma_f32 v156, v156, v184, v185
v_fma_f32 v157, v157, v184, v185
v_fma_f32 v158, v158, v184, v185
v_fma_f32 v159, v159, v184, v185
v_fma_f32 v160, v160, v184, v185
v_fma_f32 v161, v161, v184, v185
v_fma_f32 v162, v162, v184, v185
v_fma_f32 v163, v163, v184, v185
v_cvt_pk_bf16_f32 v64, v156, v157
v_cvt_pk_bf16_f32 v65, v158, v159
v_cvt_pk_bf16_f32 v66, v160, v161
v_cvt_pk_bf16_f32 v67, v162, v163
ds_write_b128 v41, v[64:67]
s_add_u32 m0, s63, 0x2000
s_nop 0
buffer_load_dwordx4 v17, s[44:47], s68 offen offset:0 lds
buffer_load_dwordx4 v18, s[44:47], s68 offen offset:1024 lds
buffer_load_dwordx4 v19, s[44:47], s68 offen offset:2048 lds
buffer_load_dwordx4 v20, s[44:47], s68 offen offset:3072 lds
s_add_u32 s40, s28, 0x1fe00
s_addc_u32 s41, s29, 0
s_mov_b32 s42, 0x200
s_mov_b32 s43, 0x00020000
v_lshlrev_b32 v5, 4, v4
s_lshr_b32 s6, s66, 8
buffer_load_dwordx4 a[0:3], v5, s[40:43], s6 offen
s_lshr_b32 s6, s67, 8
buffer_load_dwordx4 a[4:7], v5, s[40:43], s6 offen
s_lshr_b32 s6, s68, 8
buffer_load_dwordx4 a[8:11], v5, s[40:43], s6 offen
s_lshr_b32 s6, s69, 8
buffer_load_dwordx4 a[12:15], v5, s[40:43], s6 offen
s_lshr_b32 s6, s70, 8
buffer_load_dwordx4 a[16:19], v5, s[40:43], s6 offen
s_lshr_b32 s6, s71, 8
buffer_load_dwordx4 a[20:23], v5, s[40:43], s6 offen
s_lshr_b32 s6, s72, 8
buffer_load_dwordx4 a[24:27], v5, s[40:43], s6 offen
s_lshr_b32 s6, s73, 8
buffer_load_dwordx4 a[28:31], v5, s[40:43], s6 offen
v_and_b32 v5, 31, v2
v_cmp_eq_u32 vcc, 31, v5
v_mov_b32 v6, 0xffff
v_mov_b32 v7, 0x3f800000
v_cndmask_b32 v6, -1, v6, vcc
v_cndmask_b32 v7, 0, v7, vcc
s_waitcnt vmcnt(16)
ds_read_b64_tr_b16 v[164:165], v25 offset:0
ds_read_b64_tr_b16 v[166:167], v25 offset:512
ds_read_b64_tr_b16 v[168:169], v26 offset:0
ds_read_b64_tr_b16 v[170:171], v26 offset:512
ds_read_b64_tr_b16 v[172:173], v27 offset:0
ds_read_b64_tr_b16 v[174:175], v27 offset:512
s_waitcnt lgkmcnt(6)
s_barrier
ds_read_b128 v[204:207], v31 offset:0
ds_read_b128 v[208:211], v31 offset:8192
ds_read_b128 v[212:215], v31 offset:16384
s_waitcnt lgkmcnt(2)
v_mfma_f32_16x16x32_bf16 v[68:71], v[164:167], v[204:207], 0
s_waitcnt lgkmcnt(1)
v_mfma_f32_16x16x32_bf16 v[72:75], v[164:167], v[208:211], 0
s_waitcnt lgkmcnt(0)
v_mfma_f32_16x16x32_bf16 v[76:79], v[164:167], v[212:215], 0
ds_read_b64_tr_b16 v[176:177], v28 offset:0
ds_read_b64_tr_b16 v[178:179], v28 offset:512
v_mfma_f32_16x16x32_bf16 v[80:83], v[168:171], v[204:207], 0
v_mfma_f32_16x16x32_bf16 v[84:87], v[168:171], v[208:211], 0
v_mfma_f32_16x16x32_bf16 v[88:91], v[168:171], v[212:215], 0
ds_read_b128 v[216:219], v32 offset:1024
s_waitcnt vmcnt(12)
ds_read_b64_tr_b16 v[180:181], v25 offset:4096
ds_read_b64_tr_b16 v[182:183], v25 offset:4608
v_mfma_f32_16x16x32_bf16 v[92:95], v[172:175], v[204:207], 0
ds_read_b128 v[220:223], v32 offset:9216
v_mfma_f32_16x16x32_bf16 v[96:99], v[172:175], v[208:211], 0
ds_read_b128 v[224:227], v32 offset:17408
v_mfma_f32_16x16x32_bf16 v[100:103], v[172:175], v[212:215], 0
ds_read_b64_tr_b16 v[184:185], v26 offset:4096
ds_read_b64_tr_b16 v[186:187], v26 offset:4608
s_waitcnt lgkmcnt(7)
v_mfma_f32_16x16x32_bf16 v[104:107], v[176:179], v[204:207], 0
s_add_u32 m0, s63, 0x0
s_nop 0
buffer_load_dwordx4 v17, s[44:47], s69 offen offset:0 lds
buffer_load_dwordx4 v18, s[44:47], s69 offen offset:1024 lds
buffer_load_dwordx4 v19, s[44:47], s69 offen offset:2048 lds
buffer_load_dwordx4 v20, s[44:47], s69 offen offset:3072 lds
v_mfma_f32_16x16x32_bf16 v[108:111], v[176:179], v[208:211], 0
v_mfma_f32_16x16x32_bf16 v[112:115], v[176:179], v[212:215], 0
ds_read_b64_tr_b16 v[188:189], v27 offset:4096
ds_read_b64_tr_b16 v[190:191], v27 offset:4608
s_waitcnt lgkmcnt(6)
v_mfma_f32_16x16x32_bf16 v[68:71], v[180:183], v[216:219], v[68:71]
s_waitcnt lgkmcnt(5)
v_mfma_f32_16x16x32_bf16 v[72:75], v[180:183], v[220:223], v[72:75]
s_waitcnt lgkmcnt(4)
v_mfma_f32_16x16x32_bf16 v[76:79], v[180:183], v[224:227], v[76:79]
ds_read_b64_tr_b16 v[192:193], v28 offset:4096
ds_read_b64_tr_b16 v[194:195], v28 offset:4608
s_waitcnt lgkmcnt(4)
v_mfma_f32_16x16x32_bf16 v[80:83], v[184:187], v[216:219], v[80:83]
v_mfma_f32_16x16x32_bf16 v[84:87], v[184:187], v[220:223], v[84:87]
v_mfma_f32_16x16x32_bf16 v[88:91], v[184:187], v[224:227], v[88:91]
ds_read_b128 v[228:231], v31 offset:2048
s_waitcnt vmcnt(12)
ds_read_b64_tr_b16 v[196:197], v25 offset:8192
ds_read_b64_tr_b16 v[198:199], v25 offset:8704
s_waitcnt lgkmcnt(5)
v_mfma_f32_16x16x32_bf16 v[92:95], v[188:191], v[216:219], v[92:95]
ds_read_b128 v[232:235], v31 offset:10240
v_mfma_f32_16x16x32_bf16 v[96:99], v[188:191], v[220:223], v[96:99]
ds_read_b128 v[236:239], v31 offset:18432
v_mfma_f32_16x16x32_bf16 v[100:103], v[188:191], v[224:227], v[100:103]
ds_read_b64_tr_b16 v[200:201], v26 offset:8192
ds_read_b64_tr_b16 v[202:203], v26 offset:8704
s_waitcnt lgkmcnt(7)
v_mfma_f32_16x16x32_bf16 v[104:107], v[192:195], v[216:219], v[104:107]
s_add_u32 m0, s63, 0x1000
s_nop 0
buffer_load_dwordx4 v17, s[44:47], s70 offen offset:0 lds
buffer_load_dwordx4 v18, s[44:47], s70 offen offset:1024 lds
buffer_load_dwordx4 v19, s[44:47], s70 offen offset:2048 lds
buffer_load_dwordx4 v20, s[44:47], s70 offen offset:3072 lds
v_mfma_f32_16x16x32_bf16 v[108:111], v[192:195], v[220:223], v[108:111]
v_mfma_f32_16x16x32_bf16 v[112:115], v[192:195], v[224:227], v[112:115]
ds_read_b64_tr_b16 v[164:165], v27 offset:8192
ds_read_b64_tr_b16 v[166:167], v27 offset:8704
s_waitcnt lgkmcnt(6)
v_mfma_f32_16x16x32_bf16 v[68:71], v[196:199], v[228:231], v[68:71]
s_waitcnt lgkmcnt(5)
v_mfma_f32_16x16x32_bf16 v[72:75], v[196:199], v[232:235], v[72:75]
s_waitcnt lgkmcnt(4)
v_mfma_f32_16x16x32_bf16 v[76:79], v[196:199], v[236:239], v[76:79]
ds_read_b64_tr_b16 v[168:169], v28 offset:8192
ds_read_b64_tr_b16 v[170:171], v28 offset:8704
s_waitcnt lgkmcnt(4)
v_mfma_f32_16x16x32_bf16 v[80:83], v[200:203], v[228:231], v[80:83]
v_mfma_f32_16x16x32_bf16 v[84:87], v[200:203], v[232:235], v[84:87]
v_mfma_f32_16x16x32_bf16 v[88:91], v[200:203], v[236:239], v[88:91]
ds_read_b128 v[204:207], v32 offset:3072
s_waitcnt vmcnt(4)
ds_read_b64_tr_b16 v[172:173], v25 offset:0
ds_read_b64_tr_b16 v[174:175], v25 offset:512
s_waitcnt lgkmcnt(5)
v_mfma_f32_16x16x32_bf16 v[92:95], v[164:167], v[228:231], v[92:95]
ds_read_b128 v[208:211], v32 offset:11264
v_mfma_f32_16x16x32_bf16 v[96:99], v[164:167], v[232:235], v[96:99]
ds_read_b128 v[212:215], v32 offset:19456
v_mfma_f32_16x16x32_bf16 v[100:103], v[164:167], v[236:239], v[100:103]
ds_read_b64_tr_b16 v[176:177], v26 offset:0
ds_read_b64_tr_b16 v[178:179], v26 offset:512
s_waitcnt lgkmcnt(7)
v_mfma_f32_16x16x32_bf16 v[104:107], v[168:171], v[228:231], v[104:107]
s_add_u32 m0, s63, 0x2000
s_nop 0
buffer_load_dwordx4 v17, s[44:47], s71 offen offset:0 lds
buffer_load_dwordx4 v18, s[44:47], s71 offen offset:1024 lds
buffer_load_dwordx4 v19, s[44:47], s71 offen offset:2048 lds
buffer_load_dwordx4 v20, s[44:47], s71 offen offset:3072 lds
v_mfma_f32_16x16x32_bf16 v[108:111], v[168:171], v[232:235], v[108:111]
v_mfma_f32_16x16x32_bf16 v[112:115], v[168:171], v[236:239], v[112:115]
ds_read_b64_tr_b16 v[180:181], v27 offset:0
ds_read_b64_tr_b16 v[182:183], v27 offset:512
s_waitcnt lgkmcnt(6)
v_mfma_f32_16x16x32_bf16 v[68:71], v[172:175], v[204:207], v[68:71]
s_waitcnt lgkmcnt(5)
v_mfma_f32_16x16x32_bf16 v[72:75], v[172:175], v[208:211], v[72:75]
s_waitcnt lgkmcnt(4)
v_mfma_f32_16x16x32_bf16 v[76:79], v[172:175], v[212:215], v[76:79]
ds_read_b64_tr_b16 v[184:185], v28 offset:0
ds_read_b64_tr_b16 v[186:187], v28 offset:512
s_waitcnt lgkmcnt(4)
v_mfma_f32_16x16x32_bf16 v[80:83], v[176:179], v[204:207], v[80:83]
v_mfma_f32_16x16x32_bf16 v[84:87], v[176:179], v[208:211], v[84:87]
v_mfma_f32_16x16x32_bf16 v[88:91], v[176:179], v[212:215], v[88:91]
ds_read_b128 v[216:219], v31 offset:4096
s_waitcnt vmcnt(4)
ds_read_b64_tr_b16 v[188:189], v25 offset:4096
ds_read_b64_tr_b16 v[190:191], v25 offset:4608
s_waitcnt lgkmcnt(5)
v_mfma_f32_16x16x32_bf16 v[92:95], v[180:183], v[204:207], v[92:95]
ds_read_b128 v[220:223], v31 offset:12288
v_mfma_f32_16x16x32_bf16 v[96:99], v[180:183], v[208:211], v[96:99]
ds_read_b128 v[224:227], v31 offset:20480
v_mfma_f32_16x16x32_bf16 v[100:103], v[180:183], v[212:215], v[100:103]
ds_read_b64_tr_b16 v[192:193], v26 offset:4096
ds_read_b64_tr_b16 v[194:195], v26 offset:4608
s_waitcnt lgkmcnt(7)
v_mfma_f32_16x16x32_bf16 v[104:107], v[184:187], v[204:207], v[104:107]
s_add_u32 m0, s63, 0x0
s_nop 0
buffer_load_dwordx4 v17, s[44:47], s72 offen offset:0 lds
buffer_load_dwordx4 v18, s[44:47], s72 offen offset:1024 lds
buffer_load_dwordx4 v19, s[44:47], s72 offen offset:2048 lds
buffer_load_dwordx4 v20, s[44:47], s72 offen offset:3072 lds
v_mfma_f32_16x16x32_bf16 v[108:111], v[184:187], v[208:211], v[108:111]
v_mfma_f32_16x16x32_bf16 v[112:115], v[184:187], v[212:215], v[112:115]
ds_read_b64_tr_b16 v[196:197], v27 offset:4096
ds_read_b64_tr_b16 v[198:199], v27 offset:4608
s_waitcnt lgkmcnt(6)
v_mfma_f32_16x16x32_bf16 v[68:71], v[188:191], v[216:219], v[68:71]
s_waitcnt lgkmcnt(5)
v_mfma_f32_16x16x32_bf16 v[72:75], v[188:191], v[220:223], v[72:75]
s_waitcnt lgkmcnt(4)
v_mfma_f32_16x16x32_bf16 v[76:79], v[188:191], v[224:227], v[76:79]
ds_read_b64_tr_b16 v[200:201], v28 offset:4096
ds_read_b64_tr_b16 v[202:203], v28 offset:4608
s_waitcnt lgkmcnt(4)
v_mfma_f32_16x16x32_bf16 v[80:83], v[192:195], v[216:219], v[80:83]
v_mfma_f32_16x16x32_bf16 v[84:87], v[192:195], v[220:223], v[84:87]
v_mfma_f32_16x16x32_bf16 v[88:91], v[192:195], v[224:227], v[88:91]
ds_read_b128 v[228:231], v32 offset:5120
s_waitcnt vmcnt(4)
ds_read_b64_tr_b16 v[164:165], v25 offset:8192
ds_read_b64_tr_b16 v[166:167], v25 offset:8704
s_waitcnt lgkmcnt(5)
v_mfma_f32_16x16x32_bf16 v[92:95], v[196:199], v[216:219], v[92:95]
ds_read_b128 v[232:235], v32 offset:13312
v_mfma_f32_16x16x32_bf16 v[96:99], v[196:199], v[220:223], v[96:99]
ds_read_b128 v[236:239], v32 offset:21504
v_mfma_f32_16x16x32_bf16 v[100:103], v[196:199], v[224:227], v[100:103]
ds_read_b64_tr_b16 v[168:169], v26 offset:8192
ds_read_b64_tr_b16 v[170:171], v26 offset:8704
s_waitcnt lgkmcnt(7)
v_mfma_f32_16x16x32_bf16 v[104:107], v[200:203], v[216:219], v[104:107]
s_add_u32 m0, s63, 0x1000
s_nop 0
buffer_load_dwordx4 v17, s[44:47], s73 offen offset:0 lds
buffer_load_dwordx4 v18, s[44:47], s73 offen offset:1024 lds
buffer_load_dwordx4 v19, s[44:47], s73 offen offset:2048 lds
buffer_load_dwordx4 v20, s[44:47], s73 offen offset:3072 lds
v_mfma_f32_16x16x32_bf16 v[108:111], v[200:203], v[220:223], v[108:111]
v_mfma_f32_16x16x32_bf16 v[112:115], v[200:203], v[224:227], v[112:115]
ds_read_b64_tr_b16 v[172:173], v27 offset:8192
ds_read_b64_tr_b16 v[174:175], v27 offset:8704
s_waitcnt lgkmcnt(6)
v_mfma_f32_16x16x32_bf16 v[68:71], v[164:167], v[228:231], v[68:71]
s_waitcnt lgkmcnt(5)
v_mfma_f32_16x16x32_bf16 v[72:75], v[164:167], v[232:235], v[72:75]
s_waitcnt lgkmcnt(4)
v_mfma_f32_16x16x32_bf16 v[76:79], v[164:167], v[236:239], v[76:79]
ds_read_b64_tr_b16 v[176:177], v28 offset:8192
ds_read_b64_tr_b16 v[178:179], v28 offset:8704
s_waitcnt lgkmcnt(4)
v_mfma_f32_16x16x32_bf16 v[80:83], v[168:171], v[228:231], v[80:83]
v_mfma_f32_16x16x32_bf16 v[84:87], v[168:171], v[232:235], v[84:87]
v_mfma_f32_16x16x32_bf16 v[88:91], v[168:171], v[236:239], v[88:91]
ds_read_b128 v[204:207], v31 offset:6144
s_waitcnt vmcnt(4)
ds_read_b64_tr_b16 v[180:181], v25 offset:0
ds_read_b64_tr_b16 v[182:183], v25 offset:512
s_waitcnt lgkmcnt(5)
v_mfma_f32_16x16x32_bf16 v[92:95], v[172:175], v[228:231], v[92:95]
ds_read_b128 v[208:211], v31 offset:14336
v_mfma_f32_16x16x32_bf16 v[96:99], v[172:175], v[232:235], v[96:99]
ds_read_b128 v[212:215], v31 offset:22528
v_mfma_f32_16x16x32_bf16 v[100:103], v[172:175], v[236:239], v[100:103]
ds_read_b64_tr_b16 v[184:185], v26 offset:0
ds_read_b64_tr_b16 v[186:187], v26 offset:512
s_waitcnt lgkmcnt(7)
v_mfma_f32_16x16x32_bf16 v[104:107], v[176:179], v[228:231], v[104:107]
s_add_u32 m0, s63, 0x2000
s_nop 0
buffer_load_dwordx4 v21, s[48:51], s74 offen offset:0 lds
buffer_load_dwordx4 v22, s[48:51], s74 offen offset:1024 lds
buffer_load_dwordx4 v23, s[48:51], s74 offen offset:2048 lds
buffer_load_dwordx4 v24, s[48:51], s74 offen offset:3072 lds
v_mfma_f32_16x16x32_bf16 v[108:111], v[176:179], v[232:235], v[108:111]
v_mfma_f32_16x16x32_bf16 v[112:115], v[176:179], v[236:239], v[112:115]
ds_read_b64_tr_b16 v[188:189], v27 offset:0
ds_read_b64_tr_b16 v[190:191], v27 offset:512
s_waitcnt lgkmcnt(6)
v_mfma_f32_16x16x32_bf16 v[68:71], v[180:183], v[204:207], v[68:71]
s_waitcnt lgkmcnt(5)
v_mfma_f32_16x16x32_bf16 v[72:75], v[180:183], v[208:211], v[72:75]
s_waitcnt lgkmcnt(4)
v_mfma_f32_16x16x32_bf16 v[76:79], v[180:183], v[212:215], v[76:79]
ds_read_b64_tr_b16 v[192:193], v28 offset:0
ds_read_b64_tr_b16 v[194:195], v28 offset:512
s_waitcnt lgkmcnt(4)
v_mfma_f32_16x16x32_bf16 v[80:83], v[184:187], v[204:207], v[80:83]
v_mfma_f32_16x16x32_bf16 v[84:87], v[184:187], v[208:211], v[84:87]
v_mfma_f32_16x16x32_bf16 v[88:91], v[184:187], v[212:215], v[88:91]
ds_read_b128 v[216:219], v32 offset:7168
s_waitcnt vmcnt(4)
ds_read_b64_tr_b16 v[196:197], v25 offset:4096
ds_read_b64_tr_b16 v[198:199], v25 offset:4608
s_waitcnt lgkmcnt(5)
v_mfma_f32_16x16x32_bf16 v[92:95], v[188:191], v[204:207], v[92:95]
ds_read_b128 v[220:223], v32 offset:15360
v_mfma_f32_16x16x32_bf16 v[96:99], v[188:191], v[208:211], v[96:99]
ds_read_b128 v[224:227], v32 offset:23552
v_mfma_f32_16x16x32_bf16 v[100:103], v[188:191], v[212:215], v[100:103]
ds_read_b64_tr_b16 v[200:201], v26 offset:4096
ds_read_b64_tr_b16 v[202:203], v26 offset:4608
s_waitcnt lgkmcnt(7)
v_mfma_f32_16x16x32_bf16 v[104:107], v[192:195], v[204:207], v[104:107]
s_add_u32 m0, s63, 0x0
s_nop 0
buffer_load_dwordx4 v21, s[48:51], s75 offen offset:0 lds
buffer_load_dwordx4 v22, s[48:51], s75 offen offset:1024 lds
buffer_load_dwordx4 v23, s[48:51], s75 offen offset:2048 lds
buffer_load_dwordx4 v24, s[48:51], s75 offen offset:3072 lds
v_mfma_f32_16x16x32_bf16 v[108:111], v[192:195], v[208:211], v[108:111]
v_mfma_f32_16x16x32_bf16 v[112:115], v[192:195], v[212:215], v[112:115]
ds_read_b64_tr_b16 v[164:165], v27 offset:4096
ds_read_b64_tr_b16 v[166:167], v27 offset:4608
s_waitcnt lgkmcnt(6)
v_mfma_f32_16x16x32_bf16 v[68:71], v[196:199], v[216:219], v[68:71]
s_waitcnt lgkmcnt(5)
v_mfma_f32_16x16x32_bf16 v[72:75], v[196:199], v[220:223], v[72:75]
s_waitcnt lgkmcnt(4)
v_mfma_f32_16x16x32_bf16 v[76:79], v[196:199], v[224:227], v[76:79]
ds_read_b64_tr_b16 v[168:169], v28 offset:4096
ds_read_b64_tr_b16 v[170:171], v28 offset:4608
s_waitcnt lgkmcnt(4)
v_mfma_f32_16x16x32_bf16 v[80:83], v[200:203], v[216:219], v[80:83]
v_cvt_pk_bf16_f32 v68, v68, v69
v_cvt_pk_bf16_f32 v69, v70, v71
ds_write_b64 v33, v[68:69] offset:0
v_mfma_f32_16x16x32_bf16 v[84:87], v[200:203], v[220:223], v[84:87]
v_cvt_pk_bf16_f32 v72, v72, v73
v_cvt_pk_bf16_f32 v73, v74, v75
ds_write_b64 v33, v[72:73] offset:8192
v_mfma_f32_16x16x32_bf16 v[88:91], v[200:203], v[224:227], v[88:91]
v_cvt_pk_bf16_f32 v76, v76, v77
v_cvt_pk_bf16_f32 v77, v78, v79
ds_write_b64 v33, v[76:77] offset:16384
s_waitcnt lgkmcnt(5)
v_mfma_f32_16x16x32_bf16 v[92:95], v[164:167], v[216:219], v[92:95]
v_cvt_pk_bf16_f32 v80, v80, v81
v_cvt_pk_bf16_f32 v81, v82, v83
ds_write_b64 v33, v[80:81] offset:512
v_mfma_f32_16x16x32_bf16 v[96:99], v[164:167], v[220:223], v[96:99]
v_cvt_pk_bf16_f32 v84, v84, v85
v_cvt_pk_bf16_f32 v85, v86, v87
ds_write_b64 v33, v[84:85] offset:8704
v_mfma_f32_16x16x32_bf16 v[100:103], v[164:167], v[224:227], v[100:103]
v_cvt_pk_bf16_f32 v88, v88, v89
v_cvt_pk_bf16_f32 v89, v90, v91
ds_write_b64 v33, v[88:89] offset:16896
s_waitcnt lgkmcnt(6)
v_mfma_f32_16x16x32_bf16 v[104:107], v[168:171], v[216:219], v[104:107]
v_cvt_pk_bf16_f32 v92, v92, v93
v_cvt_pk_bf16_f32 v93, v94, v95
ds_write_b64 v34, v[92:93] offset:0
s_add_u32 m0, s63, 0x1000
s_nop 0
buffer_load_dwordx4 v21, s[48:51], s76 offen offset:0 lds
buffer_load_dwordx4 v22, s[48:51], s76 offen offset:1024 lds
buffer_load_dwordx4 v23, s[48:51], s76 offen offset:2048 lds
buffer_load_dwordx4 v24, s[48:51], s76 offen offset:3072 lds
v_mfma_f32_16x16x32_bf16 v[108:111], v[168:171], v[220:223], v[108:111]
v_cvt_pk_bf16_f32 v96, v96, v97
v_cvt_pk_bf16_f32 v97, v98, v99
ds_write_b64 v34, v[96:97] offset:8192
v_mfma_f32_16x16x32_bf16 v[112:115], v[168:171], v[224:227], v[112:115]
v_cvt_pk_bf16_f32 v100, v100, v101
v_cvt_pk_bf16_f32 v101, v102, v103
ds_write_b64 v34, v[100:101] offset:16384
v_cvt_pk_bf16_f32 v104, v104, v105
v_cvt_pk_bf16_f32 v105, v106, v107
ds_write_b64 v34, v[104:105] offset:512
v_cvt_pk_bf16_f32 v108, v108, v109
v_cvt_pk_bf16_f32 v109, v110, v111
ds_write_b64 v34, v[108:109] offset:8704
v_cvt_pk_bf16_f32 v112, v112, v113
v_cvt_pk_bf16_f32 v113, v114, v115
ds_write_b64 v34, v[112:113] offset:16896
s_waitcnt vmcnt(8)
ds_read_b128 v[172:175], v29 offset:8192
ds_read_b128 v[176:179], v30 offset:8192
s_waitcnt lgkmcnt(2)
s_barrier
ds_read_b128 v[228:231], v35 offset:0
ds_read_b128 v[232:235], v35 offset:8192
ds_read_b128 v[236:239], v35 offset:16384
ds_read_b128 v[204:207], v35 offset:1024
s_waitcnt lgkmcnt(3)
v_mfma_f32_16x16x32_bf16 v[116:119], v[172:175], v[228:231], 0
ds_read_b128 v[208:211], v35 offset:9216
s_waitcnt lgkmcnt(3)
v_mfma_f32_16x16x32_bf16 v[132:135], v[172:175], v[232:235], 0
ds_read_b128 v[212:215], v35 offset:17408
s_waitcnt lgkmcnt(3)
v_mfma_f32_16x16x32_bf16 v[148:151], v[172:175], v[236:239], 0
v_mfma_f32_16x16x32_bf16 v[240:243], a[0:3], v[228:231], 0
v_mfma_f32_16x16x32_bf16 v[244:247], a[0:3], v[232:235], 0
v_mfma_f32_16x16x32_bf16 v[248:251], a[0:3], v[236:239], 0
ds_read_b128 v[180:183], v29 offset:10240
s_waitcnt lgkmcnt(3)
v_mfma_f32_16x16x32_bf16 v[116:119], v[176:179], v[204:207], v[116:119]
s_waitcnt lgkmcnt(2)
v_mfma_f32_16x16x32_bf16 v[132:135], v[176:179], v[208:211], v[132:135]
s_waitcnt lgkmcnt(1)
v_mfma_f32_16x16x32_bf16 v[148:151], v[176:179], v[212:215], v[148:151]
ds_read_b128 v[184:187], v30 offset:10240
v_mfma_f32_16x16x32_bf16 v[240:243], a[4:7], v[204:207], v[240:243]
v_mfma_f32_16x16x32_bf16 v[244:247], a[4:7], v[208:211], v[244:247]
v_mfma_f32_16x16x32_bf16 v[248:251], a[4:7], v[212:215], v[248:251]
s_waitcnt vmcnt(4)
ds_read_b128 v[188:191], v29 offset:0
s_waitcnt lgkmcnt(2)
v_mfma_f32_16x16x32_bf16 v[120:123], v[180:183], v[228:231], 0
v_mfma_f32_16x16x32_bf16 v[136:139], v[180:183], v[232:235], 0
v_mfma_f32_16x16x32_bf16 v[152:155], v[180:183], v[236:239], 0
ds_read_b128 v[192:195], v30 offset:0
s_waitcnt lgkmcnt(2)
v_mfma_f32_16x16x32_bf16 v[120:123], v[184:187], v[204:207], v[120:123]
s_add_u32 m0, s63, 0x2000
s_nop 0
buffer_load_dwordx4 v21, s[48:51], s77 offen offset:0 lds
buffer_load_dwordx4 v22, s[48:51], s77 offen offset:1024 lds
buffer_load_dwordx4 v23, s[48:51], s77 offen offset:2048 lds
buffer_load_dwordx4 v24, s[48:51], s77 offen offset:3072 lds
v_mfma_f32_16x16x32_bf16 v[136:139], v[184:187], v[208:211], v[136:139]
v_mfma_f32_16x16x32_bf16 v[152:155], v[184:187], v[212:215], v[152:155]
ds_read_b128 v[196:199], v29 offset:2048
s_waitcnt lgkmcnt(2)
v_mfma_f32_16x16x32_bf16 v[124:127], v[188:191], v[228:231], 0
v_mfma_f32_16x16x32_bf16 v[140:143], v[188:191], v[232:235], 0
v_mfma_f32_16x16x32_bf16 v[156:159], v[188:191], v[236:239], 0
ds_read_b128 v[200:203], v30 offset:2048
s_waitcnt lgkmcnt(2)
v_mfma_f32_16x16x32_bf16 v[124:127], v[192:195], v[204:207], v[124:127]
v_mfma_f32_16x16x32_bf16 v[140:143], v[192:195], v[208:211], v[140:143]
v_mfma_f32_16x16x32_bf16 v[156:159], v[192:195], v[212:215], v[156:159]
ds_read_b128 v[216:219], v35 offset:2048
s_waitcnt vmcnt(4)
ds_read_b128 v[164:167], v29 offset:4096
s_waitcnt lgkmcnt(3)
v_mfma_f32_16x16x32_bf16 v[128:131], v[196:199], v[228:231], 0
ds_read_b128 v[220:223], v35 offset:10240
v_mfma_f32_16x16x32_bf16 v[144:147], v[196:199], v[232:235], 0
ds_read_b128 v[224:227], v35 offset:18432
v_mfma_f32_16x16x32_bf16 v[160:163], v[196:199], v[236:239], 0
s_waitcnt lgkmcnt(4)
v_mfma_f32_16x16x32_bf16 v[128:131], v[200:203], v[204:207], v[128:131]
s_add_u32 m0, s63, 0x0
s_nop 0
buffer_load_dwordx4 v21, s[48:51], s78 offen offset:0 lds
buffer_load_dwordx4 v22, s[48:51], s78 offen offset:1024 lds
buffer_load_dwordx4 v23, s[48:51], s78 offen offset:2048 lds
buffer_load_dwordx4 v24, s[48:51], s78 offen offset:3072 lds
v_mfma_f32_16x16x32_bf16 v[144:147], v[200:203], v[208:211], v[144:147]
v_mfma_f32_16x16x32_bf16 v[160:163], v[200:203], v[212:215], v[160:163]
ds_read_b128 v[228:231], v35 offset:3072
ds_read_b128 v[168:171], v30 offset:4096
s_waitcnt lgkmcnt(4)
v_mfma_f32_16x16x32_bf16 v[116:119], v[164:167], v[216:219], v[116:119]
ds_read_b128 v[232:235], v35 offset:11264
s_waitcnt lgkmcnt(4)
v_mfma_f32_16x16x32_bf16 v[132:135], v[164:167], v[220:223], v[132:135]
ds_read_b128 v[236:239], v35 offset:19456
s_waitcnt lgkmcnt(4)
v_mfma_f32_16x16x32_bf16 v[148:151], v[164:167], v[224:227], v[148:151]
v_mfma_f32_16x16x32_bf16 v[240:243], a[8:11], v[216:219], v[240:243]
v_mfma_f32_16x16x32_bf16 v[244:247], a[8:11], v[220:223], v[244:247]
v_mfma_f32_16x16x32_bf16 v[248:251], a[8:11], v[224:227], v[248:251]
ds_read_b128 v[172:175], v29 offset:6144
s_waitcnt lgkmcnt(3)
v_mfma_f32_16x16x32_bf16 v[116:119], v[168:171], v[228:231], v[116:119]
s_waitcnt lgkmcnt(2)
v_mfma_f32_16x16x32_bf16 v[132:135], v[168:171], v[232:235], v[132:135]
s_waitcnt lgkmcnt(1)
v_mfma_f32_16x16x32_bf16 v[148:151], v[168:171], v[236:239], v[148:151]
ds_read_b128 v[176:179], v30 offset:6144
v_mfma_f32_16x16x32_bf16 v[240:243], a[12:15], v[228:231], v[240:243]
v_mfma_f32_16x16x32_bf16 v[244:247], a[12:15], v[232:235], v[244:247]
v_mfma_f32_16x16x32_bf16 v[248:251], a[12:15], v[236:239], v[248:251]
s_waitcnt vmcnt(4)
ds_read_b128 v[180:183], v29 offset:8192
s_waitcnt lgkmcnt(2)
v_mfma_f32_16x16x32_bf16 v[120:123], v[172:175], v[216:219], v[120:123]
v_mfma_f32_16x16x32_bf16 v[136:139], v[172:175], v[220:223], v[136:139]
v_mfma_f32_16x16x32_bf16 v[152:155], v[172:175], v[224:227], v[152:155]
ds_read_b128 v[184:187], v30 offset:8192
s_waitcnt lgkmcnt(2)
v_mfma_f32_16x16x32_bf16 v[120:123], v[176:179], v[228:231], v[120:123]
s_add_u32 m0, s63, 0x1000
s_nop 0
buffer_load_dwordx4 v21, s[48:51], s79 offen offset:0 lds
buffer_load_dwordx4 v22, s[48:51], s79 offen offset:1024 lds
buffer_load_dwordx4 v23, s[48:51], s79 offen offset:2048 lds
buffer_load_dwordx4 v24, s[48:51], s79 offen offset:3072 lds
v_mfma_f32_16x16x32_bf16 v[136:139], v[176:179], v[232:235], v[136:139]
v_mfma_f32_16x16x32_bf16 v[152:155], v[176:179], v[236:239], v[152:155]
ds_read_b128 v[188:191], v29 offset:10240
s_waitcnt lgkmcnt(2)
v_mfma_f32_16x16x32_bf16 v[124:127], v[180:183], v[216:219], v[124:127]
v_mfma_f32_16x16x32_bf16 v[140:143], v[180:183], v[220:223], v[140:143]
v_mfma_f32_16x16x32_bf16 v[156:159], v[180:183], v[224:227], v[156:159]
ds_read_b128 v[192:195], v30 offset:10240
s_waitcnt lgkmcnt(2)
v_mfma_f32_16x16x32_bf16 v[124:127], v[184:187], v[228:231], v[124:127]
v_mfma_f32_16x16x32_bf16 v[140:143], v[184:187], v[232:235], v[140:143]
v_mfma_f32_16x16x32_bf16 v[156:159], v[184:187], v[236:239], v[156:159]
ds_read_b128 v[204:207], v35 offset:4096
s_waitcnt vmcnt(4)
ds_read_b128 v[196:199], v29 offset:0
s_waitcnt lgkmcnt(3)
v_mfma_f32_16x16x32_bf16 v[128:131], v[188:191], v[216:219], v[128:131]
ds_read_b128 v[208:211], v35 offset:12288
v_mfma_f32_16x16x32_bf16 v[144:147], v[188:191], v[220:223], v[144:147]
ds_read_b128 v[212:215], v35 offset:20480
v_mfma_f32_16x16x32_bf16 v[160:163], v[188:191], v[224:227], v[160:163]
s_waitcnt lgkmcnt(4)
v_mfma_f32_16x16x32_bf16 v[128:131], v[192:195], v[228:231], v[128:131]
s_add_u32 m0, s63, 0x2000
s_nop 0
buffer_load_dwordx4 v21, s[48:51], s80 offen offset:0 lds
buffer_load_dwordx4 v22, s[48:51], s80 offen offset:1024 lds
buffer_load_dwordx4 v23, s[48:51], s80 offen offset:2048 lds
buffer_load_dwordx4 v24, s[48:51], s80 offen offset:3072 lds
v_mfma_f32_16x16x32_bf16 v[144:147], v[192:195], v[232:235], v[144:147]
v_mfma_f32_16x16x32_bf16 v[160:163], v[192:195], v[236:239], v[160:163]
ds_read_b128 v[216:219], v35 offset:5120
ds_read_b128 v[200:203], v30 offset:0
s_waitcnt lgkmcnt(4)
v_mfma_f32_16x16x32_bf16 v[116:119], v[196:199], v[204:207], v[116:119]
ds_read_b128 v[220:223], v35 offset:13312
s_waitcnt lgkmcnt(4)
v_mfma_f32_16x16x32_bf16 v[132:135], v[196:199], v[208:211], v[132:135]
ds_read_b128 v[224:227], v35 offset:21504
s_waitcnt lgkmcnt(4)
v_mfma_f32_16x16x32_bf16 v[148:151], v[196:199], v[212:215], v[148:151]
v_mfma_f32_16x16x32_bf16 v[240:243], a[16:19], v[204:207], v[240:243]
v_mfma_f32_16x16x32_bf16 v[244:247], a[16:19], v[208:211], v[244:247]
v_mfma_f32_16x16x32_bf16 v[248:251], a[16:19], v[212:215], v[248:251]
ds_read_b128 v[164:167], v29 offset:2048
s_waitcnt lgkmcnt(3)
v_mfma_f32_16x16x32_bf16 v[116:119], v[200:203], v[216:219], v[116:119]
s_waitcnt lgkmcnt(2)
v_mfma_f32_16x16x32_bf16 v[132:135], v[200:203], v[220:223], v[132:135]
s_waitcnt lgkmcnt(1)
v_mfma_f32_16x16x32_bf16 v[148:151], v[200:203], v[224:227], v[148:151]
ds_read_b128 v[168:171], v30 offset:2048
v_mfma_f32_16x16x32_bf16 v[240:243], a[20:23], v[216:219], v[240:243]
v_mfma_f32_16x16x32_bf16 v[244:247], a[20:23], v[220:223], v[244:247]
v_mfma_f32_16x16x32_bf16 v[248:251], a[20:23], v[224:227], v[248:251]
s_waitcnt vmcnt(4)
ds_read_b128 v[172:175], v29 offset:4096
s_waitcnt lgkmcnt(2)
v_mfma_f32_16x16x32_bf16 v[120:123], v[164:167], v[204:207], v[120:123]
v_mfma_f32_16x16x32_bf16 v[136:139], v[164:167], v[208:211], v[136:139]
v_mfma_f32_16x16x32_bf16 v[152:155], v[164:167], v[212:215], v[152:155]
ds_read_b128 v[176:179], v30 offset:4096
s_waitcnt lgkmcnt(2)
v_mfma_f32_16x16x32_bf16 v[120:123], v[168:171], v[216:219], v[120:123]
s_add_u32 m0, s63, 0x0
s_nop 0
buffer_load_dwordx4 v21, s[48:51], s81 offen offset:0 lds
buffer_load_dwordx4 v22, s[48:51], s81 offen offset:1024 lds
buffer_load_dwordx4 v23, s[48:51], s81 offen offset:2048 lds
buffer_load_dwordx4 v24, s[48:51], s81 offen offset:3072 lds
v_mfma_f32_16x16x32_bf16 v[136:139], v[168:171], v[220:223], v[136:139]
v_and_or_b32 v47, v47, v6, v7
v_and_or_b32 v51, v51, v6, v7
v_mfma_f32_16x16x32_bf16 v[152:155], v[168:171], v[224:227], v[152:155]
ds_read_b128 v[180:183], v29 offset:6144
v_and_or_b32 v55, v55, v6, v7
s_waitcnt lgkmcnt(2)
v_mfma_f32_16x16x32_bf16 v[124:127], v[172:175], v[204:207], v[124:127]
v_and_or_b32 v59, v59, v6, v7
v_and_or_b32 v63, v63, v6, v7
v_mfma_f32_16x16x32_bf16 v[140:143], v[172:175], v[208:211], v[140:143]
v_and_or_b32 v67, v67, v6, v7
buffer_store_dwordx4 v[44:47], v16, s[56:59], s64 offen offset:0 sc1
v_mfma_f32_16x16x32_bf16 v[156:159], v[172:175], v[212:215], v[156:159]
ds_read_b128 v[184:187], v30 offset:6144
buffer_store_dwordx4 v[48:51], v16, s[56:59], s64 offen offset:1024 sc1
s_waitcnt lgkmcnt(2)
v_mfma_f32_16x16x32_bf16 v[124:127], v[176:179], v[216:219], v[124:127]
buffer_store_dwordx4 v[52:55], v16, s[56:59], s64 offen offset:2048 sc1
buffer_store_dwordx4 v[56:59], v16, s[56:59], s64 offen offset:3072 sc1
v_mfma_f32_16x16x32_bf16 v[140:143], v[176:179], v[220:223], v[140:143]
buffer_store_dwordx4 v[60:63], v16, s[56:59], s65 offen offset:0 sc1
buffer_store_dwordx4 v[64:67], v16, s[56:59], s65 offen offset:1024 sc1
v_mfma_f32_16x16x32_bf16 v[156:159], v[176:179], v[224:227], v[156:159]
ds_read_b128 v[228:231], v35 offset:6144
s_waitcnt vmcnt(10)
ds_read_b128 v[188:191], v29 offset:8192
s_waitcnt lgkmcnt(3)
v_mfma_f32_16x16x32_bf16 v[128:131], v[180:183], v[204:207], v[128:131]
ds_read_b128 v[232:235], v35 offset:14336
v_mfma_f32_16x16x32_bf16 v[144:147], v[180:183], v[208:211], v[144:147]
ds_read_b128 v[236:239], v35 offset:22528
v_mfma_f32_16x16x32_bf16 v[160:163], v[180:183], v[212:215], v[160:163]
s_waitcnt lgkmcnt(4)
v_mfma_f32_16x16x32_bf16 v[128:131], v[184:187], v[216:219], v[128:131]
v_mfma_f32_16x16x32_bf16 v[144:147], v[184:187], v[220:223], v[144:147]
v_mfma_f32_16x16x32_bf16 v[160:163], v[184:187], v[224:227], v[160:163]
ds_read_b128 v[204:207], v35 offset:7168
ds_read_b128 v[192:195], v30 offset:8192
s_waitcnt lgkmcnt(4)
v_mfma_f32_16x16x32_bf16 v[116:119], v[188:191], v[228:231], v[116:119]
ds_read_b128 v[208:211], v35 offset:15360
s_waitcnt lgkmcnt(4)
v_mfma_f32_16x16x32_bf16 v[132:135], v[188:191], v[232:235], v[132:135]
ds_read_b128 v[212:215], v35 offset:23552
s_waitcnt lgkmcnt(4)
v_mfma_f32_16x16x32_bf16 v[148:151], v[188:191], v[236:239], v[148:151]
v_mfma_f32_16x16x32_bf16 v[240:243], a[24:27], v[228:231], v[240:243]
v_mfma_f32_16x16x32_bf16 v[244:247], a[24:27], v[232:235], v[244:247]
v_mfma_f32_16x16x32_bf16 v[248:251], a[24:27], v[236:239], v[248:251]
ds_read_b128 v[196:199], v29 offset:10240
s_waitcnt lgkmcnt(3)
v_mfma_f32_16x16x32_bf16 v[116:119], v[192:195], v[204:207], v[116:119]
s_waitcnt lgkmcnt(2)
v_mfma_f32_16x16x32_bf16 v[132:135], v[192:195], v[208:211], v[132:135]
s_waitcnt lgkmcnt(1)
v_mfma_f32_16x16x32_bf16 v[148:151], v[192:195], v[212:215], v[148:151]
ds_read_b128 v[200:203], v30 offset:10240
v_mfma_f32_16x16x32_bf16 v[240:243], a[28:31], v[204:207], v[240:243]
v_mfma_f32_16x16x32_bf16 v[244:247], a[28:31], v[208:211], v[244:247]
v_mfma_f32_16x16x32_bf16 v[248:251], a[28:31], v[212:215], v[248:251]
s_waitcnt vmcnt(6)
ds_read_b128 v[164:167], v29 offset:0
s_waitcnt lgkmcnt(2)
v_mfma_f32_16x16x32_bf16 v[120:123], v[196:199], v[228:231], v[120:123]
v_mfma_f32_16x16x32_bf16 v[136:139], v[196:199], v[232:235], v[136:139]
v_mfma_f32_16x16x32_bf16 v[152:155], v[196:199], v[236:239], v[152:155]
ds_read_b128 v[168:171], v30 offset:0
s_waitcnt lgkmcnt(2)
v_mfma_f32_16x16x32_bf16 v[120:123], v[200:203], v[204:207], v[120:123]
v_mul_f32 v240, s86, v240
v_mul_f32 v244, s86, v244
v_mul_f32 v248, s86, v248
v_mfma_f32_16x16x32_bf16 v[136:139], v[200:203], v[208:211], v[136:139]
v_mfma_f32_16x16x32_bf16 v[152:155], v[200:203], v[212:215], v[152:155]
ds_read_b128 v[172:175], v29 offset:2048
s_waitcnt lgkmcnt(2)
v_mfma_f32_16x16x32_bf16 v[124:127], v[164:167], v[228:231], v[124:127]
v_fma_f32 v116, s86, v116, -v240
v_fma_f32 v117, s86, v117, -v240
v_fma_f32 v118, s86, v118, -v240
v_fma_f32 v119, s86, v119, -v240
v_fma_f32 v120, s86, v120, -v240
v_fma_f32 v121, s86, v121, -v240
v_fma_f32 v122, s86, v122, -v240
v_fma_f32 v123, s86, v123, -v240
v_cvt_pk_bf16_f32 v116, v116, v117
v_cvt_pk_bf16_f32 v117, v118, v119
v_cvt_pk_bf16_f32 v118, v120, v121
v_cvt_pk_bf16_f32 v119, v122, v123
buffer_store_dwordx4 v[116:119], v16, s[52:55], s82 offen offset:0 sc1
v_mfma_f32_16x16x32_bf16 v[140:143], v[164:167], v[232:235], v[140:143]
v_fma_f32 v132, s86, v132, -v244
v_fma_f32 v133, s86, v133, -v244
v_fma_f32 v134, s86, v134, -v244
v_fma_f32 v135, s86, v135, -v244
v_fma_f32 v136, s86, v136, -v244
v_fma_f32 v137, s86, v137, -v244
v_fma_f32 v138, s86, v138, -v244
v_fma_f32 v139, s86, v139, -v244
v_cvt_pk_bf16_f32 v132, v132, v133
v_cvt_pk_bf16_f32 v133, v134, v135
v_cvt_pk_bf16_f32 v134, v136, v137
v_cvt_pk_bf16_f32 v135, v138, v139
buffer_store_dwordx4 v[132:135], v16, s[52:55], s83 offen offset:0 sc1
v_mfma_f32_16x16x32_bf16 v[156:159], v[164:167], v[236:239], v[156:159]
ds_read_b128 v[176:179], v30 offset:2048
v_fma_f32 v148, s86, v148, -v248
v_fma_f32 v149, s86, v149, -v248
v_fma_f32 v150, s86, v150, -v248
v_fma_f32 v151, s86, v151, -v248
v_fma_f32 v152, s86, v152, -v248
v_fma_f32 v153, s86, v153, -v248
v_fma_f32 v154, s86, v154, -v248
v_fma_f32 v155, s86, v155, -v248
v_cvt_pk_bf16_f32 v148, v148, v149
v_cvt_pk_bf16_f32 v149, v150, v151
v_cvt_pk_bf16_f32 v150, v152, v153
v_cvt_pk_bf16_f32 v151, v154, v155
buffer_store_dwordx4 v[148:151], v16, s[52:55], s84 offen offset:0 sc1
s_waitcnt lgkmcnt(2)
v_mfma_f32_16x16x32_bf16 v[124:127], v[168:171], v[204:207], v[124:127]
v_mfma_f32_16x16x32_bf16 v[140:143], v[168:171], v[208:211], v[140:143]
v_mfma_f32_16x16x32_bf16 v[156:159], v[168:171], v[212:215], v[156:159]
s_waitcnt lgkmcnt(1)
v_mfma_f32_16x16x32_bf16 v[128:131], v[172:175], v[228:231], v[128:131]
v_mfma_f32_16x16x32_bf16 v[144:147], v[172:175], v[232:235], v[144:147]
v_mfma_f32_16x16x32_bf16 v[160:163], v[172:175], v[236:239], v[160:163]
s_waitcnt lgkmcnt(0)
v_mfma_f32_16x16x32_bf16 v[128:131], v[176:179], v[204:207], v[128:131]
v_mfma_f32_16x16x32_bf16 v[144:147], v[176:179], v[208:211], v[144:147]
v_mfma_f32_16x16x32_bf16 v[160:163], v[176:179], v[212:215], v[160:163]
v_fma_f32 v124, s86, v124, -v240
v_fma_f32 v125, s86, v125, -v240
v_fma_f32 v126, s86, v126, -v240
v_fma_f32 v127, s86, v127, -v240
s_nop 1
v_fma_f32 v128, s86, v128, -v240
v_fma_f32 v129, s86, v129, -v240
v_fma_f32 v130, s86, v130, -v240
v_fma_f32 v131, s86, v131, -v240
v_cvt_pk_bf16_f32 v124, v124, v125
v_cvt_pk_bf16_f32 v125, v126, v127
v_cvt_pk_bf16_f32 v126, v128, v129
v_cvt_pk_bf16_f32 v127, v130, v131
buffer_store_dwordx4 v[124:127], v16, s[52:55], s82 offen offset:1024 sc1
v_fma_f32 v140, s86, v140, -v244
v_fma_f32 v141, s86, v141, -v244
v_fma_f32 v142, s86, v142, -v244
v_fma_f32 v143, s86, v143, -v244
v_fma_f32 v144, s86, v144, -v244
v_fma_f32 v145, s86, v145, -v244
v_fma_f32 v146, s86, v146, -v244
v_fma_f32 v147, s86, v147, -v244
v_cvt_pk_bf16_f32 v140, v140, v141
v_cvt_pk_bf16_f32 v141, v142, v143
v_cvt_pk_bf16_f32 v142, v144, v145
v_cvt_pk_bf16_f32 v143, v146, v147
buffer_store_dwordx4 v[140:143], v16, s[52:55], s83 offen offset:1024 sc1
v_fma_f32 v156, s86, v156, -v248
v_fma_f32 v157, s86, v157, -v248
v_fma_f32 v158, s86, v158, -v248
v_fma_f32 v159, s86, v159, -v248
v_fma_f32 v160, s86, v160, -v248
v_fma_f32 v161, s86, v161, -v248
v_fma_f32 v162, s86, v162, -v248
v_fma_f32 v163, s86, v163, -v248
v_cvt_pk_bf16_f32 v156, v156, v157
v_cvt_pk_bf16_f32 v157, v158, v159
v_cvt_pk_bf16_f32 v158, v160, v161
v_cvt_pk_bf16_f32 v159, v162, v163
buffer_store_dwordx4 v[156:159], v16, s[52:55], s84 offen offset:1024 sc1
L1_fin:
s_add_u32 s91, s91, 1344
s_waitcnt lgkmcnt(0)
s_add_u32 s98, s98, 0x7f4a7c15
s_addc_u32 s99, s99, 0x9e3779b9
LM_pub:
s_add_u32 s40, s38, 0x7c00000
s_addc_u32 s41, s39, 0
s_mov_b32 s42, 0x40000
s_mov_b32 s43, 0x00020000
s_lshl_b32 s6, s91, 7
s_cmp_eq_u32 s60, 0
s_cselect_b32 s6, s6, 0x70000000
s_waitcnt vmcnt(0) lgkmcnt(0)
s_barrier
v_mov_b32 v6, s98
v_mov_b32 v7, s99
s_mov_b64 exec, 1
buffer_store_dwordx2 v[6:7], off, s[40:43], s6 sc1
s_mov_b64 exec, -1
s_cmp_eq_u32 s61, 0
s_cbranch_scc1 L2_entry
s_mov_b32 s61, 0
s_sub_u32 s4, s91, 1578
s_min_u32 s6, s4, 14
s_cmp_lt_u32 s4, 6
s_cselect_b32 s6, 0, s6
s_sub_u32 s4, s4, s6
s_add_u32 s91, s4, 1600
v_lshlrev_b32 v16, 4, v2
s_mul_i32 s63, s60, 12288
s_and_b32 s6, s4, 3
s_lshl_b32 s6, s6, 6
s_mul_i32 s7, s60, 16
s_add_u32 s6, s6, s7
v_lshrrev_b32 v5, 5, v2
v_and_b32 v6, 31, v2
v_lshlrev_b32 v6, 4, v6
s_cmp_ge_u32 s4, 4
s_cselect_b64 vcc, -1, 0
v_add3_u32 v7, v5, s6, 0
v_and_b32 v8, 0x80, v7
v_bfe_u32 v9, v7, 2, 1
v_lshl_or_b32 v8, v9, 6, v8
v_bfe_u32 v9, v7, 4, 1
v_lshl_or_b32 v8, v9, 5, v8
v_and_b32 v9, 3, v7
v_lshl_or_b32 v8, v9, 3, v8
v_bfe_u32 v9, v7, 5, 2
v_lshl_or_b32 v8, v9, 1, v8
v_bfe_u32 v9, v7, 3, 1
v_or_b32 v8, v9, v8
v_cndmask_b32 v8, v8, v7, vcc
v_lshl_add_u32 v44, v8, 9, v6
v_add3_u32 v7, v5, s6, 2
v_and_b32 v8, 0x80, v7
v_bfe_u32 v9, v7, 2, 1
v_lshl_or_b32 v8, v9, 6, v8
v_bfe_u32 v9, v7, 4, 1
v_lshl_or_b32 v8, v9, 5, v8
v_and_b32 v9, 3, v7
v_lshl_or_b32 v8, v9, 3, v8
v_bfe_u32 v9, v7, 5, 2
v_lshl_or_b32 v8, v9, 1, v8
v_bfe_u32 v9, v7, 3, 1
v_or_b32 v8, v9, v8
v_cndmask_b32 v8, v8, v7, vcc
v_lshl_add_u32 v48, v8, 9, v6
v_add3_u32 v7, v5, s6, 4
v_and_b32 v8, 0x80, v7
v_bfe_u32 v9, v7, 2, 1
v_lshl_or_b32 v8, v9, 6, v8
v_bfe_u32 v9, v7, 4, 1
v_lshl_or_b32 v8, v9, 5, v8
v_and_b32 v9, 3, v7
v_lshl_or_b32 v8, v9, 3, v8
v_bfe_u32 v9, v7, 5, 2
v_lshl_or_b32 v8, v9, 1, v8
v_bfe_u32 v9, v7, 3, 1
v_or_b32 v8, v9, v8
v_cndmask_b32 v8, v8, v7, vcc
v_lshl_add_u32 v52, v8, 9, v6
v_add3_u32 v7, v5, s6, 6
v_and_b32 v8, 0x80, v7
v_bfe_u32 v9, v7, 2, 1
v_lshl_or_b32 v8, v9, 6, v8
v_bfe_u32 v9, v7, 4, 1
v_lshl_or_b32 v8, v9, 5, v8
v_and_b32 v9, 3, v7
v_lshl_or_b32 v8, v9, 3, v8
v_bfe_u32 v9, v7, 5, 2
v_lshl_or_b32 v8, v9, 1, v8
v_bfe_u32 v9, v7, 3, 1
v_or_b32 v8, v9, v8
v_cndmask_b32 v8, v8, v7, vcc
v_lshl_add_u32 v56, v8, 9, v6
v_add3_u32 v7, v5, s6, 8
v_and_b32 v8, 0x80, v7
v_bfe_u32 v9, v7, 2, 1
v_lshl_or_b32 v8, v9, 6, v8
v_bfe_u32 v9, v7, 4, 1
v_lshl_or_b32 v8, v9, 5, v8
v_and_b32 v9, 3, v7
v_lshl_or_b32 v8, v9, 3, v8
v_bfe_u32 v9, v7, 5, 2
v_lshl_or_b32 v8, v9, 1, v8
v_bfe_u32 v9, v7, 3, 1
v_or_b32 v8, v9, v8
v_cndmask_b32 v8, v8, v7, vcc
v_lshl_add_u32 v60, v8, 9, v6
v_add3_u32 v7, v5, s6, 10
v_and_b32 v8, 0x80, v7
v_bfe_u32 v9, v7, 2, 1
v_lshl_or_b32 v8, v9, 6, v8
v_bfe_u32 v9, v7, 4, 1
v_lshl_or_b32 v8, v9, 5, v8
v_and_b32 v9, 3, v7
v_lshl_or_b32 v8, v9, 3, v8
v_bfe_u32 v9, v7, 5, 2
v_lshl_or_b32 v8, v9, 1, v8
v_bfe_u32 v9, v7, 3, 1
v_or_b32 v8, v9, v8
v_cndmask_b32 v8, v8, v7, vcc
v_lshl_add_u32 v64, v8, 9, v6
v_add3_u32 v7, v5, s6, 12
v_and_b32 v8, 0x80, v7
v_bfe_u32 v9, v7, 2, 1
v_lshl_or_b32 v8, v9, 6, v8
v_bfe_u32 v9, v7, 4, 1
v_lshl_or_b32 v8, v9, 5, v8
v_and_b32 v9, 3, v7
v_lshl_or_b32 v8, v9, 3, v8
v_bfe_u32 v9, v7, 5, 2
v_lshl_or_b32 v8, v9, 1, v8
v_bfe_u32 v9, v7, 3, 1
v_or_b32 v8, v9, v8
v_cndmask_b32 v8, v8, v7, vcc
v_lshl_add_u32 v68, v8, 9, v6
v_add3_u32 v7, v5, s6, 14
v_and_b32 v8, 0x80, v7
v_bfe_u32 v9, v7, 2, 1
v_lshl_or_b32 v8, v9, 6, v8
v_bfe_u32 v9, v7, 4, 1
v_lshl_or_b32 v8, v9, 5, v8
v_and_b32 v9, 3, v7
v_lshl_or_b32 v8, v9, 3, v8
v_bfe_u32 v9, v7, 5, 2
v_lshl_or_b32 v8, v9, 1, v8
v_bfe_u32 v9, v7, 3, 1
v_or_b32 v8, v9, v8
v_cndmask_b32 v8, v8, v7, vcc
v_lshl_add_u32 v72, v8, 9, v6
s_lshl_b32 s7, s60, 7
v_lshrrev_b32 v5, 3, v2
v_and_b32 v6, 7, v2
v_and_b32 v7, 2, v5
v_xor_b32 v6, v6, v7
v_lshl_add_u32 v5, v5, 9, s7
v_lshl_add_u32 v17, v6, 4, v5
v_xor_b32 v6, 4, v6
v_lshl_add_u32 v18, v6, 4, v5
v_add_u32 v18, 0xc00, v18
v_add_u32 v19, 0x1800, v17
v_add_u32 v20, 0x1800, v18
s_xor_b32 s6, s62, 0
s_lshl_b32 s66, s6, 14
s_xor_b32 s6, s62, 1
s_lshl_b32 s67, s6, 14
s_xor_b32 s6, s62, 2
s_lshl_b32 s68, s6, 14
s_xor_b32 s6, s62, 3
s_lshl_b32 s69, s6, 14
s_xor_b32 s6, s62, 4
s_lshl_b32 s70, s6, 14
s_xor_b32 s6, s62, 5
s_lshl_b32 s71, s6, 14
s_xor_b32 s6, s62, 6
s_lshl_b32 s72, s6, 14
s_xor_b32 s6, s62, 7
s_lshl_b32 s73, s6, 14
s_waitcnt lgkmcnt(0)
s_cmp_ge_u32 s4, 4
s_cselect_b32 s6, s30, s24
s_cselect_b32 s7, s31, s25
s_add_u32 s40, s6, 0x0
s_addc_u32 s41, s7, 0
s_mov_b32 s42, 0x20000
s_mov_b32 s43, 0x00020000
s_add_u32 s44, s32, 0x0
s_addc_u32 s45, s33, 0
s_mov_b32 s46, 0x20000
s_mov_b32 s47, 0x00020000
buffer_load_dwordx4 v[44:47], v44, s[40:43], 0 offen
buffer_load_dwordx4 v[48:51], v48, s[40:43], 0 offen
buffer_load_dwordx4 v[52:55], v52, s[40:43], 0 offen
buffer_load_dwordx4 v[56:59], v56, s[40:43], 0 offen
buffer_load_dwordx4 v[60:63], v60, s[40:43], 0 offen
buffer_load_dwordx4 v[64:67], v64, s[40:43], 0 offen
buffer_load_dwordx4 v[68:71], v68, s[40:43], 0 offen
buffer_load_dwordx4 v[72:75], v72, s[40:43], 0 offen
s_add_u32 m0, s63, 0x0
s_nop 0
buffer_load_dwordx4 v17, s[44:47], s66 offen offset:0 lds
buffer_load_dwordx4 v18, s[44:47], s66 offen offset:1024 lds
buffer_load_dwordx4 v19, s[44:47], s66 offen offset:2048 lds
buffer_load_dwordx4 v20, s[44:47], s66 offen offset:3072 lds
s_add_u32 m0, s63, 0x1000
s_nop 0
buffer_load_dwordx4 v17, s[44:47], s67 offen offset:0 lds
buffer_load_dwordx4 v18, s[44:47], s67 offen offset:1024 lds
buffer_load_dwordx4 v19, s[44:47], s67 offen offset:2048 lds
buffer_load_dwordx4 v20, s[44:47], s67 offen offset:3072 lds
v_bfe_u32 v5, v2, 2, 3
v_xor_b32 v5, s62, v5
v_and_b32 v6, 3, v2
v_lshlrev_b32 v7, 10, v5
v_lshl_add_u32 v7, v6, 8, v7
v_add_u32 v7, 0xc000, v7
v_and_b32 v5, 1, v5
v_lshl_or_b32 v6, v5, 2, v6
v_lshrrev_b32 v5, 5, v2
s_mul_i32 s6, s60, 16
v_add3_u32 v8, v5, s6, 0
v_lshrrev_b32 v9, 4, v8
v_lshl_add_u32 v9, v9, 13, v7
v_and_b32 v8, 15, v8
v_xor_b32 v8, v8, v6
v_lshl_add_u32 v36, v8, 4, v9
v_add3_u32 v8, v5, s6, 2
v_lshrrev_b32 v9, 4, v8
v_lshl_add_u32 v9, v9, 13, v7
v_and_b32 v8, 15, v8
v_xor_b32 v8, v8, v6
v_lshl_add_u32 v37, v8, 4, v9
v_add3_u32 v8, v5, s6, 4
v_lshrrev_b32 v9, 4, v8
v_lshl_add_u32 v9, v9, 13, v7
v_and_b32 v8, 15, v8
v_xor_b32 v8, v8, v6
v_lshl_add_u32 v38, v8, 4, v9
v_add3_u32 v8, v5, s6, 6
v_lshrrev_b32 v9, 4, v8
v_lshl_add_u32 v9, v9, 13, v7
v_and_b32 v8, 15, v8
v_xor_b32 v8, v8, v6
v_lshl_add_u32 v39, v8, 4, v9
v_add3_u32 v8, v5, s6, 8
v_lshrrev_b32 v9, 4, v8
v_lshl_add_u32 v9, v9, 13, v7
v_and_b32 v8, 15, v8
v_xor_b32 v8, v8, v6
v_lshl_add_u32 v40, v8, 4, v9
v_add3_u32 v8, v5, s6, 10
v_lshrrev_b32 v9, 4, v8
v_lshl_add_u32 v9, v9, 13, v7
v_and_b32 v8, 15, v8
v_xor_b32 v8, v8, v6
v_lshl_add_u32 v41, v8, 4, v9
v_add3_u32 v8, v5, s6, 12
v_lshrrev_b32 v9, 4, v8
v_lshl_add_u32 v9, v9, 13, v7
v_and_b32 v8, 15, v8
v_xor_b32 v8, v8, v6
v_lshl_add_u32 v42, v8, 4, v9
v_add3_u32 v8, v5, s6, 14
v_lshrrev_b32 v9, 4, v8
v_lshl_add_u32 v9, v9, 13, v7
v_and_b32 v8, 15, v8
v_xor_b32 v8, v8, v6
v_lshl_add_u32 v43, v8, 4, v9
v_xor_b32 v5, v3, v4
v_lshlrev_b32 v5, 4, v5
v_lshl_add_u32 v5, v4, 8, v5
v_add_u32 v31, 0xc000, v5
v_xor_b32 v32, 64, v31
v_lshrrev_b32 v5, 2, v3
v_and_b32 v6, 3, v3
v_and_b32 v7, 1, v4
v_lshlrev_b32 v7, 2, v7
v_and_b32 v8, 2, v5
v_or_b32 v7, v7, v8
v_lshl_add_u32 v8, v4, 3, v5
v_lshlrev_b32 v8, 7, v8
v_add_u32 v8, s63, v8
v_xor_b32 v6, v6, v7
v_xor_b32 v9, 0, v6
v_lshl_add_u32 v25, v9, 4, v8
v_add_u32 v26, 8, v25
v_xor_b32 v9, 4, v6
v_lshl_add_u32 v27, v9, 4, v8
v_add_u32 v28, 8, v27
s_lshr_b32 s6, s4, 2
s_lshl_b32 s6, s6, 17
s_and_b32 s7, s4, 3
s_lshl_b32 s7, s7, 12
s_add_u32 s6, s6, s7
s_mul_i32 s7, s60, 32768
s_add_u32 s82, s6, s7
s_add_u32 s83, s82, 16384
s_add_u32 s52, s38, 0x1000000
s_addc_u32 s53, s39, 0
s_mov_b32 s54, 0x40000
s_mov_b32 s55, 0x00020000
v_and_b32 v5, 31, v2
v_lshlrev_b32 v5, 4, v5
s_mov_b32 s6, 130560
s_mov_b32 s90, 0xffff0000
buffer_load_dwordx4 v[92:95], v5, s[40:43], s6 offen
s_waitcnt vmcnt(0)
v_lshlrev_b32 v84, 16, v92
v_lshlrev_b32 v86, 16, v93
v_lshlrev_b32 v88, 16, v94
v_lshlrev_b32 v90, 16, v95
v_and_b32 v85, s90, v92
v_and_b32 v87, s90, v93
v_and_b32 v89, s90, v94
v_and_b32 v91, s90, v95
v_lshlrev_b32 v76, 16, v44
v_lshlrev_b32 v78, 16, v45
v_lshlrev_b32 v80, 16, v46
v_lshlrev_b32 v82, 16, v47
v_and_b32 v77, s90, v44
v_and_b32 v79, s90, v45
v_and_b32 v81, s90, v46
v_and_b32 v83, s90, v47
v_sub_f32 v76, v76, v84
v_sub_f32 v77, v77, v85
v_sub_f32 v78, v78, v86
v_sub_f32 v79, v79, v87
v_sub_f32 v80, v80, v88
v_sub_f32 v81, v81, v89
v_sub_f32 v82, v82, v90
v_sub_f32 v83, v83, v91
v_cvt_pk_bf16_f32 v44, v76, v77
v_cvt_pk_bf16_f32 v45, v78, v79
v_cvt_pk_bf16_f32 v46, v80, v81
v_cvt_pk_bf16_f32 v47, v82, v83
v_lshlrev_b32 v76, 16, v48
v_lshlrev_b32 v78, 16, v49
v_lshlrev_b32 v80, 16, v50
v_lshlrev_b32 v82, 16, v51
v_and_b32 v77, s90, v48
v_and_b32 v79, s90, v49
v_and_b32 v81, s90, v50
v_and_b32 v83, s90, v51
v_sub_f32 v76, v76, v84
v_sub_f32 v77, v77, v85
v_sub_f32 v78, v78, v86
v_sub_f32 v79, v79, v87
v_sub_f32 v80, v80, v88
v_sub_f32 v81, v81, v89
v_sub_f32 v82, v82, v90
v_sub_f32 v83, v83, v91
v_cvt_pk_bf16_f32 v48, v76, v77
v_cvt_pk_bf16_f32 v49, v78, v79
v_cvt_pk_bf16_f32 v50, v80, v81
v_cvt_pk_bf16_f32 v51, v82, v83
v_lshlrev_b32 v76, 16, v52
v_lshlrev_b32 v78, 16, v53
v_lshlrev_b32 v80, 16, v54
v_lshlrev_b32 v82, 16, v55
v_and_b32 v77, s90, v52
v_and_b32 v79, s90, v53
v_and_b32 v81, s90, v54
v_and_b32 v83, s90, v55
v_sub_f32 v76, v76, v84
v_sub_f32 v77, v77, v85
v_sub_f32 v78, v78, v86
v_sub_f32 v79, v79, v87
v_sub_f32 v80, v80, v88
v_sub_f32 v81, v81, v89
v_sub_f32 v82, v82, v90
v_sub_f32 v83, v83, v91
v_cvt_pk_bf16_f32 v52, v76, v77
v_cvt_pk_bf16_f32 v53, v78, v79
v_cvt_pk_bf16_f32 v54, v80, v81
v_cvt_pk_bf16_f32 v55, v82, v83
v_lshlrev_b32 v76, 16, v56
v_lshlrev_b32 v78, 16, v57
v_lshlrev_b32 v80, 16, v58
v_lshlrev_b32 v82, 16, v59
v_and_b32 v77, s90, v56
v_and_b32 v79, s90, v57
v_and_b32 v81, s90, v58
v_and_b32 v83, s90, v59
v_sub_f32 v76, v76, v84
v_sub_f32 v77, v77, v85
v_sub_f32 v78, v78, v86
v_sub_f32 v79, v79, v87
v_sub_f32 v80, v80, v88
v_sub_f32 v81, v81, v89
v_sub_f32 v82, v82, v90
v_sub_f32 v83, v83, v91
v_cvt_pk_bf16_f32 v56, v76, v77
v_cvt_pk_bf16_f32 v57, v78, v79
v_cvt_pk_bf16_f32 v58, v80, v81
v_cvt_pk_bf16_f32 v59, v82, v83
v_lshlrev_b32 v76, 16, v60
v_lshlrev_b32 v78, 16, v61
v_lshlrev_b32 v80, 16, v62
v_lshlrev_b32 v82, 16, v63
v_and_b32 v77, s90, v60
v_and_b32 v79, s90, v61
v_and_b32 v81, s90, v62
v_and_b32 v83, s90, v63
v_sub_f32 v76, v76, v84
v_sub_f32 v77, v77, v85
v_sub_f32 v78, v78, v86
v_sub_f32 v79, v79, v87
v_sub_f32 v80, v80, v88
v_sub_f32 v81, v81, v89
v_sub_f32 v82, v82, v90
v_sub_f32 v83, v83, v91
v_cvt_pk_bf16_f32 v60, v76, v77
v_cvt_pk_bf16_f32 v61, v78, v79
v_cvt_pk_bf16_f32 v62, v80, v81
v_cvt_pk_bf16_f32 v63, v82, v83
v_lshlrev_b32 v76, 16, v64
v_lshlrev_b32 v78, 16, v65
v_lshlrev_b32 v80, 16, v66
v_lshlrev_b32 v82, 16, v67
v_and_b32 v77, s90, v64
v_and_b32 v79, s90, v65
v_and_b32 v81, s90, v66
v_and_b32 v83, s90, v67
v_sub_f32 v76, v76, v84
v_sub_f32 v77, v77, v85
v_sub_f32 v78, v78, v86
v_sub_f32 v79, v79, v87
v_sub_f32 v80, v80, v88
v_sub_f32 v81, v81, v89
v_sub_f32 v82, v82, v90
v_sub_f32 v83, v83, v91
v_cvt_pk_bf16_f32 v64, v76, v77
v_cvt_pk_bf16_f32 v65, v78, v79
v_cvt_pk_bf16_f32 v66, v80, v81
v_cvt_pk_bf16_f32 v67, v82, v83
v_lshlrev_b32 v76, 16, v68
v_lshlrev_b32 v78, 16, v69
v_lshlrev_b32 v80, 16, v70
v_lshlrev_b32 v82, 16, v71
v_and_b32 v77, s90, v68
v_and_b32 v79, s90, v69
v_and_b32 v81, s90, v70
v_and_b32 v83, s90, v71
v_sub_f32 v76, v76, v84
v_sub_f32 v77, v77, v85
v_sub_f32 v78, v78, v86
v_sub_f32 v79, v79, v87
v_sub_f32 v80, v80, v88
v_sub_f32 v81, v81, v89
v_sub_f32 v82, v82, v90
v_sub_f32 v83, v83, v91
v_cvt_pk_bf16_f32 v68, v76, v77
v_cvt_pk_bf16_f32 v69, v78, v79
v_cvt_pk_bf16_f32 v70, v80, v81
v_cvt_pk_bf16_f32 v71, v82, v83
v_lshlrev_b32 v76, 16, v72
v_lshlrev_b32 v78, 16, v73
v_lshlrev_b32 v80, 16, v74
v_lshlrev_b32 v82, 16, v75
v_and_b32 v77, s90, v72
v_and_b32 v79, s90, v73
v_and_b32 v81, s90, v74
v_and_b32 v83, s90, v75
v_sub_f32 v76, v76, v84
v_sub_f32 v77, v77, v85
v_sub_f32 v78, v78, v86
v_sub_f32 v79, v79, v87
v_sub_f32 v80, v80, v88
v_sub_f32 v81, v81, v89
v_sub_f32 v82, v82, v90
v_sub_f32 v83, v83, v91
v_cvt_pk_bf16_f32 v72, v76, v77
v_cvt_pk_bf16_f32 v73, v78, v79
v_cvt_pk_bf16_f32 v74, v80, v81
v_cvt_pk_bf16_f32 v75, v82, v83
ds_write_b128 v36, v[44:47]
ds_write_b128 v37, v[48:51]
ds_write_b128 v38, v[52:55]
ds_write_b128 v39, v[56:59]
ds_write_b128 v40, v[60:63]
ds_write_b128 v41, v[64:67]
ds_write_b128 v42, v[68:71]
ds_write_b128 v43, v[72:75]
s_add_u32 m0, s63, 0x2000
s_nop 0
buffer_load_dwordx4 v17, s[44:47], s68 offen offset:0 lds
buffer_load_dwordx4 v18, s[44:47], s68 offen offset:1024 lds
buffer_load_dwordx4 v19, s[44:47], s68 offen offset:2048 lds
buffer_load_dwordx4 v20, s[44:47], s68 offen offset:3072 lds
ds_read_b64_tr_b16 v[140:141], v25 offset:0
ds_read_b64_tr_b16 v[142:143], v25 offset:512
ds_read_b64_tr_b16 v[144:145], v26 offset:0
ds_read_b64_tr_b16 v[146:147], v26 offset:512
ds_read_b64_tr_b16 v[148:149], v27 offset:0
ds_read_b64_tr_b16 v[150:151], v27 offset:512
s_waitcnt lgkmcnt(6)
s_barrier
ds_read_b128 v[180:183], v31 offset:0
ds_read_b128 v[184:187], v31 offset:8192
ds_read_b128 v[188:191], v31 offset:16384
ds_read_b128 v[192:195], v31 offset:24576
s_waitcnt lgkmcnt(3)
v_mfma_f32_16x16x32_bf16 v[76:79], v[180:183], v[140:143], 0
s_waitcnt lgkmcnt(2)
v_mfma_f32_16x16x32_bf16 v[80:83], v[184:187], v[140:143], 0
s_waitcnt lgkmcnt(1)
v_mfma_f32_16x16x32_bf16 v[84:87], v[188:191], v[140:143], 0
s_waitcnt lgkmcnt(0)
v_mfma_f32_16x16x32_bf16 v[88:91], v[192:195], v[140:143], 0
ds_read_b64_tr_b16 v[152:153], v28 offset:0
ds_read_b64_tr_b16 v[154:155], v28 offset:512
v_mfma_f32_16x16x32_bf16 v[92:95], v[180:183], v[144:147], 0
v_mfma_f32_16x16x32_bf16 v[96:99], v[184:187], v[144:147], 0
v_mfma_f32_16x16x32_bf16 v[100:103], v[188:191], v[144:147], 0
v_mfma_f32_16x16x32_bf16 v[104:107], v[192:195], v[144:147], 0
ds_read_b128 v[196:199], v32 offset:1024
ds_read_b64_tr_b16 v[156:157], v25 offset:4096
ds_read_b64_tr_b16 v[158:159], v25 offset:4608
v_mfma_f32_16x16x32_bf16 v[108:111], v[180:183], v[148:151], 0
ds_read_b128 v[200:203], v32 offset:9216
v_mfma_f32_16x16x32_bf16 v[112:115], v[184:187], v[148:151], 0
ds_read_b128 v[204:207], v32 offset:17408
v_mfma_f32_16x16x32_bf16 v[116:119], v[188:191], v[148:151], 0
ds_read_b128 v[208:211], v32 offset:25600
v_mfma_f32_16x16x32_bf16 v[120:123], v[192:195], v[148:151], 0
ds_read_b64_tr_b16 v[160:161], v26 offset:4096
ds_read_b64_tr_b16 v[162:163], v26 offset:4608
s_waitcnt lgkmcnt(8)
v_mfma_f32_16x16x32_bf16 v[124:127], v[180:183], v[152:155], 0
s_add_u32 m0, s63, 0x0
s_nop 0
buffer_load_dwordx4 v17, s[44:47], s69 offen offset:0 lds
buffer_load_dwordx4 v18, s[44:47], s69 offen offset:1024 lds
buffer_load_dwordx4 v19, s[44:47], s69 offen offset:2048 lds
buffer_load_dwordx4 v20, s[44:47], s69 offen offset:3072 lds
v_mfma_f32_16x16x32_bf16 v[128:131], v[184:187], v[152:155], 0
v_mfma_f32_16x16x32_bf16 v[132:135], v[188:191], v[152:155], 0
v_mfma_f32_16x16x32_bf16 v[136:139], v[192:195], v[152:155], 0
ds_read_b64_tr_b16 v[164:165], v27 offset:4096
ds_read_b64_tr_b16 v[166:167], v27 offset:4608
s_waitcnt lgkmcnt(7)
v_mfma_f32_16x16x32_bf16 v[76:79], v[196:199], v[156:159], v[76:79]
s_waitcnt lgkmcnt(6)
v_mfma_f32_16x16x32_bf16 v[80:83], v[200:203], v[156:159], v[80:83]
s_waitcnt lgkmcnt(5)
v_mfma_f32_16x16x32_bf16 v[84:87], v[204:207], v[156:159], v[84:87]
s_waitcnt lgkmcnt(4)
v_mfma_f32_16x16x32_bf16 v[88:91], v[208:211], v[156:159], v[88:91]
ds_read_b64_tr_b16 v[168:169], v28 offset:4096
ds_read_b64_tr_b16 v[170:171], v28 offset:4608
s_waitcnt lgkmcnt(4)
v_mfma_f32_16x16x32_bf16 v[92:95], v[196:199], v[160:163], v[92:95]
v_mfma_f32_16x16x32_bf16 v[96:99], v[200:203], v[160:163], v[96:99]
v_mfma_f32_16x16x32_bf16 v[100:103], v[204:207], v[160:163], v[100:103]
v_mfma_f32_16x16x32_bf16 v[104:107], v[208:211], v[160:163], v[104:107]
ds_read_b128 v[212:215], v31 offset:2048
s_waitcnt vmcnt(4)
ds_read_b64_tr_b16 v[172:173], v25 offset:8192
ds_read_b64_tr_b16 v[174:175], v25 offset:8704
s_waitcnt lgkmcnt(5)
v_mfma_f32_16x16x32_bf16 v[108:111], v[196:199], v[164:167], v[108:111]
ds_read_b128 v[216:219], v31 offset:10240
v_mfma_f32_16x16x32_bf16 v[112:115], v[200:203], v[164:167], v[112:115]
ds_read_b128 v[220:223], v31 offset:18432
v_mfma_f32_16x16x32_bf16 v[116:119], v[204:207], v[164:167], v[116:119]
ds_read_b128 v[224:227], v31 offset:26624
v_mfma_f32_16x16x32_bf16 v[120:123], v[208:211], v[164:167], v[120:123]
ds_read_b64_tr_b16 v[176:177], v26 offset:8192
ds_read_b64_tr_b16 v[178:179], v26 offset:8704
s_waitcnt lgkmcnt(8)
v_mfma_f32_16x16x32_bf16 v[124:127], v[196:199], v[168:171], v[124:127]
s_add_u32 m0, s63, 0x1000
s_nop 0
buffer_load_dwordx4 v17, s[44:47], s70 offen offset:0 lds
buffer_load_dwordx4 v18, s[44:47], s70 offen offset:1024 lds
buffer_load_dwordx4 v19, s[44:47], s70 offen offset:2048 lds
buffer_load_dwordx4 v20, s[44:47], s70 offen offset:3072 lds
v_mfma_f32_16x16x32_bf16 v[128:131], v[200:203], v[168:171], v[128:131]
v_mfma_f32_16x16x32_bf16 v[132:135], v[204:207], v[168:171], v[132:135]
v_mfma_f32_16x16x32_bf16 v[136:139], v[208:211], v[168:171], v[136:139]
ds_read_b64_tr_b16 v[140:141], v27 offset:8192
ds_read_b64_tr_b16 v[142:143], v27 offset:8704
s_waitcnt lgkmcnt(7)
v_mfma_f32_16x16x32_bf16 v[76:79], v[212:215], v[172:175], v[76:79]
s_waitcnt lgkmcnt(6)
v_mfma_f32_16x16x32_bf16 v[80:83], v[216:219], v[172:175], v[80:83]
s_waitcnt lgkmcnt(5)
v_mfma_f32_16x16x32_bf16 v[84:87], v[220:223], v[172:175], v[84:87]
s_waitcnt lgkmcnt(4)
v_mfma_f32_16x16x32_bf16 v[88:91], v[224:227], v[172:175], v[88:91]
ds_read_b64_tr_b16 v[144:145], v28 offset:8192
ds_read_b64_tr_b16 v[146:147], v28 offset:8704
s_waitcnt lgkmcnt(4)
v_mfma_f32_16x16x32_bf16 v[92:95], v[212:215], v[176:179], v[92:95]
v_mfma_f32_16x16x32_bf16 v[96:99], v[216:219], v[176:179], v[96:99]
v_mfma_f32_16x16x32_bf16 v[100:103], v[220:223], v[176:179], v[100:103]
v_mfma_f32_16x16x32_bf16 v[104:107], v[224:227], v[176:179], v[104:107]
ds_read_b128 v[180:183], v32 offset:3072
s_waitcnt vmcnt(4)
ds_read_b64_tr_b16 v[148:149], v25 offset:0
ds_read_b64_tr_b16 v[150:151], v25 offset:512
s_waitcnt lgkmcnt(5)
v_mfma_f32_16x16x32_bf16 v[108:111], v[212:215], v[140:143], v[108:111]
ds_read_b128 v[184:187], v32 offset:11264
v_mfma_f32_16x16x32_bf16 v[112:115], v[216:219], v[140:143], v[112:115]
ds_read_b128 v[188:191], v32 offset:19456
v_mfma_f32_16x16x32_bf16 v[116:119], v[220:223], v[140:143], v[116:119]
ds_read_b128 v[192:195], v32 offset:27648
v_mfma_f32_16x16x32_bf16 v[120:123], v[224:227], v[140:143], v[120:123]
ds_read_b64_tr_b16 v[152:153], v26 offset:0
ds_read_b64_tr_b16 v[154:155], v26 offset:512
s_waitcnt lgkmcnt(8)
v_mfma_f32_16x16x32_bf16 v[124:127], v[212:215], v[144:147], v[124:127]
s_add_u32 m0, s63, 0x2000
s_nop 0
buffer_load_dwordx4 v17, s[44:47], s71 offen offset:0 lds
buffer_load_dwordx4 v18, s[44:47], s71 offen offset:1024 lds
buffer_load_dwordx4 v19, s[44:47], s71 offen offset:2048 lds
buffer_load_dwordx4 v20, s[44:47], s71 offen offset:3072 lds
v_mfma_f32_16x16x32_bf16 v[128:131], v[216:219], v[144:147], v[128:131]
v_mfma_f32_16x16x32_bf16 v[132:135], v[220:223], v[144:147], v[132:135]
v_mfma_f32_16x16x32_bf16 v[136:139], v[224:227], v[144:147], v[136:139]
ds_read_b64_tr_b16 v[156:157], v27 offset:0
ds_read_b64_tr_b16 v[158:159], v27 offset:512
s_waitcnt lgkmcnt(7)
v_mfma_f32_16x16x32_bf16 v[76:79], v[180:183], v[148:151], v[76:79]
s_waitcnt lgkmcnt(6)
v_mfma_f32_16x16x32_bf16 v[80:83], v[184:187], v[148:151], v[80:83]
s_waitcnt lgkmcnt(5)
v_mfma_f32_16x16x32_bf16 v[84:87], v[188:191], v[148:151], v[84:87]
s_waitcnt lgkmcnt(4)
v_mfma_f32_16x16x32_bf16 v[88:91], v[192:195], v[148:151], v[88:91]
ds_read_b64_tr_b16 v[160:161], v28 offset:0
ds_read_b64_tr_b16 v[162:163], v28 offset:512
s_waitcnt lgkmcnt(4)
v_mfma_f32_16x16x32_bf16 v[92:95], v[180:183], v[152:155], v[92:95]
v_mfma_f32_16x16x32_bf16 v[96:99], v[184:187], v[152:155], v[96:99]
v_mfma_f32_16x16x32_bf16 v[100:103], v[188:191], v[152:155], v[100:103]
v_mfma_f32_16x16x32_bf16 v[104:107], v[192:195], v[152:155], v[104:107]
ds_read_b128 v[196:199], v31 offset:4096
s_waitcnt vmcnt(4)
ds_read_b64_tr_b16 v[164:165], v25 offset:4096
ds_read_b64_tr_b16 v[166:167], v25 offset:4608
s_waitcnt lgkmcnt(5)
v_mfma_f32_16x16x32_bf16 v[108:111], v[180:183], v[156:159], v[108:111]
ds_read_b128 v[200:203], v31 offset:12288
v_mfma_f32_16x16x32_bf16 v[112:115], v[184:187], v[156:159], v[112:115]
ds_read_b128 v[204:207], v31 offset:20480
v_mfma_f32_16x16x32_bf16 v[116:119], v[188:191], v[156:159], v[116:119]
ds_read_b128 v[208:211], v31 offset:28672
v_mfma_f32_16x16x32_bf16 v[120:123], v[192:195], v[156:159], v[120:123]
ds_read_b64_tr_b16 v[168:169], v26 offset:4096
ds_read_b64_tr_b16 v[170:171], v26 offset:4608
s_waitcnt lgkmcnt(8)
v_mfma_f32_16x16x32_bf16 v[124:127], v[180:183], v[160:163], v[124:127]
s_add_u32 m0, s63, 0x0
s_nop 0
buffer_load_dwordx4 v17, s[44:47], s72 offen offset:0 lds
buffer_load_dwordx4 v18, s[44:47], s72 offen offset:1024 lds
buffer_load_dwordx4 v19, s[44:47], s72 offen offset:2048 lds
buffer_load_dwordx4 v20, s[44:47], s72 offen offset:3072 lds
v_mfma_f32_16x16x32_bf16 v[128:131], v[184:187], v[160:163], v[128:131]
v_mfma_f32_16x16x32_bf16 v[132:135], v[188:191], v[160:163], v[132:135]
v_mfma_f32_16x16x32_bf16 v[136:139], v[192:195], v[160:163], v[136:139]
ds_read_b64_tr_b16 v[172:173], v27 offset:4096
ds_read_b64_tr_b16 v[174:175], v27 offset:4608
s_waitcnt lgkmcnt(7)
v_mfma_f32_16x16x32_bf16 v[76:79], v[196:199], v[164:167], v[76:79]
s_waitcnt lgkmcnt(6)
v_mfma_f32_16x16x32_bf16 v[80:83], v[200:203], v[164:167], v[80:83]
s_waitcnt lgkmcnt(5)
v_mfma_f32_16x16x32_bf16 v[84:87], v[204:207], v[164:167], v[84:87]
s_waitcnt lgkmcnt(4)
v_mfma_f32_16x16x32_bf16 v[88:91], v[208:211], v[164:167], v[88:91]
ds_read_b64_tr_b16 v[176:177], v28 offset:4096
ds_read_b64_tr_b16 v[178:179], v28 offset:4608
s_waitcnt lgkmcnt(4)
v_mfma_f32_16x16x32_bf16 v[92:95], v[196:199], v[168:171], v[92:95]
v_mfma_f32_16x16x32_bf16 v[96:99], v[200:203], v[168:171], v[96:99]
v_mfma_f32_16x16x32_bf16 v[100:103], v[204:207], v[168:171], v[100:103]
v_mfma_f32_16x16x32_bf16 v[104:107], v[208:211], v[168:171], v[104:107]
ds_read_b128 v[212:215], v32 offset:5120
s_waitcnt vmcnt(4)
ds_read_b64_tr_b16 v[140:141], v25 offset:8192
ds_read_b64_tr_b16 v[142:143], v25 offset:8704
s_waitcnt lgkmcnt(5)
v_mfma_f32_16x16x32_bf16 v[108:111], v[196:199], v[172:175], v[108:111]
ds_read_b128 v[216:219], v32 offset:13312
v_mfma_f32_16x16x32_bf16 v[112:115], v[200:203], v[172:175], v[112:115]
ds_read_b128 v[220:223], v32 offset:21504
v_mfma_f32_16x16x32_bf16 v[116:119], v[204:207], v[172:175], v[116:119]
ds_read_b128 v[224:227], v32 offset:29696
v_mfma_f32_16x16x32_bf16 v[120:123], v[208:211], v[172:175], v[120:123]
ds_read_b64_tr_b16 v[144:145], v26 offset:8192
ds_read_b64_tr_b16 v[146:147], v26 offset:8704
s_waitcnt lgkmcnt(8)
v_mfma_f32_16x16x32_bf16 v[124:127], v[196:199], v[176:179], v[124:127]
s_add_u32 m0, s63, 0x1000
s_nop 0
buffer_load_dwordx4 v17, s[44:47], s73 offen offset:0 lds
buffer_load_dwordx4 v18, s[44:47], s73 offen offset:1024 lds
buffer_load_dwordx4 v19, s[44:47], s73 offen offset:2048 lds
buffer_load_dwordx4 v20, s[44:47], s73 offen offset:3072 lds
v_mfma_f32_16x16x32_bf16 v[128:131], v[200:203], v[176:179], v[128:131]
v_mfma_f32_16x16x32_bf16 v[132:135], v[204:207], v[176:179], v[132:135]
v_mfma_f32_16x16x32_bf16 v[136:139], v[208:211], v[176:179], v[136:139]
ds_read_b64_tr_b16 v[148:149], v27 offset:8192
ds_read_b64_tr_b16 v[150:151], v27 offset:8704
s_waitcnt lgkmcnt(7)
v_mfma_f32_16x16x32_bf16 v[76:79], v[212:215], v[140:143], v[76:79]
s_waitcnt lgkmcnt(6)
v_mfma_f32_16x16x32_bf16 v[80:83], v[216:219], v[140:143], v[80:83]
s_waitcnt lgkmcnt(5)
v_mfma_f32_16x16x32_bf16 v[84:87], v[220:223], v[140:143], v[84:87]
s_waitcnt lgkmcnt(4)
v_mfma_f32_16x16x32_bf16 v[88:91], v[224:227], v[140:143], v[88:91]
ds_read_b64_tr_b16 v[152:153], v28 offset:8192
ds_read_b64_tr_b16 v[154:155], v28 offset:8704
s_waitcnt lgkmcnt(4)
v_mfma_f32_16x16x32_bf16 v[92:95], v[212:215], v[144:147], v[92:95]
v_mfma_f32_16x16x32_bf16 v[96:99], v[216:219], v[144:147], v[96:99]
v_mfma_f32_16x16x32_bf16 v[100:103], v[220:223], v[144:147], v[100:103]
v_mfma_f32_16x16x32_bf16 v[104:107], v[224:227], v[144:147], v[104:107]
ds_read_b128 v[180:183], v31 offset:6144
s_waitcnt vmcnt(4)
ds_read_b64_tr_b16 v[156:157], v25 offset:0
ds_read_b64_tr_b16 v[158:159], v25 offset:512
s_waitcnt lgkmcnt(5)
v_mfma_f32_16x16x32_bf16 v[108:111], v[212:215], v[148:151], v[108:111]
ds_read_b128 v[184:187], v31 offset:14336
v_mfma_f32_16x16x32_bf16 v[112:115], v[216:219], v[148:151], v[112:115]
ds_read_b128 v[188:191], v31 offset:22528
v_mfma_f32_16x16x32_bf16 v[116:119], v[220:223], v[148:151], v[116:119]
ds_read_b128 v[192:195], v31 offset:30720
v_mfma_f32_16x16x32_bf16 v[120:123], v[224:227], v[148:151], v[120:123]
ds_read_b64_tr_b16 v[160:161], v26 offset:0
ds_read_b64_tr_b16 v[162:163], v26 offset:512
s_waitcnt lgkmcnt(8)
v_mfma_f32_16x16x32_bf16 v[124:127], v[212:215], v[152:155], v[124:127]
v_mfma_f32_16x16x32_bf16 v[128:131], v[216:219], v[152:155], v[128:131]
v_mfma_f32_16x16x32_bf16 v[132:135], v[220:223], v[152:155], v[132:135]
v_mfma_f32_16x16x32_bf16 v[136:139], v[224:227], v[152:155], v[136:139]
ds_read_b64_tr_b16 v[164:165], v27 offset:0
ds_read_b64_tr_b16 v[166:167], v27 offset:512
s_waitcnt lgkmcnt(7)
v_mfma_f32_16x16x32_bf16 v[76:79], v[180:183], v[156:159], v[76:79]
s_waitcnt lgkmcnt(6)
v_mfma_f32_16x16x32_bf16 v[80:83], v[184:187], v[156:159], v[80:83]
s_waitcnt lgkmcnt(5)
v_mfma_f32_16x16x32_bf16 v[84:87], v[188:191], v[156:159], v[84:87]
s_waitcnt lgkmcnt(4)
v_mfma_f32_16x16x32_bf16 v[88:91], v[192:195], v[156:159], v[88:91]
ds_read_b64_tr_b16 v[168:169], v28 offset:0
ds_read_b64_tr_b16 v[170:171], v28 offset:512
s_waitcnt lgkmcnt(4)
v_mfma_f32_16x16x32_bf16 v[92:95], v[180:183], v[160:163], v[92:95]
v_mfma_f32_16x16x32_bf16 v[96:99], v[184:187], v[160:163], v[96:99]
v_mfma_f32_16x16x32_bf16 v[100:103], v[188:191], v[160:163], v[100:103]
v_mfma_f32_16x16x32_bf16 v[104:107], v[192:195], v[160:163], v[104:107]
ds_read_b128 v[196:199], v32 offset:7168
s_waitcnt vmcnt(0)
ds_read_b64_tr_b16 v[172:173], v25 offset:4096
ds_read_b64_tr_b16 v[174:175], v25 offset:4608
s_waitcnt lgkmcnt(5)
v_mfma_f32_16x16x32_bf16 v[108:111], v[180:183], v[164:167], v[108:111]
ds_read_b128 v[200:203], v32 offset:15360
v_mfma_f32_16x16x32_bf16 v[112:115], v[184:187], v[164:167], v[112:115]
ds_read_b128 v[204:207], v32 offset:23552
v_mfma_f32_16x16x32_bf16 v[116:119], v[188:191], v[164:167], v[116:119]
ds_read_b128 v[208:211], v32 offset:31744
v_mfma_f32_16x16x32_bf16 v[120:123], v[192:195], v[164:167], v[120:123]
ds_read_b64_tr_b16 v[176:177], v26 offset:4096
ds_read_b64_tr_b16 v[178:179], v26 offset:4608
s_waitcnt lgkmcnt(8)
v_mfma_f32_16x16x32_bf16 v[124:127], v[180:183], v[168:171], v[124:127]
v_mfma_f32_16x16x32_bf16 v[128:131], v[184:187], v[168:171], v[128:131]
v_mfma_f32_16x16x32_bf16 v[132:135], v[188:191], v[168:171], v[132:135]
v_mfma_f32_16x16x32_bf16 v[136:139], v[192:195], v[168:171], v[136:139]
ds_read_b64_tr_b16 v[140:141], v27 offset:4096
ds_read_b64_tr_b16 v[142:143], v27 offset:4608
s_waitcnt lgkmcnt(7)
v_mfma_f32_16x16x32_bf16 v[76:79], v[196:199], v[172:175], v[76:79]
s_waitcnt lgkmcnt(6)
v_mfma_f32_16x16x32_bf16 v[80:83], v[200:203], v[172:175], v[80:83]
s_waitcnt lgkmcnt(5)
v_mfma_f32_16x16x32_bf16 v[84:87], v[204:207], v[172:175], v[84:87]
s_waitcnt lgkmcnt(4)
v_mfma_f32_16x16x32_bf16 v[88:91], v[208:211], v[172:175], v[88:91]
ds_read_b64_tr_b16 v[144:145], v28 offset:4096
ds_read_b64_tr_b16 v[146:147], v28 offset:4608
s_waitcnt lgkmcnt(4)
v_mfma_f32_16x16x32_bf16 v[92:95], v[196:199], v[176:179], v[92:95]
v_cvt_pk_bf16_f32 v76, v76, v77
v_cvt_pk_bf16_f32 v77, v78, v79
v_cvt_pk_bf16_f32 v78, v80, v81
v_cvt_pk_bf16_f32 v79, v82, v83
buffer_store_dwordx4 v[76:79], v16, s[52:55], s82 offen offset:0 sc1
v_mfma_f32_16x16x32_bf16 v[96:99], v[200:203], v[176:179], v[96:99]
v_mfma_f32_16x16x32_bf16 v[100:103], v[204:207], v[176:179], v[100:103]
v_cvt_pk_bf16_f32 v84, v84, v85
v_cvt_pk_bf16_f32 v85, v86, v87
v_cvt_pk_bf16_f32 v86, v88, v89
v_cvt_pk_bf16_f32 v87, v90, v91
buffer_store_dwordx4 v[84:87], v16, s[52:55], s82 offen offset:2048 sc1
v_mfma_f32_16x16x32_bf16 v[104:107], v[208:211], v[176:179], v[104:107]
s_waitcnt lgkmcnt(2)
v_mfma_f32_16x16x32_bf16 v[108:111], v[196:199], v[140:143], v[108:111]
v_cvt_pk_bf16_f32 v92, v92, v93
v_cvt_pk_bf16_f32 v93, v94, v95
v_cvt_pk_bf16_f32 v94, v96, v97
v_cvt_pk_bf16_f32 v95, v98, v99
buffer_store_dwordx4 v[92:95], v16, s[52:55], s82 offen offset:1024 sc1
v_mfma_f32_16x16x32_bf16 v[112:115], v[200:203], v[140:143], v[112:115]
v_mfma_f32_16x16x32_bf16 v[116:119], v[204:207], v[140:143], v[116:119]
v_cvt_pk_bf16_f32 v100, v100, v101
v_cvt_pk_bf16_f32 v101, v102, v103
v_cvt_pk_bf16_f32 v102, v104, v105
v_cvt_pk_bf16_f32 v103, v106, v107
buffer_store_dwordx4 v[100:103], v16, s[52:55], s82 offen offset:3072 sc1
v_mfma_f32_16x16x32_bf16 v[120:123], v[208:211], v[140:143], v[120:123]
s_waitcnt lgkmcnt(0)
v_mfma_f32_16x16x32_bf16 v[124:127], v[196:199], v[144:147], v[124:127]
v_cvt_pk_bf16_f32 v108, v108, v109
v_cvt_pk_bf16_f32 v109, v110, v111
v_cvt_pk_bf16_f32 v110, v112, v113
v_cvt_pk_bf16_f32 v111, v114, v115
buffer_store_dwordx4 v[108:111], v16, s[52:55], s83 offen offset:0 sc1
v_mfma_f32_16x16x32_bf16 v[128:131], v[200:203], v[144:147], v[128:131]
v_mfma_f32_16x16x32_bf16 v[132:135], v[204:207], v[144:147], v[132:135]
v_cvt_pk_bf16_f32 v116, v116, v117
v_cvt_pk_bf16_f32 v117, v118, v119
v_cvt_pk_bf16_f32 v118, v120, v121
v_cvt_pk_bf16_f32 v119, v122, v123
buffer_store_dwordx4 v[116:119], v16, s[52:55], s83 offen offset:2048 sc1
v_mfma_f32_16x16x32_bf16 v[136:139], v[208:211], v[144:147], v[136:139]
v_cvt_pk_bf16_f32 v124, v124, v125
v_cvt_pk_bf16_f32 v125, v126, v127
v_cvt_pk_bf16_f32 v126, v128, v129
v_cvt_pk_bf16_f32 v127, v130, v131
buffer_store_dwordx4 v[124:127], v16, s[52:55], s83 offen offset:1024 sc1
v_cvt_pk_bf16_f32 v132, v132, v133
v_cvt_pk_bf16_f32 v133, v134, v135
s_nop 0
v_cvt_pk_bf16_f32 v134, v136, v137
v_cvt_pk_bf16_f32 v135, v138, v139
buffer_store_dwordx4 v[132:135], v16, s[52:55], s83 offen offset:3072 sc1
s_branch LM_pub
LM_light:
s_mov_b32 s61, 1
s_waitcnt lgkmcnt(0)
s_mov_b32 s98, 0x7c3ff80
s_load_dwordx2 s[98:99], s[38:39], s98
s_branch L1_fin
LM_edge:
s_sub_u32 s4, s3, 30
s_lshl_b32 s8, s8, 1
s_add_u32 s4, s4, s8
s_add_u32 s91, s4, 240
s_cmp_ge_u32 s4, 14
s_cselect_b32 s61, 1, 0
s_mul_i32 s6, s4, 40000
v_lshlrev_b32 v5, 4, v0
v_lshlrev_b32 v6, 2, v2
v_add_u32 v6, 0x10000, v6
v_mov_b32 v7, 0
ds_write_b32 v6, v7
s_mov_b32 s66, 0
s_mov_b32 s67, 4096
s_mov_b32 s68, 8192
s_mov_b32 s69, 12288
s_mov_b32 s70, 16384
s_mov_b32 s71, 20480
s_mov_b32 s72, 24576
s_mov_b32 s73, 28672
s_mov_b32 s74, 32768
s_mov_b32 s75, 36864
s_waitcnt lgkmcnt(0)
s_add_u32 s40, s20, 0x0
s_addc_u32 s41, s21, 0
s_add_u32 s40, s40, s6
s_addc_u32 s41, s41, 0
s_mov_b32 s42, 0x9c40
s_mov_b32 s43, 0x00020000
s_add_u32 s44, s18, 0x0
s_addc_u32 s45, s19, 0
s_add_u32 s44, s44, s6
s_addc_u32 s45, s45, 0
s_mov_b32 s46, 0x9c40
s_mov_b32 s47, 0x00020000
buffer_load_dwordx4 v[16:19], v5, s[40:43], s66 offen
buffer_load_dwordx4 v[20:23], v5, s[40:43], s67 offen
buffer_load_dwordx4 v[24:27], v5, s[40:43], s68 offen
buffer_load_dwordx4 v[28:31], v5, s[40:43], s69 offen
buffer_load_dwordx4 v[32:35], v5, s[40:43], s70 offen
buffer_load_dwordx4 v[36:39], v5, s[40:43], s71 offen
buffer_load_dwordx4 v[40:43], v5, s[40:43], s72 offen
buffer_load_dwordx4 v[44:47], v5, s[40:43], s73 offen
buffer_load_dwordx4 v[48:51], v5, s[40:43], s74 offen
buffer_load_dwordx4 v[52:55], v5, s[40:43], s75 offen
buffer_load_dwordx4 v[56:59], v5, s[44:47], s66 offen
buffer_load_dwordx4 v[60:63], v5, s[44:47], s67 offen
buffer_load_dwordx4 v[64:67], v5, s[44:47], s68 offen
buffer_load_dwordx4 v[68:71], v5, s[44:47], s69 offen
buffer_load_dwordx4 v[72:75], v5, s[44:47], s70 offen
buffer_load_dwordx4 v[76:79], v5, s[44:47], s71 offen
buffer_load_dwordx4 v[80:83], v5, s[44:47], s72 offen
buffer_load_dwordx4 v[84:87], v5, s[44:47], s73 offen
buffer_load_dwordx4 v[88:91], v5, s[44:47], s74 offen
buffer_load_dwordx4 v[92:95], v5, s[44:47], s75 offen
s_mov_b32 s98, 0x7c3ff80
s_load_dwordx2 s[98:99], s[38:39], s98
s_add_u32 s48, s38, 0x8000000
s_addc_u32 s49, s39, 0
s_mov_b32 s50, 0x2800000
s_mov_b32 s51, 0x00020000
s_add_u32 s52, s38, 0x7800000
s_addc_u32 s53, s39, 0
s_mov_b32 s54, 0x1000
s_mov_b32 s55, 0x00020000
v_mov_b32 v240, 6945
v_mov_b32 v241, 0x0
v_mov_b32 v242, 6317
v_mov_b32 v243, 0x340674
v_mov_b32 v244, 6899
v_mov_b32 v245, 0xfffae6a0
v_mov_b32 v246, 6242
v_mov_b32 v247, 0x4484a0
s_mov_b32 s11, 0x10000
v_mov_b32 v7, 1
v_cmp_gt_u32 vcc, 0xc4, v0
s_mov_b64 s[12:13], vcc
s_barrier
s_waitcnt vmcnt(19)
v_cmp_le_u32 vcc, 5436, v16
s_nop 1
v_cndmask_b32 v96, v240, v242, vcc
v_cndmask_b32 v136, v241, v243, vcc
v_cmp_le_u32 vcc, 6432, v16
s_nop 1
v_cndmask_b32 v96, v96, v244, vcc
v_cndmask_b32 v136, v136, v245, vcc
v_cmp_le_u32 vcc, 7344, v16
s_nop 1
v_cndmask_b32 v96, v96, v246, vcc
v_cndmask_b32 v136, v136, v247, vcc
v_mad_u32_u24 v96, v96, v16, v136
v_lshrrev_b32 v96, 20, v96
v_lshl_add_u32 v136, v96, 2, s11
ds_add_rtn_u32 v136, v136, v7
v_cmp_le_u32 vcc, 5436, v17
s_nop 1
v_cndmask_b32 v97, v240, v242, vcc
v_cndmask_b32 v137, v241, v243, vcc
v_cmp_le_u32 vcc, 6432, v17
s_nop 1
v_cndmask_b32 v97, v97, v244, vcc
v_cndmask_b32 v137, v137, v245, vcc
v_cmp_le_u32 vcc, 7344, v17
s_nop 1
v_cndmask_b32 v97, v97, v246, vcc
v_cndmask_b32 v137, v137, v247, vcc
v_mad_u32_u24 v97, v97, v17, v137
v_lshrrev_b32 v97, 20, v97
v_lshl_add_u32 v137, v97, 2, s11
ds_add_rtn_u32 v137, v137, v7
v_cmp_le_u32 vcc, 5436, v18
s_nop 1
v_cndmask_b32 v98, v240, v242, vcc
v_cndmask_b32 v138, v241, v243, vcc
v_cmp_le_u32 vcc, 6432, v18
s_nop 1
v_cndmask_b32 v98, v98, v244, vcc
v_cndmask_b32 v138, v138, v245, vcc
v_cmp_le_u32 vcc, 7344, v18
s_nop 1
v_cndmask_b32 v98, v98, v246, vcc
v_cndmask_b32 v138, v138, v247, vcc
v_mad_u32_u24 v98, v98, v18, v138
v_lshrrev_b32 v98, 20, v98
v_lshl_add_u32 v138, v98, 2, s11
ds_add_rtn_u32 v138, v138, v7
v_cmp_le_u32 vcc, 5436, v19
s_nop 1
v_cndmask_b32 v99, v240, v242, vcc
v_cndmask_b32 v139, v241, v243, vcc
v_cmp_le_u32 vcc, 6432, v19
s_nop 1
v_cndmask_b32 v99, v99, v244, vcc
v_cndmask_b32 v139, v139, v245, vcc
v_cmp_le_u32 vcc, 7344, v19
s_nop 1
v_cndmask_b32 v99, v99, v246, vcc
v_cndmask_b32 v139, v139, v247, vcc
v_mad_u32_u24 v99, v99, v19, v139
v_lshrrev_b32 v99, 20, v99
v_lshl_add_u32 v139, v99, 2, s11
ds_add_rtn_u32 v139, v139, v7
s_waitcnt vmcnt(18)
v_cmp_le_u32 vcc, 5436, v20
s_nop 1
v_cndmask_b32 v100, v240, v242, vcc
v_cndmask_b32 v140, v241, v243, vcc
v_cmp_le_u32 vcc, 6432, v20
s_nop 1
v_cndmask_b32 v100, v100, v244, vcc
v_cndmask_b32 v140, v140, v245, vcc
v_cmp_le_u32 vcc, 7344, v20
s_nop 1
v_cndmask_b32 v100, v100, v246, vcc
v_cndmask_b32 v140, v140, v247, vcc
v_mad_u32_u24 v100, v100, v20, v140
v_lshrrev_b32 v100, 20, v100
v_lshl_add_u32 v140, v100, 2, s11
ds_add_rtn_u32 v140, v140, v7
v_cmp_le_u32 vcc, 5436, v21
s_nop 1
v_cndmask_b32 v101, v240, v242, vcc
v_cndmask_b32 v141, v241, v243, vcc
v_cmp_le_u32 vcc, 6432, v21
s_nop 1
v_cndmask_b32 v101, v101, v244, vcc
v_cndmask_b32 v141, v141, v245, vcc
v_cmp_le_u32 vcc, 7344, v21
s_nop 1
v_cndmask_b32 v101, v101, v246, vcc
v_cndmask_b32 v141, v141, v247, vcc
v_mad_u32_u24 v101, v101, v21, v141
v_lshrrev_b32 v101, 20, v101
v_lshl_add_u32 v141, v101, 2, s11
ds_add_rtn_u32 v141, v141, v7
v_cmp_le_u32 vcc, 5436, v22
s_nop 1
v_cndmask_b32 v102, v240, v242, vcc
v_cndmask_b32 v142, v241, v243, vcc
v_cmp_le_u32 vcc, 6432, v22
s_nop 1
v_cndmask_b32 v102, v102, v244, vcc
v_cndmask_b32 v142, v142, v245, vcc
v_cmp_le_u32 vcc, 7344, v22
s_nop 1
v_cndmask_b32 v102, v102, v246, vcc
v_cndmask_b32 v142, v142, v247, vcc
v_mad_u32_u24 v102, v102, v22, v142
v_lshrrev_b32 v102, 20, v102
v_lshl_add_u32 v142, v102, 2, s11
ds_add_rtn_u32 v142, v142, v7
v_cmp_le_u32 vcc, 5436, v23
s_nop 1
v_cndmask_b32 v103, v240, v242, vcc
v_cndmask_b32 v143, v241, v243, vcc
v_cmp_le_u32 vcc, 6432, v23
s_nop 1
v_cndmask_b32 v103, v103, v244, vcc
v_cndmask_b32 v143, v143, v245, vcc
v_cmp_le_u32 vcc, 7344, v23
s_nop 1
v_cndmask_b32 v103, v103, v246, vcc
v_cndmask_b32 v143, v143, v247, vcc
v_mad_u32_u24 v103, v103, v23, v143
v_lshrrev_b32 v103, 20, v103
v_lshl_add_u32 v143, v103, 2, s11
ds_add_rtn_u32 v143, v143, v7
s_waitcnt vmcnt(17)
v_cmp_le_u32 vcc, 5436, v24
s_nop 1
v_cndmask_b32 v104, v240, v242, vcc
v_cndmask_b32 v144, v241, v243, vcc
v_cmp_le_u32 vcc, 6432, v24
s_nop 1
v_cndmask_b32 v104, v104, v244, vcc
v_cndmask_b32 v144, v144, v245, vcc
v_cmp_le_u32 vcc, 7344, v24
s_nop 1
v_cndmask_b32 v104, v104, v246, vcc
v_cndmask_b32 v144, v144, v247, vcc
v_mad_u32_u24 v104, v104, v24, v144
v_lshrrev_b32 v104, 20, v104
v_lshl_add_u32 v144, v104, 2, s11
ds_add_rtn_u32 v144, v144, v7
v_cmp_le_u32 vcc, 5436, v25
s_nop 1
v_cndmask_b32 v105, v240, v242, vcc
v_cndmask_b32 v145, v241, v243, vcc
v_cmp_le_u32 vcc, 6432, v25
s_nop 1
v_cndmask_b32 v105, v105, v244, vcc
v_cndmask_b32 v145, v145, v245, vcc
v_cmp_le_u32 vcc, 7344, v25
s_nop 1
v_cndmask_b32 v105, v105, v246, vcc
v_cndmask_b32 v145, v145, v247, vcc
v_mad_u32_u24 v105, v105, v25, v145
v_lshrrev_b32 v105, 20, v105
v_lshl_add_u32 v145, v105, 2, s11
ds_add_rtn_u32 v145, v145, v7
v_cmp_le_u32 vcc, 5436, v26
s_nop 1
v_cndmask_b32 v106, v240, v242, vcc
v_cndmask_b32 v146, v241, v243, vcc
v_cmp_le_u32 vcc, 6432, v26
s_nop 1
v_cndmask_b32 v106, v106, v244, vcc
v_cndmask_b32 v146, v146, v245, vcc
v_cmp_le_u32 vcc, 7344, v26
s_nop 1
v_cndmask_b32 v106, v106, v246, vcc
v_cndmask_b32 v146, v146, v247, vcc
v_mad_u32_u24 v106, v106, v26, v146
v_lshrrev_b32 v106, 20, v106
v_lshl_add_u32 v146, v106, 2, s11
ds_add_rtn_u32 v146, v146, v7
v_cmp_le_u32 vcc, 5436, v27
s_nop 1
v_cndmask_b32 v107, v240, v242, vcc
v_cndmask_b32 v147, v241, v243, vcc
v_cmp_le_u32 vcc, 6432, v27
s_nop 1
v_cndmask_b32 v107, v107, v244, vcc
v_cndmask_b32 v147, v147, v245, vcc
v_cmp_le_u32 vcc, 7344, v27
s_nop 1
v_cndmask_b32 v107, v107, v246, vcc
v_cndmask_b32 v147, v147, v247, vcc
v_mad_u32_u24 v107, v107, v27, v147
v_lshrrev_b32 v107, 20, v107
v_lshl_add_u32 v147, v107, 2, s11
ds_add_rtn_u32 v147, v147, v7
s_waitcnt vmcnt(16)
v_cmp_le_u32 vcc, 5436, v28
s_nop 1
v_cndmask_b32 v108, v240, v242, vcc
v_cndmask_b32 v148, v241, v243, vcc
v_cmp_le_u32 vcc, 6432, v28
s_nop 1
v_cndmask_b32 v108, v108, v244, vcc
v_cndmask_b32 v148, v148, v245, vcc
v_cmp_le_u32 vcc, 7344, v28
s_nop 1
v_cndmask_b32 v108, v108, v246, vcc
v_cndmask_b32 v148, v148, v247, vcc
v_mad_u32_u24 v108, v108, v28, v148
v_lshrrev_b32 v108, 20, v108
v_lshl_add_u32 v148, v108, 2, s11
ds_add_rtn_u32 v148, v148, v7
v_cmp_le_u32 vcc, 5436, v29
s_nop 1
v_cndmask_b32 v109, v240, v242, vcc
v_cndmask_b32 v149, v241, v243, vcc
v_cmp_le_u32 vcc, 6432, v29
s_nop 1
v_cndmask_b32 v109, v109, v244, vcc
v_cndmask_b32 v149, v149, v245, vcc
v_cmp_le_u32 vcc, 7344, v29
s_nop 1
v_cndmask_b32 v109, v109, v246, vcc
v_cndmask_b32 v149, v149, v247, vcc
v_mad_u32_u24 v109, v109, v29, v149
v_lshrrev_b32 v109, 20, v109
v_lshl_add_u32 v149, v109, 2, s11
ds_add_rtn_u32 v149, v149, v7
v_cmp_le_u32 vcc, 5436, v30
s_nop 1
v_cndmask_b32 v110, v240, v242, vcc
v_cndmask_b32 v150, v241, v243, vcc
v_cmp_le_u32 vcc, 6432, v30
s_nop 1
v_cndmask_b32 v110, v110, v244, vcc
v_cndmask_b32 v150, v150, v245, vcc
v_cmp_le_u32 vcc, 7344, v30
s_nop 1
v_cndmask_b32 v110, v110, v246, vcc
v_cndmask_b32 v150, v150, v247, vcc
v_mad_u32_u24 v110, v110, v30, v150
v_lshrrev_b32 v110, 20, v110
v_lshl_add_u32 v150, v110, 2, s11
ds_add_rtn_u32 v150, v150, v7
v_cmp_le_u32 vcc, 5436, v31
s_nop 1
v_cndmask_b32 v111, v240, v242, vcc
v_cndmask_b32 v151, v241, v243, vcc
v_cmp_le_u32 vcc, 6432, v31
s_nop 1
v_cndmask_b32 v111, v111, v244, vcc
v_cndmask_b32 v151, v151, v245, vcc
v_cmp_le_u32 vcc, 7344, v31
s_nop 1
v_cndmask_b32 v111, v111, v246, vcc
v_cndmask_b32 v151, v151, v247, vcc
v_mad_u32_u24 v111, v111, v31, v151
v_lshrrev_b32 v111, 20, v111
v_lshl_add_u32 v151, v111, 2, s11
ds_add_rtn_u32 v151, v151, v7
s_waitcnt vmcnt(15)
v_cmp_le_u32 vcc, 5436, v32
s_nop 1
v_cndmask_b32 v112, v240, v242, vcc
v_cndmask_b32 v152, v241, v243, vcc
v_cmp_le_u32 vcc, 6432, v32
s_nop 1
v_cndmask_b32 v112, v112, v244, vcc
v_cndmask_b32 v152, v152, v245, vcc
v_cmp_le_u32 vcc, 7344, v32
s_nop 1
v_cndmask_b32 v112, v112, v246, vcc
v_cndmask_b32 v152, v152, v247, vcc
v_mad_u32_u24 v112, v112, v32, v152
v_lshrrev_b32 v112, 20, v112
v_lshl_add_u32 v152, v112, 2, s11
ds_add_rtn_u32 v152, v152, v7
v_cmp_le_u32 vcc, 5436, v33
s_nop 1
v_cndmask_b32 v113, v240, v242, vcc
v_cndmask_b32 v153, v241, v243, vcc
v_cmp_le_u32 vcc, 6432, v33
s_nop 1
v_cndmask_b32 v113, v113, v244, vcc
v_cndmask_b32 v153, v153, v245, vcc
v_cmp_le_u32 vcc, 7344, v33
s_nop 1
v_cndmask_b32 v113, v113, v246, vcc
v_cndmask_b32 v153, v153, v247, vcc
v_mad_u32_u24 v113, v113, v33, v153
v_lshrrev_b32 v113, 20, v113
v_lshl_add_u32 v153, v113, 2, s11
ds_add_rtn_u32 v153, v153, v7
v_cmp_le_u32 vcc, 5436, v34
s_nop 1
v_cndmask_b32 v114, v240, v242, vcc
v_cndmask_b32 v154, v241, v243, vcc
v_cmp_le_u32 vcc, 6432, v34
s_nop 1
v_cndmask_b32 v114, v114, v244, vcc
v_cndmask_b32 v154, v154, v245, vcc
v_cmp_le_u32 vcc, 7344, v34
s_nop 1
v_cndmask_b32 v114, v114, v246, vcc
v_cndmask_b32 v154, v154, v247, vcc
v_mad_u32_u24 v114, v114, v34, v154
v_lshrrev_b32 v114, 20, v114
v_lshl_add_u32 v154, v114, 2, s11
ds_add_rtn_u32 v154, v154, v7
v_cmp_le_u32 vcc, 5436, v35
s_nop 1
v_cndmask_b32 v115, v240, v242, vcc
v_cndmask_b32 v155, v241, v243, vcc
v_cmp_le_u32 vcc, 6432, v35
s_nop 1
v_cndmask_b32 v115, v115, v244, vcc
v_cndmask_b32 v155, v155, v245, vcc
v_cmp_le_u32 vcc, 7344, v35
s_nop 1
v_cndmask_b32 v115, v115, v246, vcc
v_cndmask_b32 v155, v155, v247, vcc
v_mad_u32_u24 v115, v115, v35, v155
v_lshrrev_b32 v115, 20, v115
v_lshl_add_u32 v155, v115, 2, s11
ds_add_rtn_u32 v155, v155, v7
s_waitcnt vmcnt(14)
v_cmp_le_u32 vcc, 5436, v36
s_nop 1
v_cndmask_b32 v116, v240, v242, vcc
v_cndmask_b32 v156, v241, v243, vcc
v_cmp_le_u32 vcc, 6432, v36
s_nop 1
v_cndmask_b32 v116, v116, v244, vcc
v_cndmask_b32 v156, v156, v245, vcc
v_cmp_le_u32 vcc, 7344, v36
s_nop 1
v_cndmask_b32 v116, v116, v246, vcc
v_cndmask_b32 v156, v156, v247, vcc
v_mad_u32_u24 v116, v116, v36, v156
v_lshrrev_b32 v116, 20, v116
v_lshl_add_u32 v156, v116, 2, s11
ds_add_rtn_u32 v156, v156, v7
v_cmp_le_u32 vcc, 5436, v37
s_nop 1
v_cndmask_b32 v117, v240, v242, vcc
v_cndmask_b32 v157, v241, v243, vcc
v_cmp_le_u32 vcc, 6432, v37
s_nop 1
v_cndmask_b32 v117, v117, v244, vcc
v_cndmask_b32 v157, v157, v245, vcc
v_cmp_le_u32 vcc, 7344, v37
s_nop 1
v_cndmask_b32 v117, v117, v246, vcc
v_cndmask_b32 v157, v157, v247, vcc
v_mad_u32_u24 v117, v117, v37, v157
v_lshrrev_b32 v117, 20, v117
v_lshl_add_u32 v157, v117, 2, s11
ds_add_rtn_u32 v157, v157, v7
v_cmp_le_u32 vcc, 5436, v38
s_nop 1
v_cndmask_b32 v118, v240, v242, vcc
v_cndmask_b32 v158, v241, v243, vcc
v_cmp_le_u32 vcc, 6432, v38
s_nop 1
v_cndmask_b32 v118, v118, v244, vcc
v_cndmask_b32 v158, v158, v245, vcc
v_cmp_le_u32 vcc, 7344, v38
s_nop 1
v_cndmask_b32 v118, v118, v246, vcc
v_cndmask_b32 v158, v158, v247, vcc
v_mad_u32_u24 v118, v118, v38, v158
v_lshrrev_b32 v118, 20, v118
v_lshl_add_u32 v158, v118, 2, s11
ds_add_rtn_u32 v158, v158, v7
v_cmp_le_u32 vcc, 5436, v39
s_nop 1
v_cndmask_b32 v119, v240, v242, vcc
v_cndmask_b32 v159, v241, v243, vcc
v_cmp_le_u32 vcc, 6432, v39
s_nop 1
v_cndmask_b32 v119, v119, v244, vcc
v_cndmask_b32 v159, v159, v245, vcc
v_cmp_le_u32 vcc, 7344, v39
s_nop 1
v_cndmask_b32 v119, v119, v246, vcc
v_cndmask_b32 v159, v159, v247, vcc
v_mad_u32_u24 v119, v119, v39, v159
v_lshrrev_b32 v119, 20, v119
v_lshl_add_u32 v159, v119, 2, s11
ds_add_rtn_u32 v159, v159, v7
s_waitcnt vmcnt(13)
v_cmp_le_u32 vcc, 5436, v40
s_nop 1
v_cndmask_b32 v120, v240, v242, vcc
v_cndmask_b32 v160, v241, v243, vcc
v_cmp_le_u32 vcc, 6432, v40
s_nop 1
v_cndmask_b32 v120, v120, v244, vcc
v_cndmask_b32 v160, v160, v245, vcc
v_cmp_le_u32 vcc, 7344, v40
s_nop 1
v_cndmask_b32 v120, v120, v246, vcc
v_cndmask_b32 v160, v160, v247, vcc
v_mad_u32_u24 v120, v120, v40, v160
v_lshrrev_b32 v120, 20, v120
v_lshl_add_u32 v160, v120, 2, s11
ds_add_rtn_u32 v160, v160, v7
v_cmp_le_u32 vcc, 5436, v41
s_nop 1
v_cndmask_b32 v121, v240, v242, vcc
v_cndmask_b32 v161, v241, v243, vcc
v_cmp_le_u32 vcc, 6432, v41
s_nop 1
v_cndmask_b32 v121, v121, v244, vcc
v_cndmask_b32 v161, v161, v245, vcc
v_cmp_le_u32 vcc, 7344, v41
s_nop 1
v_cndmask_b32 v121, v121, v246, vcc
v_cndmask_b32 v161, v161, v247, vcc
v_mad_u32_u24 v121, v121, v41, v161
v_lshrrev_b32 v121, 20, v121
v_lshl_add_u32 v161, v121, 2, s11
ds_add_rtn_u32 v161, v161, v7
v_cmp_le_u32 vcc, 5436, v42
s_nop 1
v_cndmask_b32 v122, v240, v242, vcc
v_cndmask_b32 v162, v241, v243, vcc
v_cmp_le_u32 vcc, 6432, v42
s_nop 1
v_cndmask_b32 v122, v122, v244, vcc
v_cndmask_b32 v162, v162, v245, vcc
v_cmp_le_u32 vcc, 7344, v42
s_nop 1
v_cndmask_b32 v122, v122, v246, vcc
v_cndmask_b32 v162, v162, v247, vcc
v_mad_u32_u24 v122, v122, v42, v162
v_lshrrev_b32 v122, 20, v122
v_lshl_add_u32 v162, v122, 2, s11
ds_add_rtn_u32 v162, v162, v7
v_cmp_le_u32 vcc, 5436, v43
s_nop 1
v_cndmask_b32 v123, v240, v242, vcc
v_cndmask_b32 v163, v241, v243, vcc
v_cmp_le_u32 vcc, 6432, v43
s_nop 1
v_cndmask_b32 v123, v123, v244, vcc
v_cndmask_b32 v163, v163, v245, vcc
v_cmp_le_u32 vcc, 7344, v43
s_nop 1
v_cndmask_b32 v123, v123, v246, vcc
v_cndmask_b32 v163, v163, v247, vcc
v_mad_u32_u24 v123, v123, v43, v163
v_lshrrev_b32 v123, 20, v123
v_lshl_add_u32 v163, v123, 2, s11
ds_add_rtn_u32 v163, v163, v7
s_waitcnt vmcnt(12)
v_cmp_le_u32 vcc, 5436, v44
s_nop 1
v_cndmask_b32 v124, v240, v242, vcc
v_cndmask_b32 v164, v241, v243, vcc
v_cmp_le_u32 vcc, 6432, v44
s_nop 1
v_cndmask_b32 v124, v124, v244, vcc
v_cndmask_b32 v164, v164, v245, vcc
v_cmp_le_u32 vcc, 7344, v44
s_nop 1
v_cndmask_b32 v124, v124, v246, vcc
v_cndmask_b32 v164, v164, v247, vcc
v_mad_u32_u24 v124, v124, v44, v164
v_lshrrev_b32 v124, 20, v124
v_lshl_add_u32 v164, v124, 2, s11
ds_add_rtn_u32 v164, v164, v7
v_cmp_le_u32 vcc, 5436, v45
s_nop 1
v_cndmask_b32 v125, v240, v242, vcc
v_cndmask_b32 v165, v241, v243, vcc
v_cmp_le_u32 vcc, 6432, v45
s_nop 1
v_cndmask_b32 v125, v125, v244, vcc
v_cndmask_b32 v165, v165, v245, vcc
v_cmp_le_u32 vcc, 7344, v45
s_nop 1
v_cndmask_b32 v125, v125, v246, vcc
v_cndmask_b32 v165, v165, v247, vcc
v_mad_u32_u24 v125, v125, v45, v165
v_lshrrev_b32 v125, 20, v125
v_lshl_add_u32 v165, v125, 2, s11
ds_add_rtn_u32 v165, v165, v7
v_cmp_le_u32 vcc, 5436, v46
s_nop 1
v_cndmask_b32 v126, v240, v242, vcc
v_cndmask_b32 v166, v241, v243, vcc
v_cmp_le_u32 vcc, 6432, v46
s_nop 1
v_cndmask_b32 v126, v126, v244, vcc
v_cndmask_b32 v166, v166, v245, vcc
v_cmp_le_u32 vcc, 7344, v46
s_nop 1
v_cndmask_b32 v126, v126, v246, vcc
v_cndmask_b32 v166, v166, v247, vcc
v_mad_u32_u24 v126, v126, v46, v166
v_lshrrev_b32 v126, 20, v126
v_lshl_add_u32 v166, v126, 2, s11
ds_add_rtn_u32 v166, v166, v7
v_cmp_le_u32 vcc, 5436, v47
s_nop 1
v_cndmask_b32 v127, v240, v242, vcc
v_cndmask_b32 v167, v241, v243, vcc
v_cmp_le_u32 vcc, 6432, v47
s_nop 1
v_cndmask_b32 v127, v127, v244, vcc
v_cndmask_b32 v167, v167, v245, vcc
v_cmp_le_u32 vcc, 7344, v47
s_nop 1
v_cndmask_b32 v127, v127, v246, vcc
v_cndmask_b32 v167, v167, v247, vcc
v_mad_u32_u24 v127, v127, v47, v167
v_lshrrev_b32 v127, 20, v127
v_lshl_add_u32 v167, v127, 2, s11
ds_add_rtn_u32 v167, v167, v7
s_waitcnt vmcnt(11)
v_cmp_le_u32 vcc, 5436, v48
s_nop 1
v_cndmask_b32 v128, v240, v242, vcc
v_cndmask_b32 v168, v241, v243, vcc
v_cmp_le_u32 vcc, 6432, v48
s_nop 1
v_cndmask_b32 v128, v128, v244, vcc
v_cndmask_b32 v168, v168, v245, vcc
v_cmp_le_u32 vcc, 7344, v48
s_nop 1
v_cndmask_b32 v128, v128, v246, vcc
v_cndmask_b32 v168, v168, v247, vcc
v_mad_u32_u24 v128, v128, v48, v168
v_lshrrev_b32 v128, 20, v128
v_lshl_add_u32 v168, v128, 2, s11
ds_add_rtn_u32 v168, v168, v7
v_cmp_le_u32 vcc, 5436, v49
s_nop 1
v_cndmask_b32 v129, v240, v242, vcc
v_cndmask_b32 v169, v241, v243, vcc
v_cmp_le_u32 vcc, 6432, v49
s_nop 1
v_cndmask_b32 v129, v129, v244, vcc
v_cndmask_b32 v169, v169, v245, vcc
v_cmp_le_u32 vcc, 7344, v49
s_nop 1
v_cndmask_b32 v129, v129, v246, vcc
v_cndmask_b32 v169, v169, v247, vcc
v_mad_u32_u24 v129, v129, v49, v169
v_lshrrev_b32 v129, 20, v129
v_lshl_add_u32 v169, v129, 2, s11
ds_add_rtn_u32 v169, v169, v7
v_cmp_le_u32 vcc, 5436, v50
s_nop 1
v_cndmask_b32 v130, v240, v242, vcc
v_cndmask_b32 v170, v241, v243, vcc
v_cmp_le_u32 vcc, 6432, v50
s_nop 1
v_cndmask_b32 v130, v130, v244, vcc
v_cndmask_b32 v170, v170, v245, vcc
v_cmp_le_u32 vcc, 7344, v50
s_nop 1
v_cndmask_b32 v130, v130, v246, vcc
v_cndmask_b32 v170, v170, v247, vcc
v_mad_u32_u24 v130, v130, v50, v170
v_lshrrev_b32 v130, 20, v130
v_lshl_add_u32 v170, v130, 2, s11
ds_add_rtn_u32 v170, v170, v7
v_cmp_le_u32 vcc, 5436, v51
s_nop 1
v_cndmask_b32 v131, v240, v242, vcc
v_cndmask_b32 v171, v241, v243, vcc
v_cmp_le_u32 vcc, 6432, v51
s_nop 1
v_cndmask_b32 v131, v131, v244, vcc
v_cndmask_b32 v171, v171, v245, vcc
v_cmp_le_u32 vcc, 7344, v51
s_nop 1
v_cndmask_b32 v131, v131, v246, vcc
v_cndmask_b32 v171, v171, v247, vcc
v_mad_u32_u24 v131, v131, v51, v171
v_lshrrev_b32 v131, 20, v131
v_lshl_add_u32 v171, v131, 2, s11
ds_add_rtn_u32 v171, v171, v7
s_waitcnt vmcnt(10)
s_mov_b64 exec, s[12:13]
v_cmp_le_u32 vcc, 5436, v52
s_nop 1
v_cndmask_b32 v132, v240, v242, vcc
v_cndmask_b32 v172, v241, v243, vcc
v_cmp_le_u32 vcc, 6432, v52
s_nop 1
v_cndmask_b32 v132, v132, v244, vcc
v_cndmask_b32 v172, v172, v245, vcc
v_cmp_le_u32 vcc, 7344, v52
s_nop 1
v_cndmask_b32 v132, v132, v246, vcc
v_cndmask_b32 v172, v172, v247, vcc
v_mad_u32_u24 v132, v132, v52, v172
v_lshrrev_b32 v132, 20, v132
v_lshl_add_u32 v172, v132, 2, s11
ds_add_rtn_u32 v172, v172, v7
v_cmp_le_u32 vcc, 5436, v53
s_nop 1
v_cndmask_b32 v133, v240, v242, vcc
v_cndmask_b32 v173, v241, v243, vcc
v_cmp_le_u32 vcc, 6432, v53
s_nop 1
v_cndmask_b32 v133, v133, v244, vcc
v_cndmask_b32 v173, v173, v245, vcc
v_cmp_le_u32 vcc, 7344, v53
s_nop 1
v_cndmask_b32 v133, v133, v246, vcc
v_cndmask_b32 v173, v173, v247, vcc
v_mad_u32_u24 v133, v133, v53, v173
v_lshrrev_b32 v133, 20, v133
v_lshl_add_u32 v173, v133, 2, s11
ds_add_rtn_u32 v173, v173, v7
v_cmp_le_u32 vcc, 5436, v54
s_nop 1
v_cndmask_b32 v134, v240, v242, vcc
v_cndmask_b32 v174, v241, v243, vcc
v_cmp_le_u32 vcc, 6432, v54
s_nop 1
v_cndmask_b32 v134, v134, v244, vcc
v_cndmask_b32 v174, v174, v245, vcc
v_cmp_le_u32 vcc, 7344, v54
s_nop 1
v_cndmask_b32 v134, v134, v246, vcc
v_cndmask_b32 v174, v174, v247, vcc
v_mad_u32_u24 v134, v134, v54, v174
v_lshrrev_b32 v134, 20, v134
v_lshl_add_u32 v174, v134, 2, s11
ds_add_rtn_u32 v174, v174, v7
v_cmp_le_u32 vcc, 5436, v55
s_nop 1
v_cndmask_b32 v135, v240, v242, vcc
v_cndmask_b32 v175, v241, v243, vcc
v_cmp_le_u32 vcc, 6432, v55
s_nop 1
v_cndmask_b32 v135, v135, v244, vcc
v_cndmask_b32 v175, v175, v245, vcc
v_cmp_le_u32 vcc, 7344, v55
s_nop 1
v_cndmask_b32 v135, v135, v246, vcc
v_cndmask_b32 v175, v175, v247, vcc
v_mad_u32_u24 v135, v135, v55, v175
v_lshrrev_b32 v135, 20, v135
v_lshl_add_u32 v175, v135, 2, s11
ds_add_rtn_u32 v175, v175, v7
s_mov_b64 exec, -1
s_waitcnt vmcnt(9) lgkmcnt(15)
v_and_b32 v8, 0xff, v136
v_lshl_or_b32 v56, v16, 18, v56
v_lshlrev_b32 v8, 2, v8
v_lshl_add_u32 v8, v96, 10, v8
ds_write_b32 v8, v56
v_and_b32 v8, 0xff, v137
v_lshl_or_b32 v57, v17, 18, v57
v_lshlrev_b32 v8, 2, v8
v_lshl_add_u32 v8, v97, 10, v8
ds_write_b32 v8, v57
v_and_b32 v8, 0xff, v138
v_lshl_or_b32 v58, v18, 18, v58
v_lshlrev_b32 v8, 2, v8
v_lshl_add_u32 v8, v98, 10, v8
ds_write_b32 v8, v58
v_and_b32 v8, 0xff, v139
v_lshl_or_b32 v59, v19, 18, v59
v_lshlrev_b32 v8, 2, v8
v_lshl_add_u32 v8, v99, 10, v8
ds_write_b32 v8, v59
s_waitcnt vmcnt(8) lgkmcnt(15)
v_and_b32 v8, 0xff, v140
v_lshl_or_b32 v60, v20, 18, v60
v_lshlrev_b32 v8, 2, v8
v_lshl_add_u32 v8, v100, 10, v8
ds_write_b32 v8, v60
v_and_b32 v8, 0xff, v141
v_lshl_or_b32 v61, v21, 18, v61
v_lshlrev_b32 v8, 2, v8
v_lshl_add_u32 v8, v101, 10, v8
ds_write_b32 v8, v61
v_and_b32 v8, 0xff, v142
v_lshl_or_b32 v62, v22, 18, v62
v_lshlrev_b32 v8, 2, v8
v_lshl_add_u32 v8, v102, 10, v8
ds_write_b32 v8, v62
v_and_b32 v8, 0xff, v143
v_lshl_or_b32 v63, v23, 18, v63
v_lshlrev_b32 v8, 2, v8
v_lshl_add_u32 v8, v103, 10, v8
ds_write_b32 v8, v63
s_waitcnt vmcnt(7) lgkmcnt(15)
v_and_b32 v8, 0xff, v144
v_lshl_or_b32 v64, v24, 18, v64
v_lshlrev_b32 v8, 2, v8
v_lshl_add_u32 v8, v104, 10, v8
ds_write_b32 v8, v64
v_and_b32 v8, 0xff, v145
v_lshl_or_b32 v65, v25, 18, v65
v_lshlrev_b32 v8, 2, v8
v_lshl_add_u32 v8, v105, 10, v8
ds_write_b32 v8, v65
v_and_b32 v8, 0xff, v146
v_lshl_or_b32 v66, v26, 18, v66
v_lshlrev_b32 v8, 2, v8
v_lshl_add_u32 v8, v106, 10, v8
ds_write_b32 v8, v66
v_and_b32 v8, 0xff, v147
v_lshl_or_b32 v67, v27, 18, v67
v_lshlrev_b32 v8, 2, v8
v_lshl_add_u32 v8, v107, 10, v8
ds_write_b32 v8, v67
s_waitcnt vmcnt(6) lgkmcnt(15)
v_and_b32 v8, 0xff, v148
v_lshl_or_b32 v68, v28, 18, v68
v_lshlrev_b32 v8, 2, v8
v_lshl_add_u32 v8, v108, 10, v8
ds_write_b32 v8, v68
v_and_b32 v8, 0xff, v149
v_lshl_or_b32 v69, v29, 18, v69
v_lshlrev_b32 v8, 2, v8
v_lshl_add_u32 v8, v109, 10, v8
ds_write_b32 v8, v69
v_and_b32 v8, 0xff, v150
v_lshl_or_b32 v70, v30, 18, v70
v_lshlrev_b32 v8, 2, v8
v_lshl_add_u32 v8, v110, 10, v8
ds_write_b32 v8, v70
v_and_b32 v8, 0xff, v151
v_lshl_or_b32 v71, v31, 18, v71
v_lshlrev_b32 v8, 2, v8
v_lshl_add_u32 v8, v111, 10, v8
ds_write_b32 v8, v71
s_waitcnt vmcnt(5) lgkmcnt(15)
v_and_b32 v8, 0xff, v152
v_lshl_or_b32 v72, v32, 18, v72
v_lshlrev_b32 v8, 2, v8
v_lshl_add_u32 v8, v112, 10, v8
ds_write_b32 v8, v72
v_and_b32 v8, 0xff, v153
v_lshl_or_b32 v73, v33, 18, v73
v_lshlrev_b32 v8, 2, v8
v_lshl_add_u32 v8, v113, 10, v8
ds_write_b32 v8, v73
v_and_b32 v8, 0xff, v154
v_lshl_or_b32 v74, v34, 18, v74
v_lshlrev_b32 v8, 2, v8
v_lshl_add_u32 v8, v114, 10, v8
ds_write_b32 v8, v74
v_and_b32 v8, 0xff, v155
v_lshl_or_b32 v75, v35, 18, v75
v_lshlrev_b32 v8, 2, v8
v_lshl_add_u32 v8, v115, 10, v8
ds_write_b32 v8, v75
s_waitcnt vmcnt(4) lgkmcnt(15)
v_and_b32 v8, 0xff, v156
v_lshl_or_b32 v76, v36, 18, v76
v_lshlrev_b32 v8, 2, v8
v_lshl_add_u32 v8, v116, 10, v8
ds_write_b32 v8, v76
v_and_b32 v8, 0xff, v157
v_lshl_or_b32 v77, v37, 18, v77
v_lshlrev_b32 v8, 2, v8
v_lshl_add_u32 v8, v117, 10, v8
ds_write_b32 v8, v77
v_and_b32 v8, 0xff, v158
v_lshl_or_b32 v78, v38, 18, v78
v_lshlrev_b32 v8, 2, v8
v_lshl_add_u32 v8, v118, 10, v8
ds_write_b32 v8, v78
v_and_b32 v8, 0xff, v159
v_lshl_or_b32 v79, v39, 18, v79
v_lshlrev_b32 v8, 2, v8
v_lshl_add_u32 v8, v119, 10, v8
ds_write_b32 v8, v79
s_waitcnt vmcnt(3) lgkmcnt(15)
v_and_b32 v8, 0xff, v160
v_lshl_or_b32 v80, v40, 18, v80
v_lshlrev_b32 v8, 2, v8
v_lshl_add_u32 v8, v120, 10, v8
ds_write_b32 v8, v80
v_and_b32 v8, 0xff, v161
v_lshl_or_b32 v81, v41, 18, v81
v_lshlrev_b32 v8, 2, v8
v_lshl_add_u32 v8, v121, 10, v8
ds_write_b32 v8, v81
v_and_b32 v8, 0xff, v162
v_lshl_or_b32 v82, v42, 18, v82
v_lshlrev_b32 v8, 2, v8
v_lshl_add_u32 v8, v122, 10, v8
ds_write_b32 v8, v82
v_and_b32 v8, 0xff, v163
v_lshl_or_b32 v83, v43, 18, v83
v_lshlrev_b32 v8, 2, v8
v_lshl_add_u32 v8, v123, 10, v8
ds_write_b32 v8, v83
s_waitcnt vmcnt(2) lgkmcnt(15)
v_and_b32 v8, 0xff, v164
v_lshl_or_b32 v84, v44, 18, v84
v_lshlrev_b32 v8, 2, v8
v_lshl_add_u32 v8, v124, 10, v8
ds_write_b32 v8, v84
v_and_b32 v8, 0xff, v165
v_lshl_or_b32 v85, v45, 18, v85
v_lshlrev_b32 v8, 2, v8
v_lshl_add_u32 v8, v125, 10, v8
ds_write_b32 v8, v85
v_and_b32 v8, 0xff, v166
v_lshl_or_b32 v86, v46, 18, v86
v_lshlrev_b32 v8, 2, v8
v_lshl_add_u32 v8, v126, 10, v8
ds_write_b32 v8, v86
v_and_b32 v8, 0xff, v167
v_lshl_or_b32 v87, v47, 18, v87
v_lshlrev_b32 v8, 2, v8
v_lshl_add_u32 v8, v127, 10, v8
ds_write_b32 v8, v87
s_waitcnt vmcnt(1) lgkmcnt(15)
v_and_b32 v8, 0xff, v168
v_lshl_or_b32 v88, v48, 18, v88
v_lshlrev_b32 v8, 2, v8
v_lshl_add_u32 v8, v128, 10, v8
ds_write_b32 v8, v88
v_and_b32 v8, 0xff, v169
v_lshl_or_b32 v89, v49, 18, v89
v_lshlrev_b32 v8, 2, v8
v_lshl_add_u32 v8, v129, 10, v8
ds_write_b32 v8, v89
v_and_b32 v8, 0xff, v170
v_lshl_or_b32 v90, v50, 18, v90
v_lshlrev_b32 v8, 2, v8
v_lshl_add_u32 v8, v130, 10, v8
ds_write_b32 v8, v90
v_and_b32 v8, 0xff, v171
v_lshl_or_b32 v91, v51, 18, v91
v_lshlrev_b32 v8, 2, v8
v_lshl_add_u32 v8, v131, 10, v8
ds_write_b32 v8, v91
s_waitcnt vmcnt(0) lgkmcnt(15)
s_mov_b64 exec, s[12:13]
v_and_b32 v8, 0xff, v172
v_lshl_or_b32 v92, v52, 18, v92
v_lshlrev_b32 v8, 2, v8
v_lshl_add_u32 v8, v132, 10, v8
ds_write_b32 v8, v92
v_and_b32 v8, 0xff, v173
v_lshl_or_b32 v93, v53, 18, v93
v_lshlrev_b32 v8, 2, v8
v_lshl_add_u32 v8, v133, 10, v8
ds_write_b32 v8, v93
v_and_b32 v8, 0xff, v174
v_lshl_or_b32 v94, v54, 18, v94
v_lshlrev_b32 v8, 2, v8
v_lshl_add_u32 v8, v134, 10, v8
ds_write_b32 v8, v94
v_and_b32 v8, 0xff, v175
v_lshl_or_b32 v95, v55, 18, v95
v_lshlrev_b32 v8, 2, v8
v_lshl_add_u32 v8, v135, 10, v8
ds_write_b32 v8, v95
s_mov_b64 exec, -1
s_waitcnt lgkmcnt(0)
s_barrier
ds_read_b32 v8, v6
s_mul_i32 s6, s60, 16384
v_lshlrev_b32 v10, 4, v2
v_add_u32 v9, s6, v10
ds_read_b128 v[176:179], v9 offset:0
ds_read_b128 v[180:183], v9 offset:1024
ds_read_b128 v[184:187], v9 offset:2048
ds_read_b128 v[188:191], v9 offset:3072
ds_read_b128 v[192:195], v9 offset:4096
ds_read_b128 v[196:199], v9 offset:5120
ds_read_b128 v[200:203], v9 offset:6144
ds_read_b128 v[204:207], v9 offset:7168
ds_read_b128 v[208:211], v9 offset:8192
ds_read_b128 v[212:215], v9 offset:9216
ds_read_b128 v[216:219], v9 offset:10240
ds_read_b128 v[220:223], v9 offset:11264
ds_read_b128 v[224:227], v9 offset:12288
ds_read_b128 v[228:231], v9 offset:13312
ds_read_b128 v[232:235], v9 offset:14336
ds_read_b128 v[236:239], v9 offset:15360
s_mul_i32 s6, s60, 262144
s_mul_i32 s7, s4, 1024
s_add_u32 s6, s6, s7
v_lshlrev_b32 v9, 6, v2
s_lshl_b32 s8, s4, 2
s_cmp_eq_u32 s60, 0
s_cselect_b32 s8, s8, 0x7fff0000
s_waitcnt lgkmcnt(15)
buffer_store_dword v8, v9, s[52:55], s8 offen sc1
v_cmp_lt_u32 vcc, 0x100, v8
s_cbranch_vccnz L1_eslow
s_waitcnt lgkmcnt(15)
buffer_store_dwordx4 v[176:179], v10, s[48:51], s6 offen sc1
s_add_u32 s6, s6, 16384
s_waitcnt lgkmcnt(14)
buffer_store_dwordx4 v[180:183], v10, s[48:51], s6 offen sc1
s_add_u32 s6, s6, 16384
s_waitcnt lgkmcnt(13)
buffer_store_dwordx4 v[184:187], v10, s[48:51], s6 offen sc1
s_add_u32 s6, s6, 16384
s_waitcnt lgkmcnt(12)
buffer_store_dwordx4 v[188:191], v10, s[48:51], s6 offen sc1
s_add_u32 s6, s6, 16384
s_waitcnt lgkmcnt(11)
buffer_store_dwordx4 v[192:195], v10, s[48:51], s6 offen sc1
s_add_u32 s6, s6, 16384
s_waitcnt lgkmcnt(10)
buffer_store_dwordx4 v[196:199], v10, s[48:51], s6 offen sc1
s_add_u32 s6, s6, 16384
s_waitcnt lgkmcnt(9)
buffer_store_dwordx4 v[200:203], v10, s[48:51], s6 offen sc1
s_add_u32 s6, s6, 16384
s_waitcnt lgkmcnt(8)
buffer_store_dwordx4 v[204:207], v10, s[48:51], s6 offen sc1
s_add_u32 s6, s6, 16384
s_waitcnt lgkmcnt(7)
buffer_store_dwordx4 v[208:211], v10, s[48:51], s6 offen sc1
s_add_u32 s6, s6, 16384
s_waitcnt lgkmcnt(6)
buffer_store_dwordx4 v[212:215], v10, s[48:51], s6 offen sc1
s_add_u32 s6, s6, 16384
s_waitcnt lgkmcnt(5)
buffer_store_dwordx4 v[216:219], v10, s[48:51], s6 offen sc1
s_add_u32 s6, s6, 16384
s_waitcnt lgkmcnt(4)
buffer_store_dwordx4 v[220:223], v10, s[48:51], s6 offen sc1
s_add_u32 s6, s6, 16384
s_waitcnt lgkmcnt(3)
buffer_store_dwordx4 v[224:227], v10, s[48:51], s6 offen sc1
s_add_u32 s6, s6, 16384
s_waitcnt lgkmcnt(2)
buffer_store_dwordx4 v[228:231], v10, s[48:51], s6 offen sc1
s_add_u32 s6, s6, 16384
s_waitcnt lgkmcnt(1)
buffer_store_dwordx4 v[232:235], v10, s[48:51], s6 offen sc1
s_add_u32 s6, s6, 16384
s_waitcnt lgkmcnt(0)
buffer_store_dwordx4 v[236:239], v10, s[48:51], s6 offen sc1
s_add_u32 s6, s6, 16384
s_branch L1_fin
L1_eslow:
s_mov_b32 s9, 16384
v_mul_u32_u24 v96, s9, v96
v_and_b32 v8, 255, v136
v_lshl_add_u32 v96, v8, 2, v96
v_lshrrev_b32 v8, 8, v136
v_lshl_add_u32 v96, v8, 20, v96
v_mul_u32_u24 v97, s9, v97
v_and_b32 v8, 255, v137
v_lshl_add_u32 v97, v8, 2, v97
v_lshrrev_b32 v8, 8, v137
v_lshl_add_u32 v97, v8, 20, v97
v_mul_u32_u24 v98, s9, v98
v_and_b32 v8, 255, v138
v_lshl_add_u32 v98, v8, 2, v98
v_lshrrev_b32 v8, 8, v138
v_lshl_add_u32 v98, v8, 20, v98
v_mul_u32_u24 v99, s9, v99
v_and_b32 v8, 255, v139
v_lshl_add_u32 v99, v8, 2, v99
v_lshrrev_b32 v8, 8, v139
v_lshl_add_u32 v99, v8, 20, v99
v_mul_u32_u24 v100, s9, v100
v_and_b32 v8, 255, v140
v_lshl_add_u32 v100, v8, 2, v100
v_lshrrev_b32 v8, 8, v140
v_lshl_add_u32 v100, v8, 20, v100
v_mul_u32_u24 v101, s9, v101
v_and_b32 v8, 255, v141
v_lshl_add_u32 v101, v8, 2, v101
v_lshrrev_b32 v8, 8, v141
v_lshl_add_u32 v101, v8, 20, v101
v_mul_u32_u24 v102, s9, v102
v_and_b32 v8, 255, v142
v_lshl_add_u32 v102, v8, 2, v102
v_lshrrev_b32 v8, 8, v142
v_lshl_add_u32 v102, v8, 20, v102
v_mul_u32_u24 v103, s9, v103
v_and_b32 v8, 255, v143
v_lshl_add_u32 v103, v8, 2, v103
v_lshrrev_b32 v8, 8, v143
v_lshl_add_u32 v103, v8, 20, v103
v_mul_u32_u24 v104, s9, v104
v_and_b32 v8, 255, v144
v_lshl_add_u32 v104, v8, 2, v104
v_lshrrev_b32 v8, 8, v144
v_lshl_add_u32 v104, v8, 20, v104
v_mul_u32_u24 v105, s9, v105
v_and_b32 v8, 255, v145
v_lshl_add_u32 v105, v8, 2, v105
v_lshrrev_b32 v8, 8, v145
v_lshl_add_u32 v105, v8, 20, v105
v_mul_u32_u24 v106, s9, v106
v_and_b32 v8, 255, v146
v_lshl_add_u32 v106, v8, 2, v106
v_lshrrev_b32 v8, 8, v146
v_lshl_add_u32 v106, v8, 20, v106
v_mul_u32_u24 v107, s9, v107
v_and_b32 v8, 255, v147
v_lshl_add_u32 v107, v8, 2, v107
v_lshrrev_b32 v8, 8, v147
v_lshl_add_u32 v107, v8, 20, v107
v_mul_u32_u24 v108, s9, v108
v_and_b32 v8, 255, v148
v_lshl_add_u32 v108, v8, 2, v108
v_lshrrev_b32 v8, 8, v148
v_lshl_add_u32 v108, v8, 20, v108
v_mul_u32_u24 v109, s9, v109
v_and_b32 v8, 255, v149
v_lshl_add_u32 v109, v8, 2, v109
v_lshrrev_b32 v8, 8, v149
v_lshl_add_u32 v109, v8, 20, v109
v_mul_u32_u24 v110, s9, v110
v_and_b32 v8, 255, v150
v_lshl_add_u32 v110, v8, 2, v110
v_lshrrev_b32 v8, 8, v150
v_lshl_add_u32 v110, v8, 20, v110
v_mul_u32_u24 v111, s9, v111
v_and_b32 v8, 255, v151
v_lshl_add_u32 v111, v8, 2, v111
v_lshrrev_b32 v8, 8, v151
v_lshl_add_u32 v111, v8, 20, v111
v_mul_u32_u24 v112, s9, v112
v_and_b32 v8, 255, v152
v_lshl_add_u32 v112, v8, 2, v112
v_lshrrev_b32 v8, 8, v152
v_lshl_add_u32 v112, v8, 20, v112
v_mul_u32_u24 v113, s9, v113
v_and_b32 v8, 255, v153
v_lshl_add_u32 v113, v8, 2, v113
v_lshrrev_b32 v8, 8, v153
v_lshl_add_u32 v113, v8, 20, v113
v_mul_u32_u24 v114, s9, v114
v_and_b32 v8, 255, v154
v_lshl_add_u32 v114, v8, 2, v114
v_lshrrev_b32 v8, 8, v154
v_lshl_add_u32 v114, v8, 20, v114
v_mul_u32_u24 v115, s9, v115
v_and_b32 v8, 255, v155
v_lshl_add_u32 v115, v8, 2, v115
v_lshrrev_b32 v8, 8, v155
v_lshl_add_u32 v115, v8, 20, v115
v_mul_u32_u24 v116, s9, v116
v_and_b32 v8, 255, v156
v_lshl_add_u32 v116, v8, 2, v116
v_lshrrev_b32 v8, 8, v156
v_lshl_add_u32 v116, v8, 20, v116
v_mul_u32_u24 v117, s9, v117
v_and_b32 v8, 255, v157
v_lshl_add_u32 v117, v8, 2, v117
v_lshrrev_b32 v8, 8, v157
v_lshl_add_u32 v117, v8, 20, v117
v_mul_u32_u24 v118, s9, v118
v_and_b32 v8, 255, v158
v_lshl_add_u32 v118, v8, 2, v118
v_lshrrev_b32 v8, 8, v158
v_lshl_add_u32 v118, v8, 20, v118
v_mul_u32_u24 v119, s9, v119
v_and_b32 v8, 255, v159
v_lshl_add_u32 v119, v8, 2, v119
v_lshrrev_b32 v8, 8, v159
v_lshl_add_u32 v119, v8, 20, v119
v_mul_u32_u24 v120, s9, v120
v_and_b32 v8, 255, v160
v_lshl_add_u32 v120, v8, 2, v120
v_lshrrev_b32 v8, 8, v160
v_lshl_add_u32 v120, v8, 20, v120
v_mul_u32_u24 v121, s9, v121
v_and_b32 v8, 255, v161
v_lshl_add_u32 v121, v8, 2, v121
v_lshrrev_b32 v8, 8, v161
v_lshl_add_u32 v121, v8, 20, v121
v_mul_u32_u24 v122, s9, v122
v_and_b32 v8, 255, v162
v_lshl_add_u32 v122, v8, 2, v122
v_lshrrev_b32 v8, 8, v162
v_lshl_add_u32 v122, v8, 20, v122
v_mul_u32_u24 v123, s9, v123
v_and_b32 v8, 255, v163
v_lshl_add_u32 v123, v8, 2, v123
v_lshrrev_b32 v8, 8, v163
v_lshl_add_u32 v123, v8, 20, v123
v_mul_u32_u24 v124, s9, v124
v_and_b32 v8, 255, v164
v_lshl_add_u32 v124, v8, 2, v124
v_lshrrev_b32 v8, 8, v164
v_lshl_add_u32 v124, v8, 20, v124
v_mul_u32_u24 v125, s9, v125
v_and_b32 v8, 255, v165
v_lshl_add_u32 v125, v8, 2, v125
v_lshrrev_b32 v8, 8, v165
v_lshl_add_u32 v125, v8, 20, v125
v_mul_u32_u24 v126, s9, v126
v_and_b32 v8, 255, v166
v_lshl_add_u32 v126, v8, 2, v126
v_lshrrev_b32 v8, 8, v166
v_lshl_add_u32 v126, v8, 20, v126
v_mul_u32_u24 v127, s9, v127
v_and_b32 v8, 255, v167
v_lshl_add_u32 v127, v8, 2, v127
v_lshrrev_b32 v8, 8, v167
v_lshl_add_u32 v127, v8, 20, v127
v_mul_u32_u24 v128, s9, v128
v_and_b32 v8, 255, v168
v_lshl_add_u32 v128, v8, 2, v128
v_lshrrev_b32 v8, 8, v168
v_lshl_add_u32 v128, v8, 20, v128
v_mul_u32_u24 v129, s9, v129
v_and_b32 v8, 255, v169
v_lshl_add_u32 v129, v8, 2, v129
v_lshrrev_b32 v8, 8, v169
v_lshl_add_u32 v129, v8, 20, v129
v_mul_u32_u24 v130, s9, v130
v_and_b32 v8, 255, v170
v_lshl_add_u32 v130, v8, 2, v130
v_lshrrev_b32 v8, 8, v170
v_lshl_add_u32 v130, v8, 20, v130
v_mul_u32_u24 v131, s9, v131
v_and_b32 v8, 255, v171
v_lshl_add_u32 v131, v8, 2, v131
v_lshrrev_b32 v8, 8, v171
v_lshl_add_u32 v131, v8, 20, v131
v_mul_u32_u24 v132, s9, v132
v_and_b32 v8, 255, v172
v_lshl_add_u32 v132, v8, 2, v132
v_lshrrev_b32 v8, 8, v172
v_lshl_add_u32 v132, v8, 20, v132
v_mul_u32_u24 v133, s9, v133
v_and_b32 v8, 255, v173
v_lshl_add_u32 v133, v8, 2, v133
v_lshrrev_b32 v8, 8, v173
v_lshl_add_u32 v133, v8, 20, v133
v_mul_u32_u24 v134, s9, v134
v_and_b32 v8, 255, v174
v_lshl_add_u32 v134, v8, 2, v134
v_lshrrev_b32 v8, 8, v174
v_lshl_add_u32 v134, v8, 20, v134
v_mul_u32_u24 v135, s9, v135
v_and_b32 v8, 255, v175
v_lshl_add_u32 v135, v8, 2, v135
v_lshrrev_b32 v8, 8, v175
v_lshl_add_u32 v135, v8, 20, v135
buffer_store_dword v56, v96, s[48:51], s7 offen sc1
buffer_store_dword v57, v97, s[48:51], s7 offen sc1
buffer_store_dword v58, v98, s[48:51], s7 offen sc1
buffer_store_dword v59, v99, s[48:51], s7 offen sc1
buffer_store_dword v60, v100, s[48:51], s7 offen sc1
buffer_store_dword v61, v101, s[48:51], s7 offen sc1
buffer_store_dword v62, v102, s[48:51], s7 offen sc1
buffer_store_dword v63, v103, s[48:51], s7 offen sc1
buffer_store_dword v64, v104, s[48:51], s7 offen sc1
buffer_store_dword v65, v105, s[48:51], s7 offen sc1
buffer_store_dword v66, v106, s[48:51], s7 offen sc1
buffer_store_dword v67, v107, s[48:51], s7 offen sc1
buffer_store_dword v68, v108, s[48:51], s7 offen sc1
buffer_store_dword v69, v109, s[48:51], s7 offen sc1
buffer_store_dword v70, v110, s[48:51], s7 offen sc1
buffer_store_dword v71, v111, s[48:51], s7 offen sc1
buffer_store_dword v72, v112, s[48:51], s7 offen sc1
buffer_store_dword v73, v113, s[48:51], s7 offen sc1
buffer_store_dword v74, v114, s[48:51], s7 offen sc1
buffer_store_dword v75, v115, s[48:51], s7 offen sc1
buffer_store_dword v76, v116, s[48:51], s7 offen sc1
buffer_store_dword v77, v117, s[48:51], s7 offen sc1
buffer_store_dword v78, v118, s[48:51], s7 offen sc1
buffer_store_dword v79, v119, s[48:51], s7 offen sc1
buffer_store_dword v80, v120, s[48:51], s7 offen sc1
buffer_store_dword v81, v121, s[48:51], s7 offen sc1
buffer_store_dword v82, v122, s[48:51], s7 offen sc1
buffer_store_dword v83, v123, s[48:51], s7 offen sc1
buffer_store_dword v84, v124, s[48:51], s7 offen sc1
buffer_store_dword v85, v125, s[48:51], s7 offen sc1
buffer_store_dword v86, v126, s[48:51], s7 offen sc1
buffer_store_dword v87, v127, s[48:51], s7 offen sc1
buffer_store_dword v88, v128, s[48:51], s7 offen sc1
buffer_store_dword v89, v129, s[48:51], s7 offen sc1
buffer_store_dword v90, v130, s[48:51], s7 offen sc1
buffer_store_dword v91, v131, s[48:51], s7 offen sc1
s_mov_b64 exec, s[12:13]
buffer_store_dword v92, v132, s[48:51], s7 offen sc1
buffer_store_dword v93, v133, s[48:51], s7 offen sc1
buffer_store_dword v94, v134, s[48:51], s7 offen sc1
buffer_store_dword v95, v135, s[48:51], s7 offen sc1
s_mov_b64 exec, -1
s_branch L1_fin
L2_entry:
s_load_dwordx2 s[4:5], s[0:1], 88
s_load_dwordx2 s[60:61], s[0:1], 0
s_load_dwordx2 s[52:53], s[0:1], 24
s_load_dwordx2 s[56:57], s[0:1], 72
s_and_b32 s35, s2, 7
s_lshr_b32 s37, s2, 3
s_add_u32 s37, s37, 30
s_and_b32 s37, s37, 31
v_lshrrev_b32 v1, 6, v0
s_mov_b32 s36, -1
v_readfirstlane_b32 s38, v1
s_cmp_lt_u32 s37, 30
s_cbranch_scc1 L2_att
s_lshl_b32 s39, s35, 1
s_add_u32 s39, s39, s37
s_sub_u32 s39, s39, 30
s_cmp_lt_u32 s38, 3
s_cbranch_scc1 LE_start
s_cmp_ge_u32 s39, 12
s_cbranch_scc1 L2_end
s_and_b32 s36, s39, 1
s_lshr_b32 s37, s39, 1
s_mov_b32 s38, 39
v_and_b32 v0, 63, v0
s_branch L2_att2
L2_att:
s_mul_i32 s38, s37, 26
s_lshr_b32 s38, s38, 8
s_mul_i32 s39, s38, 10
s_sub_u32 s39, s37, s39
s_and_b32 s37, s35, 1
s_mul_i32 s37, s37, 3
s_add_u32 s37, s37, s38
s_and_b32 s38, s35, 1
s_mul_i32 s38, s38, 5
s_add_u32 s35, s35, s38
s_and_b32 s35, s35, 7
s_lshr_b32 s38, s35, 1
s_mul_i32 s38, s38, 10
s_add_u32 s38, s38, s39
L2_att2:
v_lshrrev_b32 v1, 6, v0
v_and_b32 v243, 63, v0
v_lshlrev_b32 v243, 4, v243
v_readfirstlane_b32 s34, v1
s_mov_b32 s50, 0xe1a06800
s_mov_b32 s51, 0x4e20ad04
s_mul_i32 s39, s37, 9
s_lshr_b64 s[50:51], s[50:51], s39
s_and_b32 s39, s50, 0x1ff
s_bfe_u32 s49, s50, 0x90009
s_sub_u32 s31, s49, s39
s_sub_u32 s31, s31, 4
s_lshl_b32 s39, s39, 14
s_lshl_b32 s49, s49, 14
s_add_u32 s28, s39, 0x4000
s_cmp_eq_u32 s37, 5
s_addc_u32 s31, s31, 0
s_cmp_eq_u32 s37, 5
s_cselect_b32 s28, s39, s28
s_cselect_b32 s39, 5111808, s39
s_cselect_b32 s49, 5120000, s49
s_cselect_b32 s33, 0xff800000, 0
s_mov_b32 s32, 0x5d800000
v_and_b32 v2, 63, v0
v_bfe_u32 v3, v2, 3, 2
v_bfe_u32 v4, v2, 2, 1
v_lshlrev_b32 v241, 12, v3
v_lshl_or_b32 v241, v4, 9, v241
v_lshl_or_b32 v241, v1, 7, v241
v_lshrrev_b32 v4, 5, v2
v_lshl_or_b32 v241, v4, 6, v241
v_and_b32 v3, 2, v3
v_and_b32 v4, 3, v2
v_xor_b32 v3, v3, v4
v_lshl_or_b32 v241, v3, 4, v241
s_cmp_eq_u32 s38, 39
s_cbranch_scc1 LT_disp
s_cmp_lt_u32 s37, 3
s_cselect_b32 s101, 1, -1
s_cselect_b32 s39, 0, 103
s_cselect_b32 s3, 0, 3
s_sub_u32 s3, s37, s3
s_mul_i32 s3, s3, 104
s_add_u32 s39, s39, s3
s_cmp_eq_u32 s37, 5
s_addc_u32 s39, s39, 0
s_lshl_b32 s101, s101, 14
s_lshl_b32 s39, s39, 14
s_add_u32 s28, s39, s101
s_mov_b32 s49, 5120000
s_mov_b32 s31, 40
s_mov_b32 s100, 5
s_lshl_b32 s30, s34, 12
s_lshl_b32 s50, s34, 13
s_add_u32 s50, s50, 0x20000
s_mov_b32 m0, s30
s_cmp_lt_u32 s37, 3
s_mov_b32 s40, 0x4682d124
s_cselect_b32 s40, s40, 0xc003fdb0
s_cselect_b32 s41, 11, 15
s_cselect_b32 s3, 0, 36
s_lshl_b32 s94, s37, 2
s_add_u32 s94, s94, s34
s_mul_i32 s94, s94, 3
s_sub_u32 s3, s94, s3
s_lshr_b64 s[40:41], s[40:41], s3
s_and_b32 s94, s40, 3
s_bfe_u32 s95, s40, 0x10002
s_mov_b32 s6, 0x92c51840
s_mov_b32 s7, 0xfb73ea6d
s_mul_i32 s3, s37, 12
s_min_u32 s3, s3, 56
s_lshr_b64 s[6:7], s[6:7], s3
s_bfe_u32 s29, s6, 0x40008
s_bfe_u32 s7, s6, 0x40004
s_and_b32 s6, s6, 15
s_cmp_lt_u32 s37, 4
s_cselect_b32 s29, s29, 16
s_lshl_b32 s3, s38, 17
s_lshl_b32 s51, s34, 7
s_add_u32 s3, s3, s51
s_lshl_b32 s6, s6, 13
s_add_u32 s6, s6, s3
s_lshl_b32 s7, s7, 13
s_add_u32 s7, s7, s3
s_lshl_b32 s29, s29, 13
s_add_u32 s29, s29, s3
s_mov_b64 s[96:97], 0
s_lshr_b32 s3, s6, 9
s_mul_i32 s90, s3, 6945
s_mov_b32 s91, s90
s_mul_i32 s90, s3, 6317
s_add_u32 s90, s90, 0x340674
s_cmp_lt_u32 s3, 5436
s_cselect_b32 s91, s91, s90
s_mul_i32 s90, s3, 6899
s_add_u32 s90, s90, 0xfffae6a0
s_cmp_lt_u32 s3, 6432
s_cselect_b32 s91, s91, s90
s_mul_i32 s90, s3, 6242
s_add_u32 s90, s90, 0x4484a0
s_cmp_lt_u32 s3, 7344
s_cselect_b32 s91, s91, s90
s_lshr_b32 s3, s91, 20
s_bitset1_b64 s[96:97], s3
s_lshr_b32 s3, s6, 9
s_add_u32 s3, s3, 15
s_mul_i32 s90, s3, 6945
s_mov_b32 s91, s90
s_mul_i32 s90, s3, 6317
s_add_u32 s90, s90, 0x340674
s_cmp_lt_u32 s3, 5436
s_cselect_b32 s91, s91, s90
s_mul_i32 s90, s3, 6899
s_add_u32 s90, s90, 0xfffae6a0
s_cmp_lt_u32 s3, 6432
s_cselect_b32 s91, s91, s90
s_mul_i32 s90, s3, 6242
s_add_u32 s90, s90, 0x4484a0
s_cmp_lt_u32 s3, 7344
s_cselect_b32 s91, s91, s90
s_lshr_b32 s3, s91, 20
s_bitset1_b64 s[96:97], s3
s_lshr_b32 s3, s7, 9
s_mul_i32 s90, s3, 6945
s_mov_b32 s91, s90
s_mul_i32 s90, s3, 6317
s_add_u32 s90, s90, 0x340674
s_cmp_lt_u32 s3, 5436
s_cselect_b32 s91, s91, s90
s_mul_i32 s90, s3, 6899
s_add_u32 s90, s90, 0xfffae6a0
s_cmp_lt_u32 s3, 6432
s_cselect_b32 s91, s91, s90
s_mul_i32 s90, s3, 6242
s_add_u32 s90, s90, 0x4484a0
s_cmp_lt_u32 s3, 7344
s_cselect_b32 s91, s91, s90
s_lshr_b32 s3, s91, 20
s_bitset1_b64 s[96:97], s3
s_lshr_b32 s3, s7, 9
s_add_u32 s3, s3, 15
s_mul_i32 s90, s3, 6945
s_mov_b32 s91, s90
s_mul_i32 s90, s3, 6317
s_add_u32 s90, s90, 0x340674
s_cmp_lt_u32 s3, 5436
s_cselect_b32 s91, s91, s90
s_mul_i32 s90, s3, 6899
s_add_u32 s90, s90, 0xfffae6a0
s_cmp_lt_u32 s3, 6432
s_cselect_b32 s91, s91, s90
s_mul_i32 s90, s3, 6242
s_add_u32 s90, s90, 0x4484a0
s_cmp_lt_u32 s3, 7344
s_cselect_b32 s91, s91, s90
s_lshr_b32 s3, s91, 20
s_bitset1_b64 s[96:97], s3
s_lshr_b32 s3, s29, 9
s_mul_i32 s90, s3, 6945
s_mov_b32 s91, s90
s_mul_i32 s90, s3, 6317
s_add_u32 s90, s90, 0x340674
s_cmp_lt_u32 s3, 5436
s_cselect_b32 s91, s91, s90
s_mul_i32 s90, s3, 6899
s_add_u32 s90, s90, 0xfffae6a0
s_cmp_lt_u32 s3, 6432
s_cselect_b32 s91, s91, s90
s_mul_i32 s90, s3, 6242
s_add_u32 s90, s90, 0x4484a0
s_cmp_lt_u32 s3, 7344
s_cselect_b32 s91, s91, s90
s_lshr_b32 s3, s91, 20
s_bitset1_b64 s[96:97], s3
s_lshr_b32 s3, s29, 9
s_add_u32 s3, s3, 15
s_mul_i32 s90, s3, 6945
s_mov_b32 s91, s90
s_mul_i32 s90, s3, 6317
s_add_u32 s90, s90, 0x340674
s_cmp_lt_u32 s3, 5436
s_cselect_b32 s91, s91, s90
s_mul_i32 s90, s3, 6899
s_add_u32 s90, s90, 0xfffae6a0
s_cmp_lt_u32 s3, 6432
s_cselect_b32 s91, s91, s90
s_mul_i32 s90, s3, 6242
s_add_u32 s90, s90, 0x4484a0
s_cmp_lt_u32 s3, 7344
s_cselect_b32 s91, s91, s90
s_lshr_b32 s3, s91, 20
s_bitset1_b64 s[96:97], s3
s_mul_i32 s3, s38, 6
s_add_u32 s3, s3, s37
s_cmp_eq_u32 s3, 233
s_cselect_b32 s3, 0, s37
s_cmp_lt_u32 s3, 4
s_cselect_b32 s29, s29, 0x70000000
s_lshl_b32 s51, s38, 5
s_lshl_b32 s3, s34, 3
s_add_u32 s51, s51, s3
s_add_u32 s51, s51, s37
s_mul_i32 s51, s51, 128
s_add_u32 s51, s51, 0x7c00000
s_lshr_b32 s40, s39, 17
s_min_u32 s40, s40, 38
s_lshr_b32 s41, s28, 17
s_add_u32 s3, s28, s101
s_lshr_b32 s3, s3, 17
v_mov_b32 v5, s38
v_mov_b32 v6, s40
v_cmp_lt_u32 vcc, 0x7f, v243
s_nop 1
v_cndmask_b32 v5, v5, v6, vcc
v_mov_b32 v6, s41
v_cmp_lt_u32 vcc, 0xff, v243
s_nop 1
v_cndmask_b32 v5, v5, v6, vcc
v_mov_b32 v6, s3
v_cmp_lt_u32 vcc, 0x17f, v243
s_nop 1
v_cndmask_b32 v5, v5, v6, vcc
v_bfe_u32 v6, v243, 4, 3
v_min_u32 v6, 5, v6
v_mad_u32_u24 v5, v5, 6, v6
v_lshlrev_b32 v5, 7, v5
v_add_u32 v5, 0x7c2a000, v5
s_mul_i32 s3, s101, 54
s_add_u32 s3, s3, s39
s_min_u32 s41, s3, s39
s_max_u32 s3, s3, s39
s_lshr_b32 s41, s41, 17
s_min_u32 s40, s40, s41
s_mul_i32 s40, s40, 6
s_lshr_b32 s3, s3, 17
s_min_u32 s3, s3, 38
s_mul_i32 s3, s3, 6
s_add_u32 s3, s3, 5
v_lshrrev_b32 v230, 4, v243
v_add_u32 v230, s40, v230
v_min_u32 v230, s3, v230
v_lshlrev_b32 v230, 7, v230
v_add_u32 v230, 0x7c2a000, v230
s_waitcnt lgkmcnt(0)
s_add_u32 s12, s4, 0x6800000
s_addc_u32 s13, s5, 0
s_mov_b32 s14, 0x0
s_mov_b32 s15, 0x00020000
s_mov_b32 s14, s49
s_add_u32 s8, s4, 0x0
s_addc_u32 s9, s5, 0
s_mov_b32 s10, 0x4e4000
s_mov_b32 s11, 0x00020000
s_mul_i32 s35, s37, 0x600000
s_add_u32 s20, s4, 0x2000000
s_addc_u32 s21, s5, 0
s_add_u32 s20, s20, s35
s_addc_u32 s21, s21, 0
s_mov_b32 s22, 0x4e4000
s_mov_b32 s23, 0x00020000
s_add_u32 s24, s4, 0x6000000
s_addc_u32 s25, s5, 0
s_mov_b32 s26, 0x139000
s_mov_b32 s27, 0x00020000
s_lshl_b32 s35, s38, 4
s_lshl_b32 s41, s34, 2
s_add_u32 s35, s35, s41
s_lshl_b32 s40, s35, 13
s_lshl_b32 s94, s94, 13
s_add_u32 s40, s40, s94
s_xor_b32 s41, s40, 8192
s_xor_b32 s42, s40, 16384
s_xor_b32 s43, s40, 24576
s_add_u32 s44, s40, 4096
s_add_u32 s45, s41, 4096
s_add_u32 s46, s42, 4096
s_add_u32 s47, s43, 4096
s_lshl_b32 s48, s35, 10
s_lshl_b32 s35, s37, 3
s_add_u32 s48, s48, s35
v_mov_b32 v232, 0
v_mov_b32 v233, 0
v_mov_b32 v234, 0
v_mov_b32 v235, 0
v_bfe_u32 v240, v243, 4, 3
v_lshlrev_b32 v240, 6, v240
v_bfe_u32 v242, v243, 7, 1
v_lshl_or_b32 v240, v242, 10, v240
v_bfe_u32 v242, v243, 8, 2
v_lshl_or_b32 v240, v242, 4, v240
v_bfe_u32 v242, v243, 6, 1
v_lshlrev_b32 v242, 5, v242
v_xor_b32 v240, v240, v242
v_and_b32 v246, 0x1c0, v243
v_bfe_u32 v242, v243, 9, 1
v_lshl_or_b32 v246, v242, 10, v246
v_bfe_u32 v242, v243, 8, 1
v_lshl_or_b32 v246, v242, 5, v246
v_bfe_u32 v242, v243, 4, 2
v_lshl_or_b32 v246, v242, 3, v246
v_xor_b32 v247, 32, v246
v_bfe_i32 v242, v243, 8, 1
v_and_b32 v192, s33, v242
v_and_b32 v193, s33, v242
v_and_b32 v194, s33, v242
v_and_b32 v195, s33, v242
v_mfma_f32_32x32x16_bf16 a[0:15], v[232:235], v[232:235], 0
v_mfma_f32_32x32x16_bf16 a[16:31], v[232:235], v[232:235], 0
v_mfma_f32_32x32x16_bf16 a[32:47], v[232:235], v[232:235], 0
v_mfma_f32_32x32x16_bf16 a[48:63], v[232:235], v[232:235], 0
v_mfma_f32_32x32x16_bf16 a[64:79], v[232:235], v[232:235], 0
v_mfma_f32_32x32x16_bf16 a[80:95], v[232:235], v[232:235], 0
v_mfma_f32_32x32x16_bf16 a[96:111], v[232:235], v[232:235], 0
v_mfma_f32_32x32x16_bf16 a[112:127], v[232:235], v[232:235], 0
v_mfma_f32_32x32x16_bf16 a[128:143], v[232:235], v[232:235], 0
v_mfma_f32_32x32x16_bf16 a[144:159], v[232:235], v[232:235], 0
v_mfma_f32_32x32x16_bf16 a[160:175], v[232:235], v[232:235], 0
v_mfma_f32_32x32x16_bf16 a[176:191], v[232:235], v[232:235], 0
v_mfma_f32_32x32x16_bf16 a[192:207], v[232:235], v[232:235], 0
v_mfma_f32_32x32x16_bf16 a[208:223], v[232:235], v[232:235], 0
v_mfma_f32_32x32x16_bf16 a[224:239], v[232:235], v[232:235], 0
v_mfma_f32_32x32x16_bf16 a[240:255], v[232:235], v[232:235], 0
s_add_u32 s16, s4, 0x0
s_addc_u32 s17, s5, 0
s_mov_b32 s18, 0x10000000
s_mov_b32 s19, 0x00020000
s_mov_b32 s3, 0x10000
LM_pa:
buffer_load_dwordx2 v[6:7], v5, s[16:19], 0 offen sc1
s_sub_u32 s3, s3, 1
s_waitcnt vmcnt(0)
s_cbranch_scc1 LM_pa_go
v_cmp_ne_u64 vcc, s[98:99], v[6:7]
s_nop 1
s_cbranch_vccnz LM_pa
LM_pa_go:
buffer_load_dwordx4 v241, s[12:15], s39 offen offset:0 sc1 lds
buffer_load_dwordx4 v241, s[12:15], s39 offen offset:1024 sc1 lds
buffer_load_dwordx4 v241, s[12:15], s39 offen offset:2048 sc1 lds
buffer_load_dwordx4 v241, s[12:15], s39 offen offset:3072 sc1 lds
s_add_u32 m0, s30, 0x4000
s_nop 0
buffer_load_dwordx4 v241, s[12:15], s28 offen offset:0 sc1 lds
buffer_load_dwordx4 v241, s[12:15], s28 offen offset:1024 sc1 lds
buffer_load_dwordx4 v[0:3], v243, s[8:11], s44 offen offset:3072 sc1
buffer_load_dwordx4 v[32:35], v243, s[8:11], s45 offen offset:3072 sc1
buffer_load_dwordx4 v[64:67], v243, s[8:11], s46 offen offset:3072 sc1
buffer_load_dwordx4 v[96:99], v243, s[8:11], s47 offen offset:3072 sc1
buffer_load_dwordx4 v[4:7], v243, s[8:11], s44 offen offset:2048 sc1
buffer_load_dwordx4 v[36:39], v243, s[8:11], s45 offen offset:2048 sc1
buffer_load_dwordx4 v[68:71], v243, s[8:11], s46 offen offset:2048 sc1
buffer_load_dwordx4 v[100:103], v243, s[8:11], s47 offen offset:2048 sc1
buffer_load_dwordx4 v[8:11], v243, s[8:11], s40 offen offset:0 sc1
buffer_load_dwordx4 v[40:43], v243, s[8:11], s41 offen offset:0 sc1
buffer_load_dwordx4 v[72:75], v243, s[8:11], s42 offen offset:0 sc1
buffer_load_dwordx4 v[104:107], v243, s[8:11], s43 offen offset:0 sc1
buffer_load_dwordx4 v[12:15], v243, s[8:11], s40 offen offset:1024 sc1
buffer_load_dwordx4 v[44:47], v243, s[8:11], s41 offen offset:1024 sc1
buffer_load_dwordx4 v[76:79], v243, s[8:11], s42 offen offset:1024 sc1
buffer_load_dwordx4 v[108:111], v243, s[8:11], s43 offen offset:1024 sc1
buffer_load_dwordx4 v[16:19], v243, s[8:11], s40 offen offset:2048 sc1
buffer_load_dwordx4 v[48:51], v243, s[8:11], s41 offen offset:2048 sc1
buffer_load_dwordx4 v[80:83], v243, s[8:11], s42 offen offset:2048 sc1
buffer_load_dwordx4 v[112:115], v243, s[8:11], s43 offen offset:2048 sc1
buffer_load_dwordx2 v[228:229], v230, s[16:19], 0 offen sc1
s_waitcnt vmcnt(21)
s_barrier
ds_read_b128 v[208:211], v240 offset:12800
ds_read_b128 v[212:215], v240 offset:14848
ds_read_b128 v[216:219], v240 offset:29184
ds_read_b128 v[220:223], v240 offset:12288
s_waitcnt lgkmcnt(3)
s_waitcnt vmcnt(17)
v_mfma_f32_16x16x32_bf16 v[128:131], v[208:211], v[0:3], v[192:195]
buffer_load_dwordx4 v[20:23], v243, s[8:11], s40 offen offset:3072 sc1
v_mfma_f32_16x16x32_bf16 v[132:135], v[208:211], v[32:35], v[192:195]
v_mfma_f32_16x16x32_bf16 v[136:139], v[208:211], v[64:67], v[192:195]
v_mfma_f32_16x16x32_bf16 v[140:143], v[208:211], v[96:99], v[192:195]
ds_read_b128 v[208:211], v240 offset:14336
s_waitcnt lgkmcnt(3)
buffer_load_dwordx4 v[52:55], v243, s[8:11], s41 offen offset:3072 sc1
v_mfma_f32_16x16x32_bf16 v[144:147], v[212:215], v[0:3], v[192:195]
v_mfma_f32_16x16x32_bf16 v[148:151], v[212:215], v[32:35], v[192:195]
v_mfma_f32_16x16x32_bf16 v[152:155], v[212:215], v[64:67], v[192:195]
buffer_load_dwordx4 v[84:87], v243, s[8:11], s42 offen offset:3072 sc1
v_mfma_f32_16x16x32_bf16 v[156:159], v[212:215], v[96:99], v[192:195]
ds_read_b128 v[212:215], v240 offset:28672
s_waitcnt lgkmcnt(3)
v_mfma_f32_16x16x32_bf16 v[176:179], v[216:219], v[0:3], 0
v_mfma_f32_16x16x32_bf16 v[180:183], v[216:219], v[32:35], 0
buffer_load_dwordx4 v[116:119], v243, s[8:11], s43 offen offset:3072 sc1
v_mfma_f32_16x16x32_bf16 v[184:187], v[216:219], v[64:67], 0
v_mfma_f32_16x16x32_bf16 v[188:191], v[216:219], v[96:99], 0
ds_read_b128 v[216:219], v240 offset:0
s_waitcnt lgkmcnt(3)
s_waitcnt vmcnt(17)
v_mfma_f32_16x16x32_bf16 v[128:131], v[220:223], v[4:7], v[128:131]
buffer_load_dwordx4 v[24:27], v243, s[8:11], s44 offen offset:0 sc1
v_mfma_f32_16x16x32_bf16 v[132:135], v[220:223], v[36:39], v[132:135]
v_mfma_f32_16x16x32_bf16 v[136:139], v[220:223], v[68:71], v[136:139]
v_mfma_f32_16x16x32_bf16 v[140:143], v[220:223], v[100:103], v[140:143]
ds_read_b128 v[220:223], v240 offset:2048
s_waitcnt lgkmcnt(3)
buffer_load_dwordx4 v[56:59], v243, s[8:11], s45 offen offset:0 sc1
v_mfma_f32_16x16x32_bf16 v[144:147], v[208:211], v[4:7], v[144:147]
v_mfma_f32_16x16x32_bf16 v[148:151], v[208:211], v[36:39], v[148:151]
v_mfma_f32_16x16x32_bf16 v[152:155], v[208:211], v[68:71], v[152:155]
buffer_load_dwordx4 v[88:91], v243, s[8:11], s46 offen offset:0 sc1
v_mfma_f32_16x16x32_bf16 v[156:159], v[208:211], v[100:103], v[156:159]
ds_read_b128 v[208:211], v240 offset:16384
s_waitcnt lgkmcnt(3)
v_mfma_f32_16x16x32_bf16 v[176:179], v[212:215], v[4:7], v[176:179]
v_mfma_f32_16x16x32_bf16 v[180:183], v[212:215], v[36:39], v[180:183]
buffer_load_dwordx4 v[120:123], v243, s[8:11], s47 offen offset:0 sc1
v_mfma_f32_16x16x32_bf16 v[184:187], v[212:215], v[68:71], v[184:187]
v_mfma_f32_16x16x32_bf16 v[188:191], v[212:215], v[100:103], v[188:191]
ds_read_b128 v[212:215], v240 offset:512
s_waitcnt lgkmcnt(3)
s_waitcnt vmcnt(17)
v_mfma_f32_16x16x32_bf16 v[128:131], v[216:219], v[8:11], v[128:131]
buffer_load_dwordx4 v[28:31], v243, s[8:11], s44 offen offset:1024 sc1
v_mfma_f32_16x16x32_bf16 v[132:135], v[216:219], v[40:43], v[132:135]
v_mfma_f32_16x16x32_bf16 v[136:139], v[216:219], v[72:75], v[136:139]
v_mfma_f32_16x16x32_bf16 v[140:143], v[216:219], v[104:107], v[140:143]
ds_read_b128 v[216:219], v240 offset:2560
s_waitcnt lgkmcnt(3)
buffer_load_dwordx4 v[60:63], v243, s[8:11], s45 offen offset:1024 sc1
v_mfma_f32_16x16x32_bf16 v[144:147], v[220:223], v[8:11], v[144:147]
v_mfma_f32_16x16x32_bf16 v[148:151], v[220:223], v[40:43], v[148:151]
v_mfma_f32_16x16x32_bf16 v[152:155], v[220:223], v[72:75], v[152:155]
buffer_load_dwordx4 v[92:95], v243, s[8:11], s46 offen offset:1024 sc1
v_mfma_f32_16x16x32_bf16 v[156:159], v[220:223], v[104:107], v[156:159]
ds_read_b128 v[220:223], v240 offset:16896
s_waitcnt lgkmcnt(3)
v_mfma_f32_16x16x32_bf16 v[176:179], v[208:211], v[8:11], v[176:179]
v_mfma_f32_16x16x32_bf16 v[180:183], v[208:211], v[40:43], v[180:183]
buffer_load_dwordx4 v[124:127], v243, s[8:11], s47 offen offset:1024 sc1
v_mfma_f32_16x16x32_bf16 v[184:187], v[208:211], v[72:75], v[184:187]
v_mfma_f32_16x16x32_bf16 v[188:191], v[208:211], v[104:107], v[188:191]
ds_read_b128 v[208:211], v240 offset:4096
s_waitcnt lgkmcnt(3)
s_waitcnt vmcnt(17)
v_mfma_f32_16x16x32_bf16 v[128:131], v[212:215], v[12:15], v[128:131]
s_add_u32 s16, s4, 0x0
s_addc_u32 s17, s5, 0
s_mov_b32 s18, 0x10000000
v_mfma_f32_16x16x32_bf16 v[132:135], v[212:215], v[44:47], v[132:135]
buffer_load_dwordx4 v241, s[12:15], s28 offen offset:2048 sc1 lds
s_mov_b32 s19, 0x00020000
s_add_u32 s8, s60, 0x0
v_mfma_f32_16x16x32_bf16 v[136:139], v[212:215], v[76:79], v[136:139]
s_addc_u32 s9, s61, 0
s_mov_b32 s10, 0x4e2000
s_mov_b32 s11, 0x00020000
v_mfma_f32_16x16x32_bf16 v[140:143], v[212:215], v[108:111], v[140:143]
ds_read_b128 v[212:215], v240 offset:6144
s_waitcnt lgkmcnt(3)
buffer_load_dwordx4 v241, s[12:15], s28 offen offset:3072 sc1 lds
v_mfma_f32_16x16x32_bf16 v[144:147], v[216:219], v[12:15], v[144:147]
s_mov_b32 s54, 0x4e20
s_mov_b32 s55, 0x00020000
s_mov_b32 s58, 0x4e2000
v_mfma_f32_16x16x32_bf16 v[148:151], v[216:219], v[44:47], v[148:151]
s_mov_b32 s59, 0x00020000
s_lshr_b32 s48, s40, 2
s_cmp_eq_u32 s95, 1
v_mfma_f32_16x16x32_bf16 v[152:155], v[216:219], v[76:79], v[152:155]
s_cselect_b32 s40, 0x70000000, s40
s_cselect_b32 s44, 0x70000000, s44
s_cmp_lt_u32 s37, 3
v_mfma_f32_16x16x32_bf16 v[156:159], v[216:219], v[108:111], v[156:159]
ds_read_b128 v[216:219], v240 offset:20480
s_waitcnt lgkmcnt(3)
s_cselect_b32 s3, 0, 3
v_mfma_f32_16x16x32_bf16 v[176:179], v[220:223], v[12:15], v[176:179]
s_cselect_b32 s94, 0, 8
s_sub_u32 s3, s37, s3
s_lshl_b32 s38, s38, 2
v_mfma_f32_16x16x32_bf16 v[180:183], v[220:223], v[44:47], v[180:183]
s_add_u32 s38, s38, s3
s_lshl_b32 s38, s38, 10
s_add_u32 s38, s38, 0x7c00300
v_mfma_f32_16x16x32_bf16 v[184:187], v[220:223], v[76:79], v[184:187]
s_add_u32 s94, s94, s38
s_xor_b32 s95, s94, 8
s_add_u32 s49, s95, 32
v_mfma_f32_16x16x32_bf16 v[188:191], v[220:223], v[108:111], v[188:191]
ds_read_b128 v[220:223], v240 offset:4608
s_waitcnt lgkmcnt(3)
s_waitcnt vmcnt(15)
v_mfma_f32_16x16x32_bf16 v[128:131], v[208:211], v[16:19], v[128:131]
s_cmp_eq_u32 s3, 2
s_cselect_b32 s35, s38, s94
s_cselect_b32 s49, s49, s95
v_mfma_f32_16x16x32_bf16 v[132:135], v[208:211], v[48:51], v[132:135]
s_add_u32 s28, s28, s101
s_add_u32 m0, s30, 0x8000
s_nop 0
s_mov_b32 s39, 4
v_mfma_f32_16x16x32_bf16 v[136:139], v[208:211], v[80:83], v[136:139]
v_mfma_f32_16x16x32_bf16 v[140:143], v[208:211], v[112:115], v[140:143]
ds_read_b128 v[208:211], v240 offset:6656
s_waitcnt lgkmcnt(3)
buffer_load_dwordx4 v241, s[12:15], s28 offen offset:0 sc1 lds
v_mfma_f32_16x16x32_bf16 v[144:147], v[212:215], v[16:19], v[144:147]
v_mfma_f32_16x16x32_bf16 v[148:151], v[212:215], v[48:51], v[148:151]
buffer_load_dwordx4 v241, s[12:15], s28 offen offset:1024 sc1 lds
v_mfma_f32_16x16x32_bf16 v[152:155], v[212:215], v[80:83], v[152:155]
v_mfma_f32_16x16x32_bf16 v[156:159], v[212:215], v[112:115], v[156:159]
ds_read_b128 v[212:215], v240 offset:20992
s_waitcnt lgkmcnt(3)
v_mfma_f32_16x16x32_bf16 v[176:179], v[216:219], v[16:19], v[176:179]
v_mfma_f32_16x16x32_bf16 v[180:183], v[216:219], v[48:51], v[180:183]
v_mfma_f32_16x16x32_bf16 v[184:187], v[216:219], v[80:83], v[184:187]
v_mfma_f32_16x16x32_bf16 v[188:191], v[216:219], v[112:115], v[188:191]
ds_read_b128 v[216:219], v240 offset:8192
s_waitcnt lgkmcnt(3)
s_waitcnt vmcnt(12)
v_mfma_f32_16x16x32_bf16 v[128:131], v[220:223], v[20:23], v[128:131]
v_mfma_f32_16x16x32_bf16 v[132:135], v[220:223], v[52:55], v[132:135]
buffer_load_dwordx4 v241, s[12:15], s28 offen offset:2048 sc1 lds
v_mfma_f32_16x16x32_bf16 v[136:139], v[220:223], v[84:87], v[136:139]
v_mfma_f32_16x16x32_bf16 v[140:143], v[220:223], v[116:119], v[140:143]
ds_read_b128 v[220:223], v240 offset:10240
s_waitcnt lgkmcnt(3)
buffer_load_dwordx4 v241, s[12:15], s28 offen offset:3072 sc1 lds
v_mfma_f32_16x16x32_bf16 v[144:147], v[208:211], v[20:23], v[144:147]
v_mfma_f32_16x16x32_bf16 v[148:151], v[208:211], v[52:55], v[148:151]
v_mfma_f32_16x16x32_bf16 v[152:155], v[208:211], v[84:87], v[152:155]
v_mfma_f32_16x16x32_bf16 v[156:159], v[208:211], v[116:119], v[156:159]
ds_read_b128 v[208:211], v240 offset:24576
s_waitcnt lgkmcnt(3)
v_mfma_f32_16x16x32_bf16 v[176:179], v[212:215], v[20:23], v[176:179]
v_mfma_f32_16x16x32_bf16 v[180:183], v[212:215], v[52:55], v[180:183]
v_mfma_f32_16x16x32_bf16 v[184:187], v[212:215], v[84:87], v[184:187]
v_mfma_f32_16x16x32_bf16 v[188:191], v[212:215], v[116:119], v[188:191]
ds_read_b128 v[212:215], v240 offset:8704
s_waitcnt lgkmcnt(3)
s_waitcnt vmcnt(10)
v_mfma_f32_16x16x32_bf16 v[128:131], v[216:219], v[24:27], v[128:131]
v_mfma_f32_16x16x32_bf16 v[132:135], v[216:219], v[56:59], v[132:135]
s_add_u32 s28, s28, s101
s_add_u32 s30, s30, 0xc000
v_mfma_f32_16x16x32_bf16 v[136:139], v[216:219], v[88:91], v[136:139]
v_mfma_f32_16x16x32_bf16 v[140:143], v[216:219], v[120:123], v[140:143]
ds_read_b128 v[216:219], v240 offset:10752
s_waitcnt lgkmcnt(3)
v_mfma_f32_16x16x32_bf16 v[144:147], v[220:223], v[24:27], v[144:147]
v_mfma_f32_16x16x32_bf16 v[148:151], v[220:223], v[56:59], v[148:151]
v_mfma_f32_16x16x32_bf16 v[152:155], v[220:223], v[88:91], v[152:155]
v_mfma_f32_16x16x32_bf16 v[156:159], v[220:223], v[120:123], v[156:159]
ds_read_b128 v[220:223], v240 offset:25088
s_waitcnt lgkmcnt(3)
v_mfma_f32_16x16x32_bf16 v[176:179], v[208:211], v[24:27], v[176:179]
v_mfma_f32_16x16x32_bf16 v[180:183], v[208:211], v[56:59], v[180:183]
v_mfma_f32_16x16x32_bf16 v[184:187], v[208:211], v[88:91], v[184:187]
v_mfma_f32_16x16x32_bf16 v[188:191], v[208:211], v[120:123], v[188:191]
s_waitcnt lgkmcnt(2)
s_waitcnt vmcnt(6)
v_mfma_f32_16x16x32_bf16 v[128:131], v[212:215], v[28:31], v[128:131]
v_mfma_f32_16x16x32_bf16 v[132:135], v[212:215], v[60:63], v[132:135]
v_mfma_f32_16x16x32_bf16 v[136:139], v[212:215], v[92:95], v[136:139]
v_mfma_f32_16x16x32_bf16 v[140:143], v[212:215], v[124:127], v[140:143]
s_waitcnt lgkmcnt(1)
v_mfma_f32_16x16x32_bf16 v[144:147], v[216:219], v[28:31], v[144:147]
v_mfma_f32_16x16x32_bf16 v[148:151], v[216:219], v[60:63], v[148:151]
v_mfma_f32_16x16x32_bf16 v[152:155], v[216:219], v[92:95], v[152:155]
v_mfma_f32_16x16x32_bf16 v[156:159], v[216:219], v[124:127], v[156:159]
s_waitcnt lgkmcnt(0)
v_mfma_f32_16x16x32_bf16 v[176:179], v[220:223], v[28:31], v[176:179]
v_mfma_f32_16x16x32_bf16 v[180:183], v[220:223], v[60:63], v[180:183]
v_mfma_f32_16x16x32_bf16 v[184:187], v[220:223], v[92:95], v[184:187]
v_mfma_f32_16x16x32_bf16 v[188:191], v[220:223], v[124:127], v[188:191]
v_max3_f32 v248, v128, v129, v130
v_max3_f32 v249, v132, v133, v134
v_max3_f32 v250, v136, v137, v138
v_max3_f32 v251, v140, v141, v142
v_max3_f32 v248, v248, v131, v144
v_max3_f32 v249, v249, v135, v148
v_max3_f32 v250, v250, v139, v152
v_max3_f32 v251, v251, v143, v156
v_max3_f32 v248, v248, v145, v146
v_max3_f32 v249, v249, v149, v150
v_max3_f32 v250, v250, v153, v154
v_max3_f32 v251, v251, v157, v158
v_max_f32 v248, v248, v147
v_max_f32 v249, v249, v151
v_max_f32 v250, v250, v155
v_max_f32 v251, v251, v159
v_mov_b32 v232, v248
v_mov_b32 v233, v249
v_mov_b32 v234, v250
v_mov_b32 v235, v251
v_permlane32_swap_b32 v248, v232
v_permlane32_swap_b32 v249, v233
v_permlane32_swap_b32 v250, v234
v_permlane32_swap_b32 v251, v235
v_max_f32 v248, v248, v232
v_max_f32 v249, v249, v233
v_max_f32 v250, v250, v234
v_max_f32 v251, v251, v235
v_mov_b32 v232, v248
v_mov_b32 v233, v249
v_mov_b32 v234, v250
v_mov_b32 v235, v251
v_permlane16_swap_b32 v248, v232
v_permlane16_swap_b32 v249, v233
v_permlane16_swap_b32 v250, v234
v_permlane16_swap_b32 v251, v235
v_max_f32 v248, v248, v232
v_max_f32 v249, v249, v233
v_max_f32 v250, v250, v234
v_max_f32 v251, v251, v235
v_ceil_f32 v248, v248
v_ceil_f32 v249, v249
v_ceil_f32 v250, v250
v_ceil_f32 v251, v251
v_add_f32 v248, 40.0, v248
v_add_f32 v249, 40.0, v249
v_add_f32 v250, 40.0, v250
v_add_f32 v251, 40.0, v251
v_cvt_pk_bf16_f32 v248, v248, v248
v_cvt_pk_bf16_f32 v249, v249, v249
v_cvt_pk_bf16_f32 v250, v250, v250
v_cvt_pk_bf16_f32 v251, v251, v251
v_and_b32 v248, 0xffff0000, v248
v_and_b32 v249, 0xffff0000, v249
v_and_b32 v250, 0xffff0000, v250
v_and_b32 v251, 0xffff0000, v251
v_bfe_i32 v242, v243, 8, 1
v_bfe_i32 v232, v243, 9, 1
v_and_b32 v242, v242, v232
v_and_b32 v242, 0xffff0000, v242
v_sub_f32 v224, 0, v248
v_sub_f32 v225, 0, v249
v_sub_f32 v226, 0, v250
v_sub_f32 v227, 0, v251
v_bfi_b32 v3, v242, v224, v3
v_bfi_b32 v35, v242, v225, v35
v_bfi_b32 v67, v242, v226, v67
v_bfi_b32 v99, v242, v227, v99
v_sub_f32 v128, v128, v248
v_sub_f32 v129, v129, v248
v_sub_f32 v130, v130, v248
v_sub_f32 v131, v131, v248
v_exp_f32 v128, v128
v_exp_f32 v129, v129
v_exp_f32 v130, v130
v_exp_f32 v131, v131
v_sub_f32 v132, v132, v249
v_sub_f32 v133, v133, v249
v_sub_f32 v134, v134, v249
v_sub_f32 v135, v135, v249
v_exp_f32 v132, v132
v_exp_f32 v133, v133
v_exp_f32 v134, v134
v_exp_f32 v135, v135
v_sub_f32 v136, v136, v250
v_sub_f32 v137, v137, v250
v_sub_f32 v138, v138, v250
v_sub_f32 v139, v139, v250
v_exp_f32 v136, v136
v_exp_f32 v137, v137
v_exp_f32 v138, v138
v_exp_f32 v139, v139
v_sub_f32 v140, v140, v251
v_sub_f32 v141, v141, v251
v_sub_f32 v142, v142, v251
v_sub_f32 v143, v143, v251
v_exp_f32 v140, v140
v_exp_f32 v141, v141
v_exp_f32 v142, v142
v_exp_f32 v143, v143
s_waitcnt vmcnt(4)
s_barrier
ds_read_b128 v[208:211], v240 offset:31232
ds_read_b128 v[212:215], v240 offset:30720
ds_read_b128 v[216:219], v240 offset:18432
ds_read_b128 v[220:223], v240 offset:18944
v_add_f32 v144, v144, v224
v_add_f32 v145, v145, v224
v_add_f32 v146, v146, v224
v_add_f32 v147, v147, v224
v_exp_f32 v144, v144
v_exp_f32 v145, v145
v_exp_f32 v146, v146
v_exp_f32 v147, v147
v_add_f32 v148, v148, v225
v_add_f32 v149, v149, v225
v_add_f32 v150, v150, v225
v_add_f32 v151, v151, v225
v_exp_f32 v148, v148
v_exp_f32 v149, v149
v_exp_f32 v150, v150
v_exp_f32 v151, v151
v_add_f32 v152, v152, v226
v_add_f32 v153, v153, v226
v_add_f32 v154, v154, v226
v_add_f32 v155, v155, v226
v_exp_f32 v152, v152
v_exp_f32 v153, v153
v_exp_f32 v154, v154
v_exp_f32 v155, v155
v_add_f32 v156, v156, v227
v_add_f32 v157, v157, v227
v_add_f32 v158, v158, v227
v_add_f32 v159, v159, v227
v_exp_f32 v156, v156
v_exp_f32 v157, v157
v_exp_f32 v158, v158
v_exp_f32 v159, v159
v_cvt_pk_bf16_f32 v160, v128, v129
v_cvt_pk_bf16_f32 v161, v130, v131
v_cvt_pk_bf16_f32 v164, v132, v133
v_cvt_pk_bf16_f32 v165, v134, v135
v_cvt_pk_bf16_f32 v168, v136, v137
v_cvt_pk_bf16_f32 v169, v138, v139
v_cvt_pk_bf16_f32 v172, v140, v141
v_cvt_pk_bf16_f32 v173, v142, v143
v_cvt_pk_bf16_f32 v162, v144, v145
v_cvt_pk_bf16_f32 v163, v146, v147
v_cvt_pk_bf16_f32 v166, v148, v149
v_cvt_pk_bf16_f32 v167, v150, v151
v_cvt_pk_bf16_f32 v170, v152, v153
v_cvt_pk_bf16_f32 v171, v154, v155
v_cvt_pk_bf16_f32 v174, v156, v157
v_cvt_pk_bf16_f32 v175, v158, v159
v_add_f32 v128, v176, v224
v_add_f32 v129, v177, v224
v_add_f32 v130, v178, v224
v_add_f32 v131, v179, v224
v_add_f32 v132, v180, v225
v_add_f32 v133, v181, v225
v_add_f32 v134, v182, v225
v_add_f32 v135, v183, v225
v_add_f32 v136, v184, v226
v_add_f32 v137, v185, v226
v_add_f32 v138, v186, v226
v_add_f32 v139, v187, v226
v_add_f32 v140, v188, v227
v_add_f32 v141, v189, v227
v_add_f32 v142, v190, v227
v_add_f32 v143, v191, v227
v_cmp_ne_u64 vcc, s[98:99], v[228:229]
s_nop 1
s_cbranch_vccnz LM_pb
LM_pb_ret:
s_nop 1
s_waitcnt lgkmcnt(2)
L2_ret5:
v_mfma_f32_16x16x32_bf16 v[144:147], v[208:211], v[0:3], 0
v_mfma_f32_16x16x32_bf16 v[144:147], v[212:215], v[4:7], v[144:147]
v_mfma_f32_16x16x32_bf16 v[148:151], v[208:211], v[32:35], 0
v_mfma_f32_16x16x32_bf16 v[148:151], v[212:215], v[36:39], v[148:151]
v_mfma_f32_16x16x32_bf16 v[152:155], v[208:211], v[64:67], 0
v_exp_f32 v128, v128
v_mfma_f32_16x16x32_bf16 v[152:155], v[212:215], v[68:71], v[152:155]
v_exp_f32 v129, v129
v_mfma_f32_16x16x32_bf16 v[156:159], v[208:211], v[96:99], 0
ds_read_b128 v[208:211], v240 offset:22528
v_mfma_f32_16x16x32_bf16 v[156:159], v[212:215], v[100:103], v[156:159]
ds_read_b128 v[212:215], v240 offset:23040
s_waitcnt lgkmcnt(2)
v_mfma_f32_16x16x32_bf16 v[144:147], v[216:219], v[8:11], v[144:147]
v_exp_f32 v130, v130
v_mfma_f32_16x16x32_bf16 v[144:147], v[220:223], v[12:15], v[144:147]
v_exp_f32 v131, v131
v_mfma_f32_16x16x32_bf16 v[148:151], v[216:219], v[40:43], v[148:151]
v_exp_f32 v132, v132
v_mfma_f32_16x16x32_bf16 v[148:151], v[220:223], v[44:47], v[148:151]
v_exp_f32 v133, v133
v_mfma_f32_16x16x32_bf16 v[152:155], v[216:219], v[72:75], v[152:155]
v_exp_f32 v134, v134
v_mfma_f32_16x16x32_bf16 v[152:155], v[220:223], v[76:79], v[152:155]
v_exp_f32 v135, v135
v_mfma_f32_16x16x32_bf16 v[156:159], v[216:219], v[104:107], v[156:159]
ds_read_b128 v[216:219], v240 offset:26624
v_mfma_f32_16x16x32_bf16 v[156:159], v[220:223], v[108:111], v[156:159]
ds_read_b128 v[220:223], v240 offset:27136
s_waitcnt lgkmcnt(2)
v_mfma_f32_16x16x32_bf16 v[144:147], v[208:211], v[16:19], v[144:147]
v_exp_f32 v136, v136
v_mfma_f32_16x16x32_bf16 v[144:147], v[212:215], v[20:23], v[144:147]
v_add_u32 v240, 0x8000, v240
v_mfma_f32_16x16x32_bf16 v[148:151], v[208:211], v[48:51], v[148:151]
v_and_b32 v240, 0x1ffff, v240
v_mfma_f32_16x16x32_bf16 v[148:151], v[212:215], v[52:55], v[148:151]
v_exp_f32 v137, v137
v_mfma_f32_16x16x32_bf16 v[152:155], v[208:211], v[80:83], v[152:155]
v_exp_f32 v138, v138
v_mfma_f32_16x16x32_bf16 v[152:155], v[212:215], v[84:87], v[152:155]
v_exp_f32 v139, v139
v_mfma_f32_16x16x32_bf16 v[156:159], v[208:211], v[112:115], v[156:159]
ds_read_b64_tr_b16 v[208:209], v246 offset:0
ds_read_b64_tr_b16 v[210:211], v246 offset:2048
v_mfma_f32_16x16x32_bf16 v[156:159], v[212:215], v[116:119], v[156:159]
ds_read_b64_tr_b16 v[212:213], v247 offset:0
s_waitcnt lgkmcnt(3)
v_mfma_f32_16x16x32_bf16 v[144:147], v[216:219], v[24:27], v[144:147]
ds_read_b64_tr_b16 v[214:215], v247 offset:2048
v_mfma_f32_16x16x32_bf16 v[144:147], v[220:223], v[28:31], v[144:147]
v_exp_f32 v140, v140
v_mfma_f32_16x16x32_bf16 v[148:151], v[216:219], v[56:59], v[148:151]
v_exp_f32 v141, v141
v_mfma_f32_16x16x32_bf16 v[148:151], v[220:223], v[60:63], v[148:151]
v_exp_f32 v142, v142
v_mfma_f32_16x16x32_bf16 v[152:155], v[216:219], v[88:91], v[152:155]
v_exp_f32 v143, v143
v_mfma_f32_16x16x32_bf16 v[152:155], v[220:223], v[92:95], v[152:155]
v_mfma_f32_16x16x32_bf16 v[156:159], v[216:219], v[120:123], v[156:159]
ds_read_b64_tr_b16 v[216:217], v246 offset:512
ds_read_b64_tr_b16 v[218:219], v246 offset:2560
v_mfma_f32_16x16x32_bf16 v[156:159], v[220:223], v[124:127], v[156:159]
ds_read_b64_tr_b16 v[220:221], v247 offset:512
s_waitcnt lgkmcnt(5)
v_mfma_f32_16x16x32_bf16 a[0:3], v[160:163], v[208:211], a[0:3]
ds_read_b64_tr_b16 v[222:223], v247 offset:2560
v_mfma_f32_16x16x32_bf16 a[4:7], v[164:167], v[208:211], a[4:7]
s_mov_b32 m0, s30
v_mfma_f32_16x16x32_bf16 a[8:11], v[168:171], v[208:211], a[8:11]
buffer_load_dwordx4 v241, s[12:15], s28 offen offset:0 sc1 lds
v_mfma_f32_16x16x32_bf16 a[12:15], v[172:175], v[208:211], a[12:15]
ds_read_b64_tr_b16 v[208:209], v246 offset:4096
s_waitcnt lgkmcnt(5)
v_mfma_f32_16x16x32_bf16 a[16:19], v[160:163], v[212:215], a[16:19]
ds_read_b64_tr_b16 v[210:211], v246 offset:6144
buffer_load_dwordx4 v241, s[12:15], s28 offen offset:1024 sc1 lds
v_mfma_f32_16x16x32_bf16 a[20:23], v[164:167], v[212:215], a[20:23]
v_mfma_f32_16x16x32_bf16 a[24:27], v[168:171], v[212:215], a[24:27]
buffer_load_dwordx4 v241, s[12:15], s28 offen offset:2048 sc1 lds
v_mfma_f32_16x16x32_bf16 a[28:31], v[172:175], v[212:215], a[28:31]
ds_read_b64_tr_b16 v[212:213], v247 offset:4096
s_waitcnt lgkmcnt(5)
v_mfma_f32_16x16x32_bf16 a[32:35], v[160:163], v[216:219], a[32:35]
ds_read_b64_tr_b16 v[214:215], v247 offset:6144
v_mfma_f32_16x16x32_bf16 a[36:39], v[164:167], v[216:219], a[36:39]
buffer_load_dwordx4 v241, s[12:15], s28 offen offset:3072 sc1 lds
v_mfma_f32_16x16x32_bf16 a[40:43], v[168:171], v[216:219], a[40:43]
v_exp_f32 v144, v144
v_mfma_f32_16x16x32_bf16 a[44:47], v[172:175], v[216:219], a[44:47]
ds_read_b64_tr_b16 v[216:217], v246 offset:4608
s_waitcnt lgkmcnt(5)
v_mfma_f32_16x16x32_bf16 a[48:51], v[160:163], v[220:223], a[48:51]
ds_read_b64_tr_b16 v[218:219], v246 offset:6656
v_mfma_f32_16x16x32_bf16 a[52:55], v[164:167], v[220:223], a[52:55]
v_exp_f32 v145, v145
v_mfma_f32_16x16x32_bf16 a[56:59], v[168:171], v[220:223], a[56:59]
v_exp_f32 v146, v146
v_mfma_f32_16x16x32_bf16 a[60:63], v[172:175], v[220:223], a[60:63]
ds_read_b64_tr_b16 v[220:221], v247 offset:4608
s_waitcnt lgkmcnt(5)
v_mfma_f32_16x16x32_bf16 a[64:67], v[160:163], v[208:211], a[64:67]
ds_read_b64_tr_b16 v[222:223], v247 offset:6656
v_mfma_f32_16x16x32_bf16 a[68:71], v[164:167], v[208:211], a[68:71]
s_waitcnt vmcnt(4)
s_barrier
v_mfma_f32_16x16x32_bf16 a[72:75], v[168:171], v[208:211], a[72:75]
v_exp_f32 v147, v147
v_mfma_f32_16x16x32_bf16 a[76:79], v[172:175], v[208:211], a[76:79]
ds_read_b128 v[208:211], v240 offset:12800
s_waitcnt lgkmcnt(5)
v_mfma_f32_16x16x32_bf16 a[80:83], v[160:163], v[212:215], a[80:83]
v_exp_f32 v148, v148
v_mfma_f32_16x16x32_bf16 a[84:87], v[164:167], v[212:215], a[84:87]
v_exp_f32 v149, v149
v_mfma_f32_16x16x32_bf16 a[88:91], v[168:171], v[212:215], a[88:91]
v_exp_f32 v150, v150
v_mfma_f32_16x16x32_bf16 a[92:95], v[172:175], v[212:215], a[92:95]
ds_read_b128 v[212:215], v240 offset:12288
s_waitcnt lgkmcnt(4)
v_mfma_f32_16x16x32_bf16 a[96:99], v[160:163], v[216:219], a[96:99]
v_exp_f32 v151, v151
v_mfma_f32_16x16x32_bf16 a[100:103], v[164:167], v[216:219], a[100:103]
v_cvt_pk_bf16_f32 v176, v128, v129
v_cvt_pk_bf16_f32 v177, v130, v131
v_mfma_f32_16x16x32_bf16 a[104:107], v[168:171], v[216:219], a[104:107]
v_exp_f32 v152, v152
v_mfma_f32_16x16x32_bf16 a[108:111], v[172:175], v[216:219], a[108:111]
ds_read_b128 v[216:219], v240 offset:0
s_waitcnt lgkmcnt(3)
v_cvt_pk_bf16_f32 v180, v132, v133
v_cvt_pk_bf16_f32 v181, v134, v135
v_mfma_f32_16x16x32_bf16 a[112:115], v[160:163], v[220:223], a[112:115]
v_exp_f32 v153, v153
v_mfma_f32_16x16x32_bf16 a[116:119], v[164:167], v[220:223], a[116:119]
v_cvt_pk_bf16_f32 v184, v136, v137
v_cvt_pk_bf16_f32 v185, v138, v139
v_mfma_f32_16x16x32_bf16 a[120:123], v[168:171], v[220:223], a[120:123]
v_exp_f32 v154, v154
v_mfma_f32_16x16x32_bf16 a[124:127], v[172:175], v[220:223], a[124:127]
ds_read_b128 v[220:223], v240 offset:512
s_waitcnt lgkmcnt(2)
v_mfma_f32_16x16x32_bf16 v[128:131], v[208:211], v[0:3], 0
v_exp_f32 v155, v155
v_mfma_f32_16x16x32_bf16 v[128:131], v[212:215], v[4:7], v[128:131]
v_cvt_pk_bf16_f32 v188, v140, v141
v_cvt_pk_bf16_f32 v189, v142, v143
v_mfma_f32_16x16x32_bf16 v[132:135], v[208:211], v[32:35], 0
v_exp_f32 v156, v156
v_mfma_f32_16x16x32_bf16 v[132:135], v[212:215], v[36:39], v[132:135]
v_exp_f32 v157, v157
v_mfma_f32_16x16x32_bf16 v[136:139], v[208:211], v[64:67], 0
v_exp_f32 v158, v158
v_mfma_f32_16x16x32_bf16 v[136:139], v[212:215], v[68:71], v[136:139]
v_exp_f32 v159, v159
v_mfma_f32_16x16x32_bf16 v[140:143], v[208:211], v[96:99], 0
ds_read_b128 v[208:211], v240 offset:4096
v_cvt_pk_bf16_f32 v178, v144, v145
v_cvt_pk_bf16_f32 v179, v146, v147
v_mfma_f32_16x16x32_bf16 v[140:143], v[212:215], v[100:103], v[140:143]
ds_read_b128 v[212:215], v240 offset:4608
s_waitcnt lgkmcnt(2)
v_cvt_pk_bf16_f32 v182, v148, v149
v_mfma_f32_16x16x32_bf16 v[128:131], v[216:219], v[8:11], v[128:131]
v_cvt_pk_bf16_f32 v183, v150, v151
v_cvt_pk_bf16_f32 v186, v152, v153
v_cvt_pk_bf16_f32 v187, v154, v155
v_mfma_f32_16x16x32_bf16 v[128:131], v[220:223], v[12:15], v[128:131]
v_cvt_pk_bf16_f32 v190, v156, v157
v_cvt_pk_bf16_f32 v191, v158, v159
v_or3_b32 v242, v176, v177, v178
v_mfma_f32_16x16x32_bf16 v[132:135], v[216:219], v[40:43], v[132:135]
v_or3_b32 v242, v242, v179, v180
v_or3_b32 v242, v242, v181, v182
v_or3_b32 v242, v242, v183, v184
v_mfma_f32_16x16x32_bf16 v[132:135], v[220:223], v[44:47], v[132:135]
v_or3_b32 v242, v242, v185, v186
v_or3_b32 v242, v242, v187, v188
v_or3_b32 v242, v242, v189, v190
v_mfma_f32_16x16x32_bf16 v[136:139], v[216:219], v[72:75], v[136:139]
v_or_b32 v242, v242, v191
v_lshl_or_b32 v242, v242, 16, v242
v_cmp_le_u32 vcc, 2.0, v242
v_mfma_f32_16x16x32_bf16 v[136:139], v[220:223], v[76:79], v[136:139]
v_mfma_f32_16x16x32_bf16 v[140:143], v[216:219], v[104:107], v[140:143]
ds_read_b128 v[216:219], v240 offset:8192
v_mfma_f32_16x16x32_bf16 v[140:143], v[220:223], v[108:111], v[140:143]
ds_read_b128 v[220:223], v240 offset:8704
s_waitcnt lgkmcnt(2)
s_cbranch_vccnz L2_rare_site4
L2_ret4:
v_mfma_f32_16x16x32_bf16 v[128:131], v[208:211], v[16:19], v[128:131]
v_mfma_f32_16x16x32_bf16 v[128:131], v[212:215], v[20:23], v[128:131]
v_mfma_f32_16x16x32_bf16 v[132:135], v[208:211], v[48:51], v[132:135]
v_mfma_f32_16x16x32_bf16 v[132:135], v[212:215], v[52:55], v[132:135]
v_mfma_f32_16x16x32_bf16 v[136:139], v[208:211], v[80:83], v[136:139]
v_mfma_f32_16x16x32_bf16 v[136:139], v[212:215], v[84:87], v[136:139]
s_sub_u32 s31, s31, 1
v_mfma_f32_16x16x32_bf16 v[140:143], v[208:211], v[112:115], v[140:143]
ds_read_b128 v[208:211], v240 offset:14848
v_mfma_f32_16x16x32_bf16 v[140:143], v[212:215], v[116:119], v[140:143]
ds_read_b128 v[212:215], v240 offset:14336
s_waitcnt lgkmcnt(2)
v_mfma_f32_16x16x32_bf16 v[128:131], v[216:219], v[24:27], v[128:131]
s_add_u32 s28, s28, s101
s_add_u32 s30, s30, 0x4000
v_mfma_f32_16x16x32_bf16 v[128:131], v[220:223], v[28:31], v[128:131]
s_and_b32 s30, s30, 0x1ffff
v_mfma_f32_16x16x32_bf16 v[132:135], v[216:219], v[56:59], v[132:135]
v_mfma_f32_16x16x32_bf16 v[132:135], v[220:223], v[60:63], v[132:135]
v_mfma_f32_16x16x32_bf16 v[136:139], v[216:219], v[88:91], v[136:139]
v_mfma_f32_16x16x32_bf16 v[136:139], v[220:223], v[92:95], v[136:139]
v_mfma_f32_16x16x32_bf16 v[140:143], v[216:219], v[120:123], v[140:143]
ds_read_b128 v[216:219], v240 offset:2048
v_mfma_f32_16x16x32_bf16 v[140:143], v[220:223], v[124:127], v[140:143]
ds_read_b128 v[220:223], v240 offset:2560
s_branch L2_loop1
.p2align 6
L2_loop:
s_waitcnt lgkmcnt(2)
L2_ret1:
v_mfma_f32_16x16x32_bf16 v[144:147], v[208:211], v[0:3], 0
v_mfma_f32_16x16x32_bf16 v[144:147], v[212:215], v[4:7], v[144:147]
v_mfma_f32_16x16x32_bf16 v[148:151], v[208:211], v[32:35], 0
v_mfma_f32_16x16x32_bf16 v[148:151], v[212:215], v[36:39], v[148:151]
v_mfma_f32_16x16x32_bf16 v[152:155], v[208:211], v[64:67], 0
v_exp_f32 v128, v128
v_mfma_f32_16x16x32_bf16 v[152:155], v[212:215], v[68:71], v[152:155]
v_exp_f32 v129, v129
v_mfma_f32_16x16x32_bf16 v[156:159], v[208:211], v[96:99], 0
ds_read_b128 v[208:211], v240 offset:22528
v_mfma_f32_16x16x32_bf16 v[156:159], v[212:215], v[100:103], v[156:159]
ds_read_b128 v[212:215], v240 offset:23040
s_waitcnt lgkmcnt(2)
v_mfma_f32_16x16x32_bf16 v[144:147], v[216:219], v[8:11], v[144:147]
v_exp_f32 v130, v130
v_mfma_f32_16x16x32_bf16 v[144:147], v[220:223], v[12:15], v[144:147]
v_exp_f32 v131, v131
v_mfma_f32_16x16x32_bf16 v[148:151], v[216:219], v[40:43], v[148:151]
v_exp_f32 v132, v132
v_mfma_f32_16x16x32_bf16 v[148:151], v[220:223], v[44:47], v[148:151]
v_exp_f32 v133, v133
v_mfma_f32_16x16x32_bf16 v[152:155], v[216:219], v[72:75], v[152:155]
v_exp_f32 v134, v134
v_mfma_f32_16x16x32_bf16 v[152:155], v[220:223], v[76:79], v[152:155]
v_exp_f32 v135, v135
v_mfma_f32_16x16x32_bf16 v[156:159], v[216:219], v[104:107], v[156:159]
ds_read_b128 v[216:219], v240 offset:26624
v_mfma_f32_16x16x32_bf16 v[156:159], v[220:223], v[108:111], v[156:159]
ds_read_b128 v[220:223], v240 offset:27136
s_waitcnt lgkmcnt(2)
v_mfma_f32_16x16x32_bf16 v[144:147], v[208:211], v[16:19], v[144:147]
v_exp_f32 v136, v136
v_mfma_f32_16x16x32_bf16 v[144:147], v[212:215], v[20:23], v[144:147]
v_add_u32 v240, 0x8000, v240
v_mfma_f32_16x16x32_bf16 v[148:151], v[208:211], v[48:51], v[148:151]
v_and_b32 v240, 0x1ffff, v240
v_mfma_f32_16x16x32_bf16 v[148:151], v[212:215], v[52:55], v[148:151]
v_exp_f32 v137, v137
v_mfma_f32_16x16x32_bf16 v[152:155], v[208:211], v[80:83], v[152:155]
v_exp_f32 v138, v138
v_mfma_f32_16x16x32_bf16 v[152:155], v[212:215], v[84:87], v[152:155]
v_exp_f32 v139, v139
v_mfma_f32_16x16x32_bf16 v[156:159], v[208:211], v[112:115], v[156:159]
ds_read_b64_tr_b16 v[208:209], v244 offset:16384
ds_read_b64_tr_b16 v[210:211], v244 offset:18432
v_mfma_f32_16x16x32_bf16 v[156:159], v[212:215], v[116:119], v[156:159]
ds_read_b64_tr_b16 v[212:213], v246 offset:0
s_waitcnt lgkmcnt(3)
v_mfma_f32_16x16x32_bf16 v[144:147], v[216:219], v[24:27], v[144:147]
ds_read_b64_tr_b16 v[214:215], v246 offset:2048
v_mfma_f32_16x16x32_bf16 v[144:147], v[220:223], v[28:31], v[144:147]
v_exp_f32 v140, v140
v_mfma_f32_16x16x32_bf16 v[148:151], v[216:219], v[56:59], v[148:151]
v_exp_f32 v141, v141
v_mfma_f32_16x16x32_bf16 v[148:151], v[220:223], v[60:63], v[148:151]
v_exp_f32 v142, v142
v_mfma_f32_16x16x32_bf16 v[152:155], v[216:219], v[88:91], v[152:155]
v_exp_f32 v143, v143
v_mfma_f32_16x16x32_bf16 v[152:155], v[220:223], v[92:95], v[152:155]
v_mfma_f32_16x16x32_bf16 v[156:159], v[216:219], v[120:123], v[156:159]
ds_read_b64_tr_b16 v[216:217], v245 offset:16384
ds_read_b64_tr_b16 v[218:219], v245 offset:18432
v_mfma_f32_16x16x32_bf16 v[156:159], v[220:223], v[124:127], v[156:159]
ds_read_b64_tr_b16 v[220:221], v247 offset:0
s_waitcnt lgkmcnt(3)
v_mfma_f32_16x16x32_bf16 a[0:3], v[176:179], v[208:211], a[0:3]
ds_read_b64_tr_b16 v[222:223], v247 offset:2048
v_mfma_f32_16x16x32_bf16 a[0:3], v[160:163], v[212:215], a[0:3]
v_mfma_f32_16x16x32_bf16 a[4:7], v[180:183], v[208:211], a[4:7]
v_mfma_f32_16x16x32_bf16 a[4:7], v[164:167], v[212:215], a[4:7]
v_mfma_f32_16x16x32_bf16 a[8:11], v[184:187], v[208:211], a[8:11]
v_mfma_f32_16x16x32_bf16 a[8:11], v[168:171], v[212:215], a[8:11]
v_mfma_f32_16x16x32_bf16 a[12:15], v[188:191], v[208:211], a[12:15]
ds_read_b64_tr_b16 v[208:209], v244 offset:16896
ds_read_b64_tr_b16 v[210:211], v244 offset:18944
v_mfma_f32_16x16x32_bf16 a[12:15], v[172:175], v[212:215], a[12:15]
ds_read_b64_tr_b16 v[212:213], v246 offset:512
s_waitcnt lgkmcnt(3)
v_mfma_f32_16x16x32_bf16 a[16:19], v[176:179], v[216:219], a[16:19]
ds_read_b64_tr_b16 v[214:215], v246 offset:2560
v_mfma_f32_16x16x32_bf16 a[16:19], v[160:163], v[220:223], a[16:19]
v_exp_f32 v144, v144
v_mfma_f32_16x16x32_bf16 a[20:23], v[180:183], v[216:219], a[20:23]
v_exp_f32 v145, v145
v_mfma_f32_16x16x32_bf16 a[20:23], v[164:167], v[220:223], a[20:23]
v_exp_f32 v146, v146
v_mfma_f32_16x16x32_bf16 a[24:27], v[184:187], v[216:219], a[24:27]
v_exp_f32 v147, v147
v_mfma_f32_16x16x32_bf16 a[24:27], v[168:171], v[220:223], a[24:27]
v_exp_f32 v148, v148
v_mfma_f32_16x16x32_bf16 a[28:31], v[188:191], v[216:219], a[28:31]
ds_read_b64_tr_b16 v[216:217], v245 offset:16896
ds_read_b64_tr_b16 v[218:219], v245 offset:18944
v_mfma_f32_16x16x32_bf16 a[28:31], v[172:175], v[220:223], a[28:31]
ds_read_b64_tr_b16 v[220:221], v247 offset:512
s_waitcnt lgkmcnt(3)
v_mfma_f32_16x16x32_bf16 a[32:35], v[176:179], v[208:211], a[32:35]
ds_read_b64_tr_b16 v[222:223], v247 offset:2560
v_mfma_f32_16x16x32_bf16 a[32:35], v[160:163], v[212:215], a[32:35]
v_exp_f32 v149, v149
v_mfma_f32_16x16x32_bf16 a[36:39], v[180:183], v[208:211], a[36:39]
v_exp_f32 v150, v150
v_mfma_f32_16x16x32_bf16 a[36:39], v[164:167], v[212:215], a[36:39]
v_exp_f32 v151, v151
v_mfma_f32_16x16x32_bf16 a[40:43], v[184:187], v[208:211], a[40:43]
s_mov_b32 m0, s30
v_mfma_f32_16x16x32_bf16 a[40:43], v[168:171], v[212:215], a[40:43]
buffer_load_dwordx4 v241, s[12:15], s28 offen offset:0 sc1 lds
v_mfma_f32_16x16x32_bf16 a[44:47], v[188:191], v[208:211], a[44:47]
ds_read_b64_tr_b16 v[208:209], v244 offset:20480
ds_read_b64_tr_b16 v[210:211], v244 offset:22528
v_mfma_f32_16x16x32_bf16 a[44:47], v[172:175], v[212:215], a[44:47]
ds_read_b64_tr_b16 v[212:213], v246 offset:4096
s_waitcnt lgkmcnt(3)
v_mfma_f32_16x16x32_bf16 a[48:51], v[176:179], v[216:219], a[48:51]
ds_read_b64_tr_b16 v[214:215], v246 offset:6144
v_mfma_f32_16x16x32_bf16 a[48:51], v[160:163], v[220:223], a[48:51]
buffer_load_dwordx4 v241, s[12:15], s28 offen offset:1024 sc1 lds
v_mfma_f32_16x16x32_bf16 a[52:55], v[180:183], v[216:219], a[52:55]
v_exp_f32 v152, v152
v_mfma_f32_16x16x32_bf16 a[52:55], v[164:167], v[220:223], a[52:55]
v_exp_f32 v153, v153
v_mfma_f32_16x16x32_bf16 a[56:59], v[184:187], v[216:219], a[56:59]
v_exp_f32 v154, v154
v_mfma_f32_16x16x32_bf16 a[56:59], v[168:171], v[220:223], a[56:59]
buffer_load_dwordx4 v241, s[12:15], s28 offen offset:2048 sc1 lds
v_mfma_f32_16x16x32_bf16 a[60:63], v[188:191], v[216:219], a[60:63]
ds_read_b64_tr_b16 v[216:217], v245 offset:20480
ds_read_b64_tr_b16 v[218:219], v245 offset:22528
v_mfma_f32_16x16x32_bf16 a[60:63], v[172:175], v[220:223], a[60:63]
ds_read_b64_tr_b16 v[220:221], v247 offset:4096
s_waitcnt lgkmcnt(3)
v_mfma_f32_16x16x32_bf16 a[64:67], v[176:179], v[208:211], a[64:67]
ds_read_b64_tr_b16 v[222:223], v247 offset:6144
v_mfma_f32_16x16x32_bf16 a[64:67], v[160:163], v[212:215], a[64:67]
buffer_load_dwordx4 v241, s[12:15], s28 offen offset:3072 sc1 lds
v_mfma_f32_16x16x32_bf16 a[68:71], v[180:183], v[208:211], a[68:71]
v_exp_f32 v155, v155
v_mfma_f32_16x16x32_bf16 a[68:71], v[164:167], v[212:215], a[68:71]
v_exp_f32 v156, v156
v_mfma_f32_16x16x32_bf16 a[72:75], v[184:187], v[208:211], a[72:75]
v_exp_f32 v157, v157
v_mfma_f32_16x16x32_bf16 a[72:75], v[168:171], v[212:215], a[72:75]
v_exp_f32 v158, v158
v_mfma_f32_16x16x32_bf16 a[76:79], v[188:191], v[208:211], a[76:79]
ds_read_b64_tr_b16 v[208:209], v244 offset:20992
ds_read_b64_tr_b16 v[210:211], v244 offset:23040
v_mfma_f32_16x16x32_bf16 a[76:79], v[172:175], v[212:215], a[76:79]
ds_read_b64_tr_b16 v[212:213], v246 offset:4608
s_waitcnt lgkmcnt(3)
v_mfma_f32_16x16x32_bf16 a[80:83], v[176:179], v[216:219], a[80:83]
ds_read_b64_tr_b16 v[214:215], v246 offset:6656
v_mfma_f32_16x16x32_bf16 a[80:83], v[160:163], v[220:223], a[80:83]
v_exp_f32 v159, v159
v_mfma_f32_16x16x32_bf16 a[84:87], v[180:183], v[216:219], a[84:87]
v_mfma_f32_16x16x32_bf16 a[84:87], v[164:167], v[220:223], a[84:87]
v_mfma_f32_16x16x32_bf16 a[88:91], v[184:187], v[216:219], a[88:91]
v_mfma_f32_16x16x32_bf16 a[88:91], v[168:171], v[220:223], a[88:91]
v_mfma_f32_16x16x32_bf16 a[92:95], v[188:191], v[216:219], a[92:95]
ds_read_b64_tr_b16 v[216:217], v245 offset:20992
ds_read_b64_tr_b16 v[218:219], v245 offset:23040
v_mfma_f32_16x16x32_bf16 a[92:95], v[172:175], v[220:223], a[92:95]
ds_read_b64_tr_b16 v[220:221], v247 offset:4608
s_waitcnt lgkmcnt(3)
v_mfma_f32_16x16x32_bf16 a[96:99], v[176:179], v[208:211], a[96:99]
ds_read_b64_tr_b16 v[222:223], v247 offset:6656
v_mfma_f32_16x16x32_bf16 a[96:99], v[160:163], v[212:215], a[96:99]
s_waitcnt vmcnt(4)
s_barrier
v_mfma_f32_16x16x32_bf16 a[100:103], v[180:183], v[208:211], a[100:103]
v_mfma_f32_16x16x32_bf16 a[100:103], v[164:167], v[212:215], a[100:103]
v_mfma_f32_16x16x32_bf16 a[104:107], v[184:187], v[208:211], a[104:107]
v_mfma_f32_16x16x32_bf16 a[104:107], v[168:171], v[212:215], a[104:107]
v_mfma_f32_16x16x32_bf16 a[108:111], v[188:191], v[208:211], a[108:111]
ds_read_b128 v[208:211], v240 offset:12800
v_mfma_f32_16x16x32_bf16 a[108:111], v[172:175], v[212:215], a[108:111]
ds_read_b128 v[212:215], v240 offset:12288
s_waitcnt lgkmcnt(2)
v_mfma_f32_16x16x32_bf16 a[112:115], v[176:179], v[216:219], a[112:115]
v_mfma_f32_16x16x32_bf16 a[112:115], v[160:163], v[220:223], a[112:115]
v_cvt_pk_bf16_f32 v176, v128, v129
v_cvt_pk_bf16_f32 v177, v130, v131
v_mfma_f32_16x16x32_bf16 a[116:119], v[180:183], v[216:219], a[116:119]
v_cvt_pk_bf16_f32 v178, v144, v145
v_cvt_pk_bf16_f32 v179, v146, v147
v_mfma_f32_16x16x32_bf16 a[116:119], v[164:167], v[220:223], a[116:119]
v_cvt_pk_bf16_f32 v180, v132, v133
v_cvt_pk_bf16_f32 v181, v134, v135
v_mfma_f32_16x16x32_bf16 a[120:123], v[184:187], v[216:219], a[120:123]
v_cvt_pk_bf16_f32 v182, v148, v149
v_cvt_pk_bf16_f32 v183, v150, v151
v_mfma_f32_16x16x32_bf16 a[120:123], v[168:171], v[220:223], a[120:123]
v_cvt_pk_bf16_f32 v184, v136, v137
v_cvt_pk_bf16_f32 v185, v138, v139
v_mfma_f32_16x16x32_bf16 a[124:127], v[188:191], v[216:219], a[124:127]
ds_read_b128 v[216:219], v240 offset:0
v_or3_b32 v242, v176, v177, v178
v_mfma_f32_16x16x32_bf16 a[124:127], v[172:175], v[220:223], a[124:127]
ds_read_b128 v[220:223], v240 offset:512
s_waitcnt lgkmcnt(2)
v_mfma_f32_16x16x32_bf16 v[128:131], v[208:211], v[0:3], 0
v_cvt_pk_bf16_f32 v186, v152, v153
v_cvt_pk_bf16_f32 v187, v154, v155
v_mfma_f32_16x16x32_bf16 v[128:131], v[212:215], v[4:7], v[128:131]
v_cvt_pk_bf16_f32 v188, v140, v141
v_cvt_pk_bf16_f32 v189, v142, v143
v_mfma_f32_16x16x32_bf16 v[132:135], v[208:211], v[32:35], 0
v_cvt_pk_bf16_f32 v190, v156, v157
v_cvt_pk_bf16_f32 v191, v158, v159
v_mfma_f32_16x16x32_bf16 v[132:135], v[212:215], v[36:39], v[132:135]
v_or3_b32 v242, v242, v179, v180
v_or3_b32 v242, v242, v181, v182
v_mfma_f32_16x16x32_bf16 v[136:139], v[208:211], v[64:67], 0
v_or3_b32 v242, v242, v183, v184
v_or3_b32 v242, v242, v185, v186
v_mfma_f32_16x16x32_bf16 v[136:139], v[212:215], v[68:71], v[136:139]
v_or3_b32 v242, v242, v187, v188
v_or3_b32 v242, v242, v189, v190
v_mfma_f32_16x16x32_bf16 v[140:143], v[208:211], v[96:99], 0
ds_read_b128 v[208:211], v240 offset:4096
v_or_b32 v242, v242, v191
v_mfma_f32_16x16x32_bf16 v[140:143], v[212:215], v[100:103], v[140:143]
ds_read_b128 v[212:215], v240 offset:4608
s_waitcnt lgkmcnt(2)
v_mfma_f32_16x16x32_bf16 v[128:131], v[216:219], v[8:11], v[128:131]
v_lshl_or_b32 v242, v242, 16, v242
v_cmp_le_u32 vcc, 2.0, v242
v_mfma_f32_16x16x32_bf16 v[128:131], v[220:223], v[12:15], v[128:131]
v_mfma_f32_16x16x32_bf16 v[132:135], v[216:219], v[40:43], v[132:135]
v_mfma_f32_16x16x32_bf16 v[132:135], v[220:223], v[44:47], v[132:135]
s_cbranch_vccnz L2_rare_site0
L2_ret0:
v_mfma_f32_16x16x32_bf16 v[136:139], v[216:219], v[72:75], v[136:139]
v_mfma_f32_16x16x32_bf16 v[136:139], v[220:223], v[76:79], v[136:139]
v_mfma_f32_16x16x32_bf16 v[140:143], v[216:219], v[104:107], v[140:143]
ds_read_b128 v[216:219], v240 offset:8192
v_mfma_f32_16x16x32_bf16 v[140:143], v[220:223], v[108:111], v[140:143]
ds_read_b128 v[220:223], v240 offset:8704
s_waitcnt lgkmcnt(2)
v_mfma_f32_16x16x32_bf16 v[128:131], v[208:211], v[16:19], v[128:131]
v_mfma_f32_16x16x32_bf16 v[128:131], v[212:215], v[20:23], v[128:131]
v_mfma_f32_16x16x32_bf16 v[132:135], v[208:211], v[48:51], v[132:135]
v_mfma_f32_16x16x32_bf16 v[132:135], v[212:215], v[52:55], v[132:135]
v_mfma_f32_16x16x32_bf16 v[136:139], v[208:211], v[80:83], v[136:139]
v_mfma_f32_16x16x32_bf16 v[136:139], v[212:215], v[84:87], v[136:139]
s_sub_u32 s31, s31, 1
v_mfma_f32_16x16x32_bf16 v[140:143], v[208:211], v[112:115], v[140:143]
ds_read_b128 v[208:211], v240 offset:14848
v_mfma_f32_16x16x32_bf16 v[140:143], v[212:215], v[116:119], v[140:143]
ds_read_b128 v[212:215], v240 offset:14336
s_waitcnt lgkmcnt(2)
v_mfma_f32_16x16x32_bf16 v[128:131], v[216:219], v[24:27], v[128:131]
s_add_u32 s28, s28, s101
s_add_u32 s30, s30, 0x4000
v_mfma_f32_16x16x32_bf16 v[128:131], v[220:223], v[28:31], v[128:131]
s_and_b32 s30, s30, 0x1ffff
v_mfma_f32_16x16x32_bf16 v[132:135], v[216:219], v[56:59], v[132:135]
s_cmp_eq_u32 s31, 0
v_mfma_f32_16x16x32_bf16 v[132:135], v[220:223], v[60:63], v[132:135]
v_mfma_f32_16x16x32_bf16 v[136:139], v[216:219], v[88:91], v[136:139]
v_mfma_f32_16x16x32_bf16 v[136:139], v[220:223], v[92:95], v[136:139]
v_mfma_f32_16x16x32_bf16 v[140:143], v[216:219], v[120:123], v[140:143]
ds_read_b128 v[216:219], v240 offset:2048
v_mfma_f32_16x16x32_bf16 v[140:143], v[220:223], v[124:127], v[140:143]
ds_read_b128 v[220:223], v240 offset:2560
s_cbranch_scc1 L2_x1
L2_loop1:
s_waitcnt lgkmcnt(2)
L2_ret3:
v_mfma_f32_16x16x32_bf16 v[144:147], v[208:211], v[0:3], 0
v_mfma_f32_16x16x32_bf16 v[144:147], v[212:215], v[4:7], v[144:147]
v_mfma_f32_16x16x32_bf16 v[148:151], v[208:211], v[32:35], 0
v_mfma_f32_16x16x32_bf16 v[148:151], v[212:215], v[36:39], v[148:151]
v_mfma_f32_16x16x32_bf16 v[152:155], v[208:211], v[64:67], 0
v_exp_f32 v128, v128
v_mfma_f32_16x16x32_bf16 v[152:155], v[212:215], v[68:71], v[152:155]
v_exp_f32 v129, v129
v_mfma_f32_16x16x32_bf16 v[156:159], v[208:211], v[96:99], 0
ds_read_b128 v[208:211], v240 offset:6144
v_mfma_f32_16x16x32_bf16 v[156:159], v[212:215], v[100:103], v[156:159]
ds_read_b128 v[212:215], v240 offset:6656
s_waitcnt lgkmcnt(2)
v_mfma_f32_16x16x32_bf16 v[144:147], v[216:219], v[8:11], v[144:147]
v_exp_f32 v130, v130
v_mfma_f32_16x16x32_bf16 v[144:147], v[220:223], v[12:15], v[144:147]
v_exp_f32 v131, v131
v_mfma_f32_16x16x32_bf16 v[148:151], v[216:219], v[40:43], v[148:151]
v_exp_f32 v132, v132
v_mfma_f32_16x16x32_bf16 v[148:151], v[220:223], v[44:47], v[148:151]
v_exp_f32 v133, v133
v_mfma_f32_16x16x32_bf16 v[152:155], v[216:219], v[72:75], v[152:155]
v_exp_f32 v134, v134
v_mfma_f32_16x16x32_bf16 v[152:155], v[220:223], v[76:79], v[152:155]
v_exp_f32 v135, v135
v_mfma_f32_16x16x32_bf16 v[156:159], v[216:219], v[104:107], v[156:159]
ds_read_b128 v[216:219], v240 offset:10240
v_mfma_f32_16x16x32_bf16 v[156:159], v[220:223], v[108:111], v[156:159]
ds_read_b128 v[220:223], v240 offset:10752
s_waitcnt lgkmcnt(2)
v_mfma_f32_16x16x32_bf16 v[144:147], v[208:211], v[16:19], v[144:147]
v_exp_f32 v136, v136
v_mfma_f32_16x16x32_bf16 v[144:147], v[212:215], v[20:23], v[144:147]
v_exp_f32 v137, v137
v_mfma_f32_16x16x32_bf16 v[148:151], v[208:211], v[48:51], v[148:151]
v_exp_f32 v138, v138
v_mfma_f32_16x16x32_bf16 v[148:151], v[212:215], v[52:55], v[148:151]
v_exp_f32 v139, v139
v_mfma_f32_16x16x32_bf16 v[152:155], v[208:211], v[80:83], v[152:155]
v_exp_f32 v140, v140
v_mfma_f32_16x16x32_bf16 v[152:155], v[212:215], v[84:87], v[152:155]
v_exp_f32 v141, v141
v_mfma_f32_16x16x32_bf16 v[156:159], v[208:211], v[112:115], v[156:159]
ds_read_b64_tr_b16 v[208:209], v246 offset:8192
ds_read_b64_tr_b16 v[210:211], v246 offset:10240
v_mfma_f32_16x16x32_bf16 v[156:159], v[212:215], v[116:119], v[156:159]
ds_read_b64_tr_b16 v[212:213], v246 offset:24576
s_waitcnt lgkmcnt(3)
v_mfma_f32_16x16x32_bf16 v[144:147], v[216:219], v[24:27], v[144:147]
ds_read_b64_tr_b16 v[214:215], v246 offset:26624
v_mfma_f32_16x16x32_bf16 v[144:147], v[220:223], v[28:31], v[144:147]
v_exp_f32 v142, v142
v_mfma_f32_16x16x32_bf16 v[148:151], v[216:219], v[56:59], v[148:151]
v_exp_f32 v143, v143
v_mfma_f32_16x16x32_bf16 v[148:151], v[220:223], v[60:63], v[148:151]
v_mfma_f32_16x16x32_bf16 v[152:155], v[216:219], v[88:91], v[152:155]
v_mfma_f32_16x16x32_bf16 v[152:155], v[220:223], v[92:95], v[152:155]
v_mfma_f32_16x16x32_bf16 v[156:159], v[216:219], v[120:123], v[156:159]
ds_read_b64_tr_b16 v[216:217], v247 offset:8192
ds_read_b64_tr_b16 v[218:219], v247 offset:10240
v_mfma_f32_16x16x32_bf16 v[156:159], v[220:223], v[124:127], v[156:159]
ds_read_b64_tr_b16 v[220:221], v247 offset:24576
s_waitcnt lgkmcnt(3)
v_mfma_f32_16x16x32_bf16 a[128:131], v[160:163], v[208:211], a[128:131]
ds_read_b64_tr_b16 v[222:223], v247 offset:26624
v_mfma_f32_16x16x32_bf16 a[128:131], v[176:179], v[212:215], a[128:131]
v_mfma_f32_16x16x32_bf16 a[132:135], v[164:167], v[208:211], a[132:135]
v_mfma_f32_16x16x32_bf16 a[132:135], v[180:183], v[212:215], a[132:135]
v_mfma_f32_16x16x32_bf16 a[136:139], v[168:171], v[208:211], a[136:139]
v_mfma_f32_16x16x32_bf16 a[136:139], v[184:187], v[212:215], a[136:139]
v_mfma_f32_16x16x32_bf16 a[140:143], v[172:175], v[208:211], a[140:143]
ds_read_b64_tr_b16 v[208:209], v246 offset:8704
ds_read_b64_tr_b16 v[210:211], v246 offset:10752
v_mfma_f32_16x16x32_bf16 a[140:143], v[188:191], v[212:215], a[140:143]
ds_read_b64_tr_b16 v[212:213], v246 offset:25088
s_waitcnt lgkmcnt(3)
v_mfma_f32_16x16x32_bf16 a[144:147], v[160:163], v[216:219], a[144:147]
ds_read_b64_tr_b16 v[214:215], v246 offset:27136
v_mfma_f32_16x16x32_bf16 a[144:147], v[176:179], v[220:223], a[144:147]
v_exp_f32 v144, v144
v_mfma_f32_16x16x32_bf16 a[148:151], v[164:167], v[216:219], a[148:151]
v_exp_f32 v145, v145
v_mfma_f32_16x16x32_bf16 a[148:151], v[180:183], v[220:223], a[148:151]
v_exp_f32 v146, v146
v_mfma_f32_16x16x32_bf16 a[152:155], v[168:171], v[216:219], a[152:155]
v_exp_f32 v147, v147
v_mfma_f32_16x16x32_bf16 a[152:155], v[184:187], v[220:223], a[152:155]
v_exp_f32 v148, v148
v_mfma_f32_16x16x32_bf16 a[156:159], v[172:175], v[216:219], a[156:159]
ds_read_b64_tr_b16 v[216:217], v247 offset:8704
ds_read_b64_tr_b16 v[218:219], v247 offset:10752
v_mfma_f32_16x16x32_bf16 a[156:159], v[188:191], v[220:223], a[156:159]
ds_read_b64_tr_b16 v[220:221], v247 offset:25088
s_waitcnt lgkmcnt(3)
v_mfma_f32_16x16x32_bf16 a[160:163], v[160:163], v[208:211], a[160:163]
ds_read_b64_tr_b16 v[222:223], v247 offset:27136
v_mfma_f32_16x16x32_bf16 a[160:163], v[176:179], v[212:215], a[160:163]
v_exp_f32 v149, v149
v_mfma_f32_16x16x32_bf16 a[164:167], v[164:167], v[208:211], a[164:167]
v_exp_f32 v150, v150
v_mfma_f32_16x16x32_bf16 a[164:167], v[180:183], v[212:215], a[164:167]
v_exp_f32 v151, v151
v_mfma_f32_16x16x32_bf16 a[168:171], v[168:171], v[208:211], a[168:171]
s_mov_b32 m0, s30
v_mfma_f32_16x16x32_bf16 a[168:171], v[184:187], v[212:215], a[168:171]
buffer_load_dwordx4 v241, s[12:15], s28 offen offset:0 sc1 lds
v_mfma_f32_16x16x32_bf16 a[172:175], v[172:175], v[208:211], a[172:175]
ds_read_b64_tr_b16 v[208:209], v246 offset:12288
ds_read_b64_tr_b16 v[210:211], v246 offset:14336
v_mfma_f32_16x16x32_bf16 a[172:175], v[188:191], v[212:215], a[172:175]
ds_read_b64_tr_b16 v[212:213], v246 offset:28672
s_waitcnt lgkmcnt(3)
v_mfma_f32_16x16x32_bf16 a[176:179], v[160:163], v[216:219], a[176:179]
ds_read_b64_tr_b16 v[214:215], v246 offset:30720
v_mfma_f32_16x16x32_bf16 a[176:179], v[176:179], v[220:223], a[176:179]
buffer_load_dwordx4 v241, s[12:15], s28 offen offset:1024 sc1 lds
v_mfma_f32_16x16x32_bf16 a[180:183], v[164:167], v[216:219], a[180:183]
v_exp_f32 v152, v152
v_mfma_f32_16x16x32_bf16 a[180:183], v[180:183], v[220:223], a[180:183]
v_exp_f32 v153, v153
v_mfma_f32_16x16x32_bf16 a[184:187], v[168:171], v[216:219], a[184:187]
v_exp_f32 v154, v154
v_mfma_f32_16x16x32_bf16 a[184:187], v[184:187], v[220:223], a[184:187]
buffer_load_dwordx4 v241, s[12:15], s28 offen offset:2048 sc1 lds
v_mfma_f32_16x16x32_bf16 a[188:191], v[172:175], v[216:219], a[188:191]
ds_read_b64_tr_b16 v[216:217], v247 offset:12288
ds_read_b64_tr_b16 v[218:219], v247 offset:14336
v_mfma_f32_16x16x32_bf16 a[188:191], v[188:191], v[220:223], a[188:191]
ds_read_b64_tr_b16 v[220:221], v247 offset:28672
s_waitcnt lgkmcnt(3)
v_mfma_f32_16x16x32_bf16 a[192:195], v[160:163], v[208:211], a[192:195]
ds_read_b64_tr_b16 v[222:223], v247 offset:30720
v_mfma_f32_16x16x32_bf16 a[192:195], v[176:179], v[212:215], a[192:195]
buffer_load_dwordx4 v241, s[12:15], s28 offen offset:3072 sc1 lds
v_mfma_f32_16x16x32_bf16 a[196:199], v[164:167], v[208:211], a[196:199]
v_exp_f32 v155, v155
v_mfma_f32_16x16x32_bf16 a[196:199], v[180:183], v[212:215], a[196:199]
v_exp_f32 v156, v156
v_mfma_f32_16x16x32_bf16 a[200:203], v[168:171], v[208:211], a[200:203]
v_exp_f32 v157, v157
v_mfma_f32_16x16x32_bf16 a[200:203], v[184:187], v[212:215], a[200:203]
v_exp_f32 v158, v158
v_mfma_f32_16x16x32_bf16 a[204:207], v[172:175], v[208:211], a[204:207]
ds_read_b64_tr_b16 v[208:209], v246 offset:12800
ds_read_b64_tr_b16 v[210:211], v246 offset:14848
v_mfma_f32_16x16x32_bf16 a[204:207], v[188:191], v[212:215], a[204:207]
ds_read_b64_tr_b16 v[212:213], v246 offset:29184
s_waitcnt lgkmcnt(3)
v_mfma_f32_16x16x32_bf16 a[208:211], v[160:163], v[216:219], a[208:211]
ds_read_b64_tr_b16 v[214:215], v246 offset:31232
v_mfma_f32_16x16x32_bf16 a[208:211], v[176:179], v[220:223], a[208:211]
v_exp_f32 v159, v159
v_mfma_f32_16x16x32_bf16 a[212:215], v[164:167], v[216:219], a[212:215]
v_mfma_f32_16x16x32_bf16 a[212:215], v[180:183], v[220:223], a[212:215]
v_mfma_f32_16x16x32_bf16 a[216:219], v[168:171], v[216:219], a[216:219]
v_mfma_f32_16x16x32_bf16 a[216:219], v[184:187], v[220:223], a[216:219]
v_mfma_f32_16x16x32_bf16 a[220:223], v[172:175], v[216:219], a[220:223]
ds_read_b64_tr_b16 v[216:217], v247 offset:12800
ds_read_b64_tr_b16 v[218:219], v247 offset:14848
v_mfma_f32_16x16x32_bf16 a[220:223], v[188:191], v[220:223], a[220:223]
ds_read_b64_tr_b16 v[220:221], v247 offset:29184
s_waitcnt lgkmcnt(3)
v_mfma_f32_16x16x32_bf16 a[224:227], v[160:163], v[208:211], a[224:227]
ds_read_b64_tr_b16 v[222:223], v247 offset:31232
v_mfma_f32_16x16x32_bf16 a[224:227], v[176:179], v[212:215], a[224:227]
s_waitcnt vmcnt(4)
s_barrier
v_mfma_f32_16x16x32_bf16 a[228:231], v[164:167], v[208:211], a[228:231]
v_mfma_f32_16x16x32_bf16 a[228:231], v[180:183], v[212:215], a[228:231]
v_mfma_f32_16x16x32_bf16 a[232:235], v[168:171], v[208:211], a[232:235]
v_mfma_f32_16x16x32_bf16 a[232:235], v[184:187], v[212:215], a[232:235]
v_mfma_f32_16x16x32_bf16 a[236:239], v[172:175], v[208:211], a[236:239]
ds_read_b128 v[208:211], v240 offset:29184
v_mfma_f32_16x16x32_bf16 a[236:239], v[188:191], v[212:215], a[236:239]
ds_read_b128 v[212:215], v240 offset:28672
s_waitcnt lgkmcnt(2)
v_mfma_f32_16x16x32_bf16 a[240:243], v[160:163], v[216:219], a[240:243]
v_mfma_f32_16x16x32_bf16 a[240:243], v[176:179], v[220:223], a[240:243]
v_cvt_pk_bf16_f32 v160, v128, v129
v_cvt_pk_bf16_f32 v161, v130, v131
v_mfma_f32_16x16x32_bf16 a[244:247], v[164:167], v[216:219], a[244:247]
v_cvt_pk_bf16_f32 v162, v144, v145
v_cvt_pk_bf16_f32 v163, v146, v147
v_mfma_f32_16x16x32_bf16 a[244:247], v[180:183], v[220:223], a[244:247]
v_cvt_pk_bf16_f32 v164, v132, v133
v_cvt_pk_bf16_f32 v165, v134, v135
v_mfma_f32_16x16x32_bf16 a[248:251], v[168:171], v[216:219], a[248:251]
v_cvt_pk_bf16_f32 v166, v148, v149
v_cvt_pk_bf16_f32 v167, v150, v151
v_mfma_f32_16x16x32_bf16 a[248:251], v[184:187], v[220:223], a[248:251]
v_cvt_pk_bf16_f32 v168, v136, v137
v_cvt_pk_bf16_f32 v169, v138, v139
v_mfma_f32_16x16x32_bf16 a[252:255], v[172:175], v[216:219], a[252:255]
ds_read_b128 v[216:219], v240 offset:16384
v_or3_b32 v242, v160, v161, v162
v_mfma_f32_16x16x32_bf16 a[252:255], v[188:191], v[220:223], a[252:255]
ds_read_b128 v[220:223], v240 offset:16896
s_waitcnt lgkmcnt(2)
v_mfma_f32_16x16x32_bf16 v[128:131], v[208:211], v[0:3], 0
v_cvt_pk_bf16_f32 v170, v152, v153
v_cvt_pk_bf16_f32 v171, v154, v155
v_mfma_f32_16x16x32_bf16 v[128:131], v[212:215], v[4:7], v[128:131]
v_cvt_pk_bf16_f32 v172, v140, v141
v_cvt_pk_bf16_f32 v173, v142, v143
v_mfma_f32_16x16x32_bf16 v[132:135], v[208:211], v[32:35], 0
v_cvt_pk_bf16_f32 v174, v156, v157
v_cvt_pk_bf16_f32 v175, v158, v159
v_mfma_f32_16x16x32_bf16 v[132:135], v[212:215], v[36:39], v[132:135]
v_or3_b32 v242, v242, v163, v164
v_or3_b32 v242, v242, v165, v166
v_mfma_f32_16x16x32_bf16 v[136:139], v[208:211], v[64:67], 0
v_or3_b32 v242, v242, v167, v168
v_or3_b32 v242, v242, v169, v170
v_mfma_f32_16x16x32_bf16 v[136:139], v[212:215], v[68:71], v[136:139]
v_or3_b32 v242, v242, v171, v172
v_or3_b32 v242, v242, v173, v174
v_mfma_f32_16x16x32_bf16 v[140:143], v[208:211], v[96:99], 0
ds_read_b128 v[208:211], v240 offset:20480
v_or_b32 v242, v242, v175
v_mfma_f32_16x16x32_bf16 v[140:143], v[212:215], v[100:103], v[140:143]
ds_read_b128 v[212:215], v240 offset:20992
s_waitcnt lgkmcnt(2)
v_mfma_f32_16x16x32_bf16 v[128:131], v[216:219], v[8:11], v[128:131]
v_mov_b32 v244, v246
v_mov_b32 v245, v247
v_mfma_f32_16x16x32_bf16 v[128:131], v[220:223], v[12:15], v[128:131]
v_add_u32 v246, 0x8000, v246
v_lshl_or_b32 v242, v242, 16, v242
v_mfma_f32_16x16x32_bf16 v[132:135], v[216:219], v[40:43], v[132:135]
v_and_b32 v246, 0x1ffff, v246
v_cmp_le_u32 vcc, 2.0, v242
v_mfma_f32_16x16x32_bf16 v[132:135], v[220:223], v[44:47], v[132:135]
v_mfma_f32_16x16x32_bf16 v[136:139], v[216:219], v[72:75], v[136:139]
v_xor_b32 v247, 32, v246
v_mfma_f32_16x16x32_bf16 v[136:139], v[220:223], v[76:79], v[136:139]
s_cbranch_vccnz L2_rare_site2
L2_ret2:
v_mfma_f32_16x16x32_bf16 v[140:143], v[216:219], v[104:107], v[140:143]
ds_read_b128 v[216:219], v240 offset:24576
v_mfma_f32_16x16x32_bf16 v[140:143], v[220:223], v[108:111], v[140:143]
ds_read_b128 v[220:223], v240 offset:25088
s_waitcnt lgkmcnt(2)
v_mfma_f32_16x16x32_bf16 v[128:131], v[208:211], v[16:19], v[128:131]
v_mfma_f32_16x16x32_bf16 v[128:131], v[212:215], v[20:23], v[128:131]
v_mfma_f32_16x16x32_bf16 v[132:135], v[208:211], v[48:51], v[132:135]
v_mfma_f32_16x16x32_bf16 v[132:135], v[212:215], v[52:55], v[132:135]
v_mfma_f32_16x16x32_bf16 v[136:139], v[208:211], v[80:83], v[136:139]
v_mfma_f32_16x16x32_bf16 v[136:139], v[212:215], v[84:87], v[136:139]
s_sub_u32 s31, s31, 1
v_mfma_f32_16x16x32_bf16 v[140:143], v[208:211], v[112:115], v[140:143]
ds_read_b128 v[208:211], v240 offset:31232
v_mfma_f32_16x16x32_bf16 v[140:143], v[212:215], v[116:119], v[140:143]
ds_read_b128 v[212:215], v240 offset:30720
s_waitcnt lgkmcnt(2)
v_mfma_f32_16x16x32_bf16 v[128:131], v[216:219], v[24:27], v[128:131]
s_add_u32 s28, s28, s101
s_add_u32 s30, s30, 0x4000
v_mfma_f32_16x16x32_bf16 v[128:131], v[220:223], v[28:31], v[128:131]
s_and_b32 s30, s30, 0x1ffff
v_mfma_f32_16x16x32_bf16 v[132:135], v[216:219], v[56:59], v[132:135]
s_cmp_eq_u32 s31, 0
v_mfma_f32_16x16x32_bf16 v[132:135], v[220:223], v[60:63], v[132:135]
v_mfma_f32_16x16x32_bf16 v[136:139], v[216:219], v[88:91], v[136:139]
v_mfma_f32_16x16x32_bf16 v[136:139], v[220:223], v[92:95], v[136:139]
v_mfma_f32_16x16x32_bf16 v[140:143], v[216:219], v[120:123], v[140:143]
ds_read_b128 v[216:219], v240 offset:18432
v_mfma_f32_16x16x32_bf16 v[140:143], v[220:223], v[124:127], v[140:143]
ds_read_b128 v[220:223], v240 offset:18944
s_cbranch_scc0 L2_loop
s_cmp_eq_u32 s100, 0
s_cbranch_scc1 L2_tail_0
s_mov_b32 s3, 0
s_branch L2_ev
L2_x1:
s_cmp_eq_u32 s100, 0
s_cbranch_scc1 L2_tail_1
s_mov_b32 s3, 1
L2_ev:
s_sub_u32 s100, s100, 1
s_mov_b32 s31, 1
v_mov_b32 v230, 0x20000
s_cmp_eq_u32 s100, 0
s_cbranch_scc1 L2_ev5
s_cmp_lg_u32 s34, 0
s_cbranch_scc1 L2_evr
s_mov_b64 exec, 1
s_cmp_eq_u32 s100, 4
s_cbranch_scc1 L2_ev1
s_cmp_eq_u32 s100, 1
s_cbranch_scc1 L2_ev4
v_cmp_eq_u64 vcc, s[98:99], v[228:229]
s_nop 1
s_bitcmp1_b32 vcc_lo, 0
s_subb_u32 s39, s39, 0
v_mov_b32 v228, s98
v_mov_b32 v229, s99
s_cmp_eq_u32 s100, 2
s_cbranch_scc1 L2_ev3
buffer_atomic_swap_x2 v[228:229], off, s[16:19], s49 offset:0 sc0 sc1
s_branch L2_evx
L2_ev1:
v_mov_b32 v228, s98
v_mov_b32 v229, s99
buffer_atomic_swap_x2 v[228:229], off, s[16:19], s95 offset:16 sc0 sc1
s_branch L2_evx
L2_ev3:
v_mov_b32 v252, s98
v_mov_b32 v253, s99
buffer_atomic_swap_x2 v[228:229], off, s[16:19], s35 offset:0 sc0 sc1
buffer_atomic_swap_x2 v[252:253], off, s[16:19], s94 offset:16 sc0 sc1
s_branch L2_evx
L2_ev4:
v_cmp_ne_u64 vcc, s[98:99], v[228:229]
s_nop 1
s_bitcmp1_b32 vcc_lo, 0
s_addc_u32 s39, s39, 0
v_cmp_ne_u64 vcc, s[98:99], v[252:253]
s_nop 1
s_bitcmp1_b32 vcc_lo, 0
s_addc_u32 s39, s39, 0
v_mov_b32 v228, s39
ds_write_b32 v230, v228
L2_evx:
s_mov_b64 exec, -1
s_branch L2_evr
L2_ev5:
ds_read_b32 v228, v230
s_waitcnt lgkmcnt(0)
v_readfirstlane_b32 s31, v228
L2_evr:
s_cmp_eq_u32 s3, 0
s_cbranch_scc1 L2_loop
s_branch L2_loop1
L2_tail_0:
s_waitcnt lgkmcnt(2)
v_add_u32 v231, s50, v243
v_mfma_f32_16x16x32_bf16 v[144:147], v[208:211], v[0:3], 0
s_mov_b32 m0, s30
ds_write_b128 v231, v[176:179] offset:0
v_mfma_f32_16x16x32_bf16 v[144:147], v[212:215], v[4:7], v[144:147]
buffer_load_dwordx4 v241, s[12:15], s28 offen offset:0 sc1 lds
ds_write_b128 v231, v[180:183] offset:1024
v_mfma_f32_16x16x32_bf16 v[148:151], v[208:211], v[32:35], 0
buffer_load_dwordx4 v241, s[12:15], s28 offen offset:1024 sc1 lds
ds_write_b128 v231, v[184:187] offset:2048
v_mfma_f32_16x16x32_bf16 v[148:151], v[212:215], v[36:39], v[148:151]
buffer_load_dwordx4 v241, s[12:15], s28 offen offset:2048 sc1 lds
ds_write_b128 v231, v[188:191] offset:3072
v_mfma_f32_16x16x32_bf16 v[152:155], v[208:211], v[64:67], 0
buffer_load_dwordx4 v241, s[12:15], s28 offen offset:3072 sc1 lds
v_add_u32 v230, 0x8000, v240
v_and_b32 v230, 0x1ffff, v230
v_mfma_f32_16x16x32_bf16 v[152:155], v[212:215], v[68:71], v[152:155]
v_exp_f32 v232, v128
v_mfma_f32_16x16x32_bf16 v[156:159], v[208:211], v[96:99], 0
ds_read_b128 v[208:211], v240 offset:22528
v_exp_f32 v233, v129
v_mfma_f32_16x16x32_bf16 v[156:159], v[212:215], v[100:103], v[156:159]
ds_read_b128 v[212:215], v240 offset:23040
s_waitcnt lgkmcnt(2)
s_and_b32 s30, s30, 0x1c000
v_mfma_f32_16x16x32_bf16 v[144:147], v[216:219], v[8:11], v[144:147]
v_exp_f32 v234, v130
v_cvt_pk_bf16_f32 v176, v232, v233
v_mfma_f32_16x16x32_bf16 v[144:147], v[220:223], v[12:15], v[144:147]
v_exp_f32 v235, v131
s_add_u32 s28, s30, 0xc000
v_mfma_f32_16x16x32_bf16 v[148:151], v[216:219], v[40:43], v[148:151]
v_exp_f32 v236, v132
v_cvt_pk_bf16_f32 v177, v234, v235
v_mfma_f32_16x16x32_bf16 v[148:151], v[220:223], v[44:47], v[148:151]
v_exp_f32 v237, v133
s_and_b32 s28, s28, 0x1ffff
v_mfma_f32_16x16x32_bf16 v[152:155], v[216:219], v[72:75], v[152:155]
v_exp_f32 v238, v134
v_cvt_pk_bf16_f32 v180, v236, v237
v_mfma_f32_16x16x32_bf16 v[152:155], v[220:223], v[76:79], v[152:155]
v_exp_f32 v239, v135
s_add_u32 s30, s30, 0x4000
v_mfma_f32_16x16x32_bf16 v[156:159], v[216:219], v[104:107], v[156:159]
ds_read_b128 v[216:219], v240 offset:26624
v_exp_f32 v232, v136
v_mfma_f32_16x16x32_bf16 v[156:159], v[220:223], v[108:111], v[156:159]
ds_read_b128 v[220:223], v240 offset:27136
s_waitcnt lgkmcnt(2)
v_cvt_pk_bf16_f32 v181, v238, v239
v_mfma_f32_16x16x32_bf16 v[144:147], v[208:211], v[16:19], v[144:147]
v_exp_f32 v233, v137
s_and_b32 s30, s30, 0x1ffff
v_mfma_f32_16x16x32_bf16 v[144:147], v[212:215], v[20:23], v[144:147]
s_waitcnt vmcnt(4)
s_barrier
s_mul_i32 s31, s34, 6144
v_mfma_f32_16x16x32_bf16 v[148:151], v[208:211], v[48:51], v[148:151]
v_exp_f32 v234, v138
v_cvt_pk_bf16_f32 v184, v232, v233
v_mfma_f32_16x16x32_bf16 v[148:151], v[212:215], v[52:55], v[148:151]
v_exp_f32 v235, v139
s_add_u32 s31, s31, s30
v_mfma_f32_16x16x32_bf16 v[152:155], v[208:211], v[80:83], v[152:155]
v_exp_f32 v236, v140
v_cvt_pk_bf16_f32 v185, v234, v235
v_mfma_f32_16x16x32_bf16 v[152:155], v[212:215], v[84:87], v[152:155]
v_exp_f32 v237, v141
s_lshl_b32 s3, s34, 10
v_mfma_f32_16x16x32_bf16 v[156:159], v[208:211], v[112:115], v[156:159]
ds_read_b128 v[208:211], v230 offset:12800
v_exp_f32 v238, v142
v_mfma_f32_16x16x32_bf16 v[156:159], v[212:215], v[116:119], v[156:159]
ds_read_b128 v[212:215], v230 offset:12288
s_waitcnt lgkmcnt(2)
v_cvt_pk_bf16_f32 v188, v236, v237
v_mfma_f32_16x16x32_bf16 v[144:147], v[216:219], v[24:27], v[144:147]
v_exp_f32 v239, v143
v_or3_b32 v242, v176, v177, v180
v_mfma_f32_16x16x32_bf16 v[144:147], v[220:223], v[28:31], v[144:147]
v_cvt_pk_bf16_f32 v189, v238, v239
v_or3_b32 v242, v242, v181, v184
v_or3_b32 v242, v242, v185, v188
v_mfma_f32_16x16x32_bf16 v[148:151], v[216:219], v[56:59], v[148:151]
v_or_b32 v242, v242, v189
v_lshl_or_b32 v242, v242, 16, v242
v_cmp_le_u32 vcc, 2.0, v242
v_mfma_f32_16x16x32_bf16 v[148:151], v[220:223], v[60:63], v[148:151]
s_add_u32 s28, s28, s3
s_add_u32 s3, s3, 24576
s_add_u32 s30, s30, s3
v_mfma_f32_16x16x32_bf16 v[152:155], v[216:219], v[88:91], v[152:155]
v_lshrrev_b32 v241, 4, v243
v_and_b32 v241, 0x30, v241
v_xor_b32 v241, v241, v243
v_mfma_f32_16x16x32_bf16 v[152:155], v[220:223], v[92:95], v[152:155]
s_cbranch_vccnz L2_rare_site6
L2_ret6:
v_and_b32 v228, 0x380, v243
v_mad_u32_u24 v241, v228, 3, v241
v_mfma_f32_16x16x32_bf16 v[156:159], v[216:219], v[120:123], v[156:159]
ds_read_b128 v[216:219], v230 offset:0
s_add_u32 m0, s31, 0
v_mfma_f32_16x16x32_bf16 v[156:159], v[220:223], v[124:127], v[156:159]
ds_read_b128 v[220:223], v230 offset:512
s_waitcnt lgkmcnt(2)
v_mfma_f32_16x16x32_bf16 v[128:131], v[208:211], v[0:3], 0
buffer_load_dwordx4 v241, s[8:11], s6 offen lds
s_add_u32 m0, s31, 2048
v_mfma_f32_16x16x32_bf16 v[128:131], v[212:215], v[4:7], v[128:131]
v_exp_f32 v232, v144
v_mfma_f32_16x16x32_bf16 v[132:135], v[208:211], v[32:35], 0
v_exp_f32 v233, v145
v_mfma_f32_16x16x32_bf16 v[132:135], v[212:215], v[36:39], v[132:135]
v_exp_f32 v234, v146
v_cvt_pk_bf16_f32 v178, v232, v233
v_mfma_f32_16x16x32_bf16 v[136:139], v[208:211], v[64:67], 0
v_exp_f32 v235, v147
v_mfma_f32_16x16x32_bf16 v[136:139], v[212:215], v[68:71], v[136:139]
v_exp_f32 v236, v148
v_cvt_pk_bf16_f32 v179, v234, v235
v_mfma_f32_16x16x32_bf16 v[140:143], v[208:211], v[96:99], 0
ds_read_b128 v[208:211], v230 offset:4096
v_exp_f32 v237, v149
v_mfma_f32_16x16x32_bf16 v[140:143], v[212:215], v[100:103], v[140:143]
ds_read_b128 v[212:215], v230 offset:4608
s_waitcnt lgkmcnt(2)
v_mfma_f32_16x16x32_bf16 v[128:131], v[216:219], v[8:11], v[128:131]
ds_write_b128 v231, v[160:163] offset:4096
v_exp_f32 v238, v150
v_mfma_f32_16x16x32_bf16 v[128:131], v[220:223], v[12:15], v[128:131]
ds_write_b128 v231, v[164:167] offset:5120
v_cvt_pk_bf16_f32 v182, v236, v237
v_mfma_f32_16x16x32_bf16 v[132:135], v[216:219], v[40:43], v[132:135]
ds_write_b128 v231, v[168:171] offset:6144
v_exp_f32 v239, v151
v_mfma_f32_16x16x32_bf16 v[132:135], v[220:223], v[44:47], v[132:135]
ds_write_b128 v231, v[172:175] offset:7168
v_exp_f32 v232, v152
v_mfma_f32_16x16x32_bf16 v[136:139], v[216:219], v[72:75], v[136:139]
v_cvt_pk_bf16_f32 v183, v238, v239
v_exp_f32 v233, v153
v_mfma_f32_16x16x32_bf16 v[136:139], v[220:223], v[76:79], v[136:139]
v_exp_f32 v234, v154
v_cvt_pk_bf16_f32 v186, v232, v233
v_mfma_f32_16x16x32_bf16 v[140:143], v[216:219], v[104:107], v[140:143]
ds_read_b128 v[216:219], v230 offset:8192
v_exp_f32 v235, v155
v_mfma_f32_16x16x32_bf16 v[140:143], v[220:223], v[108:111], v[140:143]
ds_read_b128 v[220:223], v230 offset:8704
s_waitcnt lgkmcnt(2)
v_mfma_f32_16x16x32_bf16 v[128:131], v[208:211], v[16:19], v[128:131]
v_exp_f32 v236, v156
v_cvt_pk_bf16_f32 v187, v234, v235
v_mfma_f32_16x16x32_bf16 v[128:131], v[212:215], v[20:23], v[128:131]
v_exp_f32 v237, v157
v_mfma_f32_16x16x32_bf16 v[132:135], v[208:211], v[48:51], v[132:135]
v_exp_f32 v238, v158
v_cvt_pk_bf16_f32 v190, v236, v237
v_mfma_f32_16x16x32_bf16 v[132:135], v[212:215], v[52:55], v[132:135]
v_exp_f32 v239, v159
v_or3_b32 v242, v178, v179, v182
v_mfma_f32_16x16x32_bf16 v[136:139], v[208:211], v[80:83], v[136:139]
v_cvt_pk_bf16_f32 v191, v238, v239
v_or3_b32 v242, v242, v183, v186
v_or3_b32 v242, v242, v187, v190
v_mfma_f32_16x16x32_bf16 v[136:139], v[212:215], v[84:87], v[136:139]
v_or_b32 v242, v242, v191
v_lshl_or_b32 v242, v242, 16, v242
v_cmp_le_u32 vcc, 2.0, v242
s_cbranch_vccnz L2_rare_site7
L2_ret7:
v_mfma_f32_16x16x32_bf16 v[140:143], v[208:211], v[112:115], v[140:143]
ds_read_b128 v[208:211], v230 offset:14848
buffer_load_dwordx4 v241, s[8:11], s7 offen lds
s_add_u32 m0, s31, 4096
v_mfma_f32_16x16x32_bf16 v[140:143], v[212:215], v[116:119], v[140:143]
ds_read_b128 v[212:215], v230 offset:14336
s_waitcnt lgkmcnt(2)
v_mfma_f32_16x16x32_bf16 v[128:131], v[216:219], v[24:27], v[128:131]
buffer_load_dwordx4 v241, s[8:11], s29 offen lds
s_add_u32 m0, s31, 1024
v_xor_b32 v241, 0x1040, v241
v_mfma_f32_16x16x32_bf16 v[128:131], v[220:223], v[28:31], v[128:131]
buffer_load_dwordx4 v241, s[8:11], s6 offen lds
s_add_u32 m0, s31, 3072
v_mfma_f32_16x16x32_bf16 v[132:135], v[216:219], v[56:59], v[132:135]
buffer_load_dwordx4 v241, s[8:11], s7 offen lds
s_add_u32 m0, s31, 5120
v_mfma_f32_16x16x32_bf16 v[132:135], v[220:223], v[60:63], v[132:135]
buffer_load_dwordx4 v241, s[8:11], s29 offen lds
v_mfma_f32_16x16x32_bf16 v[136:139], v[216:219], v[88:91], v[136:139]
v_mfma_f32_16x16x32_bf16 v[136:139], v[220:223], v[92:95], v[136:139]
v_mfma_f32_16x16x32_bf16 v[140:143], v[216:219], v[120:123], v[140:143]
ds_read_b128 v[216:219], v230 offset:2048
v_mfma_f32_16x16x32_bf16 v[140:143], v[220:223], v[124:127], v[140:143]
ds_read_b128 v[220:223], v230 offset:2560
s_waitcnt lgkmcnt(2)
v_mfma_f32_16x16x32_bf16 v[144:147], v[208:211], v[0:3], 0
v_mfma_f32_16x16x32_bf16 v[144:147], v[212:215], v[4:7], v[144:147]
v_exp_f32 v232, v128
v_mfma_f32_16x16x32_bf16 v[148:151], v[208:211], v[32:35], 0
v_exp_f32 v233, v129
v_mfma_f32_16x16x32_bf16 v[148:151], v[212:215], v[36:39], v[148:151]
v_exp_f32 v234, v130
v_cvt_pk_bf16_f32 v160, v232, v233
v_mfma_f32_16x16x32_bf16 v[152:155], v[208:211], v[64:67], 0
v_exp_f32 v235, v131
v_mfma_f32_16x16x32_bf16 v[152:155], v[212:215], v[68:71], v[152:155]
v_exp_f32 v236, v132
v_cvt_pk_bf16_f32 v161, v234, v235
v_mfma_f32_16x16x32_bf16 v[156:159], v[208:211], v[96:99], 0
ds_read_b128 v[208:211], v230 offset:6144
v_exp_f32 v237, v133
v_mfma_f32_16x16x32_bf16 v[156:159], v[212:215], v[100:103], v[156:159]
ds_read_b128 v[212:215], v230 offset:6656
s_waitcnt lgkmcnt(2)
v_mfma_f32_16x16x32_bf16 v[144:147], v[216:219], v[8:11], v[144:147]
v_exp_f32 v238, v134
v_cvt_pk_bf16_f32 v164, v236, v237
v_mfma_f32_16x16x32_bf16 v[144:147], v[220:223], v[12:15], v[144:147]
v_exp_f32 v239, v135
v_mfma_f32_16x16x32_bf16 v[148:151], v[216:219], v[40:43], v[148:151]
v_exp_f32 v232, v136
v_cvt_pk_bf16_f32 v165, v238, v239
v_mfma_f32_16x16x32_bf16 v[148:151], v[220:223], v[44:47], v[148:151]
v_exp_f32 v233, v137
v_mfma_f32_16x16x32_bf16 v[152:155], v[216:219], v[72:75], v[152:155]
v_exp_f32 v234, v138
v_cvt_pk_bf16_f32 v168, v232, v233
v_mfma_f32_16x16x32_bf16 v[152:155], v[220:223], v[76:79], v[152:155]
v_exp_f32 v235, v139
v_mfma_f32_16x16x32_bf16 v[156:159], v[216:219], v[104:107], v[156:159]
ds_read_b128 v[216:219], v230 offset:10240
v_exp_f32 v236, v140
v_mfma_f32_16x16x32_bf16 v[156:159], v[220:223], v[108:111], v[156:159]
ds_read_b128 v[220:223], v230 offset:10752
s_waitcnt lgkmcnt(2)
v_cvt_pk_bf16_f32 v169, v234, v235
v_mfma_f32_16x16x32_bf16 v[144:147], v[208:211], v[16:19], v[144:147]
v_exp_f32 v237, v141
v_mfma_f32_16x16x32_bf16 v[144:147], v[212:215], v[20:23], v[144:147]
s_waitcnt vmcnt(6)
s_barrier
v_mfma_f32_16x16x32_bf16 v[148:151], v[208:211], v[48:51], v[148:151]
v_exp_f32 v238, v142
v_cvt_pk_bf16_f32 v172, v236, v237
v_mfma_f32_16x16x32_bf16 v[148:151], v[212:215], v[52:55], v[148:151]
v_exp_f32 v239, v143
v_or3_b32 v242, v160, v161, v164
v_mfma_f32_16x16x32_bf16 v[152:155], v[208:211], v[80:83], v[152:155]
v_cvt_pk_bf16_f32 v173, v238, v239
v_or3_b32 v242, v242, v165, v168
v_or3_b32 v242, v242, v169, v172
v_mfma_f32_16x16x32_bf16 v[152:155], v[212:215], v[84:87], v[152:155]
v_or_b32 v242, v242, v173
v_lshl_or_b32 v242, v242, 16, v242
v_cmp_le_u32 vcc, 2.0, v242
s_cbranch_vccnz L2_rare_site8
L2_ret8:
v_mfma_f32_16x16x32_bf16 v[156:159], v[208:211], v[112:115], v[156:159]
ds_read_b128 v[208:211], v230 offset:29184
v_mfma_f32_16x16x32_bf16 v[156:159], v[212:215], v[116:119], v[156:159]
ds_read_b128 v[212:215], v230 offset:28672
s_waitcnt lgkmcnt(2)
v_mfma_f32_16x16x32_bf16 v[144:147], v[216:219], v[24:27], v[144:147]
v_mfma_f32_16x16x32_bf16 v[144:147], v[220:223], v[28:31], v[144:147]
v_mfma_f32_16x16x32_bf16 v[148:151], v[216:219], v[56:59], v[148:151]
v_mfma_f32_16x16x32_bf16 v[148:151], v[220:223], v[60:63], v[148:151]
v_mfma_f32_16x16x32_bf16 v[152:155], v[216:219], v[88:91], v[152:155]
v_mfma_f32_16x16x32_bf16 v[152:155], v[220:223], v[92:95], v[152:155]
v_mfma_f32_16x16x32_bf16 v[156:159], v[216:219], v[120:123], v[156:159]
ds_read_b128 v[216:219], v230 offset:16384
v_mfma_f32_16x16x32_bf16 v[156:159], v[220:223], v[124:127], v[156:159]
ds_read_b128 v[220:223], v230 offset:16896
s_waitcnt lgkmcnt(2)
v_mfma_f32_16x16x32_bf16 v[128:131], v[208:211], v[0:3], 0
v_mfma_f32_16x16x32_bf16 v[128:131], v[212:215], v[4:7], v[128:131]
v_exp_f32 v232, v144
v_mfma_f32_16x16x32_bf16 v[132:135], v[208:211], v[32:35], 0
v_exp_f32 v233, v145
v_mfma_f32_16x16x32_bf16 v[132:135], v[212:215], v[36:39], v[132:135]
v_exp_f32 v234, v146
v_cvt_pk_bf16_f32 v162, v232, v233
v_mfma_f32_16x16x32_bf16 v[136:139], v[208:211], v[64:67], 0
v_exp_f32 v235, v147
v_lshlrev_b32 v241, 3, v243
v_mfma_f32_16x16x32_bf16 v[136:139], v[212:215], v[68:71], v[136:139]
v_exp_f32 v236, v148
v_cvt_pk_bf16_f32 v163, v234, v235
v_mfma_f32_16x16x32_bf16 v[140:143], v[208:211], v[96:99], 0
ds_read_b128 v[208:211], v230 offset:20480
v_exp_f32 v237, v149
v_mfma_f32_16x16x32_bf16 v[140:143], v[212:215], v[100:103], v[140:143]
ds_read_b128 v[212:215], v230 offset:20992
s_waitcnt lgkmcnt(2)
s_mov_b32 s3, 0x7c28000
v_mfma_f32_16x16x32_bf16 v[128:131], v[216:219], v[8:11], v[128:131]
v_exp_f32 v238, v150
v_cvt_pk_bf16_f32 v166, v236, v237
v_mfma_f32_16x16x32_bf16 v[128:131], v[220:223], v[12:15], v[128:131]
v_exp_f32 v239, v151
buffer_load_dwordx2 v[240:241], v241, s[16:19], s3 offen sc1
v_mfma_f32_16x16x32_bf16 v[132:135], v[216:219], v[40:43], v[132:135]
v_exp_f32 v232, v152
v_cvt_pk_bf16_f32 v167, v238, v239
v_mfma_f32_16x16x32_bf16 v[132:135], v[220:223], v[44:47], v[132:135]
v_exp_f32 v233, v153
v_mfma_f32_16x16x32_bf16 v[136:139], v[216:219], v[72:75], v[136:139]
v_exp_f32 v234, v154
v_cvt_pk_bf16_f32 v170, v232, v233
v_mfma_f32_16x16x32_bf16 v[136:139], v[220:223], v[76:79], v[136:139]
v_exp_f32 v235, v155
v_mfma_f32_16x16x32_bf16 v[140:143], v[216:219], v[104:107], v[140:143]
ds_read_b128 v[216:219], v230 offset:24576
v_exp_f32 v236, v156
v_mfma_f32_16x16x32_bf16 v[140:143], v[220:223], v[108:111], v[140:143]
ds_read_b128 v[220:223], v230 offset:25088
s_waitcnt lgkmcnt(2)
v_cvt_pk_bf16_f32 v171, v234, v235
v_mfma_f32_16x16x32_bf16 v[128:131], v[208:211], v[16:19], v[128:131]
v_exp_f32 v237, v157
v_mfma_f32_16x16x32_bf16 v[128:131], v[212:215], v[20:23], v[128:131]
v_exp_f32 v238, v158
v_cvt_pk_bf16_f32 v174, v236, v237
v_mfma_f32_16x16x32_bf16 v[132:135], v[208:211], v[48:51], v[132:135]
v_exp_f32 v239, v159
v_or3_b32 v242, v162, v163, v166
v_mfma_f32_16x16x32_bf16 v[132:135], v[212:215], v[52:55], v[132:135]
v_cvt_pk_bf16_f32 v175, v238, v239
v_or3_b32 v242, v242, v167, v170
v_or3_b32 v242, v242, v171, v174
v_mfma_f32_16x16x32_bf16 v[136:139], v[208:211], v[80:83], v[136:139]
v_or_b32 v242, v242, v175
v_lshl_or_b32 v242, v242, 16, v242
v_cmp_le_u32 vcc, 2.0, v242
s_cbranch_vccnz L2_rare_site9
L2_ret9:
v_mfma_f32_16x16x32_bf16 v[136:139], v[212:215], v[84:87], v[136:139]
v_mfma_f32_16x16x32_bf16 v[140:143], v[208:211], v[112:115], v[140:143]
ds_read_b128 v[208:211], v230 offset:31232
v_mfma_f32_16x16x32_bf16 v[140:143], v[212:215], v[116:119], v[140:143]
ds_read_b128 v[212:215], v230 offset:30720
s_waitcnt lgkmcnt(2)
v_mfma_f32_16x16x32_bf16 v[128:131], v[216:219], v[24:27], v[128:131]
v_mfma_f32_16x16x32_bf16 v[128:131], v[220:223], v[28:31], v[128:131]
v_mfma_f32_16x16x32_bf16 v[132:135], v[216:219], v[56:59], v[132:135]
v_mfma_f32_16x16x32_bf16 v[132:135], v[220:223], v[60:63], v[132:135]
v_mfma_f32_16x16x32_bf16 v[136:139], v[216:219], v[88:91], v[136:139]
v_mfma_f32_16x16x32_bf16 v[136:139], v[220:223], v[92:95], v[136:139]
v_mfma_f32_16x16x32_bf16 v[140:143], v[216:219], v[120:123], v[140:143]
ds_read_b128 v[216:219], v230 offset:18432
v_mfma_f32_16x16x32_bf16 v[140:143], v[220:223], v[124:127], v[140:143]
ds_read_b128 v[220:223], v230 offset:18944
s_waitcnt lgkmcnt(2)
v_mfma_f32_16x16x32_bf16 v[144:147], v[208:211], v[0:3], 0
v_mfma_f32_16x16x32_bf16 v[144:147], v[212:215], v[4:7], v[144:147]
v_mfma_f32_16x16x32_bf16 v[148:151], v[208:211], v[32:35], 0
v_mfma_f32_16x16x32_bf16 v[148:151], v[212:215], v[36:39], v[148:151]
v_mfma_f32_16x16x32_bf16 v[152:155], v[208:211], v[64:67], 0
v_exp_f32 v232, v128
v_mfma_f32_16x16x32_bf16 v[152:155], v[212:215], v[68:71], v[152:155]
v_exp_f32 v233, v129
v_mfma_f32_16x16x32_bf16 v[156:159], v[208:211], v[96:99], 0
ds_read_b128 v[208:211], v230 offset:22528
v_exp_f32 v234, v130
v_mfma_f32_16x16x32_bf16 v[156:159], v[212:215], v[100:103], v[156:159]
ds_read_b128 v[212:215], v230 offset:23040
s_waitcnt lgkmcnt(2)
v_cvt_pk_bf16_f32 v0, v232, v233
v_mfma_f32_16x16x32_bf16 v[144:147], v[216:219], v[8:11], v[144:147]
v_exp_f32 v235, v131
v_mfma_f32_16x16x32_bf16 v[144:147], v[220:223], v[12:15], v[144:147]
ds_read_b128 v[4:7], v231 offset:0
v_exp_f32 v236, v132
v_mfma_f32_16x16x32_bf16 v[148:151], v[216:219], v[40:43], v[148:151]
ds_read_b128 v[36:39], v231 offset:1024
v_cvt_pk_bf16_f32 v1, v234, v235
v_mfma_f32_16x16x32_bf16 v[148:151], v[220:223], v[44:47], v[148:151]
v_exp_f32 v237, v133
v_mfma_f32_16x16x32_bf16 v[152:155], v[216:219], v[72:75], v[152:155]
v_exp_f32 v238, v134
v_cvt_pk_bf16_f32 v32, v236, v237
v_mfma_f32_16x16x32_bf16 v[152:155], v[220:223], v[76:79], v[152:155]
ds_read_b128 v[68:71], v231 offset:2048
ds_read_b128 v[8:11], v231 offset:4096
v_mfma_f32_16x16x32_bf16 v[156:159], v[216:219], v[104:107], v[156:159]
ds_read_b128 v[216:219], v230 offset:26624
v_add_u32 v12, 0x8000, v244
v_and_b32 v12, 0x1ffff, v12
ds_read_b128 v[100:103], v231 offset:3072
ds_read_b128 v[40:43], v231 offset:5120
v_mfma_f32_16x16x32_bf16 v[156:159], v[220:223], v[108:111], v[156:159]
ds_read_b128 v[220:223], v230 offset:27136
s_waitcnt lgkmcnt(2)
v_add_u32 v14, 0x10000, v244
v_and_b32 v14, 0x1ffff, v14
v_mfma_f32_16x16x32_bf16 v[144:147], v[208:211], v[16:19], v[144:147]
v_xor_b32 v13, 32, v12
v_xor_b32 v15, 32, v14
v_mfma_f32_16x16x32_bf16 v[144:147], v[212:215], v[20:23], v[144:147]
ds_read_b128 v[72:75], v231 offset:6144
v_exp_f32 v239, v135
v_mfma_f32_16x16x32_bf16 v[148:151], v[208:211], v[48:51], v[148:151]
ds_read_b128 v[104:107], v231 offset:7168
v_exp_f32 v232, v136
v_mfma_f32_16x16x32_bf16 v[148:151], v[212:215], v[52:55], v[148:151]
v_cvt_pk_bf16_f32 v33, v238, v239
v_exp_f32 v233, v137
v_mfma_f32_16x16x32_bf16 v[152:155], v[208:211], v[80:83], v[152:155]
v_exp_f32 v234, v138
v_cvt_pk_bf16_f32 v64, v232, v233
v_mfma_f32_16x16x32_bf16 v[152:155], v[212:215], v[84:87], v[152:155]
v_exp_f32 v235, v139
v_mfma_f32_16x16x32_bf16 v[156:159], v[208:211], v[112:115], v[156:159]
ds_read_b64_tr_b16 v[208:209], v12 offset:12800
ds_read_b64_tr_b16 v[210:211], v12 offset:14848
v_mfma_f32_16x16x32_bf16 v[156:159], v[212:215], v[116:119], v[156:159]
ds_read_b64_tr_b16 v[212:213], v12 offset:29184
s_waitcnt lgkmcnt(3)
v_mfma_f32_16x16x32_bf16 v[144:147], v[216:219], v[24:27], v[144:147]
ds_read_b64_tr_b16 v[214:215], v12 offset:31232
v_exp_f32 v236, v140
v_mfma_f32_16x16x32_bf16 v[144:147], v[220:223], v[28:31], v[144:147]
v_cvt_pk_bf16_f32 v65, v234, v235
v_exp_f32 v237, v141
v_mfma_f32_16x16x32_bf16 v[148:151], v[216:219], v[56:59], v[148:151]
v_exp_f32 v238, v142
v_cvt_pk_bf16_f32 v96, v236, v237
v_mfma_f32_16x16x32_bf16 v[148:151], v[220:223], v[60:63], v[148:151]
v_exp_f32 v239, v143
v_or3_b32 v242, v0, v1, v32
v_mfma_f32_16x16x32_bf16 v[152:155], v[216:219], v[88:91], v[152:155]
v_cvt_pk_bf16_f32 v97, v238, v239
v_or3_b32 v242, v242, v33, v64
v_or3_b32 v242, v242, v65, v96
v_mfma_f32_16x16x32_bf16 v[152:155], v[220:223], v[92:95], v[152:155]
v_or_b32 v242, v242, v97
v_lshl_or_b32 v242, v242, 16, v242
v_cmp_le_u32 vcc, 2.0, v242
s_cbranch_vccnz L2_rare_site10
L2_ret10:
v_mfma_f32_16x16x32_bf16 v[156:159], v[216:219], v[120:123], v[156:159]
ds_read_b64_tr_b16 v[216:217], v14 offset:12800
ds_read_b64_tr_b16 v[218:219], v14 offset:14848
s_waitcnt vmcnt(0)
v_mfma_f32_16x16x32_bf16 v[156:159], v[220:223], v[124:127], v[156:159]
ds_read_b64_tr_b16 v[220:221], v13 offset:12800
s_waitcnt lgkmcnt(3)
v_cmp_ne_u64_e64 s[38:39], s[98:99], v[240:241]
v_mfma_f32_16x16x32_bf16 a[224:227], v[8:11], v[208:211], a[224:227]
ds_read_b64_tr_b16 v[222:223], v13 offset:14848
s_and_b64 s[38:39], s[38:39], s[96:97]
s_cbranch_scc1 LF_hl_1
LF_hlret_1:
v_mfma_f32_16x16x32_bf16 a[224:227], v[176:179], v[212:215], a[224:227]
v_exp_f32 v232, v144
v_lshrrev_b32 v241, 4, v243
v_mfma_f32_16x16x32_bf16 a[228:231], v[40:43], v[208:211], a[228:231]
v_exp_f32 v233, v145
v_and_b32 v241, 0x30, v241
v_mfma_f32_16x16x32_bf16 a[228:231], v[180:183], v[212:215], a[228:231]
v_exp_f32 v234, v146
v_xor_b32 v241, v241, v243
v_mfma_f32_16x16x32_bf16 a[232:235], v[72:75], v[208:211], a[232:235]
v_cvt_pk_bf16_f32 v2, v232, v233
v_and_b32 v228, 0x380, v243
v_mad_u32_u24 v241, v228, 3, v241
v_mfma_f32_16x16x32_bf16 a[232:235], v[184:187], v[212:215], a[232:235]
v_exp_f32 v235, v147
v_add_u32 v241, 0x7000000, v241
v_mfma_f32_16x16x32_bf16 a[236:239], v[104:107], v[208:211], a[236:239]
ds_read_b64_tr_b16 v[208:209], v13 offset:29184
ds_read_b64_tr_b16 v[210:211], v13 offset:31232
v_and_b32 v110, 0x70, v243
v_mfma_f32_16x16x32_bf16 a[236:239], v[188:191], v[212:215], a[236:239]
ds_read_b64_tr_b16 v[212:213], v15 offset:12800
s_waitcnt lgkmcnt(5)
v_lshlrev_b32 v110, 3, v110
v_mfma_f32_16x16x32_bf16 a[224:227], v[160:163], v[216:219], a[224:227]
ds_read_b64_tr_b16 v[214:215], v15 offset:14848
v_add_u32 v110, 0x7c32000, v110
buffer_load_dwordx2 v[108:109], v110, s[16:19], 0 offen sc1
v_mfma_f32_16x16x32_bf16 a[228:231], v[164:167], v[216:219], a[228:231]
v_exp_f32 v236, v148
v_mfma_f32_16x16x32_bf16 a[232:235], v[168:171], v[216:219], a[232:235]
v_cvt_pk_bf16_f32 v3, v234, v235
s_add_u32 m0, s28, 0
v_mfma_f32_16x16x32_bf16 a[236:239], v[172:175], v[216:219], a[236:239]
ds_read_b64_tr_b16 v[216:217], v244 offset:16384
s_waitcnt lgkmcnt(5)
v_mfma_f32_16x16x32_bf16 a[240:243], v[8:11], v[220:223], a[240:243]
ds_read_b64_tr_b16 v[218:219], v244 offset:18432
buffer_load_dwordx4 v241, s[16:19], s6 offen sc1 lds
s_add_u32 m0, s28, 8192
v_mfma_f32_16x16x32_bf16 a[244:247], v[40:43], v[220:223], a[244:247]
v_exp_f32 v237, v149
v_mfma_f32_16x16x32_bf16 a[248:251], v[72:75], v[220:223], a[248:251]
v_exp_f32 v238, v150
v_mfma_f32_16x16x32_bf16 a[252:255], v[104:107], v[220:223], a[252:255]
ds_read_b64_tr_b16 v[220:221], v12 offset:0
s_waitcnt lgkmcnt(3)
v_mfma_f32_16x16x32_bf16 a[240:243], v[176:179], v[208:211], a[240:243]
ds_read_b64_tr_b16 v[222:223], v12 offset:2048
v_cvt_pk_bf16_f32 v34, v236, v237
v_mfma_f32_16x16x32_bf16 a[240:243], v[160:163], v[212:215], a[240:243]
v_exp_f32 v239, v151
v_mfma_f32_16x16x32_bf16 a[244:247], v[180:183], v[208:211], a[244:247]
v_exp_f32 v232, v152
v_mfma_f32_16x16x32_bf16 a[244:247], v[164:167], v[212:215], a[244:247]
v_cvt_pk_bf16_f32 v35, v238, v239
buffer_load_dwordx4 v241, s[16:19], s7 offen sc1 lds
s_add_u32 m0, s30, 0
v_mfma_f32_16x16x32_bf16 a[248:251], v[184:187], v[208:211], a[248:251]
v_exp_f32 v233, v153
v_mfma_f32_16x16x32_bf16 a[248:251], v[168:171], v[212:215], a[248:251]
v_exp_f32 v234, v154
v_mfma_f32_16x16x32_bf16 a[252:255], v[188:191], v[208:211], a[252:255]
ds_read_b64_tr_b16 v[208:209], v12 offset:16384
ds_read_b64_tr_b16 v[210:211], v12 offset:18432
v_mfma_f32_16x16x32_bf16 a[252:255], v[172:175], v[212:215], a[252:255]
ds_read_b64_tr_b16 v[212:213], v14 offset:0
s_waitcnt lgkmcnt(3)
v_mfma_f32_16x16x32_bf16 a[0:3], v[4:7], v[216:219], a[0:3]
ds_read_b64_tr_b16 v[214:215], v14 offset:2048
v_cvt_pk_bf16_f32 v66, v232, v233
v_mfma_f32_16x16x32_bf16 a[0:3], v[8:11], v[220:223], a[0:3]
v_exp_f32 v235, v155
v_mfma_f32_16x16x32_bf16 a[4:7], v[36:39], v[216:219], a[4:7]
v_exp_f32 v236, v156
v_mfma_f32_16x16x32_bf16 a[4:7], v[40:43], v[220:223], a[4:7]
v_cvt_pk_bf16_f32 v67, v234, v235
buffer_load_dwordx4 v241, s[16:19], s29 offen sc1 lds
s_add_u32 m0, s28, 4096
v_mfma_f32_16x16x32_bf16 a[8:11], v[68:71], v[216:219], a[8:11]
v_exp_f32 v237, v157
v_xor_b32 v241, 0x1040, v241
v_mfma_f32_16x16x32_bf16 a[8:11], v[72:75], v[220:223], a[8:11]
v_exp_f32 v238, v158
v_mfma_f32_16x16x32_bf16 a[12:15], v[100:103], v[216:219], a[12:15]
ds_read_b64_tr_b16 v[216:217], v245 offset:16384
ds_read_b64_tr_b16 v[218:219], v245 offset:18432
v_mfma_f32_16x16x32_bf16 a[12:15], v[104:107], v[220:223], a[12:15]
ds_read_b64_tr_b16 v[220:221], v13 offset:0
s_waitcnt lgkmcnt(3)
v_mfma_f32_16x16x32_bf16 a[0:3], v[176:179], v[208:211], a[0:3]
ds_read_b64_tr_b16 v[222:223], v13 offset:2048
v_cvt_pk_bf16_f32 v98, v236, v237
v_mfma_f32_16x16x32_bf16 a[0:3], v[160:163], v[212:215], a[0:3]
v_exp_f32 v239, v159
v_mfma_f32_16x16x32_bf16 a[4:7], v[180:183], v[208:211], a[4:7]
v_or3_b32 v242, v2, v3, v34
v_cvt_pk_bf16_f32 v99, v238, v239
v_mfma_f32_16x16x32_bf16 a[4:7], v[164:167], v[212:215], a[4:7]
v_or3_b32 v242, v242, v35, v66
v_or3_b32 v242, v242, v67, v98
v_mfma_f32_16x16x32_bf16 a[8:11], v[184:187], v[208:211], a[8:11]
v_or_b32 v242, v242, v99
v_lshl_or_b32 v242, v242, 16, v242
v_mfma_f32_16x16x32_bf16 a[8:11], v[168:171], v[212:215], a[8:11]
v_cmp_le_u32 vcc, 2.0, v242
s_cbranch_vccnz L2_rare_site11
L2_ret11:
v_mfma_f32_16x16x32_bf16 a[12:15], v[188:191], v[208:211], a[12:15]
ds_read_b64_tr_b16 v[208:209], v13 offset:16384
ds_read_b64_tr_b16 v[210:211], v13 offset:18432
v_mfma_f32_16x16x32_bf16 a[12:15], v[172:175], v[212:215], a[12:15]
ds_read_b64_tr_b16 v[212:213], v15 offset:0
s_waitcnt lgkmcnt(3)
v_mfma_f32_16x16x32_bf16 a[16:19], v[4:7], v[216:219], a[16:19]
ds_read_b64_tr_b16 v[214:215], v15 offset:2048
buffer_load_dwordx4 v241, s[16:19], s6 offen sc1 lds
s_add_u32 m0, s28, 12288
v_mfma_f32_16x16x32_bf16 a[16:19], v[8:11], v[220:223], a[16:19]
buffer_load_dwordx4 v241, s[16:19], s7 offen sc1 lds
s_add_u32 m0, s30, 4096
v_mfma_f32_16x16x32_bf16 a[20:23], v[36:39], v[216:219], a[20:23]
buffer_load_dwordx4 v241, s[16:19], s29 offen sc1 lds
v_mfma_f32_16x16x32_bf16 a[20:23], v[40:43], v[220:223], a[20:23]
v_mfma_f32_16x16x32_bf16 a[24:27], v[68:71], v[216:219], a[24:27]
v_mfma_f32_16x16x32_bf16 a[24:27], v[72:75], v[220:223], a[24:27]
v_mfma_f32_16x16x32_bf16 a[28:31], v[100:103], v[216:219], a[28:31]
ds_read_b64_tr_b16 v[216:217], v14 offset:29184
ds_read_b64_tr_b16 v[218:219], v14 offset:31232
v_mfma_f32_16x16x32_bf16 a[28:31], v[104:107], v[220:223], a[28:31]
ds_read_b64_tr_b16 v[220:221], v15 offset:29184
s_waitcnt lgkmcnt(3)
v_mfma_f32_16x16x32_bf16 a[16:19], v[176:179], v[208:211], a[16:19]
ds_read_b64_tr_b16 v[222:223], v15 offset:31232
v_mfma_f32_16x16x32_bf16 a[16:19], v[160:163], v[212:215], a[16:19]
v_mfma_f32_16x16x32_bf16 a[20:23], v[180:183], v[208:211], a[20:23]
v_mfma_f32_16x16x32_bf16 a[20:23], v[164:167], v[212:215], a[20:23]
v_mfma_f32_16x16x32_bf16 a[24:27], v[184:187], v[208:211], a[24:27]
v_mfma_f32_16x16x32_bf16 a[24:27], v[168:171], v[212:215], a[24:27]
v_mfma_f32_16x16x32_bf16 a[28:31], v[188:191], v[208:211], a[28:31]
ds_read_b64_tr_b16 v[208:209], v14 offset:16384
ds_read_b64_tr_b16 v[210:211], v14 offset:18432
v_mfma_f32_16x16x32_bf16 a[28:31], v[172:175], v[212:215], a[28:31]
ds_read_b64_tr_b16 v[212:213], v15 offset:16384
s_waitcnt lgkmcnt(5)
v_mfma_f32_16x16x32_bf16 a[224:227], v[0:3], v[216:219], a[224:227]
ds_read_b64_tr_b16 v[214:215], v15 offset:18432
v_lshrrev_b32 v228, 4, v243
v_and_b32 v228, 0x3c, v228
v_mfma_f32_16x16x32_bf16 a[228:231], v[32:35], v[216:219], a[228:231]
v_sub_f32 v224, 0, v224
v_sub_f32 v225, 0, v225
v_sub_f32 v226, 0, v226
v_mfma_f32_16x16x32_bf16 a[232:235], v[64:67], v[216:219], a[232:235]
v_sub_f32 v227, 0, v227
ds_bpermute_b32 v232, v228, v224
ds_bpermute_b32 v234, v228, v225
v_mfma_f32_16x16x32_bf16 a[236:239], v[96:99], v[216:219], a[236:239]
ds_read_b64_tr_b16 v[216:217], v244 offset:16896
s_waitcnt lgkmcnt(5)
ds_bpermute_b32 v236, v228, v226
v_mfma_f32_16x16x32_bf16 a[240:243], v[0:3], v[220:223], a[240:243]
ds_read_b64_tr_b16 v[218:219], v244 offset:18944
ds_bpermute_b32 v238, v228, v227
v_bfe_u32 v228, v243, 4, 1
v_mfma_f32_16x16x32_bf16 a[244:247], v[32:35], v[220:223], a[244:247]
v_mul_u32_u24 v228, 768, v228
v_lshl_add_u32 v228, s37, 7, v228
v_lshrrev_b32 v242, 6, v243
v_mfma_f32_16x16x32_bf16 a[248:251], v[64:67], v[220:223], a[248:251]
v_lshl_add_u32 v242, v242, 3, v228
v_accvgpr_read_b32 v128, a224
v_accvgpr_read_b32 v129, a225
v_mfma_f32_16x16x32_bf16 a[252:255], v[96:99], v[220:223], a[252:255]
ds_read_b64_tr_b16 v[220:221], v12 offset:512
s_waitcnt lgkmcnt(5)
v_accvgpr_read_b32 v130, a226
v_mfma_f32_16x16x32_bf16 a[0:3], v[0:3], v[208:211], a[0:3]
ds_read_b64_tr_b16 v[222:223], v12 offset:2560
v_accvgpr_read_b32 v131, a227
v_cvt_pk_bf16_f32 v28, v128, v129
v_mfma_f32_16x16x32_bf16 a[4:7], v[32:35], v[208:211], a[4:7]
v_cvt_pk_bf16_f32 v29, v130, v131
v_accvgpr_read_b32 v136, a228
v_accvgpr_read_b32 v137, a229
v_mfma_f32_16x16x32_bf16 a[8:11], v[64:67], v[208:211], a[8:11]
v_accvgpr_read_b32 v138, a230
v_accvgpr_read_b32 v139, a231
v_cvt_pk_bf16_f32 v60, v136, v137
v_mfma_f32_16x16x32_bf16 a[12:15], v[96:99], v[208:211], a[12:15]
ds_read_b64_tr_b16 v[208:209], v12 offset:16896
s_waitcnt lgkmcnt(5)
v_cvt_pk_bf16_f32 v61, v138, v139
v_mfma_f32_16x16x32_bf16 a[16:19], v[0:3], v[212:215], a[16:19]
ds_read_b64_tr_b16 v[210:211], v12 offset:18944
v_accvgpr_read_b32 v144, a232
v_accvgpr_read_b32 v145, a233
v_mfma_f32_16x16x32_bf16 a[20:23], v[32:35], v[212:215], a[20:23]
v_accvgpr_read_b32 v146, a234
v_accvgpr_read_b32 v147, a235
v_cvt_pk_bf16_f32 v92, v144, v145
v_mfma_f32_16x16x32_bf16 a[24:27], v[64:67], v[212:215], a[24:27]
v_cvt_pk_bf16_f32 v93, v146, v147
v_accvgpr_read_b32 v152, a236
v_accvgpr_read_b32 v153, a237
v_mfma_f32_16x16x32_bf16 a[28:31], v[96:99], v[212:215], a[28:31]
ds_read_b64_tr_b16 v[212:213], v14 offset:512
s_waitcnt lgkmcnt(3)
v_accvgpr_read_b32 v154, a238
v_mfma_f32_16x16x32_bf16 a[32:35], v[4:7], v[216:219], a[32:35]
ds_read_b64_tr_b16 v[214:215], v14 offset:2560
v_accvgpr_read_b32 v155, a239
v_cvt_pk_bf16_f32 v124, v152, v153
v_mfma_f32_16x16x32_bf16 a[32:35], v[8:11], v[220:223], a[32:35]
v_cvt_pk_bf16_f32 v125, v154, v155
v_accvgpr_read_b32 v132, a240
v_accvgpr_read_b32 v133, a241
v_mfma_f32_16x16x32_bf16 a[36:39], v[36:39], v[216:219], a[36:39]
v_accvgpr_read_b32 v134, a242
v_accvgpr_read_b32 v135, a243
v_cvt_pk_bf16_f32 v30, v132, v133
v_mfma_f32_16x16x32_bf16 a[36:39], v[40:43], v[220:223], a[36:39]
v_cvt_pk_bf16_f32 v31, v134, v135
buffer_store_dwordx4 v[28:31], v243, s[20:23], s44 offen offset:3072 sc1
ds_write_b128 v231, v[28:31] offset:7168
v_mfma_f32_16x16x32_bf16 a[40:43], v[68:71], v[216:219], a[40:43]
v_accvgpr_read_b32 v140, a244
v_accvgpr_read_b32 v141, a245
v_accvgpr_read_b32 v142, a246
v_mfma_f32_16x16x32_bf16 a[40:43], v[72:75], v[220:223], a[40:43]
v_accvgpr_read_b32 v143, a247
v_cvt_pk_bf16_f32 v62, v140, v141
v_cvt_pk_bf16_f32 v63, v142, v143
v_mfma_f32_16x16x32_bf16 a[44:47], v[100:103], v[216:219], a[44:47]
ds_read_b64_tr_b16 v[216:217], v14 offset:16896
ds_read_b64_tr_b16 v[218:219], v14 offset:18944
buffer_store_dwordx4 v[60:63], v243, s[20:23], s45 offen offset:3072 sc1
v_mfma_f32_16x16x32_bf16 a[44:47], v[104:107], v[220:223], a[44:47]
ds_read_b64_tr_b16 v[220:221], v245 offset:16896
s_waitcnt lgkmcnt(3)
v_accvgpr_read_b32 v148, a248
v_mfma_f32_16x16x32_bf16 a[32:35], v[176:179], v[208:211], a[32:35]
ds_read_b64_tr_b16 v[222:223], v245 offset:18944
v_accvgpr_read_b32 v149, a249
v_accvgpr_read_b32 v150, a250
v_mfma_f32_16x16x32_bf16 a[32:35], v[160:163], v[212:215], a[32:35]
v_accvgpr_read_b32 v151, a251
v_cvt_pk_bf16_f32 v94, v148, v149
v_cvt_pk_bf16_f32 v95, v150, v151
v_mfma_f32_16x16x32_bf16 a[36:39], v[180:183], v[208:211], a[36:39]
buffer_store_dwordx4 v[92:95], v243, s[20:23], s46 offen offset:3072 sc1
v_accvgpr_read_b32 v156, a252
v_accvgpr_read_b32 v157, a253
v_mfma_f32_16x16x32_bf16 a[36:39], v[164:167], v[212:215], a[36:39]
v_accvgpr_read_b32 v158, a254
v_accvgpr_read_b32 v159, a255
v_cvt_pk_bf16_f32 v126, v156, v157
v_mfma_f32_16x16x32_bf16 a[40:43], v[184:187], v[208:211], a[40:43]
v_cvt_pk_bf16_f32 v127, v158, v159
buffer_store_dwordx4 v[124:127], v243, s[20:23], s47 offen offset:3072 sc1
v_mov_b32_dpp v233, v132 row_newbcast:15 row_mask:0xf bank_mask:0x1
v_mfma_f32_16x16x32_bf16 a[40:43], v[168:171], v[212:215], a[40:43]
v_mov_b32_dpp v235, v140 row_newbcast:15 row_mask:0xf bank_mask:0x1
v_mov_b32_dpp v237, v148 row_newbcast:15 row_mask:0xf bank_mask:0x1
v_mov_b32_dpp v239, v156 row_newbcast:15 row_mask:0xf bank_mask:0x1
v_mfma_f32_16x16x32_bf16 a[44:47], v[188:191], v[208:211], a[44:47]
ds_read_b64_tr_b16 v[208:209], v13 offset:512
ds_read_b64_tr_b16 v[210:211], v13 offset:2560
v_mov_b32_dpp v233, v133 row_newbcast:15 row_mask:0xf bank_mask:0x2
v_mfma_f32_16x16x32_bf16 a[44:47], v[172:175], v[212:215], a[44:47]
ds_read_b64_tr_b16 v[212:213], v13 offset:16896
s_waitcnt lgkmcnt(5)
v_mov_b32_dpp v235, v141 row_newbcast:15 row_mask:0xf bank_mask:0x2
v_mfma_f32_16x16x32_bf16 a[32:35], v[0:3], v[216:219], a[32:35]
ds_read_b64_tr_b16 v[214:215], v13 offset:18944
v_mov_b32_dpp v237, v149 row_newbcast:15 row_mask:0xf bank_mask:0x2
v_mov_b32_dpp v239, v157 row_newbcast:15 row_mask:0xf bank_mask:0x2
v_mfma_f32_16x16x32_bf16 a[36:39], v[32:35], v[216:219], a[36:39]
v_mov_b32_dpp v233, v134 row_newbcast:15 row_mask:0xf bank_mask:0x4
v_mov_b32_dpp v235, v142 row_newbcast:15 row_mask:0xf bank_mask:0x4
v_mov_b32_dpp v237, v150 row_newbcast:15 row_mask:0xf bank_mask:0x4
v_mfma_f32_16x16x32_bf16 a[40:43], v[64:67], v[216:219], a[40:43]
v_mov_b32_dpp v239, v158 row_newbcast:15 row_mask:0xf bank_mask:0x4
v_mov_b32_dpp v233, v135 row_newbcast:15 row_mask:0xf bank_mask:0x8
v_mov_b32_dpp v235, v143 row_newbcast:15 row_mask:0xf bank_mask:0x8
v_mfma_f32_16x16x32_bf16 a[44:47], v[96:99], v[216:219], a[44:47]
ds_read_b64_tr_b16 v[216:217], v15 offset:512
s_waitcnt lgkmcnt(5)
v_mov_b32_dpp v237, v151 row_newbcast:15 row_mask:0xf bank_mask:0x8
v_mfma_f32_16x16x32_bf16 a[48:51], v[4:7], v[220:223], a[48:51]
ds_read_b64_tr_b16 v[218:219], v15 offset:2560
v_mov_b32_dpp v239, v159 row_newbcast:15 row_mask:0xf bank_mask:0x8
v_mfma_f32_16x16x32_bf16 a[52:55], v[36:39], v[220:223], a[52:55]
s_mov_b32 exec_lo, 0x33333333
s_mov_b32 exec_hi, 0x33333333
buffer_store_dwordx2 v[232:233], v242, s[24:27], s48 offen sc1
s_lshr_b32 s3, s41, 2
buffer_store_dwordx2 v[234:235], v242, s[24:27], s3 offen sc1
s_lshr_b32 s3, s42, 2
buffer_store_dwordx2 v[236:237], v242, s[24:27], s3 offen sc1
s_lshr_b32 s3, s43, 2
buffer_store_dwordx2 v[238:239], v242, s[24:27], s3 offen sc1
s_mov_b64 exec, -1
v_mfma_f32_16x16x32_bf16 a[56:59], v[68:71], v[220:223], a[56:59]
v_accvgpr_read_b32 v128, a0
v_accvgpr_read_b32 v129, a1
v_accvgpr_read_b32 v130, a2
v_mfma_f32_16x16x32_bf16 a[60:63], v[100:103], v[220:223], a[60:63]
ds_read_b64_tr_b16 v[220:221], v15 offset:16896
s_waitcnt lgkmcnt(3)
v_accvgpr_read_b32 v131, a3
v_mfma_f32_16x16x32_bf16 a[48:51], v[8:11], v[208:211], a[48:51]
ds_read_b64_tr_b16 v[222:223], v15 offset:18944
v_cvt_pk_bf16_f32 v16, v128, v129
v_cvt_pk_bf16_f32 v17, v130, v131
v_mfma_f32_16x16x32_bf16 a[48:51], v[176:179], v[212:215], a[48:51]
v_accvgpr_read_b32 v136, a4
v_accvgpr_read_b32 v137, a5
v_accvgpr_read_b32 v138, a6
v_mfma_f32_16x16x32_bf16 a[52:55], v[40:43], v[208:211], a[52:55]
v_accvgpr_read_b32 v139, a7
v_cvt_pk_bf16_f32 v48, v136, v137
v_cvt_pk_bf16_f32 v49, v138, v139
v_mfma_f32_16x16x32_bf16 a[52:55], v[180:183], v[212:215], a[52:55]
v_accvgpr_read_b32 v144, a8
v_accvgpr_read_b32 v145, a9
v_accvgpr_read_b32 v146, a10
v_mfma_f32_16x16x32_bf16 a[56:59], v[72:75], v[208:211], a[56:59]
v_accvgpr_read_b32 v147, a11
v_cvt_pk_bf16_f32 v80, v144, v145
v_cvt_pk_bf16_f32 v81, v146, v147
v_mfma_f32_16x16x32_bf16 a[56:59], v[184:187], v[212:215], a[56:59]
v_accvgpr_read_b32 v152, a12
v_accvgpr_read_b32 v153, a13
v_accvgpr_read_b32 v154, a14
v_mfma_f32_16x16x32_bf16 a[60:63], v[104:107], v[208:211], a[60:63]
ds_read_b64_tr_b16 v[208:209], v244 offset:20480
ds_read_b64_tr_b16 v[210:211], v244 offset:22528
v_accvgpr_read_b32 v155, a15
v_mfma_f32_16x16x32_bf16 a[60:63], v[188:191], v[212:215], a[60:63]
ds_read_b64_tr_b16 v[212:213], v12 offset:4096
s_waitcnt lgkmcnt(3)
v_cvt_pk_bf16_f32 v112, v152, v153
v_mfma_f32_16x16x32_bf16 a[48:51], v[160:163], v[216:219], a[48:51]
ds_read_b64_tr_b16 v[214:215], v12 offset:6144
v_cvt_pk_bf16_f32 v113, v154, v155
v_accvgpr_read_b32 v132, a16
v_mfma_f32_16x16x32_bf16 a[48:51], v[0:3], v[220:223], a[48:51]
v_accvgpr_read_b32 v133, a17
v_accvgpr_read_b32 v134, a18
v_accvgpr_read_b32 v135, a19
v_mfma_f32_16x16x32_bf16 a[52:55], v[164:167], v[216:219], a[52:55]
v_cvt_pk_bf16_f32 v18, v132, v133
v_cvt_pk_bf16_f32 v19, v134, v135
buffer_store_dwordx4 v[16:19], v243, s[20:23], s40 offen offset:0 sc1
v_mfma_f32_16x16x32_bf16 a[52:55], v[32:35], v[220:223], a[52:55]
ds_write_b128 v231, v[16:19] offset:0
v_accvgpr_read_b32 v140, a20
v_accvgpr_read_b32 v141, a21
v_mfma_f32_16x16x32_bf16 a[56:59], v[168:171], v[216:219], a[56:59]
v_accvgpr_read_b32 v142, a22
v_accvgpr_read_b32 v143, a23
v_cvt_pk_bf16_f32 v50, v140, v141
v_mfma_f32_16x16x32_bf16 a[56:59], v[64:67], v[220:223], a[56:59]
v_cvt_pk_bf16_f32 v51, v142, v143
buffer_store_dwordx4 v[48:51], v243, s[20:23], s41 offen offset:0 sc1
v_accvgpr_read_b32 v148, a24
v_mfma_f32_16x16x32_bf16 a[60:63], v[172:175], v[216:219], a[60:63]
ds_read_b64_tr_b16 v[216:217], v12 offset:20480
ds_read_b64_tr_b16 v[218:219], v12 offset:22528
v_accvgpr_read_b32 v149, a25
v_mfma_f32_16x16x32_bf16 a[60:63], v[96:99], v[220:223], a[60:63]
ds_read_b64_tr_b16 v[220:221], v14 offset:4096
s_waitcnt lgkmcnt(3)
v_accvgpr_read_b32 v150, a26
v_mfma_f32_16x16x32_bf16 a[64:67], v[4:7], v[208:211], a[64:67]
ds_read_b64_tr_b16 v[222:223], v14 offset:6144
v_accvgpr_read_b32 v151, a27
v_cvt_pk_bf16_f32 v82, v148, v149
v_mfma_f32_16x16x32_bf16 a[64:67], v[8:11], v[212:215], a[64:67]
v_cvt_pk_bf16_f32 v83, v150, v151
buffer_store_dwordx4 v[80:83], v243, s[20:23], s42 offen offset:0 sc1
v_accvgpr_read_b32 v156, a28
v_mfma_f32_16x16x32_bf16 a[68:71], v[36:39], v[208:211], a[68:71]
v_accvgpr_read_b32 v157, a29
v_accvgpr_read_b32 v158, a30
v_accvgpr_read_b32 v159, a31
v_mfma_f32_16x16x32_bf16 a[68:71], v[40:43], v[212:215], a[68:71]
v_cvt_pk_bf16_f32 v114, v156, v157
v_cvt_pk_bf16_f32 v115, v158, v159
buffer_store_dwordx4 v[112:115], v243, s[20:23], s43 offen offset:0 sc1
v_mfma_f32_16x16x32_bf16 a[72:75], v[68:71], v[208:211], a[72:75]
v_accvgpr_read_b32 v128, a32
v_accvgpr_read_b32 v129, a33
v_accvgpr_read_b32 v130, a34
v_mfma_f32_16x16x32_bf16 a[72:75], v[72:75], v[212:215], a[72:75]
v_accvgpr_read_b32 v131, a35
v_cvt_pk_bf16_f32 v20, v128, v129
v_cvt_pk_bf16_f32 v21, v130, v131
v_mfma_f32_16x16x32_bf16 a[76:79], v[100:103], v[208:211], a[76:79]
ds_read_b64_tr_b16 v[208:209], v14 offset:20480
ds_read_b64_tr_b16 v[210:211], v14 offset:22528
v_accvgpr_read_b32 v136, a36
v_mfma_f32_16x16x32_bf16 a[76:79], v[104:107], v[212:215], a[76:79]
ds_read_b64_tr_b16 v[212:213], v245 offset:20480
s_waitcnt lgkmcnt(3)
v_accvgpr_read_b32 v137, a37
v_mfma_f32_16x16x32_bf16 a[64:67], v[176:179], v[216:219], a[64:67]
ds_read_b64_tr_b16 v[214:215], v245 offset:22528
v_accvgpr_read_b32 v138, a38
v_accvgpr_read_b32 v139, a39
v_mfma_f32_16x16x32_bf16 a[64:67], v[160:163], v[220:223], a[64:67]
v_cvt_pk_bf16_f32 v52, v136, v137
v_cvt_pk_bf16_f32 v53, v138, v139
v_accvgpr_read_b32 v144, a40
v_mfma_f32_16x16x32_bf16 a[68:71], v[180:183], v[216:219], a[68:71]
v_accvgpr_read_b32 v145, a41
v_accvgpr_read_b32 v146, a42
v_accvgpr_read_b32 v147, a43
v_mfma_f32_16x16x32_bf16 a[68:71], v[164:167], v[220:223], a[68:71]
v_cvt_pk_bf16_f32 v84, v144, v145
v_cvt_pk_bf16_f32 v85, v146, v147
v_accvgpr_read_b32 v152, a44
v_mfma_f32_16x16x32_bf16 a[72:75], v[184:187], v[216:219], a[72:75]
v_accvgpr_read_b32 v153, a45
v_accvgpr_read_b32 v154, a46
v_accvgpr_read_b32 v155, a47
v_mfma_f32_16x16x32_bf16 a[72:75], v[168:171], v[220:223], a[72:75]
v_cvt_pk_bf16_f32 v116, v152, v153
v_cvt_pk_bf16_f32 v117, v154, v155
v_accvgpr_read_b32 v132, a48
v_mfma_f32_16x16x32_bf16 a[76:79], v[188:191], v[216:219], a[76:79]
ds_read_b64_tr_b16 v[216:217], v13 offset:4096
ds_read_b64_tr_b16 v[218:219], v13 offset:6144
v_accvgpr_read_b32 v133, a49
v_mfma_f32_16x16x32_bf16 a[76:79], v[172:175], v[220:223], a[76:79]
ds_read_b64_tr_b16 v[220:221], v13 offset:20480
s_waitcnt lgkmcnt(5)
v_accvgpr_read_b32 v134, a50
v_mfma_f32_16x16x32_bf16 a[64:67], v[0:3], v[208:211], a[64:67]
ds_read_b64_tr_b16 v[222:223], v13 offset:22528
v_accvgpr_read_b32 v135, a51
v_cvt_pk_bf16_f32 v22, v132, v133
v_mfma_f32_16x16x32_bf16 a[68:71], v[32:35], v[208:211], a[68:71]
v_cvt_pk_bf16_f32 v23, v134, v135
buffer_store_dwordx4 v[20:23], v243, s[20:23], s40 offen offset:1024 sc1
ds_write_b128 v231, v[20:23] offset:1024
v_mfma_f32_16x16x32_bf16 a[72:75], v[64:67], v[208:211], a[72:75]
v_accvgpr_read_b32 v140, a52
v_accvgpr_read_b32 v141, a53
v_accvgpr_read_b32 v142, a54
v_mfma_f32_16x16x32_bf16 a[76:79], v[96:99], v[208:211], a[76:79]
ds_read_b64_tr_b16 v[208:209], v15 offset:4096
s_waitcnt lgkmcnt(5)
v_accvgpr_read_b32 v143, a55
v_mfma_f32_16x16x32_bf16 a[80:83], v[4:7], v[212:215], a[80:83]
ds_read_b64_tr_b16 v[210:211], v15 offset:6144
v_cvt_pk_bf16_f32 v54, v140, v141
v_cvt_pk_bf16_f32 v55, v142, v143
v_mfma_f32_16x16x32_bf16 a[84:87], v[36:39], v[212:215], a[84:87]
buffer_store_dwordx4 v[52:55], v243, s[20:23], s41 offen offset:1024 sc1
v_accvgpr_read_b32 v148, a56
v_accvgpr_read_b32 v149, a57
v_mfma_f32_16x16x32_bf16 a[88:91], v[68:71], v[212:215], a[88:91]
v_accvgpr_read_b32 v150, a58
v_accvgpr_read_b32 v151, a59
v_cvt_pk_bf16_f32 v86, v148, v149
v_mfma_f32_16x16x32_bf16 a[92:95], v[100:103], v[212:215], a[92:95]
ds_read_b64_tr_b16 v[212:213], v15 offset:20480
s_waitcnt lgkmcnt(3)
v_cvt_pk_bf16_f32 v87, v150, v151
v_mfma_f32_16x16x32_bf16 a[80:83], v[8:11], v[216:219], a[80:83]
ds_read_b64_tr_b16 v[214:215], v15 offset:22528
buffer_store_dwordx4 v[84:87], v243, s[20:23], s42 offen offset:1024 sc1
v_accvgpr_read_b32 v156, a60
v_mfma_f32_16x16x32_bf16 a[80:83], v[176:179], v[220:223], a[80:83]
v_accvgpr_read_b32 v157, a61
v_accvgpr_read_b32 v158, a62
v_accvgpr_read_b32 v159, a63
v_mfma_f32_16x16x32_bf16 a[84:87], v[40:43], v[216:219], a[84:87]
v_cvt_pk_bf16_f32 v118, v156, v157
v_cvt_pk_bf16_f32 v119, v158, v159
buffer_store_dwordx4 v[116:119], v243, s[20:23], s43 offen offset:1024 sc1
v_mfma_f32_16x16x32_bf16 a[84:87], v[180:183], v[220:223], a[84:87]
v_accvgpr_read_b32 v128, a64
v_accvgpr_read_b32 v129, a65
v_mfma_f32_16x16x32_bf16 a[88:91], v[72:75], v[216:219], a[88:91]
v_accvgpr_read_b32 v130, a66
v_accvgpr_read_b32 v131, a67
v_mfma_f32_16x16x32_bf16 a[88:91], v[184:187], v[220:223], a[88:91]
v_cvt_pk_bf16_f32 v24, v128, v129
v_cvt_pk_bf16_f32 v25, v130, v131
v_mfma_f32_16x16x32_bf16 a[92:95], v[104:107], v[216:219], a[92:95]
ds_read_b64_tr_b16 v[216:217], v244 offset:20992
ds_read_b64_tr_b16 v[218:219], v244 offset:23040
v_mfma_f32_16x16x32_bf16 a[92:95], v[188:191], v[220:223], a[92:95]
ds_read_b64_tr_b16 v[220:221], v12 offset:4608
s_waitcnt lgkmcnt(3)
v_mfma_f32_16x16x32_bf16 a[80:83], v[160:163], v[208:211], a[80:83]
ds_read_b64_tr_b16 v[222:223], v12 offset:6656
v_accvgpr_read_b32 v136, a68
v_mfma_f32_16x16x32_bf16 a[80:83], v[0:3], v[212:215], a[80:83]
v_accvgpr_read_b32 v137, a69
v_accvgpr_read_b32 v138, a70
v_mfma_f32_16x16x32_bf16 a[84:87], v[164:167], v[208:211], a[84:87]
v_accvgpr_read_b32 v139, a71
v_cvt_pk_bf16_f32 v56, v136, v137
v_mfma_f32_16x16x32_bf16 a[84:87], v[32:35], v[212:215], a[84:87]
v_cvt_pk_bf16_f32 v57, v138, v139
v_accvgpr_read_b32 v144, a72
v_mfma_f32_16x16x32_bf16 a[88:91], v[168:171], v[208:211], a[88:91]
v_accvgpr_read_b32 v145, a73
v_accvgpr_read_b32 v146, a74
v_mfma_f32_16x16x32_bf16 a[88:91], v[64:67], v[212:215], a[88:91]
v_accvgpr_read_b32 v147, a75
v_cvt_pk_bf16_f32 v88, v144, v145
v_mfma_f32_16x16x32_bf16 a[92:95], v[172:175], v[208:211], a[92:95]
ds_read_b64_tr_b16 v[208:209], v12 offset:20992
ds_read_b64_tr_b16 v[210:211], v12 offset:23040
v_mfma_f32_16x16x32_bf16 a[92:95], v[96:99], v[212:215], a[92:95]
ds_read_b64_tr_b16 v[212:213], v14 offset:4608
s_waitcnt lgkmcnt(3)
v_mfma_f32_16x16x32_bf16 a[96:99], v[4:7], v[216:219], a[96:99]
ds_read_b64_tr_b16 v[214:215], v14 offset:6656
v_cvt_pk_bf16_f32 v89, v146, v147
v_mfma_f32_16x16x32_bf16 a[96:99], v[8:11], v[220:223], a[96:99]
v_accvgpr_read_b32 v152, a76
v_accvgpr_read_b32 v153, a77
v_mfma_f32_16x16x32_bf16 a[100:103], v[36:39], v[216:219], a[100:103]
v_accvgpr_read_b32 v154, a78
v_accvgpr_read_b32 v155, a79
v_mfma_f32_16x16x32_bf16 a[100:103], v[40:43], v[220:223], a[100:103]
v_cvt_pk_bf16_f32 v120, v152, v153
v_cvt_pk_bf16_f32 v121, v154, v155
v_mfma_f32_16x16x32_bf16 a[104:107], v[68:71], v[216:219], a[104:107]
v_accvgpr_read_b32 v132, a80
v_accvgpr_read_b32 v133, a81
v_mfma_f32_16x16x32_bf16 a[104:107], v[72:75], v[220:223], a[104:107]
v_accvgpr_read_b32 v134, a82
v_accvgpr_read_b32 v135, a83
v_mfma_f32_16x16x32_bf16 a[108:111], v[100:103], v[216:219], a[108:111]
ds_read_b64_tr_b16 v[216:217], v14 offset:20992
ds_read_b64_tr_b16 v[218:219], v14 offset:23040
v_mfma_f32_16x16x32_bf16 a[108:111], v[104:107], v[220:223], a[108:111]
ds_read_b64_tr_b16 v[220:221], v245 offset:20992
s_waitcnt lgkmcnt(3)
v_mfma_f32_16x16x32_bf16 a[96:99], v[176:179], v[208:211], a[96:99]
ds_read_b64_tr_b16 v[222:223], v245 offset:23040
v_cvt_pk_bf16_f32 v26, v132, v133
v_mfma_f32_16x16x32_bf16 a[96:99], v[160:163], v[212:215], a[96:99]
v_cvt_pk_bf16_f32 v27, v134, v135
buffer_store_dwordx4 v[24:27], v243, s[20:23], s40 offen offset:2048 sc1
v_mfma_f32_16x16x32_bf16 a[100:103], v[180:183], v[208:211], a[100:103]
ds_write_b128 v231, v[24:27] offset:2048
v_accvgpr_read_b32 v140, a84
v_mfma_f32_16x16x32_bf16 a[100:103], v[164:167], v[212:215], a[100:103]
v_accvgpr_read_b32 v141, a85
v_accvgpr_read_b32 v142, a86
v_mfma_f32_16x16x32_bf16 a[104:107], v[184:187], v[208:211], a[104:107]
v_accvgpr_read_b32 v143, a87
v_cvt_pk_bf16_f32 v58, v140, v141
v_mfma_f32_16x16x32_bf16 a[104:107], v[168:171], v[212:215], a[104:107]
v_cvt_pk_bf16_f32 v59, v142, v143
buffer_store_dwordx4 v[56:59], v243, s[20:23], s41 offen offset:2048 sc1
v_mfma_f32_16x16x32_bf16 a[108:111], v[188:191], v[208:211], a[108:111]
ds_read_b64_tr_b16 v[208:209], v13 offset:4608
ds_read_b64_tr_b16 v[210:211], v13 offset:6656
v_mfma_f32_16x16x32_bf16 a[108:111], v[172:175], v[212:215], a[108:111]
ds_read_b64_tr_b16 v[212:213], v13 offset:20992
s_waitcnt lgkmcnt(5)
v_mfma_f32_16x16x32_bf16 a[96:99], v[0:3], v[216:219], a[96:99]
ds_read_b64_tr_b16 v[214:215], v13 offset:23040
v_accvgpr_read_b32 v148, a88
v_mfma_f32_16x16x32_bf16 a[100:103], v[32:35], v[216:219], a[100:103]
v_accvgpr_read_b32 v149, a89
v_accvgpr_read_b32 v150, a90
v_mfma_f32_16x16x32_bf16 a[104:107], v[64:67], v[216:219], a[104:107]
v_accvgpr_read_b32 v151, a91
v_cvt_pk_bf16_f32 v90, v148, v149
v_mfma_f32_16x16x32_bf16 a[108:111], v[96:99], v[216:219], a[108:111]
ds_read_b64_tr_b16 v[216:217], v15 offset:4608
s_waitcnt lgkmcnt(5)
v_mfma_f32_16x16x32_bf16 a[112:115], v[4:7], v[220:223], a[112:115]
ds_read_b64_tr_b16 v[218:219], v15 offset:6656
v_cvt_pk_bf16_f32 v91, v150, v151
v_mfma_f32_16x16x32_bf16 a[116:119], v[36:39], v[220:223], a[116:119]
buffer_store_dwordx4 v[88:91], v243, s[20:23], s42 offen offset:2048 sc1
v_accvgpr_read_b32 v156, a92
v_mfma_f32_16x16x32_bf16 a[120:123], v[68:71], v[220:223], a[120:123]
v_accvgpr_read_b32 v157, a93
v_accvgpr_read_b32 v158, a94
v_mfma_f32_16x16x32_bf16 a[124:127], v[100:103], v[220:223], a[124:127]
ds_read_b64_tr_b16 v[220:221], v15 offset:20992
s_waitcnt lgkmcnt(3)
v_mfma_f32_16x16x32_bf16 a[112:115], v[8:11], v[208:211], a[112:115]
ds_read_b64_tr_b16 v[222:223], v15 offset:23040
v_accvgpr_read_b32 v159, a95
v_mfma_f32_16x16x32_bf16 a[112:115], v[176:179], v[212:215], a[112:115]
v_cvt_pk_bf16_f32 v122, v156, v157
v_cvt_pk_bf16_f32 v123, v158, v159
v_mfma_f32_16x16x32_bf16 a[116:119], v[40:43], v[208:211], a[116:119]
buffer_store_dwordx4 v[120:123], v243, s[20:23], s43 offen offset:2048 sc1
v_accvgpr_read_b32 v128, a96
v_mfma_f32_16x16x32_bf16 a[116:119], v[180:183], v[212:215], a[116:119]
v_accvgpr_read_b32 v129, a97
v_accvgpr_read_b32 v130, a98
v_mfma_f32_16x16x32_bf16 a[120:123], v[72:75], v[208:211], a[120:123]
v_accvgpr_read_b32 v131, a99
v_cvt_pk_bf16_f32 v28, v128, v129
v_mfma_f32_16x16x32_bf16 a[120:123], v[184:187], v[212:215], a[120:123]
v_cvt_pk_bf16_f32 v29, v130, v131
v_accvgpr_read_b32 v136, a100
v_mfma_f32_16x16x32_bf16 a[124:127], v[104:107], v[208:211], a[124:127]
ds_read_b64_tr_b16 v[208:209], v12 offset:8192
ds_read_b64_tr_b16 v[210:211], v12 offset:10240
v_mfma_f32_16x16x32_bf16 a[124:127], v[188:191], v[212:215], a[124:127]
ds_read_b64_tr_b16 v[212:213], v12 offset:24576
s_waitcnt lgkmcnt(3)
v_mfma_f32_16x16x32_bf16 a[112:115], v[160:163], v[216:219], a[112:115]
ds_read_b64_tr_b16 v[214:215], v12 offset:26624
v_accvgpr_read_b32 v137, a101
v_mfma_f32_16x16x32_bf16 a[112:115], v[0:3], v[220:223], a[112:115]
v_accvgpr_read_b32 v138, a102
v_accvgpr_read_b32 v139, a103
v_mfma_f32_16x16x32_bf16 a[116:119], v[164:167], v[216:219], a[116:119]
v_cvt_pk_bf16_f32 v60, v136, v137
v_cvt_pk_bf16_f32 v61, v138, v139
v_mfma_f32_16x16x32_bf16 a[116:119], v[32:35], v[220:223], a[116:119]
v_accvgpr_read_b32 v144, a104
v_accvgpr_read_b32 v145, a105
v_mfma_f32_16x16x32_bf16 a[120:123], v[168:171], v[216:219], a[120:123]
v_accvgpr_read_b32 v146, a106
v_accvgpr_read_b32 v147, a107
v_mfma_f32_16x16x32_bf16 a[120:123], v[64:67], v[220:223], a[120:123]
v_cvt_pk_bf16_f32 v92, v144, v145
v_cvt_pk_bf16_f32 v93, v146, v147
v_mfma_f32_16x16x32_bf16 a[124:127], v[172:175], v[216:219], a[124:127]
ds_read_b64_tr_b16 v[216:217], v14 offset:8192
ds_read_b64_tr_b16 v[218:219], v14 offset:10240
v_mfma_f32_16x16x32_bf16 a[124:127], v[96:99], v[220:223], a[124:127]
ds_read_b64_tr_b16 v[220:221], v14 offset:24576
s_waitcnt lgkmcnt(3)
v_mfma_f32_16x16x32_bf16 a[128:131], v[8:11], v[208:211], a[128:131]
ds_read_b64_tr_b16 v[222:223], v14 offset:26624
v_accvgpr_read_b32 v152, a108
v_mfma_f32_16x16x32_bf16 a[128:131], v[176:179], v[212:215], a[128:131]
v_accvgpr_read_b32 v153, a109
v_accvgpr_read_b32 v154, a110
v_mfma_f32_16x16x32_bf16 a[132:135], v[40:43], v[208:211], a[132:135]
v_accvgpr_read_b32 v155, a111
v_cvt_pk_bf16_f32 v124, v152, v153
v_mfma_f32_16x16x32_bf16 a[132:135], v[180:183], v[212:215], a[132:135]
v_cvt_pk_bf16_f32 v125, v154, v155
v_accvgpr_read_b32 v132, a112
v_mfma_f32_16x16x32_bf16 a[136:139], v[72:75], v[208:211], a[136:139]
v_accvgpr_read_b32 v133, a113
v_accvgpr_read_b32 v134, a114
v_mfma_f32_16x16x32_bf16 a[136:139], v[184:187], v[212:215], a[136:139]
v_accvgpr_read_b32 v135, a115
v_cvt_pk_bf16_f32 v30, v132, v133
v_mfma_f32_16x16x32_bf16 a[140:143], v[104:107], v[208:211], a[140:143]
ds_read_b64_tr_b16 v[208:209], v13 offset:8192
ds_read_b64_tr_b16 v[210:211], v13 offset:10240
v_mfma_f32_16x16x32_bf16 a[140:143], v[188:191], v[212:215], a[140:143]
ds_read_b64_tr_b16 v[212:213], v13 offset:24576
s_waitcnt lgkmcnt(3)
v_mfma_f32_16x16x32_bf16 a[128:131], v[160:163], v[216:219], a[128:131]
ds_read_b64_tr_b16 v[214:215], v13 offset:26624
v_cvt_pk_bf16_f32 v31, v134, v135
v_mfma_f32_16x16x32_bf16 a[128:131], v[0:3], v[220:223], a[128:131]
buffer_store_dwordx4 v[28:31], v243, s[20:23], s40 offen offset:3072 sc1
ds_write_b128 v231, v[28:31] offset:3072
v_mfma_f32_16x16x32_bf16 a[132:135], v[164:167], v[216:219], a[132:135]
v_accvgpr_read_b32 v140, a116
v_accvgpr_read_b32 v141, a117
v_mfma_f32_16x16x32_bf16 a[132:135], v[32:35], v[220:223], a[132:135]
v_accvgpr_read_b32 v142, a118
v_accvgpr_read_b32 v143, a119
v_mfma_f32_16x16x32_bf16 a[136:139], v[168:171], v[216:219], a[136:139]
v_cvt_pk_bf16_f32 v62, v140, v141
v_cvt_pk_bf16_f32 v63, v142, v143
v_mfma_f32_16x16x32_bf16 a[136:139], v[64:67], v[220:223], a[136:139]
buffer_store_dwordx4 v[60:63], v243, s[20:23], s41 offen offset:3072 sc1
v_accvgpr_read_b32 v148, a120
v_mfma_f32_16x16x32_bf16 a[140:143], v[172:175], v[216:219], a[140:143]
ds_read_b64_tr_b16 v[216:217], v15 offset:8192
ds_read_b64_tr_b16 v[218:219], v15 offset:10240
v_mfma_f32_16x16x32_bf16 a[140:143], v[96:99], v[220:223], a[140:143]
ds_read_b64_tr_b16 v[220:221], v15 offset:24576
s_waitcnt lgkmcnt(3)
v_mfma_f32_16x16x32_bf16 a[144:147], v[8:11], v[208:211], a[144:147]
ds_read_b64_tr_b16 v[222:223], v15 offset:26624
v_accvgpr_read_b32 v149, a121
v_mfma_f32_16x16x32_bf16 a[144:147], v[176:179], v[212:215], a[144:147]
v_accvgpr_read_b32 v150, a122
v_accvgpr_read_b32 v151, a123
v_mfma_f32_16x16x32_bf16 a[148:151], v[40:43], v[208:211], a[148:151]
v_cvt_pk_bf16_f32 v94, v148, v149
v_cvt_pk_bf16_f32 v95, v150, v151
v_mfma_f32_16x16x32_bf16 a[148:151], v[180:183], v[212:215], a[148:151]
buffer_store_dwordx4 v[92:95], v243, s[20:23], s42 offen offset:3072 sc1
v_accvgpr_read_b32 v156, a124
v_mfma_f32_16x16x32_bf16 a[152:155], v[72:75], v[208:211], a[152:155]
v_accvgpr_read_b32 v157, a125
v_accvgpr_read_b32 v158, a126
v_mfma_f32_16x16x32_bf16 a[152:155], v[184:187], v[212:215], a[152:155]
v_accvgpr_read_b32 v159, a127
v_cvt_pk_bf16_f32 v126, v156, v157
v_mfma_f32_16x16x32_bf16 a[156:159], v[104:107], v[208:211], a[156:159]
ds_read_b64_tr_b16 v[208:209], v12 offset:8704
ds_read_b64_tr_b16 v[210:211], v12 offset:10752
v_mfma_f32_16x16x32_bf16 a[156:159], v[188:191], v[212:215], a[156:159]
ds_read_b64_tr_b16 v[212:213], v12 offset:25088
s_waitcnt lgkmcnt(3)
v_mfma_f32_16x16x32_bf16 a[144:147], v[160:163], v[216:219], a[144:147]
ds_read_b64_tr_b16 v[214:215], v12 offset:27136
v_cvt_pk_bf16_f32 v127, v158, v159
v_mfma_f32_16x16x32_bf16 a[144:147], v[0:3], v[220:223], a[144:147]
buffer_store_dwordx4 v[124:127], v243, s[20:23], s43 offen offset:3072 sc1
v_accvgpr_read_b32 v128, a128
v_mfma_f32_16x16x32_bf16 a[148:151], v[164:167], v[216:219], a[148:151]
v_accvgpr_read_b32 v129, a129
v_accvgpr_read_b32 v130, a130
v_mfma_f32_16x16x32_bf16 a[148:151], v[32:35], v[220:223], a[148:151]
v_accvgpr_read_b32 v131, a131
v_cvt_pk_bf16_f32 v16, v128, v129
v_mfma_f32_16x16x32_bf16 a[152:155], v[168:171], v[216:219], a[152:155]
v_cvt_pk_bf16_f32 v17, v130, v131
v_accvgpr_read_b32 v136, a132
v_mfma_f32_16x16x32_bf16 a[152:155], v[64:67], v[220:223], a[152:155]
v_accvgpr_read_b32 v137, a133
v_accvgpr_read_b32 v138, a134
v_mfma_f32_16x16x32_bf16 a[156:159], v[172:175], v[216:219], a[156:159]
ds_read_b64_tr_b16 v[216:217], v14 offset:8704
ds_read_b64_tr_b16 v[218:219], v14 offset:10752
v_mfma_f32_16x16x32_bf16 a[156:159], v[96:99], v[220:223], a[156:159]
ds_read_b64_tr_b16 v[220:221], v14 offset:25088
s_waitcnt lgkmcnt(3)
v_mfma_f32_16x16x32_bf16 a[160:163], v[8:11], v[208:211], a[160:163]
ds_read_b64_tr_b16 v[222:223], v14 offset:27136
v_accvgpr_read_b32 v139, a135
v_mfma_f32_16x16x32_bf16 a[160:163], v[176:179], v[212:215], a[160:163]
v_cvt_pk_bf16_f32 v48, v136, v137
v_cvt_pk_bf16_f32 v49, v138, v139
v_mfma_f32_16x16x32_bf16 a[164:167], v[40:43], v[208:211], a[164:167]
v_accvgpr_read_b32 v144, a136
v_accvgpr_read_b32 v145, a137
v_mfma_f32_16x16x32_bf16 a[164:167], v[180:183], v[212:215], a[164:167]
v_accvgpr_read_b32 v146, a138
v_accvgpr_read_b32 v147, a139
v_mfma_f32_16x16x32_bf16 a[168:171], v[72:75], v[208:211], a[168:171]
v_cvt_pk_bf16_f32 v80, v144, v145
v_cvt_pk_bf16_f32 v81, v146, v147
v_mfma_f32_16x16x32_bf16 a[168:171], v[184:187], v[212:215], a[168:171]
v_accvgpr_read_b32 v152, a140
v_accvgpr_read_b32 v153, a141
v_mfma_f32_16x16x32_bf16 a[172:175], v[104:107], v[208:211], a[172:175]
ds_read_b64_tr_b16 v[208:209], v13 offset:8704
ds_read_b64_tr_b16 v[210:211], v13 offset:10752
v_mfma_f32_16x16x32_bf16 a[172:175], v[188:191], v[212:215], a[172:175]
ds_read_b64_tr_b16 v[212:213], v13 offset:25088
s_waitcnt lgkmcnt(3)
v_mfma_f32_16x16x32_bf16 a[160:163], v[160:163], v[216:219], a[160:163]
ds_read_b64_tr_b16 v[214:215], v13 offset:27136
v_accvgpr_read_b32 v154, a142
v_mfma_f32_16x16x32_bf16 a[160:163], v[0:3], v[220:223], a[160:163]
v_accvgpr_read_b32 v155, a143
v_cvt_pk_bf16_f32 v112, v152, v153
v_mfma_f32_16x16x32_bf16 a[164:167], v[164:167], v[216:219], a[164:167]
v_cvt_pk_bf16_f32 v113, v154, v155
v_accvgpr_read_b32 v132, a144
v_mfma_f32_16x16x32_bf16 a[164:167], v[32:35], v[220:223], a[164:167]
v_accvgpr_read_b32 v133, a145
v_accvgpr_read_b32 v134, a146
v_mfma_f32_16x16x32_bf16 a[168:171], v[168:171], v[216:219], a[168:171]
v_accvgpr_read_b32 v135, a147
v_cvt_pk_bf16_f32 v18, v132, v133
v_mfma_f32_16x16x32_bf16 a[168:171], v[64:67], v[220:223], a[168:171]
v_cvt_pk_bf16_f32 v19, v134, v135
buffer_store_dwordx4 v[16:19], v243, s[20:23], s44 offen offset:0 sc1
v_mfma_f32_16x16x32_bf16 a[172:175], v[172:175], v[216:219], a[172:175]
ds_read_b64_tr_b16 v[216:217], v15 offset:8704
ds_read_b64_tr_b16 v[218:219], v15 offset:10752
v_mfma_f32_16x16x32_bf16 a[172:175], v[96:99], v[220:223], a[172:175]
ds_read_b64_tr_b16 v[220:221], v15 offset:25088
s_waitcnt lgkmcnt(3)
v_mfma_f32_16x16x32_bf16 a[176:179], v[8:11], v[208:211], a[176:179]
ds_read_b64_tr_b16 v[222:223], v15 offset:27136
ds_write_b128 v231, v[16:19] offset:4096
v_mfma_f32_16x16x32_bf16 a[176:179], v[176:179], v[212:215], a[176:179]
v_accvgpr_read_b32 v140, a148
v_accvgpr_read_b32 v141, a149
v_mfma_f32_16x16x32_bf16 a[180:183], v[40:43], v[208:211], a[180:183]
v_accvgpr_read_b32 v142, a150
v_accvgpr_read_b32 v143, a151
v_mfma_f32_16x16x32_bf16 a[180:183], v[180:183], v[212:215], a[180:183]
v_cvt_pk_bf16_f32 v50, v140, v141
v_cvt_pk_bf16_f32 v51, v142, v143
v_mfma_f32_16x16x32_bf16 a[184:187], v[72:75], v[208:211], a[184:187]
buffer_store_dwordx4 v[48:51], v243, s[20:23], s45 offen offset:0 sc1
v_accvgpr_read_b32 v148, a152
v_mfma_f32_16x16x32_bf16 a[184:187], v[184:187], v[212:215], a[184:187]
v_accvgpr_read_b32 v149, a153
v_accvgpr_read_b32 v150, a154
v_mfma_f32_16x16x32_bf16 a[188:191], v[104:107], v[208:211], a[188:191]
ds_read_b64_tr_b16 v[208:209], v12 offset:12288
ds_read_b64_tr_b16 v[210:211], v12 offset:14336
v_mfma_f32_16x16x32_bf16 a[188:191], v[188:191], v[212:215], a[188:191]
ds_read_b64_tr_b16 v[212:213], v12 offset:28672
s_waitcnt lgkmcnt(3)
v_mfma_f32_16x16x32_bf16 a[176:179], v[160:163], v[216:219], a[176:179]
ds_read_b64_tr_b16 v[214:215], v12 offset:30720
v_accvgpr_read_b32 v151, a155
v_mfma_f32_16x16x32_bf16 a[176:179], v[0:3], v[220:223], a[176:179]
v_cvt_pk_bf16_f32 v82, v148, v149
v_cvt_pk_bf16_f32 v83, v150, v151
v_mfma_f32_16x16x32_bf16 a[180:183], v[164:167], v[216:219], a[180:183]
buffer_store_dwordx4 v[80:83], v243, s[20:23], s46 offen offset:0 sc1
v_accvgpr_read_b32 v156, a156
v_mfma_f32_16x16x32_bf16 a[180:183], v[32:35], v[220:223], a[180:183]
v_accvgpr_read_b32 v157, a157
v_accvgpr_read_b32 v158, a158
v_mfma_f32_16x16x32_bf16 a[184:187], v[168:171], v[216:219], a[184:187]
v_accvgpr_read_b32 v159, a159
v_cvt_pk_bf16_f32 v114, v156, v157
v_mfma_f32_16x16x32_bf16 a[184:187], v[64:67], v[220:223], a[184:187]
v_cvt_pk_bf16_f32 v115, v158, v159
buffer_store_dwordx4 v[112:115], v243, s[20:23], s47 offen offset:0 sc1
v_mfma_f32_16x16x32_bf16 a[188:191], v[172:175], v[216:219], a[188:191]
ds_read_b64_tr_b16 v[216:217], v14 offset:12288
ds_read_b64_tr_b16 v[218:219], v14 offset:14336
v_mfma_f32_16x16x32_bf16 a[188:191], v[96:99], v[220:223], a[188:191]
ds_read_b64_tr_b16 v[220:221], v14 offset:28672
s_waitcnt lgkmcnt(3)
v_mfma_f32_16x16x32_bf16 a[192:195], v[8:11], v[208:211], a[192:195]
ds_read_b64_tr_b16 v[222:223], v14 offset:30720
v_accvgpr_read_b32 v128, a160
v_mfma_f32_16x16x32_bf16 a[192:195], v[176:179], v[212:215], a[192:195]
v_accvgpr_read_b32 v129, a161
v_accvgpr_read_b32 v130, a162
v_mfma_f32_16x16x32_bf16 a[196:199], v[40:43], v[208:211], a[196:199]
v_accvgpr_read_b32 v131, a163
v_cvt_pk_bf16_f32 v20, v128, v129
v_mfma_f32_16x16x32_bf16 a[196:199], v[180:183], v[212:215], a[196:199]
v_cvt_pk_bf16_f32 v21, v130, v131
v_accvgpr_read_b32 v136, a164
v_mfma_f32_16x16x32_bf16 a[200:203], v[72:75], v[208:211], a[200:203]
v_accvgpr_read_b32 v137, a165
v_accvgpr_read_b32 v138, a166
v_mfma_f32_16x16x32_bf16 a[200:203], v[184:187], v[212:215], a[200:203]
v_accvgpr_read_b32 v139, a167
v_cvt_pk_bf16_f32 v52, v136, v137
v_mfma_f32_16x16x32_bf16 a[204:207], v[104:107], v[208:211], a[204:207]
ds_read_b64_tr_b16 v[208:209], v13 offset:12288
ds_read_b64_tr_b16 v[210:211], v13 offset:14336
v_mfma_f32_16x16x32_bf16 a[204:207], v[188:191], v[212:215], a[204:207]
ds_read_b64_tr_b16 v[212:213], v13 offset:28672
s_waitcnt lgkmcnt(3)
v_mfma_f32_16x16x32_bf16 a[192:195], v[160:163], v[216:219], a[192:195]
ds_read_b64_tr_b16 v[214:215], v13 offset:30720
v_cvt_pk_bf16_f32 v53, v138, v139
v_mfma_f32_16x16x32_bf16 a[192:195], v[0:3], v[220:223], a[192:195]
v_accvgpr_read_b32 v144, a168
v_accvgpr_read_b32 v145, a169
v_mfma_f32_16x16x32_bf16 a[196:199], v[164:167], v[216:219], a[196:199]
v_accvgpr_read_b32 v146, a170
v_accvgpr_read_b32 v147, a171
v_mfma_f32_16x16x32_bf16 a[196:199], v[32:35], v[220:223], a[196:199]
v_cvt_pk_bf16_f32 v84, v144, v145
v_cvt_pk_bf16_f32 v85, v146, v147
v_mfma_f32_16x16x32_bf16 a[200:203], v[168:171], v[216:219], a[200:203]
v_accvgpr_read_b32 v152, a172
v_accvgpr_read_b32 v153, a173
v_mfma_f32_16x16x32_bf16 a[200:203], v[64:67], v[220:223], a[200:203]
v_accvgpr_read_b32 v154, a174
v_accvgpr_read_b32 v155, a175
v_mfma_f32_16x16x32_bf16 a[204:207], v[172:175], v[216:219], a[204:207]
ds_read_b64_tr_b16 v[216:217], v15 offset:12288
ds_read_b64_tr_b16 v[218:219], v15 offset:14336
v_mfma_f32_16x16x32_bf16 a[204:207], v[96:99], v[220:223], a[204:207]
ds_read_b64_tr_b16 v[220:221], v15 offset:28672
s_waitcnt lgkmcnt(3)
v_mfma_f32_16x16x32_bf16 a[208:211], v[8:11], v[208:211], a[208:211]
ds_read_b64_tr_b16 v[222:223], v15 offset:30720
v_cvt_pk_bf16_f32 v116, v152, v153
v_mfma_f32_16x16x32_bf16 a[208:211], v[176:179], v[212:215], a[208:211]
v_cvt_pk_bf16_f32 v117, v154, v155
v_accvgpr_read_b32 v132, a176
v_mfma_f32_16x16x32_bf16 a[212:215], v[40:43], v[208:211], a[212:215]
v_accvgpr_read_b32 v133, a177
v_accvgpr_read_b32 v134, a178
v_mfma_f32_16x16x32_bf16 a[212:215], v[180:183], v[212:215], a[212:215]
v_accvgpr_read_b32 v135, a179
v_cvt_pk_bf16_f32 v22, v132, v133
v_mfma_f32_16x16x32_bf16 a[216:219], v[72:75], v[208:211], a[216:219]
v_cvt_pk_bf16_f32 v23, v134, v135
buffer_store_dwordx4 v[20:23], v243, s[20:23], s44 offen offset:1024 sc1
v_mfma_f32_16x16x32_bf16 a[216:219], v[184:187], v[212:215], a[216:219]
ds_write_b128 v231, v[20:23] offset:5120
v_accvgpr_read_b32 v140, a180
v_mfma_f32_16x16x32_bf16 a[220:223], v[104:107], v[208:211], a[220:223]
v_accvgpr_read_b32 v141, a181
v_accvgpr_read_b32 v142, a182
v_mfma_f32_16x16x32_bf16 a[220:223], v[188:191], v[212:215], a[220:223]
s_waitcnt lgkmcnt(0)
v_accvgpr_read_b32 v143, a183
v_mfma_f32_16x16x32_bf16 a[208:211], v[160:163], v[216:219], a[208:211]
v_cvt_pk_bf16_f32 v54, v140, v141
v_cvt_pk_bf16_f32 v55, v142, v143
v_mfma_f32_16x16x32_bf16 a[208:211], v[0:3], v[220:223], a[208:211]
buffer_store_dwordx4 v[52:55], v243, s[20:23], s45 offen offset:1024 sc1
v_accvgpr_read_b32 v148, a184
v_mfma_f32_16x16x32_bf16 a[212:215], v[164:167], v[216:219], a[212:215]
v_accvgpr_read_b32 v149, a185
v_accvgpr_read_b32 v150, a186
v_mfma_f32_16x16x32_bf16 a[212:215], v[32:35], v[220:223], a[212:215]
v_accvgpr_read_b32 v151, a187
v_cvt_pk_bf16_f32 v86, v148, v149
v_mfma_f32_16x16x32_bf16 a[216:219], v[168:171], v[216:219], a[216:219]
v_cvt_pk_bf16_f32 v87, v150, v151
buffer_store_dwordx4 v[84:87], v243, s[20:23], s46 offen offset:1024 sc1
v_mfma_f32_16x16x32_bf16 a[216:219], v[64:67], v[220:223], a[216:219]
v_accvgpr_read_b32 v156, a188
v_accvgpr_read_b32 v157, a189
v_mfma_f32_16x16x32_bf16 a[220:223], v[172:175], v[216:219], a[220:223]
v_accvgpr_read_b32 v158, a190
v_accvgpr_read_b32 v159, a191
v_mfma_f32_16x16x32_bf16 a[220:223], v[96:99], v[220:223], a[220:223]
v_cvt_pk_bf16_f32 v118, v156, v157
v_cvt_pk_bf16_f32 v119, v158, v159
buffer_store_dwordx4 v[116:119], v243, s[20:23], s47 offen offset:1024 sc1
v_accvgpr_read_b32 v128, a192
v_accvgpr_read_b32 v129, a193
v_accvgpr_read_b32 v130, a194
v_accvgpr_read_b32 v131, a195
v_cvt_pk_bf16_f32 v24, v128, v129
v_cvt_pk_bf16_f32 v25, v130, v131
v_accvgpr_read_b32 v136, a196
v_accvgpr_read_b32 v137, a197
v_accvgpr_read_b32 v138, a198
v_accvgpr_read_b32 v139, a199
v_cvt_pk_bf16_f32 v56, v136, v137
v_cvt_pk_bf16_f32 v57, v138, v139
v_accvgpr_read_b32 v144, a200
v_accvgpr_read_b32 v145, a201
v_accvgpr_read_b32 v146, a202
v_accvgpr_read_b32 v147, a203
v_cvt_pk_bf16_f32 v88, v144, v145
v_cvt_pk_bf16_f32 v89, v146, v147
v_accvgpr_read_b32 v152, a204
v_accvgpr_read_b32 v153, a205
v_accvgpr_read_b32 v154, a206
v_accvgpr_read_b32 v155, a207
v_cvt_pk_bf16_f32 v120, v152, v153
v_cvt_pk_bf16_f32 v121, v154, v155
v_accvgpr_read_b32 v132, a208
v_accvgpr_read_b32 v133, a209
v_accvgpr_read_b32 v134, a210
v_accvgpr_read_b32 v135, a211
v_cvt_pk_bf16_f32 v26, v132, v133
v_cvt_pk_bf16_f32 v27, v134, v135
buffer_store_dwordx4 v[24:27], v243, s[20:23], s44 offen offset:2048 sc1
ds_write_b128 v231, v[24:27] offset:6144
v_accvgpr_read_b32 v140, a212
v_accvgpr_read_b32 v141, a213
v_accvgpr_read_b32 v142, a214
v_accvgpr_read_b32 v143, a215
v_cvt_pk_bf16_f32 v58, v140, v141
v_cvt_pk_bf16_f32 v59, v142, v143
buffer_store_dwordx4 v[56:59], v243, s[20:23], s45 offen offset:2048 sc1
v_accvgpr_read_b32 v148, a216
v_accvgpr_read_b32 v149, a217
v_accvgpr_read_b32 v150, a218
v_accvgpr_read_b32 v151, a219
v_cvt_pk_bf16_f32 v90, v148, v149
v_cvt_pk_bf16_f32 v91, v150, v151
buffer_store_dwordx4 v[88:91], v243, s[20:23], s46 offen offset:2048 sc1
v_accvgpr_read_b32 v156, a220
v_accvgpr_read_b32 v157, a221
v_accvgpr_read_b32 v158, a222
v_accvgpr_read_b32 v159, a223
v_cvt_pk_bf16_f32 v122, v156, v157
v_cvt_pk_bf16_f32 v123, v158, v159
buffer_store_dwordx4 v[120:123], v243, s[20:23], s47 offen offset:2048 sc1
s_waitcnt vmcnt(36)
s_branch L2_F
L2_tail_1:
s_waitcnt lgkmcnt(2)
v_add_u32 v231, s50, v243
v_mfma_f32_16x16x32_bf16 v[144:147], v[208:211], v[0:3], 0
s_mov_b32 m0, s30
ds_write_b128 v231, v[160:163] offset:0
v_mfma_f32_16x16x32_bf16 v[144:147], v[212:215], v[4:7], v[144:147]
buffer_load_dwordx4 v241, s[12:15], s28 offen offset:0 sc1 lds
ds_write_b128 v231, v[164:167] offset:1024
v_mfma_f32_16x16x32_bf16 v[148:151], v[208:211], v[32:35], 0
buffer_load_dwordx4 v241, s[12:15], s28 offen offset:1024 sc1 lds
ds_write_b128 v231, v[168:171] offset:2048
v_mfma_f32_16x16x32_bf16 v[148:151], v[212:215], v[36:39], v[148:151]
buffer_load_dwordx4 v241, s[12:15], s28 offen offset:2048 sc1 lds
ds_write_b128 v231, v[172:175] offset:3072
v_mfma_f32_16x16x32_bf16 v[152:155], v[208:211], v[64:67], 0
buffer_load_dwordx4 v241, s[12:15], s28 offen offset:3072 sc1 lds
v_add_u32 v230, 0x8000, v240
v_and_b32 v230, 0x1ffff, v230
v_mfma_f32_16x16x32_bf16 v[152:155], v[212:215], v[68:71], v[152:155]
v_exp_f32 v232, v128
v_mfma_f32_16x16x32_bf16 v[156:159], v[208:211], v[96:99], 0
ds_read_b128 v[208:211], v240 offset:6144
v_exp_f32 v233, v129
v_mfma_f32_16x16x32_bf16 v[156:159], v[212:215], v[100:103], v[156:159]
ds_read_b128 v[212:215], v240 offset:6656
s_waitcnt lgkmcnt(2)
s_and_b32 s30, s30, 0x1c000
v_mfma_f32_16x16x32_bf16 v[144:147], v[216:219], v[8:11], v[144:147]
v_exp_f32 v234, v130
v_cvt_pk_bf16_f32 v160, v232, v233
v_mfma_f32_16x16x32_bf16 v[144:147], v[220:223], v[12:15], v[144:147]
v_exp_f32 v235, v131
s_add_u32 s28, s30, 0x4000
v_mfma_f32_16x16x32_bf16 v[148:151], v[216:219], v[40:43], v[148:151]
v_exp_f32 v236, v132
v_cvt_pk_bf16_f32 v161, v234, v235
v_mfma_f32_16x16x32_bf16 v[148:151], v[220:223], v[44:47], v[148:151]
v_exp_f32 v237, v133
s_and_b32 s28, s28, 0x1ffff
v_mfma_f32_16x16x32_bf16 v[152:155], v[216:219], v[72:75], v[152:155]
v_exp_f32 v238, v134
v_cvt_pk_bf16_f32 v164, v236, v237
v_mfma_f32_16x16x32_bf16 v[152:155], v[220:223], v[76:79], v[152:155]
v_exp_f32 v239, v135
s_add_u32 s30, s30, 0x8000
v_mfma_f32_16x16x32_bf16 v[156:159], v[216:219], v[104:107], v[156:159]
ds_read_b128 v[216:219], v240 offset:10240
v_exp_f32 v232, v136
v_mfma_f32_16x16x32_bf16 v[156:159], v[220:223], v[108:111], v[156:159]
ds_read_b128 v[220:223], v240 offset:10752
s_waitcnt lgkmcnt(2)
v_cvt_pk_bf16_f32 v165, v238, v239
v_mfma_f32_16x16x32_bf16 v[144:147], v[208:211], v[16:19], v[144:147]
v_exp_f32 v233, v137
s_and_b32 s30, s30, 0x1ffff
v_mfma_f32_16x16x32_bf16 v[144:147], v[212:215], v[20:23], v[144:147]
s_waitcnt vmcnt(4)
s_barrier
s_mul_i32 s31, s34, 6144
v_mfma_f32_16x16x32_bf16 v[148:151], v[208:211], v[48:51], v[148:151]
v_exp_f32 v234, v138
v_cvt_pk_bf16_f32 v168, v232, v233
v_mfma_f32_16x16x32_bf16 v[148:151], v[212:215], v[52:55], v[148:151]
v_exp_f32 v235, v139
s_add_u32 s31, s31, s30
v_mfma_f32_16x16x32_bf16 v[152:155], v[208:211], v[80:83], v[152:155]
v_exp_f32 v236, v140
v_cvt_pk_bf16_f32 v169, v234, v235
v_mfma_f32_16x16x32_bf16 v[152:155], v[212:215], v[84:87], v[152:155]
v_exp_f32 v237, v141
s_lshl_b32 s3, s34, 10
v_mfma_f32_16x16x32_bf16 v[156:159], v[208:211], v[112:115], v[156:159]
ds_read_b128 v[208:211], v240 offset:29184
v_exp_f32 v238, v142
v_mfma_f32_16x16x32_bf16 v[156:159], v[212:215], v[116:119], v[156:159]
ds_read_b128 v[212:215], v240 offset:28672
s_waitcnt lgkmcnt(2)
v_cvt_pk_bf16_f32 v172, v236, v237
v_mfma_f32_16x16x32_bf16 v[144:147], v[216:219], v[24:27], v[144:147]
v_exp_f32 v239, v143
v_or3_b32 v242, v160, v161, v164
v_mfma_f32_16x16x32_bf16 v[144:147], v[220:223], v[28:31], v[144:147]
v_cvt_pk_bf16_f32 v173, v238, v239
v_or3_b32 v242, v242, v165, v168
v_or3_b32 v242, v242, v169, v172
v_mfma_f32_16x16x32_bf16 v[148:151], v[216:219], v[56:59], v[148:151]
v_or_b32 v242, v242, v173
v_lshl_or_b32 v242, v242, 16, v242
v_cmp_le_u32 vcc, 2.0, v242
v_mfma_f32_16x16x32_bf16 v[148:151], v[220:223], v[60:63], v[148:151]
s_add_u32 s28, s28, s3
s_add_u32 s3, s3, 24576
s_add_u32 s30, s30, s3
v_mfma_f32_16x16x32_bf16 v[152:155], v[216:219], v[88:91], v[152:155]
v_lshrrev_b32 v241, 4, v243
v_and_b32 v241, 0x30, v241
v_xor_b32 v241, v241, v243
v_mfma_f32_16x16x32_bf16 v[152:155], v[220:223], v[92:95], v[152:155]
s_cbranch_vccnz L2_rare_site12
L2_ret12:
v_and_b32 v228, 0x380, v243
v_mad_u32_u24 v241, v228, 3, v241
v_mfma_f32_16x16x32_bf16 v[156:159], v[216:219], v[120:123], v[156:159]
ds_read_b128 v[216:219], v240 offset:16384
s_add_u32 m0, s31, 0
v_mfma_f32_16x16x32_bf16 v[156:159], v[220:223], v[124:127], v[156:159]
ds_read_b128 v[220:223], v240 offset:16896
s_waitcnt lgkmcnt(2)
v_mfma_f32_16x16x32_bf16 v[128:131], v[208:211], v[0:3], 0
buffer_load_dwordx4 v241, s[8:11], s6 offen lds
s_add_u32 m0, s31, 2048
v_mfma_f32_16x16x32_bf16 v[128:131], v[212:215], v[4:7], v[128:131]
v_exp_f32 v232, v144
v_mfma_f32_16x16x32_bf16 v[132:135], v[208:211], v[32:35], 0
v_exp_f32 v233, v145
v_mfma_f32_16x16x32_bf16 v[132:135], v[212:215], v[36:39], v[132:135]
v_exp_f32 v234, v146
v_cvt_pk_bf16_f32 v162, v232, v233
v_mfma_f32_16x16x32_bf16 v[136:139], v[208:211], v[64:67], 0
v_exp_f32 v235, v147
v_mfma_f32_16x16x32_bf16 v[136:139], v[212:215], v[68:71], v[136:139]
v_exp_f32 v236, v148
v_cvt_pk_bf16_f32 v163, v234, v235
v_mfma_f32_16x16x32_bf16 v[140:143], v[208:211], v[96:99], 0
ds_read_b128 v[208:211], v240 offset:20480
v_exp_f32 v237, v149
v_mfma_f32_16x16x32_bf16 v[140:143], v[212:215], v[100:103], v[140:143]
ds_read_b128 v[212:215], v240 offset:20992
s_waitcnt lgkmcnt(2)
v_mfma_f32_16x16x32_bf16 v[128:131], v[216:219], v[8:11], v[128:131]
ds_write_b128 v231, v[176:179] offset:4096
v_exp_f32 v238, v150
v_mfma_f32_16x16x32_bf16 v[128:131], v[220:223], v[12:15], v[128:131]
ds_write_b128 v231, v[180:183] offset:5120
v_cvt_pk_bf16_f32 v166, v236, v237
v_mfma_f32_16x16x32_bf16 v[132:135], v[216:219], v[40:43], v[132:135]
ds_write_b128 v231, v[184:187] offset:6144
v_exp_f32 v239, v151
v_mfma_f32_16x16x32_bf16 v[132:135], v[220:223], v[44:47], v[132:135]
ds_write_b128 v231, v[188:191] offset:7168
v_exp_f32 v232, v152
v_mfma_f32_16x16x32_bf16 v[136:139], v[216:219], v[72:75], v[136:139]
v_cvt_pk_bf16_f32 v167, v238, v239
v_exp_f32 v233, v153
v_mfma_f32_16x16x32_bf16 v[136:139], v[220:223], v[76:79], v[136:139]
v_exp_f32 v234, v154
v_cvt_pk_bf16_f32 v170, v232, v233
v_mfma_f32_16x16x32_bf16 v[140:143], v[216:219], v[104:107], v[140:143]
ds_read_b128 v[216:219], v240 offset:24576
v_exp_f32 v235, v155
v_mfma_f32_16x16x32_bf16 v[140:143], v[220:223], v[108:111], v[140:143]
ds_read_b128 v[220:223], v240 offset:25088
s_waitcnt lgkmcnt(2)
v_mfma_f32_16x16x32_bf16 v[128:131], v[208:211], v[16:19], v[128:131]
v_exp_f32 v236, v156
v_cvt_pk_bf16_f32 v171, v234, v235
v_mfma_f32_16x16x32_bf16 v[128:131], v[212:215], v[20:23], v[128:131]
v_exp_f32 v237, v157
v_mfma_f32_16x16x32_bf16 v[132:135], v[208:211], v[48:51], v[132:135]
v_exp_f32 v238, v158
v_cvt_pk_bf16_f32 v174, v236, v237
v_mfma_f32_16x16x32_bf16 v[132:135], v[212:215], v[52:55], v[132:135]
v_exp_f32 v239, v159
v_or3_b32 v242, v162, v163, v166
v_mfma_f32_16x16x32_bf16 v[136:139], v[208:211], v[80:83], v[136:139]
v_cvt_pk_bf16_f32 v175, v238, v239
v_or3_b32 v242, v242, v167, v170
v_or3_b32 v242, v242, v171, v174
v_mfma_f32_16x16x32_bf16 v[136:139], v[212:215], v[84:87], v[136:139]
v_or_b32 v242, v242, v175
v_lshl_or_b32 v242, v242, 16, v242
v_cmp_le_u32 vcc, 2.0, v242
s_cbranch_vccnz L2_rare_site13
L2_ret13:
v_mfma_f32_16x16x32_bf16 v[140:143], v[208:211], v[112:115], v[140:143]
ds_read_b128 v[208:211], v240 offset:31232
buffer_load_dwordx4 v241, s[8:11], s7 offen lds
s_add_u32 m0, s31, 4096
v_mfma_f32_16x16x32_bf16 v[140:143], v[212:215], v[116:119], v[140:143]
ds_read_b128 v[212:215], v240 offset:30720
s_waitcnt lgkmcnt(2)
v_mfma_f32_16x16x32_bf16 v[128:131], v[216:219], v[24:27], v[128:131]
buffer_load_dwordx4 v241, s[8:11], s29 offen lds
s_add_u32 m0, s31, 1024
v_xor_b32 v241, 0x1040, v241
v_mfma_f32_16x16x32_bf16 v[128:131], v[220:223], v[28:31], v[128:131]
buffer_load_dwordx4 v241, s[8:11], s6 offen lds
s_add_u32 m0, s31, 3072
v_mfma_f32_16x16x32_bf16 v[132:135], v[216:219], v[56:59], v[132:135]
buffer_load_dwordx4 v241, s[8:11], s7 offen lds
s_add_u32 m0, s31, 5120
v_mfma_f32_16x16x32_bf16 v[132:135], v[220:223], v[60:63], v[132:135]
buffer_load_dwordx4 v241, s[8:11], s29 offen lds
v_mfma_f32_16x16x32_bf16 v[136:139], v[216:219], v[88:91], v[136:139]
v_mfma_f32_16x16x32_bf16 v[136:139], v[220:223], v[92:95], v[136:139]
v_mfma_f32_16x16x32_bf16 v[140:143], v[216:219], v[120:123], v[140:143]
ds_read_b128 v[216:219], v240 offset:18432
v_mfma_f32_16x16x32_bf16 v[140:143], v[220:223], v[124:127], v[140:143]
ds_read_b128 v[220:223], v240 offset:18944
s_waitcnt lgkmcnt(2)
v_mfma_f32_16x16x32_bf16 v[144:147], v[208:211], v[0:3], 0
v_mfma_f32_16x16x32_bf16 v[144:147], v[212:215], v[4:7], v[144:147]
v_exp_f32 v232, v128
v_mfma_f32_16x16x32_bf16 v[148:151], v[208:211], v[32:35], 0
v_exp_f32 v233, v129
v_mfma_f32_16x16x32_bf16 v[148:151], v[212:215], v[36:39], v[148:151]
v_exp_f32 v234, v130
v_cvt_pk_bf16_f32 v176, v232, v233
v_mfma_f32_16x16x32_bf16 v[152:155], v[208:211], v[64:67], 0
v_exp_f32 v235, v131
v_mfma_f32_16x16x32_bf16 v[152:155], v[212:215], v[68:71], v[152:155]
v_exp_f32 v236, v132
v_cvt_pk_bf16_f32 v177, v234, v235
v_mfma_f32_16x16x32_bf16 v[156:159], v[208:211], v[96:99], 0
ds_read_b128 v[208:211], v240 offset:22528
v_exp_f32 v237, v133
v_mfma_f32_16x16x32_bf16 v[156:159], v[212:215], v[100:103], v[156:159]
ds_read_b128 v[212:215], v240 offset:23040
s_waitcnt lgkmcnt(2)
v_mfma_f32_16x16x32_bf16 v[144:147], v[216:219], v[8:11], v[144:147]
v_exp_f32 v238, v134
v_cvt_pk_bf16_f32 v180, v236, v237
v_mfma_f32_16x16x32_bf16 v[144:147], v[220:223], v[12:15], v[144:147]
v_exp_f32 v239, v135
v_mfma_f32_16x16x32_bf16 v[148:151], v[216:219], v[40:43], v[148:151]
v_exp_f32 v232, v136
v_cvt_pk_bf16_f32 v181, v238, v239
v_mfma_f32_16x16x32_bf16 v[148:151], v[220:223], v[44:47], v[148:151]
v_exp_f32 v233, v137
v_mfma_f32_16x16x32_bf16 v[152:155], v[216:219], v[72:75], v[152:155]
v_exp_f32 v234, v138
v_cvt_pk_bf16_f32 v184, v232, v233
v_mfma_f32_16x16x32_bf16 v[152:155], v[220:223], v[76:79], v[152:155]
v_exp_f32 v235, v139
v_mfma_f32_16x16x32_bf16 v[156:159], v[216:219], v[104:107], v[156:159]
ds_read_b128 v[216:219], v240 offset:26624
v_exp_f32 v236, v140
v_mfma_f32_16x16x32_bf16 v[156:159], v[220:223], v[108:111], v[156:159]
ds_read_b128 v[220:223], v240 offset:27136
s_waitcnt lgkmcnt(2)
v_cvt_pk_bf16_f32 v185, v234, v235
v_mfma_f32_16x16x32_bf16 v[144:147], v[208:211], v[16:19], v[144:147]
v_exp_f32 v237, v141
v_mfma_f32_16x16x32_bf16 v[144:147], v[212:215], v[20:23], v[144:147]
s_waitcnt vmcnt(6)
s_barrier
v_mfma_f32_16x16x32_bf16 v[148:151], v[208:211], v[48:51], v[148:151]
v_exp_f32 v238, v142
v_cvt_pk_bf16_f32 v188, v236, v237
v_mfma_f32_16x16x32_bf16 v[148:151], v[212:215], v[52:55], v[148:151]
v_exp_f32 v239, v143
v_or3_b32 v242, v176, v177, v180
v_mfma_f32_16x16x32_bf16 v[152:155], v[208:211], v[80:83], v[152:155]
v_cvt_pk_bf16_f32 v189, v238, v239
v_or3_b32 v242, v242, v181, v184
v_or3_b32 v242, v242, v185, v188
v_mfma_f32_16x16x32_bf16 v[152:155], v[212:215], v[84:87], v[152:155]
v_or_b32 v242, v242, v189
v_lshl_or_b32 v242, v242, 16, v242
v_cmp_le_u32 vcc, 2.0, v242
s_cbranch_vccnz L2_rare_site14
L2_ret14:
v_mfma_f32_16x16x32_bf16 v[156:159], v[208:211], v[112:115], v[156:159]
ds_read_b128 v[208:211], v230 offset:12800
v_mfma_f32_16x16x32_bf16 v[156:159], v[212:215], v[116:119], v[156:159]
ds_read_b128 v[212:215], v230 offset:12288
s_waitcnt lgkmcnt(2)
v_mfma_f32_16x16x32_bf16 v[144:147], v[216:219], v[24:27], v[144:147]
v_mfma_f32_16x16x32_bf16 v[144:147], v[220:223], v[28:31], v[144:147]
v_mfma_f32_16x16x32_bf16 v[148:151], v[216:219], v[56:59], v[148:151]
v_mfma_f32_16x16x32_bf16 v[148:151], v[220:223], v[60:63], v[148:151]
v_mfma_f32_16x16x32_bf16 v[152:155], v[216:219], v[88:91], v[152:155]
v_mfma_f32_16x16x32_bf16 v[152:155], v[220:223], v[92:95], v[152:155]
v_mfma_f32_16x16x32_bf16 v[156:159], v[216:219], v[120:123], v[156:159]
ds_read_b128 v[216:219], v230 offset:0
v_mfma_f32_16x16x32_bf16 v[156:159], v[220:223], v[124:127], v[156:159]
ds_read_b128 v[220:223], v230 offset:512
s_waitcnt lgkmcnt(2)
v_mfma_f32_16x16x32_bf16 v[128:131], v[208:211], v[0:3], 0
v_mfma_f32_16x16x32_bf16 v[128:131], v[212:215], v[4:7], v[128:131]
v_exp_f32 v232, v144
v_mfma_f32_16x16x32_bf16 v[132:135], v[208:211], v[32:35], 0
v_exp_f32 v233, v145
v_mfma_f32_16x16x32_bf16 v[132:135], v[212:215], v[36:39], v[132:135]
v_exp_f32 v234, v146
v_cvt_pk_bf16_f32 v178, v232, v233
v_mfma_f32_16x16x32_bf16 v[136:139], v[208:211], v[64:67], 0
v_exp_f32 v235, v147
v_lshlrev_b32 v241, 3, v243
v_mfma_f32_16x16x32_bf16 v[136:139], v[212:215], v[68:71], v[136:139]
v_exp_f32 v236, v148
v_cvt_pk_bf16_f32 v179, v234, v235
v_mfma_f32_16x16x32_bf16 v[140:143], v[208:211], v[96:99], 0
ds_read_b128 v[208:211], v230 offset:4096
v_exp_f32 v237, v149
v_mfma_f32_16x16x32_bf16 v[140:143], v[212:215], v[100:103], v[140:143]
ds_read_b128 v[212:215], v230 offset:4608
s_waitcnt lgkmcnt(2)
s_mov_b32 s3, 0x7c28000
v_mfma_f32_16x16x32_bf16 v[128:131], v[216:219], v[8:11], v[128:131]
v_exp_f32 v238, v150
v_cvt_pk_bf16_f32 v182, v236, v237
v_mfma_f32_16x16x32_bf16 v[128:131], v[220:223], v[12:15], v[128:131]
v_exp_f32 v239, v151
buffer_load_dwordx2 v[240:241], v241, s[16:19], s3 offen sc1
v_mfma_f32_16x16x32_bf16 v[132:135], v[216:219], v[40:43], v[132:135]
v_exp_f32 v232, v152
v_cvt_pk_bf16_f32 v183, v238, v239
v_mfma_f32_16x16x32_bf16 v[132:135], v[220:223], v[44:47], v[132:135]
v_exp_f32 v233, v153
v_mfma_f32_16x16x32_bf16 v[136:139], v[216:219], v[72:75], v[136:139]
v_exp_f32 v234, v154
v_cvt_pk_bf16_f32 v186, v232, v233
v_mfma_f32_16x16x32_bf16 v[136:139], v[220:223], v[76:79], v[136:139]
v_exp_f32 v235, v155
v_mfma_f32_16x16x32_bf16 v[140:143], v[216:219], v[104:107], v[140:143]
ds_read_b128 v[216:219], v230 offset:8192
v_exp_f32 v236, v156
v_mfma_f32_16x16x32_bf16 v[140:143], v[220:223], v[108:111], v[140:143]
ds_read_b128 v[220:223], v230 offset:8704
s_waitcnt lgkmcnt(2)
v_cvt_pk_bf16_f32 v187, v234, v235
v_mfma_f32_16x16x32_bf16 v[128:131], v[208:211], v[16:19], v[128:131]
v_exp_f32 v237, v157
v_mfma_f32_16x16x32_bf16 v[128:131], v[212:215], v[20:23], v[128:131]
v_exp_f32 v238, v158
v_cvt_pk_bf16_f32 v190, v236, v237
v_mfma_f32_16x16x32_bf16 v[132:135], v[208:211], v[48:51], v[132:135]
v_exp_f32 v239, v159
v_or3_b32 v242, v178, v179, v182
v_mfma_f32_16x16x32_bf16 v[132:135], v[212:215], v[52:55], v[132:135]
v_cvt_pk_bf16_f32 v191, v238, v239
v_or3_b32 v242, v242, v183, v186
v_or3_b32 v242, v242, v187, v190
v_mfma_f32_16x16x32_bf16 v[136:139], v[208:211], v[80:83], v[136:139]
v_or_b32 v242, v242, v191
v_lshl_or_b32 v242, v242, 16, v242
v_cmp_le_u32 vcc, 2.0, v242
s_cbranch_vccnz L2_rare_site15
L2_ret15:
v_mfma_f32_16x16x32_bf16 v[136:139], v[212:215], v[84:87], v[136:139]
v_mfma_f32_16x16x32_bf16 v[140:143], v[208:211], v[112:115], v[140:143]
ds_read_b128 v[208:211], v230 offset:14848
v_mfma_f32_16x16x32_bf16 v[140:143], v[212:215], v[116:119], v[140:143]
ds_read_b128 v[212:215], v230 offset:14336
s_waitcnt lgkmcnt(2)
v_mfma_f32_16x16x32_bf16 v[128:131], v[216:219], v[24:27], v[128:131]
v_mfma_f32_16x16x32_bf16 v[128:131], v[220:223], v[28:31], v[128:131]
v_mfma_f32_16x16x32_bf16 v[132:135], v[216:219], v[56:59], v[132:135]
v_mfma_f32_16x16x32_bf16 v[132:135], v[220:223], v[60:63], v[132:135]
v_mfma_f32_16x16x32_bf16 v[136:139], v[216:219], v[88:91], v[136:139]
v_mfma_f32_16x16x32_bf16 v[136:139], v[220:223], v[92:95], v[136:139]
v_mfma_f32_16x16x32_bf16 v[140:143], v[216:219], v[120:123], v[140:143]
ds_read_b128 v[216:219], v230 offset:2048
v_mfma_f32_16x16x32_bf16 v[140:143], v[220:223], v[124:127], v[140:143]
ds_read_b128 v[220:223], v230 offset:2560
s_waitcnt lgkmcnt(2)
v_mfma_f32_16x16x32_bf16 v[144:147], v[208:211], v[0:3], 0
v_mfma_f32_16x16x32_bf16 v[144:147], v[212:215], v[4:7], v[144:147]
v_mfma_f32_16x16x32_bf16 v[148:151], v[208:211], v[32:35], 0
v_mfma_f32_16x16x32_bf16 v[148:151], v[212:215], v[36:39], v[148:151]
v_mfma_f32_16x16x32_bf16 v[152:155], v[208:211], v[64:67], 0
v_exp_f32 v232, v128
v_mfma_f32_16x16x32_bf16 v[152:155], v[212:215], v[68:71], v[152:155]
v_exp_f32 v233, v129
v_mfma_f32_16x16x32_bf16 v[156:159], v[208:211], v[96:99], 0
ds_read_b128 v[208:211], v230 offset:6144
v_exp_f32 v234, v130
v_mfma_f32_16x16x32_bf16 v[156:159], v[212:215], v[100:103], v[156:159]
ds_read_b128 v[212:215], v230 offset:6656
s_waitcnt lgkmcnt(2)
v_cvt_pk_bf16_f32 v0, v232, v233
v_mfma_f32_16x16x32_bf16 v[144:147], v[216:219], v[8:11], v[144:147]
v_exp_f32 v235, v131
v_mfma_f32_16x16x32_bf16 v[144:147], v[220:223], v[12:15], v[144:147]
ds_read_b128 v[4:7], v231 offset:0
v_exp_f32 v236, v132
v_mfma_f32_16x16x32_bf16 v[148:151], v[216:219], v[40:43], v[148:151]
ds_read_b128 v[36:39], v231 offset:1024
v_cvt_pk_bf16_f32 v1, v234, v235
v_mfma_f32_16x16x32_bf16 v[148:151], v[220:223], v[44:47], v[148:151]
v_exp_f32 v237, v133
v_mfma_f32_16x16x32_bf16 v[152:155], v[216:219], v[72:75], v[152:155]
v_exp_f32 v238, v134
v_cvt_pk_bf16_f32 v32, v236, v237
v_mfma_f32_16x16x32_bf16 v[152:155], v[220:223], v[76:79], v[152:155]
ds_read_b128 v[68:71], v231 offset:2048
ds_read_b128 v[8:11], v231 offset:4096
v_mfma_f32_16x16x32_bf16 v[156:159], v[216:219], v[104:107], v[156:159]
ds_read_b128 v[216:219], v230 offset:10240
v_add_u32 v12, 0x8000, v246
v_and_b32 v12, 0x1ffff, v12
ds_read_b128 v[100:103], v231 offset:3072
ds_read_b128 v[40:43], v231 offset:5120
v_mfma_f32_16x16x32_bf16 v[156:159], v[220:223], v[108:111], v[156:159]
ds_read_b128 v[220:223], v230 offset:10752
s_waitcnt lgkmcnt(2)
v_add_u32 v14, 0x10000, v246
v_and_b32 v14, 0x1ffff, v14
v_mfma_f32_16x16x32_bf16 v[144:147], v[208:211], v[16:19], v[144:147]
v_xor_b32 v13, 32, v12
v_xor_b32 v15, 32, v14
v_mfma_f32_16x16x32_bf16 v[144:147], v[212:215], v[20:23], v[144:147]
ds_read_b128 v[72:75], v231 offset:6144
v_exp_f32 v239, v135
v_mfma_f32_16x16x32_bf16 v[148:151], v[208:211], v[48:51], v[148:151]
ds_read_b128 v[104:107], v231 offset:7168
v_exp_f32 v232, v136
v_mfma_f32_16x16x32_bf16 v[148:151], v[212:215], v[52:55], v[148:151]
v_cvt_pk_bf16_f32 v33, v238, v239
v_exp_f32 v233, v137
v_mfma_f32_16x16x32_bf16 v[152:155], v[208:211], v[80:83], v[152:155]
v_exp_f32 v234, v138
v_cvt_pk_bf16_f32 v64, v232, v233
v_mfma_f32_16x16x32_bf16 v[152:155], v[212:215], v[84:87], v[152:155]
v_exp_f32 v235, v139
v_mfma_f32_16x16x32_bf16 v[156:159], v[208:211], v[112:115], v[156:159]
ds_read_b64_tr_b16 v[208:209], v246 offset:12800
ds_read_b64_tr_b16 v[210:211], v246 offset:14848
v_mfma_f32_16x16x32_bf16 v[156:159], v[212:215], v[116:119], v[156:159]
ds_read_b64_tr_b16 v[212:213], v246 offset:29184
s_waitcnt lgkmcnt(3)
v_mfma_f32_16x16x32_bf16 v[144:147], v[216:219], v[24:27], v[144:147]
ds_read_b64_tr_b16 v[214:215], v246 offset:31232
v_exp_f32 v236, v140
v_mfma_f32_16x16x32_bf16 v[144:147], v[220:223], v[28:31], v[144:147]
v_cvt_pk_bf16_f32 v65, v234, v235
v_exp_f32 v237, v141
v_mfma_f32_16x16x32_bf16 v[148:151], v[216:219], v[56:59], v[148:151]
v_exp_f32 v238, v142
v_cvt_pk_bf16_f32 v96, v236, v237
v_mfma_f32_16x16x32_bf16 v[148:151], v[220:223], v[60:63], v[148:151]
v_exp_f32 v239, v143
v_or3_b32 v242, v0, v1, v32
v_mfma_f32_16x16x32_bf16 v[152:155], v[216:219], v[88:91], v[152:155]
v_cvt_pk_bf16_f32 v97, v238, v239
v_or3_b32 v242, v242, v33, v64
v_or3_b32 v242, v242, v65, v96
v_mfma_f32_16x16x32_bf16 v[152:155], v[220:223], v[92:95], v[152:155]
v_or_b32 v242, v242, v97
v_lshl_or_b32 v242, v242, 16, v242
v_cmp_le_u32 vcc, 2.0, v242
s_cbranch_vccnz L2_rare_site16
L2_ret16:
v_mfma_f32_16x16x32_bf16 v[156:159], v[216:219], v[120:123], v[156:159]
ds_read_b64_tr_b16 v[216:217], v12 offset:12800
ds_read_b64_tr_b16 v[218:219], v12 offset:14848
s_waitcnt vmcnt(0)
v_mfma_f32_16x16x32_bf16 v[156:159], v[220:223], v[124:127], v[156:159]
ds_read_b64_tr_b16 v[220:221], v12 offset:29184
s_waitcnt lgkmcnt(3)
v_cmp_ne_u64_e64 s[38:39], s[98:99], v[240:241]
v_mfma_f32_16x16x32_bf16 a[224:227], v[4:7], v[208:211], a[224:227]
ds_read_b64_tr_b16 v[222:223], v12 offset:31232
s_and_b64 s[38:39], s[38:39], s[96:97]
s_cbranch_scc1 LF_hl_0
LF_hlret_0:
v_mfma_f32_16x16x32_bf16 a[224:227], v[8:11], v[212:215], a[224:227]
v_exp_f32 v232, v144
v_lshrrev_b32 v241, 4, v243
v_mfma_f32_16x16x32_bf16 a[228:231], v[36:39], v[208:211], a[228:231]
v_exp_f32 v233, v145
v_and_b32 v241, 0x30, v241
v_mfma_f32_16x16x32_bf16 a[228:231], v[40:43], v[212:215], a[228:231]
v_exp_f32 v234, v146
v_xor_b32 v241, v241, v243
v_mfma_f32_16x16x32_bf16 a[232:235], v[68:71], v[208:211], a[232:235]
v_cvt_pk_bf16_f32 v2, v232, v233
v_and_b32 v228, 0x380, v243
v_mad_u32_u24 v241, v228, 3, v241
v_mfma_f32_16x16x32_bf16 a[232:235], v[72:75], v[212:215], a[232:235]
v_exp_f32 v235, v147
v_add_u32 v241, 0x7000000, v241
v_mfma_f32_16x16x32_bf16 a[236:239], v[100:103], v[208:211], a[236:239]
ds_read_b64_tr_b16 v[208:209], v247 offset:12800
ds_read_b64_tr_b16 v[210:211], v247 offset:14848
v_and_b32 v110, 0x70, v243
v_mfma_f32_16x16x32_bf16 a[236:239], v[104:107], v[212:215], a[236:239]
ds_read_b64_tr_b16 v[212:213], v247 offset:29184
s_waitcnt lgkmcnt(3)
v_lshlrev_b32 v110, 3, v110
v_mfma_f32_16x16x32_bf16 a[224:227], v[160:163], v[216:219], a[224:227]
ds_read_b64_tr_b16 v[214:215], v247 offset:31232
v_add_u32 v110, 0x7c32000, v110
buffer_load_dwordx2 v[108:109], v110, s[16:19], 0 offen sc1
v_mfma_f32_16x16x32_bf16 a[224:227], v[176:179], v[220:223], a[224:227]
v_exp_f32 v236, v148
v_mfma_f32_16x16x32_bf16 a[228:231], v[164:167], v[216:219], a[228:231]
v_cvt_pk_bf16_f32 v3, v234, v235
s_add_u32 m0, s28, 0
v_mfma_f32_16x16x32_bf16 a[228:231], v[180:183], v[220:223], a[228:231]
v_exp_f32 v237, v149
v_mfma_f32_16x16x32_bf16 a[232:235], v[168:171], v[216:219], a[232:235]
v_exp_f32 v238, v150
v_mfma_f32_16x16x32_bf16 a[232:235], v[184:187], v[220:223], a[232:235]
v_cvt_pk_bf16_f32 v34, v236, v237
buffer_load_dwordx4 v241, s[16:19], s6 offen sc1 lds
s_add_u32 m0, s28, 8192
v_mfma_f32_16x16x32_bf16 a[236:239], v[172:175], v[216:219], a[236:239]
ds_read_b64_tr_b16 v[216:217], v13 offset:12800
ds_read_b64_tr_b16 v[218:219], v13 offset:14848
v_mfma_f32_16x16x32_bf16 a[236:239], v[188:191], v[220:223], a[236:239]
ds_read_b64_tr_b16 v[220:221], v13 offset:29184
s_waitcnt lgkmcnt(3)
v_mfma_f32_16x16x32_bf16 a[240:243], v[4:7], v[208:211], a[240:243]
ds_read_b64_tr_b16 v[222:223], v13 offset:31232
buffer_load_dwordx4 v241, s[16:19], s7 offen sc1 lds
s_add_u32 m0, s30, 0
v_mfma_f32_16x16x32_bf16 a[240:243], v[8:11], v[212:215], a[240:243]
v_exp_f32 v239, v151
v_mfma_f32_16x16x32_bf16 a[244:247], v[36:39], v[208:211], a[244:247]
v_exp_f32 v232, v152
v_mfma_f32_16x16x32_bf16 a[244:247], v[40:43], v[212:215], a[244:247]
v_cvt_pk_bf16_f32 v35, v238, v239
buffer_load_dwordx4 v241, s[16:19], s29 offen sc1 lds
s_add_u32 m0, s28, 4096
v_mfma_f32_16x16x32_bf16 a[248:251], v[68:71], v[208:211], a[248:251]
v_exp_f32 v233, v153
v_xor_b32 v241, 0x1040, v241
v_mfma_f32_16x16x32_bf16 a[248:251], v[72:75], v[212:215], a[248:251]
v_exp_f32 v234, v154
v_mfma_f32_16x16x32_bf16 a[252:255], v[100:103], v[208:211], a[252:255]
ds_read_b64_tr_b16 v[208:209], v246 offset:16384
ds_read_b64_tr_b16 v[210:211], v246 offset:18432
v_mfma_f32_16x16x32_bf16 a[252:255], v[104:107], v[212:215], a[252:255]
ds_read_b64_tr_b16 v[212:213], v12 offset:0
s_waitcnt lgkmcnt(3)
v_mfma_f32_16x16x32_bf16 a[240:243], v[160:163], v[216:219], a[240:243]
ds_read_b64_tr_b16 v[214:215], v12 offset:2048
v_cvt_pk_bf16_f32 v66, v232, v233
v_mfma_f32_16x16x32_bf16 a[240:243], v[176:179], v[220:223], a[240:243]
v_exp_f32 v235, v155
v_mfma_f32_16x16x32_bf16 a[244:247], v[164:167], v[216:219], a[244:247]
v_exp_f32 v236, v156
v_mfma_f32_16x16x32_bf16 a[244:247], v[180:183], v[220:223], a[244:247]
v_cvt_pk_bf16_f32 v67, v234, v235
buffer_load_dwordx4 v241, s[16:19], s6 offen sc1 lds
s_add_u32 m0, s28, 12288
v_mfma_f32_16x16x32_bf16 a[248:251], v[168:171], v[216:219], a[248:251]
v_exp_f32 v237, v157
v_mfma_f32_16x16x32_bf16 a[248:251], v[184:187], v[220:223], a[248:251]
v_exp_f32 v238, v158
v_mfma_f32_16x16x32_bf16 a[252:255], v[172:175], v[216:219], a[252:255]
ds_read_b64_tr_b16 v[216:217], v12 offset:16384
ds_read_b64_tr_b16 v[218:219], v12 offset:18432
v_mfma_f32_16x16x32_bf16 a[252:255], v[188:191], v[220:223], a[252:255]
ds_read_b64_tr_b16 v[220:221], v247 offset:16384
s_waitcnt lgkmcnt(3)
v_mfma_f32_16x16x32_bf16 a[0:3], v[8:11], v[208:211], a[0:3]
ds_read_b64_tr_b16 v[222:223], v247 offset:18432
v_cvt_pk_bf16_f32 v98, v236, v237
v_mfma_f32_16x16x32_bf16 a[0:3], v[160:163], v[212:215], a[0:3]
v_exp_f32 v239, v159
v_mfma_f32_16x16x32_bf16 a[4:7], v[40:43], v[208:211], a[4:7]
v_or3_b32 v242, v2, v3, v34
v_cvt_pk_bf16_f32 v99, v238, v239
v_mfma_f32_16x16x32_bf16 a[4:7], v[164:167], v[212:215], a[4:7]
v_or3_b32 v242, v242, v35, v66
v_or3_b32 v242, v242, v67, v98
v_mfma_f32_16x16x32_bf16 a[8:11], v[72:75], v[208:211], a[8:11]
v_or_b32 v242, v242, v99
v_lshl_or_b32 v242, v242, 16, v242
v_mfma_f32_16x16x32_bf16 a[8:11], v[168:171], v[212:215], a[8:11]
v_cmp_le_u32 vcc, 2.0, v242
s_cbranch_vccnz L2_rare_site17
L2_ret17:
v_mfma_f32_16x16x32_bf16 a[12:15], v[104:107], v[208:211], a[12:15]
ds_read_b64_tr_b16 v[208:209], v13 offset:0
ds_read_b64_tr_b16 v[210:211], v13 offset:2048
v_mfma_f32_16x16x32_bf16 a[12:15], v[172:175], v[212:215], a[12:15]
ds_read_b64_tr_b16 v[212:213], v13 offset:16384
s_waitcnt lgkmcnt(5)
v_mfma_f32_16x16x32_bf16 a[0:3], v[176:179], v[216:219], a[0:3]
ds_read_b64_tr_b16 v[214:215], v13 offset:18432
buffer_load_dwordx4 v241, s[16:19], s7 offen sc1 lds
s_add_u32 m0, s30, 4096
v_mfma_f32_16x16x32_bf16 a[4:7], v[180:183], v[216:219], a[4:7]
buffer_load_dwordx4 v241, s[16:19], s29 offen sc1 lds
v_mfma_f32_16x16x32_bf16 a[8:11], v[184:187], v[216:219], a[8:11]
v_mfma_f32_16x16x32_bf16 a[12:15], v[188:191], v[216:219], a[12:15]
ds_read_b64_tr_b16 v[216:217], v14 offset:12800
s_waitcnt lgkmcnt(5)
v_mfma_f32_16x16x32_bf16 a[16:19], v[8:11], v[220:223], a[16:19]
ds_read_b64_tr_b16 v[218:219], v14 offset:14848
v_mfma_f32_16x16x32_bf16 a[20:23], v[40:43], v[220:223], a[20:23]
v_mfma_f32_16x16x32_bf16 a[24:27], v[72:75], v[220:223], a[24:27]
v_mfma_f32_16x16x32_bf16 a[28:31], v[104:107], v[220:223], a[28:31]
ds_read_b64_tr_b16 v[220:221], v15 offset:12800
s_waitcnt lgkmcnt(3)
v_mfma_f32_16x16x32_bf16 a[16:19], v[160:163], v[208:211], a[16:19]
ds_read_b64_tr_b16 v[222:223], v15 offset:14848
v_mfma_f32_16x16x32_bf16 a[16:19], v[176:179], v[212:215], a[16:19]
v_mfma_f32_16x16x32_bf16 a[20:23], v[164:167], v[208:211], a[20:23]
v_mfma_f32_16x16x32_bf16 a[20:23], v[180:183], v[212:215], a[20:23]
v_mfma_f32_16x16x32_bf16 a[24:27], v[168:171], v[208:211], a[24:27]
v_mfma_f32_16x16x32_bf16 a[24:27], v[184:187], v[212:215], a[24:27]
v_mfma_f32_16x16x32_bf16 a[28:31], v[172:175], v[208:211], a[28:31]
ds_read_b64_tr_b16 v[208:209], v14 offset:0
ds_read_b64_tr_b16 v[210:211], v14 offset:2048
v_mfma_f32_16x16x32_bf16 a[28:31], v[188:191], v[212:215], a[28:31]
ds_read_b64_tr_b16 v[212:213], v15 offset:0
s_waitcnt lgkmcnt(5)
v_mfma_f32_16x16x32_bf16 a[224:227], v[0:3], v[216:219], a[224:227]
ds_read_b64_tr_b16 v[214:215], v15 offset:2048
v_lshrrev_b32 v228, 4, v243
v_and_b32 v228, 0x3c, v228
v_mfma_f32_16x16x32_bf16 a[228:231], v[32:35], v[216:219], a[228:231]
v_sub_f32 v224, 0, v224
v_sub_f32 v225, 0, v225
v_sub_f32 v226, 0, v226
v_mfma_f32_16x16x32_bf16 a[232:235], v[64:67], v[216:219], a[232:235]
v_sub_f32 v227, 0, v227
ds_bpermute_b32 v232, v228, v224
ds_bpermute_b32 v234, v228, v225
v_mfma_f32_16x16x32_bf16 a[236:239], v[96:99], v[216:219], a[236:239]
ds_read_b64_tr_b16 v[216:217], v246 offset:16896
s_waitcnt lgkmcnt(5)
ds_bpermute_b32 v236, v228, v226
v_mfma_f32_16x16x32_bf16 a[240:243], v[0:3], v[220:223], a[240:243]
ds_read_b64_tr_b16 v[218:219], v246 offset:18944
ds_bpermute_b32 v238, v228, v227
v_bfe_u32 v228, v243, 4, 1
v_mfma_f32_16x16x32_bf16 a[244:247], v[32:35], v[220:223], a[244:247]
v_mul_u32_u24 v228, 768, v228
v_lshl_add_u32 v228, s37, 7, v228
v_lshrrev_b32 v242, 6, v243
v_mfma_f32_16x16x32_bf16 a[248:251], v[64:67], v[220:223], a[248:251]
v_lshl_add_u32 v242, v242, 3, v228
v_accvgpr_read_b32 v128, a224
v_accvgpr_read_b32 v129, a225
v_mfma_f32_16x16x32_bf16 a[252:255], v[96:99], v[220:223], a[252:255]
ds_read_b64_tr_b16 v[220:221], v12 offset:512
s_waitcnt lgkmcnt(5)
v_accvgpr_read_b32 v130, a226
v_mfma_f32_16x16x32_bf16 a[0:3], v[0:3], v[208:211], a[0:3]
ds_read_b64_tr_b16 v[222:223], v12 offset:2560
v_accvgpr_read_b32 v131, a227
v_cvt_pk_bf16_f32 v28, v128, v129
v_mfma_f32_16x16x32_bf16 a[4:7], v[32:35], v[208:211], a[4:7]
v_cvt_pk_bf16_f32 v29, v130, v131
v_accvgpr_read_b32 v136, a228
v_accvgpr_read_b32 v137, a229
v_mfma_f32_16x16x32_bf16 a[8:11], v[64:67], v[208:211], a[8:11]
v_accvgpr_read_b32 v138, a230
v_accvgpr_read_b32 v139, a231
v_cvt_pk_bf16_f32 v60, v136, v137
v_mfma_f32_16x16x32_bf16 a[12:15], v[96:99], v[208:211], a[12:15]
ds_read_b64_tr_b16 v[208:209], v12 offset:16896
s_waitcnt lgkmcnt(5)
v_cvt_pk_bf16_f32 v61, v138, v139
v_mfma_f32_16x16x32_bf16 a[16:19], v[0:3], v[212:215], a[16:19]
ds_read_b64_tr_b16 v[210:211], v12 offset:18944
v_accvgpr_read_b32 v144, a232
v_accvgpr_read_b32 v145, a233
v_mfma_f32_16x16x32_bf16 a[20:23], v[32:35], v[212:215], a[20:23]
v_accvgpr_read_b32 v146, a234
v_accvgpr_read_b32 v147, a235
v_cvt_pk_bf16_f32 v92, v144, v145
v_mfma_f32_16x16x32_bf16 a[24:27], v[64:67], v[212:215], a[24:27]
v_cvt_pk_bf16_f32 v93, v146, v147
v_accvgpr_read_b32 v152, a236
v_accvgpr_read_b32 v153, a237
v_mfma_f32_16x16x32_bf16 a[28:31], v[96:99], v[212:215], a[28:31]
ds_read_b64_tr_b16 v[212:213], v14 offset:512
s_waitcnt lgkmcnt(3)
v_accvgpr_read_b32 v154, a238
v_mfma_f32_16x16x32_bf16 a[32:35], v[8:11], v[216:219], a[32:35]
ds_read_b64_tr_b16 v[214:215], v14 offset:2560
v_accvgpr_read_b32 v155, a239
v_cvt_pk_bf16_f32 v124, v152, v153
v_mfma_f32_16x16x32_bf16 a[32:35], v[160:163], v[220:223], a[32:35]
v_cvt_pk_bf16_f32 v125, v154, v155
v_accvgpr_read_b32 v132, a240
v_accvgpr_read_b32 v133, a241
v_mfma_f32_16x16x32_bf16 a[36:39], v[40:43], v[216:219], a[36:39]
v_accvgpr_read_b32 v134, a242
v_accvgpr_read_b32 v135, a243
v_cvt_pk_bf16_f32 v30, v132, v133
v_mfma_f32_16x16x32_bf16 a[36:39], v[164:167], v[220:223], a[36:39]
v_cvt_pk_bf16_f32 v31, v134, v135
buffer_store_dwordx4 v[28:31], v243, s[20:23], s44 offen offset:3072 sc1
ds_write_b128 v231, v[28:31] offset:7168
v_mfma_f32_16x16x32_bf16 a[40:43], v[72:75], v[216:219], a[40:43]
v_accvgpr_read_b32 v140, a244
v_accvgpr_read_b32 v141, a245
v_accvgpr_read_b32 v142, a246
v_mfma_f32_16x16x32_bf16 a[40:43], v[168:171], v[220:223], a[40:43]
v_accvgpr_read_b32 v143, a247
v_cvt_pk_bf16_f32 v62, v140, v141
v_cvt_pk_bf16_f32 v63, v142, v143
v_mfma_f32_16x16x32_bf16 a[44:47], v[104:107], v[216:219], a[44:47]
ds_read_b64_tr_b16 v[216:217], v247 offset:16896
ds_read_b64_tr_b16 v[218:219], v247 offset:18944
buffer_store_dwordx4 v[60:63], v243, s[20:23], s45 offen offset:3072 sc1
v_mfma_f32_16x16x32_bf16 a[44:47], v[172:175], v[220:223], a[44:47]
ds_read_b64_tr_b16 v[220:221], v13 offset:512
s_waitcnt lgkmcnt(3)
v_accvgpr_read_b32 v148, a248
v_mfma_f32_16x16x32_bf16 a[32:35], v[176:179], v[208:211], a[32:35]
ds_read_b64_tr_b16 v[222:223], v13 offset:2560
v_accvgpr_read_b32 v149, a249
v_accvgpr_read_b32 v150, a250
v_mfma_f32_16x16x32_bf16 a[32:35], v[0:3], v[212:215], a[32:35]
v_accvgpr_read_b32 v151, a251
v_cvt_pk_bf16_f32 v94, v148, v149
v_cvt_pk_bf16_f32 v95, v150, v151
v_mfma_f32_16x16x32_bf16 a[36:39], v[180:183], v[208:211], a[36:39]
buffer_store_dwordx4 v[92:95], v243, s[20:23], s46 offen offset:3072 sc1
v_accvgpr_read_b32 v156, a252
v_accvgpr_read_b32 v157, a253
v_mfma_f32_16x16x32_bf16 a[36:39], v[32:35], v[212:215], a[36:39]
v_accvgpr_read_b32 v158, a254
v_accvgpr_read_b32 v159, a255
v_cvt_pk_bf16_f32 v126, v156, v157
v_mfma_f32_16x16x32_bf16 a[40:43], v[184:187], v[208:211], a[40:43]
v_cvt_pk_bf16_f32 v127, v158, v159
buffer_store_dwordx4 v[124:127], v243, s[20:23], s47 offen offset:3072 sc1
v_mov_b32_dpp v233, v132 row_newbcast:15 row_mask:0xf bank_mask:0x1
v_mfma_f32_16x16x32_bf16 a[40:43], v[64:67], v[212:215], a[40:43]
v_mov_b32_dpp v235, v140 row_newbcast:15 row_mask:0xf bank_mask:0x1
v_mov_b32_dpp v237, v148 row_newbcast:15 row_mask:0xf bank_mask:0x1
v_mov_b32_dpp v239, v156 row_newbcast:15 row_mask:0xf bank_mask:0x1
v_mfma_f32_16x16x32_bf16 a[44:47], v[188:191], v[208:211], a[44:47]
ds_read_b64_tr_b16 v[208:209], v13 offset:16896
ds_read_b64_tr_b16 v[210:211], v13 offset:18944
v_mov_b32_dpp v233, v133 row_newbcast:15 row_mask:0xf bank_mask:0x2
v_mfma_f32_16x16x32_bf16 a[44:47], v[96:99], v[212:215], a[44:47]
ds_read_b64_tr_b16 v[212:213], v15 offset:512
s_waitcnt lgkmcnt(3)
v_mov_b32_dpp v235, v141 row_newbcast:15 row_mask:0xf bank_mask:0x2
v_mfma_f32_16x16x32_bf16 a[48:51], v[8:11], v[216:219], a[48:51]
ds_read_b64_tr_b16 v[214:215], v15 offset:2560
v_mov_b32_dpp v237, v149 row_newbcast:15 row_mask:0xf bank_mask:0x2
v_mov_b32_dpp v239, v157 row_newbcast:15 row_mask:0xf bank_mask:0x2
v_mfma_f32_16x16x32_bf16 a[48:51], v[160:163], v[220:223], a[48:51]
v_mov_b32_dpp v233, v134 row_newbcast:15 row_mask:0xf bank_mask:0x4
v_mov_b32_dpp v235, v142 row_newbcast:15 row_mask:0xf bank_mask:0x4
v_mov_b32_dpp v237, v150 row_newbcast:15 row_mask:0xf bank_mask:0x4
v_mfma_f32_16x16x32_bf16 a[52:55], v[40:43], v[216:219], a[52:55]
v_mov_b32_dpp v239, v158 row_newbcast:15 row_mask:0xf bank_mask:0x4
v_mov_b32_dpp v233, v135 row_newbcast:15 row_mask:0xf bank_mask:0x8
v_mov_b32_dpp v235, v143 row_newbcast:15 row_mask:0xf bank_mask:0x8
v_mfma_f32_16x16x32_bf16 a[52:55], v[164:167], v[220:223], a[52:55]
v_mov_b32_dpp v237, v151 row_newbcast:15 row_mask:0xf bank_mask:0x8
v_mov_b32_dpp v239, v159 row_newbcast:15 row_mask:0xf bank_mask:0x8
v_mfma_f32_16x16x32_bf16 a[56:59], v[72:75], v[216:219], a[56:59]
s_mov_b32 exec_lo, 0x33333333
s_mov_b32 exec_hi, 0x33333333
buffer_store_dwordx2 v[232:233], v242, s[24:27], s48 offen sc1
s_lshr_b32 s3, s41, 2
buffer_store_dwordx2 v[234:235], v242, s[24:27], s3 offen sc1
s_lshr_b32 s3, s42, 2
buffer_store_dwordx2 v[236:237], v242, s[24:27], s3 offen sc1
s_lshr_b32 s3, s43, 2
buffer_store_dwordx2 v[238:239], v242, s[24:27], s3 offen sc1
s_mov_b64 exec, -1
v_mfma_f32_16x16x32_bf16 a[56:59], v[168:171], v[220:223], a[56:59]
v_accvgpr_read_b32 v128, a0
v_accvgpr_read_b32 v129, a1
v_accvgpr_read_b32 v130, a2
v_mfma_f32_16x16x32_bf16 a[60:63], v[104:107], v[216:219], a[60:63]
ds_read_b64_tr_b16 v[216:217], v246 offset:20480
ds_read_b64_tr_b16 v[218:219], v246 offset:22528
v_accvgpr_read_b32 v131, a3
v_mfma_f32_16x16x32_bf16 a[60:63], v[172:175], v[220:223], a[60:63]
ds_read_b64_tr_b16 v[220:221], v12 offset:4096
s_waitcnt lgkmcnt(3)
v_cvt_pk_bf16_f32 v16, v128, v129
v_mfma_f32_16x16x32_bf16 a[48:51], v[176:179], v[208:211], a[48:51]
ds_read_b64_tr_b16 v[222:223], v12 offset:6144
v_cvt_pk_bf16_f32 v17, v130, v131
v_accvgpr_read_b32 v136, a4
v_mfma_f32_16x16x32_bf16 a[48:51], v[0:3], v[212:215], a[48:51]
v_accvgpr_read_b32 v137, a5
v_accvgpr_read_b32 v138, a6
v_accvgpr_read_b32 v139, a7
v_mfma_f32_16x16x32_bf16 a[52:55], v[180:183], v[208:211], a[52:55]
v_cvt_pk_bf16_f32 v48, v136, v137
v_cvt_pk_bf16_f32 v49, v138, v139
v_accvgpr_read_b32 v144, a8
v_mfma_f32_16x16x32_bf16 a[52:55], v[32:35], v[212:215], a[52:55]
v_accvgpr_read_b32 v145, a9
v_accvgpr_read_b32 v146, a10
v_accvgpr_read_b32 v147, a11
v_mfma_f32_16x16x32_bf16 a[56:59], v[184:187], v[208:211], a[56:59]
v_cvt_pk_bf16_f32 v80, v144, v145
v_cvt_pk_bf16_f32 v81, v146, v147
v_accvgpr_read_b32 v152, a12
v_mfma_f32_16x16x32_bf16 a[56:59], v[64:67], v[212:215], a[56:59]
v_accvgpr_read_b32 v153, a13
v_accvgpr_read_b32 v154, a14
v_accvgpr_read_b32 v155, a15
v_mfma_f32_16x16x32_bf16 a[60:63], v[188:191], v[208:211], a[60:63]
ds_read_b64_tr_b16 v[208:209], v12 offset:20480
ds_read_b64_tr_b16 v[210:211], v12 offset:22528
v_cvt_pk_bf16_f32 v112, v152, v153
v_mfma_f32_16x16x32_bf16 a[60:63], v[96:99], v[212:215], a[60:63]
ds_read_b64_tr_b16 v[212:213], v14 offset:4096
s_waitcnt lgkmcnt(3)
v_cvt_pk_bf16_f32 v113, v154, v155
v_mfma_f32_16x16x32_bf16 a[64:67], v[8:11], v[216:219], a[64:67]
ds_read_b64_tr_b16 v[214:215], v14 offset:6144
v_accvgpr_read_b32 v132, a16
v_accvgpr_read_b32 v133, a17
v_mfma_f32_16x16x32_bf16 a[64:67], v[160:163], v[220:223], a[64:67]
v_accvgpr_read_b32 v134, a18
v_accvgpr_read_b32 v135, a19
v_cvt_pk_bf16_f32 v18, v132, v133
v_mfma_f32_16x16x32_bf16 a[68:71], v[40:43], v[216:219], a[68:71]
v_cvt_pk_bf16_f32 v19, v134, v135
buffer_store_dwordx4 v[16:19], v243, s[20:23], s40 offen offset:0 sc1
ds_write_b128 v231, v[16:19] offset:0
v_mfma_f32_16x16x32_bf16 a[68:71], v[164:167], v[220:223], a[68:71]
v_accvgpr_read_b32 v140, a20
v_accvgpr_read_b32 v141, a21
v_accvgpr_read_b32 v142, a22
v_mfma_f32_16x16x32_bf16 a[72:75], v[72:75], v[216:219], a[72:75]
v_accvgpr_read_b32 v143, a23
v_cvt_pk_bf16_f32 v50, v140, v141
v_cvt_pk_bf16_f32 v51, v142, v143
v_mfma_f32_16x16x32_bf16 a[72:75], v[168:171], v[220:223], a[72:75]
buffer_store_dwordx4 v[48:51], v243, s[20:23], s41 offen offset:0 sc1
v_accvgpr_read_b32 v148, a24
v_accvgpr_read_b32 v149, a25
v_mfma_f32_16x16x32_bf16 a[76:79], v[104:107], v[216:219], a[76:79]
ds_read_b64_tr_b16 v[216:217], v247 offset:20480
ds_read_b64_tr_b16 v[218:219], v247 offset:22528
v_accvgpr_read_b32 v150, a26
v_mfma_f32_16x16x32_bf16 a[76:79], v[172:175], v[220:223], a[76:79]
ds_read_b64_tr_b16 v[220:221], v13 offset:4096
s_waitcnt lgkmcnt(3)
v_accvgpr_read_b32 v151, a27
v_mfma_f32_16x16x32_bf16 a[64:67], v[176:179], v[208:211], a[64:67]
ds_read_b64_tr_b16 v[222:223], v13 offset:6144
v_cvt_pk_bf16_f32 v82, v148, v149
v_cvt_pk_bf16_f32 v83, v150, v151
v_mfma_f32_16x16x32_bf16 a[64:67], v[0:3], v[212:215], a[64:67]
buffer_store_dwordx4 v[80:83], v243, s[20:23], s42 offen offset:0 sc1
v_accvgpr_read_b32 v156, a28
v_accvgpr_read_b32 v157, a29
v_mfma_f32_16x16x32_bf16 a[68:71], v[180:183], v[208:211], a[68:71]
v_accvgpr_read_b32 v158, a30
v_accvgpr_read_b32 v159, a31
v_cvt_pk_bf16_f32 v114, v156, v157
v_mfma_f32_16x16x32_bf16 a[68:71], v[32:35], v[212:215], a[68:71]
v_cvt_pk_bf16_f32 v115, v158, v159
buffer_store_dwordx4 v[112:115], v243, s[20:23], s43 offen offset:0 sc1
v_accvgpr_read_b32 v128, a32
v_mfma_f32_16x16x32_bf16 a[72:75], v[184:187], v[208:211], a[72:75]
v_accvgpr_read_b32 v129, a33
v_accvgpr_read_b32 v130, a34
v_accvgpr_read_b32 v131, a35
v_mfma_f32_16x16x32_bf16 a[72:75], v[64:67], v[212:215], a[72:75]
v_cvt_pk_bf16_f32 v20, v128, v129
v_cvt_pk_bf16_f32 v21, v130, v131
v_accvgpr_read_b32 v136, a36
v_mfma_f32_16x16x32_bf16 a[76:79], v[188:191], v[208:211], a[76:79]
ds_read_b64_tr_b16 v[208:209], v13 offset:20480
ds_read_b64_tr_b16 v[210:211], v13 offset:22528
v_accvgpr_read_b32 v137, a37
v_mfma_f32_16x16x32_bf16 a[76:79], v[96:99], v[212:215], a[76:79]
ds_read_b64_tr_b16 v[212:213], v15 offset:4096
s_waitcnt lgkmcnt(3)
v_accvgpr_read_b32 v138, a38
v_mfma_f32_16x16x32_bf16 a[80:83], v[8:11], v[216:219], a[80:83]
ds_read_b64_tr_b16 v[214:215], v15 offset:6144
v_accvgpr_read_b32 v139, a39
v_cvt_pk_bf16_f32 v52, v136, v137
v_mfma_f32_16x16x32_bf16 a[80:83], v[160:163], v[220:223], a[80:83]
v_cvt_pk_bf16_f32 v53, v138, v139
v_accvgpr_read_b32 v144, a40
v_accvgpr_read_b32 v145, a41
v_mfma_f32_16x16x32_bf16 a[84:87], v[40:43], v[216:219], a[84:87]
v_accvgpr_read_b32 v146, a42
v_accvgpr_read_b32 v147, a43
v_cvt_pk_bf16_f32 v84, v144, v145
v_mfma_f32_16x16x32_bf16 a[84:87], v[164:167], v[220:223], a[84:87]
v_cvt_pk_bf16_f32 v85, v146, v147
v_accvgpr_read_b32 v152, a44
v_accvgpr_read_b32 v153, a45
v_mfma_f32_16x16x32_bf16 a[88:91], v[72:75], v[216:219], a[88:91]
v_accvgpr_read_b32 v154, a46
v_accvgpr_read_b32 v155, a47
v_cvt_pk_bf16_f32 v116, v152, v153
v_mfma_f32_16x16x32_bf16 a[88:91], v[168:171], v[220:223], a[88:91]
v_cvt_pk_bf16_f32 v117, v154, v155
v_accvgpr_read_b32 v132, a48
v_accvgpr_read_b32 v133, a49
v_mfma_f32_16x16x32_bf16 a[92:95], v[104:107], v[216:219], a[92:95]
ds_read_b64_tr_b16 v[216:217], v246 offset:20992
ds_read_b64_tr_b16 v[218:219], v246 offset:23040
v_accvgpr_read_b32 v134, a50
v_mfma_f32_16x16x32_bf16 a[92:95], v[172:175], v[220:223], a[92:95]
ds_read_b64_tr_b16 v[220:221], v12 offset:4608
s_waitcnt lgkmcnt(3)
v_accvgpr_read_b32 v135, a51
v_mfma_f32_16x16x32_bf16 a[80:83], v[176:179], v[208:211], a[80:83]
ds_read_b64_tr_b16 v[222:223], v12 offset:6656
v_cvt_pk_bf16_f32 v22, v132, v133
v_cvt_pk_bf16_f32 v23, v134, v135
v_mfma_f32_16x16x32_bf16 a[80:83], v[0:3], v[212:215], a[80:83]
buffer_store_dwordx4 v[20:23], v243, s[20:23], s40 offen offset:1024 sc1
ds_write_b128 v231, v[20:23] offset:1024
v_accvgpr_read_b32 v140, a52
v_mfma_f32_16x16x32_bf16 a[84:87], v[180:183], v[208:211], a[84:87]
v_accvgpr_read_b32 v141, a53
v_accvgpr_read_b32 v142, a54
v_accvgpr_read_b32 v143, a55
v_mfma_f32_16x16x32_bf16 a[84:87], v[32:35], v[212:215], a[84:87]
v_cvt_pk_bf16_f32 v54, v140, v141
v_cvt_pk_bf16_f32 v55, v142, v143
buffer_store_dwordx4 v[52:55], v243, s[20:23], s41 offen offset:1024 sc1
v_mfma_f32_16x16x32_bf16 a[88:91], v[184:187], v[208:211], a[88:91]
v_accvgpr_read_b32 v148, a56
v_accvgpr_read_b32 v149, a57
v_accvgpr_read_b32 v150, a58
v_mfma_f32_16x16x32_bf16 a[88:91], v[64:67], v[212:215], a[88:91]
v_accvgpr_read_b32 v151, a59
v_cvt_pk_bf16_f32 v86, v148, v149
v_cvt_pk_bf16_f32 v87, v150, v151
v_mfma_f32_16x16x32_bf16 a[92:95], v[188:191], v[208:211], a[92:95]
ds_read_b64_tr_b16 v[208:209], v12 offset:20992
ds_read_b64_tr_b16 v[210:211], v12 offset:23040
buffer_store_dwordx4 v[84:87], v243, s[20:23], s42 offen offset:1024 sc1
v_mfma_f32_16x16x32_bf16 a[92:95], v[96:99], v[212:215], a[92:95]
ds_read_b64_tr_b16 v[212:213], v14 offset:4608
s_waitcnt lgkmcnt(3)
v_accvgpr_read_b32 v156, a60
v_mfma_f32_16x16x32_bf16 a[96:99], v[8:11], v[216:219], a[96:99]
ds_read_b64_tr_b16 v[214:215], v14 offset:6656
v_accvgpr_read_b32 v157, a61
v_accvgpr_read_b32 v158, a62
v_mfma_f32_16x16x32_bf16 a[96:99], v[160:163], v[220:223], a[96:99]
v_accvgpr_read_b32 v159, a63
v_cvt_pk_bf16_f32 v118, v156, v157
v_cvt_pk_bf16_f32 v119, v158, v159
v_mfma_f32_16x16x32_bf16 a[100:103], v[40:43], v[216:219], a[100:103]
buffer_store_dwordx4 v[116:119], v243, s[20:23], s43 offen offset:1024 sc1
v_accvgpr_read_b32 v128, a64
v_mfma_f32_16x16x32_bf16 a[100:103], v[164:167], v[220:223], a[100:103]
v_accvgpr_read_b32 v129, a65
v_accvgpr_read_b32 v130, a66
v_mfma_f32_16x16x32_bf16 a[104:107], v[72:75], v[216:219], a[104:107]
v_accvgpr_read_b32 v131, a67
v_cvt_pk_bf16_f32 v24, v128, v129
v_mfma_f32_16x16x32_bf16 a[104:107], v[168:171], v[220:223], a[104:107]
v_cvt_pk_bf16_f32 v25, v130, v131
v_accvgpr_read_b32 v136, a68
v_mfma_f32_16x16x32_bf16 a[108:111], v[104:107], v[216:219], a[108:111]
ds_read_b64_tr_b16 v[216:217], v247 offset:20992
ds_read_b64_tr_b16 v[218:219], v247 offset:23040
v_mfma_f32_16x16x32_bf16 a[108:111], v[172:175], v[220:223], a[108:111]
ds_read_b64_tr_b16 v[220:221], v13 offset:4608
s_waitcnt lgkmcnt(3)
v_mfma_f32_16x16x32_bf16 a[96:99], v[176:179], v[208:211], a[96:99]
ds_read_b64_tr_b16 v[222:223], v13 offset:6656
v_accvgpr_read_b32 v137, a69
v_mfma_f32_16x16x32_bf16 a[96:99], v[0:3], v[212:215], a[96:99]
v_accvgpr_read_b32 v138, a70
v_accvgpr_read_b32 v139, a71
v_mfma_f32_16x16x32_bf16 a[100:103], v[180:183], v[208:211], a[100:103]
v_cvt_pk_bf16_f32 v56, v136, v137
v_cvt_pk_bf16_f32 v57, v138, v139
v_mfma_f32_16x16x32_bf16 a[100:103], v[32:35], v[212:215], a[100:103]
v_accvgpr_read_b32 v144, a72
v_accvgpr_read_b32 v145, a73
v_mfma_f32_16x16x32_bf16 a[104:107], v[184:187], v[208:211], a[104:107]
v_accvgpr_read_b32 v146, a74
v_accvgpr_read_b32 v147, a75
v_mfma_f32_16x16x32_bf16 a[104:107], v[64:67], v[212:215], a[104:107]
v_cvt_pk_bf16_f32 v88, v144, v145
v_cvt_pk_bf16_f32 v89, v146, v147
v_mfma_f32_16x16x32_bf16 a[108:111], v[188:191], v[208:211], a[108:111]
ds_read_b64_tr_b16 v[208:209], v13 offset:20992
ds_read_b64_tr_b16 v[210:211], v13 offset:23040
v_mfma_f32_16x16x32_bf16 a[108:111], v[96:99], v[212:215], a[108:111]
ds_read_b64_tr_b16 v[212:213], v15 offset:4608
s_waitcnt lgkmcnt(3)
v_mfma_f32_16x16x32_bf16 a[112:115], v[8:11], v[216:219], a[112:115]
ds_read_b64_tr_b16 v[214:215], v15 offset:6656
v_accvgpr_read_b32 v152, a76
v_mfma_f32_16x16x32_bf16 a[112:115], v[160:163], v[220:223], a[112:115]
v_accvgpr_read_b32 v153, a77
v_accvgpr_read_b32 v154, a78
v_mfma_f32_16x16x32_bf16 a[116:119], v[40:43], v[216:219], a[116:119]
v_accvgpr_read_b32 v155, a79
v_cvt_pk_bf16_f32 v120, v152, v153
v_mfma_f32_16x16x32_bf16 a[116:119], v[164:167], v[220:223], a[116:119]
v_cvt_pk_bf16_f32 v121, v154, v155
v_accvgpr_read_b32 v132, a80
v_mfma_f32_16x16x32_bf16 a[120:123], v[72:75], v[216:219], a[120:123]
v_accvgpr_read_b32 v133, a81
v_accvgpr_read_b32 v134, a82
v_mfma_f32_16x16x32_bf16 a[120:123], v[168:171], v[220:223], a[120:123]
v_accvgpr_read_b32 v135, a83
v_cvt_pk_bf16_f32 v26, v132, v133
v_mfma_f32_16x16x32_bf16 a[124:127], v[104:107], v[216:219], a[124:127]
ds_read_b64_tr_b16 v[216:217], v246 offset:8192
ds_read_b64_tr_b16 v[218:219], v246 offset:10240
v_mfma_f32_16x16x32_bf16 a[124:127], v[172:175], v[220:223], a[124:127]
ds_read_b64_tr_b16 v[220:221], v246 offset:24576
s_waitcnt lgkmcnt(3)
v_mfma_f32_16x16x32_bf16 a[112:115], v[176:179], v[208:211], a[112:115]
ds_read_b64_tr_b16 v[222:223], v246 offset:26624
v_cvt_pk_bf16_f32 v27, v134, v135
v_mfma_f32_16x16x32_bf16 a[112:115], v[0:3], v[212:215], a[112:115]
buffer_store_dwordx4 v[24:27], v243, s[20:23], s40 offen offset:2048 sc1
ds_write_b128 v231, v[24:27] offset:2048
v_mfma_f32_16x16x32_bf16 a[116:119], v[180:183], v[208:211], a[116:119]
v_accvgpr_read_b32 v140, a84
v_accvgpr_read_b32 v141, a85
v_mfma_f32_16x16x32_bf16 a[116:119], v[32:35], v[212:215], a[116:119]
v_accvgpr_read_b32 v142, a86
v_accvgpr_read_b32 v143, a87
v_mfma_f32_16x16x32_bf16 a[120:123], v[184:187], v[208:211], a[120:123]
v_cvt_pk_bf16_f32 v58, v140, v141
v_cvt_pk_bf16_f32 v59, v142, v143
v_mfma_f32_16x16x32_bf16 a[120:123], v[64:67], v[212:215], a[120:123]
buffer_store_dwordx4 v[56:59], v243, s[20:23], s41 offen offset:2048 sc1
v_accvgpr_read_b32 v148, a88
v_mfma_f32_16x16x32_bf16 a[124:127], v[188:191], v[208:211], a[124:127]
ds_read_b64_tr_b16 v[208:209], v12 offset:8192
ds_read_b64_tr_b16 v[210:211], v12 offset:10240
v_mfma_f32_16x16x32_bf16 a[124:127], v[96:99], v[212:215], a[124:127]
ds_read_b64_tr_b16 v[212:213], v12 offset:24576
s_waitcnt lgkmcnt(3)
v_mfma_f32_16x16x32_bf16 a[128:131], v[4:7], v[216:219], a[128:131]
ds_read_b64_tr_b16 v[214:215], v12 offset:26624
v_accvgpr_read_b32 v149, a89
v_mfma_f32_16x16x32_bf16 a[128:131], v[8:11], v[220:223], a[128:131]
v_accvgpr_read_b32 v150, a90
v_accvgpr_read_b32 v151, a91
v_mfma_f32_16x16x32_bf16 a[132:135], v[36:39], v[216:219], a[132:135]
v_cvt_pk_bf16_f32 v90, v148, v149
v_cvt_pk_bf16_f32 v91, v150, v151
v_mfma_f32_16x16x32_bf16 a[132:135], v[40:43], v[220:223], a[132:135]
buffer_store_dwordx4 v[88:91], v243, s[20:23], s42 offen offset:2048 sc1
v_accvgpr_read_b32 v156, a92
v_mfma_f32_16x16x32_bf16 a[136:139], v[68:71], v[216:219], a[136:139]
v_accvgpr_read_b32 v157, a93
v_accvgpr_read_b32 v158, a94
v_mfma_f32_16x16x32_bf16 a[136:139], v[72:75], v[220:223], a[136:139]
v_accvgpr_read_b32 v159, a95
v_cvt_pk_bf16_f32 v122, v156, v157
v_mfma_f32_16x16x32_bf16 a[140:143], v[100:103], v[216:219], a[140:143]
ds_read_b64_tr_b16 v[216:217], v14 offset:8192
ds_read_b64_tr_b16 v[218:219], v14 offset:10240
v_mfma_f32_16x16x32_bf16 a[140:143], v[104:107], v[220:223], a[140:143]
ds_read_b64_tr_b16 v[220:221], v247 offset:8192
s_waitcnt lgkmcnt(3)
v_mfma_f32_16x16x32_bf16 a[128:131], v[160:163], v[208:211], a[128:131]
ds_read_b64_tr_b16 v[222:223], v247 offset:10240
v_cvt_pk_bf16_f32 v123, v158, v159
v_mfma_f32_16x16x32_bf16 a[128:131], v[176:179], v[212:215], a[128:131]
buffer_store_dwordx4 v[120:123], v243, s[20:23], s43 offen offset:2048 sc1
v_accvgpr_read_b32 v128, a96
v_mfma_f32_16x16x32_bf16 a[132:135], v[164:167], v[208:211], a[132:135]
v_accvgpr_read_b32 v129, a97
v_accvgpr_read_b32 v130, a98
v_mfma_f32_16x16x32_bf16 a[132:135], v[180:183], v[212:215], a[132:135]
v_accvgpr_read_b32 v131, a99
v_cvt_pk_bf16_f32 v28, v128, v129
v_mfma_f32_16x16x32_bf16 a[136:139], v[168:171], v[208:211], a[136:139]
v_cvt_pk_bf16_f32 v29, v130, v131
v_accvgpr_read_b32 v136, a100
v_mfma_f32_16x16x32_bf16 a[136:139], v[184:187], v[212:215], a[136:139]
v_accvgpr_read_b32 v137, a101
v_accvgpr_read_b32 v138, a102
v_mfma_f32_16x16x32_bf16 a[140:143], v[172:175], v[208:211], a[140:143]
ds_read_b64_tr_b16 v[208:209], v247 offset:24576
ds_read_b64_tr_b16 v[210:211], v247 offset:26624
v_mfma_f32_16x16x32_bf16 a[140:143], v[188:191], v[212:215], a[140:143]
ds_read_b64_tr_b16 v[212:213], v13 offset:8192
s_waitcnt lgkmcnt(5)
v_mfma_f32_16x16x32_bf16 a[128:131], v[0:3], v[216:219], a[128:131]
ds_read_b64_tr_b16 v[214:215], v13 offset:10240
v_accvgpr_read_b32 v139, a103
v_mfma_f32_16x16x32_bf16 a[132:135], v[32:35], v[216:219], a[132:135]
v_cvt_pk_bf16_f32 v60, v136, v137
v_cvt_pk_bf16_f32 v61, v138, v139
v_mfma_f32_16x16x32_bf16 a[136:139], v[64:67], v[216:219], a[136:139]
v_accvgpr_read_b32 v144, a104
v_accvgpr_read_b32 v145, a105
v_mfma_f32_16x16x32_bf16 a[140:143], v[96:99], v[216:219], a[140:143]
ds_read_b64_tr_b16 v[216:217], v13 offset:24576
s_waitcnt lgkmcnt(5)
v_mfma_f32_16x16x32_bf16 a[144:147], v[4:7], v[220:223], a[144:147]
ds_read_b64_tr_b16 v[218:219], v13 offset:26624
v_accvgpr_read_b32 v146, a106
v_mfma_f32_16x16x32_bf16 a[148:151], v[36:39], v[220:223], a[148:151]
v_accvgpr_read_b32 v147, a107
v_cvt_pk_bf16_f32 v92, v144, v145
v_mfma_f32_16x16x32_bf16 a[152:155], v[68:71], v[220:223], a[152:155]
v_cvt_pk_bf16_f32 v93, v146, v147
v_accvgpr_read_b32 v152, a108
v_mfma_f32_16x16x32_bf16 a[156:159], v[100:103], v[220:223], a[156:159]
ds_read_b64_tr_b16 v[220:221], v15 offset:8192
s_waitcnt lgkmcnt(3)
v_mfma_f32_16x16x32_bf16 a[144:147], v[8:11], v[208:211], a[144:147]
ds_read_b64_tr_b16 v[222:223], v15 offset:10240
v_accvgpr_read_b32 v153, a109
v_mfma_f32_16x16x32_bf16 a[144:147], v[160:163], v[212:215], a[144:147]
v_accvgpr_read_b32 v154, a110
v_accvgpr_read_b32 v155, a111
v_mfma_f32_16x16x32_bf16 a[148:151], v[40:43], v[208:211], a[148:151]
v_cvt_pk_bf16_f32 v124, v152, v153
v_cvt_pk_bf16_f32 v125, v154, v155
v_mfma_f32_16x16x32_bf16 a[148:151], v[164:167], v[212:215], a[148:151]
v_accvgpr_read_b32 v132, a112
v_accvgpr_read_b32 v133, a113
v_mfma_f32_16x16x32_bf16 a[152:155], v[72:75], v[208:211], a[152:155]
v_accvgpr_read_b32 v134, a114
v_accvgpr_read_b32 v135, a115
v_mfma_f32_16x16x32_bf16 a[152:155], v[168:171], v[212:215], a[152:155]
v_cvt_pk_bf16_f32 v30, v132, v133
v_cvt_pk_bf16_f32 v31, v134, v135
v_mfma_f32_16x16x32_bf16 a[156:159], v[104:107], v[208:211], a[156:159]
ds_read_b64_tr_b16 v[208:209], v246 offset:8704
ds_read_b64_tr_b16 v[210:211], v246 offset:10752
v_mfma_f32_16x16x32_bf16 a[156:159], v[172:175], v[212:215], a[156:159]
ds_read_b64_tr_b16 v[212:213], v246 offset:25088
s_waitcnt lgkmcnt(3)
v_mfma_f32_16x16x32_bf16 a[144:147], v[176:179], v[216:219], a[144:147]
ds_read_b64_tr_b16 v[214:215], v246 offset:27136
buffer_store_dwordx4 v[28:31], v243, s[20:23], s40 offen offset:3072 sc1
v_mfma_f32_16x16x32_bf16 a[144:147], v[0:3], v[220:223], a[144:147]
ds_write_b128 v231, v[28:31] offset:3072
v_accvgpr_read_b32 v140, a116
v_mfma_f32_16x16x32_bf16 a[148:151], v[180:183], v[216:219], a[148:151]
v_accvgpr_read_b32 v141, a117
v_accvgpr_read_b32 v142, a118
v_mfma_f32_16x16x32_bf16 a[148:151], v[32:35], v[220:223], a[148:151]
v_accvgpr_read_b32 v143, a119
v_cvt_pk_bf16_f32 v62, v140, v141
v_mfma_f32_16x16x32_bf16 a[152:155], v[184:187], v[216:219], a[152:155]
v_cvt_pk_bf16_f32 v63, v142, v143
buffer_store_dwordx4 v[60:63], v243, s[20:23], s41 offen offset:3072 sc1
v_mfma_f32_16x16x32_bf16 a[152:155], v[64:67], v[220:223], a[152:155]
v_accvgpr_read_b32 v148, a120
v_accvgpr_read_b32 v149, a121
v_mfma_f32_16x16x32_bf16 a[156:159], v[188:191], v[216:219], a[156:159]
ds_read_b64_tr_b16 v[216:217], v12 offset:8704
ds_read_b64_tr_b16 v[218:219], v12 offset:10752
v_mfma_f32_16x16x32_bf16 a[156:159], v[96:99], v[220:223], a[156:159]
ds_read_b64_tr_b16 v[220:221], v12 offset:25088
s_waitcnt lgkmcnt(3)
v_mfma_f32_16x16x32_bf16 a[160:163], v[4:7], v[208:211], a[160:163]
ds_read_b64_tr_b16 v[222:223], v12 offset:27136
v_accvgpr_read_b32 v150, a122
v_mfma_f32_16x16x32_bf16 a[160:163], v[8:11], v[212:215], a[160:163]
v_accvgpr_read_b32 v151, a123
v_cvt_pk_bf16_f32 v94, v148, v149
v_mfma_f32_16x16x32_bf16 a[164:167], v[36:39], v[208:211], a[164:167]
v_cvt_pk_bf16_f32 v95, v150, v151
buffer_store_dwordx4 v[92:95], v243, s[20:23], s42 offen offset:3072 sc1
v_mfma_f32_16x16x32_bf16 a[164:167], v[40:43], v[212:215], a[164:167]
v_accvgpr_read_b32 v156, a124
v_accvgpr_read_b32 v157, a125
v_mfma_f32_16x16x32_bf16 a[168:171], v[68:71], v[208:211], a[168:171]
v_accvgpr_read_b32 v158, a126
v_accvgpr_read_b32 v159, a127
v_mfma_f32_16x16x32_bf16 a[168:171], v[72:75], v[212:215], a[168:171]
v_cvt_pk_bf16_f32 v126, v156, v157
v_cvt_pk_bf16_f32 v127, v158, v159
v_mfma_f32_16x16x32_bf16 a[172:175], v[100:103], v[208:211], a[172:175]
ds_read_b64_tr_b16 v[208:209], v14 offset:8704
ds_read_b64_tr_b16 v[210:211], v14 offset:10752
v_mfma_f32_16x16x32_bf16 a[172:175], v[104:107], v[212:215], a[172:175]
ds_read_b64_tr_b16 v[212:213], v247 offset:8704
s_waitcnt lgkmcnt(3)
v_mfma_f32_16x16x32_bf16 a[160:163], v[160:163], v[216:219], a[160:163]
ds_read_b64_tr_b16 v[214:215], v247 offset:10752
buffer_store_dwordx4 v[124:127], v243, s[20:23], s43 offen offset:3072 sc1
v_mfma_f32_16x16x32_bf16 a[160:163], v[176:179], v[220:223], a[160:163]
v_accvgpr_read_b32 v128, a128
v_accvgpr_read_b32 v129, a129
v_mfma_f32_16x16x32_bf16 a[164:167], v[164:167], v[216:219], a[164:167]
v_accvgpr_read_b32 v130, a130
v_accvgpr_read_b32 v131, a131
v_mfma_f32_16x16x32_bf16 a[164:167], v[180:183], v[220:223], a[164:167]
v_cvt_pk_bf16_f32 v16, v128, v129
v_cvt_pk_bf16_f32 v17, v130, v131
v_mfma_f32_16x16x32_bf16 a[168:171], v[168:171], v[216:219], a[168:171]
v_accvgpr_read_b32 v136, a132
v_accvgpr_read_b32 v137, a133
v_mfma_f32_16x16x32_bf16 a[168:171], v[184:187], v[220:223], a[168:171]
v_accvgpr_read_b32 v138, a134
v_accvgpr_read_b32 v139, a135
v_mfma_f32_16x16x32_bf16 a[172:175], v[172:175], v[216:219], a[172:175]
ds_read_b64_tr_b16 v[216:217], v247 offset:25088
ds_read_b64_tr_b16 v[218:219], v247 offset:27136
v_mfma_f32_16x16x32_bf16 a[172:175], v[188:191], v[220:223], a[172:175]
ds_read_b64_tr_b16 v[220:221], v13 offset:8704
s_waitcnt lgkmcnt(5)
v_mfma_f32_16x16x32_bf16 a[160:163], v[0:3], v[208:211], a[160:163]
ds_read_b64_tr_b16 v[222:223], v13 offset:10752
v_cvt_pk_bf16_f32 v48, v136, v137
v_mfma_f32_16x16x32_bf16 a[164:167], v[32:35], v[208:211], a[164:167]
v_cvt_pk_bf16_f32 v49, v138, v139
v_accvgpr_read_b32 v144, a136
v_mfma_f32_16x16x32_bf16 a[168:171], v[64:67], v[208:211], a[168:171]
v_accvgpr_read_b32 v145, a137
v_accvgpr_read_b32 v146, a138
v_mfma_f32_16x16x32_bf16 a[172:175], v[96:99], v[208:211], a[172:175]
ds_read_b64_tr_b16 v[208:209], v13 offset:25088
s_waitcnt lgkmcnt(5)
v_mfma_f32_16x16x32_bf16 a[176:179], v[4:7], v[212:215], a[176:179]
ds_read_b64_tr_b16 v[210:211], v13 offset:27136
v_accvgpr_read_b32 v147, a139
v_mfma_f32_16x16x32_bf16 a[180:183], v[36:39], v[212:215], a[180:183]
v_cvt_pk_bf16_f32 v80, v144, v145
v_cvt_pk_bf16_f32 v81, v146, v147
v_mfma_f32_16x16x32_bf16 a[184:187], v[68:71], v[212:215], a[184:187]
v_accvgpr_read_b32 v152, a140
v_accvgpr_read_b32 v153, a141
v_mfma_f32_16x16x32_bf16 a[188:191], v[100:103], v[212:215], a[188:191]
ds_read_b64_tr_b16 v[212:213], v15 offset:8704
s_waitcnt lgkmcnt(3)
v_mfma_f32_16x16x32_bf16 a[176:179], v[8:11], v[216:219], a[176:179]
ds_read_b64_tr_b16 v[214:215], v15 offset:10752
v_accvgpr_read_b32 v154, a142
v_mfma_f32_16x16x32_bf16 a[176:179], v[160:163], v[220:223], a[176:179]
v_accvgpr_read_b32 v155, a143
v_cvt_pk_bf16_f32 v112, v152, v153
v_mfma_f32_16x16x32_bf16 a[180:183], v[40:43], v[216:219], a[180:183]
v_cvt_pk_bf16_f32 v113, v154, v155
v_accvgpr_read_b32 v132, a144
v_mfma_f32_16x16x32_bf16 a[180:183], v[164:167], v[220:223], a[180:183]
v_accvgpr_read_b32 v133, a145
v_accvgpr_read_b32 v134, a146
v_mfma_f32_16x16x32_bf16 a[184:187], v[72:75], v[216:219], a[184:187]
v_accvgpr_read_b32 v135, a147
v_cvt_pk_bf16_f32 v18, v132, v133
v_mfma_f32_16x16x32_bf16 a[184:187], v[168:171], v[220:223], a[184:187]
v_cvt_pk_bf16_f32 v19, v134, v135
buffer_store_dwordx4 v[16:19], v243, s[20:23], s44 offen offset:0 sc1
v_mfma_f32_16x16x32_bf16 a[188:191], v[104:107], v[216:219], a[188:191]
ds_read_b64_tr_b16 v[216:217], v246 offset:12288
ds_read_b64_tr_b16 v[218:219], v246 offset:14336
v_mfma_f32_16x16x32_bf16 a[188:191], v[172:175], v[220:223], a[188:191]
ds_read_b64_tr_b16 v[220:221], v246 offset:28672
s_waitcnt lgkmcnt(3)
v_mfma_f32_16x16x32_bf16 a[176:179], v[176:179], v[208:211], a[176:179]
ds_read_b64_tr_b16 v[222:223], v246 offset:30720
ds_write_b128 v231, v[16:19] offset:4096
v_mfma_f32_16x16x32_bf16 a[176:179], v[0:3], v[212:215], a[176:179]
v_accvgpr_read_b32 v140, a148
v_accvgpr_read_b32 v141, a149
v_mfma_f32_16x16x32_bf16 a[180:183], v[180:183], v[208:211], a[180:183]
v_accvgpr_read_b32 v142, a150
v_accvgpr_read_b32 v143, a151
v_mfma_f32_16x16x32_bf16 a[180:183], v[32:35], v[212:215], a[180:183]
v_cvt_pk_bf16_f32 v50, v140, v141
v_cvt_pk_bf16_f32 v51, v142, v143
v_mfma_f32_16x16x32_bf16 a[184:187], v[184:187], v[208:211], a[184:187]
buffer_store_dwordx4 v[48:51], v243, s[20:23], s45 offen offset:0 sc1
v_accvgpr_read_b32 v148, a152
v_mfma_f32_16x16x32_bf16 a[184:187], v[64:67], v[212:215], a[184:187]
v_accvgpr_read_b32 v149, a153
v_accvgpr_read_b32 v150, a154
v_mfma_f32_16x16x32_bf16 a[188:191], v[188:191], v[208:211], a[188:191]
ds_read_b64_tr_b16 v[208:209], v12 offset:12288
ds_read_b64_tr_b16 v[210:211], v12 offset:14336
v_mfma_f32_16x16x32_bf16 a[188:191], v[96:99], v[212:215], a[188:191]
ds_read_b64_tr_b16 v[212:213], v12 offset:28672
s_waitcnt lgkmcnt(3)
v_mfma_f32_16x16x32_bf16 a[192:195], v[4:7], v[216:219], a[192:195]
ds_read_b64_tr_b16 v[214:215], v12 offset:30720
v_accvgpr_read_b32 v151, a155
v_mfma_f32_16x16x32_bf16 a[192:195], v[8:11], v[220:223], a[192:195]
v_cvt_pk_bf16_f32 v82, v148, v149
v_cvt_pk_bf16_f32 v83, v150, v151
v_mfma_f32_16x16x32_bf16 a[196:199], v[36:39], v[216:219], a[196:199]
buffer_store_dwordx4 v[80:83], v243, s[20:23], s46 offen offset:0 sc1
v_accvgpr_read_b32 v156, a156
v_mfma_f32_16x16x32_bf16 a[196:199], v[40:43], v[220:223], a[196:199]
v_accvgpr_read_b32 v157, a157
v_accvgpr_read_b32 v158, a158
v_mfma_f32_16x16x32_bf16 a[200:203], v[68:71], v[216:219], a[200:203]
v_accvgpr_read_b32 v159, a159
v_cvt_pk_bf16_f32 v114, v156, v157
v_mfma_f32_16x16x32_bf16 a[200:203], v[72:75], v[220:223], a[200:203]
v_cvt_pk_bf16_f32 v115, v158, v159
buffer_store_dwordx4 v[112:115], v243, s[20:23], s47 offen offset:0 sc1
v_mfma_f32_16x16x32_bf16 a[204:207], v[100:103], v[216:219], a[204:207]
ds_read_b64_tr_b16 v[216:217], v14 offset:12288
ds_read_b64_tr_b16 v[218:219], v14 offset:14336
v_mfma_f32_16x16x32_bf16 a[204:207], v[104:107], v[220:223], a[204:207]
ds_read_b64_tr_b16 v[220:221], v247 offset:12288
s_waitcnt lgkmcnt(3)
v_mfma_f32_16x16x32_bf16 a[192:195], v[160:163], v[208:211], a[192:195]
ds_read_b64_tr_b16 v[222:223], v247 offset:14336
v_accvgpr_read_b32 v128, a160
v_mfma_f32_16x16x32_bf16 a[192:195], v[176:179], v[212:215], a[192:195]
v_accvgpr_read_b32 v129, a161
v_accvgpr_read_b32 v130, a162
v_mfma_f32_16x16x32_bf16 a[196:199], v[164:167], v[208:211], a[196:199]
v_accvgpr_read_b32 v131, a163
v_cvt_pk_bf16_f32 v20, v128, v129
v_mfma_f32_16x16x32_bf16 a[196:199], v[180:183], v[212:215], a[196:199]
v_cvt_pk_bf16_f32 v21, v130, v131
v_accvgpr_read_b32 v136, a164
v_mfma_f32_16x16x32_bf16 a[200:203], v[168:171], v[208:211], a[200:203]
v_accvgpr_read_b32 v137, a165
v_accvgpr_read_b32 v138, a166
v_mfma_f32_16x16x32_bf16 a[200:203], v[184:187], v[212:215], a[200:203]
v_accvgpr_read_b32 v139, a167
v_cvt_pk_bf16_f32 v52, v136, v137
v_mfma_f32_16x16x32_bf16 a[204:207], v[172:175], v[208:211], a[204:207]
ds_read_b64_tr_b16 v[208:209], v247 offset:28672
ds_read_b64_tr_b16 v[210:211], v247 offset:30720
v_mfma_f32_16x16x32_bf16 a[204:207], v[188:191], v[212:215], a[204:207]
ds_read_b64_tr_b16 v[212:213], v13 offset:12288
s_waitcnt lgkmcnt(5)
v_mfma_f32_16x16x32_bf16 a[192:195], v[0:3], v[216:219], a[192:195]
ds_read_b64_tr_b16 v[214:215], v13 offset:14336
v_cvt_pk_bf16_f32 v53, v138, v139
v_mfma_f32_16x16x32_bf16 a[196:199], v[32:35], v[216:219], a[196:199]
v_accvgpr_read_b32 v144, a168
v_accvgpr_read_b32 v145, a169
v_mfma_f32_16x16x32_bf16 a[200:203], v[64:67], v[216:219], a[200:203]
v_accvgpr_read_b32 v146, a170
v_accvgpr_read_b32 v147, a171
v_mfma_f32_16x16x32_bf16 a[204:207], v[96:99], v[216:219], a[204:207]
ds_read_b64_tr_b16 v[216:217], v13 offset:28672
s_waitcnt lgkmcnt(5)
v_mfma_f32_16x16x32_bf16 a[208:211], v[4:7], v[220:223], a[208:211]
ds_read_b64_tr_b16 v[218:219], v13 offset:30720
v_cvt_pk_bf16_f32 v84, v144, v145
v_mfma_f32_16x16x32_bf16 a[212:215], v[36:39], v[220:223], a[212:215]
v_cvt_pk_bf16_f32 v85, v146, v147
v_accvgpr_read_b32 v152, a172
v_mfma_f32_16x16x32_bf16 a[216:219], v[68:71], v[220:223], a[216:219]
v_accvgpr_read_b32 v153, a173
v_accvgpr_read_b32 v154, a174
v_mfma_f32_16x16x32_bf16 a[220:223], v[100:103], v[220:223], a[220:223]
ds_read_b64_tr_b16 v[220:221], v15 offset:12288
s_waitcnt lgkmcnt(3)
v_mfma_f32_16x16x32_bf16 a[208:211], v[8:11], v[208:211], a[208:211]
ds_read_b64_tr_b16 v[222:223], v15 offset:14336
v_accvgpr_read_b32 v155, a175
v_mfma_f32_16x16x32_bf16 a[208:211], v[160:163], v[212:215], a[208:211]
v_cvt_pk_bf16_f32 v116, v152, v153
v_cvt_pk_bf16_f32 v117, v154, v155
v_mfma_f32_16x16x32_bf16 a[212:215], v[40:43], v[208:211], a[212:215]
v_accvgpr_read_b32 v132, a176
v_accvgpr_read_b32 v133, a177
v_mfma_f32_16x16x32_bf16 a[212:215], v[164:167], v[212:215], a[212:215]
v_accvgpr_read_b32 v134, a178
v_accvgpr_read_b32 v135, a179
v_mfma_f32_16x16x32_bf16 a[216:219], v[72:75], v[208:211], a[216:219]
v_cvt_pk_bf16_f32 v22, v132, v133
v_cvt_pk_bf16_f32 v23, v134, v135
v_mfma_f32_16x16x32_bf16 a[216:219], v[168:171], v[212:215], a[216:219]
buffer_store_dwordx4 v[20:23], v243, s[20:23], s44 offen offset:1024 sc1
ds_write_b128 v231, v[20:23] offset:5120
v_mfma_f32_16x16x32_bf16 a[220:223], v[104:107], v[208:211], a[220:223]
v_accvgpr_read_b32 v140, a180
v_accvgpr_read_b32 v141, a181
v_mfma_f32_16x16x32_bf16 a[220:223], v[172:175], v[212:215], a[220:223]
s_waitcnt lgkmcnt(0)
v_accvgpr_read_b32 v142, a182
v_mfma_f32_16x16x32_bf16 a[208:211], v[176:179], v[216:219], a[208:211]
v_accvgpr_read_b32 v143, a183
v_cvt_pk_bf16_f32 v54, v140, v141
v_mfma_f32_16x16x32_bf16 a[208:211], v[0:3], v[220:223], a[208:211]
v_cvt_pk_bf16_f32 v55, v142, v143
buffer_store_dwordx4 v[52:55], v243, s[20:23], s45 offen offset:1024 sc1
v_mfma_f32_16x16x32_bf16 a[212:215], v[180:183], v[216:219], a[212:215]
v_accvgpr_read_b32 v148, a184
v_accvgpr_read_b32 v149, a185
v_mfma_f32_16x16x32_bf16 a[212:215], v[32:35], v[220:223], a[212:215]
v_accvgpr_read_b32 v150, a186
v_accvgpr_read_b32 v151, a187
v_mfma_f32_16x16x32_bf16 a[216:219], v[184:187], v[216:219], a[216:219]
v_cvt_pk_bf16_f32 v86, v148, v149
v_cvt_pk_bf16_f32 v87, v150, v151
v_mfma_f32_16x16x32_bf16 a[216:219], v[64:67], v[220:223], a[216:219]
buffer_store_dwordx4 v[84:87], v243, s[20:23], s46 offen offset:1024 sc1
v_accvgpr_read_b32 v156, a188
v_mfma_f32_16x16x32_bf16 a[220:223], v[188:191], v[216:219], a[220:223]
v_accvgpr_read_b32 v157, a189
v_accvgpr_read_b32 v158, a190
v_mfma_f32_16x16x32_bf16 a[220:223], v[96:99], v[220:223], a[220:223]
v_accvgpr_read_b32 v159, a191
v_cvt_pk_bf16_f32 v118, v156, v157
v_cvt_pk_bf16_f32 v119, v158, v159
buffer_store_dwordx4 v[116:119], v243, s[20:23], s47 offen offset:1024 sc1
v_accvgpr_read_b32 v128, a192
v_accvgpr_read_b32 v129, a193
v_accvgpr_read_b32 v130, a194
v_accvgpr_read_b32 v131, a195
v_cvt_pk_bf16_f32 v24, v128, v129
v_cvt_pk_bf16_f32 v25, v130, v131
v_accvgpr_read_b32 v136, a196
v_accvgpr_read_b32 v137, a197
v_accvgpr_read_b32 v138, a198
v_accvgpr_read_b32 v139, a199
v_cvt_pk_bf16_f32 v56, v136, v137
v_cvt_pk_bf16_f32 v57, v138, v139
v_accvgpr_read_b32 v144, a200
v_accvgpr_read_b32 v145, a201
v_accvgpr_read_b32 v146, a202
v_accvgpr_read_b32 v147, a203
v_cvt_pk_bf16_f32 v88, v144, v145
v_cvt_pk_bf16_f32 v89, v146, v147
v_accvgpr_read_b32 v152, a204
v_accvgpr_read_b32 v153, a205
v_accvgpr_read_b32 v154, a206
v_accvgpr_read_b32 v155, a207
v_cvt_pk_bf16_f32 v120, v152, v153
v_cvt_pk_bf16_f32 v121, v154, v155
v_accvgpr_read_b32 v132, a208
v_accvgpr_read_b32 v133, a209
v_accvgpr_read_b32 v134, a210
v_accvgpr_read_b32 v135, a211
v_cvt_pk_bf16_f32 v26, v132, v133
v_cvt_pk_bf16_f32 v27, v134, v135
buffer_store_dwordx4 v[24:27], v243, s[20:23], s44 offen offset:2048 sc1
ds_write_b128 v231, v[24:27] offset:6144
v_accvgpr_read_b32 v140, a212
v_accvgpr_read_b32 v141, a213
v_accvgpr_read_b32 v142, a214
v_accvgpr_read_b32 v143, a215
v_cvt_pk_bf16_f32 v58, v140, v141
v_cvt_pk_bf16_f32 v59, v142, v143
buffer_store_dwordx4 v[56:59], v243, s[20:23], s45 offen offset:2048 sc1
v_accvgpr_read_b32 v148, a216
v_accvgpr_read_b32 v149, a217
v_accvgpr_read_b32 v150, a218
v_accvgpr_read_b32 v151, a219
v_cvt_pk_bf16_f32 v90, v148, v149
v_cvt_pk_bf16_f32 v91, v150, v151
buffer_store_dwordx4 v[88:91], v243, s[20:23], s46 offen offset:2048 sc1
v_accvgpr_read_b32 v156, a220
v_accvgpr_read_b32 v157, a221
v_accvgpr_read_b32 v158, a222
v_accvgpr_read_b32 v159, a223
v_cvt_pk_bf16_f32 v122, v156, v157
v_cvt_pk_bf16_f32 v123, v158, v159
buffer_store_dwordx4 v[120:123], v243, s[20:23], s47 offen offset:2048 sc1
s_waitcnt vmcnt(36)
s_branch L2_F
L2_F:
v_cmp_ne_u64 vcc, s[98:99], v[108:109]
s_lshl_b32 s3, s34, 15
s_add_u32 s3, s3, 0x1000000
s_cbranch_vccnz LF_wf
LF_wf_go:
v_add_u32 v240, s3, v243
v_add_u32 v241, 0x4000, v240
s_mov_b32 s32, 0x0
s_mov_b32 s33, 0x1000
s_mov_b32 s35, 0x2000
s_mov_b32 s36, 0x3000
s_mov_b32 s38, 0x20000
s_mov_b32 s39, 0x21000
s_mov_b32 s40, 0x22000
s_mov_b32 s41, 0x23000
s_lshr_b32 s42, s6, 13
s_lshr_b32 s43, s7, 13
s_lshr_b32 s44, s29, 13
v_mov_b32 v244, s42
v_mov_b32 v232, s43
v_cmp_lt_u32 vcc, 0xff, v243
v_mov_b32 v233, s44
s_nop 0
v_cndmask_b32 v244, v244, v232, vcc
v_cmp_lt_u32 vcc, 0x1ff, v243
v_and_b32 v235, 0xf0, v243
s_nop 0
v_cndmask_b32 v244, v244, v233, vcc
v_lshrrev_b32 v232, 3, v235
v_lshl_add_u32 v79, v244, 5, v232
buffer_load_ushort v79, v79, s[52:55], 0 offen
buffer_load_dwordx4 a[0:3], v240, s[16:19], s32 offen offset:0 sc1
buffer_load_dwordx4 a[4:7], v240, s[16:19], s32 offen offset:1024 sc1
buffer_load_dwordx4 a[8:11], v241, s[16:19], s32 offen offset:0 sc1
buffer_load_dwordx4 a[12:15], v241, s[16:19], s32 offen offset:1024 sc1
buffer_load_dwordx4 a[16:19], v240, s[16:19], s32 offen offset:2048 sc1
buffer_load_dwordx4 a[20:23], v240, s[16:19], s32 offen offset:3072 sc1
buffer_load_dwordx4 a[24:27], v241, s[16:19], s32 offen offset:2048 sc1
buffer_load_dwordx4 a[28:31], v241, s[16:19], s32 offen offset:3072 sc1
buffer_load_dwordx4 a[32:35], v240, s[16:19], s33 offen offset:0 sc1
buffer_load_dwordx4 a[36:39], v240, s[16:19], s33 offen offset:1024 sc1
buffer_load_dwordx4 a[40:43], v241, s[16:19], s33 offen offset:0 sc1
buffer_load_dwordx4 a[44:47], v241, s[16:19], s33 offen offset:1024 sc1
s_lshl_b32 s3, s37, 7
v_lshl_add_u32 v244, v244, 11, s3
v_lshl_add_u32 v244, v232, 2, v244
s_cmp_ge_u32 s29, 0x70000000
s_cselect_b32 s44, s43, s44
v_mov_b32 v46, s42
v_mov_b32 v232, s43
v_lshrrev_b32 v233, 7, v243
v_cmp_lt_u32_e64 vcc, 0, v233
s_nop 1
v_cndmask_b32_e64 v46, v46, v232, vcc
v_cmp_lt_u32_e64 vcc, 1, v233
v_mov_b32 v233, s44
v_bfe_u32 v232, v243, 4, 3
v_cndmask_b32_e64 v46, v46, v233, vcc
v_min_u32 v232, 5, v232
v_lshrrev_b32 v46, 2, v46
v_lshl_add_u32 v46, v46, 3, v232
v_lshlrev_b32 v46, 7, v46
v_add_u32 v46, 0x7c00000, v46
s_lshl_b32 s49, s34, 10
s_add_u32 s49, s49, 0x20000
s_bfe_u32 s3, s6, 0x2000f
s_lshl_b32 s3, s3, 13
s_add_u32 s3, s3, s49
v_add_u32 v76, s3, v243
s_bfe_u32 s3, s7, 0x2000f
s_lshl_b32 s3, s3, 13
s_add_u32 s3, s3, s49
v_add_u32 v77, s3, v243
s_bfe_u32 s3, s29, 0x2000f
s_lshl_b32 s3, s3, 13
s_add_u32 s3, s3, s49
v_add_u32 v78, s3, v243
s_add_u32 s3, s37, 1
s_sub_u32 s49, s3, 6
s_cselect_b32 s3, s3, s49
s_mul_i32 s3, s3, 0x600000
s_add_u32 s42, s3, 0x2000000
s_add_u32 s3, s37, 2
s_sub_u32 s49, s3, 6
s_cselect_b32 s3, s3, s49
s_mul_i32 s3, s3, 0x600000
s_add_u32 s43, s3, 0x2000000
s_add_u32 s3, s37, 3
s_sub_u32 s49, s3, 6
s_cselect_b32 s3, s3, s49
s_mul_i32 s3, s3, 0x600000
s_add_u32 s44, s3, 0x2000000
s_add_u32 s3, s37, 4
s_sub_u32 s49, s3, 6
s_cselect_b32 s3, s3, s49
s_mul_i32 s3, s3, 0x600000
s_add_u32 s45, s3, 0x2000000
s_add_u32 s3, s37, 5
s_sub_u32 s49, s3, 6
s_cselect_b32 s3, s3, s49
s_mul_i32 s3, s3, 0x600000
s_add_u32 s46, s3, 0x2000000
s_add_u32 s3, s37, 6
s_sub_u32 s49, s3, 6
s_cselect_b32 s3, s3, s49
s_mul_i32 s3, s3, 0x600000
s_add_u32 s47, s3, 0x2000000
s_mul_i32 s3, s34, 896
v_add_u32 v47, s3, v243
v_add_u32 v43, 0x1000, v47
v_lshrrev_b32 v44, 4, v243
v_and_b32 v44, 0x30, v44
v_xor_b32 v44, v44, v243
v_and_b32 v232, 0x380, v243
v_mad_u32_u24 v44, v232, 3, v44
v_xor_b32 v45, 0x1040, v44
v_bfe_u32 v232, v243, 5, 3
v_lshrrev_b32 v234, 8, v243
v_xor_b32 v232, v232, v234
v_bfe_u32 v233, v243, 4, 3
v_lshlrev_b32 v233, 7, v233
v_lshl_or_b32 v232, v232, 4, v233
v_bfe_u32 v233, v243, 7, 1
s_lshl_b32 s49, s34, 10
s_sub_u32 s3, s28, s49
v_lshl_add_u32 v74, v233, 12, v232
v_add_u32 v72, s3, v74
s_sub_u32 s3, s30, s49
v_add_u32 v74, s3, v74
v_xor_b32 v73, 64, v72
v_xor_b32 v75, 64, v74
v_lshl_add_u32 v245, v233, 10, v232
v_add_u32 v245, s31, v245
v_xor_b32 v246, 64, v245
v_add_u32 v247, s31, v243
s_add_u32 s3, s3, 0xa000
s_and_b32 s3, s3, 0x1ffff
v_add_u32 v252, s3, v243
v_add_u32 v251, s49, v252
s_lshl_b32 s49, s34, 11
s_add_u32 s3, s3, s49
s_add_u32 s3, s3, 24576
v_lshl_add_u32 v242, v243, 1, s3
v_lshl_add_u32 v250, v235, 1, s3
v_lshrrev_b32 v232, 4, v235
v_lshlrev_b32 v234, 2, v234
v_sub_u32 v232, v232, v234
v_and_b32 v233, 1, v232
v_lshlrev_b32 v233, 4, v233
v_mov_b32 v234, 0xffff
v_lshlrev_b32 v233, v233, v234
v_lshrrev_b32 v232, 1, v232
v_cmp_eq_u32 vcc, 0, v232
s_nop 1
v_cndmask_b32 v156, 0, v233, vcc
v_cmp_eq_u32 vcc, 1, v232
s_nop 1
v_cndmask_b32 v157, 0, v233, vcc
s_mov_b32 s95, 0xffff0000
s_waitcnt vmcnt(13)
v_mov_b32 v158, s98
v_mov_b32 v159, s99
s_mov_b64 exec, 1
buffer_store_dwordx2 v[158:159], off, s[16:19], s51 sc1
s_mov_b64 exec, -1
s_waitcnt lgkmcnt(0)
s_barrier
ds_read_b128 v[208:211], v72 offset:0
ds_read_b128 v[212:215], v72 offset:8192
ds_read_b128 v[216:219], v74 offset:0
ds_read_b128 v[220:223], v73 offset:0
ds_read_b128 v[224:227], v73 offset:8192
ds_read_b128 v[104:107], v245 offset:0
ds_read_b128 v[108:111], v246 offset:0
ds_read_b128 v[152:155], v245 offset:2048
s_waitcnt vmcnt(13)
v_lshlrev_b32 v79, 16, v79
ds_write_b32 v242, v79 offset:28
ds_read_b32 v253, v250 offset:28
ds_read_b32 v254, v250 offset:540
ds_read_b32 v255, v250 offset:1052
s_waitcnt vmcnt(12)
buffer_load_dwordx4 a[48:51], v240, s[16:19], s33 offen offset:2048 sc1
s_waitcnt vmcnt(12)
buffer_load_dwordx4 a[52:55], v240, s[16:19], s33 offen offset:3072 sc1
s_waitcnt vmcnt(12)
buffer_load_dwordx4 a[56:59], v241, s[16:19], s33 offen offset:2048 sc1
s_waitcnt vmcnt(12)
s_waitcnt lgkmcnt(11)
v_mfma_f32_16x16x32_bf16 v[160:163], a[0:3], v[208:211], 0
ds_read_b128 v[228:231], v75 offset:0
buffer_load_dwordx4 a[60:63], v241, s[16:19], s33 offen offset:3072 sc1
v_mfma_f32_16x16x32_bf16 v[164:167], a[4:7], v[208:211], 0
v_mfma_f32_16x16x32_bf16 v[168:171], a[8:11], v[208:211], 0
v_mfma_f32_16x16x32_bf16 v[172:175], a[12:15], v[208:211], 0
s_waitcnt vmcnt(12)
s_waitcnt lgkmcnt(11)
v_mfma_f32_16x16x32_bf16 v[176:179], a[0:3], v[212:215], 0
ds_read_b128 v[208:211], v72 offset:1024
buffer_load_dwordx4 a[64:67], v240, s[16:19], s35 offen offset:0 sc1
v_mfma_f32_16x16x32_bf16 v[180:183], a[4:7], v[212:215], 0
v_mfma_f32_16x16x32_bf16 v[184:187], a[8:11], v[212:215], 0
v_mfma_f32_16x16x32_bf16 v[188:191], a[12:15], v[212:215], 0
s_waitcnt vmcnt(12)
s_waitcnt lgkmcnt(11)
v_mfma_f32_16x16x32_bf16 v[192:195], a[0:3], v[216:219], 0
ds_read_b128 v[212:215], v72 offset:9216
buffer_load_dwordx4 a[68:71], v240, s[16:19], s35 offen offset:1024 sc1
v_mfma_f32_16x16x32_bf16 v[196:199], a[4:7], v[216:219], 0
v_mfma_f32_16x16x32_bf16 v[200:203], a[8:11], v[216:219], 0
v_mfma_f32_16x16x32_bf16 v[204:207], a[12:15], v[216:219], 0
s_waitcnt vmcnt(12)
buffer_load_dwordx4 a[72:75], v241, s[16:19], s35 offen offset:0 sc1
s_waitcnt vmcnt(12)
s_waitcnt lgkmcnt(11)
v_mfma_f32_16x16x32_bf16 v[160:163], a[16:19], v[220:223], v[160:163]
ds_read_b128 v[216:219], v74 offset:1024
buffer_load_dwordx4 a[76:79], v241, s[16:19], s35 offen offset:1024 sc1
v_mfma_f32_16x16x32_bf16 v[164:167], a[20:23], v[220:223], v[164:167]
v_mfma_f32_16x16x32_bf16 v[168:171], a[24:27], v[220:223], v[168:171]
v_mfma_f32_16x16x32_bf16 v[172:175], a[28:31], v[220:223], v[172:175]
s_waitcnt vmcnt(12)
s_waitcnt lgkmcnt(11)
v_mfma_f32_16x16x32_bf16 v[176:179], a[16:19], v[224:227], v[176:179]
ds_read_b128 v[220:223], v73 offset:1024
buffer_load_dwordx4 a[80:83], v240, s[16:19], s35 offen offset:2048 sc1
v_mfma_f32_16x16x32_bf16 v[180:183], a[20:23], v[224:227], v[180:183]
v_mfma_f32_16x16x32_bf16 v[184:187], a[24:27], v[224:227], v[184:187]
v_mfma_f32_16x16x32_bf16 v[188:191], a[28:31], v[224:227], v[188:191]
s_waitcnt vmcnt(12)
s_waitcnt lgkmcnt(4)
v_mfma_f32_16x16x32_bf16 v[192:195], a[16:19], v[228:231], v[192:195]
ds_read_b128 v[224:227], v73 offset:9216
buffer_load_dwordx4 a[84:87], v240, s[16:19], s35 offen offset:3072 sc1
v_mfma_f32_16x16x32_bf16 v[196:199], a[20:23], v[228:231], v[196:199]
v_mfma_f32_16x16x32_bf16 v[200:203], a[24:27], v[228:231], v[200:203]
v_mfma_f32_16x16x32_bf16 v[204:207], a[28:31], v[228:231], v[204:207]
s_waitcnt vmcnt(12)
buffer_load_dwordx4 a[88:91], v241, s[16:19], s35 offen offset:2048 sc1
s_waitcnt vmcnt(12)
s_waitcnt lgkmcnt(4)
v_mfma_f32_16x16x32_bf16 v[160:163], a[32:35], v[208:211], v[160:163]
ds_read_b128 v[228:231], v75 offset:1024
buffer_load_dwordx4 a[92:95], v241, s[16:19], s35 offen offset:3072 sc1
v_mfma_f32_16x16x32_bf16 v[164:167], a[36:39], v[208:211], v[164:167]
v_mfma_f32_16x16x32_bf16 v[168:171], a[40:43], v[208:211], v[168:171]
v_mfma_f32_16x16x32_bf16 v[172:175], a[44:47], v[208:211], v[172:175]
s_waitcnt lgkmcnt(4)
v_mfma_f32_16x16x32_bf16 v[176:179], a[32:35], v[212:215], v[176:179]
ds_read_b128 v[208:211], v72 offset:2048
v_mfma_f32_16x16x32_bf16 v[180:183], a[36:39], v[212:215], v[180:183]
v_mfma_f32_16x16x32_bf16 v[184:187], a[40:43], v[212:215], v[184:187]
v_mfma_f32_16x16x32_bf16 v[188:191], a[44:47], v[212:215], v[188:191]
s_waitcnt vmcnt(11)
s_waitcnt lgkmcnt(4)
v_mfma_f32_16x16x32_bf16 v[192:195], a[32:35], v[216:219], v[192:195]
ds_read_b128 v[212:215], v72 offset:10240
buffer_load_dwordx2 v[248:249], v46, s[16:19], 0 offen offset:0 sc1
v_mfma_f32_16x16x32_bf16 v[196:199], a[36:39], v[216:219], v[196:199]
v_mfma_f32_16x16x32_bf16 v[200:203], a[40:43], v[216:219], v[200:203]
v_mfma_f32_16x16x32_bf16 v[204:207], a[44:47], v[216:219], v[204:207]
s_waitcnt vmcnt(11)
buffer_load_dwordx4 a[96:99], v240, s[16:19], s36 offen offset:0 sc1
s_waitcnt vmcnt(11)
buffer_load_dwordx4 a[100:103], v240, s[16:19], s36 offen offset:1024 sc1
s_waitcnt vmcnt(11)
s_waitcnt lgkmcnt(4)
v_mfma_f32_16x16x32_bf16 v[160:163], a[48:51], v[220:223], v[160:163]
ds_read_b128 v[216:219], v74 offset:2048
buffer_load_dwordx4 a[104:107], v241, s[16:19], s36 offen offset:0 sc1
v_mfma_f32_16x16x32_bf16 v[164:167], a[52:55], v[220:223], v[164:167]
v_mfma_f32_16x16x32_bf16 v[168:171], a[56:59], v[220:223], v[168:171]
v_mfma_f32_16x16x32_bf16 v[172:175], a[60:63], v[220:223], v[172:175]
s_waitcnt vmcnt(11)
s_waitcnt lgkmcnt(4)
v_mfma_f32_16x16x32_bf16 v[176:179], a[48:51], v[224:227], v[176:179]
ds_read_b128 v[220:223], v73 offset:2048
buffer_load_dwordx4 a[108:111], v241, s[16:19], s36 offen offset:1024 sc1
v_mfma_f32_16x16x32_bf16 v[180:183], a[52:55], v[224:227], v[180:183]
v_mfma_f32_16x16x32_bf16 v[184:187], a[56:59], v[224:227], v[184:187]
v_mfma_f32_16x16x32_bf16 v[188:191], a[60:63], v[224:227], v[188:191]
s_waitcnt vmcnt(11)
s_waitcnt lgkmcnt(4)
v_mfma_f32_16x16x32_bf16 v[192:195], a[48:51], v[228:231], v[192:195]
ds_read_b128 v[224:227], v73 offset:10240
buffer_load_dwordx4 a[112:115], v240, s[16:19], s36 offen offset:2048 sc1
v_mfma_f32_16x16x32_bf16 v[196:199], a[52:55], v[228:231], v[196:199]
v_mfma_f32_16x16x32_bf16 v[200:203], a[56:59], v[228:231], v[200:203]
v_mfma_f32_16x16x32_bf16 v[204:207], a[60:63], v[228:231], v[204:207]
s_waitcnt vmcnt(11)
buffer_load_dwordx4 a[116:119], v240, s[16:19], s36 offen offset:3072 sc1
s_waitcnt vmcnt(11)
s_waitcnt lgkmcnt(4)
v_mfma_f32_16x16x32_bf16 v[160:163], a[64:67], v[208:211], v[160:163]
ds_read_b128 v[228:231], v75 offset:2048
buffer_load_dwordx4 a[120:123], v241, s[16:19], s36 offen offset:2048 sc1
v_mfma_f32_16x16x32_bf16 v[164:167], a[68:71], v[208:211], v[164:167]
v_mfma_f32_16x16x32_bf16 v[168:171], a[72:75], v[208:211], v[168:171]
v_mfma_f32_16x16x32_bf16 v[172:175], a[76:79], v[208:211], v[172:175]
s_waitcnt vmcnt(11)
s_waitcnt lgkmcnt(4)
v_mfma_f32_16x16x32_bf16 v[176:179], a[64:67], v[212:215], v[176:179]
ds_read_b128 v[208:211], v72 offset:3072
buffer_load_dwordx4 a[124:127], v241, s[16:19], s36 offen offset:3072 sc1
v_mfma_f32_16x16x32_bf16 v[180:183], a[68:71], v[212:215], v[180:183]
v_mfma_f32_16x16x32_bf16 v[184:187], a[72:75], v[212:215], v[184:187]
v_mfma_f32_16x16x32_bf16 v[188:191], a[76:79], v[212:215], v[188:191]
s_waitcnt vmcnt(11)
s_waitcnt lgkmcnt(4)
v_mfma_f32_16x16x32_bf16 v[192:195], a[64:67], v[216:219], v[192:195]
ds_read_b128 v[212:215], v72 offset:11264
v_mfma_f32_16x16x32_bf16 v[196:199], a[68:71], v[216:219], v[196:199]
v_mfma_f32_16x16x32_bf16 v[200:203], a[72:75], v[216:219], v[200:203]
v_mfma_f32_16x16x32_bf16 v[204:207], a[76:79], v[216:219], v[204:207]
s_waitcnt vmcnt(10)
s_waitcnt vmcnt(9)
s_waitcnt lgkmcnt(4)
v_mfma_f32_16x16x32_bf16 v[160:163], a[80:83], v[220:223], v[160:163]
ds_read_b128 v[216:219], v74 offset:3072
v_mfma_f32_16x16x32_bf16 v[164:167], a[84:87], v[220:223], v[164:167]
v_mfma_f32_16x16x32_bf16 v[168:171], a[88:91], v[220:223], v[168:171]
v_mfma_f32_16x16x32_bf16 v[172:175], a[92:95], v[220:223], v[172:175]
s_waitcnt vmcnt(8)
s_waitcnt lgkmcnt(4)
v_mfma_f32_16x16x32_bf16 v[176:179], a[80:83], v[224:227], v[176:179]
ds_read_b128 v[220:223], v73 offset:3072
v_cmp_ne_u64 vcc, s[98:99], v[248:249]
s_nop 1
s_cbranch_vccnz LF_spinQ
LF_goQ:
v_mfma_f32_16x16x32_bf16 v[180:183], a[84:87], v[224:227], v[180:183]
buffer_load_dwordx2 v[128:129], v244, s[24:27], 0 offen offset:128 sc1
v_mfma_f32_16x16x32_bf16 v[184:187], a[88:91], v[224:227], v[184:187]
buffer_load_dwordx2 v[130:131], v244, s[24:27], 0 offen offset:256 sc1
v_mfma_f32_16x16x32_bf16 v[188:191], a[92:95], v[224:227], v[188:191]
buffer_load_dwordx2 v[132:133], v244, s[24:27], 0 offen offset:384 sc1
buffer_load_dwordx2 v[134:135], v244, s[24:27], 0 offen offset:512 sc1
buffer_load_dwordx2 v[136:137], v244, s[24:27], 0 offen offset:640 sc1
buffer_load_dwordx2 v[138:139], v244, s[24:27], 0 offen offset:768 sc1
s_waitcnt vmcnt(13)
s_waitcnt lgkmcnt(4)
v_mfma_f32_16x16x32_bf16 v[192:195], a[80:83], v[228:231], v[192:195]
ds_read_b128 v[224:227], v73 offset:11264
s_add_u32 s49, s6, s42
buffer_load_dwordx4 v[48:51], v47, s[16:19], s49 offen sc1
v_mfma_f32_16x16x32_bf16 v[196:199], a[84:87], v[228:231], v[196:199]
s_add_u32 s3, s6, s43
buffer_load_dwordx4 v[52:55], v47, s[16:19], s3 offen sc1
v_mfma_f32_16x16x32_bf16 v[200:203], a[88:91], v[228:231], v[200:203]
v_mfma_f32_16x16x32_bf16 v[204:207], a[92:95], v[228:231], v[204:207]
s_waitcnt vmcnt(14)
buffer_load_dwordx4 a[128:131], v240, s[16:19], s38 offen offset:0 sc1
s_waitcnt vmcnt(14)
buffer_load_dwordx4 a[132:135], v240, s[16:19], s38 offen offset:1024 sc1
s_waitcnt vmcnt(14)
s_waitcnt lgkmcnt(4)
v_mfma_f32_16x16x32_bf16 v[160:163], a[96:99], v[208:211], v[160:163]
ds_read_b128 v[228:231], v75 offset:3072
v_mfma_f32_16x16x32_bf16 v[164:167], a[100:103], v[208:211], v[164:167]
v_mfma_f32_16x16x32_bf16 v[168:171], a[104:107], v[208:211], v[168:171]
v_mfma_f32_16x16x32_bf16 v[172:175], a[108:111], v[208:211], v[172:175]
s_waitcnt vmcnt(13)
s_waitcnt lgkmcnt(4)
v_mfma_f32_16x16x32_bf16 v[176:179], a[96:99], v[212:215], v[176:179]
s_add_u32 s49, s6, s44
buffer_load_dwordx4 v[56:59], v47, s[16:19], s49 offen sc1
v_mfma_f32_16x16x32_bf16 v[180:183], a[100:103], v[212:215], v[180:183]
s_add_u32 s3, s6, s45
buffer_load_dwordx4 v[60:63], v47, s[16:19], s3 offen sc1
v_mfma_f32_16x16x32_bf16 v[184:187], a[104:107], v[212:215], v[184:187]
v_mfma_f32_16x16x32_bf16 v[188:191], a[108:111], v[212:215], v[188:191]
s_waitcnt vmcnt(14)
s_waitcnt lgkmcnt(3)
v_mfma_f32_16x16x32_bf16 v[192:195], a[96:99], v[216:219], v[192:195]
buffer_load_dwordx4 a[136:139], v241, s[16:19], s38 offen offset:0 sc1
v_mfma_f32_16x16x32_bf16 v[196:199], a[100:103], v[216:219], v[196:199]
v_mfma_f32_16x16x32_bf16 v[200:203], a[104:107], v[216:219], v[200:203]
v_mfma_f32_16x16x32_bf16 v[204:207], a[108:111], v[216:219], v[204:207]
s_waitcnt vmcnt(14)
buffer_load_dwordx4 a[140:143], v241, s[16:19], s38 offen offset:1024 sc1
s_waitcnt vmcnt(14)
s_waitcnt lgkmcnt(2)
v_mfma_f32_16x16x32_bf16 v[160:163], a[112:115], v[220:223], v[160:163]
s_add_u32 s49, s6, s46
buffer_load_dwordx4 v[64:67], v47, s[16:19], s49 offen sc1
v_mfma_f32_16x16x32_bf16 v[164:167], a[116:119], v[220:223], v[164:167]
ds_read_b128 v[68:71], v76 offset:0
v_mfma_f32_16x16x32_bf16 v[168:171], a[120:123], v[220:223], v[168:171]
v_mfma_f32_16x16x32_bf16 v[172:175], a[124:127], v[220:223], v[172:175]
s_waitcnt lgkmcnt(2)
v_mfma_f32_16x16x32_bf16 v[176:179], a[112:115], v[224:227], v[176:179]
v_lshlrev_b32 v234, 16, v104
v_and_b32 v235, s95, v104
v_mfma_f32_16x16x32_bf16 v[180:183], a[116:119], v[224:227], v[180:183]
v_fma_f32 v160, v160, v253, v234
v_fma_f32 v161, v161, v253, v235
v_mfma_f32_16x16x32_bf16 v[184:187], a[120:123], v[224:227], v[184:187]
v_lshlrev_b32 v236, 16, v105
v_and_b32 v237, s95, v105
v_mfma_f32_16x16x32_bf16 v[188:191], a[124:127], v[224:227], v[188:191]
v_fma_f32 v162, v162, v253, v236
v_fma_f32 v163, v163, v253, v237
s_waitcnt lgkmcnt(1)
v_mfma_f32_16x16x32_bf16 v[192:195], a[112:115], v[228:231], v[192:195]
v_lshlrev_b32 v238, 16, v106
v_and_b32 v239, s95, v106
v_mfma_f32_16x16x32_bf16 v[196:199], a[116:119], v[228:231], v[196:199]
v_fma_f32 v164, v164, v253, v238
v_fma_f32 v165, v165, v253, v239
v_mfma_f32_16x16x32_bf16 v[200:203], a[120:123], v[228:231], v[200:203]
v_lshlrev_b32 v232, 16, v107
v_and_b32 v233, s95, v107
v_mfma_f32_16x16x32_bf16 v[204:207], a[124:127], v[228:231], v[204:207]
v_fma_f32 v166, v166, v253, v232
v_fma_f32 v167, v167, v253, v233
ds_read_b128 v[104:107], v246 offset:2048
v_lshlrev_b32 v234, 16, v108
v_and_b32 v235, s95, v108
v_fma_f32 v168, v168, v253, v234
v_fma_f32 v169, v169, v253, v235
v_lshlrev_b32 v236, 16, v109
v_and_b32 v237, s95, v109
v_fma_f32 v170, v170, v253, v236
v_fma_f32 v171, v171, v253, v237
v_lshlrev_b32 v238, 16, v110
v_and_b32 v239, s95, v110
v_fma_f32 v172, v172, v253, v238
v_fma_f32 v173, v173, v253, v239
v_lshlrev_b32 v232, 16, v111
v_and_b32 v233, s95, v111
v_fma_f32 v174, v174, v253, v232
v_fma_f32 v175, v175, v253, v233
ds_read_b128 v[108:111], v245 offset:4096
s_waitcnt vmcnt(13)
buffer_load_dwordx4 a[144:147], v240, s[16:19], s38 offen offset:2048 sc1
v_lshlrev_b32 v234, 16, v152
v_and_b32 v235, s95, v152
v_fma_f32 v176, v176, v254, v234
v_fma_f32 v177, v177, v254, v235
v_lshlrev_b32 v236, 16, v153
v_and_b32 v237, s95, v153
v_fma_f32 v178, v178, v254, v236
v_fma_f32 v179, v179, v254, v237
v_lshlrev_b32 v238, 16, v154
v_and_b32 v239, s95, v154
v_fma_f32 v180, v180, v254, v238
v_fma_f32 v181, v181, v254, v239
v_lshlrev_b32 v232, 16, v155
v_and_b32 v233, s95, v155
v_fma_f32 v182, v182, v254, v232
v_fma_f32 v183, v183, v254, v233
ds_read_b128 v[152:155], v246 offset:4096
s_waitcnt lgkmcnt(2)
v_lshlrev_b32 v234, 16, v104
v_and_b32 v235, s95, v104
v_fma_f32 v184, v184, v254, v234
v_fma_f32 v185, v185, v254, v235
v_lshlrev_b32 v236, 16, v105
v_and_b32 v237, s95, v105
v_fma_f32 v186, v186, v254, v236
v_fma_f32 v187, v187, v254, v237
v_lshlrev_b32 v238, 16, v106
v_and_b32 v239, s95, v106
v_fma_f32 v188, v188, v254, v238
v_fma_f32 v189, v189, v254, v239
v_lshlrev_b32 v232, 16, v107
v_and_b32 v233, s95, v107
v_fma_f32 v190, v190, v254, v232
v_fma_f32 v191, v191, v254, v233
s_waitcnt vmcnt(12)
buffer_load_dwordx4 a[148:151], v240, s[16:19], s38 offen offset:3072 sc1
s_waitcnt lgkmcnt(1)
v_lshlrev_b32 v234, 16, v108
v_and_b32 v235, s95, v108
v_fma_f32 v192, v192, v255, v234
v_fma_f32 v193, v193, v255, v235
v_lshlrev_b32 v236, 16, v109
v_and_b32 v237, s95, v109
v_fma_f32 v194, v194, v255, v236
v_fma_f32 v195, v195, v255, v237
v_lshlrev_b32 v238, 16, v110
v_and_b32 v239, s95, v110
v_fma_f32 v196, v196, v255, v238
v_fma_f32 v197, v197, v255, v239
v_lshlrev_b32 v232, 16, v111
v_and_b32 v233, s95, v111
v_fma_f32 v198, v198, v255, v232
v_fma_f32 v199, v199, v255, v233
s_waitcnt lgkmcnt(0)
v_lshlrev_b32 v234, 16, v152
v_and_b32 v235, s95, v152
v_fma_f32 v200, v200, v255, v234
v_fma_f32 v201, v201, v255, v235
v_lshlrev_b32 v236, 16, v153
v_and_b32 v237, s95, v153
v_fma_f32 v202, v202, v255, v236
v_fma_f32 v203, v203, v255, v237
v_lshlrev_b32 v238, 16, v154
v_and_b32 v239, s95, v154
v_fma_f32 v204, v204, v255, v238
v_fma_f32 v205, v205, v255, v239
v_lshlrev_b32 v232, 16, v155
v_and_b32 v233, s95, v155
v_fma_f32 v206, v206, v255, v232
v_fma_f32 v207, v207, v255, v233
s_waitcnt vmcnt(11)
v_max3_f32 v232, v128, v130, v132
v_max3_f32 v233, v134, v136, v138
v_max_f32 v232, v232, v233
v_subrev_f32 v232, 0x42fe0000, v232
v_sub_f32 v128, v128, v232
v_sub_f32 v130, v130, v232
v_sub_f32 v132, v132, v232
v_sub_f32 v134, v134, v232
v_sub_f32 v136, v136, v232
v_sub_f32 v138, v138, v232
v_cvt_u32_f32 v128, v128
v_cvt_u32_f32 v130, v130
v_cvt_u32_f32 v132, v132
v_cvt_u32_f32 v134, v134
v_cvt_u32_f32 v136, v136
v_cvt_u32_f32 v138, v138
v_lshlrev_b32 v234, 23, v128
v_lshlrev_b32 v235, 23, v130
v_lshlrev_b32 v236, 23, v132
v_lshlrev_b32 v237, 23, v134
v_lshlrev_b32 v238, 23, v136
v_lshlrev_b32 v239, 23, v138
v_mul_f32 v232, v234, v129
v_fmac_f32 v232, v235, v131
v_fmac_f32 v232, v236, v133
v_fmac_f32 v232, v237, v135
v_fmac_f32 v232, v238, v137
v_fmac_f32 v232, v239, v139
v_rcp_f32 v150, v232
v_mul_u32_u24 v144, 0x800080, v128
v_mul_u32_u24 v145, 0x800080, v130
v_mul_u32_u24 v146, 0x800080, v132
v_mul_u32_u24 v147, 0x800080, v134
v_mul_u32_u24 v148, 0x800080, v136
v_mul_u32_u24 v149, 0x800080, v138
ds_write_b128 v242, v[144:147]
ds_write_b96 v242, v[148:150] offset:16
ds_read_b128 v[144:147], v250 offset:0
ds_read_b128 v[148:151], v250 offset:16
ds_read_b128 v[128:131], v250 offset:512
ds_read_b128 v[132:135], v250 offset:528
ds_read_b128 v[136:139], v250 offset:1024
ds_read_b128 v[140:143], v250 offset:1040
s_waitcnt lgkmcnt(4)
v_and_b32 v0, v144, v156
v_and_b32 v1, v144, v157
v_and_b32 v2, v145, v156
v_and_b32 v3, v145, v157
v_and_b32 v4, v146, v156
v_and_b32 v5, v146, v157
v_and_b32 v6, v147, v156
v_and_b32 v7, v147, v157
v_and_b32 v8, v148, v156
v_and_b32 v9, v148, v157
v_and_b32 v10, v149, v156
v_and_b32 v11, v149, v157
v_mov_b32 v40, v150
s_waitcnt lgkmcnt(2)
v_and_b32 v12, v128, v156
v_and_b32 v13, v128, v157
v_and_b32 v14, v129, v156
v_and_b32 v15, v129, v157
v_and_b32 v16, v130, v156
v_and_b32 v17, v130, v157
v_and_b32 v18, v131, v156
v_and_b32 v19, v131, v157
v_and_b32 v20, v132, v156
v_and_b32 v21, v132, v157
v_and_b32 v22, v133, v156
v_and_b32 v23, v133, v157
v_mov_b32 v41, v134
s_waitcnt lgkmcnt(0)
v_and_b32 v24, v136, v156
v_and_b32 v25, v136, v157
v_and_b32 v26, v137, v156
v_and_b32 v27, v137, v157
v_and_b32 v28, v138, v156
v_and_b32 v29, v138, v157
v_and_b32 v30, v139, v156
v_and_b32 v31, v139, v157
v_and_b32 v32, v140, v156
v_and_b32 v33, v140, v157
v_and_b32 v34, v141, v156
v_and_b32 v35, v141, v157
v_mov_b32 v42, v142
s_waitcnt vmcnt(9)
v_swap_b32 v50, v52
v_swap_b32 v51, v53
s_nop 1
v_mfma_f32_16x16x32_bf16 v[136:139], v[48:51], v[0:3], 0
s_add_u32 s49, s6, s42
buffer_load_dwordx4 v[80:83], v43, s[16:19], s49 offen sc1
v_mfma_f32_16x16x32_bf16 v[140:143], v[52:55], v[0:3], 0
s_add_u32 s3, s6, s43
buffer_load_dwordx4 v[84:87], v43, s[16:19], s3 offen sc1
buffer_load_dwordx4 a[152:155], v241, s[16:19], s38 offen offset:2048 sc1
s_waitcnt vmcnt(11)
buffer_load_dwordx4 a[156:159], v241, s[16:19], s38 offen offset:3072 sc1
s_waitcnt vmcnt(11)
s_waitcnt vmcnt(9)
v_swap_b32 v58, v60
v_swap_b32 v59, v61
s_nop 1
v_mfma_f32_16x16x32_bf16 v[136:139], v[56:59], v[4:7], v[136:139]
s_add_u32 s49, s6, s44
buffer_load_dwordx4 v[88:91], v43, s[16:19], s49 offen sc1
v_mfma_f32_16x16x32_bf16 v[140:143], v[60:63], v[4:7], v[140:143]
s_add_u32 s3, s6, s45
buffer_load_dwordx4 v[92:95], v43, s[16:19], s3 offen sc1
buffer_load_dwordx4 a[160:163], v240, s[16:19], s39 offen offset:0 sc1
s_waitcnt vmcnt(11)
buffer_load_dwordx4 a[164:167], v240, s[16:19], s39 offen offset:1024 sc1
s_waitcnt vmcnt(11)
s_add_u32 s49, s6, s46
buffer_load_dwordx4 v[96:99], v43, s[16:19], s49 offen sc1
ds_read_b128 v[100:103], v76 offset:4096
s_waitcnt vmcnt(11)
v_swap_b32 v66, v68
v_swap_b32 v67, v69
s_nop 1
v_mfma_f32_16x16x32_bf16 v[136:139], v[64:67], v[8:11], v[136:139]
buffer_load_dwordx4 a[168:171], v241, s[16:19], s39 offen offset:0 sc1
v_mfma_f32_16x16x32_bf16 v[140:143], v[68:71], v[8:11], v[140:143]
s_waitcnt vmcnt(11)
buffer_load_dwordx4 a[172:175], v241, s[16:19], s39 offen offset:1024 sc1
s_nop 3
v_mul_f32 v136, v136, v40
v_mul_f32 v137, v137, v40
v_mul_f32 v138, v138, v40
v_mul_f32 v139, v139, v40
v_mul_f32 v140, v140, v40
v_mul_f32 v141, v141, v40
v_mul_f32 v142, v142, v40
v_mul_f32 v143, v143, v40
v_cvt_pk_bf16_f32 v136, v136, v137
v_cvt_pk_bf16_f32 v137, v138, v139
v_cvt_pk_bf16_f32 v138, v140, v141
v_cvt_pk_bf16_f32 v139, v142, v143
ds_write_b128 v251, v[136:139] offset:0
s_waitcnt vmcnt(11)
s_waitcnt vmcnt(9)
v_swap_b32 v82, v84
v_swap_b32 v83, v85
s_nop 1
v_mfma_f32_16x16x32_bf16 v[128:131], v[80:83], v[0:3], 0
s_add_u32 s49, s7, s42
buffer_load_dwordx4 v[112:115], v47, s[16:19], s49 offen sc1
v_mfma_f32_16x16x32_bf16 v[132:135], v[84:87], v[0:3], 0
s_add_u32 s3, s7, s43
buffer_load_dwordx4 v[116:119], v47, s[16:19], s3 offen sc1
buffer_load_dwordx4 a[176:179], v240, s[16:19], s39 offen offset:2048 sc1
s_waitcnt vmcnt(11)
buffer_load_dwordx4 a[180:183], v240, s[16:19], s39 offen offset:3072 sc1
s_waitcnt vmcnt(11)
s_waitcnt vmcnt(9)
v_swap_b32 v90, v92
v_swap_b32 v91, v93
s_nop 1
v_mfma_f32_16x16x32_bf16 v[128:131], v[88:91], v[4:7], v[128:131]
s_add_u32 s49, s7, s44
buffer_load_dwordx4 v[120:123], v47, s[16:19], s49 offen sc1
v_mfma_f32_16x16x32_bf16 v[132:135], v[92:95], v[4:7], v[132:135]
s_add_u32 s3, s7, s45
buffer_load_dwordx4 v[124:127], v47, s[16:19], s3 offen sc1
buffer_load_dwordx4 a[184:187], v241, s[16:19], s39 offen offset:2048 sc1
s_waitcnt vmcnt(11)
buffer_load_dwordx4 a[188:191], v241, s[16:19], s39 offen offset:3072 sc1
s_waitcnt vmcnt(11)
s_add_u32 s49, s7, s46
buffer_load_dwordx4 v[48:51], v47, s[16:19], s49 offen sc1
ds_read_b128 v[52:55], v77 offset:0
s_waitcnt vmcnt(11)
s_waitcnt lgkmcnt(2)
v_swap_b32 v98, v100
v_swap_b32 v99, v101
s_nop 1
v_mfma_f32_16x16x32_bf16 v[128:131], v[96:99], v[8:11], v[128:131]
buffer_load_dwordx4 a[192:195], v240, s[16:19], s40 offen offset:0 sc1
v_mfma_f32_16x16x32_bf16 v[132:135], v[100:103], v[8:11], v[132:135]
s_waitcnt vmcnt(11)
buffer_load_dwordx4 a[196:199], v240, s[16:19], s40 offen offset:1024 sc1
s_nop 3
v_mul_f32 v128, v128, v40
v_mul_f32 v129, v129, v40
v_mul_f32 v130, v130, v40
v_mul_f32 v131, v131, v40
v_mul_f32 v132, v132, v40
v_mul_f32 v133, v133, v40
v_mul_f32 v134, v134, v40
v_mul_f32 v135, v135, v40
v_cvt_pk_bf16_f32 v128, v128, v129
v_cvt_pk_bf16_f32 v129, v130, v131
v_cvt_pk_bf16_f32 v130, v132, v133
v_cvt_pk_bf16_f32 v131, v134, v135
ds_write_b128 v251, v[128:131] offset:4096
s_waitcnt vmcnt(11)
s_waitcnt lgkmcnt(0)
s_barrier
ds_read_b128 v[208:211], v252 offset:0
ds_read_b128 v[212:215], v252 offset:1024
ds_read_b128 v[216:219], v252 offset:2048
ds_read_b128 v[220:223], v252 offset:3072
ds_read_b128 v[224:227], v252 offset:4096
s_waitcnt vmcnt(9)
s_waitcnt lgkmcnt(4)
v_mfma_f32_16x16x32_bf16 v[160:163], a[128:131], v[208:211], v[160:163]
ds_read_b128 v[228:231], v252 offset:5120
v_swap_b32 v114, v116
v_mfma_f32_16x16x32_bf16 v[164:167], a[132:135], v[208:211], v[164:167]
v_swap_b32 v115, v117
s_nop 1
v_mfma_f32_16x16x32_bf16 v[136:139], v[112:115], v[12:15], 0
s_add_u32 s49, s7, s42
buffer_load_dwordx4 v[56:59], v43, s[16:19], s49 offen sc1
v_mfma_f32_16x16x32_bf16 v[140:143], v[116:119], v[12:15], 0
s_add_u32 s3, s7, s43
buffer_load_dwordx4 v[60:63], v43, s[16:19], s3 offen sc1
v_mfma_f32_16x16x32_bf16 v[168:171], a[136:139], v[208:211], v[168:171]
buffer_load_dwordx4 a[200:203], v241, s[16:19], s40 offen offset:0 sc1
v_mfma_f32_16x16x32_bf16 v[172:175], a[140:143], v[208:211], v[172:175]
s_waitcnt lgkmcnt(4)
v_mfma_f32_16x16x32_bf16 v[160:163], a[144:147], v[212:215], v[160:163]
v_mfma_f32_16x16x32_bf16 v[164:167], a[148:151], v[212:215], v[164:167]
v_mfma_f32_16x16x32_bf16 v[168:171], a[152:155], v[212:215], v[168:171]
v_mfma_f32_16x16x32_bf16 v[172:175], a[156:159], v[212:215], v[172:175]
s_waitcnt vmcnt(11)
s_waitcnt lgkmcnt(3)
v_mfma_f32_16x16x32_bf16 v[160:163], a[160:163], v[216:219], v[160:163]
buffer_load_dwordx4 a[204:207], v241, s[16:19], s40 offen offset:1024 sc1
v_mfma_f32_16x16x32_bf16 v[164:167], a[164:167], v[216:219], v[164:167]
v_mfma_f32_16x16x32_bf16 v[168:171], a[168:171], v[216:219], v[168:171]
v_mfma_f32_16x16x32_bf16 v[172:175], a[172:175], v[216:219], v[172:175]
s_waitcnt vmcnt(11)
s_waitcnt vmcnt(9)
v_swap_b32 v122, v124
v_swap_b32 v123, v125
s_nop 1
v_mfma_f32_16x16x32_bf16 v[136:139], v[120:123], v[16:19], v[136:139]
s_add_u32 s49, s7, s44
buffer_load_dwordx4 v[64:67], v43, s[16:19], s49 offen sc1
v_mfma_f32_16x16x32_bf16 v[140:143], v[124:127], v[16:19], v[140:143]
s_add_u32 s3, s7, s45
buffer_load_dwordx4 v[68:71], v43, s[16:19], s3 offen sc1
buffer_load_dwordx4 a[208:211], v240, s[16:19], s40 offen offset:2048 sc1
s_waitcnt vmcnt(11)
buffer_load_dwordx4 a[212:215], v240, s[16:19], s40 offen offset:3072 sc1
s_waitcnt vmcnt(11)
s_waitcnt lgkmcnt(2)
v_mfma_f32_16x16x32_bf16 v[160:163], a[176:179], v[220:223], v[160:163]
s_add_u32 s49, s7, s46
buffer_load_dwordx4 v[80:83], v43, s[16:19], s49 offen sc1
v_mfma_f32_16x16x32_bf16 v[164:167], a[180:183], v[220:223], v[164:167]
ds_read_b128 v[84:87], v77 offset:4096
v_mfma_f32_16x16x32_bf16 v[168:171], a[184:187], v[220:223], v[168:171]
v_mfma_f32_16x16x32_bf16 v[172:175], a[188:191], v[220:223], v[172:175]
s_waitcnt vmcnt(11)
v_swap_b32 v50, v52
v_swap_b32 v51, v53
s_nop 1
v_mfma_f32_16x16x32_bf16 v[136:139], v[48:51], v[20:23], v[136:139]
buffer_load_dwordx4 a[216:219], v241, s[16:19], s40 offen offset:2048 sc1
v_mfma_f32_16x16x32_bf16 v[140:143], v[52:55], v[20:23], v[140:143]
s_waitcnt vmcnt(11)
buffer_load_dwordx4 a[220:223], v241, s[16:19], s40 offen offset:3072 sc1
s_nop 3
v_mul_f32 v136, v136, v41
v_mul_f32 v137, v137, v41
v_mul_f32 v138, v138, v41
v_mul_f32 v139, v139, v41
v_mul_f32 v140, v140, v41
v_mul_f32 v141, v141, v41
v_mul_f32 v142, v142, v41
v_mul_f32 v143, v143, v41
v_cvt_pk_bf16_f32 v136, v136, v137
v_cvt_pk_bf16_f32 v137, v138, v139
v_cvt_pk_bf16_f32 v138, v140, v141
v_cvt_pk_bf16_f32 v139, v142, v143
ds_write_b128 v251, v[136:139] offset:8192
s_waitcnt vmcnt(11)
s_waitcnt vmcnt(9)
v_swap_b32 v58, v60
v_swap_b32 v59, v61
s_nop 1
v_mfma_f32_16x16x32_bf16 v[128:131], v[56:59], v[12:15], 0
s_add_u32 s49, s29, s42
buffer_load_dwordx4 v[88:91], v47, s[16:19], s49 offen sc1
v_mfma_f32_16x16x32_bf16 v[132:135], v[60:63], v[12:15], 0
s_add_u32 s3, s29, s43
buffer_load_dwordx4 v[92:95], v47, s[16:19], s3 offen sc1
buffer_load_dwordx4 a[224:227], v240, s[16:19], s41 offen offset:0 sc1
s_waitcnt vmcnt(11)
buffer_load_dwordx4 a[228:231], v240, s[16:19], s41 offen offset:1024 sc1
s_waitcnt vmcnt(11)
s_waitcnt lgkmcnt(3)
v_mfma_f32_16x16x32_bf16 v[160:163], a[192:195], v[224:227], v[160:163]
buffer_load_dwordx4 a[232:235], v241, s[16:19], s41 offen offset:0 sc1
v_mfma_f32_16x16x32_bf16 v[164:167], a[196:199], v[224:227], v[164:167]
v_mfma_f32_16x16x32_bf16 v[168:171], a[200:203], v[224:227], v[168:171]
v_mfma_f32_16x16x32_bf16 v[172:175], a[204:207], v[224:227], v[172:175]
s_waitcnt vmcnt(10)
v_swap_b32 v66, v68
v_swap_b32 v67, v69
s_nop 1
v_mfma_f32_16x16x32_bf16 v[128:131], v[64:67], v[16:19], v[128:131]
buffer_load_dwordx4 a[236:239], v241, s[16:19], s41 offen offset:1024 sc1
v_mfma_f32_16x16x32_bf16 v[132:135], v[68:71], v[16:19], v[132:135]
s_waitcnt vmcnt(10)
s_add_u32 s49, s29, s44
buffer_load_dwordx4 v[96:99], v47, s[16:19], s49 offen sc1
s_add_u32 s3, s29, s45
buffer_load_dwordx4 v[100:103], v47, s[16:19], s3 offen sc1
s_waitcnt vmcnt(11)
buffer_load_dwordx4 a[240:243], v240, s[16:19], s41 offen offset:2048 sc1
s_waitcnt vmcnt(11)
s_waitcnt lgkmcnt(1)
v_swap_b32 v82, v84
v_swap_b32 v83, v85
s_nop 1
v_mfma_f32_16x16x32_bf16 v[128:131], v[80:83], v[20:23], v[128:131]
buffer_load_dwordx4 a[244:247], v240, s[16:19], s41 offen offset:3072 sc1
v_mfma_f32_16x16x32_bf16 v[132:135], v[84:87], v[20:23], v[132:135]
s_waitcnt vmcnt(11)
buffer_load_dwordx4 a[248:251], v241, s[16:19], s41 offen offset:2048 sc1
s_nop 3
v_mul_f32 v128, v128, v41
v_mul_f32 v129, v129, v41
v_mul_f32 v130, v130, v41
v_mul_f32 v131, v131, v41
v_mul_f32 v132, v132, v41
v_mul_f32 v133, v133, v41
v_mul_f32 v134, v134, v41
v_mul_f32 v135, v135, v41
v_cvt_pk_bf16_f32 v128, v128, v129
v_cvt_pk_bf16_f32 v129, v130, v131
v_cvt_pk_bf16_f32 v130, v132, v133
v_cvt_pk_bf16_f32 v131, v134, v135
ds_write_b128 v251, v[128:131] offset:12288
s_waitcnt vmcnt(11)
v_mfma_f32_16x16x32_bf16 v[160:163], a[208:211], v[228:231], v[160:163]
buffer_load_dwordx4 a[252:255], v241, s[16:19], s41 offen offset:3072 sc1
v_mfma_f32_16x16x32_bf16 v[164:167], a[212:215], v[228:231], v[164:167]
v_mfma_f32_16x16x32_bf16 v[168:171], a[216:219], v[228:231], v[168:171]
v_mfma_f32_16x16x32_bf16 v[172:175], a[220:223], v[228:231], v[172:175]
s_waitcnt lgkmcnt(0)
s_barrier
ds_read_b128 v[208:211], v252 offset:8192
ds_read_b128 v[212:215], v252 offset:9216
ds_read_b128 v[216:219], v252 offset:10240
ds_read_b128 v[220:223], v252 offset:11264
ds_read_b128 v[224:227], v252 offset:12288
s_waitcnt vmcnt(10)
s_waitcnt lgkmcnt(4)
v_mfma_f32_16x16x32_bf16 v[176:179], a[128:131], v[208:211], v[176:179]
ds_read_b128 v[228:231], v252 offset:6144
v_swap_b32 v90, v92
v_mfma_f32_16x16x32_bf16 v[180:183], a[132:135], v[208:211], v[180:183]
v_swap_b32 v91, v93
s_nop 1
v_mfma_f32_16x16x32_bf16 v[136:139], v[88:91], v[24:27], 0
s_add_u32 s49, s29, s46
buffer_load_dwordx4 v[112:115], v47, s[16:19], s49 offen sc1
v_mfma_f32_16x16x32_bf16 v[140:143], v[92:95], v[24:27], 0
s_add_u32 s3, s29, s47
s_cmp_lt_u32 s37, 4
s_cbranch_scc1 LF_o0
buffer_load_dwordx4 v[116:119], v47, s[16:19], s3 offen sc1
ds_read_b128 v[36:39], v78 offset:0
s_branch LF_j0
LF_o0:
s_mov_b32 s3, 0x70000000
buffer_load_dwordx4 v[36:39], v47, s[16:19], s3 offen sc1
ds_read_b128 v[116:119], v78 offset:0
LF_j0:
v_mfma_f32_16x16x32_bf16 v[184:187], a[136:139], v[208:211], v[184:187]
v_mfma_f32_16x16x32_bf16 v[188:191], a[140:143], v[208:211], v[188:191]
s_waitcnt lgkmcnt(5)
v_mfma_f32_16x16x32_bf16 v[176:179], a[144:147], v[212:215], v[176:179]
ds_read_b128 v[208:211], v252 offset:13312
v_mfma_f32_16x16x32_bf16 v[180:183], a[148:151], v[212:215], v[180:183]
v_mfma_f32_16x16x32_bf16 v[184:187], a[152:155], v[212:215], v[184:187]
v_mfma_f32_16x16x32_bf16 v[188:191], a[156:159], v[212:215], v[188:191]
s_waitcnt vmcnt(11)
s_waitcnt lgkmcnt(5)
v_mfma_f32_16x16x32_bf16 v[176:179], a[160:163], v[216:219], v[176:179]
ds_read_b128 v[212:215], v252 offset:14336
v_mfma_f32_16x16x32_bf16 v[180:183], a[164:167], v[216:219], v[180:183]
v_mfma_f32_16x16x32_bf16 v[184:187], a[168:171], v[216:219], v[184:187]
v_mfma_f32_16x16x32_bf16 v[188:191], a[172:175], v[216:219], v[188:191]
s_waitcnt vmcnt(10)
s_waitcnt lgkmcnt(5)
v_mfma_f32_16x16x32_bf16 v[176:179], a[176:179], v[220:223], v[176:179]
ds_read_b128 v[216:219], v252 offset:7168
s_add_u32 s49, s29, s42
buffer_load_dwordx4 v[120:123], v43, s[16:19], s49 offen sc1
v_mfma_f32_16x16x32_bf16 v[180:183], a[180:183], v[220:223], v[180:183]
s_add_u32 s3, s29, s43
buffer_load_dwordx4 v[124:127], v43, s[16:19], s3 offen sc1
v_mfma_f32_16x16x32_bf16 v[184:187], a[184:187], v[220:223], v[184:187]
v_mfma_f32_16x16x32_bf16 v[188:191], a[188:191], v[220:223], v[188:191]
s_waitcnt vmcnt(11)
s_waitcnt lgkmcnt(5)
v_mfma_f32_16x16x32_bf16 v[176:179], a[192:195], v[224:227], v[176:179]
ds_read_b128 v[220:223], v252 offset:15360
v_mfma_f32_16x16x32_bf16 v[180:183], a[196:199], v[224:227], v[180:183]
v_mfma_f32_16x16x32_bf16 v[184:187], a[200:203], v[224:227], v[184:187]
v_mfma_f32_16x16x32_bf16 v[188:191], a[204:207], v[224:227], v[188:191]
s_waitcnt vmcnt(10)
s_waitcnt lgkmcnt(5)
v_mfma_f32_16x16x32_bf16 v[160:163], a[224:227], v[228:231], v[160:163]
s_add_u32 s49, s29, s44
buffer_load_dwordx4 v[48:51], v43, s[16:19], s49 offen sc1
v_mfma_f32_16x16x32_bf16 v[164:167], a[228:231], v[228:231], v[164:167]
s_add_u32 s3, s29, s45
buffer_load_dwordx4 v[52:55], v43, s[16:19], s3 offen sc1
v_mfma_f32_16x16x32_bf16 v[168:171], a[232:235], v[228:231], v[168:171]
v_mfma_f32_16x16x32_bf16 v[172:175], a[236:239], v[228:231], v[172:175]
s_waitcnt vmcnt(10)
s_waitcnt lgkmcnt(3)
v_mfma_f32_16x16x32_bf16 v[176:179], a[208:211], v[208:211], v[176:179]
v_swap_b32 v98, v100
v_mfma_f32_16x16x32_bf16 v[180:183], a[212:215], v[208:211], v[180:183]
v_swap_b32 v99, v101
s_nop 1
v_mfma_f32_16x16x32_bf16 v[136:139], v[96:99], v[28:31], v[136:139]
s_add_u32 s49, s29, s46
buffer_load_dwordx4 v[56:59], v43, s[16:19], s49 offen sc1
v_mfma_f32_16x16x32_bf16 v[140:143], v[100:103], v[28:31], v[140:143]
s_add_u32 s3, s29, s47
s_cmp_lt_u32 s37, 4
s_cbranch_scc1 LF_o1
buffer_load_dwordx4 v[60:63], v43, s[16:19], s3 offen sc1
ds_read_b128 v[36:39], v78 offset:4096
s_branch LF_j1
LF_o1:
s_mov_b32 s3, 0x70000000
buffer_load_dwordx4 v[36:39], v43, s[16:19], s3 offen sc1
ds_read_b128 v[60:63], v78 offset:4096
LF_j1:
v_mfma_f32_16x16x32_bf16 v[184:187], a[216:219], v[208:211], v[184:187]
v_mfma_f32_16x16x32_bf16 v[188:191], a[220:223], v[208:211], v[188:191]
s_waitcnt lgkmcnt(3)
v_mfma_f32_16x16x32_bf16 v[176:179], a[224:227], v[212:215], v[176:179]
v_mfma_f32_16x16x32_bf16 v[180:183], a[228:231], v[212:215], v[180:183]
v_mfma_f32_16x16x32_bf16 v[184:187], a[232:235], v[212:215], v[184:187]
v_mfma_f32_16x16x32_bf16 v[188:191], a[236:239], v[212:215], v[188:191]
s_waitcnt vmcnt(11)
s_waitcnt vmcnt(10)
s_waitcnt vmcnt(9)
s_waitcnt vmcnt(8)
s_waitcnt lgkmcnt(2)
v_mfma_f32_16x16x32_bf16 v[160:163], a[240:243], v[216:219], v[160:163]
v_mfma_f32_16x16x32_bf16 v[164:167], a[244:247], v[216:219], v[164:167]
v_mfma_f32_16x16x32_bf16 v[168:171], a[248:251], v[216:219], v[168:171]
v_mfma_f32_16x16x32_bf16 v[172:175], a[252:255], v[216:219], v[172:175]
s_waitcnt vmcnt(6)
s_waitcnt lgkmcnt(1)
v_mfma_f32_16x16x32_bf16 v[176:179], a[240:243], v[220:223], v[176:179]
v_swap_b32 v114, v116
v_mfma_f32_16x16x32_bf16 v[180:183], a[244:247], v[220:223], v[180:183]
v_swap_b32 v115, v117
s_nop 1
v_mfma_f32_16x16x32_bf16 v[136:139], v[112:115], v[32:35], v[136:139]
v_cvt_pk_bf16_f32 v160, v160, v161
v_cvt_pk_bf16_f32 v161, v162, v163
v_mfma_f32_16x16x32_bf16 v[140:143], v[116:119], v[32:35], v[140:143]
v_cvt_pk_bf16_f32 v162, v164, v165
v_cvt_pk_bf16_f32 v163, v166, v167
v_mfma_f32_16x16x32_bf16 v[184:187], a[248:251], v[220:223], v[184:187]
ds_write_b128 v245, v[160:163] offset:0
v_cvt_pk_bf16_f32 v168, v168, v169
v_mfma_f32_16x16x32_bf16 v[188:191], a[252:255], v[220:223], v[188:191]
v_cvt_pk_bf16_f32 v169, v170, v171
v_cvt_pk_bf16_f32 v170, v172, v173
v_cvt_pk_bf16_f32 v171, v174, v175
ds_write_b128 v246, v[168:171] offset:0
ds_read_b128 v[164:167], v247 offset:0
ds_read_b128 v[172:175], v247 offset:1024
v_mul_f32 v136, v136, v42
v_mul_f32 v137, v137, v42
v_mul_f32 v138, v138, v42
v_mul_f32 v139, v139, v42
v_mul_f32 v140, v140, v42
v_mul_f32 v141, v141, v42
v_mul_f32 v142, v142, v42
v_mul_f32 v143, v143, v42
v_cvt_pk_bf16_f32 v136, v136, v137
v_cvt_pk_bf16_f32 v137, v138, v139
v_cvt_pk_bf16_f32 v138, v140, v141
v_cvt_pk_bf16_f32 v139, v142, v143
ds_write_b128 v251, v[136:139] offset:16384
s_waitcnt lgkmcnt(0)
s_barrier
ds_read_b128 v[224:227], v252 offset:16384
ds_read_b128 v[228:231], v252 offset:17408
ds_read_b128 v[208:211], v252 offset:18432
ds_read_b128 v[212:215], v252 offset:19456
s_waitcnt vmcnt(4)
s_waitcnt lgkmcnt(3)
v_mfma_f32_16x16x32_bf16 v[192:195], a[128:131], v[224:227], v[192:195]
v_swap_b32 v122, v124
v_mfma_f32_16x16x32_bf16 v[196:199], a[132:135], v[224:227], v[196:199]
v_swap_b32 v123, v125
s_nop 1
v_mfma_f32_16x16x32_bf16 v[128:131], v[120:123], v[24:27], 0
buffer_store_dwordx4 v[164:167], v44, s[56:59], s6 offen sc1
v_mfma_f32_16x16x32_bf16 v[132:135], v[124:127], v[24:27], 0
buffer_store_dwordx4 v[172:175], v45, s[56:59], s6 offen sc1
v_mfma_f32_16x16x32_bf16 v[200:203], a[136:139], v[224:227], v[200:203]
v_cvt_pk_bf16_f32 v176, v176, v177
v_cvt_pk_bf16_f32 v177, v178, v179
v_mfma_f32_16x16x32_bf16 v[204:207], a[140:143], v[224:227], v[204:207]
v_cvt_pk_bf16_f32 v178, v180, v181
v_cvt_pk_bf16_f32 v179, v182, v183
s_waitcnt lgkmcnt(2)
v_mfma_f32_16x16x32_bf16 v[192:195], a[144:147], v[228:231], v[192:195]
ds_write_b128 v245, v[176:179] offset:2048
v_cvt_pk_bf16_f32 v184, v184, v185
v_mfma_f32_16x16x32_bf16 v[196:199], a[148:151], v[228:231], v[196:199]
v_cvt_pk_bf16_f32 v185, v186, v187
v_cvt_pk_bf16_f32 v186, v188, v189
v_mfma_f32_16x16x32_bf16 v[200:203], a[152:155], v[228:231], v[200:203]
v_cvt_pk_bf16_f32 v187, v190, v191
ds_write_b128 v246, v[184:187] offset:2048
v_mfma_f32_16x16x32_bf16 v[204:207], a[156:159], v[228:231], v[204:207]
ds_read_b128 v[180:183], v247 offset:2048
ds_read_b128 v[188:191], v247 offset:3072
s_waitcnt vmcnt(4)
s_waitcnt lgkmcnt(5)
v_mfma_f32_16x16x32_bf16 v[192:195], a[160:163], v[208:211], v[192:195]
v_swap_b32 v50, v52
v_mfma_f32_16x16x32_bf16 v[196:199], a[164:167], v[208:211], v[196:199]
v_swap_b32 v51, v53
s_nop 1
v_mfma_f32_16x16x32_bf16 v[128:131], v[48:51], v[28:31], v[128:131]
s_waitcnt lgkmcnt(1)
buffer_store_dwordx4 v[180:183], v44, s[56:59], s7 offen sc1
v_mfma_f32_16x16x32_bf16 v[132:135], v[52:55], v[28:31], v[132:135]
s_waitcnt lgkmcnt(0)
buffer_store_dwordx4 v[188:191], v45, s[56:59], s7 offen sc1
v_mfma_f32_16x16x32_bf16 v[200:203], a[168:171], v[208:211], v[200:203]
v_mfma_f32_16x16x32_bf16 v[204:207], a[172:175], v[208:211], v[204:207]
v_mfma_f32_16x16x32_bf16 v[192:195], a[176:179], v[212:215], v[192:195]
v_mfma_f32_16x16x32_bf16 v[196:199], a[180:183], v[212:215], v[196:199]
v_mfma_f32_16x16x32_bf16 v[200:203], a[184:187], v[212:215], v[200:203]
v_mfma_f32_16x16x32_bf16 v[204:207], a[188:191], v[212:215], v[204:207]
s_waitcnt vmcnt(4)
v_swap_b32 v58, v60
v_swap_b32 v59, v61
s_nop 1
v_mfma_f32_16x16x32_bf16 v[128:131], v[56:59], v[32:35], v[128:131]
v_mfma_f32_16x16x32_bf16 v[132:135], v[60:63], v[32:35], v[132:135]
s_nop 6
v_mul_f32 v128, v128, v42
v_mul_f32 v129, v129, v42
v_mul_f32 v130, v130, v42
v_mul_f32 v131, v131, v42
v_mul_f32 v132, v132, v42
v_mul_f32 v133, v133, v42
v_mul_f32 v134, v134, v42
v_mul_f32 v135, v135, v42
v_cvt_pk_bf16_f32 v128, v128, v129
v_cvt_pk_bf16_f32 v129, v130, v131
v_cvt_pk_bf16_f32 v130, v132, v133
v_cvt_pk_bf16_f32 v131, v134, v135
ds_write_b128 v251, v[128:131] offset:20480
s_waitcnt lgkmcnt(0)
s_barrier
ds_read_b128 v[216:219], v252 offset:20480
ds_read_b128 v[220:223], v252 offset:21504
ds_read_b128 v[224:227], v252 offset:22528
ds_read_b128 v[228:231], v252 offset:23552
s_waitcnt lgkmcnt(3)
v_mfma_f32_16x16x32_bf16 v[192:195], a[192:195], v[216:219], v[192:195]
v_mfma_f32_16x16x32_bf16 v[196:199], a[196:199], v[216:219], v[196:199]
v_mfma_f32_16x16x32_bf16 v[200:203], a[200:203], v[216:219], v[200:203]
v_mfma_f32_16x16x32_bf16 v[204:207], a[204:207], v[216:219], v[204:207]
s_waitcnt lgkmcnt(2)
v_mfma_f32_16x16x32_bf16 v[192:195], a[208:211], v[220:223], v[192:195]
v_mfma_f32_16x16x32_bf16 v[196:199], a[212:215], v[220:223], v[196:199]
v_mfma_f32_16x16x32_bf16 v[200:203], a[216:219], v[220:223], v[200:203]
v_mfma_f32_16x16x32_bf16 v[204:207], a[220:223], v[220:223], v[204:207]
s_waitcnt lgkmcnt(1)
v_mfma_f32_16x16x32_bf16 v[192:195], a[224:227], v[224:227], v[192:195]
v_mfma_f32_16x16x32_bf16 v[196:199], a[228:231], v[224:227], v[196:199]
v_mfma_f32_16x16x32_bf16 v[200:203], a[232:235], v[224:227], v[200:203]
v_mfma_f32_16x16x32_bf16 v[204:207], a[236:239], v[224:227], v[204:207]
s_waitcnt lgkmcnt(0)
v_mfma_f32_16x16x32_bf16 v[192:195], a[240:243], v[228:231], v[192:195]
v_mfma_f32_16x16x32_bf16 v[196:199], a[244:247], v[228:231], v[196:199]
v_mfma_f32_16x16x32_bf16 v[200:203], a[248:251], v[228:231], v[200:203]
v_mfma_f32_16x16x32_bf16 v[204:207], a[252:255], v[228:231], v[204:207]
s_nop 4
v_cvt_pk_bf16_f32 v192, v192, v193
v_cvt_pk_bf16_f32 v193, v194, v195
v_cvt_pk_bf16_f32 v194, v196, v197
v_cvt_pk_bf16_f32 v195, v198, v199
ds_write_b128 v245, v[192:195] offset:4096
v_cvt_pk_bf16_f32 v200, v200, v201
v_cvt_pk_bf16_f32 v201, v202, v203
v_cvt_pk_bf16_f32 v202, v204, v205
v_cvt_pk_bf16_f32 v203, v206, v207
ds_write_b128 v246, v[200:203] offset:4096
ds_read_b128 v[196:199], v247 offset:4096
ds_read_b128 v[204:207], v247 offset:5120
s_waitcnt lgkmcnt(1)
buffer_store_dwordx4 v[196:199], v44, s[56:59], s29 offen sc1
s_waitcnt lgkmcnt(0)
buffer_store_dwordx4 v[204:207], v45, s[56:59], s29 offen sc1
s_branch L2_fin
LF_spinQ:
s_mov_b32 s94, 0x10000
LF_spin2Q:
buffer_load_dwordx2 v[248:249], v46, s[16:19], 0 offen offset:0 sc1
s_sub_u32 s94, s94, 1
s_waitcnt vmcnt(0)
s_cbranch_scc1 LF_spin2Q_go
v_cmp_ne_u64 vcc, s[98:99], v[248:249]
s_nop 1
s_cbranch_vccnz LF_spin2Q
LF_spin2Q_go:
s_branch LF_goQ
LF_wf:
s_mov_b32 s94, 0x10000
LF_wf2:
buffer_load_dwordx2 v[108:109], v110, s[16:19], 0 offen sc1
s_sub_u32 s94, s94, 1
s_waitcnt vmcnt(0)
s_cbranch_scc1 LF_wf2_go
v_cmp_ne_u64 vcc, s[98:99], v[108:109]
s_nop 1
s_cbranch_vccnz LF_wf2
LF_wf2_go:
s_branch LF_wf_go
LM_pb:
s_mov_b32 s3, 0x10000
LM_pb2:
buffer_load_dwordx2 v[228:229], v230, s[16:19], 0 offen sc1
s_sub_u32 s3, s3, 1
s_waitcnt vmcnt(0)
s_cbranch_scc1 LM_pb2_go
v_cmp_ne_u64 vcc, s[98:99], v[228:229]
s_nop 1
s_cbranch_vccnz LM_pb2
LM_pb2_go:
s_branch LM_pb_ret
L2_Fend:
LT_disp:
s_cmp_ge_i32 s36, 0
s_cbranch_scc1 LT_start
s_cmp_eq_u32 s34, 0
s_cbranch_scc1 L2_end
s_mov_b32 s41, s34
s_mul_i32 s40, s34, 6
s_add_u32 s40, s40, s37
s_add_u32 s40, s40, 42
s_cmp_lt_u32 s40, 64
s_cbranch_scc1 LE_common
s_branch L2_end
LT_start:
s_waitcnt lgkmcnt(0)
s_add_u32 s12, s4, 0x7c2a000
s_addc_u32 s13, s5, 0
s_mov_b32 s14, 0x8000
s_mov_b32 s15, 0x00020000
v_and_b32 v8, 63, v0
v_lshlrev_b32 v8, 7, v8
s_mov_b32 s91, 8192
s_mov_b32 s90, 16384
s_mov_b32 s95, 24576
v_min_u32 v9, 5248, v8
s_mov_b32 s94, 0x10000
LT_poll:
buffer_load_dwordx2 v[0:1], v8, s[12:15], 0 offen sc1
buffer_load_dwordx2 v[2:3], v8, s[12:15], s91 offen sc1
buffer_load_dwordx2 v[4:5], v8, s[12:15], s90 offen sc1
buffer_load_dwordx2 v[6:7], v9, s[12:15], s95 offen sc1
s_sub_u32 s94, s94, 1
s_waitcnt vmcnt(0)
s_cbranch_scc1 LT_poll_go
v_cmp_ne_u64 vcc, s[98:99], v[0:1]
s_nop 1
s_cbranch_vccnz LT_poll
v_cmp_ne_u64 vcc, s[98:99], v[2:3]
s_nop 1
s_cbranch_vccnz LT_poll
v_cmp_ne_u64 vcc, s[98:99], v[4:5]
s_nop 1
s_cbranch_vccnz LT_poll
v_cmp_ne_u64 vcc, s[98:99], v[6:7]
s_nop 1
s_cbranch_vccnz LT_poll
LT_poll_go:
s_add_u32 s31, s31, -22
s_add_u32 s3, s28, 409600
s_cmp_eq_u32 s36, 0
s_cselect_b32 s31, 26, s31
s_cselect_b32 s39, s39, s3
s_cselect_b32 s33, s33, 0
s_cselect_b32 s3, 0, 425984
s_add_u32 s28, s28, s3
s_add_u32 s12, s4, 0x6800000
s_addc_u32 s13, s5, 0
s_mov_b32 s14, 0x0
s_mov_b32 s15, 0x00020000
s_mov_b32 s14, s49
s_add_u32 s8, s4, 0x0
s_addc_u32 s9, s5, 0
s_mov_b32 s10, 0x4e4000
s_mov_b32 s11, 0x00020000
s_mov_b32 s40, 5111808
s_mov_b32 s44, 5115904
buffer_load_dwordx4 v[0:3], v243, s[8:11], s40 offen offset:0 sc1
buffer_load_dwordx4 v[4:7], v243, s[8:11], s40 offen offset:1024 sc1
buffer_load_dwordx4 v[8:11], v243, s[8:11], s40 offen offset:2048 sc1
buffer_load_dwordx4 v[12:15], v243, s[8:11], s40 offen offset:3072 sc1
buffer_load_dwordx4 v[16:19], v243, s[8:11], s44 offen offset:0 sc1
buffer_load_dwordx4 v[20:23], v243, s[8:11], s44 offen offset:1024 sc1
buffer_load_dwordx4 v[24:27], v243, s[8:11], s44 offen offset:2048 sc1
buffer_load_dwordx4 v[28:31], v243, s[8:11], s44 offen offset:3072 sc1
s_mov_b32 s53, 0
s_add_u32 m0, s53, 90112
s_add_u32 s54, s39, 0
buffer_load_dwordx4 v241, s[12:15], s54 offen offset:0 sc1 lds
buffer_load_dwordx4 v241, s[12:15], s54 offen offset:1024 sc1 lds
buffer_load_dwordx4 v241, s[12:15], s54 offen offset:2048 sc1 lds
buffer_load_dwordx4 v241, s[12:15], s54 offen offset:3072 sc1 lds
s_add_u32 m0, s53, 94208
s_add_u32 s54, s39, 128
buffer_load_dwordx4 v241, s[12:15], s54 offen offset:0 sc1 lds
buffer_load_dwordx4 v241, s[12:15], s54 offen offset:1024 sc1 lds
buffer_load_dwordx4 v241, s[12:15], s54 offen offset:2048 sc1 lds
buffer_load_dwordx4 v241, s[12:15], s54 offen offset:3072 sc1 lds
s_add_u32 m0, s53, 98304
s_add_u32 s54, s39, 256
buffer_load_dwordx4 v241, s[12:15], s54 offen offset:0 sc1 lds
buffer_load_dwordx4 v241, s[12:15], s54 offen offset:1024 sc1 lds
buffer_load_dwordx4 v241, s[12:15], s54 offen offset:2048 sc1 lds
buffer_load_dwordx4 v241, s[12:15], s54 offen offset:3072 sc1 lds
s_add_u32 m0, s53, 102400
s_add_u32 s54, s39, 384
buffer_load_dwordx4 v241, s[12:15], s54 offen offset:0 sc1 lds
buffer_load_dwordx4 v241, s[12:15], s54 offen offset:1024 sc1 lds
buffer_load_dwordx4 v241, s[12:15], s54 offen offset:2048 sc1 lds
buffer_load_dwordx4 v241, s[12:15], s54 offen offset:3072 sc1 lds
s_add_u32 s53, s53, 0x4000
s_and_b32 s53, s53, 0xffff
s_add_u32 m0, s53, 90112
s_add_u32 s54, s28, 0
buffer_load_dwordx4 v241, s[12:15], s54 offen offset:0 sc1 lds
buffer_load_dwordx4 v241, s[12:15], s54 offen offset:1024 sc1 lds
buffer_load_dwordx4 v241, s[12:15], s54 offen offset:2048 sc1 lds
buffer_load_dwordx4 v241, s[12:15], s54 offen offset:3072 sc1 lds
s_add_u32 m0, s53, 94208
s_add_u32 s54, s28, 128
buffer_load_dwordx4 v241, s[12:15], s54 offen offset:0 sc1 lds
buffer_load_dwordx4 v241, s[12:15], s54 offen offset:1024 sc1 lds
buffer_load_dwordx4 v241, s[12:15], s54 offen offset:2048 sc1 lds
buffer_load_dwordx4 v241, s[12:15], s54 offen offset:3072 sc1 lds
s_add_u32 m0, s53, 98304
s_add_u32 s54, s28, 256
buffer_load_dwordx4 v241, s[12:15], s54 offen offset:0 sc1 lds
buffer_load_dwordx4 v241, s[12:15], s54 offen offset:1024 sc1 lds
buffer_load_dwordx4 v241, s[12:15], s54 offen offset:2048 sc1 lds
buffer_load_dwordx4 v241, s[12:15], s54 offen offset:3072 sc1 lds
s_add_u32 m0, s53, 102400
s_add_u32 s54, s28, 384
buffer_load_dwordx4 v241, s[12:15], s54 offen offset:0 sc1 lds
buffer_load_dwordx4 v241, s[12:15], s54 offen offset:1024 sc1 lds
buffer_load_dwordx4 v241, s[12:15], s54 offen offset:2048 sc1 lds
buffer_load_dwordx4 v241, s[12:15], s54 offen offset:3072 sc1 lds
s_add_u32 s53, s53, 0x4000
s_and_b32 s53, s53, 0xffff
s_add_u32 s28, s28, 0x4000
s_add_u32 m0, s53, 90112
s_add_u32 s54, s28, 0
buffer_load_dwordx4 v241, s[12:15], s54 offen offset:0 sc1 lds
buffer_load_dwordx4 v241, s[12:15], s54 offen offset:1024 sc1 lds
buffer_load_dwordx4 v241, s[12:15], s54 offen offset:2048 sc1 lds
buffer_load_dwordx4 v241, s[12:15], s54 offen offset:3072 sc1 lds
s_add_u32 m0, s53, 94208
s_add_u32 s54, s28, 128
buffer_load_dwordx4 v241, s[12:15], s54 offen offset:0 sc1 lds
buffer_load_dwordx4 v241, s[12:15], s54 offen offset:1024 sc1 lds
buffer_load_dwordx4 v241, s[12:15], s54 offen offset:2048 sc1 lds
buffer_load_dwordx4 v241, s[12:15], s54 offen offset:3072 sc1 lds
s_add_u32 m0, s53, 98304
s_add_u32 s54, s28, 256
buffer_load_dwordx4 v241, s[12:15], s54 offen offset:0 sc1 lds
buffer_load_dwordx4 v241, s[12:15], s54 offen offset:1024 sc1 lds
buffer_load_dwordx4 v241, s[12:15], s54 offen offset:2048 sc1 lds
buffer_load_dwordx4 v241, s[12:15], s54 offen offset:3072 sc1 lds
s_add_u32 m0, s53, 102400
s_add_u32 s54, s28, 384
buffer_load_dwordx4 v241, s[12:15], s54 offen offset:0 sc1 lds
buffer_load_dwordx4 v241, s[12:15], s54 offen offset:1024 sc1 lds
buffer_load_dwordx4 v241, s[12:15], s54 offen offset:2048 sc1 lds
buffer_load_dwordx4 v241, s[12:15], s54 offen offset:3072 sc1 lds
s_add_u32 s53, s53, 0x4000
s_and_b32 s53, s53, 0xffff
s_add_u32 s28, s28, 0x4000
s_mul_i32 s35, s37, 0x600000
s_add_u32 s20, s4, 0x2000000
s_addc_u32 s21, s5, 0
s_add_u32 s20, s20, s35
s_addc_u32 s21, s21, 0
s_mov_b32 s22, 0x4e4000
s_mov_b32 s23, 0x00020000
s_add_u32 s24, s4, 0x6000000
s_addc_u32 s25, s5, 0
s_mov_b32 s26, 0x139000
s_mov_b32 s27, 0x00020000
s_lshl_b32 s48, s37, 3
s_add_u32 s48, s48, 638976
s_mov_b32 s48, 1277952
v_bfe_u32 v240, v243, 4, 3
v_lshlrev_b32 v240, 6, v240
v_bfe_u32 v242, v243, 7, 1
v_lshl_or_b32 v240, v242, 10, v240
v_bfe_u32 v242, v243, 8, 2
v_lshl_or_b32 v240, v242, 4, v240
v_bfe_u32 v242, v243, 6, 1
v_lshlrev_b32 v242, 5, v242
v_xor_b32 v240, v240, v242
v_and_b32 v246, 0x1c0, v243
v_bfe_u32 v242, v243, 9, 1
v_lshl_or_b32 v246, v242, 10, v246
v_bfe_u32 v242, v243, 8, 1
v_lshl_or_b32 v246, v242, 5, v246
v_bfe_u32 v242, v243, 4, 2
v_lshl_or_b32 v246, v242, 3, v246
v_xor_b32 v247, 32, v246
v_bfe_i32 v242, v243, 8, 1
v_and_b32 v192, s33, v242
v_and_b32 v193, s33, v242
v_and_b32 v194, s33, v242
v_and_b32 v195, s33, v242
s_add_u32 s51, s31, 0
s_mov_b32 s52, 90112
v_mov_b32 v172, 0xff800000
v_mov_b32 v173, 0
v_accvgpr_write_b32 a0, 0
v_accvgpr_write_b32 a1, 0
v_accvgpr_write_b32 a2, 0
v_accvgpr_write_b32 a3, 0
v_accvgpr_write_b32 a4, 0
v_accvgpr_write_b32 a5, 0
v_accvgpr_write_b32 a6, 0
v_accvgpr_write_b32 a7, 0
v_accvgpr_write_b32 a8, 0
v_accvgpr_write_b32 a9, 0
v_accvgpr_write_b32 a10, 0
v_accvgpr_write_b32 a11, 0
v_accvgpr_write_b32 a12, 0
v_accvgpr_write_b32 a13, 0
v_accvgpr_write_b32 a14, 0
v_accvgpr_write_b32 a15, 0
v_accvgpr_write_b32 a16, 0
v_accvgpr_write_b32 a17, 0
v_accvgpr_write_b32 a18, 0
v_accvgpr_write_b32 a19, 0
v_accvgpr_write_b32 a20, 0
v_accvgpr_write_b32 a21, 0
v_accvgpr_write_b32 a22, 0
v_accvgpr_write_b32 a23, 0
v_accvgpr_write_b32 a24, 0
v_accvgpr_write_b32 a25, 0
v_accvgpr_write_b32 a26, 0
v_accvgpr_write_b32 a27, 0
v_accvgpr_write_b32 a28, 0
v_accvgpr_write_b32 a29, 0
v_accvgpr_write_b32 a30, 0
v_accvgpr_write_b32 a31, 0
v_accvgpr_write_b32 a32, 0
v_accvgpr_write_b32 a33, 0
v_accvgpr_write_b32 a34, 0
v_accvgpr_write_b32 a35, 0
v_accvgpr_write_b32 a36, 0
v_accvgpr_write_b32 a37, 0
v_accvgpr_write_b32 a38, 0
v_accvgpr_write_b32 a39, 0
v_accvgpr_write_b32 a40, 0
v_accvgpr_write_b32 a41, 0
v_accvgpr_write_b32 a42, 0
v_accvgpr_write_b32 a43, 0
v_accvgpr_write_b32 a44, 0
v_accvgpr_write_b32 a45, 0
v_accvgpr_write_b32 a46, 0
v_accvgpr_write_b32 a47, 0
v_accvgpr_write_b32 a48, 0
v_accvgpr_write_b32 a49, 0
v_accvgpr_write_b32 a50, 0
v_accvgpr_write_b32 a51, 0
v_accvgpr_write_b32 a52, 0
v_accvgpr_write_b32 a53, 0
v_accvgpr_write_b32 a54, 0
v_accvgpr_write_b32 a55, 0
v_accvgpr_write_b32 a56, 0
v_accvgpr_write_b32 a57, 0
v_accvgpr_write_b32 a58, 0
v_accvgpr_write_b32 a59, 0
v_accvgpr_write_b32 a60, 0
v_accvgpr_write_b32 a61, 0
v_accvgpr_write_b32 a62, 0
v_accvgpr_write_b32 a63, 0
LT_loop:
s_add_u32 m0, s53, 90112
s_add_u32 s54, s28, 0
buffer_load_dwordx4 v241, s[12:15], s54 offen offset:0 sc1 lds
buffer_load_dwordx4 v241, s[12:15], s54 offen offset:1024 sc1 lds
buffer_load_dwordx4 v241, s[12:15], s54 offen offset:2048 sc1 lds
buffer_load_dwordx4 v241, s[12:15], s54 offen offset:3072 sc1 lds
s_add_u32 m0, s53, 94208
s_add_u32 s54, s28, 128
buffer_load_dwordx4 v241, s[12:15], s54 offen offset:0 sc1 lds
buffer_load_dwordx4 v241, s[12:15], s54 offen offset:1024 sc1 lds
buffer_load_dwordx4 v241, s[12:15], s54 offen offset:2048 sc1 lds
buffer_load_dwordx4 v241, s[12:15], s54 offen offset:3072 sc1 lds
s_add_u32 m0, s53, 98304
s_add_u32 s54, s28, 256
buffer_load_dwordx4 v241, s[12:15], s54 offen offset:0 sc1 lds
buffer_load_dwordx4 v241, s[12:15], s54 offen offset:1024 sc1 lds
buffer_load_dwordx4 v241, s[12:15], s54 offen offset:2048 sc1 lds
buffer_load_dwordx4 v241, s[12:15], s54 offen offset:3072 sc1 lds
s_add_u32 m0, s53, 102400
s_add_u32 s54, s28, 384
buffer_load_dwordx4 v241, s[12:15], s54 offen offset:0 sc1 lds
buffer_load_dwordx4 v241, s[12:15], s54 offen offset:1024 sc1 lds
buffer_load_dwordx4 v241, s[12:15], s54 offen offset:2048 sc1 lds
buffer_load_dwordx4 v241, s[12:15], s54 offen offset:3072 sc1 lds
s_add_u32 s53, s53, 0x4000
s_and_b32 s53, s53, 0xffff
s_add_u32 s28, s28, 0x4000
v_add_u32 v177, s52, v240
v_add_u32 v178, s52, v246
v_add_u32 v179, s52, v247
s_add_u32 s52, s52, 0x4000
s_cmp_eq_u32 s52, 155648
s_cselect_b32 s52, 90112, s52
s_waitcnt vmcnt(48)
ds_read_b128 v[32:35], v177 offset:0
ds_read_b128 v[64:67], v177 offset:2048
ds_read_b128 v[36:39], v177 offset:512
ds_read_b128 v[68:71], v177 offset:2560
ds_read_b128 v[40:43], v177 offset:4096
ds_read_b128 v[72:75], v177 offset:6144
ds_read_b128 v[44:47], v177 offset:4608
ds_read_b128 v[76:79], v177 offset:6656
ds_read_b128 v[48:51], v177 offset:8192
ds_read_b128 v[80:83], v177 offset:10240
ds_read_b128 v[52:55], v177 offset:8704
ds_read_b128 v[84:87], v177 offset:10752
ds_read_b128 v[56:59], v177 offset:12288
ds_read_b128 v[88:91], v177 offset:14336
ds_read_b128 v[60:63], v177 offset:12800
ds_read_b128 v[92:95], v177 offset:14848
s_waitcnt lgkmcnt(14)
v_mfma_f32_16x16x32_bf16 v[160:163], v[32:35], v[0:3], v[192:195]
v_mfma_f32_16x16x32_bf16 v[164:167], v[64:67], v[0:3], v[192:195]
s_waitcnt lgkmcnt(12)
v_mfma_f32_16x16x32_bf16 v[160:163], v[36:39], v[4:7], v[160:163]
v_mfma_f32_16x16x32_bf16 v[164:167], v[68:71], v[4:7], v[164:167]
s_waitcnt lgkmcnt(10)
v_mfma_f32_16x16x32_bf16 v[160:163], v[40:43], v[8:11], v[160:163]
v_mfma_f32_16x16x32_bf16 v[164:167], v[72:75], v[8:11], v[164:167]
s_waitcnt lgkmcnt(8)
v_mfma_f32_16x16x32_bf16 v[160:163], v[44:47], v[12:15], v[160:163]
v_mfma_f32_16x16x32_bf16 v[164:167], v[76:79], v[12:15], v[164:167]
s_waitcnt lgkmcnt(6)
v_mfma_f32_16x16x32_bf16 v[160:163], v[48:51], v[16:19], v[160:163]
v_mfma_f32_16x16x32_bf16 v[164:167], v[80:83], v[16:19], v[164:167]
s_waitcnt lgkmcnt(4)
v_mfma_f32_16x16x32_bf16 v[160:163], v[52:55], v[20:23], v[160:163]
v_mfma_f32_16x16x32_bf16 v[164:167], v[84:87], v[20:23], v[164:167]
s_waitcnt lgkmcnt(2)
v_mfma_f32_16x16x32_bf16 v[160:163], v[56:59], v[24:27], v[160:163]
v_mfma_f32_16x16x32_bf16 v[164:167], v[88:91], v[24:27], v[164:167]
s_waitcnt lgkmcnt(0)
v_mfma_f32_16x16x32_bf16 v[160:163], v[60:63], v[28:31], v[160:163]
v_mfma_f32_16x16x32_bf16 v[164:167], v[92:95], v[28:31], v[164:167]
ds_read_b64_tr_b16 v[96:97], v178 offset:0
ds_read_b64_tr_b16 v[98:99], v178 offset:2048
ds_read_b64_tr_b16 v[100:101], v179 offset:0
ds_read_b64_tr_b16 v[102:103], v179 offset:2048
ds_read_b64_tr_b16 v[104:105], v178 offset:512
ds_read_b64_tr_b16 v[106:107], v178 offset:2560
ds_read_b64_tr_b16 v[108:109], v179 offset:512
ds_read_b64_tr_b16 v[110:111], v179 offset:2560
ds_read_b64_tr_b16 v[112:113], v178 offset:4096
ds_read_b64_tr_b16 v[114:115], v178 offset:6144
ds_read_b64_tr_b16 v[116:117], v179 offset:4096
ds_read_b64_tr_b16 v[118:119], v179 offset:6144
ds_read_b64_tr_b16 v[120:121], v178 offset:4608
ds_read_b64_tr_b16 v[122:123], v178 offset:6656
ds_read_b64_tr_b16 v[124:125], v179 offset:4608
ds_read_b64_tr_b16 v[126:127], v179 offset:6656
ds_read_b64_tr_b16 v[128:129], v178 offset:8192
ds_read_b64_tr_b16 v[130:131], v178 offset:10240
ds_read_b64_tr_b16 v[132:133], v179 offset:8192
ds_read_b64_tr_b16 v[134:135], v179 offset:10240
ds_read_b64_tr_b16 v[136:137], v178 offset:8704
ds_read_b64_tr_b16 v[138:139], v178 offset:10752
ds_read_b64_tr_b16 v[140:141], v179 offset:8704
ds_read_b64_tr_b16 v[142:143], v179 offset:10752
ds_read_b64_tr_b16 v[144:145], v178 offset:12288
ds_read_b64_tr_b16 v[146:147], v178 offset:14336
ds_read_b64_tr_b16 v[148:149], v179 offset:12288
ds_read_b64_tr_b16 v[150:151], v179 offset:14336
ds_read_b64_tr_b16 v[152:153], v178 offset:12800
ds_read_b64_tr_b16 v[154:155], v178 offset:14848
ds_read_b64_tr_b16 v[156:157], v179 offset:12800
ds_read_b64_tr_b16 v[158:159], v179 offset:14848
v_mov_b32 v192, 0
v_mov_b32 v193, 0
v_mov_b32 v194, 0
v_mov_b32 v195, 0
s_nop 7
v_max3_f32 v175, v160, v161, v162
v_max3_f32 v175, v175, v163, v164
v_max3_f32 v175, v175, v165, v166
v_max3_f32 v175, v175, v167, v172
v_mov_b32 v176, v175
s_nop 1
v_permlane32_swap_b32 v175, v176
s_nop 1
v_max_f32 v175, v175, v176
v_mov_b32 v176, v175
s_nop 1
v_permlane16_swap_b32 v175, v176
s_nop 1
v_max_f32 v175, v175, v176
v_ceil_f32 v175, v175
v_sub_f32 v174, v172, v175
v_exp_f32 v174, v174
v_mov_b32 v172, v175
v_sub_f32 v160, v160, v172
v_sub_f32 v161, v161, v172
v_sub_f32 v162, v162, v172
v_sub_f32 v163, v163, v172
v_sub_f32 v164, v164, v172
v_sub_f32 v165, v165, v172
v_sub_f32 v166, v166, v172
v_sub_f32 v167, v167, v172
v_exp_f32 v160, v160
v_exp_f32 v161, v161
v_exp_f32 v162, v162
v_exp_f32 v163, v163
v_exp_f32 v164, v164
v_exp_f32 v165, v165
v_exp_f32 v166, v166
v_exp_f32 v167, v167
v_mul_f32 v173, v173, v174
v_cvt_pk_bf16_f32 v168, v160, v161
v_cvt_pk_bf16_f32 v169, v162, v163
v_cvt_pk_bf16_f32 v170, v164, v165
v_cvt_pk_bf16_f32 v171, v166, v167
v_cmp_neq_f32 vcc, 1.0, v174
v_add_f32 v173, v173, v160
v_add_f32 v173, v173, v161
v_add_f32 v173, v173, v162
v_add_f32 v173, v173, v163
v_add_f32 v173, v173, v164
v_add_f32 v173, v173, v165
v_add_f32 v173, v173, v166
v_add_f32 v173, v173, v167
s_cbranch_vccz LT_nors
v_lshrrev_b32 v176, 4, v243
v_and_b32 v176, 0x30, v176
ds_bpermute_b32 v188, v176, v174 offset:0
ds_bpermute_b32 v189, v176, v174 offset:4
ds_bpermute_b32 v190, v176, v174 offset:8
ds_bpermute_b32 v191, v176, v174 offset:12
s_waitcnt lgkmcnt(0)
v_accvgpr_read_b32 v180, a0
v_accvgpr_read_b32 v181, a1
v_accvgpr_read_b32 v182, a2
v_accvgpr_read_b32 v183, a3
v_accvgpr_read_b32 v184, a4
v_accvgpr_read_b32 v185, a5
v_accvgpr_read_b32 v186, a6
v_accvgpr_read_b32 v187, a7
v_mul_f32 v180, v180, v188
v_mul_f32 v181, v181, v189
v_mul_f32 v182, v182, v190
v_mul_f32 v183, v183, v191
v_mul_f32 v184, v184, v188
v_mul_f32 v185, v185, v189
v_mul_f32 v186, v186, v190
v_mul_f32 v187, v187, v191
v_accvgpr_write_b32 a0, v180
v_accvgpr_write_b32 a1, v181
v_accvgpr_write_b32 a2, v182
v_accvgpr_write_b32 a3, v183
v_accvgpr_write_b32 a4, v184
v_accvgpr_write_b32 a5, v185
v_accvgpr_write_b32 a6, v186
v_accvgpr_write_b32 a7, v187
v_accvgpr_read_b32 v180, a8
v_accvgpr_read_b32 v181, a9
v_accvgpr_read_b32 v182, a10
v_accvgpr_read_b32 v183, a11
v_accvgpr_read_b32 v184, a12
v_accvgpr_read_b32 v185, a13
v_accvgpr_read_b32 v186, a14
v_accvgpr_read_b32 v187, a15
v_mul_f32 v180, v180, v188
v_mul_f32 v181, v181, v189
v_mul_f32 v182, v182, v190
v_mul_f32 v183, v183, v191
v_mul_f32 v184, v184, v188
v_mul_f32 v185, v185, v189
v_mul_f32 v186, v186, v190
v_mul_f32 v187, v187, v191
v_accvgpr_write_b32 a8, v180
v_accvgpr_write_b32 a9, v181
v_accvgpr_write_b32 a10, v182
v_accvgpr_write_b32 a11, v183
v_accvgpr_write_b32 a12, v184
v_accvgpr_write_b32 a13, v185
v_accvgpr_write_b32 a14, v186
v_accvgpr_write_b32 a15, v187
v_accvgpr_read_b32 v180, a16
v_accvgpr_read_b32 v181, a17
v_accvgpr_read_b32 v182, a18
v_accvgpr_read_b32 v183, a19
v_accvgpr_read_b32 v184, a20
v_accvgpr_read_b32 v185, a21
v_accvgpr_read_b32 v186, a22
v_accvgpr_read_b32 v187, a23
v_mul_f32 v180, v180, v188
v_mul_f32 v181, v181, v189
v_mul_f32 v182, v182, v190
v_mul_f32 v183, v183, v191
v_mul_f32 v184, v184, v188
v_mul_f32 v185, v185, v189
v_mul_f32 v186, v186, v190
v_mul_f32 v187, v187, v191
v_accvgpr_write_b32 a16, v180
v_accvgpr_write_b32 a17, v181
v_accvgpr_write_b32 a18, v182
v_accvgpr_write_b32 a19, v183
v_accvgpr_write_b32 a20, v184
v_accvgpr_write_b32 a21, v185
v_accvgpr_write_b32 a22, v186
v_accvgpr_write_b32 a23, v187
v_accvgpr_read_b32 v180, a24
v_accvgpr_read_b32 v181, a25
v_accvgpr_read_b32 v182, a26
v_accvgpr_read_b32 v183, a27
v_accvgpr_read_b32 v184, a28
v_accvgpr_read_b32 v185, a29
v_accvgpr_read_b32 v186, a30
v_accvgpr_read_b32 v187, a31
v_mul_f32 v180, v180, v188
v_mul_f32 v181, v181, v189
v_mul_f32 v182, v182, v190
v_mul_f32 v183, v183, v191
v_mul_f32 v184, v184, v188
v_mul_f32 v185, v185, v189
v_mul_f32 v186, v186, v190
v_mul_f32 v187, v187, v191
v_accvgpr_write_b32 a24, v180
v_accvgpr_write_b32 a25, v181
v_accvgpr_write_b32 a26, v182
v_accvgpr_write_b32 a27, v183
v_accvgpr_write_b32 a28, v184
v_accvgpr_write_b32 a29, v185
v_accvgpr_write_b32 a30, v186
v_accvgpr_write_b32 a31, v187
v_accvgpr_read_b32 v180, a32
v_accvgpr_read_b32 v181, a33
v_accvgpr_read_b32 v182, a34
v_accvgpr_read_b32 v183, a35
v_accvgpr_read_b32 v184, a36
v_accvgpr_read_b32 v185, a37
v_accvgpr_read_b32 v186, a38
v_accvgpr_read_b32 v187, a39
v_mul_f32 v180, v180, v188
v_mul_f32 v181, v181, v189
v_mul_f32 v182, v182, v190
v_mul_f32 v183, v183, v191
v_mul_f32 v184, v184, v188
v_mul_f32 v185, v185, v189
v_mul_f32 v186, v186, v190
v_mul_f32 v187, v187, v191
v_accvgpr_write_b32 a32, v180
v_accvgpr_write_b32 a33, v181
v_accvgpr_write_b32 a34, v182
v_accvgpr_write_b32 a35, v183
v_accvgpr_write_b32 a36, v184
v_accvgpr_write_b32 a37, v185
v_accvgpr_write_b32 a38, v186
v_accvgpr_write_b32 a39, v187
v_accvgpr_read_b32 v180, a40
v_accvgpr_read_b32 v181, a41
v_accvgpr_read_b32 v182, a42
v_accvgpr_read_b32 v183, a43
v_accvgpr_read_b32 v184, a44
v_accvgpr_read_b32 v185, a45
v_accvgpr_read_b32 v186, a46
v_accvgpr_read_b32 v187, a47
v_mul_f32 v180, v180, v188
v_mul_f32 v181, v181, v189
v_mul_f32 v182, v182, v190
v_mul_f32 v183, v183, v191
v_mul_f32 v184, v184, v188
v_mul_f32 v185, v185, v189
v_mul_f32 v186, v186, v190
v_mul_f32 v187, v187, v191
v_accvgpr_write_b32 a40, v180
v_accvgpr_write_b32 a41, v181
v_accvgpr_write_b32 a42, v182
v_accvgpr_write_b32 a43, v183
v_accvgpr_write_b32 a44, v184
v_accvgpr_write_b32 a45, v185
v_accvgpr_write_b32 a46, v186
v_accvgpr_write_b32 a47, v187
v_accvgpr_read_b32 v180, a48
v_accvgpr_read_b32 v181, a49
v_accvgpr_read_b32 v182, a50
v_accvgpr_read_b32 v183, a51
v_accvgpr_read_b32 v184, a52
v_accvgpr_read_b32 v185, a53
v_accvgpr_read_b32 v186, a54
v_accvgpr_read_b32 v187, a55
v_mul_f32 v180, v180, v188
v_mul_f32 v181, v181, v189
v_mul_f32 v182, v182, v190
v_mul_f32 v183, v183, v191
v_mul_f32 v184, v184, v188
v_mul_f32 v185, v185, v189
v_mul_f32 v186, v186, v190
v_mul_f32 v187, v187, v191
v_accvgpr_write_b32 a48, v180
v_accvgpr_write_b32 a49, v181
v_accvgpr_write_b32 a50, v182
v_accvgpr_write_b32 a51, v183
v_accvgpr_write_b32 a52, v184
v_accvgpr_write_b32 a53, v185
v_accvgpr_write_b32 a54, v186
v_accvgpr_write_b32 a55, v187
v_accvgpr_read_b32 v180, a56
v_accvgpr_read_b32 v181, a57
v_accvgpr_read_b32 v182, a58
v_accvgpr_read_b32 v183, a59
v_accvgpr_read_b32 v184, a60
v_accvgpr_read_b32 v185, a61
v_accvgpr_read_b32 v186, a62
v_accvgpr_read_b32 v187, a63
v_mul_f32 v180, v180, v188
v_mul_f32 v181, v181, v189
v_mul_f32 v182, v182, v190
v_mul_f32 v183, v183, v191
v_mul_f32 v184, v184, v188
v_mul_f32 v185, v185, v189
v_mul_f32 v186, v186, v190
v_mul_f32 v187, v187, v191
v_accvgpr_write_b32 a56, v180
v_accvgpr_write_b32 a57, v181
v_accvgpr_write_b32 a58, v182
v_accvgpr_write_b32 a59, v183
v_accvgpr_write_b32 a60, v184
v_accvgpr_write_b32 a61, v185
v_accvgpr_write_b32 a62, v186
v_accvgpr_write_b32 a63, v187
LT_nors:
s_waitcnt lgkmcnt(0)
s_nop 1
v_mfma_f32_16x16x32_bf16 a[0:3], v[168:171], v[96:99], a[0:3]
v_mfma_f32_16x16x32_bf16 a[4:7], v[168:171], v[100:103], a[4:7]
v_mfma_f32_16x16x32_bf16 a[8:11], v[168:171], v[104:107], a[8:11]
v_mfma_f32_16x16x32_bf16 a[12:15], v[168:171], v[108:111], a[12:15]
v_mfma_f32_16x16x32_bf16 a[16:19], v[168:171], v[112:115], a[16:19]
v_mfma_f32_16x16x32_bf16 a[20:23], v[168:171], v[116:119], a[20:23]
v_mfma_f32_16x16x32_bf16 a[24:27], v[168:171], v[120:123], a[24:27]
v_mfma_f32_16x16x32_bf16 a[28:31], v[168:171], v[124:127], a[28:31]
v_mfma_f32_16x16x32_bf16 a[32:35], v[168:171], v[128:131], a[32:35]
v_mfma_f32_16x16x32_bf16 a[36:39], v[168:171], v[132:135], a[36:39]
v_mfma_f32_16x16x32_bf16 a[40:43], v[168:171], v[136:139], a[40:43]
v_mfma_f32_16x16x32_bf16 a[44:47], v[168:171], v[140:143], a[44:47]
v_mfma_f32_16x16x32_bf16 a[48:51], v[168:171], v[144:147], a[48:51]
v_mfma_f32_16x16x32_bf16 a[52:55], v[168:171], v[148:151], a[52:55]
v_mfma_f32_16x16x32_bf16 a[56:59], v[168:171], v[152:155], a[56:59]
v_mfma_f32_16x16x32_bf16 a[60:63], v[168:171], v[156:159], a[60:63]
s_sub_u32 s51, s51, 1
s_cmp_lg_u32 s51, 0
s_cbranch_scc1 LT_loop
s_nop 15
s_add_u32 s16, s4, 0x0
s_addc_u32 s17, s5, 0
s_mov_b32 s18, 0x10000000
s_mov_b32 s19, 0x00020000
s_mul_i32 s52, s37, 0x5000
s_add_u32 s52, s52, 0x1200000
s_add_u32 s53, s37, 1610
s_lshl_b32 s53, s53, 7
s_add_u32 s53, s53, 0x7c00000
s_waitcnt vmcnt(0)
s_cmp_eq_u32 s36, 0
s_cbranch_scc1 LT_merge
buffer_store_dwordx4 a[0:3], v243, s[16:19], s52 offen offset:0 sc1
buffer_store_dwordx4 a[4:7], v243, s[16:19], s52 offen offset:1024 sc1
buffer_store_dwordx4 a[8:11], v243, s[16:19], s52 offen offset:2048 sc1
buffer_store_dwordx4 a[12:15], v243, s[16:19], s52 offen offset:3072 sc1
s_add_u32 s52, s52, 4096
buffer_store_dwordx4 a[16:19], v243, s[16:19], s52 offen offset:0 sc1
buffer_store_dwordx4 a[20:23], v243, s[16:19], s52 offen offset:1024 sc1
buffer_store_dwordx4 a[24:27], v243, s[16:19], s52 offen offset:2048 sc1
buffer_store_dwordx4 a[28:31], v243, s[16:19], s52 offen offset:3072 sc1
s_add_u32 s52, s52, 4096
buffer_store_dwordx4 a[32:35], v243, s[16:19], s52 offen offset:0 sc1
buffer_store_dwordx4 a[36:39], v243, s[16:19], s52 offen offset:1024 sc1
buffer_store_dwordx4 a[40:43], v243, s[16:19], s52 offen offset:2048 sc1
buffer_store_dwordx4 a[44:47], v243, s[16:19], s52 offen offset:3072 sc1
s_add_u32 s52, s52, 4096
buffer_store_dwordx4 a[48:51], v243, s[16:19], s52 offen offset:0 sc1
buffer_store_dwordx4 a[52:55], v243, s[16:19], s52 offen offset:1024 sc1
buffer_store_dwordx4 a[56:59], v243, s[16:19], s52 offen offset:2048 sc1
buffer_store_dwordx4 a[60:63], v243, s[16:19], s52 offen offset:3072 sc1
s_add_u32 s52, s52, 4096
buffer_store_dwordx2 v[172:173], v243, s[16:19], s52 offen sc1
s_waitcnt vmcnt(0)
v_mov_b32 v176, s98
v_mov_b32 v177, s99
s_mov_b64 exec, 1
buffer_store_dwordx2 v[176:177], off, s[16:19], s53 sc1
s_mov_b64 exec, -1
s_branch L2_fin
LT_merge:
s_mov_b32 s94, 0x10000
LT_mw:
buffer_load_dwordx2 v[0:1], off, s[16:19], s53 sc1
s_sub_u32 s94, s94, 1
s_waitcnt vmcnt(0)
s_cbranch_scc1 LT_mw_go
v_cmp_ne_u64 vcc, s[98:99], v[0:1]
s_nop 1
s_cbranch_vccnz LT_mw
LT_mw_go:
buffer_load_dwordx4 v[96:99], v243, s[16:19], s52 offen offset:0 sc1
buffer_load_dwordx4 v[100:103], v243, s[16:19], s52 offen offset:1024 sc1
buffer_load_dwordx4 v[104:107], v243, s[16:19], s52 offen offset:2048 sc1
buffer_load_dwordx4 v[108:111], v243, s[16:19], s52 offen offset:3072 sc1
s_add_u32 s52, s52, 4096
buffer_load_dwordx4 v[112:115], v243, s[16:19], s52 offen offset:0 sc1
buffer_load_dwordx4 v[116:119], v243, s[16:19], s52 offen offset:1024 sc1
buffer_load_dwordx4 v[120:123], v243, s[16:19], s52 offen offset:2048 sc1
buffer_load_dwordx4 v[124:127], v243, s[16:19], s52 offen offset:3072 sc1
s_add_u32 s52, s52, 4096
buffer_load_dwordx4 v[128:131], v243, s[16:19], s52 offen offset:0 sc1
buffer_load_dwordx4 v[132:135], v243, s[16:19], s52 offen offset:1024 sc1
buffer_load_dwordx4 v[136:139], v243, s[16:19], s52 offen offset:2048 sc1
buffer_load_dwordx4 v[140:143], v243, s[16:19], s52 offen offset:3072 sc1
s_add_u32 s52, s52, 4096
buffer_load_dwordx4 v[144:147], v243, s[16:19], s52 offen offset:0 sc1
buffer_load_dwordx4 v[148:151], v243, s[16:19], s52 offen offset:1024 sc1
buffer_load_dwordx4 v[152:155], v243, s[16:19], s52 offen offset:2048 sc1
buffer_load_dwordx4 v[156:159], v243, s[16:19], s52 offen offset:3072 sc1
s_add_u32 s52, s52, 4096
buffer_load_dwordx2 v[0:1], v243, s[16:19], s52 offen sc1
v_lshrrev_b32 v176, 4, v243
v_and_b32 v176, 0x30, v176
s_waitcnt vmcnt(0)
v_max_f32 v175, v172, v0
v_sub_f32 v2, v172, v175
v_sub_f32 v3, v0, v175
v_mov_b32 v172, v175
v_exp_f32 v2, v2
v_exp_f32 v3, v3
s_nop 0
v_mul_f32 v173, v173, v2
v_fmac_f32 v173, v1, v3
ds_bpermute_b32 v4, v176, v2 offset:0
ds_bpermute_b32 v8, v176, v3 offset:0
ds_bpermute_b32 v5, v176, v2 offset:4
ds_bpermute_b32 v9, v176, v3 offset:4
ds_bpermute_b32 v6, v176, v2 offset:8
ds_bpermute_b32 v10, v176, v3 offset:8
ds_bpermute_b32 v7, v176, v2 offset:12
ds_bpermute_b32 v11, v176, v3 offset:12
s_waitcnt lgkmcnt(0)
v_accvgpr_read_b32 v180, a0
v_accvgpr_read_b32 v181, a1
v_accvgpr_read_b32 v182, a2
v_accvgpr_read_b32 v183, a3
v_accvgpr_read_b32 v184, a4
v_accvgpr_read_b32 v185, a5
v_accvgpr_read_b32 v186, a6
v_accvgpr_read_b32 v187, a7
v_mul_f32 v180, v180, v4
v_mul_f32 v181, v181, v5
v_mul_f32 v182, v182, v6
v_mul_f32 v183, v183, v7
v_mul_f32 v184, v184, v4
v_mul_f32 v185, v185, v5
v_mul_f32 v186, v186, v6
v_mul_f32 v187, v187, v7
v_fmac_f32 v180, v96, v8
v_fmac_f32 v181, v97, v9
v_fmac_f32 v182, v98, v10
v_fmac_f32 v183, v99, v11
v_fmac_f32 v184, v100, v8
v_fmac_f32 v185, v101, v9
v_fmac_f32 v186, v102, v10
v_fmac_f32 v187, v103, v11
v_cvt_pk_bf16_f32 v32, v180, v181
v_cvt_pk_bf16_f32 v33, v182, v183
v_cvt_pk_bf16_f32 v34, v184, v185
v_cvt_pk_bf16_f32 v35, v186, v187
buffer_store_dwordx4 v[32:35], v243, s[20:23], s40 offen offset:0 sc1
v_accvgpr_read_b32 v180, a8
v_accvgpr_read_b32 v181, a9
v_accvgpr_read_b32 v182, a10
v_accvgpr_read_b32 v183, a11
v_accvgpr_read_b32 v184, a12
v_accvgpr_read_b32 v185, a13
v_accvgpr_read_b32 v186, a14
v_accvgpr_read_b32 v187, a15
v_mul_f32 v180, v180, v4
v_mul_f32 v181, v181, v5
v_mul_f32 v182, v182, v6
v_mul_f32 v183, v183, v7
v_mul_f32 v184, v184, v4
v_mul_f32 v185, v185, v5
v_mul_f32 v186, v186, v6
v_mul_f32 v187, v187, v7
v_fmac_f32 v180, v104, v8
v_fmac_f32 v181, v105, v9
v_fmac_f32 v182, v106, v10
v_fmac_f32 v183, v107, v11
v_fmac_f32 v184, v108, v8
v_fmac_f32 v185, v109, v9
v_fmac_f32 v186, v110, v10
v_fmac_f32 v187, v111, v11
v_cvt_pk_bf16_f32 v36, v180, v181
v_cvt_pk_bf16_f32 v37, v182, v183
v_cvt_pk_bf16_f32 v38, v184, v185
v_cvt_pk_bf16_f32 v39, v186, v187
buffer_store_dwordx4 v[36:39], v243, s[20:23], s40 offen offset:1024 sc1
v_accvgpr_read_b32 v180, a16
v_accvgpr_read_b32 v181, a17
v_accvgpr_read_b32 v182, a18
v_accvgpr_read_b32 v183, a19
v_accvgpr_read_b32 v184, a20
v_accvgpr_read_b32 v185, a21
v_accvgpr_read_b32 v186, a22
v_accvgpr_read_b32 v187, a23
v_mul_f32 v180, v180, v4
v_mul_f32 v181, v181, v5
v_mul_f32 v182, v182, v6
v_mul_f32 v183, v183, v7
v_mul_f32 v184, v184, v4
v_mul_f32 v185, v185, v5
v_mul_f32 v186, v186, v6
v_mul_f32 v187, v187, v7
v_fmac_f32 v180, v112, v8
v_fmac_f32 v181, v113, v9
v_fmac_f32 v182, v114, v10
v_fmac_f32 v183, v115, v11
v_fmac_f32 v184, v116, v8
v_fmac_f32 v185, v117, v9
v_fmac_f32 v186, v118, v10
v_fmac_f32 v187, v119, v11
v_cvt_pk_bf16_f32 v40, v180, v181
v_cvt_pk_bf16_f32 v41, v182, v183
v_cvt_pk_bf16_f32 v42, v184, v185
v_cvt_pk_bf16_f32 v43, v186, v187
buffer_store_dwordx4 v[40:43], v243, s[20:23], s40 offen offset:2048 sc1
v_accvgpr_read_b32 v180, a24
v_accvgpr_read_b32 v181, a25
v_accvgpr_read_b32 v182, a26
v_accvgpr_read_b32 v183, a27
v_accvgpr_read_b32 v184, a28
v_accvgpr_read_b32 v185, a29
v_accvgpr_read_b32 v186, a30
v_accvgpr_read_b32 v187, a31
v_mul_f32 v180, v180, v4
v_mul_f32 v181, v181, v5
v_mul_f32 v182, v182, v6
v_mul_f32 v183, v183, v7
v_mul_f32 v184, v184, v4
v_mul_f32 v185, v185, v5
v_mul_f32 v186, v186, v6
v_mul_f32 v187, v187, v7
v_fmac_f32 v180, v120, v8
v_fmac_f32 v181, v121, v9
v_fmac_f32 v182, v122, v10
v_fmac_f32 v183, v123, v11
v_fmac_f32 v184, v124, v8
v_fmac_f32 v185, v125, v9
v_fmac_f32 v186, v126, v10
v_fmac_f32 v187, v127, v11
v_cvt_pk_bf16_f32 v44, v180, v181
v_cvt_pk_bf16_f32 v45, v182, v183
v_cvt_pk_bf16_f32 v46, v184, v185
v_cvt_pk_bf16_f32 v47, v186, v187
buffer_store_dwordx4 v[44:47], v243, s[20:23], s40 offen offset:3072 sc1
v_accvgpr_read_b32 v180, a32
v_accvgpr_read_b32 v181, a33
v_accvgpr_read_b32 v182, a34
v_accvgpr_read_b32 v183, a35
v_accvgpr_read_b32 v184, a36
v_accvgpr_read_b32 v185, a37
v_accvgpr_read_b32 v186, a38
v_accvgpr_read_b32 v187, a39
v_mul_f32 v180, v180, v4
v_mul_f32 v181, v181, v5
v_mul_f32 v182, v182, v6
v_mul_f32 v183, v183, v7
v_mul_f32 v184, v184, v4
v_mul_f32 v185, v185, v5
v_mul_f32 v186, v186, v6
v_mul_f32 v187, v187, v7
v_fmac_f32 v180, v128, v8
v_fmac_f32 v181, v129, v9
v_fmac_f32 v182, v130, v10
v_fmac_f32 v183, v131, v11
v_fmac_f32 v184, v132, v8
v_fmac_f32 v185, v133, v9
v_fmac_f32 v186, v134, v10
v_fmac_f32 v187, v135, v11
v_cvt_pk_bf16_f32 v48, v180, v181
v_cvt_pk_bf16_f32 v49, v182, v183
v_cvt_pk_bf16_f32 v50, v184, v185
v_cvt_pk_bf16_f32 v51, v186, v187
buffer_store_dwordx4 v[48:51], v243, s[20:23], s44 offen offset:0 sc1
v_accvgpr_read_b32 v180, a40
v_accvgpr_read_b32 v181, a41
v_accvgpr_read_b32 v182, a42
v_accvgpr_read_b32 v183, a43
v_accvgpr_read_b32 v184, a44
v_accvgpr_read_b32 v185, a45
v_accvgpr_read_b32 v186, a46
v_accvgpr_read_b32 v187, a47
v_mul_f32 v180, v180, v4
v_mul_f32 v181, v181, v5
v_mul_f32 v182, v182, v6
v_mul_f32 v183, v183, v7
v_mul_f32 v184, v184, v4
v_mul_f32 v185, v185, v5
v_mul_f32 v186, v186, v6
v_mul_f32 v187, v187, v7
v_fmac_f32 v180, v136, v8
v_fmac_f32 v181, v137, v9
v_fmac_f32 v182, v138, v10
v_fmac_f32 v183, v139, v11
v_fmac_f32 v184, v140, v8
v_fmac_f32 v185, v141, v9
v_fmac_f32 v186, v142, v10
v_fmac_f32 v187, v143, v11
v_cvt_pk_bf16_f32 v52, v180, v181
v_cvt_pk_bf16_f32 v53, v182, v183
v_cvt_pk_bf16_f32 v54, v184, v185
v_cvt_pk_bf16_f32 v55, v186, v187
buffer_store_dwordx4 v[52:55], v243, s[20:23], s44 offen offset:1024 sc1
v_accvgpr_read_b32 v180, a48
v_accvgpr_read_b32 v181, a49
v_accvgpr_read_b32 v182, a50
v_accvgpr_read_b32 v183, a51
v_accvgpr_read_b32 v184, a52
v_accvgpr_read_b32 v185, a53
v_accvgpr_read_b32 v186, a54
v_accvgpr_read_b32 v187, a55
v_mul_f32 v180, v180, v4
v_mul_f32 v181, v181, v5
v_mul_f32 v182, v182, v6
v_mul_f32 v183, v183, v7
v_mul_f32 v184, v184, v4
v_mul_f32 v185, v185, v5
v_mul_f32 v186, v186, v6
v_mul_f32 v187, v187, v7
v_fmac_f32 v180, v144, v8
v_fmac_f32 v181, v145, v9
v_fmac_f32 v182, v146, v10
v_fmac_f32 v183, v147, v11
v_fmac_f32 v184, v148, v8
v_fmac_f32 v185, v149, v9
v_fmac_f32 v186, v150, v10
v_fmac_f32 v187, v151, v11
v_cvt_pk_bf16_f32 v56, v180, v181
v_cvt_pk_bf16_f32 v57, v182, v183
v_cvt_pk_bf16_f32 v58, v184, v185
v_cvt_pk_bf16_f32 v59, v186, v187
buffer_store_dwordx4 v[56:59], v243, s[20:23], s44 offen offset:2048 sc1
v_accvgpr_read_b32 v180, a56
v_accvgpr_read_b32 v181, a57
v_accvgpr_read_b32 v182, a58
v_accvgpr_read_b32 v183, a59
v_accvgpr_read_b32 v184, a60
v_accvgpr_read_b32 v185, a61
v_accvgpr_read_b32 v186, a62
v_accvgpr_read_b32 v187, a63
v_mul_f32 v180, v180, v4
v_mul_f32 v181, v181, v5
v_mul_f32 v182, v182, v6
v_mul_f32 v183, v183, v7
v_mul_f32 v184, v184, v4
v_mul_f32 v185, v185, v5
v_mul_f32 v186, v186, v6
v_mul_f32 v187, v187, v7
v_fmac_f32 v180, v152, v8
v_fmac_f32 v181, v153, v9
v_fmac_f32 v182, v154, v10
v_fmac_f32 v183, v155, v11
v_fmac_f32 v184, v156, v8
v_fmac_f32 v185, v157, v9
v_fmac_f32 v186, v158, v10
v_fmac_f32 v187, v159, v11
v_cvt_pk_bf16_f32 v60, v180, v181
v_cvt_pk_bf16_f32 v61, v182, v183
v_cvt_pk_bf16_f32 v62, v184, v185
v_cvt_pk_bf16_f32 v63, v186, v187
buffer_store_dwordx4 v[60:63], v243, s[20:23], s44 offen offset:3072 sc1
v_mov_b32 v176, v173
s_nop 1
v_permlane32_swap_b32 v173, v176
s_nop 1
v_add_f32 v173, v173, v176
v_mov_b32 v176, v173
s_nop 1
v_permlane16_swap_b32 v173, v176
s_nop 1
v_add_f32 v173, v173, v176
v_lshlrev_b32 v175, 2, v243
s_mov_b64 exec, 0xffff
s_mov_b64 exec, -1
v_bfe_u32 v175, v243, 8, 1
v_mul_u32_u24 v175, 768, v175
v_lshl_add_u32 v175, s37, 7, v175
v_bfe_u32 v176, v243, 4, 4
v_lshl_add_u32 v175, v176, 3, v175
s_mov_b32 exec_hi, 0
buffer_store_dwordx2 v[172:173], v175, s[24:27], s48 offen sc1
s_add_u32 s16, s4, 0x7c00000
s_addc_u32 s17, s5, 0
s_mov_b32 s18, 0x40000
s_mov_b32 s19, 0x00020000
s_add_u32 s48, s37, 1248
s_mul_i32 s48, s48, 128
s_waitcnt vmcnt(0)
v_mov_b32 v176, s98
v_mov_b32 v177, s99
s_mov_b64 exec, 1
buffer_store_dwordx2 v[176:177], off, s[16:19], s48 sc1
buffer_store_dwordx2 v[176:177], off, s[16:19], s48 offset:8 sc1
s_mov_b64 exec, -1
s_branch L2_fin
LE_start:
s_cmp_ge_u32 s37, 32
s_cbranch_scc1 L2_end
v_lshrrev_b32 v1, 6, v0
s_sub_u32 s37, s37, 30
s_lshl_b32 s35, s35, 1
v_readfirstlane_b32 s41, v1
s_add_u32 s35, s35, s37
s_mul_i32 s35, s35, 3
s_add_u32 s40, s35, s41
s_cmp_ge_u32 s41, 3
s_cbranch_scc1 L2_end
LE_common:
v_and_b32 v1, 63, v0
s_sub_u32 s36, s40, 0
s_mov_b32 s54, 151
s_mul_i32 s36, s36, 151
s_mov_b32 s55, s36
s_sub_u32 s36, s40, 36
s_cselect_b32 s54, s54, 166
s_mul_i32 s36, s36, 166
s_add_u32 s36, s36, 5436
s_cmp_lt_u32 s40, 36
s_cselect_b32 s55, s55, s36
s_sub_u32 s36, s40, 42
s_cselect_b32 s54, s54, 152
s_mul_i32 s36, s36, 152
s_add_u32 s36, s36, 6432
s_cmp_lt_u32 s40, 42
s_cselect_b32 s55, s55, s36
s_sub_u32 s36, s40, 48
s_cselect_b32 s54, s54, 168
s_mul_i32 s36, s36, 168
s_add_u32 s36, s36, 7344
s_cmp_lt_u32 s40, 48
s_cselect_b32 s55, s55, s36
s_mov_b32 s42, 0
s_mov_b32 s49, 512
v_lshrrev_b32 v33, 2, v1
v_and_b32 v34, 3, v1
v_mul_u32_u24 v6, 0x400, v33
v_lshl_add_u32 v6, v34, 4, v6
v_lshlrev_b32 v33, 2, v33
s_mul_i32 s50, s40, 16384
s_mul_i32 s48, s40, 64
s_waitcnt lgkmcnt(0)
s_add_u32 s8, s4, 0x7c31800
s_addc_u32 s9, s5, 0
s_mov_b32 s10, 0x800
s_mov_b32 s11, 0x00020000
v_and_b32 v194, 15, v0
v_lshlrev_b32 v194, 7, v194
s_mov_b32 s94, 0x10000
LE_poll0:
buffer_load_dwordx2 v[192:193], v194, s[8:11], 0 offen sc1
s_sub_u32 s94, s94, 1
s_waitcnt vmcnt(0)
s_cbranch_scc1 LE_poll0_go
v_cmp_ne_u64 vcc, s[98:99], v[192:193]
s_nop 1
s_cbranch_vccnz LE_poll0
LE_poll0_go:
s_add_u32 s8, s4, 0x7800000
s_addc_u32 s9, s5, 0
s_mov_b32 s10, 0x1000
s_mov_b32 s11, 0x00020000
s_add_u32 s12, s4, 0x8000000
s_addc_u32 s13, s5, 0
s_mov_b32 s14, 0x2800000
s_mov_b32 s15, 0x00020000
buffer_load_dword v4, v33, s[8:11], s48 offen sc1
buffer_load_dwordx4 v[192:195], v6, s[12:15], s50 offen offset:0 sc1
buffer_load_dwordx4 v[196:199], v6, s[12:15], s50 offen offset:64 sc1
buffer_load_dwordx4 v[200:203], v6, s[12:15], s50 offen offset:128 sc1
buffer_load_dwordx4 v[204:207], v6, s[12:15], s50 offen offset:192 sc1
buffer_load_dwordx4 v[208:211], v6, s[12:15], s50 offen offset:256 sc1
buffer_load_dwordx4 v[212:215], v6, s[12:15], s50 offen offset:320 sc1
buffer_load_dwordx4 v[216:219], v6, s[12:15], s50 offen offset:384 sc1
buffer_load_dwordx4 v[220:223], v6, s[12:15], s50 offen offset:448 sc1
buffer_load_dwordx4 v[224:227], v6, s[12:15], s50 offen offset:512 sc1
buffer_load_dwordx4 v[228:231], v6, s[12:15], s50 offen offset:576 sc1
buffer_load_dwordx4 v[232:235], v6, s[12:15], s50 offen offset:640 sc1
buffer_load_dwordx4 v[236:239], v6, s[12:15], s50 offen offset:704 sc1
buffer_load_dwordx4 v[240:243], v6, s[12:15], s50 offen offset:768 sc1
buffer_load_dwordx4 v[244:247], v6, s[12:15], s50 offen offset:832 sc1
buffer_load_dwordx4 v[248:251], v6, s[12:15], s50 offen offset:896 sc1
buffer_load_dwordx4 v[252:255], v6, s[12:15], s50 offen offset:960 sc1
s_add_u32 s16, s4, 0x6800000
s_addc_u32 s17, s5, 0
s_mov_b32 s18, 0x4e2000
s_mov_b32 s19, 0x00020000
s_add_u32 s20, s4, 0x7000000
s_addc_u32 s21, s5, 0
s_mov_b32 s22, 0x4e2000
s_mov_b32 s23, 0x00020000
v_lshlrev_b32 v5, 2, v34
v_and_b32 v2, 15, v1
v_lshrrev_b32 v3, 4, v1
v_mov_b32 v16, 1
v_mov_b32 v17, 4
v_and_b32 v33, 1, v2
v_lshlrev_b32 v33, 4, v33
v_lshlrev_b32 v33, v33, v16
v_mul_u32_u24 v33, 0x3f80, v33
v_lshrrev_b32 v34, 1, v2
v_cmp_eq_u32 vcc, 0, v34
s_nop 1
v_cndmask_b32 v40, 0, v33, vcc
v_cmp_eq_u32 vcc, 1, v34
s_nop 1
v_cndmask_b32 v41, 0, v33, vcc
v_cmp_eq_u32 vcc, 2, v34
s_nop 1
v_cndmask_b32 v42, 0, v33, vcc
v_cmp_eq_u32 vcc, 3, v34
s_nop 1
v_cndmask_b32 v43, 0, v33, vcc
v_cmp_eq_u32 vcc, 4, v34
s_nop 1
v_cndmask_b32 v44, 0, v33, vcc
v_cmp_eq_u32 vcc, 5, v34
s_nop 1
v_cndmask_b32 v45, 0, v33, vcc
v_cmp_eq_u32 vcc, 6, v34
s_nop 1
v_cndmask_b32 v46, 0, v33, vcc
v_cmp_eq_u32 vcc, 7, v34
s_nop 1
v_cndmask_b32 v47, 0, v33, vcc
v_lshlrev_b32 v39, 5, v2
v_lshl_add_u32 v39, v3, 3, v39
v_lshlrev_b32 v2, 4, v2
s_mul_i32 s48, s41, 21504
s_add_u32 s48, s48, 4096
v_mov_b32 v36, s48
v_lshl_add_u32 v38, v3, 2, v36
s_lshl_b32 s36, s41, 10
s_lshl_b32 s35, s55, 2
s_sub_u32 s35, s36, s35
v_mov_b32 v7, s35
v_lshlrev_b32 v35, 4, v1
v_add_u32 v68, s48, v35
v_add_u32 v35, s36, v35
v_lshlrev_b32 v33, 2, v1
v_mov_b32 v72, 0xffff
v_mov_b32 v73, 0xffff
v_mov_b32 v74, 0xffff
v_mov_b32 v75, 0xffff
v_cmp_gt_u32 vcc, s54, v33
v_mov_b32 v48, 0
s_nop 0
v_cndmask_b32 v18, 0, v16, vcc
v_add_u32 v33, 1, v33
v_cmp_gt_u32 vcc, s54, v33
v_mov_b32 v49, 0
s_nop 0
v_cndmask_b32 v19, 0, v16, vcc
v_add_u32 v33, 1, v33
v_cmp_gt_u32 vcc, s54, v33
v_mov_b32 v50, 0
s_nop 0
v_cndmask_b32 v20, 0, v16, vcc
v_add_u32 v33, 1, v33
v_cmp_gt_u32 vcc, s54, v33
v_mov_b32 v51, 0
s_nop 0
v_cndmask_b32 v21, 0, v16, vcc
LE_pass:
ds_write_b128 v35, v[48:51]
ds_write_b128 v68, v[72:75] offset:0
ds_write_b128 v68, v[72:75] offset:1024
ds_write_b128 v68, v[72:75] offset:2048
ds_write_b128 v68, v[72:75] offset:3072
ds_write_b128 v68, v[72:75] offset:4096
ds_write_b128 v68, v[72:75] offset:5120
ds_write_b128 v68, v[72:75] offset:6144
ds_write_b128 v68, v[72:75] offset:7168
ds_write_b128 v68, v[72:75] offset:8192
ds_write_b128 v68, v[72:75] offset:9216
ds_write_b128 v68, v[72:75] offset:10240
ds_write_b128 v68, v[72:75] offset:11264
ds_write_b128 v68, v[72:75] offset:12288
ds_write_b128 v68, v[72:75] offset:13312
ds_write_b128 v68, v[72:75] offset:14336
ds_write_b128 v68, v[72:75] offset:15360
ds_write_b128 v68, v[72:75] offset:16384
ds_write_b128 v68, v[72:75] offset:17408
ds_write_b128 v68, v[72:75] offset:18432
ds_write_b128 v68, v[72:75] offset:19456
v_lshl_add_u32 v32, v1, 2, v36
ds_write_b32 v32, v48 offset:20480
s_waitcnt vmcnt(16)
v_sub_u32 v32, v4, v5
s_waitcnt vmcnt(15)
v_cmpx_lt_i32 vcc, 0, v32
s_cbranch_execz LE_c
v_mad_u32_u16 v128, v192, 1, v7 op_sel:[1,0,0,0]
ds_add_u32 v128, v16
v_cmpx_lt_i32 vcc, 1, v32
v_mad_u32_u16 v129, v193, 1, v7 op_sel:[1,0,0,0]
ds_add_u32 v129, v16
v_cmpx_lt_i32 vcc, 2, v32
v_mad_u32_u16 v130, v194, 1, v7 op_sel:[1,0,0,0]
ds_add_u32 v130, v16
v_cmpx_lt_i32 vcc, 3, v32
v_mad_u32_u16 v131, v195, 1, v7 op_sel:[1,0,0,0]
ds_add_u32 v131, v16
s_waitcnt vmcnt(14)
v_cmpx_lt_i32 vcc, 16, v32
s_cbranch_execz LE_c
v_mad_u32_u16 v132, v196, 1, v7 op_sel:[1,0,0,0]
ds_add_u32 v132, v16
v_cmpx_lt_i32 vcc, 17, v32
v_mad_u32_u16 v133, v197, 1, v7 op_sel:[1,0,0,0]
ds_add_u32 v133, v16
v_cmpx_lt_i32 vcc, 18, v32
v_mad_u32_u16 v134, v198, 1, v7 op_sel:[1,0,0,0]
ds_add_u32 v134, v16
v_cmpx_lt_i32 vcc, 19, v32
v_mad_u32_u16 v135, v199, 1, v7 op_sel:[1,0,0,0]
ds_add_u32 v135, v16
s_waitcnt vmcnt(13)
v_cmpx_lt_i32 vcc, 32, v32
s_cbranch_execz LE_c
v_mad_u32_u16 v136, v200, 1, v7 op_sel:[1,0,0,0]
ds_add_u32 v136, v16
v_cmpx_lt_i32 vcc, 33, v32
v_mad_u32_u16 v137, v201, 1, v7 op_sel:[1,0,0,0]
ds_add_u32 v137, v16
v_cmpx_lt_i32 vcc, 34, v32
v_mad_u32_u16 v138, v202, 1, v7 op_sel:[1,0,0,0]
ds_add_u32 v138, v16
v_cmpx_lt_i32 vcc, 35, v32
v_mad_u32_u16 v139, v203, 1, v7 op_sel:[1,0,0,0]
ds_add_u32 v139, v16
s_waitcnt vmcnt(12)
v_cmpx_lt_i32 vcc, 48, v32
s_cbranch_execz LE_c
v_mad_u32_u16 v140, v204, 1, v7 op_sel:[1,0,0,0]
ds_add_u32 v140, v16
v_cmpx_lt_i32 vcc, 49, v32
v_mad_u32_u16 v141, v205, 1, v7 op_sel:[1,0,0,0]
ds_add_u32 v141, v16
v_cmpx_lt_i32 vcc, 50, v32
v_mad_u32_u16 v142, v206, 1, v7 op_sel:[1,0,0,0]
ds_add_u32 v142, v16
v_cmpx_lt_i32 vcc, 51, v32
v_mad_u32_u16 v143, v207, 1, v7 op_sel:[1,0,0,0]
ds_add_u32 v143, v16
s_waitcnt vmcnt(11)
v_cmpx_lt_i32 vcc, 64, v32
s_cbranch_execz LE_c
v_mad_u32_u16 v144, v208, 1, v7 op_sel:[1,0,0,0]
ds_add_u32 v144, v16
v_cmpx_lt_i32 vcc, 65, v32
v_mad_u32_u16 v145, v209, 1, v7 op_sel:[1,0,0,0]
ds_add_u32 v145, v16
v_cmpx_lt_i32 vcc, 66, v32
v_mad_u32_u16 v146, v210, 1, v7 op_sel:[1,0,0,0]
ds_add_u32 v146, v16
v_cmpx_lt_i32 vcc, 67, v32
v_mad_u32_u16 v147, v211, 1, v7 op_sel:[1,0,0,0]
ds_add_u32 v147, v16
s_waitcnt vmcnt(10)
v_cmpx_lt_i32 vcc, 80, v32
s_cbranch_execz LE_c
v_mad_u32_u16 v148, v212, 1, v7 op_sel:[1,0,0,0]
ds_add_u32 v148, v16
v_cmpx_lt_i32 vcc, 81, v32
v_mad_u32_u16 v149, v213, 1, v7 op_sel:[1,0,0,0]
ds_add_u32 v149, v16
v_cmpx_lt_i32 vcc, 82, v32
v_mad_u32_u16 v150, v214, 1, v7 op_sel:[1,0,0,0]
ds_add_u32 v150, v16
v_cmpx_lt_i32 vcc, 83, v32
v_mad_u32_u16 v151, v215, 1, v7 op_sel:[1,0,0,0]
ds_add_u32 v151, v16
s_waitcnt vmcnt(9)
v_cmpx_lt_i32 vcc, 96, v32
s_cbranch_execz LE_c
v_mad_u32_u16 v152, v216, 1, v7 op_sel:[1,0,0,0]
ds_add_u32 v152, v16
v_cmpx_lt_i32 vcc, 97, v32
v_mad_u32_u16 v153, v217, 1, v7 op_sel:[1,0,0,0]
ds_add_u32 v153, v16
v_cmpx_lt_i32 vcc, 98, v32
v_mad_u32_u16 v154, v218, 1, v7 op_sel:[1,0,0,0]
ds_add_u32 v154, v16
v_cmpx_lt_i32 vcc, 99, v32
v_mad_u32_u16 v155, v219, 1, v7 op_sel:[1,0,0,0]
ds_add_u32 v155, v16
s_waitcnt vmcnt(8)
v_cmpx_lt_i32 vcc, 112, v32
s_cbranch_execz LE_c
v_mad_u32_u16 v156, v220, 1, v7 op_sel:[1,0,0,0]
ds_add_u32 v156, v16
v_cmpx_lt_i32 vcc, 113, v32
v_mad_u32_u16 v157, v221, 1, v7 op_sel:[1,0,0,0]
ds_add_u32 v157, v16
v_cmpx_lt_i32 vcc, 114, v32
v_mad_u32_u16 v158, v222, 1, v7 op_sel:[1,0,0,0]
ds_add_u32 v158, v16
v_cmpx_lt_i32 vcc, 115, v32
v_mad_u32_u16 v159, v223, 1, v7 op_sel:[1,0,0,0]
ds_add_u32 v159, v16
s_waitcnt vmcnt(7)
v_cmpx_lt_i32 vcc, 128, v32
s_cbranch_execz LE_c
v_mad_u32_u16 v160, v224, 1, v7 op_sel:[1,0,0,0]
ds_add_u32 v160, v16
v_cmpx_lt_i32 vcc, 129, v32
v_mad_u32_u16 v161, v225, 1, v7 op_sel:[1,0,0,0]
ds_add_u32 v161, v16
v_cmpx_lt_i32 vcc, 130, v32
v_mad_u32_u16 v162, v226, 1, v7 op_sel:[1,0,0,0]
ds_add_u32 v162, v16
v_cmpx_lt_i32 vcc, 131, v32
v_mad_u32_u16 v163, v227, 1, v7 op_sel:[1,0,0,0]
ds_add_u32 v163, v16
s_waitcnt vmcnt(6)
v_cmpx_lt_i32 vcc, 144, v32
s_cbranch_execz LE_c
v_mad_u32_u16 v164, v228, 1, v7 op_sel:[1,0,0,0]
ds_add_u32 v164, v16
v_cmpx_lt_i32 vcc, 145, v32
v_mad_u32_u16 v165, v229, 1, v7 op_sel:[1,0,0,0]
ds_add_u32 v165, v16
v_cmpx_lt_i32 vcc, 146, v32
v_mad_u32_u16 v166, v230, 1, v7 op_sel:[1,0,0,0]
ds_add_u32 v166, v16
v_cmpx_lt_i32 vcc, 147, v32
v_mad_u32_u16 v167, v231, 1, v7 op_sel:[1,0,0,0]
ds_add_u32 v167, v16
s_waitcnt vmcnt(5)
v_cmpx_lt_i32 vcc, 160, v32
s_cbranch_execz LE_c
v_mad_u32_u16 v168, v232, 1, v7 op_sel:[1,0,0,0]
ds_add_u32 v168, v16
v_cmpx_lt_i32 vcc, 161, v32
v_mad_u32_u16 v169, v233, 1, v7 op_sel:[1,0,0,0]
ds_add_u32 v169, v16
v_cmpx_lt_i32 vcc, 162, v32
v_mad_u32_u16 v170, v234, 1, v7 op_sel:[1,0,0,0]
ds_add_u32 v170, v16
v_cmpx_lt_i32 vcc, 163, v32
v_mad_u32_u16 v171, v235, 1, v7 op_sel:[1,0,0,0]
ds_add_u32 v171, v16
s_waitcnt vmcnt(4)
v_cmpx_lt_i32 vcc, 176, v32
s_cbranch_execz LE_c
v_mad_u32_u16 v172, v236, 1, v7 op_sel:[1,0,0,0]
ds_add_u32 v172, v16
v_cmpx_lt_i32 vcc, 177, v32
v_mad_u32_u16 v173, v237, 1, v7 op_sel:[1,0,0,0]
ds_add_u32 v173, v16
v_cmpx_lt_i32 vcc, 178, v32
v_mad_u32_u16 v174, v238, 1, v7 op_sel:[1,0,0,0]
ds_add_u32 v174, v16
v_cmpx_lt_i32 vcc, 179, v32
v_mad_u32_u16 v175, v239, 1, v7 op_sel:[1,0,0,0]
ds_add_u32 v175, v16
s_waitcnt vmcnt(3)
v_cmpx_lt_i32 vcc, 192, v32
s_cbranch_execz LE_c
v_mad_u32_u16 v176, v240, 1, v7 op_sel:[1,0,0,0]
ds_add_u32 v176, v16
v_cmpx_lt_i32 vcc, 193, v32
v_mad_u32_u16 v177, v241, 1, v7 op_sel:[1,0,0,0]
ds_add_u32 v177, v16
v_cmpx_lt_i32 vcc, 194, v32
v_mad_u32_u16 v178, v242, 1, v7 op_sel:[1,0,0,0]
ds_add_u32 v178, v16
v_cmpx_lt_i32 vcc, 195, v32
v_mad_u32_u16 v179, v243, 1, v7 op_sel:[1,0,0,0]
ds_add_u32 v179, v16
s_waitcnt vmcnt(2)
v_cmpx_lt_i32 vcc, 208, v32
s_cbranch_execz LE_c
v_mad_u32_u16 v180, v244, 1, v7 op_sel:[1,0,0,0]
ds_add_u32 v180, v16
v_cmpx_lt_i32 vcc, 209, v32
v_mad_u32_u16 v181, v245, 1, v7 op_sel:[1,0,0,0]
ds_add_u32 v181, v16
v_cmpx_lt_i32 vcc, 210, v32
v_mad_u32_u16 v182, v246, 1, v7 op_sel:[1,0,0,0]
ds_add_u32 v182, v16
v_cmpx_lt_i32 vcc, 211, v32
v_mad_u32_u16 v183, v247, 1, v7 op_sel:[1,0,0,0]
ds_add_u32 v183, v16
s_waitcnt vmcnt(1)
v_cmpx_lt_i32 vcc, 224, v32
s_cbranch_execz LE_c
v_mad_u32_u16 v184, v248, 1, v7 op_sel:[1,0,0,0]
ds_add_u32 v184, v16
v_cmpx_lt_i32 vcc, 225, v32
v_mad_u32_u16 v185, v249, 1, v7 op_sel:[1,0,0,0]
ds_add_u32 v185, v16
v_cmpx_lt_i32 vcc, 226, v32
v_mad_u32_u16 v186, v250, 1, v7 op_sel:[1,0,0,0]
ds_add_u32 v186, v16
v_cmpx_lt_i32 vcc, 227, v32
v_mad_u32_u16 v187, v251, 1, v7 op_sel:[1,0,0,0]
ds_add_u32 v187, v16
s_waitcnt vmcnt(0)
v_cmpx_lt_i32 vcc, 240, v32
s_cbranch_execz LE_c
v_mad_u32_u16 v188, v252, 1, v7 op_sel:[1,0,0,0]
ds_add_u32 v188, v16
v_cmpx_lt_i32 vcc, 241, v32
v_mad_u32_u16 v189, v253, 1, v7 op_sel:[1,0,0,0]
ds_add_u32 v189, v16
v_cmpx_lt_i32 vcc, 242, v32
v_mad_u32_u16 v190, v254, 1, v7 op_sel:[1,0,0,0]
ds_add_u32 v190, v16
v_cmpx_lt_i32 vcc, 243, v32
v_mad_u32_u16 v191, v255, 1, v7 op_sel:[1,0,0,0]
ds_add_u32 v191, v16
LE_c:
s_mov_b64 exec, -1
ds_read_b128 v[24:27], v35
s_waitcnt lgkmcnt(0)
v_add_u32 v24, 3, v24
v_lshrrev_b32 v24, 2, v24
v_max_u32 v24, v24, v18
v_add_u32 v25, 3, v25
v_lshrrev_b32 v25, 2, v25
v_max_u32 v25, v25, v19
v_add_u32 v26, 3, v26
v_lshrrev_b32 v26, 2, v26
v_max_u32 v26, v26, v20
v_add_u32 v27, 3, v27
v_lshrrev_b32 v27, 2, v27
v_max_u32 v27, v27, v21
v_add_u32 v33, v24, v25
v_add3_u32 v33, v33, v26, v27
v_mov_b32 v64, v33
s_nop 1
v_add_u32_dpp v64, v64, v64 row_shr:1 row_mask:0xf bank_mask:0xf
s_nop 1
v_add_u32_dpp v64, v64, v64 row_shr:2 row_mask:0xf bank_mask:0xf
s_nop 1
v_add_u32_dpp v64, v64, v64 row_shr:4 row_mask:0xf bank_mask:0xf
s_nop 1
v_add_u32_dpp v64, v64, v64 row_shr:8 row_mask:0xf bank_mask:0xf
s_nop 1
v_add_u32_dpp v64, v64, v64 row_bcast:15 row_mask:0xa bank_mask:0xf
s_nop 1
v_add_u32_dpp v64, v64, v64 row_bcast:31 row_mask:0xc bank_mask:0xf
s_nop 1
v_readlane_b32 s44, v64, 63
v_sub_u32 v28, v64, v33
v_add_u32 v29, v28, v24
v_add_u32 v30, v29, v25
v_add_u32 v31, v30, v26
v_add3_u32 v33, v28, v24, -1
v_lshlrev_b32 v34, v33, v18
v_lshrrev_b32 v33, 5, v33
v_lshl_add_u32 v33, v33, 2, v36
ds_or_b32 v33, v34 offset:20480
v_lshl_add_u32 v28, v28, 4, v36
v_add3_u32 v33, v29, v25, -1
v_lshlrev_b32 v34, v33, v19
v_lshrrev_b32 v33, 5, v33
v_lshl_add_u32 v33, v33, 2, v36
ds_or_b32 v33, v34 offset:20480
v_lshl_add_u32 v29, v29, 4, v36
v_add3_u32 v33, v30, v26, -1
v_lshlrev_b32 v34, v33, v20
v_lshrrev_b32 v33, 5, v33
v_lshl_add_u32 v33, v33, 2, v36
ds_or_b32 v33, v34 offset:20480
v_lshl_add_u32 v30, v30, 4, v36
v_add3_u32 v33, v31, v27, -1
v_lshlrev_b32 v34, v33, v21
v_lshrrev_b32 v33, 5, v33
v_lshl_add_u32 v33, v33, 2, v36
ds_or_b32 v33, v34 offset:20480
v_lshl_add_u32 v31, v31, 4, v36
ds_write_b128 v35, v[28:31]
s_add_u32 s44, s44, 31
s_lshr_b32 s44, s44, 5
v_cmpx_lt_i32 vcc, 0, v32
s_cbranch_execz LE_p
ds_add_rtn_u32 v128, v128, v17
v_cmpx_lt_i32 vcc, 1, v32
ds_add_rtn_u32 v129, v129, v17
v_cmpx_lt_i32 vcc, 2, v32
ds_add_rtn_u32 v130, v130, v17
v_cmpx_lt_i32 vcc, 3, v32
ds_add_rtn_u32 v131, v131, v17
v_cmpx_lt_i32 vcc, 16, v32
s_cbranch_execz LE_p
ds_add_rtn_u32 v132, v132, v17
v_cmpx_lt_i32 vcc, 17, v32
ds_add_rtn_u32 v133, v133, v17
v_cmpx_lt_i32 vcc, 18, v32
ds_add_rtn_u32 v134, v134, v17
v_cmpx_lt_i32 vcc, 19, v32
ds_add_rtn_u32 v135, v135, v17
v_cmpx_lt_i32 vcc, 32, v32
s_cbranch_execz LE_p
ds_add_rtn_u32 v136, v136, v17
v_cmpx_lt_i32 vcc, 33, v32
ds_add_rtn_u32 v137, v137, v17
v_cmpx_lt_i32 vcc, 34, v32
ds_add_rtn_u32 v138, v138, v17
v_cmpx_lt_i32 vcc, 35, v32
ds_add_rtn_u32 v139, v139, v17
v_cmpx_lt_i32 vcc, 48, v32
s_cbranch_execz LE_p
ds_add_rtn_u32 v140, v140, v17
v_cmpx_lt_i32 vcc, 49, v32
ds_add_rtn_u32 v141, v141, v17
v_cmpx_lt_i32 vcc, 50, v32
ds_add_rtn_u32 v142, v142, v17
v_cmpx_lt_i32 vcc, 51, v32
ds_add_rtn_u32 v143, v143, v17
v_cmpx_lt_i32 vcc, 64, v32
s_cbranch_execz LE_p
ds_add_rtn_u32 v144, v144, v17
v_cmpx_lt_i32 vcc, 65, v32
ds_add_rtn_u32 v145, v145, v17
v_cmpx_lt_i32 vcc, 66, v32
ds_add_rtn_u32 v146, v146, v17
v_cmpx_lt_i32 vcc, 67, v32
ds_add_rtn_u32 v147, v147, v17
v_cmpx_lt_i32 vcc, 80, v32
s_cbranch_execz LE_p
ds_add_rtn_u32 v148, v148, v17
v_cmpx_lt_i32 vcc, 81, v32
ds_add_rtn_u32 v149, v149, v17
v_cmpx_lt_i32 vcc, 82, v32
ds_add_rtn_u32 v150, v150, v17
v_cmpx_lt_i32 vcc, 83, v32
ds_add_rtn_u32 v151, v151, v17
v_cmpx_lt_i32 vcc, 96, v32
s_cbranch_execz LE_p
ds_add_rtn_u32 v152, v152, v17
v_cmpx_lt_i32 vcc, 97, v32
ds_add_rtn_u32 v153, v153, v17
v_cmpx_lt_i32 vcc, 98, v32
ds_add_rtn_u32 v154, v154, v17
v_cmpx_lt_i32 vcc, 99, v32
ds_add_rtn_u32 v155, v155, v17
v_cmpx_lt_i32 vcc, 112, v32
s_cbranch_execz LE_p
ds_add_rtn_u32 v156, v156, v17
v_cmpx_lt_i32 vcc, 113, v32
ds_add_rtn_u32 v157, v157, v17
v_cmpx_lt_i32 vcc, 114, v32
ds_add_rtn_u32 v158, v158, v17
v_cmpx_lt_i32 vcc, 115, v32
ds_add_rtn_u32 v159, v159, v17
v_cmpx_lt_i32 vcc, 128, v32
s_cbranch_execz LE_p
ds_add_rtn_u32 v160, v160, v17
v_cmpx_lt_i32 vcc, 129, v32
ds_add_rtn_u32 v161, v161, v17
v_cmpx_lt_i32 vcc, 130, v32
ds_add_rtn_u32 v162, v162, v17
v_cmpx_lt_i32 vcc, 131, v32
ds_add_rtn_u32 v163, v163, v17
v_cmpx_lt_i32 vcc, 144, v32
s_cbranch_execz LE_p
ds_add_rtn_u32 v164, v164, v17
v_cmpx_lt_i32 vcc, 145, v32
ds_add_rtn_u32 v165, v165, v17
v_cmpx_lt_i32 vcc, 146, v32
ds_add_rtn_u32 v166, v166, v17
v_cmpx_lt_i32 vcc, 147, v32
ds_add_rtn_u32 v167, v167, v17
v_cmpx_lt_i32 vcc, 160, v32
s_cbranch_execz LE_p
ds_add_rtn_u32 v168, v168, v17
v_cmpx_lt_i32 vcc, 161, v32
ds_add_rtn_u32 v169, v169, v17
v_cmpx_lt_i32 vcc, 162, v32
ds_add_rtn_u32 v170, v170, v17
v_cmpx_lt_i32 vcc, 163, v32
ds_add_rtn_u32 v171, v171, v17
v_cmpx_lt_i32 vcc, 176, v32
s_cbranch_execz LE_p
ds_add_rtn_u32 v172, v172, v17
v_cmpx_lt_i32 vcc, 177, v32
ds_add_rtn_u32 v173, v173, v17
v_cmpx_lt_i32 vcc, 178, v32
ds_add_rtn_u32 v174, v174, v17
v_cmpx_lt_i32 vcc, 179, v32
ds_add_rtn_u32 v175, v175, v17
v_cmpx_lt_i32 vcc, 192, v32
s_cbranch_execz LE_p
ds_add_rtn_u32 v176, v176, v17
v_cmpx_lt_i32 vcc, 193, v32
ds_add_rtn_u32 v177, v177, v17
v_cmpx_lt_i32 vcc, 194, v32
ds_add_rtn_u32 v178, v178, v17
v_cmpx_lt_i32 vcc, 195, v32
ds_add_rtn_u32 v179, v179, v17
v_cmpx_lt_i32 vcc, 208, v32
s_cbranch_execz LE_p
ds_add_rtn_u32 v180, v180, v17
v_cmpx_lt_i32 vcc, 209, v32
ds_add_rtn_u32 v181, v181, v17
v_cmpx_lt_i32 vcc, 210, v32
ds_add_rtn_u32 v182, v182, v17
v_cmpx_lt_i32 vcc, 211, v32
ds_add_rtn_u32 v183, v183, v17
v_cmpx_lt_i32 vcc, 224, v32
s_cbranch_execz LE_p
ds_add_rtn_u32 v184, v184, v17
v_cmpx_lt_i32 vcc, 225, v32
ds_add_rtn_u32 v185, v185, v17
v_cmpx_lt_i32 vcc, 226, v32
ds_add_rtn_u32 v186, v186, v17
v_cmpx_lt_i32 vcc, 227, v32
ds_add_rtn_u32 v187, v187, v17
v_cmpx_lt_i32 vcc, 240, v32
s_cbranch_execz LE_p
ds_add_rtn_u32 v188, v188, v17
v_cmpx_lt_i32 vcc, 241, v32
ds_add_rtn_u32 v189, v189, v17
v_cmpx_lt_i32 vcc, 242, v32
ds_add_rtn_u32 v190, v190, v17
v_cmpx_lt_i32 vcc, 243, v32
ds_add_rtn_u32 v191, v191, v17
LE_p:
s_mov_b64 exec, -1
v_lshl_add_u32 v33, v1, 2, v36
ds_read_b32 v37, v33 offset:20480
s_waitcnt lgkmcnt(0)
v_cmpx_lt_i32 vcc, 0, v32
s_cbranch_execz LE_w
ds_write_b32 v128, v192
v_cmpx_lt_i32 vcc, 1, v32
ds_write_b32 v129, v193
v_cmpx_lt_i32 vcc, 2, v32
ds_write_b32 v130, v194
v_cmpx_lt_i32 vcc, 3, v32
ds_write_b32 v131, v195
v_cmpx_lt_i32 vcc, 16, v32
s_cbranch_execz LE_w
ds_write_b32 v132, v196
v_cmpx_lt_i32 vcc, 17, v32
ds_write_b32 v133, v197
v_cmpx_lt_i32 vcc, 18, v32
ds_write_b32 v134, v198
v_cmpx_lt_i32 vcc, 19, v32
ds_write_b32 v135, v199
v_cmpx_lt_i32 vcc, 32, v32
s_cbranch_execz LE_w
ds_write_b32 v136, v200
v_cmpx_lt_i32 vcc, 33, v32
ds_write_b32 v137, v201
v_cmpx_lt_i32 vcc, 34, v32
ds_write_b32 v138, v202
v_cmpx_lt_i32 vcc, 35, v32
ds_write_b32 v139, v203
v_cmpx_lt_i32 vcc, 48, v32
s_cbranch_execz LE_w
ds_write_b32 v140, v204
v_cmpx_lt_i32 vcc, 49, v32
ds_write_b32 v141, v205
v_cmpx_lt_i32 vcc, 50, v32
ds_write_b32 v142, v206
v_cmpx_lt_i32 vcc, 51, v32
ds_write_b32 v143, v207
v_cmpx_lt_i32 vcc, 64, v32
s_cbranch_execz LE_w
ds_write_b32 v144, v208
v_cmpx_lt_i32 vcc, 65, v32
ds_write_b32 v145, v209
v_cmpx_lt_i32 vcc, 66, v32
ds_write_b32 v146, v210
v_cmpx_lt_i32 vcc, 67, v32
ds_write_b32 v147, v211
v_cmpx_lt_i32 vcc, 80, v32
s_cbranch_execz LE_w
ds_write_b32 v148, v212
v_cmpx_lt_i32 vcc, 81, v32
ds_write_b32 v149, v213
v_cmpx_lt_i32 vcc, 82, v32
ds_write_b32 v150, v214
v_cmpx_lt_i32 vcc, 83, v32
ds_write_b32 v151, v215
v_cmpx_lt_i32 vcc, 96, v32
s_cbranch_execz LE_w
ds_write_b32 v152, v216
v_cmpx_lt_i32 vcc, 97, v32
ds_write_b32 v153, v217
v_cmpx_lt_i32 vcc, 98, v32
ds_write_b32 v154, v218
v_cmpx_lt_i32 vcc, 99, v32
ds_write_b32 v155, v219
v_cmpx_lt_i32 vcc, 112, v32
s_cbranch_execz LE_w
ds_write_b32 v156, v220
v_cmpx_lt_i32 vcc, 113, v32
ds_write_b32 v157, v221
v_cmpx_lt_i32 vcc, 114, v32
ds_write_b32 v158, v222
v_cmpx_lt_i32 vcc, 115, v32
ds_write_b32 v159, v223
v_cmpx_lt_i32 vcc, 128, v32
s_cbranch_execz LE_w
ds_write_b32 v160, v224
v_cmpx_lt_i32 vcc, 129, v32
ds_write_b32 v161, v225
v_cmpx_lt_i32 vcc, 130, v32
ds_write_b32 v162, v226
v_cmpx_lt_i32 vcc, 131, v32
ds_write_b32 v163, v227
v_cmpx_lt_i32 vcc, 144, v32
s_cbranch_execz LE_w
ds_write_b32 v164, v228
v_cmpx_lt_i32 vcc, 145, v32
ds_write_b32 v165, v229
v_cmpx_lt_i32 vcc, 146, v32
ds_write_b32 v166, v230
v_cmpx_lt_i32 vcc, 147, v32
ds_write_b32 v167, v231
v_cmpx_lt_i32 vcc, 160, v32
s_cbranch_execz LE_w
ds_write_b32 v168, v232
v_cmpx_lt_i32 vcc, 161, v32
ds_write_b32 v169, v233
v_cmpx_lt_i32 vcc, 162, v32
ds_write_b32 v170, v234
v_cmpx_lt_i32 vcc, 163, v32
ds_write_b32 v171, v235
v_cmpx_lt_i32 vcc, 176, v32
s_cbranch_execz LE_w
ds_write_b32 v172, v236
v_cmpx_lt_i32 vcc, 177, v32
ds_write_b32 v173, v237
v_cmpx_lt_i32 vcc, 178, v32
ds_write_b32 v174, v238
v_cmpx_lt_i32 vcc, 179, v32
ds_write_b32 v175, v239
v_cmpx_lt_i32 vcc, 192, v32
s_cbranch_execz LE_w
ds_write_b32 v176, v240
v_cmpx_lt_i32 vcc, 193, v32
ds_write_b32 v177, v241
v_cmpx_lt_i32 vcc, 194, v32
ds_write_b32 v178, v242
v_cmpx_lt_i32 vcc, 195, v32
ds_write_b32 v179, v243
v_cmpx_lt_i32 vcc, 208, v32
s_cbranch_execz LE_w
ds_write_b32 v180, v244
v_cmpx_lt_i32 vcc, 209, v32
ds_write_b32 v181, v245
v_cmpx_lt_i32 vcc, 210, v32
ds_write_b32 v182, v246
v_cmpx_lt_i32 vcc, 211, v32
ds_write_b32 v183, v247
v_cmpx_lt_i32 vcc, 224, v32
s_cbranch_execz LE_w
ds_write_b32 v184, v248
v_cmpx_lt_i32 vcc, 225, v32
ds_write_b32 v185, v249
v_cmpx_lt_i32 vcc, 226, v32
ds_write_b32 v186, v250
v_cmpx_lt_i32 vcc, 227, v32
ds_write_b32 v187, v251
v_cmpx_lt_i32 vcc, 240, v32
s_cbranch_execz LE_w
ds_write_b32 v188, v252
v_cmpx_lt_i32 vcc, 241, v32
ds_write_b32 v189, v253
v_cmpx_lt_i32 vcc, 242, v32
ds_write_b32 v190, v254
v_cmpx_lt_i32 vcc, 243, v32
ds_write_b32 v191, v255
LE_w:
s_mov_b64 exec, -1
s_add_u32 s8, s4, 0x7c2a000
s_addc_u32 s9, s5, 0
s_mov_b32 s10, 0x8000
s_mov_b32 s11, 0x00020000
v_and_b32 v200, 63, v0
v_lshlrev_b32 v200, 7, v200
s_mov_b32 s91, 8192
s_mov_b32 s90, 16384
s_mov_b32 s95, 24576
s_mov_b32 s94, 0x10000
LE_poll:
buffer_load_dwordx2 v[192:193], v200, s[8:11], 0 offen sc1
buffer_load_dwordx2 v[194:195], v200, s[8:11], s91 offen sc1
buffer_load_dwordx2 v[196:197], v200, s[8:11], s90 offen sc1
buffer_load_dwordx2 v[198:199], v200, s[8:11], s95 offen sc1
s_sub_u32 s94, s94, 1
s_waitcnt vmcnt(0)
s_cbranch_scc1 LE_poll_go
v_cmp_ne_u64 vcc, s[98:99], v[192:193]
s_nop 1
s_cbranch_vccnz LE_poll
v_cmp_ne_u64 vcc, s[98:99], v[194:195]
s_nop 1
s_cbranch_vccnz LE_poll
v_cmp_ne_u64 vcc, s[98:99], v[196:197]
s_nop 1
s_cbranch_vccnz LE_poll
v_cmp_ne_u64 vcc, s[98:99], v[198:199]
s_nop 1
s_cbranch_vccnz LE_poll
LE_poll_go:
s_cmp_lg_u32 s40, 0
s_cbranch_scc1 LE_nobump
s_mov_b32 s90, 89984
s_mov_b32 s10, 90112
v_mov_b32 v192, s98
v_mov_b32 v193, s99
s_mov_b64 exec, 1
buffer_store_dwordx2 v[192:193], off, s[8:11], s90 sc1
s_mov_b64 exec, -1
LE_nobump:
v_mov_b32 v34, v38
ds_read2_b32 v[52:53], v34 offset0:0 offset1:4
ds_read2_b32 v[54:55], v34 offset0:8 offset1:12
s_waitcnt lgkmcnt(0)
ds_read2_b32 v[56:57], v34 offset0:16 offset1:20
ds_read2_b32 v[58:59], v34 offset0:24 offset1:28
v_mad_u32_u16 v60, v52, s49, v2
v_mad_u32_u16 v61, v53, s49, v2
v_mad_u32_u16 v62, v54, s49, v2
v_mad_u32_u16 v63, v55, s49, v2
buffer_load_dwordx4 a[0:3], v60, s[16:19], 0 offen sc1
buffer_load_dwordx4 a[4:7], v60, s[16:19], 0 offen offset:256 sc1
buffer_load_dwordx4 a[8:11], v61, s[16:19], 0 offen sc1
buffer_load_dwordx4 a[12:15], v61, s[16:19], 0 offen offset:256 sc1
buffer_load_dwordx4 a[16:19], v62, s[16:19], 0 offen sc1
buffer_load_dwordx4 a[20:23], v62, s[16:19], 0 offen offset:256 sc1
buffer_load_dwordx4 a[24:27], v63, s[16:19], 0 offen sc1
buffer_load_dwordx4 a[28:31], v63, s[16:19], 0 offen offset:256 sc1
s_waitcnt lgkmcnt(0)
ds_read2_b32 v[52:53], v34 offset0:32 offset1:36
ds_read2_b32 v[54:55], v34 offset0:40 offset1:44
v_mad_u32_u16 v60, v56, s49, v2
v_mad_u32_u16 v61, v57, s49, v2
v_mad_u32_u16 v62, v58, s49, v2
v_mad_u32_u16 v63, v59, s49, v2
buffer_load_dwordx4 a[32:35], v60, s[16:19], 0 offen sc1
buffer_load_dwordx4 a[36:39], v60, s[16:19], 0 offen offset:256 sc1
buffer_load_dwordx4 a[40:43], v61, s[16:19], 0 offen sc1
buffer_load_dwordx4 a[44:47], v61, s[16:19], 0 offen offset:256 sc1
buffer_load_dwordx4 a[48:51], v62, s[16:19], 0 offen sc1
buffer_load_dwordx4 a[52:55], v62, s[16:19], 0 offen offset:256 sc1
buffer_load_dwordx4 a[56:59], v63, s[16:19], 0 offen sc1
buffer_load_dwordx4 a[60:63], v63, s[16:19], 0 offen offset:256 sc1
s_waitcnt lgkmcnt(0)
ds_read2_b32 v[56:57], v34 offset0:48 offset1:52
ds_read2_b32 v[58:59], v34 offset0:56 offset1:60
v_mad_u32_u16 v60, v52, s49, v2
v_mad_u32_u16 v61, v53, s49, v2
v_mad_u32_u16 v62, v54, s49, v2
v_mad_u32_u16 v63, v55, s49, v2
buffer_load_dwordx4 a[64:67], v60, s[16:19], 0 offen sc1
buffer_load_dwordx4 a[68:71], v60, s[16:19], 0 offen offset:256 sc1
buffer_load_dwordx4 a[72:75], v61, s[16:19], 0 offen sc1
buffer_load_dwordx4 a[76:79], v61, s[16:19], 0 offen offset:256 sc1
buffer_load_dwordx4 a[80:83], v62, s[16:19], 0 offen sc1
buffer_load_dwordx4 a[84:87], v62, s[16:19], 0 offen offset:256 sc1
buffer_load_dwordx4 a[88:91], v63, s[16:19], 0 offen sc1
buffer_load_dwordx4 a[92:95], v63, s[16:19], 0 offen offset:256 sc1
s_waitcnt lgkmcnt(0)
ds_read2_b32 v[52:53], v34 offset0:64 offset1:68
ds_read2_b32 v[54:55], v34 offset0:72 offset1:76
v_mad_u32_u16 v60, v56, s49, v2
v_mad_u32_u16 v61, v57, s49, v2
v_mad_u32_u16 v62, v58, s49, v2
v_mad_u32_u16 v63, v59, s49, v2
buffer_load_dwordx4 a[96:99], v60, s[16:19], 0 offen sc1
buffer_load_dwordx4 a[100:103], v60, s[16:19], 0 offen offset:256 sc1
buffer_load_dwordx4 a[104:107], v61, s[16:19], 0 offen sc1
buffer_load_dwordx4 a[108:111], v61, s[16:19], 0 offen offset:256 sc1
buffer_load_dwordx4 a[112:115], v62, s[16:19], 0 offen sc1
buffer_load_dwordx4 a[116:119], v62, s[16:19], 0 offen offset:256 sc1
buffer_load_dwordx4 a[120:123], v63, s[16:19], 0 offen sc1
buffer_load_dwordx4 a[124:127], v63, s[16:19], 0 offen offset:256 sc1
s_waitcnt lgkmcnt(0)
ds_read2_b32 v[56:57], v34 offset0:80 offset1:84
ds_read2_b32 v[58:59], v34 offset0:88 offset1:92
v_mad_u32_u16 v60, v52, s49, v2
v_mad_u32_u16 v61, v53, s49, v2
v_mad_u32_u16 v62, v54, s49, v2
v_mad_u32_u16 v63, v55, s49, v2
buffer_load_dwordx4 a[128:131], v60, s[16:19], 0 offen sc1
buffer_load_dwordx4 a[132:135], v60, s[16:19], 0 offen offset:256 sc1
buffer_load_dwordx4 a[136:139], v61, s[16:19], 0 offen sc1
buffer_load_dwordx4 a[140:143], v61, s[16:19], 0 offen offset:256 sc1
buffer_load_dwordx4 a[144:147], v62, s[16:19], 0 offen sc1
buffer_load_dwordx4 a[148:151], v62, s[16:19], 0 offen offset:256 sc1
buffer_load_dwordx4 a[152:155], v63, s[16:19], 0 offen sc1
buffer_load_dwordx4 a[156:159], v63, s[16:19], 0 offen offset:256 sc1
s_waitcnt lgkmcnt(0)
ds_read2_b32 v[52:53], v34 offset0:96 offset1:100
ds_read2_b32 v[54:55], v34 offset0:104 offset1:108
v_mad_u32_u16 v60, v56, s49, v2
v_mad_u32_u16 v61, v57, s49, v2
v_mad_u32_u16 v62, v58, s49, v2
v_mad_u32_u16 v63, v59, s49, v2
buffer_load_dwordx4 a[160:163], v60, s[16:19], 0 offen sc1
buffer_load_dwordx4 a[164:167], v60, s[16:19], 0 offen offset:256 sc1
buffer_load_dwordx4 a[168:171], v61, s[16:19], 0 offen sc1
buffer_load_dwordx4 a[172:175], v61, s[16:19], 0 offen offset:256 sc1
buffer_load_dwordx4 a[176:179], v62, s[16:19], 0 offen sc1
buffer_load_dwordx4 a[180:183], v62, s[16:19], 0 offen offset:256 sc1
buffer_load_dwordx4 a[184:187], v63, s[16:19], 0 offen sc1
buffer_load_dwordx4 a[188:191], v63, s[16:19], 0 offen offset:256 sc1
s_waitcnt lgkmcnt(0)
ds_read2_b32 v[56:57], v34 offset0:112 offset1:116
ds_read2_b32 v[58:59], v34 offset0:120 offset1:124
v_mad_u32_u16 v60, v52, s49, v2
v_mad_u32_u16 v61, v53, s49, v2
v_mad_u32_u16 v62, v54, s49, v2
v_mad_u32_u16 v63, v55, s49, v2
buffer_load_dwordx4 a[192:195], v60, s[16:19], 0 offen sc1
buffer_load_dwordx4 a[196:199], v60, s[16:19], 0 offen offset:256 sc1
buffer_load_dwordx4 a[200:203], v61, s[16:19], 0 offen sc1
buffer_load_dwordx4 a[204:207], v61, s[16:19], 0 offen offset:256 sc1
buffer_load_dwordx4 a[208:211], v62, s[16:19], 0 offen sc1
buffer_load_dwordx4 a[212:215], v62, s[16:19], 0 offen offset:256 sc1
buffer_load_dwordx4 a[216:219], v63, s[16:19], 0 offen sc1
buffer_load_dwordx4 a[220:223], v63, s[16:19], 0 offen offset:256 sc1
s_waitcnt lgkmcnt(0)
ds_read2_b32 v[52:53], v34 offset0:128 offset1:132
ds_read2_b32 v[54:55], v34 offset0:136 offset1:140
v_mad_u32_u16 v60, v56, s49, v2
v_mad_u32_u16 v61, v57, s49, v2
v_mad_u32_u16 v62, v58, s49, v2
v_mad_u32_u16 v63, v59, s49, v2
buffer_load_dwordx4 a[224:227], v60, s[16:19], 0 offen sc1
buffer_load_dwordx4 a[228:231], v60, s[16:19], 0 offen offset:256 sc1
buffer_load_dwordx4 a[232:235], v61, s[16:19], 0 offen sc1
buffer_load_dwordx4 a[236:239], v61, s[16:19], 0 offen offset:256 sc1
buffer_load_dwordx4 a[240:243], v62, s[16:19], 0 offen sc1
buffer_load_dwordx4 a[244:247], v62, s[16:19], 0 offen offset:256 sc1
buffer_load_dwordx4 a[248:251], v63, s[16:19], 0 offen sc1
buffer_load_dwordx4 a[252:255], v63, s[16:19], 0 offen offset:256 sc1
v_add_u32 v34, 512, v34
s_mov_b32 s45, 0
s_lshl_b32 s47, s55, 9
LE_loop:
v_readlane_b32 s46, v37, s45
s_add_u32 s45, s45, 1
s_waitcnt vmcnt(56)
v_mfma_f32_16x16x32_bf16 v[48:51], a[0:3], v[40:43], v[48:51]
v_mfma_f32_16x16x32_bf16 v[48:51], a[4:7], v[44:47], v[48:51]
s_bitcmp1_b32 s46, 0
s_cbranch_scc0 LE_nf0
s_cmp_eq_u32 s42, 0
s_cbranch_scc1 LE_fl0
buffer_load_dwordx2 v[66:67], v39, s[20:23], s47 offen sc1
s_waitcnt vmcnt(0)
v_lshlrev_b32 v64, 16, v66
v_and_b32 v65, 0xffff0000, v66
v_add_f32 v48, v48, v64
v_add_f32 v49, v49, v65
v_lshlrev_b32 v64, 16, v67
v_and_b32 v65, 0xffff0000, v67
v_add_f32 v50, v50, v64
v_add_f32 v51, v51, v65
LE_fl0:
s_nop 3
v_cvt_pk_bf16_f32 v64, v48, v49
v_cvt_pk_bf16_f32 v65, v50, v51
v_mov_b32 v48, 0
v_mov_b32 v49, 0
v_mov_b32 v50, 0
v_mov_b32 v51, 0
buffer_store_dwordx2 v[64:65], v39, s[20:23], s47 offen sc1
s_add_u32 s47, s47, 512
LE_nf0:
v_mfma_f32_16x16x32_bf16 v[48:51], a[8:11], v[40:43], v[48:51]
v_mfma_f32_16x16x32_bf16 v[48:51], a[12:15], v[44:47], v[48:51]
s_bitcmp1_b32 s46, 1
s_cbranch_scc0 LE_nf1
s_cmp_eq_u32 s42, 0
s_cbranch_scc1 LE_fl1
buffer_load_dwordx2 v[66:67], v39, s[20:23], s47 offen sc1
s_waitcnt vmcnt(0)
v_lshlrev_b32 v64, 16, v66
v_and_b32 v65, 0xffff0000, v66
v_add_f32 v48, v48, v64
v_add_f32 v49, v49, v65
v_lshlrev_b32 v64, 16, v67
v_and_b32 v65, 0xffff0000, v67
v_add_f32 v50, v50, v64
v_add_f32 v51, v51, v65
LE_fl1:
s_nop 3
v_cvt_pk_bf16_f32 v64, v48, v49
v_cvt_pk_bf16_f32 v65, v50, v51
v_mov_b32 v48, 0
v_mov_b32 v49, 0
v_mov_b32 v50, 0
v_mov_b32 v51, 0
buffer_store_dwordx2 v[64:65], v39, s[20:23], s47 offen sc1
s_add_u32 s47, s47, 512
LE_nf1:
v_mfma_f32_16x16x32_bf16 v[48:51], a[16:19], v[40:43], v[48:51]
v_mfma_f32_16x16x32_bf16 v[48:51], a[20:23], v[44:47], v[48:51]
s_bitcmp1_b32 s46, 2
s_cbranch_scc0 LE_nf2
s_cmp_eq_u32 s42, 0
s_cbranch_scc1 LE_fl2
buffer_load_dwordx2 v[66:67], v39, s[20:23], s47 offen sc1
s_waitcnt vmcnt(0)
v_lshlrev_b32 v64, 16, v66
v_and_b32 v65, 0xffff0000, v66
v_add_f32 v48, v48, v64
v_add_f32 v49, v49, v65
v_lshlrev_b32 v64, 16, v67
v_and_b32 v65, 0xffff0000, v67
v_add_f32 v50, v50, v64
v_add_f32 v51, v51, v65
LE_fl2:
s_nop 3
v_cvt_pk_bf16_f32 v64, v48, v49
v_cvt_pk_bf16_f32 v65, v50, v51
v_mov_b32 v48, 0
v_mov_b32 v49, 0
v_mov_b32 v50, 0
v_mov_b32 v51, 0
buffer_store_dwordx2 v[64:65], v39, s[20:23], s47 offen sc1
s_add_u32 s47, s47, 512
LE_nf2:
v_mfma_f32_16x16x32_bf16 v[48:51], a[24:27], v[40:43], v[48:51]
v_mfma_f32_16x16x32_bf16 v[48:51], a[28:31], v[44:47], v[48:51]
s_bitcmp1_b32 s46, 3
s_cbranch_scc0 LE_nf3
s_cmp_eq_u32 s42, 0
s_cbranch_scc1 LE_fl3
buffer_load_dwordx2 v[66:67], v39, s[20:23], s47 offen sc1
s_waitcnt vmcnt(0)
v_lshlrev_b32 v64, 16, v66
v_and_b32 v65, 0xffff0000, v66
v_add_f32 v48, v48, v64
v_add_f32 v49, v49, v65
v_lshlrev_b32 v64, 16, v67
v_and_b32 v65, 0xffff0000, v67
v_add_f32 v50, v50, v64
v_add_f32 v51, v51, v65
LE_fl3:
s_nop 3
v_cvt_pk_bf16_f32 v64, v48, v49
v_cvt_pk_bf16_f32 v65, v50, v51
v_mov_b32 v48, 0
v_mov_b32 v49, 0
v_mov_b32 v50, 0
v_mov_b32 v51, 0
buffer_store_dwordx2 v[64:65], v39, s[20:23], s47 offen sc1
s_add_u32 s47, s47, 512
LE_nf3:
s_waitcnt lgkmcnt(0)
ds_read2_b32 v[56:57], v34 offset0:16 offset1:20
ds_read2_b32 v[58:59], v34 offset0:24 offset1:28
v_mad_u32_u16 v60, v52, s49, v2
v_mad_u32_u16 v61, v53, s49, v2
v_mad_u32_u16 v62, v54, s49, v2
v_mad_u32_u16 v63, v55, s49, v2
buffer_load_dwordx4 a[0:3], v60, s[16:19], 0 offen sc1
buffer_load_dwordx4 a[4:7], v60, s[16:19], 0 offen offset:256 sc1
buffer_load_dwordx4 a[8:11], v61, s[16:19], 0 offen sc1
buffer_load_dwordx4 a[12:15], v61, s[16:19], 0 offen offset:256 sc1
buffer_load_dwordx4 a[16:19], v62, s[16:19], 0 offen sc1
buffer_load_dwordx4 a[20:23], v62, s[16:19], 0 offen offset:256 sc1
buffer_load_dwordx4 a[24:27], v63, s[16:19], 0 offen sc1
buffer_load_dwordx4 a[28:31], v63, s[16:19], 0 offen offset:256 sc1
s_waitcnt vmcnt(56)
v_mfma_f32_16x16x32_bf16 v[48:51], a[32:35], v[40:43], v[48:51]
v_mfma_f32_16x16x32_bf16 v[48:51], a[36:39], v[44:47], v[48:51]
s_bitcmp1_b32 s46, 4
s_cbranch_scc0 LE_nf4
s_cmp_eq_u32 s42, 0
s_cbranch_scc1 LE_fl4
buffer_load_dwordx2 v[66:67], v39, s[20:23], s47 offen sc1
s_waitcnt vmcnt(0)
v_lshlrev_b32 v64, 16, v66
v_and_b32 v65, 0xffff0000, v66
v_add_f32 v48, v48, v64
v_add_f32 v49, v49, v65
v_lshlrev_b32 v64, 16, v67
v_and_b32 v65, 0xffff0000, v67
v_add_f32 v50, v50, v64
v_add_f32 v51, v51, v65
LE_fl4:
s_nop 3
v_cvt_pk_bf16_f32 v64, v48, v49
v_cvt_pk_bf16_f32 v65, v50, v51
v_mov_b32 v48, 0
v_mov_b32 v49, 0
v_mov_b32 v50, 0
v_mov_b32 v51, 0
buffer_store_dwordx2 v[64:65], v39, s[20:23], s47 offen sc1
s_add_u32 s47, s47, 512
LE_nf4:
v_mfma_f32_16x16x32_bf16 v[48:51], a[40:43], v[40:43], v[48:51]
v_mfma_f32_16x16x32_bf16 v[48:51], a[44:47], v[44:47], v[48:51]
s_bitcmp1_b32 s46, 5
s_cbranch_scc0 LE_nf5
s_cmp_eq_u32 s42, 0
s_cbranch_scc1 LE_fl5
buffer_load_dwordx2 v[66:67], v39, s[20:23], s47 offen sc1
s_waitcnt vmcnt(0)
v_lshlrev_b32 v64, 16, v66
v_and_b32 v65, 0xffff0000, v66
v_add_f32 v48, v48, v64
v_add_f32 v49, v49, v65
v_lshlrev_b32 v64, 16, v67
v_and_b32 v65, 0xffff0000, v67
v_add_f32 v50, v50, v64
v_add_f32 v51, v51, v65
LE_fl5:
s_nop 3
v_cvt_pk_bf16_f32 v64, v48, v49
v_cvt_pk_bf16_f32 v65, v50, v51
v_mov_b32 v48, 0
v_mov_b32 v49, 0
v_mov_b32 v50, 0
v_mov_b32 v51, 0
buffer_store_dwordx2 v[64:65], v39, s[20:23], s47 offen sc1
s_add_u32 s47, s47, 512
LE_nf5:
v_mfma_f32_16x16x32_bf16 v[48:51], a[48:51], v[40:43], v[48:51]
v_mfma_f32_16x16x32_bf16 v[48:51], a[52:55], v[44:47], v[48:51]
s_bitcmp1_b32 s46, 6
s_cbranch_scc0 LE_nf6
s_cmp_eq_u32 s42, 0
s_cbranch_scc1 LE_fl6
buffer_load_dwordx2 v[66:67], v39, s[20:23], s47 offen sc1
s_waitcnt vmcnt(0)
v_lshlrev_b32 v64, 16, v66
v_and_b32 v65, 0xffff0000, v66
v_add_f32 v48, v48, v64
v_add_f32 v49, v49, v65
v_lshlrev_b32 v64, 16, v67
v_and_b32 v65, 0xffff0000, v67
v_add_f32 v50, v50, v64
v_add_f32 v51, v51, v65
LE_fl6:
s_nop 3
v_cvt_pk_bf16_f32 v64, v48, v49
v_cvt_pk_bf16_f32 v65, v50, v51
v_mov_b32 v48, 0
v_mov_b32 v49, 0
v_mov_b32 v50, 0
v_mov_b32 v51, 0
buffer_store_dwordx2 v[64:65], v39, s[20:23], s47 offen sc1
s_add_u32 s47, s47, 512
LE_nf6:
v_mfma_f32_16x16x32_bf16 v[48:51], a[56:59], v[40:43], v[48:51]
v_mfma_f32_16x16x32_bf16 v[48:51], a[60:63], v[44:47], v[48:51]
s_bitcmp1_b32 s46, 7
s_cbranch_scc0 LE_nf7
s_cmp_eq_u32 s42, 0
s_cbranch_scc1 LE_fl7
buffer_load_dwordx2 v[66:67], v39, s[20:23], s47 offen sc1
s_waitcnt vmcnt(0)
v_lshlrev_b32 v64, 16, v66
v_and_b32 v65, 0xffff0000, v66
v_add_f32 v48, v48, v64
v_add_f32 v49, v49, v65
v_lshlrev_b32 v64, 16, v67
v_and_b32 v65, 0xffff0000, v67
v_add_f32 v50, v50, v64
v_add_f32 v51, v51, v65
LE_fl7:
s_nop 3
v_cvt_pk_bf16_f32 v64, v48, v49
v_cvt_pk_bf16_f32 v65, v50, v51
v_mov_b32 v48, 0
v_mov_b32 v49, 0
v_mov_b32 v50, 0
v_mov_b32 v51, 0
buffer_store_dwordx2 v[64:65], v39, s[20:23], s47 offen sc1
s_add_u32 s47, s47, 512
LE_nf7:
s_waitcnt lgkmcnt(0)
ds_read2_b32 v[52:53], v34 offset0:32 offset1:36
ds_read2_b32 v[54:55], v34 offset0:40 offset1:44
v_mad_u32_u16 v60, v56, s49, v2
v_mad_u32_u16 v61, v57, s49, v2
v_mad_u32_u16 v62, v58, s49, v2
v_mad_u32_u16 v63, v59, s49, v2
buffer_load_dwordx4 a[32:35], v60, s[16:19], 0 offen sc1
buffer_load_dwordx4 a[36:39], v60, s[16:19], 0 offen offset:256 sc1
buffer_load_dwordx4 a[40:43], v61, s[16:19], 0 offen sc1
buffer_load_dwordx4 a[44:47], v61, s[16:19], 0 offen offset:256 sc1
buffer_load_dwordx4 a[48:51], v62, s[16:19], 0 offen sc1
buffer_load_dwordx4 a[52:55], v62, s[16:19], 0 offen offset:256 sc1
buffer_load_dwordx4 a[56:59], v63, s[16:19], 0 offen sc1
buffer_load_dwordx4 a[60:63], v63, s[16:19], 0 offen offset:256 sc1
s_waitcnt vmcnt(56)
v_mfma_f32_16x16x32_bf16 v[48:51], a[64:67], v[40:43], v[48:51]
v_mfma_f32_16x16x32_bf16 v[48:51], a[68:71], v[44:47], v[48:51]
s_bitcmp1_b32 s46, 8
s_cbranch_scc0 LE_nf8
s_cmp_eq_u32 s42, 0
s_cbranch_scc1 LE_fl8
buffer_load_dwordx2 v[66:67], v39, s[20:23], s47 offen sc1
s_waitcnt vmcnt(0)
v_lshlrev_b32 v64, 16, v66
v_and_b32 v65, 0xffff0000, v66
v_add_f32 v48, v48, v64
v_add_f32 v49, v49, v65
v_lshlrev_b32 v64, 16, v67
v_and_b32 v65, 0xffff0000, v67
v_add_f32 v50, v50, v64
v_add_f32 v51, v51, v65
LE_fl8:
s_nop 3
v_cvt_pk_bf16_f32 v64, v48, v49
v_cvt_pk_bf16_f32 v65, v50, v51
v_mov_b32 v48, 0
v_mov_b32 v49, 0
v_mov_b32 v50, 0
v_mov_b32 v51, 0
buffer_store_dwordx2 v[64:65], v39, s[20:23], s47 offen sc1
s_add_u32 s47, s47, 512
LE_nf8:
v_mfma_f32_16x16x32_bf16 v[48:51], a[72:75], v[40:43], v[48:51]
v_mfma_f32_16x16x32_bf16 v[48:51], a[76:79], v[44:47], v[48:51]
s_bitcmp1_b32 s46, 9
s_cbranch_scc0 LE_nf9
s_cmp_eq_u32 s42, 0
s_cbranch_scc1 LE_fl9
buffer_load_dwordx2 v[66:67], v39, s[20:23], s47 offen sc1
s_waitcnt vmcnt(0)
v_lshlrev_b32 v64, 16, v66
v_and_b32 v65, 0xffff0000, v66
v_add_f32 v48, v48, v64
v_add_f32 v49, v49, v65
v_lshlrev_b32 v64, 16, v67
v_and_b32 v65, 0xffff0000, v67
v_add_f32 v50, v50, v64
v_add_f32 v51, v51, v65
LE_fl9:
s_nop 3
v_cvt_pk_bf16_f32 v64, v48, v49
v_cvt_pk_bf16_f32 v65, v50, v51
v_mov_b32 v48, 0
v_mov_b32 v49, 0
v_mov_b32 v50, 0
v_mov_b32 v51, 0
buffer_store_dwordx2 v[64:65], v39, s[20:23], s47 offen sc1
s_add_u32 s47, s47, 512
LE_nf9:
v_mfma_f32_16x16x32_bf16 v[48:51], a[80:83], v[40:43], v[48:51]
v_mfma_f32_16x16x32_bf16 v[48:51], a[84:87], v[44:47], v[48:51]
s_bitcmp1_b32 s46, 10
s_cbranch_scc0 LE_nf10
s_cmp_eq_u32 s42, 0
s_cbranch_scc1 LE_fl10
buffer_load_dwordx2 v[66:67], v39, s[20:23], s47 offen sc1
s_waitcnt vmcnt(0)
v_lshlrev_b32 v64, 16, v66
v_and_b32 v65, 0xffff0000, v66
v_add_f32 v48, v48, v64
v_add_f32 v49, v49, v65
v_lshlrev_b32 v64, 16, v67
v_and_b32 v65, 0xffff0000, v67
v_add_f32 v50, v50, v64
v_add_f32 v51, v51, v65
LE_fl10:
s_nop 3
v_cvt_pk_bf16_f32 v64, v48, v49
v_cvt_pk_bf16_f32 v65, v50, v51
v_mov_b32 v48, 0
v_mov_b32 v49, 0
v_mov_b32 v50, 0
v_mov_b32 v51, 0
buffer_store_dwordx2 v[64:65], v39, s[20:23], s47 offen sc1
s_add_u32 s47, s47, 512
LE_nf10:
v_mfma_f32_16x16x32_bf16 v[48:51], a[88:91], v[40:43], v[48:51]
v_mfma_f32_16x16x32_bf16 v[48:51], a[92:95], v[44:47], v[48:51]
s_bitcmp1_b32 s46, 11
s_cbranch_scc0 LE_nf11
s_cmp_eq_u32 s42, 0
s_cbranch_scc1 LE_fl11
buffer_load_dwordx2 v[66:67], v39, s[20:23], s47 offen sc1
s_waitcnt vmcnt(0)
v_lshlrev_b32 v64, 16, v66
v_and_b32 v65, 0xffff0000, v66
v_add_f32 v48, v48, v64
v_add_f32 v49, v49, v65
v_lshlrev_b32 v64, 16, v67
v_and_b32 v65, 0xffff0000, v67
v_add_f32 v50, v50, v64
v_add_f32 v51, v51, v65
LE_fl11:
s_nop 3
v_cvt_pk_bf16_f32 v64, v48, v49
v_cvt_pk_bf16_f32 v65, v50, v51
v_mov_b32 v48, 0
v_mov_b32 v49, 0
v_mov_b32 v50, 0
v_mov_b32 v51, 0
buffer_store_dwordx2 v[64:65], v39, s[20:23], s47 offen sc1
s_add_u32 s47, s47, 512
LE_nf11:
s_waitcnt lgkmcnt(0)
ds_read2_b32 v[56:57], v34 offset0:48 offset1:52
ds_read2_b32 v[58:59], v34 offset0:56 offset1:60
v_mad_u32_u16 v60, v52, s49, v2
v_mad_u32_u16 v61, v53, s49, v2
v_mad_u32_u16 v62, v54, s49, v2
v_mad_u32_u16 v63, v55, s49, v2
buffer_load_dwordx4 a[64:67], v60, s[16:19], 0 offen sc1
buffer_load_dwordx4 a[68:71], v60, s[16:19], 0 offen offset:256 sc1
buffer_load_dwordx4 a[72:75], v61, s[16:19], 0 offen sc1
buffer_load_dwordx4 a[76:79], v61, s[16:19], 0 offen offset:256 sc1
buffer_load_dwordx4 a[80:83], v62, s[16:19], 0 offen sc1
buffer_load_dwordx4 a[84:87], v62, s[16:19], 0 offen offset:256 sc1
buffer_load_dwordx4 a[88:91], v63, s[16:19], 0 offen sc1
buffer_load_dwordx4 a[92:95], v63, s[16:19], 0 offen offset:256 sc1
s_waitcnt vmcnt(56)
v_mfma_f32_16x16x32_bf16 v[48:51], a[96:99], v[40:43], v[48:51]
v_mfma_f32_16x16x32_bf16 v[48:51], a[100:103], v[44:47], v[48:51]
s_bitcmp1_b32 s46, 12
s_cbranch_scc0 LE_nf12
s_cmp_eq_u32 s42, 0
s_cbranch_scc1 LE_fl12
buffer_load_dwordx2 v[66:67], v39, s[20:23], s47 offen sc1
s_waitcnt vmcnt(0)
v_lshlrev_b32 v64, 16, v66
v_and_b32 v65, 0xffff0000, v66
v_add_f32 v48, v48, v64
v_add_f32 v49, v49, v65
v_lshlrev_b32 v64, 16, v67
v_and_b32 v65, 0xffff0000, v67
v_add_f32 v50, v50, v64
v_add_f32 v51, v51, v65
LE_fl12:
s_nop 3
v_cvt_pk_bf16_f32 v64, v48, v49
v_cvt_pk_bf16_f32 v65, v50, v51
v_mov_b32 v48, 0
v_mov_b32 v49, 0
v_mov_b32 v50, 0
v_mov_b32 v51, 0
buffer_store_dwordx2 v[64:65], v39, s[20:23], s47 offen sc1
s_add_u32 s47, s47, 512
LE_nf12:
v_mfma_f32_16x16x32_bf16 v[48:51], a[104:107], v[40:43], v[48:51]
v_mfma_f32_16x16x32_bf16 v[48:51], a[108:111], v[44:47], v[48:51]
s_bitcmp1_b32 s46, 13
s_cbranch_scc0 LE_nf13
s_cmp_eq_u32 s42, 0
s_cbranch_scc1 LE_fl13
buffer_load_dwordx2 v[66:67], v39, s[20:23], s47 offen sc1
s_waitcnt vmcnt(0)
v_lshlrev_b32 v64, 16, v66
v_and_b32 v65, 0xffff0000, v66
v_add_f32 v48, v48, v64
v_add_f32 v49, v49, v65
v_lshlrev_b32 v64, 16, v67
v_and_b32 v65, 0xffff0000, v67
v_add_f32 v50, v50, v64
v_add_f32 v51, v51, v65
LE_fl13:
s_nop 3
v_cvt_pk_bf16_f32 v64, v48, v49
v_cvt_pk_bf16_f32 v65, v50, v51
v_mov_b32 v48, 0
v_mov_b32 v49, 0
v_mov_b32 v50, 0
v_mov_b32 v51, 0
buffer_store_dwordx2 v[64:65], v39, s[20:23], s47 offen sc1
s_add_u32 s47, s47, 512
LE_nf13:
v_mfma_f32_16x16x32_bf16 v[48:51], a[112:115], v[40:43], v[48:51]
v_mfma_f32_16x16x32_bf16 v[48:51], a[116:119], v[44:47], v[48:51]
s_bitcmp1_b32 s46, 14
s_cbranch_scc0 LE_nf14
s_cmp_eq_u32 s42, 0
s_cbranch_scc1 LE_fl14
buffer_load_dwordx2 v[66:67], v39, s[20:23], s47 offen sc1
s_waitcnt vmcnt(0)
v_lshlrev_b32 v64, 16, v66
v_and_b32 v65, 0xffff0000, v66
v_add_f32 v48, v48, v64
v_add_f32 v49, v49, v65
v_lshlrev_b32 v64, 16, v67
v_and_b32 v65, 0xffff0000, v67
v_add_f32 v50, v50, v64
v_add_f32 v51, v51, v65
LE_fl14:
s_nop 3
v_cvt_pk_bf16_f32 v64, v48, v49
v_cvt_pk_bf16_f32 v65, v50, v51
v_mov_b32 v48, 0
v_mov_b32 v49, 0
v_mov_b32 v50, 0
v_mov_b32 v51, 0
buffer_store_dwordx2 v[64:65], v39, s[20:23], s47 offen sc1
s_add_u32 s47, s47, 512
LE_nf14:
v_mfma_f32_16x16x32_bf16 v[48:51], a[120:123], v[40:43], v[48:51]
v_mfma_f32_16x16x32_bf16 v[48:51], a[124:127], v[44:47], v[48:51]
s_bitcmp1_b32 s46, 15
s_cbranch_scc0 LE_nf15
s_cmp_eq_u32 s42, 0
s_cbranch_scc1 LE_fl15
buffer_load_dwordx2 v[66:67], v39, s[20:23], s47 offen sc1
s_waitcnt vmcnt(0)
v_lshlrev_b32 v64, 16, v66
v_and_b32 v65, 0xffff0000, v66
v_add_f32 v48, v48, v64
v_add_f32 v49, v49, v65
v_lshlrev_b32 v64, 16, v67
v_and_b32 v65, 0xffff0000, v67
v_add_f32 v50, v50, v64
v_add_f32 v51, v51, v65
LE_fl15:
s_nop 3
v_cvt_pk_bf16_f32 v64, v48, v49
v_cvt_pk_bf16_f32 v65, v50, v51
v_mov_b32 v48, 0
v_mov_b32 v49, 0
v_mov_b32 v50, 0
v_mov_b32 v51, 0
buffer_store_dwordx2 v[64:65], v39, s[20:23], s47 offen sc1
s_add_u32 s47, s47, 512
LE_nf15:
s_waitcnt lgkmcnt(0)
ds_read2_b32 v[52:53], v34 offset0:64 offset1:68
ds_read2_b32 v[54:55], v34 offset0:72 offset1:76
v_mad_u32_u16 v60, v56, s49, v2
v_mad_u32_u16 v61, v57, s49, v2
v_mad_u32_u16 v62, v58, s49, v2
v_mad_u32_u16 v63, v59, s49, v2
buffer_load_dwordx4 a[96:99], v60, s[16:19], 0 offen sc1
buffer_load_dwordx4 a[100:103], v60, s[16:19], 0 offen offset:256 sc1
buffer_load_dwordx4 a[104:107], v61, s[16:19], 0 offen sc1
buffer_load_dwordx4 a[108:111], v61, s[16:19], 0 offen offset:256 sc1
buffer_load_dwordx4 a[112:115], v62, s[16:19], 0 offen sc1
buffer_load_dwordx4 a[116:119], v62, s[16:19], 0 offen offset:256 sc1
buffer_load_dwordx4 a[120:123], v63, s[16:19], 0 offen sc1
buffer_load_dwordx4 a[124:127], v63, s[16:19], 0 offen offset:256 sc1
s_waitcnt vmcnt(56)
v_mfma_f32_16x16x32_bf16 v[48:51], a[128:131], v[40:43], v[48:51]
v_mfma_f32_16x16x32_bf16 v[48:51], a[132:135], v[44:47], v[48:51]
s_bitcmp1_b32 s46, 16
s_cbranch_scc0 LE_nf16
s_cmp_eq_u32 s42, 0
s_cbranch_scc1 LE_fl16
buffer_load_dwordx2 v[66:67], v39, s[20:23], s47 offen sc1
s_waitcnt vmcnt(0)
v_lshlrev_b32 v64, 16, v66
v_and_b32 v65, 0xffff0000, v66
v_add_f32 v48, v48, v64
v_add_f32 v49, v49, v65
v_lshlrev_b32 v64, 16, v67
v_and_b32 v65, 0xffff0000, v67
v_add_f32 v50, v50, v64
v_add_f32 v51, v51, v65
LE_fl16:
s_nop 3
v_cvt_pk_bf16_f32 v64, v48, v49
v_cvt_pk_bf16_f32 v65, v50, v51
v_mov_b32 v48, 0
v_mov_b32 v49, 0
v_mov_b32 v50, 0
v_mov_b32 v51, 0
buffer_store_dwordx2 v[64:65], v39, s[20:23], s47 offen sc1
s_add_u32 s47, s47, 512
LE_nf16:
v_mfma_f32_16x16x32_bf16 v[48:51], a[136:139], v[40:43], v[48:51]
v_mfma_f32_16x16x32_bf16 v[48:51], a[140:143], v[44:47], v[48:51]
s_bitcmp1_b32 s46, 17
s_cbranch_scc0 LE_nf17
s_cmp_eq_u32 s42, 0
s_cbranch_scc1 LE_fl17
buffer_load_dwordx2 v[66:67], v39, s[20:23], s47 offen sc1
s_waitcnt vmcnt(0)
v_lshlrev_b32 v64, 16, v66
v_and_b32 v65, 0xffff0000, v66
v_add_f32 v48, v48, v64
v_add_f32 v49, v49, v65
v_lshlrev_b32 v64, 16, v67
v_and_b32 v65, 0xffff0000, v67
v_add_f32 v50, v50, v64
v_add_f32 v51, v51, v65
LE_fl17:
s_nop 3
v_cvt_pk_bf16_f32 v64, v48, v49
v_cvt_pk_bf16_f32 v65, v50, v51
v_mov_b32 v48, 0
v_mov_b32 v49, 0
v_mov_b32 v50, 0
v_mov_b32 v51, 0
buffer_store_dwordx2 v[64:65], v39, s[20:23], s47 offen sc1
s_add_u32 s47, s47, 512
LE_nf17:
v_mfma_f32_16x16x32_bf16 v[48:51], a[144:147], v[40:43], v[48:51]
v_mfma_f32_16x16x32_bf16 v[48:51], a[148:151], v[44:47], v[48:51]
s_bitcmp1_b32 s46, 18
s_cbranch_scc0 LE_nf18
s_cmp_eq_u32 s42, 0
s_cbranch_scc1 LE_fl18
buffer_load_dwordx2 v[66:67], v39, s[20:23], s47 offen sc1
s_waitcnt vmcnt(0)
v_lshlrev_b32 v64, 16, v66
v_and_b32 v65, 0xffff0000, v66
v_add_f32 v48, v48, v64
v_add_f32 v49, v49, v65
v_lshlrev_b32 v64, 16, v67
v_and_b32 v65, 0xffff0000, v67
v_add_f32 v50, v50, v64
v_add_f32 v51, v51, v65
LE_fl18:
s_nop 3
v_cvt_pk_bf16_f32 v64, v48, v49
v_cvt_pk_bf16_f32 v65, v50, v51
v_mov_b32 v48, 0
v_mov_b32 v49, 0
v_mov_b32 v50, 0
v_mov_b32 v51, 0
buffer_store_dwordx2 v[64:65], v39, s[20:23], s47 offen sc1
s_add_u32 s47, s47, 512
LE_nf18:
v_mfma_f32_16x16x32_bf16 v[48:51], a[152:155], v[40:43], v[48:51]
v_mfma_f32_16x16x32_bf16 v[48:51], a[156:159], v[44:47], v[48:51]
s_bitcmp1_b32 s46, 19
s_cbranch_scc0 LE_nf19
s_cmp_eq_u32 s42, 0
s_cbranch_scc1 LE_fl19
buffer_load_dwordx2 v[66:67], v39, s[20:23], s47 offen sc1
s_waitcnt vmcnt(0)
v_lshlrev_b32 v64, 16, v66
v_and_b32 v65, 0xffff0000, v66
v_add_f32 v48, v48, v64
v_add_f32 v49, v49, v65
v_lshlrev_b32 v64, 16, v67
v_and_b32 v65, 0xffff0000, v67
v_add_f32 v50, v50, v64
v_add_f32 v51, v51, v65
LE_fl19:
s_nop 3
v_cvt_pk_bf16_f32 v64, v48, v49
v_cvt_pk_bf16_f32 v65, v50, v51
v_mov_b32 v48, 0
v_mov_b32 v49, 0
v_mov_b32 v50, 0
v_mov_b32 v51, 0
buffer_store_dwordx2 v[64:65], v39, s[20:23], s47 offen sc1
s_add_u32 s47, s47, 512
LE_nf19:
s_waitcnt lgkmcnt(0)
ds_read2_b32 v[56:57], v34 offset0:80 offset1:84
ds_read2_b32 v[58:59], v34 offset0:88 offset1:92
v_mad_u32_u16 v60, v52, s49, v2
v_mad_u32_u16 v61, v53, s49, v2
v_mad_u32_u16 v62, v54, s49, v2
v_mad_u32_u16 v63, v55, s49, v2
buffer_load_dwordx4 a[128:131], v60, s[16:19], 0 offen sc1
buffer_load_dwordx4 a[132:135], v60, s[16:19], 0 offen offset:256 sc1
buffer_load_dwordx4 a[136:139], v61, s[16:19], 0 offen sc1
buffer_load_dwordx4 a[140:143], v61, s[16:19], 0 offen offset:256 sc1
buffer_load_dwordx4 a[144:147], v62, s[16:19], 0 offen sc1
buffer_load_dwordx4 a[148:151], v62, s[16:19], 0 offen offset:256 sc1
buffer_load_dwordx4 a[152:155], v63, s[16:19], 0 offen sc1
buffer_load_dwordx4 a[156:159], v63, s[16:19], 0 offen offset:256 sc1
s_waitcnt vmcnt(56)
v_mfma_f32_16x16x32_bf16 v[48:51], a[160:163], v[40:43], v[48:51]
v_mfma_f32_16x16x32_bf16 v[48:51], a[164:167], v[44:47], v[48:51]
s_bitcmp1_b32 s46, 20
s_cbranch_scc0 LE_nf20
s_cmp_eq_u32 s42, 0
s_cbranch_scc1 LE_fl20
buffer_load_dwordx2 v[66:67], v39, s[20:23], s47 offen sc1
s_waitcnt vmcnt(0)
v_lshlrev_b32 v64, 16, v66
v_and_b32 v65, 0xffff0000, v66
v_add_f32 v48, v48, v64
v_add_f32 v49, v49, v65
v_lshlrev_b32 v64, 16, v67
v_and_b32 v65, 0xffff0000, v67
v_add_f32 v50, v50, v64
v_add_f32 v51, v51, v65
LE_fl20:
s_nop 3
v_cvt_pk_bf16_f32 v64, v48, v49
v_cvt_pk_bf16_f32 v65, v50, v51
v_mov_b32 v48, 0
v_mov_b32 v49, 0
v_mov_b32 v50, 0
v_mov_b32 v51, 0
buffer_store_dwordx2 v[64:65], v39, s[20:23], s47 offen sc1
s_add_u32 s47, s47, 512
LE_nf20:
v_mfma_f32_16x16x32_bf16 v[48:51], a[168:171], v[40:43], v[48:51]
v_mfma_f32_16x16x32_bf16 v[48:51], a[172:175], v[44:47], v[48:51]
s_bitcmp1_b32 s46, 21
s_cbranch_scc0 LE_nf21
s_cmp_eq_u32 s42, 0
s_cbranch_scc1 LE_fl21
buffer_load_dwordx2 v[66:67], v39, s[20:23], s47 offen sc1
s_waitcnt vmcnt(0)
v_lshlrev_b32 v64, 16, v66
v_and_b32 v65, 0xffff0000, v66
v_add_f32 v48, v48, v64
v_add_f32 v49, v49, v65
v_lshlrev_b32 v64, 16, v67
v_and_b32 v65, 0xffff0000, v67
v_add_f32 v50, v50, v64
v_add_f32 v51, v51, v65
LE_fl21:
s_nop 3
v_cvt_pk_bf16_f32 v64, v48, v49
v_cvt_pk_bf16_f32 v65, v50, v51
v_mov_b32 v48, 0
v_mov_b32 v49, 0
v_mov_b32 v50, 0
v_mov_b32 v51, 0
buffer_store_dwordx2 v[64:65], v39, s[20:23], s47 offen sc1
s_add_u32 s47, s47, 512
LE_nf21:
v_mfma_f32_16x16x32_bf16 v[48:51], a[176:179], v[40:43], v[48:51]
v_mfma_f32_16x16x32_bf16 v[48:51], a[180:183], v[44:47], v[48:51]
s_bitcmp1_b32 s46, 22
s_cbranch_scc0 LE_nf22
s_cmp_eq_u32 s42, 0
s_cbranch_scc1 LE_fl22
buffer_load_dwordx2 v[66:67], v39, s[20:23], s47 offen sc1
s_waitcnt vmcnt(0)
v_lshlrev_b32 v64, 16, v66
v_and_b32 v65, 0xffff0000, v66
v_add_f32 v48, v48, v64
v_add_f32 v49, v49, v65
v_lshlrev_b32 v64, 16, v67
v_and_b32 v65, 0xffff0000, v67
v_add_f32 v50, v50, v64
v_add_f32 v51, v51, v65
LE_fl22:
s_nop 3
v_cvt_pk_bf16_f32 v64, v48, v49
v_cvt_pk_bf16_f32 v65, v50, v51
v_mov_b32 v48, 0
v_mov_b32 v49, 0
v_mov_b32 v50, 0
v_mov_b32 v51, 0
buffer_store_dwordx2 v[64:65], v39, s[20:23], s47 offen sc1
s_add_u32 s47, s47, 512
LE_nf22:
v_mfma_f32_16x16x32_bf16 v[48:51], a[184:187], v[40:43], v[48:51]
v_mfma_f32_16x16x32_bf16 v[48:51], a[188:191], v[44:47], v[48:51]
s_bitcmp1_b32 s46, 23
s_cbranch_scc0 LE_nf23
s_cmp_eq_u32 s42, 0
s_cbranch_scc1 LE_fl23
buffer_load_dwordx2 v[66:67], v39, s[20:23], s47 offen sc1
s_waitcnt vmcnt(0)
v_lshlrev_b32 v64, 16, v66
v_and_b32 v65, 0xffff0000, v66
v_add_f32 v48, v48, v64
v_add_f32 v49, v49, v65
v_lshlrev_b32 v64, 16, v67
v_and_b32 v65, 0xffff0000, v67
v_add_f32 v50, v50, v64
v_add_f32 v51, v51, v65
LE_fl23:
s_nop 3
v_cvt_pk_bf16_f32 v64, v48, v49
v_cvt_pk_bf16_f32 v65, v50, v51
v_mov_b32 v48, 0
v_mov_b32 v49, 0
v_mov_b32 v50, 0
v_mov_b32 v51, 0
buffer_store_dwordx2 v[64:65], v39, s[20:23], s47 offen sc1
s_add_u32 s47, s47, 512
LE_nf23:
s_waitcnt lgkmcnt(0)
ds_read2_b32 v[52:53], v34 offset0:96 offset1:100
ds_read2_b32 v[54:55], v34 offset0:104 offset1:108
v_mad_u32_u16 v60, v56, s49, v2
v_mad_u32_u16 v61, v57, s49, v2
v_mad_u32_u16 v62, v58, s49, v2
v_mad_u32_u16 v63, v59, s49, v2
buffer_load_dwordx4 a[160:163], v60, s[16:19], 0 offen sc1
buffer_load_dwordx4 a[164:167], v60, s[16:19], 0 offen offset:256 sc1
buffer_load_dwordx4 a[168:171], v61, s[16:19], 0 offen sc1
buffer_load_dwordx4 a[172:175], v61, s[16:19], 0 offen offset:256 sc1
buffer_load_dwordx4 a[176:179], v62, s[16:19], 0 offen sc1
buffer_load_dwordx4 a[180:183], v62, s[16:19], 0 offen offset:256 sc1
buffer_load_dwordx4 a[184:187], v63, s[16:19], 0 offen sc1
buffer_load_dwordx4 a[188:191], v63, s[16:19], 0 offen offset:256 sc1
s_waitcnt vmcnt(56)
v_mfma_f32_16x16x32_bf16 v[48:51], a[192:195], v[40:43], v[48:51]
v_mfma_f32_16x16x32_bf16 v[48:51], a[196:199], v[44:47], v[48:51]
s_bitcmp1_b32 s46, 24
s_cbranch_scc0 LE_nf24
s_cmp_eq_u32 s42, 0
s_cbranch_scc1 LE_fl24
buffer_load_dwordx2 v[66:67], v39, s[20:23], s47 offen sc1
s_waitcnt vmcnt(0)
v_lshlrev_b32 v64, 16, v66
v_and_b32 v65, 0xffff0000, v66
v_add_f32 v48, v48, v64
v_add_f32 v49, v49, v65
v_lshlrev_b32 v64, 16, v67
v_and_b32 v65, 0xffff0000, v67
v_add_f32 v50, v50, v64
v_add_f32 v51, v51, v65
LE_fl24:
s_nop 3
v_cvt_pk_bf16_f32 v64, v48, v49
v_cvt_pk_bf16_f32 v65, v50, v51
v_mov_b32 v48, 0
v_mov_b32 v49, 0
v_mov_b32 v50, 0
v_mov_b32 v51, 0
buffer_store_dwordx2 v[64:65], v39, s[20:23], s47 offen sc1
s_add_u32 s47, s47, 512
LE_nf24:
v_mfma_f32_16x16x32_bf16 v[48:51], a[200:203], v[40:43], v[48:51]
v_mfma_f32_16x16x32_bf16 v[48:51], a[204:207], v[44:47], v[48:51]
s_bitcmp1_b32 s46, 25
s_cbranch_scc0 LE_nf25
s_cmp_eq_u32 s42, 0
s_cbranch_scc1 LE_fl25
buffer_load_dwordx2 v[66:67], v39, s[20:23], s47 offen sc1
s_waitcnt vmcnt(0)
v_lshlrev_b32 v64, 16, v66
v_and_b32 v65, 0xffff0000, v66
v_add_f32 v48, v48, v64
v_add_f32 v49, v49, v65
v_lshlrev_b32 v64, 16, v67
v_and_b32 v65, 0xffff0000, v67
v_add_f32 v50, v50, v64
v_add_f32 v51, v51, v65
LE_fl25:
s_nop 3
v_cvt_pk_bf16_f32 v64, v48, v49
v_cvt_pk_bf16_f32 v65, v50, v51
v_mov_b32 v48, 0
v_mov_b32 v49, 0
v_mov_b32 v50, 0
v_mov_b32 v51, 0
buffer_store_dwordx2 v[64:65], v39, s[20:23], s47 offen sc1
s_add_u32 s47, s47, 512
LE_nf25:
v_mfma_f32_16x16x32_bf16 v[48:51], a[208:211], v[40:43], v[48:51]
v_mfma_f32_16x16x32_bf16 v[48:51], a[212:215], v[44:47], v[48:51]
s_bitcmp1_b32 s46, 26
s_cbranch_scc0 LE_nf26
s_cmp_eq_u32 s42, 0
s_cbranch_scc1 LE_fl26
buffer_load_dwordx2 v[66:67], v39, s[20:23], s47 offen sc1
s_waitcnt vmcnt(0)
v_lshlrev_b32 v64, 16, v66
v_and_b32 v65, 0xffff0000, v66
v_add_f32 v48, v48, v64
v_add_f32 v49, v49, v65
v_lshlrev_b32 v64, 16, v67
v_and_b32 v65, 0xffff0000, v67
v_add_f32 v50, v50, v64
v_add_f32 v51, v51, v65
LE_fl26:
s_nop 3
v_cvt_pk_bf16_f32 v64, v48, v49
v_cvt_pk_bf16_f32 v65, v50, v51
v_mov_b32 v48, 0
v_mov_b32 v49, 0
v_mov_b32 v50, 0
v_mov_b32 v51, 0
buffer_store_dwordx2 v[64:65], v39, s[20:23], s47 offen sc1
s_add_u32 s47, s47, 512
LE_nf26:
v_mfma_f32_16x16x32_bf16 v[48:51], a[216:219], v[40:43], v[48:51]
v_mfma_f32_16x16x32_bf16 v[48:51], a[220:223], v[44:47], v[48:51]
s_bitcmp1_b32 s46, 27
s_cbranch_scc0 LE_nf27
s_cmp_eq_u32 s42, 0
s_cbranch_scc1 LE_fl27
buffer_load_dwordx2 v[66:67], v39, s[20:23], s47 offen sc1
s_waitcnt vmcnt(0)
v_lshlrev_b32 v64, 16, v66
v_and_b32 v65, 0xffff0000, v66
v_add_f32 v48, v48, v64
v_add_f32 v49, v49, v65
v_lshlrev_b32 v64, 16, v67
v_and_b32 v65, 0xffff0000, v67
v_add_f32 v50, v50, v64
v_add_f32 v51, v51, v65
LE_fl27:
s_nop 3
v_cvt_pk_bf16_f32 v64, v48, v49
v_cvt_pk_bf16_f32 v65, v50, v51
v_mov_b32 v48, 0
v_mov_b32 v49, 0
v_mov_b32 v50, 0
v_mov_b32 v51, 0
buffer_store_dwordx2 v[64:65], v39, s[20:23], s47 offen sc1
s_add_u32 s47, s47, 512
LE_nf27:
s_waitcnt lgkmcnt(0)
ds_read2_b32 v[56:57], v34 offset0:112 offset1:116
ds_read2_b32 v[58:59], v34 offset0:120 offset1:124
v_mad_u32_u16 v60, v52, s49, v2
v_mad_u32_u16 v61, v53, s49, v2
v_mad_u32_u16 v62, v54, s49, v2
v_mad_u32_u16 v63, v55, s49, v2
buffer_load_dwordx4 a[192:195], v60, s[16:19], 0 offen sc1
buffer_load_dwordx4 a[196:199], v60, s[16:19], 0 offen offset:256 sc1
buffer_load_dwordx4 a[200:203], v61, s[16:19], 0 offen sc1
buffer_load_dwordx4 a[204:207], v61, s[16:19], 0 offen offset:256 sc1
buffer_load_dwordx4 a[208:211], v62, s[16:19], 0 offen sc1
buffer_load_dwordx4 a[212:215], v62, s[16:19], 0 offen offset:256 sc1
buffer_load_dwordx4 a[216:219], v63, s[16:19], 0 offen sc1
buffer_load_dwordx4 a[220:223], v63, s[16:19], 0 offen offset:256 sc1
s_waitcnt vmcnt(56)
v_mfma_f32_16x16x32_bf16 v[48:51], a[224:227], v[40:43], v[48:51]
v_mfma_f32_16x16x32_bf16 v[48:51], a[228:231], v[44:47], v[48:51]
s_bitcmp1_b32 s46, 28
s_cbranch_scc0 LE_nf28
s_cmp_eq_u32 s42, 0
s_cbranch_scc1 LE_fl28
buffer_load_dwordx2 v[66:67], v39, s[20:23], s47 offen sc1
s_waitcnt vmcnt(0)
v_lshlrev_b32 v64, 16, v66
v_and_b32 v65, 0xffff0000, v66
v_add_f32 v48, v48, v64
v_add_f32 v49, v49, v65
v_lshlrev_b32 v64, 16, v67
v_and_b32 v65, 0xffff0000, v67
v_add_f32 v50, v50, v64
v_add_f32 v51, v51, v65
LE_fl28:
s_nop 3
v_cvt_pk_bf16_f32 v64, v48, v49
v_cvt_pk_bf16_f32 v65, v50, v51
v_mov_b32 v48, 0
v_mov_b32 v49, 0
v_mov_b32 v50, 0
v_mov_b32 v51, 0
buffer_store_dwordx2 v[64:65], v39, s[20:23], s47 offen sc1
s_add_u32 s47, s47, 512
LE_nf28:
v_mfma_f32_16x16x32_bf16 v[48:51], a[232:235], v[40:43], v[48:51]
v_mfma_f32_16x16x32_bf16 v[48:51], a[236:239], v[44:47], v[48:51]
s_bitcmp1_b32 s46, 29
s_cbranch_scc0 LE_nf29
s_cmp_eq_u32 s42, 0
s_cbranch_scc1 LE_fl29
buffer_load_dwordx2 v[66:67], v39, s[20:23], s47 offen sc1
s_waitcnt vmcnt(0)
v_lshlrev_b32 v64, 16, v66
v_and_b32 v65, 0xffff0000, v66
v_add_f32 v48, v48, v64
v_add_f32 v49, v49, v65
v_lshlrev_b32 v64, 16, v67
v_and_b32 v65, 0xffff0000, v67
v_add_f32 v50, v50, v64
v_add_f32 v51, v51, v65
LE_fl29:
s_nop 3
v_cvt_pk_bf16_f32 v64, v48, v49
v_cvt_pk_bf16_f32 v65, v50, v51
v_mov_b32 v48, 0
v_mov_b32 v49, 0
v_mov_b32 v50, 0
v_mov_b32 v51, 0
buffer_store_dwordx2 v[64:65], v39, s[20:23], s47 offen sc1
s_add_u32 s47, s47, 512
LE_nf29:
v_mfma_f32_16x16x32_bf16 v[48:51], a[240:243], v[40:43], v[48:51]
v_mfma_f32_16x16x32_bf16 v[48:51], a[244:247], v[44:47], v[48:51]
s_bitcmp1_b32 s46, 30
s_cbranch_scc0 LE_nf30
s_cmp_eq_u32 s42, 0
s_cbranch_scc1 LE_fl30
buffer_load_dwordx2 v[66:67], v39, s[20:23], s47 offen sc1
s_waitcnt vmcnt(0)
v_lshlrev_b32 v64, 16, v66
v_and_b32 v65, 0xffff0000, v66
v_add_f32 v48, v48, v64
v_add_f32 v49, v49, v65
v_lshlrev_b32 v64, 16, v67
v_and_b32 v65, 0xffff0000, v67
v_add_f32 v50, v50, v64
v_add_f32 v51, v51, v65
LE_fl30:
s_nop 3
v_cvt_pk_bf16_f32 v64, v48, v49
v_cvt_pk_bf16_f32 v65, v50, v51
v_mov_b32 v48, 0
v_mov_b32 v49, 0
v_mov_b32 v50, 0
v_mov_b32 v51, 0
buffer_store_dwordx2 v[64:65], v39, s[20:23], s47 offen sc1
s_add_u32 s47, s47, 512
LE_nf30:
v_mfma_f32_16x16x32_bf16 v[48:51], a[248:251], v[40:43], v[48:51]
v_mfma_f32_16x16x32_bf16 v[48:51], a[252:255], v[44:47], v[48:51]
s_bitcmp1_b32 s46, 31
s_cbranch_scc0 LE_nf31
s_cmp_eq_u32 s42, 0
s_cbranch_scc1 LE_fl31
buffer_load_dwordx2 v[66:67], v39, s[20:23], s47 offen sc1
s_waitcnt vmcnt(0)
v_lshlrev_b32 v64, 16, v66
v_and_b32 v65, 0xffff0000, v66
v_add_f32 v48, v48, v64
v_add_f32 v49, v49, v65
v_lshlrev_b32 v64, 16, v67
v_and_b32 v65, 0xffff0000, v67
v_add_f32 v50, v50, v64
v_add_f32 v51, v51, v65
LE_fl31:
s_nop 3
v_cvt_pk_bf16_f32 v64, v48, v49
v_cvt_pk_bf16_f32 v65, v50, v51
v_mov_b32 v48, 0
v_mov_b32 v49, 0
v_mov_b32 v50, 0
v_mov_b32 v51, 0
buffer_store_dwordx2 v[64:65], v39, s[20:23], s47 offen sc1
s_add_u32 s47, s47, 512
LE_nf31:
s_waitcnt lgkmcnt(0)
ds_read2_b32 v[52:53], v34 offset0:128 offset1:132
ds_read2_b32 v[54:55], v34 offset0:136 offset1:140
v_mad_u32_u16 v60, v56, s49, v2
v_mad_u32_u16 v61, v57, s49, v2
v_mad_u32_u16 v62, v58, s49, v2
v_mad_u32_u16 v63, v59, s49, v2
buffer_load_dwordx4 a[224:227], v60, s[16:19], 0 offen sc1
buffer_load_dwordx4 a[228:231], v60, s[16:19], 0 offen offset:256 sc1
buffer_load_dwordx4 a[232:235], v61, s[16:19], 0 offen sc1
buffer_load_dwordx4 a[236:239], v61, s[16:19], 0 offen offset:256 sc1
buffer_load_dwordx4 a[240:243], v62, s[16:19], 0 offen sc1
buffer_load_dwordx4 a[244:247], v62, s[16:19], 0 offen offset:256 sc1
buffer_load_dwordx4 a[248:251], v63, s[16:19], 0 offen sc1
buffer_load_dwordx4 a[252:255], v63, s[16:19], 0 offen offset:256 sc1
v_add_u32 v34, 512, v34
s_cmp_lt_u32 s45, s44
s_cbranch_scc1 LE_loop
s_add_u32 s42, s42, 1
s_mul_i32 s43, s42, 256
v_cmp_lt_u32 vcc, s43, v4
s_cbranch_vccz LE_done
s_cmp_ge_u32 s42, 40
s_cbranch_scc1 LE_done
s_waitcnt vmcnt(0) lgkmcnt(0)
s_add_u32 s50, s50, 1048576
v_add_u32 v5, 0x100, v5
buffer_load_dwordx4 v[192:195], v6, s[12:15], s50 offen offset:0 sc1
buffer_load_dwordx4 v[196:199], v6, s[12:15], s50 offen offset:64 sc1
buffer_load_dwordx4 v[200:203], v6, s[12:15], s50 offen offset:128 sc1
buffer_load_dwordx4 v[204:207], v6, s[12:15], s50 offen offset:192 sc1
buffer_load_dwordx4 v[208:211], v6, s[12:15], s50 offen offset:256 sc1
buffer_load_dwordx4 v[212:215], v6, s[12:15], s50 offen offset:320 sc1
buffer_load_dwordx4 v[216:219], v6, s[12:15], s50 offen offset:384 sc1
buffer_load_dwordx4 v[220:223], v6, s[12:15], s50 offen offset:448 sc1
buffer_load_dwordx4 v[224:227], v6, s[12:15], s50 offen offset:512 sc1
buffer_load_dwordx4 v[228:231], v6, s[12:15], s50 offen offset:576 sc1
buffer_load_dwordx4 v[232:235], v6, s[12:15], s50 offen offset:640 sc1
buffer_load_dwordx4 v[236:239], v6, s[12:15], s50 offen offset:704 sc1
buffer_load_dwordx4 v[240:243], v6, s[12:15], s50 offen offset:768 sc1
buffer_load_dwordx4 v[244:247], v6, s[12:15], s50 offen offset:832 sc1
buffer_load_dwordx4 v[248:251], v6, s[12:15], s50 offen offset:896 sc1
buffer_load_dwordx4 v[252:255], v6, s[12:15], s50 offen offset:960 sc1
s_branch LE_pass
LE_done:
s_add_u32 s24, s4, 0x7c00000
s_addc_u32 s25, s5, 0
s_mov_b32 s26, 0x40000
s_mov_b32 s27, 0x00020000
s_add_u32 s48, s40, 1280
s_mul_i32 s48, s48, 128
s_waitcnt vmcnt(0)
v_mov_b32 v32, s98
v_mov_b32 v33, s99
s_mov_b64 exec, 1
buffer_store_dwordx2 v[32:33], off, s[24:27], s48 sc1
s_mov_b64 exec, -1
s_branch L2_end
L2_fin:
L2_end:
s_endpgm
L2_hot:
L2_rare_site0:
s_mov_b32 s36, 0
s_branch L2_rare_0
L2_rare_site4:
s_mov_b32 s36, 4
s_branch L2_rare_0
L2_rare_0:
s_nop 15
s_nop 15
s_waitcnt lgkmcnt(0)
v_lshrrev_b32 v206, 8, v243
v_add_u32 v206, 1, v206
v_lshrrev_b32 v206, 2, v206
v_sub_u32 v206, 0, v206
v_and_b32 v206, 0xffff0000, v206
v_add_u32 v207, 0x18000, v240
v_and_b32 v207, 0x1ffff, v207
ds_read_b128 v[200:203], v207 offset:29184
s_waitcnt lgkmcnt(0)
v_mfma_f32_16x16x32_bf16 v[192:195], v[200:203], v[0:3], 0
s_nop 7
ds_read_b128 v[200:203], v207 offset:28672
s_waitcnt lgkmcnt(0)
v_mfma_f32_16x16x32_bf16 v[192:195], v[200:203], v[4:7], v[192:195]
s_nop 7
ds_read_b128 v[200:203], v207 offset:16384
s_waitcnt lgkmcnt(0)
v_mfma_f32_16x16x32_bf16 v[192:195], v[200:203], v[8:11], v[192:195]
s_nop 7
ds_read_b128 v[200:203], v207 offset:16896
s_waitcnt lgkmcnt(0)
v_mfma_f32_16x16x32_bf16 v[192:195], v[200:203], v[12:15], v[192:195]
s_nop 7
ds_read_b128 v[200:203], v207 offset:20480
s_waitcnt lgkmcnt(0)
v_mfma_f32_16x16x32_bf16 v[192:195], v[200:203], v[16:19], v[192:195]
s_nop 7
ds_read_b128 v[200:203], v207 offset:20992
s_waitcnt lgkmcnt(0)
v_mfma_f32_16x16x32_bf16 v[192:195], v[200:203], v[20:23], v[192:195]
s_nop 7
ds_read_b128 v[200:203], v207 offset:24576
s_waitcnt lgkmcnt(0)
v_mfma_f32_16x16x32_bf16 v[192:195], v[200:203], v[24:27], v[192:195]
s_nop 7
ds_read_b128 v[200:203], v207 offset:25088
s_waitcnt lgkmcnt(0)
v_mfma_f32_16x16x32_bf16 v[192:195], v[200:203], v[28:31], v[192:195]
s_nop 7
ds_read_b128 v[200:203], v207 offset:31232
s_waitcnt lgkmcnt(0)
v_mfma_f32_16x16x32_bf16 v[196:199], v[200:203], v[0:3], 0
s_nop 7
ds_read_b128 v[200:203], v207 offset:30720
s_waitcnt lgkmcnt(0)
v_mfma_f32_16x16x32_bf16 v[196:199], v[200:203], v[4:7], v[196:199]
s_nop 7
ds_read_b128 v[200:203], v207 offset:18432
s_waitcnt lgkmcnt(0)
v_mfma_f32_16x16x32_bf16 v[196:199], v[200:203], v[8:11], v[196:199]
s_nop 7
ds_read_b128 v[200:203], v207 offset:18944
s_waitcnt lgkmcnt(0)
v_mfma_f32_16x16x32_bf16 v[196:199], v[200:203], v[12:15], v[196:199]
s_nop 7
ds_read_b128 v[200:203], v207 offset:22528
s_waitcnt lgkmcnt(0)
v_mfma_f32_16x16x32_bf16 v[196:199], v[200:203], v[16:19], v[196:199]
s_nop 7
ds_read_b128 v[200:203], v207 offset:23040
s_waitcnt lgkmcnt(0)
v_mfma_f32_16x16x32_bf16 v[196:199], v[200:203], v[20:23], v[196:199]
s_nop 7
ds_read_b128 v[200:203], v207 offset:26624
s_waitcnt lgkmcnt(0)
v_mfma_f32_16x16x32_bf16 v[196:199], v[200:203], v[24:27], v[196:199]
s_nop 7
ds_read_b128 v[200:203], v207 offset:27136
s_waitcnt lgkmcnt(0)
v_mfma_f32_16x16x32_bf16 v[196:199], v[200:203], v[28:31], v[196:199]
s_nop 7
s_nop 7
v_max_f32 v204, v192, v193
v_max3_f32 v204, v204, v194, v195
v_max3_f32 v204, v204, v196, v197
v_max3_f32 v204, v204, v198, v199
v_mov_b32 v205, v204
s_nop 1
v_permlane32_swap_b32 v204, v205
s_nop 1
v_max_f32 v204, v204, v205
v_mov_b32 v205, v204
s_nop 1
v_permlane16_swap_b32 v204, v205
s_nop 1
v_max_f32 v204, v204, v205
v_add_f32 v204, 40.0, v204
v_ceil_f32 v204, v204
v_max_f32 v204, 0, v204
v_sub_f32 v205, v224, v204
v_cvt_pk_bf16_f32 v205, v205, v205
v_and_b32 v205, 0xffff0000, v205
v_sub_f32 v204, v205, v224
v_mov_b32 v224, v205
v_exp_f32 v236, v204
v_bfi_b32 v3, v206, v205, v3
v_add_f32 v192, v192, v204
v_add_f32 v193, v193, v204
v_add_f32 v194, v194, v204
v_add_f32 v195, v195, v204
v_add_f32 v196, v196, v204
v_add_f32 v197, v197, v204
v_add_f32 v198, v198, v204
v_add_f32 v199, v199, v204
v_add_f32 v128, v128, v204
v_add_f32 v129, v129, v204
v_add_f32 v130, v130, v204
v_add_f32 v131, v131, v204
v_lshlrev_b32 v242, 16, v160
v_and_b32 v248, 0xffff0000, v160
v_mul_f32 v242, v242, v236
v_mul_f32 v248, v248, v236
v_cvt_pk_bf16_f32 v160, v242, v248
v_lshlrev_b32 v242, 16, v161
v_and_b32 v248, 0xffff0000, v161
v_mul_f32 v242, v242, v236
v_mul_f32 v248, v248, v236
v_cvt_pk_bf16_f32 v161, v242, v248
v_lshlrev_b32 v242, 16, v162
v_and_b32 v248, 0xffff0000, v162
v_mul_f32 v242, v242, v236
v_mul_f32 v248, v248, v236
v_cvt_pk_bf16_f32 v162, v242, v248
v_lshlrev_b32 v242, 16, v163
v_and_b32 v248, 0xffff0000, v163
v_mul_f32 v242, v242, v236
v_mul_f32 v248, v248, v236
v_cvt_pk_bf16_f32 v163, v242, v248
v_exp_f32 v232, v192
v_exp_f32 v233, v193
v_exp_f32 v234, v194
v_exp_f32 v235, v195
s_nop 1
v_cvt_pk_bf16_f32 v176, v232, v233
v_cvt_pk_bf16_f32 v177, v234, v235
v_exp_f32 v232, v196
v_exp_f32 v233, v197
v_exp_f32 v234, v198
v_exp_f32 v235, v199
s_nop 1
v_cvt_pk_bf16_f32 v178, v232, v233
v_cvt_pk_bf16_f32 v179, v234, v235
ds_read_b128 v[200:203], v207 offset:29184
s_waitcnt lgkmcnt(0)
v_mfma_f32_16x16x32_bf16 v[192:195], v[200:203], v[32:35], 0
s_nop 7
ds_read_b128 v[200:203], v207 offset:28672
s_waitcnt lgkmcnt(0)
v_mfma_f32_16x16x32_bf16 v[192:195], v[200:203], v[36:39], v[192:195]
s_nop 7
ds_read_b128 v[200:203], v207 offset:16384
s_waitcnt lgkmcnt(0)
v_mfma_f32_16x16x32_bf16 v[192:195], v[200:203], v[40:43], v[192:195]
s_nop 7
ds_read_b128 v[200:203], v207 offset:16896
s_waitcnt lgkmcnt(0)
v_mfma_f32_16x16x32_bf16 v[192:195], v[200:203], v[44:47], v[192:195]
s_nop 7
ds_read_b128 v[200:203], v207 offset:20480
s_waitcnt lgkmcnt(0)
v_mfma_f32_16x16x32_bf16 v[192:195], v[200:203], v[48:51], v[192:195]
s_nop 7
ds_read_b128 v[200:203], v207 offset:20992
s_waitcnt lgkmcnt(0)
v_mfma_f32_16x16x32_bf16 v[192:195], v[200:203], v[52:55], v[192:195]
s_nop 7
ds_read_b128 v[200:203], v207 offset:24576
s_waitcnt lgkmcnt(0)
v_mfma_f32_16x16x32_bf16 v[192:195], v[200:203], v[56:59], v[192:195]
s_nop 7
ds_read_b128 v[200:203], v207 offset:25088
s_waitcnt lgkmcnt(0)
v_mfma_f32_16x16x32_bf16 v[192:195], v[200:203], v[60:63], v[192:195]
s_nop 7
ds_read_b128 v[200:203], v207 offset:31232
s_waitcnt lgkmcnt(0)
v_mfma_f32_16x16x32_bf16 v[196:199], v[200:203], v[32:35], 0
s_nop 7
ds_read_b128 v[200:203], v207 offset:30720
s_waitcnt lgkmcnt(0)
v_mfma_f32_16x16x32_bf16 v[196:199], v[200:203], v[36:39], v[196:199]
s_nop 7
ds_read_b128 v[200:203], v207 offset:18432
s_waitcnt lgkmcnt(0)
v_mfma_f32_16x16x32_bf16 v[196:199], v[200:203], v[40:43], v[196:199]
s_nop 7
ds_read_b128 v[200:203], v207 offset:18944
s_waitcnt lgkmcnt(0)
v_mfma_f32_16x16x32_bf16 v[196:199], v[200:203], v[44:47], v[196:199]
s_nop 7
ds_read_b128 v[200:203], v207 offset:22528
s_waitcnt lgkmcnt(0)
v_mfma_f32_16x16x32_bf16 v[196:199], v[200:203], v[48:51], v[196:199]
s_nop 7
ds_read_b128 v[200:203], v207 offset:23040
s_waitcnt lgkmcnt(0)
v_mfma_f32_16x16x32_bf16 v[196:199], v[200:203], v[52:55], v[196:199]
s_nop 7
ds_read_b128 v[200:203], v207 offset:26624
s_waitcnt lgkmcnt(0)
v_mfma_f32_16x16x32_bf16 v[196:199], v[200:203], v[56:59], v[196:199]
s_nop 7
ds_read_b128 v[200:203], v207 offset:27136
s_waitcnt lgkmcnt(0)
v_mfma_f32_16x16x32_bf16 v[196:199], v[200:203], v[60:63], v[196:199]
s_nop 7
s_nop 7
v_max_f32 v204, v192, v193
v_max3_f32 v204, v204, v194, v195
v_max3_f32 v204, v204, v196, v197
v_max3_f32 v204, v204, v198, v199
v_mov_b32 v205, v204
s_nop 1
v_permlane32_swap_b32 v204, v205
s_nop 1
v_max_f32 v204, v204, v205
v_mov_b32 v205, v204
s_nop 1
v_permlane16_swap_b32 v204, v205
s_nop 1
v_max_f32 v204, v204, v205
v_add_f32 v204, 40.0, v204
v_ceil_f32 v204, v204
v_max_f32 v204, 0, v204
v_sub_f32 v205, v225, v204
v_cvt_pk_bf16_f32 v205, v205, v205
v_and_b32 v205, 0xffff0000, v205
v_sub_f32 v204, v205, v225
v_mov_b32 v225, v205
v_exp_f32 v237, v204
v_bfi_b32 v35, v206, v205, v35
v_add_f32 v192, v192, v204
v_add_f32 v193, v193, v204
v_add_f32 v194, v194, v204
v_add_f32 v195, v195, v204
v_add_f32 v196, v196, v204
v_add_f32 v197, v197, v204
v_add_f32 v198, v198, v204
v_add_f32 v199, v199, v204
v_add_f32 v132, v132, v204
v_add_f32 v133, v133, v204
v_add_f32 v134, v134, v204
v_add_f32 v135, v135, v204
v_lshlrev_b32 v242, 16, v164
v_and_b32 v248, 0xffff0000, v164
v_mul_f32 v242, v242, v237
v_mul_f32 v248, v248, v237
v_cvt_pk_bf16_f32 v164, v242, v248
v_lshlrev_b32 v242, 16, v165
v_and_b32 v248, 0xffff0000, v165
v_mul_f32 v242, v242, v237
v_mul_f32 v248, v248, v237
v_cvt_pk_bf16_f32 v165, v242, v248
v_lshlrev_b32 v242, 16, v166
v_and_b32 v248, 0xffff0000, v166
v_mul_f32 v242, v242, v237
v_mul_f32 v248, v248, v237
v_cvt_pk_bf16_f32 v166, v242, v248
v_lshlrev_b32 v242, 16, v167
v_and_b32 v248, 0xffff0000, v167
v_mul_f32 v242, v242, v237
v_mul_f32 v248, v248, v237
v_cvt_pk_bf16_f32 v167, v242, v248
v_exp_f32 v232, v192
v_exp_f32 v233, v193
v_exp_f32 v234, v194
v_exp_f32 v235, v195
s_nop 1
v_cvt_pk_bf16_f32 v180, v232, v233
v_cvt_pk_bf16_f32 v181, v234, v235
v_exp_f32 v232, v196
v_exp_f32 v233, v197
v_exp_f32 v234, v198
v_exp_f32 v235, v199
s_nop 1
v_cvt_pk_bf16_f32 v182, v232, v233
v_cvt_pk_bf16_f32 v183, v234, v235
ds_read_b128 v[200:203], v207 offset:29184
s_waitcnt lgkmcnt(0)
v_mfma_f32_16x16x32_bf16 v[192:195], v[200:203], v[64:67], 0
s_nop 7
ds_read_b128 v[200:203], v207 offset:28672
s_waitcnt lgkmcnt(0)
v_mfma_f32_16x16x32_bf16 v[192:195], v[200:203], v[68:71], v[192:195]
s_nop 7
ds_read_b128 v[200:203], v207 offset:16384
s_waitcnt lgkmcnt(0)
v_mfma_f32_16x16x32_bf16 v[192:195], v[200:203], v[72:75], v[192:195]
s_nop 7
ds_read_b128 v[200:203], v207 offset:16896
s_waitcnt lgkmcnt(0)
v_mfma_f32_16x16x32_bf16 v[192:195], v[200:203], v[76:79], v[192:195]
s_nop 7
ds_read_b128 v[200:203], v207 offset:20480
s_waitcnt lgkmcnt(0)
v_mfma_f32_16x16x32_bf16 v[192:195], v[200:203], v[80:83], v[192:195]
s_nop 7
ds_read_b128 v[200:203], v207 offset:20992
s_waitcnt lgkmcnt(0)
v_mfma_f32_16x16x32_bf16 v[192:195], v[200:203], v[84:87], v[192:195]
s_nop 7
ds_read_b128 v[200:203], v207 offset:24576
s_waitcnt lgkmcnt(0)
v_mfma_f32_16x16x32_bf16 v[192:195], v[200:203], v[88:91], v[192:195]
s_nop 7
ds_read_b128 v[200:203], v207 offset:25088
s_waitcnt lgkmcnt(0)
v_mfma_f32_16x16x32_bf16 v[192:195], v[200:203], v[92:95], v[192:195]
s_nop 7
ds_read_b128 v[200:203], v207 offset:31232
s_waitcnt lgkmcnt(0)
v_mfma_f32_16x16x32_bf16 v[196:199], v[200:203], v[64:67], 0
s_nop 7
ds_read_b128 v[200:203], v207 offset:30720
s_waitcnt lgkmcnt(0)
v_mfma_f32_16x16x32_bf16 v[196:199], v[200:203], v[68:71], v[196:199]
s_nop 7
ds_read_b128 v[200:203], v207 offset:18432
s_waitcnt lgkmcnt(0)
v_mfma_f32_16x16x32_bf16 v[196:199], v[200:203], v[72:75], v[196:199]
s_nop 7
ds_read_b128 v[200:203], v207 offset:18944
s_waitcnt lgkmcnt(0)
v_mfma_f32_16x16x32_bf16 v[196:199], v[200:203], v[76:79], v[196:199]
s_nop 7
ds_read_b128 v[200:203], v207 offset:22528
s_waitcnt lgkmcnt(0)
v_mfma_f32_16x16x32_bf16 v[196:199], v[200:203], v[80:83], v[196:199]
s_nop 7
ds_read_b128 v[200:203], v207 offset:23040
s_waitcnt lgkmcnt(0)
v_mfma_f32_16x16x32_bf16 v[196:199], v[200:203], v[84:87], v[196:199]
s_nop 7
ds_read_b128 v[200:203], v207 offset:26624
s_waitcnt lgkmcnt(0)
v_mfma_f32_16x16x32_bf16 v[196:199], v[200:203], v[88:91], v[196:199]
s_nop 7
ds_read_b128 v[200:203], v207 offset:27136
s_waitcnt lgkmcnt(0)
v_mfma_f32_16x16x32_bf16 v[196:199], v[200:203], v[92:95], v[196:199]
s_nop 7
s_nop 7
v_max_f32 v204, v192, v193
v_max3_f32 v204, v204, v194, v195
v_max3_f32 v204, v204, v196, v197
v_max3_f32 v204, v204, v198, v199
v_mov_b32 v205, v204
s_nop 1
v_permlane32_swap_b32 v204, v205
s_nop 1
v_max_f32 v204, v204, v205
v_mov_b32 v205, v204
s_nop 1
v_permlane16_swap_b32 v204, v205
s_nop 1
v_max_f32 v204, v204, v205
v_add_f32 v204, 40.0, v204
v_ceil_f32 v204, v204
v_max_f32 v204, 0, v204
v_sub_f32 v205, v226, v204
v_cvt_pk_bf16_f32 v205, v205, v205
v_and_b32 v205, 0xffff0000, v205
v_sub_f32 v204, v205, v226
v_mov_b32 v226, v205
v_exp_f32 v238, v204
v_bfi_b32 v67, v206, v205, v67
v_add_f32 v192, v192, v204
v_add_f32 v193, v193, v204
v_add_f32 v194, v194, v204
v_add_f32 v195, v195, v204
v_add_f32 v196, v196, v204
v_add_f32 v197, v197, v204
v_add_f32 v198, v198, v204
v_add_f32 v199, v199, v204
v_add_f32 v136, v136, v204
v_add_f32 v137, v137, v204
v_add_f32 v138, v138, v204
v_add_f32 v139, v139, v204
v_lshlrev_b32 v242, 16, v168
v_and_b32 v248, 0xffff0000, v168
v_mul_f32 v242, v242, v238
v_mul_f32 v248, v248, v238
v_cvt_pk_bf16_f32 v168, v242, v248
v_lshlrev_b32 v242, 16, v169
v_and_b32 v248, 0xffff0000, v169
v_mul_f32 v242, v242, v238
v_mul_f32 v248, v248, v238
v_cvt_pk_bf16_f32 v169, v242, v248
v_lshlrev_b32 v242, 16, v170
v_and_b32 v248, 0xffff0000, v170
v_mul_f32 v242, v242, v238
v_mul_f32 v248, v248, v238
v_cvt_pk_bf16_f32 v170, v242, v248
v_lshlrev_b32 v242, 16, v171
v_and_b32 v248, 0xffff0000, v171
v_mul_f32 v242, v242, v238
v_mul_f32 v248, v248, v238
v_cvt_pk_bf16_f32 v171, v242, v248
v_exp_f32 v232, v192
v_exp_f32 v233, v193
v_exp_f32 v234, v194
v_exp_f32 v235, v195
s_nop 1
v_cvt_pk_bf16_f32 v184, v232, v233
v_cvt_pk_bf16_f32 v185, v234, v235
v_exp_f32 v232, v196
v_exp_f32 v233, v197
v_exp_f32 v234, v198
v_exp_f32 v235, v199
s_nop 1
v_cvt_pk_bf16_f32 v186, v232, v233
v_cvt_pk_bf16_f32 v187, v234, v235
ds_read_b128 v[200:203], v207 offset:29184
s_waitcnt lgkmcnt(0)
v_mfma_f32_16x16x32_bf16 v[192:195], v[200:203], v[96:99], 0
s_nop 7
ds_read_b128 v[200:203], v207 offset:28672
s_waitcnt lgkmcnt(0)
v_mfma_f32_16x16x32_bf16 v[192:195], v[200:203], v[100:103], v[192:195]
s_nop 7
ds_read_b128 v[200:203], v207 offset:16384
s_waitcnt lgkmcnt(0)
v_mfma_f32_16x16x32_bf16 v[192:195], v[200:203], v[104:107], v[192:195]
s_nop 7
ds_read_b128 v[200:203], v207 offset:16896
s_waitcnt lgkmcnt(0)
v_mfma_f32_16x16x32_bf16 v[192:195], v[200:203], v[108:111], v[192:195]
s_nop 7
ds_read_b128 v[200:203], v207 offset:20480
s_waitcnt lgkmcnt(0)
v_mfma_f32_16x16x32_bf16 v[192:195], v[200:203], v[112:115], v[192:195]
s_nop 7
ds_read_b128 v[200:203], v207 offset:20992
s_waitcnt lgkmcnt(0)
v_mfma_f32_16x16x32_bf16 v[192:195], v[200:203], v[116:119], v[192:195]
s_nop 7
ds_read_b128 v[200:203], v207 offset:24576
s_waitcnt lgkmcnt(0)
v_mfma_f32_16x16x32_bf16 v[192:195], v[200:203], v[120:123], v[192:195]
s_nop 7
ds_read_b128 v[200:203], v207 offset:25088
s_waitcnt lgkmcnt(0)
v_mfma_f32_16x16x32_bf16 v[192:195], v[200:203], v[124:127], v[192:195]
s_nop 7
ds_read_b128 v[200:203], v207 offset:31232
s_waitcnt lgkmcnt(0)
v_mfma_f32_16x16x32_bf16 v[196:199], v[200:203], v[96:99], 0
s_nop 7
ds_read_b128 v[200:203], v207 offset:30720
s_waitcnt lgkmcnt(0)
v_mfma_f32_16x16x32_bf16 v[196:199], v[200:203], v[100:103], v[196:199]
s_nop 7
ds_read_b128 v[200:203], v207 offset:18432
s_waitcnt lgkmcnt(0)
v_mfma_f32_16x16x32_bf16 v[196:199], v[200:203], v[104:107], v[196:199]
s_nop 7
ds_read_b128 v[200:203], v207 offset:18944
s_waitcnt lgkmcnt(0)
v_mfma_f32_16x16x32_bf16 v[196:199], v[200:203], v[108:111], v[196:199]
s_nop 7
ds_read_b128 v[200:203], v207 offset:22528
s_waitcnt lgkmcnt(0)
v_mfma_f32_16x16x32_bf16 v[196:199], v[200:203], v[112:115], v[196:199]
s_nop 7
ds_read_b128 v[200:203], v207 offset:23040
s_waitcnt lgkmcnt(0)
v_mfma_f32_16x16x32_bf16 v[196:199], v[200:203], v[116:119], v[196:199]
s_nop 7
ds_read_b128 v[200:203], v207 offset:26624
s_waitcnt lgkmcnt(0)
v_mfma_f32_16x16x32_bf16 v[196:199], v[200:203], v[120:123], v[196:199]
s_nop 7
ds_read_b128 v[200:203], v207 offset:27136
s_waitcnt lgkmcnt(0)
v_mfma_f32_16x16x32_bf16 v[196:199], v[200:203], v[124:127], v[196:199]
s_nop 7
s_nop 7
v_max_f32 v204, v192, v193
v_max3_f32 v204, v204, v194, v195
v_max3_f32 v204, v204, v196, v197
v_max3_f32 v204, v204, v198, v199
v_mov_b32 v205, v204
s_nop 1
v_permlane32_swap_b32 v204, v205
s_nop 1
v_max_f32 v204, v204, v205
v_mov_b32 v205, v204
s_nop 1
v_permlane16_swap_b32 v204, v205
s_nop 1
v_max_f32 v204, v204, v205
v_add_f32 v204, 40.0, v204
v_ceil_f32 v204, v204
v_max_f32 v204, 0, v204
v_sub_f32 v205, v227, v204
v_cvt_pk_bf16_f32 v205, v205, v205
v_and_b32 v205, 0xffff0000, v205
v_sub_f32 v204, v205, v227
v_mov_b32 v227, v205
v_exp_f32 v239, v204
v_bfi_b32 v99, v206, v205, v99
v_add_f32 v192, v192, v204
v_add_f32 v193, v193, v204
v_add_f32 v194, v194, v204
v_add_f32 v195, v195, v204
v_add_f32 v196, v196, v204
v_add_f32 v197, v197, v204
v_add_f32 v198, v198, v204
v_add_f32 v199, v199, v204
v_add_f32 v140, v140, v204
v_add_f32 v141, v141, v204
v_add_f32 v142, v142, v204
v_add_f32 v143, v143, v204
v_lshlrev_b32 v242, 16, v172
v_and_b32 v248, 0xffff0000, v172
v_mul_f32 v242, v242, v239
v_mul_f32 v248, v248, v239
v_cvt_pk_bf16_f32 v172, v242, v248
v_lshlrev_b32 v242, 16, v173
v_and_b32 v248, 0xffff0000, v173
v_mul_f32 v242, v242, v239
v_mul_f32 v248, v248, v239
v_cvt_pk_bf16_f32 v173, v242, v248
v_lshlrev_b32 v242, 16, v174
v_and_b32 v248, 0xffff0000, v174
v_mul_f32 v242, v242, v239
v_mul_f32 v248, v248, v239
v_cvt_pk_bf16_f32 v174, v242, v248
v_lshlrev_b32 v242, 16, v175
v_and_b32 v248, 0xffff0000, v175
v_mul_f32 v242, v242, v239
v_mul_f32 v248, v248, v239
v_cvt_pk_bf16_f32 v175, v242, v248
v_exp_f32 v232, v192
v_exp_f32 v233, v193
v_exp_f32 v234, v194
v_exp_f32 v235, v195
s_nop 1
v_cvt_pk_bf16_f32 v188, v232, v233
v_cvt_pk_bf16_f32 v189, v234, v235
v_exp_f32 v232, v196
v_exp_f32 v233, v197
v_exp_f32 v234, v198
v_exp_f32 v235, v199
s_nop 1
v_cvt_pk_bf16_f32 v190, v232, v233
v_cvt_pk_bf16_f32 v191, v234, v235
s_branch L2_rare_common
L2_rare_site2:
s_mov_b32 s36, 2
s_branch L2_rare_1
L2_rare_1:
s_nop 15
s_nop 15
s_waitcnt lgkmcnt(0)
v_lshrrev_b32 v206, 8, v243
v_add_u32 v206, 1, v206
v_lshrrev_b32 v206, 2, v206
v_sub_u32 v206, 0, v206
v_and_b32 v206, 0xffff0000, v206
v_add_u32 v207, 0x0, v240
v_and_b32 v207, 0x1ffff, v207
ds_read_b128 v[200:203], v207 offset:12800
s_waitcnt lgkmcnt(0)
v_mfma_f32_16x16x32_bf16 v[192:195], v[200:203], v[0:3], 0
s_nop 7
ds_read_b128 v[200:203], v207 offset:12288
s_waitcnt lgkmcnt(0)
v_mfma_f32_16x16x32_bf16 v[192:195], v[200:203], v[4:7], v[192:195]
s_nop 7
ds_read_b128 v[200:203], v207 offset:0
s_waitcnt lgkmcnt(0)
v_mfma_f32_16x16x32_bf16 v[192:195], v[200:203], v[8:11], v[192:195]
s_nop 7
ds_read_b128 v[200:203], v207 offset:512
s_waitcnt lgkmcnt(0)
v_mfma_f32_16x16x32_bf16 v[192:195], v[200:203], v[12:15], v[192:195]
s_nop 7
ds_read_b128 v[200:203], v207 offset:4096
s_waitcnt lgkmcnt(0)
v_mfma_f32_16x16x32_bf16 v[192:195], v[200:203], v[16:19], v[192:195]
s_nop 7
ds_read_b128 v[200:203], v207 offset:4608
s_waitcnt lgkmcnt(0)
v_mfma_f32_16x16x32_bf16 v[192:195], v[200:203], v[20:23], v[192:195]
s_nop 7
ds_read_b128 v[200:203], v207 offset:8192
s_waitcnt lgkmcnt(0)
v_mfma_f32_16x16x32_bf16 v[192:195], v[200:203], v[24:27], v[192:195]
s_nop 7
ds_read_b128 v[200:203], v207 offset:8704
s_waitcnt lgkmcnt(0)
v_mfma_f32_16x16x32_bf16 v[192:195], v[200:203], v[28:31], v[192:195]
s_nop 7
ds_read_b128 v[200:203], v207 offset:14848
s_waitcnt lgkmcnt(0)
v_mfma_f32_16x16x32_bf16 v[196:199], v[200:203], v[0:3], 0
s_nop 7
ds_read_b128 v[200:203], v207 offset:14336
s_waitcnt lgkmcnt(0)
v_mfma_f32_16x16x32_bf16 v[196:199], v[200:203], v[4:7], v[196:199]
s_nop 7
ds_read_b128 v[200:203], v207 offset:2048
s_waitcnt lgkmcnt(0)
v_mfma_f32_16x16x32_bf16 v[196:199], v[200:203], v[8:11], v[196:199]
s_nop 7
ds_read_b128 v[200:203], v207 offset:2560
s_waitcnt lgkmcnt(0)
v_mfma_f32_16x16x32_bf16 v[196:199], v[200:203], v[12:15], v[196:199]
s_nop 7
ds_read_b128 v[200:203], v207 offset:6144
s_waitcnt lgkmcnt(0)
v_mfma_f32_16x16x32_bf16 v[196:199], v[200:203], v[16:19], v[196:199]
s_nop 7
ds_read_b128 v[200:203], v207 offset:6656
s_waitcnt lgkmcnt(0)
v_mfma_f32_16x16x32_bf16 v[196:199], v[200:203], v[20:23], v[196:199]
s_nop 7
ds_read_b128 v[200:203], v207 offset:10240
s_waitcnt lgkmcnt(0)
v_mfma_f32_16x16x32_bf16 v[196:199], v[200:203], v[24:27], v[196:199]
s_nop 7
ds_read_b128 v[200:203], v207 offset:10752
s_waitcnt lgkmcnt(0)
v_mfma_f32_16x16x32_bf16 v[196:199], v[200:203], v[28:31], v[196:199]
s_nop 7
s_nop 7
v_max_f32 v204, v192, v193
v_max3_f32 v204, v204, v194, v195
v_max3_f32 v204, v204, v196, v197
v_max3_f32 v204, v204, v198, v199
v_mov_b32 v205, v204
s_nop 1
v_permlane32_swap_b32 v204, v205
s_nop 1
v_max_f32 v204, v204, v205
v_mov_b32 v205, v204
s_nop 1
v_permlane16_swap_b32 v204, v205
s_nop 1
v_max_f32 v204, v204, v205
v_add_f32 v204, 40.0, v204
v_ceil_f32 v204, v204
v_max_f32 v204, 0, v204
v_sub_f32 v205, v224, v204
v_cvt_pk_bf16_f32 v205, v205, v205
v_and_b32 v205, 0xffff0000, v205
v_sub_f32 v204, v205, v224
v_mov_b32 v224, v205
v_exp_f32 v236, v204
v_bfi_b32 v3, v206, v205, v3
v_add_f32 v192, v192, v204
v_add_f32 v193, v193, v204
v_add_f32 v194, v194, v204
v_add_f32 v195, v195, v204
v_add_f32 v196, v196, v204
v_add_f32 v197, v197, v204
v_add_f32 v198, v198, v204
v_add_f32 v199, v199, v204
v_add_f32 v128, v128, v204
v_add_f32 v129, v129, v204
v_add_f32 v130, v130, v204
v_add_f32 v131, v131, v204
v_lshlrev_b32 v242, 16, v176
v_and_b32 v248, 0xffff0000, v176
v_mul_f32 v242, v242, v236
v_mul_f32 v248, v248, v236
v_cvt_pk_bf16_f32 v176, v242, v248
v_lshlrev_b32 v242, 16, v177
v_and_b32 v248, 0xffff0000, v177
v_mul_f32 v242, v242, v236
v_mul_f32 v248, v248, v236
v_cvt_pk_bf16_f32 v177, v242, v248
v_lshlrev_b32 v242, 16, v178
v_and_b32 v248, 0xffff0000, v178
v_mul_f32 v242, v242, v236
v_mul_f32 v248, v248, v236
v_cvt_pk_bf16_f32 v178, v242, v248
v_lshlrev_b32 v242, 16, v179
v_and_b32 v248, 0xffff0000, v179
v_mul_f32 v242, v242, v236
v_mul_f32 v248, v248, v236
v_cvt_pk_bf16_f32 v179, v242, v248
v_exp_f32 v232, v192
v_exp_f32 v233, v193
v_exp_f32 v234, v194
v_exp_f32 v235, v195
s_nop 1
v_cvt_pk_bf16_f32 v160, v232, v233
v_cvt_pk_bf16_f32 v161, v234, v235
v_exp_f32 v232, v196
v_exp_f32 v233, v197
v_exp_f32 v234, v198
v_exp_f32 v235, v199
s_nop 1
v_cvt_pk_bf16_f32 v162, v232, v233
v_cvt_pk_bf16_f32 v163, v234, v235
ds_read_b128 v[200:203], v207 offset:12800
s_waitcnt lgkmcnt(0)
v_mfma_f32_16x16x32_bf16 v[192:195], v[200:203], v[32:35], 0
s_nop 7
ds_read_b128 v[200:203], v207 offset:12288
s_waitcnt lgkmcnt(0)
v_mfma_f32_16x16x32_bf16 v[192:195], v[200:203], v[36:39], v[192:195]
s_nop 7
ds_read_b128 v[200:203], v207 offset:0
s_waitcnt lgkmcnt(0)
v_mfma_f32_16x16x32_bf16 v[192:195], v[200:203], v[40:43], v[192:195]
s_nop 7
ds_read_b128 v[200:203], v207 offset:512
s_waitcnt lgkmcnt(0)
v_mfma_f32_16x16x32_bf16 v[192:195], v[200:203], v[44:47], v[192:195]
s_nop 7
ds_read_b128 v[200:203], v207 offset:4096
s_waitcnt lgkmcnt(0)
v_mfma_f32_16x16x32_bf16 v[192:195], v[200:203], v[48:51], v[192:195]
s_nop 7
ds_read_b128 v[200:203], v207 offset:4608
s_waitcnt lgkmcnt(0)
v_mfma_f32_16x16x32_bf16 v[192:195], v[200:203], v[52:55], v[192:195]
s_nop 7
ds_read_b128 v[200:203], v207 offset:8192
s_waitcnt lgkmcnt(0)
v_mfma_f32_16x16x32_bf16 v[192:195], v[200:203], v[56:59], v[192:195]
s_nop 7
ds_read_b128 v[200:203], v207 offset:8704
s_waitcnt lgkmcnt(0)
v_mfma_f32_16x16x32_bf16 v[192:195], v[200:203], v[60:63], v[192:195]
s_nop 7
ds_read_b128 v[200:203], v207 offset:14848
s_waitcnt lgkmcnt(0)
v_mfma_f32_16x16x32_bf16 v[196:199], v[200:203], v[32:35], 0
s_nop 7
ds_read_b128 v[200:203], v207 offset:14336
s_waitcnt lgkmcnt(0)
v_mfma_f32_16x16x32_bf16 v[196:199], v[200:203], v[36:39], v[196:199]
s_nop 7
ds_read_b128 v[200:203], v207 offset:2048
s_waitcnt lgkmcnt(0)
v_mfma_f32_16x16x32_bf16 v[196:199], v[200:203], v[40:43], v[196:199]
s_nop 7
ds_read_b128 v[200:203], v207 offset:2560
s_waitcnt lgkmcnt(0)
v_mfma_f32_16x16x32_bf16 v[196:199], v[200:203], v[44:47], v[196:199]
s_nop 7
ds_read_b128 v[200:203], v207 offset:6144
s_waitcnt lgkmcnt(0)
v_mfma_f32_16x16x32_bf16 v[196:199], v[200:203], v[48:51], v[196:199]
s_nop 7
ds_read_b128 v[200:203], v207 offset:6656
s_waitcnt lgkmcnt(0)
v_mfma_f32_16x16x32_bf16 v[196:199], v[200:203], v[52:55], v[196:199]
s_nop 7
ds_read_b128 v[200:203], v207 offset:10240
s_waitcnt lgkmcnt(0)
v_mfma_f32_16x16x32_bf16 v[196:199], v[200:203], v[56:59], v[196:199]
s_nop 7
ds_read_b128 v[200:203], v207 offset:10752
s_waitcnt lgkmcnt(0)
v_mfma_f32_16x16x32_bf16 v[196:199], v[200:203], v[60:63], v[196:199]
s_nop 7
s_nop 7
v_max_f32 v204, v192, v193
v_max3_f32 v204, v204, v194, v195
v_max3_f32 v204, v204, v196, v197
v_max3_f32 v204, v204, v198, v199
v_mov_b32 v205, v204
s_nop 1
v_permlane32_swap_b32 v204, v205
s_nop 1
v_max_f32 v204, v204, v205
v_mov_b32 v205, v204
s_nop 1
v_permlane16_swap_b32 v204, v205
s_nop 1
v_max_f32 v204, v204, v205
v_add_f32 v204, 40.0, v204
v_ceil_f32 v204, v204
v_max_f32 v204, 0, v204
v_sub_f32 v205, v225, v204
v_cvt_pk_bf16_f32 v205, v205, v205
v_and_b32 v205, 0xffff0000, v205
v_sub_f32 v204, v205, v225
v_mov_b32 v225, v205
v_exp_f32 v237, v204
v_bfi_b32 v35, v206, v205, v35
v_add_f32 v192, v192, v204
v_add_f32 v193, v193, v204
v_add_f32 v194, v194, v204
v_add_f32 v195, v195, v204
v_add_f32 v196, v196, v204
v_add_f32 v197, v197, v204
v_add_f32 v198, v198, v204
v_add_f32 v199, v199, v204
v_add_f32 v132, v132, v204
v_add_f32 v133, v133, v204
v_add_f32 v134, v134, v204
v_add_f32 v135, v135, v204
v_lshlrev_b32 v242, 16, v180
v_and_b32 v248, 0xffff0000, v180
v_mul_f32 v242, v242, v237
v_mul_f32 v248, v248, v237
v_cvt_pk_bf16_f32 v180, v242, v248
v_lshlrev_b32 v242, 16, v181
v_and_b32 v248, 0xffff0000, v181
v_mul_f32 v242, v242, v237
v_mul_f32 v248, v248, v237
v_cvt_pk_bf16_f32 v181, v242, v248
v_lshlrev_b32 v242, 16, v182
v_and_b32 v248, 0xffff0000, v182
v_mul_f32 v242, v242, v237
v_mul_f32 v248, v248, v237
v_cvt_pk_bf16_f32 v182, v242, v248
v_lshlrev_b32 v242, 16, v183
v_and_b32 v248, 0xffff0000, v183
v_mul_f32 v242, v242, v237
v_mul_f32 v248, v248, v237
v_cvt_pk_bf16_f32 v183, v242, v248
v_exp_f32 v232, v192
v_exp_f32 v233, v193
v_exp_f32 v234, v194
v_exp_f32 v235, v195
s_nop 1
v_cvt_pk_bf16_f32 v164, v232, v233
v_cvt_pk_bf16_f32 v165, v234, v235
v_exp_f32 v232, v196
v_exp_f32 v233, v197
v_exp_f32 v234, v198
v_exp_f32 v235, v199
s_nop 1
v_cvt_pk_bf16_f32 v166, v232, v233
v_cvt_pk_bf16_f32 v167, v234, v235
ds_read_b128 v[200:203], v207 offset:12800
s_waitcnt lgkmcnt(0)
v_mfma_f32_16x16x32_bf16 v[192:195], v[200:203], v[64:67], 0
s_nop 7
ds_read_b128 v[200:203], v207 offset:12288
s_waitcnt lgkmcnt(0)
v_mfma_f32_16x16x32_bf16 v[192:195], v[200:203], v[68:71], v[192:195]
s_nop 7
ds_read_b128 v[200:203], v207 offset:0
s_waitcnt lgkmcnt(0)
v_mfma_f32_16x16x32_bf16 v[192:195], v[200:203], v[72:75], v[192:195]
s_nop 7
ds_read_b128 v[200:203], v207 offset:512
s_waitcnt lgkmcnt(0)
v_mfma_f32_16x16x32_bf16 v[192:195], v[200:203], v[76:79], v[192:195]
s_nop 7
ds_read_b128 v[200:203], v207 offset:4096
s_waitcnt lgkmcnt(0)
v_mfma_f32_16x16x32_bf16 v[192:195], v[200:203], v[80:83], v[192:195]
s_nop 7
ds_read_b128 v[200:203], v207 offset:4608
s_waitcnt lgkmcnt(0)
v_mfma_f32_16x16x32_bf16 v[192:195], v[200:203], v[84:87], v[192:195]
s_nop 7
ds_read_b128 v[200:203], v207 offset:8192
s_waitcnt lgkmcnt(0)
v_mfma_f32_16x16x32_bf16 v[192:195], v[200:203], v[88:91], v[192:195]
s_nop 7
ds_read_b128 v[200:203], v207 offset:8704
s_waitcnt lgkmcnt(0)
v_mfma_f32_16x16x32_bf16 v[192:195], v[200:203], v[92:95], v[192:195]
s_nop 7
ds_read_b128 v[200:203], v207 offset:14848
s_waitcnt lgkmcnt(0)
v_mfma_f32_16x16x32_bf16 v[196:199], v[200:203], v[64:67], 0
s_nop 7
ds_read_b128 v[200:203], v207 offset:14336
s_waitcnt lgkmcnt(0)
v_mfma_f32_16x16x32_bf16 v[196:199], v[200:203], v[68:71], v[196:199]
s_nop 7
ds_read_b128 v[200:203], v207 offset:2048
s_waitcnt lgkmcnt(0)
v_mfma_f32_16x16x32_bf16 v[196:199], v[200:203], v[72:75], v[196:199]
s_nop 7
ds_read_b128 v[200:203], v207 offset:2560
s_waitcnt lgkmcnt(0)
v_mfma_f32_16x16x32_bf16 v[196:199], v[200:203], v[76:79], v[196:199]
s_nop 7
ds_read_b128 v[200:203], v207 offset:6144
s_waitcnt lgkmcnt(0)
v_mfma_f32_16x16x32_bf16 v[196:199], v[200:203], v[80:83], v[196:199]
s_nop 7
ds_read_b128 v[200:203], v207 offset:6656
s_waitcnt lgkmcnt(0)
v_mfma_f32_16x16x32_bf16 v[196:199], v[200:203], v[84:87], v[196:199]
s_nop 7
ds_read_b128 v[200:203], v207 offset:10240
s_waitcnt lgkmcnt(0)
v_mfma_f32_16x16x32_bf16 v[196:199], v[200:203], v[88:91], v[196:199]
s_nop 7
ds_read_b128 v[200:203], v207 offset:10752
s_waitcnt lgkmcnt(0)
v_mfma_f32_16x16x32_bf16 v[196:199], v[200:203], v[92:95], v[196:199]
s_nop 7
s_nop 7
v_max_f32 v204, v192, v193
v_max3_f32 v204, v204, v194, v195
v_max3_f32 v204, v204, v196, v197
v_max3_f32 v204, v204, v198, v199
v_mov_b32 v205, v204
s_nop 1
v_permlane32_swap_b32 v204, v205
s_nop 1
v_max_f32 v204, v204, v205
v_mov_b32 v205, v204
s_nop 1
v_permlane16_swap_b32 v204, v205
s_nop 1
v_max_f32 v204, v204, v205
v_add_f32 v204, 40.0, v204
v_ceil_f32 v204, v204
v_max_f32 v204, 0, v204
v_sub_f32 v205, v226, v204
v_cvt_pk_bf16_f32 v205, v205, v205
v_and_b32 v205, 0xffff0000, v205
v_sub_f32 v204, v205, v226
v_mov_b32 v226, v205
v_exp_f32 v238, v204
v_bfi_b32 v67, v206, v205, v67
v_add_f32 v192, v192, v204
v_add_f32 v193, v193, v204
v_add_f32 v194, v194, v204
v_add_f32 v195, v195, v204
v_add_f32 v196, v196, v204
v_add_f32 v197, v197, v204
v_add_f32 v198, v198, v204
v_add_f32 v199, v199, v204
v_add_f32 v136, v136, v204
v_add_f32 v137, v137, v204
v_add_f32 v138, v138, v204
v_add_f32 v139, v139, v204
v_lshlrev_b32 v242, 16, v184
v_and_b32 v248, 0xffff0000, v184
v_mul_f32 v242, v242, v238
v_mul_f32 v248, v248, v238
v_cvt_pk_bf16_f32 v184, v242, v248
v_lshlrev_b32 v242, 16, v185
v_and_b32 v248, 0xffff0000, v185
v_mul_f32 v242, v242, v238
v_mul_f32 v248, v248, v238
v_cvt_pk_bf16_f32 v185, v242, v248
v_lshlrev_b32 v242, 16, v186
v_and_b32 v248, 0xffff0000, v186
v_mul_f32 v242, v242, v238
v_mul_f32 v248, v248, v238
v_cvt_pk_bf16_f32 v186, v242, v248
v_lshlrev_b32 v242, 16, v187
v_and_b32 v248, 0xffff0000, v187
v_mul_f32 v242, v242, v238
v_mul_f32 v248, v248, v238
v_cvt_pk_bf16_f32 v187, v242, v248
v_exp_f32 v232, v192
v_exp_f32 v233, v193
v_exp_f32 v234, v194
v_exp_f32 v235, v195
s_nop 1
v_cvt_pk_bf16_f32 v168, v232, v233
v_cvt_pk_bf16_f32 v169, v234, v235
v_exp_f32 v232, v196
v_exp_f32 v233, v197
v_exp_f32 v234, v198
v_exp_f32 v235, v199
s_nop 1
v_cvt_pk_bf16_f32 v170, v232, v233
v_cvt_pk_bf16_f32 v171, v234, v235
ds_read_b128 v[200:203], v207 offset:12800
s_waitcnt lgkmcnt(0)
v_mfma_f32_16x16x32_bf16 v[192:195], v[200:203], v[96:99], 0
s_nop 7
ds_read_b128 v[200:203], v207 offset:12288
s_waitcnt lgkmcnt(0)
v_mfma_f32_16x16x32_bf16 v[192:195], v[200:203], v[100:103], v[192:195]
s_nop 7
ds_read_b128 v[200:203], v207 offset:0
s_waitcnt lgkmcnt(0)
v_mfma_f32_16x16x32_bf16 v[192:195], v[200:203], v[104:107], v[192:195]
s_nop 7
ds_read_b128 v[200:203], v207 offset:512
s_waitcnt lgkmcnt(0)
v_mfma_f32_16x16x32_bf16 v[192:195], v[200:203], v[108:111], v[192:195]
s_nop 7
ds_read_b128 v[200:203], v207 offset:4096
s_waitcnt lgkmcnt(0)
v_mfma_f32_16x16x32_bf16 v[192:195], v[200:203], v[112:115], v[192:195]
s_nop 7
ds_read_b128 v[200:203], v207 offset:4608
s_waitcnt lgkmcnt(0)
v_mfma_f32_16x16x32_bf16 v[192:195], v[200:203], v[116:119], v[192:195]
s_nop 7
ds_read_b128 v[200:203], v207 offset:8192
s_waitcnt lgkmcnt(0)
v_mfma_f32_16x16x32_bf16 v[192:195], v[200:203], v[120:123], v[192:195]
s_nop 7
ds_read_b128 v[200:203], v207 offset:8704
s_waitcnt lgkmcnt(0)
v_mfma_f32_16x16x32_bf16 v[192:195], v[200:203], v[124:127], v[192:195]
s_nop 7
ds_read_b128 v[200:203], v207 offset:14848
s_waitcnt lgkmcnt(0)
v_mfma_f32_16x16x32_bf16 v[196:199], v[200:203], v[96:99], 0
s_nop 7
ds_read_b128 v[200:203], v207 offset:14336
s_waitcnt lgkmcnt(0)
v_mfma_f32_16x16x32_bf16 v[196:199], v[200:203], v[100:103], v[196:199]
s_nop 7
ds_read_b128 v[200:203], v207 offset:2048
s_waitcnt lgkmcnt(0)
v_mfma_f32_16x16x32_bf16 v[196:199], v[200:203], v[104:107], v[196:199]
s_nop 7
ds_read_b128 v[200:203], v207 offset:2560
s_waitcnt lgkmcnt(0)
v_mfma_f32_16x16x32_bf16 v[196:199], v[200:203], v[108:111], v[196:199]
s_nop 7
ds_read_b128 v[200:203], v207 offset:6144
s_waitcnt lgkmcnt(0)
v_mfma_f32_16x16x32_bf16 v[196:199], v[200:203], v[112:115], v[196:199]
s_nop 7
ds_read_b128 v[200:203], v207 offset:6656
s_waitcnt lgkmcnt(0)
v_mfma_f32_16x16x32_bf16 v[196:199], v[200:203], v[116:119], v[196:199]
s_nop 7
ds_read_b128 v[200:203], v207 offset:10240
s_waitcnt lgkmcnt(0)
v_mfma_f32_16x16x32_bf16 v[196:199], v[200:203], v[120:123], v[196:199]
s_nop 7
ds_read_b128 v[200:203], v207 offset:10752
s_waitcnt lgkmcnt(0)
v_mfma_f32_16x16x32_bf16 v[196:199], v[200:203], v[124:127], v[196:199]
s_nop 7
s_nop 7
v_max_f32 v204, v192, v193
v_max3_f32 v204, v204, v194, v195
v_max3_f32 v204, v204, v196, v197
v_max3_f32 v204, v204, v198, v199
v_mov_b32 v205, v204
s_nop 1
v_permlane32_swap_b32 v204, v205
s_nop 1
v_max_f32 v204, v204, v205
v_mov_b32 v205, v204
s_nop 1
v_permlane16_swap_b32 v204, v205
s_nop 1
v_max_f32 v204, v204, v205
v_add_f32 v204, 40.0, v204
v_ceil_f32 v204, v204
v_max_f32 v204, 0, v204
v_sub_f32 v205, v227, v204
v_cvt_pk_bf16_f32 v205, v205, v205
v_and_b32 v205, 0xffff0000, v205
v_sub_f32 v204, v205, v227
v_mov_b32 v227, v205
v_exp_f32 v239, v204
v_bfi_b32 v99, v206, v205, v99
v_add_f32 v192, v192, v204
v_add_f32 v193, v193, v204
v_add_f32 v194, v194, v204
v_add_f32 v195, v195, v204
v_add_f32 v196, v196, v204
v_add_f32 v197, v197, v204
v_add_f32 v198, v198, v204
v_add_f32 v199, v199, v204
v_add_f32 v140, v140, v204
v_add_f32 v141, v141, v204
v_add_f32 v142, v142, v204
v_add_f32 v143, v143, v204
v_lshlrev_b32 v242, 16, v188
v_and_b32 v248, 0xffff0000, v188
v_mul_f32 v242, v242, v239
v_mul_f32 v248, v248, v239
v_cvt_pk_bf16_f32 v188, v242, v248
v_lshlrev_b32 v242, 16, v189
v_and_b32 v248, 0xffff0000, v189
v_mul_f32 v242, v242, v239
v_mul_f32 v248, v248, v239
v_cvt_pk_bf16_f32 v189, v242, v248
v_lshlrev_b32 v242, 16, v190
v_and_b32 v248, 0xffff0000, v190
v_mul_f32 v242, v242, v239
v_mul_f32 v248, v248, v239
v_cvt_pk_bf16_f32 v190, v242, v248
v_lshlrev_b32 v242, 16, v191
v_and_b32 v248, 0xffff0000, v191
v_mul_f32 v242, v242, v239
v_mul_f32 v248, v248, v239
v_cvt_pk_bf16_f32 v191, v242, v248
v_exp_f32 v232, v192
v_exp_f32 v233, v193
v_exp_f32 v234, v194
v_exp_f32 v235, v195
s_nop 1
v_cvt_pk_bf16_f32 v172, v232, v233
v_cvt_pk_bf16_f32 v173, v234, v235
v_exp_f32 v232, v196
v_exp_f32 v233, v197
v_exp_f32 v234, v198
v_exp_f32 v235, v199
s_nop 1
v_cvt_pk_bf16_f32 v174, v232, v233
v_cvt_pk_bf16_f32 v175, v234, v235
s_branch L2_rare_common
L2_rare_site6:
s_mov_b32 s36, 6
s_branch L2_rare_t1_0
L2_rare_t1_0:
s_nop 15
s_nop 15
s_waitcnt lgkmcnt(0)
v_lshrrev_b32 v206, 8, v243
v_add_u32 v206, 1, v206
v_lshrrev_b32 v206, 2, v206
v_sub_u32 v206, 0, v206
v_and_b32 v206, 0xffff0000, v206
v_max_f32 v204, v128, v129
v_max3_f32 v204, v204, v130, v131
v_mov_b32 v205, v204
s_nop 1
v_permlane32_swap_b32 v204, v205
s_nop 1
v_max_f32 v204, v204, v205
v_mov_b32 v205, v204
s_nop 1
v_permlane16_swap_b32 v204, v205
s_nop 1
v_max_f32 v204, v204, v205
v_add_f32 v204, 40.0, v204
v_ceil_f32 v204, v204
v_max_f32 v204, 0, v204
v_sub_f32 v205, v224, v204
v_cvt_pk_bf16_f32 v205, v205, v205
v_and_b32 v205, 0xffff0000, v205
v_sub_f32 v204, v205, v224
v_mov_b32 v224, v205
v_exp_f32 v236, v204
v_bfi_b32 v3, v206, v205, v3
v_add_f32 v128, v128, v204
v_add_f32 v129, v129, v204
v_add_f32 v130, v130, v204
v_add_f32 v131, v131, v204
v_add_f32 v144, v144, v204
v_add_f32 v145, v145, v204
v_add_f32 v146, v146, v204
v_add_f32 v147, v147, v204
v_lshlrev_b32 v242, 16, v160
v_and_b32 v248, 0xffff0000, v160
v_mul_f32 v242, v242, v236
v_mul_f32 v248, v248, v236
v_cvt_pk_bf16_f32 v160, v242, v248
v_lshlrev_b32 v242, 16, v161
v_and_b32 v248, 0xffff0000, v161
v_mul_f32 v242, v242, v236
v_mul_f32 v248, v248, v236
v_cvt_pk_bf16_f32 v161, v242, v248
v_lshlrev_b32 v242, 16, v162
v_and_b32 v248, 0xffff0000, v162
v_mul_f32 v242, v242, v236
v_mul_f32 v248, v248, v236
v_cvt_pk_bf16_f32 v162, v242, v248
v_lshlrev_b32 v242, 16, v163
v_and_b32 v248, 0xffff0000, v163
v_mul_f32 v242, v242, v236
v_mul_f32 v248, v248, v236
v_cvt_pk_bf16_f32 v163, v242, v248
ds_read_b64 v[250:251], v231 offset:0
s_waitcnt lgkmcnt(0)
v_lshlrev_b32 v242, 16, v250
v_and_b32 v248, 0xffff0000, v250
v_mul_f32 v242, v242, v236
v_mul_f32 v248, v248, v236
v_cvt_pk_bf16_f32 v250, v242, v248
v_lshlrev_b32 v242, 16, v251
v_and_b32 v248, 0xffff0000, v251
v_mul_f32 v242, v242, v236
v_mul_f32 v248, v248, v236
v_cvt_pk_bf16_f32 v251, v242, v248
ds_write_b64 v231, v[250:251] offset:0
s_waitcnt lgkmcnt(0)
ds_read_b64 v[250:251], v231 offset:8
s_waitcnt lgkmcnt(0)
v_lshlrev_b32 v242, 16, v250
v_and_b32 v248, 0xffff0000, v250
v_mul_f32 v242, v242, v236
v_mul_f32 v248, v248, v236
v_cvt_pk_bf16_f32 v250, v242, v248
v_lshlrev_b32 v242, 16, v251
v_and_b32 v248, 0xffff0000, v251
v_mul_f32 v242, v242, v236
v_mul_f32 v248, v248, v236
v_cvt_pk_bf16_f32 v251, v242, v248
ds_write_b64 v231, v[250:251] offset:8
s_waitcnt lgkmcnt(0)
v_exp_f32 v232, v128
v_exp_f32 v233, v129
v_exp_f32 v234, v130
v_exp_f32 v235, v131
s_nop 1
v_cvt_pk_bf16_f32 v176, v232, v233
v_cvt_pk_bf16_f32 v177, v234, v235
v_max_f32 v204, v132, v133
v_max3_f32 v204, v204, v134, v135
v_mov_b32 v205, v204
s_nop 1
v_permlane32_swap_b32 v204, v205
s_nop 1
v_max_f32 v204, v204, v205
v_mov_b32 v205, v204
s_nop 1
v_permlane16_swap_b32 v204, v205
s_nop 1
v_max_f32 v204, v204, v205
v_add_f32 v204, 40.0, v204
v_ceil_f32 v204, v204
v_max_f32 v204, 0, v204
v_sub_f32 v205, v225, v204
v_cvt_pk_bf16_f32 v205, v205, v205
v_and_b32 v205, 0xffff0000, v205
v_sub_f32 v204, v205, v225
v_mov_b32 v225, v205
v_exp_f32 v237, v204
v_bfi_b32 v35, v206, v205, v35
v_add_f32 v132, v132, v204
v_add_f32 v133, v133, v204
v_add_f32 v134, v134, v204
v_add_f32 v135, v135, v204
v_add_f32 v148, v148, v204
v_add_f32 v149, v149, v204
v_add_f32 v150, v150, v204
v_add_f32 v151, v151, v204
v_lshlrev_b32 v242, 16, v164
v_and_b32 v248, 0xffff0000, v164
v_mul_f32 v242, v242, v237
v_mul_f32 v248, v248, v237
v_cvt_pk_bf16_f32 v164, v242, v248
v_lshlrev_b32 v242, 16, v165
v_and_b32 v248, 0xffff0000, v165
v_mul_f32 v242, v242, v237
v_mul_f32 v248, v248, v237
v_cvt_pk_bf16_f32 v165, v242, v248
v_lshlrev_b32 v242, 16, v166
v_and_b32 v248, 0xffff0000, v166
v_mul_f32 v242, v242, v237
v_mul_f32 v248, v248, v237
v_cvt_pk_bf16_f32 v166, v242, v248
v_lshlrev_b32 v242, 16, v167
v_and_b32 v248, 0xffff0000, v167
v_mul_f32 v242, v242, v237
v_mul_f32 v248, v248, v237
v_cvt_pk_bf16_f32 v167, v242, v248
ds_read_b64 v[250:251], v231 offset:1024
s_waitcnt lgkmcnt(0)
v_lshlrev_b32 v242, 16, v250
v_and_b32 v248, 0xffff0000, v250
v_mul_f32 v242, v242, v237
v_mul_f32 v248, v248, v237
v_cvt_pk_bf16_f32 v250, v242, v248
v_lshlrev_b32 v242, 16, v251
v_and_b32 v248, 0xffff0000, v251
v_mul_f32 v242, v242, v237
v_mul_f32 v248, v248, v237
v_cvt_pk_bf16_f32 v251, v242, v248
ds_write_b64 v231, v[250:251] offset:1024
s_waitcnt lgkmcnt(0)
ds_read_b64 v[250:251], v231 offset:1032
s_waitcnt lgkmcnt(0)
v_lshlrev_b32 v242, 16, v250
v_and_b32 v248, 0xffff0000, v250
v_mul_f32 v242, v242, v237
v_mul_f32 v248, v248, v237
v_cvt_pk_bf16_f32 v250, v242, v248
v_lshlrev_b32 v242, 16, v251
v_and_b32 v248, 0xffff0000, v251
v_mul_f32 v242, v242, v237
v_mul_f32 v248, v248, v237
v_cvt_pk_bf16_f32 v251, v242, v248
ds_write_b64 v231, v[250:251] offset:1032
s_waitcnt lgkmcnt(0)
v_exp_f32 v232, v132
v_exp_f32 v233, v133
v_exp_f32 v234, v134
v_exp_f32 v235, v135
s_nop 1
v_cvt_pk_bf16_f32 v180, v232, v233
v_cvt_pk_bf16_f32 v181, v234, v235
v_max_f32 v204, v136, v137
v_max3_f32 v204, v204, v138, v139
v_mov_b32 v205, v204
s_nop 1
v_permlane32_swap_b32 v204, v205
s_nop 1
v_max_f32 v204, v204, v205
v_mov_b32 v205, v204
s_nop 1
v_permlane16_swap_b32 v204, v205
s_nop 1
v_max_f32 v204, v204, v205
v_add_f32 v204, 40.0, v204
v_ceil_f32 v204, v204
v_max_f32 v204, 0, v204
v_sub_f32 v205, v226, v204
v_cvt_pk_bf16_f32 v205, v205, v205
v_and_b32 v205, 0xffff0000, v205
v_sub_f32 v204, v205, v226
v_mov_b32 v226, v205
v_exp_f32 v238, v204
v_bfi_b32 v67, v206, v205, v67
v_add_f32 v136, v136, v204
v_add_f32 v137, v137, v204
v_add_f32 v138, v138, v204
v_add_f32 v139, v139, v204
v_add_f32 v152, v152, v204
v_add_f32 v153, v153, v204
v_add_f32 v154, v154, v204
v_add_f32 v155, v155, v204
v_lshlrev_b32 v242, 16, v168
v_and_b32 v248, 0xffff0000, v168
v_mul_f32 v242, v242, v238
v_mul_f32 v248, v248, v238
v_cvt_pk_bf16_f32 v168, v242, v248
v_lshlrev_b32 v242, 16, v169
v_and_b32 v248, 0xffff0000, v169
v_mul_f32 v242, v242, v238
v_mul_f32 v248, v248, v238
v_cvt_pk_bf16_f32 v169, v242, v248
v_lshlrev_b32 v242, 16, v170
v_and_b32 v248, 0xffff0000, v170
v_mul_f32 v242, v242, v238
v_mul_f32 v248, v248, v238
v_cvt_pk_bf16_f32 v170, v242, v248
v_lshlrev_b32 v242, 16, v171
v_and_b32 v248, 0xffff0000, v171
v_mul_f32 v242, v242, v238
v_mul_f32 v248, v248, v238
v_cvt_pk_bf16_f32 v171, v242, v248
ds_read_b64 v[250:251], v231 offset:2048
s_waitcnt lgkmcnt(0)
v_lshlrev_b32 v242, 16, v250
v_and_b32 v248, 0xffff0000, v250
v_mul_f32 v242, v242, v238
v_mul_f32 v248, v248, v238
v_cvt_pk_bf16_f32 v250, v242, v248
v_lshlrev_b32 v242, 16, v251
v_and_b32 v248, 0xffff0000, v251
v_mul_f32 v242, v242, v238
v_mul_f32 v248, v248, v238
v_cvt_pk_bf16_f32 v251, v242, v248
ds_write_b64 v231, v[250:251] offset:2048
s_waitcnt lgkmcnt(0)
ds_read_b64 v[250:251], v231 offset:2056
s_waitcnt lgkmcnt(0)
v_lshlrev_b32 v242, 16, v250
v_and_b32 v248, 0xffff0000, v250
v_mul_f32 v242, v242, v238
v_mul_f32 v248, v248, v238
v_cvt_pk_bf16_f32 v250, v242, v248
v_lshlrev_b32 v242, 16, v251
v_and_b32 v248, 0xffff0000, v251
v_mul_f32 v242, v242, v238
v_mul_f32 v248, v248, v238
v_cvt_pk_bf16_f32 v251, v242, v248
ds_write_b64 v231, v[250:251] offset:2056
s_waitcnt lgkmcnt(0)
v_exp_f32 v232, v136
v_exp_f32 v233, v137
v_exp_f32 v234, v138
v_exp_f32 v235, v139
s_nop 1
v_cvt_pk_bf16_f32 v184, v232, v233
v_cvt_pk_bf16_f32 v185, v234, v235
v_max_f32 v204, v140, v141
v_max3_f32 v204, v204, v142, v143
v_mov_b32 v205, v204
s_nop 1
v_permlane32_swap_b32 v204, v205
s_nop 1
v_max_f32 v204, v204, v205
v_mov_b32 v205, v204
s_nop 1
v_permlane16_swap_b32 v204, v205
s_nop 1
v_max_f32 v204, v204, v205
v_add_f32 v204, 40.0, v204
v_ceil_f32 v204, v204
v_max_f32 v204, 0, v204
v_sub_f32 v205, v227, v204
v_cvt_pk_bf16_f32 v205, v205, v205
v_and_b32 v205, 0xffff0000, v205
v_sub_f32 v204, v205, v227
v_mov_b32 v227, v205
v_exp_f32 v239, v204
v_bfi_b32 v99, v206, v205, v99
v_add_f32 v140, v140, v204
v_add_f32 v141, v141, v204
v_add_f32 v142, v142, v204
v_add_f32 v143, v143, v204
v_add_f32 v156, v156, v204
v_add_f32 v157, v157, v204
v_add_f32 v158, v158, v204
v_add_f32 v159, v159, v204
v_lshlrev_b32 v242, 16, v172
v_and_b32 v248, 0xffff0000, v172
v_mul_f32 v242, v242, v239
v_mul_f32 v248, v248, v239
v_cvt_pk_bf16_f32 v172, v242, v248
v_lshlrev_b32 v242, 16, v173
v_and_b32 v248, 0xffff0000, v173
v_mul_f32 v242, v242, v239
v_mul_f32 v248, v248, v239
v_cvt_pk_bf16_f32 v173, v242, v248
v_lshlrev_b32 v242, 16, v174
v_and_b32 v248, 0xffff0000, v174
v_mul_f32 v242, v242, v239
v_mul_f32 v248, v248, v239
v_cvt_pk_bf16_f32 v174, v242, v248
v_lshlrev_b32 v242, 16, v175
v_and_b32 v248, 0xffff0000, v175
v_mul_f32 v242, v242, v239
v_mul_f32 v248, v248, v239
v_cvt_pk_bf16_f32 v175, v242, v248
ds_read_b64 v[250:251], v231 offset:3072
s_waitcnt lgkmcnt(0)
v_lshlrev_b32 v242, 16, v250
v_and_b32 v248, 0xffff0000, v250
v_mul_f32 v242, v242, v239
v_mul_f32 v248, v248, v239
v_cvt_pk_bf16_f32 v250, v242, v248
v_lshlrev_b32 v242, 16, v251
v_and_b32 v248, 0xffff0000, v251
v_mul_f32 v242, v242, v239
v_mul_f32 v248, v248, v239
v_cvt_pk_bf16_f32 v251, v242, v248
ds_write_b64 v231, v[250:251] offset:3072
s_waitcnt lgkmcnt(0)
ds_read_b64 v[250:251], v231 offset:3080
s_waitcnt lgkmcnt(0)
v_lshlrev_b32 v242, 16, v250
v_and_b32 v248, 0xffff0000, v250
v_mul_f32 v242, v242, v239
v_mul_f32 v248, v248, v239
v_cvt_pk_bf16_f32 v250, v242, v248
v_lshlrev_b32 v242, 16, v251
v_and_b32 v248, 0xffff0000, v251
v_mul_f32 v242, v242, v239
v_mul_f32 v248, v248, v239
v_cvt_pk_bf16_f32 v251, v242, v248
ds_write_b64 v231, v[250:251] offset:3080
s_waitcnt lgkmcnt(0)
v_exp_f32 v232, v140
v_exp_f32 v233, v141
v_exp_f32 v234, v142
v_exp_f32 v235, v143
s_nop 1
v_cvt_pk_bf16_f32 v188, v232, v233
v_cvt_pk_bf16_f32 v189, v234, v235
s_branch L2_rare_common
L2_rare_site7:
s_mov_b32 s36, 7
s_branch L2_rare_t1_1
L2_rare_t1_1:
s_nop 15
s_nop 15
s_waitcnt lgkmcnt(0)
v_lshrrev_b32 v206, 8, v243
v_add_u32 v206, 1, v206
v_lshrrev_b32 v206, 2, v206
v_sub_u32 v206, 0, v206
v_and_b32 v206, 0xffff0000, v206
v_max_f32 v204, v144, v145
v_max3_f32 v204, v204, v146, v147
v_mov_b32 v205, v204
s_nop 1
v_permlane32_swap_b32 v204, v205
s_nop 1
v_max_f32 v204, v204, v205
v_mov_b32 v205, v204
s_nop 1
v_permlane16_swap_b32 v204, v205
s_nop 1
v_max_f32 v204, v204, v205
v_add_f32 v204, 40.0, v204
v_ceil_f32 v204, v204
v_max_f32 v204, 0, v204
v_sub_f32 v205, v224, v204
v_cvt_pk_bf16_f32 v205, v205, v205
v_and_b32 v205, 0xffff0000, v205
v_sub_f32 v204, v205, v224
v_mov_b32 v224, v205
v_exp_f32 v236, v204
v_bfi_b32 v3, v206, v205, v3
v_add_f32 v144, v144, v204
v_add_f32 v145, v145, v204
v_add_f32 v146, v146, v204
v_add_f32 v147, v147, v204
v_add_f32 v128, v128, v204
v_add_f32 v129, v129, v204
v_add_f32 v130, v130, v204
v_add_f32 v131, v131, v204
v_lshlrev_b32 v242, 16, v176
v_and_b32 v248, 0xffff0000, v176
v_mul_f32 v242, v242, v236
v_mul_f32 v248, v248, v236
v_cvt_pk_bf16_f32 v176, v242, v248
v_lshlrev_b32 v242, 16, v177
v_and_b32 v248, 0xffff0000, v177
v_mul_f32 v242, v242, v236
v_mul_f32 v248, v248, v236
v_cvt_pk_bf16_f32 v177, v242, v248
ds_read_b64 v[250:251], v231 offset:0
s_waitcnt lgkmcnt(0)
v_lshlrev_b32 v242, 16, v250
v_and_b32 v248, 0xffff0000, v250
v_mul_f32 v242, v242, v236
v_mul_f32 v248, v248, v236
v_cvt_pk_bf16_f32 v250, v242, v248
v_lshlrev_b32 v242, 16, v251
v_and_b32 v248, 0xffff0000, v251
v_mul_f32 v242, v242, v236
v_mul_f32 v248, v248, v236
v_cvt_pk_bf16_f32 v251, v242, v248
ds_write_b64 v231, v[250:251] offset:0
s_waitcnt lgkmcnt(0)
ds_read_b64 v[250:251], v231 offset:8
s_waitcnt lgkmcnt(0)
v_lshlrev_b32 v242, 16, v250
v_and_b32 v248, 0xffff0000, v250
v_mul_f32 v242, v242, v236
v_mul_f32 v248, v248, v236
v_cvt_pk_bf16_f32 v250, v242, v248
v_lshlrev_b32 v242, 16, v251
v_and_b32 v248, 0xffff0000, v251
v_mul_f32 v242, v242, v236
v_mul_f32 v248, v248, v236
v_cvt_pk_bf16_f32 v251, v242, v248
ds_write_b64 v231, v[250:251] offset:8
s_waitcnt lgkmcnt(0)
ds_read_b64 v[250:251], v231 offset:4096
s_waitcnt lgkmcnt(0)
v_lshlrev_b32 v242, 16, v250
v_and_b32 v248, 0xffff0000, v250
v_mul_f32 v242, v242, v236
v_mul_f32 v248, v248, v236
v_cvt_pk_bf16_f32 v250, v242, v248
v_lshlrev_b32 v242, 16, v251
v_and_b32 v248, 0xffff0000, v251
v_mul_f32 v242, v242, v236
v_mul_f32 v248, v248, v236
v_cvt_pk_bf16_f32 v251, v242, v248
ds_write_b64 v231, v[250:251] offset:4096
s_waitcnt lgkmcnt(0)
ds_read_b64 v[250:251], v231 offset:4104
s_waitcnt lgkmcnt(0)
v_lshlrev_b32 v242, 16, v250
v_and_b32 v248, 0xffff0000, v250
v_mul_f32 v242, v242, v236
v_mul_f32 v248, v248, v236
v_cvt_pk_bf16_f32 v250, v242, v248
v_lshlrev_b32 v242, 16, v251
v_and_b32 v248, 0xffff0000, v251
v_mul_f32 v242, v242, v236
v_mul_f32 v248, v248, v236
v_cvt_pk_bf16_f32 v251, v242, v248
ds_write_b64 v231, v[250:251] offset:4104
s_waitcnt lgkmcnt(0)
v_exp_f32 v232, v144
v_exp_f32 v233, v145
v_exp_f32 v234, v146
v_exp_f32 v235, v147
s_nop 1
v_cvt_pk_bf16_f32 v178, v232, v233
v_cvt_pk_bf16_f32 v179, v234, v235
v_max_f32 v204, v148, v149
v_max3_f32 v204, v204, v150, v151
v_mov_b32 v205, v204
s_nop 1
v_permlane32_swap_b32 v204, v205
s_nop 1
v_max_f32 v204, v204, v205
v_mov_b32 v205, v204
s_nop 1
v_permlane16_swap_b32 v204, v205
s_nop 1
v_max_f32 v204, v204, v205
v_add_f32 v204, 40.0, v204
v_ceil_f32 v204, v204
v_max_f32 v204, 0, v204
v_sub_f32 v205, v225, v204
v_cvt_pk_bf16_f32 v205, v205, v205
v_and_b32 v205, 0xffff0000, v205
v_sub_f32 v204, v205, v225
v_mov_b32 v225, v205
v_exp_f32 v237, v204
v_bfi_b32 v35, v206, v205, v35
v_add_f32 v148, v148, v204
v_add_f32 v149, v149, v204
v_add_f32 v150, v150, v204
v_add_f32 v151, v151, v204
v_add_f32 v132, v132, v204
v_add_f32 v133, v133, v204
v_add_f32 v134, v134, v204
v_add_f32 v135, v135, v204
v_lshlrev_b32 v242, 16, v180
v_and_b32 v248, 0xffff0000, v180
v_mul_f32 v242, v242, v237
v_mul_f32 v248, v248, v237
v_cvt_pk_bf16_f32 v180, v242, v248
v_lshlrev_b32 v242, 16, v181
v_and_b32 v248, 0xffff0000, v181
v_mul_f32 v242, v242, v237
v_mul_f32 v248, v248, v237
v_cvt_pk_bf16_f32 v181, v242, v248
ds_read_b64 v[250:251], v231 offset:1024
s_waitcnt lgkmcnt(0)
v_lshlrev_b32 v242, 16, v250
v_and_b32 v248, 0xffff0000, v250
v_mul_f32 v242, v242, v237
v_mul_f32 v248, v248, v237
v_cvt_pk_bf16_f32 v250, v242, v248
v_lshlrev_b32 v242, 16, v251
v_and_b32 v248, 0xffff0000, v251
v_mul_f32 v242, v242, v237
v_mul_f32 v248, v248, v237
v_cvt_pk_bf16_f32 v251, v242, v248
ds_write_b64 v231, v[250:251] offset:1024
s_waitcnt lgkmcnt(0)
ds_read_b64 v[250:251], v231 offset:1032
s_waitcnt lgkmcnt(0)
v_lshlrev_b32 v242, 16, v250
v_and_b32 v248, 0xffff0000, v250
v_mul_f32 v242, v242, v237
v_mul_f32 v248, v248, v237
v_cvt_pk_bf16_f32 v250, v242, v248
v_lshlrev_b32 v242, 16, v251
v_and_b32 v248, 0xffff0000, v251
v_mul_f32 v242, v242, v237
v_mul_f32 v248, v248, v237
v_cvt_pk_bf16_f32 v251, v242, v248
ds_write_b64 v231, v[250:251] offset:1032
s_waitcnt lgkmcnt(0)
ds_read_b64 v[250:251], v231 offset:5120
s_waitcnt lgkmcnt(0)
v_lshlrev_b32 v242, 16, v250
v_and_b32 v248, 0xffff0000, v250
v_mul_f32 v242, v242, v237
v_mul_f32 v248, v248, v237
v_cvt_pk_bf16_f32 v250, v242, v248
v_lshlrev_b32 v242, 16, v251
v_and_b32 v248, 0xffff0000, v251
v_mul_f32 v242, v242, v237
v_mul_f32 v248, v248, v237
v_cvt_pk_bf16_f32 v251, v242, v248
ds_write_b64 v231, v[250:251] offset:5120
s_waitcnt lgkmcnt(0)
ds_read_b64 v[250:251], v231 offset:5128
s_waitcnt lgkmcnt(0)
v_lshlrev_b32 v242, 16, v250
v_and_b32 v248, 0xffff0000, v250
v_mul_f32 v242, v242, v237
v_mul_f32 v248, v248, v237
v_cvt_pk_bf16_f32 v250, v242, v248
v_lshlrev_b32 v242, 16, v251
v_and_b32 v248, 0xffff0000, v251
v_mul_f32 v242, v242, v237
v_mul_f32 v248, v248, v237
v_cvt_pk_bf16_f32 v251, v242, v248
ds_write_b64 v231, v[250:251] offset:5128
s_waitcnt lgkmcnt(0)
v_exp_f32 v232, v148
v_exp_f32 v233, v149
v_exp_f32 v234, v150
v_exp_f32 v235, v151
s_nop 1
v_cvt_pk_bf16_f32 v182, v232, v233
v_cvt_pk_bf16_f32 v183, v234, v235
v_max_f32 v204, v152, v153
v_max3_f32 v204, v204, v154, v155
v_mov_b32 v205, v204
s_nop 1
v_permlane32_swap_b32 v204, v205
s_nop 1
v_max_f32 v204, v204, v205
v_mov_b32 v205, v204
s_nop 1
v_permlane16_swap_b32 v204, v205
s_nop 1
v_max_f32 v204, v204, v205
v_add_f32 v204, 40.0, v204
v_ceil_f32 v204, v204
v_max_f32 v204, 0, v204
v_sub_f32 v205, v226, v204
v_cvt_pk_bf16_f32 v205, v205, v205
v_and_b32 v205, 0xffff0000, v205
v_sub_f32 v204, v205, v226
v_mov_b32 v226, v205
v_exp_f32 v238, v204
v_bfi_b32 v67, v206, v205, v67
v_add_f32 v152, v152, v204
v_add_f32 v153, v153, v204
v_add_f32 v154, v154, v204
v_add_f32 v155, v155, v204
v_add_f32 v136, v136, v204
v_add_f32 v137, v137, v204
v_add_f32 v138, v138, v204
v_add_f32 v139, v139, v204
v_lshlrev_b32 v242, 16, v184
v_and_b32 v248, 0xffff0000, v184
v_mul_f32 v242, v242, v238
v_mul_f32 v248, v248, v238
v_cvt_pk_bf16_f32 v184, v242, v248
v_lshlrev_b32 v242, 16, v185
v_and_b32 v248, 0xffff0000, v185
v_mul_f32 v242, v242, v238
v_mul_f32 v248, v248, v238
v_cvt_pk_bf16_f32 v185, v242, v248
ds_read_b64 v[250:251], v231 offset:2048
s_waitcnt lgkmcnt(0)
v_lshlrev_b32 v242, 16, v250
v_and_b32 v248, 0xffff0000, v250
v_mul_f32 v242, v242, v238
v_mul_f32 v248, v248, v238
v_cvt_pk_bf16_f32 v250, v242, v248
v_lshlrev_b32 v242, 16, v251
v_and_b32 v248, 0xffff0000, v251
v_mul_f32 v242, v242, v238
v_mul_f32 v248, v248, v238
v_cvt_pk_bf16_f32 v251, v242, v248
ds_write_b64 v231, v[250:251] offset:2048
s_waitcnt lgkmcnt(0)
ds_read_b64 v[250:251], v231 offset:2056
s_waitcnt lgkmcnt(0)
v_lshlrev_b32 v242, 16, v250
v_and_b32 v248, 0xffff0000, v250
v_mul_f32 v242, v242, v238
v_mul_f32 v248, v248, v238
v_cvt_pk_bf16_f32 v250, v242, v248
v_lshlrev_b32 v242, 16, v251
v_and_b32 v248, 0xffff0000, v251
v_mul_f32 v242, v242, v238
v_mul_f32 v248, v248, v238
v_cvt_pk_bf16_f32 v251, v242, v248
ds_write_b64 v231, v[250:251] offset:2056
s_waitcnt lgkmcnt(0)
ds_read_b64 v[250:251], v231 offset:6144
s_waitcnt lgkmcnt(0)
v_lshlrev_b32 v242, 16, v250
v_and_b32 v248, 0xffff0000, v250
v_mul_f32 v242, v242, v238
v_mul_f32 v248, v248, v238
v_cvt_pk_bf16_f32 v250, v242, v248
v_lshlrev_b32 v242, 16, v251
v_and_b32 v248, 0xffff0000, v251
v_mul_f32 v242, v242, v238
v_mul_f32 v248, v248, v238
v_cvt_pk_bf16_f32 v251, v242, v248
ds_write_b64 v231, v[250:251] offset:6144
s_waitcnt lgkmcnt(0)
ds_read_b64 v[250:251], v231 offset:6152
s_waitcnt lgkmcnt(0)
v_lshlrev_b32 v242, 16, v250
v_and_b32 v248, 0xffff0000, v250
v_mul_f32 v242, v242, v238
v_mul_f32 v248, v248, v238
v_cvt_pk_bf16_f32 v250, v242, v248
v_lshlrev_b32 v242, 16, v251
v_and_b32 v248, 0xffff0000, v251
v_mul_f32 v242, v242, v238
v_mul_f32 v248, v248, v238
v_cvt_pk_bf16_f32 v251, v242, v248
ds_write_b64 v231, v[250:251] offset:6152
s_waitcnt lgkmcnt(0)
v_exp_f32 v232, v152
v_exp_f32 v233, v153
v_exp_f32 v234, v154
v_exp_f32 v235, v155
s_nop 1
v_cvt_pk_bf16_f32 v186, v232, v233
v_cvt_pk_bf16_f32 v187, v234, v235
v_max_f32 v204, v156, v157
v_max3_f32 v204, v204, v158, v159
v_mov_b32 v205, v204
s_nop 1
v_permlane32_swap_b32 v204, v205
s_nop 1
v_max_f32 v204, v204, v205
v_mov_b32 v205, v204
s_nop 1
v_permlane16_swap_b32 v204, v205
s_nop 1
v_max_f32 v204, v204, v205
v_add_f32 v204, 40.0, v204
v_ceil_f32 v204, v204
v_max_f32 v204, 0, v204
v_sub_f32 v205, v227, v204
v_cvt_pk_bf16_f32 v205, v205, v205
v_and_b32 v205, 0xffff0000, v205
v_sub_f32 v204, v205, v227
v_mov_b32 v227, v205
v_exp_f32 v239, v204
v_bfi_b32 v99, v206, v205, v99
v_add_f32 v156, v156, v204
v_add_f32 v157, v157, v204
v_add_f32 v158, v158, v204
v_add_f32 v159, v159, v204
v_add_f32 v140, v140, v204
v_add_f32 v141, v141, v204
v_add_f32 v142, v142, v204
v_add_f32 v143, v143, v204
v_lshlrev_b32 v242, 16, v188
v_and_b32 v248, 0xffff0000, v188
v_mul_f32 v242, v242, v239
v_mul_f32 v248, v248, v239
v_cvt_pk_bf16_f32 v188, v242, v248
v_lshlrev_b32 v242, 16, v189
v_and_b32 v248, 0xffff0000, v189
v_mul_f32 v242, v242, v239
v_mul_f32 v248, v248, v239
v_cvt_pk_bf16_f32 v189, v242, v248
ds_read_b64 v[250:251], v231 offset:3072
s_waitcnt lgkmcnt(0)
v_lshlrev_b32 v242, 16, v250
v_and_b32 v248, 0xffff0000, v250
v_mul_f32 v242, v242, v239
v_mul_f32 v248, v248, v239
v_cvt_pk_bf16_f32 v250, v242, v248
v_lshlrev_b32 v242, 16, v251
v_and_b32 v248, 0xffff0000, v251
v_mul_f32 v242, v242, v239
v_mul_f32 v248, v248, v239
v_cvt_pk_bf16_f32 v251, v242, v248
ds_write_b64 v231, v[250:251] offset:3072
s_waitcnt lgkmcnt(0)
ds_read_b64 v[250:251], v231 offset:3080
s_waitcnt lgkmcnt(0)
v_lshlrev_b32 v242, 16, v250
v_and_b32 v248, 0xffff0000, v250
v_mul_f32 v242, v242, v239
v_mul_f32 v248, v248, v239
v_cvt_pk_bf16_f32 v250, v242, v248
v_lshlrev_b32 v242, 16, v251
v_and_b32 v248, 0xffff0000, v251
v_mul_f32 v242, v242, v239
v_mul_f32 v248, v248, v239
v_cvt_pk_bf16_f32 v251, v242, v248
ds_write_b64 v231, v[250:251] offset:3080
s_waitcnt lgkmcnt(0)
ds_read_b64 v[250:251], v231 offset:7168
s_waitcnt lgkmcnt(0)
v_lshlrev_b32 v242, 16, v250
v_and_b32 v248, 0xffff0000, v250
v_mul_f32 v242, v242, v239
v_mul_f32 v248, v248, v239
v_cvt_pk_bf16_f32 v250, v242, v248
v_lshlrev_b32 v242, 16, v251
v_and_b32 v248, 0xffff0000, v251
v_mul_f32 v242, v242, v239
v_mul_f32 v248, v248, v239
v_cvt_pk_bf16_f32 v251, v242, v248
ds_write_b64 v231, v[250:251] offset:7168
s_waitcnt lgkmcnt(0)
ds_read_b64 v[250:251], v231 offset:7176
s_waitcnt lgkmcnt(0)
v_lshlrev_b32 v242, 16, v250
v_and_b32 v248, 0xffff0000, v250
v_mul_f32 v242, v242, v239
v_mul_f32 v248, v248, v239
v_cvt_pk_bf16_f32 v250, v242, v248
v_lshlrev_b32 v242, 16, v251
v_and_b32 v248, 0xffff0000, v251
v_mul_f32 v242, v242, v239
v_mul_f32 v248, v248, v239
v_cvt_pk_bf16_f32 v251, v242, v248
ds_write_b64 v231, v[250:251] offset:7176
s_waitcnt lgkmcnt(0)
v_exp_f32 v232, v156
v_exp_f32 v233, v157
v_exp_f32 v234, v158
v_exp_f32 v235, v159
s_nop 1
v_cvt_pk_bf16_f32 v190, v232, v233
v_cvt_pk_bf16_f32 v191, v234, v235
s_branch L2_rare_common
L2_rare_site8:
s_mov_b32 s36, 8
s_branch L2_rare_t1_2
L2_rare_t1_2:
s_nop 15
s_nop 15
s_waitcnt lgkmcnt(0)
v_lshrrev_b32 v206, 8, v243
v_add_u32 v206, 1, v206
v_lshrrev_b32 v206, 2, v206
v_sub_u32 v206, 0, v206
v_and_b32 v206, 0xffff0000, v206
v_max_f32 v204, v128, v129
v_max3_f32 v204, v204, v130, v131
v_mov_b32 v205, v204
s_nop 1
v_permlane32_swap_b32 v204, v205
s_nop 1
v_max_f32 v204, v204, v205
v_mov_b32 v205, v204
s_nop 1
v_permlane16_swap_b32 v204, v205
s_nop 1
v_max_f32 v204, v204, v205
v_add_f32 v204, 40.0, v204
v_ceil_f32 v204, v204
v_max_f32 v204, 0, v204
v_sub_f32 v205, v224, v204
v_cvt_pk_bf16_f32 v205, v205, v205
v_and_b32 v205, 0xffff0000, v205
v_sub_f32 v204, v205, v224
v_mov_b32 v224, v205
v_exp_f32 v236, v204
v_bfi_b32 v3, v206, v205, v3
v_add_f32 v128, v128, v204
v_add_f32 v129, v129, v204
v_add_f32 v130, v130, v204
v_add_f32 v131, v131, v204
v_add_f32 v144, v144, v204
v_add_f32 v145, v145, v204
v_add_f32 v146, v146, v204
v_add_f32 v147, v147, v204
v_lshlrev_b32 v242, 16, v176
v_and_b32 v248, 0xffff0000, v176
v_mul_f32 v242, v242, v236
v_mul_f32 v248, v248, v236
v_cvt_pk_bf16_f32 v176, v242, v248
v_lshlrev_b32 v242, 16, v177
v_and_b32 v248, 0xffff0000, v177
v_mul_f32 v242, v242, v236
v_mul_f32 v248, v248, v236
v_cvt_pk_bf16_f32 v177, v242, v248
v_lshlrev_b32 v242, 16, v178
v_and_b32 v248, 0xffff0000, v178
v_mul_f32 v242, v242, v236
v_mul_f32 v248, v248, v236
v_cvt_pk_bf16_f32 v178, v242, v248
v_lshlrev_b32 v242, 16, v179
v_and_b32 v248, 0xffff0000, v179
v_mul_f32 v242, v242, v236
v_mul_f32 v248, v248, v236
v_cvt_pk_bf16_f32 v179, v242, v248
ds_read_b64 v[250:251], v231 offset:0
s_waitcnt lgkmcnt(0)
v_lshlrev_b32 v242, 16, v250
v_and_b32 v248, 0xffff0000, v250
v_mul_f32 v242, v242, v236
v_mul_f32 v248, v248, v236
v_cvt_pk_bf16_f32 v250, v242, v248
v_lshlrev_b32 v242, 16, v251
v_and_b32 v248, 0xffff0000, v251
v_mul_f32 v242, v242, v236
v_mul_f32 v248, v248, v236
v_cvt_pk_bf16_f32 v251, v242, v248
ds_write_b64 v231, v[250:251] offset:0
s_waitcnt lgkmcnt(0)
ds_read_b64 v[250:251], v231 offset:8
s_waitcnt lgkmcnt(0)
v_lshlrev_b32 v242, 16, v250
v_and_b32 v248, 0xffff0000, v250
v_mul_f32 v242, v242, v236
v_mul_f32 v248, v248, v236
v_cvt_pk_bf16_f32 v250, v242, v248
v_lshlrev_b32 v242, 16, v251
v_and_b32 v248, 0xffff0000, v251
v_mul_f32 v242, v242, v236
v_mul_f32 v248, v248, v236
v_cvt_pk_bf16_f32 v251, v242, v248
ds_write_b64 v231, v[250:251] offset:8
s_waitcnt lgkmcnt(0)
ds_read_b64 v[250:251], v231 offset:4096
s_waitcnt lgkmcnt(0)
v_lshlrev_b32 v242, 16, v250
v_and_b32 v248, 0xffff0000, v250
v_mul_f32 v242, v242, v236
v_mul_f32 v248, v248, v236
v_cvt_pk_bf16_f32 v250, v242, v248
v_lshlrev_b32 v242, 16, v251
v_and_b32 v248, 0xffff0000, v251
v_mul_f32 v242, v242, v236
v_mul_f32 v248, v248, v236
v_cvt_pk_bf16_f32 v251, v242, v248
ds_write_b64 v231, v[250:251] offset:4096
s_waitcnt lgkmcnt(0)
ds_read_b64 v[250:251], v231 offset:4104
s_waitcnt lgkmcnt(0)
v_lshlrev_b32 v242, 16, v250
v_and_b32 v248, 0xffff0000, v250
v_mul_f32 v242, v242, v236
v_mul_f32 v248, v248, v236
v_cvt_pk_bf16_f32 v250, v242, v248
v_lshlrev_b32 v242, 16, v251
v_and_b32 v248, 0xffff0000, v251
v_mul_f32 v242, v242, v236
v_mul_f32 v248, v248, v236
v_cvt_pk_bf16_f32 v251, v242, v248
ds_write_b64 v231, v[250:251] offset:4104
s_waitcnt lgkmcnt(0)
v_exp_f32 v232, v128
v_exp_f32 v233, v129
v_exp_f32 v234, v130
v_exp_f32 v235, v131
s_nop 1
v_cvt_pk_bf16_f32 v160, v232, v233
v_cvt_pk_bf16_f32 v161, v234, v235
v_max_f32 v204, v132, v133
v_max3_f32 v204, v204, v134, v135
v_mov_b32 v205, v204
s_nop 1
v_permlane32_swap_b32 v204, v205
s_nop 1
v_max_f32 v204, v204, v205
v_mov_b32 v205, v204
s_nop 1
v_permlane16_swap_b32 v204, v205
s_nop 1
v_max_f32 v204, v204, v205
v_add_f32 v204, 40.0, v204
v_ceil_f32 v204, v204
v_max_f32 v204, 0, v204
v_sub_f32 v205, v225, v204
v_cvt_pk_bf16_f32 v205, v205, v205
v_and_b32 v205, 0xffff0000, v205
v_sub_f32 v204, v205, v225
v_mov_b32 v225, v205
v_exp_f32 v237, v204
v_bfi_b32 v35, v206, v205, v35
v_add_f32 v132, v132, v204
v_add_f32 v133, v133, v204
v_add_f32 v134, v134, v204
v_add_f32 v135, v135, v204
v_add_f32 v148, v148, v204
v_add_f32 v149, v149, v204
v_add_f32 v150, v150, v204
v_add_f32 v151, v151, v204
v_lshlrev_b32 v242, 16, v180
v_and_b32 v248, 0xffff0000, v180
v_mul_f32 v242, v242, v237
v_mul_f32 v248, v248, v237
v_cvt_pk_bf16_f32 v180, v242, v248
v_lshlrev_b32 v242, 16, v181
v_and_b32 v248, 0xffff0000, v181
v_mul_f32 v242, v242, v237
v_mul_f32 v248, v248, v237
v_cvt_pk_bf16_f32 v181, v242, v248
v_lshlrev_b32 v242, 16, v182
v_and_b32 v248, 0xffff0000, v182
v_mul_f32 v242, v242, v237
v_mul_f32 v248, v248, v237
v_cvt_pk_bf16_f32 v182, v242, v248
v_lshlrev_b32 v242, 16, v183
v_and_b32 v248, 0xffff0000, v183
v_mul_f32 v242, v242, v237
v_mul_f32 v248, v248, v237
v_cvt_pk_bf16_f32 v183, v242, v248
ds_read_b64 v[250:251], v231 offset:1024
s_waitcnt lgkmcnt(0)
v_lshlrev_b32 v242, 16, v250
v_and_b32 v248, 0xffff0000, v250
v_mul_f32 v242, v242, v237
v_mul_f32 v248, v248, v237
v_cvt_pk_bf16_f32 v250, v242, v248
v_lshlrev_b32 v242, 16, v251
v_and_b32 v248, 0xffff0000, v251
v_mul_f32 v242, v242, v237
v_mul_f32 v248, v248, v237
v_cvt_pk_bf16_f32 v251, v242, v248
ds_write_b64 v231, v[250:251] offset:1024
s_waitcnt lgkmcnt(0)
ds_read_b64 v[250:251], v231 offset:1032
s_waitcnt lgkmcnt(0)
v_lshlrev_b32 v242, 16, v250
v_and_b32 v248, 0xffff0000, v250
v_mul_f32 v242, v242, v237
v_mul_f32 v248, v248, v237
v_cvt_pk_bf16_f32 v250, v242, v248
v_lshlrev_b32 v242, 16, v251
v_and_b32 v248, 0xffff0000, v251
v_mul_f32 v242, v242, v237
v_mul_f32 v248, v248, v237
v_cvt_pk_bf16_f32 v251, v242, v248
ds_write_b64 v231, v[250:251] offset:1032
s_waitcnt lgkmcnt(0)
ds_read_b64 v[250:251], v231 offset:5120
s_waitcnt lgkmcnt(0)
v_lshlrev_b32 v242, 16, v250
v_and_b32 v248, 0xffff0000, v250
v_mul_f32 v242, v242, v237
v_mul_f32 v248, v248, v237
v_cvt_pk_bf16_f32 v250, v242, v248
v_lshlrev_b32 v242, 16, v251
v_and_b32 v248, 0xffff0000, v251
v_mul_f32 v242, v242, v237
v_mul_f32 v248, v248, v237
v_cvt_pk_bf16_f32 v251, v242, v248
ds_write_b64 v231, v[250:251] offset:5120
s_waitcnt lgkmcnt(0)
ds_read_b64 v[250:251], v231 offset:5128
s_waitcnt lgkmcnt(0)
v_lshlrev_b32 v242, 16, v250
v_and_b32 v248, 0xffff0000, v250
v_mul_f32 v242, v242, v237
v_mul_f32 v248, v248, v237
v_cvt_pk_bf16_f32 v250, v242, v248
v_lshlrev_b32 v242, 16, v251
v_and_b32 v248, 0xffff0000, v251
v_mul_f32 v242, v242, v237
v_mul_f32 v248, v248, v237
v_cvt_pk_bf16_f32 v251, v242, v248
ds_write_b64 v231, v[250:251] offset:5128
s_waitcnt lgkmcnt(0)
v_exp_f32 v232, v132
v_exp_f32 v233, v133
v_exp_f32 v234, v134
v_exp_f32 v235, v135
s_nop 1
v_cvt_pk_bf16_f32 v164, v232, v233
v_cvt_pk_bf16_f32 v165, v234, v235
v_max_f32 v204, v136, v137
v_max3_f32 v204, v204, v138, v139
v_mov_b32 v205, v204
s_nop 1
v_permlane32_swap_b32 v204, v205
s_nop 1
v_max_f32 v204, v204, v205
v_mov_b32 v205, v204
s_nop 1
v_permlane16_swap_b32 v204, v205
s_nop 1
v_max_f32 v204, v204, v205
v_add_f32 v204, 40.0, v204
v_ceil_f32 v204, v204
v_max_f32 v204, 0, v204
v_sub_f32 v205, v226, v204
v_cvt_pk_bf16_f32 v205, v205, v205
v_and_b32 v205, 0xffff0000, v205
v_sub_f32 v204, v205, v226
v_mov_b32 v226, v205
v_exp_f32 v238, v204
v_bfi_b32 v67, v206, v205, v67
v_add_f32 v136, v136, v204
v_add_f32 v137, v137, v204
v_add_f32 v138, v138, v204
v_add_f32 v139, v139, v204
v_add_f32 v152, v152, v204
v_add_f32 v153, v153, v204
v_add_f32 v154, v154, v204
v_add_f32 v155, v155, v204
v_lshlrev_b32 v242, 16, v184
v_and_b32 v248, 0xffff0000, v184
v_mul_f32 v242, v242, v238
v_mul_f32 v248, v248, v238
v_cvt_pk_bf16_f32 v184, v242, v248
v_lshlrev_b32 v242, 16, v185
v_and_b32 v248, 0xffff0000, v185
v_mul_f32 v242, v242, v238
v_mul_f32 v248, v248, v238
v_cvt_pk_bf16_f32 v185, v242, v248
v_lshlrev_b32 v242, 16, v186
v_and_b32 v248, 0xffff0000, v186
v_mul_f32 v242, v242, v238
v_mul_f32 v248, v248, v238
v_cvt_pk_bf16_f32 v186, v242, v248
v_lshlrev_b32 v242, 16, v187
v_and_b32 v248, 0xffff0000, v187
v_mul_f32 v242, v242, v238
v_mul_f32 v248, v248, v238
v_cvt_pk_bf16_f32 v187, v242, v248
ds_read_b64 v[250:251], v231 offset:2048
s_waitcnt lgkmcnt(0)
v_lshlrev_b32 v242, 16, v250
v_and_b32 v248, 0xffff0000, v250
v_mul_f32 v242, v242, v238
v_mul_f32 v248, v248, v238
v_cvt_pk_bf16_f32 v250, v242, v248
v_lshlrev_b32 v242, 16, v251
v_and_b32 v248, 0xffff0000, v251
v_mul_f32 v242, v242, v238
v_mul_f32 v248, v248, v238
v_cvt_pk_bf16_f32 v251, v242, v248
ds_write_b64 v231, v[250:251] offset:2048
s_waitcnt lgkmcnt(0)
ds_read_b64 v[250:251], v231 offset:2056
s_waitcnt lgkmcnt(0)
v_lshlrev_b32 v242, 16, v250
v_and_b32 v248, 0xffff0000, v250
v_mul_f32 v242, v242, v238
v_mul_f32 v248, v248, v238
v_cvt_pk_bf16_f32 v250, v242, v248
v_lshlrev_b32 v242, 16, v251
v_and_b32 v248, 0xffff0000, v251
v_mul_f32 v242, v242, v238
v_mul_f32 v248, v248, v238
v_cvt_pk_bf16_f32 v251, v242, v248
ds_write_b64 v231, v[250:251] offset:2056
s_waitcnt lgkmcnt(0)
ds_read_b64 v[250:251], v231 offset:6144
s_waitcnt lgkmcnt(0)
v_lshlrev_b32 v242, 16, v250
v_and_b32 v248, 0xffff0000, v250
v_mul_f32 v242, v242, v238
v_mul_f32 v248, v248, v238
v_cvt_pk_bf16_f32 v250, v242, v248
v_lshlrev_b32 v242, 16, v251
v_and_b32 v248, 0xffff0000, v251
v_mul_f32 v242, v242, v238
v_mul_f32 v248, v248, v238
v_cvt_pk_bf16_f32 v251, v242, v248
ds_write_b64 v231, v[250:251] offset:6144
s_waitcnt lgkmcnt(0)
ds_read_b64 v[250:251], v231 offset:6152
s_waitcnt lgkmcnt(0)
v_lshlrev_b32 v242, 16, v250
v_and_b32 v248, 0xffff0000, v250
v_mul_f32 v242, v242, v238
v_mul_f32 v248, v248, v238
v_cvt_pk_bf16_f32 v250, v242, v248
v_lshlrev_b32 v242, 16, v251
v_and_b32 v248, 0xffff0000, v251
v_mul_f32 v242, v242, v238
v_mul_f32 v248, v248, v238
v_cvt_pk_bf16_f32 v251, v242, v248
ds_write_b64 v231, v[250:251] offset:6152
s_waitcnt lgkmcnt(0)
v_exp_f32 v232, v136
v_exp_f32 v233, v137
v_exp_f32 v234, v138
v_exp_f32 v235, v139
s_nop 1
v_cvt_pk_bf16_f32 v168, v232, v233
v_cvt_pk_bf16_f32 v169, v234, v235
v_max_f32 v204, v140, v141
v_max3_f32 v204, v204, v142, v143
v_mov_b32 v205, v204
s_nop 1
v_permlane32_swap_b32 v204, v205
s_nop 1
v_max_f32 v204, v204, v205
v_mov_b32 v205, v204
s_nop 1
v_permlane16_swap_b32 v204, v205
s_nop 1
v_max_f32 v204, v204, v205
v_add_f32 v204, 40.0, v204
v_ceil_f32 v204, v204
v_max_f32 v204, 0, v204
v_sub_f32 v205, v227, v204
v_cvt_pk_bf16_f32 v205, v205, v205
v_and_b32 v205, 0xffff0000, v205
v_sub_f32 v204, v205, v227
v_mov_b32 v227, v205
v_exp_f32 v239, v204
v_bfi_b32 v99, v206, v205, v99
v_add_f32 v140, v140, v204
v_add_f32 v141, v141, v204
v_add_f32 v142, v142, v204
v_add_f32 v143, v143, v204
v_add_f32 v156, v156, v204
v_add_f32 v157, v157, v204
v_add_f32 v158, v158, v204
v_add_f32 v159, v159, v204
v_lshlrev_b32 v242, 16, v188
v_and_b32 v248, 0xffff0000, v188
v_mul_f32 v242, v242, v239
v_mul_f32 v248, v248, v239
v_cvt_pk_bf16_f32 v188, v242, v248
v_lshlrev_b32 v242, 16, v189
v_and_b32 v248, 0xffff0000, v189
v_mul_f32 v242, v242, v239
v_mul_f32 v248, v248, v239
v_cvt_pk_bf16_f32 v189, v242, v248
v_lshlrev_b32 v242, 16, v190
v_and_b32 v248, 0xffff0000, v190
v_mul_f32 v242, v242, v239
v_mul_f32 v248, v248, v239
v_cvt_pk_bf16_f32 v190, v242, v248
v_lshlrev_b32 v242, 16, v191
v_and_b32 v248, 0xffff0000, v191
v_mul_f32 v242, v242, v239
v_mul_f32 v248, v248, v239
v_cvt_pk_bf16_f32 v191, v242, v248
ds_read_b64 v[250:251], v231 offset:3072
s_waitcnt lgkmcnt(0)
v_lshlrev_b32 v242, 16, v250
v_and_b32 v248, 0xffff0000, v250
v_mul_f32 v242, v242, v239
v_mul_f32 v248, v248, v239
v_cvt_pk_bf16_f32 v250, v242, v248
v_lshlrev_b32 v242, 16, v251
v_and_b32 v248, 0xffff0000, v251
v_mul_f32 v242, v242, v239
v_mul_f32 v248, v248, v239
v_cvt_pk_bf16_f32 v251, v242, v248
ds_write_b64 v231, v[250:251] offset:3072
s_waitcnt lgkmcnt(0)
ds_read_b64 v[250:251], v231 offset:3080
s_waitcnt lgkmcnt(0)
v_lshlrev_b32 v242, 16, v250
v_and_b32 v248, 0xffff0000, v250
v_mul_f32 v242, v242, v239
v_mul_f32 v248, v248, v239
v_cvt_pk_bf16_f32 v250, v242, v248
v_lshlrev_b32 v242, 16, v251
v_and_b32 v248, 0xffff0000, v251
v_mul_f32 v242, v242, v239
v_mul_f32 v248, v248, v239
v_cvt_pk_bf16_f32 v251, v242, v248
ds_write_b64 v231, v[250:251] offset:3080
s_waitcnt lgkmcnt(0)
ds_read_b64 v[250:251], v231 offset:7168
s_waitcnt lgkmcnt(0)
v_lshlrev_b32 v242, 16, v250
v_and_b32 v248, 0xffff0000, v250
v_mul_f32 v242, v242, v239
v_mul_f32 v248, v248, v239
v_cvt_pk_bf16_f32 v250, v242, v248
v_lshlrev_b32 v242, 16, v251
v_and_b32 v248, 0xffff0000, v251
v_mul_f32 v242, v242, v239
v_mul_f32 v248, v248, v239
v_cvt_pk_bf16_f32 v251, v242, v248
ds_write_b64 v231, v[250:251] offset:7168
s_waitcnt lgkmcnt(0)
ds_read_b64 v[250:251], v231 offset:7176
s_waitcnt lgkmcnt(0)
v_lshlrev_b32 v242, 16, v250
v_and_b32 v248, 0xffff0000, v250
v_mul_f32 v242, v242, v239
v_mul_f32 v248, v248, v239
v_cvt_pk_bf16_f32 v250, v242, v248
v_lshlrev_b32 v242, 16, v251
v_and_b32 v248, 0xffff0000, v251
v_mul_f32 v242, v242, v239
v_mul_f32 v248, v248, v239
v_cvt_pk_bf16_f32 v251, v242, v248
ds_write_b64 v231, v[250:251] offset:7176
s_waitcnt lgkmcnt(0)
v_exp_f32 v232, v140
v_exp_f32 v233, v141
v_exp_f32 v234, v142
v_exp_f32 v235, v143
s_nop 1
v_cvt_pk_bf16_f32 v172, v232, v233
v_cvt_pk_bf16_f32 v173, v234, v235
s_branch L2_rare_common
L2_rare_site9:
s_mov_b32 s36, 9
s_branch L2_rare_t1_3
L2_rare_t1_3:
s_nop 15
s_nop 15
s_waitcnt lgkmcnt(0)
v_lshrrev_b32 v206, 8, v243
v_add_u32 v206, 1, v206
v_lshrrev_b32 v206, 2, v206
v_sub_u32 v206, 0, v206
v_and_b32 v206, 0xffff0000, v206
v_max_f32 v204, v144, v145
v_max3_f32 v204, v204, v146, v147
v_mov_b32 v205, v204
s_nop 1
v_permlane32_swap_b32 v204, v205
s_nop 1
v_max_f32 v204, v204, v205
v_mov_b32 v205, v204
s_nop 1
v_permlane16_swap_b32 v204, v205
s_nop 1
v_max_f32 v204, v204, v205
v_add_f32 v204, 40.0, v204
v_ceil_f32 v204, v204
v_max_f32 v204, 0, v204
v_sub_f32 v205, v224, v204
v_cvt_pk_bf16_f32 v205, v205, v205
v_and_b32 v205, 0xffff0000, v205
v_sub_f32 v204, v205, v224
v_mov_b32 v224, v205
v_exp_f32 v236, v204
v_bfi_b32 v3, v206, v205, v3
v_add_f32 v144, v144, v204
v_add_f32 v145, v145, v204
v_add_f32 v146, v146, v204
v_add_f32 v147, v147, v204
v_add_f32 v128, v128, v204
v_add_f32 v129, v129, v204
v_add_f32 v130, v130, v204
v_add_f32 v131, v131, v204
v_lshlrev_b32 v242, 16, v176
v_and_b32 v248, 0xffff0000, v176
v_mul_f32 v242, v242, v236
v_mul_f32 v248, v248, v236
v_cvt_pk_bf16_f32 v176, v242, v248
v_lshlrev_b32 v242, 16, v177
v_and_b32 v248, 0xffff0000, v177
v_mul_f32 v242, v242, v236
v_mul_f32 v248, v248, v236
v_cvt_pk_bf16_f32 v177, v242, v248
v_lshlrev_b32 v242, 16, v178
v_and_b32 v248, 0xffff0000, v178
v_mul_f32 v242, v242, v236
v_mul_f32 v248, v248, v236
v_cvt_pk_bf16_f32 v178, v242, v248
v_lshlrev_b32 v242, 16, v179
v_and_b32 v248, 0xffff0000, v179
v_mul_f32 v242, v242, v236
v_mul_f32 v248, v248, v236
v_cvt_pk_bf16_f32 v179, v242, v248
v_lshlrev_b32 v242, 16, v160
v_and_b32 v248, 0xffff0000, v160
v_mul_f32 v242, v242, v236
v_mul_f32 v248, v248, v236
v_cvt_pk_bf16_f32 v160, v242, v248
v_lshlrev_b32 v242, 16, v161
v_and_b32 v248, 0xffff0000, v161
v_mul_f32 v242, v242, v236
v_mul_f32 v248, v248, v236
v_cvt_pk_bf16_f32 v161, v242, v248
ds_read_b64 v[250:251], v231 offset:0
s_waitcnt lgkmcnt(0)
v_lshlrev_b32 v242, 16, v250
v_and_b32 v248, 0xffff0000, v250
v_mul_f32 v242, v242, v236
v_mul_f32 v248, v248, v236
v_cvt_pk_bf16_f32 v250, v242, v248
v_lshlrev_b32 v242, 16, v251
v_and_b32 v248, 0xffff0000, v251
v_mul_f32 v242, v242, v236
v_mul_f32 v248, v248, v236
v_cvt_pk_bf16_f32 v251, v242, v248
ds_write_b64 v231, v[250:251] offset:0
s_waitcnt lgkmcnt(0)
ds_read_b64 v[250:251], v231 offset:8
s_waitcnt lgkmcnt(0)
v_lshlrev_b32 v242, 16, v250
v_and_b32 v248, 0xffff0000, v250
v_mul_f32 v242, v242, v236
v_mul_f32 v248, v248, v236
v_cvt_pk_bf16_f32 v250, v242, v248
v_lshlrev_b32 v242, 16, v251
v_and_b32 v248, 0xffff0000, v251
v_mul_f32 v242, v242, v236
v_mul_f32 v248, v248, v236
v_cvt_pk_bf16_f32 v251, v242, v248
ds_write_b64 v231, v[250:251] offset:8
s_waitcnt lgkmcnt(0)
ds_read_b64 v[250:251], v231 offset:4096
s_waitcnt lgkmcnt(0)
v_lshlrev_b32 v242, 16, v250
v_and_b32 v248, 0xffff0000, v250
v_mul_f32 v242, v242, v236
v_mul_f32 v248, v248, v236
v_cvt_pk_bf16_f32 v250, v242, v248
v_lshlrev_b32 v242, 16, v251
v_and_b32 v248, 0xffff0000, v251
v_mul_f32 v242, v242, v236
v_mul_f32 v248, v248, v236
v_cvt_pk_bf16_f32 v251, v242, v248
ds_write_b64 v231, v[250:251] offset:4096
s_waitcnt lgkmcnt(0)
ds_read_b64 v[250:251], v231 offset:4104
s_waitcnt lgkmcnt(0)
v_lshlrev_b32 v242, 16, v250
v_and_b32 v248, 0xffff0000, v250
v_mul_f32 v242, v242, v236
v_mul_f32 v248, v248, v236
v_cvt_pk_bf16_f32 v250, v242, v248
v_lshlrev_b32 v242, 16, v251
v_and_b32 v248, 0xffff0000, v251
v_mul_f32 v242, v242, v236
v_mul_f32 v248, v248, v236
v_cvt_pk_bf16_f32 v251, v242, v248
ds_write_b64 v231, v[250:251] offset:4104
s_waitcnt lgkmcnt(0)
v_exp_f32 v232, v144
v_exp_f32 v233, v145
v_exp_f32 v234, v146
v_exp_f32 v235, v147
s_nop 1
v_cvt_pk_bf16_f32 v162, v232, v233
v_cvt_pk_bf16_f32 v163, v234, v235
v_max_f32 v204, v148, v149
v_max3_f32 v204, v204, v150, v151
v_mov_b32 v205, v204
s_nop 1
v_permlane32_swap_b32 v204, v205
s_nop 1
v_max_f32 v204, v204, v205
v_mov_b32 v205, v204
s_nop 1
v_permlane16_swap_b32 v204, v205
s_nop 1
v_max_f32 v204, v204, v205
v_add_f32 v204, 40.0, v204
v_ceil_f32 v204, v204
v_max_f32 v204, 0, v204
v_sub_f32 v205, v225, v204
v_cvt_pk_bf16_f32 v205, v205, v205
v_and_b32 v205, 0xffff0000, v205
v_sub_f32 v204, v205, v225
v_mov_b32 v225, v205
v_exp_f32 v237, v204
v_bfi_b32 v35, v206, v205, v35
v_add_f32 v148, v148, v204
v_add_f32 v149, v149, v204
v_add_f32 v150, v150, v204
v_add_f32 v151, v151, v204
v_add_f32 v132, v132, v204
v_add_f32 v133, v133, v204
v_add_f32 v134, v134, v204
v_add_f32 v135, v135, v204
v_lshlrev_b32 v242, 16, v180
v_and_b32 v248, 0xffff0000, v180
v_mul_f32 v242, v242, v237
v_mul_f32 v248, v248, v237
v_cvt_pk_bf16_f32 v180, v242, v248
v_lshlrev_b32 v242, 16, v181
v_and_b32 v248, 0xffff0000, v181
v_mul_f32 v242, v242, v237
v_mul_f32 v248, v248, v237
v_cvt_pk_bf16_f32 v181, v242, v248
v_lshlrev_b32 v242, 16, v182
v_and_b32 v248, 0xffff0000, v182
v_mul_f32 v242, v242, v237
v_mul_f32 v248, v248, v237
v_cvt_pk_bf16_f32 v182, v242, v248
v_lshlrev_b32 v242, 16, v183
v_and_b32 v248, 0xffff0000, v183
v_mul_f32 v242, v242, v237
v_mul_f32 v248, v248, v237
v_cvt_pk_bf16_f32 v183, v242, v248
v_lshlrev_b32 v242, 16, v164
v_and_b32 v248, 0xffff0000, v164
v_mul_f32 v242, v242, v237
v_mul_f32 v248, v248, v237
v_cvt_pk_bf16_f32 v164, v242, v248
v_lshlrev_b32 v242, 16, v165
v_and_b32 v248, 0xffff0000, v165
v_mul_f32 v242, v242, v237
v_mul_f32 v248, v248, v237
v_cvt_pk_bf16_f32 v165, v242, v248
ds_read_b64 v[250:251], v231 offset:1024
s_waitcnt lgkmcnt(0)
v_lshlrev_b32 v242, 16, v250
v_and_b32 v248, 0xffff0000, v250
v_mul_f32 v242, v242, v237
v_mul_f32 v248, v248, v237
v_cvt_pk_bf16_f32 v250, v242, v248
v_lshlrev_b32 v242, 16, v251
v_and_b32 v248, 0xffff0000, v251
v_mul_f32 v242, v242, v237
v_mul_f32 v248, v248, v237
v_cvt_pk_bf16_f32 v251, v242, v248
ds_write_b64 v231, v[250:251] offset:1024
s_waitcnt lgkmcnt(0)
ds_read_b64 v[250:251], v231 offset:1032
s_waitcnt lgkmcnt(0)
v_lshlrev_b32 v242, 16, v250
v_and_b32 v248, 0xffff0000, v250
v_mul_f32 v242, v242, v237
v_mul_f32 v248, v248, v237
v_cvt_pk_bf16_f32 v250, v242, v248
v_lshlrev_b32 v242, 16, v251
v_and_b32 v248, 0xffff0000, v251
v_mul_f32 v242, v242, v237
v_mul_f32 v248, v248, v237
v_cvt_pk_bf16_f32 v251, v242, v248
ds_write_b64 v231, v[250:251] offset:1032
s_waitcnt lgkmcnt(0)
ds_read_b64 v[250:251], v231 offset:5120
s_waitcnt lgkmcnt(0)
v_lshlrev_b32 v242, 16, v250
v_and_b32 v248, 0xffff0000, v250
v_mul_f32 v242, v242, v237
v_mul_f32 v248, v248, v237
v_cvt_pk_bf16_f32 v250, v242, v248
v_lshlrev_b32 v242, 16, v251
v_and_b32 v248, 0xffff0000, v251
v_mul_f32 v242, v242, v237
v_mul_f32 v248, v248, v237
v_cvt_pk_bf16_f32 v251, v242, v248
ds_write_b64 v231, v[250:251] offset:5120
s_waitcnt lgkmcnt(0)
ds_read_b64 v[250:251], v231 offset:5128
s_waitcnt lgkmcnt(0)
v_lshlrev_b32 v242, 16, v250
v_and_b32 v248, 0xffff0000, v250
v_mul_f32 v242, v242, v237
v_mul_f32 v248, v248, v237
v_cvt_pk_bf16_f32 v250, v242, v248
v_lshlrev_b32 v242, 16, v251
v_and_b32 v248, 0xffff0000, v251
v_mul_f32 v242, v242, v237
v_mul_f32 v248, v248, v237
v_cvt_pk_bf16_f32 v251, v242, v248
ds_write_b64 v231, v[250:251] offset:5128
s_waitcnt lgkmcnt(0)
v_exp_f32 v232, v148
v_exp_f32 v233, v149
v_exp_f32 v234, v150
v_exp_f32 v235, v151
s_nop 1
v_cvt_pk_bf16_f32 v166, v232, v233
v_cvt_pk_bf16_f32 v167, v234, v235
v_max_f32 v204, v152, v153
v_max3_f32 v204, v204, v154, v155
v_mov_b32 v205, v204
s_nop 1
v_permlane32_swap_b32 v204, v205
s_nop 1
v_max_f32 v204, v204, v205
v_mov_b32 v205, v204
s_nop 1
v_permlane16_swap_b32 v204, v205
s_nop 1
v_max_f32 v204, v204, v205
v_add_f32 v204, 40.0, v204
v_ceil_f32 v204, v204
v_max_f32 v204, 0, v204
v_sub_f32 v205, v226, v204
v_cvt_pk_bf16_f32 v205, v205, v205
v_and_b32 v205, 0xffff0000, v205
v_sub_f32 v204, v205, v226
v_mov_b32 v226, v205
v_exp_f32 v238, v204
v_bfi_b32 v67, v206, v205, v67
v_add_f32 v152, v152, v204
v_add_f32 v153, v153, v204
v_add_f32 v154, v154, v204
v_add_f32 v155, v155, v204
v_add_f32 v136, v136, v204
v_add_f32 v137, v137, v204
v_add_f32 v138, v138, v204
v_add_f32 v139, v139, v204
v_lshlrev_b32 v242, 16, v184
v_and_b32 v248, 0xffff0000, v184
v_mul_f32 v242, v242, v238
v_mul_f32 v248, v248, v238
v_cvt_pk_bf16_f32 v184, v242, v248
v_lshlrev_b32 v242, 16, v185
v_and_b32 v248, 0xffff0000, v185
v_mul_f32 v242, v242, v238
v_mul_f32 v248, v248, v238
v_cvt_pk_bf16_f32 v185, v242, v248
v_lshlrev_b32 v242, 16, v186
v_and_b32 v248, 0xffff0000, v186
v_mul_f32 v242, v242, v238
v_mul_f32 v248, v248, v238
v_cvt_pk_bf16_f32 v186, v242, v248
v_lshlrev_b32 v242, 16, v187
v_and_b32 v248, 0xffff0000, v187
v_mul_f32 v242, v242, v238
v_mul_f32 v248, v248, v238
v_cvt_pk_bf16_f32 v187, v242, v248
v_lshlrev_b32 v242, 16, v168
v_and_b32 v248, 0xffff0000, v168
v_mul_f32 v242, v242, v238
v_mul_f32 v248, v248, v238
v_cvt_pk_bf16_f32 v168, v242, v248
v_lshlrev_b32 v242, 16, v169
v_and_b32 v248, 0xffff0000, v169
v_mul_f32 v242, v242, v238
v_mul_f32 v248, v248, v238
v_cvt_pk_bf16_f32 v169, v242, v248
ds_read_b64 v[250:251], v231 offset:2048
s_waitcnt lgkmcnt(0)
v_lshlrev_b32 v242, 16, v250
v_and_b32 v248, 0xffff0000, v250
v_mul_f32 v242, v242, v238
v_mul_f32 v248, v248, v238
v_cvt_pk_bf16_f32 v250, v242, v248
v_lshlrev_b32 v242, 16, v251
v_and_b32 v248, 0xffff0000, v251
v_mul_f32 v242, v242, v238
v_mul_f32 v248, v248, v238
v_cvt_pk_bf16_f32 v251, v242, v248
ds_write_b64 v231, v[250:251] offset:2048
s_waitcnt lgkmcnt(0)
ds_read_b64 v[250:251], v231 offset:2056
s_waitcnt lgkmcnt(0)
v_lshlrev_b32 v242, 16, v250
v_and_b32 v248, 0xffff0000, v250
v_mul_f32 v242, v242, v238
v_mul_f32 v248, v248, v238
v_cvt_pk_bf16_f32 v250, v242, v248
v_lshlrev_b32 v242, 16, v251
v_and_b32 v248, 0xffff0000, v251
v_mul_f32 v242, v242, v238
v_mul_f32 v248, v248, v238
v_cvt_pk_bf16_f32 v251, v242, v248
ds_write_b64 v231, v[250:251] offset:2056
s_waitcnt lgkmcnt(0)
ds_read_b64 v[250:251], v231 offset:6144
s_waitcnt lgkmcnt(0)
v_lshlrev_b32 v242, 16, v250
v_and_b32 v248, 0xffff0000, v250
v_mul_f32 v242, v242, v238
v_mul_f32 v248, v248, v238
v_cvt_pk_bf16_f32 v250, v242, v248
v_lshlrev_b32 v242, 16, v251
v_and_b32 v248, 0xffff0000, v251
v_mul_f32 v242, v242, v238
v_mul_f32 v248, v248, v238
v_cvt_pk_bf16_f32 v251, v242, v248
ds_write_b64 v231, v[250:251] offset:6144
s_waitcnt lgkmcnt(0)
ds_read_b64 v[250:251], v231 offset:6152
s_waitcnt lgkmcnt(0)
v_lshlrev_b32 v242, 16, v250
v_and_b32 v248, 0xffff0000, v250
v_mul_f32 v242, v242, v238
v_mul_f32 v248, v248, v238
v_cvt_pk_bf16_f32 v250, v242, v248
v_lshlrev_b32 v242, 16, v251
v_and_b32 v248, 0xffff0000, v251
v_mul_f32 v242, v242, v238
v_mul_f32 v248, v248, v238
v_cvt_pk_bf16_f32 v251, v242, v248
ds_write_b64 v231, v[250:251] offset:6152
s_waitcnt lgkmcnt(0)
v_exp_f32 v232, v152
v_exp_f32 v233, v153
v_exp_f32 v234, v154
v_exp_f32 v235, v155
s_nop 1
v_cvt_pk_bf16_f32 v170, v232, v233
v_cvt_pk_bf16_f32 v171, v234, v235
v_max_f32 v204, v156, v157
v_max3_f32 v204, v204, v158, v159
v_mov_b32 v205, v204
s_nop 1
v_permlane32_swap_b32 v204, v205
s_nop 1
v_max_f32 v204, v204, v205
v_mov_b32 v205, v204
s_nop 1
v_permlane16_swap_b32 v204, v205
s_nop 1
v_max_f32 v204, v204, v205
v_add_f32 v204, 40.0, v204
v_ceil_f32 v204, v204
v_max_f32 v204, 0, v204
v_sub_f32 v205, v227, v204
v_cvt_pk_bf16_f32 v205, v205, v205
v_and_b32 v205, 0xffff0000, v205
v_sub_f32 v204, v205, v227
v_mov_b32 v227, v205
v_exp_f32 v239, v204
v_bfi_b32 v99, v206, v205, v99
v_add_f32 v156, v156, v204
v_add_f32 v157, v157, v204
v_add_f32 v158, v158, v204
v_add_f32 v159, v159, v204
v_add_f32 v140, v140, v204
v_add_f32 v141, v141, v204
v_add_f32 v142, v142, v204
v_add_f32 v143, v143, v204
v_lshlrev_b32 v242, 16, v188
v_and_b32 v248, 0xffff0000, v188
v_mul_f32 v242, v242, v239
v_mul_f32 v248, v248, v239
v_cvt_pk_bf16_f32 v188, v242, v248
v_lshlrev_b32 v242, 16, v189
v_and_b32 v248, 0xffff0000, v189
v_mul_f32 v242, v242, v239
v_mul_f32 v248, v248, v239
v_cvt_pk_bf16_f32 v189, v242, v248
v_lshlrev_b32 v242, 16, v190
v_and_b32 v248, 0xffff0000, v190
v_mul_f32 v242, v242, v239
v_mul_f32 v248, v248, v239
v_cvt_pk_bf16_f32 v190, v242, v248
v_lshlrev_b32 v242, 16, v191
v_and_b32 v248, 0xffff0000, v191
v_mul_f32 v242, v242, v239
v_mul_f32 v248, v248, v239
v_cvt_pk_bf16_f32 v191, v242, v248
v_lshlrev_b32 v242, 16, v172
v_and_b32 v248, 0xffff0000, v172
v_mul_f32 v242, v242, v239
v_mul_f32 v248, v248, v239
v_cvt_pk_bf16_f32 v172, v242, v248
v_lshlrev_b32 v242, 16, v173
v_and_b32 v248, 0xffff0000, v173
v_mul_f32 v242, v242, v239
v_mul_f32 v248, v248, v239
v_cvt_pk_bf16_f32 v173, v242, v248
ds_read_b64 v[250:251], v231 offset:3072
s_waitcnt lgkmcnt(0)
v_lshlrev_b32 v242, 16, v250
v_and_b32 v248, 0xffff0000, v250
v_mul_f32 v242, v242, v239
v_mul_f32 v248, v248, v239
v_cvt_pk_bf16_f32 v250, v242, v248
v_lshlrev_b32 v242, 16, v251
v_and_b32 v248, 0xffff0000, v251
v_mul_f32 v242, v242, v239
v_mul_f32 v248, v248, v239
v_cvt_pk_bf16_f32 v251, v242, v248
ds_write_b64 v231, v[250:251] offset:3072
s_waitcnt lgkmcnt(0)
ds_read_b64 v[250:251], v231 offset:3080
s_waitcnt lgkmcnt(0)
v_lshlrev_b32 v242, 16, v250
v_and_b32 v248, 0xffff0000, v250
v_mul_f32 v242, v242, v239
v_mul_f32 v248, v248, v239
v_cvt_pk_bf16_f32 v250, v242, v248
v_lshlrev_b32 v242, 16, v251
v_and_b32 v248, 0xffff0000, v251
v_mul_f32 v242, v242, v239
v_mul_f32 v248, v248, v239
v_cvt_pk_bf16_f32 v251, v242, v248
ds_write_b64 v231, v[250:251] offset:3080
s_waitcnt lgkmcnt(0)
ds_read_b64 v[250:251], v231 offset:7168
s_waitcnt lgkmcnt(0)
v_lshlrev_b32 v242, 16, v250
v_and_b32 v248, 0xffff0000, v250
v_mul_f32 v242, v242, v239
v_mul_f32 v248, v248, v239
v_cvt_pk_bf16_f32 v250, v242, v248
v_lshlrev_b32 v242, 16, v251
v_and_b32 v248, 0xffff0000, v251
v_mul_f32 v242, v242, v239
v_mul_f32 v248, v248, v239
v_cvt_pk_bf16_f32 v251, v242, v248
ds_write_b64 v231, v[250:251] offset:7168
s_waitcnt lgkmcnt(0)
ds_read_b64 v[250:251], v231 offset:7176
s_waitcnt lgkmcnt(0)
v_lshlrev_b32 v242, 16, v250
v_and_b32 v248, 0xffff0000, v250
v_mul_f32 v242, v242, v239
v_mul_f32 v248, v248, v239
v_cvt_pk_bf16_f32 v250, v242, v248
v_lshlrev_b32 v242, 16, v251
v_and_b32 v248, 0xffff0000, v251
v_mul_f32 v242, v242, v239
v_mul_f32 v248, v248, v239
v_cvt_pk_bf16_f32 v251, v242, v248
ds_write_b64 v231, v[250:251] offset:7176
s_waitcnt lgkmcnt(0)
v_exp_f32 v232, v156
v_exp_f32 v233, v157
v_exp_f32 v234, v158
v_exp_f32 v235, v159
s_nop 1
v_cvt_pk_bf16_f32 v174, v232, v233
v_cvt_pk_bf16_f32 v175, v234, v235
s_branch L2_rare_common
L2_rare_site10:
s_mov_b32 s36, 10
s_branch L2_rare_t1_4
L2_rare_t1_4:
s_nop 15
s_nop 15
s_waitcnt lgkmcnt(0)
v_lshrrev_b32 v206, 8, v243
v_add_u32 v206, 1, v206
v_lshrrev_b32 v206, 2, v206
v_sub_u32 v206, 0, v206
v_and_b32 v206, 0xffff0000, v206
v_max_f32 v204, v128, v129
v_max3_f32 v204, v204, v130, v131
v_mov_b32 v205, v204
s_nop 1
v_permlane32_swap_b32 v204, v205
s_nop 1
v_max_f32 v204, v204, v205
v_mov_b32 v205, v204
s_nop 1
v_permlane16_swap_b32 v204, v205
s_nop 1
v_max_f32 v204, v204, v205
v_add_f32 v204, 40.0, v204
v_ceil_f32 v204, v204
v_max_f32 v204, 0, v204
v_sub_f32 v205, v224, v204
v_cvt_pk_bf16_f32 v205, v205, v205
v_and_b32 v205, 0xffff0000, v205
v_sub_f32 v204, v205, v224
v_mov_b32 v224, v205
v_exp_f32 v236, v204
v_add_f32 v128, v128, v204
v_add_f32 v129, v129, v204
v_add_f32 v130, v130, v204
v_add_f32 v131, v131, v204
v_add_f32 v144, v144, v204
v_add_f32 v145, v145, v204
v_add_f32 v146, v146, v204
v_add_f32 v147, v147, v204
v_lshlrev_b32 v242, 16, v4
v_and_b32 v248, 0xffff0000, v4
v_mul_f32 v242, v242, v236
v_mul_f32 v248, v248, v236
v_cvt_pk_bf16_f32 v4, v242, v248
v_lshlrev_b32 v242, 16, v5
v_and_b32 v248, 0xffff0000, v5
v_mul_f32 v242, v242, v236
v_mul_f32 v248, v248, v236
v_cvt_pk_bf16_f32 v5, v242, v248
v_lshlrev_b32 v242, 16, v6
v_and_b32 v248, 0xffff0000, v6
v_mul_f32 v242, v242, v236
v_mul_f32 v248, v248, v236
v_cvt_pk_bf16_f32 v6, v242, v248
v_lshlrev_b32 v242, 16, v7
v_and_b32 v248, 0xffff0000, v7
v_mul_f32 v242, v242, v236
v_mul_f32 v248, v248, v236
v_cvt_pk_bf16_f32 v7, v242, v248
v_lshlrev_b32 v242, 16, v8
v_and_b32 v248, 0xffff0000, v8
v_mul_f32 v242, v242, v236
v_mul_f32 v248, v248, v236
v_cvt_pk_bf16_f32 v8, v242, v248
v_lshlrev_b32 v242, 16, v9
v_and_b32 v248, 0xffff0000, v9
v_mul_f32 v242, v242, v236
v_mul_f32 v248, v248, v236
v_cvt_pk_bf16_f32 v9, v242, v248
v_lshlrev_b32 v242, 16, v10
v_and_b32 v248, 0xffff0000, v10
v_mul_f32 v242, v242, v236
v_mul_f32 v248, v248, v236
v_cvt_pk_bf16_f32 v10, v242, v248
v_lshlrev_b32 v242, 16, v11
v_and_b32 v248, 0xffff0000, v11
v_mul_f32 v242, v242, v236
v_mul_f32 v248, v248, v236
v_cvt_pk_bf16_f32 v11, v242, v248
v_lshlrev_b32 v242, 16, v176
v_and_b32 v248, 0xffff0000, v176
v_mul_f32 v242, v242, v236
v_mul_f32 v248, v248, v236
v_cvt_pk_bf16_f32 v176, v242, v248
v_lshlrev_b32 v242, 16, v177
v_and_b32 v248, 0xffff0000, v177
v_mul_f32 v242, v242, v236
v_mul_f32 v248, v248, v236
v_cvt_pk_bf16_f32 v177, v242, v248
v_lshlrev_b32 v242, 16, v178
v_and_b32 v248, 0xffff0000, v178
v_mul_f32 v242, v242, v236
v_mul_f32 v248, v248, v236
v_cvt_pk_bf16_f32 v178, v242, v248
v_lshlrev_b32 v242, 16, v179
v_and_b32 v248, 0xffff0000, v179
v_mul_f32 v242, v242, v236
v_mul_f32 v248, v248, v236
v_cvt_pk_bf16_f32 v179, v242, v248
v_lshlrev_b32 v242, 16, v160
v_and_b32 v248, 0xffff0000, v160
v_mul_f32 v242, v242, v236
v_mul_f32 v248, v248, v236
v_cvt_pk_bf16_f32 v160, v242, v248
v_lshlrev_b32 v242, 16, v161
v_and_b32 v248, 0xffff0000, v161
v_mul_f32 v242, v242, v236
v_mul_f32 v248, v248, v236
v_cvt_pk_bf16_f32 v161, v242, v248
v_lshlrev_b32 v242, 16, v162
v_and_b32 v248, 0xffff0000, v162
v_mul_f32 v242, v242, v236
v_mul_f32 v248, v248, v236
v_cvt_pk_bf16_f32 v162, v242, v248
v_lshlrev_b32 v242, 16, v163
v_and_b32 v248, 0xffff0000, v163
v_mul_f32 v242, v242, v236
v_mul_f32 v248, v248, v236
v_cvt_pk_bf16_f32 v163, v242, v248
v_exp_f32 v232, v128
v_exp_f32 v233, v129
v_exp_f32 v234, v130
v_exp_f32 v235, v131
s_nop 1
v_cvt_pk_bf16_f32 v0, v232, v233
v_cvt_pk_bf16_f32 v1, v234, v235
v_max_f32 v204, v132, v133
v_max3_f32 v204, v204, v134, v135
v_mov_b32 v205, v204
s_nop 1
v_permlane32_swap_b32 v204, v205
s_nop 1
v_max_f32 v204, v204, v205
v_mov_b32 v205, v204
s_nop 1
v_permlane16_swap_b32 v204, v205
s_nop 1
v_max_f32 v204, v204, v205
v_add_f32 v204, 40.0, v204
v_ceil_f32 v204, v204
v_max_f32 v204, 0, v204
v_sub_f32 v205, v225, v204
v_cvt_pk_bf16_f32 v205, v205, v205
v_and_b32 v205, 0xffff0000, v205
v_sub_f32 v204, v205, v225
v_mov_b32 v225, v205
v_exp_f32 v237, v204
v_add_f32 v132, v132, v204
v_add_f32 v133, v133, v204
v_add_f32 v134, v134, v204
v_add_f32 v135, v135, v204
v_add_f32 v148, v148, v204
v_add_f32 v149, v149, v204
v_add_f32 v150, v150, v204
v_add_f32 v151, v151, v204
v_lshlrev_b32 v242, 16, v36
v_and_b32 v248, 0xffff0000, v36
v_mul_f32 v242, v242, v237
v_mul_f32 v248, v248, v237
v_cvt_pk_bf16_f32 v36, v242, v248
v_lshlrev_b32 v242, 16, v37
v_and_b32 v248, 0xffff0000, v37
v_mul_f32 v242, v242, v237
v_mul_f32 v248, v248, v237
v_cvt_pk_bf16_f32 v37, v242, v248
v_lshlrev_b32 v242, 16, v38
v_and_b32 v248, 0xffff0000, v38
v_mul_f32 v242, v242, v237
v_mul_f32 v248, v248, v237
v_cvt_pk_bf16_f32 v38, v242, v248
v_lshlrev_b32 v242, 16, v39
v_and_b32 v248, 0xffff0000, v39
v_mul_f32 v242, v242, v237
v_mul_f32 v248, v248, v237
v_cvt_pk_bf16_f32 v39, v242, v248
v_lshlrev_b32 v242, 16, v40
v_and_b32 v248, 0xffff0000, v40
v_mul_f32 v242, v242, v237
v_mul_f32 v248, v248, v237
v_cvt_pk_bf16_f32 v40, v242, v248
v_lshlrev_b32 v242, 16, v41
v_and_b32 v248, 0xffff0000, v41
v_mul_f32 v242, v242, v237
v_mul_f32 v248, v248, v237
v_cvt_pk_bf16_f32 v41, v242, v248
v_lshlrev_b32 v242, 16, v42
v_and_b32 v248, 0xffff0000, v42
v_mul_f32 v242, v242, v237
v_mul_f32 v248, v248, v237
v_cvt_pk_bf16_f32 v42, v242, v248
v_lshlrev_b32 v242, 16, v43
v_and_b32 v248, 0xffff0000, v43
v_mul_f32 v242, v242, v237
v_mul_f32 v248, v248, v237
v_cvt_pk_bf16_f32 v43, v242, v248
v_lshlrev_b32 v242, 16, v180
v_and_b32 v248, 0xffff0000, v180
v_mul_f32 v242, v242, v237
v_mul_f32 v248, v248, v237
v_cvt_pk_bf16_f32 v180, v242, v248
v_lshlrev_b32 v242, 16, v181
v_and_b32 v248, 0xffff0000, v181
v_mul_f32 v242, v242, v237
v_mul_f32 v248, v248, v237
v_cvt_pk_bf16_f32 v181, v242, v248
v_lshlrev_b32 v242, 16, v182
v_and_b32 v248, 0xffff0000, v182
v_mul_f32 v242, v242, v237
v_mul_f32 v248, v248, v237
v_cvt_pk_bf16_f32 v182, v242, v248
v_lshlrev_b32 v242, 16, v183
v_and_b32 v248, 0xffff0000, v183
v_mul_f32 v242, v242, v237
v_mul_f32 v248, v248, v237
v_cvt_pk_bf16_f32 v183, v242, v248
v_lshlrev_b32 v242, 16, v164
v_and_b32 v248, 0xffff0000, v164
v_mul_f32 v242, v242, v237
v_mul_f32 v248, v248, v237
v_cvt_pk_bf16_f32 v164, v242, v248
v_lshlrev_b32 v242, 16, v165
v_and_b32 v248, 0xffff0000, v165
v_mul_f32 v242, v242, v237
v_mul_f32 v248, v248, v237
v_cvt_pk_bf16_f32 v165, v242, v248
v_lshlrev_b32 v242, 16, v166
v_and_b32 v248, 0xffff0000, v166
v_mul_f32 v242, v242, v237
v_mul_f32 v248, v248, v237
v_cvt_pk_bf16_f32 v166, v242, v248
v_lshlrev_b32 v242, 16, v167
v_and_b32 v248, 0xffff0000, v167
v_mul_f32 v242, v242, v237
v_mul_f32 v248, v248, v237
v_cvt_pk_bf16_f32 v167, v242, v248
v_exp_f32 v232, v132
v_exp_f32 v233, v133
v_exp_f32 v234, v134
v_exp_f32 v235, v135
s_nop 1
v_cvt_pk_bf16_f32 v32, v232, v233
v_cvt_pk_bf16_f32 v33, v234, v235
v_max_f32 v204, v136, v137
v_max3_f32 v204, v204, v138, v139
v_mov_b32 v205, v204
s_nop 1
v_permlane32_swap_b32 v204, v205
s_nop 1
v_max_f32 v204, v204, v205
v_mov_b32 v205, v204
s_nop 1
v_permlane16_swap_b32 v204, v205
s_nop 1
v_max_f32 v204, v204, v205
v_add_f32 v204, 40.0, v204
v_ceil_f32 v204, v204
v_max_f32 v204, 0, v204
v_sub_f32 v205, v226, v204
v_cvt_pk_bf16_f32 v205, v205, v205
v_and_b32 v205, 0xffff0000, v205
v_sub_f32 v204, v205, v226
v_mov_b32 v226, v205
v_exp_f32 v238, v204
v_add_f32 v136, v136, v204
v_add_f32 v137, v137, v204
v_add_f32 v138, v138, v204
v_add_f32 v139, v139, v204
v_add_f32 v152, v152, v204
v_add_f32 v153, v153, v204
v_add_f32 v154, v154, v204
v_add_f32 v155, v155, v204
v_lshlrev_b32 v242, 16, v68
v_and_b32 v248, 0xffff0000, v68
v_mul_f32 v242, v242, v238
v_mul_f32 v248, v248, v238
v_cvt_pk_bf16_f32 v68, v242, v248
v_lshlrev_b32 v242, 16, v69
v_and_b32 v248, 0xffff0000, v69
v_mul_f32 v242, v242, v238
v_mul_f32 v248, v248, v238
v_cvt_pk_bf16_f32 v69, v242, v248
v_lshlrev_b32 v242, 16, v70
v_and_b32 v248, 0xffff0000, v70
v_mul_f32 v242, v242, v238
v_mul_f32 v248, v248, v238
v_cvt_pk_bf16_f32 v70, v242, v248
v_lshlrev_b32 v242, 16, v71
v_and_b32 v248, 0xffff0000, v71
v_mul_f32 v242, v242, v238
v_mul_f32 v248, v248, v238
v_cvt_pk_bf16_f32 v71, v242, v248
v_lshlrev_b32 v242, 16, v72
v_and_b32 v248, 0xffff0000, v72
v_mul_f32 v242, v242, v238
v_mul_f32 v248, v248, v238
v_cvt_pk_bf16_f32 v72, v242, v248
v_lshlrev_b32 v242, 16, v73
v_and_b32 v248, 0xffff0000, v73
v_mul_f32 v242, v242, v238
v_mul_f32 v248, v248, v238
v_cvt_pk_bf16_f32 v73, v242, v248
v_lshlrev_b32 v242, 16, v74
v_and_b32 v248, 0xffff0000, v74
v_mul_f32 v242, v242, v238
v_mul_f32 v248, v248, v238
v_cvt_pk_bf16_f32 v74, v242, v248
v_lshlrev_b32 v242, 16, v75
v_and_b32 v248, 0xffff0000, v75
v_mul_f32 v242, v242, v238
v_mul_f32 v248, v248, v238
v_cvt_pk_bf16_f32 v75, v242, v248
v_lshlrev_b32 v242, 16, v184
v_and_b32 v248, 0xffff0000, v184
v_mul_f32 v242, v242, v238
v_mul_f32 v248, v248, v238
v_cvt_pk_bf16_f32 v184, v242, v248
v_lshlrev_b32 v242, 16, v185
v_and_b32 v248, 0xffff0000, v185
v_mul_f32 v242, v242, v238
v_mul_f32 v248, v248, v238
v_cvt_pk_bf16_f32 v185, v242, v248
v_lshlrev_b32 v242, 16, v186
v_and_b32 v248, 0xffff0000, v186
v_mul_f32 v242, v242, v238
v_mul_f32 v248, v248, v238
v_cvt_pk_bf16_f32 v186, v242, v248
v_lshlrev_b32 v242, 16, v187
v_and_b32 v248, 0xffff0000, v187
v_mul_f32 v242, v242, v238
v_mul_f32 v248, v248, v238
v_cvt_pk_bf16_f32 v187, v242, v248
v_lshlrev_b32 v242, 16, v168
v_and_b32 v248, 0xffff0000, v168
v_mul_f32 v242, v242, v238
v_mul_f32 v248, v248, v238
v_cvt_pk_bf16_f32 v168, v242, v248
v_lshlrev_b32 v242, 16, v169
v_and_b32 v248, 0xffff0000, v169
v_mul_f32 v242, v242, v238
v_mul_f32 v248, v248, v238
v_cvt_pk_bf16_f32 v169, v242, v248
v_lshlrev_b32 v242, 16, v170
v_and_b32 v248, 0xffff0000, v170
v_mul_f32 v242, v242, v238
v_mul_f32 v248, v248, v238
v_cvt_pk_bf16_f32 v170, v242, v248
v_lshlrev_b32 v242, 16, v171
v_and_b32 v248, 0xffff0000, v171
v_mul_f32 v242, v242, v238
v_mul_f32 v248, v248, v238
v_cvt_pk_bf16_f32 v171, v242, v248
v_exp_f32 v232, v136
v_exp_f32 v233, v137
v_exp_f32 v234, v138
v_exp_f32 v235, v139
s_nop 1
v_cvt_pk_bf16_f32 v64, v232, v233
v_cvt_pk_bf16_f32 v65, v234, v235
v_max_f32 v204, v140, v141
v_max3_f32 v204, v204, v142, v143
v_mov_b32 v205, v204
s_nop 1
v_permlane32_swap_b32 v204, v205
s_nop 1
v_max_f32 v204, v204, v205
v_mov_b32 v205, v204
s_nop 1
v_permlane16_swap_b32 v204, v205
s_nop 1
v_max_f32 v204, v204, v205
v_add_f32 v204, 40.0, v204
v_ceil_f32 v204, v204
v_max_f32 v204, 0, v204
v_sub_f32 v205, v227, v204
v_cvt_pk_bf16_f32 v205, v205, v205
v_and_b32 v205, 0xffff0000, v205
v_sub_f32 v204, v205, v227
v_mov_b32 v227, v205
v_exp_f32 v239, v204
v_add_f32 v140, v140, v204
v_add_f32 v141, v141, v204
v_add_f32 v142, v142, v204
v_add_f32 v143, v143, v204
v_add_f32 v156, v156, v204
v_add_f32 v157, v157, v204
v_add_f32 v158, v158, v204
v_add_f32 v159, v159, v204
v_lshlrev_b32 v242, 16, v100
v_and_b32 v248, 0xffff0000, v100
v_mul_f32 v242, v242, v239
v_mul_f32 v248, v248, v239
v_cvt_pk_bf16_f32 v100, v242, v248
v_lshlrev_b32 v242, 16, v101
v_and_b32 v248, 0xffff0000, v101
v_mul_f32 v242, v242, v239
v_mul_f32 v248, v248, v239
v_cvt_pk_bf16_f32 v101, v242, v248
v_lshlrev_b32 v242, 16, v102
v_and_b32 v248, 0xffff0000, v102
v_mul_f32 v242, v242, v239
v_mul_f32 v248, v248, v239
v_cvt_pk_bf16_f32 v102, v242, v248
v_lshlrev_b32 v242, 16, v103
v_and_b32 v248, 0xffff0000, v103
v_mul_f32 v242, v242, v239
v_mul_f32 v248, v248, v239
v_cvt_pk_bf16_f32 v103, v242, v248
v_lshlrev_b32 v242, 16, v104
v_and_b32 v248, 0xffff0000, v104
v_mul_f32 v242, v242, v239
v_mul_f32 v248, v248, v239
v_cvt_pk_bf16_f32 v104, v242, v248
v_lshlrev_b32 v242, 16, v105
v_and_b32 v248, 0xffff0000, v105
v_mul_f32 v242, v242, v239
v_mul_f32 v248, v248, v239
v_cvt_pk_bf16_f32 v105, v242, v248
v_lshlrev_b32 v242, 16, v106
v_and_b32 v248, 0xffff0000, v106
v_mul_f32 v242, v242, v239
v_mul_f32 v248, v248, v239
v_cvt_pk_bf16_f32 v106, v242, v248
v_lshlrev_b32 v242, 16, v107
v_and_b32 v248, 0xffff0000, v107
v_mul_f32 v242, v242, v239
v_mul_f32 v248, v248, v239
v_cvt_pk_bf16_f32 v107, v242, v248
v_lshlrev_b32 v242, 16, v188
v_and_b32 v248, 0xffff0000, v188
v_mul_f32 v242, v242, v239
v_mul_f32 v248, v248, v239
v_cvt_pk_bf16_f32 v188, v242, v248
v_lshlrev_b32 v242, 16, v189
v_and_b32 v248, 0xffff0000, v189
v_mul_f32 v242, v242, v239
v_mul_f32 v248, v248, v239
v_cvt_pk_bf16_f32 v189, v242, v248
v_lshlrev_b32 v242, 16, v190
v_and_b32 v248, 0xffff0000, v190
v_mul_f32 v242, v242, v239
v_mul_f32 v248, v248, v239
v_cvt_pk_bf16_f32 v190, v242, v248
v_lshlrev_b32 v242, 16, v191
v_and_b32 v248, 0xffff0000, v191
v_mul_f32 v242, v242, v239
v_mul_f32 v248, v248, v239
v_cvt_pk_bf16_f32 v191, v242, v248
v_lshlrev_b32 v242, 16, v172
v_and_b32 v248, 0xffff0000, v172
v_mul_f32 v242, v242, v239
v_mul_f32 v248, v248, v239
v_cvt_pk_bf16_f32 v172, v242, v248
v_lshlrev_b32 v242, 16, v173
v_and_b32 v248, 0xffff0000, v173
v_mul_f32 v242, v242, v239
v_mul_f32 v248, v248, v239
v_cvt_pk_bf16_f32 v173, v242, v248
v_lshlrev_b32 v242, 16, v174
v_and_b32 v248, 0xffff0000, v174
v_mul_f32 v242, v242, v239
v_mul_f32 v248, v248, v239
v_cvt_pk_bf16_f32 v174, v242, v248
v_lshlrev_b32 v242, 16, v175
v_and_b32 v248, 0xffff0000, v175
v_mul_f32 v242, v242, v239
v_mul_f32 v248, v248, v239
v_cvt_pk_bf16_f32 v175, v242, v248
v_exp_f32 v232, v140
v_exp_f32 v233, v141
v_exp_f32 v234, v142
v_exp_f32 v235, v143
s_nop 1
v_cvt_pk_bf16_f32 v96, v232, v233
v_cvt_pk_bf16_f32 v97, v234, v235
s_branch L2_rare_common
L2_rare_site11:
s_mov_b32 s36, 11
s_branch L2_rare_t1_5
L2_rare_t1_5:
s_nop 15
s_nop 15
s_waitcnt lgkmcnt(0)
v_lshrrev_b32 v206, 8, v243
v_add_u32 v206, 1, v206
v_lshrrev_b32 v206, 2, v206
v_sub_u32 v206, 0, v206
v_and_b32 v206, 0xffff0000, v206
v_max_f32 v204, v144, v145
v_max3_f32 v204, v204, v146, v147
v_mov_b32 v205, v204
s_nop 1
v_permlane32_swap_b32 v204, v205
s_nop 1
v_max_f32 v204, v204, v205
v_mov_b32 v205, v204
s_nop 1
v_permlane16_swap_b32 v204, v205
s_nop 1
v_max_f32 v204, v204, v205
v_add_f32 v204, 40.0, v204
v_ceil_f32 v204, v204
v_max_f32 v204, 0, v204
v_sub_f32 v205, v224, v204
v_cvt_pk_bf16_f32 v205, v205, v205
v_and_b32 v205, 0xffff0000, v205
v_sub_f32 v204, v205, v224
v_mov_b32 v224, v205
v_exp_f32 v236, v204
v_add_f32 v144, v144, v204
v_add_f32 v145, v145, v204
v_add_f32 v146, v146, v204
v_add_f32 v147, v147, v204
v_add_f32 v128, v128, v204
v_add_f32 v129, v129, v204
v_add_f32 v130, v130, v204
v_add_f32 v131, v131, v204
v_lshlrev_b32 v242, 16, v4
v_and_b32 v248, 0xffff0000, v4
v_mul_f32 v242, v242, v236
v_mul_f32 v248, v248, v236
v_cvt_pk_bf16_f32 v4, v242, v248
v_lshlrev_b32 v242, 16, v5
v_and_b32 v248, 0xffff0000, v5
v_mul_f32 v242, v242, v236
v_mul_f32 v248, v248, v236
v_cvt_pk_bf16_f32 v5, v242, v248
v_lshlrev_b32 v242, 16, v6
v_and_b32 v248, 0xffff0000, v6
v_mul_f32 v242, v242, v236
v_mul_f32 v248, v248, v236
v_cvt_pk_bf16_f32 v6, v242, v248
v_lshlrev_b32 v242, 16, v7
v_and_b32 v248, 0xffff0000, v7
v_mul_f32 v242, v242, v236
v_mul_f32 v248, v248, v236
v_cvt_pk_bf16_f32 v7, v242, v248
v_lshlrev_b32 v242, 16, v8
v_and_b32 v248, 0xffff0000, v8
v_mul_f32 v242, v242, v236
v_mul_f32 v248, v248, v236
v_cvt_pk_bf16_f32 v8, v242, v248
v_lshlrev_b32 v242, 16, v9
v_and_b32 v248, 0xffff0000, v9
v_mul_f32 v242, v242, v236
v_mul_f32 v248, v248, v236
v_cvt_pk_bf16_f32 v9, v242, v248
v_lshlrev_b32 v242, 16, v10
v_and_b32 v248, 0xffff0000, v10
v_mul_f32 v242, v242, v236
v_mul_f32 v248, v248, v236
v_cvt_pk_bf16_f32 v10, v242, v248
v_lshlrev_b32 v242, 16, v11
v_and_b32 v248, 0xffff0000, v11
v_mul_f32 v242, v242, v236
v_mul_f32 v248, v248, v236
v_cvt_pk_bf16_f32 v11, v242, v248
v_lshlrev_b32 v242, 16, v176
v_and_b32 v248, 0xffff0000, v176
v_mul_f32 v242, v242, v236
v_mul_f32 v248, v248, v236
v_cvt_pk_bf16_f32 v176, v242, v248
v_lshlrev_b32 v242, 16, v177
v_and_b32 v248, 0xffff0000, v177
v_mul_f32 v242, v242, v236
v_mul_f32 v248, v248, v236
v_cvt_pk_bf16_f32 v177, v242, v248
v_lshlrev_b32 v242, 16, v178
v_and_b32 v248, 0xffff0000, v178
v_mul_f32 v242, v242, v236
v_mul_f32 v248, v248, v236
v_cvt_pk_bf16_f32 v178, v242, v248
v_lshlrev_b32 v242, 16, v179
v_and_b32 v248, 0xffff0000, v179
v_mul_f32 v242, v242, v236
v_mul_f32 v248, v248, v236
v_cvt_pk_bf16_f32 v179, v242, v248
v_lshlrev_b32 v242, 16, v160
v_and_b32 v248, 0xffff0000, v160
v_mul_f32 v242, v242, v236
v_mul_f32 v248, v248, v236
v_cvt_pk_bf16_f32 v160, v242, v248
v_lshlrev_b32 v242, 16, v161
v_and_b32 v248, 0xffff0000, v161
v_mul_f32 v242, v242, v236
v_mul_f32 v248, v248, v236
v_cvt_pk_bf16_f32 v161, v242, v248
v_lshlrev_b32 v242, 16, v162
v_and_b32 v248, 0xffff0000, v162
v_mul_f32 v242, v242, v236
v_mul_f32 v248, v248, v236
v_cvt_pk_bf16_f32 v162, v242, v248
v_lshlrev_b32 v242, 16, v163
v_and_b32 v248, 0xffff0000, v163
v_mul_f32 v242, v242, v236
v_mul_f32 v248, v248, v236
v_cvt_pk_bf16_f32 v163, v242, v248
v_lshlrev_b32 v242, 16, v0
v_and_b32 v248, 0xffff0000, v0
v_mul_f32 v242, v242, v236
v_mul_f32 v248, v248, v236
v_cvt_pk_bf16_f32 v0, v242, v248
v_lshlrev_b32 v242, 16, v1
v_and_b32 v248, 0xffff0000, v1
v_mul_f32 v242, v242, v236
v_mul_f32 v248, v248, v236
v_cvt_pk_bf16_f32 v1, v242, v248
v_exp_f32 v232, v144
v_exp_f32 v233, v145
v_exp_f32 v234, v146
v_exp_f32 v235, v147
s_nop 1
v_cvt_pk_bf16_f32 v2, v232, v233
v_cvt_pk_bf16_f32 v3, v234, v235
v_max_f32 v204, v148, v149
v_max3_f32 v204, v204, v150, v151
v_mov_b32 v205, v204
s_nop 1
v_permlane32_swap_b32 v204, v205
s_nop 1
v_max_f32 v204, v204, v205
v_mov_b32 v205, v204
s_nop 1
v_permlane16_swap_b32 v204, v205
s_nop 1
v_max_f32 v204, v204, v205
v_add_f32 v204, 40.0, v204
v_ceil_f32 v204, v204
v_max_f32 v204, 0, v204
v_sub_f32 v205, v225, v204
v_cvt_pk_bf16_f32 v205, v205, v205
v_and_b32 v205, 0xffff0000, v205
v_sub_f32 v204, v205, v225
v_mov_b32 v225, v205
v_exp_f32 v237, v204
v_add_f32 v148, v148, v204
v_add_f32 v149, v149, v204
v_add_f32 v150, v150, v204
v_add_f32 v151, v151, v204
v_add_f32 v132, v132, v204
v_add_f32 v133, v133, v204
v_add_f32 v134, v134, v204
v_add_f32 v135, v135, v204
v_lshlrev_b32 v242, 16, v36
v_and_b32 v248, 0xffff0000, v36
v_mul_f32 v242, v242, v237
v_mul_f32 v248, v248, v237
v_cvt_pk_bf16_f32 v36, v242, v248
v_lshlrev_b32 v242, 16, v37
v_and_b32 v248, 0xffff0000, v37
v_mul_f32 v242, v242, v237
v_mul_f32 v248, v248, v237
v_cvt_pk_bf16_f32 v37, v242, v248
v_lshlrev_b32 v242, 16, v38
v_and_b32 v248, 0xffff0000, v38
v_mul_f32 v242, v242, v237
v_mul_f32 v248, v248, v237
v_cvt_pk_bf16_f32 v38, v242, v248
v_lshlrev_b32 v242, 16, v39
v_and_b32 v248, 0xffff0000, v39
v_mul_f32 v242, v242, v237
v_mul_f32 v248, v248, v237
v_cvt_pk_bf16_f32 v39, v242, v248
v_lshlrev_b32 v242, 16, v40
v_and_b32 v248, 0xffff0000, v40
v_mul_f32 v242, v242, v237
v_mul_f32 v248, v248, v237
v_cvt_pk_bf16_f32 v40, v242, v248
v_lshlrev_b32 v242, 16, v41
v_and_b32 v248, 0xffff0000, v41
v_mul_f32 v242, v242, v237
v_mul_f32 v248, v248, v237
v_cvt_pk_bf16_f32 v41, v242, v248
v_lshlrev_b32 v242, 16, v42
v_and_b32 v248, 0xffff0000, v42
v_mul_f32 v242, v242, v237
v_mul_f32 v248, v248, v237
v_cvt_pk_bf16_f32 v42, v242, v248
v_lshlrev_b32 v242, 16, v43
v_and_b32 v248, 0xffff0000, v43
v_mul_f32 v242, v242, v237
v_mul_f32 v248, v248, v237
v_cvt_pk_bf16_f32 v43, v242, v248
v_lshlrev_b32 v242, 16, v180
v_and_b32 v248, 0xffff0000, v180
v_mul_f32 v242, v242, v237
v_mul_f32 v248, v248, v237
v_cvt_pk_bf16_f32 v180, v242, v248
v_lshlrev_b32 v242, 16, v181
v_and_b32 v248, 0xffff0000, v181
v_mul_f32 v242, v242, v237
v_mul_f32 v248, v248, v237
v_cvt_pk_bf16_f32 v181, v242, v248
v_lshlrev_b32 v242, 16, v182
v_and_b32 v248, 0xffff0000, v182
v_mul_f32 v242, v242, v237
v_mul_f32 v248, v248, v237
v_cvt_pk_bf16_f32 v182, v242, v248
v_lshlrev_b32 v242, 16, v183
v_and_b32 v248, 0xffff0000, v183
v_mul_f32 v242, v242, v237
v_mul_f32 v248, v248, v237
v_cvt_pk_bf16_f32 v183, v242, v248
v_lshlrev_b32 v242, 16, v164
v_and_b32 v248, 0xffff0000, v164
v_mul_f32 v242, v242, v237
v_mul_f32 v248, v248, v237
v_cvt_pk_bf16_f32 v164, v242, v248
v_lshlrev_b32 v242, 16, v165
v_and_b32 v248, 0xffff0000, v165
v_mul_f32 v242, v242, v237
v_mul_f32 v248, v248, v237
v_cvt_pk_bf16_f32 v165, v242, v248
v_lshlrev_b32 v242, 16, v166
v_and_b32 v248, 0xffff0000, v166
v_mul_f32 v242, v242, v237
v_mul_f32 v248, v248, v237
v_cvt_pk_bf16_f32 v166, v242, v248
v_lshlrev_b32 v242, 16, v167
v_and_b32 v248, 0xffff0000, v167
v_mul_f32 v242, v242, v237
v_mul_f32 v248, v248, v237
v_cvt_pk_bf16_f32 v167, v242, v248
v_lshlrev_b32 v242, 16, v32
v_and_b32 v248, 0xffff0000, v32
v_mul_f32 v242, v242, v237
v_mul_f32 v248, v248, v237
v_cvt_pk_bf16_f32 v32, v242, v248
v_lshlrev_b32 v242, 16, v33
v_and_b32 v248, 0xffff0000, v33
v_mul_f32 v242, v242, v237
v_mul_f32 v248, v248, v237
v_cvt_pk_bf16_f32 v33, v242, v248
v_exp_f32 v232, v148
v_exp_f32 v233, v149
v_exp_f32 v234, v150
v_exp_f32 v235, v151
s_nop 1
v_cvt_pk_bf16_f32 v34, v232, v233
v_cvt_pk_bf16_f32 v35, v234, v235
v_max_f32 v204, v152, v153
v_max3_f32 v204, v204, v154, v155
v_mov_b32 v205, v204
s_nop 1
v_permlane32_swap_b32 v204, v205
s_nop 1
v_max_f32 v204, v204, v205
v_mov_b32 v205, v204
s_nop 1
v_permlane16_swap_b32 v204, v205
s_nop 1
v_max_f32 v204, v204, v205
v_add_f32 v204, 40.0, v204
v_ceil_f32 v204, v204
v_max_f32 v204, 0, v204
v_sub_f32 v205, v226, v204
v_cvt_pk_bf16_f32 v205, v205, v205
v_and_b32 v205, 0xffff0000, v205
v_sub_f32 v204, v205, v226
v_mov_b32 v226, v205
v_exp_f32 v238, v204
v_add_f32 v152, v152, v204
v_add_f32 v153, v153, v204
v_add_f32 v154, v154, v204
v_add_f32 v155, v155, v204
v_add_f32 v136, v136, v204
v_add_f32 v137, v137, v204
v_add_f32 v138, v138, v204
v_add_f32 v139, v139, v204
v_lshlrev_b32 v242, 16, v68
v_and_b32 v248, 0xffff0000, v68
v_mul_f32 v242, v242, v238
v_mul_f32 v248, v248, v238
v_cvt_pk_bf16_f32 v68, v242, v248
v_lshlrev_b32 v242, 16, v69
v_and_b32 v248, 0xffff0000, v69
v_mul_f32 v242, v242, v238
v_mul_f32 v248, v248, v238
v_cvt_pk_bf16_f32 v69, v242, v248
v_lshlrev_b32 v242, 16, v70
v_and_b32 v248, 0xffff0000, v70
v_mul_f32 v242, v242, v238
v_mul_f32 v248, v248, v238
v_cvt_pk_bf16_f32 v70, v242, v248
v_lshlrev_b32 v242, 16, v71
v_and_b32 v248, 0xffff0000, v71
v_mul_f32 v242, v242, v238
v_mul_f32 v248, v248, v238
v_cvt_pk_bf16_f32 v71, v242, v248
v_lshlrev_b32 v242, 16, v72
v_and_b32 v248, 0xffff0000, v72
v_mul_f32 v242, v242, v238
v_mul_f32 v248, v248, v238
v_cvt_pk_bf16_f32 v72, v242, v248
v_lshlrev_b32 v242, 16, v73
v_and_b32 v248, 0xffff0000, v73
v_mul_f32 v242, v242, v238
v_mul_f32 v248, v248, v238
v_cvt_pk_bf16_f32 v73, v242, v248
v_lshlrev_b32 v242, 16, v74
v_and_b32 v248, 0xffff0000, v74
v_mul_f32 v242, v242, v238
v_mul_f32 v248, v248, v238
v_cvt_pk_bf16_f32 v74, v242, v248
v_lshlrev_b32 v242, 16, v75
v_and_b32 v248, 0xffff0000, v75
v_mul_f32 v242, v242, v238
v_mul_f32 v248, v248, v238
v_cvt_pk_bf16_f32 v75, v242, v248
v_lshlrev_b32 v242, 16, v184
v_and_b32 v248, 0xffff0000, v184
v_mul_f32 v242, v242, v238
v_mul_f32 v248, v248, v238
v_cvt_pk_bf16_f32 v184, v242, v248
v_lshlrev_b32 v242, 16, v185
v_and_b32 v248, 0xffff0000, v185
v_mul_f32 v242, v242, v238
v_mul_f32 v248, v248, v238
v_cvt_pk_bf16_f32 v185, v242, v248
v_lshlrev_b32 v242, 16, v186
v_and_b32 v248, 0xffff0000, v186
v_mul_f32 v242, v242, v238
v_mul_f32 v248, v248, v238
v_cvt_pk_bf16_f32 v186, v242, v248
v_lshlrev_b32 v242, 16, v187
v_and_b32 v248, 0xffff0000, v187
v_mul_f32 v242, v242, v238
v_mul_f32 v248, v248, v238
v_cvt_pk_bf16_f32 v187, v242, v248
v_lshlrev_b32 v242, 16, v168
v_and_b32 v248, 0xffff0000, v168
v_mul_f32 v242, v242, v238
v_mul_f32 v248, v248, v238
v_cvt_pk_bf16_f32 v168, v242, v248
v_lshlrev_b32 v242, 16, v169
v_and_b32 v248, 0xffff0000, v169
v_mul_f32 v242, v242, v238
v_mul_f32 v248, v248, v238
v_cvt_pk_bf16_f32 v169, v242, v248
v_lshlrev_b32 v242, 16, v170
v_and_b32 v248, 0xffff0000, v170
v_mul_f32 v242, v242, v238
v_mul_f32 v248, v248, v238
v_cvt_pk_bf16_f32 v170, v242, v248
v_lshlrev_b32 v242, 16, v171
v_and_b32 v248, 0xffff0000, v171
v_mul_f32 v242, v242, v238
v_mul_f32 v248, v248, v238
v_cvt_pk_bf16_f32 v171, v242, v248
v_lshlrev_b32 v242, 16, v64
v_and_b32 v248, 0xffff0000, v64
v_mul_f32 v242, v242, v238
v_mul_f32 v248, v248, v238
v_cvt_pk_bf16_f32 v64, v242, v248
v_lshlrev_b32 v242, 16, v65
v_and_b32 v248, 0xffff0000, v65
v_mul_f32 v242, v242, v238
v_mul_f32 v248, v248, v238
v_cvt_pk_bf16_f32 v65, v242, v248
v_exp_f32 v232, v152
v_exp_f32 v233, v153
v_exp_f32 v234, v154
v_exp_f32 v235, v155
s_nop 1
v_cvt_pk_bf16_f32 v66, v232, v233
v_cvt_pk_bf16_f32 v67, v234, v235
v_max_f32 v204, v156, v157
v_max3_f32 v204, v204, v158, v159
v_mov_b32 v205, v204
s_nop 1
v_permlane32_swap_b32 v204, v205
s_nop 1
v_max_f32 v204, v204, v205
v_mov_b32 v205, v204
s_nop 1
v_permlane16_swap_b32 v204, v205
s_nop 1
v_max_f32 v204, v204, v205
v_add_f32 v204, 40.0, v204
v_ceil_f32 v204, v204
v_max_f32 v204, 0, v204
v_sub_f32 v205, v227, v204
v_cvt_pk_bf16_f32 v205, v205, v205
v_and_b32 v205, 0xffff0000, v205
v_sub_f32 v204, v205, v227
v_mov_b32 v227, v205
v_exp_f32 v239, v204
v_add_f32 v156, v156, v204
v_add_f32 v157, v157, v204
v_add_f32 v158, v158, v204
v_add_f32 v159, v159, v204
v_add_f32 v140, v140, v204
v_add_f32 v141, v141, v204
v_add_f32 v142, v142, v204
v_add_f32 v143, v143, v204
v_lshlrev_b32 v242, 16, v100
v_and_b32 v248, 0xffff0000, v100
v_mul_f32 v242, v242, v239
v_mul_f32 v248, v248, v239
v_cvt_pk_bf16_f32 v100, v242, v248
v_lshlrev_b32 v242, 16, v101
v_and_b32 v248, 0xffff0000, v101
v_mul_f32 v242, v242, v239
v_mul_f32 v248, v248, v239
v_cvt_pk_bf16_f32 v101, v242, v248
v_lshlrev_b32 v242, 16, v102
v_and_b32 v248, 0xffff0000, v102
v_mul_f32 v242, v242, v239
v_mul_f32 v248, v248, v239
v_cvt_pk_bf16_f32 v102, v242, v248
v_lshlrev_b32 v242, 16, v103
v_and_b32 v248, 0xffff0000, v103
v_mul_f32 v242, v242, v239
v_mul_f32 v248, v248, v239
v_cvt_pk_bf16_f32 v103, v242, v248
v_lshlrev_b32 v242, 16, v104
v_and_b32 v248, 0xffff0000, v104
v_mul_f32 v242, v242, v239
v_mul_f32 v248, v248, v239
v_cvt_pk_bf16_f32 v104, v242, v248
v_lshlrev_b32 v242, 16, v105
v_and_b32 v248, 0xffff0000, v105
v_mul_f32 v242, v242, v239
v_mul_f32 v248, v248, v239
v_cvt_pk_bf16_f32 v105, v242, v248
v_lshlrev_b32 v242, 16, v106
v_and_b32 v248, 0xffff0000, v106
v_mul_f32 v242, v242, v239
v_mul_f32 v248, v248, v239
v_cvt_pk_bf16_f32 v106, v242, v248
v_lshlrev_b32 v242, 16, v107
v_and_b32 v248, 0xffff0000, v107
v_mul_f32 v242, v242, v239
v_mul_f32 v248, v248, v239
v_cvt_pk_bf16_f32 v107, v242, v248
v_lshlrev_b32 v242, 16, v188
v_and_b32 v248, 0xffff0000, v188
v_mul_f32 v242, v242, v239
v_mul_f32 v248, v248, v239
v_cvt_pk_bf16_f32 v188, v242, v248
v_lshlrev_b32 v242, 16, v189
v_and_b32 v248, 0xffff0000, v189
v_mul_f32 v242, v242, v239
v_mul_f32 v248, v248, v239
v_cvt_pk_bf16_f32 v189, v242, v248
v_lshlrev_b32 v242, 16, v190
v_and_b32 v248, 0xffff0000, v190
v_mul_f32 v242, v242, v239
v_mul_f32 v248, v248, v239
v_cvt_pk_bf16_f32 v190, v242, v248
v_lshlrev_b32 v242, 16, v191
v_and_b32 v248, 0xffff0000, v191
v_mul_f32 v242, v242, v239
v_mul_f32 v248, v248, v239
v_cvt_pk_bf16_f32 v191, v242, v248
v_lshlrev_b32 v242, 16, v172
v_and_b32 v248, 0xffff0000, v172
v_mul_f32 v242, v242, v239
v_mul_f32 v248, v248, v239
v_cvt_pk_bf16_f32 v172, v242, v248
v_lshlrev_b32 v242, 16, v173
v_and_b32 v248, 0xffff0000, v173
v_mul_f32 v242, v242, v239
v_mul_f32 v248, v248, v239
v_cvt_pk_bf16_f32 v173, v242, v248
v_lshlrev_b32 v242, 16, v174
v_and_b32 v248, 0xffff0000, v174
v_mul_f32 v242, v242, v239
v_mul_f32 v248, v248, v239
v_cvt_pk_bf16_f32 v174, v242, v248
v_lshlrev_b32 v242, 16, v175
v_and_b32 v248, 0xffff0000, v175
v_mul_f32 v242, v242, v239
v_mul_f32 v248, v248, v239
v_cvt_pk_bf16_f32 v175, v242, v248
v_lshlrev_b32 v242, 16, v96
v_and_b32 v248, 0xffff0000, v96
v_mul_f32 v242, v242, v239
v_mul_f32 v248, v248, v239
v_cvt_pk_bf16_f32 v96, v242, v248
v_lshlrev_b32 v242, 16, v97
v_and_b32 v248, 0xffff0000, v97
v_mul_f32 v242, v242, v239
v_mul_f32 v248, v248, v239
v_cvt_pk_bf16_f32 v97, v242, v248
v_exp_f32 v232, v156
v_exp_f32 v233, v157
v_exp_f32 v234, v158
v_exp_f32 v235, v159
s_nop 1
v_cvt_pk_bf16_f32 v98, v232, v233
v_cvt_pk_bf16_f32 v99, v234, v235
s_branch L2_rare_common
LF_hl_1:
s_mov_b32 s94, 0x10000
s_mov_b32 s3, 0x7c28000
LF_hl2_1:
v_lshlrev_b32 v241, 3, v243
buffer_load_dwordx2 v[240:241], v241, s[16:19], s3 offen sc1
s_sub_u32 s94, s94, 1
s_waitcnt vmcnt(0)
s_cbranch_scc1 LF_hlret_1
v_cmp_ne_u64_e64 s[38:39], s[98:99], v[240:241]
s_and_b64 s[38:39], s[38:39], s[96:97]
s_cbranch_scc1 LF_hl2_1
s_branch LF_hlret_1
L2_rare_site12:
s_mov_b32 s36, 12
s_branch L2_rare_t0_0
L2_rare_t0_0:
s_nop 15
s_nop 15
s_waitcnt lgkmcnt(0)
v_lshrrev_b32 v206, 8, v243
v_add_u32 v206, 1, v206
v_lshrrev_b32 v206, 2, v206
v_sub_u32 v206, 0, v206
v_and_b32 v206, 0xffff0000, v206
v_max_f32 v204, v128, v129
v_max3_f32 v204, v204, v130, v131
v_mov_b32 v205, v204
s_nop 1
v_permlane32_swap_b32 v204, v205
s_nop 1
v_max_f32 v204, v204, v205
v_mov_b32 v205, v204
s_nop 1
v_permlane16_swap_b32 v204, v205
s_nop 1
v_max_f32 v204, v204, v205
v_add_f32 v204, 40.0, v204
v_ceil_f32 v204, v204
v_max_f32 v204, 0, v204
v_sub_f32 v205, v224, v204
v_cvt_pk_bf16_f32 v205, v205, v205
v_and_b32 v205, 0xffff0000, v205
v_sub_f32 v204, v205, v224
v_mov_b32 v224, v205
v_exp_f32 v236, v204
v_bfi_b32 v3, v206, v205, v3
v_add_f32 v128, v128, v204
v_add_f32 v129, v129, v204
v_add_f32 v130, v130, v204
v_add_f32 v131, v131, v204
v_add_f32 v144, v144, v204
v_add_f32 v145, v145, v204
v_add_f32 v146, v146, v204
v_add_f32 v147, v147, v204
v_lshlrev_b32 v242, 16, v176
v_and_b32 v248, 0xffff0000, v176
v_mul_f32 v242, v242, v236
v_mul_f32 v248, v248, v236
v_cvt_pk_bf16_f32 v176, v242, v248
v_lshlrev_b32 v242, 16, v177
v_and_b32 v248, 0xffff0000, v177
v_mul_f32 v242, v242, v236
v_mul_f32 v248, v248, v236
v_cvt_pk_bf16_f32 v177, v242, v248
v_lshlrev_b32 v242, 16, v178
v_and_b32 v248, 0xffff0000, v178
v_mul_f32 v242, v242, v236
v_mul_f32 v248, v248, v236
v_cvt_pk_bf16_f32 v178, v242, v248
v_lshlrev_b32 v242, 16, v179
v_and_b32 v248, 0xffff0000, v179
v_mul_f32 v242, v242, v236
v_mul_f32 v248, v248, v236
v_cvt_pk_bf16_f32 v179, v242, v248
ds_read_b64 v[250:251], v231 offset:0
s_waitcnt lgkmcnt(0)
v_lshlrev_b32 v242, 16, v250
v_and_b32 v248, 0xffff0000, v250
v_mul_f32 v242, v242, v236
v_mul_f32 v248, v248, v236
v_cvt_pk_bf16_f32 v250, v242, v248
v_lshlrev_b32 v242, 16, v251
v_and_b32 v248, 0xffff0000, v251
v_mul_f32 v242, v242, v236
v_mul_f32 v248, v248, v236
v_cvt_pk_bf16_f32 v251, v242, v248
ds_write_b64 v231, v[250:251] offset:0
s_waitcnt lgkmcnt(0)
ds_read_b64 v[250:251], v231 offset:8
s_waitcnt lgkmcnt(0)
v_lshlrev_b32 v242, 16, v250
v_and_b32 v248, 0xffff0000, v250
v_mul_f32 v242, v242, v236
v_mul_f32 v248, v248, v236
v_cvt_pk_bf16_f32 v250, v242, v248
v_lshlrev_b32 v242, 16, v251
v_and_b32 v248, 0xffff0000, v251
v_mul_f32 v242, v242, v236
v_mul_f32 v248, v248, v236
v_cvt_pk_bf16_f32 v251, v242, v248
ds_write_b64 v231, v[250:251] offset:8
s_waitcnt lgkmcnt(0)
v_exp_f32 v232, v128
v_exp_f32 v233, v129
v_exp_f32 v234, v130
v_exp_f32 v235, v131
s_nop 1
v_cvt_pk_bf16_f32 v160, v232, v233
v_cvt_pk_bf16_f32 v161, v234, v235
v_max_f32 v204, v132, v133
v_max3_f32 v204, v204, v134, v135
v_mov_b32 v205, v204
s_nop 1
v_permlane32_swap_b32 v204, v205
s_nop 1
v_max_f32 v204, v204, v205
v_mov_b32 v205, v204
s_nop 1
v_permlane16_swap_b32 v204, v205
s_nop 1
v_max_f32 v204, v204, v205
v_add_f32 v204, 40.0, v204
v_ceil_f32 v204, v204
v_max_f32 v204, 0, v204
v_sub_f32 v205, v225, v204
v_cvt_pk_bf16_f32 v205, v205, v205
v_and_b32 v205, 0xffff0000, v205
v_sub_f32 v204, v205, v225
v_mov_b32 v225, v205
v_exp_f32 v237, v204
v_bfi_b32 v35, v206, v205, v35
v_add_f32 v132, v132, v204
v_add_f32 v133, v133, v204
v_add_f32 v134, v134, v204
v_add_f32 v135, v135, v204
v_add_f32 v148, v148, v204
v_add_f32 v149, v149, v204
v_add_f32 v150, v150, v204
v_add_f32 v151, v151, v204
v_lshlrev_b32 v242, 16, v180
v_and_b32 v248, 0xffff0000, v180
v_mul_f32 v242, v242, v237
v_mul_f32 v248, v248, v237
v_cvt_pk_bf16_f32 v180, v242, v248
v_lshlrev_b32 v242, 16, v181
v_and_b32 v248, 0xffff0000, v181
v_mul_f32 v242, v242, v237
v_mul_f32 v248, v248, v237
v_cvt_pk_bf16_f32 v181, v242, v248
v_lshlrev_b32 v242, 16, v182
v_and_b32 v248, 0xffff0000, v182
v_mul_f32 v242, v242, v237
v_mul_f32 v248, v248, v237
v_cvt_pk_bf16_f32 v182, v242, v248
v_lshlrev_b32 v242, 16, v183
v_and_b32 v248, 0xffff0000, v183
v_mul_f32 v242, v242, v237
v_mul_f32 v248, v248, v237
v_cvt_pk_bf16_f32 v183, v242, v248
ds_read_b64 v[250:251], v231 offset:1024
s_waitcnt lgkmcnt(0)
v_lshlrev_b32 v242, 16, v250
v_and_b32 v248, 0xffff0000, v250
v_mul_f32 v242, v242, v237
v_mul_f32 v248, v248, v237
v_cvt_pk_bf16_f32 v250, v242, v248
v_lshlrev_b32 v242, 16, v251
v_and_b32 v248, 0xffff0000, v251
v_mul_f32 v242, v242, v237
v_mul_f32 v248, v248, v237
v_cvt_pk_bf16_f32 v251, v242, v248
ds_write_b64 v231, v[250:251] offset:1024
s_waitcnt lgkmcnt(0)
ds_read_b64 v[250:251], v231 offset:1032
s_waitcnt lgkmcnt(0)
v_lshlrev_b32 v242, 16, v250
v_and_b32 v248, 0xffff0000, v250
v_mul_f32 v242, v242, v237
v_mul_f32 v248, v248, v237
v_cvt_pk_bf16_f32 v250, v242, v248
v_lshlrev_b32 v242, 16, v251
v_and_b32 v248, 0xffff0000, v251
v_mul_f32 v242, v242, v237
v_mul_f32 v248, v248, v237
v_cvt_pk_bf16_f32 v251, v242, v248
ds_write_b64 v231, v[250:251] offset:1032
s_waitcnt lgkmcnt(0)
v_exp_f32 v232, v132
v_exp_f32 v233, v133
v_exp_f32 v234, v134
v_exp_f32 v235, v135
s_nop 1
v_cvt_pk_bf16_f32 v164, v232, v233
v_cvt_pk_bf16_f32 v165, v234, v235
v_max_f32 v204, v136, v137
v_max3_f32 v204, v204, v138, v139
v_mov_b32 v205, v204
s_nop 1
v_permlane32_swap_b32 v204, v205
s_nop 1
v_max_f32 v204, v204, v205
v_mov_b32 v205, v204
s_nop 1
v_permlane16_swap_b32 v204, v205
s_nop 1
v_max_f32 v204, v204, v205
v_add_f32 v204, 40.0, v204
v_ceil_f32 v204, v204
v_max_f32 v204, 0, v204
v_sub_f32 v205, v226, v204
v_cvt_pk_bf16_f32 v205, v205, v205
v_and_b32 v205, 0xffff0000, v205
v_sub_f32 v204, v205, v226
v_mov_b32 v226, v205
v_exp_f32 v238, v204
v_bfi_b32 v67, v206, v205, v67
v_add_f32 v136, v136, v204
v_add_f32 v137, v137, v204
v_add_f32 v138, v138, v204
v_add_f32 v139, v139, v204
v_add_f32 v152, v152, v204
v_add_f32 v153, v153, v204
v_add_f32 v154, v154, v204
v_add_f32 v155, v155, v204
v_lshlrev_b32 v242, 16, v184
v_and_b32 v248, 0xffff0000, v184
v_mul_f32 v242, v242, v238
v_mul_f32 v248, v248, v238
v_cvt_pk_bf16_f32 v184, v242, v248
v_lshlrev_b32 v242, 16, v185
v_and_b32 v248, 0xffff0000, v185
v_mul_f32 v242, v242, v238
v_mul_f32 v248, v248, v238
v_cvt_pk_bf16_f32 v185, v242, v248
v_lshlrev_b32 v242, 16, v186
v_and_b32 v248, 0xffff0000, v186
v_mul_f32 v242, v242, v238
v_mul_f32 v248, v248, v238
v_cvt_pk_bf16_f32 v186, v242, v248
v_lshlrev_b32 v242, 16, v187
v_and_b32 v248, 0xffff0000, v187
v_mul_f32 v242, v242, v238
v_mul_f32 v248, v248, v238
v_cvt_pk_bf16_f32 v187, v242, v248
ds_read_b64 v[250:251], v231 offset:2048
s_waitcnt lgkmcnt(0)
v_lshlrev_b32 v242, 16, v250
v_and_b32 v248, 0xffff0000, v250
v_mul_f32 v242, v242, v238
v_mul_f32 v248, v248, v238
v_cvt_pk_bf16_f32 v250, v242, v248
v_lshlrev_b32 v242, 16, v251
v_and_b32 v248, 0xffff0000, v251
v_mul_f32 v242, v242, v238
v_mul_f32 v248, v248, v238
v_cvt_pk_bf16_f32 v251, v242, v248
ds_write_b64 v231, v[250:251] offset:2048
s_waitcnt lgkmcnt(0)
ds_read_b64 v[250:251], v231 offset:2056
s_waitcnt lgkmcnt(0)
v_lshlrev_b32 v242, 16, v250
v_and_b32 v248, 0xffff0000, v250
v_mul_f32 v242, v242, v238
v_mul_f32 v248, v248, v238
v_cvt_pk_bf16_f32 v250, v242, v248
v_lshlrev_b32 v242, 16, v251
v_and_b32 v248, 0xffff0000, v251
v_mul_f32 v242, v242, v238
v_mul_f32 v248, v248, v238
v_cvt_pk_bf16_f32 v251, v242, v248
ds_write_b64 v231, v[250:251] offset:2056
s_waitcnt lgkmcnt(0)
v_exp_f32 v232, v136
v_exp_f32 v233, v137
v_exp_f32 v234, v138
v_exp_f32 v235, v139
s_nop 1
v_cvt_pk_bf16_f32 v168, v232, v233
v_cvt_pk_bf16_f32 v169, v234, v235
v_max_f32 v204, v140, v141
v_max3_f32 v204, v204, v142, v143
v_mov_b32 v205, v204
s_nop 1
v_permlane32_swap_b32 v204, v205
s_nop 1
v_max_f32 v204, v204, v205
v_mov_b32 v205, v204
s_nop 1
v_permlane16_swap_b32 v204, v205
s_nop 1
v_max_f32 v204, v204, v205
v_add_f32 v204, 40.0, v204
v_ceil_f32 v204, v204
v_max_f32 v204, 0, v204
v_sub_f32 v205, v227, v204
v_cvt_pk_bf16_f32 v205, v205, v205
v_and_b32 v205, 0xffff0000, v205
v_sub_f32 v204, v205, v227
v_mov_b32 v227, v205
v_exp_f32 v239, v204
v_bfi_b32 v99, v206, v205, v99
v_add_f32 v140, v140, v204
v_add_f32 v141, v141, v204
v_add_f32 v142, v142, v204
v_add_f32 v143, v143, v204
v_add_f32 v156, v156, v204
v_add_f32 v157, v157, v204
v_add_f32 v158, v158, v204
v_add_f32 v159, v159, v204
v_lshlrev_b32 v242, 16, v188
v_and_b32 v248, 0xffff0000, v188
v_mul_f32 v242, v242, v239
v_mul_f32 v248, v248, v239
v_cvt_pk_bf16_f32 v188, v242, v248
v_lshlrev_b32 v242, 16, v189
v_and_b32 v248, 0xffff0000, v189
v_mul_f32 v242, v242, v239
v_mul_f32 v248, v248, v239
v_cvt_pk_bf16_f32 v189, v242, v248
v_lshlrev_b32 v242, 16, v190
v_and_b32 v248, 0xffff0000, v190
v_mul_f32 v242, v242, v239
v_mul_f32 v248, v248, v239
v_cvt_pk_bf16_f32 v190, v242, v248
v_lshlrev_b32 v242, 16, v191
v_and_b32 v248, 0xffff0000, v191
v_mul_f32 v242, v242, v239
v_mul_f32 v248, v248, v239
v_cvt_pk_bf16_f32 v191, v242, v248
ds_read_b64 v[250:251], v231 offset:3072
s_waitcnt lgkmcnt(0)
v_lshlrev_b32 v242, 16, v250
v_and_b32 v248, 0xffff0000, v250
v_mul_f32 v242, v242, v239
v_mul_f32 v248, v248, v239
v_cvt_pk_bf16_f32 v250, v242, v248
v_lshlrev_b32 v242, 16, v251
v_and_b32 v248, 0xffff0000, v251
v_mul_f32 v242, v242, v239
v_mul_f32 v248, v248, v239
v_cvt_pk_bf16_f32 v251, v242, v248
ds_write_b64 v231, v[250:251] offset:3072
s_waitcnt lgkmcnt(0)
ds_read_b64 v[250:251], v231 offset:3080
s_waitcnt lgkmcnt(0)
v_lshlrev_b32 v242, 16, v250
v_and_b32 v248, 0xffff0000, v250
v_mul_f32 v242, v242, v239
v_mul_f32 v248, v248, v239
v_cvt_pk_bf16_f32 v250, v242, v248
v_lshlrev_b32 v242, 16, v251
v_and_b32 v248, 0xffff0000, v251
v_mul_f32 v242, v242, v239
v_mul_f32 v248, v248, v239
v_cvt_pk_bf16_f32 v251, v242, v248
ds_write_b64 v231, v[250:251] offset:3080
s_waitcnt lgkmcnt(0)
v_exp_f32 v232, v140
v_exp_f32 v233, v141
v_exp_f32 v234, v142
v_exp_f32 v235, v143
s_nop 1
v_cvt_pk_bf16_f32 v172, v232, v233
v_cvt_pk_bf16_f32 v173, v234, v235
s_branch L2_rare_common
L2_rare_site13:
s_mov_b32 s36, 13
s_branch L2_rare_t0_1
L2_rare_t0_1:
s_nop 15
s_nop 15
s_waitcnt lgkmcnt(0)
v_lshrrev_b32 v206, 8, v243
v_add_u32 v206, 1, v206
v_lshrrev_b32 v206, 2, v206
v_sub_u32 v206, 0, v206
v_and_b32 v206, 0xffff0000, v206
v_max_f32 v204, v144, v145
v_max3_f32 v204, v204, v146, v147
v_mov_b32 v205, v204
s_nop 1
v_permlane32_swap_b32 v204, v205
s_nop 1
v_max_f32 v204, v204, v205
v_mov_b32 v205, v204
s_nop 1
v_permlane16_swap_b32 v204, v205
s_nop 1
v_max_f32 v204, v204, v205
v_add_f32 v204, 40.0, v204
v_ceil_f32 v204, v204
v_max_f32 v204, 0, v204
v_sub_f32 v205, v224, v204
v_cvt_pk_bf16_f32 v205, v205, v205
v_and_b32 v205, 0xffff0000, v205
v_sub_f32 v204, v205, v224
v_mov_b32 v224, v205
v_exp_f32 v236, v204
v_bfi_b32 v3, v206, v205, v3
v_add_f32 v144, v144, v204
v_add_f32 v145, v145, v204
v_add_f32 v146, v146, v204
v_add_f32 v147, v147, v204
v_add_f32 v128, v128, v204
v_add_f32 v129, v129, v204
v_add_f32 v130, v130, v204
v_add_f32 v131, v131, v204
v_lshlrev_b32 v242, 16, v160
v_and_b32 v248, 0xffff0000, v160
v_mul_f32 v242, v242, v236
v_mul_f32 v248, v248, v236
v_cvt_pk_bf16_f32 v160, v242, v248
v_lshlrev_b32 v242, 16, v161
v_and_b32 v248, 0xffff0000, v161
v_mul_f32 v242, v242, v236
v_mul_f32 v248, v248, v236
v_cvt_pk_bf16_f32 v161, v242, v248
ds_read_b64 v[250:251], v231 offset:0
s_waitcnt lgkmcnt(0)
v_lshlrev_b32 v242, 16, v250
v_and_b32 v248, 0xffff0000, v250
v_mul_f32 v242, v242, v236
v_mul_f32 v248, v248, v236
v_cvt_pk_bf16_f32 v250, v242, v248
v_lshlrev_b32 v242, 16, v251
v_and_b32 v248, 0xffff0000, v251
v_mul_f32 v242, v242, v236
v_mul_f32 v248, v248, v236
v_cvt_pk_bf16_f32 v251, v242, v248
ds_write_b64 v231, v[250:251] offset:0
s_waitcnt lgkmcnt(0)
ds_read_b64 v[250:251], v231 offset:8
s_waitcnt lgkmcnt(0)
v_lshlrev_b32 v242, 16, v250
v_and_b32 v248, 0xffff0000, v250
v_mul_f32 v242, v242, v236
v_mul_f32 v248, v248, v236
v_cvt_pk_bf16_f32 v250, v242, v248
v_lshlrev_b32 v242, 16, v251
v_and_b32 v248, 0xffff0000, v251
v_mul_f32 v242, v242, v236
v_mul_f32 v248, v248, v236
v_cvt_pk_bf16_f32 v251, v242, v248
ds_write_b64 v231, v[250:251] offset:8
s_waitcnt lgkmcnt(0)
ds_read_b64 v[250:251], v231 offset:4096
s_waitcnt lgkmcnt(0)
v_lshlrev_b32 v242, 16, v250
v_and_b32 v248, 0xffff0000, v250
v_mul_f32 v242, v242, v236
v_mul_f32 v248, v248, v236
v_cvt_pk_bf16_f32 v250, v242, v248
v_lshlrev_b32 v242, 16, v251
v_and_b32 v248, 0xffff0000, v251
v_mul_f32 v242, v242, v236
v_mul_f32 v248, v248, v236
v_cvt_pk_bf16_f32 v251, v242, v248
ds_write_b64 v231, v[250:251] offset:4096
s_waitcnt lgkmcnt(0)
ds_read_b64 v[250:251], v231 offset:4104
s_waitcnt lgkmcnt(0)
v_lshlrev_b32 v242, 16, v250
v_and_b32 v248, 0xffff0000, v250
v_mul_f32 v242, v242, v236
v_mul_f32 v248, v248, v236
v_cvt_pk_bf16_f32 v250, v242, v248
v_lshlrev_b32 v242, 16, v251
v_and_b32 v248, 0xffff0000, v251
v_mul_f32 v242, v242, v236
v_mul_f32 v248, v248, v236
v_cvt_pk_bf16_f32 v251, v242, v248
ds_write_b64 v231, v[250:251] offset:4104
s_waitcnt lgkmcnt(0)
v_exp_f32 v232, v144
v_exp_f32 v233, v145
v_exp_f32 v234, v146
v_exp_f32 v235, v147
s_nop 1
v_cvt_pk_bf16_f32 v162, v232, v233
v_cvt_pk_bf16_f32 v163, v234, v235
v_max_f32 v204, v148, v149
v_max3_f32 v204, v204, v150, v151
v_mov_b32 v205, v204
s_nop 1
v_permlane32_swap_b32 v204, v205
s_nop 1
v_max_f32 v204, v204, v205
v_mov_b32 v205, v204
s_nop 1
v_permlane16_swap_b32 v204, v205
s_nop 1
v_max_f32 v204, v204, v205
v_add_f32 v204, 40.0, v204
v_ceil_f32 v204, v204
v_max_f32 v204, 0, v204
v_sub_f32 v205, v225, v204
v_cvt_pk_bf16_f32 v205, v205, v205
v_and_b32 v205, 0xffff0000, v205
v_sub_f32 v204, v205, v225
v_mov_b32 v225, v205
v_exp_f32 v237, v204
v_bfi_b32 v35, v206, v205, v35
v_add_f32 v148, v148, v204
v_add_f32 v149, v149, v204
v_add_f32 v150, v150, v204
v_add_f32 v151, v151, v204
v_add_f32 v132, v132, v204
v_add_f32 v133, v133, v204
v_add_f32 v134, v134, v204
v_add_f32 v135, v135, v204
v_lshlrev_b32 v242, 16, v164
v_and_b32 v248, 0xffff0000, v164
v_mul_f32 v242, v242, v237
v_mul_f32 v248, v248, v237
v_cvt_pk_bf16_f32 v164, v242, v248
v_lshlrev_b32 v242, 16, v165
v_and_b32 v248, 0xffff0000, v165
v_mul_f32 v242, v242, v237
v_mul_f32 v248, v248, v237
v_cvt_pk_bf16_f32 v165, v242, v248
ds_read_b64 v[250:251], v231 offset:1024
s_waitcnt lgkmcnt(0)
v_lshlrev_b32 v242, 16, v250
v_and_b32 v248, 0xffff0000, v250
v_mul_f32 v242, v242, v237
v_mul_f32 v248, v248, v237
v_cvt_pk_bf16_f32 v250, v242, v248
v_lshlrev_b32 v242, 16, v251
v_and_b32 v248, 0xffff0000, v251
v_mul_f32 v242, v242, v237
v_mul_f32 v248, v248, v237
v_cvt_pk_bf16_f32 v251, v242, v248
ds_write_b64 v231, v[250:251] offset:1024
s_waitcnt lgkmcnt(0)
ds_read_b64 v[250:251], v231 offset:1032
s_waitcnt lgkmcnt(0)
v_lshlrev_b32 v242, 16, v250
v_and_b32 v248, 0xffff0000, v250
v_mul_f32 v242, v242, v237
v_mul_f32 v248, v248, v237
v_cvt_pk_bf16_f32 v250, v242, v248
v_lshlrev_b32 v242, 16, v251
v_and_b32 v248, 0xffff0000, v251
v_mul_f32 v242, v242, v237
v_mul_f32 v248, v248, v237
v_cvt_pk_bf16_f32 v251, v242, v248
ds_write_b64 v231, v[250:251] offset:1032
s_waitcnt lgkmcnt(0)
ds_read_b64 v[250:251], v231 offset:5120
s_waitcnt lgkmcnt(0)
v_lshlrev_b32 v242, 16, v250
v_and_b32 v248, 0xffff0000, v250
v_mul_f32 v242, v242, v237
v_mul_f32 v248, v248, v237
v_cvt_pk_bf16_f32 v250, v242, v248
v_lshlrev_b32 v242, 16, v251
v_and_b32 v248, 0xffff0000, v251
v_mul_f32 v242, v242, v237
v_mul_f32 v248, v248, v237
v_cvt_pk_bf16_f32 v251, v242, v248
ds_write_b64 v231, v[250:251] offset:5120
s_waitcnt lgkmcnt(0)
ds_read_b64 v[250:251], v231 offset:5128
s_waitcnt lgkmcnt(0)
v_lshlrev_b32 v242, 16, v250
v_and_b32 v248, 0xffff0000, v250
v_mul_f32 v242, v242, v237
v_mul_f32 v248, v248, v237
v_cvt_pk_bf16_f32 v250, v242, v248
v_lshlrev_b32 v242, 16, v251
v_and_b32 v248, 0xffff0000, v251
v_mul_f32 v242, v242, v237
v_mul_f32 v248, v248, v237
v_cvt_pk_bf16_f32 v251, v242, v248
ds_write_b64 v231, v[250:251] offset:5128
s_waitcnt lgkmcnt(0)
v_exp_f32 v232, v148
v_exp_f32 v233, v149
v_exp_f32 v234, v150
v_exp_f32 v235, v151
s_nop 1
v_cvt_pk_bf16_f32 v166, v232, v233
v_cvt_pk_bf16_f32 v167, v234, v235
v_max_f32 v204, v152, v153
v_max3_f32 v204, v204, v154, v155
v_mov_b32 v205, v204
s_nop 1
v_permlane32_swap_b32 v204, v205
s_nop 1
v_max_f32 v204, v204, v205
v_mov_b32 v205, v204
s_nop 1
v_permlane16_swap_b32 v204, v205
s_nop 1
v_max_f32 v204, v204, v205
v_add_f32 v204, 40.0, v204
v_ceil_f32 v204, v204
v_max_f32 v204, 0, v204
v_sub_f32 v205, v226, v204
v_cvt_pk_bf16_f32 v205, v205, v205
v_and_b32 v205, 0xffff0000, v205
v_sub_f32 v204, v205, v226
v_mov_b32 v226, v205
v_exp_f32 v238, v204
v_bfi_b32 v67, v206, v205, v67
v_add_f32 v152, v152, v204
v_add_f32 v153, v153, v204
v_add_f32 v154, v154, v204
v_add_f32 v155, v155, v204
v_add_f32 v136, v136, v204
v_add_f32 v137, v137, v204
v_add_f32 v138, v138, v204
v_add_f32 v139, v139, v204
v_lshlrev_b32 v242, 16, v168
v_and_b32 v248, 0xffff0000, v168
v_mul_f32 v242, v242, v238
v_mul_f32 v248, v248, v238
v_cvt_pk_bf16_f32 v168, v242, v248
v_lshlrev_b32 v242, 16, v169
v_and_b32 v248, 0xffff0000, v169
v_mul_f32 v242, v242, v238
v_mul_f32 v248, v248, v238
v_cvt_pk_bf16_f32 v169, v242, v248
ds_read_b64 v[250:251], v231 offset:2048
s_waitcnt lgkmcnt(0)
v_lshlrev_b32 v242, 16, v250
v_and_b32 v248, 0xffff0000, v250
v_mul_f32 v242, v242, v238
v_mul_f32 v248, v248, v238
v_cvt_pk_bf16_f32 v250, v242, v248
v_lshlrev_b32 v242, 16, v251
v_and_b32 v248, 0xffff0000, v251
v_mul_f32 v242, v242, v238
v_mul_f32 v248, v248, v238
v_cvt_pk_bf16_f32 v251, v242, v248
ds_write_b64 v231, v[250:251] offset:2048
s_waitcnt lgkmcnt(0)
ds_read_b64 v[250:251], v231 offset:2056
s_waitcnt lgkmcnt(0)
v_lshlrev_b32 v242, 16, v250
v_and_b32 v248, 0xffff0000, v250
v_mul_f32 v242, v242, v238
v_mul_f32 v248, v248, v238
v_cvt_pk_bf16_f32 v250, v242, v248
v_lshlrev_b32 v242, 16, v251
v_and_b32 v248, 0xffff0000, v251
v_mul_f32 v242, v242, v238
v_mul_f32 v248, v248, v238
v_cvt_pk_bf16_f32 v251, v242, v248
ds_write_b64 v231, v[250:251] offset:2056
s_waitcnt lgkmcnt(0)
ds_read_b64 v[250:251], v231 offset:6144
s_waitcnt lgkmcnt(0)
v_lshlrev_b32 v242, 16, v250
v_and_b32 v248, 0xffff0000, v250
v_mul_f32 v242, v242, v238
v_mul_f32 v248, v248, v238
v_cvt_pk_bf16_f32 v250, v242, v248
v_lshlrev_b32 v242, 16, v251
v_and_b32 v248, 0xffff0000, v251
v_mul_f32 v242, v242, v238
v_mul_f32 v248, v248, v238
v_cvt_pk_bf16_f32 v251, v242, v248
ds_write_b64 v231, v[250:251] offset:6144
s_waitcnt lgkmcnt(0)
ds_read_b64 v[250:251], v231 offset:6152
s_waitcnt lgkmcnt(0)
v_lshlrev_b32 v242, 16, v250
v_and_b32 v248, 0xffff0000, v250
v_mul_f32 v242, v242, v238
v_mul_f32 v248, v248, v238
v_cvt_pk_bf16_f32 v250, v242, v248
v_lshlrev_b32 v242, 16, v251
v_and_b32 v248, 0xffff0000, v251
v_mul_f32 v242, v242, v238
v_mul_f32 v248, v248, v238
v_cvt_pk_bf16_f32 v251, v242, v248
ds_write_b64 v231, v[250:251] offset:6152
s_waitcnt lgkmcnt(0)
v_exp_f32 v232, v152
v_exp_f32 v233, v153
v_exp_f32 v234, v154
v_exp_f32 v235, v155
s_nop 1
v_cvt_pk_bf16_f32 v170, v232, v233
v_cvt_pk_bf16_f32 v171, v234, v235
v_max_f32 v204, v156, v157
v_max3_f32 v204, v204, v158, v159
v_mov_b32 v205, v204
s_nop 1
v_permlane32_swap_b32 v204, v205
s_nop 1
v_max_f32 v204, v204, v205
v_mov_b32 v205, v204
s_nop 1
v_permlane16_swap_b32 v204, v205
s_nop 1
v_max_f32 v204, v204, v205
v_add_f32 v204, 40.0, v204
v_ceil_f32 v204, v204
v_max_f32 v204, 0, v204
v_sub_f32 v205, v227, v204
v_cvt_pk_bf16_f32 v205, v205, v205
v_and_b32 v205, 0xffff0000, v205
v_sub_f32 v204, v205, v227
v_mov_b32 v227, v205
v_exp_f32 v239, v204
v_bfi_b32 v99, v206, v205, v99
v_add_f32 v156, v156, v204
v_add_f32 v157, v157, v204
v_add_f32 v158, v158, v204
v_add_f32 v159, v159, v204
v_add_f32 v140, v140, v204
v_add_f32 v141, v141, v204
v_add_f32 v142, v142, v204
v_add_f32 v143, v143, v204
v_lshlrev_b32 v242, 16, v172
v_and_b32 v248, 0xffff0000, v172
v_mul_f32 v242, v242, v239
v_mul_f32 v248, v248, v239
v_cvt_pk_bf16_f32 v172, v242, v248
v_lshlrev_b32 v242, 16, v173
v_and_b32 v248, 0xffff0000, v173
v_mul_f32 v242, v242, v239
v_mul_f32 v248, v248, v239
v_cvt_pk_bf16_f32 v173, v242, v248
ds_read_b64 v[250:251], v231 offset:3072
s_waitcnt lgkmcnt(0)
v_lshlrev_b32 v242, 16, v250
v_and_b32 v248, 0xffff0000, v250
v_mul_f32 v242, v242, v239
v_mul_f32 v248, v248, v239
v_cvt_pk_bf16_f32 v250, v242, v248
v_lshlrev_b32 v242, 16, v251
v_and_b32 v248, 0xffff0000, v251
v_mul_f32 v242, v242, v239
v_mul_f32 v248, v248, v239
v_cvt_pk_bf16_f32 v251, v242, v248
ds_write_b64 v231, v[250:251] offset:3072
s_waitcnt lgkmcnt(0)
ds_read_b64 v[250:251], v231 offset:3080
s_waitcnt lgkmcnt(0)
v_lshlrev_b32 v242, 16, v250
v_and_b32 v248, 0xffff0000, v250
v_mul_f32 v242, v242, v239
v_mul_f32 v248, v248, v239
v_cvt_pk_bf16_f32 v250, v242, v248
v_lshlrev_b32 v242, 16, v251
v_and_b32 v248, 0xffff0000, v251
v_mul_f32 v242, v242, v239
v_mul_f32 v248, v248, v239
v_cvt_pk_bf16_f32 v251, v242, v248
ds_write_b64 v231, v[250:251] offset:3080
s_waitcnt lgkmcnt(0)
ds_read_b64 v[250:251], v231 offset:7168
s_waitcnt lgkmcnt(0)
v_lshlrev_b32 v242, 16, v250
v_and_b32 v248, 0xffff0000, v250
v_mul_f32 v242, v242, v239
v_mul_f32 v248, v248, v239
v_cvt_pk_bf16_f32 v250, v242, v248
v_lshlrev_b32 v242, 16, v251
v_and_b32 v248, 0xffff0000, v251
v_mul_f32 v242, v242, v239
v_mul_f32 v248, v248, v239
v_cvt_pk_bf16_f32 v251, v242, v248
ds_write_b64 v231, v[250:251] offset:7168
s_waitcnt lgkmcnt(0)
ds_read_b64 v[250:251], v231 offset:7176
s_waitcnt lgkmcnt(0)
v_lshlrev_b32 v242, 16, v250
v_and_b32 v248, 0xffff0000, v250
v_mul_f32 v242, v242, v239
v_mul_f32 v248, v248, v239
v_cvt_pk_bf16_f32 v250, v242, v248
v_lshlrev_b32 v242, 16, v251
v_and_b32 v248, 0xffff0000, v251
v_mul_f32 v242, v242, v239
v_mul_f32 v248, v248, v239
v_cvt_pk_bf16_f32 v251, v242, v248
ds_write_b64 v231, v[250:251] offset:7176
s_waitcnt lgkmcnt(0)
v_exp_f32 v232, v156
v_exp_f32 v233, v157
v_exp_f32 v234, v158
v_exp_f32 v235, v159
s_nop 1
v_cvt_pk_bf16_f32 v174, v232, v233
v_cvt_pk_bf16_f32 v175, v234, v235
s_branch L2_rare_common
L2_rare_site14:
s_mov_b32 s36, 14
s_branch L2_rare_t0_2
L2_rare_t0_2:
s_nop 15
s_nop 15
s_waitcnt lgkmcnt(0)
v_lshrrev_b32 v206, 8, v243
v_add_u32 v206, 1, v206
v_lshrrev_b32 v206, 2, v206
v_sub_u32 v206, 0, v206
v_and_b32 v206, 0xffff0000, v206
v_max_f32 v204, v128, v129
v_max3_f32 v204, v204, v130, v131
v_mov_b32 v205, v204
s_nop 1
v_permlane32_swap_b32 v204, v205
s_nop 1
v_max_f32 v204, v204, v205
v_mov_b32 v205, v204
s_nop 1
v_permlane16_swap_b32 v204, v205
s_nop 1
v_max_f32 v204, v204, v205
v_add_f32 v204, 40.0, v204
v_ceil_f32 v204, v204
v_max_f32 v204, 0, v204
v_sub_f32 v205, v224, v204
v_cvt_pk_bf16_f32 v205, v205, v205
v_and_b32 v205, 0xffff0000, v205
v_sub_f32 v204, v205, v224
v_mov_b32 v224, v205
v_exp_f32 v236, v204
v_bfi_b32 v3, v206, v205, v3
v_add_f32 v128, v128, v204
v_add_f32 v129, v129, v204
v_add_f32 v130, v130, v204
v_add_f32 v131, v131, v204
v_add_f32 v144, v144, v204
v_add_f32 v145, v145, v204
v_add_f32 v146, v146, v204
v_add_f32 v147, v147, v204
v_lshlrev_b32 v242, 16, v160
v_and_b32 v248, 0xffff0000, v160
v_mul_f32 v242, v242, v236
v_mul_f32 v248, v248, v236
v_cvt_pk_bf16_f32 v160, v242, v248
v_lshlrev_b32 v242, 16, v161
v_and_b32 v248, 0xffff0000, v161
v_mul_f32 v242, v242, v236
v_mul_f32 v248, v248, v236
v_cvt_pk_bf16_f32 v161, v242, v248
v_lshlrev_b32 v242, 16, v162
v_and_b32 v248, 0xffff0000, v162
v_mul_f32 v242, v242, v236
v_mul_f32 v248, v248, v236
v_cvt_pk_bf16_f32 v162, v242, v248
v_lshlrev_b32 v242, 16, v163
v_and_b32 v248, 0xffff0000, v163
v_mul_f32 v242, v242, v236
v_mul_f32 v248, v248, v236
v_cvt_pk_bf16_f32 v163, v242, v248
ds_read_b64 v[250:251], v231 offset:0
s_waitcnt lgkmcnt(0)
v_lshlrev_b32 v242, 16, v250
v_and_b32 v248, 0xffff0000, v250
v_mul_f32 v242, v242, v236
v_mul_f32 v248, v248, v236
v_cvt_pk_bf16_f32 v250, v242, v248
v_lshlrev_b32 v242, 16, v251
v_and_b32 v248, 0xffff0000, v251
v_mul_f32 v242, v242, v236
v_mul_f32 v248, v248, v236
v_cvt_pk_bf16_f32 v251, v242, v248
ds_write_b64 v231, v[250:251] offset:0
s_waitcnt lgkmcnt(0)
ds_read_b64 v[250:251], v231 offset:8
s_waitcnt lgkmcnt(0)
v_lshlrev_b32 v242, 16, v250
v_and_b32 v248, 0xffff0000, v250
v_mul_f32 v242, v242, v236
v_mul_f32 v248, v248, v236
v_cvt_pk_bf16_f32 v250, v242, v248
v_lshlrev_b32 v242, 16, v251
v_and_b32 v248, 0xffff0000, v251
v_mul_f32 v242, v242, v236
v_mul_f32 v248, v248, v236
v_cvt_pk_bf16_f32 v251, v242, v248
ds_write_b64 v231, v[250:251] offset:8
s_waitcnt lgkmcnt(0)
ds_read_b64 v[250:251], v231 offset:4096
s_waitcnt lgkmcnt(0)
v_lshlrev_b32 v242, 16, v250
v_and_b32 v248, 0xffff0000, v250
v_mul_f32 v242, v242, v236
v_mul_f32 v248, v248, v236
v_cvt_pk_bf16_f32 v250, v242, v248
v_lshlrev_b32 v242, 16, v251
v_and_b32 v248, 0xffff0000, v251
v_mul_f32 v242, v242, v236
v_mul_f32 v248, v248, v236
v_cvt_pk_bf16_f32 v251, v242, v248
ds_write_b64 v231, v[250:251] offset:4096
s_waitcnt lgkmcnt(0)
ds_read_b64 v[250:251], v231 offset:4104
s_waitcnt lgkmcnt(0)
v_lshlrev_b32 v242, 16, v250
v_and_b32 v248, 0xffff0000, v250
v_mul_f32 v242, v242, v236
v_mul_f32 v248, v248, v236
v_cvt_pk_bf16_f32 v250, v242, v248
v_lshlrev_b32 v242, 16, v251
v_and_b32 v248, 0xffff0000, v251
v_mul_f32 v242, v242, v236
v_mul_f32 v248, v248, v236
v_cvt_pk_bf16_f32 v251, v242, v248
ds_write_b64 v231, v[250:251] offset:4104
s_waitcnt lgkmcnt(0)
v_exp_f32 v232, v128
v_exp_f32 v233, v129
v_exp_f32 v234, v130
v_exp_f32 v235, v131
s_nop 1
v_cvt_pk_bf16_f32 v176, v232, v233
v_cvt_pk_bf16_f32 v177, v234, v235
v_max_f32 v204, v132, v133
v_max3_f32 v204, v204, v134, v135
v_mov_b32 v205, v204
s_nop 1
v_permlane32_swap_b32 v204, v205
s_nop 1
v_max_f32 v204, v204, v205
v_mov_b32 v205, v204
s_nop 1
v_permlane16_swap_b32 v204, v205
s_nop 1
v_max_f32 v204, v204, v205
v_add_f32 v204, 40.0, v204
v_ceil_f32 v204, v204
v_max_f32 v204, 0, v204
v_sub_f32 v205, v225, v204
v_cvt_pk_bf16_f32 v205, v205, v205
v_and_b32 v205, 0xffff0000, v205
v_sub_f32 v204, v205, v225
v_mov_b32 v225, v205
v_exp_f32 v237, v204
v_bfi_b32 v35, v206, v205, v35
v_add_f32 v132, v132, v204
v_add_f32 v133, v133, v204
v_add_f32 v134, v134, v204
v_add_f32 v135, v135, v204
v_add_f32 v148, v148, v204
v_add_f32 v149, v149, v204
v_add_f32 v150, v150, v204
v_add_f32 v151, v151, v204
v_lshlrev_b32 v242, 16, v164
v_and_b32 v248, 0xffff0000, v164
v_mul_f32 v242, v242, v237
v_mul_f32 v248, v248, v237
v_cvt_pk_bf16_f32 v164, v242, v248
v_lshlrev_b32 v242, 16, v165
v_and_b32 v248, 0xffff0000, v165
v_mul_f32 v242, v242, v237
v_mul_f32 v248, v248, v237
v_cvt_pk_bf16_f32 v165, v242, v248
v_lshlrev_b32 v242, 16, v166
v_and_b32 v248, 0xffff0000, v166
v_mul_f32 v242, v242, v237
v_mul_f32 v248, v248, v237
v_cvt_pk_bf16_f32 v166, v242, v248
v_lshlrev_b32 v242, 16, v167
v_and_b32 v248, 0xffff0000, v167
v_mul_f32 v242, v242, v237
v_mul_f32 v248, v248, v237
v_cvt_pk_bf16_f32 v167, v242, v248
ds_read_b64 v[250:251], v231 offset:1024
s_waitcnt lgkmcnt(0)
v_lshlrev_b32 v242, 16, v250
v_and_b32 v248, 0xffff0000, v250
v_mul_f32 v242, v242, v237
v_mul_f32 v248, v248, v237
v_cvt_pk_bf16_f32 v250, v242, v248
v_lshlrev_b32 v242, 16, v251
v_and_b32 v248, 0xffff0000, v251
v_mul_f32 v242, v242, v237
v_mul_f32 v248, v248, v237
v_cvt_pk_bf16_f32 v251, v242, v248
ds_write_b64 v231, v[250:251] offset:1024
s_waitcnt lgkmcnt(0)
ds_read_b64 v[250:251], v231 offset:1032
s_waitcnt lgkmcnt(0)
v_lshlrev_b32 v242, 16, v250
v_and_b32 v248, 0xffff0000, v250
v_mul_f32 v242, v242, v237
v_mul_f32 v248, v248, v237
v_cvt_pk_bf16_f32 v250, v242, v248
v_lshlrev_b32 v242, 16, v251
v_and_b32 v248, 0xffff0000, v251
v_mul_f32 v242, v242, v237
v_mul_f32 v248, v248, v237
v_cvt_pk_bf16_f32 v251, v242, v248
ds_write_b64 v231, v[250:251] offset:1032
s_waitcnt lgkmcnt(0)
ds_read_b64 v[250:251], v231 offset:5120
s_waitcnt lgkmcnt(0)
v_lshlrev_b32 v242, 16, v250
v_and_b32 v248, 0xffff0000, v250
v_mul_f32 v242, v242, v237
v_mul_f32 v248, v248, v237
v_cvt_pk_bf16_f32 v250, v242, v248
v_lshlrev_b32 v242, 16, v251
v_and_b32 v248, 0xffff0000, v251
v_mul_f32 v242, v242, v237
v_mul_f32 v248, v248, v237
v_cvt_pk_bf16_f32 v251, v242, v248
ds_write_b64 v231, v[250:251] offset:5120
s_waitcnt lgkmcnt(0)
ds_read_b64 v[250:251], v231 offset:5128
s_waitcnt lgkmcnt(0)
v_lshlrev_b32 v242, 16, v250
v_and_b32 v248, 0xffff0000, v250
v_mul_f32 v242, v242, v237
v_mul_f32 v248, v248, v237
v_cvt_pk_bf16_f32 v250, v242, v248
v_lshlrev_b32 v242, 16, v251
v_and_b32 v248, 0xffff0000, v251
v_mul_f32 v242, v242, v237
v_mul_f32 v248, v248, v237
v_cvt_pk_bf16_f32 v251, v242, v248
ds_write_b64 v231, v[250:251] offset:5128
s_waitcnt lgkmcnt(0)
v_exp_f32 v232, v132
v_exp_f32 v233, v133
v_exp_f32 v234, v134
v_exp_f32 v235, v135
s_nop 1
v_cvt_pk_bf16_f32 v180, v232, v233
v_cvt_pk_bf16_f32 v181, v234, v235
v_max_f32 v204, v136, v137
v_max3_f32 v204, v204, v138, v139
v_mov_b32 v205, v204
s_nop 1
v_permlane32_swap_b32 v204, v205
s_nop 1
v_max_f32 v204, v204, v205
v_mov_b32 v205, v204
s_nop 1
v_permlane16_swap_b32 v204, v205
s_nop 1
v_max_f32 v204, v204, v205
v_add_f32 v204, 40.0, v204
v_ceil_f32 v204, v204
v_max_f32 v204, 0, v204
v_sub_f32 v205, v226, v204
v_cvt_pk_bf16_f32 v205, v205, v205
v_and_b32 v205, 0xffff0000, v205
v_sub_f32 v204, v205, v226
v_mov_b32 v226, v205
v_exp_f32 v238, v204
v_bfi_b32 v67, v206, v205, v67
v_add_f32 v136, v136, v204
v_add_f32 v137, v137, v204
v_add_f32 v138, v138, v204
v_add_f32 v139, v139, v204
v_add_f32 v152, v152, v204
v_add_f32 v153, v153, v204
v_add_f32 v154, v154, v204
v_add_f32 v155, v155, v204
v_lshlrev_b32 v242, 16, v168
v_and_b32 v248, 0xffff0000, v168
v_mul_f32 v242, v242, v238
v_mul_f32 v248, v248, v238
v_cvt_pk_bf16_f32 v168, v242, v248
v_lshlrev_b32 v242, 16, v169
v_and_b32 v248, 0xffff0000, v169
v_mul_f32 v242, v242, v238
v_mul_f32 v248, v248, v238
v_cvt_pk_bf16_f32 v169, v242, v248
v_lshlrev_b32 v242, 16, v170
v_and_b32 v248, 0xffff0000, v170
v_mul_f32 v242, v242, v238
v_mul_f32 v248, v248, v238
v_cvt_pk_bf16_f32 v170, v242, v248
v_lshlrev_b32 v242, 16, v171
v_and_b32 v248, 0xffff0000, v171
v_mul_f32 v242, v242, v238
v_mul_f32 v248, v248, v238
v_cvt_pk_bf16_f32 v171, v242, v248
ds_read_b64 v[250:251], v231 offset:2048
s_waitcnt lgkmcnt(0)
v_lshlrev_b32 v242, 16, v250
v_and_b32 v248, 0xffff0000, v250
v_mul_f32 v242, v242, v238
v_mul_f32 v248, v248, v238
v_cvt_pk_bf16_f32 v250, v242, v248
v_lshlrev_b32 v242, 16, v251
v_and_b32 v248, 0xffff0000, v251
v_mul_f32 v242, v242, v238
v_mul_f32 v248, v248, v238
v_cvt_pk_bf16_f32 v251, v242, v248
ds_write_b64 v231, v[250:251] offset:2048
s_waitcnt lgkmcnt(0)
ds_read_b64 v[250:251], v231 offset:2056
s_waitcnt lgkmcnt(0)
v_lshlrev_b32 v242, 16, v250
v_and_b32 v248, 0xffff0000, v250
v_mul_f32 v242, v242, v238
v_mul_f32 v248, v248, v238
v_cvt_pk_bf16_f32 v250, v242, v248
v_lshlrev_b32 v242, 16, v251
v_and_b32 v248, 0xffff0000, v251
v_mul_f32 v242, v242, v238
v_mul_f32 v248, v248, v238
v_cvt_pk_bf16_f32 v251, v242, v248
ds_write_b64 v231, v[250:251] offset:2056
s_waitcnt lgkmcnt(0)
ds_read_b64 v[250:251], v231 offset:6144
s_waitcnt lgkmcnt(0)
v_lshlrev_b32 v242, 16, v250
v_and_b32 v248, 0xffff0000, v250
v_mul_f32 v242, v242, v238
v_mul_f32 v248, v248, v238
v_cvt_pk_bf16_f32 v250, v242, v248
v_lshlrev_b32 v242, 16, v251
v_and_b32 v248, 0xffff0000, v251
v_mul_f32 v242, v242, v238
v_mul_f32 v248, v248, v238
v_cvt_pk_bf16_f32 v251, v242, v248
ds_write_b64 v231, v[250:251] offset:6144
s_waitcnt lgkmcnt(0)
ds_read_b64 v[250:251], v231 offset:6152
s_waitcnt lgkmcnt(0)
v_lshlrev_b32 v242, 16, v250
v_and_b32 v248, 0xffff0000, v250
v_mul_f32 v242, v242, v238
v_mul_f32 v248, v248, v238
v_cvt_pk_bf16_f32 v250, v242, v248
v_lshlrev_b32 v242, 16, v251
v_and_b32 v248, 0xffff0000, v251
v_mul_f32 v242, v242, v238
v_mul_f32 v248, v248, v238
v_cvt_pk_bf16_f32 v251, v242, v248
ds_write_b64 v231, v[250:251] offset:6152
s_waitcnt lgkmcnt(0)
v_exp_f32 v232, v136
v_exp_f32 v233, v137
v_exp_f32 v234, v138
v_exp_f32 v235, v139
s_nop 1
v_cvt_pk_bf16_f32 v184, v232, v233
v_cvt_pk_bf16_f32 v185, v234, v235
v_max_f32 v204, v140, v141
v_max3_f32 v204, v204, v142, v143
v_mov_b32 v205, v204
s_nop 1
v_permlane32_swap_b32 v204, v205
s_nop 1
v_max_f32 v204, v204, v205
v_mov_b32 v205, v204
s_nop 1
v_permlane16_swap_b32 v204, v205
s_nop 1
v_max_f32 v204, v204, v205
v_add_f32 v204, 40.0, v204
v_ceil_f32 v204, v204
v_max_f32 v204, 0, v204
v_sub_f32 v205, v227, v204
v_cvt_pk_bf16_f32 v205, v205, v205
v_and_b32 v205, 0xffff0000, v205
v_sub_f32 v204, v205, v227
v_mov_b32 v227, v205
v_exp_f32 v239, v204
v_bfi_b32 v99, v206, v205, v99
v_add_f32 v140, v140, v204
v_add_f32 v141, v141, v204
v_add_f32 v142, v142, v204
v_add_f32 v143, v143, v204
v_add_f32 v156, v156, v204
v_add_f32 v157, v157, v204
v_add_f32 v158, v158, v204
v_add_f32 v159, v159, v204
v_lshlrev_b32 v242, 16, v172
v_and_b32 v248, 0xffff0000, v172
v_mul_f32 v242, v242, v239
v_mul_f32 v248, v248, v239
v_cvt_pk_bf16_f32 v172, v242, v248
v_lshlrev_b32 v242, 16, v173
v_and_b32 v248, 0xffff0000, v173
v_mul_f32 v242, v242, v239
v_mul_f32 v248, v248, v239
v_cvt_pk_bf16_f32 v173, v242, v248
v_lshlrev_b32 v242, 16, v174
v_and_b32 v248, 0xffff0000, v174
v_mul_f32 v242, v242, v239
v_mul_f32 v248, v248, v239
v_cvt_pk_bf16_f32 v174, v242, v248
v_lshlrev_b32 v242, 16, v175
v_and_b32 v248, 0xffff0000, v175
v_mul_f32 v242, v242, v239
v_mul_f32 v248, v248, v239
v_cvt_pk_bf16_f32 v175, v242, v248
ds_read_b64 v[250:251], v231 offset:3072
s_waitcnt lgkmcnt(0)
v_lshlrev_b32 v242, 16, v250
v_and_b32 v248, 0xffff0000, v250
v_mul_f32 v242, v242, v239
v_mul_f32 v248, v248, v239
v_cvt_pk_bf16_f32 v250, v242, v248
v_lshlrev_b32 v242, 16, v251
v_and_b32 v248, 0xffff0000, v251
v_mul_f32 v242, v242, v239
v_mul_f32 v248, v248, v239
v_cvt_pk_bf16_f32 v251, v242, v248
ds_write_b64 v231, v[250:251] offset:3072
s_waitcnt lgkmcnt(0)
ds_read_b64 v[250:251], v231 offset:3080
s_waitcnt lgkmcnt(0)
v_lshlrev_b32 v242, 16, v250
v_and_b32 v248, 0xffff0000, v250
v_mul_f32 v242, v242, v239
v_mul_f32 v248, v248, v239
v_cvt_pk_bf16_f32 v250, v242, v248
v_lshlrev_b32 v242, 16, v251
v_and_b32 v248, 0xffff0000, v251
v_mul_f32 v242, v242, v239
v_mul_f32 v248, v248, v239
v_cvt_pk_bf16_f32 v251, v242, v248
ds_write_b64 v231, v[250:251] offset:3080
s_waitcnt lgkmcnt(0)
ds_read_b64 v[250:251], v231 offset:7168
s_waitcnt lgkmcnt(0)
v_lshlrev_b32 v242, 16, v250
v_and_b32 v248, 0xffff0000, v250
v_mul_f32 v242, v242, v239
v_mul_f32 v248, v248, v239
v_cvt_pk_bf16_f32 v250, v242, v248
v_lshlrev_b32 v242, 16, v251
v_and_b32 v248, 0xffff0000, v251
v_mul_f32 v242, v242, v239
v_mul_f32 v248, v248, v239
v_cvt_pk_bf16_f32 v251, v242, v248
ds_write_b64 v231, v[250:251] offset:7168
s_waitcnt lgkmcnt(0)
ds_read_b64 v[250:251], v231 offset:7176
s_waitcnt lgkmcnt(0)
v_lshlrev_b32 v242, 16, v250
v_and_b32 v248, 0xffff0000, v250
v_mul_f32 v242, v242, v239
v_mul_f32 v248, v248, v239
v_cvt_pk_bf16_f32 v250, v242, v248
v_lshlrev_b32 v242, 16, v251
v_and_b32 v248, 0xffff0000, v251
v_mul_f32 v242, v242, v239
v_mul_f32 v248, v248, v239
v_cvt_pk_bf16_f32 v251, v242, v248
ds_write_b64 v231, v[250:251] offset:7176
s_waitcnt lgkmcnt(0)
v_exp_f32 v232, v140
v_exp_f32 v233, v141
v_exp_f32 v234, v142
v_exp_f32 v235, v143
s_nop 1
v_cvt_pk_bf16_f32 v188, v232, v233
v_cvt_pk_bf16_f32 v189, v234, v235
s_branch L2_rare_common
L2_rare_site15:
s_mov_b32 s36, 15
s_branch L2_rare_t0_3
L2_rare_t0_3:
s_nop 15
s_nop 15
s_waitcnt lgkmcnt(0)
v_lshrrev_b32 v206, 8, v243
v_add_u32 v206, 1, v206
v_lshrrev_b32 v206, 2, v206
v_sub_u32 v206, 0, v206
v_and_b32 v206, 0xffff0000, v206
v_max_f32 v204, v144, v145
v_max3_f32 v204, v204, v146, v147
v_mov_b32 v205, v204
s_nop 1
v_permlane32_swap_b32 v204, v205
s_nop 1
v_max_f32 v204, v204, v205
v_mov_b32 v205, v204
s_nop 1
v_permlane16_swap_b32 v204, v205
s_nop 1
v_max_f32 v204, v204, v205
v_add_f32 v204, 40.0, v204
v_ceil_f32 v204, v204
v_max_f32 v204, 0, v204
v_sub_f32 v205, v224, v204
v_cvt_pk_bf16_f32 v205, v205, v205
v_and_b32 v205, 0xffff0000, v205
v_sub_f32 v204, v205, v224
v_mov_b32 v224, v205
v_exp_f32 v236, v204
v_bfi_b32 v3, v206, v205, v3
v_add_f32 v144, v144, v204
v_add_f32 v145, v145, v204
v_add_f32 v146, v146, v204
v_add_f32 v147, v147, v204
v_add_f32 v128, v128, v204
v_add_f32 v129, v129, v204
v_add_f32 v130, v130, v204
v_add_f32 v131, v131, v204
v_lshlrev_b32 v242, 16, v160
v_and_b32 v248, 0xffff0000, v160
v_mul_f32 v242, v242, v236
v_mul_f32 v248, v248, v236
v_cvt_pk_bf16_f32 v160, v242, v248
v_lshlrev_b32 v242, 16, v161
v_and_b32 v248, 0xffff0000, v161
v_mul_f32 v242, v242, v236
v_mul_f32 v248, v248, v236
v_cvt_pk_bf16_f32 v161, v242, v248
v_lshlrev_b32 v242, 16, v162
v_and_b32 v248, 0xffff0000, v162
v_mul_f32 v242, v242, v236
v_mul_f32 v248, v248, v236
v_cvt_pk_bf16_f32 v162, v242, v248
v_lshlrev_b32 v242, 16, v163
v_and_b32 v248, 0xffff0000, v163
v_mul_f32 v242, v242, v236
v_mul_f32 v248, v248, v236
v_cvt_pk_bf16_f32 v163, v242, v248
v_lshlrev_b32 v242, 16, v176
v_and_b32 v248, 0xffff0000, v176
v_mul_f32 v242, v242, v236
v_mul_f32 v248, v248, v236
v_cvt_pk_bf16_f32 v176, v242, v248
v_lshlrev_b32 v242, 16, v177
v_and_b32 v248, 0xffff0000, v177
v_mul_f32 v242, v242, v236
v_mul_f32 v248, v248, v236
v_cvt_pk_bf16_f32 v177, v242, v248
ds_read_b64 v[250:251], v231 offset:0
s_waitcnt lgkmcnt(0)
v_lshlrev_b32 v242, 16, v250
v_and_b32 v248, 0xffff0000, v250
v_mul_f32 v242, v242, v236
v_mul_f32 v248, v248, v236
v_cvt_pk_bf16_f32 v250, v242, v248
v_lshlrev_b32 v242, 16, v251
v_and_b32 v248, 0xffff0000, v251
v_mul_f32 v242, v242, v236
v_mul_f32 v248, v248, v236
v_cvt_pk_bf16_f32 v251, v242, v248
ds_write_b64 v231, v[250:251] offset:0
s_waitcnt lgkmcnt(0)
ds_read_b64 v[250:251], v231 offset:8
s_waitcnt lgkmcnt(0)
v_lshlrev_b32 v242, 16, v250
v_and_b32 v248, 0xffff0000, v250
v_mul_f32 v242, v242, v236
v_mul_f32 v248, v248, v236
v_cvt_pk_bf16_f32 v250, v242, v248
v_lshlrev_b32 v242, 16, v251
v_and_b32 v248, 0xffff0000, v251
v_mul_f32 v242, v242, v236
v_mul_f32 v248, v248, v236
v_cvt_pk_bf16_f32 v251, v242, v248
ds_write_b64 v231, v[250:251] offset:8
s_waitcnt lgkmcnt(0)
ds_read_b64 v[250:251], v231 offset:4096
s_waitcnt lgkmcnt(0)
v_lshlrev_b32 v242, 16, v250
v_and_b32 v248, 0xffff0000, v250
v_mul_f32 v242, v242, v236
v_mul_f32 v248, v248, v236
v_cvt_pk_bf16_f32 v250, v242, v248
v_lshlrev_b32 v242, 16, v251
v_and_b32 v248, 0xffff0000, v251
v_mul_f32 v242, v242, v236
v_mul_f32 v248, v248, v236
v_cvt_pk_bf16_f32 v251, v242, v248
ds_write_b64 v231, v[250:251] offset:4096
s_waitcnt lgkmcnt(0)
ds_read_b64 v[250:251], v231 offset:4104
s_waitcnt lgkmcnt(0)
v_lshlrev_b32 v242, 16, v250
v_and_b32 v248, 0xffff0000, v250
v_mul_f32 v242, v242, v236
v_mul_f32 v248, v248, v236
v_cvt_pk_bf16_f32 v250, v242, v248
v_lshlrev_b32 v242, 16, v251
v_and_b32 v248, 0xffff0000, v251
v_mul_f32 v242, v242, v236
v_mul_f32 v248, v248, v236
v_cvt_pk_bf16_f32 v251, v242, v248
ds_write_b64 v231, v[250:251] offset:4104
s_waitcnt lgkmcnt(0)
v_exp_f32 v232, v144
v_exp_f32 v233, v145
v_exp_f32 v234, v146
v_exp_f32 v235, v147
s_nop 1
v_cvt_pk_bf16_f32 v178, v232, v233
v_cvt_pk_bf16_f32 v179, v234, v235
v_max_f32 v204, v148, v149
v_max3_f32 v204, v204, v150, v151
v_mov_b32 v205, v204
s_nop 1
v_permlane32_swap_b32 v204, v205
s_nop 1
v_max_f32 v204, v204, v205
v_mov_b32 v205, v204
s_nop 1
v_permlane16_swap_b32 v204, v205
s_nop 1
v_max_f32 v204, v204, v205
v_add_f32 v204, 40.0, v204
v_ceil_f32 v204, v204
v_max_f32 v204, 0, v204
v_sub_f32 v205, v225, v204
v_cvt_pk_bf16_f32 v205, v205, v205
v_and_b32 v205, 0xffff0000, v205
v_sub_f32 v204, v205, v225
v_mov_b32 v225, v205
v_exp_f32 v237, v204
v_bfi_b32 v35, v206, v205, v35
v_add_f32 v148, v148, v204
v_add_f32 v149, v149, v204
v_add_f32 v150, v150, v204
v_add_f32 v151, v151, v204
v_add_f32 v132, v132, v204
v_add_f32 v133, v133, v204
v_add_f32 v134, v134, v204
v_add_f32 v135, v135, v204
v_lshlrev_b32 v242, 16, v164
v_and_b32 v248, 0xffff0000, v164
v_mul_f32 v242, v242, v237
v_mul_f32 v248, v248, v237
v_cvt_pk_bf16_f32 v164, v242, v248
v_lshlrev_b32 v242, 16, v165
v_and_b32 v248, 0xffff0000, v165
v_mul_f32 v242, v242, v237
v_mul_f32 v248, v248, v237
v_cvt_pk_bf16_f32 v165, v242, v248
v_lshlrev_b32 v242, 16, v166
v_and_b32 v248, 0xffff0000, v166
v_mul_f32 v242, v242, v237
v_mul_f32 v248, v248, v237
v_cvt_pk_bf16_f32 v166, v242, v248
v_lshlrev_b32 v242, 16, v167
v_and_b32 v248, 0xffff0000, v167
v_mul_f32 v242, v242, v237
v_mul_f32 v248, v248, v237
v_cvt_pk_bf16_f32 v167, v242, v248
v_lshlrev_b32 v242, 16, v180
v_and_b32 v248, 0xffff0000, v180
v_mul_f32 v242, v242, v237
v_mul_f32 v248, v248, v237
v_cvt_pk_bf16_f32 v180, v242, v248
v_lshlrev_b32 v242, 16, v181
v_and_b32 v248, 0xffff0000, v181
v_mul_f32 v242, v242, v237
v_mul_f32 v248, v248, v237
v_cvt_pk_bf16_f32 v181, v242, v248
ds_read_b64 v[250:251], v231 offset:1024
s_waitcnt lgkmcnt(0)
v_lshlrev_b32 v242, 16, v250
v_and_b32 v248, 0xffff0000, v250
v_mul_f32 v242, v242, v237
v_mul_f32 v248, v248, v237
v_cvt_pk_bf16_f32 v250, v242, v248
v_lshlrev_b32 v242, 16, v251
v_and_b32 v248, 0xffff0000, v251
v_mul_f32 v242, v242, v237
v_mul_f32 v248, v248, v237
v_cvt_pk_bf16_f32 v251, v242, v248
ds_write_b64 v231, v[250:251] offset:1024
s_waitcnt lgkmcnt(0)
ds_read_b64 v[250:251], v231 offset:1032
s_waitcnt lgkmcnt(0)
v_lshlrev_b32 v242, 16, v250
v_and_b32 v248, 0xffff0000, v250
v_mul_f32 v242, v242, v237
v_mul_f32 v248, v248, v237
v_cvt_pk_bf16_f32 v250, v242, v248
v_lshlrev_b32 v242, 16, v251
v_and_b32 v248, 0xffff0000, v251
v_mul_f32 v242, v242, v237
v_mul_f32 v248, v248, v237
v_cvt_pk_bf16_f32 v251, v242, v248
ds_write_b64 v231, v[250:251] offset:1032
s_waitcnt lgkmcnt(0)
ds_read_b64 v[250:251], v231 offset:5120
s_waitcnt lgkmcnt(0)
v_lshlrev_b32 v242, 16, v250
v_and_b32 v248, 0xffff0000, v250
v_mul_f32 v242, v242, v237
v_mul_f32 v248, v248, v237
v_cvt_pk_bf16_f32 v250, v242, v248
v_lshlrev_b32 v242, 16, v251
v_and_b32 v248, 0xffff0000, v251
v_mul_f32 v242, v242, v237
v_mul_f32 v248, v248, v237
v_cvt_pk_bf16_f32 v251, v242, v248
ds_write_b64 v231, v[250:251] offset:5120
s_waitcnt lgkmcnt(0)
ds_read_b64 v[250:251], v231 offset:5128
s_waitcnt lgkmcnt(0)
v_lshlrev_b32 v242, 16, v250
v_and_b32 v248, 0xffff0000, v250
v_mul_f32 v242, v242, v237
v_mul_f32 v248, v248, v237
v_cvt_pk_bf16_f32 v250, v242, v248
v_lshlrev_b32 v242, 16, v251
v_and_b32 v248, 0xffff0000, v251
v_mul_f32 v242, v242, v237
v_mul_f32 v248, v248, v237
v_cvt_pk_bf16_f32 v251, v242, v248
ds_write_b64 v231, v[250:251] offset:5128
s_waitcnt lgkmcnt(0)
v_exp_f32 v232, v148
v_exp_f32 v233, v149
v_exp_f32 v234, v150
v_exp_f32 v235, v151
s_nop 1
v_cvt_pk_bf16_f32 v182, v232, v233
v_cvt_pk_bf16_f32 v183, v234, v235
v_max_f32 v204, v152, v153
v_max3_f32 v204, v204, v154, v155
v_mov_b32 v205, v204
s_nop 1
v_permlane32_swap_b32 v204, v205
s_nop 1
v_max_f32 v204, v204, v205
v_mov_b32 v205, v204
s_nop 1
v_permlane16_swap_b32 v204, v205
s_nop 1
v_max_f32 v204, v204, v205
v_add_f32 v204, 40.0, v204
v_ceil_f32 v204, v204
v_max_f32 v204, 0, v204
v_sub_f32 v205, v226, v204
v_cvt_pk_bf16_f32 v205, v205, v205
v_and_b32 v205, 0xffff0000, v205
v_sub_f32 v204, v205, v226
v_mov_b32 v226, v205
v_exp_f32 v238, v204
v_bfi_b32 v67, v206, v205, v67
v_add_f32 v152, v152, v204
v_add_f32 v153, v153, v204
v_add_f32 v154, v154, v204
v_add_f32 v155, v155, v204
v_add_f32 v136, v136, v204
v_add_f32 v137, v137, v204
v_add_f32 v138, v138, v204
v_add_f32 v139, v139, v204
v_lshlrev_b32 v242, 16, v168
v_and_b32 v248, 0xffff0000, v168
v_mul_f32 v242, v242, v238
v_mul_f32 v248, v248, v238
v_cvt_pk_bf16_f32 v168, v242, v248
v_lshlrev_b32 v242, 16, v169
v_and_b32 v248, 0xffff0000, v169
v_mul_f32 v242, v242, v238
v_mul_f32 v248, v248, v238
v_cvt_pk_bf16_f32 v169, v242, v248
v_lshlrev_b32 v242, 16, v170
v_and_b32 v248, 0xffff0000, v170
v_mul_f32 v242, v242, v238
v_mul_f32 v248, v248, v238
v_cvt_pk_bf16_f32 v170, v242, v248
v_lshlrev_b32 v242, 16, v171
v_and_b32 v248, 0xffff0000, v171
v_mul_f32 v242, v242, v238
v_mul_f32 v248, v248, v238
v_cvt_pk_bf16_f32 v171, v242, v248
v_lshlrev_b32 v242, 16, v184
v_and_b32 v248, 0xffff0000, v184
v_mul_f32 v242, v242, v238
v_mul_f32 v248, v248, v238
v_cvt_pk_bf16_f32 v184, v242, v248
v_lshlrev_b32 v242, 16, v185
v_and_b32 v248, 0xffff0000, v185
v_mul_f32 v242, v242, v238
v_mul_f32 v248, v248, v238
v_cvt_pk_bf16_f32 v185, v242, v248
ds_read_b64 v[250:251], v231 offset:2048
s_waitcnt lgkmcnt(0)
v_lshlrev_b32 v242, 16, v250
v_and_b32 v248, 0xffff0000, v250
v_mul_f32 v242, v242, v238
v_mul_f32 v248, v248, v238
v_cvt_pk_bf16_f32 v250, v242, v248
v_lshlrev_b32 v242, 16, v251
v_and_b32 v248, 0xffff0000, v251
v_mul_f32 v242, v242, v238
v_mul_f32 v248, v248, v238
v_cvt_pk_bf16_f32 v251, v242, v248
ds_write_b64 v231, v[250:251] offset:2048
s_waitcnt lgkmcnt(0)
ds_read_b64 v[250:251], v231 offset:2056
s_waitcnt lgkmcnt(0)
v_lshlrev_b32 v242, 16, v250
v_and_b32 v248, 0xffff0000, v250
v_mul_f32 v242, v242, v238
v_mul_f32 v248, v248, v238
v_cvt_pk_bf16_f32 v250, v242, v248
v_lshlrev_b32 v242, 16, v251
v_and_b32 v248, 0xffff0000, v251
v_mul_f32 v242, v242, v238
v_mul_f32 v248, v248, v238
v_cvt_pk_bf16_f32 v251, v242, v248
ds_write_b64 v231, v[250:251] offset:2056
s_waitcnt lgkmcnt(0)
ds_read_b64 v[250:251], v231 offset:6144
s_waitcnt lgkmcnt(0)
v_lshlrev_b32 v242, 16, v250
v_and_b32 v248, 0xffff0000, v250
v_mul_f32 v242, v242, v238
v_mul_f32 v248, v248, v238
v_cvt_pk_bf16_f32 v250, v242, v248
v_lshlrev_b32 v242, 16, v251
v_and_b32 v248, 0xffff0000, v251
v_mul_f32 v242, v242, v238
v_mul_f32 v248, v248, v238
v_cvt_pk_bf16_f32 v251, v242, v248
ds_write_b64 v231, v[250:251] offset:6144
s_waitcnt lgkmcnt(0)
ds_read_b64 v[250:251], v231 offset:6152
s_waitcnt lgkmcnt(0)
v_lshlrev_b32 v242, 16, v250
v_and_b32 v248, 0xffff0000, v250
v_mul_f32 v242, v242, v238
v_mul_f32 v248, v248, v238
v_cvt_pk_bf16_f32 v250, v242, v248
v_lshlrev_b32 v242, 16, v251
v_and_b32 v248, 0xffff0000, v251
v_mul_f32 v242, v242, v238
v_mul_f32 v248, v248, v238
v_cvt_pk_bf16_f32 v251, v242, v248
ds_write_b64 v231, v[250:251] offset:6152
s_waitcnt lgkmcnt(0)
v_exp_f32 v232, v152
v_exp_f32 v233, v153
v_exp_f32 v234, v154
v_exp_f32 v235, v155
s_nop 1
v_cvt_pk_bf16_f32 v186, v232, v233
v_cvt_pk_bf16_f32 v187, v234, v235
v_max_f32 v204, v156, v157
v_max3_f32 v204, v204, v158, v159
v_mov_b32 v205, v204
s_nop 1
v_permlane32_swap_b32 v204, v205
s_nop 1
v_max_f32 v204, v204, v205
v_mov_b32 v205, v204
s_nop 1
v_permlane16_swap_b32 v204, v205
s_nop 1
v_max_f32 v204, v204, v205
v_add_f32 v204, 40.0, v204
v_ceil_f32 v204, v204
v_max_f32 v204, 0, v204
v_sub_f32 v205, v227, v204
v_cvt_pk_bf16_f32 v205, v205, v205
v_and_b32 v205, 0xffff0000, v205
v_sub_f32 v204, v205, v227
v_mov_b32 v227, v205
v_exp_f32 v239, v204
v_bfi_b32 v99, v206, v205, v99
v_add_f32 v156, v156, v204
v_add_f32 v157, v157, v204
v_add_f32 v158, v158, v204
v_add_f32 v159, v159, v204
v_add_f32 v140, v140, v204
v_add_f32 v141, v141, v204
v_add_f32 v142, v142, v204
v_add_f32 v143, v143, v204
v_lshlrev_b32 v242, 16, v172
v_and_b32 v248, 0xffff0000, v172
v_mul_f32 v242, v242, v239
v_mul_f32 v248, v248, v239
v_cvt_pk_bf16_f32 v172, v242, v248
v_lshlrev_b32 v242, 16, v173
v_and_b32 v248, 0xffff0000, v173
v_mul_f32 v242, v242, v239
v_mul_f32 v248, v248, v239
v_cvt_pk_bf16_f32 v173, v242, v248
v_lshlrev_b32 v242, 16, v174
v_and_b32 v248, 0xffff0000, v174
v_mul_f32 v242, v242, v239
v_mul_f32 v248, v248, v239
v_cvt_pk_bf16_f32 v174, v242, v248
v_lshlrev_b32 v242, 16, v175
v_and_b32 v248, 0xffff0000, v175
v_mul_f32 v242, v242, v239
v_mul_f32 v248, v248, v239
v_cvt_pk_bf16_f32 v175, v242, v248
v_lshlrev_b32 v242, 16, v188
v_and_b32 v248, 0xffff0000, v188
v_mul_f32 v242, v242, v239
v_mul_f32 v248, v248, v239
v_cvt_pk_bf16_f32 v188, v242, v248
v_lshlrev_b32 v242, 16, v189
v_and_b32 v248, 0xffff0000, v189
v_mul_f32 v242, v242, v239
v_mul_f32 v248, v248, v239
v_cvt_pk_bf16_f32 v189, v242, v248
ds_read_b64 v[250:251], v231 offset:3072
s_waitcnt lgkmcnt(0)
v_lshlrev_b32 v242, 16, v250
v_and_b32 v248, 0xffff0000, v250
v_mul_f32 v242, v242, v239
v_mul_f32 v248, v248, v239
v_cvt_pk_bf16_f32 v250, v242, v248
v_lshlrev_b32 v242, 16, v251
v_and_b32 v248, 0xffff0000, v251
v_mul_f32 v242, v242, v239
v_mul_f32 v248, v248, v239
v_cvt_pk_bf16_f32 v251, v242, v248
ds_write_b64 v231, v[250:251] offset:3072
s_waitcnt lgkmcnt(0)
ds_read_b64 v[250:251], v231 offset:3080
s_waitcnt lgkmcnt(0)
v_lshlrev_b32 v242, 16, v250
v_and_b32 v248, 0xffff0000, v250
v_mul_f32 v242, v242, v239
v_mul_f32 v248, v248, v239
v_cvt_pk_bf16_f32 v250, v242, v248
v_lshlrev_b32 v242, 16, v251
v_and_b32 v248, 0xffff0000, v251
v_mul_f32 v242, v242, v239
v_mul_f32 v248, v248, v239
v_cvt_pk_bf16_f32 v251, v242, v248
ds_write_b64 v231, v[250:251] offset:3080
s_waitcnt lgkmcnt(0)
ds_read_b64 v[250:251], v231 offset:7168
s_waitcnt lgkmcnt(0)
v_lshlrev_b32 v242, 16, v250
v_and_b32 v248, 0xffff0000, v250
v_mul_f32 v242, v242, v239
v_mul_f32 v248, v248, v239
v_cvt_pk_bf16_f32 v250, v242, v248
v_lshlrev_b32 v242, 16, v251
v_and_b32 v248, 0xffff0000, v251
v_mul_f32 v242, v242, v239
v_mul_f32 v248, v248, v239
v_cvt_pk_bf16_f32 v251, v242, v248
ds_write_b64 v231, v[250:251] offset:7168
s_waitcnt lgkmcnt(0)
ds_read_b64 v[250:251], v231 offset:7176
s_waitcnt lgkmcnt(0)
v_lshlrev_b32 v242, 16, v250
v_and_b32 v248, 0xffff0000, v250
v_mul_f32 v242, v242, v239
v_mul_f32 v248, v248, v239
v_cvt_pk_bf16_f32 v250, v242, v248
v_lshlrev_b32 v242, 16, v251
v_and_b32 v248, 0xffff0000, v251
v_mul_f32 v242, v242, v239
v_mul_f32 v248, v248, v239
v_cvt_pk_bf16_f32 v251, v242, v248
ds_write_b64 v231, v[250:251] offset:7176
s_waitcnt lgkmcnt(0)
v_exp_f32 v232, v156
v_exp_f32 v233, v157
v_exp_f32 v234, v158
v_exp_f32 v235, v159
s_nop 1
v_cvt_pk_bf16_f32 v190, v232, v233
v_cvt_pk_bf16_f32 v191, v234, v235
s_branch L2_rare_common
L2_rare_site16:
s_mov_b32 s36, 16
s_branch L2_rare_t0_4
L2_rare_t0_4:
s_nop 15
s_nop 15
s_waitcnt lgkmcnt(0)
v_lshrrev_b32 v206, 8, v243
v_add_u32 v206, 1, v206
v_lshrrev_b32 v206, 2, v206
v_sub_u32 v206, 0, v206
v_and_b32 v206, 0xffff0000, v206
v_max_f32 v204, v128, v129
v_max3_f32 v204, v204, v130, v131
v_mov_b32 v205, v204
s_nop 1
v_permlane32_swap_b32 v204, v205
s_nop 1
v_max_f32 v204, v204, v205
v_mov_b32 v205, v204
s_nop 1
v_permlane16_swap_b32 v204, v205
s_nop 1
v_max_f32 v204, v204, v205
v_add_f32 v204, 40.0, v204
v_ceil_f32 v204, v204
v_max_f32 v204, 0, v204
v_sub_f32 v205, v224, v204
v_cvt_pk_bf16_f32 v205, v205, v205
v_and_b32 v205, 0xffff0000, v205
v_sub_f32 v204, v205, v224
v_mov_b32 v224, v205
v_exp_f32 v236, v204
v_add_f32 v128, v128, v204
v_add_f32 v129, v129, v204
v_add_f32 v130, v130, v204
v_add_f32 v131, v131, v204
v_add_f32 v144, v144, v204
v_add_f32 v145, v145, v204
v_add_f32 v146, v146, v204
v_add_f32 v147, v147, v204
v_lshlrev_b32 v242, 16, v4
v_and_b32 v248, 0xffff0000, v4
v_mul_f32 v242, v242, v236
v_mul_f32 v248, v248, v236
v_cvt_pk_bf16_f32 v4, v242, v248
v_lshlrev_b32 v242, 16, v5
v_and_b32 v248, 0xffff0000, v5
v_mul_f32 v242, v242, v236
v_mul_f32 v248, v248, v236
v_cvt_pk_bf16_f32 v5, v242, v248
v_lshlrev_b32 v242, 16, v6
v_and_b32 v248, 0xffff0000, v6
v_mul_f32 v242, v242, v236
v_mul_f32 v248, v248, v236
v_cvt_pk_bf16_f32 v6, v242, v248
v_lshlrev_b32 v242, 16, v7
v_and_b32 v248, 0xffff0000, v7
v_mul_f32 v242, v242, v236
v_mul_f32 v248, v248, v236
v_cvt_pk_bf16_f32 v7, v242, v248
v_lshlrev_b32 v242, 16, v8
v_and_b32 v248, 0xffff0000, v8
v_mul_f32 v242, v242, v236
v_mul_f32 v248, v248, v236
v_cvt_pk_bf16_f32 v8, v242, v248
v_lshlrev_b32 v242, 16, v9
v_and_b32 v248, 0xffff0000, v9
v_mul_f32 v242, v242, v236
v_mul_f32 v248, v248, v236
v_cvt_pk_bf16_f32 v9, v242, v248
v_lshlrev_b32 v242, 16, v10
v_and_b32 v248, 0xffff0000, v10
v_mul_f32 v242, v242, v236
v_mul_f32 v248, v248, v236
v_cvt_pk_bf16_f32 v10, v242, v248
v_lshlrev_b32 v242, 16, v11
v_and_b32 v248, 0xffff0000, v11
v_mul_f32 v242, v242, v236
v_mul_f32 v248, v248, v236
v_cvt_pk_bf16_f32 v11, v242, v248
v_lshlrev_b32 v242, 16, v160
v_and_b32 v248, 0xffff0000, v160
v_mul_f32 v242, v242, v236
v_mul_f32 v248, v248, v236
v_cvt_pk_bf16_f32 v160, v242, v248
v_lshlrev_b32 v242, 16, v161
v_and_b32 v248, 0xffff0000, v161
v_mul_f32 v242, v242, v236
v_mul_f32 v248, v248, v236
v_cvt_pk_bf16_f32 v161, v242, v248
v_lshlrev_b32 v242, 16, v162
v_and_b32 v248, 0xffff0000, v162
v_mul_f32 v242, v242, v236
v_mul_f32 v248, v248, v236
v_cvt_pk_bf16_f32 v162, v242, v248
v_lshlrev_b32 v242, 16, v163
v_and_b32 v248, 0xffff0000, v163
v_mul_f32 v242, v242, v236
v_mul_f32 v248, v248, v236
v_cvt_pk_bf16_f32 v163, v242, v248
v_lshlrev_b32 v242, 16, v176
v_and_b32 v248, 0xffff0000, v176
v_mul_f32 v242, v242, v236
v_mul_f32 v248, v248, v236
v_cvt_pk_bf16_f32 v176, v242, v248
v_lshlrev_b32 v242, 16, v177
v_and_b32 v248, 0xffff0000, v177
v_mul_f32 v242, v242, v236
v_mul_f32 v248, v248, v236
v_cvt_pk_bf16_f32 v177, v242, v248
v_lshlrev_b32 v242, 16, v178
v_and_b32 v248, 0xffff0000, v178
v_mul_f32 v242, v242, v236
v_mul_f32 v248, v248, v236
v_cvt_pk_bf16_f32 v178, v242, v248
v_lshlrev_b32 v242, 16, v179
v_and_b32 v248, 0xffff0000, v179
v_mul_f32 v242, v242, v236
v_mul_f32 v248, v248, v236
v_cvt_pk_bf16_f32 v179, v242, v248
v_exp_f32 v232, v128
v_exp_f32 v233, v129
v_exp_f32 v234, v130
v_exp_f32 v235, v131
s_nop 1
v_cvt_pk_bf16_f32 v0, v232, v233
v_cvt_pk_bf16_f32 v1, v234, v235
v_max_f32 v204, v132, v133
v_max3_f32 v204, v204, v134, v135
v_mov_b32 v205, v204
s_nop 1
v_permlane32_swap_b32 v204, v205
s_nop 1
v_max_f32 v204, v204, v205
v_mov_b32 v205, v204
s_nop 1
v_permlane16_swap_b32 v204, v205
s_nop 1
v_max_f32 v204, v204, v205
v_add_f32 v204, 40.0, v204
v_ceil_f32 v204, v204
v_max_f32 v204, 0, v204
v_sub_f32 v205, v225, v204
v_cvt_pk_bf16_f32 v205, v205, v205
v_and_b32 v205, 0xffff0000, v205
v_sub_f32 v204, v205, v225
v_mov_b32 v225, v205
v_exp_f32 v237, v204
v_add_f32 v132, v132, v204
v_add_f32 v133, v133, v204
v_add_f32 v134, v134, v204
v_add_f32 v135, v135, v204
v_add_f32 v148, v148, v204
v_add_f32 v149, v149, v204
v_add_f32 v150, v150, v204
v_add_f32 v151, v151, v204
v_lshlrev_b32 v242, 16, v36
v_and_b32 v248, 0xffff0000, v36
v_mul_f32 v242, v242, v237
v_mul_f32 v248, v248, v237
v_cvt_pk_bf16_f32 v36, v242, v248
v_lshlrev_b32 v242, 16, v37
v_and_b32 v248, 0xffff0000, v37
v_mul_f32 v242, v242, v237
v_mul_f32 v248, v248, v237
v_cvt_pk_bf16_f32 v37, v242, v248
v_lshlrev_b32 v242, 16, v38
v_and_b32 v248, 0xffff0000, v38
v_mul_f32 v242, v242, v237
v_mul_f32 v248, v248, v237
v_cvt_pk_bf16_f32 v38, v242, v248
v_lshlrev_b32 v242, 16, v39
v_and_b32 v248, 0xffff0000, v39
v_mul_f32 v242, v242, v237
v_mul_f32 v248, v248, v237
v_cvt_pk_bf16_f32 v39, v242, v248
v_lshlrev_b32 v242, 16, v40
v_and_b32 v248, 0xffff0000, v40
v_mul_f32 v242, v242, v237
v_mul_f32 v248, v248, v237
v_cvt_pk_bf16_f32 v40, v242, v248
v_lshlrev_b32 v242, 16, v41
v_and_b32 v248, 0xffff0000, v41
v_mul_f32 v242, v242, v237
v_mul_f32 v248, v248, v237
v_cvt_pk_bf16_f32 v41, v242, v248
v_lshlrev_b32 v242, 16, v42
v_and_b32 v248, 0xffff0000, v42
v_mul_f32 v242, v242, v237
v_mul_f32 v248, v248, v237
v_cvt_pk_bf16_f32 v42, v242, v248
v_lshlrev_b32 v242, 16, v43
v_and_b32 v248, 0xffff0000, v43
v_mul_f32 v242, v242, v237
v_mul_f32 v248, v248, v237
v_cvt_pk_bf16_f32 v43, v242, v248
v_lshlrev_b32 v242, 16, v164
v_and_b32 v248, 0xffff0000, v164
v_mul_f32 v242, v242, v237
v_mul_f32 v248, v248, v237
v_cvt_pk_bf16_f32 v164, v242, v248
v_lshlrev_b32 v242, 16, v165
v_and_b32 v248, 0xffff0000, v165
v_mul_f32 v242, v242, v237
v_mul_f32 v248, v248, v237
v_cvt_pk_bf16_f32 v165, v242, v248
v_lshlrev_b32 v242, 16, v166
v_and_b32 v248, 0xffff0000, v166
v_mul_f32 v242, v242, v237
v_mul_f32 v248, v248, v237
v_cvt_pk_bf16_f32 v166, v242, v248
v_lshlrev_b32 v242, 16, v167
v_and_b32 v248, 0xffff0000, v167
v_mul_f32 v242, v242, v237
v_mul_f32 v248, v248, v237
v_cvt_pk_bf16_f32 v167, v242, v248
v_lshlrev_b32 v242, 16, v180
v_and_b32 v248, 0xffff0000, v180
v_mul_f32 v242, v242, v237
v_mul_f32 v248, v248, v237
v_cvt_pk_bf16_f32 v180, v242, v248
v_lshlrev_b32 v242, 16, v181
v_and_b32 v248, 0xffff0000, v181
v_mul_f32 v242, v242, v237
v_mul_f32 v248, v248, v237
v_cvt_pk_bf16_f32 v181, v242, v248
v_lshlrev_b32 v242, 16, v182
v_and_b32 v248, 0xffff0000, v182
v_mul_f32 v242, v242, v237
v_mul_f32 v248, v248, v237
v_cvt_pk_bf16_f32 v182, v242, v248
v_lshlrev_b32 v242, 16, v183
v_and_b32 v248, 0xffff0000, v183
v_mul_f32 v242, v242, v237
v_mul_f32 v248, v248, v237
v_cvt_pk_bf16_f32 v183, v242, v248
v_exp_f32 v232, v132
v_exp_f32 v233, v133
v_exp_f32 v234, v134
v_exp_f32 v235, v135
s_nop 1
v_cvt_pk_bf16_f32 v32, v232, v233
v_cvt_pk_bf16_f32 v33, v234, v235
v_max_f32 v204, v136, v137
v_max3_f32 v204, v204, v138, v139
v_mov_b32 v205, v204
s_nop 1
v_permlane32_swap_b32 v204, v205
s_nop 1
v_max_f32 v204, v204, v205
v_mov_b32 v205, v204
s_nop 1
v_permlane16_swap_b32 v204, v205
s_nop 1
v_max_f32 v204, v204, v205
v_add_f32 v204, 40.0, v204
v_ceil_f32 v204, v204
v_max_f32 v204, 0, v204
v_sub_f32 v205, v226, v204
v_cvt_pk_bf16_f32 v205, v205, v205
v_and_b32 v205, 0xffff0000, v205
v_sub_f32 v204, v205, v226
v_mov_b32 v226, v205
v_exp_f32 v238, v204
v_add_f32 v136, v136, v204
v_add_f32 v137, v137, v204
v_add_f32 v138, v138, v204
v_add_f32 v139, v139, v204
v_add_f32 v152, v152, v204
v_add_f32 v153, v153, v204
v_add_f32 v154, v154, v204
v_add_f32 v155, v155, v204
v_lshlrev_b32 v242, 16, v68
v_and_b32 v248, 0xffff0000, v68
v_mul_f32 v242, v242, v238
v_mul_f32 v248, v248, v238
v_cvt_pk_bf16_f32 v68, v242, v248
v_lshlrev_b32 v242, 16, v69
v_and_b32 v248, 0xffff0000, v69
v_mul_f32 v242, v242, v238
v_mul_f32 v248, v248, v238
v_cvt_pk_bf16_f32 v69, v242, v248
v_lshlrev_b32 v242, 16, v70
v_and_b32 v248, 0xffff0000, v70
v_mul_f32 v242, v242, v238
v_mul_f32 v248, v248, v238
v_cvt_pk_bf16_f32 v70, v242, v248
v_lshlrev_b32 v242, 16, v71
v_and_b32 v248, 0xffff0000, v71
v_mul_f32 v242, v242, v238
v_mul_f32 v248, v248, v238
v_cvt_pk_bf16_f32 v71, v242, v248
v_lshlrev_b32 v242, 16, v72
v_and_b32 v248, 0xffff0000, v72
v_mul_f32 v242, v242, v238
v_mul_f32 v248, v248, v238
v_cvt_pk_bf16_f32 v72, v242, v248
v_lshlrev_b32 v242, 16, v73
v_and_b32 v248, 0xffff0000, v73
v_mul_f32 v242, v242, v238
v_mul_f32 v248, v248, v238
v_cvt_pk_bf16_f32 v73, v242, v248
v_lshlrev_b32 v242, 16, v74
v_and_b32 v248, 0xffff0000, v74
v_mul_f32 v242, v242, v238
v_mul_f32 v248, v248, v238
v_cvt_pk_bf16_f32 v74, v242, v248
v_lshlrev_b32 v242, 16, v75
v_and_b32 v248, 0xffff0000, v75
v_mul_f32 v242, v242, v238
v_mul_f32 v248, v248, v238
v_cvt_pk_bf16_f32 v75, v242, v248
v_lshlrev_b32 v242, 16, v168
v_and_b32 v248, 0xffff0000, v168
v_mul_f32 v242, v242, v238
v_mul_f32 v248, v248, v238
v_cvt_pk_bf16_f32 v168, v242, v248
v_lshlrev_b32 v242, 16, v169
v_and_b32 v248, 0xffff0000, v169
v_mul_f32 v242, v242, v238
v_mul_f32 v248, v248, v238
v_cvt_pk_bf16_f32 v169, v242, v248
v_lshlrev_b32 v242, 16, v170
v_and_b32 v248, 0xffff0000, v170
v_mul_f32 v242, v242, v238
v_mul_f32 v248, v248, v238
v_cvt_pk_bf16_f32 v170, v242, v248
v_lshlrev_b32 v242, 16, v171
v_and_b32 v248, 0xffff0000, v171
v_mul_f32 v242, v242, v238
v_mul_f32 v248, v248, v238
v_cvt_pk_bf16_f32 v171, v242, v248
v_lshlrev_b32 v242, 16, v184
v_and_b32 v248, 0xffff0000, v184
v_mul_f32 v242, v242, v238
v_mul_f32 v248, v248, v238
v_cvt_pk_bf16_f32 v184, v242, v248
v_lshlrev_b32 v242, 16, v185
v_and_b32 v248, 0xffff0000, v185
v_mul_f32 v242, v242, v238
v_mul_f32 v248, v248, v238
v_cvt_pk_bf16_f32 v185, v242, v248
v_lshlrev_b32 v242, 16, v186
v_and_b32 v248, 0xffff0000, v186
v_mul_f32 v242, v242, v238
v_mul_f32 v248, v248, v238
v_cvt_pk_bf16_f32 v186, v242, v248
v_lshlrev_b32 v242, 16, v187
v_and_b32 v248, 0xffff0000, v187
v_mul_f32 v242, v242, v238
v_mul_f32 v248, v248, v238
v_cvt_pk_bf16_f32 v187, v242, v248
v_exp_f32 v232, v136
v_exp_f32 v233, v137
v_exp_f32 v234, v138
v_exp_f32 v235, v139
s_nop 1
v_cvt_pk_bf16_f32 v64, v232, v233
v_cvt_pk_bf16_f32 v65, v234, v235
v_max_f32 v204, v140, v141
v_max3_f32 v204, v204, v142, v143
v_mov_b32 v205, v204
s_nop 1
v_permlane32_swap_b32 v204, v205
s_nop 1
v_max_f32 v204, v204, v205
v_mov_b32 v205, v204
s_nop 1
v_permlane16_swap_b32 v204, v205
s_nop 1
v_max_f32 v204, v204, v205
v_add_f32 v204, 40.0, v204
v_ceil_f32 v204, v204
v_max_f32 v204, 0, v204
v_sub_f32 v205, v227, v204
v_cvt_pk_bf16_f32 v205, v205, v205
v_and_b32 v205, 0xffff0000, v205
v_sub_f32 v204, v205, v227
v_mov_b32 v227, v205
v_exp_f32 v239, v204
v_add_f32 v140, v140, v204
v_add_f32 v141, v141, v204
v_add_f32 v142, v142, v204
v_add_f32 v143, v143, v204
v_add_f32 v156, v156, v204
v_add_f32 v157, v157, v204
v_add_f32 v158, v158, v204
v_add_f32 v159, v159, v204
v_lshlrev_b32 v242, 16, v100
v_and_b32 v248, 0xffff0000, v100
v_mul_f32 v242, v242, v239
v_mul_f32 v248, v248, v239
v_cvt_pk_bf16_f32 v100, v242, v248
v_lshlrev_b32 v242, 16, v101
v_and_b32 v248, 0xffff0000, v101
v_mul_f32 v242, v242, v239
v_mul_f32 v248, v248, v239
v_cvt_pk_bf16_f32 v101, v242, v248
v_lshlrev_b32 v242, 16, v102
v_and_b32 v248, 0xffff0000, v102
v_mul_f32 v242, v242, v239
v_mul_f32 v248, v248, v239
v_cvt_pk_bf16_f32 v102, v242, v248
v_lshlrev_b32 v242, 16, v103
v_and_b32 v248, 0xffff0000, v103
v_mul_f32 v242, v242, v239
v_mul_f32 v248, v248, v239
v_cvt_pk_bf16_f32 v103, v242, v248
v_lshlrev_b32 v242, 16, v104
v_and_b32 v248, 0xffff0000, v104
v_mul_f32 v242, v242, v239
v_mul_f32 v248, v248, v239
v_cvt_pk_bf16_f32 v104, v242, v248
v_lshlrev_b32 v242, 16, v105
v_and_b32 v248, 0xffff0000, v105
v_mul_f32 v242, v242, v239
v_mul_f32 v248, v248, v239
v_cvt_pk_bf16_f32 v105, v242, v248
v_lshlrev_b32 v242, 16, v106
v_and_b32 v248, 0xffff0000, v106
v_mul_f32 v242, v242, v239
v_mul_f32 v248, v248, v239
v_cvt_pk_bf16_f32 v106, v242, v248
v_lshlrev_b32 v242, 16, v107
v_and_b32 v248, 0xffff0000, v107
v_mul_f32 v242, v242, v239
v_mul_f32 v248, v248, v239
v_cvt_pk_bf16_f32 v107, v242, v248
v_lshlrev_b32 v242, 16, v172
v_and_b32 v248, 0xffff0000, v172
v_mul_f32 v242, v242, v239
v_mul_f32 v248, v248, v239
v_cvt_pk_bf16_f32 v172, v242, v248
v_lshlrev_b32 v242, 16, v173
v_and_b32 v248, 0xffff0000, v173
v_mul_f32 v242, v242, v239
v_mul_f32 v248, v248, v239
v_cvt_pk_bf16_f32 v173, v242, v248
v_lshlrev_b32 v242, 16, v174
v_and_b32 v248, 0xffff0000, v174
v_mul_f32 v242, v242, v239
v_mul_f32 v248, v248, v239
v_cvt_pk_bf16_f32 v174, v242, v248
v_lshlrev_b32 v242, 16, v175
v_and_b32 v248, 0xffff0000, v175
v_mul_f32 v242, v242, v239
v_mul_f32 v248, v248, v239
v_cvt_pk_bf16_f32 v175, v242, v248
v_lshlrev_b32 v242, 16, v188
v_and_b32 v248, 0xffff0000, v188
v_mul_f32 v242, v242, v239
v_mul_f32 v248, v248, v239
v_cvt_pk_bf16_f32 v188, v242, v248
v_lshlrev_b32 v242, 16, v189
v_and_b32 v248, 0xffff0000, v189
v_mul_f32 v242, v242, v239
v_mul_f32 v248, v248, v239
v_cvt_pk_bf16_f32 v189, v242, v248
v_lshlrev_b32 v242, 16, v190
v_and_b32 v248, 0xffff0000, v190
v_mul_f32 v242, v242, v239
v_mul_f32 v248, v248, v239
v_cvt_pk_bf16_f32 v190, v242, v248
v_lshlrev_b32 v242, 16, v191
v_and_b32 v248, 0xffff0000, v191
v_mul_f32 v242, v242, v239
v_mul_f32 v248, v248, v239
v_cvt_pk_bf16_f32 v191, v242, v248
v_exp_f32 v232, v140
v_exp_f32 v233, v141
v_exp_f32 v234, v142
v_exp_f32 v235, v143
s_nop 1
v_cvt_pk_bf16_f32 v96, v232, v233
v_cvt_pk_bf16_f32 v97, v234, v235
s_branch L2_rare_common
L2_rare_site17:
s_mov_b32 s36, 17
s_branch L2_rare_t0_5
L2_rare_t0_5:
s_nop 15
s_nop 15
s_waitcnt lgkmcnt(0)
v_lshrrev_b32 v206, 8, v243
v_add_u32 v206, 1, v206
v_lshrrev_b32 v206, 2, v206
v_sub_u32 v206, 0, v206
v_and_b32 v206, 0xffff0000, v206
v_max_f32 v204, v144, v145
v_max3_f32 v204, v204, v146, v147
v_mov_b32 v205, v204
s_nop 1
v_permlane32_swap_b32 v204, v205
s_nop 1
v_max_f32 v204, v204, v205
v_mov_b32 v205, v204
s_nop 1
v_permlane16_swap_b32 v204, v205
s_nop 1
v_max_f32 v204, v204, v205
v_add_f32 v204, 40.0, v204
v_ceil_f32 v204, v204
v_max_f32 v204, 0, v204
v_sub_f32 v205, v224, v204
v_cvt_pk_bf16_f32 v205, v205, v205
v_and_b32 v205, 0xffff0000, v205
v_sub_f32 v204, v205, v224
v_mov_b32 v224, v205
v_exp_f32 v236, v204
v_add_f32 v144, v144, v204
v_add_f32 v145, v145, v204
v_add_f32 v146, v146, v204
v_add_f32 v147, v147, v204
v_add_f32 v128, v128, v204
v_add_f32 v129, v129, v204
v_add_f32 v130, v130, v204
v_add_f32 v131, v131, v204
v_lshlrev_b32 v242, 16, v4
v_and_b32 v248, 0xffff0000, v4
v_mul_f32 v242, v242, v236
v_mul_f32 v248, v248, v236
v_cvt_pk_bf16_f32 v4, v242, v248
v_lshlrev_b32 v242, 16, v5
v_and_b32 v248, 0xffff0000, v5
v_mul_f32 v242, v242, v236
v_mul_f32 v248, v248, v236
v_cvt_pk_bf16_f32 v5, v242, v248
v_lshlrev_b32 v242, 16, v6
v_and_b32 v248, 0xffff0000, v6
v_mul_f32 v242, v242, v236
v_mul_f32 v248, v248, v236
v_cvt_pk_bf16_f32 v6, v242, v248
v_lshlrev_b32 v242, 16, v7
v_and_b32 v248, 0xffff0000, v7
v_mul_f32 v242, v242, v236
v_mul_f32 v248, v248, v236
v_cvt_pk_bf16_f32 v7, v242, v248
v_lshlrev_b32 v242, 16, v8
v_and_b32 v248, 0xffff0000, v8
v_mul_f32 v242, v242, v236
v_mul_f32 v248, v248, v236
v_cvt_pk_bf16_f32 v8, v242, v248
v_lshlrev_b32 v242, 16, v9
v_and_b32 v248, 0xffff0000, v9
v_mul_f32 v242, v242, v236
v_mul_f32 v248, v248, v236
v_cvt_pk_bf16_f32 v9, v242, v248
v_lshlrev_b32 v242, 16, v10
v_and_b32 v248, 0xffff0000, v10
v_mul_f32 v242, v242, v236
v_mul_f32 v248, v248, v236
v_cvt_pk_bf16_f32 v10, v242, v248
v_lshlrev_b32 v242, 16, v11
v_and_b32 v248, 0xffff0000, v11
v_mul_f32 v242, v242, v236
v_mul_f32 v248, v248, v236
v_cvt_pk_bf16_f32 v11, v242, v248
v_lshlrev_b32 v242, 16, v160
v_and_b32 v248, 0xffff0000, v160
v_mul_f32 v242, v242, v236
v_mul_f32 v248, v248, v236
v_cvt_pk_bf16_f32 v160, v242, v248
v_lshlrev_b32 v242, 16, v161
v_and_b32 v248, 0xffff0000, v161
v_mul_f32 v242, v242, v236
v_mul_f32 v248, v248, v236
v_cvt_pk_bf16_f32 v161, v242, v248
v_lshlrev_b32 v242, 16, v162
v_and_b32 v248, 0xffff0000, v162
v_mul_f32 v242, v242, v236
v_mul_f32 v248, v248, v236
v_cvt_pk_bf16_f32 v162, v242, v248
v_lshlrev_b32 v242, 16, v163
v_and_b32 v248, 0xffff0000, v163
v_mul_f32 v242, v242, v236
v_mul_f32 v248, v248, v236
v_cvt_pk_bf16_f32 v163, v242, v248
v_lshlrev_b32 v242, 16, v176
v_and_b32 v248, 0xffff0000, v176
v_mul_f32 v242, v242, v236
v_mul_f32 v248, v248, v236
v_cvt_pk_bf16_f32 v176, v242, v248
v_lshlrev_b32 v242, 16, v177
v_and_b32 v248, 0xffff0000, v177
v_mul_f32 v242, v242, v236
v_mul_f32 v248, v248, v236
v_cvt_pk_bf16_f32 v177, v242, v248
v_lshlrev_b32 v242, 16, v178
v_and_b32 v248, 0xffff0000, v178
v_mul_f32 v242, v242, v236
v_mul_f32 v248, v248, v236
v_cvt_pk_bf16_f32 v178, v242, v248
v_lshlrev_b32 v242, 16, v179
v_and_b32 v248, 0xffff0000, v179
v_mul_f32 v242, v242, v236
v_mul_f32 v248, v248, v236
v_cvt_pk_bf16_f32 v179, v242, v248
v_lshlrev_b32 v242, 16, v0
v_and_b32 v248, 0xffff0000, v0
v_mul_f32 v242, v242, v236
v_mul_f32 v248, v248, v236
v_cvt_pk_bf16_f32 v0, v242, v248
v_lshlrev_b32 v242, 16, v1
v_and_b32 v248, 0xffff0000, v1
v_mul_f32 v242, v242, v236
v_mul_f32 v248, v248, v236
v_cvt_pk_bf16_f32 v1, v242, v248
v_exp_f32 v232, v144
v_exp_f32 v233, v145
v_exp_f32 v234, v146
v_exp_f32 v235, v147
s_nop 1
v_cvt_pk_bf16_f32 v2, v232, v233
v_cvt_pk_bf16_f32 v3, v234, v235
v_max_f32 v204, v148, v149
v_max3_f32 v204, v204, v150, v151
v_mov_b32 v205, v204
s_nop 1
v_permlane32_swap_b32 v204, v205
s_nop 1
v_max_f32 v204, v204, v205
v_mov_b32 v205, v204
s_nop 1
v_permlane16_swap_b32 v204, v205
s_nop 1
v_max_f32 v204, v204, v205
v_add_f32 v204, 40.0, v204
v_ceil_f32 v204, v204
v_max_f32 v204, 0, v204
v_sub_f32 v205, v225, v204
v_cvt_pk_bf16_f32 v205, v205, v205
v_and_b32 v205, 0xffff0000, v205
v_sub_f32 v204, v205, v225
v_mov_b32 v225, v205
v_exp_f32 v237, v204
v_add_f32 v148, v148, v204
v_add_f32 v149, v149, v204
v_add_f32 v150, v150, v204
v_add_f32 v151, v151, v204
v_add_f32 v132, v132, v204
v_add_f32 v133, v133, v204
v_add_f32 v134, v134, v204
v_add_f32 v135, v135, v204
v_lshlrev_b32 v242, 16, v36
v_and_b32 v248, 0xffff0000, v36
v_mul_f32 v242, v242, v237
v_mul_f32 v248, v248, v237
v_cvt_pk_bf16_f32 v36, v242, v248
v_lshlrev_b32 v242, 16, v37
v_and_b32 v248, 0xffff0000, v37
v_mul_f32 v242, v242, v237
v_mul_f32 v248, v248, v237
v_cvt_pk_bf16_f32 v37, v242, v248
v_lshlrev_b32 v242, 16, v38
v_and_b32 v248, 0xffff0000, v38
v_mul_f32 v242, v242, v237
v_mul_f32 v248, v248, v237
v_cvt_pk_bf16_f32 v38, v242, v248
v_lshlrev_b32 v242, 16, v39
v_and_b32 v248, 0xffff0000, v39
v_mul_f32 v242, v242, v237
v_mul_f32 v248, v248, v237
v_cvt_pk_bf16_f32 v39, v242, v248
v_lshlrev_b32 v242, 16, v40
v_and_b32 v248, 0xffff0000, v40
v_mul_f32 v242, v242, v237
v_mul_f32 v248, v248, v237
v_cvt_pk_bf16_f32 v40, v242, v248
v_lshlrev_b32 v242, 16, v41
v_and_b32 v248, 0xffff0000, v41
v_mul_f32 v242, v242, v237
v_mul_f32 v248, v248, v237
v_cvt_pk_bf16_f32 v41, v242, v248
v_lshlrev_b32 v242, 16, v42
v_and_b32 v248, 0xffff0000, v42
v_mul_f32 v242, v242, v237
v_mul_f32 v248, v248, v237
v_cvt_pk_bf16_f32 v42, v242, v248
v_lshlrev_b32 v242, 16, v43
v_and_b32 v248, 0xffff0000, v43
v_mul_f32 v242, v242, v237
v_mul_f32 v248, v248, v237
v_cvt_pk_bf16_f32 v43, v242, v248
v_lshlrev_b32 v242, 16, v164
v_and_b32 v248, 0xffff0000, v164
v_mul_f32 v242, v242, v237
v_mul_f32 v248, v248, v237
v_cvt_pk_bf16_f32 v164, v242, v248
v_lshlrev_b32 v242, 16, v165
v_and_b32 v248, 0xffff0000, v165
v_mul_f32 v242, v242, v237
v_mul_f32 v248, v248, v237
v_cvt_pk_bf16_f32 v165, v242, v248
v_lshlrev_b32 v242, 16, v166
v_and_b32 v248, 0xffff0000, v166
v_mul_f32 v242, v242, v237
v_mul_f32 v248, v248, v237
v_cvt_pk_bf16_f32 v166, v242, v248
v_lshlrev_b32 v242, 16, v167
v_and_b32 v248, 0xffff0000, v167
v_mul_f32 v242, v242, v237
v_mul_f32 v248, v248, v237
v_cvt_pk_bf16_f32 v167, v242, v248
v_lshlrev_b32 v242, 16, v180
v_and_b32 v248, 0xffff0000, v180
v_mul_f32 v242, v242, v237
v_mul_f32 v248, v248, v237
v_cvt_pk_bf16_f32 v180, v242, v248
v_lshlrev_b32 v242, 16, v181
v_and_b32 v248, 0xffff0000, v181
v_mul_f32 v242, v242, v237
v_mul_f32 v248, v248, v237
v_cvt_pk_bf16_f32 v181, v242, v248
v_lshlrev_b32 v242, 16, v182
v_and_b32 v248, 0xffff0000, v182
v_mul_f32 v242, v242, v237
v_mul_f32 v248, v248, v237
v_cvt_pk_bf16_f32 v182, v242, v248
v_lshlrev_b32 v242, 16, v183
v_and_b32 v248, 0xffff0000, v183
v_mul_f32 v242, v242, v237
v_mul_f32 v248, v248, v237
v_cvt_pk_bf16_f32 v183, v242, v248
v_lshlrev_b32 v242, 16, v32
v_and_b32 v248, 0xffff0000, v32
v_mul_f32 v242, v242, v237
v_mul_f32 v248, v248, v237
v_cvt_pk_bf16_f32 v32, v242, v248
v_lshlrev_b32 v242, 16, v33
v_and_b32 v248, 0xffff0000, v33
v_mul_f32 v242, v242, v237
v_mul_f32 v248, v248, v237
v_cvt_pk_bf16_f32 v33, v242, v248
v_exp_f32 v232, v148
v_exp_f32 v233, v149
v_exp_f32 v234, v150
v_exp_f32 v235, v151
s_nop 1
v_cvt_pk_bf16_f32 v34, v232, v233
v_cvt_pk_bf16_f32 v35, v234, v235
v_max_f32 v204, v152, v153
v_max3_f32 v204, v204, v154, v155
v_mov_b32 v205, v204
s_nop 1
v_permlane32_swap_b32 v204, v205
s_nop 1
v_max_f32 v204, v204, v205
v_mov_b32 v205, v204
s_nop 1
v_permlane16_swap_b32 v204, v205
s_nop 1
v_max_f32 v204, v204, v205
v_add_f32 v204, 40.0, v204
v_ceil_f32 v204, v204
v_max_f32 v204, 0, v204
v_sub_f32 v205, v226, v204
v_cvt_pk_bf16_f32 v205, v205, v205
v_and_b32 v205, 0xffff0000, v205
v_sub_f32 v204, v205, v226
v_mov_b32 v226, v205
v_exp_f32 v238, v204
v_add_f32 v152, v152, v204
v_add_f32 v153, v153, v204
v_add_f32 v154, v154, v204
v_add_f32 v155, v155, v204
v_add_f32 v136, v136, v204
v_add_f32 v137, v137, v204
v_add_f32 v138, v138, v204
v_add_f32 v139, v139, v204
v_lshlrev_b32 v242, 16, v68
v_and_b32 v248, 0xffff0000, v68
v_mul_f32 v242, v242, v238
v_mul_f32 v248, v248, v238
v_cvt_pk_bf16_f32 v68, v242, v248
v_lshlrev_b32 v242, 16, v69
v_and_b32 v248, 0xffff0000, v69
v_mul_f32 v242, v242, v238
v_mul_f32 v248, v248, v238
v_cvt_pk_bf16_f32 v69, v242, v248
v_lshlrev_b32 v242, 16, v70
v_and_b32 v248, 0xffff0000, v70
v_mul_f32 v242, v242, v238
v_mul_f32 v248, v248, v238
v_cvt_pk_bf16_f32 v70, v242, v248
v_lshlrev_b32 v242, 16, v71
v_and_b32 v248, 0xffff0000, v71
v_mul_f32 v242, v242, v238
v_mul_f32 v248, v248, v238
v_cvt_pk_bf16_f32 v71, v242, v248
v_lshlrev_b32 v242, 16, v72
v_and_b32 v248, 0xffff0000, v72
v_mul_f32 v242, v242, v238
v_mul_f32 v248, v248, v238
v_cvt_pk_bf16_f32 v72, v242, v248
v_lshlrev_b32 v242, 16, v73
v_and_b32 v248, 0xffff0000, v73
v_mul_f32 v242, v242, v238
v_mul_f32 v248, v248, v238
v_cvt_pk_bf16_f32 v73, v242, v248
v_lshlrev_b32 v242, 16, v74
v_and_b32 v248, 0xffff0000, v74
v_mul_f32 v242, v242, v238
v_mul_f32 v248, v248, v238
v_cvt_pk_bf16_f32 v74, v242, v248
v_lshlrev_b32 v242, 16, v75
v_and_b32 v248, 0xffff0000, v75
v_mul_f32 v242, v242, v238
v_mul_f32 v248, v248, v238
v_cvt_pk_bf16_f32 v75, v242, v248
v_lshlrev_b32 v242, 16, v168
v_and_b32 v248, 0xffff0000, v168
v_mul_f32 v242, v242, v238
v_mul_f32 v248, v248, v238
v_cvt_pk_bf16_f32 v168, v242, v248
v_lshlrev_b32 v242, 16, v169
v_and_b32 v248, 0xffff0000, v169
v_mul_f32 v242, v242, v238
v_mul_f32 v248, v248, v238
v_cvt_pk_bf16_f32 v169, v242, v248
v_lshlrev_b32 v242, 16, v170
v_and_b32 v248, 0xffff0000, v170
v_mul_f32 v242, v242, v238
v_mul_f32 v248, v248, v238
v_cvt_pk_bf16_f32 v170, v242, v248
v_lshlrev_b32 v242, 16, v171
v_and_b32 v248, 0xffff0000, v171
v_mul_f32 v242, v242, v238
v_mul_f32 v248, v248, v238
v_cvt_pk_bf16_f32 v171, v242, v248
v_lshlrev_b32 v242, 16, v184
v_and_b32 v248, 0xffff0000, v184
v_mul_f32 v242, v242, v238
v_mul_f32 v248, v248, v238
v_cvt_pk_bf16_f32 v184, v242, v248
v_lshlrev_b32 v242, 16, v185
v_and_b32 v248, 0xffff0000, v185
v_mul_f32 v242, v242, v238
v_mul_f32 v248, v248, v238
v_cvt_pk_bf16_f32 v185, v242, v248
v_lshlrev_b32 v242, 16, v186
v_and_b32 v248, 0xffff0000, v186
v_mul_f32 v242, v242, v238
v_mul_f32 v248, v248, v238
v_cvt_pk_bf16_f32 v186, v242, v248
v_lshlrev_b32 v242, 16, v187
v_and_b32 v248, 0xffff0000, v187
v_mul_f32 v242, v242, v238
v_mul_f32 v248, v248, v238
v_cvt_pk_bf16_f32 v187, v242, v248
v_lshlrev_b32 v242, 16, v64
v_and_b32 v248, 0xffff0000, v64
v_mul_f32 v242, v242, v238
v_mul_f32 v248, v248, v238
v_cvt_pk_bf16_f32 v64, v242, v248
v_lshlrev_b32 v242, 16, v65
v_and_b32 v248, 0xffff0000, v65
v_mul_f32 v242, v242, v238
v_mul_f32 v248, v248, v238
v_cvt_pk_bf16_f32 v65, v242, v248
v_exp_f32 v232, v152
v_exp_f32 v233, v153
v_exp_f32 v234, v154
v_exp_f32 v235, v155
s_nop 1
v_cvt_pk_bf16_f32 v66, v232, v233
v_cvt_pk_bf16_f32 v67, v234, v235
v_max_f32 v204, v156, v157
v_max3_f32 v204, v204, v158, v159
v_mov_b32 v205, v204
s_nop 1
v_permlane32_swap_b32 v204, v205
s_nop 1
v_max_f32 v204, v204, v205
v_mov_b32 v205, v204
s_nop 1
v_permlane16_swap_b32 v204, v205
s_nop 1
v_max_f32 v204, v204, v205
v_add_f32 v204, 40.0, v204
v_ceil_f32 v204, v204
v_max_f32 v204, 0, v204
v_sub_f32 v205, v227, v204
v_cvt_pk_bf16_f32 v205, v205, v205
v_and_b32 v205, 0xffff0000, v205
v_sub_f32 v204, v205, v227
v_mov_b32 v227, v205
v_exp_f32 v239, v204
v_add_f32 v156, v156, v204
v_add_f32 v157, v157, v204
v_add_f32 v158, v158, v204
v_add_f32 v159, v159, v204
v_add_f32 v140, v140, v204
v_add_f32 v141, v141, v204
v_add_f32 v142, v142, v204
v_add_f32 v143, v143, v204
v_lshlrev_b32 v242, 16, v100
v_and_b32 v248, 0xffff0000, v100
v_mul_f32 v242, v242, v239
v_mul_f32 v248, v248, v239
v_cvt_pk_bf16_f32 v100, v242, v248
v_lshlrev_b32 v242, 16, v101
v_and_b32 v248, 0xffff0000, v101
v_mul_f32 v242, v242, v239
v_mul_f32 v248, v248, v239
v_cvt_pk_bf16_f32 v101, v242, v248
v_lshlrev_b32 v242, 16, v102
v_and_b32 v248, 0xffff0000, v102
v_mul_f32 v242, v242, v239
v_mul_f32 v248, v248, v239
v_cvt_pk_bf16_f32 v102, v242, v248
v_lshlrev_b32 v242, 16, v103
v_and_b32 v248, 0xffff0000, v103
v_mul_f32 v242, v242, v239
v_mul_f32 v248, v248, v239
v_cvt_pk_bf16_f32 v103, v242, v248
v_lshlrev_b32 v242, 16, v104
v_and_b32 v248, 0xffff0000, v104
v_mul_f32 v242, v242, v239
v_mul_f32 v248, v248, v239
v_cvt_pk_bf16_f32 v104, v242, v248
v_lshlrev_b32 v242, 16, v105
v_and_b32 v248, 0xffff0000, v105
v_mul_f32 v242, v242, v239
v_mul_f32 v248, v248, v239
v_cvt_pk_bf16_f32 v105, v242, v248
v_lshlrev_b32 v242, 16, v106
v_and_b32 v248, 0xffff0000, v106
v_mul_f32 v242, v242, v239
v_mul_f32 v248, v248, v239
v_cvt_pk_bf16_f32 v106, v242, v248
v_lshlrev_b32 v242, 16, v107
v_and_b32 v248, 0xffff0000, v107
v_mul_f32 v242, v242, v239
v_mul_f32 v248, v248, v239
v_cvt_pk_bf16_f32 v107, v242, v248
v_lshlrev_b32 v242, 16, v172
v_and_b32 v248, 0xffff0000, v172
v_mul_f32 v242, v242, v239
v_mul_f32 v248, v248, v239
v_cvt_pk_bf16_f32 v172, v242, v248
v_lshlrev_b32 v242, 16, v173
v_and_b32 v248, 0xffff0000, v173
v_mul_f32 v242, v242, v239
v_mul_f32 v248, v248, v239
v_cvt_pk_bf16_f32 v173, v242, v248
v_lshlrev_b32 v242, 16, v174
v_and_b32 v248, 0xffff0000, v174
v_mul_f32 v242, v242, v239
v_mul_f32 v248, v248, v239
v_cvt_pk_bf16_f32 v174, v242, v248
v_lshlrev_b32 v242, 16, v175
v_and_b32 v248, 0xffff0000, v175
v_mul_f32 v242, v242, v239
v_mul_f32 v248, v248, v239
v_cvt_pk_bf16_f32 v175, v242, v248
v_lshlrev_b32 v242, 16, v188
v_and_b32 v248, 0xffff0000, v188
v_mul_f32 v242, v242, v239
v_mul_f32 v248, v248, v239
v_cvt_pk_bf16_f32 v188, v242, v248
v_lshlrev_b32 v242, 16, v189
v_and_b32 v248, 0xffff0000, v189
v_mul_f32 v242, v242, v239
v_mul_f32 v248, v248, v239
v_cvt_pk_bf16_f32 v189, v242, v248
v_lshlrev_b32 v242, 16, v190
v_and_b32 v248, 0xffff0000, v190
v_mul_f32 v242, v242, v239
v_mul_f32 v248, v248, v239
v_cvt_pk_bf16_f32 v190, v242, v248
v_lshlrev_b32 v242, 16, v191
v_and_b32 v248, 0xffff0000, v191
v_mul_f32 v242, v242, v239
v_mul_f32 v248, v248, v239
v_cvt_pk_bf16_f32 v191, v242, v248
v_lshlrev_b32 v242, 16, v96
v_and_b32 v248, 0xffff0000, v96
v_mul_f32 v242, v242, v239
v_mul_f32 v248, v248, v239
v_cvt_pk_bf16_f32 v96, v242, v248
v_lshlrev_b32 v242, 16, v97
v_and_b32 v248, 0xffff0000, v97
v_mul_f32 v242, v242, v239
v_mul_f32 v248, v248, v239
v_cvt_pk_bf16_f32 v97, v242, v248
v_exp_f32 v232, v156
v_exp_f32 v233, v157
v_exp_f32 v234, v158
v_exp_f32 v235, v159
s_nop 1
v_cvt_pk_bf16_f32 v98, v232, v233
v_cvt_pk_bf16_f32 v99, v234, v235
s_branch L2_rare_common
LF_hl_0:
s_mov_b32 s94, 0x10000
s_mov_b32 s3, 0x7c28000
LF_hl2_0:
v_lshlrev_b32 v241, 3, v243
buffer_load_dwordx2 v[240:241], v241, s[16:19], s3 offen sc1
s_sub_u32 s94, s94, 1
s_waitcnt vmcnt(0)
s_cbranch_scc1 LF_hlret_0
v_cmp_ne_u64_e64 s[38:39], s[98:99], v[240:241]
s_and_b64 s[38:39], s[38:39], s[96:97]
s_cbranch_scc1 LF_hl2_0
s_branch LF_hlret_0
L2_rare_common:
v_lshrrev_b32 v232, 4, v243
v_and_b32 v232, 0x30, v232
ds_bpermute_b32 v242, v232, v236 offset:0
ds_bpermute_b32 v248, v232, v236 offset:4
ds_bpermute_b32 v250, v232, v236 offset:8
ds_bpermute_b32 v251, v232, v236 offset:12
s_waitcnt lgkmcnt(0)
v_accvgpr_read_b32 v232, a0
v_accvgpr_read_b32 v233, a1
v_accvgpr_read_b32 v234, a2
v_accvgpr_read_b32 v235, a3
v_mul_f32 v232, v232, v242
v_mul_f32 v233, v233, v248
v_mul_f32 v234, v234, v250
v_mul_f32 v235, v235, v251
v_accvgpr_write_b32 a0, v232
v_accvgpr_write_b32 a1, v233
v_accvgpr_write_b32 a2, v234
v_accvgpr_write_b32 a3, v235
v_accvgpr_read_b32 v232, a16
v_accvgpr_read_b32 v233, a17
v_accvgpr_read_b32 v234, a18
v_accvgpr_read_b32 v235, a19
v_mul_f32 v232, v232, v242
v_mul_f32 v233, v233, v248
v_mul_f32 v234, v234, v250
v_mul_f32 v235, v235, v251
v_accvgpr_write_b32 a16, v232
v_accvgpr_write_b32 a17, v233
v_accvgpr_write_b32 a18, v234
v_accvgpr_write_b32 a19, v235
v_accvgpr_read_b32 v232, a32
v_accvgpr_read_b32 v233, a33
v_accvgpr_read_b32 v234, a34
v_accvgpr_read_b32 v235, a35
v_mul_f32 v232, v232, v242
v_mul_f32 v233, v233, v248
v_mul_f32 v234, v234, v250
v_mul_f32 v235, v235, v251
v_accvgpr_write_b32 a32, v232
v_accvgpr_write_b32 a33, v233
v_accvgpr_write_b32 a34, v234
v_accvgpr_write_b32 a35, v235
v_accvgpr_read_b32 v232, a48
v_accvgpr_read_b32 v233, a49
v_accvgpr_read_b32 v234, a50
v_accvgpr_read_b32 v235, a51
v_mul_f32 v232, v232, v242
v_mul_f32 v233, v233, v248
v_mul_f32 v234, v234, v250
v_mul_f32 v235, v235, v251
v_accvgpr_write_b32 a48, v232
v_accvgpr_write_b32 a49, v233
v_accvgpr_write_b32 a50, v234
v_accvgpr_write_b32 a51, v235
v_accvgpr_read_b32 v232, a64
v_accvgpr_read_b32 v233, a65
v_accvgpr_read_b32 v234, a66
v_accvgpr_read_b32 v235, a67
v_mul_f32 v232, v232, v242
v_mul_f32 v233, v233, v248
v_mul_f32 v234, v234, v250
v_mul_f32 v235, v235, v251
v_accvgpr_write_b32 a64, v232
v_accvgpr_write_b32 a65, v233
v_accvgpr_write_b32 a66, v234
v_accvgpr_write_b32 a67, v235
v_accvgpr_read_b32 v232, a80
v_accvgpr_read_b32 v233, a81
v_accvgpr_read_b32 v234, a82
v_accvgpr_read_b32 v235, a83
v_mul_f32 v232, v232, v242
v_mul_f32 v233, v233, v248
v_mul_f32 v234, v234, v250
v_mul_f32 v235, v235, v251
v_accvgpr_write_b32 a80, v232
v_accvgpr_write_b32 a81, v233
v_accvgpr_write_b32 a82, v234
v_accvgpr_write_b32 a83, v235
v_accvgpr_read_b32 v232, a96
v_accvgpr_read_b32 v233, a97
v_accvgpr_read_b32 v234, a98
v_accvgpr_read_b32 v235, a99
v_mul_f32 v232, v232, v242
v_mul_f32 v233, v233, v248
v_mul_f32 v234, v234, v250
v_mul_f32 v235, v235, v251
v_accvgpr_write_b32 a96, v232
v_accvgpr_write_b32 a97, v233
v_accvgpr_write_b32 a98, v234
v_accvgpr_write_b32 a99, v235
v_accvgpr_read_b32 v232, a112
v_accvgpr_read_b32 v233, a113
v_accvgpr_read_b32 v234, a114
v_accvgpr_read_b32 v235, a115
v_mul_f32 v232, v232, v242
v_mul_f32 v233, v233, v248
v_mul_f32 v234, v234, v250
v_mul_f32 v235, v235, v251
v_accvgpr_write_b32 a112, v232
v_accvgpr_write_b32 a113, v233
v_accvgpr_write_b32 a114, v234
v_accvgpr_write_b32 a115, v235
v_accvgpr_read_b32 v232, a128
v_accvgpr_read_b32 v233, a129
v_accvgpr_read_b32 v234, a130
v_accvgpr_read_b32 v235, a131
v_mul_f32 v232, v232, v242
v_mul_f32 v233, v233, v248
v_mul_f32 v234, v234, v250
v_mul_f32 v235, v235, v251
v_accvgpr_write_b32 a128, v232
v_accvgpr_write_b32 a129, v233
v_accvgpr_write_b32 a130, v234
v_accvgpr_write_b32 a131, v235
v_accvgpr_read_b32 v232, a144
v_accvgpr_read_b32 v233, a145
v_accvgpr_read_b32 v234, a146
v_accvgpr_read_b32 v235, a147
v_mul_f32 v232, v232, v242
v_mul_f32 v233, v233, v248
v_mul_f32 v234, v234, v250
v_mul_f32 v235, v235, v251
v_accvgpr_write_b32 a144, v232
v_accvgpr_write_b32 a145, v233
v_accvgpr_write_b32 a146, v234
v_accvgpr_write_b32 a147, v235
v_accvgpr_read_b32 v232, a160
v_accvgpr_read_b32 v233, a161
v_accvgpr_read_b32 v234, a162
v_accvgpr_read_b32 v235, a163
v_mul_f32 v232, v232, v242
v_mul_f32 v233, v233, v248
v_mul_f32 v234, v234, v250
v_mul_f32 v235, v235, v251
v_accvgpr_write_b32 a160, v232
v_accvgpr_write_b32 a161, v233
v_accvgpr_write_b32 a162, v234
v_accvgpr_write_b32 a163, v235
v_accvgpr_read_b32 v232, a176
v_accvgpr_read_b32 v233, a177
v_accvgpr_read_b32 v234, a178
v_accvgpr_read_b32 v235, a179
v_mul_f32 v232, v232, v242
v_mul_f32 v233, v233, v248
v_mul_f32 v234, v234, v250
v_mul_f32 v235, v235, v251
v_accvgpr_write_b32 a176, v232
v_accvgpr_write_b32 a177, v233
v_accvgpr_write_b32 a178, v234
v_accvgpr_write_b32 a179, v235
v_accvgpr_read_b32 v232, a192
v_accvgpr_read_b32 v233, a193
v_accvgpr_read_b32 v234, a194
v_accvgpr_read_b32 v235, a195
v_mul_f32 v232, v232, v242
v_mul_f32 v233, v233, v248
v_mul_f32 v234, v234, v250
v_mul_f32 v235, v235, v251
v_accvgpr_write_b32 a192, v232
v_accvgpr_write_b32 a193, v233
v_accvgpr_write_b32 a194, v234
v_accvgpr_write_b32 a195, v235
v_accvgpr_read_b32 v232, a208
v_accvgpr_read_b32 v233, a209
v_accvgpr_read_b32 v234, a210
v_accvgpr_read_b32 v235, a211
v_mul_f32 v232, v232, v242
v_mul_f32 v233, v233, v248
v_mul_f32 v234, v234, v250
v_mul_f32 v235, v235, v251
v_accvgpr_write_b32 a208, v232
v_accvgpr_write_b32 a209, v233
v_accvgpr_write_b32 a210, v234
v_accvgpr_write_b32 a211, v235
v_accvgpr_read_b32 v232, a224
v_accvgpr_read_b32 v233, a225
v_accvgpr_read_b32 v234, a226
v_accvgpr_read_b32 v235, a227
v_mul_f32 v232, v232, v242
v_mul_f32 v233, v233, v248
v_mul_f32 v234, v234, v250
v_mul_f32 v235, v235, v251
v_accvgpr_write_b32 a224, v232
v_accvgpr_write_b32 a225, v233
v_accvgpr_write_b32 a226, v234
v_accvgpr_write_b32 a227, v235
v_accvgpr_read_b32 v232, a240
v_accvgpr_read_b32 v233, a241
v_accvgpr_read_b32 v234, a242
v_accvgpr_read_b32 v235, a243
v_mul_f32 v232, v232, v242
v_mul_f32 v233, v233, v248
v_mul_f32 v234, v234, v250
v_mul_f32 v235, v235, v251
v_accvgpr_write_b32 a240, v232
v_accvgpr_write_b32 a241, v233
v_accvgpr_write_b32 a242, v234
v_accvgpr_write_b32 a243, v235
v_lshrrev_b32 v232, 4, v243
v_and_b32 v232, 0x30, v232
ds_bpermute_b32 v242, v232, v237 offset:0
ds_bpermute_b32 v248, v232, v237 offset:4
ds_bpermute_b32 v250, v232, v237 offset:8
ds_bpermute_b32 v251, v232, v237 offset:12
s_waitcnt lgkmcnt(0)
v_accvgpr_read_b32 v232, a4
v_accvgpr_read_b32 v233, a5
v_accvgpr_read_b32 v234, a6
v_accvgpr_read_b32 v235, a7
v_mul_f32 v232, v232, v242
v_mul_f32 v233, v233, v248
v_mul_f32 v234, v234, v250
v_mul_f32 v235, v235, v251
v_accvgpr_write_b32 a4, v232
v_accvgpr_write_b32 a5, v233
v_accvgpr_write_b32 a6, v234
v_accvgpr_write_b32 a7, v235
v_accvgpr_read_b32 v232, a20
v_accvgpr_read_b32 v233, a21
v_accvgpr_read_b32 v234, a22
v_accvgpr_read_b32 v235, a23
v_mul_f32 v232, v232, v242
v_mul_f32 v233, v233, v248
v_mul_f32 v234, v234, v250
v_mul_f32 v235, v235, v251
v_accvgpr_write_b32 a20, v232
v_accvgpr_write_b32 a21, v233
v_accvgpr_write_b32 a22, v234
v_accvgpr_write_b32 a23, v235
v_accvgpr_read_b32 v232, a36
v_accvgpr_read_b32 v233, a37
v_accvgpr_read_b32 v234, a38
v_accvgpr_read_b32 v235, a39
v_mul_f32 v232, v232, v242
v_mul_f32 v233, v233, v248
v_mul_f32 v234, v234, v250
v_mul_f32 v235, v235, v251
v_accvgpr_write_b32 a36, v232
v_accvgpr_write_b32 a37, v233
v_accvgpr_write_b32 a38, v234
v_accvgpr_write_b32 a39, v235
v_accvgpr_read_b32 v232, a52
v_accvgpr_read_b32 v233, a53
v_accvgpr_read_b32 v234, a54
v_accvgpr_read_b32 v235, a55
v_mul_f32 v232, v232, v242
v_mul_f32 v233, v233, v248
v_mul_f32 v234, v234, v250
v_mul_f32 v235, v235, v251
v_accvgpr_write_b32 a52, v232
v_accvgpr_write_b32 a53, v233
v_accvgpr_write_b32 a54, v234
v_accvgpr_write_b32 a55, v235
v_accvgpr_read_b32 v232, a68
v_accvgpr_read_b32 v233, a69
v_accvgpr_read_b32 v234, a70
v_accvgpr_read_b32 v235, a71
v_mul_f32 v232, v232, v242
v_mul_f32 v233, v233, v248
v_mul_f32 v234, v234, v250
v_mul_f32 v235, v235, v251
v_accvgpr_write_b32 a68, v232
v_accvgpr_write_b32 a69, v233
v_accvgpr_write_b32 a70, v234
v_accvgpr_write_b32 a71, v235
v_accvgpr_read_b32 v232, a84
v_accvgpr_read_b32 v233, a85
v_accvgpr_read_b32 v234, a86
v_accvgpr_read_b32 v235, a87
v_mul_f32 v232, v232, v242
v_mul_f32 v233, v233, v248
v_mul_f32 v234, v234, v250
v_mul_f32 v235, v235, v251
v_accvgpr_write_b32 a84, v232
v_accvgpr_write_b32 a85, v233
v_accvgpr_write_b32 a86, v234
v_accvgpr_write_b32 a87, v235
v_accvgpr_read_b32 v232, a100
v_accvgpr_read_b32 v233, a101
v_accvgpr_read_b32 v234, a102
v_accvgpr_read_b32 v235, a103
v_mul_f32 v232, v232, v242
v_mul_f32 v233, v233, v248
v_mul_f32 v234, v234, v250
v_mul_f32 v235, v235, v251
v_accvgpr_write_b32 a100, v232
v_accvgpr_write_b32 a101, v233
v_accvgpr_write_b32 a102, v234
v_accvgpr_write_b32 a103, v235
v_accvgpr_read_b32 v232, a116
v_accvgpr_read_b32 v233, a117
v_accvgpr_read_b32 v234, a118
v_accvgpr_read_b32 v235, a119
v_mul_f32 v232, v232, v242
v_mul_f32 v233, v233, v248
v_mul_f32 v234, v234, v250
v_mul_f32 v235, v235, v251
v_accvgpr_write_b32 a116, v232
v_accvgpr_write_b32 a117, v233
v_accvgpr_write_b32 a118, v234
v_accvgpr_write_b32 a119, v235
v_accvgpr_read_b32 v232, a132
v_accvgpr_read_b32 v233, a133
v_accvgpr_read_b32 v234, a134
v_accvgpr_read_b32 v235, a135
v_mul_f32 v232, v232, v242
v_mul_f32 v233, v233, v248
v_mul_f32 v234, v234, v250
v_mul_f32 v235, v235, v251
v_accvgpr_write_b32 a132, v232
v_accvgpr_write_b32 a133, v233
v_accvgpr_write_b32 a134, v234
v_accvgpr_write_b32 a135, v235
v_accvgpr_read_b32 v232, a148
v_accvgpr_read_b32 v233, a149
v_accvgpr_read_b32 v234, a150
v_accvgpr_read_b32 v235, a151
v_mul_f32 v232, v232, v242
v_mul_f32 v233, v233, v248
v_mul_f32 v234, v234, v250
v_mul_f32 v235, v235, v251
v_accvgpr_write_b32 a148, v232
v_accvgpr_write_b32 a149, v233
v_accvgpr_write_b32 a150, v234
v_accvgpr_write_b32 a151, v235
v_accvgpr_read_b32 v232, a164
v_accvgpr_read_b32 v233, a165
v_accvgpr_read_b32 v234, a166
v_accvgpr_read_b32 v235, a167
v_mul_f32 v232, v232, v242
v_mul_f32 v233, v233, v248
v_mul_f32 v234, v234, v250
v_mul_f32 v235, v235, v251
v_accvgpr_write_b32 a164, v232
v_accvgpr_write_b32 a165, v233
v_accvgpr_write_b32 a166, v234
v_accvgpr_write_b32 a167, v235
v_accvgpr_read_b32 v232, a180
v_accvgpr_read_b32 v233, a181
v_accvgpr_read_b32 v234, a182
v_accvgpr_read_b32 v235, a183
v_mul_f32 v232, v232, v242
v_mul_f32 v233, v233, v248
v_mul_f32 v234, v234, v250
v_mul_f32 v235, v235, v251
v_accvgpr_write_b32 a180, v232
v_accvgpr_write_b32 a181, v233
v_accvgpr_write_b32 a182, v234
v_accvgpr_write_b32 a183, v235
v_accvgpr_read_b32 v232, a196
v_accvgpr_read_b32 v233, a197
v_accvgpr_read_b32 v234, a198
v_accvgpr_read_b32 v235, a199
v_mul_f32 v232, v232, v242
v_mul_f32 v233, v233, v248
v_mul_f32 v234, v234, v250
v_mul_f32 v235, v235, v251
v_accvgpr_write_b32 a196, v232
v_accvgpr_write_b32 a197, v233
v_accvgpr_write_b32 a198, v234
v_accvgpr_write_b32 a199, v235
v_accvgpr_read_b32 v232, a212
v_accvgpr_read_b32 v233, a213
v_accvgpr_read_b32 v234, a214
v_accvgpr_read_b32 v235, a215
v_mul_f32 v232, v232, v242
v_mul_f32 v233, v233, v248
v_mul_f32 v234, v234, v250
v_mul_f32 v235, v235, v251
v_accvgpr_write_b32 a212, v232
v_accvgpr_write_b32 a213, v233
v_accvgpr_write_b32 a214, v234
v_accvgpr_write_b32 a215, v235
v_accvgpr_read_b32 v232, a228
v_accvgpr_read_b32 v233, a229
v_accvgpr_read_b32 v234, a230
v_accvgpr_read_b32 v235, a231
v_mul_f32 v232, v232, v242
v_mul_f32 v233, v233, v248
v_mul_f32 v234, v234, v250
v_mul_f32 v235, v235, v251
v_accvgpr_write_b32 a228, v232
v_accvgpr_write_b32 a229, v233
v_accvgpr_write_b32 a230, v234
v_accvgpr_write_b32 a231, v235
v_accvgpr_read_b32 v232, a244
v_accvgpr_read_b32 v233, a245
v_accvgpr_read_b32 v234, a246
v_accvgpr_read_b32 v235, a247
v_mul_f32 v232, v232, v242
v_mul_f32 v233, v233, v248
v_mul_f32 v234, v234, v250
v_mul_f32 v235, v235, v251
v_accvgpr_write_b32 a244, v232
v_accvgpr_write_b32 a245, v233
v_accvgpr_write_b32 a246, v234
v_accvgpr_write_b32 a247, v235
v_lshrrev_b32 v232, 4, v243
v_and_b32 v232, 0x30, v232
ds_bpermute_b32 v242, v232, v238 offset:0
ds_bpermute_b32 v248, v232, v238 offset:4
ds_bpermute_b32 v250, v232, v238 offset:8
ds_bpermute_b32 v251, v232, v238 offset:12
s_waitcnt lgkmcnt(0)
v_accvgpr_read_b32 v232, a8
v_accvgpr_read_b32 v233, a9
v_accvgpr_read_b32 v234, a10
v_accvgpr_read_b32 v235, a11
v_mul_f32 v232, v232, v242
v_mul_f32 v233, v233, v248
v_mul_f32 v234, v234, v250
v_mul_f32 v235, v235, v251
v_accvgpr_write_b32 a8, v232
v_accvgpr_write_b32 a9, v233
v_accvgpr_write_b32 a10, v234
v_accvgpr_write_b32 a11, v235
v_accvgpr_read_b32 v232, a24
v_accvgpr_read_b32 v233, a25
v_accvgpr_read_b32 v234, a26
v_accvgpr_read_b32 v235, a27
v_mul_f32 v232, v232, v242
v_mul_f32 v233, v233, v248
v_mul_f32 v234, v234, v250
v_mul_f32 v235, v235, v251
v_accvgpr_write_b32 a24, v232
v_accvgpr_write_b32 a25, v233
v_accvgpr_write_b32 a26, v234
v_accvgpr_write_b32 a27, v235
v_accvgpr_read_b32 v232, a40
v_accvgpr_read_b32 v233, a41
v_accvgpr_read_b32 v234, a42
v_accvgpr_read_b32 v235, a43
v_mul_f32 v232, v232, v242
v_mul_f32 v233, v233, v248
v_mul_f32 v234, v234, v250
v_mul_f32 v235, v235, v251
v_accvgpr_write_b32 a40, v232
v_accvgpr_write_b32 a41, v233
v_accvgpr_write_b32 a42, v234
v_accvgpr_write_b32 a43, v235
v_accvgpr_read_b32 v232, a56
v_accvgpr_read_b32 v233, a57
v_accvgpr_read_b32 v234, a58
v_accvgpr_read_b32 v235, a59
v_mul_f32 v232, v232, v242
v_mul_f32 v233, v233, v248
v_mul_f32 v234, v234, v250
v_mul_f32 v235, v235, v251
v_accvgpr_write_b32 a56, v232
v_accvgpr_write_b32 a57, v233
v_accvgpr_write_b32 a58, v234
v_accvgpr_write_b32 a59, v235
v_accvgpr_read_b32 v232, a72
v_accvgpr_read_b32 v233, a73
v_accvgpr_read_b32 v234, a74
v_accvgpr_read_b32 v235, a75
v_mul_f32 v232, v232, v242
v_mul_f32 v233, v233, v248
v_mul_f32 v234, v234, v250
v_mul_f32 v235, v235, v251
v_accvgpr_write_b32 a72, v232
v_accvgpr_write_b32 a73, v233
v_accvgpr_write_b32 a74, v234
v_accvgpr_write_b32 a75, v235
v_accvgpr_read_b32 v232, a88
v_accvgpr_read_b32 v233, a89
v_accvgpr_read_b32 v234, a90
v_accvgpr_read_b32 v235, a91
v_mul_f32 v232, v232, v242
v_mul_f32 v233, v233, v248
v_mul_f32 v234, v234, v250
v_mul_f32 v235, v235, v251
v_accvgpr_write_b32 a88, v232
v_accvgpr_write_b32 a89, v233
v_accvgpr_write_b32 a90, v234
v_accvgpr_write_b32 a91, v235
v_accvgpr_read_b32 v232, a104
v_accvgpr_read_b32 v233, a105
v_accvgpr_read_b32 v234, a106
v_accvgpr_read_b32 v235, a107
v_mul_f32 v232, v232, v242
v_mul_f32 v233, v233, v248
v_mul_f32 v234, v234, v250
v_mul_f32 v235, v235, v251
v_accvgpr_write_b32 a104, v232
v_accvgpr_write_b32 a105, v233
v_accvgpr_write_b32 a106, v234
v_accvgpr_write_b32 a107, v235
v_accvgpr_read_b32 v232, a120
v_accvgpr_read_b32 v233, a121
v_accvgpr_read_b32 v234, a122
v_accvgpr_read_b32 v235, a123
v_mul_f32 v232, v232, v242
v_mul_f32 v233, v233, v248
v_mul_f32 v234, v234, v250
v_mul_f32 v235, v235, v251
v_accvgpr_write_b32 a120, v232
v_accvgpr_write_b32 a121, v233
v_accvgpr_write_b32 a122, v234
v_accvgpr_write_b32 a123, v235
v_accvgpr_read_b32 v232, a136
v_accvgpr_read_b32 v233, a137
v_accvgpr_read_b32 v234, a138
v_accvgpr_read_b32 v235, a139
v_mul_f32 v232, v232, v242
v_mul_f32 v233, v233, v248
v_mul_f32 v234, v234, v250
v_mul_f32 v235, v235, v251
v_accvgpr_write_b32 a136, v232
v_accvgpr_write_b32 a137, v233
v_accvgpr_write_b32 a138, v234
v_accvgpr_write_b32 a139, v235
v_accvgpr_read_b32 v232, a152
v_accvgpr_read_b32 v233, a153
v_accvgpr_read_b32 v234, a154
v_accvgpr_read_b32 v235, a155
v_mul_f32 v232, v232, v242
v_mul_f32 v233, v233, v248
v_mul_f32 v234, v234, v250
v_mul_f32 v235, v235, v251
v_accvgpr_write_b32 a152, v232
v_accvgpr_write_b32 a153, v233
v_accvgpr_write_b32 a154, v234
v_accvgpr_write_b32 a155, v235
v_accvgpr_read_b32 v232, a168
v_accvgpr_read_b32 v233, a169
v_accvgpr_read_b32 v234, a170
v_accvgpr_read_b32 v235, a171
v_mul_f32 v232, v232, v242
v_mul_f32 v233, v233, v248
v_mul_f32 v234, v234, v250
v_mul_f32 v235, v235, v251
v_accvgpr_write_b32 a168, v232
v_accvgpr_write_b32 a169, v233
v_accvgpr_write_b32 a170, v234
v_accvgpr_write_b32 a171, v235
v_accvgpr_read_b32 v232, a184
v_accvgpr_read_b32 v233, a185
v_accvgpr_read_b32 v234, a186
v_accvgpr_read_b32 v235, a187
v_mul_f32 v232, v232, v242
v_mul_f32 v233, v233, v248
v_mul_f32 v234, v234, v250
v_mul_f32 v235, v235, v251
v_accvgpr_write_b32 a184, v232
v_accvgpr_write_b32 a185, v233
v_accvgpr_write_b32 a186, v234
v_accvgpr_write_b32 a187, v235
v_accvgpr_read_b32 v232, a200
v_accvgpr_read_b32 v233, a201
v_accvgpr_read_b32 v234, a202
v_accvgpr_read_b32 v235, a203
v_mul_f32 v232, v232, v242
v_mul_f32 v233, v233, v248
v_mul_f32 v234, v234, v250
v_mul_f32 v235, v235, v251
v_accvgpr_write_b32 a200, v232
v_accvgpr_write_b32 a201, v233
v_accvgpr_write_b32 a202, v234
v_accvgpr_write_b32 a203, v235
v_accvgpr_read_b32 v232, a216
v_accvgpr_read_b32 v233, a217
v_accvgpr_read_b32 v234, a218
v_accvgpr_read_b32 v235, a219
v_mul_f32 v232, v232, v242
v_mul_f32 v233, v233, v248
v_mul_f32 v234, v234, v250
v_mul_f32 v235, v235, v251
v_accvgpr_write_b32 a216, v232
v_accvgpr_write_b32 a217, v233
v_accvgpr_write_b32 a218, v234
v_accvgpr_write_b32 a219, v235
v_accvgpr_read_b32 v232, a232
v_accvgpr_read_b32 v233, a233
v_accvgpr_read_b32 v234, a234
v_accvgpr_read_b32 v235, a235
v_mul_f32 v232, v232, v242
v_mul_f32 v233, v233, v248
v_mul_f32 v234, v234, v250
v_mul_f32 v235, v235, v251
v_accvgpr_write_b32 a232, v232
v_accvgpr_write_b32 a233, v233
v_accvgpr_write_b32 a234, v234
v_accvgpr_write_b32 a235, v235
v_accvgpr_read_b32 v232, a248
v_accvgpr_read_b32 v233, a249
v_accvgpr_read_b32 v234, a250
v_accvgpr_read_b32 v235, a251
v_mul_f32 v232, v232, v242
v_mul_f32 v233, v233, v248
v_mul_f32 v234, v234, v250
v_mul_f32 v235, v235, v251
v_accvgpr_write_b32 a248, v232
v_accvgpr_write_b32 a249, v233
v_accvgpr_write_b32 a250, v234
v_accvgpr_write_b32 a251, v235
v_lshrrev_b32 v232, 4, v243
v_and_b32 v232, 0x30, v232
ds_bpermute_b32 v242, v232, v239 offset:0
ds_bpermute_b32 v248, v232, v239 offset:4
ds_bpermute_b32 v250, v232, v239 offset:8
ds_bpermute_b32 v251, v232, v239 offset:12
s_waitcnt lgkmcnt(0)
v_accvgpr_read_b32 v232, a12
v_accvgpr_read_b32 v233, a13
v_accvgpr_read_b32 v234, a14
v_accvgpr_read_b32 v235, a15
v_mul_f32 v232, v232, v242
v_mul_f32 v233, v233, v248
v_mul_f32 v234, v234, v250
v_mul_f32 v235, v235, v251
v_accvgpr_write_b32 a12, v232
v_accvgpr_write_b32 a13, v233
v_accvgpr_write_b32 a14, v234
v_accvgpr_write_b32 a15, v235
v_accvgpr_read_b32 v232, a28
v_accvgpr_read_b32 v233, a29
v_accvgpr_read_b32 v234, a30
v_accvgpr_read_b32 v235, a31
v_mul_f32 v232, v232, v242
v_mul_f32 v233, v233, v248
v_mul_f32 v234, v234, v250
v_mul_f32 v235, v235, v251
v_accvgpr_write_b32 a28, v232
v_accvgpr_write_b32 a29, v233
v_accvgpr_write_b32 a30, v234
v_accvgpr_write_b32 a31, v235
v_accvgpr_read_b32 v232, a44
v_accvgpr_read_b32 v233, a45
v_accvgpr_read_b32 v234, a46
v_accvgpr_read_b32 v235, a47
v_mul_f32 v232, v232, v242
v_mul_f32 v233, v233, v248
v_mul_f32 v234, v234, v250
v_mul_f32 v235, v235, v251
v_accvgpr_write_b32 a44, v232
v_accvgpr_write_b32 a45, v233
v_accvgpr_write_b32 a46, v234
v_accvgpr_write_b32 a47, v235
v_accvgpr_read_b32 v232, a60
v_accvgpr_read_b32 v233, a61
v_accvgpr_read_b32 v234, a62
v_accvgpr_read_b32 v235, a63
v_mul_f32 v232, v232, v242
v_mul_f32 v233, v233, v248
v_mul_f32 v234, v234, v250
v_mul_f32 v235, v235, v251
v_accvgpr_write_b32 a60, v232
v_accvgpr_write_b32 a61, v233
v_accvgpr_write_b32 a62, v234
v_accvgpr_write_b32 a63, v235
v_accvgpr_read_b32 v232, a76
v_accvgpr_read_b32 v233, a77
v_accvgpr_read_b32 v234, a78
v_accvgpr_read_b32 v235, a79
v_mul_f32 v232, v232, v242
v_mul_f32 v233, v233, v248
v_mul_f32 v234, v234, v250
v_mul_f32 v235, v235, v251
v_accvgpr_write_b32 a76, v232
v_accvgpr_write_b32 a77, v233
v_accvgpr_write_b32 a78, v234
v_accvgpr_write_b32 a79, v235
v_accvgpr_read_b32 v232, a92
v_accvgpr_read_b32 v233, a93
v_accvgpr_read_b32 v234, a94
v_accvgpr_read_b32 v235, a95
v_mul_f32 v232, v232, v242
v_mul_f32 v233, v233, v248
v_mul_f32 v234, v234, v250
v_mul_f32 v235, v235, v251
v_accvgpr_write_b32 a92, v232
v_accvgpr_write_b32 a93, v233
v_accvgpr_write_b32 a94, v234
v_accvgpr_write_b32 a95, v235
v_accvgpr_read_b32 v232, a108
v_accvgpr_read_b32 v233, a109
v_accvgpr_read_b32 v234, a110
v_accvgpr_read_b32 v235, a111
v_mul_f32 v232, v232, v242
v_mul_f32 v233, v233, v248
v_mul_f32 v234, v234, v250
v_mul_f32 v235, v235, v251
v_accvgpr_write_b32 a108, v232
v_accvgpr_write_b32 a109, v233
v_accvgpr_write_b32 a110, v234
v_accvgpr_write_b32 a111, v235
v_accvgpr_read_b32 v232, a124
v_accvgpr_read_b32 v233, a125
v_accvgpr_read_b32 v234, a126
v_accvgpr_read_b32 v235, a127
v_mul_f32 v232, v232, v242
v_mul_f32 v233, v233, v248
v_mul_f32 v234, v234, v250
v_mul_f32 v235, v235, v251
v_accvgpr_write_b32 a124, v232
v_accvgpr_write_b32 a125, v233
v_accvgpr_write_b32 a126, v234
v_accvgpr_write_b32 a127, v235
v_accvgpr_read_b32 v232, a140
v_accvgpr_read_b32 v233, a141
v_accvgpr_read_b32 v234, a142
v_accvgpr_read_b32 v235, a143
v_mul_f32 v232, v232, v242
v_mul_f32 v233, v233, v248
v_mul_f32 v234, v234, v250
v_mul_f32 v235, v235, v251
v_accvgpr_write_b32 a140, v232
v_accvgpr_write_b32 a141, v233
v_accvgpr_write_b32 a142, v234
v_accvgpr_write_b32 a143, v235
v_accvgpr_read_b32 v232, a156
v_accvgpr_read_b32 v233, a157
v_accvgpr_read_b32 v234, a158
v_accvgpr_read_b32 v235, a159
v_mul_f32 v232, v232, v242
v_mul_f32 v233, v233, v248
v_mul_f32 v234, v234, v250
v_mul_f32 v235, v235, v251
v_accvgpr_write_b32 a156, v232
v_accvgpr_write_b32 a157, v233
v_accvgpr_write_b32 a158, v234
v_accvgpr_write_b32 a159, v235
v_accvgpr_read_b32 v232, a172
v_accvgpr_read_b32 v233, a173
v_accvgpr_read_b32 v234, a174
v_accvgpr_read_b32 v235, a175
v_mul_f32 v232, v232, v242
v_mul_f32 v233, v233, v248
v_mul_f32 v234, v234, v250
v_mul_f32 v235, v235, v251
v_accvgpr_write_b32 a172, v232
v_accvgpr_write_b32 a173, v233
v_accvgpr_write_b32 a174, v234
v_accvgpr_write_b32 a175, v235
v_accvgpr_read_b32 v232, a188
v_accvgpr_read_b32 v233, a189
v_accvgpr_read_b32 v234, a190
v_accvgpr_read_b32 v235, a191
v_mul_f32 v232, v232, v242
v_mul_f32 v233, v233, v248
v_mul_f32 v234, v234, v250
v_mul_f32 v235, v235, v251
v_accvgpr_write_b32 a188, v232
v_accvgpr_write_b32 a189, v233
v_accvgpr_write_b32 a190, v234
v_accvgpr_write_b32 a191, v235
v_accvgpr_read_b32 v232, a204
v_accvgpr_read_b32 v233, a205
v_accvgpr_read_b32 v234, a206
v_accvgpr_read_b32 v235, a207
v_mul_f32 v232, v232, v242
v_mul_f32 v233, v233, v248
v_mul_f32 v234, v234, v250
v_mul_f32 v235, v235, v251
v_accvgpr_write_b32 a204, v232
v_accvgpr_write_b32 a205, v233
v_accvgpr_write_b32 a206, v234
v_accvgpr_write_b32 a207, v235
v_accvgpr_read_b32 v232, a220
v_accvgpr_read_b32 v233, a221
v_accvgpr_read_b32 v234, a222
v_accvgpr_read_b32 v235, a223
v_mul_f32 v232, v232, v242
v_mul_f32 v233, v233, v248
v_mul_f32 v234, v234, v250
v_mul_f32 v235, v235, v251
v_accvgpr_write_b32 a220, v232
v_accvgpr_write_b32 a221, v233
v_accvgpr_write_b32 a222, v234
v_accvgpr_write_b32 a223, v235
v_accvgpr_read_b32 v232, a236
v_accvgpr_read_b32 v233, a237
v_accvgpr_read_b32 v234, a238
v_accvgpr_read_b32 v235, a239
v_mul_f32 v232, v232, v242
v_mul_f32 v233, v233, v248
v_mul_f32 v234, v234, v250
v_mul_f32 v235, v235, v251
v_accvgpr_write_b32 a236, v232
v_accvgpr_write_b32 a237, v233
v_accvgpr_write_b32 a238, v234
v_accvgpr_write_b32 a239, v235
v_accvgpr_read_b32 v232, a252
v_accvgpr_read_b32 v233, a253
v_accvgpr_read_b32 v234, a254
v_accvgpr_read_b32 v235, a255
v_mul_f32 v232, v232, v242
v_mul_f32 v233, v233, v248
v_mul_f32 v234, v234, v250
v_mul_f32 v235, v235, v251
v_accvgpr_write_b32 a252, v232
v_accvgpr_write_b32 a253, v233
v_accvgpr_write_b32 a254, v234
v_accvgpr_write_b32 a255, v235
s_nop 3
s_cmp_eq_u32 s36, 0
s_cbranch_scc1 L2_rr0
s_cmp_eq_u32 s36, 1
s_cbranch_scc1 L2_rr1
s_cmp_eq_u32 s36, 2
s_cbranch_scc1 L2_rr2
s_cmp_eq_u32 s36, 3
s_cbranch_scc1 L2_rr3
s_cmp_eq_u32 s36, 4
s_cbranch_scc1 L2_rr4
s_cmp_eq_u32 s36, 5
s_cbranch_scc1 L2_rr5
s_cmp_eq_u32 s36, 6
s_cbranch_scc1 L2_rr6
s_cmp_eq_u32 s36, 7
s_cbranch_scc1 L2_rr7
s_cmp_eq_u32 s36, 8
s_cbranch_scc1 L2_rr8
s_cmp_eq_u32 s36, 9
s_cbranch_scc1 L2_rr9
s_cmp_eq_u32 s36, 10
s_cbranch_scc1 L2_rr10
s_cmp_eq_u32 s36, 11
s_cbranch_scc1 L2_rr11
s_cmp_eq_u32 s36, 12
s_cbranch_scc1 L2_rr12
s_cmp_eq_u32 s36, 13
s_cbranch_scc1 L2_rr13
s_cmp_eq_u32 s36, 14
s_cbranch_scc1 L2_rr14
s_cmp_eq_u32 s36, 15
s_cbranch_scc1 L2_rr15
s_cmp_eq_u32 s36, 16
s_cbranch_scc1 L2_rr16
L2_rr17:
s_waitcnt lgkmcnt(0)
s_branch L2_ret17
L2_rr16:
s_waitcnt lgkmcnt(0)
s_branch L2_ret16
L2_rr15:
s_waitcnt lgkmcnt(0)
s_branch L2_ret15
L2_rr14:
s_waitcnt lgkmcnt(0)
s_branch L2_ret14
L2_rr13:
s_waitcnt lgkmcnt(0)
s_branch L2_ret13
L2_rr12:
s_waitcnt lgkmcnt(0)
s_branch L2_ret12
L2_rr11:
s_waitcnt lgkmcnt(0)
s_branch L2_ret11
L2_rr10:
s_waitcnt lgkmcnt(0)
s_branch L2_ret10
L2_rr9:
s_waitcnt lgkmcnt(0)
s_branch L2_ret9
L2_rr8:
s_waitcnt lgkmcnt(0)
s_branch L2_ret8
L2_rr7:
s_waitcnt lgkmcnt(0)
s_branch L2_ret7
L2_rr6:
s_waitcnt lgkmcnt(0)
s_branch L2_ret6
L2_rr5:
s_waitcnt lgkmcnt(0)
s_branch L2_ret5
L2_rr4:
s_waitcnt lgkmcnt(0)
s_branch L2_ret4
L2_rr3:
s_waitcnt lgkmcnt(0)
s_branch L2_ret3
L2_rr2:
s_waitcnt lgkmcnt(0)
s_branch L2_ret2
L2_rr1:
s_waitcnt lgkmcnt(0)
s_branch L2_ret1
L2_rr0:
s_waitcnt lgkmcnt(0)
s_branch L2_ret0
s_endpgm
.section .rodata,"a"
.p2align 6
.amdhsa_kernel standalone__hybrid_graph_tf_graphgps__graph_kernel
  .amdhsa_next_free_vgpr 512
  .amdhsa_next_free_sgpr 102
  .amdhsa_accum_offset 256
  .amdhsa_group_segment_fixed_size 0
  .amdhsa_kernarg_size 96
  .amdhsa_user_sgpr_count 2
  .amdhsa_user_sgpr_kernarg_segment_ptr 1
  .amdhsa_system_sgpr_workgroup_id_x 1
.end_amdhsa_kernel
```

```asm
; @launch grid=(256,1,1) block=(256,1,1) lds=163840
.amdgcn_target "amdgcn-amd-amdhsa--gfx950"
.text
.globl standalone__hybrid_graph_tf_graphgps__graph_kernel
.p2align 8
.type standalone__hybrid_graph_tf_graphgps__graph_kernel,@function
standalone__hybrid_graph_tf_graphgps__graph_kernel:
s_getpc_b64 s[56:57]
s_load_dwordx16 s[16:31], s[0:1], 0
s_load_dwordx8 s[32:39], s[0:1], 64
s_cmp_ge_u32 s2, 256
s_cbranch_scc1 L2_end
v_lshrrev_b32 v1, 6, v0
v_and_b32 v2, 63, v0
s_lshr_b32 s3, s2, 3
s_add_u32 s3, s3, 30
s_and_b32 s3, s3, 31
v_readfirstlane_b32 s60, v1
s_lshl_b32 s5, s3, 2
s_add_u32 s5, s5, s60
s_and_b32 s56, s56, 0xffffff00
s_mov_b32 s58, L2_hot-standalone__hybrid_graph_tf_graphgps__graph_kernel
s_mov_b32 s59, 0x00020000
s_and_b32 s6, s5, 15
s_lshl_b32 s6, s6, 13
s_cmp_lt_u32 s5, 32
s_cselect_b32 s6, s6, 0x7fff0000
v_lshlrev_b32 v10, 7, v2
buffer_load_dword v255, v10, s[56:59], s6 offen
v_and_b32 v3, 15, v2
v_lshrrev_b32 v4, 4, v2
s_and_b32 s62, s3, 7
s_mov_b64 s[14:15], 0
s_and_b32 s8, s2, 7
s_cmp_ge_u32 s3, 30
s_cbranch_scc1 LM_edge
s_mul_i32 s12, s3, 26
s_lshr_b32 s12, s12, 8
s_mul_i32 s9, s12, 10
s_sub_u32 s9, s3, s9
s_and_b32 s13, s8, 1
s_mul_i32 s13, s13, 3
s_add_u32 s13, s13, s12
s_and_b32 s12, s8, 1
s_mul_i32 s12, s12, 5
s_add_u32 s8, s8, s12
s_and_b32 s8, s8, 7
s_lshr_b32 s12, s8, 1
s_mul_i32 s12, s12, 10
s_add_u32 s12, s12, s9
s_mul_i32 s91, s12, 6
s_add_u32 s91, s91, s13
s_mov_b32 s61, 0
s_cmp_eq_u32 s12, 39
s_cbranch_scc1 LM_light
s_mul_i32 s14, s13, 3
s_min_u32 s14, s14, 14
s_lshl_b32 s9, s12, 4
s_add_u32 s14, s14, s9
s_lshl_b32 s14, s14, 13
s_cmp_eq_u32 s91, 233
s_cselect_b32 s9, 0, s13
s_cmp_lt_u32 s9, 4
s_cselect_b32 s15, 3, 2
s_lshl_b32 s15, s15, 13
s_add_u32 s15, s15, s14
v_lshlrev_b32 v16, 4, v2
s_mul_i32 s63, s60, 12288
s_mov_b32 s6, s14
s_mul_i32 s7, s60, 6144
s_add_u32 s64, s6, s7
s_add_u32 s65, s64, 4096
s_lshl_b32 s7, s60, 7
v_lshrrev_b32 v5, 3, v2
v_and_b32 v6, 7, v2
v_and_b32 v7, 2, v5
v_xor_b32 v6, v6, v7
v_lshl_add_u32 v5, v5, 9, s7
v_lshl_add_u32 v17, v6, 4, v5
v_xor_b32 v6, 4, v6
v_lshl_add_u32 v18, v6, 4, v5
v_add_u32 v18, 0xc00, v18
v_add_u32 v19, 0x1800, v17
v_add_u32 v20, 0x1800, v18
s_xor_b32 s6, s62, 0
s_lshl_b32 s66, s6, 14
s_xor_b32 s6, s62, 1
s_lshl_b32 s67, s6, 14
s_xor_b32 s6, s62, 2
s_lshl_b32 s68, s6, 14
s_xor_b32 s6, s62, 3
s_lshl_b32 s69, s6, 14
s_xor_b32 s6, s62, 4
s_lshl_b32 s70, s6, 14
s_xor_b32 s6, s62, 5
s_lshl_b32 s71, s6, 14
s_xor_b32 s6, s62, 6
s_lshl_b32 s72, s6, 14
s_xor_b32 s6, s62, 7
s_lshl_b32 s73, s6, 14
s_waitcnt lgkmcnt(0)
s_add_u32 s40, s16, 0x0
s_addc_u32 s41, s17, 0
s_mov_b32 s42, s15
s_mov_b32 s43, 0x00020000
s_add_u32 s44, s26, 0x0
s_addc_u32 s45, s27, 0
s_mov_b32 s46, 0x20000
s_mov_b32 s47, 0x00020000
buffer_load_dwordx4 v[44:47], v16, s[40:43], s64 offen offset:0
buffer_load_dwordx4 v[48:51], v16, s[40:43], s64 offen offset:1024
buffer_load_dwordx4 v[52:55], v16, s[40:43], s64 offen offset:2048
buffer_load_dwordx4 v[56:59], v16, s[40:43], s64 offen offset:3072
buffer_load_dwordx4 v[60:63], v16, s[40:43], s65 offen offset:0
buffer_load_dwordx4 v[64:67], v16, s[40:43], s65 offen offset:1024
s_add_u32 m0, s63, 0x0
s_nop 0
buffer_load_dwordx4 v17, s[44:47], s66 offen offset:0 lds
buffer_load_dwordx4 v18, s[44:47], s66 offen offset:1024 lds
buffer_load_dwordx4 v19, s[44:47], s66 offen offset:2048 lds
buffer_load_dwordx4 v20, s[44:47], s66 offen offset:3072 lds
s_add_u32 m0, s63, 0x1000
s_nop 0
buffer_load_dwordx4 v17, s[44:47], s67 offen offset:0 lds
buffer_load_dwordx4 v18, s[44:47], s67 offen offset:1024 lds
buffer_load_dwordx4 v19, s[44:47], s67 offen offset:2048 lds
buffer_load_dwordx4 v20, s[44:47], s67 offen offset:3072 lds
s_mov_b32 s98, 0x7c3ff80
s_load_dwordx2 s[98:99], s[38:39], s98
v_bfe_u32 v5, v2, 2, 3
v_xor_b32 v5, s62, v5
v_and_b32 v6, 3, v2
v_lshlrev_b32 v7, 10, v5
v_lshl_add_u32 v7, v6, 8, v7
v_add_u32 v7, 0xc000, v7
v_and_b32 v5, 1, v5
v_lshl_or_b32 v6, v5, 2, v6
v_lshrrev_b32 v5, 5, v2
s_mul_i32 s6, s60, 12
v_add3_u32 v8, v5, s6, 0
v_lshrrev_b32 v9, 4, v8
v_lshl_add_u32 v9, v9, 13, v7
v_and_b32 v8, 15, v8
v_xor_b32 v8, v8, v6
v_lshl_add_u32 v36, v8, 4, v9
v_add3_u32 v8, v5, s6, 2
v_lshrrev_b32 v9, 4, v8
v_lshl_add_u32 v9, v9, 13, v7
v_and_b32 v8, 15, v8
v_xor_b32 v8, v8, v6
v_lshl_add_u32 v37, v8, 4, v9
v_add3_u32 v8, v5, s6, 4
v_lshrrev_b32 v9, 4, v8
v_lshl_add_u32 v9, v9, 13, v7
v_and_b32 v8, 15, v8
v_xor_b32 v8, v8, v6
v_lshl_add_u32 v38, v8, 4, v9
v_add3_u32 v8, v5, s6, 6
v_lshrrev_b32 v9, 4, v8
v_lshl_add_u32 v9, v9, 13, v7
v_and_b32 v8, 15, v8
v_xor_b32 v8, v8, v6
v_lshl_add_u32 v39, v8, 4, v9
v_add3_u32 v8, v5, s6, 8
v_lshrrev_b32 v9, 4, v8
v_lshl_add_u32 v9, v9, 13, v7
v_and_b32 v8, 15, v8
v_xor_b32 v8, v8, v6
v_lshl_add_u32 v40, v8, 4, v9
v_add3_u32 v8, v5, s6, 10
v_lshrrev_b32 v9, 4, v8
v_lshl_add_u32 v9, v9, 13, v7
v_and_b32 v8, 15, v8
v_xor_b32 v8, v8, v6
v_lshl_add_u32 v41, v8, 4, v9
v_xor_b32 v5, v3, v4
v_lshlrev_b32 v5, 4, v5
v_lshl_add_u32 v5, v4, 8, v5
v_add_u32 v31, 0xc000, v5
v_xor_b32 v32, 64, v31
v_lshrrev_b32 v5, 2, v3
v_and_b32 v6, 3, v3
v_and_b32 v7, 1, v4
v_lshlrev_b32 v7, 2, v7
v_and_b32 v8, 2, v5
v_or_b32 v7, v7, v8
v_lshl_add_u32 v8, v4, 3, v5
v_lshlrev_b32 v8, 7, v8
v_add_u32 v8, s63, v8
v_and_b32 v9, 1, v6
v_lshl_add_u32 v8, v9, 3, v8
v_lshrrev_b32 v6, 1, v6
v_xor_b32 v6, v6, v7
v_xor_b32 v9, 0, v6
v_lshl_add_u32 v25, v9, 4, v8
v_xor_b32 v9, 2, v6
v_lshl_add_u32 v26, v9, 4, v8
v_xor_b32 v9, 4, v6
v_lshl_add_u32 v27, v9, 4, v8
v_xor_b32 v9, 6, v6
v_lshl_add_u32 v28, v9, 4, v8
v_lshrrev_b32 v5, 3, v2
v_and_b32 v6, 7, v2
v_lshrrev_b32 v7, 1, v5
v_xor_b32 v6, v6, v7
v_and_b32 v7, 4, v5
v_add_u32 v5, v5, v7
s_mul_i32 s6, s60, 32768
v_lshl_add_u32 v5, v5, 9, s6
v_lshl_add_u32 v21, v6, 4, v5
v_xor_b32 v6, 4, v6
v_lshl_add_u32 v22, v6, 4, v5
v_add_u32 v22, 0x1c00, v22
v_mov_b32 v23, v21
v_mov_b32 v24, v22
s_lshr_b32 s7, s62, 1
s_xor_b32 s6, s7, 0
s_lshl_b32 s74, s6, 7
s_add_u32 s75, s74, 16384
s_xor_b32 s6, s7, 1
s_lshl_b32 s76, s6, 7
s_add_u32 s77, s76, 16384
s_xor_b32 s6, s7, 2
s_lshl_b32 s78, s6, 7
s_add_u32 s79, s78, 16384
s_xor_b32 s6, s7, 3
s_lshl_b32 s80, s6, 7
s_add_u32 s81, s80, 16384
s_and_b32 s6, s62, 1
s_lshl_b32 s6, s6, 2
v_lshrrev_b32 v5, 1, v3
v_xor_b32 v5, v5, v4
v_xor_b32 v5, s6, v5
v_lshl_add_u32 v6, v3, 7, s63
v_lshl_add_u32 v29, v5, 4, v6
v_xor_b32 v30, 64, v29
s_mul_i32 s6, s60, 2
s_xor_b32 s6, s6, s62
s_lshl_b32 s6, s6, 10
s_add_u32 s6, s6, 0x12000
v_lshrrev_b32 v5, 1, v4
v_and_b32 v6, 1, v4
v_lshl_add_u32 v5, v5, 8, s6
v_lshl_add_u32 v5, v6, 3, v5
v_lshl_add_u32 v33, v3, 4, v5
v_xor_b32 v34, 0x400, v33
v_add_u32 v35, 0x12000, v16
s_mov_b32 s6, s14
s_mul_i32 s7, s60, 2048
s_add_u32 s82, s6, s7
s_add_u32 s83, s82, 8192
s_add_u32 s84, s82, 16384
s_mov_b32 s86, 0x3db8aa3b
s_mov_b32 s87, 0x3db8aa3b
s_mov_b32 s88, 0x3727c5ac
s_mov_b32 s89, 0x3b800000
s_mov_b32 s90, 0xffff0000
s_add_u32 s48, s28, 0x0
s_addc_u32 s49, s29, 0
s_mov_b32 s50, 0x20000
s_mov_b32 s51, 0x00020000
s_add_u32 s52, s38, 0x0
s_addc_u32 s53, s39, 0
s_mov_b32 s54, s15
s_mov_b32 s55, 0x00020000
s_add_u32 s56, s38, 0x6800000
s_addc_u32 s57, s39, 0
s_mov_b32 s58, s15
s_mov_b32 s59, 0x00020000
s_waitcnt vmcnt(13)
v_lshlrev_b32 v116, 16, v44
v_and_b32 v117, s90, v44
v_lshlrev_b32 v118, 16, v45
v_and_b32 v119, s90, v45
v_lshlrev_b32 v120, 16, v46
v_and_b32 v121, s90, v46
v_lshlrev_b32 v122, 16, v47
v_and_b32 v123, s90, v47
v_pk_add_f32 v[164:165], v[116:117], v[118:119]
v_pk_mul_f32 v[166:167], v[116:117], v[116:117]
v_pk_add_f32 v[44:45], v[120:121], v[122:123]
v_pk_fma_f32 v[166:167], v[118:119], v[118:119], v[166:167]
v_pk_add_f32 v[164:165], v[164:165], v[44:45]
v_pk_fma_f32 v[166:167], v[120:121], v[120:121], v[166:167]
v_add_f32 v164, v164, v165
v_pk_fma_f32 v[166:167], v[122:123], v[122:123], v[166:167]
v_add_f32 v166, v166, v167
s_waitcnt vmcnt(12)
v_lshlrev_b32 v124, 16, v48
v_and_b32 v125, s90, v48
v_lshlrev_b32 v126, 16, v49
v_and_b32 v127, s90, v49
v_lshlrev_b32 v128, 16, v50
v_and_b32 v129, s90, v50
v_lshlrev_b32 v130, 16, v51
v_and_b32 v131, s90, v51
v_pk_add_f32 v[168:169], v[124:125], v[126:127]
v_pk_mul_f32 v[170:171], v[124:125], v[124:125]
v_pk_add_f32 v[48:49], v[128:129], v[130:131]
v_pk_fma_f32 v[170:171], v[126:127], v[126:127], v[170:171]
v_pk_add_f32 v[168:169], v[168:169], v[48:49]
v_pk_fma_f32 v[170:171], v[128:129], v[128:129], v[170:171]
v_add_f32 v168, v168, v169
v_pk_fma_f32 v[170:171], v[130:131], v[130:131], v[170:171]
v_add_f32 v170, v170, v171
s_waitcnt vmcnt(11)
v_lshlrev_b32 v132, 16, v52
v_and_b32 v133, s90, v52
v_lshlrev_b32 v134, 16, v53
v_and_b32 v135, s90, v53
v_lshlrev_b32 v136, 16, v54
v_and_b32 v137, s90, v54
v_lshlrev_b32 v138, 16, v55
v_and_b32 v139, s90, v55
v_pk_add_f32 v[172:173], v[132:133], v[134:135]
v_pk_mul_f32 v[174:175], v[132:133], v[132:133]
v_pk_add_f32 v[52:53], v[136:137], v[138:139]
v_pk_fma_f32 v[174:175], v[134:135], v[134:135], v[174:175]
v_pk_add_f32 v[172:173], v[172:173], v[52:53]
v_pk_fma_f32 v[174:175], v[136:137], v[136:137], v[174:175]
v_add_f32 v172, v172, v173
v_pk_fma_f32 v[174:175], v[138:139], v[138:139], v[174:175]
v_add_f32 v174, v174, v175
s_waitcnt vmcnt(10)
v_lshlrev_b32 v140, 16, v56
v_and_b32 v141, s90, v56
v_lshlrev_b32 v142, 16, v57
v_and_b32 v143, s90, v57
v_lshlrev_b32 v144, 16, v58
v_and_b32 v145, s90, v58
v_lshlrev_b32 v146, 16, v59
v_and_b32 v147, s90, v59
v_pk_add_f32 v[176:177], v[140:141], v[142:143]
v_pk_mul_f32 v[178:179], v[140:141], v[140:141]
v_pk_add_f32 v[56:57], v[144:145], v[146:147]
v_pk_fma_f32 v[178:179], v[142:143], v[142:143], v[178:179]
v_pk_add_f32 v[176:177], v[176:177], v[56:57]
v_pk_fma_f32 v[178:179], v[144:145], v[144:145], v[178:179]
v_add_f32 v176, v176, v177
v_pk_fma_f32 v[178:179], v[146:147], v[146:147], v[178:179]
v_add_f32 v178, v178, v179
s_waitcnt vmcnt(9)
v_lshlrev_b32 v148, 16, v60
v_and_b32 v149, s90, v60
v_lshlrev_b32 v150, 16, v61
v_and_b32 v151, s90, v61
v_lshlrev_b32 v152, 16, v62
v_and_b32 v153, s90, v62
v_lshlrev_b32 v154, 16, v63
v_and_b32 v155, s90, v63
v_pk_add_f32 v[180:181], v[148:149], v[150:151]
v_pk_mul_f32 v[182:183], v[148:149], v[148:149]
v_pk_add_f32 v[60:61], v[152:153], v[154:155]
v_pk_fma_f32 v[182:183], v[150:151], v[150:151], v[182:183]
v_pk_add_f32 v[180:181], v[180:181], v[60:61]
v_pk_fma_f32 v[182:183], v[152:153], v[152:153], v[182:183]
v_add_f32 v180, v180, v181
v_pk_fma_f32 v[182:183], v[154:155], v[154:155], v[182:183]
v_add_f32 v182, v182, v183
s_waitcnt vmcnt(8)
v_lshlrev_b32 v156, 16, v64
v_and_b32 v157, s90, v64
v_lshlrev_b32 v158, 16, v65
v_and_b32 v159, s90, v65
v_lshlrev_b32 v160, 16, v66
v_and_b32 v161, s90, v66
v_lshlrev_b32 v162, 16, v67
v_and_b32 v163, s90, v67
v_pk_add_f32 v[184:185], v[156:157], v[158:159]
v_pk_mul_f32 v[186:187], v[156:157], v[156:157]
v_pk_add_f32 v[64:65], v[160:161], v[162:163]
v_pk_fma_f32 v[186:187], v[158:159], v[158:159], v[186:187]
v_pk_add_f32 v[184:185], v[184:185], v[64:65]
v_pk_fma_f32 v[186:187], v[160:161], v[160:161], v[186:187]
v_add_f32 v184, v184, v185
v_pk_fma_f32 v[186:187], v[162:163], v[162:163], v[186:187]
v_add_f32 v186, v186, v187
v_permlane16_swap_b32 v164, v166
v_permlane16_swap_b32 v168, v170
v_permlane16_swap_b32 v172, v174
v_permlane16_swap_b32 v176, v178
v_permlane16_swap_b32 v180, v182
v_permlane16_swap_b32 v184, v186
v_add_f32 v164, v164, v166
v_add_f32 v168, v168, v170
v_add_f32 v172, v172, v174
v_add_f32 v176, v176, v178
v_add_f32 v180, v180, v182
v_add_f32 v184, v184, v186
v_add_f32_dpp v165, v164, v164 row_ror:8 row_mask:0xf bank_mask:0x3
v_add_f32_dpp v165, v168, v168 row_ror:8 row_mask:0xf bank_mask:0xc
v_add_f32_dpp v173, v172, v172 row_ror:8 row_mask:0xf bank_mask:0x3
v_add_f32_dpp v173, v176, v176 row_ror:8 row_mask:0xf bank_mask:0xc
v_add_f32_dpp v181, v180, v180 row_ror:8 row_mask:0xf bank_mask:0x3
v_add_f32_dpp v181, v184, v184 row_ror:8 row_mask:0xf bank_mask:0xc
v_add_f32_dpp v166, v165, v165 row_half_mirror row_mask:0xf bank_mask:0x5
v_add_f32_dpp v166, v173, v173 row_half_mirror row_mask:0xf bank_mask:0xa
v_add_f32_dpp v182, v181, v181 row_half_mirror row_mask:0xf bank_mask:0xf
s_nop 0
v_add_f32_dpp v166, v166, v166 quad_perm:[1,0,3,2] row_mask:0xf bank_mask:0xf
v_add_f32_dpp v182, v182, v182 quad_perm:[1,0,3,2] row_mask:0xf bank_mask:0xf
s_nop 0
v_add_f32_dpp v166, v166, v166 quad_perm:[2,3,0,1] row_mask:0xf bank_mask:0xf
v_add_f32_dpp v182, v182, v182 quad_perm:[2,3,0,1] row_mask:0xf bank_mask:0xf
v_mov_b32 v167, v166
v_mov_b32 v183, v182
s_nop 0
v_permlane16_swap_b32 v167, v166
v_permlane16_swap_b32 v183, v182
v_mul_f32 v167, s89, v167
v_mul_f32 v183, s89, v183
v_mul_f32 v166, s89, v166
v_mul_f32 v182, s89, v182
v_fma_f32 v166, -v167, v167, v166
v_fma_f32 v182, -v183, v183, v182
v_max_f32 v166, 0, v166
v_max_f32 v182, 0, v182
v_cvt_pk_bf16_f32 v166, v166, v166
v_cvt_pk_bf16_f32 v182, v182, v182
v_and_b32 v166, s90, v166
v_and_b32 v182, s90, v182
v_add_f32 v166, s88, v166
v_add_f32 v182, s88, v182
v_cvt_pk_bf16_f32 v166, v166, v166
v_cvt_pk_bf16_f32 v182, v182, v182
v_and_b32 v166, s90, v166
v_and_b32 v182, s90, v182
v_sqrt_f32 v166, v166
v_sqrt_f32 v182, v182
s_nop 0
s_nop 0
v_cvt_pk_bf16_f32 v166, v166, v166
v_cvt_pk_bf16_f32 v182, v182, v182
v_and_b32 v166, s90, v166
v_and_b32 v182, s90, v182
v_rcp_f32 v166, v166
v_rcp_f32 v182, v182
v_mul_f32 v167, -v167, v166
v_mul_f32 v183, -v183, v182
s_nop 0
v_mov_b64_dpp v[164:165], v[166:167] row_newbcast:0 row_mask:0xf bank_mask:0xf
v_mov_b64_dpp v[168:169], v[166:167] row_newbcast:8 row_mask:0xf bank_mask:0xf
v_mov_b64_dpp v[172:173], v[166:167] row_newbcast:4 row_mask:0xf bank_mask:0xf
v_mov_b64_dpp v[176:177], v[166:167] row_newbcast:12 row_mask:0xf bank_mask:0xf
v_mov_b64_dpp v[180:181], v[182:183] row_newbcast:0 row_mask:0xf bank_mask:0xf
v_mov_b64_dpp v[184:185], v[182:183] row_newbcast:8 row_mask:0xf bank_mask:0xf
v_fma_f32 v116, v116, v164, v165
v_fma_f32 v117, v117, v164, v165
v_fma_f32 v118, v118, v164, v165
v_fma_f32 v119, v119, v164, v165
v_fma_f32 v120, v120, v164, v165
v_fma_f32 v121, v121, v164, v165
v_fma_f32 v122, v122, v164, v165
v_fma_f32 v123, v123, v164, v165
v_cvt_pk_bf16_f32 v44, v116, v117
v_cvt_pk_bf16_f32 v45, v118, v119
v_cvt_pk_bf16_f32 v46, v120, v121
v_cvt_pk_bf16_f32 v47, v122, v123
ds_write_b128 v36, v[44:47]
v_fma_f32 v124, v124, v168, v169
v_fma_f32 v125, v125, v168, v169
v_fma_f32 v126, v126, v168, v169
v_fma_f32 v127, v127, v168, v169
v_fma_f32 v128, v128, v168, v169
v_fma_f32 v129, v129, v168, v169
v_fma_f32 v130, v130, v168, v169
v_fma_f32 v131, v131, v168, v169
v_cvt_pk_bf16_f32 v48, v124, v125
v_cvt_pk_bf16_f32 v49, v126, v127
v_cvt_pk_bf16_f32 v50, v128, v129
v_cvt_pk_bf16_f32 v51, v130, v131
ds_write_b128 v37, v[48:51]
v_fma_f32 v132, v132, v172, v173
v_fma_f32 v133, v133, v172, v173
v_fma_f32 v134, v134, v172, v173
v_fma_f32 v135, v135, v172, v173
v_fma_f32 v136, v136, v172, v173
v_fma_f32 v137, v137, v172, v173
v_fma_f32 v138, v138, v172, v173
v_fma_f32 v139, v139, v172, v173
v_cvt_pk_bf16_f32 v52, v132, v133
v_cvt_pk_bf16_f32 v53, v134, v135
v_cvt_pk_bf16_f32 v54, v136, v137
v_cvt_pk_bf16_f32 v55, v138, v139
ds_write_b128 v38, v[52:55]
v_fma_f32 v140, v140, v176, v177
v_fma_f32 v141, v141, v176, v177
v_fma_f32 v142, v142, v176, v177
v_fma_f32 v143, v143, v176, v177
v_fma_f32 v144, v144, v176, v177
v_fma_f32 v145, v145, v176, v177
v_fma_f32 v146, v146, v176, v177
v_fma_f32 v147, v147, v176, v177
v_cvt_pk_bf16_f32 v56, v140, v141
v_cvt_pk_bf16_f32 v57, v142, v143
v_cvt_pk_bf16_f32 v58, v144, v145
v_cvt_pk_bf16_f32 v59, v146, v147
ds_write_b128 v39, v[56:59]
v_fma_f32 v148, v148, v180, v181
v_fma_f32 v149, v149, v180, v181
v_fma_f32 v150, v150, v180, v181
v_fma_f32 v151, v151, v180, v181
v_fma_f32 v152, v152, v180, v181
v_fma_f32 v153, v153, v180, v181
v_fma_f32 v154, v154, v180, v181
v_fma_f32 v155, v155, v180, v181
v_cvt_pk_bf16_f32 v60, v148, v149
v_cvt_pk_bf16_f32 v61, v150, v151
v_cvt_pk_bf16_f32 v62, v152, v153
v_cvt_pk_bf16_f32 v63, v154, v155
ds_write_b128 v40, v[60:63]
v_fma_f32 v156, v156, v184, v185
v_fma_f32 v157, v157, v184, v185
v_fma_f32 v158, v158, v184, v185
v_fma_f32 v159, v159, v184, v185
v_fma_f32 v160, v160, v184, v185
v_fma_f32 v161, v161, v184, v185
v_fma_f32 v162, v162, v184, v185
v_fma_f32 v163, v163, v184, v185
v_cvt_pk_bf16_f32 v64, v156, v157
v_cvt_pk_bf16_f32 v65, v158, v159
v_cvt_pk_bf16_f32 v66, v160, v161
v_cvt_pk_bf16_f32 v67, v162, v163
ds_write_b128 v41, v[64:67]
s_add_u32 m0, s63, 0x2000
s_nop 0
buffer_load_dwordx4 v17, s[44:47], s68 offen offset:0 lds
buffer_load_dwordx4 v18, s[44:47], s68 offen offset:1024 lds
buffer_load_dwordx4 v19, s[44:47], s68 offen offset:2048 lds
buffer_load_dwordx4 v20, s[44:47], s68 offen offset:3072 lds
s_add_u32 s40, s28, 0x1fe00
s_addc_u32 s41, s29, 0
s_mov_b32 s42, 0x200
s_mov_b32 s43, 0x00020000
v_lshlrev_b32 v5, 4, v4
s_lshr_b32 s6, s66, 8
buffer_load_dwordx4 a[0:3], v5, s[40:43], s6 offen
s_lshr_b32 s6, s67, 8
buffer_load_dwordx4 a[4:7], v5, s[40:43], s6 offen
s_lshr_b32 s6, s68, 8
buffer_load_dwordx4 a[8:11], v5, s[40:43], s6 offen
s_lshr_b32 s6, s69, 8
buffer_load_dwordx4 a[12:15], v5, s[40:43], s6 offen
s_lshr_b32 s6, s70, 8
buffer_load_dwordx4 a[16:19], v5, s[40:43], s6 offen
s_lshr_b32 s6, s71, 8
buffer_load_dwordx4 a[20:23], v5, s[40:43], s6 offen
s_lshr_b32 s6, s72, 8
buffer_load_dwordx4 a[24:27], v5, s[40:43], s6 offen
s_lshr_b32 s6, s73, 8
buffer_load_dwordx4 a[28:31], v5, s[40:43], s6 offen
v_and_b32 v5, 31, v2
v_cmp_eq_u32 vcc, 31, v5
v_mov_b32 v6, 0xffff
v_mov_b32 v7, 0x3f800000
v_cndmask_b32 v6, -1, v6, vcc
v_cndmask_b32 v7, 0, v7, vcc
s_waitcnt vmcnt(16)
ds_read_b64_tr_b16 v[164:165], v25 offset:0
ds_read_b64_tr_b16 v[166:167], v25 offset:512
ds_read_b64_tr_b16 v[168:169], v26 offset:0
ds_read_b64_tr_b16 v[170:171], v26 offset:512
ds_read_b64_tr_b16 v[172:173], v27 offset:0
ds_read_b64_tr_b16 v[174:175], v27 offset:512
s_waitcnt lgkmcnt(6)
s_barrier
ds_read_b128 v[204:207], v31 offset:0
ds_read_b128 v[208:211], v31 offset:8192
ds_read_b128 v[212:215], v31 offset:16384
s_waitcnt lgkmcnt(2)
v_mfma_f32_16x16x32_bf16 v[68:71], v[164:167], v[204:207], 0
s_waitcnt lgkmcnt(1)
v_mfma_f32_16x16x32_bf16 v[72:75], v[164:167], v[208:211], 0
s_waitcnt lgkmcnt(0)
v_mfma_f32_16x16x32_bf16 v[76:79], v[164:167], v[212:215], 0
ds_read_b64_tr_b16 v[176:177], v28 offset:0
ds_read_b64_tr_b16 v[178:179], v28 offset:512
v_mfma_f32_16x16x32_bf16 v[80:83], v[168:171], v[204:207], 0
v_mfma_f32_16x16x32_bf16 v[84:87], v[168:171], v[208:211], 0
v_mfma_f32_16x16x32_bf16 v[88:91], v[168:171], v[212:215], 0
ds_read_b128 v[216:219], v32 offset:1024
s_waitcnt vmcnt(12)
ds_read_b64_tr_b16 v[180:181], v25 offset:4096
ds_read_b64_tr_b16 v[182:183], v25 offset:4608
v_mfma_f32_16x16x32_bf16 v[92:95], v[172:175], v[204:207], 0
ds_read_b128 v[220:223], v32 offset:9216
v_mfma_f32_16x16x32_bf16 v[96:99], v[172:175], v[208:211], 0
ds_read_b128 v[224:227], v32 offset:17408
v_mfma_f32_16x16x32_bf16 v[100:103], v[172:175], v[212:215], 0
ds_read_b64_tr_b16 v[184:185], v26 offset:4096
ds_read_b64_tr_b16 v[186:187], v26 offset:4608
s_waitcnt lgkmcnt(7)
v_mfma_f32_16x16x32_bf16 v[104:107], v[176:179], v[204:207], 0
s_add_u32 m0, s63, 0x0
s_nop 0
buffer_load_dwordx4 v17, s[44:47], s69 offen offset:0 lds
buffer_load_dwordx4 v18, s[44:47], s69 offen offset:1024 lds
buffer_load_dwordx4 v19, s[44:47], s69 offen offset:2048 lds
buffer_load_dwordx4 v20, s[44:47], s69 offen offset:3072 lds
v_mfma_f32_16x16x32_bf16 v[108:111], v[176:179], v[208:211], 0
v_mfma_f32_16x16x32_bf16 v[112:115], v[176:179], v[212:215], 0
ds_read_b64_tr_b16 v[188:189], v27 offset:4096
ds_read_b64_tr_b16 v[190:191], v27 offset:4608
s_waitcnt lgkmcnt(6)
v_mfma_f32_16x16x32_bf16 v[68:71], v[180:183], v[216:219], v[68:71]
s_waitcnt lgkmcnt(5)
v_mfma_f32_16x16x32_bf16 v[72:75], v[180:183], v[220:223], v[72:75]
s_waitcnt lgkmcnt(4)
v_mfma_f32_16x16x32_bf16 v[76:79], v[180:183], v[224:227], v[76:79]
ds_read_b64_tr_b16 v[192:193], v28 offset:4096
ds_read_b64_tr_b16 v[194:195], v28 offset:4608
s_waitcnt lgkmcnt(4)
v_mfma_f32_16x16x32_bf16 v[80:83], v[184:187], v[216:219], v[80:83]
v_mfma_f32_16x16x32_bf16 v[84:87], v[184:187], v[220:223], v[84:87]
v_mfma_f32_16x16x32_bf16 v[88:91], v[184:187], v[224:227], v[88:91]
ds_read_b128 v[228:231], v31 offset:2048
s_waitcnt vmcnt(12)
ds_read_b64_tr_b16 v[196:197], v25 offset:8192
ds_read_b64_tr_b16 v[198:199], v25 offset:8704
s_waitcnt lgkmcnt(5)
v_mfma_f32_16x16x32_bf16 v[92:95], v[188:191], v[216:219], v[92:95]
ds_read_b128 v[232:235], v31 offset:10240
v_mfma_f32_16x16x32_bf16 v[96:99], v[188:191], v[220:223], v[96:99]
ds_read_b128 v[236:239], v31 offset:18432
v_mfma_f32_16x16x32_bf16 v[100:103], v[188:191], v[224:227], v[100:103]
ds_read_b64_tr_b16 v[200:201], v26 offset:8192
ds_read_b64_tr_b16 v[202:203], v26 offset:8704
s_waitcnt lgkmcnt(7)
v_mfma_f32_16x16x32_bf16 v[104:107], v[192:195], v[216:219], v[104:107]
s_add_u32 m0, s63, 0x1000
s_nop 0
buffer_load_dwordx4 v17, s[44:47], s70 offen offset:0 lds
buffer_load_dwordx4 v18, s[44:47], s70 offen offset:1024 lds
buffer_load_dwordx4 v19, s[44:47], s70 offen offset:2048 lds
buffer_load_dwordx4 v20, s[44:47], s70 offen offset:3072 lds
v_mfma_f32_16x16x32_bf16 v[108:111], v[192:195], v[220:223], v[108:111]
v_mfma_f32_16x16x32_bf16 v[112:115], v[192:195], v[224:227], v[112:115]
ds_read_b64_tr_b16 v[164:165], v27 offset:8192
ds_read_b64_tr_b16 v[166:167], v27 offset:8704
s_waitcnt lgkmcnt(6)
v_mfma_f32_16x16x32_bf16 v[68:71], v[196:199], v[228:231], v[68:71]
s_waitcnt lgkmcnt(5)
v_mfma_f32_16x16x32_bf16 v[72:75], v[196:199], v[232:235], v[72:75]
s_waitcnt lgkmcnt(4)
v_mfma_f32_16x16x32_bf16 v[76:79], v[196:199], v[236:239], v[76:79]
ds_read_b64_tr_b16 v[168:169], v28 offset:8192
ds_read_b64_tr_b16 v[170:171], v28 offset:8704
s_waitcnt lgkmcnt(4)
v_mfma_f32_16x16x32_bf16 v[80:83], v[200:203], v[228:231], v[80:83]
v_mfma_f32_16x16x32_bf16 v[84:87], v[200:203], v[232:235], v[84:87]
v_mfma_f32_16x16x32_bf16 v[88:91], v[200:203], v[236:239], v[88:91]
ds_read_b128 v[204:207], v32 offset:3072
s_waitcnt vmcnt(4)
ds_read_b64_tr_b16 v[172:173], v25 offset:0
ds_read_b64_tr_b16 v[174:175], v25 offset:512
s_waitcnt lgkmcnt(5)
v_mfma_f32_16x16x32_bf16 v[92:95], v[164:167], v[228:231], v[92:95]
ds_read_b128 v[208:211], v32 offset:11264
v_mfma_f32_16x16x32_bf16 v[96:99], v[164:167], v[232:235], v[96:99]
ds_read_b128 v[212:215], v32 offset:19456
v_mfma_f32_16x16x32_bf16 v[100:103], v[164:167], v[236:239], v[100:103]
ds_read_b64_tr_b16 v[176:177], v26 offset:0
ds_read_b64_tr_b16 v[178:179], v26 offset:512
s_waitcnt lgkmcnt(7)
v_mfma_f32_16x16x32_bf16 v[104:107], v[168:171], v[228:231], v[104:107]
s_add_u32 m0, s63, 0x2000
s_nop 0
buffer_load_dwordx4 v17, s[44:47], s71 offen offset:0 lds
buffer_load_dwordx4 v18, s[44:47], s71 offen offset:1024 lds
buffer_load_dwordx4 v19, s[44:47], s71 offen offset:2048 lds
buffer_load_dwordx4 v20, s[44:47], s71 offen offset:3072 lds
v_mfma_f32_16x16x32_bf16 v[108:111], v[168:171], v[232:235], v[108:111]
v_mfma_f32_16x16x32_bf16 v[112:115], v[168:171], v[236:239], v[112:115]
ds_read_b64_tr_b16 v[180:181], v27 offset:0
ds_read_b64_tr_b16 v[182:183], v27 offset:512
s_waitcnt lgkmcnt(6)
v_mfma_f32_16x16x32_bf16 v[68:71], v[172:175], v[204:207], v[68:71]
s_waitcnt lgkmcnt(5)
v_mfma_f32_16x16x32_bf16 v[72:75], v[172:175], v[208:211], v[72:75]
s_waitcnt lgkmcnt(4)
v_mfma_f32_16x16x32_bf16 v[76:79], v[172:175], v[212:215], v[76:79]
ds_read_b64_tr_b16 v[184:185], v28 offset:0
ds_read_b64_tr_b16 v[186:187], v28 offset:512
s_waitcnt lgkmcnt(4)
v_mfma_f32_16x16x32_bf16 v[80:83], v[176:179], v[204:207], v[80:83]
v_mfma_f32_16x16x32_bf16 v[84:87], v[176:179], v[208:211], v[84:87]
v_mfma_f32_16x16x32_bf16 v[88:91], v[176:179], v[212:215], v[88:91]
ds_read_b128 v[216:219], v31 offset:4096
s_waitcnt vmcnt(4)
ds_read_b64_tr_b16 v[188:189], v25 offset:4096
ds_read_b64_tr_b16 v[190:191], v25 offset:4608
s_waitcnt lgkmcnt(5)
v_mfma_f32_16x16x32_bf16 v[92:95], v[180:183], v[204:207], v[92:95]
ds_read_b128 v[220:223], v31 offset:12288
v_mfma_f32_16x16x32_bf16 v[96:99], v[180:183], v[208:211], v[96:99]
ds_read_b128 v[224:227], v31 offset:20480
v_mfma_f32_16x16x32_bf16 v[100:103], v[180:183], v[212:215], v[100:103]
ds_read_b64_tr_b16 v[192:193], v26 offset:4096
ds_read_b64_tr_b16 v[194:195], v26 offset:4608
s_waitcnt lgkmcnt(7)
v_mfma_f32_16x16x32_bf16 v[104:107], v[184:187], v[204:207], v[104:107]
s_add_u32 m0, s63, 0x0
s_nop 0
buffer_load_dwordx4 v17, s[44:47], s72 offen offset:0 lds
buffer_load_dwordx4 v18, s[44:47], s72 offen offset:1024 lds
buffer_load_dwordx4 v19, s[44:47], s72 offen offset:2048 lds
buffer_load_dwordx4 v20, s[44:47], s72 offen offset:3072 lds
v_mfma_f32_16x16x32_bf16 v[108:111], v[184:187], v[208:211], v[108:111]
v_mfma_f32_16x16x32_bf16 v[112:115], v[184:187], v[212:215], v[112:115]
ds_read_b64_tr_b16 v[196:197], v27 offset:4096
ds_read_b64_tr_b16 v[198:199], v27 offset:4608
s_waitcnt lgkmcnt(6)
v_mfma_f32_16x16x32_bf16 v[68:71], v[188:191], v[216:219], v[68:71]
s_waitcnt lgkmcnt(5)
v_mfma_f32_16x16x32_bf16 v[72:75], v[188:191], v[220:223], v[72:75]
s_waitcnt lgkmcnt(4)
v_mfma_f32_16x16x32_bf16 v[76:79], v[188:191], v[224:227], v[76:79]
ds_read_b64_tr_b16 v[200:201], v28 offset:4096
ds_read_b64_tr_b16 v[202:203], v28 offset:4608
s_waitcnt lgkmcnt(4)
v_mfma_f32_16x16x32_bf16 v[80:83], v[192:195], v[216:219], v[80:83]
v_mfma_f32_16x16x32_bf16 v[84:87], v[192:195], v[220:223], v[84:87]
v_mfma_f32_16x16x32_bf16 v[88:91], v[192:195], v[224:227], v[88:91]
ds_read_b128 v[228:231], v32 offset:5120
s_waitcnt vmcnt(4)
ds_read_b64_tr_b16 v[164:165], v25 offset:8192
ds_read_b64_tr_b16 v[166:167], v25 offset:8704
s_waitcnt lgkmcnt(5)
v_mfma_f32_16x16x32_bf16 v[92:95], v[196:199], v[216:219], v[92:95]
ds_read_b128 v[232:235], v32 offset:13312
v_mfma_f32_16x16x32_bf16 v[96:99], v[196:199], v[220:223], v[96:99]
ds_read_b128 v[236:239], v32 offset:21504
v_mfma_f32_16x16x32_bf16 v[100:103], v[196:199], v[224:227], v[100:103]
ds_read_b64_tr_b16 v[168:169], v26 offset:8192
ds_read_b64_tr_b16 v[170:171], v26 offset:8704
s_waitcnt lgkmcnt(7)
v_mfma_f32_16x16x32_bf16 v[104:107], v[200:203], v[216:219], v[104:107]
s_add_u32 m0, s63, 0x1000
s_nop 0
buffer_load_dwordx4 v17, s[44:47], s73 offen offset:0 lds
buffer_load_dwordx4 v18, s[44:47], s73 offen offset:1024 lds
buffer_load_dwordx4 v19, s[44:47], s73 offen offset:2048 lds
buffer_load_dwordx4 v20, s[44:47], s73 offen offset:3072 lds
v_mfma_f32_16x16x32_bf16 v[108:111], v[200:203], v[220:223], v[108:111]
v_mfma_f32_16x16x32_bf16 v[112:115], v[200:203], v[224:227], v[112:115]
ds_read_b64_tr_b16 v[172:173], v27 offset:8192
ds_read_b64_tr_b16 v[174:175], v27 offset:8704
s_waitcnt lgkmcnt(6)
v_mfma_f32_16x16x32_bf16 v[68:71], v[164:167], v[228:231], v[68:71]
s_waitcnt lgkmcnt(5)
v_mfma_f32_16x16x32_bf16 v[72:75], v[164:167], v[232:235], v[72:75]
s_waitcnt lgkmcnt(4)
v_mfma_f32_16x16x32_bf16 v[76:79], v[164:167], v[236:239], v[76:79]
ds_read_b64_tr_b16 v[176:177], v28 offset:8192
ds_read_b64_tr_b16 v[178:179], v28 offset:8704
s_waitcnt lgkmcnt(4)
v_mfma_f32_16x16x32_bf16 v[80:83], v[168:171], v[228:231], v[80:83]
v_mfma_f32_16x16x32_bf16 v[84:87], v[168:171], v[232:235], v[84:87]
v_mfma_f32_16x16x32_bf16 v[88:91], v[168:171], v[236:239], v[88:91]
ds_read_b128 v[204:207], v31 offset:6144
s_waitcnt vmcnt(4)
ds_read_b64_tr_b16 v[180:181], v25 offset:0
ds_read_b64_tr_b16 v[182:183], v25 offset:512
s_waitcnt lgkmcnt(5)
v_mfma_f32_16x16x32_bf16 v[92:95], v[172:175], v[228:231], v[92:95]
ds_read_b128 v[208:211], v31 offset:14336
v_mfma_f32_16x16x32_bf16 v[96:99], v[172:175], v[232:235], v[96:99]
ds_read_b128 v[212:215], v31 offset:22528
v_mfma_f32_16x16x32_bf16 v[100:103], v[172:175], v[236:239], v[100:103]
ds_read_b64_tr_b16 v[184:185], v26 offset:0
ds_read_b64_tr_b16 v[186:187], v26 offset:512
s_waitcnt lgkmcnt(7)
v_mfma_f32_16x16x32_bf16 v[104:107], v[176:179], v[228:231], v[104:107]
s_add_u32 m0, s63, 0x2000
s_nop 0
buffer_load_dwordx4 v21, s[48:51], s74 offen offset:0 lds
buffer_load_dwordx4 v22, s[48:51], s74 offen offset:1024 lds
buffer_load_dwordx4 v23, s[48:51], s74 offen offset:2048 lds
buffer_load_dwordx4 v24, s[48:51], s74 offen offset:3072 lds
v_mfma_f32_16x16x32_bf16 v[108:111], v[176:179], v[232:235], v[108:111]
v_mfma_f32_16x16x32_bf16 v[112:115], v[176:179], v[236:239], v[112:115]
ds_read_b64_tr_b16 v[188:189], v27 offset:0
ds_read_b64_tr_b16 v[190:191], v27 offset:512
s_waitcnt lgkmcnt(6)
v_mfma_f32_16x16x32_bf16 v[68:71], v[180:183], v[204:207], v[68:71]
s_waitcnt lgkmcnt(5)
v_mfma_f32_16x16x32_bf16 v[72:75], v[180:183], v[208:211], v[72:75]
s_waitcnt lgkmcnt(4)
v_mfma_f32_16x16x32_bf16 v[76:79], v[180:183], v[212:215], v[76:79]
ds_read_b64_tr_b16 v[192:193], v28 offset:0
ds_read_b64_tr_b16 v[194:195], v28 offset:512
s_waitcnt lgkmcnt(4)
v_mfma_f32_16x16x32_bf16 v[80:83], v[184:187], v[204:207], v[80:83]
v_mfma_f32_16x16x32_bf16 v[84:87], v[184:187], v[208:211], v[84:87]
v_mfma_f32_16x16x32_bf16 v[88:91], v[184:187], v[212:215], v[88:91]
ds_read_b128 v[216:219], v32 offset:7168
s_waitcnt vmcnt(4)
ds_read_b64_tr_b16 v[196:197], v25 offset:4096
ds_read_b64_tr_b16 v[198:199], v25 offset:4608
s_waitcnt lgkmcnt(5)
v_mfma_f32_16x16x32_bf16 v[92:95], v[188:191], v[204:207], v[92:95]
ds_read_b128 v[220:223], v32 offset:15360
v_mfma_f32_16x16x32_bf16 v[96:99], v[188:191], v[208:211], v[96:99]
ds_read_b128 v[224:227], v32 offset:23552
v_mfma_f32_16x16x32_bf16 v[100:103], v[188:191], v[212:215], v[100:103]
ds_read_b64_tr_b16 v[200:201], v26 offset:4096
ds_read_b64_tr_b16 v[202:203], v26 offset:4608
s_waitcnt lgkmcnt(7)
v_mfma_f32_16x16x32_bf16 v[104:107], v[192:195], v[204:207], v[104:107]
s_add_u32 m0, s63, 0x0
s_nop 0
buffer_load_dwordx4 v21, s[48:51], s75 offen offset:0 lds
buffer_load_dwordx4 v22, s[48:51], s75 offen offset:1024 lds
buffer_load_dwordx4 v23, s[48:51], s75 offen offset:2048 lds
buffer_load_dwordx4 v24, s[48:51], s75 offen offset:3072 lds
v_mfma_f32_16x16x32_bf16 v[108:111], v[192:195], v[208:211], v[108:111]
v_mfma_f32_16x16x32_bf16 v[112:115], v[192:195], v[212:215], v[112:115]
ds_read_b64_tr_b16 v[164:165], v27 offset:4096
ds_read_b64_tr_b16 v[166:167], v27 offset:4608
s_waitcnt lgkmcnt(6)
v_mfma_f32_16x16x32_bf16 v[68:71], v[196:199], v[216:219], v[68:71]
s_waitcnt lgkmcnt(5)
v_mfma_f32_16x16x32_bf16 v[72:75], v[196:199], v[220:223], v[72:75]
s_waitcnt lgkmcnt(4)
v_mfma_f32_16x16x32_bf16 v[76:79], v[196:199], v[224:227], v[76:79]
ds_read_b64_tr_b16 v[168:169], v28 offset:4096
ds_read_b64_tr_b16 v[170:171], v28 offset:4608
s_waitcnt lgkmcnt(4)
v_mfma_f32_16x16x32_bf16 v[80:83], v[200:203], v[216:219], v[80:83]
v_cvt_pk_bf16_f32 v68, v68, v69
v_cvt_pk_bf16_f32 v69, v70, v71
ds_write_b64 v33, v[68:69] offset:0
v_mfma_f32_16x16x32_bf16 v[84:87], v[200:203], v[220:223], v[84:87]
v_cvt_pk_bf16_f32 v72, v72, v73
v_cvt_pk_bf16_f32 v73, v74, v75
ds_write_b64 v33, v[72:73] offset:8192
v_mfma_f32_16x16x32_bf16 v[88:91], v[200:203], v[224:227], v[88:91]
v_cvt_pk_bf16_f32 v76, v76, v77
v_cvt_pk_bf16_f32 v77, v78, v79
ds_write_b64 v33, v[76:77] offset:16384
s_waitcnt lgkmcnt(5)
v_mfma_f32_16x16x32_bf16 v[92:95], v[164:167], v[216:219], v[92:95]
v_cvt_pk_bf16_f32 v80, v80, v81
v_cvt_pk_bf16_f32 v81, v82, v83
ds_write_b64 v33, v[80:81] offset:512
v_mfma_f32_16x16x32_bf16 v[96:99], v[164:167], v[220:223], v[96:99]
v_cvt_pk_bf16_f32 v84, v84, v85
v_cvt_pk_bf16_f32 v85, v86, v87
ds_write_b64 v33, v[84:85] offset:8704
v_mfma_f32_16x16x32_bf16 v[100:103], v[164:167], v[224:227], v[100:103]
v_cvt_pk_bf16_f32 v88, v88, v89
v_cvt_pk_bf16_f32 v89, v90, v91
ds_write_b64 v33, v[88:89] offset:16896
s_waitcnt lgkmcnt(6)
v_mfma_f32_16x16x32_bf16 v[104:107], v[168:171], v[216:219], v[104:107]
v_cvt_pk_bf16_f32 v92, v92, v93
v_cvt_pk_bf16_f32 v93, v94, v95
ds_write_b64 v34, v[92:93] offset:0
s_add_u32 m0, s63, 0x1000
s_nop 0
buffer_load_dwordx4 v21, s[48:51], s76 offen offset:0 lds
buffer_load_dwordx4 v22, s[48:51], s76 offen offset:1024 lds
buffer_load_dwordx4 v23, s[48:51], s76 offen offset:2048 lds
buffer_load_dwordx4 v24, s[48:51], s76 offen offset:3072 lds
v_mfma_f32_16x16x32_bf16 v[108:111], v[168:171], v[220:223], v[108:111]
v_cvt_pk_bf16_f32 v96, v96, v97
v_cvt_pk_bf16_f32 v97, v98, v99
ds_write_b64 v34, v[96:97] offset:8192
v_mfma_f32_16x16x32_bf16 v[112:115], v[168:171], v[224:227], v[112:115]
v_cvt_pk_bf16_f32 v100, v100, v101
v_cvt_pk_bf16_f32 v101, v102, v103
ds_write_b64 v34, v[100:101] offset:16384
v_cvt_pk_bf16_f32 v104, v104, v105
v_cvt_pk_bf16_f32 v105, v106, v107
ds_write_b64 v34, v[104:105] offset:512
v_cvt_pk_bf16_f32 v108, v108, v109
v_cvt_pk_bf16_f32 v109, v110, v111
ds_write_b64 v34, v[108:109] offset:8704
v_cvt_pk_bf16_f32 v112, v112, v113
v_cvt_pk_bf16_f32 v113, v114, v115
ds_write_b64 v34, v[112:113] offset:16896
s_waitcnt vmcnt(8)
ds_read_b128 v[172:175], v29 offset:8192
ds_read_b128 v[176:179], v30 offset:8192
s_waitcnt lgkmcnt(2)
s_barrier
ds_read_b128 v[228:231], v35 offset:0
ds_read_b128 v[232:235], v35 offset:8192
ds_read_b128 v[236:239], v35 offset:16384
ds_read_b128 v[204:207], v35 offset:1024
s_waitcnt lgkmcnt(3)
v_mfma_f32_16x16x32_bf16 v[116:119], v[172:175], v[228:231], 0
ds_read_b128 v[208:211], v35 offset:9216
s_waitcnt lgkmcnt(3)
v_mfma_f32_16x16x32_bf16 v[132:135], v[172:175], v[232:235], 0
ds_read_b128 v[212:215], v35 offset:17408
s_waitcnt lgkmcnt(3)
v_mfma_f32_16x16x32_bf16 v[148:151], v[172:175], v[236:239], 0
v_mfma_f32_16x16x32_bf16 v[240:243], a[0:3], v[228:231], 0
v_mfma_f32_16x16x32_bf16 v[244:247], a[0:3], v[232:235], 0
v_mfma_f32_16x16x32_bf16 v[248:251], a[0:3], v[236:239], 0
ds_read_b128 v[180:183], v29 offset:10240
s_waitcnt lgkmcnt(3)
v_mfma_f32_16x16x32_bf16 v[116:119], v[176:179], v[204:207], v[116:119]
s_waitcnt lgkmcnt(2)
v_mfma_f32_16x16x32_bf16 v[132:135], v[176:179], v[208:211], v[132:135]
s_waitcnt lgkmcnt(1)
v_mfma_f32_16x16x32_bf16 v[148:151], v[176:179], v[212:215], v[148:151]
ds_read_b128 v[184:187], v30 offset:10240
v_mfma_f32_16x16x32_bf16 v[240:243], a[4:7], v[204:207], v[240:243]
v_mfma_f32_16x16x32_bf16 v[244:247], a[4:7], v[208:211], v[244:247]
v_mfma_f32_16x16x32_bf16 v[248:251], a[4:7], v[212:215], v[248:251]
s_waitcnt vmcnt(4)
ds_read_b128 v[188:191], v29 offset:0
s_waitcnt lgkmcnt(2)
v_mfma_f32_16x16x32_bf16 v[120:123], v[180:183], v[228:231], 0
v_mfma_f32_16x16x32_bf16 v[136:139], v[180:183], v[232:235], 0
v_mfma_f32_16x16x32_bf16 v[152:155], v[180:183], v[236:239], 0
ds_read_b128 v[192:195], v30 offset:0
s_waitcnt lgkmcnt(2)
v_mfma_f32_16x16x32_bf16 v[120:123], v[184:187], v[204:207], v[120:123]
s_add_u32 m0, s63, 0x2000
s_nop 0
buffer_load_dwordx4 v21, s[48:51], s77 offen offset:0 lds
buffer_load_dwordx4 v22, s[48:51], s77 offen offset:1024 lds
buffer_load_dwordx4 v23, s[48:51], s77 offen offset:2048 lds
buffer_load_dwordx4 v24, s[48:51], s77 offen offset:3072 lds
v_mfma_f32_16x16x32_bf16 v[136:139], v[184:187], v[208:211], v[136:139]
v_mfma_f32_16x16x32_bf16 v[152:155], v[184:187], v[212:215], v[152:155]
ds_read_b128 v[196:199], v29 offset:2048
s_waitcnt lgkmcnt(2)
v_mfma_f32_16x16x32_bf16 v[124:127], v[188:191], v[228:231], 0
v_mfma_f32_16x16x32_bf16 v[140:143], v[188:191], v[232:235], 0
v_mfma_f32_16x16x32_bf16 v[156:159], v[188:191], v[236:239], 0
ds_read_b128 v[200:203], v30 offset:2048
s_waitcnt lgkmcnt(2)
v_mfma_f32_16x16x32_bf16 v[124:127], v[192:195], v[204:207], v[124:127]
v_mfma_f32_16x16x32_bf16 v[140:143], v[192:195], v[208:211], v[140:143]
v_mfma_f32_16x16x32_bf16 v[156:159], v[192:195], v[212:215], v[156:159]
ds_read_b128 v[216:219], v35 offset:2048
s_waitcnt vmcnt(4)
ds_read_b128 v[164:167], v29 offset:4096
s_waitcnt lgkmcnt(3)
v_mfma_f32_16x16x32_bf16 v[128:131], v[196:199], v[228:231], 0
ds_read_b128 v[220:223], v35 offset:10240
v_mfma_f32_16x16x32_bf16 v[144:147], v[196:199], v[232:235], 0
ds_read_b128 v[224:227], v35 offset:18432
v_mfma_f32_16x16x32_bf16 v[160:163], v[196:199], v[236:239], 0
s_waitcnt lgkmcnt(4)
v_mfma_f32_16x16x32_bf16 v[128:131], v[200:203], v[204:207], v[128:131]
s_add_u32 m0, s63, 0x0
s_nop 0
buffer_load_dwordx4 v21, s[48:51], s78 offen offset:0 lds
buffer_load_dwordx4 v22, s[48:51], s78 offen offset:1024 lds
buffer_load_dwordx4 v23, s[48:51], s78 offen offset:2048 lds
buffer_load_dwordx4 v24, s[48:51], s78 offen offset:3072 lds
v_mfma_f32_16x16x32_bf16 v[144:147], v[200:203], v[208:211], v[144:147]
v_mfma_f32_16x16x32_bf16 v[160:163], v[200:203], v[212:215], v[160:163]
ds_read_b128 v[228:231], v35 offset:3072
ds_read_b128 v[168:171], v30 offset:4096
s_waitcnt lgkmcnt(4)
v_mfma_f32_16x16x32_bf16 v[116:119], v[164:167], v[216:219], v[116:119]
ds_read_b128 v[232:235], v35 offset:11264
s_waitcnt lgkmcnt(4)
v_mfma_f32_16x16x32_bf16 v[132:135], v[164:167], v[220:223], v[132:135]
ds_read_b128 v[236:239], v35 offset:19456
s_waitcnt lgkmcnt(4)
v_mfma_f32_16x16x32_bf16 v[148:151], v[164:167], v[224:227], v[148:151]
v_mfma_f32_16x16x32_bf16 v[240:243], a[8:11], v[216:219], v[240:243]
v_mfma_f32_16x16x32_bf16 v[244:247], a[8:11], v[220:223], v[244:247]
v_mfma_f32_16x16x32_bf16 v[248:251], a[8:11], v[224:227], v[248:251]
ds_read_b128 v[172:175], v29 offset:6144
s_waitcnt lgkmcnt(3)
v_mfma_f32_16x16x32_bf16 v[116:119], v[168:171], v[228:231], v[116:119]
s_waitcnt lgkmcnt(2)
v_mfma_f32_16x16x32_bf16 v[132:135], v[168:171], v[232:235], v[132:135]
s_waitcnt lgkmcnt(1)
v_mfma_f32_16x16x32_bf16 v[148:151], v[168:171], v[236:239], v[148:151]
ds_read_b128 v[176:179], v30 offset:6144
v_mfma_f32_16x16x32_bf16 v[240:243], a[12:15], v[228:231], v[240:243]
v_mfma_f32_16x16x32_bf16 v[244:247], a[12:15], v[232:235], v[244:247]
v_mfma_f32_16x16x32_bf16 v[248:251], a[12:15], v[236:239], v[248:251]
s_waitcnt vmcnt(4)
ds_read_b128 v[180:183], v29 offset:8192
s_waitcnt lgkmcnt(2)
v_mfma_f32_16x16x32_bf16 v[120:123], v[172:175], v[216:219], v[120:123]
v_mfma_f32_16x16x32_bf16 v[136:139], v[172:175], v[220:223], v[136:139]
v_mfma_f32_16x16x32_bf16 v[152:155], v[172:175], v[224:227], v[152:155]
ds_read_b128 v[184:187], v30 offset:8192
s_waitcnt lgkmcnt(2)
v_mfma_f32_16x16x32_bf16 v[120:123], v[176:179], v[228:231], v[120:123]
s_add_u32 m0, s63, 0x1000
s_nop 0
buffer_load_dwordx4 v21, s[48:51], s79 offen offset:0 lds
buffer_load_dwordx4 v22, s[48:51], s79 offen offset:1024 lds
buffer_load_dwordx4 v23, s[48:51], s79 offen offset:2048 lds
buffer_load_dwordx4 v24, s[48:51], s79 offen offset:3072 lds
v_mfma_f32_16x16x32_bf16 v[136:139], v[176:179], v[232:235], v[136:139]
v_mfma_f32_16x16x32_bf16 v[152:155], v[176:179], v[236:239], v[152:155]
ds_read_b128 v[188:191], v29 offset:10240
s_waitcnt lgkmcnt(2)
v_mfma_f32_16x16x32_bf16 v[124:127], v[180:183], v[216:219], v[124:127]
v_mfma_f32_16x16x32_bf16 v[140:143], v[180:183], v[220:223], v[140:143]
v_mfma_f32_16x16x32_bf16 v[156:159], v[180:183], v[224:227], v[156:159]
ds_read_b128 v[192:195], v30 offset:10240
s_waitcnt lgkmcnt(2)
v_mfma_f32_16x16x32_bf16 v[124:127], v[184:187], v[228:231], v[124:127]
v_mfma_f32_16x16x32_bf16 v[140:143], v[184:187], v[232:235], v[140:143]
v_mfma_f32_16x16x32_bf16 v[156:159], v[184:187], v[236:239], v[156:159]
ds_read_b128 v[204:207], v35 offset:4096
s_waitcnt vmcnt(4)
ds_read_b128 v[196:199], v29 offset:0
s_waitcnt lgkmcnt(3)
v_mfma_f32_16x16x32_bf16 v[128:131], v[188:191], v[216:219], v[128:131]
ds_read_b128 v[208:211], v35 offset:12288
v_mfma_f32_16x16x32_bf16 v[144:147], v[188:191], v[220:223], v[144:147]
ds_read_b128 v[212:215], v35 offset:20480
v_mfma_f32_16x16x32_bf16 v[160:163], v[188:191], v[224:227], v[160:163]
s_waitcnt lgkmcnt(4)
v_mfma_f32_16x16x32_bf16 v[128:131], v[192:195], v[228:231], v[128:131]
s_add_u32 m0, s63, 0x2000
s_nop 0
buffer_load_dwordx4 v21, s[48:51], s80 offen offset:0 lds
buffer_load_dwordx4 v22, s[48:51], s80 offen offset:1024 lds
buffer_load_dwordx4 v23, s[48:51], s80 offen offset:2048 lds
buffer_load_dwordx4 v24, s[48:51], s80 offen offset:3072 lds
v_mfma_f32_16x16x32_bf16 v[144:147], v[192:195], v[232:235], v[144:147]
v_mfma_f32_16x16x32_bf16 v[160:163], v[192:195], v[236:239], v[160:163]
ds_read_b128 v[216:219], v35 offset:5120
ds_read_b128 v[200:203], v30 offset:0
s_waitcnt lgkmcnt(4)
v_mfma_f32_16x16x32_bf16 v[116:119], v[196:199], v[204:207], v[116:119]
ds_read_b128 v[220:223], v35 offset:13312
s_waitcnt lgkmcnt(4)
v_mfma_f32_16x16x32_bf16 v[132:135], v[196:199], v[208:211], v[132:135]
ds_read_b128 v[224:227], v35 offset:21504
s_waitcnt lgkmcnt(4)
v_mfma_f32_16x16x32_bf16 v[148:151], v[196:199], v[212:215], v[148:151]
v_mfma_f32_16x16x32_bf16 v[240:243], a[16:19], v[204:207], v[240:243]
v_mfma_f32_16x16x32_bf16 v[244:247], a[16:19], v[208:211], v[244:247]
v_mfma_f32_16x16x32_bf16 v[248:251], a[16:19], v[212:215], v[248:251]
ds_read_b128 v[164:167], v29 offset:2048
s_waitcnt lgkmcnt(3)
v_mfma_f32_16x16x32_bf16 v[116:119], v[200:203], v[216:219], v[116:119]
s_waitcnt lgkmcnt(2)
v_mfma_f32_16x16x32_bf16 v[132:135], v[200:203], v[220:223], v[132:135]
s_waitcnt lgkmcnt(1)
v_mfma_f32_16x16x32_bf16 v[148:151], v[200:203], v[224:227], v[148:151]
ds_read_b128 v[168:171], v30 offset:2048
v_mfma_f32_16x16x32_bf16 v[240:243], a[20:23], v[216:219], v[240:243]
v_mfma_f32_16x16x32_bf16 v[244:247], a[20:23], v[220:223], v[244:247]
v_mfma_f32_16x16x32_bf16 v[248:251], a[20:23], v[224:227], v[248:251]
s_waitcnt vmcnt(4)
ds_read_b128 v[172:175], v29 offset:4096
s_waitcnt lgkmcnt(2)
v_mfma_f32_16x16x32_bf16 v[120:123], v[164:167], v[204:207], v[120:123]
v_mfma_f32_16x16x32_bf16 v[136:139], v[164:167], v[208:211], v[136:139]
v_mfma_f32_16x16x32_bf16 v[152:155], v[164:167], v[212:215], v[152:155]
ds_read_b128 v[176:179], v30 offset:4096
s_waitcnt lgkmcnt(2)
v_mfma_f32_16x16x32_bf16 v[120:123], v[168:171], v[216:219], v[120:123]
s_add_u32 m0, s63, 0x0
s_nop 0
buffer_load_dwordx4 v21, s[48:51], s81 offen offset:0 lds
buffer_load_dwordx4 v22, s[48:51], s81 offen offset:1024 lds
buffer_load_dwordx4 v23, s[48:51], s81 offen offset:2048 lds
buffer_load_dwordx4 v24, s[48:51], s81 offen offset:3072 lds
v_mfma_f32_16x16x32_bf16 v[136:139], v[168:171], v[220:223], v[136:139]
v_and_or_b32 v47, v47, v6, v7
v_and_or_b32 v51, v51, v6, v7
v_mfma_f32_16x16x32_bf16 v[152:155], v[168:171], v[224:227], v[152:155]
ds_read_b128 v[180:183], v29 offset:6144
v_and_or_b32 v55, v55, v6, v7
s_waitcnt lgkmcnt(2)
v_mfma_f32_16x16x32_bf16 v[124:127], v[172:175], v[204:207], v[124:127]
v_and_or_b32 v59, v59, v6, v7
v_and_or_b32 v63, v63, v6, v7
v_mfma_f32_16x16x32_bf16 v[140:143], v[172:175], v[208:211], v[140:143]
v_and_or_b32 v67, v67, v6, v7
buffer_store_dwordx4 v[44:47], v16, s[56:59], s64 offen offset:0 sc1
v_mfma_f32_16x16x32_bf16 v[156:159], v[172:175], v[212:215], v[156:159]
ds_read_b128 v[184:187], v30 offset:6144
buffer_store_dwordx4 v[48:51], v16, s[56:59], s64 offen offset:1024 sc1
s_waitcnt lgkmcnt(2)
v_mfma_f32_16x16x32_bf16 v[124:127], v[176:179], v[216:219], v[124:127]
buffer_store_dwordx4 v[52:55], v16, s[56:59], s64 offen offset:2048 sc1
buffer_store_dwordx4 v[56:59], v16, s[56:59], s64 offen offset:3072 sc1
v_mfma_f32_16x16x32_bf16 v[140:143], v[176:179], v[220:223], v[140:143]
buffer_store_dwordx4 v[60:63], v16, s[56:59], s65 offen offset:0 sc1
buffer_store_dwordx4 v[64:67], v16, s[56:59], s65 offen offset:1024 sc1
v_mfma_f32_16x16x32_bf16 v[156:159], v[176:179], v[224:227], v[156:159]
ds_read_b128 v[228:231], v35 offset:6144
s_waitcnt vmcnt(10)
ds_read_b128 v[188:191], v29 offset:8192
s_waitcnt lgkmcnt(3)
v_mfma_f32_16x16x32_bf16 v[128:131], v[180:183], v[204:207], v[128:131]
ds_read_b128 v[232:235], v35 offset:14336
v_mfma_f32_16x16x32_bf16 v[144:147], v[180:183], v[208:211], v[144:147]
ds_read_b128 v[236:239], v35 offset:22528
v_mfma_f32_16x16x32_bf16 v[160:163], v[180:183], v[212:215], v[160:163]
s_waitcnt lgkmcnt(4)
v_mfma_f32_16x16x32_bf16 v[128:131], v[184:187], v[216:219], v[128:131]
v_mfma_f32_16x16x32_bf16 v[144:147], v[184:187], v[220:223], v[144:147]
v_mfma_f32_16x16x32_bf16 v[160:163], v[184:187], v[224:227], v[160:163]
ds_read_b128 v[204:207], v35 offset:7168
ds_read_b128 v[192:195], v30 offset:8192
s_waitcnt lgkmcnt(4)
v_mfma_f32_16x16x32_bf16 v[116:119], v[188:191], v[228:231], v[116:119]
ds_read_b128 v[208:211], v35 offset:15360
s_waitcnt lgkmcnt(4)
v_mfma_f32_16x16x32_bf16 v[132:135], v[188:191], v[232:235], v[132:135]
ds_read_b128 v[212:215], v35 offset:23552
s_waitcnt lgkmcnt(4)
v_mfma_f32_16x16x32_bf16 v[148:151], v[188:191], v[236:239], v[148:151]
v_mfma_f32_16x16x32_bf16 v[240:243], a[24:27], v[228:231], v[240:243]
v_mfma_f32_16x16x32_bf16 v[244:247], a[24:27], v[232:235], v[244:247]
v_mfma_f32_16x16x32_bf16 v[248:251], a[24:27], v[236:239], v[248:251]
ds_read_b128 v[196:199], v29 offset:10240
s_waitcnt lgkmcnt(3)
v_mfma_f32_16x16x32_bf16 v[116:119], v[192:195], v[204:207], v[116:119]
s_waitcnt lgkmcnt(2)
v_mfma_f32_16x16x32_bf16 v[132:135], v[192:195], v[208:211], v[132:135]
s_waitcnt lgkmcnt(1)
v_mfma_f32_16x16x32_bf16 v[148:151], v[192:195], v[212:215], v[148:151]
ds_read_b128 v[200:203], v30 offset:10240
v_mfma_f32_16x16x32_bf16 v[240:243], a[28:31], v[204:207], v[240:243]
v_mfma_f32_16x16x32_bf16 v[244:247], a[28:31], v[208:211], v[244:247]
v_mfma_f32_16x16x32_bf16 v[248:251], a[28:31], v[212:215], v[248:251]
s_waitcnt vmcnt(6)
ds_read_b128 v[164:167], v29 offset:0
s_waitcnt lgkmcnt(2)
v_mfma_f32_16x16x32_bf16 v[120:123], v[196:199], v[228:231], v[120:123]
v_mfma_f32_16x16x32_bf16 v[136:139], v[196:199], v[232:235], v[136:139]
v_mfma_f32_16x16x32_bf16 v[152:155], v[196:199], v[236:239], v[152:155]
ds_read_b128 v[168:171], v30 offset:0
s_waitcnt lgkmcnt(2)
v_mfma_f32_16x16x32_bf16 v[120:123], v[200:203], v[204:207], v[120:123]
v_mul_f32 v240, s86, v240
v_mul_f32 v244, s86, v244
v_mul_f32 v248, s86, v248
v_mfma_f32_16x16x32_bf16 v[136:139], v[200:203], v[208:211], v[136:139]
v_mfma_f32_16x16x32_bf16 v[152:155], v[200:203], v[212:215], v[152:155]
ds_read_b128 v[172:175], v29 offset:2048
s_waitcnt lgkmcnt(2)
v_mfma_f32_16x16x32_bf16 v[124:127], v[164:167], v[228:231], v[124:127]
v_fma_f32 v116, s86, v116, -v240
v_fma_f32 v117, s86, v117, -v240
v_fma_f32 v118, s86, v118, -v240
v_fma_f32 v119, s86, v119, -v240
v_fma_f32 v120, s86, v120, -v240
v_fma_f32 v121, s86, v121, -v240
v_fma_f32 v122, s86, v122, -v240
v_fma_f32 v123, s86, v123, -v240
v_cvt_pk_bf16_f32 v116, v116, v117
v_cvt_pk_bf16_f32 v117, v118, v119
v_cvt_pk_bf16_f32 v118, v120, v121
v_cvt_pk_bf16_f32 v119, v122, v123
buffer_store_dwordx4 v[116:119], v16, s[52:55], s82 offen offset:0 sc1
v_mfma_f32_16x16x32_bf16 v[140:143], v[164:167], v[232:235], v[140:143]
v_fma_f32 v132, s86, v132, -v244
v_fma_f32 v133, s86, v133, -v244
v_fma_f32 v134, s86, v134, -v244
v_fma_f32 v135, s86, v135, -v244
v_fma_f32 v136, s86, v136, -v244
v_fma_f32 v137, s86, v137, -v244
v_fma_f32 v138, s86, v138, -v244
v_fma_f32 v139, s86, v139, -v244
v_cvt_pk_bf16_f32 v132, v132, v133
v_cvt_pk_bf16_f32 v133, v134, v135
v_cvt_pk_bf16_f32 v134, v136, v137
v_cvt_pk_bf16_f32 v135, v138, v139
buffer_store_dwordx4 v[132:135], v16, s[52:55], s83 offen offset:0 sc1
v_mfma_f32_16x16x32_bf16 v[156:159], v[164:167], v[236:239], v[156:159]
ds_read_b128 v[176:179], v30 offset:2048
v_fma_f32 v148, s86, v148, -v248
v_fma_f32 v149, s86, v149, -v248
v_fma_f32 v150, s86, v150, -v248
v_fma_f32 v151, s86, v151, -v248
v_fma_f32 v152, s86, v152, -v248
v_fma_f32 v153, s86, v153, -v248
v_fma_f32 v154, s86, v154, -v248
v_fma_f32 v155, s86, v155, -v248
v_cvt_pk_bf16_f32 v148, v148, v149
v_cvt_pk_bf16_f32 v149, v150, v151
v_cvt_pk_bf16_f32 v150, v152, v153
v_cvt_pk_bf16_f32 v151, v154, v155
buffer_store_dwordx4 v[148:151], v16, s[52:55], s84 offen offset:0 sc1
s_waitcnt lgkmcnt(2)
v_mfma_f32_16x16x32_bf16 v[124:127], v[168:171], v[204:207], v[124:127]
v_mfma_f32_16x16x32_bf16 v[140:143], v[168:171], v[208:211], v[140:143]
v_mfma_f32_16x16x32_bf16 v[156:159], v[168:171], v[212:215], v[156:159]
s_waitcnt lgkmcnt(1)
v_mfma_f32_16x16x32_bf16 v[128:131], v[172:175], v[228:231], v[128:131]
v_mfma_f32_16x16x32_bf16 v[144:147], v[172:175], v[232:235], v[144:147]
v_mfma_f32_16x16x32_bf16 v[160:163], v[172:175], v[236:239], v[160:163]
s_waitcnt lgkmcnt(0)
v_mfma_f32_16x16x32_bf16 v[128:131], v[176:179], v[204:207], v[128:131]
v_mfma_f32_16x16x32_bf16 v[144:147], v[176:179], v[208:211], v[144:147]
v_mfma_f32_16x16x32_bf16 v[160:163], v[176:179], v[212:215], v[160:163]
v_fma_f32 v124, s86, v124, -v240
v_fma_f32 v125, s86, v125, -v240
v_fma_f32 v126, s86, v126, -v240
v_fma_f32 v127, s86, v127, -v240
s_nop 1
v_fma_f32 v128, s86, v128, -v240
v_fma_f32 v129, s86, v129, -v240
v_fma_f32 v130, s86, v130, -v240
v_fma_f32 v131, s86, v131, -v240
v_cvt_pk_bf16_f32 v124, v124, v125
v_cvt_pk_bf16_f32 v125, v126, v127
v_cvt_pk_bf16_f32 v126, v128, v129
v_cvt_pk_bf16_f32 v127, v130, v131
buffer_store_dwordx4 v[124:127], v16, s[52:55], s82 offen offset:1024 sc1
v_fma_f32 v140, s86, v140, -v244
v_fma_f32 v141, s86, v141, -v244
v_fma_f32 v142, s86, v142, -v244
v_fma_f32 v143, s86, v143, -v244
v_fma_f32 v144, s86, v144, -v244
v_fma_f32 v145, s86, v145, -v244
v_fma_f32 v146, s86, v146, -v244
v_fma_f32 v147, s86, v147, -v244
v_cvt_pk_bf16_f32 v140, v140, v141
v_cvt_pk_bf16_f32 v141, v142, v143
v_cvt_pk_bf16_f32 v142, v144, v145
v_cvt_pk_bf16_f32 v143, v146, v147
buffer_store_dwordx4 v[140:143], v16, s[52:55], s83 offen offset:1024 sc1
v_fma_f32 v156, s86, v156, -v248
v_fma_f32 v157, s86, v157, -v248
v_fma_f32 v158, s86, v158, -v248
v_fma_f32 v159, s86, v159, -v248
v_fma_f32 v160, s86, v160, -v248
v_fma_f32 v161, s86, v161, -v248
v_fma_f32 v162, s86, v162, -v248
v_fma_f32 v163, s86, v163, -v248
v_cvt_pk_bf16_f32 v156, v156, v157
v_cvt_pk_bf16_f32 v157, v158, v159
v_cvt_pk_bf16_f32 v158, v160, v161
v_cvt_pk_bf16_f32 v159, v162, v163
buffer_store_dwordx4 v[156:159], v16, s[52:55], s84 offen offset:1024 sc1
L1_fin:
s_add_u32 s91, s91, 1344
s_waitcnt lgkmcnt(0)
s_add_u32 s98, s98, 0x7f4a7c15
s_addc_u32 s99, s99, 0x9e3779b9
LM_pub:
s_add_u32 s40, s38, 0x7c00000
s_addc_u32 s41, s39, 0
s_mov_b32 s42, 0x40000
s_mov_b32 s43, 0x00020000
s_lshl_b32 s6, s91, 7
s_cmp_eq_u32 s60, 0
s_cselect_b32 s6, s6, 0x70000000
v_lshlrev_b32 v12, 4, v2
s_waitcnt vmcnt(0) lgkmcnt(0)
s_barrier
v_mov_b32 v8, s98
v_mov_b32 v9, s99
v_mov_b32 v10, s98
v_mov_b32 v11, s99
s_mov_b64 exec, 0xff
buffer_store_dwordx4 v[8:11], v12, s[40:43], s6 offen sc1
s_mov_b64 exec, -1
s_cmp_eq_u32 s61, 0
s_cbranch_scc1 L2_entry
s_mov_b32 s61, 0
s_sub_u32 s4, s91, 1578
s_min_u32 s6, s4, 14
s_cmp_lt_u32 s4, 6
s_cselect_b32 s6, 0, s6
s_sub_u32 s4, s4, s6
s_add_u32 s91, s4, 1600
v_lshlrev_b32 v16, 4, v2
s_mul_i32 s63, s60, 12288
s_and_b32 s6, s4, 3
s_lshl_b32 s6, s6, 6
s_mul_i32 s7, s60, 16
s_add_u32 s6, s6, s7
v_lshrrev_b32 v5, 5, v2
v_and_b32 v6, 31, v2
v_lshlrev_b32 v6, 4, v6
s_cmp_ge_u32 s4, 4
s_cselect_b64 vcc, -1, 0
v_add3_u32 v7, v5, s6, 0
v_and_b32 v8, 0x80, v7
v_bfe_u32 v9, v7, 2, 1
v_lshl_or_b32 v8, v9, 6, v8
v_bfe_u32 v9, v7, 4, 1
v_lshl_or_b32 v8, v9, 5, v8
v_and_b32 v9, 3, v7
v_lshl_or_b32 v8, v9, 3, v8
v_bfe_u32 v9, v7, 5, 2
v_lshl_or_b32 v8, v9, 1, v8
v_bfe_u32 v9, v7, 3, 1
v_or_b32 v8, v9, v8
v_cndmask_b32 v8, v8, v7, vcc
v_lshl_add_u32 v44, v8, 9, v6
v_add3_u32 v7, v5, s6, 2
v_and_b32 v8, 0x80, v7
v_bfe_u32 v9, v7, 2, 1
v_lshl_or_b32 v8, v9, 6, v8
v_bfe_u32 v9, v7, 4, 1
v_lshl_or_b32 v8, v9, 5, v8
v_and_b32 v9, 3, v7
v_lshl_or_b32 v8, v9, 3, v8
v_bfe_u32 v9, v7, 5, 2
v_lshl_or_b32 v8, v9, 1, v8
v_bfe_u32 v9, v7, 3, 1
v_or_b32 v8, v9, v8
v_cndmask_b32 v8, v8, v7, vcc
v_lshl_add_u32 v48, v8, 9, v6
v_add3_u32 v7, v5, s6, 4
v_and_b32 v8, 0x80, v7
v_bfe_u32 v9, v7, 2, 1
v_lshl_or_b32 v8, v9, 6, v8
v_bfe_u32 v9, v7, 4, 1
v_lshl_or_b32 v8, v9, 5, v8
v_and_b32 v9, 3, v7
v_lshl_or_b32 v8, v9, 3, v8
v_bfe_u32 v9, v7, 5, 2
v_lshl_or_b32 v8, v9, 1, v8
v_bfe_u32 v9, v7, 3, 1
v_or_b32 v8, v9, v8
v_cndmask_b32 v8, v8, v7, vcc
v_lshl_add_u32 v52, v8, 9, v6
v_add3_u32 v7, v5, s6, 6
v_and_b32 v8, 0x80, v7
v_bfe_u32 v9, v7, 2, 1
v_lshl_or_b32 v8, v9, 6, v8
v_bfe_u32 v9, v7, 4, 1
v_lshl_or_b32 v8, v9, 5, v8
v_and_b32 v9, 3, v7
v_lshl_or_b32 v8, v9, 3, v8
v_bfe_u32 v9, v7, 5, 2
v_lshl_or_b32 v8, v9, 1, v8
v_bfe_u32 v9, v7, 3, 1
v_or_b32 v8, v9, v8
v_cndmask_b32 v8, v8, v7, vcc
v_lshl_add_u32 v56, v8, 9, v6
v_add3_u32 v7, v5, s6, 8
v_and_b32 v8, 0x80, v7
v_bfe_u32 v9, v7, 2, 1
v_lshl_or_b32 v8, v9, 6, v8
v_bfe_u32 v9, v7, 4, 1
v_lshl_or_b32 v8, v9, 5, v8
v_and_b32 v9, 3, v7
v_lshl_or_b32 v8, v9, 3, v8
v_bfe_u32 v9, v7, 5, 2
v_lshl_or_b32 v8, v9, 1, v8
v_bfe_u32 v9, v7, 3, 1
v_or_b32 v8, v9, v8
v_cndmask_b32 v8, v8, v7, vcc
v_lshl_add_u32 v60, v8, 9, v6
v_add3_u32 v7, v5, s6, 10
v_and_b32 v8, 0x80, v7
v_bfe_u32 v9, v7, 2, 1
v_lshl_or_b32 v8, v9, 6, v8
v_bfe_u32 v9, v7, 4, 1
v_lshl_or_b32 v8, v9, 5, v8
v_and_b32 v9, 3, v7
v_lshl_or_b32 v8, v9, 3, v8
v_bfe_u32 v9, v7, 5, 2
v_lshl_or_b32 v8, v9, 1, v8
v_bfe_u32 v9, v7, 3, 1
v_or_b32 v8, v9, v8
v_cndmask_b32 v8, v8, v7, vcc
v_lshl_add_u32 v64, v8, 9, v6
v_add3_u32 v7, v5, s6, 12
v_and_b32 v8, 0x80, v7
v_bfe_u32 v9, v7, 2, 1
v_lshl_or_b32 v8, v9, 6, v8
v_bfe_u32 v9, v7, 4, 1
v_lshl_or_b32 v8, v9, 5, v8
v_and_b32 v9, 3, v7
v_lshl_or_b32 v8, v9, 3, v8
v_bfe_u32 v9, v7, 5, 2
v_lshl_or_b32 v8, v9, 1, v8
v_bfe_u32 v9, v7, 3, 1
v_or_b32 v8, v9, v8
v_cndmask_b32 v8, v8, v7, vcc
v_lshl_add_u32 v68, v8, 9, v6
v_add3_u32 v7, v5, s6, 14
v_and_b32 v8, 0x80, v7
v_bfe_u32 v9, v7, 2, 1
v_lshl_or_b32 v8, v9, 6, v8
v_bfe_u32 v9, v7, 4, 1
v_lshl_or_b32 v8, v9, 5, v8
v_and_b32 v9, 3, v7
v_lshl_or_b32 v8, v9, 3, v8
v_bfe_u32 v9, v7, 5, 2
v_lshl_or_b32 v8, v9, 1, v8
v_bfe_u32 v9, v7, 3, 1
v_or_b32 v8, v9, v8
v_cndmask_b32 v8, v8, v7, vcc
v_lshl_add_u32 v72, v8, 9, v6
s_lshl_b32 s7, s60, 7
v_lshrrev_b32 v5, 3, v2
v_and_b32 v6, 7, v2
v_and_b32 v7, 2, v5
v_xor_b32 v6, v6, v7
v_lshl_add_u32 v5, v5, 9, s7
v_lshl_add_u32 v17, v6, 4, v5
v_xor_b32 v6, 4, v6
v_lshl_add_u32 v18, v6, 4, v5
v_add_u32 v18, 0xc00, v18
v_add_u32 v19, 0x1800, v17
v_add_u32 v20, 0x1800, v18
s_xor_b32 s6, s62, 0
s_lshl_b32 s66, s6, 14
s_xor_b32 s6, s62, 1
s_lshl_b32 s67, s6, 14
s_xor_b32 s6, s62, 2
s_lshl_b32 s68, s6, 14
s_xor_b32 s6, s62, 3
s_lshl_b32 s69, s6, 14
s_xor_b32 s6, s62, 4
s_lshl_b32 s70, s6, 14
s_xor_b32 s6, s62, 5
s_lshl_b32 s71, s6, 14
s_xor_b32 s6, s62, 6
s_lshl_b32 s72, s6, 14
s_xor_b32 s6, s62, 7
s_lshl_b32 s73, s6, 14
s_waitcnt lgkmcnt(0)
s_cmp_ge_u32 s4, 4
s_cselect_b32 s6, s30, s24
s_cselect_b32 s7, s31, s25
s_add_u32 s40, s6, 0x0
s_addc_u32 s41, s7, 0
s_mov_b32 s42, 0x20000
s_mov_b32 s43, 0x00020000
s_add_u32 s44, s32, 0x0
s_addc_u32 s45, s33, 0
s_mov_b32 s46, 0x20000
s_mov_b32 s47, 0x00020000
buffer_load_dwordx4 v[44:47], v44, s[40:43], 0 offen
buffer_load_dwordx4 v[48:51], v48, s[40:43], 0 offen
buffer_load_dwordx4 v[52:55], v52, s[40:43], 0 offen
buffer_load_dwordx4 v[56:59], v56, s[40:43], 0 offen
buffer_load_dwordx4 v[60:63], v60, s[40:43], 0 offen
buffer_load_dwordx4 v[64:67], v64, s[40:43], 0 offen
buffer_load_dwordx4 v[68:71], v68, s[40:43], 0 offen
buffer_load_dwordx4 v[72:75], v72, s[40:43], 0 offen
s_add_u32 m0, s63, 0x0
s_nop 0
buffer_load_dwordx4 v17, s[44:47], s66 offen offset:0 lds
buffer_load_dwordx4 v18, s[44:47], s66 offen offset:1024 lds
buffer_load_dwordx4 v19, s[44:47], s66 offen offset:2048 lds
buffer_load_dwordx4 v20, s[44:47], s66 offen offset:3072 lds
s_add_u32 m0, s63, 0x1000
s_nop 0
buffer_load_dwordx4 v17, s[44:47], s67 offen offset:0 lds
buffer_load_dwordx4 v18, s[44:47], s67 offen offset:1024 lds
buffer_load_dwordx4 v19, s[44:47], s67 offen offset:2048 lds
buffer_load_dwordx4 v20, s[44:47], s67 offen offset:3072 lds
v_bfe_u32 v5, v2, 2, 3
v_xor_b32 v5, s62, v5
v_and_b32 v6, 3, v2
v_lshlrev_b32 v7, 10, v5
v_lshl_add_u32 v7, v6, 8, v7
v_add_u32 v7, 0xc000, v7
v_and_b32 v5, 1, v5
v_lshl_or_b32 v6, v5, 2, v6
v_lshrrev_b32 v5, 5, v2
s_mul_i32 s6, s60, 16
v_add3_u32 v8, v5, s6, 0
v_lshrrev_b32 v9, 4, v8
v_lshl_add_u32 v9, v9, 13, v7
v_and_b32 v8, 15, v8
v_xor_b32 v8, v8, v6
v_lshl_add_u32 v36, v8, 4, v9
v_add3_u32 v8, v5, s6, 2
v_lshrrev_b32 v9, 4, v8
v_lshl_add_u32 v9, v9, 13, v7
v_and_b32 v8, 15, v8
v_xor_b32 v8, v8, v6
v_lshl_add_u32 v37, v8, 4, v9
v_add3_u32 v8, v5, s6, 4
v_lshrrev_b32 v9, 4, v8
v_lshl_add_u32 v9, v9, 13, v7
v_and_b32 v8, 15, v8
v_xor_b32 v8, v8, v6
v_lshl_add_u32 v38, v8, 4, v9
v_add3_u32 v8, v5, s6, 6
v_lshrrev_b32 v9, 4, v8
v_lshl_add_u32 v9, v9, 13, v7
v_and_b32 v8, 15, v8
v_xor_b32 v8, v8, v6
v_lshl_add_u32 v39, v8, 4, v9
v_add3_u32 v8, v5, s6, 8
v_lshrrev_b32 v9, 4, v8
v_lshl_add_u32 v9, v9, 13, v7
v_and_b32 v8, 15, v8
v_xor_b32 v8, v8, v6
v_lshl_add_u32 v40, v8, 4, v9
v_add3_u32 v8, v5, s6, 10
v_lshrrev_b32 v9, 4, v8
v_lshl_add_u32 v9, v9, 13, v7
v_and_b32 v8, 15, v8
v_xor_b32 v8, v8, v6
v_lshl_add_u32 v41, v8, 4, v9
v_add3_u32 v8, v5, s6, 12
v_lshrrev_b32 v9, 4, v8
v_lshl_add_u32 v9, v9, 13, v7
v_and_b32 v8, 15, v8
v_xor_b32 v8, v8, v6
v_lshl_add_u32 v42, v8, 4, v9
v_add3_u32 v8, v5, s6, 14
v_lshrrev_b32 v9, 4, v8
v_lshl_add_u32 v9, v9, 13, v7
v_and_b32 v8, 15, v8
v_xor_b32 v8, v8, v6
v_lshl_add_u32 v43, v8, 4, v9
v_xor_b32 v5, v3, v4
v_lshlrev_b32 v5, 4, v5
v_lshl_add_u32 v5, v4, 8, v5
v_add_u32 v31, 0xc000, v5
v_xor_b32 v32, 64, v31
v_lshrrev_b32 v5, 2, v3
v_and_b32 v6, 3, v3
v_and_b32 v7, 1, v4
v_lshlrev_b32 v7, 2, v7
v_and_b32 v8, 2, v5
v_or_b32 v7, v7, v8
v_lshl_add_u32 v8, v4, 3, v5
v_lshlrev_b32 v8, 7, v8
v_add_u32 v8, s63, v8
v_xor_b32 v6, v6, v7
v_xor_b32 v9, 0, v6
v_lshl_add_u32 v25, v9, 4, v8
v_add_u32 v26, 8, v25
v_xor_b32 v9, 4, v6
v_lshl_add_u32 v27, v9, 4, v8
v_add_u32 v28, 8, v27
s_lshr_b32 s6, s4, 2
s_lshl_b32 s6, s6, 17
s_and_b32 s7, s4, 3
s_lshl_b32 s7, s7, 12
s_add_u32 s6, s6, s7
s_mul_i32 s7, s60, 32768
s_add_u32 s82, s6, s7
s_add_u32 s83, s82, 16384
s_add_u32 s52, s38, 0x1000000
s_addc_u32 s53, s39, 0
s_mov_b32 s54, 0x40000
s_mov_b32 s55, 0x00020000
v_and_b32 v5, 31, v2
v_lshlrev_b32 v5, 4, v5
s_mov_b32 s6, 130560
s_mov_b32 s90, 0xffff0000
buffer_load_dwordx4 v[92:95], v5, s[40:43], s6 offen
s_waitcnt vmcnt(0)
v_lshlrev_b32 v84, 16, v92
v_lshlrev_b32 v86, 16, v93
v_lshlrev_b32 v88, 16, v94
v_lshlrev_b32 v90, 16, v95
v_and_b32 v85, s90, v92
v_and_b32 v87, s90, v93
v_and_b32 v89, s90, v94
v_and_b32 v91, s90, v95
v_lshlrev_b32 v76, 16, v44
v_lshlrev_b32 v78, 16, v45
v_lshlrev_b32 v80, 16, v46
v_lshlrev_b32 v82, 16, v47
v_and_b32 v77, s90, v44
v_and_b32 v79, s90, v45
v_and_b32 v81, s90, v46
v_and_b32 v83, s90, v47
v_sub_f32 v76, v76, v84
v_sub_f32 v77, v77, v85
v_sub_f32 v78, v78, v86
v_sub_f32 v79, v79, v87
v_sub_f32 v80, v80, v88
v_sub_f32 v81, v81, v89
v_sub_f32 v82, v82, v90
v_sub_f32 v83, v83, v91
v_cvt_pk_bf16_f32 v44, v76, v77
v_cvt_pk_bf16_f32 v45, v78, v79
v_cvt_pk_bf16_f32 v46, v80, v81
v_cvt_pk_bf16_f32 v47, v82, v83
v_lshlrev_b32 v76, 16, v48
v_lshlrev_b32 v78, 16, v49
v_lshlrev_b32 v80, 16, v50
v_lshlrev_b32 v82, 16, v51
v_and_b32 v77, s90, v48
v_and_b32 v79, s90, v49
v_and_b32 v81, s90, v50
v_and_b32 v83, s90, v51
v_sub_f32 v76, v76, v84
v_sub_f32 v77, v77, v85
v_sub_f32 v78, v78, v86
v_sub_f32 v79, v79, v87
v_sub_f32 v80, v80, v88
v_sub_f32 v81, v81, v89
v_sub_f32 v82, v82, v90
v_sub_f32 v83, v83, v91
v_cvt_pk_bf16_f32 v48, v76, v77
v_cvt_pk_bf16_f32 v49, v78, v79
v_cvt_pk_bf16_f32 v50, v80, v81
v_cvt_pk_bf16_f32 v51, v82, v83
v_lshlrev_b32 v76, 16, v52
v_lshlrev_b32 v78, 16, v53
v_lshlrev_b32 v80, 16, v54
v_lshlrev_b32 v82, 16, v55
v_and_b32 v77, s90, v52
v_and_b32 v79, s90, v53
v_and_b32 v81, s90, v54
v_and_b32 v83, s90, v55
v_sub_f32 v76, v76, v84
v_sub_f32 v77, v77, v85
v_sub_f32 v78, v78, v86
v_sub_f32 v79, v79, v87
v_sub_f32 v80, v80, v88
v_sub_f32 v81, v81, v89
v_sub_f32 v82, v82, v90
v_sub_f32 v83, v83, v91
v_cvt_pk_bf16_f32 v52, v76, v77
v_cvt_pk_bf16_f32 v53, v78, v79
v_cvt_pk_bf16_f32 v54, v80, v81
v_cvt_pk_bf16_f32 v55, v82, v83
v_lshlrev_b32 v76, 16, v56
v_lshlrev_b32 v78, 16, v57
v_lshlrev_b32 v80, 16, v58
v_lshlrev_b32 v82, 16, v59
v_and_b32 v77, s90, v56
v_and_b32 v79, s90, v57
v_and_b32 v81, s90, v58
v_and_b32 v83, s90, v59
v_sub_f32 v76, v76, v84
v_sub_f32 v77, v77, v85
v_sub_f32 v78, v78, v86
v_sub_f32 v79, v79, v87
v_sub_f32 v80, v80, v88
v_sub_f32 v81, v81, v89
v_sub_f32 v82, v82, v90
v_sub_f32 v83, v83, v91
v_cvt_pk_bf16_f32 v56, v76, v77
v_cvt_pk_bf16_f32 v57, v78, v79
v_cvt_pk_bf16_f32 v58, v80, v81
v_cvt_pk_bf16_f32 v59, v82, v83
v_lshlrev_b32 v76, 16, v60
v_lshlrev_b32 v78, 16, v61
v_lshlrev_b32 v80, 16, v62
v_lshlrev_b32 v82, 16, v63
v_and_b32 v77, s90, v60
v_and_b32 v79, s90, v61
v_and_b32 v81, s90, v62
v_and_b32 v83, s90, v63
v_sub_f32 v76, v76, v84
v_sub_f32 v77, v77, v85
v_sub_f32 v78, v78, v86
v_sub_f32 v79, v79, v87
v_sub_f32 v80, v80, v88
v_sub_f32 v81, v81, v89
v_sub_f32 v82, v82, v90
v_sub_f32 v83, v83, v91
v_cvt_pk_bf16_f32 v60, v76, v77
v_cvt_pk_bf16_f32 v61, v78, v79
v_cvt_pk_bf16_f32 v62, v80, v81
v_cvt_pk_bf16_f32 v63, v82, v83
v_lshlrev_b32 v76, 16, v64
v_lshlrev_b32 v78, 16, v65
v_lshlrev_b32 v80, 16, v66
v_lshlrev_b32 v82, 16, v67
v_and_b32 v77, s90, v64
v_and_b32 v79, s90, v65
v_and_b32 v81, s90, v66
v_and_b32 v83, s90, v67
v_sub_f32 v76, v76, v84
v_sub_f32 v77, v77, v85
v_sub_f32 v78, v78, v86
v_sub_f32 v79, v79, v87
v_sub_f32 v80, v80, v88
v_sub_f32 v81, v81, v89
v_sub_f32 v82, v82, v90
v_sub_f32 v83, v83, v91
v_cvt_pk_bf16_f32 v64, v76, v77
v_cvt_pk_bf16_f32 v65, v78, v79
v_cvt_pk_bf16_f32 v66, v80, v81
v_cvt_pk_bf16_f32 v67, v82, v83
v_lshlrev_b32 v76, 16, v68
v_lshlrev_b32 v78, 16, v69
v_lshlrev_b32 v80, 16, v70
v_lshlrev_b32 v82, 16, v71
v_and_b32 v77, s90, v68
v_and_b32 v79, s90, v69
v_and_b32 v81, s90, v70
v_and_b32 v83, s90, v71
v_sub_f32 v76, v76, v84
v_sub_f32 v77, v77, v85
v_sub_f32 v78, v78, v86
v_sub_f32 v79, v79, v87
v_sub_f32 v80, v80, v88
v_sub_f32 v81, v81, v89
v_sub_f32 v82, v82, v90
v_sub_f32 v83, v83, v91
v_cvt_pk_bf16_f32 v68, v76, v77
v_cvt_pk_bf16_f32 v69, v78, v79
v_cvt_pk_bf16_f32 v70, v80, v81
v_cvt_pk_bf16_f32 v71, v82, v83
v_lshlrev_b32 v76, 16, v72
v_lshlrev_b32 v78, 16, v73
v_lshlrev_b32 v80, 16, v74
v_lshlrev_b32 v82, 16, v75
v_and_b32 v77, s90, v72
v_and_b32 v79, s90, v73
v_and_b32 v81, s90, v74
v_and_b32 v83, s90, v75
v_sub_f32 v76, v76, v84
v_sub_f32 v77, v77, v85
v_sub_f32 v78, v78, v86
v_sub_f32 v79, v79, v87
v_sub_f32 v80, v80, v88
v_sub_f32 v81, v81, v89
v_sub_f32 v82, v82, v90
v_sub_f32 v83, v83, v91
v_cvt_pk_bf16_f32 v72, v76, v77
v_cvt_pk_bf16_f32 v73, v78, v79
v_cvt_pk_bf16_f32 v74, v80, v81
v_cvt_pk_bf16_f32 v75, v82, v83
ds_write_b128 v36, v[44:47]
ds_write_b128 v37, v[48:51]
ds_write_b128 v38, v[52:55]
ds_write_b128 v39, v[56:59]
ds_write_b128 v40, v[60:63]
ds_write_b128 v41, v[64:67]
ds_write_b128 v42, v[68:71]
ds_write_b128 v43, v[72:75]
s_add_u32 m0, s63, 0x2000
s_nop 0
buffer_load_dwordx4 v17, s[44:47], s68 offen offset:0 lds
buffer_load_dwordx4 v18, s[44:47], s68 offen offset:1024 lds
buffer_load_dwordx4 v19, s[44:47], s68 offen offset:2048 lds
buffer_load_dwordx4 v20, s[44:47], s68 offen offset:3072 lds
ds_read_b64_tr_b16 v[140:141], v25 offset:0
ds_read_b64_tr_b16 v[142:143], v25 offset:512
ds_read_b64_tr_b16 v[144:145], v26 offset:0
ds_read_b64_tr_b16 v[146:147], v26 offset:512
ds_read_b64_tr_b16 v[148:149], v27 offset:0
ds_read_b64_tr_b16 v[150:151], v27 offset:512
s_waitcnt lgkmcnt(6)
s_barrier
ds_read_b128 v[180:183], v31 offset:0
ds_read_b128 v[184:187], v31 offset:8192
ds_read_b128 v[188:191], v31 offset:16384
ds_read_b128 v[192:195], v31 offset:24576
s_waitcnt lgkmcnt(3)
v_mfma_f32_16x16x32_bf16 v[76:79], v[180:183], v[140:143], 0
s_waitcnt lgkmcnt(2)
v_mfma_f32_16x16x32_bf16 v[80:83], v[184:187], v[140:143], 0
s_waitcnt lgkmcnt(1)
v_mfma_f32_16x16x32_bf16 v[84:87], v[188:191], v[140:143], 0
s_waitcnt lgkmcnt(0)
v_mfma_f32_16x16x32_bf16 v[88:91], v[192:195], v[140:143], 0
ds_read_b64_tr_b16 v[152:153], v28 offset:0
ds_read_b64_tr_b16 v[154:155], v28 offset:512
v_mfma_f32_16x16x32_bf16 v[92:95], v[180:183], v[144:147], 0
v_mfma_f32_16x16x32_bf16 v[96:99], v[184:187], v[144:147], 0
v_mfma_f32_16x16x32_bf16 v[100:103], v[188:191], v[144:147], 0
v_mfma_f32_16x16x32_bf16 v[104:107], v[192:195], v[144:147], 0
ds_read_b128 v[196:199], v32 offset:1024
ds_read_b64_tr_b16 v[156:157], v25 offset:4096
ds_read_b64_tr_b16 v[158:159], v25 offset:4608
v_mfma_f32_16x16x32_bf16 v[108:111], v[180:183], v[148:151], 0
ds_read_b128 v[200:203], v32 offset:9216
v_mfma_f32_16x16x32_bf16 v[112:115], v[184:187], v[148:151], 0
ds_read_b128 v[204:207], v32 offset:17408
v_mfma_f32_16x16x32_bf16 v[116:119], v[188:191], v[148:151], 0
ds_read_b128 v[208:211], v32 offset:25600
v_mfma_f32_16x16x32_bf16 v[120:123], v[192:195], v[148:151], 0
ds_read_b64_tr_b16 v[160:161], v26 offset:4096
ds_read_b64_tr_b16 v[162:163], v26 offset:4608
s_waitcnt lgkmcnt(8)
v_mfma_f32_16x16x32_bf16 v[124:127], v[180:183], v[152:155], 0
s_add_u32 m0, s63, 0x0
s_nop 0
buffer_load_dwordx4 v17, s[44:47], s69 offen offset:0 lds
buffer_load_dwordx4 v18, s[44:47], s69 offen offset:1024 lds
buffer_load_dwordx4 v19, s[44:47], s69 offen offset:2048 lds
buffer_load_dwordx4 v20, s[44:47], s69 offen offset:3072 lds
v_mfma_f32_16x16x32_bf16 v[128:131], v[184:187], v[152:155], 0
v_mfma_f32_16x16x32_bf16 v[132:135], v[188:191], v[152:155], 0
v_mfma_f32_16x16x32_bf16 v[136:139], v[192:195], v[152:155], 0
ds_read_b64_tr_b16 v[164:165], v27 offset:4096
ds_read_b64_tr_b16 v[166:167], v27 offset:4608
s_waitcnt lgkmcnt(7)
v_mfma_f32_16x16x32_bf16 v[76:79], v[196:199], v[156:159], v[76:79]
s_waitcnt lgkmcnt(6)
v_mfma_f32_16x16x32_bf16 v[80:83], v[200:203], v[156:159], v[80:83]
s_waitcnt lgkmcnt(5)
v_mfma_f32_16x16x32_bf16 v[84:87], v[204:207], v[156:159], v[84:87]
s_waitcnt lgkmcnt(4)
v_mfma_f32_16x16x32_bf16 v[88:91], v[208:211], v[156:159], v[88:91]
ds_read_b64_tr_b16 v[168:169], v28 offset:4096
ds_read_b64_tr_b16 v[170:171], v28 offset:4608
s_waitcnt lgkmcnt(4)
v_mfma_f32_16x16x32_bf16 v[92:95], v[196:199], v[160:163], v[92:95]
v_mfma_f32_16x16x32_bf16 v[96:99], v[200:203], v[160:163], v[96:99]
v_mfma_f32_16x16x32_bf16 v[100:103], v[204:207], v[160:163], v[100:103]
v_mfma_f32_16x16x32_bf16 v[104:107], v[208:211], v[160:163], v[104:107]
ds_read_b128 v[212:215], v31 offset:2048
s_waitcnt vmcnt(4)
ds_read_b64_tr_b16 v[172:173], v25 offset:8192
ds_read_b64_tr_b16 v[174:175], v25 offset:8704
s_waitcnt lgkmcnt(5)
v_mfma_f32_16x16x32_bf16 v[108:111], v[196:199], v[164:167], v[108:111]
ds_read_b128 v[216:219], v31 offset:10240
v_mfma_f32_16x16x32_bf16 v[112:115], v[200:203], v[164:167], v[112:115]
ds_read_b128 v[220:223], v31 offset:18432
v_mfma_f32_16x16x32_bf16 v[116:119], v[204:207], v[164:167], v[116:119]
ds_read_b128 v[224:227], v31 offset:26624
v_mfma_f32_16x16x32_bf16 v[120:123], v[208:211], v[164:167], v[120:123]
ds_read_b64_tr_b16 v[176:177], v26 offset:8192
ds_read_b64_tr_b16 v[178:179], v26 offset:8704
s_waitcnt lgkmcnt(8)
v_mfma_f32_16x16x32_bf16 v[124:127], v[196:199], v[168:171], v[124:127]
s_add_u32 m0, s63, 0x1000
s_nop 0
buffer_load_dwordx4 v17, s[44:47], s70 offen offset:0 lds
buffer_load_dwordx4 v18, s[44:47], s70 offen offset:1024 lds
buffer_load_dwordx4 v19, s[44:47], s70 offen offset:2048 lds
buffer_load_dwordx4 v20, s[44:47], s70 offen offset:3072 lds
v_mfma_f32_16x16x32_bf16 v[128:131], v[200:203], v[168:171], v[128:131]
v_mfma_f32_16x16x32_bf16 v[132:135], v[204:207], v[168:171], v[132:135]
v_mfma_f32_16x16x32_bf16 v[136:139], v[208:211], v[168:171], v[136:139]
ds_read_b64_tr_b16 v[140:141], v27 offset:8192
ds_read_b64_tr_b16 v[142:143], v27 offset:8704
s_waitcnt lgkmcnt(7)
v_mfma_f32_16x16x32_bf16 v[76:79], v[212:215], v[172:175], v[76:79]
s_waitcnt lgkmcnt(6)
v_mfma_f32_16x16x32_bf16 v[80:83], v[216:219], v[172:175], v[80:83]
s_waitcnt lgkmcnt(5)
v_mfma_f32_16x16x32_bf16 v[84:87], v[220:223], v[172:175], v[84:87]
s_waitcnt lgkmcnt(4)
v_mfma_f32_16x16x32_bf16 v[88:91], v[224:227], v[172:175], v[88:91]
ds_read_b64_tr_b16 v[144:145], v28 offset:8192
ds_read_b64_tr_b16 v[146:147], v28 offset:8704
s_waitcnt lgkmcnt(4)
v_mfma_f32_16x16x32_bf16 v[92:95], v[212:215], v[176:179], v[92:95]
v_mfma_f32_16x16x32_bf16 v[96:99], v[216:219], v[176:179], v[96:99]
v_mfma_f32_16x16x32_bf16 v[100:103], v[220:223], v[176:179], v[100:103]
v_mfma_f32_16x16x32_bf16 v[104:107], v[224:227], v[176:179], v[104:107]
ds_read_b128 v[180:183], v32 offset:3072
s_waitcnt vmcnt(4)
ds_read_b64_tr_b16 v[148:149], v25 offset:0
ds_read_b64_tr_b16 v[150:151], v25 offset:512
s_waitcnt lgkmcnt(5)
v_mfma_f32_16x16x32_bf16 v[108:111], v[212:215], v[140:143], v[108:111]
ds_read_b128 v[184:187], v32 offset:11264
v_mfma_f32_16x16x32_bf16 v[112:115], v[216:219], v[140:143], v[112:115]
ds_read_b128 v[188:191], v32 offset:19456
v_mfma_f32_16x16x32_bf16 v[116:119], v[220:223], v[140:143], v[116:119]
ds_read_b128 v[192:195], v32 offset:27648
v_mfma_f32_16x16x32_bf16 v[120:123], v[224:227], v[140:143], v[120:123]
ds_read_b64_tr_b16 v[152:153], v26 offset:0
ds_read_b64_tr_b16 v[154:155], v26 offset:512
s_waitcnt lgkmcnt(8)
v_mfma_f32_16x16x32_bf16 v[124:127], v[212:215], v[144:147], v[124:127]
s_add_u32 m0, s63, 0x2000
s_nop 0
buffer_load_dwordx4 v17, s[44:47], s71 offen offset:0 lds
buffer_load_dwordx4 v18, s[44:47], s71 offen offset:1024 lds
buffer_load_dwordx4 v19, s[44:47], s71 offen offset:2048 lds
buffer_load_dwordx4 v20, s[44:47], s71 offen offset:3072 lds
v_mfma_f32_16x16x32_bf16 v[128:131], v[216:219], v[144:147], v[128:131]
v_mfma_f32_16x16x32_bf16 v[132:135], v[220:223], v[144:147], v[132:135]
v_mfma_f32_16x16x32_bf16 v[136:139], v[224:227], v[144:147], v[136:139]
ds_read_b64_tr_b16 v[156:157], v27 offset:0
ds_read_b64_tr_b16 v[158:159], v27 offset:512
s_waitcnt lgkmcnt(7)
v_mfma_f32_16x16x32_bf16 v[76:79], v[180:183], v[148:151], v[76:79]
s_waitcnt lgkmcnt(6)
v_mfma_f32_16x16x32_bf16 v[80:83], v[184:187], v[148:151], v[80:83]
s_waitcnt lgkmcnt(5)
v_mfma_f32_16x16x32_bf16 v[84:87], v[188:191], v[148:151], v[84:87]
s_waitcnt lgkmcnt(4)
v_mfma_f32_16x16x32_bf16 v[88:91], v[192:195], v[148:151], v[88:91]
ds_read_b64_tr_b16 v[160:161], v28 offset:0
ds_read_b64_tr_b16 v[162:163], v28 offset:512
s_waitcnt lgkmcnt(4)
v_mfma_f32_16x16x32_bf16 v[92:95], v[180:183], v[152:155], v[92:95]
v_mfma_f32_16x16x32_bf16 v[96:99], v[184:187], v[152:155], v[96:99]
v_mfma_f32_16x16x32_bf16 v[100:103], v[188:191], v[152:155], v[100:103]
v_mfma_f32_16x16x32_bf16 v[104:107], v[192:195], v[152:155], v[104:107]
ds_read_b128 v[196:199], v31 offset:4096
s_waitcnt vmcnt(4)
ds_read_b64_tr_b16 v[164:165], v25 offset:4096
ds_read_b64_tr_b16 v[166:167], v25 offset:4608
s_waitcnt lgkmcnt(5)
v_mfma_f32_16x16x32_bf16 v[108:111], v[180:183], v[156:159], v[108:111]
ds_read_b128 v[200:203], v31 offset:12288
v_mfma_f32_16x16x32_bf16 v[112:115], v[184:187], v[156:159], v[112:115]
ds_read_b128 v[204:207], v31 offset:20480
v_mfma_f32_16x16x32_bf16 v[116:119], v[188:191], v[156:159], v[116:119]
ds_read_b128 v[208:211], v31 offset:28672
v_mfma_f32_16x16x32_bf16 v[120:123], v[192:195], v[156:159], v[120:123]
ds_read_b64_tr_b16 v[168:169], v26 offset:4096
ds_read_b64_tr_b16 v[170:171], v26 offset:4608
s_waitcnt lgkmcnt(8)
v_mfma_f32_16x16x32_bf16 v[124:127], v[180:183], v[160:163], v[124:127]
s_add_u32 m0, s63, 0x0
s_nop 0
buffer_load_dwordx4 v17, s[44:47], s72 offen offset:0 lds
buffer_load_dwordx4 v18, s[44:47], s72 offen offset:1024 lds
buffer_load_dwordx4 v19, s[44:47], s72 offen offset:2048 lds
buffer_load_dwordx4 v20, s[44:47], s72 offen offset:3072 lds
v_mfma_f32_16x16x32_bf16 v[128:131], v[184:187], v[160:163], v[128:131]
v_mfma_f32_16x16x32_bf16 v[132:135], v[188:191], v[160:163], v[132:135]
v_mfma_f32_16x16x32_bf16 v[136:139], v[192:195], v[160:163], v[136:139]
ds_read_b64_tr_b16 v[172:173], v27 offset:4096
ds_read_b64_tr_b16 v[174:175], v27 offset:4608
s_waitcnt lgkmcnt(7)
v_mfma_f32_16x16x32_bf16 v[76:79], v[196:199], v[164:167], v[76:79]
s_waitcnt lgkmcnt(6)
v_mfma_f32_16x16x32_bf16 v[80:83], v[200:203], v[164:167], v[80:83]
s_waitcnt lgkmcnt(5)
v_mfma_f32_16x16x32_bf16 v[84:87], v[204:207], v[164:167], v[84:87]
s_waitcnt lgkmcnt(4)
v_mfma_f32_16x16x32_bf16 v[88:91], v[208:211], v[164:167], v[88:91]
ds_read_b64_tr_b16 v[176:177], v28 offset:4096
ds_read_b64_tr_b16 v[178:179], v28 offset:4608
s_waitcnt lgkmcnt(4)
v_mfma_f32_16x16x32_bf16 v[92:95], v[196:199], v[168:171], v[92:95]
v_mfma_f32_16x16x32_bf16 v[96:99], v[200:203], v[168:171], v[96:99]
v_mfma_f32_16x16x32_bf16 v[100:103], v[204:207], v[168:171], v[100:103]
v_mfma_f32_16x16x32_bf16 v[104:107], v[208:211], v[168:171], v[104:107]
ds_read_b128 v[212:215], v32 offset:5120
s_waitcnt vmcnt(4)
ds_read_b64_tr_b16 v[140:141], v25 offset:8192
ds_read_b64_tr_b16 v[142:143], v25 offset:8704
s_waitcnt lgkmcnt(5)
v_mfma_f32_16x16x32_bf16 v[108:111], v[196:199], v[172:175], v[108:111]
ds_read_b128 v[216:219], v32 offset:13312
v_mfma_f32_16x16x32_bf16 v[112:115], v[200:203], v[172:175], v[112:115]
ds_read_b128 v[220:223], v32 offset:21504
v_mfma_f32_16x16x32_bf16 v[116:119], v[204:207], v[172:175], v[116:119]
ds_read_b128 v[224:227], v32 offset:29696
v_mfma_f32_16x16x32_bf16 v[120:123], v[208:211], v[172:175], v[120:123]
ds_read_b64_tr_b16 v[144:145], v26 offset:8192
ds_read_b64_tr_b16 v[146:147], v26 offset:8704
s_waitcnt lgkmcnt(8)
v_mfma_f32_16x16x32_bf16 v[124:127], v[196:199], v[176:179], v[124:127]
s_add_u32 m0, s63, 0x1000
s_nop 0
buffer_load_dwordx4 v17, s[44:47], s73 offen offset:0 lds
buffer_load_dwordx4 v18, s[44:47], s73 offen offset:1024 lds
buffer_load_dwordx4 v19, s[44:47], s73 offen offset:2048 lds
buffer_load_dwordx4 v20, s[44:47], s73 offen offset:3072 lds
v_mfma_f32_16x16x32_bf16 v[128:131], v[200:203], v[176:179], v[128:131]
v_mfma_f32_16x16x32_bf16 v[132:135], v[204:207], v[176:179], v[132:135]
v_mfma_f32_16x16x32_bf16 v[136:139], v[208:211], v[176:179], v[136:139]
ds_read_b64_tr_b16 v[148:149], v27 offset:8192
ds_read_b64_tr_b16 v[150:151], v27 offset:8704
s_waitcnt lgkmcnt(7)
v_mfma_f32_16x16x32_bf16 v[76:79], v[212:215], v[140:143], v[76:79]
s_waitcnt lgkmcnt(6)
v_mfma_f32_16x16x32_bf16 v[80:83], v[216:219], v[140:143], v[80:83]
s_waitcnt lgkmcnt(5)
v_mfma_f32_16x16x32_bf16 v[84:87], v[220:223], v[140:143], v[84:87]
s_waitcnt lgkmcnt(4)
v_mfma_f32_16x16x32_bf16 v[88:91], v[224:227], v[140:143], v[88:91]
ds_read_b64_tr_b16 v[152:153], v28 offset:8192
ds_read_b64_tr_b16 v[154:155], v28 offset:8704
s_waitcnt lgkmcnt(4)
v_mfma_f32_16x16x32_bf16 v[92:95], v[212:215], v[144:147], v[92:95]
v_mfma_f32_16x16x32_bf16 v[96:99], v[216:219], v[144:147], v[96:99]
v_mfma_f32_16x16x32_bf16 v[100:103], v[220:223], v[144:147], v[100:103]
v_mfma_f32_16x16x32_bf16 v[104:107], v[224:227], v[144:147], v[104:107]
ds_read_b128 v[180:183], v31 offset:6144
s_waitcnt vmcnt(4)
ds_read_b64_tr_b16 v[156:157], v25 offset:0
ds_read_b64_tr_b16 v[158:159], v25 offset:512
s_waitcnt lgkmcnt(5)
v_mfma_f32_16x16x32_bf16 v[108:111], v[212:215], v[148:151], v[108:111]
ds_read_b128 v[184:187], v31 offset:14336
v_mfma_f32_16x16x32_bf16 v[112:115], v[216:219], v[148:151], v[112:115]
ds_read_b128 v[188:191], v31 offset:22528
v_mfma_f32_16x16x32_bf16 v[116:119], v[220:223], v[148:151], v[116:119]
ds_read_b128 v[192:195], v31 offset:30720
v_mfma_f32_16x16x32_bf16 v[120:123], v[224:227], v[148:151], v[120:123]
ds_read_b64_tr_b16 v[160:161], v26 offset:0
ds_read_b64_tr_b16 v[162:163], v26 offset:512
s_waitcnt lgkmcnt(8)
v_mfma_f32_16x16x32_bf16 v[124:127], v[212:215], v[152:155], v[124:127]
v_mfma_f32_16x16x32_bf16 v[128:131], v[216:219], v[152:155], v[128:131]
v_mfma_f32_16x16x32_bf16 v[132:135], v[220:223], v[152:155], v[132:135]
v_mfma_f32_16x16x32_bf16 v[136:139], v[224:227], v[152:155], v[136:139]
ds_read_b64_tr_b16 v[164:165], v27 offset:0
ds_read_b64_tr_b16 v[166:167], v27 offset:512
s_waitcnt lgkmcnt(7)
v_mfma_f32_16x16x32_bf16 v[76:79], v[180:183], v[156:159], v[76:79]
s_waitcnt lgkmcnt(6)
v_mfma_f32_16x16x32_bf16 v[80:83], v[184:187], v[156:159], v[80:83]
s_waitcnt lgkmcnt(5)
v_mfma_f32_16x16x32_bf16 v[84:87], v[188:191], v[156:159], v[84:87]
s_waitcnt lgkmcnt(4)
v_mfma_f32_16x16x32_bf16 v[88:91], v[192:195], v[156:159], v[88:91]
ds_read_b64_tr_b16 v[168:169], v28 offset:0
ds_read_b64_tr_b16 v[170:171], v28 offset:512
s_waitcnt lgkmcnt(4)
v_mfma_f32_16x16x32_bf16 v[92:95], v[180:183], v[160:163], v[92:95]
v_mfma_f32_16x16x32_bf16 v[96:99], v[184:187], v[160:163], v[96:99]
v_mfma_f32_16x16x32_bf16 v[100:103], v[188:191], v[160:163], v[100:103]
v_mfma_f32_16x16x32_bf16 v[104:107], v[192:195], v[160:163], v[104:107]
ds_read_b128 v[196:199], v32 offset:7168
s_waitcnt vmcnt(0)
ds_read_b64_tr_b16 v[172:173], v25 offset:4096
ds_read_b64_tr_b16 v[174:175], v25 offset:4608
s_waitcnt lgkmcnt(5)
v_mfma_f32_16x16x32_bf16 v[108:111], v[180:183], v[164:167], v[108:111]
ds_read_b128 v[200:203], v32 offset:15360
v_mfma_f32_16x16x32_bf16 v[112:115], v[184:187], v[164:167], v[112:115]
ds_read_b128 v[204:207], v32 offset:23552
v_mfma_f32_16x16x32_bf16 v[116:119], v[188:191], v[164:167], v[116:119]
ds_read_b128 v[208:211], v32 offset:31744
v_mfma_f32_16x16x32_bf16 v[120:123], v[192:195], v[164:167], v[120:123]
ds_read_b64_tr_b16 v[176:177], v26 offset:4096
ds_read_b64_tr_b16 v[178:179], v26 offset:4608
s_waitcnt lgkmcnt(8)
v_mfma_f32_16x16x32_bf16 v[124:127], v[180:183], v[168:171], v[124:127]
v_mfma_f32_16x16x32_bf16 v[128:131], v[184:187], v[168:171], v[128:131]
v_mfma_f32_16x16x32_bf16 v[132:135], v[188:191], v[168:171], v[132:135]
v_mfma_f32_16x16x32_bf16 v[136:139], v[192:195], v[168:171], v[136:139]
ds_read_b64_tr_b16 v[140:141], v27 offset:4096
ds_read_b64_tr_b16 v[142:143], v27 offset:4608
s_waitcnt lgkmcnt(7)
v_mfma_f32_16x16x32_bf16 v[76:79], v[196:199], v[172:175], v[76:79]
s_waitcnt lgkmcnt(6)
v_mfma_f32_16x16x32_bf16 v[80:83], v[200:203], v[172:175], v[80:83]
s_waitcnt lgkmcnt(5)
v_mfma_f32_16x16x32_bf16 v[84:87], v[204:207], v[172:175], v[84:87]
s_waitcnt lgkmcnt(4)
v_mfma_f32_16x16x32_bf16 v[88:91], v[208:211], v[172:175], v[88:91]
ds_read_b64_tr_b16 v[144:145], v28 offset:4096
ds_read_b64_tr_b16 v[146:147], v28 offset:4608
s_waitcnt lgkmcnt(4)
v_mfma_f32_16x16x32_bf16 v[92:95], v[196:199], v[176:179], v[92:95]
v_cvt_pk_bf16_f32 v76, v76, v77
v_cvt_pk_bf16_f32 v77, v78, v79
v_cvt_pk_bf16_f32 v78, v80, v81
v_cvt_pk_bf16_f32 v79, v82, v83
buffer_store_dwordx4 v[76:79], v16, s[52:55], s82 offen offset:0 sc1
v_mfma_f32_16x16x32_bf16 v[96:99], v[200:203], v[176:179], v[96:99]
v_mfma_f32_16x16x32_bf16 v[100:103], v[204:207], v[176:179], v[100:103]
v_cvt_pk_bf16_f32 v84, v84, v85
v_cvt_pk_bf16_f32 v85, v86, v87
v_cvt_pk_bf16_f32 v86, v88, v89
v_cvt_pk_bf16_f32 v87, v90, v91
buffer_store_dwordx4 v[84:87], v16, s[52:55], s82 offen offset:2048 sc1
v_mfma_f32_16x16x32_bf16 v[104:107], v[208:211], v[176:179], v[104:107]
s_waitcnt lgkmcnt(2)
v_mfma_f32_16x16x32_bf16 v[108:111], v[196:199], v[140:143], v[108:111]
v_cvt_pk_bf16_f32 v92, v92, v93
v_cvt_pk_bf16_f32 v93, v94, v95
v_cvt_pk_bf16_f32 v94, v96, v97
v_cvt_pk_bf16_f32 v95, v98, v99
buffer_store_dwordx4 v[92:95], v16, s[52:55], s82 offen offset:1024 sc1
v_mfma_f32_16x16x32_bf16 v[112:115], v[200:203], v[140:143], v[112:115]
v_mfma_f32_16x16x32_bf16 v[116:119], v[204:207], v[140:143], v[116:119]
v_cvt_pk_bf16_f32 v100, v100, v101
v_cvt_pk_bf16_f32 v101, v102, v103
v_cvt_pk_bf16_f32 v102, v104, v105
v_cvt_pk_bf16_f32 v103, v106, v107
buffer_store_dwordx4 v[100:103], v16, s[52:55], s82 offen offset:3072 sc1
v_mfma_f32_16x16x32_bf16 v[120:123], v[208:211], v[140:143], v[120:123]
s_waitcnt lgkmcnt(0)
v_mfma_f32_16x16x32_bf16 v[124:127], v[196:199], v[144:147], v[124:127]
v_cvt_pk_bf16_f32 v108, v108, v109
v_cvt_pk_bf16_f32 v109, v110, v111
v_cvt_pk_bf16_f32 v110, v112, v113
v_cvt_pk_bf16_f32 v111, v114, v115
buffer_store_dwordx4 v[108:111], v16, s[52:55], s83 offen offset:0 sc1
v_mfma_f32_16x16x32_bf16 v[128:131], v[200:203], v[144:147], v[128:131]
v_mfma_f32_16x16x32_bf16 v[132:135], v[204:207], v[144:147], v[132:135]
v_cvt_pk_bf16_f32 v116, v116, v117
v_cvt_pk_bf16_f32 v117, v118, v119
v_cvt_pk_bf16_f32 v118, v120, v121
v_cvt_pk_bf16_f32 v119, v122, v123
buffer_store_dwordx4 v[116:119], v16, s[52:55], s83 offen offset:2048 sc1
v_mfma_f32_16x16x32_bf16 v[136:139], v[208:211], v[144:147], v[136:139]
v_cvt_pk_bf16_f32 v124, v124, v125
v_cvt_pk_bf16_f32 v125, v126, v127
v_cvt_pk_bf16_f32 v126, v128, v129
v_cvt_pk_bf16_f32 v127, v130, v131
buffer_store_dwordx4 v[124:127], v16, s[52:55], s83 offen offset:1024 sc1
v_cvt_pk_bf16_f32 v132, v132, v133
v_cvt_pk_bf16_f32 v133, v134, v135
s_nop 0
v_cvt_pk_bf16_f32 v134, v136, v137
v_cvt_pk_bf16_f32 v135, v138, v139
buffer_store_dwordx4 v[132:135], v16, s[52:55], s83 offen offset:3072 sc1
s_branch LM_pub
LM_light:
s_mov_b32 s61, 1
s_waitcnt lgkmcnt(0)
s_mov_b32 s98, 0x7c3ff80
s_load_dwordx2 s[98:99], s[38:39], s98
s_branch L1_fin
LM_edge:
s_sub_u32 s4, s3, 30
s_lshl_b32 s8, s8, 1
s_add_u32 s4, s4, s8
s_add_u32 s91, s4, 240
s_cmp_ge_u32 s4, 14
s_cselect_b32 s61, 1, 0
s_mul_i32 s6, s4, 40000
v_lshlrev_b32 v5, 4, v0
v_lshlrev_b32 v6, 2, v2
v_add_u32 v6, 0x10000, v6
v_mov_b32 v7, 0
ds_write_b32 v6, v7
s_mov_b32 s66, 0
s_mov_b32 s67, 4096
s_mov_b32 s68, 8192
s_mov_b32 s69, 12288
s_mov_b32 s70, 16384
s_mov_b32 s71, 20480
s_mov_b32 s72, 24576
s_mov_b32 s73, 28672
s_mov_b32 s74, 32768
s_mov_b32 s75, 36864
s_waitcnt lgkmcnt(0)
s_add_u32 s40, s20, 0x0
s_addc_u32 s41, s21, 0
s_add_u32 s40, s40, s6
s_addc_u32 s41, s41, 0
s_mov_b32 s42, 0x9c40
s_mov_b32 s43, 0x00020000
s_add_u32 s44, s18, 0x0
s_addc_u32 s45, s19, 0
s_add_u32 s44, s44, s6
s_addc_u32 s45, s45, 0
s_mov_b32 s46, 0x9c40
s_mov_b32 s47, 0x00020000
buffer_load_dwordx4 v[16:19], v5, s[40:43], s66 offen
buffer_load_dwordx4 v[20:23], v5, s[40:43], s67 offen
buffer_load_dwordx4 v[24:27], v5, s[40:43], s68 offen
buffer_load_dwordx4 v[28:31], v5, s[40:43], s69 offen
buffer_load_dwordx4 v[32:35], v5, s[40:43], s70 offen
buffer_load_dwordx4 v[36:39], v5, s[40:43], s71 offen
buffer_load_dwordx4 v[40:43], v5, s[40:43], s72 offen
buffer_load_dwordx4 v[44:47], v5, s[40:43], s73 offen
buffer_load_dwordx4 v[48:51], v5, s[40:43], s74 offen
buffer_load_dwordx4 v[52:55], v5, s[40:43], s75 offen
buffer_load_dwordx4 v[56:59], v5, s[44:47], s66 offen
buffer_load_dwordx4 v[60:63], v5, s[44:47], s67 offen
buffer_load_dwordx4 v[64:67], v5, s[44:47], s68 offen
buffer_load_dwordx4 v[68:71], v5, s[44:47], s69 offen
buffer_load_dwordx4 v[72:75], v5, s[44:47], s70 offen
buffer_load_dwordx4 v[76:79], v5, s[44:47], s71 offen
buffer_load_dwordx4 v[80:83], v5, s[44:47], s72 offen
buffer_load_dwordx4 v[84:87], v5, s[44:47], s73 offen
buffer_load_dwordx4 v[88:91], v5, s[44:47], s74 offen
buffer_load_dwordx4 v[92:95], v5, s[44:47], s75 offen
s_mov_b32 s98, 0x7c3ff80
s_load_dwordx2 s[98:99], s[38:39], s98
s_add_u32 s48, s38, 0x8000000
s_addc_u32 s49, s39, 0
s_mov_b32 s50, 0x2800000
s_mov_b32 s51, 0x00020000
s_add_u32 s52, s38, 0x7800000
s_addc_u32 s53, s39, 0
s_mov_b32 s54, 0x1000
s_mov_b32 s55, 0x00020000
v_mov_b32 v240, 6945
v_mov_b32 v241, 0x0
v_mov_b32 v242, 6317
v_mov_b32 v243, 0x340674
v_mov_b32 v244, 6899
v_mov_b32 v245, 0xfffae6a0
v_mov_b32 v246, 6242
v_mov_b32 v247, 0x4484a0
s_mov_b32 s11, 0x10000
v_mov_b32 v7, 1
v_cmp_gt_u32 vcc, 0xc4, v0
s_mov_b64 s[12:13], vcc
s_barrier
s_waitcnt vmcnt(19)
v_cmp_le_u32 vcc, 5436, v16
s_nop 1
v_cndmask_b32 v96, v240, v242, vcc
v_cndmask_b32 v136, v241, v243, vcc
v_cmp_le_u32 vcc, 6432, v16
s_nop 1
v_cndmask_b32 v96, v96, v244, vcc
v_cndmask_b32 v136, v136, v245, vcc
v_cmp_le_u32 vcc, 7344, v16
s_nop 1
v_cndmask_b32 v96, v96, v246, vcc
v_cndmask_b32 v136, v136, v247, vcc
v_mad_u32_u24 v96, v96, v16, v136
v_lshrrev_b32 v96, 20, v96
v_lshl_add_u32 v136, v96, 2, s11
ds_add_rtn_u32 v136, v136, v7
v_cmp_le_u32 vcc, 5436, v17
s_nop 1
v_cndmask_b32 v97, v240, v242, vcc
v_cndmask_b32 v137, v241, v243, vcc
v_cmp_le_u32 vcc, 6432, v17
s_nop 1
v_cndmask_b32 v97, v97, v244, vcc
v_cndmask_b32 v137, v137, v245, vcc
v_cmp_le_u32 vcc, 7344, v17
s_nop 1
v_cndmask_b32 v97, v97, v246, vcc
v_cndmask_b32 v137, v137, v247, vcc
v_mad_u32_u24 v97, v97, v17, v137
v_lshrrev_b32 v97, 20, v97
v_lshl_add_u32 v137, v97, 2, s11
ds_add_rtn_u32 v137, v137, v7
v_cmp_le_u32 vcc, 5436, v18
s_nop 1
v_cndmask_b32 v98, v240, v242, vcc
v_cndmask_b32 v138, v241, v243, vcc
v_cmp_le_u32 vcc, 6432, v18
s_nop 1
v_cndmask_b32 v98, v98, v244, vcc
v_cndmask_b32 v138, v138, v245, vcc
v_cmp_le_u32 vcc, 7344, v18
s_nop 1
v_cndmask_b32 v98, v98, v246, vcc
v_cndmask_b32 v138, v138, v247, vcc
v_mad_u32_u24 v98, v98, v18, v138
v_lshrrev_b32 v98, 20, v98
v_lshl_add_u32 v138, v98, 2, s11
ds_add_rtn_u32 v138, v138, v7
v_cmp_le_u32 vcc, 5436, v19
s_nop 1
v_cndmask_b32 v99, v240, v242, vcc
v_cndmask_b32 v139, v241, v243, vcc
v_cmp_le_u32 vcc, 6432, v19
s_nop 1
v_cndmask_b32 v99, v99, v244, vcc
v_cndmask_b32 v139, v139, v245, vcc
v_cmp_le_u32 vcc, 7344, v19
s_nop 1
v_cndmask_b32 v99, v99, v246, vcc
v_cndmask_b32 v139, v139, v247, vcc
v_mad_u32_u24 v99, v99, v19, v139
v_lshrrev_b32 v99, 20, v99
v_lshl_add_u32 v139, v99, 2, s11
ds_add_rtn_u32 v139, v139, v7
s_waitcnt vmcnt(18)
v_cmp_le_u32 vcc, 5436, v20
s_nop 1
v_cndmask_b32 v100, v240, v242, vcc
v_cndmask_b32 v140, v241, v243, vcc
v_cmp_le_u32 vcc, 6432, v20
s_nop 1
v_cndmask_b32 v100, v100, v244, vcc
v_cndmask_b32 v140, v140, v245, vcc
v_cmp_le_u32 vcc, 7344, v20
s_nop 1
v_cndmask_b32 v100, v100, v246, vcc
v_cndmask_b32 v140, v140, v247, vcc
v_mad_u32_u24 v100, v100, v20, v140
v_lshrrev_b32 v100, 20, v100
v_lshl_add_u32 v140, v100, 2, s11
ds_add_rtn_u32 v140, v140, v7
v_cmp_le_u32 vcc, 5436, v21
s_nop 1
v_cndmask_b32 v101, v240, v242, vcc
v_cndmask_b32 v141, v241, v243, vcc
v_cmp_le_u32 vcc, 6432, v21
s_nop 1
v_cndmask_b32 v101, v101, v244, vcc
v_cndmask_b32 v141, v141, v245, vcc
v_cmp_le_u32 vcc, 7344, v21
s_nop 1
v_cndmask_b32 v101, v101, v246, vcc
v_cndmask_b32 v141, v141, v247, vcc
v_mad_u32_u24 v101, v101, v21, v141
v_lshrrev_b32 v101, 20, v101
v_lshl_add_u32 v141, v101, 2, s11
ds_add_rtn_u32 v141, v141, v7
v_cmp_le_u32 vcc, 5436, v22
s_nop 1
v_cndmask_b32 v102, v240, v242, vcc
v_cndmask_b32 v142, v241, v243, vcc
v_cmp_le_u32 vcc, 6432, v22
s_nop 1
v_cndmask_b32 v102, v102, v244, vcc
v_cndmask_b32 v142, v142, v245, vcc
v_cmp_le_u32 vcc, 7344, v22
s_nop 1
v_cndmask_b32 v102, v102, v246, vcc
v_cndmask_b32 v142, v142, v247, vcc
v_mad_u32_u24 v102, v102, v22, v142
v_lshrrev_b32 v102, 20, v102
v_lshl_add_u32 v142, v102, 2, s11
ds_add_rtn_u32 v142, v142, v7
v_cmp_le_u32 vcc, 5436, v23
s_nop 1
v_cndmask_b32 v103, v240, v242, vcc
v_cndmask_b32 v143, v241, v243, vcc
v_cmp_le_u32 vcc, 6432, v23
s_nop 1
v_cndmask_b32 v103, v103, v244, vcc
v_cndmask_b32 v143, v143, v245, vcc
v_cmp_le_u32 vcc, 7344, v23
s_nop 1
v_cndmask_b32 v103, v103, v246, vcc
v_cndmask_b32 v143, v143, v247, vcc
v_mad_u32_u24 v103, v103, v23, v143
v_lshrrev_b32 v103, 20, v103
v_lshl_add_u32 v143, v103, 2, s11
ds_add_rtn_u32 v143, v143, v7
s_waitcnt vmcnt(17)
v_cmp_le_u32 vcc, 5436, v24
s_nop 1
v_cndmask_b32 v104, v240, v242, vcc
v_cndmask_b32 v144, v241, v243, vcc
v_cmp_le_u32 vcc, 6432, v24
s_nop 1
v_cndmask_b32 v104, v104, v244, vcc
v_cndmask_b32 v144, v144, v245, vcc
v_cmp_le_u32 vcc, 7344, v24
s_nop 1
v_cndmask_b32 v104, v104, v246, vcc
v_cndmask_b32 v144, v144, v247, vcc
v_mad_u32_u24 v104, v104, v24, v144
v_lshrrev_b32 v104, 20, v104
v_lshl_add_u32 v144, v104, 2, s11
ds_add_rtn_u32 v144, v144, v7
v_cmp_le_u32 vcc, 5436, v25
s_nop 1
v_cndmask_b32 v105, v240, v242, vcc
v_cndmask_b32 v145, v241, v243, vcc
v_cmp_le_u32 vcc, 6432, v25
s_nop 1
v_cndmask_b32 v105, v105, v244, vcc
v_cndmask_b32 v145, v145, v245, vcc
v_cmp_le_u32 vcc, 7344, v25
s_nop 1
v_cndmask_b32 v105, v105, v246, vcc
v_cndmask_b32 v145, v145, v247, vcc
v_mad_u32_u24 v105, v105, v25, v145
v_lshrrev_b32 v105, 20, v105
v_lshl_add_u32 v145, v105, 2, s11
ds_add_rtn_u32 v145, v145, v7
v_cmp_le_u32 vcc, 5436, v26
s_nop 1
v_cndmask_b32 v106, v240, v242, vcc
v_cndmask_b32 v146, v241, v243, vcc
v_cmp_le_u32 vcc, 6432, v26
s_nop 1
v_cndmask_b32 v106, v106, v244, vcc
v_cndmask_b32 v146, v146, v245, vcc
v_cmp_le_u32 vcc, 7344, v26
s_nop 1
v_cndmask_b32 v106, v106, v246, vcc
v_cndmask_b32 v146, v146, v247, vcc
v_mad_u32_u24 v106, v106, v26, v146
v_lshrrev_b32 v106, 20, v106
v_lshl_add_u32 v146, v106, 2, s11
ds_add_rtn_u32 v146, v146, v7
v_cmp_le_u32 vcc, 5436, v27
s_nop 1
v_cndmask_b32 v107, v240, v242, vcc
v_cndmask_b32 v147, v241, v243, vcc
v_cmp_le_u32 vcc, 6432, v27
s_nop 1
v_cndmask_b32 v107, v107, v244, vcc
v_cndmask_b32 v147, v147, v245, vcc
v_cmp_le_u32 vcc, 7344, v27
s_nop 1
v_cndmask_b32 v107, v107, v246, vcc
v_cndmask_b32 v147, v147, v247, vcc
v_mad_u32_u24 v107, v107, v27, v147
v_lshrrev_b32 v107, 20, v107
v_lshl_add_u32 v147, v107, 2, s11
ds_add_rtn_u32 v147, v147, v7
s_waitcnt vmcnt(16)
v_cmp_le_u32 vcc, 5436, v28
s_nop 1
v_cndmask_b32 v108, v240, v242, vcc
v_cndmask_b32 v148, v241, v243, vcc
v_cmp_le_u32 vcc, 6432, v28
s_nop 1
v_cndmask_b32 v108, v108, v244, vcc
v_cndmask_b32 v148, v148, v245, vcc
v_cmp_le_u32 vcc, 7344, v28
s_nop 1
v_cndmask_b32 v108, v108, v246, vcc
v_cndmask_b32 v148, v148, v247, vcc
v_mad_u32_u24 v108, v108, v28, v148
v_lshrrev_b32 v108, 20, v108
v_lshl_add_u32 v148, v108, 2, s11
ds_add_rtn_u32 v148, v148, v7
v_cmp_le_u32 vcc, 5436, v29
s_nop 1
v_cndmask_b32 v109, v240, v242, vcc
v_cndmask_b32 v149, v241, v243, vcc
v_cmp_le_u32 vcc, 6432, v29
s_nop 1
v_cndmask_b32 v109, v109, v244, vcc
v_cndmask_b32 v149, v149, v245, vcc
v_cmp_le_u32 vcc, 7344, v29
s_nop 1
v_cndmask_b32 v109, v109, v246, vcc
v_cndmask_b32 v149, v149, v247, vcc
v_mad_u32_u24 v109, v109, v29, v149
v_lshrrev_b32 v109, 20, v109
v_lshl_add_u32 v149, v109, 2, s11
ds_add_rtn_u32 v149, v149, v7
v_cmp_le_u32 vcc, 5436, v30
s_nop 1
v_cndmask_b32 v110, v240, v242, vcc
v_cndmask_b32 v150, v241, v243, vcc
v_cmp_le_u32 vcc, 6432, v30
s_nop 1
v_cndmask_b32 v110, v110, v244, vcc
v_cndmask_b32 v150, v150, v245, vcc
v_cmp_le_u32 vcc, 7344, v30
s_nop 1
v_cndmask_b32 v110, v110, v246, vcc
v_cndmask_b32 v150, v150, v247, vcc
v_mad_u32_u24 v110, v110, v30, v150
v_lshrrev_b32 v110, 20, v110
v_lshl_add_u32 v150, v110, 2, s11
ds_add_rtn_u32 v150, v150, v7
v_cmp_le_u32 vcc, 5436, v31
s_nop 1
v_cndmask_b32 v111, v240, v242, vcc
v_cndmask_b32 v151, v241, v243, vcc
v_cmp_le_u32 vcc, 6432, v31
s_nop 1
v_cndmask_b32 v111, v111, v244, vcc
v_cndmask_b32 v151, v151, v245, vcc
v_cmp_le_u32 vcc, 7344, v31
s_nop 1
v_cndmask_b32 v111, v111, v246, vcc
v_cndmask_b32 v151, v151, v247, vcc
v_mad_u32_u24 v111, v111, v31, v151
v_lshrrev_b32 v111, 20, v111
v_lshl_add_u32 v151, v111, 2, s11
ds_add_rtn_u32 v151, v151, v7
s_waitcnt vmcnt(15)
v_cmp_le_u32 vcc, 5436, v32
s_nop 1
v_cndmask_b32 v112, v240, v242, vcc
v_cndmask_b32 v152, v241, v243, vcc
v_cmp_le_u32 vcc, 6432, v32
s_nop 1
v_cndmask_b32 v112, v112, v244, vcc
v_cndmask_b32 v152, v152, v245, vcc
v_cmp_le_u32 vcc, 7344, v32
s_nop 1
v_cndmask_b32 v112, v112, v246, vcc
v_cndmask_b32 v152, v152, v247, vcc
v_mad_u32_u24 v112, v112, v32, v152
v_lshrrev_b32 v112, 20, v112
v_lshl_add_u32 v152, v112, 2, s11
ds_add_rtn_u32 v152, v152, v7
v_cmp_le_u32 vcc, 5436, v33
s_nop 1
v_cndmask_b32 v113, v240, v242, vcc
v_cndmask_b32 v153, v241, v243, vcc
v_cmp_le_u32 vcc, 6432, v33
s_nop 1
v_cndmask_b32 v113, v113, v244, vcc
v_cndmask_b32 v153, v153, v245, vcc
v_cmp_le_u32 vcc, 7344, v33
s_nop 1
v_cndmask_b32 v113, v113, v246, vcc
v_cndmask_b32 v153, v153, v247, vcc
v_mad_u32_u24 v113, v113, v33, v153
v_lshrrev_b32 v113, 20, v113
v_lshl_add_u32 v153, v113, 2, s11
ds_add_rtn_u32 v153, v153, v7
v_cmp_le_u32 vcc, 5436, v34
s_nop 1
v_cndmask_b32 v114, v240, v242, vcc
v_cndmask_b32 v154, v241, v243, vcc
v_cmp_le_u32 vcc, 6432, v34
s_nop 1
v_cndmask_b32 v114, v114, v244, vcc
v_cndmask_b32 v154, v154, v245, vcc
v_cmp_le_u32 vcc, 7344, v34
s_nop 1
v_cndmask_b32 v114, v114, v246, vcc
v_cndmask_b32 v154, v154, v247, vcc
v_mad_u32_u24 v114, v114, v34, v154
v_lshrrev_b32 v114, 20, v114
v_lshl_add_u32 v154, v114, 2, s11
ds_add_rtn_u32 v154, v154, v7
v_cmp_le_u32 vcc, 5436, v35
s_nop 1
v_cndmask_b32 v115, v240, v242, vcc
v_cndmask_b32 v155, v241, v243, vcc
v_cmp_le_u32 vcc, 6432, v35
s_nop 1
v_cndmask_b32 v115, v115, v244, vcc
v_cndmask_b32 v155, v155, v245, vcc
v_cmp_le_u32 vcc, 7344, v35
s_nop 1
v_cndmask_b32 v115, v115, v246, vcc
v_cndmask_b32 v155, v155, v247, vcc
v_mad_u32_u24 v115, v115, v35, v155
v_lshrrev_b32 v115, 20, v115
v_lshl_add_u32 v155, v115, 2, s11
ds_add_rtn_u32 v155, v155, v7
s_waitcnt vmcnt(14)
v_cmp_le_u32 vcc, 5436, v36
s_nop 1
v_cndmask_b32 v116, v240, v242, vcc
v_cndmask_b32 v156, v241, v243, vcc
v_cmp_le_u32 vcc, 6432, v36
s_nop 1
v_cndmask_b32 v116, v116, v244, vcc
v_cndmask_b32 v156, v156, v245, vcc
v_cmp_le_u32 vcc, 7344, v36
s_nop 1
v_cndmask_b32 v116, v116, v246, vcc
v_cndmask_b32 v156, v156, v247, vcc
v_mad_u32_u24 v116, v116, v36, v156
v_lshrrev_b32 v116, 20, v116
v_lshl_add_u32 v156, v116, 2, s11
ds_add_rtn_u32 v156, v156, v7
v_cmp_le_u32 vcc, 5436, v37
s_nop 1
v_cndmask_b32 v117, v240, v242, vcc
v_cndmask_b32 v157, v241, v243, vcc
v_cmp_le_u32 vcc, 6432, v37
s_nop 1
v_cndmask_b32 v117, v117, v244, vcc
v_cndmask_b32 v157, v157, v245, vcc
v_cmp_le_u32 vcc, 7344, v37
s_nop 1
v_cndmask_b32 v117, v117, v246, vcc
v_cndmask_b32 v157, v157, v247, vcc
v_mad_u32_u24 v117, v117, v37, v157
v_lshrrev_b32 v117, 20, v117
v_lshl_add_u32 v157, v117, 2, s11
ds_add_rtn_u32 v157, v157, v7
v_cmp_le_u32 vcc, 5436, v38
s_nop 1
v_cndmask_b32 v118, v240, v242, vcc
v_cndmask_b32 v158, v241, v243, vcc
v_cmp_le_u32 vcc, 6432, v38
s_nop 1
v_cndmask_b32 v118, v118, v244, vcc
v_cndmask_b32 v158, v158, v245, vcc
v_cmp_le_u32 vcc, 7344, v38
s_nop 1
v_cndmask_b32 v118, v118, v246, vcc
v_cndmask_b32 v158, v158, v247, vcc
v_mad_u32_u24 v118, v118, v38, v158
v_lshrrev_b32 v118, 20, v118
v_lshl_add_u32 v158, v118, 2, s11
ds_add_rtn_u32 v158, v158, v7
v_cmp_le_u32 vcc, 5436, v39
s_nop 1
v_cndmask_b32 v119, v240, v242, vcc
v_cndmask_b32 v159, v241, v243, vcc
v_cmp_le_u32 vcc, 6432, v39
s_nop 1
v_cndmask_b32 v119, v119, v244, vcc
v_cndmask_b32 v159, v159, v245, vcc
v_cmp_le_u32 vcc, 7344, v39
s_nop 1
v_cndmask_b32 v119, v119, v246, vcc
v_cndmask_b32 v159, v159, v247, vcc
v_mad_u32_u24 v119, v119, v39, v159
v_lshrrev_b32 v119, 20, v119
v_lshl_add_u32 v159, v119, 2, s11
ds_add_rtn_u32 v159, v159, v7
s_waitcnt vmcnt(13)
v_cmp_le_u32 vcc, 5436, v40
s_nop 1
v_cndmask_b32 v120, v240, v242, vcc
v_cndmask_b32 v160, v241, v243, vcc
v_cmp_le_u32 vcc, 6432, v40
s_nop 1
v_cndmask_b32 v120, v120, v244, vcc
v_cndmask_b32 v160, v160, v245, vcc
v_cmp_le_u32 vcc, 7344, v40
s_nop 1
v_cndmask_b32 v120, v120, v246, vcc
v_cndmask_b32 v160, v160, v247, vcc
v_mad_u32_u24 v120, v120, v40, v160
v_lshrrev_b32 v120, 20, v120
v_lshl_add_u32 v160, v120, 2, s11
ds_add_rtn_u32 v160, v160, v7
v_cmp_le_u32 vcc, 5436, v41
s_nop 1
v_cndmask_b32 v121, v240, v242, vcc
v_cndmask_b32 v161, v241, v243, vcc
v_cmp_le_u32 vcc, 6432, v41
s_nop 1
v_cndmask_b32 v121, v121, v244, vcc
v_cndmask_b32 v161, v161, v245, vcc
v_cmp_le_u32 vcc, 7344, v41
s_nop 1
v_cndmask_b32 v121, v121, v246, vcc
v_cndmask_b32 v161, v161, v247, vcc
v_mad_u32_u24 v121, v121, v41, v161
v_lshrrev_b32 v121, 20, v121
v_lshl_add_u32 v161, v121, 2, s11
ds_add_rtn_u32 v161, v161, v7
v_cmp_le_u32 vcc, 5436, v42
s_nop 1
v_cndmask_b32 v122, v240, v242, vcc
v_cndmask_b32 v162, v241, v243, vcc
v_cmp_le_u32 vcc, 6432, v42
s_nop 1
v_cndmask_b32 v122, v122, v244, vcc
v_cndmask_b32 v162, v162, v245, vcc
v_cmp_le_u32 vcc, 7344, v42
s_nop 1
v_cndmask_b32 v122, v122, v246, vcc
v_cndmask_b32 v162, v162, v247, vcc
v_mad_u32_u24 v122, v122, v42, v162
v_lshrrev_b32 v122, 20, v122
v_lshl_add_u32 v162, v122, 2, s11
ds_add_rtn_u32 v162, v162, v7
v_cmp_le_u32 vcc, 5436, v43
s_nop 1
v_cndmask_b32 v123, v240, v242, vcc
v_cndmask_b32 v163, v241, v243, vcc
v_cmp_le_u32 vcc, 6432, v43
s_nop 1
v_cndmask_b32 v123, v123, v244, vcc
v_cndmask_b32 v163, v163, v245, vcc
v_cmp_le_u32 vcc, 7344, v43
s_nop 1
v_cndmask_b32 v123, v123, v246, vcc
v_cndmask_b32 v163, v163, v247, vcc
v_mad_u32_u24 v123, v123, v43, v163
v_lshrrev_b32 v123, 20, v123
v_lshl_add_u32 v163, v123, 2, s11
ds_add_rtn_u32 v163, v163, v7
s_waitcnt vmcnt(12)
v_cmp_le_u32 vcc, 5436, v44
s_nop 1
v_cndmask_b32 v124, v240, v242, vcc
v_cndmask_b32 v164, v241, v243, vcc
v_cmp_le_u32 vcc, 6432, v44
s_nop 1
v_cndmask_b32 v124, v124, v244, vcc
v_cndmask_b32 v164, v164, v245, vcc
v_cmp_le_u32 vcc, 7344, v44
s_nop 1
v_cndmask_b32 v124, v124, v246, vcc
v_cndmask_b32 v164, v164, v247, vcc
v_mad_u32_u24 v124, v124, v44, v164
v_lshrrev_b32 v124, 20, v124
v_lshl_add_u32 v164, v124, 2, s11
ds_add_rtn_u32 v164, v164, v7
v_cmp_le_u32 vcc, 5436, v45
s_nop 1
v_cndmask_b32 v125, v240, v242, vcc
v_cndmask_b32 v165, v241, v243, vcc
v_cmp_le_u32 vcc, 6432, v45
s_nop 1
v_cndmask_b32 v125, v125, v244, vcc
v_cndmask_b32 v165, v165, v245, vcc
v_cmp_le_u32 vcc, 7344, v45
s_nop 1
v_cndmask_b32 v125, v125, v246, vcc
v_cndmask_b32 v165, v165, v247, vcc
v_mad_u32_u24 v125, v125, v45, v165
v_lshrrev_b32 v125, 20, v125
v_lshl_add_u32 v165, v125, 2, s11
ds_add_rtn_u32 v165, v165, v7
v_cmp_le_u32 vcc, 5436, v46
s_nop 1
v_cndmask_b32 v126, v240, v242, vcc
v_cndmask_b32 v166, v241, v243, vcc
v_cmp_le_u32 vcc, 6432, v46
s_nop 1
v_cndmask_b32 v126, v126, v244, vcc
v_cndmask_b32 v166, v166, v245, vcc
v_cmp_le_u32 vcc, 7344, v46
s_nop 1
v_cndmask_b32 v126, v126, v246, vcc
v_cndmask_b32 v166, v166, v247, vcc
v_mad_u32_u24 v126, v126, v46, v166
v_lshrrev_b32 v126, 20, v126
v_lshl_add_u32 v166, v126, 2, s11
ds_add_rtn_u32 v166, v166, v7
v_cmp_le_u32 vcc, 5436, v47
s_nop 1
v_cndmask_b32 v127, v240, v242, vcc
v_cndmask_b32 v167, v241, v243, vcc
v_cmp_le_u32 vcc, 6432, v47
s_nop 1
v_cndmask_b32 v127, v127, v244, vcc
v_cndmask_b32 v167, v167, v245, vcc
v_cmp_le_u32 vcc, 7344, v47
s_nop 1
v_cndmask_b32 v127, v127, v246, vcc
v_cndmask_b32 v167, v167, v247, vcc
v_mad_u32_u24 v127, v127, v47, v167
v_lshrrev_b32 v127, 20, v127
v_lshl_add_u32 v167, v127, 2, s11
ds_add_rtn_u32 v167, v167, v7
s_waitcnt vmcnt(11)
v_cmp_le_u32 vcc, 5436, v48
s_nop 1
v_cndmask_b32 v128, v240, v242, vcc
v_cndmask_b32 v168, v241, v243, vcc
v_cmp_le_u32 vcc, 6432, v48
s_nop 1
v_cndmask_b32 v128, v128, v244, vcc
v_cndmask_b32 v168, v168, v245, vcc
v_cmp_le_u32 vcc, 7344, v48
s_nop 1
v_cndmask_b32 v128, v128, v246, vcc
v_cndmask_b32 v168, v168, v247, vcc
v_mad_u32_u24 v128, v128, v48, v168
v_lshrrev_b32 v128, 20, v128
v_lshl_add_u32 v168, v128, 2, s11
ds_add_rtn_u32 v168, v168, v7
v_cmp_le_u32 vcc, 5436, v49
s_nop 1
v_cndmask_b32 v129, v240, v242, vcc
v_cndmask_b32 v169, v241, v243, vcc
v_cmp_le_u32 vcc, 6432, v49
s_nop 1
v_cndmask_b32 v129, v129, v244, vcc
v_cndmask_b32 v169, v169, v245, vcc
v_cmp_le_u32 vcc, 7344, v49
s_nop 1
v_cndmask_b32 v129, v129, v246, vcc
v_cndmask_b32 v169, v169, v247, vcc
v_mad_u32_u24 v129, v129, v49, v169
v_lshrrev_b32 v129, 20, v129
v_lshl_add_u32 v169, v129, 2, s11
ds_add_rtn_u32 v169, v169, v7
v_cmp_le_u32 vcc, 5436, v50
s_nop 1
v_cndmask_b32 v130, v240, v242, vcc
v_cndmask_b32 v170, v241, v243, vcc
v_cmp_le_u32 vcc, 6432, v50
s_nop 1
v_cndmask_b32 v130, v130, v244, vcc
v_cndmask_b32 v170, v170, v245, vcc
v_cmp_le_u32 vcc, 7344, v50
s_nop 1
v_cndmask_b32 v130, v130, v246, vcc
v_cndmask_b32 v170, v170, v247, vcc
v_mad_u32_u24 v130, v130, v50, v170
v_lshrrev_b32 v130, 20, v130
v_lshl_add_u32 v170, v130, 2, s11
ds_add_rtn_u32 v170, v170, v7
v_cmp_le_u32 vcc, 5436, v51
s_nop 1
v_cndmask_b32 v131, v240, v242, vcc
v_cndmask_b32 v171, v241, v243, vcc
v_cmp_le_u32 vcc, 6432, v51
s_nop 1
v_cndmask_b32 v131, v131, v244, vcc
v_cndmask_b32 v171, v171, v245, vcc
v_cmp_le_u32 vcc, 7344, v51
s_nop 1
v_cndmask_b32 v131, v131, v246, vcc
v_cndmask_b32 v171, v171, v247, vcc
v_mad_u32_u24 v131, v131, v51, v171
v_lshrrev_b32 v131, 20, v131
v_lshl_add_u32 v171, v131, 2, s11
ds_add_rtn_u32 v171, v171, v7
s_waitcnt vmcnt(10)
s_mov_b64 exec, s[12:13]
v_cmp_le_u32 vcc, 5436, v52
s_nop 1
v_cndmask_b32 v132, v240, v242, vcc
v_cndmask_b32 v172, v241, v243, vcc
v_cmp_le_u32 vcc, 6432, v52
s_nop 1
v_cndmask_b32 v132, v132, v244, vcc
v_cndmask_b32 v172, v172, v245, vcc
v_cmp_le_u32 vcc, 7344, v52
s_nop 1
v_cndmask_b32 v132, v132, v246, vcc
v_cndmask_b32 v172, v172, v247, vcc
v_mad_u32_u24 v132, v132, v52, v172
v_lshrrev_b32 v132, 20, v132
v_lshl_add_u32 v172, v132, 2, s11
ds_add_rtn_u32 v172, v172, v7
v_cmp_le_u32 vcc, 5436, v53
s_nop 1
v_cndmask_b32 v133, v240, v242, vcc
v_cndmask_b32 v173, v241, v243, vcc
v_cmp_le_u32 vcc, 6432, v53
s_nop 1
v_cndmask_b32 v133, v133, v244, vcc
v_cndmask_b32 v173, v173, v245, vcc
v_cmp_le_u32 vcc, 7344, v53
s_nop 1
v_cndmask_b32 v133, v133, v246, vcc
v_cndmask_b32 v173, v173, v247, vcc
v_mad_u32_u24 v133, v133, v53, v173
v_lshrrev_b32 v133, 20, v133
v_lshl_add_u32 v173, v133, 2, s11
ds_add_rtn_u32 v173, v173, v7
v_cmp_le_u32 vcc, 5436, v54
s_nop 1
v_cndmask_b32 v134, v240, v242, vcc
v_cndmask_b32 v174, v241, v243, vcc
v_cmp_le_u32 vcc, 6432, v54
s_nop 1
v_cndmask_b32 v134, v134, v244, vcc
v_cndmask_b32 v174, v174, v245, vcc
v_cmp_le_u32 vcc, 7344, v54
s_nop 1
v_cndmask_b32 v134, v134, v246, vcc
v_cndmask_b32 v174, v174, v247, vcc
v_mad_u32_u24 v134, v134, v54, v174
v_lshrrev_b32 v134, 20, v134
v_lshl_add_u32 v174, v134, 2, s11
ds_add_rtn_u32 v174, v174, v7
v_cmp_le_u32 vcc, 5436, v55
s_nop 1
v_cndmask_b32 v135, v240, v242, vcc
v_cndmask_b32 v175, v241, v243, vcc
v_cmp_le_u32 vcc, 6432, v55
s_nop 1
v_cndmask_b32 v135, v135, v244, vcc
v_cndmask_b32 v175, v175, v245, vcc
v_cmp_le_u32 vcc, 7344, v55
s_nop 1
v_cndmask_b32 v135, v135, v246, vcc
v_cndmask_b32 v175, v175, v247, vcc
v_mad_u32_u24 v135, v135, v55, v175
v_lshrrev_b32 v135, 20, v135
v_lshl_add_u32 v175, v135, 2, s11
ds_add_rtn_u32 v175, v175, v7
s_mov_b64 exec, -1
s_waitcnt vmcnt(9) lgkmcnt(15)
v_and_b32 v8, 0xff, v136
v_lshl_or_b32 v56, v16, 18, v56
v_lshlrev_b32 v8, 2, v8
v_lshl_add_u32 v8, v96, 10, v8
ds_write_b32 v8, v56
v_and_b32 v8, 0xff, v137
v_lshl_or_b32 v57, v17, 18, v57
v_lshlrev_b32 v8, 2, v8
v_lshl_add_u32 v8, v97, 10, v8
ds_write_b32 v8, v57
v_and_b32 v8, 0xff, v138
v_lshl_or_b32 v58, v18, 18, v58
v_lshlrev_b32 v8, 2, v8
v_lshl_add_u32 v8, v98, 10, v8
ds_write_b32 v8, v58
v_and_b32 v8, 0xff, v139
v_lshl_or_b32 v59, v19, 18, v59
v_lshlrev_b32 v8, 2, v8
v_lshl_add_u32 v8, v99, 10, v8
ds_write_b32 v8, v59
s_waitcnt vmcnt(8) lgkmcnt(15)
v_and_b32 v8, 0xff, v140
v_lshl_or_b32 v60, v20, 18, v60
v_lshlrev_b32 v8, 2, v8
v_lshl_add_u32 v8, v100, 10, v8
ds_write_b32 v8, v60
v_and_b32 v8, 0xff, v141
v_lshl_or_b32 v61, v21, 18, v61
v_lshlrev_b32 v8, 2, v8
v_lshl_add_u32 v8, v101, 10, v8
ds_write_b32 v8, v61
v_and_b32 v8, 0xff, v142
v_lshl_or_b32 v62, v22, 18, v62
v_lshlrev_b32 v8, 2, v8
v_lshl_add_u32 v8, v102, 10, v8
ds_write_b32 v8, v62
v_and_b32 v8, 0xff, v143
v_lshl_or_b32 v63, v23, 18, v63
v_lshlrev_b32 v8, 2, v8
v_lshl_add_u32 v8, v103, 10, v8
ds_write_b32 v8, v63
s_waitcnt vmcnt(7) lgkmcnt(15)
v_and_b32 v8, 0xff, v144
v_lshl_or_b32 v64, v24, 18, v64
v_lshlrev_b32 v8, 2, v8
v_lshl_add_u32 v8, v104, 10, v8
ds_write_b32 v8, v64
v_and_b32 v8, 0xff, v145
v_lshl_or_b32 v65, v25, 18, v65
v_lshlrev_b32 v8, 2, v8
v_lshl_add_u32 v8, v105, 10, v8
ds_write_b32 v8, v65
v_and_b32 v8, 0xff, v146
v_lshl_or_b32 v66, v26, 18, v66
v_lshlrev_b32 v8, 2, v8
v_lshl_add_u32 v8, v106, 10, v8
ds_write_b32 v8, v66
v_and_b32 v8, 0xff, v147
v_lshl_or_b32 v67, v27, 18, v67
v_lshlrev_b32 v8, 2, v8
v_lshl_add_u32 v8, v107, 10, v8
ds_write_b32 v8, v67
s_waitcnt vmcnt(6) lgkmcnt(15)
v_and_b32 v8, 0xff, v148
v_lshl_or_b32 v68, v28, 18, v68
v_lshlrev_b32 v8, 2, v8
v_lshl_add_u32 v8, v108, 10, v8
ds_write_b32 v8, v68
v_and_b32 v8, 0xff, v149
v_lshl_or_b32 v69, v29, 18, v69
v_lshlrev_b32 v8, 2, v8
v_lshl_add_u32 v8, v109, 10, v8
ds_write_b32 v8, v69
v_and_b32 v8, 0xff, v150
v_lshl_or_b32 v70, v30, 18, v70
v_lshlrev_b32 v8, 2, v8
v_lshl_add_u32 v8, v110, 10, v8
ds_write_b32 v8, v70
v_and_b32 v8, 0xff, v151
v_lshl_or_b32 v71, v31, 18, v71
v_lshlrev_b32 v8, 2, v8
v_lshl_add_u32 v8, v111, 10, v8
ds_write_b32 v8, v71
s_waitcnt vmcnt(5) lgkmcnt(15)
v_and_b32 v8, 0xff, v152
v_lshl_or_b32 v72, v32, 18, v72
v_lshlrev_b32 v8, 2, v8
v_lshl_add_u32 v8, v112, 10, v8
ds_write_b32 v8, v72
v_and_b32 v8, 0xff, v153
v_lshl_or_b32 v73, v33, 18, v73
v_lshlrev_b32 v8, 2, v8
v_lshl_add_u32 v8, v113, 10, v8
ds_write_b32 v8, v73
v_and_b32 v8, 0xff, v154
v_lshl_or_b32 v74, v34, 18, v74
v_lshlrev_b32 v8, 2, v8
v_lshl_add_u32 v8, v114, 10, v8
ds_write_b32 v8, v74
v_and_b32 v8, 0xff, v155
v_lshl_or_b32 v75, v35, 18, v75
v_lshlrev_b32 v8, 2, v8
v_lshl_add_u32 v8, v115, 10, v8
ds_write_b32 v8, v75
s_waitcnt vmcnt(4) lgkmcnt(15)
v_and_b32 v8, 0xff, v156
v_lshl_or_b32 v76, v36, 18, v76
v_lshlrev_b32 v8, 2, v8
v_lshl_add_u32 v8, v116, 10, v8
ds_write_b32 v8, v76
v_and_b32 v8, 0xff, v157
v_lshl_or_b32 v77, v37, 18, v77
v_lshlrev_b32 v8, 2, v8
v_lshl_add_u32 v8, v117, 10, v8
ds_write_b32 v8, v77
v_and_b32 v8, 0xff, v158
v_lshl_or_b32 v78, v38, 18, v78
v_lshlrev_b32 v8, 2, v8
v_lshl_add_u32 v8, v118, 10, v8
ds_write_b32 v8, v78
v_and_b32 v8, 0xff, v159
v_lshl_or_b32 v79, v39, 18, v79
v_lshlrev_b32 v8, 2, v8
v_lshl_add_u32 v8, v119, 10, v8
ds_write_b32 v8, v79
s_waitcnt vmcnt(3) lgkmcnt(15)
v_and_b32 v8, 0xff, v160
v_lshl_or_b32 v80, v40, 18, v80
v_lshlrev_b32 v8, 2, v8
v_lshl_add_u32 v8, v120, 10, v8
ds_write_b32 v8, v80
v_and_b32 v8, 0xff, v161
v_lshl_or_b32 v81, v41, 18, v81
v_lshlrev_b32 v8, 2, v8
v_lshl_add_u32 v8, v121, 10, v8
ds_write_b32 v8, v81
v_and_b32 v8, 0xff, v162
v_lshl_or_b32 v82, v42, 18, v82
v_lshlrev_b32 v8, 2, v8
v_lshl_add_u32 v8, v122, 10, v8
ds_write_b32 v8, v82
v_and_b32 v8, 0xff, v163
v_lshl_or_b32 v83, v43, 18, v83
v_lshlrev_b32 v8, 2, v8
v_lshl_add_u32 v8, v123, 10, v8
ds_write_b32 v8, v83
s_waitcnt vmcnt(2) lgkmcnt(15)
v_and_b32 v8, 0xff, v164
v_lshl_or_b32 v84, v44, 18, v84
v_lshlrev_b32 v8, 2, v8
v_lshl_add_u32 v8, v124, 10, v8
ds_write_b32 v8, v84
v_and_b32 v8, 0xff, v165
v_lshl_or_b32 v85, v45, 18, v85
v_lshlrev_b32 v8, 2, v8
v_lshl_add_u32 v8, v125, 10, v8
ds_write_b32 v8, v85
v_and_b32 v8, 0xff, v166
v_lshl_or_b32 v86, v46, 18, v86
v_lshlrev_b32 v8, 2, v8
v_lshl_add_u32 v8, v126, 10, v8
ds_write_b32 v8, v86
v_and_b32 v8, 0xff, v167
v_lshl_or_b32 v87, v47, 18, v87
v_lshlrev_b32 v8, 2, v8
v_lshl_add_u32 v8, v127, 10, v8
ds_write_b32 v8, v87
s_waitcnt vmcnt(1) lgkmcnt(15)
v_and_b32 v8, 0xff, v168
v_lshl_or_b32 v88, v48, 18, v88
v_lshlrev_b32 v8, 2, v8
v_lshl_add_u32 v8, v128, 10, v8
ds_write_b32 v8, v88
v_and_b32 v8, 0xff, v169
v_lshl_or_b32 v89, v49, 18, v89
v_lshlrev_b32 v8, 2, v8
v_lshl_add_u32 v8, v129, 10, v8
ds_write_b32 v8, v89
v_and_b32 v8, 0xff, v170
v_lshl_or_b32 v90, v50, 18, v90
v_lshlrev_b32 v8, 2, v8
v_lshl_add_u32 v8, v130, 10, v8
ds_write_b32 v8, v90
v_and_b32 v8, 0xff, v171
v_lshl_or_b32 v91, v51, 18, v91
v_lshlrev_b32 v8, 2, v8
v_lshl_add_u32 v8, v131, 10, v8
ds_write_b32 v8, v91
s_waitcnt vmcnt(0) lgkmcnt(15)
s_mov_b64 exec, s[12:13]
v_and_b32 v8, 0xff, v172
v_lshl_or_b32 v92, v52, 18, v92
v_lshlrev_b32 v8, 2, v8
v_lshl_add_u32 v8, v132, 10, v8
ds_write_b32 v8, v92
v_and_b32 v8, 0xff, v173
v_lshl_or_b32 v93, v53, 18, v93
v_lshlrev_b32 v8, 2, v8
v_lshl_add_u32 v8, v133, 10, v8
ds_write_b32 v8, v93
v_and_b32 v8, 0xff, v174
v_lshl_or_b32 v94, v54, 18, v94
v_lshlrev_b32 v8, 2, v8
v_lshl_add_u32 v8, v134, 10, v8
ds_write_b32 v8, v94
v_and_b32 v8, 0xff, v175
v_lshl_or_b32 v95, v55, 18, v95
v_lshlrev_b32 v8, 2, v8
v_lshl_add_u32 v8, v135, 10, v8
ds_write_b32 v8, v95
s_mov_b64 exec, -1
s_waitcnt lgkmcnt(0)
s_barrier
ds_read_b32 v8, v6
s_mul_i32 s6, s60, 16384
v_lshlrev_b32 v10, 4, v2
v_add_u32 v9, s6, v10
ds_read_b128 v[176:179], v9 offset:0
ds_read_b128 v[180:183], v9 offset:1024
ds_read_b128 v[184:187], v9 offset:2048
ds_read_b128 v[188:191], v9 offset:3072
ds_read_b128 v[192:195], v9 offset:4096
ds_read_b128 v[196:199], v9 offset:5120
ds_read_b128 v[200:203], v9 offset:6144
ds_read_b128 v[204:207], v9 offset:7168
ds_read_b128 v[208:211], v9 offset:8192
ds_read_b128 v[212:215], v9 offset:9216
ds_read_b128 v[216:219], v9 offset:10240
ds_read_b128 v[220:223], v9 offset:11264
ds_read_b128 v[224:227], v9 offset:12288
ds_read_b128 v[228:231], v9 offset:13312
ds_read_b128 v[232:235], v9 offset:14336
ds_read_b128 v[236:239], v9 offset:15360
s_mul_i32 s6, s60, 262144
s_mul_i32 s7, s4, 1024
s_add_u32 s6, s6, s7
v_lshlrev_b32 v9, 2, v2
s_lshl_b32 s8, s4, 8
s_cmp_eq_u32 s60, 0
s_cselect_b32 s8, s8, 0x7fff0000
s_waitcnt lgkmcnt(15)
buffer_store_dword v8, v9, s[52:55], s8 offen sc1
v_cmp_lt_u32 vcc, 0x100, v8
s_cbranch_vccnz L1_eslow
s_waitcnt lgkmcnt(15)
buffer_store_dwordx4 v[176:179], v10, s[48:51], s6 offen sc1
s_add_u32 s6, s6, 16384
s_waitcnt lgkmcnt(14)
buffer_store_dwordx4 v[180:183], v10, s[48:51], s6 offen sc1
s_add_u32 s6, s6, 16384
s_waitcnt lgkmcnt(13)
buffer_store_dwordx4 v[184:187], v10, s[48:51], s6 offen sc1
s_add_u32 s6, s6, 16384
s_waitcnt lgkmcnt(12)
buffer_store_dwordx4 v[188:191], v10, s[48:51], s6 offen sc1
s_add_u32 s6, s6, 16384
s_waitcnt lgkmcnt(11)
buffer_store_dwordx4 v[192:195], v10, s[48:51], s6 offen sc1
s_add_u32 s6, s6, 16384
s_waitcnt lgkmcnt(10)
buffer_store_dwordx4 v[196:199], v10, s[48:51], s6 offen sc1
s_add_u32 s6, s6, 16384
s_waitcnt lgkmcnt(9)
buffer_store_dwordx4 v[200:203], v10, s[48:51], s6 offen sc1
s_add_u32 s6, s6, 16384
s_waitcnt lgkmcnt(8)
buffer_store_dwordx4 v[204:207], v10, s[48:51], s6 offen sc1
s_add_u32 s6, s6, 16384
s_waitcnt lgkmcnt(7)
buffer_store_dwordx4 v[208:211], v10, s[48:51], s6 offen sc1
s_add_u32 s6, s6, 16384
s_waitcnt lgkmcnt(6)
buffer_store_dwordx4 v[212:215], v10, s[48:51], s6 offen sc1
s_add_u32 s6, s6, 16384
s_waitcnt lgkmcnt(5)
buffer_store_dwordx4 v[216:219], v10, s[48:51], s6 offen sc1
s_add_u32 s6, s6, 16384
s_waitcnt lgkmcnt(4)
buffer_store_dwordx4 v[220:223], v10, s[48:51], s6 offen sc1
s_add_u32 s6, s6, 16384
s_waitcnt lgkmcnt(3)
buffer_store_dwordx4 v[224:227], v10, s[48:51], s6 offen sc1
s_add_u32 s6, s6, 16384
s_waitcnt lgkmcnt(2)
buffer_store_dwordx4 v[228:231], v10, s[48:51], s6 offen sc1
s_add_u32 s6, s6, 16384
s_waitcnt lgkmcnt(1)
buffer_store_dwordx4 v[232:235], v10, s[48:51], s6 offen sc1
s_add_u32 s6, s6, 16384
s_waitcnt lgkmcnt(0)
buffer_store_dwordx4 v[236:239], v10, s[48:51], s6 offen sc1
s_add_u32 s6, s6, 16384
s_branch L1_fin
L1_eslow:
s_mov_b32 s9, 16384
v_mul_u32_u24 v96, s9, v96
v_and_b32 v8, 255, v136
v_lshl_add_u32 v96, v8, 2, v96
v_lshrrev_b32 v8, 8, v136
v_lshl_add_u32 v96, v8, 20, v96
v_mul_u32_u24 v97, s9, v97
v_and_b32 v8, 255, v137
v_lshl_add_u32 v97, v8, 2, v97
v_lshrrev_b32 v8, 8, v137
v_lshl_add_u32 v97, v8, 20, v97
v_mul_u32_u24 v98, s9, v98
v_and_b32 v8, 255, v138
v_lshl_add_u32 v98, v8, 2, v98
v_lshrrev_b32 v8, 8, v138
v_lshl_add_u32 v98, v8, 20, v98
v_mul_u32_u24 v99, s9, v99
v_and_b32 v8, 255, v139
v_lshl_add_u32 v99, v8, 2, v99
v_lshrrev_b32 v8, 8, v139
v_lshl_add_u32 v99, v8, 20, v99
v_mul_u32_u24 v100, s9, v100
v_and_b32 v8, 255, v140
v_lshl_add_u32 v100, v8, 2, v100
v_lshrrev_b32 v8, 8, v140
v_lshl_add_u32 v100, v8, 20, v100
v_mul_u32_u24 v101, s9, v101
v_and_b32 v8, 255, v141
v_lshl_add_u32 v101, v8, 2, v101
v_lshrrev_b32 v8, 8, v141
v_lshl_add_u32 v101, v8, 20, v101
v_mul_u32_u24 v102, s9, v102
v_and_b32 v8, 255, v142
v_lshl_add_u32 v102, v8, 2, v102
v_lshrrev_b32 v8, 8, v142
v_lshl_add_u32 v102, v8, 20, v102
v_mul_u32_u24 v103, s9, v103
v_and_b32 v8, 255, v143
v_lshl_add_u32 v103, v8, 2, v103
v_lshrrev_b32 v8, 8, v143
v_lshl_add_u32 v103, v8, 20, v103
v_mul_u32_u24 v104, s9, v104
v_and_b32 v8, 255, v144
v_lshl_add_u32 v104, v8, 2, v104
v_lshrrev_b32 v8, 8, v144
v_lshl_add_u32 v104, v8, 20, v104
v_mul_u32_u24 v105, s9, v105
v_and_b32 v8, 255, v145
v_lshl_add_u32 v105, v8, 2, v105
v_lshrrev_b32 v8, 8, v145
v_lshl_add_u32 v105, v8, 20, v105
v_mul_u32_u24 v106, s9, v106
v_and_b32 v8, 255, v146
v_lshl_add_u32 v106, v8, 2, v106
v_lshrrev_b32 v8, 8, v146
v_lshl_add_u32 v106, v8, 20, v106
v_mul_u32_u24 v107, s9, v107
v_and_b32 v8, 255, v147
v_lshl_add_u32 v107, v8, 2, v107
v_lshrrev_b32 v8, 8, v147
v_lshl_add_u32 v107, v8, 20, v107
v_mul_u32_u24 v108, s9, v108
v_and_b32 v8, 255, v148
v_lshl_add_u32 v108, v8, 2, v108
v_lshrrev_b32 v8, 8, v148
v_lshl_add_u32 v108, v8, 20, v108
v_mul_u32_u24 v109, s9, v109
v_and_b32 v8, 255, v149
v_lshl_add_u32 v109, v8, 2, v109
v_lshrrev_b32 v8, 8, v149
v_lshl_add_u32 v109, v8, 20, v109
v_mul_u32_u24 v110, s9, v110
v_and_b32 v8, 255, v150
v_lshl_add_u32 v110, v8, 2, v110
v_lshrrev_b32 v8, 8, v150
v_lshl_add_u32 v110, v8, 20, v110
v_mul_u32_u24 v111, s9, v111
v_and_b32 v8, 255, v151
v_lshl_add_u32 v111, v8, 2, v111
v_lshrrev_b32 v8, 8, v151
v_lshl_add_u32 v111, v8, 20, v111
v_mul_u32_u24 v112, s9, v112
v_and_b32 v8, 255, v152
v_lshl_add_u32 v112, v8, 2, v112
v_lshrrev_b32 v8, 8, v152
v_lshl_add_u32 v112, v8, 20, v112
v_mul_u32_u24 v113, s9, v113
v_and_b32 v8, 255, v153
v_lshl_add_u32 v113, v8, 2, v113
v_lshrrev_b32 v8, 8, v153
v_lshl_add_u32 v113, v8, 20, v113
v_mul_u32_u24 v114, s9, v114
v_and_b32 v8, 255, v154
v_lshl_add_u32 v114, v8, 2, v114
v_lshrrev_b32 v8, 8, v154
v_lshl_add_u32 v114, v8, 20, v114
v_mul_u32_u24 v115, s9, v115
v_and_b32 v8, 255, v155
v_lshl_add_u32 v115, v8, 2, v115
v_lshrrev_b32 v8, 8, v155
v_lshl_add_u32 v115, v8, 20, v115
v_mul_u32_u24 v116, s9, v116
v_and_b32 v8, 255, v156
v_lshl_add_u32 v116, v8, 2, v116
v_lshrrev_b32 v8, 8, v156
v_lshl_add_u32 v116, v8, 20, v116
v_mul_u32_u24 v117, s9, v117
v_and_b32 v8, 255, v157
v_lshl_add_u32 v117, v8, 2, v117
v_lshrrev_b32 v8, 8, v157
v_lshl_add_u32 v117, v8, 20, v117
v_mul_u32_u24 v118, s9, v118
v_and_b32 v8, 255, v158
v_lshl_add_u32 v118, v8, 2, v118
v_lshrrev_b32 v8, 8, v158
v_lshl_add_u32 v118, v8, 20, v118
v_mul_u32_u24 v119, s9, v119
v_and_b32 v8, 255, v159
v_lshl_add_u32 v119, v8, 2, v119
v_lshrrev_b32 v8, 8, v159
v_lshl_add_u32 v119, v8, 20, v119
v_mul_u32_u24 v120, s9, v120
v_and_b32 v8, 255, v160
v_lshl_add_u32 v120, v8, 2, v120
v_lshrrev_b32 v8, 8, v160
v_lshl_add_u32 v120, v8, 20, v120
v_mul_u32_u24 v121, s9, v121
v_and_b32 v8, 255, v161
v_lshl_add_u32 v121, v8, 2, v121
v_lshrrev_b32 v8, 8, v161
v_lshl_add_u32 v121, v8, 20, v121
v_mul_u32_u24 v122, s9, v122
v_and_b32 v8, 255, v162
v_lshl_add_u32 v122, v8, 2, v122
v_lshrrev_b32 v8, 8, v162
v_lshl_add_u32 v122, v8, 20, v122
v_mul_u32_u24 v123, s9, v123
v_and_b32 v8, 255, v163
v_lshl_add_u32 v123, v8, 2, v123
v_lshrrev_b32 v8, 8, v163
v_lshl_add_u32 v123, v8, 20, v123
v_mul_u32_u24 v124, s9, v124
v_and_b32 v8, 255, v164
v_lshl_add_u32 v124, v8, 2, v124
v_lshrrev_b32 v8, 8, v164
v_lshl_add_u32 v124, v8, 20, v124
v_mul_u32_u24 v125, s9, v125
v_and_b32 v8, 255, v165
v_lshl_add_u32 v125, v8, 2, v125
v_lshrrev_b32 v8, 8, v165
v_lshl_add_u32 v125, v8, 20, v125
v_mul_u32_u24 v126, s9, v126
v_and_b32 v8, 255, v166
v_lshl_add_u32 v126, v8, 2, v126
v_lshrrev_b32 v8, 8, v166
v_lshl_add_u32 v126, v8, 20, v126
v_mul_u32_u24 v127, s9, v127
v_and_b32 v8, 255, v167
v_lshl_add_u32 v127, v8, 2, v127
v_lshrrev_b32 v8, 8, v167
v_lshl_add_u32 v127, v8, 20, v127
v_mul_u32_u24 v128, s9, v128
v_and_b32 v8, 255, v168
v_lshl_add_u32 v128, v8, 2, v128
v_lshrrev_b32 v8, 8, v168
v_lshl_add_u32 v128, v8, 20, v128
v_mul_u32_u24 v129, s9, v129
v_and_b32 v8, 255, v169
v_lshl_add_u32 v129, v8, 2, v129
v_lshrrev_b32 v8, 8, v169
v_lshl_add_u32 v129, v8, 20, v129
v_mul_u32_u24 v130, s9, v130
v_and_b32 v8, 255, v170
v_lshl_add_u32 v130, v8, 2, v130
v_lshrrev_b32 v8, 8, v170
v_lshl_add_u32 v130, v8, 20, v130
v_mul_u32_u24 v131, s9, v131
v_and_b32 v8, 255, v171
v_lshl_add_u32 v131, v8, 2, v131
v_lshrrev_b32 v8, 8, v171
v_lshl_add_u32 v131, v8, 20, v131
v_mul_u32_u24 v132, s9, v132
v_and_b32 v8, 255, v172
v_lshl_add_u32 v132, v8, 2, v132
v_lshrrev_b32 v8, 8, v172
v_lshl_add_u32 v132, v8, 20, v132
v_mul_u32_u24 v133, s9, v133
v_and_b32 v8, 255, v173
v_lshl_add_u32 v133, v8, 2, v133
v_lshrrev_b32 v8, 8, v173
v_lshl_add_u32 v133, v8, 20, v133
v_mul_u32_u24 v134, s9, v134
v_and_b32 v8, 255, v174
v_lshl_add_u32 v134, v8, 2, v134
v_lshrrev_b32 v8, 8, v174
v_lshl_add_u32 v134, v8, 20, v134
v_mul_u32_u24 v135, s9, v135
v_and_b32 v8, 255, v175
v_lshl_add_u32 v135, v8, 2, v135
v_lshrrev_b32 v8, 8, v175
v_lshl_add_u32 v135, v8, 20, v135
buffer_store_dword v56, v96, s[48:51], s7 offen sc1
buffer_store_dword v57, v97, s[48:51], s7 offen sc1
buffer_store_dword v58, v98, s[48:51], s7 offen sc1
buffer_store_dword v59, v99, s[48:51], s7 offen sc1
buffer_store_dword v60, v100, s[48:51], s7 offen sc1
buffer_store_dword v61, v101, s[48:51], s7 offen sc1
buffer_store_dword v62, v102, s[48:51], s7 offen sc1
buffer_store_dword v63, v103, s[48:51], s7 offen sc1
buffer_store_dword v64, v104, s[48:51], s7 offen sc1
buffer_store_dword v65, v105, s[48:51], s7 offen sc1
buffer_store_dword v66, v106, s[48:51], s7 offen sc1
buffer_store_dword v67, v107, s[48:51], s7 offen sc1
buffer_store_dword v68, v108, s[48:51], s7 offen sc1
buffer_store_dword v69, v109, s[48:51], s7 offen sc1
buffer_store_dword v70, v110, s[48:51], s7 offen sc1
buffer_store_dword v71, v111, s[48:51], s7 offen sc1
buffer_store_dword v72, v112, s[48:51], s7 offen sc1
buffer_store_dword v73, v113, s[48:51], s7 offen sc1
buffer_store_dword v74, v114, s[48:51], s7 offen sc1
buffer_store_dword v75, v115, s[48:51], s7 offen sc1
buffer_store_dword v76, v116, s[48:51], s7 offen sc1
buffer_store_dword v77, v117, s[48:51], s7 offen sc1
buffer_store_dword v78, v118, s[48:51], s7 offen sc1
buffer_store_dword v79, v119, s[48:51], s7 offen sc1
buffer_store_dword v80, v120, s[48:51], s7 offen sc1
buffer_store_dword v81, v121, s[48:51], s7 offen sc1
buffer_store_dword v82, v122, s[48:51], s7 offen sc1
buffer_store_dword v83, v123, s[48:51], s7 offen sc1
buffer_store_dword v84, v124, s[48:51], s7 offen sc1
buffer_store_dword v85, v125, s[48:51], s7 offen sc1
buffer_store_dword v86, v126, s[48:51], s7 offen sc1
buffer_store_dword v87, v127, s[48:51], s7 offen sc1
buffer_store_dword v88, v128, s[48:51], s7 offen sc1
buffer_store_dword v89, v129, s[48:51], s7 offen sc1
buffer_store_dword v90, v130, s[48:51], s7 offen sc1
buffer_store_dword v91, v131, s[48:51], s7 offen sc1
s_mov_b64 exec, s[12:13]
buffer_store_dword v92, v132, s[48:51], s7 offen sc1
buffer_store_dword v93, v133, s[48:51], s7 offen sc1
buffer_store_dword v94, v134, s[48:51], s7 offen sc1
buffer_store_dword v95, v135, s[48:51], s7 offen sc1
s_mov_b64 exec, -1
s_branch L1_fin
L2_entry:
s_load_dwordx2 s[4:5], s[0:1], 88
s_load_dwordx2 s[60:61], s[0:1], 0
s_load_dwordx2 s[52:53], s[0:1], 24
s_load_dwordx2 s[56:57], s[0:1], 72
s_and_b32 s35, s2, 7
s_lshr_b32 s37, s2, 3
s_add_u32 s37, s37, 30
s_and_b32 s37, s37, 31
v_lshrrev_b32 v1, 6, v0
s_mov_b32 s36, -1
v_readfirstlane_b32 s38, v1
s_cmp_lt_u32 s37, 30
s_cbranch_scc1 L2_att
s_lshl_b32 s39, s35, 1
s_add_u32 s39, s39, s37
s_sub_u32 s39, s39, 30
s_cmp_lt_u32 s38, 3
s_cbranch_scc1 LE_start
s_cmp_ge_u32 s39, 12
s_cbranch_scc1 L2_end
s_and_b32 s36, s39, 1
s_lshr_b32 s37, s39, 1
s_mov_b32 s38, 39
v_and_b32 v0, 63, v0
s_branch L2_att2
L2_att:
s_mul_i32 s38, s37, 26
s_lshr_b32 s38, s38, 8
s_mul_i32 s39, s38, 10
s_sub_u32 s39, s37, s39
s_and_b32 s37, s35, 1
s_mul_i32 s37, s37, 3
s_add_u32 s37, s37, s38
s_and_b32 s38, s35, 1
s_mul_i32 s38, s38, 5
s_add_u32 s35, s35, s38
s_and_b32 s35, s35, 7
s_lshr_b32 s38, s35, 1
s_mul_i32 s38, s38, 10
s_add_u32 s38, s38, s39
L2_att2:
v_lshrrev_b32 v1, 6, v0
v_and_b32 v243, 63, v0
v_lshlrev_b32 v243, 4, v243
v_readfirstlane_b32 s34, v1
s_mov_b32 s50, 0xe1a06800
s_mov_b32 s51, 0x4e20ad04
s_mul_i32 s39, s37, 9
s_lshr_b64 s[50:51], s[50:51], s39
s_and_b32 s39, s50, 0x1ff
s_bfe_u32 s49, s50, 0x90009
s_sub_u32 s31, s49, s39
s_sub_u32 s31, s31, 4
s_lshl_b32 s39, s39, 14
s_lshl_b32 s49, s49, 14
s_add_u32 s28, s39, 0x4000
s_cmp_eq_u32 s37, 5
s_addc_u32 s31, s31, 0
s_cmp_eq_u32 s37, 5
s_cselect_b32 s28, s39, s28
s_cselect_b32 s39, 5111808, s39
s_cselect_b32 s49, 5120000, s49
s_cselect_b32 s33, 0xff800000, 0
s_mov_b32 s32, 0x5d800000
v_and_b32 v2, 63, v0
v_bfe_u32 v3, v2, 3, 2
v_bfe_u32 v4, v2, 2, 1
v_lshlrev_b32 v241, 12, v3
v_lshl_or_b32 v241, v4, 9, v241
v_lshl_or_b32 v241, v1, 7, v241
v_lshrrev_b32 v4, 5, v2
v_lshl_or_b32 v241, v4, 6, v241
v_and_b32 v3, 2, v3
v_and_b32 v4, 3, v2
v_xor_b32 v3, v3, v4
v_lshl_or_b32 v241, v3, 4, v241
s_cmp_eq_u32 s38, 39
s_cbranch_scc1 LT_disp
s_cmp_lt_u32 s37, 3
s_cselect_b32 s101, 1, -1
s_cselect_b32 s39, 0, 103
s_cselect_b32 s3, 0, 3
s_sub_u32 s3, s37, s3
s_mul_i32 s3, s3, 104
s_add_u32 s39, s39, s3
s_cmp_eq_u32 s37, 5
s_addc_u32 s39, s39, 0
s_lshl_b32 s101, s101, 14
s_lshl_b32 s39, s39, 14
s_add_u32 s28, s39, s101
s_mov_b32 s49, 5120000
s_mov_b32 s31, 40
s_mov_b32 s100, 5
s_lshl_b32 s30, s34, 12
s_lshl_b32 s50, s34, 13
s_add_u32 s50, s50, 0x20000
s_mov_b32 m0, s30
s_cmp_lt_u32 s37, 3
s_mov_b32 s40, 0x4682d124
s_cselect_b32 s40, s40, 0xc003fdb0
s_cselect_b32 s41, 11, 15
s_cselect_b32 s3, 0, 36
s_lshl_b32 s94, s37, 2
s_add_u32 s94, s94, s34
s_mul_i32 s94, s94, 3
s_sub_u32 s3, s94, s3
s_lshr_b64 s[40:41], s[40:41], s3
s_and_b32 s94, s40, 3
s_bfe_u32 s95, s40, 0x10002
s_mov_b32 s6, 0x92c51840
s_mov_b32 s7, 0xfb73ea6d
s_mul_i32 s3, s37, 12
s_min_u32 s3, s3, 56
s_lshr_b64 s[6:7], s[6:7], s3
s_bfe_u32 s29, s6, 0x40008
s_bfe_u32 s7, s6, 0x40004
s_and_b32 s6, s6, 15
s_cmp_lt_u32 s37, 4
s_cselect_b32 s29, s29, 16
s_lshl_b32 s3, s38, 17
s_lshl_b32 s51, s34, 7
s_add_u32 s3, s3, s51
s_lshl_b32 s6, s6, 13
s_add_u32 s6, s6, s3
s_lshl_b32 s7, s7, 13
s_add_u32 s7, s7, s3
s_lshl_b32 s29, s29, 13
s_add_u32 s29, s29, s3
s_mov_b64 s[96:97], 0
s_lshr_b32 s3, s6, 9
s_mul_i32 s90, s3, 6945
s_mov_b32 s91, s90
s_mul_i32 s90, s3, 6317
s_add_u32 s90, s90, 0x340674
s_cmp_lt_u32 s3, 5436
s_cselect_b32 s91, s91, s90
s_mul_i32 s90, s3, 6899
s_add_u32 s90, s90, 0xfffae6a0
s_cmp_lt_u32 s3, 6432
s_cselect_b32 s91, s91, s90
s_mul_i32 s90, s3, 6242
s_add_u32 s90, s90, 0x4484a0
s_cmp_lt_u32 s3, 7344
s_cselect_b32 s91, s91, s90
s_lshr_b32 s3, s91, 20
s_bitset1_b64 s[96:97], s3
s_lshr_b32 s3, s6, 9
s_add_u32 s3, s3, 15
s_mul_i32 s90, s3, 6945
s_mov_b32 s91, s90
s_mul_i32 s90, s3, 6317
s_add_u32 s90, s90, 0x340674
s_cmp_lt_u32 s3, 5436
s_cselect_b32 s91, s91, s90
s_mul_i32 s90, s3, 6899
s_add_u32 s90, s90, 0xfffae6a0
s_cmp_lt_u32 s3, 6432
s_cselect_b32 s91, s91, s90
s_mul_i32 s90, s3, 6242
s_add_u32 s90, s90, 0x4484a0
s_cmp_lt_u32 s3, 7344
s_cselect_b32 s91, s91, s90
s_lshr_b32 s3, s91, 20
s_bitset1_b64 s[96:97], s3
s_lshr_b32 s3, s7, 9
s_mul_i32 s90, s3, 6945
s_mov_b32 s91, s90
s_mul_i32 s90, s3, 6317
s_add_u32 s90, s90, 0x340674
s_cmp_lt_u32 s3, 5436
s_cselect_b32 s91, s91, s90
s_mul_i32 s90, s3, 6899
s_add_u32 s90, s90, 0xfffae6a0
s_cmp_lt_u32 s3, 6432
s_cselect_b32 s91, s91, s90
s_mul_i32 s90, s3, 6242
s_add_u32 s90, s90, 0x4484a0
s_cmp_lt_u32 s3, 7344
s_cselect_b32 s91, s91, s90
s_lshr_b32 s3, s91, 20
s_bitset1_b64 s[96:97], s3
s_lshr_b32 s3, s7, 9
s_add_u32 s3, s3, 15
s_mul_i32 s90, s3, 6945
s_mov_b32 s91, s90
s_mul_i32 s90, s3, 6317
s_add_u32 s90, s90, 0x340674
s_cmp_lt_u32 s3, 5436
s_cselect_b32 s91, s91, s90
s_mul_i32 s90, s3, 6899
s_add_u32 s90, s90, 0xfffae6a0
s_cmp_lt_u32 s3, 6432
s_cselect_b32 s91, s91, s90
s_mul_i32 s90, s3, 6242
s_add_u32 s90, s90, 0x4484a0
s_cmp_lt_u32 s3, 7344
s_cselect_b32 s91, s91, s90
s_lshr_b32 s3, s91, 20
s_bitset1_b64 s[96:97], s3
s_lshr_b32 s3, s29, 9
s_mul_i32 s90, s3, 6945
s_mov_b32 s91, s90
s_mul_i32 s90, s3, 6317
s_add_u32 s90, s90, 0x340674
s_cmp_lt_u32 s3, 5436
s_cselect_b32 s91, s91, s90
s_mul_i32 s90, s3, 6899
s_add_u32 s90, s90, 0xfffae6a0
s_cmp_lt_u32 s3, 6432
s_cselect_b32 s91, s91, s90
s_mul_i32 s90, s3, 6242
s_add_u32 s90, s90, 0x4484a0
s_cmp_lt_u32 s3, 7344
s_cselect_b32 s91, s91, s90
s_lshr_b32 s3, s91, 20
s_bitset1_b64 s[96:97], s3
s_lshr_b32 s3, s29, 9
s_add_u32 s3, s3, 15
s_mul_i32 s90, s3, 6945
s_mov_b32 s91, s90
s_mul_i32 s90, s3, 6317
s_add_u32 s90, s90, 0x340674
s_cmp_lt_u32 s3, 5436
s_cselect_b32 s91, s91, s90
s_mul_i32 s90, s3, 6899
s_add_u32 s90, s90, 0xfffae6a0
s_cmp_lt_u32 s3, 6432
s_cselect_b32 s91, s91, s90
s_mul_i32 s90, s3, 6242
s_add_u32 s90, s90, 0x4484a0
s_cmp_lt_u32 s3, 7344
s_cselect_b32 s91, s91, s90
s_lshr_b32 s3, s91, 20
s_bitset1_b64 s[96:97], s3
s_mul_i32 s3, s38, 6
s_add_u32 s3, s3, s37
s_cmp_eq_u32 s3, 233
s_cselect_b32 s3, 0, s37
s_cmp_lt_u32 s3, 4
s_cselect_b32 s29, s29, 0x70000000
s_lshl_b32 s51, s38, 5
s_lshl_b32 s3, s34, 3
s_add_u32 s51, s51, s3
s_add_u32 s51, s51, s37
s_mul_i32 s51, s51, 128
s_add_u32 s51, s51, 0x7c00000
s_lshr_b32 s40, s39, 17
s_min_u32 s40, s40, 38
s_lshr_b32 s41, s28, 17
s_add_u32 s3, s28, s101
s_lshr_b32 s3, s3, 17
v_mov_b32 v5, s38
v_mov_b32 v6, s40
v_cmp_lt_u32 vcc, 0x7f, v243
s_nop 1
v_cndmask_b32 v5, v5, v6, vcc
v_mov_b32 v6, s41
v_cmp_lt_u32 vcc, 0xff, v243
s_nop 1
v_cndmask_b32 v5, v5, v6, vcc
v_mov_b32 v6, s3
v_cmp_lt_u32 vcc, 0x17f, v243
s_nop 1
v_cndmask_b32 v5, v5, v6, vcc
v_bfe_u32 v6, v243, 4, 3
v_min_u32 v6, 5, v6
v_mad_u32_u24 v5, v5, 6, v6
v_lshlrev_b32 v5, 7, v5
v_add_u32 v5, 0x7c2a000, v5
s_mul_i32 s3, s101, 54
s_add_u32 s3, s3, s39
s_min_u32 s41, s3, s39
s_max_u32 s3, s3, s39
s_lshr_b32 s41, s41, 17
s_min_u32 s40, s40, s41
s_mul_i32 s40, s40, 6
s_lshr_b32 s3, s3, 17
s_min_u32 s3, s3, 38
s_mul_i32 s3, s3, 6
s_add_u32 s3, s3, 5
v_lshrrev_b32 v230, 4, v243
v_add_u32 v230, s40, v230
v_min_u32 v230, s3, v230
v_lshlrev_b32 v230, 7, v230
v_add_u32 v230, 0x7c2a000, v230
s_waitcnt lgkmcnt(0)
s_add_u32 s12, s4, 0x6800000
s_addc_u32 s13, s5, 0
s_mov_b32 s14, 0x0
s_mov_b32 s15, 0x00020000
s_mov_b32 s14, s49
s_add_u32 s8, s4, 0x0
s_addc_u32 s9, s5, 0
s_mov_b32 s10, 0x4e4000
s_mov_b32 s11, 0x00020000
s_mul_i32 s35, s37, 0x600000
s_add_u32 s20, s4, 0x2000000
s_addc_u32 s21, s5, 0
s_add_u32 s20, s20, s35
s_addc_u32 s21, s21, 0
s_mov_b32 s22, 0x4e4000
s_mov_b32 s23, 0x00020000
s_add_u32 s24, s4, 0x6000000
s_addc_u32 s25, s5, 0
s_mov_b32 s26, 0x139000
s_mov_b32 s27, 0x00020000
s_lshl_b32 s35, s38, 4
s_lshl_b32 s41, s34, 2
s_add_u32 s35, s35, s41
s_lshl_b32 s40, s35, 13
s_lshl_b32 s94, s94, 13
s_add_u32 s40, s40, s94
s_xor_b32 s41, s40, 8192
s_xor_b32 s42, s40, 16384
s_xor_b32 s43, s40, 24576
s_add_u32 s44, s40, 4096
s_add_u32 s45, s41, 4096
s_add_u32 s46, s42, 4096
s_add_u32 s47, s43, 4096
s_lshl_b32 s48, s35, 10
s_lshl_b32 s35, s37, 3
s_add_u32 s48, s48, s35
v_mov_b32 v232, 0
v_mov_b32 v233, 0
v_mov_b32 v234, 0
v_mov_b32 v235, 0
v_bfe_u32 v240, v243, 4, 3
v_lshlrev_b32 v240, 6, v240
v_bfe_u32 v242, v243, 7, 1
v_lshl_or_b32 v240, v242, 10, v240
v_bfe_u32 v242, v243, 8, 2
v_lshl_or_b32 v240, v242, 4, v240
v_bfe_u32 v242, v243, 6, 1
v_lshlrev_b32 v242, 5, v242
v_xor_b32 v240, v240, v242
v_and_b32 v246, 0x1c0, v243
v_bfe_u32 v242, v243, 9, 1
v_lshl_or_b32 v246, v242, 10, v246
v_bfe_u32 v242, v243, 8, 1
v_lshl_or_b32 v246, v242, 5, v246
v_bfe_u32 v242, v243, 4, 2
v_lshl_or_b32 v246, v242, 3, v246
v_xor_b32 v247, 32, v246
v_bfe_i32 v242, v243, 8, 1
v_and_b32 v192, s33, v242
v_and_b32 v193, s33, v242
v_and_b32 v194, s33, v242
v_and_b32 v195, s33, v242
v_mfma_f32_32x32x16_bf16 a[0:15], v[232:235], v[232:235], 0
v_mfma_f32_32x32x16_bf16 a[16:31], v[232:235], v[232:235], 0
v_mfma_f32_32x32x16_bf16 a[32:47], v[232:235], v[232:235], 0
v_mfma_f32_32x32x16_bf16 a[48:63], v[232:235], v[232:235], 0
v_mfma_f32_32x32x16_bf16 a[64:79], v[232:235], v[232:235], 0
v_mfma_f32_32x32x16_bf16 a[80:95], v[232:235], v[232:235], 0
v_mfma_f32_32x32x16_bf16 a[96:111], v[232:235], v[232:235], 0
v_mfma_f32_32x32x16_bf16 a[112:127], v[232:235], v[232:235], 0
v_mfma_f32_32x32x16_bf16 a[128:143], v[232:235], v[232:235], 0
v_mfma_f32_32x32x16_bf16 a[144:159], v[232:235], v[232:235], 0
v_mfma_f32_32x32x16_bf16 a[160:175], v[232:235], v[232:235], 0
v_mfma_f32_32x32x16_bf16 a[176:191], v[232:235], v[232:235], 0
v_mfma_f32_32x32x16_bf16 a[192:207], v[232:235], v[232:235], 0
v_mfma_f32_32x32x16_bf16 a[208:223], v[232:235], v[232:235], 0
v_mfma_f32_32x32x16_bf16 a[224:239], v[232:235], v[232:235], 0
v_mfma_f32_32x32x16_bf16 a[240:255], v[232:235], v[232:235], 0
s_add_u32 s16, s4, 0x0
s_addc_u32 s17, s5, 0
s_mov_b32 s18, 0x10000000
s_mov_b32 s19, 0x00020000
s_mov_b32 s3, 0x10000
LM_pa:
buffer_load_dwordx2 v[6:7], v5, s[16:19], 0 offen sc1
s_sub_u32 s3, s3, 1
s_waitcnt vmcnt(0)
s_cbranch_scc1 LM_pa_go
v_cmp_ne_u64 vcc, s[98:99], v[6:7]
s_nop 1
s_cbranch_vccnz LM_pa
LM_pa_go:
buffer_load_dwordx4 v241, s[12:15], s39 offen offset:0 sc1 lds
buffer_load_dwordx4 v241, s[12:15], s39 offen offset:1024 sc1 lds
buffer_load_dwordx4 v241, s[12:15], s39 offen offset:2048 sc1 lds
buffer_load_dwordx4 v241, s[12:15], s39 offen offset:3072 sc1 lds
s_add_u32 m0, s30, 0x4000
s_nop 0
buffer_load_dwordx4 v241, s[12:15], s28 offen offset:0 sc1 lds
buffer_load_dwordx4 v241, s[12:15], s28 offen offset:1024 sc1 lds
buffer_load_dwordx4 v[0:3], v243, s[8:11], s44 offen offset:3072 sc1
buffer_load_dwordx4 v[32:35], v243, s[8:11], s45 offen offset:3072 sc1
buffer_load_dwordx4 v[64:67], v243, s[8:11], s46 offen offset:3072 sc1
buffer_load_dwordx4 v[96:99], v243, s[8:11], s47 offen offset:3072 sc1
buffer_load_dwordx4 v[4:7], v243, s[8:11], s44 offen offset:2048 sc1
buffer_load_dwordx4 v[36:39], v243, s[8:11], s45 offen offset:2048 sc1
buffer_load_dwordx4 v[68:71], v243, s[8:11], s46 offen offset:2048 sc1
buffer_load_dwordx4 v[100:103], v243, s[8:11], s47 offen offset:2048 sc1
buffer_load_dwordx4 v[8:11], v243, s[8:11], s40 offen offset:0 sc1
buffer_load_dwordx4 v[40:43], v243, s[8:11], s41 offen offset:0 sc1
buffer_load_dwordx4 v[72:75], v243, s[8:11], s42 offen offset:0 sc1
buffer_load_dwordx4 v[104:107], v243, s[8:11], s43 offen offset:0 sc1
buffer_load_dwordx4 v[12:15], v243, s[8:11], s40 offen offset:1024 sc1
buffer_load_dwordx4 v[44:47], v243, s[8:11], s41 offen offset:1024 sc1
buffer_load_dwordx4 v[76:79], v243, s[8:11], s42 offen offset:1024 sc1
buffer_load_dwordx4 v[108:111], v243, s[8:11], s43 offen offset:1024 sc1
buffer_load_dwordx4 v[16:19], v243, s[8:11], s40 offen offset:2048 sc1
buffer_load_dwordx4 v[48:51], v243, s[8:11], s41 offen offset:2048 sc1
buffer_load_dwordx4 v[80:83], v243, s[8:11], s42 offen offset:2048 sc1
buffer_load_dwordx4 v[112:115], v243, s[8:11], s43 offen offset:2048 sc1
buffer_load_dwordx2 v[228:229], v230, s[16:19], 0 offen sc1
s_waitcnt vmcnt(21)
s_barrier
ds_read_b128 v[208:211], v240 offset:12800
ds_read_b128 v[212:215], v240 offset:14848
ds_read_b128 v[216:219], v240 offset:29184
ds_read_b128 v[220:223], v240 offset:12288
s_waitcnt lgkmcnt(3)
s_waitcnt vmcnt(17)
v_mfma_f32_16x16x32_bf16 v[128:131], v[208:211], v[0:3], v[192:195]
buffer_load_dwordx4 v[20:23], v243, s[8:11], s40 offen offset:3072 sc1
v_mfma_f32_16x16x32_bf16 v[132:135], v[208:211], v[32:35], v[192:195]
v_mfma_f32_16x16x32_bf16 v[136:139], v[208:211], v[64:67], v[192:195]
v_mfma_f32_16x16x32_bf16 v[140:143], v[208:211], v[96:99], v[192:195]
ds_read_b128 v[208:211], v240 offset:14336
s_waitcnt lgkmcnt(3)
buffer_load_dwordx4 v[52:55], v243, s[8:11], s41 offen offset:3072 sc1
v_mfma_f32_16x16x32_bf16 v[144:147], v[212:215], v[0:3], v[192:195]
v_mfma_f32_16x16x32_bf16 v[148:151], v[212:215], v[32:35], v[192:195]
v_mfma_f32_16x16x32_bf16 v[152:155], v[212:215], v[64:67], v[192:195]
buffer_load_dwordx4 v[84:87], v243, s[8:11], s42 offen offset:3072 sc1
v_mfma_f32_16x16x32_bf16 v[156:159], v[212:215], v[96:99], v[192:195]
ds_read_b128 v[212:215], v240 offset:28672
s_waitcnt lgkmcnt(3)
v_mfma_f32_16x16x32_bf16 v[176:179], v[216:219], v[0:3], 0
v_mfma_f32_16x16x32_bf16 v[180:183], v[216:219], v[32:35], 0
buffer_load_dwordx4 v[116:119], v243, s[8:11], s43 offen offset:3072 sc1
v_mfma_f32_16x16x32_bf16 v[184:187], v[216:219], v[64:67], 0
v_mfma_f32_16x16x32_bf16 v[188:191], v[216:219], v[96:99], 0
ds_read_b128 v[216:219], v240 offset:0
s_waitcnt lgkmcnt(3)
s_waitcnt vmcnt(17)
v_mfma_f32_16x16x32_bf16 v[128:131], v[220:223], v[4:7], v[128:131]
buffer_load_dwordx4 v[24:27], v243, s[8:11], s44 offen offset:0 sc1
v_mfma_f32_16x16x32_bf16 v[132:135], v[220:223], v[36:39], v[132:135]
v_mfma_f32_16x16x32_bf16 v[136:139], v[220:223], v[68:71], v[136:139]
v_mfma_f32_16x16x32_bf16 v[140:143], v[220:223], v[100:103], v[140:143]
ds_read_b128 v[220:223], v240 offset:2048
s_waitcnt lgkmcnt(3)
buffer_load_dwordx4 v[56:59], v243, s[8:11], s45 offen offset:0 sc1
v_mfma_f32_16x16x32_bf16 v[144:147], v[208:211], v[4:7], v[144:147]
v_mfma_f32_16x16x32_bf16 v[148:151], v[208:211], v[36:39], v[148:151]
v_mfma_f32_16x16x32_bf16 v[152:155], v[208:211], v[68:71], v[152:155]
buffer_load_dwordx4 v[88:91], v243, s[8:11], s46 offen offset:0 sc1
v_mfma_f32_16x16x32_bf16 v[156:159], v[208:211], v[100:103], v[156:159]
ds_read_b128 v[208:211], v240 offset:16384
s_waitcnt lgkmcnt(3)
v_mfma_f32_16x16x32_bf16 v[176:179], v[212:215], v[4:7], v[176:179]
v_mfma_f32_16x16x32_bf16 v[180:183], v[212:215], v[36:39], v[180:183]
buffer_load_dwordx4 v[120:123], v243, s[8:11], s47 offen offset:0 sc1
v_mfma_f32_16x16x32_bf16 v[184:187], v[212:215], v[68:71], v[184:187]
v_mfma_f32_16x16x32_bf16 v[188:191], v[212:215], v[100:103], v[188:191]
ds_read_b128 v[212:215], v240 offset:512
s_waitcnt lgkmcnt(3)
s_waitcnt vmcnt(17)
v_mfma_f32_16x16x32_bf16 v[128:131], v[216:219], v[8:11], v[128:131]
buffer_load_dwordx4 v[28:31], v243, s[8:11], s44 offen offset:1024 sc1
v_mfma_f32_16x16x32_bf16 v[132:135], v[216:219], v[40:43], v[132:135]
v_mfma_f32_16x16x32_bf16 v[136:139], v[216:219], v[72:75], v[136:139]
v_mfma_f32_16x16x32_bf16 v[140:143], v[216:219], v[104:107], v[140:143]
ds_read_b128 v[216:219], v240 offset:2560
s_waitcnt lgkmcnt(3)
buffer_load_dwordx4 v[60:63], v243, s[8:11], s45 offen offset:1024 sc1
v_mfma_f32_16x16x32_bf16 v[144:147], v[220:223], v[8:11], v[144:147]
v_mfma_f32_16x16x32_bf16 v[148:151], v[220:223], v[40:43], v[148:151]
v_mfma_f32_16x16x32_bf16 v[152:155], v[220:223], v[72:75], v[152:155]
buffer_load_dwordx4 v[92:95], v243, s[8:11], s46 offen offset:1024 sc1
v_mfma_f32_16x16x32_bf16 v[156:159], v[220:223], v[104:107], v[156:159]
ds_read_b128 v[220:223], v240 offset:16896
s_waitcnt lgkmcnt(3)
v_mfma_f32_16x16x32_bf16 v[176:179], v[208:211], v[8:11], v[176:179]
v_mfma_f32_16x16x32_bf16 v[180:183], v[208:211], v[40:43], v[180:183]
buffer_load_dwordx4 v[124:127], v243, s[8:11], s47 offen offset:1024 sc1
v_mfma_f32_16x16x32_bf16 v[184:187], v[208:211], v[72:75], v[184:187]
v_mfma_f32_16x16x32_bf16 v[188:191], v[208:211], v[104:107], v[188:191]
ds_read_b128 v[208:211], v240 offset:4096
s_waitcnt lgkmcnt(3)
s_waitcnt vmcnt(17)
v_mfma_f32_16x16x32_bf16 v[128:131], v[212:215], v[12:15], v[128:131]
s_add_u32 s16, s4, 0x0
s_addc_u32 s17, s5, 0
s_mov_b32 s18, 0x10000000
v_mfma_f32_16x16x32_bf16 v[132:135], v[212:215], v[44:47], v[132:135]
buffer_load_dwordx4 v241, s[12:15], s28 offen offset:2048 sc1 lds
s_mov_b32 s19, 0x00020000
s_add_u32 s8, s60, 0x0
v_mfma_f32_16x16x32_bf16 v[136:139], v[212:215], v[76:79], v[136:139]
s_addc_u32 s9, s61, 0
s_mov_b32 s10, 0x4e2000
s_mov_b32 s11, 0x00020000
v_mfma_f32_16x16x32_bf16 v[140:143], v[212:215], v[108:111], v[140:143]
ds_read_b128 v[212:215], v240 offset:6144
s_waitcnt lgkmcnt(3)
buffer_load_dwordx4 v241, s[12:15], s28 offen offset:3072 sc1 lds
v_mfma_f32_16x16x32_bf16 v[144:147], v[216:219], v[12:15], v[144:147]
s_mov_b32 s54, 0x4e20
s_mov_b32 s55, 0x00020000
s_mov_b32 s58, 0x4e2000
v_mfma_f32_16x16x32_bf16 v[148:151], v[216:219], v[44:47], v[148:151]
s_mov_b32 s59, 0x00020000
s_lshr_b32 s48, s40, 2
s_cmp_eq_u32 s95, 1
v_mfma_f32_16x16x32_bf16 v[152:155], v[216:219], v[76:79], v[152:155]
s_cselect_b32 s40, 0x70000000, s40
s_cselect_b32 s44, 0x70000000, s44
s_cmp_lt_u32 s37, 3
v_mfma_f32_16x16x32_bf16 v[156:159], v[216:219], v[108:111], v[156:159]
ds_read_b128 v[216:219], v240 offset:20480
s_waitcnt lgkmcnt(3)
s_cselect_b32 s3, 0, 3
v_mfma_f32_16x16x32_bf16 v[176:179], v[220:223], v[12:15], v[176:179]
s_cselect_b32 s94, 0, 8
s_sub_u32 s3, s37, s3
s_lshl_b32 s38, s38, 2
v_mfma_f32_16x16x32_bf16 v[180:183], v[220:223], v[44:47], v[180:183]
s_add_u32 s38, s38, s3
s_lshl_b32 s38, s38, 10
s_add_u32 s38, s38, 0x7c00300
v_mfma_f32_16x16x32_bf16 v[184:187], v[220:223], v[76:79], v[184:187]
s_add_u32 s94, s94, s38
s_xor_b32 s95, s94, 8
s_add_u32 s49, s95, 32
v_mfma_f32_16x16x32_bf16 v[188:191], v[220:223], v[108:111], v[188:191]
ds_read_b128 v[220:223], v240 offset:4608
s_waitcnt lgkmcnt(3)
s_waitcnt vmcnt(15)
v_mfma_f32_16x16x32_bf16 v[128:131], v[208:211], v[16:19], v[128:131]
s_cmp_eq_u32 s3, 2
s_cselect_b32 s35, s38, s94
s_cselect_b32 s49, s49, s95
v_mfma_f32_16x16x32_bf16 v[132:135], v[208:211], v[48:51], v[132:135]
s_add_u32 s28, s28, s101
s_add_u32 m0, s30, 0x8000
s_nop 0
s_mov_b32 s39, 4
v_mfma_f32_16x16x32_bf16 v[136:139], v[208:211], v[80:83], v[136:139]
v_mfma_f32_16x16x32_bf16 v[140:143], v[208:211], v[112:115], v[140:143]
ds_read_b128 v[208:211], v240 offset:6656
s_waitcnt lgkmcnt(3)
buffer_load_dwordx4 v241, s[12:15], s28 offen offset:0 sc1 lds
v_mfma_f32_16x16x32_bf16 v[144:147], v[212:215], v[16:19], v[144:147]
v_mfma_f32_16x16x32_bf16 v[148:151], v[212:215], v[48:51], v[148:151]
buffer_load_dwordx4 v241, s[12:15], s28 offen offset:1024 sc1 lds
v_mfma_f32_16x16x32_bf16 v[152:155], v[212:215], v[80:83], v[152:155]
v_mfma_f32_16x16x32_bf16 v[156:159], v[212:215], v[112:115], v[156:159]
ds_read_b128 v[212:215], v240 offset:20992
s_waitcnt lgkmcnt(3)
v_mfma_f32_16x16x32_bf16 v[176:179], v[216:219], v[16:19], v[176:179]
v_mfma_f32_16x16x32_bf16 v[180:183], v[216:219], v[48:51], v[180:183]
v_mfma_f32_16x16x32_bf16 v[184:187], v[216:219], v[80:83], v[184:187]
v_mfma_f32_16x16x32_bf16 v[188:191], v[216:219], v[112:115], v[188:191]
ds_read_b128 v[216:219], v240 offset:8192
s_waitcnt lgkmcnt(3)
s_waitcnt vmcnt(12)
v_mfma_f32_16x16x32_bf16 v[128:131], v[220:223], v[20:23], v[128:131]
v_mfma_f32_16x16x32_bf16 v[132:135], v[220:223], v[52:55], v[132:135]
buffer_load_dwordx4 v241, s[12:15], s28 offen offset:2048 sc1 lds
v_mfma_f32_16x16x32_bf16 v[136:139], v[220:223], v[84:87], v[136:139]
v_mfma_f32_16x16x32_bf16 v[140:143], v[220:223], v[116:119], v[140:143]
ds_read_b128 v[220:223], v240 offset:10240
s_waitcnt lgkmcnt(3)
buffer_load_dwordx4 v241, s[12:15], s28 offen offset:3072 sc1 lds
v_mfma_f32_16x16x32_bf16 v[144:147], v[208:211], v[20:23], v[144:147]
v_mfma_f32_16x16x32_bf16 v[148:151], v[208:211], v[52:55], v[148:151]
v_mfma_f32_16x16x32_bf16 v[152:155], v[208:211], v[84:87], v[152:155]
v_mfma_f32_16x16x32_bf16 v[156:159], v[208:211], v[116:119], v[156:159]
ds_read_b128 v[208:211], v240 offset:24576
s_waitcnt lgkmcnt(3)
v_mfma_f32_16x16x32_bf16 v[176:179], v[212:215], v[20:23], v[176:179]
v_mfma_f32_16x16x32_bf16 v[180:183], v[212:215], v[52:55], v[180:183]
v_mfma_f32_16x16x32_bf16 v[184:187], v[212:215], v[84:87], v[184:187]
v_mfma_f32_16x16x32_bf16 v[188:191], v[212:215], v[116:119], v[188:191]
ds_read_b128 v[212:215], v240 offset:8704
s_waitcnt lgkmcnt(3)
s_waitcnt vmcnt(10)
v_mfma_f32_16x16x32_bf16 v[128:131], v[216:219], v[24:27], v[128:131]
v_mfma_f32_16x16x32_bf16 v[132:135], v[216:219], v[56:59], v[132:135]
s_add_u32 s28, s28, s101
s_add_u32 s30, s30, 0xc000
v_mfma_f32_16x16x32_bf16 v[136:139], v[216:219], v[88:91], v[136:139]
v_mfma_f32_16x16x32_bf16 v[140:143], v[216:219], v[120:123], v[140:143]
ds_read_b128 v[216:219], v240 offset:10752
s_waitcnt lgkmcnt(3)
v_mfma_f32_16x16x32_bf16 v[144:147], v[220:223], v[24:27], v[144:147]
v_mfma_f32_16x16x32_bf16 v[148:151], v[220:223], v[56:59], v[148:151]
v_mfma_f32_16x16x32_bf16 v[152:155], v[220:223], v[88:91], v[152:155]
v_mfma_f32_16x16x32_bf16 v[156:159], v[220:223], v[120:123], v[156:159]
ds_read_b128 v[220:223], v240 offset:25088
s_waitcnt lgkmcnt(3)
v_mfma_f32_16x16x32_bf16 v[176:179], v[208:211], v[24:27], v[176:179]
v_mfma_f32_16x16x32_bf16 v[180:183], v[208:211], v[56:59], v[180:183]
v_mfma_f32_16x16x32_bf16 v[184:187], v[208:211], v[88:91], v[184:187]
v_mfma_f32_16x16x32_bf16 v[188:191], v[208:211], v[120:123], v[188:191]
s_waitcnt lgkmcnt(2)
s_waitcnt vmcnt(6)
v_mfma_f32_16x16x32_bf16 v[128:131], v[212:215], v[28:31], v[128:131]
v_mfma_f32_16x16x32_bf16 v[132:135], v[212:215], v[60:63], v[132:135]
v_mfma_f32_16x16x32_bf16 v[136:139], v[212:215], v[92:95], v[136:139]
v_mfma_f32_16x16x32_bf16 v[140:143], v[212:215], v[124:127], v[140:143]
s_waitcnt lgkmcnt(1)
v_mfma_f32_16x16x32_bf16 v[144:147], v[216:219], v[28:31], v[144:147]
v_mfma_f32_16x16x32_bf16 v[148:151], v[216:219], v[60:63], v[148:151]
v_mfma_f32_16x16x32_bf16 v[152:155], v[216:219], v[92:95], v[152:155]
v_mfma_f32_16x16x32_bf16 v[156:159], v[216:219], v[124:127], v[156:159]
s_waitcnt lgkmcnt(0)
v_mfma_f32_16x16x32_bf16 v[176:179], v[220:223], v[28:31], v[176:179]
v_mfma_f32_16x16x32_bf16 v[180:183], v[220:223], v[60:63], v[180:183]
v_mfma_f32_16x16x32_bf16 v[184:187], v[220:223], v[92:95], v[184:187]
v_mfma_f32_16x16x32_bf16 v[188:191], v[220:223], v[124:127], v[188:191]
v_max3_f32 v248, v128, v129, v130
v_max3_f32 v249, v132, v133, v134
v_max3_f32 v250, v136, v137, v138
v_max3_f32 v251, v140, v141, v142
v_max3_f32 v248, v248, v131, v144
v_max3_f32 v249, v249, v135, v148
v_max3_f32 v250, v250, v139, v152
v_max3_f32 v251, v251, v143, v156
v_max3_f32 v248, v248, v145, v146
v_max3_f32 v249, v249, v149, v150
v_max3_f32 v250, v250, v153, v154
v_max3_f32 v251, v251, v157, v158
v_max_f32 v248, v248, v147
v_max_f32 v249, v249, v151
v_max_f32 v250, v250, v155
v_max_f32 v251, v251, v159
v_mov_b32 v232, v248
v_mov_b32 v233, v249
v_mov_b32 v234, v250
v_mov_b32 v235, v251
v_permlane32_swap_b32 v248, v232
v_permlane32_swap_b32 v249, v233
v_permlane32_swap_b32 v250, v234
v_permlane32_swap_b32 v251, v235
v_max_f32 v248, v248, v232
v_max_f32 v249, v249, v233
v_max_f32 v250, v250, v234
v_max_f32 v251, v251, v235
v_mov_b32 v232, v248
v_mov_b32 v233, v249
v_mov_b32 v234, v250
v_mov_b32 v235, v251
v_permlane16_swap_b32 v248, v232
v_permlane16_swap_b32 v249, v233
v_permlane16_swap_b32 v250, v234
v_permlane16_swap_b32 v251, v235
v_max_f32 v248, v248, v232
v_max_f32 v249, v249, v233
v_max_f32 v250, v250, v234
v_max_f32 v251, v251, v235
v_ceil_f32 v248, v248
v_ceil_f32 v249, v249
v_ceil_f32 v250, v250
v_ceil_f32 v251, v251
v_add_f32 v248, 40.0, v248
v_add_f32 v249, 40.0, v249
v_add_f32 v250, 40.0, v250
v_add_f32 v251, 40.0, v251
v_cvt_pk_bf16_f32 v248, v248, v248
v_cvt_pk_bf16_f32 v249, v249, v249
v_cvt_pk_bf16_f32 v250, v250, v250
v_cvt_pk_bf16_f32 v251, v251, v251
v_and_b32 v248, 0xffff0000, v248
v_and_b32 v249, 0xffff0000, v249
v_and_b32 v250, 0xffff0000, v250
v_and_b32 v251, 0xffff0000, v251
v_bfe_i32 v242, v243, 8, 1
v_bfe_i32 v232, v243, 9, 1
v_and_b32 v242, v242, v232
v_and_b32 v242, 0xffff0000, v242
v_sub_f32 v224, 0, v248
v_sub_f32 v225, 0, v249
v_sub_f32 v226, 0, v250
v_sub_f32 v227, 0, v251
v_bfi_b32 v3, v242, v224, v3
v_bfi_b32 v35, v242, v225, v35
v_bfi_b32 v67, v242, v226, v67
v_bfi_b32 v99, v242, v227, v99
v_sub_f32 v128, v128, v248
v_sub_f32 v129, v129, v248
v_sub_f32 v130, v130, v248
v_sub_f32 v131, v131, v248
v_exp_f32 v128, v128
v_exp_f32 v129, v129
v_exp_f32 v130, v130
v_exp_f32 v131, v131
v_sub_f32 v132, v132, v249
v_sub_f32 v133, v133, v249
v_sub_f32 v134, v134, v249
v_sub_f32 v135, v135, v249
v_exp_f32 v132, v132
v_exp_f32 v133, v133
v_exp_f32 v134, v134
v_exp_f32 v135, v135
v_sub_f32 v136, v136, v250
v_sub_f32 v137, v137, v250
v_sub_f32 v138, v138, v250
v_sub_f32 v139, v139, v250
v_exp_f32 v136, v136
v_exp_f32 v137, v137
v_exp_f32 v138, v138
v_exp_f32 v139, v139
v_sub_f32 v140, v140, v251
v_sub_f32 v141, v141, v251
v_sub_f32 v142, v142, v251
v_sub_f32 v143, v143, v251
v_exp_f32 v140, v140
v_exp_f32 v141, v141
v_exp_f32 v142, v142
v_exp_f32 v143, v143
s_waitcnt vmcnt(4)
s_barrier
ds_read_b128 v[208:211], v240 offset:31232
ds_read_b128 v[212:215], v240 offset:30720
ds_read_b128 v[216:219], v240 offset:18432
ds_read_b128 v[220:223], v240 offset:18944
v_add_f32 v144, v144, v224
v_add_f32 v145, v145, v224
v_add_f32 v146, v146, v224
v_add_f32 v147, v147, v224
v_exp_f32 v144, v144
v_exp_f32 v145, v145
v_exp_f32 v146, v146
v_exp_f32 v147, v147
v_add_f32 v148, v148, v225
v_add_f32 v149, v149, v225
v_add_f32 v150, v150, v225
v_add_f32 v151, v151, v225
v_exp_f32 v148, v148
v_exp_f32 v149, v149
v_exp_f32 v150, v150
v_exp_f32 v151, v151
v_add_f32 v152, v152, v226
v_add_f32 v153, v153, v226
v_add_f32 v154, v154, v226
v_add_f32 v155, v155, v226
v_exp_f32 v152, v152
v_exp_f32 v153, v153
v_exp_f32 v154, v154
v_exp_f32 v155, v155
v_add_f32 v156, v156, v227
v_add_f32 v157, v157, v227
v_add_f32 v158, v158, v227
v_add_f32 v159, v159, v227
v_exp_f32 v156, v156
v_exp_f32 v157, v157
v_exp_f32 v158, v158
v_exp_f32 v159, v159
v_cvt_pk_bf16_f32 v160, v128, v129
v_cvt_pk_bf16_f32 v161, v130, v131
v_cvt_pk_bf16_f32 v164, v132, v133
v_cvt_pk_bf16_f32 v165, v134, v135
v_cvt_pk_bf16_f32 v168, v136, v137
v_cvt_pk_bf16_f32 v169, v138, v139
v_cvt_pk_bf16_f32 v172, v140, v141
v_cvt_pk_bf16_f32 v173, v142, v143
v_cvt_pk_bf16_f32 v162, v144, v145
v_cvt_pk_bf16_f32 v163, v146, v147
v_cvt_pk_bf16_f32 v166, v148, v149
v_cvt_pk_bf16_f32 v167, v150, v151
v_cvt_pk_bf16_f32 v170, v152, v153
v_cvt_pk_bf16_f32 v171, v154, v155
v_cvt_pk_bf16_f32 v174, v156, v157
v_cvt_pk_bf16_f32 v175, v158, v159
v_add_f32 v128, v176, v224
v_add_f32 v129, v177, v224
v_add_f32 v130, v178, v224
v_add_f32 v131, v179, v224
v_add_f32 v132, v180, v225
v_add_f32 v133, v181, v225
v_add_f32 v134, v182, v225
v_add_f32 v135, v183, v225
v_add_f32 v136, v184, v226
v_add_f32 v137, v185, v226
v_add_f32 v138, v186, v226
v_add_f32 v139, v187, v226
v_add_f32 v140, v188, v227
v_add_f32 v141, v189, v227
v_add_f32 v142, v190, v227
v_add_f32 v143, v191, v227
v_cmp_ne_u64 vcc, s[98:99], v[228:229]
s_nop 1
s_cbranch_vccnz LM_pb
LM_pb_ret:
s_nop 1
s_waitcnt lgkmcnt(2)
L2_ret5:
v_mfma_f32_16x16x32_bf16 v[144:147], v[208:211], v[0:3], 0
v_mfma_f32_16x16x32_bf16 v[144:147], v[212:215], v[4:7], v[144:147]
v_mfma_f32_16x16x32_bf16 v[148:151], v[208:211], v[32:35], 0
v_mfma_f32_16x16x32_bf16 v[148:151], v[212:215], v[36:39], v[148:151]
v_mfma_f32_16x16x32_bf16 v[152:155], v[208:211], v[64:67], 0
v_exp_f32 v128, v128
v_mfma_f32_16x16x32_bf16 v[152:155], v[212:215], v[68:71], v[152:155]
v_exp_f32 v129, v129
v_mfma_f32_16x16x32_bf16 v[156:159], v[208:211], v[96:99], 0
ds_read_b128 v[208:211], v240 offset:22528
v_mfma_f32_16x16x32_bf16 v[156:159], v[212:215], v[100:103], v[156:159]
ds_read_b128 v[212:215], v240 offset:23040
s_waitcnt lgkmcnt(2)
v_mfma_f32_16x16x32_bf16 v[144:147], v[216:219], v[8:11], v[144:147]
v_exp_f32 v130, v130
v_mfma_f32_16x16x32_bf16 v[144:147], v[220:223], v[12:15], v[144:147]
v_exp_f32 v131, v131
v_mfma_f32_16x16x32_bf16 v[148:151], v[216:219], v[40:43], v[148:151]
v_exp_f32 v132, v132
v_mfma_f32_16x16x32_bf16 v[148:151], v[220:223], v[44:47], v[148:151]
v_exp_f32 v133, v133
v_mfma_f32_16x16x32_bf16 v[152:155], v[216:219], v[72:75], v[152:155]
v_exp_f32 v134, v134
v_mfma_f32_16x16x32_bf16 v[152:155], v[220:223], v[76:79], v[152:155]
v_exp_f32 v135, v135
v_mfma_f32_16x16x32_bf16 v[156:159], v[216:219], v[104:107], v[156:159]
ds_read_b128 v[216:219], v240 offset:26624
v_mfma_f32_16x16x32_bf16 v[156:159], v[220:223], v[108:111], v[156:159]
ds_read_b128 v[220:223], v240 offset:27136
s_waitcnt lgkmcnt(2)
v_mfma_f32_16x16x32_bf16 v[144:147], v[208:211], v[16:19], v[144:147]
v_exp_f32 v136, v136
v_mfma_f32_16x16x32_bf16 v[144:147], v[212:215], v[20:23], v[144:147]
v_add_u32 v240, 0x8000, v240
v_mfma_f32_16x16x32_bf16 v[148:151], v[208:211], v[48:51], v[148:151]
v_and_b32 v240, 0x1ffff, v240
v_mfma_f32_16x16x32_bf16 v[148:151], v[212:215], v[52:55], v[148:151]
v_exp_f32 v137, v137
v_mfma_f32_16x16x32_bf16 v[152:155], v[208:211], v[80:83], v[152:155]
v_exp_f32 v138, v138
v_mfma_f32_16x16x32_bf16 v[152:155], v[212:215], v[84:87], v[152:155]
v_exp_f32 v139, v139
v_mfma_f32_16x16x32_bf16 v[156:159], v[208:211], v[112:115], v[156:159]
ds_read_b64_tr_b16 v[208:209], v246 offset:0
ds_read_b64_tr_b16 v[210:211], v246 offset:2048
v_mfma_f32_16x16x32_bf16 v[156:159], v[212:215], v[116:119], v[156:159]
ds_read_b64_tr_b16 v[212:213], v247 offset:0
s_waitcnt lgkmcnt(3)
v_mfma_f32_16x16x32_bf16 v[144:147], v[216:219], v[24:27], v[144:147]
ds_read_b64_tr_b16 v[214:215], v247 offset:2048
v_mfma_f32_16x16x32_bf16 v[144:147], v[220:223], v[28:31], v[144:147]
v_exp_f32 v140, v140
v_mfma_f32_16x16x32_bf16 v[148:151], v[216:219], v[56:59], v[148:151]
v_exp_f32 v141, v141
v_mfma_f32_16x16x32_bf16 v[148:151], v[220:223], v[60:63], v[148:151]
v_exp_f32 v142, v142
v_mfma_f32_16x16x32_bf16 v[152:155], v[216:219], v[88:91], v[152:155]
v_exp_f32 v143, v143
v_mfma_f32_16x16x32_bf16 v[152:155], v[220:223], v[92:95], v[152:155]
v_mfma_f32_16x16x32_bf16 v[156:159], v[216:219], v[120:123], v[156:159]
ds_read_b64_tr_b16 v[216:217], v246 offset:512
ds_read_b64_tr_b16 v[218:219], v246 offset:2560
v_mfma_f32_16x16x32_bf16 v[156:159], v[220:223], v[124:127], v[156:159]
ds_read_b64_tr_b16 v[220:221], v247 offset:512
s_waitcnt lgkmcnt(5)
v_mfma_f32_16x16x32_bf16 a[0:3], v[160:163], v[208:211], a[0:3]
ds_read_b64_tr_b16 v[222:223], v247 offset:2560
v_mfma_f32_16x16x32_bf16 a[4:7], v[164:167], v[208:211], a[4:7]
s_mov_b32 m0, s30
v_mfma_f32_16x16x32_bf16 a[8:11], v[168:171], v[208:211], a[8:11]
buffer_load_dwordx4 v241, s[12:15], s28 offen offset:0 sc1 lds
v_mfma_f32_16x16x32_bf16 a[12:15], v[172:175], v[208:211], a[12:15]
ds_read_b64_tr_b16 v[208:209], v246 offset:4096
s_waitcnt lgkmcnt(5)
v_mfma_f32_16x16x32_bf16 a[16:19], v[160:163], v[212:215], a[16:19]
ds_read_b64_tr_b16 v[210:211], v246 offset:6144
buffer_load_dwordx4 v241, s[12:15], s28 offen offset:1024 sc1 lds
v_mfma_f32_16x16x32_bf16 a[20:23], v[164:167], v[212:215], a[20:23]
v_mfma_f32_16x16x32_bf16 a[24:27], v[168:171], v[212:215], a[24:27]
buffer_load_dwordx4 v241, s[12:15], s28 offen offset:2048 sc1 lds
v_mfma_f32_16x16x32_bf16 a[28:31], v[172:175], v[212:215], a[28:31]
ds_read_b64_tr_b16 v[212:213], v247 offset:4096
s_waitcnt lgkmcnt(5)
v_mfma_f32_16x16x32_bf16 a[32:35], v[160:163], v[216:219], a[32:35]
ds_read_b64_tr_b16 v[214:215], v247 offset:6144
v_mfma_f32_16x16x32_bf16 a[36:39], v[164:167], v[216:219], a[36:39]
buffer_load_dwordx4 v241, s[12:15], s28 offen offset:3072 sc1 lds
v_mfma_f32_16x16x32_bf16 a[40:43], v[168:171], v[216:219], a[40:43]
v_exp_f32 v144, v144
v_mfma_f32_16x16x32_bf16 a[44:47], v[172:175], v[216:219], a[44:47]
ds_read_b64_tr_b16 v[216:217], v246 offset:4608
s_waitcnt lgkmcnt(5)
v_mfma_f32_16x16x32_bf16 a[48:51], v[160:163], v[220:223], a[48:51]
ds_read_b64_tr_b16 v[218:219], v246 offset:6656
v_mfma_f32_16x16x32_bf16 a[52:55], v[164:167], v[220:223], a[52:55]
v_exp_f32 v145, v145
v_mfma_f32_16x16x32_bf16 a[56:59], v[168:171], v[220:223], a[56:59]
v_exp_f32 v146, v146
v_mfma_f32_16x16x32_bf16 a[60:63], v[172:175], v[220:223], a[60:63]
ds_read_b64_tr_b16 v[220:221], v247 offset:4608
s_waitcnt lgkmcnt(5)
v_mfma_f32_16x16x32_bf16 a[64:67], v[160:163], v[208:211], a[64:67]
ds_read_b64_tr_b16 v[222:223], v247 offset:6656
v_mfma_f32_16x16x32_bf16 a[68:71], v[164:167], v[208:211], a[68:71]
s_waitcnt vmcnt(4)
s_barrier
v_mfma_f32_16x16x32_bf16 a[72:75], v[168:171], v[208:211], a[72:75]
v_exp_f32 v147, v147
v_mfma_f32_16x16x32_bf16 a[76:79], v[172:175], v[208:211], a[76:79]
ds_read_b128 v[208:211], v240 offset:12800
s_waitcnt lgkmcnt(5)
v_mfma_f32_16x16x32_bf16 a[80:83], v[160:163], v[212:215], a[80:83]
v_exp_f32 v148, v148
v_mfma_f32_16x16x32_bf16 a[84:87], v[164:167], v[212:215], a[84:87]
v_exp_f32 v149, v149
v_mfma_f32_16x16x32_bf16 a[88:91], v[168:171], v[212:215], a[88:91]
v_exp_f32 v150, v150
v_mfma_f32_16x16x32_bf16 a[92:95], v[172:175], v[212:215], a[92:95]
ds_read_b128 v[212:215], v240 offset:12288
s_waitcnt lgkmcnt(4)
v_mfma_f32_16x16x32_bf16 a[96:99], v[160:163], v[216:219], a[96:99]
v_exp_f32 v151, v151
v_mfma_f32_16x16x32_bf16 a[100:103], v[164:167], v[216:219], a[100:103]
v_cvt_pk_bf16_f32 v176, v128, v129
v_cvt_pk_bf16_f32 v177, v130, v131
v_mfma_f32_16x16x32_bf16 a[104:107], v[168:171], v[216:219], a[104:107]
v_exp_f32 v152, v152
v_mfma_f32_16x16x32_bf16 a[108:111], v[172:175], v[216:219], a[108:111]
ds_read_b128 v[216:219], v240 offset:0
s_waitcnt lgkmcnt(3)
v_cvt_pk_bf16_f32 v180, v132, v133
v_cvt_pk_bf16_f32 v181, v134, v135
v_mfma_f32_16x16x32_bf16 a[112:115], v[160:163], v[220:223], a[112:115]
v_exp_f32 v153, v153
v_mfma_f32_16x16x32_bf16 a[116:119], v[164:167], v[220:223], a[116:119]
v_cvt_pk_bf16_f32 v184, v136, v137
v_cvt_pk_bf16_f32 v185, v138, v139
v_mfma_f32_16x16x32_bf16 a[120:123], v[168:171], v[220:223], a[120:123]
v_exp_f32 v154, v154
v_mfma_f32_16x16x32_bf16 a[124:127], v[172:175], v[220:223], a[124:127]
ds_read_b128 v[220:223], v240 offset:512
s_waitcnt lgkmcnt(2)
v_mfma_f32_16x16x32_bf16 v[128:131], v[208:211], v[0:3], 0
v_exp_f32 v155, v155
v_mfma_f32_16x16x32_bf16 v[128:131], v[212:215], v[4:7], v[128:131]
v_cvt_pk_bf16_f32 v188, v140, v141
v_cvt_pk_bf16_f32 v189, v142, v143
v_mfma_f32_16x16x32_bf16 v[132:135], v[208:211], v[32:35], 0
v_exp_f32 v156, v156
v_mfma_f32_16x16x32_bf16 v[132:135], v[212:215], v[36:39], v[132:135]
v_exp_f32 v157, v157
v_mfma_f32_16x16x32_bf16 v[136:139], v[208:211], v[64:67], 0
v_exp_f32 v158, v158
v_mfma_f32_16x16x32_bf16 v[136:139], v[212:215], v[68:71], v[136:139]
v_exp_f32 v159, v159
v_mfma_f32_16x16x32_bf16 v[140:143], v[208:211], v[96:99], 0
ds_read_b128 v[208:211], v240 offset:4096
v_cvt_pk_bf16_f32 v178, v144, v145
v_cvt_pk_bf16_f32 v179, v146, v147
v_mfma_f32_16x16x32_bf16 v[140:143], v[212:215], v[100:103], v[140:143]
ds_read_b128 v[212:215], v240 offset:4608
s_waitcnt lgkmcnt(2)
v_cvt_pk_bf16_f32 v182, v148, v149
v_mfma_f32_16x16x32_bf16 v[128:131], v[216:219], v[8:11], v[128:131]
v_cvt_pk_bf16_f32 v183, v150, v151
v_cvt_pk_bf16_f32 v186, v152, v153
v_cvt_pk_bf16_f32 v187, v154, v155
v_mfma_f32_16x16x32_bf16 v[128:131], v[220:223], v[12:15], v[128:131]
v_cvt_pk_bf16_f32 v190, v156, v157
v_cvt_pk_bf16_f32 v191, v158, v159
v_or3_b32 v242, v176, v177, v178
v_mfma_f32_16x16x32_bf16 v[132:135], v[216:219], v[40:43], v[132:135]
v_or3_b32 v242, v242, v179, v180
v_or3_b32 v242, v242, v181, v182
v_or3_b32 v242, v242, v183, v184
v_mfma_f32_16x16x32_bf16 v[132:135], v[220:223], v[44:47], v[132:135]
v_or3_b32 v242, v242, v185, v186
v_or3_b32 v242, v242, v187, v188
v_or3_b32 v242, v242, v189, v190
v_mfma_f32_16x16x32_bf16 v[136:139], v[216:219], v[72:75], v[136:139]
v_or_b32 v242, v242, v191
v_lshl_or_b32 v242, v242, 16, v242
v_cmp_le_u32 vcc, 2.0, v242
v_mfma_f32_16x16x32_bf16 v[136:139], v[220:223], v[76:79], v[136:139]
v_mfma_f32_16x16x32_bf16 v[140:143], v[216:219], v[104:107], v[140:143]
ds_read_b128 v[216:219], v240 offset:8192
v_mfma_f32_16x16x32_bf16 v[140:143], v[220:223], v[108:111], v[140:143]
ds_read_b128 v[220:223], v240 offset:8704
s_waitcnt lgkmcnt(2)
s_cbranch_vccnz L2_rare_site4
L2_ret4:
v_mfma_f32_16x16x32_bf16 v[128:131], v[208:211], v[16:19], v[128:131]
v_mfma_f32_16x16x32_bf16 v[128:131], v[212:215], v[20:23], v[128:131]
v_mfma_f32_16x16x32_bf16 v[132:135], v[208:211], v[48:51], v[132:135]
v_mfma_f32_16x16x32_bf16 v[132:135], v[212:215], v[52:55], v[132:135]
v_mfma_f32_16x16x32_bf16 v[136:139], v[208:211], v[80:83], v[136:139]
v_mfma_f32_16x16x32_bf16 v[136:139], v[212:215], v[84:87], v[136:139]
s_sub_u32 s31, s31, 1
v_mfma_f32_16x16x32_bf16 v[140:143], v[208:211], v[112:115], v[140:143]
ds_read_b128 v[208:211], v240 offset:14848
v_mfma_f32_16x16x32_bf16 v[140:143], v[212:215], v[116:119], v[140:143]
ds_read_b128 v[212:215], v240 offset:14336
s_waitcnt lgkmcnt(2)
v_mfma_f32_16x16x32_bf16 v[128:131], v[216:219], v[24:27], v[128:131]
s_add_u32 s28, s28, s101
s_add_u32 s30, s30, 0x4000
v_mfma_f32_16x16x32_bf16 v[128:131], v[220:223], v[28:31], v[128:131]
s_and_b32 s30, s30, 0x1ffff
v_mfma_f32_16x16x32_bf16 v[132:135], v[216:219], v[56:59], v[132:135]
v_mfma_f32_16x16x32_bf16 v[132:135], v[220:223], v[60:63], v[132:135]
v_mfma_f32_16x16x32_bf16 v[136:139], v[216:219], v[88:91], v[136:139]
v_mfma_f32_16x16x32_bf16 v[136:139], v[220:223], v[92:95], v[136:139]
v_mfma_f32_16x16x32_bf16 v[140:143], v[216:219], v[120:123], v[140:143]
ds_read_b128 v[216:219], v240 offset:2048
v_mfma_f32_16x16x32_bf16 v[140:143], v[220:223], v[124:127], v[140:143]
ds_read_b128 v[220:223], v240 offset:2560
s_branch L2_loop1
.p2align 6
L2_loop:
s_waitcnt lgkmcnt(2)
L2_ret1:
v_mfma_f32_16x16x32_bf16 v[144:147], v[208:211], v[0:3], 0
v_mfma_f32_16x16x32_bf16 v[144:147], v[212:215], v[4:7], v[144:147]
v_mfma_f32_16x16x32_bf16 v[148:151], v[208:211], v[32:35], 0
v_mfma_f32_16x16x32_bf16 v[148:151], v[212:215], v[36:39], v[148:151]
v_mfma_f32_16x16x32_bf16 v[152:155], v[208:211], v[64:67], 0
v_exp_f32 v128, v128
v_mfma_f32_16x16x32_bf16 v[152:155], v[212:215], v[68:71], v[152:155]
v_exp_f32 v129, v129
v_mfma_f32_16x16x32_bf16 v[156:159], v[208:211], v[96:99], 0
ds_read_b128 v[208:211], v240 offset:22528
v_mfma_f32_16x16x32_bf16 v[156:159], v[212:215], v[100:103], v[156:159]
ds_read_b128 v[212:215], v240 offset:23040
s_waitcnt lgkmcnt(2)
v_mfma_f32_16x16x32_bf16 v[144:147], v[216:219], v[8:11], v[144:147]
v_exp_f32 v130, v130
v_mfma_f32_16x16x32_bf16 v[144:147], v[220:223], v[12:15], v[144:147]
v_exp_f32 v131, v131
v_mfma_f32_16x16x32_bf16 v[148:151], v[216:219], v[40:43], v[148:151]
v_exp_f32 v132, v132
v_mfma_f32_16x16x32_bf16 v[148:151], v[220:223], v[44:47], v[148:151]
v_exp_f32 v133, v133
v_mfma_f32_16x16x32_bf16 v[152:155], v[216:219], v[72:75], v[152:155]
v_exp_f32 v134, v134
v_mfma_f32_16x16x32_bf16 v[152:155], v[220:223], v[76:79], v[152:155]
v_exp_f32 v135, v135
v_mfma_f32_16x16x32_bf16 v[156:159], v[216:219], v[104:107], v[156:159]
ds_read_b128 v[216:219], v240 offset:26624
v_mfma_f32_16x16x32_bf16 v[156:159], v[220:223], v[108:111], v[156:159]
ds_read_b128 v[220:223], v240 offset:27136
s_waitcnt lgkmcnt(2)
v_mfma_f32_16x16x32_bf16 v[144:147], v[208:211], v[16:19], v[144:147]
v_exp_f32 v136, v136
v_mfma_f32_16x16x32_bf16 v[144:147], v[212:215], v[20:23], v[144:147]
v_add_u32 v240, 0x8000, v240
v_mfma_f32_16x16x32_bf16 v[148:151], v[208:211], v[48:51], v[148:151]
v_and_b32 v240, 0x1ffff, v240
v_mfma_f32_16x16x32_bf16 v[148:151], v[212:215], v[52:55], v[148:151]
v_exp_f32 v137, v137
v_mfma_f32_16x16x32_bf16 v[152:155], v[208:211], v[80:83], v[152:155]
v_exp_f32 v138, v138
v_mfma_f32_16x16x32_bf16 v[152:155], v[212:215], v[84:87], v[152:155]
v_exp_f32 v139, v139
v_mfma_f32_16x16x32_bf16 v[156:159], v[208:211], v[112:115], v[156:159]
ds_read_b64_tr_b16 v[208:209], v244 offset:16384
ds_read_b64_tr_b16 v[210:211], v244 offset:18432
v_mfma_f32_16x16x32_bf16 v[156:159], v[212:215], v[116:119], v[156:159]
ds_read_b64_tr_b16 v[212:213], v246 offset:0
s_waitcnt lgkmcnt(3)
v_mfma_f32_16x16x32_bf16 v[144:147], v[216:219], v[24:27], v[144:147]
ds_read_b64_tr_b16 v[214:215], v246 offset:2048
v_mfma_f32_16x16x32_bf16 v[144:147], v[220:223], v[28:31], v[144:147]
v_exp_f32 v140, v140
v_mfma_f32_16x16x32_bf16 v[148:151], v[216:219], v[56:59], v[148:151]
v_exp_f32 v141, v141
v_mfma_f32_16x16x32_bf16 v[148:151], v[220:223], v[60:63], v[148:151]
v_exp_f32 v142, v142
v_mfma_f32_16x16x32_bf16 v[152:155], v[216:219], v[88:91], v[152:155]
v_exp_f32 v143, v143
v_mfma_f32_16x16x32_bf16 v[152:155], v[220:223], v[92:95], v[152:155]
v_mfma_f32_16x16x32_bf16 v[156:159], v[216:219], v[120:123], v[156:159]
ds_read_b64_tr_b16 v[216:217], v245 offset:16384
ds_read_b64_tr_b16 v[218:219], v245 offset:18432
v_mfma_f32_16x16x32_bf16 v[156:159], v[220:223], v[124:127], v[156:159]
ds_read_b64_tr_b16 v[220:221], v247 offset:0
s_waitcnt lgkmcnt(3)
v_mfma_f32_16x16x32_bf16 a[0:3], v[176:179], v[208:211], a[0:3]
ds_read_b64_tr_b16 v[222:223], v247 offset:2048
v_mfma_f32_16x16x32_bf16 a[0:3], v[160:163], v[212:215], a[0:3]
v_mfma_f32_16x16x32_bf16 a[4:7], v[180:183], v[208:211], a[4:7]
v_mfma_f32_16x16x32_bf16 a[4:7], v[164:167], v[212:215], a[4:7]
v_mfma_f32_16x16x32_bf16 a[8:11], v[184:187], v[208:211], a[8:11]
v_mfma_f32_16x16x32_bf16 a[8:11], v[168:171], v[212:215], a[8:11]
v_mfma_f32_16x16x32_bf16 a[12:15], v[188:191], v[208:211], a[12:15]
ds_read_b64_tr_b16 v[208:209], v244 offset:16896
ds_read_b64_tr_b16 v[210:211], v244 offset:18944
v_mfma_f32_16x16x32_bf16 a[12:15], v[172:175], v[212:215], a[12:15]
ds_read_b64_tr_b16 v[212:213], v246 offset:512
s_waitcnt lgkmcnt(3)
v_mfma_f32_16x16x32_bf16 a[16:19], v[176:179], v[216:219], a[16:19]
ds_read_b64_tr_b16 v[214:215], v246 offset:2560
v_mfma_f32_16x16x32_bf16 a[16:19], v[160:163], v[220:223], a[16:19]
v_exp_f32 v144, v144
v_mfma_f32_16x16x32_bf16 a[20:23], v[180:183], v[216:219], a[20:23]
v_exp_f32 v145, v145
v_mfma_f32_16x16x32_bf16 a[20:23], v[164:167], v[220:223], a[20:23]
v_exp_f32 v146, v146
v_mfma_f32_16x16x32_bf16 a[24:27], v[184:187], v[216:219], a[24:27]
v_exp_f32 v147, v147
v_mfma_f32_16x16x32_bf16 a[24:27], v[168:171], v[220:223], a[24:27]
v_exp_f32 v148, v148
v_mfma_f32_16x16x32_bf16 a[28:31], v[188:191], v[216:219], a[28:31]
ds_read_b64_tr_b16 v[216:217], v245 offset:16896
ds_read_b64_tr_b16 v[218:219], v245 offset:18944
v_mfma_f32_16x16x32_bf16 a[28:31], v[172:175], v[220:223], a[28:31]
ds_read_b64_tr_b16 v[220:221], v247 offset:512
s_waitcnt lgkmcnt(3)
v_mfma_f32_16x16x32_bf16 a[32:35], v[176:179], v[208:211], a[32:35]
ds_read_b64_tr_b16 v[222:223], v247 offset:2560
v_mfma_f32_16x16x32_bf16 a[32:35], v[160:163], v[212:215], a[32:35]
v_exp_f32 v149, v149
v_mfma_f32_16x16x32_bf16 a[36:39], v[180:183], v[208:211], a[36:39]
v_exp_f32 v150, v150
v_mfma_f32_16x16x32_bf16 a[36:39], v[164:167], v[212:215], a[36:39]
v_exp_f32 v151, v151
v_mfma_f32_16x16x32_bf16 a[40:43], v[184:187], v[208:211], a[40:43]
s_mov_b32 m0, s30
v_mfma_f32_16x16x32_bf16 a[40:43], v[168:171], v[212:215], a[40:43]
buffer_load_dwordx4 v241, s[12:15], s28 offen offset:0 sc1 lds
v_mfma_f32_16x16x32_bf16 a[44:47], v[188:191], v[208:211], a[44:47]
ds_read_b64_tr_b16 v[208:209], v244 offset:20480
ds_read_b64_tr_b16 v[210:211], v244 offset:22528
v_mfma_f32_16x16x32_bf16 a[44:47], v[172:175], v[212:215], a[44:47]
ds_read_b64_tr_b16 v[212:213], v246 offset:4096
s_waitcnt lgkmcnt(3)
v_mfma_f32_16x16x32_bf16 a[48:51], v[176:179], v[216:219], a[48:51]
ds_read_b64_tr_b16 v[214:215], v246 offset:6144
v_mfma_f32_16x16x32_bf16 a[48:51], v[160:163], v[220:223], a[48:51]
buffer_load_dwordx4 v241, s[12:15], s28 offen offset:1024 sc1 lds
v_mfma_f32_16x16x32_bf16 a[52:55], v[180:183], v[216:219], a[52:55]
v_exp_f32 v152, v152
v_mfma_f32_16x16x32_bf16 a[52:55], v[164:167], v[220:223], a[52:55]
v_exp_f32 v153, v153
v_mfma_f32_16x16x32_bf16 a[56:59], v[184:187], v[216:219], a[56:59]
v_exp_f32 v154, v154
v_mfma_f32_16x16x32_bf16 a[56:59], v[168:171], v[220:223], a[56:59]
buffer_load_dwordx4 v241, s[12:15], s28 offen offset:2048 sc1 lds
v_mfma_f32_16x16x32_bf16 a[60:63], v[188:191], v[216:219], a[60:63]
ds_read_b64_tr_b16 v[216:217], v245 offset:20480
ds_read_b64_tr_b16 v[218:219], v245 offset:22528
v_mfma_f32_16x16x32_bf16 a[60:63], v[172:175], v[220:223], a[60:63]
ds_read_b64_tr_b16 v[220:221], v247 offset:4096
s_waitcnt lgkmcnt(3)
v_mfma_f32_16x16x32_bf16 a[64:67], v[176:179], v[208:211], a[64:67]
ds_read_b64_tr_b16 v[222:223], v247 offset:6144
v_mfma_f32_16x16x32_bf16 a[64:67], v[160:163], v[212:215], a[64:67]
buffer_load_dwordx4 v241, s[12:15], s28 offen offset:3072 sc1 lds
v_mfma_f32_16x16x32_bf16 a[68:71], v[180:183], v[208:211], a[68:71]
v_exp_f32 v155, v155
v_mfma_f32_16x16x32_bf16 a[68:71], v[164:167], v[212:215], a[68:71]
v_exp_f32 v156, v156
v_mfma_f32_16x16x32_bf16 a[72:75], v[184:187], v[208:211], a[72:75]
v_exp_f32 v157, v157
v_mfma_f32_16x16x32_bf16 a[72:75], v[168:171], v[212:215], a[72:75]
v_exp_f32 v158, v158
v_mfma_f32_16x16x32_bf16 a[76:79], v[188:191], v[208:211], a[76:79]
ds_read_b64_tr_b16 v[208:209], v244 offset:20992
ds_read_b64_tr_b16 v[210:211], v244 offset:23040
v_mfma_f32_16x16x32_bf16 a[76:79], v[172:175], v[212:215], a[76:79]
ds_read_b64_tr_b16 v[212:213], v246 offset:4608
s_waitcnt lgkmcnt(3)
v_mfma_f32_16x16x32_bf16 a[80:83], v[176:179], v[216:219], a[80:83]
ds_read_b64_tr_b16 v[214:215], v246 offset:6656
v_mfma_f32_16x16x32_bf16 a[80:83], v[160:163], v[220:223], a[80:83]
v_exp_f32 v159, v159
v_mfma_f32_16x16x32_bf16 a[84:87], v[180:183], v[216:219], a[84:87]
v_mfma_f32_16x16x32_bf16 a[84:87], v[164:167], v[220:223], a[84:87]
v_mfma_f32_16x16x32_bf16 a[88:91], v[184:187], v[216:219], a[88:91]
v_mfma_f32_16x16x32_bf16 a[88:91], v[168:171], v[220:223], a[88:91]
v_mfma_f32_16x16x32_bf16 a[92:95], v[188:191], v[216:219], a[92:95]
ds_read_b64_tr_b16 v[216:217], v245 offset:20992
ds_read_b64_tr_b16 v[218:219], v245 offset:23040
v_mfma_f32_16x16x32_bf16 a[92:95], v[172:175], v[220:223], a[92:95]
ds_read_b64_tr_b16 v[220:221], v247 offset:4608
s_waitcnt lgkmcnt(3)
v_mfma_f32_16x16x32_bf16 a[96:99], v[176:179], v[208:211], a[96:99]
ds_read_b64_tr_b16 v[222:223], v247 offset:6656
v_mfma_f32_16x16x32_bf16 a[96:99], v[160:163], v[212:215], a[96:99]
s_waitcnt vmcnt(4)
s_barrier
v_mfma_f32_16x16x32_bf16 a[100:103], v[180:183], v[208:211], a[100:103]
v_mfma_f32_16x16x32_bf16 a[100:103], v[164:167], v[212:215], a[100:103]
v_mfma_f32_16x16x32_bf16 a[104:107], v[184:187], v[208:211], a[104:107]
v_mfma_f32_16x16x32_bf16 a[104:107], v[168:171], v[212:215], a[104:107]
v_mfma_f32_16x16x32_bf16 a[108:111], v[188:191], v[208:211], a[108:111]
ds_read_b128 v[208:211], v240 offset:12800
v_mfma_f32_16x16x32_bf16 a[108:111], v[172:175], v[212:215], a[108:111]
ds_read_b128 v[212:215], v240 offset:12288
s_waitcnt lgkmcnt(2)
v_mfma_f32_16x16x32_bf16 a[112:115], v[176:179], v[216:219], a[112:115]
v_mfma_f32_16x16x32_bf16 a[112:115], v[160:163], v[220:223], a[112:115]
v_cvt_pk_bf16_f32 v176, v128, v129
v_cvt_pk_bf16_f32 v177, v130, v131
v_mfma_f32_16x16x32_bf16 a[116:119], v[180:183], v[216:219], a[116:119]
v_cvt_pk_bf16_f32 v178, v144, v145
v_cvt_pk_bf16_f32 v179, v146, v147
v_mfma_f32_16x16x32_bf16 a[116:119], v[164:167], v[220:223], a[116:119]
v_cvt_pk_bf16_f32 v180, v132, v133
v_cvt_pk_bf16_f32 v181, v134, v135
v_mfma_f32_16x16x32_bf16 a[120:123], v[184:187], v[216:219], a[120:123]
v_cvt_pk_bf16_f32 v182, v148, v149
v_cvt_pk_bf16_f32 v183, v150, v151
v_mfma_f32_16x16x32_bf16 a[120:123], v[168:171], v[220:223], a[120:123]
v_cvt_pk_bf16_f32 v184, v136, v137
v_cvt_pk_bf16_f32 v185, v138, v139
v_mfma_f32_16x16x32_bf16 a[124:127], v[188:191], v[216:219], a[124:127]
ds_read_b128 v[216:219], v240 offset:0
v_or3_b32 v242, v176, v177, v178
v_mfma_f32_16x16x32_bf16 a[124:127], v[172:175], v[220:223], a[124:127]
ds_read_b128 v[220:223], v240 offset:512
s_waitcnt lgkmcnt(2)
v_mfma_f32_16x16x32_bf16 v[128:131], v[208:211], v[0:3], 0
v_cvt_pk_bf16_f32 v186, v152, v153
v_cvt_pk_bf16_f32 v187, v154, v155
v_mfma_f32_16x16x32_bf16 v[128:131], v[212:215], v[4:7], v[128:131]
v_cvt_pk_bf16_f32 v188, v140, v141
v_cvt_pk_bf16_f32 v189, v142, v143
v_mfma_f32_16x16x32_bf16 v[132:135], v[208:211], v[32:35], 0
v_cvt_pk_bf16_f32 v190, v156, v157
v_cvt_pk_bf16_f32 v191, v158, v159
v_mfma_f32_16x16x32_bf16 v[132:135], v[212:215], v[36:39], v[132:135]
v_or3_b32 v242, v242, v179, v180
v_or3_b32 v242, v242, v181, v182
v_mfma_f32_16x16x32_bf16 v[136:139], v[208:211], v[64:67], 0
v_or3_b32 v242, v242, v183, v184
v_or3_b32 v242, v242, v185, v186
v_mfma_f32_16x16x32_bf16 v[136:139], v[212:215], v[68:71], v[136:139]
v_or3_b32 v242, v242, v187, v188
v_or3_b32 v242, v242, v189, v190
v_mfma_f32_16x16x32_bf16 v[140:143], v[208:211], v[96:99], 0
ds_read_b128 v[208:211], v240 offset:4096
v_or_b32 v242, v242, v191
v_mfma_f32_16x16x32_bf16 v[140:143], v[212:215], v[100:103], v[140:143]
ds_read_b128 v[212:215], v240 offset:4608
s_waitcnt lgkmcnt(2)
v_mfma_f32_16x16x32_bf16 v[128:131], v[216:219], v[8:11], v[128:131]
v_lshl_or_b32 v242, v242, 16, v242
v_cmp_le_u32 vcc, 2.0, v242
v_mfma_f32_16x16x32_bf16 v[128:131], v[220:223], v[12:15], v[128:131]
v_mfma_f32_16x16x32_bf16 v[132:135], v[216:219], v[40:43], v[132:135]
v_mfma_f32_16x16x32_bf16 v[132:135], v[220:223], v[44:47], v[132:135]
s_cbranch_vccnz L2_rare_site0
L2_ret0:
v_mfma_f32_16x16x32_bf16 v[136:139], v[216:219], v[72:75], v[136:139]
v_mfma_f32_16x16x32_bf16 v[136:139], v[220:223], v[76:79], v[136:139]
v_mfma_f32_16x16x32_bf16 v[140:143], v[216:219], v[104:107], v[140:143]
ds_read_b128 v[216:219], v240 offset:8192
v_mfma_f32_16x16x32_bf16 v[140:143], v[220:223], v[108:111], v[140:143]
ds_read_b128 v[220:223], v240 offset:8704
s_waitcnt lgkmcnt(2)
v_mfma_f32_16x16x32_bf16 v[128:131], v[208:211], v[16:19], v[128:131]
v_mfma_f32_16x16x32_bf16 v[128:131], v[212:215], v[20:23], v[128:131]
v_mfma_f32_16x16x32_bf16 v[132:135], v[208:211], v[48:51], v[132:135]
v_mfma_f32_16x16x32_bf16 v[132:135], v[212:215], v[52:55], v[132:135]
v_mfma_f32_16x16x32_bf16 v[136:139], v[208:211], v[80:83], v[136:139]
v_mfma_f32_16x16x32_bf16 v[136:139], v[212:215], v[84:87], v[136:139]
s_sub_u32 s31, s31, 1
v_mfma_f32_16x16x32_bf16 v[140:143], v[208:211], v[112:115], v[140:143]
ds_read_b128 v[208:211], v240 offset:14848
v_mfma_f32_16x16x32_bf16 v[140:143], v[212:215], v[116:119], v[140:143]
ds_read_b128 v[212:215], v240 offset:14336
s_waitcnt lgkmcnt(2)
v_mfma_f32_16x16x32_bf16 v[128:131], v[216:219], v[24:27], v[128:131]
s_add_u32 s28, s28, s101
s_add_u32 s30, s30, 0x4000
v_mfma_f32_16x16x32_bf16 v[128:131], v[220:223], v[28:31], v[128:131]
s_and_b32 s30, s30, 0x1ffff
v_mfma_f32_16x16x32_bf16 v[132:135], v[216:219], v[56:59], v[132:135]
s_cmp_eq_u32 s31, 0
v_mfma_f32_16x16x32_bf16 v[132:135], v[220:223], v[60:63], v[132:135]
v_mfma_f32_16x16x32_bf16 v[136:139], v[216:219], v[88:91], v[136:139]
v_mfma_f32_16x16x32_bf16 v[136:139], v[220:223], v[92:95], v[136:139]
v_mfma_f32_16x16x32_bf16 v[140:143], v[216:219], v[120:123], v[140:143]
ds_read_b128 v[216:219], v240 offset:2048
v_mfma_f32_16x16x32_bf16 v[140:143], v[220:223], v[124:127], v[140:143]
ds_read_b128 v[220:223], v240 offset:2560
s_cbranch_scc1 L2_x1
L2_loop1:
s_waitcnt lgkmcnt(2)
L2_ret3:
v_mfma_f32_16x16x32_bf16 v[144:147], v[208:211], v[0:3], 0
v_mfma_f32_16x16x32_bf16 v[144:147], v[212:215], v[4:7], v[144:147]
v_mfma_f32_16x16x32_bf16 v[148:151], v[208:211], v[32:35], 0
v_mfma_f32_16x16x32_bf16 v[148:151], v[212:215], v[36:39], v[148:151]
v_mfma_f32_16x16x32_bf16 v[152:155], v[208:211], v[64:67], 0
v_exp_f32 v128, v128
v_mfma_f32_16x16x32_bf16 v[152:155], v[212:215], v[68:71], v[152:155]
v_exp_f32 v129, v129
v_mfma_f32_16x16x32_bf16 v[156:159], v[208:211], v[96:99], 0
ds_read_b128 v[208:211], v240 offset:6144
v_mfma_f32_16x16x32_bf16 v[156:159], v[212:215], v[100:103], v[156:159]
ds_read_b128 v[212:215], v240 offset:6656
s_waitcnt lgkmcnt(2)
v_mfma_f32_16x16x32_bf16 v[144:147], v[216:219], v[8:11], v[144:147]
v_exp_f32 v130, v130
v_mfma_f32_16x16x32_bf16 v[144:147], v[220:223], v[12:15], v[144:147]
v_exp_f32 v131, v131
v_mfma_f32_16x16x32_bf16 v[148:151], v[216:219], v[40:43], v[148:151]
v_exp_f32 v132, v132
v_mfma_f32_16x16x32_bf16 v[148:151], v[220:223], v[44:47], v[148:151]
v_exp_f32 v133, v133
v_mfma_f32_16x16x32_bf16 v[152:155], v[216:219], v[72:75], v[152:155]
v_exp_f32 v134, v134
v_mfma_f32_16x16x32_bf16 v[152:155], v[220:223], v[76:79], v[152:155]
v_exp_f32 v135, v135
v_mfma_f32_16x16x32_bf16 v[156:159], v[216:219], v[104:107], v[156:159]
ds_read_b128 v[216:219], v240 offset:10240
v_mfma_f32_16x16x32_bf16 v[156:159], v[220:223], v[108:111], v[156:159]
ds_read_b128 v[220:223], v240 offset:10752
s_waitcnt lgkmcnt(2)
v_mfma_f32_16x16x32_bf16 v[144:147], v[208:211], v[16:19], v[144:147]
v_exp_f32 v136, v136
v_mfma_f32_16x16x32_bf16 v[144:147], v[212:215], v[20:23], v[144:147]
v_exp_f32 v137, v137
v_mfma_f32_16x16x32_bf16 v[148:151], v[208:211], v[48:51], v[148:151]
v_exp_f32 v138, v138
v_mfma_f32_16x16x32_bf16 v[148:151], v[212:215], v[52:55], v[148:151]
v_exp_f32 v139, v139
v_mfma_f32_16x16x32_bf16 v[152:155], v[208:211], v[80:83], v[152:155]
v_exp_f32 v140, v140
v_mfma_f32_16x16x32_bf16 v[152:155], v[212:215], v[84:87], v[152:155]
v_exp_f32 v141, v141
v_mfma_f32_16x16x32_bf16 v[156:159], v[208:211], v[112:115], v[156:159]
ds_read_b64_tr_b16 v[208:209], v246 offset:8192
ds_read_b64_tr_b16 v[210:211], v246 offset:10240
v_mfma_f32_16x16x32_bf16 v[156:159], v[212:215], v[116:119], v[156:159]
ds_read_b64_tr_b16 v[212:213], v246 offset:24576
s_waitcnt lgkmcnt(3)
v_mfma_f32_16x16x32_bf16 v[144:147], v[216:219], v[24:27], v[144:147]
ds_read_b64_tr_b16 v[214:215], v246 offset:26624
v_mfma_f32_16x16x32_bf16 v[144:147], v[220:223], v[28:31], v[144:147]
v_exp_f32 v142, v142
v_mfma_f32_16x16x32_bf16 v[148:151], v[216:219], v[56:59], v[148:151]
v_exp_f32 v143, v143
v_mfma_f32_16x16x32_bf16 v[148:151], v[220:223], v[60:63], v[148:151]
v_mfma_f32_16x16x32_bf16 v[152:155], v[216:219], v[88:91], v[152:155]
v_mfma_f32_16x16x32_bf16 v[152:155], v[220:223], v[92:95], v[152:155]
v_mfma_f32_16x16x32_bf16 v[156:159], v[216:219], v[120:123], v[156:159]
ds_read_b64_tr_b16 v[216:217], v247 offset:8192
ds_read_b64_tr_b16 v[218:219], v247 offset:10240
v_mfma_f32_16x16x32_bf16 v[156:159], v[220:223], v[124:127], v[156:159]
ds_read_b64_tr_b16 v[220:221], v247 offset:24576
s_waitcnt lgkmcnt(3)
v_mfma_f32_16x16x32_bf16 a[128:131], v[160:163], v[208:211], a[128:131]
ds_read_b64_tr_b16 v[222:223], v247 offset:26624
v_mfma_f32_16x16x32_bf16 a[128:131], v[176:179], v[212:215], a[128:131]
v_mfma_f32_16x16x32_bf16 a[132:135], v[164:167], v[208:211], a[132:135]
v_mfma_f32_16x16x32_bf16 a[132:135], v[180:183], v[212:215], a[132:135]
v_mfma_f32_16x16x32_bf16 a[136:139], v[168:171], v[208:211], a[136:139]
v_mfma_f32_16x16x32_bf16 a[136:139], v[184:187], v[212:215], a[136:139]
v_mfma_f32_16x16x32_bf16 a[140:143], v[172:175], v[208:211], a[140:143]
ds_read_b64_tr_b16 v[208:209], v246 offset:8704
ds_read_b64_tr_b16 v[210:211], v246 offset:10752
v_mfma_f32_16x16x32_bf16 a[140:143], v[188:191], v[212:215], a[140:143]
ds_read_b64_tr_b16 v[212:213], v246 offset:25088
s_waitcnt lgkmcnt(3)
v_mfma_f32_16x16x32_bf16 a[144:147], v[160:163], v[216:219], a[144:147]
ds_read_b64_tr_b16 v[214:215], v246 offset:27136
v_mfma_f32_16x16x32_bf16 a[144:147], v[176:179], v[220:223], a[144:147]
v_exp_f32 v144, v144
v_mfma_f32_16x16x32_bf16 a[148:151], v[164:167], v[216:219], a[148:151]
v_exp_f32 v145, v145
v_mfma_f32_16x16x32_bf16 a[148:151], v[180:183], v[220:223], a[148:151]
v_exp_f32 v146, v146
v_mfma_f32_16x16x32_bf16 a[152:155], v[168:171], v[216:219], a[152:155]
v_exp_f32 v147, v147
v_mfma_f32_16x16x32_bf16 a[152:155], v[184:187], v[220:223], a[152:155]
v_exp_f32 v148, v148
v_mfma_f32_16x16x32_bf16 a[156:159], v[172:175], v[216:219], a[156:159]
ds_read_b64_tr_b16 v[216:217], v247 offset:8704
ds_read_b64_tr_b16 v[218:219], v247 offset:10752
v_mfma_f32_16x16x32_bf16 a[156:159], v[188:191], v[220:223], a[156:159]
ds_read_b64_tr_b16 v[220:221], v247 offset:25088
s_waitcnt lgkmcnt(3)
v_mfma_f32_16x16x32_bf16 a[160:163], v[160:163], v[208:211], a[160:163]
ds_read_b64_tr_b16 v[222:223], v247 offset:27136
v_mfma_f32_16x16x32_bf16 a[160:163], v[176:179], v[212:215], a[160:163]
v_exp_f32 v149, v149
v_mfma_f32_16x16x32_bf16 a[164:167], v[164:167], v[208:211], a[164:167]
v_exp_f32 v150, v150
v_mfma_f32_16x16x32_bf16 a[164:167], v[180:183], v[212:215], a[164:167]
v_exp_f32 v151, v151
v_mfma_f32_16x16x32_bf16 a[168:171], v[168:171], v[208:211], a[168:171]
s_mov_b32 m0, s30
v_mfma_f32_16x16x32_bf16 a[168:171], v[184:187], v[212:215], a[168:171]
buffer_load_dwordx4 v241, s[12:15], s28 offen offset:0 sc1 lds
v_mfma_f32_16x16x32_bf16 a[172:175], v[172:175], v[208:211], a[172:175]
ds_read_b64_tr_b16 v[208:209], v246 offset:12288
ds_read_b64_tr_b16 v[210:211], v246 offset:14336
v_mfma_f32_16x16x32_bf16 a[172:175], v[188:191], v[212:215], a[172:175]
ds_read_b64_tr_b16 v[212:213], v246 offset:28672
s_waitcnt lgkmcnt(3)
v_mfma_f32_16x16x32_bf16 a[176:179], v[160:163], v[216:219], a[176:179]
ds_read_b64_tr_b16 v[214:215], v246 offset:30720
v_mfma_f32_16x16x32_bf16 a[176:179], v[176:179], v[220:223], a[176:179]
buffer_load_dwordx4 v241, s[12:15], s28 offen offset:1024 sc1 lds
v_mfma_f32_16x16x32_bf16 a[180:183], v[164:167], v[216:219], a[180:183]
v_exp_f32 v152, v152
v_mfma_f32_16x16x32_bf16 a[180:183], v[180:183], v[220:223], a[180:183]
v_exp_f32 v153, v153
v_mfma_f32_16x16x32_bf16 a[184:187], v[168:171], v[216:219], a[184:187]
v_exp_f32 v154, v154
v_mfma_f32_16x16x32_bf16 a[184:187], v[184:187], v[220:223], a[184:187]
buffer_load_dwordx4 v241, s[12:15], s28 offen offset:2048 sc1 lds
v_mfma_f32_16x16x32_bf16 a[188:191], v[172:175], v[216:219], a[188:191]
ds_read_b64_tr_b16 v[216:217], v247 offset:12288
ds_read_b64_tr_b16 v[218:219], v247 offset:14336
v_mfma_f32_16x16x32_bf16 a[188:191], v[188:191], v[220:223], a[188:191]
ds_read_b64_tr_b16 v[220:221], v247 offset:28672
s_waitcnt lgkmcnt(3)
v_mfma_f32_16x16x32_bf16 a[192:195], v[160:163], v[208:211], a[192:195]
ds_read_b64_tr_b16 v[222:223], v247 offset:30720
v_mfma_f32_16x16x32_bf16 a[192:195], v[176:179], v[212:215], a[192:195]
buffer_load_dwordx4 v241, s[12:15], s28 offen offset:3072 sc1 lds
v_mfma_f32_16x16x32_bf16 a[196:199], v[164:167], v[208:211], a[196:199]
v_exp_f32 v155, v155
v_mfma_f32_16x16x32_bf16 a[196:199], v[180:183], v[212:215], a[196:199]
v_exp_f32 v156, v156
v_mfma_f32_16x16x32_bf16 a[200:203], v[168:171], v[208:211], a[200:203]
v_exp_f32 v157, v157
v_mfma_f32_16x16x32_bf16 a[200:203], v[184:187], v[212:215], a[200:203]
v_exp_f32 v158, v158
v_mfma_f32_16x16x32_bf16 a[204:207], v[172:175], v[208:211], a[204:207]
ds_read_b64_tr_b16 v[208:209], v246 offset:12800
ds_read_b64_tr_b16 v[210:211], v246 offset:14848
v_mfma_f32_16x16x32_bf16 a[204:207], v[188:191], v[212:215], a[204:207]
ds_read_b64_tr_b16 v[212:213], v246 offset:29184
s_waitcnt lgkmcnt(3)
v_mfma_f32_16x16x32_bf16 a[208:211], v[160:163], v[216:219], a[208:211]
ds_read_b64_tr_b16 v[214:215], v246 offset:31232
v_mfma_f32_16x16x32_bf16 a[208:211], v[176:179], v[220:223], a[208:211]
v_exp_f32 v159, v159
v_mfma_f32_16x16x32_bf16 a[212:215], v[164:167], v[216:219], a[212:215]
v_mfma_f32_16x16x32_bf16 a[212:215], v[180:183], v[220:223], a[212:215]
v_mfma_f32_16x16x32_bf16 a[216:219], v[168:171], v[216:219], a[216:219]
v_mfma_f32_16x16x32_bf16 a[216:219], v[184:187], v[220:223], a[216:219]
v_mfma_f32_16x16x32_bf16 a[220:223], v[172:175], v[216:219], a[220:223]
ds_read_b64_tr_b16 v[216:217], v247 offset:12800
ds_read_b64_tr_b16 v[218:219], v247 offset:14848
v_mfma_f32_16x16x32_bf16 a[220:223], v[188:191], v[220:223], a[220:223]
ds_read_b64_tr_b16 v[220:221], v247 offset:29184
s_waitcnt lgkmcnt(3)
v_mfma_f32_16x16x32_bf16 a[224:227], v[160:163], v[208:211], a[224:227]
ds_read_b64_tr_b16 v[222:223], v247 offset:31232
v_mfma_f32_16x16x32_bf16 a[224:227], v[176:179], v[212:215], a[224:227]
s_waitcnt vmcnt(4)
s_barrier
v_mfma_f32_16x16x32_bf16 a[228:231], v[164:167], v[208:211], a[228:231]
v_mfma_f32_16x16x32_bf16 a[228:231], v[180:183], v[212:215], a[228:231]
v_mfma_f32_16x16x32_bf16 a[232:235], v[168:171], v[208:211], a[232:235]
v_mfma_f32_16x16x32_bf16 a[232:235], v[184:187], v[212:215], a[232:235]
v_mfma_f32_16x16x32_bf16 a[236:239], v[172:175], v[208:211], a[236:239]
ds_read_b128 v[208:211], v240 offset:29184
v_mfma_f32_16x16x32_bf16 a[236:239], v[188:191], v[212:215], a[236:239]
ds_read_b128 v[212:215], v240 offset:28672
s_waitcnt lgkmcnt(2)
v_mfma_f32_16x16x32_bf16 a[240:243], v[160:163], v[216:219], a[240:243]
v_mfma_f32_16x16x32_bf16 a[240:243], v[176:179], v[220:223], a[240:243]
v_cvt_pk_bf16_f32 v160, v128, v129
v_cvt_pk_bf16_f32 v161, v130, v131
v_mfma_f32_16x16x32_bf16 a[244:247], v[164:167], v[216:219], a[244:247]
v_cvt_pk_bf16_f32 v162, v144, v145
v_cvt_pk_bf16_f32 v163, v146, v147
v_mfma_f32_16x16x32_bf16 a[244:247], v[180:183], v[220:223], a[244:247]
v_cvt_pk_bf16_f32 v164, v132, v133
v_cvt_pk_bf16_f32 v165, v134, v135
v_mfma_f32_16x16x32_bf16 a[248:251], v[168:171], v[216:219], a[248:251]
v_cvt_pk_bf16_f32 v166, v148, v149
v_cvt_pk_bf16_f32 v167, v150, v151
v_mfma_f32_16x16x32_bf16 a[248:251], v[184:187], v[220:223], a[248:251]
v_cvt_pk_bf16_f32 v168, v136, v137
v_cvt_pk_bf16_f32 v169, v138, v139
v_mfma_f32_16x16x32_bf16 a[252:255], v[172:175], v[216:219], a[252:255]
ds_read_b128 v[216:219], v240 offset:16384
v_or3_b32 v242, v160, v161, v162
v_mfma_f32_16x16x32_bf16 a[252:255], v[188:191], v[220:223], a[252:255]
ds_read_b128 v[220:223], v240 offset:16896
s_waitcnt lgkmcnt(2)
v_mfma_f32_16x16x32_bf16 v[128:131], v[208:211], v[0:3], 0
v_cvt_pk_bf16_f32 v170, v152, v153
v_cvt_pk_bf16_f32 v171, v154, v155
v_mfma_f32_16x16x32_bf16 v[128:131], v[212:215], v[4:7], v[128:131]
v_cvt_pk_bf16_f32 v172, v140, v141
v_cvt_pk_bf16_f32 v173, v142, v143
v_mfma_f32_16x16x32_bf16 v[132:135], v[208:211], v[32:35], 0
v_cvt_pk_bf16_f32 v174, v156, v157
v_cvt_pk_bf16_f32 v175, v158, v159
v_mfma_f32_16x16x32_bf16 v[132:135], v[212:215], v[36:39], v[132:135]
v_or3_b32 v242, v242, v163, v164
v_or3_b32 v242, v242, v165, v166
v_mfma_f32_16x16x32_bf16 v[136:139], v[208:211], v[64:67], 0
v_or3_b32 v242, v242, v167, v168
v_or3_b32 v242, v242, v169, v170
v_mfma_f32_16x16x32_bf16 v[136:139], v[212:215], v[68:71], v[136:139]
v_or3_b32 v242, v242, v171, v172
v_or3_b32 v242, v242, v173, v174
v_mfma_f32_16x16x32_bf16 v[140:143], v[208:211], v[96:99], 0
ds_read_b128 v[208:211], v240 offset:20480
v_or_b32 v242, v242, v175
v_mfma_f32_16x16x32_bf16 v[140:143], v[212:215], v[100:103], v[140:143]
ds_read_b128 v[212:215], v240 offset:20992
s_waitcnt lgkmcnt(2)
v_mfma_f32_16x16x32_bf16 v[128:131], v[216:219], v[8:11], v[128:131]
v_mov_b32 v244, v246
v_mov_b32 v245, v247
v_mfma_f32_16x16x32_bf16 v[128:131], v[220:223], v[12:15], v[128:131]
v_add_u32 v246, 0x8000, v246
v_lshl_or_b32 v242, v242, 16, v242
v_mfma_f32_16x16x32_bf16 v[132:135], v[216:219], v[40:43], v[132:135]
v_and_b32 v246, 0x1ffff, v246
v_cmp_le_u32 vcc, 2.0, v242
v_mfma_f32_16x16x32_bf16 v[132:135], v[220:223], v[44:47], v[132:135]
v_mfma_f32_16x16x32_bf16 v[136:139], v[216:219], v[72:75], v[136:139]
v_xor_b32 v247, 32, v246
v_mfma_f32_16x16x32_bf16 v[136:139], v[220:223], v[76:79], v[136:139]
s_cbranch_vccnz L2_rare_site2
L2_ret2:
v_mfma_f32_16x16x32_bf16 v[140:143], v[216:219], v[104:107], v[140:143]
ds_read_b128 v[216:219], v240 offset:24576
v_mfma_f32_16x16x32_bf16 v[140:143], v[220:223], v[108:111], v[140:143]
ds_read_b128 v[220:223], v240 offset:25088
s_waitcnt lgkmcnt(2)
v_mfma_f32_16x16x32_bf16 v[128:131], v[208:211], v[16:19], v[128:131]
v_mfma_f32_16x16x32_bf16 v[128:131], v[212:215], v[20:23], v[128:131]
v_mfma_f32_16x16x32_bf16 v[132:135], v[208:211], v[48:51], v[132:135]
v_mfma_f32_16x16x32_bf16 v[132:135], v[212:215], v[52:55], v[132:135]
v_mfma_f32_16x16x32_bf16 v[136:139], v[208:211], v[80:83], v[136:139]
v_mfma_f32_16x16x32_bf16 v[136:139], v[212:215], v[84:87], v[136:139]
s_sub_u32 s31, s31, 1
v_mfma_f32_16x16x32_bf16 v[140:143], v[208:211], v[112:115], v[140:143]
ds_read_b128 v[208:211], v240 offset:31232
v_mfma_f32_16x16x32_bf16 v[140:143], v[212:215], v[116:119], v[140:143]
ds_read_b128 v[212:215], v240 offset:30720
s_waitcnt lgkmcnt(2)
v_mfma_f32_16x16x32_bf16 v[128:131], v[216:219], v[24:27], v[128:131]
s_add_u32 s28, s28, s101
s_add_u32 s30, s30, 0x4000
v_mfma_f32_16x16x32_bf16 v[128:131], v[220:223], v[28:31], v[128:131]
s_and_b32 s30, s30, 0x1ffff
v_mfma_f32_16x16x32_bf16 v[132:135], v[216:219], v[56:59], v[132:135]
s_cmp_eq_u32 s31, 0
v_mfma_f32_16x16x32_bf16 v[132:135], v[220:223], v[60:63], v[132:135]
v_mfma_f32_16x16x32_bf16 v[136:139], v[216:219], v[88:91], v[136:139]
v_mfma_f32_16x16x32_bf16 v[136:139], v[220:223], v[92:95], v[136:139]
v_mfma_f32_16x16x32_bf16 v[140:143], v[216:219], v[120:123], v[140:143]
ds_read_b128 v[216:219], v240 offset:18432
v_mfma_f32_16x16x32_bf16 v[140:143], v[220:223], v[124:127], v[140:143]
ds_read_b128 v[220:223], v240 offset:18944
s_cbranch_scc0 L2_loop
s_cmp_eq_u32 s100, 0
s_cbranch_scc1 L2_tail_0
s_mov_b32 s3, 0
s_branch L2_ev
L2_x1:
s_cmp_eq_u32 s100, 0
s_cbranch_scc1 L2_tail_1
s_mov_b32 s3, 1
L2_ev:
s_sub_u32 s100, s100, 1
s_mov_b32 s31, 1
v_mov_b32 v230, 0x20000
s_cmp_eq_u32 s100, 0
s_cbranch_scc1 L2_ev5
s_cmp_lg_u32 s34, 0
s_cbranch_scc1 L2_evr
s_mov_b64 exec, 1
s_cmp_eq_u32 s100, 4
s_cbranch_scc1 L2_ev1
s_cmp_eq_u32 s100, 1
s_cbranch_scc1 L2_ev4
v_cmp_eq_u64 vcc, s[98:99], v[228:229]
s_nop 1
s_bitcmp1_b32 vcc_lo, 0
s_subb_u32 s39, s39, 0
v_mov_b32 v228, s98
v_mov_b32 v229, s99
s_cmp_eq_u32 s100, 2
s_cbranch_scc1 L2_ev3
buffer_atomic_swap_x2 v[228:229], off, s[16:19], s49 offset:0 sc0 sc1
s_branch L2_evx
L2_ev1:
v_mov_b32 v228, s98
v_mov_b32 v229, s99
buffer_atomic_swap_x2 v[228:229], off, s[16:19], s95 offset:16 sc0 sc1
s_branch L2_evx
L2_ev3:
v_mov_b32 v252, s98
v_mov_b32 v253, s99
buffer_atomic_swap_x2 v[228:229], off, s[16:19], s35 offset:0 sc0 sc1
buffer_atomic_swap_x2 v[252:253], off, s[16:19], s94 offset:16 sc0 sc1
s_branch L2_evx
L2_ev4:
v_cmp_ne_u64 vcc, s[98:99], v[228:229]
s_nop 1
s_bitcmp1_b32 vcc_lo, 0
s_addc_u32 s39, s39, 0
v_cmp_ne_u64 vcc, s[98:99], v[252:253]
s_nop 1
s_bitcmp1_b32 vcc_lo, 0
s_addc_u32 s39, s39, 0
v_mov_b32 v228, s39
ds_write_b32 v230, v228
L2_evx:
s_mov_b64 exec, -1
s_branch L2_evr
L2_ev5:
ds_read_b32 v228, v230
s_waitcnt lgkmcnt(0)
v_readfirstlane_b32 s31, v228
L2_evr:
s_cmp_eq_u32 s3, 0
s_cbranch_scc1 L2_loop
s_branch L2_loop1
L2_tail_0:
s_waitcnt lgkmcnt(2)
v_add_u32 v231, s50, v243
v_mfma_f32_16x16x32_bf16 v[144:147], v[208:211], v[0:3], 0
s_mov_b32 m0, s30
ds_write_b128 v231, v[176:179] offset:0
v_mfma_f32_16x16x32_bf16 v[144:147], v[212:215], v[4:7], v[144:147]
buffer_load_dwordx4 v241, s[12:15], s28 offen offset:0 sc1 lds
ds_write_b128 v231, v[180:183] offset:1024
v_mfma_f32_16x16x32_bf16 v[148:151], v[208:211], v[32:35], 0
buffer_load_dwordx4 v241, s[12:15], s28 offen offset:1024 sc1 lds
ds_write_b128 v231, v[184:187] offset:2048
v_mfma_f32_16x16x32_bf16 v[148:151], v[212:215], v[36:39], v[148:151]
buffer_load_dwordx4 v241, s[12:15], s28 offen offset:2048 sc1 lds
ds_write_b128 v231, v[188:191] offset:3072
v_mfma_f32_16x16x32_bf16 v[152:155], v[208:211], v[64:67], 0
buffer_load_dwordx4 v241, s[12:15], s28 offen offset:3072 sc1 lds
v_add_u32 v230, 0x8000, v240
v_and_b32 v230, 0x1ffff, v230
v_mfma_f32_16x16x32_bf16 v[152:155], v[212:215], v[68:71], v[152:155]
v_exp_f32 v232, v128
v_mfma_f32_16x16x32_bf16 v[156:159], v[208:211], v[96:99], 0
ds_read_b128 v[208:211], v240 offset:22528
v_exp_f32 v233, v129
v_mfma_f32_16x16x32_bf16 v[156:159], v[212:215], v[100:103], v[156:159]
ds_read_b128 v[212:215], v240 offset:23040
s_waitcnt lgkmcnt(2)
s_and_b32 s30, s30, 0x1c000
v_mfma_f32_16x16x32_bf16 v[144:147], v[216:219], v[8:11], v[144:147]
v_exp_f32 v234, v130
v_cvt_pk_bf16_f32 v176, v232, v233
v_mfma_f32_16x16x32_bf16 v[144:147], v[220:223], v[12:15], v[144:147]
v_exp_f32 v235, v131
s_add_u32 s28, s30, 0xc000
v_mfma_f32_16x16x32_bf16 v[148:151], v[216:219], v[40:43], v[148:151]
v_exp_f32 v236, v132
v_cvt_pk_bf16_f32 v177, v234, v235
v_mfma_f32_16x16x32_bf16 v[148:151], v[220:223], v[44:47], v[148:151]
v_exp_f32 v237, v133
s_and_b32 s28, s28, 0x1ffff
v_mfma_f32_16x16x32_bf16 v[152:155], v[216:219], v[72:75], v[152:155]
v_exp_f32 v238, v134
v_cvt_pk_bf16_f32 v180, v236, v237
v_mfma_f32_16x16x32_bf16 v[152:155], v[220:223], v[76:79], v[152:155]
v_exp_f32 v239, v135
s_add_u32 s30, s30, 0x4000
v_mfma_f32_16x16x32_bf16 v[156:159], v[216:219], v[104:107], v[156:159]
ds_read_b128 v[216:219], v240 offset:26624
v_exp_f32 v232, v136
v_mfma_f32_16x16x32_bf16 v[156:159], v[220:223], v[108:111], v[156:159]
ds_read_b128 v[220:223], v240 offset:27136
s_waitcnt lgkmcnt(2)
v_cvt_pk_bf16_f32 v181, v238, v239
v_mfma_f32_16x16x32_bf16 v[144:147], v[208:211], v[16:19], v[144:147]
v_exp_f32 v233, v137
s_and_b32 s30, s30, 0x1ffff
v_mfma_f32_16x16x32_bf16 v[144:147], v[212:215], v[20:23], v[144:147]
s_waitcnt vmcnt(4)
s_barrier
s_mul_i32 s31, s34, 6144
v_mfma_f32_16x16x32_bf16 v[148:151], v[208:211], v[48:51], v[148:151]
v_exp_f32 v234, v138
v_cvt_pk_bf16_f32 v184, v232, v233
v_mfma_f32_16x16x32_bf16 v[148:151], v[212:215], v[52:55], v[148:151]
v_exp_f32 v235, v139
s_add_u32 s31, s31, s30
v_mfma_f32_16x16x32_bf16 v[152:155], v[208:211], v[80:83], v[152:155]
v_exp_f32 v236, v140
v_cvt_pk_bf16_f32 v185, v234, v235
v_mfma_f32_16x16x32_bf16 v[152:155], v[212:215], v[84:87], v[152:155]
v_exp_f32 v237, v141
s_lshl_b32 s3, s34, 10
v_mfma_f32_16x16x32_bf16 v[156:159], v[208:211], v[112:115], v[156:159]
ds_read_b128 v[208:211], v230 offset:12800
v_exp_f32 v238, v142
v_mfma_f32_16x16x32_bf16 v[156:159], v[212:215], v[116:119], v[156:159]
ds_read_b128 v[212:215], v230 offset:12288
s_waitcnt lgkmcnt(2)
v_cvt_pk_bf16_f32 v188, v236, v237
v_mfma_f32_16x16x32_bf16 v[144:147], v[216:219], v[24:27], v[144:147]
v_exp_f32 v239, v143
v_or3_b32 v242, v176, v177, v180
v_mfma_f32_16x16x32_bf16 v[144:147], v[220:223], v[28:31], v[144:147]
v_cvt_pk_bf16_f32 v189, v238, v239
v_or3_b32 v242, v242, v181, v184
v_or3_b32 v242, v242, v185, v188
v_mfma_f32_16x16x32_bf16 v[148:151], v[216:219], v[56:59], v[148:151]
v_or_b32 v242, v242, v189
v_lshl_or_b32 v242, v242, 16, v242
v_cmp_le_u32 vcc, 2.0, v242
v_mfma_f32_16x16x32_bf16 v[148:151], v[220:223], v[60:63], v[148:151]
s_add_u32 s28, s28, s3
s_add_u32 s3, s3, 24576
s_add_u32 s30, s30, s3
v_mfma_f32_16x16x32_bf16 v[152:155], v[216:219], v[88:91], v[152:155]
v_lshrrev_b32 v241, 4, v243
v_and_b32 v241, 0x30, v241
v_xor_b32 v241, v241, v243
v_mfma_f32_16x16x32_bf16 v[152:155], v[220:223], v[92:95], v[152:155]
s_cbranch_vccnz L2_rare_site6
L2_ret6:
v_and_b32 v228, 0x380, v243
v_mad_u32_u24 v241, v228, 3, v241
v_mfma_f32_16x16x32_bf16 v[156:159], v[216:219], v[120:123], v[156:159]
ds_read_b128 v[216:219], v230 offset:0
s_add_u32 m0, s31, 0
v_mfma_f32_16x16x32_bf16 v[156:159], v[220:223], v[124:127], v[156:159]
ds_read_b128 v[220:223], v230 offset:512
s_waitcnt lgkmcnt(2)
v_mfma_f32_16x16x32_bf16 v[128:131], v[208:211], v[0:3], 0
buffer_load_dwordx4 v241, s[8:11], s6 offen lds
s_add_u32 m0, s31, 2048
v_mfma_f32_16x16x32_bf16 v[128:131], v[212:215], v[4:7], v[128:131]
v_exp_f32 v232, v144
v_mfma_f32_16x16x32_bf16 v[132:135], v[208:211], v[32:35], 0
v_exp_f32 v233, v145
v_mfma_f32_16x16x32_bf16 v[132:135], v[212:215], v[36:39], v[132:135]
v_exp_f32 v234, v146
v_cvt_pk_bf16_f32 v178, v232, v233
v_mfma_f32_16x16x32_bf16 v[136:139], v[208:211], v[64:67], 0
v_exp_f32 v235, v147
v_mfma_f32_16x16x32_bf16 v[136:139], v[212:215], v[68:71], v[136:139]
v_exp_f32 v236, v148
v_cvt_pk_bf16_f32 v179, v234, v235
v_mfma_f32_16x16x32_bf16 v[140:143], v[208:211], v[96:99], 0
ds_read_b128 v[208:211], v230 offset:4096
v_exp_f32 v237, v149
v_mfma_f32_16x16x32_bf16 v[140:143], v[212:215], v[100:103], v[140:143]
ds_read_b128 v[212:215], v230 offset:4608
s_waitcnt lgkmcnt(2)
v_mfma_f32_16x16x32_bf16 v[128:131], v[216:219], v[8:11], v[128:131]
ds_write_b128 v231, v[160:163] offset:4096
v_exp_f32 v238, v150
v_mfma_f32_16x16x32_bf16 v[128:131], v[220:223], v[12:15], v[128:131]
ds_write_b128 v231, v[164:167] offset:5120
v_cvt_pk_bf16_f32 v182, v236, v237
v_mfma_f32_16x16x32_bf16 v[132:135], v[216:219], v[40:43], v[132:135]
ds_write_b128 v231, v[168:171] offset:6144
v_exp_f32 v239, v151
v_mfma_f32_16x16x32_bf16 v[132:135], v[220:223], v[44:47], v[132:135]
ds_write_b128 v231, v[172:175] offset:7168
v_exp_f32 v232, v152
v_mfma_f32_16x16x32_bf16 v[136:139], v[216:219], v[72:75], v[136:139]
v_cvt_pk_bf16_f32 v183, v238, v239
v_exp_f32 v233, v153
v_mfma_f32_16x16x32_bf16 v[136:139], v[220:223], v[76:79], v[136:139]
v_exp_f32 v234, v154
v_cvt_pk_bf16_f32 v186, v232, v233
v_mfma_f32_16x16x32_bf16 v[140:143], v[216:219], v[104:107], v[140:143]
ds_read_b128 v[216:219], v230 offset:8192
v_exp_f32 v235, v155
v_mfma_f32_16x16x32_bf16 v[140:143], v[220:223], v[108:111], v[140:143]
ds_read_b128 v[220:223], v230 offset:8704
s_waitcnt lgkmcnt(2)
v_mfma_f32_16x16x32_bf16 v[128:131], v[208:211], v[16:19], v[128:131]
v_exp_f32 v236, v156
v_cvt_pk_bf16_f32 v187, v234, v235
v_mfma_f32_16x16x32_bf16 v[128:131], v[212:215], v[20:23], v[128:131]
v_exp_f32 v237, v157
v_mfma_f32_16x16x32_bf16 v[132:135], v[208:211], v[48:51], v[132:135]
v_exp_f32 v238, v158
v_cvt_pk_bf16_f32 v190, v236, v237
v_mfma_f32_16x16x32_bf16 v[132:135], v[212:215], v[52:55], v[132:135]
v_exp_f32 v239, v159
v_or3_b32 v242, v178, v179, v182
v_mfma_f32_16x16x32_bf16 v[136:139], v[208:211], v[80:83], v[136:139]
v_cvt_pk_bf16_f32 v191, v238, v239
v_or3_b32 v242, v242, v183, v186
v_or3_b32 v242, v242, v187, v190
v_mfma_f32_16x16x32_bf16 v[136:139], v[212:215], v[84:87], v[136:139]
v_or_b32 v242, v242, v191
v_lshl_or_b32 v242, v242, 16, v242
v_cmp_le_u32 vcc, 2.0, v242
s_cbranch_vccnz L2_rare_site7
L2_ret7:
v_mfma_f32_16x16x32_bf16 v[140:143], v[208:211], v[112:115], v[140:143]
ds_read_b128 v[208:211], v230 offset:14848
buffer_load_dwordx4 v241, s[8:11], s7 offen lds
s_add_u32 m0, s31, 4096
v_mfma_f32_16x16x32_bf16 v[140:143], v[212:215], v[116:119], v[140:143]
ds_read_b128 v[212:215], v230 offset:14336
s_waitcnt lgkmcnt(2)
v_mfma_f32_16x16x32_bf16 v[128:131], v[216:219], v[24:27], v[128:131]
buffer_load_dwordx4 v241, s[8:11], s29 offen lds
s_add_u32 m0, s31, 1024
v_xor_b32 v241, 0x1040, v241
v_mfma_f32_16x16x32_bf16 v[128:131], v[220:223], v[28:31], v[128:131]
buffer_load_dwordx4 v241, s[8:11], s6 offen lds
s_add_u32 m0, s31, 3072
v_mfma_f32_16x16x32_bf16 v[132:135], v[216:219], v[56:59], v[132:135]
buffer_load_dwordx4 v241, s[8:11], s7 offen lds
s_add_u32 m0, s31, 5120
v_mfma_f32_16x16x32_bf16 v[132:135], v[220:223], v[60:63], v[132:135]
buffer_load_dwordx4 v241, s[8:11], s29 offen lds
v_mfma_f32_16x16x32_bf16 v[136:139], v[216:219], v[88:91], v[136:139]
v_mfma_f32_16x16x32_bf16 v[136:139], v[220:223], v[92:95], v[136:139]
v_mfma_f32_16x16x32_bf16 v[140:143], v[216:219], v[120:123], v[140:143]
ds_read_b128 v[216:219], v230 offset:2048
v_mfma_f32_16x16x32_bf16 v[140:143], v[220:223], v[124:127], v[140:143]
ds_read_b128 v[220:223], v230 offset:2560
s_waitcnt lgkmcnt(2)
v_mfma_f32_16x16x32_bf16 v[144:147], v[208:211], v[0:3], 0
v_mfma_f32_16x16x32_bf16 v[144:147], v[212:215], v[4:7], v[144:147]
v_exp_f32 v232, v128
v_mfma_f32_16x16x32_bf16 v[148:151], v[208:211], v[32:35], 0
v_exp_f32 v233, v129
v_mfma_f32_16x16x32_bf16 v[148:151], v[212:215], v[36:39], v[148:151]
v_exp_f32 v234, v130
v_cvt_pk_bf16_f32 v160, v232, v233
v_mfma_f32_16x16x32_bf16 v[152:155], v[208:211], v[64:67], 0
v_exp_f32 v235, v131
v_mfma_f32_16x16x32_bf16 v[152:155], v[212:215], v[68:71], v[152:155]
v_exp_f32 v236, v132
v_cvt_pk_bf16_f32 v161, v234, v235
v_mfma_f32_16x16x32_bf16 v[156:159], v[208:211], v[96:99], 0
ds_read_b128 v[208:211], v230 offset:6144
v_exp_f32 v237, v133
v_mfma_f32_16x16x32_bf16 v[156:159], v[212:215], v[100:103], v[156:159]
ds_read_b128 v[212:215], v230 offset:6656
s_waitcnt lgkmcnt(2)
v_mfma_f32_16x16x32_bf16 v[144:147], v[216:219], v[8:11], v[144:147]
v_exp_f32 v238, v134
v_cvt_pk_bf16_f32 v164, v236, v237
v_mfma_f32_16x16x32_bf16 v[144:147], v[220:223], v[12:15], v[144:147]
v_exp_f32 v239, v135
v_mfma_f32_16x16x32_bf16 v[148:151], v[216:219], v[40:43], v[148:151]
v_exp_f32 v232, v136
v_cvt_pk_bf16_f32 v165, v238, v239
v_mfma_f32_16x16x32_bf16 v[148:151], v[220:223], v[44:47], v[148:151]
v_exp_f32 v233, v137
v_mfma_f32_16x16x32_bf16 v[152:155], v[216:219], v[72:75], v[152:155]
v_exp_f32 v234, v138
v_cvt_pk_bf16_f32 v168, v232, v233
v_mfma_f32_16x16x32_bf16 v[152:155], v[220:223], v[76:79], v[152:155]
v_exp_f32 v235, v139
v_mfma_f32_16x16x32_bf16 v[156:159], v[216:219], v[104:107], v[156:159]
ds_read_b128 v[216:219], v230 offset:10240
v_exp_f32 v236, v140
v_mfma_f32_16x16x32_bf16 v[156:159], v[220:223], v[108:111], v[156:159]
ds_read_b128 v[220:223], v230 offset:10752
s_waitcnt lgkmcnt(2)
v_cvt_pk_bf16_f32 v169, v234, v235
v_mfma_f32_16x16x32_bf16 v[144:147], v[208:211], v[16:19], v[144:147]
v_exp_f32 v237, v141
v_mfma_f32_16x16x32_bf16 v[144:147], v[212:215], v[20:23], v[144:147]
s_waitcnt vmcnt(6)
s_barrier
v_mfma_f32_16x16x32_bf16 v[148:151], v[208:211], v[48:51], v[148:151]
v_exp_f32 v238, v142
v_cvt_pk_bf16_f32 v172, v236, v237
v_mfma_f32_16x16x32_bf16 v[148:151], v[212:215], v[52:55], v[148:151]
v_exp_f32 v239, v143
v_or3_b32 v242, v160, v161, v164
v_mfma_f32_16x16x32_bf16 v[152:155], v[208:211], v[80:83], v[152:155]
v_cvt_pk_bf16_f32 v173, v238, v239
v_or3_b32 v242, v242, v165, v168
v_or3_b32 v242, v242, v169, v172
v_mfma_f32_16x16x32_bf16 v[152:155], v[212:215], v[84:87], v[152:155]
v_or_b32 v242, v242, v173
v_lshl_or_b32 v242, v242, 16, v242
v_cmp_le_u32 vcc, 2.0, v242
s_cbranch_vccnz L2_rare_site8
L2_ret8:
v_mfma_f32_16x16x32_bf16 v[156:159], v[208:211], v[112:115], v[156:159]
ds_read_b128 v[208:211], v230 offset:29184
v_mfma_f32_16x16x32_bf16 v[156:159], v[212:215], v[116:119], v[156:159]
ds_read_b128 v[212:215], v230 offset:28672
s_waitcnt lgkmcnt(2)
v_mfma_f32_16x16x32_bf16 v[144:147], v[216:219], v[24:27], v[144:147]
v_mfma_f32_16x16x32_bf16 v[144:147], v[220:223], v[28:31], v[144:147]
v_mfma_f32_16x16x32_bf16 v[148:151], v[216:219], v[56:59], v[148:151]
v_mfma_f32_16x16x32_bf16 v[148:151], v[220:223], v[60:63], v[148:151]
v_mfma_f32_16x16x32_bf16 v[152:155], v[216:219], v[88:91], v[152:155]
v_mfma_f32_16x16x32_bf16 v[152:155], v[220:223], v[92:95], v[152:155]
v_mfma_f32_16x16x32_bf16 v[156:159], v[216:219], v[120:123], v[156:159]
ds_read_b128 v[216:219], v230 offset:16384
v_mfma_f32_16x16x32_bf16 v[156:159], v[220:223], v[124:127], v[156:159]
ds_read_b128 v[220:223], v230 offset:16896
s_waitcnt lgkmcnt(2)
v_mfma_f32_16x16x32_bf16 v[128:131], v[208:211], v[0:3], 0
v_mfma_f32_16x16x32_bf16 v[128:131], v[212:215], v[4:7], v[128:131]
v_exp_f32 v232, v144
v_mfma_f32_16x16x32_bf16 v[132:135], v[208:211], v[32:35], 0
v_exp_f32 v233, v145
v_mfma_f32_16x16x32_bf16 v[132:135], v[212:215], v[36:39], v[132:135]
v_exp_f32 v234, v146
v_cvt_pk_bf16_f32 v162, v232, v233
v_mfma_f32_16x16x32_bf16 v[136:139], v[208:211], v[64:67], 0
v_exp_f32 v235, v147
v_lshlrev_b32 v241, 3, v243
v_mfma_f32_16x16x32_bf16 v[136:139], v[212:215], v[68:71], v[136:139]
v_exp_f32 v236, v148
v_cvt_pk_bf16_f32 v163, v234, v235
v_mfma_f32_16x16x32_bf16 v[140:143], v[208:211], v[96:99], 0
ds_read_b128 v[208:211], v230 offset:20480
v_exp_f32 v237, v149
v_mfma_f32_16x16x32_bf16 v[140:143], v[212:215], v[100:103], v[140:143]
ds_read_b128 v[212:215], v230 offset:20992
s_waitcnt lgkmcnt(2)
s_mov_b32 s3, 0x7c28000
v_mfma_f32_16x16x32_bf16 v[128:131], v[216:219], v[8:11], v[128:131]
v_exp_f32 v238, v150
v_cvt_pk_bf16_f32 v166, v236, v237
v_mfma_f32_16x16x32_bf16 v[128:131], v[220:223], v[12:15], v[128:131]
v_exp_f32 v239, v151
buffer_load_dwordx2 v[240:241], v241, s[16:19], s3 offen sc1
v_mfma_f32_16x16x32_bf16 v[132:135], v[216:219], v[40:43], v[132:135]
v_exp_f32 v232, v152
v_cvt_pk_bf16_f32 v167, v238, v239
v_mfma_f32_16x16x32_bf16 v[132:135], v[220:223], v[44:47], v[132:135]
v_exp_f32 v233, v153
v_mfma_f32_16x16x32_bf16 v[136:139], v[216:219], v[72:75], v[136:139]
v_exp_f32 v234, v154
v_cvt_pk_bf16_f32 v170, v232, v233
v_mfma_f32_16x16x32_bf16 v[136:139], v[220:223], v[76:79], v[136:139]
v_exp_f32 v235, v155
v_mfma_f32_16x16x32_bf16 v[140:143], v[216:219], v[104:107], v[140:143]
ds_read_b128 v[216:219], v230 offset:24576
v_exp_f32 v236, v156
v_mfma_f32_16x16x32_bf16 v[140:143], v[220:223], v[108:111], v[140:143]
ds_read_b128 v[220:223], v230 offset:25088
s_waitcnt lgkmcnt(2)
v_cvt_pk_bf16_f32 v171, v234, v235
v_mfma_f32_16x16x32_bf16 v[128:131], v[208:211], v[16:19], v[128:131]
v_exp_f32 v237, v157
v_mfma_f32_16x16x32_bf16 v[128:131], v[212:215], v[20:23], v[128:131]
v_exp_f32 v238, v158
v_cvt_pk_bf16_f32 v174, v236, v237
v_mfma_f32_16x16x32_bf16 v[132:135], v[208:211], v[48:51], v[132:135]
v_exp_f32 v239, v159
v_or3_b32 v242, v162, v163, v166
v_mfma_f32_16x16x32_bf16 v[132:135], v[212:215], v[52:55], v[132:135]
v_cvt_pk_bf16_f32 v175, v238, v239
v_or3_b32 v242, v242, v167, v170
v_or3_b32 v242, v242, v171, v174
v_mfma_f32_16x16x32_bf16 v[136:139], v[208:211], v[80:83], v[136:139]
v_or_b32 v242, v242, v175
v_lshl_or_b32 v242, v242, 16, v242
v_cmp_le_u32 vcc, 2.0, v242
s_cbranch_vccnz L2_rare_site9
L2_ret9:
v_mfma_f32_16x16x32_bf16 v[136:139], v[212:215], v[84:87], v[136:139]
v_mfma_f32_16x16x32_bf16 v[140:143], v[208:211], v[112:115], v[140:143]
ds_read_b128 v[208:211], v230 offset:31232
v_mfma_f32_16x16x32_bf16 v[140:143], v[212:215], v[116:119], v[140:143]
ds_read_b128 v[212:215], v230 offset:30720
s_waitcnt lgkmcnt(2)
v_mfma_f32_16x16x32_bf16 v[128:131], v[216:219], v[24:27], v[128:131]
v_mfma_f32_16x16x32_bf16 v[128:131], v[220:223], v[28:31], v[128:131]
v_mfma_f32_16x16x32_bf16 v[132:135], v[216:219], v[56:59], v[132:135]
v_mfma_f32_16x16x32_bf16 v[132:135], v[220:223], v[60:63], v[132:135]
v_mfma_f32_16x16x32_bf16 v[136:139], v[216:219], v[88:91], v[136:139]
v_mfma_f32_16x16x32_bf16 v[136:139], v[220:223], v[92:95], v[136:139]
v_mfma_f32_16x16x32_bf16 v[140:143], v[216:219], v[120:123], v[140:143]
ds_read_b128 v[216:219], v230 offset:18432
v_mfma_f32_16x16x32_bf16 v[140:143], v[220:223], v[124:127], v[140:143]
ds_read_b128 v[220:223], v230 offset:18944
s_waitcnt lgkmcnt(2)
v_mfma_f32_16x16x32_bf16 v[144:147], v[208:211], v[0:3], 0
v_mfma_f32_16x16x32_bf16 v[144:147], v[212:215], v[4:7], v[144:147]
v_mfma_f32_16x16x32_bf16 v[148:151], v[208:211], v[32:35], 0
v_mfma_f32_16x16x32_bf16 v[148:151], v[212:215], v[36:39], v[148:151]
v_mfma_f32_16x16x32_bf16 v[152:155], v[208:211], v[64:67], 0
v_exp_f32 v232, v128
v_mfma_f32_16x16x32_bf16 v[152:155], v[212:215], v[68:71], v[152:155]
v_exp_f32 v233, v129
v_mfma_f32_16x16x32_bf16 v[156:159], v[208:211], v[96:99], 0
ds_read_b128 v[208:211], v230 offset:22528
v_exp_f32 v234, v130
v_mfma_f32_16x16x32_bf16 v[156:159], v[212:215], v[100:103], v[156:159]
ds_read_b128 v[212:215], v230 offset:23040
s_waitcnt lgkmcnt(2)
v_cvt_pk_bf16_f32 v0, v232, v233
v_mfma_f32_16x16x32_bf16 v[144:147], v[216:219], v[8:11], v[144:147]
v_exp_f32 v235, v131
v_mfma_f32_16x16x32_bf16 v[144:147], v[220:223], v[12:15], v[144:147]
ds_read_b128 v[4:7], v231 offset:0
v_exp_f32 v236, v132
v_mfma_f32_16x16x32_bf16 v[148:151], v[216:219], v[40:43], v[148:151]
ds_read_b128 v[36:39], v231 offset:1024
v_cvt_pk_bf16_f32 v1, v234, v235
v_mfma_f32_16x16x32_bf16 v[148:151], v[220:223], v[44:47], v[148:151]
v_exp_f32 v237, v133
v_mfma_f32_16x16x32_bf16 v[152:155], v[216:219], v[72:75], v[152:155]
v_exp_f32 v238, v134
v_cvt_pk_bf16_f32 v32, v236, v237
v_mfma_f32_16x16x32_bf16 v[152:155], v[220:223], v[76:79], v[152:155]
ds_read_b128 v[68:71], v231 offset:2048
ds_read_b128 v[8:11], v231 offset:4096
v_mfma_f32_16x16x32_bf16 v[156:159], v[216:219], v[104:107], v[156:159]
ds_read_b128 v[216:219], v230 offset:26624
v_add_u32 v12, 0x8000, v244
v_and_b32 v12, 0x1ffff, v12
ds_read_b128 v[100:103], v231 offset:3072
ds_read_b128 v[40:43], v231 offset:5120
v_mfma_f32_16x16x32_bf16 v[156:159], v[220:223], v[108:111], v[156:159]
ds_read_b128 v[220:223], v230 offset:27136
s_waitcnt lgkmcnt(2)
v_add_u32 v14, 0x10000, v244
v_and_b32 v14, 0x1ffff, v14
v_mfma_f32_16x16x32_bf16 v[144:147], v[208:211], v[16:19], v[144:147]
v_xor_b32 v13, 32, v12
v_xor_b32 v15, 32, v14
v_mfma_f32_16x16x32_bf16 v[144:147], v[212:215], v[20:23], v[144:147]
ds_read_b128 v[72:75], v231 offset:6144
v_exp_f32 v239, v135
v_mfma_f32_16x16x32_bf16 v[148:151], v[208:211], v[48:51], v[148:151]
ds_read_b128 v[104:107], v231 offset:7168
v_exp_f32 v232, v136
v_mfma_f32_16x16x32_bf16 v[148:151], v[212:215], v[52:55], v[148:151]
v_cvt_pk_bf16_f32 v33, v238, v239
v_exp_f32 v233, v137
v_mfma_f32_16x16x32_bf16 v[152:155], v[208:211], v[80:83], v[152:155]
v_exp_f32 v234, v138
v_cvt_pk_bf16_f32 v64, v232, v233
v_mfma_f32_16x16x32_bf16 v[152:155], v[212:215], v[84:87], v[152:155]
v_exp_f32 v235, v139
v_mfma_f32_16x16x32_bf16 v[156:159], v[208:211], v[112:115], v[156:159]
ds_read_b64_tr_b16 v[208:209], v12 offset:12800
ds_read_b64_tr_b16 v[210:211], v12 offset:14848
v_mfma_f32_16x16x32_bf16 v[156:159], v[212:215], v[116:119], v[156:159]
ds_read_b64_tr_b16 v[212:213], v12 offset:29184
s_waitcnt lgkmcnt(3)
v_mfma_f32_16x16x32_bf16 v[144:147], v[216:219], v[24:27], v[144:147]
ds_read_b64_tr_b16 v[214:215], v12 offset:31232
v_exp_f32 v236, v140
v_mfma_f32_16x16x32_bf16 v[144:147], v[220:223], v[28:31], v[144:147]
v_cvt_pk_bf16_f32 v65, v234, v235
v_exp_f32 v237, v141
v_mfma_f32_16x16x32_bf16 v[148:151], v[216:219], v[56:59], v[148:151]
v_exp_f32 v238, v142
v_cvt_pk_bf16_f32 v96, v236, v237
v_mfma_f32_16x16x32_bf16 v[148:151], v[220:223], v[60:63], v[148:151]
v_exp_f32 v239, v143
v_or3_b32 v242, v0, v1, v32
v_mfma_f32_16x16x32_bf16 v[152:155], v[216:219], v[88:91], v[152:155]
v_cvt_pk_bf16_f32 v97, v238, v239
v_or3_b32 v242, v242, v33, v64
v_or3_b32 v242, v242, v65, v96
v_mfma_f32_16x16x32_bf16 v[152:155], v[220:223], v[92:95], v[152:155]
v_or_b32 v242, v242, v97
v_lshl_or_b32 v242, v242, 16, v242
v_cmp_le_u32 vcc, 2.0, v242
s_cbranch_vccnz L2_rare_site10
L2_ret10:
v_mfma_f32_16x16x32_bf16 v[156:159], v[216:219], v[120:123], v[156:159]
ds_read_b64_tr_b16 v[216:217], v14 offset:12800
ds_read_b64_tr_b16 v[218:219], v14 offset:14848
s_waitcnt vmcnt(0)
v_mfma_f32_16x16x32_bf16 v[156:159], v[220:223], v[124:127], v[156:159]
ds_read_b64_tr_b16 v[220:221], v13 offset:12800
s_waitcnt lgkmcnt(3)
v_cmp_ne_u64_e64 s[38:39], s[98:99], v[240:241]
v_mfma_f32_16x16x32_bf16 a[224:227], v[8:11], v[208:211], a[224:227]
ds_read_b64_tr_b16 v[222:223], v13 offset:14848
s_and_b64 s[38:39], s[38:39], s[96:97]
s_cbranch_scc1 LF_hl_1
LF_hlret_1:
v_mfma_f32_16x16x32_bf16 a[224:227], v[176:179], v[212:215], a[224:227]
v_exp_f32 v232, v144
v_lshrrev_b32 v241, 4, v243
v_mfma_f32_16x16x32_bf16 a[228:231], v[40:43], v[208:211], a[228:231]
v_exp_f32 v233, v145
v_and_b32 v241, 0x30, v241
v_mfma_f32_16x16x32_bf16 a[228:231], v[180:183], v[212:215], a[228:231]
v_exp_f32 v234, v146
v_xor_b32 v241, v241, v243
v_mfma_f32_16x16x32_bf16 a[232:235], v[72:75], v[208:211], a[232:235]
v_cvt_pk_bf16_f32 v2, v232, v233
v_and_b32 v228, 0x380, v243
v_mad_u32_u24 v241, v228, 3, v241
v_mfma_f32_16x16x32_bf16 a[232:235], v[184:187], v[212:215], a[232:235]
v_exp_f32 v235, v147
v_add_u32 v241, 0x7000000, v241
v_mfma_f32_16x16x32_bf16 a[236:239], v[104:107], v[208:211], a[236:239]
ds_read_b64_tr_b16 v[208:209], v13 offset:29184
ds_read_b64_tr_b16 v[210:211], v13 offset:31232
v_and_b32 v110, 0x70, v243
v_mfma_f32_16x16x32_bf16 a[236:239], v[188:191], v[212:215], a[236:239]
ds_read_b64_tr_b16 v[212:213], v15 offset:12800
s_waitcnt lgkmcnt(5)
v_lshlrev_b32 v110, 3, v110
v_mfma_f32_16x16x32_bf16 a[224:227], v[160:163], v[216:219], a[224:227]
ds_read_b64_tr_b16 v[214:215], v15 offset:14848
v_add_u32 v110, 0x7c32000, v110
buffer_load_dwordx2 v[108:109], v110, s[16:19], 0 offen sc1
v_mfma_f32_16x16x32_bf16 a[228:231], v[164:167], v[216:219], a[228:231]
v_exp_f32 v236, v148
v_mfma_f32_16x16x32_bf16 a[232:235], v[168:171], v[216:219], a[232:235]
v_cvt_pk_bf16_f32 v3, v234, v235
s_add_u32 m0, s28, 0
v_mfma_f32_16x16x32_bf16 a[236:239], v[172:175], v[216:219], a[236:239]
ds_read_b64_tr_b16 v[216:217], v244 offset:16384
s_waitcnt lgkmcnt(5)
v_mfma_f32_16x16x32_bf16 a[240:243], v[8:11], v[220:223], a[240:243]
ds_read_b64_tr_b16 v[218:219], v244 offset:18432
buffer_load_dwordx4 v241, s[16:19], s6 offen sc1 lds
s_add_u32 m0, s28, 8192
v_mfma_f32_16x16x32_bf16 a[244:247], v[40:43], v[220:223], a[244:247]
v_exp_f32 v237, v149
v_mfma_f32_16x16x32_bf16 a[248:251], v[72:75], v[220:223], a[248:251]
v_exp_f32 v238, v150
v_mfma_f32_16x16x32_bf16 a[252:255], v[104:107], v[220:223], a[252:255]
ds_read_b64_tr_b16 v[220:221], v12 offset:0
s_waitcnt lgkmcnt(3)
v_mfma_f32_16x16x32_bf16 a[240:243], v[176:179], v[208:211], a[240:243]
ds_read_b64_tr_b16 v[222:223], v12 offset:2048
v_cvt_pk_bf16_f32 v34, v236, v237
v_mfma_f32_16x16x32_bf16 a[240:243], v[160:163], v[212:215], a[240:243]
v_exp_f32 v239, v151
v_mfma_f32_16x16x32_bf16 a[244:247], v[180:183], v[208:211], a[244:247]
v_exp_f32 v232, v152
v_mfma_f32_16x16x32_bf16 a[244:247], v[164:167], v[212:215], a[244:247]
v_cvt_pk_bf16_f32 v35, v238, v239
buffer_load_dwordx4 v241, s[16:19], s7 offen sc1 lds
s_add_u32 m0, s30, 0
v_mfma_f32_16x16x32_bf16 a[248:251], v[184:187], v[208:211], a[248:251]
v_exp_f32 v233, v153
v_mfma_f32_16x16x32_bf16 a[248:251], v[168:171], v[212:215], a[248:251]
v_exp_f32 v234, v154
v_mfma_f32_16x16x32_bf16 a[252:255], v[188:191], v[208:211], a[252:255]
ds_read_b64_tr_b16 v[208:209], v12 offset:16384
ds_read_b64_tr_b16 v[210:211], v12 offset:18432
v_mfma_f32_16x16x32_bf16 a[252:255], v[172:175], v[212:215], a[252:255]
ds_read_b64_tr_b16 v[212:213], v14 offset:0
s_waitcnt lgkmcnt(3)
v_mfma_f32_16x16x32_bf16 a[0:3], v[4:7], v[216:219], a[0:3]
ds_read_b64_tr_b16 v[214:215], v14 offset:2048
v_cvt_pk_bf16_f32 v66, v232, v233
v_mfma_f32_16x16x32_bf16 a[0:3], v[8:11], v[220:223], a[0:3]
v_exp_f32 v235, v155
v_mfma_f32_16x16x32_bf16 a[4:7], v[36:39], v[216:219], a[4:7]
v_exp_f32 v236, v156
v_mfma_f32_16x16x32_bf16 a[4:7], v[40:43], v[220:223], a[4:7]
v_cvt_pk_bf16_f32 v67, v234, v235
buffer_load_dwordx4 v241, s[16:19], s29 offen sc1 lds
s_add_u32 m0, s28, 4096
v_mfma_f32_16x16x32_bf16 a[8:11], v[68:71], v[216:219], a[8:11]
v_exp_f32 v237, v157
v_xor_b32 v241, 0x1040, v241
v_mfma_f32_16x16x32_bf16 a[8:11], v[72:75], v[220:223], a[8:11]
v_exp_f32 v238, v158
v_mfma_f32_16x16x32_bf16 a[12:15], v[100:103], v[216:219], a[12:15]
ds_read_b64_tr_b16 v[216:217], v245 offset:16384
ds_read_b64_tr_b16 v[218:219], v245 offset:18432
v_mfma_f32_16x16x32_bf16 a[12:15], v[104:107], v[220:223], a[12:15]
ds_read_b64_tr_b16 v[220:221], v13 offset:0
s_waitcnt lgkmcnt(3)
v_mfma_f32_16x16x32_bf16 a[0:3], v[176:179], v[208:211], a[0:3]
ds_read_b64_tr_b16 v[222:223], v13 offset:2048
v_cvt_pk_bf16_f32 v98, v236, v237
v_mfma_f32_16x16x32_bf16 a[0:3], v[160:163], v[212:215], a[0:3]
v_exp_f32 v239, v159
v_mfma_f32_16x16x32_bf16 a[4:7], v[180:183], v[208:211], a[4:7]
v_or3_b32 v242, v2, v3, v34
v_cvt_pk_bf16_f32 v99, v238, v239
v_mfma_f32_16x16x32_bf16 a[4:7], v[164:167], v[212:215], a[4:7]
v_or3_b32 v242, v242, v35, v66
v_or3_b32 v242, v242, v67, v98
v_mfma_f32_16x16x32_bf16 a[8:11], v[184:187], v[208:211], a[8:11]
v_or_b32 v242, v242, v99
v_lshl_or_b32 v242, v242, 16, v242
v_mfma_f32_16x16x32_bf16 a[8:11], v[168:171], v[212:215], a[8:11]
v_cmp_le_u32 vcc, 2.0, v242
s_cbranch_vccnz L2_rare_site11
L2_ret11:
v_mfma_f32_16x16x32_bf16 a[12:15], v[188:191], v[208:211], a[12:15]
ds_read_b64_tr_b16 v[208:209], v13 offset:16384
ds_read_b64_tr_b16 v[210:211], v13 offset:18432
v_mfma_f32_16x16x32_bf16 a[12:15], v[172:175], v[212:215], a[12:15]
ds_read_b64_tr_b16 v[212:213], v15 offset:0
s_waitcnt lgkmcnt(3)
v_mfma_f32_16x16x32_bf16 a[16:19], v[4:7], v[216:219], a[16:19]
ds_read_b64_tr_b16 v[214:215], v15 offset:2048
buffer_load_dwordx4 v241, s[16:19], s6 offen sc1 lds
s_add_u32 m0, s28, 12288
v_mfma_f32_16x16x32_bf16 a[16:19], v[8:11], v[220:223], a[16:19]
buffer_load_dwordx4 v241, s[16:19], s7 offen sc1 lds
s_add_u32 m0, s30, 4096
v_mfma_f32_16x16x32_bf16 a[20:23], v[36:39], v[216:219], a[20:23]
buffer_load_dwordx4 v241, s[16:19], s29 offen sc1 lds
v_mfma_f32_16x16x32_bf16 a[20:23], v[40:43], v[220:223], a[20:23]
v_mfma_f32_16x16x32_bf16 a[24:27], v[68:71], v[216:219], a[24:27]
v_mfma_f32_16x16x32_bf16 a[24:27], v[72:75], v[220:223], a[24:27]
v_mfma_f32_16x16x32_bf16 a[28:31], v[100:103], v[216:219], a[28:31]
ds_read_b64_tr_b16 v[216:217], v14 offset:29184
ds_read_b64_tr_b16 v[218:219], v14 offset:31232
v_mfma_f32_16x16x32_bf16 a[28:31], v[104:107], v[220:223], a[28:31]
ds_read_b64_tr_b16 v[220:221], v15 offset:29184
s_waitcnt lgkmcnt(3)
v_mfma_f32_16x16x32_bf16 a[16:19], v[176:179], v[208:211], a[16:19]
ds_read_b64_tr_b16 v[222:223], v15 offset:31232
v_mfma_f32_16x16x32_bf16 a[16:19], v[160:163], v[212:215], a[16:19]
v_mfma_f32_16x16x32_bf16 a[20:23], v[180:183], v[208:211], a[20:23]
v_mfma_f32_16x16x32_bf16 a[20:23], v[164:167], v[212:215], a[20:23]
v_mfma_f32_16x16x32_bf16 a[24:27], v[184:187], v[208:211], a[24:27]
v_mfma_f32_16x16x32_bf16 a[24:27], v[168:171], v[212:215], a[24:27]
v_mfma_f32_16x16x32_bf16 a[28:31], v[188:191], v[208:211], a[28:31]
ds_read_b64_tr_b16 v[208:209], v14 offset:16384
ds_read_b64_tr_b16 v[210:211], v14 offset:18432
v_mfma_f32_16x16x32_bf16 a[28:31], v[172:175], v[212:215], a[28:31]
ds_read_b64_tr_b16 v[212:213], v15 offset:16384
s_waitcnt lgkmcnt(5)
v_mfma_f32_16x16x32_bf16 a[224:227], v[0:3], v[216:219], a[224:227]
ds_read_b64_tr_b16 v[214:215], v15 offset:18432
v_lshrrev_b32 v228, 4, v243
v_and_b32 v228, 0x3c, v228
v_mfma_f32_16x16x32_bf16 a[228:231], v[32:35], v[216:219], a[228:231]
v_sub_f32 v224, 0, v224
v_sub_f32 v225, 0, v225
v_sub_f32 v226, 0, v226
v_mfma_f32_16x16x32_bf16 a[232:235], v[64:67], v[216:219], a[232:235]
v_sub_f32 v227, 0, v227
ds_bpermute_b32 v232, v228, v224
ds_bpermute_b32 v234, v228, v225
v_mfma_f32_16x16x32_bf16 a[236:239], v[96:99], v[216:219], a[236:239]
ds_read_b64_tr_b16 v[216:217], v244 offset:16896
s_waitcnt lgkmcnt(5)
ds_bpermute_b32 v236, v228, v226
v_mfma_f32_16x16x32_bf16 a[240:243], v[0:3], v[220:223], a[240:243]
ds_read_b64_tr_b16 v[218:219], v244 offset:18944
ds_bpermute_b32 v238, v228, v227
v_bfe_u32 v228, v243, 4, 1
v_mfma_f32_16x16x32_bf16 a[244:247], v[32:35], v[220:223], a[244:247]
v_mul_u32_u24 v228, 768, v228
v_lshl_add_u32 v228, s37, 7, v228
v_lshrrev_b32 v242, 6, v243
v_mfma_f32_16x16x32_bf16 a[248:251], v[64:67], v[220:223], a[248:251]
v_lshl_add_u32 v242, v242, 3, v228
v_accvgpr_read_b32 v128, a224
v_accvgpr_read_b32 v129, a225
v_mfma_f32_16x16x32_bf16 a[252:255], v[96:99], v[220:223], a[252:255]
ds_read_b64_tr_b16 v[220:221], v12 offset:512
s_waitcnt lgkmcnt(5)
v_accvgpr_read_b32 v130, a226
v_mfma_f32_16x16x32_bf16 a[0:3], v[0:3], v[208:211], a[0:3]
ds_read_b64_tr_b16 v[222:223], v12 offset:2560
v_accvgpr_read_b32 v131, a227
v_cvt_pk_bf16_f32 v28, v128, v129
v_mfma_f32_16x16x32_bf16 a[4:7], v[32:35], v[208:211], a[4:7]
v_cvt_pk_bf16_f32 v29, v130, v131
v_accvgpr_read_b32 v136, a228
v_accvgpr_read_b32 v137, a229
v_mfma_f32_16x16x32_bf16 a[8:11], v[64:67], v[208:211], a[8:11]
v_accvgpr_read_b32 v138, a230
v_accvgpr_read_b32 v139, a231
v_cvt_pk_bf16_f32 v60, v136, v137
v_mfma_f32_16x16x32_bf16 a[12:15], v[96:99], v[208:211], a[12:15]
ds_read_b64_tr_b16 v[208:209], v12 offset:16896
s_waitcnt lgkmcnt(5)
v_cvt_pk_bf16_f32 v61, v138, v139
v_mfma_f32_16x16x32_bf16 a[16:19], v[0:3], v[212:215], a[16:19]
ds_read_b64_tr_b16 v[210:211], v12 offset:18944
v_accvgpr_read_b32 v144, a232
v_accvgpr_read_b32 v145, a233
v_mfma_f32_16x16x32_bf16 a[20:23], v[32:35], v[212:215], a[20:23]
v_accvgpr_read_b32 v146, a234
v_accvgpr_read_b32 v147, a235
v_cvt_pk_bf16_f32 v92, v144, v145
v_mfma_f32_16x16x32_bf16 a[24:27], v[64:67], v[212:215], a[24:27]
v_cvt_pk_bf16_f32 v93, v146, v147
v_accvgpr_read_b32 v152, a236
v_accvgpr_read_b32 v153, a237
v_mfma_f32_16x16x32_bf16 a[28:31], v[96:99], v[212:215], a[28:31]
ds_read_b64_tr_b16 v[212:213], v14 offset:512
s_waitcnt lgkmcnt(3)
v_accvgpr_read_b32 v154, a238
v_mfma_f32_16x16x32_bf16 a[32:35], v[4:7], v[216:219], a[32:35]
ds_read_b64_tr_b16 v[214:215], v14 offset:2560
v_accvgpr_read_b32 v155, a239
v_cvt_pk_bf16_f32 v124, v152, v153
v_mfma_f32_16x16x32_bf16 a[32:35], v[8:11], v[220:223], a[32:35]
v_cvt_pk_bf16_f32 v125, v154, v155
v_accvgpr_read_b32 v132, a240
v_accvgpr_read_b32 v133, a241
v_mfma_f32_16x16x32_bf16 a[36:39], v[36:39], v[216:219], a[36:39]
v_accvgpr_read_b32 v134, a242
v_accvgpr_read_b32 v135, a243
v_cvt_pk_bf16_f32 v30, v132, v133
v_mfma_f32_16x16x32_bf16 a[36:39], v[40:43], v[220:223], a[36:39]
v_cvt_pk_bf16_f32 v31, v134, v135
buffer_store_dwordx4 v[28:31], v243, s[20:23], s44 offen offset:3072 sc1
ds_write_b128 v231, v[28:31] offset:7168
v_mfma_f32_16x16x32_bf16 a[40:43], v[68:71], v[216:219], a[40:43]
v_accvgpr_read_b32 v140, a244
v_accvgpr_read_b32 v141, a245
v_accvgpr_read_b32 v142, a246
v_mfma_f32_16x16x32_bf16 a[40:43], v[72:75], v[220:223], a[40:43]
v_accvgpr_read_b32 v143, a247
v_cvt_pk_bf16_f32 v62, v140, v141
v_cvt_pk_bf16_f32 v63, v142, v143
v_mfma_f32_16x16x32_bf16 a[44:47], v[100:103], v[216:219], a[44:47]
ds_read_b64_tr_b16 v[216:217], v14 offset:16896
ds_read_b64_tr_b16 v[218:219], v14 offset:18944
buffer_store_dwordx4 v[60:63], v243, s[20:23], s45 offen offset:3072 sc1
v_mfma_f32_16x16x32_bf16 a[44:47], v[104:107], v[220:223], a[44:47]
ds_read_b64_tr_b16 v[220:221], v245 offset:16896
s_waitcnt lgkmcnt(3)
v_accvgpr_read_b32 v148, a248
v_mfma_f32_16x16x32_bf16 a[32:35], v[176:179], v[208:211], a[32:35]
ds_read_b64_tr_b16 v[222:223], v245 offset:18944
v_accvgpr_read_b32 v149, a249
v_accvgpr_read_b32 v150, a250
v_mfma_f32_16x16x32_bf16 a[32:35], v[160:163], v[212:215], a[32:35]
v_accvgpr_read_b32 v151, a251
v_cvt_pk_bf16_f32 v94, v148, v149
v_cvt_pk_bf16_f32 v95, v150, v151
v_mfma_f32_16x16x32_bf16 a[36:39], v[180:183], v[208:211], a[36:39]
buffer_store_dwordx4 v[92:95], v243, s[20:23], s46 offen offset:3072 sc1
v_accvgpr_read_b32 v156, a252
v_accvgpr_read_b32 v157, a253
v_mfma_f32_16x16x32_bf16 a[36:39], v[164:167], v[212:215], a[36:39]
v_accvgpr_read_b32 v158, a254
v_accvgpr_read_b32 v159, a255
v_cvt_pk_bf16_f32 v126, v156, v157
v_mfma_f32_16x16x32_bf16 a[40:43], v[184:187], v[208:211], a[40:43]
v_cvt_pk_bf16_f32 v127, v158, v159
buffer_store_dwordx4 v[124:127], v243, s[20:23], s47 offen offset:3072 sc1
v_mov_b32_dpp v233, v132 row_newbcast:15 row_mask:0xf bank_mask:0x1
v_mfma_f32_16x16x32_bf16 a[40:43], v[168:171], v[212:215], a[40:43]
v_mov_b32_dpp v235, v140 row_newbcast:15 row_mask:0xf bank_mask:0x1
v_mov_b32_dpp v237, v148 row_newbcast:15 row_mask:0xf bank_mask:0x1
v_mov_b32_dpp v239, v156 row_newbcast:15 row_mask:0xf bank_mask:0x1
v_mfma_f32_16x16x32_bf16 a[44:47], v[188:191], v[208:211], a[44:47]
ds_read_b64_tr_b16 v[208:209], v13 offset:512
ds_read_b64_tr_b16 v[210:211], v13 offset:2560
v_mov_b32_dpp v233, v133 row_newbcast:15 row_mask:0xf bank_mask:0x2
v_mfma_f32_16x16x32_bf16 a[44:47], v[172:175], v[212:215], a[44:47]
ds_read_b64_tr_b16 v[212:213], v13 offset:16896
s_waitcnt lgkmcnt(5)
v_mov_b32_dpp v235, v141 row_newbcast:15 row_mask:0xf bank_mask:0x2
v_mfma_f32_16x16x32_bf16 a[32:35], v[0:3], v[216:219], a[32:35]
ds_read_b64_tr_b16 v[214:215], v13 offset:18944
v_mov_b32_dpp v237, v149 row_newbcast:15 row_mask:0xf bank_mask:0x2
v_mov_b32_dpp v239, v157 row_newbcast:15 row_mask:0xf bank_mask:0x2
v_mfma_f32_16x16x32_bf16 a[36:39], v[32:35], v[216:219], a[36:39]
v_mov_b32_dpp v233, v134 row_newbcast:15 row_mask:0xf bank_mask:0x4
v_mov_b32_dpp v235, v142 row_newbcast:15 row_mask:0xf bank_mask:0x4
v_mov_b32_dpp v237, v150 row_newbcast:15 row_mask:0xf bank_mask:0x4
v_mfma_f32_16x16x32_bf16 a[40:43], v[64:67], v[216:219], a[40:43]
v_mov_b32_dpp v239, v158 row_newbcast:15 row_mask:0xf bank_mask:0x4
v_mov_b32_dpp v233, v135 row_newbcast:15 row_mask:0xf bank_mask:0x8
v_mov_b32_dpp v235, v143 row_newbcast:15 row_mask:0xf bank_mask:0x8
v_mfma_f32_16x16x32_bf16 a[44:47], v[96:99], v[216:219], a[44:47]
ds_read_b64_tr_b16 v[216:217], v15 offset:512
s_waitcnt lgkmcnt(5)
v_mov_b32_dpp v237, v151 row_newbcast:15 row_mask:0xf bank_mask:0x8
v_mfma_f32_16x16x32_bf16 a[48:51], v[4:7], v[220:223], a[48:51]
ds_read_b64_tr_b16 v[218:219], v15 offset:2560
v_mov_b32_dpp v239, v159 row_newbcast:15 row_mask:0xf bank_mask:0x8
v_mfma_f32_16x16x32_bf16 a[52:55], v[36:39], v[220:223], a[52:55]
s_mov_b32 exec_lo, 0x33333333
s_mov_b32 exec_hi, 0x33333333
buffer_store_dwordx2 v[232:233], v242, s[24:27], s48 offen sc1
s_lshr_b32 s3, s41, 2
buffer_store_dwordx2 v[234:235], v242, s[24:27], s3 offen sc1
s_lshr_b32 s3, s42, 2
buffer_store_dwordx2 v[236:237], v242, s[24:27], s3 offen sc1
s_lshr_b32 s3, s43, 2
buffer_store_dwordx2 v[238:239], v242, s[24:27], s3 offen sc1
s_mov_b64 exec, -1
v_mfma_f32_16x16x32_bf16 a[56:59], v[68:71], v[220:223], a[56:59]
v_accvgpr_read_b32 v128, a0
v_accvgpr_read_b32 v129, a1
v_accvgpr_read_b32 v130, a2
v_mfma_f32_16x16x32_bf16 a[60:63], v[100:103], v[220:223], a[60:63]
ds_read_b64_tr_b16 v[220:221], v15 offset:16896
s_waitcnt lgkmcnt(3)
v_accvgpr_read_b32 v131, a3
v_mfma_f32_16x16x32_bf16 a[48:51], v[8:11], v[208:211], a[48:51]
ds_read_b64_tr_b16 v[222:223], v15 offset:18944
v_cvt_pk_bf16_f32 v16, v128, v129
v_cvt_pk_bf16_f32 v17, v130, v131
v_mfma_f32_16x16x32_bf16 a[48:51], v[176:179], v[212:215], a[48:51]
v_accvgpr_read_b32 v136, a4
v_accvgpr_read_b32 v137, a5
v_accvgpr_read_b32 v138, a6
v_mfma_f32_16x16x32_bf16 a[52:55], v[40:43], v[208:211], a[52:55]
v_accvgpr_read_b32 v139, a7
v_cvt_pk_bf16_f32 v48, v136, v137
v_cvt_pk_bf16_f32 v49, v138, v139
v_mfma_f32_16x16x32_bf16 a[52:55], v[180:183], v[212:215], a[52:55]
v_accvgpr_read_b32 v144, a8
v_accvgpr_read_b32 v145, a9
v_accvgpr_read_b32 v146, a10
v_mfma_f32_16x16x32_bf16 a[56:59], v[72:75], v[208:211], a[56:59]
v_accvgpr_read_b32 v147, a11
v_cvt_pk_bf16_f32 v80, v144, v145
v_cvt_pk_bf16_f32 v81, v146, v147
v_mfma_f32_16x16x32_bf16 a[56:59], v[184:187], v[212:215], a[56:59]
v_accvgpr_read_b32 v152, a12
v_accvgpr_read_b32 v153, a13
v_accvgpr_read_b32 v154, a14
v_mfma_f32_16x16x32_bf16 a[60:63], v[104:107], v[208:211], a[60:63]
ds_read_b64_tr_b16 v[208:209], v244 offset:20480
ds_read_b64_tr_b16 v[210:211], v244 offset:22528
v_accvgpr_read_b32 v155, a15
v_mfma_f32_16x16x32_bf16 a[60:63], v[188:191], v[212:215], a[60:63]
ds_read_b64_tr_b16 v[212:213], v12 offset:4096
s_waitcnt lgkmcnt(3)
v_cvt_pk_bf16_f32 v112, v152, v153
v_mfma_f32_16x16x32_bf16 a[48:51], v[160:163], v[216:219], a[48:51]
ds_read_b64_tr_b16 v[214:215], v12 offset:6144
v_cvt_pk_bf16_f32 v113, v154, v155
v_accvgpr_read_b32 v132, a16
v_mfma_f32_16x16x32_bf16 a[48:51], v[0:3], v[220:223], a[48:51]
v_accvgpr_read_b32 v133, a17
v_accvgpr_read_b32 v134, a18
v_accvgpr_read_b32 v135, a19
v_mfma_f32_16x16x32_bf16 a[52:55], v[164:167], v[216:219], a[52:55]
v_cvt_pk_bf16_f32 v18, v132, v133
v_cvt_pk_bf16_f32 v19, v134, v135
buffer_store_dwordx4 v[16:19], v243, s[20:23], s40 offen offset:0 sc1
v_mfma_f32_16x16x32_bf16 a[52:55], v[32:35], v[220:223], a[52:55]
ds_write_b128 v231, v[16:19] offset:0
v_accvgpr_read_b32 v140, a20
v_accvgpr_read_b32 v141, a21
v_mfma_f32_16x16x32_bf16 a[56:59], v[168:171], v[216:219], a[56:59]
v_accvgpr_read_b32 v142, a22
v_accvgpr_read_b32 v143, a23
v_cvt_pk_bf16_f32 v50, v140, v141
v_mfma_f32_16x16x32_bf16 a[56:59], v[64:67], v[220:223], a[56:59]
v_cvt_pk_bf16_f32 v51, v142, v143
buffer_store_dwordx4 v[48:51], v243, s[20:23], s41 offen offset:0 sc1
v_accvgpr_read_b32 v148, a24
v_mfma_f32_16x16x32_bf16 a[60:63], v[172:175], v[216:219], a[60:63]
ds_read_b64_tr_b16 v[216:217], v12 offset:20480
ds_read_b64_tr_b16 v[218:219], v12 offset:22528
v_accvgpr_read_b32 v149, a25
v_mfma_f32_16x16x32_bf16 a[60:63], v[96:99], v[220:223], a[60:63]
ds_read_b64_tr_b16 v[220:221], v14 offset:4096
s_waitcnt lgkmcnt(3)
v_accvgpr_read_b32 v150, a26
v_mfma_f32_16x16x32_bf16 a[64:67], v[4:7], v[208:211], a[64:67]
ds_read_b64_tr_b16 v[222:223], v14 offset:6144
v_accvgpr_read_b32 v151, a27
v_cvt_pk_bf16_f32 v82, v148, v149
v_mfma_f32_16x16x32_bf16 a[64:67], v[8:11], v[212:215], a[64:67]
v_cvt_pk_bf16_f32 v83, v150, v151
buffer_store_dwordx4 v[80:83], v243, s[20:23], s42 offen offset:0 sc1
v_accvgpr_read_b32 v156, a28
v_mfma_f32_16x16x32_bf16 a[68:71], v[36:39], v[208:211], a[68:71]
v_accvgpr_read_b32 v157, a29
v_accvgpr_read_b32 v158, a30
v_accvgpr_read_b32 v159, a31
v_mfma_f32_16x16x32_bf16 a[68:71], v[40:43], v[212:215], a[68:71]
v_cvt_pk_bf16_f32 v114, v156, v157
v_cvt_pk_bf16_f32 v115, v158, v159
buffer_store_dwordx4 v[112:115], v243, s[20:23], s43 offen offset:0 sc1
v_mfma_f32_16x16x32_bf16 a[72:75], v[68:71], v[208:211], a[72:75]
v_accvgpr_read_b32 v128, a32
v_accvgpr_read_b32 v129, a33
v_accvgpr_read_b32 v130, a34
v_mfma_f32_16x16x32_bf16 a[72:75], v[72:75], v[212:215], a[72:75]
v_accvgpr_read_b32 v131, a35
v_cvt_pk_bf16_f32 v20, v128, v129
v_cvt_pk_bf16_f32 v21, v130, v131
v_mfma_f32_16x16x32_bf16 a[76:79], v[100:103], v[208:211], a[76:79]
ds_read_b64_tr_b16 v[208:209], v14 offset:20480
ds_read_b64_tr_b16 v[210:211], v14 offset:22528
v_accvgpr_read_b32 v136, a36
v_mfma_f32_16x16x32_bf16 a[76:79], v[104:107], v[212:215], a[76:79]
ds_read_b64_tr_b16 v[212:213], v245 offset:20480
s_waitcnt lgkmcnt(3)
v_accvgpr_read_b32 v137, a37
v_mfma_f32_16x16x32_bf16 a[64:67], v[176:179], v[216:219], a[64:67]
ds_read_b64_tr_b16 v[214:215], v245 offset:22528
v_accvgpr_read_b32 v138, a38
v_accvgpr_read_b32 v139, a39
v_mfma_f32_16x16x32_bf16 a[64:67], v[160:163], v[220:223], a[64:67]
v_cvt_pk_bf16_f32 v52, v136, v137
v_cvt_pk_bf16_f32 v53, v138, v139
v_accvgpr_read_b32 v144, a40
v_mfma_f32_16x16x32_bf16 a[68:71], v[180:183], v[216:219], a[68:71]
v_accvgpr_read_b32 v145, a41
v_accvgpr_read_b32 v146, a42
v_accvgpr_read_b32 v147, a43
v_mfma_f32_16x16x32_bf16 a[68:71], v[164:167], v[220:223], a[68:71]
v_cvt_pk_bf16_f32 v84, v144, v145
v_cvt_pk_bf16_f32 v85, v146, v147
v_accvgpr_read_b32 v152, a44
v_mfma_f32_16x16x32_bf16 a[72:75], v[184:187], v[216:219], a[72:75]
v_accvgpr_read_b32 v153, a45
v_accvgpr_read_b32 v154, a46
v_accvgpr_read_b32 v155, a47
v_mfma_f32_16x16x32_bf16 a[72:75], v[168:171], v[220:223], a[72:75]
v_cvt_pk_bf16_f32 v116, v152, v153
v_cvt_pk_bf16_f32 v117, v154, v155
v_accvgpr_read_b32 v132, a48
v_mfma_f32_16x16x32_bf16 a[76:79], v[188:191], v[216:219], a[76:79]
ds_read_b64_tr_b16 v[216:217], v13 offset:4096
ds_read_b64_tr_b16 v[218:219], v13 offset:6144
v_accvgpr_read_b32 v133, a49
v_mfma_f32_16x16x32_bf16 a[76:79], v[172:175], v[220:223], a[76:79]
ds_read_b64_tr_b16 v[220:221], v13 offset:20480
s_waitcnt lgkmcnt(5)
v_accvgpr_read_b32 v134, a50
v_mfma_f32_16x16x32_bf16 a[64:67], v[0:3], v[208:211], a[64:67]
ds_read_b64_tr_b16 v[222:223], v13 offset:22528
v_accvgpr_read_b32 v135, a51
v_cvt_pk_bf16_f32 v22, v132, v133
v_mfma_f32_16x16x32_bf16 a[68:71], v[32:35], v[208:211], a[68:71]
v_cvt_pk_bf16_f32 v23, v134, v135
buffer_store_dwordx4 v[20:23], v243, s[20:23], s40 offen offset:1024 sc1
ds_write_b128 v231, v[20:23] offset:1024
v_mfma_f32_16x16x32_bf16 a[72:75], v[64:67], v[208:211], a[72:75]
v_accvgpr_read_b32 v140, a52
v_accvgpr_read_b32 v141, a53
v_accvgpr_read_b32 v142, a54
v_mfma_f32_16x16x32_bf16 a[76:79], v[96:99], v[208:211], a[76:79]
ds_read_b64_tr_b16 v[208:209], v15 offset:4096
s_waitcnt lgkmcnt(5)
v_accvgpr_read_b32 v143, a55
v_mfma_f32_16x16x32_bf16 a[80:83], v[4:7], v[212:215], a[80:83]
ds_read_b64_tr_b16 v[210:211], v15 offset:6144
v_cvt_pk_bf16_f32 v54, v140, v141
v_cvt_pk_bf16_f32 v55, v142, v143
v_mfma_f32_16x16x32_bf16 a[84:87], v[36:39], v[212:215], a[84:87]
buffer_store_dwordx4 v[52:55], v243, s[20:23], s41 offen offset:1024 sc1
v_accvgpr_read_b32 v148, a56
v_accvgpr_read_b32 v149, a57
v_mfma_f32_16x16x32_bf16 a[88:91], v[68:71], v[212:215], a[88:91]
v_accvgpr_read_b32 v150, a58
v_accvgpr_read_b32 v151, a59
v_cvt_pk_bf16_f32 v86, v148, v149
v_mfma_f32_16x16x32_bf16 a[92:95], v[100:103], v[212:215], a[92:95]
ds_read_b64_tr_b16 v[212:213], v15 offset:20480
s_waitcnt lgkmcnt(3)
v_cvt_pk_bf16_f32 v87, v150, v151
v_mfma_f32_16x16x32_bf16 a[80:83], v[8:11], v[216:219], a[80:83]
ds_read_b64_tr_b16 v[214:215], v15 offset:22528
buffer_store_dwordx4 v[84:87], v243, s[20:23], s42 offen offset:1024 sc1
v_accvgpr_read_b32 v156, a60
v_mfma_f32_16x16x32_bf16 a[80:83], v[176:179], v[220:223], a[80:83]
v_accvgpr_read_b32 v157, a61
v_accvgpr_read_b32 v158, a62
v_accvgpr_read_b32 v159, a63
v_mfma_f32_16x16x32_bf16 a[84:87], v[40:43], v[216:219], a[84:87]
v_cvt_pk_bf16_f32 v118, v156, v157
v_cvt_pk_bf16_f32 v119, v158, v159
buffer_store_dwordx4 v[116:119], v243, s[20:23], s43 offen offset:1024 sc1
v_mfma_f32_16x16x32_bf16 a[84:87], v[180:183], v[220:223], a[84:87]
v_accvgpr_read_b32 v128, a64
v_accvgpr_read_b32 v129, a65
v_mfma_f32_16x16x32_bf16 a[88:91], v[72:75], v[216:219], a[88:91]
v_accvgpr_read_b32 v130, a66
v_accvgpr_read_b32 v131, a67
v_mfma_f32_16x16x32_bf16 a[88:91], v[184:187], v[220:223], a[88:91]
v_cvt_pk_bf16_f32 v24, v128, v129
v_cvt_pk_bf16_f32 v25, v130, v131
v_mfma_f32_16x16x32_bf16 a[92:95], v[104:107], v[216:219], a[92:95]
ds_read_b64_tr_b16 v[216:217], v244 offset:20992
ds_read_b64_tr_b16 v[218:219], v244 offset:23040
v_mfma_f32_16x16x32_bf16 a[92:95], v[188:191], v[220:223], a[92:95]
ds_read_b64_tr_b16 v[220:221], v12 offset:4608
s_waitcnt lgkmcnt(3)
v_mfma_f32_16x16x32_bf16 a[80:83], v[160:163], v[208:211], a[80:83]
ds_read_b64_tr_b16 v[222:223], v12 offset:6656
v_accvgpr_read_b32 v136, a68
v_mfma_f32_16x16x32_bf16 a[80:83], v[0:3], v[212:215], a[80:83]
v_accvgpr_read_b32 v137, a69
v_accvgpr_read_b32 v138, a70
v_mfma_f32_16x16x32_bf16 a[84:87], v[164:167], v[208:211], a[84:87]
v_accvgpr_read_b32 v139, a71
v_cvt_pk_bf16_f32 v56, v136, v137
v_mfma_f32_16x16x32_bf16 a[84:87], v[32:35], v[212:215], a[84:87]
v_cvt_pk_bf16_f32 v57, v138, v139
v_accvgpr_read_b32 v144, a72
v_mfma_f32_16x16x32_bf16 a[88:91], v[168:171], v[208:211], a[88:91]
v_accvgpr_read_b32 v145, a73
v_accvgpr_read_b32 v146, a74
v_mfma_f32_16x16x32_bf16 a[88:91], v[64:67], v[212:215], a[88:91]
v_accvgpr_read_b32 v147, a75
v_cvt_pk_bf16_f32 v88, v144, v145
v_mfma_f32_16x16x32_bf16 a[92:95], v[172:175], v[208:211], a[92:95]
ds_read_b64_tr_b16 v[208:209], v12 offset:20992
ds_read_b64_tr_b16 v[210:211], v12 offset:23040
v_mfma_f32_16x16x32_bf16 a[92:95], v[96:99], v[212:215], a[92:95]
ds_read_b64_tr_b16 v[212:213], v14 offset:4608
s_waitcnt lgkmcnt(3)
v_mfma_f32_16x16x32_bf16 a[96:99], v[4:7], v[216:219], a[96:99]
ds_read_b64_tr_b16 v[214:215], v14 offset:6656
v_cvt_pk_bf16_f32 v89, v146, v147
v_mfma_f32_16x16x32_bf16 a[96:99], v[8:11], v[220:223], a[96:99]
v_accvgpr_read_b32 v152, a76
v_accvgpr_read_b32 v153, a77
v_mfma_f32_16x16x32_bf16 a[100:103], v[36:39], v[216:219], a[100:103]
v_accvgpr_read_b32 v154, a78
v_accvgpr_read_b32 v155, a79
v_mfma_f32_16x16x32_bf16 a[100:103], v[40:43], v[220:223], a[100:103]
v_cvt_pk_bf16_f32 v120, v152, v153
v_cvt_pk_bf16_f32 v121, v154, v155
v_mfma_f32_16x16x32_bf16 a[104:107], v[68:71], v[216:219], a[104:107]
v_accvgpr_read_b32 v132, a80
v_accvgpr_read_b32 v133, a81
v_mfma_f32_16x16x32_bf16 a[104:107], v[72:75], v[220:223], a[104:107]
v_accvgpr_read_b32 v134, a82
v_accvgpr_read_b32 v135, a83
v_mfma_f32_16x16x32_bf16 a[108:111], v[100:103], v[216:219], a[108:111]
ds_read_b64_tr_b16 v[216:217], v14 offset:20992
ds_read_b64_tr_b16 v[218:219], v14 offset:23040
v_mfma_f32_16x16x32_bf16 a[108:111], v[104:107], v[220:223], a[108:111]
ds_read_b64_tr_b16 v[220:221], v245 offset:20992
s_waitcnt lgkmcnt(3)
v_mfma_f32_16x16x32_bf16 a[96:99], v[176:179], v[208:211], a[96:99]
ds_read_b64_tr_b16 v[222:223], v245 offset:23040
v_cvt_pk_bf16_f32 v26, v132, v133
v_mfma_f32_16x16x32_bf16 a[96:99], v[160:163], v[212:215], a[96:99]
v_cvt_pk_bf16_f32 v27, v134, v135
buffer_store_dwordx4 v[24:27], v243, s[20:23], s40 offen offset:2048 sc1
v_mfma_f32_16x16x32_bf16 a[100:103], v[180:183], v[208:211], a[100:103]
ds_write_b128 v231, v[24:27] offset:2048
v_accvgpr_read_b32 v140, a84
v_mfma_f32_16x16x32_bf16 a[100:103], v[164:167], v[212:215], a[100:103]
v_accvgpr_read_b32 v141, a85
v_accvgpr_read_b32 v142, a86
v_mfma_f32_16x16x32_bf16 a[104:107], v[184:187], v[208:211], a[104:107]
v_accvgpr_read_b32 v143, a87
v_cvt_pk_bf16_f32 v58, v140, v141
v_mfma_f32_16x16x32_bf16 a[104:107], v[168:171], v[212:215], a[104:107]
v_cvt_pk_bf16_f32 v59, v142, v143
buffer_store_dwordx4 v[56:59], v243, s[20:23], s41 offen offset:2048 sc1
v_mfma_f32_16x16x32_bf16 a[108:111], v[188:191], v[208:211], a[108:111]
ds_read_b64_tr_b16 v[208:209], v13 offset:4608
ds_read_b64_tr_b16 v[210:211], v13 offset:6656
v_mfma_f32_16x16x32_bf16 a[108:111], v[172:175], v[212:215], a[108:111]
ds_read_b64_tr_b16 v[212:213], v13 offset:20992
s_waitcnt lgkmcnt(5)
v_mfma_f32_16x16x32_bf16 a[96:99], v[0:3], v[216:219], a[96:99]
ds_read_b64_tr_b16 v[214:215], v13 offset:23040
v_accvgpr_read_b32 v148, a88
v_mfma_f32_16x16x32_bf16 a[100:103], v[32:35], v[216:219], a[100:103]
v_accvgpr_read_b32 v149, a89
v_accvgpr_read_b32 v150, a90
v_mfma_f32_16x16x32_bf16 a[104:107], v[64:67], v[216:219], a[104:107]
v_accvgpr_read_b32 v151, a91
v_cvt_pk_bf16_f32 v90, v148, v149
v_mfma_f32_16x16x32_bf16 a[108:111], v[96:99], v[216:219], a[108:111]
ds_read_b64_tr_b16 v[216:217], v15 offset:4608
s_waitcnt lgkmcnt(5)
v_mfma_f32_16x16x32_bf16 a[112:115], v[4:7], v[220:223], a[112:115]
ds_read_b64_tr_b16 v[218:219], v15 offset:6656
v_cvt_pk_bf16_f32 v91, v150, v151
v_mfma_f32_16x16x32_bf16 a[116:119], v[36:39], v[220:223], a[116:119]
buffer_store_dwordx4 v[88:91], v243, s[20:23], s42 offen offset:2048 sc1
v_accvgpr_read_b32 v156, a92
v_mfma_f32_16x16x32_bf16 a[120:123], v[68:71], v[220:223], a[120:123]
v_accvgpr_read_b32 v157, a93
v_accvgpr_read_b32 v158, a94
v_mfma_f32_16x16x32_bf16 a[124:127], v[100:103], v[220:223], a[124:127]
ds_read_b64_tr_b16 v[220:221], v15 offset:20992
s_waitcnt lgkmcnt(3)
v_mfma_f32_16x16x32_bf16 a[112:115], v[8:11], v[208:211], a[112:115]
ds_read_b64_tr_b16 v[222:223], v15 offset:23040
v_accvgpr_read_b32 v159, a95
v_mfma_f32_16x16x32_bf16 a[112:115], v[176:179], v[212:215], a[112:115]
v_cvt_pk_bf16_f32 v122, v156, v157
v_cvt_pk_bf16_f32 v123, v158, v159
v_mfma_f32_16x16x32_bf16 a[116:119], v[40:43], v[208:211], a[116:119]
buffer_store_dwordx4 v[120:123], v243, s[20:23], s43 offen offset:2048 sc1
v_accvgpr_read_b32 v128, a96
v_mfma_f32_16x16x32_bf16 a[116:119], v[180:183], v[212:215], a[116:119]
v_accvgpr_read_b32 v129, a97
v_accvgpr_read_b32 v130, a98
v_mfma_f32_16x16x32_bf16 a[120:123], v[72:75], v[208:211], a[120:123]
v_accvgpr_read_b32 v131, a99
v_cvt_pk_bf16_f32 v28, v128, v129
v_mfma_f32_16x16x32_bf16 a[120:123], v[184:187], v[212:215], a[120:123]
v_cvt_pk_bf16_f32 v29, v130, v131
v_accvgpr_read_b32 v136, a100
v_mfma_f32_16x16x32_bf16 a[124:127], v[104:107], v[208:211], a[124:127]
ds_read_b64_tr_b16 v[208:209], v12 offset:8192
ds_read_b64_tr_b16 v[210:211], v12 offset:10240
v_mfma_f32_16x16x32_bf16 a[124:127], v[188:191], v[212:215], a[124:127]
ds_read_b64_tr_b16 v[212:213], v12 offset:24576
s_waitcnt lgkmcnt(3)
v_mfma_f32_16x16x32_bf16 a[112:115], v[160:163], v[216:219], a[112:115]
ds_read_b64_tr_b16 v[214:215], v12 offset:26624
v_accvgpr_read_b32 v137, a101
v_mfma_f32_16x16x32_bf16 a[112:115], v[0:3], v[220:223], a[112:115]
v_accvgpr_read_b32 v138, a102
v_accvgpr_read_b32 v139, a103
v_mfma_f32_16x16x32_bf16 a[116:119], v[164:167], v[216:219], a[116:119]
v_cvt_pk_bf16_f32 v60, v136, v137
v_cvt_pk_bf16_f32 v61, v138, v139
v_mfma_f32_16x16x32_bf16 a[116:119], v[32:35], v[220:223], a[116:119]
v_accvgpr_read_b32 v144, a104
v_accvgpr_read_b32 v145, a105
v_mfma_f32_16x16x32_bf16 a[120:123], v[168:171], v[216:219], a[120:123]
v_accvgpr_read_b32 v146, a106
v_accvgpr_read_b32 v147, a107
v_mfma_f32_16x16x32_bf16 a[120:123], v[64:67], v[220:223], a[120:123]
v_cvt_pk_bf16_f32 v92, v144, v145
v_cvt_pk_bf16_f32 v93, v146, v147
v_mfma_f32_16x16x32_bf16 a[124:127], v[172:175], v[216:219], a[124:127]
ds_read_b64_tr_b16 v[216:217], v14 offset:8192
ds_read_b64_tr_b16 v[218:219], v14 offset:10240
v_mfma_f32_16x16x32_bf16 a[124:127], v[96:99], v[220:223], a[124:127]
ds_read_b64_tr_b16 v[220:221], v14 offset:24576
s_waitcnt lgkmcnt(3)
v_mfma_f32_16x16x32_bf16 a[128:131], v[8:11], v[208:211], a[128:131]
ds_read_b64_tr_b16 v[222:223], v14 offset:26624
v_accvgpr_read_b32 v152, a108
v_mfma_f32_16x16x32_bf16 a[128:131], v[176:179], v[212:215], a[128:131]
v_accvgpr_read_b32 v153, a109
v_accvgpr_read_b32 v154, a110
v_mfma_f32_16x16x32_bf16 a[132:135], v[40:43], v[208:211], a[132:135]
v_accvgpr_read_b32 v155, a111
v_cvt_pk_bf16_f32 v124, v152, v153
v_mfma_f32_16x16x32_bf16 a[132:135], v[180:183], v[212:215], a[132:135]
v_cvt_pk_bf16_f32 v125, v154, v155
v_accvgpr_read_b32 v132, a112
v_mfma_f32_16x16x32_bf16 a[136:139], v[72:75], v[208:211], a[136:139]
v_accvgpr_read_b32 v133, a113
v_accvgpr_read_b32 v134, a114
v_mfma_f32_16x16x32_bf16 a[136:139], v[184:187], v[212:215], a[136:139]
v_accvgpr_read_b32 v135, a115
v_cvt_pk_bf16_f32 v30, v132, v133
v_mfma_f32_16x16x32_bf16 a[140:143], v[104:107], v[208:211], a[140:143]
ds_read_b64_tr_b16 v[208:209], v13 offset:8192
ds_read_b64_tr_b16 v[210:211], v13 offset:10240
v_mfma_f32_16x16x32_bf16 a[140:143], v[188:191], v[212:215], a[140:143]
ds_read_b64_tr_b16 v[212:213], v13 offset:24576
s_waitcnt lgkmcnt(3)
v_mfma_f32_16x16x32_bf16 a[128:131], v[160:163], v[216:219], a[128:131]
ds_read_b64_tr_b16 v[214:215], v13 offset:26624
v_cvt_pk_bf16_f32 v31, v134, v135
v_mfma_f32_16x16x32_bf16 a[128:131], v[0:3], v[220:223], a[128:131]
buffer_store_dwordx4 v[28:31], v243, s[20:23], s40 offen offset:3072 sc1
ds_write_b128 v231, v[28:31] offset:3072
v_mfma_f32_16x16x32_bf16 a[132:135], v[164:167], v[216:219], a[132:135]
v_accvgpr_read_b32 v140, a116
v_accvgpr_read_b32 v141, a117
v_mfma_f32_16x16x32_bf16 a[132:135], v[32:35], v[220:223], a[132:135]
v_accvgpr_read_b32 v142, a118
v_accvgpr_read_b32 v143, a119
v_mfma_f32_16x16x32_bf16 a[136:139], v[168:171], v[216:219], a[136:139]
v_cvt_pk_bf16_f32 v62, v140, v141
v_cvt_pk_bf16_f32 v63, v142, v143
v_mfma_f32_16x16x32_bf16 a[136:139], v[64:67], v[220:223], a[136:139]
buffer_store_dwordx4 v[60:63], v243, s[20:23], s41 offen offset:3072 sc1
v_accvgpr_read_b32 v148, a120
v_mfma_f32_16x16x32_bf16 a[140:143], v[172:175], v[216:219], a[140:143]
ds_read_b64_tr_b16 v[216:217], v15 offset:8192
ds_read_b64_tr_b16 v[218:219], v15 offset:10240
v_mfma_f32_16x16x32_bf16 a[140:143], v[96:99], v[220:223], a[140:143]
ds_read_b64_tr_b16 v[220:221], v15 offset:24576
s_waitcnt lgkmcnt(3)
v_mfma_f32_16x16x32_bf16 a[144:147], v[8:11], v[208:211], a[144:147]
ds_read_b64_tr_b16 v[222:223], v15 offset:26624
v_accvgpr_read_b32 v149, a121
v_mfma_f32_16x16x32_bf16 a[144:147], v[176:179], v[212:215], a[144:147]
v_accvgpr_read_b32 v150, a122
v_accvgpr_read_b32 v151, a123
v_mfma_f32_16x16x32_bf16 a[148:151], v[40:43], v[208:211], a[148:151]
v_cvt_pk_bf16_f32 v94, v148, v149
v_cvt_pk_bf16_f32 v95, v150, v151
v_mfma_f32_16x16x32_bf16 a[148:151], v[180:183], v[212:215], a[148:151]
buffer_store_dwordx4 v[92:95], v243, s[20:23], s42 offen offset:3072 sc1
v_accvgpr_read_b32 v156, a124
v_mfma_f32_16x16x32_bf16 a[152:155], v[72:75], v[208:211], a[152:155]
v_accvgpr_read_b32 v157, a125
v_accvgpr_read_b32 v158, a126
v_mfma_f32_16x16x32_bf16 a[152:155], v[184:187], v[212:215], a[152:155]
v_accvgpr_read_b32 v159, a127
v_cvt_pk_bf16_f32 v126, v156, v157
v_mfma_f32_16x16x32_bf16 a[156:159], v[104:107], v[208:211], a[156:159]
ds_read_b64_tr_b16 v[208:209], v12 offset:8704
ds_read_b64_tr_b16 v[210:211], v12 offset:10752
v_mfma_f32_16x16x32_bf16 a[156:159], v[188:191], v[212:215], a[156:159]
ds_read_b64_tr_b16 v[212:213], v12 offset:25088
s_waitcnt lgkmcnt(3)
v_mfma_f32_16x16x32_bf16 a[144:147], v[160:163], v[216:219], a[144:147]
ds_read_b64_tr_b16 v[214:215], v12 offset:27136
v_cvt_pk_bf16_f32 v127, v158, v159
v_mfma_f32_16x16x32_bf16 a[144:147], v[0:3], v[220:223], a[144:147]
buffer_store_dwordx4 v[124:127], v243, s[20:23], s43 offen offset:3072 sc1
v_accvgpr_read_b32 v128, a128
v_mfma_f32_16x16x32_bf16 a[148:151], v[164:167], v[216:219], a[148:151]
v_accvgpr_read_b32 v129, a129
v_accvgpr_read_b32 v130, a130
v_mfma_f32_16x16x32_bf16 a[148:151], v[32:35], v[220:223], a[148:151]
v_accvgpr_read_b32 v131, a131
v_cvt_pk_bf16_f32 v16, v128, v129
v_mfma_f32_16x16x32_bf16 a[152:155], v[168:171], v[216:219], a[152:155]
v_cvt_pk_bf16_f32 v17, v130, v131
v_accvgpr_read_b32 v136, a132
v_mfma_f32_16x16x32_bf16 a[152:155], v[64:67], v[220:223], a[152:155]
v_accvgpr_read_b32 v137, a133
v_accvgpr_read_b32 v138, a134
v_mfma_f32_16x16x32_bf16 a[156:159], v[172:175], v[216:219], a[156:159]
ds_read_b64_tr_b16 v[216:217], v14 offset:8704
ds_read_b64_tr_b16 v[218:219], v14 offset:10752
v_mfma_f32_16x16x32_bf16 a[156:159], v[96:99], v[220:223], a[156:159]
ds_read_b64_tr_b16 v[220:221], v14 offset:25088
s_waitcnt lgkmcnt(3)
v_mfma_f32_16x16x32_bf16 a[160:163], v[8:11], v[208:211], a[160:163]
ds_read_b64_tr_b16 v[222:223], v14 offset:27136
v_accvgpr_read_b32 v139, a135
v_mfma_f32_16x16x32_bf16 a[160:163], v[176:179], v[212:215], a[160:163]
v_cvt_pk_bf16_f32 v48, v136, v137
v_cvt_pk_bf16_f32 v49, v138, v139
v_mfma_f32_16x16x32_bf16 a[164:167], v[40:43], v[208:211], a[164:167]
v_accvgpr_read_b32 v144, a136
v_accvgpr_read_b32 v145, a137
v_mfma_f32_16x16x32_bf16 a[164:167], v[180:183], v[212:215], a[164:167]
v_accvgpr_read_b32 v146, a138
v_accvgpr_read_b32 v147, a139
v_mfma_f32_16x16x32_bf16 a[168:171], v[72:75], v[208:211], a[168:171]
v_cvt_pk_bf16_f32 v80, v144, v145
v_cvt_pk_bf16_f32 v81, v146, v147
v_mfma_f32_16x16x32_bf16 a[168:171], v[184:187], v[212:215], a[168:171]
v_accvgpr_read_b32 v152, a140
v_accvgpr_read_b32 v153, a141
v_mfma_f32_16x16x32_bf16 a[172:175], v[104:107], v[208:211], a[172:175]
ds_read_b64_tr_b16 v[208:209], v13 offset:8704
ds_read_b64_tr_b16 v[210:211], v13 offset:10752
v_mfma_f32_16x16x32_bf16 a[172:175], v[188:191], v[212:215], a[172:175]
ds_read_b64_tr_b16 v[212:213], v13 offset:25088
s_waitcnt lgkmcnt(3)
v_mfma_f32_16x16x32_bf16 a[160:163], v[160:163], v[216:219], a[160:163]
ds_read_b64_tr_b16 v[214:215], v13 offset:27136
v_accvgpr_read_b32 v154, a142
v_mfma_f32_16x16x32_bf16 a[160:163], v[0:3], v[220:223], a[160:163]
v_accvgpr_read_b32 v155, a143
v_cvt_pk_bf16_f32 v112, v152, v153
v_mfma_f32_16x16x32_bf16 a[164:167], v[164:167], v[216:219], a[164:167]
v_cvt_pk_bf16_f32 v113, v154, v155
v_accvgpr_read_b32 v132, a144
v_mfma_f32_16x16x32_bf16 a[164:167], v[32:35], v[220:223], a[164:167]
v_accvgpr_read_b32 v133, a145
v_accvgpr_read_b32 v134, a146
v_mfma_f32_16x16x32_bf16 a[168:171], v[168:171], v[216:219], a[168:171]
v_accvgpr_read_b32 v135, a147
v_cvt_pk_bf16_f32 v18, v132, v133
v_mfma_f32_16x16x32_bf16 a[168:171], v[64:67], v[220:223], a[168:171]
v_cvt_pk_bf16_f32 v19, v134, v135
buffer_store_dwordx4 v[16:19], v243, s[20:23], s44 offen offset:0 sc1
v_mfma_f32_16x16x32_bf16 a[172:175], v[172:175], v[216:219], a[172:175]
ds_read_b64_tr_b16 v[216:217], v15 offset:8704
ds_read_b64_tr_b16 v[218:219], v15 offset:10752
v_mfma_f32_16x16x32_bf16 a[172:175], v[96:99], v[220:223], a[172:175]
ds_read_b64_tr_b16 v[220:221], v15 offset:25088
s_waitcnt lgkmcnt(3)
v_mfma_f32_16x16x32_bf16 a[176:179], v[8:11], v[208:211], a[176:179]
ds_read_b64_tr_b16 v[222:223], v15 offset:27136
ds_write_b128 v231, v[16:19] offset:4096
v_mfma_f32_16x16x32_bf16 a[176:179], v[176:179], v[212:215], a[176:179]
v_accvgpr_read_b32 v140, a148
v_accvgpr_read_b32 v141, a149
v_mfma_f32_16x16x32_bf16 a[180:183], v[40:43], v[208:211], a[180:183]
v_accvgpr_read_b32 v142, a150
v_accvgpr_read_b32 v143, a151
v_mfma_f32_16x16x32_bf16 a[180:183], v[180:183], v[212:215], a[180:183]
v_cvt_pk_bf16_f32 v50, v140, v141
v_cvt_pk_bf16_f32 v51, v142, v143
v_mfma_f32_16x16x32_bf16 a[184:187], v[72:75], v[208:211], a[184:187]
buffer_store_dwordx4 v[48:51], v243, s[20:23], s45 offen offset:0 sc1
v_accvgpr_read_b32 v148, a152
v_mfma_f32_16x16x32_bf16 a[184:187], v[184:187], v[212:215], a[184:187]
v_accvgpr_read_b32 v149, a153
v_accvgpr_read_b32 v150, a154
v_mfma_f32_16x16x32_bf16 a[188:191], v[104:107], v[208:211], a[188:191]
ds_read_b64_tr_b16 v[208:209], v12 offset:12288
ds_read_b64_tr_b16 v[210:211], v12 offset:14336
v_mfma_f32_16x16x32_bf16 a[188:191], v[188:191], v[212:215], a[188:191]
ds_read_b64_tr_b16 v[212:213], v12 offset:28672
s_waitcnt lgkmcnt(3)
v_mfma_f32_16x16x32_bf16 a[176:179], v[160:163], v[216:219], a[176:179]
ds_read_b64_tr_b16 v[214:215], v12 offset:30720
v_accvgpr_read_b32 v151, a155
v_mfma_f32_16x16x32_bf16 a[176:179], v[0:3], v[220:223], a[176:179]
v_cvt_pk_bf16_f32 v82, v148, v149
v_cvt_pk_bf16_f32 v83, v150, v151
v_mfma_f32_16x16x32_bf16 a[180:183], v[164:167], v[216:219], a[180:183]
buffer_store_dwordx4 v[80:83], v243, s[20:23], s46 offen offset:0 sc1
v_accvgpr_read_b32 v156, a156
v_mfma_f32_16x16x32_bf16 a[180:183], v[32:35], v[220:223], a[180:183]
v_accvgpr_read_b32 v157, a157
v_accvgpr_read_b32 v158, a158
v_mfma_f32_16x16x32_bf16 a[184:187], v[168:171], v[216:219], a[184:187]
v_accvgpr_read_b32 v159, a159
v_cvt_pk_bf16_f32 v114, v156, v157
v_mfma_f32_16x16x32_bf16 a[184:187], v[64:67], v[220:223], a[184:187]
v_cvt_pk_bf16_f32 v115, v158, v159
buffer_store_dwordx4 v[112:115], v243, s[20:23], s47 offen offset:0 sc1
v_mfma_f32_16x16x32_bf16 a[188:191], v[172:175], v[216:219], a[188:191]
ds_read_b64_tr_b16 v[216:217], v14 offset:12288
ds_read_b64_tr_b16 v[218:219], v14 offset:14336
v_mfma_f32_16x16x32_bf16 a[188:191], v[96:99], v[220:223], a[188:191]
ds_read_b64_tr_b16 v[220:221], v14 offset:28672
s_waitcnt lgkmcnt(3)
v_mfma_f32_16x16x32_bf16 a[192:195], v[8:11], v[208:211], a[192:195]
ds_read_b64_tr_b16 v[222:223], v14 offset:30720
v_accvgpr_read_b32 v128, a160
v_mfma_f32_16x16x32_bf16 a[192:195], v[176:179], v[212:215], a[192:195]
v_accvgpr_read_b32 v129, a161
v_accvgpr_read_b32 v130, a162
v_mfma_f32_16x16x32_bf16 a[196:199], v[40:43], v[208:211], a[196:199]
v_accvgpr_read_b32 v131, a163
v_cvt_pk_bf16_f32 v20, v128, v129
v_mfma_f32_16x16x32_bf16 a[196:199], v[180:183], v[212:215], a[196:199]
v_cvt_pk_bf16_f32 v21, v130, v131
v_accvgpr_read_b32 v136, a164
v_mfma_f32_16x16x32_bf16 a[200:203], v[72:75], v[208:211], a[200:203]
v_accvgpr_read_b32 v137, a165
v_accvgpr_read_b32 v138, a166
v_mfma_f32_16x16x32_bf16 a[200:203], v[184:187], v[212:215], a[200:203]
v_accvgpr_read_b32 v139, a167
v_cvt_pk_bf16_f32 v52, v136, v137
v_mfma_f32_16x16x32_bf16 a[204:207], v[104:107], v[208:211], a[204:207]
ds_read_b64_tr_b16 v[208:209], v13 offset:12288
ds_read_b64_tr_b16 v[210:211], v13 offset:14336
v_mfma_f32_16x16x32_bf16 a[204:207], v[188:191], v[212:215], a[204:207]
ds_read_b64_tr_b16 v[212:213], v13 offset:28672
s_waitcnt lgkmcnt(3)
v_mfma_f32_16x16x32_bf16 a[192:195], v[160:163], v[216:219], a[192:195]
ds_read_b64_tr_b16 v[214:215], v13 offset:30720
v_cvt_pk_bf16_f32 v53, v138, v139
v_mfma_f32_16x16x32_bf16 a[192:195], v[0:3], v[220:223], a[192:195]
v_accvgpr_read_b32 v144, a168
v_accvgpr_read_b32 v145, a169
v_mfma_f32_16x16x32_bf16 a[196:199], v[164:167], v[216:219], a[196:199]
v_accvgpr_read_b32 v146, a170
v_accvgpr_read_b32 v147, a171
v_mfma_f32_16x16x32_bf16 a[196:199], v[32:35], v[220:223], a[196:199]
v_cvt_pk_bf16_f32 v84, v144, v145
v_cvt_pk_bf16_f32 v85, v146, v147
v_mfma_f32_16x16x32_bf16 a[200:203], v[168:171], v[216:219], a[200:203]
v_accvgpr_read_b32 v152, a172
v_accvgpr_read_b32 v153, a173
v_mfma_f32_16x16x32_bf16 a[200:203], v[64:67], v[220:223], a[200:203]
v_accvgpr_read_b32 v154, a174
v_accvgpr_read_b32 v155, a175
v_mfma_f32_16x16x32_bf16 a[204:207], v[172:175], v[216:219], a[204:207]
ds_read_b64_tr_b16 v[216:217], v15 offset:12288
ds_read_b64_tr_b16 v[218:219], v15 offset:14336
v_mfma_f32_16x16x32_bf16 a[204:207], v[96:99], v[220:223], a[204:207]
ds_read_b64_tr_b16 v[220:221], v15 offset:28672
s_waitcnt lgkmcnt(3)
v_mfma_f32_16x16x32_bf16 a[208:211], v[8:11], v[208:211], a[208:211]
ds_read_b64_tr_b16 v[222:223], v15 offset:30720
v_cvt_pk_bf16_f32 v116, v152, v153
v_mfma_f32_16x16x32_bf16 a[208:211], v[176:179], v[212:215], a[208:211]
v_cvt_pk_bf16_f32 v117, v154, v155
v_accvgpr_read_b32 v132, a176
v_mfma_f32_16x16x32_bf16 a[212:215], v[40:43], v[208:211], a[212:215]
v_accvgpr_read_b32 v133, a177
v_accvgpr_read_b32 v134, a178
v_mfma_f32_16x16x32_bf16 a[212:215], v[180:183], v[212:215], a[212:215]
v_accvgpr_read_b32 v135, a179
v_cvt_pk_bf16_f32 v22, v132, v133
v_mfma_f32_16x16x32_bf16 a[216:219], v[72:75], v[208:211], a[216:219]
v_cvt_pk_bf16_f32 v23, v134, v135
buffer_store_dwordx4 v[20:23], v243, s[20:23], s44 offen offset:1024 sc1
v_mfma_f32_16x16x32_bf16 a[216:219], v[184:187], v[212:215], a[216:219]
ds_write_b128 v231, v[20:23] offset:5120
v_accvgpr_read_b32 v140, a180
v_mfma_f32_16x16x32_bf16 a[220:223], v[104:107], v[208:211], a[220:223]
v_accvgpr_read_b32 v141, a181
v_accvgpr_read_b32 v142, a182
v_mfma_f32_16x16x32_bf16 a[220:223], v[188:191], v[212:215], a[220:223]
s_waitcnt lgkmcnt(0)
v_accvgpr_read_b32 v143, a183
v_mfma_f32_16x16x32_bf16 a[208:211], v[160:163], v[216:219], a[208:211]
v_cvt_pk_bf16_f32 v54, v140, v141
v_cvt_pk_bf16_f32 v55, v142, v143
v_mfma_f32_16x16x32_bf16 a[208:211], v[0:3], v[220:223], a[208:211]
buffer_store_dwordx4 v[52:55], v243, s[20:23], s45 offen offset:1024 sc1
v_accvgpr_read_b32 v148, a184
v_mfma_f32_16x16x32_bf16 a[212:215], v[164:167], v[216:219], a[212:215]
v_accvgpr_read_b32 v149, a185
v_accvgpr_read_b32 v150, a186
v_mfma_f32_16x16x32_bf16 a[212:215], v[32:35], v[220:223], a[212:215]
v_accvgpr_read_b32 v151, a187
v_cvt_pk_bf16_f32 v86, v148, v149
v_mfma_f32_16x16x32_bf16 a[216:219], v[168:171], v[216:219], a[216:219]
v_cvt_pk_bf16_f32 v87, v150, v151
buffer_store_dwordx4 v[84:87], v243, s[20:23], s46 offen offset:1024 sc1
v_mfma_f32_16x16x32_bf16 a[216:219], v[64:67], v[220:223], a[216:219]
v_accvgpr_read_b32 v156, a188
v_accvgpr_read_b32 v157, a189
v_mfma_f32_16x16x32_bf16 a[220:223], v[172:175], v[216:219], a[220:223]
v_accvgpr_read_b32 v158, a190
v_accvgpr_read_b32 v159, a191
v_mfma_f32_16x16x32_bf16 a[220:223], v[96:99], v[220:223], a[220:223]
v_cvt_pk_bf16_f32 v118, v156, v157
v_cvt_pk_bf16_f32 v119, v158, v159
buffer_store_dwordx4 v[116:119], v243, s[20:23], s47 offen offset:1024 sc1
v_accvgpr_read_b32 v128, a192
v_accvgpr_read_b32 v129, a193
v_accvgpr_read_b32 v130, a194
v_accvgpr_read_b32 v131, a195
v_cvt_pk_bf16_f32 v24, v128, v129
v_cvt_pk_bf16_f32 v25, v130, v131
v_accvgpr_read_b32 v136, a196
v_accvgpr_read_b32 v137, a197
v_accvgpr_read_b32 v138, a198
v_accvgpr_read_b32 v139, a199
v_cvt_pk_bf16_f32 v56, v136, v137
v_cvt_pk_bf16_f32 v57, v138, v139
v_accvgpr_read_b32 v144, a200
v_accvgpr_read_b32 v145, a201
v_accvgpr_read_b32 v146, a202
v_accvgpr_read_b32 v147, a203
v_cvt_pk_bf16_f32 v88, v144, v145
v_cvt_pk_bf16_f32 v89, v146, v147
v_accvgpr_read_b32 v152, a204
v_accvgpr_read_b32 v153, a205
v_accvgpr_read_b32 v154, a206
v_accvgpr_read_b32 v155, a207
v_cvt_pk_bf16_f32 v120, v152, v153
v_cvt_pk_bf16_f32 v121, v154, v155
v_accvgpr_read_b32 v132, a208
v_accvgpr_read_b32 v133, a209
v_accvgpr_read_b32 v134, a210
v_accvgpr_read_b32 v135, a211
v_cvt_pk_bf16_f32 v26, v132, v133
v_cvt_pk_bf16_f32 v27, v134, v135
buffer_store_dwordx4 v[24:27], v243, s[20:23], s44 offen offset:2048 sc1
ds_write_b128 v231, v[24:27] offset:6144
v_accvgpr_read_b32 v140, a212
v_accvgpr_read_b32 v141, a213
v_accvgpr_read_b32 v142, a214
v_accvgpr_read_b32 v143, a215
v_cvt_pk_bf16_f32 v58, v140, v141
v_cvt_pk_bf16_f32 v59, v142, v143
buffer_store_dwordx4 v[56:59], v243, s[20:23], s45 offen offset:2048 sc1
v_accvgpr_read_b32 v148, a216
v_accvgpr_read_b32 v149, a217
v_accvgpr_read_b32 v150, a218
v_accvgpr_read_b32 v151, a219
v_cvt_pk_bf16_f32 v90, v148, v149
v_cvt_pk_bf16_f32 v91, v150, v151
buffer_store_dwordx4 v[88:91], v243, s[20:23], s46 offen offset:2048 sc1
v_accvgpr_read_b32 v156, a220
v_accvgpr_read_b32 v157, a221
v_accvgpr_read_b32 v158, a222
v_accvgpr_read_b32 v159, a223
v_cvt_pk_bf16_f32 v122, v156, v157
v_cvt_pk_bf16_f32 v123, v158, v159
buffer_store_dwordx4 v[120:123], v243, s[20:23], s47 offen offset:2048 sc1
s_waitcnt vmcnt(36)
s_branch L2_F
L2_tail_1:
s_waitcnt lgkmcnt(2)
v_add_u32 v231, s50, v243
v_mfma_f32_16x16x32_bf16 v[144:147], v[208:211], v[0:3], 0
s_mov_b32 m0, s30
ds_write_b128 v231, v[160:163] offset:0
v_mfma_f32_16x16x32_bf16 v[144:147], v[212:215], v[4:7], v[144:147]
buffer_load_dwordx4 v241, s[12:15], s28 offen offset:0 sc1 lds
ds_write_b128 v231, v[164:167] offset:1024
v_mfma_f32_16x16x32_bf16 v[148:151], v[208:211], v[32:35], 0
buffer_load_dwordx4 v241, s[12:15], s28 offen offset:1024 sc1 lds
ds_write_b128 v231, v[168:171] offset:2048
v_mfma_f32_16x16x32_bf16 v[148:151], v[212:215], v[36:39], v[148:151]
buffer_load_dwordx4 v241, s[12:15], s28 offen offset:2048 sc1 lds
ds_write_b128 v231, v[172:175] offset:3072
v_mfma_f32_16x16x32_bf16 v[152:155], v[208:211], v[64:67], 0
buffer_load_dwordx4 v241, s[12:15], s28 offen offset:3072 sc1 lds
v_add_u32 v230, 0x8000, v240
v_and_b32 v230, 0x1ffff, v230
v_mfma_f32_16x16x32_bf16 v[152:155], v[212:215], v[68:71], v[152:155]
v_exp_f32 v232, v128
v_mfma_f32_16x16x32_bf16 v[156:159], v[208:211], v[96:99], 0
ds_read_b128 v[208:211], v240 offset:6144
v_exp_f32 v233, v129
v_mfma_f32_16x16x32_bf16 v[156:159], v[212:215], v[100:103], v[156:159]
ds_read_b128 v[212:215], v240 offset:6656
s_waitcnt lgkmcnt(2)
s_and_b32 s30, s30, 0x1c000
v_mfma_f32_16x16x32_bf16 v[144:147], v[216:219], v[8:11], v[144:147]
v_exp_f32 v234, v130
v_cvt_pk_bf16_f32 v160, v232, v233
v_mfma_f32_16x16x32_bf16 v[144:147], v[220:223], v[12:15], v[144:147]
v_exp_f32 v235, v131
s_add_u32 s28, s30, 0x4000
v_mfma_f32_16x16x32_bf16 v[148:151], v[216:219], v[40:43], v[148:151]
v_exp_f32 v236, v132
v_cvt_pk_bf16_f32 v161, v234, v235
v_mfma_f32_16x16x32_bf16 v[148:151], v[220:223], v[44:47], v[148:151]
v_exp_f32 v237, v133
s_and_b32 s28, s28, 0x1ffff
v_mfma_f32_16x16x32_bf16 v[152:155], v[216:219], v[72:75], v[152:155]
v_exp_f32 v238, v134
v_cvt_pk_bf16_f32 v164, v236, v237
v_mfma_f32_16x16x32_bf16 v[152:155], v[220:223], v[76:79], v[152:155]
v_exp_f32 v239, v135
s_add_u32 s30, s30, 0x8000
v_mfma_f32_16x16x32_bf16 v[156:159], v[216:219], v[104:107], v[156:159]
ds_read_b128 v[216:219], v240 offset:10240
v_exp_f32 v232, v136
v_mfma_f32_16x16x32_bf16 v[156:159], v[220:223], v[108:111], v[156:159]
ds_read_b128 v[220:223], v240 offset:10752
s_waitcnt lgkmcnt(2)
v_cvt_pk_bf16_f32 v165, v238, v239
v_mfma_f32_16x16x32_bf16 v[144:147], v[208:211], v[16:19], v[144:147]
v_exp_f32 v233, v137
s_and_b32 s30, s30, 0x1ffff
v_mfma_f32_16x16x32_bf16 v[144:147], v[212:215], v[20:23], v[144:147]
s_waitcnt vmcnt(4)
s_barrier
s_mul_i32 s31, s34, 6144
v_mfma_f32_16x16x32_bf16 v[148:151], v[208:211], v[48:51], v[148:151]
v_exp_f32 v234, v138
v_cvt_pk_bf16_f32 v168, v232, v233
v_mfma_f32_16x16x32_bf16 v[148:151], v[212:215], v[52:55], v[148:151]
v_exp_f32 v235, v139
s_add_u32 s31, s31, s30
v_mfma_f32_16x16x32_bf16 v[152:155], v[208:211], v[80:83], v[152:155]
v_exp_f32 v236, v140
v_cvt_pk_bf16_f32 v169, v234, v235
v_mfma_f32_16x16x32_bf16 v[152:155], v[212:215], v[84:87], v[152:155]
v_exp_f32 v237, v141
s_lshl_b32 s3, s34, 10
v_mfma_f32_16x16x32_bf16 v[156:159], v[208:211], v[112:115], v[156:159]
ds_read_b128 v[208:211], v240 offset:29184
v_exp_f32 v238, v142
v_mfma_f32_16x16x32_bf16 v[156:159], v[212:215], v[116:119], v[156:159]
ds_read_b128 v[212:215], v240 offset:28672
s_waitcnt lgkmcnt(2)
v_cvt_pk_bf16_f32 v172, v236, v237
v_mfma_f32_16x16x32_bf16 v[144:147], v[216:219], v[24:27], v[144:147]
v_exp_f32 v239, v143
v_or3_b32 v242, v160, v161, v164
v_mfma_f32_16x16x32_bf16 v[144:147], v[220:223], v[28:31], v[144:147]
v_cvt_pk_bf16_f32 v173, v238, v239
v_or3_b32 v242, v242, v165, v168
v_or3_b32 v242, v242, v169, v172
v_mfma_f32_16x16x32_bf16 v[148:151], v[216:219], v[56:59], v[148:151]
v_or_b32 v242, v242, v173
v_lshl_or_b32 v242, v242, 16, v242
v_cmp_le_u32 vcc, 2.0, v242
v_mfma_f32_16x16x32_bf16 v[148:151], v[220:223], v[60:63], v[148:151]
s_add_u32 s28, s28, s3
s_add_u32 s3, s3, 24576
s_add_u32 s30, s30, s3
v_mfma_f32_16x16x32_bf16 v[152:155], v[216:219], v[88:91], v[152:155]
v_lshrrev_b32 v241, 4, v243
v_and_b32 v241, 0x30, v241
v_xor_b32 v241, v241, v243
v_mfma_f32_16x16x32_bf16 v[152:155], v[220:223], v[92:95], v[152:155]
s_cbranch_vccnz L2_rare_site12
L2_ret12:
v_and_b32 v228, 0x380, v243
v_mad_u32_u24 v241, v228, 3, v241
v_mfma_f32_16x16x32_bf16 v[156:159], v[216:219], v[120:123], v[156:159]
ds_read_b128 v[216:219], v240 offset:16384
s_add_u32 m0, s31, 0
v_mfma_f32_16x16x32_bf16 v[156:159], v[220:223], v[124:127], v[156:159]
ds_read_b128 v[220:223], v240 offset:16896
s_waitcnt lgkmcnt(2)
v_mfma_f32_16x16x32_bf16 v[128:131], v[208:211], v[0:3], 0
buffer_load_dwordx4 v241, s[8:11], s6 offen lds
s_add_u32 m0, s31, 2048
v_mfma_f32_16x16x32_bf16 v[128:131], v[212:215], v[4:7], v[128:131]
v_exp_f32 v232, v144
v_mfma_f32_16x16x32_bf16 v[132:135], v[208:211], v[32:35], 0
v_exp_f32 v233, v145
v_mfma_f32_16x16x32_bf16 v[132:135], v[212:215], v[36:39], v[132:135]
v_exp_f32 v234, v146
v_cvt_pk_bf16_f32 v162, v232, v233
v_mfma_f32_16x16x32_bf16 v[136:139], v[208:211], v[64:67], 0
v_exp_f32 v235, v147
v_mfma_f32_16x16x32_bf16 v[136:139], v[212:215], v[68:71], v[136:139]
v_exp_f32 v236, v148
v_cvt_pk_bf16_f32 v163, v234, v235
v_mfma_f32_16x16x32_bf16 v[140:143], v[208:211], v[96:99], 0
ds_read_b128 v[208:211], v240 offset:20480
v_exp_f32 v237, v149
v_mfma_f32_16x16x32_bf16 v[140:143], v[212:215], v[100:103], v[140:143]
ds_read_b128 v[212:215], v240 offset:20992
s_waitcnt lgkmcnt(2)
v_mfma_f32_16x16x32_bf16 v[128:131], v[216:219], v[8:11], v[128:131]
ds_write_b128 v231, v[176:179] offset:4096
v_exp_f32 v238, v150
v_mfma_f32_16x16x32_bf16 v[128:131], v[220:223], v[12:15], v[128:131]
ds_write_b128 v231, v[180:183] offset:5120
v_cvt_pk_bf16_f32 v166, v236, v237
v_mfma_f32_16x16x32_bf16 v[132:135], v[216:219], v[40:43], v[132:135]
ds_write_b128 v231, v[184:187] offset:6144
v_exp_f32 v239, v151
v_mfma_f32_16x16x32_bf16 v[132:135], v[220:223], v[44:47], v[132:135]
ds_write_b128 v231, v[188:191] offset:7168
v_exp_f32 v232, v152
v_mfma_f32_16x16x32_bf16 v[136:139], v[216:219], v[72:75], v[136:139]
v_cvt_pk_bf16_f32 v167, v238, v239
v_exp_f32 v233, v153
v_mfma_f32_16x16x32_bf16 v[136:139], v[220:223], v[76:79], v[136:139]
v_exp_f32 v234, v154
v_cvt_pk_bf16_f32 v170, v232, v233
v_mfma_f32_16x16x32_bf16 v[140:143], v[216:219], v[104:107], v[140:143]
ds_read_b128 v[216:219], v240 offset:24576
v_exp_f32 v235, v155
v_mfma_f32_16x16x32_bf16 v[140:143], v[220:223], v[108:111], v[140:143]
ds_read_b128 v[220:223], v240 offset:25088
s_waitcnt lgkmcnt(2)
v_mfma_f32_16x16x32_bf16 v[128:131], v[208:211], v[16:19], v[128:131]
v_exp_f32 v236, v156
v_cvt_pk_bf16_f32 v171, v234, v235
v_mfma_f32_16x16x32_bf16 v[128:131], v[212:215], v[20:23], v[128:131]
v_exp_f32 v237, v157
v_mfma_f32_16x16x32_bf16 v[132:135], v[208:211], v[48:51], v[132:135]
v_exp_f32 v238, v158
v_cvt_pk_bf16_f32 v174, v236, v237
v_mfma_f32_16x16x32_bf16 v[132:135], v[212:215], v[52:55], v[132:135]
v_exp_f32 v239, v159
v_or3_b32 v242, v162, v163, v166
v_mfma_f32_16x16x32_bf16 v[136:139], v[208:211], v[80:83], v[136:139]
v_cvt_pk_bf16_f32 v175, v238, v239
v_or3_b32 v242, v242, v167, v170
v_or3_b32 v242, v242, v171, v174
v_mfma_f32_16x16x32_bf16 v[136:139], v[212:215], v[84:87], v[136:139]
v_or_b32 v242, v242, v175
v_lshl_or_b32 v242, v242, 16, v242
v_cmp_le_u32 vcc, 2.0, v242
s_cbranch_vccnz L2_rare_site13
L2_ret13:
v_mfma_f32_16x16x32_bf16 v[140:143], v[208:211], v[112:115], v[140:143]
ds_read_b128 v[208:211], v240 offset:31232
buffer_load_dwordx4 v241, s[8:11], s7 offen lds
s_add_u32 m0, s31, 4096
v_mfma_f32_16x16x32_bf16 v[140:143], v[212:215], v[116:119], v[140:143]
ds_read_b128 v[212:215], v240 offset:30720
s_waitcnt lgkmcnt(2)
v_mfma_f32_16x16x32_bf16 v[128:131], v[216:219], v[24:27], v[128:131]
buffer_load_dwordx4 v241, s[8:11], s29 offen lds
s_add_u32 m0, s31, 1024
v_xor_b32 v241, 0x1040, v241
v_mfma_f32_16x16x32_bf16 v[128:131], v[220:223], v[28:31], v[128:131]
buffer_load_dwordx4 v241, s[8:11], s6 offen lds
s_add_u32 m0, s31, 3072
v_mfma_f32_16x16x32_bf16 v[132:135], v[216:219], v[56:59], v[132:135]
buffer_load_dwordx4 v241, s[8:11], s7 offen lds
s_add_u32 m0, s31, 5120
v_mfma_f32_16x16x32_bf16 v[132:135], v[220:223], v[60:63], v[132:135]
buffer_load_dwordx4 v241, s[8:11], s29 offen lds
v_mfma_f32_16x16x32_bf16 v[136:139], v[216:219], v[88:91], v[136:139]
v_mfma_f32_16x16x32_bf16 v[136:139], v[220:223], v[92:95], v[136:139]
v_mfma_f32_16x16x32_bf16 v[140:143], v[216:219], v[120:123], v[140:143]
ds_read_b128 v[216:219], v240 offset:18432
v_mfma_f32_16x16x32_bf16 v[140:143], v[220:223], v[124:127], v[140:143]
ds_read_b128 v[220:223], v240 offset:18944
s_waitcnt lgkmcnt(2)
v_mfma_f32_16x16x32_bf16 v[144:147], v[208:211], v[0:3], 0
v_mfma_f32_16x16x32_bf16 v[144:147], v[212:215], v[4:7], v[144:147]
v_exp_f32 v232, v128
v_mfma_f32_16x16x32_bf16 v[148:151], v[208:211], v[32:35], 0
v_exp_f32 v233, v129
v_mfma_f32_16x16x32_bf16 v[148:151], v[212:215], v[36:39], v[148:151]
v_exp_f32 v234, v130
v_cvt_pk_bf16_f32 v176, v232, v233
v_mfma_f32_16x16x32_bf16 v[152:155], v[208:211], v[64:67], 0
v_exp_f32 v235, v131
v_mfma_f32_16x16x32_bf16 v[152:155], v[212:215], v[68:71], v[152:155]
v_exp_f32 v236, v132
v_cvt_pk_bf16_f32 v177, v234, v235
v_mfma_f32_16x16x32_bf16 v[156:159], v[208:211], v[96:99], 0
ds_read_b128 v[208:211], v240 offset:22528
v_exp_f32 v237, v133
v_mfma_f32_16x16x32_bf16 v[156:159], v[212:215], v[100:103], v[156:159]
ds_read_b128 v[212:215], v240 offset:23040
s_waitcnt lgkmcnt(2)
v_mfma_f32_16x16x32_bf16 v[144:147], v[216:219], v[8:11], v[144:147]
v_exp_f32 v238, v134
v_cvt_pk_bf16_f32 v180, v236, v237
v_mfma_f32_16x16x32_bf16 v[144:147], v[220:223], v[12:15], v[144:147]
v_exp_f32 v239, v135
v_mfma_f32_16x16x32_bf16 v[148:151], v[216:219], v[40:43], v[148:151]
v_exp_f32 v232, v136
v_cvt_pk_bf16_f32 v181, v238, v239
v_mfma_f32_16x16x32_bf16 v[148:151], v[220:223], v[44:47], v[148:151]
v_exp_f32 v233, v137
v_mfma_f32_16x16x32_bf16 v[152:155], v[216:219], v[72:75], v[152:155]
v_exp_f32 v234, v138
v_cvt_pk_bf16_f32 v184, v232, v233
v_mfma_f32_16x16x32_bf16 v[152:155], v[220:223], v[76:79], v[152:155]
v_exp_f32 v235, v139
v_mfma_f32_16x16x32_bf16 v[156:159], v[216:219], v[104:107], v[156:159]
ds_read_b128 v[216:219], v240 offset:26624
v_exp_f32 v236, v140
v_mfma_f32_16x16x32_bf16 v[156:159], v[220:223], v[108:111], v[156:159]
ds_read_b128 v[220:223], v240 offset:27136
s_waitcnt lgkmcnt(2)
v_cvt_pk_bf16_f32 v185, v234, v235
v_mfma_f32_16x16x32_bf16 v[144:147], v[208:211], v[16:19], v[144:147]
v_exp_f32 v237, v141
v_mfma_f32_16x16x32_bf16 v[144:147], v[212:215], v[20:23], v[144:147]
s_waitcnt vmcnt(6)
s_barrier
v_mfma_f32_16x16x32_bf16 v[148:151], v[208:211], v[48:51], v[148:151]
v_exp_f32 v238, v142
v_cvt_pk_bf16_f32 v188, v236, v237
v_mfma_f32_16x16x32_bf16 v[148:151], v[212:215], v[52:55], v[148:151]
v_exp_f32 v239, v143
v_or3_b32 v242, v176, v177, v180
v_mfma_f32_16x16x32_bf16 v[152:155], v[208:211], v[80:83], v[152:155]
v_cvt_pk_bf16_f32 v189, v238, v239
v_or3_b32 v242, v242, v181, v184
v_or3_b32 v242, v242, v185, v188
v_mfma_f32_16x16x32_bf16 v[152:155], v[212:215], v[84:87], v[152:155]
v_or_b32 v242, v242, v189
v_lshl_or_b32 v242, v242, 16, v242
v_cmp_le_u32 vcc, 2.0, v242
s_cbranch_vccnz L2_rare_site14
L2_ret14:
v_mfma_f32_16x16x32_bf16 v[156:159], v[208:211], v[112:115], v[156:159]
ds_read_b128 v[208:211], v230 offset:12800
v_mfma_f32_16x16x32_bf16 v[156:159], v[212:215], v[116:119], v[156:159]
ds_read_b128 v[212:215], v230 offset:12288
s_waitcnt lgkmcnt(2)
v_mfma_f32_16x16x32_bf16 v[144:147], v[216:219], v[24:27], v[144:147]
v_mfma_f32_16x16x32_bf16 v[144:147], v[220:223], v[28:31], v[144:147]
v_mfma_f32_16x16x32_bf16 v[148:151], v[216:219], v[56:59], v[148:151]
v_mfma_f32_16x16x32_bf16 v[148:151], v[220:223], v[60:63], v[148:151]
v_mfma_f32_16x16x32_bf16 v[152:155], v[216:219], v[88:91], v[152:155]
v_mfma_f32_16x16x32_bf16 v[152:155], v[220:223], v[92:95], v[152:155]
v_mfma_f32_16x16x32_bf16 v[156:159], v[216:219], v[120:123], v[156:159]
ds_read_b128 v[216:219], v230 offset:0
v_mfma_f32_16x16x32_bf16 v[156:159], v[220:223], v[124:127], v[156:159]
ds_read_b128 v[220:223], v230 offset:512
s_waitcnt lgkmcnt(2)
v_mfma_f32_16x16x32_bf16 v[128:131], v[208:211], v[0:3], 0
v_mfma_f32_16x16x32_bf16 v[128:131], v[212:215], v[4:7], v[128:131]
v_exp_f32 v232, v144
v_mfma_f32_16x16x32_bf16 v[132:135], v[208:211], v[32:35], 0
v_exp_f32 v233, v145
v_mfma_f32_16x16x32_bf16 v[132:135], v[212:215], v[36:39], v[132:135]
v_exp_f32 v234, v146
v_cvt_pk_bf16_f32 v178, v232, v233
v_mfma_f32_16x16x32_bf16 v[136:139], v[208:211], v[64:67], 0
v_exp_f32 v235, v147
v_lshlrev_b32 v241, 3, v243
v_mfma_f32_16x16x32_bf16 v[136:139], v[212:215], v[68:71], v[136:139]
v_exp_f32 v236, v148
v_cvt_pk_bf16_f32 v179, v234, v235
v_mfma_f32_16x16x32_bf16 v[140:143], v[208:211], v[96:99], 0
ds_read_b128 v[208:211], v230 offset:4096
v_exp_f32 v237, v149
v_mfma_f32_16x16x32_bf16 v[140:143], v[212:215], v[100:103], v[140:143]
ds_read_b128 v[212:215], v230 offset:4608
s_waitcnt lgkmcnt(2)
s_mov_b32 s3, 0x7c28000
v_mfma_f32_16x16x32_bf16 v[128:131], v[216:219], v[8:11], v[128:131]
v_exp_f32 v238, v150
v_cvt_pk_bf16_f32 v182, v236, v237
v_mfma_f32_16x16x32_bf16 v[128:131], v[220:223], v[12:15], v[128:131]
v_exp_f32 v239, v151
buffer_load_dwordx2 v[240:241], v241, s[16:19], s3 offen sc1
v_mfma_f32_16x16x32_bf16 v[132:135], v[216:219], v[40:43], v[132:135]
v_exp_f32 v232, v152
v_cvt_pk_bf16_f32 v183, v238, v239
v_mfma_f32_16x16x32_bf16 v[132:135], v[220:223], v[44:47], v[132:135]
v_exp_f32 v233, v153
v_mfma_f32_16x16x32_bf16 v[136:139], v[216:219], v[72:75], v[136:139]
v_exp_f32 v234, v154
v_cvt_pk_bf16_f32 v186, v232, v233
v_mfma_f32_16x16x32_bf16 v[136:139], v[220:223], v[76:79], v[136:139]
v_exp_f32 v235, v155
v_mfma_f32_16x16x32_bf16 v[140:143], v[216:219], v[104:107], v[140:143]
ds_read_b128 v[216:219], v230 offset:8192
v_exp_f32 v236, v156
v_mfma_f32_16x16x32_bf16 v[140:143], v[220:223], v[108:111], v[140:143]
ds_read_b128 v[220:223], v230 offset:8704
s_waitcnt lgkmcnt(2)
v_cvt_pk_bf16_f32 v187, v234, v235
v_mfma_f32_16x16x32_bf16 v[128:131], v[208:211], v[16:19], v[128:131]
v_exp_f32 v237, v157
v_mfma_f32_16x16x32_bf16 v[128:131], v[212:215], v[20:23], v[128:131]
v_exp_f32 v238, v158
v_cvt_pk_bf16_f32 v190, v236, v237
v_mfma_f32_16x16x32_bf16 v[132:135], v[208:211], v[48:51], v[132:135]
v_exp_f32 v239, v159
v_or3_b32 v242, v178, v179, v182
v_mfma_f32_16x16x32_bf16 v[132:135], v[212:215], v[52:55], v[132:135]
v_cvt_pk_bf16_f32 v191, v238, v239
v_or3_b32 v242, v242, v183, v186
v_or3_b32 v242, v242, v187, v190
v_mfma_f32_16x16x32_bf16 v[136:139], v[208:211], v[80:83], v[136:139]
v_or_b32 v242, v242, v191
v_lshl_or_b32 v242, v242, 16, v242
v_cmp_le_u32 vcc, 2.0, v242
s_cbranch_vccnz L2_rare_site15
L2_ret15:
v_mfma_f32_16x16x32_bf16 v[136:139], v[212:215], v[84:87], v[136:139]
v_mfma_f32_16x16x32_bf16 v[140:143], v[208:211], v[112:115], v[140:143]
ds_read_b128 v[208:211], v230 offset:14848
v_mfma_f32_16x16x32_bf16 v[140:143], v[212:215], v[116:119], v[140:143]
ds_read_b128 v[212:215], v230 offset:14336
s_waitcnt lgkmcnt(2)
v_mfma_f32_16x16x32_bf16 v[128:131], v[216:219], v[24:27], v[128:131]
v_mfma_f32_16x16x32_bf16 v[128:131], v[220:223], v[28:31], v[128:131]
v_mfma_f32_16x16x32_bf16 v[132:135], v[216:219], v[56:59], v[132:135]
v_mfma_f32_16x16x32_bf16 v[132:135], v[220:223], v[60:63], v[132:135]
v_mfma_f32_16x16x32_bf16 v[136:139], v[216:219], v[88:91], v[136:139]
v_mfma_f32_16x16x32_bf16 v[136:139], v[220:223], v[92:95], v[136:139]
v_mfma_f32_16x16x32_bf16 v[140:143], v[216:219], v[120:123], v[140:143]
ds_read_b128 v[216:219], v230 offset:2048
v_mfma_f32_16x16x32_bf16 v[140:143], v[220:223], v[124:127], v[140:143]
ds_read_b128 v[220:223], v230 offset:2560
s_waitcnt lgkmcnt(2)
v_mfma_f32_16x16x32_bf16 v[144:147], v[208:211], v[0:3], 0
v_mfma_f32_16x16x32_bf16 v[144:147], v[212:215], v[4:7], v[144:147]
v_mfma_f32_16x16x32_bf16 v[148:151], v[208:211], v[32:35], 0
v_mfma_f32_16x16x32_bf16 v[148:151], v[212:215], v[36:39], v[148:151]
v_mfma_f32_16x16x32_bf16 v[152:155], v[208:211], v[64:67], 0
v_exp_f32 v232, v128
v_mfma_f32_16x16x32_bf16 v[152:155], v[212:215], v[68:71], v[152:155]
v_exp_f32 v233, v129
v_mfma_f32_16x16x32_bf16 v[156:159], v[208:211], v[96:99], 0
ds_read_b128 v[208:211], v230 offset:6144
v_exp_f32 v234, v130
v_mfma_f32_16x16x32_bf16 v[156:159], v[212:215], v[100:103], v[156:159]
ds_read_b128 v[212:215], v230 offset:6656
s_waitcnt lgkmcnt(2)
v_cvt_pk_bf16_f32 v0, v232, v233
v_mfma_f32_16x16x32_bf16 v[144:147], v[216:219], v[8:11], v[144:147]
v_exp_f32 v235, v131
v_mfma_f32_16x16x32_bf16 v[144:147], v[220:223], v[12:15], v[144:147]
ds_read_b128 v[4:7], v231 offset:0
v_exp_f32 v236, v132
v_mfma_f32_16x16x32_bf16 v[148:151], v[216:219], v[40:43], v[148:151]
ds_read_b128 v[36:39], v231 offset:1024
v_cvt_pk_bf16_f32 v1, v234, v235
v_mfma_f32_16x16x32_bf16 v[148:151], v[220:223], v[44:47], v[148:151]
v_exp_f32 v237, v133
v_mfma_f32_16x16x32_bf16 v[152:155], v[216:219], v[72:75], v[152:155]
v_exp_f32 v238, v134
v_cvt_pk_bf16_f32 v32, v236, v237
v_mfma_f32_16x16x32_bf16 v[152:155], v[220:223], v[76:79], v[152:155]
ds_read_b128 v[68:71], v231 offset:2048
ds_read_b128 v[8:11], v231 offset:4096
v_mfma_f32_16x16x32_bf16 v[156:159], v[216:219], v[104:107], v[156:159]
ds_read_b128 v[216:219], v230 offset:10240
v_add_u32 v12, 0x8000, v246
v_and_b32 v12, 0x1ffff, v12
ds_read_b128 v[100:103], v231 offset:3072
ds_read_b128 v[40:43], v231 offset:5120
v_mfma_f32_16x16x32_bf16 v[156:159], v[220:223], v[108:111], v[156:159]
ds_read_b128 v[220:223], v230 offset:10752
s_waitcnt lgkmcnt(2)
v_add_u32 v14, 0x10000, v246
v_and_b32 v14, 0x1ffff, v14
v_mfma_f32_16x16x32_bf16 v[144:147], v[208:211], v[16:19], v[144:147]
v_xor_b32 v13, 32, v12
v_xor_b32 v15, 32, v14
v_mfma_f32_16x16x32_bf16 v[144:147], v[212:215], v[20:23], v[144:147]
ds_read_b128 v[72:75], v231 offset:6144
v_exp_f32 v239, v135
v_mfma_f32_16x16x32_bf16 v[148:151], v[208:211], v[48:51], v[148:151]
ds_read_b128 v[104:107], v231 offset:7168
v_exp_f32 v232, v136
v_mfma_f32_16x16x32_bf16 v[148:151], v[212:215], v[52:55], v[148:151]
v_cvt_pk_bf16_f32 v33, v238, v239
v_exp_f32 v233, v137
v_mfma_f32_16x16x32_bf16 v[152:155], v[208:211], v[80:83], v[152:155]
v_exp_f32 v234, v138
v_cvt_pk_bf16_f32 v64, v232, v233
v_mfma_f32_16x16x32_bf16 v[152:155], v[212:215], v[84:87], v[152:155]
v_exp_f32 v235, v139
v_mfma_f32_16x16x32_bf16 v[156:159], v[208:211], v[112:115], v[156:159]
ds_read_b64_tr_b16 v[208:209], v246 offset:12800
ds_read_b64_tr_b16 v[210:211], v246 offset:14848
v_mfma_f32_16x16x32_bf16 v[156:159], v[212:215], v[116:119], v[156:159]
ds_read_b64_tr_b16 v[212:213], v246 offset:29184
s_waitcnt lgkmcnt(3)
v_mfma_f32_16x16x32_bf16 v[144:147], v[216:219], v[24:27], v[144:147]
ds_read_b64_tr_b16 v[214:215], v246 offset:31232
v_exp_f32 v236, v140
v_mfma_f32_16x16x32_bf16 v[144:147], v[220:223], v[28:31], v[144:147]
v_cvt_pk_bf16_f32 v65, v234, v235
v_exp_f32 v237, v141
v_mfma_f32_16x16x32_bf16 v[148:151], v[216:219], v[56:59], v[148:151]
v_exp_f32 v238, v142
v_cvt_pk_bf16_f32 v96, v236, v237
v_mfma_f32_16x16x32_bf16 v[148:151], v[220:223], v[60:63], v[148:151]
v_exp_f32 v239, v143
v_or3_b32 v242, v0, v1, v32
v_mfma_f32_16x16x32_bf16 v[152:155], v[216:219], v[88:91], v[152:155]
v_cvt_pk_bf16_f32 v97, v238, v239
v_or3_b32 v242, v242, v33, v64
v_or3_b32 v242, v242, v65, v96
v_mfma_f32_16x16x32_bf16 v[152:155], v[220:223], v[92:95], v[152:155]
v_or_b32 v242, v242, v97
v_lshl_or_b32 v242, v242, 16, v242
v_cmp_le_u32 vcc, 2.0, v242
s_cbranch_vccnz L2_rare_site16
L2_ret16:
v_mfma_f32_16x16x32_bf16 v[156:159], v[216:219], v[120:123], v[156:159]
ds_read_b64_tr_b16 v[216:217], v12 offset:12800
ds_read_b64_tr_b16 v[218:219], v12 offset:14848
s_waitcnt vmcnt(0)
v_mfma_f32_16x16x32_bf16 v[156:159], v[220:223], v[124:127], v[156:159]
ds_read_b64_tr_b16 v[220:221], v12 offset:29184
s_waitcnt lgkmcnt(3)
v_cmp_ne_u64_e64 s[38:39], s[98:99], v[240:241]
v_mfma_f32_16x16x32_bf16 a[224:227], v[4:7], v[208:211], a[224:227]
ds_read_b64_tr_b16 v[222:223], v12 offset:31232
s_and_b64 s[38:39], s[38:39], s[96:97]
s_cbranch_scc1 LF_hl_0
LF_hlret_0:
v_mfma_f32_16x16x32_bf16 a[224:227], v[8:11], v[212:215], a[224:227]
v_exp_f32 v232, v144
v_lshrrev_b32 v241, 4, v243
v_mfma_f32_16x16x32_bf16 a[228:231], v[36:39], v[208:211], a[228:231]
v_exp_f32 v233, v145
v_and_b32 v241, 0x30, v241
v_mfma_f32_16x16x32_bf16 a[228:231], v[40:43], v[212:215], a[228:231]
v_exp_f32 v234, v146
v_xor_b32 v241, v241, v243
v_mfma_f32_16x16x32_bf16 a[232:235], v[68:71], v[208:211], a[232:235]
v_cvt_pk_bf16_f32 v2, v232, v233
v_and_b32 v228, 0x380, v243
v_mad_u32_u24 v241, v228, 3, v241
v_mfma_f32_16x16x32_bf16 a[232:235], v[72:75], v[212:215], a[232:235]
v_exp_f32 v235, v147
v_add_u32 v241, 0x7000000, v241
v_mfma_f32_16x16x32_bf16 a[236:239], v[100:103], v[208:211], a[236:239]
ds_read_b64_tr_b16 v[208:209], v247 offset:12800
ds_read_b64_tr_b16 v[210:211], v247 offset:14848
v_and_b32 v110, 0x70, v243
v_mfma_f32_16x16x32_bf16 a[236:239], v[104:107], v[212:215], a[236:239]
ds_read_b64_tr_b16 v[212:213], v247 offset:29184
s_waitcnt lgkmcnt(3)
v_lshlrev_b32 v110, 3, v110
v_mfma_f32_16x16x32_bf16 a[224:227], v[160:163], v[216:219], a[224:227]
ds_read_b64_tr_b16 v[214:215], v247 offset:31232
v_add_u32 v110, 0x7c32000, v110
buffer_load_dwordx2 v[108:109], v110, s[16:19], 0 offen sc1
v_mfma_f32_16x16x32_bf16 a[224:227], v[176:179], v[220:223], a[224:227]
v_exp_f32 v236, v148
v_mfma_f32_16x16x32_bf16 a[228:231], v[164:167], v[216:219], a[228:231]
v_cvt_pk_bf16_f32 v3, v234, v235
s_add_u32 m0, s28, 0
v_mfma_f32_16x16x32_bf16 a[228:231], v[180:183], v[220:223], a[228:231]
v_exp_f32 v237, v149
v_mfma_f32_16x16x32_bf16 a[232:235], v[168:171], v[216:219], a[232:235]
v_exp_f32 v238, v150
v_mfma_f32_16x16x32_bf16 a[232:235], v[184:187], v[220:223], a[232:235]
v_cvt_pk_bf16_f32 v34, v236, v237
buffer_load_dwordx4 v241, s[16:19], s6 offen sc1 lds
s_add_u32 m0, s28, 8192
v_mfma_f32_16x16x32_bf16 a[236:239], v[172:175], v[216:219], a[236:239]
ds_read_b64_tr_b16 v[216:217], v13 offset:12800
ds_read_b64_tr_b16 v[218:219], v13 offset:14848
v_mfma_f32_16x16x32_bf16 a[236:239], v[188:191], v[220:223], a[236:239]
ds_read_b64_tr_b16 v[220:221], v13 offset:29184
s_waitcnt lgkmcnt(3)
v_mfma_f32_16x16x32_bf16 a[240:243], v[4:7], v[208:211], a[240:243]
ds_read_b64_tr_b16 v[222:223], v13 offset:31232
buffer_load_dwordx4 v241, s[16:19], s7 offen sc1 lds
s_add_u32 m0, s30, 0
v_mfma_f32_16x16x32_bf16 a[240:243], v[8:11], v[212:215], a[240:243]
v_exp_f32 v239, v151
v_mfma_f32_16x16x32_bf16 a[244:247], v[36:39], v[208:211], a[244:247]
v_exp_f32 v232, v152
v_mfma_f32_16x16x32_bf16 a[244:247], v[40:43], v[212:215], a[244:247]
v_cvt_pk_bf16_f32 v35, v238, v239
buffer_load_dwordx4 v241, s[16:19], s29 offen sc1 lds
s_add_u32 m0, s28, 4096
v_mfma_f32_16x16x32_bf16 a[248:251], v[68:71], v[208:211], a[248:251]
v_exp_f32 v233, v153
v_xor_b32 v241, 0x1040, v241
v_mfma_f32_16x16x32_bf16 a[248:251], v[72:75], v[212:215], a[248:251]
v_exp_f32 v234, v154
v_mfma_f32_16x16x32_bf16 a[252:255], v[100:103], v[208:211], a[252:255]
ds_read_b64_tr_b16 v[208:209], v246 offset:16384
ds_read_b64_tr_b16 v[210:211], v246 offset:18432
v_mfma_f32_16x16x32_bf16 a[252:255], v[104:107], v[212:215], a[252:255]
ds_read_b64_tr_b16 v[212:213], v12 offset:0
s_waitcnt lgkmcnt(3)
v_mfma_f32_16x16x32_bf16 a[240:243], v[160:163], v[216:219], a[240:243]
ds_read_b64_tr_b16 v[214:215], v12 offset:2048
v_cvt_pk_bf16_f32 v66, v232, v233
v_mfma_f32_16x16x32_bf16 a[240:243], v[176:179], v[220:223], a[240:243]
v_exp_f32 v235, v155
v_mfma_f32_16x16x32_bf16 a[244:247], v[164:167], v[216:219], a[244:247]
v_exp_f32 v236, v156
v_mfma_f32_16x16x32_bf16 a[244:247], v[180:183], v[220:223], a[244:247]
v_cvt_pk_bf16_f32 v67, v234, v235
buffer_load_dwordx4 v241, s[16:19], s6 offen sc1 lds
s_add_u32 m0, s28, 12288
v_mfma_f32_16x16x32_bf16 a[248:251], v[168:171], v[216:219], a[248:251]
v_exp_f32 v237, v157
v_mfma_f32_16x16x32_bf16 a[248:251], v[184:187], v[220:223], a[248:251]
v_exp_f32 v238, v158
v_mfma_f32_16x16x32_bf16 a[252:255], v[172:175], v[216:219], a[252:255]
ds_read_b64_tr_b16 v[216:217], v12 offset:16384
ds_read_b64_tr_b16 v[218:219], v12 offset:18432
v_mfma_f32_16x16x32_bf16 a[252:255], v[188:191], v[220:223], a[252:255]
ds_read_b64_tr_b16 v[220:221], v247 offset:16384
s_waitcnt lgkmcnt(3)
v_mfma_f32_16x16x32_bf16 a[0:3], v[8:11], v[208:211], a[0:3]
ds_read_b64_tr_b16 v[222:223], v247 offset:18432
v_cvt_pk_bf16_f32 v98, v236, v237
v_mfma_f32_16x16x32_bf16 a[0:3], v[160:163], v[212:215], a[0:3]
v_exp_f32 v239, v159
v_mfma_f32_16x16x32_bf16 a[4:7], v[40:43], v[208:211], a[4:7]
v_or3_b32 v242, v2, v3, v34
v_cvt_pk_bf16_f32 v99, v238, v239
v_mfma_f32_16x16x32_bf16 a[4:7], v[164:167], v[212:215], a[4:7]
v_or3_b32 v242, v242, v35, v66
v_or3_b32 v242, v242, v67, v98
v_mfma_f32_16x16x32_bf16 a[8:11], v[72:75], v[208:211], a[8:11]
v_or_b32 v242, v242, v99
v_lshl_or_b32 v242, v242, 16, v242
v_mfma_f32_16x16x32_bf16 a[8:11], v[168:171], v[212:215], a[8:11]
v_cmp_le_u32 vcc, 2.0, v242
s_cbranch_vccnz L2_rare_site17
L2_ret17:
v_mfma_f32_16x16x32_bf16 a[12:15], v[104:107], v[208:211], a[12:15]
ds_read_b64_tr_b16 v[208:209], v13 offset:0
ds_read_b64_tr_b16 v[210:211], v13 offset:2048
v_mfma_f32_16x16x32_bf16 a[12:15], v[172:175], v[212:215], a[12:15]
ds_read_b64_tr_b16 v[212:213], v13 offset:16384
s_waitcnt lgkmcnt(5)
v_mfma_f32_16x16x32_bf16 a[0:3], v[176:179], v[216:219], a[0:3]
ds_read_b64_tr_b16 v[214:215], v13 offset:18432
buffer_load_dwordx4 v241, s[16:19], s7 offen sc1 lds
s_add_u32 m0, s30, 4096
v_mfma_f32_16x16x32_bf16 a[4:7], v[180:183], v[216:219], a[4:7]
buffer_load_dwordx4 v241, s[16:19], s29 offen sc1 lds
v_mfma_f32_16x16x32_bf16 a[8:11], v[184:187], v[216:219], a[8:11]
v_mfma_f32_16x16x32_bf16 a[12:15], v[188:191], v[216:219], a[12:15]
ds_read_b64_tr_b16 v[216:217], v14 offset:12800
s_waitcnt lgkmcnt(5)
v_mfma_f32_16x16x32_bf16 a[16:19], v[8:11], v[220:223], a[16:19]
ds_read_b64_tr_b16 v[218:219], v14 offset:14848
v_mfma_f32_16x16x32_bf16 a[20:23], v[40:43], v[220:223], a[20:23]
v_mfma_f32_16x16x32_bf16 a[24:27], v[72:75], v[220:223], a[24:27]
v_mfma_f32_16x16x32_bf16 a[28:31], v[104:107], v[220:223], a[28:31]
ds_read_b64_tr_b16 v[220:221], v15 offset:12800
s_waitcnt lgkmcnt(3)
v_mfma_f32_16x16x32_bf16 a[16:19], v[160:163], v[208:211], a[16:19]
ds_read_b64_tr_b16 v[222:223], v15 offset:14848
v_mfma_f32_16x16x32_bf16 a[16:19], v[176:179], v[212:215], a[16:19]
v_mfma_f32_16x16x32_bf16 a[20:23], v[164:167], v[208:211], a[20:23]
v_mfma_f32_16x16x32_bf16 a[20:23], v[180:183], v[212:215], a[20:23]
v_mfma_f32_16x16x32_bf16 a[24:27], v[168:171], v[208:211], a[24:27]
v_mfma_f32_16x16x32_bf16 a[24:27], v[184:187], v[212:215], a[24:27]
v_mfma_f32_16x16x32_bf16 a[28:31], v[172:175], v[208:211], a[28:31]
ds_read_b64_tr_b16 v[208:209], v14 offset:0
ds_read_b64_tr_b16 v[210:211], v14 offset:2048
v_mfma_f32_16x16x32_bf16 a[28:31], v[188:191], v[212:215], a[28:31]
ds_read_b64_tr_b16 v[212:213], v15 offset:0
s_waitcnt lgkmcnt(5)
v_mfma_f32_16x16x32_bf16 a[224:227], v[0:3], v[216:219], a[224:227]
ds_read_b64_tr_b16 v[214:215], v15 offset:2048
v_lshrrev_b32 v228, 4, v243
v_and_b32 v228, 0x3c, v228
v_mfma_f32_16x16x32_bf16 a[228:231], v[32:35], v[216:219], a[228:231]
v_sub_f32 v224, 0, v224
v_sub_f32 v225, 0, v225
v_sub_f32 v226, 0, v226
v_mfma_f32_16x16x32_bf16 a[232:235], v[64:67], v[216:219], a[232:235]
v_sub_f32 v227, 0, v227
ds_bpermute_b32 v232, v228, v224
ds_bpermute_b32 v234, v228, v225
v_mfma_f32_16x16x32_bf16 a[236:239], v[96:99], v[216:219], a[236:239]
ds_read_b64_tr_b16 v[216:217], v246 offset:16896
s_waitcnt lgkmcnt(5)
ds_bpermute_b32 v236, v228, v226
v_mfma_f32_16x16x32_bf16 a[240:243], v[0:3], v[220:223], a[240:243]
ds_read_b64_tr_b16 v[218:219], v246 offset:18944
ds_bpermute_b32 v238, v228, v227
v_bfe_u32 v228, v243, 4, 1
v_mfma_f32_16x16x32_bf16 a[244:247], v[32:35], v[220:223], a[244:247]
v_mul_u32_u24 v228, 768, v228
v_lshl_add_u32 v228, s37, 7, v228
v_lshrrev_b32 v242, 6, v243
v_mfma_f32_16x16x32_bf16 a[248:251], v[64:67], v[220:223], a[248:251]
v_lshl_add_u32 v242, v242, 3, v228
v_accvgpr_read_b32 v128, a224
v_accvgpr_read_b32 v129, a225
v_mfma_f32_16x16x32_bf16 a[252:255], v[96:99], v[220:223], a[252:255]
ds_read_b64_tr_b16 v[220:221], v12 offset:512
s_waitcnt lgkmcnt(5)
v_accvgpr_read_b32 v130, a226
v_mfma_f32_16x16x32_bf16 a[0:3], v[0:3], v[208:211], a[0:3]
ds_read_b64_tr_b16 v[222:223], v12 offset:2560
v_accvgpr_read_b32 v131, a227
v_cvt_pk_bf16_f32 v28, v128, v129
v_mfma_f32_16x16x32_bf16 a[4:7], v[32:35], v[208:211], a[4:7]
v_cvt_pk_bf16_f32 v29, v130, v131
v_accvgpr_read_b32 v136, a228
v_accvgpr_read_b32 v137, a229
v_mfma_f32_16x16x32_bf16 a[8:11], v[64:67], v[208:211], a[8:11]
v_accvgpr_read_b32 v138, a230
v_accvgpr_read_b32 v139, a231
v_cvt_pk_bf16_f32 v60, v136, v137
v_mfma_f32_16x16x32_bf16 a[12:15], v[96:99], v[208:211], a[12:15]
ds_read_b64_tr_b16 v[208:209], v12 offset:16896
s_waitcnt lgkmcnt(5)
v_cvt_pk_bf16_f32 v61, v138, v139
v_mfma_f32_16x16x32_bf16 a[16:19], v[0:3], v[212:215], a[16:19]
ds_read_b64_tr_b16 v[210:211], v12 offset:18944
v_accvgpr_read_b32 v144, a232
v_accvgpr_read_b32 v145, a233
v_mfma_f32_16x16x32_bf16 a[20:23], v[32:35], v[212:215], a[20:23]
v_accvgpr_read_b32 v146, a234
v_accvgpr_read_b32 v147, a235
v_cvt_pk_bf16_f32 v92, v144, v145
v_mfma_f32_16x16x32_bf16 a[24:27], v[64:67], v[212:215], a[24:27]
v_cvt_pk_bf16_f32 v93, v146, v147
v_accvgpr_read_b32 v152, a236
v_accvgpr_read_b32 v153, a237
v_mfma_f32_16x16x32_bf16 a[28:31], v[96:99], v[212:215], a[28:31]
ds_read_b64_tr_b16 v[212:213], v14 offset:512
s_waitcnt lgkmcnt(3)
v_accvgpr_read_b32 v154, a238
v_mfma_f32_16x16x32_bf16 a[32:35], v[8:11], v[216:219], a[32:35]
ds_read_b64_tr_b16 v[214:215], v14 offset:2560
v_accvgpr_read_b32 v155, a239
v_cvt_pk_bf16_f32 v124, v152, v153
v_mfma_f32_16x16x32_bf16 a[32:35], v[160:163], v[220:223], a[32:35]
v_cvt_pk_bf16_f32 v125, v154, v155
v_accvgpr_read_b32 v132, a240
v_accvgpr_read_b32 v133, a241
v_mfma_f32_16x16x32_bf16 a[36:39], v[40:43], v[216:219], a[36:39]
v_accvgpr_read_b32 v134, a242
v_accvgpr_read_b32 v135, a243
v_cvt_pk_bf16_f32 v30, v132, v133
v_mfma_f32_16x16x32_bf16 a[36:39], v[164:167], v[220:223], a[36:39]
v_cvt_pk_bf16_f32 v31, v134, v135
buffer_store_dwordx4 v[28:31], v243, s[20:23], s44 offen offset:3072 sc1
ds_write_b128 v231, v[28:31] offset:7168
v_mfma_f32_16x16x32_bf16 a[40:43], v[72:75], v[216:219], a[40:43]
v_accvgpr_read_b32 v140, a244
v_accvgpr_read_b32 v141, a245
v_accvgpr_read_b32 v142, a246
v_mfma_f32_16x16x32_bf16 a[40:43], v[168:171], v[220:223], a[40:43]
v_accvgpr_read_b32 v143, a247
v_cvt_pk_bf16_f32 v62, v140, v141
v_cvt_pk_bf16_f32 v63, v142, v143
v_mfma_f32_16x16x32_bf16 a[44:47], v[104:107], v[216:219], a[44:47]
ds_read_b64_tr_b16 v[216:217], v247 offset:16896
ds_read_b64_tr_b16 v[218:219], v247 offset:18944
buffer_store_dwordx4 v[60:63], v243, s[20:23], s45 offen offset:3072 sc1
v_mfma_f32_16x16x32_bf16 a[44:47], v[172:175], v[220:223], a[44:47]
ds_read_b64_tr_b16 v[220:221], v13 offset:512
s_waitcnt lgkmcnt(3)
v_accvgpr_read_b32 v148, a248
v_mfma_f32_16x16x32_bf16 a[32:35], v[176:179], v[208:211], a[32:35]
ds_read_b64_tr_b16 v[222:223], v13 offset:2560
v_accvgpr_read_b32 v149, a249
v_accvgpr_read_b32 v150, a250
v_mfma_f32_16x16x32_bf16 a[32:35], v[0:3], v[212:215], a[32:35]
v_accvgpr_read_b32 v151, a251
v_cvt_pk_bf16_f32 v94, v148, v149
v_cvt_pk_bf16_f32 v95, v150, v151
v_mfma_f32_16x16x32_bf16 a[36:39], v[180:183], v[208:211], a[36:39]
buffer_store_dwordx4 v[92:95], v243, s[20:23], s46 offen offset:3072 sc1
v_accvgpr_read_b32 v156, a252
v_accvgpr_read_b32 v157, a253
v_mfma_f32_16x16x32_bf16 a[36:39], v[32:35], v[212:215], a[36:39]
v_accvgpr_read_b32 v158, a254
v_accvgpr_read_b32 v159, a255
v_cvt_pk_bf16_f32 v126, v156, v157
v_mfma_f32_16x16x32_bf16 a[40:43], v[184:187], v[208:211], a[40:43]
v_cvt_pk_bf16_f32 v127, v158, v159
buffer_store_dwordx4 v[124:127], v243, s[20:23], s47 offen offset:3072 sc1
v_mov_b32_dpp v233, v132 row_newbcast:15 row_mask:0xf bank_mask:0x1
v_mfma_f32_16x16x32_bf16 a[40:43], v[64:67], v[212:215], a[40:43]
v_mov_b32_dpp v235, v140 row_newbcast:15 row_mask:0xf bank_mask:0x1
v_mov_b32_dpp v237, v148 row_newbcast:15 row_mask:0xf bank_mask:0x1
v_mov_b32_dpp v239, v156 row_newbcast:15 row_mask:0xf bank_mask:0x1
v_mfma_f32_16x16x32_bf16 a[44:47], v[188:191], v[208:211], a[44:47]
ds_read_b64_tr_b16 v[208:209], v13 offset:16896
ds_read_b64_tr_b16 v[210:211], v13 offset:18944
v_mov_b32_dpp v233, v133 row_newbcast:15 row_mask:0xf bank_mask:0x2
v_mfma_f32_16x16x32_bf16 a[44:47], v[96:99], v[212:215], a[44:47]
ds_read_b64_tr_b16 v[212:213], v15 offset:512
s_waitcnt lgkmcnt(3)
v_mov_b32_dpp v235, v141 row_newbcast:15 row_mask:0xf bank_mask:0x2
v_mfma_f32_16x16x32_bf16 a[48:51], v[8:11], v[216:219], a[48:51]
ds_read_b64_tr_b16 v[214:215], v15 offset:2560
v_mov_b32_dpp v237, v149 row_newbcast:15 row_mask:0xf bank_mask:0x2
v_mov_b32_dpp v239, v157 row_newbcast:15 row_mask:0xf bank_mask:0x2
v_mfma_f32_16x16x32_bf16 a[48:51], v[160:163], v[220:223], a[48:51]
v_mov_b32_dpp v233, v134 row_newbcast:15 row_mask:0xf bank_mask:0x4
v_mov_b32_dpp v235, v142 row_newbcast:15 row_mask:0xf bank_mask:0x4
v_mov_b32_dpp v237, v150 row_newbcast:15 row_mask:0xf bank_mask:0x4
v_mfma_f32_16x16x32_bf16 a[52:55], v[40:43], v[216:219], a[52:55]
v_mov_b32_dpp v239, v158 row_newbcast:15 row_mask:0xf bank_mask:0x4
v_mov_b32_dpp v233, v135 row_newbcast:15 row_mask:0xf bank_mask:0x8
v_mov_b32_dpp v235, v143 row_newbcast:15 row_mask:0xf bank_mask:0x8
v_mfma_f32_16x16x32_bf16 a[52:55], v[164:167], v[220:223], a[52:55]
v_mov_b32_dpp v237, v151 row_newbcast:15 row_mask:0xf bank_mask:0x8
v_mov_b32_dpp v239, v159 row_newbcast:15 row_mask:0xf bank_mask:0x8
v_mfma_f32_16x16x32_bf16 a[56:59], v[72:75], v[216:219], a[56:59]
s_mov_b32 exec_lo, 0x33333333
s_mov_b32 exec_hi, 0x33333333
buffer_store_dwordx2 v[232:233], v242, s[24:27], s48 offen sc1
s_lshr_b32 s3, s41, 2
buffer_store_dwordx2 v[234:235], v242, s[24:27], s3 offen sc1
s_lshr_b32 s3, s42, 2
buffer_store_dwordx2 v[236:237], v242, s[24:27], s3 offen sc1
s_lshr_b32 s3, s43, 2
buffer_store_dwordx2 v[238:239], v242, s[24:27], s3 offen sc1
s_mov_b64 exec, -1
v_mfma_f32_16x16x32_bf16 a[56:59], v[168:171], v[220:223], a[56:59]
v_accvgpr_read_b32 v128, a0
v_accvgpr_read_b32 v129, a1
v_accvgpr_read_b32 v130, a2
v_mfma_f32_16x16x32_bf16 a[60:63], v[104:107], v[216:219], a[60:63]
ds_read_b64_tr_b16 v[216:217], v246 offset:20480
ds_read_b64_tr_b16 v[218:219], v246 offset:22528
v_accvgpr_read_b32 v131, a3
v_mfma_f32_16x16x32_bf16 a[60:63], v[172:175], v[220:223], a[60:63]
ds_read_b64_tr_b16 v[220:221], v12 offset:4096
s_waitcnt lgkmcnt(3)
v_cvt_pk_bf16_f32 v16, v128, v129
v_mfma_f32_16x16x32_bf16 a[48:51], v[176:179], v[208:211], a[48:51]
ds_read_b64_tr_b16 v[222:223], v12 offset:6144
v_cvt_pk_bf16_f32 v17, v130, v131
v_accvgpr_read_b32 v136, a4
v_mfma_f32_16x16x32_bf16 a[48:51], v[0:3], v[212:215], a[48:51]
v_accvgpr_read_b32 v137, a5
v_accvgpr_read_b32 v138, a6
v_accvgpr_read_b32 v139, a7
v_mfma_f32_16x16x32_bf16 a[52:55], v[180:183], v[208:211], a[52:55]
v_cvt_pk_bf16_f32 v48, v136, v137
v_cvt_pk_bf16_f32 v49, v138, v139
v_accvgpr_read_b32 v144, a8
v_mfma_f32_16x16x32_bf16 a[52:55], v[32:35], v[212:215], a[52:55]
v_accvgpr_read_b32 v145, a9
v_accvgpr_read_b32 v146, a10
v_accvgpr_read_b32 v147, a11
v_mfma_f32_16x16x32_bf16 a[56:59], v[184:187], v[208:211], a[56:59]
v_cvt_pk_bf16_f32 v80, v144, v145
v_cvt_pk_bf16_f32 v81, v146, v147
v_accvgpr_read_b32 v152, a12
v_mfma_f32_16x16x32_bf16 a[56:59], v[64:67], v[212:215], a[56:59]
v_accvgpr_read_b32 v153, a13
v_accvgpr_read_b32 v154, a14
v_accvgpr_read_b32 v155, a15
v_mfma_f32_16x16x32_bf16 a[60:63], v[188:191], v[208:211], a[60:63]
ds_read_b64_tr_b16 v[208:209], v12 offset:20480
ds_read_b64_tr_b16 v[210:211], v12 offset:22528
v_cvt_pk_bf16_f32 v112, v152, v153
v_mfma_f32_16x16x32_bf16 a[60:63], v[96:99], v[212:215], a[60:63]
ds_read_b64_tr_b16 v[212:213], v14 offset:4096
s_waitcnt lgkmcnt(3)
v_cvt_pk_bf16_f32 v113, v154, v155
v_mfma_f32_16x16x32_bf16 a[64:67], v[8:11], v[216:219], a[64:67]
ds_read_b64_tr_b16 v[214:215], v14 offset:6144
v_accvgpr_read_b32 v132, a16
v_accvgpr_read_b32 v133, a17
v_mfma_f32_16x16x32_bf16 a[64:67], v[160:163], v[220:223], a[64:67]
v_accvgpr_read_b32 v134, a18
v_accvgpr_read_b32 v135, a19
v_cvt_pk_bf16_f32 v18, v132, v133
v_mfma_f32_16x16x32_bf16 a[68:71], v[40:43], v[216:219], a[68:71]
v_cvt_pk_bf16_f32 v19, v134, v135
buffer_store_dwordx4 v[16:19], v243, s[20:23], s40 offen offset:0 sc1
ds_write_b128 v231, v[16:19] offset:0
v_mfma_f32_16x16x32_bf16 a[68:71], v[164:167], v[220:223], a[68:71]
v_accvgpr_read_b32 v140, a20
v_accvgpr_read_b32 v141, a21
v_accvgpr_read_b32 v142, a22
v_mfma_f32_16x16x32_bf16 a[72:75], v[72:75], v[216:219], a[72:75]
v_accvgpr_read_b32 v143, a23
v_cvt_pk_bf16_f32 v50, v140, v141
v_cvt_pk_bf16_f32 v51, v142, v143
v_mfma_f32_16x16x32_bf16 a[72:75], v[168:171], v[220:223], a[72:75]
buffer_store_dwordx4 v[48:51], v243, s[20:23], s41 offen offset:0 sc1
v_accvgpr_read_b32 v148, a24
v_accvgpr_read_b32 v149, a25
v_mfma_f32_16x16x32_bf16 a[76:79], v[104:107], v[216:219], a[76:79]
ds_read_b64_tr_b16 v[216:217], v247 offset:20480
ds_read_b64_tr_b16 v[218:219], v247 offset:22528
v_accvgpr_read_b32 v150, a26
v_mfma_f32_16x16x32_bf16 a[76:79], v[172:175], v[220:223], a[76:79]
ds_read_b64_tr_b16 v[220:221], v13 offset:4096
s_waitcnt lgkmcnt(3)
v_accvgpr_read_b32 v151, a27
v_mfma_f32_16x16x32_bf16 a[64:67], v[176:179], v[208:211], a[64:67]
ds_read_b64_tr_b16 v[222:223], v13 offset:6144
v_cvt_pk_bf16_f32 v82, v148, v149
v_cvt_pk_bf16_f32 v83, v150, v151
v_mfma_f32_16x16x32_bf16 a[64:67], v[0:3], v[212:215], a[64:67]
buffer_store_dwordx4 v[80:83], v243, s[20:23], s42 offen offset:0 sc1
v_accvgpr_read_b32 v156, a28
v_accvgpr_read_b32 v157, a29
v_mfma_f32_16x16x32_bf16 a[68:71], v[180:183], v[208:211], a[68:71]
v_accvgpr_read_b32 v158, a30
v_accvgpr_read_b32 v159, a31
v_cvt_pk_bf16_f32 v114, v156, v157
v_mfma_f32_16x16x32_bf16 a[68:71], v[32:35], v[212:215], a[68:71]
v_cvt_pk_bf16_f32 v115, v158, v159
buffer_store_dwordx4 v[112:115], v243, s[20:23], s43 offen offset:0 sc1
v_accvgpr_read_b32 v128, a32
v_mfma_f32_16x16x32_bf16 a[72:75], v[184:187], v[208:211], a[72:75]
v_accvgpr_read_b32 v129, a33
v_accvgpr_read_b32 v130, a34
v_accvgpr_read_b32 v131, a35
v_mfma_f32_16x16x32_bf16 a[72:75], v[64:67], v[212:215], a[72:75]
v_cvt_pk_bf16_f32 v20, v128, v129
v_cvt_pk_bf16_f32 v21, v130, v131
v_accvgpr_read_b32 v136, a36
v_mfma_f32_16x16x32_bf16 a[76:79], v[188:191], v[208:211], a[76:79]
ds_read_b64_tr_b16 v[208:209], v13 offset:20480
ds_read_b64_tr_b16 v[210:211], v13 offset:22528
v_accvgpr_read_b32 v137, a37
v_mfma_f32_16x16x32_bf16 a[76:79], v[96:99], v[212:215], a[76:79]
ds_read_b64_tr_b16 v[212:213], v15 offset:4096
s_waitcnt lgkmcnt(3)
v_accvgpr_read_b32 v138, a38
v_mfma_f32_16x16x32_bf16 a[80:83], v[8:11], v[216:219], a[80:83]
ds_read_b64_tr_b16 v[214:215], v15 offset:6144
v_accvgpr_read_b32 v139, a39
v_cvt_pk_bf16_f32 v52, v136, v137
v_mfma_f32_16x16x32_bf16 a[80:83], v[160:163], v[220:223], a[80:83]
v_cvt_pk_bf16_f32 v53, v138, v139
v_accvgpr_read_b32 v144, a40
v_accvgpr_read_b32 v145, a41
v_mfma_f32_16x16x32_bf16 a[84:87], v[40:43], v[216:219], a[84:87]
v_accvgpr_read_b32 v146, a42
v_accvgpr_read_b32 v147, a43
v_cvt_pk_bf16_f32 v84, v144, v145
v_mfma_f32_16x16x32_bf16 a[84:87], v[164:167], v[220:223], a[84:87]
v_cvt_pk_bf16_f32 v85, v146, v147
v_accvgpr_read_b32 v152, a44
v_accvgpr_read_b32 v153, a45
v_mfma_f32_16x16x32_bf16 a[88:91], v[72:75], v[216:219], a[88:91]
v_accvgpr_read_b32 v154, a46
v_accvgpr_read_b32 v155, a47
v_cvt_pk_bf16_f32 v116, v152, v153
v_mfma_f32_16x16x32_bf16 a[88:91], v[168:171], v[220:223], a[88:91]
v_cvt_pk_bf16_f32 v117, v154, v155
v_accvgpr_read_b32 v132, a48
v_accvgpr_read_b32 v133, a49
v_mfma_f32_16x16x32_bf16 a[92:95], v[104:107], v[216:219], a[92:95]
ds_read_b64_tr_b16 v[216:217], v246 offset:20992
ds_read_b64_tr_b16 v[218:219], v246 offset:23040
v_accvgpr_read_b32 v134, a50
v_mfma_f32_16x16x32_bf16 a[92:95], v[172:175], v[220:223], a[92:95]
ds_read_b64_tr_b16 v[220:221], v12 offset:4608
s_waitcnt lgkmcnt(3)
v_accvgpr_read_b32 v135, a51
v_mfma_f32_16x16x32_bf16 a[80:83], v[176:179], v[208:211], a[80:83]
ds_read_b64_tr_b16 v[222:223], v12 offset:6656
v_cvt_pk_bf16_f32 v22, v132, v133
v_cvt_pk_bf16_f32 v23, v134, v135
v_mfma_f32_16x16x32_bf16 a[80:83], v[0:3], v[212:215], a[80:83]
buffer_store_dwordx4 v[20:23], v243, s[20:23], s40 offen offset:1024 sc1
ds_write_b128 v231, v[20:23] offset:1024
v_accvgpr_read_b32 v140, a52
v_mfma_f32_16x16x32_bf16 a[84:87], v[180:183], v[208:211], a[84:87]
v_accvgpr_read_b32 v141, a53
v_accvgpr_read_b32 v142, a54
v_accvgpr_read_b32 v143, a55
v_mfma_f32_16x16x32_bf16 a[84:87], v[32:35], v[212:215], a[84:87]
v_cvt_pk_bf16_f32 v54, v140, v141
v_cvt_pk_bf16_f32 v55, v142, v143
buffer_store_dwordx4 v[52:55], v243, s[20:23], s41 offen offset:1024 sc1
v_mfma_f32_16x16x32_bf16 a[88:91], v[184:187], v[208:211], a[88:91]
v_accvgpr_read_b32 v148, a56
v_accvgpr_read_b32 v149, a57
v_accvgpr_read_b32 v150, a58
v_mfma_f32_16x16x32_bf16 a[88:91], v[64:67], v[212:215], a[88:91]
v_accvgpr_read_b32 v151, a59
v_cvt_pk_bf16_f32 v86, v148, v149
v_cvt_pk_bf16_f32 v87, v150, v151
v_mfma_f32_16x16x32_bf16 a[92:95], v[188:191], v[208:211], a[92:95]
ds_read_b64_tr_b16 v[208:209], v12 offset:20992
ds_read_b64_tr_b16 v[210:211], v12 offset:23040
buffer_store_dwordx4 v[84:87], v243, s[20:23], s42 offen offset:1024 sc1
v_mfma_f32_16x16x32_bf16 a[92:95], v[96:99], v[212:215], a[92:95]
ds_read_b64_tr_b16 v[212:213], v14 offset:4608
s_waitcnt lgkmcnt(3)
v_accvgpr_read_b32 v156, a60
v_mfma_f32_16x16x32_bf16 a[96:99], v[8:11], v[216:219], a[96:99]
ds_read_b64_tr_b16 v[214:215], v14 offset:6656
v_accvgpr_read_b32 v157, a61
v_accvgpr_read_b32 v158, a62
v_mfma_f32_16x16x32_bf16 a[96:99], v[160:163], v[220:223], a[96:99]
v_accvgpr_read_b32 v159, a63
v_cvt_pk_bf16_f32 v118, v156, v157
v_cvt_pk_bf16_f32 v119, v158, v159
v_mfma_f32_16x16x32_bf16 a[100:103], v[40:43], v[216:219], a[100:103]
buffer_store_dwordx4 v[116:119], v243, s[20:23], s43 offen offset:1024 sc1
v_accvgpr_read_b32 v128, a64
v_mfma_f32_16x16x32_bf16 a[100:103], v[164:167], v[220:223], a[100:103]
v_accvgpr_read_b32 v129, a65
v_accvgpr_read_b32 v130, a66
v_mfma_f32_16x16x32_bf16 a[104:107], v[72:75], v[216:219], a[104:107]
v_accvgpr_read_b32 v131, a67
v_cvt_pk_bf16_f32 v24, v128, v129
v_mfma_f32_16x16x32_bf16 a[104:107], v[168:171], v[220:223], a[104:107]
v_cvt_pk_bf16_f32 v25, v130, v131
v_accvgpr_read_b32 v136, a68
v_mfma_f32_16x16x32_bf16 a[108:111], v[104:107], v[216:219], a[108:111]
ds_read_b64_tr_b16 v[216:217], v247 offset:20992
ds_read_b64_tr_b16 v[218:219], v247 offset:23040
v_mfma_f32_16x16x32_bf16 a[108:111], v[172:175], v[220:223], a[108:111]
ds_read_b64_tr_b16 v[220:221], v13 offset:4608
s_waitcnt lgkmcnt(3)
v_mfma_f32_16x16x32_bf16 a[96:99], v[176:179], v[208:211], a[96:99]
ds_read_b64_tr_b16 v[222:223], v13 offset:6656
v_accvgpr_read_b32 v137, a69
v_mfma_f32_16x16x32_bf16 a[96:99], v[0:3], v[212:215], a[96:99]
v_accvgpr_read_b32 v138, a70
v_accvgpr_read_b32 v139, a71
v_mfma_f32_16x16x32_bf16 a[100:103], v[180:183], v[208:211], a[100:103]
v_cvt_pk_bf16_f32 v56, v136, v137
v_cvt_pk_bf16_f32 v57, v138, v139
v_mfma_f32_16x16x32_bf16 a[100:103], v[32:35], v[212:215], a[100:103]
v_accvgpr_read_b32 v144, a72
v_accvgpr_read_b32 v145, a73
v_mfma_f32_16x16x32_bf16 a[104:107], v[184:187], v[208:211], a[104:107]
v_accvgpr_read_b32 v146, a74
v_accvgpr_read_b32 v147, a75
v_mfma_f32_16x16x32_bf16 a[104:107], v[64:67], v[212:215], a[104:107]
v_cvt_pk_bf16_f32 v88, v144, v145
v_cvt_pk_bf16_f32 v89, v146, v147
v_mfma_f32_16x16x32_bf16 a[108:111], v[188:191], v[208:211], a[108:111]
ds_read_b64_tr_b16 v[208:209], v13 offset:20992
ds_read_b64_tr_b16 v[210:211], v13 offset:23040
v_mfma_f32_16x16x32_bf16 a[108:111], v[96:99], v[212:215], a[108:111]
ds_read_b64_tr_b16 v[212:213], v15 offset:4608
s_waitcnt lgkmcnt(3)
v_mfma_f32_16x16x32_bf16 a[112:115], v[8:11], v[216:219], a[112:115]
ds_read_b64_tr_b16 v[214:215], v15 offset:6656
v_accvgpr_read_b32 v152, a76
v_mfma_f32_16x16x32_bf16 a[112:115], v[160:163], v[220:223], a[112:115]
v_accvgpr_read_b32 v153, a77
v_accvgpr_read_b32 v154, a78
v_mfma_f32_16x16x32_bf16 a[116:119], v[40:43], v[216:219], a[116:119]
v_accvgpr_read_b32 v155, a79
v_cvt_pk_bf16_f32 v120, v152, v153
v_mfma_f32_16x16x32_bf16 a[116:119], v[164:167], v[220:223], a[116:119]
v_cvt_pk_bf16_f32 v121, v154, v155
v_accvgpr_read_b32 v132, a80
v_mfma_f32_16x16x32_bf16 a[120:123], v[72:75], v[216:219], a[120:123]
v_accvgpr_read_b32 v133, a81
v_accvgpr_read_b32 v134, a82
v_mfma_f32_16x16x32_bf16 a[120:123], v[168:171], v[220:223], a[120:123]
v_accvgpr_read_b32 v135, a83
v_cvt_pk_bf16_f32 v26, v132, v133
v_mfma_f32_16x16x32_bf16 a[124:127], v[104:107], v[216:219], a[124:127]
ds_read_b64_tr_b16 v[216:217], v246 offset:8192
ds_read_b64_tr_b16 v[218:219], v246 offset:10240
v_mfma_f32_16x16x32_bf16 a[124:127], v[172:175], v[220:223], a[124:127]
ds_read_b64_tr_b16 v[220:221], v246 offset:24576
s_waitcnt lgkmcnt(3)
v_mfma_f32_16x16x32_bf16 a[112:115], v[176:179], v[208:211], a[112:115]
ds_read_b64_tr_b16 v[222:223], v246 offset:26624
v_cvt_pk_bf16_f32 v27, v134, v135
v_mfma_f32_16x16x32_bf16 a[112:115], v[0:3], v[212:215], a[112:115]
buffer_store_dwordx4 v[24:27], v243, s[20:23], s40 offen offset:2048 sc1
ds_write_b128 v231, v[24:27] offset:2048
v_mfma_f32_16x16x32_bf16 a[116:119], v[180:183], v[208:211], a[116:119]
v_accvgpr_read_b32 v140, a84
v_accvgpr_read_b32 v141, a85
v_mfma_f32_16x16x32_bf16 a[116:119], v[32:35], v[212:215], a[116:119]
v_accvgpr_read_b32 v142, a86
v_accvgpr_read_b32 v143, a87
v_mfma_f32_16x16x32_bf16 a[120:123], v[184:187], v[208:211], a[120:123]
v_cvt_pk_bf16_f32 v58, v140, v141
v_cvt_pk_bf16_f32 v59, v142, v143
v_mfma_f32_16x16x32_bf16 a[120:123], v[64:67], v[212:215], a[120:123]
buffer_store_dwordx4 v[56:59], v243, s[20:23], s41 offen offset:2048 sc1
v_accvgpr_read_b32 v148, a88
v_mfma_f32_16x16x32_bf16 a[124:127], v[188:191], v[208:211], a[124:127]
ds_read_b64_tr_b16 v[208:209], v12 offset:8192
ds_read_b64_tr_b16 v[210:211], v12 offset:10240
v_mfma_f32_16x16x32_bf16 a[124:127], v[96:99], v[212:215], a[124:127]
ds_read_b64_tr_b16 v[212:213], v12 offset:24576
s_waitcnt lgkmcnt(3)
v_mfma_f32_16x16x32_bf16 a[128:131], v[4:7], v[216:219], a[128:131]
ds_read_b64_tr_b16 v[214:215], v12 offset:26624
v_accvgpr_read_b32 v149, a89
v_mfma_f32_16x16x32_bf16 a[128:131], v[8:11], v[220:223], a[128:131]
v_accvgpr_read_b32 v150, a90
v_accvgpr_read_b32 v151, a91
v_mfma_f32_16x16x32_bf16 a[132:135], v[36:39], v[216:219], a[132:135]
v_cvt_pk_bf16_f32 v90, v148, v149
v_cvt_pk_bf16_f32 v91, v150, v151
v_mfma_f32_16x16x32_bf16 a[132:135], v[40:43], v[220:223], a[132:135]
buffer_store_dwordx4 v[88:91], v243, s[20:23], s42 offen offset:2048 sc1
v_accvgpr_read_b32 v156, a92
v_mfma_f32_16x16x32_bf16 a[136:139], v[68:71], v[216:219], a[136:139]
v_accvgpr_read_b32 v157, a93
v_accvgpr_read_b32 v158, a94
v_mfma_f32_16x16x32_bf16 a[136:139], v[72:75], v[220:223], a[136:139]
v_accvgpr_read_b32 v159, a95
v_cvt_pk_bf16_f32 v122, v156, v157
v_mfma_f32_16x16x32_bf16 a[140:143], v[100:103], v[216:219], a[140:143]
ds_read_b64_tr_b16 v[216:217], v14 offset:8192
ds_read_b64_tr_b16 v[218:219], v14 offset:10240
v_mfma_f32_16x16x32_bf16 a[140:143], v[104:107], v[220:223], a[140:143]
ds_read_b64_tr_b16 v[220:221], v247 offset:8192
s_waitcnt lgkmcnt(3)
v_mfma_f32_16x16x32_bf16 a[128:131], v[160:163], v[208:211], a[128:131]
ds_read_b64_tr_b16 v[222:223], v247 offset:10240
v_cvt_pk_bf16_f32 v123, v158, v159
v_mfma_f32_16x16x32_bf16 a[128:131], v[176:179], v[212:215], a[128:131]
buffer_store_dwordx4 v[120:123], v243, s[20:23], s43 offen offset:2048 sc1
v_accvgpr_read_b32 v128, a96
v_mfma_f32_16x16x32_bf16 a[132:135], v[164:167], v[208:211], a[132:135]
v_accvgpr_read_b32 v129, a97
v_accvgpr_read_b32 v130, a98
v_mfma_f32_16x16x32_bf16 a[132:135], v[180:183], v[212:215], a[132:135]
v_accvgpr_read_b32 v131, a99
v_cvt_pk_bf16_f32 v28, v128, v129
v_mfma_f32_16x16x32_bf16 a[136:139], v[168:171], v[208:211], a[136:139]
v_cvt_pk_bf16_f32 v29, v130, v131
v_accvgpr_read_b32 v136, a100
v_mfma_f32_16x16x32_bf16 a[136:139], v[184:187], v[212:215], a[136:139]
v_accvgpr_read_b32 v137, a101
v_accvgpr_read_b32 v138, a102
v_mfma_f32_16x16x32_bf16 a[140:143], v[172:175], v[208:211], a[140:143]
ds_read_b64_tr_b16 v[208:209], v247 offset:24576
ds_read_b64_tr_b16 v[210:211], v247 offset:26624
v_mfma_f32_16x16x32_bf16 a[140:143], v[188:191], v[212:215], a[140:143]
ds_read_b64_tr_b16 v[212:213], v13 offset:8192
s_waitcnt lgkmcnt(5)
v_mfma_f32_16x16x32_bf16 a[128:131], v[0:3], v[216:219], a[128:131]
ds_read_b64_tr_b16 v[214:215], v13 offset:10240
v_accvgpr_read_b32 v139, a103
v_mfma_f32_16x16x32_bf16 a[132:135], v[32:35], v[216:219], a[132:135]
v_cvt_pk_bf16_f32 v60, v136, v137
v_cvt_pk_bf16_f32 v61, v138, v139
v_mfma_f32_16x16x32_bf16 a[136:139], v[64:67], v[216:219], a[136:139]
v_accvgpr_read_b32 v144, a104
v_accvgpr_read_b32 v145, a105
v_mfma_f32_16x16x32_bf16 a[140:143], v[96:99], v[216:219], a[140:143]
ds_read_b64_tr_b16 v[216:217], v13 offset:24576
s_waitcnt lgkmcnt(5)
v_mfma_f32_16x16x32_bf16 a[144:147], v[4:7], v[220:223], a[144:147]
ds_read_b64_tr_b16 v[218:219], v13 offset:26624
v_accvgpr_read_b32 v146, a106
v_mfma_f32_16x16x32_bf16 a[148:151], v[36:39], v[220:223], a[148:151]
v_accvgpr_read_b32 v147, a107
v_cvt_pk_bf16_f32 v92, v144, v145
v_mfma_f32_16x16x32_bf16 a[152:155], v[68:71], v[220:223], a[152:155]
v_cvt_pk_bf16_f32 v93, v146, v147
v_accvgpr_read_b32 v152, a108
v_mfma_f32_16x16x32_bf16 a[156:159], v[100:103], v[220:223], a[156:159]
ds_read_b64_tr_b16 v[220:221], v15 offset:8192
s_waitcnt lgkmcnt(3)
v_mfma_f32_16x16x32_bf16 a[144:147], v[8:11], v[208:211], a[144:147]
ds_read_b64_tr_b16 v[222:223], v15 offset:10240
v_accvgpr_read_b32 v153, a109
v_mfma_f32_16x16x32_bf16 a[144:147], v[160:163], v[212:215], a[144:147]
v_accvgpr_read_b32 v154, a110
v_accvgpr_read_b32 v155, a111
v_mfma_f32_16x16x32_bf16 a[148:151], v[40:43], v[208:211], a[148:151]
v_cvt_pk_bf16_f32 v124, v152, v153
v_cvt_pk_bf16_f32 v125, v154, v155
v_mfma_f32_16x16x32_bf16 a[148:151], v[164:167], v[212:215], a[148:151]
v_accvgpr_read_b32 v132, a112
v_accvgpr_read_b32 v133, a113
v_mfma_f32_16x16x32_bf16 a[152:155], v[72:75], v[208:211], a[152:155]
v_accvgpr_read_b32 v134, a114
v_accvgpr_read_b32 v135, a115
v_mfma_f32_16x16x32_bf16 a[152:155], v[168:171], v[212:215], a[152:155]
v_cvt_pk_bf16_f32 v30, v132, v133
v_cvt_pk_bf16_f32 v31, v134, v135
v_mfma_f32_16x16x32_bf16 a[156:159], v[104:107], v[208:211], a[156:159]
ds_read_b64_tr_b16 v[208:209], v246 offset:8704
ds_read_b64_tr_b16 v[210:211], v246 offset:10752
v_mfma_f32_16x16x32_bf16 a[156:159], v[172:175], v[212:215], a[156:159]
ds_read_b64_tr_b16 v[212:213], v246 offset:25088
s_waitcnt lgkmcnt(3)
v_mfma_f32_16x16x32_bf16 a[144:147], v[176:179], v[216:219], a[144:147]
ds_read_b64_tr_b16 v[214:215], v246 offset:27136
buffer_store_dwordx4 v[28:31], v243, s[20:23], s40 offen offset:3072 sc1
v_mfma_f32_16x16x32_bf16 a[144:147], v[0:3], v[220:223], a[144:147]
ds_write_b128 v231, v[28:31] offset:3072
v_accvgpr_read_b32 v140, a116
v_mfma_f32_16x16x32_bf16 a[148:151], v[180:183], v[216:219], a[148:151]
v_accvgpr_read_b32 v141, a117
v_accvgpr_read_b32 v142, a118
v_mfma_f32_16x16x32_bf16 a[148:151], v[32:35], v[220:223], a[148:151]
v_accvgpr_read_b32 v143, a119
v_cvt_pk_bf16_f32 v62, v140, v141
v_mfma_f32_16x16x32_bf16 a[152:155], v[184:187], v[216:219], a[152:155]
v_cvt_pk_bf16_f32 v63, v142, v143
buffer_store_dwordx4 v[60:63], v243, s[20:23], s41 offen offset:3072 sc1
v_mfma_f32_16x16x32_bf16 a[152:155], v[64:67], v[220:223], a[152:155]
v_accvgpr_read_b32 v148, a120
v_accvgpr_read_b32 v149, a121
v_mfma_f32_16x16x32_bf16 a[156:159], v[188:191], v[216:219], a[156:159]
ds_read_b64_tr_b16 v[216:217], v12 offset:8704
ds_read_b64_tr_b16 v[218:219], v12 offset:10752
v_mfma_f32_16x16x32_bf16 a[156:159], v[96:99], v[220:223], a[156:159]
ds_read_b64_tr_b16 v[220:221], v12 offset:25088
s_waitcnt lgkmcnt(3)
v_mfma_f32_16x16x32_bf16 a[160:163], v[4:7], v[208:211], a[160:163]
ds_read_b64_tr_b16 v[222:223], v12 offset:27136
v_accvgpr_read_b32 v150, a122
v_mfma_f32_16x16x32_bf16 a[160:163], v[8:11], v[212:215], a[160:163]
v_accvgpr_read_b32 v151, a123
v_cvt_pk_bf16_f32 v94, v148, v149
v_mfma_f32_16x16x32_bf16 a[164:167], v[36:39], v[208:211], a[164:167]
v_cvt_pk_bf16_f32 v95, v150, v151
buffer_store_dwordx4 v[92:95], v243, s[20:23], s42 offen offset:3072 sc1
v_mfma_f32_16x16x32_bf16 a[164:167], v[40:43], v[212:215], a[164:167]
v_accvgpr_read_b32 v156, a124
v_accvgpr_read_b32 v157, a125
v_mfma_f32_16x16x32_bf16 a[168:171], v[68:71], v[208:211], a[168:171]
v_accvgpr_read_b32 v158, a126
v_accvgpr_read_b32 v159, a127
v_mfma_f32_16x16x32_bf16 a[168:171], v[72:75], v[212:215], a[168:171]
v_cvt_pk_bf16_f32 v126, v156, v157
v_cvt_pk_bf16_f32 v127, v158, v159
v_mfma_f32_16x16x32_bf16 a[172:175], v[100:103], v[208:211], a[172:175]
ds_read_b64_tr_b16 v[208:209], v14 offset:8704
ds_read_b64_tr_b16 v[210:211], v14 offset:10752
v_mfma_f32_16x16x32_bf16 a[172:175], v[104:107], v[212:215], a[172:175]
ds_read_b64_tr_b16 v[212:213], v247 offset:8704
s_waitcnt lgkmcnt(3)
v_mfma_f32_16x16x32_bf16 a[160:163], v[160:163], v[216:219], a[160:163]
ds_read_b64_tr_b16 v[214:215], v247 offset:10752
buffer_store_dwordx4 v[124:127], v243, s[20:23], s43 offen offset:3072 sc1
v_mfma_f32_16x16x32_bf16 a[160:163], v[176:179], v[220:223], a[160:163]
v_accvgpr_read_b32 v128, a128
v_accvgpr_read_b32 v129, a129
v_mfma_f32_16x16x32_bf16 a[164:167], v[164:167], v[216:219], a[164:167]
v_accvgpr_read_b32 v130, a130
v_accvgpr_read_b32 v131, a131
v_mfma_f32_16x16x32_bf16 a[164:167], v[180:183], v[220:223], a[164:167]
v_cvt_pk_bf16_f32 v16, v128, v129
v_cvt_pk_bf16_f32 v17, v130, v131
v_mfma_f32_16x16x32_bf16 a[168:171], v[168:171], v[216:219], a[168:171]
v_accvgpr_read_b32 v136, a132
v_accvgpr_read_b32 v137, a133
v_mfma_f32_16x16x32_bf16 a[168:171], v[184:187], v[220:223], a[168:171]
v_accvgpr_read_b32 v138, a134
v_accvgpr_read_b32 v139, a135
v_mfma_f32_16x16x32_bf16 a[172:175], v[172:175], v[216:219], a[172:175]
ds_read_b64_tr_b16 v[216:217], v247 offset:25088
ds_read_b64_tr_b16 v[218:219], v247 offset:27136
v_mfma_f32_16x16x32_bf16 a[172:175], v[188:191], v[220:223], a[172:175]
ds_read_b64_tr_b16 v[220:221], v13 offset:8704
s_waitcnt lgkmcnt(5)
v_mfma_f32_16x16x32_bf16 a[160:163], v[0:3], v[208:211], a[160:163]
ds_read_b64_tr_b16 v[222:223], v13 offset:10752
v_cvt_pk_bf16_f32 v48, v136, v137
v_mfma_f32_16x16x32_bf16 a[164:167], v[32:35], v[208:211], a[164:167]
v_cvt_pk_bf16_f32 v49, v138, v139
v_accvgpr_read_b32 v144, a136
v_mfma_f32_16x16x32_bf16 a[168:171], v[64:67], v[208:211], a[168:171]
v_accvgpr_read_b32 v145, a137
v_accvgpr_read_b32 v146, a138
v_mfma_f32_16x16x32_bf16 a[172:175], v[96:99], v[208:211], a[172:175]
ds_read_b64_tr_b16 v[208:209], v13 offset:25088
s_waitcnt lgkmcnt(5)
v_mfma_f32_16x16x32_bf16 a[176:179], v[4:7], v[212:215], a[176:179]
ds_read_b64_tr_b16 v[210:211], v13 offset:27136
v_accvgpr_read_b32 v147, a139
v_mfma_f32_16x16x32_bf16 a[180:183], v[36:39], v[212:215], a[180:183]
v_cvt_pk_bf16_f32 v80, v144, v145
v_cvt_pk_bf16_f32 v81, v146, v147
v_mfma_f32_16x16x32_bf16 a[184:187], v[68:71], v[212:215], a[184:187]
v_accvgpr_read_b32 v152, a140
v_accvgpr_read_b32 v153, a141
v_mfma_f32_16x16x32_bf16 a[188:191], v[100:103], v[212:215], a[188:191]
ds_read_b64_tr_b16 v[212:213], v15 offset:8704
s_waitcnt lgkmcnt(3)
v_mfma_f32_16x16x32_bf16 a[176:179], v[8:11], v[216:219], a[176:179]
ds_read_b64_tr_b16 v[214:215], v15 offset:10752
v_accvgpr_read_b32 v154, a142
v_mfma_f32_16x16x32_bf16 a[176:179], v[160:163], v[220:223], a[176:179]
v_accvgpr_read_b32 v155, a143
v_cvt_pk_bf16_f32 v112, v152, v153
v_mfma_f32_16x16x32_bf16 a[180:183], v[40:43], v[216:219], a[180:183]
v_cvt_pk_bf16_f32 v113, v154, v155
v_accvgpr_read_b32 v132, a144
v_mfma_f32_16x16x32_bf16 a[180:183], v[164:167], v[220:223], a[180:183]
v_accvgpr_read_b32 v133, a145
v_accvgpr_read_b32 v134, a146
v_mfma_f32_16x16x32_bf16 a[184:187], v[72:75], v[216:219], a[184:187]
v_accvgpr_read_b32 v135, a147
v_cvt_pk_bf16_f32 v18, v132, v133
v_mfma_f32_16x16x32_bf16 a[184:187], v[168:171], v[220:223], a[184:187]
v_cvt_pk_bf16_f32 v19, v134, v135
buffer_store_dwordx4 v[16:19], v243, s[20:23], s44 offen offset:0 sc1
v_mfma_f32_16x16x32_bf16 a[188:191], v[104:107], v[216:219], a[188:191]
ds_read_b64_tr_b16 v[216:217], v246 offset:12288
ds_read_b64_tr_b16 v[218:219], v246 offset:14336
v_mfma_f32_16x16x32_bf16 a[188:191], v[172:175], v[220:223], a[188:191]
ds_read_b64_tr_b16 v[220:221], v246 offset:28672
s_waitcnt lgkmcnt(3)
v_mfma_f32_16x16x32_bf16 a[176:179], v[176:179], v[208:211], a[176:179]
ds_read_b64_tr_b16 v[222:223], v246 offset:30720
ds_write_b128 v231, v[16:19] offset:4096
v_mfma_f32_16x16x32_bf16 a[176:179], v[0:3], v[212:215], a[176:179]
v_accvgpr_read_b32 v140, a148
v_accvgpr_read_b32 v141, a149
v_mfma_f32_16x16x32_bf16 a[180:183], v[180:183], v[208:211], a[180:183]
v_accvgpr_read_b32 v142, a150
v_accvgpr_read_b32 v143, a151
v_mfma_f32_16x16x32_bf16 a[180:183], v[32:35], v[212:215], a[180:183]
v_cvt_pk_bf16_f32 v50, v140, v141
v_cvt_pk_bf16_f32 v51, v142, v143
v_mfma_f32_16x16x32_bf16 a[184:187], v[184:187], v[208:211], a[184:187]
buffer_store_dwordx4 v[48:51], v243, s[20:23], s45 offen offset:0 sc1
v_accvgpr_read_b32 v148, a152
v_mfma_f32_16x16x32_bf16 a[184:187], v[64:67], v[212:215], a[184:187]
v_accvgpr_read_b32 v149, a153
v_accvgpr_read_b32 v150, a154
v_mfma_f32_16x16x32_bf16 a[188:191], v[188:191], v[208:211], a[188:191]
ds_read_b64_tr_b16 v[208:209], v12 offset:12288
ds_read_b64_tr_b16 v[210:211], v12 offset:14336
v_mfma_f32_16x16x32_bf16 a[188:191], v[96:99], v[212:215], a[188:191]
ds_read_b64_tr_b16 v[212:213], v12 offset:28672
s_waitcnt lgkmcnt(3)
v_mfma_f32_16x16x32_bf16 a[192:195], v[4:7], v[216:219], a[192:195]
ds_read_b64_tr_b16 v[214:215], v12 offset:30720
v_accvgpr_read_b32 v151, a155
v_mfma_f32_16x16x32_bf16 a[192:195], v[8:11], v[220:223], a[192:195]
v_cvt_pk_bf16_f32 v82, v148, v149
v_cvt_pk_bf16_f32 v83, v150, v151
v_mfma_f32_16x16x32_bf16 a[196:199], v[36:39], v[216:219], a[196:199]
buffer_store_dwordx4 v[80:83], v243, s[20:23], s46 offen offset:0 sc1
v_accvgpr_read_b32 v156, a156
v_mfma_f32_16x16x32_bf16 a[196:199], v[40:43], v[220:223], a[196:199]
v_accvgpr_read_b32 v157, a157
v_accvgpr_read_b32 v158, a158
v_mfma_f32_16x16x32_bf16 a[200:203], v[68:71], v[216:219], a[200:203]
v_accvgpr_read_b32 v159, a159
v_cvt_pk_bf16_f32 v114, v156, v157
v_mfma_f32_16x16x32_bf16 a[200:203], v[72:75], v[220:223], a[200:203]
v_cvt_pk_bf16_f32 v115, v158, v159
buffer_store_dwordx4 v[112:115], v243, s[20:23], s47 offen offset:0 sc1
v_mfma_f32_16x16x32_bf16 a[204:207], v[100:103], v[216:219], a[204:207]
ds_read_b64_tr_b16 v[216:217], v14 offset:12288
ds_read_b64_tr_b16 v[218:219], v14 offset:14336
v_mfma_f32_16x16x32_bf16 a[204:207], v[104:107], v[220:223], a[204:207]
ds_read_b64_tr_b16 v[220:221], v247 offset:12288
s_waitcnt lgkmcnt(3)
v_mfma_f32_16x16x32_bf16 a[192:195], v[160:163], v[208:211], a[192:195]
ds_read_b64_tr_b16 v[222:223], v247 offset:14336
v_accvgpr_read_b32 v128, a160
v_mfma_f32_16x16x32_bf16 a[192:195], v[176:179], v[212:215], a[192:195]
v_accvgpr_read_b32 v129, a161
v_accvgpr_read_b32 v130, a162
v_mfma_f32_16x16x32_bf16 a[196:199], v[164:167], v[208:211], a[196:199]
v_accvgpr_read_b32 v131, a163
v_cvt_pk_bf16_f32 v20, v128, v129
v_mfma_f32_16x16x32_bf16 a[196:199], v[180:183], v[212:215], a[196:199]
v_cvt_pk_bf16_f32 v21, v130, v131
v_accvgpr_read_b32 v136, a164
v_mfma_f32_16x16x32_bf16 a[200:203], v[168:171], v[208:211], a[200:203]
v_accvgpr_read_b32 v137, a165
v_accvgpr_read_b32 v138, a166
v_mfma_f32_16x16x32_bf16 a[200:203], v[184:187], v[212:215], a[200:203]
v_accvgpr_read_b32 v139, a167
v_cvt_pk_bf16_f32 v52, v136, v137
v_mfma_f32_16x16x32_bf16 a[204:207], v[172:175], v[208:211], a[204:207]
ds_read_b64_tr_b16 v[208:209], v247 offset:28672
ds_read_b64_tr_b16 v[210:211], v247 offset:30720
v_mfma_f32_16x16x32_bf16 a[204:207], v[188:191], v[212:215], a[204:207]
ds_read_b64_tr_b16 v[212:213], v13 offset:12288
s_waitcnt lgkmcnt(5)
v_mfma_f32_16x16x32_bf16 a[192:195], v[0:3], v[216:219], a[192:195]
ds_read_b64_tr_b16 v[214:215], v13 offset:14336
v_cvt_pk_bf16_f32 v53, v138, v139
v_mfma_f32_16x16x32_bf16 a[196:199], v[32:35], v[216:219], a[196:199]
v_accvgpr_read_b32 v144, a168
v_accvgpr_read_b32 v145, a169
v_mfma_f32_16x16x32_bf16 a[200:203], v[64:67], v[216:219], a[200:203]
v_accvgpr_read_b32 v146, a170
v_accvgpr_read_b32 v147, a171
v_mfma_f32_16x16x32_bf16 a[204:207], v[96:99], v[216:219], a[204:207]
ds_read_b64_tr_b16 v[216:217], v13 offset:28672
s_waitcnt lgkmcnt(5)
v_mfma_f32_16x16x32_bf16 a[208:211], v[4:7], v[220:223], a[208:211]
ds_read_b64_tr_b16 v[218:219], v13 offset:30720
v_cvt_pk_bf16_f32 v84, v144, v145
v_mfma_f32_16x16x32_bf16 a[212:215], v[36:39], v[220:223], a[212:215]
v_cvt_pk_bf16_f32 v85, v146, v147
v_accvgpr_read_b32 v152, a172
v_mfma_f32_16x16x32_bf16 a[216:219], v[68:71], v[220:223], a[216:219]
v_accvgpr_read_b32 v153, a173
v_accvgpr_read_b32 v154, a174
v_mfma_f32_16x16x32_bf16 a[220:223], v[100:103], v[220:223], a[220:223]
ds_read_b64_tr_b16 v[220:221], v15 offset:12288
s_waitcnt lgkmcnt(3)
v_mfma_f32_16x16x32_bf16 a[208:211], v[8:11], v[208:211], a[208:211]
ds_read_b64_tr_b16 v[222:223], v15 offset:14336
v_accvgpr_read_b32 v155, a175
v_mfma_f32_16x16x32_bf16 a[208:211], v[160:163], v[212:215], a[208:211]
v_cvt_pk_bf16_f32 v116, v152, v153
v_cvt_pk_bf16_f32 v117, v154, v155
v_mfma_f32_16x16x32_bf16 a[212:215], v[40:43], v[208:211], a[212:215]
v_accvgpr_read_b32 v132, a176
v_accvgpr_read_b32 v133, a177
v_mfma_f32_16x16x32_bf16 a[212:215], v[164:167], v[212:215], a[212:215]
v_accvgpr_read_b32 v134, a178
v_accvgpr_read_b32 v135, a179
v_mfma_f32_16x16x32_bf16 a[216:219], v[72:75], v[208:211], a[216:219]
v_cvt_pk_bf16_f32 v22, v132, v133
v_cvt_pk_bf16_f32 v23, v134, v135
v_mfma_f32_16x16x32_bf16 a[216:219], v[168:171], v[212:215], a[216:219]
buffer_store_dwordx4 v[20:23], v243, s[20:23], s44 offen offset:1024 sc1
ds_write_b128 v231, v[20:23] offset:5120
v_mfma_f32_16x16x32_bf16 a[220:223], v[104:107], v[208:211], a[220:223]
v_accvgpr_read_b32 v140, a180
v_accvgpr_read_b32 v141, a181
v_mfma_f32_16x16x32_bf16 a[220:223], v[172:175], v[212:215], a[220:223]
s_waitcnt lgkmcnt(0)
v_accvgpr_read_b32 v142, a182
v_mfma_f32_16x16x32_bf16 a[208:211], v[176:179], v[216:219], a[208:211]
v_accvgpr_read_b32 v143, a183
v_cvt_pk_bf16_f32 v54, v140, v141
v_mfma_f32_16x16x32_bf16 a[208:211], v[0:3], v[220:223], a[208:211]
v_cvt_pk_bf16_f32 v55, v142, v143
buffer_store_dwordx4 v[52:55], v243, s[20:23], s45 offen offset:1024 sc1
v_mfma_f32_16x16x32_bf16 a[212:215], v[180:183], v[216:219], a[212:215]
v_accvgpr_read_b32 v148, a184
v_accvgpr_read_b32 v149, a185
v_mfma_f32_16x16x32_bf16 a[212:215], v[32:35], v[220:223], a[212:215]
v_accvgpr_read_b32 v150, a186
v_accvgpr_read_b32 v151, a187
v_mfma_f32_16x16x32_bf16 a[216:219], v[184:187], v[216:219], a[216:219]
v_cvt_pk_bf16_f32 v86, v148, v149
v_cvt_pk_bf16_f32 v87, v150, v151
v_mfma_f32_16x16x32_bf16 a[216:219], v[64:67], v[220:223], a[216:219]
buffer_store_dwordx4 v[84:87], v243, s[20:23], s46 offen offset:1024 sc1
v_accvgpr_read_b32 v156, a188
v_mfma_f32_16x16x32_bf16 a[220:223], v[188:191], v[216:219], a[220:223]
v_accvgpr_read_b32 v157, a189
v_accvgpr_read_b32 v158, a190
v_mfma_f32_16x16x32_bf16 a[220:223], v[96:99], v[220:223], a[220:223]
v_accvgpr_read_b32 v159, a191
v_cvt_pk_bf16_f32 v118, v156, v157
v_cvt_pk_bf16_f32 v119, v158, v159
buffer_store_dwordx4 v[116:119], v243, s[20:23], s47 offen offset:1024 sc1
v_accvgpr_read_b32 v128, a192
v_accvgpr_read_b32 v129, a193
v_accvgpr_read_b32 v130, a194
v_accvgpr_read_b32 v131, a195
v_cvt_pk_bf16_f32 v24, v128, v129
v_cvt_pk_bf16_f32 v25, v130, v131
v_accvgpr_read_b32 v136, a196
v_accvgpr_read_b32 v137, a197
v_accvgpr_read_b32 v138, a198
v_accvgpr_read_b32 v139, a199
v_cvt_pk_bf16_f32 v56, v136, v137
v_cvt_pk_bf16_f32 v57, v138, v139
v_accvgpr_read_b32 v144, a200
v_accvgpr_read_b32 v145, a201
v_accvgpr_read_b32 v146, a202
v_accvgpr_read_b32 v147, a203
v_cvt_pk_bf16_f32 v88, v144, v145
v_cvt_pk_bf16_f32 v89, v146, v147
v_accvgpr_read_b32 v152, a204
v_accvgpr_read_b32 v153, a205
v_accvgpr_read_b32 v154, a206
v_accvgpr_read_b32 v155, a207
v_cvt_pk_bf16_f32 v120, v152, v153
v_cvt_pk_bf16_f32 v121, v154, v155
v_accvgpr_read_b32 v132, a208
v_accvgpr_read_b32 v133, a209
v_accvgpr_read_b32 v134, a210
v_accvgpr_read_b32 v135, a211
v_cvt_pk_bf16_f32 v26, v132, v133
v_cvt_pk_bf16_f32 v27, v134, v135
buffer_store_dwordx4 v[24:27], v243, s[20:23], s44 offen offset:2048 sc1
ds_write_b128 v231, v[24:27] offset:6144
v_accvgpr_read_b32 v140, a212
v_accvgpr_read_b32 v141, a213
v_accvgpr_read_b32 v142, a214
v_accvgpr_read_b32 v143, a215
v_cvt_pk_bf16_f32 v58, v140, v141
v_cvt_pk_bf16_f32 v59, v142, v143
buffer_store_dwordx4 v[56:59], v243, s[20:23], s45 offen offset:2048 sc1
v_accvgpr_read_b32 v148, a216
v_accvgpr_read_b32 v149, a217
v_accvgpr_read_b32 v150, a218
v_accvgpr_read_b32 v151, a219
v_cvt_pk_bf16_f32 v90, v148, v149
v_cvt_pk_bf16_f32 v91, v150, v151
buffer_store_dwordx4 v[88:91], v243, s[20:23], s46 offen offset:2048 sc1
v_accvgpr_read_b32 v156, a220
v_accvgpr_read_b32 v157, a221
v_accvgpr_read_b32 v158, a222
v_accvgpr_read_b32 v159, a223
v_cvt_pk_bf16_f32 v122, v156, v157
v_cvt_pk_bf16_f32 v123, v158, v159
buffer_store_dwordx4 v[120:123], v243, s[20:23], s47 offen offset:2048 sc1
s_waitcnt vmcnt(36)
s_branch L2_F
L2_F:
v_cmp_ne_u64 vcc, s[98:99], v[108:109]
s_lshl_b32 s3, s34, 15
s_add_u32 s3, s3, 0x1000000
s_cbranch_vccnz LF_wf
LF_wf_go:
v_add_u32 v240, s3, v243
v_add_u32 v241, 0x4000, v240
s_mov_b32 s32, 0x0
s_mov_b32 s33, 0x1000
s_mov_b32 s35, 0x2000
s_mov_b32 s36, 0x3000
s_mov_b32 s38, 0x20000
s_mov_b32 s39, 0x21000
s_mov_b32 s40, 0x22000
s_mov_b32 s41, 0x23000
s_lshr_b32 s42, s6, 13
s_lshr_b32 s43, s7, 13
s_lshr_b32 s44, s29, 13
v_mov_b32 v244, s42
v_mov_b32 v232, s43
v_cmp_lt_u32 vcc, 0xff, v243
v_mov_b32 v233, s44
s_nop 0
v_cndmask_b32 v244, v244, v232, vcc
v_cmp_lt_u32 vcc, 0x1ff, v243
v_and_b32 v235, 0xf0, v243
s_nop 0
v_cndmask_b32 v244, v244, v233, vcc
v_lshrrev_b32 v232, 3, v235
v_lshl_add_u32 v79, v244, 5, v232
buffer_load_ushort v79, v79, s[52:55], 0 offen
buffer_load_dwordx4 a[0:3], v240, s[16:19], s32 offen offset:0 sc1
buffer_load_dwordx4 a[4:7], v240, s[16:19], s32 offen offset:1024 sc1
buffer_load_dwordx4 a[8:11], v241, s[16:19], s32 offen offset:0 sc1
buffer_load_dwordx4 a[12:15], v241, s[16:19], s32 offen offset:1024 sc1
buffer_load_dwordx4 a[16:19], v240, s[16:19], s32 offen offset:2048 sc1
buffer_load_dwordx4 a[20:23], v240, s[16:19], s32 offen offset:3072 sc1
buffer_load_dwordx4 a[24:27], v241, s[16:19], s32 offen offset:2048 sc1
buffer_load_dwordx4 a[28:31], v241, s[16:19], s32 offen offset:3072 sc1
buffer_load_dwordx4 a[32:35], v240, s[16:19], s33 offen offset:0 sc1
buffer_load_dwordx4 a[36:39], v240, s[16:19], s33 offen offset:1024 sc1
buffer_load_dwordx4 a[40:43], v241, s[16:19], s33 offen offset:0 sc1
buffer_load_dwordx4 a[44:47], v241, s[16:19], s33 offen offset:1024 sc1
s_lshl_b32 s3, s37, 7
v_lshl_add_u32 v244, v244, 11, s3
v_lshl_add_u32 v244, v232, 2, v244
s_cmp_ge_u32 s29, 0x70000000
s_cselect_b32 s44, s43, s44
v_mov_b32 v46, s42
v_mov_b32 v232, s43
v_lshrrev_b32 v233, 7, v243
v_cmp_lt_u32_e64 vcc, 0, v233
s_nop 1
v_cndmask_b32_e64 v46, v46, v232, vcc
v_cmp_lt_u32_e64 vcc, 1, v233
v_mov_b32 v233, s44
v_bfe_u32 v232, v243, 4, 3
v_cndmask_b32_e64 v46, v46, v233, vcc
v_min_u32 v232, 5, v232
v_lshrrev_b32 v46, 2, v46
v_lshl_add_u32 v46, v46, 3, v232
v_lshlrev_b32 v46, 7, v46
v_add_u32 v46, 0x7c00000, v46
s_lshl_b32 s49, s34, 10
s_add_u32 s49, s49, 0x20000
s_bfe_u32 s3, s6, 0x2000f
s_lshl_b32 s3, s3, 13
s_add_u32 s3, s3, s49
v_add_u32 v76, s3, v243
s_bfe_u32 s3, s7, 0x2000f
s_lshl_b32 s3, s3, 13
s_add_u32 s3, s3, s49
v_add_u32 v77, s3, v243
s_bfe_u32 s3, s29, 0x2000f
s_lshl_b32 s3, s3, 13
s_add_u32 s3, s3, s49
v_add_u32 v78, s3, v243
s_add_u32 s3, s37, 1
s_sub_u32 s49, s3, 6
s_cselect_b32 s3, s3, s49
s_mul_i32 s3, s3, 0x600000
s_add_u32 s42, s3, 0x2000000
s_add_u32 s3, s37, 2
s_sub_u32 s49, s3, 6
s_cselect_b32 s3, s3, s49
s_mul_i32 s3, s3, 0x600000
s_add_u32 s43, s3, 0x2000000
s_add_u32 s3, s37, 3
s_sub_u32 s49, s3, 6
s_cselect_b32 s3, s3, s49
s_mul_i32 s3, s3, 0x600000
s_add_u32 s44, s3, 0x2000000
s_add_u32 s3, s37, 4
s_sub_u32 s49, s3, 6
s_cselect_b32 s3, s3, s49
s_mul_i32 s3, s3, 0x600000
s_add_u32 s45, s3, 0x2000000
s_add_u32 s3, s37, 5
s_sub_u32 s49, s3, 6
s_cselect_b32 s3, s3, s49
s_mul_i32 s3, s3, 0x600000
s_add_u32 s46, s3, 0x2000000
s_add_u32 s3, s37, 6
s_sub_u32 s49, s3, 6
s_cselect_b32 s3, s3, s49
s_mul_i32 s3, s3, 0x600000
s_add_u32 s47, s3, 0x2000000
s_mul_i32 s3, s34, 896
v_add_u32 v47, s3, v243
v_add_u32 v43, 0x1000, v47
v_lshrrev_b32 v44, 4, v243
v_and_b32 v44, 0x30, v44
v_xor_b32 v44, v44, v243
v_and_b32 v232, 0x380, v243
v_mad_u32_u24 v44, v232, 3, v44
v_xor_b32 v45, 0x1040, v44
v_bfe_u32 v232, v243, 5, 3
v_lshrrev_b32 v234, 8, v243
v_xor_b32 v232, v232, v234
v_bfe_u32 v233, v243, 4, 3
v_lshlrev_b32 v233, 7, v233
v_lshl_or_b32 v232, v232, 4, v233
v_bfe_u32 v233, v243, 7, 1
s_lshl_b32 s49, s34, 10
s_sub_u32 s3, s28, s49
v_lshl_add_u32 v74, v233, 12, v232
v_add_u32 v72, s3, v74
s_sub_u32 s3, s30, s49
v_add_u32 v74, s3, v74
v_xor_b32 v73, 64, v72
v_xor_b32 v75, 64, v74
v_lshl_add_u32 v245, v233, 10, v232
v_add_u32 v245, s31, v245
v_xor_b32 v246, 64, v245
v_add_u32 v247, s31, v243
s_add_u32 s3, s3, 0xa000
s_and_b32 s3, s3, 0x1ffff
v_add_u32 v252, s3, v243
v_add_u32 v251, s49, v252
s_lshl_b32 s49, s34, 11
s_add_u32 s3, s3, s49
s_add_u32 s3, s3, 24576
v_lshl_add_u32 v242, v243, 1, s3
v_lshl_add_u32 v250, v235, 1, s3
v_lshrrev_b32 v232, 4, v235
v_lshlrev_b32 v234, 2, v234
v_sub_u32 v232, v232, v234
v_and_b32 v233, 1, v232
v_lshlrev_b32 v233, 4, v233
v_mov_b32 v234, 0xffff
v_lshlrev_b32 v233, v233, v234
v_lshrrev_b32 v232, 1, v232
v_cmp_eq_u32 vcc, 0, v232
s_nop 1
v_cndmask_b32 v156, 0, v233, vcc
v_cmp_eq_u32 vcc, 1, v232
s_nop 1
v_cndmask_b32 v157, 0, v233, vcc
s_mov_b32 s95, 0xffff0000
s_waitcnt vmcnt(13)
v_mov_b32 v36, s98
v_mov_b32 v37, s99
v_mov_b32 v38, s98
v_mov_b32 v39, s99
s_mov_b64 exec, 0xff
buffer_store_dwordx4 v[36:39], v243, s[16:19], s51 offen sc1
s_mov_b64 exec, -1
s_waitcnt lgkmcnt(0)
s_barrier
ds_read_b128 v[208:211], v72 offset:0
ds_read_b128 v[212:215], v72 offset:8192
ds_read_b128 v[216:219], v74 offset:0
ds_read_b128 v[220:223], v73 offset:0
ds_read_b128 v[224:227], v73 offset:8192
ds_read_b128 v[104:107], v245 offset:0
ds_read_b128 v[108:111], v246 offset:0
ds_read_b128 v[152:155], v245 offset:2048
s_waitcnt vmcnt(13)
v_lshlrev_b32 v79, 16, v79
ds_write_b32 v242, v79 offset:28
ds_read_b32 v253, v250 offset:28
ds_read_b32 v254, v250 offset:540
ds_read_b32 v255, v250 offset:1052
s_waitcnt vmcnt(12)
buffer_load_dwordx4 a[48:51], v240, s[16:19], s33 offen offset:2048 sc1
s_waitcnt vmcnt(12)
buffer_load_dwordx4 a[52:55], v240, s[16:19], s33 offen offset:3072 sc1
s_waitcnt vmcnt(12)
buffer_load_dwordx4 a[56:59], v241, s[16:19], s33 offen offset:2048 sc1
s_waitcnt vmcnt(12)
s_waitcnt lgkmcnt(11)
v_mfma_f32_16x16x32_bf16 v[160:163], a[0:3], v[208:211], 0
ds_read_b128 v[228:231], v75 offset:0
buffer_load_dwordx4 a[60:63], v241, s[16:19], s33 offen offset:3072 sc1
v_mfma_f32_16x16x32_bf16 v[164:167], a[4:7], v[208:211], 0
v_mfma_f32_16x16x32_bf16 v[168:171], a[8:11], v[208:211], 0
v_mfma_f32_16x16x32_bf16 v[172:175], a[12:15], v[208:211], 0
s_waitcnt vmcnt(12)
s_waitcnt lgkmcnt(11)
v_mfma_f32_16x16x32_bf16 v[176:179], a[0:3], v[212:215], 0
ds_read_b128 v[208:211], v72 offset:1024
buffer_load_dwordx4 a[64:67], v240, s[16:19], s35 offen offset:0 sc1
v_mfma_f32_16x16x32_bf16 v[180:183], a[4:7], v[212:215], 0
v_mfma_f32_16x16x32_bf16 v[184:187], a[8:11], v[212:215], 0
v_mfma_f32_16x16x32_bf16 v[188:191], a[12:15], v[212:215], 0
s_waitcnt vmcnt(12)
s_waitcnt lgkmcnt(11)
v_mfma_f32_16x16x32_bf16 v[192:195], a[0:3], v[216:219], 0
ds_read_b128 v[212:215], v72 offset:9216
buffer_load_dwordx4 a[68:71], v240, s[16:19], s35 offen offset:1024 sc1
v_mfma_f32_16x16x32_bf16 v[196:199], a[4:7], v[216:219], 0
v_mfma_f32_16x16x32_bf16 v[200:203], a[8:11], v[216:219], 0
v_mfma_f32_16x16x32_bf16 v[204:207], a[12:15], v[216:219], 0
s_waitcnt vmcnt(12)
buffer_load_dwordx4 a[72:75], v241, s[16:19], s35 offen offset:0 sc1
s_waitcnt vmcnt(12)
s_waitcnt lgkmcnt(11)
v_mfma_f32_16x16x32_bf16 v[160:163], a[16:19], v[220:223], v[160:163]
ds_read_b128 v[216:219], v74 offset:1024
buffer_load_dwordx4 a[76:79], v241, s[16:19], s35 offen offset:1024 sc1
v_mfma_f32_16x16x32_bf16 v[164:167], a[20:23], v[220:223], v[164:167]
v_mfma_f32_16x16x32_bf16 v[168:171], a[24:27], v[220:223], v[168:171]
v_mfma_f32_16x16x32_bf16 v[172:175], a[28:31], v[220:223], v[172:175]
s_waitcnt vmcnt(12)
s_waitcnt lgkmcnt(11)
v_mfma_f32_16x16x32_bf16 v[176:179], a[16:19], v[224:227], v[176:179]
ds_read_b128 v[220:223], v73 offset:1024
buffer_load_dwordx4 a[80:83], v240, s[16:19], s35 offen offset:2048 sc1
v_mfma_f32_16x16x32_bf16 v[180:183], a[20:23], v[224:227], v[180:183]
v_mfma_f32_16x16x32_bf16 v[184:187], a[24:27], v[224:227], v[184:187]
v_mfma_f32_16x16x32_bf16 v[188:191], a[28:31], v[224:227], v[188:191]
s_waitcnt vmcnt(12)
s_waitcnt lgkmcnt(4)
v_mfma_f32_16x16x32_bf16 v[192:195], a[16:19], v[228:231], v[192:195]
ds_read_b128 v[224:227], v73 offset:9216
buffer_load_dwordx4 a[84:87], v240, s[16:19], s35 offen offset:3072 sc1
v_mfma_f32_16x16x32_bf16 v[196:199], a[20:23], v[228:231], v[196:199]
v_mfma_f32_16x16x32_bf16 v[200:203], a[24:27], v[228:231], v[200:203]
v_mfma_f32_16x16x32_bf16 v[204:207], a[28:31], v[228:231], v[204:207]
s_waitcnt vmcnt(12)
buffer_load_dwordx4 a[88:91], v241, s[16:19], s35 offen offset:2048 sc1
s_waitcnt vmcnt(12)
s_waitcnt lgkmcnt(4)
v_mfma_f32_16x16x32_bf16 v[160:163], a[32:35], v[208:211], v[160:163]
ds_read_b128 v[228:231], v75 offset:1024
buffer_load_dwordx4 a[92:95], v241, s[16:19], s35 offen offset:3072 sc1
v_mfma_f32_16x16x32_bf16 v[164:167], a[36:39], v[208:211], v[164:167]
v_mfma_f32_16x16x32_bf16 v[168:171], a[40:43], v[208:211], v[168:171]
v_mfma_f32_16x16x32_bf16 v[172:175], a[44:47], v[208:211], v[172:175]
s_waitcnt lgkmcnt(4)
v_mfma_f32_16x16x32_bf16 v[176:179], a[32:35], v[212:215], v[176:179]
ds_read_b128 v[208:211], v72 offset:2048
v_mfma_f32_16x16x32_bf16 v[180:183], a[36:39], v[212:215], v[180:183]
v_mfma_f32_16x16x32_bf16 v[184:187], a[40:43], v[212:215], v[184:187]
v_mfma_f32_16x16x32_bf16 v[188:191], a[44:47], v[212:215], v[188:191]
s_waitcnt vmcnt(11)
s_waitcnt lgkmcnt(4)
v_mfma_f32_16x16x32_bf16 v[192:195], a[32:35], v[216:219], v[192:195]
ds_read_b128 v[212:215], v72 offset:10240
buffer_load_dwordx2 v[248:249], v46, s[16:19], 0 offen offset:0 sc1
v_mfma_f32_16x16x32_bf16 v[196:199], a[36:39], v[216:219], v[196:199]
v_mfma_f32_16x16x32_bf16 v[200:203], a[40:43], v[216:219], v[200:203]
v_mfma_f32_16x16x32_bf16 v[204:207], a[44:47], v[216:219], v[204:207]
s_waitcnt vmcnt(11)
buffer_load_dwordx4 a[96:99], v240, s[16:19], s36 offen offset:0 sc1
s_waitcnt vmcnt(11)
buffer_load_dwordx4 a[100:103], v240, s[16:19], s36 offen offset:1024 sc1
s_waitcnt vmcnt(11)
s_waitcnt lgkmcnt(4)
v_mfma_f32_16x16x32_bf16 v[160:163], a[48:51], v[220:223], v[160:163]
ds_read_b128 v[216:219], v74 offset:2048
buffer_load_dwordx4 a[104:107], v241, s[16:19], s36 offen offset:0 sc1
v_mfma_f32_16x16x32_bf16 v[164:167], a[52:55], v[220:223], v[164:167]
v_mfma_f32_16x16x32_bf16 v[168:171], a[56:59], v[220:223], v[168:171]
v_mfma_f32_16x16x32_bf16 v[172:175], a[60:63], v[220:223], v[172:175]
s_waitcnt vmcnt(11)
s_waitcnt lgkmcnt(4)
v_mfma_f32_16x16x32_bf16 v[176:179], a[48:51], v[224:227], v[176:179]
ds_read_b128 v[220:223], v73 offset:2048
buffer_load_dwordx4 a[108:111], v241, s[16:19], s36 offen offset:1024 sc1
v_mfma_f32_16x16x32_bf16 v[180:183], a[52:55], v[224:227], v[180:183]
v_mfma_f32_16x16x32_bf16 v[184:187], a[56:59], v[224:227], v[184:187]
v_mfma_f32_16x16x32_bf16 v[188:191], a[60:63], v[224:227], v[188:191]
s_waitcnt vmcnt(11)
s_waitcnt lgkmcnt(4)
v_mfma_f32_16x16x32_bf16 v[192:195], a[48:51], v[228:231], v[192:195]
ds_read_b128 v[224:227], v73 offset:10240
buffer_load_dwordx4 a[112:115], v240, s[16:19], s36 offen offset:2048 sc1
v_mfma_f32_16x16x32_bf16 v[196:199], a[52:55], v[228:231], v[196:199]
v_mfma_f32_16x16x32_bf16 v[200:203], a[56:59], v[228:231], v[200:203]
v_mfma_f32_16x16x32_bf16 v[204:207], a[60:63], v[228:231], v[204:207]
s_waitcnt vmcnt(11)
buffer_load_dwordx4 a[116:119], v240, s[16:19], s36 offen offset:3072 sc1
s_waitcnt vmcnt(11)
s_waitcnt lgkmcnt(4)
v_mfma_f32_16x16x32_bf16 v[160:163], a[64:67], v[208:211], v[160:163]
ds_read_b128 v[228:231], v75 offset:2048
buffer_load_dwordx4 a[120:123], v241, s[16:19], s36 offen offset:2048 sc1
v_mfma_f32_16x16x32_bf16 v[164:167], a[68:71], v[208:211], v[164:167]
v_mfma_f32_16x16x32_bf16 v[168:171], a[72:75], v[208:211], v[168:171]
v_mfma_f32_16x16x32_bf16 v[172:175], a[76:79], v[208:211], v[172:175]
s_waitcnt vmcnt(11)
s_waitcnt lgkmcnt(4)
v_mfma_f32_16x16x32_bf16 v[176:179], a[64:67], v[212:215], v[176:179]
ds_read_b128 v[208:211], v72 offset:3072
buffer_load_dwordx4 a[124:127], v241, s[16:19], s36 offen offset:3072 sc1
v_mfma_f32_16x16x32_bf16 v[180:183], a[68:71], v[212:215], v[180:183]
v_mfma_f32_16x16x32_bf16 v[184:187], a[72:75], v[212:215], v[184:187]
v_mfma_f32_16x16x32_bf16 v[188:191], a[76:79], v[212:215], v[188:191]
s_waitcnt vmcnt(11)
s_waitcnt lgkmcnt(4)
v_mfma_f32_16x16x32_bf16 v[192:195], a[64:67], v[216:219], v[192:195]
ds_read_b128 v[212:215], v72 offset:11264
v_mfma_f32_16x16x32_bf16 v[196:199], a[68:71], v[216:219], v[196:199]
v_mfma_f32_16x16x32_bf16 v[200:203], a[72:75], v[216:219], v[200:203]
v_mfma_f32_16x16x32_bf16 v[204:207], a[76:79], v[216:219], v[204:207]
s_waitcnt vmcnt(10)
s_waitcnt vmcnt(9)
s_waitcnt lgkmcnt(4)
v_mfma_f32_16x16x32_bf16 v[160:163], a[80:83], v[220:223], v[160:163]
ds_read_b128 v[216:219], v74 offset:3072
v_mfma_f32_16x16x32_bf16 v[164:167], a[84:87], v[220:223], v[164:167]
v_mfma_f32_16x16x32_bf16 v[168:171], a[88:91], v[220:223], v[168:171]
v_mfma_f32_16x16x32_bf16 v[172:175], a[92:95], v[220:223], v[172:175]
s_waitcnt vmcnt(8)
s_waitcnt lgkmcnt(4)
v_mfma_f32_16x16x32_bf16 v[176:179], a[80:83], v[224:227], v[176:179]
ds_read_b128 v[220:223], v73 offset:3072
v_cmp_ne_u64 vcc, s[98:99], v[248:249]
s_nop 1
s_cbranch_vccnz LF_spinQ
LF_goQ:
v_mfma_f32_16x16x32_bf16 v[180:183], a[84:87], v[224:227], v[180:183]
buffer_load_dwordx2 v[128:129], v244, s[24:27], 0 offen offset:128 sc1
v_mfma_f32_16x16x32_bf16 v[184:187], a[88:91], v[224:227], v[184:187]
buffer_load_dwordx2 v[130:131], v244, s[24:27], 0 offen offset:256 sc1
v_mfma_f32_16x16x32_bf16 v[188:191], a[92:95], v[224:227], v[188:191]
buffer_load_dwordx2 v[132:133], v244, s[24:27], 0 offen offset:384 sc1
buffer_load_dwordx2 v[134:135], v244, s[24:27], 0 offen offset:512 sc1
buffer_load_dwordx2 v[136:137], v244, s[24:27], 0 offen offset:640 sc1
buffer_load_dwordx2 v[138:139], v244, s[24:27], 0 offen offset:768 sc1
s_waitcnt vmcnt(13)
s_waitcnt lgkmcnt(4)
v_mfma_f32_16x16x32_bf16 v[192:195], a[80:83], v[228:231], v[192:195]
ds_read_b128 v[224:227], v73 offset:11264
s_add_u32 s49, s6, s42
buffer_load_dwordx4 v[48:51], v47, s[16:19], s49 offen sc1
v_mfma_f32_16x16x32_bf16 v[196:199], a[84:87], v[228:231], v[196:199]
s_add_u32 s3, s6, s43
buffer_load_dwordx4 v[52:55], v47, s[16:19], s3 offen sc1
v_mfma_f32_16x16x32_bf16 v[200:203], a[88:91], v[228:231], v[200:203]
v_mfma_f32_16x16x32_bf16 v[204:207], a[92:95], v[228:231], v[204:207]
s_waitcnt vmcnt(14)
buffer_load_dwordx4 a[128:131], v240, s[16:19], s38 offen offset:0 sc1
s_waitcnt vmcnt(14)
buffer_load_dwordx4 a[132:135], v240, s[16:19], s38 offen offset:1024 sc1
s_waitcnt vmcnt(14)
s_waitcnt lgkmcnt(4)
v_mfma_f32_16x16x32_bf16 v[160:163], a[96:99], v[208:211], v[160:163]
ds_read_b128 v[228:231], v75 offset:3072
v_mfma_f32_16x16x32_bf16 v[164:167], a[100:103], v[208:211], v[164:167]
v_mfma_f32_16x16x32_bf16 v[168:171], a[104:107], v[208:211], v[168:171]
v_mfma_f32_16x16x32_bf16 v[172:175], a[108:111], v[208:211], v[172:175]
s_waitcnt vmcnt(13)
s_waitcnt lgkmcnt(4)
v_mfma_f32_16x16x32_bf16 v[176:179], a[96:99], v[212:215], v[176:179]
s_add_u32 s49, s6, s44
buffer_load_dwordx4 v[56:59], v47, s[16:19], s49 offen sc1
v_mfma_f32_16x16x32_bf16 v[180:183], a[100:103], v[212:215], v[180:183]
s_add_u32 s3, s6, s45
buffer_load_dwordx4 v[60:63], v47, s[16:19], s3 offen sc1
v_mfma_f32_16x16x32_bf16 v[184:187], a[104:107], v[212:215], v[184:187]
v_mfma_f32_16x16x32_bf16 v[188:191], a[108:111], v[212:215], v[188:191]
s_waitcnt vmcnt(14)
s_waitcnt lgkmcnt(3)
v_mfma_f32_16x16x32_bf16 v[192:195], a[96:99], v[216:219], v[192:195]
buffer_load_dwordx4 a[136:139], v241, s[16:19], s38 offen offset:0 sc1
v_mfma_f32_16x16x32_bf16 v[196:199], a[100:103], v[216:219], v[196:199]
v_mfma_f32_16x16x32_bf16 v[200:203], a[104:107], v[216:219], v[200:203]
v_mfma_f32_16x16x32_bf16 v[204:207], a[108:111], v[216:219], v[204:207]
s_waitcnt vmcnt(14)
buffer_load_dwordx4 a[140:143], v241, s[16:19], s38 offen offset:1024 sc1
s_waitcnt vmcnt(14)
s_waitcnt lgkmcnt(2)
v_mfma_f32_16x16x32_bf16 v[160:163], a[112:115], v[220:223], v[160:163]
s_add_u32 s49, s6, s46
buffer_load_dwordx4 v[64:67], v47, s[16:19], s49 offen sc1
v_mfma_f32_16x16x32_bf16 v[164:167], a[116:119], v[220:223], v[164:167]
ds_read_b128 v[68:71], v76 offset:0
v_mfma_f32_16x16x32_bf16 v[168:171], a[120:123], v[220:223], v[168:171]
v_mfma_f32_16x16x32_bf16 v[172:175], a[124:127], v[220:223], v[172:175]
s_waitcnt lgkmcnt(2)
v_mfma_f32_16x16x32_bf16 v[176:179], a[112:115], v[224:227], v[176:179]
v_lshlrev_b32 v234, 16, v104
v_and_b32 v235, s95, v104
v_mfma_f32_16x16x32_bf16 v[180:183], a[116:119], v[224:227], v[180:183]
v_fma_f32 v160, v160, v253, v234
v_fma_f32 v161, v161, v253, v235
v_mfma_f32_16x16x32_bf16 v[184:187], a[120:123], v[224:227], v[184:187]
v_lshlrev_b32 v236, 16, v105
v_and_b32 v237, s95, v105
v_mfma_f32_16x16x32_bf16 v[188:191], a[124:127], v[224:227], v[188:191]
v_fma_f32 v162, v162, v253, v236
v_fma_f32 v163, v163, v253, v237
s_waitcnt lgkmcnt(1)
v_mfma_f32_16x16x32_bf16 v[192:195], a[112:115], v[228:231], v[192:195]
v_lshlrev_b32 v238, 16, v106
v_and_b32 v239, s95, v106
v_mfma_f32_16x16x32_bf16 v[196:199], a[116:119], v[228:231], v[196:199]
v_fma_f32 v164, v164, v253, v238
v_fma_f32 v165, v165, v253, v239
v_mfma_f32_16x16x32_bf16 v[200:203], a[120:123], v[228:231], v[200:203]
v_lshlrev_b32 v232, 16, v107
v_and_b32 v233, s95, v107
v_mfma_f32_16x16x32_bf16 v[204:207], a[124:127], v[228:231], v[204:207]
v_fma_f32 v166, v166, v253, v232
v_fma_f32 v167, v167, v253, v233
ds_read_b128 v[104:107], v246 offset:2048
v_lshlrev_b32 v234, 16, v108
v_and_b32 v235, s95, v108
v_fma_f32 v168, v168, v253, v234
v_fma_f32 v169, v169, v253, v235
v_lshlrev_b32 v236, 16, v109
v_and_b32 v237, s95, v109
v_fma_f32 v170, v170, v253, v236
v_fma_f32 v171, v171, v253, v237
v_lshlrev_b32 v238, 16, v110
v_and_b32 v239, s95, v110
v_fma_f32 v172, v172, v253, v238
v_fma_f32 v173, v173, v253, v239
v_lshlrev_b32 v232, 16, v111
v_and_b32 v233, s95, v111
v_fma_f32 v174, v174, v253, v232
v_fma_f32 v175, v175, v253, v233
ds_read_b128 v[108:111], v245 offset:4096
s_waitcnt vmcnt(13)
buffer_load_dwordx4 a[144:147], v240, s[16:19], s38 offen offset:2048 sc1
v_lshlrev_b32 v234, 16, v152
v_and_b32 v235, s95, v152
v_fma_f32 v176, v176, v254, v234
v_fma_f32 v177, v177, v254, v235
v_lshlrev_b32 v236, 16, v153
v_and_b32 v237, s95, v153
v_fma_f32 v178, v178, v254, v236
v_fma_f32 v179, v179, v254, v237
v_lshlrev_b32 v238, 16, v154
v_and_b32 v239, s95, v154
v_fma_f32 v180, v180, v254, v238
v_fma_f32 v181, v181, v254, v239
v_lshlrev_b32 v232, 16, v155
v_and_b32 v233, s95, v155
v_fma_f32 v182, v182, v254, v232
v_fma_f32 v183, v183, v254, v233
ds_read_b128 v[152:155], v246 offset:4096
s_waitcnt lgkmcnt(2)
v_lshlrev_b32 v234, 16, v104
v_and_b32 v235, s95, v104
v_fma_f32 v184, v184, v254, v234
v_fma_f32 v185, v185, v254, v235
v_lshlrev_b32 v236, 16, v105
v_and_b32 v237, s95, v105
v_fma_f32 v186, v186, v254, v236
v_fma_f32 v187, v187, v254, v237
v_lshlrev_b32 v238, 16, v106
v_and_b32 v239, s95, v106
v_fma_f32 v188, v188, v254, v238
v_fma_f32 v189, v189, v254, v239
v_lshlrev_b32 v232, 16, v107
v_and_b32 v233, s95, v107
v_fma_f32 v190, v190, v254, v232
v_fma_f32 v191, v191, v254, v233
s_waitcnt vmcnt(12)
buffer_load_dwordx4 a[148:151], v240, s[16:19], s38 offen offset:3072 sc1
s_waitcnt lgkmcnt(1)
v_lshlrev_b32 v234, 16, v108
v_and_b32 v235, s95, v108
v_fma_f32 v192, v192, v255, v234
v_fma_f32 v193, v193, v255, v235
v_lshlrev_b32 v236, 16, v109
v_and_b32 v237, s95, v109
v_fma_f32 v194, v194, v255, v236
v_fma_f32 v195, v195, v255, v237
v_lshlrev_b32 v238, 16, v110
v_and_b32 v239, s95, v110
v_fma_f32 v196, v196, v255, v238
v_fma_f32 v197, v197, v255, v239
v_lshlrev_b32 v232, 16, v111
v_and_b32 v233, s95, v111
v_fma_f32 v198, v198, v255, v232
v_fma_f32 v199, v199, v255, v233
s_waitcnt lgkmcnt(0)
v_lshlrev_b32 v234, 16, v152
v_and_b32 v235, s95, v152
v_fma_f32 v200, v200, v255, v234
v_fma_f32 v201, v201, v255, v235
v_lshlrev_b32 v236, 16, v153
v_and_b32 v237, s95, v153
v_fma_f32 v202, v202, v255, v236
v_fma_f32 v203, v203, v255, v237
v_lshlrev_b32 v238, 16, v154
v_and_b32 v239, s95, v154
v_fma_f32 v204, v204, v255, v238
v_fma_f32 v205, v205, v255, v239
v_lshlrev_b32 v232, 16, v155
v_and_b32 v233, s95, v155
v_fma_f32 v206, v206, v255, v232
v_fma_f32 v207, v207, v255, v233
s_waitcnt vmcnt(11)
v_max3_f32 v232, v128, v130, v132
v_max3_f32 v233, v134, v136, v138
v_max_f32 v232, v232, v233
v_subrev_f32 v232, 0x42fe0000, v232
v_sub_f32 v128, v128, v232
v_sub_f32 v130, v130, v232
v_sub_f32 v132, v132, v232
v_sub_f32 v134, v134, v232
v_sub_f32 v136, v136, v232
v_sub_f32 v138, v138, v232
v_cvt_u32_f32 v128, v128
v_cvt_u32_f32 v130, v130
v_cvt_u32_f32 v132, v132
v_cvt_u32_f32 v134, v134
v_cvt_u32_f32 v136, v136
v_cvt_u32_f32 v138, v138
v_lshlrev_b32 v234, 23, v128
v_lshlrev_b32 v235, 23, v130
v_lshlrev_b32 v236, 23, v132
v_lshlrev_b32 v237, 23, v134
v_lshlrev_b32 v238, 23, v136
v_lshlrev_b32 v239, 23, v138
v_mul_f32 v232, v234, v129
v_fmac_f32 v232, v235, v131
v_fmac_f32 v232, v236, v133
v_fmac_f32 v232, v237, v135
v_fmac_f32 v232, v238, v137
v_fmac_f32 v232, v239, v139
v_rcp_f32 v150, v232
v_mul_u32_u24 v144, 0x800080, v128
v_mul_u32_u24 v145, 0x800080, v130
v_mul_u32_u24 v146, 0x800080, v132
v_mul_u32_u24 v147, 0x800080, v134
v_mul_u32_u24 v148, 0x800080, v136
v_mul_u32_u24 v149, 0x800080, v138
ds_write_b128 v242, v[144:147]
ds_write_b96 v242, v[148:150] offset:16
ds_read_b128 v[144:147], v250 offset:0
ds_read_b128 v[148:151], v250 offset:16
ds_read_b128 v[128:131], v250 offset:512
ds_read_b128 v[132:135], v250 offset:528
ds_read_b128 v[136:139], v250 offset:1024
ds_read_b128 v[140:143], v250 offset:1040
s_waitcnt lgkmcnt(4)
v_and_b32 v0, v144, v156
v_and_b32 v1, v144, v157
v_and_b32 v2, v145, v156
v_and_b32 v3, v145, v157
v_and_b32 v4, v146, v156
v_and_b32 v5, v146, v157
v_and_b32 v6, v147, v156
v_and_b32 v7, v147, v157
v_and_b32 v8, v148, v156
v_and_b32 v9, v148, v157
v_and_b32 v10, v149, v156
v_and_b32 v11, v149, v157
v_mov_b32 v40, v150
s_waitcnt lgkmcnt(2)
v_and_b32 v12, v128, v156
v_and_b32 v13, v128, v157
v_and_b32 v14, v129, v156
v_and_b32 v15, v129, v157
v_and_b32 v16, v130, v156
v_and_b32 v17, v130, v157
v_and_b32 v18, v131, v156
v_and_b32 v19, v131, v157
v_and_b32 v20, v132, v156
v_and_b32 v21, v132, v157
v_and_b32 v22, v133, v156
v_and_b32 v23, v133, v157
v_mov_b32 v41, v134
s_waitcnt lgkmcnt(0)
v_and_b32 v24, v136, v156
v_and_b32 v25, v136, v157
v_and_b32 v26, v137, v156
v_and_b32 v27, v137, v157
v_and_b32 v28, v138, v156
v_and_b32 v29, v138, v157
v_and_b32 v30, v139, v156
v_and_b32 v31, v139, v157
v_and_b32 v32, v140, v156
v_and_b32 v33, v140, v157
v_and_b32 v34, v141, v156
v_and_b32 v35, v141, v157
v_mov_b32 v42, v142
s_waitcnt vmcnt(9)
v_swap_b32 v50, v52
v_swap_b32 v51, v53
s_nop 1
v_mfma_f32_16x16x32_bf16 v[136:139], v[48:51], v[0:3], 0
s_add_u32 s49, s6, s42
buffer_load_dwordx4 v[80:83], v43, s[16:19], s49 offen sc1
v_mfma_f32_16x16x32_bf16 v[140:143], v[52:55], v[0:3], 0
s_add_u32 s3, s6, s43
buffer_load_dwordx4 v[84:87], v43, s[16:19], s3 offen sc1
buffer_load_dwordx4 a[152:155], v241, s[16:19], s38 offen offset:2048 sc1
s_waitcnt vmcnt(11)
buffer_load_dwordx4 a[156:159], v241, s[16:19], s38 offen offset:3072 sc1
s_waitcnt vmcnt(11)
s_waitcnt vmcnt(9)
v_swap_b32 v58, v60
v_swap_b32 v59, v61
s_nop 1
v_mfma_f32_16x16x32_bf16 v[136:139], v[56:59], v[4:7], v[136:139]
s_add_u32 s49, s6, s44
buffer_load_dwordx4 v[88:91], v43, s[16:19], s49 offen sc1
v_mfma_f32_16x16x32_bf16 v[140:143], v[60:63], v[4:7], v[140:143]
s_add_u32 s3, s6, s45
buffer_load_dwordx4 v[92:95], v43, s[16:19], s3 offen sc1
buffer_load_dwordx4 a[160:163], v240, s[16:19], s39 offen offset:0 sc1
s_waitcnt vmcnt(11)
buffer_load_dwordx4 a[164:167], v240, s[16:19], s39 offen offset:1024 sc1
s_waitcnt vmcnt(11)
s_add_u32 s49, s6, s46
buffer_load_dwordx4 v[96:99], v43, s[16:19], s49 offen sc1
ds_read_b128 v[100:103], v76 offset:4096
s_waitcnt vmcnt(11)
v_swap_b32 v66, v68
v_swap_b32 v67, v69
s_nop 1
v_mfma_f32_16x16x32_bf16 v[136:139], v[64:67], v[8:11], v[136:139]
buffer_load_dwordx4 a[168:171], v241, s[16:19], s39 offen offset:0 sc1
v_mfma_f32_16x16x32_bf16 v[140:143], v[68:71], v[8:11], v[140:143]
s_waitcnt vmcnt(11)
buffer_load_dwordx4 a[172:175], v241, s[16:19], s39 offen offset:1024 sc1
s_nop 3
v_mul_f32 v136, v136, v40
v_mul_f32 v137, v137, v40
v_mul_f32 v138, v138, v40
v_mul_f32 v139, v139, v40
v_mul_f32 v140, v140, v40
v_mul_f32 v141, v141, v40
v_mul_f32 v142, v142, v40
v_mul_f32 v143, v143, v40
v_cvt_pk_bf16_f32 v136, v136, v137
v_cvt_pk_bf16_f32 v137, v138, v139
v_cvt_pk_bf16_f32 v138, v140, v141
v_cvt_pk_bf16_f32 v139, v142, v143
ds_write_b128 v251, v[136:139] offset:0
s_waitcnt vmcnt(11)
s_waitcnt vmcnt(9)
v_swap_b32 v82, v84
v_swap_b32 v83, v85
s_nop 1
v_mfma_f32_16x16x32_bf16 v[128:131], v[80:83], v[0:3], 0
s_add_u32 s49, s7, s42
buffer_load_dwordx4 v[112:115], v47, s[16:19], s49 offen sc1
v_mfma_f32_16x16x32_bf16 v[132:135], v[84:87], v[0:3], 0
s_add_u32 s3, s7, s43
buffer_load_dwordx4 v[116:119], v47, s[16:19], s3 offen sc1
buffer_load_dwordx4 a[176:179], v240, s[16:19], s39 offen offset:2048 sc1
s_waitcnt vmcnt(11)
buffer_load_dwordx4 a[180:183], v240, s[16:19], s39 offen offset:3072 sc1
s_waitcnt vmcnt(11)
s_waitcnt vmcnt(9)
v_swap_b32 v90, v92
v_swap_b32 v91, v93
s_nop 1
v_mfma_f32_16x16x32_bf16 v[128:131], v[88:91], v[4:7], v[128:131]
s_add_u32 s49, s7, s44
buffer_load_dwordx4 v[120:123], v47, s[16:19], s49 offen sc1
v_mfma_f32_16x16x32_bf16 v[132:135], v[92:95], v[4:7], v[132:135]
s_add_u32 s3, s7, s45
buffer_load_dwordx4 v[124:127], v47, s[16:19], s3 offen sc1
buffer_load_dwordx4 a[184:187], v241, s[16:19], s39 offen offset:2048 sc1
s_waitcnt vmcnt(11)
buffer_load_dwordx4 a[188:191], v241, s[16:19], s39 offen offset:3072 sc1
s_waitcnt vmcnt(11)
s_add_u32 s49, s7, s46
buffer_load_dwordx4 v[48:51], v47, s[16:19], s49 offen sc1
ds_read_b128 v[52:55], v77 offset:0
s_waitcnt vmcnt(11)
s_waitcnt lgkmcnt(2)
v_swap_b32 v98, v100
v_swap_b32 v99, v101
s_nop 1
v_mfma_f32_16x16x32_bf16 v[128:131], v[96:99], v[8:11], v[128:131]
buffer_load_dwordx4 a[192:195], v240, s[16:19], s40 offen offset:0 sc1
v_mfma_f32_16x16x32_bf16 v[132:135], v[100:103], v[8:11], v[132:135]
s_waitcnt vmcnt(11)
buffer_load_dwordx4 a[196:199], v240, s[16:19], s40 offen offset:1024 sc1
s_nop 3
v_mul_f32 v128, v128, v40
v_mul_f32 v129, v129, v40
v_mul_f32 v130, v130, v40
v_mul_f32 v131, v131, v40
v_mul_f32 v132, v132, v40
v_mul_f32 v133, v133, v40
v_mul_f32 v134, v134, v40
v_mul_f32 v135, v135, v40
v_cvt_pk_bf16_f32 v128, v128, v129
v_cvt_pk_bf16_f32 v129, v130, v131
v_cvt_pk_bf16_f32 v130, v132, v133
v_cvt_pk_bf16_f32 v131, v134, v135
ds_write_b128 v251, v[128:131] offset:4096
s_waitcnt vmcnt(11)
s_waitcnt lgkmcnt(0)
s_barrier
ds_read_b128 v[208:211], v252 offset:0
ds_read_b128 v[212:215], v252 offset:1024
ds_read_b128 v[216:219], v252 offset:2048
ds_read_b128 v[220:223], v252 offset:3072
ds_read_b128 v[224:227], v252 offset:4096
s_waitcnt vmcnt(9)
s_waitcnt lgkmcnt(4)
v_mfma_f32_16x16x32_bf16 v[160:163], a[128:131], v[208:211], v[160:163]
ds_read_b128 v[228:231], v252 offset:5120
v_swap_b32 v114, v116
v_mfma_f32_16x16x32_bf16 v[164:167], a[132:135], v[208:211], v[164:167]
v_swap_b32 v115, v117
s_nop 1
v_mfma_f32_16x16x32_bf16 v[136:139], v[112:115], v[12:15], 0
s_add_u32 s49, s7, s42
buffer_load_dwordx4 v[56:59], v43, s[16:19], s49 offen sc1
v_mfma_f32_16x16x32_bf16 v[140:143], v[116:119], v[12:15], 0
s_add_u32 s3, s7, s43
buffer_load_dwordx4 v[60:63], v43, s[16:19], s3 offen sc1
v_mfma_f32_16x16x32_bf16 v[168:171], a[136:139], v[208:211], v[168:171]
buffer_load_dwordx4 a[200:203], v241, s[16:19], s40 offen offset:0 sc1
v_mfma_f32_16x16x32_bf16 v[172:175], a[140:143], v[208:211], v[172:175]
s_waitcnt lgkmcnt(4)
v_mfma_f32_16x16x32_bf16 v[160:163], a[144:147], v[212:215], v[160:163]
v_mfma_f32_16x16x32_bf16 v[164:167], a[148:151], v[212:215], v[164:167]
v_mfma_f32_16x16x32_bf16 v[168:171], a[152:155], v[212:215], v[168:171]
v_mfma_f32_16x16x32_bf16 v[172:175], a[156:159], v[212:215], v[172:175]
s_waitcnt vmcnt(11)
s_waitcnt lgkmcnt(3)
v_mfma_f32_16x16x32_bf16 v[160:163], a[160:163], v[216:219], v[160:163]
buffer_load_dwordx4 a[204:207], v241, s[16:19], s40 offen offset:1024 sc1
v_mfma_f32_16x16x32_bf16 v[164:167], a[164:167], v[216:219], v[164:167]
v_mfma_f32_16x16x32_bf16 v[168:171], a[168:171], v[216:219], v[168:171]
v_mfma_f32_16x16x32_bf16 v[172:175], a[172:175], v[216:219], v[172:175]
s_waitcnt vmcnt(11)
s_waitcnt vmcnt(9)
v_swap_b32 v122, v124
v_swap_b32 v123, v125
s_nop 1
v_mfma_f32_16x16x32_bf16 v[136:139], v[120:123], v[16:19], v[136:139]
s_add_u32 s49, s7, s44
buffer_load_dwordx4 v[64:67], v43, s[16:19], s49 offen sc1
v_mfma_f32_16x16x32_bf16 v[140:143], v[124:127], v[16:19], v[140:143]
s_add_u32 s3, s7, s45
buffer_load_dwordx4 v[68:71], v43, s[16:19], s3 offen sc1
buffer_load_dwordx4 a[208:211], v240, s[16:19], s40 offen offset:2048 sc1
s_waitcnt vmcnt(11)
buffer_load_dwordx4 a[212:215], v240, s[16:19], s40 offen offset:3072 sc1
s_waitcnt vmcnt(11)
s_waitcnt lgkmcnt(2)
v_mfma_f32_16x16x32_bf16 v[160:163], a[176:179], v[220:223], v[160:163]
s_add_u32 s49, s7, s46
buffer_load_dwordx4 v[80:83], v43, s[16:19], s49 offen sc1
v_mfma_f32_16x16x32_bf16 v[164:167], a[180:183], v[220:223], v[164:167]
ds_read_b128 v[84:87], v77 offset:4096
v_mfma_f32_16x16x32_bf16 v[168:171], a[184:187], v[220:223], v[168:171]
v_mfma_f32_16x16x32_bf16 v[172:175], a[188:191], v[220:223], v[172:175]
s_waitcnt vmcnt(11)
v_swap_b32 v50, v52
v_swap_b32 v51, v53
s_nop 1
v_mfma_f32_16x16x32_bf16 v[136:139], v[48:51], v[20:23], v[136:139]
buffer_load_dwordx4 a[216:219], v241, s[16:19], s40 offen offset:2048 sc1
v_mfma_f32_16x16x32_bf16 v[140:143], v[52:55], v[20:23], v[140:143]
s_waitcnt vmcnt(11)
buffer_load_dwordx4 a[220:223], v241, s[16:19], s40 offen offset:3072 sc1
s_nop 3
v_mul_f32 v136, v136, v41
v_mul_f32 v137, v137, v41
v_mul_f32 v138, v138, v41
v_mul_f32 v139, v139, v41
v_mul_f32 v140, v140, v41
v_mul_f32 v141, v141, v41
v_mul_f32 v142, v142, v41
v_mul_f32 v143, v143, v41
v_cvt_pk_bf16_f32 v136, v136, v137
v_cvt_pk_bf16_f32 v137, v138, v139
v_cvt_pk_bf16_f32 v138, v140, v141
v_cvt_pk_bf16_f32 v139, v142, v143
ds_write_b128 v251, v[136:139] offset:8192
s_waitcnt vmcnt(11)
s_waitcnt vmcnt(9)
v_swap_b32 v58, v60
v_swap_b32 v59, v61
s_nop 1
v_mfma_f32_16x16x32_bf16 v[128:131], v[56:59], v[12:15], 0
s_add_u32 s49, s29, s42
buffer_load_dwordx4 v[88:91], v47, s[16:19], s49 offen sc1
v_mfma_f32_16x16x32_bf16 v[132:135], v[60:63], v[12:15], 0
s_add_u32 s3, s29, s43
buffer_load_dwordx4 v[92:95], v47, s[16:19], s3 offen sc1
buffer_load_dwordx4 a[224:227], v240, s[16:19], s41 offen offset:0 sc1
s_waitcnt vmcnt(11)
buffer_load_dwordx4 a[228:231], v240, s[16:19], s41 offen offset:1024 sc1
s_waitcnt vmcnt(11)
s_waitcnt lgkmcnt(3)
v_mfma_f32_16x16x32_bf16 v[160:163], a[192:195], v[224:227], v[160:163]
buffer_load_dwordx4 a[232:235], v241, s[16:19], s41 offen offset:0 sc1
v_mfma_f32_16x16x32_bf16 v[164:167], a[196:199], v[224:227], v[164:167]
v_mfma_f32_16x16x32_bf16 v[168:171], a[200:203], v[224:227], v[168:171]
v_mfma_f32_16x16x32_bf16 v[172:175], a[204:207], v[224:227], v[172:175]
s_waitcnt vmcnt(10)
v_swap_b32 v66, v68
v_swap_b32 v67, v69
s_nop 1
v_mfma_f32_16x16x32_bf16 v[128:131], v[64:67], v[16:19], v[128:131]
buffer_load_dwordx4 a[236:239], v241, s[16:19], s41 offen offset:1024 sc1
v_mfma_f32_16x16x32_bf16 v[132:135], v[68:71], v[16:19], v[132:135]
s_waitcnt vmcnt(10)
s_add_u32 s49, s29, s44
buffer_load_dwordx4 v[96:99], v47, s[16:19], s49 offen sc1
s_add_u32 s3, s29, s45
buffer_load_dwordx4 v[100:103], v47, s[16:19], s3 offen sc1
s_waitcnt vmcnt(11)
buffer_load_dwordx4 a[240:243], v240, s[16:19], s41 offen offset:2048 sc1
s_waitcnt vmcnt(11)
s_waitcnt lgkmcnt(1)
v_swap_b32 v82, v84
v_swap_b32 v83, v85
s_nop 1
v_mfma_f32_16x16x32_bf16 v[128:131], v[80:83], v[20:23], v[128:131]
buffer_load_dwordx4 a[244:247], v240, s[16:19], s41 offen offset:3072 sc1
v_mfma_f32_16x16x32_bf16 v[132:135], v[84:87], v[20:23], v[132:135]
s_waitcnt vmcnt(11)
buffer_load_dwordx4 a[248:251], v241, s[16:19], s41 offen offset:2048 sc1
s_nop 3
v_mul_f32 v128, v128, v41
v_mul_f32 v129, v129, v41
v_mul_f32 v130, v130, v41
v_mul_f32 v131, v131, v41
v_mul_f32 v132, v132, v41
v_mul_f32 v133, v133, v41
v_mul_f32 v134, v134, v41
v_mul_f32 v135, v135, v41
v_cvt_pk_bf16_f32 v128, v128, v129
v_cvt_pk_bf16_f32 v129, v130, v131
v_cvt_pk_bf16_f32 v130, v132, v133
v_cvt_pk_bf16_f32 v131, v134, v135
ds_write_b128 v251, v[128:131] offset:12288
s_waitcnt vmcnt(11)
v_mfma_f32_16x16x32_bf16 v[160:163], a[208:211], v[228:231], v[160:163]
buffer_load_dwordx4 a[252:255], v241, s[16:19], s41 offen offset:3072 sc1
v_mfma_f32_16x16x32_bf16 v[164:167], a[212:215], v[228:231], v[164:167]
v_mfma_f32_16x16x32_bf16 v[168:171], a[216:219], v[228:231], v[168:171]
v_mfma_f32_16x16x32_bf16 v[172:175], a[220:223], v[228:231], v[172:175]
s_waitcnt lgkmcnt(0)
s_barrier
ds_read_b128 v[208:211], v252 offset:8192
ds_read_b128 v[212:215], v252 offset:9216
ds_read_b128 v[216:219], v252 offset:10240
ds_read_b128 v[220:223], v252 offset:11264
ds_read_b128 v[224:227], v252 offset:12288
s_waitcnt vmcnt(10)
s_waitcnt lgkmcnt(4)
v_mfma_f32_16x16x32_bf16 v[176:179], a[128:131], v[208:211], v[176:179]
ds_read_b128 v[228:231], v252 offset:6144
v_swap_b32 v90, v92
v_mfma_f32_16x16x32_bf16 v[180:183], a[132:135], v[208:211], v[180:183]
v_swap_b32 v91, v93
s_nop 1
v_mfma_f32_16x16x32_bf16 v[136:139], v[88:91], v[24:27], 0
s_add_u32 s49, s29, s46
buffer_load_dwordx4 v[112:115], v47, s[16:19], s49 offen sc1
v_mfma_f32_16x16x32_bf16 v[140:143], v[92:95], v[24:27], 0
s_add_u32 s3, s29, s47
s_cmp_lt_u32 s37, 4
s_cbranch_scc1 LF_o0
buffer_load_dwordx4 v[116:119], v47, s[16:19], s3 offen sc1
ds_read_b128 v[36:39], v78 offset:0
s_branch LF_j0
LF_o0:
s_mov_b32 s3, 0x70000000
buffer_load_dwordx4 v[36:39], v47, s[16:19], s3 offen sc1
ds_read_b128 v[116:119], v78 offset:0
LF_j0:
v_mfma_f32_16x16x32_bf16 v[184:187], a[136:139], v[208:211], v[184:187]
v_mfma_f32_16x16x32_bf16 v[188:191], a[140:143], v[208:211], v[188:191]
s_waitcnt lgkmcnt(5)
v_mfma_f32_16x16x32_bf16 v[176:179], a[144:147], v[212:215], v[176:179]
ds_read_b128 v[208:211], v252 offset:13312
v_mfma_f32_16x16x32_bf16 v[180:183], a[148:151], v[212:215], v[180:183]
v_mfma_f32_16x16x32_bf16 v[184:187], a[152:155], v[212:215], v[184:187]
v_mfma_f32_16x16x32_bf16 v[188:191], a[156:159], v[212:215], v[188:191]
s_waitcnt vmcnt(11)
s_waitcnt lgkmcnt(5)
v_mfma_f32_16x16x32_bf16 v[176:179], a[160:163], v[216:219], v[176:179]
ds_read_b128 v[212:215], v252 offset:14336
v_mfma_f32_16x16x32_bf16 v[180:183], a[164:167], v[216:219], v[180:183]
v_mfma_f32_16x16x32_bf16 v[184:187], a[168:171], v[216:219], v[184:187]
v_mfma_f32_16x16x32_bf16 v[188:191], a[172:175], v[216:219], v[188:191]
s_waitcnt vmcnt(10)
s_waitcnt lgkmcnt(5)
v_mfma_f32_16x16x32_bf16 v[176:179], a[176:179], v[220:223], v[176:179]
ds_read_b128 v[216:219], v252 offset:7168
s_add_u32 s49, s29, s42
buffer_load_dwordx4 v[120:123], v43, s[16:19], s49 offen sc1
v_mfma_f32_16x16x32_bf16 v[180:183], a[180:183], v[220:223], v[180:183]
s_add_u32 s3, s29, s43
buffer_load_dwordx4 v[124:127], v43, s[16:19], s3 offen sc1
v_mfma_f32_16x16x32_bf16 v[184:187], a[184:187], v[220:223], v[184:187]
v_mfma_f32_16x16x32_bf16 v[188:191], a[188:191], v[220:223], v[188:191]
s_waitcnt vmcnt(11)
s_waitcnt lgkmcnt(5)
v_mfma_f32_16x16x32_bf16 v[176:179], a[192:195], v[224:227], v[176:179]
ds_read_b128 v[220:223], v252 offset:15360
v_mfma_f32_16x16x32_bf16 v[180:183], a[196:199], v[224:227], v[180:183]
v_mfma_f32_16x16x32_bf16 v[184:187], a[200:203], v[224:227], v[184:187]
v_mfma_f32_16x16x32_bf16 v[188:191], a[204:207], v[224:227], v[188:191]
s_waitcnt vmcnt(10)
s_waitcnt lgkmcnt(5)
v_mfma_f32_16x16x32_bf16 v[160:163], a[224:227], v[228:231], v[160:163]
s_add_u32 s49, s29, s44
buffer_load_dwordx4 v[48:51], v43, s[16:19], s49 offen sc1
v_mfma_f32_16x16x32_bf16 v[164:167], a[228:231], v[228:231], v[164:167]
s_add_u32 s3, s29, s45
buffer_load_dwordx4 v[52:55], v43, s[16:19], s3 offen sc1
v_mfma_f32_16x16x32_bf16 v[168:171], a[232:235], v[228:231], v[168:171]
v_mfma_f32_16x16x32_bf16 v[172:175], a[236:239], v[228:231], v[172:175]
s_waitcnt vmcnt(10)
s_waitcnt lgkmcnt(3)
v_mfma_f32_16x16x32_bf16 v[176:179], a[208:211], v[208:211], v[176:179]
v_swap_b32 v98, v100
v_mfma_f32_16x16x32_bf16 v[180:183], a[212:215], v[208:211], v[180:183]
v_swap_b32 v99, v101
s_nop 1
v_mfma_f32_16x16x32_bf16 v[136:139], v[96:99], v[28:31], v[136:139]
s_add_u32 s49, s29, s46
buffer_load_dwordx4 v[56:59], v43, s[16:19], s49 offen sc1
v_mfma_f32_16x16x32_bf16 v[140:143], v[100:103], v[28:31], v[140:143]
s_add_u32 s3, s29, s47
s_cmp_lt_u32 s37, 4
s_cbranch_scc1 LF_o1
buffer_load_dwordx4 v[60:63], v43, s[16:19], s3 offen sc1
ds_read_b128 v[36:39], v78 offset:4096
s_branch LF_j1
LF_o1:
s_mov_b32 s3, 0x70000000
buffer_load_dwordx4 v[36:39], v43, s[16:19], s3 offen sc1
ds_read_b128 v[60:63], v78 offset:4096
LF_j1:
v_mfma_f32_16x16x32_bf16 v[184:187], a[216:219], v[208:211], v[184:187]
v_mfma_f32_16x16x32_bf16 v[188:191], a[220:223], v[208:211], v[188:191]
s_waitcnt lgkmcnt(3)
v_mfma_f32_16x16x32_bf16 v[176:179], a[224:227], v[212:215], v[176:179]
v_mfma_f32_16x16x32_bf16 v[180:183], a[228:231], v[212:215], v[180:183]
v_mfma_f32_16x16x32_bf16 v[184:187], a[232:235], v[212:215], v[184:187]
v_mfma_f32_16x16x32_bf16 v[188:191], a[236:239], v[212:215], v[188:191]
s_waitcnt vmcnt(11)
s_waitcnt vmcnt(10)
s_waitcnt vmcnt(9)
s_waitcnt vmcnt(8)
s_waitcnt lgkmcnt(2)
v_mfma_f32_16x16x32_bf16 v[160:163], a[240:243], v[216:219], v[160:163]
v_mfma_f32_16x16x32_bf16 v[164:167], a[244:247], v[216:219], v[164:167]
v_mfma_f32_16x16x32_bf16 v[168:171], a[248:251], v[216:219], v[168:171]
v_mfma_f32_16x16x32_bf16 v[172:175], a[252:255], v[216:219], v[172:175]
s_waitcnt vmcnt(6)
s_waitcnt lgkmcnt(1)
v_mfma_f32_16x16x32_bf16 v[176:179], a[240:243], v[220:223], v[176:179]
v_swap_b32 v114, v116
v_mfma_f32_16x16x32_bf16 v[180:183], a[244:247], v[220:223], v[180:183]
v_swap_b32 v115, v117
s_nop 1
v_mfma_f32_16x16x32_bf16 v[136:139], v[112:115], v[32:35], v[136:139]
v_cvt_pk_bf16_f32 v160, v160, v161
v_cvt_pk_bf16_f32 v161, v162, v163
v_mfma_f32_16x16x32_bf16 v[140:143], v[116:119], v[32:35], v[140:143]
v_cvt_pk_bf16_f32 v162, v164, v165
v_cvt_pk_bf16_f32 v163, v166, v167
v_mfma_f32_16x16x32_bf16 v[184:187], a[248:251], v[220:223], v[184:187]
ds_write_b128 v245, v[160:163] offset:0
v_cvt_pk_bf16_f32 v168, v168, v169
v_mfma_f32_16x16x32_bf16 v[188:191], a[252:255], v[220:223], v[188:191]
v_cvt_pk_bf16_f32 v169, v170, v171
v_cvt_pk_bf16_f32 v170, v172, v173
v_cvt_pk_bf16_f32 v171, v174, v175
ds_write_b128 v246, v[168:171] offset:0
ds_read_b128 v[164:167], v247 offset:0
ds_read_b128 v[172:175], v247 offset:1024
v_mul_f32 v136, v136, v42
v_mul_f32 v137, v137, v42
v_mul_f32 v138, v138, v42
v_mul_f32 v139, v139, v42
v_mul_f32 v140, v140, v42
v_mul_f32 v141, v141, v42
v_mul_f32 v142, v142, v42
v_mul_f32 v143, v143, v42
v_cvt_pk_bf16_f32 v136, v136, v137
v_cvt_pk_bf16_f32 v137, v138, v139
v_cvt_pk_bf16_f32 v138, v140, v141
v_cvt_pk_bf16_f32 v139, v142, v143
ds_write_b128 v251, v[136:139] offset:16384
s_waitcnt lgkmcnt(0)
s_barrier
ds_read_b128 v[224:227], v252 offset:16384
ds_read_b128 v[228:231], v252 offset:17408
ds_read_b128 v[208:211], v252 offset:18432
ds_read_b128 v[212:215], v252 offset:19456
s_waitcnt vmcnt(4)
s_waitcnt lgkmcnt(3)
v_mfma_f32_16x16x32_bf16 v[192:195], a[128:131], v[224:227], v[192:195]
v_swap_b32 v122, v124
v_mfma_f32_16x16x32_bf16 v[196:199], a[132:135], v[224:227], v[196:199]
v_swap_b32 v123, v125
s_nop 1
v_mfma_f32_16x16x32_bf16 v[128:131], v[120:123], v[24:27], 0
buffer_store_dwordx4 v[164:167], v44, s[56:59], s6 offen sc1
v_mfma_f32_16x16x32_bf16 v[132:135], v[124:127], v[24:27], 0
buffer_store_dwordx4 v[172:175], v45, s[56:59], s6 offen sc1
v_mfma_f32_16x16x32_bf16 v[200:203], a[136:139], v[224:227], v[200:203]
v_cvt_pk_bf16_f32 v176, v176, v177
v_cvt_pk_bf16_f32 v177, v178, v179
v_mfma_f32_16x16x32_bf16 v[204:207], a[140:143], v[224:227], v[204:207]
v_cvt_pk_bf16_f32 v178, v180, v181
v_cvt_pk_bf16_f32 v179, v182, v183
s_waitcnt lgkmcnt(2)
v_mfma_f32_16x16x32_bf16 v[192:195], a[144:147], v[228:231], v[192:195]
ds_write_b128 v245, v[176:179] offset:2048
v_cvt_pk_bf16_f32 v184, v184, v185
v_mfma_f32_16x16x32_bf16 v[196:199], a[148:151], v[228:231], v[196:199]
v_cvt_pk_bf16_f32 v185, v186, v187
v_cvt_pk_bf16_f32 v186, v188, v189
v_mfma_f32_16x16x32_bf16 v[200:203], a[152:155], v[228:231], v[200:203]
v_cvt_pk_bf16_f32 v187, v190, v191
ds_write_b128 v246, v[184:187] offset:2048
v_mfma_f32_16x16x32_bf16 v[204:207], a[156:159], v[228:231], v[204:207]
ds_read_b128 v[180:183], v247 offset:2048
ds_read_b128 v[188:191], v247 offset:3072
s_waitcnt vmcnt(4)
s_waitcnt lgkmcnt(5)
v_mfma_f32_16x16x32_bf16 v[192:195], a[160:163], v[208:211], v[192:195]
v_swap_b32 v50, v52
v_mfma_f32_16x16x32_bf16 v[196:199], a[164:167], v[208:211], v[196:199]
v_swap_b32 v51, v53
s_nop 1
v_mfma_f32_16x16x32_bf16 v[128:131], v[48:51], v[28:31], v[128:131]
s_waitcnt lgkmcnt(1)
buffer_store_dwordx4 v[180:183], v44, s[56:59], s7 offen sc1
v_mfma_f32_16x16x32_bf16 v[132:135], v[52:55], v[28:31], v[132:135]
s_waitcnt lgkmcnt(0)
buffer_store_dwordx4 v[188:191], v45, s[56:59], s7 offen sc1
v_mfma_f32_16x16x32_bf16 v[200:203], a[168:171], v[208:211], v[200:203]
v_mfma_f32_16x16x32_bf16 v[204:207], a[172:175], v[208:211], v[204:207]
v_mfma_f32_16x16x32_bf16 v[192:195], a[176:179], v[212:215], v[192:195]
v_mfma_f32_16x16x32_bf16 v[196:199], a[180:183], v[212:215], v[196:199]
v_mfma_f32_16x16x32_bf16 v[200:203], a[184:187], v[212:215], v[200:203]
v_mfma_f32_16x16x32_bf16 v[204:207], a[188:191], v[212:215], v[204:207]
s_waitcnt vmcnt(4)
v_swap_b32 v58, v60
v_swap_b32 v59, v61
s_nop 1
v_mfma_f32_16x16x32_bf16 v[128:131], v[56:59], v[32:35], v[128:131]
v_mfma_f32_16x16x32_bf16 v[132:135], v[60:63], v[32:35], v[132:135]
s_nop 6
v_mul_f32 v128, v128, v42
v_mul_f32 v129, v129, v42
v_mul_f32 v130, v130, v42
v_mul_f32 v131, v131, v42
v_mul_f32 v132, v132, v42
v_mul_f32 v133, v133, v42
v_mul_f32 v134, v134, v42
v_mul_f32 v135, v135, v42
v_cvt_pk_bf16_f32 v128, v128, v129
v_cvt_pk_bf16_f32 v129, v130, v131
v_cvt_pk_bf16_f32 v130, v132, v133
v_cvt_pk_bf16_f32 v131, v134, v135
ds_write_b128 v251, v[128:131] offset:20480
s_waitcnt lgkmcnt(0)
s_barrier
ds_read_b128 v[216:219], v252 offset:20480
ds_read_b128 v[220:223], v252 offset:21504
ds_read_b128 v[224:227], v252 offset:22528
ds_read_b128 v[228:231], v252 offset:23552
s_waitcnt lgkmcnt(3)
v_mfma_f32_16x16x32_bf16 v[192:195], a[192:195], v[216:219], v[192:195]
v_mfma_f32_16x16x32_bf16 v[196:199], a[196:199], v[216:219], v[196:199]
v_mfma_f32_16x16x32_bf16 v[200:203], a[200:203], v[216:219], v[200:203]
v_mfma_f32_16x16x32_bf16 v[204:207], a[204:207], v[216:219], v[204:207]
s_waitcnt lgkmcnt(2)
v_mfma_f32_16x16x32_bf16 v[192:195], a[208:211], v[220:223], v[192:195]
v_mfma_f32_16x16x32_bf16 v[196:199], a[212:215], v[220:223], v[196:199]
v_mfma_f32_16x16x32_bf16 v[200:203], a[216:219], v[220:223], v[200:203]
v_mfma_f32_16x16x32_bf16 v[204:207], a[220:223], v[220:223], v[204:207]
s_waitcnt lgkmcnt(1)
v_mfma_f32_16x16x32_bf16 v[192:195], a[224:227], v[224:227], v[192:195]
v_mfma_f32_16x16x32_bf16 v[196:199], a[228:231], v[224:227], v[196:199]
v_mfma_f32_16x16x32_bf16 v[200:203], a[232:235], v[224:227], v[200:203]
v_mfma_f32_16x16x32_bf16 v[204:207], a[236:239], v[224:227], v[204:207]
s_waitcnt lgkmcnt(0)
v_mfma_f32_16x16x32_bf16 v[192:195], a[240:243], v[228:231], v[192:195]
v_mfma_f32_16x16x32_bf16 v[196:199], a[244:247], v[228:231], v[196:199]
v_mfma_f32_16x16x32_bf16 v[200:203], a[248:251], v[228:231], v[200:203]
v_mfma_f32_16x16x32_bf16 v[204:207], a[252:255], v[228:231], v[204:207]
s_nop 4
v_cvt_pk_bf16_f32 v192, v192, v193
v_cvt_pk_bf16_f32 v193, v194, v195
v_cvt_pk_bf16_f32 v194, v196, v197
v_cvt_pk_bf16_f32 v195, v198, v199
ds_write_b128 v245, v[192:195] offset:4096
v_cvt_pk_bf16_f32 v200, v200, v201
v_cvt_pk_bf16_f32 v201, v202, v203
v_cvt_pk_bf16_f32 v202, v204, v205
v_cvt_pk_bf16_f32 v203, v206, v207
ds_write_b128 v246, v[200:203] offset:4096
ds_read_b128 v[196:199], v247 offset:4096
ds_read_b128 v[204:207], v247 offset:5120
s_waitcnt lgkmcnt(1)
buffer_store_dwordx4 v[196:199], v44, s[56:59], s29 offen sc1
s_waitcnt lgkmcnt(0)
buffer_store_dwordx4 v[204:207], v45, s[56:59], s29 offen sc1
s_branch L2_fin
LF_spinQ:
s_mov_b32 s94, 0x10000
LF_spin2Q:
buffer_load_dwordx2 v[248:249], v46, s[16:19], 0 offen offset:0 sc1
s_sub_u32 s94, s94, 1
s_waitcnt vmcnt(0)
s_cbranch_scc1 LF_spin2Q_go
v_cmp_ne_u64 vcc, s[98:99], v[248:249]
s_nop 1
s_cbranch_vccnz LF_spin2Q
LF_spin2Q_go:
s_branch LF_goQ
LF_wf:
s_mov_b32 s94, 0x10000
LF_wf2:
buffer_load_dwordx2 v[108:109], v110, s[16:19], 0 offen sc1
s_sub_u32 s94, s94, 1
s_waitcnt vmcnt(0)
s_cbranch_scc1 LF_wf2_go
v_cmp_ne_u64 vcc, s[98:99], v[108:109]
s_nop 1
s_cbranch_vccnz LF_wf2
LF_wf2_go:
s_branch LF_wf_go
LM_pb:
s_mov_b32 s3, 0x10000
LM_pb2:
buffer_load_dwordx2 v[228:229], v230, s[16:19], 0 offen sc1
s_sub_u32 s3, s3, 1
s_waitcnt vmcnt(0)
s_cbranch_scc1 LM_pb2_go
v_cmp_ne_u64 vcc, s[98:99], v[228:229]
s_nop 1
s_cbranch_vccnz LM_pb2
LM_pb2_go:
s_branch LM_pb_ret
L2_Fend:
LT_disp:
s_cmp_ge_i32 s36, 0
s_cbranch_scc1 LT_start
s_cmp_eq_u32 s34, 0
s_cbranch_scc1 L2_end
s_mov_b32 s41, s34
s_mul_i32 s40, s34, 6
s_add_u32 s40, s40, s37
s_add_u32 s40, s40, 42
s_cmp_lt_u32 s40, 64
s_cbranch_scc1 LE_common
s_branch L2_end
LT_start:
s_waitcnt lgkmcnt(0)
s_add_u32 s12, s4, 0x7c2a000
s_addc_u32 s13, s5, 0
s_mov_b32 s14, 0x8000
s_mov_b32 s15, 0x00020000
v_and_b32 v8, 63, v0
v_lshlrev_b32 v8, 7, v8
s_mov_b32 s91, 8192
s_mov_b32 s90, 16384
s_mov_b32 s95, 24576
v_min_u32 v9, 5248, v8
s_mov_b32 s94, 0x10000
LT_poll:
buffer_load_dwordx2 v[0:1], v8, s[12:15], 0 offen sc1
buffer_load_dwordx2 v[2:3], v8, s[12:15], s91 offen sc1
buffer_load_dwordx2 v[4:5], v8, s[12:15], s90 offen sc1
buffer_load_dwordx2 v[6:7], v9, s[12:15], s95 offen sc1
s_sub_u32 s94, s94, 1
s_waitcnt vmcnt(0)
s_cbranch_scc1 LT_poll_go
v_cmp_ne_u64 vcc, s[98:99], v[0:1]
s_nop 1
s_cbranch_vccnz LT_poll
v_cmp_ne_u64 vcc, s[98:99], v[2:3]
s_nop 1
s_cbranch_vccnz LT_poll
v_cmp_ne_u64 vcc, s[98:99], v[4:5]
s_nop 1
s_cbranch_vccnz LT_poll
v_cmp_ne_u64 vcc, s[98:99], v[6:7]
s_nop 1
s_cbranch_vccnz LT_poll
LT_poll_go:
s_add_u32 s31, s31, -22
s_add_u32 s3, s28, 409600
s_cmp_eq_u32 s36, 0
s_cselect_b32 s31, 26, s31
s_cselect_b32 s39, s39, s3
s_cselect_b32 s33, s33, 0
s_cselect_b32 s3, 0, 425984
s_add_u32 s28, s28, s3
s_add_u32 s12, s4, 0x6800000
s_addc_u32 s13, s5, 0
s_mov_b32 s14, 0x0
s_mov_b32 s15, 0x00020000
s_mov_b32 s14, s49
s_add_u32 s8, s4, 0x0
s_addc_u32 s9, s5, 0
s_mov_b32 s10, 0x4e4000
s_mov_b32 s11, 0x00020000
s_mov_b32 s40, 5111808
s_mov_b32 s44, 5115904
buffer_load_dwordx4 v[0:3], v243, s[8:11], s40 offen offset:0 sc1
buffer_load_dwordx4 v[4:7], v243, s[8:11], s40 offen offset:1024 sc1
buffer_load_dwordx4 v[8:11], v243, s[8:11], s40 offen offset:2048 sc1
buffer_load_dwordx4 v[12:15], v243, s[8:11], s40 offen offset:3072 sc1
buffer_load_dwordx4 v[16:19], v243, s[8:11], s44 offen offset:0 sc1
buffer_load_dwordx4 v[20:23], v243, s[8:11], s44 offen offset:1024 sc1
buffer_load_dwordx4 v[24:27], v243, s[8:11], s44 offen offset:2048 sc1
buffer_load_dwordx4 v[28:31], v243, s[8:11], s44 offen offset:3072 sc1
s_mov_b32 s53, 0
s_add_u32 m0, s53, 90112
s_add_u32 s54, s39, 0
buffer_load_dwordx4 v241, s[12:15], s54 offen offset:0 sc1 lds
buffer_load_dwordx4 v241, s[12:15], s54 offen offset:1024 sc1 lds
buffer_load_dwordx4 v241, s[12:15], s54 offen offset:2048 sc1 lds
buffer_load_dwordx4 v241, s[12:15], s54 offen offset:3072 sc1 lds
s_add_u32 m0, s53, 94208
s_add_u32 s54, s39, 128
buffer_load_dwordx4 v241, s[12:15], s54 offen offset:0 sc1 lds
buffer_load_dwordx4 v241, s[12:15], s54 offen offset:1024 sc1 lds
buffer_load_dwordx4 v241, s[12:15], s54 offen offset:2048 sc1 lds
buffer_load_dwordx4 v241, s[12:15], s54 offen offset:3072 sc1 lds
s_add_u32 m0, s53, 98304
s_add_u32 s54, s39, 256
buffer_load_dwordx4 v241, s[12:15], s54 offen offset:0 sc1 lds
buffer_load_dwordx4 v241, s[12:15], s54 offen offset:1024 sc1 lds
buffer_load_dwordx4 v241, s[12:15], s54 offen offset:2048 sc1 lds
buffer_load_dwordx4 v241, s[12:15], s54 offen offset:3072 sc1 lds
s_add_u32 m0, s53, 102400
s_add_u32 s54, s39, 384
buffer_load_dwordx4 v241, s[12:15], s54 offen offset:0 sc1 lds
buffer_load_dwordx4 v241, s[12:15], s54 offen offset:1024 sc1 lds
buffer_load_dwordx4 v241, s[12:15], s54 offen offset:2048 sc1 lds
buffer_load_dwordx4 v241, s[12:15], s54 offen offset:3072 sc1 lds
s_add_u32 s53, s53, 0x4000
s_and_b32 s53, s53, 0xffff
s_add_u32 m0, s53, 90112
s_add_u32 s54, s28, 0
buffer_load_dwordx4 v241, s[12:15], s54 offen offset:0 sc1 lds
buffer_load_dwordx4 v241, s[12:15], s54 offen offset:1024 sc1 lds
buffer_load_dwordx4 v241, s[12:15], s54 offen offset:2048 sc1 lds
buffer_load_dwordx4 v241, s[12:15], s54 offen offset:3072 sc1 lds
s_add_u32 m0, s53, 94208
s_add_u32 s54, s28, 128
buffer_load_dwordx4 v241, s[12:15], s54 offen offset:0 sc1 lds
buffer_load_dwordx4 v241, s[12:15], s54 offen offset:1024 sc1 lds
buffer_load_dwordx4 v241, s[12:15], s54 offen offset:2048 sc1 lds
buffer_load_dwordx4 v241, s[12:15], s54 offen offset:3072 sc1 lds
s_add_u32 m0, s53, 98304
s_add_u32 s54, s28, 256
buffer_load_dwordx4 v241, s[12:15], s54 offen offset:0 sc1 lds
buffer_load_dwordx4 v241, s[12:15], s54 offen offset:1024 sc1 lds
buffer_load_dwordx4 v241, s[12:15], s54 offen offset:2048 sc1 lds
buffer_load_dwordx4 v241, s[12:15], s54 offen offset:3072 sc1 lds
s_add_u32 m0, s53, 102400
s_add_u32 s54, s28, 384
buffer_load_dwordx4 v241, s[12:15], s54 offen offset:0 sc1 lds
buffer_load_dwordx4 v241, s[12:15], s54 offen offset:1024 sc1 lds
buffer_load_dwordx4 v241, s[12:15], s54 offen offset:2048 sc1 lds
buffer_load_dwordx4 v241, s[12:15], s54 offen offset:3072 sc1 lds
s_add_u32 s53, s53, 0x4000
s_and_b32 s53, s53, 0xffff
s_add_u32 s28, s28, 0x4000
s_add_u32 m0, s53, 90112
s_add_u32 s54, s28, 0
buffer_load_dwordx4 v241, s[12:15], s54 offen offset:0 sc1 lds
buffer_load_dwordx4 v241, s[12:15], s54 offen offset:1024 sc1 lds
buffer_load_dwordx4 v241, s[12:15], s54 offen offset:2048 sc1 lds
buffer_load_dwordx4 v241, s[12:15], s54 offen offset:3072 sc1 lds
s_add_u32 m0, s53, 94208
s_add_u32 s54, s28, 128
buffer_load_dwordx4 v241, s[12:15], s54 offen offset:0 sc1 lds
buffer_load_dwordx4 v241, s[12:15], s54 offen offset:1024 sc1 lds
buffer_load_dwordx4 v241, s[12:15], s54 offen offset:2048 sc1 lds
buffer_load_dwordx4 v241, s[12:15], s54 offen offset:3072 sc1 lds
s_add_u32 m0, s53, 98304
s_add_u32 s54, s28, 256
buffer_load_dwordx4 v241, s[12:15], s54 offen offset:0 sc1 lds
buffer_load_dwordx4 v241, s[12:15], s54 offen offset:1024 sc1 lds
buffer_load_dwordx4 v241, s[12:15], s54 offen offset:2048 sc1 lds
buffer_load_dwordx4 v241, s[12:15], s54 offen offset:3072 sc1 lds
s_add_u32 m0, s53, 102400
s_add_u32 s54, s28, 384
buffer_load_dwordx4 v241, s[12:15], s54 offen offset:0 sc1 lds
buffer_load_dwordx4 v241, s[12:15], s54 offen offset:1024 sc1 lds
buffer_load_dwordx4 v241, s[12:15], s54 offen offset:2048 sc1 lds
buffer_load_dwordx4 v241, s[12:15], s54 offen offset:3072 sc1 lds
s_add_u32 s53, s53, 0x4000
s_and_b32 s53, s53, 0xffff
s_add_u32 s28, s28, 0x4000
s_mul_i32 s35, s37, 0x600000
s_add_u32 s20, s4, 0x2000000
s_addc_u32 s21, s5, 0
s_add_u32 s20, s20, s35
s_addc_u32 s21, s21, 0
s_mov_b32 s22, 0x4e4000
s_mov_b32 s23, 0x00020000
s_add_u32 s24, s4, 0x6000000
s_addc_u32 s25, s5, 0
s_mov_b32 s26, 0x139000
s_mov_b32 s27, 0x00020000
s_lshl_b32 s48, s37, 3
s_add_u32 s48, s48, 638976
s_mov_b32 s48, 1277952
v_bfe_u32 v240, v243, 4, 3
v_lshlrev_b32 v240, 6, v240
v_bfe_u32 v242, v243, 7, 1
v_lshl_or_b32 v240, v242, 10, v240
v_bfe_u32 v242, v243, 8, 2
v_lshl_or_b32 v240, v242, 4, v240
v_bfe_u32 v242, v243, 6, 1
v_lshlrev_b32 v242, 5, v242
v_xor_b32 v240, v240, v242
v_and_b32 v246, 0x1c0, v243
v_bfe_u32 v242, v243, 9, 1
v_lshl_or_b32 v246, v242, 10, v246
v_bfe_u32 v242, v243, 8, 1
v_lshl_or_b32 v246, v242, 5, v246
v_bfe_u32 v242, v243, 4, 2
v_lshl_or_b32 v246, v242, 3, v246
v_xor_b32 v247, 32, v246
v_bfe_i32 v242, v243, 8, 1
v_and_b32 v192, s33, v242
v_and_b32 v193, s33, v242
v_and_b32 v194, s33, v242
v_and_b32 v195, s33, v242
s_add_u32 s51, s31, 0
s_mov_b32 s52, 90112
v_mov_b32 v172, 0xff800000
v_mov_b32 v173, 0
v_accvgpr_write_b32 a0, 0
v_accvgpr_write_b32 a1, 0
v_accvgpr_write_b32 a2, 0
v_accvgpr_write_b32 a3, 0
v_accvgpr_write_b32 a4, 0
v_accvgpr_write_b32 a5, 0
v_accvgpr_write_b32 a6, 0
v_accvgpr_write_b32 a7, 0
v_accvgpr_write_b32 a8, 0
v_accvgpr_write_b32 a9, 0
v_accvgpr_write_b32 a10, 0
v_accvgpr_write_b32 a11, 0
v_accvgpr_write_b32 a12, 0
v_accvgpr_write_b32 a13, 0
v_accvgpr_write_b32 a14, 0
v_accvgpr_write_b32 a15, 0
v_accvgpr_write_b32 a16, 0
v_accvgpr_write_b32 a17, 0
v_accvgpr_write_b32 a18, 0
v_accvgpr_write_b32 a19, 0
v_accvgpr_write_b32 a20, 0
v_accvgpr_write_b32 a21, 0
v_accvgpr_write_b32 a22, 0
v_accvgpr_write_b32 a23, 0
v_accvgpr_write_b32 a24, 0
v_accvgpr_write_b32 a25, 0
v_accvgpr_write_b32 a26, 0
v_accvgpr_write_b32 a27, 0
v_accvgpr_write_b32 a28, 0
v_accvgpr_write_b32 a29, 0
v_accvgpr_write_b32 a30, 0
v_accvgpr_write_b32 a31, 0
v_accvgpr_write_b32 a32, 0
v_accvgpr_write_b32 a33, 0
v_accvgpr_write_b32 a34, 0
v_accvgpr_write_b32 a35, 0
v_accvgpr_write_b32 a36, 0
v_accvgpr_write_b32 a37, 0
v_accvgpr_write_b32 a38, 0
v_accvgpr_write_b32 a39, 0
v_accvgpr_write_b32 a40, 0
v_accvgpr_write_b32 a41, 0
v_accvgpr_write_b32 a42, 0
v_accvgpr_write_b32 a43, 0
v_accvgpr_write_b32 a44, 0
v_accvgpr_write_b32 a45, 0
v_accvgpr_write_b32 a46, 0
v_accvgpr_write_b32 a47, 0
v_accvgpr_write_b32 a48, 0
v_accvgpr_write_b32 a49, 0
v_accvgpr_write_b32 a50, 0
v_accvgpr_write_b32 a51, 0
v_accvgpr_write_b32 a52, 0
v_accvgpr_write_b32 a53, 0
v_accvgpr_write_b32 a54, 0
v_accvgpr_write_b32 a55, 0
v_accvgpr_write_b32 a56, 0
v_accvgpr_write_b32 a57, 0
v_accvgpr_write_b32 a58, 0
v_accvgpr_write_b32 a59, 0
v_accvgpr_write_b32 a60, 0
v_accvgpr_write_b32 a61, 0
v_accvgpr_write_b32 a62, 0
v_accvgpr_write_b32 a63, 0
LT_loop:
s_add_u32 m0, s53, 90112
s_add_u32 s54, s28, 0
buffer_load_dwordx4 v241, s[12:15], s54 offen offset:0 sc1 lds
buffer_load_dwordx4 v241, s[12:15], s54 offen offset:1024 sc1 lds
buffer_load_dwordx4 v241, s[12:15], s54 offen offset:2048 sc1 lds
buffer_load_dwordx4 v241, s[12:15], s54 offen offset:3072 sc1 lds
s_add_u32 m0, s53, 94208
s_add_u32 s54, s28, 128
buffer_load_dwordx4 v241, s[12:15], s54 offen offset:0 sc1 lds
buffer_load_dwordx4 v241, s[12:15], s54 offen offset:1024 sc1 lds
buffer_load_dwordx4 v241, s[12:15], s54 offen offset:2048 sc1 lds
buffer_load_dwordx4 v241, s[12:15], s54 offen offset:3072 sc1 lds
s_add_u32 m0, s53, 98304
s_add_u32 s54, s28, 256
buffer_load_dwordx4 v241, s[12:15], s54 offen offset:0 sc1 lds
buffer_load_dwordx4 v241, s[12:15], s54 offen offset:1024 sc1 lds
buffer_load_dwordx4 v241, s[12:15], s54 offen offset:2048 sc1 lds
buffer_load_dwordx4 v241, s[12:15], s54 offen offset:3072 sc1 lds
s_add_u32 m0, s53, 102400
s_add_u32 s54, s28, 384
buffer_load_dwordx4 v241, s[12:15], s54 offen offset:0 sc1 lds
buffer_load_dwordx4 v241, s[12:15], s54 offen offset:1024 sc1 lds
buffer_load_dwordx4 v241, s[12:15], s54 offen offset:2048 sc1 lds
buffer_load_dwordx4 v241, s[12:15], s54 offen offset:3072 sc1 lds
s_add_u32 s53, s53, 0x4000
s_and_b32 s53, s53, 0xffff
s_add_u32 s28, s28, 0x4000
v_add_u32 v177, s52, v240
v_add_u32 v178, s52, v246
v_add_u32 v179, s52, v247
s_add_u32 s52, s52, 0x4000
s_cmp_eq_u32 s52, 155648
s_cselect_b32 s52, 90112, s52
s_waitcnt vmcnt(48)
ds_read_b128 v[32:35], v177 offset:0
ds_read_b128 v[64:67], v177 offset:2048
ds_read_b128 v[36:39], v177 offset:512
ds_read_b128 v[68:71], v177 offset:2560
ds_read_b128 v[40:43], v177 offset:4096
ds_read_b128 v[72:75], v177 offset:6144
ds_read_b128 v[44:47], v177 offset:4608
ds_read_b128 v[76:79], v177 offset:6656
ds_read_b128 v[48:51], v177 offset:8192
ds_read_b128 v[80:83], v177 offset:10240
ds_read_b128 v[52:55], v177 offset:8704
ds_read_b128 v[84:87], v177 offset:10752
ds_read_b128 v[56:59], v177 offset:12288
ds_read_b128 v[88:91], v177 offset:14336
ds_read_b128 v[60:63], v177 offset:12800
ds_read_b128 v[92:95], v177 offset:14848
s_waitcnt lgkmcnt(14)
v_mfma_f32_16x16x32_bf16 v[160:163], v[32:35], v[0:3], v[192:195]
v_mfma_f32_16x16x32_bf16 v[164:167], v[64:67], v[0:3], v[192:195]
s_waitcnt lgkmcnt(12)
v_mfma_f32_16x16x32_bf16 v[160:163], v[36:39], v[4:7], v[160:163]
v_mfma_f32_16x16x32_bf16 v[164:167], v[68:71], v[4:7], v[164:167]
s_waitcnt lgkmcnt(10)
v_mfma_f32_16x16x32_bf16 v[160:163], v[40:43], v[8:11], v[160:163]
v_mfma_f32_16x16x32_bf16 v[164:167], v[72:75], v[8:11], v[164:167]
s_waitcnt lgkmcnt(8)
v_mfma_f32_16x16x32_bf16 v[160:163], v[44:47], v[12:15], v[160:163]
v_mfma_f32_16x16x32_bf16 v[164:167], v[76:79], v[12:15], v[164:167]
s_waitcnt lgkmcnt(6)
v_mfma_f32_16x16x32_bf16 v[160:163], v[48:51], v[16:19], v[160:163]
v_mfma_f32_16x16x32_bf16 v[164:167], v[80:83], v[16:19], v[164:167]
s_waitcnt lgkmcnt(4)
v_mfma_f32_16x16x32_bf16 v[160:163], v[52:55], v[20:23], v[160:163]
v_mfma_f32_16x16x32_bf16 v[164:167], v[84:87], v[20:23], v[164:167]
s_waitcnt lgkmcnt(2)
v_mfma_f32_16x16x32_bf16 v[160:163], v[56:59], v[24:27], v[160:163]
v_mfma_f32_16x16x32_bf16 v[164:167], v[88:91], v[24:27], v[164:167]
s_waitcnt lgkmcnt(0)
v_mfma_f32_16x16x32_bf16 v[160:163], v[60:63], v[28:31], v[160:163]
v_mfma_f32_16x16x32_bf16 v[164:167], v[92:95], v[28:31], v[164:167]
ds_read_b64_tr_b16 v[96:97], v178 offset:0
ds_read_b64_tr_b16 v[98:99], v178 offset:2048
ds_read_b64_tr_b16 v[100:101], v179 offset:0
ds_read_b64_tr_b16 v[102:103], v179 offset:2048
ds_read_b64_tr_b16 v[104:105], v178 offset:512
ds_read_b64_tr_b16 v[106:107], v178 offset:2560
ds_read_b64_tr_b16 v[108:109], v179 offset:512
ds_read_b64_tr_b16 v[110:111], v179 offset:2560
ds_read_b64_tr_b16 v[112:113], v178 offset:4096
ds_read_b64_tr_b16 v[114:115], v178 offset:6144
ds_read_b64_tr_b16 v[116:117], v179 offset:4096
ds_read_b64_tr_b16 v[118:119], v179 offset:6144
ds_read_b64_tr_b16 v[120:121], v178 offset:4608
ds_read_b64_tr_b16 v[122:123], v178 offset:6656
ds_read_b64_tr_b16 v[124:125], v179 offset:4608
ds_read_b64_tr_b16 v[126:127], v179 offset:6656
ds_read_b64_tr_b16 v[128:129], v178 offset:8192
ds_read_b64_tr_b16 v[130:131], v178 offset:10240
ds_read_b64_tr_b16 v[132:133], v179 offset:8192
ds_read_b64_tr_b16 v[134:135], v179 offset:10240
ds_read_b64_tr_b16 v[136:137], v178 offset:8704
ds_read_b64_tr_b16 v[138:139], v178 offset:10752
ds_read_b64_tr_b16 v[140:141], v179 offset:8704
ds_read_b64_tr_b16 v[142:143], v179 offset:10752
ds_read_b64_tr_b16 v[144:145], v178 offset:12288
ds_read_b64_tr_b16 v[146:147], v178 offset:14336
ds_read_b64_tr_b16 v[148:149], v179 offset:12288
ds_read_b64_tr_b16 v[150:151], v179 offset:14336
ds_read_b64_tr_b16 v[152:153], v178 offset:12800
ds_read_b64_tr_b16 v[154:155], v178 offset:14848
ds_read_b64_tr_b16 v[156:157], v179 offset:12800
ds_read_b64_tr_b16 v[158:159], v179 offset:14848
v_mov_b32 v192, 0
v_mov_b32 v193, 0
v_mov_b32 v194, 0
v_mov_b32 v195, 0
s_nop 7
v_max3_f32 v175, v160, v161, v162
v_max3_f32 v175, v175, v163, v164
v_max3_f32 v175, v175, v165, v166
v_max3_f32 v175, v175, v167, v172
v_mov_b32 v176, v175
s_nop 1
v_permlane32_swap_b32 v175, v176
s_nop 1
v_max_f32 v175, v175, v176
v_mov_b32 v176, v175
s_nop 1
v_permlane16_swap_b32 v175, v176
s_nop 1
v_max_f32 v175, v175, v176
v_ceil_f32 v175, v175
v_sub_f32 v174, v172, v175
v_exp_f32 v174, v174
v_mov_b32 v172, v175
v_sub_f32 v160, v160, v172
v_sub_f32 v161, v161, v172
v_sub_f32 v162, v162, v172
v_sub_f32 v163, v163, v172
v_sub_f32 v164, v164, v172
v_sub_f32 v165, v165, v172
v_sub_f32 v166, v166, v172
v_sub_f32 v167, v167, v172
v_exp_f32 v160, v160
v_exp_f32 v161, v161
v_exp_f32 v162, v162
v_exp_f32 v163, v163
v_exp_f32 v164, v164
v_exp_f32 v165, v165
v_exp_f32 v166, v166
v_exp_f32 v167, v167
v_mul_f32 v173, v173, v174
v_cvt_pk_bf16_f32 v168, v160, v161
v_cvt_pk_bf16_f32 v169, v162, v163
v_cvt_pk_bf16_f32 v170, v164, v165
v_cvt_pk_bf16_f32 v171, v166, v167
v_cmp_neq_f32 vcc, 1.0, v174
v_add_f32 v173, v173, v160
v_add_f32 v173, v173, v161
v_add_f32 v173, v173, v162
v_add_f32 v173, v173, v163
v_add_f32 v173, v173, v164
v_add_f32 v173, v173, v165
v_add_f32 v173, v173, v166
v_add_f32 v173, v173, v167
s_cbranch_vccz LT_nors
v_lshrrev_b32 v176, 4, v243
v_and_b32 v176, 0x30, v176
ds_bpermute_b32 v188, v176, v174 offset:0
ds_bpermute_b32 v189, v176, v174 offset:4
ds_bpermute_b32 v190, v176, v174 offset:8
ds_bpermute_b32 v191, v176, v174 offset:12
s_waitcnt lgkmcnt(0)
v_accvgpr_read_b32 v180, a0
v_accvgpr_read_b32 v181, a1
v_accvgpr_read_b32 v182, a2
v_accvgpr_read_b32 v183, a3
v_accvgpr_read_b32 v184, a4
v_accvgpr_read_b32 v185, a5
v_accvgpr_read_b32 v186, a6
v_accvgpr_read_b32 v187, a7
v_mul_f32 v180, v180, v188
v_mul_f32 v181, v181, v189
v_mul_f32 v182, v182, v190
v_mul_f32 v183, v183, v191
v_mul_f32 v184, v184, v188
v_mul_f32 v185, v185, v189
v_mul_f32 v186, v186, v190
v_mul_f32 v187, v187, v191
v_accvgpr_write_b32 a0, v180
v_accvgpr_write_b32 a1, v181
v_accvgpr_write_b32 a2, v182
v_accvgpr_write_b32 a3, v183
v_accvgpr_write_b32 a4, v184
v_accvgpr_write_b32 a5, v185
v_accvgpr_write_b32 a6, v186
v_accvgpr_write_b32 a7, v187
v_accvgpr_read_b32 v180, a8
v_accvgpr_read_b32 v181, a9
v_accvgpr_read_b32 v182, a10
v_accvgpr_read_b32 v183, a11
v_accvgpr_read_b32 v184, a12
v_accvgpr_read_b32 v185, a13
v_accvgpr_read_b32 v186, a14
v_accvgpr_read_b32 v187, a15
v_mul_f32 v180, v180, v188
v_mul_f32 v181, v181, v189
v_mul_f32 v182, v182, v190
v_mul_f32 v183, v183, v191
v_mul_f32 v184, v184, v188
v_mul_f32 v185, v185, v189
v_mul_f32 v186, v186, v190
v_mul_f32 v187, v187, v191
v_accvgpr_write_b32 a8, v180
v_accvgpr_write_b32 a9, v181
v_accvgpr_write_b32 a10, v182
v_accvgpr_write_b32 a11, v183
v_accvgpr_write_b32 a12, v184
v_accvgpr_write_b32 a13, v185
v_accvgpr_write_b32 a14, v186
v_accvgpr_write_b32 a15, v187
v_accvgpr_read_b32 v180, a16
v_accvgpr_read_b32 v181, a17
v_accvgpr_read_b32 v182, a18
v_accvgpr_read_b32 v183, a19
v_accvgpr_read_b32 v184, a20
v_accvgpr_read_b32 v185, a21
v_accvgpr_read_b32 v186, a22
v_accvgpr_read_b32 v187, a23
v_mul_f32 v180, v180, v188
v_mul_f32 v181, v181, v189
v_mul_f32 v182, v182, v190
v_mul_f32 v183, v183, v191
v_mul_f32 v184, v184, v188
v_mul_f32 v185, v185, v189
v_mul_f32 v186, v186, v190
v_mul_f32 v187, v187, v191
v_accvgpr_write_b32 a16, v180
v_accvgpr_write_b32 a17, v181
v_accvgpr_write_b32 a18, v182
v_accvgpr_write_b32 a19, v183
v_accvgpr_write_b32 a20, v184
v_accvgpr_write_b32 a21, v185
v_accvgpr_write_b32 a22, v186
v_accvgpr_write_b32 a23, v187
v_accvgpr_read_b32 v180, a24
v_accvgpr_read_b32 v181, a25
v_accvgpr_read_b32 v182, a26
v_accvgpr_read_b32 v183, a27
v_accvgpr_read_b32 v184, a28
v_accvgpr_read_b32 v185, a29
v_accvgpr_read_b32 v186, a30
v_accvgpr_read_b32 v187, a31
v_mul_f32 v180, v180, v188
v_mul_f32 v181, v181, v189
v_mul_f32 v182, v182, v190
v_mul_f32 v183, v183, v191
v_mul_f32 v184, v184, v188
v_mul_f32 v185, v185, v189
v_mul_f32 v186, v186, v190
v_mul_f32 v187, v187, v191
v_accvgpr_write_b32 a24, v180
v_accvgpr_write_b32 a25, v181
v_accvgpr_write_b32 a26, v182
v_accvgpr_write_b32 a27, v183
v_accvgpr_write_b32 a28, v184
v_accvgpr_write_b32 a29, v185
v_accvgpr_write_b32 a30, v186
v_accvgpr_write_b32 a31, v187
v_accvgpr_read_b32 v180, a32
v_accvgpr_read_b32 v181, a33
v_accvgpr_read_b32 v182, a34
v_accvgpr_read_b32 v183, a35
v_accvgpr_read_b32 v184, a36
v_accvgpr_read_b32 v185, a37
v_accvgpr_read_b32 v186, a38
v_accvgpr_read_b32 v187, a39
v_mul_f32 v180, v180, v188
v_mul_f32 v181, v181, v189
v_mul_f32 v182, v182, v190
v_mul_f32 v183, v183, v191
v_mul_f32 v184, v184, v188
v_mul_f32 v185, v185, v189
v_mul_f32 v186, v186, v190
v_mul_f32 v187, v187, v191
v_accvgpr_write_b32 a32, v180
v_accvgpr_write_b32 a33, v181
v_accvgpr_write_b32 a34, v182
v_accvgpr_write_b32 a35, v183
v_accvgpr_write_b32 a36, v184
v_accvgpr_write_b32 a37, v185
v_accvgpr_write_b32 a38, v186
v_accvgpr_write_b32 a39, v187
v_accvgpr_read_b32 v180, a40
v_accvgpr_read_b32 v181, a41
v_accvgpr_read_b32 v182, a42
v_accvgpr_read_b32 v183, a43
v_accvgpr_read_b32 v184, a44
v_accvgpr_read_b32 v185, a45
v_accvgpr_read_b32 v186, a46
v_accvgpr_read_b32 v187, a47
v_mul_f32 v180, v180, v188
v_mul_f32 v181, v181, v189
v_mul_f32 v182, v182, v190
v_mul_f32 v183, v183, v191
v_mul_f32 v184, v184, v188
v_mul_f32 v185, v185, v189
v_mul_f32 v186, v186, v190
v_mul_f32 v187, v187, v191
v_accvgpr_write_b32 a40, v180
v_accvgpr_write_b32 a41, v181
v_accvgpr_write_b32 a42, v182
v_accvgpr_write_b32 a43, v183
v_accvgpr_write_b32 a44, v184
v_accvgpr_write_b32 a45, v185
v_accvgpr_write_b32 a46, v186
v_accvgpr_write_b32 a47, v187
v_accvgpr_read_b32 v180, a48
v_accvgpr_read_b32 v181, a49
v_accvgpr_read_b32 v182, a50
v_accvgpr_read_b32 v183, a51
v_accvgpr_read_b32 v184, a52
v_accvgpr_read_b32 v185, a53
v_accvgpr_read_b32 v186, a54
v_accvgpr_read_b32 v187, a55
v_mul_f32 v180, v180, v188
v_mul_f32 v181, v181, v189
v_mul_f32 v182, v182, v190
v_mul_f32 v183, v183, v191
v_mul_f32 v184, v184, v188
v_mul_f32 v185, v185, v189
v_mul_f32 v186, v186, v190
v_mul_f32 v187, v187, v191
v_accvgpr_write_b32 a48, v180
v_accvgpr_write_b32 a49, v181
v_accvgpr_write_b32 a50, v182
v_accvgpr_write_b32 a51, v183
v_accvgpr_write_b32 a52, v184
v_accvgpr_write_b32 a53, v185
v_accvgpr_write_b32 a54, v186
v_accvgpr_write_b32 a55, v187
v_accvgpr_read_b32 v180, a56
v_accvgpr_read_b32 v181, a57
v_accvgpr_read_b32 v182, a58
v_accvgpr_read_b32 v183, a59
v_accvgpr_read_b32 v184, a60
v_accvgpr_read_b32 v185, a61
v_accvgpr_read_b32 v186, a62
v_accvgpr_read_b32 v187, a63
v_mul_f32 v180, v180, v188
v_mul_f32 v181, v181, v189
v_mul_f32 v182, v182, v190
v_mul_f32 v183, v183, v191
v_mul_f32 v184, v184, v188
v_mul_f32 v185, v185, v189
v_mul_f32 v186, v186, v190
v_mul_f32 v187, v187, v191
v_accvgpr_write_b32 a56, v180
v_accvgpr_write_b32 a57, v181
v_accvgpr_write_b32 a58, v182
v_accvgpr_write_b32 a59, v183
v_accvgpr_write_b32 a60, v184
v_accvgpr_write_b32 a61, v185
v_accvgpr_write_b32 a62, v186
v_accvgpr_write_b32 a63, v187
LT_nors:
s_waitcnt lgkmcnt(0)
s_nop 1
v_mfma_f32_16x16x32_bf16 a[0:3], v[168:171], v[96:99], a[0:3]
v_mfma_f32_16x16x32_bf16 a[4:7], v[168:171], v[100:103], a[4:7]
v_mfma_f32_16x16x32_bf16 a[8:11], v[168:171], v[104:107], a[8:11]
v_mfma_f32_16x16x32_bf16 a[12:15], v[168:171], v[108:111], a[12:15]
v_mfma_f32_16x16x32_bf16 a[16:19], v[168:171], v[112:115], a[16:19]
v_mfma_f32_16x16x32_bf16 a[20:23], v[168:171], v[116:119], a[20:23]
v_mfma_f32_16x16x32_bf16 a[24:27], v[168:171], v[120:123], a[24:27]
v_mfma_f32_16x16x32_bf16 a[28:31], v[168:171], v[124:127], a[28:31]
v_mfma_f32_16x16x32_bf16 a[32:35], v[168:171], v[128:131], a[32:35]
v_mfma_f32_16x16x32_bf16 a[36:39], v[168:171], v[132:135], a[36:39]
v_mfma_f32_16x16x32_bf16 a[40:43], v[168:171], v[136:139], a[40:43]
v_mfma_f32_16x16x32_bf16 a[44:47], v[168:171], v[140:143], a[44:47]
v_mfma_f32_16x16x32_bf16 a[48:51], v[168:171], v[144:147], a[48:51]
v_mfma_f32_16x16x32_bf16 a[52:55], v[168:171], v[148:151], a[52:55]
v_mfma_f32_16x16x32_bf16 a[56:59], v[168:171], v[152:155], a[56:59]
v_mfma_f32_16x16x32_bf16 a[60:63], v[168:171], v[156:159], a[60:63]
s_sub_u32 s51, s51, 1
s_cmp_lg_u32 s51, 0
s_cbranch_scc1 LT_loop
s_nop 15
s_add_u32 s16, s4, 0x0
s_addc_u32 s17, s5, 0
s_mov_b32 s18, 0x10000000
s_mov_b32 s19, 0x00020000
s_mul_i32 s52, s37, 0x5000
s_add_u32 s52, s52, 0x1200000
s_add_u32 s53, s37, 1610
s_lshl_b32 s53, s53, 7
s_add_u32 s53, s53, 0x7c00000
s_waitcnt vmcnt(0)
s_cmp_eq_u32 s36, 0
s_cbranch_scc1 LT_merge
buffer_store_dwordx4 a[0:3], v243, s[16:19], s52 offen offset:0 sc1
buffer_store_dwordx4 a[4:7], v243, s[16:19], s52 offen offset:1024 sc1
buffer_store_dwordx4 a[8:11], v243, s[16:19], s52 offen offset:2048 sc1
buffer_store_dwordx4 a[12:15], v243, s[16:19], s52 offen offset:3072 sc1
s_add_u32 s52, s52, 4096
buffer_store_dwordx4 a[16:19], v243, s[16:19], s52 offen offset:0 sc1
buffer_store_dwordx4 a[20:23], v243, s[16:19], s52 offen offset:1024 sc1
buffer_store_dwordx4 a[24:27], v243, s[16:19], s52 offen offset:2048 sc1
buffer_store_dwordx4 a[28:31], v243, s[16:19], s52 offen offset:3072 sc1
s_add_u32 s52, s52, 4096
buffer_store_dwordx4 a[32:35], v243, s[16:19], s52 offen offset:0 sc1
buffer_store_dwordx4 a[36:39], v243, s[16:19], s52 offen offset:1024 sc1
buffer_store_dwordx4 a[40:43], v243, s[16:19], s52 offen offset:2048 sc1
buffer_store_dwordx4 a[44:47], v243, s[16:19], s52 offen offset:3072 sc1
s_add_u32 s52, s52, 4096
buffer_store_dwordx4 a[48:51], v243, s[16:19], s52 offen offset:0 sc1
buffer_store_dwordx4 a[52:55], v243, s[16:19], s52 offen offset:1024 sc1
buffer_store_dwordx4 a[56:59], v243, s[16:19], s52 offen offset:2048 sc1
buffer_store_dwordx4 a[60:63], v243, s[16:19], s52 offen offset:3072 sc1
s_add_u32 s52, s52, 4096
buffer_store_dwordx2 v[172:173], v243, s[16:19], s52 offen sc1
s_waitcnt vmcnt(0)
v_mov_b32 v176, s98
v_mov_b32 v177, s99
v_mov_b32 v178, s98
v_mov_b32 v179, s99
s_mov_b64 exec, 0xff
buffer_store_dwordx4 v[176:179], v243, s[16:19], s53 offen sc1
s_mov_b64 exec, -1
s_branch L2_fin
LT_merge:
s_mov_b32 s94, 0x10000
LT_mw:
buffer_load_dwordx2 v[0:1], off, s[16:19], s53 sc1
s_sub_u32 s94, s94, 1
s_waitcnt vmcnt(0)
s_cbranch_scc1 LT_mw_go
v_cmp_ne_u64 vcc, s[98:99], v[0:1]
s_nop 1
s_cbranch_vccnz LT_mw
LT_mw_go:
buffer_load_dwordx4 v[96:99], v243, s[16:19], s52 offen offset:0 sc1
buffer_load_dwordx4 v[100:103], v243, s[16:19], s52 offen offset:1024 sc1
buffer_load_dwordx4 v[104:107], v243, s[16:19], s52 offen offset:2048 sc1
buffer_load_dwordx4 v[108:111], v243, s[16:19], s52 offen offset:3072 sc1
s_add_u32 s52, s52, 4096
buffer_load_dwordx4 v[112:115], v243, s[16:19], s52 offen offset:0 sc1
buffer_load_dwordx4 v[116:119], v243, s[16:19], s52 offen offset:1024 sc1
buffer_load_dwordx4 v[120:123], v243, s[16:19], s52 offen offset:2048 sc1
buffer_load_dwordx4 v[124:127], v243, s[16:19], s52 offen offset:3072 sc1
s_add_u32 s52, s52, 4096
buffer_load_dwordx4 v[128:131], v243, s[16:19], s52 offen offset:0 sc1
buffer_load_dwordx4 v[132:135], v243, s[16:19], s52 offen offset:1024 sc1
buffer_load_dwordx4 v[136:139], v243, s[16:19], s52 offen offset:2048 sc1
buffer_load_dwordx4 v[140:143], v243, s[16:19], s52 offen offset:3072 sc1
s_add_u32 s52, s52, 4096
buffer_load_dwordx4 v[144:147], v243, s[16:19], s52 offen offset:0 sc1
buffer_load_dwordx4 v[148:151], v243, s[16:19], s52 offen offset:1024 sc1
buffer_load_dwordx4 v[152:155], v243, s[16:19], s52 offen offset:2048 sc1
buffer_load_dwordx4 v[156:159], v243, s[16:19], s52 offen offset:3072 sc1
s_add_u32 s52, s52, 4096
buffer_load_dwordx2 v[0:1], v243, s[16:19], s52 offen sc1
v_lshrrev_b32 v176, 4, v243
v_and_b32 v176, 0x30, v176
s_waitcnt vmcnt(0)
v_max_f32 v175, v172, v0
v_sub_f32 v2, v172, v175
v_sub_f32 v3, v0, v175
v_mov_b32 v172, v175
v_exp_f32 v2, v2
v_exp_f32 v3, v3
s_nop 0
v_mul_f32 v173, v173, v2
v_fmac_f32 v173, v1, v3
ds_bpermute_b32 v4, v176, v2 offset:0
ds_bpermute_b32 v8, v176, v3 offset:0
ds_bpermute_b32 v5, v176, v2 offset:4
ds_bpermute_b32 v9, v176, v3 offset:4
ds_bpermute_b32 v6, v176, v2 offset:8
ds_bpermute_b32 v10, v176, v3 offset:8
ds_bpermute_b32 v7, v176, v2 offset:12
ds_bpermute_b32 v11, v176, v3 offset:12
s_waitcnt lgkmcnt(0)
v_accvgpr_read_b32 v180, a0
v_accvgpr_read_b32 v181, a1
v_accvgpr_read_b32 v182, a2
v_accvgpr_read_b32 v183, a3
v_accvgpr_read_b32 v184, a4
v_accvgpr_read_b32 v185, a5
v_accvgpr_read_b32 v186, a6
v_accvgpr_read_b32 v187, a7
v_mul_f32 v180, v180, v4
v_mul_f32 v181, v181, v5
v_mul_f32 v182, v182, v6
v_mul_f32 v183, v183, v7
v_mul_f32 v184, v184, v4
v_mul_f32 v185, v185, v5
v_mul_f32 v186, v186, v6
v_mul_f32 v187, v187, v7
v_fmac_f32 v180, v96, v8
v_fmac_f32 v181, v97, v9
v_fmac_f32 v182, v98, v10
v_fmac_f32 v183, v99, v11
v_fmac_f32 v184, v100, v8
v_fmac_f32 v185, v101, v9
v_fmac_f32 v186, v102, v10
v_fmac_f32 v187, v103, v11
v_cvt_pk_bf16_f32 v32, v180, v181
v_cvt_pk_bf16_f32 v33, v182, v183
v_cvt_pk_bf16_f32 v34, v184, v185
v_cvt_pk_bf16_f32 v35, v186, v187
buffer_store_dwordx4 v[32:35], v243, s[20:23], s40 offen offset:0 sc1
v_accvgpr_read_b32 v180, a8
v_accvgpr_read_b32 v181, a9
v_accvgpr_read_b32 v182, a10
v_accvgpr_read_b32 v183, a11
v_accvgpr_read_b32 v184, a12
v_accvgpr_read_b32 v185, a13
v_accvgpr_read_b32 v186, a14
v_accvgpr_read_b32 v187, a15
v_mul_f32 v180, v180, v4
v_mul_f32 v181, v181, v5
v_mul_f32 v182, v182, v6
v_mul_f32 v183, v183, v7
v_mul_f32 v184, v184, v4
v_mul_f32 v185, v185, v5
v_mul_f32 v186, v186, v6
v_mul_f32 v187, v187, v7
v_fmac_f32 v180, v104, v8
v_fmac_f32 v181, v105, v9
v_fmac_f32 v182, v106, v10
v_fmac_f32 v183, v107, v11
v_fmac_f32 v184, v108, v8
v_fmac_f32 v185, v109, v9
v_fmac_f32 v186, v110, v10
v_fmac_f32 v187, v111, v11
v_cvt_pk_bf16_f32 v36, v180, v181
v_cvt_pk_bf16_f32 v37, v182, v183
v_cvt_pk_bf16_f32 v38, v184, v185
v_cvt_pk_bf16_f32 v39, v186, v187
buffer_store_dwordx4 v[36:39], v243, s[20:23], s40 offen offset:1024 sc1
v_accvgpr_read_b32 v180, a16
v_accvgpr_read_b32 v181, a17
v_accvgpr_read_b32 v182, a18
v_accvgpr_read_b32 v183, a19
v_accvgpr_read_b32 v184, a20
v_accvgpr_read_b32 v185, a21
v_accvgpr_read_b32 v186, a22
v_accvgpr_read_b32 v187, a23
v_mul_f32 v180, v180, v4
v_mul_f32 v181, v181, v5
v_mul_f32 v182, v182, v6
v_mul_f32 v183, v183, v7
v_mul_f32 v184, v184, v4
v_mul_f32 v185, v185, v5
v_mul_f32 v186, v186, v6
v_mul_f32 v187, v187, v7
v_fmac_f32 v180, v112, v8
v_fmac_f32 v181, v113, v9
v_fmac_f32 v182, v114, v10
v_fmac_f32 v183, v115, v11
v_fmac_f32 v184, v116, v8
v_fmac_f32 v185, v117, v9
v_fmac_f32 v186, v118, v10
v_fmac_f32 v187, v119, v11
v_cvt_pk_bf16_f32 v40, v180, v181
v_cvt_pk_bf16_f32 v41, v182, v183
v_cvt_pk_bf16_f32 v42, v184, v185
v_cvt_pk_bf16_f32 v43, v186, v187
buffer_store_dwordx4 v[40:43], v243, s[20:23], s40 offen offset:2048 sc1
v_accvgpr_read_b32 v180, a24
v_accvgpr_read_b32 v181, a25
v_accvgpr_read_b32 v182, a26
v_accvgpr_read_b32 v183, a27
v_accvgpr_read_b32 v184, a28
v_accvgpr_read_b32 v185, a29
v_accvgpr_read_b32 v186, a30
v_accvgpr_read_b32 v187, a31
v_mul_f32 v180, v180, v4
v_mul_f32 v181, v181, v5
v_mul_f32 v182, v182, v6
v_mul_f32 v183, v183, v7
v_mul_f32 v184, v184, v4
v_mul_f32 v185, v185, v5
v_mul_f32 v186, v186, v6
v_mul_f32 v187, v187, v7
v_fmac_f32 v180, v120, v8
v_fmac_f32 v181, v121, v9
v_fmac_f32 v182, v122, v10
v_fmac_f32 v183, v123, v11
v_fmac_f32 v184, v124, v8
v_fmac_f32 v185, v125, v9
v_fmac_f32 v186, v126, v10
v_fmac_f32 v187, v127, v11
v_cvt_pk_bf16_f32 v44, v180, v181
v_cvt_pk_bf16_f32 v45, v182, v183
v_cvt_pk_bf16_f32 v46, v184, v185
v_cvt_pk_bf16_f32 v47, v186, v187
buffer_store_dwordx4 v[44:47], v243, s[20:23], s40 offen offset:3072 sc1
v_accvgpr_read_b32 v180, a32
v_accvgpr_read_b32 v181, a33
v_accvgpr_read_b32 v182, a34
v_accvgpr_read_b32 v183, a35
v_accvgpr_read_b32 v184, a36
v_accvgpr_read_b32 v185, a37
v_accvgpr_read_b32 v186, a38
v_accvgpr_read_b32 v187, a39
v_mul_f32 v180, v180, v4
v_mul_f32 v181, v181, v5
v_mul_f32 v182, v182, v6
v_mul_f32 v183, v183, v7
v_mul_f32 v184, v184, v4
v_mul_f32 v185, v185, v5
v_mul_f32 v186, v186, v6
v_mul_f32 v187, v187, v7
v_fmac_f32 v180, v128, v8
v_fmac_f32 v181, v129, v9
v_fmac_f32 v182, v130, v10
v_fmac_f32 v183, v131, v11
v_fmac_f32 v184, v132, v8
v_fmac_f32 v185, v133, v9
v_fmac_f32 v186, v134, v10
v_fmac_f32 v187, v135, v11
v_cvt_pk_bf16_f32 v48, v180, v181
v_cvt_pk_bf16_f32 v49, v182, v183
v_cvt_pk_bf16_f32 v50, v184, v185
v_cvt_pk_bf16_f32 v51, v186, v187
buffer_store_dwordx4 v[48:51], v243, s[20:23], s44 offen offset:0 sc1
v_accvgpr_read_b32 v180, a40
v_accvgpr_read_b32 v181, a41
v_accvgpr_read_b32 v182, a42
v_accvgpr_read_b32 v183, a43
v_accvgpr_read_b32 v184, a44
v_accvgpr_read_b32 v185, a45
v_accvgpr_read_b32 v186, a46
v_accvgpr_read_b32 v187, a47
v_mul_f32 v180, v180, v4
v_mul_f32 v181, v181, v5
v_mul_f32 v182, v182, v6
v_mul_f32 v183, v183, v7
v_mul_f32 v184, v184, v4
v_mul_f32 v185, v185, v5
v_mul_f32 v186, v186, v6
v_mul_f32 v187, v187, v7
v_fmac_f32 v180, v136, v8
v_fmac_f32 v181, v137, v9
v_fmac_f32 v182, v138, v10
v_fmac_f32 v183, v139, v11
v_fmac_f32 v184, v140, v8
v_fmac_f32 v185, v141, v9
v_fmac_f32 v186, v142, v10
v_fmac_f32 v187, v143, v11
v_cvt_pk_bf16_f32 v52, v180, v181
v_cvt_pk_bf16_f32 v53, v182, v183
v_cvt_pk_bf16_f32 v54, v184, v185
v_cvt_pk_bf16_f32 v55, v186, v187
buffer_store_dwordx4 v[52:55], v243, s[20:23], s44 offen offset:1024 sc1
v_accvgpr_read_b32 v180, a48
v_accvgpr_read_b32 v181, a49
v_accvgpr_read_b32 v182, a50
v_accvgpr_read_b32 v183, a51
v_accvgpr_read_b32 v184, a52
v_accvgpr_read_b32 v185, a53
v_accvgpr_read_b32 v186, a54
v_accvgpr_read_b32 v187, a55
v_mul_f32 v180, v180, v4
v_mul_f32 v181, v181, v5
v_mul_f32 v182, v182, v6
v_mul_f32 v183, v183, v7
v_mul_f32 v184, v184, v4
v_mul_f32 v185, v185, v5
v_mul_f32 v186, v186, v6
v_mul_f32 v187, v187, v7
v_fmac_f32 v180, v144, v8
v_fmac_f32 v181, v145, v9
v_fmac_f32 v182, v146, v10
v_fmac_f32 v183, v147, v11
v_fmac_f32 v184, v148, v8
v_fmac_f32 v185, v149, v9
v_fmac_f32 v186, v150, v10
v_fmac_f32 v187, v151, v11
v_cvt_pk_bf16_f32 v56, v180, v181
v_cvt_pk_bf16_f32 v57, v182, v183
v_cvt_pk_bf16_f32 v58, v184, v185
v_cvt_pk_bf16_f32 v59, v186, v187
buffer_store_dwordx4 v[56:59], v243, s[20:23], s44 offen offset:2048 sc1
v_accvgpr_read_b32 v180, a56
v_accvgpr_read_b32 v181, a57
v_accvgpr_read_b32 v182, a58
v_accvgpr_read_b32 v183, a59
v_accvgpr_read_b32 v184, a60
v_accvgpr_read_b32 v185, a61
v_accvgpr_read_b32 v186, a62
v_accvgpr_read_b32 v187, a63
v_mul_f32 v180, v180, v4
v_mul_f32 v181, v181, v5
v_mul_f32 v182, v182, v6
v_mul_f32 v183, v183, v7
v_mul_f32 v184, v184, v4
v_mul_f32 v185, v185, v5
v_mul_f32 v186, v186, v6
v_mul_f32 v187, v187, v7
v_fmac_f32 v180, v152, v8
v_fmac_f32 v181, v153, v9
v_fmac_f32 v182, v154, v10
v_fmac_f32 v183, v155, v11
v_fmac_f32 v184, v156, v8
v_fmac_f32 v185, v157, v9
v_fmac_f32 v186, v158, v10
v_fmac_f32 v187, v159, v11
v_cvt_pk_bf16_f32 v60, v180, v181
v_cvt_pk_bf16_f32 v61, v182, v183
v_cvt_pk_bf16_f32 v62, v184, v185
v_cvt_pk_bf16_f32 v63, v186, v187
buffer_store_dwordx4 v[60:63], v243, s[20:23], s44 offen offset:3072 sc1
v_mov_b32 v176, v173
s_nop 1
v_permlane32_swap_b32 v173, v176
s_nop 1
v_add_f32 v173, v173, v176
v_mov_b32 v176, v173
s_nop 1
v_permlane16_swap_b32 v173, v176
s_nop 1
v_add_f32 v173, v173, v176
v_lshlrev_b32 v175, 2, v243
s_mov_b64 exec, 0xffff
s_mov_b64 exec, -1
v_bfe_u32 v175, v243, 8, 1
v_mul_u32_u24 v175, 768, v175
v_lshl_add_u32 v175, s37, 7, v175
v_bfe_u32 v176, v243, 4, 4
v_lshl_add_u32 v175, v176, 3, v175
s_mov_b32 exec_hi, 0
buffer_store_dwordx2 v[172:173], v175, s[24:27], s48 offen sc1
s_add_u32 s16, s4, 0x7c00000
s_addc_u32 s17, s5, 0
s_mov_b32 s18, 0x40000
s_mov_b32 s19, 0x00020000
s_add_u32 s48, s37, 1248
s_mul_i32 s48, s48, 128
s_waitcnt vmcnt(0)
v_mov_b32 v176, s98
v_mov_b32 v177, s99
v_mov_b32 v178, s98
v_mov_b32 v179, s99
s_mov_b64 exec, 0xff
buffer_store_dwordx4 v[176:179], v243, s[16:19], s48 offen sc1
s_mov_b64 exec, -1
s_branch L2_fin
LE_start:
s_cmp_ge_u32 s37, 32
s_cbranch_scc1 L2_end
v_lshrrev_b32 v1, 6, v0
s_sub_u32 s37, s37, 30
s_lshl_b32 s35, s35, 1
v_readfirstlane_b32 s41, v1
s_add_u32 s35, s35, s37
s_mul_i32 s35, s35, 3
s_add_u32 s40, s35, s41
s_cmp_ge_u32 s41, 3
s_cbranch_scc1 L2_end
LE_common:
v_and_b32 v1, 63, v0
s_sub_u32 s36, s40, 0
s_mov_b32 s54, 151
s_mul_i32 s36, s36, 151
s_mov_b32 s55, s36
s_sub_u32 s36, s40, 36
s_cselect_b32 s54, s54, 166
s_mul_i32 s36, s36, 166
s_add_u32 s36, s36, 5436
s_cmp_lt_u32 s40, 36
s_cselect_b32 s55, s55, s36
s_sub_u32 s36, s40, 42
s_cselect_b32 s54, s54, 152
s_mul_i32 s36, s36, 152
s_add_u32 s36, s36, 6432
s_cmp_lt_u32 s40, 42
s_cselect_b32 s55, s55, s36
s_sub_u32 s36, s40, 48
s_cselect_b32 s54, s54, 168
s_mul_i32 s36, s36, 168
s_add_u32 s36, s36, 7344
s_cmp_lt_u32 s40, 48
s_cselect_b32 s55, s55, s36
s_mov_b32 s42, 0
s_mov_b32 s49, 512
v_lshrrev_b32 v33, 2, v1
v_and_b32 v34, 3, v1
v_mul_u32_u24 v6, 0x400, v33
v_lshl_add_u32 v6, v34, 4, v6
v_lshlrev_b32 v33, 8, v33
s_mul_i32 s50, s40, 16384
s_lshl_b32 s48, s40, 2
s_waitcnt lgkmcnt(0)
s_add_u32 s8, s4, 0x7c31800
s_addc_u32 s9, s5, 0
s_mov_b32 s10, 0x800
s_mov_b32 s11, 0x00020000
v_and_b32 v194, 15, v0
v_lshlrev_b32 v194, 7, v194
s_mov_b32 s94, 0x10000
LE_poll0:
buffer_load_dwordx2 v[192:193], v194, s[8:11], 0 offen sc1
s_sub_u32 s94, s94, 1
s_waitcnt vmcnt(0)
s_cbranch_scc1 LE_poll0_go
v_cmp_ne_u64 vcc, s[98:99], v[192:193]
s_nop 1
s_cbranch_vccnz LE_poll0
LE_poll0_go:
s_add_u32 s8, s4, 0x7800000
s_addc_u32 s9, s5, 0
s_mov_b32 s10, 0x1000
s_mov_b32 s11, 0x00020000
s_add_u32 s12, s4, 0x8000000
s_addc_u32 s13, s5, 0
s_mov_b32 s14, 0x2800000
s_mov_b32 s15, 0x00020000
buffer_load_dword v4, v33, s[8:11], s48 offen sc1
buffer_load_dwordx4 v[192:195], v6, s[12:15], s50 offen offset:0 sc1
buffer_load_dwordx4 v[196:199], v6, s[12:15], s50 offen offset:64 sc1
buffer_load_dwordx4 v[200:203], v6, s[12:15], s50 offen offset:128 sc1
buffer_load_dwordx4 v[204:207], v6, s[12:15], s50 offen offset:192 sc1
buffer_load_dwordx4 v[208:211], v6, s[12:15], s50 offen offset:256 sc1
buffer_load_dwordx4 v[212:215], v6, s[12:15], s50 offen offset:320 sc1
buffer_load_dwordx4 v[216:219], v6, s[12:15], s50 offen offset:384 sc1
buffer_load_dwordx4 v[220:223], v6, s[12:15], s50 offen offset:448 sc1
buffer_load_dwordx4 v[224:227], v6, s[12:15], s50 offen offset:512 sc1
buffer_load_dwordx4 v[228:231], v6, s[12:15], s50 offen offset:576 sc1
buffer_load_dwordx4 v[232:235], v6, s[12:15], s50 offen offset:640 sc1
buffer_load_dwordx4 v[236:239], v6, s[12:15], s50 offen offset:704 sc1
buffer_load_dwordx4 v[240:243], v6, s[12:15], s50 offen offset:768 sc1
buffer_load_dwordx4 v[244:247], v6, s[12:15], s50 offen offset:832 sc1
buffer_load_dwordx4 v[248:251], v6, s[12:15], s50 offen offset:896 sc1
buffer_load_dwordx4 v[252:255], v6, s[12:15], s50 offen offset:960 sc1
s_add_u32 s16, s4, 0x6800000
s_addc_u32 s17, s5, 0
s_mov_b32 s18, 0x4e2000
s_mov_b32 s19, 0x00020000
s_add_u32 s20, s4, 0x7000000
s_addc_u32 s21, s5, 0
s_mov_b32 s22, 0x4e2000
s_mov_b32 s23, 0x00020000
v_lshlrev_b32 v5, 2, v34
v_and_b32 v2, 15, v1
v_lshrrev_b32 v3, 4, v1
v_mov_b32 v16, 1
v_mov_b32 v17, 4
v_and_b32 v33, 1, v2
v_lshlrev_b32 v33, 4, v33
v_lshlrev_b32 v33, v33, v16
v_mul_u32_u24 v33, 0x3f80, v33
v_lshrrev_b32 v34, 1, v2
v_cmp_eq_u32 vcc, 0, v34
s_nop 1
v_cndmask_b32 v40, 0, v33, vcc
v_cmp_eq_u32 vcc, 1, v34
s_nop 1
v_cndmask_b32 v41, 0, v33, vcc
v_cmp_eq_u32 vcc, 2, v34
s_nop 1
v_cndmask_b32 v42, 0, v33, vcc
v_cmp_eq_u32 vcc, 3, v34
s_nop 1
v_cndmask_b32 v43, 0, v33, vcc
v_cmp_eq_u32 vcc, 4, v34
s_nop 1
v_cndmask_b32 v44, 0, v33, vcc
v_cmp_eq_u32 vcc, 5, v34
s_nop 1
v_cndmask_b32 v45, 0, v33, vcc
v_cmp_eq_u32 vcc, 6, v34
s_nop 1
v_cndmask_b32 v46, 0, v33, vcc
v_cmp_eq_u32 vcc, 7, v34
s_nop 1
v_cndmask_b32 v47, 0, v33, vcc
v_lshlrev_b32 v39, 5, v2
v_lshl_add_u32 v39, v3, 3, v39
v_lshlrev_b32 v2, 4, v2
s_mul_i32 s48, s41, 21504
s_add_u32 s48, s48, 4096
v_mov_b32 v36, s48
v_lshl_add_u32 v38, v3, 2, v36
s_lshl_b32 s36, s41, 10
s_lshl_b32 s35, s55, 2
s_sub_u32 s35, s36, s35
v_mov_b32 v7, s35
v_lshlrev_b32 v35, 4, v1
v_add_u32 v68, s48, v35
v_add_u32 v35, s36, v35
v_lshlrev_b32 v33, 2, v1
v_mov_b32 v72, 0xffff
v_mov_b32 v73, 0xffff
v_mov_b32 v74, 0xffff
v_mov_b32 v75, 0xffff
v_cmp_gt_u32 vcc, s54, v33
v_mov_b32 v48, 0
s_nop 0
v_cndmask_b32 v18, 0, v16, vcc
v_add_u32 v33, 1, v33
v_cmp_gt_u32 vcc, s54, v33
v_mov_b32 v49, 0
s_nop 0
v_cndmask_b32 v19, 0, v16, vcc
v_add_u32 v33, 1, v33
v_cmp_gt_u32 vcc, s54, v33
v_mov_b32 v50, 0
s_nop 0
v_cndmask_b32 v20, 0, v16, vcc
v_add_u32 v33, 1, v33
v_cmp_gt_u32 vcc, s54, v33
v_mov_b32 v51, 0
s_nop 0
v_cndmask_b32 v21, 0, v16, vcc
LE_pass:
ds_write_b128 v35, v[48:51]
ds_write_b128 v68, v[72:75] offset:0
ds_write_b128 v68, v[72:75] offset:1024
ds_write_b128 v68, v[72:75] offset:2048
ds_write_b128 v68, v[72:75] offset:3072
ds_write_b128 v68, v[72:75] offset:4096
ds_write_b128 v68, v[72:75] offset:5120
ds_write_b128 v68, v[72:75] offset:6144
ds_write_b128 v68, v[72:75] offset:7168
ds_write_b128 v68, v[72:75] offset:8192
ds_write_b128 v68, v[72:75] offset:9216
ds_write_b128 v68, v[72:75] offset:10240
ds_write_b128 v68, v[72:75] offset:11264
ds_write_b128 v68, v[72:75] offset:12288
ds_write_b128 v68, v[72:75] offset:13312
ds_write_b128 v68, v[72:75] offset:14336
ds_write_b128 v68, v[72:75] offset:15360
ds_write_b128 v68, v[72:75] offset:16384
ds_write_b128 v68, v[72:75] offset:17408
ds_write_b128 v68, v[72:75] offset:18432
ds_write_b128 v68, v[72:75] offset:19456
v_lshl_add_u32 v32, v1, 2, v36
ds_write_b32 v32, v48 offset:20480
s_waitcnt vmcnt(16)
v_sub_u32 v32, v4, v5
s_waitcnt vmcnt(15)
v_cmpx_lt_i32 vcc, 0, v32
s_cbranch_execz LE_c
v_mad_u32_u16 v128, v192, 1, v7 op_sel:[1,0,0,0]
ds_add_u32 v128, v16
v_cmpx_lt_i32 vcc, 1, v32
v_mad_u32_u16 v129, v193, 1, v7 op_sel:[1,0,0,0]
ds_add_u32 v129, v16
v_cmpx_lt_i32 vcc, 2, v32
v_mad_u32_u16 v130, v194, 1, v7 op_sel:[1,0,0,0]
ds_add_u32 v130, v16
v_cmpx_lt_i32 vcc, 3, v32
v_mad_u32_u16 v131, v195, 1, v7 op_sel:[1,0,0,0]
ds_add_u32 v131, v16
s_waitcnt vmcnt(14)
v_cmpx_lt_i32 vcc, 16, v32
s_cbranch_execz LE_c
v_mad_u32_u16 v132, v196, 1, v7 op_sel:[1,0,0,0]
ds_add_u32 v132, v16
v_cmpx_lt_i32 vcc, 17, v32
v_mad_u32_u16 v133, v197, 1, v7 op_sel:[1,0,0,0]
ds_add_u32 v133, v16
v_cmpx_lt_i32 vcc, 18, v32
v_mad_u32_u16 v134, v198, 1, v7 op_sel:[1,0,0,0]
ds_add_u32 v134, v16
v_cmpx_lt_i32 vcc, 19, v32
v_mad_u32_u16 v135, v199, 1, v7 op_sel:[1,0,0,0]
ds_add_u32 v135, v16
s_waitcnt vmcnt(13)
v_cmpx_lt_i32 vcc, 32, v32
s_cbranch_execz LE_c
v_mad_u32_u16 v136, v200, 1, v7 op_sel:[1,0,0,0]
ds_add_u32 v136, v16
v_cmpx_lt_i32 vcc, 33, v32
v_mad_u32_u16 v137, v201, 1, v7 op_sel:[1,0,0,0]
ds_add_u32 v137, v16
v_cmpx_lt_i32 vcc, 34, v32
v_mad_u32_u16 v138, v202, 1, v7 op_sel:[1,0,0,0]
ds_add_u32 v138, v16
v_cmpx_lt_i32 vcc, 35, v32
v_mad_u32_u16 v139, v203, 1, v7 op_sel:[1,0,0,0]
ds_add_u32 v139, v16
s_waitcnt vmcnt(12)
v_cmpx_lt_i32 vcc, 48, v32
s_cbranch_execz LE_c
v_mad_u32_u16 v140, v204, 1, v7 op_sel:[1,0,0,0]
ds_add_u32 v140, v16
v_cmpx_lt_i32 vcc, 49, v32
v_mad_u32_u16 v141, v205, 1, v7 op_sel:[1,0,0,0]
ds_add_u32 v141, v16
v_cmpx_lt_i32 vcc, 50, v32
v_mad_u32_u16 v142, v206, 1, v7 op_sel:[1,0,0,0]
ds_add_u32 v142, v16
v_cmpx_lt_i32 vcc, 51, v32
v_mad_u32_u16 v143, v207, 1, v7 op_sel:[1,0,0,0]
ds_add_u32 v143, v16
s_waitcnt vmcnt(11)
v_cmpx_lt_i32 vcc, 64, v32
s_cbranch_execz LE_c
v_mad_u32_u16 v144, v208, 1, v7 op_sel:[1,0,0,0]
ds_add_u32 v144, v16
v_cmpx_lt_i32 vcc, 65, v32
v_mad_u32_u16 v145, v209, 1, v7 op_sel:[1,0,0,0]
ds_add_u32 v145, v16
v_cmpx_lt_i32 vcc, 66, v32
v_mad_u32_u16 v146, v210, 1, v7 op_sel:[1,0,0,0]
ds_add_u32 v146, v16
v_cmpx_lt_i32 vcc, 67, v32
v_mad_u32_u16 v147, v211, 1, v7 op_sel:[1,0,0,0]
ds_add_u32 v147, v16
s_waitcnt vmcnt(10)
v_cmpx_lt_i32 vcc, 80, v32
s_cbranch_execz LE_c
v_mad_u32_u16 v148, v212, 1, v7 op_sel:[1,0,0,0]
ds_add_u32 v148, v16
v_cmpx_lt_i32 vcc, 81, v32
v_mad_u32_u16 v149, v213, 1, v7 op_sel:[1,0,0,0]
ds_add_u32 v149, v16
v_cmpx_lt_i32 vcc, 82, v32
v_mad_u32_u16 v150, v214, 1, v7 op_sel:[1,0,0,0]
ds_add_u32 v150, v16
v_cmpx_lt_i32 vcc, 83, v32
v_mad_u32_u16 v151, v215, 1, v7 op_sel:[1,0,0,0]
ds_add_u32 v151, v16
s_waitcnt vmcnt(9)
v_cmpx_lt_i32 vcc, 96, v32
s_cbranch_execz LE_c
v_mad_u32_u16 v152, v216, 1, v7 op_sel:[1,0,0,0]
ds_add_u32 v152, v16
v_cmpx_lt_i32 vcc, 97, v32
v_mad_u32_u16 v153, v217, 1, v7 op_sel:[1,0,0,0]
ds_add_u32 v153, v16
v_cmpx_lt_i32 vcc, 98, v32
v_mad_u32_u16 v154, v218, 1, v7 op_sel:[1,0,0,0]
ds_add_u32 v154, v16
v_cmpx_lt_i32 vcc, 99, v32
v_mad_u32_u16 v155, v219, 1, v7 op_sel:[1,0,0,0]
ds_add_u32 v155, v16
s_waitcnt vmcnt(8)
v_cmpx_lt_i32 vcc, 112, v32
s_cbranch_execz LE_c
v_mad_u32_u16 v156, v220, 1, v7 op_sel:[1,0,0,0]
ds_add_u32 v156, v16
v_cmpx_lt_i32 vcc, 113, v32
v_mad_u32_u16 v157, v221, 1, v7 op_sel:[1,0,0,0]
ds_add_u32 v157, v16
v_cmpx_lt_i32 vcc, 114, v32
v_mad_u32_u16 v158, v222, 1, v7 op_sel:[1,0,0,0]
ds_add_u32 v158, v16
v_cmpx_lt_i32 vcc, 115, v32
v_mad_u32_u16 v159, v223, 1, v7 op_sel:[1,0,0,0]
ds_add_u32 v159, v16
s_waitcnt vmcnt(7)
v_cmpx_lt_i32 vcc, 128, v32
s_cbranch_execz LE_c
v_mad_u32_u16 v160, v224, 1, v7 op_sel:[1,0,0,0]
ds_add_u32 v160, v16
v_cmpx_lt_i32 vcc, 129, v32
v_mad_u32_u16 v161, v225, 1, v7 op_sel:[1,0,0,0]
ds_add_u32 v161, v16
v_cmpx_lt_i32 vcc, 130, v32
v_mad_u32_u16 v162, v226, 1, v7 op_sel:[1,0,0,0]
ds_add_u32 v162, v16
v_cmpx_lt_i32 vcc, 131, v32
v_mad_u32_u16 v163, v227, 1, v7 op_sel:[1,0,0,0]
ds_add_u32 v163, v16
s_waitcnt vmcnt(6)
v_cmpx_lt_i32 vcc, 144, v32
s_cbranch_execz LE_c
v_mad_u32_u16 v164, v228, 1, v7 op_sel:[1,0,0,0]
ds_add_u32 v164, v16
v_cmpx_lt_i32 vcc, 145, v32
v_mad_u32_u16 v165, v229, 1, v7 op_sel:[1,0,0,0]
ds_add_u32 v165, v16
v_cmpx_lt_i32 vcc, 146, v32
v_mad_u32_u16 v166, v230, 1, v7 op_sel:[1,0,0,0]
ds_add_u32 v166, v16
v_cmpx_lt_i32 vcc, 147, v32
v_mad_u32_u16 v167, v231, 1, v7 op_sel:[1,0,0,0]
ds_add_u32 v167, v16
s_waitcnt vmcnt(5)
v_cmpx_lt_i32 vcc, 160, v32
s_cbranch_execz LE_c
v_mad_u32_u16 v168, v232, 1, v7 op_sel:[1,0,0,0]
ds_add_u32 v168, v16
v_cmpx_lt_i32 vcc, 161, v32
v_mad_u32_u16 v169, v233, 1, v7 op_sel:[1,0,0,0]
ds_add_u32 v169, v16
v_cmpx_lt_i32 vcc, 162, v32
v_mad_u32_u16 v170, v234, 1, v7 op_sel:[1,0,0,0]
ds_add_u32 v170, v16
v_cmpx_lt_i32 vcc, 163, v32
v_mad_u32_u16 v171, v235, 1, v7 op_sel:[1,0,0,0]
ds_add_u32 v171, v16
s_waitcnt vmcnt(4)
v_cmpx_lt_i32 vcc, 176, v32
s_cbranch_execz LE_c
v_mad_u32_u16 v172, v236, 1, v7 op_sel:[1,0,0,0]
ds_add_u32 v172, v16
v_cmpx_lt_i32 vcc, 177, v32
v_mad_u32_u16 v173, v237, 1, v7 op_sel:[1,0,0,0]
ds_add_u32 v173, v16
v_cmpx_lt_i32 vcc, 178, v32
v_mad_u32_u16 v174, v238, 1, v7 op_sel:[1,0,0,0]
ds_add_u32 v174, v16
v_cmpx_lt_i32 vcc, 179, v32
v_mad_u32_u16 v175, v239, 1, v7 op_sel:[1,0,0,0]
ds_add_u32 v175, v16
s_waitcnt vmcnt(3)
v_cmpx_lt_i32 vcc, 192, v32
s_cbranch_execz LE_c
v_mad_u32_u16 v176, v240, 1, v7 op_sel:[1,0,0,0]
ds_add_u32 v176, v16
v_cmpx_lt_i32 vcc, 193, v32
v_mad_u32_u16 v177, v241, 1, v7 op_sel:[1,0,0,0]
ds_add_u32 v177, v16
v_cmpx_lt_i32 vcc, 194, v32
v_mad_u32_u16 v178, v242, 1, v7 op_sel:[1,0,0,0]
ds_add_u32 v178, v16
v_cmpx_lt_i32 vcc, 195, v32
v_mad_u32_u16 v179, v243, 1, v7 op_sel:[1,0,0,0]
ds_add_u32 v179, v16
s_waitcnt vmcnt(2)
v_cmpx_lt_i32 vcc, 208, v32
s_cbranch_execz LE_c
v_mad_u32_u16 v180, v244, 1, v7 op_sel:[1,0,0,0]
ds_add_u32 v180, v16
v_cmpx_lt_i32 vcc, 209, v32
v_mad_u32_u16 v181, v245, 1, v7 op_sel:[1,0,0,0]
ds_add_u32 v181, v16
v_cmpx_lt_i32 vcc, 210, v32
v_mad_u32_u16 v182, v246, 1, v7 op_sel:[1,0,0,0]
ds_add_u32 v182, v16
v_cmpx_lt_i32 vcc, 211, v32
v_mad_u32_u16 v183, v247, 1, v7 op_sel:[1,0,0,0]
ds_add_u32 v183, v16
s_waitcnt vmcnt(1)
v_cmpx_lt_i32 vcc, 224, v32
s_cbranch_execz LE_c
v_mad_u32_u16 v184, v248, 1, v7 op_sel:[1,0,0,0]
ds_add_u32 v184, v16
v_cmpx_lt_i32 vcc, 225, v32
v_mad_u32_u16 v185, v249, 1, v7 op_sel:[1,0,0,0]
ds_add_u32 v185, v16
v_cmpx_lt_i32 vcc, 226, v32
v_mad_u32_u16 v186, v250, 1, v7 op_sel:[1,0,0,0]
ds_add_u32 v186, v16
v_cmpx_lt_i32 vcc, 227, v32
v_mad_u32_u16 v187, v251, 1, v7 op_sel:[1,0,0,0]
ds_add_u32 v187, v16
s_waitcnt vmcnt(0)
v_cmpx_lt_i32 vcc, 240, v32
s_cbranch_execz LE_c
v_mad_u32_u16 v188, v252, 1, v7 op_sel:[1,0,0,0]
ds_add_u32 v188, v16
v_cmpx_lt_i32 vcc, 241, v32
v_mad_u32_u16 v189, v253, 1, v7 op_sel:[1,0,0,0]
ds_add_u32 v189, v16
v_cmpx_lt_i32 vcc, 242, v32
v_mad_u32_u16 v190, v254, 1, v7 op_sel:[1,0,0,0]
ds_add_u32 v190, v16
v_cmpx_lt_i32 vcc, 243, v32
v_mad_u32_u16 v191, v255, 1, v7 op_sel:[1,0,0,0]
ds_add_u32 v191, v16
LE_c:
s_mov_b64 exec, -1
ds_read_b128 v[24:27], v35
s_waitcnt lgkmcnt(0)
v_add_u32 v24, 3, v24
v_lshrrev_b32 v24, 2, v24
v_max_u32 v24, v24, v18
v_add_u32 v25, 3, v25
v_lshrrev_b32 v25, 2, v25
v_max_u32 v25, v25, v19
v_add_u32 v26, 3, v26
v_lshrrev_b32 v26, 2, v26
v_max_u32 v26, v26, v20
v_add_u32 v27, 3, v27
v_lshrrev_b32 v27, 2, v27
v_max_u32 v27, v27, v21
v_add_u32 v33, v24, v25
v_add3_u32 v33, v33, v26, v27
v_mov_b32 v64, v33
s_nop 1
v_add_u32_dpp v64, v64, v64 row_shr:1 row_mask:0xf bank_mask:0xf
s_nop 1
v_add_u32_dpp v64, v64, v64 row_shr:2 row_mask:0xf bank_mask:0xf
s_nop 1
v_add_u32_dpp v64, v64, v64 row_shr:4 row_mask:0xf bank_mask:0xf
s_nop 1
v_add_u32_dpp v64, v64, v64 row_shr:8 row_mask:0xf bank_mask:0xf
s_nop 1
v_add_u32_dpp v64, v64, v64 row_bcast:15 row_mask:0xa bank_mask:0xf
s_nop 1
v_add_u32_dpp v64, v64, v64 row_bcast:31 row_mask:0xc bank_mask:0xf
s_nop 1
v_readlane_b32 s44, v64, 63
v_sub_u32 v28, v64, v33
v_add_u32 v29, v28, v24
v_add_u32 v30, v29, v25
v_add_u32 v31, v30, v26
v_add3_u32 v33, v28, v24, -1
v_lshlrev_b32 v34, v33, v18
v_lshrrev_b32 v33, 5, v33
v_lshl_add_u32 v33, v33, 2, v36
ds_or_b32 v33, v34 offset:20480
v_lshl_add_u32 v28, v28, 4, v36
v_add3_u32 v33, v29, v25, -1
v_lshlrev_b32 v34, v33, v19
v_lshrrev_b32 v33, 5, v33
v_lshl_add_u32 v33, v33, 2, v36
ds_or_b32 v33, v34 offset:20480
v_lshl_add_u32 v29, v29, 4, v36
v_add3_u32 v33, v30, v26, -1
v_lshlrev_b32 v34, v33, v20
v_lshrrev_b32 v33, 5, v33
v_lshl_add_u32 v33, v33, 2, v36
ds_or_b32 v33, v34 offset:20480
v_lshl_add_u32 v30, v30, 4, v36
v_add3_u32 v33, v31, v27, -1
v_lshlrev_b32 v34, v33, v21
v_lshrrev_b32 v33, 5, v33
v_lshl_add_u32 v33, v33, 2, v36
ds_or_b32 v33, v34 offset:20480
v_lshl_add_u32 v31, v31, 4, v36
ds_write_b128 v35, v[28:31]
s_add_u32 s44, s44, 31
s_lshr_b32 s44, s44, 5
v_cmpx_lt_i32 vcc, 0, v32
s_cbranch_execz LE_p
ds_add_rtn_u32 v128, v128, v17
v_cmpx_lt_i32 vcc, 1, v32
ds_add_rtn_u32 v129, v129, v17
v_cmpx_lt_i32 vcc, 2, v32
ds_add_rtn_u32 v130, v130, v17
v_cmpx_lt_i32 vcc, 3, v32
ds_add_rtn_u32 v131, v131, v17
v_cmpx_lt_i32 vcc, 16, v32
s_cbranch_execz LE_p
ds_add_rtn_u32 v132, v132, v17
v_cmpx_lt_i32 vcc, 17, v32
ds_add_rtn_u32 v133, v133, v17
v_cmpx_lt_i32 vcc, 18, v32
ds_add_rtn_u32 v134, v134, v17
v_cmpx_lt_i32 vcc, 19, v32
ds_add_rtn_u32 v135, v135, v17
v_cmpx_lt_i32 vcc, 32, v32
s_cbranch_execz LE_p
ds_add_rtn_u32 v136, v136, v17
v_cmpx_lt_i32 vcc, 33, v32
ds_add_rtn_u32 v137, v137, v17
v_cmpx_lt_i32 vcc, 34, v32
ds_add_rtn_u32 v138, v138, v17
v_cmpx_lt_i32 vcc, 35, v32
ds_add_rtn_u32 v139, v139, v17
v_cmpx_lt_i32 vcc, 48, v32
s_cbranch_execz LE_p
ds_add_rtn_u32 v140, v140, v17
v_cmpx_lt_i32 vcc, 49, v32
ds_add_rtn_u32 v141, v141, v17
v_cmpx_lt_i32 vcc, 50, v32
ds_add_rtn_u32 v142, v142, v17
v_cmpx_lt_i32 vcc, 51, v32
ds_add_rtn_u32 v143, v143, v17
v_cmpx_lt_i32 vcc, 64, v32
s_cbranch_execz LE_p
ds_add_rtn_u32 v144, v144, v17
v_cmpx_lt_i32 vcc, 65, v32
ds_add_rtn_u32 v145, v145, v17
v_cmpx_lt_i32 vcc, 66, v32
ds_add_rtn_u32 v146, v146, v17
v_cmpx_lt_i32 vcc, 67, v32
ds_add_rtn_u32 v147, v147, v17
v_cmpx_lt_i32 vcc, 80, v32
s_cbranch_execz LE_p
ds_add_rtn_u32 v148, v148, v17
v_cmpx_lt_i32 vcc, 81, v32
ds_add_rtn_u32 v149, v149, v17
v_cmpx_lt_i32 vcc, 82, v32
ds_add_rtn_u32 v150, v150, v17
v_cmpx_lt_i32 vcc, 83, v32
ds_add_rtn_u32 v151, v151, v17
v_cmpx_lt_i32 vcc, 96, v32
s_cbranch_execz LE_p
ds_add_rtn_u32 v152, v152, v17
v_cmpx_lt_i32 vcc, 97, v32
ds_add_rtn_u32 v153, v153, v17
v_cmpx_lt_i32 vcc, 98, v32
ds_add_rtn_u32 v154, v154, v17
v_cmpx_lt_i32 vcc, 99, v32
ds_add_rtn_u32 v155, v155, v17
v_cmpx_lt_i32 vcc, 112, v32
s_cbranch_execz LE_p
ds_add_rtn_u32 v156, v156, v17
v_cmpx_lt_i32 vcc, 113, v32
ds_add_rtn_u32 v157, v157, v17
v_cmpx_lt_i32 vcc, 114, v32
ds_add_rtn_u32 v158, v158, v17
v_cmpx_lt_i32 vcc, 115, v32
ds_add_rtn_u32 v159, v159, v17
v_cmpx_lt_i32 vcc, 128, v32
s_cbranch_execz LE_p
ds_add_rtn_u32 v160, v160, v17
v_cmpx_lt_i32 vcc, 129, v32
ds_add_rtn_u32 v161, v161, v17
v_cmpx_lt_i32 vcc, 130, v32
ds_add_rtn_u32 v162, v162, v17
v_cmpx_lt_i32 vcc, 131, v32
ds_add_rtn_u32 v163, v163, v17
v_cmpx_lt_i32 vcc, 144, v32
s_cbranch_execz LE_p
ds_add_rtn_u32 v164, v164, v17
v_cmpx_lt_i32 vcc, 145, v32
ds_add_rtn_u32 v165, v165, v17
v_cmpx_lt_i32 vcc, 146, v32
ds_add_rtn_u32 v166, v166, v17
v_cmpx_lt_i32 vcc, 147, v32
ds_add_rtn_u32 v167, v167, v17
v_cmpx_lt_i32 vcc, 160, v32
s_cbranch_execz LE_p
ds_add_rtn_u32 v168, v168, v17
v_cmpx_lt_i32 vcc, 161, v32
ds_add_rtn_u32 v169, v169, v17
v_cmpx_lt_i32 vcc, 162, v32
ds_add_rtn_u32 v170, v170, v17
v_cmpx_lt_i32 vcc, 163, v32
ds_add_rtn_u32 v171, v171, v17
v_cmpx_lt_i32 vcc, 176, v32
s_cbranch_execz LE_p
ds_add_rtn_u32 v172, v172, v17
v_cmpx_lt_i32 vcc, 177, v32
ds_add_rtn_u32 v173, v173, v17
v_cmpx_lt_i32 vcc, 178, v32
ds_add_rtn_u32 v174, v174, v17
v_cmpx_lt_i32 vcc, 179, v32
ds_add_rtn_u32 v175, v175, v17
v_cmpx_lt_i32 vcc, 192, v32
s_cbranch_execz LE_p
ds_add_rtn_u32 v176, v176, v17
v_cmpx_lt_i32 vcc, 193, v32
ds_add_rtn_u32 v177, v177, v17
v_cmpx_lt_i32 vcc, 194, v32
ds_add_rtn_u32 v178, v178, v17
v_cmpx_lt_i32 vcc, 195, v32
ds_add_rtn_u32 v179, v179, v17
v_cmpx_lt_i32 vcc, 208, v32
s_cbranch_execz LE_p
ds_add_rtn_u32 v180, v180, v17
v_cmpx_lt_i32 vcc, 209, v32
ds_add_rtn_u32 v181, v181, v17
v_cmpx_lt_i32 vcc, 210, v32
ds_add_rtn_u32 v182, v182, v17
v_cmpx_lt_i32 vcc, 211, v32
ds_add_rtn_u32 v183, v183, v17
v_cmpx_lt_i32 vcc, 224, v32
s_cbranch_execz LE_p
ds_add_rtn_u32 v184, v184, v17
v_cmpx_lt_i32 vcc, 225, v32
ds_add_rtn_u32 v185, v185, v17
v_cmpx_lt_i32 vcc, 226, v32
ds_add_rtn_u32 v186, v186, v17
v_cmpx_lt_i32 vcc, 227, v32
ds_add_rtn_u32 v187, v187, v17
v_cmpx_lt_i32 vcc, 240, v32
s_cbranch_execz LE_p
ds_add_rtn_u32 v188, v188, v17
v_cmpx_lt_i32 vcc, 241, v32
ds_add_rtn_u32 v189, v189, v17
v_cmpx_lt_i32 vcc, 242, v32
ds_add_rtn_u32 v190, v190, v17
v_cmpx_lt_i32 vcc, 243, v32
ds_add_rtn_u32 v191, v191, v17
LE_p:
s_mov_b64 exec, -1
v_lshl_add_u32 v33, v1, 2, v36
ds_read_b32 v37, v33 offset:20480
s_waitcnt lgkmcnt(0)
v_cmpx_lt_i32 vcc, 0, v32
s_cbranch_execz LE_w
ds_write_b32 v128, v192
v_cmpx_lt_i32 vcc, 1, v32
ds_write_b32 v129, v193
v_cmpx_lt_i32 vcc, 2, v32
ds_write_b32 v130, v194
v_cmpx_lt_i32 vcc, 3, v32
ds_write_b32 v131, v195
v_cmpx_lt_i32 vcc, 16, v32
s_cbranch_execz LE_w
ds_write_b32 v132, v196
v_cmpx_lt_i32 vcc, 17, v32
ds_write_b32 v133, v197
v_cmpx_lt_i32 vcc, 18, v32
ds_write_b32 v134, v198
v_cmpx_lt_i32 vcc, 19, v32
ds_write_b32 v135, v199
v_cmpx_lt_i32 vcc, 32, v32
s_cbranch_execz LE_w
ds_write_b32 v136, v200
v_cmpx_lt_i32 vcc, 33, v32
ds_write_b32 v137, v201
v_cmpx_lt_i32 vcc, 34, v32
ds_write_b32 v138, v202
v_cmpx_lt_i32 vcc, 35, v32
ds_write_b32 v139, v203
v_cmpx_lt_i32 vcc, 48, v32
s_cbranch_execz LE_w
ds_write_b32 v140, v204
v_cmpx_lt_i32 vcc, 49, v32
ds_write_b32 v141, v205
v_cmpx_lt_i32 vcc, 50, v32
ds_write_b32 v142, v206
v_cmpx_lt_i32 vcc, 51, v32
ds_write_b32 v143, v207
v_cmpx_lt_i32 vcc, 64, v32
s_cbranch_execz LE_w
ds_write_b32 v144, v208
v_cmpx_lt_i32 vcc, 65, v32
ds_write_b32 v145, v209
v_cmpx_lt_i32 vcc, 66, v32
ds_write_b32 v146, v210
v_cmpx_lt_i32 vcc, 67, v32
ds_write_b32 v147, v211
v_cmpx_lt_i32 vcc, 80, v32
s_cbranch_execz LE_w
ds_write_b32 v148, v212
v_cmpx_lt_i32 vcc, 81, v32
ds_write_b32 v149, v213
v_cmpx_lt_i32 vcc, 82, v32
ds_write_b32 v150, v214
v_cmpx_lt_i32 vcc, 83, v32
ds_write_b32 v151, v215
v_cmpx_lt_i32 vcc, 96, v32
s_cbranch_execz LE_w
ds_write_b32 v152, v216
v_cmpx_lt_i32 vcc, 97, v32
ds_write_b32 v153, v217
v_cmpx_lt_i32 vcc, 98, v32
ds_write_b32 v154, v218
v_cmpx_lt_i32 vcc, 99, v32
ds_write_b32 v155, v219
v_cmpx_lt_i32 vcc, 112, v32
s_cbranch_execz LE_w
ds_write_b32 v156, v220
v_cmpx_lt_i32 vcc, 113, v32
ds_write_b32 v157, v221
v_cmpx_lt_i32 vcc, 114, v32
ds_write_b32 v158, v222
v_cmpx_lt_i32 vcc, 115, v32
ds_write_b32 v159, v223
v_cmpx_lt_i32 vcc, 128, v32
s_cbranch_execz LE_w
ds_write_b32 v160, v224
v_cmpx_lt_i32 vcc, 129, v32
ds_write_b32 v161, v225
v_cmpx_lt_i32 vcc, 130, v32
ds_write_b32 v162, v226
v_cmpx_lt_i32 vcc, 131, v32
ds_write_b32 v163, v227
v_cmpx_lt_i32 vcc, 144, v32
s_cbranch_execz LE_w
ds_write_b32 v164, v228
v_cmpx_lt_i32 vcc, 145, v32
ds_write_b32 v165, v229
v_cmpx_lt_i32 vcc, 146, v32
ds_write_b32 v166, v230
v_cmpx_lt_i32 vcc, 147, v32
ds_write_b32 v167, v231
v_cmpx_lt_i32 vcc, 160, v32
s_cbranch_execz LE_w
ds_write_b32 v168, v232
v_cmpx_lt_i32 vcc, 161, v32
ds_write_b32 v169, v233
v_cmpx_lt_i32 vcc, 162, v32
ds_write_b32 v170, v234
v_cmpx_lt_i32 vcc, 163, v32
ds_write_b32 v171, v235
v_cmpx_lt_i32 vcc, 176, v32
s_cbranch_execz LE_w
ds_write_b32 v172, v236
v_cmpx_lt_i32 vcc, 177, v32
ds_write_b32 v173, v237
v_cmpx_lt_i32 vcc, 178, v32
ds_write_b32 v174, v238
v_cmpx_lt_i32 vcc, 179, v32
ds_write_b32 v175, v239
v_cmpx_lt_i32 vcc, 192, v32
s_cbranch_execz LE_w
ds_write_b32 v176, v240
v_cmpx_lt_i32 vcc, 193, v32
ds_write_b32 v177, v241
v_cmpx_lt_i32 vcc, 194, v32
ds_write_b32 v178, v242
v_cmpx_lt_i32 vcc, 195, v32
ds_write_b32 v179, v243
v_cmpx_lt_i32 vcc, 208, v32
s_cbranch_execz LE_w
ds_write_b32 v180, v244
v_cmpx_lt_i32 vcc, 209, v32
ds_write_b32 v181, v245
v_cmpx_lt_i32 vcc, 210, v32
ds_write_b32 v182, v246
v_cmpx_lt_i32 vcc, 211, v32
ds_write_b32 v183, v247
v_cmpx_lt_i32 vcc, 224, v32
s_cbranch_execz LE_w
ds_write_b32 v184, v248
v_cmpx_lt_i32 vcc, 225, v32
ds_write_b32 v185, v249
v_cmpx_lt_i32 vcc, 226, v32
ds_write_b32 v186, v250
v_cmpx_lt_i32 vcc, 227, v32
ds_write_b32 v187, v251
v_cmpx_lt_i32 vcc, 240, v32
s_cbranch_execz LE_w
ds_write_b32 v188, v252
v_cmpx_lt_i32 vcc, 241, v32
ds_write_b32 v189, v253
v_cmpx_lt_i32 vcc, 242, v32
ds_write_b32 v190, v254
v_cmpx_lt_i32 vcc, 243, v32
ds_write_b32 v191, v255
LE_w:
s_mov_b64 exec, -1
s_add_u32 s8, s4, 0x7c2a000
s_addc_u32 s9, s5, 0
s_mov_b32 s10, 0x8000
s_mov_b32 s11, 0x00020000
v_and_b32 v200, 63, v0
v_lshlrev_b32 v200, 7, v200
s_mov_b32 s91, 8192
s_mov_b32 s90, 16384
s_mov_b32 s95, 24576
s_mov_b32 s94, 0x10000
LE_poll:
buffer_load_dwordx2 v[192:193], v200, s[8:11], 0 offen sc1
buffer_load_dwordx2 v[194:195], v200, s[8:11], s91 offen sc1
buffer_load_dwordx2 v[196:197], v200, s[8:11], s90 offen sc1
buffer_load_dwordx2 v[198:199], v200, s[8:11], s95 offen sc1
s_sub_u32 s94, s94, 1
s_waitcnt vmcnt(0)
s_cbranch_scc1 LE_poll_go
v_cmp_ne_u64 vcc, s[98:99], v[192:193]
s_nop 1
s_cbranch_vccnz LE_poll
v_cmp_ne_u64 vcc, s[98:99], v[194:195]
s_nop 1
s_cbranch_vccnz LE_poll
v_cmp_ne_u64 vcc, s[98:99], v[196:197]
s_nop 1
s_cbranch_vccnz LE_poll
v_cmp_ne_u64 vcc, s[98:99], v[198:199]
s_nop 1
s_cbranch_vccnz LE_poll
LE_poll_go:
s_cmp_lg_u32 s40, 0
s_cbranch_scc1 LE_nobump
s_mov_b32 s90, 89984
s_mov_b32 s10, 90112
v_lshlrev_b32 v196, 4, v1
v_mov_b32 v192, s98
v_mov_b32 v193, s99
v_mov_b32 v194, s98
v_mov_b32 v195, s99
s_mov_b64 exec, 0xff
buffer_store_dwordx4 v[192:195], v196, s[8:11], s90 offen sc1
s_mov_b64 exec, -1
LE_nobump:
v_mov_b32 v34, v38
ds_read2_b32 v[52:53], v34 offset0:0 offset1:4
ds_read2_b32 v[54:55], v34 offset0:8 offset1:12
s_waitcnt lgkmcnt(0)
ds_read2_b32 v[56:57], v34 offset0:16 offset1:20
ds_read2_b32 v[58:59], v34 offset0:24 offset1:28
v_mad_u32_u16 v60, v52, s49, v2
v_mad_u32_u16 v61, v53, s49, v2
v_mad_u32_u16 v62, v54, s49, v2
v_mad_u32_u16 v63, v55, s49, v2
buffer_load_dwordx4 a[0:3], v60, s[16:19], 0 offen sc1
buffer_load_dwordx4 a[4:7], v60, s[16:19], 0 offen offset:256 sc1
buffer_load_dwordx4 a[8:11], v61, s[16:19], 0 offen sc1
buffer_load_dwordx4 a[12:15], v61, s[16:19], 0 offen offset:256 sc1
buffer_load_dwordx4 a[16:19], v62, s[16:19], 0 offen sc1
buffer_load_dwordx4 a[20:23], v62, s[16:19], 0 offen offset:256 sc1
buffer_load_dwordx4 a[24:27], v63, s[16:19], 0 offen sc1
buffer_load_dwordx4 a[28:31], v63, s[16:19], 0 offen offset:256 sc1
s_waitcnt lgkmcnt(0)
ds_read2_b32 v[52:53], v34 offset0:32 offset1:36
ds_read2_b32 v[54:55], v34 offset0:40 offset1:44
v_mad_u32_u16 v60, v56, s49, v2
v_mad_u32_u16 v61, v57, s49, v2
v_mad_u32_u16 v62, v58, s49, v2
v_mad_u32_u16 v63, v59, s49, v2
buffer_load_dwordx4 a[32:35], v60, s[16:19], 0 offen sc1
buffer_load_dwordx4 a[36:39], v60, s[16:19], 0 offen offset:256 sc1
buffer_load_dwordx4 a[40:43], v61, s[16:19], 0 offen sc1
buffer_load_dwordx4 a[44:47], v61, s[16:19], 0 offen offset:256 sc1
buffer_load_dwordx4 a[48:51], v62, s[16:19], 0 offen sc1
buffer_load_dwordx4 a[52:55], v62, s[16:19], 0 offen offset:256 sc1
buffer_load_dwordx4 a[56:59], v63, s[16:19], 0 offen sc1
buffer_load_dwordx4 a[60:63], v63, s[16:19], 0 offen offset:256 sc1
s_waitcnt lgkmcnt(0)
ds_read2_b32 v[56:57], v34 offset0:48 offset1:52
ds_read2_b32 v[58:59], v34 offset0:56 offset1:60
v_mad_u32_u16 v60, v52, s49, v2
v_mad_u32_u16 v61, v53, s49, v2
v_mad_u32_u16 v62, v54, s49, v2
v_mad_u32_u16 v63, v55, s49, v2
buffer_load_dwordx4 a[64:67], v60, s[16:19], 0 offen sc1
buffer_load_dwordx4 a[68:71], v60, s[16:19], 0 offen offset:256 sc1
buffer_load_dwordx4 a[72:75], v61, s[16:19], 0 offen sc1
buffer_load_dwordx4 a[76:79], v61, s[16:19], 0 offen offset:256 sc1
buffer_load_dwordx4 a[80:83], v62, s[16:19], 0 offen sc1
buffer_load_dwordx4 a[84:87], v62, s[16:19], 0 offen offset:256 sc1
buffer_load_dwordx4 a[88:91], v63, s[16:19], 0 offen sc1
buffer_load_dwordx4 a[92:95], v63, s[16:19], 0 offen offset:256 sc1
s_waitcnt lgkmcnt(0)
ds_read2_b32 v[52:53], v34 offset0:64 offset1:68
ds_read2_b32 v[54:55], v34 offset0:72 offset1:76
v_mad_u32_u16 v60, v56, s49, v2
v_mad_u32_u16 v61, v57, s49, v2
v_mad_u32_u16 v62, v58, s49, v2
v_mad_u32_u16 v63, v59, s49, v2
buffer_load_dwordx4 a[96:99], v60, s[16:19], 0 offen sc1
buffer_load_dwordx4 a[100:103], v60, s[16:19], 0 offen offset:256 sc1
buffer_load_dwordx4 a[104:107], v61, s[16:19], 0 offen sc1
buffer_load_dwordx4 a[108:111], v61, s[16:19], 0 offen offset:256 sc1
buffer_load_dwordx4 a[112:115], v62, s[16:19], 0 offen sc1
buffer_load_dwordx4 a[116:119], v62, s[16:19], 0 offen offset:256 sc1
buffer_load_dwordx4 a[120:123], v63, s[16:19], 0 offen sc1
buffer_load_dwordx4 a[124:127], v63, s[16:19], 0 offen offset:256 sc1
s_waitcnt lgkmcnt(0)
ds_read2_b32 v[56:57], v34 offset0:80 offset1:84
ds_read2_b32 v[58:59], v34 offset0:88 offset1:92
v_mad_u32_u16 v60, v52, s49, v2
v_mad_u32_u16 v61, v53, s49, v2
v_mad_u32_u16 v62, v54, s49, v2
v_mad_u32_u16 v63, v55, s49, v2
buffer_load_dwordx4 a[128:131], v60, s[16:19], 0 offen sc1
buffer_load_dwordx4 a[132:135], v60, s[16:19], 0 offen offset:256 sc1
buffer_load_dwordx4 a[136:139], v61, s[16:19], 0 offen sc1
buffer_load_dwordx4 a[140:143], v61, s[16:19], 0 offen offset:256 sc1
buffer_load_dwordx4 a[144:147], v62, s[16:19], 0 offen sc1
buffer_load_dwordx4 a[148:151], v62, s[16:19], 0 offen offset:256 sc1
buffer_load_dwordx4 a[152:155], v63, s[16:19], 0 offen sc1
buffer_load_dwordx4 a[156:159], v63, s[16:19], 0 offen offset:256 sc1
s_waitcnt lgkmcnt(0)
ds_read2_b32 v[52:53], v34 offset0:96 offset1:100
ds_read2_b32 v[54:55], v34 offset0:104 offset1:108
v_mad_u32_u16 v60, v56, s49, v2
v_mad_u32_u16 v61, v57, s49, v2
v_mad_u32_u16 v62, v58, s49, v2
v_mad_u32_u16 v63, v59, s49, v2
buffer_load_dwordx4 a[160:163], v60, s[16:19], 0 offen sc1
buffer_load_dwordx4 a[164:167], v60, s[16:19], 0 offen offset:256 sc1
buffer_load_dwordx4 a[168:171], v61, s[16:19], 0 offen sc1
buffer_load_dwordx4 a[172:175], v61, s[16:19], 0 offen offset:256 sc1
buffer_load_dwordx4 a[176:179], v62, s[16:19], 0 offen sc1
buffer_load_dwordx4 a[180:183], v62, s[16:19], 0 offen offset:256 sc1
buffer_load_dwordx4 a[184:187], v63, s[16:19], 0 offen sc1
buffer_load_dwordx4 a[188:191], v63, s[16:19], 0 offen offset:256 sc1
s_waitcnt lgkmcnt(0)
ds_read2_b32 v[56:57], v34 offset0:112 offset1:116
ds_read2_b32 v[58:59], v34 offset0:120 offset1:124
v_mad_u32_u16 v60, v52, s49, v2
v_mad_u32_u16 v61, v53, s49, v2
v_mad_u32_u16 v62, v54, s49, v2
v_mad_u32_u16 v63, v55, s49, v2
buffer_load_dwordx4 a[192:195], v60, s[16:19], 0 offen sc1
buffer_load_dwordx4 a[196:199], v60, s[16:19], 0 offen offset:256 sc1
buffer_load_dwordx4 a[200:203], v61, s[16:19], 0 offen sc1
buffer_load_dwordx4 a[204:207], v61, s[16:19], 0 offen offset:256 sc1
buffer_load_dwordx4 a[208:211], v62, s[16:19], 0 offen sc1
buffer_load_dwordx4 a[212:215], v62, s[16:19], 0 offen offset:256 sc1
buffer_load_dwordx4 a[216:219], v63, s[16:19], 0 offen sc1
buffer_load_dwordx4 a[220:223], v63, s[16:19], 0 offen offset:256 sc1
s_waitcnt lgkmcnt(0)
ds_read2_b32 v[52:53], v34 offset0:128 offset1:132
ds_read2_b32 v[54:55], v34 offset0:136 offset1:140
v_mad_u32_u16 v60, v56, s49, v2
v_mad_u32_u16 v61, v57, s49, v2
v_mad_u32_u16 v62, v58, s49, v2
v_mad_u32_u16 v63, v59, s49, v2
buffer_load_dwordx4 a[224:227], v60, s[16:19], 0 offen sc1
buffer_load_dwordx4 a[228:231], v60, s[16:19], 0 offen offset:256 sc1
buffer_load_dwordx4 a[232:235], v61, s[16:19], 0 offen sc1
buffer_load_dwordx4 a[236:239], v61, s[16:19], 0 offen offset:256 sc1
buffer_load_dwordx4 a[240:243], v62, s[16:19], 0 offen sc1
buffer_load_dwordx4 a[244:247], v62, s[16:19], 0 offen offset:256 sc1
buffer_load_dwordx4 a[248:251], v63, s[16:19], 0 offen sc1
buffer_load_dwordx4 a[252:255], v63, s[16:19], 0 offen offset:256 sc1
v_add_u32 v34, 512, v34
s_mov_b32 s45, 0
s_lshl_b32 s47, s55, 9
LE_loop:
v_readlane_b32 s46, v37, s45
s_add_u32 s45, s45, 1
s_waitcnt vmcnt(56)
v_mfma_f32_16x16x32_bf16 v[48:51], a[0:3], v[40:43], v[48:51]
v_mfma_f32_16x16x32_bf16 v[48:51], a[4:7], v[44:47], v[48:51]
s_bitcmp1_b32 s46, 0
s_cbranch_scc0 LE_nf0
s_cmp_eq_u32 s42, 0
s_cbranch_scc1 LE_fl0
buffer_load_dwordx2 v[66:67], v39, s[20:23], s47 offen sc1
s_waitcnt vmcnt(0)
v_lshlrev_b32 v64, 16, v66
v_and_b32 v65, 0xffff0000, v66
v_add_f32 v48, v48, v64
v_add_f32 v49, v49, v65
v_lshlrev_b32 v64, 16, v67
v_and_b32 v65, 0xffff0000, v67
v_add_f32 v50, v50, v64
v_add_f32 v51, v51, v65
LE_fl0:
s_nop 3
v_cvt_pk_bf16_f32 v64, v48, v49
v_cvt_pk_bf16_f32 v65, v50, v51
v_mov_b32 v48, 0
v_mov_b32 v49, 0
v_mov_b32 v50, 0
v_mov_b32 v51, 0
buffer_store_dwordx2 v[64:65], v39, s[20:23], s47 offen sc1
s_add_u32 s47, s47, 512
LE_nf0:
v_mfma_f32_16x16x32_bf16 v[48:51], a[8:11], v[40:43], v[48:51]
v_mfma_f32_16x16x32_bf16 v[48:51], a[12:15], v[44:47], v[48:51]
s_bitcmp1_b32 s46, 1
s_cbranch_scc0 LE_nf1
s_cmp_eq_u32 s42, 0
s_cbranch_scc1 LE_fl1
buffer_load_dwordx2 v[66:67], v39, s[20:23], s47 offen sc1
s_waitcnt vmcnt(0)
v_lshlrev_b32 v64, 16, v66
v_and_b32 v65, 0xffff0000, v66
v_add_f32 v48, v48, v64
v_add_f32 v49, v49, v65
v_lshlrev_b32 v64, 16, v67
v_and_b32 v65, 0xffff0000, v67
v_add_f32 v50, v50, v64
v_add_f32 v51, v51, v65
LE_fl1:
s_nop 3
v_cvt_pk_bf16_f32 v64, v48, v49
v_cvt_pk_bf16_f32 v65, v50, v51
v_mov_b32 v48, 0
v_mov_b32 v49, 0
v_mov_b32 v50, 0
v_mov_b32 v51, 0
buffer_store_dwordx2 v[64:65], v39, s[20:23], s47 offen sc1
s_add_u32 s47, s47, 512
LE_nf1:
v_mfma_f32_16x16x32_bf16 v[48:51], a[16:19], v[40:43], v[48:51]
v_mfma_f32_16x16x32_bf16 v[48:51], a[20:23], v[44:47], v[48:51]
s_bitcmp1_b32 s46, 2
s_cbranch_scc0 LE_nf2
s_cmp_eq_u32 s42, 0
s_cbranch_scc1 LE_fl2
buffer_load_dwordx2 v[66:67], v39, s[20:23], s47 offen sc1
s_waitcnt vmcnt(0)
v_lshlrev_b32 v64, 16, v66
v_and_b32 v65, 0xffff0000, v66
v_add_f32 v48, v48, v64
v_add_f32 v49, v49, v65
v_lshlrev_b32 v64, 16, v67
v_and_b32 v65, 0xffff0000, v67
v_add_f32 v50, v50, v64
v_add_f32 v51, v51, v65
LE_fl2:
s_nop 3
v_cvt_pk_bf16_f32 v64, v48, v49
v_cvt_pk_bf16_f32 v65, v50, v51
v_mov_b32 v48, 0
v_mov_b32 v49, 0
v_mov_b32 v50, 0
v_mov_b32 v51, 0
buffer_store_dwordx2 v[64:65], v39, s[20:23], s47 offen sc1
s_add_u32 s47, s47, 512
LE_nf2:
v_mfma_f32_16x16x32_bf16 v[48:51], a[24:27], v[40:43], v[48:51]
v_mfma_f32_16x16x32_bf16 v[48:51], a[28:31], v[44:47], v[48:51]
s_bitcmp1_b32 s46, 3
s_cbranch_scc0 LE_nf3
s_cmp_eq_u32 s42, 0
s_cbranch_scc1 LE_fl3
buffer_load_dwordx2 v[66:67], v39, s[20:23], s47 offen sc1
s_waitcnt vmcnt(0)
v_lshlrev_b32 v64, 16, v66
v_and_b32 v65, 0xffff0000, v66
v_add_f32 v48, v48, v64
v_add_f32 v49, v49, v65
v_lshlrev_b32 v64, 16, v67
v_and_b32 v65, 0xffff0000, v67
v_add_f32 v50, v50, v64
v_add_f32 v51, v51, v65
LE_fl3:
s_nop 3
v_cvt_pk_bf16_f32 v64, v48, v49
v_cvt_pk_bf16_f32 v65, v50, v51
v_mov_b32 v48, 0
v_mov_b32 v49, 0
v_mov_b32 v50, 0
v_mov_b32 v51, 0
buffer_store_dwordx2 v[64:65], v39, s[20:23], s47 offen sc1
s_add_u32 s47, s47, 512
LE_nf3:
s_waitcnt lgkmcnt(0)
ds_read2_b32 v[56:57], v34 offset0:16 offset1:20
ds_read2_b32 v[58:59], v34 offset0:24 offset1:28
v_mad_u32_u16 v60, v52, s49, v2
v_mad_u32_u16 v61, v53, s49, v2
v_mad_u32_u16 v62, v54, s49, v2
v_mad_u32_u16 v63, v55, s49, v2
buffer_load_dwordx4 a[0:3], v60, s[16:19], 0 offen sc1
buffer_load_dwordx4 a[4:7], v60, s[16:19], 0 offen offset:256 sc1
buffer_load_dwordx4 a[8:11], v61, s[16:19], 0 offen sc1
buffer_load_dwordx4 a[12:15], v61, s[16:19], 0 offen offset:256 sc1
buffer_load_dwordx4 a[16:19], v62, s[16:19], 0 offen sc1
buffer_load_dwordx4 a[20:23], v62, s[16:19], 0 offen offset:256 sc1
buffer_load_dwordx4 a[24:27], v63, s[16:19], 0 offen sc1
buffer_load_dwordx4 a[28:31], v63, s[16:19], 0 offen offset:256 sc1
s_waitcnt vmcnt(56)
v_mfma_f32_16x16x32_bf16 v[48:51], a[32:35], v[40:43], v[48:51]
v_mfma_f32_16x16x32_bf16 v[48:51], a[36:39], v[44:47], v[48:51]
s_bitcmp1_b32 s46, 4
s_cbranch_scc0 LE_nf4
s_cmp_eq_u32 s42, 0
s_cbranch_scc1 LE_fl4
buffer_load_dwordx2 v[66:67], v39, s[20:23], s47 offen sc1
s_waitcnt vmcnt(0)
v_lshlrev_b32 v64, 16, v66
v_and_b32 v65, 0xffff0000, v66
v_add_f32 v48, v48, v64
v_add_f32 v49, v49, v65
v_lshlrev_b32 v64, 16, v67
v_and_b32 v65, 0xffff0000, v67
v_add_f32 v50, v50, v64
v_add_f32 v51, v51, v65
LE_fl4:
s_nop 3
v_cvt_pk_bf16_f32 v64, v48, v49
v_cvt_pk_bf16_f32 v65, v50, v51
v_mov_b32 v48, 0
v_mov_b32 v49, 0
v_mov_b32 v50, 0
v_mov_b32 v51, 0
buffer_store_dwordx2 v[64:65], v39, s[20:23], s47 offen sc1
s_add_u32 s47, s47, 512
LE_nf4:
v_mfma_f32_16x16x32_bf16 v[48:51], a[40:43], v[40:43], v[48:51]
v_mfma_f32_16x16x32_bf16 v[48:51], a[44:47], v[44:47], v[48:51]
s_bitcmp1_b32 s46, 5
s_cbranch_scc0 LE_nf5
s_cmp_eq_u32 s42, 0
s_cbranch_scc1 LE_fl5
buffer_load_dwordx2 v[66:67], v39, s[20:23], s47 offen sc1
s_waitcnt vmcnt(0)
v_lshlrev_b32 v64, 16, v66
v_and_b32 v65, 0xffff0000, v66
v_add_f32 v48, v48, v64
v_add_f32 v49, v49, v65
v_lshlrev_b32 v64, 16, v67
v_and_b32 v65, 0xffff0000, v67
v_add_f32 v50, v50, v64
v_add_f32 v51, v51, v65
LE_fl5:
s_nop 3
v_cvt_pk_bf16_f32 v64, v48, v49
v_cvt_pk_bf16_f32 v65, v50, v51
v_mov_b32 v48, 0
v_mov_b32 v49, 0
v_mov_b32 v50, 0
v_mov_b32 v51, 0
buffer_store_dwordx2 v[64:65], v39, s[20:23], s47 offen sc1
s_add_u32 s47, s47, 512
LE_nf5:
v_mfma_f32_16x16x32_bf16 v[48:51], a[48:51], v[40:43], v[48:51]
v_mfma_f32_16x16x32_bf16 v[48:51], a[52:55], v[44:47], v[48:51]
s_bitcmp1_b32 s46, 6
s_cbranch_scc0 LE_nf6
s_cmp_eq_u32 s42, 0
s_cbranch_scc1 LE_fl6
buffer_load_dwordx2 v[66:67], v39, s[20:23], s47 offen sc1
s_waitcnt vmcnt(0)
v_lshlrev_b32 v64, 16, v66
v_and_b32 v65, 0xffff0000, v66
v_add_f32 v48, v48, v64
v_add_f32 v49, v49, v65
v_lshlrev_b32 v64, 16, v67
v_and_b32 v65, 0xffff0000, v67
v_add_f32 v50, v50, v64
v_add_f32 v51, v51, v65
LE_fl6:
s_nop 3
v_cvt_pk_bf16_f32 v64, v48, v49
v_cvt_pk_bf16_f32 v65, v50, v51
v_mov_b32 v48, 0
v_mov_b32 v49, 0
v_mov_b32 v50, 0
v_mov_b32 v51, 0
buffer_store_dwordx2 v[64:65], v39, s[20:23], s47 offen sc1
s_add_u32 s47, s47, 512
LE_nf6:
v_mfma_f32_16x16x32_bf16 v[48:51], a[56:59], v[40:43], v[48:51]
v_mfma_f32_16x16x32_bf16 v[48:51], a[60:63], v[44:47], v[48:51]
s_bitcmp1_b32 s46, 7
s_cbranch_scc0 LE_nf7
s_cmp_eq_u32 s42, 0
s_cbranch_scc1 LE_fl7
buffer_load_dwordx2 v[66:67], v39, s[20:23], s47 offen sc1
s_waitcnt vmcnt(0)
v_lshlrev_b32 v64, 16, v66
v_and_b32 v65, 0xffff0000, v66
v_add_f32 v48, v48, v64
v_add_f32 v49, v49, v65
v_lshlrev_b32 v64, 16, v67
v_and_b32 v65, 0xffff0000, v67
v_add_f32 v50, v50, v64
v_add_f32 v51, v51, v65
LE_fl7:
s_nop 3
v_cvt_pk_bf16_f32 v64, v48, v49
v_cvt_pk_bf16_f32 v65, v50, v51
v_mov_b32 v48, 0
v_mov_b32 v49, 0
v_mov_b32 v50, 0
v_mov_b32 v51, 0
buffer_store_dwordx2 v[64:65], v39, s[20:23], s47 offen sc1
s_add_u32 s47, s47, 512
LE_nf7:
s_waitcnt lgkmcnt(0)
ds_read2_b32 v[52:53], v34 offset0:32 offset1:36
ds_read2_b32 v[54:55], v34 offset0:40 offset1:44
v_mad_u32_u16 v60, v56, s49, v2
v_mad_u32_u16 v61, v57, s49, v2
v_mad_u32_u16 v62, v58, s49, v2
v_mad_u32_u16 v63, v59, s49, v2
buffer_load_dwordx4 a[32:35], v60, s[16:19], 0 offen sc1
buffer_load_dwordx4 a[36:39], v60, s[16:19], 0 offen offset:256 sc1
buffer_load_dwordx4 a[40:43], v61, s[16:19], 0 offen sc1
buffer_load_dwordx4 a[44:47], v61, s[16:19], 0 offen offset:256 sc1
buffer_load_dwordx4 a[48:51], v62, s[16:19], 0 offen sc1
buffer_load_dwordx4 a[52:55], v62, s[16:19], 0 offen offset:256 sc1
buffer_load_dwordx4 a[56:59], v63, s[16:19], 0 offen sc1
buffer_load_dwordx4 a[60:63], v63, s[16:19], 0 offen offset:256 sc1
s_waitcnt vmcnt(56)
v_mfma_f32_16x16x32_bf16 v[48:51], a[64:67], v[40:43], v[48:51]
v_mfma_f32_16x16x32_bf16 v[48:51], a[68:71], v[44:47], v[48:51]
s_bitcmp1_b32 s46, 8
s_cbranch_scc0 LE_nf8
s_cmp_eq_u32 s42, 0
s_cbranch_scc1 LE_fl8
buffer_load_dwordx2 v[66:67], v39, s[20:23], s47 offen sc1
s_waitcnt vmcnt(0)
v_lshlrev_b32 v64, 16, v66
v_and_b32 v65, 0xffff0000, v66
v_add_f32 v48, v48, v64
v_add_f32 v49, v49, v65
v_lshlrev_b32 v64, 16, v67
v_and_b32 v65, 0xffff0000, v67
v_add_f32 v50, v50, v64
v_add_f32 v51, v51, v65
LE_fl8:
s_nop 3
v_cvt_pk_bf16_f32 v64, v48, v49
v_cvt_pk_bf16_f32 v65, v50, v51
v_mov_b32 v48, 0
v_mov_b32 v49, 0
v_mov_b32 v50, 0
v_mov_b32 v51, 0
buffer_store_dwordx2 v[64:65], v39, s[20:23], s47 offen sc1
s_add_u32 s47, s47, 512
LE_nf8:
v_mfma_f32_16x16x32_bf16 v[48:51], a[72:75], v[40:43], v[48:51]
v_mfma_f32_16x16x32_bf16 v[48:51], a[76:79], v[44:47], v[48:51]
s_bitcmp1_b32 s46, 9
s_cbranch_scc0 LE_nf9
s_cmp_eq_u32 s42, 0
s_cbranch_scc1 LE_fl9
buffer_load_dwordx2 v[66:67], v39, s[20:23], s47 offen sc1
s_waitcnt vmcnt(0)
v_lshlrev_b32 v64, 16, v66
v_and_b32 v65, 0xffff0000, v66
v_add_f32 v48, v48, v64
v_add_f32 v49, v49, v65
v_lshlrev_b32 v64, 16, v67
v_and_b32 v65, 0xffff0000, v67
v_add_f32 v50, v50, v64
v_add_f32 v51, v51, v65
LE_fl9:
s_nop 3
v_cvt_pk_bf16_f32 v64, v48, v49
v_cvt_pk_bf16_f32 v65, v50, v51
v_mov_b32 v48, 0
v_mov_b32 v49, 0
v_mov_b32 v50, 0
v_mov_b32 v51, 0
buffer_store_dwordx2 v[64:65], v39, s[20:23], s47 offen sc1
s_add_u32 s47, s47, 512
LE_nf9:
v_mfma_f32_16x16x32_bf16 v[48:51], a[80:83], v[40:43], v[48:51]
v_mfma_f32_16x16x32_bf16 v[48:51], a[84:87], v[44:47], v[48:51]
s_bitcmp1_b32 s46, 10
s_cbranch_scc0 LE_nf10
s_cmp_eq_u32 s42, 0
s_cbranch_scc1 LE_fl10
buffer_load_dwordx2 v[66:67], v39, s[20:23], s47 offen sc1
s_waitcnt vmcnt(0)
v_lshlrev_b32 v64, 16, v66
v_and_b32 v65, 0xffff0000, v66
v_add_f32 v48, v48, v64
v_add_f32 v49, v49, v65
v_lshlrev_b32 v64, 16, v67
v_and_b32 v65, 0xffff0000, v67
v_add_f32 v50, v50, v64
v_add_f32 v51, v51, v65
LE_fl10:
s_nop 3
v_cvt_pk_bf16_f32 v64, v48, v49
v_cvt_pk_bf16_f32 v65, v50, v51
v_mov_b32 v48, 0
v_mov_b32 v49, 0
v_mov_b32 v50, 0
v_mov_b32 v51, 0
buffer_store_dwordx2 v[64:65], v39, s[20:23], s47 offen sc1
s_add_u32 s47, s47, 512
LE_nf10:
v_mfma_f32_16x16x32_bf16 v[48:51], a[88:91], v[40:43], v[48:51]
v_mfma_f32_16x16x32_bf16 v[48:51], a[92:95], v[44:47], v[48:51]
s_bitcmp1_b32 s46, 11
s_cbranch_scc0 LE_nf11
s_cmp_eq_u32 s42, 0
s_cbranch_scc1 LE_fl11
buffer_load_dwordx2 v[66:67], v39, s[20:23], s47 offen sc1
s_waitcnt vmcnt(0)
v_lshlrev_b32 v64, 16, v66
v_and_b32 v65, 0xffff0000, v66
v_add_f32 v48, v48, v64
v_add_f32 v49, v49, v65
v_lshlrev_b32 v64, 16, v67
v_and_b32 v65, 0xffff0000, v67
v_add_f32 v50, v50, v64
v_add_f32 v51, v51, v65
LE_fl11:
s_nop 3
v_cvt_pk_bf16_f32 v64, v48, v49
v_cvt_pk_bf16_f32 v65, v50, v51
v_mov_b32 v48, 0
v_mov_b32 v49, 0
v_mov_b32 v50, 0
v_mov_b32 v51, 0
buffer_store_dwordx2 v[64:65], v39, s[20:23], s47 offen sc1
s_add_u32 s47, s47, 512
LE_nf11:
s_waitcnt lgkmcnt(0)
ds_read2_b32 v[56:57], v34 offset0:48 offset1:52
ds_read2_b32 v[58:59], v34 offset0:56 offset1:60
v_mad_u32_u16 v60, v52, s49, v2
v_mad_u32_u16 v61, v53, s49, v2
v_mad_u32_u16 v62, v54, s49, v2
v_mad_u32_u16 v63, v55, s49, v2
buffer_load_dwordx4 a[64:67], v60, s[16:19], 0 offen sc1
buffer_load_dwordx4 a[68:71], v60, s[16:19], 0 offen offset:256 sc1
buffer_load_dwordx4 a[72:75], v61, s[16:19], 0 offen sc1
buffer_load_dwordx4 a[76:79], v61, s[16:19], 0 offen offset:256 sc1
buffer_load_dwordx4 a[80:83], v62, s[16:19], 0 offen sc1
buffer_load_dwordx4 a[84:87], v62, s[16:19], 0 offen offset:256 sc1
buffer_load_dwordx4 a[88:91], v63, s[16:19], 0 offen sc1
buffer_load_dwordx4 a[92:95], v63, s[16:19], 0 offen offset:256 sc1
s_waitcnt vmcnt(56)
v_mfma_f32_16x16x32_bf16 v[48:51], a[96:99], v[40:43], v[48:51]
v_mfma_f32_16x16x32_bf16 v[48:51], a[100:103], v[44:47], v[48:51]
s_bitcmp1_b32 s46, 12
s_cbranch_scc0 LE_nf12
s_cmp_eq_u32 s42, 0
s_cbranch_scc1 LE_fl12
buffer_load_dwordx2 v[66:67], v39, s[20:23], s47 offen sc1
s_waitcnt vmcnt(0)
v_lshlrev_b32 v64, 16, v66
v_and_b32 v65, 0xffff0000, v66
v_add_f32 v48, v48, v64
v_add_f32 v49, v49, v65
v_lshlrev_b32 v64, 16, v67
v_and_b32 v65, 0xffff0000, v67
v_add_f32 v50, v50, v64
v_add_f32 v51, v51, v65
LE_fl12:
s_nop 3
v_cvt_pk_bf16_f32 v64, v48, v49
v_cvt_pk_bf16_f32 v65, v50, v51
v_mov_b32 v48, 0
v_mov_b32 v49, 0
v_mov_b32 v50, 0
v_mov_b32 v51, 0
buffer_store_dwordx2 v[64:65], v39, s[20:23], s47 offen sc1
s_add_u32 s47, s47, 512
LE_nf12:
v_mfma_f32_16x16x32_bf16 v[48:51], a[104:107], v[40:43], v[48:51]
v_mfma_f32_16x16x32_bf16 v[48:51], a[108:111], v[44:47], v[48:51]
s_bitcmp1_b32 s46, 13
s_cbranch_scc0 LE_nf13
s_cmp_eq_u32 s42, 0
s_cbranch_scc1 LE_fl13
buffer_load_dwordx2 v[66:67], v39, s[20:23], s47 offen sc1
s_waitcnt vmcnt(0)
v_lshlrev_b32 v64, 16, v66
v_and_b32 v65, 0xffff0000, v66
v_add_f32 v48, v48, v64
v_add_f32 v49, v49, v65
v_lshlrev_b32 v64, 16, v67
v_and_b32 v65, 0xffff0000, v67
v_add_f32 v50, v50, v64
v_add_f32 v51, v51, v65
LE_fl13:
s_nop 3
v_cvt_pk_bf16_f32 v64, v48, v49
v_cvt_pk_bf16_f32 v65, v50, v51
v_mov_b32 v48, 0
v_mov_b32 v49, 0
v_mov_b32 v50, 0
v_mov_b32 v51, 0
buffer_store_dwordx2 v[64:65], v39, s[20:23], s47 offen sc1
s_add_u32 s47, s47, 512
LE_nf13:
v_mfma_f32_16x16x32_bf16 v[48:51], a[112:115], v[40:43], v[48:51]
v_mfma_f32_16x16x32_bf16 v[48:51], a[116:119], v[44:47], v[48:51]
s_bitcmp1_b32 s46, 14
s_cbranch_scc0 LE_nf14
s_cmp_eq_u32 s42, 0
s_cbranch_scc1 LE_fl14
buffer_load_dwordx2 v[66:67], v39, s[20:23], s47 offen sc1
s_waitcnt vmcnt(0)
v_lshlrev_b32 v64, 16, v66
v_and_b32 v65, 0xffff0000, v66
v_add_f32 v48, v48, v64
v_add_f32 v49, v49, v65
v_lshlrev_b32 v64, 16, v67
v_and_b32 v65, 0xffff0000, v67
v_add_f32 v50, v50, v64
v_add_f32 v51, v51, v65
LE_fl14:
s_nop 3
v_cvt_pk_bf16_f32 v64, v48, v49
v_cvt_pk_bf16_f32 v65, v50, v51
v_mov_b32 v48, 0
v_mov_b32 v49, 0
v_mov_b32 v50, 0
v_mov_b32 v51, 0
buffer_store_dwordx2 v[64:65], v39, s[20:23], s47 offen sc1
s_add_u32 s47, s47, 512
LE_nf14:
v_mfma_f32_16x16x32_bf16 v[48:51], a[120:123], v[40:43], v[48:51]
v_mfma_f32_16x16x32_bf16 v[48:51], a[124:127], v[44:47], v[48:51]
s_bitcmp1_b32 s46, 15
s_cbranch_scc0 LE_nf15
s_cmp_eq_u32 s42, 0
s_cbranch_scc1 LE_fl15
buffer_load_dwordx2 v[66:67], v39, s[20:23], s47 offen sc1
s_waitcnt vmcnt(0)
v_lshlrev_b32 v64, 16, v66
v_and_b32 v65, 0xffff0000, v66
v_add_f32 v48, v48, v64
v_add_f32 v49, v49, v65
v_lshlrev_b32 v64, 16, v67
v_and_b32 v65, 0xffff0000, v67
v_add_f32 v50, v50, v64
v_add_f32 v51, v51, v65
LE_fl15:
s_nop 3
v_cvt_pk_bf16_f32 v64, v48, v49
v_cvt_pk_bf16_f32 v65, v50, v51
v_mov_b32 v48, 0
v_mov_b32 v49, 0
v_mov_b32 v50, 0
v_mov_b32 v51, 0
buffer_store_dwordx2 v[64:65], v39, s[20:23], s47 offen sc1
s_add_u32 s47, s47, 512
LE_nf15:
s_waitcnt lgkmcnt(0)
ds_read2_b32 v[52:53], v34 offset0:64 offset1:68
ds_read2_b32 v[54:55], v34 offset0:72 offset1:76
v_mad_u32_u16 v60, v56, s49, v2
v_mad_u32_u16 v61, v57, s49, v2
v_mad_u32_u16 v62, v58, s49, v2
v_mad_u32_u16 v63, v59, s49, v2
buffer_load_dwordx4 a[96:99], v60, s[16:19], 0 offen sc1
buffer_load_dwordx4 a[100:103], v60, s[16:19], 0 offen offset:256 sc1
buffer_load_dwordx4 a[104:107], v61, s[16:19], 0 offen sc1
buffer_load_dwordx4 a[108:111], v61, s[16:19], 0 offen offset:256 sc1
buffer_load_dwordx4 a[112:115], v62, s[16:19], 0 offen sc1
buffer_load_dwordx4 a[116:119], v62, s[16:19], 0 offen offset:256 sc1
buffer_load_dwordx4 a[120:123], v63, s[16:19], 0 offen sc1
buffer_load_dwordx4 a[124:127], v63, s[16:19], 0 offen offset:256 sc1
s_waitcnt vmcnt(56)
v_mfma_f32_16x16x32_bf16 v[48:51], a[128:131], v[40:43], v[48:51]
v_mfma_f32_16x16x32_bf16 v[48:51], a[132:135], v[44:47], v[48:51]
s_bitcmp1_b32 s46, 16
s_cbranch_scc0 LE_nf16
s_cmp_eq_u32 s42, 0
s_cbranch_scc1 LE_fl16
buffer_load_dwordx2 v[66:67], v39, s[20:23], s47 offen sc1
s_waitcnt vmcnt(0)
v_lshlrev_b32 v64, 16, v66
v_and_b32 v65, 0xffff0000, v66
v_add_f32 v48, v48, v64
v_add_f32 v49, v49, v65
v_lshlrev_b32 v64, 16, v67
v_and_b32 v65, 0xffff0000, v67
v_add_f32 v50, v50, v64
v_add_f32 v51, v51, v65
LE_fl16:
s_nop 3
v_cvt_pk_bf16_f32 v64, v48, v49
v_cvt_pk_bf16_f32 v65, v50, v51
v_mov_b32 v48, 0
v_mov_b32 v49, 0
v_mov_b32 v50, 0
v_mov_b32 v51, 0
buffer_store_dwordx2 v[64:65], v39, s[20:23], s47 offen sc1
s_add_u32 s47, s47, 512
LE_nf16:
v_mfma_f32_16x16x32_bf16 v[48:51], a[136:139], v[40:43], v[48:51]
v_mfma_f32_16x16x32_bf16 v[48:51], a[140:143], v[44:47], v[48:51]
s_bitcmp1_b32 s46, 17
s_cbranch_scc0 LE_nf17
s_cmp_eq_u32 s42, 0
s_cbranch_scc1 LE_fl17
buffer_load_dwordx2 v[66:67], v39, s[20:23], s47 offen sc1
s_waitcnt vmcnt(0)
v_lshlrev_b32 v64, 16, v66
v_and_b32 v65, 0xffff0000, v66
v_add_f32 v48, v48, v64
v_add_f32 v49, v49, v65
v_lshlrev_b32 v64, 16, v67
v_and_b32 v65, 0xffff0000, v67
v_add_f32 v50, v50, v64
v_add_f32 v51, v51, v65
LE_fl17:
s_nop 3
v_cvt_pk_bf16_f32 v64, v48, v49
v_cvt_pk_bf16_f32 v65, v50, v51
v_mov_b32 v48, 0
v_mov_b32 v49, 0
v_mov_b32 v50, 0
v_mov_b32 v51, 0
buffer_store_dwordx2 v[64:65], v39, s[20:23], s47 offen sc1
s_add_u32 s47, s47, 512
LE_nf17:
v_mfma_f32_16x16x32_bf16 v[48:51], a[144:147], v[40:43], v[48:51]
v_mfma_f32_16x16x32_bf16 v[48:51], a[148:151], v[44:47], v[48:51]
s_bitcmp1_b32 s46, 18
s_cbranch_scc0 LE_nf18
s_cmp_eq_u32 s42, 0
s_cbranch_scc1 LE_fl18
buffer_load_dwordx2 v[66:67], v39, s[20:23], s47 offen sc1
s_waitcnt vmcnt(0)
v_lshlrev_b32 v64, 16, v66
v_and_b32 v65, 0xffff0000, v66
v_add_f32 v48, v48, v64
v_add_f32 v49, v49, v65
v_lshlrev_b32 v64, 16, v67
v_and_b32 v65, 0xffff0000, v67
v_add_f32 v50, v50, v64
v_add_f32 v51, v51, v65
LE_fl18:
s_nop 3
v_cvt_pk_bf16_f32 v64, v48, v49
v_cvt_pk_bf16_f32 v65, v50, v51
v_mov_b32 v48, 0
v_mov_b32 v49, 0
v_mov_b32 v50, 0
v_mov_b32 v51, 0
buffer_store_dwordx2 v[64:65], v39, s[20:23], s47 offen sc1
s_add_u32 s47, s47, 512
LE_nf18:
v_mfma_f32_16x16x32_bf16 v[48:51], a[152:155], v[40:43], v[48:51]
v_mfma_f32_16x16x32_bf16 v[48:51], a[156:159], v[44:47], v[48:51]
s_bitcmp1_b32 s46, 19
s_cbranch_scc0 LE_nf19
s_cmp_eq_u32 s42, 0
s_cbranch_scc1 LE_fl19
buffer_load_dwordx2 v[66:67], v39, s[20:23], s47 offen sc1
s_waitcnt vmcnt(0)
v_lshlrev_b32 v64, 16, v66
v_and_b32 v65, 0xffff0000, v66
v_add_f32 v48, v48, v64
v_add_f32 v49, v49, v65
v_lshlrev_b32 v64, 16, v67
v_and_b32 v65, 0xffff0000, v67
v_add_f32 v50, v50, v64
v_add_f32 v51, v51, v65
LE_fl19:
s_nop 3
v_cvt_pk_bf16_f32 v64, v48, v49
v_cvt_pk_bf16_f32 v65, v50, v51
v_mov_b32 v48, 0
v_mov_b32 v49, 0
v_mov_b32 v50, 0
v_mov_b32 v51, 0
buffer_store_dwordx2 v[64:65], v39, s[20:23], s47 offen sc1
s_add_u32 s47, s47, 512
LE_nf19:
s_waitcnt lgkmcnt(0)
ds_read2_b32 v[56:57], v34 offset0:80 offset1:84
ds_read2_b32 v[58:59], v34 offset0:88 offset1:92
v_mad_u32_u16 v60, v52, s49, v2
v_mad_u32_u16 v61, v53, s49, v2
v_mad_u32_u16 v62, v54, s49, v2
v_mad_u32_u16 v63, v55, s49, v2
buffer_load_dwordx4 a[128:131], v60, s[16:19], 0 offen sc1
buffer_load_dwordx4 a[132:135], v60, s[16:19], 0 offen offset:256 sc1
buffer_load_dwordx4 a[136:139], v61, s[16:19], 0 offen sc1
buffer_load_dwordx4 a[140:143], v61, s[16:19], 0 offen offset:256 sc1
buffer_load_dwordx4 a[144:147], v62, s[16:19], 0 offen sc1
buffer_load_dwordx4 a[148:151], v62, s[16:19], 0 offen offset:256 sc1
buffer_load_dwordx4 a[152:155], v63, s[16:19], 0 offen sc1
buffer_load_dwordx4 a[156:159], v63, s[16:19], 0 offen offset:256 sc1
s_waitcnt vmcnt(56)
v_mfma_f32_16x16x32_bf16 v[48:51], a[160:163], v[40:43], v[48:51]
v_mfma_f32_16x16x32_bf16 v[48:51], a[164:167], v[44:47], v[48:51]
s_bitcmp1_b32 s46, 20
s_cbranch_scc0 LE_nf20
s_cmp_eq_u32 s42, 0
s_cbranch_scc1 LE_fl20
buffer_load_dwordx2 v[66:67], v39, s[20:23], s47 offen sc1
s_waitcnt vmcnt(0)
v_lshlrev_b32 v64, 16, v66
v_and_b32 v65, 0xffff0000, v66
v_add_f32 v48, v48, v64
v_add_f32 v49, v49, v65
v_lshlrev_b32 v64, 16, v67
v_and_b32 v65, 0xffff0000, v67
v_add_f32 v50, v50, v64
v_add_f32 v51, v51, v65
LE_fl20:
s_nop 3
v_cvt_pk_bf16_f32 v64, v48, v49
v_cvt_pk_bf16_f32 v65, v50, v51
v_mov_b32 v48, 0
v_mov_b32 v49, 0
v_mov_b32 v50, 0
v_mov_b32 v51, 0
buffer_store_dwordx2 v[64:65], v39, s[20:23], s47 offen sc1
s_add_u32 s47, s47, 512
LE_nf20:
v_mfma_f32_16x16x32_bf16 v[48:51], a[168:171], v[40:43], v[48:51]
v_mfma_f32_16x16x32_bf16 v[48:51], a[172:175], v[44:47], v[48:51]
s_bitcmp1_b32 s46, 21
s_cbranch_scc0 LE_nf21
s_cmp_eq_u32 s42, 0
s_cbranch_scc1 LE_fl21
buffer_load_dwordx2 v[66:67], v39, s[20:23], s47 offen sc1
s_waitcnt vmcnt(0)
v_lshlrev_b32 v64, 16, v66
v_and_b32 v65, 0xffff0000, v66
v_add_f32 v48, v48, v64
v_add_f32 v49, v49, v65
v_lshlrev_b32 v64, 16, v67
v_and_b32 v65, 0xffff0000, v67
v_add_f32 v50, v50, v64
v_add_f32 v51, v51, v65
LE_fl21:
s_nop 3
v_cvt_pk_bf16_f32 v64, v48, v49
v_cvt_pk_bf16_f32 v65, v50, v51
v_mov_b32 v48, 0
v_mov_b32 v49, 0
v_mov_b32 v50, 0
v_mov_b32 v51, 0
buffer_store_dwordx2 v[64:65], v39, s[20:23], s47 offen sc1
s_add_u32 s47, s47, 512
LE_nf21:
v_mfma_f32_16x16x32_bf16 v[48:51], a[176:179], v[40:43], v[48:51]
v_mfma_f32_16x16x32_bf16 v[48:51], a[180:183], v[44:47], v[48:51]
s_bitcmp1_b32 s46, 22
s_cbranch_scc0 LE_nf22
s_cmp_eq_u32 s42, 0
s_cbranch_scc1 LE_fl22
buffer_load_dwordx2 v[66:67], v39, s[20:23], s47 offen sc1
s_waitcnt vmcnt(0)
v_lshlrev_b32 v64, 16, v66
v_and_b32 v65, 0xffff0000, v66
v_add_f32 v48, v48, v64
v_add_f32 v49, v49, v65
v_lshlrev_b32 v64, 16, v67
v_and_b32 v65, 0xffff0000, v67
v_add_f32 v50, v50, v64
v_add_f32 v51, v51, v65
LE_fl22:
s_nop 3
v_cvt_pk_bf16_f32 v64, v48, v49
v_cvt_pk_bf16_f32 v65, v50, v51
v_mov_b32 v48, 0
v_mov_b32 v49, 0
v_mov_b32 v50, 0
v_mov_b32 v51, 0
buffer_store_dwordx2 v[64:65], v39, s[20:23], s47 offen sc1
s_add_u32 s47, s47, 512
LE_nf22:
v_mfma_f32_16x16x32_bf16 v[48:51], a[184:187], v[40:43], v[48:51]
v_mfma_f32_16x16x32_bf16 v[48:51], a[188:191], v[44:47], v[48:51]
s_bitcmp1_b32 s46, 23
s_cbranch_scc0 LE_nf23
s_cmp_eq_u32 s42, 0
s_cbranch_scc1 LE_fl23
buffer_load_dwordx2 v[66:67], v39, s[20:23], s47 offen sc1
s_waitcnt vmcnt(0)
v_lshlrev_b32 v64, 16, v66
v_and_b32 v65, 0xffff0000, v66
v_add_f32 v48, v48, v64
v_add_f32 v49, v49, v65
v_lshlrev_b32 v64, 16, v67
v_and_b32 v65, 0xffff0000, v67
v_add_f32 v50, v50, v64
v_add_f32 v51, v51, v65
LE_fl23:
s_nop 3
v_cvt_pk_bf16_f32 v64, v48, v49
v_cvt_pk_bf16_f32 v65, v50, v51
v_mov_b32 v48, 0
v_mov_b32 v49, 0
v_mov_b32 v50, 0
v_mov_b32 v51, 0
buffer_store_dwordx2 v[64:65], v39, s[20:23], s47 offen sc1
s_add_u32 s47, s47, 512
LE_nf23:
s_waitcnt lgkmcnt(0)
ds_read2_b32 v[52:53], v34 offset0:96 offset1:100
ds_read2_b32 v[54:55], v34 offset0:104 offset1:108
v_mad_u32_u16 v60, v56, s49, v2
v_mad_u32_u16 v61, v57, s49, v2
v_mad_u32_u16 v62, v58, s49, v2
v_mad_u32_u16 v63, v59, s49, v2
buffer_load_dwordx4 a[160:163], v60, s[16:19], 0 offen sc1
buffer_load_dwordx4 a[164:167], v60, s[16:19], 0 offen offset:256 sc1
buffer_load_dwordx4 a[168:171], v61, s[16:19], 0 offen sc1
buffer_load_dwordx4 a[172:175], v61, s[16:19], 0 offen offset:256 sc1
buffer_load_dwordx4 a[176:179], v62, s[16:19], 0 offen sc1
buffer_load_dwordx4 a[180:183], v62, s[16:19], 0 offen offset:256 sc1
buffer_load_dwordx4 a[184:187], v63, s[16:19], 0 offen sc1
buffer_load_dwordx4 a[188:191], v63, s[16:19], 0 offen offset:256 sc1
s_waitcnt vmcnt(56)
v_mfma_f32_16x16x32_bf16 v[48:51], a[192:195], v[40:43], v[48:51]
v_mfma_f32_16x16x32_bf16 v[48:51], a[196:199], v[44:47], v[48:51]
s_bitcmp1_b32 s46, 24
s_cbranch_scc0 LE_nf24
s_cmp_eq_u32 s42, 0
s_cbranch_scc1 LE_fl24
buffer_load_dwordx2 v[66:67], v39, s[20:23], s47 offen sc1
s_waitcnt vmcnt(0)
v_lshlrev_b32 v64, 16, v66
v_and_b32 v65, 0xffff0000, v66
v_add_f32 v48, v48, v64
v_add_f32 v49, v49, v65
v_lshlrev_b32 v64, 16, v67
v_and_b32 v65, 0xffff0000, v67
v_add_f32 v50, v50, v64
v_add_f32 v51, v51, v65
LE_fl24:
s_nop 3
v_cvt_pk_bf16_f32 v64, v48, v49
v_cvt_pk_bf16_f32 v65, v50, v51
v_mov_b32 v48, 0
v_mov_b32 v49, 0
v_mov_b32 v50, 0
v_mov_b32 v51, 0
buffer_store_dwordx2 v[64:65], v39, s[20:23], s47 offen sc1
s_add_u32 s47, s47, 512
LE_nf24:
v_mfma_f32_16x16x32_bf16 v[48:51], a[200:203], v[40:43], v[48:51]
v_mfma_f32_16x16x32_bf16 v[48:51], a[204:207], v[44:47], v[48:51]
s_bitcmp1_b32 s46, 25
s_cbranch_scc0 LE_nf25
s_cmp_eq_u32 s42, 0
s_cbranch_scc1 LE_fl25
buffer_load_dwordx2 v[66:67], v39, s[20:23], s47 offen sc1
s_waitcnt vmcnt(0)
v_lshlrev_b32 v64, 16, v66
v_and_b32 v65, 0xffff0000, v66
v_add_f32 v48, v48, v64
v_add_f32 v49, v49, v65
v_lshlrev_b32 v64, 16, v67
v_and_b32 v65, 0xffff0000, v67
v_add_f32 v50, v50, v64
v_add_f32 v51, v51, v65
LE_fl25:
s_nop 3
v_cvt_pk_bf16_f32 v64, v48, v49
v_cvt_pk_bf16_f32 v65, v50, v51
v_mov_b32 v48, 0
v_mov_b32 v49, 0
v_mov_b32 v50, 0
v_mov_b32 v51, 0
buffer_store_dwordx2 v[64:65], v39, s[20:23], s47 offen sc1
s_add_u32 s47, s47, 512
LE_nf25:
v_mfma_f32_16x16x32_bf16 v[48:51], a[208:211], v[40:43], v[48:51]
v_mfma_f32_16x16x32_bf16 v[48:51], a[212:215], v[44:47], v[48:51]
s_bitcmp1_b32 s46, 26
s_cbranch_scc0 LE_nf26
s_cmp_eq_u32 s42, 0
s_cbranch_scc1 LE_fl26
buffer_load_dwordx2 v[66:67], v39, s[20:23], s47 offen sc1
s_waitcnt vmcnt(0)
v_lshlrev_b32 v64, 16, v66
v_and_b32 v65, 0xffff0000, v66
v_add_f32 v48, v48, v64
v_add_f32 v49, v49, v65
v_lshlrev_b32 v64, 16, v67
v_and_b32 v65, 0xffff0000, v67
v_add_f32 v50, v50, v64
v_add_f32 v51, v51, v65
LE_fl26:
s_nop 3
v_cvt_pk_bf16_f32 v64, v48, v49
v_cvt_pk_bf16_f32 v65, v50, v51
v_mov_b32 v48, 0
v_mov_b32 v49, 0
v_mov_b32 v50, 0
v_mov_b32 v51, 0
buffer_store_dwordx2 v[64:65], v39, s[20:23], s47 offen sc1
s_add_u32 s47, s47, 512
LE_nf26:
v_mfma_f32_16x16x32_bf16 v[48:51], a[216:219], v[40:43], v[48:51]
v_mfma_f32_16x16x32_bf16 v[48:51], a[220:223], v[44:47], v[48:51]
s_bitcmp1_b32 s46, 27
s_cbranch_scc0 LE_nf27
s_cmp_eq_u32 s42, 0
s_cbranch_scc1 LE_fl27
buffer_load_dwordx2 v[66:67], v39, s[20:23], s47 offen sc1
s_waitcnt vmcnt(0)
v_lshlrev_b32 v64, 16, v66
v_and_b32 v65, 0xffff0000, v66
v_add_f32 v48, v48, v64
v_add_f32 v49, v49, v65
v_lshlrev_b32 v64, 16, v67
v_and_b32 v65, 0xffff0000, v67
v_add_f32 v50, v50, v64
v_add_f32 v51, v51, v65
LE_fl27:
s_nop 3
v_cvt_pk_bf16_f32 v64, v48, v49
v_cvt_pk_bf16_f32 v65, v50, v51
v_mov_b32 v48, 0
v_mov_b32 v49, 0
v_mov_b32 v50, 0
v_mov_b32 v51, 0
buffer_store_dwordx2 v[64:65], v39, s[20:23], s47 offen sc1
s_add_u32 s47, s47, 512
LE_nf27:
s_waitcnt lgkmcnt(0)
ds_read2_b32 v[56:57], v34 offset0:112 offset1:116
ds_read2_b32 v[58:59], v34 offset0:120 offset1:124
v_mad_u32_u16 v60, v52, s49, v2
v_mad_u32_u16 v61, v53, s49, v2
v_mad_u32_u16 v62, v54, s49, v2
v_mad_u32_u16 v63, v55, s49, v2
buffer_load_dwordx4 a[192:195], v60, s[16:19], 0 offen sc1
buffer_load_dwordx4 a[196:199], v60, s[16:19], 0 offen offset:256 sc1
buffer_load_dwordx4 a[200:203], v61, s[16:19], 0 offen sc1
buffer_load_dwordx4 a[204:207], v61, s[16:19], 0 offen offset:256 sc1
buffer_load_dwordx4 a[208:211], v62, s[16:19], 0 offen sc1
buffer_load_dwordx4 a[212:215], v62, s[16:19], 0 offen offset:256 sc1
buffer_load_dwordx4 a[216:219], v63, s[16:19], 0 offen sc1
buffer_load_dwordx4 a[220:223], v63, s[16:19], 0 offen offset:256 sc1
s_waitcnt vmcnt(56)
v_mfma_f32_16x16x32_bf16 v[48:51], a[224:227], v[40:43], v[48:51]
v_mfma_f32_16x16x32_bf16 v[48:51], a[228:231], v[44:47], v[48:51]
s_bitcmp1_b32 s46, 28
s_cbranch_scc0 LE_nf28
s_cmp_eq_u32 s42, 0
s_cbranch_scc1 LE_fl28
buffer_load_dwordx2 v[66:67], v39, s[20:23], s47 offen sc1
s_waitcnt vmcnt(0)
v_lshlrev_b32 v64, 16, v66
v_and_b32 v65, 0xffff0000, v66
v_add_f32 v48, v48, v64
v_add_f32 v49, v49, v65
v_lshlrev_b32 v64, 16, v67
v_and_b32 v65, 0xffff0000, v67
v_add_f32 v50, v50, v64
v_add_f32 v51, v51, v65
LE_fl28:
s_nop 3
v_cvt_pk_bf16_f32 v64, v48, v49
v_cvt_pk_bf16_f32 v65, v50, v51
v_mov_b32 v48, 0
v_mov_b32 v49, 0
v_mov_b32 v50, 0
v_mov_b32 v51, 0
buffer_store_dwordx2 v[64:65], v39, s[20:23], s47 offen sc1
s_add_u32 s47, s47, 512
LE_nf28:
v_mfma_f32_16x16x32_bf16 v[48:51], a[232:235], v[40:43], v[48:51]
v_mfma_f32_16x16x32_bf16 v[48:51], a[236:239], v[44:47], v[48:51]
s_bitcmp1_b32 s46, 29
s_cbranch_scc0 LE_nf29
s_cmp_eq_u32 s42, 0
s_cbranch_scc1 LE_fl29
buffer_load_dwordx2 v[66:67], v39, s[20:23], s47 offen sc1
s_waitcnt vmcnt(0)
v_lshlrev_b32 v64, 16, v66
v_and_b32 v65, 0xffff0000, v66
v_add_f32 v48, v48, v64
v_add_f32 v49, v49, v65
v_lshlrev_b32 v64, 16, v67
v_and_b32 v65, 0xffff0000, v67
v_add_f32 v50, v50, v64
v_add_f32 v51, v51, v65
LE_fl29:
s_nop 3
v_cvt_pk_bf16_f32 v64, v48, v49
v_cvt_pk_bf16_f32 v65, v50, v51
v_mov_b32 v48, 0
v_mov_b32 v49, 0
v_mov_b32 v50, 0
v_mov_b32 v51, 0
buffer_store_dwordx2 v[64:65], v39, s[20:23], s47 offen sc1
s_add_u32 s47, s47, 512
LE_nf29:
v_mfma_f32_16x16x32_bf16 v[48:51], a[240:243], v[40:43], v[48:51]
v_mfma_f32_16x16x32_bf16 v[48:51], a[244:247], v[44:47], v[48:51]
s_bitcmp1_b32 s46, 30
s_cbranch_scc0 LE_nf30
s_cmp_eq_u32 s42, 0
s_cbranch_scc1 LE_fl30
buffer_load_dwordx2 v[66:67], v39, s[20:23], s47 offen sc1
s_waitcnt vmcnt(0)
v_lshlrev_b32 v64, 16, v66
v_and_b32 v65, 0xffff0000, v66
v_add_f32 v48, v48, v64
v_add_f32 v49, v49, v65
v_lshlrev_b32 v64, 16, v67
v_and_b32 v65, 0xffff0000, v67
v_add_f32 v50, v50, v64
v_add_f32 v51, v51, v65
LE_fl30:
s_nop 3
v_cvt_pk_bf16_f32 v64, v48, v49
v_cvt_pk_bf16_f32 v65, v50, v51
v_mov_b32 v48, 0
v_mov_b32 v49, 0
v_mov_b32 v50, 0
v_mov_b32 v51, 0
buffer_store_dwordx2 v[64:65], v39, s[20:23], s47 offen sc1
s_add_u32 s47, s47, 512
LE_nf30:
v_mfma_f32_16x16x32_bf16 v[48:51], a[248:251], v[40:43], v[48:51]
v_mfma_f32_16x16x32_bf16 v[48:51], a[252:255], v[44:47], v[48:51]
s_bitcmp1_b32 s46, 31
s_cbranch_scc0 LE_nf31
s_cmp_eq_u32 s42, 0
s_cbranch_scc1 LE_fl31
buffer_load_dwordx2 v[66:67], v39, s[20:23], s47 offen sc1
s_waitcnt vmcnt(0)
v_lshlrev_b32 v64, 16, v66
v_and_b32 v65, 0xffff0000, v66
v_add_f32 v48, v48, v64
v_add_f32 v49, v49, v65
v_lshlrev_b32 v64, 16, v67
v_and_b32 v65, 0xffff0000, v67
v_add_f32 v50, v50, v64
v_add_f32 v51, v51, v65
LE_fl31:
s_nop 3
v_cvt_pk_bf16_f32 v64, v48, v49
v_cvt_pk_bf16_f32 v65, v50, v51
v_mov_b32 v48, 0
v_mov_b32 v49, 0
v_mov_b32 v50, 0
v_mov_b32 v51, 0
buffer_store_dwordx2 v[64:65], v39, s[20:23], s47 offen sc1
s_add_u32 s47, s47, 512
LE_nf31:
s_waitcnt lgkmcnt(0)
ds_read2_b32 v[52:53], v34 offset0:128 offset1:132
ds_read2_b32 v[54:55], v34 offset0:136 offset1:140
v_mad_u32_u16 v60, v56, s49, v2
v_mad_u32_u16 v61, v57, s49, v2
v_mad_u32_u16 v62, v58, s49, v2
v_mad_u32_u16 v63, v59, s49, v2
buffer_load_dwordx4 a[224:227], v60, s[16:19], 0 offen sc1
buffer_load_dwordx4 a[228:231], v60, s[16:19], 0 offen offset:256 sc1
buffer_load_dwordx4 a[232:235], v61, s[16:19], 0 offen sc1
buffer_load_dwordx4 a[236:239], v61, s[16:19], 0 offen offset:256 sc1
buffer_load_dwordx4 a[240:243], v62, s[16:19], 0 offen sc1
buffer_load_dwordx4 a[244:247], v62, s[16:19], 0 offen offset:256 sc1
buffer_load_dwordx4 a[248:251], v63, s[16:19], 0 offen sc1
buffer_load_dwordx4 a[252:255], v63, s[16:19], 0 offen offset:256 sc1
v_add_u32 v34, 512, v34
s_cmp_lt_u32 s45, s44
s_cbranch_scc1 LE_loop
s_add_u32 s42, s42, 1
s_mul_i32 s43, s42, 256
v_cmp_lt_u32 vcc, s43, v4
s_cbranch_vccz LE_done
s_cmp_ge_u32 s42, 40
s_cbranch_scc1 LE_done
s_waitcnt vmcnt(0) lgkmcnt(0)
s_add_u32 s50, s50, 1048576
v_add_u32 v5, 0x100, v5
buffer_load_dwordx4 v[192:195], v6, s[12:15], s50 offen offset:0 sc1
buffer_load_dwordx4 v[196:199], v6, s[12:15], s50 offen offset:64 sc1
buffer_load_dwordx4 v[200:203], v6, s[12:15], s50 offen offset:128 sc1
buffer_load_dwordx4 v[204:207], v6, s[12:15], s50 offen offset:192 sc1
buffer_load_dwordx4 v[208:211], v6, s[12:15], s50 offen offset:256 sc1
buffer_load_dwordx4 v[212:215], v6, s[12:15], s50 offen offset:320 sc1
buffer_load_dwordx4 v[216:219], v6, s[12:15], s50 offen offset:384 sc1
buffer_load_dwordx4 v[220:223], v6, s[12:15], s50 offen offset:448 sc1
buffer_load_dwordx4 v[224:227], v6, s[12:15], s50 offen offset:512 sc1
buffer_load_dwordx4 v[228:231], v6, s[12:15], s50 offen offset:576 sc1
buffer_load_dwordx4 v[232:235], v6, s[12:15], s50 offen offset:640 sc1
buffer_load_dwordx4 v[236:239], v6, s[12:15], s50 offen offset:704 sc1
buffer_load_dwordx4 v[240:243], v6, s[12:15], s50 offen offset:768 sc1
buffer_load_dwordx4 v[244:247], v6, s[12:15], s50 offen offset:832 sc1
buffer_load_dwordx4 v[248:251], v6, s[12:15], s50 offen offset:896 sc1
buffer_load_dwordx4 v[252:255], v6, s[12:15], s50 offen offset:960 sc1
s_branch LE_pass
LE_done:
s_add_u32 s24, s4, 0x7c00000
s_addc_u32 s25, s5, 0
s_mov_b32 s26, 0x40000
s_mov_b32 s27, 0x00020000
s_add_u32 s48, s40, 1280
s_mul_i32 s48, s48, 128
s_waitcnt vmcnt(0)
v_lshlrev_b32 v196, 4, v1
v_mov_b32 v192, s98
v_mov_b32 v193, s99
v_mov_b32 v194, s98
v_mov_b32 v195, s99
s_mov_b64 exec, 0xff
buffer_store_dwordx4 v[192:195], v196, s[24:27], s48 offen sc1
s_mov_b64 exec, -1
s_branch L2_end
L2_fin:
L2_end:
s_endpgm
L2_hot:
L2_rare_site0:
s_mov_b32 s36, 0
s_branch L2_rare_0
L2_rare_site4:
s_mov_b32 s36, 4
s_branch L2_rare_0
L2_rare_0:
s_nop 15
s_nop 15
s_waitcnt lgkmcnt(0)
v_lshrrev_b32 v206, 8, v243
v_add_u32 v206, 1, v206
v_lshrrev_b32 v206, 2, v206
v_sub_u32 v206, 0, v206
v_and_b32 v206, 0xffff0000, v206
v_add_u32 v207, 0x18000, v240
v_and_b32 v207, 0x1ffff, v207
ds_read_b128 v[200:203], v207 offset:29184
s_waitcnt lgkmcnt(0)
v_mfma_f32_16x16x32_bf16 v[192:195], v[200:203], v[0:3], 0
s_nop 7
ds_read_b128 v[200:203], v207 offset:28672
s_waitcnt lgkmcnt(0)
v_mfma_f32_16x16x32_bf16 v[192:195], v[200:203], v[4:7], v[192:195]
s_nop 7
ds_read_b128 v[200:203], v207 offset:16384
s_waitcnt lgkmcnt(0)
v_mfma_f32_16x16x32_bf16 v[192:195], v[200:203], v[8:11], v[192:195]
s_nop 7
ds_read_b128 v[200:203], v207 offset:16896
s_waitcnt lgkmcnt(0)
v_mfma_f32_16x16x32_bf16 v[192:195], v[200:203], v[12:15], v[192:195]
s_nop 7
ds_read_b128 v[200:203], v207 offset:20480
s_waitcnt lgkmcnt(0)
v_mfma_f32_16x16x32_bf16 v[192:195], v[200:203], v[16:19], v[192:195]
s_nop 7
ds_read_b128 v[200:203], v207 offset:20992
s_waitcnt lgkmcnt(0)
v_mfma_f32_16x16x32_bf16 v[192:195], v[200:203], v[20:23], v[192:195]
s_nop 7
ds_read_b128 v[200:203], v207 offset:24576
s_waitcnt lgkmcnt(0)
v_mfma_f32_16x16x32_bf16 v[192:195], v[200:203], v[24:27], v[192:195]
s_nop 7
ds_read_b128 v[200:203], v207 offset:25088
s_waitcnt lgkmcnt(0)
v_mfma_f32_16x16x32_bf16 v[192:195], v[200:203], v[28:31], v[192:195]
s_nop 7
ds_read_b128 v[200:203], v207 offset:31232
s_waitcnt lgkmcnt(0)
v_mfma_f32_16x16x32_bf16 v[196:199], v[200:203], v[0:3], 0
s_nop 7
ds_read_b128 v[200:203], v207 offset:30720
s_waitcnt lgkmcnt(0)
v_mfma_f32_16x16x32_bf16 v[196:199], v[200:203], v[4:7], v[196:199]
s_nop 7
ds_read_b128 v[200:203], v207 offset:18432
s_waitcnt lgkmcnt(0)
v_mfma_f32_16x16x32_bf16 v[196:199], v[200:203], v[8:11], v[196:199]
s_nop 7
ds_read_b128 v[200:203], v207 offset:18944
s_waitcnt lgkmcnt(0)
v_mfma_f32_16x16x32_bf16 v[196:199], v[200:203], v[12:15], v[196:199]
s_nop 7
ds_read_b128 v[200:203], v207 offset:22528
s_waitcnt lgkmcnt(0)
v_mfma_f32_16x16x32_bf16 v[196:199], v[200:203], v[16:19], v[196:199]
s_nop 7
ds_read_b128 v[200:203], v207 offset:23040
s_waitcnt lgkmcnt(0)
v_mfma_f32_16x16x32_bf16 v[196:199], v[200:203], v[20:23], v[196:199]
s_nop 7
ds_read_b128 v[200:203], v207 offset:26624
s_waitcnt lgkmcnt(0)
v_mfma_f32_16x16x32_bf16 v[196:199], v[200:203], v[24:27], v[196:199]
s_nop 7
ds_read_b128 v[200:203], v207 offset:27136
s_waitcnt lgkmcnt(0)
v_mfma_f32_16x16x32_bf16 v[196:199], v[200:203], v[28:31], v[196:199]
s_nop 7
s_nop 7
v_max_f32 v204, v192, v193
v_max3_f32 v204, v204, v194, v195
v_max3_f32 v204, v204, v196, v197
v_max3_f32 v204, v204, v198, v199
v_mov_b32 v205, v204
s_nop 1
v_permlane32_swap_b32 v204, v205
s_nop 1
v_max_f32 v204, v204, v205
v_mov_b32 v205, v204
s_nop 1
v_permlane16_swap_b32 v204, v205
s_nop 1
v_max_f32 v204, v204, v205
v_add_f32 v204, 40.0, v204
v_ceil_f32 v204, v204
v_max_f32 v204, 0, v204
v_sub_f32 v205, v224, v204
v_cvt_pk_bf16_f32 v205, v205, v205
v_and_b32 v205, 0xffff0000, v205
v_sub_f32 v204, v205, v224
v_mov_b32 v224, v205
v_exp_f32 v236, v204
v_bfi_b32 v3, v206, v205, v3
v_add_f32 v192, v192, v204
v_add_f32 v193, v193, v204
v_add_f32 v194, v194, v204
v_add_f32 v195, v195, v204
v_add_f32 v196, v196, v204
v_add_f32 v197, v197, v204
v_add_f32 v198, v198, v204
v_add_f32 v199, v199, v204
v_add_f32 v128, v128, v204
v_add_f32 v129, v129, v204
v_add_f32 v130, v130, v204
v_add_f32 v131, v131, v204
v_lshlrev_b32 v242, 16, v160
v_and_b32 v248, 0xffff0000, v160
v_mul_f32 v242, v242, v236
v_mul_f32 v248, v248, v236
v_cvt_pk_bf16_f32 v160, v242, v248
v_lshlrev_b32 v242, 16, v161
v_and_b32 v248, 0xffff0000, v161
v_mul_f32 v242, v242, v236
v_mul_f32 v248, v248, v236
v_cvt_pk_bf16_f32 v161, v242, v248
v_lshlrev_b32 v242, 16, v162
v_and_b32 v248, 0xffff0000, v162
v_mul_f32 v242, v242, v236
v_mul_f32 v248, v248, v236
v_cvt_pk_bf16_f32 v162, v242, v248
v_lshlrev_b32 v242, 16, v163
v_and_b32 v248, 0xffff0000, v163
v_mul_f32 v242, v242, v236
v_mul_f32 v248, v248, v236
v_cvt_pk_bf16_f32 v163, v242, v248
v_exp_f32 v232, v192
v_exp_f32 v233, v193
v_exp_f32 v234, v194
v_exp_f32 v235, v195
s_nop 1
v_cvt_pk_bf16_f32 v176, v232, v233
v_cvt_pk_bf16_f32 v177, v234, v235
v_exp_f32 v232, v196
v_exp_f32 v233, v197
v_exp_f32 v234, v198
v_exp_f32 v235, v199
s_nop 1
v_cvt_pk_bf16_f32 v178, v232, v233
v_cvt_pk_bf16_f32 v179, v234, v235
ds_read_b128 v[200:203], v207 offset:29184
s_waitcnt lgkmcnt(0)
v_mfma_f32_16x16x32_bf16 v[192:195], v[200:203], v[32:35], 0
s_nop 7
ds_read_b128 v[200:203], v207 offset:28672
s_waitcnt lgkmcnt(0)
v_mfma_f32_16x16x32_bf16 v[192:195], v[200:203], v[36:39], v[192:195]
s_nop 7
ds_read_b128 v[200:203], v207 offset:16384
s_waitcnt lgkmcnt(0)
v_mfma_f32_16x16x32_bf16 v[192:195], v[200:203], v[40:43], v[192:195]
s_nop 7
ds_read_b128 v[200:203], v207 offset:16896
s_waitcnt lgkmcnt(0)
v_mfma_f32_16x16x32_bf16 v[192:195], v[200:203], v[44:47], v[192:195]
s_nop 7
ds_read_b128 v[200:203], v207 offset:20480
s_waitcnt lgkmcnt(0)
v_mfma_f32_16x16x32_bf16 v[192:195], v[200:203], v[48:51], v[192:195]
s_nop 7
ds_read_b128 v[200:203], v207 offset:20992
s_waitcnt lgkmcnt(0)
v_mfma_f32_16x16x32_bf16 v[192:195], v[200:203], v[52:55], v[192:195]
s_nop 7
ds_read_b128 v[200:203], v207 offset:24576
s_waitcnt lgkmcnt(0)
v_mfma_f32_16x16x32_bf16 v[192:195], v[200:203], v[56:59], v[192:195]
s_nop 7
ds_read_b128 v[200:203], v207 offset:25088
s_waitcnt lgkmcnt(0)
v_mfma_f32_16x16x32_bf16 v[192:195], v[200:203], v[60:63], v[192:195]
s_nop 7
ds_read_b128 v[200:203], v207 offset:31232
s_waitcnt lgkmcnt(0)
v_mfma_f32_16x16x32_bf16 v[196:199], v[200:203], v[32:35], 0
s_nop 7
ds_read_b128 v[200:203], v207 offset:30720
s_waitcnt lgkmcnt(0)
v_mfma_f32_16x16x32_bf16 v[196:199], v[200:203], v[36:39], v[196:199]
s_nop 7
ds_read_b128 v[200:203], v207 offset:18432
s_waitcnt lgkmcnt(0)
v_mfma_f32_16x16x32_bf16 v[196:199], v[200:203], v[40:43], v[196:199]
s_nop 7
ds_read_b128 v[200:203], v207 offset:18944
s_waitcnt lgkmcnt(0)
v_mfma_f32_16x16x32_bf16 v[196:199], v[200:203], v[44:47], v[196:199]
s_nop 7
ds_read_b128 v[200:203], v207 offset:22528
s_waitcnt lgkmcnt(0)
v_mfma_f32_16x16x32_bf16 v[196:199], v[200:203], v[48:51], v[196:199]
s_nop 7
ds_read_b128 v[200:203], v207 offset:23040
s_waitcnt lgkmcnt(0)
v_mfma_f32_16x16x32_bf16 v[196:199], v[200:203], v[52:55], v[196:199]
s_nop 7
ds_read_b128 v[200:203], v207 offset:26624
s_waitcnt lgkmcnt(0)
v_mfma_f32_16x16x32_bf16 v[196:199], v[200:203], v[56:59], v[196:199]
s_nop 7
ds_read_b128 v[200:203], v207 offset:27136
s_waitcnt lgkmcnt(0)
v_mfma_f32_16x16x32_bf16 v[196:199], v[200:203], v[60:63], v[196:199]
s_nop 7
s_nop 7
v_max_f32 v204, v192, v193
v_max3_f32 v204, v204, v194, v195
v_max3_f32 v204, v204, v196, v197
v_max3_f32 v204, v204, v198, v199
v_mov_b32 v205, v204
s_nop 1
v_permlane32_swap_b32 v204, v205
s_nop 1
v_max_f32 v204, v204, v205
v_mov_b32 v205, v204
s_nop 1
v_permlane16_swap_b32 v204, v205
s_nop 1
v_max_f32 v204, v204, v205
v_add_f32 v204, 40.0, v204
v_ceil_f32 v204, v204
v_max_f32 v204, 0, v204
v_sub_f32 v205, v225, v204
v_cvt_pk_bf16_f32 v205, v205, v205
v_and_b32 v205, 0xffff0000, v205
v_sub_f32 v204, v205, v225
v_mov_b32 v225, v205
v_exp_f32 v237, v204
v_bfi_b32 v35, v206, v205, v35
v_add_f32 v192, v192, v204
v_add_f32 v193, v193, v204
v_add_f32 v194, v194, v204
v_add_f32 v195, v195, v204
v_add_f32 v196, v196, v204
v_add_f32 v197, v197, v204
v_add_f32 v198, v198, v204
v_add_f32 v199, v199, v204
v_add_f32 v132, v132, v204
v_add_f32 v133, v133, v204
v_add_f32 v134, v134, v204
v_add_f32 v135, v135, v204
v_lshlrev_b32 v242, 16, v164
v_and_b32 v248, 0xffff0000, v164
v_mul_f32 v242, v242, v237
v_mul_f32 v248, v248, v237
v_cvt_pk_bf16_f32 v164, v242, v248
v_lshlrev_b32 v242, 16, v165
v_and_b32 v248, 0xffff0000, v165
v_mul_f32 v242, v242, v237
v_mul_f32 v248, v248, v237
v_cvt_pk_bf16_f32 v165, v242, v248
v_lshlrev_b32 v242, 16, v166
v_and_b32 v248, 0xffff0000, v166
v_mul_f32 v242, v242, v237
v_mul_f32 v248, v248, v237
v_cvt_pk_bf16_f32 v166, v242, v248
v_lshlrev_b32 v242, 16, v167
v_and_b32 v248, 0xffff0000, v167
v_mul_f32 v242, v242, v237
v_mul_f32 v248, v248, v237
v_cvt_pk_bf16_f32 v167, v242, v248
v_exp_f32 v232, v192
v_exp_f32 v233, v193
v_exp_f32 v234, v194
v_exp_f32 v235, v195
s_nop 1
v_cvt_pk_bf16_f32 v180, v232, v233
v_cvt_pk_bf16_f32 v181, v234, v235
v_exp_f32 v232, v196
v_exp_f32 v233, v197
v_exp_f32 v234, v198
v_exp_f32 v235, v199
s_nop 1
v_cvt_pk_bf16_f32 v182, v232, v233
v_cvt_pk_bf16_f32 v183, v234, v235
ds_read_b128 v[200:203], v207 offset:29184
s_waitcnt lgkmcnt(0)
v_mfma_f32_16x16x32_bf16 v[192:195], v[200:203], v[64:67], 0
s_nop 7
ds_read_b128 v[200:203], v207 offset:28672
s_waitcnt lgkmcnt(0)
v_mfma_f32_16x16x32_bf16 v[192:195], v[200:203], v[68:71], v[192:195]
s_nop 7
ds_read_b128 v[200:203], v207 offset:16384
s_waitcnt lgkmcnt(0)
v_mfma_f32_16x16x32_bf16 v[192:195], v[200:203], v[72:75], v[192:195]
s_nop 7
ds_read_b128 v[200:203], v207 offset:16896
s_waitcnt lgkmcnt(0)
v_mfma_f32_16x16x32_bf16 v[192:195], v[200:203], v[76:79], v[192:195]
s_nop 7
ds_read_b128 v[200:203], v207 offset:20480
s_waitcnt lgkmcnt(0)
v_mfma_f32_16x16x32_bf16 v[192:195], v[200:203], v[80:83], v[192:195]
s_nop 7
ds_read_b128 v[200:203], v207 offset:20992
s_waitcnt lgkmcnt(0)
v_mfma_f32_16x16x32_bf16 v[192:195], v[200:203], v[84:87], v[192:195]
s_nop 7
ds_read_b128 v[200:203], v207 offset:24576
s_waitcnt lgkmcnt(0)
v_mfma_f32_16x16x32_bf16 v[192:195], v[200:203], v[88:91], v[192:195]
s_nop 7
ds_read_b128 v[200:203], v207 offset:25088
s_waitcnt lgkmcnt(0)
v_mfma_f32_16x16x32_bf16 v[192:195], v[200:203], v[92:95], v[192:195]
s_nop 7
ds_read_b128 v[200:203], v207 offset:31232
s_waitcnt lgkmcnt(0)
v_mfma_f32_16x16x32_bf16 v[196:199], v[200:203], v[64:67], 0
s_nop 7
ds_read_b128 v[200:203], v207 offset:30720
s_waitcnt lgkmcnt(0)
v_mfma_f32_16x16x32_bf16 v[196:199], v[200:203], v[68:71], v[196:199]
s_nop 7
ds_read_b128 v[200:203], v207 offset:18432
s_waitcnt lgkmcnt(0)
v_mfma_f32_16x16x32_bf16 v[196:199], v[200:203], v[72:75], v[196:199]
s_nop 7
ds_read_b128 v[200:203], v207 offset:18944
s_waitcnt lgkmcnt(0)
v_mfma_f32_16x16x32_bf16 v[196:199], v[200:203], v[76:79], v[196:199]
s_nop 7
ds_read_b128 v[200:203], v207 offset:22528
s_waitcnt lgkmcnt(0)
v_mfma_f32_16x16x32_bf16 v[196:199], v[200:203], v[80:83], v[196:199]
s_nop 7
ds_read_b128 v[200:203], v207 offset:23040
s_waitcnt lgkmcnt(0)
v_mfma_f32_16x16x32_bf16 v[196:199], v[200:203], v[84:87], v[196:199]
s_nop 7
ds_read_b128 v[200:203], v207 offset:26624
s_waitcnt lgkmcnt(0)
v_mfma_f32_16x16x32_bf16 v[196:199], v[200:203], v[88:91], v[196:199]
s_nop 7
ds_read_b128 v[200:203], v207 offset:27136
s_waitcnt lgkmcnt(0)
v_mfma_f32_16x16x32_bf16 v[196:199], v[200:203], v[92:95], v[196:199]
s_nop 7
s_nop 7
v_max_f32 v204, v192, v193
v_max3_f32 v204, v204, v194, v195
v_max3_f32 v204, v204, v196, v197
v_max3_f32 v204, v204, v198, v199
v_mov_b32 v205, v204
s_nop 1
v_permlane32_swap_b32 v204, v205
s_nop 1
v_max_f32 v204, v204, v205
v_mov_b32 v205, v204
s_nop 1
v_permlane16_swap_b32 v204, v205
s_nop 1
v_max_f32 v204, v204, v205
v_add_f32 v204, 40.0, v204
v_ceil_f32 v204, v204
v_max_f32 v204, 0, v204
v_sub_f32 v205, v226, v204
v_cvt_pk_bf16_f32 v205, v205, v205
v_and_b32 v205, 0xffff0000, v205
v_sub_f32 v204, v205, v226
v_mov_b32 v226, v205
v_exp_f32 v238, v204
v_bfi_b32 v67, v206, v205, v67
v_add_f32 v192, v192, v204
v_add_f32 v193, v193, v204
v_add_f32 v194, v194, v204
v_add_f32 v195, v195, v204
v_add_f32 v196, v196, v204
v_add_f32 v197, v197, v204
v_add_f32 v198, v198, v204
v_add_f32 v199, v199, v204
v_add_f32 v136, v136, v204
v_add_f32 v137, v137, v204
v_add_f32 v138, v138, v204
v_add_f32 v139, v139, v204
v_lshlrev_b32 v242, 16, v168
v_and_b32 v248, 0xffff0000, v168
v_mul_f32 v242, v242, v238
v_mul_f32 v248, v248, v238
v_cvt_pk_bf16_f32 v168, v242, v248
v_lshlrev_b32 v242, 16, v169
v_and_b32 v248, 0xffff0000, v169
v_mul_f32 v242, v242, v238
v_mul_f32 v248, v248, v238
v_cvt_pk_bf16_f32 v169, v242, v248
v_lshlrev_b32 v242, 16, v170
v_and_b32 v248, 0xffff0000, v170
v_mul_f32 v242, v242, v238
v_mul_f32 v248, v248, v238
v_cvt_pk_bf16_f32 v170, v242, v248
v_lshlrev_b32 v242, 16, v171
v_and_b32 v248, 0xffff0000, v171
v_mul_f32 v242, v242, v238
v_mul_f32 v248, v248, v238
v_cvt_pk_bf16_f32 v171, v242, v248
v_exp_f32 v232, v192
v_exp_f32 v233, v193
v_exp_f32 v234, v194
v_exp_f32 v235, v195
s_nop 1
v_cvt_pk_bf16_f32 v184, v232, v233
v_cvt_pk_bf16_f32 v185, v234, v235
v_exp_f32 v232, v196
v_exp_f32 v233, v197
v_exp_f32 v234, v198
v_exp_f32 v235, v199
s_nop 1
v_cvt_pk_bf16_f32 v186, v232, v233
v_cvt_pk_bf16_f32 v187, v234, v235
ds_read_b128 v[200:203], v207 offset:29184
s_waitcnt lgkmcnt(0)
v_mfma_f32_16x16x32_bf16 v[192:195], v[200:203], v[96:99], 0
s_nop 7
ds_read_b128 v[200:203], v207 offset:28672
s_waitcnt lgkmcnt(0)
v_mfma_f32_16x16x32_bf16 v[192:195], v[200:203], v[100:103], v[192:195]
s_nop 7
ds_read_b128 v[200:203], v207 offset:16384
s_waitcnt lgkmcnt(0)
v_mfma_f32_16x16x32_bf16 v[192:195], v[200:203], v[104:107], v[192:195]
s_nop 7
ds_read_b128 v[200:203], v207 offset:16896
s_waitcnt lgkmcnt(0)
v_mfma_f32_16x16x32_bf16 v[192:195], v[200:203], v[108:111], v[192:195]
s_nop 7
ds_read_b128 v[200:203], v207 offset:20480
s_waitcnt lgkmcnt(0)
v_mfma_f32_16x16x32_bf16 v[192:195], v[200:203], v[112:115], v[192:195]
s_nop 7
ds_read_b128 v[200:203], v207 offset:20992
s_waitcnt lgkmcnt(0)
v_mfma_f32_16x16x32_bf16 v[192:195], v[200:203], v[116:119], v[192:195]
s_nop 7
ds_read_b128 v[200:203], v207 offset:24576
s_waitcnt lgkmcnt(0)
v_mfma_f32_16x16x32_bf16 v[192:195], v[200:203], v[120:123], v[192:195]
s_nop 7
ds_read_b128 v[200:203], v207 offset:25088
s_waitcnt lgkmcnt(0)
v_mfma_f32_16x16x32_bf16 v[192:195], v[200:203], v[124:127], v[192:195]
s_nop 7
ds_read_b128 v[200:203], v207 offset:31232
s_waitcnt lgkmcnt(0)
v_mfma_f32_16x16x32_bf16 v[196:199], v[200:203], v[96:99], 0
s_nop 7
ds_read_b128 v[200:203], v207 offset:30720
s_waitcnt lgkmcnt(0)
v_mfma_f32_16x16x32_bf16 v[196:199], v[200:203], v[100:103], v[196:199]
s_nop 7
ds_read_b128 v[200:203], v207 offset:18432
s_waitcnt lgkmcnt(0)
v_mfma_f32_16x16x32_bf16 v[196:199], v[200:203], v[104:107], v[196:199]
s_nop 7
ds_read_b128 v[200:203], v207 offset:18944
s_waitcnt lgkmcnt(0)
v_mfma_f32_16x16x32_bf16 v[196:199], v[200:203], v[108:111], v[196:199]
s_nop 7
ds_read_b128 v[200:203], v207 offset:22528
s_waitcnt lgkmcnt(0)
v_mfma_f32_16x16x32_bf16 v[196:199], v[200:203], v[112:115], v[196:199]
s_nop 7
ds_read_b128 v[200:203], v207 offset:23040
s_waitcnt lgkmcnt(0)
v_mfma_f32_16x16x32_bf16 v[196:199], v[200:203], v[116:119], v[196:199]
s_nop 7
ds_read_b128 v[200:203], v207 offset:26624
s_waitcnt lgkmcnt(0)
v_mfma_f32_16x16x32_bf16 v[196:199], v[200:203], v[120:123], v[196:199]
s_nop 7
ds_read_b128 v[200:203], v207 offset:27136
s_waitcnt lgkmcnt(0)
v_mfma_f32_16x16x32_bf16 v[196:199], v[200:203], v[124:127], v[196:199]
s_nop 7
s_nop 7
v_max_f32 v204, v192, v193
v_max3_f32 v204, v204, v194, v195
v_max3_f32 v204, v204, v196, v197
v_max3_f32 v204, v204, v198, v199
v_mov_b32 v205, v204
s_nop 1
v_permlane32_swap_b32 v204, v205
s_nop 1
v_max_f32 v204, v204, v205
v_mov_b32 v205, v204
s_nop 1
v_permlane16_swap_b32 v204, v205
s_nop 1
v_max_f32 v204, v204, v205
v_add_f32 v204, 40.0, v204
v_ceil_f32 v204, v204
v_max_f32 v204, 0, v204
v_sub_f32 v205, v227, v204
v_cvt_pk_bf16_f32 v205, v205, v205
v_and_b32 v205, 0xffff0000, v205
v_sub_f32 v204, v205, v227
v_mov_b32 v227, v205
v_exp_f32 v239, v204
v_bfi_b32 v99, v206, v205, v99
v_add_f32 v192, v192, v204
v_add_f32 v193, v193, v204
v_add_f32 v194, v194, v204
v_add_f32 v195, v195, v204
v_add_f32 v196, v196, v204
v_add_f32 v197, v197, v204
v_add_f32 v198, v198, v204
v_add_f32 v199, v199, v204
v_add_f32 v140, v140, v204
v_add_f32 v141, v141, v204
v_add_f32 v142, v142, v204
v_add_f32 v143, v143, v204
v_lshlrev_b32 v242, 16, v172
v_and_b32 v248, 0xffff0000, v172
v_mul_f32 v242, v242, v239
v_mul_f32 v248, v248, v239
v_cvt_pk_bf16_f32 v172, v242, v248
v_lshlrev_b32 v242, 16, v173
v_and_b32 v248, 0xffff0000, v173
v_mul_f32 v242, v242, v239
v_mul_f32 v248, v248, v239
v_cvt_pk_bf16_f32 v173, v242, v248
v_lshlrev_b32 v242, 16, v174
v_and_b32 v248, 0xffff0000, v174
v_mul_f32 v242, v242, v239
v_mul_f32 v248, v248, v239
v_cvt_pk_bf16_f32 v174, v242, v248
v_lshlrev_b32 v242, 16, v175
v_and_b32 v248, 0xffff0000, v175
v_mul_f32 v242, v242, v239
v_mul_f32 v248, v248, v239
v_cvt_pk_bf16_f32 v175, v242, v248
v_exp_f32 v232, v192
v_exp_f32 v233, v193
v_exp_f32 v234, v194
v_exp_f32 v235, v195
s_nop 1
v_cvt_pk_bf16_f32 v188, v232, v233
v_cvt_pk_bf16_f32 v189, v234, v235
v_exp_f32 v232, v196
v_exp_f32 v233, v197
v_exp_f32 v234, v198
v_exp_f32 v235, v199
s_nop 1
v_cvt_pk_bf16_f32 v190, v232, v233
v_cvt_pk_bf16_f32 v191, v234, v235
s_branch L2_rare_common
L2_rare_site2:
s_mov_b32 s36, 2
s_branch L2_rare_1
L2_rare_1:
s_nop 15
s_nop 15
s_waitcnt lgkmcnt(0)
v_lshrrev_b32 v206, 8, v243
v_add_u32 v206, 1, v206
v_lshrrev_b32 v206, 2, v206
v_sub_u32 v206, 0, v206
v_and_b32 v206, 0xffff0000, v206
v_add_u32 v207, 0x0, v240
v_and_b32 v207, 0x1ffff, v207
ds_read_b128 v[200:203], v207 offset:12800
s_waitcnt lgkmcnt(0)
v_mfma_f32_16x16x32_bf16 v[192:195], v[200:203], v[0:3], 0
s_nop 7
ds_read_b128 v[200:203], v207 offset:12288
s_waitcnt lgkmcnt(0)
v_mfma_f32_16x16x32_bf16 v[192:195], v[200:203], v[4:7], v[192:195]
s_nop 7
ds_read_b128 v[200:203], v207 offset:0
s_waitcnt lgkmcnt(0)
v_mfma_f32_16x16x32_bf16 v[192:195], v[200:203], v[8:11], v[192:195]
s_nop 7
ds_read_b128 v[200:203], v207 offset:512
s_waitcnt lgkmcnt(0)
v_mfma_f32_16x16x32_bf16 v[192:195], v[200:203], v[12:15], v[192:195]
s_nop 7
ds_read_b128 v[200:203], v207 offset:4096
s_waitcnt lgkmcnt(0)
v_mfma_f32_16x16x32_bf16 v[192:195], v[200:203], v[16:19], v[192:195]
s_nop 7
ds_read_b128 v[200:203], v207 offset:4608
s_waitcnt lgkmcnt(0)
v_mfma_f32_16x16x32_bf16 v[192:195], v[200:203], v[20:23], v[192:195]
s_nop 7
ds_read_b128 v[200:203], v207 offset:8192
s_waitcnt lgkmcnt(0)
v_mfma_f32_16x16x32_bf16 v[192:195], v[200:203], v[24:27], v[192:195]
s_nop 7
ds_read_b128 v[200:203], v207 offset:8704
s_waitcnt lgkmcnt(0)
v_mfma_f32_16x16x32_bf16 v[192:195], v[200:203], v[28:31], v[192:195]
s_nop 7
ds_read_b128 v[200:203], v207 offset:14848
s_waitcnt lgkmcnt(0)
v_mfma_f32_16x16x32_bf16 v[196:199], v[200:203], v[0:3], 0
s_nop 7
ds_read_b128 v[200:203], v207 offset:14336
s_waitcnt lgkmcnt(0)
v_mfma_f32_16x16x32_bf16 v[196:199], v[200:203], v[4:7], v[196:199]
s_nop 7
ds_read_b128 v[200:203], v207 offset:2048
s_waitcnt lgkmcnt(0)
v_mfma_f32_16x16x32_bf16 v[196:199], v[200:203], v[8:11], v[196:199]
s_nop 7
ds_read_b128 v[200:203], v207 offset:2560
s_waitcnt lgkmcnt(0)
v_mfma_f32_16x16x32_bf16 v[196:199], v[200:203], v[12:15], v[196:199]
s_nop 7
ds_read_b128 v[200:203], v207 offset:6144
s_waitcnt lgkmcnt(0)
v_mfma_f32_16x16x32_bf16 v[196:199], v[200:203], v[16:19], v[196:199]
s_nop 7
ds_read_b128 v[200:203], v207 offset:6656
s_waitcnt lgkmcnt(0)
v_mfma_f32_16x16x32_bf16 v[196:199], v[200:203], v[20:23], v[196:199]
s_nop 7
ds_read_b128 v[200:203], v207 offset:10240
s_waitcnt lgkmcnt(0)
v_mfma_f32_16x16x32_bf16 v[196:199], v[200:203], v[24:27], v[196:199]
s_nop 7
ds_read_b128 v[200:203], v207 offset:10752
s_waitcnt lgkmcnt(0)
v_mfma_f32_16x16x32_bf16 v[196:199], v[200:203], v[28:31], v[196:199]
s_nop 7
s_nop 7
v_max_f32 v204, v192, v193
v_max3_f32 v204, v204, v194, v195
v_max3_f32 v204, v204, v196, v197
v_max3_f32 v204, v204, v198, v199
v_mov_b32 v205, v204
s_nop 1
v_permlane32_swap_b32 v204, v205
s_nop 1
v_max_f32 v204, v204, v205
v_mov_b32 v205, v204
s_nop 1
v_permlane16_swap_b32 v204, v205
s_nop 1
v_max_f32 v204, v204, v205
v_add_f32 v204, 40.0, v204
v_ceil_f32 v204, v204
v_max_f32 v204, 0, v204
v_sub_f32 v205, v224, v204
v_cvt_pk_bf16_f32 v205, v205, v205
v_and_b32 v205, 0xffff0000, v205
v_sub_f32 v204, v205, v224
v_mov_b32 v224, v205
v_exp_f32 v236, v204
v_bfi_b32 v3, v206, v205, v3
v_add_f32 v192, v192, v204
v_add_f32 v193, v193, v204
v_add_f32 v194, v194, v204
v_add_f32 v195, v195, v204
v_add_f32 v196, v196, v204
v_add_f32 v197, v197, v204
v_add_f32 v198, v198, v204
v_add_f32 v199, v199, v204
v_add_f32 v128, v128, v204
v_add_f32 v129, v129, v204
v_add_f32 v130, v130, v204
v_add_f32 v131, v131, v204
v_lshlrev_b32 v242, 16, v176
v_and_b32 v248, 0xffff0000, v176
v_mul_f32 v242, v242, v236
v_mul_f32 v248, v248, v236
v_cvt_pk_bf16_f32 v176, v242, v248
v_lshlrev_b32 v242, 16, v177
v_and_b32 v248, 0xffff0000, v177
v_mul_f32 v242, v242, v236
v_mul_f32 v248, v248, v236
v_cvt_pk_bf16_f32 v177, v242, v248
v_lshlrev_b32 v242, 16, v178
v_and_b32 v248, 0xffff0000, v178
v_mul_f32 v242, v242, v236
v_mul_f32 v248, v248, v236
v_cvt_pk_bf16_f32 v178, v242, v248
v_lshlrev_b32 v242, 16, v179
v_and_b32 v248, 0xffff0000, v179
v_mul_f32 v242, v242, v236
v_mul_f32 v248, v248, v236
v_cvt_pk_bf16_f32 v179, v242, v248
v_exp_f32 v232, v192
v_exp_f32 v233, v193
v_exp_f32 v234, v194
v_exp_f32 v235, v195
s_nop 1
v_cvt_pk_bf16_f32 v160, v232, v233
v_cvt_pk_bf16_f32 v161, v234, v235
v_exp_f32 v232, v196
v_exp_f32 v233, v197
v_exp_f32 v234, v198
v_exp_f32 v235, v199
s_nop 1
v_cvt_pk_bf16_f32 v162, v232, v233
v_cvt_pk_bf16_f32 v163, v234, v235
ds_read_b128 v[200:203], v207 offset:12800
s_waitcnt lgkmcnt(0)
v_mfma_f32_16x16x32_bf16 v[192:195], v[200:203], v[32:35], 0
s_nop 7
ds_read_b128 v[200:203], v207 offset:12288
s_waitcnt lgkmcnt(0)
v_mfma_f32_16x16x32_bf16 v[192:195], v[200:203], v[36:39], v[192:195]
s_nop 7
ds_read_b128 v[200:203], v207 offset:0
s_waitcnt lgkmcnt(0)
v_mfma_f32_16x16x32_bf16 v[192:195], v[200:203], v[40:43], v[192:195]
s_nop 7
ds_read_b128 v[200:203], v207 offset:512
s_waitcnt lgkmcnt(0)
v_mfma_f32_16x16x32_bf16 v[192:195], v[200:203], v[44:47], v[192:195]
s_nop 7
ds_read_b128 v[200:203], v207 offset:4096
s_waitcnt lgkmcnt(0)
v_mfma_f32_16x16x32_bf16 v[192:195], v[200:203], v[48:51], v[192:195]
s_nop 7
ds_read_b128 v[200:203], v207 offset:4608
s_waitcnt lgkmcnt(0)
v_mfma_f32_16x16x32_bf16 v[192:195], v[200:203], v[52:55], v[192:195]
s_nop 7
ds_read_b128 v[200:203], v207 offset:8192
s_waitcnt lgkmcnt(0)
v_mfma_f32_16x16x32_bf16 v[192:195], v[200:203], v[56:59], v[192:195]
s_nop 7
ds_read_b128 v[200:203], v207 offset:8704
s_waitcnt lgkmcnt(0)
v_mfma_f32_16x16x32_bf16 v[192:195], v[200:203], v[60:63], v[192:195]
s_nop 7
ds_read_b128 v[200:203], v207 offset:14848
s_waitcnt lgkmcnt(0)
v_mfma_f32_16x16x32_bf16 v[196:199], v[200:203], v[32:35], 0
s_nop 7
ds_read_b128 v[200:203], v207 offset:14336
s_waitcnt lgkmcnt(0)
v_mfma_f32_16x16x32_bf16 v[196:199], v[200:203], v[36:39], v[196:199]
s_nop 7
ds_read_b128 v[200:203], v207 offset:2048
s_waitcnt lgkmcnt(0)
v_mfma_f32_16x16x32_bf16 v[196:199], v[200:203], v[40:43], v[196:199]
s_nop 7
ds_read_b128 v[200:203], v207 offset:2560
s_waitcnt lgkmcnt(0)
v_mfma_f32_16x16x32_bf16 v[196:199], v[200:203], v[44:47], v[196:199]
s_nop 7
ds_read_b128 v[200:203], v207 offset:6144
s_waitcnt lgkmcnt(0)
v_mfma_f32_16x16x32_bf16 v[196:199], v[200:203], v[48:51], v[196:199]
s_nop 7
ds_read_b128 v[200:203], v207 offset:6656
s_waitcnt lgkmcnt(0)
v_mfma_f32_16x16x32_bf16 v[196:199], v[200:203], v[52:55], v[196:199]
s_nop 7
ds_read_b128 v[200:203], v207 offset:10240
s_waitcnt lgkmcnt(0)
v_mfma_f32_16x16x32_bf16 v[196:199], v[200:203], v[56:59], v[196:199]
s_nop 7
ds_read_b128 v[200:203], v207 offset:10752
s_waitcnt lgkmcnt(0)
v_mfma_f32_16x16x32_bf16 v[196:199], v[200:203], v[60:63], v[196:199]
s_nop 7
s_nop 7
v_max_f32 v204, v192, v193
v_max3_f32 v204, v204, v194, v195
v_max3_f32 v204, v204, v196, v197
v_max3_f32 v204, v204, v198, v199
v_mov_b32 v205, v204
s_nop 1
v_permlane32_swap_b32 v204, v205
s_nop 1
v_max_f32 v204, v204, v205
v_mov_b32 v205, v204
s_nop 1
v_permlane16_swap_b32 v204, v205
s_nop 1
v_max_f32 v204, v204, v205
v_add_f32 v204, 40.0, v204
v_ceil_f32 v204, v204
v_max_f32 v204, 0, v204
v_sub_f32 v205, v225, v204
v_cvt_pk_bf16_f32 v205, v205, v205
v_and_b32 v205, 0xffff0000, v205
v_sub_f32 v204, v205, v225
v_mov_b32 v225, v205
v_exp_f32 v237, v204
v_bfi_b32 v35, v206, v205, v35
v_add_f32 v192, v192, v204
v_add_f32 v193, v193, v204
v_add_f32 v194, v194, v204
v_add_f32 v195, v195, v204
v_add_f32 v196, v196, v204
v_add_f32 v197, v197, v204
v_add_f32 v198, v198, v204
v_add_f32 v199, v199, v204
v_add_f32 v132, v132, v204
v_add_f32 v133, v133, v204
v_add_f32 v134, v134, v204
v_add_f32 v135, v135, v204
v_lshlrev_b32 v242, 16, v180
v_and_b32 v248, 0xffff0000, v180
v_mul_f32 v242, v242, v237
v_mul_f32 v248, v248, v237
v_cvt_pk_bf16_f32 v180, v242, v248
v_lshlrev_b32 v242, 16, v181
v_and_b32 v248, 0xffff0000, v181
v_mul_f32 v242, v242, v237
v_mul_f32 v248, v248, v237
v_cvt_pk_bf16_f32 v181, v242, v248
v_lshlrev_b32 v242, 16, v182
v_and_b32 v248, 0xffff0000, v182
v_mul_f32 v242, v242, v237
v_mul_f32 v248, v248, v237
v_cvt_pk_bf16_f32 v182, v242, v248
v_lshlrev_b32 v242, 16, v183
v_and_b32 v248, 0xffff0000, v183
v_mul_f32 v242, v242, v237
v_mul_f32 v248, v248, v237
v_cvt_pk_bf16_f32 v183, v242, v248
v_exp_f32 v232, v192
v_exp_f32 v233, v193
v_exp_f32 v234, v194
v_exp_f32 v235, v195
s_nop 1
v_cvt_pk_bf16_f32 v164, v232, v233
v_cvt_pk_bf16_f32 v165, v234, v235
v_exp_f32 v232, v196
v_exp_f32 v233, v197
v_exp_f32 v234, v198
v_exp_f32 v235, v199
s_nop 1
v_cvt_pk_bf16_f32 v166, v232, v233
v_cvt_pk_bf16_f32 v167, v234, v235
ds_read_b128 v[200:203], v207 offset:12800
s_waitcnt lgkmcnt(0)
v_mfma_f32_16x16x32_bf16 v[192:195], v[200:203], v[64:67], 0
s_nop 7
ds_read_b128 v[200:203], v207 offset:12288
s_waitcnt lgkmcnt(0)
v_mfma_f32_16x16x32_bf16 v[192:195], v[200:203], v[68:71], v[192:195]
s_nop 7
ds_read_b128 v[200:203], v207 offset:0
s_waitcnt lgkmcnt(0)
v_mfma_f32_16x16x32_bf16 v[192:195], v[200:203], v[72:75], v[192:195]
s_nop 7
ds_read_b128 v[200:203], v207 offset:512
s_waitcnt lgkmcnt(0)
v_mfma_f32_16x16x32_bf16 v[192:195], v[200:203], v[76:79], v[192:195]
s_nop 7
ds_read_b128 v[200:203], v207 offset:4096
s_waitcnt lgkmcnt(0)
v_mfma_f32_16x16x32_bf16 v[192:195], v[200:203], v[80:83], v[192:195]
s_nop 7
ds_read_b128 v[200:203], v207 offset:4608
s_waitcnt lgkmcnt(0)
v_mfma_f32_16x16x32_bf16 v[192:195], v[200:203], v[84:87], v[192:195]
s_nop 7
ds_read_b128 v[200:203], v207 offset:8192
s_waitcnt lgkmcnt(0)
v_mfma_f32_16x16x32_bf16 v[192:195], v[200:203], v[88:91], v[192:195]
s_nop 7
ds_read_b128 v[200:203], v207 offset:8704
s_waitcnt lgkmcnt(0)
v_mfma_f32_16x16x32_bf16 v[192:195], v[200:203], v[92:95], v[192:195]
s_nop 7
ds_read_b128 v[200:203], v207 offset:14848
s_waitcnt lgkmcnt(0)
v_mfma_f32_16x16x32_bf16 v[196:199], v[200:203], v[64:67], 0
s_nop 7
ds_read_b128 v[200:203], v207 offset:14336
s_waitcnt lgkmcnt(0)
v_mfma_f32_16x16x32_bf16 v[196:199], v[200:203], v[68:71], v[196:199]
s_nop 7
ds_read_b128 v[200:203], v207 offset:2048
s_waitcnt lgkmcnt(0)
v_mfma_f32_16x16x32_bf16 v[196:199], v[200:203], v[72:75], v[196:199]
s_nop 7
ds_read_b128 v[200:203], v207 offset:2560
s_waitcnt lgkmcnt(0)
v_mfma_f32_16x16x32_bf16 v[196:199], v[200:203], v[76:79], v[196:199]
s_nop 7
ds_read_b128 v[200:203], v207 offset:6144
s_waitcnt lgkmcnt(0)
v_mfma_f32_16x16x32_bf16 v[196:199], v[200:203], v[80:83], v[196:199]
s_nop 7
ds_read_b128 v[200:203], v207 offset:6656
s_waitcnt lgkmcnt(0)
v_mfma_f32_16x16x32_bf16 v[196:199], v[200:203], v[84:87], v[196:199]
s_nop 7
ds_read_b128 v[200:203], v207 offset:10240
s_waitcnt lgkmcnt(0)
v_mfma_f32_16x16x32_bf16 v[196:199], v[200:203], v[88:91], v[196:199]
s_nop 7
ds_read_b128 v[200:203], v207 offset:10752
s_waitcnt lgkmcnt(0)
v_mfma_f32_16x16x32_bf16 v[196:199], v[200:203], v[92:95], v[196:199]
s_nop 7
s_nop 7
v_max_f32 v204, v192, v193
v_max3_f32 v204, v204, v194, v195
v_max3_f32 v204, v204, v196, v197
v_max3_f32 v204, v204, v198, v199
v_mov_b32 v205, v204
s_nop 1
v_permlane32_swap_b32 v204, v205
s_nop 1
v_max_f32 v204, v204, v205
v_mov_b32 v205, v204
s_nop 1
v_permlane16_swap_b32 v204, v205
s_nop 1
v_max_f32 v204, v204, v205
v_add_f32 v204, 40.0, v204
v_ceil_f32 v204, v204
v_max_f32 v204, 0, v204
v_sub_f32 v205, v226, v204
v_cvt_pk_bf16_f32 v205, v205, v205
v_and_b32 v205, 0xffff0000, v205
v_sub_f32 v204, v205, v226
v_mov_b32 v226, v205
v_exp_f32 v238, v204
v_bfi_b32 v67, v206, v205, v67
v_add_f32 v192, v192, v204
v_add_f32 v193, v193, v204
v_add_f32 v194, v194, v204
v_add_f32 v195, v195, v204
v_add_f32 v196, v196, v204
v_add_f32 v197, v197, v204
v_add_f32 v198, v198, v204
v_add_f32 v199, v199, v204
v_add_f32 v136, v136, v204
v_add_f32 v137, v137, v204
v_add_f32 v138, v138, v204
v_add_f32 v139, v139, v204
v_lshlrev_b32 v242, 16, v184
v_and_b32 v248, 0xffff0000, v184
v_mul_f32 v242, v242, v238
v_mul_f32 v248, v248, v238
v_cvt_pk_bf16_f32 v184, v242, v248
v_lshlrev_b32 v242, 16, v185
v_and_b32 v248, 0xffff0000, v185
v_mul_f32 v242, v242, v238
v_mul_f32 v248, v248, v238
v_cvt_pk_bf16_f32 v185, v242, v248
v_lshlrev_b32 v242, 16, v186
v_and_b32 v248, 0xffff0000, v186
v_mul_f32 v242, v242, v238
v_mul_f32 v248, v248, v238
v_cvt_pk_bf16_f32 v186, v242, v248
v_lshlrev_b32 v242, 16, v187
v_and_b32 v248, 0xffff0000, v187
v_mul_f32 v242, v242, v238
v_mul_f32 v248, v248, v238
v_cvt_pk_bf16_f32 v187, v242, v248
v_exp_f32 v232, v192
v_exp_f32 v233, v193
v_exp_f32 v234, v194
v_exp_f32 v235, v195
s_nop 1
v_cvt_pk_bf16_f32 v168, v232, v233
v_cvt_pk_bf16_f32 v169, v234, v235
v_exp_f32 v232, v196
v_exp_f32 v233, v197
v_exp_f32 v234, v198
v_exp_f32 v235, v199
s_nop 1
v_cvt_pk_bf16_f32 v170, v232, v233
v_cvt_pk_bf16_f32 v171, v234, v235
ds_read_b128 v[200:203], v207 offset:12800
s_waitcnt lgkmcnt(0)
v_mfma_f32_16x16x32_bf16 v[192:195], v[200:203], v[96:99], 0
s_nop 7
ds_read_b128 v[200:203], v207 offset:12288
s_waitcnt lgkmcnt(0)
v_mfma_f32_16x16x32_bf16 v[192:195], v[200:203], v[100:103], v[192:195]
s_nop 7
ds_read_b128 v[200:203], v207 offset:0
s_waitcnt lgkmcnt(0)
v_mfma_f32_16x16x32_bf16 v[192:195], v[200:203], v[104:107], v[192:195]
s_nop 7
ds_read_b128 v[200:203], v207 offset:512
s_waitcnt lgkmcnt(0)
v_mfma_f32_16x16x32_bf16 v[192:195], v[200:203], v[108:111], v[192:195]
s_nop 7
ds_read_b128 v[200:203], v207 offset:4096
s_waitcnt lgkmcnt(0)
v_mfma_f32_16x16x32_bf16 v[192:195], v[200:203], v[112:115], v[192:195]
s_nop 7
ds_read_b128 v[200:203], v207 offset:4608
s_waitcnt lgkmcnt(0)
v_mfma_f32_16x16x32_bf16 v[192:195], v[200:203], v[116:119], v[192:195]
s_nop 7
ds_read_b128 v[200:203], v207 offset:8192
s_waitcnt lgkmcnt(0)
v_mfma_f32_16x16x32_bf16 v[192:195], v[200:203], v[120:123], v[192:195]
s_nop 7
ds_read_b128 v[200:203], v207 offset:8704
s_waitcnt lgkmcnt(0)
v_mfma_f32_16x16x32_bf16 v[192:195], v[200:203], v[124:127], v[192:195]
s_nop 7
ds_read_b128 v[200:203], v207 offset:14848
s_waitcnt lgkmcnt(0)
v_mfma_f32_16x16x32_bf16 v[196:199], v[200:203], v[96:99], 0
s_nop 7
ds_read_b128 v[200:203], v207 offset:14336
s_waitcnt lgkmcnt(0)
v_mfma_f32_16x16x32_bf16 v[196:199], v[200:203], v[100:103], v[196:199]
s_nop 7
ds_read_b128 v[200:203], v207 offset:2048
s_waitcnt lgkmcnt(0)
v_mfma_f32_16x16x32_bf16 v[196:199], v[200:203], v[104:107], v[196:199]
s_nop 7
ds_read_b128 v[200:203], v207 offset:2560
s_waitcnt lgkmcnt(0)
v_mfma_f32_16x16x32_bf16 v[196:199], v[200:203], v[108:111], v[196:199]
s_nop 7
ds_read_b128 v[200:203], v207 offset:6144
s_waitcnt lgkmcnt(0)
v_mfma_f32_16x16x32_bf16 v[196:199], v[200:203], v[112:115], v[196:199]
s_nop 7
ds_read_b128 v[200:203], v207 offset:6656
s_waitcnt lgkmcnt(0)
v_mfma_f32_16x16x32_bf16 v[196:199], v[200:203], v[116:119], v[196:199]
s_nop 7
ds_read_b128 v[200:203], v207 offset:10240
s_waitcnt lgkmcnt(0)
v_mfma_f32_16x16x32_bf16 v[196:199], v[200:203], v[120:123], v[196:199]
s_nop 7
ds_read_b128 v[200:203], v207 offset:10752
s_waitcnt lgkmcnt(0)
v_mfma_f32_16x16x32_bf16 v[196:199], v[200:203], v[124:127], v[196:199]
s_nop 7
s_nop 7
v_max_f32 v204, v192, v193
v_max3_f32 v204, v204, v194, v195
v_max3_f32 v204, v204, v196, v197
v_max3_f32 v204, v204, v198, v199
v_mov_b32 v205, v204
s_nop 1
v_permlane32_swap_b32 v204, v205
s_nop 1
v_max_f32 v204, v204, v205
v_mov_b32 v205, v204
s_nop 1
v_permlane16_swap_b32 v204, v205
s_nop 1
v_max_f32 v204, v204, v205
v_add_f32 v204, 40.0, v204
v_ceil_f32 v204, v204
v_max_f32 v204, 0, v204
v_sub_f32 v205, v227, v204
v_cvt_pk_bf16_f32 v205, v205, v205
v_and_b32 v205, 0xffff0000, v205
v_sub_f32 v204, v205, v227
v_mov_b32 v227, v205
v_exp_f32 v239, v204
v_bfi_b32 v99, v206, v205, v99
v_add_f32 v192, v192, v204
v_add_f32 v193, v193, v204
v_add_f32 v194, v194, v204
v_add_f32 v195, v195, v204
v_add_f32 v196, v196, v204
v_add_f32 v197, v197, v204
v_add_f32 v198, v198, v204
v_add_f32 v199, v199, v204
v_add_f32 v140, v140, v204
v_add_f32 v141, v141, v204
v_add_f32 v142, v142, v204
v_add_f32 v143, v143, v204
v_lshlrev_b32 v242, 16, v188
v_and_b32 v248, 0xffff0000, v188
v_mul_f32 v242, v242, v239
v_mul_f32 v248, v248, v239
v_cvt_pk_bf16_f32 v188, v242, v248
v_lshlrev_b32 v242, 16, v189
v_and_b32 v248, 0xffff0000, v189
v_mul_f32 v242, v242, v239
v_mul_f32 v248, v248, v239
v_cvt_pk_bf16_f32 v189, v242, v248
v_lshlrev_b32 v242, 16, v190
v_and_b32 v248, 0xffff0000, v190
v_mul_f32 v242, v242, v239
v_mul_f32 v248, v248, v239
v_cvt_pk_bf16_f32 v190, v242, v248
v_lshlrev_b32 v242, 16, v191
v_and_b32 v248, 0xffff0000, v191
v_mul_f32 v242, v242, v239
v_mul_f32 v248, v248, v239
v_cvt_pk_bf16_f32 v191, v242, v248
v_exp_f32 v232, v192
v_exp_f32 v233, v193
v_exp_f32 v234, v194
v_exp_f32 v235, v195
s_nop 1
v_cvt_pk_bf16_f32 v172, v232, v233
v_cvt_pk_bf16_f32 v173, v234, v235
v_exp_f32 v232, v196
v_exp_f32 v233, v197
v_exp_f32 v234, v198
v_exp_f32 v235, v199
s_nop 1
v_cvt_pk_bf16_f32 v174, v232, v233
v_cvt_pk_bf16_f32 v175, v234, v235
s_branch L2_rare_common
L2_rare_site6:
s_mov_b32 s36, 6
s_branch L2_rare_t1_0
L2_rare_t1_0:
s_nop 15
s_nop 15
s_waitcnt lgkmcnt(0)
v_lshrrev_b32 v206, 8, v243
v_add_u32 v206, 1, v206
v_lshrrev_b32 v206, 2, v206
v_sub_u32 v206, 0, v206
v_and_b32 v206, 0xffff0000, v206
v_max_f32 v204, v128, v129
v_max3_f32 v204, v204, v130, v131
v_mov_b32 v205, v204
s_nop 1
v_permlane32_swap_b32 v204, v205
s_nop 1
v_max_f32 v204, v204, v205
v_mov_b32 v205, v204
s_nop 1
v_permlane16_swap_b32 v204, v205
s_nop 1
v_max_f32 v204, v204, v205
v_add_f32 v204, 40.0, v204
v_ceil_f32 v204, v204
v_max_f32 v204, 0, v204
v_sub_f32 v205, v224, v204
v_cvt_pk_bf16_f32 v205, v205, v205
v_and_b32 v205, 0xffff0000, v205
v_sub_f32 v204, v205, v224
v_mov_b32 v224, v205
v_exp_f32 v236, v204
v_bfi_b32 v3, v206, v205, v3
v_add_f32 v128, v128, v204
v_add_f32 v129, v129, v204
v_add_f32 v130, v130, v204
v_add_f32 v131, v131, v204
v_add_f32 v144, v144, v204
v_add_f32 v145, v145, v204
v_add_f32 v146, v146, v204
v_add_f32 v147, v147, v204
v_lshlrev_b32 v242, 16, v160
v_and_b32 v248, 0xffff0000, v160
v_mul_f32 v242, v242, v236
v_mul_f32 v248, v248, v236
v_cvt_pk_bf16_f32 v160, v242, v248
v_lshlrev_b32 v242, 16, v161
v_and_b32 v248, 0xffff0000, v161
v_mul_f32 v242, v242, v236
v_mul_f32 v248, v248, v236
v_cvt_pk_bf16_f32 v161, v242, v248
v_lshlrev_b32 v242, 16, v162
v_and_b32 v248, 0xffff0000, v162
v_mul_f32 v242, v242, v236
v_mul_f32 v248, v248, v236
v_cvt_pk_bf16_f32 v162, v242, v248
v_lshlrev_b32 v242, 16, v163
v_and_b32 v248, 0xffff0000, v163
v_mul_f32 v242, v242, v236
v_mul_f32 v248, v248, v236
v_cvt_pk_bf16_f32 v163, v242, v248
ds_read_b64 v[250:251], v231 offset:0
s_waitcnt lgkmcnt(0)
v_lshlrev_b32 v242, 16, v250
v_and_b32 v248, 0xffff0000, v250
v_mul_f32 v242, v242, v236
v_mul_f32 v248, v248, v236
v_cvt_pk_bf16_f32 v250, v242, v248
v_lshlrev_b32 v242, 16, v251
v_and_b32 v248, 0xffff0000, v251
v_mul_f32 v242, v242, v236
v_mul_f32 v248, v248, v236
v_cvt_pk_bf16_f32 v251, v242, v248
ds_write_b64 v231, v[250:251] offset:0
s_waitcnt lgkmcnt(0)
ds_read_b64 v[250:251], v231 offset:8
s_waitcnt lgkmcnt(0)
v_lshlrev_b32 v242, 16, v250
v_and_b32 v248, 0xffff0000, v250
v_mul_f32 v242, v242, v236
v_mul_f32 v248, v248, v236
v_cvt_pk_bf16_f32 v250, v242, v248
v_lshlrev_b32 v242, 16, v251
v_and_b32 v248, 0xffff0000, v251
v_mul_f32 v242, v242, v236
v_mul_f32 v248, v248, v236
v_cvt_pk_bf16_f32 v251, v242, v248
ds_write_b64 v231, v[250:251] offset:8
s_waitcnt lgkmcnt(0)
v_exp_f32 v232, v128
v_exp_f32 v233, v129
v_exp_f32 v234, v130
v_exp_f32 v235, v131
s_nop 1
v_cvt_pk_bf16_f32 v176, v232, v233
v_cvt_pk_bf16_f32 v177, v234, v235
v_max_f32 v204, v132, v133
v_max3_f32 v204, v204, v134, v135
v_mov_b32 v205, v204
s_nop 1
v_permlane32_swap_b32 v204, v205
s_nop 1
v_max_f32 v204, v204, v205
v_mov_b32 v205, v204
s_nop 1
v_permlane16_swap_b32 v204, v205
s_nop 1
v_max_f32 v204, v204, v205
v_add_f32 v204, 40.0, v204
v_ceil_f32 v204, v204
v_max_f32 v204, 0, v204
v_sub_f32 v205, v225, v204
v_cvt_pk_bf16_f32 v205, v205, v205
v_and_b32 v205, 0xffff0000, v205
v_sub_f32 v204, v205, v225
v_mov_b32 v225, v205
v_exp_f32 v237, v204
v_bfi_b32 v35, v206, v205, v35
v_add_f32 v132, v132, v204
v_add_f32 v133, v133, v204
v_add_f32 v134, v134, v204
v_add_f32 v135, v135, v204
v_add_f32 v148, v148, v204
v_add_f32 v149, v149, v204
v_add_f32 v150, v150, v204
v_add_f32 v151, v151, v204
v_lshlrev_b32 v242, 16, v164
v_and_b32 v248, 0xffff0000, v164
v_mul_f32 v242, v242, v237
v_mul_f32 v248, v248, v237
v_cvt_pk_bf16_f32 v164, v242, v248
v_lshlrev_b32 v242, 16, v165
v_and_b32 v248, 0xffff0000, v165
v_mul_f32 v242, v242, v237
v_mul_f32 v248, v248, v237
v_cvt_pk_bf16_f32 v165, v242, v248
v_lshlrev_b32 v242, 16, v166
v_and_b32 v248, 0xffff0000, v166
v_mul_f32 v242, v242, v237
v_mul_f32 v248, v248, v237
v_cvt_pk_bf16_f32 v166, v242, v248
v_lshlrev_b32 v242, 16, v167
v_and_b32 v248, 0xffff0000, v167
v_mul_f32 v242, v242, v237
v_mul_f32 v248, v248, v237
v_cvt_pk_bf16_f32 v167, v242, v248
ds_read_b64 v[250:251], v231 offset:1024
s_waitcnt lgkmcnt(0)
v_lshlrev_b32 v242, 16, v250
v_and_b32 v248, 0xffff0000, v250
v_mul_f32 v242, v242, v237
v_mul_f32 v248, v248, v237
v_cvt_pk_bf16_f32 v250, v242, v248
v_lshlrev_b32 v242, 16, v251
v_and_b32 v248, 0xffff0000, v251
v_mul_f32 v242, v242, v237
v_mul_f32 v248, v248, v237
v_cvt_pk_bf16_f32 v251, v242, v248
ds_write_b64 v231, v[250:251] offset:1024
s_waitcnt lgkmcnt(0)
ds_read_b64 v[250:251], v231 offset:1032
s_waitcnt lgkmcnt(0)
v_lshlrev_b32 v242, 16, v250
v_and_b32 v248, 0xffff0000, v250
v_mul_f32 v242, v242, v237
v_mul_f32 v248, v248, v237
v_cvt_pk_bf16_f32 v250, v242, v248
v_lshlrev_b32 v242, 16, v251
v_and_b32 v248, 0xffff0000, v251
v_mul_f32 v242, v242, v237
v_mul_f32 v248, v248, v237
v_cvt_pk_bf16_f32 v251, v242, v248
ds_write_b64 v231, v[250:251] offset:1032
s_waitcnt lgkmcnt(0)
v_exp_f32 v232, v132
v_exp_f32 v233, v133
v_exp_f32 v234, v134
v_exp_f32 v235, v135
s_nop 1
v_cvt_pk_bf16_f32 v180, v232, v233
v_cvt_pk_bf16_f32 v181, v234, v235
v_max_f32 v204, v136, v137
v_max3_f32 v204, v204, v138, v139
v_mov_b32 v205, v204
s_nop 1
v_permlane32_swap_b32 v204, v205
s_nop 1
v_max_f32 v204, v204, v205
v_mov_b32 v205, v204
s_nop 1
v_permlane16_swap_b32 v204, v205
s_nop 1
v_max_f32 v204, v204, v205
v_add_f32 v204, 40.0, v204
v_ceil_f32 v204, v204
v_max_f32 v204, 0, v204
v_sub_f32 v205, v226, v204
v_cvt_pk_bf16_f32 v205, v205, v205
v_and_b32 v205, 0xffff0000, v205
v_sub_f32 v204, v205, v226
v_mov_b32 v226, v205
v_exp_f32 v238, v204
v_bfi_b32 v67, v206, v205, v67
v_add_f32 v136, v136, v204
v_add_f32 v137, v137, v204
v_add_f32 v138, v138, v204
v_add_f32 v139, v139, v204
v_add_f32 v152, v152, v204
v_add_f32 v153, v153, v204
v_add_f32 v154, v154, v204
v_add_f32 v155, v155, v204
v_lshlrev_b32 v242, 16, v168
v_and_b32 v248, 0xffff0000, v168
v_mul_f32 v242, v242, v238
v_mul_f32 v248, v248, v238
v_cvt_pk_bf16_f32 v168, v242, v248
v_lshlrev_b32 v242, 16, v169
v_and_b32 v248, 0xffff0000, v169
v_mul_f32 v242, v242, v238
v_mul_f32 v248, v248, v238
v_cvt_pk_bf16_f32 v169, v242, v248
v_lshlrev_b32 v242, 16, v170
v_and_b32 v248, 0xffff0000, v170
v_mul_f32 v242, v242, v238
v_mul_f32 v248, v248, v238
v_cvt_pk_bf16_f32 v170, v242, v248
v_lshlrev_b32 v242, 16, v171
v_and_b32 v248, 0xffff0000, v171
v_mul_f32 v242, v242, v238
v_mul_f32 v248, v248, v238
v_cvt_pk_bf16_f32 v171, v242, v248
ds_read_b64 v[250:251], v231 offset:2048
s_waitcnt lgkmcnt(0)
v_lshlrev_b32 v242, 16, v250
v_and_b32 v248, 0xffff0000, v250
v_mul_f32 v242, v242, v238
v_mul_f32 v248, v248, v238
v_cvt_pk_bf16_f32 v250, v242, v248
v_lshlrev_b32 v242, 16, v251
v_and_b32 v248, 0xffff0000, v251
v_mul_f32 v242, v242, v238
v_mul_f32 v248, v248, v238
v_cvt_pk_bf16_f32 v251, v242, v248
ds_write_b64 v231, v[250:251] offset:2048
s_waitcnt lgkmcnt(0)
ds_read_b64 v[250:251], v231 offset:2056
s_waitcnt lgkmcnt(0)
v_lshlrev_b32 v242, 16, v250
v_and_b32 v248, 0xffff0000, v250
v_mul_f32 v242, v242, v238
v_mul_f32 v248, v248, v238
v_cvt_pk_bf16_f32 v250, v242, v248
v_lshlrev_b32 v242, 16, v251
v_and_b32 v248, 0xffff0000, v251
v_mul_f32 v242, v242, v238
v_mul_f32 v248, v248, v238
v_cvt_pk_bf16_f32 v251, v242, v248
ds_write_b64 v231, v[250:251] offset:2056
s_waitcnt lgkmcnt(0)
v_exp_f32 v232, v136
v_exp_f32 v233, v137
v_exp_f32 v234, v138
v_exp_f32 v235, v139
s_nop 1
v_cvt_pk_bf16_f32 v184, v232, v233
v_cvt_pk_bf16_f32 v185, v234, v235
v_max_f32 v204, v140, v141
v_max3_f32 v204, v204, v142, v143
v_mov_b32 v205, v204
s_nop 1
v_permlane32_swap_b32 v204, v205
s_nop 1
v_max_f32 v204, v204, v205
v_mov_b32 v205, v204
s_nop 1
v_permlane16_swap_b32 v204, v205
s_nop 1
v_max_f32 v204, v204, v205
v_add_f32 v204, 40.0, v204
v_ceil_f32 v204, v204
v_max_f32 v204, 0, v204
v_sub_f32 v205, v227, v204
v_cvt_pk_bf16_f32 v205, v205, v205
v_and_b32 v205, 0xffff0000, v205
v_sub_f32 v204, v205, v227
v_mov_b32 v227, v205
v_exp_f32 v239, v204
v_bfi_b32 v99, v206, v205, v99
v_add_f32 v140, v140, v204
v_add_f32 v141, v141, v204
v_add_f32 v142, v142, v204
v_add_f32 v143, v143, v204
v_add_f32 v156, v156, v204
v_add_f32 v157, v157, v204
v_add_f32 v158, v158, v204
v_add_f32 v159, v159, v204
v_lshlrev_b32 v242, 16, v172
v_and_b32 v248, 0xffff0000, v172
v_mul_f32 v242, v242, v239
v_mul_f32 v248, v248, v239
v_cvt_pk_bf16_f32 v172, v242, v248
v_lshlrev_b32 v242, 16, v173
v_and_b32 v248, 0xffff0000, v173
v_mul_f32 v242, v242, v239
v_mul_f32 v248, v248, v239
v_cvt_pk_bf16_f32 v173, v242, v248
v_lshlrev_b32 v242, 16, v174
v_and_b32 v248, 0xffff0000, v174
v_mul_f32 v242, v242, v239
v_mul_f32 v248, v248, v239
v_cvt_pk_bf16_f32 v174, v242, v248
v_lshlrev_b32 v242, 16, v175
v_and_b32 v248, 0xffff0000, v175
v_mul_f32 v242, v242, v239
v_mul_f32 v248, v248, v239
v_cvt_pk_bf16_f32 v175, v242, v248
ds_read_b64 v[250:251], v231 offset:3072
s_waitcnt lgkmcnt(0)
v_lshlrev_b32 v242, 16, v250
v_and_b32 v248, 0xffff0000, v250
v_mul_f32 v242, v242, v239
v_mul_f32 v248, v248, v239
v_cvt_pk_bf16_f32 v250, v242, v248
v_lshlrev_b32 v242, 16, v251
v_and_b32 v248, 0xffff0000, v251
v_mul_f32 v242, v242, v239
v_mul_f32 v248, v248, v239
v_cvt_pk_bf16_f32 v251, v242, v248
ds_write_b64 v231, v[250:251] offset:3072
s_waitcnt lgkmcnt(0)
ds_read_b64 v[250:251], v231 offset:3080
s_waitcnt lgkmcnt(0)
v_lshlrev_b32 v242, 16, v250
v_and_b32 v248, 0xffff0000, v250
v_mul_f32 v242, v242, v239
v_mul_f32 v248, v248, v239
v_cvt_pk_bf16_f32 v250, v242, v248
v_lshlrev_b32 v242, 16, v251
v_and_b32 v248, 0xffff0000, v251
v_mul_f32 v242, v242, v239
v_mul_f32 v248, v248, v239
v_cvt_pk_bf16_f32 v251, v242, v248
ds_write_b64 v231, v[250:251] offset:3080
s_waitcnt lgkmcnt(0)
v_exp_f32 v232, v140
v_exp_f32 v233, v141
v_exp_f32 v234, v142
v_exp_f32 v235, v143
s_nop 1
v_cvt_pk_bf16_f32 v188, v232, v233
v_cvt_pk_bf16_f32 v189, v234, v235
s_branch L2_rare_common
L2_rare_site7:
s_mov_b32 s36, 7
s_branch L2_rare_t1_1
L2_rare_t1_1:
s_nop 15
s_nop 15
s_waitcnt lgkmcnt(0)
v_lshrrev_b32 v206, 8, v243
v_add_u32 v206, 1, v206
v_lshrrev_b32 v206, 2, v206
v_sub_u32 v206, 0, v206
v_and_b32 v206, 0xffff0000, v206
v_max_f32 v204, v144, v145
v_max3_f32 v204, v204, v146, v147
v_mov_b32 v205, v204
s_nop 1
v_permlane32_swap_b32 v204, v205
s_nop 1
v_max_f32 v204, v204, v205
v_mov_b32 v205, v204
s_nop 1
v_permlane16_swap_b32 v204, v205
s_nop 1
v_max_f32 v204, v204, v205
v_add_f32 v204, 40.0, v204
v_ceil_f32 v204, v204
v_max_f32 v204, 0, v204
v_sub_f32 v205, v224, v204
v_cvt_pk_bf16_f32 v205, v205, v205
v_and_b32 v205, 0xffff0000, v205
v_sub_f32 v204, v205, v224
v_mov_b32 v224, v205
v_exp_f32 v236, v204
v_bfi_b32 v3, v206, v205, v3
v_add_f32 v144, v144, v204
v_add_f32 v145, v145, v204
v_add_f32 v146, v146, v204
v_add_f32 v147, v147, v204
v_add_f32 v128, v128, v204
v_add_f32 v129, v129, v204
v_add_f32 v130, v130, v204
v_add_f32 v131, v131, v204
v_lshlrev_b32 v242, 16, v176
v_and_b32 v248, 0xffff0000, v176
v_mul_f32 v242, v242, v236
v_mul_f32 v248, v248, v236
v_cvt_pk_bf16_f32 v176, v242, v248
v_lshlrev_b32 v242, 16, v177
v_and_b32 v248, 0xffff0000, v177
v_mul_f32 v242, v242, v236
v_mul_f32 v248, v248, v236
v_cvt_pk_bf16_f32 v177, v242, v248
ds_read_b64 v[250:251], v231 offset:0
s_waitcnt lgkmcnt(0)
v_lshlrev_b32 v242, 16, v250
v_and_b32 v248, 0xffff0000, v250
v_mul_f32 v242, v242, v236
v_mul_f32 v248, v248, v236
v_cvt_pk_bf16_f32 v250, v242, v248
v_lshlrev_b32 v242, 16, v251
v_and_b32 v248, 0xffff0000, v251
v_mul_f32 v242, v242, v236
v_mul_f32 v248, v248, v236
v_cvt_pk_bf16_f32 v251, v242, v248
ds_write_b64 v231, v[250:251] offset:0
s_waitcnt lgkmcnt(0)
ds_read_b64 v[250:251], v231 offset:8
s_waitcnt lgkmcnt(0)
v_lshlrev_b32 v242, 16, v250
v_and_b32 v248, 0xffff0000, v250
v_mul_f32 v242, v242, v236
v_mul_f32 v248, v248, v236
v_cvt_pk_bf16_f32 v250, v242, v248
v_lshlrev_b32 v242, 16, v251
v_and_b32 v248, 0xffff0000, v251
v_mul_f32 v242, v242, v236
v_mul_f32 v248, v248, v236
v_cvt_pk_bf16_f32 v251, v242, v248
ds_write_b64 v231, v[250:251] offset:8
s_waitcnt lgkmcnt(0)
ds_read_b64 v[250:251], v231 offset:4096
s_waitcnt lgkmcnt(0)
v_lshlrev_b32 v242, 16, v250
v_and_b32 v248, 0xffff0000, v250
v_mul_f32 v242, v242, v236
v_mul_f32 v248, v248, v236
v_cvt_pk_bf16_f32 v250, v242, v248
v_lshlrev_b32 v242, 16, v251
v_and_b32 v248, 0xffff0000, v251
v_mul_f32 v242, v242, v236
v_mul_f32 v248, v248, v236
v_cvt_pk_bf16_f32 v251, v242, v248
ds_write_b64 v231, v[250:251] offset:4096
s_waitcnt lgkmcnt(0)
ds_read_b64 v[250:251], v231 offset:4104
s_waitcnt lgkmcnt(0)
v_lshlrev_b32 v242, 16, v250
v_and_b32 v248, 0xffff0000, v250
v_mul_f32 v242, v242, v236
v_mul_f32 v248, v248, v236
v_cvt_pk_bf16_f32 v250, v242, v248
v_lshlrev_b32 v242, 16, v251
v_and_b32 v248, 0xffff0000, v251
v_mul_f32 v242, v242, v236
v_mul_f32 v248, v248, v236
v_cvt_pk_bf16_f32 v251, v242, v248
ds_write_b64 v231, v[250:251] offset:4104
s_waitcnt lgkmcnt(0)
v_exp_f32 v232, v144
v_exp_f32 v233, v145
v_exp_f32 v234, v146
v_exp_f32 v235, v147
s_nop 1
v_cvt_pk_bf16_f32 v178, v232, v233
v_cvt_pk_bf16_f32 v179, v234, v235
v_max_f32 v204, v148, v149
v_max3_f32 v204, v204, v150, v151
v_mov_b32 v205, v204
s_nop 1
v_permlane32_swap_b32 v204, v205
s_nop 1
v_max_f32 v204, v204, v205
v_mov_b32 v205, v204
s_nop 1
v_permlane16_swap_b32 v204, v205
s_nop 1
v_max_f32 v204, v204, v205
v_add_f32 v204, 40.0, v204
v_ceil_f32 v204, v204
v_max_f32 v204, 0, v204
v_sub_f32 v205, v225, v204
v_cvt_pk_bf16_f32 v205, v205, v205
v_and_b32 v205, 0xffff0000, v205
v_sub_f32 v204, v205, v225
v_mov_b32 v225, v205
v_exp_f32 v237, v204
v_bfi_b32 v35, v206, v205, v35
v_add_f32 v148, v148, v204
v_add_f32 v149, v149, v204
v_add_f32 v150, v150, v204
v_add_f32 v151, v151, v204
v_add_f32 v132, v132, v204
v_add_f32 v133, v133, v204
v_add_f32 v134, v134, v204
v_add_f32 v135, v135, v204
v_lshlrev_b32 v242, 16, v180
v_and_b32 v248, 0xffff0000, v180
v_mul_f32 v242, v242, v237
v_mul_f32 v248, v248, v237
v_cvt_pk_bf16_f32 v180, v242, v248
v_lshlrev_b32 v242, 16, v181
v_and_b32 v248, 0xffff0000, v181
v_mul_f32 v242, v242, v237
v_mul_f32 v248, v248, v237
v_cvt_pk_bf16_f32 v181, v242, v248
ds_read_b64 v[250:251], v231 offset:1024
s_waitcnt lgkmcnt(0)
v_lshlrev_b32 v242, 16, v250
v_and_b32 v248, 0xffff0000, v250
v_mul_f32 v242, v242, v237
v_mul_f32 v248, v248, v237
v_cvt_pk_bf16_f32 v250, v242, v248
v_lshlrev_b32 v242, 16, v251
v_and_b32 v248, 0xffff0000, v251
v_mul_f32 v242, v242, v237
v_mul_f32 v248, v248, v237
v_cvt_pk_bf16_f32 v251, v242, v248
ds_write_b64 v231, v[250:251] offset:1024
s_waitcnt lgkmcnt(0)
ds_read_b64 v[250:251], v231 offset:1032
s_waitcnt lgkmcnt(0)
v_lshlrev_b32 v242, 16, v250
v_and_b32 v248, 0xffff0000, v250
v_mul_f32 v242, v242, v237
v_mul_f32 v248, v248, v237
v_cvt_pk_bf16_f32 v250, v242, v248
v_lshlrev_b32 v242, 16, v251
v_and_b32 v248, 0xffff0000, v251
v_mul_f32 v242, v242, v237
v_mul_f32 v248, v248, v237
v_cvt_pk_bf16_f32 v251, v242, v248
ds_write_b64 v231, v[250:251] offset:1032
s_waitcnt lgkmcnt(0)
ds_read_b64 v[250:251], v231 offset:5120
s_waitcnt lgkmcnt(0)
v_lshlrev_b32 v242, 16, v250
v_and_b32 v248, 0xffff0000, v250
v_mul_f32 v242, v242, v237
v_mul_f32 v248, v248, v237
v_cvt_pk_bf16_f32 v250, v242, v248
v_lshlrev_b32 v242, 16, v251
v_and_b32 v248, 0xffff0000, v251
v_mul_f32 v242, v242, v237
v_mul_f32 v248, v248, v237
v_cvt_pk_bf16_f32 v251, v242, v248
ds_write_b64 v231, v[250:251] offset:5120
s_waitcnt lgkmcnt(0)
ds_read_b64 v[250:251], v231 offset:5128
s_waitcnt lgkmcnt(0)
v_lshlrev_b32 v242, 16, v250
v_and_b32 v248, 0xffff0000, v250
v_mul_f32 v242, v242, v237
v_mul_f32 v248, v248, v237
v_cvt_pk_bf16_f32 v250, v242, v248
v_lshlrev_b32 v242, 16, v251
v_and_b32 v248, 0xffff0000, v251
v_mul_f32 v242, v242, v237
v_mul_f32 v248, v248, v237
v_cvt_pk_bf16_f32 v251, v242, v248
ds_write_b64 v231, v[250:251] offset:5128
s_waitcnt lgkmcnt(0)
v_exp_f32 v232, v148
v_exp_f32 v233, v149
v_exp_f32 v234, v150
v_exp_f32 v235, v151
s_nop 1
v_cvt_pk_bf16_f32 v182, v232, v233
v_cvt_pk_bf16_f32 v183, v234, v235
v_max_f32 v204, v152, v153
v_max3_f32 v204, v204, v154, v155
v_mov_b32 v205, v204
s_nop 1
v_permlane32_swap_b32 v204, v205
s_nop 1
v_max_f32 v204, v204, v205
v_mov_b32 v205, v204
s_nop 1
v_permlane16_swap_b32 v204, v205
s_nop 1
v_max_f32 v204, v204, v205
v_add_f32 v204, 40.0, v204
v_ceil_f32 v204, v204
v_max_f32 v204, 0, v204
v_sub_f32 v205, v226, v204
v_cvt_pk_bf16_f32 v205, v205, v205
v_and_b32 v205, 0xffff0000, v205
v_sub_f32 v204, v205, v226
v_mov_b32 v226, v205
v_exp_f32 v238, v204
v_bfi_b32 v67, v206, v205, v67
v_add_f32 v152, v152, v204
v_add_f32 v153, v153, v204
v_add_f32 v154, v154, v204
v_add_f32 v155, v155, v204
v_add_f32 v136, v136, v204
v_add_f32 v137, v137, v204
v_add_f32 v138, v138, v204
v_add_f32 v139, v139, v204
v_lshlrev_b32 v242, 16, v184
v_and_b32 v248, 0xffff0000, v184
v_mul_f32 v242, v242, v238
v_mul_f32 v248, v248, v238
v_cvt_pk_bf16_f32 v184, v242, v248
v_lshlrev_b32 v242, 16, v185
v_and_b32 v248, 0xffff0000, v185
v_mul_f32 v242, v242, v238
v_mul_f32 v248, v248, v238
v_cvt_pk_bf16_f32 v185, v242, v248
ds_read_b64 v[250:251], v231 offset:2048
s_waitcnt lgkmcnt(0)
v_lshlrev_b32 v242, 16, v250
v_and_b32 v248, 0xffff0000, v250
v_mul_f32 v242, v242, v238
v_mul_f32 v248, v248, v238
v_cvt_pk_bf16_f32 v250, v242, v248
v_lshlrev_b32 v242, 16, v251
v_and_b32 v248, 0xffff0000, v251
v_mul_f32 v242, v242, v238
v_mul_f32 v248, v248, v238
v_cvt_pk_bf16_f32 v251, v242, v248
ds_write_b64 v231, v[250:251] offset:2048
s_waitcnt lgkmcnt(0)
ds_read_b64 v[250:251], v231 offset:2056
s_waitcnt lgkmcnt(0)
v_lshlrev_b32 v242, 16, v250
v_and_b32 v248, 0xffff0000, v250
v_mul_f32 v242, v242, v238
v_mul_f32 v248, v248, v238
v_cvt_pk_bf16_f32 v250, v242, v248
v_lshlrev_b32 v242, 16, v251
v_and_b32 v248, 0xffff0000, v251
v_mul_f32 v242, v242, v238
v_mul_f32 v248, v248, v238
v_cvt_pk_bf16_f32 v251, v242, v248
ds_write_b64 v231, v[250:251] offset:2056
s_waitcnt lgkmcnt(0)
ds_read_b64 v[250:251], v231 offset:6144
s_waitcnt lgkmcnt(0)
v_lshlrev_b32 v242, 16, v250
v_and_b32 v248, 0xffff0000, v250
v_mul_f32 v242, v242, v238
v_mul_f32 v248, v248, v238
v_cvt_pk_bf16_f32 v250, v242, v248
v_lshlrev_b32 v242, 16, v251
v_and_b32 v248, 0xffff0000, v251
v_mul_f32 v242, v242, v238
v_mul_f32 v248, v248, v238
v_cvt_pk_bf16_f32 v251, v242, v248
ds_write_b64 v231, v[250:251] offset:6144
s_waitcnt lgkmcnt(0)
ds_read_b64 v[250:251], v231 offset:6152
s_waitcnt lgkmcnt(0)
v_lshlrev_b32 v242, 16, v250
v_and_b32 v248, 0xffff0000, v250
v_mul_f32 v242, v242, v238
v_mul_f32 v248, v248, v238
v_cvt_pk_bf16_f32 v250, v242, v248
v_lshlrev_b32 v242, 16, v251
v_and_b32 v248, 0xffff0000, v251
v_mul_f32 v242, v242, v238
v_mul_f32 v248, v248, v238
v_cvt_pk_bf16_f32 v251, v242, v248
ds_write_b64 v231, v[250:251] offset:6152
s_waitcnt lgkmcnt(0)
v_exp_f32 v232, v152
v_exp_f32 v233, v153
v_exp_f32 v234, v154
v_exp_f32 v235, v155
s_nop 1
v_cvt_pk_bf16_f32 v186, v232, v233
v_cvt_pk_bf16_f32 v187, v234, v235
v_max_f32 v204, v156, v157
v_max3_f32 v204, v204, v158, v159
v_mov_b32 v205, v204
s_nop 1
v_permlane32_swap_b32 v204, v205
s_nop 1
v_max_f32 v204, v204, v205
v_mov_b32 v205, v204
s_nop 1
v_permlane16_swap_b32 v204, v205
s_nop 1
v_max_f32 v204, v204, v205
v_add_f32 v204, 40.0, v204
v_ceil_f32 v204, v204
v_max_f32 v204, 0, v204
v_sub_f32 v205, v227, v204
v_cvt_pk_bf16_f32 v205, v205, v205
v_and_b32 v205, 0xffff0000, v205
v_sub_f32 v204, v205, v227
v_mov_b32 v227, v205
v_exp_f32 v239, v204
v_bfi_b32 v99, v206, v205, v99
v_add_f32 v156, v156, v204
v_add_f32 v157, v157, v204
v_add_f32 v158, v158, v204
v_add_f32 v159, v159, v204
v_add_f32 v140, v140, v204
v_add_f32 v141, v141, v204
v_add_f32 v142, v142, v204
v_add_f32 v143, v143, v204
v_lshlrev_b32 v242, 16, v188
v_and_b32 v248, 0xffff0000, v188
v_mul_f32 v242, v242, v239
v_mul_f32 v248, v248, v239
v_cvt_pk_bf16_f32 v188, v242, v248
v_lshlrev_b32 v242, 16, v189
v_and_b32 v248, 0xffff0000, v189
v_mul_f32 v242, v242, v239
v_mul_f32 v248, v248, v239
v_cvt_pk_bf16_f32 v189, v242, v248
ds_read_b64 v[250:251], v231 offset:3072
s_waitcnt lgkmcnt(0)
v_lshlrev_b32 v242, 16, v250
v_and_b32 v248, 0xffff0000, v250
v_mul_f32 v242, v242, v239
v_mul_f32 v248, v248, v239
v_cvt_pk_bf16_f32 v250, v242, v248
v_lshlrev_b32 v242, 16, v251
v_and_b32 v248, 0xffff0000, v251
v_mul_f32 v242, v242, v239
v_mul_f32 v248, v248, v239
v_cvt_pk_bf16_f32 v251, v242, v248
ds_write_b64 v231, v[250:251] offset:3072
s_waitcnt lgkmcnt(0)
ds_read_b64 v[250:251], v231 offset:3080
s_waitcnt lgkmcnt(0)
v_lshlrev_b32 v242, 16, v250
v_and_b32 v248, 0xffff0000, v250
v_mul_f32 v242, v242, v239
v_mul_f32 v248, v248, v239
v_cvt_pk_bf16_f32 v250, v242, v248
v_lshlrev_b32 v242, 16, v251
v_and_b32 v248, 0xffff0000, v251
v_mul_f32 v242, v242, v239
v_mul_f32 v248, v248, v239
v_cvt_pk_bf16_f32 v251, v242, v248
ds_write_b64 v231, v[250:251] offset:3080
s_waitcnt lgkmcnt(0)
ds_read_b64 v[250:251], v231 offset:7168
s_waitcnt lgkmcnt(0)
v_lshlrev_b32 v242, 16, v250
v_and_b32 v248, 0xffff0000, v250
v_mul_f32 v242, v242, v239
v_mul_f32 v248, v248, v239
v_cvt_pk_bf16_f32 v250, v242, v248
v_lshlrev_b32 v242, 16, v251
v_and_b32 v248, 0xffff0000, v251
v_mul_f32 v242, v242, v239
v_mul_f32 v248, v248, v239
v_cvt_pk_bf16_f32 v251, v242, v248
ds_write_b64 v231, v[250:251] offset:7168
s_waitcnt lgkmcnt(0)
ds_read_b64 v[250:251], v231 offset:7176
s_waitcnt lgkmcnt(0)
v_lshlrev_b32 v242, 16, v250
v_and_b32 v248, 0xffff0000, v250
v_mul_f32 v242, v242, v239
v_mul_f32 v248, v248, v239
v_cvt_pk_bf16_f32 v250, v242, v248
v_lshlrev_b32 v242, 16, v251
v_and_b32 v248, 0xffff0000, v251
v_mul_f32 v242, v242, v239
v_mul_f32 v248, v248, v239
v_cvt_pk_bf16_f32 v251, v242, v248
ds_write_b64 v231, v[250:251] offset:7176
s_waitcnt lgkmcnt(0)
v_exp_f32 v232, v156
v_exp_f32 v233, v157
v_exp_f32 v234, v158
v_exp_f32 v235, v159
s_nop 1
v_cvt_pk_bf16_f32 v190, v232, v233
v_cvt_pk_bf16_f32 v191, v234, v235
s_branch L2_rare_common
L2_rare_site8:
s_mov_b32 s36, 8
s_branch L2_rare_t1_2
L2_rare_t1_2:
s_nop 15
s_nop 15
s_waitcnt lgkmcnt(0)
v_lshrrev_b32 v206, 8, v243
v_add_u32 v206, 1, v206
v_lshrrev_b32 v206, 2, v206
v_sub_u32 v206, 0, v206
v_and_b32 v206, 0xffff0000, v206
v_max_f32 v204, v128, v129
v_max3_f32 v204, v204, v130, v131
v_mov_b32 v205, v204
s_nop 1
v_permlane32_swap_b32 v204, v205
s_nop 1
v_max_f32 v204, v204, v205
v_mov_b32 v205, v204
s_nop 1
v_permlane16_swap_b32 v204, v205
s_nop 1
v_max_f32 v204, v204, v205
v_add_f32 v204, 40.0, v204
v_ceil_f32 v204, v204
v_max_f32 v204, 0, v204
v_sub_f32 v205, v224, v204
v_cvt_pk_bf16_f32 v205, v205, v205
v_and_b32 v205, 0xffff0000, v205
v_sub_f32 v204, v205, v224
v_mov_b32 v224, v205
v_exp_f32 v236, v204
v_bfi_b32 v3, v206, v205, v3
v_add_f32 v128, v128, v204
v_add_f32 v129, v129, v204
v_add_f32 v130, v130, v204
v_add_f32 v131, v131, v204
v_add_f32 v144, v144, v204
v_add_f32 v145, v145, v204
v_add_f32 v146, v146, v204
v_add_f32 v147, v147, v204
v_lshlrev_b32 v242, 16, v176
v_and_b32 v248, 0xffff0000, v176
v_mul_f32 v242, v242, v236
v_mul_f32 v248, v248, v236
v_cvt_pk_bf16_f32 v176, v242, v248
v_lshlrev_b32 v242, 16, v177
v_and_b32 v248, 0xffff0000, v177
v_mul_f32 v242, v242, v236
v_mul_f32 v248, v248, v236
v_cvt_pk_bf16_f32 v177, v242, v248
v_lshlrev_b32 v242, 16, v178
v_and_b32 v248, 0xffff0000, v178
v_mul_f32 v242, v242, v236
v_mul_f32 v248, v248, v236
v_cvt_pk_bf16_f32 v178, v242, v248
v_lshlrev_b32 v242, 16, v179
v_and_b32 v248, 0xffff0000, v179
v_mul_f32 v242, v242, v236
v_mul_f32 v248, v248, v236
v_cvt_pk_bf16_f32 v179, v242, v248
ds_read_b64 v[250:251], v231 offset:0
s_waitcnt lgkmcnt(0)
v_lshlrev_b32 v242, 16, v250
v_and_b32 v248, 0xffff0000, v250
v_mul_f32 v242, v242, v236
v_mul_f32 v248, v248, v236
v_cvt_pk_bf16_f32 v250, v242, v248
v_lshlrev_b32 v242, 16, v251
v_and_b32 v248, 0xffff0000, v251
v_mul_f32 v242, v242, v236
v_mul_f32 v248, v248, v236
v_cvt_pk_bf16_f32 v251, v242, v248
ds_write_b64 v231, v[250:251] offset:0
s_waitcnt lgkmcnt(0)
ds_read_b64 v[250:251], v231 offset:8
s_waitcnt lgkmcnt(0)
v_lshlrev_b32 v242, 16, v250
v_and_b32 v248, 0xffff0000, v250
v_mul_f32 v242, v242, v236
v_mul_f32 v248, v248, v236
v_cvt_pk_bf16_f32 v250, v242, v248
v_lshlrev_b32 v242, 16, v251
v_and_b32 v248, 0xffff0000, v251
v_mul_f32 v242, v242, v236
v_mul_f32 v248, v248, v236
v_cvt_pk_bf16_f32 v251, v242, v248
ds_write_b64 v231, v[250:251] offset:8
s_waitcnt lgkmcnt(0)
ds_read_b64 v[250:251], v231 offset:4096
s_waitcnt lgkmcnt(0)
v_lshlrev_b32 v242, 16, v250
v_and_b32 v248, 0xffff0000, v250
v_mul_f32 v242, v242, v236
v_mul_f32 v248, v248, v236
v_cvt_pk_bf16_f32 v250, v242, v248
v_lshlrev_b32 v242, 16, v251
v_and_b32 v248, 0xffff0000, v251
v_mul_f32 v242, v242, v236
v_mul_f32 v248, v248, v236
v_cvt_pk_bf16_f32 v251, v242, v248
ds_write_b64 v231, v[250:251] offset:4096
s_waitcnt lgkmcnt(0)
ds_read_b64 v[250:251], v231 offset:4104
s_waitcnt lgkmcnt(0)
v_lshlrev_b32 v242, 16, v250
v_and_b32 v248, 0xffff0000, v250
v_mul_f32 v242, v242, v236
v_mul_f32 v248, v248, v236
v_cvt_pk_bf16_f32 v250, v242, v248
v_lshlrev_b32 v242, 16, v251
v_and_b32 v248, 0xffff0000, v251
v_mul_f32 v242, v242, v236
v_mul_f32 v248, v248, v236
v_cvt_pk_bf16_f32 v251, v242, v248
ds_write_b64 v231, v[250:251] offset:4104
s_waitcnt lgkmcnt(0)
v_exp_f32 v232, v128
v_exp_f32 v233, v129
v_exp_f32 v234, v130
v_exp_f32 v235, v131
s_nop 1
v_cvt_pk_bf16_f32 v160, v232, v233
v_cvt_pk_bf16_f32 v161, v234, v235
v_max_f32 v204, v132, v133
v_max3_f32 v204, v204, v134, v135
v_mov_b32 v205, v204
s_nop 1
v_permlane32_swap_b32 v204, v205
s_nop 1
v_max_f32 v204, v204, v205
v_mov_b32 v205, v204
s_nop 1
v_permlane16_swap_b32 v204, v205
s_nop 1
v_max_f32 v204, v204, v205
v_add_f32 v204, 40.0, v204
v_ceil_f32 v204, v204
v_max_f32 v204, 0, v204
v_sub_f32 v205, v225, v204
v_cvt_pk_bf16_f32 v205, v205, v205
v_and_b32 v205, 0xffff0000, v205
v_sub_f32 v204, v205, v225
v_mov_b32 v225, v205
v_exp_f32 v237, v204
v_bfi_b32 v35, v206, v205, v35
v_add_f32 v132, v132, v204
v_add_f32 v133, v133, v204
v_add_f32 v134, v134, v204
v_add_f32 v135, v135, v204
v_add_f32 v148, v148, v204
v_add_f32 v149, v149, v204
v_add_f32 v150, v150, v204
v_add_f32 v151, v151, v204
v_lshlrev_b32 v242, 16, v180
v_and_b32 v248, 0xffff0000, v180
v_mul_f32 v242, v242, v237
v_mul_f32 v248, v248, v237
v_cvt_pk_bf16_f32 v180, v242, v248
v_lshlrev_b32 v242, 16, v181
v_and_b32 v248, 0xffff0000, v181
v_mul_f32 v242, v242, v237
v_mul_f32 v248, v248, v237
v_cvt_pk_bf16_f32 v181, v242, v248
v_lshlrev_b32 v242, 16, v182
v_and_b32 v248, 0xffff0000, v182
v_mul_f32 v242, v242, v237
v_mul_f32 v248, v248, v237
v_cvt_pk_bf16_f32 v182, v242, v248
v_lshlrev_b32 v242, 16, v183
v_and_b32 v248, 0xffff0000, v183
v_mul_f32 v242, v242, v237
v_mul_f32 v248, v248, v237
v_cvt_pk_bf16_f32 v183, v242, v248
ds_read_b64 v[250:251], v231 offset:1024
s_waitcnt lgkmcnt(0)
v_lshlrev_b32 v242, 16, v250
v_and_b32 v248, 0xffff0000, v250
v_mul_f32 v242, v242, v237
v_mul_f32 v248, v248, v237
v_cvt_pk_bf16_f32 v250, v242, v248
v_lshlrev_b32 v242, 16, v251
v_and_b32 v248, 0xffff0000, v251
v_mul_f32 v242, v242, v237
v_mul_f32 v248, v248, v237
v_cvt_pk_bf16_f32 v251, v242, v248
ds_write_b64 v231, v[250:251] offset:1024
s_waitcnt lgkmcnt(0)
ds_read_b64 v[250:251], v231 offset:1032
s_waitcnt lgkmcnt(0)
v_lshlrev_b32 v242, 16, v250
v_and_b32 v248, 0xffff0000, v250
v_mul_f32 v242, v242, v237
v_mul_f32 v248, v248, v237
v_cvt_pk_bf16_f32 v250, v242, v248
v_lshlrev_b32 v242, 16, v251
v_and_b32 v248, 0xffff0000, v251
v_mul_f32 v242, v242, v237
v_mul_f32 v248, v248, v237
v_cvt_pk_bf16_f32 v251, v242, v248
ds_write_b64 v231, v[250:251] offset:1032
s_waitcnt lgkmcnt(0)
ds_read_b64 v[250:251], v231 offset:5120
s_waitcnt lgkmcnt(0)
v_lshlrev_b32 v242, 16, v250
v_and_b32 v248, 0xffff0000, v250
v_mul_f32 v242, v242, v237
v_mul_f32 v248, v248, v237
v_cvt_pk_bf16_f32 v250, v242, v248
v_lshlrev_b32 v242, 16, v251
v_and_b32 v248, 0xffff0000, v251
v_mul_f32 v242, v242, v237
v_mul_f32 v248, v248, v237
v_cvt_pk_bf16_f32 v251, v242, v248
ds_write_b64 v231, v[250:251] offset:5120
s_waitcnt lgkmcnt(0)
ds_read_b64 v[250:251], v231 offset:5128
s_waitcnt lgkmcnt(0)
v_lshlrev_b32 v242, 16, v250
v_and_b32 v248, 0xffff0000, v250
v_mul_f32 v242, v242, v237
v_mul_f32 v248, v248, v237
v_cvt_pk_bf16_f32 v250, v242, v248
v_lshlrev_b32 v242, 16, v251
v_and_b32 v248, 0xffff0000, v251
v_mul_f32 v242, v242, v237
v_mul_f32 v248, v248, v237
v_cvt_pk_bf16_f32 v251, v242, v248
ds_write_b64 v231, v[250:251] offset:5128
s_waitcnt lgkmcnt(0)
v_exp_f32 v232, v132
v_exp_f32 v233, v133
v_exp_f32 v234, v134
v_exp_f32 v235, v135
s_nop 1
v_cvt_pk_bf16_f32 v164, v232, v233
v_cvt_pk_bf16_f32 v165, v234, v235
v_max_f32 v204, v136, v137
v_max3_f32 v204, v204, v138, v139
v_mov_b32 v205, v204
s_nop 1
v_permlane32_swap_b32 v204, v205
s_nop 1
v_max_f32 v204, v204, v205
v_mov_b32 v205, v204
s_nop 1
v_permlane16_swap_b32 v204, v205
s_nop 1
v_max_f32 v204, v204, v205
v_add_f32 v204, 40.0, v204
v_ceil_f32 v204, v204
v_max_f32 v204, 0, v204
v_sub_f32 v205, v226, v204
v_cvt_pk_bf16_f32 v205, v205, v205
v_and_b32 v205, 0xffff0000, v205
v_sub_f32 v204, v205, v226
v_mov_b32 v226, v205
v_exp_f32 v238, v204
v_bfi_b32 v67, v206, v205, v67
v_add_f32 v136, v136, v204
v_add_f32 v137, v137, v204
v_add_f32 v138, v138, v204
v_add_f32 v139, v139, v204
v_add_f32 v152, v152, v204
v_add_f32 v153, v153, v204
v_add_f32 v154, v154, v204
v_add_f32 v155, v155, v204
v_lshlrev_b32 v242, 16, v184
v_and_b32 v248, 0xffff0000, v184
v_mul_f32 v242, v242, v238
v_mul_f32 v248, v248, v238
v_cvt_pk_bf16_f32 v184, v242, v248
v_lshlrev_b32 v242, 16, v185
v_and_b32 v248, 0xffff0000, v185
v_mul_f32 v242, v242, v238
v_mul_f32 v248, v248, v238
v_cvt_pk_bf16_f32 v185, v242, v248
v_lshlrev_b32 v242, 16, v186
v_and_b32 v248, 0xffff0000, v186
v_mul_f32 v242, v242, v238
v_mul_f32 v248, v248, v238
v_cvt_pk_bf16_f32 v186, v242, v248
v_lshlrev_b32 v242, 16, v187
v_and_b32 v248, 0xffff0000, v187
v_mul_f32 v242, v242, v238
v_mul_f32 v248, v248, v238
v_cvt_pk_bf16_f32 v187, v242, v248
ds_read_b64 v[250:251], v231 offset:2048
s_waitcnt lgkmcnt(0)
v_lshlrev_b32 v242, 16, v250
v_and_b32 v248, 0xffff0000, v250
v_mul_f32 v242, v242, v238
v_mul_f32 v248, v248, v238
v_cvt_pk_bf16_f32 v250, v242, v248
v_lshlrev_b32 v242, 16, v251
v_and_b32 v248, 0xffff0000, v251
v_mul_f32 v242, v242, v238
v_mul_f32 v248, v248, v238
v_cvt_pk_bf16_f32 v251, v242, v248
ds_write_b64 v231, v[250:251] offset:2048
s_waitcnt lgkmcnt(0)
ds_read_b64 v[250:251], v231 offset:2056
s_waitcnt lgkmcnt(0)
v_lshlrev_b32 v242, 16, v250
v_and_b32 v248, 0xffff0000, v250
v_mul_f32 v242, v242, v238
v_mul_f32 v248, v248, v238
v_cvt_pk_bf16_f32 v250, v242, v248
v_lshlrev_b32 v242, 16, v251
v_and_b32 v248, 0xffff0000, v251
v_mul_f32 v242, v242, v238
v_mul_f32 v248, v248, v238
v_cvt_pk_bf16_f32 v251, v242, v248
ds_write_b64 v231, v[250:251] offset:2056
s_waitcnt lgkmcnt(0)
ds_read_b64 v[250:251], v231 offset:6144
s_waitcnt lgkmcnt(0)
v_lshlrev_b32 v242, 16, v250
v_and_b32 v248, 0xffff0000, v250
v_mul_f32 v242, v242, v238
v_mul_f32 v248, v248, v238
v_cvt_pk_bf16_f32 v250, v242, v248
v_lshlrev_b32 v242, 16, v251
v_and_b32 v248, 0xffff0000, v251
v_mul_f32 v242, v242, v238
v_mul_f32 v248, v248, v238
v_cvt_pk_bf16_f32 v251, v242, v248
ds_write_b64 v231, v[250:251] offset:6144
s_waitcnt lgkmcnt(0)
ds_read_b64 v[250:251], v231 offset:6152
s_waitcnt lgkmcnt(0)
v_lshlrev_b32 v242, 16, v250
v_and_b32 v248, 0xffff0000, v250
v_mul_f32 v242, v242, v238
v_mul_f32 v248, v248, v238
v_cvt_pk_bf16_f32 v250, v242, v248
v_lshlrev_b32 v242, 16, v251
v_and_b32 v248, 0xffff0000, v251
v_mul_f32 v242, v242, v238
v_mul_f32 v248, v248, v238
v_cvt_pk_bf16_f32 v251, v242, v248
ds_write_b64 v231, v[250:251] offset:6152
s_waitcnt lgkmcnt(0)
v_exp_f32 v232, v136
v_exp_f32 v233, v137
v_exp_f32 v234, v138
v_exp_f32 v235, v139
s_nop 1
v_cvt_pk_bf16_f32 v168, v232, v233
v_cvt_pk_bf16_f32 v169, v234, v235
v_max_f32 v204, v140, v141
v_max3_f32 v204, v204, v142, v143
v_mov_b32 v205, v204
s_nop 1
v_permlane32_swap_b32 v204, v205
s_nop 1
v_max_f32 v204, v204, v205
v_mov_b32 v205, v204
s_nop 1
v_permlane16_swap_b32 v204, v205
s_nop 1
v_max_f32 v204, v204, v205
v_add_f32 v204, 40.0, v204
v_ceil_f32 v204, v204
v_max_f32 v204, 0, v204
v_sub_f32 v205, v227, v204
v_cvt_pk_bf16_f32 v205, v205, v205
v_and_b32 v205, 0xffff0000, v205
v_sub_f32 v204, v205, v227
v_mov_b32 v227, v205
v_exp_f32 v239, v204
v_bfi_b32 v99, v206, v205, v99
v_add_f32 v140, v140, v204
v_add_f32 v141, v141, v204
v_add_f32 v142, v142, v204
v_add_f32 v143, v143, v204
v_add_f32 v156, v156, v204
v_add_f32 v157, v157, v204
v_add_f32 v158, v158, v204
v_add_f32 v159, v159, v204
v_lshlrev_b32 v242, 16, v188
v_and_b32 v248, 0xffff0000, v188
v_mul_f32 v242, v242, v239
v_mul_f32 v248, v248, v239
v_cvt_pk_bf16_f32 v188, v242, v248
v_lshlrev_b32 v242, 16, v189
v_and_b32 v248, 0xffff0000, v189
v_mul_f32 v242, v242, v239
v_mul_f32 v248, v248, v239
v_cvt_pk_bf16_f32 v189, v242, v248
v_lshlrev_b32 v242, 16, v190
v_and_b32 v248, 0xffff0000, v190
v_mul_f32 v242, v242, v239
v_mul_f32 v248, v248, v239
v_cvt_pk_bf16_f32 v190, v242, v248
v_lshlrev_b32 v242, 16, v191
v_and_b32 v248, 0xffff0000, v191
v_mul_f32 v242, v242, v239
v_mul_f32 v248, v248, v239
v_cvt_pk_bf16_f32 v191, v242, v248
ds_read_b64 v[250:251], v231 offset:3072
s_waitcnt lgkmcnt(0)
v_lshlrev_b32 v242, 16, v250
v_and_b32 v248, 0xffff0000, v250
v_mul_f32 v242, v242, v239
v_mul_f32 v248, v248, v239
v_cvt_pk_bf16_f32 v250, v242, v248
v_lshlrev_b32 v242, 16, v251
v_and_b32 v248, 0xffff0000, v251
v_mul_f32 v242, v242, v239
v_mul_f32 v248, v248, v239
v_cvt_pk_bf16_f32 v251, v242, v248
ds_write_b64 v231, v[250:251] offset:3072
s_waitcnt lgkmcnt(0)
ds_read_b64 v[250:251], v231 offset:3080
s_waitcnt lgkmcnt(0)
v_lshlrev_b32 v242, 16, v250
v_and_b32 v248, 0xffff0000, v250
v_mul_f32 v242, v242, v239
v_mul_f32 v248, v248, v239
v_cvt_pk_bf16_f32 v250, v242, v248
v_lshlrev_b32 v242, 16, v251
v_and_b32 v248, 0xffff0000, v251
v_mul_f32 v242, v242, v239
v_mul_f32 v248, v248, v239
v_cvt_pk_bf16_f32 v251, v242, v248
ds_write_b64 v231, v[250:251] offset:3080
s_waitcnt lgkmcnt(0)
ds_read_b64 v[250:251], v231 offset:7168
s_waitcnt lgkmcnt(0)
v_lshlrev_b32 v242, 16, v250
v_and_b32 v248, 0xffff0000, v250
v_mul_f32 v242, v242, v239
v_mul_f32 v248, v248, v239
v_cvt_pk_bf16_f32 v250, v242, v248
v_lshlrev_b32 v242, 16, v251
v_and_b32 v248, 0xffff0000, v251
v_mul_f32 v242, v242, v239
v_mul_f32 v248, v248, v239
v_cvt_pk_bf16_f32 v251, v242, v248
ds_write_b64 v231, v[250:251] offset:7168
s_waitcnt lgkmcnt(0)
ds_read_b64 v[250:251], v231 offset:7176
s_waitcnt lgkmcnt(0)
v_lshlrev_b32 v242, 16, v250
v_and_b32 v248, 0xffff0000, v250
v_mul_f32 v242, v242, v239
v_mul_f32 v248, v248, v239
v_cvt_pk_bf16_f32 v250, v242, v248
v_lshlrev_b32 v242, 16, v251
v_and_b32 v248, 0xffff0000, v251
v_mul_f32 v242, v242, v239
v_mul_f32 v248, v248, v239
v_cvt_pk_bf16_f32 v251, v242, v248
ds_write_b64 v231, v[250:251] offset:7176
s_waitcnt lgkmcnt(0)
v_exp_f32 v232, v140
v_exp_f32 v233, v141
v_exp_f32 v234, v142
v_exp_f32 v235, v143
s_nop 1
v_cvt_pk_bf16_f32 v172, v232, v233
v_cvt_pk_bf16_f32 v173, v234, v235
s_branch L2_rare_common
L2_rare_site9:
s_mov_b32 s36, 9
s_branch L2_rare_t1_3
L2_rare_t1_3:
s_nop 15
s_nop 15
s_waitcnt lgkmcnt(0)
v_lshrrev_b32 v206, 8, v243
v_add_u32 v206, 1, v206
v_lshrrev_b32 v206, 2, v206
v_sub_u32 v206, 0, v206
v_and_b32 v206, 0xffff0000, v206
v_max_f32 v204, v144, v145
v_max3_f32 v204, v204, v146, v147
v_mov_b32 v205, v204
s_nop 1
v_permlane32_swap_b32 v204, v205
s_nop 1
v_max_f32 v204, v204, v205
v_mov_b32 v205, v204
s_nop 1
v_permlane16_swap_b32 v204, v205
s_nop 1
v_max_f32 v204, v204, v205
v_add_f32 v204, 40.0, v204
v_ceil_f32 v204, v204
v_max_f32 v204, 0, v204
v_sub_f32 v205, v224, v204
v_cvt_pk_bf16_f32 v205, v205, v205
v_and_b32 v205, 0xffff0000, v205
v_sub_f32 v204, v205, v224
v_mov_b32 v224, v205
v_exp_f32 v236, v204
v_bfi_b32 v3, v206, v205, v3
v_add_f32 v144, v144, v204
v_add_f32 v145, v145, v204
v_add_f32 v146, v146, v204
v_add_f32 v147, v147, v204
v_add_f32 v128, v128, v204
v_add_f32 v129, v129, v204
v_add_f32 v130, v130, v204
v_add_f32 v131, v131, v204
v_lshlrev_b32 v242, 16, v176
v_and_b32 v248, 0xffff0000, v176
v_mul_f32 v242, v242, v236
v_mul_f32 v248, v248, v236
v_cvt_pk_bf16_f32 v176, v242, v248
v_lshlrev_b32 v242, 16, v177
v_and_b32 v248, 0xffff0000, v177
v_mul_f32 v242, v242, v236
v_mul_f32 v248, v248, v236
v_cvt_pk_bf16_f32 v177, v242, v248
v_lshlrev_b32 v242, 16, v178
v_and_b32 v248, 0xffff0000, v178
v_mul_f32 v242, v242, v236
v_mul_f32 v248, v248, v236
v_cvt_pk_bf16_f32 v178, v242, v248
v_lshlrev_b32 v242, 16, v179
v_and_b32 v248, 0xffff0000, v179
v_mul_f32 v242, v242, v236
v_mul_f32 v248, v248, v236
v_cvt_pk_bf16_f32 v179, v242, v248
v_lshlrev_b32 v242, 16, v160
v_and_b32 v248, 0xffff0000, v160
v_mul_f32 v242, v242, v236
v_mul_f32 v248, v248, v236
v_cvt_pk_bf16_f32 v160, v242, v248
v_lshlrev_b32 v242, 16, v161
v_and_b32 v248, 0xffff0000, v161
v_mul_f32 v242, v242, v236
v_mul_f32 v248, v248, v236
v_cvt_pk_bf16_f32 v161, v242, v248
ds_read_b64 v[250:251], v231 offset:0
s_waitcnt lgkmcnt(0)
v_lshlrev_b32 v242, 16, v250
v_and_b32 v248, 0xffff0000, v250
v_mul_f32 v242, v242, v236
v_mul_f32 v248, v248, v236
v_cvt_pk_bf16_f32 v250, v242, v248
v_lshlrev_b32 v242, 16, v251
v_and_b32 v248, 0xffff0000, v251
v_mul_f32 v242, v242, v236
v_mul_f32 v248, v248, v236
v_cvt_pk_bf16_f32 v251, v242, v248
ds_write_b64 v231, v[250:251] offset:0
s_waitcnt lgkmcnt(0)
ds_read_b64 v[250:251], v231 offset:8
s_waitcnt lgkmcnt(0)
v_lshlrev_b32 v242, 16, v250
v_and_b32 v248, 0xffff0000, v250
v_mul_f32 v242, v242, v236
v_mul_f32 v248, v248, v236
v_cvt_pk_bf16_f32 v250, v242, v248
v_lshlrev_b32 v242, 16, v251
v_and_b32 v248, 0xffff0000, v251
v_mul_f32 v242, v242, v236
v_mul_f32 v248, v248, v236
v_cvt_pk_bf16_f32 v251, v242, v248
ds_write_b64 v231, v[250:251] offset:8
s_waitcnt lgkmcnt(0)
ds_read_b64 v[250:251], v231 offset:4096
s_waitcnt lgkmcnt(0)
v_lshlrev_b32 v242, 16, v250
v_and_b32 v248, 0xffff0000, v250
v_mul_f32 v242, v242, v236
v_mul_f32 v248, v248, v236
v_cvt_pk_bf16_f32 v250, v242, v248
v_lshlrev_b32 v242, 16, v251
v_and_b32 v248, 0xffff0000, v251
v_mul_f32 v242, v242, v236
v_mul_f32 v248, v248, v236
v_cvt_pk_bf16_f32 v251, v242, v248
ds_write_b64 v231, v[250:251] offset:4096
s_waitcnt lgkmcnt(0)
ds_read_b64 v[250:251], v231 offset:4104
s_waitcnt lgkmcnt(0)
v_lshlrev_b32 v242, 16, v250
v_and_b32 v248, 0xffff0000, v250
v_mul_f32 v242, v242, v236
v_mul_f32 v248, v248, v236
v_cvt_pk_bf16_f32 v250, v242, v248
v_lshlrev_b32 v242, 16, v251
v_and_b32 v248, 0xffff0000, v251
v_mul_f32 v242, v242, v236
v_mul_f32 v248, v248, v236
v_cvt_pk_bf16_f32 v251, v242, v248
ds_write_b64 v231, v[250:251] offset:4104
s_waitcnt lgkmcnt(0)
v_exp_f32 v232, v144
v_exp_f32 v233, v145
v_exp_f32 v234, v146
v_exp_f32 v235, v147
s_nop 1
v_cvt_pk_bf16_f32 v162, v232, v233
v_cvt_pk_bf16_f32 v163, v234, v235
v_max_f32 v204, v148, v149
v_max3_f32 v204, v204, v150, v151
v_mov_b32 v205, v204
s_nop 1
v_permlane32_swap_b32 v204, v205
s_nop 1
v_max_f32 v204, v204, v205
v_mov_b32 v205, v204
s_nop 1
v_permlane16_swap_b32 v204, v205
s_nop 1
v_max_f32 v204, v204, v205
v_add_f32 v204, 40.0, v204
v_ceil_f32 v204, v204
v_max_f32 v204, 0, v204
v_sub_f32 v205, v225, v204
v_cvt_pk_bf16_f32 v205, v205, v205
v_and_b32 v205, 0xffff0000, v205
v_sub_f32 v204, v205, v225
v_mov_b32 v225, v205
v_exp_f32 v237, v204
v_bfi_b32 v35, v206, v205, v35
v_add_f32 v148, v148, v204
v_add_f32 v149, v149, v204
v_add_f32 v150, v150, v204
v_add_f32 v151, v151, v204
v_add_f32 v132, v132, v204
v_add_f32 v133, v133, v204
v_add_f32 v134, v134, v204
v_add_f32 v135, v135, v204
v_lshlrev_b32 v242, 16, v180
v_and_b32 v248, 0xffff0000, v180
v_mul_f32 v242, v242, v237
v_mul_f32 v248, v248, v237
v_cvt_pk_bf16_f32 v180, v242, v248
v_lshlrev_b32 v242, 16, v181
v_and_b32 v248, 0xffff0000, v181
v_mul_f32 v242, v242, v237
v_mul_f32 v248, v248, v237
v_cvt_pk_bf16_f32 v181, v242, v248
v_lshlrev_b32 v242, 16, v182
v_and_b32 v248, 0xffff0000, v182
v_mul_f32 v242, v242, v237
v_mul_f32 v248, v248, v237
v_cvt_pk_bf16_f32 v182, v242, v248
v_lshlrev_b32 v242, 16, v183
v_and_b32 v248, 0xffff0000, v183
v_mul_f32 v242, v242, v237
v_mul_f32 v248, v248, v237
v_cvt_pk_bf16_f32 v183, v242, v248
v_lshlrev_b32 v242, 16, v164
v_and_b32 v248, 0xffff0000, v164
v_mul_f32 v242, v242, v237
v_mul_f32 v248, v248, v237
v_cvt_pk_bf16_f32 v164, v242, v248
v_lshlrev_b32 v242, 16, v165
v_and_b32 v248, 0xffff0000, v165
v_mul_f32 v242, v242, v237
v_mul_f32 v248, v248, v237
v_cvt_pk_bf16_f32 v165, v242, v248
ds_read_b64 v[250:251], v231 offset:1024
s_waitcnt lgkmcnt(0)
v_lshlrev_b32 v242, 16, v250
v_and_b32 v248, 0xffff0000, v250
v_mul_f32 v242, v242, v237
v_mul_f32 v248, v248, v237
v_cvt_pk_bf16_f32 v250, v242, v248
v_lshlrev_b32 v242, 16, v251
v_and_b32 v248, 0xffff0000, v251
v_mul_f32 v242, v242, v237
v_mul_f32 v248, v248, v237
v_cvt_pk_bf16_f32 v251, v242, v248
ds_write_b64 v231, v[250:251] offset:1024
s_waitcnt lgkmcnt(0)
ds_read_b64 v[250:251], v231 offset:1032
s_waitcnt lgkmcnt(0)
v_lshlrev_b32 v242, 16, v250
v_and_b32 v248, 0xffff0000, v250
v_mul_f32 v242, v242, v237
v_mul_f32 v248, v248, v237
v_cvt_pk_bf16_f32 v250, v242, v248
v_lshlrev_b32 v242, 16, v251
v_and_b32 v248, 0xffff0000, v251
v_mul_f32 v242, v242, v237
v_mul_f32 v248, v248, v237
v_cvt_pk_bf16_f32 v251, v242, v248
ds_write_b64 v231, v[250:251] offset:1032
s_waitcnt lgkmcnt(0)
ds_read_b64 v[250:251], v231 offset:5120
s_waitcnt lgkmcnt(0)
v_lshlrev_b32 v242, 16, v250
v_and_b32 v248, 0xffff0000, v250
v_mul_f32 v242, v242, v237
v_mul_f32 v248, v248, v237
v_cvt_pk_bf16_f32 v250, v242, v248
v_lshlrev_b32 v242, 16, v251
v_and_b32 v248, 0xffff0000, v251
v_mul_f32 v242, v242, v237
v_mul_f32 v248, v248, v237
v_cvt_pk_bf16_f32 v251, v242, v248
ds_write_b64 v231, v[250:251] offset:5120
s_waitcnt lgkmcnt(0)
ds_read_b64 v[250:251], v231 offset:5128
s_waitcnt lgkmcnt(0)
v_lshlrev_b32 v242, 16, v250
v_and_b32 v248, 0xffff0000, v250
v_mul_f32 v242, v242, v237
v_mul_f32 v248, v248, v237
v_cvt_pk_bf16_f32 v250, v242, v248
v_lshlrev_b32 v242, 16, v251
v_and_b32 v248, 0xffff0000, v251
v_mul_f32 v242, v242, v237
v_mul_f32 v248, v248, v237
v_cvt_pk_bf16_f32 v251, v242, v248
ds_write_b64 v231, v[250:251] offset:5128
s_waitcnt lgkmcnt(0)
v_exp_f32 v232, v148
v_exp_f32 v233, v149
v_exp_f32 v234, v150
v_exp_f32 v235, v151
s_nop 1
v_cvt_pk_bf16_f32 v166, v232, v233
v_cvt_pk_bf16_f32 v167, v234, v235
v_max_f32 v204, v152, v153
v_max3_f32 v204, v204, v154, v155
v_mov_b32 v205, v204
s_nop 1
v_permlane32_swap_b32 v204, v205
s_nop 1
v_max_f32 v204, v204, v205
v_mov_b32 v205, v204
s_nop 1
v_permlane16_swap_b32 v204, v205
s_nop 1
v_max_f32 v204, v204, v205
v_add_f32 v204, 40.0, v204
v_ceil_f32 v204, v204
v_max_f32 v204, 0, v204
v_sub_f32 v205, v226, v204
v_cvt_pk_bf16_f32 v205, v205, v205
v_and_b32 v205, 0xffff0000, v205
v_sub_f32 v204, v205, v226
v_mov_b32 v226, v205
v_exp_f32 v238, v204
v_bfi_b32 v67, v206, v205, v67
v_add_f32 v152, v152, v204
v_add_f32 v153, v153, v204
v_add_f32 v154, v154, v204
v_add_f32 v155, v155, v204
v_add_f32 v136, v136, v204
v_add_f32 v137, v137, v204
v_add_f32 v138, v138, v204
v_add_f32 v139, v139, v204
v_lshlrev_b32 v242, 16, v184
v_and_b32 v248, 0xffff0000, v184
v_mul_f32 v242, v242, v238
v_mul_f32 v248, v248, v238
v_cvt_pk_bf16_f32 v184, v242, v248
v_lshlrev_b32 v242, 16, v185
v_and_b32 v248, 0xffff0000, v185
v_mul_f32 v242, v242, v238
v_mul_f32 v248, v248, v238
v_cvt_pk_bf16_f32 v185, v242, v248
v_lshlrev_b32 v242, 16, v186
v_and_b32 v248, 0xffff0000, v186
v_mul_f32 v242, v242, v238
v_mul_f32 v248, v248, v238
v_cvt_pk_bf16_f32 v186, v242, v248
v_lshlrev_b32 v242, 16, v187
v_and_b32 v248, 0xffff0000, v187
v_mul_f32 v242, v242, v238
v_mul_f32 v248, v248, v238
v_cvt_pk_bf16_f32 v187, v242, v248
v_lshlrev_b32 v242, 16, v168
v_and_b32 v248, 0xffff0000, v168
v_mul_f32 v242, v242, v238
v_mul_f32 v248, v248, v238
v_cvt_pk_bf16_f32 v168, v242, v248
v_lshlrev_b32 v242, 16, v169
v_and_b32 v248, 0xffff0000, v169
v_mul_f32 v242, v242, v238
v_mul_f32 v248, v248, v238
v_cvt_pk_bf16_f32 v169, v242, v248
ds_read_b64 v[250:251], v231 offset:2048
s_waitcnt lgkmcnt(0)
v_lshlrev_b32 v242, 16, v250
v_and_b32 v248, 0xffff0000, v250
v_mul_f32 v242, v242, v238
v_mul_f32 v248, v248, v238
v_cvt_pk_bf16_f32 v250, v242, v248
v_lshlrev_b32 v242, 16, v251
v_and_b32 v248, 0xffff0000, v251
v_mul_f32 v242, v242, v238
v_mul_f32 v248, v248, v238
v_cvt_pk_bf16_f32 v251, v242, v248
ds_write_b64 v231, v[250:251] offset:2048
s_waitcnt lgkmcnt(0)
ds_read_b64 v[250:251], v231 offset:2056
s_waitcnt lgkmcnt(0)
v_lshlrev_b32 v242, 16, v250
v_and_b32 v248, 0xffff0000, v250
v_mul_f32 v242, v242, v238
v_mul_f32 v248, v248, v238
v_cvt_pk_bf16_f32 v250, v242, v248
v_lshlrev_b32 v242, 16, v251
v_and_b32 v248, 0xffff0000, v251
v_mul_f32 v242, v242, v238
v_mul_f32 v248, v248, v238
v_cvt_pk_bf16_f32 v251, v242, v248
ds_write_b64 v231, v[250:251] offset:2056
s_waitcnt lgkmcnt(0)
ds_read_b64 v[250:251], v231 offset:6144
s_waitcnt lgkmcnt(0)
v_lshlrev_b32 v242, 16, v250
v_and_b32 v248, 0xffff0000, v250
v_mul_f32 v242, v242, v238
v_mul_f32 v248, v248, v238
v_cvt_pk_bf16_f32 v250, v242, v248
v_lshlrev_b32 v242, 16, v251
v_and_b32 v248, 0xffff0000, v251
v_mul_f32 v242, v242, v238
v_mul_f32 v248, v248, v238
v_cvt_pk_bf16_f32 v251, v242, v248
ds_write_b64 v231, v[250:251] offset:6144
s_waitcnt lgkmcnt(0)
ds_read_b64 v[250:251], v231 offset:6152
s_waitcnt lgkmcnt(0)
v_lshlrev_b32 v242, 16, v250
v_and_b32 v248, 0xffff0000, v250
v_mul_f32 v242, v242, v238
v_mul_f32 v248, v248, v238
v_cvt_pk_bf16_f32 v250, v242, v248
v_lshlrev_b32 v242, 16, v251
v_and_b32 v248, 0xffff0000, v251
v_mul_f32 v242, v242, v238
v_mul_f32 v248, v248, v238
v_cvt_pk_bf16_f32 v251, v242, v248
ds_write_b64 v231, v[250:251] offset:6152
s_waitcnt lgkmcnt(0)
v_exp_f32 v232, v152
v_exp_f32 v233, v153
v_exp_f32 v234, v154
v_exp_f32 v235, v155
s_nop 1
v_cvt_pk_bf16_f32 v170, v232, v233
v_cvt_pk_bf16_f32 v171, v234, v235
v_max_f32 v204, v156, v157
v_max3_f32 v204, v204, v158, v159
v_mov_b32 v205, v204
s_nop 1
v_permlane32_swap_b32 v204, v205
s_nop 1
v_max_f32 v204, v204, v205
v_mov_b32 v205, v204
s_nop 1
v_permlane16_swap_b32 v204, v205
s_nop 1
v_max_f32 v204, v204, v205
v_add_f32 v204, 40.0, v204
v_ceil_f32 v204, v204
v_max_f32 v204, 0, v204
v_sub_f32 v205, v227, v204
v_cvt_pk_bf16_f32 v205, v205, v205
v_and_b32 v205, 0xffff0000, v205
v_sub_f32 v204, v205, v227
v_mov_b32 v227, v205
v_exp_f32 v239, v204
v_bfi_b32 v99, v206, v205, v99
v_add_f32 v156, v156, v204
v_add_f32 v157, v157, v204
v_add_f32 v158, v158, v204
v_add_f32 v159, v159, v204
v_add_f32 v140, v140, v204
v_add_f32 v141, v141, v204
v_add_f32 v142, v142, v204
v_add_f32 v143, v143, v204
v_lshlrev_b32 v242, 16, v188
v_and_b32 v248, 0xffff0000, v188
v_mul_f32 v242, v242, v239
v_mul_f32 v248, v248, v239
v_cvt_pk_bf16_f32 v188, v242, v248
v_lshlrev_b32 v242, 16, v189
v_and_b32 v248, 0xffff0000, v189
v_mul_f32 v242, v242, v239
v_mul_f32 v248, v248, v239
v_cvt_pk_bf16_f32 v189, v242, v248
v_lshlrev_b32 v242, 16, v190
v_and_b32 v248, 0xffff0000, v190
v_mul_f32 v242, v242, v239
v_mul_f32 v248, v248, v239
v_cvt_pk_bf16_f32 v190, v242, v248
v_lshlrev_b32 v242, 16, v191
v_and_b32 v248, 0xffff0000, v191
v_mul_f32 v242, v242, v239
v_mul_f32 v248, v248, v239
v_cvt_pk_bf16_f32 v191, v242, v248
v_lshlrev_b32 v242, 16, v172
v_and_b32 v248, 0xffff0000, v172
v_mul_f32 v242, v242, v239
v_mul_f32 v248, v248, v239
v_cvt_pk_bf16_f32 v172, v242, v248
v_lshlrev_b32 v242, 16, v173
v_and_b32 v248, 0xffff0000, v173
v_mul_f32 v242, v242, v239
v_mul_f32 v248, v248, v239
v_cvt_pk_bf16_f32 v173, v242, v248
ds_read_b64 v[250:251], v231 offset:3072
s_waitcnt lgkmcnt(0)
v_lshlrev_b32 v242, 16, v250
v_and_b32 v248, 0xffff0000, v250
v_mul_f32 v242, v242, v239
v_mul_f32 v248, v248, v239
v_cvt_pk_bf16_f32 v250, v242, v248
v_lshlrev_b32 v242, 16, v251
v_and_b32 v248, 0xffff0000, v251
v_mul_f32 v242, v242, v239
v_mul_f32 v248, v248, v239
v_cvt_pk_bf16_f32 v251, v242, v248
ds_write_b64 v231, v[250:251] offset:3072
s_waitcnt lgkmcnt(0)
ds_read_b64 v[250:251], v231 offset:3080
s_waitcnt lgkmcnt(0)
v_lshlrev_b32 v242, 16, v250
v_and_b32 v248, 0xffff0000, v250
v_mul_f32 v242, v242, v239
v_mul_f32 v248, v248, v239
v_cvt_pk_bf16_f32 v250, v242, v248
v_lshlrev_b32 v242, 16, v251
v_and_b32 v248, 0xffff0000, v251
v_mul_f32 v242, v242, v239
v_mul_f32 v248, v248, v239
v_cvt_pk_bf16_f32 v251, v242, v248
ds_write_b64 v231, v[250:251] offset:3080
s_waitcnt lgkmcnt(0)
ds_read_b64 v[250:251], v231 offset:7168
s_waitcnt lgkmcnt(0)
v_lshlrev_b32 v242, 16, v250
v_and_b32 v248, 0xffff0000, v250
v_mul_f32 v242, v242, v239
v_mul_f32 v248, v248, v239
v_cvt_pk_bf16_f32 v250, v242, v248
v_lshlrev_b32 v242, 16, v251
v_and_b32 v248, 0xffff0000, v251
v_mul_f32 v242, v242, v239
v_mul_f32 v248, v248, v239
v_cvt_pk_bf16_f32 v251, v242, v248
ds_write_b64 v231, v[250:251] offset:7168
s_waitcnt lgkmcnt(0)
ds_read_b64 v[250:251], v231 offset:7176
s_waitcnt lgkmcnt(0)
v_lshlrev_b32 v242, 16, v250
v_and_b32 v248, 0xffff0000, v250
v_mul_f32 v242, v242, v239
v_mul_f32 v248, v248, v239
v_cvt_pk_bf16_f32 v250, v242, v248
v_lshlrev_b32 v242, 16, v251
v_and_b32 v248, 0xffff0000, v251
v_mul_f32 v242, v242, v239
v_mul_f32 v248, v248, v239
v_cvt_pk_bf16_f32 v251, v242, v248
ds_write_b64 v231, v[250:251] offset:7176
s_waitcnt lgkmcnt(0)
v_exp_f32 v232, v156
v_exp_f32 v233, v157
v_exp_f32 v234, v158
v_exp_f32 v235, v159
s_nop 1
v_cvt_pk_bf16_f32 v174, v232, v233
v_cvt_pk_bf16_f32 v175, v234, v235
s_branch L2_rare_common
L2_rare_site10:
s_mov_b32 s36, 10
s_branch L2_rare_t1_4
L2_rare_t1_4:
s_nop 15
s_nop 15
s_waitcnt lgkmcnt(0)
v_lshrrev_b32 v206, 8, v243
v_add_u32 v206, 1, v206
v_lshrrev_b32 v206, 2, v206
v_sub_u32 v206, 0, v206
v_and_b32 v206, 0xffff0000, v206
v_max_f32 v204, v128, v129
v_max3_f32 v204, v204, v130, v131
v_mov_b32 v205, v204
s_nop 1
v_permlane32_swap_b32 v204, v205
s_nop 1
v_max_f32 v204, v204, v205
v_mov_b32 v205, v204
s_nop 1
v_permlane16_swap_b32 v204, v205
s_nop 1
v_max_f32 v204, v204, v205
v_add_f32 v204, 40.0, v204
v_ceil_f32 v204, v204
v_max_f32 v204, 0, v204
v_sub_f32 v205, v224, v204
v_cvt_pk_bf16_f32 v205, v205, v205
v_and_b32 v205, 0xffff0000, v205
v_sub_f32 v204, v205, v224
v_mov_b32 v224, v205
v_exp_f32 v236, v204
v_add_f32 v128, v128, v204
v_add_f32 v129, v129, v204
v_add_f32 v130, v130, v204
v_add_f32 v131, v131, v204
v_add_f32 v144, v144, v204
v_add_f32 v145, v145, v204
v_add_f32 v146, v146, v204
v_add_f32 v147, v147, v204
v_lshlrev_b32 v242, 16, v4
v_and_b32 v248, 0xffff0000, v4
v_mul_f32 v242, v242, v236
v_mul_f32 v248, v248, v236
v_cvt_pk_bf16_f32 v4, v242, v248
v_lshlrev_b32 v242, 16, v5
v_and_b32 v248, 0xffff0000, v5
v_mul_f32 v242, v242, v236
v_mul_f32 v248, v248, v236
v_cvt_pk_bf16_f32 v5, v242, v248
v_lshlrev_b32 v242, 16, v6
v_and_b32 v248, 0xffff0000, v6
v_mul_f32 v242, v242, v236
v_mul_f32 v248, v248, v236
v_cvt_pk_bf16_f32 v6, v242, v248
v_lshlrev_b32 v242, 16, v7
v_and_b32 v248, 0xffff0000, v7
v_mul_f32 v242, v242, v236
v_mul_f32 v248, v248, v236
v_cvt_pk_bf16_f32 v7, v242, v248
v_lshlrev_b32 v242, 16, v8
v_and_b32 v248, 0xffff0000, v8
v_mul_f32 v242, v242, v236
v_mul_f32 v248, v248, v236
v_cvt_pk_bf16_f32 v8, v242, v248
v_lshlrev_b32 v242, 16, v9
v_and_b32 v248, 0xffff0000, v9
v_mul_f32 v242, v242, v236
v_mul_f32 v248, v248, v236
v_cvt_pk_bf16_f32 v9, v242, v248
v_lshlrev_b32 v242, 16, v10
v_and_b32 v248, 0xffff0000, v10
v_mul_f32 v242, v242, v236
v_mul_f32 v248, v248, v236
v_cvt_pk_bf16_f32 v10, v242, v248
v_lshlrev_b32 v242, 16, v11
v_and_b32 v248, 0xffff0000, v11
v_mul_f32 v242, v242, v236
v_mul_f32 v248, v248, v236
v_cvt_pk_bf16_f32 v11, v242, v248
v_lshlrev_b32 v242, 16, v176
v_and_b32 v248, 0xffff0000, v176
v_mul_f32 v242, v242, v236
v_mul_f32 v248, v248, v236
v_cvt_pk_bf16_f32 v176, v242, v248
v_lshlrev_b32 v242, 16, v177
v_and_b32 v248, 0xffff0000, v177
v_mul_f32 v242, v242, v236
v_mul_f32 v248, v248, v236
v_cvt_pk_bf16_f32 v177, v242, v248
v_lshlrev_b32 v242, 16, v178
v_and_b32 v248, 0xffff0000, v178
v_mul_f32 v242, v242, v236
v_mul_f32 v248, v248, v236
v_cvt_pk_bf16_f32 v178, v242, v248
v_lshlrev_b32 v242, 16, v179
v_and_b32 v248, 0xffff0000, v179
v_mul_f32 v242, v242, v236
v_mul_f32 v248, v248, v236
v_cvt_pk_bf16_f32 v179, v242, v248
v_lshlrev_b32 v242, 16, v160
v_and_b32 v248, 0xffff0000, v160
v_mul_f32 v242, v242, v236
v_mul_f32 v248, v248, v236
v_cvt_pk_bf16_f32 v160, v242, v248
v_lshlrev_b32 v242, 16, v161
v_and_b32 v248, 0xffff0000, v161
v_mul_f32 v242, v242, v236
v_mul_f32 v248, v248, v236
v_cvt_pk_bf16_f32 v161, v242, v248
v_lshlrev_b32 v242, 16, v162
v_and_b32 v248, 0xffff0000, v162
v_mul_f32 v242, v242, v236
v_mul_f32 v248, v248, v236
v_cvt_pk_bf16_f32 v162, v242, v248
v_lshlrev_b32 v242, 16, v163
v_and_b32 v248, 0xffff0000, v163
v_mul_f32 v242, v242, v236
v_mul_f32 v248, v248, v236
v_cvt_pk_bf16_f32 v163, v242, v248
v_exp_f32 v232, v128
v_exp_f32 v233, v129
v_exp_f32 v234, v130
v_exp_f32 v235, v131
s_nop 1
v_cvt_pk_bf16_f32 v0, v232, v233
v_cvt_pk_bf16_f32 v1, v234, v235
v_max_f32 v204, v132, v133
v_max3_f32 v204, v204, v134, v135
v_mov_b32 v205, v204
s_nop 1
v_permlane32_swap_b32 v204, v205
s_nop 1
v_max_f32 v204, v204, v205
v_mov_b32 v205, v204
s_nop 1
v_permlane16_swap_b32 v204, v205
s_nop 1
v_max_f32 v204, v204, v205
v_add_f32 v204, 40.0, v204
v_ceil_f32 v204, v204
v_max_f32 v204, 0, v204
v_sub_f32 v205, v225, v204
v_cvt_pk_bf16_f32 v205, v205, v205
v_and_b32 v205, 0xffff0000, v205
v_sub_f32 v204, v205, v225
v_mov_b32 v225, v205
v_exp_f32 v237, v204
v_add_f32 v132, v132, v204
v_add_f32 v133, v133, v204
v_add_f32 v134, v134, v204
v_add_f32 v135, v135, v204
v_add_f32 v148, v148, v204
v_add_f32 v149, v149, v204
v_add_f32 v150, v150, v204
v_add_f32 v151, v151, v204
v_lshlrev_b32 v242, 16, v36
v_and_b32 v248, 0xffff0000, v36
v_mul_f32 v242, v242, v237
v_mul_f32 v248, v248, v237
v_cvt_pk_bf16_f32 v36, v242, v248
v_lshlrev_b32 v242, 16, v37
v_and_b32 v248, 0xffff0000, v37
v_mul_f32 v242, v242, v237
v_mul_f32 v248, v248, v237
v_cvt_pk_bf16_f32 v37, v242, v248
v_lshlrev_b32 v242, 16, v38
v_and_b32 v248, 0xffff0000, v38
v_mul_f32 v242, v242, v237
v_mul_f32 v248, v248, v237
v_cvt_pk_bf16_f32 v38, v242, v248
v_lshlrev_b32 v242, 16, v39
v_and_b32 v248, 0xffff0000, v39
v_mul_f32 v242, v242, v237
v_mul_f32 v248, v248, v237
v_cvt_pk_bf16_f32 v39, v242, v248
v_lshlrev_b32 v242, 16, v40
v_and_b32 v248, 0xffff0000, v40
v_mul_f32 v242, v242, v237
v_mul_f32 v248, v248, v237
v_cvt_pk_bf16_f32 v40, v242, v248
v_lshlrev_b32 v242, 16, v41
v_and_b32 v248, 0xffff0000, v41
v_mul_f32 v242, v242, v237
v_mul_f32 v248, v248, v237
v_cvt_pk_bf16_f32 v41, v242, v248
v_lshlrev_b32 v242, 16, v42
v_and_b32 v248, 0xffff0000, v42
v_mul_f32 v242, v242, v237
v_mul_f32 v248, v248, v237
v_cvt_pk_bf16_f32 v42, v242, v248
v_lshlrev_b32 v242, 16, v43
v_and_b32 v248, 0xffff0000, v43
v_mul_f32 v242, v242, v237
v_mul_f32 v248, v248, v237
v_cvt_pk_bf16_f32 v43, v242, v248
v_lshlrev_b32 v242, 16, v180
v_and_b32 v248, 0xffff0000, v180
v_mul_f32 v242, v242, v237
v_mul_f32 v248, v248, v237
v_cvt_pk_bf16_f32 v180, v242, v248
v_lshlrev_b32 v242, 16, v181
v_and_b32 v248, 0xffff0000, v181
v_mul_f32 v242, v242, v237
v_mul_f32 v248, v248, v237
v_cvt_pk_bf16_f32 v181, v242, v248
v_lshlrev_b32 v242, 16, v182
v_and_b32 v248, 0xffff0000, v182
v_mul_f32 v242, v242, v237
v_mul_f32 v248, v248, v237
v_cvt_pk_bf16_f32 v182, v242, v248
v_lshlrev_b32 v242, 16, v183
v_and_b32 v248, 0xffff0000, v183
v_mul_f32 v242, v242, v237
v_mul_f32 v248, v248, v237
v_cvt_pk_bf16_f32 v183, v242, v248
v_lshlrev_b32 v242, 16, v164
v_and_b32 v248, 0xffff0000, v164
v_mul_f32 v242, v242, v237
v_mul_f32 v248, v248, v237
v_cvt_pk_bf16_f32 v164, v242, v248
v_lshlrev_b32 v242, 16, v165
v_and_b32 v248, 0xffff0000, v165
v_mul_f32 v242, v242, v237
v_mul_f32 v248, v248, v237
v_cvt_pk_bf16_f32 v165, v242, v248
v_lshlrev_b32 v242, 16, v166
v_and_b32 v248, 0xffff0000, v166
v_mul_f32 v242, v242, v237
v_mul_f32 v248, v248, v237
v_cvt_pk_bf16_f32 v166, v242, v248
v_lshlrev_b32 v242, 16, v167
v_and_b32 v248, 0xffff0000, v167
v_mul_f32 v242, v242, v237
v_mul_f32 v248, v248, v237
v_cvt_pk_bf16_f32 v167, v242, v248
v_exp_f32 v232, v132
v_exp_f32 v233, v133
v_exp_f32 v234, v134
v_exp_f32 v235, v135
s_nop 1
v_cvt_pk_bf16_f32 v32, v232, v233
v_cvt_pk_bf16_f32 v33, v234, v235
v_max_f32 v204, v136, v137
v_max3_f32 v204, v204, v138, v139
v_mov_b32 v205, v204
s_nop 1
v_permlane32_swap_b32 v204, v205
s_nop 1
v_max_f32 v204, v204, v205
v_mov_b32 v205, v204
s_nop 1
v_permlane16_swap_b32 v204, v205
s_nop 1
v_max_f32 v204, v204, v205
v_add_f32 v204, 40.0, v204
v_ceil_f32 v204, v204
v_max_f32 v204, 0, v204
v_sub_f32 v205, v226, v204
v_cvt_pk_bf16_f32 v205, v205, v205
v_and_b32 v205, 0xffff0000, v205
v_sub_f32 v204, v205, v226
v_mov_b32 v226, v205
v_exp_f32 v238, v204
v_add_f32 v136, v136, v204
v_add_f32 v137, v137, v204
v_add_f32 v138, v138, v204
v_add_f32 v139, v139, v204
v_add_f32 v152, v152, v204
v_add_f32 v153, v153, v204
v_add_f32 v154, v154, v204
v_add_f32 v155, v155, v204
v_lshlrev_b32 v242, 16, v68
v_and_b32 v248, 0xffff0000, v68
v_mul_f32 v242, v242, v238
v_mul_f32 v248, v248, v238
v_cvt_pk_bf16_f32 v68, v242, v248
v_lshlrev_b32 v242, 16, v69
v_and_b32 v248, 0xffff0000, v69
v_mul_f32 v242, v242, v238
v_mul_f32 v248, v248, v238
v_cvt_pk_bf16_f32 v69, v242, v248
v_lshlrev_b32 v242, 16, v70
v_and_b32 v248, 0xffff0000, v70
v_mul_f32 v242, v242, v238
v_mul_f32 v248, v248, v238
v_cvt_pk_bf16_f32 v70, v242, v248
v_lshlrev_b32 v242, 16, v71
v_and_b32 v248, 0xffff0000, v71
v_mul_f32 v242, v242, v238
v_mul_f32 v248, v248, v238
v_cvt_pk_bf16_f32 v71, v242, v248
v_lshlrev_b32 v242, 16, v72
v_and_b32 v248, 0xffff0000, v72
v_mul_f32 v242, v242, v238
v_mul_f32 v248, v248, v238
v_cvt_pk_bf16_f32 v72, v242, v248
v_lshlrev_b32 v242, 16, v73
v_and_b32 v248, 0xffff0000, v73
v_mul_f32 v242, v242, v238
v_mul_f32 v248, v248, v238
v_cvt_pk_bf16_f32 v73, v242, v248
v_lshlrev_b32 v242, 16, v74
v_and_b32 v248, 0xffff0000, v74
v_mul_f32 v242, v242, v238
v_mul_f32 v248, v248, v238
v_cvt_pk_bf16_f32 v74, v242, v248
v_lshlrev_b32 v242, 16, v75
v_and_b32 v248, 0xffff0000, v75
v_mul_f32 v242, v242, v238
v_mul_f32 v248, v248, v238
v_cvt_pk_bf16_f32 v75, v242, v248
v_lshlrev_b32 v242, 16, v184
v_and_b32 v248, 0xffff0000, v184
v_mul_f32 v242, v242, v238
v_mul_f32 v248, v248, v238
v_cvt_pk_bf16_f32 v184, v242, v248
v_lshlrev_b32 v242, 16, v185
v_and_b32 v248, 0xffff0000, v185
v_mul_f32 v242, v242, v238
v_mul_f32 v248, v248, v238
v_cvt_pk_bf16_f32 v185, v242, v248
v_lshlrev_b32 v242, 16, v186
v_and_b32 v248, 0xffff0000, v186
v_mul_f32 v242, v242, v238
v_mul_f32 v248, v248, v238
v_cvt_pk_bf16_f32 v186, v242, v248
v_lshlrev_b32 v242, 16, v187
v_and_b32 v248, 0xffff0000, v187
v_mul_f32 v242, v242, v238
v_mul_f32 v248, v248, v238
v_cvt_pk_bf16_f32 v187, v242, v248
v_lshlrev_b32 v242, 16, v168
v_and_b32 v248, 0xffff0000, v168
v_mul_f32 v242, v242, v238
v_mul_f32 v248, v248, v238
v_cvt_pk_bf16_f32 v168, v242, v248
v_lshlrev_b32 v242, 16, v169
v_and_b32 v248, 0xffff0000, v169
v_mul_f32 v242, v242, v238
v_mul_f32 v248, v248, v238
v_cvt_pk_bf16_f32 v169, v242, v248
v_lshlrev_b32 v242, 16, v170
v_and_b32 v248, 0xffff0000, v170
v_mul_f32 v242, v242, v238
v_mul_f32 v248, v248, v238
v_cvt_pk_bf16_f32 v170, v242, v248
v_lshlrev_b32 v242, 16, v171
v_and_b32 v248, 0xffff0000, v171
v_mul_f32 v242, v242, v238
v_mul_f32 v248, v248, v238
v_cvt_pk_bf16_f32 v171, v242, v248
v_exp_f32 v232, v136
v_exp_f32 v233, v137
v_exp_f32 v234, v138
v_exp_f32 v235, v139
s_nop 1
v_cvt_pk_bf16_f32 v64, v232, v233
v_cvt_pk_bf16_f32 v65, v234, v235
v_max_f32 v204, v140, v141
v_max3_f32 v204, v204, v142, v143
v_mov_b32 v205, v204
s_nop 1
v_permlane32_swap_b32 v204, v205
s_nop 1
v_max_f32 v204, v204, v205
v_mov_b32 v205, v204
s_nop 1
v_permlane16_swap_b32 v204, v205
s_nop 1
v_max_f32 v204, v204, v205
v_add_f32 v204, 40.0, v204
v_ceil_f32 v204, v204
v_max_f32 v204, 0, v204
v_sub_f32 v205, v227, v204
v_cvt_pk_bf16_f32 v205, v205, v205
v_and_b32 v205, 0xffff0000, v205
v_sub_f32 v204, v205, v227
v_mov_b32 v227, v205
v_exp_f32 v239, v204
v_add_f32 v140, v140, v204
v_add_f32 v141, v141, v204
v_add_f32 v142, v142, v204
v_add_f32 v143, v143, v204
v_add_f32 v156, v156, v204
v_add_f32 v157, v157, v204
v_add_f32 v158, v158, v204
v_add_f32 v159, v159, v204
v_lshlrev_b32 v242, 16, v100
v_and_b32 v248, 0xffff0000, v100
v_mul_f32 v242, v242, v239
v_mul_f32 v248, v248, v239
v_cvt_pk_bf16_f32 v100, v242, v248
v_lshlrev_b32 v242, 16, v101
v_and_b32 v248, 0xffff0000, v101
v_mul_f32 v242, v242, v239
v_mul_f32 v248, v248, v239
v_cvt_pk_bf16_f32 v101, v242, v248
v_lshlrev_b32 v242, 16, v102
v_and_b32 v248, 0xffff0000, v102
v_mul_f32 v242, v242, v239
v_mul_f32 v248, v248, v239
v_cvt_pk_bf16_f32 v102, v242, v248
v_lshlrev_b32 v242, 16, v103
v_and_b32 v248, 0xffff0000, v103
v_mul_f32 v242, v242, v239
v_mul_f32 v248, v248, v239
v_cvt_pk_bf16_f32 v103, v242, v248
v_lshlrev_b32 v242, 16, v104
v_and_b32 v248, 0xffff0000, v104
v_mul_f32 v242, v242, v239
v_mul_f32 v248, v248, v239
v_cvt_pk_bf16_f32 v104, v242, v248
v_lshlrev_b32 v242, 16, v105
v_and_b32 v248, 0xffff0000, v105
v_mul_f32 v242, v242, v239
v_mul_f32 v248, v248, v239
v_cvt_pk_bf16_f32 v105, v242, v248
v_lshlrev_b32 v242, 16, v106
v_and_b32 v248, 0xffff0000, v106
v_mul_f32 v242, v242, v239
v_mul_f32 v248, v248, v239
v_cvt_pk_bf16_f32 v106, v242, v248
v_lshlrev_b32 v242, 16, v107
v_and_b32 v248, 0xffff0000, v107
v_mul_f32 v242, v242, v239
v_mul_f32 v248, v248, v239
v_cvt_pk_bf16_f32 v107, v242, v248
v_lshlrev_b32 v242, 16, v188
v_and_b32 v248, 0xffff0000, v188
v_mul_f32 v242, v242, v239
v_mul_f32 v248, v248, v239
v_cvt_pk_bf16_f32 v188, v242, v248
v_lshlrev_b32 v242, 16, v189
v_and_b32 v248, 0xffff0000, v189
v_mul_f32 v242, v242, v239
v_mul_f32 v248, v248, v239
v_cvt_pk_bf16_f32 v189, v242, v248
v_lshlrev_b32 v242, 16, v190
v_and_b32 v248, 0xffff0000, v190
v_mul_f32 v242, v242, v239
v_mul_f32 v248, v248, v239
v_cvt_pk_bf16_f32 v190, v242, v248
v_lshlrev_b32 v242, 16, v191
v_and_b32 v248, 0xffff0000, v191
v_mul_f32 v242, v242, v239
v_mul_f32 v248, v248, v239
v_cvt_pk_bf16_f32 v191, v242, v248
v_lshlrev_b32 v242, 16, v172
v_and_b32 v248, 0xffff0000, v172
v_mul_f32 v242, v242, v239
v_mul_f32 v248, v248, v239
v_cvt_pk_bf16_f32 v172, v242, v248
v_lshlrev_b32 v242, 16, v173
v_and_b32 v248, 0xffff0000, v173
v_mul_f32 v242, v242, v239
v_mul_f32 v248, v248, v239
v_cvt_pk_bf16_f32 v173, v242, v248
v_lshlrev_b32 v242, 16, v174
v_and_b32 v248, 0xffff0000, v174
v_mul_f32 v242, v242, v239
v_mul_f32 v248, v248, v239
v_cvt_pk_bf16_f32 v174, v242, v248
v_lshlrev_b32 v242, 16, v175
v_and_b32 v248, 0xffff0000, v175
v_mul_f32 v242, v242, v239
v_mul_f32 v248, v248, v239
v_cvt_pk_bf16_f32 v175, v242, v248
v_exp_f32 v232, v140
v_exp_f32 v233, v141
v_exp_f32 v234, v142
v_exp_f32 v235, v143
s_nop 1
v_cvt_pk_bf16_f32 v96, v232, v233
v_cvt_pk_bf16_f32 v97, v234, v235
s_branch L2_rare_common
L2_rare_site11:
s_mov_b32 s36, 11
s_branch L2_rare_t1_5
L2_rare_t1_5:
s_nop 15
s_nop 15
s_waitcnt lgkmcnt(0)
v_lshrrev_b32 v206, 8, v243
v_add_u32 v206, 1, v206
v_lshrrev_b32 v206, 2, v206
v_sub_u32 v206, 0, v206
v_and_b32 v206, 0xffff0000, v206
v_max_f32 v204, v144, v145
v_max3_f32 v204, v204, v146, v147
v_mov_b32 v205, v204
s_nop 1
v_permlane32_swap_b32 v204, v205
s_nop 1
v_max_f32 v204, v204, v205
v_mov_b32 v205, v204
s_nop 1
v_permlane16_swap_b32 v204, v205
s_nop 1
v_max_f32 v204, v204, v205
v_add_f32 v204, 40.0, v204
v_ceil_f32 v204, v204
v_max_f32 v204, 0, v204
v_sub_f32 v205, v224, v204
v_cvt_pk_bf16_f32 v205, v205, v205
v_and_b32 v205, 0xffff0000, v205
v_sub_f32 v204, v205, v224
v_mov_b32 v224, v205
v_exp_f32 v236, v204
v_add_f32 v144, v144, v204
v_add_f32 v145, v145, v204
v_add_f32 v146, v146, v204
v_add_f32 v147, v147, v204
v_add_f32 v128, v128, v204
v_add_f32 v129, v129, v204
v_add_f32 v130, v130, v204
v_add_f32 v131, v131, v204
v_lshlrev_b32 v242, 16, v4
v_and_b32 v248, 0xffff0000, v4
v_mul_f32 v242, v242, v236
v_mul_f32 v248, v248, v236
v_cvt_pk_bf16_f32 v4, v242, v248
v_lshlrev_b32 v242, 16, v5
v_and_b32 v248, 0xffff0000, v5
v_mul_f32 v242, v242, v236
v_mul_f32 v248, v248, v236
v_cvt_pk_bf16_f32 v5, v242, v248
v_lshlrev_b32 v242, 16, v6
v_and_b32 v248, 0xffff0000, v6
v_mul_f32 v242, v242, v236
v_mul_f32 v248, v248, v236
v_cvt_pk_bf16_f32 v6, v242, v248
v_lshlrev_b32 v242, 16, v7
v_and_b32 v248, 0xffff0000, v7
v_mul_f32 v242, v242, v236
v_mul_f32 v248, v248, v236
v_cvt_pk_bf16_f32 v7, v242, v248
v_lshlrev_b32 v242, 16, v8
v_and_b32 v248, 0xffff0000, v8
v_mul_f32 v242, v242, v236
v_mul_f32 v248, v248, v236
v_cvt_pk_bf16_f32 v8, v242, v248
v_lshlrev_b32 v242, 16, v9
v_and_b32 v248, 0xffff0000, v9
v_mul_f32 v242, v242, v236
v_mul_f32 v248, v248, v236
v_cvt_pk_bf16_f32 v9, v242, v248
v_lshlrev_b32 v242, 16, v10
v_and_b32 v248, 0xffff0000, v10
v_mul_f32 v242, v242, v236
v_mul_f32 v248, v248, v236
v_cvt_pk_bf16_f32 v10, v242, v248
v_lshlrev_b32 v242, 16, v11
v_and_b32 v248, 0xffff0000, v11
v_mul_f32 v242, v242, v236
v_mul_f32 v248, v248, v236
v_cvt_pk_bf16_f32 v11, v242, v248
v_lshlrev_b32 v242, 16, v176
v_and_b32 v248, 0xffff0000, v176
v_mul_f32 v242, v242, v236
v_mul_f32 v248, v248, v236
v_cvt_pk_bf16_f32 v176, v242, v248
v_lshlrev_b32 v242, 16, v177
v_and_b32 v248, 0xffff0000, v177
v_mul_f32 v242, v242, v236
v_mul_f32 v248, v248, v236
v_cvt_pk_bf16_f32 v177, v242, v248
v_lshlrev_b32 v242, 16, v178
v_and_b32 v248, 0xffff0000, v178
v_mul_f32 v242, v242, v236
v_mul_f32 v248, v248, v236
v_cvt_pk_bf16_f32 v178, v242, v248
v_lshlrev_b32 v242, 16, v179
v_and_b32 v248, 0xffff0000, v179
v_mul_f32 v242, v242, v236
v_mul_f32 v248, v248, v236
v_cvt_pk_bf16_f32 v179, v242, v248
v_lshlrev_b32 v242, 16, v160
v_and_b32 v248, 0xffff0000, v160
v_mul_f32 v242, v242, v236
v_mul_f32 v248, v248, v236
v_cvt_pk_bf16_f32 v160, v242, v248
v_lshlrev_b32 v242, 16, v161
v_and_b32 v248, 0xffff0000, v161
v_mul_f32 v242, v242, v236
v_mul_f32 v248, v248, v236
v_cvt_pk_bf16_f32 v161, v242, v248
v_lshlrev_b32 v242, 16, v162
v_and_b32 v248, 0xffff0000, v162
v_mul_f32 v242, v242, v236
v_mul_f32 v248, v248, v236
v_cvt_pk_bf16_f32 v162, v242, v248
v_lshlrev_b32 v242, 16, v163
v_and_b32 v248, 0xffff0000, v163
v_mul_f32 v242, v242, v236
v_mul_f32 v248, v248, v236
v_cvt_pk_bf16_f32 v163, v242, v248
v_lshlrev_b32 v242, 16, v0
v_and_b32 v248, 0xffff0000, v0
v_mul_f32 v242, v242, v236
v_mul_f32 v248, v248, v236
v_cvt_pk_bf16_f32 v0, v242, v248
v_lshlrev_b32 v242, 16, v1
v_and_b32 v248, 0xffff0000, v1
v_mul_f32 v242, v242, v236
v_mul_f32 v248, v248, v236
v_cvt_pk_bf16_f32 v1, v242, v248
v_exp_f32 v232, v144
v_exp_f32 v233, v145
v_exp_f32 v234, v146
v_exp_f32 v235, v147
s_nop 1
v_cvt_pk_bf16_f32 v2, v232, v233
v_cvt_pk_bf16_f32 v3, v234, v235
v_max_f32 v204, v148, v149
v_max3_f32 v204, v204, v150, v151
v_mov_b32 v205, v204
s_nop 1
v_permlane32_swap_b32 v204, v205
s_nop 1
v_max_f32 v204, v204, v205
v_mov_b32 v205, v204
s_nop 1
v_permlane16_swap_b32 v204, v205
s_nop 1
v_max_f32 v204, v204, v205
v_add_f32 v204, 40.0, v204
v_ceil_f32 v204, v204
v_max_f32 v204, 0, v204
v_sub_f32 v205, v225, v204
v_cvt_pk_bf16_f32 v205, v205, v205
v_and_b32 v205, 0xffff0000, v205
v_sub_f32 v204, v205, v225
v_mov_b32 v225, v205
v_exp_f32 v237, v204
v_add_f32 v148, v148, v204
v_add_f32 v149, v149, v204
v_add_f32 v150, v150, v204
v_add_f32 v151, v151, v204
v_add_f32 v132, v132, v204
v_add_f32 v133, v133, v204
v_add_f32 v134, v134, v204
v_add_f32 v135, v135, v204
v_lshlrev_b32 v242, 16, v36
v_and_b32 v248, 0xffff0000, v36
v_mul_f32 v242, v242, v237
v_mul_f32 v248, v248, v237
v_cvt_pk_bf16_f32 v36, v242, v248
v_lshlrev_b32 v242, 16, v37
v_and_b32 v248, 0xffff0000, v37
v_mul_f32 v242, v242, v237
v_mul_f32 v248, v248, v237
v_cvt_pk_bf16_f32 v37, v242, v248
v_lshlrev_b32 v242, 16, v38
v_and_b32 v248, 0xffff0000, v38
v_mul_f32 v242, v242, v237
v_mul_f32 v248, v248, v237
v_cvt_pk_bf16_f32 v38, v242, v248
v_lshlrev_b32 v242, 16, v39
v_and_b32 v248, 0xffff0000, v39
v_mul_f32 v242, v242, v237
v_mul_f32 v248, v248, v237
v_cvt_pk_bf16_f32 v39, v242, v248
v_lshlrev_b32 v242, 16, v40
v_and_b32 v248, 0xffff0000, v40
v_mul_f32 v242, v242, v237
v_mul_f32 v248, v248, v237
v_cvt_pk_bf16_f32 v40, v242, v248
v_lshlrev_b32 v242, 16, v41
v_and_b32 v248, 0xffff0000, v41
v_mul_f32 v242, v242, v237
v_mul_f32 v248, v248, v237
v_cvt_pk_bf16_f32 v41, v242, v248
v_lshlrev_b32 v242, 16, v42
v_and_b32 v248, 0xffff0000, v42
v_mul_f32 v242, v242, v237
v_mul_f32 v248, v248, v237
v_cvt_pk_bf16_f32 v42, v242, v248
v_lshlrev_b32 v242, 16, v43
v_and_b32 v248, 0xffff0000, v43
v_mul_f32 v242, v242, v237
v_mul_f32 v248, v248, v237
v_cvt_pk_bf16_f32 v43, v242, v248
v_lshlrev_b32 v242, 16, v180
v_and_b32 v248, 0xffff0000, v180
v_mul_f32 v242, v242, v237
v_mul_f32 v248, v248, v237
v_cvt_pk_bf16_f32 v180, v242, v248
v_lshlrev_b32 v242, 16, v181
v_and_b32 v248, 0xffff0000, v181
v_mul_f32 v242, v242, v237
v_mul_f32 v248, v248, v237
v_cvt_pk_bf16_f32 v181, v242, v248
v_lshlrev_b32 v242, 16, v182
v_and_b32 v248, 0xffff0000, v182
v_mul_f32 v242, v242, v237
v_mul_f32 v248, v248, v237
v_cvt_pk_bf16_f32 v182, v242, v248
v_lshlrev_b32 v242, 16, v183
v_and_b32 v248, 0xffff0000, v183
v_mul_f32 v242, v242, v237
v_mul_f32 v248, v248, v237
v_cvt_pk_bf16_f32 v183, v242, v248
v_lshlrev_b32 v242, 16, v164
v_and_b32 v248, 0xffff0000, v164
v_mul_f32 v242, v242, v237
v_mul_f32 v248, v248, v237
v_cvt_pk_bf16_f32 v164, v242, v248
v_lshlrev_b32 v242, 16, v165
v_and_b32 v248, 0xffff0000, v165
v_mul_f32 v242, v242, v237
v_mul_f32 v248, v248, v237
v_cvt_pk_bf16_f32 v165, v242, v248
v_lshlrev_b32 v242, 16, v166
v_and_b32 v248, 0xffff0000, v166
v_mul_f32 v242, v242, v237
v_mul_f32 v248, v248, v237
v_cvt_pk_bf16_f32 v166, v242, v248
v_lshlrev_b32 v242, 16, v167
v_and_b32 v248, 0xffff0000, v167
v_mul_f32 v242, v242, v237
v_mul_f32 v248, v248, v237
v_cvt_pk_bf16_f32 v167, v242, v248
v_lshlrev_b32 v242, 16, v32
v_and_b32 v248, 0xffff0000, v32
v_mul_f32 v242, v242, v237
v_mul_f32 v248, v248, v237
v_cvt_pk_bf16_f32 v32, v242, v248
v_lshlrev_b32 v242, 16, v33
v_and_b32 v248, 0xffff0000, v33
v_mul_f32 v242, v242, v237
v_mul_f32 v248, v248, v237
v_cvt_pk_bf16_f32 v33, v242, v248
v_exp_f32 v232, v148
v_exp_f32 v233, v149
v_exp_f32 v234, v150
v_exp_f32 v235, v151
s_nop 1
v_cvt_pk_bf16_f32 v34, v232, v233
v_cvt_pk_bf16_f32 v35, v234, v235
v_max_f32 v204, v152, v153
v_max3_f32 v204, v204, v154, v155
v_mov_b32 v205, v204
s_nop 1
v_permlane32_swap_b32 v204, v205
s_nop 1
v_max_f32 v204, v204, v205
v_mov_b32 v205, v204
s_nop 1
v_permlane16_swap_b32 v204, v205
s_nop 1
v_max_f32 v204, v204, v205
v_add_f32 v204, 40.0, v204
v_ceil_f32 v204, v204
v_max_f32 v204, 0, v204
v_sub_f32 v205, v226, v204
v_cvt_pk_bf16_f32 v205, v205, v205
v_and_b32 v205, 0xffff0000, v205
v_sub_f32 v204, v205, v226
v_mov_b32 v226, v205
v_exp_f32 v238, v204
v_add_f32 v152, v152, v204
v_add_f32 v153, v153, v204
v_add_f32 v154, v154, v204
v_add_f32 v155, v155, v204
v_add_f32 v136, v136, v204
v_add_f32 v137, v137, v204
v_add_f32 v138, v138, v204
v_add_f32 v139, v139, v204
v_lshlrev_b32 v242, 16, v68
v_and_b32 v248, 0xffff0000, v68
v_mul_f32 v242, v242, v238
v_mul_f32 v248, v248, v238
v_cvt_pk_bf16_f32 v68, v242, v248
v_lshlrev_b32 v242, 16, v69
v_and_b32 v248, 0xffff0000, v69
v_mul_f32 v242, v242, v238
v_mul_f32 v248, v248, v238
v_cvt_pk_bf16_f32 v69, v242, v248
v_lshlrev_b32 v242, 16, v70
v_and_b32 v248, 0xffff0000, v70
v_mul_f32 v242, v242, v238
v_mul_f32 v248, v248, v238
v_cvt_pk_bf16_f32 v70, v242, v248
v_lshlrev_b32 v242, 16, v71
v_and_b32 v248, 0xffff0000, v71
v_mul_f32 v242, v242, v238
v_mul_f32 v248, v248, v238
v_cvt_pk_bf16_f32 v71, v242, v248
v_lshlrev_b32 v242, 16, v72
v_and_b32 v248, 0xffff0000, v72
v_mul_f32 v242, v242, v238
v_mul_f32 v248, v248, v238
v_cvt_pk_bf16_f32 v72, v242, v248
v_lshlrev_b32 v242, 16, v73
v_and_b32 v248, 0xffff0000, v73
v_mul_f32 v242, v242, v238
v_mul_f32 v248, v248, v238
v_cvt_pk_bf16_f32 v73, v242, v248
v_lshlrev_b32 v242, 16, v74
v_and_b32 v248, 0xffff0000, v74
v_mul_f32 v242, v242, v238
v_mul_f32 v248, v248, v238
v_cvt_pk_bf16_f32 v74, v242, v248
v_lshlrev_b32 v242, 16, v75
v_and_b32 v248, 0xffff0000, v75
v_mul_f32 v242, v242, v238
v_mul_f32 v248, v248, v238
v_cvt_pk_bf16_f32 v75, v242, v248
v_lshlrev_b32 v242, 16, v184
v_and_b32 v248, 0xffff0000, v184
v_mul_f32 v242, v242, v238
v_mul_f32 v248, v248, v238
v_cvt_pk_bf16_f32 v184, v242, v248
v_lshlrev_b32 v242, 16, v185
v_and_b32 v248, 0xffff0000, v185
v_mul_f32 v242, v242, v238
v_mul_f32 v248, v248, v238
v_cvt_pk_bf16_f32 v185, v242, v248
v_lshlrev_b32 v242, 16, v186
v_and_b32 v248, 0xffff0000, v186
v_mul_f32 v242, v242, v238
v_mul_f32 v248, v248, v238
v_cvt_pk_bf16_f32 v186, v242, v248
v_lshlrev_b32 v242, 16, v187
v_and_b32 v248, 0xffff0000, v187
v_mul_f32 v242, v242, v238
v_mul_f32 v248, v248, v238
v_cvt_pk_bf16_f32 v187, v242, v248
v_lshlrev_b32 v242, 16, v168
v_and_b32 v248, 0xffff0000, v168
v_mul_f32 v242, v242, v238
v_mul_f32 v248, v248, v238
v_cvt_pk_bf16_f32 v168, v242, v248
v_lshlrev_b32 v242, 16, v169
v_and_b32 v248, 0xffff0000, v169
v_mul_f32 v242, v242, v238
v_mul_f32 v248, v248, v238
v_cvt_pk_bf16_f32 v169, v242, v248
v_lshlrev_b32 v242, 16, v170
v_and_b32 v248, 0xffff0000, v170
v_mul_f32 v242, v242, v238
v_mul_f32 v248, v248, v238
v_cvt_pk_bf16_f32 v170, v242, v248
v_lshlrev_b32 v242, 16, v171
v_and_b32 v248, 0xffff0000, v171
v_mul_f32 v242, v242, v238
v_mul_f32 v248, v248, v238
v_cvt_pk_bf16_f32 v171, v242, v248
v_lshlrev_b32 v242, 16, v64
v_and_b32 v248, 0xffff0000, v64
v_mul_f32 v242, v242, v238
v_mul_f32 v248, v248, v238
v_cvt_pk_bf16_f32 v64, v242, v248
v_lshlrev_b32 v242, 16, v65
v_and_b32 v248, 0xffff0000, v65
v_mul_f32 v242, v242, v238
v_mul_f32 v248, v248, v238
v_cvt_pk_bf16_f32 v65, v242, v248
v_exp_f32 v232, v152
v_exp_f32 v233, v153
v_exp_f32 v234, v154
v_exp_f32 v235, v155
s_nop 1
v_cvt_pk_bf16_f32 v66, v232, v233
v_cvt_pk_bf16_f32 v67, v234, v235
v_max_f32 v204, v156, v157
v_max3_f32 v204, v204, v158, v159
v_mov_b32 v205, v204
s_nop 1
v_permlane32_swap_b32 v204, v205
s_nop 1
v_max_f32 v204, v204, v205
v_mov_b32 v205, v204
s_nop 1
v_permlane16_swap_b32 v204, v205
s_nop 1
v_max_f32 v204, v204, v205
v_add_f32 v204, 40.0, v204
v_ceil_f32 v204, v204
v_max_f32 v204, 0, v204
v_sub_f32 v205, v227, v204
v_cvt_pk_bf16_f32 v205, v205, v205
v_and_b32 v205, 0xffff0000, v205
v_sub_f32 v204, v205, v227
v_mov_b32 v227, v205
v_exp_f32 v239, v204
v_add_f32 v156, v156, v204
v_add_f32 v157, v157, v204
v_add_f32 v158, v158, v204
v_add_f32 v159, v159, v204
v_add_f32 v140, v140, v204
v_add_f32 v141, v141, v204
v_add_f32 v142, v142, v204
v_add_f32 v143, v143, v204
v_lshlrev_b32 v242, 16, v100
v_and_b32 v248, 0xffff0000, v100
v_mul_f32 v242, v242, v239
v_mul_f32 v248, v248, v239
v_cvt_pk_bf16_f32 v100, v242, v248
v_lshlrev_b32 v242, 16, v101
v_and_b32 v248, 0xffff0000, v101
v_mul_f32 v242, v242, v239
v_mul_f32 v248, v248, v239
v_cvt_pk_bf16_f32 v101, v242, v248
v_lshlrev_b32 v242, 16, v102
v_and_b32 v248, 0xffff0000, v102
v_mul_f32 v242, v242, v239
v_mul_f32 v248, v248, v239
v_cvt_pk_bf16_f32 v102, v242, v248
v_lshlrev_b32 v242, 16, v103
v_and_b32 v248, 0xffff0000, v103
v_mul_f32 v242, v242, v239
v_mul_f32 v248, v248, v239
v_cvt_pk_bf16_f32 v103, v242, v248
v_lshlrev_b32 v242, 16, v104
v_and_b32 v248, 0xffff0000, v104
v_mul_f32 v242, v242, v239
v_mul_f32 v248, v248, v239
v_cvt_pk_bf16_f32 v104, v242, v248
v_lshlrev_b32 v242, 16, v105
v_and_b32 v248, 0xffff0000, v105
v_mul_f32 v242, v242, v239
v_mul_f32 v248, v248, v239
v_cvt_pk_bf16_f32 v105, v242, v248
v_lshlrev_b32 v242, 16, v106
v_and_b32 v248, 0xffff0000, v106
v_mul_f32 v242, v242, v239
v_mul_f32 v248, v248, v239
v_cvt_pk_bf16_f32 v106, v242, v248
v_lshlrev_b32 v242, 16, v107
v_and_b32 v248, 0xffff0000, v107
v_mul_f32 v242, v242, v239
v_mul_f32 v248, v248, v239
v_cvt_pk_bf16_f32 v107, v242, v248
v_lshlrev_b32 v242, 16, v188
v_and_b32 v248, 0xffff0000, v188
v_mul_f32 v242, v242, v239
v_mul_f32 v248, v248, v239
v_cvt_pk_bf16_f32 v188, v242, v248
v_lshlrev_b32 v242, 16, v189
v_and_b32 v248, 0xffff0000, v189
v_mul_f32 v242, v242, v239
v_mul_f32 v248, v248, v239
v_cvt_pk_bf16_f32 v189, v242, v248
v_lshlrev_b32 v242, 16, v190
v_and_b32 v248, 0xffff0000, v190
v_mul_f32 v242, v242, v239
v_mul_f32 v248, v248, v239
v_cvt_pk_bf16_f32 v190, v242, v248
v_lshlrev_b32 v242, 16, v191
v_and_b32 v248, 0xffff0000, v191
v_mul_f32 v242, v242, v239
v_mul_f32 v248, v248, v239
v_cvt_pk_bf16_f32 v191, v242, v248
v_lshlrev_b32 v242, 16, v172
v_and_b32 v248, 0xffff0000, v172
v_mul_f32 v242, v242, v239
v_mul_f32 v248, v248, v239
v_cvt_pk_bf16_f32 v172, v242, v248
v_lshlrev_b32 v242, 16, v173
v_and_b32 v248, 0xffff0000, v173
v_mul_f32 v242, v242, v239
v_mul_f32 v248, v248, v239
v_cvt_pk_bf16_f32 v173, v242, v248
v_lshlrev_b32 v242, 16, v174
v_and_b32 v248, 0xffff0000, v174
v_mul_f32 v242, v242, v239
v_mul_f32 v248, v248, v239
v_cvt_pk_bf16_f32 v174, v242, v248
v_lshlrev_b32 v242, 16, v175
v_and_b32 v248, 0xffff0000, v175
v_mul_f32 v242, v242, v239
v_mul_f32 v248, v248, v239
v_cvt_pk_bf16_f32 v175, v242, v248
v_lshlrev_b32 v242, 16, v96
v_and_b32 v248, 0xffff0000, v96
v_mul_f32 v242, v242, v239
v_mul_f32 v248, v248, v239
v_cvt_pk_bf16_f32 v96, v242, v248
v_lshlrev_b32 v242, 16, v97
v_and_b32 v248, 0xffff0000, v97
v_mul_f32 v242, v242, v239
v_mul_f32 v248, v248, v239
v_cvt_pk_bf16_f32 v97, v242, v248
v_exp_f32 v232, v156
v_exp_f32 v233, v157
v_exp_f32 v234, v158
v_exp_f32 v235, v159
s_nop 1
v_cvt_pk_bf16_f32 v98, v232, v233
v_cvt_pk_bf16_f32 v99, v234, v235
s_branch L2_rare_common
LF_hl_1:
s_mov_b32 s94, 0x10000
s_mov_b32 s3, 0x7c28000
LF_hl2_1:
v_lshlrev_b32 v241, 3, v243
buffer_load_dwordx2 v[240:241], v241, s[16:19], s3 offen sc1
s_sub_u32 s94, s94, 1
s_waitcnt vmcnt(0)
s_cbranch_scc1 LF_hlret_1
v_cmp_ne_u64_e64 s[38:39], s[98:99], v[240:241]
s_and_b64 s[38:39], s[38:39], s[96:97]
s_cbranch_scc1 LF_hl2_1
s_branch LF_hlret_1
L2_rare_site12:
s_mov_b32 s36, 12
s_branch L2_rare_t0_0
L2_rare_t0_0:
s_nop 15
s_nop 15
s_waitcnt lgkmcnt(0)
v_lshrrev_b32 v206, 8, v243
v_add_u32 v206, 1, v206
v_lshrrev_b32 v206, 2, v206
v_sub_u32 v206, 0, v206
v_and_b32 v206, 0xffff0000, v206
v_max_f32 v204, v128, v129
v_max3_f32 v204, v204, v130, v131
v_mov_b32 v205, v204
s_nop 1
v_permlane32_swap_b32 v204, v205
s_nop 1
v_max_f32 v204, v204, v205
v_mov_b32 v205, v204
s_nop 1
v_permlane16_swap_b32 v204, v205
s_nop 1
v_max_f32 v204, v204, v205
v_add_f32 v204, 40.0, v204
v_ceil_f32 v204, v204
v_max_f32 v204, 0, v204
v_sub_f32 v205, v224, v204
v_cvt_pk_bf16_f32 v205, v205, v205
v_and_b32 v205, 0xffff0000, v205
v_sub_f32 v204, v205, v224
v_mov_b32 v224, v205
v_exp_f32 v236, v204
v_bfi_b32 v3, v206, v205, v3
v_add_f32 v128, v128, v204
v_add_f32 v129, v129, v204
v_add_f32 v130, v130, v204
v_add_f32 v131, v131, v204
v_add_f32 v144, v144, v204
v_add_f32 v145, v145, v204
v_add_f32 v146, v146, v204
v_add_f32 v147, v147, v204
v_lshlrev_b32 v242, 16, v176
v_and_b32 v248, 0xffff0000, v176
v_mul_f32 v242, v242, v236
v_mul_f32 v248, v248, v236
v_cvt_pk_bf16_f32 v176, v242, v248
v_lshlrev_b32 v242, 16, v177
v_and_b32 v248, 0xffff0000, v177
v_mul_f32 v242, v242, v236
v_mul_f32 v248, v248, v236
v_cvt_pk_bf16_f32 v177, v242, v248
v_lshlrev_b32 v242, 16, v178
v_and_b32 v248, 0xffff0000, v178
v_mul_f32 v242, v242, v236
v_mul_f32 v248, v248, v236
v_cvt_pk_bf16_f32 v178, v242, v248
v_lshlrev_b32 v242, 16, v179
v_and_b32 v248, 0xffff0000, v179
v_mul_f32 v242, v242, v236
v_mul_f32 v248, v248, v236
v_cvt_pk_bf16_f32 v179, v242, v248
ds_read_b64 v[250:251], v231 offset:0
s_waitcnt lgkmcnt(0)
v_lshlrev_b32 v242, 16, v250
v_and_b32 v248, 0xffff0000, v250
v_mul_f32 v242, v242, v236
v_mul_f32 v248, v248, v236
v_cvt_pk_bf16_f32 v250, v242, v248
v_lshlrev_b32 v242, 16, v251
v_and_b32 v248, 0xffff0000, v251
v_mul_f32 v242, v242, v236
v_mul_f32 v248, v248, v236
v_cvt_pk_bf16_f32 v251, v242, v248
ds_write_b64 v231, v[250:251] offset:0
s_waitcnt lgkmcnt(0)
ds_read_b64 v[250:251], v231 offset:8
s_waitcnt lgkmcnt(0)
v_lshlrev_b32 v242, 16, v250
v_and_b32 v248, 0xffff0000, v250
v_mul_f32 v242, v242, v236
v_mul_f32 v248, v248, v236
v_cvt_pk_bf16_f32 v250, v242, v248
v_lshlrev_b32 v242, 16, v251
v_and_b32 v248, 0xffff0000, v251
v_mul_f32 v242, v242, v236
v_mul_f32 v248, v248, v236
v_cvt_pk_bf16_f32 v251, v242, v248
ds_write_b64 v231, v[250:251] offset:8
s_waitcnt lgkmcnt(0)
v_exp_f32 v232, v128
v_exp_f32 v233, v129
v_exp_f32 v234, v130
v_exp_f32 v235, v131
s_nop 1
v_cvt_pk_bf16_f32 v160, v232, v233
v_cvt_pk_bf16_f32 v161, v234, v235
v_max_f32 v204, v132, v133
v_max3_f32 v204, v204, v134, v135
v_mov_b32 v205, v204
s_nop 1
v_permlane32_swap_b32 v204, v205
s_nop 1
v_max_f32 v204, v204, v205
v_mov_b32 v205, v204
s_nop 1
v_permlane16_swap_b32 v204, v205
s_nop 1
v_max_f32 v204, v204, v205
v_add_f32 v204, 40.0, v204
v_ceil_f32 v204, v204
v_max_f32 v204, 0, v204
v_sub_f32 v205, v225, v204
v_cvt_pk_bf16_f32 v205, v205, v205
v_and_b32 v205, 0xffff0000, v205
v_sub_f32 v204, v205, v225
v_mov_b32 v225, v205
v_exp_f32 v237, v204
v_bfi_b32 v35, v206, v205, v35
v_add_f32 v132, v132, v204
v_add_f32 v133, v133, v204
v_add_f32 v134, v134, v204
v_add_f32 v135, v135, v204
v_add_f32 v148, v148, v204
v_add_f32 v149, v149, v204
v_add_f32 v150, v150, v204
v_add_f32 v151, v151, v204
v_lshlrev_b32 v242, 16, v180
v_and_b32 v248, 0xffff0000, v180
v_mul_f32 v242, v242, v237
v_mul_f32 v248, v248, v237
v_cvt_pk_bf16_f32 v180, v242, v248
v_lshlrev_b32 v242, 16, v181
v_and_b32 v248, 0xffff0000, v181
v_mul_f32 v242, v242, v237
v_mul_f32 v248, v248, v237
v_cvt_pk_bf16_f32 v181, v242, v248
v_lshlrev_b32 v242, 16, v182
v_and_b32 v248, 0xffff0000, v182
v_mul_f32 v242, v242, v237
v_mul_f32 v248, v248, v237
v_cvt_pk_bf16_f32 v182, v242, v248
v_lshlrev_b32 v242, 16, v183
v_and_b32 v248, 0xffff0000, v183
v_mul_f32 v242, v242, v237
v_mul_f32 v248, v248, v237
v_cvt_pk_bf16_f32 v183, v242, v248
ds_read_b64 v[250:251], v231 offset:1024
s_waitcnt lgkmcnt(0)
v_lshlrev_b32 v242, 16, v250
v_and_b32 v248, 0xffff0000, v250
v_mul_f32 v242, v242, v237
v_mul_f32 v248, v248, v237
v_cvt_pk_bf16_f32 v250, v242, v248
v_lshlrev_b32 v242, 16, v251
v_and_b32 v248, 0xffff0000, v251
v_mul_f32 v242, v242, v237
v_mul_f32 v248, v248, v237
v_cvt_pk_bf16_f32 v251, v242, v248
ds_write_b64 v231, v[250:251] offset:1024
s_waitcnt lgkmcnt(0)
ds_read_b64 v[250:251], v231 offset:1032
s_waitcnt lgkmcnt(0)
v_lshlrev_b32 v242, 16, v250
v_and_b32 v248, 0xffff0000, v250
v_mul_f32 v242, v242, v237
v_mul_f32 v248, v248, v237
v_cvt_pk_bf16_f32 v250, v242, v248
v_lshlrev_b32 v242, 16, v251
v_and_b32 v248, 0xffff0000, v251
v_mul_f32 v242, v242, v237
v_mul_f32 v248, v248, v237
v_cvt_pk_bf16_f32 v251, v242, v248
ds_write_b64 v231, v[250:251] offset:1032
s_waitcnt lgkmcnt(0)
v_exp_f32 v232, v132
v_exp_f32 v233, v133
v_exp_f32 v234, v134
v_exp_f32 v235, v135
s_nop 1
v_cvt_pk_bf16_f32 v164, v232, v233
v_cvt_pk_bf16_f32 v165, v234, v235
v_max_f32 v204, v136, v137
v_max3_f32 v204, v204, v138, v139
v_mov_b32 v205, v204
s_nop 1
v_permlane32_swap_b32 v204, v205
s_nop 1
v_max_f32 v204, v204, v205
v_mov_b32 v205, v204
s_nop 1
v_permlane16_swap_b32 v204, v205
s_nop 1
v_max_f32 v204, v204, v205
v_add_f32 v204, 40.0, v204
v_ceil_f32 v204, v204
v_max_f32 v204, 0, v204
v_sub_f32 v205, v226, v204
v_cvt_pk_bf16_f32 v205, v205, v205
v_and_b32 v205, 0xffff0000, v205
v_sub_f32 v204, v205, v226
v_mov_b32 v226, v205
v_exp_f32 v238, v204
v_bfi_b32 v67, v206, v205, v67
v_add_f32 v136, v136, v204
v_add_f32 v137, v137, v204
v_add_f32 v138, v138, v204
v_add_f32 v139, v139, v204
v_add_f32 v152, v152, v204
v_add_f32 v153, v153, v204
v_add_f32 v154, v154, v204
v_add_f32 v155, v155, v204
v_lshlrev_b32 v242, 16, v184
v_and_b32 v248, 0xffff0000, v184
v_mul_f32 v242, v242, v238
v_mul_f32 v248, v248, v238
v_cvt_pk_bf16_f32 v184, v242, v248
v_lshlrev_b32 v242, 16, v185
v_and_b32 v248, 0xffff0000, v185
v_mul_f32 v242, v242, v238
v_mul_f32 v248, v248, v238
v_cvt_pk_bf16_f32 v185, v242, v248
v_lshlrev_b32 v242, 16, v186
v_and_b32 v248, 0xffff0000, v186
v_mul_f32 v242, v242, v238
v_mul_f32 v248, v248, v238
v_cvt_pk_bf16_f32 v186, v242, v248
v_lshlrev_b32 v242, 16, v187
v_and_b32 v248, 0xffff0000, v187
v_mul_f32 v242, v242, v238
v_mul_f32 v248, v248, v238
v_cvt_pk_bf16_f32 v187, v242, v248
ds_read_b64 v[250:251], v231 offset:2048
s_waitcnt lgkmcnt(0)
v_lshlrev_b32 v242, 16, v250
v_and_b32 v248, 0xffff0000, v250
v_mul_f32 v242, v242, v238
v_mul_f32 v248, v248, v238
v_cvt_pk_bf16_f32 v250, v242, v248
v_lshlrev_b32 v242, 16, v251
v_and_b32 v248, 0xffff0000, v251
v_mul_f32 v242, v242, v238
v_mul_f32 v248, v248, v238
v_cvt_pk_bf16_f32 v251, v242, v248
ds_write_b64 v231, v[250:251] offset:2048
s_waitcnt lgkmcnt(0)
ds_read_b64 v[250:251], v231 offset:2056
s_waitcnt lgkmcnt(0)
v_lshlrev_b32 v242, 16, v250
v_and_b32 v248, 0xffff0000, v250
v_mul_f32 v242, v242, v238
v_mul_f32 v248, v248, v238
v_cvt_pk_bf16_f32 v250, v242, v248
v_lshlrev_b32 v242, 16, v251
v_and_b32 v248, 0xffff0000, v251
v_mul_f32 v242, v242, v238
v_mul_f32 v248, v248, v238
v_cvt_pk_bf16_f32 v251, v242, v248
ds_write_b64 v231, v[250:251] offset:2056
s_waitcnt lgkmcnt(0)
v_exp_f32 v232, v136
v_exp_f32 v233, v137
v_exp_f32 v234, v138
v_exp_f32 v235, v139
s_nop 1
v_cvt_pk_bf16_f32 v168, v232, v233
v_cvt_pk_bf16_f32 v169, v234, v235
v_max_f32 v204, v140, v141
v_max3_f32 v204, v204, v142, v143
v_mov_b32 v205, v204
s_nop 1
v_permlane32_swap_b32 v204, v205
s_nop 1
v_max_f32 v204, v204, v205
v_mov_b32 v205, v204
s_nop 1
v_permlane16_swap_b32 v204, v205
s_nop 1
v_max_f32 v204, v204, v205
v_add_f32 v204, 40.0, v204
v_ceil_f32 v204, v204
v_max_f32 v204, 0, v204
v_sub_f32 v205, v227, v204
v_cvt_pk_bf16_f32 v205, v205, v205
v_and_b32 v205, 0xffff0000, v205
v_sub_f32 v204, v205, v227
v_mov_b32 v227, v205
v_exp_f32 v239, v204
v_bfi_b32 v99, v206, v205, v99
v_add_f32 v140, v140, v204
v_add_f32 v141, v141, v204
v_add_f32 v142, v142, v204
v_add_f32 v143, v143, v204
v_add_f32 v156, v156, v204
v_add_f32 v157, v157, v204
v_add_f32 v158, v158, v204
v_add_f32 v159, v159, v204
v_lshlrev_b32 v242, 16, v188
v_and_b32 v248, 0xffff0000, v188
v_mul_f32 v242, v242, v239
v_mul_f32 v248, v248, v239
v_cvt_pk_bf16_f32 v188, v242, v248
v_lshlrev_b32 v242, 16, v189
v_and_b32 v248, 0xffff0000, v189
v_mul_f32 v242, v242, v239
v_mul_f32 v248, v248, v239
v_cvt_pk_bf16_f32 v189, v242, v248
v_lshlrev_b32 v242, 16, v190
v_and_b32 v248, 0xffff0000, v190
v_mul_f32 v242, v242, v239
v_mul_f32 v248, v248, v239
v_cvt_pk_bf16_f32 v190, v242, v248
v_lshlrev_b32 v242, 16, v191
v_and_b32 v248, 0xffff0000, v191
v_mul_f32 v242, v242, v239
v_mul_f32 v248, v248, v239
v_cvt_pk_bf16_f32 v191, v242, v248
ds_read_b64 v[250:251], v231 offset:3072
s_waitcnt lgkmcnt(0)
v_lshlrev_b32 v242, 16, v250
v_and_b32 v248, 0xffff0000, v250
v_mul_f32 v242, v242, v239
v_mul_f32 v248, v248, v239
v_cvt_pk_bf16_f32 v250, v242, v248
v_lshlrev_b32 v242, 16, v251
v_and_b32 v248, 0xffff0000, v251
v_mul_f32 v242, v242, v239
v_mul_f32 v248, v248, v239
v_cvt_pk_bf16_f32 v251, v242, v248
ds_write_b64 v231, v[250:251] offset:3072
s_waitcnt lgkmcnt(0)
ds_read_b64 v[250:251], v231 offset:3080
s_waitcnt lgkmcnt(0)
v_lshlrev_b32 v242, 16, v250
v_and_b32 v248, 0xffff0000, v250
v_mul_f32 v242, v242, v239
v_mul_f32 v248, v248, v239
v_cvt_pk_bf16_f32 v250, v242, v248
v_lshlrev_b32 v242, 16, v251
v_and_b32 v248, 0xffff0000, v251
v_mul_f32 v242, v242, v239
v_mul_f32 v248, v248, v239
v_cvt_pk_bf16_f32 v251, v242, v248
ds_write_b64 v231, v[250:251] offset:3080
s_waitcnt lgkmcnt(0)
v_exp_f32 v232, v140
v_exp_f32 v233, v141
v_exp_f32 v234, v142
v_exp_f32 v235, v143
s_nop 1
v_cvt_pk_bf16_f32 v172, v232, v233
v_cvt_pk_bf16_f32 v173, v234, v235
s_branch L2_rare_common
L2_rare_site13:
s_mov_b32 s36, 13
s_branch L2_rare_t0_1
L2_rare_t0_1:
s_nop 15
s_nop 15
s_waitcnt lgkmcnt(0)
v_lshrrev_b32 v206, 8, v243
v_add_u32 v206, 1, v206
v_lshrrev_b32 v206, 2, v206
v_sub_u32 v206, 0, v206
v_and_b32 v206, 0xffff0000, v206
v_max_f32 v204, v144, v145
v_max3_f32 v204, v204, v146, v147
v_mov_b32 v205, v204
s_nop 1
v_permlane32_swap_b32 v204, v205
s_nop 1
v_max_f32 v204, v204, v205
v_mov_b32 v205, v204
s_nop 1
v_permlane16_swap_b32 v204, v205
s_nop 1
v_max_f32 v204, v204, v205
v_add_f32 v204, 40.0, v204
v_ceil_f32 v204, v204
v_max_f32 v204, 0, v204
v_sub_f32 v205, v224, v204
v_cvt_pk_bf16_f32 v205, v205, v205
v_and_b32 v205, 0xffff0000, v205
v_sub_f32 v204, v205, v224
v_mov_b32 v224, v205
v_exp_f32 v236, v204
v_bfi_b32 v3, v206, v205, v3
v_add_f32 v144, v144, v204
v_add_f32 v145, v145, v204
v_add_f32 v146, v146, v204
v_add_f32 v147, v147, v204
v_add_f32 v128, v128, v204
v_add_f32 v129, v129, v204
v_add_f32 v130, v130, v204
v_add_f32 v131, v131, v204
v_lshlrev_b32 v242, 16, v160
v_and_b32 v248, 0xffff0000, v160
v_mul_f32 v242, v242, v236
v_mul_f32 v248, v248, v236
v_cvt_pk_bf16_f32 v160, v242, v248
v_lshlrev_b32 v242, 16, v161
v_and_b32 v248, 0xffff0000, v161
v_mul_f32 v242, v242, v236
v_mul_f32 v248, v248, v236
v_cvt_pk_bf16_f32 v161, v242, v248
ds_read_b64 v[250:251], v231 offset:0
s_waitcnt lgkmcnt(0)
v_lshlrev_b32 v242, 16, v250
v_and_b32 v248, 0xffff0000, v250
v_mul_f32 v242, v242, v236
v_mul_f32 v248, v248, v236
v_cvt_pk_bf16_f32 v250, v242, v248
v_lshlrev_b32 v242, 16, v251
v_and_b32 v248, 0xffff0000, v251
v_mul_f32 v242, v242, v236
v_mul_f32 v248, v248, v236
v_cvt_pk_bf16_f32 v251, v242, v248
ds_write_b64 v231, v[250:251] offset:0
s_waitcnt lgkmcnt(0)
ds_read_b64 v[250:251], v231 offset:8
s_waitcnt lgkmcnt(0)
v_lshlrev_b32 v242, 16, v250
v_and_b32 v248, 0xffff0000, v250
v_mul_f32 v242, v242, v236
v_mul_f32 v248, v248, v236
v_cvt_pk_bf16_f32 v250, v242, v248
v_lshlrev_b32 v242, 16, v251
v_and_b32 v248, 0xffff0000, v251
v_mul_f32 v242, v242, v236
v_mul_f32 v248, v248, v236
v_cvt_pk_bf16_f32 v251, v242, v248
ds_write_b64 v231, v[250:251] offset:8
s_waitcnt lgkmcnt(0)
ds_read_b64 v[250:251], v231 offset:4096
s_waitcnt lgkmcnt(0)
v_lshlrev_b32 v242, 16, v250
v_and_b32 v248, 0xffff0000, v250
v_mul_f32 v242, v242, v236
v_mul_f32 v248, v248, v236
v_cvt_pk_bf16_f32 v250, v242, v248
v_lshlrev_b32 v242, 16, v251
v_and_b32 v248, 0xffff0000, v251
v_mul_f32 v242, v242, v236
v_mul_f32 v248, v248, v236
v_cvt_pk_bf16_f32 v251, v242, v248
ds_write_b64 v231, v[250:251] offset:4096
s_waitcnt lgkmcnt(0)
ds_read_b64 v[250:251], v231 offset:4104
s_waitcnt lgkmcnt(0)
v_lshlrev_b32 v242, 16, v250
v_and_b32 v248, 0xffff0000, v250
v_mul_f32 v242, v242, v236
v_mul_f32 v248, v248, v236
v_cvt_pk_bf16_f32 v250, v242, v248
v_lshlrev_b32 v242, 16, v251
v_and_b32 v248, 0xffff0000, v251
v_mul_f32 v242, v242, v236
v_mul_f32 v248, v248, v236
v_cvt_pk_bf16_f32 v251, v242, v248
ds_write_b64 v231, v[250:251] offset:4104
s_waitcnt lgkmcnt(0)
v_exp_f32 v232, v144
v_exp_f32 v233, v145
v_exp_f32 v234, v146
v_exp_f32 v235, v147
s_nop 1
v_cvt_pk_bf16_f32 v162, v232, v233
v_cvt_pk_bf16_f32 v163, v234, v235
v_max_f32 v204, v148, v149
v_max3_f32 v204, v204, v150, v151
v_mov_b32 v205, v204
s_nop 1
v_permlane32_swap_b32 v204, v205
s_nop 1
v_max_f32 v204, v204, v205
v_mov_b32 v205, v204
s_nop 1
v_permlane16_swap_b32 v204, v205
s_nop 1
v_max_f32 v204, v204, v205
v_add_f32 v204, 40.0, v204
v_ceil_f32 v204, v204
v_max_f32 v204, 0, v204
v_sub_f32 v205, v225, v204
v_cvt_pk_bf16_f32 v205, v205, v205
v_and_b32 v205, 0xffff0000, v205
v_sub_f32 v204, v205, v225
v_mov_b32 v225, v205
v_exp_f32 v237, v204
v_bfi_b32 v35, v206, v205, v35
v_add_f32 v148, v148, v204
v_add_f32 v149, v149, v204
v_add_f32 v150, v150, v204
v_add_f32 v151, v151, v204
v_add_f32 v132, v132, v204
v_add_f32 v133, v133, v204
v_add_f32 v134, v134, v204
v_add_f32 v135, v135, v204
v_lshlrev_b32 v242, 16, v164
v_and_b32 v248, 0xffff0000, v164
v_mul_f32 v242, v242, v237
v_mul_f32 v248, v248, v237
v_cvt_pk_bf16_f32 v164, v242, v248
v_lshlrev_b32 v242, 16, v165
v_and_b32 v248, 0xffff0000, v165
v_mul_f32 v242, v242, v237
v_mul_f32 v248, v248, v237
v_cvt_pk_bf16_f32 v165, v242, v248
ds_read_b64 v[250:251], v231 offset:1024
s_waitcnt lgkmcnt(0)
v_lshlrev_b32 v242, 16, v250
v_and_b32 v248, 0xffff0000, v250
v_mul_f32 v242, v242, v237
v_mul_f32 v248, v248, v237
v_cvt_pk_bf16_f32 v250, v242, v248
v_lshlrev_b32 v242, 16, v251
v_and_b32 v248, 0xffff0000, v251
v_mul_f32 v242, v242, v237
v_mul_f32 v248, v248, v237
v_cvt_pk_bf16_f32 v251, v242, v248
ds_write_b64 v231, v[250:251] offset:1024
s_waitcnt lgkmcnt(0)
ds_read_b64 v[250:251], v231 offset:1032
s_waitcnt lgkmcnt(0)
v_lshlrev_b32 v242, 16, v250
v_and_b32 v248, 0xffff0000, v250
v_mul_f32 v242, v242, v237
v_mul_f32 v248, v248, v237
v_cvt_pk_bf16_f32 v250, v242, v248
v_lshlrev_b32 v242, 16, v251
v_and_b32 v248, 0xffff0000, v251
v_mul_f32 v242, v242, v237
v_mul_f32 v248, v248, v237
v_cvt_pk_bf16_f32 v251, v242, v248
ds_write_b64 v231, v[250:251] offset:1032
s_waitcnt lgkmcnt(0)
ds_read_b64 v[250:251], v231 offset:5120
s_waitcnt lgkmcnt(0)
v_lshlrev_b32 v242, 16, v250
v_and_b32 v248, 0xffff0000, v250
v_mul_f32 v242, v242, v237
v_mul_f32 v248, v248, v237
v_cvt_pk_bf16_f32 v250, v242, v248
v_lshlrev_b32 v242, 16, v251
v_and_b32 v248, 0xffff0000, v251
v_mul_f32 v242, v242, v237
v_mul_f32 v248, v248, v237
v_cvt_pk_bf16_f32 v251, v242, v248
ds_write_b64 v231, v[250:251] offset:5120
s_waitcnt lgkmcnt(0)
ds_read_b64 v[250:251], v231 offset:5128
s_waitcnt lgkmcnt(0)
v_lshlrev_b32 v242, 16, v250
v_and_b32 v248, 0xffff0000, v250
v_mul_f32 v242, v242, v237
v_mul_f32 v248, v248, v237
v_cvt_pk_bf16_f32 v250, v242, v248
v_lshlrev_b32 v242, 16, v251
v_and_b32 v248, 0xffff0000, v251
v_mul_f32 v242, v242, v237
v_mul_f32 v248, v248, v237
v_cvt_pk_bf16_f32 v251, v242, v248
ds_write_b64 v231, v[250:251] offset:5128
s_waitcnt lgkmcnt(0)
v_exp_f32 v232, v148
v_exp_f32 v233, v149
v_exp_f32 v234, v150
v_exp_f32 v235, v151
s_nop 1
v_cvt_pk_bf16_f32 v166, v232, v233
v_cvt_pk_bf16_f32 v167, v234, v235
v_max_f32 v204, v152, v153
v_max3_f32 v204, v204, v154, v155
v_mov_b32 v205, v204
s_nop 1
v_permlane32_swap_b32 v204, v205
s_nop 1
v_max_f32 v204, v204, v205
v_mov_b32 v205, v204
s_nop 1
v_permlane16_swap_b32 v204, v205
s_nop 1
v_max_f32 v204, v204, v205
v_add_f32 v204, 40.0, v204
v_ceil_f32 v204, v204
v_max_f32 v204, 0, v204
v_sub_f32 v205, v226, v204
v_cvt_pk_bf16_f32 v205, v205, v205
v_and_b32 v205, 0xffff0000, v205
v_sub_f32 v204, v205, v226
v_mov_b32 v226, v205
v_exp_f32 v238, v204
v_bfi_b32 v67, v206, v205, v67
v_add_f32 v152, v152, v204
v_add_f32 v153, v153, v204
v_add_f32 v154, v154, v204
v_add_f32 v155, v155, v204
v_add_f32 v136, v136, v204
v_add_f32 v137, v137, v204
v_add_f32 v138, v138, v204
v_add_f32 v139, v139, v204
v_lshlrev_b32 v242, 16, v168
v_and_b32 v248, 0xffff0000, v168
v_mul_f32 v242, v242, v238
v_mul_f32 v248, v248, v238
v_cvt_pk_bf16_f32 v168, v242, v248
v_lshlrev_b32 v242, 16, v169
v_and_b32 v248, 0xffff0000, v169
v_mul_f32 v242, v242, v238
v_mul_f32 v248, v248, v238
v_cvt_pk_bf16_f32 v169, v242, v248
ds_read_b64 v[250:251], v231 offset:2048
s_waitcnt lgkmcnt(0)
v_lshlrev_b32 v242, 16, v250
v_and_b32 v248, 0xffff0000, v250
v_mul_f32 v242, v242, v238
v_mul_f32 v248, v248, v238
v_cvt_pk_bf16_f32 v250, v242, v248
v_lshlrev_b32 v242, 16, v251
v_and_b32 v248, 0xffff0000, v251
v_mul_f32 v242, v242, v238
v_mul_f32 v248, v248, v238
v_cvt_pk_bf16_f32 v251, v242, v248
ds_write_b64 v231, v[250:251] offset:2048
s_waitcnt lgkmcnt(0)
ds_read_b64 v[250:251], v231 offset:2056
s_waitcnt lgkmcnt(0)
v_lshlrev_b32 v242, 16, v250
v_and_b32 v248, 0xffff0000, v250
v_mul_f32 v242, v242, v238
v_mul_f32 v248, v248, v238
v_cvt_pk_bf16_f32 v250, v242, v248
v_lshlrev_b32 v242, 16, v251
v_and_b32 v248, 0xffff0000, v251
v_mul_f32 v242, v242, v238
v_mul_f32 v248, v248, v238
v_cvt_pk_bf16_f32 v251, v242, v248
ds_write_b64 v231, v[250:251] offset:2056
s_waitcnt lgkmcnt(0)
ds_read_b64 v[250:251], v231 offset:6144
s_waitcnt lgkmcnt(0)
v_lshlrev_b32 v242, 16, v250
v_and_b32 v248, 0xffff0000, v250
v_mul_f32 v242, v242, v238
v_mul_f32 v248, v248, v238
v_cvt_pk_bf16_f32 v250, v242, v248
v_lshlrev_b32 v242, 16, v251
v_and_b32 v248, 0xffff0000, v251
v_mul_f32 v242, v242, v238
v_mul_f32 v248, v248, v238
v_cvt_pk_bf16_f32 v251, v242, v248
ds_write_b64 v231, v[250:251] offset:6144
s_waitcnt lgkmcnt(0)
ds_read_b64 v[250:251], v231 offset:6152
s_waitcnt lgkmcnt(0)
v_lshlrev_b32 v242, 16, v250
v_and_b32 v248, 0xffff0000, v250
v_mul_f32 v242, v242, v238
v_mul_f32 v248, v248, v238
v_cvt_pk_bf16_f32 v250, v242, v248
v_lshlrev_b32 v242, 16, v251
v_and_b32 v248, 0xffff0000, v251
v_mul_f32 v242, v242, v238
v_mul_f32 v248, v248, v238
v_cvt_pk_bf16_f32 v251, v242, v248
ds_write_b64 v231, v[250:251] offset:6152
s_waitcnt lgkmcnt(0)
v_exp_f32 v232, v152
v_exp_f32 v233, v153
v_exp_f32 v234, v154
v_exp_f32 v235, v155
s_nop 1
v_cvt_pk_bf16_f32 v170, v232, v233
v_cvt_pk_bf16_f32 v171, v234, v235
v_max_f32 v204, v156, v157
v_max3_f32 v204, v204, v158, v159
v_mov_b32 v205, v204
s_nop 1
v_permlane32_swap_b32 v204, v205
s_nop 1
v_max_f32 v204, v204, v205
v_mov_b32 v205, v204
s_nop 1
v_permlane16_swap_b32 v204, v205
s_nop 1
v_max_f32 v204, v204, v205
v_add_f32 v204, 40.0, v204
v_ceil_f32 v204, v204
v_max_f32 v204, 0, v204
v_sub_f32 v205, v227, v204
v_cvt_pk_bf16_f32 v205, v205, v205
v_and_b32 v205, 0xffff0000, v205
v_sub_f32 v204, v205, v227
v_mov_b32 v227, v205
v_exp_f32 v239, v204
v_bfi_b32 v99, v206, v205, v99
v_add_f32 v156, v156, v204
v_add_f32 v157, v157, v204
v_add_f32 v158, v158, v204
v_add_f32 v159, v159, v204
v_add_f32 v140, v140, v204
v_add_f32 v141, v141, v204
v_add_f32 v142, v142, v204
v_add_f32 v143, v143, v204
v_lshlrev_b32 v242, 16, v172
v_and_b32 v248, 0xffff0000, v172
v_mul_f32 v242, v242, v239
v_mul_f32 v248, v248, v239
v_cvt_pk_bf16_f32 v172, v242, v248
v_lshlrev_b32 v242, 16, v173
v_and_b32 v248, 0xffff0000, v173
v_mul_f32 v242, v242, v239
v_mul_f32 v248, v248, v239
v_cvt_pk_bf16_f32 v173, v242, v248
ds_read_b64 v[250:251], v231 offset:3072
s_waitcnt lgkmcnt(0)
v_lshlrev_b32 v242, 16, v250
v_and_b32 v248, 0xffff0000, v250
v_mul_f32 v242, v242, v239
v_mul_f32 v248, v248, v239
v_cvt_pk_bf16_f32 v250, v242, v248
v_lshlrev_b32 v242, 16, v251
v_and_b32 v248, 0xffff0000, v251
v_mul_f32 v242, v242, v239
v_mul_f32 v248, v248, v239
v_cvt_pk_bf16_f32 v251, v242, v248
ds_write_b64 v231, v[250:251] offset:3072
s_waitcnt lgkmcnt(0)
ds_read_b64 v[250:251], v231 offset:3080
s_waitcnt lgkmcnt(0)
v_lshlrev_b32 v242, 16, v250
v_and_b32 v248, 0xffff0000, v250
v_mul_f32 v242, v242, v239
v_mul_f32 v248, v248, v239
v_cvt_pk_bf16_f32 v250, v242, v248
v_lshlrev_b32 v242, 16, v251
v_and_b32 v248, 0xffff0000, v251
v_mul_f32 v242, v242, v239
v_mul_f32 v248, v248, v239
v_cvt_pk_bf16_f32 v251, v242, v248
ds_write_b64 v231, v[250:251] offset:3080
s_waitcnt lgkmcnt(0)
ds_read_b64 v[250:251], v231 offset:7168
s_waitcnt lgkmcnt(0)
v_lshlrev_b32 v242, 16, v250
v_and_b32 v248, 0xffff0000, v250
v_mul_f32 v242, v242, v239
v_mul_f32 v248, v248, v239
v_cvt_pk_bf16_f32 v250, v242, v248
v_lshlrev_b32 v242, 16, v251
v_and_b32 v248, 0xffff0000, v251
v_mul_f32 v242, v242, v239
v_mul_f32 v248, v248, v239
v_cvt_pk_bf16_f32 v251, v242, v248
ds_write_b64 v231, v[250:251] offset:7168
s_waitcnt lgkmcnt(0)
ds_read_b64 v[250:251], v231 offset:7176
s_waitcnt lgkmcnt(0)
v_lshlrev_b32 v242, 16, v250
v_and_b32 v248, 0xffff0000, v250
v_mul_f32 v242, v242, v239
v_mul_f32 v248, v248, v239
v_cvt_pk_bf16_f32 v250, v242, v248
v_lshlrev_b32 v242, 16, v251
v_and_b32 v248, 0xffff0000, v251
v_mul_f32 v242, v242, v239
v_mul_f32 v248, v248, v239
v_cvt_pk_bf16_f32 v251, v242, v248
ds_write_b64 v231, v[250:251] offset:7176
s_waitcnt lgkmcnt(0)
v_exp_f32 v232, v156
v_exp_f32 v233, v157
v_exp_f32 v234, v158
v_exp_f32 v235, v159
s_nop 1
v_cvt_pk_bf16_f32 v174, v232, v233
v_cvt_pk_bf16_f32 v175, v234, v235
s_branch L2_rare_common
L2_rare_site14:
s_mov_b32 s36, 14
s_branch L2_rare_t0_2
L2_rare_t0_2:
s_nop 15
s_nop 15
s_waitcnt lgkmcnt(0)
v_lshrrev_b32 v206, 8, v243
v_add_u32 v206, 1, v206
v_lshrrev_b32 v206, 2, v206
v_sub_u32 v206, 0, v206
v_and_b32 v206, 0xffff0000, v206
v_max_f32 v204, v128, v129
v_max3_f32 v204, v204, v130, v131
v_mov_b32 v205, v204
s_nop 1
v_permlane32_swap_b32 v204, v205
s_nop 1
v_max_f32 v204, v204, v205
v_mov_b32 v205, v204
s_nop 1
v_permlane16_swap_b32 v204, v205
s_nop 1
v_max_f32 v204, v204, v205
v_add_f32 v204, 40.0, v204
v_ceil_f32 v204, v204
v_max_f32 v204, 0, v204
v_sub_f32 v205, v224, v204
v_cvt_pk_bf16_f32 v205, v205, v205
v_and_b32 v205, 0xffff0000, v205
v_sub_f32 v204, v205, v224
v_mov_b32 v224, v205
v_exp_f32 v236, v204
v_bfi_b32 v3, v206, v205, v3
v_add_f32 v128, v128, v204
v_add_f32 v129, v129, v204
v_add_f32 v130, v130, v204
v_add_f32 v131, v131, v204
v_add_f32 v144, v144, v204
v_add_f32 v145, v145, v204
v_add_f32 v146, v146, v204
v_add_f32 v147, v147, v204
v_lshlrev_b32 v242, 16, v160
v_and_b32 v248, 0xffff0000, v160
v_mul_f32 v242, v242, v236
v_mul_f32 v248, v248, v236
v_cvt_pk_bf16_f32 v160, v242, v248
v_lshlrev_b32 v242, 16, v161
v_and_b32 v248, 0xffff0000, v161
v_mul_f32 v242, v242, v236
v_mul_f32 v248, v248, v236
v_cvt_pk_bf16_f32 v161, v242, v248
v_lshlrev_b32 v242, 16, v162
v_and_b32 v248, 0xffff0000, v162
v_mul_f32 v242, v242, v236
v_mul_f32 v248, v248, v236
v_cvt_pk_bf16_f32 v162, v242, v248
v_lshlrev_b32 v242, 16, v163
v_and_b32 v248, 0xffff0000, v163
v_mul_f32 v242, v242, v236
v_mul_f32 v248, v248, v236
v_cvt_pk_bf16_f32 v163, v242, v248
ds_read_b64 v[250:251], v231 offset:0
s_waitcnt lgkmcnt(0)
v_lshlrev_b32 v242, 16, v250
v_and_b32 v248, 0xffff0000, v250
v_mul_f32 v242, v242, v236
v_mul_f32 v248, v248, v236
v_cvt_pk_bf16_f32 v250, v242, v248
v_lshlrev_b32 v242, 16, v251
v_and_b32 v248, 0xffff0000, v251
v_mul_f32 v242, v242, v236
v_mul_f32 v248, v248, v236
v_cvt_pk_bf16_f32 v251, v242, v248
ds_write_b64 v231, v[250:251] offset:0
s_waitcnt lgkmcnt(0)
ds_read_b64 v[250:251], v231 offset:8
s_waitcnt lgkmcnt(0)
v_lshlrev_b32 v242, 16, v250
v_and_b32 v248, 0xffff0000, v250
v_mul_f32 v242, v242, v236
v_mul_f32 v248, v248, v236
v_cvt_pk_bf16_f32 v250, v242, v248
v_lshlrev_b32 v242, 16, v251
v_and_b32 v248, 0xffff0000, v251
v_mul_f32 v242, v242, v236
v_mul_f32 v248, v248, v236
v_cvt_pk_bf16_f32 v251, v242, v248
ds_write_b64 v231, v[250:251] offset:8
s_waitcnt lgkmcnt(0)
ds_read_b64 v[250:251], v231 offset:4096
s_waitcnt lgkmcnt(0)
v_lshlrev_b32 v242, 16, v250
v_and_b32 v248, 0xffff0000, v250
v_mul_f32 v242, v242, v236
v_mul_f32 v248, v248, v236
v_cvt_pk_bf16_f32 v250, v242, v248
v_lshlrev_b32 v242, 16, v251
v_and_b32 v248, 0xffff0000, v251
v_mul_f32 v242, v242, v236
v_mul_f32 v248, v248, v236
v_cvt_pk_bf16_f32 v251, v242, v248
ds_write_b64 v231, v[250:251] offset:4096
s_waitcnt lgkmcnt(0)
ds_read_b64 v[250:251], v231 offset:4104
s_waitcnt lgkmcnt(0)
v_lshlrev_b32 v242, 16, v250
v_and_b32 v248, 0xffff0000, v250
v_mul_f32 v242, v242, v236
v_mul_f32 v248, v248, v236
v_cvt_pk_bf16_f32 v250, v242, v248
v_lshlrev_b32 v242, 16, v251
v_and_b32 v248, 0xffff0000, v251
v_mul_f32 v242, v242, v236
v_mul_f32 v248, v248, v236
v_cvt_pk_bf16_f32 v251, v242, v248
ds_write_b64 v231, v[250:251] offset:4104
s_waitcnt lgkmcnt(0)
v_exp_f32 v232, v128
v_exp_f32 v233, v129
v_exp_f32 v234, v130
v_exp_f32 v235, v131
s_nop 1
v_cvt_pk_bf16_f32 v176, v232, v233
v_cvt_pk_bf16_f32 v177, v234, v235
v_max_f32 v204, v132, v133
v_max3_f32 v204, v204, v134, v135
v_mov_b32 v205, v204
s_nop 1
v_permlane32_swap_b32 v204, v205
s_nop 1
v_max_f32 v204, v204, v205
v_mov_b32 v205, v204
s_nop 1
v_permlane16_swap_b32 v204, v205
s_nop 1
v_max_f32 v204, v204, v205
v_add_f32 v204, 40.0, v204
v_ceil_f32 v204, v204
v_max_f32 v204, 0, v204
v_sub_f32 v205, v225, v204
v_cvt_pk_bf16_f32 v205, v205, v205
v_and_b32 v205, 0xffff0000, v205
v_sub_f32 v204, v205, v225
v_mov_b32 v225, v205
v_exp_f32 v237, v204
v_bfi_b32 v35, v206, v205, v35
v_add_f32 v132, v132, v204
v_add_f32 v133, v133, v204
v_add_f32 v134, v134, v204
v_add_f32 v135, v135, v204
v_add_f32 v148, v148, v204
v_add_f32 v149, v149, v204
v_add_f32 v150, v150, v204
v_add_f32 v151, v151, v204
v_lshlrev_b32 v242, 16, v164
v_and_b32 v248, 0xffff0000, v164
v_mul_f32 v242, v242, v237
v_mul_f32 v248, v248, v237
v_cvt_pk_bf16_f32 v164, v242, v248
v_lshlrev_b32 v242, 16, v165
v_and_b32 v248, 0xffff0000, v165
v_mul_f32 v242, v242, v237
v_mul_f32 v248, v248, v237
v_cvt_pk_bf16_f32 v165, v242, v248
v_lshlrev_b32 v242, 16, v166
v_and_b32 v248, 0xffff0000, v166
v_mul_f32 v242, v242, v237
v_mul_f32 v248, v248, v237
v_cvt_pk_bf16_f32 v166, v242, v248
v_lshlrev_b32 v242, 16, v167
v_and_b32 v248, 0xffff0000, v167
v_mul_f32 v242, v242, v237
v_mul_f32 v248, v248, v237
v_cvt_pk_bf16_f32 v167, v242, v248
ds_read_b64 v[250:251], v231 offset:1024
s_waitcnt lgkmcnt(0)
v_lshlrev_b32 v242, 16, v250
v_and_b32 v248, 0xffff0000, v250
v_mul_f32 v242, v242, v237
v_mul_f32 v248, v248, v237
v_cvt_pk_bf16_f32 v250, v242, v248
v_lshlrev_b32 v242, 16, v251
v_and_b32 v248, 0xffff0000, v251
v_mul_f32 v242, v242, v237
v_mul_f32 v248, v248, v237
v_cvt_pk_bf16_f32 v251, v242, v248
ds_write_b64 v231, v[250:251] offset:1024
s_waitcnt lgkmcnt(0)
ds_read_b64 v[250:251], v231 offset:1032
s_waitcnt lgkmcnt(0)
v_lshlrev_b32 v242, 16, v250
v_and_b32 v248, 0xffff0000, v250
v_mul_f32 v242, v242, v237
v_mul_f32 v248, v248, v237
v_cvt_pk_bf16_f32 v250, v242, v248
v_lshlrev_b32 v242, 16, v251
v_and_b32 v248, 0xffff0000, v251
v_mul_f32 v242, v242, v237
v_mul_f32 v248, v248, v237
v_cvt_pk_bf16_f32 v251, v242, v248
ds_write_b64 v231, v[250:251] offset:1032
s_waitcnt lgkmcnt(0)
ds_read_b64 v[250:251], v231 offset:5120
s_waitcnt lgkmcnt(0)
v_lshlrev_b32 v242, 16, v250
v_and_b32 v248, 0xffff0000, v250
v_mul_f32 v242, v242, v237
v_mul_f32 v248, v248, v237
v_cvt_pk_bf16_f32 v250, v242, v248
v_lshlrev_b32 v242, 16, v251
v_and_b32 v248, 0xffff0000, v251
v_mul_f32 v242, v242, v237
v_mul_f32 v248, v248, v237
v_cvt_pk_bf16_f32 v251, v242, v248
ds_write_b64 v231, v[250:251] offset:5120
s_waitcnt lgkmcnt(0)
ds_read_b64 v[250:251], v231 offset:5128
s_waitcnt lgkmcnt(0)
v_lshlrev_b32 v242, 16, v250
v_and_b32 v248, 0xffff0000, v250
v_mul_f32 v242, v242, v237
v_mul_f32 v248, v248, v237
v_cvt_pk_bf16_f32 v250, v242, v248
v_lshlrev_b32 v242, 16, v251
v_and_b32 v248, 0xffff0000, v251
v_mul_f32 v242, v242, v237
v_mul_f32 v248, v248, v237
v_cvt_pk_bf16_f32 v251, v242, v248
ds_write_b64 v231, v[250:251] offset:5128
s_waitcnt lgkmcnt(0)
v_exp_f32 v232, v132
v_exp_f32 v233, v133
v_exp_f32 v234, v134
v_exp_f32 v235, v135
s_nop 1
v_cvt_pk_bf16_f32 v180, v232, v233
v_cvt_pk_bf16_f32 v181, v234, v235
v_max_f32 v204, v136, v137
v_max3_f32 v204, v204, v138, v139
v_mov_b32 v205, v204
s_nop 1
v_permlane32_swap_b32 v204, v205
s_nop 1
v_max_f32 v204, v204, v205
v_mov_b32 v205, v204
s_nop 1
v_permlane16_swap_b32 v204, v205
s_nop 1
v_max_f32 v204, v204, v205
v_add_f32 v204, 40.0, v204
v_ceil_f32 v204, v204
v_max_f32 v204, 0, v204
v_sub_f32 v205, v226, v204
v_cvt_pk_bf16_f32 v205, v205, v205
v_and_b32 v205, 0xffff0000, v205
v_sub_f32 v204, v205, v226
v_mov_b32 v226, v205
v_exp_f32 v238, v204
v_bfi_b32 v67, v206, v205, v67
v_add_f32 v136, v136, v204
v_add_f32 v137, v137, v204
v_add_f32 v138, v138, v204
v_add_f32 v139, v139, v204
v_add_f32 v152, v152, v204
v_add_f32 v153, v153, v204
v_add_f32 v154, v154, v204
v_add_f32 v155, v155, v204
v_lshlrev_b32 v242, 16, v168
v_and_b32 v248, 0xffff0000, v168
v_mul_f32 v242, v242, v238
v_mul_f32 v248, v248, v238
v_cvt_pk_bf16_f32 v168, v242, v248
v_lshlrev_b32 v242, 16, v169
v_and_b32 v248, 0xffff0000, v169
v_mul_f32 v242, v242, v238
v_mul_f32 v248, v248, v238
v_cvt_pk_bf16_f32 v169, v242, v248
v_lshlrev_b32 v242, 16, v170
v_and_b32 v248, 0xffff0000, v170
v_mul_f32 v242, v242, v238
v_mul_f32 v248, v248, v238
v_cvt_pk_bf16_f32 v170, v242, v248
v_lshlrev_b32 v242, 16, v171
v_and_b32 v248, 0xffff0000, v171
v_mul_f32 v242, v242, v238
v_mul_f32 v248, v248, v238
v_cvt_pk_bf16_f32 v171, v242, v248
ds_read_b64 v[250:251], v231 offset:2048
s_waitcnt lgkmcnt(0)
v_lshlrev_b32 v242, 16, v250
v_and_b32 v248, 0xffff0000, v250
v_mul_f32 v242, v242, v238
v_mul_f32 v248, v248, v238
v_cvt_pk_bf16_f32 v250, v242, v248
v_lshlrev_b32 v242, 16, v251
v_and_b32 v248, 0xffff0000, v251
v_mul_f32 v242, v242, v238
v_mul_f32 v248, v248, v238
v_cvt_pk_bf16_f32 v251, v242, v248
ds_write_b64 v231, v[250:251] offset:2048
s_waitcnt lgkmcnt(0)
ds_read_b64 v[250:251], v231 offset:2056
s_waitcnt lgkmcnt(0)
v_lshlrev_b32 v242, 16, v250
v_and_b32 v248, 0xffff0000, v250
v_mul_f32 v242, v242, v238
v_mul_f32 v248, v248, v238
v_cvt_pk_bf16_f32 v250, v242, v248
v_lshlrev_b32 v242, 16, v251
v_and_b32 v248, 0xffff0000, v251
v_mul_f32 v242, v242, v238
v_mul_f32 v248, v248, v238
v_cvt_pk_bf16_f32 v251, v242, v248
ds_write_b64 v231, v[250:251] offset:2056
s_waitcnt lgkmcnt(0)
ds_read_b64 v[250:251], v231 offset:6144
s_waitcnt lgkmcnt(0)
v_lshlrev_b32 v242, 16, v250
v_and_b32 v248, 0xffff0000, v250
v_mul_f32 v242, v242, v238
v_mul_f32 v248, v248, v238
v_cvt_pk_bf16_f32 v250, v242, v248
v_lshlrev_b32 v242, 16, v251
v_and_b32 v248, 0xffff0000, v251
v_mul_f32 v242, v242, v238
v_mul_f32 v248, v248, v238
v_cvt_pk_bf16_f32 v251, v242, v248
ds_write_b64 v231, v[250:251] offset:6144
s_waitcnt lgkmcnt(0)
ds_read_b64 v[250:251], v231 offset:6152
s_waitcnt lgkmcnt(0)
v_lshlrev_b32 v242, 16, v250
v_and_b32 v248, 0xffff0000, v250
v_mul_f32 v242, v242, v238
v_mul_f32 v248, v248, v238
v_cvt_pk_bf16_f32 v250, v242, v248
v_lshlrev_b32 v242, 16, v251
v_and_b32 v248, 0xffff0000, v251
v_mul_f32 v242, v242, v238
v_mul_f32 v248, v248, v238
v_cvt_pk_bf16_f32 v251, v242, v248
ds_write_b64 v231, v[250:251] offset:6152
s_waitcnt lgkmcnt(0)
v_exp_f32 v232, v136
v_exp_f32 v233, v137
v_exp_f32 v234, v138
v_exp_f32 v235, v139
s_nop 1
v_cvt_pk_bf16_f32 v184, v232, v233
v_cvt_pk_bf16_f32 v185, v234, v235
v_max_f32 v204, v140, v141
v_max3_f32 v204, v204, v142, v143
v_mov_b32 v205, v204
s_nop 1
v_permlane32_swap_b32 v204, v205
s_nop 1
v_max_f32 v204, v204, v205
v_mov_b32 v205, v204
s_nop 1
v_permlane16_swap_b32 v204, v205
s_nop 1
v_max_f32 v204, v204, v205
v_add_f32 v204, 40.0, v204
v_ceil_f32 v204, v204
v_max_f32 v204, 0, v204
v_sub_f32 v205, v227, v204
v_cvt_pk_bf16_f32 v205, v205, v205
v_and_b32 v205, 0xffff0000, v205
v_sub_f32 v204, v205, v227
v_mov_b32 v227, v205
v_exp_f32 v239, v204
v_bfi_b32 v99, v206, v205, v99
v_add_f32 v140, v140, v204
v_add_f32 v141, v141, v204
v_add_f32 v142, v142, v204
v_add_f32 v143, v143, v204
v_add_f32 v156, v156, v204
v_add_f32 v157, v157, v204
v_add_f32 v158, v158, v204
v_add_f32 v159, v159, v204
v_lshlrev_b32 v242, 16, v172
v_and_b32 v248, 0xffff0000, v172
v_mul_f32 v242, v242, v239
v_mul_f32 v248, v248, v239
v_cvt_pk_bf16_f32 v172, v242, v248
v_lshlrev_b32 v242, 16, v173
v_and_b32 v248, 0xffff0000, v173
v_mul_f32 v242, v242, v239
v_mul_f32 v248, v248, v239
v_cvt_pk_bf16_f32 v173, v242, v248
v_lshlrev_b32 v242, 16, v174
v_and_b32 v248, 0xffff0000, v174
v_mul_f32 v242, v242, v239
v_mul_f32 v248, v248, v239
v_cvt_pk_bf16_f32 v174, v242, v248
v_lshlrev_b32 v242, 16, v175
v_and_b32 v248, 0xffff0000, v175
v_mul_f32 v242, v242, v239
v_mul_f32 v248, v248, v239
v_cvt_pk_bf16_f32 v175, v242, v248
ds_read_b64 v[250:251], v231 offset:3072
s_waitcnt lgkmcnt(0)
v_lshlrev_b32 v242, 16, v250
v_and_b32 v248, 0xffff0000, v250
v_mul_f32 v242, v242, v239
v_mul_f32 v248, v248, v239
v_cvt_pk_bf16_f32 v250, v242, v248
v_lshlrev_b32 v242, 16, v251
v_and_b32 v248, 0xffff0000, v251
v_mul_f32 v242, v242, v239
v_mul_f32 v248, v248, v239
v_cvt_pk_bf16_f32 v251, v242, v248
ds_write_b64 v231, v[250:251] offset:3072
s_waitcnt lgkmcnt(0)
ds_read_b64 v[250:251], v231 offset:3080
s_waitcnt lgkmcnt(0)
v_lshlrev_b32 v242, 16, v250
v_and_b32 v248, 0xffff0000, v250
v_mul_f32 v242, v242, v239
v_mul_f32 v248, v248, v239
v_cvt_pk_bf16_f32 v250, v242, v248
v_lshlrev_b32 v242, 16, v251
v_and_b32 v248, 0xffff0000, v251
v_mul_f32 v242, v242, v239
v_mul_f32 v248, v248, v239
v_cvt_pk_bf16_f32 v251, v242, v248
ds_write_b64 v231, v[250:251] offset:3080
s_waitcnt lgkmcnt(0)
ds_read_b64 v[250:251], v231 offset:7168
s_waitcnt lgkmcnt(0)
v_lshlrev_b32 v242, 16, v250
v_and_b32 v248, 0xffff0000, v250
v_mul_f32 v242, v242, v239
v_mul_f32 v248, v248, v239
v_cvt_pk_bf16_f32 v250, v242, v248
v_lshlrev_b32 v242, 16, v251
v_and_b32 v248, 0xffff0000, v251
v_mul_f32 v242, v242, v239
v_mul_f32 v248, v248, v239
v_cvt_pk_bf16_f32 v251, v242, v248
ds_write_b64 v231, v[250:251] offset:7168
s_waitcnt lgkmcnt(0)
ds_read_b64 v[250:251], v231 offset:7176
s_waitcnt lgkmcnt(0)
v_lshlrev_b32 v242, 16, v250
v_and_b32 v248, 0xffff0000, v250
v_mul_f32 v242, v242, v239
v_mul_f32 v248, v248, v239
v_cvt_pk_bf16_f32 v250, v242, v248
v_lshlrev_b32 v242, 16, v251
v_and_b32 v248, 0xffff0000, v251
v_mul_f32 v242, v242, v239
v_mul_f32 v248, v248, v239
v_cvt_pk_bf16_f32 v251, v242, v248
ds_write_b64 v231, v[250:251] offset:7176
s_waitcnt lgkmcnt(0)
v_exp_f32 v232, v140
v_exp_f32 v233, v141
v_exp_f32 v234, v142
v_exp_f32 v235, v143
s_nop 1
v_cvt_pk_bf16_f32 v188, v232, v233
v_cvt_pk_bf16_f32 v189, v234, v235
s_branch L2_rare_common
L2_rare_site15:
s_mov_b32 s36, 15
s_branch L2_rare_t0_3
L2_rare_t0_3:
s_nop 15
s_nop 15
s_waitcnt lgkmcnt(0)
v_lshrrev_b32 v206, 8, v243
v_add_u32 v206, 1, v206
v_lshrrev_b32 v206, 2, v206
v_sub_u32 v206, 0, v206
v_and_b32 v206, 0xffff0000, v206
v_max_f32 v204, v144, v145
v_max3_f32 v204, v204, v146, v147
v_mov_b32 v205, v204
s_nop 1
v_permlane32_swap_b32 v204, v205
s_nop 1
v_max_f32 v204, v204, v205
v_mov_b32 v205, v204
s_nop 1
v_permlane16_swap_b32 v204, v205
s_nop 1
v_max_f32 v204, v204, v205
v_add_f32 v204, 40.0, v204
v_ceil_f32 v204, v204
v_max_f32 v204, 0, v204
v_sub_f32 v205, v224, v204
v_cvt_pk_bf16_f32 v205, v205, v205
v_and_b32 v205, 0xffff0000, v205
v_sub_f32 v204, v205, v224
v_mov_b32 v224, v205
v_exp_f32 v236, v204
v_bfi_b32 v3, v206, v205, v3
v_add_f32 v144, v144, v204
v_add_f32 v145, v145, v204
v_add_f32 v146, v146, v204
v_add_f32 v147, v147, v204
v_add_f32 v128, v128, v204
v_add_f32 v129, v129, v204
v_add_f32 v130, v130, v204
v_add_f32 v131, v131, v204
v_lshlrev_b32 v242, 16, v160
v_and_b32 v248, 0xffff0000, v160
v_mul_f32 v242, v242, v236
v_mul_f32 v248, v248, v236
v_cvt_pk_bf16_f32 v160, v242, v248
v_lshlrev_b32 v242, 16, v161
v_and_b32 v248, 0xffff0000, v161
v_mul_f32 v242, v242, v236
v_mul_f32 v248, v248, v236
v_cvt_pk_bf16_f32 v161, v242, v248
v_lshlrev_b32 v242, 16, v162
v_and_b32 v248, 0xffff0000, v162
v_mul_f32 v242, v242, v236
v_mul_f32 v248, v248, v236
v_cvt_pk_bf16_f32 v162, v242, v248
v_lshlrev_b32 v242, 16, v163
v_and_b32 v248, 0xffff0000, v163
v_mul_f32 v242, v242, v236
v_mul_f32 v248, v248, v236
v_cvt_pk_bf16_f32 v163, v242, v248
v_lshlrev_b32 v242, 16, v176
v_and_b32 v248, 0xffff0000, v176
v_mul_f32 v242, v242, v236
v_mul_f32 v248, v248, v236
v_cvt_pk_bf16_f32 v176, v242, v248
v_lshlrev_b32 v242, 16, v177
v_and_b32 v248, 0xffff0000, v177
v_mul_f32 v242, v242, v236
v_mul_f32 v248, v248, v236
v_cvt_pk_bf16_f32 v177, v242, v248
ds_read_b64 v[250:251], v231 offset:0
s_waitcnt lgkmcnt(0)
v_lshlrev_b32 v242, 16, v250
v_and_b32 v248, 0xffff0000, v250
v_mul_f32 v242, v242, v236
v_mul_f32 v248, v248, v236
v_cvt_pk_bf16_f32 v250, v242, v248
v_lshlrev_b32 v242, 16, v251
v_and_b32 v248, 0xffff0000, v251
v_mul_f32 v242, v242, v236
v_mul_f32 v248, v248, v236
v_cvt_pk_bf16_f32 v251, v242, v248
ds_write_b64 v231, v[250:251] offset:0
s_waitcnt lgkmcnt(0)
ds_read_b64 v[250:251], v231 offset:8
s_waitcnt lgkmcnt(0)
v_lshlrev_b32 v242, 16, v250
v_and_b32 v248, 0xffff0000, v250
v_mul_f32 v242, v242, v236
v_mul_f32 v248, v248, v236
v_cvt_pk_bf16_f32 v250, v242, v248
v_lshlrev_b32 v242, 16, v251
v_and_b32 v248, 0xffff0000, v251
v_mul_f32 v242, v242, v236
v_mul_f32 v248, v248, v236
v_cvt_pk_bf16_f32 v251, v242, v248
ds_write_b64 v231, v[250:251] offset:8
s_waitcnt lgkmcnt(0)
ds_read_b64 v[250:251], v231 offset:4096
s_waitcnt lgkmcnt(0)
v_lshlrev_b32 v242, 16, v250
v_and_b32 v248, 0xffff0000, v250
v_mul_f32 v242, v242, v236
v_mul_f32 v248, v248, v236
v_cvt_pk_bf16_f32 v250, v242, v248
v_lshlrev_b32 v242, 16, v251
v_and_b32 v248, 0xffff0000, v251
v_mul_f32 v242, v242, v236
v_mul_f32 v248, v248, v236
v_cvt_pk_bf16_f32 v251, v242, v248
ds_write_b64 v231, v[250:251] offset:4096
s_waitcnt lgkmcnt(0)
ds_read_b64 v[250:251], v231 offset:4104
s_waitcnt lgkmcnt(0)
v_lshlrev_b32 v242, 16, v250
v_and_b32 v248, 0xffff0000, v250
v_mul_f32 v242, v242, v236
v_mul_f32 v248, v248, v236
v_cvt_pk_bf16_f32 v250, v242, v248
v_lshlrev_b32 v242, 16, v251
v_and_b32 v248, 0xffff0000, v251
v_mul_f32 v242, v242, v236
v_mul_f32 v248, v248, v236
v_cvt_pk_bf16_f32 v251, v242, v248
ds_write_b64 v231, v[250:251] offset:4104
s_waitcnt lgkmcnt(0)
v_exp_f32 v232, v144
v_exp_f32 v233, v145
v_exp_f32 v234, v146
v_exp_f32 v235, v147
s_nop 1
v_cvt_pk_bf16_f32 v178, v232, v233
v_cvt_pk_bf16_f32 v179, v234, v235
v_max_f32 v204, v148, v149
v_max3_f32 v204, v204, v150, v151
v_mov_b32 v205, v204
s_nop 1
v_permlane32_swap_b32 v204, v205
s_nop 1
v_max_f32 v204, v204, v205
v_mov_b32 v205, v204
s_nop 1
v_permlane16_swap_b32 v204, v205
s_nop 1
v_max_f32 v204, v204, v205
v_add_f32 v204, 40.0, v204
v_ceil_f32 v204, v204
v_max_f32 v204, 0, v204
v_sub_f32 v205, v225, v204
v_cvt_pk_bf16_f32 v205, v205, v205
v_and_b32 v205, 0xffff0000, v205
v_sub_f32 v204, v205, v225
v_mov_b32 v225, v205
v_exp_f32 v237, v204
v_bfi_b32 v35, v206, v205, v35
v_add_f32 v148, v148, v204
v_add_f32 v149, v149, v204
v_add_f32 v150, v150, v204
v_add_f32 v151, v151, v204
v_add_f32 v132, v132, v204
v_add_f32 v133, v133, v204
v_add_f32 v134, v134, v204
v_add_f32 v135, v135, v204
v_lshlrev_b32 v242, 16, v164
v_and_b32 v248, 0xffff0000, v164
v_mul_f32 v242, v242, v237
v_mul_f32 v248, v248, v237
v_cvt_pk_bf16_f32 v164, v242, v248
v_lshlrev_b32 v242, 16, v165
v_and_b32 v248, 0xffff0000, v165
v_mul_f32 v242, v242, v237
v_mul_f32 v248, v248, v237
v_cvt_pk_bf16_f32 v165, v242, v248
v_lshlrev_b32 v242, 16, v166
v_and_b32 v248, 0xffff0000, v166
v_mul_f32 v242, v242, v237
v_mul_f32 v248, v248, v237
v_cvt_pk_bf16_f32 v166, v242, v248
v_lshlrev_b32 v242, 16, v167
v_and_b32 v248, 0xffff0000, v167
v_mul_f32 v242, v242, v237
v_mul_f32 v248, v248, v237
v_cvt_pk_bf16_f32 v167, v242, v248
v_lshlrev_b32 v242, 16, v180
v_and_b32 v248, 0xffff0000, v180
v_mul_f32 v242, v242, v237
v_mul_f32 v248, v248, v237
v_cvt_pk_bf16_f32 v180, v242, v248
v_lshlrev_b32 v242, 16, v181
v_and_b32 v248, 0xffff0000, v181
v_mul_f32 v242, v242, v237
v_mul_f32 v248, v248, v237
v_cvt_pk_bf16_f32 v181, v242, v248
ds_read_b64 v[250:251], v231 offset:1024
s_waitcnt lgkmcnt(0)
v_lshlrev_b32 v242, 16, v250
v_and_b32 v248, 0xffff0000, v250
v_mul_f32 v242, v242, v237
v_mul_f32 v248, v248, v237
v_cvt_pk_bf16_f32 v250, v242, v248
v_lshlrev_b32 v242, 16, v251
v_and_b32 v248, 0xffff0000, v251
v_mul_f32 v242, v242, v237
v_mul_f32 v248, v248, v237
v_cvt_pk_bf16_f32 v251, v242, v248
ds_write_b64 v231, v[250:251] offset:1024
s_waitcnt lgkmcnt(0)
ds_read_b64 v[250:251], v231 offset:1032
s_waitcnt lgkmcnt(0)
v_lshlrev_b32 v242, 16, v250
v_and_b32 v248, 0xffff0000, v250
v_mul_f32 v242, v242, v237
v_mul_f32 v248, v248, v237
v_cvt_pk_bf16_f32 v250, v242, v248
v_lshlrev_b32 v242, 16, v251
v_and_b32 v248, 0xffff0000, v251
v_mul_f32 v242, v242, v237
v_mul_f32 v248, v248, v237
v_cvt_pk_bf16_f32 v251, v242, v248
ds_write_b64 v231, v[250:251] offset:1032
s_waitcnt lgkmcnt(0)
ds_read_b64 v[250:251], v231 offset:5120
s_waitcnt lgkmcnt(0)
v_lshlrev_b32 v242, 16, v250
v_and_b32 v248, 0xffff0000, v250
v_mul_f32 v242, v242, v237
v_mul_f32 v248, v248, v237
v_cvt_pk_bf16_f32 v250, v242, v248
v_lshlrev_b32 v242, 16, v251
v_and_b32 v248, 0xffff0000, v251
v_mul_f32 v242, v242, v237
v_mul_f32 v248, v248, v237
v_cvt_pk_bf16_f32 v251, v242, v248
ds_write_b64 v231, v[250:251] offset:5120
s_waitcnt lgkmcnt(0)
ds_read_b64 v[250:251], v231 offset:5128
s_waitcnt lgkmcnt(0)
v_lshlrev_b32 v242, 16, v250
v_and_b32 v248, 0xffff0000, v250
v_mul_f32 v242, v242, v237
v_mul_f32 v248, v248, v237
v_cvt_pk_bf16_f32 v250, v242, v248
v_lshlrev_b32 v242, 16, v251
v_and_b32 v248, 0xffff0000, v251
v_mul_f32 v242, v242, v237
v_mul_f32 v248, v248, v237
v_cvt_pk_bf16_f32 v251, v242, v248
ds_write_b64 v231, v[250:251] offset:5128
s_waitcnt lgkmcnt(0)
v_exp_f32 v232, v148
v_exp_f32 v233, v149
v_exp_f32 v234, v150
v_exp_f32 v235, v151
s_nop 1
v_cvt_pk_bf16_f32 v182, v232, v233
v_cvt_pk_bf16_f32 v183, v234, v235
v_max_f32 v204, v152, v153
v_max3_f32 v204, v204, v154, v155
v_mov_b32 v205, v204
s_nop 1
v_permlane32_swap_b32 v204, v205
s_nop 1
v_max_f32 v204, v204, v205
v_mov_b32 v205, v204
s_nop 1
v_permlane16_swap_b32 v204, v205
s_nop 1
v_max_f32 v204, v204, v205
v_add_f32 v204, 40.0, v204
v_ceil_f32 v204, v204
v_max_f32 v204, 0, v204
v_sub_f32 v205, v226, v204
v_cvt_pk_bf16_f32 v205, v205, v205
v_and_b32 v205, 0xffff0000, v205
v_sub_f32 v204, v205, v226
v_mov_b32 v226, v205
v_exp_f32 v238, v204
v_bfi_b32 v67, v206, v205, v67
v_add_f32 v152, v152, v204
v_add_f32 v153, v153, v204
v_add_f32 v154, v154, v204
v_add_f32 v155, v155, v204
v_add_f32 v136, v136, v204
v_add_f32 v137, v137, v204
v_add_f32 v138, v138, v204
v_add_f32 v139, v139, v204
v_lshlrev_b32 v242, 16, v168
v_and_b32 v248, 0xffff0000, v168
v_mul_f32 v242, v242, v238
v_mul_f32 v248, v248, v238
v_cvt_pk_bf16_f32 v168, v242, v248
v_lshlrev_b32 v242, 16, v169
v_and_b32 v248, 0xffff0000, v169
v_mul_f32 v242, v242, v238
v_mul_f32 v248, v248, v238
v_cvt_pk_bf16_f32 v169, v242, v248
v_lshlrev_b32 v242, 16, v170
v_and_b32 v248, 0xffff0000, v170
v_mul_f32 v242, v242, v238
v_mul_f32 v248, v248, v238
v_cvt_pk_bf16_f32 v170, v242, v248
v_lshlrev_b32 v242, 16, v171
v_and_b32 v248, 0xffff0000, v171
v_mul_f32 v242, v242, v238
v_mul_f32 v248, v248, v238
v_cvt_pk_bf16_f32 v171, v242, v248
v_lshlrev_b32 v242, 16, v184
v_and_b32 v248, 0xffff0000, v184
v_mul_f32 v242, v242, v238
v_mul_f32 v248, v248, v238
v_cvt_pk_bf16_f32 v184, v242, v248
v_lshlrev_b32 v242, 16, v185
v_and_b32 v248, 0xffff0000, v185
v_mul_f32 v242, v242, v238
v_mul_f32 v248, v248, v238
v_cvt_pk_bf16_f32 v185, v242, v248
ds_read_b64 v[250:251], v231 offset:2048
s_waitcnt lgkmcnt(0)
v_lshlrev_b32 v242, 16, v250
v_and_b32 v248, 0xffff0000, v250
v_mul_f32 v242, v242, v238
v_mul_f32 v248, v248, v238
v_cvt_pk_bf16_f32 v250, v242, v248
v_lshlrev_b32 v242, 16, v251
v_and_b32 v248, 0xffff0000, v251
v_mul_f32 v242, v242, v238
v_mul_f32 v248, v248, v238
v_cvt_pk_bf16_f32 v251, v242, v248
ds_write_b64 v231, v[250:251] offset:2048
s_waitcnt lgkmcnt(0)
ds_read_b64 v[250:251], v231 offset:2056
s_waitcnt lgkmcnt(0)
v_lshlrev_b32 v242, 16, v250
v_and_b32 v248, 0xffff0000, v250
v_mul_f32 v242, v242, v238
v_mul_f32 v248, v248, v238
v_cvt_pk_bf16_f32 v250, v242, v248
v_lshlrev_b32 v242, 16, v251
v_and_b32 v248, 0xffff0000, v251
v_mul_f32 v242, v242, v238
v_mul_f32 v248, v248, v238
v_cvt_pk_bf16_f32 v251, v242, v248
ds_write_b64 v231, v[250:251] offset:2056
s_waitcnt lgkmcnt(0)
ds_read_b64 v[250:251], v231 offset:6144
s_waitcnt lgkmcnt(0)
v_lshlrev_b32 v242, 16, v250
v_and_b32 v248, 0xffff0000, v250
v_mul_f32 v242, v242, v238
v_mul_f32 v248, v248, v238
v_cvt_pk_bf16_f32 v250, v242, v248
v_lshlrev_b32 v242, 16, v251
v_and_b32 v248, 0xffff0000, v251
v_mul_f32 v242, v242, v238
v_mul_f32 v248, v248, v238
v_cvt_pk_bf16_f32 v251, v242, v248
ds_write_b64 v231, v[250:251] offset:6144
s_waitcnt lgkmcnt(0)
ds_read_b64 v[250:251], v231 offset:6152
s_waitcnt lgkmcnt(0)
v_lshlrev_b32 v242, 16, v250
v_and_b32 v248, 0xffff0000, v250
v_mul_f32 v242, v242, v238
v_mul_f32 v248, v248, v238
v_cvt_pk_bf16_f32 v250, v242, v248
v_lshlrev_b32 v242, 16, v251
v_and_b32 v248, 0xffff0000, v251
v_mul_f32 v242, v242, v238
v_mul_f32 v248, v248, v238
v_cvt_pk_bf16_f32 v251, v242, v248
ds_write_b64 v231, v[250:251] offset:6152
s_waitcnt lgkmcnt(0)
v_exp_f32 v232, v152
v_exp_f32 v233, v153
v_exp_f32 v234, v154
v_exp_f32 v235, v155
s_nop 1
v_cvt_pk_bf16_f32 v186, v232, v233
v_cvt_pk_bf16_f32 v187, v234, v235
v_max_f32 v204, v156, v157
v_max3_f32 v204, v204, v158, v159
v_mov_b32 v205, v204
s_nop 1
v_permlane32_swap_b32 v204, v205
s_nop 1
v_max_f32 v204, v204, v205
v_mov_b32 v205, v204
s_nop 1
v_permlane16_swap_b32 v204, v205
s_nop 1
v_max_f32 v204, v204, v205
v_add_f32 v204, 40.0, v204
v_ceil_f32 v204, v204
v_max_f32 v204, 0, v204
v_sub_f32 v205, v227, v204
v_cvt_pk_bf16_f32 v205, v205, v205
v_and_b32 v205, 0xffff0000, v205
v_sub_f32 v204, v205, v227
v_mov_b32 v227, v205
v_exp_f32 v239, v204
v_bfi_b32 v99, v206, v205, v99
v_add_f32 v156, v156, v204
v_add_f32 v157, v157, v204
v_add_f32 v158, v158, v204
v_add_f32 v159, v159, v204
v_add_f32 v140, v140, v204
v_add_f32 v141, v141, v204
v_add_f32 v142, v142, v204
v_add_f32 v143, v143, v204
v_lshlrev_b32 v242, 16, v172
v_and_b32 v248, 0xffff0000, v172
v_mul_f32 v242, v242, v239
v_mul_f32 v248, v248, v239
v_cvt_pk_bf16_f32 v172, v242, v248
v_lshlrev_b32 v242, 16, v173
v_and_b32 v248, 0xffff0000, v173
v_mul_f32 v242, v242, v239
v_mul_f32 v248, v248, v239
v_cvt_pk_bf16_f32 v173, v242, v248
v_lshlrev_b32 v242, 16, v174
v_and_b32 v248, 0xffff0000, v174
v_mul_f32 v242, v242, v239
v_mul_f32 v248, v248, v239
v_cvt_pk_bf16_f32 v174, v242, v248
v_lshlrev_b32 v242, 16, v175
v_and_b32 v248, 0xffff0000, v175
v_mul_f32 v242, v242, v239
v_mul_f32 v248, v248, v239
v_cvt_pk_bf16_f32 v175, v242, v248
v_lshlrev_b32 v242, 16, v188
v_and_b32 v248, 0xffff0000, v188
v_mul_f32 v242, v242, v239
v_mul_f32 v248, v248, v239
v_cvt_pk_bf16_f32 v188, v242, v248
v_lshlrev_b32 v242, 16, v189
v_and_b32 v248, 0xffff0000, v189
v_mul_f32 v242, v242, v239
v_mul_f32 v248, v248, v239
v_cvt_pk_bf16_f32 v189, v242, v248
ds_read_b64 v[250:251], v231 offset:3072
s_waitcnt lgkmcnt(0)
v_lshlrev_b32 v242, 16, v250
v_and_b32 v248, 0xffff0000, v250
v_mul_f32 v242, v242, v239
v_mul_f32 v248, v248, v239
v_cvt_pk_bf16_f32 v250, v242, v248
v_lshlrev_b32 v242, 16, v251
v_and_b32 v248, 0xffff0000, v251
v_mul_f32 v242, v242, v239
v_mul_f32 v248, v248, v239
v_cvt_pk_bf16_f32 v251, v242, v248
ds_write_b64 v231, v[250:251] offset:3072
s_waitcnt lgkmcnt(0)
ds_read_b64 v[250:251], v231 offset:3080
s_waitcnt lgkmcnt(0)
v_lshlrev_b32 v242, 16, v250
v_and_b32 v248, 0xffff0000, v250
v_mul_f32 v242, v242, v239
v_mul_f32 v248, v248, v239
v_cvt_pk_bf16_f32 v250, v242, v248
v_lshlrev_b32 v242, 16, v251
v_and_b32 v248, 0xffff0000, v251
v_mul_f32 v242, v242, v239
v_mul_f32 v248, v248, v239
v_cvt_pk_bf16_f32 v251, v242, v248
ds_write_b64 v231, v[250:251] offset:3080
s_waitcnt lgkmcnt(0)
ds_read_b64 v[250:251], v231 offset:7168
s_waitcnt lgkmcnt(0)
v_lshlrev_b32 v242, 16, v250
v_and_b32 v248, 0xffff0000, v250
v_mul_f32 v242, v242, v239
v_mul_f32 v248, v248, v239
v_cvt_pk_bf16_f32 v250, v242, v248
v_lshlrev_b32 v242, 16, v251
v_and_b32 v248, 0xffff0000, v251
v_mul_f32 v242, v242, v239
v_mul_f32 v248, v248, v239
v_cvt_pk_bf16_f32 v251, v242, v248
ds_write_b64 v231, v[250:251] offset:7168
s_waitcnt lgkmcnt(0)
ds_read_b64 v[250:251], v231 offset:7176
s_waitcnt lgkmcnt(0)
v_lshlrev_b32 v242, 16, v250
v_and_b32 v248, 0xffff0000, v250
v_mul_f32 v242, v242, v239
v_mul_f32 v248, v248, v239
v_cvt_pk_bf16_f32 v250, v242, v248
v_lshlrev_b32 v242, 16, v251
v_and_b32 v248, 0xffff0000, v251
v_mul_f32 v242, v242, v239
v_mul_f32 v248, v248, v239
v_cvt_pk_bf16_f32 v251, v242, v248
ds_write_b64 v231, v[250:251] offset:7176
s_waitcnt lgkmcnt(0)
v_exp_f32 v232, v156
v_exp_f32 v233, v157
v_exp_f32 v234, v158
v_exp_f32 v235, v159
s_nop 1
v_cvt_pk_bf16_f32 v190, v232, v233
v_cvt_pk_bf16_f32 v191, v234, v235
s_branch L2_rare_common
L2_rare_site16:
s_mov_b32 s36, 16
s_branch L2_rare_t0_4
L2_rare_t0_4:
s_nop 15
s_nop 15
s_waitcnt lgkmcnt(0)
v_lshrrev_b32 v206, 8, v243
v_add_u32 v206, 1, v206
v_lshrrev_b32 v206, 2, v206
v_sub_u32 v206, 0, v206
v_and_b32 v206, 0xffff0000, v206
v_max_f32 v204, v128, v129
v_max3_f32 v204, v204, v130, v131
v_mov_b32 v205, v204
s_nop 1
v_permlane32_swap_b32 v204, v205
s_nop 1
v_max_f32 v204, v204, v205
v_mov_b32 v205, v204
s_nop 1
v_permlane16_swap_b32 v204, v205
s_nop 1
v_max_f32 v204, v204, v205
v_add_f32 v204, 40.0, v204
v_ceil_f32 v204, v204
v_max_f32 v204, 0, v204
v_sub_f32 v205, v224, v204
v_cvt_pk_bf16_f32 v205, v205, v205
v_and_b32 v205, 0xffff0000, v205
v_sub_f32 v204, v205, v224
v_mov_b32 v224, v205
v_exp_f32 v236, v204
v_add_f32 v128, v128, v204
v_add_f32 v129, v129, v204
v_add_f32 v130, v130, v204
v_add_f32 v131, v131, v204
v_add_f32 v144, v144, v204
v_add_f32 v145, v145, v204
v_add_f32 v146, v146, v204
v_add_f32 v147, v147, v204
v_lshlrev_b32 v242, 16, v4
v_and_b32 v248, 0xffff0000, v4
v_mul_f32 v242, v242, v236
v_mul_f32 v248, v248, v236
v_cvt_pk_bf16_f32 v4, v242, v248
v_lshlrev_b32 v242, 16, v5
v_and_b32 v248, 0xffff0000, v5
v_mul_f32 v242, v242, v236
v_mul_f32 v248, v248, v236
v_cvt_pk_bf16_f32 v5, v242, v248
v_lshlrev_b32 v242, 16, v6
v_and_b32 v248, 0xffff0000, v6
v_mul_f32 v242, v242, v236
v_mul_f32 v248, v248, v236
v_cvt_pk_bf16_f32 v6, v242, v248
v_lshlrev_b32 v242, 16, v7
v_and_b32 v248, 0xffff0000, v7
v_mul_f32 v242, v242, v236
v_mul_f32 v248, v248, v236
v_cvt_pk_bf16_f32 v7, v242, v248
v_lshlrev_b32 v242, 16, v8
v_and_b32 v248, 0xffff0000, v8
v_mul_f32 v242, v242, v236
v_mul_f32 v248, v248, v236
v_cvt_pk_bf16_f32 v8, v242, v248
v_lshlrev_b32 v242, 16, v9
v_and_b32 v248, 0xffff0000, v9
v_mul_f32 v242, v242, v236
v_mul_f32 v248, v248, v236
v_cvt_pk_bf16_f32 v9, v242, v248
v_lshlrev_b32 v242, 16, v10
v_and_b32 v248, 0xffff0000, v10
v_mul_f32 v242, v242, v236
v_mul_f32 v248, v248, v236
v_cvt_pk_bf16_f32 v10, v242, v248
v_lshlrev_b32 v242, 16, v11
v_and_b32 v248, 0xffff0000, v11
v_mul_f32 v242, v242, v236
v_mul_f32 v248, v248, v236
v_cvt_pk_bf16_f32 v11, v242, v248
v_lshlrev_b32 v242, 16, v160
v_and_b32 v248, 0xffff0000, v160
v_mul_f32 v242, v242, v236
v_mul_f32 v248, v248, v236
v_cvt_pk_bf16_f32 v160, v242, v248
v_lshlrev_b32 v242, 16, v161
v_and_b32 v248, 0xffff0000, v161
v_mul_f32 v242, v242, v236
v_mul_f32 v248, v248, v236
v_cvt_pk_bf16_f32 v161, v242, v248
v_lshlrev_b32 v242, 16, v162
v_and_b32 v248, 0xffff0000, v162
v_mul_f32 v242, v242, v236
v_mul_f32 v248, v248, v236
v_cvt_pk_bf16_f32 v162, v242, v248
v_lshlrev_b32 v242, 16, v163
v_and_b32 v248, 0xffff0000, v163
v_mul_f32 v242, v242, v236
v_mul_f32 v248, v248, v236
v_cvt_pk_bf16_f32 v163, v242, v248
v_lshlrev_b32 v242, 16, v176
v_and_b32 v248, 0xffff0000, v176
v_mul_f32 v242, v242, v236
v_mul_f32 v248, v248, v236
v_cvt_pk_bf16_f32 v176, v242, v248
v_lshlrev_b32 v242, 16, v177
v_and_b32 v248, 0xffff0000, v177
v_mul_f32 v242, v242, v236
v_mul_f32 v248, v248, v236
v_cvt_pk_bf16_f32 v177, v242, v248
v_lshlrev_b32 v242, 16, v178
v_and_b32 v248, 0xffff0000, v178
v_mul_f32 v242, v242, v236
v_mul_f32 v248, v248, v236
v_cvt_pk_bf16_f32 v178, v242, v248
v_lshlrev_b32 v242, 16, v179
v_and_b32 v248, 0xffff0000, v179
v_mul_f32 v242, v242, v236
v_mul_f32 v248, v248, v236
v_cvt_pk_bf16_f32 v179, v242, v248
v_exp_f32 v232, v128
v_exp_f32 v233, v129
v_exp_f32 v234, v130
v_exp_f32 v235, v131
s_nop 1
v_cvt_pk_bf16_f32 v0, v232, v233
v_cvt_pk_bf16_f32 v1, v234, v235
v_max_f32 v204, v132, v133
v_max3_f32 v204, v204, v134, v135
v_mov_b32 v205, v204
s_nop 1
v_permlane32_swap_b32 v204, v205
s_nop 1
v_max_f32 v204, v204, v205
v_mov_b32 v205, v204
s_nop 1
v_permlane16_swap_b32 v204, v205
s_nop 1
v_max_f32 v204, v204, v205
v_add_f32 v204, 40.0, v204
v_ceil_f32 v204, v204
v_max_f32 v204, 0, v204
v_sub_f32 v205, v225, v204
v_cvt_pk_bf16_f32 v205, v205, v205
v_and_b32 v205, 0xffff0000, v205
v_sub_f32 v204, v205, v225
v_mov_b32 v225, v205
v_exp_f32 v237, v204
v_add_f32 v132, v132, v204
v_add_f32 v133, v133, v204
v_add_f32 v134, v134, v204
v_add_f32 v135, v135, v204
v_add_f32 v148, v148, v204
v_add_f32 v149, v149, v204
v_add_f32 v150, v150, v204
v_add_f32 v151, v151, v204
v_lshlrev_b32 v242, 16, v36
v_and_b32 v248, 0xffff0000, v36
v_mul_f32 v242, v242, v237
v_mul_f32 v248, v248, v237
v_cvt_pk_bf16_f32 v36, v242, v248
v_lshlrev_b32 v242, 16, v37
v_and_b32 v248, 0xffff0000, v37
v_mul_f32 v242, v242, v237
v_mul_f32 v248, v248, v237
v_cvt_pk_bf16_f32 v37, v242, v248
v_lshlrev_b32 v242, 16, v38
v_and_b32 v248, 0xffff0000, v38
v_mul_f32 v242, v242, v237
v_mul_f32 v248, v248, v237
v_cvt_pk_bf16_f32 v38, v242, v248
v_lshlrev_b32 v242, 16, v39
v_and_b32 v248, 0xffff0000, v39
v_mul_f32 v242, v242, v237
v_mul_f32 v248, v248, v237
v_cvt_pk_bf16_f32 v39, v242, v248
v_lshlrev_b32 v242, 16, v40
v_and_b32 v248, 0xffff0000, v40
v_mul_f32 v242, v242, v237
v_mul_f32 v248, v248, v237
v_cvt_pk_bf16_f32 v40, v242, v248
v_lshlrev_b32 v242, 16, v41
v_and_b32 v248, 0xffff0000, v41
v_mul_f32 v242, v242, v237
v_mul_f32 v248, v248, v237
v_cvt_pk_bf16_f32 v41, v242, v248
v_lshlrev_b32 v242, 16, v42
v_and_b32 v248, 0xffff0000, v42
v_mul_f32 v242, v242, v237
v_mul_f32 v248, v248, v237
v_cvt_pk_bf16_f32 v42, v242, v248
v_lshlrev_b32 v242, 16, v43
v_and_b32 v248, 0xffff0000, v43
v_mul_f32 v242, v242, v237
v_mul_f32 v248, v248, v237
v_cvt_pk_bf16_f32 v43, v242, v248
v_lshlrev_b32 v242, 16, v164
v_and_b32 v248, 0xffff0000, v164
v_mul_f32 v242, v242, v237
v_mul_f32 v248, v248, v237
v_cvt_pk_bf16_f32 v164, v242, v248
v_lshlrev_b32 v242, 16, v165
v_and_b32 v248, 0xffff0000, v165
v_mul_f32 v242, v242, v237
v_mul_f32 v248, v248, v237
v_cvt_pk_bf16_f32 v165, v242, v248
v_lshlrev_b32 v242, 16, v166
v_and_b32 v248, 0xffff0000, v166
v_mul_f32 v242, v242, v237
v_mul_f32 v248, v248, v237
v_cvt_pk_bf16_f32 v166, v242, v248
v_lshlrev_b32 v242, 16, v167
v_and_b32 v248, 0xffff0000, v167
v_mul_f32 v242, v242, v237
v_mul_f32 v248, v248, v237
v_cvt_pk_bf16_f32 v167, v242, v248
v_lshlrev_b32 v242, 16, v180
v_and_b32 v248, 0xffff0000, v180
v_mul_f32 v242, v242, v237
v_mul_f32 v248, v248, v237
v_cvt_pk_bf16_f32 v180, v242, v248
v_lshlrev_b32 v242, 16, v181
v_and_b32 v248, 0xffff0000, v181
v_mul_f32 v242, v242, v237
v_mul_f32 v248, v248, v237
v_cvt_pk_bf16_f32 v181, v242, v248
v_lshlrev_b32 v242, 16, v182
v_and_b32 v248, 0xffff0000, v182
v_mul_f32 v242, v242, v237
v_mul_f32 v248, v248, v237
v_cvt_pk_bf16_f32 v182, v242, v248
v_lshlrev_b32 v242, 16, v183
v_and_b32 v248, 0xffff0000, v183
v_mul_f32 v242, v242, v237
v_mul_f32 v248, v248, v237
v_cvt_pk_bf16_f32 v183, v242, v248
v_exp_f32 v232, v132
v_exp_f32 v233, v133
v_exp_f32 v234, v134
v_exp_f32 v235, v135
s_nop 1
v_cvt_pk_bf16_f32 v32, v232, v233
v_cvt_pk_bf16_f32 v33, v234, v235
v_max_f32 v204, v136, v137
v_max3_f32 v204, v204, v138, v139
v_mov_b32 v205, v204
s_nop 1
v_permlane32_swap_b32 v204, v205
s_nop 1
v_max_f32 v204, v204, v205
v_mov_b32 v205, v204
s_nop 1
v_permlane16_swap_b32 v204, v205
s_nop 1
v_max_f32 v204, v204, v205
v_add_f32 v204, 40.0, v204
v_ceil_f32 v204, v204
v_max_f32 v204, 0, v204
v_sub_f32 v205, v226, v204
v_cvt_pk_bf16_f32 v205, v205, v205
v_and_b32 v205, 0xffff0000, v205
v_sub_f32 v204, v205, v226
v_mov_b32 v226, v205
v_exp_f32 v238, v204
v_add_f32 v136, v136, v204
v_add_f32 v137, v137, v204
v_add_f32 v138, v138, v204
v_add_f32 v139, v139, v204
v_add_f32 v152, v152, v204
v_add_f32 v153, v153, v204
v_add_f32 v154, v154, v204
v_add_f32 v155, v155, v204
v_lshlrev_b32 v242, 16, v68
v_and_b32 v248, 0xffff0000, v68
v_mul_f32 v242, v242, v238
v_mul_f32 v248, v248, v238
v_cvt_pk_bf16_f32 v68, v242, v248
v_lshlrev_b32 v242, 16, v69
v_and_b32 v248, 0xffff0000, v69
v_mul_f32 v242, v242, v238
v_mul_f32 v248, v248, v238
v_cvt_pk_bf16_f32 v69, v242, v248
v_lshlrev_b32 v242, 16, v70
v_and_b32 v248, 0xffff0000, v70
v_mul_f32 v242, v242, v238
v_mul_f32 v248, v248, v238
v_cvt_pk_bf16_f32 v70, v242, v248
v_lshlrev_b32 v242, 16, v71
v_and_b32 v248, 0xffff0000, v71
v_mul_f32 v242, v242, v238
v_mul_f32 v248, v248, v238
v_cvt_pk_bf16_f32 v71, v242, v248
v_lshlrev_b32 v242, 16, v72
v_and_b32 v248, 0xffff0000, v72
v_mul_f32 v242, v242, v238
v_mul_f32 v248, v248, v238
v_cvt_pk_bf16_f32 v72, v242, v248
v_lshlrev_b32 v242, 16, v73
v_and_b32 v248, 0xffff0000, v73
v_mul_f32 v242, v242, v238
v_mul_f32 v248, v248, v238
v_cvt_pk_bf16_f32 v73, v242, v248
v_lshlrev_b32 v242, 16, v74
v_and_b32 v248, 0xffff0000, v74
v_mul_f32 v242, v242, v238
v_mul_f32 v248, v248, v238
v_cvt_pk_bf16_f32 v74, v242, v248
v_lshlrev_b32 v242, 16, v75
v_and_b32 v248, 0xffff0000, v75
v_mul_f32 v242, v242, v238
v_mul_f32 v248, v248, v238
v_cvt_pk_bf16_f32 v75, v242, v248
v_lshlrev_b32 v242, 16, v168
v_and_b32 v248, 0xffff0000, v168
v_mul_f32 v242, v242, v238
v_mul_f32 v248, v248, v238
v_cvt_pk_bf16_f32 v168, v242, v248
v_lshlrev_b32 v242, 16, v169
v_and_b32 v248, 0xffff0000, v169
v_mul_f32 v242, v242, v238
v_mul_f32 v248, v248, v238
v_cvt_pk_bf16_f32 v169, v242, v248
v_lshlrev_b32 v242, 16, v170
v_and_b32 v248, 0xffff0000, v170
v_mul_f32 v242, v242, v238
v_mul_f32 v248, v248, v238
v_cvt_pk_bf16_f32 v170, v242, v248
v_lshlrev_b32 v242, 16, v171
v_and_b32 v248, 0xffff0000, v171
v_mul_f32 v242, v242, v238
v_mul_f32 v248, v248, v238
v_cvt_pk_bf16_f32 v171, v242, v248
v_lshlrev_b32 v242, 16, v184
v_and_b32 v248, 0xffff0000, v184
v_mul_f32 v242, v242, v238
v_mul_f32 v248, v248, v238
v_cvt_pk_bf16_f32 v184, v242, v248
v_lshlrev_b32 v242, 16, v185
v_and_b32 v248, 0xffff0000, v185
v_mul_f32 v242, v242, v238
v_mul_f32 v248, v248, v238
v_cvt_pk_bf16_f32 v185, v242, v248
v_lshlrev_b32 v242, 16, v186
v_and_b32 v248, 0xffff0000, v186
v_mul_f32 v242, v242, v238
v_mul_f32 v248, v248, v238
v_cvt_pk_bf16_f32 v186, v242, v248
v_lshlrev_b32 v242, 16, v187
v_and_b32 v248, 0xffff0000, v187
v_mul_f32 v242, v242, v238
v_mul_f32 v248, v248, v238
v_cvt_pk_bf16_f32 v187, v242, v248
v_exp_f32 v232, v136
v_exp_f32 v233, v137
v_exp_f32 v234, v138
v_exp_f32 v235, v139
s_nop 1
v_cvt_pk_bf16_f32 v64, v232, v233
v_cvt_pk_bf16_f32 v65, v234, v235
v_max_f32 v204, v140, v141
v_max3_f32 v204, v204, v142, v143
v_mov_b32 v205, v204
s_nop 1
v_permlane32_swap_b32 v204, v205
s_nop 1
v_max_f32 v204, v204, v205
v_mov_b32 v205, v204
s_nop 1
v_permlane16_swap_b32 v204, v205
s_nop 1
v_max_f32 v204, v204, v205
v_add_f32 v204, 40.0, v204
v_ceil_f32 v204, v204
v_max_f32 v204, 0, v204
v_sub_f32 v205, v227, v204
v_cvt_pk_bf16_f32 v205, v205, v205
v_and_b32 v205, 0xffff0000, v205
v_sub_f32 v204, v205, v227
v_mov_b32 v227, v205
v_exp_f32 v239, v204
v_add_f32 v140, v140, v204
v_add_f32 v141, v141, v204
v_add_f32 v142, v142, v204
v_add_f32 v143, v143, v204
v_add_f32 v156, v156, v204
v_add_f32 v157, v157, v204
v_add_f32 v158, v158, v204
v_add_f32 v159, v159, v204
v_lshlrev_b32 v242, 16, v100
v_and_b32 v248, 0xffff0000, v100
v_mul_f32 v242, v242, v239
v_mul_f32 v248, v248, v239
v_cvt_pk_bf16_f32 v100, v242, v248
v_lshlrev_b32 v242, 16, v101
v_and_b32 v248, 0xffff0000, v101
v_mul_f32 v242, v242, v239
v_mul_f32 v248, v248, v239
v_cvt_pk_bf16_f32 v101, v242, v248
v_lshlrev_b32 v242, 16, v102
v_and_b32 v248, 0xffff0000, v102
v_mul_f32 v242, v242, v239
v_mul_f32 v248, v248, v239
v_cvt_pk_bf16_f32 v102, v242, v248
v_lshlrev_b32 v242, 16, v103
v_and_b32 v248, 0xffff0000, v103
v_mul_f32 v242, v242, v239
v_mul_f32 v248, v248, v239
v_cvt_pk_bf16_f32 v103, v242, v248
v_lshlrev_b32 v242, 16, v104
v_and_b32 v248, 0xffff0000, v104
v_mul_f32 v242, v242, v239
v_mul_f32 v248, v248, v239
v_cvt_pk_bf16_f32 v104, v242, v248
v_lshlrev_b32 v242, 16, v105
v_and_b32 v248, 0xffff0000, v105
v_mul_f32 v242, v242, v239
v_mul_f32 v248, v248, v239
v_cvt_pk_bf16_f32 v105, v242, v248
v_lshlrev_b32 v242, 16, v106
v_and_b32 v248, 0xffff0000, v106
v_mul_f32 v242, v242, v239
v_mul_f32 v248, v248, v239
v_cvt_pk_bf16_f32 v106, v242, v248
v_lshlrev_b32 v242, 16, v107
v_and_b32 v248, 0xffff0000, v107
v_mul_f32 v242, v242, v239
v_mul_f32 v248, v248, v239
v_cvt_pk_bf16_f32 v107, v242, v248
v_lshlrev_b32 v242, 16, v172
v_and_b32 v248, 0xffff0000, v172
v_mul_f32 v242, v242, v239
v_mul_f32 v248, v248, v239
v_cvt_pk_bf16_f32 v172, v242, v248
v_lshlrev_b32 v242, 16, v173
v_and_b32 v248, 0xffff0000, v173
v_mul_f32 v242, v242, v239
v_mul_f32 v248, v248, v239
v_cvt_pk_bf16_f32 v173, v242, v248
v_lshlrev_b32 v242, 16, v174
v_and_b32 v248, 0xffff0000, v174
v_mul_f32 v242, v242, v239
v_mul_f32 v248, v248, v239
v_cvt_pk_bf16_f32 v174, v242, v248
v_lshlrev_b32 v242, 16, v175
v_and_b32 v248, 0xffff0000, v175
v_mul_f32 v242, v242, v239
v_mul_f32 v248, v248, v239
v_cvt_pk_bf16_f32 v175, v242, v248
v_lshlrev_b32 v242, 16, v188
v_and_b32 v248, 0xffff0000, v188
v_mul_f32 v242, v242, v239
v_mul_f32 v248, v248, v239
v_cvt_pk_bf16_f32 v188, v242, v248
v_lshlrev_b32 v242, 16, v189
v_and_b32 v248, 0xffff0000, v189
v_mul_f32 v242, v242, v239
v_mul_f32 v248, v248, v239
v_cvt_pk_bf16_f32 v189, v242, v248
v_lshlrev_b32 v242, 16, v190
v_and_b32 v248, 0xffff0000, v190
v_mul_f32 v242, v242, v239
v_mul_f32 v248, v248, v239
v_cvt_pk_bf16_f32 v190, v242, v248
v_lshlrev_b32 v242, 16, v191
v_and_b32 v248, 0xffff0000, v191
v_mul_f32 v242, v242, v239
v_mul_f32 v248, v248, v239
v_cvt_pk_bf16_f32 v191, v242, v248
v_exp_f32 v232, v140
v_exp_f32 v233, v141
v_exp_f32 v234, v142
v_exp_f32 v235, v143
s_nop 1
v_cvt_pk_bf16_f32 v96, v232, v233
v_cvt_pk_bf16_f32 v97, v234, v235
s_branch L2_rare_common
L2_rare_site17:
s_mov_b32 s36, 17
s_branch L2_rare_t0_5
L2_rare_t0_5:
s_nop 15
s_nop 15
s_waitcnt lgkmcnt(0)
v_lshrrev_b32 v206, 8, v243
v_add_u32 v206, 1, v206
v_lshrrev_b32 v206, 2, v206
v_sub_u32 v206, 0, v206
v_and_b32 v206, 0xffff0000, v206
v_max_f32 v204, v144, v145
v_max3_f32 v204, v204, v146, v147
v_mov_b32 v205, v204
s_nop 1
v_permlane32_swap_b32 v204, v205
s_nop 1
v_max_f32 v204, v204, v205
v_mov_b32 v205, v204
s_nop 1
v_permlane16_swap_b32 v204, v205
s_nop 1
v_max_f32 v204, v204, v205
v_add_f32 v204, 40.0, v204
v_ceil_f32 v204, v204
v_max_f32 v204, 0, v204
v_sub_f32 v205, v224, v204
v_cvt_pk_bf16_f32 v205, v205, v205
v_and_b32 v205, 0xffff0000, v205
v_sub_f32 v204, v205, v224
v_mov_b32 v224, v205
v_exp_f32 v236, v204
v_add_f32 v144, v144, v204
v_add_f32 v145, v145, v204
v_add_f32 v146, v146, v204
v_add_f32 v147, v147, v204
v_add_f32 v128, v128, v204
v_add_f32 v129, v129, v204
v_add_f32 v130, v130, v204
v_add_f32 v131, v131, v204
v_lshlrev_b32 v242, 16, v4
v_and_b32 v248, 0xffff0000, v4
v_mul_f32 v242, v242, v236
v_mul_f32 v248, v248, v236
v_cvt_pk_bf16_f32 v4, v242, v248
v_lshlrev_b32 v242, 16, v5
v_and_b32 v248, 0xffff0000, v5
v_mul_f32 v242, v242, v236
v_mul_f32 v248, v248, v236
v_cvt_pk_bf16_f32 v5, v242, v248
v_lshlrev_b32 v242, 16, v6
v_and_b32 v248, 0xffff0000, v6
v_mul_f32 v242, v242, v236
v_mul_f32 v248, v248, v236
v_cvt_pk_bf16_f32 v6, v242, v248
v_lshlrev_b32 v242, 16, v7
v_and_b32 v248, 0xffff0000, v7
v_mul_f32 v242, v242, v236
v_mul_f32 v248, v248, v236
v_cvt_pk_bf16_f32 v7, v242, v248
v_lshlrev_b32 v242, 16, v8
v_and_b32 v248, 0xffff0000, v8
v_mul_f32 v242, v242, v236
v_mul_f32 v248, v248, v236
v_cvt_pk_bf16_f32 v8, v242, v248
v_lshlrev_b32 v242, 16, v9
v_and_b32 v248, 0xffff0000, v9
v_mul_f32 v242, v242, v236
v_mul_f32 v248, v248, v236
v_cvt_pk_bf16_f32 v9, v242, v248
v_lshlrev_b32 v242, 16, v10
v_and_b32 v248, 0xffff0000, v10
v_mul_f32 v242, v242, v236
v_mul_f32 v248, v248, v236
v_cvt_pk_bf16_f32 v10, v242, v248
v_lshlrev_b32 v242, 16, v11
v_and_b32 v248, 0xffff0000, v11
v_mul_f32 v242, v242, v236
v_mul_f32 v248, v248, v236
v_cvt_pk_bf16_f32 v11, v242, v248
v_lshlrev_b32 v242, 16, v160
v_and_b32 v248, 0xffff0000, v160
v_mul_f32 v242, v242, v236
v_mul_f32 v248, v248, v236
v_cvt_pk_bf16_f32 v160, v242, v248
v_lshlrev_b32 v242, 16, v161
v_and_b32 v248, 0xffff0000, v161
v_mul_f32 v242, v242, v236
v_mul_f32 v248, v248, v236
v_cvt_pk_bf16_f32 v161, v242, v248
v_lshlrev_b32 v242, 16, v162
v_and_b32 v248, 0xffff0000, v162
v_mul_f32 v242, v242, v236
v_mul_f32 v248, v248, v236
v_cvt_pk_bf16_f32 v162, v242, v248
v_lshlrev_b32 v242, 16, v163
v_and_b32 v248, 0xffff0000, v163
v_mul_f32 v242, v242, v236
v_mul_f32 v248, v248, v236
v_cvt_pk_bf16_f32 v163, v242, v248
v_lshlrev_b32 v242, 16, v176
v_and_b32 v248, 0xffff0000, v176
v_mul_f32 v242, v242, v236
v_mul_f32 v248, v248, v236
v_cvt_pk_bf16_f32 v176, v242, v248
v_lshlrev_b32 v242, 16, v177
v_and_b32 v248, 0xffff0000, v177
v_mul_f32 v242, v242, v236
v_mul_f32 v248, v248, v236
v_cvt_pk_bf16_f32 v177, v242, v248
v_lshlrev_b32 v242, 16, v178
v_and_b32 v248, 0xffff0000, v178
v_mul_f32 v242, v242, v236
v_mul_f32 v248, v248, v236
v_cvt_pk_bf16_f32 v178, v242, v248
v_lshlrev_b32 v242, 16, v179
v_and_b32 v248, 0xffff0000, v179
v_mul_f32 v242, v242, v236
v_mul_f32 v248, v248, v236
v_cvt_pk_bf16_f32 v179, v242, v248
v_lshlrev_b32 v242, 16, v0
v_and_b32 v248, 0xffff0000, v0
v_mul_f32 v242, v242, v236
v_mul_f32 v248, v248, v236
v_cvt_pk_bf16_f32 v0, v242, v248
v_lshlrev_b32 v242, 16, v1
v_and_b32 v248, 0xffff0000, v1
v_mul_f32 v242, v242, v236
v_mul_f32 v248, v248, v236
v_cvt_pk_bf16_f32 v1, v242, v248
v_exp_f32 v232, v144
v_exp_f32 v233, v145
v_exp_f32 v234, v146
v_exp_f32 v235, v147
s_nop 1
v_cvt_pk_bf16_f32 v2, v232, v233
v_cvt_pk_bf16_f32 v3, v234, v235
v_max_f32 v204, v148, v149
v_max3_f32 v204, v204, v150, v151
v_mov_b32 v205, v204
s_nop 1
v_permlane32_swap_b32 v204, v205
s_nop 1
v_max_f32 v204, v204, v205
v_mov_b32 v205, v204
s_nop 1
v_permlane16_swap_b32 v204, v205
s_nop 1
v_max_f32 v204, v204, v205
v_add_f32 v204, 40.0, v204
v_ceil_f32 v204, v204
v_max_f32 v204, 0, v204
v_sub_f32 v205, v225, v204
v_cvt_pk_bf16_f32 v205, v205, v205
v_and_b32 v205, 0xffff0000, v205
v_sub_f32 v204, v205, v225
v_mov_b32 v225, v205
v_exp_f32 v237, v204
v_add_f32 v148, v148, v204
v_add_f32 v149, v149, v204
v_add_f32 v150, v150, v204
v_add_f32 v151, v151, v204
v_add_f32 v132, v132, v204
v_add_f32 v133, v133, v204
v_add_f32 v134, v134, v204
v_add_f32 v135, v135, v204
v_lshlrev_b32 v242, 16, v36
v_and_b32 v248, 0xffff0000, v36
v_mul_f32 v242, v242, v237
v_mul_f32 v248, v248, v237
v_cvt_pk_bf16_f32 v36, v242, v248
v_lshlrev_b32 v242, 16, v37
v_and_b32 v248, 0xffff0000, v37
v_mul_f32 v242, v242, v237
v_mul_f32 v248, v248, v237
v_cvt_pk_bf16_f32 v37, v242, v248
v_lshlrev_b32 v242, 16, v38
v_and_b32 v248, 0xffff0000, v38
v_mul_f32 v242, v242, v237
v_mul_f32 v248, v248, v237
v_cvt_pk_bf16_f32 v38, v242, v248
v_lshlrev_b32 v242, 16, v39
v_and_b32 v248, 0xffff0000, v39
v_mul_f32 v242, v242, v237
v_mul_f32 v248, v248, v237
v_cvt_pk_bf16_f32 v39, v242, v248
v_lshlrev_b32 v242, 16, v40
v_and_b32 v248, 0xffff0000, v40
v_mul_f32 v242, v242, v237
v_mul_f32 v248, v248, v237
v_cvt_pk_bf16_f32 v40, v242, v248
v_lshlrev_b32 v242, 16, v41
v_and_b32 v248, 0xffff0000, v41
v_mul_f32 v242, v242, v237
v_mul_f32 v248, v248, v237
v_cvt_pk_bf16_f32 v41, v242, v248
v_lshlrev_b32 v242, 16, v42
v_and_b32 v248, 0xffff0000, v42
v_mul_f32 v242, v242, v237
v_mul_f32 v248, v248, v237
v_cvt_pk_bf16_f32 v42, v242, v248
v_lshlrev_b32 v242, 16, v43
v_and_b32 v248, 0xffff0000, v43
v_mul_f32 v242, v242, v237
v_mul_f32 v248, v248, v237
v_cvt_pk_bf16_f32 v43, v242, v248
v_lshlrev_b32 v242, 16, v164
v_and_b32 v248, 0xffff0000, v164
v_mul_f32 v242, v242, v237
v_mul_f32 v248, v248, v237
v_cvt_pk_bf16_f32 v164, v242, v248
v_lshlrev_b32 v242, 16, v165
v_and_b32 v248, 0xffff0000, v165
v_mul_f32 v242, v242, v237
v_mul_f32 v248, v248, v237
v_cvt_pk_bf16_f32 v165, v242, v248
v_lshlrev_b32 v242, 16, v166
v_and_b32 v248, 0xffff0000, v166
v_mul_f32 v242, v242, v237
v_mul_f32 v248, v248, v237
v_cvt_pk_bf16_f32 v166, v242, v248
v_lshlrev_b32 v242, 16, v167
v_and_b32 v248, 0xffff0000, v167
v_mul_f32 v242, v242, v237
v_mul_f32 v248, v248, v237
v_cvt_pk_bf16_f32 v167, v242, v248
v_lshlrev_b32 v242, 16, v180
v_and_b32 v248, 0xffff0000, v180
v_mul_f32 v242, v242, v237
v_mul_f32 v248, v248, v237
v_cvt_pk_bf16_f32 v180, v242, v248
v_lshlrev_b32 v242, 16, v181
v_and_b32 v248, 0xffff0000, v181
v_mul_f32 v242, v242, v237
v_mul_f32 v248, v248, v237
v_cvt_pk_bf16_f32 v181, v242, v248
v_lshlrev_b32 v242, 16, v182
v_and_b32 v248, 0xffff0000, v182
v_mul_f32 v242, v242, v237
v_mul_f32 v248, v248, v237
v_cvt_pk_bf16_f32 v182, v242, v248
v_lshlrev_b32 v242, 16, v183
v_and_b32 v248, 0xffff0000, v183
v_mul_f32 v242, v242, v237
v_mul_f32 v248, v248, v237
v_cvt_pk_bf16_f32 v183, v242, v248
v_lshlrev_b32 v242, 16, v32
v_and_b32 v248, 0xffff0000, v32
v_mul_f32 v242, v242, v237
v_mul_f32 v248, v248, v237
v_cvt_pk_bf16_f32 v32, v242, v248
v_lshlrev_b32 v242, 16, v33
v_and_b32 v248, 0xffff0000, v33
v_mul_f32 v242, v242, v237
v_mul_f32 v248, v248, v237
v_cvt_pk_bf16_f32 v33, v242, v248
v_exp_f32 v232, v148
v_exp_f32 v233, v149
v_exp_f32 v234, v150
v_exp_f32 v235, v151
s_nop 1
v_cvt_pk_bf16_f32 v34, v232, v233
v_cvt_pk_bf16_f32 v35, v234, v235
v_max_f32 v204, v152, v153
v_max3_f32 v204, v204, v154, v155
v_mov_b32 v205, v204
s_nop 1
v_permlane32_swap_b32 v204, v205
s_nop 1
v_max_f32 v204, v204, v205
v_mov_b32 v205, v204
s_nop 1
v_permlane16_swap_b32 v204, v205
s_nop 1
v_max_f32 v204, v204, v205
v_add_f32 v204, 40.0, v204
v_ceil_f32 v204, v204
v_max_f32 v204, 0, v204
v_sub_f32 v205, v226, v204
v_cvt_pk_bf16_f32 v205, v205, v205
v_and_b32 v205, 0xffff0000, v205
v_sub_f32 v204, v205, v226
v_mov_b32 v226, v205
v_exp_f32 v238, v204
v_add_f32 v152, v152, v204
v_add_f32 v153, v153, v204
v_add_f32 v154, v154, v204
v_add_f32 v155, v155, v204
v_add_f32 v136, v136, v204
v_add_f32 v137, v137, v204
v_add_f32 v138, v138, v204
v_add_f32 v139, v139, v204
v_lshlrev_b32 v242, 16, v68
v_and_b32 v248, 0xffff0000, v68
v_mul_f32 v242, v242, v238
v_mul_f32 v248, v248, v238
v_cvt_pk_bf16_f32 v68, v242, v248
v_lshlrev_b32 v242, 16, v69
v_and_b32 v248, 0xffff0000, v69
v_mul_f32 v242, v242, v238
v_mul_f32 v248, v248, v238
v_cvt_pk_bf16_f32 v69, v242, v248
v_lshlrev_b32 v242, 16, v70
v_and_b32 v248, 0xffff0000, v70
v_mul_f32 v242, v242, v238
v_mul_f32 v248, v248, v238
v_cvt_pk_bf16_f32 v70, v242, v248
v_lshlrev_b32 v242, 16, v71
v_and_b32 v248, 0xffff0000, v71
v_mul_f32 v242, v242, v238
v_mul_f32 v248, v248, v238
v_cvt_pk_bf16_f32 v71, v242, v248
v_lshlrev_b32 v242, 16, v72
v_and_b32 v248, 0xffff0000, v72
v_mul_f32 v242, v242, v238
v_mul_f32 v248, v248, v238
v_cvt_pk_bf16_f32 v72, v242, v248
v_lshlrev_b32 v242, 16, v73
v_and_b32 v248, 0xffff0000, v73
v_mul_f32 v242, v242, v238
v_mul_f32 v248, v248, v238
v_cvt_pk_bf16_f32 v73, v242, v248
v_lshlrev_b32 v242, 16, v74
v_and_b32 v248, 0xffff0000, v74
v_mul_f32 v242, v242, v238
v_mul_f32 v248, v248, v238
v_cvt_pk_bf16_f32 v74, v242, v248
v_lshlrev_b32 v242, 16, v75
v_and_b32 v248, 0xffff0000, v75
v_mul_f32 v242, v242, v238
v_mul_f32 v248, v248, v238
v_cvt_pk_bf16_f32 v75, v242, v248
v_lshlrev_b32 v242, 16, v168
v_and_b32 v248, 0xffff0000, v168
v_mul_f32 v242, v242, v238
v_mul_f32 v248, v248, v238
v_cvt_pk_bf16_f32 v168, v242, v248
v_lshlrev_b32 v242, 16, v169
v_and_b32 v248, 0xffff0000, v169
v_mul_f32 v242, v242, v238
v_mul_f32 v248, v248, v238
v_cvt_pk_bf16_f32 v169, v242, v248
v_lshlrev_b32 v242, 16, v170
v_and_b32 v248, 0xffff0000, v170
v_mul_f32 v242, v242, v238
v_mul_f32 v248, v248, v238
v_cvt_pk_bf16_f32 v170, v242, v248
v_lshlrev_b32 v242, 16, v171
v_and_b32 v248, 0xffff0000, v171
v_mul_f32 v242, v242, v238
v_mul_f32 v248, v248, v238
v_cvt_pk_bf16_f32 v171, v242, v248
v_lshlrev_b32 v242, 16, v184
v_and_b32 v248, 0xffff0000, v184
v_mul_f32 v242, v242, v238
v_mul_f32 v248, v248, v238
v_cvt_pk_bf16_f32 v184, v242, v248
v_lshlrev_b32 v242, 16, v185
v_and_b32 v248, 0xffff0000, v185
v_mul_f32 v242, v242, v238
v_mul_f32 v248, v248, v238
v_cvt_pk_bf16_f32 v185, v242, v248
v_lshlrev_b32 v242, 16, v186
v_and_b32 v248, 0xffff0000, v186
v_mul_f32 v242, v242, v238
v_mul_f32 v248, v248, v238
v_cvt_pk_bf16_f32 v186, v242, v248
v_lshlrev_b32 v242, 16, v187
v_and_b32 v248, 0xffff0000, v187
v_mul_f32 v242, v242, v238
v_mul_f32 v248, v248, v238
v_cvt_pk_bf16_f32 v187, v242, v248
v_lshlrev_b32 v242, 16, v64
v_and_b32 v248, 0xffff0000, v64
v_mul_f32 v242, v242, v238
v_mul_f32 v248, v248, v238
v_cvt_pk_bf16_f32 v64, v242, v248
v_lshlrev_b32 v242, 16, v65
v_and_b32 v248, 0xffff0000, v65
v_mul_f32 v242, v242, v238
v_mul_f32 v248, v248, v238
v_cvt_pk_bf16_f32 v65, v242, v248
v_exp_f32 v232, v152
v_exp_f32 v233, v153
v_exp_f32 v234, v154
v_exp_f32 v235, v155
s_nop 1
v_cvt_pk_bf16_f32 v66, v232, v233
v_cvt_pk_bf16_f32 v67, v234, v235
v_max_f32 v204, v156, v157
v_max3_f32 v204, v204, v158, v159
v_mov_b32 v205, v204
s_nop 1
v_permlane32_swap_b32 v204, v205
s_nop 1
v_max_f32 v204, v204, v205
v_mov_b32 v205, v204
s_nop 1
v_permlane16_swap_b32 v204, v205
s_nop 1
v_max_f32 v204, v204, v205
v_add_f32 v204, 40.0, v204
v_ceil_f32 v204, v204
v_max_f32 v204, 0, v204
v_sub_f32 v205, v227, v204
v_cvt_pk_bf16_f32 v205, v205, v205
v_and_b32 v205, 0xffff0000, v205
v_sub_f32 v204, v205, v227
v_mov_b32 v227, v205
v_exp_f32 v239, v204
v_add_f32 v156, v156, v204
v_add_f32 v157, v157, v204
v_add_f32 v158, v158, v204
v_add_f32 v159, v159, v204
v_add_f32 v140, v140, v204
v_add_f32 v141, v141, v204
v_add_f32 v142, v142, v204
v_add_f32 v143, v143, v204
v_lshlrev_b32 v242, 16, v100
v_and_b32 v248, 0xffff0000, v100
v_mul_f32 v242, v242, v239
v_mul_f32 v248, v248, v239
v_cvt_pk_bf16_f32 v100, v242, v248
v_lshlrev_b32 v242, 16, v101
v_and_b32 v248, 0xffff0000, v101
v_mul_f32 v242, v242, v239
v_mul_f32 v248, v248, v239
v_cvt_pk_bf16_f32 v101, v242, v248
v_lshlrev_b32 v242, 16, v102
v_and_b32 v248, 0xffff0000, v102
v_mul_f32 v242, v242, v239
v_mul_f32 v248, v248, v239
v_cvt_pk_bf16_f32 v102, v242, v248
v_lshlrev_b32 v242, 16, v103
v_and_b32 v248, 0xffff0000, v103
v_mul_f32 v242, v242, v239
v_mul_f32 v248, v248, v239
v_cvt_pk_bf16_f32 v103, v242, v248
v_lshlrev_b32 v242, 16, v104
v_and_b32 v248, 0xffff0000, v104
v_mul_f32 v242, v242, v239
v_mul_f32 v248, v248, v239
v_cvt_pk_bf16_f32 v104, v242, v248
v_lshlrev_b32 v242, 16, v105
v_and_b32 v248, 0xffff0000, v105
v_mul_f32 v242, v242, v239
v_mul_f32 v248, v248, v239
v_cvt_pk_bf16_f32 v105, v242, v248
v_lshlrev_b32 v242, 16, v106
v_and_b32 v248, 0xffff0000, v106
v_mul_f32 v242, v242, v239
v_mul_f32 v248, v248, v239
v_cvt_pk_bf16_f32 v106, v242, v248
v_lshlrev_b32 v242, 16, v107
v_and_b32 v248, 0xffff0000, v107
v_mul_f32 v242, v242, v239
v_mul_f32 v248, v248, v239
v_cvt_pk_bf16_f32 v107, v242, v248
v_lshlrev_b32 v242, 16, v172
v_and_b32 v248, 0xffff0000, v172
v_mul_f32 v242, v242, v239
v_mul_f32 v248, v248, v239
v_cvt_pk_bf16_f32 v172, v242, v248
v_lshlrev_b32 v242, 16, v173
v_and_b32 v248, 0xffff0000, v173
v_mul_f32 v242, v242, v239
v_mul_f32 v248, v248, v239
v_cvt_pk_bf16_f32 v173, v242, v248
v_lshlrev_b32 v242, 16, v174
v_and_b32 v248, 0xffff0000, v174
v_mul_f32 v242, v242, v239
v_mul_f32 v248, v248, v239
v_cvt_pk_bf16_f32 v174, v242, v248
v_lshlrev_b32 v242, 16, v175
v_and_b32 v248, 0xffff0000, v175
v_mul_f32 v242, v242, v239
v_mul_f32 v248, v248, v239
v_cvt_pk_bf16_f32 v175, v242, v248
v_lshlrev_b32 v242, 16, v188
v_and_b32 v248, 0xffff0000, v188
v_mul_f32 v242, v242, v239
v_mul_f32 v248, v248, v239
v_cvt_pk_bf16_f32 v188, v242, v248
v_lshlrev_b32 v242, 16, v189
v_and_b32 v248, 0xffff0000, v189
v_mul_f32 v242, v242, v239
v_mul_f32 v248, v248, v239
v_cvt_pk_bf16_f32 v189, v242, v248
v_lshlrev_b32 v242, 16, v190
v_and_b32 v248, 0xffff0000, v190
v_mul_f32 v242, v242, v239
v_mul_f32 v248, v248, v239
v_cvt_pk_bf16_f32 v190, v242, v248
v_lshlrev_b32 v242, 16, v191
v_and_b32 v248, 0xffff0000, v191
v_mul_f32 v242, v242, v239
v_mul_f32 v248, v248, v239
v_cvt_pk_bf16_f32 v191, v242, v248
v_lshlrev_b32 v242, 16, v96
v_and_b32 v248, 0xffff0000, v96
v_mul_f32 v242, v242, v239
v_mul_f32 v248, v248, v239
v_cvt_pk_bf16_f32 v96, v242, v248
v_lshlrev_b32 v242, 16, v97
v_and_b32 v248, 0xffff0000, v97
v_mul_f32 v242, v242, v239
v_mul_f32 v248, v248, v239
v_cvt_pk_bf16_f32 v97, v242, v248
v_exp_f32 v232, v156
v_exp_f32 v233, v157
v_exp_f32 v234, v158
v_exp_f32 v235, v159
s_nop 1
v_cvt_pk_bf16_f32 v98, v232, v233
v_cvt_pk_bf16_f32 v99, v234, v235
s_branch L2_rare_common
LF_hl_0:
s_mov_b32 s94, 0x10000
s_mov_b32 s3, 0x7c28000
LF_hl2_0:
v_lshlrev_b32 v241, 3, v243
buffer_load_dwordx2 v[240:241], v241, s[16:19], s3 offen sc1
s_sub_u32 s94, s94, 1
s_waitcnt vmcnt(0)
s_cbranch_scc1 LF_hlret_0
v_cmp_ne_u64_e64 s[38:39], s[98:99], v[240:241]
s_and_b64 s[38:39], s[38:39], s[96:97]
s_cbranch_scc1 LF_hl2_0
s_branch LF_hlret_0
L2_rare_common:
v_lshrrev_b32 v232, 4, v243
v_and_b32 v232, 0x30, v232
ds_bpermute_b32 v242, v232, v236 offset:0
ds_bpermute_b32 v248, v232, v236 offset:4
ds_bpermute_b32 v250, v232, v236 offset:8
ds_bpermute_b32 v251, v232, v236 offset:12
s_waitcnt lgkmcnt(0)
v_accvgpr_read_b32 v232, a0
v_accvgpr_read_b32 v233, a1
v_accvgpr_read_b32 v234, a2
v_accvgpr_read_b32 v235, a3
v_mul_f32 v232, v232, v242
v_mul_f32 v233, v233, v248
v_mul_f32 v234, v234, v250
v_mul_f32 v235, v235, v251
v_accvgpr_write_b32 a0, v232
v_accvgpr_write_b32 a1, v233
v_accvgpr_write_b32 a2, v234
v_accvgpr_write_b32 a3, v235
v_accvgpr_read_b32 v232, a16
v_accvgpr_read_b32 v233, a17
v_accvgpr_read_b32 v234, a18
v_accvgpr_read_b32 v235, a19
v_mul_f32 v232, v232, v242
v_mul_f32 v233, v233, v248
v_mul_f32 v234, v234, v250
v_mul_f32 v235, v235, v251
v_accvgpr_write_b32 a16, v232
v_accvgpr_write_b32 a17, v233
v_accvgpr_write_b32 a18, v234
v_accvgpr_write_b32 a19, v235
v_accvgpr_read_b32 v232, a32
v_accvgpr_read_b32 v233, a33
v_accvgpr_read_b32 v234, a34
v_accvgpr_read_b32 v235, a35
v_mul_f32 v232, v232, v242
v_mul_f32 v233, v233, v248
v_mul_f32 v234, v234, v250
v_mul_f32 v235, v235, v251
v_accvgpr_write_b32 a32, v232
v_accvgpr_write_b32 a33, v233
v_accvgpr_write_b32 a34, v234
v_accvgpr_write_b32 a35, v235
v_accvgpr_read_b32 v232, a48
v_accvgpr_read_b32 v233, a49
v_accvgpr_read_b32 v234, a50
v_accvgpr_read_b32 v235, a51
v_mul_f32 v232, v232, v242
v_mul_f32 v233, v233, v248
v_mul_f32 v234, v234, v250
v_mul_f32 v235, v235, v251
v_accvgpr_write_b32 a48, v232
v_accvgpr_write_b32 a49, v233
v_accvgpr_write_b32 a50, v234
v_accvgpr_write_b32 a51, v235
v_accvgpr_read_b32 v232, a64
v_accvgpr_read_b32 v233, a65
v_accvgpr_read_b32 v234, a66
v_accvgpr_read_b32 v235, a67
v_mul_f32 v232, v232, v242
v_mul_f32 v233, v233, v248
v_mul_f32 v234, v234, v250
v_mul_f32 v235, v235, v251
v_accvgpr_write_b32 a64, v232
v_accvgpr_write_b32 a65, v233
v_accvgpr_write_b32 a66, v234
v_accvgpr_write_b32 a67, v235
v_accvgpr_read_b32 v232, a80
v_accvgpr_read_b32 v233, a81
v_accvgpr_read_b32 v234, a82
v_accvgpr_read_b32 v235, a83
v_mul_f32 v232, v232, v242
v_mul_f32 v233, v233, v248
v_mul_f32 v234, v234, v250
v_mul_f32 v235, v235, v251
v_accvgpr_write_b32 a80, v232
v_accvgpr_write_b32 a81, v233
v_accvgpr_write_b32 a82, v234
v_accvgpr_write_b32 a83, v235
v_accvgpr_read_b32 v232, a96
v_accvgpr_read_b32 v233, a97
v_accvgpr_read_b32 v234, a98
v_accvgpr_read_b32 v235, a99
v_mul_f32 v232, v232, v242
v_mul_f32 v233, v233, v248
v_mul_f32 v234, v234, v250
v_mul_f32 v235, v235, v251
v_accvgpr_write_b32 a96, v232
v_accvgpr_write_b32 a97, v233
v_accvgpr_write_b32 a98, v234
v_accvgpr_write_b32 a99, v235
v_accvgpr_read_b32 v232, a112
v_accvgpr_read_b32 v233, a113
v_accvgpr_read_b32 v234, a114
v_accvgpr_read_b32 v235, a115
v_mul_f32 v232, v232, v242
v_mul_f32 v233, v233, v248
v_mul_f32 v234, v234, v250
v_mul_f32 v235, v235, v251
v_accvgpr_write_b32 a112, v232
v_accvgpr_write_b32 a113, v233
v_accvgpr_write_b32 a114, v234
v_accvgpr_write_b32 a115, v235
v_accvgpr_read_b32 v232, a128
v_accvgpr_read_b32 v233, a129
v_accvgpr_read_b32 v234, a130
v_accvgpr_read_b32 v235, a131
v_mul_f32 v232, v232, v242
v_mul_f32 v233, v233, v248
v_mul_f32 v234, v234, v250
v_mul_f32 v235, v235, v251
v_accvgpr_write_b32 a128, v232
v_accvgpr_write_b32 a129, v233
v_accvgpr_write_b32 a130, v234
v_accvgpr_write_b32 a131, v235
v_accvgpr_read_b32 v232, a144
v_accvgpr_read_b32 v233, a145
v_accvgpr_read_b32 v234, a146
v_accvgpr_read_b32 v235, a147
v_mul_f32 v232, v232, v242
v_mul_f32 v233, v233, v248
v_mul_f32 v234, v234, v250
v_mul_f32 v235, v235, v251
v_accvgpr_write_b32 a144, v232
v_accvgpr_write_b32 a145, v233
v_accvgpr_write_b32 a146, v234
v_accvgpr_write_b32 a147, v235
v_accvgpr_read_b32 v232, a160
v_accvgpr_read_b32 v233, a161
v_accvgpr_read_b32 v234, a162
v_accvgpr_read_b32 v235, a163
v_mul_f32 v232, v232, v242
v_mul_f32 v233, v233, v248
v_mul_f32 v234, v234, v250
v_mul_f32 v235, v235, v251
v_accvgpr_write_b32 a160, v232
v_accvgpr_write_b32 a161, v233
v_accvgpr_write_b32 a162, v234
v_accvgpr_write_b32 a163, v235
v_accvgpr_read_b32 v232, a176
v_accvgpr_read_b32 v233, a177
v_accvgpr_read_b32 v234, a178
v_accvgpr_read_b32 v235, a179
v_mul_f32 v232, v232, v242
v_mul_f32 v233, v233, v248
v_mul_f32 v234, v234, v250
v_mul_f32 v235, v235, v251
v_accvgpr_write_b32 a176, v232
v_accvgpr_write_b32 a177, v233
v_accvgpr_write_b32 a178, v234
v_accvgpr_write_b32 a179, v235
v_accvgpr_read_b32 v232, a192
v_accvgpr_read_b32 v233, a193
v_accvgpr_read_b32 v234, a194
v_accvgpr_read_b32 v235, a195
v_mul_f32 v232, v232, v242
v_mul_f32 v233, v233, v248
v_mul_f32 v234, v234, v250
v_mul_f32 v235, v235, v251
v_accvgpr_write_b32 a192, v232
v_accvgpr_write_b32 a193, v233
v_accvgpr_write_b32 a194, v234
v_accvgpr_write_b32 a195, v235
v_accvgpr_read_b32 v232, a208
v_accvgpr_read_b32 v233, a209
v_accvgpr_read_b32 v234, a210
v_accvgpr_read_b32 v235, a211
v_mul_f32 v232, v232, v242
v_mul_f32 v233, v233, v248
v_mul_f32 v234, v234, v250
v_mul_f32 v235, v235, v251
v_accvgpr_write_b32 a208, v232
v_accvgpr_write_b32 a209, v233
v_accvgpr_write_b32 a210, v234
v_accvgpr_write_b32 a211, v235
v_accvgpr_read_b32 v232, a224
v_accvgpr_read_b32 v233, a225
v_accvgpr_read_b32 v234, a226
v_accvgpr_read_b32 v235, a227
v_mul_f32 v232, v232, v242
v_mul_f32 v233, v233, v248
v_mul_f32 v234, v234, v250
v_mul_f32 v235, v235, v251
v_accvgpr_write_b32 a224, v232
v_accvgpr_write_b32 a225, v233
v_accvgpr_write_b32 a226, v234
v_accvgpr_write_b32 a227, v235
v_accvgpr_read_b32 v232, a240
v_accvgpr_read_b32 v233, a241
v_accvgpr_read_b32 v234, a242
v_accvgpr_read_b32 v235, a243
v_mul_f32 v232, v232, v242
v_mul_f32 v233, v233, v248
v_mul_f32 v234, v234, v250
v_mul_f32 v235, v235, v251
v_accvgpr_write_b32 a240, v232
v_accvgpr_write_b32 a241, v233
v_accvgpr_write_b32 a242, v234
v_accvgpr_write_b32 a243, v235
v_lshrrev_b32 v232, 4, v243
v_and_b32 v232, 0x30, v232
ds_bpermute_b32 v242, v232, v237 offset:0
ds_bpermute_b32 v248, v232, v237 offset:4
ds_bpermute_b32 v250, v232, v237 offset:8
ds_bpermute_b32 v251, v232, v237 offset:12
s_waitcnt lgkmcnt(0)
v_accvgpr_read_b32 v232, a4
v_accvgpr_read_b32 v233, a5
v_accvgpr_read_b32 v234, a6
v_accvgpr_read_b32 v235, a7
v_mul_f32 v232, v232, v242
v_mul_f32 v233, v233, v248
v_mul_f32 v234, v234, v250
v_mul_f32 v235, v235, v251
v_accvgpr_write_b32 a4, v232
v_accvgpr_write_b32 a5, v233
v_accvgpr_write_b32 a6, v234
v_accvgpr_write_b32 a7, v235
v_accvgpr_read_b32 v232, a20
v_accvgpr_read_b32 v233, a21
v_accvgpr_read_b32 v234, a22
v_accvgpr_read_b32 v235, a23
v_mul_f32 v232, v232, v242
v_mul_f32 v233, v233, v248
v_mul_f32 v234, v234, v250
v_mul_f32 v235, v235, v251
v_accvgpr_write_b32 a20, v232
v_accvgpr_write_b32 a21, v233
v_accvgpr_write_b32 a22, v234
v_accvgpr_write_b32 a23, v235
v_accvgpr_read_b32 v232, a36
v_accvgpr_read_b32 v233, a37
v_accvgpr_read_b32 v234, a38
v_accvgpr_read_b32 v235, a39
v_mul_f32 v232, v232, v242
v_mul_f32 v233, v233, v248
v_mul_f32 v234, v234, v250
v_mul_f32 v235, v235, v251
v_accvgpr_write_b32 a36, v232
v_accvgpr_write_b32 a37, v233
v_accvgpr_write_b32 a38, v234
v_accvgpr_write_b32 a39, v235
v_accvgpr_read_b32 v232, a52
v_accvgpr_read_b32 v233, a53
v_accvgpr_read_b32 v234, a54
v_accvgpr_read_b32 v235, a55
v_mul_f32 v232, v232, v242
v_mul_f32 v233, v233, v248
v_mul_f32 v234, v234, v250
v_mul_f32 v235, v235, v251
v_accvgpr_write_b32 a52, v232
v_accvgpr_write_b32 a53, v233
v_accvgpr_write_b32 a54, v234
v_accvgpr_write_b32 a55, v235
v_accvgpr_read_b32 v232, a68
v_accvgpr_read_b32 v233, a69
v_accvgpr_read_b32 v234, a70
v_accvgpr_read_b32 v235, a71
v_mul_f32 v232, v232, v242
v_mul_f32 v233, v233, v248
v_mul_f32 v234, v234, v250
v_mul_f32 v235, v235, v251
v_accvgpr_write_b32 a68, v232
v_accvgpr_write_b32 a69, v233
v_accvgpr_write_b32 a70, v234
v_accvgpr_write_b32 a71, v235
v_accvgpr_read_b32 v232, a84
v_accvgpr_read_b32 v233, a85
v_accvgpr_read_b32 v234, a86
v_accvgpr_read_b32 v235, a87
v_mul_f32 v232, v232, v242
v_mul_f32 v233, v233, v248
v_mul_f32 v234, v234, v250
v_mul_f32 v235, v235, v251
v_accvgpr_write_b32 a84, v232
v_accvgpr_write_b32 a85, v233
v_accvgpr_write_b32 a86, v234
v_accvgpr_write_b32 a87, v235
v_accvgpr_read_b32 v232, a100
v_accvgpr_read_b32 v233, a101
v_accvgpr_read_b32 v234, a102
v_accvgpr_read_b32 v235, a103
v_mul_f32 v232, v232, v242
v_mul_f32 v233, v233, v248
v_mul_f32 v234, v234, v250
v_mul_f32 v235, v235, v251
v_accvgpr_write_b32 a100, v232
v_accvgpr_write_b32 a101, v233
v_accvgpr_write_b32 a102, v234
v_accvgpr_write_b32 a103, v235
v_accvgpr_read_b32 v232, a116
v_accvgpr_read_b32 v233, a117
v_accvgpr_read_b32 v234, a118
v_accvgpr_read_b32 v235, a119
v_mul_f32 v232, v232, v242
v_mul_f32 v233, v233, v248
v_mul_f32 v234, v234, v250
v_mul_f32 v235, v235, v251
v_accvgpr_write_b32 a116, v232
v_accvgpr_write_b32 a117, v233
v_accvgpr_write_b32 a118, v234
v_accvgpr_write_b32 a119, v235
v_accvgpr_read_b32 v232, a132
v_accvgpr_read_b32 v233, a133
v_accvgpr_read_b32 v234, a134
v_accvgpr_read_b32 v235, a135
v_mul_f32 v232, v232, v242
v_mul_f32 v233, v233, v248
v_mul_f32 v234, v234, v250
v_mul_f32 v235, v235, v251
v_accvgpr_write_b32 a132, v232
v_accvgpr_write_b32 a133, v233
v_accvgpr_write_b32 a134, v234
v_accvgpr_write_b32 a135, v235
v_accvgpr_read_b32 v232, a148
v_accvgpr_read_b32 v233, a149
v_accvgpr_read_b32 v234, a150
v_accvgpr_read_b32 v235, a151
v_mul_f32 v232, v232, v242
v_mul_f32 v233, v233, v248
v_mul_f32 v234, v234, v250
v_mul_f32 v235, v235, v251
v_accvgpr_write_b32 a148, v232
v_accvgpr_write_b32 a149, v233
v_accvgpr_write_b32 a150, v234
v_accvgpr_write_b32 a151, v235
v_accvgpr_read_b32 v232, a164
v_accvgpr_read_b32 v233, a165
v_accvgpr_read_b32 v234, a166
v_accvgpr_read_b32 v235, a167
v_mul_f32 v232, v232, v242
v_mul_f32 v233, v233, v248
v_mul_f32 v234, v234, v250
v_mul_f32 v235, v235, v251
v_accvgpr_write_b32 a164, v232
v_accvgpr_write_b32 a165, v233
v_accvgpr_write_b32 a166, v234
v_accvgpr_write_b32 a167, v235
v_accvgpr_read_b32 v232, a180
v_accvgpr_read_b32 v233, a181
v_accvgpr_read_b32 v234, a182
v_accvgpr_read_b32 v235, a183
v_mul_f32 v232, v232, v242
v_mul_f32 v233, v233, v248
v_mul_f32 v234, v234, v250
v_mul_f32 v235, v235, v251
v_accvgpr_write_b32 a180, v232
v_accvgpr_write_b32 a181, v233
v_accvgpr_write_b32 a182, v234
v_accvgpr_write_b32 a183, v235
v_accvgpr_read_b32 v232, a196
v_accvgpr_read_b32 v233, a197
v_accvgpr_read_b32 v234, a198
v_accvgpr_read_b32 v235, a199
v_mul_f32 v232, v232, v242
v_mul_f32 v233, v233, v248
v_mul_f32 v234, v234, v250
v_mul_f32 v235, v235, v251
v_accvgpr_write_b32 a196, v232
v_accvgpr_write_b32 a197, v233
v_accvgpr_write_b32 a198, v234
v_accvgpr_write_b32 a199, v235
v_accvgpr_read_b32 v232, a212
v_accvgpr_read_b32 v233, a213
v_accvgpr_read_b32 v234, a214
v_accvgpr_read_b32 v235, a215
v_mul_f32 v232, v232, v242
v_mul_f32 v233, v233, v248
v_mul_f32 v234, v234, v250
v_mul_f32 v235, v235, v251
v_accvgpr_write_b32 a212, v232
v_accvgpr_write_b32 a213, v233
v_accvgpr_write_b32 a214, v234
v_accvgpr_write_b32 a215, v235
v_accvgpr_read_b32 v232, a228
v_accvgpr_read_b32 v233, a229
v_accvgpr_read_b32 v234, a230
v_accvgpr_read_b32 v235, a231
v_mul_f32 v232, v232, v242
v_mul_f32 v233, v233, v248
v_mul_f32 v234, v234, v250
v_mul_f32 v235, v235, v251
v_accvgpr_write_b32 a228, v232
v_accvgpr_write_b32 a229, v233
v_accvgpr_write_b32 a230, v234
v_accvgpr_write_b32 a231, v235
v_accvgpr_read_b32 v232, a244
v_accvgpr_read_b32 v233, a245
v_accvgpr_read_b32 v234, a246
v_accvgpr_read_b32 v235, a247
v_mul_f32 v232, v232, v242
v_mul_f32 v233, v233, v248
v_mul_f32 v234, v234, v250
v_mul_f32 v235, v235, v251
v_accvgpr_write_b32 a244, v232
v_accvgpr_write_b32 a245, v233
v_accvgpr_write_b32 a246, v234
v_accvgpr_write_b32 a247, v235
v_lshrrev_b32 v232, 4, v243
v_and_b32 v232, 0x30, v232
ds_bpermute_b32 v242, v232, v238 offset:0
ds_bpermute_b32 v248, v232, v238 offset:4
ds_bpermute_b32 v250, v232, v238 offset:8
ds_bpermute_b32 v251, v232, v238 offset:12
s_waitcnt lgkmcnt(0)
v_accvgpr_read_b32 v232, a8
v_accvgpr_read_b32 v233, a9
v_accvgpr_read_b32 v234, a10
v_accvgpr_read_b32 v235, a11
v_mul_f32 v232, v232, v242
v_mul_f32 v233, v233, v248
v_mul_f32 v234, v234, v250
v_mul_f32 v235, v235, v251
v_accvgpr_write_b32 a8, v232
v_accvgpr_write_b32 a9, v233
v_accvgpr_write_b32 a10, v234
v_accvgpr_write_b32 a11, v235
v_accvgpr_read_b32 v232, a24
v_accvgpr_read_b32 v233, a25
v_accvgpr_read_b32 v234, a26
v_accvgpr_read_b32 v235, a27
v_mul_f32 v232, v232, v242
v_mul_f32 v233, v233, v248
v_mul_f32 v234, v234, v250
v_mul_f32 v235, v235, v251
v_accvgpr_write_b32 a24, v232
v_accvgpr_write_b32 a25, v233
v_accvgpr_write_b32 a26, v234
v_accvgpr_write_b32 a27, v235
v_accvgpr_read_b32 v232, a40
v_accvgpr_read_b32 v233, a41
v_accvgpr_read_b32 v234, a42
v_accvgpr_read_b32 v235, a43
v_mul_f32 v232, v232, v242
v_mul_f32 v233, v233, v248
v_mul_f32 v234, v234, v250
v_mul_f32 v235, v235, v251
v_accvgpr_write_b32 a40, v232
v_accvgpr_write_b32 a41, v233
v_accvgpr_write_b32 a42, v234
v_accvgpr_write_b32 a43, v235
v_accvgpr_read_b32 v232, a56
v_accvgpr_read_b32 v233, a57
v_accvgpr_read_b32 v234, a58
v_accvgpr_read_b32 v235, a59
v_mul_f32 v232, v232, v242
v_mul_f32 v233, v233, v248
v_mul_f32 v234, v234, v250
v_mul_f32 v235, v235, v251
v_accvgpr_write_b32 a56, v232
v_accvgpr_write_b32 a57, v233
v_accvgpr_write_b32 a58, v234
v_accvgpr_write_b32 a59, v235
v_accvgpr_read_b32 v232, a72
v_accvgpr_read_b32 v233, a73
v_accvgpr_read_b32 v234, a74
v_accvgpr_read_b32 v235, a75
v_mul_f32 v232, v232, v242
v_mul_f32 v233, v233, v248
v_mul_f32 v234, v234, v250
v_mul_f32 v235, v235, v251
v_accvgpr_write_b32 a72, v232
v_accvgpr_write_b32 a73, v233
v_accvgpr_write_b32 a74, v234
v_accvgpr_write_b32 a75, v235
v_accvgpr_read_b32 v232, a88
v_accvgpr_read_b32 v233, a89
v_accvgpr_read_b32 v234, a90
v_accvgpr_read_b32 v235, a91
v_mul_f32 v232, v232, v242
v_mul_f32 v233, v233, v248
v_mul_f32 v234, v234, v250
v_mul_f32 v235, v235, v251
v_accvgpr_write_b32 a88, v232
v_accvgpr_write_b32 a89, v233
v_accvgpr_write_b32 a90, v234
v_accvgpr_write_b32 a91, v235
v_accvgpr_read_b32 v232, a104
v_accvgpr_read_b32 v233, a105
v_accvgpr_read_b32 v234, a106
v_accvgpr_read_b32 v235, a107
v_mul_f32 v232, v232, v242
v_mul_f32 v233, v233, v248
v_mul_f32 v234, v234, v250
v_mul_f32 v235, v235, v251
v_accvgpr_write_b32 a104, v232
v_accvgpr_write_b32 a105, v233
v_accvgpr_write_b32 a106, v234
v_accvgpr_write_b32 a107, v235
v_accvgpr_read_b32 v232, a120
v_accvgpr_read_b32 v233, a121
v_accvgpr_read_b32 v234, a122
v_accvgpr_read_b32 v235, a123
v_mul_f32 v232, v232, v242
v_mul_f32 v233, v233, v248
v_mul_f32 v234, v234, v250
v_mul_f32 v235, v235, v251
v_accvgpr_write_b32 a120, v232
v_accvgpr_write_b32 a121, v233
v_accvgpr_write_b32 a122, v234
v_accvgpr_write_b32 a123, v235
v_accvgpr_read_b32 v232, a136
v_accvgpr_read_b32 v233, a137
v_accvgpr_read_b32 v234, a138
v_accvgpr_read_b32 v235, a139
v_mul_f32 v232, v232, v242
v_mul_f32 v233, v233, v248
v_mul_f32 v234, v234, v250
v_mul_f32 v235, v235, v251
v_accvgpr_write_b32 a136, v232
v_accvgpr_write_b32 a137, v233
v_accvgpr_write_b32 a138, v234
v_accvgpr_write_b32 a139, v235
v_accvgpr_read_b32 v232, a152
v_accvgpr_read_b32 v233, a153
v_accvgpr_read_b32 v234, a154
v_accvgpr_read_b32 v235, a155
v_mul_f32 v232, v232, v242
v_mul_f32 v233, v233, v248
v_mul_f32 v234, v234, v250
v_mul_f32 v235, v235, v251
v_accvgpr_write_b32 a152, v232
v_accvgpr_write_b32 a153, v233
v_accvgpr_write_b32 a154, v234
v_accvgpr_write_b32 a155, v235
v_accvgpr_read_b32 v232, a168
v_accvgpr_read_b32 v233, a169
v_accvgpr_read_b32 v234, a170
v_accvgpr_read_b32 v235, a171
v_mul_f32 v232, v232, v242
v_mul_f32 v233, v233, v248
v_mul_f32 v234, v234, v250
v_mul_f32 v235, v235, v251
v_accvgpr_write_b32 a168, v232
v_accvgpr_write_b32 a169, v233
v_accvgpr_write_b32 a170, v234
v_accvgpr_write_b32 a171, v235
v_accvgpr_read_b32 v232, a184
v_accvgpr_read_b32 v233, a185
v_accvgpr_read_b32 v234, a186
v_accvgpr_read_b32 v235, a187
v_mul_f32 v232, v232, v242
v_mul_f32 v233, v233, v248
v_mul_f32 v234, v234, v250
v_mul_f32 v235, v235, v251
v_accvgpr_write_b32 a184, v232
v_accvgpr_write_b32 a185, v233
v_accvgpr_write_b32 a186, v234
v_accvgpr_write_b32 a187, v235
v_accvgpr_read_b32 v232, a200
v_accvgpr_read_b32 v233, a201
v_accvgpr_read_b32 v234, a202
v_accvgpr_read_b32 v235, a203
v_mul_f32 v232, v232, v242
v_mul_f32 v233, v233, v248
v_mul_f32 v234, v234, v250
v_mul_f32 v235, v235, v251
v_accvgpr_write_b32 a200, v232
v_accvgpr_write_b32 a201, v233
v_accvgpr_write_b32 a202, v234
v_accvgpr_write_b32 a203, v235
v_accvgpr_read_b32 v232, a216
v_accvgpr_read_b32 v233, a217
v_accvgpr_read_b32 v234, a218
v_accvgpr_read_b32 v235, a219
v_mul_f32 v232, v232, v242
v_mul_f32 v233, v233, v248
v_mul_f32 v234, v234, v250
v_mul_f32 v235, v235, v251
v_accvgpr_write_b32 a216, v232
v_accvgpr_write_b32 a217, v233
v_accvgpr_write_b32 a218, v234
v_accvgpr_write_b32 a219, v235
v_accvgpr_read_b32 v232, a232
v_accvgpr_read_b32 v233, a233
v_accvgpr_read_b32 v234, a234
v_accvgpr_read_b32 v235, a235
v_mul_f32 v232, v232, v242
v_mul_f32 v233, v233, v248
v_mul_f32 v234, v234, v250
v_mul_f32 v235, v235, v251
v_accvgpr_write_b32 a232, v232
v_accvgpr_write_b32 a233, v233
v_accvgpr_write_b32 a234, v234
v_accvgpr_write_b32 a235, v235
v_accvgpr_read_b32 v232, a248
v_accvgpr_read_b32 v233, a249
v_accvgpr_read_b32 v234, a250
v_accvgpr_read_b32 v235, a251
v_mul_f32 v232, v232, v242
v_mul_f32 v233, v233, v248
v_mul_f32 v234, v234, v250
v_mul_f32 v235, v235, v251
v_accvgpr_write_b32 a248, v232
v_accvgpr_write_b32 a249, v233
v_accvgpr_write_b32 a250, v234
v_accvgpr_write_b32 a251, v235
v_lshrrev_b32 v232, 4, v243
v_and_b32 v232, 0x30, v232
ds_bpermute_b32 v242, v232, v239 offset:0
ds_bpermute_b32 v248, v232, v239 offset:4
ds_bpermute_b32 v250, v232, v239 offset:8
ds_bpermute_b32 v251, v232, v239 offset:12
s_waitcnt lgkmcnt(0)
v_accvgpr_read_b32 v232, a12
v_accvgpr_read_b32 v233, a13
v_accvgpr_read_b32 v234, a14
v_accvgpr_read_b32 v235, a15
v_mul_f32 v232, v232, v242
v_mul_f32 v233, v233, v248
v_mul_f32 v234, v234, v250
v_mul_f32 v235, v235, v251
v_accvgpr_write_b32 a12, v232
v_accvgpr_write_b32 a13, v233
v_accvgpr_write_b32 a14, v234
v_accvgpr_write_b32 a15, v235
v_accvgpr_read_b32 v232, a28
v_accvgpr_read_b32 v233, a29
v_accvgpr_read_b32 v234, a30
v_accvgpr_read_b32 v235, a31
v_mul_f32 v232, v232, v242
v_mul_f32 v233, v233, v248
v_mul_f32 v234, v234, v250
v_mul_f32 v235, v235, v251
v_accvgpr_write_b32 a28, v232
v_accvgpr_write_b32 a29, v233
v_accvgpr_write_b32 a30, v234
v_accvgpr_write_b32 a31, v235
v_accvgpr_read_b32 v232, a44
v_accvgpr_read_b32 v233, a45
v_accvgpr_read_b32 v234, a46
v_accvgpr_read_b32 v235, a47
v_mul_f32 v232, v232, v242
v_mul_f32 v233, v233, v248
v_mul_f32 v234, v234, v250
v_mul_f32 v235, v235, v251
v_accvgpr_write_b32 a44, v232
v_accvgpr_write_b32 a45, v233
v_accvgpr_write_b32 a46, v234
v_accvgpr_write_b32 a47, v235
v_accvgpr_read_b32 v232, a60
v_accvgpr_read_b32 v233, a61
v_accvgpr_read_b32 v234, a62
v_accvgpr_read_b32 v235, a63
v_mul_f32 v232, v232, v242
v_mul_f32 v233, v233, v248
v_mul_f32 v234, v234, v250
v_mul_f32 v235, v235, v251
v_accvgpr_write_b32 a60, v232
v_accvgpr_write_b32 a61, v233
v_accvgpr_write_b32 a62, v234
v_accvgpr_write_b32 a63, v235
v_accvgpr_read_b32 v232, a76
v_accvgpr_read_b32 v233, a77
v_accvgpr_read_b32 v234, a78
v_accvgpr_read_b32 v235, a79
v_mul_f32 v232, v232, v242
v_mul_f32 v233, v233, v248
v_mul_f32 v234, v234, v250
v_mul_f32 v235, v235, v251
v_accvgpr_write_b32 a76, v232
v_accvgpr_write_b32 a77, v233
v_accvgpr_write_b32 a78, v234
v_accvgpr_write_b32 a79, v235
v_accvgpr_read_b32 v232, a92
v_accvgpr_read_b32 v233, a93
v_accvgpr_read_b32 v234, a94
v_accvgpr_read_b32 v235, a95
v_mul_f32 v232, v232, v242
v_mul_f32 v233, v233, v248
v_mul_f32 v234, v234, v250
v_mul_f32 v235, v235, v251
v_accvgpr_write_b32 a92, v232
v_accvgpr_write_b32 a93, v233
v_accvgpr_write_b32 a94, v234
v_accvgpr_write_b32 a95, v235
v_accvgpr_read_b32 v232, a108
v_accvgpr_read_b32 v233, a109
v_accvgpr_read_b32 v234, a110
v_accvgpr_read_b32 v235, a111
v_mul_f32 v232, v232, v242
v_mul_f32 v233, v233, v248
v_mul_f32 v234, v234, v250
v_mul_f32 v235, v235, v251
v_accvgpr_write_b32 a108, v232
v_accvgpr_write_b32 a109, v233
v_accvgpr_write_b32 a110, v234
v_accvgpr_write_b32 a111, v235
v_accvgpr_read_b32 v232, a124
v_accvgpr_read_b32 v233, a125
v_accvgpr_read_b32 v234, a126
v_accvgpr_read_b32 v235, a127
v_mul_f32 v232, v232, v242
v_mul_f32 v233, v233, v248
v_mul_f32 v234, v234, v250
v_mul_f32 v235, v235, v251
v_accvgpr_write_b32 a124, v232
v_accvgpr_write_b32 a125, v233
v_accvgpr_write_b32 a126, v234
v_accvgpr_write_b32 a127, v235
v_accvgpr_read_b32 v232, a140
v_accvgpr_read_b32 v233, a141
v_accvgpr_read_b32 v234, a142
v_accvgpr_read_b32 v235, a143
v_mul_f32 v232, v232, v242
v_mul_f32 v233, v233, v248
v_mul_f32 v234, v234, v250
v_mul_f32 v235, v235, v251
v_accvgpr_write_b32 a140, v232
v_accvgpr_write_b32 a141, v233
v_accvgpr_write_b32 a142, v234
v_accvgpr_write_b32 a143, v235
v_accvgpr_read_b32 v232, a156
v_accvgpr_read_b32 v233, a157
v_accvgpr_read_b32 v234, a158
v_accvgpr_read_b32 v235, a159
v_mul_f32 v232, v232, v242
v_mul_f32 v233, v233, v248
v_mul_f32 v234, v234, v250
v_mul_f32 v235, v235, v251
v_accvgpr_write_b32 a156, v232
v_accvgpr_write_b32 a157, v233
v_accvgpr_write_b32 a158, v234
v_accvgpr_write_b32 a159, v235
v_accvgpr_read_b32 v232, a172
v_accvgpr_read_b32 v233, a173
v_accvgpr_read_b32 v234, a174
v_accvgpr_read_b32 v235, a175
v_mul_f32 v232, v232, v242
v_mul_f32 v233, v233, v248
v_mul_f32 v234, v234, v250
v_mul_f32 v235, v235, v251
v_accvgpr_write_b32 a172, v232
v_accvgpr_write_b32 a173, v233
v_accvgpr_write_b32 a174, v234
v_accvgpr_write_b32 a175, v235
v_accvgpr_read_b32 v232, a188
v_accvgpr_read_b32 v233, a189
v_accvgpr_read_b32 v234, a190
v_accvgpr_read_b32 v235, a191
v_mul_f32 v232, v232, v242
v_mul_f32 v233, v233, v248
v_mul_f32 v234, v234, v250
v_mul_f32 v235, v235, v251
v_accvgpr_write_b32 a188, v232
v_accvgpr_write_b32 a189, v233
v_accvgpr_write_b32 a190, v234
v_accvgpr_write_b32 a191, v235
v_accvgpr_read_b32 v232, a204
v_accvgpr_read_b32 v233, a205
v_accvgpr_read_b32 v234, a206
v_accvgpr_read_b32 v235, a207
v_mul_f32 v232, v232, v242
v_mul_f32 v233, v233, v248
v_mul_f32 v234, v234, v250
v_mul_f32 v235, v235, v251
v_accvgpr_write_b32 a204, v232
v_accvgpr_write_b32 a205, v233
v_accvgpr_write_b32 a206, v234
v_accvgpr_write_b32 a207, v235
v_accvgpr_read_b32 v232, a220
v_accvgpr_read_b32 v233, a221
v_accvgpr_read_b32 v234, a222
v_accvgpr_read_b32 v235, a223
v_mul_f32 v232, v232, v242
v_mul_f32 v233, v233, v248
v_mul_f32 v234, v234, v250
v_mul_f32 v235, v235, v251
v_accvgpr_write_b32 a220, v232
v_accvgpr_write_b32 a221, v233
v_accvgpr_write_b32 a222, v234
v_accvgpr_write_b32 a223, v235
v_accvgpr_read_b32 v232, a236
v_accvgpr_read_b32 v233, a237
v_accvgpr_read_b32 v234, a238
v_accvgpr_read_b32 v235, a239
v_mul_f32 v232, v232, v242
v_mul_f32 v233, v233, v248
v_mul_f32 v234, v234, v250
v_mul_f32 v235, v235, v251
v_accvgpr_write_b32 a236, v232
v_accvgpr_write_b32 a237, v233
v_accvgpr_write_b32 a238, v234
v_accvgpr_write_b32 a239, v235
v_accvgpr_read_b32 v232, a252
v_accvgpr_read_b32 v233, a253
v_accvgpr_read_b32 v234, a254
v_accvgpr_read_b32 v235, a255
v_mul_f32 v232, v232, v242
v_mul_f32 v233, v233, v248
v_mul_f32 v234, v234, v250
v_mul_f32 v235, v235, v251
v_accvgpr_write_b32 a252, v232
v_accvgpr_write_b32 a253, v233
v_accvgpr_write_b32 a254, v234
v_accvgpr_write_b32 a255, v235
s_nop 3
s_cmp_eq_u32 s36, 0
s_cbranch_scc1 L2_rr0
s_cmp_eq_u32 s36, 1
s_cbranch_scc1 L2_rr1
s_cmp_eq_u32 s36, 2
s_cbranch_scc1 L2_rr2
s_cmp_eq_u32 s36, 3
s_cbranch_scc1 L2_rr3
s_cmp_eq_u32 s36, 4
s_cbranch_scc1 L2_rr4
s_cmp_eq_u32 s36, 5
s_cbranch_scc1 L2_rr5
s_cmp_eq_u32 s36, 6
s_cbranch_scc1 L2_rr6
s_cmp_eq_u32 s36, 7
s_cbranch_scc1 L2_rr7
s_cmp_eq_u32 s36, 8
s_cbranch_scc1 L2_rr8
s_cmp_eq_u32 s36, 9
s_cbranch_scc1 L2_rr9
s_cmp_eq_u32 s36, 10
s_cbranch_scc1 L2_rr10
s_cmp_eq_u32 s36, 11
s_cbranch_scc1 L2_rr11
s_cmp_eq_u32 s36, 12
s_cbranch_scc1 L2_rr12
s_cmp_eq_u32 s36, 13
s_cbranch_scc1 L2_rr13
s_cmp_eq_u32 s36, 14
s_cbranch_scc1 L2_rr14
s_cmp_eq_u32 s36, 15
s_cbranch_scc1 L2_rr15
s_cmp_eq_u32 s36, 16
s_cbranch_scc1 L2_rr16
L2_rr17:
s_waitcnt lgkmcnt(0)
s_branch L2_ret17
L2_rr16:
s_waitcnt lgkmcnt(0)
s_branch L2_ret16
L2_rr15:
s_waitcnt lgkmcnt(0)
s_branch L2_ret15
L2_rr14:
s_waitcnt lgkmcnt(0)
s_branch L2_ret14
L2_rr13:
s_waitcnt lgkmcnt(0)
s_branch L2_ret13
L2_rr12:
s_waitcnt lgkmcnt(0)
s_branch L2_ret12
L2_rr11:
s_waitcnt lgkmcnt(0)
s_branch L2_ret11
L2_rr10:
s_waitcnt lgkmcnt(0)
s_branch L2_ret10
L2_rr9:
s_waitcnt lgkmcnt(0)
s_branch L2_ret9
L2_rr8:
s_waitcnt lgkmcnt(0)
s_branch L2_ret8
L2_rr7:
s_waitcnt lgkmcnt(0)
s_branch L2_ret7
L2_rr6:
s_waitcnt lgkmcnt(0)
s_branch L2_ret6
L2_rr5:
s_waitcnt lgkmcnt(0)
s_branch L2_ret5
L2_rr4:
s_waitcnt lgkmcnt(0)
s_branch L2_ret4
L2_rr3:
s_waitcnt lgkmcnt(0)
s_branch L2_ret3
L2_rr2:
s_waitcnt lgkmcnt(0)
s_branch L2_ret2
L2_rr1:
s_waitcnt lgkmcnt(0)
s_branch L2_ret1
L2_rr0:
s_waitcnt lgkmcnt(0)
s_branch L2_ret0
s_endpgm
.section .rodata,"a"
.p2align 6
.amdhsa_kernel standalone__hybrid_graph_tf_graphgps__graph_kernel
  .amdhsa_next_free_vgpr 512
  .amdhsa_next_free_sgpr 102
  .amdhsa_accum_offset 256
  .amdhsa_group_segment_fixed_size 0
  .amdhsa_kernarg_size 96
  .amdhsa_user_sgpr_count 2
  .amdhsa_user_sgpr_kernarg_segment_ptr 1
  .amdhsa_system_sgpr_workgroup_id_x 1
.end_amdhsa_kernel
```

```asm
; @launch grid=(256,1,1) block=(256,1,1) lds=163840
.amdgcn_target "amdgcn-amd-amdhsa--gfx950"
.text
.globl standalone__hybrid_graph_tf_graphgps__graph_kernel
.p2align 8
.type standalone__hybrid_graph_tf_graphgps__graph_kernel,@function
standalone__hybrid_graph_tf_graphgps__graph_kernel:
s_getpc_b64 s[56:57]
s_load_dwordx16 s[16:31], s[0:1], 0
s_load_dwordx8 s[32:39], s[0:1], 64
s_cmp_ge_u32 s2, 256
s_cbranch_scc1 L2_end
v_lshrrev_b32 v1, 6, v0
v_and_b32 v2, 63, v0
s_lshr_b32 s3, s2, 3
s_add_u32 s3, s3, 30
s_and_b32 s3, s3, 31
v_readfirstlane_b32 s60, v1
s_lshl_b32 s5, s3, 2
s_add_u32 s5, s5, s60
s_and_b32 s56, s56, 0xffffff00
s_mov_b32 s58, L2_hot-standalone__hybrid_graph_tf_graphgps__graph_kernel
s_mov_b32 s59, 0x00020000
s_and_b32 s6, s5, 15
s_lshl_b32 s6, s6, 13
s_cmp_lt_u32 s5, 32
s_cselect_b32 s6, s6, 0x7fff0000
v_lshlrev_b32 v10, 7, v2
buffer_load_dword v255, v10, s[56:59], s6 offen
v_and_b32 v3, 15, v2
v_lshrrev_b32 v4, 4, v2
s_and_b32 s62, s3, 7
s_mov_b64 s[14:15], 0
s_and_b32 s8, s2, 7
s_cmp_ge_u32 s3, 30
s_cbranch_scc1 LM_edge
s_mul_i32 s12, s3, 26
s_lshr_b32 s12, s12, 8
s_mul_i32 s9, s12, 10
s_sub_u32 s9, s3, s9
s_and_b32 s13, s8, 1
s_mul_i32 s13, s13, 3
s_add_u32 s13, s13, s12
s_and_b32 s12, s8, 1
s_mul_i32 s12, s12, 5
s_add_u32 s8, s8, s12
s_and_b32 s8, s8, 7
s_lshr_b32 s12, s8, 1
s_mul_i32 s12, s12, 10
s_add_u32 s12, s12, s9
s_mul_i32 s91, s12, 6
s_add_u32 s91, s91, s13
s_mov_b32 s61, 0
s_cmp_eq_u32 s12, 39
s_cbranch_scc1 LM_light
s_mul_i32 s14, s13, 3
s_min_u32 s14, s14, 14
s_lshl_b32 s9, s12, 4
s_add_u32 s14, s14, s9
s_lshl_b32 s14, s14, 13
s_cmp_eq_u32 s91, 233
s_cselect_b32 s9, 0, s13
s_cmp_lt_u32 s9, 4
s_cselect_b32 s15, 3, 2
s_lshl_b32 s15, s15, 13
s_add_u32 s15, s15, s14
v_lshlrev_b32 v16, 4, v2
s_mul_i32 s63, s60, 12288
s_mov_b32 s6, s14
s_mul_i32 s7, s60, 6144
s_add_u32 s64, s6, s7
s_add_u32 s65, s64, 4096
s_lshl_b32 s7, s60, 7
v_lshrrev_b32 v5, 3, v2
v_and_b32 v6, 7, v2
v_and_b32 v7, 2, v5
v_xor_b32 v6, v6, v7
v_lshl_add_u32 v5, v5, 9, s7
v_lshl_add_u32 v17, v6, 4, v5
v_xor_b32 v6, 4, v6
v_lshl_add_u32 v18, v6, 4, v5
v_add_u32 v18, 0xc00, v18
v_add_u32 v19, 0x1800, v17
v_add_u32 v20, 0x1800, v18
s_xor_b32 s6, s62, 0
s_lshl_b32 s66, s6, 14
s_xor_b32 s6, s62, 1
s_lshl_b32 s67, s6, 14
s_xor_b32 s6, s62, 2
s_lshl_b32 s68, s6, 14
s_xor_b32 s6, s62, 3
s_lshl_b32 s69, s6, 14
s_xor_b32 s6, s62, 4
s_lshl_b32 s70, s6, 14
s_xor_b32 s6, s62, 5
s_lshl_b32 s71, s6, 14
s_xor_b32 s6, s62, 6
s_lshl_b32 s72, s6, 14
s_xor_b32 s6, s62, 7
s_lshl_b32 s73, s6, 14
s_waitcnt lgkmcnt(0)
s_add_u32 s40, s16, 0x0
s_addc_u32 s41, s17, 0
s_mov_b32 s42, s15
s_mov_b32 s43, 0x00020000
s_add_u32 s44, s26, 0x0
s_addc_u32 s45, s27, 0
s_mov_b32 s46, 0x20000
s_mov_b32 s47, 0x00020000
buffer_load_dwordx4 v[44:47], v16, s[40:43], s64 offen offset:0
buffer_load_dwordx4 v[48:51], v16, s[40:43], s64 offen offset:1024
buffer_load_dwordx4 v[52:55], v16, s[40:43], s64 offen offset:2048
buffer_load_dwordx4 v[56:59], v16, s[40:43], s64 offen offset:3072
buffer_load_dwordx4 v[60:63], v16, s[40:43], s65 offen offset:0
buffer_load_dwordx4 v[64:67], v16, s[40:43], s65 offen offset:1024
s_add_u32 m0, s63, 0x0
s_nop 0
buffer_load_dwordx4 v17, s[44:47], s66 offen offset:0 lds
buffer_load_dwordx4 v18, s[44:47], s66 offen offset:1024 lds
buffer_load_dwordx4 v19, s[44:47], s66 offen offset:2048 lds
buffer_load_dwordx4 v20, s[44:47], s66 offen offset:3072 lds
s_add_u32 m0, s63, 0x1000
s_nop 0
buffer_load_dwordx4 v17, s[44:47], s67 offen offset:0 lds
buffer_load_dwordx4 v18, s[44:47], s67 offen offset:1024 lds
buffer_load_dwordx4 v19, s[44:47], s67 offen offset:2048 lds
buffer_load_dwordx4 v20, s[44:47], s67 offen offset:3072 lds
s_mov_b32 s98, 0x7c3ff80
s_load_dwordx2 s[98:99], s[38:39], s98
v_bfe_u32 v5, v2, 2, 3
v_xor_b32 v5, s62, v5
v_and_b32 v6, 3, v2
v_lshlrev_b32 v7, 10, v5
v_lshl_add_u32 v7, v6, 8, v7
v_add_u32 v7, 0xc000, v7
v_and_b32 v5, 1, v5
v_lshl_or_b32 v6, v5, 2, v6
v_lshrrev_b32 v5, 5, v2
s_mul_i32 s6, s60, 12
v_add3_u32 v8, v5, s6, 0
v_lshrrev_b32 v9, 4, v8
v_lshl_add_u32 v9, v9, 13, v7
v_and_b32 v8, 15, v8
v_xor_b32 v8, v8, v6
v_lshl_add_u32 v36, v8, 4, v9
v_add3_u32 v8, v5, s6, 2
v_lshrrev_b32 v9, 4, v8
v_lshl_add_u32 v9, v9, 13, v7
v_and_b32 v8, 15, v8
v_xor_b32 v8, v8, v6
v_lshl_add_u32 v37, v8, 4, v9
v_add3_u32 v8, v5, s6, 4
v_lshrrev_b32 v9, 4, v8
v_lshl_add_u32 v9, v9, 13, v7
v_and_b32 v8, 15, v8
v_xor_b32 v8, v8, v6
v_lshl_add_u32 v38, v8, 4, v9
v_add3_u32 v8, v5, s6, 6
v_lshrrev_b32 v9, 4, v8
v_lshl_add_u32 v9, v9, 13, v7
v_and_b32 v8, 15, v8
v_xor_b32 v8, v8, v6
v_lshl_add_u32 v39, v8, 4, v9
v_add3_u32 v8, v5, s6, 8
v_lshrrev_b32 v9, 4, v8
v_lshl_add_u32 v9, v9, 13, v7
v_and_b32 v8, 15, v8
v_xor_b32 v8, v8, v6
v_lshl_add_u32 v40, v8, 4, v9
v_add3_u32 v8, v5, s6, 10
v_lshrrev_b32 v9, 4, v8
v_lshl_add_u32 v9, v9, 13, v7
v_and_b32 v8, 15, v8
v_xor_b32 v8, v8, v6
v_lshl_add_u32 v41, v8, 4, v9
v_xor_b32 v5, v3, v4
v_lshlrev_b32 v5, 4, v5
v_lshl_add_u32 v5, v4, 8, v5
v_add_u32 v31, 0xc000, v5
v_xor_b32 v32, 64, v31
v_lshrrev_b32 v5, 2, v3
v_and_b32 v6, 3, v3
v_and_b32 v7, 1, v4
v_lshlrev_b32 v7, 2, v7
v_and_b32 v8, 2, v5
v_or_b32 v7, v7, v8
v_lshl_add_u32 v8, v4, 3, v5
v_lshlrev_b32 v8, 7, v8
v_add_u32 v8, s63, v8
v_and_b32 v9, 1, v6
v_lshl_add_u32 v8, v9, 3, v8
v_lshrrev_b32 v6, 1, v6
v_xor_b32 v6, v6, v7
v_xor_b32 v9, 0, v6
v_lshl_add_u32 v25, v9, 4, v8
v_xor_b32 v9, 2, v6
v_lshl_add_u32 v26, v9, 4, v8
v_xor_b32 v9, 4, v6
v_lshl_add_u32 v27, v9, 4, v8
v_xor_b32 v9, 6, v6
v_lshl_add_u32 v28, v9, 4, v8
v_lshrrev_b32 v5, 3, v2
v_and_b32 v6, 7, v2
v_lshrrev_b32 v7, 1, v5
v_xor_b32 v6, v6, v7
v_and_b32 v7, 4, v5
v_add_u32 v5, v5, v7
s_mul_i32 s6, s60, 32768
v_lshl_add_u32 v5, v5, 9, s6
v_lshl_add_u32 v21, v6, 4, v5
v_xor_b32 v6, 4, v6
v_lshl_add_u32 v22, v6, 4, v5
v_add_u32 v22, 0x1c00, v22
v_mov_b32 v23, v21
v_mov_b32 v24, v22
s_lshr_b32 s7, s62, 1
s_xor_b32 s6, s7, 0
s_lshl_b32 s74, s6, 7
s_add_u32 s75, s74, 16384
s_xor_b32 s6, s7, 1
s_lshl_b32 s76, s6, 7
s_add_u32 s77, s76, 16384
s_xor_b32 s6, s7, 2
s_lshl_b32 s78, s6, 7
s_add_u32 s79, s78, 16384
s_xor_b32 s6, s7, 3
s_lshl_b32 s80, s6, 7
s_add_u32 s81, s80, 16384
s_and_b32 s6, s62, 1
s_lshl_b32 s6, s6, 2
v_lshrrev_b32 v5, 1, v3
v_xor_b32 v5, v5, v4
v_xor_b32 v5, s6, v5
v_lshl_add_u32 v6, v3, 7, s63
v_lshl_add_u32 v29, v5, 4, v6
v_xor_b32 v30, 64, v29
s_mul_i32 s6, s60, 2
s_xor_b32 s6, s6, s62
s_lshl_b32 s6, s6, 10
s_add_u32 s6, s6, 0x12000
v_lshrrev_b32 v5, 1, v4
v_and_b32 v6, 1, v4
v_lshl_add_u32 v5, v5, 8, s6
v_lshl_add_u32 v5, v6, 3, v5
v_lshl_add_u32 v33, v3, 4, v5
v_xor_b32 v34, 0x400, v33
v_add_u32 v35, 0x12000, v16
s_mov_b32 s6, s14
s_mul_i32 s7, s60, 2048
s_add_u32 s82, s6, s7
s_add_u32 s83, s82, 8192
s_add_u32 s84, s82, 16384
s_mov_b32 s86, 0x3db8aa3b
s_mov_b32 s87, 0x3db8aa3b
s_mov_b32 s88, 0x3727c5ac
s_mov_b32 s89, 0x3b800000
s_mov_b32 s90, 0xffff0000
s_add_u32 s48, s28, 0x0
s_addc_u32 s49, s29, 0
s_mov_b32 s50, 0x20000
s_mov_b32 s51, 0x00020000
s_add_u32 s52, s38, 0x0
s_addc_u32 s53, s39, 0
s_mov_b32 s54, s15
s_mov_b32 s55, 0x00020000
s_add_u32 s56, s38, 0x6800000
s_addc_u32 s57, s39, 0
s_mov_b32 s58, s15
s_mov_b32 s59, 0x00020000
s_waitcnt vmcnt(13)
v_lshlrev_b32 v116, 16, v44
v_and_b32 v117, s90, v44
v_lshlrev_b32 v118, 16, v45
v_and_b32 v119, s90, v45
v_lshlrev_b32 v120, 16, v46
v_and_b32 v121, s90, v46
v_lshlrev_b32 v122, 16, v47
v_and_b32 v123, s90, v47
v_pk_add_f32 v[164:165], v[116:117], v[118:119]
v_pk_mul_f32 v[166:167], v[116:117], v[116:117]
v_pk_add_f32 v[44:45], v[120:121], v[122:123]
v_pk_fma_f32 v[166:167], v[118:119], v[118:119], v[166:167]
v_pk_add_f32 v[164:165], v[164:165], v[44:45]
v_pk_fma_f32 v[166:167], v[120:121], v[120:121], v[166:167]
v_add_f32 v164, v164, v165
v_pk_fma_f32 v[166:167], v[122:123], v[122:123], v[166:167]
v_add_f32 v166, v166, v167
s_waitcnt vmcnt(12)
v_lshlrev_b32 v124, 16, v48
v_and_b32 v125, s90, v48
v_lshlrev_b32 v126, 16, v49
v_and_b32 v127, s90, v49
v_lshlrev_b32 v128, 16, v50
v_and_b32 v129, s90, v50
v_lshlrev_b32 v130, 16, v51
v_and_b32 v131, s90, v51
v_pk_add_f32 v[168:169], v[124:125], v[126:127]
v_pk_mul_f32 v[170:171], v[124:125], v[124:125]
v_pk_add_f32 v[48:49], v[128:129], v[130:131]
v_pk_fma_f32 v[170:171], v[126:127], v[126:127], v[170:171]
v_pk_add_f32 v[168:169], v[168:169], v[48:49]
v_pk_fma_f32 v[170:171], v[128:129], v[128:129], v[170:171]
v_add_f32 v168, v168, v169
v_pk_fma_f32 v[170:171], v[130:131], v[130:131], v[170:171]
v_add_f32 v170, v170, v171
s_waitcnt vmcnt(11)
v_lshlrev_b32 v132, 16, v52
v_and_b32 v133, s90, v52
v_lshlrev_b32 v134, 16, v53
v_and_b32 v135, s90, v53
v_lshlrev_b32 v136, 16, v54
v_and_b32 v137, s90, v54
v_lshlrev_b32 v138, 16, v55
v_and_b32 v139, s90, v55
v_pk_add_f32 v[172:173], v[132:133], v[134:135]
v_pk_mul_f32 v[174:175], v[132:133], v[132:133]
v_pk_add_f32 v[52:53], v[136:137], v[138:139]
v_pk_fma_f32 v[174:175], v[134:135], v[134:135], v[174:175]
v_pk_add_f32 v[172:173], v[172:173], v[52:53]
v_pk_fma_f32 v[174:175], v[136:137], v[136:137], v[174:175]
v_add_f32 v172, v172, v173
v_pk_fma_f32 v[174:175], v[138:139], v[138:139], v[174:175]
v_add_f32 v174, v174, v175
s_waitcnt vmcnt(10)
v_lshlrev_b32 v140, 16, v56
v_and_b32 v141, s90, v56
v_lshlrev_b32 v142, 16, v57
v_and_b32 v143, s90, v57
v_lshlrev_b32 v144, 16, v58
v_and_b32 v145, s90, v58
v_lshlrev_b32 v146, 16, v59
v_and_b32 v147, s90, v59
v_pk_add_f32 v[176:177], v[140:141], v[142:143]
v_pk_mul_f32 v[178:179], v[140:141], v[140:141]
v_pk_add_f32 v[56:57], v[144:145], v[146:147]
v_pk_fma_f32 v[178:179], v[142:143], v[142:143], v[178:179]
v_pk_add_f32 v[176:177], v[176:177], v[56:57]
v_pk_fma_f32 v[178:179], v[144:145], v[144:145], v[178:179]
v_add_f32 v176, v176, v177
v_pk_fma_f32 v[178:179], v[146:147], v[146:147], v[178:179]
v_add_f32 v178, v178, v179
s_waitcnt vmcnt(9)
v_lshlrev_b32 v148, 16, v60
v_and_b32 v149, s90, v60
v_lshlrev_b32 v150, 16, v61
v_and_b32 v151, s90, v61
v_lshlrev_b32 v152, 16, v62
v_and_b32 v153, s90, v62
v_lshlrev_b32 v154, 16, v63
v_and_b32 v155, s90, v63
v_pk_add_f32 v[180:181], v[148:149], v[150:151]
v_pk_mul_f32 v[182:183], v[148:149], v[148:149]
v_pk_add_f32 v[60:61], v[152:153], v[154:155]
v_pk_fma_f32 v[182:183], v[150:151], v[150:151], v[182:183]
v_pk_add_f32 v[180:181], v[180:181], v[60:61]
v_pk_fma_f32 v[182:183], v[152:153], v[152:153], v[182:183]
v_add_f32 v180, v180, v181
v_pk_fma_f32 v[182:183], v[154:155], v[154:155], v[182:183]
v_add_f32 v182, v182, v183
s_waitcnt vmcnt(8)
v_lshlrev_b32 v156, 16, v64
v_and_b32 v157, s90, v64
v_lshlrev_b32 v158, 16, v65
v_and_b32 v159, s90, v65
v_lshlrev_b32 v160, 16, v66
v_and_b32 v161, s90, v66
v_lshlrev_b32 v162, 16, v67
v_and_b32 v163, s90, v67
v_pk_add_f32 v[184:185], v[156:157], v[158:159]
v_pk_mul_f32 v[186:187], v[156:157], v[156:157]
v_pk_add_f32 v[64:65], v[160:161], v[162:163]
v_pk_fma_f32 v[186:187], v[158:159], v[158:159], v[186:187]
v_pk_add_f32 v[184:185], v[184:185], v[64:65]
v_pk_fma_f32 v[186:187], v[160:161], v[160:161], v[186:187]
v_add_f32 v184, v184, v185
v_pk_fma_f32 v[186:187], v[162:163], v[162:163], v[186:187]
v_add_f32 v186, v186, v187
v_permlane16_swap_b32 v164, v166
v_permlane16_swap_b32 v168, v170
v_permlane16_swap_b32 v172, v174
v_permlane16_swap_b32 v176, v178
v_permlane16_swap_b32 v180, v182
v_permlane16_swap_b32 v184, v186
v_add_f32 v164, v164, v166
v_add_f32 v168, v168, v170
v_add_f32 v172, v172, v174
v_add_f32 v176, v176, v178
v_add_f32 v180, v180, v182
v_add_f32 v184, v184, v186
v_add_f32_dpp v165, v164, v164 row_ror:8 row_mask:0xf bank_mask:0x3
v_add_f32_dpp v165, v168, v168 row_ror:8 row_mask:0xf bank_mask:0xc
v_add_f32_dpp v173, v172, v172 row_ror:8 row_mask:0xf bank_mask:0x3
v_add_f32_dpp v173, v176, v176 row_ror:8 row_mask:0xf bank_mask:0xc
v_add_f32_dpp v181, v180, v180 row_ror:8 row_mask:0xf bank_mask:0x3
v_add_f32_dpp v181, v184, v184 row_ror:8 row_mask:0xf bank_mask:0xc
v_add_f32_dpp v166, v165, v165 row_half_mirror row_mask:0xf bank_mask:0x5
v_add_f32_dpp v166, v173, v173 row_half_mirror row_mask:0xf bank_mask:0xa
v_add_f32_dpp v182, v181, v181 row_half_mirror row_mask:0xf bank_mask:0xf
s_nop 0
v_add_f32_dpp v166, v166, v166 quad_perm:[1,0,3,2] row_mask:0xf bank_mask:0xf
v_add_f32_dpp v182, v182, v182 quad_perm:[1,0,3,2] row_mask:0xf bank_mask:0xf
s_nop 0
v_add_f32_dpp v166, v166, v166 quad_perm:[2,3,0,1] row_mask:0xf bank_mask:0xf
v_add_f32_dpp v182, v182, v182 quad_perm:[2,3,0,1] row_mask:0xf bank_mask:0xf
v_mov_b32 v167, v166
v_mov_b32 v183, v182
s_nop 0
v_permlane16_swap_b32 v167, v166
v_permlane16_swap_b32 v183, v182
v_mul_f32 v167, s89, v167
v_mul_f32 v183, s89, v183
v_mul_f32 v166, s89, v166
v_mul_f32 v182, s89, v182
v_fma_f32 v166, -v167, v167, v166
v_fma_f32 v182, -v183, v183, v182
v_max_f32 v166, 0, v166
v_max_f32 v182, 0, v182
v_cvt_pk_bf16_f32 v166, v166, v166
v_cvt_pk_bf16_f32 v182, v182, v182
v_and_b32 v166, s90, v166
v_and_b32 v182, s90, v182
v_add_f32 v166, s88, v166
v_add_f32 v182, s88, v182
v_cvt_pk_bf16_f32 v166, v166, v166
v_cvt_pk_bf16_f32 v182, v182, v182
v_and_b32 v166, s90, v166
v_and_b32 v182, s90, v182
v_sqrt_f32 v166, v166
v_sqrt_f32 v182, v182
s_nop 0
s_nop 0
v_cvt_pk_bf16_f32 v166, v166, v166
v_cvt_pk_bf16_f32 v182, v182, v182
v_and_b32 v166, s90, v166
v_and_b32 v182, s90, v182
v_rcp_f32 v166, v166
v_rcp_f32 v182, v182
v_mul_f32 v167, -v167, v166
v_mul_f32 v183, -v183, v182
s_nop 0
v_mov_b64_dpp v[164:165], v[166:167] row_newbcast:0 row_mask:0xf bank_mask:0xf
v_mov_b64_dpp v[168:169], v[166:167] row_newbcast:8 row_mask:0xf bank_mask:0xf
v_mov_b64_dpp v[172:173], v[166:167] row_newbcast:4 row_mask:0xf bank_mask:0xf
v_mov_b64_dpp v[176:177], v[166:167] row_newbcast:12 row_mask:0xf bank_mask:0xf
v_mov_b64_dpp v[180:181], v[182:183] row_newbcast:0 row_mask:0xf bank_mask:0xf
v_mov_b64_dpp v[184:185], v[182:183] row_newbcast:8 row_mask:0xf bank_mask:0xf
v_fma_f32 v116, v116, v164, v165
v_fma_f32 v117, v117, v164, v165
v_fma_f32 v118, v118, v164, v165
v_fma_f32 v119, v119, v164, v165
v_fma_f32 v120, v120, v164, v165
v_fma_f32 v121, v121, v164, v165
v_fma_f32 v122, v122, v164, v165
v_fma_f32 v123, v123, v164, v165
v_cvt_pk_bf16_f32 v44, v116, v117
v_cvt_pk_bf16_f32 v45, v118, v119
v_cvt_pk_bf16_f32 v46, v120, v121
v_cvt_pk_bf16_f32 v47, v122, v123
ds_write_b128 v36, v[44:47]
v_fma_f32 v124, v124, v168, v169
v_fma_f32 v125, v125, v168, v169
v_fma_f32 v126, v126, v168, v169
v_fma_f32 v127, v127, v168, v169
v_fma_f32 v128, v128, v168, v169
v_fma_f32 v129, v129, v168, v169
v_fma_f32 v130, v130, v168, v169
v_fma_f32 v131, v131, v168, v169
v_cvt_pk_bf16_f32 v48, v124, v125
v_cvt_pk_bf16_f32 v49, v126, v127
v_cvt_pk_bf16_f32 v50, v128, v129
v_cvt_pk_bf16_f32 v51, v130, v131
ds_write_b128 v37, v[48:51]
v_fma_f32 v132, v132, v172, v173
v_fma_f32 v133, v133, v172, v173
v_fma_f32 v134, v134, v172, v173
v_fma_f32 v135, v135, v172, v173
v_fma_f32 v136, v136, v172, v173
v_fma_f32 v137, v137, v172, v173
v_fma_f32 v138, v138, v172, v173
v_fma_f32 v139, v139, v172, v173
v_cvt_pk_bf16_f32 v52, v132, v133
v_cvt_pk_bf16_f32 v53, v134, v135
v_cvt_pk_bf16_f32 v54, v136, v137
v_cvt_pk_bf16_f32 v55, v138, v139
ds_write_b128 v38, v[52:55]
v_fma_f32 v140, v140, v176, v177
v_fma_f32 v141, v141, v176, v177
v_fma_f32 v142, v142, v176, v177
v_fma_f32 v143, v143, v176, v177
v_fma_f32 v144, v144, v176, v177
v_fma_f32 v145, v145, v176, v177
v_fma_f32 v146, v146, v176, v177
v_fma_f32 v147, v147, v176, v177
v_cvt_pk_bf16_f32 v56, v140, v141
v_cvt_pk_bf16_f32 v57, v142, v143
v_cvt_pk_bf16_f32 v58, v144, v145
v_cvt_pk_bf16_f32 v59, v146, v147
ds_write_b128 v39, v[56:59]
v_fma_f32 v148, v148, v180, v181
v_fma_f32 v149, v149, v180, v181
v_fma_f32 v150, v150, v180, v181
v_fma_f32 v151, v151, v180, v181
v_fma_f32 v152, v152, v180, v181
v_fma_f32 v153, v153, v180, v181
v_fma_f32 v154, v154, v180, v181
v_fma_f32 v155, v155, v180, v181
v_cvt_pk_bf16_f32 v60, v148, v149
v_cvt_pk_bf16_f32 v61, v150, v151
v_cvt_pk_bf16_f32 v62, v152, v153
v_cvt_pk_bf16_f32 v63, v154, v155
ds_write_b128 v40, v[60:63]
v_fma_f32 v156, v156, v184, v185
v_fma_f32 v157, v157, v184, v185
v_fma_f32 v158, v158, v184, v185
v_fma_f32 v159, v159, v184, v185
v_fma_f32 v160, v160, v184, v185
v_fma_f32 v161, v161, v184, v185
v_fma_f32 v162, v162, v184, v185
v_fma_f32 v163, v163, v184, v185
v_cvt_pk_bf16_f32 v64, v156, v157
v_cvt_pk_bf16_f32 v65, v158, v159
v_cvt_pk_bf16_f32 v66, v160, v161
v_cvt_pk_bf16_f32 v67, v162, v163
ds_write_b128 v41, v[64:67]
s_add_u32 m0, s63, 0x2000
s_nop 0
buffer_load_dwordx4 v17, s[44:47], s68 offen offset:0 lds
buffer_load_dwordx4 v18, s[44:47], s68 offen offset:1024 lds
buffer_load_dwordx4 v19, s[44:47], s68 offen offset:2048 lds
buffer_load_dwordx4 v20, s[44:47], s68 offen offset:3072 lds
s_add_u32 s40, s28, 0x1fe00
s_addc_u32 s41, s29, 0
s_mov_b32 s42, 0x200
s_mov_b32 s43, 0x00020000
v_lshlrev_b32 v5, 4, v4
s_lshr_b32 s6, s66, 8
buffer_load_dwordx4 a[0:3], v5, s[40:43], s6 offen
s_lshr_b32 s6, s67, 8
buffer_load_dwordx4 a[4:7], v5, s[40:43], s6 offen
s_lshr_b32 s6, s68, 8
buffer_load_dwordx4 a[8:11], v5, s[40:43], s6 offen
s_lshr_b32 s6, s69, 8
buffer_load_dwordx4 a[12:15], v5, s[40:43], s6 offen
s_lshr_b32 s6, s70, 8
buffer_load_dwordx4 a[16:19], v5, s[40:43], s6 offen
s_lshr_b32 s6, s71, 8
buffer_load_dwordx4 a[20:23], v5, s[40:43], s6 offen
s_lshr_b32 s6, s72, 8
buffer_load_dwordx4 a[24:27], v5, s[40:43], s6 offen
s_lshr_b32 s6, s73, 8
buffer_load_dwordx4 a[28:31], v5, s[40:43], s6 offen
v_and_b32 v5, 31, v2
v_cmp_eq_u32 vcc, 31, v5
v_mov_b32 v6, 0xffff
v_mov_b32 v7, 0x3f800000
v_cndmask_b32 v6, -1, v6, vcc
v_cndmask_b32 v7, 0, v7, vcc
s_waitcnt vmcnt(16)
ds_read_b64_tr_b16 v[164:165], v25 offset:0
ds_read_b64_tr_b16 v[166:167], v25 offset:512
ds_read_b64_tr_b16 v[168:169], v26 offset:0
ds_read_b64_tr_b16 v[170:171], v26 offset:512
ds_read_b64_tr_b16 v[172:173], v27 offset:0
ds_read_b64_tr_b16 v[174:175], v27 offset:512
s_waitcnt lgkmcnt(6)
s_barrier
ds_read_b128 v[204:207], v31 offset:0
ds_read_b128 v[208:211], v31 offset:8192
ds_read_b128 v[212:215], v31 offset:16384
s_waitcnt lgkmcnt(2)
v_mfma_f32_16x16x32_bf16 v[68:71], v[164:167], v[204:207], 0
s_waitcnt lgkmcnt(1)
v_mfma_f32_16x16x32_bf16 v[72:75], v[164:167], v[208:211], 0
s_waitcnt lgkmcnt(0)
v_mfma_f32_16x16x32_bf16 v[76:79], v[164:167], v[212:215], 0
ds_read_b64_tr_b16 v[176:177], v28 offset:0
ds_read_b64_tr_b16 v[178:179], v28 offset:512
v_mfma_f32_16x16x32_bf16 v[80:83], v[168:171], v[204:207], 0
v_mfma_f32_16x16x32_bf16 v[84:87], v[168:171], v[208:211], 0
v_mfma_f32_16x16x32_bf16 v[88:91], v[168:171], v[212:215], 0
ds_read_b128 v[216:219], v32 offset:1024
s_waitcnt vmcnt(12)
ds_read_b64_tr_b16 v[180:181], v25 offset:4096
ds_read_b64_tr_b16 v[182:183], v25 offset:4608
v_mfma_f32_16x16x32_bf16 v[92:95], v[172:175], v[204:207], 0
ds_read_b128 v[220:223], v32 offset:9216
v_mfma_f32_16x16x32_bf16 v[96:99], v[172:175], v[208:211], 0
ds_read_b128 v[224:227], v32 offset:17408
v_mfma_f32_16x16x32_bf16 v[100:103], v[172:175], v[212:215], 0
ds_read_b64_tr_b16 v[184:185], v26 offset:4096
ds_read_b64_tr_b16 v[186:187], v26 offset:4608
s_waitcnt lgkmcnt(7)
v_mfma_f32_16x16x32_bf16 v[104:107], v[176:179], v[204:207], 0
s_add_u32 m0, s63, 0x0
s_nop 0
buffer_load_dwordx4 v17, s[44:47], s69 offen offset:0 lds
buffer_load_dwordx4 v18, s[44:47], s69 offen offset:1024 lds
buffer_load_dwordx4 v19, s[44:47], s69 offen offset:2048 lds
buffer_load_dwordx4 v20, s[44:47], s69 offen offset:3072 lds
v_mfma_f32_16x16x32_bf16 v[108:111], v[176:179], v[208:211], 0
v_mfma_f32_16x16x32_bf16 v[112:115], v[176:179], v[212:215], 0
ds_read_b64_tr_b16 v[188:189], v27 offset:4096
ds_read_b64_tr_b16 v[190:191], v27 offset:4608
s_waitcnt lgkmcnt(6)
v_mfma_f32_16x16x32_bf16 v[68:71], v[180:183], v[216:219], v[68:71]
s_waitcnt lgkmcnt(5)
v_mfma_f32_16x16x32_bf16 v[72:75], v[180:183], v[220:223], v[72:75]
s_waitcnt lgkmcnt(4)
v_mfma_f32_16x16x32_bf16 v[76:79], v[180:183], v[224:227], v[76:79]
ds_read_b64_tr_b16 v[192:193], v28 offset:4096
ds_read_b64_tr_b16 v[194:195], v28 offset:4608
s_waitcnt lgkmcnt(4)
v_mfma_f32_16x16x32_bf16 v[80:83], v[184:187], v[216:219], v[80:83]
v_mfma_f32_16x16x32_bf16 v[84:87], v[184:187], v[220:223], v[84:87]
v_mfma_f32_16x16x32_bf16 v[88:91], v[184:187], v[224:227], v[88:91]
ds_read_b128 v[228:231], v31 offset:2048
s_waitcnt vmcnt(12)
ds_read_b64_tr_b16 v[196:197], v25 offset:8192
ds_read_b64_tr_b16 v[198:199], v25 offset:8704
s_waitcnt lgkmcnt(5)
v_mfma_f32_16x16x32_bf16 v[92:95], v[188:191], v[216:219], v[92:95]
ds_read_b128 v[232:235], v31 offset:10240
v_mfma_f32_16x16x32_bf16 v[96:99], v[188:191], v[220:223], v[96:99]
ds_read_b128 v[236:239], v31 offset:18432
v_mfma_f32_16x16x32_bf16 v[100:103], v[188:191], v[224:227], v[100:103]
ds_read_b64_tr_b16 v[200:201], v26 offset:8192
ds_read_b64_tr_b16 v[202:203], v26 offset:8704
s_waitcnt lgkmcnt(7)
v_mfma_f32_16x16x32_bf16 v[104:107], v[192:195], v[216:219], v[104:107]
s_add_u32 m0, s63, 0x1000
s_nop 0
buffer_load_dwordx4 v17, s[44:47], s70 offen offset:0 lds
buffer_load_dwordx4 v18, s[44:47], s70 offen offset:1024 lds
buffer_load_dwordx4 v19, s[44:47], s70 offen offset:2048 lds
buffer_load_dwordx4 v20, s[44:47], s70 offen offset:3072 lds
v_mfma_f32_16x16x32_bf16 v[108:111], v[192:195], v[220:223], v[108:111]
v_mfma_f32_16x16x32_bf16 v[112:115], v[192:195], v[224:227], v[112:115]
ds_read_b64_tr_b16 v[164:165], v27 offset:8192
ds_read_b64_tr_b16 v[166:167], v27 offset:8704
s_waitcnt lgkmcnt(6)
v_mfma_f32_16x16x32_bf16 v[68:71], v[196:199], v[228:231], v[68:71]
s_waitcnt lgkmcnt(5)
v_mfma_f32_16x16x32_bf16 v[72:75], v[196:199], v[232:235], v[72:75]
s_waitcnt lgkmcnt(4)
v_mfma_f32_16x16x32_bf16 v[76:79], v[196:199], v[236:239], v[76:79]
ds_read_b64_tr_b16 v[168:169], v28 offset:8192
ds_read_b64_tr_b16 v[170:171], v28 offset:8704
s_waitcnt lgkmcnt(4)
v_mfma_f32_16x16x32_bf16 v[80:83], v[200:203], v[228:231], v[80:83]
v_mfma_f32_16x16x32_bf16 v[84:87], v[200:203], v[232:235], v[84:87]
v_mfma_f32_16x16x32_bf16 v[88:91], v[200:203], v[236:239], v[88:91]
ds_read_b128 v[204:207], v32 offset:3072
s_waitcnt vmcnt(4)
ds_read_b64_tr_b16 v[172:173], v25 offset:0
ds_read_b64_tr_b16 v[174:175], v25 offset:512
s_waitcnt lgkmcnt(5)
v_mfma_f32_16x16x32_bf16 v[92:95], v[164:167], v[228:231], v[92:95]
ds_read_b128 v[208:211], v32 offset:11264
v_mfma_f32_16x16x32_bf16 v[96:99], v[164:167], v[232:235], v[96:99]
ds_read_b128 v[212:215], v32 offset:19456
v_mfma_f32_16x16x32_bf16 v[100:103], v[164:167], v[236:239], v[100:103]
ds_read_b64_tr_b16 v[176:177], v26 offset:0
ds_read_b64_tr_b16 v[178:179], v26 offset:512
s_waitcnt lgkmcnt(7)
v_mfma_f32_16x16x32_bf16 v[104:107], v[168:171], v[228:231], v[104:107]
s_add_u32 m0, s63, 0x2000
s_nop 0
buffer_load_dwordx4 v17, s[44:47], s71 offen offset:0 lds
buffer_load_dwordx4 v18, s[44:47], s71 offen offset:1024 lds
buffer_load_dwordx4 v19, s[44:47], s71 offen offset:2048 lds
buffer_load_dwordx4 v20, s[44:47], s71 offen offset:3072 lds
v_mfma_f32_16x16x32_bf16 v[108:111], v[168:171], v[232:235], v[108:111]
v_mfma_f32_16x16x32_bf16 v[112:115], v[168:171], v[236:239], v[112:115]
ds_read_b64_tr_b16 v[180:181], v27 offset:0
ds_read_b64_tr_b16 v[182:183], v27 offset:512
s_waitcnt lgkmcnt(6)
v_mfma_f32_16x16x32_bf16 v[68:71], v[172:175], v[204:207], v[68:71]
s_waitcnt lgkmcnt(5)
v_mfma_f32_16x16x32_bf16 v[72:75], v[172:175], v[208:211], v[72:75]
s_waitcnt lgkmcnt(4)
v_mfma_f32_16x16x32_bf16 v[76:79], v[172:175], v[212:215], v[76:79]
ds_read_b64_tr_b16 v[184:185], v28 offset:0
ds_read_b64_tr_b16 v[186:187], v28 offset:512
s_waitcnt lgkmcnt(4)
v_mfma_f32_16x16x32_bf16 v[80:83], v[176:179], v[204:207], v[80:83]
v_mfma_f32_16x16x32_bf16 v[84:87], v[176:179], v[208:211], v[84:87]
v_mfma_f32_16x16x32_bf16 v[88:91], v[176:179], v[212:215], v[88:91]
ds_read_b128 v[216:219], v31 offset:4096
s_waitcnt vmcnt(4)
ds_read_b64_tr_b16 v[188:189], v25 offset:4096
ds_read_b64_tr_b16 v[190:191], v25 offset:4608
s_waitcnt lgkmcnt(5)
v_mfma_f32_16x16x32_bf16 v[92:95], v[180:183], v[204:207], v[92:95]
ds_read_b128 v[220:223], v31 offset:12288
v_mfma_f32_16x16x32_bf16 v[96:99], v[180:183], v[208:211], v[96:99]
ds_read_b128 v[224:227], v31 offset:20480
v_mfma_f32_16x16x32_bf16 v[100:103], v[180:183], v[212:215], v[100:103]
ds_read_b64_tr_b16 v[192:193], v26 offset:4096
ds_read_b64_tr_b16 v[194:195], v26 offset:4608
s_waitcnt lgkmcnt(7)
v_mfma_f32_16x16x32_bf16 v[104:107], v[184:187], v[204:207], v[104:107]
s_add_u32 m0, s63, 0x0
s_nop 0
buffer_load_dwordx4 v17, s[44:47], s72 offen offset:0 lds
buffer_load_dwordx4 v18, s[44:47], s72 offen offset:1024 lds
buffer_load_dwordx4 v19, s[44:47], s72 offen offset:2048 lds
buffer_load_dwordx4 v20, s[44:47], s72 offen offset:3072 lds
v_mfma_f32_16x16x32_bf16 v[108:111], v[184:187], v[208:211], v[108:111]
v_mfma_f32_16x16x32_bf16 v[112:115], v[184:187], v[212:215], v[112:115]
ds_read_b64_tr_b16 v[196:197], v27 offset:4096
ds_read_b64_tr_b16 v[198:199], v27 offset:4608
s_waitcnt lgkmcnt(6)
v_mfma_f32_16x16x32_bf16 v[68:71], v[188:191], v[216:219], v[68:71]
s_waitcnt lgkmcnt(5)
v_mfma_f32_16x16x32_bf16 v[72:75], v[188:191], v[220:223], v[72:75]
s_waitcnt lgkmcnt(4)
v_mfma_f32_16x16x32_bf16 v[76:79], v[188:191], v[224:227], v[76:79]
ds_read_b64_tr_b16 v[200:201], v28 offset:4096
ds_read_b64_tr_b16 v[202:203], v28 offset:4608
s_waitcnt lgkmcnt(4)
v_mfma_f32_16x16x32_bf16 v[80:83], v[192:195], v[216:219], v[80:83]
v_mfma_f32_16x16x32_bf16 v[84:87], v[192:195], v[220:223], v[84:87]
v_mfma_f32_16x16x32_bf16 v[88:91], v[192:195], v[224:227], v[88:91]
ds_read_b128 v[228:231], v32 offset:5120
s_waitcnt vmcnt(4)
ds_read_b64_tr_b16 v[164:165], v25 offset:8192
ds_read_b64_tr_b16 v[166:167], v25 offset:8704
s_waitcnt lgkmcnt(5)
v_mfma_f32_16x16x32_bf16 v[92:95], v[196:199], v[216:219], v[92:95]
ds_read_b128 v[232:235], v32 offset:13312
v_mfma_f32_16x16x32_bf16 v[96:99], v[196:199], v[220:223], v[96:99]
ds_read_b128 v[236:239], v32 offset:21504
v_mfma_f32_16x16x32_bf16 v[100:103], v[196:199], v[224:227], v[100:103]
ds_read_b64_tr_b16 v[168:169], v26 offset:8192
ds_read_b64_tr_b16 v[170:171], v26 offset:8704
s_waitcnt lgkmcnt(7)
v_mfma_f32_16x16x32_bf16 v[104:107], v[200:203], v[216:219], v[104:107]
s_add_u32 m0, s63, 0x1000
s_nop 0
buffer_load_dwordx4 v17, s[44:47], s73 offen offset:0 lds
buffer_load_dwordx4 v18, s[44:47], s73 offen offset:1024 lds
buffer_load_dwordx4 v19, s[44:47], s73 offen offset:2048 lds
buffer_load_dwordx4 v20, s[44:47], s73 offen offset:3072 lds
v_mfma_f32_16x16x32_bf16 v[108:111], v[200:203], v[220:223], v[108:111]
v_mfma_f32_16x16x32_bf16 v[112:115], v[200:203], v[224:227], v[112:115]
ds_read_b64_tr_b16 v[172:173], v27 offset:8192
ds_read_b64_tr_b16 v[174:175], v27 offset:8704
s_waitcnt lgkmcnt(6)
v_mfma_f32_16x16x32_bf16 v[68:71], v[164:167], v[228:231], v[68:71]
s_waitcnt lgkmcnt(5)
v_mfma_f32_16x16x32_bf16 v[72:75], v[164:167], v[232:235], v[72:75]
s_waitcnt lgkmcnt(4)
v_mfma_f32_16x16x32_bf16 v[76:79], v[164:167], v[236:239], v[76:79]
ds_read_b64_tr_b16 v[176:177], v28 offset:8192
ds_read_b64_tr_b16 v[178:179], v28 offset:8704
s_waitcnt lgkmcnt(4)
v_mfma_f32_16x16x32_bf16 v[80:83], v[168:171], v[228:231], v[80:83]
v_mfma_f32_16x16x32_bf16 v[84:87], v[168:171], v[232:235], v[84:87]
v_mfma_f32_16x16x32_bf16 v[88:91], v[168:171], v[236:239], v[88:91]
ds_read_b128 v[204:207], v31 offset:6144
s_waitcnt vmcnt(4)
ds_read_b64_tr_b16 v[180:181], v25 offset:0
ds_read_b64_tr_b16 v[182:183], v25 offset:512
s_waitcnt lgkmcnt(5)
v_mfma_f32_16x16x32_bf16 v[92:95], v[172:175], v[228:231], v[92:95]
ds_read_b128 v[208:211], v31 offset:14336
v_mfma_f32_16x16x32_bf16 v[96:99], v[172:175], v[232:235], v[96:99]
ds_read_b128 v[212:215], v31 offset:22528
v_mfma_f32_16x16x32_bf16 v[100:103], v[172:175], v[236:239], v[100:103]
ds_read_b64_tr_b16 v[184:185], v26 offset:0
ds_read_b64_tr_b16 v[186:187], v26 offset:512
s_waitcnt lgkmcnt(7)
v_mfma_f32_16x16x32_bf16 v[104:107], v[176:179], v[228:231], v[104:107]
s_add_u32 m0, s63, 0x2000
s_nop 0
buffer_load_dwordx4 v21, s[48:51], s74 offen offset:0 lds
buffer_load_dwordx4 v22, s[48:51], s74 offen offset:1024 lds
buffer_load_dwordx4 v23, s[48:51], s74 offen offset:2048 lds
buffer_load_dwordx4 v24, s[48:51], s74 offen offset:3072 lds
v_mfma_f32_16x16x32_bf16 v[108:111], v[176:179], v[232:235], v[108:111]
v_mfma_f32_16x16x32_bf16 v[112:115], v[176:179], v[236:239], v[112:115]
ds_read_b64_tr_b16 v[188:189], v27 offset:0
ds_read_b64_tr_b16 v[190:191], v27 offset:512
s_waitcnt lgkmcnt(6)
v_mfma_f32_16x16x32_bf16 v[68:71], v[180:183], v[204:207], v[68:71]
s_waitcnt lgkmcnt(5)
v_mfma_f32_16x16x32_bf16 v[72:75], v[180:183], v[208:211], v[72:75]
s_waitcnt lgkmcnt(4)
v_mfma_f32_16x16x32_bf16 v[76:79], v[180:183], v[212:215], v[76:79]
ds_read_b64_tr_b16 v[192:193], v28 offset:0
ds_read_b64_tr_b16 v[194:195], v28 offset:512
s_waitcnt lgkmcnt(4)
v_mfma_f32_16x16x32_bf16 v[80:83], v[184:187], v[204:207], v[80:83]
v_mfma_f32_16x16x32_bf16 v[84:87], v[184:187], v[208:211], v[84:87]
v_mfma_f32_16x16x32_bf16 v[88:91], v[184:187], v[212:215], v[88:91]
ds_read_b128 v[216:219], v32 offset:7168
s_waitcnt vmcnt(4)
ds_read_b64_tr_b16 v[196:197], v25 offset:4096
ds_read_b64_tr_b16 v[198:199], v25 offset:4608
s_waitcnt lgkmcnt(5)
v_mfma_f32_16x16x32_bf16 v[92:95], v[188:191], v[204:207], v[92:95]
ds_read_b128 v[220:223], v32 offset:15360
v_mfma_f32_16x16x32_bf16 v[96:99], v[188:191], v[208:211], v[96:99]
ds_read_b128 v[224:227], v32 offset:23552
v_mfma_f32_16x16x32_bf16 v[100:103], v[188:191], v[212:215], v[100:103]
ds_read_b64_tr_b16 v[200:201], v26 offset:4096
ds_read_b64_tr_b16 v[202:203], v26 offset:4608
s_waitcnt lgkmcnt(7)
v_mfma_f32_16x16x32_bf16 v[104:107], v[192:195], v[204:207], v[104:107]
s_add_u32 m0, s63, 0x0
s_nop 0
buffer_load_dwordx4 v21, s[48:51], s75 offen offset:0 lds
buffer_load_dwordx4 v22, s[48:51], s75 offen offset:1024 lds
buffer_load_dwordx4 v23, s[48:51], s75 offen offset:2048 lds
buffer_load_dwordx4 v24, s[48:51], s75 offen offset:3072 lds
v_mfma_f32_16x16x32_bf16 v[108:111], v[192:195], v[208:211], v[108:111]
v_mfma_f32_16x16x32_bf16 v[112:115], v[192:195], v[212:215], v[112:115]
ds_read_b64_tr_b16 v[164:165], v27 offset:4096
ds_read_b64_tr_b16 v[166:167], v27 offset:4608
s_waitcnt lgkmcnt(6)
v_mfma_f32_16x16x32_bf16 v[68:71], v[196:199], v[216:219], v[68:71]
s_waitcnt lgkmcnt(5)
v_mfma_f32_16x16x32_bf16 v[72:75], v[196:199], v[220:223], v[72:75]
s_waitcnt lgkmcnt(4)
v_mfma_f32_16x16x32_bf16 v[76:79], v[196:199], v[224:227], v[76:79]
ds_read_b64_tr_b16 v[168:169], v28 offset:4096
ds_read_b64_tr_b16 v[170:171], v28 offset:4608
s_waitcnt lgkmcnt(4)
v_mfma_f32_16x16x32_bf16 v[80:83], v[200:203], v[216:219], v[80:83]
v_cvt_pk_bf16_f32 v68, v68, v69
v_cvt_pk_bf16_f32 v69, v70, v71
ds_write_b64 v33, v[68:69] offset:0
v_mfma_f32_16x16x32_bf16 v[84:87], v[200:203], v[220:223], v[84:87]
v_cvt_pk_bf16_f32 v72, v72, v73
v_cvt_pk_bf16_f32 v73, v74, v75
ds_write_b64 v33, v[72:73] offset:8192
v_mfma_f32_16x16x32_bf16 v[88:91], v[200:203], v[224:227], v[88:91]
v_cvt_pk_bf16_f32 v76, v76, v77
v_cvt_pk_bf16_f32 v77, v78, v79
ds_write_b64 v33, v[76:77] offset:16384
s_waitcnt lgkmcnt(5)
v_mfma_f32_16x16x32_bf16 v[92:95], v[164:167], v[216:219], v[92:95]
v_cvt_pk_bf16_f32 v80, v80, v81
v_cvt_pk_bf16_f32 v81, v82, v83
ds_write_b64 v33, v[80:81] offset:512
v_mfma_f32_16x16x32_bf16 v[96:99], v[164:167], v[220:223], v[96:99]
v_cvt_pk_bf16_f32 v84, v84, v85
v_cvt_pk_bf16_f32 v85, v86, v87
ds_write_b64 v33, v[84:85] offset:8704
v_mfma_f32_16x16x32_bf16 v[100:103], v[164:167], v[224:227], v[100:103]
v_cvt_pk_bf16_f32 v88, v88, v89
v_cvt_pk_bf16_f32 v89, v90, v91
ds_write_b64 v33, v[88:89] offset:16896
s_waitcnt lgkmcnt(6)
v_mfma_f32_16x16x32_bf16 v[104:107], v[168:171], v[216:219], v[104:107]
v_cvt_pk_bf16_f32 v92, v92, v93
v_cvt_pk_bf16_f32 v93, v94, v95
ds_write_b64 v34, v[92:93] offset:0
s_add_u32 m0, s63, 0x1000
s_nop 0
buffer_load_dwordx4 v21, s[48:51], s76 offen offset:0 lds
buffer_load_dwordx4 v22, s[48:51], s76 offen offset:1024 lds
buffer_load_dwordx4 v23, s[48:51], s76 offen offset:2048 lds
buffer_load_dwordx4 v24, s[48:51], s76 offen offset:3072 lds
v_mfma_f32_16x16x32_bf16 v[108:111], v[168:171], v[220:223], v[108:111]
v_cvt_pk_bf16_f32 v96, v96, v97
v_cvt_pk_bf16_f32 v97, v98, v99
ds_write_b64 v34, v[96:97] offset:8192
v_mfma_f32_16x16x32_bf16 v[112:115], v[168:171], v[224:227], v[112:115]
v_cvt_pk_bf16_f32 v100, v100, v101
v_cvt_pk_bf16_f32 v101, v102, v103
ds_write_b64 v34, v[100:101] offset:16384
v_cvt_pk_bf16_f32 v104, v104, v105
v_cvt_pk_bf16_f32 v105, v106, v107
ds_write_b64 v34, v[104:105] offset:512
v_cvt_pk_bf16_f32 v108, v108, v109
v_cvt_pk_bf16_f32 v109, v110, v111
ds_write_b64 v34, v[108:109] offset:8704
v_cvt_pk_bf16_f32 v112, v112, v113
v_cvt_pk_bf16_f32 v113, v114, v115
ds_write_b64 v34, v[112:113] offset:16896
s_waitcnt vmcnt(8)
ds_read_b128 v[172:175], v29 offset:8192
ds_read_b128 v[176:179], v30 offset:8192
s_waitcnt lgkmcnt(2)
s_barrier
ds_read_b128 v[228:231], v35 offset:0
ds_read_b128 v[232:235], v35 offset:8192
ds_read_b128 v[236:239], v35 offset:16384
ds_read_b128 v[204:207], v35 offset:1024
s_waitcnt lgkmcnt(3)
v_mfma_f32_16x16x32_bf16 v[116:119], v[172:175], v[228:231], 0
ds_read_b128 v[208:211], v35 offset:9216
s_waitcnt lgkmcnt(3)
v_mfma_f32_16x16x32_bf16 v[132:135], v[172:175], v[232:235], 0
ds_read_b128 v[212:215], v35 offset:17408
s_waitcnt lgkmcnt(3)
v_mfma_f32_16x16x32_bf16 v[148:151], v[172:175], v[236:239], 0
v_mfma_f32_16x16x32_bf16 v[240:243], a[0:3], v[228:231], 0
v_mfma_f32_16x16x32_bf16 v[244:247], a[0:3], v[232:235], 0
v_mfma_f32_16x16x32_bf16 v[248:251], a[0:3], v[236:239], 0
ds_read_b128 v[180:183], v29 offset:10240
s_waitcnt lgkmcnt(3)
v_mfma_f32_16x16x32_bf16 v[116:119], v[176:179], v[204:207], v[116:119]
s_waitcnt lgkmcnt(2)
v_mfma_f32_16x16x32_bf16 v[132:135], v[176:179], v[208:211], v[132:135]
s_waitcnt lgkmcnt(1)
v_mfma_f32_16x16x32_bf16 v[148:151], v[176:179], v[212:215], v[148:151]
ds_read_b128 v[184:187], v30 offset:10240
v_mfma_f32_16x16x32_bf16 v[240:243], a[4:7], v[204:207], v[240:243]
v_mfma_f32_16x16x32_bf16 v[244:247], a[4:7], v[208:211], v[244:247]
v_mfma_f32_16x16x32_bf16 v[248:251], a[4:7], v[212:215], v[248:251]
s_waitcnt vmcnt(4)
ds_read_b128 v[188:191], v29 offset:0
s_waitcnt lgkmcnt(2)
v_mfma_f32_16x16x32_bf16 v[120:123], v[180:183], v[228:231], 0
v_mfma_f32_16x16x32_bf16 v[136:139], v[180:183], v[232:235], 0
v_mfma_f32_16x16x32_bf16 v[152:155], v[180:183], v[236:239], 0
ds_read_b128 v[192:195], v30 offset:0
s_waitcnt lgkmcnt(2)
v_mfma_f32_16x16x32_bf16 v[120:123], v[184:187], v[204:207], v[120:123]
s_add_u32 m0, s63, 0x2000
s_nop 0
buffer_load_dwordx4 v21, s[48:51], s77 offen offset:0 lds
buffer_load_dwordx4 v22, s[48:51], s77 offen offset:1024 lds
buffer_load_dwordx4 v23, s[48:51], s77 offen offset:2048 lds
buffer_load_dwordx4 v24, s[48:51], s77 offen offset:3072 lds
v_mfma_f32_16x16x32_bf16 v[136:139], v[184:187], v[208:211], v[136:139]
v_mfma_f32_16x16x32_bf16 v[152:155], v[184:187], v[212:215], v[152:155]
ds_read_b128 v[196:199], v29 offset:2048
s_waitcnt lgkmcnt(2)
v_mfma_f32_16x16x32_bf16 v[124:127], v[188:191], v[228:231], 0
v_mfma_f32_16x16x32_bf16 v[140:143], v[188:191], v[232:235], 0
v_mfma_f32_16x16x32_bf16 v[156:159], v[188:191], v[236:239], 0
ds_read_b128 v[200:203], v30 offset:2048
s_waitcnt lgkmcnt(2)
v_mfma_f32_16x16x32_bf16 v[124:127], v[192:195], v[204:207], v[124:127]
v_mfma_f32_16x16x32_bf16 v[140:143], v[192:195], v[208:211], v[140:143]
v_mfma_f32_16x16x32_bf16 v[156:159], v[192:195], v[212:215], v[156:159]
ds_read_b128 v[216:219], v35 offset:2048
s_waitcnt vmcnt(4)
ds_read_b128 v[164:167], v29 offset:4096
s_waitcnt lgkmcnt(3)
v_mfma_f32_16x16x32_bf16 v[128:131], v[196:199], v[228:231], 0
ds_read_b128 v[220:223], v35 offset:10240
v_mfma_f32_16x16x32_bf16 v[144:147], v[196:199], v[232:235], 0
ds_read_b128 v[224:227], v35 offset:18432
v_mfma_f32_16x16x32_bf16 v[160:163], v[196:199], v[236:239], 0
s_waitcnt lgkmcnt(4)
v_mfma_f32_16x16x32_bf16 v[128:131], v[200:203], v[204:207], v[128:131]
s_add_u32 m0, s63, 0x0
s_nop 0
buffer_load_dwordx4 v21, s[48:51], s78 offen offset:0 lds
buffer_load_dwordx4 v22, s[48:51], s78 offen offset:1024 lds
buffer_load_dwordx4 v23, s[48:51], s78 offen offset:2048 lds
buffer_load_dwordx4 v24, s[48:51], s78 offen offset:3072 lds
v_mfma_f32_16x16x32_bf16 v[144:147], v[200:203], v[208:211], v[144:147]
v_mfma_f32_16x16x32_bf16 v[160:163], v[200:203], v[212:215], v[160:163]
ds_read_b128 v[228:231], v35 offset:3072
ds_read_b128 v[168:171], v30 offset:4096
s_waitcnt lgkmcnt(4)
v_mfma_f32_16x16x32_bf16 v[116:119], v[164:167], v[216:219], v[116:119]
ds_read_b128 v[232:235], v35 offset:11264
s_waitcnt lgkmcnt(4)
v_mfma_f32_16x16x32_bf16 v[132:135], v[164:167], v[220:223], v[132:135]
ds_read_b128 v[236:239], v35 offset:19456
s_waitcnt lgkmcnt(4)
v_mfma_f32_16x16x32_bf16 v[148:151], v[164:167], v[224:227], v[148:151]
v_mfma_f32_16x16x32_bf16 v[240:243], a[8:11], v[216:219], v[240:243]
v_mfma_f32_16x16x32_bf16 v[244:247], a[8:11], v[220:223], v[244:247]
v_mfma_f32_16x16x32_bf16 v[248:251], a[8:11], v[224:227], v[248:251]
ds_read_b128 v[172:175], v29 offset:6144
s_waitcnt lgkmcnt(3)
v_mfma_f32_16x16x32_bf16 v[116:119], v[168:171], v[228:231], v[116:119]
s_waitcnt lgkmcnt(2)
v_mfma_f32_16x16x32_bf16 v[132:135], v[168:171], v[232:235], v[132:135]
s_waitcnt lgkmcnt(1)
v_mfma_f32_16x16x32_bf16 v[148:151], v[168:171], v[236:239], v[148:151]
ds_read_b128 v[176:179], v30 offset:6144
v_mfma_f32_16x16x32_bf16 v[240:243], a[12:15], v[228:231], v[240:243]
v_mfma_f32_16x16x32_bf16 v[244:247], a[12:15], v[232:235], v[244:247]
v_mfma_f32_16x16x32_bf16 v[248:251], a[12:15], v[236:239], v[248:251]
s_waitcnt vmcnt(4)
ds_read_b128 v[180:183], v29 offset:8192
s_waitcnt lgkmcnt(2)
v_mfma_f32_16x16x32_bf16 v[120:123], v[172:175], v[216:219], v[120:123]
v_mfma_f32_16x16x32_bf16 v[136:139], v[172:175], v[220:223], v[136:139]
v_mfma_f32_16x16x32_bf16 v[152:155], v[172:175], v[224:227], v[152:155]
ds_read_b128 v[184:187], v30 offset:8192
s_waitcnt lgkmcnt(2)
v_mfma_f32_16x16x32_bf16 v[120:123], v[176:179], v[228:231], v[120:123]
s_add_u32 m0, s63, 0x1000
s_nop 0
buffer_load_dwordx4 v21, s[48:51], s79 offen offset:0 lds
buffer_load_dwordx4 v22, s[48:51], s79 offen offset:1024 lds
buffer_load_dwordx4 v23, s[48:51], s79 offen offset:2048 lds
buffer_load_dwordx4 v24, s[48:51], s79 offen offset:3072 lds
v_mfma_f32_16x16x32_bf16 v[136:139], v[176:179], v[232:235], v[136:139]
v_mfma_f32_16x16x32_bf16 v[152:155], v[176:179], v[236:239], v[152:155]
ds_read_b128 v[188:191], v29 offset:10240
s_waitcnt lgkmcnt(2)
v_mfma_f32_16x16x32_bf16 v[124:127], v[180:183], v[216:219], v[124:127]
v_mfma_f32_16x16x32_bf16 v[140:143], v[180:183], v[220:223], v[140:143]
v_mfma_f32_16x16x32_bf16 v[156:159], v[180:183], v[224:227], v[156:159]
ds_read_b128 v[192:195], v30 offset:10240
s_waitcnt lgkmcnt(2)
v_mfma_f32_16x16x32_bf16 v[124:127], v[184:187], v[228:231], v[124:127]
v_mfma_f32_16x16x32_bf16 v[140:143], v[184:187], v[232:235], v[140:143]
v_mfma_f32_16x16x32_bf16 v[156:159], v[184:187], v[236:239], v[156:159]
ds_read_b128 v[204:207], v35 offset:4096
s_waitcnt vmcnt(4)
ds_read_b128 v[196:199], v29 offset:0
s_waitcnt lgkmcnt(3)
v_mfma_f32_16x16x32_bf16 v[128:131], v[188:191], v[216:219], v[128:131]
ds_read_b128 v[208:211], v35 offset:12288
v_mfma_f32_16x16x32_bf16 v[144:147], v[188:191], v[220:223], v[144:147]
ds_read_b128 v[212:215], v35 offset:20480
v_mfma_f32_16x16x32_bf16 v[160:163], v[188:191], v[224:227], v[160:163]
s_waitcnt lgkmcnt(4)
v_mfma_f32_16x16x32_bf16 v[128:131], v[192:195], v[228:231], v[128:131]
s_add_u32 m0, s63, 0x2000
s_nop 0
buffer_load_dwordx4 v21, s[48:51], s80 offen offset:0 lds
buffer_load_dwordx4 v22, s[48:51], s80 offen offset:1024 lds
buffer_load_dwordx4 v23, s[48:51], s80 offen offset:2048 lds
buffer_load_dwordx4 v24, s[48:51], s80 offen offset:3072 lds
v_mfma_f32_16x16x32_bf16 v[144:147], v[192:195], v[232:235], v[144:147]
v_mfma_f32_16x16x32_bf16 v[160:163], v[192:195], v[236:239], v[160:163]
ds_read_b128 v[216:219], v35 offset:5120
ds_read_b128 v[200:203], v30 offset:0
s_waitcnt lgkmcnt(4)
v_mfma_f32_16x16x32_bf16 v[116:119], v[196:199], v[204:207], v[116:119]
ds_read_b128 v[220:223], v35 offset:13312
s_waitcnt lgkmcnt(4)
v_mfma_f32_16x16x32_bf16 v[132:135], v[196:199], v[208:211], v[132:135]
ds_read_b128 v[224:227], v35 offset:21504
s_waitcnt lgkmcnt(4)
v_mfma_f32_16x16x32_bf16 v[148:151], v[196:199], v[212:215], v[148:151]
v_mfma_f32_16x16x32_bf16 v[240:243], a[16:19], v[204:207], v[240:243]
v_mfma_f32_16x16x32_bf16 v[244:247], a[16:19], v[208:211], v[244:247]
v_mfma_f32_16x16x32_bf16 v[248:251], a[16:19], v[212:215], v[248:251]
ds_read_b128 v[164:167], v29 offset:2048
s_waitcnt lgkmcnt(3)
v_mfma_f32_16x16x32_bf16 v[116:119], v[200:203], v[216:219], v[116:119]
s_waitcnt lgkmcnt(2)
v_mfma_f32_16x16x32_bf16 v[132:135], v[200:203], v[220:223], v[132:135]
s_waitcnt lgkmcnt(1)
v_mfma_f32_16x16x32_bf16 v[148:151], v[200:203], v[224:227], v[148:151]
ds_read_b128 v[168:171], v30 offset:2048
v_mfma_f32_16x16x32_bf16 v[240:243], a[20:23], v[216:219], v[240:243]
v_mfma_f32_16x16x32_bf16 v[244:247], a[20:23], v[220:223], v[244:247]
v_mfma_f32_16x16x32_bf16 v[248:251], a[20:23], v[224:227], v[248:251]
s_waitcnt vmcnt(4)
ds_read_b128 v[172:175], v29 offset:4096
s_waitcnt lgkmcnt(2)
v_mfma_f32_16x16x32_bf16 v[120:123], v[164:167], v[204:207], v[120:123]
v_mfma_f32_16x16x32_bf16 v[136:139], v[164:167], v[208:211], v[136:139]
v_mfma_f32_16x16x32_bf16 v[152:155], v[164:167], v[212:215], v[152:155]
ds_read_b128 v[176:179], v30 offset:4096
s_waitcnt lgkmcnt(2)
v_mfma_f32_16x16x32_bf16 v[120:123], v[168:171], v[216:219], v[120:123]
s_add_u32 m0, s63, 0x0
s_nop 0
buffer_load_dwordx4 v21, s[48:51], s81 offen offset:0 lds
buffer_load_dwordx4 v22, s[48:51], s81 offen offset:1024 lds
buffer_load_dwordx4 v23, s[48:51], s81 offen offset:2048 lds
buffer_load_dwordx4 v24, s[48:51], s81 offen offset:3072 lds
v_mfma_f32_16x16x32_bf16 v[136:139], v[168:171], v[220:223], v[136:139]
v_and_or_b32 v47, v47, v6, v7
v_and_or_b32 v51, v51, v6, v7
v_mfma_f32_16x16x32_bf16 v[152:155], v[168:171], v[224:227], v[152:155]
ds_read_b128 v[180:183], v29 offset:6144
v_and_or_b32 v55, v55, v6, v7
s_waitcnt lgkmcnt(2)
v_mfma_f32_16x16x32_bf16 v[124:127], v[172:175], v[204:207], v[124:127]
v_and_or_b32 v59, v59, v6, v7
v_and_or_b32 v63, v63, v6, v7
v_mfma_f32_16x16x32_bf16 v[140:143], v[172:175], v[208:211], v[140:143]
v_and_or_b32 v67, v67, v6, v7
buffer_store_dwordx4 v[44:47], v16, s[56:59], s64 offen offset:0 sc1
v_mfma_f32_16x16x32_bf16 v[156:159], v[172:175], v[212:215], v[156:159]
ds_read_b128 v[184:187], v30 offset:6144
buffer_store_dwordx4 v[48:51], v16, s[56:59], s64 offen offset:1024 sc1
s_waitcnt lgkmcnt(2)
v_mfma_f32_16x16x32_bf16 v[124:127], v[176:179], v[216:219], v[124:127]
buffer_store_dwordx4 v[52:55], v16, s[56:59], s64 offen offset:2048 sc1
buffer_store_dwordx4 v[56:59], v16, s[56:59], s64 offen offset:3072 sc1
v_mfma_f32_16x16x32_bf16 v[140:143], v[176:179], v[220:223], v[140:143]
buffer_store_dwordx4 v[60:63], v16, s[56:59], s65 offen offset:0 sc1
buffer_store_dwordx4 v[64:67], v16, s[56:59], s65 offen offset:1024 sc1
v_mfma_f32_16x16x32_bf16 v[156:159], v[176:179], v[224:227], v[156:159]
ds_read_b128 v[228:231], v35 offset:6144
s_waitcnt vmcnt(10)
ds_read_b128 v[188:191], v29 offset:8192
s_waitcnt lgkmcnt(3)
v_mfma_f32_16x16x32_bf16 v[128:131], v[180:183], v[204:207], v[128:131]
ds_read_b128 v[232:235], v35 offset:14336
v_mfma_f32_16x16x32_bf16 v[144:147], v[180:183], v[208:211], v[144:147]
ds_read_b128 v[236:239], v35 offset:22528
v_mfma_f32_16x16x32_bf16 v[160:163], v[180:183], v[212:215], v[160:163]
s_waitcnt lgkmcnt(4)
v_mfma_f32_16x16x32_bf16 v[128:131], v[184:187], v[216:219], v[128:131]
v_mfma_f32_16x16x32_bf16 v[144:147], v[184:187], v[220:223], v[144:147]
v_mfma_f32_16x16x32_bf16 v[160:163], v[184:187], v[224:227], v[160:163]
ds_read_b128 v[204:207], v35 offset:7168
ds_read_b128 v[192:195], v30 offset:8192
s_waitcnt lgkmcnt(4)
v_mfma_f32_16x16x32_bf16 v[116:119], v[188:191], v[228:231], v[116:119]
ds_read_b128 v[208:211], v35 offset:15360
s_waitcnt lgkmcnt(4)
v_mfma_f32_16x16x32_bf16 v[132:135], v[188:191], v[232:235], v[132:135]
ds_read_b128 v[212:215], v35 offset:23552
s_waitcnt lgkmcnt(4)
v_mfma_f32_16x16x32_bf16 v[148:151], v[188:191], v[236:239], v[148:151]
v_mfma_f32_16x16x32_bf16 v[240:243], a[24:27], v[228:231], v[240:243]
v_mfma_f32_16x16x32_bf16 v[244:247], a[24:27], v[232:235], v[244:247]
v_mfma_f32_16x16x32_bf16 v[248:251], a[24:27], v[236:239], v[248:251]
ds_read_b128 v[196:199], v29 offset:10240
s_waitcnt lgkmcnt(3)
v_mfma_f32_16x16x32_bf16 v[116:119], v[192:195], v[204:207], v[116:119]
s_waitcnt lgkmcnt(2)
v_mfma_f32_16x16x32_bf16 v[132:135], v[192:195], v[208:211], v[132:135]
s_waitcnt lgkmcnt(1)
v_mfma_f32_16x16x32_bf16 v[148:151], v[192:195], v[212:215], v[148:151]
ds_read_b128 v[200:203], v30 offset:10240
v_mfma_f32_16x16x32_bf16 v[240:243], a[28:31], v[204:207], v[240:243]
v_mfma_f32_16x16x32_bf16 v[244:247], a[28:31], v[208:211], v[244:247]
v_mfma_f32_16x16x32_bf16 v[248:251], a[28:31], v[212:215], v[248:251]
s_waitcnt vmcnt(6)
ds_read_b128 v[164:167], v29 offset:0
s_waitcnt lgkmcnt(2)
v_mfma_f32_16x16x32_bf16 v[120:123], v[196:199], v[228:231], v[120:123]
v_mfma_f32_16x16x32_bf16 v[136:139], v[196:199], v[232:235], v[136:139]
v_mfma_f32_16x16x32_bf16 v[152:155], v[196:199], v[236:239], v[152:155]
ds_read_b128 v[168:171], v30 offset:0
s_waitcnt lgkmcnt(2)
v_mfma_f32_16x16x32_bf16 v[120:123], v[200:203], v[204:207], v[120:123]
v_mul_f32 v240, s86, v240
v_mul_f32 v244, s86, v244
v_mul_f32 v248, s86, v248
v_mfma_f32_16x16x32_bf16 v[136:139], v[200:203], v[208:211], v[136:139]
v_mfma_f32_16x16x32_bf16 v[152:155], v[200:203], v[212:215], v[152:155]
ds_read_b128 v[172:175], v29 offset:2048
s_waitcnt lgkmcnt(2)
v_mfma_f32_16x16x32_bf16 v[124:127], v[164:167], v[228:231], v[124:127]
v_fma_f32 v116, s86, v116, -v240
v_fma_f32 v117, s86, v117, -v240
v_fma_f32 v118, s86, v118, -v240
v_fma_f32 v119, s86, v119, -v240
v_fma_f32 v120, s86, v120, -v240
v_fma_f32 v121, s86, v121, -v240
v_fma_f32 v122, s86, v122, -v240
v_fma_f32 v123, s86, v123, -v240
v_cvt_pk_bf16_f32 v116, v116, v117
v_cvt_pk_bf16_f32 v117, v118, v119
v_cvt_pk_bf16_f32 v118, v120, v121
v_cvt_pk_bf16_f32 v119, v122, v123
buffer_store_dwordx4 v[116:119], v16, s[52:55], s82 offen offset:0 sc1
v_mfma_f32_16x16x32_bf16 v[140:143], v[164:167], v[232:235], v[140:143]
v_fma_f32 v132, s86, v132, -v244
v_fma_f32 v133, s86, v133, -v244
v_fma_f32 v134, s86, v134, -v244
v_fma_f32 v135, s86, v135, -v244
v_fma_f32 v136, s86, v136, -v244
v_fma_f32 v137, s86, v137, -v244
v_fma_f32 v138, s86, v138, -v244
v_fma_f32 v139, s86, v139, -v244
v_cvt_pk_bf16_f32 v132, v132, v133
v_cvt_pk_bf16_f32 v133, v134, v135
v_cvt_pk_bf16_f32 v134, v136, v137
v_cvt_pk_bf16_f32 v135, v138, v139
buffer_store_dwordx4 v[132:135], v16, s[52:55], s83 offen offset:0 sc1
v_mfma_f32_16x16x32_bf16 v[156:159], v[164:167], v[236:239], v[156:159]
ds_read_b128 v[176:179], v30 offset:2048
v_fma_f32 v148, s86, v148, -v248
v_fma_f32 v149, s86, v149, -v248
v_fma_f32 v150, s86, v150, -v248
v_fma_f32 v151, s86, v151, -v248
v_fma_f32 v152, s86, v152, -v248
v_fma_f32 v153, s86, v153, -v248
v_fma_f32 v154, s86, v154, -v248
v_fma_f32 v155, s86, v155, -v248
v_cvt_pk_bf16_f32 v148, v148, v149
v_cvt_pk_bf16_f32 v149, v150, v151
v_cvt_pk_bf16_f32 v150, v152, v153
v_cvt_pk_bf16_f32 v151, v154, v155
buffer_store_dwordx4 v[148:151], v16, s[52:55], s84 offen offset:0 sc1
s_waitcnt lgkmcnt(2)
v_mfma_f32_16x16x32_bf16 v[124:127], v[168:171], v[204:207], v[124:127]
v_mfma_f32_16x16x32_bf16 v[140:143], v[168:171], v[208:211], v[140:143]
v_mfma_f32_16x16x32_bf16 v[156:159], v[168:171], v[212:215], v[156:159]
s_waitcnt lgkmcnt(1)
v_mfma_f32_16x16x32_bf16 v[128:131], v[172:175], v[228:231], v[128:131]
v_mfma_f32_16x16x32_bf16 v[144:147], v[172:175], v[232:235], v[144:147]
v_mfma_f32_16x16x32_bf16 v[160:163], v[172:175], v[236:239], v[160:163]
s_waitcnt lgkmcnt(0)
v_mfma_f32_16x16x32_bf16 v[128:131], v[176:179], v[204:207], v[128:131]
v_mfma_f32_16x16x32_bf16 v[144:147], v[176:179], v[208:211], v[144:147]
v_mfma_f32_16x16x32_bf16 v[160:163], v[176:179], v[212:215], v[160:163]
v_fma_f32 v124, s86, v124, -v240
v_fma_f32 v125, s86, v125, -v240
v_fma_f32 v126, s86, v126, -v240
v_fma_f32 v127, s86, v127, -v240
s_nop 1
v_fma_f32 v128, s86, v128, -v240
v_fma_f32 v129, s86, v129, -v240
v_fma_f32 v130, s86, v130, -v240
v_fma_f32 v131, s86, v131, -v240
v_cvt_pk_bf16_f32 v124, v124, v125
v_cvt_pk_bf16_f32 v125, v126, v127
v_cvt_pk_bf16_f32 v126, v128, v129
v_cvt_pk_bf16_f32 v127, v130, v131
buffer_store_dwordx4 v[124:127], v16, s[52:55], s82 offen offset:1024 sc1
v_fma_f32 v140, s86, v140, -v244
v_fma_f32 v141, s86, v141, -v244
v_fma_f32 v142, s86, v142, -v244
v_fma_f32 v143, s86, v143, -v244
v_fma_f32 v144, s86, v144, -v244
v_fma_f32 v145, s86, v145, -v244
v_fma_f32 v146, s86, v146, -v244
v_fma_f32 v147, s86, v147, -v244
v_cvt_pk_bf16_f32 v140, v140, v141
v_cvt_pk_bf16_f32 v141, v142, v143
v_cvt_pk_bf16_f32 v142, v144, v145
v_cvt_pk_bf16_f32 v143, v146, v147
buffer_store_dwordx4 v[140:143], v16, s[52:55], s83 offen offset:1024 sc1
v_fma_f32 v156, s86, v156, -v248
v_fma_f32 v157, s86, v157, -v248
v_fma_f32 v158, s86, v158, -v248
v_fma_f32 v159, s86, v159, -v248
v_fma_f32 v160, s86, v160, -v248
v_fma_f32 v161, s86, v161, -v248
v_fma_f32 v162, s86, v162, -v248
v_fma_f32 v163, s86, v163, -v248
v_cvt_pk_bf16_f32 v156, v156, v157
v_cvt_pk_bf16_f32 v157, v158, v159
v_cvt_pk_bf16_f32 v158, v160, v161
v_cvt_pk_bf16_f32 v159, v162, v163
buffer_store_dwordx4 v[156:159], v16, s[52:55], s84 offen offset:1024 sc1
L1_fin:
s_add_u32 s91, s91, 1344
s_waitcnt lgkmcnt(0)
s_add_u32 s98, s98, 0x7f4a7c15
s_addc_u32 s99, s99, 0x9e3779b9
LM_pub:
s_add_u32 s40, s38, 0x7c00000
s_addc_u32 s41, s39, 0
s_mov_b32 s42, 0x40000
s_mov_b32 s43, 0x00020000
s_lshl_b32 s6, s91, 7
s_cmp_eq_u32 s60, 0
s_cselect_b32 s6, s6, 0x70000000
v_lshlrev_b32 v12, 4, v2
s_waitcnt vmcnt(0) lgkmcnt(0)
s_barrier
v_mov_b32 v8, s98
v_mov_b32 v9, s99
v_mov_b32 v10, s98
v_mov_b32 v11, s99
s_mov_b64 exec, 0xff
buffer_store_dwordx4 v[8:11], v12, s[40:43], s6 offen sc1
s_mov_b64 exec, -1
s_cmp_eq_u32 s61, 0
s_cbranch_scc1 L2_entry
s_mov_b32 s61, 0
s_sub_u32 s4, s91, 1578
s_min_u32 s6, s4, 14
s_cmp_lt_u32 s4, 6
s_cselect_b32 s6, 0, s6
s_sub_u32 s4, s4, s6
s_add_u32 s91, s4, 1600
v_lshlrev_b32 v16, 4, v2
s_mul_i32 s63, s60, 12288
s_and_b32 s6, s4, 3
s_lshl_b32 s6, s6, 6
s_mul_i32 s7, s60, 16
s_add_u32 s6, s6, s7
v_lshrrev_b32 v5, 5, v2
v_and_b32 v6, 31, v2
v_lshlrev_b32 v6, 4, v6
s_cmp_ge_u32 s4, 4
s_cselect_b64 vcc, -1, 0
v_add3_u32 v7, v5, s6, 0
v_and_b32 v8, 0x80, v7
v_bfe_u32 v9, v7, 2, 1
v_lshl_or_b32 v8, v9, 6, v8
v_bfe_u32 v9, v7, 4, 1
v_lshl_or_b32 v8, v9, 5, v8
v_and_b32 v9, 3, v7
v_lshl_or_b32 v8, v9, 3, v8
v_bfe_u32 v9, v7, 5, 2
v_lshl_or_b32 v8, v9, 1, v8
v_bfe_u32 v9, v7, 3, 1
v_or_b32 v8, v9, v8
v_cndmask_b32 v8, v8, v7, vcc
v_lshl_add_u32 v44, v8, 9, v6
v_add3_u32 v7, v5, s6, 2
v_and_b32 v8, 0x80, v7
v_bfe_u32 v9, v7, 2, 1
v_lshl_or_b32 v8, v9, 6, v8
v_bfe_u32 v9, v7, 4, 1
v_lshl_or_b32 v8, v9, 5, v8
v_and_b32 v9, 3, v7
v_lshl_or_b32 v8, v9, 3, v8
v_bfe_u32 v9, v7, 5, 2
v_lshl_or_b32 v8, v9, 1, v8
v_bfe_u32 v9, v7, 3, 1
v_or_b32 v8, v9, v8
v_cndmask_b32 v8, v8, v7, vcc
v_lshl_add_u32 v48, v8, 9, v6
v_add3_u32 v7, v5, s6, 4
v_and_b32 v8, 0x80, v7
v_bfe_u32 v9, v7, 2, 1
v_lshl_or_b32 v8, v9, 6, v8
v_bfe_u32 v9, v7, 4, 1
v_lshl_or_b32 v8, v9, 5, v8
v_and_b32 v9, 3, v7
v_lshl_or_b32 v8, v9, 3, v8
v_bfe_u32 v9, v7, 5, 2
v_lshl_or_b32 v8, v9, 1, v8
v_bfe_u32 v9, v7, 3, 1
v_or_b32 v8, v9, v8
v_cndmask_b32 v8, v8, v7, vcc
v_lshl_add_u32 v52, v8, 9, v6
v_add3_u32 v7, v5, s6, 6
v_and_b32 v8, 0x80, v7
v_bfe_u32 v9, v7, 2, 1
v_lshl_or_b32 v8, v9, 6, v8
v_bfe_u32 v9, v7, 4, 1
v_lshl_or_b32 v8, v9, 5, v8
v_and_b32 v9, 3, v7
v_lshl_or_b32 v8, v9, 3, v8
v_bfe_u32 v9, v7, 5, 2
v_lshl_or_b32 v8, v9, 1, v8
v_bfe_u32 v9, v7, 3, 1
v_or_b32 v8, v9, v8
v_cndmask_b32 v8, v8, v7, vcc
v_lshl_add_u32 v56, v8, 9, v6
v_add3_u32 v7, v5, s6, 8
v_and_b32 v8, 0x80, v7
v_bfe_u32 v9, v7, 2, 1
v_lshl_or_b32 v8, v9, 6, v8
v_bfe_u32 v9, v7, 4, 1
v_lshl_or_b32 v8, v9, 5, v8
v_and_b32 v9, 3, v7
v_lshl_or_b32 v8, v9, 3, v8
v_bfe_u32 v9, v7, 5, 2
v_lshl_or_b32 v8, v9, 1, v8
v_bfe_u32 v9, v7, 3, 1
v_or_b32 v8, v9, v8
v_cndmask_b32 v8, v8, v7, vcc
v_lshl_add_u32 v60, v8, 9, v6
v_add3_u32 v7, v5, s6, 10
v_and_b32 v8, 0x80, v7
v_bfe_u32 v9, v7, 2, 1
v_lshl_or_b32 v8, v9, 6, v8
v_bfe_u32 v9, v7, 4, 1
v_lshl_or_b32 v8, v9, 5, v8
v_and_b32 v9, 3, v7
v_lshl_or_b32 v8, v9, 3, v8
v_bfe_u32 v9, v7, 5, 2
v_lshl_or_b32 v8, v9, 1, v8
v_bfe_u32 v9, v7, 3, 1
v_or_b32 v8, v9, v8
v_cndmask_b32 v8, v8, v7, vcc
v_lshl_add_u32 v64, v8, 9, v6
v_add3_u32 v7, v5, s6, 12
v_and_b32 v8, 0x80, v7
v_bfe_u32 v9, v7, 2, 1
v_lshl_or_b32 v8, v9, 6, v8
v_bfe_u32 v9, v7, 4, 1
v_lshl_or_b32 v8, v9, 5, v8
v_and_b32 v9, 3, v7
v_lshl_or_b32 v8, v9, 3, v8
v_bfe_u32 v9, v7, 5, 2
v_lshl_or_b32 v8, v9, 1, v8
v_bfe_u32 v9, v7, 3, 1
v_or_b32 v8, v9, v8
v_cndmask_b32 v8, v8, v7, vcc
v_lshl_add_u32 v68, v8, 9, v6
v_add3_u32 v7, v5, s6, 14
v_and_b32 v8, 0x80, v7
v_bfe_u32 v9, v7, 2, 1
v_lshl_or_b32 v8, v9, 6, v8
v_bfe_u32 v9, v7, 4, 1
v_lshl_or_b32 v8, v9, 5, v8
v_and_b32 v9, 3, v7
v_lshl_or_b32 v8, v9, 3, v8
v_bfe_u32 v9, v7, 5, 2
v_lshl_or_b32 v8, v9, 1, v8
v_bfe_u32 v9, v7, 3, 1
v_or_b32 v8, v9, v8
v_cndmask_b32 v8, v8, v7, vcc
v_lshl_add_u32 v72, v8, 9, v6
s_lshl_b32 s7, s60, 7
v_lshrrev_b32 v5, 3, v2
v_and_b32 v6, 7, v2
v_and_b32 v7, 2, v5
v_xor_b32 v6, v6, v7
v_lshl_add_u32 v5, v5, 9, s7
v_lshl_add_u32 v17, v6, 4, v5
v_xor_b32 v6, 4, v6
v_lshl_add_u32 v18, v6, 4, v5
v_add_u32 v18, 0xc00, v18
v_add_u32 v19, 0x1800, v17
v_add_u32 v20, 0x1800, v18
s_xor_b32 s6, s62, 0
s_lshl_b32 s66, s6, 14
s_xor_b32 s6, s62, 1
s_lshl_b32 s67, s6, 14
s_xor_b32 s6, s62, 2
s_lshl_b32 s68, s6, 14
s_xor_b32 s6, s62, 3
s_lshl_b32 s69, s6, 14
s_xor_b32 s6, s62, 4
s_lshl_b32 s70, s6, 14
s_xor_b32 s6, s62, 5
s_lshl_b32 s71, s6, 14
s_xor_b32 s6, s62, 6
s_lshl_b32 s72, s6, 14
s_xor_b32 s6, s62, 7
s_lshl_b32 s73, s6, 14
s_waitcnt lgkmcnt(0)
s_cmp_ge_u32 s4, 4
s_cselect_b32 s6, s30, s24
s_cselect_b32 s7, s31, s25
s_add_u32 s40, s6, 0x0
s_addc_u32 s41, s7, 0
s_mov_b32 s42, 0x20000
s_mov_b32 s43, 0x00020000
s_add_u32 s44, s32, 0x0
s_addc_u32 s45, s33, 0
s_mov_b32 s46, 0x20000
s_mov_b32 s47, 0x00020000
buffer_load_dwordx4 v[44:47], v44, s[40:43], 0 offen
buffer_load_dwordx4 v[48:51], v48, s[40:43], 0 offen
buffer_load_dwordx4 v[52:55], v52, s[40:43], 0 offen
buffer_load_dwordx4 v[56:59], v56, s[40:43], 0 offen
buffer_load_dwordx4 v[60:63], v60, s[40:43], 0 offen
buffer_load_dwordx4 v[64:67], v64, s[40:43], 0 offen
buffer_load_dwordx4 v[68:71], v68, s[40:43], 0 offen
buffer_load_dwordx4 v[72:75], v72, s[40:43], 0 offen
s_add_u32 m0, s63, 0x0
s_nop 0
buffer_load_dwordx4 v17, s[44:47], s66 offen offset:0 lds
buffer_load_dwordx4 v18, s[44:47], s66 offen offset:1024 lds
buffer_load_dwordx4 v19, s[44:47], s66 offen offset:2048 lds
buffer_load_dwordx4 v20, s[44:47], s66 offen offset:3072 lds
s_add_u32 m0, s63, 0x1000
s_nop 0
buffer_load_dwordx4 v17, s[44:47], s67 offen offset:0 lds
buffer_load_dwordx4 v18, s[44:47], s67 offen offset:1024 lds
buffer_load_dwordx4 v19, s[44:47], s67 offen offset:2048 lds
buffer_load_dwordx4 v20, s[44:47], s67 offen offset:3072 lds
v_bfe_u32 v5, v2, 2, 3
v_xor_b32 v5, s62, v5
v_and_b32 v6, 3, v2
v_lshlrev_b32 v7, 10, v5
v_lshl_add_u32 v7, v6, 8, v7
v_add_u32 v7, 0xc000, v7
v_and_b32 v5, 1, v5
v_lshl_or_b32 v6, v5, 2, v6
v_lshrrev_b32 v5, 5, v2
s_mul_i32 s6, s60, 16
v_add3_u32 v8, v5, s6, 0
v_lshrrev_b32 v9, 4, v8
v_lshl_add_u32 v9, v9, 13, v7
v_and_b32 v8, 15, v8
v_xor_b32 v8, v8, v6
v_lshl_add_u32 v36, v8, 4, v9
v_add3_u32 v8, v5, s6, 2
v_lshrrev_b32 v9, 4, v8
v_lshl_add_u32 v9, v9, 13, v7
v_and_b32 v8, 15, v8
v_xor_b32 v8, v8, v6
v_lshl_add_u32 v37, v8, 4, v9
v_add3_u32 v8, v5, s6, 4
v_lshrrev_b32 v9, 4, v8
v_lshl_add_u32 v9, v9, 13, v7
v_and_b32 v8, 15, v8
v_xor_b32 v8, v8, v6
v_lshl_add_u32 v38, v8, 4, v9
v_add3_u32 v8, v5, s6, 6
v_lshrrev_b32 v9, 4, v8
v_lshl_add_u32 v9, v9, 13, v7
v_and_b32 v8, 15, v8
v_xor_b32 v8, v8, v6
v_lshl_add_u32 v39, v8, 4, v9
v_add3_u32 v8, v5, s6, 8
v_lshrrev_b32 v9, 4, v8
v_lshl_add_u32 v9, v9, 13, v7
v_and_b32 v8, 15, v8
v_xor_b32 v8, v8, v6
v_lshl_add_u32 v40, v8, 4, v9
v_add3_u32 v8, v5, s6, 10
v_lshrrev_b32 v9, 4, v8
v_lshl_add_u32 v9, v9, 13, v7
v_and_b32 v8, 15, v8
v_xor_b32 v8, v8, v6
v_lshl_add_u32 v41, v8, 4, v9
v_add3_u32 v8, v5, s6, 12
v_lshrrev_b32 v9, 4, v8
v_lshl_add_u32 v9, v9, 13, v7
v_and_b32 v8, 15, v8
v_xor_b32 v8, v8, v6
v_lshl_add_u32 v42, v8, 4, v9
v_add3_u32 v8, v5, s6, 14
v_lshrrev_b32 v9, 4, v8
v_lshl_add_u32 v9, v9, 13, v7
v_and_b32 v8, 15, v8
v_xor_b32 v8, v8, v6
v_lshl_add_u32 v43, v8, 4, v9
v_xor_b32 v5, v3, v4
v_lshlrev_b32 v5, 4, v5
v_lshl_add_u32 v5, v4, 8, v5
v_add_u32 v31, 0xc000, v5
v_xor_b32 v32, 64, v31
v_lshrrev_b32 v5, 2, v3
v_and_b32 v6, 3, v3
v_and_b32 v7, 1, v4
v_lshlrev_b32 v7, 2, v7
v_and_b32 v8, 2, v5
v_or_b32 v7, v7, v8
v_lshl_add_u32 v8, v4, 3, v5
v_lshlrev_b32 v8, 7, v8
v_add_u32 v8, s63, v8
v_xor_b32 v6, v6, v7
v_xor_b32 v9, 0, v6
v_lshl_add_u32 v25, v9, 4, v8
v_add_u32 v26, 8, v25
v_xor_b32 v9, 4, v6
v_lshl_add_u32 v27, v9, 4, v8
v_add_u32 v28, 8, v27
s_lshr_b32 s6, s4, 2
s_lshl_b32 s6, s6, 17
s_and_b32 s7, s4, 3
s_lshl_b32 s7, s7, 12
s_add_u32 s6, s6, s7
s_mul_i32 s7, s60, 32768
s_add_u32 s82, s6, s7
s_add_u32 s83, s82, 16384
s_add_u32 s52, s38, 0x1000000
s_addc_u32 s53, s39, 0
s_mov_b32 s54, 0x40000
s_mov_b32 s55, 0x00020000
v_and_b32 v5, 31, v2
v_lshlrev_b32 v5, 4, v5
s_mov_b32 s6, 130560
s_mov_b32 s90, 0xffff0000
buffer_load_dwordx4 v[92:95], v5, s[40:43], s6 offen
s_waitcnt vmcnt(0)
v_lshlrev_b32 v84, 16, v92
v_lshlrev_b32 v86, 16, v93
v_lshlrev_b32 v88, 16, v94
v_lshlrev_b32 v90, 16, v95
v_and_b32 v85, s90, v92
v_and_b32 v87, s90, v93
v_and_b32 v89, s90, v94
v_and_b32 v91, s90, v95
v_lshlrev_b32 v76, 16, v44
v_lshlrev_b32 v78, 16, v45
v_lshlrev_b32 v80, 16, v46
v_lshlrev_b32 v82, 16, v47
v_and_b32 v77, s90, v44
v_and_b32 v79, s90, v45
v_and_b32 v81, s90, v46
v_and_b32 v83, s90, v47
v_sub_f32 v76, v76, v84
v_sub_f32 v77, v77, v85
v_sub_f32 v78, v78, v86
v_sub_f32 v79, v79, v87
v_sub_f32 v80, v80, v88
v_sub_f32 v81, v81, v89
v_sub_f32 v82, v82, v90
v_sub_f32 v83, v83, v91
v_cvt_pk_bf16_f32 v44, v76, v77
v_cvt_pk_bf16_f32 v45, v78, v79
v_cvt_pk_bf16_f32 v46, v80, v81
v_cvt_pk_bf16_f32 v47, v82, v83
v_lshlrev_b32 v76, 16, v48
v_lshlrev_b32 v78, 16, v49
v_lshlrev_b32 v80, 16, v50
v_lshlrev_b32 v82, 16, v51
v_and_b32 v77, s90, v48
v_and_b32 v79, s90, v49
v_and_b32 v81, s90, v50
v_and_b32 v83, s90, v51
v_sub_f32 v76, v76, v84
v_sub_f32 v77, v77, v85
v_sub_f32 v78, v78, v86
v_sub_f32 v79, v79, v87
v_sub_f32 v80, v80, v88
v_sub_f32 v81, v81, v89
v_sub_f32 v82, v82, v90
v_sub_f32 v83, v83, v91
v_cvt_pk_bf16_f32 v48, v76, v77
v_cvt_pk_bf16_f32 v49, v78, v79
v_cvt_pk_bf16_f32 v50, v80, v81
v_cvt_pk_bf16_f32 v51, v82, v83
v_lshlrev_b32 v76, 16, v52
v_lshlrev_b32 v78, 16, v53
v_lshlrev_b32 v80, 16, v54
v_lshlrev_b32 v82, 16, v55
v_and_b32 v77, s90, v52
v_and_b32 v79, s90, v53
v_and_b32 v81, s90, v54
v_and_b32 v83, s90, v55
v_sub_f32 v76, v76, v84
v_sub_f32 v77, v77, v85
v_sub_f32 v78, v78, v86
v_sub_f32 v79, v79, v87
v_sub_f32 v80, v80, v88
v_sub_f32 v81, v81, v89
v_sub_f32 v82, v82, v90
v_sub_f32 v83, v83, v91
v_cvt_pk_bf16_f32 v52, v76, v77
v_cvt_pk_bf16_f32 v53, v78, v79
v_cvt_pk_bf16_f32 v54, v80, v81
v_cvt_pk_bf16_f32 v55, v82, v83
v_lshlrev_b32 v76, 16, v56
v_lshlrev_b32 v78, 16, v57
v_lshlrev_b32 v80, 16, v58
v_lshlrev_b32 v82, 16, v59
v_and_b32 v77, s90, v56
v_and_b32 v79, s90, v57
v_and_b32 v81, s90, v58
v_and_b32 v83, s90, v59
v_sub_f32 v76, v76, v84
v_sub_f32 v77, v77, v85
v_sub_f32 v78, v78, v86
v_sub_f32 v79, v79, v87
v_sub_f32 v80, v80, v88
v_sub_f32 v81, v81, v89
v_sub_f32 v82, v82, v90
v_sub_f32 v83, v83, v91
v_cvt_pk_bf16_f32 v56, v76, v77
v_cvt_pk_bf16_f32 v57, v78, v79
v_cvt_pk_bf16_f32 v58, v80, v81
v_cvt_pk_bf16_f32 v59, v82, v83
v_lshlrev_b32 v76, 16, v60
v_lshlrev_b32 v78, 16, v61
v_lshlrev_b32 v80, 16, v62
v_lshlrev_b32 v82, 16, v63
v_and_b32 v77, s90, v60
v_and_b32 v79, s90, v61
v_and_b32 v81, s90, v62
v_and_b32 v83, s90, v63
v_sub_f32 v76, v76, v84
v_sub_f32 v77, v77, v85
v_sub_f32 v78, v78, v86
v_sub_f32 v79, v79, v87
v_sub_f32 v80, v80, v88
v_sub_f32 v81, v81, v89
v_sub_f32 v82, v82, v90
v_sub_f32 v83, v83, v91
v_cvt_pk_bf16_f32 v60, v76, v77
v_cvt_pk_bf16_f32 v61, v78, v79
v_cvt_pk_bf16_f32 v62, v80, v81
v_cvt_pk_bf16_f32 v63, v82, v83
v_lshlrev_b32 v76, 16, v64
v_lshlrev_b32 v78, 16, v65
v_lshlrev_b32 v80, 16, v66
v_lshlrev_b32 v82, 16, v67
v_and_b32 v77, s90, v64
v_and_b32 v79, s90, v65
v_and_b32 v81, s90, v66
v_and_b32 v83, s90, v67
v_sub_f32 v76, v76, v84
v_sub_f32 v77, v77, v85
v_sub_f32 v78, v78, v86
v_sub_f32 v79, v79, v87
v_sub_f32 v80, v80, v88
v_sub_f32 v81, v81, v89
v_sub_f32 v82, v82, v90
v_sub_f32 v83, v83, v91
v_cvt_pk_bf16_f32 v64, v76, v77
v_cvt_pk_bf16_f32 v65, v78, v79
v_cvt_pk_bf16_f32 v66, v80, v81
v_cvt_pk_bf16_f32 v67, v82, v83
v_lshlrev_b32 v76, 16, v68
v_lshlrev_b32 v78, 16, v69
v_lshlrev_b32 v80, 16, v70
v_lshlrev_b32 v82, 16, v71
v_and_b32 v77, s90, v68
v_and_b32 v79, s90, v69
v_and_b32 v81, s90, v70
v_and_b32 v83, s90, v71
v_sub_f32 v76, v76, v84
v_sub_f32 v77, v77, v85
v_sub_f32 v78, v78, v86
v_sub_f32 v79, v79, v87
v_sub_f32 v80, v80, v88
v_sub_f32 v81, v81, v89
v_sub_f32 v82, v82, v90
v_sub_f32 v83, v83, v91
v_cvt_pk_bf16_f32 v68, v76, v77
v_cvt_pk_bf16_f32 v69, v78, v79
v_cvt_pk_bf16_f32 v70, v80, v81
v_cvt_pk_bf16_f32 v71, v82, v83
v_lshlrev_b32 v76, 16, v72
v_lshlrev_b32 v78, 16, v73
v_lshlrev_b32 v80, 16, v74
v_lshlrev_b32 v82, 16, v75
v_and_b32 v77, s90, v72
v_and_b32 v79, s90, v73
v_and_b32 v81, s90, v74
v_and_b32 v83, s90, v75
v_sub_f32 v76, v76, v84
v_sub_f32 v77, v77, v85
v_sub_f32 v78, v78, v86
v_sub_f32 v79, v79, v87
v_sub_f32 v80, v80, v88
v_sub_f32 v81, v81, v89
v_sub_f32 v82, v82, v90
v_sub_f32 v83, v83, v91
v_cvt_pk_bf16_f32 v72, v76, v77
v_cvt_pk_bf16_f32 v73, v78, v79
v_cvt_pk_bf16_f32 v74, v80, v81
v_cvt_pk_bf16_f32 v75, v82, v83
ds_write_b128 v36, v[44:47]
ds_write_b128 v37, v[48:51]
ds_write_b128 v38, v[52:55]
ds_write_b128 v39, v[56:59]
ds_write_b128 v40, v[60:63]
ds_write_b128 v41, v[64:67]
ds_write_b128 v42, v[68:71]
ds_write_b128 v43, v[72:75]
s_add_u32 m0, s63, 0x2000
s_nop 0
buffer_load_dwordx4 v17, s[44:47], s68 offen offset:0 lds
buffer_load_dwordx4 v18, s[44:47], s68 offen offset:1024 lds
buffer_load_dwordx4 v19, s[44:47], s68 offen offset:2048 lds
buffer_load_dwordx4 v20, s[44:47], s68 offen offset:3072 lds
ds_read_b64_tr_b16 v[140:141], v25 offset:0
ds_read_b64_tr_b16 v[142:143], v25 offset:512
ds_read_b64_tr_b16 v[144:145], v26 offset:0
ds_read_b64_tr_b16 v[146:147], v26 offset:512
ds_read_b64_tr_b16 v[148:149], v27 offset:0
ds_read_b64_tr_b16 v[150:151], v27 offset:512
s_waitcnt lgkmcnt(6)
s_barrier
ds_read_b128 v[180:183], v31 offset:0
ds_read_b128 v[184:187], v31 offset:8192
ds_read_b128 v[188:191], v31 offset:16384
ds_read_b128 v[192:195], v31 offset:24576
s_waitcnt lgkmcnt(3)
v_mfma_f32_16x16x32_bf16 v[76:79], v[180:183], v[140:143], 0
s_waitcnt lgkmcnt(2)
v_mfma_f32_16x16x32_bf16 v[80:83], v[184:187], v[140:143], 0
s_waitcnt lgkmcnt(1)
v_mfma_f32_16x16x32_bf16 v[84:87], v[188:191], v[140:143], 0
s_waitcnt lgkmcnt(0)
v_mfma_f32_16x16x32_bf16 v[88:91], v[192:195], v[140:143], 0
ds_read_b64_tr_b16 v[152:153], v28 offset:0
ds_read_b64_tr_b16 v[154:155], v28 offset:512
v_mfma_f32_16x16x32_bf16 v[92:95], v[180:183], v[144:147], 0
v_mfma_f32_16x16x32_bf16 v[96:99], v[184:187], v[144:147], 0
v_mfma_f32_16x16x32_bf16 v[100:103], v[188:191], v[144:147], 0
v_mfma_f32_16x16x32_bf16 v[104:107], v[192:195], v[144:147], 0
ds_read_b128 v[196:199], v32 offset:1024
ds_read_b64_tr_b16 v[156:157], v25 offset:4096
ds_read_b64_tr_b16 v[158:159], v25 offset:4608
v_mfma_f32_16x16x32_bf16 v[108:111], v[180:183], v[148:151], 0
ds_read_b128 v[200:203], v32 offset:9216
v_mfma_f32_16x16x32_bf16 v[112:115], v[184:187], v[148:151], 0
ds_read_b128 v[204:207], v32 offset:17408
v_mfma_f32_16x16x32_bf16 v[116:119], v[188:191], v[148:151], 0
ds_read_b128 v[208:211], v32 offset:25600
v_mfma_f32_16x16x32_bf16 v[120:123], v[192:195], v[148:151], 0
ds_read_b64_tr_b16 v[160:161], v26 offset:4096
ds_read_b64_tr_b16 v[162:163], v26 offset:4608
s_waitcnt lgkmcnt(8)
v_mfma_f32_16x16x32_bf16 v[124:127], v[180:183], v[152:155], 0
s_add_u32 m0, s63, 0x0
s_nop 0
buffer_load_dwordx4 v17, s[44:47], s69 offen offset:0 lds
buffer_load_dwordx4 v18, s[44:47], s69 offen offset:1024 lds
buffer_load_dwordx4 v19, s[44:47], s69 offen offset:2048 lds
buffer_load_dwordx4 v20, s[44:47], s69 offen offset:3072 lds
v_mfma_f32_16x16x32_bf16 v[128:131], v[184:187], v[152:155], 0
v_mfma_f32_16x16x32_bf16 v[132:135], v[188:191], v[152:155], 0
v_mfma_f32_16x16x32_bf16 v[136:139], v[192:195], v[152:155], 0
ds_read_b64_tr_b16 v[164:165], v27 offset:4096
ds_read_b64_tr_b16 v[166:167], v27 offset:4608
s_waitcnt lgkmcnt(7)
v_mfma_f32_16x16x32_bf16 v[76:79], v[196:199], v[156:159], v[76:79]
s_waitcnt lgkmcnt(6)
v_mfma_f32_16x16x32_bf16 v[80:83], v[200:203], v[156:159], v[80:83]
s_waitcnt lgkmcnt(5)
v_mfma_f32_16x16x32_bf16 v[84:87], v[204:207], v[156:159], v[84:87]
s_waitcnt lgkmcnt(4)
v_mfma_f32_16x16x32_bf16 v[88:91], v[208:211], v[156:159], v[88:91]
ds_read_b64_tr_b16 v[168:169], v28 offset:4096
ds_read_b64_tr_b16 v[170:171], v28 offset:4608
s_waitcnt lgkmcnt(4)
v_mfma_f32_16x16x32_bf16 v[92:95], v[196:199], v[160:163], v[92:95]
v_mfma_f32_16x16x32_bf16 v[96:99], v[200:203], v[160:163], v[96:99]
v_mfma_f32_16x16x32_bf16 v[100:103], v[204:207], v[160:163], v[100:103]
v_mfma_f32_16x16x32_bf16 v[104:107], v[208:211], v[160:163], v[104:107]
ds_read_b128 v[212:215], v31 offset:2048
s_waitcnt vmcnt(4)
ds_read_b64_tr_b16 v[172:173], v25 offset:8192
ds_read_b64_tr_b16 v[174:175], v25 offset:8704
s_waitcnt lgkmcnt(5)
v_mfma_f32_16x16x32_bf16 v[108:111], v[196:199], v[164:167], v[108:111]
ds_read_b128 v[216:219], v31 offset:10240
v_mfma_f32_16x16x32_bf16 v[112:115], v[200:203], v[164:167], v[112:115]
ds_read_b128 v[220:223], v31 offset:18432
v_mfma_f32_16x16x32_bf16 v[116:119], v[204:207], v[164:167], v[116:119]
ds_read_b128 v[224:227], v31 offset:26624
v_mfma_f32_16x16x32_bf16 v[120:123], v[208:211], v[164:167], v[120:123]
ds_read_b64_tr_b16 v[176:177], v26 offset:8192
ds_read_b64_tr_b16 v[178:179], v26 offset:8704
s_waitcnt lgkmcnt(8)
v_mfma_f32_16x16x32_bf16 v[124:127], v[196:199], v[168:171], v[124:127]
s_add_u32 m0, s63, 0x1000
s_nop 0
buffer_load_dwordx4 v17, s[44:47], s70 offen offset:0 lds
buffer_load_dwordx4 v18, s[44:47], s70 offen offset:1024 lds
buffer_load_dwordx4 v19, s[44:47], s70 offen offset:2048 lds
buffer_load_dwordx4 v20, s[44:47], s70 offen offset:3072 lds
v_mfma_f32_16x16x32_bf16 v[128:131], v[200:203], v[168:171], v[128:131]
v_mfma_f32_16x16x32_bf16 v[132:135], v[204:207], v[168:171], v[132:135]
v_mfma_f32_16x16x32_bf16 v[136:139], v[208:211], v[168:171], v[136:139]
ds_read_b64_tr_b16 v[140:141], v27 offset:8192
ds_read_b64_tr_b16 v[142:143], v27 offset:8704
s_waitcnt lgkmcnt(7)
v_mfma_f32_16x16x32_bf16 v[76:79], v[212:215], v[172:175], v[76:79]
s_waitcnt lgkmcnt(6)
v_mfma_f32_16x16x32_bf16 v[80:83], v[216:219], v[172:175], v[80:83]
s_waitcnt lgkmcnt(5)
v_mfma_f32_16x16x32_bf16 v[84:87], v[220:223], v[172:175], v[84:87]
s_waitcnt lgkmcnt(4)
v_mfma_f32_16x16x32_bf16 v[88:91], v[224:227], v[172:175], v[88:91]
ds_read_b64_tr_b16 v[144:145], v28 offset:8192
ds_read_b64_tr_b16 v[146:147], v28 offset:8704
s_waitcnt lgkmcnt(4)
v_mfma_f32_16x16x32_bf16 v[92:95], v[212:215], v[176:179], v[92:95]
v_mfma_f32_16x16x32_bf16 v[96:99], v[216:219], v[176:179], v[96:99]
v_mfma_f32_16x16x32_bf16 v[100:103], v[220:223], v[176:179], v[100:103]
v_mfma_f32_16x16x32_bf16 v[104:107], v[224:227], v[176:179], v[104:107]
ds_read_b128 v[180:183], v32 offset:3072
s_waitcnt vmcnt(4)
ds_read_b64_tr_b16 v[148:149], v25 offset:0
ds_read_b64_tr_b16 v[150:151], v25 offset:512
s_waitcnt lgkmcnt(5)
v_mfma_f32_16x16x32_bf16 v[108:111], v[212:215], v[140:143], v[108:111]
ds_read_b128 v[184:187], v32 offset:11264
v_mfma_f32_16x16x32_bf16 v[112:115], v[216:219], v[140:143], v[112:115]
ds_read_b128 v[188:191], v32 offset:19456
v_mfma_f32_16x16x32_bf16 v[116:119], v[220:223], v[140:143], v[116:119]
ds_read_b128 v[192:195], v32 offset:27648
v_mfma_f32_16x16x32_bf16 v[120:123], v[224:227], v[140:143], v[120:123]
ds_read_b64_tr_b16 v[152:153], v26 offset:0
ds_read_b64_tr_b16 v[154:155], v26 offset:512
s_waitcnt lgkmcnt(8)
v_mfma_f32_16x16x32_bf16 v[124:127], v[212:215], v[144:147], v[124:127]
s_add_u32 m0, s63, 0x2000
s_nop 0
buffer_load_dwordx4 v17, s[44:47], s71 offen offset:0 lds
buffer_load_dwordx4 v18, s[44:47], s71 offen offset:1024 lds
buffer_load_dwordx4 v19, s[44:47], s71 offen offset:2048 lds
buffer_load_dwordx4 v20, s[44:47], s71 offen offset:3072 lds
v_mfma_f32_16x16x32_bf16 v[128:131], v[216:219], v[144:147], v[128:131]
v_mfma_f32_16x16x32_bf16 v[132:135], v[220:223], v[144:147], v[132:135]
v_mfma_f32_16x16x32_bf16 v[136:139], v[224:227], v[144:147], v[136:139]
ds_read_b64_tr_b16 v[156:157], v27 offset:0
ds_read_b64_tr_b16 v[158:159], v27 offset:512
s_waitcnt lgkmcnt(7)
v_mfma_f32_16x16x32_bf16 v[76:79], v[180:183], v[148:151], v[76:79]
s_waitcnt lgkmcnt(6)
v_mfma_f32_16x16x32_bf16 v[80:83], v[184:187], v[148:151], v[80:83]
s_waitcnt lgkmcnt(5)
v_mfma_f32_16x16x32_bf16 v[84:87], v[188:191], v[148:151], v[84:87]
s_waitcnt lgkmcnt(4)
v_mfma_f32_16x16x32_bf16 v[88:91], v[192:195], v[148:151], v[88:91]
ds_read_b64_tr_b16 v[160:161], v28 offset:0
ds_read_b64_tr_b16 v[162:163], v28 offset:512
s_waitcnt lgkmcnt(4)
v_mfma_f32_16x16x32_bf16 v[92:95], v[180:183], v[152:155], v[92:95]
v_mfma_f32_16x16x32_bf16 v[96:99], v[184:187], v[152:155], v[96:99]
v_mfma_f32_16x16x32_bf16 v[100:103], v[188:191], v[152:155], v[100:103]
v_mfma_f32_16x16x32_bf16 v[104:107], v[192:195], v[152:155], v[104:107]
ds_read_b128 v[196:199], v31 offset:4096
s_waitcnt vmcnt(4)
ds_read_b64_tr_b16 v[164:165], v25 offset:4096
ds_read_b64_tr_b16 v[166:167], v25 offset:4608
s_waitcnt lgkmcnt(5)
v_mfma_f32_16x16x32_bf16 v[108:111], v[180:183], v[156:159], v[108:111]
ds_read_b128 v[200:203], v31 offset:12288
v_mfma_f32_16x16x32_bf16 v[112:115], v[184:187], v[156:159], v[112:115]
ds_read_b128 v[204:207], v31 offset:20480
v_mfma_f32_16x16x32_bf16 v[116:119], v[188:191], v[156:159], v[116:119]
ds_read_b128 v[208:211], v31 offset:28672
v_mfma_f32_16x16x32_bf16 v[120:123], v[192:195], v[156:159], v[120:123]
ds_read_b64_tr_b16 v[168:169], v26 offset:4096
ds_read_b64_tr_b16 v[170:171], v26 offset:4608
s_waitcnt lgkmcnt(8)
v_mfma_f32_16x16x32_bf16 v[124:127], v[180:183], v[160:163], v[124:127]
s_add_u32 m0, s63, 0x0
s_nop 0
buffer_load_dwordx4 v17, s[44:47], s72 offen offset:0 lds
buffer_load_dwordx4 v18, s[44:47], s72 offen offset:1024 lds
buffer_load_dwordx4 v19, s[44:47], s72 offen offset:2048 lds
buffer_load_dwordx4 v20, s[44:47], s72 offen offset:3072 lds
v_mfma_f32_16x16x32_bf16 v[128:131], v[184:187], v[160:163], v[128:131]
v_mfma_f32_16x16x32_bf16 v[132:135], v[188:191], v[160:163], v[132:135]
v_mfma_f32_16x16x32_bf16 v[136:139], v[192:195], v[160:163], v[136:139]
ds_read_b64_tr_b16 v[172:173], v27 offset:4096
ds_read_b64_tr_b16 v[174:175], v27 offset:4608
s_waitcnt lgkmcnt(7)
v_mfma_f32_16x16x32_bf16 v[76:79], v[196:199], v[164:167], v[76:79]
s_waitcnt lgkmcnt(6)
v_mfma_f32_16x16x32_bf16 v[80:83], v[200:203], v[164:167], v[80:83]
s_waitcnt lgkmcnt(5)
v_mfma_f32_16x16x32_bf16 v[84:87], v[204:207], v[164:167], v[84:87]
s_waitcnt lgkmcnt(4)
v_mfma_f32_16x16x32_bf16 v[88:91], v[208:211], v[164:167], v[88:91]
ds_read_b64_tr_b16 v[176:177], v28 offset:4096
ds_read_b64_tr_b16 v[178:179], v28 offset:4608
s_waitcnt lgkmcnt(4)
v_mfma_f32_16x16x32_bf16 v[92:95], v[196:199], v[168:171], v[92:95]
v_mfma_f32_16x16x32_bf16 v[96:99], v[200:203], v[168:171], v[96:99]
v_mfma_f32_16x16x32_bf16 v[100:103], v[204:207], v[168:171], v[100:103]
v_mfma_f32_16x16x32_bf16 v[104:107], v[208:211], v[168:171], v[104:107]
ds_read_b128 v[212:215], v32 offset:5120
s_waitcnt vmcnt(4)
ds_read_b64_tr_b16 v[140:141], v25 offset:8192
ds_read_b64_tr_b16 v[142:143], v25 offset:8704
s_waitcnt lgkmcnt(5)
v_mfma_f32_16x16x32_bf16 v[108:111], v[196:199], v[172:175], v[108:111]
ds_read_b128 v[216:219], v32 offset:13312
v_mfma_f32_16x16x32_bf16 v[112:115], v[200:203], v[172:175], v[112:115]
ds_read_b128 v[220:223], v32 offset:21504
v_mfma_f32_16x16x32_bf16 v[116:119], v[204:207], v[172:175], v[116:119]
ds_read_b128 v[224:227], v32 offset:29696
v_mfma_f32_16x16x32_bf16 v[120:123], v[208:211], v[172:175], v[120:123]
ds_read_b64_tr_b16 v[144:145], v26 offset:8192
ds_read_b64_tr_b16 v[146:147], v26 offset:8704
s_waitcnt lgkmcnt(8)
v_mfma_f32_16x16x32_bf16 v[124:127], v[196:199], v[176:179], v[124:127]
s_add_u32 m0, s63, 0x1000
s_nop 0
buffer_load_dwordx4 v17, s[44:47], s73 offen offset:0 lds
buffer_load_dwordx4 v18, s[44:47], s73 offen offset:1024 lds
buffer_load_dwordx4 v19, s[44:47], s73 offen offset:2048 lds
buffer_load_dwordx4 v20, s[44:47], s73 offen offset:3072 lds
v_mfma_f32_16x16x32_bf16 v[128:131], v[200:203], v[176:179], v[128:131]
v_mfma_f32_16x16x32_bf16 v[132:135], v[204:207], v[176:179], v[132:135]
v_mfma_f32_16x16x32_bf16 v[136:139], v[208:211], v[176:179], v[136:139]
ds_read_b64_tr_b16 v[148:149], v27 offset:8192
ds_read_b64_tr_b16 v[150:151], v27 offset:8704
s_waitcnt lgkmcnt(7)
v_mfma_f32_16x16x32_bf16 v[76:79], v[212:215], v[140:143], v[76:79]
s_waitcnt lgkmcnt(6)
v_mfma_f32_16x16x32_bf16 v[80:83], v[216:219], v[140:143], v[80:83]
s_waitcnt lgkmcnt(5)
v_mfma_f32_16x16x32_bf16 v[84:87], v[220:223], v[140:143], v[84:87]
s_waitcnt lgkmcnt(4)
v_mfma_f32_16x16x32_bf16 v[88:91], v[224:227], v[140:143], v[88:91]
ds_read_b64_tr_b16 v[152:153], v28 offset:8192
ds_read_b64_tr_b16 v[154:155], v28 offset:8704
s_waitcnt lgkmcnt(4)
v_mfma_f32_16x16x32_bf16 v[92:95], v[212:215], v[144:147], v[92:95]
v_mfma_f32_16x16x32_bf16 v[96:99], v[216:219], v[144:147], v[96:99]
v_mfma_f32_16x16x32_bf16 v[100:103], v[220:223], v[144:147], v[100:103]
v_mfma_f32_16x16x32_bf16 v[104:107], v[224:227], v[144:147], v[104:107]
ds_read_b128 v[180:183], v31 offset:6144
s_waitcnt vmcnt(4)
ds_read_b64_tr_b16 v[156:157], v25 offset:0
ds_read_b64_tr_b16 v[158:159], v25 offset:512
s_waitcnt lgkmcnt(5)
v_mfma_f32_16x16x32_bf16 v[108:111], v[212:215], v[148:151], v[108:111]
ds_read_b128 v[184:187], v31 offset:14336
v_mfma_f32_16x16x32_bf16 v[112:115], v[216:219], v[148:151], v[112:115]
ds_read_b128 v[188:191], v31 offset:22528
v_mfma_f32_16x16x32_bf16 v[116:119], v[220:223], v[148:151], v[116:119]
ds_read_b128 v[192:195], v31 offset:30720
v_mfma_f32_16x16x32_bf16 v[120:123], v[224:227], v[148:151], v[120:123]
ds_read_b64_tr_b16 v[160:161], v26 offset:0
ds_read_b64_tr_b16 v[162:163], v26 offset:512
s_waitcnt lgkmcnt(8)
v_mfma_f32_16x16x32_bf16 v[124:127], v[212:215], v[152:155], v[124:127]
v_mfma_f32_16x16x32_bf16 v[128:131], v[216:219], v[152:155], v[128:131]
v_mfma_f32_16x16x32_bf16 v[132:135], v[220:223], v[152:155], v[132:135]
v_mfma_f32_16x16x32_bf16 v[136:139], v[224:227], v[152:155], v[136:139]
ds_read_b64_tr_b16 v[164:165], v27 offset:0
ds_read_b64_tr_b16 v[166:167], v27 offset:512
s_waitcnt lgkmcnt(7)
v_mfma_f32_16x16x32_bf16 v[76:79], v[180:183], v[156:159], v[76:79]
s_waitcnt lgkmcnt(6)
v_mfma_f32_16x16x32_bf16 v[80:83], v[184:187], v[156:159], v[80:83]
s_waitcnt lgkmcnt(5)
v_mfma_f32_16x16x32_bf16 v[84:87], v[188:191], v[156:159], v[84:87]
s_waitcnt lgkmcnt(4)
v_mfma_f32_16x16x32_bf16 v[88:91], v[192:195], v[156:159], v[88:91]
ds_read_b64_tr_b16 v[168:169], v28 offset:0
ds_read_b64_tr_b16 v[170:171], v28 offset:512
s_waitcnt lgkmcnt(4)
v_mfma_f32_16x16x32_bf16 v[92:95], v[180:183], v[160:163], v[92:95]
v_mfma_f32_16x16x32_bf16 v[96:99], v[184:187], v[160:163], v[96:99]
v_mfma_f32_16x16x32_bf16 v[100:103], v[188:191], v[160:163], v[100:103]
v_mfma_f32_16x16x32_bf16 v[104:107], v[192:195], v[160:163], v[104:107]
ds_read_b128 v[196:199], v32 offset:7168
s_waitcnt vmcnt(0)
ds_read_b64_tr_b16 v[172:173], v25 offset:4096
ds_read_b64_tr_b16 v[174:175], v25 offset:4608
s_waitcnt lgkmcnt(5)
v_mfma_f32_16x16x32_bf16 v[108:111], v[180:183], v[164:167], v[108:111]
ds_read_b128 v[200:203], v32 offset:15360
v_mfma_f32_16x16x32_bf16 v[112:115], v[184:187], v[164:167], v[112:115]
ds_read_b128 v[204:207], v32 offset:23552
v_mfma_f32_16x16x32_bf16 v[116:119], v[188:191], v[164:167], v[116:119]
ds_read_b128 v[208:211], v32 offset:31744
v_mfma_f32_16x16x32_bf16 v[120:123], v[192:195], v[164:167], v[120:123]
ds_read_b64_tr_b16 v[176:177], v26 offset:4096
ds_read_b64_tr_b16 v[178:179], v26 offset:4608
s_waitcnt lgkmcnt(8)
v_mfma_f32_16x16x32_bf16 v[124:127], v[180:183], v[168:171], v[124:127]
v_mfma_f32_16x16x32_bf16 v[128:131], v[184:187], v[168:171], v[128:131]
v_mfma_f32_16x16x32_bf16 v[132:135], v[188:191], v[168:171], v[132:135]
v_mfma_f32_16x16x32_bf16 v[136:139], v[192:195], v[168:171], v[136:139]
ds_read_b64_tr_b16 v[140:141], v27 offset:4096
ds_read_b64_tr_b16 v[142:143], v27 offset:4608
s_waitcnt lgkmcnt(7)
v_mfma_f32_16x16x32_bf16 v[76:79], v[196:199], v[172:175], v[76:79]
s_waitcnt lgkmcnt(6)
v_mfma_f32_16x16x32_bf16 v[80:83], v[200:203], v[172:175], v[80:83]
s_waitcnt lgkmcnt(5)
v_mfma_f32_16x16x32_bf16 v[84:87], v[204:207], v[172:175], v[84:87]
s_waitcnt lgkmcnt(4)
v_mfma_f32_16x16x32_bf16 v[88:91], v[208:211], v[172:175], v[88:91]
ds_read_b64_tr_b16 v[144:145], v28 offset:4096
ds_read_b64_tr_b16 v[146:147], v28 offset:4608
s_waitcnt lgkmcnt(4)
v_mfma_f32_16x16x32_bf16 v[92:95], v[196:199], v[176:179], v[92:95]
v_cvt_pk_bf16_f32 v76, v76, v77
v_cvt_pk_bf16_f32 v77, v78, v79
v_cvt_pk_bf16_f32 v78, v80, v81
v_cvt_pk_bf16_f32 v79, v82, v83
buffer_store_dwordx4 v[76:79], v16, s[52:55], s82 offen offset:0 sc1
v_mfma_f32_16x16x32_bf16 v[96:99], v[200:203], v[176:179], v[96:99]
v_mfma_f32_16x16x32_bf16 v[100:103], v[204:207], v[176:179], v[100:103]
v_cvt_pk_bf16_f32 v84, v84, v85
v_cvt_pk_bf16_f32 v85, v86, v87
v_cvt_pk_bf16_f32 v86, v88, v89
v_cvt_pk_bf16_f32 v87, v90, v91
buffer_store_dwordx4 v[84:87], v16, s[52:55], s82 offen offset:2048 sc1
v_mfma_f32_16x16x32_bf16 v[104:107], v[208:211], v[176:179], v[104:107]
s_waitcnt lgkmcnt(2)
v_mfma_f32_16x16x32_bf16 v[108:111], v[196:199], v[140:143], v[108:111]
v_cvt_pk_bf16_f32 v92, v92, v93
v_cvt_pk_bf16_f32 v93, v94, v95
v_cvt_pk_bf16_f32 v94, v96, v97
v_cvt_pk_bf16_f32 v95, v98, v99
buffer_store_dwordx4 v[92:95], v16, s[52:55], s82 offen offset:1024 sc1
v_mfma_f32_16x16x32_bf16 v[112:115], v[200:203], v[140:143], v[112:115]
v_mfma_f32_16x16x32_bf16 v[116:119], v[204:207], v[140:143], v[116:119]
v_cvt_pk_bf16_f32 v100, v100, v101
v_cvt_pk_bf16_f32 v101, v102, v103
v_cvt_pk_bf16_f32 v102, v104, v105
v_cvt_pk_bf16_f32 v103, v106, v107
buffer_store_dwordx4 v[100:103], v16, s[52:55], s82 offen offset:3072 sc1
v_mfma_f32_16x16x32_bf16 v[120:123], v[208:211], v[140:143], v[120:123]
s_waitcnt lgkmcnt(0)
v_mfma_f32_16x16x32_bf16 v[124:127], v[196:199], v[144:147], v[124:127]
v_cvt_pk_bf16_f32 v108, v108, v109
v_cvt_pk_bf16_f32 v109, v110, v111
v_cvt_pk_bf16_f32 v110, v112, v113
v_cvt_pk_bf16_f32 v111, v114, v115
buffer_store_dwordx4 v[108:111], v16, s[52:55], s83 offen offset:0 sc1
v_mfma_f32_16x16x32_bf16 v[128:131], v[200:203], v[144:147], v[128:131]
v_mfma_f32_16x16x32_bf16 v[132:135], v[204:207], v[144:147], v[132:135]
v_cvt_pk_bf16_f32 v116, v116, v117
v_cvt_pk_bf16_f32 v117, v118, v119
v_cvt_pk_bf16_f32 v118, v120, v121
v_cvt_pk_bf16_f32 v119, v122, v123
buffer_store_dwordx4 v[116:119], v16, s[52:55], s83 offen offset:2048 sc1
v_mfma_f32_16x16x32_bf16 v[136:139], v[208:211], v[144:147], v[136:139]
v_cvt_pk_bf16_f32 v124, v124, v125
v_cvt_pk_bf16_f32 v125, v126, v127
v_cvt_pk_bf16_f32 v126, v128, v129
v_cvt_pk_bf16_f32 v127, v130, v131
buffer_store_dwordx4 v[124:127], v16, s[52:55], s83 offen offset:1024 sc1
v_cvt_pk_bf16_f32 v132, v132, v133
v_cvt_pk_bf16_f32 v133, v134, v135
s_nop 0
v_cvt_pk_bf16_f32 v134, v136, v137
v_cvt_pk_bf16_f32 v135, v138, v139
buffer_store_dwordx4 v[132:135], v16, s[52:55], s83 offen offset:3072 sc1
s_branch LM_pub
LM_light:
s_mov_b32 s61, 1
s_waitcnt lgkmcnt(0)
s_mov_b32 s98, 0x7c3ff80
s_load_dwordx2 s[98:99], s[38:39], s98
s_branch L1_fin
LM_edge:
s_sub_u32 s4, s3, 30
s_lshl_b32 s8, s8, 1
s_add_u32 s4, s4, s8
s_add_u32 s91, s4, 240
s_cmp_ge_u32 s4, 14
s_cselect_b32 s61, 1, 0
s_mul_i32 s6, s4, 40000
v_lshlrev_b32 v5, 4, v0
v_lshlrev_b32 v6, 2, v2
v_add_u32 v6, 0x10000, v6
v_mov_b32 v7, 0
ds_write_b32 v6, v7
s_mov_b32 s66, 0
s_mov_b32 s67, 4096
s_mov_b32 s68, 8192
s_mov_b32 s69, 12288
s_mov_b32 s70, 16384
s_mov_b32 s71, 20480
s_mov_b32 s72, 24576
s_mov_b32 s73, 28672
s_mov_b32 s74, 32768
s_mov_b32 s75, 36864
s_waitcnt lgkmcnt(0)
s_add_u32 s40, s20, 0x0
s_addc_u32 s41, s21, 0
s_add_u32 s40, s40, s6
s_addc_u32 s41, s41, 0
s_mov_b32 s42, 0x9c40
s_mov_b32 s43, 0x00020000
s_add_u32 s44, s18, 0x0
s_addc_u32 s45, s19, 0
s_add_u32 s44, s44, s6
s_addc_u32 s45, s45, 0
s_mov_b32 s46, 0x9c40
s_mov_b32 s47, 0x00020000
buffer_load_dwordx4 v[16:19], v5, s[40:43], s66 offen
buffer_load_dwordx4 v[20:23], v5, s[40:43], s67 offen
buffer_load_dwordx4 v[24:27], v5, s[40:43], s68 offen
buffer_load_dwordx4 v[28:31], v5, s[40:43], s69 offen
buffer_load_dwordx4 v[32:35], v5, s[40:43], s70 offen
buffer_load_dwordx4 v[36:39], v5, s[40:43], s71 offen
buffer_load_dwordx4 v[40:43], v5, s[40:43], s72 offen
buffer_load_dwordx4 v[44:47], v5, s[40:43], s73 offen
buffer_load_dwordx4 v[48:51], v5, s[40:43], s74 offen
buffer_load_dwordx4 v[52:55], v5, s[40:43], s75 offen
buffer_load_dwordx4 v[56:59], v5, s[44:47], s66 offen
buffer_load_dwordx4 v[60:63], v5, s[44:47], s67 offen
buffer_load_dwordx4 v[64:67], v5, s[44:47], s68 offen
buffer_load_dwordx4 v[68:71], v5, s[44:47], s69 offen
buffer_load_dwordx4 v[72:75], v5, s[44:47], s70 offen
buffer_load_dwordx4 v[76:79], v5, s[44:47], s71 offen
buffer_load_dwordx4 v[80:83], v5, s[44:47], s72 offen
buffer_load_dwordx4 v[84:87], v5, s[44:47], s73 offen
buffer_load_dwordx4 v[88:91], v5, s[44:47], s74 offen
buffer_load_dwordx4 v[92:95], v5, s[44:47], s75 offen
s_mov_b32 s98, 0x7c3ff80
s_load_dwordx2 s[98:99], s[38:39], s98
s_add_u32 s48, s38, 0x8000000
s_addc_u32 s49, s39, 0
s_mov_b32 s50, 0x2800000
s_mov_b32 s51, 0x00020000
s_add_u32 s52, s38, 0x7800000
s_addc_u32 s53, s39, 0
s_mov_b32 s54, 0x1000
s_mov_b32 s55, 0x00020000
v_mov_b32 v240, 6945
v_mov_b32 v241, 0x0
v_mov_b32 v242, 6317
v_mov_b32 v243, 0x340674
v_mov_b32 v244, 6899
v_mov_b32 v245, 0xfffae6a0
v_mov_b32 v246, 6242
v_mov_b32 v247, 0x4484a0
s_mov_b32 s11, 0x10000
v_mov_b32 v7, 1
v_cmp_gt_u32 vcc, 0xc4, v0
s_mov_b64 s[12:13], vcc
s_barrier
s_waitcnt vmcnt(19)
v_cmp_le_u32 vcc, 5436, v16
s_nop 1
v_cndmask_b32 v96, v240, v242, vcc
v_cndmask_b32 v136, v241, v243, vcc
v_cmp_le_u32 vcc, 6432, v16
s_nop 1
v_cndmask_b32 v96, v96, v244, vcc
v_cndmask_b32 v136, v136, v245, vcc
v_cmp_le_u32 vcc, 7344, v16
s_nop 1
v_cndmask_b32 v96, v96, v246, vcc
v_cndmask_b32 v136, v136, v247, vcc
v_mad_u32_u24 v96, v96, v16, v136
v_lshrrev_b32 v96, 20, v96
v_lshl_add_u32 v136, v96, 2, s11
ds_add_rtn_u32 v136, v136, v7
v_cmp_le_u32 vcc, 5436, v17
s_nop 1
v_cndmask_b32 v97, v240, v242, vcc
v_cndmask_b32 v137, v241, v243, vcc
v_cmp_le_u32 vcc, 6432, v17
s_nop 1
v_cndmask_b32 v97, v97, v244, vcc
v_cndmask_b32 v137, v137, v245, vcc
v_cmp_le_u32 vcc, 7344, v17
s_nop 1
v_cndmask_b32 v97, v97, v246, vcc
v_cndmask_b32 v137, v137, v247, vcc
v_mad_u32_u24 v97, v97, v17, v137
v_lshrrev_b32 v97, 20, v97
v_lshl_add_u32 v137, v97, 2, s11
ds_add_rtn_u32 v137, v137, v7
v_cmp_le_u32 vcc, 5436, v18
s_nop 1
v_cndmask_b32 v98, v240, v242, vcc
v_cndmask_b32 v138, v241, v243, vcc
v_cmp_le_u32 vcc, 6432, v18
s_nop 1
v_cndmask_b32 v98, v98, v244, vcc
v_cndmask_b32 v138, v138, v245, vcc
v_cmp_le_u32 vcc, 7344, v18
s_nop 1
v_cndmask_b32 v98, v98, v246, vcc
v_cndmask_b32 v138, v138, v247, vcc
v_mad_u32_u24 v98, v98, v18, v138
v_lshrrev_b32 v98, 20, v98
v_lshl_add_u32 v138, v98, 2, s11
ds_add_rtn_u32 v138, v138, v7
v_cmp_le_u32 vcc, 5436, v19
s_nop 1
v_cndmask_b32 v99, v240, v242, vcc
v_cndmask_b32 v139, v241, v243, vcc
v_cmp_le_u32 vcc, 6432, v19
s_nop 1
v_cndmask_b32 v99, v99, v244, vcc
v_cndmask_b32 v139, v139, v245, vcc
v_cmp_le_u32 vcc, 7344, v19
s_nop 1
v_cndmask_b32 v99, v99, v246, vcc
v_cndmask_b32 v139, v139, v247, vcc
v_mad_u32_u24 v99, v99, v19, v139
v_lshrrev_b32 v99, 20, v99
v_lshl_add_u32 v139, v99, 2, s11
ds_add_rtn_u32 v139, v139, v7
s_waitcnt vmcnt(18)
v_cmp_le_u32 vcc, 5436, v20
s_nop 1
v_cndmask_b32 v100, v240, v242, vcc
v_cndmask_b32 v140, v241, v243, vcc
v_cmp_le_u32 vcc, 6432, v20
s_nop 1
v_cndmask_b32 v100, v100, v244, vcc
v_cndmask_b32 v140, v140, v245, vcc
v_cmp_le_u32 vcc, 7344, v20
s_nop 1
v_cndmask_b32 v100, v100, v246, vcc
v_cndmask_b32 v140, v140, v247, vcc
v_mad_u32_u24 v100, v100, v20, v140
v_lshrrev_b32 v100, 20, v100
v_lshl_add_u32 v140, v100, 2, s11
ds_add_rtn_u32 v140, v140, v7
v_cmp_le_u32 vcc, 5436, v21
s_nop 1
v_cndmask_b32 v101, v240, v242, vcc
v_cndmask_b32 v141, v241, v243, vcc
v_cmp_le_u32 vcc, 6432, v21
s_nop 1
v_cndmask_b32 v101, v101, v244, vcc
v_cndmask_b32 v141, v141, v245, vcc
v_cmp_le_u32 vcc, 7344, v21
s_nop 1
v_cndmask_b32 v101, v101, v246, vcc
v_cndmask_b32 v141, v141, v247, vcc
v_mad_u32_u24 v101, v101, v21, v141
v_lshrrev_b32 v101, 20, v101
v_lshl_add_u32 v141, v101, 2, s11
ds_add_rtn_u32 v141, v141, v7
v_cmp_le_u32 vcc, 5436, v22
s_nop 1
v_cndmask_b32 v102, v240, v242, vcc
v_cndmask_b32 v142, v241, v243, vcc
v_cmp_le_u32 vcc, 6432, v22
s_nop 1
v_cndmask_b32 v102, v102, v244, vcc
v_cndmask_b32 v142, v142, v245, vcc
v_cmp_le_u32 vcc, 7344, v22
s_nop 1
v_cndmask_b32 v102, v102, v246, vcc
v_cndmask_b32 v142, v142, v247, vcc
v_mad_u32_u24 v102, v102, v22, v142
v_lshrrev_b32 v102, 20, v102
v_lshl_add_u32 v142, v102, 2, s11
ds_add_rtn_u32 v142, v142, v7
v_cmp_le_u32 vcc, 5436, v23
s_nop 1
v_cndmask_b32 v103, v240, v242, vcc
v_cndmask_b32 v143, v241, v243, vcc
v_cmp_le_u32 vcc, 6432, v23
s_nop 1
v_cndmask_b32 v103, v103, v244, vcc
v_cndmask_b32 v143, v143, v245, vcc
v_cmp_le_u32 vcc, 7344, v23
s_nop 1
v_cndmask_b32 v103, v103, v246, vcc
v_cndmask_b32 v143, v143, v247, vcc
v_mad_u32_u24 v103, v103, v23, v143
v_lshrrev_b32 v103, 20, v103
v_lshl_add_u32 v143, v103, 2, s11
ds_add_rtn_u32 v143, v143, v7
s_waitcnt vmcnt(17)
v_cmp_le_u32 vcc, 5436, v24
s_nop 1
v_cndmask_b32 v104, v240, v242, vcc
v_cndmask_b32 v144, v241, v243, vcc
v_cmp_le_u32 vcc, 6432, v24
s_nop 1
v_cndmask_b32 v104, v104, v244, vcc
v_cndmask_b32 v144, v144, v245, vcc
v_cmp_le_u32 vcc, 7344, v24
s_nop 1
v_cndmask_b32 v104, v104, v246, vcc
v_cndmask_b32 v144, v144, v247, vcc
v_mad_u32_u24 v104, v104, v24, v144
v_lshrrev_b32 v104, 20, v104
v_lshl_add_u32 v144, v104, 2, s11
ds_add_rtn_u32 v144, v144, v7
v_cmp_le_u32 vcc, 5436, v25
s_nop 1
v_cndmask_b32 v105, v240, v242, vcc
v_cndmask_b32 v145, v241, v243, vcc
v_cmp_le_u32 vcc, 6432, v25
s_nop 1
v_cndmask_b32 v105, v105, v244, vcc
v_cndmask_b32 v145, v145, v245, vcc
v_cmp_le_u32 vcc, 7344, v25
s_nop 1
v_cndmask_b32 v105, v105, v246, vcc
v_cndmask_b32 v145, v145, v247, vcc
v_mad_u32_u24 v105, v105, v25, v145
v_lshrrev_b32 v105, 20, v105
v_lshl_add_u32 v145, v105, 2, s11
ds_add_rtn_u32 v145, v145, v7
v_cmp_le_u32 vcc, 5436, v26
s_nop 1
v_cndmask_b32 v106, v240, v242, vcc
v_cndmask_b32 v146, v241, v243, vcc
v_cmp_le_u32 vcc, 6432, v26
s_nop 1
v_cndmask_b32 v106, v106, v244, vcc
v_cndmask_b32 v146, v146, v245, vcc
v_cmp_le_u32 vcc, 7344, v26
s_nop 1
v_cndmask_b32 v106, v106, v246, vcc
v_cndmask_b32 v146, v146, v247, vcc
v_mad_u32_u24 v106, v106, v26, v146
v_lshrrev_b32 v106, 20, v106
v_lshl_add_u32 v146, v106, 2, s11
ds_add_rtn_u32 v146, v146, v7
v_cmp_le_u32 vcc, 5436, v27
s_nop 1
v_cndmask_b32 v107, v240, v242, vcc
v_cndmask_b32 v147, v241, v243, vcc
v_cmp_le_u32 vcc, 6432, v27
s_nop 1
v_cndmask_b32 v107, v107, v244, vcc
v_cndmask_b32 v147, v147, v245, vcc
v_cmp_le_u32 vcc, 7344, v27
s_nop 1
v_cndmask_b32 v107, v107, v246, vcc
v_cndmask_b32 v147, v147, v247, vcc
v_mad_u32_u24 v107, v107, v27, v147
v_lshrrev_b32 v107, 20, v107
v_lshl_add_u32 v147, v107, 2, s11
ds_add_rtn_u32 v147, v147, v7
s_waitcnt vmcnt(16)
v_cmp_le_u32 vcc, 5436, v28
s_nop 1
v_cndmask_b32 v108, v240, v242, vcc
v_cndmask_b32 v148, v241, v243, vcc
v_cmp_le_u32 vcc, 6432, v28
s_nop 1
v_cndmask_b32 v108, v108, v244, vcc
v_cndmask_b32 v148, v148, v245, vcc
v_cmp_le_u32 vcc, 7344, v28
s_nop 1
v_cndmask_b32 v108, v108, v246, vcc
v_cndmask_b32 v148, v148, v247, vcc
v_mad_u32_u24 v108, v108, v28, v148
v_lshrrev_b32 v108, 20, v108
v_lshl_add_u32 v148, v108, 2, s11
ds_add_rtn_u32 v148, v148, v7
v_cmp_le_u32 vcc, 5436, v29
s_nop 1
v_cndmask_b32 v109, v240, v242, vcc
v_cndmask_b32 v149, v241, v243, vcc
v_cmp_le_u32 vcc, 6432, v29
s_nop 1
v_cndmask_b32 v109, v109, v244, vcc
v_cndmask_b32 v149, v149, v245, vcc
v_cmp_le_u32 vcc, 7344, v29
s_nop 1
v_cndmask_b32 v109, v109, v246, vcc
v_cndmask_b32 v149, v149, v247, vcc
v_mad_u32_u24 v109, v109, v29, v149
v_lshrrev_b32 v109, 20, v109
v_lshl_add_u32 v149, v109, 2, s11
ds_add_rtn_u32 v149, v149, v7
v_cmp_le_u32 vcc, 5436, v30
s_nop 1
v_cndmask_b32 v110, v240, v242, vcc
v_cndmask_b32 v150, v241, v243, vcc
v_cmp_le_u32 vcc, 6432, v30
s_nop 1
v_cndmask_b32 v110, v110, v244, vcc
v_cndmask_b32 v150, v150, v245, vcc
v_cmp_le_u32 vcc, 7344, v30
s_nop 1
v_cndmask_b32 v110, v110, v246, vcc
v_cndmask_b32 v150, v150, v247, vcc
v_mad_u32_u24 v110, v110, v30, v150
v_lshrrev_b32 v110, 20, v110
v_lshl_add_u32 v150, v110, 2, s11
ds_add_rtn_u32 v150, v150, v7
v_cmp_le_u32 vcc, 5436, v31
s_nop 1
v_cndmask_b32 v111, v240, v242, vcc
v_cndmask_b32 v151, v241, v243, vcc
v_cmp_le_u32 vcc, 6432, v31
s_nop 1
v_cndmask_b32 v111, v111, v244, vcc
v_cndmask_b32 v151, v151, v245, vcc
v_cmp_le_u32 vcc, 7344, v31
s_nop 1
v_cndmask_b32 v111, v111, v246, vcc
v_cndmask_b32 v151, v151, v247, vcc
v_mad_u32_u24 v111, v111, v31, v151
v_lshrrev_b32 v111, 20, v111
v_lshl_add_u32 v151, v111, 2, s11
ds_add_rtn_u32 v151, v151, v7
s_waitcnt vmcnt(15)
v_cmp_le_u32 vcc, 5436, v32
s_nop 1
v_cndmask_b32 v112, v240, v242, vcc
v_cndmask_b32 v152, v241, v243, vcc
v_cmp_le_u32 vcc, 6432, v32
s_nop 1
v_cndmask_b32 v112, v112, v244, vcc
v_cndmask_b32 v152, v152, v245, vcc
v_cmp_le_u32 vcc, 7344, v32
s_nop 1
v_cndmask_b32 v112, v112, v246, vcc
v_cndmask_b32 v152, v152, v247, vcc
v_mad_u32_u24 v112, v112, v32, v152
v_lshrrev_b32 v112, 20, v112
v_lshl_add_u32 v152, v112, 2, s11
ds_add_rtn_u32 v152, v152, v7
v_cmp_le_u32 vcc, 5436, v33
s_nop 1
v_cndmask_b32 v113, v240, v242, vcc
v_cndmask_b32 v153, v241, v243, vcc
v_cmp_le_u32 vcc, 6432, v33
s_nop 1
v_cndmask_b32 v113, v113, v244, vcc
v_cndmask_b32 v153, v153, v245, vcc
v_cmp_le_u32 vcc, 7344, v33
s_nop 1
v_cndmask_b32 v113, v113, v246, vcc
v_cndmask_b32 v153, v153, v247, vcc
v_mad_u32_u24 v113, v113, v33, v153
v_lshrrev_b32 v113, 20, v113
v_lshl_add_u32 v153, v113, 2, s11
ds_add_rtn_u32 v153, v153, v7
v_cmp_le_u32 vcc, 5436, v34
s_nop 1
v_cndmask_b32 v114, v240, v242, vcc
v_cndmask_b32 v154, v241, v243, vcc
v_cmp_le_u32 vcc, 6432, v34
s_nop 1
v_cndmask_b32 v114, v114, v244, vcc
v_cndmask_b32 v154, v154, v245, vcc
v_cmp_le_u32 vcc, 7344, v34
s_nop 1
v_cndmask_b32 v114, v114, v246, vcc
v_cndmask_b32 v154, v154, v247, vcc
v_mad_u32_u24 v114, v114, v34, v154
v_lshrrev_b32 v114, 20, v114
v_lshl_add_u32 v154, v114, 2, s11
ds_add_rtn_u32 v154, v154, v7
v_cmp_le_u32 vcc, 5436, v35
s_nop 1
v_cndmask_b32 v115, v240, v242, vcc
v_cndmask_b32 v155, v241, v243, vcc
v_cmp_le_u32 vcc, 6432, v35
s_nop 1
v_cndmask_b32 v115, v115, v244, vcc
v_cndmask_b32 v155, v155, v245, vcc
v_cmp_le_u32 vcc, 7344, v35
s_nop 1
v_cndmask_b32 v115, v115, v246, vcc
v_cndmask_b32 v155, v155, v247, vcc
v_mad_u32_u24 v115, v115, v35, v155
v_lshrrev_b32 v115, 20, v115
v_lshl_add_u32 v155, v115, 2, s11
ds_add_rtn_u32 v155, v155, v7
s_waitcnt vmcnt(14)
v_cmp_le_u32 vcc, 5436, v36
s_nop 1
v_cndmask_b32 v116, v240, v242, vcc
v_cndmask_b32 v156, v241, v243, vcc
v_cmp_le_u32 vcc, 6432, v36
s_nop 1
v_cndmask_b32 v116, v116, v244, vcc
v_cndmask_b32 v156, v156, v245, vcc
v_cmp_le_u32 vcc, 7344, v36
s_nop 1
v_cndmask_b32 v116, v116, v246, vcc
v_cndmask_b32 v156, v156, v247, vcc
v_mad_u32_u24 v116, v116, v36, v156
v_lshrrev_b32 v116, 20, v116
v_lshl_add_u32 v156, v116, 2, s11
ds_add_rtn_u32 v156, v156, v7
v_cmp_le_u32 vcc, 5436, v37
s_nop 1
v_cndmask_b32 v117, v240, v242, vcc
v_cndmask_b32 v157, v241, v243, vcc
v_cmp_le_u32 vcc, 6432, v37
s_nop 1
v_cndmask_b32 v117, v117, v244, vcc
v_cndmask_b32 v157, v157, v245, vcc
v_cmp_le_u32 vcc, 7344, v37
s_nop 1
v_cndmask_b32 v117, v117, v246, vcc
v_cndmask_b32 v157, v157, v247, vcc
v_mad_u32_u24 v117, v117, v37, v157
v_lshrrev_b32 v117, 20, v117
v_lshl_add_u32 v157, v117, 2, s11
ds_add_rtn_u32 v157, v157, v7
v_cmp_le_u32 vcc, 5436, v38
s_nop 1
v_cndmask_b32 v118, v240, v242, vcc
v_cndmask_b32 v158, v241, v243, vcc
v_cmp_le_u32 vcc, 6432, v38
s_nop 1
v_cndmask_b32 v118, v118, v244, vcc
v_cndmask_b32 v158, v158, v245, vcc
v_cmp_le_u32 vcc, 7344, v38
s_nop 1
v_cndmask_b32 v118, v118, v246, vcc
v_cndmask_b32 v158, v158, v247, vcc
v_mad_u32_u24 v118, v118, v38, v158
v_lshrrev_b32 v118, 20, v118
v_lshl_add_u32 v158, v118, 2, s11
ds_add_rtn_u32 v158, v158, v7
v_cmp_le_u32 vcc, 5436, v39
s_nop 1
v_cndmask_b32 v119, v240, v242, vcc
v_cndmask_b32 v159, v241, v243, vcc
v_cmp_le_u32 vcc, 6432, v39
s_nop 1
v_cndmask_b32 v119, v119, v244, vcc
v_cndmask_b32 v159, v159, v245, vcc
v_cmp_le_u32 vcc, 7344, v39
s_nop 1
v_cndmask_b32 v119, v119, v246, vcc
v_cndmask_b32 v159, v159, v247, vcc
v_mad_u32_u24 v119, v119, v39, v159
v_lshrrev_b32 v119, 20, v119
v_lshl_add_u32 v159, v119, 2, s11
ds_add_rtn_u32 v159, v159, v7
s_waitcnt vmcnt(13)
v_cmp_le_u32 vcc, 5436, v40
s_nop 1
v_cndmask_b32 v120, v240, v242, vcc
v_cndmask_b32 v160, v241, v243, vcc
v_cmp_le_u32 vcc, 6432, v40
s_nop 1
v_cndmask_b32 v120, v120, v244, vcc
v_cndmask_b32 v160, v160, v245, vcc
v_cmp_le_u32 vcc, 7344, v40
s_nop 1
v_cndmask_b32 v120, v120, v246, vcc
v_cndmask_b32 v160, v160, v247, vcc
v_mad_u32_u24 v120, v120, v40, v160
v_lshrrev_b32 v120, 20, v120
v_lshl_add_u32 v160, v120, 2, s11
ds_add_rtn_u32 v160, v160, v7
v_cmp_le_u32 vcc, 5436, v41
s_nop 1
v_cndmask_b32 v121, v240, v242, vcc
v_cndmask_b32 v161, v241, v243, vcc
v_cmp_le_u32 vcc, 6432, v41
s_nop 1
v_cndmask_b32 v121, v121, v244, vcc
v_cndmask_b32 v161, v161, v245, vcc
v_cmp_le_u32 vcc, 7344, v41
s_nop 1
v_cndmask_b32 v121, v121, v246, vcc
v_cndmask_b32 v161, v161, v247, vcc
v_mad_u32_u24 v121, v121, v41, v161
v_lshrrev_b32 v121, 20, v121
v_lshl_add_u32 v161, v121, 2, s11
ds_add_rtn_u32 v161, v161, v7
v_cmp_le_u32 vcc, 5436, v42
s_nop 1
v_cndmask_b32 v122, v240, v242, vcc
v_cndmask_b32 v162, v241, v243, vcc
v_cmp_le_u32 vcc, 6432, v42
s_nop 1
v_cndmask_b32 v122, v122, v244, vcc
v_cndmask_b32 v162, v162, v245, vcc
v_cmp_le_u32 vcc, 7344, v42
s_nop 1
v_cndmask_b32 v122, v122, v246, vcc
v_cndmask_b32 v162, v162, v247, vcc
v_mad_u32_u24 v122, v122, v42, v162
v_lshrrev_b32 v122, 20, v122
v_lshl_add_u32 v162, v122, 2, s11
ds_add_rtn_u32 v162, v162, v7
v_cmp_le_u32 vcc, 5436, v43
s_nop 1
v_cndmask_b32 v123, v240, v242, vcc
v_cndmask_b32 v163, v241, v243, vcc
v_cmp_le_u32 vcc, 6432, v43
s_nop 1
v_cndmask_b32 v123, v123, v244, vcc
v_cndmask_b32 v163, v163, v245, vcc
v_cmp_le_u32 vcc, 7344, v43
s_nop 1
v_cndmask_b32 v123, v123, v246, vcc
v_cndmask_b32 v163, v163, v247, vcc
v_mad_u32_u24 v123, v123, v43, v163
v_lshrrev_b32 v123, 20, v123
v_lshl_add_u32 v163, v123, 2, s11
ds_add_rtn_u32 v163, v163, v7
s_waitcnt vmcnt(12)
v_cmp_le_u32 vcc, 5436, v44
s_nop 1
v_cndmask_b32 v124, v240, v242, vcc
v_cndmask_b32 v164, v241, v243, vcc
v_cmp_le_u32 vcc, 6432, v44
s_nop 1
v_cndmask_b32 v124, v124, v244, vcc
v_cndmask_b32 v164, v164, v245, vcc
v_cmp_le_u32 vcc, 7344, v44
s_nop 1
v_cndmask_b32 v124, v124, v246, vcc
v_cndmask_b32 v164, v164, v247, vcc
v_mad_u32_u24 v124, v124, v44, v164
v_lshrrev_b32 v124, 20, v124
v_lshl_add_u32 v164, v124, 2, s11
ds_add_rtn_u32 v164, v164, v7
v_cmp_le_u32 vcc, 5436, v45
s_nop 1
v_cndmask_b32 v125, v240, v242, vcc
v_cndmask_b32 v165, v241, v243, vcc
v_cmp_le_u32 vcc, 6432, v45
s_nop 1
v_cndmask_b32 v125, v125, v244, vcc
v_cndmask_b32 v165, v165, v245, vcc
v_cmp_le_u32 vcc, 7344, v45
s_nop 1
v_cndmask_b32 v125, v125, v246, vcc
v_cndmask_b32 v165, v165, v247, vcc
v_mad_u32_u24 v125, v125, v45, v165
v_lshrrev_b32 v125, 20, v125
v_lshl_add_u32 v165, v125, 2, s11
ds_add_rtn_u32 v165, v165, v7
v_cmp_le_u32 vcc, 5436, v46
s_nop 1
v_cndmask_b32 v126, v240, v242, vcc
v_cndmask_b32 v166, v241, v243, vcc
v_cmp_le_u32 vcc, 6432, v46
s_nop 1
v_cndmask_b32 v126, v126, v244, vcc
v_cndmask_b32 v166, v166, v245, vcc
v_cmp_le_u32 vcc, 7344, v46
s_nop 1
v_cndmask_b32 v126, v126, v246, vcc
v_cndmask_b32 v166, v166, v247, vcc
v_mad_u32_u24 v126, v126, v46, v166
v_lshrrev_b32 v126, 20, v126
v_lshl_add_u32 v166, v126, 2, s11
ds_add_rtn_u32 v166, v166, v7
v_cmp_le_u32 vcc, 5436, v47
s_nop 1
v_cndmask_b32 v127, v240, v242, vcc
v_cndmask_b32 v167, v241, v243, vcc
v_cmp_le_u32 vcc, 6432, v47
s_nop 1
v_cndmask_b32 v127, v127, v244, vcc
v_cndmask_b32 v167, v167, v245, vcc
v_cmp_le_u32 vcc, 7344, v47
s_nop 1
v_cndmask_b32 v127, v127, v246, vcc
v_cndmask_b32 v167, v167, v247, vcc
v_mad_u32_u24 v127, v127, v47, v167
v_lshrrev_b32 v127, 20, v127
v_lshl_add_u32 v167, v127, 2, s11
ds_add_rtn_u32 v167, v167, v7
s_waitcnt vmcnt(11)
v_cmp_le_u32 vcc, 5436, v48
s_nop 1
v_cndmask_b32 v128, v240, v242, vcc
v_cndmask_b32 v168, v241, v243, vcc
v_cmp_le_u32 vcc, 6432, v48
s_nop 1
v_cndmask_b32 v128, v128, v244, vcc
v_cndmask_b32 v168, v168, v245, vcc
v_cmp_le_u32 vcc, 7344, v48
s_nop 1
v_cndmask_b32 v128, v128, v246, vcc
v_cndmask_b32 v168, v168, v247, vcc
v_mad_u32_u24 v128, v128, v48, v168
v_lshrrev_b32 v128, 20, v128
v_lshl_add_u32 v168, v128, 2, s11
ds_add_rtn_u32 v168, v168, v7
v_cmp_le_u32 vcc, 5436, v49
s_nop 1
v_cndmask_b32 v129, v240, v242, vcc
v_cndmask_b32 v169, v241, v243, vcc
v_cmp_le_u32 vcc, 6432, v49
s_nop 1
v_cndmask_b32 v129, v129, v244, vcc
v_cndmask_b32 v169, v169, v245, vcc
v_cmp_le_u32 vcc, 7344, v49
s_nop 1
v_cndmask_b32 v129, v129, v246, vcc
v_cndmask_b32 v169, v169, v247, vcc
v_mad_u32_u24 v129, v129, v49, v169
v_lshrrev_b32 v129, 20, v129
v_lshl_add_u32 v169, v129, 2, s11
ds_add_rtn_u32 v169, v169, v7
v_cmp_le_u32 vcc, 5436, v50
s_nop 1
v_cndmask_b32 v130, v240, v242, vcc
v_cndmask_b32 v170, v241, v243, vcc
v_cmp_le_u32 vcc, 6432, v50
s_nop 1
v_cndmask_b32 v130, v130, v244, vcc
v_cndmask_b32 v170, v170, v245, vcc
v_cmp_le_u32 vcc, 7344, v50
s_nop 1
v_cndmask_b32 v130, v130, v246, vcc
v_cndmask_b32 v170, v170, v247, vcc
v_mad_u32_u24 v130, v130, v50, v170
v_lshrrev_b32 v130, 20, v130
v_lshl_add_u32 v170, v130, 2, s11
ds_add_rtn_u32 v170, v170, v7
v_cmp_le_u32 vcc, 5436, v51
s_nop 1
v_cndmask_b32 v131, v240, v242, vcc
v_cndmask_b32 v171, v241, v243, vcc
v_cmp_le_u32 vcc, 6432, v51
s_nop 1
v_cndmask_b32 v131, v131, v244, vcc
v_cndmask_b32 v171, v171, v245, vcc
v_cmp_le_u32 vcc, 7344, v51
s_nop 1
v_cndmask_b32 v131, v131, v246, vcc
v_cndmask_b32 v171, v171, v247, vcc
v_mad_u32_u24 v131, v131, v51, v171
v_lshrrev_b32 v131, 20, v131
v_lshl_add_u32 v171, v131, 2, s11
ds_add_rtn_u32 v171, v171, v7
s_waitcnt vmcnt(10)
s_mov_b64 exec, s[12:13]
v_cmp_le_u32 vcc, 5436, v52
s_nop 1
v_cndmask_b32 v132, v240, v242, vcc
v_cndmask_b32 v172, v241, v243, vcc
v_cmp_le_u32 vcc, 6432, v52
s_nop 1
v_cndmask_b32 v132, v132, v244, vcc
v_cndmask_b32 v172, v172, v245, vcc
v_cmp_le_u32 vcc, 7344, v52
s_nop 1
v_cndmask_b32 v132, v132, v246, vcc
v_cndmask_b32 v172, v172, v247, vcc
v_mad_u32_u24 v132, v132, v52, v172
v_lshrrev_b32 v132, 20, v132
v_lshl_add_u32 v172, v132, 2, s11
ds_add_rtn_u32 v172, v172, v7
v_cmp_le_u32 vcc, 5436, v53
s_nop 1
v_cndmask_b32 v133, v240, v242, vcc
v_cndmask_b32 v173, v241, v243, vcc
v_cmp_le_u32 vcc, 6432, v53
s_nop 1
v_cndmask_b32 v133, v133, v244, vcc
v_cndmask_b32 v173, v173, v245, vcc
v_cmp_le_u32 vcc, 7344, v53
s_nop 1
v_cndmask_b32 v133, v133, v246, vcc
v_cndmask_b32 v173, v173, v247, vcc
v_mad_u32_u24 v133, v133, v53, v173
v_lshrrev_b32 v133, 20, v133
v_lshl_add_u32 v173, v133, 2, s11
ds_add_rtn_u32 v173, v173, v7
v_cmp_le_u32 vcc, 5436, v54
s_nop 1
v_cndmask_b32 v134, v240, v242, vcc
v_cndmask_b32 v174, v241, v243, vcc
v_cmp_le_u32 vcc, 6432, v54
s_nop 1
v_cndmask_b32 v134, v134, v244, vcc
v_cndmask_b32 v174, v174, v245, vcc
v_cmp_le_u32 vcc, 7344, v54
s_nop 1
v_cndmask_b32 v134, v134, v246, vcc
v_cndmask_b32 v174, v174, v247, vcc
v_mad_u32_u24 v134, v134, v54, v174
v_lshrrev_b32 v134, 20, v134
v_lshl_add_u32 v174, v134, 2, s11
ds_add_rtn_u32 v174, v174, v7
v_cmp_le_u32 vcc, 5436, v55
s_nop 1
v_cndmask_b32 v135, v240, v242, vcc
v_cndmask_b32 v175, v241, v243, vcc
v_cmp_le_u32 vcc, 6432, v55
s_nop 1
v_cndmask_b32 v135, v135, v244, vcc
v_cndmask_b32 v175, v175, v245, vcc
v_cmp_le_u32 vcc, 7344, v55
s_nop 1
v_cndmask_b32 v135, v135, v246, vcc
v_cndmask_b32 v175, v175, v247, vcc
v_mad_u32_u24 v135, v135, v55, v175
v_lshrrev_b32 v135, 20, v135
v_lshl_add_u32 v175, v135, 2, s11
ds_add_rtn_u32 v175, v175, v7
s_mov_b64 exec, -1
s_waitcnt vmcnt(9) lgkmcnt(15)
v_and_b32 v8, 0xff, v136
v_lshl_or_b32 v56, v16, 18, v56
v_lshlrev_b32 v8, 2, v8
v_lshl_add_u32 v8, v96, 10, v8
ds_write_b32 v8, v56
v_and_b32 v8, 0xff, v137
v_lshl_or_b32 v57, v17, 18, v57
v_lshlrev_b32 v8, 2, v8
v_lshl_add_u32 v8, v97, 10, v8
ds_write_b32 v8, v57
v_and_b32 v8, 0xff, v138
v_lshl_or_b32 v58, v18, 18, v58
v_lshlrev_b32 v8, 2, v8
v_lshl_add_u32 v8, v98, 10, v8
ds_write_b32 v8, v58
v_and_b32 v8, 0xff, v139
v_lshl_or_b32 v59, v19, 18, v59
v_lshlrev_b32 v8, 2, v8
v_lshl_add_u32 v8, v99, 10, v8
ds_write_b32 v8, v59
s_waitcnt vmcnt(8) lgkmcnt(15)
v_and_b32 v8, 0xff, v140
v_lshl_or_b32 v60, v20, 18, v60
v_lshlrev_b32 v8, 2, v8
v_lshl_add_u32 v8, v100, 10, v8
ds_write_b32 v8, v60
v_and_b32 v8, 0xff, v141
v_lshl_or_b32 v61, v21, 18, v61
v_lshlrev_b32 v8, 2, v8
v_lshl_add_u32 v8, v101, 10, v8
ds_write_b32 v8, v61
v_and_b32 v8, 0xff, v142
v_lshl_or_b32 v62, v22, 18, v62
v_lshlrev_b32 v8, 2, v8
v_lshl_add_u32 v8, v102, 10, v8
ds_write_b32 v8, v62
v_and_b32 v8, 0xff, v143
v_lshl_or_b32 v63, v23, 18, v63
v_lshlrev_b32 v8, 2, v8
v_lshl_add_u32 v8, v103, 10, v8
ds_write_b32 v8, v63
s_waitcnt vmcnt(7) lgkmcnt(15)
v_and_b32 v8, 0xff, v144
v_lshl_or_b32 v64, v24, 18, v64
v_lshlrev_b32 v8, 2, v8
v_lshl_add_u32 v8, v104, 10, v8
ds_write_b32 v8, v64
v_and_b32 v8, 0xff, v145
v_lshl_or_b32 v65, v25, 18, v65
v_lshlrev_b32 v8, 2, v8
v_lshl_add_u32 v8, v105, 10, v8
ds_write_b32 v8, v65
v_and_b32 v8, 0xff, v146
v_lshl_or_b32 v66, v26, 18, v66
v_lshlrev_b32 v8, 2, v8
v_lshl_add_u32 v8, v106, 10, v8
ds_write_b32 v8, v66
v_and_b32 v8, 0xff, v147
v_lshl_or_b32 v67, v27, 18, v67
v_lshlrev_b32 v8, 2, v8
v_lshl_add_u32 v8, v107, 10, v8
ds_write_b32 v8, v67
s_waitcnt vmcnt(6) lgkmcnt(15)
v_and_b32 v8, 0xff, v148
v_lshl_or_b32 v68, v28, 18, v68
v_lshlrev_b32 v8, 2, v8
v_lshl_add_u32 v8, v108, 10, v8
ds_write_b32 v8, v68
v_and_b32 v8, 0xff, v149
v_lshl_or_b32 v69, v29, 18, v69
v_lshlrev_b32 v8, 2, v8
v_lshl_add_u32 v8, v109, 10, v8
ds_write_b32 v8, v69
v_and_b32 v8, 0xff, v150
v_lshl_or_b32 v70, v30, 18, v70
v_lshlrev_b32 v8, 2, v8
v_lshl_add_u32 v8, v110, 10, v8
ds_write_b32 v8, v70
v_and_b32 v8, 0xff, v151
v_lshl_or_b32 v71, v31, 18, v71
v_lshlrev_b32 v8, 2, v8
v_lshl_add_u32 v8, v111, 10, v8
ds_write_b32 v8, v71
s_waitcnt vmcnt(5) lgkmcnt(15)
v_and_b32 v8, 0xff, v152
v_lshl_or_b32 v72, v32, 18, v72
v_lshlrev_b32 v8, 2, v8
v_lshl_add_u32 v8, v112, 10, v8
ds_write_b32 v8, v72
v_and_b32 v8, 0xff, v153
v_lshl_or_b32 v73, v33, 18, v73
v_lshlrev_b32 v8, 2, v8
v_lshl_add_u32 v8, v113, 10, v8
ds_write_b32 v8, v73
v_and_b32 v8, 0xff, v154
v_lshl_or_b32 v74, v34, 18, v74
v_lshlrev_b32 v8, 2, v8
v_lshl_add_u32 v8, v114, 10, v8
ds_write_b32 v8, v74
v_and_b32 v8, 0xff, v155
v_lshl_or_b32 v75, v35, 18, v75
v_lshlrev_b32 v8, 2, v8
v_lshl_add_u32 v8, v115, 10, v8
ds_write_b32 v8, v75
s_waitcnt vmcnt(4) lgkmcnt(15)
v_and_b32 v8, 0xff, v156
v_lshl_or_b32 v76, v36, 18, v76
v_lshlrev_b32 v8, 2, v8
v_lshl_add_u32 v8, v116, 10, v8
ds_write_b32 v8, v76
v_and_b32 v8, 0xff, v157
v_lshl_or_b32 v77, v37, 18, v77
v_lshlrev_b32 v8, 2, v8
v_lshl_add_u32 v8, v117, 10, v8
ds_write_b32 v8, v77
v_and_b32 v8, 0xff, v158
v_lshl_or_b32 v78, v38, 18, v78
v_lshlrev_b32 v8, 2, v8
v_lshl_add_u32 v8, v118, 10, v8
ds_write_b32 v8, v78
v_and_b32 v8, 0xff, v159
v_lshl_or_b32 v79, v39, 18, v79
v_lshlrev_b32 v8, 2, v8
v_lshl_add_u32 v8, v119, 10, v8
ds_write_b32 v8, v79
s_waitcnt vmcnt(3) lgkmcnt(15)
v_and_b32 v8, 0xff, v160
v_lshl_or_b32 v80, v40, 18, v80
v_lshlrev_b32 v8, 2, v8
v_lshl_add_u32 v8, v120, 10, v8
ds_write_b32 v8, v80
v_and_b32 v8, 0xff, v161
v_lshl_or_b32 v81, v41, 18, v81
v_lshlrev_b32 v8, 2, v8
v_lshl_add_u32 v8, v121, 10, v8
ds_write_b32 v8, v81
v_and_b32 v8, 0xff, v162
v_lshl_or_b32 v82, v42, 18, v82
v_lshlrev_b32 v8, 2, v8
v_lshl_add_u32 v8, v122, 10, v8
ds_write_b32 v8, v82
v_and_b32 v8, 0xff, v163
v_lshl_or_b32 v83, v43, 18, v83
v_lshlrev_b32 v8, 2, v8
v_lshl_add_u32 v8, v123, 10, v8
ds_write_b32 v8, v83
s_waitcnt vmcnt(2) lgkmcnt(15)
v_and_b32 v8, 0xff, v164
v_lshl_or_b32 v84, v44, 18, v84
v_lshlrev_b32 v8, 2, v8
v_lshl_add_u32 v8, v124, 10, v8
ds_write_b32 v8, v84
v_and_b32 v8, 0xff, v165
v_lshl_or_b32 v85, v45, 18, v85
v_lshlrev_b32 v8, 2, v8
v_lshl_add_u32 v8, v125, 10, v8
ds_write_b32 v8, v85
v_and_b32 v8, 0xff, v166
v_lshl_or_b32 v86, v46, 18, v86
v_lshlrev_b32 v8, 2, v8
v_lshl_add_u32 v8, v126, 10, v8
ds_write_b32 v8, v86
v_and_b32 v8, 0xff, v167
v_lshl_or_b32 v87, v47, 18, v87
v_lshlrev_b32 v8, 2, v8
v_lshl_add_u32 v8, v127, 10, v8
ds_write_b32 v8, v87
s_waitcnt vmcnt(1) lgkmcnt(15)
v_and_b32 v8, 0xff, v168
v_lshl_or_b32 v88, v48, 18, v88
v_lshlrev_b32 v8, 2, v8
v_lshl_add_u32 v8, v128, 10, v8
ds_write_b32 v8, v88
v_and_b32 v8, 0xff, v169
v_lshl_or_b32 v89, v49, 18, v89
v_lshlrev_b32 v8, 2, v8
v_lshl_add_u32 v8, v129, 10, v8
ds_write_b32 v8, v89
v_and_b32 v8, 0xff, v170
v_lshl_or_b32 v90, v50, 18, v90
v_lshlrev_b32 v8, 2, v8
v_lshl_add_u32 v8, v130, 10, v8
ds_write_b32 v8, v90
v_and_b32 v8, 0xff, v171
v_lshl_or_b32 v91, v51, 18, v91
v_lshlrev_b32 v8, 2, v8
v_lshl_add_u32 v8, v131, 10, v8
ds_write_b32 v8, v91
s_waitcnt vmcnt(0) lgkmcnt(15)
s_mov_b64 exec, s[12:13]
v_and_b32 v8, 0xff, v172
v_lshl_or_b32 v92, v52, 18, v92
v_lshlrev_b32 v8, 2, v8
v_lshl_add_u32 v8, v132, 10, v8
ds_write_b32 v8, v92
v_and_b32 v8, 0xff, v173
v_lshl_or_b32 v93, v53, 18, v93
v_lshlrev_b32 v8, 2, v8
v_lshl_add_u32 v8, v133, 10, v8
ds_write_b32 v8, v93
v_and_b32 v8, 0xff, v174
v_lshl_or_b32 v94, v54, 18, v94
v_lshlrev_b32 v8, 2, v8
v_lshl_add_u32 v8, v134, 10, v8
ds_write_b32 v8, v94
v_and_b32 v8, 0xff, v175
v_lshl_or_b32 v95, v55, 18, v95
v_lshlrev_b32 v8, 2, v8
v_lshl_add_u32 v8, v135, 10, v8
ds_write_b32 v8, v95
s_mov_b64 exec, -1
s_waitcnt lgkmcnt(0)
s_barrier
ds_read_b32 v8, v6
s_mul_i32 s6, s60, 16384
v_lshlrev_b32 v10, 4, v2
v_add_u32 v9, s6, v10
ds_read_b128 v[176:179], v9 offset:0
ds_read_b128 v[180:183], v9 offset:1024
ds_read_b128 v[184:187], v9 offset:2048
ds_read_b128 v[188:191], v9 offset:3072
ds_read_b128 v[192:195], v9 offset:4096
ds_read_b128 v[196:199], v9 offset:5120
ds_read_b128 v[200:203], v9 offset:6144
ds_read_b128 v[204:207], v9 offset:7168
ds_read_b128 v[208:211], v9 offset:8192
ds_read_b128 v[212:215], v9 offset:9216
ds_read_b128 v[216:219], v9 offset:10240
ds_read_b128 v[220:223], v9 offset:11264
ds_read_b128 v[224:227], v9 offset:12288
ds_read_b128 v[228:231], v9 offset:13312
ds_read_b128 v[232:235], v9 offset:14336
ds_read_b128 v[236:239], v9 offset:15360
s_mul_i32 s6, s60, 262144
s_mul_i32 s7, s4, 1024
s_add_u32 s6, s6, s7
v_lshlrev_b32 v9, 2, v2
s_lshl_b32 s8, s4, 8
s_cmp_eq_u32 s60, 0
s_cselect_b32 s8, s8, 0x7fff0000
s_waitcnt lgkmcnt(15)
buffer_store_dword v8, v9, s[52:55], s8 offen sc1
v_cmp_lt_u32 vcc, 0x100, v8
s_cbranch_vccnz L1_eslow
s_waitcnt lgkmcnt(15)
buffer_store_dwordx4 v[176:179], v10, s[48:51], s6 offen sc1
s_add_u32 s6, s6, 16384
s_waitcnt lgkmcnt(14)
buffer_store_dwordx4 v[180:183], v10, s[48:51], s6 offen sc1
s_add_u32 s6, s6, 16384
s_waitcnt lgkmcnt(13)
buffer_store_dwordx4 v[184:187], v10, s[48:51], s6 offen sc1
s_add_u32 s6, s6, 16384
s_waitcnt lgkmcnt(12)
buffer_store_dwordx4 v[188:191], v10, s[48:51], s6 offen sc1
s_add_u32 s6, s6, 16384
s_waitcnt lgkmcnt(11)
buffer_store_dwordx4 v[192:195], v10, s[48:51], s6 offen sc1
s_add_u32 s6, s6, 16384
s_waitcnt lgkmcnt(10)
buffer_store_dwordx4 v[196:199], v10, s[48:51], s6 offen sc1
s_add_u32 s6, s6, 16384
s_waitcnt lgkmcnt(9)
buffer_store_dwordx4 v[200:203], v10, s[48:51], s6 offen sc1
s_add_u32 s6, s6, 16384
s_waitcnt lgkmcnt(8)
buffer_store_dwordx4 v[204:207], v10, s[48:51], s6 offen sc1
s_add_u32 s6, s6, 16384
s_waitcnt lgkmcnt(7)
buffer_store_dwordx4 v[208:211], v10, s[48:51], s6 offen sc1
s_add_u32 s6, s6, 16384
s_waitcnt lgkmcnt(6)
buffer_store_dwordx4 v[212:215], v10, s[48:51], s6 offen sc1
s_add_u32 s6, s6, 16384
s_waitcnt lgkmcnt(5)
buffer_store_dwordx4 v[216:219], v10, s[48:51], s6 offen sc1
s_add_u32 s6, s6, 16384
s_waitcnt lgkmcnt(4)
buffer_store_dwordx4 v[220:223], v10, s[48:51], s6 offen sc1
s_add_u32 s6, s6, 16384
s_waitcnt lgkmcnt(3)
buffer_store_dwordx4 v[224:227], v10, s[48:51], s6 offen sc1
s_add_u32 s6, s6, 16384
s_waitcnt lgkmcnt(2)
buffer_store_dwordx4 v[228:231], v10, s[48:51], s6 offen sc1
s_add_u32 s6, s6, 16384
s_waitcnt lgkmcnt(1)
buffer_store_dwordx4 v[232:235], v10, s[48:51], s6 offen sc1
s_add_u32 s6, s6, 16384
s_waitcnt lgkmcnt(0)
buffer_store_dwordx4 v[236:239], v10, s[48:51], s6 offen sc1
s_add_u32 s6, s6, 16384
s_branch L1_fin
L1_eslow:
s_mov_b32 s9, 16384
v_mul_u32_u24 v96, s9, v96
v_and_b32 v8, 255, v136
v_lshl_add_u32 v96, v8, 2, v96
v_lshrrev_b32 v8, 8, v136
v_lshl_add_u32 v96, v8, 20, v96
v_mul_u32_u24 v97, s9, v97
v_and_b32 v8, 255, v137
v_lshl_add_u32 v97, v8, 2, v97
v_lshrrev_b32 v8, 8, v137
v_lshl_add_u32 v97, v8, 20, v97
v_mul_u32_u24 v98, s9, v98
v_and_b32 v8, 255, v138
v_lshl_add_u32 v98, v8, 2, v98
v_lshrrev_b32 v8, 8, v138
v_lshl_add_u32 v98, v8, 20, v98
v_mul_u32_u24 v99, s9, v99
v_and_b32 v8, 255, v139
v_lshl_add_u32 v99, v8, 2, v99
v_lshrrev_b32 v8, 8, v139
v_lshl_add_u32 v99, v8, 20, v99
v_mul_u32_u24 v100, s9, v100
v_and_b32 v8, 255, v140
v_lshl_add_u32 v100, v8, 2, v100
v_lshrrev_b32 v8, 8, v140
v_lshl_add_u32 v100, v8, 20, v100
v_mul_u32_u24 v101, s9, v101
v_and_b32 v8, 255, v141
v_lshl_add_u32 v101, v8, 2, v101
v_lshrrev_b32 v8, 8, v141
v_lshl_add_u32 v101, v8, 20, v101
v_mul_u32_u24 v102, s9, v102
v_and_b32 v8, 255, v142
v_lshl_add_u32 v102, v8, 2, v102
v_lshrrev_b32 v8, 8, v142
v_lshl_add_u32 v102, v8, 20, v102
v_mul_u32_u24 v103, s9, v103
v_and_b32 v8, 255, v143
v_lshl_add_u32 v103, v8, 2, v103
v_lshrrev_b32 v8, 8, v143
v_lshl_add_u32 v103, v8, 20, v103
v_mul_u32_u24 v104, s9, v104
v_and_b32 v8, 255, v144
v_lshl_add_u32 v104, v8, 2, v104
v_lshrrev_b32 v8, 8, v144
v_lshl_add_u32 v104, v8, 20, v104
v_mul_u32_u24 v105, s9, v105
v_and_b32 v8, 255, v145
v_lshl_add_u32 v105, v8, 2, v105
v_lshrrev_b32 v8, 8, v145
v_lshl_add_u32 v105, v8, 20, v105
v_mul_u32_u24 v106, s9, v106
v_and_b32 v8, 255, v146
v_lshl_add_u32 v106, v8, 2, v106
v_lshrrev_b32 v8, 8, v146
v_lshl_add_u32 v106, v8, 20, v106
v_mul_u32_u24 v107, s9, v107
v_and_b32 v8, 255, v147
v_lshl_add_u32 v107, v8, 2, v107
v_lshrrev_b32 v8, 8, v147
v_lshl_add_u32 v107, v8, 20, v107
v_mul_u32_u24 v108, s9, v108
v_and_b32 v8, 255, v148
v_lshl_add_u32 v108, v8, 2, v108
v_lshrrev_b32 v8, 8, v148
v_lshl_add_u32 v108, v8, 20, v108
v_mul_u32_u24 v109, s9, v109
v_and_b32 v8, 255, v149
v_lshl_add_u32 v109, v8, 2, v109
v_lshrrev_b32 v8, 8, v149
v_lshl_add_u32 v109, v8, 20, v109
v_mul_u32_u24 v110, s9, v110
v_and_b32 v8, 255, v150
v_lshl_add_u32 v110, v8, 2, v110
v_lshrrev_b32 v8, 8, v150
v_lshl_add_u32 v110, v8, 20, v110
v_mul_u32_u24 v111, s9, v111
v_and_b32 v8, 255, v151
v_lshl_add_u32 v111, v8, 2, v111
v_lshrrev_b32 v8, 8, v151
v_lshl_add_u32 v111, v8, 20, v111
v_mul_u32_u24 v112, s9, v112
v_and_b32 v8, 255, v152
v_lshl_add_u32 v112, v8, 2, v112
v_lshrrev_b32 v8, 8, v152
v_lshl_add_u32 v112, v8, 20, v112
v_mul_u32_u24 v113, s9, v113
v_and_b32 v8, 255, v153
v_lshl_add_u32 v113, v8, 2, v113
v_lshrrev_b32 v8, 8, v153
v_lshl_add_u32 v113, v8, 20, v113
v_mul_u32_u24 v114, s9, v114
v_and_b32 v8, 255, v154
v_lshl_add_u32 v114, v8, 2, v114
v_lshrrev_b32 v8, 8, v154
v_lshl_add_u32 v114, v8, 20, v114
v_mul_u32_u24 v115, s9, v115
v_and_b32 v8, 255, v155
v_lshl_add_u32 v115, v8, 2, v115
v_lshrrev_b32 v8, 8, v155
v_lshl_add_u32 v115, v8, 20, v115
v_mul_u32_u24 v116, s9, v116
v_and_b32 v8, 255, v156
v_lshl_add_u32 v116, v8, 2, v116
v_lshrrev_b32 v8, 8, v156
v_lshl_add_u32 v116, v8, 20, v116
v_mul_u32_u24 v117, s9, v117
v_and_b32 v8, 255, v157
v_lshl_add_u32 v117, v8, 2, v117
v_lshrrev_b32 v8, 8, v157
v_lshl_add_u32 v117, v8, 20, v117
v_mul_u32_u24 v118, s9, v118
v_and_b32 v8, 255, v158
v_lshl_add_u32 v118, v8, 2, v118
v_lshrrev_b32 v8, 8, v158
v_lshl_add_u32 v118, v8, 20, v118
v_mul_u32_u24 v119, s9, v119
v_and_b32 v8, 255, v159
v_lshl_add_u32 v119, v8, 2, v119
v_lshrrev_b32 v8, 8, v159
v_lshl_add_u32 v119, v8, 20, v119
v_mul_u32_u24 v120, s9, v120
v_and_b32 v8, 255, v160
v_lshl_add_u32 v120, v8, 2, v120
v_lshrrev_b32 v8, 8, v160
v_lshl_add_u32 v120, v8, 20, v120
v_mul_u32_u24 v121, s9, v121
v_and_b32 v8, 255, v161
v_lshl_add_u32 v121, v8, 2, v121
v_lshrrev_b32 v8, 8, v161
v_lshl_add_u32 v121, v8, 20, v121
v_mul_u32_u24 v122, s9, v122
v_and_b32 v8, 255, v162
v_lshl_add_u32 v122, v8, 2, v122
v_lshrrev_b32 v8, 8, v162
v_lshl_add_u32 v122, v8, 20, v122
v_mul_u32_u24 v123, s9, v123
v_and_b32 v8, 255, v163
v_lshl_add_u32 v123, v8, 2, v123
v_lshrrev_b32 v8, 8, v163
v_lshl_add_u32 v123, v8, 20, v123
v_mul_u32_u24 v124, s9, v124
v_and_b32 v8, 255, v164
v_lshl_add_u32 v124, v8, 2, v124
v_lshrrev_b32 v8, 8, v164
v_lshl_add_u32 v124, v8, 20, v124
v_mul_u32_u24 v125, s9, v125
v_and_b32 v8, 255, v165
v_lshl_add_u32 v125, v8, 2, v125
v_lshrrev_b32 v8, 8, v165
v_lshl_add_u32 v125, v8, 20, v125
v_mul_u32_u24 v126, s9, v126
v_and_b32 v8, 255, v166
v_lshl_add_u32 v126, v8, 2, v126
v_lshrrev_b32 v8, 8, v166
v_lshl_add_u32 v126, v8, 20, v126
v_mul_u32_u24 v127, s9, v127
v_and_b32 v8, 255, v167
v_lshl_add_u32 v127, v8, 2, v127
v_lshrrev_b32 v8, 8, v167
v_lshl_add_u32 v127, v8, 20, v127
v_mul_u32_u24 v128, s9, v128
v_and_b32 v8, 255, v168
v_lshl_add_u32 v128, v8, 2, v128
v_lshrrev_b32 v8, 8, v168
v_lshl_add_u32 v128, v8, 20, v128
v_mul_u32_u24 v129, s9, v129
v_and_b32 v8, 255, v169
v_lshl_add_u32 v129, v8, 2, v129
v_lshrrev_b32 v8, 8, v169
v_lshl_add_u32 v129, v8, 20, v129
v_mul_u32_u24 v130, s9, v130
v_and_b32 v8, 255, v170
v_lshl_add_u32 v130, v8, 2, v130
v_lshrrev_b32 v8, 8, v170
v_lshl_add_u32 v130, v8, 20, v130
v_mul_u32_u24 v131, s9, v131
v_and_b32 v8, 255, v171
v_lshl_add_u32 v131, v8, 2, v131
v_lshrrev_b32 v8, 8, v171
v_lshl_add_u32 v131, v8, 20, v131
v_mul_u32_u24 v132, s9, v132
v_and_b32 v8, 255, v172
v_lshl_add_u32 v132, v8, 2, v132
v_lshrrev_b32 v8, 8, v172
v_lshl_add_u32 v132, v8, 20, v132
v_mul_u32_u24 v133, s9, v133
v_and_b32 v8, 255, v173
v_lshl_add_u32 v133, v8, 2, v133
v_lshrrev_b32 v8, 8, v173
v_lshl_add_u32 v133, v8, 20, v133
v_mul_u32_u24 v134, s9, v134
v_and_b32 v8, 255, v174
v_lshl_add_u32 v134, v8, 2, v134
v_lshrrev_b32 v8, 8, v174
v_lshl_add_u32 v134, v8, 20, v134
v_mul_u32_u24 v135, s9, v135
v_and_b32 v8, 255, v175
v_lshl_add_u32 v135, v8, 2, v135
v_lshrrev_b32 v8, 8, v175
v_lshl_add_u32 v135, v8, 20, v135
buffer_store_dword v56, v96, s[48:51], s7 offen sc1
buffer_store_dword v57, v97, s[48:51], s7 offen sc1
buffer_store_dword v58, v98, s[48:51], s7 offen sc1
buffer_store_dword v59, v99, s[48:51], s7 offen sc1
buffer_store_dword v60, v100, s[48:51], s7 offen sc1
buffer_store_dword v61, v101, s[48:51], s7 offen sc1
buffer_store_dword v62, v102, s[48:51], s7 offen sc1
buffer_store_dword v63, v103, s[48:51], s7 offen sc1
buffer_store_dword v64, v104, s[48:51], s7 offen sc1
buffer_store_dword v65, v105, s[48:51], s7 offen sc1
buffer_store_dword v66, v106, s[48:51], s7 offen sc1
buffer_store_dword v67, v107, s[48:51], s7 offen sc1
buffer_store_dword v68, v108, s[48:51], s7 offen sc1
buffer_store_dword v69, v109, s[48:51], s7 offen sc1
buffer_store_dword v70, v110, s[48:51], s7 offen sc1
buffer_store_dword v71, v111, s[48:51], s7 offen sc1
buffer_store_dword v72, v112, s[48:51], s7 offen sc1
buffer_store_dword v73, v113, s[48:51], s7 offen sc1
buffer_store_dword v74, v114, s[48:51], s7 offen sc1
buffer_store_dword v75, v115, s[48:51], s7 offen sc1
buffer_store_dword v76, v116, s[48:51], s7 offen sc1
buffer_store_dword v77, v117, s[48:51], s7 offen sc1
buffer_store_dword v78, v118, s[48:51], s7 offen sc1
buffer_store_dword v79, v119, s[48:51], s7 offen sc1
buffer_store_dword v80, v120, s[48:51], s7 offen sc1
buffer_store_dword v81, v121, s[48:51], s7 offen sc1
buffer_store_dword v82, v122, s[48:51], s7 offen sc1
buffer_store_dword v83, v123, s[48:51], s7 offen sc1
buffer_store_dword v84, v124, s[48:51], s7 offen sc1
buffer_store_dword v85, v125, s[48:51], s7 offen sc1
buffer_store_dword v86, v126, s[48:51], s7 offen sc1
buffer_store_dword v87, v127, s[48:51], s7 offen sc1
buffer_store_dword v88, v128, s[48:51], s7 offen sc1
buffer_store_dword v89, v129, s[48:51], s7 offen sc1
buffer_store_dword v90, v130, s[48:51], s7 offen sc1
buffer_store_dword v91, v131, s[48:51], s7 offen sc1
s_mov_b64 exec, s[12:13]
buffer_store_dword v92, v132, s[48:51], s7 offen sc1
buffer_store_dword v93, v133, s[48:51], s7 offen sc1
buffer_store_dword v94, v134, s[48:51], s7 offen sc1
buffer_store_dword v95, v135, s[48:51], s7 offen sc1
s_mov_b64 exec, -1
s_branch L1_fin
L2_entry:
s_load_dwordx2 s[4:5], s[0:1], 88
s_load_dwordx2 s[60:61], s[0:1], 0
s_load_dwordx2 s[52:53], s[0:1], 24
s_load_dwordx2 s[56:57], s[0:1], 72
s_and_b32 s35, s2, 7
s_lshr_b32 s37, s2, 3
s_add_u32 s37, s37, 30
s_and_b32 s37, s37, 31
v_lshrrev_b32 v1, 6, v0
s_mov_b32 s36, -1
v_readfirstlane_b32 s38, v1
s_cmp_lt_u32 s37, 30
s_cbranch_scc1 L2_att
s_lshl_b32 s39, s35, 1
s_add_u32 s39, s39, s37
s_sub_u32 s39, s39, 30
s_cmp_lt_u32 s38, 3
s_cbranch_scc1 LE_start
s_cmp_ge_u32 s39, 12
s_cbranch_scc1 L2_end
s_and_b32 s36, s39, 1
s_lshr_b32 s37, s39, 1
s_mov_b32 s38, 39
v_and_b32 v0, 63, v0
s_branch L2_att2
L2_att:
s_mul_i32 s38, s37, 26
s_lshr_b32 s38, s38, 8
s_mul_i32 s39, s38, 10
s_sub_u32 s39, s37, s39
s_and_b32 s37, s35, 1
s_mul_i32 s37, s37, 3
s_add_u32 s37, s37, s38
s_and_b32 s38, s35, 1
s_mul_i32 s38, s38, 5
s_add_u32 s35, s35, s38
s_and_b32 s35, s35, 7
s_lshr_b32 s38, s35, 1
s_mul_i32 s38, s38, 10
s_add_u32 s38, s38, s39
L2_att2:
v_lshrrev_b32 v1, 6, v0
v_and_b32 v243, 63, v0
v_lshlrev_b32 v243, 4, v243
v_readfirstlane_b32 s34, v1
s_mov_b32 s50, 0xe1a06800
s_mov_b32 s51, 0x4e20ad04
s_mul_i32 s39, s37, 9
s_lshr_b64 s[50:51], s[50:51], s39
s_and_b32 s39, s50, 0x1ff
s_bfe_u32 s49, s50, 0x90009
s_sub_u32 s31, s49, s39
s_sub_u32 s31, s31, 4
s_lshl_b32 s39, s39, 14
s_lshl_b32 s49, s49, 14
s_add_u32 s28, s39, 0x4000
s_cmp_eq_u32 s37, 5
s_addc_u32 s31, s31, 0
s_cmp_eq_u32 s37, 5
s_cselect_b32 s28, s39, s28
s_cselect_b32 s39, 5111808, s39
s_cselect_b32 s49, 5120000, s49
s_cselect_b32 s33, 0xff800000, 0
s_mov_b32 s32, 0x5d800000
v_and_b32 v2, 63, v0
v_bfe_u32 v3, v2, 3, 2
v_bfe_u32 v4, v2, 2, 1
v_lshlrev_b32 v241, 12, v3
v_lshl_or_b32 v241, v4, 9, v241
v_lshl_or_b32 v241, v1, 7, v241
v_lshrrev_b32 v4, 5, v2
v_lshl_or_b32 v241, v4, 6, v241
v_and_b32 v3, 2, v3
v_and_b32 v4, 3, v2
v_xor_b32 v3, v3, v4
v_lshl_or_b32 v241, v3, 4, v241
s_cmp_eq_u32 s38, 39
s_cbranch_scc1 LT_disp
s_cmp_lt_u32 s37, 3
s_cselect_b32 s101, 1, -1
s_cselect_b32 s39, 0, 103
s_cselect_b32 s3, 0, 3
s_sub_u32 s3, s37, s3
s_mul_i32 s3, s3, 104
s_add_u32 s39, s39, s3
s_cmp_eq_u32 s37, 5
s_addc_u32 s39, s39, 0
s_lshl_b32 s101, s101, 14
s_lshl_b32 s39, s39, 14
s_add_u32 s28, s39, s101
s_mov_b32 s49, 5120000
s_mov_b32 s31, 40
s_mov_b32 s100, 5
s_lshl_b32 s30, s34, 12
s_lshl_b32 s50, s34, 13
s_add_u32 s50, s50, 0x20000
s_mov_b32 m0, s30
s_cmp_lt_u32 s37, 3
s_mov_b32 s40, 0x4682d124
s_cselect_b32 s40, s40, 0xc003fdb0
s_cselect_b32 s41, 11, 15
s_cselect_b32 s3, 0, 36
s_lshl_b32 s94, s37, 2
s_add_u32 s94, s94, s34
s_mul_i32 s94, s94, 3
s_sub_u32 s3, s94, s3
s_lshr_b64 s[40:41], s[40:41], s3
s_and_b32 s94, s40, 3
s_bfe_u32 s95, s40, 0x10002
s_mov_b32 s6, 0x92c51840
s_mov_b32 s7, 0xfb73ea6d
s_mul_i32 s3, s37, 12
s_min_u32 s3, s3, 56
s_lshr_b64 s[6:7], s[6:7], s3
s_bfe_u32 s29, s6, 0x40008
s_bfe_u32 s7, s6, 0x40004
s_and_b32 s6, s6, 15
s_cmp_lt_u32 s37, 4
s_cselect_b32 s29, s29, 16
s_lshl_b32 s3, s38, 17
s_lshl_b32 s51, s34, 7
s_add_u32 s3, s3, s51
s_lshl_b32 s6, s6, 13
s_add_u32 s6, s6, s3
s_lshl_b32 s7, s7, 13
s_add_u32 s7, s7, s3
s_lshl_b32 s29, s29, 13
s_add_u32 s29, s29, s3
s_mov_b64 s[96:97], 0
s_lshr_b32 s3, s6, 9
s_mul_i32 s90, s3, 6945
s_mov_b32 s91, s90
s_mul_i32 s90, s3, 6317
s_add_u32 s90, s90, 0x340674
s_cmp_lt_u32 s3, 5436
s_cselect_b32 s91, s91, s90
s_mul_i32 s90, s3, 6899
s_add_u32 s90, s90, 0xfffae6a0
s_cmp_lt_u32 s3, 6432
s_cselect_b32 s91, s91, s90
s_mul_i32 s90, s3, 6242
s_add_u32 s90, s90, 0x4484a0
s_cmp_lt_u32 s3, 7344
s_cselect_b32 s91, s91, s90
s_lshr_b32 s3, s91, 20
s_bitset1_b64 s[96:97], s3
s_lshr_b32 s3, s6, 9
s_add_u32 s3, s3, 15
s_mul_i32 s90, s3, 6945
s_mov_b32 s91, s90
s_mul_i32 s90, s3, 6317
s_add_u32 s90, s90, 0x340674
s_cmp_lt_u32 s3, 5436
s_cselect_b32 s91, s91, s90
s_mul_i32 s90, s3, 6899
s_add_u32 s90, s90, 0xfffae6a0
s_cmp_lt_u32 s3, 6432
s_cselect_b32 s91, s91, s90
s_mul_i32 s90, s3, 6242
s_add_u32 s90, s90, 0x4484a0
s_cmp_lt_u32 s3, 7344
s_cselect_b32 s91, s91, s90
s_lshr_b32 s3, s91, 20
s_bitset1_b64 s[96:97], s3
s_lshr_b32 s3, s7, 9
s_mul_i32 s90, s3, 6945
s_mov_b32 s91, s90
s_mul_i32 s90, s3, 6317
s_add_u32 s90, s90, 0x340674
s_cmp_lt_u32 s3, 5436
s_cselect_b32 s91, s91, s90
s_mul_i32 s90, s3, 6899
s_add_u32 s90, s90, 0xfffae6a0
s_cmp_lt_u32 s3, 6432
s_cselect_b32 s91, s91, s90
s_mul_i32 s90, s3, 6242
s_add_u32 s90, s90, 0x4484a0
s_cmp_lt_u32 s3, 7344
s_cselect_b32 s91, s91, s90
s_lshr_b32 s3, s91, 20
s_bitset1_b64 s[96:97], s3
s_lshr_b32 s3, s7, 9
s_add_u32 s3, s3, 15
s_mul_i32 s90, s3, 6945
s_mov_b32 s91, s90
s_mul_i32 s90, s3, 6317
s_add_u32 s90, s90, 0x340674
s_cmp_lt_u32 s3, 5436
s_cselect_b32 s91, s91, s90
s_mul_i32 s90, s3, 6899
s_add_u32 s90, s90, 0xfffae6a0
s_cmp_lt_u32 s3, 6432
s_cselect_b32 s91, s91, s90
s_mul_i32 s90, s3, 6242
s_add_u32 s90, s90, 0x4484a0
s_cmp_lt_u32 s3, 7344
s_cselect_b32 s91, s91, s90
s_lshr_b32 s3, s91, 20
s_bitset1_b64 s[96:97], s3
s_lshr_b32 s3, s29, 9
s_mul_i32 s90, s3, 6945
s_mov_b32 s91, s90
s_mul_i32 s90, s3, 6317
s_add_u32 s90, s90, 0x340674
s_cmp_lt_u32 s3, 5436
s_cselect_b32 s91, s91, s90
s_mul_i32 s90, s3, 6899
s_add_u32 s90, s90, 0xfffae6a0
s_cmp_lt_u32 s3, 6432
s_cselect_b32 s91, s91, s90
s_mul_i32 s90, s3, 6242
s_add_u32 s90, s90, 0x4484a0
s_cmp_lt_u32 s3, 7344
s_cselect_b32 s91, s91, s90
s_lshr_b32 s3, s91, 20
s_bitset1_b64 s[96:97], s3
s_lshr_b32 s3, s29, 9
s_add_u32 s3, s3, 15
s_mul_i32 s90, s3, 6945
s_mov_b32 s91, s90
s_mul_i32 s90, s3, 6317
s_add_u32 s90, s90, 0x340674
s_cmp_lt_u32 s3, 5436
s_cselect_b32 s91, s91, s90
s_mul_i32 s90, s3, 6899
s_add_u32 s90, s90, 0xfffae6a0
s_cmp_lt_u32 s3, 6432
s_cselect_b32 s91, s91, s90
s_mul_i32 s90, s3, 6242
s_add_u32 s90, s90, 0x4484a0
s_cmp_lt_u32 s3, 7344
s_cselect_b32 s91, s91, s90
s_lshr_b32 s3, s91, 20
s_bitset1_b64 s[96:97], s3
s_mul_i32 s3, s38, 6
s_add_u32 s3, s3, s37
s_cmp_eq_u32 s3, 233
s_cselect_b32 s3, 0, s37
s_cmp_lt_u32 s3, 4
s_cselect_b32 s29, s29, 0x70000000
s_lshl_b32 s51, s38, 5
s_lshl_b32 s3, s34, 3
s_add_u32 s51, s51, s3
s_add_u32 s51, s51, s37
s_mul_i32 s51, s51, 128
s_add_u32 s51, s51, 0x7c00000
s_lshr_b32 s40, s39, 17
s_min_u32 s40, s40, 38
s_lshr_b32 s41, s28, 17
s_add_u32 s3, s28, s101
s_lshr_b32 s3, s3, 17
v_mov_b32 v5, s38
v_mov_b32 v6, s40
v_cmp_lt_u32 vcc, 0x7f, v243
s_nop 1
v_cndmask_b32 v5, v5, v6, vcc
v_mov_b32 v6, s41
v_cmp_lt_u32 vcc, 0xff, v243
s_nop 1
v_cndmask_b32 v5, v5, v6, vcc
v_mov_b32 v6, s3
v_cmp_lt_u32 vcc, 0x17f, v243
s_nop 1
v_cndmask_b32 v5, v5, v6, vcc
v_bfe_u32 v6, v243, 4, 3
v_min_u32 v6, 5, v6
v_mad_u32_u24 v5, v5, 6, v6
v_lshlrev_b32 v5, 7, v5
v_add_u32 v5, 0x7c2a000, v5
s_mul_i32 s3, s101, 54
s_add_u32 s3, s3, s39
s_min_u32 s41, s3, s39
s_max_u32 s3, s3, s39
s_lshr_b32 s41, s41, 17
s_min_u32 s40, s40, s41
s_mul_i32 s40, s40, 6
s_lshr_b32 s3, s3, 17
s_min_u32 s3, s3, 38
s_mul_i32 s3, s3, 6
s_add_u32 s3, s3, 5
v_lshrrev_b32 v230, 4, v243
v_add_u32 v230, s40, v230
v_min_u32 v230, s3, v230
v_lshlrev_b32 v230, 7, v230
v_add_u32 v230, 0x7c2a000, v230
s_waitcnt lgkmcnt(0)
s_add_u32 s12, s4, 0x6800000
s_addc_u32 s13, s5, 0
s_mov_b32 s14, 0x0
s_mov_b32 s15, 0x00020000
s_mov_b32 s14, s49
s_add_u32 s8, s4, 0x0
s_addc_u32 s9, s5, 0
s_mov_b32 s10, 0x4e4000
s_mov_b32 s11, 0x00020000
s_mul_i32 s35, s37, 0x600000
s_add_u32 s20, s4, 0x2000000
s_addc_u32 s21, s5, 0
s_add_u32 s20, s20, s35
s_addc_u32 s21, s21, 0
s_mov_b32 s22, 0x4e4000
s_mov_b32 s23, 0x00020000
s_add_u32 s24, s4, 0x6000000
s_addc_u32 s25, s5, 0
s_mov_b32 s26, 0x139000
s_mov_b32 s27, 0x00020000
s_lshl_b32 s35, s38, 4
s_lshl_b32 s41, s34, 2
s_add_u32 s35, s35, s41
s_lshl_b32 s40, s35, 13
s_lshl_b32 s94, s94, 13
s_add_u32 s40, s40, s94
s_xor_b32 s41, s40, 8192
s_xor_b32 s42, s40, 16384
s_xor_b32 s43, s40, 24576
s_add_u32 s44, s40, 4096
s_add_u32 s45, s41, 4096
s_add_u32 s46, s42, 4096
s_add_u32 s47, s43, 4096
s_lshl_b32 s48, s35, 10
s_lshl_b32 s35, s37, 3
s_add_u32 s48, s48, s35
v_mov_b32 v232, 0
v_mov_b32 v233, 0
v_mov_b32 v234, 0
v_mov_b32 v235, 0
v_bfe_u32 v240, v243, 4, 3
v_lshlrev_b32 v240, 6, v240
v_bfe_u32 v242, v243, 7, 1
v_lshl_or_b32 v240, v242, 10, v240
v_bfe_u32 v242, v243, 8, 2
v_lshl_or_b32 v240, v242, 4, v240
v_bfe_u32 v242, v243, 6, 1
v_lshlrev_b32 v242, 5, v242
v_xor_b32 v240, v240, v242
v_and_b32 v246, 0x1c0, v243
v_bfe_u32 v242, v243, 9, 1
v_lshl_or_b32 v246, v242, 10, v246
v_bfe_u32 v242, v243, 8, 1
v_lshl_or_b32 v246, v242, 5, v246
v_bfe_u32 v242, v243, 4, 2
v_lshl_or_b32 v246, v242, 3, v246
v_xor_b32 v247, 32, v246
v_bfe_i32 v242, v243, 8, 1
v_and_b32 v192, s33, v242
v_and_b32 v193, s33, v242
v_and_b32 v194, s33, v242
v_and_b32 v195, s33, v242
v_mfma_f32_32x32x16_bf16 a[0:15], v[232:235], v[232:235], 0
v_mfma_f32_32x32x16_bf16 a[16:31], v[232:235], v[232:235], 0
v_mfma_f32_32x32x16_bf16 a[32:47], v[232:235], v[232:235], 0
v_mfma_f32_32x32x16_bf16 a[48:63], v[232:235], v[232:235], 0
v_mfma_f32_32x32x16_bf16 a[64:79], v[232:235], v[232:235], 0
v_mfma_f32_32x32x16_bf16 a[80:95], v[232:235], v[232:235], 0
v_mfma_f32_32x32x16_bf16 a[96:111], v[232:235], v[232:235], 0
v_mfma_f32_32x32x16_bf16 a[112:127], v[232:235], v[232:235], 0
v_mfma_f32_32x32x16_bf16 a[128:143], v[232:235], v[232:235], 0
v_mfma_f32_32x32x16_bf16 a[144:159], v[232:235], v[232:235], 0
v_mfma_f32_32x32x16_bf16 a[160:175], v[232:235], v[232:235], 0
v_mfma_f32_32x32x16_bf16 a[176:191], v[232:235], v[232:235], 0
v_mfma_f32_32x32x16_bf16 a[192:207], v[232:235], v[232:235], 0
v_mfma_f32_32x32x16_bf16 a[208:223], v[232:235], v[232:235], 0
v_mfma_f32_32x32x16_bf16 a[224:239], v[232:235], v[232:235], 0
v_mfma_f32_32x32x16_bf16 a[240:255], v[232:235], v[232:235], 0
s_add_u32 s16, s4, 0x0
s_addc_u32 s17, s5, 0
s_mov_b32 s18, 0x10000000
s_mov_b32 s19, 0x00020000
s_mov_b32 s3, 0x10000
LM_pa:
buffer_load_dwordx2 v[6:7], v5, s[16:19], 0 offen sc1
s_sub_u32 s3, s3, 1
s_waitcnt vmcnt(0)
s_cbranch_scc1 LM_pa_go
v_cmp_ne_u64 vcc, s[98:99], v[6:7]
s_nop 1
s_cbranch_vccnz LM_pa
LM_pa_go:
buffer_load_dwordx4 v241, s[12:15], s39 offen offset:0 sc1 lds
buffer_load_dwordx4 v241, s[12:15], s39 offen offset:1024 sc1 lds
buffer_load_dwordx4 v241, s[12:15], s39 offen offset:2048 sc1 lds
buffer_load_dwordx4 v241, s[12:15], s39 offen offset:3072 sc1 lds
s_add_u32 m0, s30, 0x4000
s_nop 0
buffer_load_dwordx4 v241, s[12:15], s28 offen offset:0 sc1 lds
buffer_load_dwordx4 v241, s[12:15], s28 offen offset:1024 sc1 lds
buffer_load_dwordx4 v[0:3], v243, s[8:11], s44 offen offset:3072 sc1
buffer_load_dwordx4 v[32:35], v243, s[8:11], s45 offen offset:3072 sc1
buffer_load_dwordx4 v[64:67], v243, s[8:11], s46 offen offset:3072 sc1
buffer_load_dwordx4 v[96:99], v243, s[8:11], s47 offen offset:3072 sc1
buffer_load_dwordx4 v[4:7], v243, s[8:11], s44 offen offset:2048 sc1
buffer_load_dwordx4 v[36:39], v243, s[8:11], s45 offen offset:2048 sc1
buffer_load_dwordx4 v[68:71], v243, s[8:11], s46 offen offset:2048 sc1
buffer_load_dwordx4 v[100:103], v243, s[8:11], s47 offen offset:2048 sc1
buffer_load_dwordx4 v[8:11], v243, s[8:11], s40 offen offset:0 sc1
buffer_load_dwordx4 v[40:43], v243, s[8:11], s41 offen offset:0 sc1
buffer_load_dwordx4 v[72:75], v243, s[8:11], s42 offen offset:0 sc1
buffer_load_dwordx4 v[104:107], v243, s[8:11], s43 offen offset:0 sc1
buffer_load_dwordx4 v[12:15], v243, s[8:11], s40 offen offset:1024 sc1
buffer_load_dwordx4 v[44:47], v243, s[8:11], s41 offen offset:1024 sc1
buffer_load_dwordx4 v[76:79], v243, s[8:11], s42 offen offset:1024 sc1
buffer_load_dwordx4 v[108:111], v243, s[8:11], s43 offen offset:1024 sc1
buffer_load_dwordx4 v[16:19], v243, s[8:11], s40 offen offset:2048 sc1
buffer_load_dwordx4 v[48:51], v243, s[8:11], s41 offen offset:2048 sc1
buffer_load_dwordx4 v[80:83], v243, s[8:11], s42 offen offset:2048 sc1
buffer_load_dwordx4 v[112:115], v243, s[8:11], s43 offen offset:2048 sc1
buffer_load_dwordx2 v[228:229], v230, s[16:19], 0 offen sc1
s_waitcnt vmcnt(21)
s_barrier
ds_read_b128 v[208:211], v240 offset:12800
ds_read_b128 v[212:215], v240 offset:14848
ds_read_b128 v[216:219], v240 offset:29184
ds_read_b128 v[220:223], v240 offset:12288
s_waitcnt lgkmcnt(3)
s_waitcnt vmcnt(17)
v_mfma_f32_16x16x32_bf16 v[128:131], v[208:211], v[0:3], v[192:195]
buffer_load_dwordx4 v[20:23], v243, s[8:11], s40 offen offset:3072 sc1
v_mfma_f32_16x16x32_bf16 v[132:135], v[208:211], v[32:35], v[192:195]
v_mfma_f32_16x16x32_bf16 v[136:139], v[208:211], v[64:67], v[192:195]
v_mfma_f32_16x16x32_bf16 v[140:143], v[208:211], v[96:99], v[192:195]
ds_read_b128 v[208:211], v240 offset:14336
s_waitcnt lgkmcnt(3)
buffer_load_dwordx4 v[52:55], v243, s[8:11], s41 offen offset:3072 sc1
v_mfma_f32_16x16x32_bf16 v[144:147], v[212:215], v[0:3], v[192:195]
v_mfma_f32_16x16x32_bf16 v[148:151], v[212:215], v[32:35], v[192:195]
v_mfma_f32_16x16x32_bf16 v[152:155], v[212:215], v[64:67], v[192:195]
buffer_load_dwordx4 v[84:87], v243, s[8:11], s42 offen offset:3072 sc1
v_mfma_f32_16x16x32_bf16 v[156:159], v[212:215], v[96:99], v[192:195]
ds_read_b128 v[212:215], v240 offset:28672
s_waitcnt lgkmcnt(3)
v_mfma_f32_16x16x32_bf16 v[176:179], v[216:219], v[0:3], 0
v_mfma_f32_16x16x32_bf16 v[180:183], v[216:219], v[32:35], 0
buffer_load_dwordx4 v[116:119], v243, s[8:11], s43 offen offset:3072 sc1
v_mfma_f32_16x16x32_bf16 v[184:187], v[216:219], v[64:67], 0
v_mfma_f32_16x16x32_bf16 v[188:191], v[216:219], v[96:99], 0
ds_read_b128 v[216:219], v240 offset:0
s_waitcnt lgkmcnt(3)
s_waitcnt vmcnt(17)
v_mfma_f32_16x16x32_bf16 v[128:131], v[220:223], v[4:7], v[128:131]
buffer_load_dwordx4 v[24:27], v243, s[8:11], s44 offen offset:0 sc1
v_mfma_f32_16x16x32_bf16 v[132:135], v[220:223], v[36:39], v[132:135]
v_mfma_f32_16x16x32_bf16 v[136:139], v[220:223], v[68:71], v[136:139]
v_mfma_f32_16x16x32_bf16 v[140:143], v[220:223], v[100:103], v[140:143]
ds_read_b128 v[220:223], v240 offset:2048
s_waitcnt lgkmcnt(3)
buffer_load_dwordx4 v[56:59], v243, s[8:11], s45 offen offset:0 sc1
v_mfma_f32_16x16x32_bf16 v[144:147], v[208:211], v[4:7], v[144:147]
v_mfma_f32_16x16x32_bf16 v[148:151], v[208:211], v[36:39], v[148:151]
v_mfma_f32_16x16x32_bf16 v[152:155], v[208:211], v[68:71], v[152:155]
buffer_load_dwordx4 v[88:91], v243, s[8:11], s46 offen offset:0 sc1
v_mfma_f32_16x16x32_bf16 v[156:159], v[208:211], v[100:103], v[156:159]
ds_read_b128 v[208:211], v240 offset:16384
s_waitcnt lgkmcnt(3)
v_mfma_f32_16x16x32_bf16 v[176:179], v[212:215], v[4:7], v[176:179]
v_mfma_f32_16x16x32_bf16 v[180:183], v[212:215], v[36:39], v[180:183]
buffer_load_dwordx4 v[120:123], v243, s[8:11], s47 offen offset:0 sc1
v_mfma_f32_16x16x32_bf16 v[184:187], v[212:215], v[68:71], v[184:187]
v_mfma_f32_16x16x32_bf16 v[188:191], v[212:215], v[100:103], v[188:191]
ds_read_b128 v[212:215], v240 offset:512
s_waitcnt lgkmcnt(3)
s_waitcnt vmcnt(17)
v_mfma_f32_16x16x32_bf16 v[128:131], v[216:219], v[8:11], v[128:131]
buffer_load_dwordx4 v[28:31], v243, s[8:11], s44 offen offset:1024 sc1
v_mfma_f32_16x16x32_bf16 v[132:135], v[216:219], v[40:43], v[132:135]
v_mfma_f32_16x16x32_bf16 v[136:139], v[216:219], v[72:75], v[136:139]
v_mfma_f32_16x16x32_bf16 v[140:143], v[216:219], v[104:107], v[140:143]
ds_read_b128 v[216:219], v240 offset:2560
s_waitcnt lgkmcnt(3)
buffer_load_dwordx4 v[60:63], v243, s[8:11], s45 offen offset:1024 sc1
v_mfma_f32_16x16x32_bf16 v[144:147], v[220:223], v[8:11], v[144:147]
v_mfma_f32_16x16x32_bf16 v[148:151], v[220:223], v[40:43], v[148:151]
v_mfma_f32_16x16x32_bf16 v[152:155], v[220:223], v[72:75], v[152:155]
buffer_load_dwordx4 v[92:95], v243, s[8:11], s46 offen offset:1024 sc1
v_mfma_f32_16x16x32_bf16 v[156:159], v[220:223], v[104:107], v[156:159]
ds_read_b128 v[220:223], v240 offset:16896
s_waitcnt lgkmcnt(3)
v_mfma_f32_16x16x32_bf16 v[176:179], v[208:211], v[8:11], v[176:179]
v_mfma_f32_16x16x32_bf16 v[180:183], v[208:211], v[40:43], v[180:183]
buffer_load_dwordx4 v[124:127], v243, s[8:11], s47 offen offset:1024 sc1
v_mfma_f32_16x16x32_bf16 v[184:187], v[208:211], v[72:75], v[184:187]
v_mfma_f32_16x16x32_bf16 v[188:191], v[208:211], v[104:107], v[188:191]
ds_read_b128 v[208:211], v240 offset:4096
s_waitcnt lgkmcnt(3)
s_waitcnt vmcnt(17)
v_mfma_f32_16x16x32_bf16 v[128:131], v[212:215], v[12:15], v[128:131]
s_add_u32 s16, s4, 0x0
s_addc_u32 s17, s5, 0
s_mov_b32 s18, 0x10000000
v_mfma_f32_16x16x32_bf16 v[132:135], v[212:215], v[44:47], v[132:135]
buffer_load_dwordx4 v241, s[12:15], s28 offen offset:2048 sc1 lds
s_mov_b32 s19, 0x00020000
s_add_u32 s8, s60, 0x0
v_mfma_f32_16x16x32_bf16 v[136:139], v[212:215], v[76:79], v[136:139]
s_addc_u32 s9, s61, 0
s_mov_b32 s10, 0x4e2000
s_mov_b32 s11, 0x00020000
v_mfma_f32_16x16x32_bf16 v[140:143], v[212:215], v[108:111], v[140:143]
ds_read_b128 v[212:215], v240 offset:6144
s_waitcnt lgkmcnt(3)
buffer_load_dwordx4 v241, s[12:15], s28 offen offset:3072 sc1 lds
v_mfma_f32_16x16x32_bf16 v[144:147], v[216:219], v[12:15], v[144:147]
s_mov_b32 s54, 0x4e20
s_mov_b32 s55, 0x00020000
s_mov_b32 s58, 0x4e2000
v_mfma_f32_16x16x32_bf16 v[148:151], v[216:219], v[44:47], v[148:151]
s_mov_b32 s59, 0x00020000
s_lshr_b32 s48, s40, 2
s_cmp_eq_u32 s95, 1
v_mfma_f32_16x16x32_bf16 v[152:155], v[216:219], v[76:79], v[152:155]
s_cselect_b32 s40, 0x70000000, s40
s_cselect_b32 s44, 0x70000000, s44
s_cmp_lt_u32 s37, 3
v_mfma_f32_16x16x32_bf16 v[156:159], v[216:219], v[108:111], v[156:159]
ds_read_b128 v[216:219], v240 offset:20480
s_waitcnt lgkmcnt(3)
s_cselect_b32 s3, 0, 3
v_mfma_f32_16x16x32_bf16 v[176:179], v[220:223], v[12:15], v[176:179]
s_cselect_b32 s94, 0, 8
s_sub_u32 s3, s37, s3
s_lshl_b32 s38, s38, 2
v_mfma_f32_16x16x32_bf16 v[180:183], v[220:223], v[44:47], v[180:183]
s_add_u32 s38, s38, s3
s_lshl_b32 s38, s38, 10
s_add_u32 s38, s38, 0x7c00300
v_mfma_f32_16x16x32_bf16 v[184:187], v[220:223], v[76:79], v[184:187]
s_add_u32 s94, s94, s38
s_xor_b32 s95, s94, 8
s_add_u32 s49, s95, 32
v_mfma_f32_16x16x32_bf16 v[188:191], v[220:223], v[108:111], v[188:191]
ds_read_b128 v[220:223], v240 offset:4608
s_waitcnt lgkmcnt(3)
s_waitcnt vmcnt(15)
v_mfma_f32_16x16x32_bf16 v[128:131], v[208:211], v[16:19], v[128:131]
s_cmp_eq_u32 s3, 2
s_cselect_b32 s35, s38, s94
s_cselect_b32 s49, s49, s95
v_mfma_f32_16x16x32_bf16 v[132:135], v[208:211], v[48:51], v[132:135]
s_add_u32 s28, s28, s101
s_add_u32 m0, s30, 0x8000
s_nop 0
s_mov_b32 s39, 4
v_mfma_f32_16x16x32_bf16 v[136:139], v[208:211], v[80:83], v[136:139]
v_mfma_f32_16x16x32_bf16 v[140:143], v[208:211], v[112:115], v[140:143]
ds_read_b128 v[208:211], v240 offset:6656
s_waitcnt lgkmcnt(3)
buffer_load_dwordx4 v241, s[12:15], s28 offen offset:0 sc1 lds
v_mfma_f32_16x16x32_bf16 v[144:147], v[212:215], v[16:19], v[144:147]
v_mfma_f32_16x16x32_bf16 v[148:151], v[212:215], v[48:51], v[148:151]
buffer_load_dwordx4 v241, s[12:15], s28 offen offset:1024 sc1 lds
v_mfma_f32_16x16x32_bf16 v[152:155], v[212:215], v[80:83], v[152:155]
v_mfma_f32_16x16x32_bf16 v[156:159], v[212:215], v[112:115], v[156:159]
ds_read_b128 v[212:215], v240 offset:20992
s_waitcnt lgkmcnt(3)
v_mfma_f32_16x16x32_bf16 v[176:179], v[216:219], v[16:19], v[176:179]
v_mfma_f32_16x16x32_bf16 v[180:183], v[216:219], v[48:51], v[180:183]
v_mfma_f32_16x16x32_bf16 v[184:187], v[216:219], v[80:83], v[184:187]
v_mfma_f32_16x16x32_bf16 v[188:191], v[216:219], v[112:115], v[188:191]
ds_read_b128 v[216:219], v240 offset:8192
s_waitcnt lgkmcnt(3)
s_waitcnt vmcnt(12)
v_mfma_f32_16x16x32_bf16 v[128:131], v[220:223], v[20:23], v[128:131]
v_mfma_f32_16x16x32_bf16 v[132:135], v[220:223], v[52:55], v[132:135]
buffer_load_dwordx4 v241, s[12:15], s28 offen offset:2048 sc1 lds
v_mfma_f32_16x16x32_bf16 v[136:139], v[220:223], v[84:87], v[136:139]
v_mfma_f32_16x16x32_bf16 v[140:143], v[220:223], v[116:119], v[140:143]
ds_read_b128 v[220:223], v240 offset:10240
s_waitcnt lgkmcnt(3)
buffer_load_dwordx4 v241, s[12:15], s28 offen offset:3072 sc1 lds
v_mfma_f32_16x16x32_bf16 v[144:147], v[208:211], v[20:23], v[144:147]
v_mfma_f32_16x16x32_bf16 v[148:151], v[208:211], v[52:55], v[148:151]
v_mfma_f32_16x16x32_bf16 v[152:155], v[208:211], v[84:87], v[152:155]
v_mfma_f32_16x16x32_bf16 v[156:159], v[208:211], v[116:119], v[156:159]
ds_read_b128 v[208:211], v240 offset:24576
s_waitcnt lgkmcnt(3)
v_mfma_f32_16x16x32_bf16 v[176:179], v[212:215], v[20:23], v[176:179]
v_mfma_f32_16x16x32_bf16 v[180:183], v[212:215], v[52:55], v[180:183]
v_mfma_f32_16x16x32_bf16 v[184:187], v[212:215], v[84:87], v[184:187]
v_mfma_f32_16x16x32_bf16 v[188:191], v[212:215], v[116:119], v[188:191]
ds_read_b128 v[212:215], v240 offset:8704
s_waitcnt lgkmcnt(3)
s_waitcnt vmcnt(10)
v_mfma_f32_16x16x32_bf16 v[128:131], v[216:219], v[24:27], v[128:131]
v_mfma_f32_16x16x32_bf16 v[132:135], v[216:219], v[56:59], v[132:135]
s_add_u32 s28, s28, s101
s_add_u32 s30, s30, 0xc000
v_mfma_f32_16x16x32_bf16 v[136:139], v[216:219], v[88:91], v[136:139]
v_mfma_f32_16x16x32_bf16 v[140:143], v[216:219], v[120:123], v[140:143]
ds_read_b128 v[216:219], v240 offset:10752
s_waitcnt lgkmcnt(3)
v_mfma_f32_16x16x32_bf16 v[144:147], v[220:223], v[24:27], v[144:147]
v_mfma_f32_16x16x32_bf16 v[148:151], v[220:223], v[56:59], v[148:151]
v_mfma_f32_16x16x32_bf16 v[152:155], v[220:223], v[88:91], v[152:155]
v_mfma_f32_16x16x32_bf16 v[156:159], v[220:223], v[120:123], v[156:159]
ds_read_b128 v[220:223], v240 offset:25088
s_waitcnt lgkmcnt(3)
v_mfma_f32_16x16x32_bf16 v[176:179], v[208:211], v[24:27], v[176:179]
v_mfma_f32_16x16x32_bf16 v[180:183], v[208:211], v[56:59], v[180:183]
v_mfma_f32_16x16x32_bf16 v[184:187], v[208:211], v[88:91], v[184:187]
v_mfma_f32_16x16x32_bf16 v[188:191], v[208:211], v[120:123], v[188:191]
s_waitcnt lgkmcnt(2)
s_waitcnt vmcnt(6)
v_mfma_f32_16x16x32_bf16 v[128:131], v[212:215], v[28:31], v[128:131]
v_mfma_f32_16x16x32_bf16 v[132:135], v[212:215], v[60:63], v[132:135]
v_mfma_f32_16x16x32_bf16 v[136:139], v[212:215], v[92:95], v[136:139]
v_mfma_f32_16x16x32_bf16 v[140:143], v[212:215], v[124:127], v[140:143]
s_waitcnt lgkmcnt(1)
v_mfma_f32_16x16x32_bf16 v[144:147], v[216:219], v[28:31], v[144:147]
v_mfma_f32_16x16x32_bf16 v[148:151], v[216:219], v[60:63], v[148:151]
v_mfma_f32_16x16x32_bf16 v[152:155], v[216:219], v[92:95], v[152:155]
v_mfma_f32_16x16x32_bf16 v[156:159], v[216:219], v[124:127], v[156:159]
s_waitcnt lgkmcnt(0)
v_mfma_f32_16x16x32_bf16 v[176:179], v[220:223], v[28:31], v[176:179]
v_mfma_f32_16x16x32_bf16 v[180:183], v[220:223], v[60:63], v[180:183]
v_mfma_f32_16x16x32_bf16 v[184:187], v[220:223], v[92:95], v[184:187]
v_mfma_f32_16x16x32_bf16 v[188:191], v[220:223], v[124:127], v[188:191]
v_max3_f32 v248, v128, v129, v130
v_max3_f32 v249, v132, v133, v134
v_max3_f32 v250, v136, v137, v138
v_max3_f32 v251, v140, v141, v142
v_max3_f32 v248, v248, v131, v144
v_max3_f32 v249, v249, v135, v148
v_max3_f32 v250, v250, v139, v152
v_max3_f32 v251, v251, v143, v156
v_max3_f32 v248, v248, v145, v146
v_max3_f32 v249, v249, v149, v150
v_max3_f32 v250, v250, v153, v154
v_max3_f32 v251, v251, v157, v158
v_max_f32 v248, v248, v147
v_max_f32 v249, v249, v151
v_max_f32 v250, v250, v155
v_max_f32 v251, v251, v159
v_mov_b32 v232, v248
v_mov_b32 v233, v249
v_mov_b32 v234, v250
v_mov_b32 v235, v251
v_permlane32_swap_b32 v248, v232
v_permlane32_swap_b32 v249, v233
v_permlane32_swap_b32 v250, v234
v_permlane32_swap_b32 v251, v235
v_max_f32 v248, v248, v232
v_max_f32 v249, v249, v233
v_max_f32 v250, v250, v234
v_max_f32 v251, v251, v235
v_mov_b32 v232, v248
v_mov_b32 v233, v249
v_mov_b32 v234, v250
v_mov_b32 v235, v251
v_permlane16_swap_b32 v248, v232
v_permlane16_swap_b32 v249, v233
v_permlane16_swap_b32 v250, v234
v_permlane16_swap_b32 v251, v235
v_max_f32 v248, v248, v232
v_max_f32 v249, v249, v233
v_max_f32 v250, v250, v234
v_max_f32 v251, v251, v235
v_ceil_f32 v248, v248
v_ceil_f32 v249, v249
v_ceil_f32 v250, v250
v_ceil_f32 v251, v251
v_add_f32 v248, 40.0, v248
v_add_f32 v249, 40.0, v249
v_add_f32 v250, 40.0, v250
v_add_f32 v251, 40.0, v251
v_cvt_pk_bf16_f32 v248, v248, v248
v_cvt_pk_bf16_f32 v249, v249, v249
v_cvt_pk_bf16_f32 v250, v250, v250
v_cvt_pk_bf16_f32 v251, v251, v251
v_and_b32 v248, 0xffff0000, v248
v_and_b32 v249, 0xffff0000, v249
v_and_b32 v250, 0xffff0000, v250
v_and_b32 v251, 0xffff0000, v251
v_bfe_i32 v242, v243, 8, 1
v_bfe_i32 v232, v243, 9, 1
v_and_b32 v242, v242, v232
v_and_b32 v242, 0xffff0000, v242
v_sub_f32 v224, 0, v248
v_sub_f32 v225, 0, v249
v_sub_f32 v226, 0, v250
v_sub_f32 v227, 0, v251
v_bfi_b32 v3, v242, v224, v3
v_bfi_b32 v35, v242, v225, v35
v_bfi_b32 v67, v242, v226, v67
v_bfi_b32 v99, v242, v227, v99
v_sub_f32 v128, v128, v248
v_sub_f32 v129, v129, v248
v_sub_f32 v130, v130, v248
v_sub_f32 v131, v131, v248
v_exp_f32 v128, v128
v_exp_f32 v129, v129
v_exp_f32 v130, v130
v_exp_f32 v131, v131
v_sub_f32 v132, v132, v249
v_sub_f32 v133, v133, v249
v_sub_f32 v134, v134, v249
v_sub_f32 v135, v135, v249
v_exp_f32 v132, v132
v_exp_f32 v133, v133
v_exp_f32 v134, v134
v_exp_f32 v135, v135
v_sub_f32 v136, v136, v250
v_sub_f32 v137, v137, v250
v_sub_f32 v138, v138, v250
v_sub_f32 v139, v139, v250
v_exp_f32 v136, v136
v_exp_f32 v137, v137
v_exp_f32 v138, v138
v_exp_f32 v139, v139
v_sub_f32 v140, v140, v251
v_sub_f32 v141, v141, v251
v_sub_f32 v142, v142, v251
v_sub_f32 v143, v143, v251
v_exp_f32 v140, v140
v_exp_f32 v141, v141
v_exp_f32 v142, v142
v_exp_f32 v143, v143
s_waitcnt vmcnt(4)
s_barrier
ds_read_b128 v[208:211], v240 offset:31232
ds_read_b128 v[212:215], v240 offset:30720
ds_read_b128 v[216:219], v240 offset:18432
ds_read_b128 v[220:223], v240 offset:18944
v_add_f32 v144, v144, v224
v_add_f32 v145, v145, v224
v_add_f32 v146, v146, v224
v_add_f32 v147, v147, v224
v_exp_f32 v144, v144
v_exp_f32 v145, v145
v_exp_f32 v146, v146
v_exp_f32 v147, v147
v_add_f32 v148, v148, v225
v_add_f32 v149, v149, v225
v_add_f32 v150, v150, v225
v_add_f32 v151, v151, v225
v_exp_f32 v148, v148
v_exp_f32 v149, v149
v_exp_f32 v150, v150
v_exp_f32 v151, v151
v_add_f32 v152, v152, v226
v_add_f32 v153, v153, v226
v_add_f32 v154, v154, v226
v_add_f32 v155, v155, v226
v_exp_f32 v152, v152
v_exp_f32 v153, v153
v_exp_f32 v154, v154
v_exp_f32 v155, v155
v_add_f32 v156, v156, v227
v_add_f32 v157, v157, v227
v_add_f32 v158, v158, v227
v_add_f32 v159, v159, v227
v_exp_f32 v156, v156
v_exp_f32 v157, v157
v_exp_f32 v158, v158
v_exp_f32 v159, v159
v_cvt_pk_bf16_f32 v160, v128, v129
v_cvt_pk_bf16_f32 v161, v130, v131
v_cvt_pk_bf16_f32 v164, v132, v133
v_cvt_pk_bf16_f32 v165, v134, v135
v_cvt_pk_bf16_f32 v168, v136, v137
v_cvt_pk_bf16_f32 v169, v138, v139
v_cvt_pk_bf16_f32 v172, v140, v141
v_cvt_pk_bf16_f32 v173, v142, v143
v_cvt_pk_bf16_f32 v162, v144, v145
v_cvt_pk_bf16_f32 v163, v146, v147
v_cvt_pk_bf16_f32 v166, v148, v149
v_cvt_pk_bf16_f32 v167, v150, v151
v_cvt_pk_bf16_f32 v170, v152, v153
v_cvt_pk_bf16_f32 v171, v154, v155
v_cvt_pk_bf16_f32 v174, v156, v157
v_cvt_pk_bf16_f32 v175, v158, v159
v_add_f32 v128, v176, v224
v_add_f32 v129, v177, v224
v_add_f32 v130, v178, v224
v_add_f32 v131, v179, v224
v_add_f32 v132, v180, v225
v_add_f32 v133, v181, v225
v_add_f32 v134, v182, v225
v_add_f32 v135, v183, v225
v_add_f32 v136, v184, v226
v_add_f32 v137, v185, v226
v_add_f32 v138, v186, v226
v_add_f32 v139, v187, v226
v_add_f32 v140, v188, v227
v_add_f32 v141, v189, v227
v_add_f32 v142, v190, v227
v_add_f32 v143, v191, v227
v_cmp_ne_u64 vcc, s[98:99], v[228:229]
s_nop 1
s_cbranch_vccnz LM_pb
LM_pb_ret:
s_nop 1
s_waitcnt lgkmcnt(2)
L2_ret5:
v_mfma_f32_16x16x32_bf16 v[144:147], v[208:211], v[0:3], 0
v_mfma_f32_16x16x32_bf16 v[144:147], v[212:215], v[4:7], v[144:147]
v_mfma_f32_16x16x32_bf16 v[148:151], v[208:211], v[32:35], 0
v_mfma_f32_16x16x32_bf16 v[148:151], v[212:215], v[36:39], v[148:151]
v_mfma_f32_16x16x32_bf16 v[152:155], v[208:211], v[64:67], 0
v_exp_f32 v128, v128
v_mfma_f32_16x16x32_bf16 v[152:155], v[212:215], v[68:71], v[152:155]
v_exp_f32 v129, v129
v_mfma_f32_16x16x32_bf16 v[156:159], v[208:211], v[96:99], 0
ds_read_b128 v[208:211], v240 offset:22528
v_mfma_f32_16x16x32_bf16 v[156:159], v[212:215], v[100:103], v[156:159]
ds_read_b128 v[212:215], v240 offset:23040
s_waitcnt lgkmcnt(2)
v_mfma_f32_16x16x32_bf16 v[144:147], v[216:219], v[8:11], v[144:147]
v_exp_f32 v130, v130
v_mfma_f32_16x16x32_bf16 v[144:147], v[220:223], v[12:15], v[144:147]
v_exp_f32 v131, v131
v_mfma_f32_16x16x32_bf16 v[148:151], v[216:219], v[40:43], v[148:151]
v_exp_f32 v132, v132
v_mfma_f32_16x16x32_bf16 v[148:151], v[220:223], v[44:47], v[148:151]
v_exp_f32 v133, v133
v_mfma_f32_16x16x32_bf16 v[152:155], v[216:219], v[72:75], v[152:155]
v_exp_f32 v134, v134
v_mfma_f32_16x16x32_bf16 v[152:155], v[220:223], v[76:79], v[152:155]
v_exp_f32 v135, v135
v_mfma_f32_16x16x32_bf16 v[156:159], v[216:219], v[104:107], v[156:159]
ds_read_b128 v[216:219], v240 offset:26624
v_mfma_f32_16x16x32_bf16 v[156:159], v[220:223], v[108:111], v[156:159]
ds_read_b128 v[220:223], v240 offset:27136
s_waitcnt lgkmcnt(2)
v_mfma_f32_16x16x32_bf16 v[144:147], v[208:211], v[16:19], v[144:147]
v_exp_f32 v136, v136
v_mfma_f32_16x16x32_bf16 v[144:147], v[212:215], v[20:23], v[144:147]
v_add_u32 v240, 0x8000, v240
v_mfma_f32_16x16x32_bf16 v[148:151], v[208:211], v[48:51], v[148:151]
v_and_b32 v240, 0x1ffff, v240
v_mfma_f32_16x16x32_bf16 v[148:151], v[212:215], v[52:55], v[148:151]
v_exp_f32 v137, v137
v_mfma_f32_16x16x32_bf16 v[152:155], v[208:211], v[80:83], v[152:155]
v_exp_f32 v138, v138
v_mfma_f32_16x16x32_bf16 v[152:155], v[212:215], v[84:87], v[152:155]
v_exp_f32 v139, v139
v_mfma_f32_16x16x32_bf16 v[156:159], v[208:211], v[112:115], v[156:159]
ds_read_b64_tr_b16 v[208:209], v246 offset:0
ds_read_b64_tr_b16 v[210:211], v246 offset:2048
v_mfma_f32_16x16x32_bf16 v[156:159], v[212:215], v[116:119], v[156:159]
ds_read_b64_tr_b16 v[212:213], v247 offset:0
s_waitcnt lgkmcnt(3)
v_mfma_f32_16x16x32_bf16 v[144:147], v[216:219], v[24:27], v[144:147]
ds_read_b64_tr_b16 v[214:215], v247 offset:2048
v_mfma_f32_16x16x32_bf16 v[144:147], v[220:223], v[28:31], v[144:147]
v_exp_f32 v140, v140
v_mfma_f32_16x16x32_bf16 v[148:151], v[216:219], v[56:59], v[148:151]
v_exp_f32 v141, v141
v_mfma_f32_16x16x32_bf16 v[148:151], v[220:223], v[60:63], v[148:151]
v_exp_f32 v142, v142
v_mfma_f32_16x16x32_bf16 v[152:155], v[216:219], v[88:91], v[152:155]
v_exp_f32 v143, v143
v_mfma_f32_16x16x32_bf16 v[152:155], v[220:223], v[92:95], v[152:155]
v_mfma_f32_16x16x32_bf16 v[156:159], v[216:219], v[120:123], v[156:159]
ds_read_b64_tr_b16 v[216:217], v246 offset:512
ds_read_b64_tr_b16 v[218:219], v246 offset:2560
v_mfma_f32_16x16x32_bf16 v[156:159], v[220:223], v[124:127], v[156:159]
ds_read_b64_tr_b16 v[220:221], v247 offset:512
s_waitcnt lgkmcnt(5)
v_mfma_f32_16x16x32_bf16 a[0:3], v[160:163], v[208:211], a[0:3]
ds_read_b64_tr_b16 v[222:223], v247 offset:2560
v_mfma_f32_16x16x32_bf16 a[4:7], v[164:167], v[208:211], a[4:7]
s_mov_b32 m0, s30
v_mfma_f32_16x16x32_bf16 a[8:11], v[168:171], v[208:211], a[8:11]
buffer_load_dwordx4 v241, s[12:15], s28 offen offset:0 sc1 lds
v_mfma_f32_16x16x32_bf16 a[12:15], v[172:175], v[208:211], a[12:15]
ds_read_b64_tr_b16 v[208:209], v246 offset:4096
s_waitcnt lgkmcnt(5)
v_mfma_f32_16x16x32_bf16 a[16:19], v[160:163], v[212:215], a[16:19]
ds_read_b64_tr_b16 v[210:211], v246 offset:6144
buffer_load_dwordx4 v241, s[12:15], s28 offen offset:1024 sc1 lds
v_mfma_f32_16x16x32_bf16 a[20:23], v[164:167], v[212:215], a[20:23]
v_mfma_f32_16x16x32_bf16 a[24:27], v[168:171], v[212:215], a[24:27]
buffer_load_dwordx4 v241, s[12:15], s28 offen offset:2048 sc1 lds
v_mfma_f32_16x16x32_bf16 a[28:31], v[172:175], v[212:215], a[28:31]
ds_read_b64_tr_b16 v[212:213], v247 offset:4096
s_waitcnt lgkmcnt(5)
v_mfma_f32_16x16x32_bf16 a[32:35], v[160:163], v[216:219], a[32:35]
ds_read_b64_tr_b16 v[214:215], v247 offset:6144
v_mfma_f32_16x16x32_bf16 a[36:39], v[164:167], v[216:219], a[36:39]
buffer_load_dwordx4 v241, s[12:15], s28 offen offset:3072 sc1 lds
v_mfma_f32_16x16x32_bf16 a[40:43], v[168:171], v[216:219], a[40:43]
v_exp_f32 v144, v144
v_mfma_f32_16x16x32_bf16 a[44:47], v[172:175], v[216:219], a[44:47]
ds_read_b64_tr_b16 v[216:217], v246 offset:4608
s_waitcnt lgkmcnt(5)
v_mfma_f32_16x16x32_bf16 a[48:51], v[160:163], v[220:223], a[48:51]
ds_read_b64_tr_b16 v[218:219], v246 offset:6656
v_mfma_f32_16x16x32_bf16 a[52:55], v[164:167], v[220:223], a[52:55]
v_exp_f32 v145, v145
v_mfma_f32_16x16x32_bf16 a[56:59], v[168:171], v[220:223], a[56:59]
v_exp_f32 v146, v146
v_mfma_f32_16x16x32_bf16 a[60:63], v[172:175], v[220:223], a[60:63]
ds_read_b64_tr_b16 v[220:221], v247 offset:4608
s_waitcnt lgkmcnt(5)
v_mfma_f32_16x16x32_bf16 a[64:67], v[160:163], v[208:211], a[64:67]
ds_read_b64_tr_b16 v[222:223], v247 offset:6656
v_mfma_f32_16x16x32_bf16 a[68:71], v[164:167], v[208:211], a[68:71]
s_waitcnt vmcnt(4)
s_barrier
v_mfma_f32_16x16x32_bf16 a[72:75], v[168:171], v[208:211], a[72:75]
v_exp_f32 v147, v147
v_mfma_f32_16x16x32_bf16 a[76:79], v[172:175], v[208:211], a[76:79]
ds_read_b128 v[208:211], v240 offset:12800
s_waitcnt lgkmcnt(5)
v_mfma_f32_16x16x32_bf16 a[80:83], v[160:163], v[212:215], a[80:83]
v_exp_f32 v148, v148
v_mfma_f32_16x16x32_bf16 a[84:87], v[164:167], v[212:215], a[84:87]
v_exp_f32 v149, v149
v_mfma_f32_16x16x32_bf16 a[88:91], v[168:171], v[212:215], a[88:91]
v_exp_f32 v150, v150
v_mfma_f32_16x16x32_bf16 a[92:95], v[172:175], v[212:215], a[92:95]
ds_read_b128 v[212:215], v240 offset:12288
s_waitcnt lgkmcnt(4)
v_mfma_f32_16x16x32_bf16 a[96:99], v[160:163], v[216:219], a[96:99]
v_exp_f32 v151, v151
v_mfma_f32_16x16x32_bf16 a[100:103], v[164:167], v[216:219], a[100:103]
v_cvt_pk_bf16_f32 v176, v128, v129
v_cvt_pk_bf16_f32 v177, v130, v131
v_mfma_f32_16x16x32_bf16 a[104:107], v[168:171], v[216:219], a[104:107]
v_exp_f32 v152, v152
v_mfma_f32_16x16x32_bf16 a[108:111], v[172:175], v[216:219], a[108:111]
ds_read_b128 v[216:219], v240 offset:0
s_waitcnt lgkmcnt(3)
v_cvt_pk_bf16_f32 v180, v132, v133
v_cvt_pk_bf16_f32 v181, v134, v135
v_mfma_f32_16x16x32_bf16 a[112:115], v[160:163], v[220:223], a[112:115]
v_exp_f32 v153, v153
v_mfma_f32_16x16x32_bf16 a[116:119], v[164:167], v[220:223], a[116:119]
v_cvt_pk_bf16_f32 v184, v136, v137
v_cvt_pk_bf16_f32 v185, v138, v139
v_mfma_f32_16x16x32_bf16 a[120:123], v[168:171], v[220:223], a[120:123]
v_exp_f32 v154, v154
v_mfma_f32_16x16x32_bf16 a[124:127], v[172:175], v[220:223], a[124:127]
ds_read_b128 v[220:223], v240 offset:512
s_waitcnt lgkmcnt(2)
v_mfma_f32_16x16x32_bf16 v[128:131], v[208:211], v[0:3], 0
v_exp_f32 v155, v155
v_mfma_f32_16x16x32_bf16 v[128:131], v[212:215], v[4:7], v[128:131]
v_cvt_pk_bf16_f32 v188, v140, v141
v_cvt_pk_bf16_f32 v189, v142, v143
v_mfma_f32_16x16x32_bf16 v[132:135], v[208:211], v[32:35], 0
v_exp_f32 v156, v156
v_mfma_f32_16x16x32_bf16 v[132:135], v[212:215], v[36:39], v[132:135]
v_exp_f32 v157, v157
v_mfma_f32_16x16x32_bf16 v[136:139], v[208:211], v[64:67], 0
v_exp_f32 v158, v158
v_mfma_f32_16x16x32_bf16 v[136:139], v[212:215], v[68:71], v[136:139]
v_exp_f32 v159, v159
v_mfma_f32_16x16x32_bf16 v[140:143], v[208:211], v[96:99], 0
ds_read_b128 v[208:211], v240 offset:4096
v_cvt_pk_bf16_f32 v178, v144, v145
v_cvt_pk_bf16_f32 v179, v146, v147
v_mfma_f32_16x16x32_bf16 v[140:143], v[212:215], v[100:103], v[140:143]
ds_read_b128 v[212:215], v240 offset:4608
s_waitcnt lgkmcnt(2)
v_cvt_pk_bf16_f32 v182, v148, v149
v_mfma_f32_16x16x32_bf16 v[128:131], v[216:219], v[8:11], v[128:131]
v_cvt_pk_bf16_f32 v183, v150, v151
v_cvt_pk_bf16_f32 v186, v152, v153
v_cvt_pk_bf16_f32 v187, v154, v155
v_mfma_f32_16x16x32_bf16 v[128:131], v[220:223], v[12:15], v[128:131]
v_cvt_pk_bf16_f32 v190, v156, v157
v_cvt_pk_bf16_f32 v191, v158, v159
v_or3_b32 v242, v176, v177, v178
v_mfma_f32_16x16x32_bf16 v[132:135], v[216:219], v[40:43], v[132:135]
v_or3_b32 v242, v242, v179, v180
v_or3_b32 v242, v242, v181, v182
v_or3_b32 v242, v242, v183, v184
v_mfma_f32_16x16x32_bf16 v[132:135], v[220:223], v[44:47], v[132:135]
v_or3_b32 v242, v242, v185, v186
v_or3_b32 v242, v242, v187, v188
v_or3_b32 v242, v242, v189, v190
v_mfma_f32_16x16x32_bf16 v[136:139], v[216:219], v[72:75], v[136:139]
v_or_b32 v242, v242, v191
v_lshl_or_b32 v242, v242, 16, v242
v_cmp_le_u32 vcc, 2.0, v242
v_mfma_f32_16x16x32_bf16 v[136:139], v[220:223], v[76:79], v[136:139]
v_mfma_f32_16x16x32_bf16 v[140:143], v[216:219], v[104:107], v[140:143]
ds_read_b128 v[216:219], v240 offset:8192
v_mfma_f32_16x16x32_bf16 v[140:143], v[220:223], v[108:111], v[140:143]
ds_read_b128 v[220:223], v240 offset:8704
s_waitcnt lgkmcnt(2)
s_cbranch_vccnz L2_rare_site4
L2_ret4:
v_mfma_f32_16x16x32_bf16 v[128:131], v[208:211], v[16:19], v[128:131]
v_mfma_f32_16x16x32_bf16 v[128:131], v[212:215], v[20:23], v[128:131]
v_mfma_f32_16x16x32_bf16 v[132:135], v[208:211], v[48:51], v[132:135]
v_mfma_f32_16x16x32_bf16 v[132:135], v[212:215], v[52:55], v[132:135]
v_mfma_f32_16x16x32_bf16 v[136:139], v[208:211], v[80:83], v[136:139]
v_mfma_f32_16x16x32_bf16 v[136:139], v[212:215], v[84:87], v[136:139]
s_sub_u32 s31, s31, 1
v_mfma_f32_16x16x32_bf16 v[140:143], v[208:211], v[112:115], v[140:143]
ds_read_b128 v[208:211], v240 offset:14848
v_mfma_f32_16x16x32_bf16 v[140:143], v[212:215], v[116:119], v[140:143]
ds_read_b128 v[212:215], v240 offset:14336
s_waitcnt lgkmcnt(2)
v_mfma_f32_16x16x32_bf16 v[128:131], v[216:219], v[24:27], v[128:131]
s_add_u32 s28, s28, s101
s_add_u32 s30, s30, 0x4000
v_mfma_f32_16x16x32_bf16 v[128:131], v[220:223], v[28:31], v[128:131]
s_and_b32 s30, s30, 0x1ffff
v_mfma_f32_16x16x32_bf16 v[132:135], v[216:219], v[56:59], v[132:135]
v_mfma_f32_16x16x32_bf16 v[132:135], v[220:223], v[60:63], v[132:135]
v_mfma_f32_16x16x32_bf16 v[136:139], v[216:219], v[88:91], v[136:139]
v_mfma_f32_16x16x32_bf16 v[136:139], v[220:223], v[92:95], v[136:139]
v_mfma_f32_16x16x32_bf16 v[140:143], v[216:219], v[120:123], v[140:143]
ds_read_b128 v[216:219], v240 offset:2048
v_mfma_f32_16x16x32_bf16 v[140:143], v[220:223], v[124:127], v[140:143]
ds_read_b128 v[220:223], v240 offset:2560
s_branch L2_loop1
.p2align 6
L2_loop:
s_waitcnt lgkmcnt(2)
L2_ret1:
v_mfma_f32_16x16x32_bf16 v[144:147], v[208:211], v[0:3], 0
v_mfma_f32_16x16x32_bf16 v[144:147], v[212:215], v[4:7], v[144:147]
v_mfma_f32_16x16x32_bf16 v[148:151], v[208:211], v[32:35], 0
v_mfma_f32_16x16x32_bf16 v[148:151], v[212:215], v[36:39], v[148:151]
v_mfma_f32_16x16x32_bf16 v[152:155], v[208:211], v[64:67], 0
v_exp_f32 v128, v128
v_mfma_f32_16x16x32_bf16 v[152:155], v[212:215], v[68:71], v[152:155]
v_exp_f32 v129, v129
v_mfma_f32_16x16x32_bf16 v[156:159], v[208:211], v[96:99], 0
ds_read_b128 v[208:211], v240 offset:22528
v_mfma_f32_16x16x32_bf16 v[156:159], v[212:215], v[100:103], v[156:159]
ds_read_b128 v[212:215], v240 offset:23040
s_waitcnt lgkmcnt(2)
v_mfma_f32_16x16x32_bf16 v[144:147], v[216:219], v[8:11], v[144:147]
v_exp_f32 v130, v130
v_mfma_f32_16x16x32_bf16 v[144:147], v[220:223], v[12:15], v[144:147]
v_exp_f32 v131, v131
v_mfma_f32_16x16x32_bf16 v[148:151], v[216:219], v[40:43], v[148:151]
v_exp_f32 v132, v132
v_mfma_f32_16x16x32_bf16 v[148:151], v[220:223], v[44:47], v[148:151]
v_exp_f32 v133, v133
v_mfma_f32_16x16x32_bf16 v[152:155], v[216:219], v[72:75], v[152:155]
v_exp_f32 v134, v134
v_mfma_f32_16x16x32_bf16 v[152:155], v[220:223], v[76:79], v[152:155]
v_exp_f32 v135, v135
v_mfma_f32_16x16x32_bf16 v[156:159], v[216:219], v[104:107], v[156:159]
ds_read_b128 v[216:219], v240 offset:26624
v_mfma_f32_16x16x32_bf16 v[156:159], v[220:223], v[108:111], v[156:159]
ds_read_b128 v[220:223], v240 offset:27136
s_waitcnt lgkmcnt(2)
v_mfma_f32_16x16x32_bf16 v[144:147], v[208:211], v[16:19], v[144:147]
v_exp_f32 v136, v136
v_mfma_f32_16x16x32_bf16 v[144:147], v[212:215], v[20:23], v[144:147]
v_add_u32 v240, 0x8000, v240
v_mfma_f32_16x16x32_bf16 v[148:151], v[208:211], v[48:51], v[148:151]
v_and_b32 v240, 0x1ffff, v240
v_mfma_f32_16x16x32_bf16 v[148:151], v[212:215], v[52:55], v[148:151]
v_exp_f32 v137, v137
v_mfma_f32_16x16x32_bf16 v[152:155], v[208:211], v[80:83], v[152:155]
v_exp_f32 v138, v138
v_mfma_f32_16x16x32_bf16 v[152:155], v[212:215], v[84:87], v[152:155]
v_exp_f32 v139, v139
v_mfma_f32_16x16x32_bf16 v[156:159], v[208:211], v[112:115], v[156:159]
ds_read_b64_tr_b16 v[208:209], v244 offset:16384
ds_read_b64_tr_b16 v[210:211], v244 offset:18432
v_mfma_f32_16x16x32_bf16 v[156:159], v[212:215], v[116:119], v[156:159]
ds_read_b64_tr_b16 v[212:213], v246 offset:0
s_waitcnt lgkmcnt(3)
v_mfma_f32_16x16x32_bf16 v[144:147], v[216:219], v[24:27], v[144:147]
ds_read_b64_tr_b16 v[214:215], v246 offset:2048
v_mfma_f32_16x16x32_bf16 v[144:147], v[220:223], v[28:31], v[144:147]
v_exp_f32 v140, v140
v_mfma_f32_16x16x32_bf16 v[148:151], v[216:219], v[56:59], v[148:151]
v_exp_f32 v141, v141
v_mfma_f32_16x16x32_bf16 v[148:151], v[220:223], v[60:63], v[148:151]
v_exp_f32 v142, v142
v_mfma_f32_16x16x32_bf16 v[152:155], v[216:219], v[88:91], v[152:155]
v_exp_f32 v143, v143
v_mfma_f32_16x16x32_bf16 v[152:155], v[220:223], v[92:95], v[152:155]
v_mfma_f32_16x16x32_bf16 v[156:159], v[216:219], v[120:123], v[156:159]
ds_read_b64_tr_b16 v[216:217], v245 offset:16384
ds_read_b64_tr_b16 v[218:219], v245 offset:18432
v_mfma_f32_16x16x32_bf16 v[156:159], v[220:223], v[124:127], v[156:159]
ds_read_b64_tr_b16 v[220:221], v247 offset:0
s_waitcnt lgkmcnt(3)
v_mfma_f32_16x16x32_bf16 a[0:3], v[176:179], v[208:211], a[0:3]
ds_read_b64_tr_b16 v[222:223], v247 offset:2048
v_mfma_f32_16x16x32_bf16 a[0:3], v[160:163], v[212:215], a[0:3]
v_mfma_f32_16x16x32_bf16 a[4:7], v[180:183], v[208:211], a[4:7]
v_mfma_f32_16x16x32_bf16 a[4:7], v[164:167], v[212:215], a[4:7]
v_mfma_f32_16x16x32_bf16 a[8:11], v[184:187], v[208:211], a[8:11]
v_mfma_f32_16x16x32_bf16 a[8:11], v[168:171], v[212:215], a[8:11]
v_mfma_f32_16x16x32_bf16 a[12:15], v[188:191], v[208:211], a[12:15]
ds_read_b64_tr_b16 v[208:209], v244 offset:16896
ds_read_b64_tr_b16 v[210:211], v244 offset:18944
v_mfma_f32_16x16x32_bf16 a[12:15], v[172:175], v[212:215], a[12:15]
ds_read_b64_tr_b16 v[212:213], v246 offset:512
s_waitcnt lgkmcnt(3)
v_mfma_f32_16x16x32_bf16 a[16:19], v[176:179], v[216:219], a[16:19]
ds_read_b64_tr_b16 v[214:215], v246 offset:2560
v_mfma_f32_16x16x32_bf16 a[16:19], v[160:163], v[220:223], a[16:19]
v_exp_f32 v144, v144
v_mfma_f32_16x16x32_bf16 a[20:23], v[180:183], v[216:219], a[20:23]
v_exp_f32 v145, v145
v_mfma_f32_16x16x32_bf16 a[20:23], v[164:167], v[220:223], a[20:23]
v_exp_f32 v146, v146
v_mfma_f32_16x16x32_bf16 a[24:27], v[184:187], v[216:219], a[24:27]
v_exp_f32 v147, v147
v_mfma_f32_16x16x32_bf16 a[24:27], v[168:171], v[220:223], a[24:27]
v_exp_f32 v148, v148
v_mfma_f32_16x16x32_bf16 a[28:31], v[188:191], v[216:219], a[28:31]
ds_read_b64_tr_b16 v[216:217], v245 offset:16896
ds_read_b64_tr_b16 v[218:219], v245 offset:18944
v_mfma_f32_16x16x32_bf16 a[28:31], v[172:175], v[220:223], a[28:31]
ds_read_b64_tr_b16 v[220:221], v247 offset:512
s_waitcnt lgkmcnt(3)
v_mfma_f32_16x16x32_bf16 a[32:35], v[176:179], v[208:211], a[32:35]
ds_read_b64_tr_b16 v[222:223], v247 offset:2560
v_mfma_f32_16x16x32_bf16 a[32:35], v[160:163], v[212:215], a[32:35]
v_exp_f32 v149, v149
v_mfma_f32_16x16x32_bf16 a[36:39], v[180:183], v[208:211], a[36:39]
v_exp_f32 v150, v150
v_mfma_f32_16x16x32_bf16 a[36:39], v[164:167], v[212:215], a[36:39]
v_exp_f32 v151, v151
v_mfma_f32_16x16x32_bf16 a[40:43], v[184:187], v[208:211], a[40:43]
s_mov_b32 m0, s30
v_mfma_f32_16x16x32_bf16 a[40:43], v[168:171], v[212:215], a[40:43]
buffer_load_dwordx4 v241, s[12:15], s28 offen offset:0 sc1 lds
v_mfma_f32_16x16x32_bf16 a[44:47], v[188:191], v[208:211], a[44:47]
ds_read_b64_tr_b16 v[208:209], v244 offset:20480
ds_read_b64_tr_b16 v[210:211], v244 offset:22528
v_mfma_f32_16x16x32_bf16 a[44:47], v[172:175], v[212:215], a[44:47]
ds_read_b64_tr_b16 v[212:213], v246 offset:4096
s_waitcnt lgkmcnt(3)
v_mfma_f32_16x16x32_bf16 a[48:51], v[176:179], v[216:219], a[48:51]
ds_read_b64_tr_b16 v[214:215], v246 offset:6144
v_mfma_f32_16x16x32_bf16 a[48:51], v[160:163], v[220:223], a[48:51]
buffer_load_dwordx4 v241, s[12:15], s28 offen offset:1024 sc1 lds
v_mfma_f32_16x16x32_bf16 a[52:55], v[180:183], v[216:219], a[52:55]
v_exp_f32 v152, v152
v_mfma_f32_16x16x32_bf16 a[52:55], v[164:167], v[220:223], a[52:55]
v_exp_f32 v153, v153
v_mfma_f32_16x16x32_bf16 a[56:59], v[184:187], v[216:219], a[56:59]
v_exp_f32 v154, v154
v_mfma_f32_16x16x32_bf16 a[56:59], v[168:171], v[220:223], a[56:59]
buffer_load_dwordx4 v241, s[12:15], s28 offen offset:2048 sc1 lds
v_mfma_f32_16x16x32_bf16 a[60:63], v[188:191], v[216:219], a[60:63]
ds_read_b64_tr_b16 v[216:217], v245 offset:20480
ds_read_b64_tr_b16 v[218:219], v245 offset:22528
v_mfma_f32_16x16x32_bf16 a[60:63], v[172:175], v[220:223], a[60:63]
ds_read_b64_tr_b16 v[220:221], v247 offset:4096
s_waitcnt lgkmcnt(3)
v_mfma_f32_16x16x32_bf16 a[64:67], v[176:179], v[208:211], a[64:67]
ds_read_b64_tr_b16 v[222:223], v247 offset:6144
v_mfma_f32_16x16x32_bf16 a[64:67], v[160:163], v[212:215], a[64:67]
buffer_load_dwordx4 v241, s[12:15], s28 offen offset:3072 sc1 lds
v_mfma_f32_16x16x32_bf16 a[68:71], v[180:183], v[208:211], a[68:71]
v_exp_f32 v155, v155
v_mfma_f32_16x16x32_bf16 a[68:71], v[164:167], v[212:215], a[68:71]
v_exp_f32 v156, v156
v_mfma_f32_16x16x32_bf16 a[72:75], v[184:187], v[208:211], a[72:75]
v_exp_f32 v157, v157
v_mfma_f32_16x16x32_bf16 a[72:75], v[168:171], v[212:215], a[72:75]
v_exp_f32 v158, v158
v_mfma_f32_16x16x32_bf16 a[76:79], v[188:191], v[208:211], a[76:79]
ds_read_b64_tr_b16 v[208:209], v244 offset:20992
ds_read_b64_tr_b16 v[210:211], v244 offset:23040
v_mfma_f32_16x16x32_bf16 a[76:79], v[172:175], v[212:215], a[76:79]
ds_read_b64_tr_b16 v[212:213], v246 offset:4608
s_waitcnt lgkmcnt(3)
v_mfma_f32_16x16x32_bf16 a[80:83], v[176:179], v[216:219], a[80:83]
ds_read_b64_tr_b16 v[214:215], v246 offset:6656
v_mfma_f32_16x16x32_bf16 a[80:83], v[160:163], v[220:223], a[80:83]
v_exp_f32 v159, v159
v_mfma_f32_16x16x32_bf16 a[84:87], v[180:183], v[216:219], a[84:87]
v_mfma_f32_16x16x32_bf16 a[84:87], v[164:167], v[220:223], a[84:87]
v_mfma_f32_16x16x32_bf16 a[88:91], v[184:187], v[216:219], a[88:91]
v_mfma_f32_16x16x32_bf16 a[88:91], v[168:171], v[220:223], a[88:91]
v_mfma_f32_16x16x32_bf16 a[92:95], v[188:191], v[216:219], a[92:95]
ds_read_b64_tr_b16 v[216:217], v245 offset:20992
ds_read_b64_tr_b16 v[218:219], v245 offset:23040
v_mfma_f32_16x16x32_bf16 a[92:95], v[172:175], v[220:223], a[92:95]
ds_read_b64_tr_b16 v[220:221], v247 offset:4608
s_waitcnt lgkmcnt(3)
v_mfma_f32_16x16x32_bf16 a[96:99], v[176:179], v[208:211], a[96:99]
ds_read_b64_tr_b16 v[222:223], v247 offset:6656
v_mfma_f32_16x16x32_bf16 a[96:99], v[160:163], v[212:215], a[96:99]
s_waitcnt vmcnt(4)
s_barrier
v_mfma_f32_16x16x32_bf16 a[100:103], v[180:183], v[208:211], a[100:103]
v_mfma_f32_16x16x32_bf16 a[100:103], v[164:167], v[212:215], a[100:103]
v_mfma_f32_16x16x32_bf16 a[104:107], v[184:187], v[208:211], a[104:107]
v_mfma_f32_16x16x32_bf16 a[104:107], v[168:171], v[212:215], a[104:107]
v_mfma_f32_16x16x32_bf16 a[108:111], v[188:191], v[208:211], a[108:111]
ds_read_b128 v[208:211], v240 offset:12800
v_mfma_f32_16x16x32_bf16 a[108:111], v[172:175], v[212:215], a[108:111]
ds_read_b128 v[212:215], v240 offset:12288
s_waitcnt lgkmcnt(2)
v_mfma_f32_16x16x32_bf16 a[112:115], v[176:179], v[216:219], a[112:115]
v_mfma_f32_16x16x32_bf16 a[112:115], v[160:163], v[220:223], a[112:115]
v_cvt_pk_bf16_f32 v176, v128, v129
v_cvt_pk_bf16_f32 v177, v130, v131
v_mfma_f32_16x16x32_bf16 a[116:119], v[180:183], v[216:219], a[116:119]
v_cvt_pk_bf16_f32 v178, v144, v145
v_cvt_pk_bf16_f32 v179, v146, v147
v_mfma_f32_16x16x32_bf16 a[116:119], v[164:167], v[220:223], a[116:119]
v_cvt_pk_bf16_f32 v180, v132, v133
v_cvt_pk_bf16_f32 v181, v134, v135
v_mfma_f32_16x16x32_bf16 a[120:123], v[184:187], v[216:219], a[120:123]
v_cvt_pk_bf16_f32 v182, v148, v149
v_cvt_pk_bf16_f32 v183, v150, v151
v_mfma_f32_16x16x32_bf16 a[120:123], v[168:171], v[220:223], a[120:123]
v_cvt_pk_bf16_f32 v184, v136, v137
v_cvt_pk_bf16_f32 v185, v138, v139
v_mfma_f32_16x16x32_bf16 a[124:127], v[188:191], v[216:219], a[124:127]
ds_read_b128 v[216:219], v240 offset:0
v_or3_b32 v242, v176, v177, v178
v_mfma_f32_16x16x32_bf16 a[124:127], v[172:175], v[220:223], a[124:127]
ds_read_b128 v[220:223], v240 offset:512
s_waitcnt lgkmcnt(2)
v_mfma_f32_16x16x32_bf16 v[128:131], v[208:211], v[0:3], 0
v_cvt_pk_bf16_f32 v186, v152, v153
v_cvt_pk_bf16_f32 v187, v154, v155
v_mfma_f32_16x16x32_bf16 v[128:131], v[212:215], v[4:7], v[128:131]
v_cvt_pk_bf16_f32 v188, v140, v141
v_cvt_pk_bf16_f32 v189, v142, v143
v_mfma_f32_16x16x32_bf16 v[132:135], v[208:211], v[32:35], 0
v_cvt_pk_bf16_f32 v190, v156, v157
v_cvt_pk_bf16_f32 v191, v158, v159
v_mfma_f32_16x16x32_bf16 v[132:135], v[212:215], v[36:39], v[132:135]
v_or3_b32 v242, v242, v179, v180
v_or3_b32 v242, v242, v181, v182
v_mfma_f32_16x16x32_bf16 v[136:139], v[208:211], v[64:67], 0
v_or3_b32 v242, v242, v183, v184
v_or3_b32 v242, v242, v185, v186
v_mfma_f32_16x16x32_bf16 v[136:139], v[212:215], v[68:71], v[136:139]
v_or3_b32 v242, v242, v187, v188
v_or3_b32 v242, v242, v189, v190
v_mfma_f32_16x16x32_bf16 v[140:143], v[208:211], v[96:99], 0
ds_read_b128 v[208:211], v240 offset:4096
v_or_b32 v242, v242, v191
v_mfma_f32_16x16x32_bf16 v[140:143], v[212:215], v[100:103], v[140:143]
ds_read_b128 v[212:215], v240 offset:4608
s_waitcnt lgkmcnt(2)
v_mfma_f32_16x16x32_bf16 v[128:131], v[216:219], v[8:11], v[128:131]
v_lshl_or_b32 v242, v242, 16, v242
v_cmp_le_u32 vcc, 2.0, v242
v_mfma_f32_16x16x32_bf16 v[128:131], v[220:223], v[12:15], v[128:131]
v_mfma_f32_16x16x32_bf16 v[132:135], v[216:219], v[40:43], v[132:135]
v_mfma_f32_16x16x32_bf16 v[132:135], v[220:223], v[44:47], v[132:135]
s_cbranch_vccnz L2_rare_site0
L2_ret0:
v_mfma_f32_16x16x32_bf16 v[136:139], v[216:219], v[72:75], v[136:139]
v_mfma_f32_16x16x32_bf16 v[136:139], v[220:223], v[76:79], v[136:139]
v_mfma_f32_16x16x32_bf16 v[140:143], v[216:219], v[104:107], v[140:143]
ds_read_b128 v[216:219], v240 offset:8192
v_mfma_f32_16x16x32_bf16 v[140:143], v[220:223], v[108:111], v[140:143]
ds_read_b128 v[220:223], v240 offset:8704
s_waitcnt lgkmcnt(2)
v_mfma_f32_16x16x32_bf16 v[128:131], v[208:211], v[16:19], v[128:131]
v_mfma_f32_16x16x32_bf16 v[128:131], v[212:215], v[20:23], v[128:131]
v_mfma_f32_16x16x32_bf16 v[132:135], v[208:211], v[48:51], v[132:135]
v_mfma_f32_16x16x32_bf16 v[132:135], v[212:215], v[52:55], v[132:135]
v_mfma_f32_16x16x32_bf16 v[136:139], v[208:211], v[80:83], v[136:139]
v_mfma_f32_16x16x32_bf16 v[136:139], v[212:215], v[84:87], v[136:139]
s_sub_u32 s31, s31, 1
v_mfma_f32_16x16x32_bf16 v[140:143], v[208:211], v[112:115], v[140:143]
ds_read_b128 v[208:211], v240 offset:14848
v_mfma_f32_16x16x32_bf16 v[140:143], v[212:215], v[116:119], v[140:143]
ds_read_b128 v[212:215], v240 offset:14336
s_waitcnt lgkmcnt(2)
v_mfma_f32_16x16x32_bf16 v[128:131], v[216:219], v[24:27], v[128:131]
s_add_u32 s28, s28, s101
s_add_u32 s30, s30, 0x4000
v_mfma_f32_16x16x32_bf16 v[128:131], v[220:223], v[28:31], v[128:131]
s_and_b32 s30, s30, 0x1ffff
v_mfma_f32_16x16x32_bf16 v[132:135], v[216:219], v[56:59], v[132:135]
s_cmp_eq_u32 s31, 0
v_mfma_f32_16x16x32_bf16 v[132:135], v[220:223], v[60:63], v[132:135]
v_mfma_f32_16x16x32_bf16 v[136:139], v[216:219], v[88:91], v[136:139]
v_mfma_f32_16x16x32_bf16 v[136:139], v[220:223], v[92:95], v[136:139]
v_mfma_f32_16x16x32_bf16 v[140:143], v[216:219], v[120:123], v[140:143]
ds_read_b128 v[216:219], v240 offset:2048
v_mfma_f32_16x16x32_bf16 v[140:143], v[220:223], v[124:127], v[140:143]
ds_read_b128 v[220:223], v240 offset:2560
s_cbranch_scc1 L2_x1
L2_loop1:
s_waitcnt lgkmcnt(2)
L2_ret3:
v_mfma_f32_16x16x32_bf16 v[144:147], v[208:211], v[0:3], 0
v_mfma_f32_16x16x32_bf16 v[144:147], v[212:215], v[4:7], v[144:147]
v_mfma_f32_16x16x32_bf16 v[148:151], v[208:211], v[32:35], 0
v_mfma_f32_16x16x32_bf16 v[148:151], v[212:215], v[36:39], v[148:151]
v_mfma_f32_16x16x32_bf16 v[152:155], v[208:211], v[64:67], 0
v_exp_f32 v128, v128
v_mfma_f32_16x16x32_bf16 v[152:155], v[212:215], v[68:71], v[152:155]
v_exp_f32 v129, v129
v_mfma_f32_16x16x32_bf16 v[156:159], v[208:211], v[96:99], 0
ds_read_b128 v[208:211], v240 offset:6144
v_mfma_f32_16x16x32_bf16 v[156:159], v[212:215], v[100:103], v[156:159]
ds_read_b128 v[212:215], v240 offset:6656
s_waitcnt lgkmcnt(2)
v_mfma_f32_16x16x32_bf16 v[144:147], v[216:219], v[8:11], v[144:147]
v_exp_f32 v130, v130
v_mfma_f32_16x16x32_bf16 v[144:147], v[220:223], v[12:15], v[144:147]
v_exp_f32 v131, v131
v_mfma_f32_16x16x32_bf16 v[148:151], v[216:219], v[40:43], v[148:151]
v_exp_f32 v132, v132
v_mfma_f32_16x16x32_bf16 v[148:151], v[220:223], v[44:47], v[148:151]
v_exp_f32 v133, v133
v_mfma_f32_16x16x32_bf16 v[152:155], v[216:219], v[72:75], v[152:155]
v_exp_f32 v134, v134
v_mfma_f32_16x16x32_bf16 v[152:155], v[220:223], v[76:79], v[152:155]
v_exp_f32 v135, v135
v_mfma_f32_16x16x32_bf16 v[156:159], v[216:219], v[104:107], v[156:159]
ds_read_b128 v[216:219], v240 offset:10240
v_mfma_f32_16x16x32_bf16 v[156:159], v[220:223], v[108:111], v[156:159]
ds_read_b128 v[220:223], v240 offset:10752
s_waitcnt lgkmcnt(2)
v_mfma_f32_16x16x32_bf16 v[144:147], v[208:211], v[16:19], v[144:147]
v_exp_f32 v136, v136
v_mfma_f32_16x16x32_bf16 v[144:147], v[212:215], v[20:23], v[144:147]
v_exp_f32 v137, v137
v_mfma_f32_16x16x32_bf16 v[148:151], v[208:211], v[48:51], v[148:151]
v_exp_f32 v138, v138
v_mfma_f32_16x16x32_bf16 v[148:151], v[212:215], v[52:55], v[148:151]
v_exp_f32 v139, v139
v_mfma_f32_16x16x32_bf16 v[152:155], v[208:211], v[80:83], v[152:155]
v_exp_f32 v140, v140
v_mfma_f32_16x16x32_bf16 v[152:155], v[212:215], v[84:87], v[152:155]
v_exp_f32 v141, v141
v_mfma_f32_16x16x32_bf16 v[156:159], v[208:211], v[112:115], v[156:159]
ds_read_b64_tr_b16 v[208:209], v246 offset:8192
ds_read_b64_tr_b16 v[210:211], v246 offset:10240
v_mfma_f32_16x16x32_bf16 v[156:159], v[212:215], v[116:119], v[156:159]
ds_read_b64_tr_b16 v[212:213], v246 offset:24576
s_waitcnt lgkmcnt(3)
v_mfma_f32_16x16x32_bf16 v[144:147], v[216:219], v[24:27], v[144:147]
ds_read_b64_tr_b16 v[214:215], v246 offset:26624
v_mfma_f32_16x16x32_bf16 v[144:147], v[220:223], v[28:31], v[144:147]
v_exp_f32 v142, v142
v_mfma_f32_16x16x32_bf16 v[148:151], v[216:219], v[56:59], v[148:151]
v_exp_f32 v143, v143
v_mfma_f32_16x16x32_bf16 v[148:151], v[220:223], v[60:63], v[148:151]
v_mfma_f32_16x16x32_bf16 v[152:155], v[216:219], v[88:91], v[152:155]
v_mfma_f32_16x16x32_bf16 v[152:155], v[220:223], v[92:95], v[152:155]
v_mfma_f32_16x16x32_bf16 v[156:159], v[216:219], v[120:123], v[156:159]
ds_read_b64_tr_b16 v[216:217], v247 offset:8192
ds_read_b64_tr_b16 v[218:219], v247 offset:10240
v_mfma_f32_16x16x32_bf16 v[156:159], v[220:223], v[124:127], v[156:159]
ds_read_b64_tr_b16 v[220:221], v247 offset:24576
s_waitcnt lgkmcnt(3)
v_mfma_f32_16x16x32_bf16 a[128:131], v[160:163], v[208:211], a[128:131]
ds_read_b64_tr_b16 v[222:223], v247 offset:26624
v_mfma_f32_16x16x32_bf16 a[128:131], v[176:179], v[212:215], a[128:131]
v_mfma_f32_16x16x32_bf16 a[132:135], v[164:167], v[208:211], a[132:135]
v_mfma_f32_16x16x32_bf16 a[132:135], v[180:183], v[212:215], a[132:135]
v_mfma_f32_16x16x32_bf16 a[136:139], v[168:171], v[208:211], a[136:139]
v_mfma_f32_16x16x32_bf16 a[136:139], v[184:187], v[212:215], a[136:139]
v_mfma_f32_16x16x32_bf16 a[140:143], v[172:175], v[208:211], a[140:143]
ds_read_b64_tr_b16 v[208:209], v246 offset:8704
ds_read_b64_tr_b16 v[210:211], v246 offset:10752
v_mfma_f32_16x16x32_bf16 a[140:143], v[188:191], v[212:215], a[140:143]
ds_read_b64_tr_b16 v[212:213], v246 offset:25088
s_waitcnt lgkmcnt(3)
v_mfma_f32_16x16x32_bf16 a[144:147], v[160:163], v[216:219], a[144:147]
ds_read_b64_tr_b16 v[214:215], v246 offset:27136
v_mfma_f32_16x16x32_bf16 a[144:147], v[176:179], v[220:223], a[144:147]
v_exp_f32 v144, v144
v_mfma_f32_16x16x32_bf16 a[148:151], v[164:167], v[216:219], a[148:151]
v_exp_f32 v145, v145
v_mfma_f32_16x16x32_bf16 a[148:151], v[180:183], v[220:223], a[148:151]
v_exp_f32 v146, v146
v_mfma_f32_16x16x32_bf16 a[152:155], v[168:171], v[216:219], a[152:155]
v_exp_f32 v147, v147
v_mfma_f32_16x16x32_bf16 a[152:155], v[184:187], v[220:223], a[152:155]
v_exp_f32 v148, v148
v_mfma_f32_16x16x32_bf16 a[156:159], v[172:175], v[216:219], a[156:159]
ds_read_b64_tr_b16 v[216:217], v247 offset:8704
ds_read_b64_tr_b16 v[218:219], v247 offset:10752
v_mfma_f32_16x16x32_bf16 a[156:159], v[188:191], v[220:223], a[156:159]
ds_read_b64_tr_b16 v[220:221], v247 offset:25088
s_waitcnt lgkmcnt(3)
v_mfma_f32_16x16x32_bf16 a[160:163], v[160:163], v[208:211], a[160:163]
ds_read_b64_tr_b16 v[222:223], v247 offset:27136
v_mfma_f32_16x16x32_bf16 a[160:163], v[176:179], v[212:215], a[160:163]
v_exp_f32 v149, v149
v_mfma_f32_16x16x32_bf16 a[164:167], v[164:167], v[208:211], a[164:167]
v_exp_f32 v150, v150
v_mfma_f32_16x16x32_bf16 a[164:167], v[180:183], v[212:215], a[164:167]
v_exp_f32 v151, v151
v_mfma_f32_16x16x32_bf16 a[168:171], v[168:171], v[208:211], a[168:171]
s_mov_b32 m0, s30
v_mfma_f32_16x16x32_bf16 a[168:171], v[184:187], v[212:215], a[168:171]
buffer_load_dwordx4 v241, s[12:15], s28 offen offset:0 sc1 lds
v_mfma_f32_16x16x32_bf16 a[172:175], v[172:175], v[208:211], a[172:175]
ds_read_b64_tr_b16 v[208:209], v246 offset:12288
ds_read_b64_tr_b16 v[210:211], v246 offset:14336
v_mfma_f32_16x16x32_bf16 a[172:175], v[188:191], v[212:215], a[172:175]
ds_read_b64_tr_b16 v[212:213], v246 offset:28672
s_waitcnt lgkmcnt(3)
v_mfma_f32_16x16x32_bf16 a[176:179], v[160:163], v[216:219], a[176:179]
ds_read_b64_tr_b16 v[214:215], v246 offset:30720
v_mfma_f32_16x16x32_bf16 a[176:179], v[176:179], v[220:223], a[176:179]
buffer_load_dwordx4 v241, s[12:15], s28 offen offset:1024 sc1 lds
v_mfma_f32_16x16x32_bf16 a[180:183], v[164:167], v[216:219], a[180:183]
v_exp_f32 v152, v152
v_mfma_f32_16x16x32_bf16 a[180:183], v[180:183], v[220:223], a[180:183]
v_exp_f32 v153, v153
v_mfma_f32_16x16x32_bf16 a[184:187], v[168:171], v[216:219], a[184:187]
v_exp_f32 v154, v154
v_mfma_f32_16x16x32_bf16 a[184:187], v[184:187], v[220:223], a[184:187]
buffer_load_dwordx4 v241, s[12:15], s28 offen offset:2048 sc1 lds
v_mfma_f32_16x16x32_bf16 a[188:191], v[172:175], v[216:219], a[188:191]
ds_read_b64_tr_b16 v[216:217], v247 offset:12288
ds_read_b64_tr_b16 v[218:219], v247 offset:14336
v_mfma_f32_16x16x32_bf16 a[188:191], v[188:191], v[220:223], a[188:191]
ds_read_b64_tr_b16 v[220:221], v247 offset:28672
s_waitcnt lgkmcnt(3)
v_mfma_f32_16x16x32_bf16 a[192:195], v[160:163], v[208:211], a[192:195]
ds_read_b64_tr_b16 v[222:223], v247 offset:30720
v_mfma_f32_16x16x32_bf16 a[192:195], v[176:179], v[212:215], a[192:195]
buffer_load_dwordx4 v241, s[12:15], s28 offen offset:3072 sc1 lds
v_mfma_f32_16x16x32_bf16 a[196:199], v[164:167], v[208:211], a[196:199]
v_exp_f32 v155, v155
v_mfma_f32_16x16x32_bf16 a[196:199], v[180:183], v[212:215], a[196:199]
v_exp_f32 v156, v156
v_mfma_f32_16x16x32_bf16 a[200:203], v[168:171], v[208:211], a[200:203]
v_exp_f32 v157, v157
v_mfma_f32_16x16x32_bf16 a[200:203], v[184:187], v[212:215], a[200:203]
v_exp_f32 v158, v158
v_mfma_f32_16x16x32_bf16 a[204:207], v[172:175], v[208:211], a[204:207]
ds_read_b64_tr_b16 v[208:209], v246 offset:12800
ds_read_b64_tr_b16 v[210:211], v246 offset:14848
v_mfma_f32_16x16x32_bf16 a[204:207], v[188:191], v[212:215], a[204:207]
ds_read_b64_tr_b16 v[212:213], v246 offset:29184
s_waitcnt lgkmcnt(3)
v_mfma_f32_16x16x32_bf16 a[208:211], v[160:163], v[216:219], a[208:211]
ds_read_b64_tr_b16 v[214:215], v246 offset:31232
v_mfma_f32_16x16x32_bf16 a[208:211], v[176:179], v[220:223], a[208:211]
v_exp_f32 v159, v159
v_mfma_f32_16x16x32_bf16 a[212:215], v[164:167], v[216:219], a[212:215]
v_mfma_f32_16x16x32_bf16 a[212:215], v[180:183], v[220:223], a[212:215]
v_mfma_f32_16x16x32_bf16 a[216:219], v[168:171], v[216:219], a[216:219]
v_mfma_f32_16x16x32_bf16 a[216:219], v[184:187], v[220:223], a[216:219]
v_mfma_f32_16x16x32_bf16 a[220:223], v[172:175], v[216:219], a[220:223]
ds_read_b64_tr_b16 v[216:217], v247 offset:12800
ds_read_b64_tr_b16 v[218:219], v247 offset:14848
v_mfma_f32_16x16x32_bf16 a[220:223], v[188:191], v[220:223], a[220:223]
ds_read_b64_tr_b16 v[220:221], v247 offset:29184
s_waitcnt lgkmcnt(3)
v_mfma_f32_16x16x32_bf16 a[224:227], v[160:163], v[208:211], a[224:227]
ds_read_b64_tr_b16 v[222:223], v247 offset:31232
v_mfma_f32_16x16x32_bf16 a[224:227], v[176:179], v[212:215], a[224:227]
s_waitcnt vmcnt(4)
s_barrier
v_mfma_f32_16x16x32_bf16 a[228:231], v[164:167], v[208:211], a[228:231]
v_mfma_f32_16x16x32_bf16 a[228:231], v[180:183], v[212:215], a[228:231]
v_mfma_f32_16x16x32_bf16 a[232:235], v[168:171], v[208:211], a[232:235]
v_mfma_f32_16x16x32_bf16 a[232:235], v[184:187], v[212:215], a[232:235]
v_mfma_f32_16x16x32_bf16 a[236:239], v[172:175], v[208:211], a[236:239]
ds_read_b128 v[208:211], v240 offset:29184
v_mfma_f32_16x16x32_bf16 a[236:239], v[188:191], v[212:215], a[236:239]
ds_read_b128 v[212:215], v240 offset:28672
s_waitcnt lgkmcnt(2)
v_mfma_f32_16x16x32_bf16 a[240:243], v[160:163], v[216:219], a[240:243]
v_mfma_f32_16x16x32_bf16 a[240:243], v[176:179], v[220:223], a[240:243]
v_cvt_pk_bf16_f32 v160, v128, v129
v_cvt_pk_bf16_f32 v161, v130, v131
v_mfma_f32_16x16x32_bf16 a[244:247], v[164:167], v[216:219], a[244:247]
v_cvt_pk_bf16_f32 v162, v144, v145
v_cvt_pk_bf16_f32 v163, v146, v147
v_mfma_f32_16x16x32_bf16 a[244:247], v[180:183], v[220:223], a[244:247]
v_cvt_pk_bf16_f32 v164, v132, v133
v_cvt_pk_bf16_f32 v165, v134, v135
v_mfma_f32_16x16x32_bf16 a[248:251], v[168:171], v[216:219], a[248:251]
v_cvt_pk_bf16_f32 v166, v148, v149
v_cvt_pk_bf16_f32 v167, v150, v151
v_mfma_f32_16x16x32_bf16 a[248:251], v[184:187], v[220:223], a[248:251]
v_cvt_pk_bf16_f32 v168, v136, v137
v_cvt_pk_bf16_f32 v169, v138, v139
v_mfma_f32_16x16x32_bf16 a[252:255], v[172:175], v[216:219], a[252:255]
ds_read_b128 v[216:219], v240 offset:16384
v_or3_b32 v242, v160, v161, v162
v_mfma_f32_16x16x32_bf16 a[252:255], v[188:191], v[220:223], a[252:255]
ds_read_b128 v[220:223], v240 offset:16896
s_waitcnt lgkmcnt(2)
v_mfma_f32_16x16x32_bf16 v[128:131], v[208:211], v[0:3], 0
v_cvt_pk_bf16_f32 v170, v152, v153
v_cvt_pk_bf16_f32 v171, v154, v155
v_mfma_f32_16x16x32_bf16 v[128:131], v[212:215], v[4:7], v[128:131]
v_cvt_pk_bf16_f32 v172, v140, v141
v_cvt_pk_bf16_f32 v173, v142, v143
v_mfma_f32_16x16x32_bf16 v[132:135], v[208:211], v[32:35], 0
v_cvt_pk_bf16_f32 v174, v156, v157
v_cvt_pk_bf16_f32 v175, v158, v159
v_mfma_f32_16x16x32_bf16 v[132:135], v[212:215], v[36:39], v[132:135]
v_or3_b32 v242, v242, v163, v164
v_or3_b32 v242, v242, v165, v166
v_mfma_f32_16x16x32_bf16 v[136:139], v[208:211], v[64:67], 0
v_or3_b32 v242, v242, v167, v168
v_or3_b32 v242, v242, v169, v170
v_mfma_f32_16x16x32_bf16 v[136:139], v[212:215], v[68:71], v[136:139]
v_or3_b32 v242, v242, v171, v172
v_or3_b32 v242, v242, v173, v174
v_mfma_f32_16x16x32_bf16 v[140:143], v[208:211], v[96:99], 0
ds_read_b128 v[208:211], v240 offset:20480
v_or_b32 v242, v242, v175
v_mfma_f32_16x16x32_bf16 v[140:143], v[212:215], v[100:103], v[140:143]
ds_read_b128 v[212:215], v240 offset:20992
s_waitcnt lgkmcnt(2)
v_mfma_f32_16x16x32_bf16 v[128:131], v[216:219], v[8:11], v[128:131]
v_mov_b32 v244, v246
v_mov_b32 v245, v247
v_mfma_f32_16x16x32_bf16 v[128:131], v[220:223], v[12:15], v[128:131]
v_add_u32 v246, 0x8000, v246
v_lshl_or_b32 v242, v242, 16, v242
v_mfma_f32_16x16x32_bf16 v[132:135], v[216:219], v[40:43], v[132:135]
v_and_b32 v246, 0x1ffff, v246
v_cmp_le_u32 vcc, 2.0, v242
v_mfma_f32_16x16x32_bf16 v[132:135], v[220:223], v[44:47], v[132:135]
v_mfma_f32_16x16x32_bf16 v[136:139], v[216:219], v[72:75], v[136:139]
v_xor_b32 v247, 32, v246
v_mfma_f32_16x16x32_bf16 v[136:139], v[220:223], v[76:79], v[136:139]
s_cbranch_vccnz L2_rare_site2
L2_ret2:
v_mfma_f32_16x16x32_bf16 v[140:143], v[216:219], v[104:107], v[140:143]
ds_read_b128 v[216:219], v240 offset:24576
v_mfma_f32_16x16x32_bf16 v[140:143], v[220:223], v[108:111], v[140:143]
ds_read_b128 v[220:223], v240 offset:25088
s_waitcnt lgkmcnt(2)
v_mfma_f32_16x16x32_bf16 v[128:131], v[208:211], v[16:19], v[128:131]
v_mfma_f32_16x16x32_bf16 v[128:131], v[212:215], v[20:23], v[128:131]
v_mfma_f32_16x16x32_bf16 v[132:135], v[208:211], v[48:51], v[132:135]
v_mfma_f32_16x16x32_bf16 v[132:135], v[212:215], v[52:55], v[132:135]
v_mfma_f32_16x16x32_bf16 v[136:139], v[208:211], v[80:83], v[136:139]
v_mfma_f32_16x16x32_bf16 v[136:139], v[212:215], v[84:87], v[136:139]
s_sub_u32 s31, s31, 1
v_mfma_f32_16x16x32_bf16 v[140:143], v[208:211], v[112:115], v[140:143]
ds_read_b128 v[208:211], v240 offset:31232
v_mfma_f32_16x16x32_bf16 v[140:143], v[212:215], v[116:119], v[140:143]
ds_read_b128 v[212:215], v240 offset:30720
s_waitcnt lgkmcnt(2)
v_mfma_f32_16x16x32_bf16 v[128:131], v[216:219], v[24:27], v[128:131]
s_add_u32 s28, s28, s101
s_add_u32 s30, s30, 0x4000
v_mfma_f32_16x16x32_bf16 v[128:131], v[220:223], v[28:31], v[128:131]
s_and_b32 s30, s30, 0x1ffff
v_mfma_f32_16x16x32_bf16 v[132:135], v[216:219], v[56:59], v[132:135]
s_cmp_eq_u32 s31, 0
v_mfma_f32_16x16x32_bf16 v[132:135], v[220:223], v[60:63], v[132:135]
v_mfma_f32_16x16x32_bf16 v[136:139], v[216:219], v[88:91], v[136:139]
v_mfma_f32_16x16x32_bf16 v[136:139], v[220:223], v[92:95], v[136:139]
v_mfma_f32_16x16x32_bf16 v[140:143], v[216:219], v[120:123], v[140:143]
ds_read_b128 v[216:219], v240 offset:18432
v_mfma_f32_16x16x32_bf16 v[140:143], v[220:223], v[124:127], v[140:143]
ds_read_b128 v[220:223], v240 offset:18944
s_cbranch_scc0 L2_loop
s_cmp_eq_u32 s100, 0
s_cbranch_scc1 L2_tail_0
s_mov_b32 s3, 0
s_branch L2_ev
L2_x1:
s_cmp_eq_u32 s100, 0
s_cbranch_scc1 L2_tail_1
s_mov_b32 s3, 1
L2_ev:
s_sub_u32 s100, s100, 1
s_mov_b32 s31, 1
v_mov_b32 v230, 0x20000
s_cmp_eq_u32 s100, 0
s_cbranch_scc1 L2_ev5
s_cmp_lg_u32 s34, 0
s_cbranch_scc1 L2_evr
s_mov_b64 exec, 1
s_cmp_eq_u32 s100, 4
s_cbranch_scc1 L2_ev1
s_cmp_eq_u32 s100, 1
s_cbranch_scc1 L2_ev4
v_cmp_eq_u64 vcc, s[98:99], v[228:229]
s_nop 1
s_bitcmp1_b32 vcc_lo, 0
s_subb_u32 s39, s39, 0
v_mov_b32 v228, s98
v_mov_b32 v229, s99
s_cmp_eq_u32 s100, 2
s_cbranch_scc1 L2_ev3
buffer_atomic_swap_x2 v[228:229], off, s[16:19], s49 offset:0 sc0 sc1
s_branch L2_evx
L2_ev1:
v_mov_b32 v228, s98
v_mov_b32 v229, s99
buffer_atomic_swap_x2 v[228:229], off, s[16:19], s95 offset:16 sc0 sc1
s_branch L2_evx
L2_ev3:
v_mov_b32 v252, s98
v_mov_b32 v253, s99
buffer_atomic_swap_x2 v[228:229], off, s[16:19], s35 offset:0 sc0 sc1
buffer_atomic_swap_x2 v[252:253], off, s[16:19], s94 offset:16 sc0 sc1
s_branch L2_evx
L2_ev4:
v_cmp_ne_u64 vcc, s[98:99], v[228:229]
s_nop 1
s_bitcmp1_b32 vcc_lo, 0
s_addc_u32 s39, s39, 0
v_cmp_ne_u64 vcc, s[98:99], v[252:253]
s_nop 1
s_bitcmp1_b32 vcc_lo, 0
s_addc_u32 s39, s39, 0
v_mov_b32 v228, s39
ds_write_b32 v230, v228
L2_evx:
s_mov_b64 exec, -1
s_branch L2_evr
L2_ev5:
ds_read_b32 v228, v230
s_waitcnt lgkmcnt(0)
v_readfirstlane_b32 s31, v228
L2_evr:
s_cmp_eq_u32 s3, 0
s_cbranch_scc1 L2_loop
s_branch L2_loop1
L2_tail_0:
s_waitcnt lgkmcnt(2)
v_add_u32 v231, s50, v243
v_mfma_f32_16x16x32_bf16 v[144:147], v[208:211], v[0:3], 0
s_mov_b32 m0, s30
ds_write_b128 v231, v[176:179] offset:0
v_mfma_f32_16x16x32_bf16 v[144:147], v[212:215], v[4:7], v[144:147]
buffer_load_dwordx4 v241, s[12:15], s28 offen offset:0 sc1 lds
ds_write_b128 v231, v[180:183] offset:1024
v_mfma_f32_16x16x32_bf16 v[148:151], v[208:211], v[32:35], 0
buffer_load_dwordx4 v241, s[12:15], s28 offen offset:1024 sc1 lds
ds_write_b128 v231, v[184:187] offset:2048
v_mfma_f32_16x16x32_bf16 v[148:151], v[212:215], v[36:39], v[148:151]
buffer_load_dwordx4 v241, s[12:15], s28 offen offset:2048 sc1 lds
ds_write_b128 v231, v[188:191] offset:3072
v_mfma_f32_16x16x32_bf16 v[152:155], v[208:211], v[64:67], 0
buffer_load_dwordx4 v241, s[12:15], s28 offen offset:3072 sc1 lds
v_add_u32 v230, 0x8000, v240
v_and_b32 v230, 0x1ffff, v230
v_mfma_f32_16x16x32_bf16 v[152:155], v[212:215], v[68:71], v[152:155]
v_exp_f32 v232, v128
v_mfma_f32_16x16x32_bf16 v[156:159], v[208:211], v[96:99], 0
ds_read_b128 v[208:211], v240 offset:22528
v_exp_f32 v233, v129
v_mfma_f32_16x16x32_bf16 v[156:159], v[212:215], v[100:103], v[156:159]
ds_read_b128 v[212:215], v240 offset:23040
s_waitcnt lgkmcnt(2)
s_and_b32 s30, s30, 0x1c000
v_mfma_f32_16x16x32_bf16 v[144:147], v[216:219], v[8:11], v[144:147]
v_exp_f32 v234, v130
v_cvt_pk_bf16_f32 v176, v232, v233
v_mfma_f32_16x16x32_bf16 v[144:147], v[220:223], v[12:15], v[144:147]
v_exp_f32 v235, v131
s_add_u32 s28, s30, 0xc000
v_mfma_f32_16x16x32_bf16 v[148:151], v[216:219], v[40:43], v[148:151]
v_exp_f32 v236, v132
v_cvt_pk_bf16_f32 v177, v234, v235
v_mfma_f32_16x16x32_bf16 v[148:151], v[220:223], v[44:47], v[148:151]
v_exp_f32 v237, v133
s_and_b32 s28, s28, 0x1ffff
v_mfma_f32_16x16x32_bf16 v[152:155], v[216:219], v[72:75], v[152:155]
v_exp_f32 v238, v134
v_cvt_pk_bf16_f32 v180, v236, v237
v_mfma_f32_16x16x32_bf16 v[152:155], v[220:223], v[76:79], v[152:155]
v_exp_f32 v239, v135
s_add_u32 s30, s30, 0x4000
v_mfma_f32_16x16x32_bf16 v[156:159], v[216:219], v[104:107], v[156:159]
ds_read_b128 v[216:219], v240 offset:26624
v_exp_f32 v232, v136
v_mfma_f32_16x16x32_bf16 v[156:159], v[220:223], v[108:111], v[156:159]
ds_read_b128 v[220:223], v240 offset:27136
s_waitcnt lgkmcnt(2)
v_cvt_pk_bf16_f32 v181, v238, v239
v_mfma_f32_16x16x32_bf16 v[144:147], v[208:211], v[16:19], v[144:147]
v_exp_f32 v233, v137
s_and_b32 s30, s30, 0x1ffff
v_mfma_f32_16x16x32_bf16 v[144:147], v[212:215], v[20:23], v[144:147]
s_waitcnt vmcnt(4)
s_barrier
s_mul_i32 s31, s34, 6144
v_mfma_f32_16x16x32_bf16 v[148:151], v[208:211], v[48:51], v[148:151]
v_exp_f32 v234, v138
v_cvt_pk_bf16_f32 v184, v232, v233
v_mfma_f32_16x16x32_bf16 v[148:151], v[212:215], v[52:55], v[148:151]
v_exp_f32 v235, v139
s_add_u32 s31, s31, s30
v_mfma_f32_16x16x32_bf16 v[152:155], v[208:211], v[80:83], v[152:155]
v_exp_f32 v236, v140
v_cvt_pk_bf16_f32 v185, v234, v235
v_mfma_f32_16x16x32_bf16 v[152:155], v[212:215], v[84:87], v[152:155]
v_exp_f32 v237, v141
s_lshl_b32 s3, s34, 10
v_mfma_f32_16x16x32_bf16 v[156:159], v[208:211], v[112:115], v[156:159]
ds_read_b128 v[208:211], v230 offset:12800
v_exp_f32 v238, v142
v_mfma_f32_16x16x32_bf16 v[156:159], v[212:215], v[116:119], v[156:159]
ds_read_b128 v[212:215], v230 offset:12288
s_waitcnt lgkmcnt(2)
v_cvt_pk_bf16_f32 v188, v236, v237
v_mfma_f32_16x16x32_bf16 v[144:147], v[216:219], v[24:27], v[144:147]
v_exp_f32 v239, v143
v_or3_b32 v242, v176, v177, v180
v_mfma_f32_16x16x32_bf16 v[144:147], v[220:223], v[28:31], v[144:147]
v_cvt_pk_bf16_f32 v189, v238, v239
v_or3_b32 v242, v242, v181, v184
v_or3_b32 v242, v242, v185, v188
v_mfma_f32_16x16x32_bf16 v[148:151], v[216:219], v[56:59], v[148:151]
v_or_b32 v242, v242, v189
v_lshl_or_b32 v242, v242, 16, v242
v_cmp_le_u32 vcc, 2.0, v242
v_mfma_f32_16x16x32_bf16 v[148:151], v[220:223], v[60:63], v[148:151]
s_add_u32 s28, s28, s3
s_add_u32 s3, s3, 24576
s_add_u32 s30, s30, s3
v_mfma_f32_16x16x32_bf16 v[152:155], v[216:219], v[88:91], v[152:155]
v_lshrrev_b32 v241, 4, v243
v_and_b32 v241, 0x30, v241
v_xor_b32 v241, v241, v243
v_mfma_f32_16x16x32_bf16 v[152:155], v[220:223], v[92:95], v[152:155]
s_cbranch_vccnz L2_rare_site6
L2_ret6:
v_and_b32 v228, 0x380, v243
v_mad_u32_u24 v241, v228, 3, v241
v_mfma_f32_16x16x32_bf16 v[156:159], v[216:219], v[120:123], v[156:159]
ds_read_b128 v[216:219], v230 offset:0
s_add_u32 m0, s31, 0
v_mfma_f32_16x16x32_bf16 v[156:159], v[220:223], v[124:127], v[156:159]
ds_read_b128 v[220:223], v230 offset:512
s_waitcnt lgkmcnt(2)
v_mfma_f32_16x16x32_bf16 v[128:131], v[208:211], v[0:3], 0
buffer_load_dwordx4 v241, s[8:11], s6 offen lds
s_add_u32 m0, s31, 2048
v_mfma_f32_16x16x32_bf16 v[128:131], v[212:215], v[4:7], v[128:131]
v_exp_f32 v232, v144
v_mfma_f32_16x16x32_bf16 v[132:135], v[208:211], v[32:35], 0
v_exp_f32 v233, v145
v_mfma_f32_16x16x32_bf16 v[132:135], v[212:215], v[36:39], v[132:135]
v_exp_f32 v234, v146
v_cvt_pk_bf16_f32 v178, v232, v233
v_mfma_f32_16x16x32_bf16 v[136:139], v[208:211], v[64:67], 0
v_exp_f32 v235, v147
v_mfma_f32_16x16x32_bf16 v[136:139], v[212:215], v[68:71], v[136:139]
v_exp_f32 v236, v148
v_cvt_pk_bf16_f32 v179, v234, v235
v_mfma_f32_16x16x32_bf16 v[140:143], v[208:211], v[96:99], 0
ds_read_b128 v[208:211], v230 offset:4096
v_exp_f32 v237, v149
v_mfma_f32_16x16x32_bf16 v[140:143], v[212:215], v[100:103], v[140:143]
ds_read_b128 v[212:215], v230 offset:4608
s_waitcnt lgkmcnt(2)
v_mfma_f32_16x16x32_bf16 v[128:131], v[216:219], v[8:11], v[128:131]
ds_write_b128 v231, v[160:163] offset:4096
v_exp_f32 v238, v150
v_mfma_f32_16x16x32_bf16 v[128:131], v[220:223], v[12:15], v[128:131]
ds_write_b128 v231, v[164:167] offset:5120
v_cvt_pk_bf16_f32 v182, v236, v237
v_mfma_f32_16x16x32_bf16 v[132:135], v[216:219], v[40:43], v[132:135]
ds_write_b128 v231, v[168:171] offset:6144
v_exp_f32 v239, v151
v_mfma_f32_16x16x32_bf16 v[132:135], v[220:223], v[44:47], v[132:135]
ds_write_b128 v231, v[172:175] offset:7168
v_exp_f32 v232, v152
v_mfma_f32_16x16x32_bf16 v[136:139], v[216:219], v[72:75], v[136:139]
v_cvt_pk_bf16_f32 v183, v238, v239
v_exp_f32 v233, v153
v_mfma_f32_16x16x32_bf16 v[136:139], v[220:223], v[76:79], v[136:139]
v_exp_f32 v234, v154
v_cvt_pk_bf16_f32 v186, v232, v233
v_mfma_f32_16x16x32_bf16 v[140:143], v[216:219], v[104:107], v[140:143]
ds_read_b128 v[216:219], v230 offset:8192
v_exp_f32 v235, v155
v_mfma_f32_16x16x32_bf16 v[140:143], v[220:223], v[108:111], v[140:143]
ds_read_b128 v[220:223], v230 offset:8704
s_waitcnt lgkmcnt(2)
v_mfma_f32_16x16x32_bf16 v[128:131], v[208:211], v[16:19], v[128:131]
v_exp_f32 v236, v156
v_cvt_pk_bf16_f32 v187, v234, v235
v_mfma_f32_16x16x32_bf16 v[128:131], v[212:215], v[20:23], v[128:131]
v_exp_f32 v237, v157
v_mfma_f32_16x16x32_bf16 v[132:135], v[208:211], v[48:51], v[132:135]
v_exp_f32 v238, v158
v_cvt_pk_bf16_f32 v190, v236, v237
v_mfma_f32_16x16x32_bf16 v[132:135], v[212:215], v[52:55], v[132:135]
v_exp_f32 v239, v159
v_or3_b32 v242, v178, v179, v182
v_mfma_f32_16x16x32_bf16 v[136:139], v[208:211], v[80:83], v[136:139]
v_cvt_pk_bf16_f32 v191, v238, v239
v_or3_b32 v242, v242, v183, v186
v_or3_b32 v242, v242, v187, v190
v_mfma_f32_16x16x32_bf16 v[136:139], v[212:215], v[84:87], v[136:139]
v_or_b32 v242, v242, v191
v_lshl_or_b32 v242, v242, 16, v242
v_cmp_le_u32 vcc, 2.0, v242
s_cbranch_vccnz L2_rare_site7
L2_ret7:
v_mfma_f32_16x16x32_bf16 v[140:143], v[208:211], v[112:115], v[140:143]
ds_read_b128 v[208:211], v230 offset:14848
buffer_load_dwordx4 v241, s[8:11], s7 offen lds
s_add_u32 m0, s31, 4096
v_mfma_f32_16x16x32_bf16 v[140:143], v[212:215], v[116:119], v[140:143]
ds_read_b128 v[212:215], v230 offset:14336
s_waitcnt lgkmcnt(2)
v_mfma_f32_16x16x32_bf16 v[128:131], v[216:219], v[24:27], v[128:131]
buffer_load_dwordx4 v241, s[8:11], s29 offen lds
s_add_u32 m0, s31, 1024
v_xor_b32 v241, 0x1040, v241
v_mfma_f32_16x16x32_bf16 v[128:131], v[220:223], v[28:31], v[128:131]
buffer_load_dwordx4 v241, s[8:11], s6 offen lds
s_add_u32 m0, s31, 3072
v_mfma_f32_16x16x32_bf16 v[132:135], v[216:219], v[56:59], v[132:135]
buffer_load_dwordx4 v241, s[8:11], s7 offen lds
s_add_u32 m0, s31, 5120
v_mfma_f32_16x16x32_bf16 v[132:135], v[220:223], v[60:63], v[132:135]
buffer_load_dwordx4 v241, s[8:11], s29 offen lds
v_mfma_f32_16x16x32_bf16 v[136:139], v[216:219], v[88:91], v[136:139]
v_mfma_f32_16x16x32_bf16 v[136:139], v[220:223], v[92:95], v[136:139]
v_mfma_f32_16x16x32_bf16 v[140:143], v[216:219], v[120:123], v[140:143]
ds_read_b128 v[216:219], v230 offset:2048
v_mfma_f32_16x16x32_bf16 v[140:143], v[220:223], v[124:127], v[140:143]
ds_read_b128 v[220:223], v230 offset:2560
s_waitcnt lgkmcnt(2)
v_mfma_f32_16x16x32_bf16 v[144:147], v[208:211], v[0:3], 0
v_mfma_f32_16x16x32_bf16 v[144:147], v[212:215], v[4:7], v[144:147]
v_exp_f32 v232, v128
v_mfma_f32_16x16x32_bf16 v[148:151], v[208:211], v[32:35], 0
v_exp_f32 v233, v129
v_mfma_f32_16x16x32_bf16 v[148:151], v[212:215], v[36:39], v[148:151]
v_exp_f32 v234, v130
v_cvt_pk_bf16_f32 v160, v232, v233
v_mfma_f32_16x16x32_bf16 v[152:155], v[208:211], v[64:67], 0
v_exp_f32 v235, v131
v_mfma_f32_16x16x32_bf16 v[152:155], v[212:215], v[68:71], v[152:155]
v_exp_f32 v236, v132
v_cvt_pk_bf16_f32 v161, v234, v235
v_mfma_f32_16x16x32_bf16 v[156:159], v[208:211], v[96:99], 0
ds_read_b128 v[208:211], v230 offset:6144
v_exp_f32 v237, v133
v_mfma_f32_16x16x32_bf16 v[156:159], v[212:215], v[100:103], v[156:159]
ds_read_b128 v[212:215], v230 offset:6656
s_waitcnt lgkmcnt(2)
v_mfma_f32_16x16x32_bf16 v[144:147], v[216:219], v[8:11], v[144:147]
v_exp_f32 v238, v134
v_cvt_pk_bf16_f32 v164, v236, v237
v_mfma_f32_16x16x32_bf16 v[144:147], v[220:223], v[12:15], v[144:147]
v_exp_f32 v239, v135
v_mfma_f32_16x16x32_bf16 v[148:151], v[216:219], v[40:43], v[148:151]
v_exp_f32 v232, v136
v_cvt_pk_bf16_f32 v165, v238, v239
v_mfma_f32_16x16x32_bf16 v[148:151], v[220:223], v[44:47], v[148:151]
v_exp_f32 v233, v137
v_mfma_f32_16x16x32_bf16 v[152:155], v[216:219], v[72:75], v[152:155]
v_exp_f32 v234, v138
v_cvt_pk_bf16_f32 v168, v232, v233
v_mfma_f32_16x16x32_bf16 v[152:155], v[220:223], v[76:79], v[152:155]
v_exp_f32 v235, v139
v_mfma_f32_16x16x32_bf16 v[156:159], v[216:219], v[104:107], v[156:159]
ds_read_b128 v[216:219], v230 offset:10240
v_exp_f32 v236, v140
v_mfma_f32_16x16x32_bf16 v[156:159], v[220:223], v[108:111], v[156:159]
ds_read_b128 v[220:223], v230 offset:10752
s_waitcnt lgkmcnt(2)
v_cvt_pk_bf16_f32 v169, v234, v235
v_mfma_f32_16x16x32_bf16 v[144:147], v[208:211], v[16:19], v[144:147]
v_exp_f32 v237, v141
v_mfma_f32_16x16x32_bf16 v[144:147], v[212:215], v[20:23], v[144:147]
s_waitcnt vmcnt(6)
s_barrier
v_mfma_f32_16x16x32_bf16 v[148:151], v[208:211], v[48:51], v[148:151]
v_exp_f32 v238, v142
v_cvt_pk_bf16_f32 v172, v236, v237
v_mfma_f32_16x16x32_bf16 v[148:151], v[212:215], v[52:55], v[148:151]
v_exp_f32 v239, v143
v_or3_b32 v242, v160, v161, v164
v_mfma_f32_16x16x32_bf16 v[152:155], v[208:211], v[80:83], v[152:155]
v_cvt_pk_bf16_f32 v173, v238, v239
v_or3_b32 v242, v242, v165, v168
v_or3_b32 v242, v242, v169, v172
v_mfma_f32_16x16x32_bf16 v[152:155], v[212:215], v[84:87], v[152:155]
v_or_b32 v242, v242, v173
v_lshl_or_b32 v242, v242, 16, v242
v_cmp_le_u32 vcc, 2.0, v242
s_cbranch_vccnz L2_rare_site8
L2_ret8:
v_mfma_f32_16x16x32_bf16 v[156:159], v[208:211], v[112:115], v[156:159]
ds_read_b128 v[208:211], v230 offset:29184
v_mfma_f32_16x16x32_bf16 v[156:159], v[212:215], v[116:119], v[156:159]
ds_read_b128 v[212:215], v230 offset:28672
s_waitcnt lgkmcnt(2)
v_mfma_f32_16x16x32_bf16 v[144:147], v[216:219], v[24:27], v[144:147]
v_mfma_f32_16x16x32_bf16 v[144:147], v[220:223], v[28:31], v[144:147]
v_mfma_f32_16x16x32_bf16 v[148:151], v[216:219], v[56:59], v[148:151]
v_mfma_f32_16x16x32_bf16 v[148:151], v[220:223], v[60:63], v[148:151]
v_mfma_f32_16x16x32_bf16 v[152:155], v[216:219], v[88:91], v[152:155]
v_mfma_f32_16x16x32_bf16 v[152:155], v[220:223], v[92:95], v[152:155]
v_mfma_f32_16x16x32_bf16 v[156:159], v[216:219], v[120:123], v[156:159]
ds_read_b128 v[216:219], v230 offset:16384
v_mfma_f32_16x16x32_bf16 v[156:159], v[220:223], v[124:127], v[156:159]
ds_read_b128 v[220:223], v230 offset:16896
s_waitcnt lgkmcnt(2)
v_mfma_f32_16x16x32_bf16 v[128:131], v[208:211], v[0:3], 0
v_mfma_f32_16x16x32_bf16 v[128:131], v[212:215], v[4:7], v[128:131]
v_exp_f32 v232, v144
v_mfma_f32_16x16x32_bf16 v[132:135], v[208:211], v[32:35], 0
v_exp_f32 v233, v145
v_mfma_f32_16x16x32_bf16 v[132:135], v[212:215], v[36:39], v[132:135]
v_exp_f32 v234, v146
v_cvt_pk_bf16_f32 v162, v232, v233
v_mfma_f32_16x16x32_bf16 v[136:139], v[208:211], v[64:67], 0
v_exp_f32 v235, v147
v_lshlrev_b32 v241, 3, v243
v_mfma_f32_16x16x32_bf16 v[136:139], v[212:215], v[68:71], v[136:139]
v_exp_f32 v236, v148
v_cvt_pk_bf16_f32 v163, v234, v235
v_mfma_f32_16x16x32_bf16 v[140:143], v[208:211], v[96:99], 0
ds_read_b128 v[208:211], v230 offset:20480
v_exp_f32 v237, v149
v_mfma_f32_16x16x32_bf16 v[140:143], v[212:215], v[100:103], v[140:143]
ds_read_b128 v[212:215], v230 offset:20992
s_waitcnt lgkmcnt(2)
s_mov_b32 s3, 0x7c28000
v_mfma_f32_16x16x32_bf16 v[128:131], v[216:219], v[8:11], v[128:131]
v_exp_f32 v238, v150
v_cvt_pk_bf16_f32 v166, v236, v237
v_mfma_f32_16x16x32_bf16 v[128:131], v[220:223], v[12:15], v[128:131]
v_exp_f32 v239, v151
buffer_load_dwordx2 v[240:241], v241, s[16:19], s3 offen sc1
v_mfma_f32_16x16x32_bf16 v[132:135], v[216:219], v[40:43], v[132:135]
v_exp_f32 v232, v152
v_cvt_pk_bf16_f32 v167, v238, v239
v_mfma_f32_16x16x32_bf16 v[132:135], v[220:223], v[44:47], v[132:135]
v_exp_f32 v233, v153
v_mfma_f32_16x16x32_bf16 v[136:139], v[216:219], v[72:75], v[136:139]
v_exp_f32 v234, v154
v_cvt_pk_bf16_f32 v170, v232, v233
v_mfma_f32_16x16x32_bf16 v[136:139], v[220:223], v[76:79], v[136:139]
v_exp_f32 v235, v155
v_mfma_f32_16x16x32_bf16 v[140:143], v[216:219], v[104:107], v[140:143]
ds_read_b128 v[216:219], v230 offset:24576
v_exp_f32 v236, v156
v_mfma_f32_16x16x32_bf16 v[140:143], v[220:223], v[108:111], v[140:143]
ds_read_b128 v[220:223], v230 offset:25088
s_waitcnt lgkmcnt(2)
v_cvt_pk_bf16_f32 v171, v234, v235
v_mfma_f32_16x16x32_bf16 v[128:131], v[208:211], v[16:19], v[128:131]
v_exp_f32 v237, v157
v_mfma_f32_16x16x32_bf16 v[128:131], v[212:215], v[20:23], v[128:131]
v_exp_f32 v238, v158
v_cvt_pk_bf16_f32 v174, v236, v237
v_mfma_f32_16x16x32_bf16 v[132:135], v[208:211], v[48:51], v[132:135]
v_exp_f32 v239, v159
v_or3_b32 v242, v162, v163, v166
v_mfma_f32_16x16x32_bf16 v[132:135], v[212:215], v[52:55], v[132:135]
v_cvt_pk_bf16_f32 v175, v238, v239
v_or3_b32 v242, v242, v167, v170
v_or3_b32 v242, v242, v171, v174
v_mfma_f32_16x16x32_bf16 v[136:139], v[208:211], v[80:83], v[136:139]
v_or_b32 v242, v242, v175
v_lshl_or_b32 v242, v242, 16, v242
v_cmp_le_u32 vcc, 2.0, v242
s_cbranch_vccnz L2_rare_site9
L2_ret9:
v_mfma_f32_16x16x32_bf16 v[136:139], v[212:215], v[84:87], v[136:139]
v_mfma_f32_16x16x32_bf16 v[140:143], v[208:211], v[112:115], v[140:143]
ds_read_b128 v[208:211], v230 offset:31232
v_mfma_f32_16x16x32_bf16 v[140:143], v[212:215], v[116:119], v[140:143]
ds_read_b128 v[212:215], v230 offset:30720
s_waitcnt lgkmcnt(2)
v_mfma_f32_16x16x32_bf16 v[128:131], v[216:219], v[24:27], v[128:131]
v_mfma_f32_16x16x32_bf16 v[128:131], v[220:223], v[28:31], v[128:131]
v_mfma_f32_16x16x32_bf16 v[132:135], v[216:219], v[56:59], v[132:135]
v_mfma_f32_16x16x32_bf16 v[132:135], v[220:223], v[60:63], v[132:135]
v_mfma_f32_16x16x32_bf16 v[136:139], v[216:219], v[88:91], v[136:139]
v_mfma_f32_16x16x32_bf16 v[136:139], v[220:223], v[92:95], v[136:139]
v_mfma_f32_16x16x32_bf16 v[140:143], v[216:219], v[120:123], v[140:143]
ds_read_b128 v[216:219], v230 offset:18432
v_mfma_f32_16x16x32_bf16 v[140:143], v[220:223], v[124:127], v[140:143]
ds_read_b128 v[220:223], v230 offset:18944
s_waitcnt lgkmcnt(2)
v_mfma_f32_16x16x32_bf16 v[144:147], v[208:211], v[0:3], 0
v_mfma_f32_16x16x32_bf16 v[144:147], v[212:215], v[4:7], v[144:147]
v_mfma_f32_16x16x32_bf16 v[148:151], v[208:211], v[32:35], 0
v_mfma_f32_16x16x32_bf16 v[148:151], v[212:215], v[36:39], v[148:151]
v_mfma_f32_16x16x32_bf16 v[152:155], v[208:211], v[64:67], 0
v_exp_f32 v232, v128
v_mfma_f32_16x16x32_bf16 v[152:155], v[212:215], v[68:71], v[152:155]
v_exp_f32 v233, v129
v_mfma_f32_16x16x32_bf16 v[156:159], v[208:211], v[96:99], 0
ds_read_b128 v[208:211], v230 offset:22528
v_exp_f32 v234, v130
v_mfma_f32_16x16x32_bf16 v[156:159], v[212:215], v[100:103], v[156:159]
ds_read_b128 v[212:215], v230 offset:23040
s_waitcnt lgkmcnt(2)
v_cvt_pk_bf16_f32 v0, v232, v233
v_mfma_f32_16x16x32_bf16 v[144:147], v[216:219], v[8:11], v[144:147]
v_exp_f32 v235, v131
v_mfma_f32_16x16x32_bf16 v[144:147], v[220:223], v[12:15], v[144:147]
ds_read_b128 v[4:7], v231 offset:0
v_exp_f32 v236, v132
v_mfma_f32_16x16x32_bf16 v[148:151], v[216:219], v[40:43], v[148:151]
ds_read_b128 v[36:39], v231 offset:1024
v_cvt_pk_bf16_f32 v1, v234, v235
v_mfma_f32_16x16x32_bf16 v[148:151], v[220:223], v[44:47], v[148:151]
v_exp_f32 v237, v133
v_mfma_f32_16x16x32_bf16 v[152:155], v[216:219], v[72:75], v[152:155]
v_exp_f32 v238, v134
v_cvt_pk_bf16_f32 v32, v236, v237
v_mfma_f32_16x16x32_bf16 v[152:155], v[220:223], v[76:79], v[152:155]
ds_read_b128 v[68:71], v231 offset:2048
ds_read_b128 v[8:11], v231 offset:4096
v_mfma_f32_16x16x32_bf16 v[156:159], v[216:219], v[104:107], v[156:159]
ds_read_b128 v[216:219], v230 offset:26624
v_add_u32 v12, 0x8000, v244
v_and_b32 v12, 0x1ffff, v12
ds_read_b128 v[100:103], v231 offset:3072
ds_read_b128 v[40:43], v231 offset:5120
v_mfma_f32_16x16x32_bf16 v[156:159], v[220:223], v[108:111], v[156:159]
ds_read_b128 v[220:223], v230 offset:27136
s_waitcnt lgkmcnt(2)
v_add_u32 v14, 0x10000, v244
v_and_b32 v14, 0x1ffff, v14
v_mfma_f32_16x16x32_bf16 v[144:147], v[208:211], v[16:19], v[144:147]
v_xor_b32 v13, 32, v12
v_xor_b32 v15, 32, v14
v_mfma_f32_16x16x32_bf16 v[144:147], v[212:215], v[20:23], v[144:147]
ds_read_b128 v[72:75], v231 offset:6144
v_exp_f32 v239, v135
v_mfma_f32_16x16x32_bf16 v[148:151], v[208:211], v[48:51], v[148:151]
ds_read_b128 v[104:107], v231 offset:7168
v_exp_f32 v232, v136
v_mfma_f32_16x16x32_bf16 v[148:151], v[212:215], v[52:55], v[148:151]
v_cvt_pk_bf16_f32 v33, v238, v239
v_exp_f32 v233, v137
v_mfma_f32_16x16x32_bf16 v[152:155], v[208:211], v[80:83], v[152:155]
v_exp_f32 v234, v138
v_cvt_pk_bf16_f32 v64, v232, v233
v_mfma_f32_16x16x32_bf16 v[152:155], v[212:215], v[84:87], v[152:155]
v_exp_f32 v235, v139
v_mfma_f32_16x16x32_bf16 v[156:159], v[208:211], v[112:115], v[156:159]
ds_read_b64_tr_b16 v[208:209], v12 offset:12800
ds_read_b64_tr_b16 v[210:211], v12 offset:14848
v_mfma_f32_16x16x32_bf16 v[156:159], v[212:215], v[116:119], v[156:159]
ds_read_b64_tr_b16 v[212:213], v12 offset:29184
s_waitcnt lgkmcnt(3)
v_mfma_f32_16x16x32_bf16 v[144:147], v[216:219], v[24:27], v[144:147]
ds_read_b64_tr_b16 v[214:215], v12 offset:31232
v_exp_f32 v236, v140
v_mfma_f32_16x16x32_bf16 v[144:147], v[220:223], v[28:31], v[144:147]
v_cvt_pk_bf16_f32 v65, v234, v235
v_exp_f32 v237, v141
v_mfma_f32_16x16x32_bf16 v[148:151], v[216:219], v[56:59], v[148:151]
v_exp_f32 v238, v142
v_cvt_pk_bf16_f32 v96, v236, v237
v_mfma_f32_16x16x32_bf16 v[148:151], v[220:223], v[60:63], v[148:151]
v_exp_f32 v239, v143
v_or3_b32 v242, v0, v1, v32
v_mfma_f32_16x16x32_bf16 v[152:155], v[216:219], v[88:91], v[152:155]
v_cvt_pk_bf16_f32 v97, v238, v239
v_or3_b32 v242, v242, v33, v64
v_or3_b32 v242, v242, v65, v96
v_mfma_f32_16x16x32_bf16 v[152:155], v[220:223], v[92:95], v[152:155]
v_or_b32 v242, v242, v97
v_lshl_or_b32 v242, v242, 16, v242
v_cmp_le_u32 vcc, 2.0, v242
s_cbranch_vccnz L2_rare_site10
L2_ret10:
v_mfma_f32_16x16x32_bf16 v[156:159], v[216:219], v[120:123], v[156:159]
ds_read_b64_tr_b16 v[216:217], v14 offset:12800
ds_read_b64_tr_b16 v[218:219], v14 offset:14848
s_waitcnt vmcnt(0)
v_mfma_f32_16x16x32_bf16 v[156:159], v[220:223], v[124:127], v[156:159]
ds_read_b64_tr_b16 v[220:221], v13 offset:12800
s_waitcnt lgkmcnt(3)
v_cmp_ne_u64_e64 s[38:39], s[98:99], v[240:241]
v_mfma_f32_16x16x32_bf16 a[224:227], v[8:11], v[208:211], a[224:227]
ds_read_b64_tr_b16 v[222:223], v13 offset:14848
s_and_b64 s[38:39], s[38:39], s[96:97]
s_cbranch_scc1 LF_hl_1
LF_hlret_1:
v_mfma_f32_16x16x32_bf16 a[224:227], v[176:179], v[212:215], a[224:227]
v_exp_f32 v232, v144
v_lshrrev_b32 v241, 4, v243
v_mfma_f32_16x16x32_bf16 a[228:231], v[40:43], v[208:211], a[228:231]
v_exp_f32 v233, v145
v_and_b32 v241, 0x30, v241
v_mfma_f32_16x16x32_bf16 a[228:231], v[180:183], v[212:215], a[228:231]
v_exp_f32 v234, v146
v_xor_b32 v241, v241, v243
v_mfma_f32_16x16x32_bf16 a[232:235], v[72:75], v[208:211], a[232:235]
v_cvt_pk_bf16_f32 v2, v232, v233
v_and_b32 v228, 0x380, v243
v_mad_u32_u24 v241, v228, 3, v241
v_mfma_f32_16x16x32_bf16 a[232:235], v[184:187], v[212:215], a[232:235]
v_exp_f32 v235, v147
v_add_u32 v241, 0x7000000, v241
v_mfma_f32_16x16x32_bf16 a[236:239], v[104:107], v[208:211], a[236:239]
ds_read_b64_tr_b16 v[208:209], v13 offset:29184
ds_read_b64_tr_b16 v[210:211], v13 offset:31232
v_and_b32 v110, 0x70, v243
v_mfma_f32_16x16x32_bf16 a[236:239], v[188:191], v[212:215], a[236:239]
ds_read_b64_tr_b16 v[212:213], v15 offset:12800
s_waitcnt lgkmcnt(5)
v_lshlrev_b32 v110, 3, v110
v_mfma_f32_16x16x32_bf16 a[224:227], v[160:163], v[216:219], a[224:227]
ds_read_b64_tr_b16 v[214:215], v15 offset:14848
v_add_u32 v110, 0x7c32000, v110
buffer_load_dwordx2 v[108:109], v110, s[16:19], 0 offen sc1
v_mfma_f32_16x16x32_bf16 a[228:231], v[164:167], v[216:219], a[228:231]
v_exp_f32 v236, v148
v_mfma_f32_16x16x32_bf16 a[232:235], v[168:171], v[216:219], a[232:235]
v_cvt_pk_bf16_f32 v3, v234, v235
s_add_u32 m0, s28, 0
v_mfma_f32_16x16x32_bf16 a[236:239], v[172:175], v[216:219], a[236:239]
ds_read_b64_tr_b16 v[216:217], v244 offset:16384
s_waitcnt lgkmcnt(5)
v_mfma_f32_16x16x32_bf16 a[240:243], v[8:11], v[220:223], a[240:243]
ds_read_b64_tr_b16 v[218:219], v244 offset:18432
buffer_load_dwordx4 v241, s[16:19], s6 offen sc1 lds
s_add_u32 m0, s28, 8192
v_mfma_f32_16x16x32_bf16 a[244:247], v[40:43], v[220:223], a[244:247]
v_exp_f32 v237, v149
v_mfma_f32_16x16x32_bf16 a[248:251], v[72:75], v[220:223], a[248:251]
v_exp_f32 v238, v150
v_mfma_f32_16x16x32_bf16 a[252:255], v[104:107], v[220:223], a[252:255]
ds_read_b64_tr_b16 v[220:221], v12 offset:0
s_waitcnt lgkmcnt(3)
v_mfma_f32_16x16x32_bf16 a[240:243], v[176:179], v[208:211], a[240:243]
ds_read_b64_tr_b16 v[222:223], v12 offset:2048
v_cvt_pk_bf16_f32 v34, v236, v237
v_mfma_f32_16x16x32_bf16 a[240:243], v[160:163], v[212:215], a[240:243]
v_exp_f32 v239, v151
v_mfma_f32_16x16x32_bf16 a[244:247], v[180:183], v[208:211], a[244:247]
v_exp_f32 v232, v152
v_mfma_f32_16x16x32_bf16 a[244:247], v[164:167], v[212:215], a[244:247]
v_cvt_pk_bf16_f32 v35, v238, v239
buffer_load_dwordx4 v241, s[16:19], s7 offen sc1 lds
s_add_u32 m0, s30, 0
v_mfma_f32_16x16x32_bf16 a[248:251], v[184:187], v[208:211], a[248:251]
v_exp_f32 v233, v153
v_mfma_f32_16x16x32_bf16 a[248:251], v[168:171], v[212:215], a[248:251]
v_exp_f32 v234, v154
v_mfma_f32_16x16x32_bf16 a[252:255], v[188:191], v[208:211], a[252:255]
ds_read_b64_tr_b16 v[208:209], v12 offset:16384
ds_read_b64_tr_b16 v[210:211], v12 offset:18432
v_mfma_f32_16x16x32_bf16 a[252:255], v[172:175], v[212:215], a[252:255]
ds_read_b64_tr_b16 v[212:213], v14 offset:0
s_waitcnt lgkmcnt(3)
v_mfma_f32_16x16x32_bf16 a[0:3], v[4:7], v[216:219], a[0:3]
ds_read_b64_tr_b16 v[214:215], v14 offset:2048
v_cvt_pk_bf16_f32 v66, v232, v233
v_mfma_f32_16x16x32_bf16 a[0:3], v[8:11], v[220:223], a[0:3]
v_exp_f32 v235, v155
v_mfma_f32_16x16x32_bf16 a[4:7], v[36:39], v[216:219], a[4:7]
v_exp_f32 v236, v156
v_mfma_f32_16x16x32_bf16 a[4:7], v[40:43], v[220:223], a[4:7]
v_cvt_pk_bf16_f32 v67, v234, v235
buffer_load_dwordx4 v241, s[16:19], s29 offen sc1 lds
s_add_u32 m0, s28, 4096
v_mfma_f32_16x16x32_bf16 a[8:11], v[68:71], v[216:219], a[8:11]
v_exp_f32 v237, v157
v_xor_b32 v241, 0x1040, v241
v_mfma_f32_16x16x32_bf16 a[8:11], v[72:75], v[220:223], a[8:11]
v_exp_f32 v238, v158
v_mfma_f32_16x16x32_bf16 a[12:15], v[100:103], v[216:219], a[12:15]
ds_read_b64_tr_b16 v[216:217], v245 offset:16384
ds_read_b64_tr_b16 v[218:219], v245 offset:18432
v_mfma_f32_16x16x32_bf16 a[12:15], v[104:107], v[220:223], a[12:15]
ds_read_b64_tr_b16 v[220:221], v13 offset:0
s_waitcnt lgkmcnt(3)
v_mfma_f32_16x16x32_bf16 a[0:3], v[176:179], v[208:211], a[0:3]
ds_read_b64_tr_b16 v[222:223], v13 offset:2048
v_cvt_pk_bf16_f32 v98, v236, v237
v_mfma_f32_16x16x32_bf16 a[0:3], v[160:163], v[212:215], a[0:3]
v_exp_f32 v239, v159
v_mfma_f32_16x16x32_bf16 a[4:7], v[180:183], v[208:211], a[4:7]
v_or3_b32 v242, v2, v3, v34
v_cvt_pk_bf16_f32 v99, v238, v239
v_mfma_f32_16x16x32_bf16 a[4:7], v[164:167], v[212:215], a[4:7]
v_or3_b32 v242, v242, v35, v66
v_or3_b32 v242, v242, v67, v98
v_mfma_f32_16x16x32_bf16 a[8:11], v[184:187], v[208:211], a[8:11]
v_or_b32 v242, v242, v99
v_lshl_or_b32 v242, v242, 16, v242
v_mfma_f32_16x16x32_bf16 a[8:11], v[168:171], v[212:215], a[8:11]
v_cmp_le_u32 vcc, 2.0, v242
s_cbranch_vccnz L2_rare_site11
L2_ret11:
v_mfma_f32_16x16x32_bf16 a[12:15], v[188:191], v[208:211], a[12:15]
ds_read_b64_tr_b16 v[208:209], v13 offset:16384
ds_read_b64_tr_b16 v[210:211], v13 offset:18432
v_mfma_f32_16x16x32_bf16 a[12:15], v[172:175], v[212:215], a[12:15]
ds_read_b64_tr_b16 v[212:213], v15 offset:0
s_waitcnt lgkmcnt(3)
v_mfma_f32_16x16x32_bf16 a[16:19], v[4:7], v[216:219], a[16:19]
ds_read_b64_tr_b16 v[214:215], v15 offset:2048
buffer_load_dwordx4 v241, s[16:19], s6 offen sc1 lds
s_add_u32 m0, s28, 12288
v_mfma_f32_16x16x32_bf16 a[16:19], v[8:11], v[220:223], a[16:19]
buffer_load_dwordx4 v241, s[16:19], s7 offen sc1 lds
s_add_u32 m0, s30, 4096
v_mfma_f32_16x16x32_bf16 a[20:23], v[36:39], v[216:219], a[20:23]
buffer_load_dwordx4 v241, s[16:19], s29 offen sc1 lds
v_mfma_f32_16x16x32_bf16 a[20:23], v[40:43], v[220:223], a[20:23]
v_mfma_f32_16x16x32_bf16 a[24:27], v[68:71], v[216:219], a[24:27]
v_mfma_f32_16x16x32_bf16 a[24:27], v[72:75], v[220:223], a[24:27]
v_mfma_f32_16x16x32_bf16 a[28:31], v[100:103], v[216:219], a[28:31]
ds_read_b64_tr_b16 v[216:217], v14 offset:29184
ds_read_b64_tr_b16 v[218:219], v14 offset:31232
v_mfma_f32_16x16x32_bf16 a[28:31], v[104:107], v[220:223], a[28:31]
ds_read_b64_tr_b16 v[220:221], v15 offset:29184
s_waitcnt lgkmcnt(3)
v_mfma_f32_16x16x32_bf16 a[16:19], v[176:179], v[208:211], a[16:19]
ds_read_b64_tr_b16 v[222:223], v15 offset:31232
v_mfma_f32_16x16x32_bf16 a[16:19], v[160:163], v[212:215], a[16:19]
v_mfma_f32_16x16x32_bf16 a[20:23], v[180:183], v[208:211], a[20:23]
v_mfma_f32_16x16x32_bf16 a[20:23], v[164:167], v[212:215], a[20:23]
v_mfma_f32_16x16x32_bf16 a[24:27], v[184:187], v[208:211], a[24:27]
v_mfma_f32_16x16x32_bf16 a[24:27], v[168:171], v[212:215], a[24:27]
v_mfma_f32_16x16x32_bf16 a[28:31], v[188:191], v[208:211], a[28:31]
ds_read_b64_tr_b16 v[208:209], v14 offset:16384
ds_read_b64_tr_b16 v[210:211], v14 offset:18432
v_mfma_f32_16x16x32_bf16 a[28:31], v[172:175], v[212:215], a[28:31]
ds_read_b64_tr_b16 v[212:213], v15 offset:16384
s_waitcnt lgkmcnt(5)
v_mfma_f32_16x16x32_bf16 a[224:227], v[0:3], v[216:219], a[224:227]
ds_read_b64_tr_b16 v[214:215], v15 offset:18432
v_lshrrev_b32 v228, 4, v243
v_and_b32 v228, 0x3c, v228
v_mfma_f32_16x16x32_bf16 a[228:231], v[32:35], v[216:219], a[228:231]
v_sub_f32 v224, 0, v224
v_sub_f32 v225, 0, v225
v_sub_f32 v226, 0, v226
v_mfma_f32_16x16x32_bf16 a[232:235], v[64:67], v[216:219], a[232:235]
v_sub_f32 v227, 0, v227
ds_bpermute_b32 v232, v228, v224
ds_bpermute_b32 v234, v228, v225
v_mfma_f32_16x16x32_bf16 a[236:239], v[96:99], v[216:219], a[236:239]
ds_read_b64_tr_b16 v[216:217], v244 offset:16896
s_waitcnt lgkmcnt(5)
ds_bpermute_b32 v236, v228, v226
v_mfma_f32_16x16x32_bf16 a[240:243], v[0:3], v[220:223], a[240:243]
ds_read_b64_tr_b16 v[218:219], v244 offset:18944
ds_bpermute_b32 v238, v228, v227
v_bfe_u32 v228, v243, 4, 1
v_mfma_f32_16x16x32_bf16 a[244:247], v[32:35], v[220:223], a[244:247]
v_mul_u32_u24 v228, 768, v228
v_lshl_add_u32 v228, s37, 7, v228
v_lshrrev_b32 v242, 6, v243
v_mfma_f32_16x16x32_bf16 a[248:251], v[64:67], v[220:223], a[248:251]
v_lshl_add_u32 v242, v242, 3, v228
v_accvgpr_read_b32 v128, a224
v_accvgpr_read_b32 v129, a225
v_mfma_f32_16x16x32_bf16 a[252:255], v[96:99], v[220:223], a[252:255]
ds_read_b64_tr_b16 v[220:221], v12 offset:512
s_waitcnt lgkmcnt(5)
v_accvgpr_read_b32 v130, a226
v_mfma_f32_16x16x32_bf16 a[0:3], v[0:3], v[208:211], a[0:3]
ds_read_b64_tr_b16 v[222:223], v12 offset:2560
v_accvgpr_read_b32 v131, a227
v_cvt_pk_bf16_f32 v28, v128, v129
v_mfma_f32_16x16x32_bf16 a[4:7], v[32:35], v[208:211], a[4:7]
v_cvt_pk_bf16_f32 v29, v130, v131
v_accvgpr_read_b32 v136, a228
v_accvgpr_read_b32 v137, a229
v_mfma_f32_16x16x32_bf16 a[8:11], v[64:67], v[208:211], a[8:11]
v_accvgpr_read_b32 v138, a230
v_accvgpr_read_b32 v139, a231
v_cvt_pk_bf16_f32 v60, v136, v137
v_mfma_f32_16x16x32_bf16 a[12:15], v[96:99], v[208:211], a[12:15]
ds_read_b64_tr_b16 v[208:209], v12 offset:16896
s_waitcnt lgkmcnt(5)
v_cvt_pk_bf16_f32 v61, v138, v139
v_mfma_f32_16x16x32_bf16 a[16:19], v[0:3], v[212:215], a[16:19]
ds_read_b64_tr_b16 v[210:211], v12 offset:18944
v_accvgpr_read_b32 v144, a232
v_accvgpr_read_b32 v145, a233
v_mfma_f32_16x16x32_bf16 a[20:23], v[32:35], v[212:215], a[20:23]
v_accvgpr_read_b32 v146, a234
v_accvgpr_read_b32 v147, a235
v_cvt_pk_bf16_f32 v92, v144, v145
v_mfma_f32_16x16x32_bf16 a[24:27], v[64:67], v[212:215], a[24:27]
v_cvt_pk_bf16_f32 v93, v146, v147
v_accvgpr_read_b32 v152, a236
v_accvgpr_read_b32 v153, a237
v_mfma_f32_16x16x32_bf16 a[28:31], v[96:99], v[212:215], a[28:31]
ds_read_b64_tr_b16 v[212:213], v14 offset:512
s_waitcnt lgkmcnt(3)
v_accvgpr_read_b32 v154, a238
v_mfma_f32_16x16x32_bf16 a[32:35], v[4:7], v[216:219], a[32:35]
ds_read_b64_tr_b16 v[214:215], v14 offset:2560
v_accvgpr_read_b32 v155, a239
v_cvt_pk_bf16_f32 v124, v152, v153
v_mfma_f32_16x16x32_bf16 a[32:35], v[8:11], v[220:223], a[32:35]
v_cvt_pk_bf16_f32 v125, v154, v155
v_accvgpr_read_b32 v132, a240
v_accvgpr_read_b32 v133, a241
v_mfma_f32_16x16x32_bf16 a[36:39], v[36:39], v[216:219], a[36:39]
v_accvgpr_read_b32 v134, a242
v_accvgpr_read_b32 v135, a243
v_cvt_pk_bf16_f32 v30, v132, v133
v_mfma_f32_16x16x32_bf16 a[36:39], v[40:43], v[220:223], a[36:39]
v_cvt_pk_bf16_f32 v31, v134, v135
buffer_store_dwordx4 v[28:31], v243, s[20:23], s44 offen offset:3072 sc1
ds_write_b128 v231, v[28:31] offset:7168
v_mfma_f32_16x16x32_bf16 a[40:43], v[68:71], v[216:219], a[40:43]
v_accvgpr_read_b32 v140, a244
v_accvgpr_read_b32 v141, a245
v_accvgpr_read_b32 v142, a246
v_mfma_f32_16x16x32_bf16 a[40:43], v[72:75], v[220:223], a[40:43]
v_accvgpr_read_b32 v143, a247
v_cvt_pk_bf16_f32 v62, v140, v141
v_cvt_pk_bf16_f32 v63, v142, v143
v_mfma_f32_16x16x32_bf16 a[44:47], v[100:103], v[216:219], a[44:47]
ds_read_b64_tr_b16 v[216:217], v14 offset:16896
ds_read_b64_tr_b16 v[218:219], v14 offset:18944
buffer_store_dwordx4 v[60:63], v243, s[20:23], s45 offen offset:3072 sc1
v_mfma_f32_16x16x32_bf16 a[44:47], v[104:107], v[220:223], a[44:47]
ds_read_b64_tr_b16 v[220:221], v245 offset:16896
s_waitcnt lgkmcnt(3)
v_accvgpr_read_b32 v148, a248
v_mfma_f32_16x16x32_bf16 a[32:35], v[176:179], v[208:211], a[32:35]
ds_read_b64_tr_b16 v[222:223], v245 offset:18944
v_accvgpr_read_b32 v149, a249
v_accvgpr_read_b32 v150, a250
v_mfma_f32_16x16x32_bf16 a[32:35], v[160:163], v[212:215], a[32:35]
v_accvgpr_read_b32 v151, a251
v_cvt_pk_bf16_f32 v94, v148, v149
v_cvt_pk_bf16_f32 v95, v150, v151
v_mfma_f32_16x16x32_bf16 a[36:39], v[180:183], v[208:211], a[36:39]
buffer_store_dwordx4 v[92:95], v243, s[20:23], s46 offen offset:3072 sc1
v_accvgpr_read_b32 v156, a252
v_accvgpr_read_b32 v157, a253
v_mfma_f32_16x16x32_bf16 a[36:39], v[164:167], v[212:215], a[36:39]
v_accvgpr_read_b32 v158, a254
v_accvgpr_read_b32 v159, a255
v_cvt_pk_bf16_f32 v126, v156, v157
v_mfma_f32_16x16x32_bf16 a[40:43], v[184:187], v[208:211], a[40:43]
v_cvt_pk_bf16_f32 v127, v158, v159
buffer_store_dwordx4 v[124:127], v243, s[20:23], s47 offen offset:3072 sc1
v_mov_b32_dpp v233, v132 row_newbcast:15 row_mask:0xf bank_mask:0x1
v_mfma_f32_16x16x32_bf16 a[40:43], v[168:171], v[212:215], a[40:43]
v_mov_b32_dpp v235, v140 row_newbcast:15 row_mask:0xf bank_mask:0x1
v_mov_b32_dpp v237, v148 row_newbcast:15 row_mask:0xf bank_mask:0x1
v_mov_b32_dpp v239, v156 row_newbcast:15 row_mask:0xf bank_mask:0x1
v_mfma_f32_16x16x32_bf16 a[44:47], v[188:191], v[208:211], a[44:47]
ds_read_b64_tr_b16 v[208:209], v13 offset:512
ds_read_b64_tr_b16 v[210:211], v13 offset:2560
v_mov_b32_dpp v233, v133 row_newbcast:15 row_mask:0xf bank_mask:0x2
v_mfma_f32_16x16x32_bf16 a[44:47], v[172:175], v[212:215], a[44:47]
ds_read_b64_tr_b16 v[212:213], v13 offset:16896
s_waitcnt lgkmcnt(5)
v_mov_b32_dpp v235, v141 row_newbcast:15 row_mask:0xf bank_mask:0x2
v_mfma_f32_16x16x32_bf16 a[32:35], v[0:3], v[216:219], a[32:35]
ds_read_b64_tr_b16 v[214:215], v13 offset:18944
v_mov_b32_dpp v237, v149 row_newbcast:15 row_mask:0xf bank_mask:0x2
v_mov_b32_dpp v239, v157 row_newbcast:15 row_mask:0xf bank_mask:0x2
v_mfma_f32_16x16x32_bf16 a[36:39], v[32:35], v[216:219], a[36:39]
v_mov_b32_dpp v233, v134 row_newbcast:15 row_mask:0xf bank_mask:0x4
v_mov_b32_dpp v235, v142 row_newbcast:15 row_mask:0xf bank_mask:0x4
v_mov_b32_dpp v237, v150 row_newbcast:15 row_mask:0xf bank_mask:0x4
v_mfma_f32_16x16x32_bf16 a[40:43], v[64:67], v[216:219], a[40:43]
v_mov_b32_dpp v239, v158 row_newbcast:15 row_mask:0xf bank_mask:0x4
v_mov_b32_dpp v233, v135 row_newbcast:15 row_mask:0xf bank_mask:0x8
v_mov_b32_dpp v235, v143 row_newbcast:15 row_mask:0xf bank_mask:0x8
v_mfma_f32_16x16x32_bf16 a[44:47], v[96:99], v[216:219], a[44:47]
ds_read_b64_tr_b16 v[216:217], v15 offset:512
s_waitcnt lgkmcnt(5)
v_mov_b32_dpp v237, v151 row_newbcast:15 row_mask:0xf bank_mask:0x8
v_mfma_f32_16x16x32_bf16 a[48:51], v[4:7], v[220:223], a[48:51]
ds_read_b64_tr_b16 v[218:219], v15 offset:2560
v_mov_b32_dpp v239, v159 row_newbcast:15 row_mask:0xf bank_mask:0x8
v_mfma_f32_16x16x32_bf16 a[52:55], v[36:39], v[220:223], a[52:55]
s_mov_b32 exec_lo, 0x33333333
s_mov_b32 exec_hi, 0x33333333
buffer_store_dwordx2 v[232:233], v242, s[24:27], s48 offen sc1
s_lshr_b32 s3, s41, 2
buffer_store_dwordx2 v[234:235], v242, s[24:27], s3 offen sc1
s_lshr_b32 s3, s42, 2
buffer_store_dwordx2 v[236:237], v242, s[24:27], s3 offen sc1
s_lshr_b32 s3, s43, 2
buffer_store_dwordx2 v[238:239], v242, s[24:27], s3 offen sc1
s_mov_b64 exec, -1
v_mfma_f32_16x16x32_bf16 a[56:59], v[68:71], v[220:223], a[56:59]
v_accvgpr_read_b32 v128, a0
v_accvgpr_read_b32 v129, a1
v_accvgpr_read_b32 v130, a2
v_mfma_f32_16x16x32_bf16 a[60:63], v[100:103], v[220:223], a[60:63]
ds_read_b64_tr_b16 v[220:221], v15 offset:16896
s_waitcnt lgkmcnt(3)
v_accvgpr_read_b32 v131, a3
v_mfma_f32_16x16x32_bf16 a[48:51], v[8:11], v[208:211], a[48:51]
ds_read_b64_tr_b16 v[222:223], v15 offset:18944
v_cvt_pk_bf16_f32 v16, v128, v129
v_cvt_pk_bf16_f32 v17, v130, v131
v_mfma_f32_16x16x32_bf16 a[48:51], v[176:179], v[212:215], a[48:51]
v_accvgpr_read_b32 v136, a4
v_accvgpr_read_b32 v137, a5
v_accvgpr_read_b32 v138, a6
v_mfma_f32_16x16x32_bf16 a[52:55], v[40:43], v[208:211], a[52:55]
v_accvgpr_read_b32 v139, a7
v_cvt_pk_bf16_f32 v48, v136, v137
v_cvt_pk_bf16_f32 v49, v138, v139
v_mfma_f32_16x16x32_bf16 a[52:55], v[180:183], v[212:215], a[52:55]
v_accvgpr_read_b32 v144, a8
v_accvgpr_read_b32 v145, a9
v_accvgpr_read_b32 v146, a10
v_mfma_f32_16x16x32_bf16 a[56:59], v[72:75], v[208:211], a[56:59]
v_accvgpr_read_b32 v147, a11
v_cvt_pk_bf16_f32 v80, v144, v145
v_cvt_pk_bf16_f32 v81, v146, v147
v_mfma_f32_16x16x32_bf16 a[56:59], v[184:187], v[212:215], a[56:59]
v_accvgpr_read_b32 v152, a12
v_accvgpr_read_b32 v153, a13
v_accvgpr_read_b32 v154, a14
v_mfma_f32_16x16x32_bf16 a[60:63], v[104:107], v[208:211], a[60:63]
ds_read_b64_tr_b16 v[208:209], v244 offset:20480
ds_read_b64_tr_b16 v[210:211], v244 offset:22528
v_accvgpr_read_b32 v155, a15
v_mfma_f32_16x16x32_bf16 a[60:63], v[188:191], v[212:215], a[60:63]
ds_read_b64_tr_b16 v[212:213], v12 offset:4096
s_waitcnt lgkmcnt(3)
v_cvt_pk_bf16_f32 v112, v152, v153
v_mfma_f32_16x16x32_bf16 a[48:51], v[160:163], v[216:219], a[48:51]
ds_read_b64_tr_b16 v[214:215], v12 offset:6144
v_cvt_pk_bf16_f32 v113, v154, v155
v_accvgpr_read_b32 v132, a16
v_mfma_f32_16x16x32_bf16 a[48:51], v[0:3], v[220:223], a[48:51]
v_accvgpr_read_b32 v133, a17
v_accvgpr_read_b32 v134, a18
v_accvgpr_read_b32 v135, a19
v_mfma_f32_16x16x32_bf16 a[52:55], v[164:167], v[216:219], a[52:55]
v_cvt_pk_bf16_f32 v18, v132, v133
v_cvt_pk_bf16_f32 v19, v134, v135
buffer_store_dwordx4 v[16:19], v243, s[20:23], s40 offen offset:0 sc1
v_mfma_f32_16x16x32_bf16 a[52:55], v[32:35], v[220:223], a[52:55]
ds_write_b128 v231, v[16:19] offset:0
v_accvgpr_read_b32 v140, a20
v_accvgpr_read_b32 v141, a21
v_mfma_f32_16x16x32_bf16 a[56:59], v[168:171], v[216:219], a[56:59]
v_accvgpr_read_b32 v142, a22
v_accvgpr_read_b32 v143, a23
v_cvt_pk_bf16_f32 v50, v140, v141
v_mfma_f32_16x16x32_bf16 a[56:59], v[64:67], v[220:223], a[56:59]
v_cvt_pk_bf16_f32 v51, v142, v143
buffer_store_dwordx4 v[48:51], v243, s[20:23], s41 offen offset:0 sc1
v_accvgpr_read_b32 v148, a24
v_mfma_f32_16x16x32_bf16 a[60:63], v[172:175], v[216:219], a[60:63]
ds_read_b64_tr_b16 v[216:217], v12 offset:20480
ds_read_b64_tr_b16 v[218:219], v12 offset:22528
v_accvgpr_read_b32 v149, a25
v_mfma_f32_16x16x32_bf16 a[60:63], v[96:99], v[220:223], a[60:63]
ds_read_b64_tr_b16 v[220:221], v14 offset:4096
s_waitcnt lgkmcnt(3)
v_accvgpr_read_b32 v150, a26
v_mfma_f32_16x16x32_bf16 a[64:67], v[4:7], v[208:211], a[64:67]
ds_read_b64_tr_b16 v[222:223], v14 offset:6144
v_accvgpr_read_b32 v151, a27
v_cvt_pk_bf16_f32 v82, v148, v149
v_mfma_f32_16x16x32_bf16 a[64:67], v[8:11], v[212:215], a[64:67]
v_cvt_pk_bf16_f32 v83, v150, v151
buffer_store_dwordx4 v[80:83], v243, s[20:23], s42 offen offset:0 sc1
v_accvgpr_read_b32 v156, a28
v_mfma_f32_16x16x32_bf16 a[68:71], v[36:39], v[208:211], a[68:71]
v_accvgpr_read_b32 v157, a29
v_accvgpr_read_b32 v158, a30
v_accvgpr_read_b32 v159, a31
v_mfma_f32_16x16x32_bf16 a[68:71], v[40:43], v[212:215], a[68:71]
v_cvt_pk_bf16_f32 v114, v156, v157
v_cvt_pk_bf16_f32 v115, v158, v159
buffer_store_dwordx4 v[112:115], v243, s[20:23], s43 offen offset:0 sc1
v_mfma_f32_16x16x32_bf16 a[72:75], v[68:71], v[208:211], a[72:75]
v_accvgpr_read_b32 v128, a32
v_accvgpr_read_b32 v129, a33
v_accvgpr_read_b32 v130, a34
v_mfma_f32_16x16x32_bf16 a[72:75], v[72:75], v[212:215], a[72:75]
v_accvgpr_read_b32 v131, a35
v_cvt_pk_bf16_f32 v20, v128, v129
v_cvt_pk_bf16_f32 v21, v130, v131
v_mfma_f32_16x16x32_bf16 a[76:79], v[100:103], v[208:211], a[76:79]
ds_read_b64_tr_b16 v[208:209], v14 offset:20480
ds_read_b64_tr_b16 v[210:211], v14 offset:22528
v_accvgpr_read_b32 v136, a36
v_mfma_f32_16x16x32_bf16 a[76:79], v[104:107], v[212:215], a[76:79]
ds_read_b64_tr_b16 v[212:213], v245 offset:20480
s_waitcnt lgkmcnt(3)
v_accvgpr_read_b32 v137, a37
v_mfma_f32_16x16x32_bf16 a[64:67], v[176:179], v[216:219], a[64:67]
ds_read_b64_tr_b16 v[214:215], v245 offset:22528
v_accvgpr_read_b32 v138, a38
v_accvgpr_read_b32 v139, a39
v_mfma_f32_16x16x32_bf16 a[64:67], v[160:163], v[220:223], a[64:67]
v_cvt_pk_bf16_f32 v52, v136, v137
v_cvt_pk_bf16_f32 v53, v138, v139
v_accvgpr_read_b32 v144, a40
v_mfma_f32_16x16x32_bf16 a[68:71], v[180:183], v[216:219], a[68:71]
v_accvgpr_read_b32 v145, a41
v_accvgpr_read_b32 v146, a42
v_accvgpr_read_b32 v147, a43
v_mfma_f32_16x16x32_bf16 a[68:71], v[164:167], v[220:223], a[68:71]
v_cvt_pk_bf16_f32 v84, v144, v145
v_cvt_pk_bf16_f32 v85, v146, v147
v_accvgpr_read_b32 v152, a44
v_mfma_f32_16x16x32_bf16 a[72:75], v[184:187], v[216:219], a[72:75]
v_accvgpr_read_b32 v153, a45
v_accvgpr_read_b32 v154, a46
v_accvgpr_read_b32 v155, a47
v_mfma_f32_16x16x32_bf16 a[72:75], v[168:171], v[220:223], a[72:75]
v_cvt_pk_bf16_f32 v116, v152, v153
v_cvt_pk_bf16_f32 v117, v154, v155
v_accvgpr_read_b32 v132, a48
v_mfma_f32_16x16x32_bf16 a[76:79], v[188:191], v[216:219], a[76:79]
ds_read_b64_tr_b16 v[216:217], v13 offset:4096
ds_read_b64_tr_b16 v[218:219], v13 offset:6144
v_accvgpr_read_b32 v133, a49
v_mfma_f32_16x16x32_bf16 a[76:79], v[172:175], v[220:223], a[76:79]
ds_read_b64_tr_b16 v[220:221], v13 offset:20480
s_waitcnt lgkmcnt(5)
v_accvgpr_read_b32 v134, a50
v_mfma_f32_16x16x32_bf16 a[64:67], v[0:3], v[208:211], a[64:67]
ds_read_b64_tr_b16 v[222:223], v13 offset:22528
v_accvgpr_read_b32 v135, a51
v_cvt_pk_bf16_f32 v22, v132, v133
v_mfma_f32_16x16x32_bf16 a[68:71], v[32:35], v[208:211], a[68:71]
v_cvt_pk_bf16_f32 v23, v134, v135
buffer_store_dwordx4 v[20:23], v243, s[20:23], s40 offen offset:1024 sc1
ds_write_b128 v231, v[20:23] offset:1024
v_mfma_f32_16x16x32_bf16 a[72:75], v[64:67], v[208:211], a[72:75]
v_accvgpr_read_b32 v140, a52
v_accvgpr_read_b32 v141, a53
v_accvgpr_read_b32 v142, a54
v_mfma_f32_16x16x32_bf16 a[76:79], v[96:99], v[208:211], a[76:79]
ds_read_b64_tr_b16 v[208:209], v15 offset:4096
s_waitcnt lgkmcnt(5)
v_accvgpr_read_b32 v143, a55
v_mfma_f32_16x16x32_bf16 a[80:83], v[4:7], v[212:215], a[80:83]
ds_read_b64_tr_b16 v[210:211], v15 offset:6144
v_cvt_pk_bf16_f32 v54, v140, v141
v_cvt_pk_bf16_f32 v55, v142, v143
v_mfma_f32_16x16x32_bf16 a[84:87], v[36:39], v[212:215], a[84:87]
buffer_store_dwordx4 v[52:55], v243, s[20:23], s41 offen offset:1024 sc1
v_accvgpr_read_b32 v148, a56
v_accvgpr_read_b32 v149, a57
v_mfma_f32_16x16x32_bf16 a[88:91], v[68:71], v[212:215], a[88:91]
v_accvgpr_read_b32 v150, a58
v_accvgpr_read_b32 v151, a59
v_cvt_pk_bf16_f32 v86, v148, v149
v_mfma_f32_16x16x32_bf16 a[92:95], v[100:103], v[212:215], a[92:95]
ds_read_b64_tr_b16 v[212:213], v15 offset:20480
s_waitcnt lgkmcnt(3)
v_cvt_pk_bf16_f32 v87, v150, v151
v_mfma_f32_16x16x32_bf16 a[80:83], v[8:11], v[216:219], a[80:83]
ds_read_b64_tr_b16 v[214:215], v15 offset:22528
buffer_store_dwordx4 v[84:87], v243, s[20:23], s42 offen offset:1024 sc1
v_accvgpr_read_b32 v156, a60
v_mfma_f32_16x16x32_bf16 a[80:83], v[176:179], v[220:223], a[80:83]
v_accvgpr_read_b32 v157, a61
v_accvgpr_read_b32 v158, a62
v_accvgpr_read_b32 v159, a63
v_mfma_f32_16x16x32_bf16 a[84:87], v[40:43], v[216:219], a[84:87]
v_cvt_pk_bf16_f32 v118, v156, v157
v_cvt_pk_bf16_f32 v119, v158, v159
buffer_store_dwordx4 v[116:119], v243, s[20:23], s43 offen offset:1024 sc1
v_mfma_f32_16x16x32_bf16 a[84:87], v[180:183], v[220:223], a[84:87]
v_accvgpr_read_b32 v128, a64
v_accvgpr_read_b32 v129, a65
v_mfma_f32_16x16x32_bf16 a[88:91], v[72:75], v[216:219], a[88:91]
v_accvgpr_read_b32 v130, a66
v_accvgpr_read_b32 v131, a67
v_mfma_f32_16x16x32_bf16 a[88:91], v[184:187], v[220:223], a[88:91]
v_cvt_pk_bf16_f32 v24, v128, v129
v_cvt_pk_bf16_f32 v25, v130, v131
v_mfma_f32_16x16x32_bf16 a[92:95], v[104:107], v[216:219], a[92:95]
ds_read_b64_tr_b16 v[216:217], v244 offset:20992
ds_read_b64_tr_b16 v[218:219], v244 offset:23040
v_mfma_f32_16x16x32_bf16 a[92:95], v[188:191], v[220:223], a[92:95]
ds_read_b64_tr_b16 v[220:221], v12 offset:4608
s_waitcnt lgkmcnt(3)
v_mfma_f32_16x16x32_bf16 a[80:83], v[160:163], v[208:211], a[80:83]
ds_read_b64_tr_b16 v[222:223], v12 offset:6656
v_accvgpr_read_b32 v136, a68
v_mfma_f32_16x16x32_bf16 a[80:83], v[0:3], v[212:215], a[80:83]
v_accvgpr_read_b32 v137, a69
v_accvgpr_read_b32 v138, a70
v_mfma_f32_16x16x32_bf16 a[84:87], v[164:167], v[208:211], a[84:87]
v_accvgpr_read_b32 v139, a71
v_cvt_pk_bf16_f32 v56, v136, v137
v_mfma_f32_16x16x32_bf16 a[84:87], v[32:35], v[212:215], a[84:87]
v_cvt_pk_bf16_f32 v57, v138, v139
v_accvgpr_read_b32 v144, a72
v_mfma_f32_16x16x32_bf16 a[88:91], v[168:171], v[208:211], a[88:91]
v_accvgpr_read_b32 v145, a73
v_accvgpr_read_b32 v146, a74
v_mfma_f32_16x16x32_bf16 a[88:91], v[64:67], v[212:215], a[88:91]
v_accvgpr_read_b32 v147, a75
v_cvt_pk_bf16_f32 v88, v144, v145
v_mfma_f32_16x16x32_bf16 a[92:95], v[172:175], v[208:211], a[92:95]
ds_read_b64_tr_b16 v[208:209], v12 offset:20992
ds_read_b64_tr_b16 v[210:211], v12 offset:23040
v_mfma_f32_16x16x32_bf16 a[92:95], v[96:99], v[212:215], a[92:95]
ds_read_b64_tr_b16 v[212:213], v14 offset:4608
s_waitcnt lgkmcnt(3)
v_mfma_f32_16x16x32_bf16 a[96:99], v[4:7], v[216:219], a[96:99]
ds_read_b64_tr_b16 v[214:215], v14 offset:6656
v_cvt_pk_bf16_f32 v89, v146, v147
v_mfma_f32_16x16x32_bf16 a[96:99], v[8:11], v[220:223], a[96:99]
v_accvgpr_read_b32 v152, a76
v_accvgpr_read_b32 v153, a77
v_mfma_f32_16x16x32_bf16 a[100:103], v[36:39], v[216:219], a[100:103]
v_accvgpr_read_b32 v154, a78
v_accvgpr_read_b32 v155, a79
v_mfma_f32_16x16x32_bf16 a[100:103], v[40:43], v[220:223], a[100:103]
v_cvt_pk_bf16_f32 v120, v152, v153
v_cvt_pk_bf16_f32 v121, v154, v155
v_mfma_f32_16x16x32_bf16 a[104:107], v[68:71], v[216:219], a[104:107]
v_accvgpr_read_b32 v132, a80
v_accvgpr_read_b32 v133, a81
v_mfma_f32_16x16x32_bf16 a[104:107], v[72:75], v[220:223], a[104:107]
v_accvgpr_read_b32 v134, a82
v_accvgpr_read_b32 v135, a83
v_mfma_f32_16x16x32_bf16 a[108:111], v[100:103], v[216:219], a[108:111]
ds_read_b64_tr_b16 v[216:217], v14 offset:20992
ds_read_b64_tr_b16 v[218:219], v14 offset:23040
v_mfma_f32_16x16x32_bf16 a[108:111], v[104:107], v[220:223], a[108:111]
ds_read_b64_tr_b16 v[220:221], v245 offset:20992
s_waitcnt lgkmcnt(3)
v_mfma_f32_16x16x32_bf16 a[96:99], v[176:179], v[208:211], a[96:99]
ds_read_b64_tr_b16 v[222:223], v245 offset:23040
v_cvt_pk_bf16_f32 v26, v132, v133
v_mfma_f32_16x16x32_bf16 a[96:99], v[160:163], v[212:215], a[96:99]
v_cvt_pk_bf16_f32 v27, v134, v135
buffer_store_dwordx4 v[24:27], v243, s[20:23], s40 offen offset:2048 sc1
v_mfma_f32_16x16x32_bf16 a[100:103], v[180:183], v[208:211], a[100:103]
ds_write_b128 v231, v[24:27] offset:2048
v_accvgpr_read_b32 v140, a84
v_mfma_f32_16x16x32_bf16 a[100:103], v[164:167], v[212:215], a[100:103]
v_accvgpr_read_b32 v141, a85
v_accvgpr_read_b32 v142, a86
v_mfma_f32_16x16x32_bf16 a[104:107], v[184:187], v[208:211], a[104:107]
v_accvgpr_read_b32 v143, a87
v_cvt_pk_bf16_f32 v58, v140, v141
v_mfma_f32_16x16x32_bf16 a[104:107], v[168:171], v[212:215], a[104:107]
v_cvt_pk_bf16_f32 v59, v142, v143
buffer_store_dwordx4 v[56:59], v243, s[20:23], s41 offen offset:2048 sc1
v_mfma_f32_16x16x32_bf16 a[108:111], v[188:191], v[208:211], a[108:111]
ds_read_b64_tr_b16 v[208:209], v13 offset:4608
ds_read_b64_tr_b16 v[210:211], v13 offset:6656
v_mfma_f32_16x16x32_bf16 a[108:111], v[172:175], v[212:215], a[108:111]
ds_read_b64_tr_b16 v[212:213], v13 offset:20992
s_waitcnt lgkmcnt(5)
v_mfma_f32_16x16x32_bf16 a[96:99], v[0:3], v[216:219], a[96:99]
ds_read_b64_tr_b16 v[214:215], v13 offset:23040
v_accvgpr_read_b32 v148, a88
v_mfma_f32_16x16x32_bf16 a[100:103], v[32:35], v[216:219], a[100:103]
v_accvgpr_read_b32 v149, a89
v_accvgpr_read_b32 v150, a90
v_mfma_f32_16x16x32_bf16 a[104:107], v[64:67], v[216:219], a[104:107]
v_accvgpr_read_b32 v151, a91
v_cvt_pk_bf16_f32 v90, v148, v149
v_mfma_f32_16x16x32_bf16 a[108:111], v[96:99], v[216:219], a[108:111]
ds_read_b64_tr_b16 v[216:217], v15 offset:4608
s_waitcnt lgkmcnt(5)
v_mfma_f32_16x16x32_bf16 a[112:115], v[4:7], v[220:223], a[112:115]
ds_read_b64_tr_b16 v[218:219], v15 offset:6656
v_cvt_pk_bf16_f32 v91, v150, v151
v_mfma_f32_16x16x32_bf16 a[116:119], v[36:39], v[220:223], a[116:119]
buffer_store_dwordx4 v[88:91], v243, s[20:23], s42 offen offset:2048 sc1
v_accvgpr_read_b32 v156, a92
v_mfma_f32_16x16x32_bf16 a[120:123], v[68:71], v[220:223], a[120:123]
v_accvgpr_read_b32 v157, a93
v_accvgpr_read_b32 v158, a94
v_mfma_f32_16x16x32_bf16 a[124:127], v[100:103], v[220:223], a[124:127]
ds_read_b64_tr_b16 v[220:221], v15 offset:20992
s_waitcnt lgkmcnt(3)
v_mfma_f32_16x16x32_bf16 a[112:115], v[8:11], v[208:211], a[112:115]
ds_read_b64_tr_b16 v[222:223], v15 offset:23040
v_accvgpr_read_b32 v159, a95
v_mfma_f32_16x16x32_bf16 a[112:115], v[176:179], v[212:215], a[112:115]
v_cvt_pk_bf16_f32 v122, v156, v157
v_cvt_pk_bf16_f32 v123, v158, v159
v_mfma_f32_16x16x32_bf16 a[116:119], v[40:43], v[208:211], a[116:119]
buffer_store_dwordx4 v[120:123], v243, s[20:23], s43 offen offset:2048 sc1
v_accvgpr_read_b32 v128, a96
v_mfma_f32_16x16x32_bf16 a[116:119], v[180:183], v[212:215], a[116:119]
v_accvgpr_read_b32 v129, a97
v_accvgpr_read_b32 v130, a98
v_mfma_f32_16x16x32_bf16 a[120:123], v[72:75], v[208:211], a[120:123]
v_accvgpr_read_b32 v131, a99
v_cvt_pk_bf16_f32 v28, v128, v129
v_mfma_f32_16x16x32_bf16 a[120:123], v[184:187], v[212:215], a[120:123]
v_cvt_pk_bf16_f32 v29, v130, v131
v_accvgpr_read_b32 v136, a100
v_mfma_f32_16x16x32_bf16 a[124:127], v[104:107], v[208:211], a[124:127]
ds_read_b64_tr_b16 v[208:209], v12 offset:8192
ds_read_b64_tr_b16 v[210:211], v12 offset:10240
v_mfma_f32_16x16x32_bf16 a[124:127], v[188:191], v[212:215], a[124:127]
ds_read_b64_tr_b16 v[212:213], v12 offset:24576
s_waitcnt lgkmcnt(3)
v_mfma_f32_16x16x32_bf16 a[112:115], v[160:163], v[216:219], a[112:115]
ds_read_b64_tr_b16 v[214:215], v12 offset:26624
v_accvgpr_read_b32 v137, a101
v_mfma_f32_16x16x32_bf16 a[112:115], v[0:3], v[220:223], a[112:115]
v_accvgpr_read_b32 v138, a102
v_accvgpr_read_b32 v139, a103
v_mfma_f32_16x16x32_bf16 a[116:119], v[164:167], v[216:219], a[116:119]
v_cvt_pk_bf16_f32 v60, v136, v137
v_cvt_pk_bf16_f32 v61, v138, v139
v_mfma_f32_16x16x32_bf16 a[116:119], v[32:35], v[220:223], a[116:119]
v_accvgpr_read_b32 v144, a104
v_accvgpr_read_b32 v145, a105
v_mfma_f32_16x16x32_bf16 a[120:123], v[168:171], v[216:219], a[120:123]
v_accvgpr_read_b32 v146, a106
v_accvgpr_read_b32 v147, a107
v_mfma_f32_16x16x32_bf16 a[120:123], v[64:67], v[220:223], a[120:123]
v_cvt_pk_bf16_f32 v92, v144, v145
v_cvt_pk_bf16_f32 v93, v146, v147
v_mfma_f32_16x16x32_bf16 a[124:127], v[172:175], v[216:219], a[124:127]
ds_read_b64_tr_b16 v[216:217], v14 offset:8192
ds_read_b64_tr_b16 v[218:219], v14 offset:10240
v_mfma_f32_16x16x32_bf16 a[124:127], v[96:99], v[220:223], a[124:127]
ds_read_b64_tr_b16 v[220:221], v14 offset:24576
s_waitcnt lgkmcnt(3)
v_mfma_f32_16x16x32_bf16 a[128:131], v[8:11], v[208:211], a[128:131]
ds_read_b64_tr_b16 v[222:223], v14 offset:26624
v_accvgpr_read_b32 v152, a108
v_mfma_f32_16x16x32_bf16 a[128:131], v[176:179], v[212:215], a[128:131]
v_accvgpr_read_b32 v153, a109
v_accvgpr_read_b32 v154, a110
v_mfma_f32_16x16x32_bf16 a[132:135], v[40:43], v[208:211], a[132:135]
v_accvgpr_read_b32 v155, a111
v_cvt_pk_bf16_f32 v124, v152, v153
v_mfma_f32_16x16x32_bf16 a[132:135], v[180:183], v[212:215], a[132:135]
v_cvt_pk_bf16_f32 v125, v154, v155
v_accvgpr_read_b32 v132, a112
v_mfma_f32_16x16x32_bf16 a[136:139], v[72:75], v[208:211], a[136:139]
v_accvgpr_read_b32 v133, a113
v_accvgpr_read_b32 v134, a114
v_mfma_f32_16x16x32_bf16 a[136:139], v[184:187], v[212:215], a[136:139]
v_accvgpr_read_b32 v135, a115
v_cvt_pk_bf16_f32 v30, v132, v133
v_mfma_f32_16x16x32_bf16 a[140:143], v[104:107], v[208:211], a[140:143]
ds_read_b64_tr_b16 v[208:209], v13 offset:8192
ds_read_b64_tr_b16 v[210:211], v13 offset:10240
v_mfma_f32_16x16x32_bf16 a[140:143], v[188:191], v[212:215], a[140:143]
ds_read_b64_tr_b16 v[212:213], v13 offset:24576
s_waitcnt lgkmcnt(3)
v_mfma_f32_16x16x32_bf16 a[128:131], v[160:163], v[216:219], a[128:131]
ds_read_b64_tr_b16 v[214:215], v13 offset:26624
v_cvt_pk_bf16_f32 v31, v134, v135
v_mfma_f32_16x16x32_bf16 a[128:131], v[0:3], v[220:223], a[128:131]
buffer_store_dwordx4 v[28:31], v243, s[20:23], s40 offen offset:3072 sc1
ds_write_b128 v231, v[28:31] offset:3072
v_mfma_f32_16x16x32_bf16 a[132:135], v[164:167], v[216:219], a[132:135]
v_accvgpr_read_b32 v140, a116
v_accvgpr_read_b32 v141, a117
v_mfma_f32_16x16x32_bf16 a[132:135], v[32:35], v[220:223], a[132:135]
v_accvgpr_read_b32 v142, a118
v_accvgpr_read_b32 v143, a119
v_mfma_f32_16x16x32_bf16 a[136:139], v[168:171], v[216:219], a[136:139]
v_cvt_pk_bf16_f32 v62, v140, v141
v_cvt_pk_bf16_f32 v63, v142, v143
v_mfma_f32_16x16x32_bf16 a[136:139], v[64:67], v[220:223], a[136:139]
buffer_store_dwordx4 v[60:63], v243, s[20:23], s41 offen offset:3072 sc1
v_accvgpr_read_b32 v148, a120
v_mfma_f32_16x16x32_bf16 a[140:143], v[172:175], v[216:219], a[140:143]
ds_read_b64_tr_b16 v[216:217], v15 offset:8192
ds_read_b64_tr_b16 v[218:219], v15 offset:10240
v_mfma_f32_16x16x32_bf16 a[140:143], v[96:99], v[220:223], a[140:143]
ds_read_b64_tr_b16 v[220:221], v15 offset:24576
s_waitcnt lgkmcnt(3)
v_mfma_f32_16x16x32_bf16 a[144:147], v[8:11], v[208:211], a[144:147]
ds_read_b64_tr_b16 v[222:223], v15 offset:26624
v_accvgpr_read_b32 v149, a121
v_mfma_f32_16x16x32_bf16 a[144:147], v[176:179], v[212:215], a[144:147]
v_accvgpr_read_b32 v150, a122
v_accvgpr_read_b32 v151, a123
v_mfma_f32_16x16x32_bf16 a[148:151], v[40:43], v[208:211], a[148:151]
v_cvt_pk_bf16_f32 v94, v148, v149
v_cvt_pk_bf16_f32 v95, v150, v151
v_mfma_f32_16x16x32_bf16 a[148:151], v[180:183], v[212:215], a[148:151]
buffer_store_dwordx4 v[92:95], v243, s[20:23], s42 offen offset:3072 sc1
v_accvgpr_read_b32 v156, a124
v_mfma_f32_16x16x32_bf16 a[152:155], v[72:75], v[208:211], a[152:155]
v_accvgpr_read_b32 v157, a125
v_accvgpr_read_b32 v158, a126
v_mfma_f32_16x16x32_bf16 a[152:155], v[184:187], v[212:215], a[152:155]
v_accvgpr_read_b32 v159, a127
v_cvt_pk_bf16_f32 v126, v156, v157
v_mfma_f32_16x16x32_bf16 a[156:159], v[104:107], v[208:211], a[156:159]
ds_read_b64_tr_b16 v[208:209], v12 offset:8704
ds_read_b64_tr_b16 v[210:211], v12 offset:10752
v_mfma_f32_16x16x32_bf16 a[156:159], v[188:191], v[212:215], a[156:159]
ds_read_b64_tr_b16 v[212:213], v12 offset:25088
s_waitcnt lgkmcnt(3)
v_mfma_f32_16x16x32_bf16 a[144:147], v[160:163], v[216:219], a[144:147]
ds_read_b64_tr_b16 v[214:215], v12 offset:27136
v_cvt_pk_bf16_f32 v127, v158, v159
v_mfma_f32_16x16x32_bf16 a[144:147], v[0:3], v[220:223], a[144:147]
buffer_store_dwordx4 v[124:127], v243, s[20:23], s43 offen offset:3072 sc1
v_accvgpr_read_b32 v128, a128
v_mfma_f32_16x16x32_bf16 a[148:151], v[164:167], v[216:219], a[148:151]
v_accvgpr_read_b32 v129, a129
v_accvgpr_read_b32 v130, a130
v_mfma_f32_16x16x32_bf16 a[148:151], v[32:35], v[220:223], a[148:151]
v_accvgpr_read_b32 v131, a131
v_cvt_pk_bf16_f32 v16, v128, v129
v_mfma_f32_16x16x32_bf16 a[152:155], v[168:171], v[216:219], a[152:155]
v_cvt_pk_bf16_f32 v17, v130, v131
v_accvgpr_read_b32 v136, a132
v_mfma_f32_16x16x32_bf16 a[152:155], v[64:67], v[220:223], a[152:155]
v_accvgpr_read_b32 v137, a133
v_accvgpr_read_b32 v138, a134
v_mfma_f32_16x16x32_bf16 a[156:159], v[172:175], v[216:219], a[156:159]
ds_read_b64_tr_b16 v[216:217], v14 offset:8704
ds_read_b64_tr_b16 v[218:219], v14 offset:10752
v_mfma_f32_16x16x32_bf16 a[156:159], v[96:99], v[220:223], a[156:159]
ds_read_b64_tr_b16 v[220:221], v14 offset:25088
s_waitcnt lgkmcnt(3)
v_mfma_f32_16x16x32_bf16 a[160:163], v[8:11], v[208:211], a[160:163]
ds_read_b64_tr_b16 v[222:223], v14 offset:27136
v_accvgpr_read_b32 v139, a135
v_mfma_f32_16x16x32_bf16 a[160:163], v[176:179], v[212:215], a[160:163]
v_cvt_pk_bf16_f32 v48, v136, v137
v_cvt_pk_bf16_f32 v49, v138, v139
v_mfma_f32_16x16x32_bf16 a[164:167], v[40:43], v[208:211], a[164:167]
v_accvgpr_read_b32 v144, a136
v_accvgpr_read_b32 v145, a137
v_mfma_f32_16x16x32_bf16 a[164:167], v[180:183], v[212:215], a[164:167]
v_accvgpr_read_b32 v146, a138
v_accvgpr_read_b32 v147, a139
v_mfma_f32_16x16x32_bf16 a[168:171], v[72:75], v[208:211], a[168:171]
v_cvt_pk_bf16_f32 v80, v144, v145
v_cvt_pk_bf16_f32 v81, v146, v147
v_mfma_f32_16x16x32_bf16 a[168:171], v[184:187], v[212:215], a[168:171]
v_accvgpr_read_b32 v152, a140
v_accvgpr_read_b32 v153, a141
v_mfma_f32_16x16x32_bf16 a[172:175], v[104:107], v[208:211], a[172:175]
ds_read_b64_tr_b16 v[208:209], v13 offset:8704
ds_read_b64_tr_b16 v[210:211], v13 offset:10752
v_mfma_f32_16x16x32_bf16 a[172:175], v[188:191], v[212:215], a[172:175]
ds_read_b64_tr_b16 v[212:213], v13 offset:25088
s_waitcnt lgkmcnt(3)
v_mfma_f32_16x16x32_bf16 a[160:163], v[160:163], v[216:219], a[160:163]
ds_read_b64_tr_b16 v[214:215], v13 offset:27136
v_accvgpr_read_b32 v154, a142
v_mfma_f32_16x16x32_bf16 a[160:163], v[0:3], v[220:223], a[160:163]
v_accvgpr_read_b32 v155, a143
v_cvt_pk_bf16_f32 v112, v152, v153
v_mfma_f32_16x16x32_bf16 a[164:167], v[164:167], v[216:219], a[164:167]
v_cvt_pk_bf16_f32 v113, v154, v155
v_accvgpr_read_b32 v132, a144
v_mfma_f32_16x16x32_bf16 a[164:167], v[32:35], v[220:223], a[164:167]
v_accvgpr_read_b32 v133, a145
v_accvgpr_read_b32 v134, a146
v_mfma_f32_16x16x32_bf16 a[168:171], v[168:171], v[216:219], a[168:171]
v_accvgpr_read_b32 v135, a147
v_cvt_pk_bf16_f32 v18, v132, v133
v_mfma_f32_16x16x32_bf16 a[168:171], v[64:67], v[220:223], a[168:171]
v_cvt_pk_bf16_f32 v19, v134, v135
buffer_store_dwordx4 v[16:19], v243, s[20:23], s44 offen offset:0 sc1
v_mfma_f32_16x16x32_bf16 a[172:175], v[172:175], v[216:219], a[172:175]
ds_read_b64_tr_b16 v[216:217], v15 offset:8704
ds_read_b64_tr_b16 v[218:219], v15 offset:10752
v_mfma_f32_16x16x32_bf16 a[172:175], v[96:99], v[220:223], a[172:175]
ds_read_b64_tr_b16 v[220:221], v15 offset:25088
s_waitcnt lgkmcnt(3)
v_mfma_f32_16x16x32_bf16 a[176:179], v[8:11], v[208:211], a[176:179]
ds_read_b64_tr_b16 v[222:223], v15 offset:27136
ds_write_b128 v231, v[16:19] offset:4096
v_mfma_f32_16x16x32_bf16 a[176:179], v[176:179], v[212:215], a[176:179]
v_accvgpr_read_b32 v140, a148
v_accvgpr_read_b32 v141, a149
v_mfma_f32_16x16x32_bf16 a[180:183], v[40:43], v[208:211], a[180:183]
v_accvgpr_read_b32 v142, a150
v_accvgpr_read_b32 v143, a151
v_mfma_f32_16x16x32_bf16 a[180:183], v[180:183], v[212:215], a[180:183]
v_cvt_pk_bf16_f32 v50, v140, v141
v_cvt_pk_bf16_f32 v51, v142, v143
v_mfma_f32_16x16x32_bf16 a[184:187], v[72:75], v[208:211], a[184:187]
buffer_store_dwordx4 v[48:51], v243, s[20:23], s45 offen offset:0 sc1
v_accvgpr_read_b32 v148, a152
v_mfma_f32_16x16x32_bf16 a[184:187], v[184:187], v[212:215], a[184:187]
v_accvgpr_read_b32 v149, a153
v_accvgpr_read_b32 v150, a154
v_mfma_f32_16x16x32_bf16 a[188:191], v[104:107], v[208:211], a[188:191]
ds_read_b64_tr_b16 v[208:209], v12 offset:12288
ds_read_b64_tr_b16 v[210:211], v12 offset:14336
v_mfma_f32_16x16x32_bf16 a[188:191], v[188:191], v[212:215], a[188:191]
ds_read_b64_tr_b16 v[212:213], v12 offset:28672
s_waitcnt lgkmcnt(3)
v_mfma_f32_16x16x32_bf16 a[176:179], v[160:163], v[216:219], a[176:179]
ds_read_b64_tr_b16 v[214:215], v12 offset:30720
v_accvgpr_read_b32 v151, a155
v_mfma_f32_16x16x32_bf16 a[176:179], v[0:3], v[220:223], a[176:179]
v_cvt_pk_bf16_f32 v82, v148, v149
v_cvt_pk_bf16_f32 v83, v150, v151
v_mfma_f32_16x16x32_bf16 a[180:183], v[164:167], v[216:219], a[180:183]
buffer_store_dwordx4 v[80:83], v243, s[20:23], s46 offen offset:0 sc1
v_accvgpr_read_b32 v156, a156
v_mfma_f32_16x16x32_bf16 a[180:183], v[32:35], v[220:223], a[180:183]
v_accvgpr_read_b32 v157, a157
v_accvgpr_read_b32 v158, a158
v_mfma_f32_16x16x32_bf16 a[184:187], v[168:171], v[216:219], a[184:187]
v_accvgpr_read_b32 v159, a159
v_cvt_pk_bf16_f32 v114, v156, v157
v_mfma_f32_16x16x32_bf16 a[184:187], v[64:67], v[220:223], a[184:187]
v_cvt_pk_bf16_f32 v115, v158, v159
buffer_store_dwordx4 v[112:115], v243, s[20:23], s47 offen offset:0 sc1
v_mfma_f32_16x16x32_bf16 a[188:191], v[172:175], v[216:219], a[188:191]
ds_read_b64_tr_b16 v[216:217], v14 offset:12288
ds_read_b64_tr_b16 v[218:219], v14 offset:14336
v_mfma_f32_16x16x32_bf16 a[188:191], v[96:99], v[220:223], a[188:191]
ds_read_b64_tr_b16 v[220:221], v14 offset:28672
s_waitcnt lgkmcnt(3)
v_mfma_f32_16x16x32_bf16 a[192:195], v[8:11], v[208:211], a[192:195]
ds_read_b64_tr_b16 v[222:223], v14 offset:30720
v_accvgpr_read_b32 v128, a160
v_mfma_f32_16x16x32_bf16 a[192:195], v[176:179], v[212:215], a[192:195]
v_accvgpr_read_b32 v129, a161
v_accvgpr_read_b32 v130, a162
v_mfma_f32_16x16x32_bf16 a[196:199], v[40:43], v[208:211], a[196:199]
v_accvgpr_read_b32 v131, a163
v_cvt_pk_bf16_f32 v20, v128, v129
v_mfma_f32_16x16x32_bf16 a[196:199], v[180:183], v[212:215], a[196:199]
v_cvt_pk_bf16_f32 v21, v130, v131
v_accvgpr_read_b32 v136, a164
v_mfma_f32_16x16x32_bf16 a[200:203], v[72:75], v[208:211], a[200:203]
v_accvgpr_read_b32 v137, a165
v_accvgpr_read_b32 v138, a166
v_mfma_f32_16x16x32_bf16 a[200:203], v[184:187], v[212:215], a[200:203]
v_accvgpr_read_b32 v139, a167
v_cvt_pk_bf16_f32 v52, v136, v137
v_mfma_f32_16x16x32_bf16 a[204:207], v[104:107], v[208:211], a[204:207]
ds_read_b64_tr_b16 v[208:209], v13 offset:12288
ds_read_b64_tr_b16 v[210:211], v13 offset:14336
v_mfma_f32_16x16x32_bf16 a[204:207], v[188:191], v[212:215], a[204:207]
ds_read_b64_tr_b16 v[212:213], v13 offset:28672
s_waitcnt lgkmcnt(3)
v_mfma_f32_16x16x32_bf16 a[192:195], v[160:163], v[216:219], a[192:195]
ds_read_b64_tr_b16 v[214:215], v13 offset:30720
v_cvt_pk_bf16_f32 v53, v138, v139
v_mfma_f32_16x16x32_bf16 a[192:195], v[0:3], v[220:223], a[192:195]
v_accvgpr_read_b32 v144, a168
v_accvgpr_read_b32 v145, a169
v_mfma_f32_16x16x32_bf16 a[196:199], v[164:167], v[216:219], a[196:199]
v_accvgpr_read_b32 v146, a170
v_accvgpr_read_b32 v147, a171
v_mfma_f32_16x16x32_bf16 a[196:199], v[32:35], v[220:223], a[196:199]
v_cvt_pk_bf16_f32 v84, v144, v145
v_cvt_pk_bf16_f32 v85, v146, v147
v_mfma_f32_16x16x32_bf16 a[200:203], v[168:171], v[216:219], a[200:203]
v_accvgpr_read_b32 v152, a172
v_accvgpr_read_b32 v153, a173
v_mfma_f32_16x16x32_bf16 a[200:203], v[64:67], v[220:223], a[200:203]
v_accvgpr_read_b32 v154, a174
v_accvgpr_read_b32 v155, a175
v_mfma_f32_16x16x32_bf16 a[204:207], v[172:175], v[216:219], a[204:207]
ds_read_b64_tr_b16 v[216:217], v15 offset:12288
ds_read_b64_tr_b16 v[218:219], v15 offset:14336
v_mfma_f32_16x16x32_bf16 a[204:207], v[96:99], v[220:223], a[204:207]
ds_read_b64_tr_b16 v[220:221], v15 offset:28672
s_waitcnt lgkmcnt(3)
v_mfma_f32_16x16x32_bf16 a[208:211], v[8:11], v[208:211], a[208:211]
ds_read_b64_tr_b16 v[222:223], v15 offset:30720
v_cvt_pk_bf16_f32 v116, v152, v153
v_mfma_f32_16x16x32_bf16 a[208:211], v[176:179], v[212:215], a[208:211]
v_cvt_pk_bf16_f32 v117, v154, v155
v_accvgpr_read_b32 v132, a176
v_mfma_f32_16x16x32_bf16 a[212:215], v[40:43], v[208:211], a[212:215]
v_accvgpr_read_b32 v133, a177
v_accvgpr_read_b32 v134, a178
v_mfma_f32_16x16x32_bf16 a[212:215], v[180:183], v[212:215], a[212:215]
v_accvgpr_read_b32 v135, a179
v_cvt_pk_bf16_f32 v22, v132, v133
v_mfma_f32_16x16x32_bf16 a[216:219], v[72:75], v[208:211], a[216:219]
v_cvt_pk_bf16_f32 v23, v134, v135
buffer_store_dwordx4 v[20:23], v243, s[20:23], s44 offen offset:1024 sc1
v_mfma_f32_16x16x32_bf16 a[216:219], v[184:187], v[212:215], a[216:219]
ds_write_b128 v231, v[20:23] offset:5120
v_accvgpr_read_b32 v140, a180
v_mfma_f32_16x16x32_bf16 a[220:223], v[104:107], v[208:211], a[220:223]
v_accvgpr_read_b32 v141, a181
v_accvgpr_read_b32 v142, a182
v_mfma_f32_16x16x32_bf16 a[220:223], v[188:191], v[212:215], a[220:223]
s_waitcnt lgkmcnt(0)
v_accvgpr_read_b32 v143, a183
v_mfma_f32_16x16x32_bf16 a[208:211], v[160:163], v[216:219], a[208:211]
v_cvt_pk_bf16_f32 v54, v140, v141
v_cvt_pk_bf16_f32 v55, v142, v143
v_mfma_f32_16x16x32_bf16 a[208:211], v[0:3], v[220:223], a[208:211]
buffer_store_dwordx4 v[52:55], v243, s[20:23], s45 offen offset:1024 sc1
v_accvgpr_read_b32 v148, a184
v_mfma_f32_16x16x32_bf16 a[212:215], v[164:167], v[216:219], a[212:215]
v_accvgpr_read_b32 v149, a185
v_accvgpr_read_b32 v150, a186
v_mfma_f32_16x16x32_bf16 a[212:215], v[32:35], v[220:223], a[212:215]
v_accvgpr_read_b32 v151, a187
v_cvt_pk_bf16_f32 v86, v148, v149
v_mfma_f32_16x16x32_bf16 a[216:219], v[168:171], v[216:219], a[216:219]
v_cvt_pk_bf16_f32 v87, v150, v151
buffer_store_dwordx4 v[84:87], v243, s[20:23], s46 offen offset:1024 sc1
v_mfma_f32_16x16x32_bf16 a[216:219], v[64:67], v[220:223], a[216:219]
v_accvgpr_read_b32 v156, a188
v_accvgpr_read_b32 v157, a189
v_mfma_f32_16x16x32_bf16 a[220:223], v[172:175], v[216:219], a[220:223]
v_accvgpr_read_b32 v158, a190
v_accvgpr_read_b32 v159, a191
v_mfma_f32_16x16x32_bf16 a[220:223], v[96:99], v[220:223], a[220:223]
v_cvt_pk_bf16_f32 v118, v156, v157
v_cvt_pk_bf16_f32 v119, v158, v159
buffer_store_dwordx4 v[116:119], v243, s[20:23], s47 offen offset:1024 sc1
v_accvgpr_read_b32 v128, a192
v_accvgpr_read_b32 v129, a193
v_accvgpr_read_b32 v130, a194
v_accvgpr_read_b32 v131, a195
v_cvt_pk_bf16_f32 v24, v128, v129
v_cvt_pk_bf16_f32 v25, v130, v131
v_accvgpr_read_b32 v136, a196
v_accvgpr_read_b32 v137, a197
v_accvgpr_read_b32 v138, a198
v_accvgpr_read_b32 v139, a199
v_cvt_pk_bf16_f32 v56, v136, v137
v_cvt_pk_bf16_f32 v57, v138, v139
v_accvgpr_read_b32 v144, a200
v_accvgpr_read_b32 v145, a201
v_accvgpr_read_b32 v146, a202
v_accvgpr_read_b32 v147, a203
v_cvt_pk_bf16_f32 v88, v144, v145
v_cvt_pk_bf16_f32 v89, v146, v147
v_accvgpr_read_b32 v152, a204
v_accvgpr_read_b32 v153, a205
v_accvgpr_read_b32 v154, a206
v_accvgpr_read_b32 v155, a207
v_cvt_pk_bf16_f32 v120, v152, v153
v_cvt_pk_bf16_f32 v121, v154, v155
v_accvgpr_read_b32 v132, a208
v_accvgpr_read_b32 v133, a209
v_accvgpr_read_b32 v134, a210
v_accvgpr_read_b32 v135, a211
v_cvt_pk_bf16_f32 v26, v132, v133
v_cvt_pk_bf16_f32 v27, v134, v135
buffer_store_dwordx4 v[24:27], v243, s[20:23], s44 offen offset:2048 sc1
ds_write_b128 v231, v[24:27] offset:6144
v_accvgpr_read_b32 v140, a212
v_accvgpr_read_b32 v141, a213
v_accvgpr_read_b32 v142, a214
v_accvgpr_read_b32 v143, a215
v_cvt_pk_bf16_f32 v58, v140, v141
v_cvt_pk_bf16_f32 v59, v142, v143
buffer_store_dwordx4 v[56:59], v243, s[20:23], s45 offen offset:2048 sc1
v_accvgpr_read_b32 v148, a216
v_accvgpr_read_b32 v149, a217
v_accvgpr_read_b32 v150, a218
v_accvgpr_read_b32 v151, a219
v_cvt_pk_bf16_f32 v90, v148, v149
v_cvt_pk_bf16_f32 v91, v150, v151
buffer_store_dwordx4 v[88:91], v243, s[20:23], s46 offen offset:2048 sc1
v_accvgpr_read_b32 v156, a220
v_accvgpr_read_b32 v157, a221
v_accvgpr_read_b32 v158, a222
v_accvgpr_read_b32 v159, a223
v_cvt_pk_bf16_f32 v122, v156, v157
v_cvt_pk_bf16_f32 v123, v158, v159
buffer_store_dwordx4 v[120:123], v243, s[20:23], s47 offen offset:2048 sc1
s_waitcnt vmcnt(36)
s_branch L2_F
L2_tail_1:
s_waitcnt lgkmcnt(2)
v_add_u32 v231, s50, v243
v_mfma_f32_16x16x32_bf16 v[144:147], v[208:211], v[0:3], 0
s_mov_b32 m0, s30
ds_write_b128 v231, v[160:163] offset:0
v_mfma_f32_16x16x32_bf16 v[144:147], v[212:215], v[4:7], v[144:147]
buffer_load_dwordx4 v241, s[12:15], s28 offen offset:0 sc1 lds
ds_write_b128 v231, v[164:167] offset:1024
v_mfma_f32_16x16x32_bf16 v[148:151], v[208:211], v[32:35], 0
buffer_load_dwordx4 v241, s[12:15], s28 offen offset:1024 sc1 lds
ds_write_b128 v231, v[168:171] offset:2048
v_mfma_f32_16x16x32_bf16 v[148:151], v[212:215], v[36:39], v[148:151]
buffer_load_dwordx4 v241, s[12:15], s28 offen offset:2048 sc1 lds
ds_write_b128 v231, v[172:175] offset:3072
v_mfma_f32_16x16x32_bf16 v[152:155], v[208:211], v[64:67], 0
buffer_load_dwordx4 v241, s[12:15], s28 offen offset:3072 sc1 lds
v_add_u32 v230, 0x8000, v240
v_and_b32 v230, 0x1ffff, v230
v_mfma_f32_16x16x32_bf16 v[152:155], v[212:215], v[68:71], v[152:155]
v_exp_f32 v232, v128
v_mfma_f32_16x16x32_bf16 v[156:159], v[208:211], v[96:99], 0
ds_read_b128 v[208:211], v240 offset:6144
v_exp_f32 v233, v129
v_mfma_f32_16x16x32_bf16 v[156:159], v[212:215], v[100:103], v[156:159]
ds_read_b128 v[212:215], v240 offset:6656
s_waitcnt lgkmcnt(2)
s_and_b32 s30, s30, 0x1c000
v_mfma_f32_16x16x32_bf16 v[144:147], v[216:219], v[8:11], v[144:147]
v_exp_f32 v234, v130
v_cvt_pk_bf16_f32 v160, v232, v233
v_mfma_f32_16x16x32_bf16 v[144:147], v[220:223], v[12:15], v[144:147]
v_exp_f32 v235, v131
s_add_u32 s28, s30, 0x4000
v_mfma_f32_16x16x32_bf16 v[148:151], v[216:219], v[40:43], v[148:151]
v_exp_f32 v236, v132
v_cvt_pk_bf16_f32 v161, v234, v235
v_mfma_f32_16x16x32_bf16 v[148:151], v[220:223], v[44:47], v[148:151]
v_exp_f32 v237, v133
s_and_b32 s28, s28, 0x1ffff
v_mfma_f32_16x16x32_bf16 v[152:155], v[216:219], v[72:75], v[152:155]
v_exp_f32 v238, v134
v_cvt_pk_bf16_f32 v164, v236, v237
v_mfma_f32_16x16x32_bf16 v[152:155], v[220:223], v[76:79], v[152:155]
v_exp_f32 v239, v135
s_add_u32 s30, s30, 0x8000
v_mfma_f32_16x16x32_bf16 v[156:159], v[216:219], v[104:107], v[156:159]
ds_read_b128 v[216:219], v240 offset:10240
v_exp_f32 v232, v136
v_mfma_f32_16x16x32_bf16 v[156:159], v[220:223], v[108:111], v[156:159]
ds_read_b128 v[220:223], v240 offset:10752
s_waitcnt lgkmcnt(2)
v_cvt_pk_bf16_f32 v165, v238, v239
v_mfma_f32_16x16x32_bf16 v[144:147], v[208:211], v[16:19], v[144:147]
v_exp_f32 v233, v137
s_and_b32 s30, s30, 0x1ffff
v_mfma_f32_16x16x32_bf16 v[144:147], v[212:215], v[20:23], v[144:147]
s_waitcnt vmcnt(4)
s_barrier
s_mul_i32 s31, s34, 6144
v_mfma_f32_16x16x32_bf16 v[148:151], v[208:211], v[48:51], v[148:151]
v_exp_f32 v234, v138
v_cvt_pk_bf16_f32 v168, v232, v233
v_mfma_f32_16x16x32_bf16 v[148:151], v[212:215], v[52:55], v[148:151]
v_exp_f32 v235, v139
s_add_u32 s31, s31, s30
v_mfma_f32_16x16x32_bf16 v[152:155], v[208:211], v[80:83], v[152:155]
v_exp_f32 v236, v140
v_cvt_pk_bf16_f32 v169, v234, v235
v_mfma_f32_16x16x32_bf16 v[152:155], v[212:215], v[84:87], v[152:155]
v_exp_f32 v237, v141
s_lshl_b32 s3, s34, 10
v_mfma_f32_16x16x32_bf16 v[156:159], v[208:211], v[112:115], v[156:159]
ds_read_b128 v[208:211], v240 offset:29184
v_exp_f32 v238, v142
v_mfma_f32_16x16x32_bf16 v[156:159], v[212:215], v[116:119], v[156:159]
ds_read_b128 v[212:215], v240 offset:28672
s_waitcnt lgkmcnt(2)
v_cvt_pk_bf16_f32 v172, v236, v237
v_mfma_f32_16x16x32_bf16 v[144:147], v[216:219], v[24:27], v[144:147]
v_exp_f32 v239, v143
v_or3_b32 v242, v160, v161, v164
v_mfma_f32_16x16x32_bf16 v[144:147], v[220:223], v[28:31], v[144:147]
v_cvt_pk_bf16_f32 v173, v238, v239
v_or3_b32 v242, v242, v165, v168
v_or3_b32 v242, v242, v169, v172
v_mfma_f32_16x16x32_bf16 v[148:151], v[216:219], v[56:59], v[148:151]
v_or_b32 v242, v242, v173
v_lshl_or_b32 v242, v242, 16, v242
v_cmp_le_u32 vcc, 2.0, v242
v_mfma_f32_16x16x32_bf16 v[148:151], v[220:223], v[60:63], v[148:151]
s_add_u32 s28, s28, s3
s_add_u32 s3, s3, 24576
s_add_u32 s30, s30, s3
v_mfma_f32_16x16x32_bf16 v[152:155], v[216:219], v[88:91], v[152:155]
v_lshrrev_b32 v241, 4, v243
v_and_b32 v241, 0x30, v241
v_xor_b32 v241, v241, v243
v_mfma_f32_16x16x32_bf16 v[152:155], v[220:223], v[92:95], v[152:155]
s_cbranch_vccnz L2_rare_site12
L2_ret12:
v_and_b32 v228, 0x380, v243
v_mad_u32_u24 v241, v228, 3, v241
v_mfma_f32_16x16x32_bf16 v[156:159], v[216:219], v[120:123], v[156:159]
ds_read_b128 v[216:219], v240 offset:16384
s_add_u32 m0, s31, 0
v_mfma_f32_16x16x32_bf16 v[156:159], v[220:223], v[124:127], v[156:159]
ds_read_b128 v[220:223], v240 offset:16896
s_waitcnt lgkmcnt(2)
v_mfma_f32_16x16x32_bf16 v[128:131], v[208:211], v[0:3], 0
buffer_load_dwordx4 v241, s[8:11], s6 offen lds
s_add_u32 m0, s31, 2048
v_mfma_f32_16x16x32_bf16 v[128:131], v[212:215], v[4:7], v[128:131]
v_exp_f32 v232, v144
v_mfma_f32_16x16x32_bf16 v[132:135], v[208:211], v[32:35], 0
v_exp_f32 v233, v145
v_mfma_f32_16x16x32_bf16 v[132:135], v[212:215], v[36:39], v[132:135]
v_exp_f32 v234, v146
v_cvt_pk_bf16_f32 v162, v232, v233
v_mfma_f32_16x16x32_bf16 v[136:139], v[208:211], v[64:67], 0
v_exp_f32 v235, v147
v_mfma_f32_16x16x32_bf16 v[136:139], v[212:215], v[68:71], v[136:139]
v_exp_f32 v236, v148
v_cvt_pk_bf16_f32 v163, v234, v235
v_mfma_f32_16x16x32_bf16 v[140:143], v[208:211], v[96:99], 0
ds_read_b128 v[208:211], v240 offset:20480
v_exp_f32 v237, v149
v_mfma_f32_16x16x32_bf16 v[140:143], v[212:215], v[100:103], v[140:143]
ds_read_b128 v[212:215], v240 offset:20992
s_waitcnt lgkmcnt(2)
v_mfma_f32_16x16x32_bf16 v[128:131], v[216:219], v[8:11], v[128:131]
ds_write_b128 v231, v[176:179] offset:4096
v_exp_f32 v238, v150
v_mfma_f32_16x16x32_bf16 v[128:131], v[220:223], v[12:15], v[128:131]
ds_write_b128 v231, v[180:183] offset:5120
v_cvt_pk_bf16_f32 v166, v236, v237
v_mfma_f32_16x16x32_bf16 v[132:135], v[216:219], v[40:43], v[132:135]
ds_write_b128 v231, v[184:187] offset:6144
v_exp_f32 v239, v151
v_mfma_f32_16x16x32_bf16 v[132:135], v[220:223], v[44:47], v[132:135]
ds_write_b128 v231, v[188:191] offset:7168
v_exp_f32 v232, v152
v_mfma_f32_16x16x32_bf16 v[136:139], v[216:219], v[72:75], v[136:139]
v_cvt_pk_bf16_f32 v167, v238, v239
v_exp_f32 v233, v153
v_mfma_f32_16x16x32_bf16 v[136:139], v[220:223], v[76:79], v[136:139]
v_exp_f32 v234, v154
v_cvt_pk_bf16_f32 v170, v232, v233
v_mfma_f32_16x16x32_bf16 v[140:143], v[216:219], v[104:107], v[140:143]
ds_read_b128 v[216:219], v240 offset:24576
v_exp_f32 v235, v155
v_mfma_f32_16x16x32_bf16 v[140:143], v[220:223], v[108:111], v[140:143]
ds_read_b128 v[220:223], v240 offset:25088
s_waitcnt lgkmcnt(2)
v_mfma_f32_16x16x32_bf16 v[128:131], v[208:211], v[16:19], v[128:131]
v_exp_f32 v236, v156
v_cvt_pk_bf16_f32 v171, v234, v235
v_mfma_f32_16x16x32_bf16 v[128:131], v[212:215], v[20:23], v[128:131]
v_exp_f32 v237, v157
v_mfma_f32_16x16x32_bf16 v[132:135], v[208:211], v[48:51], v[132:135]
v_exp_f32 v238, v158
v_cvt_pk_bf16_f32 v174, v236, v237
v_mfma_f32_16x16x32_bf16 v[132:135], v[212:215], v[52:55], v[132:135]
v_exp_f32 v239, v159
v_or3_b32 v242, v162, v163, v166
v_mfma_f32_16x16x32_bf16 v[136:139], v[208:211], v[80:83], v[136:139]
v_cvt_pk_bf16_f32 v175, v238, v239
v_or3_b32 v242, v242, v167, v170
v_or3_b32 v242, v242, v171, v174
v_mfma_f32_16x16x32_bf16 v[136:139], v[212:215], v[84:87], v[136:139]
v_or_b32 v242, v242, v175
v_lshl_or_b32 v242, v242, 16, v242
v_cmp_le_u32 vcc, 2.0, v242
s_cbranch_vccnz L2_rare_site13
L2_ret13:
v_mfma_f32_16x16x32_bf16 v[140:143], v[208:211], v[112:115], v[140:143]
ds_read_b128 v[208:211], v240 offset:31232
buffer_load_dwordx4 v241, s[8:11], s7 offen lds
s_add_u32 m0, s31, 4096
v_mfma_f32_16x16x32_bf16 v[140:143], v[212:215], v[116:119], v[140:143]
ds_read_b128 v[212:215], v240 offset:30720
s_waitcnt lgkmcnt(2)
v_mfma_f32_16x16x32_bf16 v[128:131], v[216:219], v[24:27], v[128:131]
buffer_load_dwordx4 v241, s[8:11], s29 offen lds
s_add_u32 m0, s31, 1024
v_xor_b32 v241, 0x1040, v241
v_mfma_f32_16x16x32_bf16 v[128:131], v[220:223], v[28:31], v[128:131]
buffer_load_dwordx4 v241, s[8:11], s6 offen lds
s_add_u32 m0, s31, 3072
v_mfma_f32_16x16x32_bf16 v[132:135], v[216:219], v[56:59], v[132:135]
buffer_load_dwordx4 v241, s[8:11], s7 offen lds
s_add_u32 m0, s31, 5120
v_mfma_f32_16x16x32_bf16 v[132:135], v[220:223], v[60:63], v[132:135]
buffer_load_dwordx4 v241, s[8:11], s29 offen lds
v_mfma_f32_16x16x32_bf16 v[136:139], v[216:219], v[88:91], v[136:139]
v_mfma_f32_16x16x32_bf16 v[136:139], v[220:223], v[92:95], v[136:139]
v_mfma_f32_16x16x32_bf16 v[140:143], v[216:219], v[120:123], v[140:143]
ds_read_b128 v[216:219], v240 offset:18432
v_mfma_f32_16x16x32_bf16 v[140:143], v[220:223], v[124:127], v[140:143]
ds_read_b128 v[220:223], v240 offset:18944
s_waitcnt lgkmcnt(2)
v_mfma_f32_16x16x32_bf16 v[144:147], v[208:211], v[0:3], 0
v_mfma_f32_16x16x32_bf16 v[144:147], v[212:215], v[4:7], v[144:147]
v_exp_f32 v232, v128
v_mfma_f32_16x16x32_bf16 v[148:151], v[208:211], v[32:35], 0
v_exp_f32 v233, v129
v_mfma_f32_16x16x32_bf16 v[148:151], v[212:215], v[36:39], v[148:151]
v_exp_f32 v234, v130
v_cvt_pk_bf16_f32 v176, v232, v233
v_mfma_f32_16x16x32_bf16 v[152:155], v[208:211], v[64:67], 0
v_exp_f32 v235, v131
v_mfma_f32_16x16x32_bf16 v[152:155], v[212:215], v[68:71], v[152:155]
v_exp_f32 v236, v132
v_cvt_pk_bf16_f32 v177, v234, v235
v_mfma_f32_16x16x32_bf16 v[156:159], v[208:211], v[96:99], 0
ds_read_b128 v[208:211], v240 offset:22528
v_exp_f32 v237, v133
v_mfma_f32_16x16x32_bf16 v[156:159], v[212:215], v[100:103], v[156:159]
ds_read_b128 v[212:215], v240 offset:23040
s_waitcnt lgkmcnt(2)
v_mfma_f32_16x16x32_bf16 v[144:147], v[216:219], v[8:11], v[144:147]
v_exp_f32 v238, v134
v_cvt_pk_bf16_f32 v180, v236, v237
v_mfma_f32_16x16x32_bf16 v[144:147], v[220:223], v[12:15], v[144:147]
v_exp_f32 v239, v135
v_mfma_f32_16x16x32_bf16 v[148:151], v[216:219], v[40:43], v[148:151]
v_exp_f32 v232, v136
v_cvt_pk_bf16_f32 v181, v238, v239
v_mfma_f32_16x16x32_bf16 v[148:151], v[220:223], v[44:47], v[148:151]
v_exp_f32 v233, v137
v_mfma_f32_16x16x32_bf16 v[152:155], v[216:219], v[72:75], v[152:155]
v_exp_f32 v234, v138
v_cvt_pk_bf16_f32 v184, v232, v233
v_mfma_f32_16x16x32_bf16 v[152:155], v[220:223], v[76:79], v[152:155]
v_exp_f32 v235, v139
v_mfma_f32_16x16x32_bf16 v[156:159], v[216:219], v[104:107], v[156:159]
ds_read_b128 v[216:219], v240 offset:26624
v_exp_f32 v236, v140
v_mfma_f32_16x16x32_bf16 v[156:159], v[220:223], v[108:111], v[156:159]
ds_read_b128 v[220:223], v240 offset:27136
s_waitcnt lgkmcnt(2)
v_cvt_pk_bf16_f32 v185, v234, v235
v_mfma_f32_16x16x32_bf16 v[144:147], v[208:211], v[16:19], v[144:147]
v_exp_f32 v237, v141
v_mfma_f32_16x16x32_bf16 v[144:147], v[212:215], v[20:23], v[144:147]
s_waitcnt vmcnt(6)
s_barrier
v_mfma_f32_16x16x32_bf16 v[148:151], v[208:211], v[48:51], v[148:151]
v_exp_f32 v238, v142
v_cvt_pk_bf16_f32 v188, v236, v237
v_mfma_f32_16x16x32_bf16 v[148:151], v[212:215], v[52:55], v[148:151]
v_exp_f32 v239, v143
v_or3_b32 v242, v176, v177, v180
v_mfma_f32_16x16x32_bf16 v[152:155], v[208:211], v[80:83], v[152:155]
v_cvt_pk_bf16_f32 v189, v238, v239
v_or3_b32 v242, v242, v181, v184
v_or3_b32 v242, v242, v185, v188
v_mfma_f32_16x16x32_bf16 v[152:155], v[212:215], v[84:87], v[152:155]
v_or_b32 v242, v242, v189
v_lshl_or_b32 v242, v242, 16, v242
v_cmp_le_u32 vcc, 2.0, v242
s_cbranch_vccnz L2_rare_site14
L2_ret14:
v_mfma_f32_16x16x32_bf16 v[156:159], v[208:211], v[112:115], v[156:159]
ds_read_b128 v[208:211], v230 offset:12800
v_mfma_f32_16x16x32_bf16 v[156:159], v[212:215], v[116:119], v[156:159]
ds_read_b128 v[212:215], v230 offset:12288
s_waitcnt lgkmcnt(2)
v_mfma_f32_16x16x32_bf16 v[144:147], v[216:219], v[24:27], v[144:147]
v_mfma_f32_16x16x32_bf16 v[144:147], v[220:223], v[28:31], v[144:147]
v_mfma_f32_16x16x32_bf16 v[148:151], v[216:219], v[56:59], v[148:151]
v_mfma_f32_16x16x32_bf16 v[148:151], v[220:223], v[60:63], v[148:151]
v_mfma_f32_16x16x32_bf16 v[152:155], v[216:219], v[88:91], v[152:155]
v_mfma_f32_16x16x32_bf16 v[152:155], v[220:223], v[92:95], v[152:155]
v_mfma_f32_16x16x32_bf16 v[156:159], v[216:219], v[120:123], v[156:159]
ds_read_b128 v[216:219], v230 offset:0
v_mfma_f32_16x16x32_bf16 v[156:159], v[220:223], v[124:127], v[156:159]
ds_read_b128 v[220:223], v230 offset:512
s_waitcnt lgkmcnt(2)
v_mfma_f32_16x16x32_bf16 v[128:131], v[208:211], v[0:3], 0
v_mfma_f32_16x16x32_bf16 v[128:131], v[212:215], v[4:7], v[128:131]
v_exp_f32 v232, v144
v_mfma_f32_16x16x32_bf16 v[132:135], v[208:211], v[32:35], 0
v_exp_f32 v233, v145
v_mfma_f32_16x16x32_bf16 v[132:135], v[212:215], v[36:39], v[132:135]
v_exp_f32 v234, v146
v_cvt_pk_bf16_f32 v178, v232, v233
v_mfma_f32_16x16x32_bf16 v[136:139], v[208:211], v[64:67], 0
v_exp_f32 v235, v147
v_lshlrev_b32 v241, 3, v243
v_mfma_f32_16x16x32_bf16 v[136:139], v[212:215], v[68:71], v[136:139]
v_exp_f32 v236, v148
v_cvt_pk_bf16_f32 v179, v234, v235
v_mfma_f32_16x16x32_bf16 v[140:143], v[208:211], v[96:99], 0
ds_read_b128 v[208:211], v230 offset:4096
v_exp_f32 v237, v149
v_mfma_f32_16x16x32_bf16 v[140:143], v[212:215], v[100:103], v[140:143]
ds_read_b128 v[212:215], v230 offset:4608
s_waitcnt lgkmcnt(2)
s_mov_b32 s3, 0x7c28000
v_mfma_f32_16x16x32_bf16 v[128:131], v[216:219], v[8:11], v[128:131]
v_exp_f32 v238, v150
v_cvt_pk_bf16_f32 v182, v236, v237
v_mfma_f32_16x16x32_bf16 v[128:131], v[220:223], v[12:15], v[128:131]
v_exp_f32 v239, v151
buffer_load_dwordx2 v[240:241], v241, s[16:19], s3 offen sc1
v_mfma_f32_16x16x32_bf16 v[132:135], v[216:219], v[40:43], v[132:135]
v_exp_f32 v232, v152
v_cvt_pk_bf16_f32 v183, v238, v239
v_mfma_f32_16x16x32_bf16 v[132:135], v[220:223], v[44:47], v[132:135]
v_exp_f32 v233, v153
v_mfma_f32_16x16x32_bf16 v[136:139], v[216:219], v[72:75], v[136:139]
v_exp_f32 v234, v154
v_cvt_pk_bf16_f32 v186, v232, v233
v_mfma_f32_16x16x32_bf16 v[136:139], v[220:223], v[76:79], v[136:139]
v_exp_f32 v235, v155
v_mfma_f32_16x16x32_bf16 v[140:143], v[216:219], v[104:107], v[140:143]
ds_read_b128 v[216:219], v230 offset:8192
v_exp_f32 v236, v156
v_mfma_f32_16x16x32_bf16 v[140:143], v[220:223], v[108:111], v[140:143]
ds_read_b128 v[220:223], v230 offset:8704
s_waitcnt lgkmcnt(2)
v_cvt_pk_bf16_f32 v187, v234, v235
v_mfma_f32_16x16x32_bf16 v[128:131], v[208:211], v[16:19], v[128:131]
v_exp_f32 v237, v157
v_mfma_f32_16x16x32_bf16 v[128:131], v[212:215], v[20:23], v[128:131]
v_exp_f32 v238, v158
v_cvt_pk_bf16_f32 v190, v236, v237
v_mfma_f32_16x16x32_bf16 v[132:135], v[208:211], v[48:51], v[132:135]
v_exp_f32 v239, v159
v_or3_b32 v242, v178, v179, v182
v_mfma_f32_16x16x32_bf16 v[132:135], v[212:215], v[52:55], v[132:135]
v_cvt_pk_bf16_f32 v191, v238, v239
v_or3_b32 v242, v242, v183, v186
v_or3_b32 v242, v242, v187, v190
v_mfma_f32_16x16x32_bf16 v[136:139], v[208:211], v[80:83], v[136:139]
v_or_b32 v242, v242, v191
v_lshl_or_b32 v242, v242, 16, v242
v_cmp_le_u32 vcc, 2.0, v242
s_cbranch_vccnz L2_rare_site15
L2_ret15:
v_mfma_f32_16x16x32_bf16 v[136:139], v[212:215], v[84:87], v[136:139]
v_mfma_f32_16x16x32_bf16 v[140:143], v[208:211], v[112:115], v[140:143]
ds_read_b128 v[208:211], v230 offset:14848
v_mfma_f32_16x16x32_bf16 v[140:143], v[212:215], v[116:119], v[140:143]
ds_read_b128 v[212:215], v230 offset:14336
s_waitcnt lgkmcnt(2)
v_mfma_f32_16x16x32_bf16 v[128:131], v[216:219], v[24:27], v[128:131]
v_mfma_f32_16x16x32_bf16 v[128:131], v[220:223], v[28:31], v[128:131]
v_mfma_f32_16x16x32_bf16 v[132:135], v[216:219], v[56:59], v[132:135]
v_mfma_f32_16x16x32_bf16 v[132:135], v[220:223], v[60:63], v[132:135]
v_mfma_f32_16x16x32_bf16 v[136:139], v[216:219], v[88:91], v[136:139]
v_mfma_f32_16x16x32_bf16 v[136:139], v[220:223], v[92:95], v[136:139]
v_mfma_f32_16x16x32_bf16 v[140:143], v[216:219], v[120:123], v[140:143]
ds_read_b128 v[216:219], v230 offset:2048
v_mfma_f32_16x16x32_bf16 v[140:143], v[220:223], v[124:127], v[140:143]
ds_read_b128 v[220:223], v230 offset:2560
s_waitcnt lgkmcnt(2)
v_mfma_f32_16x16x32_bf16 v[144:147], v[208:211], v[0:3], 0
v_mfma_f32_16x16x32_bf16 v[144:147], v[212:215], v[4:7], v[144:147]
v_mfma_f32_16x16x32_bf16 v[148:151], v[208:211], v[32:35], 0
v_mfma_f32_16x16x32_bf16 v[148:151], v[212:215], v[36:39], v[148:151]
v_mfma_f32_16x16x32_bf16 v[152:155], v[208:211], v[64:67], 0
v_exp_f32 v232, v128
v_mfma_f32_16x16x32_bf16 v[152:155], v[212:215], v[68:71], v[152:155]
v_exp_f32 v233, v129
v_mfma_f32_16x16x32_bf16 v[156:159], v[208:211], v[96:99], 0
ds_read_b128 v[208:211], v230 offset:6144
v_exp_f32 v234, v130
v_mfma_f32_16x16x32_bf16 v[156:159], v[212:215], v[100:103], v[156:159]
ds_read_b128 v[212:215], v230 offset:6656
s_waitcnt lgkmcnt(2)
v_cvt_pk_bf16_f32 v0, v232, v233
v_mfma_f32_16x16x32_bf16 v[144:147], v[216:219], v[8:11], v[144:147]
v_exp_f32 v235, v131
v_mfma_f32_16x16x32_bf16 v[144:147], v[220:223], v[12:15], v[144:147]
ds_read_b128 v[4:7], v231 offset:0
v_exp_f32 v236, v132
v_mfma_f32_16x16x32_bf16 v[148:151], v[216:219], v[40:43], v[148:151]
ds_read_b128 v[36:39], v231 offset:1024
v_cvt_pk_bf16_f32 v1, v234, v235
v_mfma_f32_16x16x32_bf16 v[148:151], v[220:223], v[44:47], v[148:151]
v_exp_f32 v237, v133
v_mfma_f32_16x16x32_bf16 v[152:155], v[216:219], v[72:75], v[152:155]
v_exp_f32 v238, v134
v_cvt_pk_bf16_f32 v32, v236, v237
v_mfma_f32_16x16x32_bf16 v[152:155], v[220:223], v[76:79], v[152:155]
ds_read_b128 v[68:71], v231 offset:2048
ds_read_b128 v[8:11], v231 offset:4096
v_mfma_f32_16x16x32_bf16 v[156:159], v[216:219], v[104:107], v[156:159]
ds_read_b128 v[216:219], v230 offset:10240
v_add_u32 v12, 0x8000, v246
v_and_b32 v12, 0x1ffff, v12
ds_read_b128 v[100:103], v231 offset:3072
ds_read_b128 v[40:43], v231 offset:5120
v_mfma_f32_16x16x32_bf16 v[156:159], v[220:223], v[108:111], v[156:159]
ds_read_b128 v[220:223], v230 offset:10752
s_waitcnt lgkmcnt(2)
v_add_u32 v14, 0x10000, v246
v_and_b32 v14, 0x1ffff, v14
v_mfma_f32_16x16x32_bf16 v[144:147], v[208:211], v[16:19], v[144:147]
v_xor_b32 v13, 32, v12
v_xor_b32 v15, 32, v14
v_mfma_f32_16x16x32_bf16 v[144:147], v[212:215], v[20:23], v[144:147]
ds_read_b128 v[72:75], v231 offset:6144
v_exp_f32 v239, v135
v_mfma_f32_16x16x32_bf16 v[148:151], v[208:211], v[48:51], v[148:151]
ds_read_b128 v[104:107], v231 offset:7168
v_exp_f32 v232, v136
v_mfma_f32_16x16x32_bf16 v[148:151], v[212:215], v[52:55], v[148:151]
v_cvt_pk_bf16_f32 v33, v238, v239
v_exp_f32 v233, v137
v_mfma_f32_16x16x32_bf16 v[152:155], v[208:211], v[80:83], v[152:155]
v_exp_f32 v234, v138
v_cvt_pk_bf16_f32 v64, v232, v233
v_mfma_f32_16x16x32_bf16 v[152:155], v[212:215], v[84:87], v[152:155]
v_exp_f32 v235, v139
v_mfma_f32_16x16x32_bf16 v[156:159], v[208:211], v[112:115], v[156:159]
ds_read_b64_tr_b16 v[208:209], v246 offset:12800
ds_read_b64_tr_b16 v[210:211], v246 offset:14848
v_mfma_f32_16x16x32_bf16 v[156:159], v[212:215], v[116:119], v[156:159]
ds_read_b64_tr_b16 v[212:213], v246 offset:29184
s_waitcnt lgkmcnt(3)
v_mfma_f32_16x16x32_bf16 v[144:147], v[216:219], v[24:27], v[144:147]
ds_read_b64_tr_b16 v[214:215], v246 offset:31232
v_exp_f32 v236, v140
v_mfma_f32_16x16x32_bf16 v[144:147], v[220:223], v[28:31], v[144:147]
v_cvt_pk_bf16_f32 v65, v234, v235
v_exp_f32 v237, v141
v_mfma_f32_16x16x32_bf16 v[148:151], v[216:219], v[56:59], v[148:151]
v_exp_f32 v238, v142
v_cvt_pk_bf16_f32 v96, v236, v237
v_mfma_f32_16x16x32_bf16 v[148:151], v[220:223], v[60:63], v[148:151]
v_exp_f32 v239, v143
v_or3_b32 v242, v0, v1, v32
v_mfma_f32_16x16x32_bf16 v[152:155], v[216:219], v[88:91], v[152:155]
v_cvt_pk_bf16_f32 v97, v238, v239
v_or3_b32 v242, v242, v33, v64
v_or3_b32 v242, v242, v65, v96
v_mfma_f32_16x16x32_bf16 v[152:155], v[220:223], v[92:95], v[152:155]
v_or_b32 v242, v242, v97
v_lshl_or_b32 v242, v242, 16, v242
v_cmp_le_u32 vcc, 2.0, v242
s_cbranch_vccnz L2_rare_site16
L2_ret16:
v_mfma_f32_16x16x32_bf16 v[156:159], v[216:219], v[120:123], v[156:159]
ds_read_b64_tr_b16 v[216:217], v12 offset:12800
ds_read_b64_tr_b16 v[218:219], v12 offset:14848
s_waitcnt vmcnt(0)
v_mfma_f32_16x16x32_bf16 v[156:159], v[220:223], v[124:127], v[156:159]
ds_read_b64_tr_b16 v[220:221], v12 offset:29184
s_waitcnt lgkmcnt(3)
v_cmp_ne_u64_e64 s[38:39], s[98:99], v[240:241]
v_mfma_f32_16x16x32_bf16 a[224:227], v[4:7], v[208:211], a[224:227]
ds_read_b64_tr_b16 v[222:223], v12 offset:31232
s_and_b64 s[38:39], s[38:39], s[96:97]
s_cbranch_scc1 LF_hl_0
LF_hlret_0:
v_mfma_f32_16x16x32_bf16 a[224:227], v[8:11], v[212:215], a[224:227]
v_exp_f32 v232, v144
v_lshrrev_b32 v241, 4, v243
v_mfma_f32_16x16x32_bf16 a[228:231], v[36:39], v[208:211], a[228:231]
v_exp_f32 v233, v145
v_and_b32 v241, 0x30, v241
v_mfma_f32_16x16x32_bf16 a[228:231], v[40:43], v[212:215], a[228:231]
v_exp_f32 v234, v146
v_xor_b32 v241, v241, v243
v_mfma_f32_16x16x32_bf16 a[232:235], v[68:71], v[208:211], a[232:235]
v_cvt_pk_bf16_f32 v2, v232, v233
v_and_b32 v228, 0x380, v243
v_mad_u32_u24 v241, v228, 3, v241
v_mfma_f32_16x16x32_bf16 a[232:235], v[72:75], v[212:215], a[232:235]
v_exp_f32 v235, v147
v_add_u32 v241, 0x7000000, v241
v_mfma_f32_16x16x32_bf16 a[236:239], v[100:103], v[208:211], a[236:239]
ds_read_b64_tr_b16 v[208:209], v247 offset:12800
ds_read_b64_tr_b16 v[210:211], v247 offset:14848
v_and_b32 v110, 0x70, v243
v_mfma_f32_16x16x32_bf16 a[236:239], v[104:107], v[212:215], a[236:239]
ds_read_b64_tr_b16 v[212:213], v247 offset:29184
s_waitcnt lgkmcnt(3)
v_lshlrev_b32 v110, 3, v110
v_mfma_f32_16x16x32_bf16 a[224:227], v[160:163], v[216:219], a[224:227]
ds_read_b64_tr_b16 v[214:215], v247 offset:31232
v_add_u32 v110, 0x7c32000, v110
buffer_load_dwordx2 v[108:109], v110, s[16:19], 0 offen sc1
v_mfma_f32_16x16x32_bf16 a[224:227], v[176:179], v[220:223], a[224:227]
v_exp_f32 v236, v148
v_mfma_f32_16x16x32_bf16 a[228:231], v[164:167], v[216:219], a[228:231]
v_cvt_pk_bf16_f32 v3, v234, v235
s_add_u32 m0, s28, 0
v_mfma_f32_16x16x32_bf16 a[228:231], v[180:183], v[220:223], a[228:231]
v_exp_f32 v237, v149
v_mfma_f32_16x16x32_bf16 a[232:235], v[168:171], v[216:219], a[232:235]
v_exp_f32 v238, v150
v_mfma_f32_16x16x32_bf16 a[232:235], v[184:187], v[220:223], a[232:235]
v_cvt_pk_bf16_f32 v34, v236, v237
buffer_load_dwordx4 v241, s[16:19], s6 offen sc1 lds
s_add_u32 m0, s28, 8192
v_mfma_f32_16x16x32_bf16 a[236:239], v[172:175], v[216:219], a[236:239]
ds_read_b64_tr_b16 v[216:217], v13 offset:12800
ds_read_b64_tr_b16 v[218:219], v13 offset:14848
v_mfma_f32_16x16x32_bf16 a[236:239], v[188:191], v[220:223], a[236:239]
ds_read_b64_tr_b16 v[220:221], v13 offset:29184
s_waitcnt lgkmcnt(3)
v_mfma_f32_16x16x32_bf16 a[240:243], v[4:7], v[208:211], a[240:243]
ds_read_b64_tr_b16 v[222:223], v13 offset:31232
buffer_load_dwordx4 v241, s[16:19], s7 offen sc1 lds
s_add_u32 m0, s30, 0
v_mfma_f32_16x16x32_bf16 a[240:243], v[8:11], v[212:215], a[240:243]
v_exp_f32 v239, v151
v_mfma_f32_16x16x32_bf16 a[244:247], v[36:39], v[208:211], a[244:247]
v_exp_f32 v232, v152
v_mfma_f32_16x16x32_bf16 a[244:247], v[40:43], v[212:215], a[244:247]
v_cvt_pk_bf16_f32 v35, v238, v239
buffer_load_dwordx4 v241, s[16:19], s29 offen sc1 lds
s_add_u32 m0, s28, 4096
v_mfma_f32_16x16x32_bf16 a[248:251], v[68:71], v[208:211], a[248:251]
v_exp_f32 v233, v153
v_xor_b32 v241, 0x1040, v241
v_mfma_f32_16x16x32_bf16 a[248:251], v[72:75], v[212:215], a[248:251]
v_exp_f32 v234, v154
v_mfma_f32_16x16x32_bf16 a[252:255], v[100:103], v[208:211], a[252:255]
ds_read_b64_tr_b16 v[208:209], v246 offset:16384
ds_read_b64_tr_b16 v[210:211], v246 offset:18432
v_mfma_f32_16x16x32_bf16 a[252:255], v[104:107], v[212:215], a[252:255]
ds_read_b64_tr_b16 v[212:213], v12 offset:0
s_waitcnt lgkmcnt(3)
v_mfma_f32_16x16x32_bf16 a[240:243], v[160:163], v[216:219], a[240:243]
ds_read_b64_tr_b16 v[214:215], v12 offset:2048
v_cvt_pk_bf16_f32 v66, v232, v233
v_mfma_f32_16x16x32_bf16 a[240:243], v[176:179], v[220:223], a[240:243]
v_exp_f32 v235, v155
v_mfma_f32_16x16x32_bf16 a[244:247], v[164:167], v[216:219], a[244:247]
v_exp_f32 v236, v156
v_mfma_f32_16x16x32_bf16 a[244:247], v[180:183], v[220:223], a[244:247]
v_cvt_pk_bf16_f32 v67, v234, v235
buffer_load_dwordx4 v241, s[16:19], s6 offen sc1 lds
s_add_u32 m0, s28, 12288
v_mfma_f32_16x16x32_bf16 a[248:251], v[168:171], v[216:219], a[248:251]
v_exp_f32 v237, v157
v_mfma_f32_16x16x32_bf16 a[248:251], v[184:187], v[220:223], a[248:251]
v_exp_f32 v238, v158
v_mfma_f32_16x16x32_bf16 a[252:255], v[172:175], v[216:219], a[252:255]
ds_read_b64_tr_b16 v[216:217], v12 offset:16384
ds_read_b64_tr_b16 v[218:219], v12 offset:18432
v_mfma_f32_16x16x32_bf16 a[252:255], v[188:191], v[220:223], a[252:255]
ds_read_b64_tr_b16 v[220:221], v247 offset:16384
s_waitcnt lgkmcnt(3)
v_mfma_f32_16x16x32_bf16 a[0:3], v[8:11], v[208:211], a[0:3]
ds_read_b64_tr_b16 v[222:223], v247 offset:18432
v_cvt_pk_bf16_f32 v98, v236, v237
v_mfma_f32_16x16x32_bf16 a[0:3], v[160:163], v[212:215], a[0:3]
v_exp_f32 v239, v159
v_mfma_f32_16x16x32_bf16 a[4:7], v[40:43], v[208:211], a[4:7]
v_or3_b32 v242, v2, v3, v34
v_cvt_pk_bf16_f32 v99, v238, v239
v_mfma_f32_16x16x32_bf16 a[4:7], v[164:167], v[212:215], a[4:7]
v_or3_b32 v242, v242, v35, v66
v_or3_b32 v242, v242, v67, v98
v_mfma_f32_16x16x32_bf16 a[8:11], v[72:75], v[208:211], a[8:11]
v_or_b32 v242, v242, v99
v_lshl_or_b32 v242, v242, 16, v242
v_mfma_f32_16x16x32_bf16 a[8:11], v[168:171], v[212:215], a[8:11]
v_cmp_le_u32 vcc, 2.0, v242
s_cbranch_vccnz L2_rare_site17
L2_ret17:
v_mfma_f32_16x16x32_bf16 a[12:15], v[104:107], v[208:211], a[12:15]
ds_read_b64_tr_b16 v[208:209], v13 offset:0
ds_read_b64_tr_b16 v[210:211], v13 offset:2048
v_mfma_f32_16x16x32_bf16 a[12:15], v[172:175], v[212:215], a[12:15]
ds_read_b64_tr_b16 v[212:213], v13 offset:16384
s_waitcnt lgkmcnt(5)
v_mfma_f32_16x16x32_bf16 a[0:3], v[176:179], v[216:219], a[0:3]
ds_read_b64_tr_b16 v[214:215], v13 offset:18432
buffer_load_dwordx4 v241, s[16:19], s7 offen sc1 lds
s_add_u32 m0, s30, 4096
v_mfma_f32_16x16x32_bf16 a[4:7], v[180:183], v[216:219], a[4:7]
buffer_load_dwordx4 v241, s[16:19], s29 offen sc1 lds
v_mfma_f32_16x16x32_bf16 a[8:11], v[184:187], v[216:219], a[8:11]
v_mfma_f32_16x16x32_bf16 a[12:15], v[188:191], v[216:219], a[12:15]
ds_read_b64_tr_b16 v[216:217], v14 offset:12800
s_waitcnt lgkmcnt(5)
v_mfma_f32_16x16x32_bf16 a[16:19], v[8:11], v[220:223], a[16:19]
ds_read_b64_tr_b16 v[218:219], v14 offset:14848
v_mfma_f32_16x16x32_bf16 a[20:23], v[40:43], v[220:223], a[20:23]
v_mfma_f32_16x16x32_bf16 a[24:27], v[72:75], v[220:223], a[24:27]
v_mfma_f32_16x16x32_bf16 a[28:31], v[104:107], v[220:223], a[28:31]
ds_read_b64_tr_b16 v[220:221], v15 offset:12800
s_waitcnt lgkmcnt(3)
v_mfma_f32_16x16x32_bf16 a[16:19], v[160:163], v[208:211], a[16:19]
ds_read_b64_tr_b16 v[222:223], v15 offset:14848
v_mfma_f32_16x16x32_bf16 a[16:19], v[176:179], v[212:215], a[16:19]
v_mfma_f32_16x16x32_bf16 a[20:23], v[164:167], v[208:211], a[20:23]
v_mfma_f32_16x16x32_bf16 a[20:23], v[180:183], v[212:215], a[20:23]
v_mfma_f32_16x16x32_bf16 a[24:27], v[168:171], v[208:211], a[24:27]
v_mfma_f32_16x16x32_bf16 a[24:27], v[184:187], v[212:215], a[24:27]
v_mfma_f32_16x16x32_bf16 a[28:31], v[172:175], v[208:211], a[28:31]
ds_read_b64_tr_b16 v[208:209], v14 offset:0
ds_read_b64_tr_b16 v[210:211], v14 offset:2048
v_mfma_f32_16x16x32_bf16 a[28:31], v[188:191], v[212:215], a[28:31]
ds_read_b64_tr_b16 v[212:213], v15 offset:0
s_waitcnt lgkmcnt(5)
v_mfma_f32_16x16x32_bf16 a[224:227], v[0:3], v[216:219], a[224:227]
ds_read_b64_tr_b16 v[214:215], v15 offset:2048
v_lshrrev_b32 v228, 4, v243
v_and_b32 v228, 0x3c, v228
v_mfma_f32_16x16x32_bf16 a[228:231], v[32:35], v[216:219], a[228:231]
v_sub_f32 v224, 0, v224
v_sub_f32 v225, 0, v225
v_sub_f32 v226, 0, v226
v_mfma_f32_16x16x32_bf16 a[232:235], v[64:67], v[216:219], a[232:235]
v_sub_f32 v227, 0, v227
ds_bpermute_b32 v232, v228, v224
ds_bpermute_b32 v234, v228, v225
v_mfma_f32_16x16x32_bf16 a[236:239], v[96:99], v[216:219], a[236:239]
ds_read_b64_tr_b16 v[216:217], v246 offset:16896
s_waitcnt lgkmcnt(5)
ds_bpermute_b32 v236, v228, v226
v_mfma_f32_16x16x32_bf16 a[240:243], v[0:3], v[220:223], a[240:243]
ds_read_b64_tr_b16 v[218:219], v246 offset:18944
ds_bpermute_b32 v238, v228, v227
v_bfe_u32 v228, v243, 4, 1
v_mfma_f32_16x16x32_bf16 a[244:247], v[32:35], v[220:223], a[244:247]
v_mul_u32_u24 v228, 768, v228
v_lshl_add_u32 v228, s37, 7, v228
v_lshrrev_b32 v242, 6, v243
v_mfma_f32_16x16x32_bf16 a[248:251], v[64:67], v[220:223], a[248:251]
v_lshl_add_u32 v242, v242, 3, v228
v_accvgpr_read_b32 v128, a224
v_accvgpr_read_b32 v129, a225
v_mfma_f32_16x16x32_bf16 a[252:255], v[96:99], v[220:223], a[252:255]
ds_read_b64_tr_b16 v[220:221], v12 offset:512
s_waitcnt lgkmcnt(5)
v_accvgpr_read_b32 v130, a226
v_mfma_f32_16x16x32_bf16 a[0:3], v[0:3], v[208:211], a[0:3]
ds_read_b64_tr_b16 v[222:223], v12 offset:2560
v_accvgpr_read_b32 v131, a227
v_cvt_pk_bf16_f32 v28, v128, v129
v_mfma_f32_16x16x32_bf16 a[4:7], v[32:35], v[208:211], a[4:7]
v_cvt_pk_bf16_f32 v29, v130, v131
v_accvgpr_read_b32 v136, a228
v_accvgpr_read_b32 v137, a229
v_mfma_f32_16x16x32_bf16 a[8:11], v[64:67], v[208:211], a[8:11]
v_accvgpr_read_b32 v138, a230
v_accvgpr_read_b32 v139, a231
v_cvt_pk_bf16_f32 v60, v136, v137
v_mfma_f32_16x16x32_bf16 a[12:15], v[96:99], v[208:211], a[12:15]
ds_read_b64_tr_b16 v[208:209], v12 offset:16896
s_waitcnt lgkmcnt(5)
v_cvt_pk_bf16_f32 v61, v138, v139
v_mfma_f32_16x16x32_bf16 a[16:19], v[0:3], v[212:215], a[16:19]
ds_read_b64_tr_b16 v[210:211], v12 offset:18944
v_accvgpr_read_b32 v144, a232
v_accvgpr_read_b32 v145, a233
v_mfma_f32_16x16x32_bf16 a[20:23], v[32:35], v[212:215], a[20:23]
v_accvgpr_read_b32 v146, a234
v_accvgpr_read_b32 v147, a235
v_cvt_pk_bf16_f32 v92, v144, v145
v_mfma_f32_16x16x32_bf16 a[24:27], v[64:67], v[212:215], a[24:27]
v_cvt_pk_bf16_f32 v93, v146, v147
v_accvgpr_read_b32 v152, a236
v_accvgpr_read_b32 v153, a237
v_mfma_f32_16x16x32_bf16 a[28:31], v[96:99], v[212:215], a[28:31]
ds_read_b64_tr_b16 v[212:213], v14 offset:512
s_waitcnt lgkmcnt(3)
v_accvgpr_read_b32 v154, a238
v_mfma_f32_16x16x32_bf16 a[32:35], v[8:11], v[216:219], a[32:35]
ds_read_b64_tr_b16 v[214:215], v14 offset:2560
v_accvgpr_read_b32 v155, a239
v_cvt_pk_bf16_f32 v124, v152, v153
v_mfma_f32_16x16x32_bf16 a[32:35], v[160:163], v[220:223], a[32:35]
v_cvt_pk_bf16_f32 v125, v154, v155
v_accvgpr_read_b32 v132, a240
v_accvgpr_read_b32 v133, a241
v_mfma_f32_16x16x32_bf16 a[36:39], v[40:43], v[216:219], a[36:39]
v_accvgpr_read_b32 v134, a242
v_accvgpr_read_b32 v135, a243
v_cvt_pk_bf16_f32 v30, v132, v133
v_mfma_f32_16x16x32_bf16 a[36:39], v[164:167], v[220:223], a[36:39]
v_cvt_pk_bf16_f32 v31, v134, v135
buffer_store_dwordx4 v[28:31], v243, s[20:23], s44 offen offset:3072 sc1
ds_write_b128 v231, v[28:31] offset:7168
v_mfma_f32_16x16x32_bf16 a[40:43], v[72:75], v[216:219], a[40:43]
v_accvgpr_read_b32 v140, a244
v_accvgpr_read_b32 v141, a245
v_accvgpr_read_b32 v142, a246
v_mfma_f32_16x16x32_bf16 a[40:43], v[168:171], v[220:223], a[40:43]
v_accvgpr_read_b32 v143, a247
v_cvt_pk_bf16_f32 v62, v140, v141
v_cvt_pk_bf16_f32 v63, v142, v143
v_mfma_f32_16x16x32_bf16 a[44:47], v[104:107], v[216:219], a[44:47]
ds_read_b64_tr_b16 v[216:217], v247 offset:16896
ds_read_b64_tr_b16 v[218:219], v247 offset:18944
buffer_store_dwordx4 v[60:63], v243, s[20:23], s45 offen offset:3072 sc1
v_mfma_f32_16x16x32_bf16 a[44:47], v[172:175], v[220:223], a[44:47]
ds_read_b64_tr_b16 v[220:221], v13 offset:512
s_waitcnt lgkmcnt(3)
v_accvgpr_read_b32 v148, a248
v_mfma_f32_16x16x32_bf16 a[32:35], v[176:179], v[208:211], a[32:35]
ds_read_b64_tr_b16 v[222:223], v13 offset:2560
v_accvgpr_read_b32 v149, a249
v_accvgpr_read_b32 v150, a250
v_mfma_f32_16x16x32_bf16 a[32:35], v[0:3], v[212:215], a[32:35]
v_accvgpr_read_b32 v151, a251
v_cvt_pk_bf16_f32 v94, v148, v149
v_cvt_pk_bf16_f32 v95, v150, v151
v_mfma_f32_16x16x32_bf16 a[36:39], v[180:183], v[208:211], a[36:39]
buffer_store_dwordx4 v[92:95], v243, s[20:23], s46 offen offset:3072 sc1
v_accvgpr_read_b32 v156, a252
v_accvgpr_read_b32 v157, a253
v_mfma_f32_16x16x32_bf16 a[36:39], v[32:35], v[212:215], a[36:39]
v_accvgpr_read_b32 v158, a254
v_accvgpr_read_b32 v159, a255
v_cvt_pk_bf16_f32 v126, v156, v157
v_mfma_f32_16x16x32_bf16 a[40:43], v[184:187], v[208:211], a[40:43]
v_cvt_pk_bf16_f32 v127, v158, v159
buffer_store_dwordx4 v[124:127], v243, s[20:23], s47 offen offset:3072 sc1
v_mov_b32_dpp v233, v132 row_newbcast:15 row_mask:0xf bank_mask:0x1
v_mfma_f32_16x16x32_bf16 a[40:43], v[64:67], v[212:215], a[40:43]
v_mov_b32_dpp v235, v140 row_newbcast:15 row_mask:0xf bank_mask:0x1
v_mov_b32_dpp v237, v148 row_newbcast:15 row_mask:0xf bank_mask:0x1
v_mov_b32_dpp v239, v156 row_newbcast:15 row_mask:0xf bank_mask:0x1
v_mfma_f32_16x16x32_bf16 a[44:47], v[188:191], v[208:211], a[44:47]
ds_read_b64_tr_b16 v[208:209], v13 offset:16896
ds_read_b64_tr_b16 v[210:211], v13 offset:18944
v_mov_b32_dpp v233, v133 row_newbcast:15 row_mask:0xf bank_mask:0x2
v_mfma_f32_16x16x32_bf16 a[44:47], v[96:99], v[212:215], a[44:47]
ds_read_b64_tr_b16 v[212:213], v15 offset:512
s_waitcnt lgkmcnt(3)
v_mov_b32_dpp v235, v141 row_newbcast:15 row_mask:0xf bank_mask:0x2
v_mfma_f32_16x16x32_bf16 a[48:51], v[8:11], v[216:219], a[48:51]
ds_read_b64_tr_b16 v[214:215], v15 offset:2560
v_mov_b32_dpp v237, v149 row_newbcast:15 row_mask:0xf bank_mask:0x2
v_mov_b32_dpp v239, v157 row_newbcast:15 row_mask:0xf bank_mask:0x2
v_mfma_f32_16x16x32_bf16 a[48:51], v[160:163], v[220:223], a[48:51]
v_mov_b32_dpp v233, v134 row_newbcast:15 row_mask:0xf bank_mask:0x4
v_mov_b32_dpp v235, v142 row_newbcast:15 row_mask:0xf bank_mask:0x4
v_mov_b32_dpp v237, v150 row_newbcast:15 row_mask:0xf bank_mask:0x4
v_mfma_f32_16x16x32_bf16 a[52:55], v[40:43], v[216:219], a[52:55]
v_mov_b32_dpp v239, v158 row_newbcast:15 row_mask:0xf bank_mask:0x4
v_mov_b32_dpp v233, v135 row_newbcast:15 row_mask:0xf bank_mask:0x8
v_mov_b32_dpp v235, v143 row_newbcast:15 row_mask:0xf bank_mask:0x8
v_mfma_f32_16x16x32_bf16 a[52:55], v[164:167], v[220:223], a[52:55]
v_mov_b32_dpp v237, v151 row_newbcast:15 row_mask:0xf bank_mask:0x8
v_mov_b32_dpp v239, v159 row_newbcast:15 row_mask:0xf bank_mask:0x8
v_mfma_f32_16x16x32_bf16 a[56:59], v[72:75], v[216:219], a[56:59]
s_mov_b32 exec_lo, 0x33333333
s_mov_b32 exec_hi, 0x33333333
buffer_store_dwordx2 v[232:233], v242, s[24:27], s48 offen sc1
s_lshr_b32 s3, s41, 2
buffer_store_dwordx2 v[234:235], v242, s[24:27], s3 offen sc1
s_lshr_b32 s3, s42, 2
buffer_store_dwordx2 v[236:237], v242, s[24:27], s3 offen sc1
s_lshr_b32 s3, s43, 2
buffer_store_dwordx2 v[238:239], v242, s[24:27], s3 offen sc1
s_mov_b64 exec, -1
v_mfma_f32_16x16x32_bf16 a[56:59], v[168:171], v[220:223], a[56:59]
v_accvgpr_read_b32 v128, a0
v_accvgpr_read_b32 v129, a1
v_accvgpr_read_b32 v130, a2
v_mfma_f32_16x16x32_bf16 a[60:63], v[104:107], v[216:219], a[60:63]
ds_read_b64_tr_b16 v[216:217], v246 offset:20480
ds_read_b64_tr_b16 v[218:219], v246 offset:22528
v_accvgpr_read_b32 v131, a3
v_mfma_f32_16x16x32_bf16 a[60:63], v[172:175], v[220:223], a[60:63]
ds_read_b64_tr_b16 v[220:221], v12 offset:4096
s_waitcnt lgkmcnt(3)
v_cvt_pk_bf16_f32 v16, v128, v129
v_mfma_f32_16x16x32_bf16 a[48:51], v[176:179], v[208:211], a[48:51]
ds_read_b64_tr_b16 v[222:223], v12 offset:6144
v_cvt_pk_bf16_f32 v17, v130, v131
v_accvgpr_read_b32 v136, a4
v_mfma_f32_16x16x32_bf16 a[48:51], v[0:3], v[212:215], a[48:51]
v_accvgpr_read_b32 v137, a5
v_accvgpr_read_b32 v138, a6
v_accvgpr_read_b32 v139, a7
v_mfma_f32_16x16x32_bf16 a[52:55], v[180:183], v[208:211], a[52:55]
v_cvt_pk_bf16_f32 v48, v136, v137
v_cvt_pk_bf16_f32 v49, v138, v139
v_accvgpr_read_b32 v144, a8
v_mfma_f32_16x16x32_bf16 a[52:55], v[32:35], v[212:215], a[52:55]
v_accvgpr_read_b32 v145, a9
v_accvgpr_read_b32 v146, a10
v_accvgpr_read_b32 v147, a11
v_mfma_f32_16x16x32_bf16 a[56:59], v[184:187], v[208:211], a[56:59]
v_cvt_pk_bf16_f32 v80, v144, v145
v_cvt_pk_bf16_f32 v81, v146, v147
v_accvgpr_read_b32 v152, a12
v_mfma_f32_16x16x32_bf16 a[56:59], v[64:67], v[212:215], a[56:59]
v_accvgpr_read_b32 v153, a13
v_accvgpr_read_b32 v154, a14
v_accvgpr_read_b32 v155, a15
v_mfma_f32_16x16x32_bf16 a[60:63], v[188:191], v[208:211], a[60:63]
ds_read_b64_tr_b16 v[208:209], v12 offset:20480
ds_read_b64_tr_b16 v[210:211], v12 offset:22528
v_cvt_pk_bf16_f32 v112, v152, v153
v_mfma_f32_16x16x32_bf16 a[60:63], v[96:99], v[212:215], a[60:63]
ds_read_b64_tr_b16 v[212:213], v14 offset:4096
s_waitcnt lgkmcnt(3)
v_cvt_pk_bf16_f32 v113, v154, v155
v_mfma_f32_16x16x32_bf16 a[64:67], v[8:11], v[216:219], a[64:67]
ds_read_b64_tr_b16 v[214:215], v14 offset:6144
v_accvgpr_read_b32 v132, a16
v_accvgpr_read_b32 v133, a17
v_mfma_f32_16x16x32_bf16 a[64:67], v[160:163], v[220:223], a[64:67]
v_accvgpr_read_b32 v134, a18
v_accvgpr_read_b32 v135, a19
v_cvt_pk_bf16_f32 v18, v132, v133
v_mfma_f32_16x16x32_bf16 a[68:71], v[40:43], v[216:219], a[68:71]
v_cvt_pk_bf16_f32 v19, v134, v135
buffer_store_dwordx4 v[16:19], v243, s[20:23], s40 offen offset:0 sc1
ds_write_b128 v231, v[16:19] offset:0
v_mfma_f32_16x16x32_bf16 a[68:71], v[164:167], v[220:223], a[68:71]
v_accvgpr_read_b32 v140, a20
v_accvgpr_read_b32 v141, a21
v_accvgpr_read_b32 v142, a22
v_mfma_f32_16x16x32_bf16 a[72:75], v[72:75], v[216:219], a[72:75]
v_accvgpr_read_b32 v143, a23
v_cvt_pk_bf16_f32 v50, v140, v141
v_cvt_pk_bf16_f32 v51, v142, v143
v_mfma_f32_16x16x32_bf16 a[72:75], v[168:171], v[220:223], a[72:75]
buffer_store_dwordx4 v[48:51], v243, s[20:23], s41 offen offset:0 sc1
v_accvgpr_read_b32 v148, a24
v_accvgpr_read_b32 v149, a25
v_mfma_f32_16x16x32_bf16 a[76:79], v[104:107], v[216:219], a[76:79]
ds_read_b64_tr_b16 v[216:217], v247 offset:20480
ds_read_b64_tr_b16 v[218:219], v247 offset:22528
v_accvgpr_read_b32 v150, a26
v_mfma_f32_16x16x32_bf16 a[76:79], v[172:175], v[220:223], a[76:79]
ds_read_b64_tr_b16 v[220:221], v13 offset:4096
s_waitcnt lgkmcnt(3)
v_accvgpr_read_b32 v151, a27
v_mfma_f32_16x16x32_bf16 a[64:67], v[176:179], v[208:211], a[64:67]
ds_read_b64_tr_b16 v[222:223], v13 offset:6144
v_cvt_pk_bf16_f32 v82, v148, v149
v_cvt_pk_bf16_f32 v83, v150, v151
v_mfma_f32_16x16x32_bf16 a[64:67], v[0:3], v[212:215], a[64:67]
buffer_store_dwordx4 v[80:83], v243, s[20:23], s42 offen offset:0 sc1
v_accvgpr_read_b32 v156, a28
v_accvgpr_read_b32 v157, a29
v_mfma_f32_16x16x32_bf16 a[68:71], v[180:183], v[208:211], a[68:71]
v_accvgpr_read_b32 v158, a30
v_accvgpr_read_b32 v159, a31
v_cvt_pk_bf16_f32 v114, v156, v157
v_mfma_f32_16x16x32_bf16 a[68:71], v[32:35], v[212:215], a[68:71]
v_cvt_pk_bf16_f32 v115, v158, v159
buffer_store_dwordx4 v[112:115], v243, s[20:23], s43 offen offset:0 sc1
v_accvgpr_read_b32 v128, a32
v_mfma_f32_16x16x32_bf16 a[72:75], v[184:187], v[208:211], a[72:75]
v_accvgpr_read_b32 v129, a33
v_accvgpr_read_b32 v130, a34
v_accvgpr_read_b32 v131, a35
v_mfma_f32_16x16x32_bf16 a[72:75], v[64:67], v[212:215], a[72:75]
v_cvt_pk_bf16_f32 v20, v128, v129
v_cvt_pk_bf16_f32 v21, v130, v131
v_accvgpr_read_b32 v136, a36
v_mfma_f32_16x16x32_bf16 a[76:79], v[188:191], v[208:211], a[76:79]
ds_read_b64_tr_b16 v[208:209], v13 offset:20480
ds_read_b64_tr_b16 v[210:211], v13 offset:22528
v_accvgpr_read_b32 v137, a37
v_mfma_f32_16x16x32_bf16 a[76:79], v[96:99], v[212:215], a[76:79]
ds_read_b64_tr_b16 v[212:213], v15 offset:4096
s_waitcnt lgkmcnt(3)
v_accvgpr_read_b32 v138, a38
v_mfma_f32_16x16x32_bf16 a[80:83], v[8:11], v[216:219], a[80:83]
ds_read_b64_tr_b16 v[214:215], v15 offset:6144
v_accvgpr_read_b32 v139, a39
v_cvt_pk_bf16_f32 v52, v136, v137
v_mfma_f32_16x16x32_bf16 a[80:83], v[160:163], v[220:223], a[80:83]
v_cvt_pk_bf16_f32 v53, v138, v139
v_accvgpr_read_b32 v144, a40
v_accvgpr_read_b32 v145, a41
v_mfma_f32_16x16x32_bf16 a[84:87], v[40:43], v[216:219], a[84:87]
v_accvgpr_read_b32 v146, a42
v_accvgpr_read_b32 v147, a43
v_cvt_pk_bf16_f32 v84, v144, v145
v_mfma_f32_16x16x32_bf16 a[84:87], v[164:167], v[220:223], a[84:87]
v_cvt_pk_bf16_f32 v85, v146, v147
v_accvgpr_read_b32 v152, a44
v_accvgpr_read_b32 v153, a45
v_mfma_f32_16x16x32_bf16 a[88:91], v[72:75], v[216:219], a[88:91]
v_accvgpr_read_b32 v154, a46
v_accvgpr_read_b32 v155, a47
v_cvt_pk_bf16_f32 v116, v152, v153
v_mfma_f32_16x16x32_bf16 a[88:91], v[168:171], v[220:223], a[88:91]
v_cvt_pk_bf16_f32 v117, v154, v155
v_accvgpr_read_b32 v132, a48
v_accvgpr_read_b32 v133, a49
v_mfma_f32_16x16x32_bf16 a[92:95], v[104:107], v[216:219], a[92:95]
ds_read_b64_tr_b16 v[216:217], v246 offset:20992
ds_read_b64_tr_b16 v[218:219], v246 offset:23040
v_accvgpr_read_b32 v134, a50
v_mfma_f32_16x16x32_bf16 a[92:95], v[172:175], v[220:223], a[92:95]
ds_read_b64_tr_b16 v[220:221], v12 offset:4608
s_waitcnt lgkmcnt(3)
v_accvgpr_read_b32 v135, a51
v_mfma_f32_16x16x32_bf16 a[80:83], v[176:179], v[208:211], a[80:83]
ds_read_b64_tr_b16 v[222:223], v12 offset:6656
v_cvt_pk_bf16_f32 v22, v132, v133
v_cvt_pk_bf16_f32 v23, v134, v135
v_mfma_f32_16x16x32_bf16 a[80:83], v[0:3], v[212:215], a[80:83]
buffer_store_dwordx4 v[20:23], v243, s[20:23], s40 offen offset:1024 sc1
ds_write_b128 v231, v[20:23] offset:1024
v_accvgpr_read_b32 v140, a52
v_mfma_f32_16x16x32_bf16 a[84:87], v[180:183], v[208:211], a[84:87]
v_accvgpr_read_b32 v141, a53
v_accvgpr_read_b32 v142, a54
v_accvgpr_read_b32 v143, a55
v_mfma_f32_16x16x32_bf16 a[84:87], v[32:35], v[212:215], a[84:87]
v_cvt_pk_bf16_f32 v54, v140, v141
v_cvt_pk_bf16_f32 v55, v142, v143
buffer_store_dwordx4 v[52:55], v243, s[20:23], s41 offen offset:1024 sc1
v_mfma_f32_16x16x32_bf16 a[88:91], v[184:187], v[208:211], a[88:91]
v_accvgpr_read_b32 v148, a56
v_accvgpr_read_b32 v149, a57
v_accvgpr_read_b32 v150, a58
v_mfma_f32_16x16x32_bf16 a[88:91], v[64:67], v[212:215], a[88:91]
v_accvgpr_read_b32 v151, a59
v_cvt_pk_bf16_f32 v86, v148, v149
v_cvt_pk_bf16_f32 v87, v150, v151
v_mfma_f32_16x16x32_bf16 a[92:95], v[188:191], v[208:211], a[92:95]
ds_read_b64_tr_b16 v[208:209], v12 offset:20992
ds_read_b64_tr_b16 v[210:211], v12 offset:23040
buffer_store_dwordx4 v[84:87], v243, s[20:23], s42 offen offset:1024 sc1
v_mfma_f32_16x16x32_bf16 a[92:95], v[96:99], v[212:215], a[92:95]
ds_read_b64_tr_b16 v[212:213], v14 offset:4608
s_waitcnt lgkmcnt(3)
v_accvgpr_read_b32 v156, a60
v_mfma_f32_16x16x32_bf16 a[96:99], v[8:11], v[216:219], a[96:99]
ds_read_b64_tr_b16 v[214:215], v14 offset:6656
v_accvgpr_read_b32 v157, a61
v_accvgpr_read_b32 v158, a62
v_mfma_f32_16x16x32_bf16 a[96:99], v[160:163], v[220:223], a[96:99]
v_accvgpr_read_b32 v159, a63
v_cvt_pk_bf16_f32 v118, v156, v157
v_cvt_pk_bf16_f32 v119, v158, v159
v_mfma_f32_16x16x32_bf16 a[100:103], v[40:43], v[216:219], a[100:103]
buffer_store_dwordx4 v[116:119], v243, s[20:23], s43 offen offset:1024 sc1
v_accvgpr_read_b32 v128, a64
v_mfma_f32_16x16x32_bf16 a[100:103], v[164:167], v[220:223], a[100:103]
v_accvgpr_read_b32 v129, a65
v_accvgpr_read_b32 v130, a66
v_mfma_f32_16x16x32_bf16 a[104:107], v[72:75], v[216:219], a[104:107]
v_accvgpr_read_b32 v131, a67
v_cvt_pk_bf16_f32 v24, v128, v129
v_mfma_f32_16x16x32_bf16 a[104:107], v[168:171], v[220:223], a[104:107]
v_cvt_pk_bf16_f32 v25, v130, v131
v_accvgpr_read_b32 v136, a68
v_mfma_f32_16x16x32_bf16 a[108:111], v[104:107], v[216:219], a[108:111]
ds_read_b64_tr_b16 v[216:217], v247 offset:20992
ds_read_b64_tr_b16 v[218:219], v247 offset:23040
v_mfma_f32_16x16x32_bf16 a[108:111], v[172:175], v[220:223], a[108:111]
ds_read_b64_tr_b16 v[220:221], v13 offset:4608
s_waitcnt lgkmcnt(3)
v_mfma_f32_16x16x32_bf16 a[96:99], v[176:179], v[208:211], a[96:99]
ds_read_b64_tr_b16 v[222:223], v13 offset:6656
v_accvgpr_read_b32 v137, a69
v_mfma_f32_16x16x32_bf16 a[96:99], v[0:3], v[212:215], a[96:99]
v_accvgpr_read_b32 v138, a70
v_accvgpr_read_b32 v139, a71
v_mfma_f32_16x16x32_bf16 a[100:103], v[180:183], v[208:211], a[100:103]
v_cvt_pk_bf16_f32 v56, v136, v137
v_cvt_pk_bf16_f32 v57, v138, v139
v_mfma_f32_16x16x32_bf16 a[100:103], v[32:35], v[212:215], a[100:103]
v_accvgpr_read_b32 v144, a72
v_accvgpr_read_b32 v145, a73
v_mfma_f32_16x16x32_bf16 a[104:107], v[184:187], v[208:211], a[104:107]
v_accvgpr_read_b32 v146, a74
v_accvgpr_read_b32 v147, a75
v_mfma_f32_16x16x32_bf16 a[104:107], v[64:67], v[212:215], a[104:107]
v_cvt_pk_bf16_f32 v88, v144, v145
v_cvt_pk_bf16_f32 v89, v146, v147
v_mfma_f32_16x16x32_bf16 a[108:111], v[188:191], v[208:211], a[108:111]
ds_read_b64_tr_b16 v[208:209], v13 offset:20992
ds_read_b64_tr_b16 v[210:211], v13 offset:23040
v_mfma_f32_16x16x32_bf16 a[108:111], v[96:99], v[212:215], a[108:111]
ds_read_b64_tr_b16 v[212:213], v15 offset:4608
s_waitcnt lgkmcnt(3)
v_mfma_f32_16x16x32_bf16 a[112:115], v[8:11], v[216:219], a[112:115]
ds_read_b64_tr_b16 v[214:215], v15 offset:6656
v_accvgpr_read_b32 v152, a76
v_mfma_f32_16x16x32_bf16 a[112:115], v[160:163], v[220:223], a[112:115]
v_accvgpr_read_b32 v153, a77
v_accvgpr_read_b32 v154, a78
v_mfma_f32_16x16x32_bf16 a[116:119], v[40:43], v[216:219], a[116:119]
v_accvgpr_read_b32 v155, a79
v_cvt_pk_bf16_f32 v120, v152, v153
v_mfma_f32_16x16x32_bf16 a[116:119], v[164:167], v[220:223], a[116:119]
v_cvt_pk_bf16_f32 v121, v154, v155
v_accvgpr_read_b32 v132, a80
v_mfma_f32_16x16x32_bf16 a[120:123], v[72:75], v[216:219], a[120:123]
v_accvgpr_read_b32 v133, a81
v_accvgpr_read_b32 v134, a82
v_mfma_f32_16x16x32_bf16 a[120:123], v[168:171], v[220:223], a[120:123]
v_accvgpr_read_b32 v135, a83
v_cvt_pk_bf16_f32 v26, v132, v133
v_mfma_f32_16x16x32_bf16 a[124:127], v[104:107], v[216:219], a[124:127]
ds_read_b64_tr_b16 v[216:217], v246 offset:8192
ds_read_b64_tr_b16 v[218:219], v246 offset:10240
v_mfma_f32_16x16x32_bf16 a[124:127], v[172:175], v[220:223], a[124:127]
ds_read_b64_tr_b16 v[220:221], v246 offset:24576
s_waitcnt lgkmcnt(3)
v_mfma_f32_16x16x32_bf16 a[112:115], v[176:179], v[208:211], a[112:115]
ds_read_b64_tr_b16 v[222:223], v246 offset:26624
v_cvt_pk_bf16_f32 v27, v134, v135
v_mfma_f32_16x16x32_bf16 a[112:115], v[0:3], v[212:215], a[112:115]
buffer_store_dwordx4 v[24:27], v243, s[20:23], s40 offen offset:2048 sc1
ds_write_b128 v231, v[24:27] offset:2048
v_mfma_f32_16x16x32_bf16 a[116:119], v[180:183], v[208:211], a[116:119]
v_accvgpr_read_b32 v140, a84
v_accvgpr_read_b32 v141, a85
v_mfma_f32_16x16x32_bf16 a[116:119], v[32:35], v[212:215], a[116:119]
v_accvgpr_read_b32 v142, a86
v_accvgpr_read_b32 v143, a87
v_mfma_f32_16x16x32_bf16 a[120:123], v[184:187], v[208:211], a[120:123]
v_cvt_pk_bf16_f32 v58, v140, v141
v_cvt_pk_bf16_f32 v59, v142, v143
v_mfma_f32_16x16x32_bf16 a[120:123], v[64:67], v[212:215], a[120:123]
buffer_store_dwordx4 v[56:59], v243, s[20:23], s41 offen offset:2048 sc1
v_accvgpr_read_b32 v148, a88
v_mfma_f32_16x16x32_bf16 a[124:127], v[188:191], v[208:211], a[124:127]
ds_read_b64_tr_b16 v[208:209], v12 offset:8192
ds_read_b64_tr_b16 v[210:211], v12 offset:10240
v_mfma_f32_16x16x32_bf16 a[124:127], v[96:99], v[212:215], a[124:127]
ds_read_b64_tr_b16 v[212:213], v12 offset:24576
s_waitcnt lgkmcnt(3)
v_mfma_f32_16x16x32_bf16 a[128:131], v[4:7], v[216:219], a[128:131]
ds_read_b64_tr_b16 v[214:215], v12 offset:26624
v_accvgpr_read_b32 v149, a89
v_mfma_f32_16x16x32_bf16 a[128:131], v[8:11], v[220:223], a[128:131]
v_accvgpr_read_b32 v150, a90
v_accvgpr_read_b32 v151, a91
v_mfma_f32_16x16x32_bf16 a[132:135], v[36:39], v[216:219], a[132:135]
v_cvt_pk_bf16_f32 v90, v148, v149
v_cvt_pk_bf16_f32 v91, v150, v151
v_mfma_f32_16x16x32_bf16 a[132:135], v[40:43], v[220:223], a[132:135]
buffer_store_dwordx4 v[88:91], v243, s[20:23], s42 offen offset:2048 sc1
v_accvgpr_read_b32 v156, a92
v_mfma_f32_16x16x32_bf16 a[136:139], v[68:71], v[216:219], a[136:139]
v_accvgpr_read_b32 v157, a93
v_accvgpr_read_b32 v158, a94
v_mfma_f32_16x16x32_bf16 a[136:139], v[72:75], v[220:223], a[136:139]
v_accvgpr_read_b32 v159, a95
v_cvt_pk_bf16_f32 v122, v156, v157
v_mfma_f32_16x16x32_bf16 a[140:143], v[100:103], v[216:219], a[140:143]
ds_read_b64_tr_b16 v[216:217], v14 offset:8192
ds_read_b64_tr_b16 v[218:219], v14 offset:10240
v_mfma_f32_16x16x32_bf16 a[140:143], v[104:107], v[220:223], a[140:143]
ds_read_b64_tr_b16 v[220:221], v247 offset:8192
s_waitcnt lgkmcnt(3)
v_mfma_f32_16x16x32_bf16 a[128:131], v[160:163], v[208:211], a[128:131]
ds_read_b64_tr_b16 v[222:223], v247 offset:10240
v_cvt_pk_bf16_f32 v123, v158, v159
v_mfma_f32_16x16x32_bf16 a[128:131], v[176:179], v[212:215], a[128:131]
buffer_store_dwordx4 v[120:123], v243, s[20:23], s43 offen offset:2048 sc1
v_accvgpr_read_b32 v128, a96
v_mfma_f32_16x16x32_bf16 a[132:135], v[164:167], v[208:211], a[132:135]
v_accvgpr_read_b32 v129, a97
v_accvgpr_read_b32 v130, a98
v_mfma_f32_16x16x32_bf16 a[132:135], v[180:183], v[212:215], a[132:135]
v_accvgpr_read_b32 v131, a99
v_cvt_pk_bf16_f32 v28, v128, v129
v_mfma_f32_16x16x32_bf16 a[136:139], v[168:171], v[208:211], a[136:139]
v_cvt_pk_bf16_f32 v29, v130, v131
v_accvgpr_read_b32 v136, a100
v_mfma_f32_16x16x32_bf16 a[136:139], v[184:187], v[212:215], a[136:139]
v_accvgpr_read_b32 v137, a101
v_accvgpr_read_b32 v138, a102
v_mfma_f32_16x16x32_bf16 a[140:143], v[172:175], v[208:211], a[140:143]
ds_read_b64_tr_b16 v[208:209], v247 offset:24576
ds_read_b64_tr_b16 v[210:211], v247 offset:26624
v_mfma_f32_16x16x32_bf16 a[140:143], v[188:191], v[212:215], a[140:143]
ds_read_b64_tr_b16 v[212:213], v13 offset:8192
s_waitcnt lgkmcnt(5)
v_mfma_f32_16x16x32_bf16 a[128:131], v[0:3], v[216:219], a[128:131]
ds_read_b64_tr_b16 v[214:215], v13 offset:10240
v_accvgpr_read_b32 v139, a103
v_mfma_f32_16x16x32_bf16 a[132:135], v[32:35], v[216:219], a[132:135]
v_cvt_pk_bf16_f32 v60, v136, v137
v_cvt_pk_bf16_f32 v61, v138, v139
v_mfma_f32_16x16x32_bf16 a[136:139], v[64:67], v[216:219], a[136:139]
v_accvgpr_read_b32 v144, a104
v_accvgpr_read_b32 v145, a105
v_mfma_f32_16x16x32_bf16 a[140:143], v[96:99], v[216:219], a[140:143]
ds_read_b64_tr_b16 v[216:217], v13 offset:24576
s_waitcnt lgkmcnt(5)
v_mfma_f32_16x16x32_bf16 a[144:147], v[4:7], v[220:223], a[144:147]
ds_read_b64_tr_b16 v[218:219], v13 offset:26624
v_accvgpr_read_b32 v146, a106
v_mfma_f32_16x16x32_bf16 a[148:151], v[36:39], v[220:223], a[148:151]
v_accvgpr_read_b32 v147, a107
v_cvt_pk_bf16_f32 v92, v144, v145
v_mfma_f32_16x16x32_bf16 a[152:155], v[68:71], v[220:223], a[152:155]
v_cvt_pk_bf16_f32 v93, v146, v147
v_accvgpr_read_b32 v152, a108
v_mfma_f32_16x16x32_bf16 a[156:159], v[100:103], v[220:223], a[156:159]
ds_read_b64_tr_b16 v[220:221], v15 offset:8192
s_waitcnt lgkmcnt(3)
v_mfma_f32_16x16x32_bf16 a[144:147], v[8:11], v[208:211], a[144:147]
ds_read_b64_tr_b16 v[222:223], v15 offset:10240
v_accvgpr_read_b32 v153, a109
v_mfma_f32_16x16x32_bf16 a[144:147], v[160:163], v[212:215], a[144:147]
v_accvgpr_read_b32 v154, a110
v_accvgpr_read_b32 v155, a111
v_mfma_f32_16x16x32_bf16 a[148:151], v[40:43], v[208:211], a[148:151]
v_cvt_pk_bf16_f32 v124, v152, v153
v_cvt_pk_bf16_f32 v125, v154, v155
v_mfma_f32_16x16x32_bf16 a[148:151], v[164:167], v[212:215], a[148:151]
v_accvgpr_read_b32 v132, a112
v_accvgpr_read_b32 v133, a113
v_mfma_f32_16x16x32_bf16 a[152:155], v[72:75], v[208:211], a[152:155]
v_accvgpr_read_b32 v134, a114
v_accvgpr_read_b32 v135, a115
v_mfma_f32_16x16x32_bf16 a[152:155], v[168:171], v[212:215], a[152:155]
v_cvt_pk_bf16_f32 v30, v132, v133
v_cvt_pk_bf16_f32 v31, v134, v135
v_mfma_f32_16x16x32_bf16 a[156:159], v[104:107], v[208:211], a[156:159]
ds_read_b64_tr_b16 v[208:209], v246 offset:8704
ds_read_b64_tr_b16 v[210:211], v246 offset:10752
v_mfma_f32_16x16x32_bf16 a[156:159], v[172:175], v[212:215], a[156:159]
ds_read_b64_tr_b16 v[212:213], v246 offset:25088
s_waitcnt lgkmcnt(3)
v_mfma_f32_16x16x32_bf16 a[144:147], v[176:179], v[216:219], a[144:147]
ds_read_b64_tr_b16 v[214:215], v246 offset:27136
buffer_store_dwordx4 v[28:31], v243, s[20:23], s40 offen offset:3072 sc1
v_mfma_f32_16x16x32_bf16 a[144:147], v[0:3], v[220:223], a[144:147]
ds_write_b128 v231, v[28:31] offset:3072
v_accvgpr_read_b32 v140, a116
v_mfma_f32_16x16x32_bf16 a[148:151], v[180:183], v[216:219], a[148:151]
v_accvgpr_read_b32 v141, a117
v_accvgpr_read_b32 v142, a118
v_mfma_f32_16x16x32_bf16 a[148:151], v[32:35], v[220:223], a[148:151]
v_accvgpr_read_b32 v143, a119
v_cvt_pk_bf16_f32 v62, v140, v141
v_mfma_f32_16x16x32_bf16 a[152:155], v[184:187], v[216:219], a[152:155]
v_cvt_pk_bf16_f32 v63, v142, v143
buffer_store_dwordx4 v[60:63], v243, s[20:23], s41 offen offset:3072 sc1
v_mfma_f32_16x16x32_bf16 a[152:155], v[64:67], v[220:223], a[152:155]
v_accvgpr_read_b32 v148, a120
v_accvgpr_read_b32 v149, a121
v_mfma_f32_16x16x32_bf16 a[156:159], v[188:191], v[216:219], a[156:159]
ds_read_b64_tr_b16 v[216:217], v12 offset:8704
ds_read_b64_tr_b16 v[218:219], v12 offset:10752
v_mfma_f32_16x16x32_bf16 a[156:159], v[96:99], v[220:223], a[156:159]
ds_read_b64_tr_b16 v[220:221], v12 offset:25088
s_waitcnt lgkmcnt(3)
v_mfma_f32_16x16x32_bf16 a[160:163], v[4:7], v[208:211], a[160:163]
ds_read_b64_tr_b16 v[222:223], v12 offset:27136
v_accvgpr_read_b32 v150, a122
v_mfma_f32_16x16x32_bf16 a[160:163], v[8:11], v[212:215], a[160:163]
v_accvgpr_read_b32 v151, a123
v_cvt_pk_bf16_f32 v94, v148, v149
v_mfma_f32_16x16x32_bf16 a[164:167], v[36:39], v[208:211], a[164:167]
v_cvt_pk_bf16_f32 v95, v150, v151
buffer_store_dwordx4 v[92:95], v243, s[20:23], s42 offen offset:3072 sc1
v_mfma_f32_16x16x32_bf16 a[164:167], v[40:43], v[212:215], a[164:167]
v_accvgpr_read_b32 v156, a124
v_accvgpr_read_b32 v157, a125
v_mfma_f32_16x16x32_bf16 a[168:171], v[68:71], v[208:211], a[168:171]
v_accvgpr_read_b32 v158, a126
v_accvgpr_read_b32 v159, a127
v_mfma_f32_16x16x32_bf16 a[168:171], v[72:75], v[212:215], a[168:171]
v_cvt_pk_bf16_f32 v126, v156, v157
v_cvt_pk_bf16_f32 v127, v158, v159
v_mfma_f32_16x16x32_bf16 a[172:175], v[100:103], v[208:211], a[172:175]
ds_read_b64_tr_b16 v[208:209], v14 offset:8704
ds_read_b64_tr_b16 v[210:211], v14 offset:10752
v_mfma_f32_16x16x32_bf16 a[172:175], v[104:107], v[212:215], a[172:175]
ds_read_b64_tr_b16 v[212:213], v247 offset:8704
s_waitcnt lgkmcnt(3)
v_mfma_f32_16x16x32_bf16 a[160:163], v[160:163], v[216:219], a[160:163]
ds_read_b64_tr_b16 v[214:215], v247 offset:10752
buffer_store_dwordx4 v[124:127], v243, s[20:23], s43 offen offset:3072 sc1
v_mfma_f32_16x16x32_bf16 a[160:163], v[176:179], v[220:223], a[160:163]
v_accvgpr_read_b32 v128, a128
v_accvgpr_read_b32 v129, a129
v_mfma_f32_16x16x32_bf16 a[164:167], v[164:167], v[216:219], a[164:167]
v_accvgpr_read_b32 v130, a130
v_accvgpr_read_b32 v131, a131
v_mfma_f32_16x16x32_bf16 a[164:167], v[180:183], v[220:223], a[164:167]
v_cvt_pk_bf16_f32 v16, v128, v129
v_cvt_pk_bf16_f32 v17, v130, v131
v_mfma_f32_16x16x32_bf16 a[168:171], v[168:171], v[216:219], a[168:171]
v_accvgpr_read_b32 v136, a132
v_accvgpr_read_b32 v137, a133
v_mfma_f32_16x16x32_bf16 a[168:171], v[184:187], v[220:223], a[168:171]
v_accvgpr_read_b32 v138, a134
v_accvgpr_read_b32 v139, a135
v_mfma_f32_16x16x32_bf16 a[172:175], v[172:175], v[216:219], a[172:175]
ds_read_b64_tr_b16 v[216:217], v247 offset:25088
ds_read_b64_tr_b16 v[218:219], v247 offset:27136
v_mfma_f32_16x16x32_bf16 a[172:175], v[188:191], v[220:223], a[172:175]
ds_read_b64_tr_b16 v[220:221], v13 offset:8704
s_waitcnt lgkmcnt(5)
v_mfma_f32_16x16x32_bf16 a[160:163], v[0:3], v[208:211], a[160:163]
ds_read_b64_tr_b16 v[222:223], v13 offset:10752
v_cvt_pk_bf16_f32 v48, v136, v137
v_mfma_f32_16x16x32_bf16 a[164:167], v[32:35], v[208:211], a[164:167]
v_cvt_pk_bf16_f32 v49, v138, v139
v_accvgpr_read_b32 v144, a136
v_mfma_f32_16x16x32_bf16 a[168:171], v[64:67], v[208:211], a[168:171]
v_accvgpr_read_b32 v145, a137
v_accvgpr_read_b32 v146, a138
v_mfma_f32_16x16x32_bf16 a[172:175], v[96:99], v[208:211], a[172:175]
ds_read_b64_tr_b16 v[208:209], v13 offset:25088
s_waitcnt lgkmcnt(5)
v_mfma_f32_16x16x32_bf16 a[176:179], v[4:7], v[212:215], a[176:179]
ds_read_b64_tr_b16 v[210:211], v13 offset:27136
v_accvgpr_read_b32 v147, a139
v_mfma_f32_16x16x32_bf16 a[180:183], v[36:39], v[212:215], a[180:183]
v_cvt_pk_bf16_f32 v80, v144, v145
v_cvt_pk_bf16_f32 v81, v146, v147
v_mfma_f32_16x16x32_bf16 a[184:187], v[68:71], v[212:215], a[184:187]
v_accvgpr_read_b32 v152, a140
v_accvgpr_read_b32 v153, a141
v_mfma_f32_16x16x32_bf16 a[188:191], v[100:103], v[212:215], a[188:191]
ds_read_b64_tr_b16 v[212:213], v15 offset:8704
s_waitcnt lgkmcnt(3)
v_mfma_f32_16x16x32_bf16 a[176:179], v[8:11], v[216:219], a[176:179]
ds_read_b64_tr_b16 v[214:215], v15 offset:10752
v_accvgpr_read_b32 v154, a142
v_mfma_f32_16x16x32_bf16 a[176:179], v[160:163], v[220:223], a[176:179]
v_accvgpr_read_b32 v155, a143
v_cvt_pk_bf16_f32 v112, v152, v153
v_mfma_f32_16x16x32_bf16 a[180:183], v[40:43], v[216:219], a[180:183]
v_cvt_pk_bf16_f32 v113, v154, v155
v_accvgpr_read_b32 v132, a144
v_mfma_f32_16x16x32_bf16 a[180:183], v[164:167], v[220:223], a[180:183]
v_accvgpr_read_b32 v133, a145
v_accvgpr_read_b32 v134, a146
v_mfma_f32_16x16x32_bf16 a[184:187], v[72:75], v[216:219], a[184:187]
v_accvgpr_read_b32 v135, a147
v_cvt_pk_bf16_f32 v18, v132, v133
v_mfma_f32_16x16x32_bf16 a[184:187], v[168:171], v[220:223], a[184:187]
v_cvt_pk_bf16_f32 v19, v134, v135
buffer_store_dwordx4 v[16:19], v243, s[20:23], s44 offen offset:0 sc1
v_mfma_f32_16x16x32_bf16 a[188:191], v[104:107], v[216:219], a[188:191]
ds_read_b64_tr_b16 v[216:217], v246 offset:12288
ds_read_b64_tr_b16 v[218:219], v246 offset:14336
v_mfma_f32_16x16x32_bf16 a[188:191], v[172:175], v[220:223], a[188:191]
ds_read_b64_tr_b16 v[220:221], v246 offset:28672
s_waitcnt lgkmcnt(3)
v_mfma_f32_16x16x32_bf16 a[176:179], v[176:179], v[208:211], a[176:179]
ds_read_b64_tr_b16 v[222:223], v246 offset:30720
ds_write_b128 v231, v[16:19] offset:4096
v_mfma_f32_16x16x32_bf16 a[176:179], v[0:3], v[212:215], a[176:179]
v_accvgpr_read_b32 v140, a148
v_accvgpr_read_b32 v141, a149
v_mfma_f32_16x16x32_bf16 a[180:183], v[180:183], v[208:211], a[180:183]
v_accvgpr_read_b32 v142, a150
v_accvgpr_read_b32 v143, a151
v_mfma_f32_16x16x32_bf16 a[180:183], v[32:35], v[212:215], a[180:183]
v_cvt_pk_bf16_f32 v50, v140, v141
v_cvt_pk_bf16_f32 v51, v142, v143
v_mfma_f32_16x16x32_bf16 a[184:187], v[184:187], v[208:211], a[184:187]
buffer_store_dwordx4 v[48:51], v243, s[20:23], s45 offen offset:0 sc1
v_accvgpr_read_b32 v148, a152
v_mfma_f32_16x16x32_bf16 a[184:187], v[64:67], v[212:215], a[184:187]
v_accvgpr_read_b32 v149, a153
v_accvgpr_read_b32 v150, a154
v_mfma_f32_16x16x32_bf16 a[188:191], v[188:191], v[208:211], a[188:191]
ds_read_b64_tr_b16 v[208:209], v12 offset:12288
ds_read_b64_tr_b16 v[210:211], v12 offset:14336
v_mfma_f32_16x16x32_bf16 a[188:191], v[96:99], v[212:215], a[188:191]
ds_read_b64_tr_b16 v[212:213], v12 offset:28672
s_waitcnt lgkmcnt(3)
v_mfma_f32_16x16x32_bf16 a[192:195], v[4:7], v[216:219], a[192:195]
ds_read_b64_tr_b16 v[214:215], v12 offset:30720
v_accvgpr_read_b32 v151, a155
v_mfma_f32_16x16x32_bf16 a[192:195], v[8:11], v[220:223], a[192:195]
v_cvt_pk_bf16_f32 v82, v148, v149
v_cvt_pk_bf16_f32 v83, v150, v151
v_mfma_f32_16x16x32_bf16 a[196:199], v[36:39], v[216:219], a[196:199]
buffer_store_dwordx4 v[80:83], v243, s[20:23], s46 offen offset:0 sc1
v_accvgpr_read_b32 v156, a156
v_mfma_f32_16x16x32_bf16 a[196:199], v[40:43], v[220:223], a[196:199]
v_accvgpr_read_b32 v157, a157
v_accvgpr_read_b32 v158, a158
v_mfma_f32_16x16x32_bf16 a[200:203], v[68:71], v[216:219], a[200:203]
v_accvgpr_read_b32 v159, a159
v_cvt_pk_bf16_f32 v114, v156, v157
v_mfma_f32_16x16x32_bf16 a[200:203], v[72:75], v[220:223], a[200:203]
v_cvt_pk_bf16_f32 v115, v158, v159
buffer_store_dwordx4 v[112:115], v243, s[20:23], s47 offen offset:0 sc1
v_mfma_f32_16x16x32_bf16 a[204:207], v[100:103], v[216:219], a[204:207]
ds_read_b64_tr_b16 v[216:217], v14 offset:12288
ds_read_b64_tr_b16 v[218:219], v14 offset:14336
v_mfma_f32_16x16x32_bf16 a[204:207], v[104:107], v[220:223], a[204:207]
ds_read_b64_tr_b16 v[220:221], v247 offset:12288
s_waitcnt lgkmcnt(3)
v_mfma_f32_16x16x32_bf16 a[192:195], v[160:163], v[208:211], a[192:195]
ds_read_b64_tr_b16 v[222:223], v247 offset:14336
v_accvgpr_read_b32 v128, a160
v_mfma_f32_16x16x32_bf16 a[192:195], v[176:179], v[212:215], a[192:195]
v_accvgpr_read_b32 v129, a161
v_accvgpr_read_b32 v130, a162
v_mfma_f32_16x16x32_bf16 a[196:199], v[164:167], v[208:211], a[196:199]
v_accvgpr_read_b32 v131, a163
v_cvt_pk_bf16_f32 v20, v128, v129
v_mfma_f32_16x16x32_bf16 a[196:199], v[180:183], v[212:215], a[196:199]
v_cvt_pk_bf16_f32 v21, v130, v131
v_accvgpr_read_b32 v136, a164
v_mfma_f32_16x16x32_bf16 a[200:203], v[168:171], v[208:211], a[200:203]
v_accvgpr_read_b32 v137, a165
v_accvgpr_read_b32 v138, a166
v_mfma_f32_16x16x32_bf16 a[200:203], v[184:187], v[212:215], a[200:203]
v_accvgpr_read_b32 v139, a167
v_cvt_pk_bf16_f32 v52, v136, v137
v_mfma_f32_16x16x32_bf16 a[204:207], v[172:175], v[208:211], a[204:207]
ds_read_b64_tr_b16 v[208:209], v247 offset:28672
ds_read_b64_tr_b16 v[210:211], v247 offset:30720
v_mfma_f32_16x16x32_bf16 a[204:207], v[188:191], v[212:215], a[204:207]
ds_read_b64_tr_b16 v[212:213], v13 offset:12288
s_waitcnt lgkmcnt(5)
v_mfma_f32_16x16x32_bf16 a[192:195], v[0:3], v[216:219], a[192:195]
ds_read_b64_tr_b16 v[214:215], v13 offset:14336
v_cvt_pk_bf16_f32 v53, v138, v139
v_mfma_f32_16x16x32_bf16 a[196:199], v[32:35], v[216:219], a[196:199]
v_accvgpr_read_b32 v144, a168
v_accvgpr_read_b32 v145, a169
v_mfma_f32_16x16x32_bf16 a[200:203], v[64:67], v[216:219], a[200:203]
v_accvgpr_read_b32 v146, a170
v_accvgpr_read_b32 v147, a171
v_mfma_f32_16x16x32_bf16 a[204:207], v[96:99], v[216:219], a[204:207]
ds_read_b64_tr_b16 v[216:217], v13 offset:28672
s_waitcnt lgkmcnt(5)
v_mfma_f32_16x16x32_bf16 a[208:211], v[4:7], v[220:223], a[208:211]
ds_read_b64_tr_b16 v[218:219], v13 offset:30720
v_cvt_pk_bf16_f32 v84, v144, v145
v_mfma_f32_16x16x32_bf16 a[212:215], v[36:39], v[220:223], a[212:215]
v_cvt_pk_bf16_f32 v85, v146, v147
v_accvgpr_read_b32 v152, a172
v_mfma_f32_16x16x32_bf16 a[216:219], v[68:71], v[220:223], a[216:219]
v_accvgpr_read_b32 v153, a173
v_accvgpr_read_b32 v154, a174
v_mfma_f32_16x16x32_bf16 a[220:223], v[100:103], v[220:223], a[220:223]
ds_read_b64_tr_b16 v[220:221], v15 offset:12288
s_waitcnt lgkmcnt(3)
v_mfma_f32_16x16x32_bf16 a[208:211], v[8:11], v[208:211], a[208:211]
ds_read_b64_tr_b16 v[222:223], v15 offset:14336
v_accvgpr_read_b32 v155, a175
v_mfma_f32_16x16x32_bf16 a[208:211], v[160:163], v[212:215], a[208:211]
v_cvt_pk_bf16_f32 v116, v152, v153
v_cvt_pk_bf16_f32 v117, v154, v155
v_mfma_f32_16x16x32_bf16 a[212:215], v[40:43], v[208:211], a[212:215]
v_accvgpr_read_b32 v132, a176
v_accvgpr_read_b32 v133, a177
v_mfma_f32_16x16x32_bf16 a[212:215], v[164:167], v[212:215], a[212:215]
v_accvgpr_read_b32 v134, a178
v_accvgpr_read_b32 v135, a179
v_mfma_f32_16x16x32_bf16 a[216:219], v[72:75], v[208:211], a[216:219]
v_cvt_pk_bf16_f32 v22, v132, v133
v_cvt_pk_bf16_f32 v23, v134, v135
v_mfma_f32_16x16x32_bf16 a[216:219], v[168:171], v[212:215], a[216:219]
buffer_store_dwordx4 v[20:23], v243, s[20:23], s44 offen offset:1024 sc1
ds_write_b128 v231, v[20:23] offset:5120
v_mfma_f32_16x16x32_bf16 a[220:223], v[104:107], v[208:211], a[220:223]
v_accvgpr_read_b32 v140, a180
v_accvgpr_read_b32 v141, a181
v_mfma_f32_16x16x32_bf16 a[220:223], v[172:175], v[212:215], a[220:223]
s_waitcnt lgkmcnt(0)
v_accvgpr_read_b32 v142, a182
v_mfma_f32_16x16x32_bf16 a[208:211], v[176:179], v[216:219], a[208:211]
v_accvgpr_read_b32 v143, a183
v_cvt_pk_bf16_f32 v54, v140, v141
v_mfma_f32_16x16x32_bf16 a[208:211], v[0:3], v[220:223], a[208:211]
v_cvt_pk_bf16_f32 v55, v142, v143
buffer_store_dwordx4 v[52:55], v243, s[20:23], s45 offen offset:1024 sc1
v_mfma_f32_16x16x32_bf16 a[212:215], v[180:183], v[216:219], a[212:215]
v_accvgpr_read_b32 v148, a184
v_accvgpr_read_b32 v149, a185
v_mfma_f32_16x16x32_bf16 a[212:215], v[32:35], v[220:223], a[212:215]
v_accvgpr_read_b32 v150, a186
v_accvgpr_read_b32 v151, a187
v_mfma_f32_16x16x32_bf16 a[216:219], v[184:187], v[216:219], a[216:219]
v_cvt_pk_bf16_f32 v86, v148, v149
v_cvt_pk_bf16_f32 v87, v150, v151
v_mfma_f32_16x16x32_bf16 a[216:219], v[64:67], v[220:223], a[216:219]
buffer_store_dwordx4 v[84:87], v243, s[20:23], s46 offen offset:1024 sc1
v_accvgpr_read_b32 v156, a188
v_mfma_f32_16x16x32_bf16 a[220:223], v[188:191], v[216:219], a[220:223]
v_accvgpr_read_b32 v157, a189
v_accvgpr_read_b32 v158, a190
v_mfma_f32_16x16x32_bf16 a[220:223], v[96:99], v[220:223], a[220:223]
v_accvgpr_read_b32 v159, a191
v_cvt_pk_bf16_f32 v118, v156, v157
v_cvt_pk_bf16_f32 v119, v158, v159
buffer_store_dwordx4 v[116:119], v243, s[20:23], s47 offen offset:1024 sc1
v_accvgpr_read_b32 v128, a192
v_accvgpr_read_b32 v129, a193
v_accvgpr_read_b32 v130, a194
v_accvgpr_read_b32 v131, a195
v_cvt_pk_bf16_f32 v24, v128, v129
v_cvt_pk_bf16_f32 v25, v130, v131
v_accvgpr_read_b32 v136, a196
v_accvgpr_read_b32 v137, a197
v_accvgpr_read_b32 v138, a198
v_accvgpr_read_b32 v139, a199
v_cvt_pk_bf16_f32 v56, v136, v137
v_cvt_pk_bf16_f32 v57, v138, v139
v_accvgpr_read_b32 v144, a200
v_accvgpr_read_b32 v145, a201
v_accvgpr_read_b32 v146, a202
v_accvgpr_read_b32 v147, a203
v_cvt_pk_bf16_f32 v88, v144, v145
v_cvt_pk_bf16_f32 v89, v146, v147
v_accvgpr_read_b32 v152, a204
v_accvgpr_read_b32 v153, a205
v_accvgpr_read_b32 v154, a206
v_accvgpr_read_b32 v155, a207
v_cvt_pk_bf16_f32 v120, v152, v153
v_cvt_pk_bf16_f32 v121, v154, v155
v_accvgpr_read_b32 v132, a208
v_accvgpr_read_b32 v133, a209
v_accvgpr_read_b32 v134, a210
v_accvgpr_read_b32 v135, a211
v_cvt_pk_bf16_f32 v26, v132, v133
v_cvt_pk_bf16_f32 v27, v134, v135
buffer_store_dwordx4 v[24:27], v243, s[20:23], s44 offen offset:2048 sc1
ds_write_b128 v231, v[24:27] offset:6144
v_accvgpr_read_b32 v140, a212
v_accvgpr_read_b32 v141, a213
v_accvgpr_read_b32 v142, a214
v_accvgpr_read_b32 v143, a215
v_cvt_pk_bf16_f32 v58, v140, v141
v_cvt_pk_bf16_f32 v59, v142, v143
buffer_store_dwordx4 v[56:59], v243, s[20:23], s45 offen offset:2048 sc1
v_accvgpr_read_b32 v148, a216
v_accvgpr_read_b32 v149, a217
v_accvgpr_read_b32 v150, a218
v_accvgpr_read_b32 v151, a219
v_cvt_pk_bf16_f32 v90, v148, v149
v_cvt_pk_bf16_f32 v91, v150, v151
buffer_store_dwordx4 v[88:91], v243, s[20:23], s46 offen offset:2048 sc1
v_accvgpr_read_b32 v156, a220
v_accvgpr_read_b32 v157, a221
v_accvgpr_read_b32 v158, a222
v_accvgpr_read_b32 v159, a223
v_cvt_pk_bf16_f32 v122, v156, v157
v_cvt_pk_bf16_f32 v123, v158, v159
buffer_store_dwordx4 v[120:123], v243, s[20:23], s47 offen offset:2048 sc1
s_waitcnt vmcnt(36)
s_branch L2_F
L2_F:
v_cmp_ne_u64 vcc, s[98:99], v[108:109]
s_lshl_b32 s3, s34, 15
s_add_u32 s3, s3, 0x1000000
s_cbranch_vccnz LF_wf
LF_wf_go:
v_add_u32 v240, s3, v243
v_add_u32 v241, 0x4000, v240
s_mov_b32 s32, 0x0
s_mov_b32 s33, 0x1000
s_mov_b32 s35, 0x2000
s_mov_b32 s36, 0x3000
s_mov_b32 s38, 0x20000
s_mov_b32 s39, 0x21000
s_mov_b32 s40, 0x22000
s_mov_b32 s41, 0x23000
s_lshr_b32 s42, s6, 13
s_lshr_b32 s43, s7, 13
s_lshr_b32 s44, s29, 13
v_mov_b32 v244, s42
v_mov_b32 v232, s43
v_cmp_lt_u32 vcc, 0xff, v243
v_mov_b32 v233, s44
s_nop 0
v_cndmask_b32 v244, v244, v232, vcc
v_cmp_lt_u32 vcc, 0x1ff, v243
v_and_b32 v235, 0xf0, v243
s_nop 0
v_cndmask_b32 v244, v244, v233, vcc
v_lshrrev_b32 v232, 3, v235
v_lshl_add_u32 v79, v244, 5, v232
buffer_load_ushort v79, v79, s[52:55], 0 offen
buffer_load_dwordx4 a[0:3], v240, s[16:19], s32 offen offset:0 sc1
buffer_load_dwordx4 a[4:7], v240, s[16:19], s32 offen offset:1024 sc1
buffer_load_dwordx4 a[8:11], v241, s[16:19], s32 offen offset:0 sc1
buffer_load_dwordx4 a[12:15], v241, s[16:19], s32 offen offset:1024 sc1
buffer_load_dwordx4 a[16:19], v240, s[16:19], s32 offen offset:2048 sc1
buffer_load_dwordx4 a[20:23], v240, s[16:19], s32 offen offset:3072 sc1
buffer_load_dwordx4 a[24:27], v241, s[16:19], s32 offen offset:2048 sc1
buffer_load_dwordx4 a[28:31], v241, s[16:19], s32 offen offset:3072 sc1
buffer_load_dwordx4 a[32:35], v240, s[16:19], s33 offen offset:0 sc1
buffer_load_dwordx4 a[36:39], v240, s[16:19], s33 offen offset:1024 sc1
buffer_load_dwordx4 a[40:43], v241, s[16:19], s33 offen offset:0 sc1
buffer_load_dwordx4 a[44:47], v241, s[16:19], s33 offen offset:1024 sc1
s_lshl_b32 s3, s37, 7
v_lshl_add_u32 v244, v244, 11, s3
v_lshl_add_u32 v244, v232, 2, v244
s_cmp_ge_u32 s29, 0x70000000
s_cselect_b32 s44, s43, s44
v_mov_b32 v46, s42
v_mov_b32 v232, s43
v_lshrrev_b32 v233, 7, v243
v_cmp_lt_u32_e64 vcc, 0, v233
s_nop 1
v_cndmask_b32_e64 v46, v46, v232, vcc
v_cmp_lt_u32_e64 vcc, 1, v233
v_mov_b32 v233, s44
v_bfe_u32 v232, v243, 4, 3
v_cndmask_b32_e64 v46, v46, v233, vcc
v_min_u32 v232, 5, v232
v_lshrrev_b32 v46, 2, v46
v_lshl_add_u32 v46, v46, 3, v232
v_lshlrev_b32 v46, 7, v46
v_add_u32 v46, 0x7c00000, v46
s_lshl_b32 s49, s34, 10
s_add_u32 s49, s49, 0x20000
s_bfe_u32 s3, s6, 0x2000f
s_lshl_b32 s3, s3, 13
s_add_u32 s3, s3, s49
v_add_u32 v76, s3, v243
s_bfe_u32 s3, s7, 0x2000f
s_lshl_b32 s3, s3, 13
s_add_u32 s3, s3, s49
v_add_u32 v77, s3, v243
s_bfe_u32 s3, s29, 0x2000f
s_lshl_b32 s3, s3, 13
s_add_u32 s3, s3, s49
v_add_u32 v78, s3, v243
s_add_u32 s3, s37, 1
s_sub_u32 s49, s3, 6
s_cselect_b32 s3, s3, s49
s_mul_i32 s3, s3, 0x600000
s_add_u32 s42, s3, 0x2000000
s_add_u32 s3, s37, 2
s_sub_u32 s49, s3, 6
s_cselect_b32 s3, s3, s49
s_mul_i32 s3, s3, 0x600000
s_add_u32 s43, s3, 0x2000000
s_add_u32 s3, s37, 3
s_sub_u32 s49, s3, 6
s_cselect_b32 s3, s3, s49
s_mul_i32 s3, s3, 0x600000
s_add_u32 s44, s3, 0x2000000
s_add_u32 s3, s37, 4
s_sub_u32 s49, s3, 6
s_cselect_b32 s3, s3, s49
s_mul_i32 s3, s3, 0x600000
s_add_u32 s45, s3, 0x2000000
s_add_u32 s3, s37, 5
s_sub_u32 s49, s3, 6
s_cselect_b32 s3, s3, s49
s_mul_i32 s3, s3, 0x600000
s_add_u32 s46, s3, 0x2000000
s_add_u32 s3, s37, 6
s_sub_u32 s49, s3, 6
s_cselect_b32 s3, s3, s49
s_mul_i32 s3, s3, 0x600000
s_add_u32 s47, s3, 0x2000000
s_mul_i32 s3, s34, 896
v_add_u32 v47, s3, v243
v_add_u32 v43, 0x1000, v47
v_lshrrev_b32 v44, 4, v243
v_and_b32 v44, 0x30, v44
v_xor_b32 v44, v44, v243
v_and_b32 v232, 0x380, v243
v_mad_u32_u24 v44, v232, 3, v44
v_xor_b32 v45, 0x1040, v44
v_bfe_u32 v232, v243, 5, 3
v_lshrrev_b32 v234, 8, v243
v_xor_b32 v232, v232, v234
v_bfe_u32 v233, v243, 4, 3
v_lshlrev_b32 v233, 7, v233
v_lshl_or_b32 v232, v232, 4, v233
v_bfe_u32 v233, v243, 7, 1
s_lshl_b32 s49, s34, 10
s_sub_u32 s3, s28, s49
v_lshl_add_u32 v74, v233, 12, v232
v_add_u32 v72, s3, v74
s_sub_u32 s3, s30, s49
v_add_u32 v74, s3, v74
v_xor_b32 v73, 64, v72
v_xor_b32 v75, 64, v74
v_lshl_add_u32 v245, v233, 10, v232
v_add_u32 v245, s31, v245
v_xor_b32 v246, 64, v245
v_add_u32 v247, s31, v243
s_add_u32 s3, s3, 0xa000
s_and_b32 s3, s3, 0x1ffff
v_add_u32 v252, s3, v243
v_add_u32 v251, s49, v252
s_lshl_b32 s49, s34, 11
s_add_u32 s3, s3, s49
s_add_u32 s3, s3, 24576
v_lshl_add_u32 v242, v243, 1, s3
v_lshl_add_u32 v250, v235, 1, s3
v_lshrrev_b32 v232, 4, v235
v_lshlrev_b32 v234, 2, v234
v_sub_u32 v232, v232, v234
v_and_b32 v233, 1, v232
v_lshlrev_b32 v233, 4, v233
v_mov_b32 v234, 0xffff
v_lshlrev_b32 v233, v233, v234
v_lshrrev_b32 v232, 1, v232
v_cmp_eq_u32 vcc, 0, v232
s_nop 1
v_cndmask_b32 v156, 0, v233, vcc
v_cmp_eq_u32 vcc, 1, v232
s_nop 1
v_cndmask_b32 v157, 0, v233, vcc
s_mov_b32 s95, 0xffff0000
s_waitcnt vmcnt(13)
v_mov_b32 v36, s98
v_mov_b32 v37, s99
v_mov_b32 v38, s98
v_mov_b32 v39, s99
s_mov_b64 exec, 0xff
buffer_store_dwordx4 v[36:39], v243, s[16:19], s51 offen sc1
s_mov_b64 exec, -1
s_waitcnt lgkmcnt(0)
s_barrier
ds_read_b128 v[208:211], v72 offset:0
ds_read_b128 v[212:215], v72 offset:8192
ds_read_b128 v[216:219], v74 offset:0
ds_read_b128 v[220:223], v73 offset:0
ds_read_b128 v[224:227], v73 offset:8192
ds_read_b128 v[104:107], v245 offset:0
ds_read_b128 v[108:111], v246 offset:0
ds_read_b128 v[152:155], v245 offset:2048
s_waitcnt vmcnt(13)
v_lshlrev_b32 v79, 16, v79
ds_write_b32 v242, v79 offset:28
ds_read_b32 v253, v250 offset:28
ds_read_b32 v254, v250 offset:540
ds_read_b32 v255, v250 offset:1052
s_waitcnt vmcnt(12)
buffer_load_dwordx4 a[48:51], v240, s[16:19], s33 offen offset:2048 sc1
s_waitcnt vmcnt(12)
buffer_load_dwordx4 a[52:55], v240, s[16:19], s33 offen offset:3072 sc1
s_waitcnt vmcnt(12)
buffer_load_dwordx4 a[56:59], v241, s[16:19], s33 offen offset:2048 sc1
s_waitcnt vmcnt(12)
s_waitcnt lgkmcnt(11)
v_mfma_f32_16x16x32_bf16 v[160:163], a[0:3], v[208:211], 0
ds_read_b128 v[228:231], v75 offset:0
buffer_load_dwordx4 a[60:63], v241, s[16:19], s33 offen offset:3072 sc1
v_mfma_f32_16x16x32_bf16 v[164:167], a[4:7], v[208:211], 0
v_mfma_f32_16x16x32_bf16 v[168:171], a[8:11], v[208:211], 0
v_mfma_f32_16x16x32_bf16 v[172:175], a[12:15], v[208:211], 0
s_waitcnt vmcnt(12)
s_waitcnt lgkmcnt(11)
v_mfma_f32_16x16x32_bf16 v[176:179], a[0:3], v[212:215], 0
ds_read_b128 v[208:211], v72 offset:1024
buffer_load_dwordx4 a[64:67], v240, s[16:19], s35 offen offset:0 sc1
v_mfma_f32_16x16x32_bf16 v[180:183], a[4:7], v[212:215], 0
v_mfma_f32_16x16x32_bf16 v[184:187], a[8:11], v[212:215], 0
v_mfma_f32_16x16x32_bf16 v[188:191], a[12:15], v[212:215], 0
s_waitcnt vmcnt(12)
s_waitcnt lgkmcnt(11)
v_mfma_f32_16x16x32_bf16 v[192:195], a[0:3], v[216:219], 0
ds_read_b128 v[212:215], v72 offset:9216
buffer_load_dwordx4 a[68:71], v240, s[16:19], s35 offen offset:1024 sc1
v_mfma_f32_16x16x32_bf16 v[196:199], a[4:7], v[216:219], 0
v_mfma_f32_16x16x32_bf16 v[200:203], a[8:11], v[216:219], 0
v_mfma_f32_16x16x32_bf16 v[204:207], a[12:15], v[216:219], 0
s_waitcnt vmcnt(12)
buffer_load_dwordx4 a[72:75], v241, s[16:19], s35 offen offset:0 sc1
s_waitcnt vmcnt(12)
s_waitcnt lgkmcnt(11)
v_mfma_f32_16x16x32_bf16 v[160:163], a[16:19], v[220:223], v[160:163]
ds_read_b128 v[216:219], v74 offset:1024
buffer_load_dwordx4 a[76:79], v241, s[16:19], s35 offen offset:1024 sc1
v_mfma_f32_16x16x32_bf16 v[164:167], a[20:23], v[220:223], v[164:167]
v_mfma_f32_16x16x32_bf16 v[168:171], a[24:27], v[220:223], v[168:171]
v_mfma_f32_16x16x32_bf16 v[172:175], a[28:31], v[220:223], v[172:175]
s_waitcnt vmcnt(12)
s_waitcnt lgkmcnt(11)
v_mfma_f32_16x16x32_bf16 v[176:179], a[16:19], v[224:227], v[176:179]
ds_read_b128 v[220:223], v73 offset:1024
buffer_load_dwordx4 a[80:83], v240, s[16:19], s35 offen offset:2048 sc1
v_mfma_f32_16x16x32_bf16 v[180:183], a[20:23], v[224:227], v[180:183]
v_mfma_f32_16x16x32_bf16 v[184:187], a[24:27], v[224:227], v[184:187]
v_mfma_f32_16x16x32_bf16 v[188:191], a[28:31], v[224:227], v[188:191]
s_waitcnt vmcnt(12)
s_waitcnt lgkmcnt(4)
v_mfma_f32_16x16x32_bf16 v[192:195], a[16:19], v[228:231], v[192:195]
ds_read_b128 v[224:227], v73 offset:9216
buffer_load_dwordx4 a[84:87], v240, s[16:19], s35 offen offset:3072 sc1
v_mfma_f32_16x16x32_bf16 v[196:199], a[20:23], v[228:231], v[196:199]
v_mfma_f32_16x16x32_bf16 v[200:203], a[24:27], v[228:231], v[200:203]
v_mfma_f32_16x16x32_bf16 v[204:207], a[28:31], v[228:231], v[204:207]
s_waitcnt vmcnt(12)
buffer_load_dwordx4 a[88:91], v241, s[16:19], s35 offen offset:2048 sc1
s_waitcnt vmcnt(12)
s_waitcnt lgkmcnt(4)
v_mfma_f32_16x16x32_bf16 v[160:163], a[32:35], v[208:211], v[160:163]
ds_read_b128 v[228:231], v75 offset:1024
buffer_load_dwordx4 a[92:95], v241, s[16:19], s35 offen offset:3072 sc1
v_mfma_f32_16x16x32_bf16 v[164:167], a[36:39], v[208:211], v[164:167]
v_mfma_f32_16x16x32_bf16 v[168:171], a[40:43], v[208:211], v[168:171]
v_mfma_f32_16x16x32_bf16 v[172:175], a[44:47], v[208:211], v[172:175]
s_waitcnt lgkmcnt(4)
v_mfma_f32_16x16x32_bf16 v[176:179], a[32:35], v[212:215], v[176:179]
ds_read_b128 v[208:211], v72 offset:2048
v_mfma_f32_16x16x32_bf16 v[180:183], a[36:39], v[212:215], v[180:183]
v_mfma_f32_16x16x32_bf16 v[184:187], a[40:43], v[212:215], v[184:187]
v_mfma_f32_16x16x32_bf16 v[188:191], a[44:47], v[212:215], v[188:191]
s_waitcnt vmcnt(11)
s_waitcnt lgkmcnt(4)
v_mfma_f32_16x16x32_bf16 v[192:195], a[32:35], v[216:219], v[192:195]
ds_read_b128 v[212:215], v72 offset:10240
buffer_load_dwordx2 v[248:249], v46, s[16:19], 0 offen offset:0 sc1
v_mfma_f32_16x16x32_bf16 v[196:199], a[36:39], v[216:219], v[196:199]
v_mfma_f32_16x16x32_bf16 v[200:203], a[40:43], v[216:219], v[200:203]
v_mfma_f32_16x16x32_bf16 v[204:207], a[44:47], v[216:219], v[204:207]
s_waitcnt vmcnt(11)
buffer_load_dwordx4 a[96:99], v240, s[16:19], s36 offen offset:0 sc1
s_waitcnt vmcnt(11)
buffer_load_dwordx4 a[100:103], v240, s[16:19], s36 offen offset:1024 sc1
s_waitcnt vmcnt(11)
s_waitcnt lgkmcnt(4)
v_mfma_f32_16x16x32_bf16 v[160:163], a[48:51], v[220:223], v[160:163]
ds_read_b128 v[216:219], v74 offset:2048
buffer_load_dwordx4 a[104:107], v241, s[16:19], s36 offen offset:0 sc1
v_mfma_f32_16x16x32_bf16 v[164:167], a[52:55], v[220:223], v[164:167]
v_mfma_f32_16x16x32_bf16 v[168:171], a[56:59], v[220:223], v[168:171]
v_mfma_f32_16x16x32_bf16 v[172:175], a[60:63], v[220:223], v[172:175]
s_waitcnt vmcnt(11)
s_waitcnt lgkmcnt(4)
v_mfma_f32_16x16x32_bf16 v[176:179], a[48:51], v[224:227], v[176:179]
ds_read_b128 v[220:223], v73 offset:2048
buffer_load_dwordx4 a[108:111], v241, s[16:19], s36 offen offset:1024 sc1
v_mfma_f32_16x16x32_bf16 v[180:183], a[52:55], v[224:227], v[180:183]
v_mfma_f32_16x16x32_bf16 v[184:187], a[56:59], v[224:227], v[184:187]
v_mfma_f32_16x16x32_bf16 v[188:191], a[60:63], v[224:227], v[188:191]
s_waitcnt vmcnt(11)
s_waitcnt lgkmcnt(4)
v_mfma_f32_16x16x32_bf16 v[192:195], a[48:51], v[228:231], v[192:195]
ds_read_b128 v[224:227], v73 offset:10240
buffer_load_dwordx4 a[112:115], v240, s[16:19], s36 offen offset:2048 sc1
v_mfma_f32_16x16x32_bf16 v[196:199], a[52:55], v[228:231], v[196:199]
v_mfma_f32_16x16x32_bf16 v[200:203], a[56:59], v[228:231], v[200:203]
v_mfma_f32_16x16x32_bf16 v[204:207], a[60:63], v[228:231], v[204:207]
s_waitcnt vmcnt(11)
buffer_load_dwordx4 a[116:119], v240, s[16:19], s36 offen offset:3072 sc1
s_waitcnt vmcnt(11)
s_waitcnt lgkmcnt(4)
v_mfma_f32_16x16x32_bf16 v[160:163], a[64:67], v[208:211], v[160:163]
ds_read_b128 v[228:231], v75 offset:2048
buffer_load_dwordx4 a[120:123], v241, s[16:19], s36 offen offset:2048 sc1
v_mfma_f32_16x16x32_bf16 v[164:167], a[68:71], v[208:211], v[164:167]
v_mfma_f32_16x16x32_bf16 v[168:171], a[72:75], v[208:211], v[168:171]
v_mfma_f32_16x16x32_bf16 v[172:175], a[76:79], v[208:211], v[172:175]
s_waitcnt vmcnt(11)
s_waitcnt lgkmcnt(4)
v_mfma_f32_16x16x32_bf16 v[176:179], a[64:67], v[212:215], v[176:179]
ds_read_b128 v[208:211], v72 offset:3072
buffer_load_dwordx4 a[124:127], v241, s[16:19], s36 offen offset:3072 sc1
v_mfma_f32_16x16x32_bf16 v[180:183], a[68:71], v[212:215], v[180:183]
v_mfma_f32_16x16x32_bf16 v[184:187], a[72:75], v[212:215], v[184:187]
v_mfma_f32_16x16x32_bf16 v[188:191], a[76:79], v[212:215], v[188:191]
s_waitcnt vmcnt(11)
s_waitcnt lgkmcnt(4)
v_mfma_f32_16x16x32_bf16 v[192:195], a[64:67], v[216:219], v[192:195]
ds_read_b128 v[212:215], v72 offset:11264
v_mfma_f32_16x16x32_bf16 v[196:199], a[68:71], v[216:219], v[196:199]
v_mfma_f32_16x16x32_bf16 v[200:203], a[72:75], v[216:219], v[200:203]
v_mfma_f32_16x16x32_bf16 v[204:207], a[76:79], v[216:219], v[204:207]
s_waitcnt vmcnt(10)
s_waitcnt vmcnt(9)
s_waitcnt lgkmcnt(4)
v_mfma_f32_16x16x32_bf16 v[160:163], a[80:83], v[220:223], v[160:163]
ds_read_b128 v[216:219], v74 offset:3072
v_mfma_f32_16x16x32_bf16 v[164:167], a[84:87], v[220:223], v[164:167]
v_mfma_f32_16x16x32_bf16 v[168:171], a[88:91], v[220:223], v[168:171]
v_mfma_f32_16x16x32_bf16 v[172:175], a[92:95], v[220:223], v[172:175]
s_waitcnt vmcnt(8)
s_waitcnt lgkmcnt(4)
v_mfma_f32_16x16x32_bf16 v[176:179], a[80:83], v[224:227], v[176:179]
ds_read_b128 v[220:223], v73 offset:3072
v_cmp_ne_u64 vcc, s[98:99], v[248:249]
s_nop 1
s_cbranch_vccnz LF_spinQ
LF_goQ:
v_mfma_f32_16x16x32_bf16 v[180:183], a[84:87], v[224:227], v[180:183]
buffer_load_dwordx2 v[128:129], v244, s[24:27], 0 offen offset:128 sc1
v_mfma_f32_16x16x32_bf16 v[184:187], a[88:91], v[224:227], v[184:187]
buffer_load_dwordx2 v[130:131], v244, s[24:27], 0 offen offset:256 sc1
v_mfma_f32_16x16x32_bf16 v[188:191], a[92:95], v[224:227], v[188:191]
buffer_load_dwordx2 v[132:133], v244, s[24:27], 0 offen offset:384 sc1
buffer_load_dwordx2 v[134:135], v244, s[24:27], 0 offen offset:512 sc1
buffer_load_dwordx2 v[136:137], v244, s[24:27], 0 offen offset:640 sc1
buffer_load_dwordx2 v[138:139], v244, s[24:27], 0 offen offset:768 sc1
s_waitcnt vmcnt(13)
s_waitcnt lgkmcnt(4)
v_mfma_f32_16x16x32_bf16 v[192:195], a[80:83], v[228:231], v[192:195]
ds_read_b128 v[224:227], v73 offset:11264
s_add_u32 s49, s6, s42
buffer_load_dwordx4 v[48:51], v47, s[16:19], s49 offen sc1
v_mfma_f32_16x16x32_bf16 v[196:199], a[84:87], v[228:231], v[196:199]
s_add_u32 s3, s6, s43
buffer_load_dwordx4 v[52:55], v47, s[16:19], s3 offen sc1
v_mfma_f32_16x16x32_bf16 v[200:203], a[88:91], v[228:231], v[200:203]
v_mfma_f32_16x16x32_bf16 v[204:207], a[92:95], v[228:231], v[204:207]
s_waitcnt vmcnt(14)
buffer_load_dwordx4 a[128:131], v240, s[16:19], s38 offen offset:0 sc1
s_waitcnt vmcnt(14)
buffer_load_dwordx4 a[132:135], v240, s[16:19], s38 offen offset:1024 sc1
s_waitcnt vmcnt(14)
s_waitcnt lgkmcnt(4)
v_mfma_f32_16x16x32_bf16 v[160:163], a[96:99], v[208:211], v[160:163]
ds_read_b128 v[228:231], v75 offset:3072
v_mfma_f32_16x16x32_bf16 v[164:167], a[100:103], v[208:211], v[164:167]
v_mfma_f32_16x16x32_bf16 v[168:171], a[104:107], v[208:211], v[168:171]
v_mfma_f32_16x16x32_bf16 v[172:175], a[108:111], v[208:211], v[172:175]
s_waitcnt vmcnt(13)
s_waitcnt lgkmcnt(4)
v_mfma_f32_16x16x32_bf16 v[176:179], a[96:99], v[212:215], v[176:179]
s_add_u32 s49, s6, s44
buffer_load_dwordx4 v[56:59], v47, s[16:19], s49 offen sc1
v_mfma_f32_16x16x32_bf16 v[180:183], a[100:103], v[212:215], v[180:183]
s_add_u32 s3, s6, s45
buffer_load_dwordx4 v[60:63], v47, s[16:19], s3 offen sc1
v_mfma_f32_16x16x32_bf16 v[184:187], a[104:107], v[212:215], v[184:187]
v_mfma_f32_16x16x32_bf16 v[188:191], a[108:111], v[212:215], v[188:191]
s_waitcnt vmcnt(14)
s_waitcnt lgkmcnt(3)
v_mfma_f32_16x16x32_bf16 v[192:195], a[96:99], v[216:219], v[192:195]
buffer_load_dwordx4 a[136:139], v241, s[16:19], s38 offen offset:0 sc1
v_mfma_f32_16x16x32_bf16 v[196:199], a[100:103], v[216:219], v[196:199]
v_mfma_f32_16x16x32_bf16 v[200:203], a[104:107], v[216:219], v[200:203]
v_mfma_f32_16x16x32_bf16 v[204:207], a[108:111], v[216:219], v[204:207]
s_waitcnt vmcnt(14)
buffer_load_dwordx4 a[140:143], v241, s[16:19], s38 offen offset:1024 sc1
s_waitcnt vmcnt(14)
s_waitcnt lgkmcnt(2)
v_mfma_f32_16x16x32_bf16 v[160:163], a[112:115], v[220:223], v[160:163]
s_add_u32 s49, s6, s46
buffer_load_dwordx4 v[64:67], v47, s[16:19], s49 offen sc1
v_mfma_f32_16x16x32_bf16 v[164:167], a[116:119], v[220:223], v[164:167]
ds_read_b128 v[68:71], v76 offset:0
v_mfma_f32_16x16x32_bf16 v[168:171], a[120:123], v[220:223], v[168:171]
v_mfma_f32_16x16x32_bf16 v[172:175], a[124:127], v[220:223], v[172:175]
s_waitcnt lgkmcnt(2)
v_mfma_f32_16x16x32_bf16 v[176:179], a[112:115], v[224:227], v[176:179]
v_lshlrev_b32 v234, 16, v104
v_and_b32 v235, s95, v104
v_mfma_f32_16x16x32_bf16 v[180:183], a[116:119], v[224:227], v[180:183]
v_fma_f32 v160, v160, v253, v234
v_fma_f32 v161, v161, v253, v235
v_mfma_f32_16x16x32_bf16 v[184:187], a[120:123], v[224:227], v[184:187]
v_lshlrev_b32 v236, 16, v105
v_and_b32 v237, s95, v105
v_mfma_f32_16x16x32_bf16 v[188:191], a[124:127], v[224:227], v[188:191]
v_fma_f32 v162, v162, v253, v236
v_fma_f32 v163, v163, v253, v237
s_waitcnt lgkmcnt(1)
v_mfma_f32_16x16x32_bf16 v[192:195], a[112:115], v[228:231], v[192:195]
v_lshlrev_b32 v238, 16, v106
v_and_b32 v239, s95, v106
v_mfma_f32_16x16x32_bf16 v[196:199], a[116:119], v[228:231], v[196:199]
v_fma_f32 v164, v164, v253, v238
v_fma_f32 v165, v165, v253, v239
v_mfma_f32_16x16x32_bf16 v[200:203], a[120:123], v[228:231], v[200:203]
v_lshlrev_b32 v232, 16, v107
v_and_b32 v233, s95, v107
v_mfma_f32_16x16x32_bf16 v[204:207], a[124:127], v[228:231], v[204:207]
v_fma_f32 v166, v166, v253, v232
v_fma_f32 v167, v167, v253, v233
ds_read_b128 v[104:107], v246 offset:2048
v_lshlrev_b32 v234, 16, v108
v_and_b32 v235, s95, v108
v_fma_f32 v168, v168, v253, v234
v_fma_f32 v169, v169, v253, v235
v_lshlrev_b32 v236, 16, v109
v_and_b32 v237, s95, v109
v_fma_f32 v170, v170, v253, v236
v_fma_f32 v171, v171, v253, v237
v_lshlrev_b32 v238, 16, v110
v_and_b32 v239, s95, v110
v_fma_f32 v172, v172, v253, v238
v_fma_f32 v173, v173, v253, v239
v_lshlrev_b32 v232, 16, v111
v_and_b32 v233, s95, v111
v_fma_f32 v174, v174, v253, v232
v_fma_f32 v175, v175, v253, v233
ds_read_b128 v[108:111], v245 offset:4096
s_waitcnt vmcnt(13)
buffer_load_dwordx4 a[144:147], v240, s[16:19], s38 offen offset:2048 sc1
v_lshlrev_b32 v234, 16, v152
v_and_b32 v235, s95, v152
v_fma_f32 v176, v176, v254, v234
v_fma_f32 v177, v177, v254, v235
v_lshlrev_b32 v236, 16, v153
v_and_b32 v237, s95, v153
v_fma_f32 v178, v178, v254, v236
v_fma_f32 v179, v179, v254, v237
v_lshlrev_b32 v238, 16, v154
v_and_b32 v239, s95, v154
v_fma_f32 v180, v180, v254, v238
v_fma_f32 v181, v181, v254, v239
v_lshlrev_b32 v232, 16, v155
v_and_b32 v233, s95, v155
v_fma_f32 v182, v182, v254, v232
v_fma_f32 v183, v183, v254, v233
ds_read_b128 v[152:155], v246 offset:4096
s_waitcnt lgkmcnt(2)
v_lshlrev_b32 v234, 16, v104
v_and_b32 v235, s95, v104
v_fma_f32 v184, v184, v254, v234
v_fma_f32 v185, v185, v254, v235
v_lshlrev_b32 v236, 16, v105
v_and_b32 v237, s95, v105
v_fma_f32 v186, v186, v254, v236
v_fma_f32 v187, v187, v254, v237
v_lshlrev_b32 v238, 16, v106
v_and_b32 v239, s95, v106
v_fma_f32 v188, v188, v254, v238
v_fma_f32 v189, v189, v254, v239
v_lshlrev_b32 v232, 16, v107
v_and_b32 v233, s95, v107
v_fma_f32 v190, v190, v254, v232
v_fma_f32 v191, v191, v254, v233
s_waitcnt vmcnt(12)
buffer_load_dwordx4 a[148:151], v240, s[16:19], s38 offen offset:3072 sc1
s_waitcnt lgkmcnt(1)
v_lshlrev_b32 v234, 16, v108
v_and_b32 v235, s95, v108
v_fma_f32 v192, v192, v255, v234
v_fma_f32 v193, v193, v255, v235
v_lshlrev_b32 v236, 16, v109
v_and_b32 v237, s95, v109
v_fma_f32 v194, v194, v255, v236
v_fma_f32 v195, v195, v255, v237
v_lshlrev_b32 v238, 16, v110
v_and_b32 v239, s95, v110
v_fma_f32 v196, v196, v255, v238
v_fma_f32 v197, v197, v255, v239
v_lshlrev_b32 v232, 16, v111
v_and_b32 v233, s95, v111
v_fma_f32 v198, v198, v255, v232
v_fma_f32 v199, v199, v255, v233
s_waitcnt lgkmcnt(0)
v_lshlrev_b32 v234, 16, v152
v_and_b32 v235, s95, v152
v_fma_f32 v200, v200, v255, v234
v_fma_f32 v201, v201, v255, v235
v_lshlrev_b32 v236, 16, v153
v_and_b32 v237, s95, v153
v_fma_f32 v202, v202, v255, v236
v_fma_f32 v203, v203, v255, v237
v_lshlrev_b32 v238, 16, v154
v_and_b32 v239, s95, v154
v_fma_f32 v204, v204, v255, v238
v_fma_f32 v205, v205, v255, v239
v_lshlrev_b32 v232, 16, v155
v_and_b32 v233, s95, v155
v_fma_f32 v206, v206, v255, v232
v_fma_f32 v207, v207, v255, v233
s_waitcnt vmcnt(11)
v_max3_f32 v232, v128, v130, v132
v_max3_f32 v233, v134, v136, v138
v_max_f32 v232, v232, v233
v_subrev_f32 v232, 0x42fe0000, v232
v_sub_f32 v128, v128, v232
v_sub_f32 v130, v130, v232
v_sub_f32 v132, v132, v232
v_sub_f32 v134, v134, v232
v_sub_f32 v136, v136, v232
v_sub_f32 v138, v138, v232
v_cvt_u32_f32 v128, v128
v_cvt_u32_f32 v130, v130
v_cvt_u32_f32 v132, v132
v_cvt_u32_f32 v134, v134
v_cvt_u32_f32 v136, v136
v_cvt_u32_f32 v138, v138
v_lshlrev_b32 v234, 23, v128
v_lshlrev_b32 v235, 23, v130
v_lshlrev_b32 v236, 23, v132
v_lshlrev_b32 v237, 23, v134
v_lshlrev_b32 v238, 23, v136
v_lshlrev_b32 v239, 23, v138
v_mul_f32 v232, v234, v129
v_fmac_f32 v232, v235, v131
v_fmac_f32 v232, v236, v133
v_fmac_f32 v232, v237, v135
v_fmac_f32 v232, v238, v137
v_fmac_f32 v232, v239, v139
v_rcp_f32 v150, v232
v_mul_u32_u24 v144, 0x800080, v128
v_mul_u32_u24 v145, 0x800080, v130
v_mul_u32_u24 v146, 0x800080, v132
v_mul_u32_u24 v147, 0x800080, v134
v_mul_u32_u24 v148, 0x800080, v136
v_mul_u32_u24 v149, 0x800080, v138
ds_write_b128 v242, v[144:147]
ds_write_b96 v242, v[148:150] offset:16
ds_read_b128 v[144:147], v250 offset:0
ds_read_b128 v[148:151], v250 offset:16
ds_read_b128 v[128:131], v250 offset:512
ds_read_b128 v[132:135], v250 offset:528
ds_read_b128 v[136:139], v250 offset:1024
ds_read_b128 v[140:143], v250 offset:1040
s_waitcnt lgkmcnt(4)
v_and_b32 v0, v144, v156
v_and_b32 v1, v144, v157
v_and_b32 v2, v145, v156
v_and_b32 v3, v145, v157
v_and_b32 v4, v146, v156
v_and_b32 v5, v146, v157
v_and_b32 v6, v147, v156
v_and_b32 v7, v147, v157
v_and_b32 v8, v148, v156
v_and_b32 v9, v148, v157
v_and_b32 v10, v149, v156
v_and_b32 v11, v149, v157
v_mov_b32 v40, v150
s_waitcnt lgkmcnt(2)
v_and_b32 v12, v128, v156
v_and_b32 v13, v128, v157
v_and_b32 v14, v129, v156
v_and_b32 v15, v129, v157
v_and_b32 v16, v130, v156
v_and_b32 v17, v130, v157
v_and_b32 v18, v131, v156
v_and_b32 v19, v131, v157
v_and_b32 v20, v132, v156
v_and_b32 v21, v132, v157
v_and_b32 v22, v133, v156
v_and_b32 v23, v133, v157
v_mov_b32 v41, v134
s_waitcnt lgkmcnt(0)
v_and_b32 v24, v136, v156
v_and_b32 v25, v136, v157
v_and_b32 v26, v137, v156
v_and_b32 v27, v137, v157
v_and_b32 v28, v138, v156
v_and_b32 v29, v138, v157
v_and_b32 v30, v139, v156
v_and_b32 v31, v139, v157
v_and_b32 v32, v140, v156
v_and_b32 v33, v140, v157
v_and_b32 v34, v141, v156
v_and_b32 v35, v141, v157
v_mov_b32 v42, v142
s_waitcnt vmcnt(9)
v_swap_b32 v50, v52
v_swap_b32 v51, v53
s_nop 1
v_mfma_f32_16x16x32_bf16 v[136:139], v[48:51], v[0:3], 0
s_add_u32 s49, s6, s42
buffer_load_dwordx4 v[80:83], v43, s[16:19], s49 offen sc1
v_mfma_f32_16x16x32_bf16 v[140:143], v[52:55], v[0:3], 0
s_add_u32 s3, s6, s43
buffer_load_dwordx4 v[84:87], v43, s[16:19], s3 offen sc1
buffer_load_dwordx4 a[152:155], v241, s[16:19], s38 offen offset:2048 sc1
s_waitcnt vmcnt(11)
buffer_load_dwordx4 a[156:159], v241, s[16:19], s38 offen offset:3072 sc1
s_waitcnt vmcnt(11)
s_waitcnt vmcnt(9)
v_swap_b32 v58, v60
v_swap_b32 v59, v61
s_nop 1
v_mfma_f32_16x16x32_bf16 v[136:139], v[56:59], v[4:7], v[136:139]
s_add_u32 s49, s6, s44
buffer_load_dwordx4 v[88:91], v43, s[16:19], s49 offen sc1
v_mfma_f32_16x16x32_bf16 v[140:143], v[60:63], v[4:7], v[140:143]
s_add_u32 s3, s6, s45
buffer_load_dwordx4 v[92:95], v43, s[16:19], s3 offen sc1
buffer_load_dwordx4 a[160:163], v240, s[16:19], s39 offen offset:0 sc1
s_waitcnt vmcnt(11)
buffer_load_dwordx4 a[164:167], v240, s[16:19], s39 offen offset:1024 sc1
s_waitcnt vmcnt(11)
s_add_u32 s49, s6, s46
buffer_load_dwordx4 v[96:99], v43, s[16:19], s49 offen sc1
ds_read_b128 v[100:103], v76 offset:4096
s_waitcnt vmcnt(11)
v_swap_b32 v66, v68
v_swap_b32 v67, v69
s_nop 1
v_mfma_f32_16x16x32_bf16 v[136:139], v[64:67], v[8:11], v[136:139]
buffer_load_dwordx4 a[168:171], v241, s[16:19], s39 offen offset:0 sc1
v_mfma_f32_16x16x32_bf16 v[140:143], v[68:71], v[8:11], v[140:143]
s_waitcnt vmcnt(11)
buffer_load_dwordx4 a[172:175], v241, s[16:19], s39 offen offset:1024 sc1
s_nop 3
v_mul_f32 v136, v136, v40
v_mul_f32 v137, v137, v40
v_mul_f32 v138, v138, v40
v_mul_f32 v139, v139, v40
v_mul_f32 v140, v140, v40
v_mul_f32 v141, v141, v40
v_mul_f32 v142, v142, v40
v_mul_f32 v143, v143, v40
v_cvt_pk_bf16_f32 v136, v136, v137
v_cvt_pk_bf16_f32 v137, v138, v139
v_cvt_pk_bf16_f32 v138, v140, v141
v_cvt_pk_bf16_f32 v139, v142, v143
ds_write_b128 v251, v[136:139] offset:0
s_waitcnt vmcnt(11)
s_waitcnt vmcnt(9)
v_swap_b32 v82, v84
v_swap_b32 v83, v85
s_nop 1
v_mfma_f32_16x16x32_bf16 v[128:131], v[80:83], v[0:3], 0
s_add_u32 s49, s7, s42
buffer_load_dwordx4 v[112:115], v47, s[16:19], s49 offen sc1
v_mfma_f32_16x16x32_bf16 v[132:135], v[84:87], v[0:3], 0
s_add_u32 s3, s7, s43
buffer_load_dwordx4 v[116:119], v47, s[16:19], s3 offen sc1
buffer_load_dwordx4 a[176:179], v240, s[16:19], s39 offen offset:2048 sc1
s_waitcnt vmcnt(11)
buffer_load_dwordx4 a[180:183], v240, s[16:19], s39 offen offset:3072 sc1
s_waitcnt vmcnt(11)
s_waitcnt vmcnt(9)
v_swap_b32 v90, v92
v_swap_b32 v91, v93
s_nop 1
v_mfma_f32_16x16x32_bf16 v[128:131], v[88:91], v[4:7], v[128:131]
s_add_u32 s49, s7, s44
buffer_load_dwordx4 v[120:123], v47, s[16:19], s49 offen sc1
v_mfma_f32_16x16x32_bf16 v[132:135], v[92:95], v[4:7], v[132:135]
s_add_u32 s3, s7, s45
buffer_load_dwordx4 v[124:127], v47, s[16:19], s3 offen sc1
buffer_load_dwordx4 a[184:187], v241, s[16:19], s39 offen offset:2048 sc1
s_waitcnt vmcnt(11)
buffer_load_dwordx4 a[188:191], v241, s[16:19], s39 offen offset:3072 sc1
s_waitcnt vmcnt(11)
s_add_u32 s49, s7, s46
buffer_load_dwordx4 v[48:51], v47, s[16:19], s49 offen sc1
ds_read_b128 v[52:55], v77 offset:0
s_waitcnt vmcnt(11)
s_waitcnt lgkmcnt(2)
v_swap_b32 v98, v100
v_swap_b32 v99, v101
s_nop 1
v_mfma_f32_16x16x32_bf16 v[128:131], v[96:99], v[8:11], v[128:131]
buffer_load_dwordx4 a[192:195], v240, s[16:19], s40 offen offset:0 sc1
v_mfma_f32_16x16x32_bf16 v[132:135], v[100:103], v[8:11], v[132:135]
s_waitcnt vmcnt(11)
buffer_load_dwordx4 a[196:199], v240, s[16:19], s40 offen offset:1024 sc1
s_nop 3
v_mul_f32 v128, v128, v40
v_mul_f32 v129, v129, v40
v_mul_f32 v130, v130, v40
v_mul_f32 v131, v131, v40
v_mul_f32 v132, v132, v40
v_mul_f32 v133, v133, v40
v_mul_f32 v134, v134, v40
v_mul_f32 v135, v135, v40
v_cvt_pk_bf16_f32 v128, v128, v129
v_cvt_pk_bf16_f32 v129, v130, v131
v_cvt_pk_bf16_f32 v130, v132, v133
v_cvt_pk_bf16_f32 v131, v134, v135
ds_write_b128 v251, v[128:131] offset:4096
s_waitcnt vmcnt(11)
s_waitcnt lgkmcnt(0)
s_barrier
ds_read_b128 v[208:211], v252 offset:0
ds_read_b128 v[212:215], v252 offset:1024
ds_read_b128 v[216:219], v252 offset:2048
ds_read_b128 v[220:223], v252 offset:3072
ds_read_b128 v[224:227], v252 offset:4096
s_waitcnt vmcnt(9)
s_waitcnt lgkmcnt(4)
v_mfma_f32_16x16x32_bf16 v[160:163], a[128:131], v[208:211], v[160:163]
ds_read_b128 v[228:231], v252 offset:5120
v_swap_b32 v114, v116
v_mfma_f32_16x16x32_bf16 v[164:167], a[132:135], v[208:211], v[164:167]
v_swap_b32 v115, v117
s_nop 1
v_mfma_f32_16x16x32_bf16 v[136:139], v[112:115], v[12:15], 0
s_add_u32 s49, s7, s42
buffer_load_dwordx4 v[56:59], v43, s[16:19], s49 offen sc1
v_mfma_f32_16x16x32_bf16 v[140:143], v[116:119], v[12:15], 0
s_add_u32 s3, s7, s43
buffer_load_dwordx4 v[60:63], v43, s[16:19], s3 offen sc1
v_mfma_f32_16x16x32_bf16 v[168:171], a[136:139], v[208:211], v[168:171]
buffer_load_dwordx4 a[200:203], v241, s[16:19], s40 offen offset:0 sc1
v_mfma_f32_16x16x32_bf16 v[172:175], a[140:143], v[208:211], v[172:175]
s_waitcnt lgkmcnt(4)
v_mfma_f32_16x16x32_bf16 v[160:163], a[144:147], v[212:215], v[160:163]
v_mfma_f32_16x16x32_bf16 v[164:167], a[148:151], v[212:215], v[164:167]
v_mfma_f32_16x16x32_bf16 v[168:171], a[152:155], v[212:215], v[168:171]
v_mfma_f32_16x16x32_bf16 v[172:175], a[156:159], v[212:215], v[172:175]
s_waitcnt vmcnt(11)
s_waitcnt lgkmcnt(3)
v_mfma_f32_16x16x32_bf16 v[160:163], a[160:163], v[216:219], v[160:163]
buffer_load_dwordx4 a[204:207], v241, s[16:19], s40 offen offset:1024 sc1
v_mfma_f32_16x16x32_bf16 v[164:167], a[164:167], v[216:219], v[164:167]
v_mfma_f32_16x16x32_bf16 v[168:171], a[168:171], v[216:219], v[168:171]
v_mfma_f32_16x16x32_bf16 v[172:175], a[172:175], v[216:219], v[172:175]
s_waitcnt vmcnt(11)
s_waitcnt vmcnt(9)
v_swap_b32 v122, v124
v_swap_b32 v123, v125
s_nop 1
v_mfma_f32_16x16x32_bf16 v[136:139], v[120:123], v[16:19], v[136:139]
s_add_u32 s49, s7, s44
buffer_load_dwordx4 v[64:67], v43, s[16:19], s49 offen sc1
v_mfma_f32_16x16x32_bf16 v[140:143], v[124:127], v[16:19], v[140:143]
s_add_u32 s3, s7, s45
buffer_load_dwordx4 v[68:71], v43, s[16:19], s3 offen sc1
buffer_load_dwordx4 a[208:211], v240, s[16:19], s40 offen offset:2048 sc1
s_waitcnt vmcnt(11)
buffer_load_dwordx4 a[212:215], v240, s[16:19], s40 offen offset:3072 sc1
s_waitcnt vmcnt(11)
s_waitcnt lgkmcnt(2)
v_mfma_f32_16x16x32_bf16 v[160:163], a[176:179], v[220:223], v[160:163]
s_add_u32 s49, s7, s46
buffer_load_dwordx4 v[80:83], v43, s[16:19], s49 offen sc1
v_mfma_f32_16x16x32_bf16 v[164:167], a[180:183], v[220:223], v[164:167]
ds_read_b128 v[84:87], v77 offset:4096
v_mfma_f32_16x16x32_bf16 v[168:171], a[184:187], v[220:223], v[168:171]
v_mfma_f32_16x16x32_bf16 v[172:175], a[188:191], v[220:223], v[172:175]
s_waitcnt vmcnt(11)
v_swap_b32 v50, v52
v_swap_b32 v51, v53
s_nop 1
v_mfma_f32_16x16x32_bf16 v[136:139], v[48:51], v[20:23], v[136:139]
buffer_load_dwordx4 a[216:219], v241, s[16:19], s40 offen offset:2048 sc1
v_mfma_f32_16x16x32_bf16 v[140:143], v[52:55], v[20:23], v[140:143]
s_waitcnt vmcnt(11)
buffer_load_dwordx4 a[220:223], v241, s[16:19], s40 offen offset:3072 sc1
s_nop 3
v_mul_f32 v136, v136, v41
v_mul_f32 v137, v137, v41
v_mul_f32 v138, v138, v41
v_mul_f32 v139, v139, v41
v_mul_f32 v140, v140, v41
v_mul_f32 v141, v141, v41
v_mul_f32 v142, v142, v41
v_mul_f32 v143, v143, v41
v_cvt_pk_bf16_f32 v136, v136, v137
v_cvt_pk_bf16_f32 v137, v138, v139
v_cvt_pk_bf16_f32 v138, v140, v141
v_cvt_pk_bf16_f32 v139, v142, v143
ds_write_b128 v251, v[136:139] offset:8192
s_waitcnt vmcnt(11)
s_waitcnt vmcnt(9)
v_swap_b32 v58, v60
v_swap_b32 v59, v61
s_nop 1
v_mfma_f32_16x16x32_bf16 v[128:131], v[56:59], v[12:15], 0
s_add_u32 s49, s29, s42
buffer_load_dwordx4 v[88:91], v47, s[16:19], s49 offen sc1
v_mfma_f32_16x16x32_bf16 v[132:135], v[60:63], v[12:15], 0
s_add_u32 s3, s29, s43
buffer_load_dwordx4 v[92:95], v47, s[16:19], s3 offen sc1
buffer_load_dwordx4 a[224:227], v240, s[16:19], s41 offen offset:0 sc1
s_waitcnt vmcnt(11)
buffer_load_dwordx4 a[228:231], v240, s[16:19], s41 offen offset:1024 sc1
s_waitcnt vmcnt(11)
s_waitcnt lgkmcnt(3)
v_mfma_f32_16x16x32_bf16 v[160:163], a[192:195], v[224:227], v[160:163]
buffer_load_dwordx4 a[232:235], v241, s[16:19], s41 offen offset:0 sc1
v_mfma_f32_16x16x32_bf16 v[164:167], a[196:199], v[224:227], v[164:167]
v_mfma_f32_16x16x32_bf16 v[168:171], a[200:203], v[224:227], v[168:171]
v_mfma_f32_16x16x32_bf16 v[172:175], a[204:207], v[224:227], v[172:175]
s_waitcnt vmcnt(10)
v_swap_b32 v66, v68
v_swap_b32 v67, v69
s_nop 1
v_mfma_f32_16x16x32_bf16 v[128:131], v[64:67], v[16:19], v[128:131]
buffer_load_dwordx4 a[236:239], v241, s[16:19], s41 offen offset:1024 sc1
v_mfma_f32_16x16x32_bf16 v[132:135], v[68:71], v[16:19], v[132:135]
s_waitcnt vmcnt(10)
s_add_u32 s49, s29, s44
buffer_load_dwordx4 v[96:99], v47, s[16:19], s49 offen sc1
s_add_u32 s3, s29, s45
buffer_load_dwordx4 v[100:103], v47, s[16:19], s3 offen sc1
s_waitcnt vmcnt(11)
buffer_load_dwordx4 a[240:243], v240, s[16:19], s41 offen offset:2048 sc1
s_waitcnt vmcnt(11)
s_waitcnt lgkmcnt(1)
v_swap_b32 v82, v84
v_swap_b32 v83, v85
s_nop 1
v_mfma_f32_16x16x32_bf16 v[128:131], v[80:83], v[20:23], v[128:131]
buffer_load_dwordx4 a[244:247], v240, s[16:19], s41 offen offset:3072 sc1
v_mfma_f32_16x16x32_bf16 v[132:135], v[84:87], v[20:23], v[132:135]
s_waitcnt vmcnt(11)
buffer_load_dwordx4 a[248:251], v241, s[16:19], s41 offen offset:2048 sc1
s_nop 3
v_mul_f32 v128, v128, v41
v_mul_f32 v129, v129, v41
v_mul_f32 v130, v130, v41
v_mul_f32 v131, v131, v41
v_mul_f32 v132, v132, v41
v_mul_f32 v133, v133, v41
v_mul_f32 v134, v134, v41
v_mul_f32 v135, v135, v41
v_cvt_pk_bf16_f32 v128, v128, v129
v_cvt_pk_bf16_f32 v129, v130, v131
v_cvt_pk_bf16_f32 v130, v132, v133
v_cvt_pk_bf16_f32 v131, v134, v135
ds_write_b128 v251, v[128:131] offset:12288
s_waitcnt vmcnt(11)
v_mfma_f32_16x16x32_bf16 v[160:163], a[208:211], v[228:231], v[160:163]
buffer_load_dwordx4 a[252:255], v241, s[16:19], s41 offen offset:3072 sc1
v_mfma_f32_16x16x32_bf16 v[164:167], a[212:215], v[228:231], v[164:167]
v_mfma_f32_16x16x32_bf16 v[168:171], a[216:219], v[228:231], v[168:171]
v_mfma_f32_16x16x32_bf16 v[172:175], a[220:223], v[228:231], v[172:175]
s_waitcnt lgkmcnt(0)
s_barrier
ds_read_b128 v[208:211], v252 offset:8192
ds_read_b128 v[212:215], v252 offset:9216
ds_read_b128 v[216:219], v252 offset:10240
ds_read_b128 v[220:223], v252 offset:11264
ds_read_b128 v[224:227], v252 offset:12288
s_waitcnt vmcnt(10)
s_waitcnt lgkmcnt(4)
v_mfma_f32_16x16x32_bf16 v[176:179], a[128:131], v[208:211], v[176:179]
ds_read_b128 v[228:231], v252 offset:6144
v_swap_b32 v90, v92
v_mfma_f32_16x16x32_bf16 v[180:183], a[132:135], v[208:211], v[180:183]
v_swap_b32 v91, v93
s_nop 1
v_mfma_f32_16x16x32_bf16 v[136:139], v[88:91], v[24:27], 0
s_add_u32 s49, s29, s46
buffer_load_dwordx4 v[112:115], v47, s[16:19], s49 offen sc1
v_mfma_f32_16x16x32_bf16 v[140:143], v[92:95], v[24:27], 0
s_add_u32 s3, s29, s47
s_cmp_lt_u32 s37, 4
s_cbranch_scc1 LF_o0
buffer_load_dwordx4 v[116:119], v47, s[16:19], s3 offen sc1
ds_read_b128 v[36:39], v78 offset:0
s_branch LF_j0
LF_o0:
s_mov_b32 s3, 0x70000000
buffer_load_dwordx4 v[36:39], v47, s[16:19], s3 offen sc1
ds_read_b128 v[116:119], v78 offset:0
LF_j0:
v_mfma_f32_16x16x32_bf16 v[184:187], a[136:139], v[208:211], v[184:187]
v_mfma_f32_16x16x32_bf16 v[188:191], a[140:143], v[208:211], v[188:191]
s_waitcnt lgkmcnt(5)
v_mfma_f32_16x16x32_bf16 v[176:179], a[144:147], v[212:215], v[176:179]
ds_read_b128 v[208:211], v252 offset:13312
v_mfma_f32_16x16x32_bf16 v[180:183], a[148:151], v[212:215], v[180:183]
v_mfma_f32_16x16x32_bf16 v[184:187], a[152:155], v[212:215], v[184:187]
v_mfma_f32_16x16x32_bf16 v[188:191], a[156:159], v[212:215], v[188:191]
s_waitcnt vmcnt(11)
s_waitcnt lgkmcnt(5)
v_mfma_f32_16x16x32_bf16 v[176:179], a[160:163], v[216:219], v[176:179]
ds_read_b128 v[212:215], v252 offset:14336
v_mfma_f32_16x16x32_bf16 v[180:183], a[164:167], v[216:219], v[180:183]
v_mfma_f32_16x16x32_bf16 v[184:187], a[168:171], v[216:219], v[184:187]
v_mfma_f32_16x16x32_bf16 v[188:191], a[172:175], v[216:219], v[188:191]
s_waitcnt vmcnt(10)
s_waitcnt lgkmcnt(5)
v_mfma_f32_16x16x32_bf16 v[176:179], a[176:179], v[220:223], v[176:179]
ds_read_b128 v[216:219], v252 offset:7168
s_add_u32 s49, s29, s42
buffer_load_dwordx4 v[120:123], v43, s[16:19], s49 offen sc1
v_mfma_f32_16x16x32_bf16 v[180:183], a[180:183], v[220:223], v[180:183]
s_add_u32 s3, s29, s43
buffer_load_dwordx4 v[124:127], v43, s[16:19], s3 offen sc1
v_mfma_f32_16x16x32_bf16 v[184:187], a[184:187], v[220:223], v[184:187]
v_mfma_f32_16x16x32_bf16 v[188:191], a[188:191], v[220:223], v[188:191]
s_waitcnt vmcnt(11)
s_waitcnt lgkmcnt(5)
v_mfma_f32_16x16x32_bf16 v[176:179], a[192:195], v[224:227], v[176:179]
ds_read_b128 v[220:223], v252 offset:15360
v_mfma_f32_16x16x32_bf16 v[180:183], a[196:199], v[224:227], v[180:183]
v_mfma_f32_16x16x32_bf16 v[184:187], a[200:203], v[224:227], v[184:187]
v_mfma_f32_16x16x32_bf16 v[188:191], a[204:207], v[224:227], v[188:191]
s_waitcnt vmcnt(10)
s_waitcnt lgkmcnt(5)
v_mfma_f32_16x16x32_bf16 v[160:163], a[224:227], v[228:231], v[160:163]
s_add_u32 s49, s29, s44
buffer_load_dwordx4 v[48:51], v43, s[16:19], s49 offen sc1
v_mfma_f32_16x16x32_bf16 v[164:167], a[228:231], v[228:231], v[164:167]
s_add_u32 s3, s29, s45
buffer_load_dwordx4 v[52:55], v43, s[16:19], s3 offen sc1
v_mfma_f32_16x16x32_bf16 v[168:171], a[232:235], v[228:231], v[168:171]
v_mfma_f32_16x16x32_bf16 v[172:175], a[236:239], v[228:231], v[172:175]
s_waitcnt vmcnt(10)
s_waitcnt lgkmcnt(3)
v_mfma_f32_16x16x32_bf16 v[176:179], a[208:211], v[208:211], v[176:179]
v_swap_b32 v98, v100
v_mfma_f32_16x16x32_bf16 v[180:183], a[212:215], v[208:211], v[180:183]
v_swap_b32 v99, v101
s_nop 1
v_mfma_f32_16x16x32_bf16 v[136:139], v[96:99], v[28:31], v[136:139]
s_add_u32 s49, s29, s46
buffer_load_dwordx4 v[56:59], v43, s[16:19], s49 offen sc1
v_mfma_f32_16x16x32_bf16 v[140:143], v[100:103], v[28:31], v[140:143]
s_add_u32 s3, s29, s47
s_cmp_lt_u32 s37, 4
s_cbranch_scc1 LF_o1
buffer_load_dwordx4 v[60:63], v43, s[16:19], s3 offen sc1
ds_read_b128 v[36:39], v78 offset:4096
s_branch LF_j1
LF_o1:
s_mov_b32 s3, 0x70000000
buffer_load_dwordx4 v[36:39], v43, s[16:19], s3 offen sc1
ds_read_b128 v[60:63], v78 offset:4096
LF_j1:
v_mfma_f32_16x16x32_bf16 v[184:187], a[216:219], v[208:211], v[184:187]
v_mfma_f32_16x16x32_bf16 v[188:191], a[220:223], v[208:211], v[188:191]
s_waitcnt lgkmcnt(3)
v_mfma_f32_16x16x32_bf16 v[176:179], a[224:227], v[212:215], v[176:179]
v_mfma_f32_16x16x32_bf16 v[180:183], a[228:231], v[212:215], v[180:183]
v_mfma_f32_16x16x32_bf16 v[184:187], a[232:235], v[212:215], v[184:187]
v_mfma_f32_16x16x32_bf16 v[188:191], a[236:239], v[212:215], v[188:191]
s_waitcnt vmcnt(11)
s_waitcnt vmcnt(10)
s_waitcnt vmcnt(9)
s_waitcnt vmcnt(8)
s_waitcnt lgkmcnt(2)
v_mfma_f32_16x16x32_bf16 v[160:163], a[240:243], v[216:219], v[160:163]
v_mfma_f32_16x16x32_bf16 v[164:167], a[244:247], v[216:219], v[164:167]
v_mfma_f32_16x16x32_bf16 v[168:171], a[248:251], v[216:219], v[168:171]
v_mfma_f32_16x16x32_bf16 v[172:175], a[252:255], v[216:219], v[172:175]
s_waitcnt vmcnt(6)
s_waitcnt lgkmcnt(1)
v_mfma_f32_16x16x32_bf16 v[176:179], a[240:243], v[220:223], v[176:179]
v_swap_b32 v114, v116
v_mfma_f32_16x16x32_bf16 v[180:183], a[244:247], v[220:223], v[180:183]
v_swap_b32 v115, v117
s_nop 1
v_mfma_f32_16x16x32_bf16 v[136:139], v[112:115], v[32:35], v[136:139]
v_cvt_pk_bf16_f32 v160, v160, v161
v_cvt_pk_bf16_f32 v161, v162, v163
v_mfma_f32_16x16x32_bf16 v[140:143], v[116:119], v[32:35], v[140:143]
v_cvt_pk_bf16_f32 v162, v164, v165
v_cvt_pk_bf16_f32 v163, v166, v167
v_mfma_f32_16x16x32_bf16 v[184:187], a[248:251], v[220:223], v[184:187]
ds_write_b128 v245, v[160:163] offset:0
v_cvt_pk_bf16_f32 v168, v168, v169
v_mfma_f32_16x16x32_bf16 v[188:191], a[252:255], v[220:223], v[188:191]
v_cvt_pk_bf16_f32 v169, v170, v171
v_cvt_pk_bf16_f32 v170, v172, v173
v_cvt_pk_bf16_f32 v171, v174, v175
ds_write_b128 v246, v[168:171] offset:0
ds_read_b128 v[164:167], v247 offset:0
ds_read_b128 v[172:175], v247 offset:1024
v_mul_f32 v136, v136, v42
v_mul_f32 v137, v137, v42
v_mul_f32 v138, v138, v42
v_mul_f32 v139, v139, v42
v_mul_f32 v140, v140, v42
v_mul_f32 v141, v141, v42
v_mul_f32 v142, v142, v42
v_mul_f32 v143, v143, v42
v_cvt_pk_bf16_f32 v136, v136, v137
v_cvt_pk_bf16_f32 v137, v138, v139
v_cvt_pk_bf16_f32 v138, v140, v141
v_cvt_pk_bf16_f32 v139, v142, v143
ds_write_b128 v251, v[136:139] offset:16384
s_waitcnt lgkmcnt(0)
s_barrier
ds_read_b128 v[224:227], v252 offset:16384
ds_read_b128 v[228:231], v252 offset:17408
ds_read_b128 v[208:211], v252 offset:18432
ds_read_b128 v[212:215], v252 offset:19456
s_waitcnt vmcnt(4)
s_waitcnt lgkmcnt(3)
v_mfma_f32_16x16x32_bf16 v[192:195], a[128:131], v[224:227], v[192:195]
v_swap_b32 v122, v124
v_mfma_f32_16x16x32_bf16 v[196:199], a[132:135], v[224:227], v[196:199]
v_swap_b32 v123, v125
s_nop 1
v_mfma_f32_16x16x32_bf16 v[128:131], v[120:123], v[24:27], 0
buffer_store_dwordx4 v[164:167], v44, s[56:59], s6 offen sc1
v_mfma_f32_16x16x32_bf16 v[132:135], v[124:127], v[24:27], 0
buffer_store_dwordx4 v[172:175], v45, s[56:59], s6 offen sc1
v_mfma_f32_16x16x32_bf16 v[200:203], a[136:139], v[224:227], v[200:203]
v_cvt_pk_bf16_f32 v176, v176, v177
v_cvt_pk_bf16_f32 v177, v178, v179
v_mfma_f32_16x16x32_bf16 v[204:207], a[140:143], v[224:227], v[204:207]
v_cvt_pk_bf16_f32 v178, v180, v181
v_cvt_pk_bf16_f32 v179, v182, v183
s_waitcnt lgkmcnt(2)
v_mfma_f32_16x16x32_bf16 v[192:195], a[144:147], v[228:231], v[192:195]
ds_write_b128 v245, v[176:179] offset:2048
v_cvt_pk_bf16_f32 v184, v184, v185
v_mfma_f32_16x16x32_bf16 v[196:199], a[148:151], v[228:231], v[196:199]
v_cvt_pk_bf16_f32 v185, v186, v187
v_cvt_pk_bf16_f32 v186, v188, v189
v_mfma_f32_16x16x32_bf16 v[200:203], a[152:155], v[228:231], v[200:203]
v_cvt_pk_bf16_f32 v187, v190, v191
ds_write_b128 v246, v[184:187] offset:2048
v_mfma_f32_16x16x32_bf16 v[204:207], a[156:159], v[228:231], v[204:207]
ds_read_b128 v[180:183], v247 offset:2048
ds_read_b128 v[188:191], v247 offset:3072
s_waitcnt vmcnt(4)
s_waitcnt lgkmcnt(5)
v_mfma_f32_16x16x32_bf16 v[192:195], a[160:163], v[208:211], v[192:195]
v_swap_b32 v50, v52
v_mfma_f32_16x16x32_bf16 v[196:199], a[164:167], v[208:211], v[196:199]
v_swap_b32 v51, v53
s_nop 1
v_mfma_f32_16x16x32_bf16 v[128:131], v[48:51], v[28:31], v[128:131]
s_waitcnt lgkmcnt(1)
buffer_store_dwordx4 v[180:183], v44, s[56:59], s7 offen sc1
v_mfma_f32_16x16x32_bf16 v[132:135], v[52:55], v[28:31], v[132:135]
s_waitcnt lgkmcnt(0)
buffer_store_dwordx4 v[188:191], v45, s[56:59], s7 offen sc1
v_mfma_f32_16x16x32_bf16 v[200:203], a[168:171], v[208:211], v[200:203]
v_mfma_f32_16x16x32_bf16 v[204:207], a[172:175], v[208:211], v[204:207]
v_mfma_f32_16x16x32_bf16 v[192:195], a[176:179], v[212:215], v[192:195]
v_mfma_f32_16x16x32_bf16 v[196:199], a[180:183], v[212:215], v[196:199]
v_mfma_f32_16x16x32_bf16 v[200:203], a[184:187], v[212:215], v[200:203]
v_mfma_f32_16x16x32_bf16 v[204:207], a[188:191], v[212:215], v[204:207]
s_waitcnt vmcnt(4)
v_swap_b32 v58, v60
v_swap_b32 v59, v61
s_nop 1
v_mfma_f32_16x16x32_bf16 v[128:131], v[56:59], v[32:35], v[128:131]
v_mfma_f32_16x16x32_bf16 v[132:135], v[60:63], v[32:35], v[132:135]
s_nop 6
v_mul_f32 v128, v128, v42
v_mul_f32 v129, v129, v42
v_mul_f32 v130, v130, v42
v_mul_f32 v131, v131, v42
v_mul_f32 v132, v132, v42
v_mul_f32 v133, v133, v42
v_mul_f32 v134, v134, v42
v_mul_f32 v135, v135, v42
v_cvt_pk_bf16_f32 v128, v128, v129
v_cvt_pk_bf16_f32 v129, v130, v131
v_cvt_pk_bf16_f32 v130, v132, v133
v_cvt_pk_bf16_f32 v131, v134, v135
ds_write_b128 v251, v[128:131] offset:20480
s_waitcnt lgkmcnt(0)
s_barrier
ds_read_b128 v[216:219], v252 offset:20480
ds_read_b128 v[220:223], v252 offset:21504
ds_read_b128 v[224:227], v252 offset:22528
ds_read_b128 v[228:231], v252 offset:23552
s_waitcnt lgkmcnt(3)
v_mfma_f32_16x16x32_bf16 v[192:195], a[192:195], v[216:219], v[192:195]
v_mfma_f32_16x16x32_bf16 v[196:199], a[196:199], v[216:219], v[196:199]
v_mfma_f32_16x16x32_bf16 v[200:203], a[200:203], v[216:219], v[200:203]
v_mfma_f32_16x16x32_bf16 v[204:207], a[204:207], v[216:219], v[204:207]
s_waitcnt lgkmcnt(2)
v_mfma_f32_16x16x32_bf16 v[192:195], a[208:211], v[220:223], v[192:195]
v_mfma_f32_16x16x32_bf16 v[196:199], a[212:215], v[220:223], v[196:199]
v_mfma_f32_16x16x32_bf16 v[200:203], a[216:219], v[220:223], v[200:203]
v_mfma_f32_16x16x32_bf16 v[204:207], a[220:223], v[220:223], v[204:207]
s_waitcnt lgkmcnt(1)
v_mfma_f32_16x16x32_bf16 v[192:195], a[224:227], v[224:227], v[192:195]
v_mfma_f32_16x16x32_bf16 v[196:199], a[228:231], v[224:227], v[196:199]
v_mfma_f32_16x16x32_bf16 v[200:203], a[232:235], v[224:227], v[200:203]
v_mfma_f32_16x16x32_bf16 v[204:207], a[236:239], v[224:227], v[204:207]
s_waitcnt lgkmcnt(0)
v_mfma_f32_16x16x32_bf16 v[192:195], a[240:243], v[228:231], v[192:195]
v_mfma_f32_16x16x32_bf16 v[196:199], a[244:247], v[228:231], v[196:199]
v_mfma_f32_16x16x32_bf16 v[200:203], a[248:251], v[228:231], v[200:203]
v_mfma_f32_16x16x32_bf16 v[204:207], a[252:255], v[228:231], v[204:207]
s_nop 4
v_cvt_pk_bf16_f32 v192, v192, v193
v_cvt_pk_bf16_f32 v193, v194, v195
v_cvt_pk_bf16_f32 v194, v196, v197
v_cvt_pk_bf16_f32 v195, v198, v199
ds_write_b128 v245, v[192:195] offset:4096
v_cvt_pk_bf16_f32 v200, v200, v201
v_cvt_pk_bf16_f32 v201, v202, v203
v_cvt_pk_bf16_f32 v202, v204, v205
v_cvt_pk_bf16_f32 v203, v206, v207
ds_write_b128 v246, v[200:203] offset:4096
ds_read_b128 v[196:199], v247 offset:4096
ds_read_b128 v[204:207], v247 offset:5120
s_waitcnt lgkmcnt(1)
buffer_store_dwordx4 v[196:199], v44, s[56:59], s29 offen sc1
s_waitcnt lgkmcnt(0)
buffer_store_dwordx4 v[204:207], v45, s[56:59], s29 offen sc1
s_branch L2_fin
LF_spinQ:
s_mov_b32 s94, 0x10000
LF_spin2Q:
buffer_load_dwordx2 v[248:249], v46, s[16:19], 0 offen offset:0 sc1
s_sub_u32 s94, s94, 1
s_waitcnt vmcnt(0)
s_cbranch_scc1 LF_spin2Q_go
v_cmp_ne_u64 vcc, s[98:99], v[248:249]
s_nop 1
s_cbranch_vccnz LF_spin2Q
LF_spin2Q_go:
s_branch LF_goQ
LF_wf:
s_mov_b32 s94, 0x10000
LF_wf2:
buffer_load_dwordx2 v[108:109], v110, s[16:19], 0 offen sc1
s_sub_u32 s94, s94, 1
s_waitcnt vmcnt(0)
s_cbranch_scc1 LF_wf2_go
v_cmp_ne_u64 vcc, s[98:99], v[108:109]
s_nop 1
s_cbranch_vccnz LF_wf2
LF_wf2_go:
s_branch LF_wf_go
LM_pb:
s_mov_b32 s3, 0x10000
LM_pb2:
buffer_load_dwordx2 v[228:229], v230, s[16:19], 0 offen sc1
s_sub_u32 s3, s3, 1
s_waitcnt vmcnt(0)
s_cbranch_scc1 LM_pb2_go
v_cmp_ne_u64 vcc, s[98:99], v[228:229]
s_nop 1
s_cbranch_vccnz LM_pb2
LM_pb2_go:
s_branch LM_pb_ret
L2_Fend:
LT_disp:
s_cmp_ge_i32 s36, 0
s_cbranch_scc1 LT_start
s_cmp_eq_u32 s34, 0
s_cbranch_scc1 L2_end
s_mov_b32 s41, s34
s_mul_i32 s40, s34, 6
s_add_u32 s40, s40, s37
s_add_u32 s40, s40, 42
s_cmp_lt_u32 s40, 64
s_cbranch_scc1 LE_common
s_branch L2_end
LT_start:
s_waitcnt lgkmcnt(0)
s_add_u32 s12, s4, 0x7c2a000
s_addc_u32 s13, s5, 0
s_mov_b32 s14, 0x8000
s_mov_b32 s15, 0x00020000
v_and_b32 v8, 63, v0
v_lshlrev_b32 v8, 7, v8
s_mov_b32 s91, 8192
s_mov_b32 s90, 16384
s_mov_b32 s95, 24576
v_min_u32 v9, 5248, v8
s_mov_b32 s94, 0x10000
LT_poll:
buffer_load_dwordx2 v[0:1], v8, s[12:15], 0 offen sc1
buffer_load_dwordx2 v[2:3], v8, s[12:15], s91 offen sc1
buffer_load_dwordx2 v[4:5], v8, s[12:15], s90 offen sc1
buffer_load_dwordx2 v[6:7], v9, s[12:15], s95 offen sc1
s_sub_u32 s94, s94, 1
s_waitcnt vmcnt(0)
s_cbranch_scc1 LT_poll_go
v_cmp_ne_u64 vcc, s[98:99], v[0:1]
s_nop 1
s_cbranch_vccnz LT_poll
v_cmp_ne_u64 vcc, s[98:99], v[2:3]
s_nop 1
s_cbranch_vccnz LT_poll
v_cmp_ne_u64 vcc, s[98:99], v[4:5]
s_nop 1
s_cbranch_vccnz LT_poll
v_cmp_ne_u64 vcc, s[98:99], v[6:7]
s_nop 1
s_cbranch_vccnz LT_poll
LT_poll_go:
s_add_u32 s31, s31, -22
s_add_u32 s3, s28, 409600
s_cmp_eq_u32 s36, 0
s_cselect_b32 s31, 26, s31
s_cselect_b32 s39, s39, s3
s_cselect_b32 s33, s33, 0
s_cselect_b32 s3, 0, 425984
s_add_u32 s28, s28, s3
s_add_u32 s12, s4, 0x6800000
s_addc_u32 s13, s5, 0
s_mov_b32 s14, 0x0
s_mov_b32 s15, 0x00020000
s_mov_b32 s14, s49
s_add_u32 s8, s4, 0x0
s_addc_u32 s9, s5, 0
s_mov_b32 s10, 0x4e4000
s_mov_b32 s11, 0x00020000
s_mov_b32 s40, 5111808
s_mov_b32 s44, 5115904
buffer_load_dwordx4 v[0:3], v243, s[8:11], s40 offen offset:0 sc1
buffer_load_dwordx4 v[4:7], v243, s[8:11], s40 offen offset:1024 sc1
buffer_load_dwordx4 v[8:11], v243, s[8:11], s40 offen offset:2048 sc1
buffer_load_dwordx4 v[12:15], v243, s[8:11], s40 offen offset:3072 sc1
buffer_load_dwordx4 v[16:19], v243, s[8:11], s44 offen offset:0 sc1
buffer_load_dwordx4 v[20:23], v243, s[8:11], s44 offen offset:1024 sc1
buffer_load_dwordx4 v[24:27], v243, s[8:11], s44 offen offset:2048 sc1
buffer_load_dwordx4 v[28:31], v243, s[8:11], s44 offen offset:3072 sc1
s_mov_b32 s53, 0
s_add_u32 m0, s53, 90112
s_add_u32 s54, s39, 0
buffer_load_dwordx4 v241, s[12:15], s54 offen offset:0 sc1 lds
buffer_load_dwordx4 v241, s[12:15], s54 offen offset:1024 sc1 lds
buffer_load_dwordx4 v241, s[12:15], s54 offen offset:2048 sc1 lds
buffer_load_dwordx4 v241, s[12:15], s54 offen offset:3072 sc1 lds
s_add_u32 m0, s53, 94208
s_add_u32 s54, s39, 128
buffer_load_dwordx4 v241, s[12:15], s54 offen offset:0 sc1 lds
buffer_load_dwordx4 v241, s[12:15], s54 offen offset:1024 sc1 lds
buffer_load_dwordx4 v241, s[12:15], s54 offen offset:2048 sc1 lds
buffer_load_dwordx4 v241, s[12:15], s54 offen offset:3072 sc1 lds
s_add_u32 m0, s53, 98304
s_add_u32 s54, s39, 256
buffer_load_dwordx4 v241, s[12:15], s54 offen offset:0 sc1 lds
buffer_load_dwordx4 v241, s[12:15], s54 offen offset:1024 sc1 lds
buffer_load_dwordx4 v241, s[12:15], s54 offen offset:2048 sc1 lds
buffer_load_dwordx4 v241, s[12:15], s54 offen offset:3072 sc1 lds
s_add_u32 m0, s53, 102400
s_add_u32 s54, s39, 384
buffer_load_dwordx4 v241, s[12:15], s54 offen offset:0 sc1 lds
buffer_load_dwordx4 v241, s[12:15], s54 offen offset:1024 sc1 lds
buffer_load_dwordx4 v241, s[12:15], s54 offen offset:2048 sc1 lds
buffer_load_dwordx4 v241, s[12:15], s54 offen offset:3072 sc1 lds
s_add_u32 s53, s53, 0x4000
s_and_b32 s53, s53, 0xffff
s_add_u32 m0, s53, 90112
s_add_u32 s54, s28, 0
buffer_load_dwordx4 v241, s[12:15], s54 offen offset:0 sc1 lds
buffer_load_dwordx4 v241, s[12:15], s54 offen offset:1024 sc1 lds
buffer_load_dwordx4 v241, s[12:15], s54 offen offset:2048 sc1 lds
buffer_load_dwordx4 v241, s[12:15], s54 offen offset:3072 sc1 lds
s_add_u32 m0, s53, 94208
s_add_u32 s54, s28, 128
buffer_load_dwordx4 v241, s[12:15], s54 offen offset:0 sc1 lds
buffer_load_dwordx4 v241, s[12:15], s54 offen offset:1024 sc1 lds
buffer_load_dwordx4 v241, s[12:15], s54 offen offset:2048 sc1 lds
buffer_load_dwordx4 v241, s[12:15], s54 offen offset:3072 sc1 lds
s_add_u32 m0, s53, 98304
s_add_u32 s54, s28, 256
buffer_load_dwordx4 v241, s[12:15], s54 offen offset:0 sc1 lds
buffer_load_dwordx4 v241, s[12:15], s54 offen offset:1024 sc1 lds
buffer_load_dwordx4 v241, s[12:15], s54 offen offset:2048 sc1 lds
buffer_load_dwordx4 v241, s[12:15], s54 offen offset:3072 sc1 lds
s_add_u32 m0, s53, 102400
s_add_u32 s54, s28, 384
buffer_load_dwordx4 v241, s[12:15], s54 offen offset:0 sc1 lds
buffer_load_dwordx4 v241, s[12:15], s54 offen offset:1024 sc1 lds
buffer_load_dwordx4 v241, s[12:15], s54 offen offset:2048 sc1 lds
buffer_load_dwordx4 v241, s[12:15], s54 offen offset:3072 sc1 lds
s_add_u32 s53, s53, 0x4000
s_and_b32 s53, s53, 0xffff
s_add_u32 s28, s28, 0x4000
s_add_u32 m0, s53, 90112
s_add_u32 s54, s28, 0
buffer_load_dwordx4 v241, s[12:15], s54 offen offset:0 sc1 lds
buffer_load_dwordx4 v241, s[12:15], s54 offen offset:1024 sc1 lds
buffer_load_dwordx4 v241, s[12:15], s54 offen offset:2048 sc1 lds
buffer_load_dwordx4 v241, s[12:15], s54 offen offset:3072 sc1 lds
s_add_u32 m0, s53, 94208
s_add_u32 s54, s28, 128
buffer_load_dwordx4 v241, s[12:15], s54 offen offset:0 sc1 lds
buffer_load_dwordx4 v241, s[12:15], s54 offen offset:1024 sc1 lds
buffer_load_dwordx4 v241, s[12:15], s54 offen offset:2048 sc1 lds
buffer_load_dwordx4 v241, s[12:15], s54 offen offset:3072 sc1 lds
s_add_u32 m0, s53, 98304
s_add_u32 s54, s28, 256
buffer_load_dwordx4 v241, s[12:15], s54 offen offset:0 sc1 lds
buffer_load_dwordx4 v241, s[12:15], s54 offen offset:1024 sc1 lds
buffer_load_dwordx4 v241, s[12:15], s54 offen offset:2048 sc1 lds
buffer_load_dwordx4 v241, s[12:15], s54 offen offset:3072 sc1 lds
s_add_u32 m0, s53, 102400
s_add_u32 s54, s28, 384
buffer_load_dwordx4 v241, s[12:15], s54 offen offset:0 sc1 lds
buffer_load_dwordx4 v241, s[12:15], s54 offen offset:1024 sc1 lds
buffer_load_dwordx4 v241, s[12:15], s54 offen offset:2048 sc1 lds
buffer_load_dwordx4 v241, s[12:15], s54 offen offset:3072 sc1 lds
s_add_u32 s53, s53, 0x4000
s_and_b32 s53, s53, 0xffff
s_add_u32 s28, s28, 0x4000
s_mul_i32 s35, s37, 0x600000
s_add_u32 s20, s4, 0x2000000
s_addc_u32 s21, s5, 0
s_add_u32 s20, s20, s35
s_addc_u32 s21, s21, 0
s_mov_b32 s22, 0x4e4000
s_mov_b32 s23, 0x00020000
s_add_u32 s24, s4, 0x6000000
s_addc_u32 s25, s5, 0
s_mov_b32 s26, 0x139000
s_mov_b32 s27, 0x00020000
s_lshl_b32 s48, s37, 3
s_add_u32 s48, s48, 638976
s_mov_b32 s48, 1277952
v_bfe_u32 v240, v243, 4, 3
v_lshlrev_b32 v240, 6, v240
v_bfe_u32 v242, v243, 7, 1
v_lshl_or_b32 v240, v242, 10, v240
v_bfe_u32 v242, v243, 8, 2
v_lshl_or_b32 v240, v242, 4, v240
v_bfe_u32 v242, v243, 6, 1
v_lshlrev_b32 v242, 5, v242
v_xor_b32 v240, v240, v242
v_and_b32 v246, 0x1c0, v243
v_bfe_u32 v242, v243, 9, 1
v_lshl_or_b32 v246, v242, 10, v246
v_bfe_u32 v242, v243, 8, 1
v_lshl_or_b32 v246, v242, 5, v246
v_bfe_u32 v242, v243, 4, 2
v_lshl_or_b32 v246, v242, 3, v246
v_xor_b32 v247, 32, v246
v_bfe_i32 v242, v243, 8, 1
v_and_b32 v192, s33, v242
v_and_b32 v193, s33, v242
v_and_b32 v194, s33, v242
v_and_b32 v195, s33, v242
s_add_u32 s51, s31, 0
s_mov_b32 s52, 90112
v_mov_b32 v172, 0xff800000
v_mov_b32 v173, 0
v_accvgpr_write_b32 a0, 0
v_accvgpr_write_b32 a1, 0
v_accvgpr_write_b32 a2, 0
v_accvgpr_write_b32 a3, 0
v_accvgpr_write_b32 a4, 0
v_accvgpr_write_b32 a5, 0
v_accvgpr_write_b32 a6, 0
v_accvgpr_write_b32 a7, 0
v_accvgpr_write_b32 a8, 0
v_accvgpr_write_b32 a9, 0
v_accvgpr_write_b32 a10, 0
v_accvgpr_write_b32 a11, 0
v_accvgpr_write_b32 a12, 0
v_accvgpr_write_b32 a13, 0
v_accvgpr_write_b32 a14, 0
v_accvgpr_write_b32 a15, 0
v_accvgpr_write_b32 a16, 0
v_accvgpr_write_b32 a17, 0
v_accvgpr_write_b32 a18, 0
v_accvgpr_write_b32 a19, 0
v_accvgpr_write_b32 a20, 0
v_accvgpr_write_b32 a21, 0
v_accvgpr_write_b32 a22, 0
v_accvgpr_write_b32 a23, 0
v_accvgpr_write_b32 a24, 0
v_accvgpr_write_b32 a25, 0
v_accvgpr_write_b32 a26, 0
v_accvgpr_write_b32 a27, 0
v_accvgpr_write_b32 a28, 0
v_accvgpr_write_b32 a29, 0
v_accvgpr_write_b32 a30, 0
v_accvgpr_write_b32 a31, 0
v_accvgpr_write_b32 a32, 0
v_accvgpr_write_b32 a33, 0
v_accvgpr_write_b32 a34, 0
v_accvgpr_write_b32 a35, 0
v_accvgpr_write_b32 a36, 0
v_accvgpr_write_b32 a37, 0
v_accvgpr_write_b32 a38, 0
v_accvgpr_write_b32 a39, 0
v_accvgpr_write_b32 a40, 0
v_accvgpr_write_b32 a41, 0
v_accvgpr_write_b32 a42, 0
v_accvgpr_write_b32 a43, 0
v_accvgpr_write_b32 a44, 0
v_accvgpr_write_b32 a45, 0
v_accvgpr_write_b32 a46, 0
v_accvgpr_write_b32 a47, 0
v_accvgpr_write_b32 a48, 0
v_accvgpr_write_b32 a49, 0
v_accvgpr_write_b32 a50, 0
v_accvgpr_write_b32 a51, 0
v_accvgpr_write_b32 a52, 0
v_accvgpr_write_b32 a53, 0
v_accvgpr_write_b32 a54, 0
v_accvgpr_write_b32 a55, 0
v_accvgpr_write_b32 a56, 0
v_accvgpr_write_b32 a57, 0
v_accvgpr_write_b32 a58, 0
v_accvgpr_write_b32 a59, 0
v_accvgpr_write_b32 a60, 0
v_accvgpr_write_b32 a61, 0
v_accvgpr_write_b32 a62, 0
v_accvgpr_write_b32 a63, 0
LT_loop:
s_add_u32 m0, s53, 90112
s_add_u32 s54, s28, 0
buffer_load_dwordx4 v241, s[12:15], s54 offen offset:0 sc1 lds
buffer_load_dwordx4 v241, s[12:15], s54 offen offset:1024 sc1 lds
buffer_load_dwordx4 v241, s[12:15], s54 offen offset:2048 sc1 lds
buffer_load_dwordx4 v241, s[12:15], s54 offen offset:3072 sc1 lds
s_add_u32 m0, s53, 94208
s_add_u32 s54, s28, 128
buffer_load_dwordx4 v241, s[12:15], s54 offen offset:0 sc1 lds
buffer_load_dwordx4 v241, s[12:15], s54 offen offset:1024 sc1 lds
buffer_load_dwordx4 v241, s[12:15], s54 offen offset:2048 sc1 lds
buffer_load_dwordx4 v241, s[12:15], s54 offen offset:3072 sc1 lds
s_add_u32 m0, s53, 98304
s_add_u32 s54, s28, 256
buffer_load_dwordx4 v241, s[12:15], s54 offen offset:0 sc1 lds
buffer_load_dwordx4 v241, s[12:15], s54 offen offset:1024 sc1 lds
buffer_load_dwordx4 v241, s[12:15], s54 offen offset:2048 sc1 lds
buffer_load_dwordx4 v241, s[12:15], s54 offen offset:3072 sc1 lds
s_add_u32 m0, s53, 102400
s_add_u32 s54, s28, 384
buffer_load_dwordx4 v241, s[12:15], s54 offen offset:0 sc1 lds
buffer_load_dwordx4 v241, s[12:15], s54 offen offset:1024 sc1 lds
buffer_load_dwordx4 v241, s[12:15], s54 offen offset:2048 sc1 lds
buffer_load_dwordx4 v241, s[12:15], s54 offen offset:3072 sc1 lds
s_add_u32 s53, s53, 0x4000
s_and_b32 s53, s53, 0xffff
s_add_u32 s28, s28, 0x4000
v_add_u32 v177, s52, v240
v_add_u32 v178, s52, v246
v_add_u32 v179, s52, v247
s_add_u32 s52, s52, 0x4000
s_cmp_eq_u32 s52, 155648
s_cselect_b32 s52, 90112, s52
s_waitcnt vmcnt(48)
ds_read_b128 v[32:35], v177 offset:0
ds_read_b128 v[64:67], v177 offset:2048
ds_read_b128 v[36:39], v177 offset:512
ds_read_b128 v[68:71], v177 offset:2560
ds_read_b128 v[40:43], v177 offset:4096
ds_read_b128 v[72:75], v177 offset:6144
ds_read_b128 v[44:47], v177 offset:4608
ds_read_b128 v[76:79], v177 offset:6656
ds_read_b128 v[48:51], v177 offset:8192
ds_read_b128 v[80:83], v177 offset:10240
ds_read_b128 v[52:55], v177 offset:8704
ds_read_b128 v[84:87], v177 offset:10752
ds_read_b128 v[56:59], v177 offset:12288
ds_read_b128 v[88:91], v177 offset:14336
ds_read_b128 v[60:63], v177 offset:12800
ds_read_b128 v[92:95], v177 offset:14848
s_waitcnt lgkmcnt(14)
v_mfma_f32_16x16x32_bf16 v[160:163], v[32:35], v[0:3], v[192:195]
v_mfma_f32_16x16x32_bf16 v[164:167], v[64:67], v[0:3], v[192:195]
s_waitcnt lgkmcnt(12)
v_mfma_f32_16x16x32_bf16 v[160:163], v[36:39], v[4:7], v[160:163]
v_mfma_f32_16x16x32_bf16 v[164:167], v[68:71], v[4:7], v[164:167]
s_waitcnt lgkmcnt(10)
v_mfma_f32_16x16x32_bf16 v[160:163], v[40:43], v[8:11], v[160:163]
v_mfma_f32_16x16x32_bf16 v[164:167], v[72:75], v[8:11], v[164:167]
s_waitcnt lgkmcnt(8)
v_mfma_f32_16x16x32_bf16 v[160:163], v[44:47], v[12:15], v[160:163]
v_mfma_f32_16x16x32_bf16 v[164:167], v[76:79], v[12:15], v[164:167]
s_waitcnt lgkmcnt(6)
v_mfma_f32_16x16x32_bf16 v[160:163], v[48:51], v[16:19], v[160:163]
v_mfma_f32_16x16x32_bf16 v[164:167], v[80:83], v[16:19], v[164:167]
s_waitcnt lgkmcnt(4)
v_mfma_f32_16x16x32_bf16 v[160:163], v[52:55], v[20:23], v[160:163]
v_mfma_f32_16x16x32_bf16 v[164:167], v[84:87], v[20:23], v[164:167]
s_waitcnt lgkmcnt(2)
v_mfma_f32_16x16x32_bf16 v[160:163], v[56:59], v[24:27], v[160:163]
v_mfma_f32_16x16x32_bf16 v[164:167], v[88:91], v[24:27], v[164:167]
s_waitcnt lgkmcnt(0)
v_mfma_f32_16x16x32_bf16 v[160:163], v[60:63], v[28:31], v[160:163]
v_mfma_f32_16x16x32_bf16 v[164:167], v[92:95], v[28:31], v[164:167]
ds_read_b64_tr_b16 v[96:97], v178 offset:0
ds_read_b64_tr_b16 v[98:99], v178 offset:2048
ds_read_b64_tr_b16 v[100:101], v179 offset:0
ds_read_b64_tr_b16 v[102:103], v179 offset:2048
ds_read_b64_tr_b16 v[104:105], v178 offset:512
ds_read_b64_tr_b16 v[106:107], v178 offset:2560
ds_read_b64_tr_b16 v[108:109], v179 offset:512
ds_read_b64_tr_b16 v[110:111], v179 offset:2560
ds_read_b64_tr_b16 v[112:113], v178 offset:4096
ds_read_b64_tr_b16 v[114:115], v178 offset:6144
ds_read_b64_tr_b16 v[116:117], v179 offset:4096
ds_read_b64_tr_b16 v[118:119], v179 offset:6144
ds_read_b64_tr_b16 v[120:121], v178 offset:4608
ds_read_b64_tr_b16 v[122:123], v178 offset:6656
ds_read_b64_tr_b16 v[124:125], v179 offset:4608
ds_read_b64_tr_b16 v[126:127], v179 offset:6656
ds_read_b64_tr_b16 v[128:129], v178 offset:8192
ds_read_b64_tr_b16 v[130:131], v178 offset:10240
ds_read_b64_tr_b16 v[132:133], v179 offset:8192
ds_read_b64_tr_b16 v[134:135], v179 offset:10240
ds_read_b64_tr_b16 v[136:137], v178 offset:8704
ds_read_b64_tr_b16 v[138:139], v178 offset:10752
ds_read_b64_tr_b16 v[140:141], v179 offset:8704
ds_read_b64_tr_b16 v[142:143], v179 offset:10752
ds_read_b64_tr_b16 v[144:145], v178 offset:12288
ds_read_b64_tr_b16 v[146:147], v178 offset:14336
ds_read_b64_tr_b16 v[148:149], v179 offset:12288
ds_read_b64_tr_b16 v[150:151], v179 offset:14336
ds_read_b64_tr_b16 v[152:153], v178 offset:12800
ds_read_b64_tr_b16 v[154:155], v178 offset:14848
ds_read_b64_tr_b16 v[156:157], v179 offset:12800
ds_read_b64_tr_b16 v[158:159], v179 offset:14848
v_mov_b32 v192, 0
v_mov_b32 v193, 0
v_mov_b32 v194, 0
v_mov_b32 v195, 0
s_nop 7
v_max3_f32 v175, v160, v161, v162
v_max3_f32 v175, v175, v163, v164
v_max3_f32 v175, v175, v165, v166
v_max3_f32 v175, v175, v167, v172
v_mov_b32 v176, v175
s_nop 1
v_permlane32_swap_b32 v175, v176
s_nop 1
v_max_f32 v175, v175, v176
v_mov_b32 v176, v175
s_nop 1
v_permlane16_swap_b32 v175, v176
s_nop 1
v_max_f32 v175, v175, v176
v_ceil_f32 v175, v175
v_sub_f32 v174, v172, v175
v_exp_f32 v174, v174
v_mov_b32 v172, v175
v_sub_f32 v160, v160, v172
v_sub_f32 v161, v161, v172
v_sub_f32 v162, v162, v172
v_sub_f32 v163, v163, v172
v_sub_f32 v164, v164, v172
v_sub_f32 v165, v165, v172
v_sub_f32 v166, v166, v172
v_sub_f32 v167, v167, v172
v_exp_f32 v160, v160
v_exp_f32 v161, v161
v_exp_f32 v162, v162
v_exp_f32 v163, v163
v_exp_f32 v164, v164
v_exp_f32 v165, v165
v_exp_f32 v166, v166
v_exp_f32 v167, v167
v_mul_f32 v173, v173, v174
v_cvt_pk_bf16_f32 v168, v160, v161
v_cvt_pk_bf16_f32 v169, v162, v163
v_cvt_pk_bf16_f32 v170, v164, v165
v_cvt_pk_bf16_f32 v171, v166, v167
v_cmp_neq_f32 vcc, 1.0, v174
v_add_f32 v173, v173, v160
v_add_f32 v173, v173, v161
v_add_f32 v173, v173, v162
v_add_f32 v173, v173, v163
v_add_f32 v173, v173, v164
v_add_f32 v173, v173, v165
v_add_f32 v173, v173, v166
v_add_f32 v173, v173, v167
s_cbranch_vccz LT_nors
v_lshrrev_b32 v176, 4, v243
v_and_b32 v176, 0x30, v176
ds_bpermute_b32 v188, v176, v174 offset:0
ds_bpermute_b32 v189, v176, v174 offset:4
ds_bpermute_b32 v190, v176, v174 offset:8
ds_bpermute_b32 v191, v176, v174 offset:12
s_waitcnt lgkmcnt(0)
v_accvgpr_read_b32 v180, a0
v_accvgpr_read_b32 v181, a1
v_accvgpr_read_b32 v182, a2
v_accvgpr_read_b32 v183, a3
v_accvgpr_read_b32 v184, a4
v_accvgpr_read_b32 v185, a5
v_accvgpr_read_b32 v186, a6
v_accvgpr_read_b32 v187, a7
v_mul_f32 v180, v180, v188
v_mul_f32 v181, v181, v189
v_mul_f32 v182, v182, v190
v_mul_f32 v183, v183, v191
v_mul_f32 v184, v184, v188
v_mul_f32 v185, v185, v189
v_mul_f32 v186, v186, v190
v_mul_f32 v187, v187, v191
v_accvgpr_write_b32 a0, v180
v_accvgpr_write_b32 a1, v181
v_accvgpr_write_b32 a2, v182
v_accvgpr_write_b32 a3, v183
v_accvgpr_write_b32 a4, v184
v_accvgpr_write_b32 a5, v185
v_accvgpr_write_b32 a6, v186
v_accvgpr_write_b32 a7, v187
v_accvgpr_read_b32 v180, a8
v_accvgpr_read_b32 v181, a9
v_accvgpr_read_b32 v182, a10
v_accvgpr_read_b32 v183, a11
v_accvgpr_read_b32 v184, a12
v_accvgpr_read_b32 v185, a13
v_accvgpr_read_b32 v186, a14
v_accvgpr_read_b32 v187, a15
v_mul_f32 v180, v180, v188
v_mul_f32 v181, v181, v189
v_mul_f32 v182, v182, v190
v_mul_f32 v183, v183, v191
v_mul_f32 v184, v184, v188
v_mul_f32 v185, v185, v189
v_mul_f32 v186, v186, v190
v_mul_f32 v187, v187, v191
v_accvgpr_write_b32 a8, v180
v_accvgpr_write_b32 a9, v181
v_accvgpr_write_b32 a10, v182
v_accvgpr_write_b32 a11, v183
v_accvgpr_write_b32 a12, v184
v_accvgpr_write_b32 a13, v185
v_accvgpr_write_b32 a14, v186
v_accvgpr_write_b32 a15, v187
v_accvgpr_read_b32 v180, a16
v_accvgpr_read_b32 v181, a17
v_accvgpr_read_b32 v182, a18
v_accvgpr_read_b32 v183, a19
v_accvgpr_read_b32 v184, a20
v_accvgpr_read_b32 v185, a21
v_accvgpr_read_b32 v186, a22
v_accvgpr_read_b32 v187, a23
v_mul_f32 v180, v180, v188
v_mul_f32 v181, v181, v189
v_mul_f32 v182, v182, v190
v_mul_f32 v183, v183, v191
v_mul_f32 v184, v184, v188
v_mul_f32 v185, v185, v189
v_mul_f32 v186, v186, v190
v_mul_f32 v187, v187, v191
v_accvgpr_write_b32 a16, v180
v_accvgpr_write_b32 a17, v181
v_accvgpr_write_b32 a18, v182
v_accvgpr_write_b32 a19, v183
v_accvgpr_write_b32 a20, v184
v_accvgpr_write_b32 a21, v185
v_accvgpr_write_b32 a22, v186
v_accvgpr_write_b32 a23, v187
v_accvgpr_read_b32 v180, a24
v_accvgpr_read_b32 v181, a25
v_accvgpr_read_b32 v182, a26
v_accvgpr_read_b32 v183, a27
v_accvgpr_read_b32 v184, a28
v_accvgpr_read_b32 v185, a29
v_accvgpr_read_b32 v186, a30
v_accvgpr_read_b32 v187, a31
v_mul_f32 v180, v180, v188
v_mul_f32 v181, v181, v189
v_mul_f32 v182, v182, v190
v_mul_f32 v183, v183, v191
v_mul_f32 v184, v184, v188
v_mul_f32 v185, v185, v189
v_mul_f32 v186, v186, v190
v_mul_f32 v187, v187, v191
v_accvgpr_write_b32 a24, v180
v_accvgpr_write_b32 a25, v181
v_accvgpr_write_b32 a26, v182
v_accvgpr_write_b32 a27, v183
v_accvgpr_write_b32 a28, v184
v_accvgpr_write_b32 a29, v185
v_accvgpr_write_b32 a30, v186
v_accvgpr_write_b32 a31, v187
v_accvgpr_read_b32 v180, a32
v_accvgpr_read_b32 v181, a33
v_accvgpr_read_b32 v182, a34
v_accvgpr_read_b32 v183, a35
v_accvgpr_read_b32 v184, a36
v_accvgpr_read_b32 v185, a37
v_accvgpr_read_b32 v186, a38
v_accvgpr_read_b32 v187, a39
v_mul_f32 v180, v180, v188
v_mul_f32 v181, v181, v189
v_mul_f32 v182, v182, v190
v_mul_f32 v183, v183, v191
v_mul_f32 v184, v184, v188
v_mul_f32 v185, v185, v189
v_mul_f32 v186, v186, v190
v_mul_f32 v187, v187, v191
v_accvgpr_write_b32 a32, v180
v_accvgpr_write_b32 a33, v181
v_accvgpr_write_b32 a34, v182
v_accvgpr_write_b32 a35, v183
v_accvgpr_write_b32 a36, v184
v_accvgpr_write_b32 a37, v185
v_accvgpr_write_b32 a38, v186
v_accvgpr_write_b32 a39, v187
v_accvgpr_read_b32 v180, a40
v_accvgpr_read_b32 v181, a41
v_accvgpr_read_b32 v182, a42
v_accvgpr_read_b32 v183, a43
v_accvgpr_read_b32 v184, a44
v_accvgpr_read_b32 v185, a45
v_accvgpr_read_b32 v186, a46
v_accvgpr_read_b32 v187, a47
v_mul_f32 v180, v180, v188
v_mul_f32 v181, v181, v189
v_mul_f32 v182, v182, v190
v_mul_f32 v183, v183, v191
v_mul_f32 v184, v184, v188
v_mul_f32 v185, v185, v189
v_mul_f32 v186, v186, v190
v_mul_f32 v187, v187, v191
v_accvgpr_write_b32 a40, v180
v_accvgpr_write_b32 a41, v181
v_accvgpr_write_b32 a42, v182
v_accvgpr_write_b32 a43, v183
v_accvgpr_write_b32 a44, v184
v_accvgpr_write_b32 a45, v185
v_accvgpr_write_b32 a46, v186
v_accvgpr_write_b32 a47, v187
v_accvgpr_read_b32 v180, a48
v_accvgpr_read_b32 v181, a49
v_accvgpr_read_b32 v182, a50
v_accvgpr_read_b32 v183, a51
v_accvgpr_read_b32 v184, a52
v_accvgpr_read_b32 v185, a53
v_accvgpr_read_b32 v186, a54
v_accvgpr_read_b32 v187, a55
v_mul_f32 v180, v180, v188
v_mul_f32 v181, v181, v189
v_mul_f32 v182, v182, v190
v_mul_f32 v183, v183, v191
v_mul_f32 v184, v184, v188
v_mul_f32 v185, v185, v189
v_mul_f32 v186, v186, v190
v_mul_f32 v187, v187, v191
v_accvgpr_write_b32 a48, v180
v_accvgpr_write_b32 a49, v181
v_accvgpr_write_b32 a50, v182
v_accvgpr_write_b32 a51, v183
v_accvgpr_write_b32 a52, v184
v_accvgpr_write_b32 a53, v185
v_accvgpr_write_b32 a54, v186
v_accvgpr_write_b32 a55, v187
v_accvgpr_read_b32 v180, a56
v_accvgpr_read_b32 v181, a57
v_accvgpr_read_b32 v182, a58
v_accvgpr_read_b32 v183, a59
v_accvgpr_read_b32 v184, a60
v_accvgpr_read_b32 v185, a61
v_accvgpr_read_b32 v186, a62
v_accvgpr_read_b32 v187, a63
v_mul_f32 v180, v180, v188
v_mul_f32 v181, v181, v189
v_mul_f32 v182, v182, v190
v_mul_f32 v183, v183, v191
v_mul_f32 v184, v184, v188
v_mul_f32 v185, v185, v189
v_mul_f32 v186, v186, v190
v_mul_f32 v187, v187, v191
v_accvgpr_write_b32 a56, v180
v_accvgpr_write_b32 a57, v181
v_accvgpr_write_b32 a58, v182
v_accvgpr_write_b32 a59, v183
v_accvgpr_write_b32 a60, v184
v_accvgpr_write_b32 a61, v185
v_accvgpr_write_b32 a62, v186
v_accvgpr_write_b32 a63, v187
LT_nors:
s_waitcnt lgkmcnt(0)
s_nop 1
v_mfma_f32_16x16x32_bf16 a[0:3], v[168:171], v[96:99], a[0:3]
v_mfma_f32_16x16x32_bf16 a[4:7], v[168:171], v[100:103], a[4:7]
v_mfma_f32_16x16x32_bf16 a[8:11], v[168:171], v[104:107], a[8:11]
v_mfma_f32_16x16x32_bf16 a[12:15], v[168:171], v[108:111], a[12:15]
v_mfma_f32_16x16x32_bf16 a[16:19], v[168:171], v[112:115], a[16:19]
v_mfma_f32_16x16x32_bf16 a[20:23], v[168:171], v[116:119], a[20:23]
v_mfma_f32_16x16x32_bf16 a[24:27], v[168:171], v[120:123], a[24:27]
v_mfma_f32_16x16x32_bf16 a[28:31], v[168:171], v[124:127], a[28:31]
v_mfma_f32_16x16x32_bf16 a[32:35], v[168:171], v[128:131], a[32:35]
v_mfma_f32_16x16x32_bf16 a[36:39], v[168:171], v[132:135], a[36:39]
v_mfma_f32_16x16x32_bf16 a[40:43], v[168:171], v[136:139], a[40:43]
v_mfma_f32_16x16x32_bf16 a[44:47], v[168:171], v[140:143], a[44:47]
v_mfma_f32_16x16x32_bf16 a[48:51], v[168:171], v[144:147], a[48:51]
v_mfma_f32_16x16x32_bf16 a[52:55], v[168:171], v[148:151], a[52:55]
v_mfma_f32_16x16x32_bf16 a[56:59], v[168:171], v[152:155], a[56:59]
v_mfma_f32_16x16x32_bf16 a[60:63], v[168:171], v[156:159], a[60:63]
s_sub_u32 s51, s51, 1
s_cmp_lg_u32 s51, 0
s_cbranch_scc1 LT_loop
s_nop 15
s_add_u32 s16, s4, 0x0
s_addc_u32 s17, s5, 0
s_mov_b32 s18, 0x10000000
s_mov_b32 s19, 0x00020000
s_mul_i32 s52, s37, 0x5000
s_add_u32 s52, s52, 0x1200000
s_add_u32 s53, s37, 1610
s_lshl_b32 s53, s53, 7
s_add_u32 s53, s53, 0x7c00000
s_waitcnt vmcnt(0)
s_cmp_eq_u32 s36, 0
s_cbranch_scc1 LT_merge
buffer_store_dwordx4 a[0:3], v243, s[16:19], s52 offen offset:0 sc1
buffer_store_dwordx4 a[4:7], v243, s[16:19], s52 offen offset:1024 sc1
buffer_store_dwordx4 a[8:11], v243, s[16:19], s52 offen offset:2048 sc1
buffer_store_dwordx4 a[12:15], v243, s[16:19], s52 offen offset:3072 sc1
s_add_u32 s52, s52, 4096
buffer_store_dwordx4 a[16:19], v243, s[16:19], s52 offen offset:0 sc1
buffer_store_dwordx4 a[20:23], v243, s[16:19], s52 offen offset:1024 sc1
buffer_store_dwordx4 a[24:27], v243, s[16:19], s52 offen offset:2048 sc1
buffer_store_dwordx4 a[28:31], v243, s[16:19], s52 offen offset:3072 sc1
s_add_u32 s52, s52, 4096
buffer_store_dwordx4 a[32:35], v243, s[16:19], s52 offen offset:0 sc1
buffer_store_dwordx4 a[36:39], v243, s[16:19], s52 offen offset:1024 sc1
buffer_store_dwordx4 a[40:43], v243, s[16:19], s52 offen offset:2048 sc1
buffer_store_dwordx4 a[44:47], v243, s[16:19], s52 offen offset:3072 sc1
s_add_u32 s52, s52, 4096
buffer_store_dwordx4 a[48:51], v243, s[16:19], s52 offen offset:0 sc1
buffer_store_dwordx4 a[52:55], v243, s[16:19], s52 offen offset:1024 sc1
buffer_store_dwordx4 a[56:59], v243, s[16:19], s52 offen offset:2048 sc1
buffer_store_dwordx4 a[60:63], v243, s[16:19], s52 offen offset:3072 sc1
s_add_u32 s52, s52, 4096
buffer_store_dwordx2 v[172:173], v243, s[16:19], s52 offen sc1
s_waitcnt vmcnt(0)
v_mov_b32 v176, s98
v_mov_b32 v177, s99
v_mov_b32 v178, s98
v_mov_b32 v179, s99
s_mov_b64 exec, 0xff
buffer_store_dwordx4 v[176:179], v243, s[16:19], s53 offen sc1
s_mov_b64 exec, -1
s_branch L2_fin
LT_merge:
s_mov_b32 s94, 0x10000
LT_mw:
buffer_load_dwordx2 v[0:1], off, s[16:19], s53 sc1
s_sub_u32 s94, s94, 1
s_waitcnt vmcnt(0)
s_cbranch_scc1 LT_mw_go
v_cmp_ne_u64 vcc, s[98:99], v[0:1]
s_nop 1
s_cbranch_vccnz LT_mw
LT_mw_go:
buffer_load_dwordx4 v[96:99], v243, s[16:19], s52 offen offset:0 sc1
buffer_load_dwordx4 v[100:103], v243, s[16:19], s52 offen offset:1024 sc1
buffer_load_dwordx4 v[104:107], v243, s[16:19], s52 offen offset:2048 sc1
buffer_load_dwordx4 v[108:111], v243, s[16:19], s52 offen offset:3072 sc1
s_add_u32 s52, s52, 4096
buffer_load_dwordx4 v[112:115], v243, s[16:19], s52 offen offset:0 sc1
buffer_load_dwordx4 v[116:119], v243, s[16:19], s52 offen offset:1024 sc1
buffer_load_dwordx4 v[120:123], v243, s[16:19], s52 offen offset:2048 sc1
buffer_load_dwordx4 v[124:127], v243, s[16:19], s52 offen offset:3072 sc1
s_add_u32 s52, s52, 4096
buffer_load_dwordx4 v[128:131], v243, s[16:19], s52 offen offset:0 sc1
buffer_load_dwordx4 v[132:135], v243, s[16:19], s52 offen offset:1024 sc1
buffer_load_dwordx4 v[136:139], v243, s[16:19], s52 offen offset:2048 sc1
buffer_load_dwordx4 v[140:143], v243, s[16:19], s52 offen offset:3072 sc1
s_add_u32 s52, s52, 4096
buffer_load_dwordx4 v[144:147], v243, s[16:19], s52 offen offset:0 sc1
buffer_load_dwordx4 v[148:151], v243, s[16:19], s52 offen offset:1024 sc1
buffer_load_dwordx4 v[152:155], v243, s[16:19], s52 offen offset:2048 sc1
buffer_load_dwordx4 v[156:159], v243, s[16:19], s52 offen offset:3072 sc1
s_add_u32 s52, s52, 4096
buffer_load_dwordx2 v[0:1], v243, s[16:19], s52 offen sc1
v_lshrrev_b32 v176, 4, v243
v_and_b32 v176, 0x30, v176
s_waitcnt vmcnt(0)
v_max_f32 v175, v172, v0
v_sub_f32 v2, v172, v175
v_sub_f32 v3, v0, v175
v_mov_b32 v172, v175
v_exp_f32 v2, v2
v_exp_f32 v3, v3
s_nop 0
v_mul_f32 v173, v173, v2
v_fmac_f32 v173, v1, v3
ds_bpermute_b32 v4, v176, v2 offset:0
ds_bpermute_b32 v8, v176, v3 offset:0
ds_bpermute_b32 v5, v176, v2 offset:4
ds_bpermute_b32 v9, v176, v3 offset:4
ds_bpermute_b32 v6, v176, v2 offset:8
ds_bpermute_b32 v10, v176, v3 offset:8
ds_bpermute_b32 v7, v176, v2 offset:12
ds_bpermute_b32 v11, v176, v3 offset:12
s_waitcnt lgkmcnt(0)
v_accvgpr_read_b32 v180, a0
v_accvgpr_read_b32 v181, a1
v_accvgpr_read_b32 v182, a2
v_accvgpr_read_b32 v183, a3
v_accvgpr_read_b32 v184, a4
v_accvgpr_read_b32 v185, a5
v_accvgpr_read_b32 v186, a6
v_accvgpr_read_b32 v187, a7
v_mul_f32 v180, v180, v4
v_mul_f32 v181, v181, v5
v_mul_f32 v182, v182, v6
v_mul_f32 v183, v183, v7
v_mul_f32 v184, v184, v4
v_mul_f32 v185, v185, v5
v_mul_f32 v186, v186, v6
v_mul_f32 v187, v187, v7
v_fmac_f32 v180, v96, v8
v_fmac_f32 v181, v97, v9
v_fmac_f32 v182, v98, v10
v_fmac_f32 v183, v99, v11
v_fmac_f32 v184, v100, v8
v_fmac_f32 v185, v101, v9
v_fmac_f32 v186, v102, v10
v_fmac_f32 v187, v103, v11
v_cvt_pk_bf16_f32 v32, v180, v181
v_cvt_pk_bf16_f32 v33, v182, v183
v_cvt_pk_bf16_f32 v34, v184, v185
v_cvt_pk_bf16_f32 v35, v186, v187
buffer_store_dwordx4 v[32:35], v243, s[20:23], s40 offen offset:0 sc1
v_accvgpr_read_b32 v180, a8
v_accvgpr_read_b32 v181, a9
v_accvgpr_read_b32 v182, a10
v_accvgpr_read_b32 v183, a11
v_accvgpr_read_b32 v184, a12
v_accvgpr_read_b32 v185, a13
v_accvgpr_read_b32 v186, a14
v_accvgpr_read_b32 v187, a15
v_mul_f32 v180, v180, v4
v_mul_f32 v181, v181, v5
v_mul_f32 v182, v182, v6
v_mul_f32 v183, v183, v7
v_mul_f32 v184, v184, v4
v_mul_f32 v185, v185, v5
v_mul_f32 v186, v186, v6
v_mul_f32 v187, v187, v7
v_fmac_f32 v180, v104, v8
v_fmac_f32 v181, v105, v9
v_fmac_f32 v182, v106, v10
v_fmac_f32 v183, v107, v11
v_fmac_f32 v184, v108, v8
v_fmac_f32 v185, v109, v9
v_fmac_f32 v186, v110, v10
v_fmac_f32 v187, v111, v11
v_cvt_pk_bf16_f32 v36, v180, v181
v_cvt_pk_bf16_f32 v37, v182, v183
v_cvt_pk_bf16_f32 v38, v184, v185
v_cvt_pk_bf16_f32 v39, v186, v187
buffer_store_dwordx4 v[36:39], v243, s[20:23], s40 offen offset:1024 sc1
v_accvgpr_read_b32 v180, a16
v_accvgpr_read_b32 v181, a17
v_accvgpr_read_b32 v182, a18
v_accvgpr_read_b32 v183, a19
v_accvgpr_read_b32 v184, a20
v_accvgpr_read_b32 v185, a21
v_accvgpr_read_b32 v186, a22
v_accvgpr_read_b32 v187, a23
v_mul_f32 v180, v180, v4
v_mul_f32 v181, v181, v5
v_mul_f32 v182, v182, v6
v_mul_f32 v183, v183, v7
v_mul_f32 v184, v184, v4
v_mul_f32 v185, v185, v5
v_mul_f32 v186, v186, v6
v_mul_f32 v187, v187, v7
v_fmac_f32 v180, v112, v8
v_fmac_f32 v181, v113, v9
v_fmac_f32 v182, v114, v10
v_fmac_f32 v183, v115, v11
v_fmac_f32 v184, v116, v8
v_fmac_f32 v185, v117, v9
v_fmac_f32 v186, v118, v10
v_fmac_f32 v187, v119, v11
v_cvt_pk_bf16_f32 v40, v180, v181
v_cvt_pk_bf16_f32 v41, v182, v183
v_cvt_pk_bf16_f32 v42, v184, v185
v_cvt_pk_bf16_f32 v43, v186, v187
buffer_store_dwordx4 v[40:43], v243, s[20:23], s40 offen offset:2048 sc1
v_accvgpr_read_b32 v180, a24
v_accvgpr_read_b32 v181, a25
v_accvgpr_read_b32 v182, a26
v_accvgpr_read_b32 v183, a27
v_accvgpr_read_b32 v184, a28
v_accvgpr_read_b32 v185, a29
v_accvgpr_read_b32 v186, a30
v_accvgpr_read_b32 v187, a31
v_mul_f32 v180, v180, v4
v_mul_f32 v181, v181, v5
v_mul_f32 v182, v182, v6
v_mul_f32 v183, v183, v7
v_mul_f32 v184, v184, v4
v_mul_f32 v185, v185, v5
v_mul_f32 v186, v186, v6
v_mul_f32 v187, v187, v7
v_fmac_f32 v180, v120, v8
v_fmac_f32 v181, v121, v9
v_fmac_f32 v182, v122, v10
v_fmac_f32 v183, v123, v11
v_fmac_f32 v184, v124, v8
v_fmac_f32 v185, v125, v9
v_fmac_f32 v186, v126, v10
v_fmac_f32 v187, v127, v11
v_cvt_pk_bf16_f32 v44, v180, v181
v_cvt_pk_bf16_f32 v45, v182, v183
v_cvt_pk_bf16_f32 v46, v184, v185
v_cvt_pk_bf16_f32 v47, v186, v187
buffer_store_dwordx4 v[44:47], v243, s[20:23], s40 offen offset:3072 sc1
v_accvgpr_read_b32 v180, a32
v_accvgpr_read_b32 v181, a33
v_accvgpr_read_b32 v182, a34
v_accvgpr_read_b32 v183, a35
v_accvgpr_read_b32 v184, a36
v_accvgpr_read_b32 v185, a37
v_accvgpr_read_b32 v186, a38
v_accvgpr_read_b32 v187, a39
v_mul_f32 v180, v180, v4
v_mul_f32 v181, v181, v5
v_mul_f32 v182, v182, v6
v_mul_f32 v183, v183, v7
v_mul_f32 v184, v184, v4
v_mul_f32 v185, v185, v5
v_mul_f32 v186, v186, v6
v_mul_f32 v187, v187, v7
v_fmac_f32 v180, v128, v8
v_fmac_f32 v181, v129, v9
v_fmac_f32 v182, v130, v10
v_fmac_f32 v183, v131, v11
v_fmac_f32 v184, v132, v8
v_fmac_f32 v185, v133, v9
v_fmac_f32 v186, v134, v10
v_fmac_f32 v187, v135, v11
v_cvt_pk_bf16_f32 v48, v180, v181
v_cvt_pk_bf16_f32 v49, v182, v183
v_cvt_pk_bf16_f32 v50, v184, v185
v_cvt_pk_bf16_f32 v51, v186, v187
buffer_store_dwordx4 v[48:51], v243, s[20:23], s44 offen offset:0 sc1
v_accvgpr_read_b32 v180, a40
v_accvgpr_read_b32 v181, a41
v_accvgpr_read_b32 v182, a42
v_accvgpr_read_b32 v183, a43
v_accvgpr_read_b32 v184, a44
v_accvgpr_read_b32 v185, a45
v_accvgpr_read_b32 v186, a46
v_accvgpr_read_b32 v187, a47
v_mul_f32 v180, v180, v4
v_mul_f32 v181, v181, v5
v_mul_f32 v182, v182, v6
v_mul_f32 v183, v183, v7
v_mul_f32 v184, v184, v4
v_mul_f32 v185, v185, v5
v_mul_f32 v186, v186, v6
v_mul_f32 v187, v187, v7
v_fmac_f32 v180, v136, v8
v_fmac_f32 v181, v137, v9
v_fmac_f32 v182, v138, v10
v_fmac_f32 v183, v139, v11
v_fmac_f32 v184, v140, v8
v_fmac_f32 v185, v141, v9
v_fmac_f32 v186, v142, v10
v_fmac_f32 v187, v143, v11
v_cvt_pk_bf16_f32 v52, v180, v181
v_cvt_pk_bf16_f32 v53, v182, v183
v_cvt_pk_bf16_f32 v54, v184, v185
v_cvt_pk_bf16_f32 v55, v186, v187
buffer_store_dwordx4 v[52:55], v243, s[20:23], s44 offen offset:1024 sc1
v_accvgpr_read_b32 v180, a48
v_accvgpr_read_b32 v181, a49
v_accvgpr_read_b32 v182, a50
v_accvgpr_read_b32 v183, a51
v_accvgpr_read_b32 v184, a52
v_accvgpr_read_b32 v185, a53
v_accvgpr_read_b32 v186, a54
v_accvgpr_read_b32 v187, a55
v_mul_f32 v180, v180, v4
v_mul_f32 v181, v181, v5
v_mul_f32 v182, v182, v6
v_mul_f32 v183, v183, v7
v_mul_f32 v184, v184, v4
v_mul_f32 v185, v185, v5
v_mul_f32 v186, v186, v6
v_mul_f32 v187, v187, v7
v_fmac_f32 v180, v144, v8
v_fmac_f32 v181, v145, v9
v_fmac_f32 v182, v146, v10
v_fmac_f32 v183, v147, v11
v_fmac_f32 v184, v148, v8
v_fmac_f32 v185, v149, v9
v_fmac_f32 v186, v150, v10
v_fmac_f32 v187, v151, v11
v_cvt_pk_bf16_f32 v56, v180, v181
v_cvt_pk_bf16_f32 v57, v182, v183
v_cvt_pk_bf16_f32 v58, v184, v185
v_cvt_pk_bf16_f32 v59, v186, v187
buffer_store_dwordx4 v[56:59], v243, s[20:23], s44 offen offset:2048 sc1
v_accvgpr_read_b32 v180, a56
v_accvgpr_read_b32 v181, a57
v_accvgpr_read_b32 v182, a58
v_accvgpr_read_b32 v183, a59
v_accvgpr_read_b32 v184, a60
v_accvgpr_read_b32 v185, a61
v_accvgpr_read_b32 v186, a62
v_accvgpr_read_b32 v187, a63
v_mul_f32 v180, v180, v4
v_mul_f32 v181, v181, v5
v_mul_f32 v182, v182, v6
v_mul_f32 v183, v183, v7
v_mul_f32 v184, v184, v4
v_mul_f32 v185, v185, v5
v_mul_f32 v186, v186, v6
v_mul_f32 v187, v187, v7
v_fmac_f32 v180, v152, v8
v_fmac_f32 v181, v153, v9
v_fmac_f32 v182, v154, v10
v_fmac_f32 v183, v155, v11
v_fmac_f32 v184, v156, v8
v_fmac_f32 v185, v157, v9
v_fmac_f32 v186, v158, v10
v_fmac_f32 v187, v159, v11
v_cvt_pk_bf16_f32 v60, v180, v181
v_cvt_pk_bf16_f32 v61, v182, v183
v_cvt_pk_bf16_f32 v62, v184, v185
v_cvt_pk_bf16_f32 v63, v186, v187
buffer_store_dwordx4 v[60:63], v243, s[20:23], s44 offen offset:3072 sc1
v_mov_b32 v176, v173
s_nop 1
v_permlane32_swap_b32 v173, v176
s_nop 1
v_add_f32 v173, v173, v176
v_mov_b32 v176, v173
s_nop 1
v_permlane16_swap_b32 v173, v176
s_nop 1
v_add_f32 v173, v173, v176
v_lshlrev_b32 v175, 2, v243
s_mov_b64 exec, 0xffff
s_mov_b64 exec, -1
v_bfe_u32 v175, v243, 8, 1
v_mul_u32_u24 v175, 768, v175
v_lshl_add_u32 v175, s37, 7, v175
v_bfe_u32 v176, v243, 4, 4
v_lshl_add_u32 v175, v176, 3, v175
s_mov_b32 exec_hi, 0
buffer_store_dwordx2 v[172:173], v175, s[24:27], s48 offen sc1
s_add_u32 s16, s4, 0x7c00000
s_addc_u32 s17, s5, 0
s_mov_b32 s18, 0x40000
s_mov_b32 s19, 0x00020000
s_add_u32 s48, s37, 1248
s_mul_i32 s48, s48, 128
s_waitcnt vmcnt(0)
v_mov_b32 v176, s98
v_mov_b32 v177, s99
v_mov_b32 v178, s98
v_mov_b32 v179, s99
s_mov_b64 exec, 0xff
buffer_store_dwordx4 v[176:179], v243, s[16:19], s48 offen sc1
s_mov_b64 exec, -1
s_branch L2_fin
LE_start:
s_cmp_ge_u32 s37, 32
s_cbranch_scc1 L2_end
v_lshrrev_b32 v1, 6, v0
s_sub_u32 s37, s37, 30
s_lshl_b32 s35, s35, 1
v_readfirstlane_b32 s41, v1
s_add_u32 s35, s35, s37
s_mul_i32 s35, s35, 3
s_add_u32 s40, s35, s41
s_cmp_ge_u32 s41, 3
s_cbranch_scc1 L2_end
LE_common:
v_and_b32 v1, 63, v0
s_sub_u32 s36, s40, 0
s_mov_b32 s54, 151
s_mul_i32 s36, s36, 151
s_mov_b32 s55, s36
s_sub_u32 s36, s40, 36
s_cselect_b32 s54, s54, 166
s_mul_i32 s36, s36, 166
s_add_u32 s36, s36, 5436
s_cmp_lt_u32 s40, 36
s_cselect_b32 s55, s55, s36
s_sub_u32 s36, s40, 42
s_cselect_b32 s54, s54, 152
s_mul_i32 s36, s36, 152
s_add_u32 s36, s36, 6432
s_cmp_lt_u32 s40, 42
s_cselect_b32 s55, s55, s36
s_sub_u32 s36, s40, 48
s_cselect_b32 s54, s54, 168
s_mul_i32 s36, s36, 168
s_add_u32 s36, s36, 7344
s_cmp_lt_u32 s40, 48
s_cselect_b32 s55, s55, s36
s_mov_b32 s42, 0
s_mov_b32 s49, 512
v_lshrrev_b32 v33, 2, v1
v_and_b32 v34, 3, v1
v_mul_u32_u24 v6, 0x400, v33
v_lshl_add_u32 v6, v34, 4, v6
v_lshlrev_b32 v33, 8, v33
s_mul_i32 s50, s40, 16384
s_lshl_b32 s48, s40, 2
s_waitcnt lgkmcnt(0)
s_add_u32 s8, s4, 0x7c31800
s_addc_u32 s9, s5, 0
s_mov_b32 s10, 0x800
s_mov_b32 s11, 0x00020000
v_and_b32 v194, 15, v0
v_lshlrev_b32 v194, 7, v194
s_mov_b32 s94, 0x10000
LE_poll0:
buffer_load_dwordx2 v[192:193], v194, s[8:11], 0 offen sc1
s_sub_u32 s94, s94, 1
s_waitcnt vmcnt(0)
s_cbranch_scc1 LE_poll0_go
v_cmp_ne_u64 vcc, s[98:99], v[192:193]
s_nop 1
s_cbranch_vccnz LE_poll0
LE_poll0_go:
s_add_u32 s8, s4, 0x7800000
s_addc_u32 s9, s5, 0
s_mov_b32 s10, 0x1000
s_mov_b32 s11, 0x00020000
s_add_u32 s12, s4, 0x8000000
s_addc_u32 s13, s5, 0
s_mov_b32 s14, 0x2800000
s_mov_b32 s15, 0x00020000
buffer_load_dword v4, v33, s[8:11], s48 offen sc1
buffer_load_dwordx4 v[192:195], v6, s[12:15], s50 offen offset:0 sc1
buffer_load_dwordx4 v[196:199], v6, s[12:15], s50 offen offset:64 sc1
buffer_load_dwordx4 v[200:203], v6, s[12:15], s50 offen offset:128 sc1
buffer_load_dwordx4 v[204:207], v6, s[12:15], s50 offen offset:192 sc1
buffer_load_dwordx4 v[208:211], v6, s[12:15], s50 offen offset:256 sc1
buffer_load_dwordx4 v[212:215], v6, s[12:15], s50 offen offset:320 sc1
buffer_load_dwordx4 v[216:219], v6, s[12:15], s50 offen offset:384 sc1
buffer_load_dwordx4 v[220:223], v6, s[12:15], s50 offen offset:448 sc1
buffer_load_dwordx4 v[224:227], v6, s[12:15], s50 offen offset:512 sc1
buffer_load_dwordx4 v[228:231], v6, s[12:15], s50 offen offset:576 sc1
buffer_load_dwordx4 v[232:235], v6, s[12:15], s50 offen offset:640 sc1
buffer_load_dwordx4 v[236:239], v6, s[12:15], s50 offen offset:704 sc1
buffer_load_dwordx4 v[240:243], v6, s[12:15], s50 offen offset:768 sc1
buffer_load_dwordx4 v[244:247], v6, s[12:15], s50 offen offset:832 sc1
buffer_load_dwordx4 v[248:251], v6, s[12:15], s50 offen offset:896 sc1
buffer_load_dwordx4 v[252:255], v6, s[12:15], s50 offen offset:960 sc1
s_add_u32 s16, s4, 0x6800000
s_addc_u32 s17, s5, 0
s_mov_b32 s18, 0x4e2000
s_mov_b32 s19, 0x00020000
s_add_u32 s20, s4, 0x7000000
s_addc_u32 s21, s5, 0
s_mov_b32 s22, 0x4e2000
s_mov_b32 s23, 0x00020000
v_lshlrev_b32 v5, 2, v34
v_and_b32 v2, 15, v1
v_lshrrev_b32 v3, 4, v1
v_mov_b32 v16, 1
v_mov_b32 v17, 4
v_and_b32 v33, 1, v2
v_lshlrev_b32 v33, 4, v33
v_lshlrev_b32 v33, v33, v16
v_mul_u32_u24 v33, 0x3f80, v33
v_lshrrev_b32 v34, 1, v2
v_cmp_eq_u32 vcc, 0, v34
s_nop 1
v_cndmask_b32 v40, 0, v33, vcc
v_cmp_eq_u32 vcc, 1, v34
s_nop 1
v_cndmask_b32 v41, 0, v33, vcc
v_cmp_eq_u32 vcc, 2, v34
s_nop 1
v_cndmask_b32 v42, 0, v33, vcc
v_cmp_eq_u32 vcc, 3, v34
s_nop 1
v_cndmask_b32 v43, 0, v33, vcc
v_cmp_eq_u32 vcc, 4, v34
s_nop 1
v_cndmask_b32 v44, 0, v33, vcc
v_cmp_eq_u32 vcc, 5, v34
s_nop 1
v_cndmask_b32 v45, 0, v33, vcc
v_cmp_eq_u32 vcc, 6, v34
s_nop 1
v_cndmask_b32 v46, 0, v33, vcc
v_cmp_eq_u32 vcc, 7, v34
s_nop 1
v_cndmask_b32 v47, 0, v33, vcc
v_lshlrev_b32 v39, 5, v2
v_lshl_add_u32 v39, v3, 3, v39
v_lshlrev_b32 v2, 4, v2
s_mul_i32 s48, s41, 21504
s_add_u32 s48, s48, 4096
v_mov_b32 v36, s48
v_lshl_add_u32 v38, v3, 2, v36
s_lshl_b32 s36, s41, 10
s_lshl_b32 s35, s55, 2
s_sub_u32 s35, s36, s35
v_mov_b32 v7, s35
v_lshlrev_b32 v35, 4, v1
v_add_u32 v68, s48, v35
v_add_u32 v35, s36, v35
v_lshlrev_b32 v33, 2, v1
v_mov_b32 v72, 0xffff
v_mov_b32 v73, 0xffff
v_mov_b32 v74, 0xffff
v_mov_b32 v75, 0xffff
v_cmp_gt_u32 vcc, s54, v33
v_mov_b32 v48, 0
s_nop 0
v_cndmask_b32 v18, 0, v16, vcc
v_add_u32 v33, 1, v33
v_cmp_gt_u32 vcc, s54, v33
v_mov_b32 v49, 0
s_nop 0
v_cndmask_b32 v19, 0, v16, vcc
v_add_u32 v33, 1, v33
v_cmp_gt_u32 vcc, s54, v33
v_mov_b32 v50, 0
s_nop 0
v_cndmask_b32 v20, 0, v16, vcc
v_add_u32 v33, 1, v33
v_cmp_gt_u32 vcc, s54, v33
v_mov_b32 v51, 0
s_nop 0
v_cndmask_b32 v21, 0, v16, vcc
LE_pass:
ds_write_b128 v35, v[48:51]
ds_write_b128 v68, v[72:75] offset:0
ds_write_b128 v68, v[72:75] offset:1024
ds_write_b128 v68, v[72:75] offset:2048
ds_write_b128 v68, v[72:75] offset:3072
ds_write_b128 v68, v[72:75] offset:4096
ds_write_b128 v68, v[72:75] offset:5120
ds_write_b128 v68, v[72:75] offset:6144
ds_write_b128 v68, v[72:75] offset:7168
ds_write_b128 v68, v[72:75] offset:8192
ds_write_b128 v68, v[72:75] offset:9216
ds_write_b128 v68, v[72:75] offset:10240
ds_write_b128 v68, v[72:75] offset:11264
ds_write_b128 v68, v[72:75] offset:12288
ds_write_b128 v68, v[72:75] offset:13312
ds_write_b128 v68, v[72:75] offset:14336
ds_write_b128 v68, v[72:75] offset:15360
ds_write_b128 v68, v[72:75] offset:16384
ds_write_b128 v68, v[72:75] offset:17408
ds_write_b128 v68, v[72:75] offset:18432
ds_write_b128 v68, v[72:75] offset:19456
v_lshl_add_u32 v32, v1, 2, v36
ds_write_b32 v32, v48 offset:20480
s_waitcnt vmcnt(16)
v_sub_u32 v32, v4, v5
s_waitcnt vmcnt(15)
v_cmpx_lt_i32 vcc, 0, v32
s_cbranch_execz LE_c
v_mad_u32_u16 v128, v192, 1, v7 op_sel:[1,0,0,0]
ds_add_u32 v128, v16
v_cmpx_lt_i32 vcc, 1, v32
v_mad_u32_u16 v129, v193, 1, v7 op_sel:[1,0,0,0]
ds_add_u32 v129, v16
v_cmpx_lt_i32 vcc, 2, v32
v_mad_u32_u16 v130, v194, 1, v7 op_sel:[1,0,0,0]
ds_add_u32 v130, v16
v_cmpx_lt_i32 vcc, 3, v32
v_mad_u32_u16 v131, v195, 1, v7 op_sel:[1,0,0,0]
ds_add_u32 v131, v16
s_waitcnt vmcnt(14)
v_cmpx_lt_i32 vcc, 16, v32
s_cbranch_execz LE_c
v_mad_u32_u16 v132, v196, 1, v7 op_sel:[1,0,0,0]
ds_add_u32 v132, v16
v_cmpx_lt_i32 vcc, 17, v32
v_mad_u32_u16 v133, v197, 1, v7 op_sel:[1,0,0,0]
ds_add_u32 v133, v16
v_cmpx_lt_i32 vcc, 18, v32
v_mad_u32_u16 v134, v198, 1, v7 op_sel:[1,0,0,0]
ds_add_u32 v134, v16
v_cmpx_lt_i32 vcc, 19, v32
v_mad_u32_u16 v135, v199, 1, v7 op_sel:[1,0,0,0]
ds_add_u32 v135, v16
s_waitcnt vmcnt(13)
v_cmpx_lt_i32 vcc, 32, v32
s_cbranch_execz LE_c
v_mad_u32_u16 v136, v200, 1, v7 op_sel:[1,0,0,0]
ds_add_u32 v136, v16
v_cmpx_lt_i32 vcc, 33, v32
v_mad_u32_u16 v137, v201, 1, v7 op_sel:[1,0,0,0]
ds_add_u32 v137, v16
v_cmpx_lt_i32 vcc, 34, v32
v_mad_u32_u16 v138, v202, 1, v7 op_sel:[1,0,0,0]
ds_add_u32 v138, v16
v_cmpx_lt_i32 vcc, 35, v32
v_mad_u32_u16 v139, v203, 1, v7 op_sel:[1,0,0,0]
ds_add_u32 v139, v16
s_waitcnt vmcnt(12)
v_cmpx_lt_i32 vcc, 48, v32
s_cbranch_execz LE_c
v_mad_u32_u16 v140, v204, 1, v7 op_sel:[1,0,0,0]
ds_add_u32 v140, v16
v_cmpx_lt_i32 vcc, 49, v32
v_mad_u32_u16 v141, v205, 1, v7 op_sel:[1,0,0,0]
ds_add_u32 v141, v16
v_cmpx_lt_i32 vcc, 50, v32
v_mad_u32_u16 v142, v206, 1, v7 op_sel:[1,0,0,0]
ds_add_u32 v142, v16
v_cmpx_lt_i32 vcc, 51, v32
v_mad_u32_u16 v143, v207, 1, v7 op_sel:[1,0,0,0]
ds_add_u32 v143, v16
s_waitcnt vmcnt(11)
v_cmpx_lt_i32 vcc, 64, v32
s_cbranch_execz LE_c
v_mad_u32_u16 v144, v208, 1, v7 op_sel:[1,0,0,0]
ds_add_u32 v144, v16
v_cmpx_lt_i32 vcc, 65, v32
v_mad_u32_u16 v145, v209, 1, v7 op_sel:[1,0,0,0]
ds_add_u32 v145, v16
v_cmpx_lt_i32 vcc, 66, v32
v_mad_u32_u16 v146, v210, 1, v7 op_sel:[1,0,0,0]
ds_add_u32 v146, v16
v_cmpx_lt_i32 vcc, 67, v32
v_mad_u32_u16 v147, v211, 1, v7 op_sel:[1,0,0,0]
ds_add_u32 v147, v16
s_waitcnt vmcnt(10)
v_cmpx_lt_i32 vcc, 80, v32
s_cbranch_execz LE_c
v_mad_u32_u16 v148, v212, 1, v7 op_sel:[1,0,0,0]
ds_add_u32 v148, v16
v_cmpx_lt_i32 vcc, 81, v32
v_mad_u32_u16 v149, v213, 1, v7 op_sel:[1,0,0,0]
ds_add_u32 v149, v16
v_cmpx_lt_i32 vcc, 82, v32
v_mad_u32_u16 v150, v214, 1, v7 op_sel:[1,0,0,0]
ds_add_u32 v150, v16
v_cmpx_lt_i32 vcc, 83, v32
v_mad_u32_u16 v151, v215, 1, v7 op_sel:[1,0,0,0]
ds_add_u32 v151, v16
s_waitcnt vmcnt(9)
v_cmpx_lt_i32 vcc, 96, v32
s_cbranch_execz LE_c
v_mad_u32_u16 v152, v216, 1, v7 op_sel:[1,0,0,0]
ds_add_u32 v152, v16
v_cmpx_lt_i32 vcc, 97, v32
v_mad_u32_u16 v153, v217, 1, v7 op_sel:[1,0,0,0]
ds_add_u32 v153, v16
v_cmpx_lt_i32 vcc, 98, v32
v_mad_u32_u16 v154, v218, 1, v7 op_sel:[1,0,0,0]
ds_add_u32 v154, v16
v_cmpx_lt_i32 vcc, 99, v32
v_mad_u32_u16 v155, v219, 1, v7 op_sel:[1,0,0,0]
ds_add_u32 v155, v16
s_waitcnt vmcnt(8)
v_cmpx_lt_i32 vcc, 112, v32
s_cbranch_execz LE_c
v_mad_u32_u16 v156, v220, 1, v7 op_sel:[1,0,0,0]
ds_add_u32 v156, v16
v_cmpx_lt_i32 vcc, 113, v32
v_mad_u32_u16 v157, v221, 1, v7 op_sel:[1,0,0,0]
ds_add_u32 v157, v16
v_cmpx_lt_i32 vcc, 114, v32
v_mad_u32_u16 v158, v222, 1, v7 op_sel:[1,0,0,0]
ds_add_u32 v158, v16
v_cmpx_lt_i32 vcc, 115, v32
v_mad_u32_u16 v159, v223, 1, v7 op_sel:[1,0,0,0]
ds_add_u32 v159, v16
s_waitcnt vmcnt(7)
v_cmpx_lt_i32 vcc, 128, v32
s_cbranch_execz LE_c
v_mad_u32_u16 v160, v224, 1, v7 op_sel:[1,0,0,0]
ds_add_u32 v160, v16
v_cmpx_lt_i32 vcc, 129, v32
v_mad_u32_u16 v161, v225, 1, v7 op_sel:[1,0,0,0]
ds_add_u32 v161, v16
v_cmpx_lt_i32 vcc, 130, v32
v_mad_u32_u16 v162, v226, 1, v7 op_sel:[1,0,0,0]
ds_add_u32 v162, v16
v_cmpx_lt_i32 vcc, 131, v32
v_mad_u32_u16 v163, v227, 1, v7 op_sel:[1,0,0,0]
ds_add_u32 v163, v16
s_waitcnt vmcnt(6)
v_cmpx_lt_i32 vcc, 144, v32
s_cbranch_execz LE_c
v_mad_u32_u16 v164, v228, 1, v7 op_sel:[1,0,0,0]
ds_add_u32 v164, v16
v_cmpx_lt_i32 vcc, 145, v32
v_mad_u32_u16 v165, v229, 1, v7 op_sel:[1,0,0,0]
ds_add_u32 v165, v16
v_cmpx_lt_i32 vcc, 146, v32
v_mad_u32_u16 v166, v230, 1, v7 op_sel:[1,0,0,0]
ds_add_u32 v166, v16
v_cmpx_lt_i32 vcc, 147, v32
v_mad_u32_u16 v167, v231, 1, v7 op_sel:[1,0,0,0]
ds_add_u32 v167, v16
s_waitcnt vmcnt(5)
v_cmpx_lt_i32 vcc, 160, v32
s_cbranch_execz LE_c
v_mad_u32_u16 v168, v232, 1, v7 op_sel:[1,0,0,0]
ds_add_u32 v168, v16
v_cmpx_lt_i32 vcc, 161, v32
v_mad_u32_u16 v169, v233, 1, v7 op_sel:[1,0,0,0]
ds_add_u32 v169, v16
v_cmpx_lt_i32 vcc, 162, v32
v_mad_u32_u16 v170, v234, 1, v7 op_sel:[1,0,0,0]
ds_add_u32 v170, v16
v_cmpx_lt_i32 vcc, 163, v32
v_mad_u32_u16 v171, v235, 1, v7 op_sel:[1,0,0,0]
ds_add_u32 v171, v16
s_waitcnt vmcnt(4)
v_cmpx_lt_i32 vcc, 176, v32
s_cbranch_execz LE_c
v_mad_u32_u16 v172, v236, 1, v7 op_sel:[1,0,0,0]
ds_add_u32 v172, v16
v_cmpx_lt_i32 vcc, 177, v32
v_mad_u32_u16 v173, v237, 1, v7 op_sel:[1,0,0,0]
ds_add_u32 v173, v16
v_cmpx_lt_i32 vcc, 178, v32
v_mad_u32_u16 v174, v238, 1, v7 op_sel:[1,0,0,0]
ds_add_u32 v174, v16
v_cmpx_lt_i32 vcc, 179, v32
v_mad_u32_u16 v175, v239, 1, v7 op_sel:[1,0,0,0]
ds_add_u32 v175, v16
s_waitcnt vmcnt(3)
v_cmpx_lt_i32 vcc, 192, v32
s_cbranch_execz LE_c
v_mad_u32_u16 v176, v240, 1, v7 op_sel:[1,0,0,0]
ds_add_u32 v176, v16
v_cmpx_lt_i32 vcc, 193, v32
v_mad_u32_u16 v177, v241, 1, v7 op_sel:[1,0,0,0]
ds_add_u32 v177, v16
v_cmpx_lt_i32 vcc, 194, v32
v_mad_u32_u16 v178, v242, 1, v7 op_sel:[1,0,0,0]
ds_add_u32 v178, v16
v_cmpx_lt_i32 vcc, 195, v32
v_mad_u32_u16 v179, v243, 1, v7 op_sel:[1,0,0,0]
ds_add_u32 v179, v16
s_waitcnt vmcnt(2)
v_cmpx_lt_i32 vcc, 208, v32
s_cbranch_execz LE_c
v_mad_u32_u16 v180, v244, 1, v7 op_sel:[1,0,0,0]
ds_add_u32 v180, v16
v_cmpx_lt_i32 vcc, 209, v32
v_mad_u32_u16 v181, v245, 1, v7 op_sel:[1,0,0,0]
ds_add_u32 v181, v16
v_cmpx_lt_i32 vcc, 210, v32
v_mad_u32_u16 v182, v246, 1, v7 op_sel:[1,0,0,0]
ds_add_u32 v182, v16
v_cmpx_lt_i32 vcc, 211, v32
v_mad_u32_u16 v183, v247, 1, v7 op_sel:[1,0,0,0]
ds_add_u32 v183, v16
s_waitcnt vmcnt(1)
v_cmpx_lt_i32 vcc, 224, v32
s_cbranch_execz LE_c
v_mad_u32_u16 v184, v248, 1, v7 op_sel:[1,0,0,0]
ds_add_u32 v184, v16
v_cmpx_lt_i32 vcc, 225, v32
v_mad_u32_u16 v185, v249, 1, v7 op_sel:[1,0,0,0]
ds_add_u32 v185, v16
v_cmpx_lt_i32 vcc, 226, v32
v_mad_u32_u16 v186, v250, 1, v7 op_sel:[1,0,0,0]
ds_add_u32 v186, v16
v_cmpx_lt_i32 vcc, 227, v32
v_mad_u32_u16 v187, v251, 1, v7 op_sel:[1,0,0,0]
ds_add_u32 v187, v16
s_waitcnt vmcnt(0)
v_cmpx_lt_i32 vcc, 240, v32
s_cbranch_execz LE_c
v_mad_u32_u16 v188, v252, 1, v7 op_sel:[1,0,0,0]
ds_add_u32 v188, v16
v_cmpx_lt_i32 vcc, 241, v32
v_mad_u32_u16 v189, v253, 1, v7 op_sel:[1,0,0,0]
ds_add_u32 v189, v16
v_cmpx_lt_i32 vcc, 242, v32
v_mad_u32_u16 v190, v254, 1, v7 op_sel:[1,0,0,0]
ds_add_u32 v190, v16
v_cmpx_lt_i32 vcc, 243, v32
v_mad_u32_u16 v191, v255, 1, v7 op_sel:[1,0,0,0]
ds_add_u32 v191, v16
LE_c:
s_mov_b64 exec, -1
ds_read_b128 v[24:27], v35
s_waitcnt lgkmcnt(0)
v_add_u32 v24, 3, v24
v_lshrrev_b32 v24, 2, v24
v_max_u32 v24, v24, v18
v_add_u32 v25, 3, v25
v_lshrrev_b32 v25, 2, v25
v_max_u32 v25, v25, v19
v_add_u32 v26, 3, v26
v_lshrrev_b32 v26, 2, v26
v_max_u32 v26, v26, v20
v_add_u32 v27, 3, v27
v_lshrrev_b32 v27, 2, v27
v_max_u32 v27, v27, v21
v_add_u32 v33, v24, v25
v_add3_u32 v33, v33, v26, v27
v_mov_b32 v64, v33
s_nop 1
v_add_u32_dpp v64, v64, v64 row_shr:1 row_mask:0xf bank_mask:0xf
s_nop 1
v_add_u32_dpp v64, v64, v64 row_shr:2 row_mask:0xf bank_mask:0xf
s_nop 1
v_add_u32_dpp v64, v64, v64 row_shr:4 row_mask:0xf bank_mask:0xf
s_nop 1
v_add_u32_dpp v64, v64, v64 row_shr:8 row_mask:0xf bank_mask:0xf
s_nop 1
v_add_u32_dpp v64, v64, v64 row_bcast:15 row_mask:0xa bank_mask:0xf
s_nop 1
v_add_u32_dpp v64, v64, v64 row_bcast:31 row_mask:0xc bank_mask:0xf
s_nop 1
v_readlane_b32 s44, v64, 63
v_sub_u32 v28, v64, v33
v_add_u32 v29, v28, v24
v_add_u32 v30, v29, v25
v_add_u32 v31, v30, v26
v_add3_u32 v33, v28, v24, -1
v_lshlrev_b32 v34, v33, v18
v_lshrrev_b32 v33, 5, v33
v_lshl_add_u32 v33, v33, 2, v36
ds_or_b32 v33, v34 offset:20480
v_lshl_add_u32 v28, v28, 4, v36
v_add3_u32 v33, v29, v25, -1
v_lshlrev_b32 v34, v33, v19
v_lshrrev_b32 v33, 5, v33
v_lshl_add_u32 v33, v33, 2, v36
ds_or_b32 v33, v34 offset:20480
v_lshl_add_u32 v29, v29, 4, v36
v_add3_u32 v33, v30, v26, -1
v_lshlrev_b32 v34, v33, v20
v_lshrrev_b32 v33, 5, v33
v_lshl_add_u32 v33, v33, 2, v36
ds_or_b32 v33, v34 offset:20480
v_lshl_add_u32 v30, v30, 4, v36
v_add3_u32 v33, v31, v27, -1
v_lshlrev_b32 v34, v33, v21
v_lshrrev_b32 v33, 5, v33
v_lshl_add_u32 v33, v33, 2, v36
ds_or_b32 v33, v34 offset:20480
v_lshl_add_u32 v31, v31, 4, v36
ds_write_b128 v35, v[28:31]
s_add_u32 s44, s44, 31
s_lshr_b32 s44, s44, 5
v_cmpx_lt_i32 vcc, 0, v32
s_cbranch_execz LE_p
ds_add_rtn_u32 v128, v128, v17
v_cmpx_lt_i32 vcc, 1, v32
ds_add_rtn_u32 v129, v129, v17
v_cmpx_lt_i32 vcc, 2, v32
ds_add_rtn_u32 v130, v130, v17
v_cmpx_lt_i32 vcc, 3, v32
ds_add_rtn_u32 v131, v131, v17
v_cmpx_lt_i32 vcc, 16, v32
s_cbranch_execz LE_p
ds_add_rtn_u32 v132, v132, v17
v_cmpx_lt_i32 vcc, 17, v32
ds_add_rtn_u32 v133, v133, v17
v_cmpx_lt_i32 vcc, 18, v32
ds_add_rtn_u32 v134, v134, v17
v_cmpx_lt_i32 vcc, 19, v32
ds_add_rtn_u32 v135, v135, v17
v_cmpx_lt_i32 vcc, 32, v32
s_cbranch_execz LE_p
ds_add_rtn_u32 v136, v136, v17
v_cmpx_lt_i32 vcc, 33, v32
ds_add_rtn_u32 v137, v137, v17
v_cmpx_lt_i32 vcc, 34, v32
ds_add_rtn_u32 v138, v138, v17
v_cmpx_lt_i32 vcc, 35, v32
ds_add_rtn_u32 v139, v139, v17
v_cmpx_lt_i32 vcc, 48, v32
s_cbranch_execz LE_p
ds_add_rtn_u32 v140, v140, v17
v_cmpx_lt_i32 vcc, 49, v32
ds_add_rtn_u32 v141, v141, v17
v_cmpx_lt_i32 vcc, 50, v32
ds_add_rtn_u32 v142, v142, v17
v_cmpx_lt_i32 vcc, 51, v32
ds_add_rtn_u32 v143, v143, v17
v_cmpx_lt_i32 vcc, 64, v32
s_cbranch_execz LE_p
ds_add_rtn_u32 v144, v144, v17
v_cmpx_lt_i32 vcc, 65, v32
ds_add_rtn_u32 v145, v145, v17
v_cmpx_lt_i32 vcc, 66, v32
ds_add_rtn_u32 v146, v146, v17
v_cmpx_lt_i32 vcc, 67, v32
ds_add_rtn_u32 v147, v147, v17
v_cmpx_lt_i32 vcc, 80, v32
s_cbranch_execz LE_p
ds_add_rtn_u32 v148, v148, v17
v_cmpx_lt_i32 vcc, 81, v32
ds_add_rtn_u32 v149, v149, v17
v_cmpx_lt_i32 vcc, 82, v32
ds_add_rtn_u32 v150, v150, v17
v_cmpx_lt_i32 vcc, 83, v32
ds_add_rtn_u32 v151, v151, v17
v_cmpx_lt_i32 vcc, 96, v32
s_cbranch_execz LE_p
ds_add_rtn_u32 v152, v152, v17
v_cmpx_lt_i32 vcc, 97, v32
ds_add_rtn_u32 v153, v153, v17
v_cmpx_lt_i32 vcc, 98, v32
ds_add_rtn_u32 v154, v154, v17
v_cmpx_lt_i32 vcc, 99, v32
ds_add_rtn_u32 v155, v155, v17
v_cmpx_lt_i32 vcc, 112, v32
s_cbranch_execz LE_p
ds_add_rtn_u32 v156, v156, v17
v_cmpx_lt_i32 vcc, 113, v32
ds_add_rtn_u32 v157, v157, v17
v_cmpx_lt_i32 vcc, 114, v32
ds_add_rtn_u32 v158, v158, v17
v_cmpx_lt_i32 vcc, 115, v32
ds_add_rtn_u32 v159, v159, v17
v_cmpx_lt_i32 vcc, 128, v32
s_cbranch_execz LE_p
ds_add_rtn_u32 v160, v160, v17
v_cmpx_lt_i32 vcc, 129, v32
ds_add_rtn_u32 v161, v161, v17
v_cmpx_lt_i32 vcc, 130, v32
ds_add_rtn_u32 v162, v162, v17
v_cmpx_lt_i32 vcc, 131, v32
ds_add_rtn_u32 v163, v163, v17
v_cmpx_lt_i32 vcc, 144, v32
s_cbranch_execz LE_p
ds_add_rtn_u32 v164, v164, v17
v_cmpx_lt_i32 vcc, 145, v32
ds_add_rtn_u32 v165, v165, v17
v_cmpx_lt_i32 vcc, 146, v32
ds_add_rtn_u32 v166, v166, v17
v_cmpx_lt_i32 vcc, 147, v32
ds_add_rtn_u32 v167, v167, v17
v_cmpx_lt_i32 vcc, 160, v32
s_cbranch_execz LE_p
ds_add_rtn_u32 v168, v168, v17
v_cmpx_lt_i32 vcc, 161, v32
ds_add_rtn_u32 v169, v169, v17
v_cmpx_lt_i32 vcc, 162, v32
ds_add_rtn_u32 v170, v170, v17
v_cmpx_lt_i32 vcc, 163, v32
ds_add_rtn_u32 v171, v171, v17
v_cmpx_lt_i32 vcc, 176, v32
s_cbranch_execz LE_p
ds_add_rtn_u32 v172, v172, v17
v_cmpx_lt_i32 vcc, 177, v32
ds_add_rtn_u32 v173, v173, v17
v_cmpx_lt_i32 vcc, 178, v32
ds_add_rtn_u32 v174, v174, v17
v_cmpx_lt_i32 vcc, 179, v32
ds_add_rtn_u32 v175, v175, v17
v_cmpx_lt_i32 vcc, 192, v32
s_cbranch_execz LE_p
ds_add_rtn_u32 v176, v176, v17
v_cmpx_lt_i32 vcc, 193, v32
ds_add_rtn_u32 v177, v177, v17
v_cmpx_lt_i32 vcc, 194, v32
ds_add_rtn_u32 v178, v178, v17
v_cmpx_lt_i32 vcc, 195, v32
ds_add_rtn_u32 v179, v179, v17
v_cmpx_lt_i32 vcc, 208, v32
s_cbranch_execz LE_p
ds_add_rtn_u32 v180, v180, v17
v_cmpx_lt_i32 vcc, 209, v32
ds_add_rtn_u32 v181, v181, v17
v_cmpx_lt_i32 vcc, 210, v32
ds_add_rtn_u32 v182, v182, v17
v_cmpx_lt_i32 vcc, 211, v32
ds_add_rtn_u32 v183, v183, v17
v_cmpx_lt_i32 vcc, 224, v32
s_cbranch_execz LE_p
ds_add_rtn_u32 v184, v184, v17
v_cmpx_lt_i32 vcc, 225, v32
ds_add_rtn_u32 v185, v185, v17
v_cmpx_lt_i32 vcc, 226, v32
ds_add_rtn_u32 v186, v186, v17
v_cmpx_lt_i32 vcc, 227, v32
ds_add_rtn_u32 v187, v187, v17
v_cmpx_lt_i32 vcc, 240, v32
s_cbranch_execz LE_p
ds_add_rtn_u32 v188, v188, v17
v_cmpx_lt_i32 vcc, 241, v32
ds_add_rtn_u32 v189, v189, v17
v_cmpx_lt_i32 vcc, 242, v32
ds_add_rtn_u32 v190, v190, v17
v_cmpx_lt_i32 vcc, 243, v32
ds_add_rtn_u32 v191, v191, v17
LE_p:
s_mov_b64 exec, -1
v_lshl_add_u32 v33, v1, 2, v36
ds_read_b32 v37, v33 offset:20480
s_waitcnt lgkmcnt(0)
v_cmpx_lt_i32 vcc, 0, v32
s_cbranch_execz LE_w
ds_write_b32 v128, v192
v_cmpx_lt_i32 vcc, 1, v32
ds_write_b32 v129, v193
v_cmpx_lt_i32 vcc, 2, v32
ds_write_b32 v130, v194
v_cmpx_lt_i32 vcc, 3, v32
ds_write_b32 v131, v195
v_cmpx_lt_i32 vcc, 16, v32
s_cbranch_execz LE_w
ds_write_b32 v132, v196
v_cmpx_lt_i32 vcc, 17, v32
ds_write_b32 v133, v197
v_cmpx_lt_i32 vcc, 18, v32
ds_write_b32 v134, v198
v_cmpx_lt_i32 vcc, 19, v32
ds_write_b32 v135, v199
v_cmpx_lt_i32 vcc, 32, v32
s_cbranch_execz LE_w
ds_write_b32 v136, v200
v_cmpx_lt_i32 vcc, 33, v32
ds_write_b32 v137, v201
v_cmpx_lt_i32 vcc, 34, v32
ds_write_b32 v138, v202
v_cmpx_lt_i32 vcc, 35, v32
ds_write_b32 v139, v203
v_cmpx_lt_i32 vcc, 48, v32
s_cbranch_execz LE_w
ds_write_b32 v140, v204
v_cmpx_lt_i32 vcc, 49, v32
ds_write_b32 v141, v205
v_cmpx_lt_i32 vcc, 50, v32
ds_write_b32 v142, v206
v_cmpx_lt_i32 vcc, 51, v32
ds_write_b32 v143, v207
v_cmpx_lt_i32 vcc, 64, v32
s_cbranch_execz LE_w
ds_write_b32 v144, v208
v_cmpx_lt_i32 vcc, 65, v32
ds_write_b32 v145, v209
v_cmpx_lt_i32 vcc, 66, v32
ds_write_b32 v146, v210
v_cmpx_lt_i32 vcc, 67, v32
ds_write_b32 v147, v211
v_cmpx_lt_i32 vcc, 80, v32
s_cbranch_execz LE_w
ds_write_b32 v148, v212
v_cmpx_lt_i32 vcc, 81, v32
ds_write_b32 v149, v213
v_cmpx_lt_i32 vcc, 82, v32
ds_write_b32 v150, v214
v_cmpx_lt_i32 vcc, 83, v32
ds_write_b32 v151, v215
v_cmpx_lt_i32 vcc, 96, v32
s_cbranch_execz LE_w
ds_write_b32 v152, v216
v_cmpx_lt_i32 vcc, 97, v32
ds_write_b32 v153, v217
v_cmpx_lt_i32 vcc, 98, v32
ds_write_b32 v154, v218
v_cmpx_lt_i32 vcc, 99, v32
ds_write_b32 v155, v219
v_cmpx_lt_i32 vcc, 112, v32
s_cbranch_execz LE_w
ds_write_b32 v156, v220
v_cmpx_lt_i32 vcc, 113, v32
ds_write_b32 v157, v221
v_cmpx_lt_i32 vcc, 114, v32
ds_write_b32 v158, v222
v_cmpx_lt_i32 vcc, 115, v32
ds_write_b32 v159, v223
v_cmpx_lt_i32 vcc, 128, v32
s_cbranch_execz LE_w
ds_write_b32 v160, v224
v_cmpx_lt_i32 vcc, 129, v32
ds_write_b32 v161, v225
v_cmpx_lt_i32 vcc, 130, v32
ds_write_b32 v162, v226
v_cmpx_lt_i32 vcc, 131, v32
ds_write_b32 v163, v227
v_cmpx_lt_i32 vcc, 144, v32
s_cbranch_execz LE_w
ds_write_b32 v164, v228
v_cmpx_lt_i32 vcc, 145, v32
ds_write_b32 v165, v229
v_cmpx_lt_i32 vcc, 146, v32
ds_write_b32 v166, v230
v_cmpx_lt_i32 vcc, 147, v32
ds_write_b32 v167, v231
v_cmpx_lt_i32 vcc, 160, v32
s_cbranch_execz LE_w
ds_write_b32 v168, v232
v_cmpx_lt_i32 vcc, 161, v32
ds_write_b32 v169, v233
v_cmpx_lt_i32 vcc, 162, v32
ds_write_b32 v170, v234
v_cmpx_lt_i32 vcc, 163, v32
ds_write_b32 v171, v235
v_cmpx_lt_i32 vcc, 176, v32
s_cbranch_execz LE_w
ds_write_b32 v172, v236
v_cmpx_lt_i32 vcc, 177, v32
ds_write_b32 v173, v237
v_cmpx_lt_i32 vcc, 178, v32
ds_write_b32 v174, v238
v_cmpx_lt_i32 vcc, 179, v32
ds_write_b32 v175, v239
v_cmpx_lt_i32 vcc, 192, v32
s_cbranch_execz LE_w
ds_write_b32 v176, v240
v_cmpx_lt_i32 vcc, 193, v32
ds_write_b32 v177, v241
v_cmpx_lt_i32 vcc, 194, v32
ds_write_b32 v178, v242
v_cmpx_lt_i32 vcc, 195, v32
ds_write_b32 v179, v243
v_cmpx_lt_i32 vcc, 208, v32
s_cbranch_execz LE_w
ds_write_b32 v180, v244
v_cmpx_lt_i32 vcc, 209, v32
ds_write_b32 v181, v245
v_cmpx_lt_i32 vcc, 210, v32
ds_write_b32 v182, v246
v_cmpx_lt_i32 vcc, 211, v32
ds_write_b32 v183, v247
v_cmpx_lt_i32 vcc, 224, v32
s_cbranch_execz LE_w
ds_write_b32 v184, v248
v_cmpx_lt_i32 vcc, 225, v32
ds_write_b32 v185, v249
v_cmpx_lt_i32 vcc, 226, v32
ds_write_b32 v186, v250
v_cmpx_lt_i32 vcc, 227, v32
ds_write_b32 v187, v251
v_cmpx_lt_i32 vcc, 240, v32
s_cbranch_execz LE_w
ds_write_b32 v188, v252
v_cmpx_lt_i32 vcc, 241, v32
ds_write_b32 v189, v253
v_cmpx_lt_i32 vcc, 242, v32
ds_write_b32 v190, v254
v_cmpx_lt_i32 vcc, 243, v32
ds_write_b32 v191, v255
LE_w:
s_mov_b64 exec, -1
s_add_u32 s8, s4, 0x7c2a000
s_addc_u32 s9, s5, 0
s_mov_b32 s10, 0x8000
s_mov_b32 s11, 0x00020000
v_and_b32 v200, 63, v0
v_lshlrev_b32 v200, 7, v200
s_mov_b32 s91, 8192
s_mov_b32 s90, 16384
s_mov_b32 s95, 24576
s_mov_b32 s94, 0x10000
LE_poll:
buffer_load_dwordx2 v[192:193], v200, s[8:11], 0 offen sc1
buffer_load_dwordx2 v[194:195], v200, s[8:11], s91 offen sc1
buffer_load_dwordx2 v[196:197], v200, s[8:11], s90 offen sc1
buffer_load_dwordx2 v[198:199], v200, s[8:11], s95 offen sc1
s_sub_u32 s94, s94, 1
s_waitcnt vmcnt(0)
s_cbranch_scc1 LE_poll_go
v_cmp_ne_u64 vcc, s[98:99], v[192:193]
s_nop 1
s_cbranch_vccnz LE_poll
v_cmp_ne_u64 vcc, s[98:99], v[194:195]
s_nop 1
s_cbranch_vccnz LE_poll
v_cmp_ne_u64 vcc, s[98:99], v[196:197]
s_nop 1
s_cbranch_vccnz LE_poll
v_cmp_ne_u64 vcc, s[98:99], v[198:199]
s_nop 1
s_cbranch_vccnz LE_poll
LE_poll_go:
s_cmp_lg_u32 s40, 0
s_cbranch_scc1 LE_nobump
s_mov_b32 s90, 89984
s_mov_b32 s10, 90112
v_lshlrev_b32 v196, 4, v1
v_mov_b32 v192, s98
v_mov_b32 v193, s99
v_mov_b32 v194, s98
v_mov_b32 v195, s99
s_mov_b64 exec, 0xff
buffer_store_dwordx4 v[192:195], v196, s[8:11], s90 offen sc1
s_mov_b64 exec, -1
LE_nobump:
v_mov_b32 v34, v38
ds_read2_b32 v[52:53], v34 offset0:0 offset1:4
ds_read2_b32 v[54:55], v34 offset0:8 offset1:12
s_waitcnt lgkmcnt(0)
ds_read2_b32 v[56:57], v34 offset0:16 offset1:20
ds_read2_b32 v[58:59], v34 offset0:24 offset1:28
v_mad_u32_u16 v60, v52, s49, v2
v_mad_u32_u16 v61, v53, s49, v2
v_mad_u32_u16 v62, v54, s49, v2
v_mad_u32_u16 v63, v55, s49, v2
buffer_load_dwordx4 a[0:3], v60, s[16:19], 0 offen sc1
buffer_load_dwordx4 a[4:7], v60, s[16:19], 0 offen offset:256 sc1
buffer_load_dwordx4 a[8:11], v61, s[16:19], 0 offen sc1
buffer_load_dwordx4 a[12:15], v61, s[16:19], 0 offen offset:256 sc1
buffer_load_dwordx4 a[16:19], v62, s[16:19], 0 offen sc1
buffer_load_dwordx4 a[20:23], v62, s[16:19], 0 offen offset:256 sc1
buffer_load_dwordx4 a[24:27], v63, s[16:19], 0 offen sc1
buffer_load_dwordx4 a[28:31], v63, s[16:19], 0 offen offset:256 sc1
s_waitcnt lgkmcnt(0)
ds_read2_b32 v[52:53], v34 offset0:32 offset1:36
ds_read2_b32 v[54:55], v34 offset0:40 offset1:44
v_mad_u32_u16 v60, v56, s49, v2
v_mad_u32_u16 v61, v57, s49, v2
v_mad_u32_u16 v62, v58, s49, v2
v_mad_u32_u16 v63, v59, s49, v2
buffer_load_dwordx4 a[32:35], v60, s[16:19], 0 offen sc1
buffer_load_dwordx4 a[36:39], v60, s[16:19], 0 offen offset:256 sc1
buffer_load_dwordx4 a[40:43], v61, s[16:19], 0 offen sc1
buffer_load_dwordx4 a[44:47], v61, s[16:19], 0 offen offset:256 sc1
buffer_load_dwordx4 a[48:51], v62, s[16:19], 0 offen sc1
buffer_load_dwordx4 a[52:55], v62, s[16:19], 0 offen offset:256 sc1
buffer_load_dwordx4 a[56:59], v63, s[16:19], 0 offen sc1
buffer_load_dwordx4 a[60:63], v63, s[16:19], 0 offen offset:256 sc1
s_waitcnt lgkmcnt(0)
ds_read2_b32 v[56:57], v34 offset0:48 offset1:52
ds_read2_b32 v[58:59], v34 offset0:56 offset1:60
v_mad_u32_u16 v60, v52, s49, v2
v_mad_u32_u16 v61, v53, s49, v2
v_mad_u32_u16 v62, v54, s49, v2
v_mad_u32_u16 v63, v55, s49, v2
buffer_load_dwordx4 a[64:67], v60, s[16:19], 0 offen sc1
buffer_load_dwordx4 a[68:71], v60, s[16:19], 0 offen offset:256 sc1
buffer_load_dwordx4 a[72:75], v61, s[16:19], 0 offen sc1
buffer_load_dwordx4 a[76:79], v61, s[16:19], 0 offen offset:256 sc1
buffer_load_dwordx4 a[80:83], v62, s[16:19], 0 offen sc1
buffer_load_dwordx4 a[84:87], v62, s[16:19], 0 offen offset:256 sc1
buffer_load_dwordx4 a[88:91], v63, s[16:19], 0 offen sc1
buffer_load_dwordx4 a[92:95], v63, s[16:19], 0 offen offset:256 sc1
s_waitcnt lgkmcnt(0)
ds_read2_b32 v[52:53], v34 offset0:64 offset1:68
ds_read2_b32 v[54:55], v34 offset0:72 offset1:76
v_mad_u32_u16 v60, v56, s49, v2
v_mad_u32_u16 v61, v57, s49, v2
v_mad_u32_u16 v62, v58, s49, v2
v_mad_u32_u16 v63, v59, s49, v2
buffer_load_dwordx4 a[96:99], v60, s[16:19], 0 offen sc1
buffer_load_dwordx4 a[100:103], v60, s[16:19], 0 offen offset:256 sc1
buffer_load_dwordx4 a[104:107], v61, s[16:19], 0 offen sc1
buffer_load_dwordx4 a[108:111], v61, s[16:19], 0 offen offset:256 sc1
buffer_load_dwordx4 a[112:115], v62, s[16:19], 0 offen sc1
buffer_load_dwordx4 a[116:119], v62, s[16:19], 0 offen offset:256 sc1
buffer_load_dwordx4 a[120:123], v63, s[16:19], 0 offen sc1
buffer_load_dwordx4 a[124:127], v63, s[16:19], 0 offen offset:256 sc1
s_waitcnt lgkmcnt(0)
ds_read2_b32 v[56:57], v34 offset0:80 offset1:84
ds_read2_b32 v[58:59], v34 offset0:88 offset1:92
v_mad_u32_u16 v60, v52, s49, v2
v_mad_u32_u16 v61, v53, s49, v2
v_mad_u32_u16 v62, v54, s49, v2
v_mad_u32_u16 v63, v55, s49, v2
buffer_load_dwordx4 a[128:131], v60, s[16:19], 0 offen sc1
buffer_load_dwordx4 a[132:135], v60, s[16:19], 0 offen offset:256 sc1
buffer_load_dwordx4 a[136:139], v61, s[16:19], 0 offen sc1
buffer_load_dwordx4 a[140:143], v61, s[16:19], 0 offen offset:256 sc1
buffer_load_dwordx4 a[144:147], v62, s[16:19], 0 offen sc1
buffer_load_dwordx4 a[148:151], v62, s[16:19], 0 offen offset:256 sc1
buffer_load_dwordx4 a[152:155], v63, s[16:19], 0 offen sc1
buffer_load_dwordx4 a[156:159], v63, s[16:19], 0 offen offset:256 sc1
s_waitcnt lgkmcnt(0)
ds_read2_b32 v[52:53], v34 offset0:96 offset1:100
ds_read2_b32 v[54:55], v34 offset0:104 offset1:108
v_mad_u32_u16 v60, v56, s49, v2
v_mad_u32_u16 v61, v57, s49, v2
v_mad_u32_u16 v62, v58, s49, v2
v_mad_u32_u16 v63, v59, s49, v2
buffer_load_dwordx4 a[160:163], v60, s[16:19], 0 offen sc1
buffer_load_dwordx4 a[164:167], v60, s[16:19], 0 offen offset:256 sc1
buffer_load_dwordx4 a[168:171], v61, s[16:19], 0 offen sc1
buffer_load_dwordx4 a[172:175], v61, s[16:19], 0 offen offset:256 sc1
buffer_load_dwordx4 a[176:179], v62, s[16:19], 0 offen sc1
buffer_load_dwordx4 a[180:183], v62, s[16:19], 0 offen offset:256 sc1
buffer_load_dwordx4 a[184:187], v63, s[16:19], 0 offen sc1
buffer_load_dwordx4 a[188:191], v63, s[16:19], 0 offen offset:256 sc1
s_waitcnt lgkmcnt(0)
ds_read2_b32 v[56:57], v34 offset0:112 offset1:116
ds_read2_b32 v[58:59], v34 offset0:120 offset1:124
v_mad_u32_u16 v60, v52, s49, v2
v_mad_u32_u16 v61, v53, s49, v2
v_mad_u32_u16 v62, v54, s49, v2
v_mad_u32_u16 v63, v55, s49, v2
buffer_load_dwordx4 a[192:195], v60, s[16:19], 0 offen sc1
buffer_load_dwordx4 a[196:199], v60, s[16:19], 0 offen offset:256 sc1
buffer_load_dwordx4 a[200:203], v61, s[16:19], 0 offen sc1
buffer_load_dwordx4 a[204:207], v61, s[16:19], 0 offen offset:256 sc1
buffer_load_dwordx4 a[208:211], v62, s[16:19], 0 offen sc1
buffer_load_dwordx4 a[212:215], v62, s[16:19], 0 offen offset:256 sc1
buffer_load_dwordx4 a[216:219], v63, s[16:19], 0 offen sc1
buffer_load_dwordx4 a[220:223], v63, s[16:19], 0 offen offset:256 sc1
s_waitcnt lgkmcnt(0)
ds_read2_b32 v[52:53], v34 offset0:128 offset1:132
ds_read2_b32 v[54:55], v34 offset0:136 offset1:140
v_mad_u32_u16 v60, v56, s49, v2
v_mad_u32_u16 v61, v57, s49, v2
v_mad_u32_u16 v62, v58, s49, v2
v_mad_u32_u16 v63, v59, s49, v2
buffer_load_dwordx4 a[224:227], v60, s[16:19], 0 offen sc1
buffer_load_dwordx4 a[228:231], v60, s[16:19], 0 offen offset:256 sc1
buffer_load_dwordx4 a[232:235], v61, s[16:19], 0 offen sc1
buffer_load_dwordx4 a[236:239], v61, s[16:19], 0 offen offset:256 sc1
buffer_load_dwordx4 a[240:243], v62, s[16:19], 0 offen sc1
buffer_load_dwordx4 a[244:247], v62, s[16:19], 0 offen offset:256 sc1
buffer_load_dwordx4 a[248:251], v63, s[16:19], 0 offen sc1
buffer_load_dwordx4 a[252:255], v63, s[16:19], 0 offen offset:256 sc1
v_add_u32 v34, 512, v34
s_mov_b32 s45, 0
s_lshl_b32 s47, s55, 9
LE_loop:
v_readlane_b32 s46, v37, s45
s_add_u32 s45, s45, 1
s_waitcnt vmcnt(56)
v_mfma_f32_16x16x32_bf16 v[48:51], a[0:3], v[40:43], v[48:51]
v_mfma_f32_16x16x32_bf16 v[48:51], a[4:7], v[44:47], v[48:51]
s_bitcmp1_b32 s46, 0
s_cbranch_scc0 LE_nf0
s_cmp_eq_u32 s42, 0
s_cbranch_scc1 LE_fl0
buffer_load_dwordx2 v[66:67], v39, s[20:23], s47 offen sc1
s_waitcnt vmcnt(0)
v_lshlrev_b32 v64, 16, v66
v_and_b32 v65, 0xffff0000, v66
v_add_f32 v48, v48, v64
v_add_f32 v49, v49, v65
v_lshlrev_b32 v64, 16, v67
v_and_b32 v65, 0xffff0000, v67
v_add_f32 v50, v50, v64
v_add_f32 v51, v51, v65
LE_fl0:
s_nop 3
v_cvt_pk_bf16_f32 v64, v48, v49
v_cvt_pk_bf16_f32 v65, v50, v51
v_mov_b32 v48, 0
v_mov_b32 v49, 0
v_mov_b32 v50, 0
v_mov_b32 v51, 0
buffer_store_dwordx2 v[64:65], v39, s[20:23], s47 offen sc1
s_add_u32 s47, s47, 512
LE_nf0:
v_mfma_f32_16x16x32_bf16 v[48:51], a[8:11], v[40:43], v[48:51]
v_mfma_f32_16x16x32_bf16 v[48:51], a[12:15], v[44:47], v[48:51]
s_bitcmp1_b32 s46, 1
s_cbranch_scc0 LE_nf1
s_cmp_eq_u32 s42, 0
s_cbranch_scc1 LE_fl1
buffer_load_dwordx2 v[66:67], v39, s[20:23], s47 offen sc1
s_waitcnt vmcnt(0)
v_lshlrev_b32 v64, 16, v66
v_and_b32 v65, 0xffff0000, v66
v_add_f32 v48, v48, v64
v_add_f32 v49, v49, v65
v_lshlrev_b32 v64, 16, v67
v_and_b32 v65, 0xffff0000, v67
v_add_f32 v50, v50, v64
v_add_f32 v51, v51, v65
LE_fl1:
s_nop 3
v_cvt_pk_bf16_f32 v64, v48, v49
v_cvt_pk_bf16_f32 v65, v50, v51
v_mov_b32 v48, 0
v_mov_b32 v49, 0
v_mov_b32 v50, 0
v_mov_b32 v51, 0
buffer_store_dwordx2 v[64:65], v39, s[20:23], s47 offen sc1
s_add_u32 s47, s47, 512
LE_nf1:
v_mfma_f32_16x16x32_bf16 v[48:51], a[16:19], v[40:43], v[48:51]
v_mfma_f32_16x16x32_bf16 v[48:51], a[20:23], v[44:47], v[48:51]
s_bitcmp1_b32 s46, 2
s_cbranch_scc0 LE_nf2
s_cmp_eq_u32 s42, 0
s_cbranch_scc1 LE_fl2
buffer_load_dwordx2 v[66:67], v39, s[20:23], s47 offen sc1
s_waitcnt vmcnt(0)
v_lshlrev_b32 v64, 16, v66
v_and_b32 v65, 0xffff0000, v66
v_add_f32 v48, v48, v64
v_add_f32 v49, v49, v65
v_lshlrev_b32 v64, 16, v67
v_and_b32 v65, 0xffff0000, v67
v_add_f32 v50, v50, v64
v_add_f32 v51, v51, v65
LE_fl2:
s_nop 3
v_cvt_pk_bf16_f32 v64, v48, v49
v_cvt_pk_bf16_f32 v65, v50, v51
v_mov_b32 v48, 0
v_mov_b32 v49, 0
v_mov_b32 v50, 0
v_mov_b32 v51, 0
buffer_store_dwordx2 v[64:65], v39, s[20:23], s47 offen sc1
s_add_u32 s47, s47, 512
LE_nf2:
v_mfma_f32_16x16x32_bf16 v[48:51], a[24:27], v[40:43], v[48:51]
v_mfma_f32_16x16x32_bf16 v[48:51], a[28:31], v[44:47], v[48:51]
s_bitcmp1_b32 s46, 3
s_cbranch_scc0 LE_nf3
s_cmp_eq_u32 s42, 0
s_cbranch_scc1 LE_fl3
buffer_load_dwordx2 v[66:67], v39, s[20:23], s47 offen sc1
s_waitcnt vmcnt(0)
v_lshlrev_b32 v64, 16, v66
v_and_b32 v65, 0xffff0000, v66
v_add_f32 v48, v48, v64
v_add_f32 v49, v49, v65
v_lshlrev_b32 v64, 16, v67
v_and_b32 v65, 0xffff0000, v67
v_add_f32 v50, v50, v64
v_add_f32 v51, v51, v65
LE_fl3:
s_nop 3
v_cvt_pk_bf16_f32 v64, v48, v49
v_cvt_pk_bf16_f32 v65, v50, v51
v_mov_b32 v48, 0
v_mov_b32 v49, 0
v_mov_b32 v50, 0
v_mov_b32 v51, 0
buffer_store_dwordx2 v[64:65], v39, s[20:23], s47 offen sc1
s_add_u32 s47, s47, 512
LE_nf3:
s_waitcnt lgkmcnt(0)
ds_read2_b32 v[56:57], v34 offset0:16 offset1:20
ds_read2_b32 v[58:59], v34 offset0:24 offset1:28
v_mad_u32_u16 v60, v52, s49, v2
v_mad_u32_u16 v61, v53, s49, v2
v_mad_u32_u16 v62, v54, s49, v2
v_mad_u32_u16 v63, v55, s49, v2
buffer_load_dwordx4 a[0:3], v60, s[16:19], 0 offen sc1
buffer_load_dwordx4 a[4:7], v60, s[16:19], 0 offen offset:256 sc1
buffer_load_dwordx4 a[8:11], v61, s[16:19], 0 offen sc1
buffer_load_dwordx4 a[12:15], v61, s[16:19], 0 offen offset:256 sc1
buffer_load_dwordx4 a[16:19], v62, s[16:19], 0 offen sc1
buffer_load_dwordx4 a[20:23], v62, s[16:19], 0 offen offset:256 sc1
buffer_load_dwordx4 a[24:27], v63, s[16:19], 0 offen sc1
buffer_load_dwordx4 a[28:31], v63, s[16:19], 0 offen offset:256 sc1
s_waitcnt vmcnt(56)
v_mfma_f32_16x16x32_bf16 v[48:51], a[32:35], v[40:43], v[48:51]
v_mfma_f32_16x16x32_bf16 v[48:51], a[36:39], v[44:47], v[48:51]
s_bitcmp1_b32 s46, 4
s_cbranch_scc0 LE_nf4
s_cmp_eq_u32 s42, 0
s_cbranch_scc1 LE_fl4
buffer_load_dwordx2 v[66:67], v39, s[20:23], s47 offen sc1
s_waitcnt vmcnt(0)
v_lshlrev_b32 v64, 16, v66
v_and_b32 v65, 0xffff0000, v66
v_add_f32 v48, v48, v64
v_add_f32 v49, v49, v65
v_lshlrev_b32 v64, 16, v67
v_and_b32 v65, 0xffff0000, v67
v_add_f32 v50, v50, v64
v_add_f32 v51, v51, v65
LE_fl4:
s_nop 3
v_cvt_pk_bf16_f32 v64, v48, v49
v_cvt_pk_bf16_f32 v65, v50, v51
v_mov_b32 v48, 0
v_mov_b32 v49, 0
v_mov_b32 v50, 0
v_mov_b32 v51, 0
buffer_store_dwordx2 v[64:65], v39, s[20:23], s47 offen sc1
s_add_u32 s47, s47, 512
LE_nf4:
v_mfma_f32_16x16x32_bf16 v[48:51], a[40:43], v[40:43], v[48:51]
v_mfma_f32_16x16x32_bf16 v[48:51], a[44:47], v[44:47], v[48:51]
s_bitcmp1_b32 s46, 5
s_cbranch_scc0 LE_nf5
s_cmp_eq_u32 s42, 0
s_cbranch_scc1 LE_fl5
buffer_load_dwordx2 v[66:67], v39, s[20:23], s47 offen sc1
s_waitcnt vmcnt(0)
v_lshlrev_b32 v64, 16, v66
v_and_b32 v65, 0xffff0000, v66
v_add_f32 v48, v48, v64
v_add_f32 v49, v49, v65
v_lshlrev_b32 v64, 16, v67
v_and_b32 v65, 0xffff0000, v67
v_add_f32 v50, v50, v64
v_add_f32 v51, v51, v65
LE_fl5:
s_nop 3
v_cvt_pk_bf16_f32 v64, v48, v49
v_cvt_pk_bf16_f32 v65, v50, v51
v_mov_b32 v48, 0
v_mov_b32 v49, 0
v_mov_b32 v50, 0
v_mov_b32 v51, 0
buffer_store_dwordx2 v[64:65], v39, s[20:23], s47 offen sc1
s_add_u32 s47, s47, 512
LE_nf5:
v_mfma_f32_16x16x32_bf16 v[48:51], a[48:51], v[40:43], v[48:51]
v_mfma_f32_16x16x32_bf16 v[48:51], a[52:55], v[44:47], v[48:51]
s_bitcmp1_b32 s46, 6
s_cbranch_scc0 LE_nf6
s_cmp_eq_u32 s42, 0
s_cbranch_scc1 LE_fl6
buffer_load_dwordx2 v[66:67], v39, s[20:23], s47 offen sc1
s_waitcnt vmcnt(0)
v_lshlrev_b32 v64, 16, v66
v_and_b32 v65, 0xffff0000, v66
v_add_f32 v48, v48, v64
v_add_f32 v49, v49, v65
v_lshlrev_b32 v64, 16, v67
v_and_b32 v65, 0xffff0000, v67
v_add_f32 v50, v50, v64
v_add_f32 v51, v51, v65
LE_fl6:
s_nop 3
v_cvt_pk_bf16_f32 v64, v48, v49
v_cvt_pk_bf16_f32 v65, v50, v51
v_mov_b32 v48, 0
v_mov_b32 v49, 0
v_mov_b32 v50, 0
v_mov_b32 v51, 0
buffer_store_dwordx2 v[64:65], v39, s[20:23], s47 offen sc1
s_add_u32 s47, s47, 512
LE_nf6:
v_mfma_f32_16x16x32_bf16 v[48:51], a[56:59], v[40:43], v[48:51]
v_mfma_f32_16x16x32_bf16 v[48:51], a[60:63], v[44:47], v[48:51]
s_bitcmp1_b32 s46, 7
s_cbranch_scc0 LE_nf7
s_cmp_eq_u32 s42, 0
s_cbranch_scc1 LE_fl7
buffer_load_dwordx2 v[66:67], v39, s[20:23], s47 offen sc1
s_waitcnt vmcnt(0)
v_lshlrev_b32 v64, 16, v66
v_and_b32 v65, 0xffff0000, v66
v_add_f32 v48, v48, v64
v_add_f32 v49, v49, v65
v_lshlrev_b32 v64, 16, v67
v_and_b32 v65, 0xffff0000, v67
v_add_f32 v50, v50, v64
v_add_f32 v51, v51, v65
LE_fl7:
s_nop 3
v_cvt_pk_bf16_f32 v64, v48, v49
v_cvt_pk_bf16_f32 v65, v50, v51
v_mov_b32 v48, 0
v_mov_b32 v49, 0
v_mov_b32 v50, 0
v_mov_b32 v51, 0
buffer_store_dwordx2 v[64:65], v39, s[20:23], s47 offen sc1
s_add_u32 s47, s47, 512
LE_nf7:
s_waitcnt lgkmcnt(0)
ds_read2_b32 v[52:53], v34 offset0:32 offset1:36
ds_read2_b32 v[54:55], v34 offset0:40 offset1:44
v_mad_u32_u16 v60, v56, s49, v2
v_mad_u32_u16 v61, v57, s49, v2
v_mad_u32_u16 v62, v58, s49, v2
v_mad_u32_u16 v63, v59, s49, v2
buffer_load_dwordx4 a[32:35], v60, s[16:19], 0 offen sc1
buffer_load_dwordx4 a[36:39], v60, s[16:19], 0 offen offset:256 sc1
buffer_load_dwordx4 a[40:43], v61, s[16:19], 0 offen sc1
buffer_load_dwordx4 a[44:47], v61, s[16:19], 0 offen offset:256 sc1
buffer_load_dwordx4 a[48:51], v62, s[16:19], 0 offen sc1
buffer_load_dwordx4 a[52:55], v62, s[16:19], 0 offen offset:256 sc1
buffer_load_dwordx4 a[56:59], v63, s[16:19], 0 offen sc1
buffer_load_dwordx4 a[60:63], v63, s[16:19], 0 offen offset:256 sc1
s_waitcnt vmcnt(56)
v_mfma_f32_16x16x32_bf16 v[48:51], a[64:67], v[40:43], v[48:51]
v_mfma_f32_16x16x32_bf16 v[48:51], a[68:71], v[44:47], v[48:51]
s_bitcmp1_b32 s46, 8
s_cbranch_scc0 LE_nf8
s_cmp_eq_u32 s42, 0
s_cbranch_scc1 LE_fl8
buffer_load_dwordx2 v[66:67], v39, s[20:23], s47 offen sc1
s_waitcnt vmcnt(0)
v_lshlrev_b32 v64, 16, v66
v_and_b32 v65, 0xffff0000, v66
v_add_f32 v48, v48, v64
v_add_f32 v49, v49, v65
v_lshlrev_b32 v64, 16, v67
v_and_b32 v65, 0xffff0000, v67
v_add_f32 v50, v50, v64
v_add_f32 v51, v51, v65
LE_fl8:
s_nop 3
v_cvt_pk_bf16_f32 v64, v48, v49
v_cvt_pk_bf16_f32 v65, v50, v51
v_mov_b32 v48, 0
v_mov_b32 v49, 0
v_mov_b32 v50, 0
v_mov_b32 v51, 0
buffer_store_dwordx2 v[64:65], v39, s[20:23], s47 offen sc1
s_add_u32 s47, s47, 512
LE_nf8:
v_mfma_f32_16x16x32_bf16 v[48:51], a[72:75], v[40:43], v[48:51]
v_mfma_f32_16x16x32_bf16 v[48:51], a[76:79], v[44:47], v[48:51]
s_bitcmp1_b32 s46, 9
s_cbranch_scc0 LE_nf9
s_cmp_eq_u32 s42, 0
s_cbranch_scc1 LE_fl9
buffer_load_dwordx2 v[66:67], v39, s[20:23], s47 offen sc1
s_waitcnt vmcnt(0)
v_lshlrev_b32 v64, 16, v66
v_and_b32 v65, 0xffff0000, v66
v_add_f32 v48, v48, v64
v_add_f32 v49, v49, v65
v_lshlrev_b32 v64, 16, v67
v_and_b32 v65, 0xffff0000, v67
v_add_f32 v50, v50, v64
v_add_f32 v51, v51, v65
LE_fl9:
s_nop 3
v_cvt_pk_bf16_f32 v64, v48, v49
v_cvt_pk_bf16_f32 v65, v50, v51
v_mov_b32 v48, 0
v_mov_b32 v49, 0
v_mov_b32 v50, 0
v_mov_b32 v51, 0
buffer_store_dwordx2 v[64:65], v39, s[20:23], s47 offen sc1
s_add_u32 s47, s47, 512
LE_nf9:
v_mfma_f32_16x16x32_bf16 v[48:51], a[80:83], v[40:43], v[48:51]
v_mfma_f32_16x16x32_bf16 v[48:51], a[84:87], v[44:47], v[48:51]
s_bitcmp1_b32 s46, 10
s_cbranch_scc0 LE_nf10
s_cmp_eq_u32 s42, 0
s_cbranch_scc1 LE_fl10
buffer_load_dwordx2 v[66:67], v39, s[20:23], s47 offen sc1
s_waitcnt vmcnt(0)
v_lshlrev_b32 v64, 16, v66
v_and_b32 v65, 0xffff0000, v66
v_add_f32 v48, v48, v64
v_add_f32 v49, v49, v65
v_lshlrev_b32 v64, 16, v67
v_and_b32 v65, 0xffff0000, v67
v_add_f32 v50, v50, v64
v_add_f32 v51, v51, v65
LE_fl10:
s_nop 3
v_cvt_pk_bf16_f32 v64, v48, v49
v_cvt_pk_bf16_f32 v65, v50, v51
v_mov_b32 v48, 0
v_mov_b32 v49, 0
v_mov_b32 v50, 0
v_mov_b32 v51, 0
buffer_store_dwordx2 v[64:65], v39, s[20:23], s47 offen sc1
s_add_u32 s47, s47, 512
LE_nf10:
v_mfma_f32_16x16x32_bf16 v[48:51], a[88:91], v[40:43], v[48:51]
v_mfma_f32_16x16x32_bf16 v[48:51], a[92:95], v[44:47], v[48:51]
s_bitcmp1_b32 s46, 11
s_cbranch_scc0 LE_nf11
s_cmp_eq_u32 s42, 0
s_cbranch_scc1 LE_fl11
buffer_load_dwordx2 v[66:67], v39, s[20:23], s47 offen sc1
s_waitcnt vmcnt(0)
v_lshlrev_b32 v64, 16, v66
v_and_b32 v65, 0xffff0000, v66
v_add_f32 v48, v48, v64
v_add_f32 v49, v49, v65
v_lshlrev_b32 v64, 16, v67
v_and_b32 v65, 0xffff0000, v67
v_add_f32 v50, v50, v64
v_add_f32 v51, v51, v65
LE_fl11:
s_nop 3
v_cvt_pk_bf16_f32 v64, v48, v49
v_cvt_pk_bf16_f32 v65, v50, v51
v_mov_b32 v48, 0
v_mov_b32 v49, 0
v_mov_b32 v50, 0
v_mov_b32 v51, 0
buffer_store_dwordx2 v[64:65], v39, s[20:23], s47 offen sc1
s_add_u32 s47, s47, 512
LE_nf11:
s_waitcnt lgkmcnt(0)
ds_read2_b32 v[56:57], v34 offset0:48 offset1:52
ds_read2_b32 v[58:59], v34 offset0:56 offset1:60
v_mad_u32_u16 v60, v52, s49, v2
v_mad_u32_u16 v61, v53, s49, v2
v_mad_u32_u16 v62, v54, s49, v2
v_mad_u32_u16 v63, v55, s49, v2
buffer_load_dwordx4 a[64:67], v60, s[16:19], 0 offen sc1
buffer_load_dwordx4 a[68:71], v60, s[16:19], 0 offen offset:256 sc1
buffer_load_dwordx4 a[72:75], v61, s[16:19], 0 offen sc1
buffer_load_dwordx4 a[76:79], v61, s[16:19], 0 offen offset:256 sc1
buffer_load_dwordx4 a[80:83], v62, s[16:19], 0 offen sc1
buffer_load_dwordx4 a[84:87], v62, s[16:19], 0 offen offset:256 sc1
buffer_load_dwordx4 a[88:91], v63, s[16:19], 0 offen sc1
buffer_load_dwordx4 a[92:95], v63, s[16:19], 0 offen offset:256 sc1
s_waitcnt vmcnt(56)
v_mfma_f32_16x16x32_bf16 v[48:51], a[96:99], v[40:43], v[48:51]
v_mfma_f32_16x16x32_bf16 v[48:51], a[100:103], v[44:47], v[48:51]
s_bitcmp1_b32 s46, 12
s_cbranch_scc0 LE_nf12
s_cmp_eq_u32 s42, 0
s_cbranch_scc1 LE_fl12
buffer_load_dwordx2 v[66:67], v39, s[20:23], s47 offen sc1
s_waitcnt vmcnt(0)
v_lshlrev_b32 v64, 16, v66
v_and_b32 v65, 0xffff0000, v66
v_add_f32 v48, v48, v64
v_add_f32 v49, v49, v65
v_lshlrev_b32 v64, 16, v67
v_and_b32 v65, 0xffff0000, v67
v_add_f32 v50, v50, v64
v_add_f32 v51, v51, v65
LE_fl12:
s_nop 3
v_cvt_pk_bf16_f32 v64, v48, v49
v_cvt_pk_bf16_f32 v65, v50, v51
v_mov_b32 v48, 0
v_mov_b32 v49, 0
v_mov_b32 v50, 0
v_mov_b32 v51, 0
buffer_store_dwordx2 v[64:65], v39, s[20:23], s47 offen sc1
s_add_u32 s47, s47, 512
LE_nf12:
v_mfma_f32_16x16x32_bf16 v[48:51], a[104:107], v[40:43], v[48:51]
v_mfma_f32_16x16x32_bf16 v[48:51], a[108:111], v[44:47], v[48:51]
s_bitcmp1_b32 s46, 13
s_cbranch_scc0 LE_nf13
s_cmp_eq_u32 s42, 0
s_cbranch_scc1 LE_fl13
buffer_load_dwordx2 v[66:67], v39, s[20:23], s47 offen sc1
s_waitcnt vmcnt(0)
v_lshlrev_b32 v64, 16, v66
v_and_b32 v65, 0xffff0000, v66
v_add_f32 v48, v48, v64
v_add_f32 v49, v49, v65
v_lshlrev_b32 v64, 16, v67
v_and_b32 v65, 0xffff0000, v67
v_add_f32 v50, v50, v64
v_add_f32 v51, v51, v65
LE_fl13:
s_nop 3
v_cvt_pk_bf16_f32 v64, v48, v49
v_cvt_pk_bf16_f32 v65, v50, v51
v_mov_b32 v48, 0
v_mov_b32 v49, 0
v_mov_b32 v50, 0
v_mov_b32 v51, 0
buffer_store_dwordx2 v[64:65], v39, s[20:23], s47 offen sc1
s_add_u32 s47, s47, 512
LE_nf13:
v_mfma_f32_16x16x32_bf16 v[48:51], a[112:115], v[40:43], v[48:51]
v_mfma_f32_16x16x32_bf16 v[48:51], a[116:119], v[44:47], v[48:51]
s_bitcmp1_b32 s46, 14
s_cbranch_scc0 LE_nf14
s_cmp_eq_u32 s42, 0
s_cbranch_scc1 LE_fl14
buffer_load_dwordx2 v[66:67], v39, s[20:23], s47 offen sc1
s_waitcnt vmcnt(0)
v_lshlrev_b32 v64, 16, v66
v_and_b32 v65, 0xffff0000, v66
v_add_f32 v48, v48, v64
v_add_f32 v49, v49, v65
v_lshlrev_b32 v64, 16, v67
v_and_b32 v65, 0xffff0000, v67
v_add_f32 v50, v50, v64
v_add_f32 v51, v51, v65
LE_fl14:
s_nop 3
v_cvt_pk_bf16_f32 v64, v48, v49
v_cvt_pk_bf16_f32 v65, v50, v51
v_mov_b32 v48, 0
v_mov_b32 v49, 0
v_mov_b32 v50, 0
v_mov_b32 v51, 0
buffer_store_dwordx2 v[64:65], v39, s[20:23], s47 offen sc1
s_add_u32 s47, s47, 512
LE_nf14:
v_mfma_f32_16x16x32_bf16 v[48:51], a[120:123], v[40:43], v[48:51]
v_mfma_f32_16x16x32_bf16 v[48:51], a[124:127], v[44:47], v[48:51]
s_bitcmp1_b32 s46, 15
s_cbranch_scc0 LE_nf15
s_cmp_eq_u32 s42, 0
s_cbranch_scc1 LE_fl15
buffer_load_dwordx2 v[66:67], v39, s[20:23], s47 offen sc1
s_waitcnt vmcnt(0)
v_lshlrev_b32 v64, 16, v66
v_and_b32 v65, 0xffff0000, v66
v_add_f32 v48, v48, v64
v_add_f32 v49, v49, v65
v_lshlrev_b32 v64, 16, v67
v_and_b32 v65, 0xffff0000, v67
v_add_f32 v50, v50, v64
v_add_f32 v51, v51, v65
LE_fl15:
s_nop 3
v_cvt_pk_bf16_f32 v64, v48, v49
v_cvt_pk_bf16_f32 v65, v50, v51
v_mov_b32 v48, 0
v_mov_b32 v49, 0
v_mov_b32 v50, 0
v_mov_b32 v51, 0
buffer_store_dwordx2 v[64:65], v39, s[20:23], s47 offen sc1
s_add_u32 s47, s47, 512
LE_nf15:
s_waitcnt lgkmcnt(0)
ds_read2_b32 v[52:53], v34 offset0:64 offset1:68
ds_read2_b32 v[54:55], v34 offset0:72 offset1:76
v_mad_u32_u16 v60, v56, s49, v2
v_mad_u32_u16 v61, v57, s49, v2
v_mad_u32_u16 v62, v58, s49, v2
v_mad_u32_u16 v63, v59, s49, v2
buffer_load_dwordx4 a[96:99], v60, s[16:19], 0 offen sc1
buffer_load_dwordx4 a[100:103], v60, s[16:19], 0 offen offset:256 sc1
buffer_load_dwordx4 a[104:107], v61, s[16:19], 0 offen sc1
buffer_load_dwordx4 a[108:111], v61, s[16:19], 0 offen offset:256 sc1
buffer_load_dwordx4 a[112:115], v62, s[16:19], 0 offen sc1
buffer_load_dwordx4 a[116:119], v62, s[16:19], 0 offen offset:256 sc1
buffer_load_dwordx4 a[120:123], v63, s[16:19], 0 offen sc1
buffer_load_dwordx4 a[124:127], v63, s[16:19], 0 offen offset:256 sc1
s_waitcnt vmcnt(56)
v_mfma_f32_16x16x32_bf16 v[48:51], a[128:131], v[40:43], v[48:51]
v_mfma_f32_16x16x32_bf16 v[48:51], a[132:135], v[44:47], v[48:51]
s_bitcmp1_b32 s46, 16
s_cbranch_scc0 LE_nf16
s_cmp_eq_u32 s42, 0
s_cbranch_scc1 LE_fl16
buffer_load_dwordx2 v[66:67], v39, s[20:23], s47 offen sc1
s_waitcnt vmcnt(0)
v_lshlrev_b32 v64, 16, v66
v_and_b32 v65, 0xffff0000, v66
v_add_f32 v48, v48, v64
v_add_f32 v49, v49, v65
v_lshlrev_b32 v64, 16, v67
v_and_b32 v65, 0xffff0000, v67
v_add_f32 v50, v50, v64
v_add_f32 v51, v51, v65
LE_fl16:
s_nop 3
v_cvt_pk_bf16_f32 v64, v48, v49
v_cvt_pk_bf16_f32 v65, v50, v51
v_mov_b32 v48, 0
v_mov_b32 v49, 0
v_mov_b32 v50, 0
v_mov_b32 v51, 0
buffer_store_dwordx2 v[64:65], v39, s[20:23], s47 offen sc1
s_add_u32 s47, s47, 512
LE_nf16:
v_mfma_f32_16x16x32_bf16 v[48:51], a[136:139], v[40:43], v[48:51]
v_mfma_f32_16x16x32_bf16 v[48:51], a[140:143], v[44:47], v[48:51]
s_bitcmp1_b32 s46, 17
s_cbranch_scc0 LE_nf17
s_cmp_eq_u32 s42, 0
s_cbranch_scc1 LE_fl17
buffer_load_dwordx2 v[66:67], v39, s[20:23], s47 offen sc1
s_waitcnt vmcnt(0)
v_lshlrev_b32 v64, 16, v66
v_and_b32 v65, 0xffff0000, v66
v_add_f32 v48, v48, v64
v_add_f32 v49, v49, v65
v_lshlrev_b32 v64, 16, v67
v_and_b32 v65, 0xffff0000, v67
v_add_f32 v50, v50, v64
v_add_f32 v51, v51, v65
LE_fl17:
s_nop 3
v_cvt_pk_bf16_f32 v64, v48, v49
v_cvt_pk_bf16_f32 v65, v50, v51
v_mov_b32 v48, 0
v_mov_b32 v49, 0
v_mov_b32 v50, 0
v_mov_b32 v51, 0
buffer_store_dwordx2 v[64:65], v39, s[20:23], s47 offen sc1
s_add_u32 s47, s47, 512
LE_nf17:
v_mfma_f32_16x16x32_bf16 v[48:51], a[144:147], v[40:43], v[48:51]
v_mfma_f32_16x16x32_bf16 v[48:51], a[148:151], v[44:47], v[48:51]
s_bitcmp1_b32 s46, 18
s_cbranch_scc0 LE_nf18
s_cmp_eq_u32 s42, 0
s_cbranch_scc1 LE_fl18
buffer_load_dwordx2 v[66:67], v39, s[20:23], s47 offen sc1
s_waitcnt vmcnt(0)
v_lshlrev_b32 v64, 16, v66
v_and_b32 v65, 0xffff0000, v66
v_add_f32 v48, v48, v64
v_add_f32 v49, v49, v65
v_lshlrev_b32 v64, 16, v67
v_and_b32 v65, 0xffff0000, v67
v_add_f32 v50, v50, v64
v_add_f32 v51, v51, v65
LE_fl18:
s_nop 3
v_cvt_pk_bf16_f32 v64, v48, v49
v_cvt_pk_bf16_f32 v65, v50, v51
v_mov_b32 v48, 0
v_mov_b32 v49, 0
v_mov_b32 v50, 0
v_mov_b32 v51, 0
buffer_store_dwordx2 v[64:65], v39, s[20:23], s47 offen sc1
s_add_u32 s47, s47, 512
LE_nf18:
v_mfma_f32_16x16x32_bf16 v[48:51], a[152:155], v[40:43], v[48:51]
v_mfma_f32_16x16x32_bf16 v[48:51], a[156:159], v[44:47], v[48:51]
s_bitcmp1_b32 s46, 19
s_cbranch_scc0 LE_nf19
s_cmp_eq_u32 s42, 0
s_cbranch_scc1 LE_fl19
buffer_load_dwordx2 v[66:67], v39, s[20:23], s47 offen sc1
s_waitcnt vmcnt(0)
v_lshlrev_b32 v64, 16, v66
v_and_b32 v65, 0xffff0000, v66
v_add_f32 v48, v48, v64
v_add_f32 v49, v49, v65
v_lshlrev_b32 v64, 16, v67
v_and_b32 v65, 0xffff0000, v67
v_add_f32 v50, v50, v64
v_add_f32 v51, v51, v65
LE_fl19:
s_nop 3
v_cvt_pk_bf16_f32 v64, v48, v49
v_cvt_pk_bf16_f32 v65, v50, v51
v_mov_b32 v48, 0
v_mov_b32 v49, 0
v_mov_b32 v50, 0
v_mov_b32 v51, 0
buffer_store_dwordx2 v[64:65], v39, s[20:23], s47 offen sc1
s_add_u32 s47, s47, 512
LE_nf19:
s_waitcnt lgkmcnt(0)
ds_read2_b32 v[56:57], v34 offset0:80 offset1:84
ds_read2_b32 v[58:59], v34 offset0:88 offset1:92
v_mad_u32_u16 v60, v52, s49, v2
v_mad_u32_u16 v61, v53, s49, v2
v_mad_u32_u16 v62, v54, s49, v2
v_mad_u32_u16 v63, v55, s49, v2
buffer_load_dwordx4 a[128:131], v60, s[16:19], 0 offen sc1
buffer_load_dwordx4 a[132:135], v60, s[16:19], 0 offen offset:256 sc1
buffer_load_dwordx4 a[136:139], v61, s[16:19], 0 offen sc1
buffer_load_dwordx4 a[140:143], v61, s[16:19], 0 offen offset:256 sc1
buffer_load_dwordx4 a[144:147], v62, s[16:19], 0 offen sc1
buffer_load_dwordx4 a[148:151], v62, s[16:19], 0 offen offset:256 sc1
buffer_load_dwordx4 a[152:155], v63, s[16:19], 0 offen sc1
buffer_load_dwordx4 a[156:159], v63, s[16:19], 0 offen offset:256 sc1
s_waitcnt vmcnt(56)
v_mfma_f32_16x16x32_bf16 v[48:51], a[160:163], v[40:43], v[48:51]
v_mfma_f32_16x16x32_bf16 v[48:51], a[164:167], v[44:47], v[48:51]
s_bitcmp1_b32 s46, 20
s_cbranch_scc0 LE_nf20
s_cmp_eq_u32 s42, 0
s_cbranch_scc1 LE_fl20
buffer_load_dwordx2 v[66:67], v39, s[20:23], s47 offen sc1
s_waitcnt vmcnt(0)
v_lshlrev_b32 v64, 16, v66
v_and_b32 v65, 0xffff0000, v66
v_add_f32 v48, v48, v64
v_add_f32 v49, v49, v65
v_lshlrev_b32 v64, 16, v67
v_and_b32 v65, 0xffff0000, v67
v_add_f32 v50, v50, v64
v_add_f32 v51, v51, v65
LE_fl20:
s_nop 3
v_cvt_pk_bf16_f32 v64, v48, v49
v_cvt_pk_bf16_f32 v65, v50, v51
v_mov_b32 v48, 0
v_mov_b32 v49, 0
v_mov_b32 v50, 0
v_mov_b32 v51, 0
buffer_store_dwordx2 v[64:65], v39, s[20:23], s47 offen sc1
s_add_u32 s47, s47, 512
LE_nf20:
v_mfma_f32_16x16x32_bf16 v[48:51], a[168:171], v[40:43], v[48:51]
v_mfma_f32_16x16x32_bf16 v[48:51], a[172:175], v[44:47], v[48:51]
s_bitcmp1_b32 s46, 21
s_cbranch_scc0 LE_nf21
s_cmp_eq_u32 s42, 0
s_cbranch_scc1 LE_fl21
buffer_load_dwordx2 v[66:67], v39, s[20:23], s47 offen sc1
s_waitcnt vmcnt(0)
v_lshlrev_b32 v64, 16, v66
v_and_b32 v65, 0xffff0000, v66
v_add_f32 v48, v48, v64
v_add_f32 v49, v49, v65
v_lshlrev_b32 v64, 16, v67
v_and_b32 v65, 0xffff0000, v67
v_add_f32 v50, v50, v64
v_add_f32 v51, v51, v65
LE_fl21:
s_nop 3
v_cvt_pk_bf16_f32 v64, v48, v49
v_cvt_pk_bf16_f32 v65, v50, v51
v_mov_b32 v48, 0
v_mov_b32 v49, 0
v_mov_b32 v50, 0
v_mov_b32 v51, 0
buffer_store_dwordx2 v[64:65], v39, s[20:23], s47 offen sc1
s_add_u32 s47, s47, 512
LE_nf21:
v_mfma_f32_16x16x32_bf16 v[48:51], a[176:179], v[40:43], v[48:51]
v_mfma_f32_16x16x32_bf16 v[48:51], a[180:183], v[44:47], v[48:51]
s_bitcmp1_b32 s46, 22
s_cbranch_scc0 LE_nf22
s_cmp_eq_u32 s42, 0
s_cbranch_scc1 LE_fl22
buffer_load_dwordx2 v[66:67], v39, s[20:23], s47 offen sc1
s_waitcnt vmcnt(0)
v_lshlrev_b32 v64, 16, v66
v_and_b32 v65, 0xffff0000, v66
v_add_f32 v48, v48, v64
v_add_f32 v49, v49, v65
v_lshlrev_b32 v64, 16, v67
v_and_b32 v65, 0xffff0000, v67
v_add_f32 v50, v50, v64
v_add_f32 v51, v51, v65
LE_fl22:
s_nop 3
v_cvt_pk_bf16_f32 v64, v48, v49
v_cvt_pk_bf16_f32 v65, v50, v51
v_mov_b32 v48, 0
v_mov_b32 v49, 0
v_mov_b32 v50, 0
v_mov_b32 v51, 0
buffer_store_dwordx2 v[64:65], v39, s[20:23], s47 offen sc1
s_add_u32 s47, s47, 512
LE_nf22:
v_mfma_f32_16x16x32_bf16 v[48:51], a[184:187], v[40:43], v[48:51]
v_mfma_f32_16x16x32_bf16 v[48:51], a[188:191], v[44:47], v[48:51]
s_bitcmp1_b32 s46, 23
s_cbranch_scc0 LE_nf23
s_cmp_eq_u32 s42, 0
s_cbranch_scc1 LE_fl23
buffer_load_dwordx2 v[66:67], v39, s[20:23], s47 offen sc1
s_waitcnt vmcnt(0)
v_lshlrev_b32 v64, 16, v66
v_and_b32 v65, 0xffff0000, v66
v_add_f32 v48, v48, v64
v_add_f32 v49, v49, v65
v_lshlrev_b32 v64, 16, v67
v_and_b32 v65, 0xffff0000, v67
v_add_f32 v50, v50, v64
v_add_f32 v51, v51, v65
LE_fl23:
s_nop 3
v_cvt_pk_bf16_f32 v64, v48, v49
v_cvt_pk_bf16_f32 v65, v50, v51
v_mov_b32 v48, 0
v_mov_b32 v49, 0
v_mov_b32 v50, 0
v_mov_b32 v51, 0
buffer_store_dwordx2 v[64:65], v39, s[20:23], s47 offen sc1
s_add_u32 s47, s47, 512
LE_nf23:
s_waitcnt lgkmcnt(0)
ds_read2_b32 v[52:53], v34 offset0:96 offset1:100
ds_read2_b32 v[54:55], v34 offset0:104 offset1:108
v_mad_u32_u16 v60, v56, s49, v2
v_mad_u32_u16 v61, v57, s49, v2
v_mad_u32_u16 v62, v58, s49, v2
v_mad_u32_u16 v63, v59, s49, v2
buffer_load_dwordx4 a[160:163], v60, s[16:19], 0 offen sc1
buffer_load_dwordx4 a[164:167], v60, s[16:19], 0 offen offset:256 sc1
buffer_load_dwordx4 a[168:171], v61, s[16:19], 0 offen sc1
buffer_load_dwordx4 a[172:175], v61, s[16:19], 0 offen offset:256 sc1
buffer_load_dwordx4 a[176:179], v62, s[16:19], 0 offen sc1
buffer_load_dwordx4 a[180:183], v62, s[16:19], 0 offen offset:256 sc1
buffer_load_dwordx4 a[184:187], v63, s[16:19], 0 offen sc1
buffer_load_dwordx4 a[188:191], v63, s[16:19], 0 offen offset:256 sc1
s_waitcnt vmcnt(56)
v_mfma_f32_16x16x32_bf16 v[48:51], a[192:195], v[40:43], v[48:51]
v_mfma_f32_16x16x32_bf16 v[48:51], a[196:199], v[44:47], v[48:51]
s_bitcmp1_b32 s46, 24
s_cbranch_scc0 LE_nf24
s_cmp_eq_u32 s42, 0
s_cbranch_scc1 LE_fl24
buffer_load_dwordx2 v[66:67], v39, s[20:23], s47 offen sc1
s_waitcnt vmcnt(0)
v_lshlrev_b32 v64, 16, v66
v_and_b32 v65, 0xffff0000, v66
v_add_f32 v48, v48, v64
v_add_f32 v49, v49, v65
v_lshlrev_b32 v64, 16, v67
v_and_b32 v65, 0xffff0000, v67
v_add_f32 v50, v50, v64
v_add_f32 v51, v51, v65
LE_fl24:
s_nop 3
v_cvt_pk_bf16_f32 v64, v48, v49
v_cvt_pk_bf16_f32 v65, v50, v51
v_mov_b32 v48, 0
v_mov_b32 v49, 0
v_mov_b32 v50, 0
v_mov_b32 v51, 0
buffer_store_dwordx2 v[64:65], v39, s[20:23], s47 offen sc1
s_add_u32 s47, s47, 512
LE_nf24:
v_mfma_f32_16x16x32_bf16 v[48:51], a[200:203], v[40:43], v[48:51]
v_mfma_f32_16x16x32_bf16 v[48:51], a[204:207], v[44:47], v[48:51]
s_bitcmp1_b32 s46, 25
s_cbranch_scc0 LE_nf25
s_cmp_eq_u32 s42, 0
s_cbranch_scc1 LE_fl25
buffer_load_dwordx2 v[66:67], v39, s[20:23], s47 offen sc1
s_waitcnt vmcnt(0)
v_lshlrev_b32 v64, 16, v66
v_and_b32 v65, 0xffff0000, v66
v_add_f32 v48, v48, v64
v_add_f32 v49, v49, v65
v_lshlrev_b32 v64, 16, v67
v_and_b32 v65, 0xffff0000, v67
v_add_f32 v50, v50, v64
v_add_f32 v51, v51, v65
LE_fl25:
s_nop 3
v_cvt_pk_bf16_f32 v64, v48, v49
v_cvt_pk_bf16_f32 v65, v50, v51
v_mov_b32 v48, 0
v_mov_b32 v49, 0
v_mov_b32 v50, 0
v_mov_b32 v51, 0
buffer_store_dwordx2 v[64:65], v39, s[20:23], s47 offen sc1
s_add_u32 s47, s47, 512
LE_nf25:
v_mfma_f32_16x16x32_bf16 v[48:51], a[208:211], v[40:43], v[48:51]
v_mfma_f32_16x16x32_bf16 v[48:51], a[212:215], v[44:47], v[48:51]
s_bitcmp1_b32 s46, 26
s_cbranch_scc0 LE_nf26
s_cmp_eq_u32 s42, 0
s_cbranch_scc1 LE_fl26
buffer_load_dwordx2 v[66:67], v39, s[20:23], s47 offen sc1
s_waitcnt vmcnt(0)
v_lshlrev_b32 v64, 16, v66
v_and_b32 v65, 0xffff0000, v66
v_add_f32 v48, v48, v64
v_add_f32 v49, v49, v65
v_lshlrev_b32 v64, 16, v67
v_and_b32 v65, 0xffff0000, v67
v_add_f32 v50, v50, v64
v_add_f32 v51, v51, v65
LE_fl26:
s_nop 3
v_cvt_pk_bf16_f32 v64, v48, v49
v_cvt_pk_bf16_f32 v65, v50, v51
v_mov_b32 v48, 0
v_mov_b32 v49, 0
v_mov_b32 v50, 0
v_mov_b32 v51, 0
buffer_store_dwordx2 v[64:65], v39, s[20:23], s47 offen sc1
s_add_u32 s47, s47, 512
LE_nf26:
v_mfma_f32_16x16x32_bf16 v[48:51], a[216:219], v[40:43], v[48:51]
v_mfma_f32_16x16x32_bf16 v[48:51], a[220:223], v[44:47], v[48:51]
s_bitcmp1_b32 s46, 27
s_cbranch_scc0 LE_nf27
s_cmp_eq_u32 s42, 0
s_cbranch_scc1 LE_fl27
buffer_load_dwordx2 v[66:67], v39, s[20:23], s47 offen sc1
s_waitcnt vmcnt(0)
v_lshlrev_b32 v64, 16, v66
v_and_b32 v65, 0xffff0000, v66
v_add_f32 v48, v48, v64
v_add_f32 v49, v49, v65
v_lshlrev_b32 v64, 16, v67
v_and_b32 v65, 0xffff0000, v67
v_add_f32 v50, v50, v64
v_add_f32 v51, v51, v65
LE_fl27:
s_nop 3
v_cvt_pk_bf16_f32 v64, v48, v49
v_cvt_pk_bf16_f32 v65, v50, v51
v_mov_b32 v48, 0
v_mov_b32 v49, 0
v_mov_b32 v50, 0
v_mov_b32 v51, 0
buffer_store_dwordx2 v[64:65], v39, s[20:23], s47 offen sc1
s_add_u32 s47, s47, 512
LE_nf27:
s_waitcnt lgkmcnt(0)
ds_read2_b32 v[56:57], v34 offset0:112 offset1:116
ds_read2_b32 v[58:59], v34 offset0:120 offset1:124
v_mad_u32_u16 v60, v52, s49, v2
v_mad_u32_u16 v61, v53, s49, v2
v_mad_u32_u16 v62, v54, s49, v2
v_mad_u32_u16 v63, v55, s49, v2
buffer_load_dwordx4 a[192:195], v60, s[16:19], 0 offen sc1
buffer_load_dwordx4 a[196:199], v60, s[16:19], 0 offen offset:256 sc1
buffer_load_dwordx4 a[200:203], v61, s[16:19], 0 offen sc1
buffer_load_dwordx4 a[204:207], v61, s[16:19], 0 offen offset:256 sc1
buffer_load_dwordx4 a[208:211], v62, s[16:19], 0 offen sc1
buffer_load_dwordx4 a[212:215], v62, s[16:19], 0 offen offset:256 sc1
buffer_load_dwordx4 a[216:219], v63, s[16:19], 0 offen sc1
buffer_load_dwordx4 a[220:223], v63, s[16:19], 0 offen offset:256 sc1
s_waitcnt vmcnt(56)
v_mfma_f32_16x16x32_bf16 v[48:51], a[224:227], v[40:43], v[48:51]
v_mfma_f32_16x16x32_bf16 v[48:51], a[228:231], v[44:47], v[48:51]
s_bitcmp1_b32 s46, 28
s_cbranch_scc0 LE_nf28
s_cmp_eq_u32 s42, 0
s_cbranch_scc1 LE_fl28
buffer_load_dwordx2 v[66:67], v39, s[20:23], s47 offen sc1
s_waitcnt vmcnt(0)
v_lshlrev_b32 v64, 16, v66
v_and_b32 v65, 0xffff0000, v66
v_add_f32 v48, v48, v64
v_add_f32 v49, v49, v65
v_lshlrev_b32 v64, 16, v67
v_and_b32 v65, 0xffff0000, v67
v_add_f32 v50, v50, v64
v_add_f32 v51, v51, v65
LE_fl28:
s_nop 3
v_cvt_pk_bf16_f32 v64, v48, v49
v_cvt_pk_bf16_f32 v65, v50, v51
v_mov_b32 v48, 0
v_mov_b32 v49, 0
v_mov_b32 v50, 0
v_mov_b32 v51, 0
buffer_store_dwordx2 v[64:65], v39, s[20:23], s47 offen sc1
s_add_u32 s47, s47, 512
LE_nf28:
v_mfma_f32_16x16x32_bf16 v[48:51], a[232:235], v[40:43], v[48:51]
v_mfma_f32_16x16x32_bf16 v[48:51], a[236:239], v[44:47], v[48:51]
s_bitcmp1_b32 s46, 29
s_cbranch_scc0 LE_nf29
s_cmp_eq_u32 s42, 0
s_cbranch_scc1 LE_fl29
buffer_load_dwordx2 v[66:67], v39, s[20:23], s47 offen sc1
s_waitcnt vmcnt(0)
v_lshlrev_b32 v64, 16, v66
v_and_b32 v65, 0xffff0000, v66
v_add_f32 v48, v48, v64
v_add_f32 v49, v49, v65
v_lshlrev_b32 v64, 16, v67
v_and_b32 v65, 0xffff0000, v67
v_add_f32 v50, v50, v64
v_add_f32 v51, v51, v65
LE_fl29:
s_nop 3
v_cvt_pk_bf16_f32 v64, v48, v49
v_cvt_pk_bf16_f32 v65, v50, v51
v_mov_b32 v48, 0
v_mov_b32 v49, 0
v_mov_b32 v50, 0
v_mov_b32 v51, 0
buffer_store_dwordx2 v[64:65], v39, s[20:23], s47 offen sc1
s_add_u32 s47, s47, 512
LE_nf29:
v_mfma_f32_16x16x32_bf16 v[48:51], a[240:243], v[40:43], v[48:51]
v_mfma_f32_16x16x32_bf16 v[48:51], a[244:247], v[44:47], v[48:51]
s_bitcmp1_b32 s46, 30
s_cbranch_scc0 LE_nf30
s_cmp_eq_u32 s42, 0
s_cbranch_scc1 LE_fl30
buffer_load_dwordx2 v[66:67], v39, s[20:23], s47 offen sc1
s_waitcnt vmcnt(0)
v_lshlrev_b32 v64, 16, v66
v_and_b32 v65, 0xffff0000, v66
v_add_f32 v48, v48, v64
v_add_f32 v49, v49, v65
v_lshlrev_b32 v64, 16, v67
v_and_b32 v65, 0xffff0000, v67
v_add_f32 v50, v50, v64
v_add_f32 v51, v51, v65
LE_fl30:
s_nop 3
v_cvt_pk_bf16_f32 v64, v48, v49
v_cvt_pk_bf16_f32 v65, v50, v51
v_mov_b32 v48, 0
v_mov_b32 v49, 0
v_mov_b32 v50, 0
v_mov_b32 v51, 0
buffer_store_dwordx2 v[64:65], v39, s[20:23], s47 offen sc1
s_add_u32 s47, s47, 512
LE_nf30:
v_mfma_f32_16x16x32_bf16 v[48:51], a[248:251], v[40:43], v[48:51]
v_mfma_f32_16x16x32_bf16 v[48:51], a[252:255], v[44:47], v[48:51]
s_bitcmp1_b32 s46, 31
s_cbranch_scc0 LE_nf31
s_cmp_eq_u32 s42, 0
s_cbranch_scc1 LE_fl31
buffer_load_dwordx2 v[66:67], v39, s[20:23], s47 offen sc1
s_waitcnt vmcnt(0)
v_lshlrev_b32 v64, 16, v66
v_and_b32 v65, 0xffff0000, v66
v_add_f32 v48, v48, v64
v_add_f32 v49, v49, v65
v_lshlrev_b32 v64, 16, v67
v_and_b32 v65, 0xffff0000, v67
v_add_f32 v50, v50, v64
v_add_f32 v51, v51, v65
LE_fl31:
s_nop 3
v_cvt_pk_bf16_f32 v64, v48, v49
v_cvt_pk_bf16_f32 v65, v50, v51
v_mov_b32 v48, 0
v_mov_b32 v49, 0
v_mov_b32 v50, 0
v_mov_b32 v51, 0
buffer_store_dwordx2 v[64:65], v39, s[20:23], s47 offen sc1
s_add_u32 s47, s47, 512
LE_nf31:
s_waitcnt lgkmcnt(0)
ds_read2_b32 v[52:53], v34 offset0:128 offset1:132
ds_read2_b32 v[54:55], v34 offset0:136 offset1:140
v_mad_u32_u16 v60, v56, s49, v2
v_mad_u32_u16 v61, v57, s49, v2
v_mad_u32_u16 v62, v58, s49, v2
v_mad_u32_u16 v63, v59, s49, v2
buffer_load_dwordx4 a[224:227], v60, s[16:19], 0 offen sc1
buffer_load_dwordx4 a[228:231], v60, s[16:19], 0 offen offset:256 sc1
buffer_load_dwordx4 a[232:235], v61, s[16:19], 0 offen sc1
buffer_load_dwordx4 a[236:239], v61, s[16:19], 0 offen offset:256 sc1
buffer_load_dwordx4 a[240:243], v62, s[16:19], 0 offen sc1
buffer_load_dwordx4 a[244:247], v62, s[16:19], 0 offen offset:256 sc1
buffer_load_dwordx4 a[248:251], v63, s[16:19], 0 offen sc1
buffer_load_dwordx4 a[252:255], v63, s[16:19], 0 offen offset:256 sc1
v_add_u32 v34, 512, v34
s_cmp_lt_u32 s45, s44
s_cbranch_scc1 LE_loop
s_add_u32 s42, s42, 1
s_mul_i32 s43, s42, 256
v_cmp_lt_u32 vcc, s43, v4
s_cbranch_vccz LE_done
s_cmp_ge_u32 s42, 40
s_cbranch_scc1 LE_done
s_waitcnt vmcnt(0) lgkmcnt(0)
s_add_u32 s50, s50, 1048576
v_add_u32 v5, 0x100, v5
buffer_load_dwordx4 v[192:195], v6, s[12:15], s50 offen offset:0 sc1
buffer_load_dwordx4 v[196:199], v6, s[12:15], s50 offen offset:64 sc1
buffer_load_dwordx4 v[200:203], v6, s[12:15], s50 offen offset:128 sc1
buffer_load_dwordx4 v[204:207], v6, s[12:15], s50 offen offset:192 sc1
buffer_load_dwordx4 v[208:211], v6, s[12:15], s50 offen offset:256 sc1
buffer_load_dwordx4 v[212:215], v6, s[12:15], s50 offen offset:320 sc1
buffer_load_dwordx4 v[216:219], v6, s[12:15], s50 offen offset:384 sc1
buffer_load_dwordx4 v[220:223], v6, s[12:15], s50 offen offset:448 sc1
buffer_load_dwordx4 v[224:227], v6, s[12:15], s50 offen offset:512 sc1
buffer_load_dwordx4 v[228:231], v6, s[12:15], s50 offen offset:576 sc1
buffer_load_dwordx4 v[232:235], v6, s[12:15], s50 offen offset:640 sc1
buffer_load_dwordx4 v[236:239], v6, s[12:15], s50 offen offset:704 sc1
buffer_load_dwordx4 v[240:243], v6, s[12:15], s50 offen offset:768 sc1
buffer_load_dwordx4 v[244:247], v6, s[12:15], s50 offen offset:832 sc1
buffer_load_dwordx4 v[248:251], v6, s[12:15], s50 offen offset:896 sc1
buffer_load_dwordx4 v[252:255], v6, s[12:15], s50 offen offset:960 sc1
s_branch LE_pass
LE_done:
s_add_u32 s24, s4, 0x7c00000
s_addc_u32 s25, s5, 0
s_mov_b32 s26, 0x40000
s_mov_b32 s27, 0x00020000
s_add_u32 s48, s40, 1280
s_mul_i32 s48, s48, 128
s_waitcnt vmcnt(0)
v_lshlrev_b32 v196, 4, v1
v_mov_b32 v192, s98
v_mov_b32 v193, s99
v_mov_b32 v194, s98
v_mov_b32 v195, s99
s_mov_b64 exec, 0xff
buffer_store_dwordx4 v[192:195], v196, s[24:27], s48 offen sc1
s_mov_b64 exec, -1
s_add_u32 s24, s4, 0x7c32000
s_addc_u32 s25, s5, 0
s_mov_b32 s26, 0x400
s_mov_b32 s27, 0x00020000
v_and_b32 v196, 7, v1
v_lshlrev_b32 v196, 7, v196
s_mov_b32 s94, 0x10000
LE_wf:
buffer_load_dwordx2 v[192:193], v196, s[24:27], 0 offen sc1
s_sub_u32 s94, s94, 1
s_waitcnt vmcnt(0)
s_cbranch_scc1 LE_wf_go
v_cmp_ne_u64 vcc, s[98:99], v[192:193]
s_nop 1
s_cbranch_vccnz LE_wf
LE_wf_go:
s_add_u32 s24, s4, 0x1000000
s_addc_u32 s25, s5, 0
s_mov_b32 s26, 0x40000
s_mov_b32 s27, 0x00020000
s_mul_i32 s36, s40, 43
s_lshr_b32 s36, s36, 8
s_mul_i32 s36, s36, 6
s_sub_u32 s36, s40, s36
s_mul_i32 s36, s36, 49152
v_lshlrev_b32 v196, 7, v1
buffer_load_dword v200, v196, s[24:27], s36 offen
s_add_u32 s36, s36, 8192
buffer_load_dword v201, v196, s[24:27], s36 offen
s_add_u32 s36, s36, 8192
buffer_load_dword v202, v196, s[24:27], s36 offen
s_add_u32 s36, s36, 8192
buffer_load_dword v203, v196, s[24:27], s36 offen
s_add_u32 s36, s36, 8192
buffer_load_dword v204, v196, s[24:27], s36 offen
s_add_u32 s36, s36, 8192
buffer_load_dword v205, v196, s[24:27], s36 offen
s_add_u32 s36, s36, 8192
s_branch L2_end
L2_fin:
L2_end:
s_endpgm
L2_hot:
L2_rare_site0:
s_mov_b32 s36, 0
s_branch L2_rare_0
L2_rare_site4:
s_mov_b32 s36, 4
s_branch L2_rare_0
L2_rare_0:
s_nop 15
s_nop 15
s_waitcnt lgkmcnt(0)
v_lshrrev_b32 v206, 8, v243
v_add_u32 v206, 1, v206
v_lshrrev_b32 v206, 2, v206
v_sub_u32 v206, 0, v206
v_and_b32 v206, 0xffff0000, v206
v_add_u32 v207, 0x18000, v240
v_and_b32 v207, 0x1ffff, v207
ds_read_b128 v[200:203], v207 offset:29184
s_waitcnt lgkmcnt(0)
v_mfma_f32_16x16x32_bf16 v[192:195], v[200:203], v[0:3], 0
s_nop 7
ds_read_b128 v[200:203], v207 offset:28672
s_waitcnt lgkmcnt(0)
v_mfma_f32_16x16x32_bf16 v[192:195], v[200:203], v[4:7], v[192:195]
s_nop 7
ds_read_b128 v[200:203], v207 offset:16384
s_waitcnt lgkmcnt(0)
v_mfma_f32_16x16x32_bf16 v[192:195], v[200:203], v[8:11], v[192:195]
s_nop 7
ds_read_b128 v[200:203], v207 offset:16896
s_waitcnt lgkmcnt(0)
v_mfma_f32_16x16x32_bf16 v[192:195], v[200:203], v[12:15], v[192:195]
s_nop 7
ds_read_b128 v[200:203], v207 offset:20480
s_waitcnt lgkmcnt(0)
v_mfma_f32_16x16x32_bf16 v[192:195], v[200:203], v[16:19], v[192:195]
s_nop 7
ds_read_b128 v[200:203], v207 offset:20992
s_waitcnt lgkmcnt(0)
v_mfma_f32_16x16x32_bf16 v[192:195], v[200:203], v[20:23], v[192:195]
s_nop 7
ds_read_b128 v[200:203], v207 offset:24576
s_waitcnt lgkmcnt(0)
v_mfma_f32_16x16x32_bf16 v[192:195], v[200:203], v[24:27], v[192:195]
s_nop 7
ds_read_b128 v[200:203], v207 offset:25088
s_waitcnt lgkmcnt(0)
v_mfma_f32_16x16x32_bf16 v[192:195], v[200:203], v[28:31], v[192:195]
s_nop 7
ds_read_b128 v[200:203], v207 offset:31232
s_waitcnt lgkmcnt(0)
v_mfma_f32_16x16x32_bf16 v[196:199], v[200:203], v[0:3], 0
s_nop 7
ds_read_b128 v[200:203], v207 offset:30720
s_waitcnt lgkmcnt(0)
v_mfma_f32_16x16x32_bf16 v[196:199], v[200:203], v[4:7], v[196:199]
s_nop 7
ds_read_b128 v[200:203], v207 offset:18432
s_waitcnt lgkmcnt(0)
v_mfma_f32_16x16x32_bf16 v[196:199], v[200:203], v[8:11], v[196:199]
s_nop 7
ds_read_b128 v[200:203], v207 offset:18944
s_waitcnt lgkmcnt(0)
v_mfma_f32_16x16x32_bf16 v[196:199], v[200:203], v[12:15], v[196:199]
s_nop 7
ds_read_b128 v[200:203], v207 offset:22528
s_waitcnt lgkmcnt(0)
v_mfma_f32_16x16x32_bf16 v[196:199], v[200:203], v[16:19], v[196:199]
s_nop 7
ds_read_b128 v[200:203], v207 offset:23040
s_waitcnt lgkmcnt(0)
v_mfma_f32_16x16x32_bf16 v[196:199], v[200:203], v[20:23], v[196:199]
s_nop 7
ds_read_b128 v[200:203], v207 offset:26624
s_waitcnt lgkmcnt(0)
v_mfma_f32_16x16x32_bf16 v[196:199], v[200:203], v[24:27], v[196:199]
s_nop 7
ds_read_b128 v[200:203], v207 offset:27136
s_waitcnt lgkmcnt(0)
v_mfma_f32_16x16x32_bf16 v[196:199], v[200:203], v[28:31], v[196:199]
s_nop 7
s_nop 7
v_max_f32 v204, v192, v193
v_max3_f32 v204, v204, v194, v195
v_max3_f32 v204, v204, v196, v197
v_max3_f32 v204, v204, v198, v199
v_mov_b32 v205, v204
s_nop 1
v_permlane32_swap_b32 v204, v205
s_nop 1
v_max_f32 v204, v204, v205
v_mov_b32 v205, v204
s_nop 1
v_permlane16_swap_b32 v204, v205
s_nop 1
v_max_f32 v204, v204, v205
v_add_f32 v204, 40.0, v204
v_ceil_f32 v204, v204
v_max_f32 v204, 0, v204
v_sub_f32 v205, v224, v204
v_cvt_pk_bf16_f32 v205, v205, v205
v_and_b32 v205, 0xffff0000, v205
v_sub_f32 v204, v205, v224
v_mov_b32 v224, v205
v_exp_f32 v236, v204
v_bfi_b32 v3, v206, v205, v3
v_add_f32 v192, v192, v204
v_add_f32 v193, v193, v204
v_add_f32 v194, v194, v204
v_add_f32 v195, v195, v204
v_add_f32 v196, v196, v204
v_add_f32 v197, v197, v204
v_add_f32 v198, v198, v204
v_add_f32 v199, v199, v204
v_add_f32 v128, v128, v204
v_add_f32 v129, v129, v204
v_add_f32 v130, v130, v204
v_add_f32 v131, v131, v204
v_lshlrev_b32 v242, 16, v160
v_and_b32 v248, 0xffff0000, v160
v_mul_f32 v242, v242, v236
v_mul_f32 v248, v248, v236
v_cvt_pk_bf16_f32 v160, v242, v248
v_lshlrev_b32 v242, 16, v161
v_and_b32 v248, 0xffff0000, v161
v_mul_f32 v242, v242, v236
v_mul_f32 v248, v248, v236
v_cvt_pk_bf16_f32 v161, v242, v248
v_lshlrev_b32 v242, 16, v162
v_and_b32 v248, 0xffff0000, v162
v_mul_f32 v242, v242, v236
v_mul_f32 v248, v248, v236
v_cvt_pk_bf16_f32 v162, v242, v248
v_lshlrev_b32 v242, 16, v163
v_and_b32 v248, 0xffff0000, v163
v_mul_f32 v242, v242, v236
v_mul_f32 v248, v248, v236
v_cvt_pk_bf16_f32 v163, v242, v248
v_exp_f32 v232, v192
v_exp_f32 v233, v193
v_exp_f32 v234, v194
v_exp_f32 v235, v195
s_nop 1
v_cvt_pk_bf16_f32 v176, v232, v233
v_cvt_pk_bf16_f32 v177, v234, v235
v_exp_f32 v232, v196
v_exp_f32 v233, v197
v_exp_f32 v234, v198
v_exp_f32 v235, v199
s_nop 1
v_cvt_pk_bf16_f32 v178, v232, v233
v_cvt_pk_bf16_f32 v179, v234, v235
ds_read_b128 v[200:203], v207 offset:29184
s_waitcnt lgkmcnt(0)
v_mfma_f32_16x16x32_bf16 v[192:195], v[200:203], v[32:35], 0
s_nop 7
ds_read_b128 v[200:203], v207 offset:28672
s_waitcnt lgkmcnt(0)
v_mfma_f32_16x16x32_bf16 v[192:195], v[200:203], v[36:39], v[192:195]
s_nop 7
ds_read_b128 v[200:203], v207 offset:16384
s_waitcnt lgkmcnt(0)
v_mfma_f32_16x16x32_bf16 v[192:195], v[200:203], v[40:43], v[192:195]
s_nop 7
ds_read_b128 v[200:203], v207 offset:16896
s_waitcnt lgkmcnt(0)
v_mfma_f32_16x16x32_bf16 v[192:195], v[200:203], v[44:47], v[192:195]
s_nop 7
ds_read_b128 v[200:203], v207 offset:20480
s_waitcnt lgkmcnt(0)
v_mfma_f32_16x16x32_bf16 v[192:195], v[200:203], v[48:51], v[192:195]
s_nop 7
ds_read_b128 v[200:203], v207 offset:20992
s_waitcnt lgkmcnt(0)
v_mfma_f32_16x16x32_bf16 v[192:195], v[200:203], v[52:55], v[192:195]
s_nop 7
ds_read_b128 v[200:203], v207 offset:24576
s_waitcnt lgkmcnt(0)
v_mfma_f32_16x16x32_bf16 v[192:195], v[200:203], v[56:59], v[192:195]
s_nop 7
ds_read_b128 v[200:203], v207 offset:25088
s_waitcnt lgkmcnt(0)
v_mfma_f32_16x16x32_bf16 v[192:195], v[200:203], v[60:63], v[192:195]
s_nop 7
ds_read_b128 v[200:203], v207 offset:31232
s_waitcnt lgkmcnt(0)
v_mfma_f32_16x16x32_bf16 v[196:199], v[200:203], v[32:35], 0
s_nop 7
ds_read_b128 v[200:203], v207 offset:30720
s_waitcnt lgkmcnt(0)
v_mfma_f32_16x16x32_bf16 v[196:199], v[200:203], v[36:39], v[196:199]
s_nop 7
ds_read_b128 v[200:203], v207 offset:18432
s_waitcnt lgkmcnt(0)
v_mfma_f32_16x16x32_bf16 v[196:199], v[200:203], v[40:43], v[196:199]
s_nop 7
ds_read_b128 v[200:203], v207 offset:18944
s_waitcnt lgkmcnt(0)
v_mfma_f32_16x16x32_bf16 v[196:199], v[200:203], v[44:47], v[196:199]
s_nop 7
ds_read_b128 v[200:203], v207 offset:22528
s_waitcnt lgkmcnt(0)
v_mfma_f32_16x16x32_bf16 v[196:199], v[200:203], v[48:51], v[196:199]
s_nop 7
ds_read_b128 v[200:203], v207 offset:23040
s_waitcnt lgkmcnt(0)
v_mfma_f32_16x16x32_bf16 v[196:199], v[200:203], v[52:55], v[196:199]
s_nop 7
ds_read_b128 v[200:203], v207 offset:26624
s_waitcnt lgkmcnt(0)
v_mfma_f32_16x16x32_bf16 v[196:199], v[200:203], v[56:59], v[196:199]
s_nop 7
ds_read_b128 v[200:203], v207 offset:27136
s_waitcnt lgkmcnt(0)
v_mfma_f32_16x16x32_bf16 v[196:199], v[200:203], v[60:63], v[196:199]
s_nop 7
s_nop 7
v_max_f32 v204, v192, v193
v_max3_f32 v204, v204, v194, v195
v_max3_f32 v204, v204, v196, v197
v_max3_f32 v204, v204, v198, v199
v_mov_b32 v205, v204
s_nop 1
v_permlane32_swap_b32 v204, v205
s_nop 1
v_max_f32 v204, v204, v205
v_mov_b32 v205, v204
s_nop 1
v_permlane16_swap_b32 v204, v205
s_nop 1
v_max_f32 v204, v204, v205
v_add_f32 v204, 40.0, v204
v_ceil_f32 v204, v204
v_max_f32 v204, 0, v204
v_sub_f32 v205, v225, v204
v_cvt_pk_bf16_f32 v205, v205, v205
v_and_b32 v205, 0xffff0000, v205
v_sub_f32 v204, v205, v225
v_mov_b32 v225, v205
v_exp_f32 v237, v204
v_bfi_b32 v35, v206, v205, v35
v_add_f32 v192, v192, v204
v_add_f32 v193, v193, v204
v_add_f32 v194, v194, v204
v_add_f32 v195, v195, v204
v_add_f32 v196, v196, v204
v_add_f32 v197, v197, v204
v_add_f32 v198, v198, v204
v_add_f32 v199, v199, v204
v_add_f32 v132, v132, v204
v_add_f32 v133, v133, v204
v_add_f32 v134, v134, v204
v_add_f32 v135, v135, v204
v_lshlrev_b32 v242, 16, v164
v_and_b32 v248, 0xffff0000, v164
v_mul_f32 v242, v242, v237
v_mul_f32 v248, v248, v237
v_cvt_pk_bf16_f32 v164, v242, v248
v_lshlrev_b32 v242, 16, v165
v_and_b32 v248, 0xffff0000, v165
v_mul_f32 v242, v242, v237
v_mul_f32 v248, v248, v237
v_cvt_pk_bf16_f32 v165, v242, v248
v_lshlrev_b32 v242, 16, v166
v_and_b32 v248, 0xffff0000, v166
v_mul_f32 v242, v242, v237
v_mul_f32 v248, v248, v237
v_cvt_pk_bf16_f32 v166, v242, v248
v_lshlrev_b32 v242, 16, v167
v_and_b32 v248, 0xffff0000, v167
v_mul_f32 v242, v242, v237
v_mul_f32 v248, v248, v237
v_cvt_pk_bf16_f32 v167, v242, v248
v_exp_f32 v232, v192
v_exp_f32 v233, v193
v_exp_f32 v234, v194
v_exp_f32 v235, v195
s_nop 1
v_cvt_pk_bf16_f32 v180, v232, v233
v_cvt_pk_bf16_f32 v181, v234, v235
v_exp_f32 v232, v196
v_exp_f32 v233, v197
v_exp_f32 v234, v198
v_exp_f32 v235, v199
s_nop 1
v_cvt_pk_bf16_f32 v182, v232, v233
v_cvt_pk_bf16_f32 v183, v234, v235
ds_read_b128 v[200:203], v207 offset:29184
s_waitcnt lgkmcnt(0)
v_mfma_f32_16x16x32_bf16 v[192:195], v[200:203], v[64:67], 0
s_nop 7
ds_read_b128 v[200:203], v207 offset:28672
s_waitcnt lgkmcnt(0)
v_mfma_f32_16x16x32_bf16 v[192:195], v[200:203], v[68:71], v[192:195]
s_nop 7
ds_read_b128 v[200:203], v207 offset:16384
s_waitcnt lgkmcnt(0)
v_mfma_f32_16x16x32_bf16 v[192:195], v[200:203], v[72:75], v[192:195]
s_nop 7
ds_read_b128 v[200:203], v207 offset:16896
s_waitcnt lgkmcnt(0)
v_mfma_f32_16x16x32_bf16 v[192:195], v[200:203], v[76:79], v[192:195]
s_nop 7
ds_read_b128 v[200:203], v207 offset:20480
s_waitcnt lgkmcnt(0)
v_mfma_f32_16x16x32_bf16 v[192:195], v[200:203], v[80:83], v[192:195]
s_nop 7
ds_read_b128 v[200:203], v207 offset:20992
s_waitcnt lgkmcnt(0)
v_mfma_f32_16x16x32_bf16 v[192:195], v[200:203], v[84:87], v[192:195]
s_nop 7
ds_read_b128 v[200:203], v207 offset:24576
s_waitcnt lgkmcnt(0)
v_mfma_f32_16x16x32_bf16 v[192:195], v[200:203], v[88:91], v[192:195]
s_nop 7
ds_read_b128 v[200:203], v207 offset:25088
s_waitcnt lgkmcnt(0)
v_mfma_f32_16x16x32_bf16 v[192:195], v[200:203], v[92:95], v[192:195]
s_nop 7
ds_read_b128 v[200:203], v207 offset:31232
s_waitcnt lgkmcnt(0)
v_mfma_f32_16x16x32_bf16 v[196:199], v[200:203], v[64:67], 0
s_nop 7
ds_read_b128 v[200:203], v207 offset:30720
s_waitcnt lgkmcnt(0)
v_mfma_f32_16x16x32_bf16 v[196:199], v[200:203], v[68:71], v[196:199]
s_nop 7
ds_read_b128 v[200:203], v207 offset:18432
s_waitcnt lgkmcnt(0)
v_mfma_f32_16x16x32_bf16 v[196:199], v[200:203], v[72:75], v[196:199]
s_nop 7
ds_read_b128 v[200:203], v207 offset:18944
s_waitcnt lgkmcnt(0)
v_mfma_f32_16x16x32_bf16 v[196:199], v[200:203], v[76:79], v[196:199]
s_nop 7
ds_read_b128 v[200:203], v207 offset:22528
s_waitcnt lgkmcnt(0)
v_mfma_f32_16x16x32_bf16 v[196:199], v[200:203], v[80:83], v[196:199]
s_nop 7
ds_read_b128 v[200:203], v207 offset:23040
s_waitcnt lgkmcnt(0)
v_mfma_f32_16x16x32_bf16 v[196:199], v[200:203], v[84:87], v[196:199]
s_nop 7
ds_read_b128 v[200:203], v207 offset:26624
s_waitcnt lgkmcnt(0)
v_mfma_f32_16x16x32_bf16 v[196:199], v[200:203], v[88:91], v[196:199]
s_nop 7
ds_read_b128 v[200:203], v207 offset:27136
s_waitcnt lgkmcnt(0)
v_mfma_f32_16x16x32_bf16 v[196:199], v[200:203], v[92:95], v[196:199]
s_nop 7
s_nop 7
v_max_f32 v204, v192, v193
v_max3_f32 v204, v204, v194, v195
v_max3_f32 v204, v204, v196, v197
v_max3_f32 v204, v204, v198, v199
v_mov_b32 v205, v204
s_nop 1
v_permlane32_swap_b32 v204, v205
s_nop 1
v_max_f32 v204, v204, v205
v_mov_b32 v205, v204
s_nop 1
v_permlane16_swap_b32 v204, v205
s_nop 1
v_max_f32 v204, v204, v205
v_add_f32 v204, 40.0, v204
v_ceil_f32 v204, v204
v_max_f32 v204, 0, v204
v_sub_f32 v205, v226, v204
v_cvt_pk_bf16_f32 v205, v205, v205
v_and_b32 v205, 0xffff0000, v205
v_sub_f32 v204, v205, v226
v_mov_b32 v226, v205
v_exp_f32 v238, v204
v_bfi_b32 v67, v206, v205, v67
v_add_f32 v192, v192, v204
v_add_f32 v193, v193, v204
v_add_f32 v194, v194, v204
v_add_f32 v195, v195, v204
v_add_f32 v196, v196, v204
v_add_f32 v197, v197, v204
v_add_f32 v198, v198, v204
v_add_f32 v199, v199, v204
v_add_f32 v136, v136, v204
v_add_f32 v137, v137, v204
v_add_f32 v138, v138, v204
v_add_f32 v139, v139, v204
v_lshlrev_b32 v242, 16, v168
v_and_b32 v248, 0xffff0000, v168
v_mul_f32 v242, v242, v238
v_mul_f32 v248, v248, v238
v_cvt_pk_bf16_f32 v168, v242, v248
v_lshlrev_b32 v242, 16, v169
v_and_b32 v248, 0xffff0000, v169
v_mul_f32 v242, v242, v238
v_mul_f32 v248, v248, v238
v_cvt_pk_bf16_f32 v169, v242, v248
v_lshlrev_b32 v242, 16, v170
v_and_b32 v248, 0xffff0000, v170
v_mul_f32 v242, v242, v238
v_mul_f32 v248, v248, v238
v_cvt_pk_bf16_f32 v170, v242, v248
v_lshlrev_b32 v242, 16, v171
v_and_b32 v248, 0xffff0000, v171
v_mul_f32 v242, v242, v238
v_mul_f32 v248, v248, v238
v_cvt_pk_bf16_f32 v171, v242, v248
v_exp_f32 v232, v192
v_exp_f32 v233, v193
v_exp_f32 v234, v194
v_exp_f32 v235, v195
s_nop 1
v_cvt_pk_bf16_f32 v184, v232, v233
v_cvt_pk_bf16_f32 v185, v234, v235
v_exp_f32 v232, v196
v_exp_f32 v233, v197
v_exp_f32 v234, v198
v_exp_f32 v235, v199
s_nop 1
v_cvt_pk_bf16_f32 v186, v232, v233
v_cvt_pk_bf16_f32 v187, v234, v235
ds_read_b128 v[200:203], v207 offset:29184
s_waitcnt lgkmcnt(0)
v_mfma_f32_16x16x32_bf16 v[192:195], v[200:203], v[96:99], 0
s_nop 7
ds_read_b128 v[200:203], v207 offset:28672
s_waitcnt lgkmcnt(0)
v_mfma_f32_16x16x32_bf16 v[192:195], v[200:203], v[100:103], v[192:195]
s_nop 7
ds_read_b128 v[200:203], v207 offset:16384
s_waitcnt lgkmcnt(0)
v_mfma_f32_16x16x32_bf16 v[192:195], v[200:203], v[104:107], v[192:195]
s_nop 7
ds_read_b128 v[200:203], v207 offset:16896
s_waitcnt lgkmcnt(0)
v_mfma_f32_16x16x32_bf16 v[192:195], v[200:203], v[108:111], v[192:195]
s_nop 7
ds_read_b128 v[200:203], v207 offset:20480
s_waitcnt lgkmcnt(0)
v_mfma_f32_16x16x32_bf16 v[192:195], v[200:203], v[112:115], v[192:195]
s_nop 7
ds_read_b128 v[200:203], v207 offset:20992
s_waitcnt lgkmcnt(0)
v_mfma_f32_16x16x32_bf16 v[192:195], v[200:203], v[116:119], v[192:195]
s_nop 7
ds_read_b128 v[200:203], v207 offset:24576
s_waitcnt lgkmcnt(0)
v_mfma_f32_16x16x32_bf16 v[192:195], v[200:203], v[120:123], v[192:195]
s_nop 7
ds_read_b128 v[200:203], v207 offset:25088
s_waitcnt lgkmcnt(0)
v_mfma_f32_16x16x32_bf16 v[192:195], v[200:203], v[124:127], v[192:195]
s_nop 7
ds_read_b128 v[200:203], v207 offset:31232
s_waitcnt lgkmcnt(0)
v_mfma_f32_16x16x32_bf16 v[196:199], v[200:203], v[96:99], 0
s_nop 7
ds_read_b128 v[200:203], v207 offset:30720
s_waitcnt lgkmcnt(0)
v_mfma_f32_16x16x32_bf16 v[196:199], v[200:203], v[100:103], v[196:199]
s_nop 7
ds_read_b128 v[200:203], v207 offset:18432
s_waitcnt lgkmcnt(0)
v_mfma_f32_16x16x32_bf16 v[196:199], v[200:203], v[104:107], v[196:199]
s_nop 7
ds_read_b128 v[200:203], v207 offset:18944
s_waitcnt lgkmcnt(0)
v_mfma_f32_16x16x32_bf16 v[196:199], v[200:203], v[108:111], v[196:199]
s_nop 7
ds_read_b128 v[200:203], v207 offset:22528
s_waitcnt lgkmcnt(0)
v_mfma_f32_16x16x32_bf16 v[196:199], v[200:203], v[112:115], v[196:199]
s_nop 7
ds_read_b128 v[200:203], v207 offset:23040
s_waitcnt lgkmcnt(0)
v_mfma_f32_16x16x32_bf16 v[196:199], v[200:203], v[116:119], v[196:199]
s_nop 7
ds_read_b128 v[200:203], v207 offset:26624
s_waitcnt lgkmcnt(0)
v_mfma_f32_16x16x32_bf16 v[196:199], v[200:203], v[120:123], v[196:199]
s_nop 7
ds_read_b128 v[200:203], v207 offset:27136
s_waitcnt lgkmcnt(0)
v_mfma_f32_16x16x32_bf16 v[196:199], v[200:203], v[124:127], v[196:199]
s_nop 7
s_nop 7
v_max_f32 v204, v192, v193
v_max3_f32 v204, v204, v194, v195
v_max3_f32 v204, v204, v196, v197
v_max3_f32 v204, v204, v198, v199
v_mov_b32 v205, v204
s_nop 1
v_permlane32_swap_b32 v204, v205
s_nop 1
v_max_f32 v204, v204, v205
v_mov_b32 v205, v204
s_nop 1
v_permlane16_swap_b32 v204, v205
s_nop 1
v_max_f32 v204, v204, v205
v_add_f32 v204, 40.0, v204
v_ceil_f32 v204, v204
v_max_f32 v204, 0, v204
v_sub_f32 v205, v227, v204
v_cvt_pk_bf16_f32 v205, v205, v205
v_and_b32 v205, 0xffff0000, v205
v_sub_f32 v204, v205, v227
v_mov_b32 v227, v205
v_exp_f32 v239, v204
v_bfi_b32 v99, v206, v205, v99
v_add_f32 v192, v192, v204
v_add_f32 v193, v193, v204
v_add_f32 v194, v194, v204
v_add_f32 v195, v195, v204
v_add_f32 v196, v196, v204
v_add_f32 v197, v197, v204
v_add_f32 v198, v198, v204
v_add_f32 v199, v199, v204
v_add_f32 v140, v140, v204
v_add_f32 v141, v141, v204
v_add_f32 v142, v142, v204
v_add_f32 v143, v143, v204
v_lshlrev_b32 v242, 16, v172
v_and_b32 v248, 0xffff0000, v172
v_mul_f32 v242, v242, v239
v_mul_f32 v248, v248, v239
v_cvt_pk_bf16_f32 v172, v242, v248
v_lshlrev_b32 v242, 16, v173
v_and_b32 v248, 0xffff0000, v173
v_mul_f32 v242, v242, v239
v_mul_f32 v248, v248, v239
v_cvt_pk_bf16_f32 v173, v242, v248
v_lshlrev_b32 v242, 16, v174
v_and_b32 v248, 0xffff0000, v174
v_mul_f32 v242, v242, v239
v_mul_f32 v248, v248, v239
v_cvt_pk_bf16_f32 v174, v242, v248
v_lshlrev_b32 v242, 16, v175
v_and_b32 v248, 0xffff0000, v175
v_mul_f32 v242, v242, v239
v_mul_f32 v248, v248, v239
v_cvt_pk_bf16_f32 v175, v242, v248
v_exp_f32 v232, v192
v_exp_f32 v233, v193
v_exp_f32 v234, v194
v_exp_f32 v235, v195
s_nop 1
v_cvt_pk_bf16_f32 v188, v232, v233
v_cvt_pk_bf16_f32 v189, v234, v235
v_exp_f32 v232, v196
v_exp_f32 v233, v197
v_exp_f32 v234, v198
v_exp_f32 v235, v199
s_nop 1
v_cvt_pk_bf16_f32 v190, v232, v233
v_cvt_pk_bf16_f32 v191, v234, v235
s_branch L2_rare_common
L2_rare_site2:
s_mov_b32 s36, 2
s_branch L2_rare_1
L2_rare_1:
s_nop 15
s_nop 15
s_waitcnt lgkmcnt(0)
v_lshrrev_b32 v206, 8, v243
v_add_u32 v206, 1, v206
v_lshrrev_b32 v206, 2, v206
v_sub_u32 v206, 0, v206
v_and_b32 v206, 0xffff0000, v206
v_add_u32 v207, 0x0, v240
v_and_b32 v207, 0x1ffff, v207
ds_read_b128 v[200:203], v207 offset:12800
s_waitcnt lgkmcnt(0)
v_mfma_f32_16x16x32_bf16 v[192:195], v[200:203], v[0:3], 0
s_nop 7
ds_read_b128 v[200:203], v207 offset:12288
s_waitcnt lgkmcnt(0)
v_mfma_f32_16x16x32_bf16 v[192:195], v[200:203], v[4:7], v[192:195]
s_nop 7
ds_read_b128 v[200:203], v207 offset:0
s_waitcnt lgkmcnt(0)
v_mfma_f32_16x16x32_bf16 v[192:195], v[200:203], v[8:11], v[192:195]
s_nop 7
ds_read_b128 v[200:203], v207 offset:512
s_waitcnt lgkmcnt(0)
v_mfma_f32_16x16x32_bf16 v[192:195], v[200:203], v[12:15], v[192:195]
s_nop 7
ds_read_b128 v[200:203], v207 offset:4096
s_waitcnt lgkmcnt(0)
v_mfma_f32_16x16x32_bf16 v[192:195], v[200:203], v[16:19], v[192:195]
s_nop 7
ds_read_b128 v[200:203], v207 offset:4608
s_waitcnt lgkmcnt(0)
v_mfma_f32_16x16x32_bf16 v[192:195], v[200:203], v[20:23], v[192:195]
s_nop 7
ds_read_b128 v[200:203], v207 offset:8192
s_waitcnt lgkmcnt(0)
v_mfma_f32_16x16x32_bf16 v[192:195], v[200:203], v[24:27], v[192:195]
s_nop 7
ds_read_b128 v[200:203], v207 offset:8704
s_waitcnt lgkmcnt(0)
v_mfma_f32_16x16x32_bf16 v[192:195], v[200:203], v[28:31], v[192:195]
s_nop 7
ds_read_b128 v[200:203], v207 offset:14848
s_waitcnt lgkmcnt(0)
v_mfma_f32_16x16x32_bf16 v[196:199], v[200:203], v[0:3], 0
s_nop 7
ds_read_b128 v[200:203], v207 offset:14336
s_waitcnt lgkmcnt(0)
v_mfma_f32_16x16x32_bf16 v[196:199], v[200:203], v[4:7], v[196:199]
s_nop 7
ds_read_b128 v[200:203], v207 offset:2048
s_waitcnt lgkmcnt(0)
v_mfma_f32_16x16x32_bf16 v[196:199], v[200:203], v[8:11], v[196:199]
s_nop 7
ds_read_b128 v[200:203], v207 offset:2560
s_waitcnt lgkmcnt(0)
v_mfma_f32_16x16x32_bf16 v[196:199], v[200:203], v[12:15], v[196:199]
s_nop 7
ds_read_b128 v[200:203], v207 offset:6144
s_waitcnt lgkmcnt(0)
v_mfma_f32_16x16x32_bf16 v[196:199], v[200:203], v[16:19], v[196:199]
s_nop 7
ds_read_b128 v[200:203], v207 offset:6656
s_waitcnt lgkmcnt(0)
v_mfma_f32_16x16x32_bf16 v[196:199], v[200:203], v[20:23], v[196:199]
s_nop 7
ds_read_b128 v[200:203], v207 offset:10240
s_waitcnt lgkmcnt(0)
v_mfma_f32_16x16x32_bf16 v[196:199], v[200:203], v[24:27], v[196:199]
s_nop 7
ds_read_b128 v[200:203], v207 offset:10752
s_waitcnt lgkmcnt(0)
v_mfma_f32_16x16x32_bf16 v[196:199], v[200:203], v[28:31], v[196:199]
s_nop 7
s_nop 7
v_max_f32 v204, v192, v193
v_max3_f32 v204, v204, v194, v195
v_max3_f32 v204, v204, v196, v197
v_max3_f32 v204, v204, v198, v199
v_mov_b32 v205, v204
s_nop 1
v_permlane32_swap_b32 v204, v205
s_nop 1
v_max_f32 v204, v204, v205
v_mov_b32 v205, v204
s_nop 1
v_permlane16_swap_b32 v204, v205
s_nop 1
v_max_f32 v204, v204, v205
v_add_f32 v204, 40.0, v204
v_ceil_f32 v204, v204
v_max_f32 v204, 0, v204
v_sub_f32 v205, v224, v204
v_cvt_pk_bf16_f32 v205, v205, v205
v_and_b32 v205, 0xffff0000, v205
v_sub_f32 v204, v205, v224
v_mov_b32 v224, v205
v_exp_f32 v236, v204
v_bfi_b32 v3, v206, v205, v3
v_add_f32 v192, v192, v204
v_add_f32 v193, v193, v204
v_add_f32 v194, v194, v204
v_add_f32 v195, v195, v204
v_add_f32 v196, v196, v204
v_add_f32 v197, v197, v204
v_add_f32 v198, v198, v204
v_add_f32 v199, v199, v204
v_add_f32 v128, v128, v204
v_add_f32 v129, v129, v204
v_add_f32 v130, v130, v204
v_add_f32 v131, v131, v204
v_lshlrev_b32 v242, 16, v176
v_and_b32 v248, 0xffff0000, v176
v_mul_f32 v242, v242, v236
v_mul_f32 v248, v248, v236
v_cvt_pk_bf16_f32 v176, v242, v248
v_lshlrev_b32 v242, 16, v177
v_and_b32 v248, 0xffff0000, v177
v_mul_f32 v242, v242, v236
v_mul_f32 v248, v248, v236
v_cvt_pk_bf16_f32 v177, v242, v248
v_lshlrev_b32 v242, 16, v178
v_and_b32 v248, 0xffff0000, v178
v_mul_f32 v242, v242, v236
v_mul_f32 v248, v248, v236
v_cvt_pk_bf16_f32 v178, v242, v248
v_lshlrev_b32 v242, 16, v179
v_and_b32 v248, 0xffff0000, v179
v_mul_f32 v242, v242, v236
v_mul_f32 v248, v248, v236
v_cvt_pk_bf16_f32 v179, v242, v248
v_exp_f32 v232, v192
v_exp_f32 v233, v193
v_exp_f32 v234, v194
v_exp_f32 v235, v195
s_nop 1
v_cvt_pk_bf16_f32 v160, v232, v233
v_cvt_pk_bf16_f32 v161, v234, v235
v_exp_f32 v232, v196
v_exp_f32 v233, v197
v_exp_f32 v234, v198
v_exp_f32 v235, v199
s_nop 1
v_cvt_pk_bf16_f32 v162, v232, v233
v_cvt_pk_bf16_f32 v163, v234, v235
ds_read_b128 v[200:203], v207 offset:12800
s_waitcnt lgkmcnt(0)
v_mfma_f32_16x16x32_bf16 v[192:195], v[200:203], v[32:35], 0
s_nop 7
ds_read_b128 v[200:203], v207 offset:12288
s_waitcnt lgkmcnt(0)
v_mfma_f32_16x16x32_bf16 v[192:195], v[200:203], v[36:39], v[192:195]
s_nop 7
ds_read_b128 v[200:203], v207 offset:0
s_waitcnt lgkmcnt(0)
v_mfma_f32_16x16x32_bf16 v[192:195], v[200:203], v[40:43], v[192:195]
s_nop 7
ds_read_b128 v[200:203], v207 offset:512
s_waitcnt lgkmcnt(0)
v_mfma_f32_16x16x32_bf16 v[192:195], v[200:203], v[44:47], v[192:195]
s_nop 7
ds_read_b128 v[200:203], v207 offset:4096
s_waitcnt lgkmcnt(0)
v_mfma_f32_16x16x32_bf16 v[192:195], v[200:203], v[48:51], v[192:195]
s_nop 7
ds_read_b128 v[200:203], v207 offset:4608
s_waitcnt lgkmcnt(0)
v_mfma_f32_16x16x32_bf16 v[192:195], v[200:203], v[52:55], v[192:195]
s_nop 7
ds_read_b128 v[200:203], v207 offset:8192
s_waitcnt lgkmcnt(0)
v_mfma_f32_16x16x32_bf16 v[192:195], v[200:203], v[56:59], v[192:195]
s_nop 7
ds_read_b128 v[200:203], v207 offset:8704
s_waitcnt lgkmcnt(0)
v_mfma_f32_16x16x32_bf16 v[192:195], v[200:203], v[60:63], v[192:195]
s_nop 7
ds_read_b128 v[200:203], v207 offset:14848
s_waitcnt lgkmcnt(0)
v_mfma_f32_16x16x32_bf16 v[196:199], v[200:203], v[32:35], 0
s_nop 7
ds_read_b128 v[200:203], v207 offset:14336
s_waitcnt lgkmcnt(0)
v_mfma_f32_16x16x32_bf16 v[196:199], v[200:203], v[36:39], v[196:199]
s_nop 7
ds_read_b128 v[200:203], v207 offset:2048
s_waitcnt lgkmcnt(0)
v_mfma_f32_16x16x32_bf16 v[196:199], v[200:203], v[40:43], v[196:199]
s_nop 7
ds_read_b128 v[200:203], v207 offset:2560
s_waitcnt lgkmcnt(0)
v_mfma_f32_16x16x32_bf16 v[196:199], v[200:203], v[44:47], v[196:199]
s_nop 7
ds_read_b128 v[200:203], v207 offset:6144
s_waitcnt lgkmcnt(0)
v_mfma_f32_16x16x32_bf16 v[196:199], v[200:203], v[48:51], v[196:199]
s_nop 7
ds_read_b128 v[200:203], v207 offset:6656
s_waitcnt lgkmcnt(0)
v_mfma_f32_16x16x32_bf16 v[196:199], v[200:203], v[52:55], v[196:199]
s_nop 7
ds_read_b128 v[200:203], v207 offset:10240
s_waitcnt lgkmcnt(0)
v_mfma_f32_16x16x32_bf16 v[196:199], v[200:203], v[56:59], v[196:199]
s_nop 7
ds_read_b128 v[200:203], v207 offset:10752
s_waitcnt lgkmcnt(0)
v_mfma_f32_16x16x32_bf16 v[196:199], v[200:203], v[60:63], v[196:199]
s_nop 7
s_nop 7
v_max_f32 v204, v192, v193
v_max3_f32 v204, v204, v194, v195
v_max3_f32 v204, v204, v196, v197
v_max3_f32 v204, v204, v198, v199
v_mov_b32 v205, v204
s_nop 1
v_permlane32_swap_b32 v204, v205
s_nop 1
v_max_f32 v204, v204, v205
v_mov_b32 v205, v204
s_nop 1
v_permlane16_swap_b32 v204, v205
s_nop 1
v_max_f32 v204, v204, v205
v_add_f32 v204, 40.0, v204
v_ceil_f32 v204, v204
v_max_f32 v204, 0, v204
v_sub_f32 v205, v225, v204
v_cvt_pk_bf16_f32 v205, v205, v205
v_and_b32 v205, 0xffff0000, v205
v_sub_f32 v204, v205, v225
v_mov_b32 v225, v205
v_exp_f32 v237, v204
v_bfi_b32 v35, v206, v205, v35
v_add_f32 v192, v192, v204
v_add_f32 v193, v193, v204
v_add_f32 v194, v194, v204
v_add_f32 v195, v195, v204
v_add_f32 v196, v196, v204
v_add_f32 v197, v197, v204
v_add_f32 v198, v198, v204
v_add_f32 v199, v199, v204
v_add_f32 v132, v132, v204
v_add_f32 v133, v133, v204
v_add_f32 v134, v134, v204
v_add_f32 v135, v135, v204
v_lshlrev_b32 v242, 16, v180
v_and_b32 v248, 0xffff0000, v180
v_mul_f32 v242, v242, v237
v_mul_f32 v248, v248, v237
v_cvt_pk_bf16_f32 v180, v242, v248
v_lshlrev_b32 v242, 16, v181
v_and_b32 v248, 0xffff0000, v181
v_mul_f32 v242, v242, v237
v_mul_f32 v248, v248, v237
v_cvt_pk_bf16_f32 v181, v242, v248
v_lshlrev_b32 v242, 16, v182
v_and_b32 v248, 0xffff0000, v182
v_mul_f32 v242, v242, v237
v_mul_f32 v248, v248, v237
v_cvt_pk_bf16_f32 v182, v242, v248
v_lshlrev_b32 v242, 16, v183
v_and_b32 v248, 0xffff0000, v183
v_mul_f32 v242, v242, v237
v_mul_f32 v248, v248, v237
v_cvt_pk_bf16_f32 v183, v242, v248
v_exp_f32 v232, v192
v_exp_f32 v233, v193
v_exp_f32 v234, v194
v_exp_f32 v235, v195
s_nop 1
v_cvt_pk_bf16_f32 v164, v232, v233
v_cvt_pk_bf16_f32 v165, v234, v235
v_exp_f32 v232, v196
v_exp_f32 v233, v197
v_exp_f32 v234, v198
v_exp_f32 v235, v199
s_nop 1
v_cvt_pk_bf16_f32 v166, v232, v233
v_cvt_pk_bf16_f32 v167, v234, v235
ds_read_b128 v[200:203], v207 offset:12800
s_waitcnt lgkmcnt(0)
v_mfma_f32_16x16x32_bf16 v[192:195], v[200:203], v[64:67], 0
s_nop 7
ds_read_b128 v[200:203], v207 offset:12288
s_waitcnt lgkmcnt(0)
v_mfma_f32_16x16x32_bf16 v[192:195], v[200:203], v[68:71], v[192:195]
s_nop 7
ds_read_b128 v[200:203], v207 offset:0
s_waitcnt lgkmcnt(0)
v_mfma_f32_16x16x32_bf16 v[192:195], v[200:203], v[72:75], v[192:195]
s_nop 7
ds_read_b128 v[200:203], v207 offset:512
s_waitcnt lgkmcnt(0)
v_mfma_f32_16x16x32_bf16 v[192:195], v[200:203], v[76:79], v[192:195]
s_nop 7
ds_read_b128 v[200:203], v207 offset:4096
s_waitcnt lgkmcnt(0)
v_mfma_f32_16x16x32_bf16 v[192:195], v[200:203], v[80:83], v[192:195]
s_nop 7
ds_read_b128 v[200:203], v207 offset:4608
s_waitcnt lgkmcnt(0)
v_mfma_f32_16x16x32_bf16 v[192:195], v[200:203], v[84:87], v[192:195]
s_nop 7
ds_read_b128 v[200:203], v207 offset:8192
s_waitcnt lgkmcnt(0)
v_mfma_f32_16x16x32_bf16 v[192:195], v[200:203], v[88:91], v[192:195]
s_nop 7
ds_read_b128 v[200:203], v207 offset:8704
s_waitcnt lgkmcnt(0)
v_mfma_f32_16x16x32_bf16 v[192:195], v[200:203], v[92:95], v[192:195]
s_nop 7
ds_read_b128 v[200:203], v207 offset:14848
s_waitcnt lgkmcnt(0)
v_mfma_f32_16x16x32_bf16 v[196:199], v[200:203], v[64:67], 0
s_nop 7
ds_read_b128 v[200:203], v207 offset:14336
s_waitcnt lgkmcnt(0)
v_mfma_f32_16x16x32_bf16 v[196:199], v[200:203], v[68:71], v[196:199]
s_nop 7
ds_read_b128 v[200:203], v207 offset:2048
s_waitcnt lgkmcnt(0)
v_mfma_f32_16x16x32_bf16 v[196:199], v[200:203], v[72:75], v[196:199]
s_nop 7
ds_read_b128 v[200:203], v207 offset:2560
s_waitcnt lgkmcnt(0)
v_mfma_f32_16x16x32_bf16 v[196:199], v[200:203], v[76:79], v[196:199]
s_nop 7
ds_read_b128 v[200:203], v207 offset:6144
s_waitcnt lgkmcnt(0)
v_mfma_f32_16x16x32_bf16 v[196:199], v[200:203], v[80:83], v[196:199]
s_nop 7
ds_read_b128 v[200:203], v207 offset:6656
s_waitcnt lgkmcnt(0)
v_mfma_f32_16x16x32_bf16 v[196:199], v[200:203], v[84:87], v[196:199]
s_nop 7
ds_read_b128 v[200:203], v207 offset:10240
s_waitcnt lgkmcnt(0)
v_mfma_f32_16x16x32_bf16 v[196:199], v[200:203], v[88:91], v[196:199]
s_nop 7
ds_read_b128 v[200:203], v207 offset:10752
s_waitcnt lgkmcnt(0)
v_mfma_f32_16x16x32_bf16 v[196:199], v[200:203], v[92:95], v[196:199]
s_nop 7
s_nop 7
v_max_f32 v204, v192, v193
v_max3_f32 v204, v204, v194, v195
v_max3_f32 v204, v204, v196, v197
v_max3_f32 v204, v204, v198, v199
v_mov_b32 v205, v204
s_nop 1
v_permlane32_swap_b32 v204, v205
s_nop 1
v_max_f32 v204, v204, v205
v_mov_b32 v205, v204
s_nop 1
v_permlane16_swap_b32 v204, v205
s_nop 1
v_max_f32 v204, v204, v205
v_add_f32 v204, 40.0, v204
v_ceil_f32 v204, v204
v_max_f32 v204, 0, v204
v_sub_f32 v205, v226, v204
v_cvt_pk_bf16_f32 v205, v205, v205
v_and_b32 v205, 0xffff0000, v205
v_sub_f32 v204, v205, v226
v_mov_b32 v226, v205
v_exp_f32 v238, v204
v_bfi_b32 v67, v206, v205, v67
v_add_f32 v192, v192, v204
v_add_f32 v193, v193, v204
v_add_f32 v194, v194, v204
v_add_f32 v195, v195, v204
v_add_f32 v196, v196, v204
v_add_f32 v197, v197, v204
v_add_f32 v198, v198, v204
v_add_f32 v199, v199, v204
v_add_f32 v136, v136, v204
v_add_f32 v137, v137, v204
v_add_f32 v138, v138, v204
v_add_f32 v139, v139, v204
v_lshlrev_b32 v242, 16, v184
v_and_b32 v248, 0xffff0000, v184
v_mul_f32 v242, v242, v238
v_mul_f32 v248, v248, v238
v_cvt_pk_bf16_f32 v184, v242, v248
v_lshlrev_b32 v242, 16, v185
v_and_b32 v248, 0xffff0000, v185
v_mul_f32 v242, v242, v238
v_mul_f32 v248, v248, v238
v_cvt_pk_bf16_f32 v185, v242, v248
v_lshlrev_b32 v242, 16, v186
v_and_b32 v248, 0xffff0000, v186
v_mul_f32 v242, v242, v238
v_mul_f32 v248, v248, v238
v_cvt_pk_bf16_f32 v186, v242, v248
v_lshlrev_b32 v242, 16, v187
v_and_b32 v248, 0xffff0000, v187
v_mul_f32 v242, v242, v238
v_mul_f32 v248, v248, v238
v_cvt_pk_bf16_f32 v187, v242, v248
v_exp_f32 v232, v192
v_exp_f32 v233, v193
v_exp_f32 v234, v194
v_exp_f32 v235, v195
s_nop 1
v_cvt_pk_bf16_f32 v168, v232, v233
v_cvt_pk_bf16_f32 v169, v234, v235
v_exp_f32 v232, v196
v_exp_f32 v233, v197
v_exp_f32 v234, v198
v_exp_f32 v235, v199
s_nop 1
v_cvt_pk_bf16_f32 v170, v232, v233
v_cvt_pk_bf16_f32 v171, v234, v235
ds_read_b128 v[200:203], v207 offset:12800
s_waitcnt lgkmcnt(0)
v_mfma_f32_16x16x32_bf16 v[192:195], v[200:203], v[96:99], 0
s_nop 7
ds_read_b128 v[200:203], v207 offset:12288
s_waitcnt lgkmcnt(0)
v_mfma_f32_16x16x32_bf16 v[192:195], v[200:203], v[100:103], v[192:195]
s_nop 7
ds_read_b128 v[200:203], v207 offset:0
s_waitcnt lgkmcnt(0)
v_mfma_f32_16x16x32_bf16 v[192:195], v[200:203], v[104:107], v[192:195]
s_nop 7
ds_read_b128 v[200:203], v207 offset:512
s_waitcnt lgkmcnt(0)
v_mfma_f32_16x16x32_bf16 v[192:195], v[200:203], v[108:111], v[192:195]
s_nop 7
ds_read_b128 v[200:203], v207 offset:4096
s_waitcnt lgkmcnt(0)
v_mfma_f32_16x16x32_bf16 v[192:195], v[200:203], v[112:115], v[192:195]
s_nop 7
ds_read_b128 v[200:203], v207 offset:4608
s_waitcnt lgkmcnt(0)
v_mfma_f32_16x16x32_bf16 v[192:195], v[200:203], v[116:119], v[192:195]
s_nop 7
ds_read_b128 v[200:203], v207 offset:8192
s_waitcnt lgkmcnt(0)
v_mfma_f32_16x16x32_bf16 v[192:195], v[200:203], v[120:123], v[192:195]
s_nop 7
ds_read_b128 v[200:203], v207 offset:8704
s_waitcnt lgkmcnt(0)
v_mfma_f32_16x16x32_bf16 v[192:195], v[200:203], v[124:127], v[192:195]
s_nop 7
ds_read_b128 v[200:203], v207 offset:14848
s_waitcnt lgkmcnt(0)
v_mfma_f32_16x16x32_bf16 v[196:199], v[200:203], v[96:99], 0
s_nop 7
ds_read_b128 v[200:203], v207 offset:14336
s_waitcnt lgkmcnt(0)
v_mfma_f32_16x16x32_bf16 v[196:199], v[200:203], v[100:103], v[196:199]
s_nop 7
ds_read_b128 v[200:203], v207 offset:2048
s_waitcnt lgkmcnt(0)
v_mfma_f32_16x16x32_bf16 v[196:199], v[200:203], v[104:107], v[196:199]
s_nop 7
ds_read_b128 v[200:203], v207 offset:2560
s_waitcnt lgkmcnt(0)
v_mfma_f32_16x16x32_bf16 v[196:199], v[200:203], v[108:111], v[196:199]
s_nop 7
ds_read_b128 v[200:203], v207 offset:6144
s_waitcnt lgkmcnt(0)
v_mfma_f32_16x16x32_bf16 v[196:199], v[200:203], v[112:115], v[196:199]
s_nop 7
ds_read_b128 v[200:203], v207 offset:6656
s_waitcnt lgkmcnt(0)
v_mfma_f32_16x16x32_bf16 v[196:199], v[200:203], v[116:119], v[196:199]
s_nop 7
ds_read_b128 v[200:203], v207 offset:10240
s_waitcnt lgkmcnt(0)
v_mfma_f32_16x16x32_bf16 v[196:199], v[200:203], v[120:123], v[196:199]
s_nop 7
ds_read_b128 v[200:203], v207 offset:10752
s_waitcnt lgkmcnt(0)
v_mfma_f32_16x16x32_bf16 v[196:199], v[200:203], v[124:127], v[196:199]
s_nop 7
s_nop 7
v_max_f32 v204, v192, v193
v_max3_f32 v204, v204, v194, v195
v_max3_f32 v204, v204, v196, v197
v_max3_f32 v204, v204, v198, v199
v_mov_b32 v205, v204
s_nop 1
v_permlane32_swap_b32 v204, v205
s_nop 1
v_max_f32 v204, v204, v205
v_mov_b32 v205, v204
s_nop 1
v_permlane16_swap_b32 v204, v205
s_nop 1
v_max_f32 v204, v204, v205
v_add_f32 v204, 40.0, v204
v_ceil_f32 v204, v204
v_max_f32 v204, 0, v204
v_sub_f32 v205, v227, v204
v_cvt_pk_bf16_f32 v205, v205, v205
v_and_b32 v205, 0xffff0000, v205
v_sub_f32 v204, v205, v227
v_mov_b32 v227, v205
v_exp_f32 v239, v204
v_bfi_b32 v99, v206, v205, v99
v_add_f32 v192, v192, v204
v_add_f32 v193, v193, v204
v_add_f32 v194, v194, v204
v_add_f32 v195, v195, v204
v_add_f32 v196, v196, v204
v_add_f32 v197, v197, v204
v_add_f32 v198, v198, v204
v_add_f32 v199, v199, v204
v_add_f32 v140, v140, v204
v_add_f32 v141, v141, v204
v_add_f32 v142, v142, v204
v_add_f32 v143, v143, v204
v_lshlrev_b32 v242, 16, v188
v_and_b32 v248, 0xffff0000, v188
v_mul_f32 v242, v242, v239
v_mul_f32 v248, v248, v239
v_cvt_pk_bf16_f32 v188, v242, v248
v_lshlrev_b32 v242, 16, v189
v_and_b32 v248, 0xffff0000, v189
v_mul_f32 v242, v242, v239
v_mul_f32 v248, v248, v239
v_cvt_pk_bf16_f32 v189, v242, v248
v_lshlrev_b32 v242, 16, v190
v_and_b32 v248, 0xffff0000, v190
v_mul_f32 v242, v242, v239
v_mul_f32 v248, v248, v239
v_cvt_pk_bf16_f32 v190, v242, v248
v_lshlrev_b32 v242, 16, v191
v_and_b32 v248, 0xffff0000, v191
v_mul_f32 v242, v242, v239
v_mul_f32 v248, v248, v239
v_cvt_pk_bf16_f32 v191, v242, v248
v_exp_f32 v232, v192
v_exp_f32 v233, v193
v_exp_f32 v234, v194
v_exp_f32 v235, v195
s_nop 1
v_cvt_pk_bf16_f32 v172, v232, v233
v_cvt_pk_bf16_f32 v173, v234, v235
v_exp_f32 v232, v196
v_exp_f32 v233, v197
v_exp_f32 v234, v198
v_exp_f32 v235, v199
s_nop 1
v_cvt_pk_bf16_f32 v174, v232, v233
v_cvt_pk_bf16_f32 v175, v234, v235
s_branch L2_rare_common
L2_rare_site6:
s_mov_b32 s36, 6
s_branch L2_rare_t1_0
L2_rare_t1_0:
s_nop 15
s_nop 15
s_waitcnt lgkmcnt(0)
v_lshrrev_b32 v206, 8, v243
v_add_u32 v206, 1, v206
v_lshrrev_b32 v206, 2, v206
v_sub_u32 v206, 0, v206
v_and_b32 v206, 0xffff0000, v206
v_max_f32 v204, v128, v129
v_max3_f32 v204, v204, v130, v131
v_mov_b32 v205, v204
s_nop 1
v_permlane32_swap_b32 v204, v205
s_nop 1
v_max_f32 v204, v204, v205
v_mov_b32 v205, v204
s_nop 1
v_permlane16_swap_b32 v204, v205
s_nop 1
v_max_f32 v204, v204, v205
v_add_f32 v204, 40.0, v204
v_ceil_f32 v204, v204
v_max_f32 v204, 0, v204
v_sub_f32 v205, v224, v204
v_cvt_pk_bf16_f32 v205, v205, v205
v_and_b32 v205, 0xffff0000, v205
v_sub_f32 v204, v205, v224
v_mov_b32 v224, v205
v_exp_f32 v236, v204
v_bfi_b32 v3, v206, v205, v3
v_add_f32 v128, v128, v204
v_add_f32 v129, v129, v204
v_add_f32 v130, v130, v204
v_add_f32 v131, v131, v204
v_add_f32 v144, v144, v204
v_add_f32 v145, v145, v204
v_add_f32 v146, v146, v204
v_add_f32 v147, v147, v204
v_lshlrev_b32 v242, 16, v160
v_and_b32 v248, 0xffff0000, v160
v_mul_f32 v242, v242, v236
v_mul_f32 v248, v248, v236
v_cvt_pk_bf16_f32 v160, v242, v248
v_lshlrev_b32 v242, 16, v161
v_and_b32 v248, 0xffff0000, v161
v_mul_f32 v242, v242, v236
v_mul_f32 v248, v248, v236
v_cvt_pk_bf16_f32 v161, v242, v248
v_lshlrev_b32 v242, 16, v162
v_and_b32 v248, 0xffff0000, v162
v_mul_f32 v242, v242, v236
v_mul_f32 v248, v248, v236
v_cvt_pk_bf16_f32 v162, v242, v248
v_lshlrev_b32 v242, 16, v163
v_and_b32 v248, 0xffff0000, v163
v_mul_f32 v242, v242, v236
v_mul_f32 v248, v248, v236
v_cvt_pk_bf16_f32 v163, v242, v248
ds_read_b64 v[250:251], v231 offset:0
s_waitcnt lgkmcnt(0)
v_lshlrev_b32 v242, 16, v250
v_and_b32 v248, 0xffff0000, v250
v_mul_f32 v242, v242, v236
v_mul_f32 v248, v248, v236
v_cvt_pk_bf16_f32 v250, v242, v248
v_lshlrev_b32 v242, 16, v251
v_and_b32 v248, 0xffff0000, v251
v_mul_f32 v242, v242, v236
v_mul_f32 v248, v248, v236
v_cvt_pk_bf16_f32 v251, v242, v248
ds_write_b64 v231, v[250:251] offset:0
s_waitcnt lgkmcnt(0)
ds_read_b64 v[250:251], v231 offset:8
s_waitcnt lgkmcnt(0)
v_lshlrev_b32 v242, 16, v250
v_and_b32 v248, 0xffff0000, v250
v_mul_f32 v242, v242, v236
v_mul_f32 v248, v248, v236
v_cvt_pk_bf16_f32 v250, v242, v248
v_lshlrev_b32 v242, 16, v251
v_and_b32 v248, 0xffff0000, v251
v_mul_f32 v242, v242, v236
v_mul_f32 v248, v248, v236
v_cvt_pk_bf16_f32 v251, v242, v248
ds_write_b64 v231, v[250:251] offset:8
s_waitcnt lgkmcnt(0)
v_exp_f32 v232, v128
v_exp_f32 v233, v129
v_exp_f32 v234, v130
v_exp_f32 v235, v131
s_nop 1
v_cvt_pk_bf16_f32 v176, v232, v233
v_cvt_pk_bf16_f32 v177, v234, v235
v_max_f32 v204, v132, v133
v_max3_f32 v204, v204, v134, v135
v_mov_b32 v205, v204
s_nop 1
v_permlane32_swap_b32 v204, v205
s_nop 1
v_max_f32 v204, v204, v205
v_mov_b32 v205, v204
s_nop 1
v_permlane16_swap_b32 v204, v205
s_nop 1
v_max_f32 v204, v204, v205
v_add_f32 v204, 40.0, v204
v_ceil_f32 v204, v204
v_max_f32 v204, 0, v204
v_sub_f32 v205, v225, v204
v_cvt_pk_bf16_f32 v205, v205, v205
v_and_b32 v205, 0xffff0000, v205
v_sub_f32 v204, v205, v225
v_mov_b32 v225, v205
v_exp_f32 v237, v204
v_bfi_b32 v35, v206, v205, v35
v_add_f32 v132, v132, v204
v_add_f32 v133, v133, v204
v_add_f32 v134, v134, v204
v_add_f32 v135, v135, v204
v_add_f32 v148, v148, v204
v_add_f32 v149, v149, v204
v_add_f32 v150, v150, v204
v_add_f32 v151, v151, v204
v_lshlrev_b32 v242, 16, v164
v_and_b32 v248, 0xffff0000, v164
v_mul_f32 v242, v242, v237
v_mul_f32 v248, v248, v237
v_cvt_pk_bf16_f32 v164, v242, v248
v_lshlrev_b32 v242, 16, v165
v_and_b32 v248, 0xffff0000, v165
v_mul_f32 v242, v242, v237
v_mul_f32 v248, v248, v237
v_cvt_pk_bf16_f32 v165, v242, v248
v_lshlrev_b32 v242, 16, v166
v_and_b32 v248, 0xffff0000, v166
v_mul_f32 v242, v242, v237
v_mul_f32 v248, v248, v237
v_cvt_pk_bf16_f32 v166, v242, v248
v_lshlrev_b32 v242, 16, v167
v_and_b32 v248, 0xffff0000, v167
v_mul_f32 v242, v242, v237
v_mul_f32 v248, v248, v237
v_cvt_pk_bf16_f32 v167, v242, v248
ds_read_b64 v[250:251], v231 offset:1024
s_waitcnt lgkmcnt(0)
v_lshlrev_b32 v242, 16, v250
v_and_b32 v248, 0xffff0000, v250
v_mul_f32 v242, v242, v237
v_mul_f32 v248, v248, v237
v_cvt_pk_bf16_f32 v250, v242, v248
v_lshlrev_b32 v242, 16, v251
v_and_b32 v248, 0xffff0000, v251
v_mul_f32 v242, v242, v237
v_mul_f32 v248, v248, v237
v_cvt_pk_bf16_f32 v251, v242, v248
ds_write_b64 v231, v[250:251] offset:1024
s_waitcnt lgkmcnt(0)
ds_read_b64 v[250:251], v231 offset:1032
s_waitcnt lgkmcnt(0)
v_lshlrev_b32 v242, 16, v250
v_and_b32 v248, 0xffff0000, v250
v_mul_f32 v242, v242, v237
v_mul_f32 v248, v248, v237
v_cvt_pk_bf16_f32 v250, v242, v248
v_lshlrev_b32 v242, 16, v251
v_and_b32 v248, 0xffff0000, v251
v_mul_f32 v242, v242, v237
v_mul_f32 v248, v248, v237
v_cvt_pk_bf16_f32 v251, v242, v248
ds_write_b64 v231, v[250:251] offset:1032
s_waitcnt lgkmcnt(0)
v_exp_f32 v232, v132
v_exp_f32 v233, v133
v_exp_f32 v234, v134
v_exp_f32 v235, v135
s_nop 1
v_cvt_pk_bf16_f32 v180, v232, v233
v_cvt_pk_bf16_f32 v181, v234, v235
v_max_f32 v204, v136, v137
v_max3_f32 v204, v204, v138, v139
v_mov_b32 v205, v204
s_nop 1
v_permlane32_swap_b32 v204, v205
s_nop 1
v_max_f32 v204, v204, v205
v_mov_b32 v205, v204
s_nop 1
v_permlane16_swap_b32 v204, v205
s_nop 1
v_max_f32 v204, v204, v205
v_add_f32 v204, 40.0, v204
v_ceil_f32 v204, v204
v_max_f32 v204, 0, v204
v_sub_f32 v205, v226, v204
v_cvt_pk_bf16_f32 v205, v205, v205
v_and_b32 v205, 0xffff0000, v205
v_sub_f32 v204, v205, v226
v_mov_b32 v226, v205
v_exp_f32 v238, v204
v_bfi_b32 v67, v206, v205, v67
v_add_f32 v136, v136, v204
v_add_f32 v137, v137, v204
v_add_f32 v138, v138, v204
v_add_f32 v139, v139, v204
v_add_f32 v152, v152, v204
v_add_f32 v153, v153, v204
v_add_f32 v154, v154, v204
v_add_f32 v155, v155, v204
v_lshlrev_b32 v242, 16, v168
v_and_b32 v248, 0xffff0000, v168
v_mul_f32 v242, v242, v238
v_mul_f32 v248, v248, v238
v_cvt_pk_bf16_f32 v168, v242, v248
v_lshlrev_b32 v242, 16, v169
v_and_b32 v248, 0xffff0000, v169
v_mul_f32 v242, v242, v238
v_mul_f32 v248, v248, v238
v_cvt_pk_bf16_f32 v169, v242, v248
v_lshlrev_b32 v242, 16, v170
v_and_b32 v248, 0xffff0000, v170
v_mul_f32 v242, v242, v238
v_mul_f32 v248, v248, v238
v_cvt_pk_bf16_f32 v170, v242, v248
v_lshlrev_b32 v242, 16, v171
v_and_b32 v248, 0xffff0000, v171
v_mul_f32 v242, v242, v238
v_mul_f32 v248, v248, v238
v_cvt_pk_bf16_f32 v171, v242, v248
ds_read_b64 v[250:251], v231 offset:2048
s_waitcnt lgkmcnt(0)
v_lshlrev_b32 v242, 16, v250
v_and_b32 v248, 0xffff0000, v250
v_mul_f32 v242, v242, v238
v_mul_f32 v248, v248, v238
v_cvt_pk_bf16_f32 v250, v242, v248
v_lshlrev_b32 v242, 16, v251
v_and_b32 v248, 0xffff0000, v251
v_mul_f32 v242, v242, v238
v_mul_f32 v248, v248, v238
v_cvt_pk_bf16_f32 v251, v242, v248
ds_write_b64 v231, v[250:251] offset:2048
s_waitcnt lgkmcnt(0)
ds_read_b64 v[250:251], v231 offset:2056
s_waitcnt lgkmcnt(0)
v_lshlrev_b32 v242, 16, v250
v_and_b32 v248, 0xffff0000, v250
v_mul_f32 v242, v242, v238
v_mul_f32 v248, v248, v238
v_cvt_pk_bf16_f32 v250, v242, v248
v_lshlrev_b32 v242, 16, v251
v_and_b32 v248, 0xffff0000, v251
v_mul_f32 v242, v242, v238
v_mul_f32 v248, v248, v238
v_cvt_pk_bf16_f32 v251, v242, v248
ds_write_b64 v231, v[250:251] offset:2056
s_waitcnt lgkmcnt(0)
v_exp_f32 v232, v136
v_exp_f32 v233, v137
v_exp_f32 v234, v138
v_exp_f32 v235, v139
s_nop 1
v_cvt_pk_bf16_f32 v184, v232, v233
v_cvt_pk_bf16_f32 v185, v234, v235
v_max_f32 v204, v140, v141
v_max3_f32 v204, v204, v142, v143
v_mov_b32 v205, v204
s_nop 1
v_permlane32_swap_b32 v204, v205
s_nop 1
v_max_f32 v204, v204, v205
v_mov_b32 v205, v204
s_nop 1
v_permlane16_swap_b32 v204, v205
s_nop 1
v_max_f32 v204, v204, v205
v_add_f32 v204, 40.0, v204
v_ceil_f32 v204, v204
v_max_f32 v204, 0, v204
v_sub_f32 v205, v227, v204
v_cvt_pk_bf16_f32 v205, v205, v205
v_and_b32 v205, 0xffff0000, v205
v_sub_f32 v204, v205, v227
v_mov_b32 v227, v205
v_exp_f32 v239, v204
v_bfi_b32 v99, v206, v205, v99
v_add_f32 v140, v140, v204
v_add_f32 v141, v141, v204
v_add_f32 v142, v142, v204
v_add_f32 v143, v143, v204
v_add_f32 v156, v156, v204
v_add_f32 v157, v157, v204
v_add_f32 v158, v158, v204
v_add_f32 v159, v159, v204
v_lshlrev_b32 v242, 16, v172
v_and_b32 v248, 0xffff0000, v172
v_mul_f32 v242, v242, v239
v_mul_f32 v248, v248, v239
v_cvt_pk_bf16_f32 v172, v242, v248
v_lshlrev_b32 v242, 16, v173
v_and_b32 v248, 0xffff0000, v173
v_mul_f32 v242, v242, v239
v_mul_f32 v248, v248, v239
v_cvt_pk_bf16_f32 v173, v242, v248
v_lshlrev_b32 v242, 16, v174
v_and_b32 v248, 0xffff0000, v174
v_mul_f32 v242, v242, v239
v_mul_f32 v248, v248, v239
v_cvt_pk_bf16_f32 v174, v242, v248
v_lshlrev_b32 v242, 16, v175
v_and_b32 v248, 0xffff0000, v175
v_mul_f32 v242, v242, v239
v_mul_f32 v248, v248, v239
v_cvt_pk_bf16_f32 v175, v242, v248
ds_read_b64 v[250:251], v231 offset:3072
s_waitcnt lgkmcnt(0)
v_lshlrev_b32 v242, 16, v250
v_and_b32 v248, 0xffff0000, v250
v_mul_f32 v242, v242, v239
v_mul_f32 v248, v248, v239
v_cvt_pk_bf16_f32 v250, v242, v248
v_lshlrev_b32 v242, 16, v251
v_and_b32 v248, 0xffff0000, v251
v_mul_f32 v242, v242, v239
v_mul_f32 v248, v248, v239
v_cvt_pk_bf16_f32 v251, v242, v248
ds_write_b64 v231, v[250:251] offset:3072
s_waitcnt lgkmcnt(0)
ds_read_b64 v[250:251], v231 offset:3080
s_waitcnt lgkmcnt(0)
v_lshlrev_b32 v242, 16, v250
v_and_b32 v248, 0xffff0000, v250
v_mul_f32 v242, v242, v239
v_mul_f32 v248, v248, v239
v_cvt_pk_bf16_f32 v250, v242, v248
v_lshlrev_b32 v242, 16, v251
v_and_b32 v248, 0xffff0000, v251
v_mul_f32 v242, v242, v239
v_mul_f32 v248, v248, v239
v_cvt_pk_bf16_f32 v251, v242, v248
ds_write_b64 v231, v[250:251] offset:3080
s_waitcnt lgkmcnt(0)
v_exp_f32 v232, v140
v_exp_f32 v233, v141
v_exp_f32 v234, v142
v_exp_f32 v235, v143
s_nop 1
v_cvt_pk_bf16_f32 v188, v232, v233
v_cvt_pk_bf16_f32 v189, v234, v235
s_branch L2_rare_common
L2_rare_site7:
s_mov_b32 s36, 7
s_branch L2_rare_t1_1
L2_rare_t1_1:
s_nop 15
s_nop 15
s_waitcnt lgkmcnt(0)
v_lshrrev_b32 v206, 8, v243
v_add_u32 v206, 1, v206
v_lshrrev_b32 v206, 2, v206
v_sub_u32 v206, 0, v206
v_and_b32 v206, 0xffff0000, v206
v_max_f32 v204, v144, v145
v_max3_f32 v204, v204, v146, v147
v_mov_b32 v205, v204
s_nop 1
v_permlane32_swap_b32 v204, v205
s_nop 1
v_max_f32 v204, v204, v205
v_mov_b32 v205, v204
s_nop 1
v_permlane16_swap_b32 v204, v205
s_nop 1
v_max_f32 v204, v204, v205
v_add_f32 v204, 40.0, v204
v_ceil_f32 v204, v204
v_max_f32 v204, 0, v204
v_sub_f32 v205, v224, v204
v_cvt_pk_bf16_f32 v205, v205, v205
v_and_b32 v205, 0xffff0000, v205
v_sub_f32 v204, v205, v224
v_mov_b32 v224, v205
v_exp_f32 v236, v204
v_bfi_b32 v3, v206, v205, v3
v_add_f32 v144, v144, v204
v_add_f32 v145, v145, v204
v_add_f32 v146, v146, v204
v_add_f32 v147, v147, v204
v_add_f32 v128, v128, v204
v_add_f32 v129, v129, v204
v_add_f32 v130, v130, v204
v_add_f32 v131, v131, v204
v_lshlrev_b32 v242, 16, v176
v_and_b32 v248, 0xffff0000, v176
v_mul_f32 v242, v242, v236
v_mul_f32 v248, v248, v236
v_cvt_pk_bf16_f32 v176, v242, v248
v_lshlrev_b32 v242, 16, v177
v_and_b32 v248, 0xffff0000, v177
v_mul_f32 v242, v242, v236
v_mul_f32 v248, v248, v236
v_cvt_pk_bf16_f32 v177, v242, v248
ds_read_b64 v[250:251], v231 offset:0
s_waitcnt lgkmcnt(0)
v_lshlrev_b32 v242, 16, v250
v_and_b32 v248, 0xffff0000, v250
v_mul_f32 v242, v242, v236
v_mul_f32 v248, v248, v236
v_cvt_pk_bf16_f32 v250, v242, v248
v_lshlrev_b32 v242, 16, v251
v_and_b32 v248, 0xffff0000, v251
v_mul_f32 v242, v242, v236
v_mul_f32 v248, v248, v236
v_cvt_pk_bf16_f32 v251, v242, v248
ds_write_b64 v231, v[250:251] offset:0
s_waitcnt lgkmcnt(0)
ds_read_b64 v[250:251], v231 offset:8
s_waitcnt lgkmcnt(0)
v_lshlrev_b32 v242, 16, v250
v_and_b32 v248, 0xffff0000, v250
v_mul_f32 v242, v242, v236
v_mul_f32 v248, v248, v236
v_cvt_pk_bf16_f32 v250, v242, v248
v_lshlrev_b32 v242, 16, v251
v_and_b32 v248, 0xffff0000, v251
v_mul_f32 v242, v242, v236
v_mul_f32 v248, v248, v236
v_cvt_pk_bf16_f32 v251, v242, v248
ds_write_b64 v231, v[250:251] offset:8
s_waitcnt lgkmcnt(0)
ds_read_b64 v[250:251], v231 offset:4096
s_waitcnt lgkmcnt(0)
v_lshlrev_b32 v242, 16, v250
v_and_b32 v248, 0xffff0000, v250
v_mul_f32 v242, v242, v236
v_mul_f32 v248, v248, v236
v_cvt_pk_bf16_f32 v250, v242, v248
v_lshlrev_b32 v242, 16, v251
v_and_b32 v248, 0xffff0000, v251
v_mul_f32 v242, v242, v236
v_mul_f32 v248, v248, v236
v_cvt_pk_bf16_f32 v251, v242, v248
ds_write_b64 v231, v[250:251] offset:4096
s_waitcnt lgkmcnt(0)
ds_read_b64 v[250:251], v231 offset:4104
s_waitcnt lgkmcnt(0)
v_lshlrev_b32 v242, 16, v250
v_and_b32 v248, 0xffff0000, v250
v_mul_f32 v242, v242, v236
v_mul_f32 v248, v248, v236
v_cvt_pk_bf16_f32 v250, v242, v248
v_lshlrev_b32 v242, 16, v251
v_and_b32 v248, 0xffff0000, v251
v_mul_f32 v242, v242, v236
v_mul_f32 v248, v248, v236
v_cvt_pk_bf16_f32 v251, v242, v248
ds_write_b64 v231, v[250:251] offset:4104
s_waitcnt lgkmcnt(0)
v_exp_f32 v232, v144
v_exp_f32 v233, v145
v_exp_f32 v234, v146
v_exp_f32 v235, v147
s_nop 1
v_cvt_pk_bf16_f32 v178, v232, v233
v_cvt_pk_bf16_f32 v179, v234, v235
v_max_f32 v204, v148, v149
v_max3_f32 v204, v204, v150, v151
v_mov_b32 v205, v204
s_nop 1
v_permlane32_swap_b32 v204, v205
s_nop 1
v_max_f32 v204, v204, v205
v_mov_b32 v205, v204
s_nop 1
v_permlane16_swap_b32 v204, v205
s_nop 1
v_max_f32 v204, v204, v205
v_add_f32 v204, 40.0, v204
v_ceil_f32 v204, v204
v_max_f32 v204, 0, v204
v_sub_f32 v205, v225, v204
v_cvt_pk_bf16_f32 v205, v205, v205
v_and_b32 v205, 0xffff0000, v205
v_sub_f32 v204, v205, v225
v_mov_b32 v225, v205
v_exp_f32 v237, v204
v_bfi_b32 v35, v206, v205, v35
v_add_f32 v148, v148, v204
v_add_f32 v149, v149, v204
v_add_f32 v150, v150, v204
v_add_f32 v151, v151, v204
v_add_f32 v132, v132, v204
v_add_f32 v133, v133, v204
v_add_f32 v134, v134, v204
v_add_f32 v135, v135, v204
v_lshlrev_b32 v242, 16, v180
v_and_b32 v248, 0xffff0000, v180
v_mul_f32 v242, v242, v237
v_mul_f32 v248, v248, v237
v_cvt_pk_bf16_f32 v180, v242, v248
v_lshlrev_b32 v242, 16, v181
v_and_b32 v248, 0xffff0000, v181
v_mul_f32 v242, v242, v237
v_mul_f32 v248, v248, v237
v_cvt_pk_bf16_f32 v181, v242, v248
ds_read_b64 v[250:251], v231 offset:1024
s_waitcnt lgkmcnt(0)
v_lshlrev_b32 v242, 16, v250
v_and_b32 v248, 0xffff0000, v250
v_mul_f32 v242, v242, v237
v_mul_f32 v248, v248, v237
v_cvt_pk_bf16_f32 v250, v242, v248
v_lshlrev_b32 v242, 16, v251
v_and_b32 v248, 0xffff0000, v251
v_mul_f32 v242, v242, v237
v_mul_f32 v248, v248, v237
v_cvt_pk_bf16_f32 v251, v242, v248
ds_write_b64 v231, v[250:251] offset:1024
s_waitcnt lgkmcnt(0)
ds_read_b64 v[250:251], v231 offset:1032
s_waitcnt lgkmcnt(0)
v_lshlrev_b32 v242, 16, v250
v_and_b32 v248, 0xffff0000, v250
v_mul_f32 v242, v242, v237
v_mul_f32 v248, v248, v237
v_cvt_pk_bf16_f32 v250, v242, v248
v_lshlrev_b32 v242, 16, v251
v_and_b32 v248, 0xffff0000, v251
v_mul_f32 v242, v242, v237
v_mul_f32 v248, v248, v237
v_cvt_pk_bf16_f32 v251, v242, v248
ds_write_b64 v231, v[250:251] offset:1032
s_waitcnt lgkmcnt(0)
ds_read_b64 v[250:251], v231 offset:5120
s_waitcnt lgkmcnt(0)
v_lshlrev_b32 v242, 16, v250
v_and_b32 v248, 0xffff0000, v250
v_mul_f32 v242, v242, v237
v_mul_f32 v248, v248, v237
v_cvt_pk_bf16_f32 v250, v242, v248
v_lshlrev_b32 v242, 16, v251
v_and_b32 v248, 0xffff0000, v251
v_mul_f32 v242, v242, v237
v_mul_f32 v248, v248, v237
v_cvt_pk_bf16_f32 v251, v242, v248
ds_write_b64 v231, v[250:251] offset:5120
s_waitcnt lgkmcnt(0)
ds_read_b64 v[250:251], v231 offset:5128
s_waitcnt lgkmcnt(0)
v_lshlrev_b32 v242, 16, v250
v_and_b32 v248, 0xffff0000, v250
v_mul_f32 v242, v242, v237
v_mul_f32 v248, v248, v237
v_cvt_pk_bf16_f32 v250, v242, v248
v_lshlrev_b32 v242, 16, v251
v_and_b32 v248, 0xffff0000, v251
v_mul_f32 v242, v242, v237
v_mul_f32 v248, v248, v237
v_cvt_pk_bf16_f32 v251, v242, v248
ds_write_b64 v231, v[250:251] offset:5128
s_waitcnt lgkmcnt(0)
v_exp_f32 v232, v148
v_exp_f32 v233, v149
v_exp_f32 v234, v150
v_exp_f32 v235, v151
s_nop 1
v_cvt_pk_bf16_f32 v182, v232, v233
v_cvt_pk_bf16_f32 v183, v234, v235
v_max_f32 v204, v152, v153
v_max3_f32 v204, v204, v154, v155
v_mov_b32 v205, v204
s_nop 1
v_permlane32_swap_b32 v204, v205
s_nop 1
v_max_f32 v204, v204, v205
v_mov_b32 v205, v204
s_nop 1
v_permlane16_swap_b32 v204, v205
s_nop 1
v_max_f32 v204, v204, v205
v_add_f32 v204, 40.0, v204
v_ceil_f32 v204, v204
v_max_f32 v204, 0, v204
v_sub_f32 v205, v226, v204
v_cvt_pk_bf16_f32 v205, v205, v205
v_and_b32 v205, 0xffff0000, v205
v_sub_f32 v204, v205, v226
v_mov_b32 v226, v205
v_exp_f32 v238, v204
v_bfi_b32 v67, v206, v205, v67
v_add_f32 v152, v152, v204
v_add_f32 v153, v153, v204
v_add_f32 v154, v154, v204
v_add_f32 v155, v155, v204
v_add_f32 v136, v136, v204
v_add_f32 v137, v137, v204
v_add_f32 v138, v138, v204
v_add_f32 v139, v139, v204
v_lshlrev_b32 v242, 16, v184
v_and_b32 v248, 0xffff0000, v184
v_mul_f32 v242, v242, v238
v_mul_f32 v248, v248, v238
v_cvt_pk_bf16_f32 v184, v242, v248
v_lshlrev_b32 v242, 16, v185
v_and_b32 v248, 0xffff0000, v185
v_mul_f32 v242, v242, v238
v_mul_f32 v248, v248, v238
v_cvt_pk_bf16_f32 v185, v242, v248
ds_read_b64 v[250:251], v231 offset:2048
s_waitcnt lgkmcnt(0)
v_lshlrev_b32 v242, 16, v250
v_and_b32 v248, 0xffff0000, v250
v_mul_f32 v242, v242, v238
v_mul_f32 v248, v248, v238
v_cvt_pk_bf16_f32 v250, v242, v248
v_lshlrev_b32 v242, 16, v251
v_and_b32 v248, 0xffff0000, v251
v_mul_f32 v242, v242, v238
v_mul_f32 v248, v248, v238
v_cvt_pk_bf16_f32 v251, v242, v248
ds_write_b64 v231, v[250:251] offset:2048
s_waitcnt lgkmcnt(0)
ds_read_b64 v[250:251], v231 offset:2056
s_waitcnt lgkmcnt(0)
v_lshlrev_b32 v242, 16, v250
v_and_b32 v248, 0xffff0000, v250
v_mul_f32 v242, v242, v238
v_mul_f32 v248, v248, v238
v_cvt_pk_bf16_f32 v250, v242, v248
v_lshlrev_b32 v242, 16, v251
v_and_b32 v248, 0xffff0000, v251
v_mul_f32 v242, v242, v238
v_mul_f32 v248, v248, v238
v_cvt_pk_bf16_f32 v251, v242, v248
ds_write_b64 v231, v[250:251] offset:2056
s_waitcnt lgkmcnt(0)
ds_read_b64 v[250:251], v231 offset:6144
s_waitcnt lgkmcnt(0)
v_lshlrev_b32 v242, 16, v250
v_and_b32 v248, 0xffff0000, v250
v_mul_f32 v242, v242, v238
v_mul_f32 v248, v248, v238
v_cvt_pk_bf16_f32 v250, v242, v248
v_lshlrev_b32 v242, 16, v251
v_and_b32 v248, 0xffff0000, v251
v_mul_f32 v242, v242, v238
v_mul_f32 v248, v248, v238
v_cvt_pk_bf16_f32 v251, v242, v248
ds_write_b64 v231, v[250:251] offset:6144
s_waitcnt lgkmcnt(0)
ds_read_b64 v[250:251], v231 offset:6152
s_waitcnt lgkmcnt(0)
v_lshlrev_b32 v242, 16, v250
v_and_b32 v248, 0xffff0000, v250
v_mul_f32 v242, v242, v238
v_mul_f32 v248, v248, v238
v_cvt_pk_bf16_f32 v250, v242, v248
v_lshlrev_b32 v242, 16, v251
v_and_b32 v248, 0xffff0000, v251
v_mul_f32 v242, v242, v238
v_mul_f32 v248, v248, v238
v_cvt_pk_bf16_f32 v251, v242, v248
ds_write_b64 v231, v[250:251] offset:6152
s_waitcnt lgkmcnt(0)
v_exp_f32 v232, v152
v_exp_f32 v233, v153
v_exp_f32 v234, v154
v_exp_f32 v235, v155
s_nop 1
v_cvt_pk_bf16_f32 v186, v232, v233
v_cvt_pk_bf16_f32 v187, v234, v235
v_max_f32 v204, v156, v157
v_max3_f32 v204, v204, v158, v159
v_mov_b32 v205, v204
s_nop 1
v_permlane32_swap_b32 v204, v205
s_nop 1
v_max_f32 v204, v204, v205
v_mov_b32 v205, v204
s_nop 1
v_permlane16_swap_b32 v204, v205
s_nop 1
v_max_f32 v204, v204, v205
v_add_f32 v204, 40.0, v204
v_ceil_f32 v204, v204
v_max_f32 v204, 0, v204
v_sub_f32 v205, v227, v204
v_cvt_pk_bf16_f32 v205, v205, v205
v_and_b32 v205, 0xffff0000, v205
v_sub_f32 v204, v205, v227
v_mov_b32 v227, v205
v_exp_f32 v239, v204
v_bfi_b32 v99, v206, v205, v99
v_add_f32 v156, v156, v204
v_add_f32 v157, v157, v204
v_add_f32 v158, v158, v204
v_add_f32 v159, v159, v204
v_add_f32 v140, v140, v204
v_add_f32 v141, v141, v204
v_add_f32 v142, v142, v204
v_add_f32 v143, v143, v204
v_lshlrev_b32 v242, 16, v188
v_and_b32 v248, 0xffff0000, v188
v_mul_f32 v242, v242, v239
v_mul_f32 v248, v248, v239
v_cvt_pk_bf16_f32 v188, v242, v248
v_lshlrev_b32 v242, 16, v189
v_and_b32 v248, 0xffff0000, v189
v_mul_f32 v242, v242, v239
v_mul_f32 v248, v248, v239
v_cvt_pk_bf16_f32 v189, v242, v248
ds_read_b64 v[250:251], v231 offset:3072
s_waitcnt lgkmcnt(0)
v_lshlrev_b32 v242, 16, v250
v_and_b32 v248, 0xffff0000, v250
v_mul_f32 v242, v242, v239
v_mul_f32 v248, v248, v239
v_cvt_pk_bf16_f32 v250, v242, v248
v_lshlrev_b32 v242, 16, v251
v_and_b32 v248, 0xffff0000, v251
v_mul_f32 v242, v242, v239
v_mul_f32 v248, v248, v239
v_cvt_pk_bf16_f32 v251, v242, v248
ds_write_b64 v231, v[250:251] offset:3072
s_waitcnt lgkmcnt(0)
ds_read_b64 v[250:251], v231 offset:3080
s_waitcnt lgkmcnt(0)
v_lshlrev_b32 v242, 16, v250
v_and_b32 v248, 0xffff0000, v250
v_mul_f32 v242, v242, v239
v_mul_f32 v248, v248, v239
v_cvt_pk_bf16_f32 v250, v242, v248
v_lshlrev_b32 v242, 16, v251
v_and_b32 v248, 0xffff0000, v251
v_mul_f32 v242, v242, v239
v_mul_f32 v248, v248, v239
v_cvt_pk_bf16_f32 v251, v242, v248
ds_write_b64 v231, v[250:251] offset:3080
s_waitcnt lgkmcnt(0)
ds_read_b64 v[250:251], v231 offset:7168
s_waitcnt lgkmcnt(0)
v_lshlrev_b32 v242, 16, v250
v_and_b32 v248, 0xffff0000, v250
v_mul_f32 v242, v242, v239
v_mul_f32 v248, v248, v239
v_cvt_pk_bf16_f32 v250, v242, v248
v_lshlrev_b32 v242, 16, v251
v_and_b32 v248, 0xffff0000, v251
v_mul_f32 v242, v242, v239
v_mul_f32 v248, v248, v239
v_cvt_pk_bf16_f32 v251, v242, v248
ds_write_b64 v231, v[250:251] offset:7168
s_waitcnt lgkmcnt(0)
ds_read_b64 v[250:251], v231 offset:7176
s_waitcnt lgkmcnt(0)
v_lshlrev_b32 v242, 16, v250
v_and_b32 v248, 0xffff0000, v250
v_mul_f32 v242, v242, v239
v_mul_f32 v248, v248, v239
v_cvt_pk_bf16_f32 v250, v242, v248
v_lshlrev_b32 v242, 16, v251
v_and_b32 v248, 0xffff0000, v251
v_mul_f32 v242, v242, v239
v_mul_f32 v248, v248, v239
v_cvt_pk_bf16_f32 v251, v242, v248
ds_write_b64 v231, v[250:251] offset:7176
s_waitcnt lgkmcnt(0)
v_exp_f32 v232, v156
v_exp_f32 v233, v157
v_exp_f32 v234, v158
v_exp_f32 v235, v159
s_nop 1
v_cvt_pk_bf16_f32 v190, v232, v233
v_cvt_pk_bf16_f32 v191, v234, v235
s_branch L2_rare_common
L2_rare_site8:
s_mov_b32 s36, 8
s_branch L2_rare_t1_2
L2_rare_t1_2:
s_nop 15
s_nop 15
s_waitcnt lgkmcnt(0)
v_lshrrev_b32 v206, 8, v243
v_add_u32 v206, 1, v206
v_lshrrev_b32 v206, 2, v206
v_sub_u32 v206, 0, v206
v_and_b32 v206, 0xffff0000, v206
v_max_f32 v204, v128, v129
v_max3_f32 v204, v204, v130, v131
v_mov_b32 v205, v204
s_nop 1
v_permlane32_swap_b32 v204, v205
s_nop 1
v_max_f32 v204, v204, v205
v_mov_b32 v205, v204
s_nop 1
v_permlane16_swap_b32 v204, v205
s_nop 1
v_max_f32 v204, v204, v205
v_add_f32 v204, 40.0, v204
v_ceil_f32 v204, v204
v_max_f32 v204, 0, v204
v_sub_f32 v205, v224, v204
v_cvt_pk_bf16_f32 v205, v205, v205
v_and_b32 v205, 0xffff0000, v205
v_sub_f32 v204, v205, v224
v_mov_b32 v224, v205
v_exp_f32 v236, v204
v_bfi_b32 v3, v206, v205, v3
v_add_f32 v128, v128, v204
v_add_f32 v129, v129, v204
v_add_f32 v130, v130, v204
v_add_f32 v131, v131, v204
v_add_f32 v144, v144, v204
v_add_f32 v145, v145, v204
v_add_f32 v146, v146, v204
v_add_f32 v147, v147, v204
v_lshlrev_b32 v242, 16, v176
v_and_b32 v248, 0xffff0000, v176
v_mul_f32 v242, v242, v236
v_mul_f32 v248, v248, v236
v_cvt_pk_bf16_f32 v176, v242, v248
v_lshlrev_b32 v242, 16, v177
v_and_b32 v248, 0xffff0000, v177
v_mul_f32 v242, v242, v236
v_mul_f32 v248, v248, v236
v_cvt_pk_bf16_f32 v177, v242, v248
v_lshlrev_b32 v242, 16, v178
v_and_b32 v248, 0xffff0000, v178
v_mul_f32 v242, v242, v236
v_mul_f32 v248, v248, v236
v_cvt_pk_bf16_f32 v178, v242, v248
v_lshlrev_b32 v242, 16, v179
v_and_b32 v248, 0xffff0000, v179
v_mul_f32 v242, v242, v236
v_mul_f32 v248, v248, v236
v_cvt_pk_bf16_f32 v179, v242, v248
ds_read_b64 v[250:251], v231 offset:0
s_waitcnt lgkmcnt(0)
v_lshlrev_b32 v242, 16, v250
v_and_b32 v248, 0xffff0000, v250
v_mul_f32 v242, v242, v236
v_mul_f32 v248, v248, v236
v_cvt_pk_bf16_f32 v250, v242, v248
v_lshlrev_b32 v242, 16, v251
v_and_b32 v248, 0xffff0000, v251
v_mul_f32 v242, v242, v236
v_mul_f32 v248, v248, v236
v_cvt_pk_bf16_f32 v251, v242, v248
ds_write_b64 v231, v[250:251] offset:0
s_waitcnt lgkmcnt(0)
ds_read_b64 v[250:251], v231 offset:8
s_waitcnt lgkmcnt(0)
v_lshlrev_b32 v242, 16, v250
v_and_b32 v248, 0xffff0000, v250
v_mul_f32 v242, v242, v236
v_mul_f32 v248, v248, v236
v_cvt_pk_bf16_f32 v250, v242, v248
v_lshlrev_b32 v242, 16, v251
v_and_b32 v248, 0xffff0000, v251
v_mul_f32 v242, v242, v236
v_mul_f32 v248, v248, v236
v_cvt_pk_bf16_f32 v251, v242, v248
ds_write_b64 v231, v[250:251] offset:8
s_waitcnt lgkmcnt(0)
ds_read_b64 v[250:251], v231 offset:4096
s_waitcnt lgkmcnt(0)
v_lshlrev_b32 v242, 16, v250
v_and_b32 v248, 0xffff0000, v250
v_mul_f32 v242, v242, v236
v_mul_f32 v248, v248, v236
v_cvt_pk_bf16_f32 v250, v242, v248
v_lshlrev_b32 v242, 16, v251
v_and_b32 v248, 0xffff0000, v251
v_mul_f32 v242, v242, v236
v_mul_f32 v248, v248, v236
v_cvt_pk_bf16_f32 v251, v242, v248
ds_write_b64 v231, v[250:251] offset:4096
s_waitcnt lgkmcnt(0)
ds_read_b64 v[250:251], v231 offset:4104
s_waitcnt lgkmcnt(0)
v_lshlrev_b32 v242, 16, v250
v_and_b32 v248, 0xffff0000, v250
v_mul_f32 v242, v242, v236
v_mul_f32 v248, v248, v236
v_cvt_pk_bf16_f32 v250, v242, v248
v_lshlrev_b32 v242, 16, v251
v_and_b32 v248, 0xffff0000, v251
v_mul_f32 v242, v242, v236
v_mul_f32 v248, v248, v236
v_cvt_pk_bf16_f32 v251, v242, v248
ds_write_b64 v231, v[250:251] offset:4104
s_waitcnt lgkmcnt(0)
v_exp_f32 v232, v128
v_exp_f32 v233, v129
v_exp_f32 v234, v130
v_exp_f32 v235, v131
s_nop 1
v_cvt_pk_bf16_f32 v160, v232, v233
v_cvt_pk_bf16_f32 v161, v234, v235
v_max_f32 v204, v132, v133
v_max3_f32 v204, v204, v134, v135
v_mov_b32 v205, v204
s_nop 1
v_permlane32_swap_b32 v204, v205
s_nop 1
v_max_f32 v204, v204, v205
v_mov_b32 v205, v204
s_nop 1
v_permlane16_swap_b32 v204, v205
s_nop 1
v_max_f32 v204, v204, v205
v_add_f32 v204, 40.0, v204
v_ceil_f32 v204, v204
v_max_f32 v204, 0, v204
v_sub_f32 v205, v225, v204
v_cvt_pk_bf16_f32 v205, v205, v205
v_and_b32 v205, 0xffff0000, v205
v_sub_f32 v204, v205, v225
v_mov_b32 v225, v205
v_exp_f32 v237, v204
v_bfi_b32 v35, v206, v205, v35
v_add_f32 v132, v132, v204
v_add_f32 v133, v133, v204
v_add_f32 v134, v134, v204
v_add_f32 v135, v135, v204
v_add_f32 v148, v148, v204
v_add_f32 v149, v149, v204
v_add_f32 v150, v150, v204
v_add_f32 v151, v151, v204
v_lshlrev_b32 v242, 16, v180
v_and_b32 v248, 0xffff0000, v180
v_mul_f32 v242, v242, v237
v_mul_f32 v248, v248, v237
v_cvt_pk_bf16_f32 v180, v242, v248
v_lshlrev_b32 v242, 16, v181
v_and_b32 v248, 0xffff0000, v181
v_mul_f32 v242, v242, v237
v_mul_f32 v248, v248, v237
v_cvt_pk_bf16_f32 v181, v242, v248
v_lshlrev_b32 v242, 16, v182
v_and_b32 v248, 0xffff0000, v182
v_mul_f32 v242, v242, v237
v_mul_f32 v248, v248, v237
v_cvt_pk_bf16_f32 v182, v242, v248
v_lshlrev_b32 v242, 16, v183
v_and_b32 v248, 0xffff0000, v183
v_mul_f32 v242, v242, v237
v_mul_f32 v248, v248, v237
v_cvt_pk_bf16_f32 v183, v242, v248
ds_read_b64 v[250:251], v231 offset:1024
s_waitcnt lgkmcnt(0)
v_lshlrev_b32 v242, 16, v250
v_and_b32 v248, 0xffff0000, v250
v_mul_f32 v242, v242, v237
v_mul_f32 v248, v248, v237
v_cvt_pk_bf16_f32 v250, v242, v248
v_lshlrev_b32 v242, 16, v251
v_and_b32 v248, 0xffff0000, v251
v_mul_f32 v242, v242, v237
v_mul_f32 v248, v248, v237
v_cvt_pk_bf16_f32 v251, v242, v248
ds_write_b64 v231, v[250:251] offset:1024
s_waitcnt lgkmcnt(0)
ds_read_b64 v[250:251], v231 offset:1032
s_waitcnt lgkmcnt(0)
v_lshlrev_b32 v242, 16, v250
v_and_b32 v248, 0xffff0000, v250
v_mul_f32 v242, v242, v237
v_mul_f32 v248, v248, v237
v_cvt_pk_bf16_f32 v250, v242, v248
v_lshlrev_b32 v242, 16, v251
v_and_b32 v248, 0xffff0000, v251
v_mul_f32 v242, v242, v237
v_mul_f32 v248, v248, v237
v_cvt_pk_bf16_f32 v251, v242, v248
ds_write_b64 v231, v[250:251] offset:1032
s_waitcnt lgkmcnt(0)
ds_read_b64 v[250:251], v231 offset:5120
s_waitcnt lgkmcnt(0)
v_lshlrev_b32 v242, 16, v250
v_and_b32 v248, 0xffff0000, v250
v_mul_f32 v242, v242, v237
v_mul_f32 v248, v248, v237
v_cvt_pk_bf16_f32 v250, v242, v248
v_lshlrev_b32 v242, 16, v251
v_and_b32 v248, 0xffff0000, v251
v_mul_f32 v242, v242, v237
v_mul_f32 v248, v248, v237
v_cvt_pk_bf16_f32 v251, v242, v248
ds_write_b64 v231, v[250:251] offset:5120
s_waitcnt lgkmcnt(0)
ds_read_b64 v[250:251], v231 offset:5128
s_waitcnt lgkmcnt(0)
v_lshlrev_b32 v242, 16, v250
v_and_b32 v248, 0xffff0000, v250
v_mul_f32 v242, v242, v237
v_mul_f32 v248, v248, v237
v_cvt_pk_bf16_f32 v250, v242, v248
v_lshlrev_b32 v242, 16, v251
v_and_b32 v248, 0xffff0000, v251
v_mul_f32 v242, v242, v237
v_mul_f32 v248, v248, v237
v_cvt_pk_bf16_f32 v251, v242, v248
ds_write_b64 v231, v[250:251] offset:5128
s_waitcnt lgkmcnt(0)
v_exp_f32 v232, v132
v_exp_f32 v233, v133
v_exp_f32 v234, v134
v_exp_f32 v235, v135
s_nop 1
v_cvt_pk_bf16_f32 v164, v232, v233
v_cvt_pk_bf16_f32 v165, v234, v235
v_max_f32 v204, v136, v137
v_max3_f32 v204, v204, v138, v139
v_mov_b32 v205, v204
s_nop 1
v_permlane32_swap_b32 v204, v205
s_nop 1
v_max_f32 v204, v204, v205
v_mov_b32 v205, v204
s_nop 1
v_permlane16_swap_b32 v204, v205
s_nop 1
v_max_f32 v204, v204, v205
v_add_f32 v204, 40.0, v204
v_ceil_f32 v204, v204
v_max_f32 v204, 0, v204
v_sub_f32 v205, v226, v204
v_cvt_pk_bf16_f32 v205, v205, v205
v_and_b32 v205, 0xffff0000, v205
v_sub_f32 v204, v205, v226
v_mov_b32 v226, v205
v_exp_f32 v238, v204
v_bfi_b32 v67, v206, v205, v67
v_add_f32 v136, v136, v204
v_add_f32 v137, v137, v204
v_add_f32 v138, v138, v204
v_add_f32 v139, v139, v204
v_add_f32 v152, v152, v204
v_add_f32 v153, v153, v204
v_add_f32 v154, v154, v204
v_add_f32 v155, v155, v204
v_lshlrev_b32 v242, 16, v184
v_and_b32 v248, 0xffff0000, v184
v_mul_f32 v242, v242, v238
v_mul_f32 v248, v248, v238
v_cvt_pk_bf16_f32 v184, v242, v248
v_lshlrev_b32 v242, 16, v185
v_and_b32 v248, 0xffff0000, v185
v_mul_f32 v242, v242, v238
v_mul_f32 v248, v248, v238
v_cvt_pk_bf16_f32 v185, v242, v248
v_lshlrev_b32 v242, 16, v186
v_and_b32 v248, 0xffff0000, v186
v_mul_f32 v242, v242, v238
v_mul_f32 v248, v248, v238
v_cvt_pk_bf16_f32 v186, v242, v248
v_lshlrev_b32 v242, 16, v187
v_and_b32 v248, 0xffff0000, v187
v_mul_f32 v242, v242, v238
v_mul_f32 v248, v248, v238
v_cvt_pk_bf16_f32 v187, v242, v248
ds_read_b64 v[250:251], v231 offset:2048
s_waitcnt lgkmcnt(0)
v_lshlrev_b32 v242, 16, v250
v_and_b32 v248, 0xffff0000, v250
v_mul_f32 v242, v242, v238
v_mul_f32 v248, v248, v238
v_cvt_pk_bf16_f32 v250, v242, v248
v_lshlrev_b32 v242, 16, v251
v_and_b32 v248, 0xffff0000, v251
v_mul_f32 v242, v242, v238
v_mul_f32 v248, v248, v238
v_cvt_pk_bf16_f32 v251, v242, v248
ds_write_b64 v231, v[250:251] offset:2048
s_waitcnt lgkmcnt(0)
ds_read_b64 v[250:251], v231 offset:2056
s_waitcnt lgkmcnt(0)
v_lshlrev_b32 v242, 16, v250
v_and_b32 v248, 0xffff0000, v250
v_mul_f32 v242, v242, v238
v_mul_f32 v248, v248, v238
v_cvt_pk_bf16_f32 v250, v242, v248
v_lshlrev_b32 v242, 16, v251
v_and_b32 v248, 0xffff0000, v251
v_mul_f32 v242, v242, v238
v_mul_f32 v248, v248, v238
v_cvt_pk_bf16_f32 v251, v242, v248
ds_write_b64 v231, v[250:251] offset:2056
s_waitcnt lgkmcnt(0)
ds_read_b64 v[250:251], v231 offset:6144
s_waitcnt lgkmcnt(0)
v_lshlrev_b32 v242, 16, v250
v_and_b32 v248, 0xffff0000, v250
v_mul_f32 v242, v242, v238
v_mul_f32 v248, v248, v238
v_cvt_pk_bf16_f32 v250, v242, v248
v_lshlrev_b32 v242, 16, v251
v_and_b32 v248, 0xffff0000, v251
v_mul_f32 v242, v242, v238
v_mul_f32 v248, v248, v238
v_cvt_pk_bf16_f32 v251, v242, v248
ds_write_b64 v231, v[250:251] offset:6144
s_waitcnt lgkmcnt(0)
ds_read_b64 v[250:251], v231 offset:6152
s_waitcnt lgkmcnt(0)
v_lshlrev_b32 v242, 16, v250
v_and_b32 v248, 0xffff0000, v250
v_mul_f32 v242, v242, v238
v_mul_f32 v248, v248, v238
v_cvt_pk_bf16_f32 v250, v242, v248
v_lshlrev_b32 v242, 16, v251
v_and_b32 v248, 0xffff0000, v251
v_mul_f32 v242, v242, v238
v_mul_f32 v248, v248, v238
v_cvt_pk_bf16_f32 v251, v242, v248
ds_write_b64 v231, v[250:251] offset:6152
s_waitcnt lgkmcnt(0)
v_exp_f32 v232, v136
v_exp_f32 v233, v137
v_exp_f32 v234, v138
v_exp_f32 v235, v139
s_nop 1
v_cvt_pk_bf16_f32 v168, v232, v233
v_cvt_pk_bf16_f32 v169, v234, v235
v_max_f32 v204, v140, v141
v_max3_f32 v204, v204, v142, v143
v_mov_b32 v205, v204
s_nop 1
v_permlane32_swap_b32 v204, v205
s_nop 1
v_max_f32 v204, v204, v205
v_mov_b32 v205, v204
s_nop 1
v_permlane16_swap_b32 v204, v205
s_nop 1
v_max_f32 v204, v204, v205
v_add_f32 v204, 40.0, v204
v_ceil_f32 v204, v204
v_max_f32 v204, 0, v204
v_sub_f32 v205, v227, v204
v_cvt_pk_bf16_f32 v205, v205, v205
v_and_b32 v205, 0xffff0000, v205
v_sub_f32 v204, v205, v227
v_mov_b32 v227, v205
v_exp_f32 v239, v204
v_bfi_b32 v99, v206, v205, v99
v_add_f32 v140, v140, v204
v_add_f32 v141, v141, v204
v_add_f32 v142, v142, v204
v_add_f32 v143, v143, v204
v_add_f32 v156, v156, v204
v_add_f32 v157, v157, v204
v_add_f32 v158, v158, v204
v_add_f32 v159, v159, v204
v_lshlrev_b32 v242, 16, v188
v_and_b32 v248, 0xffff0000, v188
v_mul_f32 v242, v242, v239
v_mul_f32 v248, v248, v239
v_cvt_pk_bf16_f32 v188, v242, v248
v_lshlrev_b32 v242, 16, v189
v_and_b32 v248, 0xffff0000, v189
v_mul_f32 v242, v242, v239
v_mul_f32 v248, v248, v239
v_cvt_pk_bf16_f32 v189, v242, v248
v_lshlrev_b32 v242, 16, v190
v_and_b32 v248, 0xffff0000, v190
v_mul_f32 v242, v242, v239
v_mul_f32 v248, v248, v239
v_cvt_pk_bf16_f32 v190, v242, v248
v_lshlrev_b32 v242, 16, v191
v_and_b32 v248, 0xffff0000, v191
v_mul_f32 v242, v242, v239
v_mul_f32 v248, v248, v239
v_cvt_pk_bf16_f32 v191, v242, v248
ds_read_b64 v[250:251], v231 offset:3072
s_waitcnt lgkmcnt(0)
v_lshlrev_b32 v242, 16, v250
v_and_b32 v248, 0xffff0000, v250
v_mul_f32 v242, v242, v239
v_mul_f32 v248, v248, v239
v_cvt_pk_bf16_f32 v250, v242, v248
v_lshlrev_b32 v242, 16, v251
v_and_b32 v248, 0xffff0000, v251
v_mul_f32 v242, v242, v239
v_mul_f32 v248, v248, v239
v_cvt_pk_bf16_f32 v251, v242, v248
ds_write_b64 v231, v[250:251] offset:3072
s_waitcnt lgkmcnt(0)
ds_read_b64 v[250:251], v231 offset:3080
s_waitcnt lgkmcnt(0)
v_lshlrev_b32 v242, 16, v250
v_and_b32 v248, 0xffff0000, v250
v_mul_f32 v242, v242, v239
v_mul_f32 v248, v248, v239
v_cvt_pk_bf16_f32 v250, v242, v248
v_lshlrev_b32 v242, 16, v251
v_and_b32 v248, 0xffff0000, v251
v_mul_f32 v242, v242, v239
v_mul_f32 v248, v248, v239
v_cvt_pk_bf16_f32 v251, v242, v248
ds_write_b64 v231, v[250:251] offset:3080
s_waitcnt lgkmcnt(0)
ds_read_b64 v[250:251], v231 offset:7168
s_waitcnt lgkmcnt(0)
v_lshlrev_b32 v242, 16, v250
v_and_b32 v248, 0xffff0000, v250
v_mul_f32 v242, v242, v239
v_mul_f32 v248, v248, v239
v_cvt_pk_bf16_f32 v250, v242, v248
v_lshlrev_b32 v242, 16, v251
v_and_b32 v248, 0xffff0000, v251
v_mul_f32 v242, v242, v239
v_mul_f32 v248, v248, v239
v_cvt_pk_bf16_f32 v251, v242, v248
ds_write_b64 v231, v[250:251] offset:7168
s_waitcnt lgkmcnt(0)
ds_read_b64 v[250:251], v231 offset:7176
s_waitcnt lgkmcnt(0)
v_lshlrev_b32 v242, 16, v250
v_and_b32 v248, 0xffff0000, v250
v_mul_f32 v242, v242, v239
v_mul_f32 v248, v248, v239
v_cvt_pk_bf16_f32 v250, v242, v248
v_lshlrev_b32 v242, 16, v251
v_and_b32 v248, 0xffff0000, v251
v_mul_f32 v242, v242, v239
v_mul_f32 v248, v248, v239
v_cvt_pk_bf16_f32 v251, v242, v248
ds_write_b64 v231, v[250:251] offset:7176
s_waitcnt lgkmcnt(0)
v_exp_f32 v232, v140
v_exp_f32 v233, v141
v_exp_f32 v234, v142
v_exp_f32 v235, v143
s_nop 1
v_cvt_pk_bf16_f32 v172, v232, v233
v_cvt_pk_bf16_f32 v173, v234, v235
s_branch L2_rare_common
L2_rare_site9:
s_mov_b32 s36, 9
s_branch L2_rare_t1_3
L2_rare_t1_3:
s_nop 15
s_nop 15
s_waitcnt lgkmcnt(0)
v_lshrrev_b32 v206, 8, v243
v_add_u32 v206, 1, v206
v_lshrrev_b32 v206, 2, v206
v_sub_u32 v206, 0, v206
v_and_b32 v206, 0xffff0000, v206
v_max_f32 v204, v144, v145
v_max3_f32 v204, v204, v146, v147
v_mov_b32 v205, v204
s_nop 1
v_permlane32_swap_b32 v204, v205
s_nop 1
v_max_f32 v204, v204, v205
v_mov_b32 v205, v204
s_nop 1
v_permlane16_swap_b32 v204, v205
s_nop 1
v_max_f32 v204, v204, v205
v_add_f32 v204, 40.0, v204
v_ceil_f32 v204, v204
v_max_f32 v204, 0, v204
v_sub_f32 v205, v224, v204
v_cvt_pk_bf16_f32 v205, v205, v205
v_and_b32 v205, 0xffff0000, v205
v_sub_f32 v204, v205, v224
v_mov_b32 v224, v205
v_exp_f32 v236, v204
v_bfi_b32 v3, v206, v205, v3
v_add_f32 v144, v144, v204
v_add_f32 v145, v145, v204
v_add_f32 v146, v146, v204
v_add_f32 v147, v147, v204
v_add_f32 v128, v128, v204
v_add_f32 v129, v129, v204
v_add_f32 v130, v130, v204
v_add_f32 v131, v131, v204
v_lshlrev_b32 v242, 16, v176
v_and_b32 v248, 0xffff0000, v176
v_mul_f32 v242, v242, v236
v_mul_f32 v248, v248, v236
v_cvt_pk_bf16_f32 v176, v242, v248
v_lshlrev_b32 v242, 16, v177
v_and_b32 v248, 0xffff0000, v177
v_mul_f32 v242, v242, v236
v_mul_f32 v248, v248, v236
v_cvt_pk_bf16_f32 v177, v242, v248
v_lshlrev_b32 v242, 16, v178
v_and_b32 v248, 0xffff0000, v178
v_mul_f32 v242, v242, v236
v_mul_f32 v248, v248, v236
v_cvt_pk_bf16_f32 v178, v242, v248
v_lshlrev_b32 v242, 16, v179
v_and_b32 v248, 0xffff0000, v179
v_mul_f32 v242, v242, v236
v_mul_f32 v248, v248, v236
v_cvt_pk_bf16_f32 v179, v242, v248
v_lshlrev_b32 v242, 16, v160
v_and_b32 v248, 0xffff0000, v160
v_mul_f32 v242, v242, v236
v_mul_f32 v248, v248, v236
v_cvt_pk_bf16_f32 v160, v242, v248
v_lshlrev_b32 v242, 16, v161
v_and_b32 v248, 0xffff0000, v161
v_mul_f32 v242, v242, v236
v_mul_f32 v248, v248, v236
v_cvt_pk_bf16_f32 v161, v242, v248
ds_read_b64 v[250:251], v231 offset:0
s_waitcnt lgkmcnt(0)
v_lshlrev_b32 v242, 16, v250
v_and_b32 v248, 0xffff0000, v250
v_mul_f32 v242, v242, v236
v_mul_f32 v248, v248, v236
v_cvt_pk_bf16_f32 v250, v242, v248
v_lshlrev_b32 v242, 16, v251
v_and_b32 v248, 0xffff0000, v251
v_mul_f32 v242, v242, v236
v_mul_f32 v248, v248, v236
v_cvt_pk_bf16_f32 v251, v242, v248
ds_write_b64 v231, v[250:251] offset:0
s_waitcnt lgkmcnt(0)
ds_read_b64 v[250:251], v231 offset:8
s_waitcnt lgkmcnt(0)
v_lshlrev_b32 v242, 16, v250
v_and_b32 v248, 0xffff0000, v250
v_mul_f32 v242, v242, v236
v_mul_f32 v248, v248, v236
v_cvt_pk_bf16_f32 v250, v242, v248
v_lshlrev_b32 v242, 16, v251
v_and_b32 v248, 0xffff0000, v251
v_mul_f32 v242, v242, v236
v_mul_f32 v248, v248, v236
v_cvt_pk_bf16_f32 v251, v242, v248
ds_write_b64 v231, v[250:251] offset:8
s_waitcnt lgkmcnt(0)
ds_read_b64 v[250:251], v231 offset:4096
s_waitcnt lgkmcnt(0)
v_lshlrev_b32 v242, 16, v250
v_and_b32 v248, 0xffff0000, v250
v_mul_f32 v242, v242, v236
v_mul_f32 v248, v248, v236
v_cvt_pk_bf16_f32 v250, v242, v248
v_lshlrev_b32 v242, 16, v251
v_and_b32 v248, 0xffff0000, v251
v_mul_f32 v242, v242, v236
v_mul_f32 v248, v248, v236
v_cvt_pk_bf16_f32 v251, v242, v248
ds_write_b64 v231, v[250:251] offset:4096
s_waitcnt lgkmcnt(0)
ds_read_b64 v[250:251], v231 offset:4104
s_waitcnt lgkmcnt(0)
v_lshlrev_b32 v242, 16, v250
v_and_b32 v248, 0xffff0000, v250
v_mul_f32 v242, v242, v236
v_mul_f32 v248, v248, v236
v_cvt_pk_bf16_f32 v250, v242, v248
v_lshlrev_b32 v242, 16, v251
v_and_b32 v248, 0xffff0000, v251
v_mul_f32 v242, v242, v236
v_mul_f32 v248, v248, v236
v_cvt_pk_bf16_f32 v251, v242, v248
ds_write_b64 v231, v[250:251] offset:4104
s_waitcnt lgkmcnt(0)
v_exp_f32 v232, v144
v_exp_f32 v233, v145
v_exp_f32 v234, v146
v_exp_f32 v235, v147
s_nop 1
v_cvt_pk_bf16_f32 v162, v232, v233
v_cvt_pk_bf16_f32 v163, v234, v235
v_max_f32 v204, v148, v149
v_max3_f32 v204, v204, v150, v151
v_mov_b32 v205, v204
s_nop 1
v_permlane32_swap_b32 v204, v205
s_nop 1
v_max_f32 v204, v204, v205
v_mov_b32 v205, v204
s_nop 1
v_permlane16_swap_b32 v204, v205
s_nop 1
v_max_f32 v204, v204, v205
v_add_f32 v204, 40.0, v204
v_ceil_f32 v204, v204
v_max_f32 v204, 0, v204
v_sub_f32 v205, v225, v204
v_cvt_pk_bf16_f32 v205, v205, v205
v_and_b32 v205, 0xffff0000, v205
v_sub_f32 v204, v205, v225
v_mov_b32 v225, v205
v_exp_f32 v237, v204
v_bfi_b32 v35, v206, v205, v35
v_add_f32 v148, v148, v204
v_add_f32 v149, v149, v204
v_add_f32 v150, v150, v204
v_add_f32 v151, v151, v204
v_add_f32 v132, v132, v204
v_add_f32 v133, v133, v204
v_add_f32 v134, v134, v204
v_add_f32 v135, v135, v204
v_lshlrev_b32 v242, 16, v180
v_and_b32 v248, 0xffff0000, v180
v_mul_f32 v242, v242, v237
v_mul_f32 v248, v248, v237
v_cvt_pk_bf16_f32 v180, v242, v248
v_lshlrev_b32 v242, 16, v181
v_and_b32 v248, 0xffff0000, v181
v_mul_f32 v242, v242, v237
v_mul_f32 v248, v248, v237
v_cvt_pk_bf16_f32 v181, v242, v248
v_lshlrev_b32 v242, 16, v182
v_and_b32 v248, 0xffff0000, v182
v_mul_f32 v242, v242, v237
v_mul_f32 v248, v248, v237
v_cvt_pk_bf16_f32 v182, v242, v248
v_lshlrev_b32 v242, 16, v183
v_and_b32 v248, 0xffff0000, v183
v_mul_f32 v242, v242, v237
v_mul_f32 v248, v248, v237
v_cvt_pk_bf16_f32 v183, v242, v248
v_lshlrev_b32 v242, 16, v164
v_and_b32 v248, 0xffff0000, v164
v_mul_f32 v242, v242, v237
v_mul_f32 v248, v248, v237
v_cvt_pk_bf16_f32 v164, v242, v248
v_lshlrev_b32 v242, 16, v165
v_and_b32 v248, 0xffff0000, v165
v_mul_f32 v242, v242, v237
v_mul_f32 v248, v248, v237
v_cvt_pk_bf16_f32 v165, v242, v248
ds_read_b64 v[250:251], v231 offset:1024
s_waitcnt lgkmcnt(0)
v_lshlrev_b32 v242, 16, v250
v_and_b32 v248, 0xffff0000, v250
v_mul_f32 v242, v242, v237
v_mul_f32 v248, v248, v237
v_cvt_pk_bf16_f32 v250, v242, v248
v_lshlrev_b32 v242, 16, v251
v_and_b32 v248, 0xffff0000, v251
v_mul_f32 v242, v242, v237
v_mul_f32 v248, v248, v237
v_cvt_pk_bf16_f32 v251, v242, v248
ds_write_b64 v231, v[250:251] offset:1024
s_waitcnt lgkmcnt(0)
ds_read_b64 v[250:251], v231 offset:1032
s_waitcnt lgkmcnt(0)
v_lshlrev_b32 v242, 16, v250
v_and_b32 v248, 0xffff0000, v250
v_mul_f32 v242, v242, v237
v_mul_f32 v248, v248, v237
v_cvt_pk_bf16_f32 v250, v242, v248
v_lshlrev_b32 v242, 16, v251
v_and_b32 v248, 0xffff0000, v251
v_mul_f32 v242, v242, v237
v_mul_f32 v248, v248, v237
v_cvt_pk_bf16_f32 v251, v242, v248
ds_write_b64 v231, v[250:251] offset:1032
s_waitcnt lgkmcnt(0)
ds_read_b64 v[250:251], v231 offset:5120
s_waitcnt lgkmcnt(0)
v_lshlrev_b32 v242, 16, v250
v_and_b32 v248, 0xffff0000, v250
v_mul_f32 v242, v242, v237
v_mul_f32 v248, v248, v237
v_cvt_pk_bf16_f32 v250, v242, v248
v_lshlrev_b32 v242, 16, v251
v_and_b32 v248, 0xffff0000, v251
v_mul_f32 v242, v242, v237
v_mul_f32 v248, v248, v237
v_cvt_pk_bf16_f32 v251, v242, v248
ds_write_b64 v231, v[250:251] offset:5120
s_waitcnt lgkmcnt(0)
ds_read_b64 v[250:251], v231 offset:5128
s_waitcnt lgkmcnt(0)
v_lshlrev_b32 v242, 16, v250
v_and_b32 v248, 0xffff0000, v250
v_mul_f32 v242, v242, v237
v_mul_f32 v248, v248, v237
v_cvt_pk_bf16_f32 v250, v242, v248
v_lshlrev_b32 v242, 16, v251
v_and_b32 v248, 0xffff0000, v251
v_mul_f32 v242, v242, v237
v_mul_f32 v248, v248, v237
v_cvt_pk_bf16_f32 v251, v242, v248
ds_write_b64 v231, v[250:251] offset:5128
s_waitcnt lgkmcnt(0)
v_exp_f32 v232, v148
v_exp_f32 v233, v149
v_exp_f32 v234, v150
v_exp_f32 v235, v151
s_nop 1
v_cvt_pk_bf16_f32 v166, v232, v233
v_cvt_pk_bf16_f32 v167, v234, v235
v_max_f32 v204, v152, v153
v_max3_f32 v204, v204, v154, v155
v_mov_b32 v205, v204
s_nop 1
v_permlane32_swap_b32 v204, v205
s_nop 1
v_max_f32 v204, v204, v205
v_mov_b32 v205, v204
s_nop 1
v_permlane16_swap_b32 v204, v205
s_nop 1
v_max_f32 v204, v204, v205
v_add_f32 v204, 40.0, v204
v_ceil_f32 v204, v204
v_max_f32 v204, 0, v204
v_sub_f32 v205, v226, v204
v_cvt_pk_bf16_f32 v205, v205, v205
v_and_b32 v205, 0xffff0000, v205
v_sub_f32 v204, v205, v226
v_mov_b32 v226, v205
v_exp_f32 v238, v204
v_bfi_b32 v67, v206, v205, v67
v_add_f32 v152, v152, v204
v_add_f32 v153, v153, v204
v_add_f32 v154, v154, v204
v_add_f32 v155, v155, v204
v_add_f32 v136, v136, v204
v_add_f32 v137, v137, v204
v_add_f32 v138, v138, v204
v_add_f32 v139, v139, v204
v_lshlrev_b32 v242, 16, v184
v_and_b32 v248, 0xffff0000, v184
v_mul_f32 v242, v242, v238
v_mul_f32 v248, v248, v238
v_cvt_pk_bf16_f32 v184, v242, v248
v_lshlrev_b32 v242, 16, v185
v_and_b32 v248, 0xffff0000, v185
v_mul_f32 v242, v242, v238
v_mul_f32 v248, v248, v238
v_cvt_pk_bf16_f32 v185, v242, v248
v_lshlrev_b32 v242, 16, v186
v_and_b32 v248, 0xffff0000, v186
v_mul_f32 v242, v242, v238
v_mul_f32 v248, v248, v238
v_cvt_pk_bf16_f32 v186, v242, v248
v_lshlrev_b32 v242, 16, v187
v_and_b32 v248, 0xffff0000, v187
v_mul_f32 v242, v242, v238
v_mul_f32 v248, v248, v238
v_cvt_pk_bf16_f32 v187, v242, v248
v_lshlrev_b32 v242, 16, v168
v_and_b32 v248, 0xffff0000, v168
v_mul_f32 v242, v242, v238
v_mul_f32 v248, v248, v238
v_cvt_pk_bf16_f32 v168, v242, v248
v_lshlrev_b32 v242, 16, v169
v_and_b32 v248, 0xffff0000, v169
v_mul_f32 v242, v242, v238
v_mul_f32 v248, v248, v238
v_cvt_pk_bf16_f32 v169, v242, v248
ds_read_b64 v[250:251], v231 offset:2048
s_waitcnt lgkmcnt(0)
v_lshlrev_b32 v242, 16, v250
v_and_b32 v248, 0xffff0000, v250
v_mul_f32 v242, v242, v238
v_mul_f32 v248, v248, v238
v_cvt_pk_bf16_f32 v250, v242, v248
v_lshlrev_b32 v242, 16, v251
v_and_b32 v248, 0xffff0000, v251
v_mul_f32 v242, v242, v238
v_mul_f32 v248, v248, v238
v_cvt_pk_bf16_f32 v251, v242, v248
ds_write_b64 v231, v[250:251] offset:2048
s_waitcnt lgkmcnt(0)
ds_read_b64 v[250:251], v231 offset:2056
s_waitcnt lgkmcnt(0)
v_lshlrev_b32 v242, 16, v250
v_and_b32 v248, 0xffff0000, v250
v_mul_f32 v242, v242, v238
v_mul_f32 v248, v248, v238
v_cvt_pk_bf16_f32 v250, v242, v248
v_lshlrev_b32 v242, 16, v251
v_and_b32 v248, 0xffff0000, v251
v_mul_f32 v242, v242, v238
v_mul_f32 v248, v248, v238
v_cvt_pk_bf16_f32 v251, v242, v248
ds_write_b64 v231, v[250:251] offset:2056
s_waitcnt lgkmcnt(0)
ds_read_b64 v[250:251], v231 offset:6144
s_waitcnt lgkmcnt(0)
v_lshlrev_b32 v242, 16, v250
v_and_b32 v248, 0xffff0000, v250
v_mul_f32 v242, v242, v238
v_mul_f32 v248, v248, v238
v_cvt_pk_bf16_f32 v250, v242, v248
v_lshlrev_b32 v242, 16, v251
v_and_b32 v248, 0xffff0000, v251
v_mul_f32 v242, v242, v238
v_mul_f32 v248, v248, v238
v_cvt_pk_bf16_f32 v251, v242, v248
ds_write_b64 v231, v[250:251] offset:6144
s_waitcnt lgkmcnt(0)
ds_read_b64 v[250:251], v231 offset:6152
s_waitcnt lgkmcnt(0)
v_lshlrev_b32 v242, 16, v250
v_and_b32 v248, 0xffff0000, v250
v_mul_f32 v242, v242, v238
v_mul_f32 v248, v248, v238
v_cvt_pk_bf16_f32 v250, v242, v248
v_lshlrev_b32 v242, 16, v251
v_and_b32 v248, 0xffff0000, v251
v_mul_f32 v242, v242, v238
v_mul_f32 v248, v248, v238
v_cvt_pk_bf16_f32 v251, v242, v248
ds_write_b64 v231, v[250:251] offset:6152
s_waitcnt lgkmcnt(0)
v_exp_f32 v232, v152
v_exp_f32 v233, v153
v_exp_f32 v234, v154
v_exp_f32 v235, v155
s_nop 1
v_cvt_pk_bf16_f32 v170, v232, v233
v_cvt_pk_bf16_f32 v171, v234, v235
v_max_f32 v204, v156, v157
v_max3_f32 v204, v204, v158, v159
v_mov_b32 v205, v204
s_nop 1
v_permlane32_swap_b32 v204, v205
s_nop 1
v_max_f32 v204, v204, v205
v_mov_b32 v205, v204
s_nop 1
v_permlane16_swap_b32 v204, v205
s_nop 1
v_max_f32 v204, v204, v205
v_add_f32 v204, 40.0, v204
v_ceil_f32 v204, v204
v_max_f32 v204, 0, v204
v_sub_f32 v205, v227, v204
v_cvt_pk_bf16_f32 v205, v205, v205
v_and_b32 v205, 0xffff0000, v205
v_sub_f32 v204, v205, v227
v_mov_b32 v227, v205
v_exp_f32 v239, v204
v_bfi_b32 v99, v206, v205, v99
v_add_f32 v156, v156, v204
v_add_f32 v157, v157, v204
v_add_f32 v158, v158, v204
v_add_f32 v159, v159, v204
v_add_f32 v140, v140, v204
v_add_f32 v141, v141, v204
v_add_f32 v142, v142, v204
v_add_f32 v143, v143, v204
v_lshlrev_b32 v242, 16, v188
v_and_b32 v248, 0xffff0000, v188
v_mul_f32 v242, v242, v239
v_mul_f32 v248, v248, v239
v_cvt_pk_bf16_f32 v188, v242, v248
v_lshlrev_b32 v242, 16, v189
v_and_b32 v248, 0xffff0000, v189
v_mul_f32 v242, v242, v239
v_mul_f32 v248, v248, v239
v_cvt_pk_bf16_f32 v189, v242, v248
v_lshlrev_b32 v242, 16, v190
v_and_b32 v248, 0xffff0000, v190
v_mul_f32 v242, v242, v239
v_mul_f32 v248, v248, v239
v_cvt_pk_bf16_f32 v190, v242, v248
v_lshlrev_b32 v242, 16, v191
v_and_b32 v248, 0xffff0000, v191
v_mul_f32 v242, v242, v239
v_mul_f32 v248, v248, v239
v_cvt_pk_bf16_f32 v191, v242, v248
v_lshlrev_b32 v242, 16, v172
v_and_b32 v248, 0xffff0000, v172
v_mul_f32 v242, v242, v239
v_mul_f32 v248, v248, v239
v_cvt_pk_bf16_f32 v172, v242, v248
v_lshlrev_b32 v242, 16, v173
v_and_b32 v248, 0xffff0000, v173
v_mul_f32 v242, v242, v239
v_mul_f32 v248, v248, v239
v_cvt_pk_bf16_f32 v173, v242, v248
ds_read_b64 v[250:251], v231 offset:3072
s_waitcnt lgkmcnt(0)
v_lshlrev_b32 v242, 16, v250
v_and_b32 v248, 0xffff0000, v250
v_mul_f32 v242, v242, v239
v_mul_f32 v248, v248, v239
v_cvt_pk_bf16_f32 v250, v242, v248
v_lshlrev_b32 v242, 16, v251
v_and_b32 v248, 0xffff0000, v251
v_mul_f32 v242, v242, v239
v_mul_f32 v248, v248, v239
v_cvt_pk_bf16_f32 v251, v242, v248
ds_write_b64 v231, v[250:251] offset:3072
s_waitcnt lgkmcnt(0)
ds_read_b64 v[250:251], v231 offset:3080
s_waitcnt lgkmcnt(0)
v_lshlrev_b32 v242, 16, v250
v_and_b32 v248, 0xffff0000, v250
v_mul_f32 v242, v242, v239
v_mul_f32 v248, v248, v239
v_cvt_pk_bf16_f32 v250, v242, v248
v_lshlrev_b32 v242, 16, v251
v_and_b32 v248, 0xffff0000, v251
v_mul_f32 v242, v242, v239
v_mul_f32 v248, v248, v239
v_cvt_pk_bf16_f32 v251, v242, v248
ds_write_b64 v231, v[250:251] offset:3080
s_waitcnt lgkmcnt(0)
ds_read_b64 v[250:251], v231 offset:7168
s_waitcnt lgkmcnt(0)
v_lshlrev_b32 v242, 16, v250
v_and_b32 v248, 0xffff0000, v250
v_mul_f32 v242, v242, v239
v_mul_f32 v248, v248, v239
v_cvt_pk_bf16_f32 v250, v242, v248
v_lshlrev_b32 v242, 16, v251
v_and_b32 v248, 0xffff0000, v251
v_mul_f32 v242, v242, v239
v_mul_f32 v248, v248, v239
v_cvt_pk_bf16_f32 v251, v242, v248
ds_write_b64 v231, v[250:251] offset:7168
s_waitcnt lgkmcnt(0)
ds_read_b64 v[250:251], v231 offset:7176
s_waitcnt lgkmcnt(0)
v_lshlrev_b32 v242, 16, v250
v_and_b32 v248, 0xffff0000, v250
v_mul_f32 v242, v242, v239
v_mul_f32 v248, v248, v239
v_cvt_pk_bf16_f32 v250, v242, v248
v_lshlrev_b32 v242, 16, v251
v_and_b32 v248, 0xffff0000, v251
v_mul_f32 v242, v242, v239
v_mul_f32 v248, v248, v239
v_cvt_pk_bf16_f32 v251, v242, v248
ds_write_b64 v231, v[250:251] offset:7176
s_waitcnt lgkmcnt(0)
v_exp_f32 v232, v156
v_exp_f32 v233, v157
v_exp_f32 v234, v158
v_exp_f32 v235, v159
s_nop 1
v_cvt_pk_bf16_f32 v174, v232, v233
v_cvt_pk_bf16_f32 v175, v234, v235
s_branch L2_rare_common
L2_rare_site10:
s_mov_b32 s36, 10
s_branch L2_rare_t1_4
L2_rare_t1_4:
s_nop 15
s_nop 15
s_waitcnt lgkmcnt(0)
v_lshrrev_b32 v206, 8, v243
v_add_u32 v206, 1, v206
v_lshrrev_b32 v206, 2, v206
v_sub_u32 v206, 0, v206
v_and_b32 v206, 0xffff0000, v206
v_max_f32 v204, v128, v129
v_max3_f32 v204, v204, v130, v131
v_mov_b32 v205, v204
s_nop 1
v_permlane32_swap_b32 v204, v205
s_nop 1
v_max_f32 v204, v204, v205
v_mov_b32 v205, v204
s_nop 1
v_permlane16_swap_b32 v204, v205
s_nop 1
v_max_f32 v204, v204, v205
v_add_f32 v204, 40.0, v204
v_ceil_f32 v204, v204
v_max_f32 v204, 0, v204
v_sub_f32 v205, v224, v204
v_cvt_pk_bf16_f32 v205, v205, v205
v_and_b32 v205, 0xffff0000, v205
v_sub_f32 v204, v205, v224
v_mov_b32 v224, v205
v_exp_f32 v236, v204
v_add_f32 v128, v128, v204
v_add_f32 v129, v129, v204
v_add_f32 v130, v130, v204
v_add_f32 v131, v131, v204
v_add_f32 v144, v144, v204
v_add_f32 v145, v145, v204
v_add_f32 v146, v146, v204
v_add_f32 v147, v147, v204
v_lshlrev_b32 v242, 16, v4
v_and_b32 v248, 0xffff0000, v4
v_mul_f32 v242, v242, v236
v_mul_f32 v248, v248, v236
v_cvt_pk_bf16_f32 v4, v242, v248
v_lshlrev_b32 v242, 16, v5
v_and_b32 v248, 0xffff0000, v5
v_mul_f32 v242, v242, v236
v_mul_f32 v248, v248, v236
v_cvt_pk_bf16_f32 v5, v242, v248
v_lshlrev_b32 v242, 16, v6
v_and_b32 v248, 0xffff0000, v6
v_mul_f32 v242, v242, v236
v_mul_f32 v248, v248, v236
v_cvt_pk_bf16_f32 v6, v242, v248
v_lshlrev_b32 v242, 16, v7
v_and_b32 v248, 0xffff0000, v7
v_mul_f32 v242, v242, v236
v_mul_f32 v248, v248, v236
v_cvt_pk_bf16_f32 v7, v242, v248
v_lshlrev_b32 v242, 16, v8
v_and_b32 v248, 0xffff0000, v8
v_mul_f32 v242, v242, v236
v_mul_f32 v248, v248, v236
v_cvt_pk_bf16_f32 v8, v242, v248
v_lshlrev_b32 v242, 16, v9
v_and_b32 v248, 0xffff0000, v9
v_mul_f32 v242, v242, v236
v_mul_f32 v248, v248, v236
v_cvt_pk_bf16_f32 v9, v242, v248
v_lshlrev_b32 v242, 16, v10
v_and_b32 v248, 0xffff0000, v10
v_mul_f32 v242, v242, v236
v_mul_f32 v248, v248, v236
v_cvt_pk_bf16_f32 v10, v242, v248
v_lshlrev_b32 v242, 16, v11
v_and_b32 v248, 0xffff0000, v11
v_mul_f32 v242, v242, v236
v_mul_f32 v248, v248, v236
v_cvt_pk_bf16_f32 v11, v242, v248
v_lshlrev_b32 v242, 16, v176
v_and_b32 v248, 0xffff0000, v176
v_mul_f32 v242, v242, v236
v_mul_f32 v248, v248, v236
v_cvt_pk_bf16_f32 v176, v242, v248
v_lshlrev_b32 v242, 16, v177
v_and_b32 v248, 0xffff0000, v177
v_mul_f32 v242, v242, v236
v_mul_f32 v248, v248, v236
v_cvt_pk_bf16_f32 v177, v242, v248
v_lshlrev_b32 v242, 16, v178
v_and_b32 v248, 0xffff0000, v178
v_mul_f32 v242, v242, v236
v_mul_f32 v248, v248, v236
v_cvt_pk_bf16_f32 v178, v242, v248
v_lshlrev_b32 v242, 16, v179
v_and_b32 v248, 0xffff0000, v179
v_mul_f32 v242, v242, v236
v_mul_f32 v248, v248, v236
v_cvt_pk_bf16_f32 v179, v242, v248
v_lshlrev_b32 v242, 16, v160
v_and_b32 v248, 0xffff0000, v160
v_mul_f32 v242, v242, v236
v_mul_f32 v248, v248, v236
v_cvt_pk_bf16_f32 v160, v242, v248
v_lshlrev_b32 v242, 16, v161
v_and_b32 v248, 0xffff0000, v161
v_mul_f32 v242, v242, v236
v_mul_f32 v248, v248, v236
v_cvt_pk_bf16_f32 v161, v242, v248
v_lshlrev_b32 v242, 16, v162
v_and_b32 v248, 0xffff0000, v162
v_mul_f32 v242, v242, v236
v_mul_f32 v248, v248, v236
v_cvt_pk_bf16_f32 v162, v242, v248
v_lshlrev_b32 v242, 16, v163
v_and_b32 v248, 0xffff0000, v163
v_mul_f32 v242, v242, v236
v_mul_f32 v248, v248, v236
v_cvt_pk_bf16_f32 v163, v242, v248
v_exp_f32 v232, v128
v_exp_f32 v233, v129
v_exp_f32 v234, v130
v_exp_f32 v235, v131
s_nop 1
v_cvt_pk_bf16_f32 v0, v232, v233
v_cvt_pk_bf16_f32 v1, v234, v235
v_max_f32 v204, v132, v133
v_max3_f32 v204, v204, v134, v135
v_mov_b32 v205, v204
s_nop 1
v_permlane32_swap_b32 v204, v205
s_nop 1
v_max_f32 v204, v204, v205
v_mov_b32 v205, v204
s_nop 1
v_permlane16_swap_b32 v204, v205
s_nop 1
v_max_f32 v204, v204, v205
v_add_f32 v204, 40.0, v204
v_ceil_f32 v204, v204
v_max_f32 v204, 0, v204
v_sub_f32 v205, v225, v204
v_cvt_pk_bf16_f32 v205, v205, v205
v_and_b32 v205, 0xffff0000, v205
v_sub_f32 v204, v205, v225
v_mov_b32 v225, v205
v_exp_f32 v237, v204
v_add_f32 v132, v132, v204
v_add_f32 v133, v133, v204
v_add_f32 v134, v134, v204
v_add_f32 v135, v135, v204
v_add_f32 v148, v148, v204
v_add_f32 v149, v149, v204
v_add_f32 v150, v150, v204
v_add_f32 v151, v151, v204
v_lshlrev_b32 v242, 16, v36
v_and_b32 v248, 0xffff0000, v36
v_mul_f32 v242, v242, v237
v_mul_f32 v248, v248, v237
v_cvt_pk_bf16_f32 v36, v242, v248
v_lshlrev_b32 v242, 16, v37
v_and_b32 v248, 0xffff0000, v37
v_mul_f32 v242, v242, v237
v_mul_f32 v248, v248, v237
v_cvt_pk_bf16_f32 v37, v242, v248
v_lshlrev_b32 v242, 16, v38
v_and_b32 v248, 0xffff0000, v38
v_mul_f32 v242, v242, v237
v_mul_f32 v248, v248, v237
v_cvt_pk_bf16_f32 v38, v242, v248
v_lshlrev_b32 v242, 16, v39
v_and_b32 v248, 0xffff0000, v39
v_mul_f32 v242, v242, v237
v_mul_f32 v248, v248, v237
v_cvt_pk_bf16_f32 v39, v242, v248
v_lshlrev_b32 v242, 16, v40
v_and_b32 v248, 0xffff0000, v40
v_mul_f32 v242, v242, v237
v_mul_f32 v248, v248, v237
v_cvt_pk_bf16_f32 v40, v242, v248
v_lshlrev_b32 v242, 16, v41
v_and_b32 v248, 0xffff0000, v41
v_mul_f32 v242, v242, v237
v_mul_f32 v248, v248, v237
v_cvt_pk_bf16_f32 v41, v242, v248
v_lshlrev_b32 v242, 16, v42
v_and_b32 v248, 0xffff0000, v42
v_mul_f32 v242, v242, v237
v_mul_f32 v248, v248, v237
v_cvt_pk_bf16_f32 v42, v242, v248
v_lshlrev_b32 v242, 16, v43
v_and_b32 v248, 0xffff0000, v43
v_mul_f32 v242, v242, v237
v_mul_f32 v248, v248, v237
v_cvt_pk_bf16_f32 v43, v242, v248
v_lshlrev_b32 v242, 16, v180
v_and_b32 v248, 0xffff0000, v180
v_mul_f32 v242, v242, v237
v_mul_f32 v248, v248, v237
v_cvt_pk_bf16_f32 v180, v242, v248
v_lshlrev_b32 v242, 16, v181
v_and_b32 v248, 0xffff0000, v181
v_mul_f32 v242, v242, v237
v_mul_f32 v248, v248, v237
v_cvt_pk_bf16_f32 v181, v242, v248
v_lshlrev_b32 v242, 16, v182
v_and_b32 v248, 0xffff0000, v182
v_mul_f32 v242, v242, v237
v_mul_f32 v248, v248, v237
v_cvt_pk_bf16_f32 v182, v242, v248
v_lshlrev_b32 v242, 16, v183
v_and_b32 v248, 0xffff0000, v183
v_mul_f32 v242, v242, v237
v_mul_f32 v248, v248, v237
v_cvt_pk_bf16_f32 v183, v242, v248
v_lshlrev_b32 v242, 16, v164
v_and_b32 v248, 0xffff0000, v164
v_mul_f32 v242, v242, v237
v_mul_f32 v248, v248, v237
v_cvt_pk_bf16_f32 v164, v242, v248
v_lshlrev_b32 v242, 16, v165
v_and_b32 v248, 0xffff0000, v165
v_mul_f32 v242, v242, v237
v_mul_f32 v248, v248, v237
v_cvt_pk_bf16_f32 v165, v242, v248
v_lshlrev_b32 v242, 16, v166
v_and_b32 v248, 0xffff0000, v166
v_mul_f32 v242, v242, v237
v_mul_f32 v248, v248, v237
v_cvt_pk_bf16_f32 v166, v242, v248
v_lshlrev_b32 v242, 16, v167
v_and_b32 v248, 0xffff0000, v167
v_mul_f32 v242, v242, v237
v_mul_f32 v248, v248, v237
v_cvt_pk_bf16_f32 v167, v242, v248
v_exp_f32 v232, v132
v_exp_f32 v233, v133
v_exp_f32 v234, v134
v_exp_f32 v235, v135
s_nop 1
v_cvt_pk_bf16_f32 v32, v232, v233
v_cvt_pk_bf16_f32 v33, v234, v235
v_max_f32 v204, v136, v137
v_max3_f32 v204, v204, v138, v139
v_mov_b32 v205, v204
s_nop 1
v_permlane32_swap_b32 v204, v205
s_nop 1
v_max_f32 v204, v204, v205
v_mov_b32 v205, v204
s_nop 1
v_permlane16_swap_b32 v204, v205
s_nop 1
v_max_f32 v204, v204, v205
v_add_f32 v204, 40.0, v204
v_ceil_f32 v204, v204
v_max_f32 v204, 0, v204
v_sub_f32 v205, v226, v204
v_cvt_pk_bf16_f32 v205, v205, v205
v_and_b32 v205, 0xffff0000, v205
v_sub_f32 v204, v205, v226
v_mov_b32 v226, v205
v_exp_f32 v238, v204
v_add_f32 v136, v136, v204
v_add_f32 v137, v137, v204
v_add_f32 v138, v138, v204
v_add_f32 v139, v139, v204
v_add_f32 v152, v152, v204
v_add_f32 v153, v153, v204
v_add_f32 v154, v154, v204
v_add_f32 v155, v155, v204
v_lshlrev_b32 v242, 16, v68
v_and_b32 v248, 0xffff0000, v68
v_mul_f32 v242, v242, v238
v_mul_f32 v248, v248, v238
v_cvt_pk_bf16_f32 v68, v242, v248
v_lshlrev_b32 v242, 16, v69
v_and_b32 v248, 0xffff0000, v69
v_mul_f32 v242, v242, v238
v_mul_f32 v248, v248, v238
v_cvt_pk_bf16_f32 v69, v242, v248
v_lshlrev_b32 v242, 16, v70
v_and_b32 v248, 0xffff0000, v70
v_mul_f32 v242, v242, v238
v_mul_f32 v248, v248, v238
v_cvt_pk_bf16_f32 v70, v242, v248
v_lshlrev_b32 v242, 16, v71
v_and_b32 v248, 0xffff0000, v71
v_mul_f32 v242, v242, v238
v_mul_f32 v248, v248, v238
v_cvt_pk_bf16_f32 v71, v242, v248
v_lshlrev_b32 v242, 16, v72
v_and_b32 v248, 0xffff0000, v72
v_mul_f32 v242, v242, v238
v_mul_f32 v248, v248, v238
v_cvt_pk_bf16_f32 v72, v242, v248
v_lshlrev_b32 v242, 16, v73
v_and_b32 v248, 0xffff0000, v73
v_mul_f32 v242, v242, v238
v_mul_f32 v248, v248, v238
v_cvt_pk_bf16_f32 v73, v242, v248
v_lshlrev_b32 v242, 16, v74
v_and_b32 v248, 0xffff0000, v74
v_mul_f32 v242, v242, v238
v_mul_f32 v248, v248, v238
v_cvt_pk_bf16_f32 v74, v242, v248
v_lshlrev_b32 v242, 16, v75
v_and_b32 v248, 0xffff0000, v75
v_mul_f32 v242, v242, v238
v_mul_f32 v248, v248, v238
v_cvt_pk_bf16_f32 v75, v242, v248
v_lshlrev_b32 v242, 16, v184
v_and_b32 v248, 0xffff0000, v184
v_mul_f32 v242, v242, v238
v_mul_f32 v248, v248, v238
v_cvt_pk_bf16_f32 v184, v242, v248
v_lshlrev_b32 v242, 16, v185
v_and_b32 v248, 0xffff0000, v185
v_mul_f32 v242, v242, v238
v_mul_f32 v248, v248, v238
v_cvt_pk_bf16_f32 v185, v242, v248
v_lshlrev_b32 v242, 16, v186
v_and_b32 v248, 0xffff0000, v186
v_mul_f32 v242, v242, v238
v_mul_f32 v248, v248, v238
v_cvt_pk_bf16_f32 v186, v242, v248
v_lshlrev_b32 v242, 16, v187
v_and_b32 v248, 0xffff0000, v187
v_mul_f32 v242, v242, v238
v_mul_f32 v248, v248, v238
v_cvt_pk_bf16_f32 v187, v242, v248
v_lshlrev_b32 v242, 16, v168
v_and_b32 v248, 0xffff0000, v168
v_mul_f32 v242, v242, v238
v_mul_f32 v248, v248, v238
v_cvt_pk_bf16_f32 v168, v242, v248
v_lshlrev_b32 v242, 16, v169
v_and_b32 v248, 0xffff0000, v169
v_mul_f32 v242, v242, v238
v_mul_f32 v248, v248, v238
v_cvt_pk_bf16_f32 v169, v242, v248
v_lshlrev_b32 v242, 16, v170
v_and_b32 v248, 0xffff0000, v170
v_mul_f32 v242, v242, v238
v_mul_f32 v248, v248, v238
v_cvt_pk_bf16_f32 v170, v242, v248
v_lshlrev_b32 v242, 16, v171
v_and_b32 v248, 0xffff0000, v171
v_mul_f32 v242, v242, v238
v_mul_f32 v248, v248, v238
v_cvt_pk_bf16_f32 v171, v242, v248
v_exp_f32 v232, v136
v_exp_f32 v233, v137
v_exp_f32 v234, v138
v_exp_f32 v235, v139
s_nop 1
v_cvt_pk_bf16_f32 v64, v232, v233
v_cvt_pk_bf16_f32 v65, v234, v235
v_max_f32 v204, v140, v141
v_max3_f32 v204, v204, v142, v143
v_mov_b32 v205, v204
s_nop 1
v_permlane32_swap_b32 v204, v205
s_nop 1
v_max_f32 v204, v204, v205
v_mov_b32 v205, v204
s_nop 1
v_permlane16_swap_b32 v204, v205
s_nop 1
v_max_f32 v204, v204, v205
v_add_f32 v204, 40.0, v204
v_ceil_f32 v204, v204
v_max_f32 v204, 0, v204
v_sub_f32 v205, v227, v204
v_cvt_pk_bf16_f32 v205, v205, v205
v_and_b32 v205, 0xffff0000, v205
v_sub_f32 v204, v205, v227
v_mov_b32 v227, v205
v_exp_f32 v239, v204
v_add_f32 v140, v140, v204
v_add_f32 v141, v141, v204
v_add_f32 v142, v142, v204
v_add_f32 v143, v143, v204
v_add_f32 v156, v156, v204
v_add_f32 v157, v157, v204
v_add_f32 v158, v158, v204
v_add_f32 v159, v159, v204
v_lshlrev_b32 v242, 16, v100
v_and_b32 v248, 0xffff0000, v100
v_mul_f32 v242, v242, v239
v_mul_f32 v248, v248, v239
v_cvt_pk_bf16_f32 v100, v242, v248
v_lshlrev_b32 v242, 16, v101
v_and_b32 v248, 0xffff0000, v101
v_mul_f32 v242, v242, v239
v_mul_f32 v248, v248, v239
v_cvt_pk_bf16_f32 v101, v242, v248
v_lshlrev_b32 v242, 16, v102
v_and_b32 v248, 0xffff0000, v102
v_mul_f32 v242, v242, v239
v_mul_f32 v248, v248, v239
v_cvt_pk_bf16_f32 v102, v242, v248
v_lshlrev_b32 v242, 16, v103
v_and_b32 v248, 0xffff0000, v103
v_mul_f32 v242, v242, v239
v_mul_f32 v248, v248, v239
v_cvt_pk_bf16_f32 v103, v242, v248
v_lshlrev_b32 v242, 16, v104
v_and_b32 v248, 0xffff0000, v104
v_mul_f32 v242, v242, v239
v_mul_f32 v248, v248, v239
v_cvt_pk_bf16_f32 v104, v242, v248
v_lshlrev_b32 v242, 16, v105
v_and_b32 v248, 0xffff0000, v105
v_mul_f32 v242, v242, v239
v_mul_f32 v248, v248, v239
v_cvt_pk_bf16_f32 v105, v242, v248
v_lshlrev_b32 v242, 16, v106
v_and_b32 v248, 0xffff0000, v106
v_mul_f32 v242, v242, v239
v_mul_f32 v248, v248, v239
v_cvt_pk_bf16_f32 v106, v242, v248
v_lshlrev_b32 v242, 16, v107
v_and_b32 v248, 0xffff0000, v107
v_mul_f32 v242, v242, v239
v_mul_f32 v248, v248, v239
v_cvt_pk_bf16_f32 v107, v242, v248
v_lshlrev_b32 v242, 16, v188
v_and_b32 v248, 0xffff0000, v188
v_mul_f32 v242, v242, v239
v_mul_f32 v248, v248, v239
v_cvt_pk_bf16_f32 v188, v242, v248
v_lshlrev_b32 v242, 16, v189
v_and_b32 v248, 0xffff0000, v189
v_mul_f32 v242, v242, v239
v_mul_f32 v248, v248, v239
v_cvt_pk_bf16_f32 v189, v242, v248
v_lshlrev_b32 v242, 16, v190
v_and_b32 v248, 0xffff0000, v190
v_mul_f32 v242, v242, v239
v_mul_f32 v248, v248, v239
v_cvt_pk_bf16_f32 v190, v242, v248
v_lshlrev_b32 v242, 16, v191
v_and_b32 v248, 0xffff0000, v191
v_mul_f32 v242, v242, v239
v_mul_f32 v248, v248, v239
v_cvt_pk_bf16_f32 v191, v242, v248
v_lshlrev_b32 v242, 16, v172
v_and_b32 v248, 0xffff0000, v172
v_mul_f32 v242, v242, v239
v_mul_f32 v248, v248, v239
v_cvt_pk_bf16_f32 v172, v242, v248
v_lshlrev_b32 v242, 16, v173
v_and_b32 v248, 0xffff0000, v173
v_mul_f32 v242, v242, v239
v_mul_f32 v248, v248, v239
v_cvt_pk_bf16_f32 v173, v242, v248
v_lshlrev_b32 v242, 16, v174
v_and_b32 v248, 0xffff0000, v174
v_mul_f32 v242, v242, v239
v_mul_f32 v248, v248, v239
v_cvt_pk_bf16_f32 v174, v242, v248
v_lshlrev_b32 v242, 16, v175
v_and_b32 v248, 0xffff0000, v175
v_mul_f32 v242, v242, v239
v_mul_f32 v248, v248, v239
v_cvt_pk_bf16_f32 v175, v242, v248
v_exp_f32 v232, v140
v_exp_f32 v233, v141
v_exp_f32 v234, v142
v_exp_f32 v235, v143
s_nop 1
v_cvt_pk_bf16_f32 v96, v232, v233
v_cvt_pk_bf16_f32 v97, v234, v235
s_branch L2_rare_common
L2_rare_site11:
s_mov_b32 s36, 11
s_branch L2_rare_t1_5
L2_rare_t1_5:
s_nop 15
s_nop 15
s_waitcnt lgkmcnt(0)
v_lshrrev_b32 v206, 8, v243
v_add_u32 v206, 1, v206
v_lshrrev_b32 v206, 2, v206
v_sub_u32 v206, 0, v206
v_and_b32 v206, 0xffff0000, v206
v_max_f32 v204, v144, v145
v_max3_f32 v204, v204, v146, v147
v_mov_b32 v205, v204
s_nop 1
v_permlane32_swap_b32 v204, v205
s_nop 1
v_max_f32 v204, v204, v205
v_mov_b32 v205, v204
s_nop 1
v_permlane16_swap_b32 v204, v205
s_nop 1
v_max_f32 v204, v204, v205
v_add_f32 v204, 40.0, v204
v_ceil_f32 v204, v204
v_max_f32 v204, 0, v204
v_sub_f32 v205, v224, v204
v_cvt_pk_bf16_f32 v205, v205, v205
v_and_b32 v205, 0xffff0000, v205
v_sub_f32 v204, v205, v224
v_mov_b32 v224, v205
v_exp_f32 v236, v204
v_add_f32 v144, v144, v204
v_add_f32 v145, v145, v204
v_add_f32 v146, v146, v204
v_add_f32 v147, v147, v204
v_add_f32 v128, v128, v204
v_add_f32 v129, v129, v204
v_add_f32 v130, v130, v204
v_add_f32 v131, v131, v204
v_lshlrev_b32 v242, 16, v4
v_and_b32 v248, 0xffff0000, v4
v_mul_f32 v242, v242, v236
v_mul_f32 v248, v248, v236
v_cvt_pk_bf16_f32 v4, v242, v248
v_lshlrev_b32 v242, 16, v5
v_and_b32 v248, 0xffff0000, v5
v_mul_f32 v242, v242, v236
v_mul_f32 v248, v248, v236
v_cvt_pk_bf16_f32 v5, v242, v248
v_lshlrev_b32 v242, 16, v6
v_and_b32 v248, 0xffff0000, v6
v_mul_f32 v242, v242, v236
v_mul_f32 v248, v248, v236
v_cvt_pk_bf16_f32 v6, v242, v248
v_lshlrev_b32 v242, 16, v7
v_and_b32 v248, 0xffff0000, v7
v_mul_f32 v242, v242, v236
v_mul_f32 v248, v248, v236
v_cvt_pk_bf16_f32 v7, v242, v248
v_lshlrev_b32 v242, 16, v8
v_and_b32 v248, 0xffff0000, v8
v_mul_f32 v242, v242, v236
v_mul_f32 v248, v248, v236
v_cvt_pk_bf16_f32 v8, v242, v248
v_lshlrev_b32 v242, 16, v9
v_and_b32 v248, 0xffff0000, v9
v_mul_f32 v242, v242, v236
v_mul_f32 v248, v248, v236
v_cvt_pk_bf16_f32 v9, v242, v248
v_lshlrev_b32 v242, 16, v10
v_and_b32 v248, 0xffff0000, v10
v_mul_f32 v242, v242, v236
v_mul_f32 v248, v248, v236
v_cvt_pk_bf16_f32 v10, v242, v248
v_lshlrev_b32 v242, 16, v11
v_and_b32 v248, 0xffff0000, v11
v_mul_f32 v242, v242, v236
v_mul_f32 v248, v248, v236
v_cvt_pk_bf16_f32 v11, v242, v248
v_lshlrev_b32 v242, 16, v176
v_and_b32 v248, 0xffff0000, v176
v_mul_f32 v242, v242, v236
v_mul_f32 v248, v248, v236
v_cvt_pk_bf16_f32 v176, v242, v248
v_lshlrev_b32 v242, 16, v177
v_and_b32 v248, 0xffff0000, v177
v_mul_f32 v242, v242, v236
v_mul_f32 v248, v248, v236
v_cvt_pk_bf16_f32 v177, v242, v248
v_lshlrev_b32 v242, 16, v178
v_and_b32 v248, 0xffff0000, v178
v_mul_f32 v242, v242, v236
v_mul_f32 v248, v248, v236
v_cvt_pk_bf16_f32 v178, v242, v248
v_lshlrev_b32 v242, 16, v179
v_and_b32 v248, 0xffff0000, v179
v_mul_f32 v242, v242, v236
v_mul_f32 v248, v248, v236
v_cvt_pk_bf16_f32 v179, v242, v248
v_lshlrev_b32 v242, 16, v160
v_and_b32 v248, 0xffff0000, v160
v_mul_f32 v242, v242, v236
v_mul_f32 v248, v248, v236
v_cvt_pk_bf16_f32 v160, v242, v248
v_lshlrev_b32 v242, 16, v161
v_and_b32 v248, 0xffff0000, v161
v_mul_f32 v242, v242, v236
v_mul_f32 v248, v248, v236
v_cvt_pk_bf16_f32 v161, v242, v248
v_lshlrev_b32 v242, 16, v162
v_and_b32 v248, 0xffff0000, v162
v_mul_f32 v242, v242, v236
v_mul_f32 v248, v248, v236
v_cvt_pk_bf16_f32 v162, v242, v248
v_lshlrev_b32 v242, 16, v163
v_and_b32 v248, 0xffff0000, v163
v_mul_f32 v242, v242, v236
v_mul_f32 v248, v248, v236
v_cvt_pk_bf16_f32 v163, v242, v248
v_lshlrev_b32 v242, 16, v0
v_and_b32 v248, 0xffff0000, v0
v_mul_f32 v242, v242, v236
v_mul_f32 v248, v248, v236
v_cvt_pk_bf16_f32 v0, v242, v248
v_lshlrev_b32 v242, 16, v1
v_and_b32 v248, 0xffff0000, v1
v_mul_f32 v242, v242, v236
v_mul_f32 v248, v248, v236
v_cvt_pk_bf16_f32 v1, v242, v248
v_exp_f32 v232, v144
v_exp_f32 v233, v145
v_exp_f32 v234, v146
v_exp_f32 v235, v147
s_nop 1
v_cvt_pk_bf16_f32 v2, v232, v233
v_cvt_pk_bf16_f32 v3, v234, v235
v_max_f32 v204, v148, v149
v_max3_f32 v204, v204, v150, v151
v_mov_b32 v205, v204
s_nop 1
v_permlane32_swap_b32 v204, v205
s_nop 1
v_max_f32 v204, v204, v205
v_mov_b32 v205, v204
s_nop 1
v_permlane16_swap_b32 v204, v205
s_nop 1
v_max_f32 v204, v204, v205
v_add_f32 v204, 40.0, v204
v_ceil_f32 v204, v204
v_max_f32 v204, 0, v204
v_sub_f32 v205, v225, v204
v_cvt_pk_bf16_f32 v205, v205, v205
v_and_b32 v205, 0xffff0000, v205
v_sub_f32 v204, v205, v225
v_mov_b32 v225, v205
v_exp_f32 v237, v204
v_add_f32 v148, v148, v204
v_add_f32 v149, v149, v204
v_add_f32 v150, v150, v204
v_add_f32 v151, v151, v204
v_add_f32 v132, v132, v204
v_add_f32 v133, v133, v204
v_add_f32 v134, v134, v204
v_add_f32 v135, v135, v204
v_lshlrev_b32 v242, 16, v36
v_and_b32 v248, 0xffff0000, v36
v_mul_f32 v242, v242, v237
v_mul_f32 v248, v248, v237
v_cvt_pk_bf16_f32 v36, v242, v248
v_lshlrev_b32 v242, 16, v37
v_and_b32 v248, 0xffff0000, v37
v_mul_f32 v242, v242, v237
v_mul_f32 v248, v248, v237
v_cvt_pk_bf16_f32 v37, v242, v248
v_lshlrev_b32 v242, 16, v38
v_and_b32 v248, 0xffff0000, v38
v_mul_f32 v242, v242, v237
v_mul_f32 v248, v248, v237
v_cvt_pk_bf16_f32 v38, v242, v248
v_lshlrev_b32 v242, 16, v39
v_and_b32 v248, 0xffff0000, v39
v_mul_f32 v242, v242, v237
v_mul_f32 v248, v248, v237
v_cvt_pk_bf16_f32 v39, v242, v248
v_lshlrev_b32 v242, 16, v40
v_and_b32 v248, 0xffff0000, v40
v_mul_f32 v242, v242, v237
v_mul_f32 v248, v248, v237
v_cvt_pk_bf16_f32 v40, v242, v248
v_lshlrev_b32 v242, 16, v41
v_and_b32 v248, 0xffff0000, v41
v_mul_f32 v242, v242, v237
v_mul_f32 v248, v248, v237
v_cvt_pk_bf16_f32 v41, v242, v248
v_lshlrev_b32 v242, 16, v42
v_and_b32 v248, 0xffff0000, v42
v_mul_f32 v242, v242, v237
v_mul_f32 v248, v248, v237
v_cvt_pk_bf16_f32 v42, v242, v248
v_lshlrev_b32 v242, 16, v43
v_and_b32 v248, 0xffff0000, v43
v_mul_f32 v242, v242, v237
v_mul_f32 v248, v248, v237
v_cvt_pk_bf16_f32 v43, v242, v248
v_lshlrev_b32 v242, 16, v180
v_and_b32 v248, 0xffff0000, v180
v_mul_f32 v242, v242, v237
v_mul_f32 v248, v248, v237
v_cvt_pk_bf16_f32 v180, v242, v248
v_lshlrev_b32 v242, 16, v181
v_and_b32 v248, 0xffff0000, v181
v_mul_f32 v242, v242, v237
v_mul_f32 v248, v248, v237
v_cvt_pk_bf16_f32 v181, v242, v248
v_lshlrev_b32 v242, 16, v182
v_and_b32 v248, 0xffff0000, v182
v_mul_f32 v242, v242, v237
v_mul_f32 v248, v248, v237
v_cvt_pk_bf16_f32 v182, v242, v248
v_lshlrev_b32 v242, 16, v183
v_and_b32 v248, 0xffff0000, v183
v_mul_f32 v242, v242, v237
v_mul_f32 v248, v248, v237
v_cvt_pk_bf16_f32 v183, v242, v248
v_lshlrev_b32 v242, 16, v164
v_and_b32 v248, 0xffff0000, v164
v_mul_f32 v242, v242, v237
v_mul_f32 v248, v248, v237
v_cvt_pk_bf16_f32 v164, v242, v248
v_lshlrev_b32 v242, 16, v165
v_and_b32 v248, 0xffff0000, v165
v_mul_f32 v242, v242, v237
v_mul_f32 v248, v248, v237
v_cvt_pk_bf16_f32 v165, v242, v248
v_lshlrev_b32 v242, 16, v166
v_and_b32 v248, 0xffff0000, v166
v_mul_f32 v242, v242, v237
v_mul_f32 v248, v248, v237
v_cvt_pk_bf16_f32 v166, v242, v248
v_lshlrev_b32 v242, 16, v167
v_and_b32 v248, 0xffff0000, v167
v_mul_f32 v242, v242, v237
v_mul_f32 v248, v248, v237
v_cvt_pk_bf16_f32 v167, v242, v248
v_lshlrev_b32 v242, 16, v32
v_and_b32 v248, 0xffff0000, v32
v_mul_f32 v242, v242, v237
v_mul_f32 v248, v248, v237
v_cvt_pk_bf16_f32 v32, v242, v248
v_lshlrev_b32 v242, 16, v33
v_and_b32 v248, 0xffff0000, v33
v_mul_f32 v242, v242, v237
v_mul_f32 v248, v248, v237
v_cvt_pk_bf16_f32 v33, v242, v248
v_exp_f32 v232, v148
v_exp_f32 v233, v149
v_exp_f32 v234, v150
v_exp_f32 v235, v151
s_nop 1
v_cvt_pk_bf16_f32 v34, v232, v233
v_cvt_pk_bf16_f32 v35, v234, v235
v_max_f32 v204, v152, v153
v_max3_f32 v204, v204, v154, v155
v_mov_b32 v205, v204
s_nop 1
v_permlane32_swap_b32 v204, v205
s_nop 1
v_max_f32 v204, v204, v205
v_mov_b32 v205, v204
s_nop 1
v_permlane16_swap_b32 v204, v205
s_nop 1
v_max_f32 v204, v204, v205
v_add_f32 v204, 40.0, v204
v_ceil_f32 v204, v204
v_max_f32 v204, 0, v204
v_sub_f32 v205, v226, v204
v_cvt_pk_bf16_f32 v205, v205, v205
v_and_b32 v205, 0xffff0000, v205
v_sub_f32 v204, v205, v226
v_mov_b32 v226, v205
v_exp_f32 v238, v204
v_add_f32 v152, v152, v204
v_add_f32 v153, v153, v204
v_add_f32 v154, v154, v204
v_add_f32 v155, v155, v204
v_add_f32 v136, v136, v204
v_add_f32 v137, v137, v204
v_add_f32 v138, v138, v204
v_add_f32 v139, v139, v204
v_lshlrev_b32 v242, 16, v68
v_and_b32 v248, 0xffff0000, v68
v_mul_f32 v242, v242, v238
v_mul_f32 v248, v248, v238
v_cvt_pk_bf16_f32 v68, v242, v248
v_lshlrev_b32 v242, 16, v69
v_and_b32 v248, 0xffff0000, v69
v_mul_f32 v242, v242, v238
v_mul_f32 v248, v248, v238
v_cvt_pk_bf16_f32 v69, v242, v248
v_lshlrev_b32 v242, 16, v70
v_and_b32 v248, 0xffff0000, v70
v_mul_f32 v242, v242, v238
v_mul_f32 v248, v248, v238
v_cvt_pk_bf16_f32 v70, v242, v248
v_lshlrev_b32 v242, 16, v71
v_and_b32 v248, 0xffff0000, v71
v_mul_f32 v242, v242, v238
v_mul_f32 v248, v248, v238
v_cvt_pk_bf16_f32 v71, v242, v248
v_lshlrev_b32 v242, 16, v72
v_and_b32 v248, 0xffff0000, v72
v_mul_f32 v242, v242, v238
v_mul_f32 v248, v248, v238
v_cvt_pk_bf16_f32 v72, v242, v248
v_lshlrev_b32 v242, 16, v73
v_and_b32 v248, 0xffff0000, v73
v_mul_f32 v242, v242, v238
v_mul_f32 v248, v248, v238
v_cvt_pk_bf16_f32 v73, v242, v248
v_lshlrev_b32 v242, 16, v74
v_and_b32 v248, 0xffff0000, v74
v_mul_f32 v242, v242, v238
v_mul_f32 v248, v248, v238
v_cvt_pk_bf16_f32 v74, v242, v248
v_lshlrev_b32 v242, 16, v75
v_and_b32 v248, 0xffff0000, v75
v_mul_f32 v242, v242, v238
v_mul_f32 v248, v248, v238
v_cvt_pk_bf16_f32 v75, v242, v248
v_lshlrev_b32 v242, 16, v184
v_and_b32 v248, 0xffff0000, v184
v_mul_f32 v242, v242, v238
v_mul_f32 v248, v248, v238
v_cvt_pk_bf16_f32 v184, v242, v248
v_lshlrev_b32 v242, 16, v185
v_and_b32 v248, 0xffff0000, v185
v_mul_f32 v242, v242, v238
v_mul_f32 v248, v248, v238
v_cvt_pk_bf16_f32 v185, v242, v248
v_lshlrev_b32 v242, 16, v186
v_and_b32 v248, 0xffff0000, v186
v_mul_f32 v242, v242, v238
v_mul_f32 v248, v248, v238
v_cvt_pk_bf16_f32 v186, v242, v248
v_lshlrev_b32 v242, 16, v187
v_and_b32 v248, 0xffff0000, v187
v_mul_f32 v242, v242, v238
v_mul_f32 v248, v248, v238
v_cvt_pk_bf16_f32 v187, v242, v248
v_lshlrev_b32 v242, 16, v168
v_and_b32 v248, 0xffff0000, v168
v_mul_f32 v242, v242, v238
v_mul_f32 v248, v248, v238
v_cvt_pk_bf16_f32 v168, v242, v248
v_lshlrev_b32 v242, 16, v169
v_and_b32 v248, 0xffff0000, v169
v_mul_f32 v242, v242, v238
v_mul_f32 v248, v248, v238
v_cvt_pk_bf16_f32 v169, v242, v248
v_lshlrev_b32 v242, 16, v170
v_and_b32 v248, 0xffff0000, v170
v_mul_f32 v242, v242, v238
v_mul_f32 v248, v248, v238
v_cvt_pk_bf16_f32 v170, v242, v248
v_lshlrev_b32 v242, 16, v171
v_and_b32 v248, 0xffff0000, v171
v_mul_f32 v242, v242, v238
v_mul_f32 v248, v248, v238
v_cvt_pk_bf16_f32 v171, v242, v248
v_lshlrev_b32 v242, 16, v64
v_and_b32 v248, 0xffff0000, v64
v_mul_f32 v242, v242, v238
v_mul_f32 v248, v248, v238
v_cvt_pk_bf16_f32 v64, v242, v248
v_lshlrev_b32 v242, 16, v65
v_and_b32 v248, 0xffff0000, v65
v_mul_f32 v242, v242, v238
v_mul_f32 v248, v248, v238
v_cvt_pk_bf16_f32 v65, v242, v248
v_exp_f32 v232, v152
v_exp_f32 v233, v153
v_exp_f32 v234, v154
v_exp_f32 v235, v155
s_nop 1
v_cvt_pk_bf16_f32 v66, v232, v233
v_cvt_pk_bf16_f32 v67, v234, v235
v_max_f32 v204, v156, v157
v_max3_f32 v204, v204, v158, v159
v_mov_b32 v205, v204
s_nop 1
v_permlane32_swap_b32 v204, v205
s_nop 1
v_max_f32 v204, v204, v205
v_mov_b32 v205, v204
s_nop 1
v_permlane16_swap_b32 v204, v205
s_nop 1
v_max_f32 v204, v204, v205
v_add_f32 v204, 40.0, v204
v_ceil_f32 v204, v204
v_max_f32 v204, 0, v204
v_sub_f32 v205, v227, v204
v_cvt_pk_bf16_f32 v205, v205, v205
v_and_b32 v205, 0xffff0000, v205
v_sub_f32 v204, v205, v227
v_mov_b32 v227, v205
v_exp_f32 v239, v204
v_add_f32 v156, v156, v204
v_add_f32 v157, v157, v204
v_add_f32 v158, v158, v204
v_add_f32 v159, v159, v204
v_add_f32 v140, v140, v204
v_add_f32 v141, v141, v204
v_add_f32 v142, v142, v204
v_add_f32 v143, v143, v204
v_lshlrev_b32 v242, 16, v100
v_and_b32 v248, 0xffff0000, v100
v_mul_f32 v242, v242, v239
v_mul_f32 v248, v248, v239
v_cvt_pk_bf16_f32 v100, v242, v248
v_lshlrev_b32 v242, 16, v101
v_and_b32 v248, 0xffff0000, v101
v_mul_f32 v242, v242, v239
v_mul_f32 v248, v248, v239
v_cvt_pk_bf16_f32 v101, v242, v248
v_lshlrev_b32 v242, 16, v102
v_and_b32 v248, 0xffff0000, v102
v_mul_f32 v242, v242, v239
v_mul_f32 v248, v248, v239
v_cvt_pk_bf16_f32 v102, v242, v248
v_lshlrev_b32 v242, 16, v103
v_and_b32 v248, 0xffff0000, v103
v_mul_f32 v242, v242, v239
v_mul_f32 v248, v248, v239
v_cvt_pk_bf16_f32 v103, v242, v248
v_lshlrev_b32 v242, 16, v104
v_and_b32 v248, 0xffff0000, v104
v_mul_f32 v242, v242, v239
v_mul_f32 v248, v248, v239
v_cvt_pk_bf16_f32 v104, v242, v248
v_lshlrev_b32 v242, 16, v105
v_and_b32 v248, 0xffff0000, v105
v_mul_f32 v242, v242, v239
v_mul_f32 v248, v248, v239
v_cvt_pk_bf16_f32 v105, v242, v248
v_lshlrev_b32 v242, 16, v106
v_and_b32 v248, 0xffff0000, v106
v_mul_f32 v242, v242, v239
v_mul_f32 v248, v248, v239
v_cvt_pk_bf16_f32 v106, v242, v248
v_lshlrev_b32 v242, 16, v107
v_and_b32 v248, 0xffff0000, v107
v_mul_f32 v242, v242, v239
v_mul_f32 v248, v248, v239
v_cvt_pk_bf16_f32 v107, v242, v248
v_lshlrev_b32 v242, 16, v188
v_and_b32 v248, 0xffff0000, v188
v_mul_f32 v242, v242, v239
v_mul_f32 v248, v248, v239
v_cvt_pk_bf16_f32 v188, v242, v248
v_lshlrev_b32 v242, 16, v189
v_and_b32 v248, 0xffff0000, v189
v_mul_f32 v242, v242, v239
v_mul_f32 v248, v248, v239
v_cvt_pk_bf16_f32 v189, v242, v248
v_lshlrev_b32 v242, 16, v190
v_and_b32 v248, 0xffff0000, v190
v_mul_f32 v242, v242, v239
v_mul_f32 v248, v248, v239
v_cvt_pk_bf16_f32 v190, v242, v248
v_lshlrev_b32 v242, 16, v191
v_and_b32 v248, 0xffff0000, v191
v_mul_f32 v242, v242, v239
v_mul_f32 v248, v248, v239
v_cvt_pk_bf16_f32 v191, v242, v248
v_lshlrev_b32 v242, 16, v172
v_and_b32 v248, 0xffff0000, v172
v_mul_f32 v242, v242, v239
v_mul_f32 v248, v248, v239
v_cvt_pk_bf16_f32 v172, v242, v248
v_lshlrev_b32 v242, 16, v173
v_and_b32 v248, 0xffff0000, v173
v_mul_f32 v242, v242, v239
v_mul_f32 v248, v248, v239
v_cvt_pk_bf16_f32 v173, v242, v248
v_lshlrev_b32 v242, 16, v174
v_and_b32 v248, 0xffff0000, v174
v_mul_f32 v242, v242, v239
v_mul_f32 v248, v248, v239
v_cvt_pk_bf16_f32 v174, v242, v248
v_lshlrev_b32 v242, 16, v175
v_and_b32 v248, 0xffff0000, v175
v_mul_f32 v242, v242, v239
v_mul_f32 v248, v248, v239
v_cvt_pk_bf16_f32 v175, v242, v248
v_lshlrev_b32 v242, 16, v96
v_and_b32 v248, 0xffff0000, v96
v_mul_f32 v242, v242, v239
v_mul_f32 v248, v248, v239
v_cvt_pk_bf16_f32 v96, v242, v248
v_lshlrev_b32 v242, 16, v97
v_and_b32 v248, 0xffff0000, v97
v_mul_f32 v242, v242, v239
v_mul_f32 v248, v248, v239
v_cvt_pk_bf16_f32 v97, v242, v248
v_exp_f32 v232, v156
v_exp_f32 v233, v157
v_exp_f32 v234, v158
v_exp_f32 v235, v159
s_nop 1
v_cvt_pk_bf16_f32 v98, v232, v233
v_cvt_pk_bf16_f32 v99, v234, v235
s_branch L2_rare_common
LF_hl_1:
s_mov_b32 s94, 0x10000
s_mov_b32 s3, 0x7c28000
LF_hl2_1:
v_lshlrev_b32 v241, 3, v243
buffer_load_dwordx2 v[240:241], v241, s[16:19], s3 offen sc1
s_sub_u32 s94, s94, 1
s_waitcnt vmcnt(0)
s_cbranch_scc1 LF_hlret_1
v_cmp_ne_u64_e64 s[38:39], s[98:99], v[240:241]
s_and_b64 s[38:39], s[38:39], s[96:97]
s_cbranch_scc1 LF_hl2_1
s_branch LF_hlret_1
L2_rare_site12:
s_mov_b32 s36, 12
s_branch L2_rare_t0_0
L2_rare_t0_0:
s_nop 15
s_nop 15
s_waitcnt lgkmcnt(0)
v_lshrrev_b32 v206, 8, v243
v_add_u32 v206, 1, v206
v_lshrrev_b32 v206, 2, v206
v_sub_u32 v206, 0, v206
v_and_b32 v206, 0xffff0000, v206
v_max_f32 v204, v128, v129
v_max3_f32 v204, v204, v130, v131
v_mov_b32 v205, v204
s_nop 1
v_permlane32_swap_b32 v204, v205
s_nop 1
v_max_f32 v204, v204, v205
v_mov_b32 v205, v204
s_nop 1
v_permlane16_swap_b32 v204, v205
s_nop 1
v_max_f32 v204, v204, v205
v_add_f32 v204, 40.0, v204
v_ceil_f32 v204, v204
v_max_f32 v204, 0, v204
v_sub_f32 v205, v224, v204
v_cvt_pk_bf16_f32 v205, v205, v205
v_and_b32 v205, 0xffff0000, v205
v_sub_f32 v204, v205, v224
v_mov_b32 v224, v205
v_exp_f32 v236, v204
v_bfi_b32 v3, v206, v205, v3
v_add_f32 v128, v128, v204
v_add_f32 v129, v129, v204
v_add_f32 v130, v130, v204
v_add_f32 v131, v131, v204
v_add_f32 v144, v144, v204
v_add_f32 v145, v145, v204
v_add_f32 v146, v146, v204
v_add_f32 v147, v147, v204
v_lshlrev_b32 v242, 16, v176
v_and_b32 v248, 0xffff0000, v176
v_mul_f32 v242, v242, v236
v_mul_f32 v248, v248, v236
v_cvt_pk_bf16_f32 v176, v242, v248
v_lshlrev_b32 v242, 16, v177
v_and_b32 v248, 0xffff0000, v177
v_mul_f32 v242, v242, v236
v_mul_f32 v248, v248, v236
v_cvt_pk_bf16_f32 v177, v242, v248
v_lshlrev_b32 v242, 16, v178
v_and_b32 v248, 0xffff0000, v178
v_mul_f32 v242, v242, v236
v_mul_f32 v248, v248, v236
v_cvt_pk_bf16_f32 v178, v242, v248
v_lshlrev_b32 v242, 16, v179
v_and_b32 v248, 0xffff0000, v179
v_mul_f32 v242, v242, v236
v_mul_f32 v248, v248, v236
v_cvt_pk_bf16_f32 v179, v242, v248
ds_read_b64 v[250:251], v231 offset:0
s_waitcnt lgkmcnt(0)
v_lshlrev_b32 v242, 16, v250
v_and_b32 v248, 0xffff0000, v250
v_mul_f32 v242, v242, v236
v_mul_f32 v248, v248, v236
v_cvt_pk_bf16_f32 v250, v242, v248
v_lshlrev_b32 v242, 16, v251
v_and_b32 v248, 0xffff0000, v251
v_mul_f32 v242, v242, v236
v_mul_f32 v248, v248, v236
v_cvt_pk_bf16_f32 v251, v242, v248
ds_write_b64 v231, v[250:251] offset:0
s_waitcnt lgkmcnt(0)
ds_read_b64 v[250:251], v231 offset:8
s_waitcnt lgkmcnt(0)
v_lshlrev_b32 v242, 16, v250
v_and_b32 v248, 0xffff0000, v250
v_mul_f32 v242, v242, v236
v_mul_f32 v248, v248, v236
v_cvt_pk_bf16_f32 v250, v242, v248
v_lshlrev_b32 v242, 16, v251
v_and_b32 v248, 0xffff0000, v251
v_mul_f32 v242, v242, v236
v_mul_f32 v248, v248, v236
v_cvt_pk_bf16_f32 v251, v242, v248
ds_write_b64 v231, v[250:251] offset:8
s_waitcnt lgkmcnt(0)
v_exp_f32 v232, v128
v_exp_f32 v233, v129
v_exp_f32 v234, v130
v_exp_f32 v235, v131
s_nop 1
v_cvt_pk_bf16_f32 v160, v232, v233
v_cvt_pk_bf16_f32 v161, v234, v235
v_max_f32 v204, v132, v133
v_max3_f32 v204, v204, v134, v135
v_mov_b32 v205, v204
s_nop 1
v_permlane32_swap_b32 v204, v205
s_nop 1
v_max_f32 v204, v204, v205
v_mov_b32 v205, v204
s_nop 1
v_permlane16_swap_b32 v204, v205
s_nop 1
v_max_f32 v204, v204, v205
v_add_f32 v204, 40.0, v204
v_ceil_f32 v204, v204
v_max_f32 v204, 0, v204
v_sub_f32 v205, v225, v204
v_cvt_pk_bf16_f32 v205, v205, v205
v_and_b32 v205, 0xffff0000, v205
v_sub_f32 v204, v205, v225
v_mov_b32 v225, v205
v_exp_f32 v237, v204
v_bfi_b32 v35, v206, v205, v35
v_add_f32 v132, v132, v204
v_add_f32 v133, v133, v204
v_add_f32 v134, v134, v204
v_add_f32 v135, v135, v204
v_add_f32 v148, v148, v204
v_add_f32 v149, v149, v204
v_add_f32 v150, v150, v204
v_add_f32 v151, v151, v204
v_lshlrev_b32 v242, 16, v180
v_and_b32 v248, 0xffff0000, v180
v_mul_f32 v242, v242, v237
v_mul_f32 v248, v248, v237
v_cvt_pk_bf16_f32 v180, v242, v248
v_lshlrev_b32 v242, 16, v181
v_and_b32 v248, 0xffff0000, v181
v_mul_f32 v242, v242, v237
v_mul_f32 v248, v248, v237
v_cvt_pk_bf16_f32 v181, v242, v248
v_lshlrev_b32 v242, 16, v182
v_and_b32 v248, 0xffff0000, v182
v_mul_f32 v242, v242, v237
v_mul_f32 v248, v248, v237
v_cvt_pk_bf16_f32 v182, v242, v248
v_lshlrev_b32 v242, 16, v183
v_and_b32 v248, 0xffff0000, v183
v_mul_f32 v242, v242, v237
v_mul_f32 v248, v248, v237
v_cvt_pk_bf16_f32 v183, v242, v248
ds_read_b64 v[250:251], v231 offset:1024
s_waitcnt lgkmcnt(0)
v_lshlrev_b32 v242, 16, v250
v_and_b32 v248, 0xffff0000, v250
v_mul_f32 v242, v242, v237
v_mul_f32 v248, v248, v237
v_cvt_pk_bf16_f32 v250, v242, v248
v_lshlrev_b32 v242, 16, v251
v_and_b32 v248, 0xffff0000, v251
v_mul_f32 v242, v242, v237
v_mul_f32 v248, v248, v237
v_cvt_pk_bf16_f32 v251, v242, v248
ds_write_b64 v231, v[250:251] offset:1024
s_waitcnt lgkmcnt(0)
ds_read_b64 v[250:251], v231 offset:1032
s_waitcnt lgkmcnt(0)
v_lshlrev_b32 v242, 16, v250
v_and_b32 v248, 0xffff0000, v250
v_mul_f32 v242, v242, v237
v_mul_f32 v248, v248, v237
v_cvt_pk_bf16_f32 v250, v242, v248
v_lshlrev_b32 v242, 16, v251
v_and_b32 v248, 0xffff0000, v251
v_mul_f32 v242, v242, v237
v_mul_f32 v248, v248, v237
v_cvt_pk_bf16_f32 v251, v242, v248
ds_write_b64 v231, v[250:251] offset:1032
s_waitcnt lgkmcnt(0)
v_exp_f32 v232, v132
v_exp_f32 v233, v133
v_exp_f32 v234, v134
v_exp_f32 v235, v135
s_nop 1
v_cvt_pk_bf16_f32 v164, v232, v233
v_cvt_pk_bf16_f32 v165, v234, v235
v_max_f32 v204, v136, v137
v_max3_f32 v204, v204, v138, v139
v_mov_b32 v205, v204
s_nop 1
v_permlane32_swap_b32 v204, v205
s_nop 1
v_max_f32 v204, v204, v205
v_mov_b32 v205, v204
s_nop 1
v_permlane16_swap_b32 v204, v205
s_nop 1
v_max_f32 v204, v204, v205
v_add_f32 v204, 40.0, v204
v_ceil_f32 v204, v204
v_max_f32 v204, 0, v204
v_sub_f32 v205, v226, v204
v_cvt_pk_bf16_f32 v205, v205, v205
v_and_b32 v205, 0xffff0000, v205
v_sub_f32 v204, v205, v226
v_mov_b32 v226, v205
v_exp_f32 v238, v204
v_bfi_b32 v67, v206, v205, v67
v_add_f32 v136, v136, v204
v_add_f32 v137, v137, v204
v_add_f32 v138, v138, v204
v_add_f32 v139, v139, v204
v_add_f32 v152, v152, v204
v_add_f32 v153, v153, v204
v_add_f32 v154, v154, v204
v_add_f32 v155, v155, v204
v_lshlrev_b32 v242, 16, v184
v_and_b32 v248, 0xffff0000, v184
v_mul_f32 v242, v242, v238
v_mul_f32 v248, v248, v238
v_cvt_pk_bf16_f32 v184, v242, v248
v_lshlrev_b32 v242, 16, v185
v_and_b32 v248, 0xffff0000, v185
v_mul_f32 v242, v242, v238
v_mul_f32 v248, v248, v238
v_cvt_pk_bf16_f32 v185, v242, v248
v_lshlrev_b32 v242, 16, v186
v_and_b32 v248, 0xffff0000, v186
v_mul_f32 v242, v242, v238
v_mul_f32 v248, v248, v238
v_cvt_pk_bf16_f32 v186, v242, v248
v_lshlrev_b32 v242, 16, v187
v_and_b32 v248, 0xffff0000, v187
v_mul_f32 v242, v242, v238
v_mul_f32 v248, v248, v238
v_cvt_pk_bf16_f32 v187, v242, v248
ds_read_b64 v[250:251], v231 offset:2048
s_waitcnt lgkmcnt(0)
v_lshlrev_b32 v242, 16, v250
v_and_b32 v248, 0xffff0000, v250
v_mul_f32 v242, v242, v238
v_mul_f32 v248, v248, v238
v_cvt_pk_bf16_f32 v250, v242, v248
v_lshlrev_b32 v242, 16, v251
v_and_b32 v248, 0xffff0000, v251
v_mul_f32 v242, v242, v238
v_mul_f32 v248, v248, v238
v_cvt_pk_bf16_f32 v251, v242, v248
ds_write_b64 v231, v[250:251] offset:2048
s_waitcnt lgkmcnt(0)
ds_read_b64 v[250:251], v231 offset:2056
s_waitcnt lgkmcnt(0)
v_lshlrev_b32 v242, 16, v250
v_and_b32 v248, 0xffff0000, v250
v_mul_f32 v242, v242, v238
v_mul_f32 v248, v248, v238
v_cvt_pk_bf16_f32 v250, v242, v248
v_lshlrev_b32 v242, 16, v251
v_and_b32 v248, 0xffff0000, v251
v_mul_f32 v242, v242, v238
v_mul_f32 v248, v248, v238
v_cvt_pk_bf16_f32 v251, v242, v248
ds_write_b64 v231, v[250:251] offset:2056
s_waitcnt lgkmcnt(0)
v_exp_f32 v232, v136
v_exp_f32 v233, v137
v_exp_f32 v234, v138
v_exp_f32 v235, v139
s_nop 1
v_cvt_pk_bf16_f32 v168, v232, v233
v_cvt_pk_bf16_f32 v169, v234, v235
v_max_f32 v204, v140, v141
v_max3_f32 v204, v204, v142, v143
v_mov_b32 v205, v204
s_nop 1
v_permlane32_swap_b32 v204, v205
s_nop 1
v_max_f32 v204, v204, v205
v_mov_b32 v205, v204
s_nop 1
v_permlane16_swap_b32 v204, v205
s_nop 1
v_max_f32 v204, v204, v205
v_add_f32 v204, 40.0, v204
v_ceil_f32 v204, v204
v_max_f32 v204, 0, v204
v_sub_f32 v205, v227, v204
v_cvt_pk_bf16_f32 v205, v205, v205
v_and_b32 v205, 0xffff0000, v205
v_sub_f32 v204, v205, v227
v_mov_b32 v227, v205
v_exp_f32 v239, v204
v_bfi_b32 v99, v206, v205, v99
v_add_f32 v140, v140, v204
v_add_f32 v141, v141, v204
v_add_f32 v142, v142, v204
v_add_f32 v143, v143, v204
v_add_f32 v156, v156, v204
v_add_f32 v157, v157, v204
v_add_f32 v158, v158, v204
v_add_f32 v159, v159, v204
v_lshlrev_b32 v242, 16, v188
v_and_b32 v248, 0xffff0000, v188
v_mul_f32 v242, v242, v239
v_mul_f32 v248, v248, v239
v_cvt_pk_bf16_f32 v188, v242, v248
v_lshlrev_b32 v242, 16, v189
v_and_b32 v248, 0xffff0000, v189
v_mul_f32 v242, v242, v239
v_mul_f32 v248, v248, v239
v_cvt_pk_bf16_f32 v189, v242, v248
v_lshlrev_b32 v242, 16, v190
v_and_b32 v248, 0xffff0000, v190
v_mul_f32 v242, v242, v239
v_mul_f32 v248, v248, v239
v_cvt_pk_bf16_f32 v190, v242, v248
v_lshlrev_b32 v242, 16, v191
v_and_b32 v248, 0xffff0000, v191
v_mul_f32 v242, v242, v239
v_mul_f32 v248, v248, v239
v_cvt_pk_bf16_f32 v191, v242, v248
ds_read_b64 v[250:251], v231 offset:3072
s_waitcnt lgkmcnt(0)
v_lshlrev_b32 v242, 16, v250
v_and_b32 v248, 0xffff0000, v250
v_mul_f32 v242, v242, v239
v_mul_f32 v248, v248, v239
v_cvt_pk_bf16_f32 v250, v242, v248
v_lshlrev_b32 v242, 16, v251
v_and_b32 v248, 0xffff0000, v251
v_mul_f32 v242, v242, v239
v_mul_f32 v248, v248, v239
v_cvt_pk_bf16_f32 v251, v242, v248
ds_write_b64 v231, v[250:251] offset:3072
s_waitcnt lgkmcnt(0)
ds_read_b64 v[250:251], v231 offset:3080
s_waitcnt lgkmcnt(0)
v_lshlrev_b32 v242, 16, v250
v_and_b32 v248, 0xffff0000, v250
v_mul_f32 v242, v242, v239
v_mul_f32 v248, v248, v239
v_cvt_pk_bf16_f32 v250, v242, v248
v_lshlrev_b32 v242, 16, v251
v_and_b32 v248, 0xffff0000, v251
v_mul_f32 v242, v242, v239
v_mul_f32 v248, v248, v239
v_cvt_pk_bf16_f32 v251, v242, v248
ds_write_b64 v231, v[250:251] offset:3080
s_waitcnt lgkmcnt(0)
v_exp_f32 v232, v140
v_exp_f32 v233, v141
v_exp_f32 v234, v142
v_exp_f32 v235, v143
s_nop 1
v_cvt_pk_bf16_f32 v172, v232, v233
v_cvt_pk_bf16_f32 v173, v234, v235
s_branch L2_rare_common
L2_rare_site13:
s_mov_b32 s36, 13
s_branch L2_rare_t0_1
L2_rare_t0_1:
s_nop 15
s_nop 15
s_waitcnt lgkmcnt(0)
v_lshrrev_b32 v206, 8, v243
v_add_u32 v206, 1, v206
v_lshrrev_b32 v206, 2, v206
v_sub_u32 v206, 0, v206
v_and_b32 v206, 0xffff0000, v206
v_max_f32 v204, v144, v145
v_max3_f32 v204, v204, v146, v147
v_mov_b32 v205, v204
s_nop 1
v_permlane32_swap_b32 v204, v205
s_nop 1
v_max_f32 v204, v204, v205
v_mov_b32 v205, v204
s_nop 1
v_permlane16_swap_b32 v204, v205
s_nop 1
v_max_f32 v204, v204, v205
v_add_f32 v204, 40.0, v204
v_ceil_f32 v204, v204
v_max_f32 v204, 0, v204
v_sub_f32 v205, v224, v204
v_cvt_pk_bf16_f32 v205, v205, v205
v_and_b32 v205, 0xffff0000, v205
v_sub_f32 v204, v205, v224
v_mov_b32 v224, v205
v_exp_f32 v236, v204
v_bfi_b32 v3, v206, v205, v3
v_add_f32 v144, v144, v204
v_add_f32 v145, v145, v204
v_add_f32 v146, v146, v204
v_add_f32 v147, v147, v204
v_add_f32 v128, v128, v204
v_add_f32 v129, v129, v204
v_add_f32 v130, v130, v204
v_add_f32 v131, v131, v204
v_lshlrev_b32 v242, 16, v160
v_and_b32 v248, 0xffff0000, v160
v_mul_f32 v242, v242, v236
v_mul_f32 v248, v248, v236
v_cvt_pk_bf16_f32 v160, v242, v248
v_lshlrev_b32 v242, 16, v161
v_and_b32 v248, 0xffff0000, v161
v_mul_f32 v242, v242, v236
v_mul_f32 v248, v248, v236
v_cvt_pk_bf16_f32 v161, v242, v248
ds_read_b64 v[250:251], v231 offset:0
s_waitcnt lgkmcnt(0)
v_lshlrev_b32 v242, 16, v250
v_and_b32 v248, 0xffff0000, v250
v_mul_f32 v242, v242, v236
v_mul_f32 v248, v248, v236
v_cvt_pk_bf16_f32 v250, v242, v248
v_lshlrev_b32 v242, 16, v251
v_and_b32 v248, 0xffff0000, v251
v_mul_f32 v242, v242, v236
v_mul_f32 v248, v248, v236
v_cvt_pk_bf16_f32 v251, v242, v248
ds_write_b64 v231, v[250:251] offset:0
s_waitcnt lgkmcnt(0)
ds_read_b64 v[250:251], v231 offset:8
s_waitcnt lgkmcnt(0)
v_lshlrev_b32 v242, 16, v250
v_and_b32 v248, 0xffff0000, v250
v_mul_f32 v242, v242, v236
v_mul_f32 v248, v248, v236
v_cvt_pk_bf16_f32 v250, v242, v248
v_lshlrev_b32 v242, 16, v251
v_and_b32 v248, 0xffff0000, v251
v_mul_f32 v242, v242, v236
v_mul_f32 v248, v248, v236
v_cvt_pk_bf16_f32 v251, v242, v248
ds_write_b64 v231, v[250:251] offset:8
s_waitcnt lgkmcnt(0)
ds_read_b64 v[250:251], v231 offset:4096
s_waitcnt lgkmcnt(0)
v_lshlrev_b32 v242, 16, v250
v_and_b32 v248, 0xffff0000, v250
v_mul_f32 v242, v242, v236
v_mul_f32 v248, v248, v236
v_cvt_pk_bf16_f32 v250, v242, v248
v_lshlrev_b32 v242, 16, v251
v_and_b32 v248, 0xffff0000, v251
v_mul_f32 v242, v242, v236
v_mul_f32 v248, v248, v236
v_cvt_pk_bf16_f32 v251, v242, v248
ds_write_b64 v231, v[250:251] offset:4096
s_waitcnt lgkmcnt(0)
ds_read_b64 v[250:251], v231 offset:4104
s_waitcnt lgkmcnt(0)
v_lshlrev_b32 v242, 16, v250
v_and_b32 v248, 0xffff0000, v250
v_mul_f32 v242, v242, v236
v_mul_f32 v248, v248, v236
v_cvt_pk_bf16_f32 v250, v242, v248
v_lshlrev_b32 v242, 16, v251
v_and_b32 v248, 0xffff0000, v251
v_mul_f32 v242, v242, v236
v_mul_f32 v248, v248, v236
v_cvt_pk_bf16_f32 v251, v242, v248
ds_write_b64 v231, v[250:251] offset:4104
s_waitcnt lgkmcnt(0)
v_exp_f32 v232, v144
v_exp_f32 v233, v145
v_exp_f32 v234, v146
v_exp_f32 v235, v147
s_nop 1
v_cvt_pk_bf16_f32 v162, v232, v233
v_cvt_pk_bf16_f32 v163, v234, v235
v_max_f32 v204, v148, v149
v_max3_f32 v204, v204, v150, v151
v_mov_b32 v205, v204
s_nop 1
v_permlane32_swap_b32 v204, v205
s_nop 1
v_max_f32 v204, v204, v205
v_mov_b32 v205, v204
s_nop 1
v_permlane16_swap_b32 v204, v205
s_nop 1
v_max_f32 v204, v204, v205
v_add_f32 v204, 40.0, v204
v_ceil_f32 v204, v204
v_max_f32 v204, 0, v204
v_sub_f32 v205, v225, v204
v_cvt_pk_bf16_f32 v205, v205, v205
v_and_b32 v205, 0xffff0000, v205
v_sub_f32 v204, v205, v225
v_mov_b32 v225, v205
v_exp_f32 v237, v204
v_bfi_b32 v35, v206, v205, v35
v_add_f32 v148, v148, v204
v_add_f32 v149, v149, v204
v_add_f32 v150, v150, v204
v_add_f32 v151, v151, v204
v_add_f32 v132, v132, v204
v_add_f32 v133, v133, v204
v_add_f32 v134, v134, v204
v_add_f32 v135, v135, v204
v_lshlrev_b32 v242, 16, v164
v_and_b32 v248, 0xffff0000, v164
v_mul_f32 v242, v242, v237
v_mul_f32 v248, v248, v237
v_cvt_pk_bf16_f32 v164, v242, v248
v_lshlrev_b32 v242, 16, v165
v_and_b32 v248, 0xffff0000, v165
v_mul_f32 v242, v242, v237
v_mul_f32 v248, v248, v237
v_cvt_pk_bf16_f32 v165, v242, v248
ds_read_b64 v[250:251], v231 offset:1024
s_waitcnt lgkmcnt(0)
v_lshlrev_b32 v242, 16, v250
v_and_b32 v248, 0xffff0000, v250
v_mul_f32 v242, v242, v237
v_mul_f32 v248, v248, v237
v_cvt_pk_bf16_f32 v250, v242, v248
v_lshlrev_b32 v242, 16, v251
v_and_b32 v248, 0xffff0000, v251
v_mul_f32 v242, v242, v237
v_mul_f32 v248, v248, v237
v_cvt_pk_bf16_f32 v251, v242, v248
ds_write_b64 v231, v[250:251] offset:1024
s_waitcnt lgkmcnt(0)
ds_read_b64 v[250:251], v231 offset:1032
s_waitcnt lgkmcnt(0)
v_lshlrev_b32 v242, 16, v250
v_and_b32 v248, 0xffff0000, v250
v_mul_f32 v242, v242, v237
v_mul_f32 v248, v248, v237
v_cvt_pk_bf16_f32 v250, v242, v248
v_lshlrev_b32 v242, 16, v251
v_and_b32 v248, 0xffff0000, v251
v_mul_f32 v242, v242, v237
v_mul_f32 v248, v248, v237
v_cvt_pk_bf16_f32 v251, v242, v248
ds_write_b64 v231, v[250:251] offset:1032
s_waitcnt lgkmcnt(0)
ds_read_b64 v[250:251], v231 offset:5120
s_waitcnt lgkmcnt(0)
v_lshlrev_b32 v242, 16, v250
v_and_b32 v248, 0xffff0000, v250
v_mul_f32 v242, v242, v237
v_mul_f32 v248, v248, v237
v_cvt_pk_bf16_f32 v250, v242, v248
v_lshlrev_b32 v242, 16, v251
v_and_b32 v248, 0xffff0000, v251
v_mul_f32 v242, v242, v237
v_mul_f32 v248, v248, v237
v_cvt_pk_bf16_f32 v251, v242, v248
ds_write_b64 v231, v[250:251] offset:5120
s_waitcnt lgkmcnt(0)
ds_read_b64 v[250:251], v231 offset:5128
s_waitcnt lgkmcnt(0)
v_lshlrev_b32 v242, 16, v250
v_and_b32 v248, 0xffff0000, v250
v_mul_f32 v242, v242, v237
v_mul_f32 v248, v248, v237
v_cvt_pk_bf16_f32 v250, v242, v248
v_lshlrev_b32 v242, 16, v251
v_and_b32 v248, 0xffff0000, v251
v_mul_f32 v242, v242, v237
v_mul_f32 v248, v248, v237
v_cvt_pk_bf16_f32 v251, v242, v248
ds_write_b64 v231, v[250:251] offset:5128
s_waitcnt lgkmcnt(0)
v_exp_f32 v232, v148
v_exp_f32 v233, v149
v_exp_f32 v234, v150
v_exp_f32 v235, v151
s_nop 1
v_cvt_pk_bf16_f32 v166, v232, v233
v_cvt_pk_bf16_f32 v167, v234, v235
v_max_f32 v204, v152, v153
v_max3_f32 v204, v204, v154, v155
v_mov_b32 v205, v204
s_nop 1
v_permlane32_swap_b32 v204, v205
s_nop 1
v_max_f32 v204, v204, v205
v_mov_b32 v205, v204
s_nop 1
v_permlane16_swap_b32 v204, v205
s_nop 1
v_max_f32 v204, v204, v205
v_add_f32 v204, 40.0, v204
v_ceil_f32 v204, v204
v_max_f32 v204, 0, v204
v_sub_f32 v205, v226, v204
v_cvt_pk_bf16_f32 v205, v205, v205
v_and_b32 v205, 0xffff0000, v205
v_sub_f32 v204, v205, v226
v_mov_b32 v226, v205
v_exp_f32 v238, v204
v_bfi_b32 v67, v206, v205, v67
v_add_f32 v152, v152, v204
v_add_f32 v153, v153, v204
v_add_f32 v154, v154, v204
v_add_f32 v155, v155, v204
v_add_f32 v136, v136, v204
v_add_f32 v137, v137, v204
v_add_f32 v138, v138, v204
v_add_f32 v139, v139, v204
v_lshlrev_b32 v242, 16, v168
v_and_b32 v248, 0xffff0000, v168
v_mul_f32 v242, v242, v238
v_mul_f32 v248, v248, v238
v_cvt_pk_bf16_f32 v168, v242, v248
v_lshlrev_b32 v242, 16, v169
v_and_b32 v248, 0xffff0000, v169
v_mul_f32 v242, v242, v238
v_mul_f32 v248, v248, v238
v_cvt_pk_bf16_f32 v169, v242, v248
ds_read_b64 v[250:251], v231 offset:2048
s_waitcnt lgkmcnt(0)
v_lshlrev_b32 v242, 16, v250
v_and_b32 v248, 0xffff0000, v250
v_mul_f32 v242, v242, v238
v_mul_f32 v248, v248, v238
v_cvt_pk_bf16_f32 v250, v242, v248
v_lshlrev_b32 v242, 16, v251
v_and_b32 v248, 0xffff0000, v251
v_mul_f32 v242, v242, v238
v_mul_f32 v248, v248, v238
v_cvt_pk_bf16_f32 v251, v242, v248
ds_write_b64 v231, v[250:251] offset:2048
s_waitcnt lgkmcnt(0)
ds_read_b64 v[250:251], v231 offset:2056
s_waitcnt lgkmcnt(0)
v_lshlrev_b32 v242, 16, v250
v_and_b32 v248, 0xffff0000, v250
v_mul_f32 v242, v242, v238
v_mul_f32 v248, v248, v238
v_cvt_pk_bf16_f32 v250, v242, v248
v_lshlrev_b32 v242, 16, v251
v_and_b32 v248, 0xffff0000, v251
v_mul_f32 v242, v242, v238
v_mul_f32 v248, v248, v238
v_cvt_pk_bf16_f32 v251, v242, v248
ds_write_b64 v231, v[250:251] offset:2056
s_waitcnt lgkmcnt(0)
ds_read_b64 v[250:251], v231 offset:6144
s_waitcnt lgkmcnt(0)
v_lshlrev_b32 v242, 16, v250
v_and_b32 v248, 0xffff0000, v250
v_mul_f32 v242, v242, v238
v_mul_f32 v248, v248, v238
v_cvt_pk_bf16_f32 v250, v242, v248
v_lshlrev_b32 v242, 16, v251
v_and_b32 v248, 0xffff0000, v251
v_mul_f32 v242, v242, v238
v_mul_f32 v248, v248, v238
v_cvt_pk_bf16_f32 v251, v242, v248
ds_write_b64 v231, v[250:251] offset:6144
s_waitcnt lgkmcnt(0)
ds_read_b64 v[250:251], v231 offset:6152
s_waitcnt lgkmcnt(0)
v_lshlrev_b32 v242, 16, v250
v_and_b32 v248, 0xffff0000, v250
v_mul_f32 v242, v242, v238
v_mul_f32 v248, v248, v238
v_cvt_pk_bf16_f32 v250, v242, v248
v_lshlrev_b32 v242, 16, v251
v_and_b32 v248, 0xffff0000, v251
v_mul_f32 v242, v242, v238
v_mul_f32 v248, v248, v238
v_cvt_pk_bf16_f32 v251, v242, v248
ds_write_b64 v231, v[250:251] offset:6152
s_waitcnt lgkmcnt(0)
v_exp_f32 v232, v152
v_exp_f32 v233, v153
v_exp_f32 v234, v154
v_exp_f32 v235, v155
s_nop 1
v_cvt_pk_bf16_f32 v170, v232, v233
v_cvt_pk_bf16_f32 v171, v234, v235
v_max_f32 v204, v156, v157
v_max3_f32 v204, v204, v158, v159
v_mov_b32 v205, v204
s_nop 1
v_permlane32_swap_b32 v204, v205
s_nop 1
v_max_f32 v204, v204, v205
v_mov_b32 v205, v204
s_nop 1
v_permlane16_swap_b32 v204, v205
s_nop 1
v_max_f32 v204, v204, v205
v_add_f32 v204, 40.0, v204
v_ceil_f32 v204, v204
v_max_f32 v204, 0, v204
v_sub_f32 v205, v227, v204
v_cvt_pk_bf16_f32 v205, v205, v205
v_and_b32 v205, 0xffff0000, v205
v_sub_f32 v204, v205, v227
v_mov_b32 v227, v205
v_exp_f32 v239, v204
v_bfi_b32 v99, v206, v205, v99
v_add_f32 v156, v156, v204
v_add_f32 v157, v157, v204
v_add_f32 v158, v158, v204
v_add_f32 v159, v159, v204
v_add_f32 v140, v140, v204
v_add_f32 v141, v141, v204
v_add_f32 v142, v142, v204
v_add_f32 v143, v143, v204
v_lshlrev_b32 v242, 16, v172
v_and_b32 v248, 0xffff0000, v172
v_mul_f32 v242, v242, v239
v_mul_f32 v248, v248, v239
v_cvt_pk_bf16_f32 v172, v242, v248
v_lshlrev_b32 v242, 16, v173
v_and_b32 v248, 0xffff0000, v173
v_mul_f32 v242, v242, v239
v_mul_f32 v248, v248, v239
v_cvt_pk_bf16_f32 v173, v242, v248
ds_read_b64 v[250:251], v231 offset:3072
s_waitcnt lgkmcnt(0)
v_lshlrev_b32 v242, 16, v250
v_and_b32 v248, 0xffff0000, v250
v_mul_f32 v242, v242, v239
v_mul_f32 v248, v248, v239
v_cvt_pk_bf16_f32 v250, v242, v248
v_lshlrev_b32 v242, 16, v251
v_and_b32 v248, 0xffff0000, v251
v_mul_f32 v242, v242, v239
v_mul_f32 v248, v248, v239
v_cvt_pk_bf16_f32 v251, v242, v248
ds_write_b64 v231, v[250:251] offset:3072
s_waitcnt lgkmcnt(0)
ds_read_b64 v[250:251], v231 offset:3080
s_waitcnt lgkmcnt(0)
v_lshlrev_b32 v242, 16, v250
v_and_b32 v248, 0xffff0000, v250
v_mul_f32 v242, v242, v239
v_mul_f32 v248, v248, v239
v_cvt_pk_bf16_f32 v250, v242, v248
v_lshlrev_b32 v242, 16, v251
v_and_b32 v248, 0xffff0000, v251
v_mul_f32 v242, v242, v239
v_mul_f32 v248, v248, v239
v_cvt_pk_bf16_f32 v251, v242, v248
ds_write_b64 v231, v[250:251] offset:3080
s_waitcnt lgkmcnt(0)
ds_read_b64 v[250:251], v231 offset:7168
s_waitcnt lgkmcnt(0)
v_lshlrev_b32 v242, 16, v250
v_and_b32 v248, 0xffff0000, v250
v_mul_f32 v242, v242, v239
v_mul_f32 v248, v248, v239
v_cvt_pk_bf16_f32 v250, v242, v248
v_lshlrev_b32 v242, 16, v251
v_and_b32 v248, 0xffff0000, v251
v_mul_f32 v242, v242, v239
v_mul_f32 v248, v248, v239
v_cvt_pk_bf16_f32 v251, v242, v248
ds_write_b64 v231, v[250:251] offset:7168
s_waitcnt lgkmcnt(0)
ds_read_b64 v[250:251], v231 offset:7176
s_waitcnt lgkmcnt(0)
v_lshlrev_b32 v242, 16, v250
v_and_b32 v248, 0xffff0000, v250
v_mul_f32 v242, v242, v239
v_mul_f32 v248, v248, v239
v_cvt_pk_bf16_f32 v250, v242, v248
v_lshlrev_b32 v242, 16, v251
v_and_b32 v248, 0xffff0000, v251
v_mul_f32 v242, v242, v239
v_mul_f32 v248, v248, v239
v_cvt_pk_bf16_f32 v251, v242, v248
ds_write_b64 v231, v[250:251] offset:7176
s_waitcnt lgkmcnt(0)
v_exp_f32 v232, v156
v_exp_f32 v233, v157
v_exp_f32 v234, v158
v_exp_f32 v235, v159
s_nop 1
v_cvt_pk_bf16_f32 v174, v232, v233
v_cvt_pk_bf16_f32 v175, v234, v235
s_branch L2_rare_common
L2_rare_site14:
s_mov_b32 s36, 14
s_branch L2_rare_t0_2
L2_rare_t0_2:
s_nop 15
s_nop 15
s_waitcnt lgkmcnt(0)
v_lshrrev_b32 v206, 8, v243
v_add_u32 v206, 1, v206
v_lshrrev_b32 v206, 2, v206
v_sub_u32 v206, 0, v206
v_and_b32 v206, 0xffff0000, v206
v_max_f32 v204, v128, v129
v_max3_f32 v204, v204, v130, v131
v_mov_b32 v205, v204
s_nop 1
v_permlane32_swap_b32 v204, v205
s_nop 1
v_max_f32 v204, v204, v205
v_mov_b32 v205, v204
s_nop 1
v_permlane16_swap_b32 v204, v205
s_nop 1
v_max_f32 v204, v204, v205
v_add_f32 v204, 40.0, v204
v_ceil_f32 v204, v204
v_max_f32 v204, 0, v204
v_sub_f32 v205, v224, v204
v_cvt_pk_bf16_f32 v205, v205, v205
v_and_b32 v205, 0xffff0000, v205
v_sub_f32 v204, v205, v224
v_mov_b32 v224, v205
v_exp_f32 v236, v204
v_bfi_b32 v3, v206, v205, v3
v_add_f32 v128, v128, v204
v_add_f32 v129, v129, v204
v_add_f32 v130, v130, v204
v_add_f32 v131, v131, v204
v_add_f32 v144, v144, v204
v_add_f32 v145, v145, v204
v_add_f32 v146, v146, v204
v_add_f32 v147, v147, v204
v_lshlrev_b32 v242, 16, v160
v_and_b32 v248, 0xffff0000, v160
v_mul_f32 v242, v242, v236
v_mul_f32 v248, v248, v236
v_cvt_pk_bf16_f32 v160, v242, v248
v_lshlrev_b32 v242, 16, v161
v_and_b32 v248, 0xffff0000, v161
v_mul_f32 v242, v242, v236
v_mul_f32 v248, v248, v236
v_cvt_pk_bf16_f32 v161, v242, v248
v_lshlrev_b32 v242, 16, v162
v_and_b32 v248, 0xffff0000, v162
v_mul_f32 v242, v242, v236
v_mul_f32 v248, v248, v236
v_cvt_pk_bf16_f32 v162, v242, v248
v_lshlrev_b32 v242, 16, v163
v_and_b32 v248, 0xffff0000, v163
v_mul_f32 v242, v242, v236
v_mul_f32 v248, v248, v236
v_cvt_pk_bf16_f32 v163, v242, v248
ds_read_b64 v[250:251], v231 offset:0
s_waitcnt lgkmcnt(0)
v_lshlrev_b32 v242, 16, v250
v_and_b32 v248, 0xffff0000, v250
v_mul_f32 v242, v242, v236
v_mul_f32 v248, v248, v236
v_cvt_pk_bf16_f32 v250, v242, v248
v_lshlrev_b32 v242, 16, v251
v_and_b32 v248, 0xffff0000, v251
v_mul_f32 v242, v242, v236
v_mul_f32 v248, v248, v236
v_cvt_pk_bf16_f32 v251, v242, v248
ds_write_b64 v231, v[250:251] offset:0
s_waitcnt lgkmcnt(0)
ds_read_b64 v[250:251], v231 offset:8
s_waitcnt lgkmcnt(0)
v_lshlrev_b32 v242, 16, v250
v_and_b32 v248, 0xffff0000, v250
v_mul_f32 v242, v242, v236
v_mul_f32 v248, v248, v236
v_cvt_pk_bf16_f32 v250, v242, v248
v_lshlrev_b32 v242, 16, v251
v_and_b32 v248, 0xffff0000, v251
v_mul_f32 v242, v242, v236
v_mul_f32 v248, v248, v236
v_cvt_pk_bf16_f32 v251, v242, v248
ds_write_b64 v231, v[250:251] offset:8
s_waitcnt lgkmcnt(0)
ds_read_b64 v[250:251], v231 offset:4096
s_waitcnt lgkmcnt(0)
v_lshlrev_b32 v242, 16, v250
v_and_b32 v248, 0xffff0000, v250
v_mul_f32 v242, v242, v236
v_mul_f32 v248, v248, v236
v_cvt_pk_bf16_f32 v250, v242, v248
v_lshlrev_b32 v242, 16, v251
v_and_b32 v248, 0xffff0000, v251
v_mul_f32 v242, v242, v236
v_mul_f32 v248, v248, v236
v_cvt_pk_bf16_f32 v251, v242, v248
ds_write_b64 v231, v[250:251] offset:4096
s_waitcnt lgkmcnt(0)
ds_read_b64 v[250:251], v231 offset:4104
s_waitcnt lgkmcnt(0)
v_lshlrev_b32 v242, 16, v250
v_and_b32 v248, 0xffff0000, v250
v_mul_f32 v242, v242, v236
v_mul_f32 v248, v248, v236
v_cvt_pk_bf16_f32 v250, v242, v248
v_lshlrev_b32 v242, 16, v251
v_and_b32 v248, 0xffff0000, v251
v_mul_f32 v242, v242, v236
v_mul_f32 v248, v248, v236
v_cvt_pk_bf16_f32 v251, v242, v248
ds_write_b64 v231, v[250:251] offset:4104
s_waitcnt lgkmcnt(0)
v_exp_f32 v232, v128
v_exp_f32 v233, v129
v_exp_f32 v234, v130
v_exp_f32 v235, v131
s_nop 1
v_cvt_pk_bf16_f32 v176, v232, v233
v_cvt_pk_bf16_f32 v177, v234, v235
v_max_f32 v204, v132, v133
v_max3_f32 v204, v204, v134, v135
v_mov_b32 v205, v204
s_nop 1
v_permlane32_swap_b32 v204, v205
s_nop 1
v_max_f32 v204, v204, v205
v_mov_b32 v205, v204
s_nop 1
v_permlane16_swap_b32 v204, v205
s_nop 1
v_max_f32 v204, v204, v205
v_add_f32 v204, 40.0, v204
v_ceil_f32 v204, v204
v_max_f32 v204, 0, v204
v_sub_f32 v205, v225, v204
v_cvt_pk_bf16_f32 v205, v205, v205
v_and_b32 v205, 0xffff0000, v205
v_sub_f32 v204, v205, v225
v_mov_b32 v225, v205
v_exp_f32 v237, v204
v_bfi_b32 v35, v206, v205, v35
v_add_f32 v132, v132, v204
v_add_f32 v133, v133, v204
v_add_f32 v134, v134, v204
v_add_f32 v135, v135, v204
v_add_f32 v148, v148, v204
v_add_f32 v149, v149, v204
v_add_f32 v150, v150, v204
v_add_f32 v151, v151, v204
v_lshlrev_b32 v242, 16, v164
v_and_b32 v248, 0xffff0000, v164
v_mul_f32 v242, v242, v237
v_mul_f32 v248, v248, v237
v_cvt_pk_bf16_f32 v164, v242, v248
v_lshlrev_b32 v242, 16, v165
v_and_b32 v248, 0xffff0000, v165
v_mul_f32 v242, v242, v237
v_mul_f32 v248, v248, v237
v_cvt_pk_bf16_f32 v165, v242, v248
v_lshlrev_b32 v242, 16, v166
v_and_b32 v248, 0xffff0000, v166
v_mul_f32 v242, v242, v237
v_mul_f32 v248, v248, v237
v_cvt_pk_bf16_f32 v166, v242, v248
v_lshlrev_b32 v242, 16, v167
v_and_b32 v248, 0xffff0000, v167
v_mul_f32 v242, v242, v237
v_mul_f32 v248, v248, v237
v_cvt_pk_bf16_f32 v167, v242, v248
ds_read_b64 v[250:251], v231 offset:1024
s_waitcnt lgkmcnt(0)
v_lshlrev_b32 v242, 16, v250
v_and_b32 v248, 0xffff0000, v250
v_mul_f32 v242, v242, v237
v_mul_f32 v248, v248, v237
v_cvt_pk_bf16_f32 v250, v242, v248
v_lshlrev_b32 v242, 16, v251
v_and_b32 v248, 0xffff0000, v251
v_mul_f32 v242, v242, v237
v_mul_f32 v248, v248, v237
v_cvt_pk_bf16_f32 v251, v242, v248
ds_write_b64 v231, v[250:251] offset:1024
s_waitcnt lgkmcnt(0)
ds_read_b64 v[250:251], v231 offset:1032
s_waitcnt lgkmcnt(0)
v_lshlrev_b32 v242, 16, v250
v_and_b32 v248, 0xffff0000, v250
v_mul_f32 v242, v242, v237
v_mul_f32 v248, v248, v237
v_cvt_pk_bf16_f32 v250, v242, v248
v_lshlrev_b32 v242, 16, v251
v_and_b32 v248, 0xffff0000, v251
v_mul_f32 v242, v242, v237
v_mul_f32 v248, v248, v237
v_cvt_pk_bf16_f32 v251, v242, v248
ds_write_b64 v231, v[250:251] offset:1032
s_waitcnt lgkmcnt(0)
ds_read_b64 v[250:251], v231 offset:5120
s_waitcnt lgkmcnt(0)
v_lshlrev_b32 v242, 16, v250
v_and_b32 v248, 0xffff0000, v250
v_mul_f32 v242, v242, v237
v_mul_f32 v248, v248, v237
v_cvt_pk_bf16_f32 v250, v242, v248
v_lshlrev_b32 v242, 16, v251
v_and_b32 v248, 0xffff0000, v251
v_mul_f32 v242, v242, v237
v_mul_f32 v248, v248, v237
v_cvt_pk_bf16_f32 v251, v242, v248
ds_write_b64 v231, v[250:251] offset:5120
s_waitcnt lgkmcnt(0)
ds_read_b64 v[250:251], v231 offset:5128
s_waitcnt lgkmcnt(0)
v_lshlrev_b32 v242, 16, v250
v_and_b32 v248, 0xffff0000, v250
v_mul_f32 v242, v242, v237
v_mul_f32 v248, v248, v237
v_cvt_pk_bf16_f32 v250, v242, v248
v_lshlrev_b32 v242, 16, v251
v_and_b32 v248, 0xffff0000, v251
v_mul_f32 v242, v242, v237
v_mul_f32 v248, v248, v237
v_cvt_pk_bf16_f32 v251, v242, v248
ds_write_b64 v231, v[250:251] offset:5128
s_waitcnt lgkmcnt(0)
v_exp_f32 v232, v132
v_exp_f32 v233, v133
v_exp_f32 v234, v134
v_exp_f32 v235, v135
s_nop 1
v_cvt_pk_bf16_f32 v180, v232, v233
v_cvt_pk_bf16_f32 v181, v234, v235
v_max_f32 v204, v136, v137
v_max3_f32 v204, v204, v138, v139
v_mov_b32 v205, v204
s_nop 1
v_permlane32_swap_b32 v204, v205
s_nop 1
v_max_f32 v204, v204, v205
v_mov_b32 v205, v204
s_nop 1
v_permlane16_swap_b32 v204, v205
s_nop 1
v_max_f32 v204, v204, v205
v_add_f32 v204, 40.0, v204
v_ceil_f32 v204, v204
v_max_f32 v204, 0, v204
v_sub_f32 v205, v226, v204
v_cvt_pk_bf16_f32 v205, v205, v205
v_and_b32 v205, 0xffff0000, v205
v_sub_f32 v204, v205, v226
v_mov_b32 v226, v205
v_exp_f32 v238, v204
v_bfi_b32 v67, v206, v205, v67
v_add_f32 v136, v136, v204
v_add_f32 v137, v137, v204
v_add_f32 v138, v138, v204
v_add_f32 v139, v139, v204
v_add_f32 v152, v152, v204
v_add_f32 v153, v153, v204
v_add_f32 v154, v154, v204
v_add_f32 v155, v155, v204
v_lshlrev_b32 v242, 16, v168
v_and_b32 v248, 0xffff0000, v168
v_mul_f32 v242, v242, v238
v_mul_f32 v248, v248, v238
v_cvt_pk_bf16_f32 v168, v242, v248
v_lshlrev_b32 v242, 16, v169
v_and_b32 v248, 0xffff0000, v169
v_mul_f32 v242, v242, v238
v_mul_f32 v248, v248, v238
v_cvt_pk_bf16_f32 v169, v242, v248
v_lshlrev_b32 v242, 16, v170
v_and_b32 v248, 0xffff0000, v170
v_mul_f32 v242, v242, v238
v_mul_f32 v248, v248, v238
v_cvt_pk_bf16_f32 v170, v242, v248
v_lshlrev_b32 v242, 16, v171
v_and_b32 v248, 0xffff0000, v171
v_mul_f32 v242, v242, v238
v_mul_f32 v248, v248, v238
v_cvt_pk_bf16_f32 v171, v242, v248
ds_read_b64 v[250:251], v231 offset:2048
s_waitcnt lgkmcnt(0)
v_lshlrev_b32 v242, 16, v250
v_and_b32 v248, 0xffff0000, v250
v_mul_f32 v242, v242, v238
v_mul_f32 v248, v248, v238
v_cvt_pk_bf16_f32 v250, v242, v248
v_lshlrev_b32 v242, 16, v251
v_and_b32 v248, 0xffff0000, v251
v_mul_f32 v242, v242, v238
v_mul_f32 v248, v248, v238
v_cvt_pk_bf16_f32 v251, v242, v248
ds_write_b64 v231, v[250:251] offset:2048
s_waitcnt lgkmcnt(0)
ds_read_b64 v[250:251], v231 offset:2056
s_waitcnt lgkmcnt(0)
v_lshlrev_b32 v242, 16, v250
v_and_b32 v248, 0xffff0000, v250
v_mul_f32 v242, v242, v238
v_mul_f32 v248, v248, v238
v_cvt_pk_bf16_f32 v250, v242, v248
v_lshlrev_b32 v242, 16, v251
v_and_b32 v248, 0xffff0000, v251
v_mul_f32 v242, v242, v238
v_mul_f32 v248, v248, v238
v_cvt_pk_bf16_f32 v251, v242, v248
ds_write_b64 v231, v[250:251] offset:2056
s_waitcnt lgkmcnt(0)
ds_read_b64 v[250:251], v231 offset:6144
s_waitcnt lgkmcnt(0)
v_lshlrev_b32 v242, 16, v250
v_and_b32 v248, 0xffff0000, v250
v_mul_f32 v242, v242, v238
v_mul_f32 v248, v248, v238
v_cvt_pk_bf16_f32 v250, v242, v248
v_lshlrev_b32 v242, 16, v251
v_and_b32 v248, 0xffff0000, v251
v_mul_f32 v242, v242, v238
v_mul_f32 v248, v248, v238
v_cvt_pk_bf16_f32 v251, v242, v248
ds_write_b64 v231, v[250:251] offset:6144
s_waitcnt lgkmcnt(0)
ds_read_b64 v[250:251], v231 offset:6152
s_waitcnt lgkmcnt(0)
v_lshlrev_b32 v242, 16, v250
v_and_b32 v248, 0xffff0000, v250
v_mul_f32 v242, v242, v238
v_mul_f32 v248, v248, v238
v_cvt_pk_bf16_f32 v250, v242, v248
v_lshlrev_b32 v242, 16, v251
v_and_b32 v248, 0xffff0000, v251
v_mul_f32 v242, v242, v238
v_mul_f32 v248, v248, v238
v_cvt_pk_bf16_f32 v251, v242, v248
ds_write_b64 v231, v[250:251] offset:6152
s_waitcnt lgkmcnt(0)
v_exp_f32 v232, v136
v_exp_f32 v233, v137
v_exp_f32 v234, v138
v_exp_f32 v235, v139
s_nop 1
v_cvt_pk_bf16_f32 v184, v232, v233
v_cvt_pk_bf16_f32 v185, v234, v235
v_max_f32 v204, v140, v141
v_max3_f32 v204, v204, v142, v143
v_mov_b32 v205, v204
s_nop 1
v_permlane32_swap_b32 v204, v205
s_nop 1
v_max_f32 v204, v204, v205
v_mov_b32 v205, v204
s_nop 1
v_permlane16_swap_b32 v204, v205
s_nop 1
v_max_f32 v204, v204, v205
v_add_f32 v204, 40.0, v204
v_ceil_f32 v204, v204
v_max_f32 v204, 0, v204
v_sub_f32 v205, v227, v204
v_cvt_pk_bf16_f32 v205, v205, v205
v_and_b32 v205, 0xffff0000, v205
v_sub_f32 v204, v205, v227
v_mov_b32 v227, v205
v_exp_f32 v239, v204
v_bfi_b32 v99, v206, v205, v99
v_add_f32 v140, v140, v204
v_add_f32 v141, v141, v204
v_add_f32 v142, v142, v204
v_add_f32 v143, v143, v204
v_add_f32 v156, v156, v204
v_add_f32 v157, v157, v204
v_add_f32 v158, v158, v204
v_add_f32 v159, v159, v204
v_lshlrev_b32 v242, 16, v172
v_and_b32 v248, 0xffff0000, v172
v_mul_f32 v242, v242, v239
v_mul_f32 v248, v248, v239
v_cvt_pk_bf16_f32 v172, v242, v248
v_lshlrev_b32 v242, 16, v173
v_and_b32 v248, 0xffff0000, v173
v_mul_f32 v242, v242, v239
v_mul_f32 v248, v248, v239
v_cvt_pk_bf16_f32 v173, v242, v248
v_lshlrev_b32 v242, 16, v174
v_and_b32 v248, 0xffff0000, v174
v_mul_f32 v242, v242, v239
v_mul_f32 v248, v248, v239
v_cvt_pk_bf16_f32 v174, v242, v248
v_lshlrev_b32 v242, 16, v175
v_and_b32 v248, 0xffff0000, v175
v_mul_f32 v242, v242, v239
v_mul_f32 v248, v248, v239
v_cvt_pk_bf16_f32 v175, v242, v248
ds_read_b64 v[250:251], v231 offset:3072
s_waitcnt lgkmcnt(0)
v_lshlrev_b32 v242, 16, v250
v_and_b32 v248, 0xffff0000, v250
v_mul_f32 v242, v242, v239
v_mul_f32 v248, v248, v239
v_cvt_pk_bf16_f32 v250, v242, v248
v_lshlrev_b32 v242, 16, v251
v_and_b32 v248, 0xffff0000, v251
v_mul_f32 v242, v242, v239
v_mul_f32 v248, v248, v239
v_cvt_pk_bf16_f32 v251, v242, v248
ds_write_b64 v231, v[250:251] offset:3072
s_waitcnt lgkmcnt(0)
ds_read_b64 v[250:251], v231 offset:3080
s_waitcnt lgkmcnt(0)
v_lshlrev_b32 v242, 16, v250
v_and_b32 v248, 0xffff0000, v250
v_mul_f32 v242, v242, v239
v_mul_f32 v248, v248, v239
v_cvt_pk_bf16_f32 v250, v242, v248
v_lshlrev_b32 v242, 16, v251
v_and_b32 v248, 0xffff0000, v251
v_mul_f32 v242, v242, v239
v_mul_f32 v248, v248, v239
v_cvt_pk_bf16_f32 v251, v242, v248
ds_write_b64 v231, v[250:251] offset:3080
s_waitcnt lgkmcnt(0)
ds_read_b64 v[250:251], v231 offset:7168
s_waitcnt lgkmcnt(0)
v_lshlrev_b32 v242, 16, v250
v_and_b32 v248, 0xffff0000, v250
v_mul_f32 v242, v242, v239
v_mul_f32 v248, v248, v239
v_cvt_pk_bf16_f32 v250, v242, v248
v_lshlrev_b32 v242, 16, v251
v_and_b32 v248, 0xffff0000, v251
v_mul_f32 v242, v242, v239
v_mul_f32 v248, v248, v239
v_cvt_pk_bf16_f32 v251, v242, v248
ds_write_b64 v231, v[250:251] offset:7168
s_waitcnt lgkmcnt(0)
ds_read_b64 v[250:251], v231 offset:7176
s_waitcnt lgkmcnt(0)
v_lshlrev_b32 v242, 16, v250
v_and_b32 v248, 0xffff0000, v250
v_mul_f32 v242, v242, v239
v_mul_f32 v248, v248, v239
v_cvt_pk_bf16_f32 v250, v242, v248
v_lshlrev_b32 v242, 16, v251
v_and_b32 v248, 0xffff0000, v251
v_mul_f32 v242, v242, v239
v_mul_f32 v248, v248, v239
v_cvt_pk_bf16_f32 v251, v242, v248
ds_write_b64 v231, v[250:251] offset:7176
s_waitcnt lgkmcnt(0)
v_exp_f32 v232, v140
v_exp_f32 v233, v141
v_exp_f32 v234, v142
v_exp_f32 v235, v143
s_nop 1
v_cvt_pk_bf16_f32 v188, v232, v233
v_cvt_pk_bf16_f32 v189, v234, v235
s_branch L2_rare_common
L2_rare_site15:
s_mov_b32 s36, 15
s_branch L2_rare_t0_3
L2_rare_t0_3:
s_nop 15
s_nop 15
s_waitcnt lgkmcnt(0)
v_lshrrev_b32 v206, 8, v243
v_add_u32 v206, 1, v206
v_lshrrev_b32 v206, 2, v206
v_sub_u32 v206, 0, v206
v_and_b32 v206, 0xffff0000, v206
v_max_f32 v204, v144, v145
v_max3_f32 v204, v204, v146, v147
v_mov_b32 v205, v204
s_nop 1
v_permlane32_swap_b32 v204, v205
s_nop 1
v_max_f32 v204, v204, v205
v_mov_b32 v205, v204
s_nop 1
v_permlane16_swap_b32 v204, v205
s_nop 1
v_max_f32 v204, v204, v205
v_add_f32 v204, 40.0, v204
v_ceil_f32 v204, v204
v_max_f32 v204, 0, v204
v_sub_f32 v205, v224, v204
v_cvt_pk_bf16_f32 v205, v205, v205
v_and_b32 v205, 0xffff0000, v205
v_sub_f32 v204, v205, v224
v_mov_b32 v224, v205
v_exp_f32 v236, v204
v_bfi_b32 v3, v206, v205, v3
v_add_f32 v144, v144, v204
v_add_f32 v145, v145, v204
v_add_f32 v146, v146, v204
v_add_f32 v147, v147, v204
v_add_f32 v128, v128, v204
v_add_f32 v129, v129, v204
v_add_f32 v130, v130, v204
v_add_f32 v131, v131, v204
v_lshlrev_b32 v242, 16, v160
v_and_b32 v248, 0xffff0000, v160
v_mul_f32 v242, v242, v236
v_mul_f32 v248, v248, v236
v_cvt_pk_bf16_f32 v160, v242, v248
v_lshlrev_b32 v242, 16, v161
v_and_b32 v248, 0xffff0000, v161
v_mul_f32 v242, v242, v236
v_mul_f32 v248, v248, v236
v_cvt_pk_bf16_f32 v161, v242, v248
v_lshlrev_b32 v242, 16, v162
v_and_b32 v248, 0xffff0000, v162
v_mul_f32 v242, v242, v236
v_mul_f32 v248, v248, v236
v_cvt_pk_bf16_f32 v162, v242, v248
v_lshlrev_b32 v242, 16, v163
v_and_b32 v248, 0xffff0000, v163
v_mul_f32 v242, v242, v236
v_mul_f32 v248, v248, v236
v_cvt_pk_bf16_f32 v163, v242, v248
v_lshlrev_b32 v242, 16, v176
v_and_b32 v248, 0xffff0000, v176
v_mul_f32 v242, v242, v236
v_mul_f32 v248, v248, v236
v_cvt_pk_bf16_f32 v176, v242, v248
v_lshlrev_b32 v242, 16, v177
v_and_b32 v248, 0xffff0000, v177
v_mul_f32 v242, v242, v236
v_mul_f32 v248, v248, v236
v_cvt_pk_bf16_f32 v177, v242, v248
ds_read_b64 v[250:251], v231 offset:0
s_waitcnt lgkmcnt(0)
v_lshlrev_b32 v242, 16, v250
v_and_b32 v248, 0xffff0000, v250
v_mul_f32 v242, v242, v236
v_mul_f32 v248, v248, v236
v_cvt_pk_bf16_f32 v250, v242, v248
v_lshlrev_b32 v242, 16, v251
v_and_b32 v248, 0xffff0000, v251
v_mul_f32 v242, v242, v236
v_mul_f32 v248, v248, v236
v_cvt_pk_bf16_f32 v251, v242, v248
ds_write_b64 v231, v[250:251] offset:0
s_waitcnt lgkmcnt(0)
ds_read_b64 v[250:251], v231 offset:8
s_waitcnt lgkmcnt(0)
v_lshlrev_b32 v242, 16, v250
v_and_b32 v248, 0xffff0000, v250
v_mul_f32 v242, v242, v236
v_mul_f32 v248, v248, v236
v_cvt_pk_bf16_f32 v250, v242, v248
v_lshlrev_b32 v242, 16, v251
v_and_b32 v248, 0xffff0000, v251
v_mul_f32 v242, v242, v236
v_mul_f32 v248, v248, v236
v_cvt_pk_bf16_f32 v251, v242, v248
ds_write_b64 v231, v[250:251] offset:8
s_waitcnt lgkmcnt(0)
ds_read_b64 v[250:251], v231 offset:4096
s_waitcnt lgkmcnt(0)
v_lshlrev_b32 v242, 16, v250
v_and_b32 v248, 0xffff0000, v250
v_mul_f32 v242, v242, v236
v_mul_f32 v248, v248, v236
v_cvt_pk_bf16_f32 v250, v242, v248
v_lshlrev_b32 v242, 16, v251
v_and_b32 v248, 0xffff0000, v251
v_mul_f32 v242, v242, v236
v_mul_f32 v248, v248, v236
v_cvt_pk_bf16_f32 v251, v242, v248
ds_write_b64 v231, v[250:251] offset:4096
s_waitcnt lgkmcnt(0)
ds_read_b64 v[250:251], v231 offset:4104
s_waitcnt lgkmcnt(0)
v_lshlrev_b32 v242, 16, v250
v_and_b32 v248, 0xffff0000, v250
v_mul_f32 v242, v242, v236
v_mul_f32 v248, v248, v236
v_cvt_pk_bf16_f32 v250, v242, v248
v_lshlrev_b32 v242, 16, v251
v_and_b32 v248, 0xffff0000, v251
v_mul_f32 v242, v242, v236
v_mul_f32 v248, v248, v236
v_cvt_pk_bf16_f32 v251, v242, v248
ds_write_b64 v231, v[250:251] offset:4104
s_waitcnt lgkmcnt(0)
v_exp_f32 v232, v144
v_exp_f32 v233, v145
v_exp_f32 v234, v146
v_exp_f32 v235, v147
s_nop 1
v_cvt_pk_bf16_f32 v178, v232, v233
v_cvt_pk_bf16_f32 v179, v234, v235
v_max_f32 v204, v148, v149
v_max3_f32 v204, v204, v150, v151
v_mov_b32 v205, v204
s_nop 1
v_permlane32_swap_b32 v204, v205
s_nop 1
v_max_f32 v204, v204, v205
v_mov_b32 v205, v204
s_nop 1
v_permlane16_swap_b32 v204, v205
s_nop 1
v_max_f32 v204, v204, v205
v_add_f32 v204, 40.0, v204
v_ceil_f32 v204, v204
v_max_f32 v204, 0, v204
v_sub_f32 v205, v225, v204
v_cvt_pk_bf16_f32 v205, v205, v205
v_and_b32 v205, 0xffff0000, v205
v_sub_f32 v204, v205, v225
v_mov_b32 v225, v205
v_exp_f32 v237, v204
v_bfi_b32 v35, v206, v205, v35
v_add_f32 v148, v148, v204
v_add_f32 v149, v149, v204
v_add_f32 v150, v150, v204
v_add_f32 v151, v151, v204
v_add_f32 v132, v132, v204
v_add_f32 v133, v133, v204
v_add_f32 v134, v134, v204
v_add_f32 v135, v135, v204
v_lshlrev_b32 v242, 16, v164
v_and_b32 v248, 0xffff0000, v164
v_mul_f32 v242, v242, v237
v_mul_f32 v248, v248, v237
v_cvt_pk_bf16_f32 v164, v242, v248
v_lshlrev_b32 v242, 16, v165
v_and_b32 v248, 0xffff0000, v165
v_mul_f32 v242, v242, v237
v_mul_f32 v248, v248, v237
v_cvt_pk_bf16_f32 v165, v242, v248
v_lshlrev_b32 v242, 16, v166
v_and_b32 v248, 0xffff0000, v166
v_mul_f32 v242, v242, v237
v_mul_f32 v248, v248, v237
v_cvt_pk_bf16_f32 v166, v242, v248
v_lshlrev_b32 v242, 16, v167
v_and_b32 v248, 0xffff0000, v167
v_mul_f32 v242, v242, v237
v_mul_f32 v248, v248, v237
v_cvt_pk_bf16_f32 v167, v242, v248
v_lshlrev_b32 v242, 16, v180
v_and_b32 v248, 0xffff0000, v180
v_mul_f32 v242, v242, v237
v_mul_f32 v248, v248, v237
v_cvt_pk_bf16_f32 v180, v242, v248
v_lshlrev_b32 v242, 16, v181
v_and_b32 v248, 0xffff0000, v181
v_mul_f32 v242, v242, v237
v_mul_f32 v248, v248, v237
v_cvt_pk_bf16_f32 v181, v242, v248
ds_read_b64 v[250:251], v231 offset:1024
s_waitcnt lgkmcnt(0)
v_lshlrev_b32 v242, 16, v250
v_and_b32 v248, 0xffff0000, v250
v_mul_f32 v242, v242, v237
v_mul_f32 v248, v248, v237
v_cvt_pk_bf16_f32 v250, v242, v248
v_lshlrev_b32 v242, 16, v251
v_and_b32 v248, 0xffff0000, v251
v_mul_f32 v242, v242, v237
v_mul_f32 v248, v248, v237
v_cvt_pk_bf16_f32 v251, v242, v248
ds_write_b64 v231, v[250:251] offset:1024
s_waitcnt lgkmcnt(0)
ds_read_b64 v[250:251], v231 offset:1032
s_waitcnt lgkmcnt(0)
v_lshlrev_b32 v242, 16, v250
v_and_b32 v248, 0xffff0000, v250
v_mul_f32 v242, v242, v237
v_mul_f32 v248, v248, v237
v_cvt_pk_bf16_f32 v250, v242, v248
v_lshlrev_b32 v242, 16, v251
v_and_b32 v248, 0xffff0000, v251
v_mul_f32 v242, v242, v237
v_mul_f32 v248, v248, v237
v_cvt_pk_bf16_f32 v251, v242, v248
ds_write_b64 v231, v[250:251] offset:1032
s_waitcnt lgkmcnt(0)
ds_read_b64 v[250:251], v231 offset:5120
s_waitcnt lgkmcnt(0)
v_lshlrev_b32 v242, 16, v250
v_and_b32 v248, 0xffff0000, v250
v_mul_f32 v242, v242, v237
v_mul_f32 v248, v248, v237
v_cvt_pk_bf16_f32 v250, v242, v248
v_lshlrev_b32 v242, 16, v251
v_and_b32 v248, 0xffff0000, v251
v_mul_f32 v242, v242, v237
v_mul_f32 v248, v248, v237
v_cvt_pk_bf16_f32 v251, v242, v248
ds_write_b64 v231, v[250:251] offset:5120
s_waitcnt lgkmcnt(0)
ds_read_b64 v[250:251], v231 offset:5128
s_waitcnt lgkmcnt(0)
v_lshlrev_b32 v242, 16, v250
v_and_b32 v248, 0xffff0000, v250
v_mul_f32 v242, v242, v237
v_mul_f32 v248, v248, v237
v_cvt_pk_bf16_f32 v250, v242, v248
v_lshlrev_b32 v242, 16, v251
v_and_b32 v248, 0xffff0000, v251
v_mul_f32 v242, v242, v237
v_mul_f32 v248, v248, v237
v_cvt_pk_bf16_f32 v251, v242, v248
ds_write_b64 v231, v[250:251] offset:5128
s_waitcnt lgkmcnt(0)
v_exp_f32 v232, v148
v_exp_f32 v233, v149
v_exp_f32 v234, v150
v_exp_f32 v235, v151
s_nop 1
v_cvt_pk_bf16_f32 v182, v232, v233
v_cvt_pk_bf16_f32 v183, v234, v235
v_max_f32 v204, v152, v153
v_max3_f32 v204, v204, v154, v155
v_mov_b32 v205, v204
s_nop 1
v_permlane32_swap_b32 v204, v205
s_nop 1
v_max_f32 v204, v204, v205
v_mov_b32 v205, v204
s_nop 1
v_permlane16_swap_b32 v204, v205
s_nop 1
v_max_f32 v204, v204, v205
v_add_f32 v204, 40.0, v204
v_ceil_f32 v204, v204
v_max_f32 v204, 0, v204
v_sub_f32 v205, v226, v204
v_cvt_pk_bf16_f32 v205, v205, v205
v_and_b32 v205, 0xffff0000, v205
v_sub_f32 v204, v205, v226
v_mov_b32 v226, v205
v_exp_f32 v238, v204
v_bfi_b32 v67, v206, v205, v67
v_add_f32 v152, v152, v204
v_add_f32 v153, v153, v204
v_add_f32 v154, v154, v204
v_add_f32 v155, v155, v204
v_add_f32 v136, v136, v204
v_add_f32 v137, v137, v204
v_add_f32 v138, v138, v204
v_add_f32 v139, v139, v204
v_lshlrev_b32 v242, 16, v168
v_and_b32 v248, 0xffff0000, v168
v_mul_f32 v242, v242, v238
v_mul_f32 v248, v248, v238
v_cvt_pk_bf16_f32 v168, v242, v248
v_lshlrev_b32 v242, 16, v169
v_and_b32 v248, 0xffff0000, v169
v_mul_f32 v242, v242, v238
v_mul_f32 v248, v248, v238
v_cvt_pk_bf16_f32 v169, v242, v248
v_lshlrev_b32 v242, 16, v170
v_and_b32 v248, 0xffff0000, v170
v_mul_f32 v242, v242, v238
v_mul_f32 v248, v248, v238
v_cvt_pk_bf16_f32 v170, v242, v248
v_lshlrev_b32 v242, 16, v171
v_and_b32 v248, 0xffff0000, v171
v_mul_f32 v242, v242, v238
v_mul_f32 v248, v248, v238
v_cvt_pk_bf16_f32 v171, v242, v248
v_lshlrev_b32 v242, 16, v184
v_and_b32 v248, 0xffff0000, v184
v_mul_f32 v242, v242, v238
v_mul_f32 v248, v248, v238
v_cvt_pk_bf16_f32 v184, v242, v248
v_lshlrev_b32 v242, 16, v185
v_and_b32 v248, 0xffff0000, v185
v_mul_f32 v242, v242, v238
v_mul_f32 v248, v248, v238
v_cvt_pk_bf16_f32 v185, v242, v248
ds_read_b64 v[250:251], v231 offset:2048
s_waitcnt lgkmcnt(0)
v_lshlrev_b32 v242, 16, v250
v_and_b32 v248, 0xffff0000, v250
v_mul_f32 v242, v242, v238
v_mul_f32 v248, v248, v238
v_cvt_pk_bf16_f32 v250, v242, v248
v_lshlrev_b32 v242, 16, v251
v_and_b32 v248, 0xffff0000, v251
v_mul_f32 v242, v242, v238
v_mul_f32 v248, v248, v238
v_cvt_pk_bf16_f32 v251, v242, v248
ds_write_b64 v231, v[250:251] offset:2048
s_waitcnt lgkmcnt(0)
ds_read_b64 v[250:251], v231 offset:2056
s_waitcnt lgkmcnt(0)
v_lshlrev_b32 v242, 16, v250
v_and_b32 v248, 0xffff0000, v250
v_mul_f32 v242, v242, v238
v_mul_f32 v248, v248, v238
v_cvt_pk_bf16_f32 v250, v242, v248
v_lshlrev_b32 v242, 16, v251
v_and_b32 v248, 0xffff0000, v251
v_mul_f32 v242, v242, v238
v_mul_f32 v248, v248, v238
v_cvt_pk_bf16_f32 v251, v242, v248
ds_write_b64 v231, v[250:251] offset:2056
s_waitcnt lgkmcnt(0)
ds_read_b64 v[250:251], v231 offset:6144
s_waitcnt lgkmcnt(0)
v_lshlrev_b32 v242, 16, v250
v_and_b32 v248, 0xffff0000, v250
v_mul_f32 v242, v242, v238
v_mul_f32 v248, v248, v238
v_cvt_pk_bf16_f32 v250, v242, v248
v_lshlrev_b32 v242, 16, v251
v_and_b32 v248, 0xffff0000, v251
v_mul_f32 v242, v242, v238
v_mul_f32 v248, v248, v238
v_cvt_pk_bf16_f32 v251, v242, v248
ds_write_b64 v231, v[250:251] offset:6144
s_waitcnt lgkmcnt(0)
ds_read_b64 v[250:251], v231 offset:6152
s_waitcnt lgkmcnt(0)
v_lshlrev_b32 v242, 16, v250
v_and_b32 v248, 0xffff0000, v250
v_mul_f32 v242, v242, v238
v_mul_f32 v248, v248, v238
v_cvt_pk_bf16_f32 v250, v242, v248
v_lshlrev_b32 v242, 16, v251
v_and_b32 v248, 0xffff0000, v251
v_mul_f32 v242, v242, v238
v_mul_f32 v248, v248, v238
v_cvt_pk_bf16_f32 v251, v242, v248
ds_write_b64 v231, v[250:251] offset:6152
s_waitcnt lgkmcnt(0)
v_exp_f32 v232, v152
v_exp_f32 v233, v153
v_exp_f32 v234, v154
v_exp_f32 v235, v155
s_nop 1
v_cvt_pk_bf16_f32 v186, v232, v233
v_cvt_pk_bf16_f32 v187, v234, v235
v_max_f32 v204, v156, v157
v_max3_f32 v204, v204, v158, v159
v_mov_b32 v205, v204
s_nop 1
v_permlane32_swap_b32 v204, v205
s_nop 1
v_max_f32 v204, v204, v205
v_mov_b32 v205, v204
s_nop 1
v_permlane16_swap_b32 v204, v205
s_nop 1
v_max_f32 v204, v204, v205
v_add_f32 v204, 40.0, v204
v_ceil_f32 v204, v204
v_max_f32 v204, 0, v204
v_sub_f32 v205, v227, v204
v_cvt_pk_bf16_f32 v205, v205, v205
v_and_b32 v205, 0xffff0000, v205
v_sub_f32 v204, v205, v227
v_mov_b32 v227, v205
v_exp_f32 v239, v204
v_bfi_b32 v99, v206, v205, v99
v_add_f32 v156, v156, v204
v_add_f32 v157, v157, v204
v_add_f32 v158, v158, v204
v_add_f32 v159, v159, v204
v_add_f32 v140, v140, v204
v_add_f32 v141, v141, v204
v_add_f32 v142, v142, v204
v_add_f32 v143, v143, v204
v_lshlrev_b32 v242, 16, v172
v_and_b32 v248, 0xffff0000, v172
v_mul_f32 v242, v242, v239
v_mul_f32 v248, v248, v239
v_cvt_pk_bf16_f32 v172, v242, v248
v_lshlrev_b32 v242, 16, v173
v_and_b32 v248, 0xffff0000, v173
v_mul_f32 v242, v242, v239
v_mul_f32 v248, v248, v239
v_cvt_pk_bf16_f32 v173, v242, v248
v_lshlrev_b32 v242, 16, v174
v_and_b32 v248, 0xffff0000, v174
v_mul_f32 v242, v242, v239
v_mul_f32 v248, v248, v239
v_cvt_pk_bf16_f32 v174, v242, v248
v_lshlrev_b32 v242, 16, v175
v_and_b32 v248, 0xffff0000, v175
v_mul_f32 v242, v242, v239
v_mul_f32 v248, v248, v239
v_cvt_pk_bf16_f32 v175, v242, v248
v_lshlrev_b32 v242, 16, v188
v_and_b32 v248, 0xffff0000, v188
v_mul_f32 v242, v242, v239
v_mul_f32 v248, v248, v239
v_cvt_pk_bf16_f32 v188, v242, v248
v_lshlrev_b32 v242, 16, v189
v_and_b32 v248, 0xffff0000, v189
v_mul_f32 v242, v242, v239
v_mul_f32 v248, v248, v239
v_cvt_pk_bf16_f32 v189, v242, v248
ds_read_b64 v[250:251], v231 offset:3072
s_waitcnt lgkmcnt(0)
v_lshlrev_b32 v242, 16, v250
v_and_b32 v248, 0xffff0000, v250
v_mul_f32 v242, v242, v239
v_mul_f32 v248, v248, v239
v_cvt_pk_bf16_f32 v250, v242, v248
v_lshlrev_b32 v242, 16, v251
v_and_b32 v248, 0xffff0000, v251
v_mul_f32 v242, v242, v239
v_mul_f32 v248, v248, v239
v_cvt_pk_bf16_f32 v251, v242, v248
ds_write_b64 v231, v[250:251] offset:3072
s_waitcnt lgkmcnt(0)
ds_read_b64 v[250:251], v231 offset:3080
s_waitcnt lgkmcnt(0)
v_lshlrev_b32 v242, 16, v250
v_and_b32 v248, 0xffff0000, v250
v_mul_f32 v242, v242, v239
v_mul_f32 v248, v248, v239
v_cvt_pk_bf16_f32 v250, v242, v248
v_lshlrev_b32 v242, 16, v251
v_and_b32 v248, 0xffff0000, v251
v_mul_f32 v242, v242, v239
v_mul_f32 v248, v248, v239
v_cvt_pk_bf16_f32 v251, v242, v248
ds_write_b64 v231, v[250:251] offset:3080
s_waitcnt lgkmcnt(0)
ds_read_b64 v[250:251], v231 offset:7168
s_waitcnt lgkmcnt(0)
v_lshlrev_b32 v242, 16, v250
v_and_b32 v248, 0xffff0000, v250
v_mul_f32 v242, v242, v239
v_mul_f32 v248, v248, v239
v_cvt_pk_bf16_f32 v250, v242, v248
v_lshlrev_b32 v242, 16, v251
v_and_b32 v248, 0xffff0000, v251
v_mul_f32 v242, v242, v239
v_mul_f32 v248, v248, v239
v_cvt_pk_bf16_f32 v251, v242, v248
ds_write_b64 v231, v[250:251] offset:7168
s_waitcnt lgkmcnt(0)
ds_read_b64 v[250:251], v231 offset:7176
s_waitcnt lgkmcnt(0)
v_lshlrev_b32 v242, 16, v250
v_and_b32 v248, 0xffff0000, v250
v_mul_f32 v242, v242, v239
v_mul_f32 v248, v248, v239
v_cvt_pk_bf16_f32 v250, v242, v248
v_lshlrev_b32 v242, 16, v251
v_and_b32 v248, 0xffff0000, v251
v_mul_f32 v242, v242, v239
v_mul_f32 v248, v248, v239
v_cvt_pk_bf16_f32 v251, v242, v248
ds_write_b64 v231, v[250:251] offset:7176
s_waitcnt lgkmcnt(0)
v_exp_f32 v232, v156
v_exp_f32 v233, v157
v_exp_f32 v234, v158
v_exp_f32 v235, v159
s_nop 1
v_cvt_pk_bf16_f32 v190, v232, v233
v_cvt_pk_bf16_f32 v191, v234, v235
s_branch L2_rare_common
L2_rare_site16:
s_mov_b32 s36, 16
s_branch L2_rare_t0_4
L2_rare_t0_4:
s_nop 15
s_nop 15
s_waitcnt lgkmcnt(0)
v_lshrrev_b32 v206, 8, v243
v_add_u32 v206, 1, v206
v_lshrrev_b32 v206, 2, v206
v_sub_u32 v206, 0, v206
v_and_b32 v206, 0xffff0000, v206
v_max_f32 v204, v128, v129
v_max3_f32 v204, v204, v130, v131
v_mov_b32 v205, v204
s_nop 1
v_permlane32_swap_b32 v204, v205
s_nop 1
v_max_f32 v204, v204, v205
v_mov_b32 v205, v204
s_nop 1
v_permlane16_swap_b32 v204, v205
s_nop 1
v_max_f32 v204, v204, v205
v_add_f32 v204, 40.0, v204
v_ceil_f32 v204, v204
v_max_f32 v204, 0, v204
v_sub_f32 v205, v224, v204
v_cvt_pk_bf16_f32 v205, v205, v205
v_and_b32 v205, 0xffff0000, v205
v_sub_f32 v204, v205, v224
v_mov_b32 v224, v205
v_exp_f32 v236, v204
v_add_f32 v128, v128, v204
v_add_f32 v129, v129, v204
v_add_f32 v130, v130, v204
v_add_f32 v131, v131, v204
v_add_f32 v144, v144, v204
v_add_f32 v145, v145, v204
v_add_f32 v146, v146, v204
v_add_f32 v147, v147, v204
v_lshlrev_b32 v242, 16, v4
v_and_b32 v248, 0xffff0000, v4
v_mul_f32 v242, v242, v236
v_mul_f32 v248, v248, v236
v_cvt_pk_bf16_f32 v4, v242, v248
v_lshlrev_b32 v242, 16, v5
v_and_b32 v248, 0xffff0000, v5
v_mul_f32 v242, v242, v236
v_mul_f32 v248, v248, v236
v_cvt_pk_bf16_f32 v5, v242, v248
v_lshlrev_b32 v242, 16, v6
v_and_b32 v248, 0xffff0000, v6
v_mul_f32 v242, v242, v236
v_mul_f32 v248, v248, v236
v_cvt_pk_bf16_f32 v6, v242, v248
v_lshlrev_b32 v242, 16, v7
v_and_b32 v248, 0xffff0000, v7
v_mul_f32 v242, v242, v236
v_mul_f32 v248, v248, v236
v_cvt_pk_bf16_f32 v7, v242, v248
v_lshlrev_b32 v242, 16, v8
v_and_b32 v248, 0xffff0000, v8
v_mul_f32 v242, v242, v236
v_mul_f32 v248, v248, v236
v_cvt_pk_bf16_f32 v8, v242, v248
v_lshlrev_b32 v242, 16, v9
v_and_b32 v248, 0xffff0000, v9
v_mul_f32 v242, v242, v236
v_mul_f32 v248, v248, v236
v_cvt_pk_bf16_f32 v9, v242, v248
v_lshlrev_b32 v242, 16, v10
v_and_b32 v248, 0xffff0000, v10
v_mul_f32 v242, v242, v236
v_mul_f32 v248, v248, v236
v_cvt_pk_bf16_f32 v10, v242, v248
v_lshlrev_b32 v242, 16, v11
v_and_b32 v248, 0xffff0000, v11
v_mul_f32 v242, v242, v236
v_mul_f32 v248, v248, v236
v_cvt_pk_bf16_f32 v11, v242, v248
v_lshlrev_b32 v242, 16, v160
v_and_b32 v248, 0xffff0000, v160
v_mul_f32 v242, v242, v236
v_mul_f32 v248, v248, v236
v_cvt_pk_bf16_f32 v160, v242, v248
v_lshlrev_b32 v242, 16, v161
v_and_b32 v248, 0xffff0000, v161
v_mul_f32 v242, v242, v236
v_mul_f32 v248, v248, v236
v_cvt_pk_bf16_f32 v161, v242, v248
v_lshlrev_b32 v242, 16, v162
v_and_b32 v248, 0xffff0000, v162
v_mul_f32 v242, v242, v236
v_mul_f32 v248, v248, v236
v_cvt_pk_bf16_f32 v162, v242, v248
v_lshlrev_b32 v242, 16, v163
v_and_b32 v248, 0xffff0000, v163
v_mul_f32 v242, v242, v236
v_mul_f32 v248, v248, v236
v_cvt_pk_bf16_f32 v163, v242, v248
v_lshlrev_b32 v242, 16, v176
v_and_b32 v248, 0xffff0000, v176
v_mul_f32 v242, v242, v236
v_mul_f32 v248, v248, v236
v_cvt_pk_bf16_f32 v176, v242, v248
v_lshlrev_b32 v242, 16, v177
v_and_b32 v248, 0xffff0000, v177
v_mul_f32 v242, v242, v236
v_mul_f32 v248, v248, v236
v_cvt_pk_bf16_f32 v177, v242, v248
v_lshlrev_b32 v242, 16, v178
v_and_b32 v248, 0xffff0000, v178
v_mul_f32 v242, v242, v236
v_mul_f32 v248, v248, v236
v_cvt_pk_bf16_f32 v178, v242, v248
v_lshlrev_b32 v242, 16, v179
v_and_b32 v248, 0xffff0000, v179
v_mul_f32 v242, v242, v236
v_mul_f32 v248, v248, v236
v_cvt_pk_bf16_f32 v179, v242, v248
v_exp_f32 v232, v128
v_exp_f32 v233, v129
v_exp_f32 v234, v130
v_exp_f32 v235, v131
s_nop 1
v_cvt_pk_bf16_f32 v0, v232, v233
v_cvt_pk_bf16_f32 v1, v234, v235
v_max_f32 v204, v132, v133
v_max3_f32 v204, v204, v134, v135
v_mov_b32 v205, v204
s_nop 1
v_permlane32_swap_b32 v204, v205
s_nop 1
v_max_f32 v204, v204, v205
v_mov_b32 v205, v204
s_nop 1
v_permlane16_swap_b32 v204, v205
s_nop 1
v_max_f32 v204, v204, v205
v_add_f32 v204, 40.0, v204
v_ceil_f32 v204, v204
v_max_f32 v204, 0, v204
v_sub_f32 v205, v225, v204
v_cvt_pk_bf16_f32 v205, v205, v205
v_and_b32 v205, 0xffff0000, v205
v_sub_f32 v204, v205, v225
v_mov_b32 v225, v205
v_exp_f32 v237, v204
v_add_f32 v132, v132, v204
v_add_f32 v133, v133, v204
v_add_f32 v134, v134, v204
v_add_f32 v135, v135, v204
v_add_f32 v148, v148, v204
v_add_f32 v149, v149, v204
v_add_f32 v150, v150, v204
v_add_f32 v151, v151, v204
v_lshlrev_b32 v242, 16, v36
v_and_b32 v248, 0xffff0000, v36
v_mul_f32 v242, v242, v237
v_mul_f32 v248, v248, v237
v_cvt_pk_bf16_f32 v36, v242, v248
v_lshlrev_b32 v242, 16, v37
v_and_b32 v248, 0xffff0000, v37
v_mul_f32 v242, v242, v237
v_mul_f32 v248, v248, v237
v_cvt_pk_bf16_f32 v37, v242, v248
v_lshlrev_b32 v242, 16, v38
v_and_b32 v248, 0xffff0000, v38
v_mul_f32 v242, v242, v237
v_mul_f32 v248, v248, v237
v_cvt_pk_bf16_f32 v38, v242, v248
v_lshlrev_b32 v242, 16, v39
v_and_b32 v248, 0xffff0000, v39
v_mul_f32 v242, v242, v237
v_mul_f32 v248, v248, v237
v_cvt_pk_bf16_f32 v39, v242, v248
v_lshlrev_b32 v242, 16, v40
v_and_b32 v248, 0xffff0000, v40
v_mul_f32 v242, v242, v237
v_mul_f32 v248, v248, v237
v_cvt_pk_bf16_f32 v40, v242, v248
v_lshlrev_b32 v242, 16, v41
v_and_b32 v248, 0xffff0000, v41
v_mul_f32 v242, v242, v237
v_mul_f32 v248, v248, v237
v_cvt_pk_bf16_f32 v41, v242, v248
v_lshlrev_b32 v242, 16, v42
v_and_b32 v248, 0xffff0000, v42
v_mul_f32 v242, v242, v237
v_mul_f32 v248, v248, v237
v_cvt_pk_bf16_f32 v42, v242, v248
v_lshlrev_b32 v242, 16, v43
v_and_b32 v248, 0xffff0000, v43
v_mul_f32 v242, v242, v237
v_mul_f32 v248, v248, v237
v_cvt_pk_bf16_f32 v43, v242, v248
v_lshlrev_b32 v242, 16, v164
v_and_b32 v248, 0xffff0000, v164
v_mul_f32 v242, v242, v237
v_mul_f32 v248, v248, v237
v_cvt_pk_bf16_f32 v164, v242, v248
v_lshlrev_b32 v242, 16, v165
v_and_b32 v248, 0xffff0000, v165
v_mul_f32 v242, v242, v237
v_mul_f32 v248, v248, v237
v_cvt_pk_bf16_f32 v165, v242, v248
v_lshlrev_b32 v242, 16, v166
v_and_b32 v248, 0xffff0000, v166
v_mul_f32 v242, v242, v237
v_mul_f32 v248, v248, v237
v_cvt_pk_bf16_f32 v166, v242, v248
v_lshlrev_b32 v242, 16, v167
v_and_b32 v248, 0xffff0000, v167
v_mul_f32 v242, v242, v237
v_mul_f32 v248, v248, v237
v_cvt_pk_bf16_f32 v167, v242, v248
v_lshlrev_b32 v242, 16, v180
v_and_b32 v248, 0xffff0000, v180
v_mul_f32 v242, v242, v237
v_mul_f32 v248, v248, v237
v_cvt_pk_bf16_f32 v180, v242, v248
v_lshlrev_b32 v242, 16, v181
v_and_b32 v248, 0xffff0000, v181
v_mul_f32 v242, v242, v237
v_mul_f32 v248, v248, v237
v_cvt_pk_bf16_f32 v181, v242, v248
v_lshlrev_b32 v242, 16, v182
v_and_b32 v248, 0xffff0000, v182
v_mul_f32 v242, v242, v237
v_mul_f32 v248, v248, v237
v_cvt_pk_bf16_f32 v182, v242, v248
v_lshlrev_b32 v242, 16, v183
v_and_b32 v248, 0xffff0000, v183
v_mul_f32 v242, v242, v237
v_mul_f32 v248, v248, v237
v_cvt_pk_bf16_f32 v183, v242, v248
v_exp_f32 v232, v132
v_exp_f32 v233, v133
v_exp_f32 v234, v134
v_exp_f32 v235, v135
s_nop 1
v_cvt_pk_bf16_f32 v32, v232, v233
v_cvt_pk_bf16_f32 v33, v234, v235
v_max_f32 v204, v136, v137
v_max3_f32 v204, v204, v138, v139
v_mov_b32 v205, v204
s_nop 1
v_permlane32_swap_b32 v204, v205
s_nop 1
v_max_f32 v204, v204, v205
v_mov_b32 v205, v204
s_nop 1
v_permlane16_swap_b32 v204, v205
s_nop 1
v_max_f32 v204, v204, v205
v_add_f32 v204, 40.0, v204
v_ceil_f32 v204, v204
v_max_f32 v204, 0, v204
v_sub_f32 v205, v226, v204
v_cvt_pk_bf16_f32 v205, v205, v205
v_and_b32 v205, 0xffff0000, v205
v_sub_f32 v204, v205, v226
v_mov_b32 v226, v205
v_exp_f32 v238, v204
v_add_f32 v136, v136, v204
v_add_f32 v137, v137, v204
v_add_f32 v138, v138, v204
v_add_f32 v139, v139, v204
v_add_f32 v152, v152, v204
v_add_f32 v153, v153, v204
v_add_f32 v154, v154, v204
v_add_f32 v155, v155, v204
v_lshlrev_b32 v242, 16, v68
v_and_b32 v248, 0xffff0000, v68
v_mul_f32 v242, v242, v238
v_mul_f32 v248, v248, v238
v_cvt_pk_bf16_f32 v68, v242, v248
v_lshlrev_b32 v242, 16, v69
v_and_b32 v248, 0xffff0000, v69
v_mul_f32 v242, v242, v238
v_mul_f32 v248, v248, v238
v_cvt_pk_bf16_f32 v69, v242, v248
v_lshlrev_b32 v242, 16, v70
v_and_b32 v248, 0xffff0000, v70
v_mul_f32 v242, v242, v238
v_mul_f32 v248, v248, v238
v_cvt_pk_bf16_f32 v70, v242, v248
v_lshlrev_b32 v242, 16, v71
v_and_b32 v248, 0xffff0000, v71
v_mul_f32 v242, v242, v238
v_mul_f32 v248, v248, v238
v_cvt_pk_bf16_f32 v71, v242, v248
v_lshlrev_b32 v242, 16, v72
v_and_b32 v248, 0xffff0000, v72
v_mul_f32 v242, v242, v238
v_mul_f32 v248, v248, v238
v_cvt_pk_bf16_f32 v72, v242, v248
v_lshlrev_b32 v242, 16, v73
v_and_b32 v248, 0xffff0000, v73
v_mul_f32 v242, v242, v238
v_mul_f32 v248, v248, v238
v_cvt_pk_bf16_f32 v73, v242, v248
v_lshlrev_b32 v242, 16, v74
v_and_b32 v248, 0xffff0000, v74
v_mul_f32 v242, v242, v238
v_mul_f32 v248, v248, v238
v_cvt_pk_bf16_f32 v74, v242, v248
v_lshlrev_b32 v242, 16, v75
v_and_b32 v248, 0xffff0000, v75
v_mul_f32 v242, v242, v238
v_mul_f32 v248, v248, v238
v_cvt_pk_bf16_f32 v75, v242, v248
v_lshlrev_b32 v242, 16, v168
v_and_b32 v248, 0xffff0000, v168
v_mul_f32 v242, v242, v238
v_mul_f32 v248, v248, v238
v_cvt_pk_bf16_f32 v168, v242, v248
v_lshlrev_b32 v242, 16, v169
v_and_b32 v248, 0xffff0000, v169
v_mul_f32 v242, v242, v238
v_mul_f32 v248, v248, v238
v_cvt_pk_bf16_f32 v169, v242, v248
v_lshlrev_b32 v242, 16, v170
v_and_b32 v248, 0xffff0000, v170
v_mul_f32 v242, v242, v238
v_mul_f32 v248, v248, v238
v_cvt_pk_bf16_f32 v170, v242, v248
v_lshlrev_b32 v242, 16, v171
v_and_b32 v248, 0xffff0000, v171
v_mul_f32 v242, v242, v238
v_mul_f32 v248, v248, v238
v_cvt_pk_bf16_f32 v171, v242, v248
v_lshlrev_b32 v242, 16, v184
v_and_b32 v248, 0xffff0000, v184
v_mul_f32 v242, v242, v238
v_mul_f32 v248, v248, v238
v_cvt_pk_bf16_f32 v184, v242, v248
v_lshlrev_b32 v242, 16, v185
v_and_b32 v248, 0xffff0000, v185
v_mul_f32 v242, v242, v238
v_mul_f32 v248, v248, v238
v_cvt_pk_bf16_f32 v185, v242, v248
v_lshlrev_b32 v242, 16, v186
v_and_b32 v248, 0xffff0000, v186
v_mul_f32 v242, v242, v238
v_mul_f32 v248, v248, v238
v_cvt_pk_bf16_f32 v186, v242, v248
v_lshlrev_b32 v242, 16, v187
v_and_b32 v248, 0xffff0000, v187
v_mul_f32 v242, v242, v238
v_mul_f32 v248, v248, v238
v_cvt_pk_bf16_f32 v187, v242, v248
v_exp_f32 v232, v136
v_exp_f32 v233, v137
v_exp_f32 v234, v138
v_exp_f32 v235, v139
s_nop 1
v_cvt_pk_bf16_f32 v64, v232, v233
v_cvt_pk_bf16_f32 v65, v234, v235
v_max_f32 v204, v140, v141
v_max3_f32 v204, v204, v142, v143
v_mov_b32 v205, v204
s_nop 1
v_permlane32_swap_b32 v204, v205
s_nop 1
v_max_f32 v204, v204, v205
v_mov_b32 v205, v204
s_nop 1
v_permlane16_swap_b32 v204, v205
s_nop 1
v_max_f32 v204, v204, v205
v_add_f32 v204, 40.0, v204
v_ceil_f32 v204, v204
v_max_f32 v204, 0, v204
v_sub_f32 v205, v227, v204
v_cvt_pk_bf16_f32 v205, v205, v205
v_and_b32 v205, 0xffff0000, v205
v_sub_f32 v204, v205, v227
v_mov_b32 v227, v205
v_exp_f32 v239, v204
v_add_f32 v140, v140, v204
v_add_f32 v141, v141, v204
v_add_f32 v142, v142, v204
v_add_f32 v143, v143, v204
v_add_f32 v156, v156, v204
v_add_f32 v157, v157, v204
v_add_f32 v158, v158, v204
v_add_f32 v159, v159, v204
v_lshlrev_b32 v242, 16, v100
v_and_b32 v248, 0xffff0000, v100
v_mul_f32 v242, v242, v239
v_mul_f32 v248, v248, v239
v_cvt_pk_bf16_f32 v100, v242, v248
v_lshlrev_b32 v242, 16, v101
v_and_b32 v248, 0xffff0000, v101
v_mul_f32 v242, v242, v239
v_mul_f32 v248, v248, v239
v_cvt_pk_bf16_f32 v101, v242, v248
v_lshlrev_b32 v242, 16, v102
v_and_b32 v248, 0xffff0000, v102
v_mul_f32 v242, v242, v239
v_mul_f32 v248, v248, v239
v_cvt_pk_bf16_f32 v102, v242, v248
v_lshlrev_b32 v242, 16, v103
v_and_b32 v248, 0xffff0000, v103
v_mul_f32 v242, v242, v239
v_mul_f32 v248, v248, v239
v_cvt_pk_bf16_f32 v103, v242, v248
v_lshlrev_b32 v242, 16, v104
v_and_b32 v248, 0xffff0000, v104
v_mul_f32 v242, v242, v239
v_mul_f32 v248, v248, v239
v_cvt_pk_bf16_f32 v104, v242, v248
v_lshlrev_b32 v242, 16, v105
v_and_b32 v248, 0xffff0000, v105
v_mul_f32 v242, v242, v239
v_mul_f32 v248, v248, v239
v_cvt_pk_bf16_f32 v105, v242, v248
v_lshlrev_b32 v242, 16, v106
v_and_b32 v248, 0xffff0000, v106
v_mul_f32 v242, v242, v239
v_mul_f32 v248, v248, v239
v_cvt_pk_bf16_f32 v106, v242, v248
v_lshlrev_b32 v242, 16, v107
v_and_b32 v248, 0xffff0000, v107
v_mul_f32 v242, v242, v239
v_mul_f32 v248, v248, v239
v_cvt_pk_bf16_f32 v107, v242, v248
v_lshlrev_b32 v242, 16, v172
v_and_b32 v248, 0xffff0000, v172
v_mul_f32 v242, v242, v239
v_mul_f32 v248, v248, v239
v_cvt_pk_bf16_f32 v172, v242, v248
v_lshlrev_b32 v242, 16, v173
v_and_b32 v248, 0xffff0000, v173
v_mul_f32 v242, v242, v239
v_mul_f32 v248, v248, v239
v_cvt_pk_bf16_f32 v173, v242, v248
v_lshlrev_b32 v242, 16, v174
v_and_b32 v248, 0xffff0000, v174
v_mul_f32 v242, v242, v239
v_mul_f32 v248, v248, v239
v_cvt_pk_bf16_f32 v174, v242, v248
v_lshlrev_b32 v242, 16, v175
v_and_b32 v248, 0xffff0000, v175
v_mul_f32 v242, v242, v239
v_mul_f32 v248, v248, v239
v_cvt_pk_bf16_f32 v175, v242, v248
v_lshlrev_b32 v242, 16, v188
v_and_b32 v248, 0xffff0000, v188
v_mul_f32 v242, v242, v239
v_mul_f32 v248, v248, v239
v_cvt_pk_bf16_f32 v188, v242, v248
v_lshlrev_b32 v242, 16, v189
v_and_b32 v248, 0xffff0000, v189
v_mul_f32 v242, v242, v239
v_mul_f32 v248, v248, v239
v_cvt_pk_bf16_f32 v189, v242, v248
v_lshlrev_b32 v242, 16, v190
v_and_b32 v248, 0xffff0000, v190
v_mul_f32 v242, v242, v239
v_mul_f32 v248, v248, v239
v_cvt_pk_bf16_f32 v190, v242, v248
v_lshlrev_b32 v242, 16, v191
v_and_b32 v248, 0xffff0000, v191
v_mul_f32 v242, v242, v239
v_mul_f32 v248, v248, v239
v_cvt_pk_bf16_f32 v191, v242, v248
v_exp_f32 v232, v140
v_exp_f32 v233, v141
v_exp_f32 v234, v142
v_exp_f32 v235, v143
s_nop 1
v_cvt_pk_bf16_f32 v96, v232, v233
v_cvt_pk_bf16_f32 v97, v234, v235
s_branch L2_rare_common
L2_rare_site17:
s_mov_b32 s36, 17
s_branch L2_rare_t0_5
L2_rare_t0_5:
s_nop 15
s_nop 15
s_waitcnt lgkmcnt(0)
v_lshrrev_b32 v206, 8, v243
v_add_u32 v206, 1, v206
v_lshrrev_b32 v206, 2, v206
v_sub_u32 v206, 0, v206
v_and_b32 v206, 0xffff0000, v206
v_max_f32 v204, v144, v145
v_max3_f32 v204, v204, v146, v147
v_mov_b32 v205, v204
s_nop 1
v_permlane32_swap_b32 v204, v205
s_nop 1
v_max_f32 v204, v204, v205
v_mov_b32 v205, v204
s_nop 1
v_permlane16_swap_b32 v204, v205
s_nop 1
v_max_f32 v204, v204, v205
v_add_f32 v204, 40.0, v204
v_ceil_f32 v204, v204
v_max_f32 v204, 0, v204
v_sub_f32 v205, v224, v204
v_cvt_pk_bf16_f32 v205, v205, v205
v_and_b32 v205, 0xffff0000, v205
v_sub_f32 v204, v205, v224
v_mov_b32 v224, v205
v_exp_f32 v236, v204
v_add_f32 v144, v144, v204
v_add_f32 v145, v145, v204
v_add_f32 v146, v146, v204
v_add_f32 v147, v147, v204
v_add_f32 v128, v128, v204
v_add_f32 v129, v129, v204
v_add_f32 v130, v130, v204
v_add_f32 v131, v131, v204
v_lshlrev_b32 v242, 16, v4
v_and_b32 v248, 0xffff0000, v4
v_mul_f32 v242, v242, v236
v_mul_f32 v248, v248, v236
v_cvt_pk_bf16_f32 v4, v242, v248
v_lshlrev_b32 v242, 16, v5
v_and_b32 v248, 0xffff0000, v5
v_mul_f32 v242, v242, v236
v_mul_f32 v248, v248, v236
v_cvt_pk_bf16_f32 v5, v242, v248
v_lshlrev_b32 v242, 16, v6
v_and_b32 v248, 0xffff0000, v6
v_mul_f32 v242, v242, v236
v_mul_f32 v248, v248, v236
v_cvt_pk_bf16_f32 v6, v242, v248
v_lshlrev_b32 v242, 16, v7
v_and_b32 v248, 0xffff0000, v7
v_mul_f32 v242, v242, v236
v_mul_f32 v248, v248, v236
v_cvt_pk_bf16_f32 v7, v242, v248
v_lshlrev_b32 v242, 16, v8
v_and_b32 v248, 0xffff0000, v8
v_mul_f32 v242, v242, v236
v_mul_f32 v248, v248, v236
v_cvt_pk_bf16_f32 v8, v242, v248
v_lshlrev_b32 v242, 16, v9
v_and_b32 v248, 0xffff0000, v9
v_mul_f32 v242, v242, v236
v_mul_f32 v248, v248, v236
v_cvt_pk_bf16_f32 v9, v242, v248
v_lshlrev_b32 v242, 16, v10
v_and_b32 v248, 0xffff0000, v10
v_mul_f32 v242, v242, v236
v_mul_f32 v248, v248, v236
v_cvt_pk_bf16_f32 v10, v242, v248
v_lshlrev_b32 v242, 16, v11
v_and_b32 v248, 0xffff0000, v11
v_mul_f32 v242, v242, v236
v_mul_f32 v248, v248, v236
v_cvt_pk_bf16_f32 v11, v242, v248
v_lshlrev_b32 v242, 16, v160
v_and_b32 v248, 0xffff0000, v160
v_mul_f32 v242, v242, v236
v_mul_f32 v248, v248, v236
v_cvt_pk_bf16_f32 v160, v242, v248
v_lshlrev_b32 v242, 16, v161
v_and_b32 v248, 0xffff0000, v161
v_mul_f32 v242, v242, v236
v_mul_f32 v248, v248, v236
v_cvt_pk_bf16_f32 v161, v242, v248
v_lshlrev_b32 v242, 16, v162
v_and_b32 v248, 0xffff0000, v162
v_mul_f32 v242, v242, v236
v_mul_f32 v248, v248, v236
v_cvt_pk_bf16_f32 v162, v242, v248
v_lshlrev_b32 v242, 16, v163
v_and_b32 v248, 0xffff0000, v163
v_mul_f32 v242, v242, v236
v_mul_f32 v248, v248, v236
v_cvt_pk_bf16_f32 v163, v242, v248
v_lshlrev_b32 v242, 16, v176
v_and_b32 v248, 0xffff0000, v176
v_mul_f32 v242, v242, v236
v_mul_f32 v248, v248, v236
v_cvt_pk_bf16_f32 v176, v242, v248
v_lshlrev_b32 v242, 16, v177
v_and_b32 v248, 0xffff0000, v177
v_mul_f32 v242, v242, v236
v_mul_f32 v248, v248, v236
v_cvt_pk_bf16_f32 v177, v242, v248
v_lshlrev_b32 v242, 16, v178
v_and_b32 v248, 0xffff0000, v178
v_mul_f32 v242, v242, v236
v_mul_f32 v248, v248, v236
v_cvt_pk_bf16_f32 v178, v242, v248
v_lshlrev_b32 v242, 16, v179
v_and_b32 v248, 0xffff0000, v179
v_mul_f32 v242, v242, v236
v_mul_f32 v248, v248, v236
v_cvt_pk_bf16_f32 v179, v242, v248
v_lshlrev_b32 v242, 16, v0
v_and_b32 v248, 0xffff0000, v0
v_mul_f32 v242, v242, v236
v_mul_f32 v248, v248, v236
v_cvt_pk_bf16_f32 v0, v242, v248
v_lshlrev_b32 v242, 16, v1
v_and_b32 v248, 0xffff0000, v1
v_mul_f32 v242, v242, v236
v_mul_f32 v248, v248, v236
v_cvt_pk_bf16_f32 v1, v242, v248
v_exp_f32 v232, v144
v_exp_f32 v233, v145
v_exp_f32 v234, v146
v_exp_f32 v235, v147
s_nop 1
v_cvt_pk_bf16_f32 v2, v232, v233
v_cvt_pk_bf16_f32 v3, v234, v235
v_max_f32 v204, v148, v149
v_max3_f32 v204, v204, v150, v151
v_mov_b32 v205, v204
s_nop 1
v_permlane32_swap_b32 v204, v205
s_nop 1
v_max_f32 v204, v204, v205
v_mov_b32 v205, v204
s_nop 1
v_permlane16_swap_b32 v204, v205
s_nop 1
v_max_f32 v204, v204, v205
v_add_f32 v204, 40.0, v204
v_ceil_f32 v204, v204
v_max_f32 v204, 0, v204
v_sub_f32 v205, v225, v204
v_cvt_pk_bf16_f32 v205, v205, v205
v_and_b32 v205, 0xffff0000, v205
v_sub_f32 v204, v205, v225
v_mov_b32 v225, v205
v_exp_f32 v237, v204
v_add_f32 v148, v148, v204
v_add_f32 v149, v149, v204
v_add_f32 v150, v150, v204
v_add_f32 v151, v151, v204
v_add_f32 v132, v132, v204
v_add_f32 v133, v133, v204
v_add_f32 v134, v134, v204
v_add_f32 v135, v135, v204
v_lshlrev_b32 v242, 16, v36
v_and_b32 v248, 0xffff0000, v36
v_mul_f32 v242, v242, v237
v_mul_f32 v248, v248, v237
v_cvt_pk_bf16_f32 v36, v242, v248
v_lshlrev_b32 v242, 16, v37
v_and_b32 v248, 0xffff0000, v37
v_mul_f32 v242, v242, v237
v_mul_f32 v248, v248, v237
v_cvt_pk_bf16_f32 v37, v242, v248
v_lshlrev_b32 v242, 16, v38
v_and_b32 v248, 0xffff0000, v38
v_mul_f32 v242, v242, v237
v_mul_f32 v248, v248, v237
v_cvt_pk_bf16_f32 v38, v242, v248
v_lshlrev_b32 v242, 16, v39
v_and_b32 v248, 0xffff0000, v39
v_mul_f32 v242, v242, v237
v_mul_f32 v248, v248, v237
v_cvt_pk_bf16_f32 v39, v242, v248
v_lshlrev_b32 v242, 16, v40
v_and_b32 v248, 0xffff0000, v40
v_mul_f32 v242, v242, v237
v_mul_f32 v248, v248, v237
v_cvt_pk_bf16_f32 v40, v242, v248
v_lshlrev_b32 v242, 16, v41
v_and_b32 v248, 0xffff0000, v41
v_mul_f32 v242, v242, v237
v_mul_f32 v248, v248, v237
v_cvt_pk_bf16_f32 v41, v242, v248
v_lshlrev_b32 v242, 16, v42
v_and_b32 v248, 0xffff0000, v42
v_mul_f32 v242, v242, v237
v_mul_f32 v248, v248, v237
v_cvt_pk_bf16_f32 v42, v242, v248
v_lshlrev_b32 v242, 16, v43
v_and_b32 v248, 0xffff0000, v43
v_mul_f32 v242, v242, v237
v_mul_f32 v248, v248, v237
v_cvt_pk_bf16_f32 v43, v242, v248
v_lshlrev_b32 v242, 16, v164
v_and_b32 v248, 0xffff0000, v164
v_mul_f32 v242, v242, v237
v_mul_f32 v248, v248, v237
v_cvt_pk_bf16_f32 v164, v242, v248
v_lshlrev_b32 v242, 16, v165
v_and_b32 v248, 0xffff0000, v165
v_mul_f32 v242, v242, v237
v_mul_f32 v248, v248, v237
v_cvt_pk_bf16_f32 v165, v242, v248
v_lshlrev_b32 v242, 16, v166
v_and_b32 v248, 0xffff0000, v166
v_mul_f32 v242, v242, v237
v_mul_f32 v248, v248, v237
v_cvt_pk_bf16_f32 v166, v242, v248
v_lshlrev_b32 v242, 16, v167
v_and_b32 v248, 0xffff0000, v167
v_mul_f32 v242, v242, v237
v_mul_f32 v248, v248, v237
v_cvt_pk_bf16_f32 v167, v242, v248
v_lshlrev_b32 v242, 16, v180
v_and_b32 v248, 0xffff0000, v180
v_mul_f32 v242, v242, v237
v_mul_f32 v248, v248, v237
v_cvt_pk_bf16_f32 v180, v242, v248
v_lshlrev_b32 v242, 16, v181
v_and_b32 v248, 0xffff0000, v181
v_mul_f32 v242, v242, v237
v_mul_f32 v248, v248, v237
v_cvt_pk_bf16_f32 v181, v242, v248
v_lshlrev_b32 v242, 16, v182
v_and_b32 v248, 0xffff0000, v182
v_mul_f32 v242, v242, v237
v_mul_f32 v248, v248, v237
v_cvt_pk_bf16_f32 v182, v242, v248
v_lshlrev_b32 v242, 16, v183
v_and_b32 v248, 0xffff0000, v183
v_mul_f32 v242, v242, v237
v_mul_f32 v248, v248, v237
v_cvt_pk_bf16_f32 v183, v242, v248
v_lshlrev_b32 v242, 16, v32
v_and_b32 v248, 0xffff0000, v32
v_mul_f32 v242, v242, v237
v_mul_f32 v248, v248, v237
v_cvt_pk_bf16_f32 v32, v242, v248
v_lshlrev_b32 v242, 16, v33
v_and_b32 v248, 0xffff0000, v33
v_mul_f32 v242, v242, v237
v_mul_f32 v248, v248, v237
v_cvt_pk_bf16_f32 v33, v242, v248
v_exp_f32 v232, v148
v_exp_f32 v233, v149
v_exp_f32 v234, v150
v_exp_f32 v235, v151
s_nop 1
v_cvt_pk_bf16_f32 v34, v232, v233
v_cvt_pk_bf16_f32 v35, v234, v235
v_max_f32 v204, v152, v153
v_max3_f32 v204, v204, v154, v155
v_mov_b32 v205, v204
s_nop 1
v_permlane32_swap_b32 v204, v205
s_nop 1
v_max_f32 v204, v204, v205
v_mov_b32 v205, v204
s_nop 1
v_permlane16_swap_b32 v204, v205
s_nop 1
v_max_f32 v204, v204, v205
v_add_f32 v204, 40.0, v204
v_ceil_f32 v204, v204
v_max_f32 v204, 0, v204
v_sub_f32 v205, v226, v204
v_cvt_pk_bf16_f32 v205, v205, v205
v_and_b32 v205, 0xffff0000, v205
v_sub_f32 v204, v205, v226
v_mov_b32 v226, v205
v_exp_f32 v238, v204
v_add_f32 v152, v152, v204
v_add_f32 v153, v153, v204
v_add_f32 v154, v154, v204
v_add_f32 v155, v155, v204
v_add_f32 v136, v136, v204
v_add_f32 v137, v137, v204
v_add_f32 v138, v138, v204
v_add_f32 v139, v139, v204
v_lshlrev_b32 v242, 16, v68
v_and_b32 v248, 0xffff0000, v68
v_mul_f32 v242, v242, v238
v_mul_f32 v248, v248, v238
v_cvt_pk_bf16_f32 v68, v242, v248
v_lshlrev_b32 v242, 16, v69
v_and_b32 v248, 0xffff0000, v69
v_mul_f32 v242, v242, v238
v_mul_f32 v248, v248, v238
v_cvt_pk_bf16_f32 v69, v242, v248
v_lshlrev_b32 v242, 16, v70
v_and_b32 v248, 0xffff0000, v70
v_mul_f32 v242, v242, v238
v_mul_f32 v248, v248, v238
v_cvt_pk_bf16_f32 v70, v242, v248
v_lshlrev_b32 v242, 16, v71
v_and_b32 v248, 0xffff0000, v71
v_mul_f32 v242, v242, v238
v_mul_f32 v248, v248, v238
v_cvt_pk_bf16_f32 v71, v242, v248
v_lshlrev_b32 v242, 16, v72
v_and_b32 v248, 0xffff0000, v72
v_mul_f32 v242, v242, v238
v_mul_f32 v248, v248, v238
v_cvt_pk_bf16_f32 v72, v242, v248
v_lshlrev_b32 v242, 16, v73
v_and_b32 v248, 0xffff0000, v73
v_mul_f32 v242, v242, v238
v_mul_f32 v248, v248, v238
v_cvt_pk_bf16_f32 v73, v242, v248
v_lshlrev_b32 v242, 16, v74
v_and_b32 v248, 0xffff0000, v74
v_mul_f32 v242, v242, v238
v_mul_f32 v248, v248, v238
v_cvt_pk_bf16_f32 v74, v242, v248
v_lshlrev_b32 v242, 16, v75
v_and_b32 v248, 0xffff0000, v75
v_mul_f32 v242, v242, v238
v_mul_f32 v248, v248, v238
v_cvt_pk_bf16_f32 v75, v242, v248
v_lshlrev_b32 v242, 16, v168
v_and_b32 v248, 0xffff0000, v168
v_mul_f32 v242, v242, v238
v_mul_f32 v248, v248, v238
v_cvt_pk_bf16_f32 v168, v242, v248
v_lshlrev_b32 v242, 16, v169
v_and_b32 v248, 0xffff0000, v169
v_mul_f32 v242, v242, v238
v_mul_f32 v248, v248, v238
v_cvt_pk_bf16_f32 v169, v242, v248
v_lshlrev_b32 v242, 16, v170
v_and_b32 v248, 0xffff0000, v170
v_mul_f32 v242, v242, v238
v_mul_f32 v248, v248, v238
v_cvt_pk_bf16_f32 v170, v242, v248
v_lshlrev_b32 v242, 16, v171
v_and_b32 v248, 0xffff0000, v171
v_mul_f32 v242, v242, v238
v_mul_f32 v248, v248, v238
v_cvt_pk_bf16_f32 v171, v242, v248
v_lshlrev_b32 v242, 16, v184
v_and_b32 v248, 0xffff0000, v184
v_mul_f32 v242, v242, v238
v_mul_f32 v248, v248, v238
v_cvt_pk_bf16_f32 v184, v242, v248
v_lshlrev_b32 v242, 16, v185
v_and_b32 v248, 0xffff0000, v185
v_mul_f32 v242, v242, v238
v_mul_f32 v248, v248, v238
v_cvt_pk_bf16_f32 v185, v242, v248
v_lshlrev_b32 v242, 16, v186
v_and_b32 v248, 0xffff0000, v186
v_mul_f32 v242, v242, v238
v_mul_f32 v248, v248, v238
v_cvt_pk_bf16_f32 v186, v242, v248
v_lshlrev_b32 v242, 16, v187
v_and_b32 v248, 0xffff0000, v187
v_mul_f32 v242, v242, v238
v_mul_f32 v248, v248, v238
v_cvt_pk_bf16_f32 v187, v242, v248
v_lshlrev_b32 v242, 16, v64
v_and_b32 v248, 0xffff0000, v64
v_mul_f32 v242, v242, v238
v_mul_f32 v248, v248, v238
v_cvt_pk_bf16_f32 v64, v242, v248
v_lshlrev_b32 v242, 16, v65
v_and_b32 v248, 0xffff0000, v65
v_mul_f32 v242, v242, v238
v_mul_f32 v248, v248, v238
v_cvt_pk_bf16_f32 v65, v242, v248
v_exp_f32 v232, v152
v_exp_f32 v233, v153
v_exp_f32 v234, v154
v_exp_f32 v235, v155
s_nop 1
v_cvt_pk_bf16_f32 v66, v232, v233
v_cvt_pk_bf16_f32 v67, v234, v235
v_max_f32 v204, v156, v157
v_max3_f32 v204, v204, v158, v159
v_mov_b32 v205, v204
s_nop 1
v_permlane32_swap_b32 v204, v205
s_nop 1
v_max_f32 v204, v204, v205
v_mov_b32 v205, v204
s_nop 1
v_permlane16_swap_b32 v204, v205
s_nop 1
v_max_f32 v204, v204, v205
v_add_f32 v204, 40.0, v204
v_ceil_f32 v204, v204
v_max_f32 v204, 0, v204
v_sub_f32 v205, v227, v204
v_cvt_pk_bf16_f32 v205, v205, v205
v_and_b32 v205, 0xffff0000, v205
v_sub_f32 v204, v205, v227
v_mov_b32 v227, v205
v_exp_f32 v239, v204
v_add_f32 v156, v156, v204
v_add_f32 v157, v157, v204
v_add_f32 v158, v158, v204
v_add_f32 v159, v159, v204
v_add_f32 v140, v140, v204
v_add_f32 v141, v141, v204
v_add_f32 v142, v142, v204
v_add_f32 v143, v143, v204
v_lshlrev_b32 v242, 16, v100
v_and_b32 v248, 0xffff0000, v100
v_mul_f32 v242, v242, v239
v_mul_f32 v248, v248, v239
v_cvt_pk_bf16_f32 v100, v242, v248
v_lshlrev_b32 v242, 16, v101
v_and_b32 v248, 0xffff0000, v101
v_mul_f32 v242, v242, v239
v_mul_f32 v248, v248, v239
v_cvt_pk_bf16_f32 v101, v242, v248
v_lshlrev_b32 v242, 16, v102
v_and_b32 v248, 0xffff0000, v102
v_mul_f32 v242, v242, v239
v_mul_f32 v248, v248, v239
v_cvt_pk_bf16_f32 v102, v242, v248
v_lshlrev_b32 v242, 16, v103
v_and_b32 v248, 0xffff0000, v103
v_mul_f32 v242, v242, v239
v_mul_f32 v248, v248, v239
v_cvt_pk_bf16_f32 v103, v242, v248
v_lshlrev_b32 v242, 16, v104
v_and_b32 v248, 0xffff0000, v104
v_mul_f32 v242, v242, v239
v_mul_f32 v248, v248, v239
v_cvt_pk_bf16_f32 v104, v242, v248
v_lshlrev_b32 v242, 16, v105
v_and_b32 v248, 0xffff0000, v105
v_mul_f32 v242, v242, v239
v_mul_f32 v248, v248, v239
v_cvt_pk_bf16_f32 v105, v242, v248
v_lshlrev_b32 v242, 16, v106
v_and_b32 v248, 0xffff0000, v106
v_mul_f32 v242, v242, v239
v_mul_f32 v248, v248, v239
v_cvt_pk_bf16_f32 v106, v242, v248
v_lshlrev_b32 v242, 16, v107
v_and_b32 v248, 0xffff0000, v107
v_mul_f32 v242, v242, v239
v_mul_f32 v248, v248, v239
v_cvt_pk_bf16_f32 v107, v242, v248
v_lshlrev_b32 v242, 16, v172
v_and_b32 v248, 0xffff0000, v172
v_mul_f32 v242, v242, v239
v_mul_f32 v248, v248, v239
v_cvt_pk_bf16_f32 v172, v242, v248
v_lshlrev_b32 v242, 16, v173
v_and_b32 v248, 0xffff0000, v173
v_mul_f32 v242, v242, v239
v_mul_f32 v248, v248, v239
v_cvt_pk_bf16_f32 v173, v242, v248
v_lshlrev_b32 v242, 16, v174
v_and_b32 v248, 0xffff0000, v174
v_mul_f32 v242, v242, v239
v_mul_f32 v248, v248, v239
v_cvt_pk_bf16_f32 v174, v242, v248
v_lshlrev_b32 v242, 16, v175
v_and_b32 v248, 0xffff0000, v175
v_mul_f32 v242, v242, v239
v_mul_f32 v248, v248, v239
v_cvt_pk_bf16_f32 v175, v242, v248
v_lshlrev_b32 v242, 16, v188
v_and_b32 v248, 0xffff0000, v188
v_mul_f32 v242, v242, v239
v_mul_f32 v248, v248, v239
v_cvt_pk_bf16_f32 v188, v242, v248
v_lshlrev_b32 v242, 16, v189
v_and_b32 v248, 0xffff0000, v189
v_mul_f32 v242, v242, v239
v_mul_f32 v248, v248, v239
v_cvt_pk_bf16_f32 v189, v242, v248
v_lshlrev_b32 v242, 16, v190
v_and_b32 v248, 0xffff0000, v190
v_mul_f32 v242, v242, v239
v_mul_f32 v248, v248, v239
v_cvt_pk_bf16_f32 v190, v242, v248
v_lshlrev_b32 v242, 16, v191
v_and_b32 v248, 0xffff0000, v191
v_mul_f32 v242, v242, v239
v_mul_f32 v248, v248, v239
v_cvt_pk_bf16_f32 v191, v242, v248
v_lshlrev_b32 v242, 16, v96
v_and_b32 v248, 0xffff0000, v96
v_mul_f32 v242, v242, v239
v_mul_f32 v248, v248, v239
v_cvt_pk_bf16_f32 v96, v242, v248
v_lshlrev_b32 v242, 16, v97
v_and_b32 v248, 0xffff0000, v97
v_mul_f32 v242, v242, v239
v_mul_f32 v248, v248, v239
v_cvt_pk_bf16_f32 v97, v242, v248
v_exp_f32 v232, v156
v_exp_f32 v233, v157
v_exp_f32 v234, v158
v_exp_f32 v235, v159
s_nop 1
v_cvt_pk_bf16_f32 v98, v232, v233
v_cvt_pk_bf16_f32 v99, v234, v235
s_branch L2_rare_common
LF_hl_0:
s_mov_b32 s94, 0x10000
s_mov_b32 s3, 0x7c28000
LF_hl2_0:
v_lshlrev_b32 v241, 3, v243
buffer_load_dwordx2 v[240:241], v241, s[16:19], s3 offen sc1
s_sub_u32 s94, s94, 1
s_waitcnt vmcnt(0)
s_cbranch_scc1 LF_hlret_0
v_cmp_ne_u64_e64 s[38:39], s[98:99], v[240:241]
s_and_b64 s[38:39], s[38:39], s[96:97]
s_cbranch_scc1 LF_hl2_0
s_branch LF_hlret_0
L2_rare_common:
v_lshrrev_b32 v232, 4, v243
v_and_b32 v232, 0x30, v232
ds_bpermute_b32 v242, v232, v236 offset:0
ds_bpermute_b32 v248, v232, v236 offset:4
ds_bpermute_b32 v250, v232, v236 offset:8
ds_bpermute_b32 v251, v232, v236 offset:12
s_waitcnt lgkmcnt(0)
v_accvgpr_read_b32 v232, a0
v_accvgpr_read_b32 v233, a1
v_accvgpr_read_b32 v234, a2
v_accvgpr_read_b32 v235, a3
v_mul_f32 v232, v232, v242
v_mul_f32 v233, v233, v248
v_mul_f32 v234, v234, v250
v_mul_f32 v235, v235, v251
v_accvgpr_write_b32 a0, v232
v_accvgpr_write_b32 a1, v233
v_accvgpr_write_b32 a2, v234
v_accvgpr_write_b32 a3, v235
v_accvgpr_read_b32 v232, a16
v_accvgpr_read_b32 v233, a17
v_accvgpr_read_b32 v234, a18
v_accvgpr_read_b32 v235, a19
v_mul_f32 v232, v232, v242
v_mul_f32 v233, v233, v248
v_mul_f32 v234, v234, v250
v_mul_f32 v235, v235, v251
v_accvgpr_write_b32 a16, v232
v_accvgpr_write_b32 a17, v233
v_accvgpr_write_b32 a18, v234
v_accvgpr_write_b32 a19, v235
v_accvgpr_read_b32 v232, a32
v_accvgpr_read_b32 v233, a33
v_accvgpr_read_b32 v234, a34
v_accvgpr_read_b32 v235, a35
v_mul_f32 v232, v232, v242
v_mul_f32 v233, v233, v248
v_mul_f32 v234, v234, v250
v_mul_f32 v235, v235, v251
v_accvgpr_write_b32 a32, v232
v_accvgpr_write_b32 a33, v233
v_accvgpr_write_b32 a34, v234
v_accvgpr_write_b32 a35, v235
v_accvgpr_read_b32 v232, a48
v_accvgpr_read_b32 v233, a49
v_accvgpr_read_b32 v234, a50
v_accvgpr_read_b32 v235, a51
v_mul_f32 v232, v232, v242
v_mul_f32 v233, v233, v248
v_mul_f32 v234, v234, v250
v_mul_f32 v235, v235, v251
v_accvgpr_write_b32 a48, v232
v_accvgpr_write_b32 a49, v233
v_accvgpr_write_b32 a50, v234
v_accvgpr_write_b32 a51, v235
v_accvgpr_read_b32 v232, a64
v_accvgpr_read_b32 v233, a65
v_accvgpr_read_b32 v234, a66
v_accvgpr_read_b32 v235, a67
v_mul_f32 v232, v232, v242
v_mul_f32 v233, v233, v248
v_mul_f32 v234, v234, v250
v_mul_f32 v235, v235, v251
v_accvgpr_write_b32 a64, v232
v_accvgpr_write_b32 a65, v233
v_accvgpr_write_b32 a66, v234
v_accvgpr_write_b32 a67, v235
v_accvgpr_read_b32 v232, a80
v_accvgpr_read_b32 v233, a81
v_accvgpr_read_b32 v234, a82
v_accvgpr_read_b32 v235, a83
v_mul_f32 v232, v232, v242
v_mul_f32 v233, v233, v248
v_mul_f32 v234, v234, v250
v_mul_f32 v235, v235, v251
v_accvgpr_write_b32 a80, v232
v_accvgpr_write_b32 a81, v233
v_accvgpr_write_b32 a82, v234
v_accvgpr_write_b32 a83, v235
v_accvgpr_read_b32 v232, a96
v_accvgpr_read_b32 v233, a97
v_accvgpr_read_b32 v234, a98
v_accvgpr_read_b32 v235, a99
v_mul_f32 v232, v232, v242
v_mul_f32 v233, v233, v248
v_mul_f32 v234, v234, v250
v_mul_f32 v235, v235, v251
v_accvgpr_write_b32 a96, v232
v_accvgpr_write_b32 a97, v233
v_accvgpr_write_b32 a98, v234
v_accvgpr_write_b32 a99, v235
v_accvgpr_read_b32 v232, a112
v_accvgpr_read_b32 v233, a113
v_accvgpr_read_b32 v234, a114
v_accvgpr_read_b32 v235, a115
v_mul_f32 v232, v232, v242
v_mul_f32 v233, v233, v248
v_mul_f32 v234, v234, v250
v_mul_f32 v235, v235, v251
v_accvgpr_write_b32 a112, v232
v_accvgpr_write_b32 a113, v233
v_accvgpr_write_b32 a114, v234
v_accvgpr_write_b32 a115, v235
v_accvgpr_read_b32 v232, a128
v_accvgpr_read_b32 v233, a129
v_accvgpr_read_b32 v234, a130
v_accvgpr_read_b32 v235, a131
v_mul_f32 v232, v232, v242
v_mul_f32 v233, v233, v248
v_mul_f32 v234, v234, v250
v_mul_f32 v235, v235, v251
v_accvgpr_write_b32 a128, v232
v_accvgpr_write_b32 a129, v233
v_accvgpr_write_b32 a130, v234
v_accvgpr_write_b32 a131, v235
v_accvgpr_read_b32 v232, a144
v_accvgpr_read_b32 v233, a145
v_accvgpr_read_b32 v234, a146
v_accvgpr_read_b32 v235, a147
v_mul_f32 v232, v232, v242
v_mul_f32 v233, v233, v248
v_mul_f32 v234, v234, v250
v_mul_f32 v235, v235, v251
v_accvgpr_write_b32 a144, v232
v_accvgpr_write_b32 a145, v233
v_accvgpr_write_b32 a146, v234
v_accvgpr_write_b32 a147, v235
v_accvgpr_read_b32 v232, a160
v_accvgpr_read_b32 v233, a161
v_accvgpr_read_b32 v234, a162
v_accvgpr_read_b32 v235, a163
v_mul_f32 v232, v232, v242
v_mul_f32 v233, v233, v248
v_mul_f32 v234, v234, v250
v_mul_f32 v235, v235, v251
v_accvgpr_write_b32 a160, v232
v_accvgpr_write_b32 a161, v233
v_accvgpr_write_b32 a162, v234
v_accvgpr_write_b32 a163, v235
v_accvgpr_read_b32 v232, a176
v_accvgpr_read_b32 v233, a177
v_accvgpr_read_b32 v234, a178
v_accvgpr_read_b32 v235, a179
v_mul_f32 v232, v232, v242
v_mul_f32 v233, v233, v248
v_mul_f32 v234, v234, v250
v_mul_f32 v235, v235, v251
v_accvgpr_write_b32 a176, v232
v_accvgpr_write_b32 a177, v233
v_accvgpr_write_b32 a178, v234
v_accvgpr_write_b32 a179, v235
v_accvgpr_read_b32 v232, a192
v_accvgpr_read_b32 v233, a193
v_accvgpr_read_b32 v234, a194
v_accvgpr_read_b32 v235, a195
v_mul_f32 v232, v232, v242
v_mul_f32 v233, v233, v248
v_mul_f32 v234, v234, v250
v_mul_f32 v235, v235, v251
v_accvgpr_write_b32 a192, v232
v_accvgpr_write_b32 a193, v233
v_accvgpr_write_b32 a194, v234
v_accvgpr_write_b32 a195, v235
v_accvgpr_read_b32 v232, a208
v_accvgpr_read_b32 v233, a209
v_accvgpr_read_b32 v234, a210
v_accvgpr_read_b32 v235, a211
v_mul_f32 v232, v232, v242
v_mul_f32 v233, v233, v248
v_mul_f32 v234, v234, v250
v_mul_f32 v235, v235, v251
v_accvgpr_write_b32 a208, v232
v_accvgpr_write_b32 a209, v233
v_accvgpr_write_b32 a210, v234
v_accvgpr_write_b32 a211, v235
v_accvgpr_read_b32 v232, a224
v_accvgpr_read_b32 v233, a225
v_accvgpr_read_b32 v234, a226
v_accvgpr_read_b32 v235, a227
v_mul_f32 v232, v232, v242
v_mul_f32 v233, v233, v248
v_mul_f32 v234, v234, v250
v_mul_f32 v235, v235, v251
v_accvgpr_write_b32 a224, v232
v_accvgpr_write_b32 a225, v233
v_accvgpr_write_b32 a226, v234
v_accvgpr_write_b32 a227, v235
v_accvgpr_read_b32 v232, a240
v_accvgpr_read_b32 v233, a241
v_accvgpr_read_b32 v234, a242
v_accvgpr_read_b32 v235, a243
v_mul_f32 v232, v232, v242
v_mul_f32 v233, v233, v248
v_mul_f32 v234, v234, v250
v_mul_f32 v235, v235, v251
v_accvgpr_write_b32 a240, v232
v_accvgpr_write_b32 a241, v233
v_accvgpr_write_b32 a242, v234
v_accvgpr_write_b32 a243, v235
v_lshrrev_b32 v232, 4, v243
v_and_b32 v232, 0x30, v232
ds_bpermute_b32 v242, v232, v237 offset:0
ds_bpermute_b32 v248, v232, v237 offset:4
ds_bpermute_b32 v250, v232, v237 offset:8
ds_bpermute_b32 v251, v232, v237 offset:12
s_waitcnt lgkmcnt(0)
v_accvgpr_read_b32 v232, a4
v_accvgpr_read_b32 v233, a5
v_accvgpr_read_b32 v234, a6
v_accvgpr_read_b32 v235, a7
v_mul_f32 v232, v232, v242
v_mul_f32 v233, v233, v248
v_mul_f32 v234, v234, v250
v_mul_f32 v235, v235, v251
v_accvgpr_write_b32 a4, v232
v_accvgpr_write_b32 a5, v233
v_accvgpr_write_b32 a6, v234
v_accvgpr_write_b32 a7, v235
v_accvgpr_read_b32 v232, a20
v_accvgpr_read_b32 v233, a21
v_accvgpr_read_b32 v234, a22
v_accvgpr_read_b32 v235, a23
v_mul_f32 v232, v232, v242
v_mul_f32 v233, v233, v248
v_mul_f32 v234, v234, v250
v_mul_f32 v235, v235, v251
v_accvgpr_write_b32 a20, v232
v_accvgpr_write_b32 a21, v233
v_accvgpr_write_b32 a22, v234
v_accvgpr_write_b32 a23, v235
v_accvgpr_read_b32 v232, a36
v_accvgpr_read_b32 v233, a37
v_accvgpr_read_b32 v234, a38
v_accvgpr_read_b32 v235, a39
v_mul_f32 v232, v232, v242
v_mul_f32 v233, v233, v248
v_mul_f32 v234, v234, v250
v_mul_f32 v235, v235, v251
v_accvgpr_write_b32 a36, v232
v_accvgpr_write_b32 a37, v233
v_accvgpr_write_b32 a38, v234
v_accvgpr_write_b32 a39, v235
v_accvgpr_read_b32 v232, a52
v_accvgpr_read_b32 v233, a53
v_accvgpr_read_b32 v234, a54
v_accvgpr_read_b32 v235, a55
v_mul_f32 v232, v232, v242
v_mul_f32 v233, v233, v248
v_mul_f32 v234, v234, v250
v_mul_f32 v235, v235, v251
v_accvgpr_write_b32 a52, v232
v_accvgpr_write_b32 a53, v233
v_accvgpr_write_b32 a54, v234
v_accvgpr_write_b32 a55, v235
v_accvgpr_read_b32 v232, a68
v_accvgpr_read_b32 v233, a69
v_accvgpr_read_b32 v234, a70
v_accvgpr_read_b32 v235, a71
v_mul_f32 v232, v232, v242
v_mul_f32 v233, v233, v248
v_mul_f32 v234, v234, v250
v_mul_f32 v235, v235, v251
v_accvgpr_write_b32 a68, v232
v_accvgpr_write_b32 a69, v233
v_accvgpr_write_b32 a70, v234
v_accvgpr_write_b32 a71, v235
v_accvgpr_read_b32 v232, a84
v_accvgpr_read_b32 v233, a85
v_accvgpr_read_b32 v234, a86
v_accvgpr_read_b32 v235, a87
v_mul_f32 v232, v232, v242
v_mul_f32 v233, v233, v248
v_mul_f32 v234, v234, v250
v_mul_f32 v235, v235, v251
v_accvgpr_write_b32 a84, v232
v_accvgpr_write_b32 a85, v233
v_accvgpr_write_b32 a86, v234
v_accvgpr_write_b32 a87, v235
v_accvgpr_read_b32 v232, a100
v_accvgpr_read_b32 v233, a101
v_accvgpr_read_b32 v234, a102
v_accvgpr_read_b32 v235, a103
v_mul_f32 v232, v232, v242
v_mul_f32 v233, v233, v248
v_mul_f32 v234, v234, v250
v_mul_f32 v235, v235, v251
v_accvgpr_write_b32 a100, v232
v_accvgpr_write_b32 a101, v233
v_accvgpr_write_b32 a102, v234
v_accvgpr_write_b32 a103, v235
v_accvgpr_read_b32 v232, a116
v_accvgpr_read_b32 v233, a117
v_accvgpr_read_b32 v234, a118
v_accvgpr_read_b32 v235, a119
v_mul_f32 v232, v232, v242
v_mul_f32 v233, v233, v248
v_mul_f32 v234, v234, v250
v_mul_f32 v235, v235, v251
v_accvgpr_write_b32 a116, v232
v_accvgpr_write_b32 a117, v233
v_accvgpr_write_b32 a118, v234
v_accvgpr_write_b32 a119, v235
v_accvgpr_read_b32 v232, a132
v_accvgpr_read_b32 v233, a133
v_accvgpr_read_b32 v234, a134
v_accvgpr_read_b32 v235, a135
v_mul_f32 v232, v232, v242
v_mul_f32 v233, v233, v248
v_mul_f32 v234, v234, v250
v_mul_f32 v235, v235, v251
v_accvgpr_write_b32 a132, v232
v_accvgpr_write_b32 a133, v233
v_accvgpr_write_b32 a134, v234
v_accvgpr_write_b32 a135, v235
v_accvgpr_read_b32 v232, a148
v_accvgpr_read_b32 v233, a149
v_accvgpr_read_b32 v234, a150
v_accvgpr_read_b32 v235, a151
v_mul_f32 v232, v232, v242
v_mul_f32 v233, v233, v248
v_mul_f32 v234, v234, v250
v_mul_f32 v235, v235, v251
v_accvgpr_write_b32 a148, v232
v_accvgpr_write_b32 a149, v233
v_accvgpr_write_b32 a150, v234
v_accvgpr_write_b32 a151, v235
v_accvgpr_read_b32 v232, a164
v_accvgpr_read_b32 v233, a165
v_accvgpr_read_b32 v234, a166
v_accvgpr_read_b32 v235, a167
v_mul_f32 v232, v232, v242
v_mul_f32 v233, v233, v248
v_mul_f32 v234, v234, v250
v_mul_f32 v235, v235, v251
v_accvgpr_write_b32 a164, v232
v_accvgpr_write_b32 a165, v233
v_accvgpr_write_b32 a166, v234
v_accvgpr_write_b32 a167, v235
v_accvgpr_read_b32 v232, a180
v_accvgpr_read_b32 v233, a181
v_accvgpr_read_b32 v234, a182
v_accvgpr_read_b32 v235, a183
v_mul_f32 v232, v232, v242
v_mul_f32 v233, v233, v248
v_mul_f32 v234, v234, v250
v_mul_f32 v235, v235, v251
v_accvgpr_write_b32 a180, v232
v_accvgpr_write_b32 a181, v233
v_accvgpr_write_b32 a182, v234
v_accvgpr_write_b32 a183, v235
v_accvgpr_read_b32 v232, a196
v_accvgpr_read_b32 v233, a197
v_accvgpr_read_b32 v234, a198
v_accvgpr_read_b32 v235, a199
v_mul_f32 v232, v232, v242
v_mul_f32 v233, v233, v248
v_mul_f32 v234, v234, v250
v_mul_f32 v235, v235, v251
v_accvgpr_write_b32 a196, v232
v_accvgpr_write_b32 a197, v233
v_accvgpr_write_b32 a198, v234
v_accvgpr_write_b32 a199, v235
v_accvgpr_read_b32 v232, a212
v_accvgpr_read_b32 v233, a213
v_accvgpr_read_b32 v234, a214
v_accvgpr_read_b32 v235, a215
v_mul_f32 v232, v232, v242
v_mul_f32 v233, v233, v248
v_mul_f32 v234, v234, v250
v_mul_f32 v235, v235, v251
v_accvgpr_write_b32 a212, v232
v_accvgpr_write_b32 a213, v233
v_accvgpr_write_b32 a214, v234
v_accvgpr_write_b32 a215, v235
v_accvgpr_read_b32 v232, a228
v_accvgpr_read_b32 v233, a229
v_accvgpr_read_b32 v234, a230
v_accvgpr_read_b32 v235, a231
v_mul_f32 v232, v232, v242
v_mul_f32 v233, v233, v248
v_mul_f32 v234, v234, v250
v_mul_f32 v235, v235, v251
v_accvgpr_write_b32 a228, v232
v_accvgpr_write_b32 a229, v233
v_accvgpr_write_b32 a230, v234
v_accvgpr_write_b32 a231, v235
v_accvgpr_read_b32 v232, a244
v_accvgpr_read_b32 v233, a245
v_accvgpr_read_b32 v234, a246
v_accvgpr_read_b32 v235, a247
v_mul_f32 v232, v232, v242
v_mul_f32 v233, v233, v248
v_mul_f32 v234, v234, v250
v_mul_f32 v235, v235, v251
v_accvgpr_write_b32 a244, v232
v_accvgpr_write_b32 a245, v233
v_accvgpr_write_b32 a246, v234
v_accvgpr_write_b32 a247, v235
v_lshrrev_b32 v232, 4, v243
v_and_b32 v232, 0x30, v232
ds_bpermute_b32 v242, v232, v238 offset:0
ds_bpermute_b32 v248, v232, v238 offset:4
ds_bpermute_b32 v250, v232, v238 offset:8
ds_bpermute_b32 v251, v232, v238 offset:12
s_waitcnt lgkmcnt(0)
v_accvgpr_read_b32 v232, a8
v_accvgpr_read_b32 v233, a9
v_accvgpr_read_b32 v234, a10
v_accvgpr_read_b32 v235, a11
v_mul_f32 v232, v232, v242
v_mul_f32 v233, v233, v248
v_mul_f32 v234, v234, v250
v_mul_f32 v235, v235, v251
v_accvgpr_write_b32 a8, v232
v_accvgpr_write_b32 a9, v233
v_accvgpr_write_b32 a10, v234
v_accvgpr_write_b32 a11, v235
v_accvgpr_read_b32 v232, a24
v_accvgpr_read_b32 v233, a25
v_accvgpr_read_b32 v234, a26
v_accvgpr_read_b32 v235, a27
v_mul_f32 v232, v232, v242
v_mul_f32 v233, v233, v248
v_mul_f32 v234, v234, v250
v_mul_f32 v235, v235, v251
v_accvgpr_write_b32 a24, v232
v_accvgpr_write_b32 a25, v233
v_accvgpr_write_b32 a26, v234
v_accvgpr_write_b32 a27, v235
v_accvgpr_read_b32 v232, a40
v_accvgpr_read_b32 v233, a41
v_accvgpr_read_b32 v234, a42
v_accvgpr_read_b32 v235, a43
v_mul_f32 v232, v232, v242
v_mul_f32 v233, v233, v248
v_mul_f32 v234, v234, v250
v_mul_f32 v235, v235, v251
v_accvgpr_write_b32 a40, v232
v_accvgpr_write_b32 a41, v233
v_accvgpr_write_b32 a42, v234
v_accvgpr_write_b32 a43, v235
v_accvgpr_read_b32 v232, a56
v_accvgpr_read_b32 v233, a57
v_accvgpr_read_b32 v234, a58
v_accvgpr_read_b32 v235, a59
v_mul_f32 v232, v232, v242
v_mul_f32 v233, v233, v248
v_mul_f32 v234, v234, v250
v_mul_f32 v235, v235, v251
v_accvgpr_write_b32 a56, v232
v_accvgpr_write_b32 a57, v233
v_accvgpr_write_b32 a58, v234
v_accvgpr_write_b32 a59, v235
v_accvgpr_read_b32 v232, a72
v_accvgpr_read_b32 v233, a73
v_accvgpr_read_b32 v234, a74
v_accvgpr_read_b32 v235, a75
v_mul_f32 v232, v232, v242
v_mul_f32 v233, v233, v248
v_mul_f32 v234, v234, v250
v_mul_f32 v235, v235, v251
v_accvgpr_write_b32 a72, v232
v_accvgpr_write_b32 a73, v233
v_accvgpr_write_b32 a74, v234
v_accvgpr_write_b32 a75, v235
v_accvgpr_read_b32 v232, a88
v_accvgpr_read_b32 v233, a89
v_accvgpr_read_b32 v234, a90
v_accvgpr_read_b32 v235, a91
v_mul_f32 v232, v232, v242
v_mul_f32 v233, v233, v248
v_mul_f32 v234, v234, v250
v_mul_f32 v235, v235, v251
v_accvgpr_write_b32 a88, v232
v_accvgpr_write_b32 a89, v233
v_accvgpr_write_b32 a90, v234
v_accvgpr_write_b32 a91, v235
v_accvgpr_read_b32 v232, a104
v_accvgpr_read_b32 v233, a105
v_accvgpr_read_b32 v234, a106
v_accvgpr_read_b32 v235, a107
v_mul_f32 v232, v232, v242
v_mul_f32 v233, v233, v248
v_mul_f32 v234, v234, v250
v_mul_f32 v235, v235, v251
v_accvgpr_write_b32 a104, v232
v_accvgpr_write_b32 a105, v233
v_accvgpr_write_b32 a106, v234
v_accvgpr_write_b32 a107, v235
v_accvgpr_read_b32 v232, a120
v_accvgpr_read_b32 v233, a121
v_accvgpr_read_b32 v234, a122
v_accvgpr_read_b32 v235, a123
v_mul_f32 v232, v232, v242
v_mul_f32 v233, v233, v248
v_mul_f32 v234, v234, v250
v_mul_f32 v235, v235, v251
v_accvgpr_write_b32 a120, v232
v_accvgpr_write_b32 a121, v233
v_accvgpr_write_b32 a122, v234
v_accvgpr_write_b32 a123, v235
v_accvgpr_read_b32 v232, a136
v_accvgpr_read_b32 v233, a137
v_accvgpr_read_b32 v234, a138
v_accvgpr_read_b32 v235, a139
v_mul_f32 v232, v232, v242
v_mul_f32 v233, v233, v248
v_mul_f32 v234, v234, v250
v_mul_f32 v235, v235, v251
v_accvgpr_write_b32 a136, v232
v_accvgpr_write_b32 a137, v233
v_accvgpr_write_b32 a138, v234
v_accvgpr_write_b32 a139, v235
v_accvgpr_read_b32 v232, a152
v_accvgpr_read_b32 v233, a153
v_accvgpr_read_b32 v234, a154
v_accvgpr_read_b32 v235, a155
v_mul_f32 v232, v232, v242
v_mul_f32 v233, v233, v248
v_mul_f32 v234, v234, v250
v_mul_f32 v235, v235, v251
v_accvgpr_write_b32 a152, v232
v_accvgpr_write_b32 a153, v233
v_accvgpr_write_b32 a154, v234
v_accvgpr_write_b32 a155, v235
v_accvgpr_read_b32 v232, a168
v_accvgpr_read_b32 v233, a169
v_accvgpr_read_b32 v234, a170
v_accvgpr_read_b32 v235, a171
v_mul_f32 v232, v232, v242
v_mul_f32 v233, v233, v248
v_mul_f32 v234, v234, v250
v_mul_f32 v235, v235, v251
v_accvgpr_write_b32 a168, v232
v_accvgpr_write_b32 a169, v233
v_accvgpr_write_b32 a170, v234
v_accvgpr_write_b32 a171, v235
v_accvgpr_read_b32 v232, a184
v_accvgpr_read_b32 v233, a185
v_accvgpr_read_b32 v234, a186
v_accvgpr_read_b32 v235, a187
v_mul_f32 v232, v232, v242
v_mul_f32 v233, v233, v248
v_mul_f32 v234, v234, v250
v_mul_f32 v235, v235, v251
v_accvgpr_write_b32 a184, v232
v_accvgpr_write_b32 a185, v233
v_accvgpr_write_b32 a186, v234
v_accvgpr_write_b32 a187, v235
v_accvgpr_read_b32 v232, a200
v_accvgpr_read_b32 v233, a201
v_accvgpr_read_b32 v234, a202
v_accvgpr_read_b32 v235, a203
v_mul_f32 v232, v232, v242
v_mul_f32 v233, v233, v248
v_mul_f32 v234, v234, v250
v_mul_f32 v235, v235, v251
v_accvgpr_write_b32 a200, v232
v_accvgpr_write_b32 a201, v233
v_accvgpr_write_b32 a202, v234
v_accvgpr_write_b32 a203, v235
v_accvgpr_read_b32 v232, a216
v_accvgpr_read_b32 v233, a217
v_accvgpr_read_b32 v234, a218
v_accvgpr_read_b32 v235, a219
v_mul_f32 v232, v232, v242
v_mul_f32 v233, v233, v248
v_mul_f32 v234, v234, v250
v_mul_f32 v235, v235, v251
v_accvgpr_write_b32 a216, v232
v_accvgpr_write_b32 a217, v233
v_accvgpr_write_b32 a218, v234
v_accvgpr_write_b32 a219, v235
v_accvgpr_read_b32 v232, a232
v_accvgpr_read_b32 v233, a233
v_accvgpr_read_b32 v234, a234
v_accvgpr_read_b32 v235, a235
v_mul_f32 v232, v232, v242
v_mul_f32 v233, v233, v248
v_mul_f32 v234, v234, v250
v_mul_f32 v235, v235, v251
v_accvgpr_write_b32 a232, v232
v_accvgpr_write_b32 a233, v233
v_accvgpr_write_b32 a234, v234
v_accvgpr_write_b32 a235, v235
v_accvgpr_read_b32 v232, a248
v_accvgpr_read_b32 v233, a249
v_accvgpr_read_b32 v234, a250
v_accvgpr_read_b32 v235, a251
v_mul_f32 v232, v232, v242
v_mul_f32 v233, v233, v248
v_mul_f32 v234, v234, v250
v_mul_f32 v235, v235, v251
v_accvgpr_write_b32 a248, v232
v_accvgpr_write_b32 a249, v233
v_accvgpr_write_b32 a250, v234
v_accvgpr_write_b32 a251, v235
v_lshrrev_b32 v232, 4, v243
v_and_b32 v232, 0x30, v232
ds_bpermute_b32 v242, v232, v239 offset:0
ds_bpermute_b32 v248, v232, v239 offset:4
ds_bpermute_b32 v250, v232, v239 offset:8
ds_bpermute_b32 v251, v232, v239 offset:12
s_waitcnt lgkmcnt(0)
v_accvgpr_read_b32 v232, a12
v_accvgpr_read_b32 v233, a13
v_accvgpr_read_b32 v234, a14
v_accvgpr_read_b32 v235, a15
v_mul_f32 v232, v232, v242
v_mul_f32 v233, v233, v248
v_mul_f32 v234, v234, v250
v_mul_f32 v235, v235, v251
v_accvgpr_write_b32 a12, v232
v_accvgpr_write_b32 a13, v233
v_accvgpr_write_b32 a14, v234
v_accvgpr_write_b32 a15, v235
v_accvgpr_read_b32 v232, a28
v_accvgpr_read_b32 v233, a29
v_accvgpr_read_b32 v234, a30
v_accvgpr_read_b32 v235, a31
v_mul_f32 v232, v232, v242
v_mul_f32 v233, v233, v248
v_mul_f32 v234, v234, v250
v_mul_f32 v235, v235, v251
v_accvgpr_write_b32 a28, v232
v_accvgpr_write_b32 a29, v233
v_accvgpr_write_b32 a30, v234
v_accvgpr_write_b32 a31, v235
v_accvgpr_read_b32 v232, a44
v_accvgpr_read_b32 v233, a45
v_accvgpr_read_b32 v234, a46
v_accvgpr_read_b32 v235, a47
v_mul_f32 v232, v232, v242
v_mul_f32 v233, v233, v248
v_mul_f32 v234, v234, v250
v_mul_f32 v235, v235, v251
v_accvgpr_write_b32 a44, v232
v_accvgpr_write_b32 a45, v233
v_accvgpr_write_b32 a46, v234
v_accvgpr_write_b32 a47, v235
v_accvgpr_read_b32 v232, a60
v_accvgpr_read_b32 v233, a61
v_accvgpr_read_b32 v234, a62
v_accvgpr_read_b32 v235, a63
v_mul_f32 v232, v232, v242
v_mul_f32 v233, v233, v248
v_mul_f32 v234, v234, v250
v_mul_f32 v235, v235, v251
v_accvgpr_write_b32 a60, v232
v_accvgpr_write_b32 a61, v233
v_accvgpr_write_b32 a62, v234
v_accvgpr_write_b32 a63, v235
v_accvgpr_read_b32 v232, a76
v_accvgpr_read_b32 v233, a77
v_accvgpr_read_b32 v234, a78
v_accvgpr_read_b32 v235, a79
v_mul_f32 v232, v232, v242
v_mul_f32 v233, v233, v248
v_mul_f32 v234, v234, v250
v_mul_f32 v235, v235, v251
v_accvgpr_write_b32 a76, v232
v_accvgpr_write_b32 a77, v233
v_accvgpr_write_b32 a78, v234
v_accvgpr_write_b32 a79, v235
v_accvgpr_read_b32 v232, a92
v_accvgpr_read_b32 v233, a93
v_accvgpr_read_b32 v234, a94
v_accvgpr_read_b32 v235, a95
v_mul_f32 v232, v232, v242
v_mul_f32 v233, v233, v248
v_mul_f32 v234, v234, v250
v_mul_f32 v235, v235, v251
v_accvgpr_write_b32 a92, v232
v_accvgpr_write_b32 a93, v233
v_accvgpr_write_b32 a94, v234
v_accvgpr_write_b32 a95, v235
v_accvgpr_read_b32 v232, a108
v_accvgpr_read_b32 v233, a109
v_accvgpr_read_b32 v234, a110
v_accvgpr_read_b32 v235, a111
v_mul_f32 v232, v232, v242
v_mul_f32 v233, v233, v248
v_mul_f32 v234, v234, v250
v_mul_f32 v235, v235, v251
v_accvgpr_write_b32 a108, v232
v_accvgpr_write_b32 a109, v233
v_accvgpr_write_b32 a110, v234
v_accvgpr_write_b32 a111, v235
v_accvgpr_read_b32 v232, a124
v_accvgpr_read_b32 v233, a125
v_accvgpr_read_b32 v234, a126
v_accvgpr_read_b32 v235, a127
v_mul_f32 v232, v232, v242
v_mul_f32 v233, v233, v248
v_mul_f32 v234, v234, v250
v_mul_f32 v235, v235, v251
v_accvgpr_write_b32 a124, v232
v_accvgpr_write_b32 a125, v233
v_accvgpr_write_b32 a126, v234
v_accvgpr_write_b32 a127, v235
v_accvgpr_read_b32 v232, a140
v_accvgpr_read_b32 v233, a141
v_accvgpr_read_b32 v234, a142
v_accvgpr_read_b32 v235, a143
v_mul_f32 v232, v232, v242
v_mul_f32 v233, v233, v248
v_mul_f32 v234, v234, v250
v_mul_f32 v235, v235, v251
v_accvgpr_write_b32 a140, v232
v_accvgpr_write_b32 a141, v233
v_accvgpr_write_b32 a142, v234
v_accvgpr_write_b32 a143, v235
v_accvgpr_read_b32 v232, a156
v_accvgpr_read_b32 v233, a157
v_accvgpr_read_b32 v234, a158
v_accvgpr_read_b32 v235, a159
v_mul_f32 v232, v232, v242
v_mul_f32 v233, v233, v248
v_mul_f32 v234, v234, v250
v_mul_f32 v235, v235, v251
v_accvgpr_write_b32 a156, v232
v_accvgpr_write_b32 a157, v233
v_accvgpr_write_b32 a158, v234
v_accvgpr_write_b32 a159, v235
v_accvgpr_read_b32 v232, a172
v_accvgpr_read_b32 v233, a173
v_accvgpr_read_b32 v234, a174
v_accvgpr_read_b32 v235, a175
v_mul_f32 v232, v232, v242
v_mul_f32 v233, v233, v248
v_mul_f32 v234, v234, v250
v_mul_f32 v235, v235, v251
v_accvgpr_write_b32 a172, v232
v_accvgpr_write_b32 a173, v233
v_accvgpr_write_b32 a174, v234
v_accvgpr_write_b32 a175, v235
v_accvgpr_read_b32 v232, a188
v_accvgpr_read_b32 v233, a189
v_accvgpr_read_b32 v234, a190
v_accvgpr_read_b32 v235, a191
v_mul_f32 v232, v232, v242
v_mul_f32 v233, v233, v248
v_mul_f32 v234, v234, v250
v_mul_f32 v235, v235, v251
v_accvgpr_write_b32 a188, v232
v_accvgpr_write_b32 a189, v233
v_accvgpr_write_b32 a190, v234
v_accvgpr_write_b32 a191, v235
v_accvgpr_read_b32 v232, a204
v_accvgpr_read_b32 v233, a205
v_accvgpr_read_b32 v234, a206
v_accvgpr_read_b32 v235, a207
v_mul_f32 v232, v232, v242
v_mul_f32 v233, v233, v248
v_mul_f32 v234, v234, v250
v_mul_f32 v235, v235, v251
v_accvgpr_write_b32 a204, v232
v_accvgpr_write_b32 a205, v233
v_accvgpr_write_b32 a206, v234
v_accvgpr_write_b32 a207, v235
v_accvgpr_read_b32 v232, a220
v_accvgpr_read_b32 v233, a221
v_accvgpr_read_b32 v234, a222
v_accvgpr_read_b32 v235, a223
v_mul_f32 v232, v232, v242
v_mul_f32 v233, v233, v248
v_mul_f32 v234, v234, v250
v_mul_f32 v235, v235, v251
v_accvgpr_write_b32 a220, v232
v_accvgpr_write_b32 a221, v233
v_accvgpr_write_b32 a222, v234
v_accvgpr_write_b32 a223, v235
v_accvgpr_read_b32 v232, a236
v_accvgpr_read_b32 v233, a237
v_accvgpr_read_b32 v234, a238
v_accvgpr_read_b32 v235, a239
v_mul_f32 v232, v232, v242
v_mul_f32 v233, v233, v248
v_mul_f32 v234, v234, v250
v_mul_f32 v235, v235, v251
v_accvgpr_write_b32 a236, v232
v_accvgpr_write_b32 a237, v233
v_accvgpr_write_b32 a238, v234
v_accvgpr_write_b32 a239, v235
v_accvgpr_read_b32 v232, a252
v_accvgpr_read_b32 v233, a253
v_accvgpr_read_b32 v234, a254
v_accvgpr_read_b32 v235, a255
v_mul_f32 v232, v232, v242
v_mul_f32 v233, v233, v248
v_mul_f32 v234, v234, v250
v_mul_f32 v235, v235, v251
v_accvgpr_write_b32 a252, v232
v_accvgpr_write_b32 a253, v233
v_accvgpr_write_b32 a254, v234
v_accvgpr_write_b32 a255, v235
s_nop 3
s_cmp_eq_u32 s36, 0
s_cbranch_scc1 L2_rr0
s_cmp_eq_u32 s36, 1
s_cbranch_scc1 L2_rr1
s_cmp_eq_u32 s36, 2
s_cbranch_scc1 L2_rr2
s_cmp_eq_u32 s36, 3
s_cbranch_scc1 L2_rr3
s_cmp_eq_u32 s36, 4
s_cbranch_scc1 L2_rr4
s_cmp_eq_u32 s36, 5
s_cbranch_scc1 L2_rr5
s_cmp_eq_u32 s36, 6
s_cbranch_scc1 L2_rr6
s_cmp_eq_u32 s36, 7
s_cbranch_scc1 L2_rr7
s_cmp_eq_u32 s36, 8
s_cbranch_scc1 L2_rr8
s_cmp_eq_u32 s36, 9
s_cbranch_scc1 L2_rr9
s_cmp_eq_u32 s36, 10
s_cbranch_scc1 L2_rr10
s_cmp_eq_u32 s36, 11
s_cbranch_scc1 L2_rr11
s_cmp_eq_u32 s36, 12
s_cbranch_scc1 L2_rr12
s_cmp_eq_u32 s36, 13
s_cbranch_scc1 L2_rr13
s_cmp_eq_u32 s36, 14
s_cbranch_scc1 L2_rr14
s_cmp_eq_u32 s36, 15
s_cbranch_scc1 L2_rr15
s_cmp_eq_u32 s36, 16
s_cbranch_scc1 L2_rr16
L2_rr17:
s_waitcnt lgkmcnt(0)
s_branch L2_ret17
L2_rr16:
s_waitcnt lgkmcnt(0)
s_branch L2_ret16
L2_rr15:
s_waitcnt lgkmcnt(0)
s_branch L2_ret15
L2_rr14:
s_waitcnt lgkmcnt(0)
s_branch L2_ret14
L2_rr13:
s_waitcnt lgkmcnt(0)
s_branch L2_ret13
L2_rr12:
s_waitcnt lgkmcnt(0)
s_branch L2_ret12
L2_rr11:
s_waitcnt lgkmcnt(0)
s_branch L2_ret11
L2_rr10:
s_waitcnt lgkmcnt(0)
s_branch L2_ret10
L2_rr9:
s_waitcnt lgkmcnt(0)
s_branch L2_ret9
L2_rr8:
s_waitcnt lgkmcnt(0)
s_branch L2_ret8
L2_rr7:
s_waitcnt lgkmcnt(0)
s_branch L2_ret7
L2_rr6:
s_waitcnt lgkmcnt(0)
s_branch L2_ret6
L2_rr5:
s_waitcnt lgkmcnt(0)
s_branch L2_ret5
L2_rr4:
s_waitcnt lgkmcnt(0)
s_branch L2_ret4
L2_rr3:
s_waitcnt lgkmcnt(0)
s_branch L2_ret3
L2_rr2:
s_waitcnt lgkmcnt(0)
s_branch L2_ret2
L2_rr1:
s_waitcnt lgkmcnt(0)
s_branch L2_ret1
L2_rr0:
s_waitcnt lgkmcnt(0)
s_branch L2_ret0
s_endpgm
.section .rodata,"a"
.p2align 6
.amdhsa_kernel standalone__hybrid_graph_tf_graphgps__graph_kernel
  .amdhsa_next_free_vgpr 512
  .amdhsa_next_free_sgpr 102
  .amdhsa_accum_offset 256
  .amdhsa_group_segment_fixed_size 0
  .amdhsa_kernarg_size 96
  .amdhsa_user_sgpr_count 2
  .amdhsa_user_sgpr_kernarg_segment_ptr 1
  .amdhsa_system_sgpr_workgroup_id_x 1
.end_amdhsa_kernel
```

```asm
; @launch grid=(256,1,1) block=(256,1,1) lds=163840
.amdgcn_target "amdgcn-amd-amdhsa--gfx950"
.text
.globl standalone__hybrid_graph_tf_graphgps__graph_kernel
.p2align 8
.type standalone__hybrid_graph_tf_graphgps__graph_kernel,@function
standalone__hybrid_graph_tf_graphgps__graph_kernel:
s_getpc_b64 s[56:57]
s_load_dwordx16 s[16:31], s[0:1], 0
s_load_dwordx8 s[32:39], s[0:1], 64
s_cmp_ge_u32 s2, 256
s_cbranch_scc1 L2_end
v_lshrrev_b32 v1, 6, v0
v_and_b32 v2, 63, v0
s_lshr_b32 s3, s2, 3
s_add_u32 s3, s3, 30
s_and_b32 s3, s3, 31
v_readfirstlane_b32 s60, v1
s_lshl_b32 s5, s3, 2
s_add_u32 s5, s5, s60
s_and_b32 s56, s56, 0xffffff00
s_mov_b32 s58, L2_hot-standalone__hybrid_graph_tf_graphgps__graph_kernel
s_mov_b32 s59, 0x00020000
s_and_b32 s6, s5, 15
s_lshl_b32 s6, s6, 13
s_cmp_lt_u32 s5, 32
s_cselect_b32 s6, s6, 0x7fff0000
v_lshlrev_b32 v10, 7, v2
buffer_load_dword v255, v10, s[56:59], s6 offen
v_and_b32 v3, 15, v2
v_lshrrev_b32 v4, 4, v2
s_and_b32 s62, s3, 7
s_mov_b64 s[14:15], 0
s_and_b32 s8, s2, 7
s_cmp_ge_u32 s3, 30
s_cbranch_scc1 LM_edge
s_mul_i32 s12, s3, 26
s_lshr_b32 s12, s12, 8
s_mul_i32 s9, s12, 10
s_sub_u32 s9, s3, s9
s_and_b32 s13, s8, 1
s_mul_i32 s13, s13, 3
s_add_u32 s13, s13, s12
s_and_b32 s12, s8, 1
s_mul_i32 s12, s12, 5
s_add_u32 s8, s8, s12
s_and_b32 s8, s8, 7
s_lshr_b32 s12, s8, 1
s_mul_i32 s12, s12, 10
s_add_u32 s12, s12, s9
s_mul_i32 s91, s12, 6
s_add_u32 s91, s91, s13
s_mov_b32 s61, 0
s_cmp_eq_u32 s12, 39
s_cbranch_scc1 LM_light
s_mul_i32 s14, s13, 3
s_min_u32 s14, s14, 14
s_lshl_b32 s9, s12, 4
s_add_u32 s14, s14, s9
s_lshl_b32 s14, s14, 13
s_cmp_eq_u32 s91, 233
s_cselect_b32 s9, 0, s13
s_cmp_lt_u32 s9, 4
s_cselect_b32 s15, 3, 2
s_lshl_b32 s15, s15, 13
s_add_u32 s15, s15, s14
v_lshlrev_b32 v16, 4, v2
s_mul_i32 s63, s60, 12288
s_mov_b32 s6, s14
s_mul_i32 s7, s60, 6144
s_add_u32 s64, s6, s7
s_add_u32 s65, s64, 4096
s_lshl_b32 s7, s60, 7
v_lshrrev_b32 v5, 3, v2
v_and_b32 v6, 7, v2
v_and_b32 v7, 2, v5
v_xor_b32 v6, v6, v7
v_lshl_add_u32 v5, v5, 9, s7
v_lshl_add_u32 v17, v6, 4, v5
v_xor_b32 v6, 4, v6
v_lshl_add_u32 v18, v6, 4, v5
v_add_u32 v18, 0xc00, v18
v_add_u32 v19, 0x1800, v17
v_add_u32 v20, 0x1800, v18
s_xor_b32 s6, s62, 0
s_lshl_b32 s66, s6, 14
s_xor_b32 s6, s62, 1
s_lshl_b32 s67, s6, 14
s_xor_b32 s6, s62, 2
s_lshl_b32 s68, s6, 14
s_xor_b32 s6, s62, 3
s_lshl_b32 s69, s6, 14
s_xor_b32 s6, s62, 4
s_lshl_b32 s70, s6, 14
s_xor_b32 s6, s62, 5
s_lshl_b32 s71, s6, 14
s_xor_b32 s6, s62, 6
s_lshl_b32 s72, s6, 14
s_xor_b32 s6, s62, 7
s_lshl_b32 s73, s6, 14
s_waitcnt lgkmcnt(0)
s_add_u32 s40, s16, 0x0
s_addc_u32 s41, s17, 0
s_mov_b32 s42, s15
s_mov_b32 s43, 0x00020000
s_add_u32 s44, s26, 0x0
s_addc_u32 s45, s27, 0
s_mov_b32 s46, 0x20000
s_mov_b32 s47, 0x00020000
buffer_load_dwordx4 v[44:47], v16, s[40:43], s64 offen offset:0
buffer_load_dwordx4 v[48:51], v16, s[40:43], s64 offen offset:1024
buffer_load_dwordx4 v[52:55], v16, s[40:43], s64 offen offset:2048
buffer_load_dwordx4 v[56:59], v16, s[40:43], s64 offen offset:3072
buffer_load_dwordx4 v[60:63], v16, s[40:43], s65 offen offset:0
buffer_load_dwordx4 v[64:67], v16, s[40:43], s65 offen offset:1024
s_add_u32 m0, s63, 0x0
s_nop 0
buffer_load_dwordx4 v17, s[44:47], s66 offen offset:0 lds
buffer_load_dwordx4 v18, s[44:47], s66 offen offset:1024 lds
buffer_load_dwordx4 v19, s[44:47], s66 offen offset:2048 lds
buffer_load_dwordx4 v20, s[44:47], s66 offen offset:3072 lds
s_add_u32 m0, s63, 0x1000
s_nop 0
buffer_load_dwordx4 v17, s[44:47], s67 offen offset:0 lds
buffer_load_dwordx4 v18, s[44:47], s67 offen offset:1024 lds
buffer_load_dwordx4 v19, s[44:47], s67 offen offset:2048 lds
buffer_load_dwordx4 v20, s[44:47], s67 offen offset:3072 lds
s_mov_b32 s98, 0x7c3ff80
s_load_dwordx2 s[98:99], s[38:39], s98
v_bfe_u32 v5, v2, 2, 3
v_xor_b32 v5, s62, v5
v_and_b32 v6, 3, v2
v_lshlrev_b32 v7, 10, v5
v_lshl_add_u32 v7, v6, 8, v7
v_add_u32 v7, 0xc000, v7
v_and_b32 v5, 1, v5
v_lshl_or_b32 v6, v5, 2, v6
v_lshrrev_b32 v5, 5, v2
s_mul_i32 s6, s60, 12
v_add3_u32 v8, v5, s6, 0
v_lshrrev_b32 v9, 4, v8
v_lshl_add_u32 v9, v9, 13, v7
v_and_b32 v8, 15, v8
v_xor_b32 v8, v8, v6
v_lshl_add_u32 v36, v8, 4, v9
v_add3_u32 v8, v5, s6, 2
v_lshrrev_b32 v9, 4, v8
v_lshl_add_u32 v9, v9, 13, v7
v_and_b32 v8, 15, v8
v_xor_b32 v8, v8, v6
v_lshl_add_u32 v37, v8, 4, v9
v_add3_u32 v8, v5, s6, 4
v_lshrrev_b32 v9, 4, v8
v_lshl_add_u32 v9, v9, 13, v7
v_and_b32 v8, 15, v8
v_xor_b32 v8, v8, v6
v_lshl_add_u32 v38, v8, 4, v9
v_add3_u32 v8, v5, s6, 6
v_lshrrev_b32 v9, 4, v8
v_lshl_add_u32 v9, v9, 13, v7
v_and_b32 v8, 15, v8
v_xor_b32 v8, v8, v6
v_lshl_add_u32 v39, v8, 4, v9
v_add3_u32 v8, v5, s6, 8
v_lshrrev_b32 v9, 4, v8
v_lshl_add_u32 v9, v9, 13, v7
v_and_b32 v8, 15, v8
v_xor_b32 v8, v8, v6
v_lshl_add_u32 v40, v8, 4, v9
v_add3_u32 v8, v5, s6, 10
v_lshrrev_b32 v9, 4, v8
v_lshl_add_u32 v9, v9, 13, v7
v_and_b32 v8, 15, v8
v_xor_b32 v8, v8, v6
v_lshl_add_u32 v41, v8, 4, v9
v_xor_b32 v5, v3, v4
v_lshlrev_b32 v5, 4, v5
v_lshl_add_u32 v5, v4, 8, v5
v_add_u32 v31, 0xc000, v5
v_xor_b32 v32, 64, v31
v_lshrrev_b32 v5, 2, v3
v_and_b32 v6, 3, v3
v_and_b32 v7, 1, v4
v_lshlrev_b32 v7, 2, v7
v_and_b32 v8, 2, v5
v_or_b32 v7, v7, v8
v_lshl_add_u32 v8, v4, 3, v5
v_lshlrev_b32 v8, 7, v8
v_add_u32 v8, s63, v8
v_and_b32 v9, 1, v6
v_lshl_add_u32 v8, v9, 3, v8
v_lshrrev_b32 v6, 1, v6
v_xor_b32 v6, v6, v7
v_xor_b32 v9, 0, v6
v_lshl_add_u32 v25, v9, 4, v8
v_xor_b32 v9, 2, v6
v_lshl_add_u32 v26, v9, 4, v8
v_xor_b32 v9, 4, v6
v_lshl_add_u32 v27, v9, 4, v8
v_xor_b32 v9, 6, v6
v_lshl_add_u32 v28, v9, 4, v8
v_lshrrev_b32 v5, 3, v2
v_and_b32 v6, 7, v2
v_lshrrev_b32 v7, 1, v5
v_xor_b32 v6, v6, v7
v_and_b32 v7, 4, v5
v_add_u32 v5, v5, v7
s_mul_i32 s6, s60, 32768
v_lshl_add_u32 v5, v5, 9, s6
v_lshl_add_u32 v21, v6, 4, v5
v_xor_b32 v6, 4, v6
v_lshl_add_u32 v22, v6, 4, v5
v_add_u32 v22, 0x1c00, v22
v_mov_b32 v23, v21
v_mov_b32 v24, v22
s_lshr_b32 s7, s62, 1
s_xor_b32 s6, s7, 0
s_lshl_b32 s74, s6, 7
s_add_u32 s75, s74, 16384
s_xor_b32 s6, s7, 1
s_lshl_b32 s76, s6, 7
s_add_u32 s77, s76, 16384
s_xor_b32 s6, s7, 2
s_lshl_b32 s78, s6, 7
s_add_u32 s79, s78, 16384
s_xor_b32 s6, s7, 3
s_lshl_b32 s80, s6, 7
s_add_u32 s81, s80, 16384
s_and_b32 s6, s62, 1
s_lshl_b32 s6, s6, 2
v_lshrrev_b32 v5, 1, v3
v_xor_b32 v5, v5, v4
v_xor_b32 v5, s6, v5
v_lshl_add_u32 v6, v3, 7, s63
v_lshl_add_u32 v29, v5, 4, v6
v_xor_b32 v30, 64, v29
s_mul_i32 s6, s60, 2
s_xor_b32 s6, s6, s62
s_lshl_b32 s6, s6, 10
s_add_u32 s6, s6, 0x12000
v_lshrrev_b32 v5, 1, v4
v_and_b32 v6, 1, v4
v_lshl_add_u32 v5, v5, 8, s6
v_lshl_add_u32 v5, v6, 3, v5
v_lshl_add_u32 v33, v3, 4, v5
v_xor_b32 v34, 0x400, v33
v_add_u32 v35, 0x12000, v16
s_mov_b32 s6, s14
s_mul_i32 s7, s60, 2048
s_add_u32 s82, s6, s7
s_add_u32 s83, s82, 8192
s_add_u32 s84, s82, 16384
s_mov_b32 s86, 0x3db8aa3b
s_mov_b32 s87, 0x3db8aa3b
s_mov_b32 s88, 0x3727c5ac
s_mov_b32 s89, 0x3b800000
s_mov_b32 s90, 0xffff0000
s_add_u32 s48, s28, 0x0
s_addc_u32 s49, s29, 0
s_mov_b32 s50, 0x20000
s_mov_b32 s51, 0x00020000
s_add_u32 s52, s38, 0x0
s_addc_u32 s53, s39, 0
s_mov_b32 s54, s15
s_mov_b32 s55, 0x00020000
s_add_u32 s56, s38, 0x6800000
s_addc_u32 s57, s39, 0
s_mov_b32 s58, s15
s_mov_b32 s59, 0x00020000
s_waitcnt vmcnt(13)
v_lshlrev_b32 v116, 16, v44
v_and_b32 v117, s90, v44
v_lshlrev_b32 v118, 16, v45
v_and_b32 v119, s90, v45
v_lshlrev_b32 v120, 16, v46
v_and_b32 v121, s90, v46
v_lshlrev_b32 v122, 16, v47
v_and_b32 v123, s90, v47
v_pk_add_f32 v[164:165], v[116:117], v[118:119]
v_pk_mul_f32 v[166:167], v[116:117], v[116:117]
v_pk_add_f32 v[44:45], v[120:121], v[122:123]
v_pk_fma_f32 v[166:167], v[118:119], v[118:119], v[166:167]
v_pk_add_f32 v[164:165], v[164:165], v[44:45]
v_pk_fma_f32 v[166:167], v[120:121], v[120:121], v[166:167]
v_add_f32 v164, v164, v165
v_pk_fma_f32 v[166:167], v[122:123], v[122:123], v[166:167]
v_add_f32 v166, v166, v167
s_waitcnt vmcnt(12)
v_lshlrev_b32 v124, 16, v48
v_and_b32 v125, s90, v48
v_lshlrev_b32 v126, 16, v49
v_and_b32 v127, s90, v49
v_lshlrev_b32 v128, 16, v50
v_and_b32 v129, s90, v50
v_lshlrev_b32 v130, 16, v51
v_and_b32 v131, s90, v51
v_pk_add_f32 v[168:169], v[124:125], v[126:127]
v_pk_mul_f32 v[170:171], v[124:125], v[124:125]
v_pk_add_f32 v[48:49], v[128:129], v[130:131]
v_pk_fma_f32 v[170:171], v[126:127], v[126:127], v[170:171]
v_pk_add_f32 v[168:169], v[168:169], v[48:49]
v_pk_fma_f32 v[170:171], v[128:129], v[128:129], v[170:171]
v_add_f32 v168, v168, v169
v_pk_fma_f32 v[170:171], v[130:131], v[130:131], v[170:171]
v_add_f32 v170, v170, v171
s_waitcnt vmcnt(11)
v_lshlrev_b32 v132, 16, v52
v_and_b32 v133, s90, v52
v_lshlrev_b32 v134, 16, v53
v_and_b32 v135, s90, v53
v_lshlrev_b32 v136, 16, v54
v_and_b32 v137, s90, v54
v_lshlrev_b32 v138, 16, v55
v_and_b32 v139, s90, v55
v_pk_add_f32 v[172:173], v[132:133], v[134:135]
v_pk_mul_f32 v[174:175], v[132:133], v[132:133]
v_pk_add_f32 v[52:53], v[136:137], v[138:139]
v_pk_fma_f32 v[174:175], v[134:135], v[134:135], v[174:175]
v_pk_add_f32 v[172:173], v[172:173], v[52:53]
v_pk_fma_f32 v[174:175], v[136:137], v[136:137], v[174:175]
v_add_f32 v172, v172, v173
v_pk_fma_f32 v[174:175], v[138:139], v[138:139], v[174:175]
v_add_f32 v174, v174, v175
s_waitcnt vmcnt(10)
v_lshlrev_b32 v140, 16, v56
v_and_b32 v141, s90, v56
v_lshlrev_b32 v142, 16, v57
v_and_b32 v143, s90, v57
v_lshlrev_b32 v144, 16, v58
v_and_b32 v145, s90, v58
v_lshlrev_b32 v146, 16, v59
v_and_b32 v147, s90, v59
v_pk_add_f32 v[176:177], v[140:141], v[142:143]
v_pk_mul_f32 v[178:179], v[140:141], v[140:141]
v_pk_add_f32 v[56:57], v[144:145], v[146:147]
v_pk_fma_f32 v[178:179], v[142:143], v[142:143], v[178:179]
v_pk_add_f32 v[176:177], v[176:177], v[56:57]
v_pk_fma_f32 v[178:179], v[144:145], v[144:145], v[178:179]
v_add_f32 v176, v176, v177
v_pk_fma_f32 v[178:179], v[146:147], v[146:147], v[178:179]
v_add_f32 v178, v178, v179
s_waitcnt vmcnt(9)
v_lshlrev_b32 v148, 16, v60
v_and_b32 v149, s90, v60
v_lshlrev_b32 v150, 16, v61
v_and_b32 v151, s90, v61
v_lshlrev_b32 v152, 16, v62
v_and_b32 v153, s90, v62
v_lshlrev_b32 v154, 16, v63
v_and_b32 v155, s90, v63
v_pk_add_f32 v[180:181], v[148:149], v[150:151]
v_pk_mul_f32 v[182:183], v[148:149], v[148:149]
v_pk_add_f32 v[60:61], v[152:153], v[154:155]
v_pk_fma_f32 v[182:183], v[150:151], v[150:151], v[182:183]
v_pk_add_f32 v[180:181], v[180:181], v[60:61]
v_pk_fma_f32 v[182:183], v[152:153], v[152:153], v[182:183]
v_add_f32 v180, v180, v181
v_pk_fma_f32 v[182:183], v[154:155], v[154:155], v[182:183]
v_add_f32 v182, v182, v183
s_waitcnt vmcnt(8)
v_lshlrev_b32 v156, 16, v64
v_and_b32 v157, s90, v64
v_lshlrev_b32 v158, 16, v65
v_and_b32 v159, s90, v65
v_lshlrev_b32 v160, 16, v66
v_and_b32 v161, s90, v66
v_lshlrev_b32 v162, 16, v67
v_and_b32 v163, s90, v67
v_pk_add_f32 v[184:185], v[156:157], v[158:159]
v_pk_mul_f32 v[186:187], v[156:157], v[156:157]
v_pk_add_f32 v[64:65], v[160:161], v[162:163]
v_pk_fma_f32 v[186:187], v[158:159], v[158:159], v[186:187]
v_pk_add_f32 v[184:185], v[184:185], v[64:65]
v_pk_fma_f32 v[186:187], v[160:161], v[160:161], v[186:187]
v_add_f32 v184, v184, v185
v_pk_fma_f32 v[186:187], v[162:163], v[162:163], v[186:187]
v_add_f32 v186, v186, v187
v_permlane16_swap_b32 v164, v166
v_permlane16_swap_b32 v168, v170
v_permlane16_swap_b32 v172, v174
v_permlane16_swap_b32 v176, v178
v_permlane16_swap_b32 v180, v182
v_permlane16_swap_b32 v184, v186
v_add_f32 v164, v164, v166
v_add_f32 v168, v168, v170
v_add_f32 v172, v172, v174
v_add_f32 v176, v176, v178
v_add_f32 v180, v180, v182
v_add_f32 v184, v184, v186
v_add_f32_dpp v165, v164, v164 row_ror:8 row_mask:0xf bank_mask:0x3
v_add_f32_dpp v165, v168, v168 row_ror:8 row_mask:0xf bank_mask:0xc
v_add_f32_dpp v173, v172, v172 row_ror:8 row_mask:0xf bank_mask:0x3
v_add_f32_dpp v173, v176, v176 row_ror:8 row_mask:0xf bank_mask:0xc
v_add_f32_dpp v181, v180, v180 row_ror:8 row_mask:0xf bank_mask:0x3
v_add_f32_dpp v181, v184, v184 row_ror:8 row_mask:0xf bank_mask:0xc
v_add_f32_dpp v166, v165, v165 row_half_mirror row_mask:0xf bank_mask:0x5
v_add_f32_dpp v166, v173, v173 row_half_mirror row_mask:0xf bank_mask:0xa
v_add_f32_dpp v182, v181, v181 row_half_mirror row_mask:0xf bank_mask:0xf
s_nop 0
v_add_f32_dpp v166, v166, v166 quad_perm:[1,0,3,2] row_mask:0xf bank_mask:0xf
v_add_f32_dpp v182, v182, v182 quad_perm:[1,0,3,2] row_mask:0xf bank_mask:0xf
s_nop 0
v_add_f32_dpp v166, v166, v166 quad_perm:[2,3,0,1] row_mask:0xf bank_mask:0xf
v_add_f32_dpp v182, v182, v182 quad_perm:[2,3,0,1] row_mask:0xf bank_mask:0xf
v_mov_b32 v167, v166
v_mov_b32 v183, v182
s_nop 0
v_permlane16_swap_b32 v167, v166
v_permlane16_swap_b32 v183, v182
v_mul_f32 v167, s89, v167
v_mul_f32 v183, s89, v183
v_mul_f32 v166, s89, v166
v_mul_f32 v182, s89, v182
v_fma_f32 v166, -v167, v167, v166
v_fma_f32 v182, -v183, v183, v182
v_max_f32 v166, 0, v166
v_max_f32 v182, 0, v182
v_cvt_pk_bf16_f32 v166, v166, v166
v_cvt_pk_bf16_f32 v182, v182, v182
v_and_b32 v166, s90, v166
v_and_b32 v182, s90, v182
v_add_f32 v166, s88, v166
v_add_f32 v182, s88, v182
v_cvt_pk_bf16_f32 v166, v166, v166
v_cvt_pk_bf16_f32 v182, v182, v182
v_and_b32 v166, s90, v166
v_and_b32 v182, s90, v182
v_sqrt_f32 v166, v166
v_sqrt_f32 v182, v182
s_nop 0
s_nop 0
v_cvt_pk_bf16_f32 v166, v166, v166
v_cvt_pk_bf16_f32 v182, v182, v182
v_and_b32 v166, s90, v166
v_and_b32 v182, s90, v182
v_rcp_f32 v166, v166
v_rcp_f32 v182, v182
v_mul_f32 v167, -v167, v166
v_mul_f32 v183, -v183, v182
s_nop 0
v_mov_b64_dpp v[164:165], v[166:167] row_newbcast:0 row_mask:0xf bank_mask:0xf
v_mov_b64_dpp v[168:169], v[166:167] row_newbcast:8 row_mask:0xf bank_mask:0xf
v_mov_b64_dpp v[172:173], v[166:167] row_newbcast:4 row_mask:0xf bank_mask:0xf
v_mov_b64_dpp v[176:177], v[166:167] row_newbcast:12 row_mask:0xf bank_mask:0xf
v_mov_b64_dpp v[180:181], v[182:183] row_newbcast:0 row_mask:0xf bank_mask:0xf
v_mov_b64_dpp v[184:185], v[182:183] row_newbcast:8 row_mask:0xf bank_mask:0xf
v_fma_f32 v116, v116, v164, v165
v_fma_f32 v117, v117, v164, v165
v_fma_f32 v118, v118, v164, v165
v_fma_f32 v119, v119, v164, v165
v_fma_f32 v120, v120, v164, v165
v_fma_f32 v121, v121, v164, v165
v_fma_f32 v122, v122, v164, v165
v_fma_f32 v123, v123, v164, v165
v_cvt_pk_bf16_f32 v44, v116, v117
v_cvt_pk_bf16_f32 v45, v118, v119
v_cvt_pk_bf16_f32 v46, v120, v121
v_cvt_pk_bf16_f32 v47, v122, v123
ds_write_b128 v36, v[44:47]
v_fma_f32 v124, v124, v168, v169
v_fma_f32 v125, v125, v168, v169
v_fma_f32 v126, v126, v168, v169
v_fma_f32 v127, v127, v168, v169
v_fma_f32 v128, v128, v168, v169
v_fma_f32 v129, v129, v168, v169
v_fma_f32 v130, v130, v168, v169
v_fma_f32 v131, v131, v168, v169
v_cvt_pk_bf16_f32 v48, v124, v125
v_cvt_pk_bf16_f32 v49, v126, v127
v_cvt_pk_bf16_f32 v50, v128, v129
v_cvt_pk_bf16_f32 v51, v130, v131
ds_write_b128 v37, v[48:51]
v_fma_f32 v132, v132, v172, v173
v_fma_f32 v133, v133, v172, v173
v_fma_f32 v134, v134, v172, v173
v_fma_f32 v135, v135, v172, v173
v_fma_f32 v136, v136, v172, v173
v_fma_f32 v137, v137, v172, v173
v_fma_f32 v138, v138, v172, v173
v_fma_f32 v139, v139, v172, v173
v_cvt_pk_bf16_f32 v52, v132, v133
v_cvt_pk_bf16_f32 v53, v134, v135
v_cvt_pk_bf16_f32 v54, v136, v137
v_cvt_pk_bf16_f32 v55, v138, v139
ds_write_b128 v38, v[52:55]
v_fma_f32 v140, v140, v176, v177
v_fma_f32 v141, v141, v176, v177
v_fma_f32 v142, v142, v176, v177
v_fma_f32 v143, v143, v176, v177
v_fma_f32 v144, v144, v176, v177
v_fma_f32 v145, v145, v176, v177
v_fma_f32 v146, v146, v176, v177
v_fma_f32 v147, v147, v176, v177
v_cvt_pk_bf16_f32 v56, v140, v141
v_cvt_pk_bf16_f32 v57, v142, v143
v_cvt_pk_bf16_f32 v58, v144, v145
v_cvt_pk_bf16_f32 v59, v146, v147
ds_write_b128 v39, v[56:59]
v_fma_f32 v148, v148, v180, v181
v_fma_f32 v149, v149, v180, v181
v_fma_f32 v150, v150, v180, v181
v_fma_f32 v151, v151, v180, v181
v_fma_f32 v152, v152, v180, v181
v_fma_f32 v153, v153, v180, v181
v_fma_f32 v154, v154, v180, v181
v_fma_f32 v155, v155, v180, v181
v_cvt_pk_bf16_f32 v60, v148, v149
v_cvt_pk_bf16_f32 v61, v150, v151
v_cvt_pk_bf16_f32 v62, v152, v153
v_cvt_pk_bf16_f32 v63, v154, v155
ds_write_b128 v40, v[60:63]
v_fma_f32 v156, v156, v184, v185
v_fma_f32 v157, v157, v184, v185
v_fma_f32 v158, v158, v184, v185
v_fma_f32 v159, v159, v184, v185
v_fma_f32 v160, v160, v184, v185
v_fma_f32 v161, v161, v184, v185
v_fma_f32 v162, v162, v184, v185
v_fma_f32 v163, v163, v184, v185
v_cvt_pk_bf16_f32 v64, v156, v157
v_cvt_pk_bf16_f32 v65, v158, v159
v_cvt_pk_bf16_f32 v66, v160, v161
v_cvt_pk_bf16_f32 v67, v162, v163
ds_write_b128 v41, v[64:67]
s_add_u32 m0, s63, 0x2000
s_nop 0
buffer_load_dwordx4 v17, s[44:47], s68 offen offset:0 lds
buffer_load_dwordx4 v18, s[44:47], s68 offen offset:1024 lds
buffer_load_dwordx4 v19, s[44:47], s68 offen offset:2048 lds
buffer_load_dwordx4 v20, s[44:47], s68 offen offset:3072 lds
s_add_u32 s40, s28, 0x1fe00
s_addc_u32 s41, s29, 0
s_mov_b32 s42, 0x200
s_mov_b32 s43, 0x00020000
v_lshlrev_b32 v5, 4, v4
s_lshr_b32 s6, s66, 8
buffer_load_dwordx4 a[0:3], v5, s[40:43], s6 offen
s_lshr_b32 s6, s67, 8
buffer_load_dwordx4 a[4:7], v5, s[40:43], s6 offen
s_lshr_b32 s6, s68, 8
buffer_load_dwordx4 a[8:11], v5, s[40:43], s6 offen
s_lshr_b32 s6, s69, 8
buffer_load_dwordx4 a[12:15], v5, s[40:43], s6 offen
s_lshr_b32 s6, s70, 8
buffer_load_dwordx4 a[16:19], v5, s[40:43], s6 offen
s_lshr_b32 s6, s71, 8
buffer_load_dwordx4 a[20:23], v5, s[40:43], s6 offen
s_lshr_b32 s6, s72, 8
buffer_load_dwordx4 a[24:27], v5, s[40:43], s6 offen
s_lshr_b32 s6, s73, 8
buffer_load_dwordx4 a[28:31], v5, s[40:43], s6 offen
v_and_b32 v5, 31, v2
v_cmp_eq_u32 vcc, 31, v5
v_mov_b32 v6, 0xffff
v_mov_b32 v7, 0x3f800000
v_cndmask_b32 v6, -1, v6, vcc
v_cndmask_b32 v7, 0, v7, vcc
s_waitcnt vmcnt(16)
ds_read_b64_tr_b16 v[164:165], v25 offset:0
ds_read_b64_tr_b16 v[166:167], v25 offset:512
ds_read_b64_tr_b16 v[168:169], v26 offset:0
ds_read_b64_tr_b16 v[170:171], v26 offset:512
ds_read_b64_tr_b16 v[172:173], v27 offset:0
ds_read_b64_tr_b16 v[174:175], v27 offset:512
s_waitcnt lgkmcnt(6)
s_barrier
ds_read_b128 v[204:207], v31 offset:0
ds_read_b128 v[208:211], v31 offset:8192
ds_read_b128 v[212:215], v31 offset:16384
s_waitcnt lgkmcnt(2)
v_mfma_f32_16x16x32_bf16 v[68:71], v[164:167], v[204:207], 0
s_waitcnt lgkmcnt(1)
v_mfma_f32_16x16x32_bf16 v[72:75], v[164:167], v[208:211], 0
s_waitcnt lgkmcnt(0)
v_mfma_f32_16x16x32_bf16 v[76:79], v[164:167], v[212:215], 0
ds_read_b64_tr_b16 v[176:177], v28 offset:0
ds_read_b64_tr_b16 v[178:179], v28 offset:512
v_mfma_f32_16x16x32_bf16 v[80:83], v[168:171], v[204:207], 0
v_mfma_f32_16x16x32_bf16 v[84:87], v[168:171], v[208:211], 0
v_mfma_f32_16x16x32_bf16 v[88:91], v[168:171], v[212:215], 0
ds_read_b128 v[216:219], v32 offset:1024
s_waitcnt vmcnt(12)
ds_read_b64_tr_b16 v[180:181], v25 offset:4096
ds_read_b64_tr_b16 v[182:183], v25 offset:4608
v_mfma_f32_16x16x32_bf16 v[92:95], v[172:175], v[204:207], 0
ds_read_b128 v[220:223], v32 offset:9216
v_mfma_f32_16x16x32_bf16 v[96:99], v[172:175], v[208:211], 0
ds_read_b128 v[224:227], v32 offset:17408
v_mfma_f32_16x16x32_bf16 v[100:103], v[172:175], v[212:215], 0
ds_read_b64_tr_b16 v[184:185], v26 offset:4096
ds_read_b64_tr_b16 v[186:187], v26 offset:4608
s_waitcnt lgkmcnt(7)
v_mfma_f32_16x16x32_bf16 v[104:107], v[176:179], v[204:207], 0
s_add_u32 m0, s63, 0x0
s_nop 0
buffer_load_dwordx4 v17, s[44:47], s69 offen offset:0 lds
buffer_load_dwordx4 v18, s[44:47], s69 offen offset:1024 lds
buffer_load_dwordx4 v19, s[44:47], s69 offen offset:2048 lds
buffer_load_dwordx4 v20, s[44:47], s69 offen offset:3072 lds
v_mfma_f32_16x16x32_bf16 v[108:111], v[176:179], v[208:211], 0
v_mfma_f32_16x16x32_bf16 v[112:115], v[176:179], v[212:215], 0
ds_read_b64_tr_b16 v[188:189], v27 offset:4096
ds_read_b64_tr_b16 v[190:191], v27 offset:4608
s_waitcnt lgkmcnt(6)
v_mfma_f32_16x16x32_bf16 v[68:71], v[180:183], v[216:219], v[68:71]
s_waitcnt lgkmcnt(5)
v_mfma_f32_16x16x32_bf16 v[72:75], v[180:183], v[220:223], v[72:75]
s_waitcnt lgkmcnt(4)
v_mfma_f32_16x16x32_bf16 v[76:79], v[180:183], v[224:227], v[76:79]
ds_read_b64_tr_b16 v[192:193], v28 offset:4096
ds_read_b64_tr_b16 v[194:195], v28 offset:4608
s_waitcnt lgkmcnt(4)
v_mfma_f32_16x16x32_bf16 v[80:83], v[184:187], v[216:219], v[80:83]
v_mfma_f32_16x16x32_bf16 v[84:87], v[184:187], v[220:223], v[84:87]
v_mfma_f32_16x16x32_bf16 v[88:91], v[184:187], v[224:227], v[88:91]
ds_read_b128 v[228:231], v31 offset:2048
s_waitcnt vmcnt(12)
ds_read_b64_tr_b16 v[196:197], v25 offset:8192
ds_read_b64_tr_b16 v[198:199], v25 offset:8704
s_waitcnt lgkmcnt(5)
v_mfma_f32_16x16x32_bf16 v[92:95], v[188:191], v[216:219], v[92:95]
ds_read_b128 v[232:235], v31 offset:10240
v_mfma_f32_16x16x32_bf16 v[96:99], v[188:191], v[220:223], v[96:99]
ds_read_b128 v[236:239], v31 offset:18432
v_mfma_f32_16x16x32_bf16 v[100:103], v[188:191], v[224:227], v[100:103]
ds_read_b64_tr_b16 v[200:201], v26 offset:8192
ds_read_b64_tr_b16 v[202:203], v26 offset:8704
s_waitcnt lgkmcnt(7)
v_mfma_f32_16x16x32_bf16 v[104:107], v[192:195], v[216:219], v[104:107]
s_add_u32 m0, s63, 0x1000
s_nop 0
buffer_load_dwordx4 v17, s[44:47], s70 offen offset:0 lds
buffer_load_dwordx4 v18, s[44:47], s70 offen offset:1024 lds
buffer_load_dwordx4 v19, s[44:47], s70 offen offset:2048 lds
buffer_load_dwordx4 v20, s[44:47], s70 offen offset:3072 lds
v_mfma_f32_16x16x32_bf16 v[108:111], v[192:195], v[220:223], v[108:111]
v_mfma_f32_16x16x32_bf16 v[112:115], v[192:195], v[224:227], v[112:115]
ds_read_b64_tr_b16 v[164:165], v27 offset:8192
ds_read_b64_tr_b16 v[166:167], v27 offset:8704
s_waitcnt lgkmcnt(6)
v_mfma_f32_16x16x32_bf16 v[68:71], v[196:199], v[228:231], v[68:71]
s_waitcnt lgkmcnt(5)
v_mfma_f32_16x16x32_bf16 v[72:75], v[196:199], v[232:235], v[72:75]
s_waitcnt lgkmcnt(4)
v_mfma_f32_16x16x32_bf16 v[76:79], v[196:199], v[236:239], v[76:79]
ds_read_b64_tr_b16 v[168:169], v28 offset:8192
ds_read_b64_tr_b16 v[170:171], v28 offset:8704
s_waitcnt lgkmcnt(4)
v_mfma_f32_16x16x32_bf16 v[80:83], v[200:203], v[228:231], v[80:83]
v_mfma_f32_16x16x32_bf16 v[84:87], v[200:203], v[232:235], v[84:87]
v_mfma_f32_16x16x32_bf16 v[88:91], v[200:203], v[236:239], v[88:91]
ds_read_b128 v[204:207], v32 offset:3072
s_waitcnt vmcnt(4)
ds_read_b64_tr_b16 v[172:173], v25 offset:0
ds_read_b64_tr_b16 v[174:175], v25 offset:512
s_waitcnt lgkmcnt(5)
v_mfma_f32_16x16x32_bf16 v[92:95], v[164:167], v[228:231], v[92:95]
ds_read_b128 v[208:211], v32 offset:11264
v_mfma_f32_16x16x32_bf16 v[96:99], v[164:167], v[232:235], v[96:99]
ds_read_b128 v[212:215], v32 offset:19456
v_mfma_f32_16x16x32_bf16 v[100:103], v[164:167], v[236:239], v[100:103]
ds_read_b64_tr_b16 v[176:177], v26 offset:0
ds_read_b64_tr_b16 v[178:179], v26 offset:512
s_waitcnt lgkmcnt(7)
v_mfma_f32_16x16x32_bf16 v[104:107], v[168:171], v[228:231], v[104:107]
s_add_u32 m0, s63, 0x2000
s_nop 0
buffer_load_dwordx4 v17, s[44:47], s71 offen offset:0 lds
buffer_load_dwordx4 v18, s[44:47], s71 offen offset:1024 lds
buffer_load_dwordx4 v19, s[44:47], s71 offen offset:2048 lds
buffer_load_dwordx4 v20, s[44:47], s71 offen offset:3072 lds
v_mfma_f32_16x16x32_bf16 v[108:111], v[168:171], v[232:235], v[108:111]
v_mfma_f32_16x16x32_bf16 v[112:115], v[168:171], v[236:239], v[112:115]
ds_read_b64_tr_b16 v[180:181], v27 offset:0
ds_read_b64_tr_b16 v[182:183], v27 offset:512
s_waitcnt lgkmcnt(6)
v_mfma_f32_16x16x32_bf16 v[68:71], v[172:175], v[204:207], v[68:71]
s_waitcnt lgkmcnt(5)
v_mfma_f32_16x16x32_bf16 v[72:75], v[172:175], v[208:211], v[72:75]
s_waitcnt lgkmcnt(4)
v_mfma_f32_16x16x32_bf16 v[76:79], v[172:175], v[212:215], v[76:79]
ds_read_b64_tr_b16 v[184:185], v28 offset:0
ds_read_b64_tr_b16 v[186:187], v28 offset:512
s_waitcnt lgkmcnt(4)
v_mfma_f32_16x16x32_bf16 v[80:83], v[176:179], v[204:207], v[80:83]
v_mfma_f32_16x16x32_bf16 v[84:87], v[176:179], v[208:211], v[84:87]
v_mfma_f32_16x16x32_bf16 v[88:91], v[176:179], v[212:215], v[88:91]
ds_read_b128 v[216:219], v31 offset:4096
s_waitcnt vmcnt(4)
ds_read_b64_tr_b16 v[188:189], v25 offset:4096
ds_read_b64_tr_b16 v[190:191], v25 offset:4608
s_waitcnt lgkmcnt(5)
v_mfma_f32_16x16x32_bf16 v[92:95], v[180:183], v[204:207], v[92:95]
ds_read_b128 v[220:223], v31 offset:12288
v_mfma_f32_16x16x32_bf16 v[96:99], v[180:183], v[208:211], v[96:99]
ds_read_b128 v[224:227], v31 offset:20480
v_mfma_f32_16x16x32_bf16 v[100:103], v[180:183], v[212:215], v[100:103]
ds_read_b64_tr_b16 v[192:193], v26 offset:4096
ds_read_b64_tr_b16 v[194:195], v26 offset:4608
s_waitcnt lgkmcnt(7)
v_mfma_f32_16x16x32_bf16 v[104:107], v[184:187], v[204:207], v[104:107]
s_add_u32 m0, s63, 0x0
s_nop 0
buffer_load_dwordx4 v17, s[44:47], s72 offen offset:0 lds
buffer_load_dwordx4 v18, s[44:47], s72 offen offset:1024 lds
buffer_load_dwordx4 v19, s[44:47], s72 offen offset:2048 lds
buffer_load_dwordx4 v20, s[44:47], s72 offen offset:3072 lds
v_mfma_f32_16x16x32_bf16 v[108:111], v[184:187], v[208:211], v[108:111]
v_mfma_f32_16x16x32_bf16 v[112:115], v[184:187], v[212:215], v[112:115]
ds_read_b64_tr_b16 v[196:197], v27 offset:4096
ds_read_b64_tr_b16 v[198:199], v27 offset:4608
s_waitcnt lgkmcnt(6)
v_mfma_f32_16x16x32_bf16 v[68:71], v[188:191], v[216:219], v[68:71]
s_waitcnt lgkmcnt(5)
v_mfma_f32_16x16x32_bf16 v[72:75], v[188:191], v[220:223], v[72:75]
s_waitcnt lgkmcnt(4)
v_mfma_f32_16x16x32_bf16 v[76:79], v[188:191], v[224:227], v[76:79]
ds_read_b64_tr_b16 v[200:201], v28 offset:4096
ds_read_b64_tr_b16 v[202:203], v28 offset:4608
s_waitcnt lgkmcnt(4)
v_mfma_f32_16x16x32_bf16 v[80:83], v[192:195], v[216:219], v[80:83]
v_mfma_f32_16x16x32_bf16 v[84:87], v[192:195], v[220:223], v[84:87]
v_mfma_f32_16x16x32_bf16 v[88:91], v[192:195], v[224:227], v[88:91]
ds_read_b128 v[228:231], v32 offset:5120
s_waitcnt vmcnt(4)
ds_read_b64_tr_b16 v[164:165], v25 offset:8192
ds_read_b64_tr_b16 v[166:167], v25 offset:8704
s_waitcnt lgkmcnt(5)
v_mfma_f32_16x16x32_bf16 v[92:95], v[196:199], v[216:219], v[92:95]
ds_read_b128 v[232:235], v32 offset:13312
v_mfma_f32_16x16x32_bf16 v[96:99], v[196:199], v[220:223], v[96:99]
ds_read_b128 v[236:239], v32 offset:21504
v_mfma_f32_16x16x32_bf16 v[100:103], v[196:199], v[224:227], v[100:103]
ds_read_b64_tr_b16 v[168:169], v26 offset:8192
ds_read_b64_tr_b16 v[170:171], v26 offset:8704
s_waitcnt lgkmcnt(7)
v_mfma_f32_16x16x32_bf16 v[104:107], v[200:203], v[216:219], v[104:107]
s_add_u32 m0, s63, 0x1000
s_nop 0
buffer_load_dwordx4 v17, s[44:47], s73 offen offset:0 lds
buffer_load_dwordx4 v18, s[44:47], s73 offen offset:1024 lds
buffer_load_dwordx4 v19, s[44:47], s73 offen offset:2048 lds
buffer_load_dwordx4 v20, s[44:47], s73 offen offset:3072 lds
v_mfma_f32_16x16x32_bf16 v[108:111], v[200:203], v[220:223], v[108:111]
v_mfma_f32_16x16x32_bf16 v[112:115], v[200:203], v[224:227], v[112:115]
ds_read_b64_tr_b16 v[172:173], v27 offset:8192
ds_read_b64_tr_b16 v[174:175], v27 offset:8704
s_waitcnt lgkmcnt(6)
v_mfma_f32_16x16x32_bf16 v[68:71], v[164:167], v[228:231], v[68:71]
s_waitcnt lgkmcnt(5)
v_mfma_f32_16x16x32_bf16 v[72:75], v[164:167], v[232:235], v[72:75]
s_waitcnt lgkmcnt(4)
v_mfma_f32_16x16x32_bf16 v[76:79], v[164:167], v[236:239], v[76:79]
ds_read_b64_tr_b16 v[176:177], v28 offset:8192
ds_read_b64_tr_b16 v[178:179], v28 offset:8704
s_waitcnt lgkmcnt(4)
v_mfma_f32_16x16x32_bf16 v[80:83], v[168:171], v[228:231], v[80:83]
v_mfma_f32_16x16x32_bf16 v[84:87], v[168:171], v[232:235], v[84:87]
v_mfma_f32_16x16x32_bf16 v[88:91], v[168:171], v[236:239], v[88:91]
ds_read_b128 v[204:207], v31 offset:6144
s_waitcnt vmcnt(4)
ds_read_b64_tr_b16 v[180:181], v25 offset:0
ds_read_b64_tr_b16 v[182:183], v25 offset:512
s_waitcnt lgkmcnt(5)
v_mfma_f32_16x16x32_bf16 v[92:95], v[172:175], v[228:231], v[92:95]
ds_read_b128 v[208:211], v31 offset:14336
v_mfma_f32_16x16x32_bf16 v[96:99], v[172:175], v[232:235], v[96:99]
ds_read_b128 v[212:215], v31 offset:22528
v_mfma_f32_16x16x32_bf16 v[100:103], v[172:175], v[236:239], v[100:103]
ds_read_b64_tr_b16 v[184:185], v26 offset:0
ds_read_b64_tr_b16 v[186:187], v26 offset:512
s_waitcnt lgkmcnt(7)
v_mfma_f32_16x16x32_bf16 v[104:107], v[176:179], v[228:231], v[104:107]
s_add_u32 m0, s63, 0x2000
s_nop 0
buffer_load_dwordx4 v21, s[48:51], s74 offen offset:0 lds
buffer_load_dwordx4 v22, s[48:51], s74 offen offset:1024 lds
buffer_load_dwordx4 v23, s[48:51], s74 offen offset:2048 lds
buffer_load_dwordx4 v24, s[48:51], s74 offen offset:3072 lds
v_mfma_f32_16x16x32_bf16 v[108:111], v[176:179], v[232:235], v[108:111]
v_mfma_f32_16x16x32_bf16 v[112:115], v[176:179], v[236:239], v[112:115]
ds_read_b64_tr_b16 v[188:189], v27 offset:0
ds_read_b64_tr_b16 v[190:191], v27 offset:512
s_waitcnt lgkmcnt(6)
v_mfma_f32_16x16x32_bf16 v[68:71], v[180:183], v[204:207], v[68:71]
s_waitcnt lgkmcnt(5)
v_mfma_f32_16x16x32_bf16 v[72:75], v[180:183], v[208:211], v[72:75]
s_waitcnt lgkmcnt(4)
v_mfma_f32_16x16x32_bf16 v[76:79], v[180:183], v[212:215], v[76:79]
ds_read_b64_tr_b16 v[192:193], v28 offset:0
ds_read_b64_tr_b16 v[194:195], v28 offset:512
s_waitcnt lgkmcnt(4)
v_mfma_f32_16x16x32_bf16 v[80:83], v[184:187], v[204:207], v[80:83]
v_mfma_f32_16x16x32_bf16 v[84:87], v[184:187], v[208:211], v[84:87]
v_mfma_f32_16x16x32_bf16 v[88:91], v[184:187], v[212:215], v[88:91]
ds_read_b128 v[216:219], v32 offset:7168
s_waitcnt vmcnt(4)
ds_read_b64_tr_b16 v[196:197], v25 offset:4096
ds_read_b64_tr_b16 v[198:199], v25 offset:4608
s_waitcnt lgkmcnt(5)
v_mfma_f32_16x16x32_bf16 v[92:95], v[188:191], v[204:207], v[92:95]
ds_read_b128 v[220:223], v32 offset:15360
v_mfma_f32_16x16x32_bf16 v[96:99], v[188:191], v[208:211], v[96:99]
ds_read_b128 v[224:227], v32 offset:23552
v_mfma_f32_16x16x32_bf16 v[100:103], v[188:191], v[212:215], v[100:103]
ds_read_b64_tr_b16 v[200:201], v26 offset:4096
ds_read_b64_tr_b16 v[202:203], v26 offset:4608
s_waitcnt lgkmcnt(7)
v_mfma_f32_16x16x32_bf16 v[104:107], v[192:195], v[204:207], v[104:107]
s_add_u32 m0, s63, 0x0
s_nop 0
buffer_load_dwordx4 v21, s[48:51], s75 offen offset:0 lds
buffer_load_dwordx4 v22, s[48:51], s75 offen offset:1024 lds
buffer_load_dwordx4 v23, s[48:51], s75 offen offset:2048 lds
buffer_load_dwordx4 v24, s[48:51], s75 offen offset:3072 lds
v_mfma_f32_16x16x32_bf16 v[108:111], v[192:195], v[208:211], v[108:111]
v_mfma_f32_16x16x32_bf16 v[112:115], v[192:195], v[212:215], v[112:115]
ds_read_b64_tr_b16 v[164:165], v27 offset:4096
ds_read_b64_tr_b16 v[166:167], v27 offset:4608
s_waitcnt lgkmcnt(6)
v_mfma_f32_16x16x32_bf16 v[68:71], v[196:199], v[216:219], v[68:71]
s_waitcnt lgkmcnt(5)
v_mfma_f32_16x16x32_bf16 v[72:75], v[196:199], v[220:223], v[72:75]
s_waitcnt lgkmcnt(4)
v_mfma_f32_16x16x32_bf16 v[76:79], v[196:199], v[224:227], v[76:79]
ds_read_b64_tr_b16 v[168:169], v28 offset:4096
ds_read_b64_tr_b16 v[170:171], v28 offset:4608
s_waitcnt lgkmcnt(4)
v_mfma_f32_16x16x32_bf16 v[80:83], v[200:203], v[216:219], v[80:83]
v_cvt_pk_bf16_f32 v68, v68, v69
v_cvt_pk_bf16_f32 v69, v70, v71
ds_write_b64 v33, v[68:69] offset:0
v_mfma_f32_16x16x32_bf16 v[84:87], v[200:203], v[220:223], v[84:87]
v_cvt_pk_bf16_f32 v72, v72, v73
v_cvt_pk_bf16_f32 v73, v74, v75
ds_write_b64 v33, v[72:73] offset:8192
v_mfma_f32_16x16x32_bf16 v[88:91], v[200:203], v[224:227], v[88:91]
v_cvt_pk_bf16_f32 v76, v76, v77
v_cvt_pk_bf16_f32 v77, v78, v79
ds_write_b64 v33, v[76:77] offset:16384
s_waitcnt lgkmcnt(5)
v_mfma_f32_16x16x32_bf16 v[92:95], v[164:167], v[216:219], v[92:95]
v_cvt_pk_bf16_f32 v80, v80, v81
v_cvt_pk_bf16_f32 v81, v82, v83
ds_write_b64 v33, v[80:81] offset:512
v_mfma_f32_16x16x32_bf16 v[96:99], v[164:167], v[220:223], v[96:99]
v_cvt_pk_bf16_f32 v84, v84, v85
v_cvt_pk_bf16_f32 v85, v86, v87
ds_write_b64 v33, v[84:85] offset:8704
v_mfma_f32_16x16x32_bf16 v[100:103], v[164:167], v[224:227], v[100:103]
v_cvt_pk_bf16_f32 v88, v88, v89
v_cvt_pk_bf16_f32 v89, v90, v91
ds_write_b64 v33, v[88:89] offset:16896
s_waitcnt lgkmcnt(6)
v_mfma_f32_16x16x32_bf16 v[104:107], v[168:171], v[216:219], v[104:107]
v_cvt_pk_bf16_f32 v92, v92, v93
v_cvt_pk_bf16_f32 v93, v94, v95
ds_write_b64 v34, v[92:93] offset:0
s_add_u32 m0, s63, 0x1000
s_nop 0
buffer_load_dwordx4 v21, s[48:51], s76 offen offset:0 lds
buffer_load_dwordx4 v22, s[48:51], s76 offen offset:1024 lds
buffer_load_dwordx4 v23, s[48:51], s76 offen offset:2048 lds
buffer_load_dwordx4 v24, s[48:51], s76 offen offset:3072 lds
v_mfma_f32_16x16x32_bf16 v[108:111], v[168:171], v[220:223], v[108:111]
v_cvt_pk_bf16_f32 v96, v96, v97
v_cvt_pk_bf16_f32 v97, v98, v99
ds_write_b64 v34, v[96:97] offset:8192
v_mfma_f32_16x16x32_bf16 v[112:115], v[168:171], v[224:227], v[112:115]
v_cvt_pk_bf16_f32 v100, v100, v101
v_cvt_pk_bf16_f32 v101, v102, v103
ds_write_b64 v34, v[100:101] offset:16384
v_cvt_pk_bf16_f32 v104, v104, v105
v_cvt_pk_bf16_f32 v105, v106, v107
ds_write_b64 v34, v[104:105] offset:512
v_cvt_pk_bf16_f32 v108, v108, v109
v_cvt_pk_bf16_f32 v109, v110, v111
ds_write_b64 v34, v[108:109] offset:8704
v_cvt_pk_bf16_f32 v112, v112, v113
v_cvt_pk_bf16_f32 v113, v114, v115
ds_write_b64 v34, v[112:113] offset:16896
s_waitcnt vmcnt(8)
ds_read_b128 v[172:175], v29 offset:8192
ds_read_b128 v[176:179], v30 offset:8192
s_waitcnt lgkmcnt(2)
s_barrier
ds_read_b128 v[228:231], v35 offset:0
ds_read_b128 v[232:235], v35 offset:8192
ds_read_b128 v[236:239], v35 offset:16384
ds_read_b128 v[204:207], v35 offset:1024
s_waitcnt lgkmcnt(3)
v_mfma_f32_16x16x32_bf16 v[116:119], v[172:175], v[228:231], 0
ds_read_b128 v[208:211], v35 offset:9216
s_waitcnt lgkmcnt(3)
v_mfma_f32_16x16x32_bf16 v[132:135], v[172:175], v[232:235], 0
ds_read_b128 v[212:215], v35 offset:17408
s_waitcnt lgkmcnt(3)
v_mfma_f32_16x16x32_bf16 v[148:151], v[172:175], v[236:239], 0
v_mfma_f32_16x16x32_bf16 v[240:243], a[0:3], v[228:231], 0
v_mfma_f32_16x16x32_bf16 v[244:247], a[0:3], v[232:235], 0
v_mfma_f32_16x16x32_bf16 v[248:251], a[0:3], v[236:239], 0
ds_read_b128 v[180:183], v29 offset:10240
s_waitcnt lgkmcnt(3)
v_mfma_f32_16x16x32_bf16 v[116:119], v[176:179], v[204:207], v[116:119]
s_waitcnt lgkmcnt(2)
v_mfma_f32_16x16x32_bf16 v[132:135], v[176:179], v[208:211], v[132:135]
s_waitcnt lgkmcnt(1)
v_mfma_f32_16x16x32_bf16 v[148:151], v[176:179], v[212:215], v[148:151]
ds_read_b128 v[184:187], v30 offset:10240
v_mfma_f32_16x16x32_bf16 v[240:243], a[4:7], v[204:207], v[240:243]
v_mfma_f32_16x16x32_bf16 v[244:247], a[4:7], v[208:211], v[244:247]
v_mfma_f32_16x16x32_bf16 v[248:251], a[4:7], v[212:215], v[248:251]
s_waitcnt vmcnt(4)
ds_read_b128 v[188:191], v29 offset:0
s_waitcnt lgkmcnt(2)
v_mfma_f32_16x16x32_bf16 v[120:123], v[180:183], v[228:231], 0
v_mfma_f32_16x16x32_bf16 v[136:139], v[180:183], v[232:235], 0
v_mfma_f32_16x16x32_bf16 v[152:155], v[180:183], v[236:239], 0
ds_read_b128 v[192:195], v30 offset:0
s_waitcnt lgkmcnt(2)
v_mfma_f32_16x16x32_bf16 v[120:123], v[184:187], v[204:207], v[120:123]
s_add_u32 m0, s63, 0x2000
s_nop 0
buffer_load_dwordx4 v21, s[48:51], s77 offen offset:0 lds
buffer_load_dwordx4 v22, s[48:51], s77 offen offset:1024 lds
buffer_load_dwordx4 v23, s[48:51], s77 offen offset:2048 lds
buffer_load_dwordx4 v24, s[48:51], s77 offen offset:3072 lds
v_mfma_f32_16x16x32_bf16 v[136:139], v[184:187], v[208:211], v[136:139]
v_mfma_f32_16x16x32_bf16 v[152:155], v[184:187], v[212:215], v[152:155]
ds_read_b128 v[196:199], v29 offset:2048
s_waitcnt lgkmcnt(2)
v_mfma_f32_16x16x32_bf16 v[124:127], v[188:191], v[228:231], 0
v_mfma_f32_16x16x32_bf16 v[140:143], v[188:191], v[232:235], 0
v_mfma_f32_16x16x32_bf16 v[156:159], v[188:191], v[236:239], 0
ds_read_b128 v[200:203], v30 offset:2048
s_waitcnt lgkmcnt(2)
v_mfma_f32_16x16x32_bf16 v[124:127], v[192:195], v[204:207], v[124:127]
v_mfma_f32_16x16x32_bf16 v[140:143], v[192:195], v[208:211], v[140:143]
v_mfma_f32_16x16x32_bf16 v[156:159], v[192:195], v[212:215], v[156:159]
ds_read_b128 v[216:219], v35 offset:2048
s_waitcnt vmcnt(4)
ds_read_b128 v[164:167], v29 offset:4096
s_waitcnt lgkmcnt(3)
v_mfma_f32_16x16x32_bf16 v[128:131], v[196:199], v[228:231], 0
ds_read_b128 v[220:223], v35 offset:10240
v_mfma_f32_16x16x32_bf16 v[144:147], v[196:199], v[232:235], 0
ds_read_b128 v[224:227], v35 offset:18432
v_mfma_f32_16x16x32_bf16 v[160:163], v[196:199], v[236:239], 0
s_waitcnt lgkmcnt(4)
v_mfma_f32_16x16x32_bf16 v[128:131], v[200:203], v[204:207], v[128:131]
s_add_u32 m0, s63, 0x0
s_nop 0
buffer_load_dwordx4 v21, s[48:51], s78 offen offset:0 lds
buffer_load_dwordx4 v22, s[48:51], s78 offen offset:1024 lds
buffer_load_dwordx4 v23, s[48:51], s78 offen offset:2048 lds
buffer_load_dwordx4 v24, s[48:51], s78 offen offset:3072 lds
v_mfma_f32_16x16x32_bf16 v[144:147], v[200:203], v[208:211], v[144:147]
v_mfma_f32_16x16x32_bf16 v[160:163], v[200:203], v[212:215], v[160:163]
ds_read_b128 v[228:231], v35 offset:3072
ds_read_b128 v[168:171], v30 offset:4096
s_waitcnt lgkmcnt(4)
v_mfma_f32_16x16x32_bf16 v[116:119], v[164:167], v[216:219], v[116:119]
ds_read_b128 v[232:235], v35 offset:11264
s_waitcnt lgkmcnt(4)
v_mfma_f32_16x16x32_bf16 v[132:135], v[164:167], v[220:223], v[132:135]
ds_read_b128 v[236:239], v35 offset:19456
s_waitcnt lgkmcnt(4)
v_mfma_f32_16x16x32_bf16 v[148:151], v[164:167], v[224:227], v[148:151]
v_mfma_f32_16x16x32_bf16 v[240:243], a[8:11], v[216:219], v[240:243]
v_mfma_f32_16x16x32_bf16 v[244:247], a[8:11], v[220:223], v[244:247]
v_mfma_f32_16x16x32_bf16 v[248:251], a[8:11], v[224:227], v[248:251]
ds_read_b128 v[172:175], v29 offset:6144
s_waitcnt lgkmcnt(3)
v_mfma_f32_16x16x32_bf16 v[116:119], v[168:171], v[228:231], v[116:119]
s_waitcnt lgkmcnt(2)
v_mfma_f32_16x16x32_bf16 v[132:135], v[168:171], v[232:235], v[132:135]
s_waitcnt lgkmcnt(1)
v_mfma_f32_16x16x32_bf16 v[148:151], v[168:171], v[236:239], v[148:151]
ds_read_b128 v[176:179], v30 offset:6144
v_mfma_f32_16x16x32_bf16 v[240:243], a[12:15], v[228:231], v[240:243]
v_mfma_f32_16x16x32_bf16 v[244:247], a[12:15], v[232:235], v[244:247]
v_mfma_f32_16x16x32_bf16 v[248:251], a[12:15], v[236:239], v[248:251]
s_waitcnt vmcnt(4)
ds_read_b128 v[180:183], v29 offset:8192
s_waitcnt lgkmcnt(2)
v_mfma_f32_16x16x32_bf16 v[120:123], v[172:175], v[216:219], v[120:123]
v_mfma_f32_16x16x32_bf16 v[136:139], v[172:175], v[220:223], v[136:139]
v_mfma_f32_16x16x32_bf16 v[152:155], v[172:175], v[224:227], v[152:155]
ds_read_b128 v[184:187], v30 offset:8192
s_waitcnt lgkmcnt(2)
v_mfma_f32_16x16x32_bf16 v[120:123], v[176:179], v[228:231], v[120:123]
s_add_u32 m0, s63, 0x1000
s_nop 0
buffer_load_dwordx4 v21, s[48:51], s79 offen offset:0 lds
buffer_load_dwordx4 v22, s[48:51], s79 offen offset:1024 lds
buffer_load_dwordx4 v23, s[48:51], s79 offen offset:2048 lds
buffer_load_dwordx4 v24, s[48:51], s79 offen offset:3072 lds
v_mfma_f32_16x16x32_bf16 v[136:139], v[176:179], v[232:235], v[136:139]
v_mfma_f32_16x16x32_bf16 v[152:155], v[176:179], v[236:239], v[152:155]
ds_read_b128 v[188:191], v29 offset:10240
s_waitcnt lgkmcnt(2)
v_mfma_f32_16x16x32_bf16 v[124:127], v[180:183], v[216:219], v[124:127]
v_mfma_f32_16x16x32_bf16 v[140:143], v[180:183], v[220:223], v[140:143]
v_mfma_f32_16x16x32_bf16 v[156:159], v[180:183], v[224:227], v[156:159]
ds_read_b128 v[192:195], v30 offset:10240
s_waitcnt lgkmcnt(2)
v_mfma_f32_16x16x32_bf16 v[124:127], v[184:187], v[228:231], v[124:127]
v_mfma_f32_16x16x32_bf16 v[140:143], v[184:187], v[232:235], v[140:143]
v_mfma_f32_16x16x32_bf16 v[156:159], v[184:187], v[236:239], v[156:159]
ds_read_b128 v[204:207], v35 offset:4096
s_waitcnt vmcnt(4)
ds_read_b128 v[196:199], v29 offset:0
s_waitcnt lgkmcnt(3)
v_mfma_f32_16x16x32_bf16 v[128:131], v[188:191], v[216:219], v[128:131]
ds_read_b128 v[208:211], v35 offset:12288
v_mfma_f32_16x16x32_bf16 v[144:147], v[188:191], v[220:223], v[144:147]
ds_read_b128 v[212:215], v35 offset:20480
v_mfma_f32_16x16x32_bf16 v[160:163], v[188:191], v[224:227], v[160:163]
s_waitcnt lgkmcnt(4)
v_mfma_f32_16x16x32_bf16 v[128:131], v[192:195], v[228:231], v[128:131]
s_add_u32 m0, s63, 0x2000
s_nop 0
buffer_load_dwordx4 v21, s[48:51], s80 offen offset:0 lds
buffer_load_dwordx4 v22, s[48:51], s80 offen offset:1024 lds
buffer_load_dwordx4 v23, s[48:51], s80 offen offset:2048 lds
buffer_load_dwordx4 v24, s[48:51], s80 offen offset:3072 lds
v_mfma_f32_16x16x32_bf16 v[144:147], v[192:195], v[232:235], v[144:147]
v_mfma_f32_16x16x32_bf16 v[160:163], v[192:195], v[236:239], v[160:163]
ds_read_b128 v[216:219], v35 offset:5120
ds_read_b128 v[200:203], v30 offset:0
s_waitcnt lgkmcnt(4)
v_mfma_f32_16x16x32_bf16 v[116:119], v[196:199], v[204:207], v[116:119]
ds_read_b128 v[220:223], v35 offset:13312
s_waitcnt lgkmcnt(4)
v_mfma_f32_16x16x32_bf16 v[132:135], v[196:199], v[208:211], v[132:135]
ds_read_b128 v[224:227], v35 offset:21504
s_waitcnt lgkmcnt(4)
v_mfma_f32_16x16x32_bf16 v[148:151], v[196:199], v[212:215], v[148:151]
v_mfma_f32_16x16x32_bf16 v[240:243], a[16:19], v[204:207], v[240:243]
v_mfma_f32_16x16x32_bf16 v[244:247], a[16:19], v[208:211], v[244:247]
v_mfma_f32_16x16x32_bf16 v[248:251], a[16:19], v[212:215], v[248:251]
ds_read_b128 v[164:167], v29 offset:2048
s_waitcnt lgkmcnt(3)
v_mfma_f32_16x16x32_bf16 v[116:119], v[200:203], v[216:219], v[116:119]
s_waitcnt lgkmcnt(2)
v_mfma_f32_16x16x32_bf16 v[132:135], v[200:203], v[220:223], v[132:135]
s_waitcnt lgkmcnt(1)
v_mfma_f32_16x16x32_bf16 v[148:151], v[200:203], v[224:227], v[148:151]
ds_read_b128 v[168:171], v30 offset:2048
v_mfma_f32_16x16x32_bf16 v[240:243], a[20:23], v[216:219], v[240:243]
v_mfma_f32_16x16x32_bf16 v[244:247], a[20:23], v[220:223], v[244:247]
v_mfma_f32_16x16x32_bf16 v[248:251], a[20:23], v[224:227], v[248:251]
s_waitcnt vmcnt(4)
ds_read_b128 v[172:175], v29 offset:4096
s_waitcnt lgkmcnt(2)
v_mfma_f32_16x16x32_bf16 v[120:123], v[164:167], v[204:207], v[120:123]
v_mfma_f32_16x16x32_bf16 v[136:139], v[164:167], v[208:211], v[136:139]
v_mfma_f32_16x16x32_bf16 v[152:155], v[164:167], v[212:215], v[152:155]
ds_read_b128 v[176:179], v30 offset:4096
s_waitcnt lgkmcnt(2)
v_mfma_f32_16x16x32_bf16 v[120:123], v[168:171], v[216:219], v[120:123]
s_add_u32 m0, s63, 0x0
s_nop 0
buffer_load_dwordx4 v21, s[48:51], s81 offen offset:0 lds
buffer_load_dwordx4 v22, s[48:51], s81 offen offset:1024 lds
buffer_load_dwordx4 v23, s[48:51], s81 offen offset:2048 lds
buffer_load_dwordx4 v24, s[48:51], s81 offen offset:3072 lds
v_mfma_f32_16x16x32_bf16 v[136:139], v[168:171], v[220:223], v[136:139]
v_and_or_b32 v47, v47, v6, v7
v_and_or_b32 v51, v51, v6, v7
v_mfma_f32_16x16x32_bf16 v[152:155], v[168:171], v[224:227], v[152:155]
ds_read_b128 v[180:183], v29 offset:6144
v_and_or_b32 v55, v55, v6, v7
s_waitcnt lgkmcnt(2)
v_mfma_f32_16x16x32_bf16 v[124:127], v[172:175], v[204:207], v[124:127]
v_and_or_b32 v59, v59, v6, v7
v_and_or_b32 v63, v63, v6, v7
v_mfma_f32_16x16x32_bf16 v[140:143], v[172:175], v[208:211], v[140:143]
v_and_or_b32 v67, v67, v6, v7
buffer_store_dwordx4 v[44:47], v16, s[56:59], s64 offen offset:0 sc1
v_mfma_f32_16x16x32_bf16 v[156:159], v[172:175], v[212:215], v[156:159]
ds_read_b128 v[184:187], v30 offset:6144
buffer_store_dwordx4 v[48:51], v16, s[56:59], s64 offen offset:1024 sc1
s_waitcnt lgkmcnt(2)
v_mfma_f32_16x16x32_bf16 v[124:127], v[176:179], v[216:219], v[124:127]
buffer_store_dwordx4 v[52:55], v16, s[56:59], s64 offen offset:2048 sc1
buffer_store_dwordx4 v[56:59], v16, s[56:59], s64 offen offset:3072 sc1
v_mfma_f32_16x16x32_bf16 v[140:143], v[176:179], v[220:223], v[140:143]
buffer_store_dwordx4 v[60:63], v16, s[56:59], s65 offen offset:0 sc1
buffer_store_dwordx4 v[64:67], v16, s[56:59], s65 offen offset:1024 sc1
v_mfma_f32_16x16x32_bf16 v[156:159], v[176:179], v[224:227], v[156:159]
ds_read_b128 v[228:231], v35 offset:6144
s_waitcnt vmcnt(10)
ds_read_b128 v[188:191], v29 offset:8192
s_waitcnt lgkmcnt(3)
v_mfma_f32_16x16x32_bf16 v[128:131], v[180:183], v[204:207], v[128:131]
ds_read_b128 v[232:235], v35 offset:14336
v_mfma_f32_16x16x32_bf16 v[144:147], v[180:183], v[208:211], v[144:147]
ds_read_b128 v[236:239], v35 offset:22528
v_mfma_f32_16x16x32_bf16 v[160:163], v[180:183], v[212:215], v[160:163]
s_waitcnt lgkmcnt(4)
v_mfma_f32_16x16x32_bf16 v[128:131], v[184:187], v[216:219], v[128:131]
v_mfma_f32_16x16x32_bf16 v[144:147], v[184:187], v[220:223], v[144:147]
v_mfma_f32_16x16x32_bf16 v[160:163], v[184:187], v[224:227], v[160:163]
ds_read_b128 v[204:207], v35 offset:7168
ds_read_b128 v[192:195], v30 offset:8192
s_waitcnt lgkmcnt(4)
v_mfma_f32_16x16x32_bf16 v[116:119], v[188:191], v[228:231], v[116:119]
ds_read_b128 v[208:211], v35 offset:15360
s_waitcnt lgkmcnt(4)
v_mfma_f32_16x16x32_bf16 v[132:135], v[188:191], v[232:235], v[132:135]
ds_read_b128 v[212:215], v35 offset:23552
s_waitcnt lgkmcnt(4)
v_mfma_f32_16x16x32_bf16 v[148:151], v[188:191], v[236:239], v[148:151]
v_mfma_f32_16x16x32_bf16 v[240:243], a[24:27], v[228:231], v[240:243]
v_mfma_f32_16x16x32_bf16 v[244:247], a[24:27], v[232:235], v[244:247]
v_mfma_f32_16x16x32_bf16 v[248:251], a[24:27], v[236:239], v[248:251]
ds_read_b128 v[196:199], v29 offset:10240
s_waitcnt lgkmcnt(3)
v_mfma_f32_16x16x32_bf16 v[116:119], v[192:195], v[204:207], v[116:119]
s_waitcnt lgkmcnt(2)
v_mfma_f32_16x16x32_bf16 v[132:135], v[192:195], v[208:211], v[132:135]
s_waitcnt lgkmcnt(1)
v_mfma_f32_16x16x32_bf16 v[148:151], v[192:195], v[212:215], v[148:151]
ds_read_b128 v[200:203], v30 offset:10240
v_mfma_f32_16x16x32_bf16 v[240:243], a[28:31], v[204:207], v[240:243]
v_mfma_f32_16x16x32_bf16 v[244:247], a[28:31], v[208:211], v[244:247]
v_mfma_f32_16x16x32_bf16 v[248:251], a[28:31], v[212:215], v[248:251]
s_waitcnt vmcnt(6)
ds_read_b128 v[164:167], v29 offset:0
s_waitcnt lgkmcnt(2)
v_mfma_f32_16x16x32_bf16 v[120:123], v[196:199], v[228:231], v[120:123]
v_mfma_f32_16x16x32_bf16 v[136:139], v[196:199], v[232:235], v[136:139]
v_mfma_f32_16x16x32_bf16 v[152:155], v[196:199], v[236:239], v[152:155]
ds_read_b128 v[168:171], v30 offset:0
s_waitcnt lgkmcnt(2)
v_mfma_f32_16x16x32_bf16 v[120:123], v[200:203], v[204:207], v[120:123]
v_mul_f32 v240, s86, v240
v_mul_f32 v244, s86, v244
v_mul_f32 v248, s86, v248
v_mfma_f32_16x16x32_bf16 v[136:139], v[200:203], v[208:211], v[136:139]
v_mfma_f32_16x16x32_bf16 v[152:155], v[200:203], v[212:215], v[152:155]
ds_read_b128 v[172:175], v29 offset:2048
s_waitcnt lgkmcnt(2)
v_mfma_f32_16x16x32_bf16 v[124:127], v[164:167], v[228:231], v[124:127]
v_fma_f32 v116, s86, v116, -v240
v_fma_f32 v117, s86, v117, -v240
v_fma_f32 v118, s86, v118, -v240
v_fma_f32 v119, s86, v119, -v240
v_fma_f32 v120, s86, v120, -v240
v_fma_f32 v121, s86, v121, -v240
v_fma_f32 v122, s86, v122, -v240
v_fma_f32 v123, s86, v123, -v240
v_cvt_pk_bf16_f32 v116, v116, v117
v_cvt_pk_bf16_f32 v117, v118, v119
v_cvt_pk_bf16_f32 v118, v120, v121
v_cvt_pk_bf16_f32 v119, v122, v123
buffer_store_dwordx4 v[116:119], v16, s[52:55], s82 offen offset:0 sc1
v_mfma_f32_16x16x32_bf16 v[140:143], v[164:167], v[232:235], v[140:143]
v_fma_f32 v132, s86, v132, -v244
v_fma_f32 v133, s86, v133, -v244
v_fma_f32 v134, s86, v134, -v244
v_fma_f32 v135, s86, v135, -v244
v_fma_f32 v136, s86, v136, -v244
v_fma_f32 v137, s86, v137, -v244
v_fma_f32 v138, s86, v138, -v244
v_fma_f32 v139, s86, v139, -v244
v_cvt_pk_bf16_f32 v132, v132, v133
v_cvt_pk_bf16_f32 v133, v134, v135
v_cvt_pk_bf16_f32 v134, v136, v137
v_cvt_pk_bf16_f32 v135, v138, v139
buffer_store_dwordx4 v[132:135], v16, s[52:55], s83 offen offset:0 sc1
v_mfma_f32_16x16x32_bf16 v[156:159], v[164:167], v[236:239], v[156:159]
ds_read_b128 v[176:179], v30 offset:2048
v_fma_f32 v148, s86, v148, -v248
v_fma_f32 v149, s86, v149, -v248
v_fma_f32 v150, s86, v150, -v248
v_fma_f32 v151, s86, v151, -v248
v_fma_f32 v152, s86, v152, -v248
v_fma_f32 v153, s86, v153, -v248
v_fma_f32 v154, s86, v154, -v248
v_fma_f32 v155, s86, v155, -v248
v_cvt_pk_bf16_f32 v148, v148, v149
v_cvt_pk_bf16_f32 v149, v150, v151
v_cvt_pk_bf16_f32 v150, v152, v153
v_cvt_pk_bf16_f32 v151, v154, v155
buffer_store_dwordx4 v[148:151], v16, s[52:55], s84 offen offset:0 sc1
s_waitcnt lgkmcnt(2)
v_mfma_f32_16x16x32_bf16 v[124:127], v[168:171], v[204:207], v[124:127]
v_mfma_f32_16x16x32_bf16 v[140:143], v[168:171], v[208:211], v[140:143]
v_mfma_f32_16x16x32_bf16 v[156:159], v[168:171], v[212:215], v[156:159]
s_waitcnt lgkmcnt(1)
v_mfma_f32_16x16x32_bf16 v[128:131], v[172:175], v[228:231], v[128:131]
v_mfma_f32_16x16x32_bf16 v[144:147], v[172:175], v[232:235], v[144:147]
v_mfma_f32_16x16x32_bf16 v[160:163], v[172:175], v[236:239], v[160:163]
s_waitcnt lgkmcnt(0)
v_mfma_f32_16x16x32_bf16 v[128:131], v[176:179], v[204:207], v[128:131]
v_mfma_f32_16x16x32_bf16 v[144:147], v[176:179], v[208:211], v[144:147]
v_mfma_f32_16x16x32_bf16 v[160:163], v[176:179], v[212:215], v[160:163]
v_fma_f32 v124, s86, v124, -v240
v_fma_f32 v125, s86, v125, -v240
v_fma_f32 v126, s86, v126, -v240
v_fma_f32 v127, s86, v127, -v240
s_nop 1
v_fma_f32 v128, s86, v128, -v240
v_fma_f32 v129, s86, v129, -v240
v_fma_f32 v130, s86, v130, -v240
v_fma_f32 v131, s86, v131, -v240
v_cvt_pk_bf16_f32 v124, v124, v125
v_cvt_pk_bf16_f32 v125, v126, v127
v_cvt_pk_bf16_f32 v126, v128, v129
v_cvt_pk_bf16_f32 v127, v130, v131
buffer_store_dwordx4 v[124:127], v16, s[52:55], s82 offen offset:1024 sc1
v_fma_f32 v140, s86, v140, -v244
v_fma_f32 v141, s86, v141, -v244
v_fma_f32 v142, s86, v142, -v244
v_fma_f32 v143, s86, v143, -v244
v_fma_f32 v144, s86, v144, -v244
v_fma_f32 v145, s86, v145, -v244
v_fma_f32 v146, s86, v146, -v244
v_fma_f32 v147, s86, v147, -v244
v_cvt_pk_bf16_f32 v140, v140, v141
v_cvt_pk_bf16_f32 v141, v142, v143
v_cvt_pk_bf16_f32 v142, v144, v145
v_cvt_pk_bf16_f32 v143, v146, v147
buffer_store_dwordx4 v[140:143], v16, s[52:55], s83 offen offset:1024 sc1
v_fma_f32 v156, s86, v156, -v248
v_fma_f32 v157, s86, v157, -v248
v_fma_f32 v158, s86, v158, -v248
v_fma_f32 v159, s86, v159, -v248
v_fma_f32 v160, s86, v160, -v248
v_fma_f32 v161, s86, v161, -v248
v_fma_f32 v162, s86, v162, -v248
v_fma_f32 v163, s86, v163, -v248
v_cvt_pk_bf16_f32 v156, v156, v157
v_cvt_pk_bf16_f32 v157, v158, v159
v_cvt_pk_bf16_f32 v158, v160, v161
v_cvt_pk_bf16_f32 v159, v162, v163
buffer_store_dwordx4 v[156:159], v16, s[52:55], s84 offen offset:1024 sc1
L1_fin:
s_add_u32 s91, s91, 1344
s_waitcnt lgkmcnt(0)
s_add_u32 s98, s98, 0x7f4a7c15
s_addc_u32 s99, s99, 0x9e3779b9
LM_pub:
s_add_u32 s40, s38, 0x7c00000
s_addc_u32 s41, s39, 0
s_mov_b32 s42, 0x80000
s_mov_b32 s43, 0x00020000
s_lshl_b32 s6, s91, 7
s_cmp_eq_u32 s60, 0
s_cselect_b32 s6, s6, 0x70000000
v_lshlrev_b32 v12, 4, v2
s_waitcnt vmcnt(0) lgkmcnt(0)
s_barrier
v_mov_b32 v8, s98
v_mov_b32 v9, s99
v_mov_b32 v10, s98
v_mov_b32 v11, s99
s_mov_b64 exec, 0xff
buffer_store_dwordx4 v[8:11], v12, s[40:43], s6 offen sc1
s_mov_b64 exec, -1
s_cmp_eq_u32 s61, 0
s_cbranch_scc1 L2_entry
s_mov_b32 s61, 0
s_sub_u32 s4, s91, 1578
s_min_u32 s6, s4, 14
s_cmp_lt_u32 s4, 6
s_cselect_b32 s6, 0, s6
s_sub_u32 s4, s4, s6
s_add_u32 s91, s4, 1600
v_lshlrev_b32 v16, 4, v2
s_mul_i32 s63, s60, 12288
s_and_b32 s6, s4, 3
s_lshl_b32 s6, s6, 6
s_mul_i32 s7, s60, 16
s_add_u32 s6, s6, s7
v_lshrrev_b32 v5, 5, v2
v_and_b32 v6, 31, v2
v_lshlrev_b32 v6, 4, v6
s_cmp_ge_u32 s4, 4
s_cselect_b64 vcc, -1, 0
v_add3_u32 v7, v5, s6, 0
v_and_b32 v8, 0x80, v7
v_bfe_u32 v9, v7, 2, 1
v_lshl_or_b32 v8, v9, 6, v8
v_bfe_u32 v9, v7, 4, 1
v_lshl_or_b32 v8, v9, 5, v8
v_and_b32 v9, 3, v7
v_lshl_or_b32 v8, v9, 3, v8
v_bfe_u32 v9, v7, 5, 2
v_lshl_or_b32 v8, v9, 1, v8
v_bfe_u32 v9, v7, 3, 1
v_or_b32 v8, v9, v8
v_cndmask_b32 v8, v8, v7, vcc
v_lshl_add_u32 v44, v8, 9, v6
v_add3_u32 v7, v5, s6, 2
v_and_b32 v8, 0x80, v7
v_bfe_u32 v9, v7, 2, 1
v_lshl_or_b32 v8, v9, 6, v8
v_bfe_u32 v9, v7, 4, 1
v_lshl_or_b32 v8, v9, 5, v8
v_and_b32 v9, 3, v7
v_lshl_or_b32 v8, v9, 3, v8
v_bfe_u32 v9, v7, 5, 2
v_lshl_or_b32 v8, v9, 1, v8
v_bfe_u32 v9, v7, 3, 1
v_or_b32 v8, v9, v8
v_cndmask_b32 v8, v8, v7, vcc
v_lshl_add_u32 v48, v8, 9, v6
v_add3_u32 v7, v5, s6, 4
v_and_b32 v8, 0x80, v7
v_bfe_u32 v9, v7, 2, 1
v_lshl_or_b32 v8, v9, 6, v8
v_bfe_u32 v9, v7, 4, 1
v_lshl_or_b32 v8, v9, 5, v8
v_and_b32 v9, 3, v7
v_lshl_or_b32 v8, v9, 3, v8
v_bfe_u32 v9, v7, 5, 2
v_lshl_or_b32 v8, v9, 1, v8
v_bfe_u32 v9, v7, 3, 1
v_or_b32 v8, v9, v8
v_cndmask_b32 v8, v8, v7, vcc
v_lshl_add_u32 v52, v8, 9, v6
v_add3_u32 v7, v5, s6, 6
v_and_b32 v8, 0x80, v7
v_bfe_u32 v9, v7, 2, 1
v_lshl_or_b32 v8, v9, 6, v8
v_bfe_u32 v9, v7, 4, 1
v_lshl_or_b32 v8, v9, 5, v8
v_and_b32 v9, 3, v7
v_lshl_or_b32 v8, v9, 3, v8
v_bfe_u32 v9, v7, 5, 2
v_lshl_or_b32 v8, v9, 1, v8
v_bfe_u32 v9, v7, 3, 1
v_or_b32 v8, v9, v8
v_cndmask_b32 v8, v8, v7, vcc
v_lshl_add_u32 v56, v8, 9, v6
v_add3_u32 v7, v5, s6, 8
v_and_b32 v8, 0x80, v7
v_bfe_u32 v9, v7, 2, 1
v_lshl_or_b32 v8, v9, 6, v8
v_bfe_u32 v9, v7, 4, 1
v_lshl_or_b32 v8, v9, 5, v8
v_and_b32 v9, 3, v7
v_lshl_or_b32 v8, v9, 3, v8
v_bfe_u32 v9, v7, 5, 2
v_lshl_or_b32 v8, v9, 1, v8
v_bfe_u32 v9, v7, 3, 1
v_or_b32 v8, v9, v8
v_cndmask_b32 v8, v8, v7, vcc
v_lshl_add_u32 v60, v8, 9, v6
v_add3_u32 v7, v5, s6, 10
v_and_b32 v8, 0x80, v7
v_bfe_u32 v9, v7, 2, 1
v_lshl_or_b32 v8, v9, 6, v8
v_bfe_u32 v9, v7, 4, 1
v_lshl_or_b32 v8, v9, 5, v8
v_and_b32 v9, 3, v7
v_lshl_or_b32 v8, v9, 3, v8
v_bfe_u32 v9, v7, 5, 2
v_lshl_or_b32 v8, v9, 1, v8
v_bfe_u32 v9, v7, 3, 1
v_or_b32 v8, v9, v8
v_cndmask_b32 v8, v8, v7, vcc
v_lshl_add_u32 v64, v8, 9, v6
v_add3_u32 v7, v5, s6, 12
v_and_b32 v8, 0x80, v7
v_bfe_u32 v9, v7, 2, 1
v_lshl_or_b32 v8, v9, 6, v8
v_bfe_u32 v9, v7, 4, 1
v_lshl_or_b32 v8, v9, 5, v8
v_and_b32 v9, 3, v7
v_lshl_or_b32 v8, v9, 3, v8
v_bfe_u32 v9, v7, 5, 2
v_lshl_or_b32 v8, v9, 1, v8
v_bfe_u32 v9, v7, 3, 1
v_or_b32 v8, v9, v8
v_cndmask_b32 v8, v8, v7, vcc
v_lshl_add_u32 v68, v8, 9, v6
v_add3_u32 v7, v5, s6, 14
v_and_b32 v8, 0x80, v7
v_bfe_u32 v9, v7, 2, 1
v_lshl_or_b32 v8, v9, 6, v8
v_bfe_u32 v9, v7, 4, 1
v_lshl_or_b32 v8, v9, 5, v8
v_and_b32 v9, 3, v7
v_lshl_or_b32 v8, v9, 3, v8
v_bfe_u32 v9, v7, 5, 2
v_lshl_or_b32 v8, v9, 1, v8
v_bfe_u32 v9, v7, 3, 1
v_or_b32 v8, v9, v8
v_cndmask_b32 v8, v8, v7, vcc
v_lshl_add_u32 v72, v8, 9, v6
s_lshl_b32 s7, s60, 7
v_lshrrev_b32 v5, 3, v2
v_and_b32 v6, 7, v2
v_and_b32 v7, 2, v5
v_xor_b32 v6, v6, v7
v_lshl_add_u32 v5, v5, 9, s7
v_lshl_add_u32 v17, v6, 4, v5
v_xor_b32 v6, 4, v6
v_lshl_add_u32 v18, v6, 4, v5
v_add_u32 v18, 0xc00, v18
v_add_u32 v19, 0x1800, v17
v_add_u32 v20, 0x1800, v18
s_xor_b32 s6, s62, 0
s_lshl_b32 s66, s6, 14
s_xor_b32 s6, s62, 1
s_lshl_b32 s67, s6, 14
s_xor_b32 s6, s62, 2
s_lshl_b32 s68, s6, 14
s_xor_b32 s6, s62, 3
s_lshl_b32 s69, s6, 14
s_xor_b32 s6, s62, 4
s_lshl_b32 s70, s6, 14
s_xor_b32 s6, s62, 5
s_lshl_b32 s71, s6, 14
s_xor_b32 s6, s62, 6
s_lshl_b32 s72, s6, 14
s_xor_b32 s6, s62, 7
s_lshl_b32 s73, s6, 14
s_waitcnt lgkmcnt(0)
s_cmp_ge_u32 s4, 4
s_cselect_b32 s6, s30, s24
s_cselect_b32 s7, s31, s25
s_add_u32 s40, s6, 0x0
s_addc_u32 s41, s7, 0
s_mov_b32 s42, 0x20000
s_mov_b32 s43, 0x00020000
s_add_u32 s44, s32, 0x0
s_addc_u32 s45, s33, 0
s_mov_b32 s46, 0x20000
s_mov_b32 s47, 0x00020000
buffer_load_dwordx4 v[44:47], v44, s[40:43], 0 offen
buffer_load_dwordx4 v[48:51], v48, s[40:43], 0 offen
buffer_load_dwordx4 v[52:55], v52, s[40:43], 0 offen
buffer_load_dwordx4 v[56:59], v56, s[40:43], 0 offen
buffer_load_dwordx4 v[60:63], v60, s[40:43], 0 offen
buffer_load_dwordx4 v[64:67], v64, s[40:43], 0 offen
buffer_load_dwordx4 v[68:71], v68, s[40:43], 0 offen
buffer_load_dwordx4 v[72:75], v72, s[40:43], 0 offen
s_add_u32 m0, s63, 0x0
s_nop 0
buffer_load_dwordx4 v17, s[44:47], s66 offen offset:0 lds
buffer_load_dwordx4 v18, s[44:47], s66 offen offset:1024 lds
buffer_load_dwordx4 v19, s[44:47], s66 offen offset:2048 lds
buffer_load_dwordx4 v20, s[44:47], s66 offen offset:3072 lds
s_add_u32 m0, s63, 0x1000
s_nop 0
buffer_load_dwordx4 v17, s[44:47], s67 offen offset:0 lds
buffer_load_dwordx4 v18, s[44:47], s67 offen offset:1024 lds
buffer_load_dwordx4 v19, s[44:47], s67 offen offset:2048 lds
buffer_load_dwordx4 v20, s[44:47], s67 offen offset:3072 lds
v_bfe_u32 v5, v2, 2, 3
v_xor_b32 v5, s62, v5
v_and_b32 v6, 3, v2
v_lshlrev_b32 v7, 10, v5
v_lshl_add_u32 v7, v6, 8, v7
v_add_u32 v7, 0xc000, v7
v_and_b32 v5, 1, v5
v_lshl_or_b32 v6, v5, 2, v6
v_lshrrev_b32 v5, 5, v2
s_mul_i32 s6, s60, 16
v_add3_u32 v8, v5, s6, 0
v_lshrrev_b32 v9, 4, v8
v_lshl_add_u32 v9, v9, 13, v7
v_and_b32 v8, 15, v8
v_xor_b32 v8, v8, v6
v_lshl_add_u32 v36, v8, 4, v9
v_add3_u32 v8, v5, s6, 2
v_lshrrev_b32 v9, 4, v8
v_lshl_add_u32 v9, v9, 13, v7
v_and_b32 v8, 15, v8
v_xor_b32 v8, v8, v6
v_lshl_add_u32 v37, v8, 4, v9
v_add3_u32 v8, v5, s6, 4
v_lshrrev_b32 v9, 4, v8
v_lshl_add_u32 v9, v9, 13, v7
v_and_b32 v8, 15, v8
v_xor_b32 v8, v8, v6
v_lshl_add_u32 v38, v8, 4, v9
v_add3_u32 v8, v5, s6, 6
v_lshrrev_b32 v9, 4, v8
v_lshl_add_u32 v9, v9, 13, v7
v_and_b32 v8, 15, v8
v_xor_b32 v8, v8, v6
v_lshl_add_u32 v39, v8, 4, v9
v_add3_u32 v8, v5, s6, 8
v_lshrrev_b32 v9, 4, v8
v_lshl_add_u32 v9, v9, 13, v7
v_and_b32 v8, 15, v8
v_xor_b32 v8, v8, v6
v_lshl_add_u32 v40, v8, 4, v9
v_add3_u32 v8, v5, s6, 10
v_lshrrev_b32 v9, 4, v8
v_lshl_add_u32 v9, v9, 13, v7
v_and_b32 v8, 15, v8
v_xor_b32 v8, v8, v6
v_lshl_add_u32 v41, v8, 4, v9
v_add3_u32 v8, v5, s6, 12
v_lshrrev_b32 v9, 4, v8
v_lshl_add_u32 v9, v9, 13, v7
v_and_b32 v8, 15, v8
v_xor_b32 v8, v8, v6
v_lshl_add_u32 v42, v8, 4, v9
v_add3_u32 v8, v5, s6, 14
v_lshrrev_b32 v9, 4, v8
v_lshl_add_u32 v9, v9, 13, v7
v_and_b32 v8, 15, v8
v_xor_b32 v8, v8, v6
v_lshl_add_u32 v43, v8, 4, v9
v_xor_b32 v5, v3, v4
v_lshlrev_b32 v5, 4, v5
v_lshl_add_u32 v5, v4, 8, v5
v_add_u32 v31, 0xc000, v5
v_xor_b32 v32, 64, v31
v_lshrrev_b32 v5, 2, v3
v_and_b32 v6, 3, v3
v_and_b32 v7, 1, v4
v_lshlrev_b32 v7, 2, v7
v_and_b32 v8, 2, v5
v_or_b32 v7, v7, v8
v_lshl_add_u32 v8, v4, 3, v5
v_lshlrev_b32 v8, 7, v8
v_add_u32 v8, s63, v8
v_xor_b32 v6, v6, v7
v_xor_b32 v9, 0, v6
v_lshl_add_u32 v25, v9, 4, v8
v_add_u32 v26, 8, v25
v_xor_b32 v9, 4, v6
v_lshl_add_u32 v27, v9, 4, v8
v_add_u32 v28, 8, v27
s_lshr_b32 s6, s4, 2
s_lshl_b32 s6, s6, 17
s_and_b32 s7, s4, 3
s_lshl_b32 s7, s7, 12
s_add_u32 s6, s6, s7
s_mul_i32 s7, s60, 32768
s_add_u32 s82, s6, s7
s_add_u32 s83, s82, 16384
s_add_u32 s52, s38, 0x1000000
s_addc_u32 s53, s39, 0
s_mov_b32 s54, 0x40000
s_mov_b32 s55, 0x00020000
v_and_b32 v5, 31, v2
v_lshlrev_b32 v5, 4, v5
s_mov_b32 s6, 130560
s_mov_b32 s90, 0xffff0000
buffer_load_dwordx4 v[92:95], v5, s[40:43], s6 offen
s_waitcnt vmcnt(0)
v_lshlrev_b32 v84, 16, v92
v_lshlrev_b32 v86, 16, v93
v_lshlrev_b32 v88, 16, v94
v_lshlrev_b32 v90, 16, v95
v_and_b32 v85, s90, v92
v_and_b32 v87, s90, v93
v_and_b32 v89, s90, v94
v_and_b32 v91, s90, v95
v_lshlrev_b32 v76, 16, v44
v_lshlrev_b32 v78, 16, v45
v_lshlrev_b32 v80, 16, v46
v_lshlrev_b32 v82, 16, v47
v_and_b32 v77, s90, v44
v_and_b32 v79, s90, v45
v_and_b32 v81, s90, v46
v_and_b32 v83, s90, v47
v_sub_f32 v76, v76, v84
v_sub_f32 v77, v77, v85
v_sub_f32 v78, v78, v86
v_sub_f32 v79, v79, v87
v_sub_f32 v80, v80, v88
v_sub_f32 v81, v81, v89
v_sub_f32 v82, v82, v90
v_sub_f32 v83, v83, v91
v_cvt_pk_bf16_f32 v44, v76, v77
v_cvt_pk_bf16_f32 v45, v78, v79
v_cvt_pk_bf16_f32 v46, v80, v81
v_cvt_pk_bf16_f32 v47, v82, v83
v_lshlrev_b32 v76, 16, v48
v_lshlrev_b32 v78, 16, v49
v_lshlrev_b32 v80, 16, v50
v_lshlrev_b32 v82, 16, v51
v_and_b32 v77, s90, v48
v_and_b32 v79, s90, v49
v_and_b32 v81, s90, v50
v_and_b32 v83, s90, v51
v_sub_f32 v76, v76, v84
v_sub_f32 v77, v77, v85
v_sub_f32 v78, v78, v86
v_sub_f32 v79, v79, v87
v_sub_f32 v80, v80, v88
v_sub_f32 v81, v81, v89
v_sub_f32 v82, v82, v90
v_sub_f32 v83, v83, v91
v_cvt_pk_bf16_f32 v48, v76, v77
v_cvt_pk_bf16_f32 v49, v78, v79
v_cvt_pk_bf16_f32 v50, v80, v81
v_cvt_pk_bf16_f32 v51, v82, v83
v_lshlrev_b32 v76, 16, v52
v_lshlrev_b32 v78, 16, v53
v_lshlrev_b32 v80, 16, v54
v_lshlrev_b32 v82, 16, v55
v_and_b32 v77, s90, v52
v_and_b32 v79, s90, v53
v_and_b32 v81, s90, v54
v_and_b32 v83, s90, v55
v_sub_f32 v76, v76, v84
v_sub_f32 v77, v77, v85
v_sub_f32 v78, v78, v86
v_sub_f32 v79, v79, v87
v_sub_f32 v80, v80, v88
v_sub_f32 v81, v81, v89
v_sub_f32 v82, v82, v90
v_sub_f32 v83, v83, v91
v_cvt_pk_bf16_f32 v52, v76, v77
v_cvt_pk_bf16_f32 v53, v78, v79
v_cvt_pk_bf16_f32 v54, v80, v81
v_cvt_pk_bf16_f32 v55, v82, v83
v_lshlrev_b32 v76, 16, v56
v_lshlrev_b32 v78, 16, v57
v_lshlrev_b32 v80, 16, v58
v_lshlrev_b32 v82, 16, v59
v_and_b32 v77, s90, v56
v_and_b32 v79, s90, v57
v_and_b32 v81, s90, v58
v_and_b32 v83, s90, v59
v_sub_f32 v76, v76, v84
v_sub_f32 v77, v77, v85
v_sub_f32 v78, v78, v86
v_sub_f32 v79, v79, v87
v_sub_f32 v80, v80, v88
v_sub_f32 v81, v81, v89
v_sub_f32 v82, v82, v90
v_sub_f32 v83, v83, v91
v_cvt_pk_bf16_f32 v56, v76, v77
v_cvt_pk_bf16_f32 v57, v78, v79
v_cvt_pk_bf16_f32 v58, v80, v81
v_cvt_pk_bf16_f32 v59, v82, v83
v_lshlrev_b32 v76, 16, v60
v_lshlrev_b32 v78, 16, v61
v_lshlrev_b32 v80, 16, v62
v_lshlrev_b32 v82, 16, v63
v_and_b32 v77, s90, v60
v_and_b32 v79, s90, v61
v_and_b32 v81, s90, v62
v_and_b32 v83, s90, v63
v_sub_f32 v76, v76, v84
v_sub_f32 v77, v77, v85
v_sub_f32 v78, v78, v86
v_sub_f32 v79, v79, v87
v_sub_f32 v80, v80, v88
v_sub_f32 v81, v81, v89
v_sub_f32 v82, v82, v90
v_sub_f32 v83, v83, v91
v_cvt_pk_bf16_f32 v60, v76, v77
v_cvt_pk_bf16_f32 v61, v78, v79
v_cvt_pk_bf16_f32 v62, v80, v81
v_cvt_pk_bf16_f32 v63, v82, v83
v_lshlrev_b32 v76, 16, v64
v_lshlrev_b32 v78, 16, v65
v_lshlrev_b32 v80, 16, v66
v_lshlrev_b32 v82, 16, v67
v_and_b32 v77, s90, v64
v_and_b32 v79, s90, v65
v_and_b32 v81, s90, v66
v_and_b32 v83, s90, v67
v_sub_f32 v76, v76, v84
v_sub_f32 v77, v77, v85
v_sub_f32 v78, v78, v86
v_sub_f32 v79, v79, v87
v_sub_f32 v80, v80, v88
v_sub_f32 v81, v81, v89
v_sub_f32 v82, v82, v90
v_sub_f32 v83, v83, v91
v_cvt_pk_bf16_f32 v64, v76, v77
v_cvt_pk_bf16_f32 v65, v78, v79
v_cvt_pk_bf16_f32 v66, v80, v81
v_cvt_pk_bf16_f32 v67, v82, v83
v_lshlrev_b32 v76, 16, v68
v_lshlrev_b32 v78, 16, v69
v_lshlrev_b32 v80, 16, v70
v_lshlrev_b32 v82, 16, v71
v_and_b32 v77, s90, v68
v_and_b32 v79, s90, v69
v_and_b32 v81, s90, v70
v_and_b32 v83, s90, v71
v_sub_f32 v76, v76, v84
v_sub_f32 v77, v77, v85
v_sub_f32 v78, v78, v86
v_sub_f32 v79, v79, v87
v_sub_f32 v80, v80, v88
v_sub_f32 v81, v81, v89
v_sub_f32 v82, v82, v90
v_sub_f32 v83, v83, v91
v_cvt_pk_bf16_f32 v68, v76, v77
v_cvt_pk_bf16_f32 v69, v78, v79
v_cvt_pk_bf16_f32 v70, v80, v81
v_cvt_pk_bf16_f32 v71, v82, v83
v_lshlrev_b32 v76, 16, v72
v_lshlrev_b32 v78, 16, v73
v_lshlrev_b32 v80, 16, v74
v_lshlrev_b32 v82, 16, v75
v_and_b32 v77, s90, v72
v_and_b32 v79, s90, v73
v_and_b32 v81, s90, v74
v_and_b32 v83, s90, v75
v_sub_f32 v76, v76, v84
v_sub_f32 v77, v77, v85
v_sub_f32 v78, v78, v86
v_sub_f32 v79, v79, v87
v_sub_f32 v80, v80, v88
v_sub_f32 v81, v81, v89
v_sub_f32 v82, v82, v90
v_sub_f32 v83, v83, v91
v_cvt_pk_bf16_f32 v72, v76, v77
v_cvt_pk_bf16_f32 v73, v78, v79
v_cvt_pk_bf16_f32 v74, v80, v81
v_cvt_pk_bf16_f32 v75, v82, v83
ds_write_b128 v36, v[44:47]
ds_write_b128 v37, v[48:51]
ds_write_b128 v38, v[52:55]
ds_write_b128 v39, v[56:59]
ds_write_b128 v40, v[60:63]
ds_write_b128 v41, v[64:67]
ds_write_b128 v42, v[68:71]
ds_write_b128 v43, v[72:75]
s_add_u32 m0, s63, 0x2000
s_nop 0
buffer_load_dwordx4 v17, s[44:47], s68 offen offset:0 lds
buffer_load_dwordx4 v18, s[44:47], s68 offen offset:1024 lds
buffer_load_dwordx4 v19, s[44:47], s68 offen offset:2048 lds
buffer_load_dwordx4 v20, s[44:47], s68 offen offset:3072 lds
ds_read_b64_tr_b16 v[140:141], v25 offset:0
ds_read_b64_tr_b16 v[142:143], v25 offset:512
ds_read_b64_tr_b16 v[144:145], v26 offset:0
ds_read_b64_tr_b16 v[146:147], v26 offset:512
ds_read_b64_tr_b16 v[148:149], v27 offset:0
ds_read_b64_tr_b16 v[150:151], v27 offset:512
s_waitcnt lgkmcnt(6)
s_barrier
ds_read_b128 v[180:183], v31 offset:0
ds_read_b128 v[184:187], v31 offset:8192
ds_read_b128 v[188:191], v31 offset:16384
ds_read_b128 v[192:195], v31 offset:24576
s_waitcnt lgkmcnt(3)
v_mfma_f32_16x16x32_bf16 v[76:79], v[180:183], v[140:143], 0
s_waitcnt lgkmcnt(2)
v_mfma_f32_16x16x32_bf16 v[80:83], v[184:187], v[140:143], 0
s_waitcnt lgkmcnt(1)
v_mfma_f32_16x16x32_bf16 v[84:87], v[188:191], v[140:143], 0
s_waitcnt lgkmcnt(0)
v_mfma_f32_16x16x32_bf16 v[88:91], v[192:195], v[140:143], 0
ds_read_b64_tr_b16 v[152:153], v28 offset:0
ds_read_b64_tr_b16 v[154:155], v28 offset:512
v_mfma_f32_16x16x32_bf16 v[92:95], v[180:183], v[144:147], 0
v_mfma_f32_16x16x32_bf16 v[96:99], v[184:187], v[144:147], 0
v_mfma_f32_16x16x32_bf16 v[100:103], v[188:191], v[144:147], 0
v_mfma_f32_16x16x32_bf16 v[104:107], v[192:195], v[144:147], 0
ds_read_b128 v[196:199], v32 offset:1024
ds_read_b64_tr_b16 v[156:157], v25 offset:4096
ds_read_b64_tr_b16 v[158:159], v25 offset:4608
v_mfma_f32_16x16x32_bf16 v[108:111], v[180:183], v[148:151], 0
ds_read_b128 v[200:203], v32 offset:9216
v_mfma_f32_16x16x32_bf16 v[112:115], v[184:187], v[148:151], 0
ds_read_b128 v[204:207], v32 offset:17408
v_mfma_f32_16x16x32_bf16 v[116:119], v[188:191], v[148:151], 0
ds_read_b128 v[208:211], v32 offset:25600
v_mfma_f32_16x16x32_bf16 v[120:123], v[192:195], v[148:151], 0
ds_read_b64_tr_b16 v[160:161], v26 offset:4096
ds_read_b64_tr_b16 v[162:163], v26 offset:4608
s_waitcnt lgkmcnt(8)
v_mfma_f32_16x16x32_bf16 v[124:127], v[180:183], v[152:155], 0
s_add_u32 m0, s63, 0x0
s_nop 0
buffer_load_dwordx4 v17, s[44:47], s69 offen offset:0 lds
buffer_load_dwordx4 v18, s[44:47], s69 offen offset:1024 lds
buffer_load_dwordx4 v19, s[44:47], s69 offen offset:2048 lds
buffer_load_dwordx4 v20, s[44:47], s69 offen offset:3072 lds
v_mfma_f32_16x16x32_bf16 v[128:131], v[184:187], v[152:155], 0
v_mfma_f32_16x16x32_bf16 v[132:135], v[188:191], v[152:155], 0
v_mfma_f32_16x16x32_bf16 v[136:139], v[192:195], v[152:155], 0
ds_read_b64_tr_b16 v[164:165], v27 offset:4096
ds_read_b64_tr_b16 v[166:167], v27 offset:4608
s_waitcnt lgkmcnt(7)
v_mfma_f32_16x16x32_bf16 v[76:79], v[196:199], v[156:159], v[76:79]
s_waitcnt lgkmcnt(6)
v_mfma_f32_16x16x32_bf16 v[80:83], v[200:203], v[156:159], v[80:83]
s_waitcnt lgkmcnt(5)
v_mfma_f32_16x16x32_bf16 v[84:87], v[204:207], v[156:159], v[84:87]
s_waitcnt lgkmcnt(4)
v_mfma_f32_16x16x32_bf16 v[88:91], v[208:211], v[156:159], v[88:91]
ds_read_b64_tr_b16 v[168:169], v28 offset:4096
ds_read_b64_tr_b16 v[170:171], v28 offset:4608
s_waitcnt lgkmcnt(4)
v_mfma_f32_16x16x32_bf16 v[92:95], v[196:199], v[160:163], v[92:95]
v_mfma_f32_16x16x32_bf16 v[96:99], v[200:203], v[160:163], v[96:99]
v_mfma_f32_16x16x32_bf16 v[100:103], v[204:207], v[160:163], v[100:103]
v_mfma_f32_16x16x32_bf16 v[104:107], v[208:211], v[160:163], v[104:107]
ds_read_b128 v[212:215], v31 offset:2048
s_waitcnt vmcnt(4)
ds_read_b64_tr_b16 v[172:173], v25 offset:8192
ds_read_b64_tr_b16 v[174:175], v25 offset:8704
s_waitcnt lgkmcnt(5)
v_mfma_f32_16x16x32_bf16 v[108:111], v[196:199], v[164:167], v[108:111]
ds_read_b128 v[216:219], v31 offset:10240
v_mfma_f32_16x16x32_bf16 v[112:115], v[200:203], v[164:167], v[112:115]
ds_read_b128 v[220:223], v31 offset:18432
v_mfma_f32_16x16x32_bf16 v[116:119], v[204:207], v[164:167], v[116:119]
ds_read_b128 v[224:227], v31 offset:26624
v_mfma_f32_16x16x32_bf16 v[120:123], v[208:211], v[164:167], v[120:123]
ds_read_b64_tr_b16 v[176:177], v26 offset:8192
ds_read_b64_tr_b16 v[178:179], v26 offset:8704
s_waitcnt lgkmcnt(8)
v_mfma_f32_16x16x32_bf16 v[124:127], v[196:199], v[168:171], v[124:127]
s_add_u32 m0, s63, 0x1000
s_nop 0
buffer_load_dwordx4 v17, s[44:47], s70 offen offset:0 lds
buffer_load_dwordx4 v18, s[44:47], s70 offen offset:1024 lds
buffer_load_dwordx4 v19, s[44:47], s70 offen offset:2048 lds
buffer_load_dwordx4 v20, s[44:47], s70 offen offset:3072 lds
v_mfma_f32_16x16x32_bf16 v[128:131], v[200:203], v[168:171], v[128:131]
v_mfma_f32_16x16x32_bf16 v[132:135], v[204:207], v[168:171], v[132:135]
v_mfma_f32_16x16x32_bf16 v[136:139], v[208:211], v[168:171], v[136:139]
ds_read_b64_tr_b16 v[140:141], v27 offset:8192
ds_read_b64_tr_b16 v[142:143], v27 offset:8704
s_waitcnt lgkmcnt(7)
v_mfma_f32_16x16x32_bf16 v[76:79], v[212:215], v[172:175], v[76:79]
s_waitcnt lgkmcnt(6)
v_mfma_f32_16x16x32_bf16 v[80:83], v[216:219], v[172:175], v[80:83]
s_waitcnt lgkmcnt(5)
v_mfma_f32_16x16x32_bf16 v[84:87], v[220:223], v[172:175], v[84:87]
s_waitcnt lgkmcnt(4)
v_mfma_f32_16x16x32_bf16 v[88:91], v[224:227], v[172:175], v[88:91]
ds_read_b64_tr_b16 v[144:145], v28 offset:8192
ds_read_b64_tr_b16 v[146:147], v28 offset:8704
s_waitcnt lgkmcnt(4)
v_mfma_f32_16x16x32_bf16 v[92:95], v[212:215], v[176:179], v[92:95]
v_mfma_f32_16x16x32_bf16 v[96:99], v[216:219], v[176:179], v[96:99]
v_mfma_f32_16x16x32_bf16 v[100:103], v[220:223], v[176:179], v[100:103]
v_mfma_f32_16x16x32_bf16 v[104:107], v[224:227], v[176:179], v[104:107]
ds_read_b128 v[180:183], v32 offset:3072
s_waitcnt vmcnt(4)
ds_read_b64_tr_b16 v[148:149], v25 offset:0
ds_read_b64_tr_b16 v[150:151], v25 offset:512
s_waitcnt lgkmcnt(5)
v_mfma_f32_16x16x32_bf16 v[108:111], v[212:215], v[140:143], v[108:111]
ds_read_b128 v[184:187], v32 offset:11264
v_mfma_f32_16x16x32_bf16 v[112:115], v[216:219], v[140:143], v[112:115]
ds_read_b128 v[188:191], v32 offset:19456
v_mfma_f32_16x16x32_bf16 v[116:119], v[220:223], v[140:143], v[116:119]
ds_read_b128 v[192:195], v32 offset:27648
v_mfma_f32_16x16x32_bf16 v[120:123], v[224:227], v[140:143], v[120:123]
ds_read_b64_tr_b16 v[152:153], v26 offset:0
ds_read_b64_tr_b16 v[154:155], v26 offset:512
s_waitcnt lgkmcnt(8)
v_mfma_f32_16x16x32_bf16 v[124:127], v[212:215], v[144:147], v[124:127]
s_add_u32 m0, s63, 0x2000
s_nop 0
buffer_load_dwordx4 v17, s[44:47], s71 offen offset:0 lds
buffer_load_dwordx4 v18, s[44:47], s71 offen offset:1024 lds
buffer_load_dwordx4 v19, s[44:47], s71 offen offset:2048 lds
buffer_load_dwordx4 v20, s[44:47], s71 offen offset:3072 lds
v_mfma_f32_16x16x32_bf16 v[128:131], v[216:219], v[144:147], v[128:131]
v_mfma_f32_16x16x32_bf16 v[132:135], v[220:223], v[144:147], v[132:135]
v_mfma_f32_16x16x32_bf16 v[136:139], v[224:227], v[144:147], v[136:139]
ds_read_b64_tr_b16 v[156:157], v27 offset:0
ds_read_b64_tr_b16 v[158:159], v27 offset:512
s_waitcnt lgkmcnt(7)
v_mfma_f32_16x16x32_bf16 v[76:79], v[180:183], v[148:151], v[76:79]
s_waitcnt lgkmcnt(6)
v_mfma_f32_16x16x32_bf16 v[80:83], v[184:187], v[148:151], v[80:83]
s_waitcnt lgkmcnt(5)
v_mfma_f32_16x16x32_bf16 v[84:87], v[188:191], v[148:151], v[84:87]
s_waitcnt lgkmcnt(4)
v_mfma_f32_16x16x32_bf16 v[88:91], v[192:195], v[148:151], v[88:91]
ds_read_b64_tr_b16 v[160:161], v28 offset:0
ds_read_b64_tr_b16 v[162:163], v28 offset:512
s_waitcnt lgkmcnt(4)
v_mfma_f32_16x16x32_bf16 v[92:95], v[180:183], v[152:155], v[92:95]
v_mfma_f32_16x16x32_bf16 v[96:99], v[184:187], v[152:155], v[96:99]
v_mfma_f32_16x16x32_bf16 v[100:103], v[188:191], v[152:155], v[100:103]
v_mfma_f32_16x16x32_bf16 v[104:107], v[192:195], v[152:155], v[104:107]
ds_read_b128 v[196:199], v31 offset:4096
s_waitcnt vmcnt(4)
ds_read_b64_tr_b16 v[164:165], v25 offset:4096
ds_read_b64_tr_b16 v[166:167], v25 offset:4608
s_waitcnt lgkmcnt(5)
v_mfma_f32_16x16x32_bf16 v[108:111], v[180:183], v[156:159], v[108:111]
ds_read_b128 v[200:203], v31 offset:12288
v_mfma_f32_16x16x32_bf16 v[112:115], v[184:187], v[156:159], v[112:115]
ds_read_b128 v[204:207], v31 offset:20480
v_mfma_f32_16x16x32_bf16 v[116:119], v[188:191], v[156:159], v[116:119]
ds_read_b128 v[208:211], v31 offset:28672
v_mfma_f32_16x16x32_bf16 v[120:123], v[192:195], v[156:159], v[120:123]
ds_read_b64_tr_b16 v[168:169], v26 offset:4096
ds_read_b64_tr_b16 v[170:171], v26 offset:4608
s_waitcnt lgkmcnt(8)
v_mfma_f32_16x16x32_bf16 v[124:127], v[180:183], v[160:163], v[124:127]
s_add_u32 m0, s63, 0x0
s_nop 0
buffer_load_dwordx4 v17, s[44:47], s72 offen offset:0 lds
buffer_load_dwordx4 v18, s[44:47], s72 offen offset:1024 lds
buffer_load_dwordx4 v19, s[44:47], s72 offen offset:2048 lds
buffer_load_dwordx4 v20, s[44:47], s72 offen offset:3072 lds
v_mfma_f32_16x16x32_bf16 v[128:131], v[184:187], v[160:163], v[128:131]
v_mfma_f32_16x16x32_bf16 v[132:135], v[188:191], v[160:163], v[132:135]
v_mfma_f32_16x16x32_bf16 v[136:139], v[192:195], v[160:163], v[136:139]
ds_read_b64_tr_b16 v[172:173], v27 offset:4096
ds_read_b64_tr_b16 v[174:175], v27 offset:4608
s_waitcnt lgkmcnt(7)
v_mfma_f32_16x16x32_bf16 v[76:79], v[196:199], v[164:167], v[76:79]
s_waitcnt lgkmcnt(6)
v_mfma_f32_16x16x32_bf16 v[80:83], v[200:203], v[164:167], v[80:83]
s_waitcnt lgkmcnt(5)
v_mfma_f32_16x16x32_bf16 v[84:87], v[204:207], v[164:167], v[84:87]
s_waitcnt lgkmcnt(4)
v_mfma_f32_16x16x32_bf16 v[88:91], v[208:211], v[164:167], v[88:91]
ds_read_b64_tr_b16 v[176:177], v28 offset:4096
ds_read_b64_tr_b16 v[178:179], v28 offset:4608
s_waitcnt lgkmcnt(4)
v_mfma_f32_16x16x32_bf16 v[92:95], v[196:199], v[168:171], v[92:95]
v_mfma_f32_16x16x32_bf16 v[96:99], v[200:203], v[168:171], v[96:99]
v_mfma_f32_16x16x32_bf16 v[100:103], v[204:207], v[168:171], v[100:103]
v_mfma_f32_16x16x32_bf16 v[104:107], v[208:211], v[168:171], v[104:107]
ds_read_b128 v[212:215], v32 offset:5120
s_waitcnt vmcnt(4)
ds_read_b64_tr_b16 v[140:141], v25 offset:8192
ds_read_b64_tr_b16 v[142:143], v25 offset:8704
s_waitcnt lgkmcnt(5)
v_mfma_f32_16x16x32_bf16 v[108:111], v[196:199], v[172:175], v[108:111]
ds_read_b128 v[216:219], v32 offset:13312
v_mfma_f32_16x16x32_bf16 v[112:115], v[200:203], v[172:175], v[112:115]
ds_read_b128 v[220:223], v32 offset:21504
v_mfma_f32_16x16x32_bf16 v[116:119], v[204:207], v[172:175], v[116:119]
ds_read_b128 v[224:227], v32 offset:29696
v_mfma_f32_16x16x32_bf16 v[120:123], v[208:211], v[172:175], v[120:123]
ds_read_b64_tr_b16 v[144:145], v26 offset:8192
ds_read_b64_tr_b16 v[146:147], v26 offset:8704
s_waitcnt lgkmcnt(8)
v_mfma_f32_16x16x32_bf16 v[124:127], v[196:199], v[176:179], v[124:127]
s_add_u32 m0, s63, 0x1000
s_nop 0
buffer_load_dwordx4 v17, s[44:47], s73 offen offset:0 lds
buffer_load_dwordx4 v18, s[44:47], s73 offen offset:1024 lds
buffer_load_dwordx4 v19, s[44:47], s73 offen offset:2048 lds
buffer_load_dwordx4 v20, s[44:47], s73 offen offset:3072 lds
v_mfma_f32_16x16x32_bf16 v[128:131], v[200:203], v[176:179], v[128:131]
v_mfma_f32_16x16x32_bf16 v[132:135], v[204:207], v[176:179], v[132:135]
v_mfma_f32_16x16x32_bf16 v[136:139], v[208:211], v[176:179], v[136:139]
ds_read_b64_tr_b16 v[148:149], v27 offset:8192
ds_read_b64_tr_b16 v[150:151], v27 offset:8704
s_waitcnt lgkmcnt(7)
v_mfma_f32_16x16x32_bf16 v[76:79], v[212:215], v[140:143], v[76:79]
s_waitcnt lgkmcnt(6)
v_mfma_f32_16x16x32_bf16 v[80:83], v[216:219], v[140:143], v[80:83]
s_waitcnt lgkmcnt(5)
v_mfma_f32_16x16x32_bf16 v[84:87], v[220:223], v[140:143], v[84:87]
s_waitcnt lgkmcnt(4)
v_mfma_f32_16x16x32_bf16 v[88:91], v[224:227], v[140:143], v[88:91]
ds_read_b64_tr_b16 v[152:153], v28 offset:8192
ds_read_b64_tr_b16 v[154:155], v28 offset:8704
s_waitcnt lgkmcnt(4)
v_mfma_f32_16x16x32_bf16 v[92:95], v[212:215], v[144:147], v[92:95]
v_mfma_f32_16x16x32_bf16 v[96:99], v[216:219], v[144:147], v[96:99]
v_mfma_f32_16x16x32_bf16 v[100:103], v[220:223], v[144:147], v[100:103]
v_mfma_f32_16x16x32_bf16 v[104:107], v[224:227], v[144:147], v[104:107]
ds_read_b128 v[180:183], v31 offset:6144
s_waitcnt vmcnt(4)
ds_read_b64_tr_b16 v[156:157], v25 offset:0
ds_read_b64_tr_b16 v[158:159], v25 offset:512
s_waitcnt lgkmcnt(5)
v_mfma_f32_16x16x32_bf16 v[108:111], v[212:215], v[148:151], v[108:111]
ds_read_b128 v[184:187], v31 offset:14336
v_mfma_f32_16x16x32_bf16 v[112:115], v[216:219], v[148:151], v[112:115]
ds_read_b128 v[188:191], v31 offset:22528
v_mfma_f32_16x16x32_bf16 v[116:119], v[220:223], v[148:151], v[116:119]
ds_read_b128 v[192:195], v31 offset:30720
v_mfma_f32_16x16x32_bf16 v[120:123], v[224:227], v[148:151], v[120:123]
ds_read_b64_tr_b16 v[160:161], v26 offset:0
ds_read_b64_tr_b16 v[162:163], v26 offset:512
s_waitcnt lgkmcnt(8)
v_mfma_f32_16x16x32_bf16 v[124:127], v[212:215], v[152:155], v[124:127]
v_mfma_f32_16x16x32_bf16 v[128:131], v[216:219], v[152:155], v[128:131]
v_mfma_f32_16x16x32_bf16 v[132:135], v[220:223], v[152:155], v[132:135]
v_mfma_f32_16x16x32_bf16 v[136:139], v[224:227], v[152:155], v[136:139]
ds_read_b64_tr_b16 v[164:165], v27 offset:0
ds_read_b64_tr_b16 v[166:167], v27 offset:512
s_waitcnt lgkmcnt(7)
v_mfma_f32_16x16x32_bf16 v[76:79], v[180:183], v[156:159], v[76:79]
s_waitcnt lgkmcnt(6)
v_mfma_f32_16x16x32_bf16 v[80:83], v[184:187], v[156:159], v[80:83]
s_waitcnt lgkmcnt(5)
v_mfma_f32_16x16x32_bf16 v[84:87], v[188:191], v[156:159], v[84:87]
s_waitcnt lgkmcnt(4)
v_mfma_f32_16x16x32_bf16 v[88:91], v[192:195], v[156:159], v[88:91]
ds_read_b64_tr_b16 v[168:169], v28 offset:0
ds_read_b64_tr_b16 v[170:171], v28 offset:512
s_waitcnt lgkmcnt(4)
v_mfma_f32_16x16x32_bf16 v[92:95], v[180:183], v[160:163], v[92:95]
v_mfma_f32_16x16x32_bf16 v[96:99], v[184:187], v[160:163], v[96:99]
v_mfma_f32_16x16x32_bf16 v[100:103], v[188:191], v[160:163], v[100:103]
v_mfma_f32_16x16x32_bf16 v[104:107], v[192:195], v[160:163], v[104:107]
ds_read_b128 v[196:199], v32 offset:7168
s_waitcnt vmcnt(0)
ds_read_b64_tr_b16 v[172:173], v25 offset:4096
ds_read_b64_tr_b16 v[174:175], v25 offset:4608
s_waitcnt lgkmcnt(5)
v_mfma_f32_16x16x32_bf16 v[108:111], v[180:183], v[164:167], v[108:111]
ds_read_b128 v[200:203], v32 offset:15360
v_mfma_f32_16x16x32_bf16 v[112:115], v[184:187], v[164:167], v[112:115]
ds_read_b128 v[204:207], v32 offset:23552
v_mfma_f32_16x16x32_bf16 v[116:119], v[188:191], v[164:167], v[116:119]
ds_read_b128 v[208:211], v32 offset:31744
v_mfma_f32_16x16x32_bf16 v[120:123], v[192:195], v[164:167], v[120:123]
ds_read_b64_tr_b16 v[176:177], v26 offset:4096
ds_read_b64_tr_b16 v[178:179], v26 offset:4608
s_waitcnt lgkmcnt(8)
v_mfma_f32_16x16x32_bf16 v[124:127], v[180:183], v[168:171], v[124:127]
v_mfma_f32_16x16x32_bf16 v[128:131], v[184:187], v[168:171], v[128:131]
v_mfma_f32_16x16x32_bf16 v[132:135], v[188:191], v[168:171], v[132:135]
v_mfma_f32_16x16x32_bf16 v[136:139], v[192:195], v[168:171], v[136:139]
ds_read_b64_tr_b16 v[140:141], v27 offset:4096
ds_read_b64_tr_b16 v[142:143], v27 offset:4608
s_waitcnt lgkmcnt(7)
v_mfma_f32_16x16x32_bf16 v[76:79], v[196:199], v[172:175], v[76:79]
s_waitcnt lgkmcnt(6)
v_mfma_f32_16x16x32_bf16 v[80:83], v[200:203], v[172:175], v[80:83]
s_waitcnt lgkmcnt(5)
v_mfma_f32_16x16x32_bf16 v[84:87], v[204:207], v[172:175], v[84:87]
s_waitcnt lgkmcnt(4)
v_mfma_f32_16x16x32_bf16 v[88:91], v[208:211], v[172:175], v[88:91]
ds_read_b64_tr_b16 v[144:145], v28 offset:4096
ds_read_b64_tr_b16 v[146:147], v28 offset:4608
s_waitcnt lgkmcnt(4)
v_mfma_f32_16x16x32_bf16 v[92:95], v[196:199], v[176:179], v[92:95]
v_cvt_pk_bf16_f32 v76, v76, v77
v_cvt_pk_bf16_f32 v77, v78, v79
v_cvt_pk_bf16_f32 v78, v80, v81
v_cvt_pk_bf16_f32 v79, v82, v83
buffer_store_dwordx4 v[76:79], v16, s[52:55], s82 offen offset:0 sc1
v_mfma_f32_16x16x32_bf16 v[96:99], v[200:203], v[176:179], v[96:99]
v_mfma_f32_16x16x32_bf16 v[100:103], v[204:207], v[176:179], v[100:103]
v_cvt_pk_bf16_f32 v84, v84, v85
v_cvt_pk_bf16_f32 v85, v86, v87
v_cvt_pk_bf16_f32 v86, v88, v89
v_cvt_pk_bf16_f32 v87, v90, v91
buffer_store_dwordx4 v[84:87], v16, s[52:55], s82 offen offset:2048 sc1
v_mfma_f32_16x16x32_bf16 v[104:107], v[208:211], v[176:179], v[104:107]
s_waitcnt lgkmcnt(2)
v_mfma_f32_16x16x32_bf16 v[108:111], v[196:199], v[140:143], v[108:111]
v_cvt_pk_bf16_f32 v92, v92, v93
v_cvt_pk_bf16_f32 v93, v94, v95
v_cvt_pk_bf16_f32 v94, v96, v97
v_cvt_pk_bf16_f32 v95, v98, v99
buffer_store_dwordx4 v[92:95], v16, s[52:55], s82 offen offset:1024 sc1
v_mfma_f32_16x16x32_bf16 v[112:115], v[200:203], v[140:143], v[112:115]
v_mfma_f32_16x16x32_bf16 v[116:119], v[204:207], v[140:143], v[116:119]
v_cvt_pk_bf16_f32 v100, v100, v101
v_cvt_pk_bf16_f32 v101, v102, v103
v_cvt_pk_bf16_f32 v102, v104, v105
v_cvt_pk_bf16_f32 v103, v106, v107
buffer_store_dwordx4 v[100:103], v16, s[52:55], s82 offen offset:3072 sc1
v_mfma_f32_16x16x32_bf16 v[120:123], v[208:211], v[140:143], v[120:123]
s_waitcnt lgkmcnt(0)
v_mfma_f32_16x16x32_bf16 v[124:127], v[196:199], v[144:147], v[124:127]
v_cvt_pk_bf16_f32 v108, v108, v109
v_cvt_pk_bf16_f32 v109, v110, v111
v_cvt_pk_bf16_f32 v110, v112, v113
v_cvt_pk_bf16_f32 v111, v114, v115
buffer_store_dwordx4 v[108:111], v16, s[52:55], s83 offen offset:0 sc1
v_mfma_f32_16x16x32_bf16 v[128:131], v[200:203], v[144:147], v[128:131]
v_mfma_f32_16x16x32_bf16 v[132:135], v[204:207], v[144:147], v[132:135]
v_cvt_pk_bf16_f32 v116, v116, v117
v_cvt_pk_bf16_f32 v117, v118, v119
v_cvt_pk_bf16_f32 v118, v120, v121
v_cvt_pk_bf16_f32 v119, v122, v123
buffer_store_dwordx4 v[116:119], v16, s[52:55], s83 offen offset:2048 sc1
v_mfma_f32_16x16x32_bf16 v[136:139], v[208:211], v[144:147], v[136:139]
v_cvt_pk_bf16_f32 v124, v124, v125
v_cvt_pk_bf16_f32 v125, v126, v127
v_cvt_pk_bf16_f32 v126, v128, v129
v_cvt_pk_bf16_f32 v127, v130, v131
buffer_store_dwordx4 v[124:127], v16, s[52:55], s83 offen offset:1024 sc1
v_cvt_pk_bf16_f32 v132, v132, v133
v_cvt_pk_bf16_f32 v133, v134, v135
s_nop 0
v_cvt_pk_bf16_f32 v134, v136, v137
v_cvt_pk_bf16_f32 v135, v138, v139
buffer_store_dwordx4 v[132:135], v16, s[52:55], s83 offen offset:3072 sc1
s_branch LM_pub
LM_light:
s_mov_b32 s61, 1
s_waitcnt lgkmcnt(0)
s_mov_b32 s98, 0x7c3ff80
s_load_dwordx2 s[98:99], s[38:39], s98
s_branch L1_fin
LM_edge:
s_sub_u32 s4, s3, 30
s_lshl_b32 s8, s8, 1
s_add_u32 s4, s4, s8
s_add_u32 s91, s4, 240
s_cmp_ge_u32 s4, 14
s_cselect_b32 s61, 1, 0
s_mul_i32 s6, s4, 40000
v_lshlrev_b32 v5, 4, v0
v_lshlrev_b32 v6, 2, v2
v_add_u32 v6, 0x10000, v6
v_mov_b32 v7, 0
ds_write_b32 v6, v7
s_mov_b32 s66, 0
s_mov_b32 s67, 4096
s_mov_b32 s68, 8192
s_mov_b32 s69, 12288
s_mov_b32 s70, 16384
s_mov_b32 s71, 20480
s_mov_b32 s72, 24576
s_mov_b32 s73, 28672
s_mov_b32 s74, 32768
s_mov_b32 s75, 36864
s_waitcnt lgkmcnt(0)
s_add_u32 s40, s20, 0x0
s_addc_u32 s41, s21, 0
s_add_u32 s40, s40, s6
s_addc_u32 s41, s41, 0
s_mov_b32 s42, 0x9c40
s_mov_b32 s43, 0x00020000
s_add_u32 s44, s18, 0x0
s_addc_u32 s45, s19, 0
s_add_u32 s44, s44, s6
s_addc_u32 s45, s45, 0
s_mov_b32 s46, 0x9c40
s_mov_b32 s47, 0x00020000
buffer_load_dwordx4 v[16:19], v5, s[40:43], s66 offen
buffer_load_dwordx4 v[20:23], v5, s[40:43], s67 offen
buffer_load_dwordx4 v[24:27], v5, s[40:43], s68 offen
buffer_load_dwordx4 v[28:31], v5, s[40:43], s69 offen
buffer_load_dwordx4 v[32:35], v5, s[40:43], s70 offen
buffer_load_dwordx4 v[36:39], v5, s[40:43], s71 offen
buffer_load_dwordx4 v[40:43], v5, s[40:43], s72 offen
buffer_load_dwordx4 v[44:47], v5, s[40:43], s73 offen
buffer_load_dwordx4 v[48:51], v5, s[40:43], s74 offen
buffer_load_dwordx4 v[52:55], v5, s[40:43], s75 offen
buffer_load_dwordx4 v[56:59], v5, s[44:47], s66 offen
buffer_load_dwordx4 v[60:63], v5, s[44:47], s67 offen
buffer_load_dwordx4 v[64:67], v5, s[44:47], s68 offen
buffer_load_dwordx4 v[68:71], v5, s[44:47], s69 offen
buffer_load_dwordx4 v[72:75], v5, s[44:47], s70 offen
buffer_load_dwordx4 v[76:79], v5, s[44:47], s71 offen
buffer_load_dwordx4 v[80:83], v5, s[44:47], s72 offen
buffer_load_dwordx4 v[84:87], v5, s[44:47], s73 offen
buffer_load_dwordx4 v[88:91], v5, s[44:47], s74 offen
buffer_load_dwordx4 v[92:95], v5, s[44:47], s75 offen
s_mov_b32 s98, 0x7c3ff80
s_load_dwordx2 s[98:99], s[38:39], s98
s_add_u32 s48, s38, 0x8000000
s_addc_u32 s49, s39, 0
s_mov_b32 s50, 0x2800000
s_mov_b32 s51, 0x00020000
s_add_u32 s52, s38, 0x7800000
s_addc_u32 s53, s39, 0
s_mov_b32 s54, 0x1000
s_mov_b32 s55, 0x00020000
v_mov_b32 v240, 6945
v_mov_b32 v241, 0x0
v_mov_b32 v242, 6317
v_mov_b32 v243, 0x340674
v_mov_b32 v244, 6899
v_mov_b32 v245, 0xfffae6a0
v_mov_b32 v246, 6242
v_mov_b32 v247, 0x4484a0
s_mov_b32 s11, 0x10000
v_mov_b32 v7, 1
v_cmp_gt_u32 vcc, 0xc4, v0
s_mov_b64 s[12:13], vcc
s_barrier
s_waitcnt vmcnt(19)
v_cmp_le_u32 vcc, 5436, v16
s_nop 1
v_cndmask_b32 v96, v240, v242, vcc
v_cndmask_b32 v136, v241, v243, vcc
v_cmp_le_u32 vcc, 6432, v16
s_nop 1
v_cndmask_b32 v96, v96, v244, vcc
v_cndmask_b32 v136, v136, v245, vcc
v_cmp_le_u32 vcc, 7344, v16
s_nop 1
v_cndmask_b32 v96, v96, v246, vcc
v_cndmask_b32 v136, v136, v247, vcc
v_mad_u32_u24 v96, v96, v16, v136
v_lshrrev_b32 v96, 20, v96
v_lshl_add_u32 v136, v96, 2, s11
ds_add_rtn_u32 v136, v136, v7
v_cmp_le_u32 vcc, 5436, v17
s_nop 1
v_cndmask_b32 v97, v240, v242, vcc
v_cndmask_b32 v137, v241, v243, vcc
v_cmp_le_u32 vcc, 6432, v17
s_nop 1
v_cndmask_b32 v97, v97, v244, vcc
v_cndmask_b32 v137, v137, v245, vcc
v_cmp_le_u32 vcc, 7344, v17
s_nop 1
v_cndmask_b32 v97, v97, v246, vcc
v_cndmask_b32 v137, v137, v247, vcc
v_mad_u32_u24 v97, v97, v17, v137
v_lshrrev_b32 v97, 20, v97
v_lshl_add_u32 v137, v97, 2, s11
ds_add_rtn_u32 v137, v137, v7
v_cmp_le_u32 vcc, 5436, v18
s_nop 1
v_cndmask_b32 v98, v240, v242, vcc
v_cndmask_b32 v138, v241, v243, vcc
v_cmp_le_u32 vcc, 6432, v18
s_nop 1
v_cndmask_b32 v98, v98, v244, vcc
v_cndmask_b32 v138, v138, v245, vcc
v_cmp_le_u32 vcc, 7344, v18
s_nop 1
v_cndmask_b32 v98, v98, v246, vcc
v_cndmask_b32 v138, v138, v247, vcc
v_mad_u32_u24 v98, v98, v18, v138
v_lshrrev_b32 v98, 20, v98
v_lshl_add_u32 v138, v98, 2, s11
ds_add_rtn_u32 v138, v138, v7
v_cmp_le_u32 vcc, 5436, v19
s_nop 1
v_cndmask_b32 v99, v240, v242, vcc
v_cndmask_b32 v139, v241, v243, vcc
v_cmp_le_u32 vcc, 6432, v19
s_nop 1
v_cndmask_b32 v99, v99, v244, vcc
v_cndmask_b32 v139, v139, v245, vcc
v_cmp_le_u32 vcc, 7344, v19
s_nop 1
v_cndmask_b32 v99, v99, v246, vcc
v_cndmask_b32 v139, v139, v247, vcc
v_mad_u32_u24 v99, v99, v19, v139
v_lshrrev_b32 v99, 20, v99
v_lshl_add_u32 v139, v99, 2, s11
ds_add_rtn_u32 v139, v139, v7
s_waitcnt vmcnt(18)
v_cmp_le_u32 vcc, 5436, v20
s_nop 1
v_cndmask_b32 v100, v240, v242, vcc
v_cndmask_b32 v140, v241, v243, vcc
v_cmp_le_u32 vcc, 6432, v20
s_nop 1
v_cndmask_b32 v100, v100, v244, vcc
v_cndmask_b32 v140, v140, v245, vcc
v_cmp_le_u32 vcc, 7344, v20
s_nop 1
v_cndmask_b32 v100, v100, v246, vcc
v_cndmask_b32 v140, v140, v247, vcc
v_mad_u32_u24 v100, v100, v20, v140
v_lshrrev_b32 v100, 20, v100
v_lshl_add_u32 v140, v100, 2, s11
ds_add_rtn_u32 v140, v140, v7
v_cmp_le_u32 vcc, 5436, v21
s_nop 1
v_cndmask_b32 v101, v240, v242, vcc
v_cndmask_b32 v141, v241, v243, vcc
v_cmp_le_u32 vcc, 6432, v21
s_nop 1
v_cndmask_b32 v101, v101, v244, vcc
v_cndmask_b32 v141, v141, v245, vcc
v_cmp_le_u32 vcc, 7344, v21
s_nop 1
v_cndmask_b32 v101, v101, v246, vcc
v_cndmask_b32 v141, v141, v247, vcc
v_mad_u32_u24 v101, v101, v21, v141
v_lshrrev_b32 v101, 20, v101
v_lshl_add_u32 v141, v101, 2, s11
ds_add_rtn_u32 v141, v141, v7
v_cmp_le_u32 vcc, 5436, v22
s_nop 1
v_cndmask_b32 v102, v240, v242, vcc
v_cndmask_b32 v142, v241, v243, vcc
v_cmp_le_u32 vcc, 6432, v22
s_nop 1
v_cndmask_b32 v102, v102, v244, vcc
v_cndmask_b32 v142, v142, v245, vcc
v_cmp_le_u32 vcc, 7344, v22
s_nop 1
v_cndmask_b32 v102, v102, v246, vcc
v_cndmask_b32 v142, v142, v247, vcc
v_mad_u32_u24 v102, v102, v22, v142
v_lshrrev_b32 v102, 20, v102
v_lshl_add_u32 v142, v102, 2, s11
ds_add_rtn_u32 v142, v142, v7
v_cmp_le_u32 vcc, 5436, v23
s_nop 1
v_cndmask_b32 v103, v240, v242, vcc
v_cndmask_b32 v143, v241, v243, vcc
v_cmp_le_u32 vcc, 6432, v23
s_nop 1
v_cndmask_b32 v103, v103, v244, vcc
v_cndmask_b32 v143, v143, v245, vcc
v_cmp_le_u32 vcc, 7344, v23
s_nop 1
v_cndmask_b32 v103, v103, v246, vcc
v_cndmask_b32 v143, v143, v247, vcc
v_mad_u32_u24 v103, v103, v23, v143
v_lshrrev_b32 v103, 20, v103
v_lshl_add_u32 v143, v103, 2, s11
ds_add_rtn_u32 v143, v143, v7
s_waitcnt vmcnt(17)
v_cmp_le_u32 vcc, 5436, v24
s_nop 1
v_cndmask_b32 v104, v240, v242, vcc
v_cndmask_b32 v144, v241, v243, vcc
v_cmp_le_u32 vcc, 6432, v24
s_nop 1
v_cndmask_b32 v104, v104, v244, vcc
v_cndmask_b32 v144, v144, v245, vcc
v_cmp_le_u32 vcc, 7344, v24
s_nop 1
v_cndmask_b32 v104, v104, v246, vcc
v_cndmask_b32 v144, v144, v247, vcc
v_mad_u32_u24 v104, v104, v24, v144
v_lshrrev_b32 v104, 20, v104
v_lshl_add_u32 v144, v104, 2, s11
ds_add_rtn_u32 v144, v144, v7
v_cmp_le_u32 vcc, 5436, v25
s_nop 1
v_cndmask_b32 v105, v240, v242, vcc
v_cndmask_b32 v145, v241, v243, vcc
v_cmp_le_u32 vcc, 6432, v25
s_nop 1
v_cndmask_b32 v105, v105, v244, vcc
v_cndmask_b32 v145, v145, v245, vcc
v_cmp_le_u32 vcc, 7344, v25
s_nop 1
v_cndmask_b32 v105, v105, v246, vcc
v_cndmask_b32 v145, v145, v247, vcc
v_mad_u32_u24 v105, v105, v25, v145
v_lshrrev_b32 v105, 20, v105
v_lshl_add_u32 v145, v105, 2, s11
ds_add_rtn_u32 v145, v145, v7
v_cmp_le_u32 vcc, 5436, v26
s_nop 1
v_cndmask_b32 v106, v240, v242, vcc
v_cndmask_b32 v146, v241, v243, vcc
v_cmp_le_u32 vcc, 6432, v26
s_nop 1
v_cndmask_b32 v106, v106, v244, vcc
v_cndmask_b32 v146, v146, v245, vcc
v_cmp_le_u32 vcc, 7344, v26
s_nop 1
v_cndmask_b32 v106, v106, v246, vcc
v_cndmask_b32 v146, v146, v247, vcc
v_mad_u32_u24 v106, v106, v26, v146
v_lshrrev_b32 v106, 20, v106
v_lshl_add_u32 v146, v106, 2, s11
ds_add_rtn_u32 v146, v146, v7
v_cmp_le_u32 vcc, 5436, v27
s_nop 1
v_cndmask_b32 v107, v240, v242, vcc
v_cndmask_b32 v147, v241, v243, vcc
v_cmp_le_u32 vcc, 6432, v27
s_nop 1
v_cndmask_b32 v107, v107, v244, vcc
v_cndmask_b32 v147, v147, v245, vcc
v_cmp_le_u32 vcc, 7344, v27
s_nop 1
v_cndmask_b32 v107, v107, v246, vcc
v_cndmask_b32 v147, v147, v247, vcc
v_mad_u32_u24 v107, v107, v27, v147
v_lshrrev_b32 v107, 20, v107
v_lshl_add_u32 v147, v107, 2, s11
ds_add_rtn_u32 v147, v147, v7
s_waitcnt vmcnt(16)
v_cmp_le_u32 vcc, 5436, v28
s_nop 1
v_cndmask_b32 v108, v240, v242, vcc
v_cndmask_b32 v148, v241, v243, vcc
v_cmp_le_u32 vcc, 6432, v28
s_nop 1
v_cndmask_b32 v108, v108, v244, vcc
v_cndmask_b32 v148, v148, v245, vcc
v_cmp_le_u32 vcc, 7344, v28
s_nop 1
v_cndmask_b32 v108, v108, v246, vcc
v_cndmask_b32 v148, v148, v247, vcc
v_mad_u32_u24 v108, v108, v28, v148
v_lshrrev_b32 v108, 20, v108
v_lshl_add_u32 v148, v108, 2, s11
ds_add_rtn_u32 v148, v148, v7
v_cmp_le_u32 vcc, 5436, v29
s_nop 1
v_cndmask_b32 v109, v240, v242, vcc
v_cndmask_b32 v149, v241, v243, vcc
v_cmp_le_u32 vcc, 6432, v29
s_nop 1
v_cndmask_b32 v109, v109, v244, vcc
v_cndmask_b32 v149, v149, v245, vcc
v_cmp_le_u32 vcc, 7344, v29
s_nop 1
v_cndmask_b32 v109, v109, v246, vcc
v_cndmask_b32 v149, v149, v247, vcc
v_mad_u32_u24 v109, v109, v29, v149
v_lshrrev_b32 v109, 20, v109
v_lshl_add_u32 v149, v109, 2, s11
ds_add_rtn_u32 v149, v149, v7
v_cmp_le_u32 vcc, 5436, v30
s_nop 1
v_cndmask_b32 v110, v240, v242, vcc
v_cndmask_b32 v150, v241, v243, vcc
v_cmp_le_u32 vcc, 6432, v30
s_nop 1
v_cndmask_b32 v110, v110, v244, vcc
v_cndmask_b32 v150, v150, v245, vcc
v_cmp_le_u32 vcc, 7344, v30
s_nop 1
v_cndmask_b32 v110, v110, v246, vcc
v_cndmask_b32 v150, v150, v247, vcc
v_mad_u32_u24 v110, v110, v30, v150
v_lshrrev_b32 v110, 20, v110
v_lshl_add_u32 v150, v110, 2, s11
ds_add_rtn_u32 v150, v150, v7
v_cmp_le_u32 vcc, 5436, v31
s_nop 1
v_cndmask_b32 v111, v240, v242, vcc
v_cndmask_b32 v151, v241, v243, vcc
v_cmp_le_u32 vcc, 6432, v31
s_nop 1
v_cndmask_b32 v111, v111, v244, vcc
v_cndmask_b32 v151, v151, v245, vcc
v_cmp_le_u32 vcc, 7344, v31
s_nop 1
v_cndmask_b32 v111, v111, v246, vcc
v_cndmask_b32 v151, v151, v247, vcc
v_mad_u32_u24 v111, v111, v31, v151
v_lshrrev_b32 v111, 20, v111
v_lshl_add_u32 v151, v111, 2, s11
ds_add_rtn_u32 v151, v151, v7
s_waitcnt vmcnt(15)
v_cmp_le_u32 vcc, 5436, v32
s_nop 1
v_cndmask_b32 v112, v240, v242, vcc
v_cndmask_b32 v152, v241, v243, vcc
v_cmp_le_u32 vcc, 6432, v32
s_nop 1
v_cndmask_b32 v112, v112, v244, vcc
v_cndmask_b32 v152, v152, v245, vcc
v_cmp_le_u32 vcc, 7344, v32
s_nop 1
v_cndmask_b32 v112, v112, v246, vcc
v_cndmask_b32 v152, v152, v247, vcc
v_mad_u32_u24 v112, v112, v32, v152
v_lshrrev_b32 v112, 20, v112
v_lshl_add_u32 v152, v112, 2, s11
ds_add_rtn_u32 v152, v152, v7
v_cmp_le_u32 vcc, 5436, v33
s_nop 1
v_cndmask_b32 v113, v240, v242, vcc
v_cndmask_b32 v153, v241, v243, vcc
v_cmp_le_u32 vcc, 6432, v33
s_nop 1
v_cndmask_b32 v113, v113, v244, vcc
v_cndmask_b32 v153, v153, v245, vcc
v_cmp_le_u32 vcc, 7344, v33
s_nop 1
v_cndmask_b32 v113, v113, v246, vcc
v_cndmask_b32 v153, v153, v247, vcc
v_mad_u32_u24 v113, v113, v33, v153
v_lshrrev_b32 v113, 20, v113
v_lshl_add_u32 v153, v113, 2, s11
ds_add_rtn_u32 v153, v153, v7
v_cmp_le_u32 vcc, 5436, v34
s_nop 1
v_cndmask_b32 v114, v240, v242, vcc
v_cndmask_b32 v154, v241, v243, vcc
v_cmp_le_u32 vcc, 6432, v34
s_nop 1
v_cndmask_b32 v114, v114, v244, vcc
v_cndmask_b32 v154, v154, v245, vcc
v_cmp_le_u32 vcc, 7344, v34
s_nop 1
v_cndmask_b32 v114, v114, v246, vcc
v_cndmask_b32 v154, v154, v247, vcc
v_mad_u32_u24 v114, v114, v34, v154
v_lshrrev_b32 v114, 20, v114
v_lshl_add_u32 v154, v114, 2, s11
ds_add_rtn_u32 v154, v154, v7
v_cmp_le_u32 vcc, 5436, v35
s_nop 1
v_cndmask_b32 v115, v240, v242, vcc
v_cndmask_b32 v155, v241, v243, vcc
v_cmp_le_u32 vcc, 6432, v35
s_nop 1
v_cndmask_b32 v115, v115, v244, vcc
v_cndmask_b32 v155, v155, v245, vcc
v_cmp_le_u32 vcc, 7344, v35
s_nop 1
v_cndmask_b32 v115, v115, v246, vcc
v_cndmask_b32 v155, v155, v247, vcc
v_mad_u32_u24 v115, v115, v35, v155
v_lshrrev_b32 v115, 20, v115
v_lshl_add_u32 v155, v115, 2, s11
ds_add_rtn_u32 v155, v155, v7
s_waitcnt vmcnt(14)
v_cmp_le_u32 vcc, 5436, v36
s_nop 1
v_cndmask_b32 v116, v240, v242, vcc
v_cndmask_b32 v156, v241, v243, vcc
v_cmp_le_u32 vcc, 6432, v36
s_nop 1
v_cndmask_b32 v116, v116, v244, vcc
v_cndmask_b32 v156, v156, v245, vcc
v_cmp_le_u32 vcc, 7344, v36
s_nop 1
v_cndmask_b32 v116, v116, v246, vcc
v_cndmask_b32 v156, v156, v247, vcc
v_mad_u32_u24 v116, v116, v36, v156
v_lshrrev_b32 v116, 20, v116
v_lshl_add_u32 v156, v116, 2, s11
ds_add_rtn_u32 v156, v156, v7
v_cmp_le_u32 vcc, 5436, v37
s_nop 1
v_cndmask_b32 v117, v240, v242, vcc
v_cndmask_b32 v157, v241, v243, vcc
v_cmp_le_u32 vcc, 6432, v37
s_nop 1
v_cndmask_b32 v117, v117, v244, vcc
v_cndmask_b32 v157, v157, v245, vcc
v_cmp_le_u32 vcc, 7344, v37
s_nop 1
v_cndmask_b32 v117, v117, v246, vcc
v_cndmask_b32 v157, v157, v247, vcc
v_mad_u32_u24 v117, v117, v37, v157
v_lshrrev_b32 v117, 20, v117
v_lshl_add_u32 v157, v117, 2, s11
ds_add_rtn_u32 v157, v157, v7
v_cmp_le_u32 vcc, 5436, v38
s_nop 1
v_cndmask_b32 v118, v240, v242, vcc
v_cndmask_b32 v158, v241, v243, vcc
v_cmp_le_u32 vcc, 6432, v38
s_nop 1
v_cndmask_b32 v118, v118, v244, vcc
v_cndmask_b32 v158, v158, v245, vcc
v_cmp_le_u32 vcc, 7344, v38
s_nop 1
v_cndmask_b32 v118, v118, v246, vcc
v_cndmask_b32 v158, v158, v247, vcc
v_mad_u32_u24 v118, v118, v38, v158
v_lshrrev_b32 v118, 20, v118
v_lshl_add_u32 v158, v118, 2, s11
ds_add_rtn_u32 v158, v158, v7
v_cmp_le_u32 vcc, 5436, v39
s_nop 1
v_cndmask_b32 v119, v240, v242, vcc
v_cndmask_b32 v159, v241, v243, vcc
v_cmp_le_u32 vcc, 6432, v39
s_nop 1
v_cndmask_b32 v119, v119, v244, vcc
v_cndmask_b32 v159, v159, v245, vcc
v_cmp_le_u32 vcc, 7344, v39
s_nop 1
v_cndmask_b32 v119, v119, v246, vcc
v_cndmask_b32 v159, v159, v247, vcc
v_mad_u32_u24 v119, v119, v39, v159
v_lshrrev_b32 v119, 20, v119
v_lshl_add_u32 v159, v119, 2, s11
ds_add_rtn_u32 v159, v159, v7
s_waitcnt vmcnt(13)
v_cmp_le_u32 vcc, 5436, v40
s_nop 1
v_cndmask_b32 v120, v240, v242, vcc
v_cndmask_b32 v160, v241, v243, vcc
v_cmp_le_u32 vcc, 6432, v40
s_nop 1
v_cndmask_b32 v120, v120, v244, vcc
v_cndmask_b32 v160, v160, v245, vcc
v_cmp_le_u32 vcc, 7344, v40
s_nop 1
v_cndmask_b32 v120, v120, v246, vcc
v_cndmask_b32 v160, v160, v247, vcc
v_mad_u32_u24 v120, v120, v40, v160
v_lshrrev_b32 v120, 20, v120
v_lshl_add_u32 v160, v120, 2, s11
ds_add_rtn_u32 v160, v160, v7
v_cmp_le_u32 vcc, 5436, v41
s_nop 1
v_cndmask_b32 v121, v240, v242, vcc
v_cndmask_b32 v161, v241, v243, vcc
v_cmp_le_u32 vcc, 6432, v41
s_nop 1
v_cndmask_b32 v121, v121, v244, vcc
v_cndmask_b32 v161, v161, v245, vcc
v_cmp_le_u32 vcc, 7344, v41
s_nop 1
v_cndmask_b32 v121, v121, v246, vcc
v_cndmask_b32 v161, v161, v247, vcc
v_mad_u32_u24 v121, v121, v41, v161
v_lshrrev_b32 v121, 20, v121
v_lshl_add_u32 v161, v121, 2, s11
ds_add_rtn_u32 v161, v161, v7
v_cmp_le_u32 vcc, 5436, v42
s_nop 1
v_cndmask_b32 v122, v240, v242, vcc
v_cndmask_b32 v162, v241, v243, vcc
v_cmp_le_u32 vcc, 6432, v42
s_nop 1
v_cndmask_b32 v122, v122, v244, vcc
v_cndmask_b32 v162, v162, v245, vcc
v_cmp_le_u32 vcc, 7344, v42
s_nop 1
v_cndmask_b32 v122, v122, v246, vcc
v_cndmask_b32 v162, v162, v247, vcc
v_mad_u32_u24 v122, v122, v42, v162
v_lshrrev_b32 v122, 20, v122
v_lshl_add_u32 v162, v122, 2, s11
ds_add_rtn_u32 v162, v162, v7
v_cmp_le_u32 vcc, 5436, v43
s_nop 1
v_cndmask_b32 v123, v240, v242, vcc
v_cndmask_b32 v163, v241, v243, vcc
v_cmp_le_u32 vcc, 6432, v43
s_nop 1
v_cndmask_b32 v123, v123, v244, vcc
v_cndmask_b32 v163, v163, v245, vcc
v_cmp_le_u32 vcc, 7344, v43
s_nop 1
v_cndmask_b32 v123, v123, v246, vcc
v_cndmask_b32 v163, v163, v247, vcc
v_mad_u32_u24 v123, v123, v43, v163
v_lshrrev_b32 v123, 20, v123
v_lshl_add_u32 v163, v123, 2, s11
ds_add_rtn_u32 v163, v163, v7
s_waitcnt vmcnt(12)
v_cmp_le_u32 vcc, 5436, v44
s_nop 1
v_cndmask_b32 v124, v240, v242, vcc
v_cndmask_b32 v164, v241, v243, vcc
v_cmp_le_u32 vcc, 6432, v44
s_nop 1
v_cndmask_b32 v124, v124, v244, vcc
v_cndmask_b32 v164, v164, v245, vcc
v_cmp_le_u32 vcc, 7344, v44
s_nop 1
v_cndmask_b32 v124, v124, v246, vcc
v_cndmask_b32 v164, v164, v247, vcc
v_mad_u32_u24 v124, v124, v44, v164
v_lshrrev_b32 v124, 20, v124
v_lshl_add_u32 v164, v124, 2, s11
ds_add_rtn_u32 v164, v164, v7
v_cmp_le_u32 vcc, 5436, v45
s_nop 1
v_cndmask_b32 v125, v240, v242, vcc
v_cndmask_b32 v165, v241, v243, vcc
v_cmp_le_u32 vcc, 6432, v45
s_nop 1
v_cndmask_b32 v125, v125, v244, vcc
v_cndmask_b32 v165, v165, v245, vcc
v_cmp_le_u32 vcc, 7344, v45
s_nop 1
v_cndmask_b32 v125, v125, v246, vcc
v_cndmask_b32 v165, v165, v247, vcc
v_mad_u32_u24 v125, v125, v45, v165
v_lshrrev_b32 v125, 20, v125
v_lshl_add_u32 v165, v125, 2, s11
ds_add_rtn_u32 v165, v165, v7
v_cmp_le_u32 vcc, 5436, v46
s_nop 1
v_cndmask_b32 v126, v240, v242, vcc
v_cndmask_b32 v166, v241, v243, vcc
v_cmp_le_u32 vcc, 6432, v46
s_nop 1
v_cndmask_b32 v126, v126, v244, vcc
v_cndmask_b32 v166, v166, v245, vcc
v_cmp_le_u32 vcc, 7344, v46
s_nop 1
v_cndmask_b32 v126, v126, v246, vcc
v_cndmask_b32 v166, v166, v247, vcc
v_mad_u32_u24 v126, v126, v46, v166
v_lshrrev_b32 v126, 20, v126
v_lshl_add_u32 v166, v126, 2, s11
ds_add_rtn_u32 v166, v166, v7
v_cmp_le_u32 vcc, 5436, v47
s_nop 1
v_cndmask_b32 v127, v240, v242, vcc
v_cndmask_b32 v167, v241, v243, vcc
v_cmp_le_u32 vcc, 6432, v47
s_nop 1
v_cndmask_b32 v127, v127, v244, vcc
v_cndmask_b32 v167, v167, v245, vcc
v_cmp_le_u32 vcc, 7344, v47
s_nop 1
v_cndmask_b32 v127, v127, v246, vcc
v_cndmask_b32 v167, v167, v247, vcc
v_mad_u32_u24 v127, v127, v47, v167
v_lshrrev_b32 v127, 20, v127
v_lshl_add_u32 v167, v127, 2, s11
ds_add_rtn_u32 v167, v167, v7
s_waitcnt vmcnt(11)
v_cmp_le_u32 vcc, 5436, v48
s_nop 1
v_cndmask_b32 v128, v240, v242, vcc
v_cndmask_b32 v168, v241, v243, vcc
v_cmp_le_u32 vcc, 6432, v48
s_nop 1
v_cndmask_b32 v128, v128, v244, vcc
v_cndmask_b32 v168, v168, v245, vcc
v_cmp_le_u32 vcc, 7344, v48
s_nop 1
v_cndmask_b32 v128, v128, v246, vcc
v_cndmask_b32 v168, v168, v247, vcc
v_mad_u32_u24 v128, v128, v48, v168
v_lshrrev_b32 v128, 20, v128
v_lshl_add_u32 v168, v128, 2, s11
ds_add_rtn_u32 v168, v168, v7
v_cmp_le_u32 vcc, 5436, v49
s_nop 1
v_cndmask_b32 v129, v240, v242, vcc
v_cndmask_b32 v169, v241, v243, vcc
v_cmp_le_u32 vcc, 6432, v49
s_nop 1
v_cndmask_b32 v129, v129, v244, vcc
v_cndmask_b32 v169, v169, v245, vcc
v_cmp_le_u32 vcc, 7344, v49
s_nop 1
v_cndmask_b32 v129, v129, v246, vcc
v_cndmask_b32 v169, v169, v247, vcc
v_mad_u32_u24 v129, v129, v49, v169
v_lshrrev_b32 v129, 20, v129
v_lshl_add_u32 v169, v129, 2, s11
ds_add_rtn_u32 v169, v169, v7
v_cmp_le_u32 vcc, 5436, v50
s_nop 1
v_cndmask_b32 v130, v240, v242, vcc
v_cndmask_b32 v170, v241, v243, vcc
v_cmp_le_u32 vcc, 6432, v50
s_nop 1
v_cndmask_b32 v130, v130, v244, vcc
v_cndmask_b32 v170, v170, v245, vcc
v_cmp_le_u32 vcc, 7344, v50
s_nop 1
v_cndmask_b32 v130, v130, v246, vcc
v_cndmask_b32 v170, v170, v247, vcc
v_mad_u32_u24 v130, v130, v50, v170
v_lshrrev_b32 v130, 20, v130
v_lshl_add_u32 v170, v130, 2, s11
ds_add_rtn_u32 v170, v170, v7
v_cmp_le_u32 vcc, 5436, v51
s_nop 1
v_cndmask_b32 v131, v240, v242, vcc
v_cndmask_b32 v171, v241, v243, vcc
v_cmp_le_u32 vcc, 6432, v51
s_nop 1
v_cndmask_b32 v131, v131, v244, vcc
v_cndmask_b32 v171, v171, v245, vcc
v_cmp_le_u32 vcc, 7344, v51
s_nop 1
v_cndmask_b32 v131, v131, v246, vcc
v_cndmask_b32 v171, v171, v247, vcc
v_mad_u32_u24 v131, v131, v51, v171
v_lshrrev_b32 v131, 20, v131
v_lshl_add_u32 v171, v131, 2, s11
ds_add_rtn_u32 v171, v171, v7
s_waitcnt vmcnt(10)
s_mov_b64 exec, s[12:13]
v_cmp_le_u32 vcc, 5436, v52
s_nop 1
v_cndmask_b32 v132, v240, v242, vcc
v_cndmask_b32 v172, v241, v243, vcc
v_cmp_le_u32 vcc, 6432, v52
s_nop 1
v_cndmask_b32 v132, v132, v244, vcc
v_cndmask_b32 v172, v172, v245, vcc
v_cmp_le_u32 vcc, 7344, v52
s_nop 1
v_cndmask_b32 v132, v132, v246, vcc
v_cndmask_b32 v172, v172, v247, vcc
v_mad_u32_u24 v132, v132, v52, v172
v_lshrrev_b32 v132, 20, v132
v_lshl_add_u32 v172, v132, 2, s11
ds_add_rtn_u32 v172, v172, v7
v_cmp_le_u32 vcc, 5436, v53
s_nop 1
v_cndmask_b32 v133, v240, v242, vcc
v_cndmask_b32 v173, v241, v243, vcc
v_cmp_le_u32 vcc, 6432, v53
s_nop 1
v_cndmask_b32 v133, v133, v244, vcc
v_cndmask_b32 v173, v173, v245, vcc
v_cmp_le_u32 vcc, 7344, v53
s_nop 1
v_cndmask_b32 v133, v133, v246, vcc
v_cndmask_b32 v173, v173, v247, vcc
v_mad_u32_u24 v133, v133, v53, v173
v_lshrrev_b32 v133, 20, v133
v_lshl_add_u32 v173, v133, 2, s11
ds_add_rtn_u32 v173, v173, v7
v_cmp_le_u32 vcc, 5436, v54
s_nop 1
v_cndmask_b32 v134, v240, v242, vcc
v_cndmask_b32 v174, v241, v243, vcc
v_cmp_le_u32 vcc, 6432, v54
s_nop 1
v_cndmask_b32 v134, v134, v244, vcc
v_cndmask_b32 v174, v174, v245, vcc
v_cmp_le_u32 vcc, 7344, v54
s_nop 1
v_cndmask_b32 v134, v134, v246, vcc
v_cndmask_b32 v174, v174, v247, vcc
v_mad_u32_u24 v134, v134, v54, v174
v_lshrrev_b32 v134, 20, v134
v_lshl_add_u32 v174, v134, 2, s11
ds_add_rtn_u32 v174, v174, v7
v_cmp_le_u32 vcc, 5436, v55
s_nop 1
v_cndmask_b32 v135, v240, v242, vcc
v_cndmask_b32 v175, v241, v243, vcc
v_cmp_le_u32 vcc, 6432, v55
s_nop 1
v_cndmask_b32 v135, v135, v244, vcc
v_cndmask_b32 v175, v175, v245, vcc
v_cmp_le_u32 vcc, 7344, v55
s_nop 1
v_cndmask_b32 v135, v135, v246, vcc
v_cndmask_b32 v175, v175, v247, vcc
v_mad_u32_u24 v135, v135, v55, v175
v_lshrrev_b32 v135, 20, v135
v_lshl_add_u32 v175, v135, 2, s11
ds_add_rtn_u32 v175, v175, v7
s_mov_b64 exec, -1
s_waitcnt vmcnt(9) lgkmcnt(15)
v_and_b32 v8, 0xff, v136
v_lshl_or_b32 v56, v16, 18, v56
v_lshlrev_b32 v8, 2, v8
v_lshl_add_u32 v8, v96, 10, v8
ds_write_b32 v8, v56
v_and_b32 v8, 0xff, v137
v_lshl_or_b32 v57, v17, 18, v57
v_lshlrev_b32 v8, 2, v8
v_lshl_add_u32 v8, v97, 10, v8
ds_write_b32 v8, v57
v_and_b32 v8, 0xff, v138
v_lshl_or_b32 v58, v18, 18, v58
v_lshlrev_b32 v8, 2, v8
v_lshl_add_u32 v8, v98, 10, v8
ds_write_b32 v8, v58
v_and_b32 v8, 0xff, v139
v_lshl_or_b32 v59, v19, 18, v59
v_lshlrev_b32 v8, 2, v8
v_lshl_add_u32 v8, v99, 10, v8
ds_write_b32 v8, v59
s_waitcnt vmcnt(8) lgkmcnt(15)
v_and_b32 v8, 0xff, v140
v_lshl_or_b32 v60, v20, 18, v60
v_lshlrev_b32 v8, 2, v8
v_lshl_add_u32 v8, v100, 10, v8
ds_write_b32 v8, v60
v_and_b32 v8, 0xff, v141
v_lshl_or_b32 v61, v21, 18, v61
v_lshlrev_b32 v8, 2, v8
v_lshl_add_u32 v8, v101, 10, v8
ds_write_b32 v8, v61
v_and_b32 v8, 0xff, v142
v_lshl_or_b32 v62, v22, 18, v62
v_lshlrev_b32 v8, 2, v8
v_lshl_add_u32 v8, v102, 10, v8
ds_write_b32 v8, v62
v_and_b32 v8, 0xff, v143
v_lshl_or_b32 v63, v23, 18, v63
v_lshlrev_b32 v8, 2, v8
v_lshl_add_u32 v8, v103, 10, v8
ds_write_b32 v8, v63
s_waitcnt vmcnt(7) lgkmcnt(15)
v_and_b32 v8, 0xff, v144
v_lshl_or_b32 v64, v24, 18, v64
v_lshlrev_b32 v8, 2, v8
v_lshl_add_u32 v8, v104, 10, v8
ds_write_b32 v8, v64
v_and_b32 v8, 0xff, v145
v_lshl_or_b32 v65, v25, 18, v65
v_lshlrev_b32 v8, 2, v8
v_lshl_add_u32 v8, v105, 10, v8
ds_write_b32 v8, v65
v_and_b32 v8, 0xff, v146
v_lshl_or_b32 v66, v26, 18, v66
v_lshlrev_b32 v8, 2, v8
v_lshl_add_u32 v8, v106, 10, v8
ds_write_b32 v8, v66
v_and_b32 v8, 0xff, v147
v_lshl_or_b32 v67, v27, 18, v67
v_lshlrev_b32 v8, 2, v8
v_lshl_add_u32 v8, v107, 10, v8
ds_write_b32 v8, v67
s_waitcnt vmcnt(6) lgkmcnt(15)
v_and_b32 v8, 0xff, v148
v_lshl_or_b32 v68, v28, 18, v68
v_lshlrev_b32 v8, 2, v8
v_lshl_add_u32 v8, v108, 10, v8
ds_write_b32 v8, v68
v_and_b32 v8, 0xff, v149
v_lshl_or_b32 v69, v29, 18, v69
v_lshlrev_b32 v8, 2, v8
v_lshl_add_u32 v8, v109, 10, v8
ds_write_b32 v8, v69
v_and_b32 v8, 0xff, v150
v_lshl_or_b32 v70, v30, 18, v70
v_lshlrev_b32 v8, 2, v8
v_lshl_add_u32 v8, v110, 10, v8
ds_write_b32 v8, v70
v_and_b32 v8, 0xff, v151
v_lshl_or_b32 v71, v31, 18, v71
v_lshlrev_b32 v8, 2, v8
v_lshl_add_u32 v8, v111, 10, v8
ds_write_b32 v8, v71
s_waitcnt vmcnt(5) lgkmcnt(15)
v_and_b32 v8, 0xff, v152
v_lshl_or_b32 v72, v32, 18, v72
v_lshlrev_b32 v8, 2, v8
v_lshl_add_u32 v8, v112, 10, v8
ds_write_b32 v8, v72
v_and_b32 v8, 0xff, v153
v_lshl_or_b32 v73, v33, 18, v73
v_lshlrev_b32 v8, 2, v8
v_lshl_add_u32 v8, v113, 10, v8
ds_write_b32 v8, v73
v_and_b32 v8, 0xff, v154
v_lshl_or_b32 v74, v34, 18, v74
v_lshlrev_b32 v8, 2, v8
v_lshl_add_u32 v8, v114, 10, v8
ds_write_b32 v8, v74
v_and_b32 v8, 0xff, v155
v_lshl_or_b32 v75, v35, 18, v75
v_lshlrev_b32 v8, 2, v8
v_lshl_add_u32 v8, v115, 10, v8
ds_write_b32 v8, v75
s_waitcnt vmcnt(4) lgkmcnt(15)
v_and_b32 v8, 0xff, v156
v_lshl_or_b32 v76, v36, 18, v76
v_lshlrev_b32 v8, 2, v8
v_lshl_add_u32 v8, v116, 10, v8
ds_write_b32 v8, v76
v_and_b32 v8, 0xff, v157
v_lshl_or_b32 v77, v37, 18, v77
v_lshlrev_b32 v8, 2, v8
v_lshl_add_u32 v8, v117, 10, v8
ds_write_b32 v8, v77
v_and_b32 v8, 0xff, v158
v_lshl_or_b32 v78, v38, 18, v78
v_lshlrev_b32 v8, 2, v8
v_lshl_add_u32 v8, v118, 10, v8
ds_write_b32 v8, v78
v_and_b32 v8, 0xff, v159
v_lshl_or_b32 v79, v39, 18, v79
v_lshlrev_b32 v8, 2, v8
v_lshl_add_u32 v8, v119, 10, v8
ds_write_b32 v8, v79
s_waitcnt vmcnt(3) lgkmcnt(15)
v_and_b32 v8, 0xff, v160
v_lshl_or_b32 v80, v40, 18, v80
v_lshlrev_b32 v8, 2, v8
v_lshl_add_u32 v8, v120, 10, v8
ds_write_b32 v8, v80
v_and_b32 v8, 0xff, v161
v_lshl_or_b32 v81, v41, 18, v81
v_lshlrev_b32 v8, 2, v8
v_lshl_add_u32 v8, v121, 10, v8
ds_write_b32 v8, v81
v_and_b32 v8, 0xff, v162
v_lshl_or_b32 v82, v42, 18, v82
v_lshlrev_b32 v8, 2, v8
v_lshl_add_u32 v8, v122, 10, v8
ds_write_b32 v8, v82
v_and_b32 v8, 0xff, v163
v_lshl_or_b32 v83, v43, 18, v83
v_lshlrev_b32 v8, 2, v8
v_lshl_add_u32 v8, v123, 10, v8
ds_write_b32 v8, v83
s_waitcnt vmcnt(2) lgkmcnt(15)
v_and_b32 v8, 0xff, v164
v_lshl_or_b32 v84, v44, 18, v84
v_lshlrev_b32 v8, 2, v8
v_lshl_add_u32 v8, v124, 10, v8
ds_write_b32 v8, v84
v_and_b32 v8, 0xff, v165
v_lshl_or_b32 v85, v45, 18, v85
v_lshlrev_b32 v8, 2, v8
v_lshl_add_u32 v8, v125, 10, v8
ds_write_b32 v8, v85
v_and_b32 v8, 0xff, v166
v_lshl_or_b32 v86, v46, 18, v86
v_lshlrev_b32 v8, 2, v8
v_lshl_add_u32 v8, v126, 10, v8
ds_write_b32 v8, v86
v_and_b32 v8, 0xff, v167
v_lshl_or_b32 v87, v47, 18, v87
v_lshlrev_b32 v8, 2, v8
v_lshl_add_u32 v8, v127, 10, v8
ds_write_b32 v8, v87
s_waitcnt vmcnt(1) lgkmcnt(15)
v_and_b32 v8, 0xff, v168
v_lshl_or_b32 v88, v48, 18, v88
v_lshlrev_b32 v8, 2, v8
v_lshl_add_u32 v8, v128, 10, v8
ds_write_b32 v8, v88
v_and_b32 v8, 0xff, v169
v_lshl_or_b32 v89, v49, 18, v89
v_lshlrev_b32 v8, 2, v8
v_lshl_add_u32 v8, v129, 10, v8
ds_write_b32 v8, v89
v_and_b32 v8, 0xff, v170
v_lshl_or_b32 v90, v50, 18, v90
v_lshlrev_b32 v8, 2, v8
v_lshl_add_u32 v8, v130, 10, v8
ds_write_b32 v8, v90
v_and_b32 v8, 0xff, v171
v_lshl_or_b32 v91, v51, 18, v91
v_lshlrev_b32 v8, 2, v8
v_lshl_add_u32 v8, v131, 10, v8
ds_write_b32 v8, v91
s_waitcnt vmcnt(0) lgkmcnt(15)
s_mov_b64 exec, s[12:13]
v_and_b32 v8, 0xff, v172
v_lshl_or_b32 v92, v52, 18, v92
v_lshlrev_b32 v8, 2, v8
v_lshl_add_u32 v8, v132, 10, v8
ds_write_b32 v8, v92
v_and_b32 v8, 0xff, v173
v_lshl_or_b32 v93, v53, 18, v93
v_lshlrev_b32 v8, 2, v8
v_lshl_add_u32 v8, v133, 10, v8
ds_write_b32 v8, v93
v_and_b32 v8, 0xff, v174
v_lshl_or_b32 v94, v54, 18, v94
v_lshlrev_b32 v8, 2, v8
v_lshl_add_u32 v8, v134, 10, v8
ds_write_b32 v8, v94
v_and_b32 v8, 0xff, v175
v_lshl_or_b32 v95, v55, 18, v95
v_lshlrev_b32 v8, 2, v8
v_lshl_add_u32 v8, v135, 10, v8
ds_write_b32 v8, v95
s_mov_b64 exec, -1
s_waitcnt lgkmcnt(0)
s_barrier
ds_read_b32 v8, v6
s_mul_i32 s6, s60, 16384
v_lshlrev_b32 v10, 4, v2
v_add_u32 v9, s6, v10
ds_read_b128 v[176:179], v9 offset:0
ds_read_b128 v[180:183], v9 offset:1024
ds_read_b128 v[184:187], v9 offset:2048
ds_read_b128 v[188:191], v9 offset:3072
ds_read_b128 v[192:195], v9 offset:4096
ds_read_b128 v[196:199], v9 offset:5120
ds_read_b128 v[200:203], v9 offset:6144
ds_read_b128 v[204:207], v9 offset:7168
ds_read_b128 v[208:211], v9 offset:8192
ds_read_b128 v[212:215], v9 offset:9216
ds_read_b128 v[216:219], v9 offset:10240
ds_read_b128 v[220:223], v9 offset:11264
ds_read_b128 v[224:227], v9 offset:12288
ds_read_b128 v[228:231], v9 offset:13312
ds_read_b128 v[232:235], v9 offset:14336
ds_read_b128 v[236:239], v9 offset:15360
s_mul_i32 s6, s60, 262144
s_mul_i32 s7, s4, 1024
s_add_u32 s6, s6, s7
v_lshlrev_b32 v9, 2, v2
s_lshl_b32 s8, s4, 8
s_cmp_eq_u32 s60, 0
s_cselect_b32 s8, s8, 0x7fff0000
s_waitcnt lgkmcnt(15)
buffer_store_dword v8, v9, s[52:55], s8 offen sc1
v_cmp_lt_u32 vcc, 0x100, v8
s_cbranch_vccnz L1_eslow
s_waitcnt lgkmcnt(15)
buffer_store_dwordx4 v[176:179], v10, s[48:51], s6 offen sc1
s_add_u32 s6, s6, 16384
s_waitcnt lgkmcnt(14)
buffer_store_dwordx4 v[180:183], v10, s[48:51], s6 offen sc1
s_add_u32 s6, s6, 16384
s_waitcnt lgkmcnt(13)
buffer_store_dwordx4 v[184:187], v10, s[48:51], s6 offen sc1
s_add_u32 s6, s6, 16384
s_waitcnt lgkmcnt(12)
buffer_store_dwordx4 v[188:191], v10, s[48:51], s6 offen sc1
s_add_u32 s6, s6, 16384
s_waitcnt lgkmcnt(11)
buffer_store_dwordx4 v[192:195], v10, s[48:51], s6 offen sc1
s_add_u32 s6, s6, 16384
s_waitcnt lgkmcnt(10)
buffer_store_dwordx4 v[196:199], v10, s[48:51], s6 offen sc1
s_add_u32 s6, s6, 16384
s_waitcnt lgkmcnt(9)
buffer_store_dwordx4 v[200:203], v10, s[48:51], s6 offen sc1
s_add_u32 s6, s6, 16384
s_waitcnt lgkmcnt(8)
buffer_store_dwordx4 v[204:207], v10, s[48:51], s6 offen sc1
s_add_u32 s6, s6, 16384
s_waitcnt lgkmcnt(7)
buffer_store_dwordx4 v[208:211], v10, s[48:51], s6 offen sc1
s_add_u32 s6, s6, 16384
s_waitcnt lgkmcnt(6)
buffer_store_dwordx4 v[212:215], v10, s[48:51], s6 offen sc1
s_add_u32 s6, s6, 16384
s_waitcnt lgkmcnt(5)
buffer_store_dwordx4 v[216:219], v10, s[48:51], s6 offen sc1
s_add_u32 s6, s6, 16384
s_waitcnt lgkmcnt(4)
buffer_store_dwordx4 v[220:223], v10, s[48:51], s6 offen sc1
s_add_u32 s6, s6, 16384
s_waitcnt lgkmcnt(3)
buffer_store_dwordx4 v[224:227], v10, s[48:51], s6 offen sc1
s_add_u32 s6, s6, 16384
s_waitcnt lgkmcnt(2)
buffer_store_dwordx4 v[228:231], v10, s[48:51], s6 offen sc1
s_add_u32 s6, s6, 16384
s_waitcnt lgkmcnt(1)
buffer_store_dwordx4 v[232:235], v10, s[48:51], s6 offen sc1
s_add_u32 s6, s6, 16384
s_waitcnt lgkmcnt(0)
buffer_store_dwordx4 v[236:239], v10, s[48:51], s6 offen sc1
s_add_u32 s6, s6, 16384
s_branch L1_fin
L1_eslow:
s_mov_b32 s9, 16384
v_mul_u32_u24 v96, s9, v96
v_and_b32 v8, 255, v136
v_lshl_add_u32 v96, v8, 2, v96
v_lshrrev_b32 v8, 8, v136
v_lshl_add_u32 v96, v8, 20, v96
v_mul_u32_u24 v97, s9, v97
v_and_b32 v8, 255, v137
v_lshl_add_u32 v97, v8, 2, v97
v_lshrrev_b32 v8, 8, v137
v_lshl_add_u32 v97, v8, 20, v97
v_mul_u32_u24 v98, s9, v98
v_and_b32 v8, 255, v138
v_lshl_add_u32 v98, v8, 2, v98
v_lshrrev_b32 v8, 8, v138
v_lshl_add_u32 v98, v8, 20, v98
v_mul_u32_u24 v99, s9, v99
v_and_b32 v8, 255, v139
v_lshl_add_u32 v99, v8, 2, v99
v_lshrrev_b32 v8, 8, v139
v_lshl_add_u32 v99, v8, 20, v99
v_mul_u32_u24 v100, s9, v100
v_and_b32 v8, 255, v140
v_lshl_add_u32 v100, v8, 2, v100
v_lshrrev_b32 v8, 8, v140
v_lshl_add_u32 v100, v8, 20, v100
v_mul_u32_u24 v101, s9, v101
v_and_b32 v8, 255, v141
v_lshl_add_u32 v101, v8, 2, v101
v_lshrrev_b32 v8, 8, v141
v_lshl_add_u32 v101, v8, 20, v101
v_mul_u32_u24 v102, s9, v102
v_and_b32 v8, 255, v142
v_lshl_add_u32 v102, v8, 2, v102
v_lshrrev_b32 v8, 8, v142
v_lshl_add_u32 v102, v8, 20, v102
v_mul_u32_u24 v103, s9, v103
v_and_b32 v8, 255, v143
v_lshl_add_u32 v103, v8, 2, v103
v_lshrrev_b32 v8, 8, v143
v_lshl_add_u32 v103, v8, 20, v103
v_mul_u32_u24 v104, s9, v104
v_and_b32 v8, 255, v144
v_lshl_add_u32 v104, v8, 2, v104
v_lshrrev_b32 v8, 8, v144
v_lshl_add_u32 v104, v8, 20, v104
v_mul_u32_u24 v105, s9, v105
v_and_b32 v8, 255, v145
v_lshl_add_u32 v105, v8, 2, v105
v_lshrrev_b32 v8, 8, v145
v_lshl_add_u32 v105, v8, 20, v105
v_mul_u32_u24 v106, s9, v106
v_and_b32 v8, 255, v146
v_lshl_add_u32 v106, v8, 2, v106
v_lshrrev_b32 v8, 8, v146
v_lshl_add_u32 v106, v8, 20, v106
v_mul_u32_u24 v107, s9, v107
v_and_b32 v8, 255, v147
v_lshl_add_u32 v107, v8, 2, v107
v_lshrrev_b32 v8, 8, v147
v_lshl_add_u32 v107, v8, 20, v107
v_mul_u32_u24 v108, s9, v108
v_and_b32 v8, 255, v148
v_lshl_add_u32 v108, v8, 2, v108
v_lshrrev_b32 v8, 8, v148
v_lshl_add_u32 v108, v8, 20, v108
v_mul_u32_u24 v109, s9, v109
v_and_b32 v8, 255, v149
v_lshl_add_u32 v109, v8, 2, v109
v_lshrrev_b32 v8, 8, v149
v_lshl_add_u32 v109, v8, 20, v109
v_mul_u32_u24 v110, s9, v110
v_and_b32 v8, 255, v150
v_lshl_add_u32 v110, v8, 2, v110
v_lshrrev_b32 v8, 8, v150
v_lshl_add_u32 v110, v8, 20, v110
v_mul_u32_u24 v111, s9, v111
v_and_b32 v8, 255, v151
v_lshl_add_u32 v111, v8, 2, v111
v_lshrrev_b32 v8, 8, v151
v_lshl_add_u32 v111, v8, 20, v111
v_mul_u32_u24 v112, s9, v112
v_and_b32 v8, 255, v152
v_lshl_add_u32 v112, v8, 2, v112
v_lshrrev_b32 v8, 8, v152
v_lshl_add_u32 v112, v8, 20, v112
v_mul_u32_u24 v113, s9, v113
v_and_b32 v8, 255, v153
v_lshl_add_u32 v113, v8, 2, v113
v_lshrrev_b32 v8, 8, v153
v_lshl_add_u32 v113, v8, 20, v113
v_mul_u32_u24 v114, s9, v114
v_and_b32 v8, 255, v154
v_lshl_add_u32 v114, v8, 2, v114
v_lshrrev_b32 v8, 8, v154
v_lshl_add_u32 v114, v8, 20, v114
v_mul_u32_u24 v115, s9, v115
v_and_b32 v8, 255, v155
v_lshl_add_u32 v115, v8, 2, v115
v_lshrrev_b32 v8, 8, v155
v_lshl_add_u32 v115, v8, 20, v115
v_mul_u32_u24 v116, s9, v116
v_and_b32 v8, 255, v156
v_lshl_add_u32 v116, v8, 2, v116
v_lshrrev_b32 v8, 8, v156
v_lshl_add_u32 v116, v8, 20, v116
v_mul_u32_u24 v117, s9, v117
v_and_b32 v8, 255, v157
v_lshl_add_u32 v117, v8, 2, v117
v_lshrrev_b32 v8, 8, v157
v_lshl_add_u32 v117, v8, 20, v117
v_mul_u32_u24 v118, s9, v118
v_and_b32 v8, 255, v158
v_lshl_add_u32 v118, v8, 2, v118
v_lshrrev_b32 v8, 8, v158
v_lshl_add_u32 v118, v8, 20, v118
v_mul_u32_u24 v119, s9, v119
v_and_b32 v8, 255, v159
v_lshl_add_u32 v119, v8, 2, v119
v_lshrrev_b32 v8, 8, v159
v_lshl_add_u32 v119, v8, 20, v119
v_mul_u32_u24 v120, s9, v120
v_and_b32 v8, 255, v160
v_lshl_add_u32 v120, v8, 2, v120
v_lshrrev_b32 v8, 8, v160
v_lshl_add_u32 v120, v8, 20, v120
v_mul_u32_u24 v121, s9, v121
v_and_b32 v8, 255, v161
v_lshl_add_u32 v121, v8, 2, v121
v_lshrrev_b32 v8, 8, v161
v_lshl_add_u32 v121, v8, 20, v121
v_mul_u32_u24 v122, s9, v122
v_and_b32 v8, 255, v162
v_lshl_add_u32 v122, v8, 2, v122
v_lshrrev_b32 v8, 8, v162
v_lshl_add_u32 v122, v8, 20, v122
v_mul_u32_u24 v123, s9, v123
v_and_b32 v8, 255, v163
v_lshl_add_u32 v123, v8, 2, v123
v_lshrrev_b32 v8, 8, v163
v_lshl_add_u32 v123, v8, 20, v123
v_mul_u32_u24 v124, s9, v124
v_and_b32 v8, 255, v164
v_lshl_add_u32 v124, v8, 2, v124
v_lshrrev_b32 v8, 8, v164
v_lshl_add_u32 v124, v8, 20, v124
v_mul_u32_u24 v125, s9, v125
v_and_b32 v8, 255, v165
v_lshl_add_u32 v125, v8, 2, v125
v_lshrrev_b32 v8, 8, v165
v_lshl_add_u32 v125, v8, 20, v125
v_mul_u32_u24 v126, s9, v126
v_and_b32 v8, 255, v166
v_lshl_add_u32 v126, v8, 2, v126
v_lshrrev_b32 v8, 8, v166
v_lshl_add_u32 v126, v8, 20, v126
v_mul_u32_u24 v127, s9, v127
v_and_b32 v8, 255, v167
v_lshl_add_u32 v127, v8, 2, v127
v_lshrrev_b32 v8, 8, v167
v_lshl_add_u32 v127, v8, 20, v127
v_mul_u32_u24 v128, s9, v128
v_and_b32 v8, 255, v168
v_lshl_add_u32 v128, v8, 2, v128
v_lshrrev_b32 v8, 8, v168
v_lshl_add_u32 v128, v8, 20, v128
v_mul_u32_u24 v129, s9, v129
v_and_b32 v8, 255, v169
v_lshl_add_u32 v129, v8, 2, v129
v_lshrrev_b32 v8, 8, v169
v_lshl_add_u32 v129, v8, 20, v129
v_mul_u32_u24 v130, s9, v130
v_and_b32 v8, 255, v170
v_lshl_add_u32 v130, v8, 2, v130
v_lshrrev_b32 v8, 8, v170
v_lshl_add_u32 v130, v8, 20, v130
v_mul_u32_u24 v131, s9, v131
v_and_b32 v8, 255, v171
v_lshl_add_u32 v131, v8, 2, v131
v_lshrrev_b32 v8, 8, v171
v_lshl_add_u32 v131, v8, 20, v131
v_mul_u32_u24 v132, s9, v132
v_and_b32 v8, 255, v172
v_lshl_add_u32 v132, v8, 2, v132
v_lshrrev_b32 v8, 8, v172
v_lshl_add_u32 v132, v8, 20, v132
v_mul_u32_u24 v133, s9, v133
v_and_b32 v8, 255, v173
v_lshl_add_u32 v133, v8, 2, v133
v_lshrrev_b32 v8, 8, v173
v_lshl_add_u32 v133, v8, 20, v133
v_mul_u32_u24 v134, s9, v134
v_and_b32 v8, 255, v174
v_lshl_add_u32 v134, v8, 2, v134
v_lshrrev_b32 v8, 8, v174
v_lshl_add_u32 v134, v8, 20, v134
v_mul_u32_u24 v135, s9, v135
v_and_b32 v8, 255, v175
v_lshl_add_u32 v135, v8, 2, v135
v_lshrrev_b32 v8, 8, v175
v_lshl_add_u32 v135, v8, 20, v135
buffer_store_dword v56, v96, s[48:51], s7 offen sc1
buffer_store_dword v57, v97, s[48:51], s7 offen sc1
buffer_store_dword v58, v98, s[48:51], s7 offen sc1
buffer_store_dword v59, v99, s[48:51], s7 offen sc1
buffer_store_dword v60, v100, s[48:51], s7 offen sc1
buffer_store_dword v61, v101, s[48:51], s7 offen sc1
buffer_store_dword v62, v102, s[48:51], s7 offen sc1
buffer_store_dword v63, v103, s[48:51], s7 offen sc1
buffer_store_dword v64, v104, s[48:51], s7 offen sc1
buffer_store_dword v65, v105, s[48:51], s7 offen sc1
buffer_store_dword v66, v106, s[48:51], s7 offen sc1
buffer_store_dword v67, v107, s[48:51], s7 offen sc1
buffer_store_dword v68, v108, s[48:51], s7 offen sc1
buffer_store_dword v69, v109, s[48:51], s7 offen sc1
buffer_store_dword v70, v110, s[48:51], s7 offen sc1
buffer_store_dword v71, v111, s[48:51], s7 offen sc1
buffer_store_dword v72, v112, s[48:51], s7 offen sc1
buffer_store_dword v73, v113, s[48:51], s7 offen sc1
buffer_store_dword v74, v114, s[48:51], s7 offen sc1
buffer_store_dword v75, v115, s[48:51], s7 offen sc1
buffer_store_dword v76, v116, s[48:51], s7 offen sc1
buffer_store_dword v77, v117, s[48:51], s7 offen sc1
buffer_store_dword v78, v118, s[48:51], s7 offen sc1
buffer_store_dword v79, v119, s[48:51], s7 offen sc1
buffer_store_dword v80, v120, s[48:51], s7 offen sc1
buffer_store_dword v81, v121, s[48:51], s7 offen sc1
buffer_store_dword v82, v122, s[48:51], s7 offen sc1
buffer_store_dword v83, v123, s[48:51], s7 offen sc1
buffer_store_dword v84, v124, s[48:51], s7 offen sc1
buffer_store_dword v85, v125, s[48:51], s7 offen sc1
buffer_store_dword v86, v126, s[48:51], s7 offen sc1
buffer_store_dword v87, v127, s[48:51], s7 offen sc1
buffer_store_dword v88, v128, s[48:51], s7 offen sc1
buffer_store_dword v89, v129, s[48:51], s7 offen sc1
buffer_store_dword v90, v130, s[48:51], s7 offen sc1
buffer_store_dword v91, v131, s[48:51], s7 offen sc1
s_mov_b64 exec, s[12:13]
buffer_store_dword v92, v132, s[48:51], s7 offen sc1
buffer_store_dword v93, v133, s[48:51], s7 offen sc1
buffer_store_dword v94, v134, s[48:51], s7 offen sc1
buffer_store_dword v95, v135, s[48:51], s7 offen sc1
s_mov_b64 exec, -1
s_branch L1_fin
L2_entry:
s_load_dwordx2 s[4:5], s[0:1], 88
s_load_dwordx2 s[60:61], s[0:1], 0
s_load_dwordx2 s[52:53], s[0:1], 24
s_load_dwordx2 s[56:57], s[0:1], 72
s_and_b32 s35, s2, 7
s_lshr_b32 s37, s2, 3
s_add_u32 s37, s37, 30
s_and_b32 s37, s37, 31
v_lshrrev_b32 v1, 6, v0
s_mov_b32 s36, -1
v_readfirstlane_b32 s38, v1
s_cmp_lt_u32 s37, 30
s_cbranch_scc1 L2_att
s_lshl_b32 s39, s35, 1
s_add_u32 s39, s39, s37
s_sub_u32 s39, s39, 30
s_cmp_lt_u32 s38, 3
s_cbranch_scc1 LE_start
s_cmp_ge_u32 s39, 12
s_cbranch_scc1 L2_end
s_and_b32 s36, s39, 1
s_lshr_b32 s37, s39, 1
s_mov_b32 s38, 39
v_and_b32 v0, 63, v0
s_branch L2_att2
L2_att:
s_mul_i32 s38, s37, 26
s_lshr_b32 s38, s38, 8
s_mul_i32 s39, s38, 10
s_sub_u32 s39, s37, s39
s_and_b32 s37, s35, 1
s_mul_i32 s37, s37, 3
s_add_u32 s37, s37, s38
s_and_b32 s38, s35, 1
s_mul_i32 s38, s38, 5
s_add_u32 s35, s35, s38
s_and_b32 s35, s35, 7
s_lshr_b32 s38, s35, 1
s_mul_i32 s38, s38, 10
s_add_u32 s38, s38, s39
L2_att2:
v_lshrrev_b32 v1, 6, v0
v_and_b32 v243, 63, v0
v_lshlrev_b32 v243, 4, v243
v_readfirstlane_b32 s34, v1
s_mov_b32 s50, 0xe1a06800
s_mov_b32 s51, 0x4e20ad04
s_mul_i32 s39, s37, 9
s_lshr_b64 s[50:51], s[50:51], s39
s_and_b32 s39, s50, 0x1ff
s_bfe_u32 s49, s50, 0x90009
s_sub_u32 s31, s49, s39
s_sub_u32 s31, s31, 4
s_lshl_b32 s39, s39, 14
s_lshl_b32 s49, s49, 14
s_add_u32 s28, s39, 0x4000
s_cmp_eq_u32 s37, 5
s_addc_u32 s31, s31, 0
s_cmp_eq_u32 s37, 5
s_cselect_b32 s28, s39, s28
s_cselect_b32 s39, 5111808, s39
s_cselect_b32 s49, 5120000, s49
s_cselect_b32 s33, 0xff800000, 0
s_mov_b32 s32, 0x5d800000
v_and_b32 v2, 63, v0
v_bfe_u32 v3, v2, 3, 2
v_bfe_u32 v4, v2, 2, 1
v_lshlrev_b32 v241, 12, v3
v_lshl_or_b32 v241, v4, 9, v241
v_lshl_or_b32 v241, v1, 7, v241
v_lshrrev_b32 v4, 5, v2
v_lshl_or_b32 v241, v4, 6, v241
v_and_b32 v3, 2, v3
v_and_b32 v4, 3, v2
v_xor_b32 v3, v3, v4
v_lshl_or_b32 v241, v3, 4, v241
s_cmp_eq_u32 s38, 39
s_cbranch_scc1 LT_disp
s_cmp_lt_u32 s37, 3
s_cselect_b32 s101, 1, -1
s_cselect_b32 s39, 0, 103
s_cselect_b32 s3, 0, 3
s_sub_u32 s3, s37, s3
s_mul_i32 s3, s3, 104
s_add_u32 s39, s39, s3
s_cmp_eq_u32 s37, 5
s_addc_u32 s39, s39, 0
s_lshl_b32 s101, s101, 14
s_lshl_b32 s39, s39, 14
s_add_u32 s28, s39, s101
s_mov_b32 s49, 5120000
s_mov_b32 s31, 40
s_mov_b32 s100, 5
s_lshl_b32 s30, s34, 12
s_lshl_b32 s50, s34, 13
s_add_u32 s50, s50, 0x20000
s_mov_b32 m0, s30
s_cmp_lt_u32 s37, 3
s_mov_b32 s40, 0x4682d124
s_cselect_b32 s40, s40, 0xc003fdb0
s_cselect_b32 s41, 11, 15
s_cselect_b32 s3, 0, 36
s_lshl_b32 s94, s37, 2
s_add_u32 s94, s94, s34
s_mul_i32 s94, s94, 3
s_sub_u32 s3, s94, s3
s_lshr_b64 s[40:41], s[40:41], s3
s_and_b32 s94, s40, 3
s_bfe_u32 s95, s40, 0x10002
s_mov_b32 s6, 0x92c51840
s_mov_b32 s7, 0xfb73ea6d
s_mul_i32 s3, s37, 12
s_min_u32 s3, s3, 56
s_lshr_b64 s[6:7], s[6:7], s3
s_bfe_u32 s29, s6, 0x40008
s_bfe_u32 s7, s6, 0x40004
s_and_b32 s6, s6, 15
s_cmp_lt_u32 s37, 4
s_cselect_b32 s29, s29, 16
s_lshl_b32 s3, s38, 17
s_lshl_b32 s51, s34, 7
s_add_u32 s3, s3, s51
s_lshl_b32 s6, s6, 13
s_add_u32 s6, s6, s3
s_lshl_b32 s7, s7, 13
s_add_u32 s7, s7, s3
s_lshl_b32 s29, s29, 13
s_add_u32 s29, s29, s3
s_mov_b64 s[96:97], 0
s_lshr_b32 s3, s6, 9
s_mul_i32 s90, s3, 6945
s_mov_b32 s91, s90
s_mul_i32 s90, s3, 6317
s_add_u32 s90, s90, 0x340674
s_cmp_lt_u32 s3, 5436
s_cselect_b32 s91, s91, s90
s_mul_i32 s90, s3, 6899
s_add_u32 s90, s90, 0xfffae6a0
s_cmp_lt_u32 s3, 6432
s_cselect_b32 s91, s91, s90
s_mul_i32 s90, s3, 6242
s_add_u32 s90, s90, 0x4484a0
s_cmp_lt_u32 s3, 7344
s_cselect_b32 s91, s91, s90
s_lshr_b32 s3, s91, 20
s_bitset1_b64 s[96:97], s3
s_lshr_b32 s3, s6, 9
s_add_u32 s3, s3, 15
s_mul_i32 s90, s3, 6945
s_mov_b32 s91, s90
s_mul_i32 s90, s3, 6317
s_add_u32 s90, s90, 0x340674
s_cmp_lt_u32 s3, 5436
s_cselect_b32 s91, s91, s90
s_mul_i32 s90, s3, 6899
s_add_u32 s90, s90, 0xfffae6a0
s_cmp_lt_u32 s3, 6432
s_cselect_b32 s91, s91, s90
s_mul_i32 s90, s3, 6242
s_add_u32 s90, s90, 0x4484a0
s_cmp_lt_u32 s3, 7344
s_cselect_b32 s91, s91, s90
s_lshr_b32 s3, s91, 20
s_bitset1_b64 s[96:97], s3
s_lshr_b32 s3, s7, 9
s_mul_i32 s90, s3, 6945
s_mov_b32 s91, s90
s_mul_i32 s90, s3, 6317
s_add_u32 s90, s90, 0x340674
s_cmp_lt_u32 s3, 5436
s_cselect_b32 s91, s91, s90
s_mul_i32 s90, s3, 6899
s_add_u32 s90, s90, 0xfffae6a0
s_cmp_lt_u32 s3, 6432
s_cselect_b32 s91, s91, s90
s_mul_i32 s90, s3, 6242
s_add_u32 s90, s90, 0x4484a0
s_cmp_lt_u32 s3, 7344
s_cselect_b32 s91, s91, s90
s_lshr_b32 s3, s91, 20
s_bitset1_b64 s[96:97], s3
s_lshr_b32 s3, s7, 9
s_add_u32 s3, s3, 15
s_mul_i32 s90, s3, 6945
s_mov_b32 s91, s90
s_mul_i32 s90, s3, 6317
s_add_u32 s90, s90, 0x340674
s_cmp_lt_u32 s3, 5436
s_cselect_b32 s91, s91, s90
s_mul_i32 s90, s3, 6899
s_add_u32 s90, s90, 0xfffae6a0
s_cmp_lt_u32 s3, 6432
s_cselect_b32 s91, s91, s90
s_mul_i32 s90, s3, 6242
s_add_u32 s90, s90, 0x4484a0
s_cmp_lt_u32 s3, 7344
s_cselect_b32 s91, s91, s90
s_lshr_b32 s3, s91, 20
s_bitset1_b64 s[96:97], s3
s_lshr_b32 s3, s29, 9
s_mul_i32 s90, s3, 6945
s_mov_b32 s91, s90
s_mul_i32 s90, s3, 6317
s_add_u32 s90, s90, 0x340674
s_cmp_lt_u32 s3, 5436
s_cselect_b32 s91, s91, s90
s_mul_i32 s90, s3, 6899
s_add_u32 s90, s90, 0xfffae6a0
s_cmp_lt_u32 s3, 6432
s_cselect_b32 s91, s91, s90
s_mul_i32 s90, s3, 6242
s_add_u32 s90, s90, 0x4484a0
s_cmp_lt_u32 s3, 7344
s_cselect_b32 s91, s91, s90
s_lshr_b32 s3, s91, 20
s_bitset1_b64 s[96:97], s3
s_lshr_b32 s3, s29, 9
s_add_u32 s3, s3, 15
s_mul_i32 s90, s3, 6945
s_mov_b32 s91, s90
s_mul_i32 s90, s3, 6317
s_add_u32 s90, s90, 0x340674
s_cmp_lt_u32 s3, 5436
s_cselect_b32 s91, s91, s90
s_mul_i32 s90, s3, 6899
s_add_u32 s90, s90, 0xfffae6a0
s_cmp_lt_u32 s3, 6432
s_cselect_b32 s91, s91, s90
s_mul_i32 s90, s3, 6242
s_add_u32 s90, s90, 0x4484a0
s_cmp_lt_u32 s3, 7344
s_cselect_b32 s91, s91, s90
s_lshr_b32 s3, s91, 20
s_bitset1_b64 s[96:97], s3
s_mul_i32 s3, s38, 6
s_add_u32 s3, s3, s37
s_cmp_eq_u32 s3, 233
s_cselect_b32 s3, 0, s37
s_cmp_lt_u32 s3, 4
s_cselect_b32 s29, s29, 0x70000000
s_lshl_b32 s51, s38, 5
s_lshl_b32 s3, s34, 3
s_add_u32 s51, s51, s3
s_add_u32 s51, s51, s37
s_mul_i32 s51, s51, 128
s_add_u32 s51, s51, 0x7c00000
s_lshr_b32 s40, s39, 17
s_min_u32 s40, s40, 38
s_lshr_b32 s41, s28, 17
s_add_u32 s3, s28, s101
s_lshr_b32 s3, s3, 17
v_mov_b32 v5, s38
v_mov_b32 v6, s40
v_cmp_lt_u32 vcc, 0x7f, v243
s_nop 1
v_cndmask_b32 v5, v5, v6, vcc
v_mov_b32 v6, s41
v_cmp_lt_u32 vcc, 0xff, v243
s_nop 1
v_cndmask_b32 v5, v5, v6, vcc
v_mov_b32 v6, s3
v_cmp_lt_u32 vcc, 0x17f, v243
s_nop 1
v_cndmask_b32 v5, v5, v6, vcc
v_bfe_u32 v6, v243, 4, 3
v_min_u32 v6, 5, v6
v_mad_u32_u24 v5, v5, 6, v6
v_lshlrev_b32 v5, 7, v5
v_add_u32 v5, 0x7c2a000, v5
s_mul_i32 s3, s101, 54
s_add_u32 s3, s3, s39
s_min_u32 s41, s3, s39
s_max_u32 s3, s3, s39
s_lshr_b32 s41, s41, 17
s_min_u32 s40, s40, s41
s_mul_i32 s40, s40, 6
s_lshr_b32 s3, s3, 17
s_min_u32 s3, s3, 38
s_mul_i32 s3, s3, 6
s_add_u32 s3, s3, 5
v_lshrrev_b32 v230, 4, v243
v_add_u32 v230, s40, v230
v_min_u32 v230, s3, v230
v_lshlrev_b32 v230, 7, v230
v_add_u32 v230, 0x7c2a000, v230
s_waitcnt lgkmcnt(0)
s_add_u32 s12, s4, 0x6800000
s_addc_u32 s13, s5, 0
s_mov_b32 s14, 0x0
s_mov_b32 s15, 0x00020000
s_mov_b32 s14, s49
s_add_u32 s8, s4, 0x0
s_addc_u32 s9, s5, 0
s_mov_b32 s10, 0x4e4000
s_mov_b32 s11, 0x00020000
s_mul_i32 s35, s37, 0x600000
s_add_u32 s20, s4, 0x2000000
s_addc_u32 s21, s5, 0
s_add_u32 s20, s20, s35
s_addc_u32 s21, s21, 0
s_mov_b32 s22, 0x4e4000
s_mov_b32 s23, 0x00020000
s_add_u32 s24, s4, 0x6000000
s_addc_u32 s25, s5, 0
s_mov_b32 s26, 0x139000
s_mov_b32 s27, 0x00020000
s_lshl_b32 s35, s38, 4
s_lshl_b32 s41, s34, 2
s_add_u32 s35, s35, s41
s_lshl_b32 s40, s35, 13
s_lshl_b32 s94, s94, 13
s_add_u32 s40, s40, s94
s_xor_b32 s41, s40, 8192
s_xor_b32 s42, s40, 16384
s_xor_b32 s43, s40, 24576
s_add_u32 s44, s40, 4096
s_add_u32 s45, s41, 4096
s_add_u32 s46, s42, 4096
s_add_u32 s47, s43, 4096
s_lshl_b32 s48, s35, 10
s_lshl_b32 s35, s37, 3
s_add_u32 s48, s48, s35
v_mov_b32 v232, 0
v_mov_b32 v233, 0
v_mov_b32 v234, 0
v_mov_b32 v235, 0
v_bfe_u32 v240, v243, 4, 3
v_lshlrev_b32 v240, 6, v240
v_bfe_u32 v242, v243, 7, 1
v_lshl_or_b32 v240, v242, 10, v240
v_bfe_u32 v242, v243, 8, 2
v_lshl_or_b32 v240, v242, 4, v240
v_bfe_u32 v242, v243, 6, 1
v_lshlrev_b32 v242, 5, v242
v_xor_b32 v240, v240, v242
v_and_b32 v246, 0x1c0, v243
v_bfe_u32 v242, v243, 9, 1
v_lshl_or_b32 v246, v242, 10, v246
v_bfe_u32 v242, v243, 8, 1
v_lshl_or_b32 v246, v242, 5, v246
v_bfe_u32 v242, v243, 4, 2
v_lshl_or_b32 v246, v242, 3, v246
v_xor_b32 v247, 32, v246
v_bfe_i32 v242, v243, 8, 1
v_and_b32 v192, s33, v242
v_and_b32 v193, s33, v242
v_and_b32 v194, s33, v242
v_and_b32 v195, s33, v242
v_mfma_f32_32x32x16_bf16 a[0:15], v[232:235], v[232:235], 0
v_mfma_f32_32x32x16_bf16 a[16:31], v[232:235], v[232:235], 0
v_mfma_f32_32x32x16_bf16 a[32:47], v[232:235], v[232:235], 0
v_mfma_f32_32x32x16_bf16 a[48:63], v[232:235], v[232:235], 0
v_mfma_f32_32x32x16_bf16 a[64:79], v[232:235], v[232:235], 0
v_mfma_f32_32x32x16_bf16 a[80:95], v[232:235], v[232:235], 0
v_mfma_f32_32x32x16_bf16 a[96:111], v[232:235], v[232:235], 0
v_mfma_f32_32x32x16_bf16 a[112:127], v[232:235], v[232:235], 0
v_mfma_f32_32x32x16_bf16 a[128:143], v[232:235], v[232:235], 0
v_mfma_f32_32x32x16_bf16 a[144:159], v[232:235], v[232:235], 0
v_mfma_f32_32x32x16_bf16 a[160:175], v[232:235], v[232:235], 0
v_mfma_f32_32x32x16_bf16 a[176:191], v[232:235], v[232:235], 0
v_mfma_f32_32x32x16_bf16 a[192:207], v[232:235], v[232:235], 0
v_mfma_f32_32x32x16_bf16 a[208:223], v[232:235], v[232:235], 0
v_mfma_f32_32x32x16_bf16 a[224:239], v[232:235], v[232:235], 0
v_mfma_f32_32x32x16_bf16 a[240:255], v[232:235], v[232:235], 0
s_add_u32 s16, s4, 0x0
s_addc_u32 s17, s5, 0
s_mov_b32 s18, 0x10000000
s_mov_b32 s19, 0x00020000
s_mov_b32 s3, 0x10000
LM_pa:
buffer_load_dwordx2 v[6:7], v5, s[16:19], 0 offen sc1
s_sub_u32 s3, s3, 1
s_waitcnt vmcnt(0)
s_cbranch_scc1 LM_pa_go
v_cmp_ne_u64 vcc, s[98:99], v[6:7]
s_nop 1
s_cbranch_vccnz LM_pa
LM_pa_go:
buffer_load_dwordx4 v241, s[12:15], s39 offen offset:0 sc1 lds
buffer_load_dwordx4 v241, s[12:15], s39 offen offset:1024 sc1 lds
buffer_load_dwordx4 v241, s[12:15], s39 offen offset:2048 sc1 lds
buffer_load_dwordx4 v241, s[12:15], s39 offen offset:3072 sc1 lds
s_add_u32 m0, s30, 0x4000
s_nop 0
buffer_load_dwordx4 v241, s[12:15], s28 offen offset:0 sc1 lds
buffer_load_dwordx4 v241, s[12:15], s28 offen offset:1024 sc1 lds
buffer_load_dwordx4 v[0:3], v243, s[8:11], s44 offen offset:3072 sc1
buffer_load_dwordx4 v[32:35], v243, s[8:11], s45 offen offset:3072 sc1
buffer_load_dwordx4 v[64:67], v243, s[8:11], s46 offen offset:3072 sc1
buffer_load_dwordx4 v[96:99], v243, s[8:11], s47 offen offset:3072 sc1
buffer_load_dwordx4 v[4:7], v243, s[8:11], s44 offen offset:2048 sc1
buffer_load_dwordx4 v[36:39], v243, s[8:11], s45 offen offset:2048 sc1
buffer_load_dwordx4 v[68:71], v243, s[8:11], s46 offen offset:2048 sc1
buffer_load_dwordx4 v[100:103], v243, s[8:11], s47 offen offset:2048 sc1
buffer_load_dwordx4 v[8:11], v243, s[8:11], s40 offen offset:0 sc1
buffer_load_dwordx4 v[40:43], v243, s[8:11], s41 offen offset:0 sc1
buffer_load_dwordx4 v[72:75], v243, s[8:11], s42 offen offset:0 sc1
buffer_load_dwordx4 v[104:107], v243, s[8:11], s43 offen offset:0 sc1
buffer_load_dwordx4 v[12:15], v243, s[8:11], s40 offen offset:1024 sc1
buffer_load_dwordx4 v[44:47], v243, s[8:11], s41 offen offset:1024 sc1
buffer_load_dwordx4 v[76:79], v243, s[8:11], s42 offen offset:1024 sc1
buffer_load_dwordx4 v[108:111], v243, s[8:11], s43 offen offset:1024 sc1
buffer_load_dwordx4 v[16:19], v243, s[8:11], s40 offen offset:2048 sc1
buffer_load_dwordx4 v[48:51], v243, s[8:11], s41 offen offset:2048 sc1
buffer_load_dwordx4 v[80:83], v243, s[8:11], s42 offen offset:2048 sc1
buffer_load_dwordx4 v[112:115], v243, s[8:11], s43 offen offset:2048 sc1
buffer_load_dwordx2 v[228:229], v230, s[16:19], 0 offen sc1
s_waitcnt vmcnt(21)
s_barrier
ds_read_b128 v[208:211], v240 offset:12800
ds_read_b128 v[212:215], v240 offset:14848
ds_read_b128 v[216:219], v240 offset:29184
ds_read_b128 v[220:223], v240 offset:12288
s_waitcnt lgkmcnt(3)
s_waitcnt vmcnt(17)
v_mfma_f32_16x16x32_bf16 v[128:131], v[208:211], v[0:3], v[192:195]
buffer_load_dwordx4 v[20:23], v243, s[8:11], s40 offen offset:3072 sc1
v_mfma_f32_16x16x32_bf16 v[132:135], v[208:211], v[32:35], v[192:195]
v_mfma_f32_16x16x32_bf16 v[136:139], v[208:211], v[64:67], v[192:195]
v_mfma_f32_16x16x32_bf16 v[140:143], v[208:211], v[96:99], v[192:195]
ds_read_b128 v[208:211], v240 offset:14336
s_waitcnt lgkmcnt(3)
buffer_load_dwordx4 v[52:55], v243, s[8:11], s41 offen offset:3072 sc1
v_mfma_f32_16x16x32_bf16 v[144:147], v[212:215], v[0:3], v[192:195]
v_mfma_f32_16x16x32_bf16 v[148:151], v[212:215], v[32:35], v[192:195]
v_mfma_f32_16x16x32_bf16 v[152:155], v[212:215], v[64:67], v[192:195]
buffer_load_dwordx4 v[84:87], v243, s[8:11], s42 offen offset:3072 sc1
v_mfma_f32_16x16x32_bf16 v[156:159], v[212:215], v[96:99], v[192:195]
ds_read_b128 v[212:215], v240 offset:28672
s_waitcnt lgkmcnt(3)
v_mfma_f32_16x16x32_bf16 v[176:179], v[216:219], v[0:3], 0
v_mfma_f32_16x16x32_bf16 v[180:183], v[216:219], v[32:35], 0
buffer_load_dwordx4 v[116:119], v243, s[8:11], s43 offen offset:3072 sc1
v_mfma_f32_16x16x32_bf16 v[184:187], v[216:219], v[64:67], 0
v_mfma_f32_16x16x32_bf16 v[188:191], v[216:219], v[96:99], 0
ds_read_b128 v[216:219], v240 offset:0
s_waitcnt lgkmcnt(3)
s_waitcnt vmcnt(17)
v_mfma_f32_16x16x32_bf16 v[128:131], v[220:223], v[4:7], v[128:131]
buffer_load_dwordx4 v[24:27], v243, s[8:11], s44 offen offset:0 sc1
v_mfma_f32_16x16x32_bf16 v[132:135], v[220:223], v[36:39], v[132:135]
v_mfma_f32_16x16x32_bf16 v[136:139], v[220:223], v[68:71], v[136:139]
v_mfma_f32_16x16x32_bf16 v[140:143], v[220:223], v[100:103], v[140:143]
ds_read_b128 v[220:223], v240 offset:2048
s_waitcnt lgkmcnt(3)
buffer_load_dwordx4 v[56:59], v243, s[8:11], s45 offen offset:0 sc1
v_mfma_f32_16x16x32_bf16 v[144:147], v[208:211], v[4:7], v[144:147]
v_mfma_f32_16x16x32_bf16 v[148:151], v[208:211], v[36:39], v[148:151]
v_mfma_f32_16x16x32_bf16 v[152:155], v[208:211], v[68:71], v[152:155]
buffer_load_dwordx4 v[88:91], v243, s[8:11], s46 offen offset:0 sc1
v_mfma_f32_16x16x32_bf16 v[156:159], v[208:211], v[100:103], v[156:159]
ds_read_b128 v[208:211], v240 offset:16384
s_waitcnt lgkmcnt(3)
v_mfma_f32_16x16x32_bf16 v[176:179], v[212:215], v[4:7], v[176:179]
v_mfma_f32_16x16x32_bf16 v[180:183], v[212:215], v[36:39], v[180:183]
buffer_load_dwordx4 v[120:123], v243, s[8:11], s47 offen offset:0 sc1
v_mfma_f32_16x16x32_bf16 v[184:187], v[212:215], v[68:71], v[184:187]
v_mfma_f32_16x16x32_bf16 v[188:191], v[212:215], v[100:103], v[188:191]
ds_read_b128 v[212:215], v240 offset:512
s_waitcnt lgkmcnt(3)
s_waitcnt vmcnt(17)
v_mfma_f32_16x16x32_bf16 v[128:131], v[216:219], v[8:11], v[128:131]
buffer_load_dwordx4 v[28:31], v243, s[8:11], s44 offen offset:1024 sc1
v_mfma_f32_16x16x32_bf16 v[132:135], v[216:219], v[40:43], v[132:135]
v_mfma_f32_16x16x32_bf16 v[136:139], v[216:219], v[72:75], v[136:139]
v_mfma_f32_16x16x32_bf16 v[140:143], v[216:219], v[104:107], v[140:143]
ds_read_b128 v[216:219], v240 offset:2560
s_waitcnt lgkmcnt(3)
buffer_load_dwordx4 v[60:63], v243, s[8:11], s45 offen offset:1024 sc1
v_mfma_f32_16x16x32_bf16 v[144:147], v[220:223], v[8:11], v[144:147]
v_mfma_f32_16x16x32_bf16 v[148:151], v[220:223], v[40:43], v[148:151]
v_mfma_f32_16x16x32_bf16 v[152:155], v[220:223], v[72:75], v[152:155]
buffer_load_dwordx4 v[92:95], v243, s[8:11], s46 offen offset:1024 sc1
v_mfma_f32_16x16x32_bf16 v[156:159], v[220:223], v[104:107], v[156:159]
ds_read_b128 v[220:223], v240 offset:16896
s_waitcnt lgkmcnt(3)
v_mfma_f32_16x16x32_bf16 v[176:179], v[208:211], v[8:11], v[176:179]
v_mfma_f32_16x16x32_bf16 v[180:183], v[208:211], v[40:43], v[180:183]
buffer_load_dwordx4 v[124:127], v243, s[8:11], s47 offen offset:1024 sc1
v_mfma_f32_16x16x32_bf16 v[184:187], v[208:211], v[72:75], v[184:187]
v_mfma_f32_16x16x32_bf16 v[188:191], v[208:211], v[104:107], v[188:191]
ds_read_b128 v[208:211], v240 offset:4096
s_waitcnt lgkmcnt(3)
s_waitcnt vmcnt(17)
v_mfma_f32_16x16x32_bf16 v[128:131], v[212:215], v[12:15], v[128:131]
s_add_u32 s16, s4, 0x0
s_addc_u32 s17, s5, 0
s_mov_b32 s18, 0x10000000
v_mfma_f32_16x16x32_bf16 v[132:135], v[212:215], v[44:47], v[132:135]
buffer_load_dwordx4 v241, s[12:15], s28 offen offset:2048 sc1 lds
s_mov_b32 s19, 0x00020000
s_add_u32 s8, s60, 0x0
v_mfma_f32_16x16x32_bf16 v[136:139], v[212:215], v[76:79], v[136:139]
s_addc_u32 s9, s61, 0
s_mov_b32 s10, 0x4e2000
s_mov_b32 s11, 0x00020000
v_mfma_f32_16x16x32_bf16 v[140:143], v[212:215], v[108:111], v[140:143]
ds_read_b128 v[212:215], v240 offset:6144
s_waitcnt lgkmcnt(3)
buffer_load_dwordx4 v241, s[12:15], s28 offen offset:3072 sc1 lds
v_mfma_f32_16x16x32_bf16 v[144:147], v[216:219], v[12:15], v[144:147]
s_mov_b32 s54, 0x4e20
s_mov_b32 s55, 0x00020000
s_mov_b32 s58, 0x4e2000
v_mfma_f32_16x16x32_bf16 v[148:151], v[216:219], v[44:47], v[148:151]
s_mov_b32 s59, 0x00020000
s_lshr_b32 s48, s40, 2
s_cmp_eq_u32 s95, 1
v_mfma_f32_16x16x32_bf16 v[152:155], v[216:219], v[76:79], v[152:155]
s_cselect_b32 s40, 0x70000000, s40
s_cselect_b32 s44, 0x70000000, s44
s_cmp_lt_u32 s37, 3
v_mfma_f32_16x16x32_bf16 v[156:159], v[216:219], v[108:111], v[156:159]
ds_read_b128 v[216:219], v240 offset:20480
s_waitcnt lgkmcnt(3)
s_cselect_b32 s3, 0, 3
v_mfma_f32_16x16x32_bf16 v[176:179], v[220:223], v[12:15], v[176:179]
s_cselect_b32 s94, 0, 8
s_sub_u32 s3, s37, s3
s_lshl_b32 s38, s38, 2
v_mfma_f32_16x16x32_bf16 v[180:183], v[220:223], v[44:47], v[180:183]
s_add_u32 s38, s38, s3
s_lshl_b32 s38, s38, 10
s_add_u32 s38, s38, 0x7c00300
v_mfma_f32_16x16x32_bf16 v[184:187], v[220:223], v[76:79], v[184:187]
s_add_u32 s94, s94, s38
s_xor_b32 s95, s94, 8
s_add_u32 s49, s95, 32
v_mfma_f32_16x16x32_bf16 v[188:191], v[220:223], v[108:111], v[188:191]
ds_read_b128 v[220:223], v240 offset:4608
s_waitcnt lgkmcnt(3)
s_waitcnt vmcnt(15)
v_mfma_f32_16x16x32_bf16 v[128:131], v[208:211], v[16:19], v[128:131]
s_cmp_eq_u32 s3, 2
s_cselect_b32 s35, s38, s94
s_cselect_b32 s49, s49, s95
v_mfma_f32_16x16x32_bf16 v[132:135], v[208:211], v[48:51], v[132:135]
s_add_u32 s28, s28, s101
s_add_u32 m0, s30, 0x8000
s_nop 0
s_mov_b32 s39, 4
v_mfma_f32_16x16x32_bf16 v[136:139], v[208:211], v[80:83], v[136:139]
v_mfma_f32_16x16x32_bf16 v[140:143], v[208:211], v[112:115], v[140:143]
ds_read_b128 v[208:211], v240 offset:6656
s_waitcnt lgkmcnt(3)
buffer_load_dwordx4 v241, s[12:15], s28 offen offset:0 sc1 lds
v_mfma_f32_16x16x32_bf16 v[144:147], v[212:215], v[16:19], v[144:147]
v_mfma_f32_16x16x32_bf16 v[148:151], v[212:215], v[48:51], v[148:151]
buffer_load_dwordx4 v241, s[12:15], s28 offen offset:1024 sc1 lds
v_mfma_f32_16x16x32_bf16 v[152:155], v[212:215], v[80:83], v[152:155]
v_mfma_f32_16x16x32_bf16 v[156:159], v[212:215], v[112:115], v[156:159]
ds_read_b128 v[212:215], v240 offset:20992
s_waitcnt lgkmcnt(3)
v_mfma_f32_16x16x32_bf16 v[176:179], v[216:219], v[16:19], v[176:179]
v_mfma_f32_16x16x32_bf16 v[180:183], v[216:219], v[48:51], v[180:183]
v_mfma_f32_16x16x32_bf16 v[184:187], v[216:219], v[80:83], v[184:187]
v_mfma_f32_16x16x32_bf16 v[188:191], v[216:219], v[112:115], v[188:191]
ds_read_b128 v[216:219], v240 offset:8192
s_waitcnt lgkmcnt(3)
s_waitcnt vmcnt(12)
v_mfma_f32_16x16x32_bf16 v[128:131], v[220:223], v[20:23], v[128:131]
v_mfma_f32_16x16x32_bf16 v[132:135], v[220:223], v[52:55], v[132:135]
buffer_load_dwordx4 v241, s[12:15], s28 offen offset:2048 sc1 lds
v_mfma_f32_16x16x32_bf16 v[136:139], v[220:223], v[84:87], v[136:139]
v_mfma_f32_16x16x32_bf16 v[140:143], v[220:223], v[116:119], v[140:143]
ds_read_b128 v[220:223], v240 offset:10240
s_waitcnt lgkmcnt(3)
buffer_load_dwordx4 v241, s[12:15], s28 offen offset:3072 sc1 lds
v_mfma_f32_16x16x32_bf16 v[144:147], v[208:211], v[20:23], v[144:147]
v_mfma_f32_16x16x32_bf16 v[148:151], v[208:211], v[52:55], v[148:151]
v_mfma_f32_16x16x32_bf16 v[152:155], v[208:211], v[84:87], v[152:155]
v_mfma_f32_16x16x32_bf16 v[156:159], v[208:211], v[116:119], v[156:159]
ds_read_b128 v[208:211], v240 offset:24576
s_waitcnt lgkmcnt(3)
v_mfma_f32_16x16x32_bf16 v[176:179], v[212:215], v[20:23], v[176:179]
v_mfma_f32_16x16x32_bf16 v[180:183], v[212:215], v[52:55], v[180:183]
v_mfma_f32_16x16x32_bf16 v[184:187], v[212:215], v[84:87], v[184:187]
v_mfma_f32_16x16x32_bf16 v[188:191], v[212:215], v[116:119], v[188:191]
ds_read_b128 v[212:215], v240 offset:8704
s_waitcnt lgkmcnt(3)
s_waitcnt vmcnt(10)
v_mfma_f32_16x16x32_bf16 v[128:131], v[216:219], v[24:27], v[128:131]
v_mfma_f32_16x16x32_bf16 v[132:135], v[216:219], v[56:59], v[132:135]
s_add_u32 s28, s28, s101
s_add_u32 s30, s30, 0xc000
v_mfma_f32_16x16x32_bf16 v[136:139], v[216:219], v[88:91], v[136:139]
v_mfma_f32_16x16x32_bf16 v[140:143], v[216:219], v[120:123], v[140:143]
ds_read_b128 v[216:219], v240 offset:10752
s_waitcnt lgkmcnt(3)
v_mfma_f32_16x16x32_bf16 v[144:147], v[220:223], v[24:27], v[144:147]
v_mfma_f32_16x16x32_bf16 v[148:151], v[220:223], v[56:59], v[148:151]
v_mfma_f32_16x16x32_bf16 v[152:155], v[220:223], v[88:91], v[152:155]
v_mfma_f32_16x16x32_bf16 v[156:159], v[220:223], v[120:123], v[156:159]
ds_read_b128 v[220:223], v240 offset:25088
s_waitcnt lgkmcnt(3)
v_mfma_f32_16x16x32_bf16 v[176:179], v[208:211], v[24:27], v[176:179]
v_mfma_f32_16x16x32_bf16 v[180:183], v[208:211], v[56:59], v[180:183]
v_mfma_f32_16x16x32_bf16 v[184:187], v[208:211], v[88:91], v[184:187]
v_mfma_f32_16x16x32_bf16 v[188:191], v[208:211], v[120:123], v[188:191]
s_waitcnt lgkmcnt(2)
s_waitcnt vmcnt(6)
v_mfma_f32_16x16x32_bf16 v[128:131], v[212:215], v[28:31], v[128:131]
v_mfma_f32_16x16x32_bf16 v[132:135], v[212:215], v[60:63], v[132:135]
v_mfma_f32_16x16x32_bf16 v[136:139], v[212:215], v[92:95], v[136:139]
v_mfma_f32_16x16x32_bf16 v[140:143], v[212:215], v[124:127], v[140:143]
s_waitcnt lgkmcnt(1)
v_mfma_f32_16x16x32_bf16 v[144:147], v[216:219], v[28:31], v[144:147]
v_mfma_f32_16x16x32_bf16 v[148:151], v[216:219], v[60:63], v[148:151]
v_mfma_f32_16x16x32_bf16 v[152:155], v[216:219], v[92:95], v[152:155]
v_mfma_f32_16x16x32_bf16 v[156:159], v[216:219], v[124:127], v[156:159]
s_waitcnt lgkmcnt(0)
v_mfma_f32_16x16x32_bf16 v[176:179], v[220:223], v[28:31], v[176:179]
v_mfma_f32_16x16x32_bf16 v[180:183], v[220:223], v[60:63], v[180:183]
v_mfma_f32_16x16x32_bf16 v[184:187], v[220:223], v[92:95], v[184:187]
v_mfma_f32_16x16x32_bf16 v[188:191], v[220:223], v[124:127], v[188:191]
v_max3_f32 v248, v128, v129, v130
v_max3_f32 v249, v132, v133, v134
v_max3_f32 v250, v136, v137, v138
v_max3_f32 v251, v140, v141, v142
v_max3_f32 v248, v248, v131, v144
v_max3_f32 v249, v249, v135, v148
v_max3_f32 v250, v250, v139, v152
v_max3_f32 v251, v251, v143, v156
v_max3_f32 v248, v248, v145, v146
v_max3_f32 v249, v249, v149, v150
v_max3_f32 v250, v250, v153, v154
v_max3_f32 v251, v251, v157, v158
v_max_f32 v248, v248, v147
v_max_f32 v249, v249, v151
v_max_f32 v250, v250, v155
v_max_f32 v251, v251, v159
v_mov_b32 v232, v248
v_mov_b32 v233, v249
v_mov_b32 v234, v250
v_mov_b32 v235, v251
v_permlane32_swap_b32 v248, v232
v_permlane32_swap_b32 v249, v233
v_permlane32_swap_b32 v250, v234
v_permlane32_swap_b32 v251, v235
v_max_f32 v248, v248, v232
v_max_f32 v249, v249, v233
v_max_f32 v250, v250, v234
v_max_f32 v251, v251, v235
v_mov_b32 v232, v248
v_mov_b32 v233, v249
v_mov_b32 v234, v250
v_mov_b32 v235, v251
v_permlane16_swap_b32 v248, v232
v_permlane16_swap_b32 v249, v233
v_permlane16_swap_b32 v250, v234
v_permlane16_swap_b32 v251, v235
v_max_f32 v248, v248, v232
v_max_f32 v249, v249, v233
v_max_f32 v250, v250, v234
v_max_f32 v251, v251, v235
v_ceil_f32 v248, v248
v_ceil_f32 v249, v249
v_ceil_f32 v250, v250
v_ceil_f32 v251, v251
v_add_f32 v248, 40.0, v248
v_add_f32 v249, 40.0, v249
v_add_f32 v250, 40.0, v250
v_add_f32 v251, 40.0, v251
v_cvt_pk_bf16_f32 v248, v248, v248
v_cvt_pk_bf16_f32 v249, v249, v249
v_cvt_pk_bf16_f32 v250, v250, v250
v_cvt_pk_bf16_f32 v251, v251, v251
v_and_b32 v248, 0xffff0000, v248
v_and_b32 v249, 0xffff0000, v249
v_and_b32 v250, 0xffff0000, v250
v_and_b32 v251, 0xffff0000, v251
v_bfe_i32 v242, v243, 8, 1
v_bfe_i32 v232, v243, 9, 1
v_and_b32 v242, v242, v232
v_and_b32 v242, 0xffff0000, v242
v_sub_f32 v224, 0, v248
v_sub_f32 v225, 0, v249
v_sub_f32 v226, 0, v250
v_sub_f32 v227, 0, v251
v_bfi_b32 v3, v242, v224, v3
v_bfi_b32 v35, v242, v225, v35
v_bfi_b32 v67, v242, v226, v67
v_bfi_b32 v99, v242, v227, v99
v_sub_f32 v128, v128, v248
v_sub_f32 v129, v129, v248
v_sub_f32 v130, v130, v248
v_sub_f32 v131, v131, v248
v_exp_f32 v128, v128
v_exp_f32 v129, v129
v_exp_f32 v130, v130
v_exp_f32 v131, v131
v_sub_f32 v132, v132, v249
v_sub_f32 v133, v133, v249
v_sub_f32 v134, v134, v249
v_sub_f32 v135, v135, v249
v_exp_f32 v132, v132
v_exp_f32 v133, v133
v_exp_f32 v134, v134
v_exp_f32 v135, v135
v_sub_f32 v136, v136, v250
v_sub_f32 v137, v137, v250
v_sub_f32 v138, v138, v250
v_sub_f32 v139, v139, v250
v_exp_f32 v136, v136
v_exp_f32 v137, v137
v_exp_f32 v138, v138
v_exp_f32 v139, v139
v_sub_f32 v140, v140, v251
v_sub_f32 v141, v141, v251
v_sub_f32 v142, v142, v251
v_sub_f32 v143, v143, v251
v_exp_f32 v140, v140
v_exp_f32 v141, v141
v_exp_f32 v142, v142
v_exp_f32 v143, v143
s_waitcnt vmcnt(4)
s_barrier
ds_read_b128 v[208:211], v240 offset:31232
ds_read_b128 v[212:215], v240 offset:30720
ds_read_b128 v[216:219], v240 offset:18432
ds_read_b128 v[220:223], v240 offset:18944
v_add_f32 v144, v144, v224
v_add_f32 v145, v145, v224
v_add_f32 v146, v146, v224
v_add_f32 v147, v147, v224
v_exp_f32 v144, v144
v_exp_f32 v145, v145
v_exp_f32 v146, v146
v_exp_f32 v147, v147
v_add_f32 v148, v148, v225
v_add_f32 v149, v149, v225
v_add_f32 v150, v150, v225
v_add_f32 v151, v151, v225
v_exp_f32 v148, v148
v_exp_f32 v149, v149
v_exp_f32 v150, v150
v_exp_f32 v151, v151
v_add_f32 v152, v152, v226
v_add_f32 v153, v153, v226
v_add_f32 v154, v154, v226
v_add_f32 v155, v155, v226
v_exp_f32 v152, v152
v_exp_f32 v153, v153
v_exp_f32 v154, v154
v_exp_f32 v155, v155
v_add_f32 v156, v156, v227
v_add_f32 v157, v157, v227
v_add_f32 v158, v158, v227
v_add_f32 v159, v159, v227
v_exp_f32 v156, v156
v_exp_f32 v157, v157
v_exp_f32 v158, v158
v_exp_f32 v159, v159
v_cvt_pk_bf16_f32 v160, v128, v129
v_cvt_pk_bf16_f32 v161, v130, v131
v_cvt_pk_bf16_f32 v164, v132, v133
v_cvt_pk_bf16_f32 v165, v134, v135
v_cvt_pk_bf16_f32 v168, v136, v137
v_cvt_pk_bf16_f32 v169, v138, v139
v_cvt_pk_bf16_f32 v172, v140, v141
v_cvt_pk_bf16_f32 v173, v142, v143
v_cvt_pk_bf16_f32 v162, v144, v145
v_cvt_pk_bf16_f32 v163, v146, v147
v_cvt_pk_bf16_f32 v166, v148, v149
v_cvt_pk_bf16_f32 v167, v150, v151
v_cvt_pk_bf16_f32 v170, v152, v153
v_cvt_pk_bf16_f32 v171, v154, v155
v_cvt_pk_bf16_f32 v174, v156, v157
v_cvt_pk_bf16_f32 v175, v158, v159
v_add_f32 v128, v176, v224
v_add_f32 v129, v177, v224
v_add_f32 v130, v178, v224
v_add_f32 v131, v179, v224
v_add_f32 v132, v180, v225
v_add_f32 v133, v181, v225
v_add_f32 v134, v182, v225
v_add_f32 v135, v183, v225
v_add_f32 v136, v184, v226
v_add_f32 v137, v185, v226
v_add_f32 v138, v186, v226
v_add_f32 v139, v187, v226
v_add_f32 v140, v188, v227
v_add_f32 v141, v189, v227
v_add_f32 v142, v190, v227
v_add_f32 v143, v191, v227
v_cmp_ne_u64 vcc, s[98:99], v[228:229]
s_nop 1
s_cbranch_vccnz LM_pb
LM_pb_ret:
s_nop 1
s_waitcnt lgkmcnt(2)
L2_ret5:
v_mfma_f32_16x16x32_bf16 v[144:147], v[208:211], v[0:3], 0
v_mfma_f32_16x16x32_bf16 v[144:147], v[212:215], v[4:7], v[144:147]
v_mfma_f32_16x16x32_bf16 v[148:151], v[208:211], v[32:35], 0
v_mfma_f32_16x16x32_bf16 v[148:151], v[212:215], v[36:39], v[148:151]
v_mfma_f32_16x16x32_bf16 v[152:155], v[208:211], v[64:67], 0
v_exp_f32 v128, v128
v_mfma_f32_16x16x32_bf16 v[152:155], v[212:215], v[68:71], v[152:155]
v_exp_f32 v129, v129
v_mfma_f32_16x16x32_bf16 v[156:159], v[208:211], v[96:99], 0
ds_read_b128 v[208:211], v240 offset:22528
v_mfma_f32_16x16x32_bf16 v[156:159], v[212:215], v[100:103], v[156:159]
ds_read_b128 v[212:215], v240 offset:23040
s_waitcnt lgkmcnt(2)
v_mfma_f32_16x16x32_bf16 v[144:147], v[216:219], v[8:11], v[144:147]
v_exp_f32 v130, v130
v_mfma_f32_16x16x32_bf16 v[144:147], v[220:223], v[12:15], v[144:147]
v_exp_f32 v131, v131
v_mfma_f32_16x16x32_bf16 v[148:151], v[216:219], v[40:43], v[148:151]
v_exp_f32 v132, v132
v_mfma_f32_16x16x32_bf16 v[148:151], v[220:223], v[44:47], v[148:151]
v_exp_f32 v133, v133
v_mfma_f32_16x16x32_bf16 v[152:155], v[216:219], v[72:75], v[152:155]
v_exp_f32 v134, v134
v_mfma_f32_16x16x32_bf16 v[152:155], v[220:223], v[76:79], v[152:155]
v_exp_f32 v135, v135
v_mfma_f32_16x16x32_bf16 v[156:159], v[216:219], v[104:107], v[156:159]
ds_read_b128 v[216:219], v240 offset:26624
v_mfma_f32_16x16x32_bf16 v[156:159], v[220:223], v[108:111], v[156:159]
ds_read_b128 v[220:223], v240 offset:27136
s_waitcnt lgkmcnt(2)
v_mfma_f32_16x16x32_bf16 v[144:147], v[208:211], v[16:19], v[144:147]
v_exp_f32 v136, v136
v_mfma_f32_16x16x32_bf16 v[144:147], v[212:215], v[20:23], v[144:147]
v_add_u32 v240, 0x8000, v240
v_mfma_f32_16x16x32_bf16 v[148:151], v[208:211], v[48:51], v[148:151]
v_and_b32 v240, 0x1ffff, v240
v_mfma_f32_16x16x32_bf16 v[148:151], v[212:215], v[52:55], v[148:151]
v_exp_f32 v137, v137
v_mfma_f32_16x16x32_bf16 v[152:155], v[208:211], v[80:83], v[152:155]
v_exp_f32 v138, v138
v_mfma_f32_16x16x32_bf16 v[152:155], v[212:215], v[84:87], v[152:155]
v_exp_f32 v139, v139
v_mfma_f32_16x16x32_bf16 v[156:159], v[208:211], v[112:115], v[156:159]
ds_read_b64_tr_b16 v[208:209], v246 offset:0
ds_read_b64_tr_b16 v[210:211], v246 offset:2048
v_mfma_f32_16x16x32_bf16 v[156:159], v[212:215], v[116:119], v[156:159]
ds_read_b64_tr_b16 v[212:213], v247 offset:0
s_waitcnt lgkmcnt(3)
v_mfma_f32_16x16x32_bf16 v[144:147], v[216:219], v[24:27], v[144:147]
ds_read_b64_tr_b16 v[214:215], v247 offset:2048
v_mfma_f32_16x16x32_bf16 v[144:147], v[220:223], v[28:31], v[144:147]
v_exp_f32 v140, v140
v_mfma_f32_16x16x32_bf16 v[148:151], v[216:219], v[56:59], v[148:151]
v_exp_f32 v141, v141
v_mfma_f32_16x16x32_bf16 v[148:151], v[220:223], v[60:63], v[148:151]
v_exp_f32 v142, v142
v_mfma_f32_16x16x32_bf16 v[152:155], v[216:219], v[88:91], v[152:155]
v_exp_f32 v143, v143
v_mfma_f32_16x16x32_bf16 v[152:155], v[220:223], v[92:95], v[152:155]
v_mfma_f32_16x16x32_bf16 v[156:159], v[216:219], v[120:123], v[156:159]
ds_read_b64_tr_b16 v[216:217], v246 offset:512
ds_read_b64_tr_b16 v[218:219], v246 offset:2560
v_mfma_f32_16x16x32_bf16 v[156:159], v[220:223], v[124:127], v[156:159]
ds_read_b64_tr_b16 v[220:221], v247 offset:512
s_waitcnt lgkmcnt(5)
v_mfma_f32_16x16x32_bf16 a[0:3], v[160:163], v[208:211], a[0:3]
ds_read_b64_tr_b16 v[222:223], v247 offset:2560
v_mfma_f32_16x16x32_bf16 a[4:7], v[164:167], v[208:211], a[4:7]
s_mov_b32 m0, s30
v_mfma_f32_16x16x32_bf16 a[8:11], v[168:171], v[208:211], a[8:11]
buffer_load_dwordx4 v241, s[12:15], s28 offen offset:0 sc1 lds
v_mfma_f32_16x16x32_bf16 a[12:15], v[172:175], v[208:211], a[12:15]
ds_read_b64_tr_b16 v[208:209], v246 offset:4096
s_waitcnt lgkmcnt(5)
v_mfma_f32_16x16x32_bf16 a[16:19], v[160:163], v[212:215], a[16:19]
ds_read_b64_tr_b16 v[210:211], v246 offset:6144
buffer_load_dwordx4 v241, s[12:15], s28 offen offset:1024 sc1 lds
v_mfma_f32_16x16x32_bf16 a[20:23], v[164:167], v[212:215], a[20:23]
v_mfma_f32_16x16x32_bf16 a[24:27], v[168:171], v[212:215], a[24:27]
buffer_load_dwordx4 v241, s[12:15], s28 offen offset:2048 sc1 lds
v_mfma_f32_16x16x32_bf16 a[28:31], v[172:175], v[212:215], a[28:31]
ds_read_b64_tr_b16 v[212:213], v247 offset:4096
s_waitcnt lgkmcnt(5)
v_mfma_f32_16x16x32_bf16 a[32:35], v[160:163], v[216:219], a[32:35]
ds_read_b64_tr_b16 v[214:215], v247 offset:6144
v_mfma_f32_16x16x32_bf16 a[36:39], v[164:167], v[216:219], a[36:39]
buffer_load_dwordx4 v241, s[12:15], s28 offen offset:3072 sc1 lds
v_mfma_f32_16x16x32_bf16 a[40:43], v[168:171], v[216:219], a[40:43]
v_exp_f32 v144, v144
v_mfma_f32_16x16x32_bf16 a[44:47], v[172:175], v[216:219], a[44:47]
ds_read_b64_tr_b16 v[216:217], v246 offset:4608
s_waitcnt lgkmcnt(5)
v_mfma_f32_16x16x32_bf16 a[48:51], v[160:163], v[220:223], a[48:51]
ds_read_b64_tr_b16 v[218:219], v246 offset:6656
v_mfma_f32_16x16x32_bf16 a[52:55], v[164:167], v[220:223], a[52:55]
v_exp_f32 v145, v145
v_mfma_f32_16x16x32_bf16 a[56:59], v[168:171], v[220:223], a[56:59]
v_exp_f32 v146, v146
v_mfma_f32_16x16x32_bf16 a[60:63], v[172:175], v[220:223], a[60:63]
ds_read_b64_tr_b16 v[220:221], v247 offset:4608
s_waitcnt lgkmcnt(5)
v_mfma_f32_16x16x32_bf16 a[64:67], v[160:163], v[208:211], a[64:67]
ds_read_b64_tr_b16 v[222:223], v247 offset:6656
v_mfma_f32_16x16x32_bf16 a[68:71], v[164:167], v[208:211], a[68:71]
s_waitcnt vmcnt(4)
s_barrier
v_mfma_f32_16x16x32_bf16 a[72:75], v[168:171], v[208:211], a[72:75]
v_exp_f32 v147, v147
v_mfma_f32_16x16x32_bf16 a[76:79], v[172:175], v[208:211], a[76:79]
ds_read_b128 v[208:211], v240 offset:12800
s_waitcnt lgkmcnt(5)
v_mfma_f32_16x16x32_bf16 a[80:83], v[160:163], v[212:215], a[80:83]
v_exp_f32 v148, v148
v_mfma_f32_16x16x32_bf16 a[84:87], v[164:167], v[212:215], a[84:87]
v_exp_f32 v149, v149
v_mfma_f32_16x16x32_bf16 a[88:91], v[168:171], v[212:215], a[88:91]
v_exp_f32 v150, v150
v_mfma_f32_16x16x32_bf16 a[92:95], v[172:175], v[212:215], a[92:95]
ds_read_b128 v[212:215], v240 offset:12288
s_waitcnt lgkmcnt(4)
v_mfma_f32_16x16x32_bf16 a[96:99], v[160:163], v[216:219], a[96:99]
v_exp_f32 v151, v151
v_mfma_f32_16x16x32_bf16 a[100:103], v[164:167], v[216:219], a[100:103]
v_cvt_pk_bf16_f32 v176, v128, v129
v_cvt_pk_bf16_f32 v177, v130, v131
v_mfma_f32_16x16x32_bf16 a[104:107], v[168:171], v[216:219], a[104:107]
v_exp_f32 v152, v152
v_mfma_f32_16x16x32_bf16 a[108:111], v[172:175], v[216:219], a[108:111]
ds_read_b128 v[216:219], v240 offset:0
s_waitcnt lgkmcnt(3)
v_cvt_pk_bf16_f32 v180, v132, v133
v_cvt_pk_bf16_f32 v181, v134, v135
v_mfma_f32_16x16x32_bf16 a[112:115], v[160:163], v[220:223], a[112:115]
v_exp_f32 v153, v153
v_mfma_f32_16x16x32_bf16 a[116:119], v[164:167], v[220:223], a[116:119]
v_cvt_pk_bf16_f32 v184, v136, v137
v_cvt_pk_bf16_f32 v185, v138, v139
v_mfma_f32_16x16x32_bf16 a[120:123], v[168:171], v[220:223], a[120:123]
v_exp_f32 v154, v154
v_mfma_f32_16x16x32_bf16 a[124:127], v[172:175], v[220:223], a[124:127]
ds_read_b128 v[220:223], v240 offset:512
s_waitcnt lgkmcnt(2)
v_mfma_f32_16x16x32_bf16 v[128:131], v[208:211], v[0:3], 0
v_exp_f32 v155, v155
v_mfma_f32_16x16x32_bf16 v[128:131], v[212:215], v[4:7], v[128:131]
v_cvt_pk_bf16_f32 v188, v140, v141
v_cvt_pk_bf16_f32 v189, v142, v143
v_mfma_f32_16x16x32_bf16 v[132:135], v[208:211], v[32:35], 0
v_exp_f32 v156, v156
v_mfma_f32_16x16x32_bf16 v[132:135], v[212:215], v[36:39], v[132:135]
v_exp_f32 v157, v157
v_mfma_f32_16x16x32_bf16 v[136:139], v[208:211], v[64:67], 0
v_exp_f32 v158, v158
v_mfma_f32_16x16x32_bf16 v[136:139], v[212:215], v[68:71], v[136:139]
v_exp_f32 v159, v159
v_mfma_f32_16x16x32_bf16 v[140:143], v[208:211], v[96:99], 0
ds_read_b128 v[208:211], v240 offset:4096
v_cvt_pk_bf16_f32 v178, v144, v145
v_cvt_pk_bf16_f32 v179, v146, v147
v_mfma_f32_16x16x32_bf16 v[140:143], v[212:215], v[100:103], v[140:143]
ds_read_b128 v[212:215], v240 offset:4608
s_waitcnt lgkmcnt(2)
v_cvt_pk_bf16_f32 v182, v148, v149
v_mfma_f32_16x16x32_bf16 v[128:131], v[216:219], v[8:11], v[128:131]
v_cvt_pk_bf16_f32 v183, v150, v151
v_cvt_pk_bf16_f32 v186, v152, v153
v_cvt_pk_bf16_f32 v187, v154, v155
v_mfma_f32_16x16x32_bf16 v[128:131], v[220:223], v[12:15], v[128:131]
v_cvt_pk_bf16_f32 v190, v156, v157
v_cvt_pk_bf16_f32 v191, v158, v159
v_or3_b32 v242, v176, v177, v178
v_mfma_f32_16x16x32_bf16 v[132:135], v[216:219], v[40:43], v[132:135]
v_or3_b32 v242, v242, v179, v180
v_or3_b32 v242, v242, v181, v182
v_or3_b32 v242, v242, v183, v184
v_mfma_f32_16x16x32_bf16 v[132:135], v[220:223], v[44:47], v[132:135]
v_or3_b32 v242, v242, v185, v186
v_or3_b32 v242, v242, v187, v188
v_or3_b32 v242, v242, v189, v190
v_mfma_f32_16x16x32_bf16 v[136:139], v[216:219], v[72:75], v[136:139]
v_or_b32 v242, v242, v191
v_lshl_or_b32 v242, v242, 16, v242
v_cmp_le_u32 vcc, 2.0, v242
v_mfma_f32_16x16x32_bf16 v[136:139], v[220:223], v[76:79], v[136:139]
v_mfma_f32_16x16x32_bf16 v[140:143], v[216:219], v[104:107], v[140:143]
ds_read_b128 v[216:219], v240 offset:8192
v_mfma_f32_16x16x32_bf16 v[140:143], v[220:223], v[108:111], v[140:143]
ds_read_b128 v[220:223], v240 offset:8704
s_waitcnt lgkmcnt(2)
s_cbranch_vccnz L2_rare_site4
L2_ret4:
v_mfma_f32_16x16x32_bf16 v[128:131], v[208:211], v[16:19], v[128:131]
v_mfma_f32_16x16x32_bf16 v[128:131], v[212:215], v[20:23], v[128:131]
v_mfma_f32_16x16x32_bf16 v[132:135], v[208:211], v[48:51], v[132:135]
v_mfma_f32_16x16x32_bf16 v[132:135], v[212:215], v[52:55], v[132:135]
v_mfma_f32_16x16x32_bf16 v[136:139], v[208:211], v[80:83], v[136:139]
v_mfma_f32_16x16x32_bf16 v[136:139], v[212:215], v[84:87], v[136:139]
s_sub_u32 s31, s31, 1
v_mfma_f32_16x16x32_bf16 v[140:143], v[208:211], v[112:115], v[140:143]
ds_read_b128 v[208:211], v240 offset:14848
v_mfma_f32_16x16x32_bf16 v[140:143], v[212:215], v[116:119], v[140:143]
ds_read_b128 v[212:215], v240 offset:14336
s_waitcnt lgkmcnt(2)
v_mfma_f32_16x16x32_bf16 v[128:131], v[216:219], v[24:27], v[128:131]
s_add_u32 s28, s28, s101
s_add_u32 s30, s30, 0x4000
v_mfma_f32_16x16x32_bf16 v[128:131], v[220:223], v[28:31], v[128:131]
s_and_b32 s30, s30, 0x1ffff
v_mfma_f32_16x16x32_bf16 v[132:135], v[216:219], v[56:59], v[132:135]
v_mfma_f32_16x16x32_bf16 v[132:135], v[220:223], v[60:63], v[132:135]
v_mfma_f32_16x16x32_bf16 v[136:139], v[216:219], v[88:91], v[136:139]
v_mfma_f32_16x16x32_bf16 v[136:139], v[220:223], v[92:95], v[136:139]
v_mfma_f32_16x16x32_bf16 v[140:143], v[216:219], v[120:123], v[140:143]
ds_read_b128 v[216:219], v240 offset:2048
v_mfma_f32_16x16x32_bf16 v[140:143], v[220:223], v[124:127], v[140:143]
ds_read_b128 v[220:223], v240 offset:2560
s_branch L2_loop1
.p2align 6
L2_loop:
s_waitcnt lgkmcnt(2)
L2_ret1:
v_mfma_f32_16x16x32_bf16 v[144:147], v[208:211], v[0:3], 0
v_mfma_f32_16x16x32_bf16 v[144:147], v[212:215], v[4:7], v[144:147]
v_mfma_f32_16x16x32_bf16 v[148:151], v[208:211], v[32:35], 0
v_mfma_f32_16x16x32_bf16 v[148:151], v[212:215], v[36:39], v[148:151]
v_mfma_f32_16x16x32_bf16 v[152:155], v[208:211], v[64:67], 0
v_exp_f32 v128, v128
v_mfma_f32_16x16x32_bf16 v[152:155], v[212:215], v[68:71], v[152:155]
v_exp_f32 v129, v129
v_mfma_f32_16x16x32_bf16 v[156:159], v[208:211], v[96:99], 0
ds_read_b128 v[208:211], v240 offset:22528
v_mfma_f32_16x16x32_bf16 v[156:159], v[212:215], v[100:103], v[156:159]
ds_read_b128 v[212:215], v240 offset:23040
s_waitcnt lgkmcnt(2)
v_mfma_f32_16x16x32_bf16 v[144:147], v[216:219], v[8:11], v[144:147]
v_exp_f32 v130, v130
v_mfma_f32_16x16x32_bf16 v[144:147], v[220:223], v[12:15], v[144:147]
v_exp_f32 v131, v131
v_mfma_f32_16x16x32_bf16 v[148:151], v[216:219], v[40:43], v[148:151]
v_exp_f32 v132, v132
v_mfma_f32_16x16x32_bf16 v[148:151], v[220:223], v[44:47], v[148:151]
v_exp_f32 v133, v133
v_mfma_f32_16x16x32_bf16 v[152:155], v[216:219], v[72:75], v[152:155]
v_exp_f32 v134, v134
v_mfma_f32_16x16x32_bf16 v[152:155], v[220:223], v[76:79], v[152:155]
v_exp_f32 v135, v135
v_mfma_f32_16x16x32_bf16 v[156:159], v[216:219], v[104:107], v[156:159]
ds_read_b128 v[216:219], v240 offset:26624
v_mfma_f32_16x16x32_bf16 v[156:159], v[220:223], v[108:111], v[156:159]
ds_read_b128 v[220:223], v240 offset:27136
s_waitcnt lgkmcnt(2)
v_mfma_f32_16x16x32_bf16 v[144:147], v[208:211], v[16:19], v[144:147]
v_exp_f32 v136, v136
v_mfma_f32_16x16x32_bf16 v[144:147], v[212:215], v[20:23], v[144:147]
v_add_u32 v240, 0x8000, v240
v_mfma_f32_16x16x32_bf16 v[148:151], v[208:211], v[48:51], v[148:151]
v_and_b32 v240, 0x1ffff, v240
v_mfma_f32_16x16x32_bf16 v[148:151], v[212:215], v[52:55], v[148:151]
v_exp_f32 v137, v137
v_mfma_f32_16x16x32_bf16 v[152:155], v[208:211], v[80:83], v[152:155]
v_exp_f32 v138, v138
v_mfma_f32_16x16x32_bf16 v[152:155], v[212:215], v[84:87], v[152:155]
v_exp_f32 v139, v139
v_mfma_f32_16x16x32_bf16 v[156:159], v[208:211], v[112:115], v[156:159]
ds_read_b64_tr_b16 v[208:209], v244 offset:16384
ds_read_b64_tr_b16 v[210:211], v244 offset:18432
v_mfma_f32_16x16x32_bf16 v[156:159], v[212:215], v[116:119], v[156:159]
ds_read_b64_tr_b16 v[212:213], v246 offset:0
s_waitcnt lgkmcnt(3)
v_mfma_f32_16x16x32_bf16 v[144:147], v[216:219], v[24:27], v[144:147]
ds_read_b64_tr_b16 v[214:215], v246 offset:2048
v_mfma_f32_16x16x32_bf16 v[144:147], v[220:223], v[28:31], v[144:147]
v_exp_f32 v140, v140
v_mfma_f32_16x16x32_bf16 v[148:151], v[216:219], v[56:59], v[148:151]
v_exp_f32 v141, v141
v_mfma_f32_16x16x32_bf16 v[148:151], v[220:223], v[60:63], v[148:151]
v_exp_f32 v142, v142
v_mfma_f32_16x16x32_bf16 v[152:155], v[216:219], v[88:91], v[152:155]
v_exp_f32 v143, v143
v_mfma_f32_16x16x32_bf16 v[152:155], v[220:223], v[92:95], v[152:155]
v_mfma_f32_16x16x32_bf16 v[156:159], v[216:219], v[120:123], v[156:159]
ds_read_b64_tr_b16 v[216:217], v245 offset:16384
ds_read_b64_tr_b16 v[218:219], v245 offset:18432
v_mfma_f32_16x16x32_bf16 v[156:159], v[220:223], v[124:127], v[156:159]
ds_read_b64_tr_b16 v[220:221], v247 offset:0
s_waitcnt lgkmcnt(3)
v_mfma_f32_16x16x32_bf16 a[0:3], v[176:179], v[208:211], a[0:3]
ds_read_b64_tr_b16 v[222:223], v247 offset:2048
v_mfma_f32_16x16x32_bf16 a[0:3], v[160:163], v[212:215], a[0:3]
v_mfma_f32_16x16x32_bf16 a[4:7], v[180:183], v[208:211], a[4:7]
v_mfma_f32_16x16x32_bf16 a[4:7], v[164:167], v[212:215], a[4:7]
v_mfma_f32_16x16x32_bf16 a[8:11], v[184:187], v[208:211], a[8:11]
v_mfma_f32_16x16x32_bf16 a[8:11], v[168:171], v[212:215], a[8:11]
v_mfma_f32_16x16x32_bf16 a[12:15], v[188:191], v[208:211], a[12:15]
ds_read_b64_tr_b16 v[208:209], v244 offset:16896
ds_read_b64_tr_b16 v[210:211], v244 offset:18944
v_mfma_f32_16x16x32_bf16 a[12:15], v[172:175], v[212:215], a[12:15]
ds_read_b64_tr_b16 v[212:213], v246 offset:512
s_waitcnt lgkmcnt(3)
v_mfma_f32_16x16x32_bf16 a[16:19], v[176:179], v[216:219], a[16:19]
ds_read_b64_tr_b16 v[214:215], v246 offset:2560
v_mfma_f32_16x16x32_bf16 a[16:19], v[160:163], v[220:223], a[16:19]
v_exp_f32 v144, v144
v_mfma_f32_16x16x32_bf16 a[20:23], v[180:183], v[216:219], a[20:23]
v_exp_f32 v145, v145
v_mfma_f32_16x16x32_bf16 a[20:23], v[164:167], v[220:223], a[20:23]
v_exp_f32 v146, v146
v_mfma_f32_16x16x32_bf16 a[24:27], v[184:187], v[216:219], a[24:27]
v_exp_f32 v147, v147
v_mfma_f32_16x16x32_bf16 a[24:27], v[168:171], v[220:223], a[24:27]
v_exp_f32 v148, v148
v_mfma_f32_16x16x32_bf16 a[28:31], v[188:191], v[216:219], a[28:31]
ds_read_b64_tr_b16 v[216:217], v245 offset:16896
ds_read_b64_tr_b16 v[218:219], v245 offset:18944
v_mfma_f32_16x16x32_bf16 a[28:31], v[172:175], v[220:223], a[28:31]
ds_read_b64_tr_b16 v[220:221], v247 offset:512
s_waitcnt lgkmcnt(3)
v_mfma_f32_16x16x32_bf16 a[32:35], v[176:179], v[208:211], a[32:35]
ds_read_b64_tr_b16 v[222:223], v247 offset:2560
v_mfma_f32_16x16x32_bf16 a[32:35], v[160:163], v[212:215], a[32:35]
v_exp_f32 v149, v149
v_mfma_f32_16x16x32_bf16 a[36:39], v[180:183], v[208:211], a[36:39]
v_exp_f32 v150, v150
v_mfma_f32_16x16x32_bf16 a[36:39], v[164:167], v[212:215], a[36:39]
v_exp_f32 v151, v151
v_mfma_f32_16x16x32_bf16 a[40:43], v[184:187], v[208:211], a[40:43]
s_mov_b32 m0, s30
v_mfma_f32_16x16x32_bf16 a[40:43], v[168:171], v[212:215], a[40:43]
buffer_load_dwordx4 v241, s[12:15], s28 offen offset:0 sc1 lds
v_mfma_f32_16x16x32_bf16 a[44:47], v[188:191], v[208:211], a[44:47]
ds_read_b64_tr_b16 v[208:209], v244 offset:20480
ds_read_b64_tr_b16 v[210:211], v244 offset:22528
v_mfma_f32_16x16x32_bf16 a[44:47], v[172:175], v[212:215], a[44:47]
ds_read_b64_tr_b16 v[212:213], v246 offset:4096
s_waitcnt lgkmcnt(3)
v_mfma_f32_16x16x32_bf16 a[48:51], v[176:179], v[216:219], a[48:51]
ds_read_b64_tr_b16 v[214:215], v246 offset:6144
v_mfma_f32_16x16x32_bf16 a[48:51], v[160:163], v[220:223], a[48:51]
buffer_load_dwordx4 v241, s[12:15], s28 offen offset:1024 sc1 lds
v_mfma_f32_16x16x32_bf16 a[52:55], v[180:183], v[216:219], a[52:55]
v_exp_f32 v152, v152
v_mfma_f32_16x16x32_bf16 a[52:55], v[164:167], v[220:223], a[52:55]
v_exp_f32 v153, v153
v_mfma_f32_16x16x32_bf16 a[56:59], v[184:187], v[216:219], a[56:59]
v_exp_f32 v154, v154
v_mfma_f32_16x16x32_bf16 a[56:59], v[168:171], v[220:223], a[56:59]
buffer_load_dwordx4 v241, s[12:15], s28 offen offset:2048 sc1 lds
v_mfma_f32_16x16x32_bf16 a[60:63], v[188:191], v[216:219], a[60:63]
ds_read_b64_tr_b16 v[216:217], v245 offset:20480
ds_read_b64_tr_b16 v[218:219], v245 offset:22528
v_mfma_f32_16x16x32_bf16 a[60:63], v[172:175], v[220:223], a[60:63]
ds_read_b64_tr_b16 v[220:221], v247 offset:4096
s_waitcnt lgkmcnt(3)
v_mfma_f32_16x16x32_bf16 a[64:67], v[176:179], v[208:211], a[64:67]
ds_read_b64_tr_b16 v[222:223], v247 offset:6144
v_mfma_f32_16x16x32_bf16 a[64:67], v[160:163], v[212:215], a[64:67]
buffer_load_dwordx4 v241, s[12:15], s28 offen offset:3072 sc1 lds
v_mfma_f32_16x16x32_bf16 a[68:71], v[180:183], v[208:211], a[68:71]
v_exp_f32 v155, v155
v_mfma_f32_16x16x32_bf16 a[68:71], v[164:167], v[212:215], a[68:71]
v_exp_f32 v156, v156
v_mfma_f32_16x16x32_bf16 a[72:75], v[184:187], v[208:211], a[72:75]
v_exp_f32 v157, v157
v_mfma_f32_16x16x32_bf16 a[72:75], v[168:171], v[212:215], a[72:75]
v_exp_f32 v158, v158
v_mfma_f32_16x16x32_bf16 a[76:79], v[188:191], v[208:211], a[76:79]
ds_read_b64_tr_b16 v[208:209], v244 offset:20992
ds_read_b64_tr_b16 v[210:211], v244 offset:23040
v_mfma_f32_16x16x32_bf16 a[76:79], v[172:175], v[212:215], a[76:79]
ds_read_b64_tr_b16 v[212:213], v246 offset:4608
s_waitcnt lgkmcnt(3)
v_mfma_f32_16x16x32_bf16 a[80:83], v[176:179], v[216:219], a[80:83]
ds_read_b64_tr_b16 v[214:215], v246 offset:6656
v_mfma_f32_16x16x32_bf16 a[80:83], v[160:163], v[220:223], a[80:83]
v_exp_f32 v159, v159
v_mfma_f32_16x16x32_bf16 a[84:87], v[180:183], v[216:219], a[84:87]
v_mfma_f32_16x16x32_bf16 a[84:87], v[164:167], v[220:223], a[84:87]
v_mfma_f32_16x16x32_bf16 a[88:91], v[184:187], v[216:219], a[88:91]
v_mfma_f32_16x16x32_bf16 a[88:91], v[168:171], v[220:223], a[88:91]
v_mfma_f32_16x16x32_bf16 a[92:95], v[188:191], v[216:219], a[92:95]
ds_read_b64_tr_b16 v[216:217], v245 offset:20992
ds_read_b64_tr_b16 v[218:219], v245 offset:23040
v_mfma_f32_16x16x32_bf16 a[92:95], v[172:175], v[220:223], a[92:95]
ds_read_b64_tr_b16 v[220:221], v247 offset:4608
s_waitcnt lgkmcnt(3)
v_mfma_f32_16x16x32_bf16 a[96:99], v[176:179], v[208:211], a[96:99]
ds_read_b64_tr_b16 v[222:223], v247 offset:6656
v_mfma_f32_16x16x32_bf16 a[96:99], v[160:163], v[212:215], a[96:99]
s_waitcnt vmcnt(4)
s_barrier
v_mfma_f32_16x16x32_bf16 a[100:103], v[180:183], v[208:211], a[100:103]
v_mfma_f32_16x16x32_bf16 a[100:103], v[164:167], v[212:215], a[100:103]
v_mfma_f32_16x16x32_bf16 a[104:107], v[184:187], v[208:211], a[104:107]
v_mfma_f32_16x16x32_bf16 a[104:107], v[168:171], v[212:215], a[104:107]
v_mfma_f32_16x16x32_bf16 a[108:111], v[188:191], v[208:211], a[108:111]
ds_read_b128 v[208:211], v240 offset:12800
v_mfma_f32_16x16x32_bf16 a[108:111], v[172:175], v[212:215], a[108:111]
ds_read_b128 v[212:215], v240 offset:12288
s_waitcnt lgkmcnt(2)
v_mfma_f32_16x16x32_bf16 a[112:115], v[176:179], v[216:219], a[112:115]
v_mfma_f32_16x16x32_bf16 a[112:115], v[160:163], v[220:223], a[112:115]
v_cvt_pk_bf16_f32 v176, v128, v129
v_cvt_pk_bf16_f32 v177, v130, v131
v_mfma_f32_16x16x32_bf16 a[116:119], v[180:183], v[216:219], a[116:119]
v_cvt_pk_bf16_f32 v178, v144, v145
v_cvt_pk_bf16_f32 v179, v146, v147
v_mfma_f32_16x16x32_bf16 a[116:119], v[164:167], v[220:223], a[116:119]
v_cvt_pk_bf16_f32 v180, v132, v133
v_cvt_pk_bf16_f32 v181, v134, v135
v_mfma_f32_16x16x32_bf16 a[120:123], v[184:187], v[216:219], a[120:123]
v_cvt_pk_bf16_f32 v182, v148, v149
v_cvt_pk_bf16_f32 v183, v150, v151
v_mfma_f32_16x16x32_bf16 a[120:123], v[168:171], v[220:223], a[120:123]
v_cvt_pk_bf16_f32 v184, v136, v137
v_cvt_pk_bf16_f32 v185, v138, v139
v_mfma_f32_16x16x32_bf16 a[124:127], v[188:191], v[216:219], a[124:127]
ds_read_b128 v[216:219], v240 offset:0
v_or3_b32 v242, v176, v177, v178
v_mfma_f32_16x16x32_bf16 a[124:127], v[172:175], v[220:223], a[124:127]
ds_read_b128 v[220:223], v240 offset:512
s_waitcnt lgkmcnt(2)
v_mfma_f32_16x16x32_bf16 v[128:131], v[208:211], v[0:3], 0
v_cvt_pk_bf16_f32 v186, v152, v153
v_cvt_pk_bf16_f32 v187, v154, v155
v_mfma_f32_16x16x32_bf16 v[128:131], v[212:215], v[4:7], v[128:131]
v_cvt_pk_bf16_f32 v188, v140, v141
v_cvt_pk_bf16_f32 v189, v142, v143
v_mfma_f32_16x16x32_bf16 v[132:135], v[208:211], v[32:35], 0
v_cvt_pk_bf16_f32 v190, v156, v157
v_cvt_pk_bf16_f32 v191, v158, v159
v_mfma_f32_16x16x32_bf16 v[132:135], v[212:215], v[36:39], v[132:135]
v_or3_b32 v242, v242, v179, v180
v_or3_b32 v242, v242, v181, v182
v_mfma_f32_16x16x32_bf16 v[136:139], v[208:211], v[64:67], 0
v_or3_b32 v242, v242, v183, v184
v_or3_b32 v242, v242, v185, v186
v_mfma_f32_16x16x32_bf16 v[136:139], v[212:215], v[68:71], v[136:139]
v_or3_b32 v242, v242, v187, v188
v_or3_b32 v242, v242, v189, v190
v_mfma_f32_16x16x32_bf16 v[140:143], v[208:211], v[96:99], 0
ds_read_b128 v[208:211], v240 offset:4096
v_or_b32 v242, v242, v191
v_mfma_f32_16x16x32_bf16 v[140:143], v[212:215], v[100:103], v[140:143]
ds_read_b128 v[212:215], v240 offset:4608
s_waitcnt lgkmcnt(2)
v_mfma_f32_16x16x32_bf16 v[128:131], v[216:219], v[8:11], v[128:131]
v_lshl_or_b32 v242, v242, 16, v242
v_cmp_le_u32 vcc, 2.0, v242
v_mfma_f32_16x16x32_bf16 v[128:131], v[220:223], v[12:15], v[128:131]
v_mfma_f32_16x16x32_bf16 v[132:135], v[216:219], v[40:43], v[132:135]
v_mfma_f32_16x16x32_bf16 v[132:135], v[220:223], v[44:47], v[132:135]
s_cbranch_vccnz L2_rare_site0
L2_ret0:
v_mfma_f32_16x16x32_bf16 v[136:139], v[216:219], v[72:75], v[136:139]
v_mfma_f32_16x16x32_bf16 v[136:139], v[220:223], v[76:79], v[136:139]
v_mfma_f32_16x16x32_bf16 v[140:143], v[216:219], v[104:107], v[140:143]
ds_read_b128 v[216:219], v240 offset:8192
v_mfma_f32_16x16x32_bf16 v[140:143], v[220:223], v[108:111], v[140:143]
ds_read_b128 v[220:223], v240 offset:8704
s_waitcnt lgkmcnt(2)
v_mfma_f32_16x16x32_bf16 v[128:131], v[208:211], v[16:19], v[128:131]
v_mfma_f32_16x16x32_bf16 v[128:131], v[212:215], v[20:23], v[128:131]
v_mfma_f32_16x16x32_bf16 v[132:135], v[208:211], v[48:51], v[132:135]
v_mfma_f32_16x16x32_bf16 v[132:135], v[212:215], v[52:55], v[132:135]
v_mfma_f32_16x16x32_bf16 v[136:139], v[208:211], v[80:83], v[136:139]
v_mfma_f32_16x16x32_bf16 v[136:139], v[212:215], v[84:87], v[136:139]
s_sub_u32 s31, s31, 1
v_mfma_f32_16x16x32_bf16 v[140:143], v[208:211], v[112:115], v[140:143]
ds_read_b128 v[208:211], v240 offset:14848
v_mfma_f32_16x16x32_bf16 v[140:143], v[212:215], v[116:119], v[140:143]
ds_read_b128 v[212:215], v240 offset:14336
s_waitcnt lgkmcnt(2)
v_mfma_f32_16x16x32_bf16 v[128:131], v[216:219], v[24:27], v[128:131]
s_add_u32 s28, s28, s101
s_add_u32 s30, s30, 0x4000
v_mfma_f32_16x16x32_bf16 v[128:131], v[220:223], v[28:31], v[128:131]
s_and_b32 s30, s30, 0x1ffff
v_mfma_f32_16x16x32_bf16 v[132:135], v[216:219], v[56:59], v[132:135]
s_cmp_eq_u32 s31, 0
v_mfma_f32_16x16x32_bf16 v[132:135], v[220:223], v[60:63], v[132:135]
v_mfma_f32_16x16x32_bf16 v[136:139], v[216:219], v[88:91], v[136:139]
v_mfma_f32_16x16x32_bf16 v[136:139], v[220:223], v[92:95], v[136:139]
v_mfma_f32_16x16x32_bf16 v[140:143], v[216:219], v[120:123], v[140:143]
ds_read_b128 v[216:219], v240 offset:2048
v_mfma_f32_16x16x32_bf16 v[140:143], v[220:223], v[124:127], v[140:143]
ds_read_b128 v[220:223], v240 offset:2560
s_cbranch_scc1 L2_x1
L2_loop1:
s_waitcnt lgkmcnt(2)
L2_ret3:
v_mfma_f32_16x16x32_bf16 v[144:147], v[208:211], v[0:3], 0
v_mfma_f32_16x16x32_bf16 v[144:147], v[212:215], v[4:7], v[144:147]
v_mfma_f32_16x16x32_bf16 v[148:151], v[208:211], v[32:35], 0
v_mfma_f32_16x16x32_bf16 v[148:151], v[212:215], v[36:39], v[148:151]
v_mfma_f32_16x16x32_bf16 v[152:155], v[208:211], v[64:67], 0
v_exp_f32 v128, v128
v_mfma_f32_16x16x32_bf16 v[152:155], v[212:215], v[68:71], v[152:155]
v_exp_f32 v129, v129
v_mfma_f32_16x16x32_bf16 v[156:159], v[208:211], v[96:99], 0
ds_read_b128 v[208:211], v240 offset:6144
v_mfma_f32_16x16x32_bf16 v[156:159], v[212:215], v[100:103], v[156:159]
ds_read_b128 v[212:215], v240 offset:6656
s_waitcnt lgkmcnt(2)
v_mfma_f32_16x16x32_bf16 v[144:147], v[216:219], v[8:11], v[144:147]
v_exp_f32 v130, v130
v_mfma_f32_16x16x32_bf16 v[144:147], v[220:223], v[12:15], v[144:147]
v_exp_f32 v131, v131
v_mfma_f32_16x16x32_bf16 v[148:151], v[216:219], v[40:43], v[148:151]
v_exp_f32 v132, v132
v_mfma_f32_16x16x32_bf16 v[148:151], v[220:223], v[44:47], v[148:151]
v_exp_f32 v133, v133
v_mfma_f32_16x16x32_bf16 v[152:155], v[216:219], v[72:75], v[152:155]
v_exp_f32 v134, v134
v_mfma_f32_16x16x32_bf16 v[152:155], v[220:223], v[76:79], v[152:155]
v_exp_f32 v135, v135
v_mfma_f32_16x16x32_bf16 v[156:159], v[216:219], v[104:107], v[156:159]
ds_read_b128 v[216:219], v240 offset:10240
v_mfma_f32_16x16x32_bf16 v[156:159], v[220:223], v[108:111], v[156:159]
ds_read_b128 v[220:223], v240 offset:10752
s_waitcnt lgkmcnt(2)
v_mfma_f32_16x16x32_bf16 v[144:147], v[208:211], v[16:19], v[144:147]
v_exp_f32 v136, v136
v_mfma_f32_16x16x32_bf16 v[144:147], v[212:215], v[20:23], v[144:147]
v_exp_f32 v137, v137
v_mfma_f32_16x16x32_bf16 v[148:151], v[208:211], v[48:51], v[148:151]
v_exp_f32 v138, v138
v_mfma_f32_16x16x32_bf16 v[148:151], v[212:215], v[52:55], v[148:151]
v_exp_f32 v139, v139
v_mfma_f32_16x16x32_bf16 v[152:155], v[208:211], v[80:83], v[152:155]
v_exp_f32 v140, v140
v_mfma_f32_16x16x32_bf16 v[152:155], v[212:215], v[84:87], v[152:155]
v_exp_f32 v141, v141
v_mfma_f32_16x16x32_bf16 v[156:159], v[208:211], v[112:115], v[156:159]
ds_read_b64_tr_b16 v[208:209], v246 offset:8192
ds_read_b64_tr_b16 v[210:211], v246 offset:10240
v_mfma_f32_16x16x32_bf16 v[156:159], v[212:215], v[116:119], v[156:159]
ds_read_b64_tr_b16 v[212:213], v246 offset:24576
s_waitcnt lgkmcnt(3)
v_mfma_f32_16x16x32_bf16 v[144:147], v[216:219], v[24:27], v[144:147]
ds_read_b64_tr_b16 v[214:215], v246 offset:26624
v_mfma_f32_16x16x32_bf16 v[144:147], v[220:223], v[28:31], v[144:147]
v_exp_f32 v142, v142
v_mfma_f32_16x16x32_bf16 v[148:151], v[216:219], v[56:59], v[148:151]
v_exp_f32 v143, v143
v_mfma_f32_16x16x32_bf16 v[148:151], v[220:223], v[60:63], v[148:151]
v_mfma_f32_16x16x32_bf16 v[152:155], v[216:219], v[88:91], v[152:155]
v_mfma_f32_16x16x32_bf16 v[152:155], v[220:223], v[92:95], v[152:155]
v_mfma_f32_16x16x32_bf16 v[156:159], v[216:219], v[120:123], v[156:159]
ds_read_b64_tr_b16 v[216:217], v247 offset:8192
ds_read_b64_tr_b16 v[218:219], v247 offset:10240
v_mfma_f32_16x16x32_bf16 v[156:159], v[220:223], v[124:127], v[156:159]
ds_read_b64_tr_b16 v[220:221], v247 offset:24576
s_waitcnt lgkmcnt(3)
v_mfma_f32_16x16x32_bf16 a[128:131], v[160:163], v[208:211], a[128:131]
ds_read_b64_tr_b16 v[222:223], v247 offset:26624
v_mfma_f32_16x16x32_bf16 a[128:131], v[176:179], v[212:215], a[128:131]
v_mfma_f32_16x16x32_bf16 a[132:135], v[164:167], v[208:211], a[132:135]
v_mfma_f32_16x16x32_bf16 a[132:135], v[180:183], v[212:215], a[132:135]
v_mfma_f32_16x16x32_bf16 a[136:139], v[168:171], v[208:211], a[136:139]
v_mfma_f32_16x16x32_bf16 a[136:139], v[184:187], v[212:215], a[136:139]
v_mfma_f32_16x16x32_bf16 a[140:143], v[172:175], v[208:211], a[140:143]
ds_read_b64_tr_b16 v[208:209], v246 offset:8704
ds_read_b64_tr_b16 v[210:211], v246 offset:10752
v_mfma_f32_16x16x32_bf16 a[140:143], v[188:191], v[212:215], a[140:143]
ds_read_b64_tr_b16 v[212:213], v246 offset:25088
s_waitcnt lgkmcnt(3)
v_mfma_f32_16x16x32_bf16 a[144:147], v[160:163], v[216:219], a[144:147]
ds_read_b64_tr_b16 v[214:215], v246 offset:27136
v_mfma_f32_16x16x32_bf16 a[144:147], v[176:179], v[220:223], a[144:147]
v_exp_f32 v144, v144
v_mfma_f32_16x16x32_bf16 a[148:151], v[164:167], v[216:219], a[148:151]
v_exp_f32 v145, v145
v_mfma_f32_16x16x32_bf16 a[148:151], v[180:183], v[220:223], a[148:151]
v_exp_f32 v146, v146
v_mfma_f32_16x16x32_bf16 a[152:155], v[168:171], v[216:219], a[152:155]
v_exp_f32 v147, v147
v_mfma_f32_16x16x32_bf16 a[152:155], v[184:187], v[220:223], a[152:155]
v_exp_f32 v148, v148
v_mfma_f32_16x16x32_bf16 a[156:159], v[172:175], v[216:219], a[156:159]
ds_read_b64_tr_b16 v[216:217], v247 offset:8704
ds_read_b64_tr_b16 v[218:219], v247 offset:10752
v_mfma_f32_16x16x32_bf16 a[156:159], v[188:191], v[220:223], a[156:159]
ds_read_b64_tr_b16 v[220:221], v247 offset:25088
s_waitcnt lgkmcnt(3)
v_mfma_f32_16x16x32_bf16 a[160:163], v[160:163], v[208:211], a[160:163]
ds_read_b64_tr_b16 v[222:223], v247 offset:27136
v_mfma_f32_16x16x32_bf16 a[160:163], v[176:179], v[212:215], a[160:163]
v_exp_f32 v149, v149
v_mfma_f32_16x16x32_bf16 a[164:167], v[164:167], v[208:211], a[164:167]
v_exp_f32 v150, v150
v_mfma_f32_16x16x32_bf16 a[164:167], v[180:183], v[212:215], a[164:167]
v_exp_f32 v151, v151
v_mfma_f32_16x16x32_bf16 a[168:171], v[168:171], v[208:211], a[168:171]
s_mov_b32 m0, s30
v_mfma_f32_16x16x32_bf16 a[168:171], v[184:187], v[212:215], a[168:171]
buffer_load_dwordx4 v241, s[12:15], s28 offen offset:0 sc1 lds
v_mfma_f32_16x16x32_bf16 a[172:175], v[172:175], v[208:211], a[172:175]
ds_read_b64_tr_b16 v[208:209], v246 offset:12288
ds_read_b64_tr_b16 v[210:211], v246 offset:14336
v_mfma_f32_16x16x32_bf16 a[172:175], v[188:191], v[212:215], a[172:175]
ds_read_b64_tr_b16 v[212:213], v246 offset:28672
s_waitcnt lgkmcnt(3)
v_mfma_f32_16x16x32_bf16 a[176:179], v[160:163], v[216:219], a[176:179]
ds_read_b64_tr_b16 v[214:215], v246 offset:30720
v_mfma_f32_16x16x32_bf16 a[176:179], v[176:179], v[220:223], a[176:179]
buffer_load_dwordx4 v241, s[12:15], s28 offen offset:1024 sc1 lds
v_mfma_f32_16x16x32_bf16 a[180:183], v[164:167], v[216:219], a[180:183]
v_exp_f32 v152, v152
v_mfma_f32_16x16x32_bf16 a[180:183], v[180:183], v[220:223], a[180:183]
v_exp_f32 v153, v153
v_mfma_f32_16x16x32_bf16 a[184:187], v[168:171], v[216:219], a[184:187]
v_exp_f32 v154, v154
v_mfma_f32_16x16x32_bf16 a[184:187], v[184:187], v[220:223], a[184:187]
buffer_load_dwordx4 v241, s[12:15], s28 offen offset:2048 sc1 lds
v_mfma_f32_16x16x32_bf16 a[188:191], v[172:175], v[216:219], a[188:191]
ds_read_b64_tr_b16 v[216:217], v247 offset:12288
ds_read_b64_tr_b16 v[218:219], v247 offset:14336
v_mfma_f32_16x16x32_bf16 a[188:191], v[188:191], v[220:223], a[188:191]
ds_read_b64_tr_b16 v[220:221], v247 offset:28672
s_waitcnt lgkmcnt(3)
v_mfma_f32_16x16x32_bf16 a[192:195], v[160:163], v[208:211], a[192:195]
ds_read_b64_tr_b16 v[222:223], v247 offset:30720
v_mfma_f32_16x16x32_bf16 a[192:195], v[176:179], v[212:215], a[192:195]
buffer_load_dwordx4 v241, s[12:15], s28 offen offset:3072 sc1 lds
v_mfma_f32_16x16x32_bf16 a[196:199], v[164:167], v[208:211], a[196:199]
v_exp_f32 v155, v155
v_mfma_f32_16x16x32_bf16 a[196:199], v[180:183], v[212:215], a[196:199]
v_exp_f32 v156, v156
v_mfma_f32_16x16x32_bf16 a[200:203], v[168:171], v[208:211], a[200:203]
v_exp_f32 v157, v157
v_mfma_f32_16x16x32_bf16 a[200:203], v[184:187], v[212:215], a[200:203]
v_exp_f32 v158, v158
v_mfma_f32_16x16x32_bf16 a[204:207], v[172:175], v[208:211], a[204:207]
ds_read_b64_tr_b16 v[208:209], v246 offset:12800
ds_read_b64_tr_b16 v[210:211], v246 offset:14848
v_mfma_f32_16x16x32_bf16 a[204:207], v[188:191], v[212:215], a[204:207]
ds_read_b64_tr_b16 v[212:213], v246 offset:29184
s_waitcnt lgkmcnt(3)
v_mfma_f32_16x16x32_bf16 a[208:211], v[160:163], v[216:219], a[208:211]
ds_read_b64_tr_b16 v[214:215], v246 offset:31232
v_mfma_f32_16x16x32_bf16 a[208:211], v[176:179], v[220:223], a[208:211]
v_exp_f32 v159, v159
v_mfma_f32_16x16x32_bf16 a[212:215], v[164:167], v[216:219], a[212:215]
v_mfma_f32_16x16x32_bf16 a[212:215], v[180:183], v[220:223], a[212:215]
v_mfma_f32_16x16x32_bf16 a[216:219], v[168:171], v[216:219], a[216:219]
v_mfma_f32_16x16x32_bf16 a[216:219], v[184:187], v[220:223], a[216:219]
v_mfma_f32_16x16x32_bf16 a[220:223], v[172:175], v[216:219], a[220:223]
ds_read_b64_tr_b16 v[216:217], v247 offset:12800
ds_read_b64_tr_b16 v[218:219], v247 offset:14848
v_mfma_f32_16x16x32_bf16 a[220:223], v[188:191], v[220:223], a[220:223]
ds_read_b64_tr_b16 v[220:221], v247 offset:29184
s_waitcnt lgkmcnt(3)
v_mfma_f32_16x16x32_bf16 a[224:227], v[160:163], v[208:211], a[224:227]
ds_read_b64_tr_b16 v[222:223], v247 offset:31232
v_mfma_f32_16x16x32_bf16 a[224:227], v[176:179], v[212:215], a[224:227]
s_waitcnt vmcnt(4)
s_barrier
v_mfma_f32_16x16x32_bf16 a[228:231], v[164:167], v[208:211], a[228:231]
v_mfma_f32_16x16x32_bf16 a[228:231], v[180:183], v[212:215], a[228:231]
v_mfma_f32_16x16x32_bf16 a[232:235], v[168:171], v[208:211], a[232:235]
v_mfma_f32_16x16x32_bf16 a[232:235], v[184:187], v[212:215], a[232:235]
v_mfma_f32_16x16x32_bf16 a[236:239], v[172:175], v[208:211], a[236:239]
ds_read_b128 v[208:211], v240 offset:29184
v_mfma_f32_16x16x32_bf16 a[236:239], v[188:191], v[212:215], a[236:239]
ds_read_b128 v[212:215], v240 offset:28672
s_waitcnt lgkmcnt(2)
v_mfma_f32_16x16x32_bf16 a[240:243], v[160:163], v[216:219], a[240:243]
v_mfma_f32_16x16x32_bf16 a[240:243], v[176:179], v[220:223], a[240:243]
v_cvt_pk_bf16_f32 v160, v128, v129
v_cvt_pk_bf16_f32 v161, v130, v131
v_mfma_f32_16x16x32_bf16 a[244:247], v[164:167], v[216:219], a[244:247]
v_cvt_pk_bf16_f32 v162, v144, v145
v_cvt_pk_bf16_f32 v163, v146, v147
v_mfma_f32_16x16x32_bf16 a[244:247], v[180:183], v[220:223], a[244:247]
v_cvt_pk_bf16_f32 v164, v132, v133
v_cvt_pk_bf16_f32 v165, v134, v135
v_mfma_f32_16x16x32_bf16 a[248:251], v[168:171], v[216:219], a[248:251]
v_cvt_pk_bf16_f32 v166, v148, v149
v_cvt_pk_bf16_f32 v167, v150, v151
v_mfma_f32_16x16x32_bf16 a[248:251], v[184:187], v[220:223], a[248:251]
v_cvt_pk_bf16_f32 v168, v136, v137
v_cvt_pk_bf16_f32 v169, v138, v139
v_mfma_f32_16x16x32_bf16 a[252:255], v[172:175], v[216:219], a[252:255]
ds_read_b128 v[216:219], v240 offset:16384
v_or3_b32 v242, v160, v161, v162
v_mfma_f32_16x16x32_bf16 a[252:255], v[188:191], v[220:223], a[252:255]
ds_read_b128 v[220:223], v240 offset:16896
s_waitcnt lgkmcnt(2)
v_mfma_f32_16x16x32_bf16 v[128:131], v[208:211], v[0:3], 0
v_cvt_pk_bf16_f32 v170, v152, v153
v_cvt_pk_bf16_f32 v171, v154, v155
v_mfma_f32_16x16x32_bf16 v[128:131], v[212:215], v[4:7], v[128:131]
v_cvt_pk_bf16_f32 v172, v140, v141
v_cvt_pk_bf16_f32 v173, v142, v143
v_mfma_f32_16x16x32_bf16 v[132:135], v[208:211], v[32:35], 0
v_cvt_pk_bf16_f32 v174, v156, v157
v_cvt_pk_bf16_f32 v175, v158, v159
v_mfma_f32_16x16x32_bf16 v[132:135], v[212:215], v[36:39], v[132:135]
v_or3_b32 v242, v242, v163, v164
v_or3_b32 v242, v242, v165, v166
v_mfma_f32_16x16x32_bf16 v[136:139], v[208:211], v[64:67], 0
v_or3_b32 v242, v242, v167, v168
v_or3_b32 v242, v242, v169, v170
v_mfma_f32_16x16x32_bf16 v[136:139], v[212:215], v[68:71], v[136:139]
v_or3_b32 v242, v242, v171, v172
v_or3_b32 v242, v242, v173, v174
v_mfma_f32_16x16x32_bf16 v[140:143], v[208:211], v[96:99], 0
ds_read_b128 v[208:211], v240 offset:20480
v_or_b32 v242, v242, v175
v_mfma_f32_16x16x32_bf16 v[140:143], v[212:215], v[100:103], v[140:143]
ds_read_b128 v[212:215], v240 offset:20992
s_waitcnt lgkmcnt(2)
v_mfma_f32_16x16x32_bf16 v[128:131], v[216:219], v[8:11], v[128:131]
v_mov_b32 v244, v246
v_mov_b32 v245, v247
v_mfma_f32_16x16x32_bf16 v[128:131], v[220:223], v[12:15], v[128:131]
v_add_u32 v246, 0x8000, v246
v_lshl_or_b32 v242, v242, 16, v242
v_mfma_f32_16x16x32_bf16 v[132:135], v[216:219], v[40:43], v[132:135]
v_and_b32 v246, 0x1ffff, v246
v_cmp_le_u32 vcc, 2.0, v242
v_mfma_f32_16x16x32_bf16 v[132:135], v[220:223], v[44:47], v[132:135]
v_mfma_f32_16x16x32_bf16 v[136:139], v[216:219], v[72:75], v[136:139]
v_xor_b32 v247, 32, v246
v_mfma_f32_16x16x32_bf16 v[136:139], v[220:223], v[76:79], v[136:139]
s_cbranch_vccnz L2_rare_site2
L2_ret2:
v_mfma_f32_16x16x32_bf16 v[140:143], v[216:219], v[104:107], v[140:143]
ds_read_b128 v[216:219], v240 offset:24576
v_mfma_f32_16x16x32_bf16 v[140:143], v[220:223], v[108:111], v[140:143]
ds_read_b128 v[220:223], v240 offset:25088
s_waitcnt lgkmcnt(2)
v_mfma_f32_16x16x32_bf16 v[128:131], v[208:211], v[16:19], v[128:131]
v_mfma_f32_16x16x32_bf16 v[128:131], v[212:215], v[20:23], v[128:131]
v_mfma_f32_16x16x32_bf16 v[132:135], v[208:211], v[48:51], v[132:135]
v_mfma_f32_16x16x32_bf16 v[132:135], v[212:215], v[52:55], v[132:135]
v_mfma_f32_16x16x32_bf16 v[136:139], v[208:211], v[80:83], v[136:139]
v_mfma_f32_16x16x32_bf16 v[136:139], v[212:215], v[84:87], v[136:139]
s_sub_u32 s31, s31, 1
v_mfma_f32_16x16x32_bf16 v[140:143], v[208:211], v[112:115], v[140:143]
ds_read_b128 v[208:211], v240 offset:31232
v_mfma_f32_16x16x32_bf16 v[140:143], v[212:215], v[116:119], v[140:143]
ds_read_b128 v[212:215], v240 offset:30720
s_waitcnt lgkmcnt(2)
v_mfma_f32_16x16x32_bf16 v[128:131], v[216:219], v[24:27], v[128:131]
s_add_u32 s28, s28, s101
s_add_u32 s30, s30, 0x4000
v_mfma_f32_16x16x32_bf16 v[128:131], v[220:223], v[28:31], v[128:131]
s_and_b32 s30, s30, 0x1ffff
v_mfma_f32_16x16x32_bf16 v[132:135], v[216:219], v[56:59], v[132:135]
s_cmp_eq_u32 s31, 0
v_mfma_f32_16x16x32_bf16 v[132:135], v[220:223], v[60:63], v[132:135]
v_mfma_f32_16x16x32_bf16 v[136:139], v[216:219], v[88:91], v[136:139]
v_mfma_f32_16x16x32_bf16 v[136:139], v[220:223], v[92:95], v[136:139]
v_mfma_f32_16x16x32_bf16 v[140:143], v[216:219], v[120:123], v[140:143]
ds_read_b128 v[216:219], v240 offset:18432
v_mfma_f32_16x16x32_bf16 v[140:143], v[220:223], v[124:127], v[140:143]
ds_read_b128 v[220:223], v240 offset:18944
s_cbranch_scc0 L2_loop
s_cmp_eq_u32 s100, 0
s_cbranch_scc1 L2_tail_0
s_mov_b32 s3, 0
s_branch L2_ev
L2_x1:
s_cmp_eq_u32 s100, 0
s_cbranch_scc1 L2_tail_1
s_mov_b32 s3, 1
L2_ev:
s_sub_u32 s100, s100, 1
s_mov_b32 s31, 1
v_mov_b32 v230, 0x20000
s_cmp_eq_u32 s100, 0
s_cbranch_scc1 L2_ev5
s_cmp_lg_u32 s34, 0
s_cbranch_scc1 L2_evr
s_mov_b64 exec, 1
s_cmp_eq_u32 s100, 4
s_cbranch_scc1 L2_ev1
s_cmp_eq_u32 s100, 1
s_cbranch_scc1 L2_ev4
v_cmp_eq_u64 vcc, s[98:99], v[228:229]
s_nop 1
s_bitcmp1_b32 vcc_lo, 0
s_subb_u32 s39, s39, 0
v_mov_b32 v228, s98
v_mov_b32 v229, s99
s_cmp_eq_u32 s100, 2
s_cbranch_scc1 L2_ev3
buffer_atomic_swap_x2 v[228:229], off, s[16:19], s49 offset:0 sc0 sc1
s_branch L2_evx
L2_ev1:
v_mov_b32 v228, s98
v_mov_b32 v229, s99
buffer_atomic_swap_x2 v[228:229], off, s[16:19], s95 offset:16 sc0 sc1
s_branch L2_evx
L2_ev3:
v_mov_b32 v252, s98
v_mov_b32 v253, s99
buffer_atomic_swap_x2 v[228:229], off, s[16:19], s35 offset:0 sc0 sc1
buffer_atomic_swap_x2 v[252:253], off, s[16:19], s94 offset:16 sc0 sc1
s_branch L2_evx
L2_ev4:
v_cmp_ne_u64 vcc, s[98:99], v[228:229]
s_nop 1
s_bitcmp1_b32 vcc_lo, 0
s_addc_u32 s39, s39, 0
v_cmp_ne_u64 vcc, s[98:99], v[252:253]
s_nop 1
s_bitcmp1_b32 vcc_lo, 0
s_addc_u32 s39, s39, 0
v_mov_b32 v228, s39
ds_write_b32 v230, v228
L2_evx:
s_mov_b64 exec, -1
s_branch L2_evr
L2_ev5:
ds_read_b32 v228, v230
s_waitcnt lgkmcnt(0)
v_readfirstlane_b32 s31, v228
L2_evr:
s_cmp_eq_u32 s3, 0
s_cbranch_scc1 L2_loop
s_branch L2_loop1
L2_tail_0:
s_waitcnt lgkmcnt(2)
v_add_u32 v231, s50, v243
v_mfma_f32_16x16x32_bf16 v[144:147], v[208:211], v[0:3], 0
s_mov_b32 m0, s30
ds_write_b128 v231, v[176:179] offset:0
v_mfma_f32_16x16x32_bf16 v[144:147], v[212:215], v[4:7], v[144:147]
buffer_load_dwordx4 v241, s[12:15], s28 offen offset:0 sc1 lds
ds_write_b128 v231, v[180:183] offset:1024
v_mfma_f32_16x16x32_bf16 v[148:151], v[208:211], v[32:35], 0
buffer_load_dwordx4 v241, s[12:15], s28 offen offset:1024 sc1 lds
ds_write_b128 v231, v[184:187] offset:2048
v_mfma_f32_16x16x32_bf16 v[148:151], v[212:215], v[36:39], v[148:151]
buffer_load_dwordx4 v241, s[12:15], s28 offen offset:2048 sc1 lds
ds_write_b128 v231, v[188:191] offset:3072
v_mfma_f32_16x16x32_bf16 v[152:155], v[208:211], v[64:67], 0
buffer_load_dwordx4 v241, s[12:15], s28 offen offset:3072 sc1 lds
v_add_u32 v230, 0x8000, v240
v_and_b32 v230, 0x1ffff, v230
v_mfma_f32_16x16x32_bf16 v[152:155], v[212:215], v[68:71], v[152:155]
v_exp_f32 v232, v128
v_mfma_f32_16x16x32_bf16 v[156:159], v[208:211], v[96:99], 0
ds_read_b128 v[208:211], v240 offset:22528
v_exp_f32 v233, v129
v_mfma_f32_16x16x32_bf16 v[156:159], v[212:215], v[100:103], v[156:159]
ds_read_b128 v[212:215], v240 offset:23040
s_waitcnt lgkmcnt(2)
s_and_b32 s30, s30, 0x1c000
v_mfma_f32_16x16x32_bf16 v[144:147], v[216:219], v[8:11], v[144:147]
v_exp_f32 v234, v130
v_cvt_pk_bf16_f32 v176, v232, v233
v_mfma_f32_16x16x32_bf16 v[144:147], v[220:223], v[12:15], v[144:147]
v_exp_f32 v235, v131
s_add_u32 s28, s30, 0xc000
v_mfma_f32_16x16x32_bf16 v[148:151], v[216:219], v[40:43], v[148:151]
v_exp_f32 v236, v132
v_cvt_pk_bf16_f32 v177, v234, v235
v_mfma_f32_16x16x32_bf16 v[148:151], v[220:223], v[44:47], v[148:151]
v_exp_f32 v237, v133
s_and_b32 s28, s28, 0x1ffff
v_mfma_f32_16x16x32_bf16 v[152:155], v[216:219], v[72:75], v[152:155]
v_exp_f32 v238, v134
v_cvt_pk_bf16_f32 v180, v236, v237
v_mfma_f32_16x16x32_bf16 v[152:155], v[220:223], v[76:79], v[152:155]
v_exp_f32 v239, v135
s_add_u32 s30, s30, 0x4000
v_mfma_f32_16x16x32_bf16 v[156:159], v[216:219], v[104:107], v[156:159]
ds_read_b128 v[216:219], v240 offset:26624
v_exp_f32 v232, v136
v_mfma_f32_16x16x32_bf16 v[156:159], v[220:223], v[108:111], v[156:159]
ds_read_b128 v[220:223], v240 offset:27136
s_waitcnt lgkmcnt(2)
v_cvt_pk_bf16_f32 v181, v238, v239
v_mfma_f32_16x16x32_bf16 v[144:147], v[208:211], v[16:19], v[144:147]
v_exp_f32 v233, v137
s_and_b32 s30, s30, 0x1ffff
v_mfma_f32_16x16x32_bf16 v[144:147], v[212:215], v[20:23], v[144:147]
s_waitcnt vmcnt(4)
s_barrier
s_mul_i32 s31, s34, 6144
v_mfma_f32_16x16x32_bf16 v[148:151], v[208:211], v[48:51], v[148:151]
v_exp_f32 v234, v138
v_cvt_pk_bf16_f32 v184, v232, v233
v_mfma_f32_16x16x32_bf16 v[148:151], v[212:215], v[52:55], v[148:151]
v_exp_f32 v235, v139
s_add_u32 s31, s31, s30
v_mfma_f32_16x16x32_bf16 v[152:155], v[208:211], v[80:83], v[152:155]
v_exp_f32 v236, v140
v_cvt_pk_bf16_f32 v185, v234, v235
v_mfma_f32_16x16x32_bf16 v[152:155], v[212:215], v[84:87], v[152:155]
v_exp_f32 v237, v141
s_lshl_b32 s3, s34, 10
v_mfma_f32_16x16x32_bf16 v[156:159], v[208:211], v[112:115], v[156:159]
ds_read_b128 v[208:211], v230 offset:12800
v_exp_f32 v238, v142
v_mfma_f32_16x16x32_bf16 v[156:159], v[212:215], v[116:119], v[156:159]
ds_read_b128 v[212:215], v230 offset:12288
s_waitcnt lgkmcnt(2)
v_cvt_pk_bf16_f32 v188, v236, v237
v_mfma_f32_16x16x32_bf16 v[144:147], v[216:219], v[24:27], v[144:147]
v_exp_f32 v239, v143
v_or3_b32 v242, v176, v177, v180
v_mfma_f32_16x16x32_bf16 v[144:147], v[220:223], v[28:31], v[144:147]
v_cvt_pk_bf16_f32 v189, v238, v239
v_or3_b32 v242, v242, v181, v184
v_or3_b32 v242, v242, v185, v188
v_mfma_f32_16x16x32_bf16 v[148:151], v[216:219], v[56:59], v[148:151]
v_or_b32 v242, v242, v189
v_lshl_or_b32 v242, v242, 16, v242
v_cmp_le_u32 vcc, 2.0, v242
v_mfma_f32_16x16x32_bf16 v[148:151], v[220:223], v[60:63], v[148:151]
s_add_u32 s28, s28, s3
s_add_u32 s3, s3, 24576
s_add_u32 s30, s30, s3
v_mfma_f32_16x16x32_bf16 v[152:155], v[216:219], v[88:91], v[152:155]
v_lshrrev_b32 v241, 4, v243
v_and_b32 v241, 0x30, v241
v_xor_b32 v241, v241, v243
v_mfma_f32_16x16x32_bf16 v[152:155], v[220:223], v[92:95], v[152:155]
s_cbranch_vccnz L2_rare_site6
L2_ret6:
v_and_b32 v228, 0x380, v243
v_mad_u32_u24 v241, v228, 3, v241
v_mfma_f32_16x16x32_bf16 v[156:159], v[216:219], v[120:123], v[156:159]
ds_read_b128 v[216:219], v230 offset:0
s_add_u32 m0, s31, 0
v_mfma_f32_16x16x32_bf16 v[156:159], v[220:223], v[124:127], v[156:159]
ds_read_b128 v[220:223], v230 offset:512
s_waitcnt lgkmcnt(2)
v_mfma_f32_16x16x32_bf16 v[128:131], v[208:211], v[0:3], 0
buffer_load_dwordx4 v241, s[8:11], s6 offen lds
s_add_u32 m0, s31, 2048
v_mfma_f32_16x16x32_bf16 v[128:131], v[212:215], v[4:7], v[128:131]
v_exp_f32 v232, v144
v_mfma_f32_16x16x32_bf16 v[132:135], v[208:211], v[32:35], 0
v_exp_f32 v233, v145
v_mfma_f32_16x16x32_bf16 v[132:135], v[212:215], v[36:39], v[132:135]
v_exp_f32 v234, v146
v_cvt_pk_bf16_f32 v178, v232, v233
v_mfma_f32_16x16x32_bf16 v[136:139], v[208:211], v[64:67], 0
v_exp_f32 v235, v147
v_mfma_f32_16x16x32_bf16 v[136:139], v[212:215], v[68:71], v[136:139]
v_exp_f32 v236, v148
v_cvt_pk_bf16_f32 v179, v234, v235
v_mfma_f32_16x16x32_bf16 v[140:143], v[208:211], v[96:99], 0
ds_read_b128 v[208:211], v230 offset:4096
v_exp_f32 v237, v149
v_mfma_f32_16x16x32_bf16 v[140:143], v[212:215], v[100:103], v[140:143]
ds_read_b128 v[212:215], v230 offset:4608
s_waitcnt lgkmcnt(2)
v_mfma_f32_16x16x32_bf16 v[128:131], v[216:219], v[8:11], v[128:131]
ds_write_b128 v231, v[160:163] offset:4096
v_exp_f32 v238, v150
v_mfma_f32_16x16x32_bf16 v[128:131], v[220:223], v[12:15], v[128:131]
ds_write_b128 v231, v[164:167] offset:5120
v_cvt_pk_bf16_f32 v182, v236, v237
v_mfma_f32_16x16x32_bf16 v[132:135], v[216:219], v[40:43], v[132:135]
ds_write_b128 v231, v[168:171] offset:6144
v_exp_f32 v239, v151
v_mfma_f32_16x16x32_bf16 v[132:135], v[220:223], v[44:47], v[132:135]
ds_write_b128 v231, v[172:175] offset:7168
v_exp_f32 v232, v152
v_mfma_f32_16x16x32_bf16 v[136:139], v[216:219], v[72:75], v[136:139]
v_cvt_pk_bf16_f32 v183, v238, v239
v_exp_f32 v233, v153
v_mfma_f32_16x16x32_bf16 v[136:139], v[220:223], v[76:79], v[136:139]
v_exp_f32 v234, v154
v_cvt_pk_bf16_f32 v186, v232, v233
v_mfma_f32_16x16x32_bf16 v[140:143], v[216:219], v[104:107], v[140:143]
ds_read_b128 v[216:219], v230 offset:8192
v_exp_f32 v235, v155
v_mfma_f32_16x16x32_bf16 v[140:143], v[220:223], v[108:111], v[140:143]
ds_read_b128 v[220:223], v230 offset:8704
s_waitcnt lgkmcnt(2)
v_mfma_f32_16x16x32_bf16 v[128:131], v[208:211], v[16:19], v[128:131]
v_exp_f32 v236, v156
v_cvt_pk_bf16_f32 v187, v234, v235
v_mfma_f32_16x16x32_bf16 v[128:131], v[212:215], v[20:23], v[128:131]
v_exp_f32 v237, v157
v_mfma_f32_16x16x32_bf16 v[132:135], v[208:211], v[48:51], v[132:135]
v_exp_f32 v238, v158
v_cvt_pk_bf16_f32 v190, v236, v237
v_mfma_f32_16x16x32_bf16 v[132:135], v[212:215], v[52:55], v[132:135]
v_exp_f32 v239, v159
v_or3_b32 v242, v178, v179, v182
v_mfma_f32_16x16x32_bf16 v[136:139], v[208:211], v[80:83], v[136:139]
v_cvt_pk_bf16_f32 v191, v238, v239
v_or3_b32 v242, v242, v183, v186
v_or3_b32 v242, v242, v187, v190
v_mfma_f32_16x16x32_bf16 v[136:139], v[212:215], v[84:87], v[136:139]
v_or_b32 v242, v242, v191
v_lshl_or_b32 v242, v242, 16, v242
v_cmp_le_u32 vcc, 2.0, v242
s_cbranch_vccnz L2_rare_site7
L2_ret7:
v_mfma_f32_16x16x32_bf16 v[140:143], v[208:211], v[112:115], v[140:143]
ds_read_b128 v[208:211], v230 offset:14848
buffer_load_dwordx4 v241, s[8:11], s7 offen lds
s_add_u32 m0, s31, 4096
v_mfma_f32_16x16x32_bf16 v[140:143], v[212:215], v[116:119], v[140:143]
ds_read_b128 v[212:215], v230 offset:14336
s_waitcnt lgkmcnt(2)
v_mfma_f32_16x16x32_bf16 v[128:131], v[216:219], v[24:27], v[128:131]
buffer_load_dwordx4 v241, s[8:11], s29 offen lds
s_add_u32 m0, s31, 1024
v_xor_b32 v241, 0x1040, v241
v_mfma_f32_16x16x32_bf16 v[128:131], v[220:223], v[28:31], v[128:131]
buffer_load_dwordx4 v241, s[8:11], s6 offen lds
s_add_u32 m0, s31, 3072
v_mfma_f32_16x16x32_bf16 v[132:135], v[216:219], v[56:59], v[132:135]
buffer_load_dwordx4 v241, s[8:11], s7 offen lds
s_add_u32 m0, s31, 5120
v_mfma_f32_16x16x32_bf16 v[132:135], v[220:223], v[60:63], v[132:135]
buffer_load_dwordx4 v241, s[8:11], s29 offen lds
v_mfma_f32_16x16x32_bf16 v[136:139], v[216:219], v[88:91], v[136:139]
v_mfma_f32_16x16x32_bf16 v[136:139], v[220:223], v[92:95], v[136:139]
v_mfma_f32_16x16x32_bf16 v[140:143], v[216:219], v[120:123], v[140:143]
ds_read_b128 v[216:219], v230 offset:2048
v_mfma_f32_16x16x32_bf16 v[140:143], v[220:223], v[124:127], v[140:143]
ds_read_b128 v[220:223], v230 offset:2560
s_waitcnt lgkmcnt(2)
v_mfma_f32_16x16x32_bf16 v[144:147], v[208:211], v[0:3], 0
v_mfma_f32_16x16x32_bf16 v[144:147], v[212:215], v[4:7], v[144:147]
v_exp_f32 v232, v128
v_mfma_f32_16x16x32_bf16 v[148:151], v[208:211], v[32:35], 0
v_exp_f32 v233, v129
v_mfma_f32_16x16x32_bf16 v[148:151], v[212:215], v[36:39], v[148:151]
v_exp_f32 v234, v130
v_cvt_pk_bf16_f32 v160, v232, v233
v_mfma_f32_16x16x32_bf16 v[152:155], v[208:211], v[64:67], 0
v_exp_f32 v235, v131
v_mfma_f32_16x16x32_bf16 v[152:155], v[212:215], v[68:71], v[152:155]
v_exp_f32 v236, v132
v_cvt_pk_bf16_f32 v161, v234, v235
v_mfma_f32_16x16x32_bf16 v[156:159], v[208:211], v[96:99], 0
ds_read_b128 v[208:211], v230 offset:6144
v_exp_f32 v237, v133
v_mfma_f32_16x16x32_bf16 v[156:159], v[212:215], v[100:103], v[156:159]
ds_read_b128 v[212:215], v230 offset:6656
s_waitcnt lgkmcnt(2)
v_mfma_f32_16x16x32_bf16 v[144:147], v[216:219], v[8:11], v[144:147]
v_exp_f32 v238, v134
v_cvt_pk_bf16_f32 v164, v236, v237
v_mfma_f32_16x16x32_bf16 v[144:147], v[220:223], v[12:15], v[144:147]
v_exp_f32 v239, v135
v_mfma_f32_16x16x32_bf16 v[148:151], v[216:219], v[40:43], v[148:151]
v_exp_f32 v232, v136
v_cvt_pk_bf16_f32 v165, v238, v239
v_mfma_f32_16x16x32_bf16 v[148:151], v[220:223], v[44:47], v[148:151]
v_exp_f32 v233, v137
v_mfma_f32_16x16x32_bf16 v[152:155], v[216:219], v[72:75], v[152:155]
v_exp_f32 v234, v138
v_cvt_pk_bf16_f32 v168, v232, v233
v_mfma_f32_16x16x32_bf16 v[152:155], v[220:223], v[76:79], v[152:155]
v_exp_f32 v235, v139
v_mfma_f32_16x16x32_bf16 v[156:159], v[216:219], v[104:107], v[156:159]
ds_read_b128 v[216:219], v230 offset:10240
v_exp_f32 v236, v140
v_mfma_f32_16x16x32_bf16 v[156:159], v[220:223], v[108:111], v[156:159]
ds_read_b128 v[220:223], v230 offset:10752
s_waitcnt lgkmcnt(2)
v_cvt_pk_bf16_f32 v169, v234, v235
v_mfma_f32_16x16x32_bf16 v[144:147], v[208:211], v[16:19], v[144:147]
v_exp_f32 v237, v141
v_mfma_f32_16x16x32_bf16 v[144:147], v[212:215], v[20:23], v[144:147]
s_waitcnt vmcnt(6)
s_barrier
v_mfma_f32_16x16x32_bf16 v[148:151], v[208:211], v[48:51], v[148:151]
v_exp_f32 v238, v142
v_cvt_pk_bf16_f32 v172, v236, v237
v_mfma_f32_16x16x32_bf16 v[148:151], v[212:215], v[52:55], v[148:151]
v_exp_f32 v239, v143
v_or3_b32 v242, v160, v161, v164
v_mfma_f32_16x16x32_bf16 v[152:155], v[208:211], v[80:83], v[152:155]
v_cvt_pk_bf16_f32 v173, v238, v239
v_or3_b32 v242, v242, v165, v168
v_or3_b32 v242, v242, v169, v172
v_mfma_f32_16x16x32_bf16 v[152:155], v[212:215], v[84:87], v[152:155]
v_or_b32 v242, v242, v173
v_lshl_or_b32 v242, v242, 16, v242
v_cmp_le_u32 vcc, 2.0, v242
s_cbranch_vccnz L2_rare_site8
L2_ret8:
v_mfma_f32_16x16x32_bf16 v[156:159], v[208:211], v[112:115], v[156:159]
ds_read_b128 v[208:211], v230 offset:29184
v_mfma_f32_16x16x32_bf16 v[156:159], v[212:215], v[116:119], v[156:159]
ds_read_b128 v[212:215], v230 offset:28672
s_waitcnt lgkmcnt(2)
v_mfma_f32_16x16x32_bf16 v[144:147], v[216:219], v[24:27], v[144:147]
v_mfma_f32_16x16x32_bf16 v[144:147], v[220:223], v[28:31], v[144:147]
v_mfma_f32_16x16x32_bf16 v[148:151], v[216:219], v[56:59], v[148:151]
v_mfma_f32_16x16x32_bf16 v[148:151], v[220:223], v[60:63], v[148:151]
v_mfma_f32_16x16x32_bf16 v[152:155], v[216:219], v[88:91], v[152:155]
v_mfma_f32_16x16x32_bf16 v[152:155], v[220:223], v[92:95], v[152:155]
v_mfma_f32_16x16x32_bf16 v[156:159], v[216:219], v[120:123], v[156:159]
ds_read_b128 v[216:219], v230 offset:16384
v_mfma_f32_16x16x32_bf16 v[156:159], v[220:223], v[124:127], v[156:159]
ds_read_b128 v[220:223], v230 offset:16896
s_waitcnt lgkmcnt(2)
v_mfma_f32_16x16x32_bf16 v[128:131], v[208:211], v[0:3], 0
v_mfma_f32_16x16x32_bf16 v[128:131], v[212:215], v[4:7], v[128:131]
v_exp_f32 v232, v144
v_mfma_f32_16x16x32_bf16 v[132:135], v[208:211], v[32:35], 0
v_exp_f32 v233, v145
v_mfma_f32_16x16x32_bf16 v[132:135], v[212:215], v[36:39], v[132:135]
v_exp_f32 v234, v146
v_cvt_pk_bf16_f32 v162, v232, v233
v_mfma_f32_16x16x32_bf16 v[136:139], v[208:211], v[64:67], 0
v_exp_f32 v235, v147
v_lshlrev_b32 v241, 3, v243
v_mfma_f32_16x16x32_bf16 v[136:139], v[212:215], v[68:71], v[136:139]
v_exp_f32 v236, v148
v_cvt_pk_bf16_f32 v163, v234, v235
v_mfma_f32_16x16x32_bf16 v[140:143], v[208:211], v[96:99], 0
ds_read_b128 v[208:211], v230 offset:20480
v_exp_f32 v237, v149
v_mfma_f32_16x16x32_bf16 v[140:143], v[212:215], v[100:103], v[140:143]
ds_read_b128 v[212:215], v230 offset:20992
s_waitcnt lgkmcnt(2)
s_mov_b32 s3, 0x7c28000
v_mfma_f32_16x16x32_bf16 v[128:131], v[216:219], v[8:11], v[128:131]
v_exp_f32 v238, v150
v_cvt_pk_bf16_f32 v166, v236, v237
v_mfma_f32_16x16x32_bf16 v[128:131], v[220:223], v[12:15], v[128:131]
v_exp_f32 v239, v151
buffer_load_dwordx2 v[240:241], v241, s[16:19], s3 offen sc1
v_mfma_f32_16x16x32_bf16 v[132:135], v[216:219], v[40:43], v[132:135]
v_exp_f32 v232, v152
v_cvt_pk_bf16_f32 v167, v238, v239
v_mfma_f32_16x16x32_bf16 v[132:135], v[220:223], v[44:47], v[132:135]
v_exp_f32 v233, v153
v_mfma_f32_16x16x32_bf16 v[136:139], v[216:219], v[72:75], v[136:139]
v_exp_f32 v234, v154
v_cvt_pk_bf16_f32 v170, v232, v233
v_mfma_f32_16x16x32_bf16 v[136:139], v[220:223], v[76:79], v[136:139]
v_exp_f32 v235, v155
v_mfma_f32_16x16x32_bf16 v[140:143], v[216:219], v[104:107], v[140:143]
ds_read_b128 v[216:219], v230 offset:24576
v_exp_f32 v236, v156
v_mfma_f32_16x16x32_bf16 v[140:143], v[220:223], v[108:111], v[140:143]
ds_read_b128 v[220:223], v230 offset:25088
s_waitcnt lgkmcnt(2)
v_cvt_pk_bf16_f32 v171, v234, v235
v_mfma_f32_16x16x32_bf16 v[128:131], v[208:211], v[16:19], v[128:131]
v_exp_f32 v237, v157
v_mfma_f32_16x16x32_bf16 v[128:131], v[212:215], v[20:23], v[128:131]
v_exp_f32 v238, v158
v_cvt_pk_bf16_f32 v174, v236, v237
v_mfma_f32_16x16x32_bf16 v[132:135], v[208:211], v[48:51], v[132:135]
v_exp_f32 v239, v159
v_or3_b32 v242, v162, v163, v166
v_mfma_f32_16x16x32_bf16 v[132:135], v[212:215], v[52:55], v[132:135]
v_cvt_pk_bf16_f32 v175, v238, v239
v_or3_b32 v242, v242, v167, v170
v_or3_b32 v242, v242, v171, v174
v_mfma_f32_16x16x32_bf16 v[136:139], v[208:211], v[80:83], v[136:139]
v_or_b32 v242, v242, v175
v_lshl_or_b32 v242, v242, 16, v242
v_cmp_le_u32 vcc, 2.0, v242
s_cbranch_vccnz L2_rare_site9
L2_ret9:
v_mfma_f32_16x16x32_bf16 v[136:139], v[212:215], v[84:87], v[136:139]
v_mfma_f32_16x16x32_bf16 v[140:143], v[208:211], v[112:115], v[140:143]
ds_read_b128 v[208:211], v230 offset:31232
v_mfma_f32_16x16x32_bf16 v[140:143], v[212:215], v[116:119], v[140:143]
ds_read_b128 v[212:215], v230 offset:30720
s_waitcnt lgkmcnt(2)
v_mfma_f32_16x16x32_bf16 v[128:131], v[216:219], v[24:27], v[128:131]
v_mfma_f32_16x16x32_bf16 v[128:131], v[220:223], v[28:31], v[128:131]
v_mfma_f32_16x16x32_bf16 v[132:135], v[216:219], v[56:59], v[132:135]
v_mfma_f32_16x16x32_bf16 v[132:135], v[220:223], v[60:63], v[132:135]
v_mfma_f32_16x16x32_bf16 v[136:139], v[216:219], v[88:91], v[136:139]
v_mfma_f32_16x16x32_bf16 v[136:139], v[220:223], v[92:95], v[136:139]
v_mfma_f32_16x16x32_bf16 v[140:143], v[216:219], v[120:123], v[140:143]
ds_read_b128 v[216:219], v230 offset:18432
v_mfma_f32_16x16x32_bf16 v[140:143], v[220:223], v[124:127], v[140:143]
ds_read_b128 v[220:223], v230 offset:18944
s_waitcnt lgkmcnt(2)
v_mfma_f32_16x16x32_bf16 v[144:147], v[208:211], v[0:3], 0
v_mfma_f32_16x16x32_bf16 v[144:147], v[212:215], v[4:7], v[144:147]
v_mfma_f32_16x16x32_bf16 v[148:151], v[208:211], v[32:35], 0
v_mfma_f32_16x16x32_bf16 v[148:151], v[212:215], v[36:39], v[148:151]
v_mfma_f32_16x16x32_bf16 v[152:155], v[208:211], v[64:67], 0
v_exp_f32 v232, v128
v_mfma_f32_16x16x32_bf16 v[152:155], v[212:215], v[68:71], v[152:155]
v_exp_f32 v233, v129
v_mfma_f32_16x16x32_bf16 v[156:159], v[208:211], v[96:99], 0
ds_read_b128 v[208:211], v230 offset:22528
v_exp_f32 v234, v130
v_mfma_f32_16x16x32_bf16 v[156:159], v[212:215], v[100:103], v[156:159]
ds_read_b128 v[212:215], v230 offset:23040
s_waitcnt lgkmcnt(2)
v_cvt_pk_bf16_f32 v0, v232, v233
v_mfma_f32_16x16x32_bf16 v[144:147], v[216:219], v[8:11], v[144:147]
v_exp_f32 v235, v131
v_mfma_f32_16x16x32_bf16 v[144:147], v[220:223], v[12:15], v[144:147]
ds_read_b128 v[4:7], v231 offset:0
v_exp_f32 v236, v132
v_mfma_f32_16x16x32_bf16 v[148:151], v[216:219], v[40:43], v[148:151]
ds_read_b128 v[36:39], v231 offset:1024
v_cvt_pk_bf16_f32 v1, v234, v235
v_mfma_f32_16x16x32_bf16 v[148:151], v[220:223], v[44:47], v[148:151]
v_exp_f32 v237, v133
v_mfma_f32_16x16x32_bf16 v[152:155], v[216:219], v[72:75], v[152:155]
v_exp_f32 v238, v134
v_cvt_pk_bf16_f32 v32, v236, v237
v_mfma_f32_16x16x32_bf16 v[152:155], v[220:223], v[76:79], v[152:155]
ds_read_b128 v[68:71], v231 offset:2048
ds_read_b128 v[8:11], v231 offset:4096
v_mfma_f32_16x16x32_bf16 v[156:159], v[216:219], v[104:107], v[156:159]
ds_read_b128 v[216:219], v230 offset:26624
v_add_u32 v12, 0x8000, v244
v_and_b32 v12, 0x1ffff, v12
ds_read_b128 v[100:103], v231 offset:3072
ds_read_b128 v[40:43], v231 offset:5120
v_mfma_f32_16x16x32_bf16 v[156:159], v[220:223], v[108:111], v[156:159]
ds_read_b128 v[220:223], v230 offset:27136
s_waitcnt lgkmcnt(2)
v_add_u32 v14, 0x10000, v244
v_and_b32 v14, 0x1ffff, v14
v_mfma_f32_16x16x32_bf16 v[144:147], v[208:211], v[16:19], v[144:147]
v_xor_b32 v13, 32, v12
v_xor_b32 v15, 32, v14
v_mfma_f32_16x16x32_bf16 v[144:147], v[212:215], v[20:23], v[144:147]
ds_read_b128 v[72:75], v231 offset:6144
v_exp_f32 v239, v135
v_mfma_f32_16x16x32_bf16 v[148:151], v[208:211], v[48:51], v[148:151]
ds_read_b128 v[104:107], v231 offset:7168
v_exp_f32 v232, v136
v_mfma_f32_16x16x32_bf16 v[148:151], v[212:215], v[52:55], v[148:151]
v_cvt_pk_bf16_f32 v33, v238, v239
v_exp_f32 v233, v137
v_mfma_f32_16x16x32_bf16 v[152:155], v[208:211], v[80:83], v[152:155]
v_exp_f32 v234, v138
v_cvt_pk_bf16_f32 v64, v232, v233
v_mfma_f32_16x16x32_bf16 v[152:155], v[212:215], v[84:87], v[152:155]
v_exp_f32 v235, v139
v_mfma_f32_16x16x32_bf16 v[156:159], v[208:211], v[112:115], v[156:159]
ds_read_b64_tr_b16 v[208:209], v12 offset:12800
ds_read_b64_tr_b16 v[210:211], v12 offset:14848
v_mfma_f32_16x16x32_bf16 v[156:159], v[212:215], v[116:119], v[156:159]
ds_read_b64_tr_b16 v[212:213], v12 offset:29184
s_waitcnt lgkmcnt(3)
v_mfma_f32_16x16x32_bf16 v[144:147], v[216:219], v[24:27], v[144:147]
ds_read_b64_tr_b16 v[214:215], v12 offset:31232
v_exp_f32 v236, v140
v_mfma_f32_16x16x32_bf16 v[144:147], v[220:223], v[28:31], v[144:147]
v_cvt_pk_bf16_f32 v65, v234, v235
v_exp_f32 v237, v141
v_mfma_f32_16x16x32_bf16 v[148:151], v[216:219], v[56:59], v[148:151]
v_exp_f32 v238, v142
v_cvt_pk_bf16_f32 v96, v236, v237
v_mfma_f32_16x16x32_bf16 v[148:151], v[220:223], v[60:63], v[148:151]
v_exp_f32 v239, v143
v_or3_b32 v242, v0, v1, v32
v_mfma_f32_16x16x32_bf16 v[152:155], v[216:219], v[88:91], v[152:155]
v_cvt_pk_bf16_f32 v97, v238, v239
v_or3_b32 v242, v242, v33, v64
v_or3_b32 v242, v242, v65, v96
v_mfma_f32_16x16x32_bf16 v[152:155], v[220:223], v[92:95], v[152:155]
v_or_b32 v242, v242, v97
v_lshl_or_b32 v242, v242, 16, v242
v_cmp_le_u32 vcc, 2.0, v242
s_cbranch_vccnz L2_rare_site10
L2_ret10:
v_mfma_f32_16x16x32_bf16 v[156:159], v[216:219], v[120:123], v[156:159]
ds_read_b64_tr_b16 v[216:217], v14 offset:12800
ds_read_b64_tr_b16 v[218:219], v14 offset:14848
s_waitcnt vmcnt(0)
v_mfma_f32_16x16x32_bf16 v[156:159], v[220:223], v[124:127], v[156:159]
ds_read_b64_tr_b16 v[220:221], v13 offset:12800
s_waitcnt lgkmcnt(3)
v_cmp_ne_u64_e64 s[38:39], s[98:99], v[240:241]
v_mfma_f32_16x16x32_bf16 a[224:227], v[8:11], v[208:211], a[224:227]
ds_read_b64_tr_b16 v[222:223], v13 offset:14848
s_and_b64 s[38:39], s[38:39], s[96:97]
s_cbranch_scc1 LF_hl_1
LF_hlret_1:
v_mfma_f32_16x16x32_bf16 a[224:227], v[176:179], v[212:215], a[224:227]
v_exp_f32 v232, v144
v_lshrrev_b32 v241, 4, v243
v_mfma_f32_16x16x32_bf16 a[228:231], v[40:43], v[208:211], a[228:231]
v_exp_f32 v233, v145
v_and_b32 v241, 0x30, v241
v_mfma_f32_16x16x32_bf16 a[228:231], v[180:183], v[212:215], a[228:231]
v_exp_f32 v234, v146
v_xor_b32 v241, v241, v243
v_mfma_f32_16x16x32_bf16 a[232:235], v[72:75], v[208:211], a[232:235]
v_cvt_pk_bf16_f32 v2, v232, v233
v_and_b32 v228, 0x380, v243
v_mad_u32_u24 v241, v228, 3, v241
v_mfma_f32_16x16x32_bf16 a[232:235], v[184:187], v[212:215], a[232:235]
v_exp_f32 v235, v147
v_add_u32 v241, 0x7000000, v241
v_mfma_f32_16x16x32_bf16 a[236:239], v[104:107], v[208:211], a[236:239]
ds_read_b64_tr_b16 v[208:209], v13 offset:29184
ds_read_b64_tr_b16 v[210:211], v13 offset:31232
v_and_b32 v110, 0x70, v243
v_mfma_f32_16x16x32_bf16 a[236:239], v[188:191], v[212:215], a[236:239]
ds_read_b64_tr_b16 v[212:213], v15 offset:12800
s_waitcnt lgkmcnt(5)
v_lshlrev_b32 v110, 3, v110
v_mfma_f32_16x16x32_bf16 a[224:227], v[160:163], v[216:219], a[224:227]
ds_read_b64_tr_b16 v[214:215], v15 offset:14848
v_add_u32 v110, 0x7c32000, v110
buffer_load_dwordx2 v[108:109], v110, s[16:19], 0 offen sc1
v_mfma_f32_16x16x32_bf16 a[228:231], v[164:167], v[216:219], a[228:231]
v_exp_f32 v236, v148
v_mfma_f32_16x16x32_bf16 a[232:235], v[168:171], v[216:219], a[232:235]
v_cvt_pk_bf16_f32 v3, v234, v235
s_add_u32 m0, s28, 0
v_mfma_f32_16x16x32_bf16 a[236:239], v[172:175], v[216:219], a[236:239]
ds_read_b64_tr_b16 v[216:217], v244 offset:16384
s_waitcnt lgkmcnt(5)
v_mfma_f32_16x16x32_bf16 a[240:243], v[8:11], v[220:223], a[240:243]
ds_read_b64_tr_b16 v[218:219], v244 offset:18432
buffer_load_dwordx4 v241, s[16:19], s6 offen sc1 lds
s_add_u32 m0, s28, 8192
v_mfma_f32_16x16x32_bf16 a[244:247], v[40:43], v[220:223], a[244:247]
v_exp_f32 v237, v149
v_mfma_f32_16x16x32_bf16 a[248:251], v[72:75], v[220:223], a[248:251]
v_exp_f32 v238, v150
v_mfma_f32_16x16x32_bf16 a[252:255], v[104:107], v[220:223], a[252:255]
ds_read_b64_tr_b16 v[220:221], v12 offset:0
s_waitcnt lgkmcnt(3)
v_mfma_f32_16x16x32_bf16 a[240:243], v[176:179], v[208:211], a[240:243]
ds_read_b64_tr_b16 v[222:223], v12 offset:2048
v_cvt_pk_bf16_f32 v34, v236, v237
v_mfma_f32_16x16x32_bf16 a[240:243], v[160:163], v[212:215], a[240:243]
v_exp_f32 v239, v151
v_mfma_f32_16x16x32_bf16 a[244:247], v[180:183], v[208:211], a[244:247]
v_exp_f32 v232, v152
v_mfma_f32_16x16x32_bf16 a[244:247], v[164:167], v[212:215], a[244:247]
v_cvt_pk_bf16_f32 v35, v238, v239
buffer_load_dwordx4 v241, s[16:19], s7 offen sc1 lds
s_add_u32 m0, s30, 0
v_mfma_f32_16x16x32_bf16 a[248:251], v[184:187], v[208:211], a[248:251]
v_exp_f32 v233, v153
v_mfma_f32_16x16x32_bf16 a[248:251], v[168:171], v[212:215], a[248:251]
v_exp_f32 v234, v154
v_mfma_f32_16x16x32_bf16 a[252:255], v[188:191], v[208:211], a[252:255]
ds_read_b64_tr_b16 v[208:209], v12 offset:16384
ds_read_b64_tr_b16 v[210:211], v12 offset:18432
v_mfma_f32_16x16x32_bf16 a[252:255], v[172:175], v[212:215], a[252:255]
ds_read_b64_tr_b16 v[212:213], v14 offset:0
s_waitcnt lgkmcnt(3)
v_mfma_f32_16x16x32_bf16 a[0:3], v[4:7], v[216:219], a[0:3]
ds_read_b64_tr_b16 v[214:215], v14 offset:2048
v_cvt_pk_bf16_f32 v66, v232, v233
v_mfma_f32_16x16x32_bf16 a[0:3], v[8:11], v[220:223], a[0:3]
v_exp_f32 v235, v155
v_mfma_f32_16x16x32_bf16 a[4:7], v[36:39], v[216:219], a[4:7]
v_exp_f32 v236, v156
v_mfma_f32_16x16x32_bf16 a[4:7], v[40:43], v[220:223], a[4:7]
v_cvt_pk_bf16_f32 v67, v234, v235
buffer_load_dwordx4 v241, s[16:19], s29 offen sc1 lds
s_add_u32 m0, s28, 4096
v_mfma_f32_16x16x32_bf16 a[8:11], v[68:71], v[216:219], a[8:11]
v_exp_f32 v237, v157
v_xor_b32 v241, 0x1040, v241
v_mfma_f32_16x16x32_bf16 a[8:11], v[72:75], v[220:223], a[8:11]
v_exp_f32 v238, v158
v_mfma_f32_16x16x32_bf16 a[12:15], v[100:103], v[216:219], a[12:15]
ds_read_b64_tr_b16 v[216:217], v245 offset:16384
ds_read_b64_tr_b16 v[218:219], v245 offset:18432
v_mfma_f32_16x16x32_bf16 a[12:15], v[104:107], v[220:223], a[12:15]
ds_read_b64_tr_b16 v[220:221], v13 offset:0
s_waitcnt lgkmcnt(3)
v_mfma_f32_16x16x32_bf16 a[0:3], v[176:179], v[208:211], a[0:3]
ds_read_b64_tr_b16 v[222:223], v13 offset:2048
v_cvt_pk_bf16_f32 v98, v236, v237
v_mfma_f32_16x16x32_bf16 a[0:3], v[160:163], v[212:215], a[0:3]
v_exp_f32 v239, v159
v_mfma_f32_16x16x32_bf16 a[4:7], v[180:183], v[208:211], a[4:7]
v_or3_b32 v242, v2, v3, v34
v_cvt_pk_bf16_f32 v99, v238, v239
v_mfma_f32_16x16x32_bf16 a[4:7], v[164:167], v[212:215], a[4:7]
v_or3_b32 v242, v242, v35, v66
v_or3_b32 v242, v242, v67, v98
v_mfma_f32_16x16x32_bf16 a[8:11], v[184:187], v[208:211], a[8:11]
v_or_b32 v242, v242, v99
v_lshl_or_b32 v242, v242, 16, v242
v_mfma_f32_16x16x32_bf16 a[8:11], v[168:171], v[212:215], a[8:11]
v_cmp_le_u32 vcc, 2.0, v242
s_cbranch_vccnz L2_rare_site11
L2_ret11:
v_mfma_f32_16x16x32_bf16 a[12:15], v[188:191], v[208:211], a[12:15]
ds_read_b64_tr_b16 v[208:209], v13 offset:16384
ds_read_b64_tr_b16 v[210:211], v13 offset:18432
v_mfma_f32_16x16x32_bf16 a[12:15], v[172:175], v[212:215], a[12:15]
ds_read_b64_tr_b16 v[212:213], v15 offset:0
s_waitcnt lgkmcnt(3)
v_mfma_f32_16x16x32_bf16 a[16:19], v[4:7], v[216:219], a[16:19]
ds_read_b64_tr_b16 v[214:215], v15 offset:2048
buffer_load_dwordx4 v241, s[16:19], s6 offen sc1 lds
s_add_u32 m0, s28, 12288
v_mfma_f32_16x16x32_bf16 a[16:19], v[8:11], v[220:223], a[16:19]
buffer_load_dwordx4 v241, s[16:19], s7 offen sc1 lds
s_add_u32 m0, s30, 4096
v_mfma_f32_16x16x32_bf16 a[20:23], v[36:39], v[216:219], a[20:23]
buffer_load_dwordx4 v241, s[16:19], s29 offen sc1 lds
v_mfma_f32_16x16x32_bf16 a[20:23], v[40:43], v[220:223], a[20:23]
v_mfma_f32_16x16x32_bf16 a[24:27], v[68:71], v[216:219], a[24:27]
v_mfma_f32_16x16x32_bf16 a[24:27], v[72:75], v[220:223], a[24:27]
v_mfma_f32_16x16x32_bf16 a[28:31], v[100:103], v[216:219], a[28:31]
ds_read_b64_tr_b16 v[216:217], v14 offset:29184
ds_read_b64_tr_b16 v[218:219], v14 offset:31232
v_mfma_f32_16x16x32_bf16 a[28:31], v[104:107], v[220:223], a[28:31]
ds_read_b64_tr_b16 v[220:221], v15 offset:29184
s_waitcnt lgkmcnt(3)
v_mfma_f32_16x16x32_bf16 a[16:19], v[176:179], v[208:211], a[16:19]
ds_read_b64_tr_b16 v[222:223], v15 offset:31232
v_mfma_f32_16x16x32_bf16 a[16:19], v[160:163], v[212:215], a[16:19]
v_mfma_f32_16x16x32_bf16 a[20:23], v[180:183], v[208:211], a[20:23]
v_mfma_f32_16x16x32_bf16 a[20:23], v[164:167], v[212:215], a[20:23]
v_mfma_f32_16x16x32_bf16 a[24:27], v[184:187], v[208:211], a[24:27]
v_mfma_f32_16x16x32_bf16 a[24:27], v[168:171], v[212:215], a[24:27]
v_mfma_f32_16x16x32_bf16 a[28:31], v[188:191], v[208:211], a[28:31]
ds_read_b64_tr_b16 v[208:209], v14 offset:16384
ds_read_b64_tr_b16 v[210:211], v14 offset:18432
v_mfma_f32_16x16x32_bf16 a[28:31], v[172:175], v[212:215], a[28:31]
ds_read_b64_tr_b16 v[212:213], v15 offset:16384
s_waitcnt lgkmcnt(5)
v_mfma_f32_16x16x32_bf16 a[224:227], v[0:3], v[216:219], a[224:227]
ds_read_b64_tr_b16 v[214:215], v15 offset:18432
v_lshrrev_b32 v228, 4, v243
v_and_b32 v228, 0x3c, v228
v_mfma_f32_16x16x32_bf16 a[228:231], v[32:35], v[216:219], a[228:231]
v_sub_f32 v224, 0, v224
v_sub_f32 v225, 0, v225
v_sub_f32 v226, 0, v226
v_mfma_f32_16x16x32_bf16 a[232:235], v[64:67], v[216:219], a[232:235]
v_sub_f32 v227, 0, v227
ds_bpermute_b32 v232, v228, v224
ds_bpermute_b32 v234, v228, v225
v_mfma_f32_16x16x32_bf16 a[236:239], v[96:99], v[216:219], a[236:239]
ds_read_b64_tr_b16 v[216:217], v244 offset:16896
s_waitcnt lgkmcnt(5)
ds_bpermute_b32 v236, v228, v226
v_mfma_f32_16x16x32_bf16 a[240:243], v[0:3], v[220:223], a[240:243]
ds_read_b64_tr_b16 v[218:219], v244 offset:18944
ds_bpermute_b32 v238, v228, v227
v_bfe_u32 v228, v243, 4, 1
v_mfma_f32_16x16x32_bf16 a[244:247], v[32:35], v[220:223], a[244:247]
v_mul_u32_u24 v228, 768, v228
v_lshl_add_u32 v228, s37, 7, v228
v_lshrrev_b32 v242, 6, v243
v_mfma_f32_16x16x32_bf16 a[248:251], v[64:67], v[220:223], a[248:251]
v_lshl_add_u32 v242, v242, 3, v228
v_accvgpr_read_b32 v128, a224
v_accvgpr_read_b32 v129, a225
v_mfma_f32_16x16x32_bf16 a[252:255], v[96:99], v[220:223], a[252:255]
ds_read_b64_tr_b16 v[220:221], v12 offset:512
s_waitcnt lgkmcnt(5)
v_accvgpr_read_b32 v130, a226
v_mfma_f32_16x16x32_bf16 a[0:3], v[0:3], v[208:211], a[0:3]
ds_read_b64_tr_b16 v[222:223], v12 offset:2560
v_accvgpr_read_b32 v131, a227
v_cvt_pk_bf16_f32 v28, v128, v129
v_mfma_f32_16x16x32_bf16 a[4:7], v[32:35], v[208:211], a[4:7]
v_cvt_pk_bf16_f32 v29, v130, v131
v_accvgpr_read_b32 v136, a228
v_accvgpr_read_b32 v137, a229
v_mfma_f32_16x16x32_bf16 a[8:11], v[64:67], v[208:211], a[8:11]
v_accvgpr_read_b32 v138, a230
v_accvgpr_read_b32 v139, a231
v_cvt_pk_bf16_f32 v60, v136, v137
v_mfma_f32_16x16x32_bf16 a[12:15], v[96:99], v[208:211], a[12:15]
ds_read_b64_tr_b16 v[208:209], v12 offset:16896
s_waitcnt lgkmcnt(5)
v_cvt_pk_bf16_f32 v61, v138, v139
v_mfma_f32_16x16x32_bf16 a[16:19], v[0:3], v[212:215], a[16:19]
ds_read_b64_tr_b16 v[210:211], v12 offset:18944
v_accvgpr_read_b32 v144, a232
v_accvgpr_read_b32 v145, a233
v_mfma_f32_16x16x32_bf16 a[20:23], v[32:35], v[212:215], a[20:23]
v_accvgpr_read_b32 v146, a234
v_accvgpr_read_b32 v147, a235
v_cvt_pk_bf16_f32 v92, v144, v145
v_mfma_f32_16x16x32_bf16 a[24:27], v[64:67], v[212:215], a[24:27]
v_cvt_pk_bf16_f32 v93, v146, v147
v_accvgpr_read_b32 v152, a236
v_accvgpr_read_b32 v153, a237
v_mfma_f32_16x16x32_bf16 a[28:31], v[96:99], v[212:215], a[28:31]
ds_read_b64_tr_b16 v[212:213], v14 offset:512
s_waitcnt lgkmcnt(3)
v_accvgpr_read_b32 v154, a238
v_mfma_f32_16x16x32_bf16 a[32:35], v[4:7], v[216:219], a[32:35]
ds_read_b64_tr_b16 v[214:215], v14 offset:2560
v_accvgpr_read_b32 v155, a239
v_cvt_pk_bf16_f32 v124, v152, v153
v_mfma_f32_16x16x32_bf16 a[32:35], v[8:11], v[220:223], a[32:35]
v_cvt_pk_bf16_f32 v125, v154, v155
v_accvgpr_read_b32 v132, a240
v_accvgpr_read_b32 v133, a241
v_mfma_f32_16x16x32_bf16 a[36:39], v[36:39], v[216:219], a[36:39]
v_accvgpr_read_b32 v134, a242
v_accvgpr_read_b32 v135, a243
v_cvt_pk_bf16_f32 v30, v132, v133
v_mfma_f32_16x16x32_bf16 a[36:39], v[40:43], v[220:223], a[36:39]
v_cvt_pk_bf16_f32 v31, v134, v135
buffer_store_dwordx4 v[28:31], v243, s[20:23], s44 offen offset:3072 sc1
ds_write_b128 v231, v[28:31] offset:7168
v_mfma_f32_16x16x32_bf16 a[40:43], v[68:71], v[216:219], a[40:43]
v_accvgpr_read_b32 v140, a244
v_accvgpr_read_b32 v141, a245
v_accvgpr_read_b32 v142, a246
v_mfma_f32_16x16x32_bf16 a[40:43], v[72:75], v[220:223], a[40:43]
v_accvgpr_read_b32 v143, a247
v_cvt_pk_bf16_f32 v62, v140, v141
v_cvt_pk_bf16_f32 v63, v142, v143
v_mfma_f32_16x16x32_bf16 a[44:47], v[100:103], v[216:219], a[44:47]
ds_read_b64_tr_b16 v[216:217], v14 offset:16896
ds_read_b64_tr_b16 v[218:219], v14 offset:18944
buffer_store_dwordx4 v[60:63], v243, s[20:23], s45 offen offset:3072 sc1
v_mfma_f32_16x16x32_bf16 a[44:47], v[104:107], v[220:223], a[44:47]
ds_read_b64_tr_b16 v[220:221], v245 offset:16896
s_waitcnt lgkmcnt(3)
v_accvgpr_read_b32 v148, a248
v_mfma_f32_16x16x32_bf16 a[32:35], v[176:179], v[208:211], a[32:35]
ds_read_b64_tr_b16 v[222:223], v245 offset:18944
v_accvgpr_read_b32 v149, a249
v_accvgpr_read_b32 v150, a250
v_mfma_f32_16x16x32_bf16 a[32:35], v[160:163], v[212:215], a[32:35]
v_accvgpr_read_b32 v151, a251
v_cvt_pk_bf16_f32 v94, v148, v149
v_cvt_pk_bf16_f32 v95, v150, v151
v_mfma_f32_16x16x32_bf16 a[36:39], v[180:183], v[208:211], a[36:39]
buffer_store_dwordx4 v[92:95], v243, s[20:23], s46 offen offset:3072 sc1
v_accvgpr_read_b32 v156, a252
v_accvgpr_read_b32 v157, a253
v_mfma_f32_16x16x32_bf16 a[36:39], v[164:167], v[212:215], a[36:39]
v_accvgpr_read_b32 v158, a254
v_accvgpr_read_b32 v159, a255
v_cvt_pk_bf16_f32 v126, v156, v157
v_mfma_f32_16x16x32_bf16 a[40:43], v[184:187], v[208:211], a[40:43]
v_cvt_pk_bf16_f32 v127, v158, v159
buffer_store_dwordx4 v[124:127], v243, s[20:23], s47 offen offset:3072 sc1
v_mov_b32_dpp v233, v132 row_newbcast:15 row_mask:0xf bank_mask:0x1
v_mfma_f32_16x16x32_bf16 a[40:43], v[168:171], v[212:215], a[40:43]
v_mov_b32_dpp v235, v140 row_newbcast:15 row_mask:0xf bank_mask:0x1
v_mov_b32_dpp v237, v148 row_newbcast:15 row_mask:0xf bank_mask:0x1
v_mov_b32_dpp v239, v156 row_newbcast:15 row_mask:0xf bank_mask:0x1
v_mfma_f32_16x16x32_bf16 a[44:47], v[188:191], v[208:211], a[44:47]
ds_read_b64_tr_b16 v[208:209], v13 offset:512
ds_read_b64_tr_b16 v[210:211], v13 offset:2560
v_mov_b32_dpp v233, v133 row_newbcast:15 row_mask:0xf bank_mask:0x2
v_mfma_f32_16x16x32_bf16 a[44:47], v[172:175], v[212:215], a[44:47]
ds_read_b64_tr_b16 v[212:213], v13 offset:16896
s_waitcnt lgkmcnt(5)
v_mov_b32_dpp v235, v141 row_newbcast:15 row_mask:0xf bank_mask:0x2
v_mfma_f32_16x16x32_bf16 a[32:35], v[0:3], v[216:219], a[32:35]
ds_read_b64_tr_b16 v[214:215], v13 offset:18944
v_mov_b32_dpp v237, v149 row_newbcast:15 row_mask:0xf bank_mask:0x2
v_mov_b32_dpp v239, v157 row_newbcast:15 row_mask:0xf bank_mask:0x2
v_mfma_f32_16x16x32_bf16 a[36:39], v[32:35], v[216:219], a[36:39]
v_mov_b32_dpp v233, v134 row_newbcast:15 row_mask:0xf bank_mask:0x4
v_mov_b32_dpp v235, v142 row_newbcast:15 row_mask:0xf bank_mask:0x4
v_mov_b32_dpp v237, v150 row_newbcast:15 row_mask:0xf bank_mask:0x4
v_mfma_f32_16x16x32_bf16 a[40:43], v[64:67], v[216:219], a[40:43]
v_mov_b32_dpp v239, v158 row_newbcast:15 row_mask:0xf bank_mask:0x4
v_mov_b32_dpp v233, v135 row_newbcast:15 row_mask:0xf bank_mask:0x8
v_mov_b32_dpp v235, v143 row_newbcast:15 row_mask:0xf bank_mask:0x8
v_mfma_f32_16x16x32_bf16 a[44:47], v[96:99], v[216:219], a[44:47]
ds_read_b64_tr_b16 v[216:217], v15 offset:512
s_waitcnt lgkmcnt(5)
v_mov_b32_dpp v237, v151 row_newbcast:15 row_mask:0xf bank_mask:0x8
v_mfma_f32_16x16x32_bf16 a[48:51], v[4:7], v[220:223], a[48:51]
ds_read_b64_tr_b16 v[218:219], v15 offset:2560
v_mov_b32_dpp v239, v159 row_newbcast:15 row_mask:0xf bank_mask:0x8
v_mfma_f32_16x16x32_bf16 a[52:55], v[36:39], v[220:223], a[52:55]
s_mov_b32 exec_lo, 0x33333333
s_mov_b32 exec_hi, 0x33333333
buffer_store_dwordx2 v[232:233], v242, s[24:27], s48 offen sc1
s_lshr_b32 s3, s41, 2
buffer_store_dwordx2 v[234:235], v242, s[24:27], s3 offen sc1
s_lshr_b32 s3, s42, 2
buffer_store_dwordx2 v[236:237], v242, s[24:27], s3 offen sc1
s_lshr_b32 s3, s43, 2
buffer_store_dwordx2 v[238:239], v242, s[24:27], s3 offen sc1
s_mov_b64 exec, -1
v_mfma_f32_16x16x32_bf16 a[56:59], v[68:71], v[220:223], a[56:59]
v_accvgpr_read_b32 v128, a0
v_accvgpr_read_b32 v129, a1
v_accvgpr_read_b32 v130, a2
v_mfma_f32_16x16x32_bf16 a[60:63], v[100:103], v[220:223], a[60:63]
ds_read_b64_tr_b16 v[220:221], v15 offset:16896
s_waitcnt lgkmcnt(3)
v_accvgpr_read_b32 v131, a3
v_mfma_f32_16x16x32_bf16 a[48:51], v[8:11], v[208:211], a[48:51]
ds_read_b64_tr_b16 v[222:223], v15 offset:18944
v_cvt_pk_bf16_f32 v16, v128, v129
v_cvt_pk_bf16_f32 v17, v130, v131
v_mfma_f32_16x16x32_bf16 a[48:51], v[176:179], v[212:215], a[48:51]
v_accvgpr_read_b32 v136, a4
v_accvgpr_read_b32 v137, a5
v_accvgpr_read_b32 v138, a6
v_mfma_f32_16x16x32_bf16 a[52:55], v[40:43], v[208:211], a[52:55]
v_accvgpr_read_b32 v139, a7
v_cvt_pk_bf16_f32 v48, v136, v137
v_cvt_pk_bf16_f32 v49, v138, v139
v_mfma_f32_16x16x32_bf16 a[52:55], v[180:183], v[212:215], a[52:55]
v_accvgpr_read_b32 v144, a8
v_accvgpr_read_b32 v145, a9
v_accvgpr_read_b32 v146, a10
v_mfma_f32_16x16x32_bf16 a[56:59], v[72:75], v[208:211], a[56:59]
v_accvgpr_read_b32 v147, a11
v_cvt_pk_bf16_f32 v80, v144, v145
v_cvt_pk_bf16_f32 v81, v146, v147
v_mfma_f32_16x16x32_bf16 a[56:59], v[184:187], v[212:215], a[56:59]
v_accvgpr_read_b32 v152, a12
v_accvgpr_read_b32 v153, a13
v_accvgpr_read_b32 v154, a14
v_mfma_f32_16x16x32_bf16 a[60:63], v[104:107], v[208:211], a[60:63]
ds_read_b64_tr_b16 v[208:209], v244 offset:20480
ds_read_b64_tr_b16 v[210:211], v244 offset:22528
v_accvgpr_read_b32 v155, a15
v_mfma_f32_16x16x32_bf16 a[60:63], v[188:191], v[212:215], a[60:63]
ds_read_b64_tr_b16 v[212:213], v12 offset:4096
s_waitcnt lgkmcnt(3)
v_cvt_pk_bf16_f32 v112, v152, v153
v_mfma_f32_16x16x32_bf16 a[48:51], v[160:163], v[216:219], a[48:51]
ds_read_b64_tr_b16 v[214:215], v12 offset:6144
v_cvt_pk_bf16_f32 v113, v154, v155
v_accvgpr_read_b32 v132, a16
v_mfma_f32_16x16x32_bf16 a[48:51], v[0:3], v[220:223], a[48:51]
v_accvgpr_read_b32 v133, a17
v_accvgpr_read_b32 v134, a18
v_accvgpr_read_b32 v135, a19
v_mfma_f32_16x16x32_bf16 a[52:55], v[164:167], v[216:219], a[52:55]
v_cvt_pk_bf16_f32 v18, v132, v133
v_cvt_pk_bf16_f32 v19, v134, v135
buffer_store_dwordx4 v[16:19], v243, s[20:23], s40 offen offset:0 sc1
v_mfma_f32_16x16x32_bf16 a[52:55], v[32:35], v[220:223], a[52:55]
ds_write_b128 v231, v[16:19] offset:0
v_accvgpr_read_b32 v140, a20
v_accvgpr_read_b32 v141, a21
v_mfma_f32_16x16x32_bf16 a[56:59], v[168:171], v[216:219], a[56:59]
v_accvgpr_read_b32 v142, a22
v_accvgpr_read_b32 v143, a23
v_cvt_pk_bf16_f32 v50, v140, v141
v_mfma_f32_16x16x32_bf16 a[56:59], v[64:67], v[220:223], a[56:59]
v_cvt_pk_bf16_f32 v51, v142, v143
buffer_store_dwordx4 v[48:51], v243, s[20:23], s41 offen offset:0 sc1
v_accvgpr_read_b32 v148, a24
v_mfma_f32_16x16x32_bf16 a[60:63], v[172:175], v[216:219], a[60:63]
ds_read_b64_tr_b16 v[216:217], v12 offset:20480
ds_read_b64_tr_b16 v[218:219], v12 offset:22528
v_accvgpr_read_b32 v149, a25
v_mfma_f32_16x16x32_bf16 a[60:63], v[96:99], v[220:223], a[60:63]
ds_read_b64_tr_b16 v[220:221], v14 offset:4096
s_waitcnt lgkmcnt(3)
v_accvgpr_read_b32 v150, a26
v_mfma_f32_16x16x32_bf16 a[64:67], v[4:7], v[208:211], a[64:67]
ds_read_b64_tr_b16 v[222:223], v14 offset:6144
v_accvgpr_read_b32 v151, a27
v_cvt_pk_bf16_f32 v82, v148, v149
v_mfma_f32_16x16x32_bf16 a[64:67], v[8:11], v[212:215], a[64:67]
v_cvt_pk_bf16_f32 v83, v150, v151
buffer_store_dwordx4 v[80:83], v243, s[20:23], s42 offen offset:0 sc1
v_accvgpr_read_b32 v156, a28
v_mfma_f32_16x16x32_bf16 a[68:71], v[36:39], v[208:211], a[68:71]
v_accvgpr_read_b32 v157, a29
v_accvgpr_read_b32 v158, a30
v_accvgpr_read_b32 v159, a31
v_mfma_f32_16x16x32_bf16 a[68:71], v[40:43], v[212:215], a[68:71]
v_cvt_pk_bf16_f32 v114, v156, v157
v_cvt_pk_bf16_f32 v115, v158, v159
buffer_store_dwordx4 v[112:115], v243, s[20:23], s43 offen offset:0 sc1
v_mfma_f32_16x16x32_bf16 a[72:75], v[68:71], v[208:211], a[72:75]
v_accvgpr_read_b32 v128, a32
v_accvgpr_read_b32 v129, a33
v_accvgpr_read_b32 v130, a34
v_mfma_f32_16x16x32_bf16 a[72:75], v[72:75], v[212:215], a[72:75]
v_accvgpr_read_b32 v131, a35
v_cvt_pk_bf16_f32 v20, v128, v129
v_cvt_pk_bf16_f32 v21, v130, v131
v_mfma_f32_16x16x32_bf16 a[76:79], v[100:103], v[208:211], a[76:79]
ds_read_b64_tr_b16 v[208:209], v14 offset:20480
ds_read_b64_tr_b16 v[210:211], v14 offset:22528
v_accvgpr_read_b32 v136, a36
v_mfma_f32_16x16x32_bf16 a[76:79], v[104:107], v[212:215], a[76:79]
ds_read_b64_tr_b16 v[212:213], v245 offset:20480
s_waitcnt lgkmcnt(3)
v_accvgpr_read_b32 v137, a37
v_mfma_f32_16x16x32_bf16 a[64:67], v[176:179], v[216:219], a[64:67]
ds_read_b64_tr_b16 v[214:215], v245 offset:22528
v_accvgpr_read_b32 v138, a38
v_accvgpr_read_b32 v139, a39
v_mfma_f32_16x16x32_bf16 a[64:67], v[160:163], v[220:223], a[64:67]
v_cvt_pk_bf16_f32 v52, v136, v137
v_cvt_pk_bf16_f32 v53, v138, v139
v_accvgpr_read_b32 v144, a40
v_mfma_f32_16x16x32_bf16 a[68:71], v[180:183], v[216:219], a[68:71]
v_accvgpr_read_b32 v145, a41
v_accvgpr_read_b32 v146, a42
v_accvgpr_read_b32 v147, a43
v_mfma_f32_16x16x32_bf16 a[68:71], v[164:167], v[220:223], a[68:71]
v_cvt_pk_bf16_f32 v84, v144, v145
v_cvt_pk_bf16_f32 v85, v146, v147
v_accvgpr_read_b32 v152, a44
v_mfma_f32_16x16x32_bf16 a[72:75], v[184:187], v[216:219], a[72:75]
v_accvgpr_read_b32 v153, a45
v_accvgpr_read_b32 v154, a46
v_accvgpr_read_b32 v155, a47
v_mfma_f32_16x16x32_bf16 a[72:75], v[168:171], v[220:223], a[72:75]
v_cvt_pk_bf16_f32 v116, v152, v153
v_cvt_pk_bf16_f32 v117, v154, v155
v_accvgpr_read_b32 v132, a48
v_mfma_f32_16x16x32_bf16 a[76:79], v[188:191], v[216:219], a[76:79]
ds_read_b64_tr_b16 v[216:217], v13 offset:4096
ds_read_b64_tr_b16 v[218:219], v13 offset:6144
v_accvgpr_read_b32 v133, a49
v_mfma_f32_16x16x32_bf16 a[76:79], v[172:175], v[220:223], a[76:79]
ds_read_b64_tr_b16 v[220:221], v13 offset:20480
s_waitcnt lgkmcnt(5)
v_accvgpr_read_b32 v134, a50
v_mfma_f32_16x16x32_bf16 a[64:67], v[0:3], v[208:211], a[64:67]
ds_read_b64_tr_b16 v[222:223], v13 offset:22528
v_accvgpr_read_b32 v135, a51
v_cvt_pk_bf16_f32 v22, v132, v133
v_mfma_f32_16x16x32_bf16 a[68:71], v[32:35], v[208:211], a[68:71]
v_cvt_pk_bf16_f32 v23, v134, v135
buffer_store_dwordx4 v[20:23], v243, s[20:23], s40 offen offset:1024 sc1
ds_write_b128 v231, v[20:23] offset:1024
v_mfma_f32_16x16x32_bf16 a[72:75], v[64:67], v[208:211], a[72:75]
v_accvgpr_read_b32 v140, a52
v_accvgpr_read_b32 v141, a53
v_accvgpr_read_b32 v142, a54
v_mfma_f32_16x16x32_bf16 a[76:79], v[96:99], v[208:211], a[76:79]
ds_read_b64_tr_b16 v[208:209], v15 offset:4096
s_waitcnt lgkmcnt(5)
v_accvgpr_read_b32 v143, a55
v_mfma_f32_16x16x32_bf16 a[80:83], v[4:7], v[212:215], a[80:83]
ds_read_b64_tr_b16 v[210:211], v15 offset:6144
v_cvt_pk_bf16_f32 v54, v140, v141
v_cvt_pk_bf16_f32 v55, v142, v143
v_mfma_f32_16x16x32_bf16 a[84:87], v[36:39], v[212:215], a[84:87]
buffer_store_dwordx4 v[52:55], v243, s[20:23], s41 offen offset:1024 sc1
v_accvgpr_read_b32 v148, a56
v_accvgpr_read_b32 v149, a57
v_mfma_f32_16x16x32_bf16 a[88:91], v[68:71], v[212:215], a[88:91]
v_accvgpr_read_b32 v150, a58
v_accvgpr_read_b32 v151, a59
v_cvt_pk_bf16_f32 v86, v148, v149
v_mfma_f32_16x16x32_bf16 a[92:95], v[100:103], v[212:215], a[92:95]
ds_read_b64_tr_b16 v[212:213], v15 offset:20480
s_waitcnt lgkmcnt(3)
v_cvt_pk_bf16_f32 v87, v150, v151
v_mfma_f32_16x16x32_bf16 a[80:83], v[8:11], v[216:219], a[80:83]
ds_read_b64_tr_b16 v[214:215], v15 offset:22528
buffer_store_dwordx4 v[84:87], v243, s[20:23], s42 offen offset:1024 sc1
v_accvgpr_read_b32 v156, a60
v_mfma_f32_16x16x32_bf16 a[80:83], v[176:179], v[220:223], a[80:83]
v_accvgpr_read_b32 v157, a61
v_accvgpr_read_b32 v158, a62
v_accvgpr_read_b32 v159, a63
v_mfma_f32_16x16x32_bf16 a[84:87], v[40:43], v[216:219], a[84:87]
v_cvt_pk_bf16_f32 v118, v156, v157
v_cvt_pk_bf16_f32 v119, v158, v159
buffer_store_dwordx4 v[116:119], v243, s[20:23], s43 offen offset:1024 sc1
v_mfma_f32_16x16x32_bf16 a[84:87], v[180:183], v[220:223], a[84:87]
v_accvgpr_read_b32 v128, a64
v_accvgpr_read_b32 v129, a65
v_mfma_f32_16x16x32_bf16 a[88:91], v[72:75], v[216:219], a[88:91]
v_accvgpr_read_b32 v130, a66
v_accvgpr_read_b32 v131, a67
v_mfma_f32_16x16x32_bf16 a[88:91], v[184:187], v[220:223], a[88:91]
v_cvt_pk_bf16_f32 v24, v128, v129
v_cvt_pk_bf16_f32 v25, v130, v131
v_mfma_f32_16x16x32_bf16 a[92:95], v[104:107], v[216:219], a[92:95]
ds_read_b64_tr_b16 v[216:217], v244 offset:20992
ds_read_b64_tr_b16 v[218:219], v244 offset:23040
v_mfma_f32_16x16x32_bf16 a[92:95], v[188:191], v[220:223], a[92:95]
ds_read_b64_tr_b16 v[220:221], v12 offset:4608
s_waitcnt lgkmcnt(3)
v_mfma_f32_16x16x32_bf16 a[80:83], v[160:163], v[208:211], a[80:83]
ds_read_b64_tr_b16 v[222:223], v12 offset:6656
v_accvgpr_read_b32 v136, a68
v_mfma_f32_16x16x32_bf16 a[80:83], v[0:3], v[212:215], a[80:83]
v_accvgpr_read_b32 v137, a69
v_accvgpr_read_b32 v138, a70
v_mfma_f32_16x16x32_bf16 a[84:87], v[164:167], v[208:211], a[84:87]
v_accvgpr_read_b32 v139, a71
v_cvt_pk_bf16_f32 v56, v136, v137
v_mfma_f32_16x16x32_bf16 a[84:87], v[32:35], v[212:215], a[84:87]
v_cvt_pk_bf16_f32 v57, v138, v139
v_accvgpr_read_b32 v144, a72
v_mfma_f32_16x16x32_bf16 a[88:91], v[168:171], v[208:211], a[88:91]
v_accvgpr_read_b32 v145, a73
v_accvgpr_read_b32 v146, a74
v_mfma_f32_16x16x32_bf16 a[88:91], v[64:67], v[212:215], a[88:91]
v_accvgpr_read_b32 v147, a75
v_cvt_pk_bf16_f32 v88, v144, v145
v_mfma_f32_16x16x32_bf16 a[92:95], v[172:175], v[208:211], a[92:95]
ds_read_b64_tr_b16 v[208:209], v12 offset:20992
ds_read_b64_tr_b16 v[210:211], v12 offset:23040
v_mfma_f32_16x16x32_bf16 a[92:95], v[96:99], v[212:215], a[92:95]
ds_read_b64_tr_b16 v[212:213], v14 offset:4608
s_waitcnt lgkmcnt(3)
v_mfma_f32_16x16x32_bf16 a[96:99], v[4:7], v[216:219], a[96:99]
ds_read_b64_tr_b16 v[214:215], v14 offset:6656
v_cvt_pk_bf16_f32 v89, v146, v147
v_mfma_f32_16x16x32_bf16 a[96:99], v[8:11], v[220:223], a[96:99]
v_accvgpr_read_b32 v152, a76
v_accvgpr_read_b32 v153, a77
v_mfma_f32_16x16x32_bf16 a[100:103], v[36:39], v[216:219], a[100:103]
v_accvgpr_read_b32 v154, a78
v_accvgpr_read_b32 v155, a79
v_mfma_f32_16x16x32_bf16 a[100:103], v[40:43], v[220:223], a[100:103]
v_cvt_pk_bf16_f32 v120, v152, v153
v_cvt_pk_bf16_f32 v121, v154, v155
v_mfma_f32_16x16x32_bf16 a[104:107], v[68:71], v[216:219], a[104:107]
v_accvgpr_read_b32 v132, a80
v_accvgpr_read_b32 v133, a81
v_mfma_f32_16x16x32_bf16 a[104:107], v[72:75], v[220:223], a[104:107]
v_accvgpr_read_b32 v134, a82
v_accvgpr_read_b32 v135, a83
v_mfma_f32_16x16x32_bf16 a[108:111], v[100:103], v[216:219], a[108:111]
ds_read_b64_tr_b16 v[216:217], v14 offset:20992
ds_read_b64_tr_b16 v[218:219], v14 offset:23040
v_mfma_f32_16x16x32_bf16 a[108:111], v[104:107], v[220:223], a[108:111]
ds_read_b64_tr_b16 v[220:221], v245 offset:20992
s_waitcnt lgkmcnt(3)
v_mfma_f32_16x16x32_bf16 a[96:99], v[176:179], v[208:211], a[96:99]
ds_read_b64_tr_b16 v[222:223], v245 offset:23040
v_cvt_pk_bf16_f32 v26, v132, v133
v_mfma_f32_16x16x32_bf16 a[96:99], v[160:163], v[212:215], a[96:99]
v_cvt_pk_bf16_f32 v27, v134, v135
buffer_store_dwordx4 v[24:27], v243, s[20:23], s40 offen offset:2048 sc1
v_mfma_f32_16x16x32_bf16 a[100:103], v[180:183], v[208:211], a[100:103]
ds_write_b128 v231, v[24:27] offset:2048
v_accvgpr_read_b32 v140, a84
v_mfma_f32_16x16x32_bf16 a[100:103], v[164:167], v[212:215], a[100:103]
v_accvgpr_read_b32 v141, a85
v_accvgpr_read_b32 v142, a86
v_mfma_f32_16x16x32_bf16 a[104:107], v[184:187], v[208:211], a[104:107]
v_accvgpr_read_b32 v143, a87
v_cvt_pk_bf16_f32 v58, v140, v141
v_mfma_f32_16x16x32_bf16 a[104:107], v[168:171], v[212:215], a[104:107]
v_cvt_pk_bf16_f32 v59, v142, v143
buffer_store_dwordx4 v[56:59], v243, s[20:23], s41 offen offset:2048 sc1
v_mfma_f32_16x16x32_bf16 a[108:111], v[188:191], v[208:211], a[108:111]
ds_read_b64_tr_b16 v[208:209], v13 offset:4608
ds_read_b64_tr_b16 v[210:211], v13 offset:6656
v_mfma_f32_16x16x32_bf16 a[108:111], v[172:175], v[212:215], a[108:111]
ds_read_b64_tr_b16 v[212:213], v13 offset:20992
s_waitcnt lgkmcnt(5)
v_mfma_f32_16x16x32_bf16 a[96:99], v[0:3], v[216:219], a[96:99]
ds_read_b64_tr_b16 v[214:215], v13 offset:23040
v_accvgpr_read_b32 v148, a88
v_mfma_f32_16x16x32_bf16 a[100:103], v[32:35], v[216:219], a[100:103]
v_accvgpr_read_b32 v149, a89
v_accvgpr_read_b32 v150, a90
v_mfma_f32_16x16x32_bf16 a[104:107], v[64:67], v[216:219], a[104:107]
v_accvgpr_read_b32 v151, a91
v_cvt_pk_bf16_f32 v90, v148, v149
v_mfma_f32_16x16x32_bf16 a[108:111], v[96:99], v[216:219], a[108:111]
ds_read_b64_tr_b16 v[216:217], v15 offset:4608
s_waitcnt lgkmcnt(5)
v_mfma_f32_16x16x32_bf16 a[112:115], v[4:7], v[220:223], a[112:115]
ds_read_b64_tr_b16 v[218:219], v15 offset:6656
v_cvt_pk_bf16_f32 v91, v150, v151
v_mfma_f32_16x16x32_bf16 a[116:119], v[36:39], v[220:223], a[116:119]
buffer_store_dwordx4 v[88:91], v243, s[20:23], s42 offen offset:2048 sc1
v_accvgpr_read_b32 v156, a92
v_mfma_f32_16x16x32_bf16 a[120:123], v[68:71], v[220:223], a[120:123]
v_accvgpr_read_b32 v157, a93
v_accvgpr_read_b32 v158, a94
v_mfma_f32_16x16x32_bf16 a[124:127], v[100:103], v[220:223], a[124:127]
ds_read_b64_tr_b16 v[220:221], v15 offset:20992
s_waitcnt lgkmcnt(3)
v_mfma_f32_16x16x32_bf16 a[112:115], v[8:11], v[208:211], a[112:115]
ds_read_b64_tr_b16 v[222:223], v15 offset:23040
v_accvgpr_read_b32 v159, a95
v_mfma_f32_16x16x32_bf16 a[112:115], v[176:179], v[212:215], a[112:115]
v_cvt_pk_bf16_f32 v122, v156, v157
v_cvt_pk_bf16_f32 v123, v158, v159
v_mfma_f32_16x16x32_bf16 a[116:119], v[40:43], v[208:211], a[116:119]
buffer_store_dwordx4 v[120:123], v243, s[20:23], s43 offen offset:2048 sc1
v_accvgpr_read_b32 v128, a96
v_mfma_f32_16x16x32_bf16 a[116:119], v[180:183], v[212:215], a[116:119]
v_accvgpr_read_b32 v129, a97
v_accvgpr_read_b32 v130, a98
v_mfma_f32_16x16x32_bf16 a[120:123], v[72:75], v[208:211], a[120:123]
v_accvgpr_read_b32 v131, a99
v_cvt_pk_bf16_f32 v28, v128, v129
v_mfma_f32_16x16x32_bf16 a[120:123], v[184:187], v[212:215], a[120:123]
v_cvt_pk_bf16_f32 v29, v130, v131
v_accvgpr_read_b32 v136, a100
v_mfma_f32_16x16x32_bf16 a[124:127], v[104:107], v[208:211], a[124:127]
ds_read_b64_tr_b16 v[208:209], v12 offset:8192
ds_read_b64_tr_b16 v[210:211], v12 offset:10240
v_mfma_f32_16x16x32_bf16 a[124:127], v[188:191], v[212:215], a[124:127]
ds_read_b64_tr_b16 v[212:213], v12 offset:24576
s_waitcnt lgkmcnt(3)
v_mfma_f32_16x16x32_bf16 a[112:115], v[160:163], v[216:219], a[112:115]
ds_read_b64_tr_b16 v[214:215], v12 offset:26624
v_accvgpr_read_b32 v137, a101
v_mfma_f32_16x16x32_bf16 a[112:115], v[0:3], v[220:223], a[112:115]
v_accvgpr_read_b32 v138, a102
v_accvgpr_read_b32 v139, a103
v_mfma_f32_16x16x32_bf16 a[116:119], v[164:167], v[216:219], a[116:119]
v_cvt_pk_bf16_f32 v60, v136, v137
v_cvt_pk_bf16_f32 v61, v138, v139
v_mfma_f32_16x16x32_bf16 a[116:119], v[32:35], v[220:223], a[116:119]
v_accvgpr_read_b32 v144, a104
v_accvgpr_read_b32 v145, a105
v_mfma_f32_16x16x32_bf16 a[120:123], v[168:171], v[216:219], a[120:123]
v_accvgpr_read_b32 v146, a106
v_accvgpr_read_b32 v147, a107
v_mfma_f32_16x16x32_bf16 a[120:123], v[64:67], v[220:223], a[120:123]
v_cvt_pk_bf16_f32 v92, v144, v145
v_cvt_pk_bf16_f32 v93, v146, v147
v_mfma_f32_16x16x32_bf16 a[124:127], v[172:175], v[216:219], a[124:127]
ds_read_b64_tr_b16 v[216:217], v14 offset:8192
ds_read_b64_tr_b16 v[218:219], v14 offset:10240
v_mfma_f32_16x16x32_bf16 a[124:127], v[96:99], v[220:223], a[124:127]
ds_read_b64_tr_b16 v[220:221], v14 offset:24576
s_waitcnt lgkmcnt(3)
v_mfma_f32_16x16x32_bf16 a[128:131], v[8:11], v[208:211], a[128:131]
ds_read_b64_tr_b16 v[222:223], v14 offset:26624
v_accvgpr_read_b32 v152, a108
v_mfma_f32_16x16x32_bf16 a[128:131], v[176:179], v[212:215], a[128:131]
v_accvgpr_read_b32 v153, a109
v_accvgpr_read_b32 v154, a110
v_mfma_f32_16x16x32_bf16 a[132:135], v[40:43], v[208:211], a[132:135]
v_accvgpr_read_b32 v155, a111
v_cvt_pk_bf16_f32 v124, v152, v153
v_mfma_f32_16x16x32_bf16 a[132:135], v[180:183], v[212:215], a[132:135]
v_cvt_pk_bf16_f32 v125, v154, v155
v_accvgpr_read_b32 v132, a112
v_mfma_f32_16x16x32_bf16 a[136:139], v[72:75], v[208:211], a[136:139]
v_accvgpr_read_b32 v133, a113
v_accvgpr_read_b32 v134, a114
v_mfma_f32_16x16x32_bf16 a[136:139], v[184:187], v[212:215], a[136:139]
v_accvgpr_read_b32 v135, a115
v_cvt_pk_bf16_f32 v30, v132, v133
v_mfma_f32_16x16x32_bf16 a[140:143], v[104:107], v[208:211], a[140:143]
ds_read_b64_tr_b16 v[208:209], v13 offset:8192
ds_read_b64_tr_b16 v[210:211], v13 offset:10240
v_mfma_f32_16x16x32_bf16 a[140:143], v[188:191], v[212:215], a[140:143]
ds_read_b64_tr_b16 v[212:213], v13 offset:24576
s_waitcnt lgkmcnt(3)
v_mfma_f32_16x16x32_bf16 a[128:131], v[160:163], v[216:219], a[128:131]
ds_read_b64_tr_b16 v[214:215], v13 offset:26624
v_cvt_pk_bf16_f32 v31, v134, v135
v_mfma_f32_16x16x32_bf16 a[128:131], v[0:3], v[220:223], a[128:131]
buffer_store_dwordx4 v[28:31], v243, s[20:23], s40 offen offset:3072 sc1
ds_write_b128 v231, v[28:31] offset:3072
v_mfma_f32_16x16x32_bf16 a[132:135], v[164:167], v[216:219], a[132:135]
v_accvgpr_read_b32 v140, a116
v_accvgpr_read_b32 v141, a117
v_mfma_f32_16x16x32_bf16 a[132:135], v[32:35], v[220:223], a[132:135]
v_accvgpr_read_b32 v142, a118
v_accvgpr_read_b32 v143, a119
v_mfma_f32_16x16x32_bf16 a[136:139], v[168:171], v[216:219], a[136:139]
v_cvt_pk_bf16_f32 v62, v140, v141
v_cvt_pk_bf16_f32 v63, v142, v143
v_mfma_f32_16x16x32_bf16 a[136:139], v[64:67], v[220:223], a[136:139]
buffer_store_dwordx4 v[60:63], v243, s[20:23], s41 offen offset:3072 sc1
v_accvgpr_read_b32 v148, a120
v_mfma_f32_16x16x32_bf16 a[140:143], v[172:175], v[216:219], a[140:143]
ds_read_b64_tr_b16 v[216:217], v15 offset:8192
ds_read_b64_tr_b16 v[218:219], v15 offset:10240
v_mfma_f32_16x16x32_bf16 a[140:143], v[96:99], v[220:223], a[140:143]
ds_read_b64_tr_b16 v[220:221], v15 offset:24576
s_waitcnt lgkmcnt(3)
v_mfma_f32_16x16x32_bf16 a[144:147], v[8:11], v[208:211], a[144:147]
ds_read_b64_tr_b16 v[222:223], v15 offset:26624
v_accvgpr_read_b32 v149, a121
v_mfma_f32_16x16x32_bf16 a[144:147], v[176:179], v[212:215], a[144:147]
v_accvgpr_read_b32 v150, a122
v_accvgpr_read_b32 v151, a123
v_mfma_f32_16x16x32_bf16 a[148:151], v[40:43], v[208:211], a[148:151]
v_cvt_pk_bf16_f32 v94, v148, v149
v_cvt_pk_bf16_f32 v95, v150, v151
v_mfma_f32_16x16x32_bf16 a[148:151], v[180:183], v[212:215], a[148:151]
buffer_store_dwordx4 v[92:95], v243, s[20:23], s42 offen offset:3072 sc1
v_accvgpr_read_b32 v156, a124
v_mfma_f32_16x16x32_bf16 a[152:155], v[72:75], v[208:211], a[152:155]
v_accvgpr_read_b32 v157, a125
v_accvgpr_read_b32 v158, a126
v_mfma_f32_16x16x32_bf16 a[152:155], v[184:187], v[212:215], a[152:155]
v_accvgpr_read_b32 v159, a127
v_cvt_pk_bf16_f32 v126, v156, v157
v_mfma_f32_16x16x32_bf16 a[156:159], v[104:107], v[208:211], a[156:159]
ds_read_b64_tr_b16 v[208:209], v12 offset:8704
ds_read_b64_tr_b16 v[210:211], v12 offset:10752
v_mfma_f32_16x16x32_bf16 a[156:159], v[188:191], v[212:215], a[156:159]
ds_read_b64_tr_b16 v[212:213], v12 offset:25088
s_waitcnt lgkmcnt(3)
v_mfma_f32_16x16x32_bf16 a[144:147], v[160:163], v[216:219], a[144:147]
ds_read_b64_tr_b16 v[214:215], v12 offset:27136
v_cvt_pk_bf16_f32 v127, v158, v159
v_mfma_f32_16x16x32_bf16 a[144:147], v[0:3], v[220:223], a[144:147]
buffer_store_dwordx4 v[124:127], v243, s[20:23], s43 offen offset:3072 sc1
v_accvgpr_read_b32 v128, a128
v_mfma_f32_16x16x32_bf16 a[148:151], v[164:167], v[216:219], a[148:151]
v_accvgpr_read_b32 v129, a129
v_accvgpr_read_b32 v130, a130
v_mfma_f32_16x16x32_bf16 a[148:151], v[32:35], v[220:223], a[148:151]
v_accvgpr_read_b32 v131, a131
v_cvt_pk_bf16_f32 v16, v128, v129
v_mfma_f32_16x16x32_bf16 a[152:155], v[168:171], v[216:219], a[152:155]
v_cvt_pk_bf16_f32 v17, v130, v131
v_accvgpr_read_b32 v136, a132
v_mfma_f32_16x16x32_bf16 a[152:155], v[64:67], v[220:223], a[152:155]
v_accvgpr_read_b32 v137, a133
v_accvgpr_read_b32 v138, a134
v_mfma_f32_16x16x32_bf16 a[156:159], v[172:175], v[216:219], a[156:159]
ds_read_b64_tr_b16 v[216:217], v14 offset:8704
ds_read_b64_tr_b16 v[218:219], v14 offset:10752
v_mfma_f32_16x16x32_bf16 a[156:159], v[96:99], v[220:223], a[156:159]
ds_read_b64_tr_b16 v[220:221], v14 offset:25088
s_waitcnt lgkmcnt(3)
v_mfma_f32_16x16x32_bf16 a[160:163], v[8:11], v[208:211], a[160:163]
ds_read_b64_tr_b16 v[222:223], v14 offset:27136
v_accvgpr_read_b32 v139, a135
v_mfma_f32_16x16x32_bf16 a[160:163], v[176:179], v[212:215], a[160:163]
v_cvt_pk_bf16_f32 v48, v136, v137
v_cvt_pk_bf16_f32 v49, v138, v139
v_mfma_f32_16x16x32_bf16 a[164:167], v[40:43], v[208:211], a[164:167]
v_accvgpr_read_b32 v144, a136
v_accvgpr_read_b32 v145, a137
v_mfma_f32_16x16x32_bf16 a[164:167], v[180:183], v[212:215], a[164:167]
v_accvgpr_read_b32 v146, a138
v_accvgpr_read_b32 v147, a139
v_mfma_f32_16x16x32_bf16 a[168:171], v[72:75], v[208:211], a[168:171]
v_cvt_pk_bf16_f32 v80, v144, v145
v_cvt_pk_bf16_f32 v81, v146, v147
v_mfma_f32_16x16x32_bf16 a[168:171], v[184:187], v[212:215], a[168:171]
v_accvgpr_read_b32 v152, a140
v_accvgpr_read_b32 v153, a141
v_mfma_f32_16x16x32_bf16 a[172:175], v[104:107], v[208:211], a[172:175]
ds_read_b64_tr_b16 v[208:209], v13 offset:8704
ds_read_b64_tr_b16 v[210:211], v13 offset:10752
v_mfma_f32_16x16x32_bf16 a[172:175], v[188:191], v[212:215], a[172:175]
ds_read_b64_tr_b16 v[212:213], v13 offset:25088
s_waitcnt lgkmcnt(3)
v_mfma_f32_16x16x32_bf16 a[160:163], v[160:163], v[216:219], a[160:163]
ds_read_b64_tr_b16 v[214:215], v13 offset:27136
v_accvgpr_read_b32 v154, a142
v_mfma_f32_16x16x32_bf16 a[160:163], v[0:3], v[220:223], a[160:163]
v_accvgpr_read_b32 v155, a143
v_cvt_pk_bf16_f32 v112, v152, v153
v_mfma_f32_16x16x32_bf16 a[164:167], v[164:167], v[216:219], a[164:167]
v_cvt_pk_bf16_f32 v113, v154, v155
v_accvgpr_read_b32 v132, a144
v_mfma_f32_16x16x32_bf16 a[164:167], v[32:35], v[220:223], a[164:167]
v_accvgpr_read_b32 v133, a145
v_accvgpr_read_b32 v134, a146
v_mfma_f32_16x16x32_bf16 a[168:171], v[168:171], v[216:219], a[168:171]
v_accvgpr_read_b32 v135, a147
v_cvt_pk_bf16_f32 v18, v132, v133
v_mfma_f32_16x16x32_bf16 a[168:171], v[64:67], v[220:223], a[168:171]
v_cvt_pk_bf16_f32 v19, v134, v135
buffer_store_dwordx4 v[16:19], v243, s[20:23], s44 offen offset:0 sc1
v_mfma_f32_16x16x32_bf16 a[172:175], v[172:175], v[216:219], a[172:175]
ds_read_b64_tr_b16 v[216:217], v15 offset:8704
ds_read_b64_tr_b16 v[218:219], v15 offset:10752
v_mfma_f32_16x16x32_bf16 a[172:175], v[96:99], v[220:223], a[172:175]
ds_read_b64_tr_b16 v[220:221], v15 offset:25088
s_waitcnt lgkmcnt(3)
v_mfma_f32_16x16x32_bf16 a[176:179], v[8:11], v[208:211], a[176:179]
ds_read_b64_tr_b16 v[222:223], v15 offset:27136
ds_write_b128 v231, v[16:19] offset:4096
v_mfma_f32_16x16x32_bf16 a[176:179], v[176:179], v[212:215], a[176:179]
v_accvgpr_read_b32 v140, a148
v_accvgpr_read_b32 v141, a149
v_mfma_f32_16x16x32_bf16 a[180:183], v[40:43], v[208:211], a[180:183]
v_accvgpr_read_b32 v142, a150
v_accvgpr_read_b32 v143, a151
v_mfma_f32_16x16x32_bf16 a[180:183], v[180:183], v[212:215], a[180:183]
v_cvt_pk_bf16_f32 v50, v140, v141
v_cvt_pk_bf16_f32 v51, v142, v143
v_mfma_f32_16x16x32_bf16 a[184:187], v[72:75], v[208:211], a[184:187]
buffer_store_dwordx4 v[48:51], v243, s[20:23], s45 offen offset:0 sc1
v_accvgpr_read_b32 v148, a152
v_mfma_f32_16x16x32_bf16 a[184:187], v[184:187], v[212:215], a[184:187]
v_accvgpr_read_b32 v149, a153
v_accvgpr_read_b32 v150, a154
v_mfma_f32_16x16x32_bf16 a[188:191], v[104:107], v[208:211], a[188:191]
ds_read_b64_tr_b16 v[208:209], v12 offset:12288
ds_read_b64_tr_b16 v[210:211], v12 offset:14336
v_mfma_f32_16x16x32_bf16 a[188:191], v[188:191], v[212:215], a[188:191]
ds_read_b64_tr_b16 v[212:213], v12 offset:28672
s_waitcnt lgkmcnt(3)
v_mfma_f32_16x16x32_bf16 a[176:179], v[160:163], v[216:219], a[176:179]
ds_read_b64_tr_b16 v[214:215], v12 offset:30720
v_accvgpr_read_b32 v151, a155
v_mfma_f32_16x16x32_bf16 a[176:179], v[0:3], v[220:223], a[176:179]
v_cvt_pk_bf16_f32 v82, v148, v149
v_cvt_pk_bf16_f32 v83, v150, v151
v_mfma_f32_16x16x32_bf16 a[180:183], v[164:167], v[216:219], a[180:183]
buffer_store_dwordx4 v[80:83], v243, s[20:23], s46 offen offset:0 sc1
v_accvgpr_read_b32 v156, a156
v_mfma_f32_16x16x32_bf16 a[180:183], v[32:35], v[220:223], a[180:183]
v_accvgpr_read_b32 v157, a157
v_accvgpr_read_b32 v158, a158
v_mfma_f32_16x16x32_bf16 a[184:187], v[168:171], v[216:219], a[184:187]
v_accvgpr_read_b32 v159, a159
v_cvt_pk_bf16_f32 v114, v156, v157
v_mfma_f32_16x16x32_bf16 a[184:187], v[64:67], v[220:223], a[184:187]
v_cvt_pk_bf16_f32 v115, v158, v159
buffer_store_dwordx4 v[112:115], v243, s[20:23], s47 offen offset:0 sc1
v_mfma_f32_16x16x32_bf16 a[188:191], v[172:175], v[216:219], a[188:191]
ds_read_b64_tr_b16 v[216:217], v14 offset:12288
ds_read_b64_tr_b16 v[218:219], v14 offset:14336
v_mfma_f32_16x16x32_bf16 a[188:191], v[96:99], v[220:223], a[188:191]
ds_read_b64_tr_b16 v[220:221], v14 offset:28672
s_waitcnt lgkmcnt(3)
v_mfma_f32_16x16x32_bf16 a[192:195], v[8:11], v[208:211], a[192:195]
ds_read_b64_tr_b16 v[222:223], v14 offset:30720
v_accvgpr_read_b32 v128, a160
v_mfma_f32_16x16x32_bf16 a[192:195], v[176:179], v[212:215], a[192:195]
v_accvgpr_read_b32 v129, a161
v_accvgpr_read_b32 v130, a162
v_mfma_f32_16x16x32_bf16 a[196:199], v[40:43], v[208:211], a[196:199]
v_accvgpr_read_b32 v131, a163
v_cvt_pk_bf16_f32 v20, v128, v129
v_mfma_f32_16x16x32_bf16 a[196:199], v[180:183], v[212:215], a[196:199]
v_cvt_pk_bf16_f32 v21, v130, v131
v_accvgpr_read_b32 v136, a164
v_mfma_f32_16x16x32_bf16 a[200:203], v[72:75], v[208:211], a[200:203]
v_accvgpr_read_b32 v137, a165
v_accvgpr_read_b32 v138, a166
v_mfma_f32_16x16x32_bf16 a[200:203], v[184:187], v[212:215], a[200:203]
v_accvgpr_read_b32 v139, a167
v_cvt_pk_bf16_f32 v52, v136, v137
v_mfma_f32_16x16x32_bf16 a[204:207], v[104:107], v[208:211], a[204:207]
ds_read_b64_tr_b16 v[208:209], v13 offset:12288
ds_read_b64_tr_b16 v[210:211], v13 offset:14336
v_mfma_f32_16x16x32_bf16 a[204:207], v[188:191], v[212:215], a[204:207]
ds_read_b64_tr_b16 v[212:213], v13 offset:28672
s_waitcnt lgkmcnt(3)
v_mfma_f32_16x16x32_bf16 a[192:195], v[160:163], v[216:219], a[192:195]
ds_read_b64_tr_b16 v[214:215], v13 offset:30720
v_cvt_pk_bf16_f32 v53, v138, v139
v_mfma_f32_16x16x32_bf16 a[192:195], v[0:3], v[220:223], a[192:195]
v_accvgpr_read_b32 v144, a168
v_accvgpr_read_b32 v145, a169
v_mfma_f32_16x16x32_bf16 a[196:199], v[164:167], v[216:219], a[196:199]
v_accvgpr_read_b32 v146, a170
v_accvgpr_read_b32 v147, a171
v_mfma_f32_16x16x32_bf16 a[196:199], v[32:35], v[220:223], a[196:199]
v_cvt_pk_bf16_f32 v84, v144, v145
v_cvt_pk_bf16_f32 v85, v146, v147
v_mfma_f32_16x16x32_bf16 a[200:203], v[168:171], v[216:219], a[200:203]
v_accvgpr_read_b32 v152, a172
v_accvgpr_read_b32 v153, a173
v_mfma_f32_16x16x32_bf16 a[200:203], v[64:67], v[220:223], a[200:203]
v_accvgpr_read_b32 v154, a174
v_accvgpr_read_b32 v155, a175
v_mfma_f32_16x16x32_bf16 a[204:207], v[172:175], v[216:219], a[204:207]
ds_read_b64_tr_b16 v[216:217], v15 offset:12288
ds_read_b64_tr_b16 v[218:219], v15 offset:14336
v_mfma_f32_16x16x32_bf16 a[204:207], v[96:99], v[220:223], a[204:207]
ds_read_b64_tr_b16 v[220:221], v15 offset:28672
s_waitcnt lgkmcnt(3)
v_mfma_f32_16x16x32_bf16 a[208:211], v[8:11], v[208:211], a[208:211]
ds_read_b64_tr_b16 v[222:223], v15 offset:30720
v_cvt_pk_bf16_f32 v116, v152, v153
v_mfma_f32_16x16x32_bf16 a[208:211], v[176:179], v[212:215], a[208:211]
v_cvt_pk_bf16_f32 v117, v154, v155
v_accvgpr_read_b32 v132, a176
v_mfma_f32_16x16x32_bf16 a[212:215], v[40:43], v[208:211], a[212:215]
v_accvgpr_read_b32 v133, a177
v_accvgpr_read_b32 v134, a178
v_mfma_f32_16x16x32_bf16 a[212:215], v[180:183], v[212:215], a[212:215]
v_accvgpr_read_b32 v135, a179
v_cvt_pk_bf16_f32 v22, v132, v133
v_mfma_f32_16x16x32_bf16 a[216:219], v[72:75], v[208:211], a[216:219]
v_cvt_pk_bf16_f32 v23, v134, v135
buffer_store_dwordx4 v[20:23], v243, s[20:23], s44 offen offset:1024 sc1
v_mfma_f32_16x16x32_bf16 a[216:219], v[184:187], v[212:215], a[216:219]
ds_write_b128 v231, v[20:23] offset:5120
v_accvgpr_read_b32 v140, a180
v_mfma_f32_16x16x32_bf16 a[220:223], v[104:107], v[208:211], a[220:223]
v_accvgpr_read_b32 v141, a181
v_accvgpr_read_b32 v142, a182
v_mfma_f32_16x16x32_bf16 a[220:223], v[188:191], v[212:215], a[220:223]
s_waitcnt lgkmcnt(0)
v_accvgpr_read_b32 v143, a183
v_mfma_f32_16x16x32_bf16 a[208:211], v[160:163], v[216:219], a[208:211]
v_cvt_pk_bf16_f32 v54, v140, v141
v_cvt_pk_bf16_f32 v55, v142, v143
v_mfma_f32_16x16x32_bf16 a[208:211], v[0:3], v[220:223], a[208:211]
buffer_store_dwordx4 v[52:55], v243, s[20:23], s45 offen offset:1024 sc1
v_accvgpr_read_b32 v148, a184
v_mfma_f32_16x16x32_bf16 a[212:215], v[164:167], v[216:219], a[212:215]
v_accvgpr_read_b32 v149, a185
v_accvgpr_read_b32 v150, a186
v_mfma_f32_16x16x32_bf16 a[212:215], v[32:35], v[220:223], a[212:215]
v_accvgpr_read_b32 v151, a187
v_cvt_pk_bf16_f32 v86, v148, v149
v_mfma_f32_16x16x32_bf16 a[216:219], v[168:171], v[216:219], a[216:219]
v_cvt_pk_bf16_f32 v87, v150, v151
buffer_store_dwordx4 v[84:87], v243, s[20:23], s46 offen offset:1024 sc1
v_mfma_f32_16x16x32_bf16 a[216:219], v[64:67], v[220:223], a[216:219]
v_accvgpr_read_b32 v156, a188
v_accvgpr_read_b32 v157, a189
v_mfma_f32_16x16x32_bf16 a[220:223], v[172:175], v[216:219], a[220:223]
v_accvgpr_read_b32 v158, a190
v_accvgpr_read_b32 v159, a191
v_mfma_f32_16x16x32_bf16 a[220:223], v[96:99], v[220:223], a[220:223]
v_cvt_pk_bf16_f32 v118, v156, v157
v_cvt_pk_bf16_f32 v119, v158, v159
buffer_store_dwordx4 v[116:119], v243, s[20:23], s47 offen offset:1024 sc1
v_accvgpr_read_b32 v128, a192
v_accvgpr_read_b32 v129, a193
v_accvgpr_read_b32 v130, a194
v_accvgpr_read_b32 v131, a195
v_cvt_pk_bf16_f32 v24, v128, v129
v_cvt_pk_bf16_f32 v25, v130, v131
v_accvgpr_read_b32 v136, a196
v_accvgpr_read_b32 v137, a197
v_accvgpr_read_b32 v138, a198
v_accvgpr_read_b32 v139, a199
v_cvt_pk_bf16_f32 v56, v136, v137
v_cvt_pk_bf16_f32 v57, v138, v139
v_accvgpr_read_b32 v144, a200
v_accvgpr_read_b32 v145, a201
v_accvgpr_read_b32 v146, a202
v_accvgpr_read_b32 v147, a203
v_cvt_pk_bf16_f32 v88, v144, v145
v_cvt_pk_bf16_f32 v89, v146, v147
v_accvgpr_read_b32 v152, a204
v_accvgpr_read_b32 v153, a205
v_accvgpr_read_b32 v154, a206
v_accvgpr_read_b32 v155, a207
v_cvt_pk_bf16_f32 v120, v152, v153
v_cvt_pk_bf16_f32 v121, v154, v155
v_accvgpr_read_b32 v132, a208
v_accvgpr_read_b32 v133, a209
v_accvgpr_read_b32 v134, a210
v_accvgpr_read_b32 v135, a211
v_cvt_pk_bf16_f32 v26, v132, v133
v_cvt_pk_bf16_f32 v27, v134, v135
buffer_store_dwordx4 v[24:27], v243, s[20:23], s44 offen offset:2048 sc1
ds_write_b128 v231, v[24:27] offset:6144
v_accvgpr_read_b32 v140, a212
v_accvgpr_read_b32 v141, a213
v_accvgpr_read_b32 v142, a214
v_accvgpr_read_b32 v143, a215
v_cvt_pk_bf16_f32 v58, v140, v141
v_cvt_pk_bf16_f32 v59, v142, v143
buffer_store_dwordx4 v[56:59], v243, s[20:23], s45 offen offset:2048 sc1
v_accvgpr_read_b32 v148, a216
v_accvgpr_read_b32 v149, a217
v_accvgpr_read_b32 v150, a218
v_accvgpr_read_b32 v151, a219
v_cvt_pk_bf16_f32 v90, v148, v149
v_cvt_pk_bf16_f32 v91, v150, v151
buffer_store_dwordx4 v[88:91], v243, s[20:23], s46 offen offset:2048 sc1
v_accvgpr_read_b32 v156, a220
v_accvgpr_read_b32 v157, a221
v_accvgpr_read_b32 v158, a222
v_accvgpr_read_b32 v159, a223
v_cvt_pk_bf16_f32 v122, v156, v157
v_cvt_pk_bf16_f32 v123, v158, v159
buffer_store_dwordx4 v[120:123], v243, s[20:23], s47 offen offset:2048 sc1
s_waitcnt vmcnt(36)
s_branch L2_F
L2_tail_1:
s_waitcnt lgkmcnt(2)
v_add_u32 v231, s50, v243
v_mfma_f32_16x16x32_bf16 v[144:147], v[208:211], v[0:3], 0
s_mov_b32 m0, s30
ds_write_b128 v231, v[160:163] offset:0
v_mfma_f32_16x16x32_bf16 v[144:147], v[212:215], v[4:7], v[144:147]
buffer_load_dwordx4 v241, s[12:15], s28 offen offset:0 sc1 lds
ds_write_b128 v231, v[164:167] offset:1024
v_mfma_f32_16x16x32_bf16 v[148:151], v[208:211], v[32:35], 0
buffer_load_dwordx4 v241, s[12:15], s28 offen offset:1024 sc1 lds
ds_write_b128 v231, v[168:171] offset:2048
v_mfma_f32_16x16x32_bf16 v[148:151], v[212:215], v[36:39], v[148:151]
buffer_load_dwordx4 v241, s[12:15], s28 offen offset:2048 sc1 lds
ds_write_b128 v231, v[172:175] offset:3072
v_mfma_f32_16x16x32_bf16 v[152:155], v[208:211], v[64:67], 0
buffer_load_dwordx4 v241, s[12:15], s28 offen offset:3072 sc1 lds
v_add_u32 v230, 0x8000, v240
v_and_b32 v230, 0x1ffff, v230
v_mfma_f32_16x16x32_bf16 v[152:155], v[212:215], v[68:71], v[152:155]
v_exp_f32 v232, v128
v_mfma_f32_16x16x32_bf16 v[156:159], v[208:211], v[96:99], 0
ds_read_b128 v[208:211], v240 offset:6144
v_exp_f32 v233, v129
v_mfma_f32_16x16x32_bf16 v[156:159], v[212:215], v[100:103], v[156:159]
ds_read_b128 v[212:215], v240 offset:6656
s_waitcnt lgkmcnt(2)
s_and_b32 s30, s30, 0x1c000
v_mfma_f32_16x16x32_bf16 v[144:147], v[216:219], v[8:11], v[144:147]
v_exp_f32 v234, v130
v_cvt_pk_bf16_f32 v160, v232, v233
v_mfma_f32_16x16x32_bf16 v[144:147], v[220:223], v[12:15], v[144:147]
v_exp_f32 v235, v131
s_add_u32 s28, s30, 0x4000
v_mfma_f32_16x16x32_bf16 v[148:151], v[216:219], v[40:43], v[148:151]
v_exp_f32 v236, v132
v_cvt_pk_bf16_f32 v161, v234, v235
v_mfma_f32_16x16x32_bf16 v[148:151], v[220:223], v[44:47], v[148:151]
v_exp_f32 v237, v133
s_and_b32 s28, s28, 0x1ffff
v_mfma_f32_16x16x32_bf16 v[152:155], v[216:219], v[72:75], v[152:155]
v_exp_f32 v238, v134
v_cvt_pk_bf16_f32 v164, v236, v237
v_mfma_f32_16x16x32_bf16 v[152:155], v[220:223], v[76:79], v[152:155]
v_exp_f32 v239, v135
s_add_u32 s30, s30, 0x8000
v_mfma_f32_16x16x32_bf16 v[156:159], v[216:219], v[104:107], v[156:159]
ds_read_b128 v[216:219], v240 offset:10240
v_exp_f32 v232, v136
v_mfma_f32_16x16x32_bf16 v[156:159], v[220:223], v[108:111], v[156:159]
ds_read_b128 v[220:223], v240 offset:10752
s_waitcnt lgkmcnt(2)
v_cvt_pk_bf16_f32 v165, v238, v239
v_mfma_f32_16x16x32_bf16 v[144:147], v[208:211], v[16:19], v[144:147]
v_exp_f32 v233, v137
s_and_b32 s30, s30, 0x1ffff
v_mfma_f32_16x16x32_bf16 v[144:147], v[212:215], v[20:23], v[144:147]
s_waitcnt vmcnt(4)
s_barrier
s_mul_i32 s31, s34, 6144
v_mfma_f32_16x16x32_bf16 v[148:151], v[208:211], v[48:51], v[148:151]
v_exp_f32 v234, v138
v_cvt_pk_bf16_f32 v168, v232, v233
v_mfma_f32_16x16x32_bf16 v[148:151], v[212:215], v[52:55], v[148:151]
v_exp_f32 v235, v139
s_add_u32 s31, s31, s30
v_mfma_f32_16x16x32_bf16 v[152:155], v[208:211], v[80:83], v[152:155]
v_exp_f32 v236, v140
v_cvt_pk_bf16_f32 v169, v234, v235
v_mfma_f32_16x16x32_bf16 v[152:155], v[212:215], v[84:87], v[152:155]
v_exp_f32 v237, v141
s_lshl_b32 s3, s34, 10
v_mfma_f32_16x16x32_bf16 v[156:159], v[208:211], v[112:115], v[156:159]
ds_read_b128 v[208:211], v240 offset:29184
v_exp_f32 v238, v142
v_mfma_f32_16x16x32_bf16 v[156:159], v[212:215], v[116:119], v[156:159]
ds_read_b128 v[212:215], v240 offset:28672
s_waitcnt lgkmcnt(2)
v_cvt_pk_bf16_f32 v172, v236, v237
v_mfma_f32_16x16x32_bf16 v[144:147], v[216:219], v[24:27], v[144:147]
v_exp_f32 v239, v143
v_or3_b32 v242, v160, v161, v164
v_mfma_f32_16x16x32_bf16 v[144:147], v[220:223], v[28:31], v[144:147]
v_cvt_pk_bf16_f32 v173, v238, v239
v_or3_b32 v242, v242, v165, v168
v_or3_b32 v242, v242, v169, v172
v_mfma_f32_16x16x32_bf16 v[148:151], v[216:219], v[56:59], v[148:151]
v_or_b32 v242, v242, v173
v_lshl_or_b32 v242, v242, 16, v242
v_cmp_le_u32 vcc, 2.0, v242
v_mfma_f32_16x16x32_bf16 v[148:151], v[220:223], v[60:63], v[148:151]
s_add_u32 s28, s28, s3
s_add_u32 s3, s3, 24576
s_add_u32 s30, s30, s3
v_mfma_f32_16x16x32_bf16 v[152:155], v[216:219], v[88:91], v[152:155]
v_lshrrev_b32 v241, 4, v243
v_and_b32 v241, 0x30, v241
v_xor_b32 v241, v241, v243
v_mfma_f32_16x16x32_bf16 v[152:155], v[220:223], v[92:95], v[152:155]
s_cbranch_vccnz L2_rare_site12
L2_ret12:
v_and_b32 v228, 0x380, v243
v_mad_u32_u24 v241, v228, 3, v241
v_mfma_f32_16x16x32_bf16 v[156:159], v[216:219], v[120:123], v[156:159]
ds_read_b128 v[216:219], v240 offset:16384
s_add_u32 m0, s31, 0
v_mfma_f32_16x16x32_bf16 v[156:159], v[220:223], v[124:127], v[156:159]
ds_read_b128 v[220:223], v240 offset:16896
s_waitcnt lgkmcnt(2)
v_mfma_f32_16x16x32_bf16 v[128:131], v[208:211], v[0:3], 0
buffer_load_dwordx4 v241, s[8:11], s6 offen lds
s_add_u32 m0, s31, 2048
v_mfma_f32_16x16x32_bf16 v[128:131], v[212:215], v[4:7], v[128:131]
v_exp_f32 v232, v144
v_mfma_f32_16x16x32_bf16 v[132:135], v[208:211], v[32:35], 0
v_exp_f32 v233, v145
v_mfma_f32_16x16x32_bf16 v[132:135], v[212:215], v[36:39], v[132:135]
v_exp_f32 v234, v146
v_cvt_pk_bf16_f32 v162, v232, v233
v_mfma_f32_16x16x32_bf16 v[136:139], v[208:211], v[64:67], 0
v_exp_f32 v235, v147
v_mfma_f32_16x16x32_bf16 v[136:139], v[212:215], v[68:71], v[136:139]
v_exp_f32 v236, v148
v_cvt_pk_bf16_f32 v163, v234, v235
v_mfma_f32_16x16x32_bf16 v[140:143], v[208:211], v[96:99], 0
ds_read_b128 v[208:211], v240 offset:20480
v_exp_f32 v237, v149
v_mfma_f32_16x16x32_bf16 v[140:143], v[212:215], v[100:103], v[140:143]
ds_read_b128 v[212:215], v240 offset:20992
s_waitcnt lgkmcnt(2)
v_mfma_f32_16x16x32_bf16 v[128:131], v[216:219], v[8:11], v[128:131]
ds_write_b128 v231, v[176:179] offset:4096
v_exp_f32 v238, v150
v_mfma_f32_16x16x32_bf16 v[128:131], v[220:223], v[12:15], v[128:131]
ds_write_b128 v231, v[180:183] offset:5120
v_cvt_pk_bf16_f32 v166, v236, v237
v_mfma_f32_16x16x32_bf16 v[132:135], v[216:219], v[40:43], v[132:135]
ds_write_b128 v231, v[184:187] offset:6144
v_exp_f32 v239, v151
v_mfma_f32_16x16x32_bf16 v[132:135], v[220:223], v[44:47], v[132:135]
ds_write_b128 v231, v[188:191] offset:7168
v_exp_f32 v232, v152
v_mfma_f32_16x16x32_bf16 v[136:139], v[216:219], v[72:75], v[136:139]
v_cvt_pk_bf16_f32 v167, v238, v239
v_exp_f32 v233, v153
v_mfma_f32_16x16x32_bf16 v[136:139], v[220:223], v[76:79], v[136:139]
v_exp_f32 v234, v154
v_cvt_pk_bf16_f32 v170, v232, v233
v_mfma_f32_16x16x32_bf16 v[140:143], v[216:219], v[104:107], v[140:143]
ds_read_b128 v[216:219], v240 offset:24576
v_exp_f32 v235, v155
v_mfma_f32_16x16x32_bf16 v[140:143], v[220:223], v[108:111], v[140:143]
ds_read_b128 v[220:223], v240 offset:25088
s_waitcnt lgkmcnt(2)
v_mfma_f32_16x16x32_bf16 v[128:131], v[208:211], v[16:19], v[128:131]
v_exp_f32 v236, v156
v_cvt_pk_bf16_f32 v171, v234, v235
v_mfma_f32_16x16x32_bf16 v[128:131], v[212:215], v[20:23], v[128:131]
v_exp_f32 v237, v157
v_mfma_f32_16x16x32_bf16 v[132:135], v[208:211], v[48:51], v[132:135]
v_exp_f32 v238, v158
v_cvt_pk_bf16_f32 v174, v236, v237
v_mfma_f32_16x16x32_bf16 v[132:135], v[212:215], v[52:55], v[132:135]
v_exp_f32 v239, v159
v_or3_b32 v242, v162, v163, v166
v_mfma_f32_16x16x32_bf16 v[136:139], v[208:211], v[80:83], v[136:139]
v_cvt_pk_bf16_f32 v175, v238, v239
v_or3_b32 v242, v242, v167, v170
v_or3_b32 v242, v242, v171, v174
v_mfma_f32_16x16x32_bf16 v[136:139], v[212:215], v[84:87], v[136:139]
v_or_b32 v242, v242, v175
v_lshl_or_b32 v242, v242, 16, v242
v_cmp_le_u32 vcc, 2.0, v242
s_cbranch_vccnz L2_rare_site13
L2_ret13:
v_mfma_f32_16x16x32_bf16 v[140:143], v[208:211], v[112:115], v[140:143]
ds_read_b128 v[208:211], v240 offset:31232
buffer_load_dwordx4 v241, s[8:11], s7 offen lds
s_add_u32 m0, s31, 4096
v_mfma_f32_16x16x32_bf16 v[140:143], v[212:215], v[116:119], v[140:143]
ds_read_b128 v[212:215], v240 offset:30720
s_waitcnt lgkmcnt(2)
v_mfma_f32_16x16x32_bf16 v[128:131], v[216:219], v[24:27], v[128:131]
buffer_load_dwordx4 v241, s[8:11], s29 offen lds
s_add_u32 m0, s31, 1024
v_xor_b32 v241, 0x1040, v241
v_mfma_f32_16x16x32_bf16 v[128:131], v[220:223], v[28:31], v[128:131]
buffer_load_dwordx4 v241, s[8:11], s6 offen lds
s_add_u32 m0, s31, 3072
v_mfma_f32_16x16x32_bf16 v[132:135], v[216:219], v[56:59], v[132:135]
buffer_load_dwordx4 v241, s[8:11], s7 offen lds
s_add_u32 m0, s31, 5120
v_mfma_f32_16x16x32_bf16 v[132:135], v[220:223], v[60:63], v[132:135]
buffer_load_dwordx4 v241, s[8:11], s29 offen lds
v_mfma_f32_16x16x32_bf16 v[136:139], v[216:219], v[88:91], v[136:139]
v_mfma_f32_16x16x32_bf16 v[136:139], v[220:223], v[92:95], v[136:139]
v_mfma_f32_16x16x32_bf16 v[140:143], v[216:219], v[120:123], v[140:143]
ds_read_b128 v[216:219], v240 offset:18432
v_mfma_f32_16x16x32_bf16 v[140:143], v[220:223], v[124:127], v[140:143]
ds_read_b128 v[220:223], v240 offset:18944
s_waitcnt lgkmcnt(2)
v_mfma_f32_16x16x32_bf16 v[144:147], v[208:211], v[0:3], 0
v_mfma_f32_16x16x32_bf16 v[144:147], v[212:215], v[4:7], v[144:147]
v_exp_f32 v232, v128
v_mfma_f32_16x16x32_bf16 v[148:151], v[208:211], v[32:35], 0
v_exp_f32 v233, v129
v_mfma_f32_16x16x32_bf16 v[148:151], v[212:215], v[36:39], v[148:151]
v_exp_f32 v234, v130
v_cvt_pk_bf16_f32 v176, v232, v233
v_mfma_f32_16x16x32_bf16 v[152:155], v[208:211], v[64:67], 0
v_exp_f32 v235, v131
v_mfma_f32_16x16x32_bf16 v[152:155], v[212:215], v[68:71], v[152:155]
v_exp_f32 v236, v132
v_cvt_pk_bf16_f32 v177, v234, v235
v_mfma_f32_16x16x32_bf16 v[156:159], v[208:211], v[96:99], 0
ds_read_b128 v[208:211], v240 offset:22528
v_exp_f32 v237, v133
v_mfma_f32_16x16x32_bf16 v[156:159], v[212:215], v[100:103], v[156:159]
ds_read_b128 v[212:215], v240 offset:23040
s_waitcnt lgkmcnt(2)
v_mfma_f32_16x16x32_bf16 v[144:147], v[216:219], v[8:11], v[144:147]
v_exp_f32 v238, v134
v_cvt_pk_bf16_f32 v180, v236, v237
v_mfma_f32_16x16x32_bf16 v[144:147], v[220:223], v[12:15], v[144:147]
v_exp_f32 v239, v135
v_mfma_f32_16x16x32_bf16 v[148:151], v[216:219], v[40:43], v[148:151]
v_exp_f32 v232, v136
v_cvt_pk_bf16_f32 v181, v238, v239
v_mfma_f32_16x16x32_bf16 v[148:151], v[220:223], v[44:47], v[148:151]
v_exp_f32 v233, v137
v_mfma_f32_16x16x32_bf16 v[152:155], v[216:219], v[72:75], v[152:155]
v_exp_f32 v234, v138
v_cvt_pk_bf16_f32 v184, v232, v233
v_mfma_f32_16x16x32_bf16 v[152:155], v[220:223], v[76:79], v[152:155]
v_exp_f32 v235, v139
v_mfma_f32_16x16x32_bf16 v[156:159], v[216:219], v[104:107], v[156:159]
ds_read_b128 v[216:219], v240 offset:26624
v_exp_f32 v236, v140
v_mfma_f32_16x16x32_bf16 v[156:159], v[220:223], v[108:111], v[156:159]
ds_read_b128 v[220:223], v240 offset:27136
s_waitcnt lgkmcnt(2)
v_cvt_pk_bf16_f32 v185, v234, v235
v_mfma_f32_16x16x32_bf16 v[144:147], v[208:211], v[16:19], v[144:147]
v_exp_f32 v237, v141
v_mfma_f32_16x16x32_bf16 v[144:147], v[212:215], v[20:23], v[144:147]
s_waitcnt vmcnt(6)
s_barrier
v_mfma_f32_16x16x32_bf16 v[148:151], v[208:211], v[48:51], v[148:151]
v_exp_f32 v238, v142
v_cvt_pk_bf16_f32 v188, v236, v237
v_mfma_f32_16x16x32_bf16 v[148:151], v[212:215], v[52:55], v[148:151]
v_exp_f32 v239, v143
v_or3_b32 v242, v176, v177, v180
v_mfma_f32_16x16x32_bf16 v[152:155], v[208:211], v[80:83], v[152:155]
v_cvt_pk_bf16_f32 v189, v238, v239
v_or3_b32 v242, v242, v181, v184
v_or3_b32 v242, v242, v185, v188
v_mfma_f32_16x16x32_bf16 v[152:155], v[212:215], v[84:87], v[152:155]
v_or_b32 v242, v242, v189
v_lshl_or_b32 v242, v242, 16, v242
v_cmp_le_u32 vcc, 2.0, v242
s_cbranch_vccnz L2_rare_site14
L2_ret14:
v_mfma_f32_16x16x32_bf16 v[156:159], v[208:211], v[112:115], v[156:159]
ds_read_b128 v[208:211], v230 offset:12800
v_mfma_f32_16x16x32_bf16 v[156:159], v[212:215], v[116:119], v[156:159]
ds_read_b128 v[212:215], v230 offset:12288
s_waitcnt lgkmcnt(2)
v_mfma_f32_16x16x32_bf16 v[144:147], v[216:219], v[24:27], v[144:147]
v_mfma_f32_16x16x32_bf16 v[144:147], v[220:223], v[28:31], v[144:147]
v_mfma_f32_16x16x32_bf16 v[148:151], v[216:219], v[56:59], v[148:151]
v_mfma_f32_16x16x32_bf16 v[148:151], v[220:223], v[60:63], v[148:151]
v_mfma_f32_16x16x32_bf16 v[152:155], v[216:219], v[88:91], v[152:155]
v_mfma_f32_16x16x32_bf16 v[152:155], v[220:223], v[92:95], v[152:155]
v_mfma_f32_16x16x32_bf16 v[156:159], v[216:219], v[120:123], v[156:159]
ds_read_b128 v[216:219], v230 offset:0
v_mfma_f32_16x16x32_bf16 v[156:159], v[220:223], v[124:127], v[156:159]
ds_read_b128 v[220:223], v230 offset:512
s_waitcnt lgkmcnt(2)
v_mfma_f32_16x16x32_bf16 v[128:131], v[208:211], v[0:3], 0
v_mfma_f32_16x16x32_bf16 v[128:131], v[212:215], v[4:7], v[128:131]
v_exp_f32 v232, v144
v_mfma_f32_16x16x32_bf16 v[132:135], v[208:211], v[32:35], 0
v_exp_f32 v233, v145
v_mfma_f32_16x16x32_bf16 v[132:135], v[212:215], v[36:39], v[132:135]
v_exp_f32 v234, v146
v_cvt_pk_bf16_f32 v178, v232, v233
v_mfma_f32_16x16x32_bf16 v[136:139], v[208:211], v[64:67], 0
v_exp_f32 v235, v147
v_lshlrev_b32 v241, 3, v243
v_mfma_f32_16x16x32_bf16 v[136:139], v[212:215], v[68:71], v[136:139]
v_exp_f32 v236, v148
v_cvt_pk_bf16_f32 v179, v234, v235
v_mfma_f32_16x16x32_bf16 v[140:143], v[208:211], v[96:99], 0
ds_read_b128 v[208:211], v230 offset:4096
v_exp_f32 v237, v149
v_mfma_f32_16x16x32_bf16 v[140:143], v[212:215], v[100:103], v[140:143]
ds_read_b128 v[212:215], v230 offset:4608
s_waitcnt lgkmcnt(2)
s_mov_b32 s3, 0x7c28000
v_mfma_f32_16x16x32_bf16 v[128:131], v[216:219], v[8:11], v[128:131]
v_exp_f32 v238, v150
v_cvt_pk_bf16_f32 v182, v236, v237
v_mfma_f32_16x16x32_bf16 v[128:131], v[220:223], v[12:15], v[128:131]
v_exp_f32 v239, v151
buffer_load_dwordx2 v[240:241], v241, s[16:19], s3 offen sc1
v_mfma_f32_16x16x32_bf16 v[132:135], v[216:219], v[40:43], v[132:135]
v_exp_f32 v232, v152
v_cvt_pk_bf16_f32 v183, v238, v239
v_mfma_f32_16x16x32_bf16 v[132:135], v[220:223], v[44:47], v[132:135]
v_exp_f32 v233, v153
v_mfma_f32_16x16x32_bf16 v[136:139], v[216:219], v[72:75], v[136:139]
v_exp_f32 v234, v154
v_cvt_pk_bf16_f32 v186, v232, v233
v_mfma_f32_16x16x32_bf16 v[136:139], v[220:223], v[76:79], v[136:139]
v_exp_f32 v235, v155
v_mfma_f32_16x16x32_bf16 v[140:143], v[216:219], v[104:107], v[140:143]
ds_read_b128 v[216:219], v230 offset:8192
v_exp_f32 v236, v156
v_mfma_f32_16x16x32_bf16 v[140:143], v[220:223], v[108:111], v[140:143]
ds_read_b128 v[220:223], v230 offset:8704
s_waitcnt lgkmcnt(2)
v_cvt_pk_bf16_f32 v187, v234, v235
v_mfma_f32_16x16x32_bf16 v[128:131], v[208:211], v[16:19], v[128:131]
v_exp_f32 v237, v157
v_mfma_f32_16x16x32_bf16 v[128:131], v[212:215], v[20:23], v[128:131]
v_exp_f32 v238, v158
v_cvt_pk_bf16_f32 v190, v236, v237
v_mfma_f32_16x16x32_bf16 v[132:135], v[208:211], v[48:51], v[132:135]
v_exp_f32 v239, v159
v_or3_b32 v242, v178, v179, v182
v_mfma_f32_16x16x32_bf16 v[132:135], v[212:215], v[52:55], v[132:135]
v_cvt_pk_bf16_f32 v191, v238, v239
v_or3_b32 v242, v242, v183, v186
v_or3_b32 v242, v242, v187, v190
v_mfma_f32_16x16x32_bf16 v[136:139], v[208:211], v[80:83], v[136:139]
v_or_b32 v242, v242, v191
v_lshl_or_b32 v242, v242, 16, v242
v_cmp_le_u32 vcc, 2.0, v242
s_cbranch_vccnz L2_rare_site15
L2_ret15:
v_mfma_f32_16x16x32_bf16 v[136:139], v[212:215], v[84:87], v[136:139]
v_mfma_f32_16x16x32_bf16 v[140:143], v[208:211], v[112:115], v[140:143]
ds_read_b128 v[208:211], v230 offset:14848
v_mfma_f32_16x16x32_bf16 v[140:143], v[212:215], v[116:119], v[140:143]
ds_read_b128 v[212:215], v230 offset:14336
s_waitcnt lgkmcnt(2)
v_mfma_f32_16x16x32_bf16 v[128:131], v[216:219], v[24:27], v[128:131]
v_mfma_f32_16x16x32_bf16 v[128:131], v[220:223], v[28:31], v[128:131]
v_mfma_f32_16x16x32_bf16 v[132:135], v[216:219], v[56:59], v[132:135]
v_mfma_f32_16x16x32_bf16 v[132:135], v[220:223], v[60:63], v[132:135]
v_mfma_f32_16x16x32_bf16 v[136:139], v[216:219], v[88:91], v[136:139]
v_mfma_f32_16x16x32_bf16 v[136:139], v[220:223], v[92:95], v[136:139]
v_mfma_f32_16x16x32_bf16 v[140:143], v[216:219], v[120:123], v[140:143]
ds_read_b128 v[216:219], v230 offset:2048
v_mfma_f32_16x16x32_bf16 v[140:143], v[220:223], v[124:127], v[140:143]
ds_read_b128 v[220:223], v230 offset:2560
s_waitcnt lgkmcnt(2)
v_mfma_f32_16x16x32_bf16 v[144:147], v[208:211], v[0:3], 0
v_mfma_f32_16x16x32_bf16 v[144:147], v[212:215], v[4:7], v[144:147]
v_mfma_f32_16x16x32_bf16 v[148:151], v[208:211], v[32:35], 0
v_mfma_f32_16x16x32_bf16 v[148:151], v[212:215], v[36:39], v[148:151]
v_mfma_f32_16x16x32_bf16 v[152:155], v[208:211], v[64:67], 0
v_exp_f32 v232, v128
v_mfma_f32_16x16x32_bf16 v[152:155], v[212:215], v[68:71], v[152:155]
v_exp_f32 v233, v129
v_mfma_f32_16x16x32_bf16 v[156:159], v[208:211], v[96:99], 0
ds_read_b128 v[208:211], v230 offset:6144
v_exp_f32 v234, v130
v_mfma_f32_16x16x32_bf16 v[156:159], v[212:215], v[100:103], v[156:159]
ds_read_b128 v[212:215], v230 offset:6656
s_waitcnt lgkmcnt(2)
v_cvt_pk_bf16_f32 v0, v232, v233
v_mfma_f32_16x16x32_bf16 v[144:147], v[216:219], v[8:11], v[144:147]
v_exp_f32 v235, v131
v_mfma_f32_16x16x32_bf16 v[144:147], v[220:223], v[12:15], v[144:147]
ds_read_b128 v[4:7], v231 offset:0
v_exp_f32 v236, v132
v_mfma_f32_16x16x32_bf16 v[148:151], v[216:219], v[40:43], v[148:151]
ds_read_b128 v[36:39], v231 offset:1024
v_cvt_pk_bf16_f32 v1, v234, v235
v_mfma_f32_16x16x32_bf16 v[148:151], v[220:223], v[44:47], v[148:151]
v_exp_f32 v237, v133
v_mfma_f32_16x16x32_bf16 v[152:155], v[216:219], v[72:75], v[152:155]
v_exp_f32 v238, v134
v_cvt_pk_bf16_f32 v32, v236, v237
v_mfma_f32_16x16x32_bf16 v[152:155], v[220:223], v[76:79], v[152:155]
ds_read_b128 v[68:71], v231 offset:2048
ds_read_b128 v[8:11], v231 offset:4096
v_mfma_f32_16x16x32_bf16 v[156:159], v[216:219], v[104:107], v[156:159]
ds_read_b128 v[216:219], v230 offset:10240
v_add_u32 v12, 0x8000, v246
v_and_b32 v12, 0x1ffff, v12
ds_read_b128 v[100:103], v231 offset:3072
ds_read_b128 v[40:43], v231 offset:5120
v_mfma_f32_16x16x32_bf16 v[156:159], v[220:223], v[108:111], v[156:159]
ds_read_b128 v[220:223], v230 offset:10752
s_waitcnt lgkmcnt(2)
v_add_u32 v14, 0x10000, v246
v_and_b32 v14, 0x1ffff, v14
v_mfma_f32_16x16x32_bf16 v[144:147], v[208:211], v[16:19], v[144:147]
v_xor_b32 v13, 32, v12
v_xor_b32 v15, 32, v14
v_mfma_f32_16x16x32_bf16 v[144:147], v[212:215], v[20:23], v[144:147]
ds_read_b128 v[72:75], v231 offset:6144
v_exp_f32 v239, v135
v_mfma_f32_16x16x32_bf16 v[148:151], v[208:211], v[48:51], v[148:151]
ds_read_b128 v[104:107], v231 offset:7168
v_exp_f32 v232, v136
v_mfma_f32_16x16x32_bf16 v[148:151], v[212:215], v[52:55], v[148:151]
v_cvt_pk_bf16_f32 v33, v238, v239
v_exp_f32 v233, v137
v_mfma_f32_16x16x32_bf16 v[152:155], v[208:211], v[80:83], v[152:155]
v_exp_f32 v234, v138
v_cvt_pk_bf16_f32 v64, v232, v233
v_mfma_f32_16x16x32_bf16 v[152:155], v[212:215], v[84:87], v[152:155]
v_exp_f32 v235, v139
v_mfma_f32_16x16x32_bf16 v[156:159], v[208:211], v[112:115], v[156:159]
ds_read_b64_tr_b16 v[208:209], v246 offset:12800
ds_read_b64_tr_b16 v[210:211], v246 offset:14848
v_mfma_f32_16x16x32_bf16 v[156:159], v[212:215], v[116:119], v[156:159]
ds_read_b64_tr_b16 v[212:213], v246 offset:29184
s_waitcnt lgkmcnt(3)
v_mfma_f32_16x16x32_bf16 v[144:147], v[216:219], v[24:27], v[144:147]
ds_read_b64_tr_b16 v[214:215], v246 offset:31232
v_exp_f32 v236, v140
v_mfma_f32_16x16x32_bf16 v[144:147], v[220:223], v[28:31], v[144:147]
v_cvt_pk_bf16_f32 v65, v234, v235
v_exp_f32 v237, v141
v_mfma_f32_16x16x32_bf16 v[148:151], v[216:219], v[56:59], v[148:151]
v_exp_f32 v238, v142
v_cvt_pk_bf16_f32 v96, v236, v237
v_mfma_f32_16x16x32_bf16 v[148:151], v[220:223], v[60:63], v[148:151]
v_exp_f32 v239, v143
v_or3_b32 v242, v0, v1, v32
v_mfma_f32_16x16x32_bf16 v[152:155], v[216:219], v[88:91], v[152:155]
v_cvt_pk_bf16_f32 v97, v238, v239
v_or3_b32 v242, v242, v33, v64
v_or3_b32 v242, v242, v65, v96
v_mfma_f32_16x16x32_bf16 v[152:155], v[220:223], v[92:95], v[152:155]
v_or_b32 v242, v242, v97
v_lshl_or_b32 v242, v242, 16, v242
v_cmp_le_u32 vcc, 2.0, v242
s_cbranch_vccnz L2_rare_site16
L2_ret16:
v_mfma_f32_16x16x32_bf16 v[156:159], v[216:219], v[120:123], v[156:159]
ds_read_b64_tr_b16 v[216:217], v12 offset:12800
ds_read_b64_tr_b16 v[218:219], v12 offset:14848
s_waitcnt vmcnt(0)
v_mfma_f32_16x16x32_bf16 v[156:159], v[220:223], v[124:127], v[156:159]
ds_read_b64_tr_b16 v[220:221], v12 offset:29184
s_waitcnt lgkmcnt(3)
v_cmp_ne_u64_e64 s[38:39], s[98:99], v[240:241]
v_mfma_f32_16x16x32_bf16 a[224:227], v[4:7], v[208:211], a[224:227]
ds_read_b64_tr_b16 v[222:223], v12 offset:31232
s_and_b64 s[38:39], s[38:39], s[96:97]
s_cbranch_scc1 LF_hl_0
LF_hlret_0:
v_mfma_f32_16x16x32_bf16 a[224:227], v[8:11], v[212:215], a[224:227]
v_exp_f32 v232, v144
v_lshrrev_b32 v241, 4, v243
v_mfma_f32_16x16x32_bf16 a[228:231], v[36:39], v[208:211], a[228:231]
v_exp_f32 v233, v145
v_and_b32 v241, 0x30, v241
v_mfma_f32_16x16x32_bf16 a[228:231], v[40:43], v[212:215], a[228:231]
v_exp_f32 v234, v146
v_xor_b32 v241, v241, v243
v_mfma_f32_16x16x32_bf16 a[232:235], v[68:71], v[208:211], a[232:235]
v_cvt_pk_bf16_f32 v2, v232, v233
v_and_b32 v228, 0x380, v243
v_mad_u32_u24 v241, v228, 3, v241
v_mfma_f32_16x16x32_bf16 a[232:235], v[72:75], v[212:215], a[232:235]
v_exp_f32 v235, v147
v_add_u32 v241, 0x7000000, v241
v_mfma_f32_16x16x32_bf16 a[236:239], v[100:103], v[208:211], a[236:239]
ds_read_b64_tr_b16 v[208:209], v247 offset:12800
ds_read_b64_tr_b16 v[210:211], v247 offset:14848
v_and_b32 v110, 0x70, v243
v_mfma_f32_16x16x32_bf16 a[236:239], v[104:107], v[212:215], a[236:239]
ds_read_b64_tr_b16 v[212:213], v247 offset:29184
s_waitcnt lgkmcnt(3)
v_lshlrev_b32 v110, 3, v110
v_mfma_f32_16x16x32_bf16 a[224:227], v[160:163], v[216:219], a[224:227]
ds_read_b64_tr_b16 v[214:215], v247 offset:31232
v_add_u32 v110, 0x7c32000, v110
buffer_load_dwordx2 v[108:109], v110, s[16:19], 0 offen sc1
v_mfma_f32_16x16x32_bf16 a[224:227], v[176:179], v[220:223], a[224:227]
v_exp_f32 v236, v148
v_mfma_f32_16x16x32_bf16 a[228:231], v[164:167], v[216:219], a[228:231]
v_cvt_pk_bf16_f32 v3, v234, v235
s_add_u32 m0, s28, 0
v_mfma_f32_16x16x32_bf16 a[228:231], v[180:183], v[220:223], a[228:231]
v_exp_f32 v237, v149
v_mfma_f32_16x16x32_bf16 a[232:235], v[168:171], v[216:219], a[232:235]
v_exp_f32 v238, v150
v_mfma_f32_16x16x32_bf16 a[232:235], v[184:187], v[220:223], a[232:235]
v_cvt_pk_bf16_f32 v34, v236, v237
buffer_load_dwordx4 v241, s[16:19], s6 offen sc1 lds
s_add_u32 m0, s28, 8192
v_mfma_f32_16x16x32_bf16 a[236:239], v[172:175], v[216:219], a[236:239]
ds_read_b64_tr_b16 v[216:217], v13 offset:12800
ds_read_b64_tr_b16 v[218:219], v13 offset:14848
v_mfma_f32_16x16x32_bf16 a[236:239], v[188:191], v[220:223], a[236:239]
ds_read_b64_tr_b16 v[220:221], v13 offset:29184
s_waitcnt lgkmcnt(3)
v_mfma_f32_16x16x32_bf16 a[240:243], v[4:7], v[208:211], a[240:243]
ds_read_b64_tr_b16 v[222:223], v13 offset:31232
buffer_load_dwordx4 v241, s[16:19], s7 offen sc1 lds
s_add_u32 m0, s30, 0
v_mfma_f32_16x16x32_bf16 a[240:243], v[8:11], v[212:215], a[240:243]
v_exp_f32 v239, v151
v_mfma_f32_16x16x32_bf16 a[244:247], v[36:39], v[208:211], a[244:247]
v_exp_f32 v232, v152
v_mfma_f32_16x16x32_bf16 a[244:247], v[40:43], v[212:215], a[244:247]
v_cvt_pk_bf16_f32 v35, v238, v239
buffer_load_dwordx4 v241, s[16:19], s29 offen sc1 lds
s_add_u32 m0, s28, 4096
v_mfma_f32_16x16x32_bf16 a[248:251], v[68:71], v[208:211], a[248:251]
v_exp_f32 v233, v153
v_xor_b32 v241, 0x1040, v241
v_mfma_f32_16x16x32_bf16 a[248:251], v[72:75], v[212:215], a[248:251]
v_exp_f32 v234, v154
v_mfma_f32_16x16x32_bf16 a[252:255], v[100:103], v[208:211], a[252:255]
ds_read_b64_tr_b16 v[208:209], v246 offset:16384
ds_read_b64_tr_b16 v[210:211], v246 offset:18432
v_mfma_f32_16x16x32_bf16 a[252:255], v[104:107], v[212:215], a[252:255]
ds_read_b64_tr_b16 v[212:213], v12 offset:0
s_waitcnt lgkmcnt(3)
v_mfma_f32_16x16x32_bf16 a[240:243], v[160:163], v[216:219], a[240:243]
ds_read_b64_tr_b16 v[214:215], v12 offset:2048
v_cvt_pk_bf16_f32 v66, v232, v233
v_mfma_f32_16x16x32_bf16 a[240:243], v[176:179], v[220:223], a[240:243]
v_exp_f32 v235, v155
v_mfma_f32_16x16x32_bf16 a[244:247], v[164:167], v[216:219], a[244:247]
v_exp_f32 v236, v156
v_mfma_f32_16x16x32_bf16 a[244:247], v[180:183], v[220:223], a[244:247]
v_cvt_pk_bf16_f32 v67, v234, v235
buffer_load_dwordx4 v241, s[16:19], s6 offen sc1 lds
s_add_u32 m0, s28, 12288
v_mfma_f32_16x16x32_bf16 a[248:251], v[168:171], v[216:219], a[248:251]
v_exp_f32 v237, v157
v_mfma_f32_16x16x32_bf16 a[248:251], v[184:187], v[220:223], a[248:251]
v_exp_f32 v238, v158
v_mfma_f32_16x16x32_bf16 a[252:255], v[172:175], v[216:219], a[252:255]
ds_read_b64_tr_b16 v[216:217], v12 offset:16384
ds_read_b64_tr_b16 v[218:219], v12 offset:18432
v_mfma_f32_16x16x32_bf16 a[252:255], v[188:191], v[220:223], a[252:255]
ds_read_b64_tr_b16 v[220:221], v247 offset:16384
s_waitcnt lgkmcnt(3)
v_mfma_f32_16x16x32_bf16 a[0:3], v[8:11], v[208:211], a[0:3]
ds_read_b64_tr_b16 v[222:223], v247 offset:18432
v_cvt_pk_bf16_f32 v98, v236, v237
v_mfma_f32_16x16x32_bf16 a[0:3], v[160:163], v[212:215], a[0:3]
v_exp_f32 v239, v159
v_mfma_f32_16x16x32_bf16 a[4:7], v[40:43], v[208:211], a[4:7]
v_or3_b32 v242, v2, v3, v34
v_cvt_pk_bf16_f32 v99, v238, v239
v_mfma_f32_16x16x32_bf16 a[4:7], v[164:167], v[212:215], a[4:7]
v_or3_b32 v242, v242, v35, v66
v_or3_b32 v242, v242, v67, v98
v_mfma_f32_16x16x32_bf16 a[8:11], v[72:75], v[208:211], a[8:11]
v_or_b32 v242, v242, v99
v_lshl_or_b32 v242, v242, 16, v242
v_mfma_f32_16x16x32_bf16 a[8:11], v[168:171], v[212:215], a[8:11]
v_cmp_le_u32 vcc, 2.0, v242
s_cbranch_vccnz L2_rare_site17
L2_ret17:
v_mfma_f32_16x16x32_bf16 a[12:15], v[104:107], v[208:211], a[12:15]
ds_read_b64_tr_b16 v[208:209], v13 offset:0
ds_read_b64_tr_b16 v[210:211], v13 offset:2048
v_mfma_f32_16x16x32_bf16 a[12:15], v[172:175], v[212:215], a[12:15]
ds_read_b64_tr_b16 v[212:213], v13 offset:16384
s_waitcnt lgkmcnt(5)
v_mfma_f32_16x16x32_bf16 a[0:3], v[176:179], v[216:219], a[0:3]
ds_read_b64_tr_b16 v[214:215], v13 offset:18432
buffer_load_dwordx4 v241, s[16:19], s7 offen sc1 lds
s_add_u32 m0, s30, 4096
v_mfma_f32_16x16x32_bf16 a[4:7], v[180:183], v[216:219], a[4:7]
buffer_load_dwordx4 v241, s[16:19], s29 offen sc1 lds
v_mfma_f32_16x16x32_bf16 a[8:11], v[184:187], v[216:219], a[8:11]
v_mfma_f32_16x16x32_bf16 a[12:15], v[188:191], v[216:219], a[12:15]
ds_read_b64_tr_b16 v[216:217], v14 offset:12800
s_waitcnt lgkmcnt(5)
v_mfma_f32_16x16x32_bf16 a[16:19], v[8:11], v[220:223], a[16:19]
ds_read_b64_tr_b16 v[218:219], v14 offset:14848
v_mfma_f32_16x16x32_bf16 a[20:23], v[40:43], v[220:223], a[20:23]
v_mfma_f32_16x16x32_bf16 a[24:27], v[72:75], v[220:223], a[24:27]
v_mfma_f32_16x16x32_bf16 a[28:31], v[104:107], v[220:223], a[28:31]
ds_read_b64_tr_b16 v[220:221], v15 offset:12800
s_waitcnt lgkmcnt(3)
v_mfma_f32_16x16x32_bf16 a[16:19], v[160:163], v[208:211], a[16:19]
ds_read_b64_tr_b16 v[222:223], v15 offset:14848
v_mfma_f32_16x16x32_bf16 a[16:19], v[176:179], v[212:215], a[16:19]
v_mfma_f32_16x16x32_bf16 a[20:23], v[164:167], v[208:211], a[20:23]
v_mfma_f32_16x16x32_bf16 a[20:23], v[180:183], v[212:215], a[20:23]
v_mfma_f32_16x16x32_bf16 a[24:27], v[168:171], v[208:211], a[24:27]
v_mfma_f32_16x16x32_bf16 a[24:27], v[184:187], v[212:215], a[24:27]
v_mfma_f32_16x16x32_bf16 a[28:31], v[172:175], v[208:211], a[28:31]
ds_read_b64_tr_b16 v[208:209], v14 offset:0
ds_read_b64_tr_b16 v[210:211], v14 offset:2048
v_mfma_f32_16x16x32_bf16 a[28:31], v[188:191], v[212:215], a[28:31]
ds_read_b64_tr_b16 v[212:213], v15 offset:0
s_waitcnt lgkmcnt(5)
v_mfma_f32_16x16x32_bf16 a[224:227], v[0:3], v[216:219], a[224:227]
ds_read_b64_tr_b16 v[214:215], v15 offset:2048
v_lshrrev_b32 v228, 4, v243
v_and_b32 v228, 0x3c, v228
v_mfma_f32_16x16x32_bf16 a[228:231], v[32:35], v[216:219], a[228:231]
v_sub_f32 v224, 0, v224
v_sub_f32 v225, 0, v225
v_sub_f32 v226, 0, v226
v_mfma_f32_16x16x32_bf16 a[232:235], v[64:67], v[216:219], a[232:235]
v_sub_f32 v227, 0, v227
ds_bpermute_b32 v232, v228, v224
ds_bpermute_b32 v234, v228, v225
v_mfma_f32_16x16x32_bf16 a[236:239], v[96:99], v[216:219], a[236:239]
ds_read_b64_tr_b16 v[216:217], v246 offset:16896
s_waitcnt lgkmcnt(5)
ds_bpermute_b32 v236, v228, v226
v_mfma_f32_16x16x32_bf16 a[240:243], v[0:3], v[220:223], a[240:243]
ds_read_b64_tr_b16 v[218:219], v246 offset:18944
ds_bpermute_b32 v238, v228, v227
v_bfe_u32 v228, v243, 4, 1
v_mfma_f32_16x16x32_bf16 a[244:247], v[32:35], v[220:223], a[244:247]
v_mul_u32_u24 v228, 768, v228
v_lshl_add_u32 v228, s37, 7, v228
v_lshrrev_b32 v242, 6, v243
v_mfma_f32_16x16x32_bf16 a[248:251], v[64:67], v[220:223], a[248:251]
v_lshl_add_u32 v242, v242, 3, v228
v_accvgpr_read_b32 v128, a224
v_accvgpr_read_b32 v129, a225
v_mfma_f32_16x16x32_bf16 a[252:255], v[96:99], v[220:223], a[252:255]
ds_read_b64_tr_b16 v[220:221], v12 offset:512
s_waitcnt lgkmcnt(5)
v_accvgpr_read_b32 v130, a226
v_mfma_f32_16x16x32_bf16 a[0:3], v[0:3], v[208:211], a[0:3]
ds_read_b64_tr_b16 v[222:223], v12 offset:2560
v_accvgpr_read_b32 v131, a227
v_cvt_pk_bf16_f32 v28, v128, v129
v_mfma_f32_16x16x32_bf16 a[4:7], v[32:35], v[208:211], a[4:7]
v_cvt_pk_bf16_f32 v29, v130, v131
v_accvgpr_read_b32 v136, a228
v_accvgpr_read_b32 v137, a229
v_mfma_f32_16x16x32_bf16 a[8:11], v[64:67], v[208:211], a[8:11]
v_accvgpr_read_b32 v138, a230
v_accvgpr_read_b32 v139, a231
v_cvt_pk_bf16_f32 v60, v136, v137
v_mfma_f32_16x16x32_bf16 a[12:15], v[96:99], v[208:211], a[12:15]
ds_read_b64_tr_b16 v[208:209], v12 offset:16896
s_waitcnt lgkmcnt(5)
v_cvt_pk_bf16_f32 v61, v138, v139
v_mfma_f32_16x16x32_bf16 a[16:19], v[0:3], v[212:215], a[16:19]
ds_read_b64_tr_b16 v[210:211], v12 offset:18944
v_accvgpr_read_b32 v144, a232
v_accvgpr_read_b32 v145, a233
v_mfma_f32_16x16x32_bf16 a[20:23], v[32:35], v[212:215], a[20:23]
v_accvgpr_read_b32 v146, a234
v_accvgpr_read_b32 v147, a235
v_cvt_pk_bf16_f32 v92, v144, v145
v_mfma_f32_16x16x32_bf16 a[24:27], v[64:67], v[212:215], a[24:27]
v_cvt_pk_bf16_f32 v93, v146, v147
v_accvgpr_read_b32 v152, a236
v_accvgpr_read_b32 v153, a237
v_mfma_f32_16x16x32_bf16 a[28:31], v[96:99], v[212:215], a[28:31]
ds_read_b64_tr_b16 v[212:213], v14 offset:512
s_waitcnt lgkmcnt(3)
v_accvgpr_read_b32 v154, a238
v_mfma_f32_16x16x32_bf16 a[32:35], v[8:11], v[216:219], a[32:35]
ds_read_b64_tr_b16 v[214:215], v14 offset:2560
v_accvgpr_read_b32 v155, a239
v_cvt_pk_bf16_f32 v124, v152, v153
v_mfma_f32_16x16x32_bf16 a[32:35], v[160:163], v[220:223], a[32:35]
v_cvt_pk_bf16_f32 v125, v154, v155
v_accvgpr_read_b32 v132, a240
v_accvgpr_read_b32 v133, a241
v_mfma_f32_16x16x32_bf16 a[36:39], v[40:43], v[216:219], a[36:39]
v_accvgpr_read_b32 v134, a242
v_accvgpr_read_b32 v135, a243
v_cvt_pk_bf16_f32 v30, v132, v133
v_mfma_f32_16x16x32_bf16 a[36:39], v[164:167], v[220:223], a[36:39]
v_cvt_pk_bf16_f32 v31, v134, v135
buffer_store_dwordx4 v[28:31], v243, s[20:23], s44 offen offset:3072 sc1
ds_write_b128 v231, v[28:31] offset:7168
v_mfma_f32_16x16x32_bf16 a[40:43], v[72:75], v[216:219], a[40:43]
v_accvgpr_read_b32 v140, a244
v_accvgpr_read_b32 v141, a245
v_accvgpr_read_b32 v142, a246
v_mfma_f32_16x16x32_bf16 a[40:43], v[168:171], v[220:223], a[40:43]
v_accvgpr_read_b32 v143, a247
v_cvt_pk_bf16_f32 v62, v140, v141
v_cvt_pk_bf16_f32 v63, v142, v143
v_mfma_f32_16x16x32_bf16 a[44:47], v[104:107], v[216:219], a[44:47]
ds_read_b64_tr_b16 v[216:217], v247 offset:16896
ds_read_b64_tr_b16 v[218:219], v247 offset:18944
buffer_store_dwordx4 v[60:63], v243, s[20:23], s45 offen offset:3072 sc1
v_mfma_f32_16x16x32_bf16 a[44:47], v[172:175], v[220:223], a[44:47]
ds_read_b64_tr_b16 v[220:221], v13 offset:512
s_waitcnt lgkmcnt(3)
v_accvgpr_read_b32 v148, a248
v_mfma_f32_16x16x32_bf16 a[32:35], v[176:179], v[208:211], a[32:35]
ds_read_b64_tr_b16 v[222:223], v13 offset:2560
v_accvgpr_read_b32 v149, a249
v_accvgpr_read_b32 v150, a250
v_mfma_f32_16x16x32_bf16 a[32:35], v[0:3], v[212:215], a[32:35]
v_accvgpr_read_b32 v151, a251
v_cvt_pk_bf16_f32 v94, v148, v149
v_cvt_pk_bf16_f32 v95, v150, v151
v_mfma_f32_16x16x32_bf16 a[36:39], v[180:183], v[208:211], a[36:39]
buffer_store_dwordx4 v[92:95], v243, s[20:23], s46 offen offset:3072 sc1
v_accvgpr_read_b32 v156, a252
v_accvgpr_read_b32 v157, a253
v_mfma_f32_16x16x32_bf16 a[36:39], v[32:35], v[212:215], a[36:39]
v_accvgpr_read_b32 v158, a254
v_accvgpr_read_b32 v159, a255
v_cvt_pk_bf16_f32 v126, v156, v157
v_mfma_f32_16x16x32_bf16 a[40:43], v[184:187], v[208:211], a[40:43]
v_cvt_pk_bf16_f32 v127, v158, v159
buffer_store_dwordx4 v[124:127], v243, s[20:23], s47 offen offset:3072 sc1
v_mov_b32_dpp v233, v132 row_newbcast:15 row_mask:0xf bank_mask:0x1
v_mfma_f32_16x16x32_bf16 a[40:43], v[64:67], v[212:215], a[40:43]
v_mov_b32_dpp v235, v140 row_newbcast:15 row_mask:0xf bank_mask:0x1
v_mov_b32_dpp v237, v148 row_newbcast:15 row_mask:0xf bank_mask:0x1
v_mov_b32_dpp v239, v156 row_newbcast:15 row_mask:0xf bank_mask:0x1
v_mfma_f32_16x16x32_bf16 a[44:47], v[188:191], v[208:211], a[44:47]
ds_read_b64_tr_b16 v[208:209], v13 offset:16896
ds_read_b64_tr_b16 v[210:211], v13 offset:18944
v_mov_b32_dpp v233, v133 row_newbcast:15 row_mask:0xf bank_mask:0x2
v_mfma_f32_16x16x32_bf16 a[44:47], v[96:99], v[212:215], a[44:47]
ds_read_b64_tr_b16 v[212:213], v15 offset:512
s_waitcnt lgkmcnt(3)
v_mov_b32_dpp v235, v141 row_newbcast:15 row_mask:0xf bank_mask:0x2
v_mfma_f32_16x16x32_bf16 a[48:51], v[8:11], v[216:219], a[48:51]
ds_read_b64_tr_b16 v[214:215], v15 offset:2560
v_mov_b32_dpp v237, v149 row_newbcast:15 row_mask:0xf bank_mask:0x2
v_mov_b32_dpp v239, v157 row_newbcast:15 row_mask:0xf bank_mask:0x2
v_mfma_f32_16x16x32_bf16 a[48:51], v[160:163], v[220:223], a[48:51]
v_mov_b32_dpp v233, v134 row_newbcast:15 row_mask:0xf bank_mask:0x4
v_mov_b32_dpp v235, v142 row_newbcast:15 row_mask:0xf bank_mask:0x4
v_mov_b32_dpp v237, v150 row_newbcast:15 row_mask:0xf bank_mask:0x4
v_mfma_f32_16x16x32_bf16 a[52:55], v[40:43], v[216:219], a[52:55]
v_mov_b32_dpp v239, v158 row_newbcast:15 row_mask:0xf bank_mask:0x4
v_mov_b32_dpp v233, v135 row_newbcast:15 row_mask:0xf bank_mask:0x8
v_mov_b32_dpp v235, v143 row_newbcast:15 row_mask:0xf bank_mask:0x8
v_mfma_f32_16x16x32_bf16 a[52:55], v[164:167], v[220:223], a[52:55]
v_mov_b32_dpp v237, v151 row_newbcast:15 row_mask:0xf bank_mask:0x8
v_mov_b32_dpp v239, v159 row_newbcast:15 row_mask:0xf bank_mask:0x8
v_mfma_f32_16x16x32_bf16 a[56:59], v[72:75], v[216:219], a[56:59]
s_mov_b32 exec_lo, 0x33333333
s_mov_b32 exec_hi, 0x33333333
buffer_store_dwordx2 v[232:233], v242, s[24:27], s48 offen sc1
s_lshr_b32 s3, s41, 2
buffer_store_dwordx2 v[234:235], v242, s[24:27], s3 offen sc1
s_lshr_b32 s3, s42, 2
buffer_store_dwordx2 v[236:237], v242, s[24:27], s3 offen sc1
s_lshr_b32 s3, s43, 2
buffer_store_dwordx2 v[238:239], v242, s[24:27], s3 offen sc1
s_mov_b64 exec, -1
v_mfma_f32_16x16x32_bf16 a[56:59], v[168:171], v[220:223], a[56:59]
v_accvgpr_read_b32 v128, a0
v_accvgpr_read_b32 v129, a1
v_accvgpr_read_b32 v130, a2
v_mfma_f32_16x16x32_bf16 a[60:63], v[104:107], v[216:219], a[60:63]
ds_read_b64_tr_b16 v[216:217], v246 offset:20480
ds_read_b64_tr_b16 v[218:219], v246 offset:22528
v_accvgpr_read_b32 v131, a3
v_mfma_f32_16x16x32_bf16 a[60:63], v[172:175], v[220:223], a[60:63]
ds_read_b64_tr_b16 v[220:221], v12 offset:4096
s_waitcnt lgkmcnt(3)
v_cvt_pk_bf16_f32 v16, v128, v129
v_mfma_f32_16x16x32_bf16 a[48:51], v[176:179], v[208:211], a[48:51]
ds_read_b64_tr_b16 v[222:223], v12 offset:6144
v_cvt_pk_bf16_f32 v17, v130, v131
v_accvgpr_read_b32 v136, a4
v_mfma_f32_16x16x32_bf16 a[48:51], v[0:3], v[212:215], a[48:51]
v_accvgpr_read_b32 v137, a5
v_accvgpr_read_b32 v138, a6
v_accvgpr_read_b32 v139, a7
v_mfma_f32_16x16x32_bf16 a[52:55], v[180:183], v[208:211], a[52:55]
v_cvt_pk_bf16_f32 v48, v136, v137
v_cvt_pk_bf16_f32 v49, v138, v139
v_accvgpr_read_b32 v144, a8
v_mfma_f32_16x16x32_bf16 a[52:55], v[32:35], v[212:215], a[52:55]
v_accvgpr_read_b32 v145, a9
v_accvgpr_read_b32 v146, a10
v_accvgpr_read_b32 v147, a11
v_mfma_f32_16x16x32_bf16 a[56:59], v[184:187], v[208:211], a[56:59]
v_cvt_pk_bf16_f32 v80, v144, v145
v_cvt_pk_bf16_f32 v81, v146, v147
v_accvgpr_read_b32 v152, a12
v_mfma_f32_16x16x32_bf16 a[56:59], v[64:67], v[212:215], a[56:59]
v_accvgpr_read_b32 v153, a13
v_accvgpr_read_b32 v154, a14
v_accvgpr_read_b32 v155, a15
v_mfma_f32_16x16x32_bf16 a[60:63], v[188:191], v[208:211], a[60:63]
ds_read_b64_tr_b16 v[208:209], v12 offset:20480
ds_read_b64_tr_b16 v[210:211], v12 offset:22528
v_cvt_pk_bf16_f32 v112, v152, v153
v_mfma_f32_16x16x32_bf16 a[60:63], v[96:99], v[212:215], a[60:63]
ds_read_b64_tr_b16 v[212:213], v14 offset:4096
s_waitcnt lgkmcnt(3)
v_cvt_pk_bf16_f32 v113, v154, v155
v_mfma_f32_16x16x32_bf16 a[64:67], v[8:11], v[216:219], a[64:67]
ds_read_b64_tr_b16 v[214:215], v14 offset:6144
v_accvgpr_read_b32 v132, a16
v_accvgpr_read_b32 v133, a17
v_mfma_f32_16x16x32_bf16 a[64:67], v[160:163], v[220:223], a[64:67]
v_accvgpr_read_b32 v134, a18
v_accvgpr_read_b32 v135, a19
v_cvt_pk_bf16_f32 v18, v132, v133
v_mfma_f32_16x16x32_bf16 a[68:71], v[40:43], v[216:219], a[68:71]
v_cvt_pk_bf16_f32 v19, v134, v135
buffer_store_dwordx4 v[16:19], v243, s[20:23], s40 offen offset:0 sc1
ds_write_b128 v231, v[16:19] offset:0
v_mfma_f32_16x16x32_bf16 a[68:71], v[164:167], v[220:223], a[68:71]
v_accvgpr_read_b32 v140, a20
v_accvgpr_read_b32 v141, a21
v_accvgpr_read_b32 v142, a22
v_mfma_f32_16x16x32_bf16 a[72:75], v[72:75], v[216:219], a[72:75]
v_accvgpr_read_b32 v143, a23
v_cvt_pk_bf16_f32 v50, v140, v141
v_cvt_pk_bf16_f32 v51, v142, v143
v_mfma_f32_16x16x32_bf16 a[72:75], v[168:171], v[220:223], a[72:75]
buffer_store_dwordx4 v[48:51], v243, s[20:23], s41 offen offset:0 sc1
v_accvgpr_read_b32 v148, a24
v_accvgpr_read_b32 v149, a25
v_mfma_f32_16x16x32_bf16 a[76:79], v[104:107], v[216:219], a[76:79]
ds_read_b64_tr_b16 v[216:217], v247 offset:20480
ds_read_b64_tr_b16 v[218:219], v247 offset:22528
v_accvgpr_read_b32 v150, a26
v_mfma_f32_16x16x32_bf16 a[76:79], v[172:175], v[220:223], a[76:79]
ds_read_b64_tr_b16 v[220:221], v13 offset:4096
s_waitcnt lgkmcnt(3)
v_accvgpr_read_b32 v151, a27
v_mfma_f32_16x16x32_bf16 a[64:67], v[176:179], v[208:211], a[64:67]
ds_read_b64_tr_b16 v[222:223], v13 offset:6144
v_cvt_pk_bf16_f32 v82, v148, v149
v_cvt_pk_bf16_f32 v83, v150, v151
v_mfma_f32_16x16x32_bf16 a[64:67], v[0:3], v[212:215], a[64:67]
buffer_store_dwordx4 v[80:83], v243, s[20:23], s42 offen offset:0 sc1
v_accvgpr_read_b32 v156, a28
v_accvgpr_read_b32 v157, a29
v_mfma_f32_16x16x32_bf16 a[68:71], v[180:183], v[208:211], a[68:71]
v_accvgpr_read_b32 v158, a30
v_accvgpr_read_b32 v159, a31
v_cvt_pk_bf16_f32 v114, v156, v157
v_mfma_f32_16x16x32_bf16 a[68:71], v[32:35], v[212:215], a[68:71]
v_cvt_pk_bf16_f32 v115, v158, v159
buffer_store_dwordx4 v[112:115], v243, s[20:23], s43 offen offset:0 sc1
v_accvgpr_read_b32 v128, a32
v_mfma_f32_16x16x32_bf16 a[72:75], v[184:187], v[208:211], a[72:75]
v_accvgpr_read_b32 v129, a33
v_accvgpr_read_b32 v130, a34
v_accvgpr_read_b32 v131, a35
v_mfma_f32_16x16x32_bf16 a[72:75], v[64:67], v[212:215], a[72:75]
v_cvt_pk_bf16_f32 v20, v128, v129
v_cvt_pk_bf16_f32 v21, v130, v131
v_accvgpr_read_b32 v136, a36
v_mfma_f32_16x16x32_bf16 a[76:79], v[188:191], v[208:211], a[76:79]
ds_read_b64_tr_b16 v[208:209], v13 offset:20480
ds_read_b64_tr_b16 v[210:211], v13 offset:22528
v_accvgpr_read_b32 v137, a37
v_mfma_f32_16x16x32_bf16 a[76:79], v[96:99], v[212:215], a[76:79]
ds_read_b64_tr_b16 v[212:213], v15 offset:4096
s_waitcnt lgkmcnt(3)
v_accvgpr_read_b32 v138, a38
v_mfma_f32_16x16x32_bf16 a[80:83], v[8:11], v[216:219], a[80:83]
ds_read_b64_tr_b16 v[214:215], v15 offset:6144
v_accvgpr_read_b32 v139, a39
v_cvt_pk_bf16_f32 v52, v136, v137
v_mfma_f32_16x16x32_bf16 a[80:83], v[160:163], v[220:223], a[80:83]
v_cvt_pk_bf16_f32 v53, v138, v139
v_accvgpr_read_b32 v144, a40
v_accvgpr_read_b32 v145, a41
v_mfma_f32_16x16x32_bf16 a[84:87], v[40:43], v[216:219], a[84:87]
v_accvgpr_read_b32 v146, a42
v_accvgpr_read_b32 v147, a43
v_cvt_pk_bf16_f32 v84, v144, v145
v_mfma_f32_16x16x32_bf16 a[84:87], v[164:167], v[220:223], a[84:87]
v_cvt_pk_bf16_f32 v85, v146, v147
v_accvgpr_read_b32 v152, a44
v_accvgpr_read_b32 v153, a45
v_mfma_f32_16x16x32_bf16 a[88:91], v[72:75], v[216:219], a[88:91]
v_accvgpr_read_b32 v154, a46
v_accvgpr_read_b32 v155, a47
v_cvt_pk_bf16_f32 v116, v152, v153
v_mfma_f32_16x16x32_bf16 a[88:91], v[168:171], v[220:223], a[88:91]
v_cvt_pk_bf16_f32 v117, v154, v155
v_accvgpr_read_b32 v132, a48
v_accvgpr_read_b32 v133, a49
v_mfma_f32_16x16x32_bf16 a[92:95], v[104:107], v[216:219], a[92:95]
ds_read_b64_tr_b16 v[216:217], v246 offset:20992
ds_read_b64_tr_b16 v[218:219], v246 offset:23040
v_accvgpr_read_b32 v134, a50
v_mfma_f32_16x16x32_bf16 a[92:95], v[172:175], v[220:223], a[92:95]
ds_read_b64_tr_b16 v[220:221], v12 offset:4608
s_waitcnt lgkmcnt(3)
v_accvgpr_read_b32 v135, a51
v_mfma_f32_16x16x32_bf16 a[80:83], v[176:179], v[208:211], a[80:83]
ds_read_b64_tr_b16 v[222:223], v12 offset:6656
v_cvt_pk_bf16_f32 v22, v132, v133
v_cvt_pk_bf16_f32 v23, v134, v135
v_mfma_f32_16x16x32_bf16 a[80:83], v[0:3], v[212:215], a[80:83]
buffer_store_dwordx4 v[20:23], v243, s[20:23], s40 offen offset:1024 sc1
ds_write_b128 v231, v[20:23] offset:1024
v_accvgpr_read_b32 v140, a52
v_mfma_f32_16x16x32_bf16 a[84:87], v[180:183], v[208:211], a[84:87]
v_accvgpr_read_b32 v141, a53
v_accvgpr_read_b32 v142, a54
v_accvgpr_read_b32 v143, a55
v_mfma_f32_16x16x32_bf16 a[84:87], v[32:35], v[212:215], a[84:87]
v_cvt_pk_bf16_f32 v54, v140, v141
v_cvt_pk_bf16_f32 v55, v142, v143
buffer_store_dwordx4 v[52:55], v243, s[20:23], s41 offen offset:1024 sc1
v_mfma_f32_16x16x32_bf16 a[88:91], v[184:187], v[208:211], a[88:91]
v_accvgpr_read_b32 v148, a56
v_accvgpr_read_b32 v149, a57
v_accvgpr_read_b32 v150, a58
v_mfma_f32_16x16x32_bf16 a[88:91], v[64:67], v[212:215], a[88:91]
v_accvgpr_read_b32 v151, a59
v_cvt_pk_bf16_f32 v86, v148, v149
v_cvt_pk_bf16_f32 v87, v150, v151
v_mfma_f32_16x16x32_bf16 a[92:95], v[188:191], v[208:211], a[92:95]
ds_read_b64_tr_b16 v[208:209], v12 offset:20992
ds_read_b64_tr_b16 v[210:211], v12 offset:23040
buffer_store_dwordx4 v[84:87], v243, s[20:23], s42 offen offset:1024 sc1
v_mfma_f32_16x16x32_bf16 a[92:95], v[96:99], v[212:215], a[92:95]
ds_read_b64_tr_b16 v[212:213], v14 offset:4608
s_waitcnt lgkmcnt(3)
v_accvgpr_read_b32 v156, a60
v_mfma_f32_16x16x32_bf16 a[96:99], v[8:11], v[216:219], a[96:99]
ds_read_b64_tr_b16 v[214:215], v14 offset:6656
v_accvgpr_read_b32 v157, a61
v_accvgpr_read_b32 v158, a62
v_mfma_f32_16x16x32_bf16 a[96:99], v[160:163], v[220:223], a[96:99]
v_accvgpr_read_b32 v159, a63
v_cvt_pk_bf16_f32 v118, v156, v157
v_cvt_pk_bf16_f32 v119, v158, v159
v_mfma_f32_16x16x32_bf16 a[100:103], v[40:43], v[216:219], a[100:103]
buffer_store_dwordx4 v[116:119], v243, s[20:23], s43 offen offset:1024 sc1
v_accvgpr_read_b32 v128, a64
v_mfma_f32_16x16x32_bf16 a[100:103], v[164:167], v[220:223], a[100:103]
v_accvgpr_read_b32 v129, a65
v_accvgpr_read_b32 v130, a66
v_mfma_f32_16x16x32_bf16 a[104:107], v[72:75], v[216:219], a[104:107]
v_accvgpr_read_b32 v131, a67
v_cvt_pk_bf16_f32 v24, v128, v129
v_mfma_f32_16x16x32_bf16 a[104:107], v[168:171], v[220:223], a[104:107]
v_cvt_pk_bf16_f32 v25, v130, v131
v_accvgpr_read_b32 v136, a68
v_mfma_f32_16x16x32_bf16 a[108:111], v[104:107], v[216:219], a[108:111]
ds_read_b64_tr_b16 v[216:217], v247 offset:20992
ds_read_b64_tr_b16 v[218:219], v247 offset:23040
v_mfma_f32_16x16x32_bf16 a[108:111], v[172:175], v[220:223], a[108:111]
ds_read_b64_tr_b16 v[220:221], v13 offset:4608
s_waitcnt lgkmcnt(3)
v_mfma_f32_16x16x32_bf16 a[96:99], v[176:179], v[208:211], a[96:99]
ds_read_b64_tr_b16 v[222:223], v13 offset:6656
v_accvgpr_read_b32 v137, a69
v_mfma_f32_16x16x32_bf16 a[96:99], v[0:3], v[212:215], a[96:99]
v_accvgpr_read_b32 v138, a70
v_accvgpr_read_b32 v139, a71
v_mfma_f32_16x16x32_bf16 a[100:103], v[180:183], v[208:211], a[100:103]
v_cvt_pk_bf16_f32 v56, v136, v137
v_cvt_pk_bf16_f32 v57, v138, v139
v_mfma_f32_16x16x32_bf16 a[100:103], v[32:35], v[212:215], a[100:103]
v_accvgpr_read_b32 v144, a72
v_accvgpr_read_b32 v145, a73
v_mfma_f32_16x16x32_bf16 a[104:107], v[184:187], v[208:211], a[104:107]
v_accvgpr_read_b32 v146, a74
v_accvgpr_read_b32 v147, a75
v_mfma_f32_16x16x32_bf16 a[104:107], v[64:67], v[212:215], a[104:107]
v_cvt_pk_bf16_f32 v88, v144, v145
v_cvt_pk_bf16_f32 v89, v146, v147
v_mfma_f32_16x16x32_bf16 a[108:111], v[188:191], v[208:211], a[108:111]
ds_read_b64_tr_b16 v[208:209], v13 offset:20992
ds_read_b64_tr_b16 v[210:211], v13 offset:23040
v_mfma_f32_16x16x32_bf16 a[108:111], v[96:99], v[212:215], a[108:111]
ds_read_b64_tr_b16 v[212:213], v15 offset:4608
s_waitcnt lgkmcnt(3)
v_mfma_f32_16x16x32_bf16 a[112:115], v[8:11], v[216:219], a[112:115]
ds_read_b64_tr_b16 v[214:215], v15 offset:6656
v_accvgpr_read_b32 v152, a76
v_mfma_f32_16x16x32_bf16 a[112:115], v[160:163], v[220:223], a[112:115]
v_accvgpr_read_b32 v153, a77
v_accvgpr_read_b32 v154, a78
v_mfma_f32_16x16x32_bf16 a[116:119], v[40:43], v[216:219], a[116:119]
v_accvgpr_read_b32 v155, a79
v_cvt_pk_bf16_f32 v120, v152, v153
v_mfma_f32_16x16x32_bf16 a[116:119], v[164:167], v[220:223], a[116:119]
v_cvt_pk_bf16_f32 v121, v154, v155
v_accvgpr_read_b32 v132, a80
v_mfma_f32_16x16x32_bf16 a[120:123], v[72:75], v[216:219], a[120:123]
v_accvgpr_read_b32 v133, a81
v_accvgpr_read_b32 v134, a82
v_mfma_f32_16x16x32_bf16 a[120:123], v[168:171], v[220:223], a[120:123]
v_accvgpr_read_b32 v135, a83
v_cvt_pk_bf16_f32 v26, v132, v133
v_mfma_f32_16x16x32_bf16 a[124:127], v[104:107], v[216:219], a[124:127]
ds_read_b64_tr_b16 v[216:217], v246 offset:8192
ds_read_b64_tr_b16 v[218:219], v246 offset:10240
v_mfma_f32_16x16x32_bf16 a[124:127], v[172:175], v[220:223], a[124:127]
ds_read_b64_tr_b16 v[220:221], v246 offset:24576
s_waitcnt lgkmcnt(3)
v_mfma_f32_16x16x32_bf16 a[112:115], v[176:179], v[208:211], a[112:115]
ds_read_b64_tr_b16 v[222:223], v246 offset:26624
v_cvt_pk_bf16_f32 v27, v134, v135
v_mfma_f32_16x16x32_bf16 a[112:115], v[0:3], v[212:215], a[112:115]
buffer_store_dwordx4 v[24:27], v243, s[20:23], s40 offen offset:2048 sc1
ds_write_b128 v231, v[24:27] offset:2048
v_mfma_f32_16x16x32_bf16 a[116:119], v[180:183], v[208:211], a[116:119]
v_accvgpr_read_b32 v140, a84
v_accvgpr_read_b32 v141, a85
v_mfma_f32_16x16x32_bf16 a[116:119], v[32:35], v[212:215], a[116:119]
v_accvgpr_read_b32 v142, a86
v_accvgpr_read_b32 v143, a87
v_mfma_f32_16x16x32_bf16 a[120:123], v[184:187], v[208:211], a[120:123]
v_cvt_pk_bf16_f32 v58, v140, v141
v_cvt_pk_bf16_f32 v59, v142, v143
v_mfma_f32_16x16x32_bf16 a[120:123], v[64:67], v[212:215], a[120:123]
buffer_store_dwordx4 v[56:59], v243, s[20:23], s41 offen offset:2048 sc1
v_accvgpr_read_b32 v148, a88
v_mfma_f32_16x16x32_bf16 a[124:127], v[188:191], v[208:211], a[124:127]
ds_read_b64_tr_b16 v[208:209], v12 offset:8192
ds_read_b64_tr_b16 v[210:211], v12 offset:10240
v_mfma_f32_16x16x32_bf16 a[124:127], v[96:99], v[212:215], a[124:127]
ds_read_b64_tr_b16 v[212:213], v12 offset:24576
s_waitcnt lgkmcnt(3)
v_mfma_f32_16x16x32_bf16 a[128:131], v[4:7], v[216:219], a[128:131]
ds_read_b64_tr_b16 v[214:215], v12 offset:26624
v_accvgpr_read_b32 v149, a89
v_mfma_f32_16x16x32_bf16 a[128:131], v[8:11], v[220:223], a[128:131]
v_accvgpr_read_b32 v150, a90
v_accvgpr_read_b32 v151, a91
v_mfma_f32_16x16x32_bf16 a[132:135], v[36:39], v[216:219], a[132:135]
v_cvt_pk_bf16_f32 v90, v148, v149
v_cvt_pk_bf16_f32 v91, v150, v151
v_mfma_f32_16x16x32_bf16 a[132:135], v[40:43], v[220:223], a[132:135]
buffer_store_dwordx4 v[88:91], v243, s[20:23], s42 offen offset:2048 sc1
v_accvgpr_read_b32 v156, a92
v_mfma_f32_16x16x32_bf16 a[136:139], v[68:71], v[216:219], a[136:139]
v_accvgpr_read_b32 v157, a93
v_accvgpr_read_b32 v158, a94
v_mfma_f32_16x16x32_bf16 a[136:139], v[72:75], v[220:223], a[136:139]
v_accvgpr_read_b32 v159, a95
v_cvt_pk_bf16_f32 v122, v156, v157
v_mfma_f32_16x16x32_bf16 a[140:143], v[100:103], v[216:219], a[140:143]
ds_read_b64_tr_b16 v[216:217], v14 offset:8192
ds_read_b64_tr_b16 v[218:219], v14 offset:10240
v_mfma_f32_16x16x32_bf16 a[140:143], v[104:107], v[220:223], a[140:143]
ds_read_b64_tr_b16 v[220:221], v247 offset:8192
s_waitcnt lgkmcnt(3)
v_mfma_f32_16x16x32_bf16 a[128:131], v[160:163], v[208:211], a[128:131]
ds_read_b64_tr_b16 v[222:223], v247 offset:10240
v_cvt_pk_bf16_f32 v123, v158, v159
v_mfma_f32_16x16x32_bf16 a[128:131], v[176:179], v[212:215], a[128:131]
buffer_store_dwordx4 v[120:123], v243, s[20:23], s43 offen offset:2048 sc1
v_accvgpr_read_b32 v128, a96
v_mfma_f32_16x16x32_bf16 a[132:135], v[164:167], v[208:211], a[132:135]
v_accvgpr_read_b32 v129, a97
v_accvgpr_read_b32 v130, a98
v_mfma_f32_16x16x32_bf16 a[132:135], v[180:183], v[212:215], a[132:135]
v_accvgpr_read_b32 v131, a99
v_cvt_pk_bf16_f32 v28, v128, v129
v_mfma_f32_16x16x32_bf16 a[136:139], v[168:171], v[208:211], a[136:139]
v_cvt_pk_bf16_f32 v29, v130, v131
v_accvgpr_read_b32 v136, a100
v_mfma_f32_16x16x32_bf16 a[136:139], v[184:187], v[212:215], a[136:139]
v_accvgpr_read_b32 v137, a101
v_accvgpr_read_b32 v138, a102
v_mfma_f32_16x16x32_bf16 a[140:143], v[172:175], v[208:211], a[140:143]
ds_read_b64_tr_b16 v[208:209], v247 offset:24576
ds_read_b64_tr_b16 v[210:211], v247 offset:26624
v_mfma_f32_16x16x32_bf16 a[140:143], v[188:191], v[212:215], a[140:143]
ds_read_b64_tr_b16 v[212:213], v13 offset:8192
s_waitcnt lgkmcnt(5)
v_mfma_f32_16x16x32_bf16 a[128:131], v[0:3], v[216:219], a[128:131]
ds_read_b64_tr_b16 v[214:215], v13 offset:10240
v_accvgpr_read_b32 v139, a103
v_mfma_f32_16x16x32_bf16 a[132:135], v[32:35], v[216:219], a[132:135]
v_cvt_pk_bf16_f32 v60, v136, v137
v_cvt_pk_bf16_f32 v61, v138, v139
v_mfma_f32_16x16x32_bf16 a[136:139], v[64:67], v[216:219], a[136:139]
v_accvgpr_read_b32 v144, a104
v_accvgpr_read_b32 v145, a105
v_mfma_f32_16x16x32_bf16 a[140:143], v[96:99], v[216:219], a[140:143]
ds_read_b64_tr_b16 v[216:217], v13 offset:24576
s_waitcnt lgkmcnt(5)
v_mfma_f32_16x16x32_bf16 a[144:147], v[4:7], v[220:223], a[144:147]
ds_read_b64_tr_b16 v[218:219], v13 offset:26624
v_accvgpr_read_b32 v146, a106
v_mfma_f32_16x16x32_bf16 a[148:151], v[36:39], v[220:223], a[148:151]
v_accvgpr_read_b32 v147, a107
v_cvt_pk_bf16_f32 v92, v144, v145
v_mfma_f32_16x16x32_bf16 a[152:155], v[68:71], v[220:223], a[152:155]
v_cvt_pk_bf16_f32 v93, v146, v147
v_accvgpr_read_b32 v152, a108
v_mfma_f32_16x16x32_bf16 a[156:159], v[100:103], v[220:223], a[156:159]
ds_read_b64_tr_b16 v[220:221], v15 offset:8192
s_waitcnt lgkmcnt(3)
v_mfma_f32_16x16x32_bf16 a[144:147], v[8:11], v[208:211], a[144:147]
ds_read_b64_tr_b16 v[222:223], v15 offset:10240
v_accvgpr_read_b32 v153, a109
v_mfma_f32_16x16x32_bf16 a[144:147], v[160:163], v[212:215], a[144:147]
v_accvgpr_read_b32 v154, a110
v_accvgpr_read_b32 v155, a111
v_mfma_f32_16x16x32_bf16 a[148:151], v[40:43], v[208:211], a[148:151]
v_cvt_pk_bf16_f32 v124, v152, v153
v_cvt_pk_bf16_f32 v125, v154, v155
v_mfma_f32_16x16x32_bf16 a[148:151], v[164:167], v[212:215], a[148:151]
v_accvgpr_read_b32 v132, a112
v_accvgpr_read_b32 v133, a113
v_mfma_f32_16x16x32_bf16 a[152:155], v[72:75], v[208:211], a[152:155]
v_accvgpr_read_b32 v134, a114
v_accvgpr_read_b32 v135, a115
v_mfma_f32_16x16x32_bf16 a[152:155], v[168:171], v[212:215], a[152:155]
v_cvt_pk_bf16_f32 v30, v132, v133
v_cvt_pk_bf16_f32 v31, v134, v135
v_mfma_f32_16x16x32_bf16 a[156:159], v[104:107], v[208:211], a[156:159]
ds_read_b64_tr_b16 v[208:209], v246 offset:8704
ds_read_b64_tr_b16 v[210:211], v246 offset:10752
v_mfma_f32_16x16x32_bf16 a[156:159], v[172:175], v[212:215], a[156:159]
ds_read_b64_tr_b16 v[212:213], v246 offset:25088
s_waitcnt lgkmcnt(3)
v_mfma_f32_16x16x32_bf16 a[144:147], v[176:179], v[216:219], a[144:147]
ds_read_b64_tr_b16 v[214:215], v246 offset:27136
buffer_store_dwordx4 v[28:31], v243, s[20:23], s40 offen offset:3072 sc1
v_mfma_f32_16x16x32_bf16 a[144:147], v[0:3], v[220:223], a[144:147]
ds_write_b128 v231, v[28:31] offset:3072
v_accvgpr_read_b32 v140, a116
v_mfma_f32_16x16x32_bf16 a[148:151], v[180:183], v[216:219], a[148:151]
v_accvgpr_read_b32 v141, a117
v_accvgpr_read_b32 v142, a118
v_mfma_f32_16x16x32_bf16 a[148:151], v[32:35], v[220:223], a[148:151]
v_accvgpr_read_b32 v143, a119
v_cvt_pk_bf16_f32 v62, v140, v141
v_mfma_f32_16x16x32_bf16 a[152:155], v[184:187], v[216:219], a[152:155]
v_cvt_pk_bf16_f32 v63, v142, v143
buffer_store_dwordx4 v[60:63], v243, s[20:23], s41 offen offset:3072 sc1
v_mfma_f32_16x16x32_bf16 a[152:155], v[64:67], v[220:223], a[152:155]
v_accvgpr_read_b32 v148, a120
v_accvgpr_read_b32 v149, a121
v_mfma_f32_16x16x32_bf16 a[156:159], v[188:191], v[216:219], a[156:159]
ds_read_b64_tr_b16 v[216:217], v12 offset:8704
ds_read_b64_tr_b16 v[218:219], v12 offset:10752
v_mfma_f32_16x16x32_bf16 a[156:159], v[96:99], v[220:223], a[156:159]
ds_read_b64_tr_b16 v[220:221], v12 offset:25088
s_waitcnt lgkmcnt(3)
v_mfma_f32_16x16x32_bf16 a[160:163], v[4:7], v[208:211], a[160:163]
ds_read_b64_tr_b16 v[222:223], v12 offset:27136
v_accvgpr_read_b32 v150, a122
v_mfma_f32_16x16x32_bf16 a[160:163], v[8:11], v[212:215], a[160:163]
v_accvgpr_read_b32 v151, a123
v_cvt_pk_bf16_f32 v94, v148, v149
v_mfma_f32_16x16x32_bf16 a[164:167], v[36:39], v[208:211], a[164:167]
v_cvt_pk_bf16_f32 v95, v150, v151
buffer_store_dwordx4 v[92:95], v243, s[20:23], s42 offen offset:3072 sc1
v_mfma_f32_16x16x32_bf16 a[164:167], v[40:43], v[212:215], a[164:167]
v_accvgpr_read_b32 v156, a124
v_accvgpr_read_b32 v157, a125
v_mfma_f32_16x16x32_bf16 a[168:171], v[68:71], v[208:211], a[168:171]
v_accvgpr_read_b32 v158, a126
v_accvgpr_read_b32 v159, a127
v_mfma_f32_16x16x32_bf16 a[168:171], v[72:75], v[212:215], a[168:171]
v_cvt_pk_bf16_f32 v126, v156, v157
v_cvt_pk_bf16_f32 v127, v158, v159
v_mfma_f32_16x16x32_bf16 a[172:175], v[100:103], v[208:211], a[172:175]
ds_read_b64_tr_b16 v[208:209], v14 offset:8704
ds_read_b64_tr_b16 v[210:211], v14 offset:10752
v_mfma_f32_16x16x32_bf16 a[172:175], v[104:107], v[212:215], a[172:175]
ds_read_b64_tr_b16 v[212:213], v247 offset:8704
s_waitcnt lgkmcnt(3)
v_mfma_f32_16x16x32_bf16 a[160:163], v[160:163], v[216:219], a[160:163]
ds_read_b64_tr_b16 v[214:215], v247 offset:10752
buffer_store_dwordx4 v[124:127], v243, s[20:23], s43 offen offset:3072 sc1
v_mfma_f32_16x16x32_bf16 a[160:163], v[176:179], v[220:223], a[160:163]
v_accvgpr_read_b32 v128, a128
v_accvgpr_read_b32 v129, a129
v_mfma_f32_16x16x32_bf16 a[164:167], v[164:167], v[216:219], a[164:167]
v_accvgpr_read_b32 v130, a130
v_accvgpr_read_b32 v131, a131
v_mfma_f32_16x16x32_bf16 a[164:167], v[180:183], v[220:223], a[164:167]
v_cvt_pk_bf16_f32 v16, v128, v129
v_cvt_pk_bf16_f32 v17, v130, v131
v_mfma_f32_16x16x32_bf16 a[168:171], v[168:171], v[216:219], a[168:171]
v_accvgpr_read_b32 v136, a132
v_accvgpr_read_b32 v137, a133
v_mfma_f32_16x16x32_bf16 a[168:171], v[184:187], v[220:223], a[168:171]
v_accvgpr_read_b32 v138, a134
v_accvgpr_read_b32 v139, a135
v_mfma_f32_16x16x32_bf16 a[172:175], v[172:175], v[216:219], a[172:175]
ds_read_b64_tr_b16 v[216:217], v247 offset:25088
ds_read_b64_tr_b16 v[218:219], v247 offset:27136
v_mfma_f32_16x16x32_bf16 a[172:175], v[188:191], v[220:223], a[172:175]
ds_read_b64_tr_b16 v[220:221], v13 offset:8704
s_waitcnt lgkmcnt(5)
v_mfma_f32_16x16x32_bf16 a[160:163], v[0:3], v[208:211], a[160:163]
ds_read_b64_tr_b16 v[222:223], v13 offset:10752
v_cvt_pk_bf16_f32 v48, v136, v137
v_mfma_f32_16x16x32_bf16 a[164:167], v[32:35], v[208:211], a[164:167]
v_cvt_pk_bf16_f32 v49, v138, v139
v_accvgpr_read_b32 v144, a136
v_mfma_f32_16x16x32_bf16 a[168:171], v[64:67], v[208:211], a[168:171]
v_accvgpr_read_b32 v145, a137
v_accvgpr_read_b32 v146, a138
v_mfma_f32_16x16x32_bf16 a[172:175], v[96:99], v[208:211], a[172:175]
ds_read_b64_tr_b16 v[208:209], v13 offset:25088
s_waitcnt lgkmcnt(5)
v_mfma_f32_16x16x32_bf16 a[176:179], v[4:7], v[212:215], a[176:179]
ds_read_b64_tr_b16 v[210:211], v13 offset:27136
v_accvgpr_read_b32 v147, a139
v_mfma_f32_16x16x32_bf16 a[180:183], v[36:39], v[212:215], a[180:183]
v_cvt_pk_bf16_f32 v80, v144, v145
v_cvt_pk_bf16_f32 v81, v146, v147
v_mfma_f32_16x16x32_bf16 a[184:187], v[68:71], v[212:215], a[184:187]
v_accvgpr_read_b32 v152, a140
v_accvgpr_read_b32 v153, a141
v_mfma_f32_16x16x32_bf16 a[188:191], v[100:103], v[212:215], a[188:191]
ds_read_b64_tr_b16 v[212:213], v15 offset:8704
s_waitcnt lgkmcnt(3)
v_mfma_f32_16x16x32_bf16 a[176:179], v[8:11], v[216:219], a[176:179]
ds_read_b64_tr_b16 v[214:215], v15 offset:10752
v_accvgpr_read_b32 v154, a142
v_mfma_f32_16x16x32_bf16 a[176:179], v[160:163], v[220:223], a[176:179]
v_accvgpr_read_b32 v155, a143
v_cvt_pk_bf16_f32 v112, v152, v153
v_mfma_f32_16x16x32_bf16 a[180:183], v[40:43], v[216:219], a[180:183]
v_cvt_pk_bf16_f32 v113, v154, v155
v_accvgpr_read_b32 v132, a144
v_mfma_f32_16x16x32_bf16 a[180:183], v[164:167], v[220:223], a[180:183]
v_accvgpr_read_b32 v133, a145
v_accvgpr_read_b32 v134, a146
v_mfma_f32_16x16x32_bf16 a[184:187], v[72:75], v[216:219], a[184:187]
v_accvgpr_read_b32 v135, a147
v_cvt_pk_bf16_f32 v18, v132, v133
v_mfma_f32_16x16x32_bf16 a[184:187], v[168:171], v[220:223], a[184:187]
v_cvt_pk_bf16_f32 v19, v134, v135
buffer_store_dwordx4 v[16:19], v243, s[20:23], s44 offen offset:0 sc1
v_mfma_f32_16x16x32_bf16 a[188:191], v[104:107], v[216:219], a[188:191]
ds_read_b64_tr_b16 v[216:217], v246 offset:12288
ds_read_b64_tr_b16 v[218:219], v246 offset:14336
v_mfma_f32_16x16x32_bf16 a[188:191], v[172:175], v[220:223], a[188:191]
ds_read_b64_tr_b16 v[220:221], v246 offset:28672
s_waitcnt lgkmcnt(3)
v_mfma_f32_16x16x32_bf16 a[176:179], v[176:179], v[208:211], a[176:179]
ds_read_b64_tr_b16 v[222:223], v246 offset:30720
ds_write_b128 v231, v[16:19] offset:4096
v_mfma_f32_16x16x32_bf16 a[176:179], v[0:3], v[212:215], a[176:179]
v_accvgpr_read_b32 v140, a148
v_accvgpr_read_b32 v141, a149
v_mfma_f32_16x16x32_bf16 a[180:183], v[180:183], v[208:211], a[180:183]
v_accvgpr_read_b32 v142, a150
v_accvgpr_read_b32 v143, a151
v_mfma_f32_16x16x32_bf16 a[180:183], v[32:35], v[212:215], a[180:183]
v_cvt_pk_bf16_f32 v50, v140, v141
v_cvt_pk_bf16_f32 v51, v142, v143
v_mfma_f32_16x16x32_bf16 a[184:187], v[184:187], v[208:211], a[184:187]
buffer_store_dwordx4 v[48:51], v243, s[20:23], s45 offen offset:0 sc1
v_accvgpr_read_b32 v148, a152
v_mfma_f32_16x16x32_bf16 a[184:187], v[64:67], v[212:215], a[184:187]
v_accvgpr_read_b32 v149, a153
v_accvgpr_read_b32 v150, a154
v_mfma_f32_16x16x32_bf16 a[188:191], v[188:191], v[208:211], a[188:191]
ds_read_b64_tr_b16 v[208:209], v12 offset:12288
ds_read_b64_tr_b16 v[210:211], v12 offset:14336
v_mfma_f32_16x16x32_bf16 a[188:191], v[96:99], v[212:215], a[188:191]
ds_read_b64_tr_b16 v[212:213], v12 offset:28672
s_waitcnt lgkmcnt(3)
v_mfma_f32_16x16x32_bf16 a[192:195], v[4:7], v[216:219], a[192:195]
ds_read_b64_tr_b16 v[214:215], v12 offset:30720
v_accvgpr_read_b32 v151, a155
v_mfma_f32_16x16x32_bf16 a[192:195], v[8:11], v[220:223], a[192:195]
v_cvt_pk_bf16_f32 v82, v148, v149
v_cvt_pk_bf16_f32 v83, v150, v151
v_mfma_f32_16x16x32_bf16 a[196:199], v[36:39], v[216:219], a[196:199]
buffer_store_dwordx4 v[80:83], v243, s[20:23], s46 offen offset:0 sc1
v_accvgpr_read_b32 v156, a156
v_mfma_f32_16x16x32_bf16 a[196:199], v[40:43], v[220:223], a[196:199]
v_accvgpr_read_b32 v157, a157
v_accvgpr_read_b32 v158, a158
v_mfma_f32_16x16x32_bf16 a[200:203], v[68:71], v[216:219], a[200:203]
v_accvgpr_read_b32 v159, a159
v_cvt_pk_bf16_f32 v114, v156, v157
v_mfma_f32_16x16x32_bf16 a[200:203], v[72:75], v[220:223], a[200:203]
v_cvt_pk_bf16_f32 v115, v158, v159
buffer_store_dwordx4 v[112:115], v243, s[20:23], s47 offen offset:0 sc1
v_mfma_f32_16x16x32_bf16 a[204:207], v[100:103], v[216:219], a[204:207]
ds_read_b64_tr_b16 v[216:217], v14 offset:12288
ds_read_b64_tr_b16 v[218:219], v14 offset:14336
v_mfma_f32_16x16x32_bf16 a[204:207], v[104:107], v[220:223], a[204:207]
ds_read_b64_tr_b16 v[220:221], v247 offset:12288
s_waitcnt lgkmcnt(3)
v_mfma_f32_16x16x32_bf16 a[192:195], v[160:163], v[208:211], a[192:195]
ds_read_b64_tr_b16 v[222:223], v247 offset:14336
v_accvgpr_read_b32 v128, a160
v_mfma_f32_16x16x32_bf16 a[192:195], v[176:179], v[212:215], a[192:195]
v_accvgpr_read_b32 v129, a161
v_accvgpr_read_b32 v130, a162
v_mfma_f32_16x16x32_bf16 a[196:199], v[164:167], v[208:211], a[196:199]
v_accvgpr_read_b32 v131, a163
v_cvt_pk_bf16_f32 v20, v128, v129
v_mfma_f32_16x16x32_bf16 a[196:199], v[180:183], v[212:215], a[196:199]
v_cvt_pk_bf16_f32 v21, v130, v131
v_accvgpr_read_b32 v136, a164
v_mfma_f32_16x16x32_bf16 a[200:203], v[168:171], v[208:211], a[200:203]
v_accvgpr_read_b32 v137, a165
v_accvgpr_read_b32 v138, a166
v_mfma_f32_16x16x32_bf16 a[200:203], v[184:187], v[212:215], a[200:203]
v_accvgpr_read_b32 v139, a167
v_cvt_pk_bf16_f32 v52, v136, v137
v_mfma_f32_16x16x32_bf16 a[204:207], v[172:175], v[208:211], a[204:207]
ds_read_b64_tr_b16 v[208:209], v247 offset:28672
ds_read_b64_tr_b16 v[210:211], v247 offset:30720
v_mfma_f32_16x16x32_bf16 a[204:207], v[188:191], v[212:215], a[204:207]
ds_read_b64_tr_b16 v[212:213], v13 offset:12288
s_waitcnt lgkmcnt(5)
v_mfma_f32_16x16x32_bf16 a[192:195], v[0:3], v[216:219], a[192:195]
ds_read_b64_tr_b16 v[214:215], v13 offset:14336
v_cvt_pk_bf16_f32 v53, v138, v139
v_mfma_f32_16x16x32_bf16 a[196:199], v[32:35], v[216:219], a[196:199]
v_accvgpr_read_b32 v144, a168
v_accvgpr_read_b32 v145, a169
v_mfma_f32_16x16x32_bf16 a[200:203], v[64:67], v[216:219], a[200:203]
v_accvgpr_read_b32 v146, a170
v_accvgpr_read_b32 v147, a171
v_mfma_f32_16x16x32_bf16 a[204:207], v[96:99], v[216:219], a[204:207]
ds_read_b64_tr_b16 v[216:217], v13 offset:28672
s_waitcnt lgkmcnt(5)
v_mfma_f32_16x16x32_bf16 a[208:211], v[4:7], v[220:223], a[208:211]
ds_read_b64_tr_b16 v[218:219], v13 offset:30720
v_cvt_pk_bf16_f32 v84, v144, v145
v_mfma_f32_16x16x32_bf16 a[212:215], v[36:39], v[220:223], a[212:215]
v_cvt_pk_bf16_f32 v85, v146, v147
v_accvgpr_read_b32 v152, a172
v_mfma_f32_16x16x32_bf16 a[216:219], v[68:71], v[220:223], a[216:219]
v_accvgpr_read_b32 v153, a173
v_accvgpr_read_b32 v154, a174
v_mfma_f32_16x16x32_bf16 a[220:223], v[100:103], v[220:223], a[220:223]
ds_read_b64_tr_b16 v[220:221], v15 offset:12288
s_waitcnt lgkmcnt(3)
v_mfma_f32_16x16x32_bf16 a[208:211], v[8:11], v[208:211], a[208:211]
ds_read_b64_tr_b16 v[222:223], v15 offset:14336
v_accvgpr_read_b32 v155, a175
v_mfma_f32_16x16x32_bf16 a[208:211], v[160:163], v[212:215], a[208:211]
v_cvt_pk_bf16_f32 v116, v152, v153
v_cvt_pk_bf16_f32 v117, v154, v155
v_mfma_f32_16x16x32_bf16 a[212:215], v[40:43], v[208:211], a[212:215]
v_accvgpr_read_b32 v132, a176
v_accvgpr_read_b32 v133, a177
v_mfma_f32_16x16x32_bf16 a[212:215], v[164:167], v[212:215], a[212:215]
v_accvgpr_read_b32 v134, a178
v_accvgpr_read_b32 v135, a179
v_mfma_f32_16x16x32_bf16 a[216:219], v[72:75], v[208:211], a[216:219]
v_cvt_pk_bf16_f32 v22, v132, v133
v_cvt_pk_bf16_f32 v23, v134, v135
v_mfma_f32_16x16x32_bf16 a[216:219], v[168:171], v[212:215], a[216:219]
buffer_store_dwordx4 v[20:23], v243, s[20:23], s44 offen offset:1024 sc1
ds_write_b128 v231, v[20:23] offset:5120
v_mfma_f32_16x16x32_bf16 a[220:223], v[104:107], v[208:211], a[220:223]
v_accvgpr_read_b32 v140, a180
v_accvgpr_read_b32 v141, a181
v_mfma_f32_16x16x32_bf16 a[220:223], v[172:175], v[212:215], a[220:223]
s_waitcnt lgkmcnt(0)
v_accvgpr_read_b32 v142, a182
v_mfma_f32_16x16x32_bf16 a[208:211], v[176:179], v[216:219], a[208:211]
v_accvgpr_read_b32 v143, a183
v_cvt_pk_bf16_f32 v54, v140, v141
v_mfma_f32_16x16x32_bf16 a[208:211], v[0:3], v[220:223], a[208:211]
v_cvt_pk_bf16_f32 v55, v142, v143
buffer_store_dwordx4 v[52:55], v243, s[20:23], s45 offen offset:1024 sc1
v_mfma_f32_16x16x32_bf16 a[212:215], v[180:183], v[216:219], a[212:215]
v_accvgpr_read_b32 v148, a184
v_accvgpr_read_b32 v149, a185
v_mfma_f32_16x16x32_bf16 a[212:215], v[32:35], v[220:223], a[212:215]
v_accvgpr_read_b32 v150, a186
v_accvgpr_read_b32 v151, a187
v_mfma_f32_16x16x32_bf16 a[216:219], v[184:187], v[216:219], a[216:219]
v_cvt_pk_bf16_f32 v86, v148, v149
v_cvt_pk_bf16_f32 v87, v150, v151
v_mfma_f32_16x16x32_bf16 a[216:219], v[64:67], v[220:223], a[216:219]
buffer_store_dwordx4 v[84:87], v243, s[20:23], s46 offen offset:1024 sc1
v_accvgpr_read_b32 v156, a188
v_mfma_f32_16x16x32_bf16 a[220:223], v[188:191], v[216:219], a[220:223]
v_accvgpr_read_b32 v157, a189
v_accvgpr_read_b32 v158, a190
v_mfma_f32_16x16x32_bf16 a[220:223], v[96:99], v[220:223], a[220:223]
v_accvgpr_read_b32 v159, a191
v_cvt_pk_bf16_f32 v118, v156, v157
v_cvt_pk_bf16_f32 v119, v158, v159
buffer_store_dwordx4 v[116:119], v243, s[20:23], s47 offen offset:1024 sc1
v_accvgpr_read_b32 v128, a192
v_accvgpr_read_b32 v129, a193
v_accvgpr_read_b32 v130, a194
v_accvgpr_read_b32 v131, a195
v_cvt_pk_bf16_f32 v24, v128, v129
v_cvt_pk_bf16_f32 v25, v130, v131
v_accvgpr_read_b32 v136, a196
v_accvgpr_read_b32 v137, a197
v_accvgpr_read_b32 v138, a198
v_accvgpr_read_b32 v139, a199
v_cvt_pk_bf16_f32 v56, v136, v137
v_cvt_pk_bf16_f32 v57, v138, v139
v_accvgpr_read_b32 v144, a200
v_accvgpr_read_b32 v145, a201
v_accvgpr_read_b32 v146, a202
v_accvgpr_read_b32 v147, a203
v_cvt_pk_bf16_f32 v88, v144, v145
v_cvt_pk_bf16_f32 v89, v146, v147
v_accvgpr_read_b32 v152, a204
v_accvgpr_read_b32 v153, a205
v_accvgpr_read_b32 v154, a206
v_accvgpr_read_b32 v155, a207
v_cvt_pk_bf16_f32 v120, v152, v153
v_cvt_pk_bf16_f32 v121, v154, v155
v_accvgpr_read_b32 v132, a208
v_accvgpr_read_b32 v133, a209
v_accvgpr_read_b32 v134, a210
v_accvgpr_read_b32 v135, a211
v_cvt_pk_bf16_f32 v26, v132, v133
v_cvt_pk_bf16_f32 v27, v134, v135
buffer_store_dwordx4 v[24:27], v243, s[20:23], s44 offen offset:2048 sc1
ds_write_b128 v231, v[24:27] offset:6144
v_accvgpr_read_b32 v140, a212
v_accvgpr_read_b32 v141, a213
v_accvgpr_read_b32 v142, a214
v_accvgpr_read_b32 v143, a215
v_cvt_pk_bf16_f32 v58, v140, v141
v_cvt_pk_bf16_f32 v59, v142, v143
buffer_store_dwordx4 v[56:59], v243, s[20:23], s45 offen offset:2048 sc1
v_accvgpr_read_b32 v148, a216
v_accvgpr_read_b32 v149, a217
v_accvgpr_read_b32 v150, a218
v_accvgpr_read_b32 v151, a219
v_cvt_pk_bf16_f32 v90, v148, v149
v_cvt_pk_bf16_f32 v91, v150, v151
buffer_store_dwordx4 v[88:91], v243, s[20:23], s46 offen offset:2048 sc1
v_accvgpr_read_b32 v156, a220
v_accvgpr_read_b32 v157, a221
v_accvgpr_read_b32 v158, a222
v_accvgpr_read_b32 v159, a223
v_cvt_pk_bf16_f32 v122, v156, v157
v_cvt_pk_bf16_f32 v123, v158, v159
buffer_store_dwordx4 v[120:123], v243, s[20:23], s47 offen offset:2048 sc1
s_waitcnt vmcnt(36)
s_branch L2_F
L2_F:
v_cmp_ne_u64 vcc, s[98:99], v[108:109]
s_lshl_b32 s3, s34, 15
s_add_u32 s3, s3, 0x1000000
s_cbranch_vccnz LF_wf
LF_wf_go:
v_add_u32 v240, s3, v243
v_add_u32 v241, 0x4000, v240
s_mov_b32 s32, 0x0
s_mov_b32 s33, 0x1000
s_mov_b32 s35, 0x2000
s_mov_b32 s36, 0x3000
s_mov_b32 s38, 0x20000
s_mov_b32 s39, 0x21000
s_mov_b32 s40, 0x22000
s_mov_b32 s41, 0x23000
s_lshr_b32 s42, s6, 13
s_lshr_b32 s43, s7, 13
s_lshr_b32 s44, s29, 13
v_mov_b32 v244, s42
v_mov_b32 v232, s43
v_cmp_lt_u32 vcc, 0xff, v243
v_mov_b32 v233, s44
s_nop 0
v_cndmask_b32 v244, v244, v232, vcc
v_cmp_lt_u32 vcc, 0x1ff, v243
v_and_b32 v235, 0xf0, v243
s_nop 0
v_cndmask_b32 v244, v244, v233, vcc
v_lshrrev_b32 v232, 3, v235
v_lshl_add_u32 v79, v244, 5, v232
buffer_load_ushort v79, v79, s[52:55], 0 offen
buffer_load_dwordx4 a[0:3], v240, s[16:19], s32 offen offset:0 sc1
buffer_load_dwordx4 a[4:7], v240, s[16:19], s32 offen offset:1024 sc1
buffer_load_dwordx4 a[8:11], v241, s[16:19], s32 offen offset:0 sc1
buffer_load_dwordx4 a[12:15], v241, s[16:19], s32 offen offset:1024 sc1
buffer_load_dwordx4 a[16:19], v240, s[16:19], s32 offen offset:2048 sc1
buffer_load_dwordx4 a[20:23], v240, s[16:19], s32 offen offset:3072 sc1
buffer_load_dwordx4 a[24:27], v241, s[16:19], s32 offen offset:2048 sc1
buffer_load_dwordx4 a[28:31], v241, s[16:19], s32 offen offset:3072 sc1
buffer_load_dwordx4 a[32:35], v240, s[16:19], s33 offen offset:0 sc1
buffer_load_dwordx4 a[36:39], v240, s[16:19], s33 offen offset:1024 sc1
buffer_load_dwordx4 a[40:43], v241, s[16:19], s33 offen offset:0 sc1
buffer_load_dwordx4 a[44:47], v241, s[16:19], s33 offen offset:1024 sc1
s_lshl_b32 s3, s37, 7
v_lshl_add_u32 v244, v244, 11, s3
v_lshl_add_u32 v244, v232, 2, v244
s_cmp_ge_u32 s29, 0x70000000
s_cselect_b32 s44, s43, s44
v_mov_b32 v46, s42
v_mov_b32 v232, s43
v_lshrrev_b32 v233, 7, v243
v_cmp_lt_u32_e64 vcc, 0, v233
s_nop 1
v_cndmask_b32_e64 v46, v46, v232, vcc
v_cmp_lt_u32_e64 vcc, 1, v233
v_mov_b32 v233, s44
v_bfe_u32 v232, v243, 4, 3
v_cndmask_b32_e64 v46, v46, v233, vcc
v_min_u32 v232, 5, v232
v_lshrrev_b32 v46, 2, v46
v_lshl_add_u32 v46, v46, 3, v232
v_lshlrev_b32 v46, 7, v46
v_add_u32 v46, 0x7c00000, v46
s_lshl_b32 s49, s34, 10
s_add_u32 s49, s49, 0x20000
s_bfe_u32 s3, s6, 0x2000f
s_lshl_b32 s3, s3, 13
s_add_u32 s3, s3, s49
v_add_u32 v76, s3, v243
s_bfe_u32 s3, s7, 0x2000f
s_lshl_b32 s3, s3, 13
s_add_u32 s3, s3, s49
v_add_u32 v77, s3, v243
s_bfe_u32 s3, s29, 0x2000f
s_lshl_b32 s3, s3, 13
s_add_u32 s3, s3, s49
v_add_u32 v78, s3, v243
s_add_u32 s3, s37, 1
s_sub_u32 s49, s3, 6
s_cselect_b32 s3, s3, s49
s_mul_i32 s3, s3, 0x600000
s_add_u32 s42, s3, 0x2000000
s_add_u32 s3, s37, 2
s_sub_u32 s49, s3, 6
s_cselect_b32 s3, s3, s49
s_mul_i32 s3, s3, 0x600000
s_add_u32 s43, s3, 0x2000000
s_add_u32 s3, s37, 3
s_sub_u32 s49, s3, 6
s_cselect_b32 s3, s3, s49
s_mul_i32 s3, s3, 0x600000
s_add_u32 s44, s3, 0x2000000
s_add_u32 s3, s37, 4
s_sub_u32 s49, s3, 6
s_cselect_b32 s3, s3, s49
s_mul_i32 s3, s3, 0x600000
s_add_u32 s45, s3, 0x2000000
s_add_u32 s3, s37, 5
s_sub_u32 s49, s3, 6
s_cselect_b32 s3, s3, s49
s_mul_i32 s3, s3, 0x600000
s_add_u32 s46, s3, 0x2000000
s_add_u32 s3, s37, 6
s_sub_u32 s49, s3, 6
s_cselect_b32 s3, s3, s49
s_mul_i32 s3, s3, 0x600000
s_add_u32 s47, s3, 0x2000000
s_mul_i32 s3, s34, 896
v_add_u32 v47, s3, v243
v_add_u32 v43, 0x1000, v47
v_lshrrev_b32 v44, 4, v243
v_and_b32 v44, 0x30, v44
v_xor_b32 v44, v44, v243
v_and_b32 v232, 0x380, v243
v_mad_u32_u24 v44, v232, 3, v44
v_xor_b32 v45, 0x1040, v44
v_bfe_u32 v232, v243, 5, 3
v_lshrrev_b32 v234, 8, v243
v_xor_b32 v232, v232, v234
v_bfe_u32 v233, v243, 4, 3
v_lshlrev_b32 v233, 7, v233
v_lshl_or_b32 v232, v232, 4, v233
v_bfe_u32 v233, v243, 7, 1
s_lshl_b32 s49, s34, 10
s_sub_u32 s3, s28, s49
v_lshl_add_u32 v74, v233, 12, v232
v_add_u32 v72, s3, v74
s_sub_u32 s3, s30, s49
v_add_u32 v74, s3, v74
v_xor_b32 v73, 64, v72
v_xor_b32 v75, 64, v74
v_lshl_add_u32 v245, v233, 10, v232
v_add_u32 v245, s31, v245
v_xor_b32 v246, 64, v245
v_add_u32 v247, s31, v243
s_add_u32 s3, s3, 0xa000
s_and_b32 s3, s3, 0x1ffff
v_add_u32 v252, s3, v243
v_add_u32 v251, s49, v252
s_lshl_b32 s49, s34, 11
s_add_u32 s3, s3, s49
s_add_u32 s3, s3, 24576
v_lshl_add_u32 v242, v243, 1, s3
v_lshl_add_u32 v250, v235, 1, s3
v_lshrrev_b32 v232, 4, v235
v_lshlrev_b32 v234, 2, v234
v_sub_u32 v232, v232, v234
v_and_b32 v233, 1, v232
v_lshlrev_b32 v233, 4, v233
v_mov_b32 v234, 0xffff
v_lshlrev_b32 v233, v233, v234
v_lshrrev_b32 v232, 1, v232
v_cmp_eq_u32 vcc, 0, v232
s_nop 1
v_cndmask_b32 v156, 0, v233, vcc
v_cmp_eq_u32 vcc, 1, v232
s_nop 1
v_cndmask_b32 v157, 0, v233, vcc
s_mov_b32 s95, 0xffff0000
s_waitcnt vmcnt(13)
v_mov_b32 v36, s98
v_mov_b32 v37, s99
v_mov_b32 v38, s98
v_mov_b32 v39, s99
s_mov_b64 exec, 0xff
buffer_store_dwordx4 v[36:39], v243, s[16:19], s51 offen sc1
s_mov_b64 exec, -1
s_waitcnt lgkmcnt(0)
s_barrier
ds_read_b128 v[208:211], v72 offset:0
ds_read_b128 v[212:215], v72 offset:8192
ds_read_b128 v[216:219], v74 offset:0
ds_read_b128 v[220:223], v73 offset:0
ds_read_b128 v[224:227], v73 offset:8192
ds_read_b128 v[104:107], v245 offset:0
ds_read_b128 v[108:111], v246 offset:0
ds_read_b128 v[152:155], v245 offset:2048
s_waitcnt vmcnt(13)
buffer_load_dwordx4 a[48:51], v240, s[16:19], s33 offen offset:2048 sc1
buffer_load_dwordx4 a[52:55], v240, s[16:19], s33 offen offset:3072 sc1
buffer_load_dwordx4 a[56:59], v241, s[16:19], s33 offen offset:2048 sc1
buffer_load_dwordx4 a[60:63], v241, s[16:19], s33 offen offset:3072 sc1
v_lshlrev_b32 v79, 16, v79
ds_write_b32 v242, v79 offset:28
ds_read_b32 v253, v250 offset:28
ds_read_b32 v254, v250 offset:540
ds_read_b32 v255, v250 offset:1052
s_waitcnt vmcnt(16)
buffer_load_dwordx4 a[64:67], v240, s[16:19], s35 offen offset:0 sc1
s_waitcnt vmcnt(16)
buffer_load_dwordx4 a[68:71], v240, s[16:19], s35 offen offset:1024 sc1
s_waitcnt vmcnt(16)
buffer_load_dwordx4 a[72:75], v241, s[16:19], s35 offen offset:0 sc1
s_waitcnt vmcnt(16)
s_waitcnt lgkmcnt(11)
v_mfma_f32_16x16x32_bf16 v[160:163], a[0:3], v[208:211], 0
ds_read_b128 v[228:231], v75 offset:0
buffer_load_dwordx4 a[76:79], v241, s[16:19], s35 offen offset:1024 sc1
v_mfma_f32_16x16x32_bf16 v[164:167], a[4:7], v[208:211], 0
v_mfma_f32_16x16x32_bf16 v[168:171], a[8:11], v[208:211], 0
v_mfma_f32_16x16x32_bf16 v[172:175], a[12:15], v[208:211], 0
s_waitcnt vmcnt(16)
s_waitcnt lgkmcnt(11)
v_mfma_f32_16x16x32_bf16 v[176:179], a[0:3], v[212:215], 0
ds_read_b128 v[208:211], v72 offset:1024
buffer_load_dwordx4 a[80:83], v240, s[16:19], s35 offen offset:2048 sc1
v_mfma_f32_16x16x32_bf16 v[180:183], a[4:7], v[212:215], 0
v_mfma_f32_16x16x32_bf16 v[184:187], a[8:11], v[212:215], 0
v_mfma_f32_16x16x32_bf16 v[188:191], a[12:15], v[212:215], 0
s_waitcnt vmcnt(16)
s_waitcnt lgkmcnt(11)
v_mfma_f32_16x16x32_bf16 v[192:195], a[0:3], v[216:219], 0
ds_read_b128 v[212:215], v72 offset:9216
buffer_load_dwordx4 a[84:87], v240, s[16:19], s35 offen offset:3072 sc1
v_mfma_f32_16x16x32_bf16 v[196:199], a[4:7], v[216:219], 0
v_mfma_f32_16x16x32_bf16 v[200:203], a[8:11], v[216:219], 0
v_mfma_f32_16x16x32_bf16 v[204:207], a[12:15], v[216:219], 0
s_waitcnt vmcnt(16)
buffer_load_dwordx4 a[88:91], v241, s[16:19], s35 offen offset:2048 sc1
s_waitcnt vmcnt(16)
s_waitcnt lgkmcnt(11)
v_mfma_f32_16x16x32_bf16 v[160:163], a[16:19], v[220:223], v[160:163]
ds_read_b128 v[216:219], v74 offset:1024
buffer_load_dwordx4 a[92:95], v241, s[16:19], s35 offen offset:3072 sc1
v_mfma_f32_16x16x32_bf16 v[164:167], a[20:23], v[220:223], v[164:167]
v_mfma_f32_16x16x32_bf16 v[168:171], a[24:27], v[220:223], v[168:171]
v_mfma_f32_16x16x32_bf16 v[172:175], a[28:31], v[220:223], v[172:175]
s_waitcnt vmcnt(16)
s_waitcnt lgkmcnt(11)
v_mfma_f32_16x16x32_bf16 v[176:179], a[16:19], v[224:227], v[176:179]
ds_read_b128 v[220:223], v73 offset:1024
buffer_load_dwordx2 v[248:249], v46, s[16:19], 0 offen offset:0 sc1
v_mfma_f32_16x16x32_bf16 v[180:183], a[20:23], v[224:227], v[180:183]
v_mfma_f32_16x16x32_bf16 v[184:187], a[24:27], v[224:227], v[184:187]
v_mfma_f32_16x16x32_bf16 v[188:191], a[28:31], v[224:227], v[188:191]
s_waitcnt vmcnt(16)
s_waitcnt lgkmcnt(4)
v_mfma_f32_16x16x32_bf16 v[192:195], a[16:19], v[228:231], v[192:195]
ds_read_b128 v[224:227], v73 offset:9216
buffer_load_dwordx4 a[96:99], v240, s[16:19], s36 offen offset:0 sc1
v_mfma_f32_16x16x32_bf16 v[196:199], a[20:23], v[228:231], v[196:199]
v_mfma_f32_16x16x32_bf16 v[200:203], a[24:27], v[228:231], v[200:203]
v_mfma_f32_16x16x32_bf16 v[204:207], a[28:31], v[228:231], v[204:207]
s_waitcnt vmcnt(16)
buffer_load_dwordx4 a[100:103], v240, s[16:19], s36 offen offset:1024 sc1
s_waitcnt vmcnt(16)
s_waitcnt lgkmcnt(4)
v_mfma_f32_16x16x32_bf16 v[160:163], a[32:35], v[208:211], v[160:163]
ds_read_b128 v[228:231], v75 offset:1024
buffer_load_dwordx4 a[104:107], v241, s[16:19], s36 offen offset:0 sc1
v_mfma_f32_16x16x32_bf16 v[164:167], a[36:39], v[208:211], v[164:167]
v_mfma_f32_16x16x32_bf16 v[168:171], a[40:43], v[208:211], v[168:171]
v_mfma_f32_16x16x32_bf16 v[172:175], a[44:47], v[208:211], v[172:175]
s_waitcnt lgkmcnt(4)
v_mfma_f32_16x16x32_bf16 v[176:179], a[32:35], v[212:215], v[176:179]
ds_read_b128 v[208:211], v72 offset:2048
v_mfma_f32_16x16x32_bf16 v[180:183], a[36:39], v[212:215], v[180:183]
v_mfma_f32_16x16x32_bf16 v[184:187], a[40:43], v[212:215], v[184:187]
v_mfma_f32_16x16x32_bf16 v[188:191], a[44:47], v[212:215], v[188:191]
s_waitcnt vmcnt(15)
s_waitcnt lgkmcnt(4)
v_mfma_f32_16x16x32_bf16 v[192:195], a[32:35], v[216:219], v[192:195]
ds_read_b128 v[212:215], v72 offset:10240
buffer_load_dwordx4 a[108:111], v241, s[16:19], s36 offen offset:1024 sc1
v_mfma_f32_16x16x32_bf16 v[196:199], a[36:39], v[216:219], v[196:199]
v_mfma_f32_16x16x32_bf16 v[200:203], a[40:43], v[216:219], v[200:203]
v_mfma_f32_16x16x32_bf16 v[204:207], a[44:47], v[216:219], v[204:207]
s_waitcnt vmcnt(15)
buffer_load_dwordx4 a[112:115], v240, s[16:19], s36 offen offset:2048 sc1
s_waitcnt vmcnt(15)
buffer_load_dwordx4 a[116:119], v240, s[16:19], s36 offen offset:3072 sc1
s_waitcnt vmcnt(15)
s_waitcnt lgkmcnt(4)
v_mfma_f32_16x16x32_bf16 v[160:163], a[48:51], v[220:223], v[160:163]
ds_read_b128 v[216:219], v74 offset:2048
buffer_load_dwordx4 a[120:123], v241, s[16:19], s36 offen offset:2048 sc1
v_mfma_f32_16x16x32_bf16 v[164:167], a[52:55], v[220:223], v[164:167]
v_mfma_f32_16x16x32_bf16 v[168:171], a[56:59], v[220:223], v[168:171]
v_mfma_f32_16x16x32_bf16 v[172:175], a[60:63], v[220:223], v[172:175]
s_waitcnt vmcnt(15)
s_waitcnt lgkmcnt(4)
v_mfma_f32_16x16x32_bf16 v[176:179], a[48:51], v[224:227], v[176:179]
ds_read_b128 v[220:223], v73 offset:2048
buffer_load_dwordx4 a[124:127], v241, s[16:19], s36 offen offset:3072 sc1
v_mfma_f32_16x16x32_bf16 v[180:183], a[52:55], v[224:227], v[180:183]
v_mfma_f32_16x16x32_bf16 v[184:187], a[56:59], v[224:227], v[184:187]
v_mfma_f32_16x16x32_bf16 v[188:191], a[60:63], v[224:227], v[188:191]
s_waitcnt vmcnt(15)
s_waitcnt lgkmcnt(4)
v_mfma_f32_16x16x32_bf16 v[192:195], a[48:51], v[228:231], v[192:195]
ds_read_b128 v[224:227], v73 offset:10240
v_mfma_f32_16x16x32_bf16 v[196:199], a[52:55], v[228:231], v[196:199]
v_mfma_f32_16x16x32_bf16 v[200:203], a[56:59], v[228:231], v[200:203]
v_mfma_f32_16x16x32_bf16 v[204:207], a[60:63], v[228:231], v[204:207]
s_waitcnt vmcnt(14)
s_waitcnt vmcnt(13)
s_waitcnt lgkmcnt(4)
v_mfma_f32_16x16x32_bf16 v[160:163], a[64:67], v[208:211], v[160:163]
ds_read_b128 v[228:231], v75 offset:2048
v_mfma_f32_16x16x32_bf16 v[164:167], a[68:71], v[208:211], v[164:167]
v_mfma_f32_16x16x32_bf16 v[168:171], a[72:75], v[208:211], v[168:171]
v_mfma_f32_16x16x32_bf16 v[172:175], a[76:79], v[208:211], v[172:175]
s_waitcnt vmcnt(12)
s_waitcnt lgkmcnt(4)
v_mfma_f32_16x16x32_bf16 v[176:179], a[64:67], v[212:215], v[176:179]
ds_read_b128 v[208:211], v72 offset:3072
v_mfma_f32_16x16x32_bf16 v[180:183], a[68:71], v[212:215], v[180:183]
v_mfma_f32_16x16x32_bf16 v[184:187], a[72:75], v[212:215], v[184:187]
v_mfma_f32_16x16x32_bf16 v[188:191], a[76:79], v[212:215], v[188:191]
s_waitcnt vmcnt(11)
s_waitcnt lgkmcnt(4)
v_mfma_f32_16x16x32_bf16 v[192:195], a[64:67], v[216:219], v[192:195]
ds_read_b128 v[212:215], v72 offset:11264
v_mfma_f32_16x16x32_bf16 v[196:199], a[68:71], v[216:219], v[196:199]
v_mfma_f32_16x16x32_bf16 v[200:203], a[72:75], v[216:219], v[200:203]
v_mfma_f32_16x16x32_bf16 v[204:207], a[76:79], v[216:219], v[204:207]
s_waitcnt vmcnt(10)
s_waitcnt vmcnt(9)
s_waitcnt lgkmcnt(4)
v_mfma_f32_16x16x32_bf16 v[160:163], a[80:83], v[220:223], v[160:163]
ds_read_b128 v[216:219], v74 offset:3072
v_mfma_f32_16x16x32_bf16 v[164:167], a[84:87], v[220:223], v[164:167]
v_mfma_f32_16x16x32_bf16 v[168:171], a[88:91], v[220:223], v[168:171]
v_mfma_f32_16x16x32_bf16 v[172:175], a[92:95], v[220:223], v[172:175]
s_waitcnt vmcnt(8)
s_waitcnt lgkmcnt(4)
v_mfma_f32_16x16x32_bf16 v[176:179], a[80:83], v[224:227], v[176:179]
ds_read_b128 v[220:223], v73 offset:3072
v_cmp_ne_u64 vcc, s[98:99], v[248:249]
s_nop 1
s_cbranch_vccnz LF_spinQ
LF_goQ:
v_mfma_f32_16x16x32_bf16 v[180:183], a[84:87], v[224:227], v[180:183]
buffer_load_dwordx2 v[128:129], v244, s[24:27], 0 offen offset:128 sc1
v_mfma_f32_16x16x32_bf16 v[184:187], a[88:91], v[224:227], v[184:187]
buffer_load_dwordx2 v[130:131], v244, s[24:27], 0 offen offset:256 sc1
v_mfma_f32_16x16x32_bf16 v[188:191], a[92:95], v[224:227], v[188:191]
buffer_load_dwordx2 v[132:133], v244, s[24:27], 0 offen offset:384 sc1
s_waitcnt lgkmcnt(4)
v_mfma_f32_16x16x32_bf16 v[192:195], a[80:83], v[228:231], v[192:195]
ds_read_b128 v[224:227], v73 offset:11264
buffer_load_dwordx2 v[134:135], v244, s[24:27], 0 offen offset:512 sc1
v_mfma_f32_16x16x32_bf16 v[196:199], a[84:87], v[228:231], v[196:199]
buffer_load_dwordx2 v[136:137], v244, s[24:27], 0 offen offset:640 sc1
v_mfma_f32_16x16x32_bf16 v[200:203], a[88:91], v[228:231], v[200:203]
buffer_load_dwordx2 v[138:139], v244, s[24:27], 0 offen offset:768 sc1
v_mfma_f32_16x16x32_bf16 v[204:207], a[92:95], v[228:231], v[204:207]
s_add_u32 s49, s6, s42
buffer_load_dwordx4 v[48:51], v47, s[16:19], s49 offen sc1
s_add_u32 s3, s6, s43
buffer_load_dwordx4 v[52:55], v47, s[16:19], s3 offen sc1
buffer_load_dwordx4 a[128:131], v240, s[16:19], s38 offen offset:0 sc1
buffer_load_dwordx4 a[132:135], v240, s[16:19], s38 offen offset:1024 sc1
s_waitcnt vmcnt(17)
s_add_u32 s49, s6, s44
buffer_load_dwordx4 v[56:59], v47, s[16:19], s49 offen sc1
s_add_u32 s3, s6, s45
buffer_load_dwordx4 v[60:63], v47, s[16:19], s3 offen sc1
s_waitcnt vmcnt(18)
buffer_load_dwordx4 a[136:139], v241, s[16:19], s38 offen offset:0 sc1
s_waitcnt vmcnt(18)
buffer_load_dwordx4 a[140:143], v241, s[16:19], s38 offen offset:1024 sc1
s_waitcnt vmcnt(18)
s_waitcnt lgkmcnt(4)
v_mfma_f32_16x16x32_bf16 v[160:163], a[96:99], v[208:211], v[160:163]
ds_read_b128 v[228:231], v75 offset:3072
s_add_u32 s49, s6, s46
buffer_load_dwordx4 v[64:67], v47, s[16:19], s49 offen sc1
v_mfma_f32_16x16x32_bf16 v[164:167], a[100:103], v[208:211], v[164:167]
ds_read_b128 v[68:71], v76 offset:0
v_mfma_f32_16x16x32_bf16 v[168:171], a[104:107], v[208:211], v[168:171]
v_mfma_f32_16x16x32_bf16 v[172:175], a[108:111], v[208:211], v[172:175]
s_waitcnt vmcnt(18)
s_waitcnt lgkmcnt(5)
v_mfma_f32_16x16x32_bf16 v[176:179], a[96:99], v[212:215], v[176:179]
buffer_load_dwordx4 a[144:147], v240, s[16:19], s38 offen offset:2048 sc1
v_mfma_f32_16x16x32_bf16 v[180:183], a[100:103], v[212:215], v[180:183]
v_mfma_f32_16x16x32_bf16 v[184:187], a[104:107], v[212:215], v[184:187]
v_mfma_f32_16x16x32_bf16 v[188:191], a[108:111], v[212:215], v[188:191]
s_waitcnt vmcnt(18)
s_waitcnt lgkmcnt(4)
v_mfma_f32_16x16x32_bf16 v[192:195], a[96:99], v[216:219], v[192:195]
buffer_load_dwordx4 a[148:151], v240, s[16:19], s38 offen offset:3072 sc1
v_mfma_f32_16x16x32_bf16 v[196:199], a[100:103], v[216:219], v[196:199]
v_mfma_f32_16x16x32_bf16 v[200:203], a[104:107], v[216:219], v[200:203]
v_mfma_f32_16x16x32_bf16 v[204:207], a[108:111], v[216:219], v[204:207]
s_waitcnt vmcnt(18)
s_waitcnt vmcnt(17)
s_waitcnt lgkmcnt(3)
v_mfma_f32_16x16x32_bf16 v[160:163], a[112:115], v[220:223], v[160:163]
s_add_u32 s49, s6, s42
buffer_load_dwordx4 v[80:83], v43, s[16:19], s49 offen sc1
v_mfma_f32_16x16x32_bf16 v[164:167], a[116:119], v[220:223], v[164:167]
s_add_u32 s3, s6, s43
buffer_load_dwordx4 v[84:87], v43, s[16:19], s3 offen sc1
v_mfma_f32_16x16x32_bf16 v[168:171], a[120:123], v[220:223], v[168:171]
v_mfma_f32_16x16x32_bf16 v[172:175], a[124:127], v[220:223], v[172:175]
s_waitcnt lgkmcnt(2)
v_mfma_f32_16x16x32_bf16 v[176:179], a[112:115], v[224:227], v[176:179]
v_lshlrev_b32 v234, 16, v104
v_and_b32 v235, s95, v104
v_mfma_f32_16x16x32_bf16 v[180:183], a[116:119], v[224:227], v[180:183]
v_fma_f32 v160, v160, v253, v234
v_fma_f32 v161, v161, v253, v235
v_mfma_f32_16x16x32_bf16 v[184:187], a[120:123], v[224:227], v[184:187]
v_lshlrev_b32 v236, 16, v105
v_and_b32 v237, s95, v105
v_mfma_f32_16x16x32_bf16 v[188:191], a[124:127], v[224:227], v[188:191]
v_fma_f32 v162, v162, v253, v236
v_fma_f32 v163, v163, v253, v237
s_waitcnt lgkmcnt(1)
v_mfma_f32_16x16x32_bf16 v[192:195], a[112:115], v[228:231], v[192:195]
v_lshlrev_b32 v238, 16, v106
v_and_b32 v239, s95, v106
v_mfma_f32_16x16x32_bf16 v[196:199], a[116:119], v[228:231], v[196:199]
v_fma_f32 v164, v164, v253, v238
v_fma_f32 v165, v165, v253, v239
v_mfma_f32_16x16x32_bf16 v[200:203], a[120:123], v[228:231], v[200:203]
v_lshlrev_b32 v232, 16, v107
v_and_b32 v233, s95, v107
v_mfma_f32_16x16x32_bf16 v[204:207], a[124:127], v[228:231], v[204:207]
v_fma_f32 v166, v166, v253, v232
v_fma_f32 v167, v167, v253, v233
ds_read_b128 v[104:107], v246 offset:2048
v_lshlrev_b32 v234, 16, v108
v_and_b32 v235, s95, v108
v_fma_f32 v168, v168, v253, v234
v_fma_f32 v169, v169, v253, v235
v_lshlrev_b32 v236, 16, v109
v_and_b32 v237, s95, v109
v_fma_f32 v170, v170, v253, v236
v_fma_f32 v171, v171, v253, v237
v_lshlrev_b32 v238, 16, v110
v_and_b32 v239, s95, v110
v_fma_f32 v172, v172, v253, v238
v_fma_f32 v173, v173, v253, v239
v_lshlrev_b32 v232, 16, v111
v_and_b32 v233, s95, v111
v_fma_f32 v174, v174, v253, v232
v_fma_f32 v175, v175, v253, v233
ds_read_b128 v[108:111], v245 offset:4096
s_waitcnt vmcnt(17)
buffer_load_dwordx4 a[152:155], v241, s[16:19], s38 offen offset:2048 sc1
v_lshlrev_b32 v234, 16, v152
v_and_b32 v235, s95, v152
v_fma_f32 v176, v176, v254, v234
v_fma_f32 v177, v177, v254, v235
v_lshlrev_b32 v236, 16, v153
v_and_b32 v237, s95, v153
v_fma_f32 v178, v178, v254, v236
v_fma_f32 v179, v179, v254, v237
v_lshlrev_b32 v238, 16, v154
v_and_b32 v239, s95, v154
v_fma_f32 v180, v180, v254, v238
v_fma_f32 v181, v181, v254, v239
v_lshlrev_b32 v232, 16, v155
v_and_b32 v233, s95, v155
v_fma_f32 v182, v182, v254, v232
v_fma_f32 v183, v183, v254, v233
ds_read_b128 v[152:155], v246 offset:4096
s_waitcnt lgkmcnt(2)
v_lshlrev_b32 v234, 16, v104
v_and_b32 v235, s95, v104
v_fma_f32 v184, v184, v254, v234
v_fma_f32 v185, v185, v254, v235
v_lshlrev_b32 v236, 16, v105
v_and_b32 v237, s95, v105
v_fma_f32 v186, v186, v254, v236
v_fma_f32 v187, v187, v254, v237
v_lshlrev_b32 v238, 16, v106
v_and_b32 v239, s95, v106
v_fma_f32 v188, v188, v254, v238
v_fma_f32 v189, v189, v254, v239
v_lshlrev_b32 v232, 16, v107
v_and_b32 v233, s95, v107
v_fma_f32 v190, v190, v254, v232
v_fma_f32 v191, v191, v254, v233
s_waitcnt vmcnt(16)
buffer_load_dwordx4 a[156:159], v241, s[16:19], s38 offen offset:3072 sc1
s_waitcnt lgkmcnt(1)
v_lshlrev_b32 v234, 16, v108
v_and_b32 v235, s95, v108
v_fma_f32 v192, v192, v255, v234
v_fma_f32 v193, v193, v255, v235
v_lshlrev_b32 v236, 16, v109
v_and_b32 v237, s95, v109
v_fma_f32 v194, v194, v255, v236
v_fma_f32 v195, v195, v255, v237
v_lshlrev_b32 v238, 16, v110
v_and_b32 v239, s95, v110
v_fma_f32 v196, v196, v255, v238
v_fma_f32 v197, v197, v255, v239
v_lshlrev_b32 v232, 16, v111
v_and_b32 v233, s95, v111
v_fma_f32 v198, v198, v255, v232
v_fma_f32 v199, v199, v255, v233
s_waitcnt lgkmcnt(0)
v_lshlrev_b32 v234, 16, v152
v_and_b32 v235, s95, v152
v_fma_f32 v200, v200, v255, v234
v_fma_f32 v201, v201, v255, v235
v_lshlrev_b32 v236, 16, v153
v_and_b32 v237, s95, v153
v_fma_f32 v202, v202, v255, v236
v_fma_f32 v203, v203, v255, v237
v_lshlrev_b32 v238, 16, v154
v_and_b32 v239, s95, v154
v_fma_f32 v204, v204, v255, v238
v_fma_f32 v205, v205, v255, v239
v_lshlrev_b32 v232, 16, v155
v_and_b32 v233, s95, v155
v_fma_f32 v206, v206, v255, v232
v_fma_f32 v207, v207, v255, v233
s_waitcnt vmcnt(15)
v_max3_f32 v232, v128, v130, v132
v_max3_f32 v233, v134, v136, v138
v_max_f32 v232, v232, v233
v_subrev_f32 v232, 0x42fe0000, v232
v_sub_f32 v128, v128, v232
v_sub_f32 v130, v130, v232
v_sub_f32 v132, v132, v232
v_sub_f32 v134, v134, v232
v_sub_f32 v136, v136, v232
v_sub_f32 v138, v138, v232
v_cvt_u32_f32 v128, v128
v_cvt_u32_f32 v130, v130
v_cvt_u32_f32 v132, v132
v_cvt_u32_f32 v134, v134
v_cvt_u32_f32 v136, v136
v_cvt_u32_f32 v138, v138
v_lshlrev_b32 v234, 23, v128
v_lshlrev_b32 v235, 23, v130
v_lshlrev_b32 v236, 23, v132
v_lshlrev_b32 v237, 23, v134
v_lshlrev_b32 v238, 23, v136
v_lshlrev_b32 v239, 23, v138
v_mul_f32 v232, v234, v129
v_fmac_f32 v232, v235, v131
v_fmac_f32 v232, v236, v133
v_fmac_f32 v232, v237, v135
v_fmac_f32 v232, v238, v137
v_fmac_f32 v232, v239, v139
v_rcp_f32 v150, v232
v_mul_u32_u24 v144, 0x800080, v128
v_mul_u32_u24 v145, 0x800080, v130
v_mul_u32_u24 v146, 0x800080, v132
v_mul_u32_u24 v147, 0x800080, v134
v_mul_u32_u24 v148, 0x800080, v136
v_mul_u32_u24 v149, 0x800080, v138
ds_write_b128 v242, v[144:147]
ds_write_b96 v242, v[148:150] offset:16
ds_read_b128 v[144:147], v250 offset:0
ds_read_b128 v[148:151], v250 offset:16
ds_read_b128 v[128:131], v250 offset:512
ds_read_b128 v[132:135], v250 offset:528
ds_read_b128 v[136:139], v250 offset:1024
ds_read_b128 v[140:143], v250 offset:1040
s_waitcnt lgkmcnt(4)
v_and_b32 v0, v144, v156
v_and_b32 v1, v144, v157
v_and_b32 v2, v145, v156
v_and_b32 v3, v145, v157
v_and_b32 v4, v146, v156
v_and_b32 v5, v146, v157
v_and_b32 v6, v147, v156
v_and_b32 v7, v147, v157
v_and_b32 v8, v148, v156
v_and_b32 v9, v148, v157
v_and_b32 v10, v149, v156
v_and_b32 v11, v149, v157
v_mov_b32 v40, v150
s_waitcnt lgkmcnt(2)
v_and_b32 v12, v128, v156
v_and_b32 v13, v128, v157
v_and_b32 v14, v129, v156
v_and_b32 v15, v129, v157
v_and_b32 v16, v130, v156
v_and_b32 v17, v130, v157
v_and_b32 v18, v131, v156
v_and_b32 v19, v131, v157
v_and_b32 v20, v132, v156
v_and_b32 v21, v132, v157
v_and_b32 v22, v133, v156
v_and_b32 v23, v133, v157
v_mov_b32 v41, v134
s_waitcnt lgkmcnt(0)
v_and_b32 v24, v136, v156
v_and_b32 v25, v136, v157
v_and_b32 v26, v137, v156
v_and_b32 v27, v137, v157
v_and_b32 v28, v138, v156
v_and_b32 v29, v138, v157
v_and_b32 v30, v139, v156
v_and_b32 v31, v139, v157
v_and_b32 v32, v140, v156
v_and_b32 v33, v140, v157
v_and_b32 v34, v141, v156
v_and_b32 v35, v141, v157
v_mov_b32 v42, v142
s_waitcnt vmcnt(13)
v_swap_b32 v50, v52
v_swap_b32 v51, v53
s_nop 1
v_mfma_f32_16x16x32_bf16 v[136:139], v[48:51], v[0:3], 0
s_add_u32 s49, s6, s44
buffer_load_dwordx4 v[88:91], v43, s[16:19], s49 offen sc1
v_mfma_f32_16x16x32_bf16 v[140:143], v[52:55], v[0:3], 0
s_add_u32 s3, s6, s45
buffer_load_dwordx4 v[92:95], v43, s[16:19], s3 offen sc1
buffer_load_dwordx4 a[160:163], v240, s[16:19], s39 offen offset:0 sc1
s_waitcnt vmcnt(15)
buffer_load_dwordx4 a[164:167], v240, s[16:19], s39 offen offset:1024 sc1
s_waitcnt vmcnt(15)
s_add_u32 s49, s6, s46
buffer_load_dwordx4 v[96:99], v43, s[16:19], s49 offen sc1
ds_read_b128 v[100:103], v76 offset:4096
s_waitcnt vmcnt(14)
v_swap_b32 v58, v60
v_swap_b32 v59, v61
s_nop 1
v_mfma_f32_16x16x32_bf16 v[136:139], v[56:59], v[4:7], v[136:139]
buffer_load_dwordx4 a[168:171], v241, s[16:19], s39 offen offset:0 sc1
v_mfma_f32_16x16x32_bf16 v[140:143], v[60:63], v[4:7], v[140:143]
buffer_load_dwordx4 a[172:175], v241, s[16:19], s39 offen offset:1024 sc1
s_waitcnt vmcnt(15)
s_waitcnt vmcnt(14)
s_add_u32 s49, s7, s42
buffer_load_dwordx4 v[112:115], v47, s[16:19], s49 offen sc1
s_add_u32 s3, s7, s43
buffer_load_dwordx4 v[116:119], v47, s[16:19], s3 offen sc1
s_waitcnt vmcnt(15)
v_swap_b32 v66, v68
v_swap_b32 v67, v69
s_nop 1
v_mfma_f32_16x16x32_bf16 v[136:139], v[64:67], v[8:11], v[136:139]
buffer_load_dwordx4 a[176:179], v240, s[16:19], s39 offen offset:2048 sc1
v_mfma_f32_16x16x32_bf16 v[140:143], v[68:71], v[8:11], v[140:143]
s_waitcnt vmcnt(15)
buffer_load_dwordx4 a[180:183], v240, s[16:19], s39 offen offset:3072 sc1
s_nop 3
v_mul_f32 v136, v136, v40
v_mul_f32 v137, v137, v40
v_mul_f32 v138, v138, v40
v_mul_f32 v139, v139, v40
v_mul_f32 v140, v140, v40
v_mul_f32 v141, v141, v40
v_mul_f32 v142, v142, v40
v_mul_f32 v143, v143, v40
v_cvt_pk_bf16_f32 v136, v136, v137
v_cvt_pk_bf16_f32 v137, v138, v139
v_cvt_pk_bf16_f32 v138, v140, v141
v_cvt_pk_bf16_f32 v139, v142, v143
ds_write_b128 v251, v[136:139] offset:0
s_waitcnt vmcnt(15)
s_waitcnt vmcnt(13)
v_swap_b32 v82, v84
v_swap_b32 v83, v85
s_nop 1
v_mfma_f32_16x16x32_bf16 v[128:131], v[80:83], v[0:3], 0
s_add_u32 s49, s7, s44
buffer_load_dwordx4 v[120:123], v47, s[16:19], s49 offen sc1
v_mfma_f32_16x16x32_bf16 v[132:135], v[84:87], v[0:3], 0
s_add_u32 s3, s7, s45
buffer_load_dwordx4 v[124:127], v47, s[16:19], s3 offen sc1
buffer_load_dwordx4 a[184:187], v241, s[16:19], s39 offen offset:2048 sc1
s_waitcnt vmcnt(15)
buffer_load_dwordx4 a[188:191], v241, s[16:19], s39 offen offset:3072 sc1
s_waitcnt vmcnt(15)
s_add_u32 s49, s7, s46
buffer_load_dwordx4 v[48:51], v47, s[16:19], s49 offen sc1
ds_read_b128 v[52:55], v77 offset:0
s_waitcnt vmcnt(14)
v_swap_b32 v90, v92
v_swap_b32 v91, v93
s_nop 1
v_mfma_f32_16x16x32_bf16 v[128:131], v[88:91], v[4:7], v[128:131]
buffer_load_dwordx4 a[192:195], v240, s[16:19], s40 offen offset:0 sc1
v_mfma_f32_16x16x32_bf16 v[132:135], v[92:95], v[4:7], v[132:135]
buffer_load_dwordx4 a[196:199], v240, s[16:19], s40 offen offset:1024 sc1
s_waitcnt vmcnt(15)
s_waitcnt vmcnt(14)
s_add_u32 s49, s7, s42
buffer_load_dwordx4 v[56:59], v43, s[16:19], s49 offen sc1
s_add_u32 s3, s7, s43
buffer_load_dwordx4 v[60:63], v43, s[16:19], s3 offen sc1
s_waitcnt vmcnt(15)
s_waitcnt lgkmcnt(2)
v_swap_b32 v98, v100
v_swap_b32 v99, v101
s_nop 1
v_mfma_f32_16x16x32_bf16 v[128:131], v[96:99], v[8:11], v[128:131]
buffer_load_dwordx4 a[200:203], v241, s[16:19], s40 offen offset:0 sc1
v_mfma_f32_16x16x32_bf16 v[132:135], v[100:103], v[8:11], v[132:135]
s_waitcnt vmcnt(15)
buffer_load_dwordx4 a[204:207], v241, s[16:19], s40 offen offset:1024 sc1
s_nop 3
v_mul_f32 v128, v128, v40
v_mul_f32 v129, v129, v40
v_mul_f32 v130, v130, v40
v_mul_f32 v131, v131, v40
v_mul_f32 v132, v132, v40
v_mul_f32 v133, v133, v40
v_mul_f32 v134, v134, v40
v_mul_f32 v135, v135, v40
v_cvt_pk_bf16_f32 v128, v128, v129
v_cvt_pk_bf16_f32 v129, v130, v131
v_cvt_pk_bf16_f32 v130, v132, v133
v_cvt_pk_bf16_f32 v131, v134, v135
ds_write_b128 v251, v[128:131] offset:4096
s_waitcnt vmcnt(15)
s_waitcnt lgkmcnt(0)
s_barrier
ds_read_b128 v[208:211], v252 offset:0
ds_read_b128 v[212:215], v252 offset:1024
ds_read_b128 v[216:219], v252 offset:2048
ds_read_b128 v[220:223], v252 offset:3072
ds_read_b128 v[224:227], v252 offset:4096
s_waitcnt vmcnt(13)
s_waitcnt lgkmcnt(4)
v_mfma_f32_16x16x32_bf16 v[160:163], a[128:131], v[208:211], v[160:163]
ds_read_b128 v[228:231], v252 offset:5120
v_swap_b32 v114, v116
v_mfma_f32_16x16x32_bf16 v[164:167], a[132:135], v[208:211], v[164:167]
v_swap_b32 v115, v117
s_nop 1
v_mfma_f32_16x16x32_bf16 v[136:139], v[112:115], v[12:15], 0
s_add_u32 s49, s7, s44
buffer_load_dwordx4 v[64:67], v43, s[16:19], s49 offen sc1
v_mfma_f32_16x16x32_bf16 v[140:143], v[116:119], v[12:15], 0
s_add_u32 s3, s7, s45
buffer_load_dwordx4 v[68:71], v43, s[16:19], s3 offen sc1
v_mfma_f32_16x16x32_bf16 v[168:171], a[136:139], v[208:211], v[168:171]
buffer_load_dwordx4 a[208:211], v240, s[16:19], s40 offen offset:2048 sc1
v_mfma_f32_16x16x32_bf16 v[172:175], a[140:143], v[208:211], v[172:175]
s_waitcnt lgkmcnt(4)
v_mfma_f32_16x16x32_bf16 v[160:163], a[144:147], v[212:215], v[160:163]
v_mfma_f32_16x16x32_bf16 v[164:167], a[148:151], v[212:215], v[164:167]
v_mfma_f32_16x16x32_bf16 v[168:171], a[152:155], v[212:215], v[168:171]
v_mfma_f32_16x16x32_bf16 v[172:175], a[156:159], v[212:215], v[172:175]
s_waitcnt vmcnt(15)
s_waitcnt lgkmcnt(3)
v_mfma_f32_16x16x32_bf16 v[160:163], a[160:163], v[216:219], v[160:163]
buffer_load_dwordx4 a[212:215], v240, s[16:19], s40 offen offset:3072 sc1
v_mfma_f32_16x16x32_bf16 v[164:167], a[164:167], v[216:219], v[164:167]
v_mfma_f32_16x16x32_bf16 v[168:171], a[168:171], v[216:219], v[168:171]
v_mfma_f32_16x16x32_bf16 v[172:175], a[172:175], v[216:219], v[172:175]
s_waitcnt vmcnt(15)
s_add_u32 s49, s7, s46
buffer_load_dwordx4 v[80:83], v43, s[16:19], s49 offen sc1
ds_read_b128 v[84:87], v77 offset:4096
s_waitcnt vmcnt(14)
v_swap_b32 v122, v124
v_swap_b32 v123, v125
s_nop 1
v_mfma_f32_16x16x32_bf16 v[136:139], v[120:123], v[16:19], v[136:139]
buffer_load_dwordx4 a[216:219], v241, s[16:19], s40 offen offset:2048 sc1
v_mfma_f32_16x16x32_bf16 v[140:143], v[124:127], v[16:19], v[140:143]
buffer_load_dwordx4 a[220:223], v241, s[16:19], s40 offen offset:3072 sc1
s_waitcnt vmcnt(15)
s_waitcnt vmcnt(14)
s_waitcnt lgkmcnt(3)
v_mfma_f32_16x16x32_bf16 v[160:163], a[176:179], v[220:223], v[160:163]
s_add_u32 s49, s29, s42
buffer_load_dwordx4 v[88:91], v47, s[16:19], s49 offen sc1
v_mfma_f32_16x16x32_bf16 v[164:167], a[180:183], v[220:223], v[164:167]
s_add_u32 s3, s29, s43
buffer_load_dwordx4 v[92:95], v47, s[16:19], s3 offen sc1
v_mfma_f32_16x16x32_bf16 v[168:171], a[184:187], v[220:223], v[168:171]
v_mfma_f32_16x16x32_bf16 v[172:175], a[188:191], v[220:223], v[172:175]
s_waitcnt vmcnt(15)
v_swap_b32 v50, v52
v_swap_b32 v51, v53
s_nop 1
v_mfma_f32_16x16x32_bf16 v[136:139], v[48:51], v[20:23], v[136:139]
buffer_load_dwordx4 a[224:227], v240, s[16:19], s41 offen offset:0 sc1
v_mfma_f32_16x16x32_bf16 v[140:143], v[52:55], v[20:23], v[140:143]
s_waitcnt vmcnt(15)
buffer_load_dwordx4 a[228:231], v240, s[16:19], s41 offen offset:1024 sc1
s_nop 3
v_mul_f32 v136, v136, v41
v_mul_f32 v137, v137, v41
v_mul_f32 v138, v138, v41
v_mul_f32 v139, v139, v41
v_mul_f32 v140, v140, v41
v_mul_f32 v141, v141, v41
v_mul_f32 v142, v142, v41
v_mul_f32 v143, v143, v41
v_cvt_pk_bf16_f32 v136, v136, v137
v_cvt_pk_bf16_f32 v137, v138, v139
v_cvt_pk_bf16_f32 v138, v140, v141
v_cvt_pk_bf16_f32 v139, v142, v143
ds_write_b128 v251, v[136:139] offset:8192
s_waitcnt vmcnt(15)
buffer_load_dwordx4 a[232:235], v241, s[16:19], s41 offen offset:0 sc1
s_waitcnt vmcnt(14)
v_swap_b32 v58, v60
v_swap_b32 v59, v61
s_nop 1
v_mfma_f32_16x16x32_bf16 v[128:131], v[56:59], v[12:15], 0
buffer_load_dwordx4 a[236:239], v241, s[16:19], s41 offen offset:1024 sc1
v_mfma_f32_16x16x32_bf16 v[132:135], v[60:63], v[12:15], 0
s_waitcnt vmcnt(14)
s_add_u32 s49, s29, s44
buffer_load_dwordx4 v[96:99], v47, s[16:19], s49 offen sc1
s_add_u32 s3, s29, s45
buffer_load_dwordx4 v[100:103], v47, s[16:19], s3 offen sc1
s_waitcnt vmcnt(15)
s_waitcnt lgkmcnt(3)
v_mfma_f32_16x16x32_bf16 v[160:163], a[192:195], v[224:227], v[160:163]
buffer_load_dwordx4 a[240:243], v240, s[16:19], s41 offen offset:2048 sc1
v_mfma_f32_16x16x32_bf16 v[164:167], a[196:199], v[224:227], v[164:167]
v_mfma_f32_16x16x32_bf16 v[168:171], a[200:203], v[224:227], v[168:171]
v_mfma_f32_16x16x32_bf16 v[172:175], a[204:207], v[224:227], v[172:175]
s_waitcnt vmcnt(14)
v_swap_b32 v66, v68
v_swap_b32 v67, v69
s_nop 1
v_mfma_f32_16x16x32_bf16 v[128:131], v[64:67], v[16:19], v[128:131]
buffer_load_dwordx4 a[244:247], v240, s[16:19], s41 offen offset:3072 sc1
v_mfma_f32_16x16x32_bf16 v[132:135], v[68:71], v[16:19], v[132:135]
buffer_load_dwordx4 a[248:251], v241, s[16:19], s41 offen offset:2048 sc1
s_waitcnt vmcnt(15)
buffer_load_dwordx4 a[252:255], v241, s[16:19], s41 offen offset:3072 sc1
s_waitcnt vmcnt(15)
s_waitcnt vmcnt(14)
s_waitcnt lgkmcnt(1)
v_swap_b32 v82, v84
v_swap_b32 v83, v85
s_nop 1
v_mfma_f32_16x16x32_bf16 v[128:131], v[80:83], v[20:23], v[128:131]
s_add_u32 s49, s29, s46
buffer_load_dwordx4 v[112:115], v47, s[16:19], s49 offen sc1
v_mfma_f32_16x16x32_bf16 v[132:135], v[84:87], v[20:23], v[132:135]
s_add_u32 s3, s29, s47
s_cmp_lt_u32 s37, 4
s_cbranch_scc1 LF_o0
buffer_load_dwordx4 v[116:119], v47, s[16:19], s3 offen sc1
ds_read_b128 v[36:39], v78 offset:0
s_branch LF_j0
LF_o0:
s_mov_b32 s3, 0x70000000
buffer_load_dwordx4 v[36:39], v47, s[16:19], s3 offen sc1
ds_read_b128 v[116:119], v78 offset:0
LF_j0:
s_waitcnt vmcnt(15)
v_mul_f32 v128, v128, v41
v_mul_f32 v129, v129, v41
v_mul_f32 v130, v130, v41
v_mul_f32 v131, v131, v41
v_mul_f32 v132, v132, v41
v_mul_f32 v133, v133, v41
v_mul_f32 v134, v134, v41
v_mul_f32 v135, v135, v41
v_cvt_pk_bf16_f32 v128, v128, v129
v_cvt_pk_bf16_f32 v129, v130, v131
v_cvt_pk_bf16_f32 v130, v132, v133
v_cvt_pk_bf16_f32 v131, v134, v135
ds_write_b128 v251, v[128:131] offset:12288
s_waitcnt vmcnt(14)
v_mfma_f32_16x16x32_bf16 v[160:163], a[208:211], v[228:231], v[160:163]
s_add_u32 s49, s29, s42
buffer_load_dwordx4 v[120:123], v43, s[16:19], s49 offen sc1
v_mfma_f32_16x16x32_bf16 v[164:167], a[212:215], v[228:231], v[164:167]
s_add_u32 s3, s29, s43
buffer_load_dwordx4 v[124:127], v43, s[16:19], s3 offen sc1
v_mfma_f32_16x16x32_bf16 v[168:171], a[216:219], v[228:231], v[168:171]
v_mfma_f32_16x16x32_bf16 v[172:175], a[220:223], v[228:231], v[172:175]
s_waitcnt lgkmcnt(0)
s_barrier
ds_read_b128 v[208:211], v252 offset:8192
ds_read_b128 v[212:215], v252 offset:9216
ds_read_b128 v[216:219], v252 offset:10240
ds_read_b128 v[220:223], v252 offset:11264
ds_read_b128 v[224:227], v252 offset:12288
s_waitcnt vmcnt(14)
s_waitcnt lgkmcnt(4)
v_mfma_f32_16x16x32_bf16 v[176:179], a[128:131], v[208:211], v[176:179]
ds_read_b128 v[228:231], v252 offset:6144
v_swap_b32 v90, v92
v_mfma_f32_16x16x32_bf16 v[180:183], a[132:135], v[208:211], v[180:183]
v_swap_b32 v91, v93
s_nop 1
v_mfma_f32_16x16x32_bf16 v[136:139], v[88:91], v[24:27], 0
s_add_u32 s49, s29, s44
buffer_load_dwordx4 v[48:51], v43, s[16:19], s49 offen sc1
v_mfma_f32_16x16x32_bf16 v[140:143], v[92:95], v[24:27], 0
s_add_u32 s3, s29, s45
buffer_load_dwordx4 v[52:55], v43, s[16:19], s3 offen sc1
v_mfma_f32_16x16x32_bf16 v[184:187], a[136:139], v[208:211], v[184:187]
v_mfma_f32_16x16x32_bf16 v[188:191], a[140:143], v[208:211], v[188:191]
s_waitcnt lgkmcnt(4)
v_mfma_f32_16x16x32_bf16 v[176:179], a[144:147], v[212:215], v[176:179]
ds_read_b128 v[208:211], v252 offset:13312
v_mfma_f32_16x16x32_bf16 v[180:183], a[148:151], v[212:215], v[180:183]
v_mfma_f32_16x16x32_bf16 v[184:187], a[152:155], v[212:215], v[184:187]
v_mfma_f32_16x16x32_bf16 v[188:191], a[156:159], v[212:215], v[188:191]
s_waitcnt vmcnt(15)
s_waitcnt lgkmcnt(4)
v_mfma_f32_16x16x32_bf16 v[176:179], a[160:163], v[216:219], v[176:179]
ds_read_b128 v[212:215], v252 offset:14336
v_mfma_f32_16x16x32_bf16 v[180:183], a[164:167], v[216:219], v[180:183]
v_mfma_f32_16x16x32_bf16 v[184:187], a[168:171], v[216:219], v[184:187]
v_mfma_f32_16x16x32_bf16 v[188:191], a[172:175], v[216:219], v[188:191]
s_waitcnt vmcnt(14)
s_waitcnt lgkmcnt(4)
v_mfma_f32_16x16x32_bf16 v[176:179], a[176:179], v[220:223], v[176:179]
ds_read_b128 v[216:219], v252 offset:7168
s_add_u32 s49, s29, s46
buffer_load_dwordx4 v[56:59], v43, s[16:19], s49 offen sc1
v_mfma_f32_16x16x32_bf16 v[180:183], a[180:183], v[220:223], v[180:183]
s_add_u32 s3, s29, s47
s_cmp_lt_u32 s37, 4
s_cbranch_scc1 LF_o1
buffer_load_dwordx4 v[60:63], v43, s[16:19], s3 offen sc1
ds_read_b128 v[36:39], v78 offset:4096
s_branch LF_j1
LF_o1:
s_mov_b32 s3, 0x70000000
buffer_load_dwordx4 v[36:39], v43, s[16:19], s3 offen sc1
ds_read_b128 v[60:63], v78 offset:4096
LF_j1:
v_mfma_f32_16x16x32_bf16 v[184:187], a[184:187], v[220:223], v[184:187]
v_mfma_f32_16x16x32_bf16 v[188:191], a[188:191], v[220:223], v[188:191]
s_waitcnt vmcnt(15)
s_waitcnt lgkmcnt(5)
v_mfma_f32_16x16x32_bf16 v[176:179], a[192:195], v[224:227], v[176:179]
ds_read_b128 v[220:223], v252 offset:15360
v_mfma_f32_16x16x32_bf16 v[180:183], a[196:199], v[224:227], v[180:183]
v_mfma_f32_16x16x32_bf16 v[184:187], a[200:203], v[224:227], v[184:187]
v_mfma_f32_16x16x32_bf16 v[188:191], a[204:207], v[224:227], v[188:191]
s_waitcnt vmcnt(14)
s_waitcnt lgkmcnt(5)
v_mfma_f32_16x16x32_bf16 v[160:163], a[224:227], v[228:231], v[160:163]
v_mfma_f32_16x16x32_bf16 v[164:167], a[228:231], v[228:231], v[164:167]
v_mfma_f32_16x16x32_bf16 v[168:171], a[232:235], v[228:231], v[168:171]
v_mfma_f32_16x16x32_bf16 v[172:175], a[236:239], v[228:231], v[172:175]
s_waitcnt vmcnt(12)
s_waitcnt lgkmcnt(4)
v_mfma_f32_16x16x32_bf16 v[176:179], a[208:211], v[208:211], v[176:179]
v_swap_b32 v98, v100
v_mfma_f32_16x16x32_bf16 v[180:183], a[212:215], v[208:211], v[180:183]
v_swap_b32 v99, v101
s_nop 1
v_mfma_f32_16x16x32_bf16 v[136:139], v[96:99], v[28:31], v[136:139]
v_mfma_f32_16x16x32_bf16 v[140:143], v[100:103], v[28:31], v[140:143]
v_mfma_f32_16x16x32_bf16 v[184:187], a[216:219], v[208:211], v[184:187]
v_mfma_f32_16x16x32_bf16 v[188:191], a[220:223], v[208:211], v[188:191]
s_waitcnt lgkmcnt(3)
v_mfma_f32_16x16x32_bf16 v[176:179], a[224:227], v[212:215], v[176:179]
v_mfma_f32_16x16x32_bf16 v[180:183], a[228:231], v[212:215], v[180:183]
v_mfma_f32_16x16x32_bf16 v[184:187], a[232:235], v[212:215], v[184:187]
v_mfma_f32_16x16x32_bf16 v[188:191], a[236:239], v[212:215], v[188:191]
s_waitcnt vmcnt(11)
s_waitcnt vmcnt(10)
s_waitcnt vmcnt(9)
s_waitcnt vmcnt(8)
s_waitcnt lgkmcnt(2)
v_mfma_f32_16x16x32_bf16 v[160:163], a[240:243], v[216:219], v[160:163]
v_mfma_f32_16x16x32_bf16 v[164:167], a[244:247], v[216:219], v[164:167]
v_mfma_f32_16x16x32_bf16 v[168:171], a[248:251], v[216:219], v[168:171]
v_mfma_f32_16x16x32_bf16 v[172:175], a[252:255], v[216:219], v[172:175]
s_waitcnt vmcnt(6)
s_waitcnt lgkmcnt(0)
v_mfma_f32_16x16x32_bf16 v[176:179], a[240:243], v[220:223], v[176:179]
v_swap_b32 v114, v116
v_mfma_f32_16x16x32_bf16 v[180:183], a[244:247], v[220:223], v[180:183]
v_swap_b32 v115, v117
s_nop 1
v_mfma_f32_16x16x32_bf16 v[136:139], v[112:115], v[32:35], v[136:139]
v_cvt_pk_bf16_f32 v160, v160, v161
v_cvt_pk_bf16_f32 v161, v162, v163
v_mfma_f32_16x16x32_bf16 v[140:143], v[116:119], v[32:35], v[140:143]
v_cvt_pk_bf16_f32 v162, v164, v165
v_cvt_pk_bf16_f32 v163, v166, v167
v_mfma_f32_16x16x32_bf16 v[184:187], a[248:251], v[220:223], v[184:187]
ds_write_b128 v245, v[160:163] offset:0
v_cvt_pk_bf16_f32 v168, v168, v169
v_mfma_f32_16x16x32_bf16 v[188:191], a[252:255], v[220:223], v[188:191]
v_cvt_pk_bf16_f32 v169, v170, v171
v_cvt_pk_bf16_f32 v170, v172, v173
v_cvt_pk_bf16_f32 v171, v174, v175
ds_write_b128 v246, v[168:171] offset:0
ds_read_b128 v[164:167], v247 offset:0
ds_read_b128 v[172:175], v247 offset:1024
v_mul_f32 v136, v136, v42
v_mul_f32 v137, v137, v42
v_mul_f32 v138, v138, v42
v_mul_f32 v139, v139, v42
v_mul_f32 v140, v140, v42
v_mul_f32 v141, v141, v42
v_mul_f32 v142, v142, v42
v_mul_f32 v143, v143, v42
v_cvt_pk_bf16_f32 v136, v136, v137
v_cvt_pk_bf16_f32 v137, v138, v139
v_cvt_pk_bf16_f32 v138, v140, v141
v_cvt_pk_bf16_f32 v139, v142, v143
ds_write_b128 v251, v[136:139] offset:16384
s_waitcnt lgkmcnt(0)
s_barrier
ds_read_b128 v[224:227], v252 offset:16384
ds_read_b128 v[228:231], v252 offset:17408
ds_read_b128 v[208:211], v252 offset:18432
ds_read_b128 v[212:215], v252 offset:19456
s_waitcnt vmcnt(4)
s_waitcnt lgkmcnt(3)
v_mfma_f32_16x16x32_bf16 v[192:195], a[128:131], v[224:227], v[192:195]
v_swap_b32 v122, v124
v_mfma_f32_16x16x32_bf16 v[196:199], a[132:135], v[224:227], v[196:199]
v_swap_b32 v123, v125
s_nop 1
v_mfma_f32_16x16x32_bf16 v[128:131], v[120:123], v[24:27], 0
buffer_store_dwordx4 v[164:167], v44, s[56:59], s6 offen sc1
v_mfma_f32_16x16x32_bf16 v[132:135], v[124:127], v[24:27], 0
buffer_store_dwordx4 v[172:175], v45, s[56:59], s6 offen sc1
v_mfma_f32_16x16x32_bf16 v[200:203], a[136:139], v[224:227], v[200:203]
v_cvt_pk_bf16_f32 v176, v176, v177
v_cvt_pk_bf16_f32 v177, v178, v179
v_mfma_f32_16x16x32_bf16 v[204:207], a[140:143], v[224:227], v[204:207]
v_cvt_pk_bf16_f32 v178, v180, v181
v_cvt_pk_bf16_f32 v179, v182, v183
s_waitcnt lgkmcnt(2)
v_mfma_f32_16x16x32_bf16 v[192:195], a[144:147], v[228:231], v[192:195]
ds_write_b128 v245, v[176:179] offset:2048
v_cvt_pk_bf16_f32 v184, v184, v185
v_mfma_f32_16x16x32_bf16 v[196:199], a[148:151], v[228:231], v[196:199]
v_cvt_pk_bf16_f32 v185, v186, v187
v_cvt_pk_bf16_f32 v186, v188, v189
v_mfma_f32_16x16x32_bf16 v[200:203], a[152:155], v[228:231], v[200:203]
v_cvt_pk_bf16_f32 v187, v190, v191
ds_write_b128 v246, v[184:187] offset:2048
v_mfma_f32_16x16x32_bf16 v[204:207], a[156:159], v[228:231], v[204:207]
ds_read_b128 v[180:183], v247 offset:2048
ds_read_b128 v[188:191], v247 offset:3072
s_waitcnt vmcnt(4)
s_waitcnt lgkmcnt(5)
v_mfma_f32_16x16x32_bf16 v[192:195], a[160:163], v[208:211], v[192:195]
v_swap_b32 v50, v52
v_mfma_f32_16x16x32_bf16 v[196:199], a[164:167], v[208:211], v[196:199]
v_swap_b32 v51, v53
s_nop 1
v_mfma_f32_16x16x32_bf16 v[128:131], v[48:51], v[28:31], v[128:131]
s_waitcnt lgkmcnt(1)
buffer_store_dwordx4 v[180:183], v44, s[56:59], s7 offen sc1
v_mfma_f32_16x16x32_bf16 v[132:135], v[52:55], v[28:31], v[132:135]
s_waitcnt lgkmcnt(0)
buffer_store_dwordx4 v[188:191], v45, s[56:59], s7 offen sc1
v_mfma_f32_16x16x32_bf16 v[200:203], a[168:171], v[208:211], v[200:203]
v_mfma_f32_16x16x32_bf16 v[204:207], a[172:175], v[208:211], v[204:207]
v_mfma_f32_16x16x32_bf16 v[192:195], a[176:179], v[212:215], v[192:195]
v_mfma_f32_16x16x32_bf16 v[196:199], a[180:183], v[212:215], v[196:199]
v_mfma_f32_16x16x32_bf16 v[200:203], a[184:187], v[212:215], v[200:203]
v_mfma_f32_16x16x32_bf16 v[204:207], a[188:191], v[212:215], v[204:207]
s_waitcnt vmcnt(4)
v_swap_b32 v58, v60
v_swap_b32 v59, v61
s_nop 1
v_mfma_f32_16x16x32_bf16 v[128:131], v[56:59], v[32:35], v[128:131]
v_mfma_f32_16x16x32_bf16 v[132:135], v[60:63], v[32:35], v[132:135]
s_nop 6
v_mul_f32 v128, v128, v42
v_mul_f32 v129, v129, v42
v_mul_f32 v130, v130, v42
v_mul_f32 v131, v131, v42
v_mul_f32 v132, v132, v42
v_mul_f32 v133, v133, v42
v_mul_f32 v134, v134, v42
v_mul_f32 v135, v135, v42
v_cvt_pk_bf16_f32 v128, v128, v129
v_cvt_pk_bf16_f32 v129, v130, v131
v_cvt_pk_bf16_f32 v130, v132, v133
v_cvt_pk_bf16_f32 v131, v134, v135
ds_write_b128 v251, v[128:131] offset:20480
s_waitcnt lgkmcnt(0)
s_barrier
ds_read_b128 v[216:219], v252 offset:20480
ds_read_b128 v[220:223], v252 offset:21504
ds_read_b128 v[224:227], v252 offset:22528
ds_read_b128 v[228:231], v252 offset:23552
s_waitcnt lgkmcnt(3)
v_mfma_f32_16x16x32_bf16 v[192:195], a[192:195], v[216:219], v[192:195]
v_mfma_f32_16x16x32_bf16 v[196:199], a[196:199], v[216:219], v[196:199]
v_mfma_f32_16x16x32_bf16 v[200:203], a[200:203], v[216:219], v[200:203]
v_mfma_f32_16x16x32_bf16 v[204:207], a[204:207], v[216:219], v[204:207]
s_waitcnt lgkmcnt(2)
v_mfma_f32_16x16x32_bf16 v[192:195], a[208:211], v[220:223], v[192:195]
v_mfma_f32_16x16x32_bf16 v[196:199], a[212:215], v[220:223], v[196:199]
v_mfma_f32_16x16x32_bf16 v[200:203], a[216:219], v[220:223], v[200:203]
v_mfma_f32_16x16x32_bf16 v[204:207], a[220:223], v[220:223], v[204:207]
s_waitcnt lgkmcnt(1)
v_mfma_f32_16x16x32_bf16 v[192:195], a[224:227], v[224:227], v[192:195]
v_mfma_f32_16x16x32_bf16 v[196:199], a[228:231], v[224:227], v[196:199]
v_mfma_f32_16x16x32_bf16 v[200:203], a[232:235], v[224:227], v[200:203]
v_mfma_f32_16x16x32_bf16 v[204:207], a[236:239], v[224:227], v[204:207]
s_waitcnt lgkmcnt(0)
v_mfma_f32_16x16x32_bf16 v[192:195], a[240:243], v[228:231], v[192:195]
v_mfma_f32_16x16x32_bf16 v[196:199], a[244:247], v[228:231], v[196:199]
v_mfma_f32_16x16x32_bf16 v[200:203], a[248:251], v[228:231], v[200:203]
v_mfma_f32_16x16x32_bf16 v[204:207], a[252:255], v[228:231], v[204:207]
s_nop 4
v_cvt_pk_bf16_f32 v192, v192, v193
v_cvt_pk_bf16_f32 v193, v194, v195
v_cvt_pk_bf16_f32 v194, v196, v197
v_cvt_pk_bf16_f32 v195, v198, v199
ds_write_b128 v245, v[192:195] offset:4096
v_cvt_pk_bf16_f32 v200, v200, v201
v_cvt_pk_bf16_f32 v201, v202, v203
v_cvt_pk_bf16_f32 v202, v204, v205
v_cvt_pk_bf16_f32 v203, v206, v207
ds_write_b128 v246, v[200:203] offset:4096
ds_read_b128 v[196:199], v247 offset:4096
ds_read_b128 v[204:207], v247 offset:5120
s_waitcnt lgkmcnt(1)
buffer_store_dwordx4 v[196:199], v44, s[56:59], s29 offen sc1
s_waitcnt lgkmcnt(0)
buffer_store_dwordx4 v[204:207], v45, s[56:59], s29 offen sc1
s_branch L2_fin
LF_spinQ:
s_mov_b32 s94, 0x10000
LF_spin2Q:
buffer_load_dwordx2 v[248:249], v46, s[16:19], 0 offen offset:0 sc1
s_sub_u32 s94, s94, 1
s_waitcnt vmcnt(0)
s_cbranch_scc1 LF_spin2Q_go
v_cmp_ne_u64 vcc, s[98:99], v[248:249]
s_nop 1
s_cbranch_vccnz LF_spin2Q
LF_spin2Q_go:
s_branch LF_goQ
LF_wf:
s_mov_b32 s94, 0x10000
LF_wf2:
buffer_load_dwordx2 v[108:109], v110, s[16:19], 0 offen sc1
s_sub_u32 s94, s94, 1
s_waitcnt vmcnt(0)
s_cbranch_scc1 LF_wf2_go
v_cmp_ne_u64 vcc, s[98:99], v[108:109]
s_nop 1
s_cbranch_vccnz LF_wf2
LF_wf2_go:
s_branch LF_wf_go
LM_pb:
s_mov_b32 s3, 0x10000
LM_pb2:
buffer_load_dwordx2 v[228:229], v230, s[16:19], 0 offen sc1
s_sub_u32 s3, s3, 1
s_waitcnt vmcnt(0)
s_cbranch_scc1 LM_pb2_go
v_cmp_ne_u64 vcc, s[98:99], v[228:229]
s_nop 1
s_cbranch_vccnz LM_pb2
LM_pb2_go:
s_branch LM_pb_ret
L2_Fend:
LT_disp:
s_cmp_ge_i32 s36, 0
s_cbranch_scc1 LT_start
s_cmp_eq_u32 s34, 0
s_cbranch_scc1 L2_end
s_mov_b32 s41, s34
s_mul_i32 s40, s34, 6
s_add_u32 s40, s40, s37
s_add_u32 s40, s40, 42
s_cmp_lt_u32 s40, 64
s_cbranch_scc1 LE_common
s_branch L2_end
LT_start:
s_waitcnt lgkmcnt(0)
s_add_u32 s12, s4, 0x7c2a000
s_addc_u32 s13, s5, 0
s_mov_b32 s14, 0x8000
s_mov_b32 s15, 0x00020000
v_and_b32 v8, 63, v0
v_lshlrev_b32 v8, 7, v8
s_mov_b32 s91, 8192
s_mov_b32 s90, 16384
s_mov_b32 s95, 24576
v_min_u32 v9, 5248, v8
s_mov_b32 s94, 0x10000
LT_poll:
buffer_load_dwordx2 v[0:1], v8, s[12:15], 0 offen sc1
buffer_load_dwordx2 v[2:3], v8, s[12:15], s91 offen sc1
buffer_load_dwordx2 v[4:5], v8, s[12:15], s90 offen sc1
buffer_load_dwordx2 v[6:7], v9, s[12:15], s95 offen sc1
s_sub_u32 s94, s94, 1
s_waitcnt vmcnt(0)
s_cbranch_scc1 LT_poll_go
v_cmp_ne_u64 vcc, s[98:99], v[0:1]
s_nop 1
s_cbranch_vccnz LT_poll
v_cmp_ne_u64 vcc, s[98:99], v[2:3]
s_nop 1
s_cbranch_vccnz LT_poll
v_cmp_ne_u64 vcc, s[98:99], v[4:5]
s_nop 1
s_cbranch_vccnz LT_poll
v_cmp_ne_u64 vcc, s[98:99], v[6:7]
s_nop 1
s_cbranch_vccnz LT_poll
LT_poll_go:
s_add_u32 s31, s31, -22
s_add_u32 s3, s28, 409600
s_cmp_eq_u32 s36, 0
s_cselect_b32 s31, 26, s31
s_cselect_b32 s39, s39, s3
s_cselect_b32 s33, s33, 0
s_cselect_b32 s3, 0, 425984
s_add_u32 s28, s28, s3
s_add_u32 s12, s4, 0x6800000
s_addc_u32 s13, s5, 0
s_mov_b32 s14, 0x0
s_mov_b32 s15, 0x00020000
s_mov_b32 s14, s49
s_add_u32 s8, s4, 0x0
s_addc_u32 s9, s5, 0
s_mov_b32 s10, 0x4e4000
s_mov_b32 s11, 0x00020000
s_mov_b32 s40, 5111808
s_mov_b32 s44, 5115904
buffer_load_dwordx4 v[0:3], v243, s[8:11], s40 offen offset:0 sc1
buffer_load_dwordx4 v[4:7], v243, s[8:11], s40 offen offset:1024 sc1
buffer_load_dwordx4 v[8:11], v243, s[8:11], s40 offen offset:2048 sc1
buffer_load_dwordx4 v[12:15], v243, s[8:11], s40 offen offset:3072 sc1
buffer_load_dwordx4 v[16:19], v243, s[8:11], s44 offen offset:0 sc1
buffer_load_dwordx4 v[20:23], v243, s[8:11], s44 offen offset:1024 sc1
buffer_load_dwordx4 v[24:27], v243, s[8:11], s44 offen offset:2048 sc1
buffer_load_dwordx4 v[28:31], v243, s[8:11], s44 offen offset:3072 sc1
s_mov_b32 s53, 0
s_add_u32 m0, s53, 90112
s_add_u32 s54, s39, 0
buffer_load_dwordx4 v241, s[12:15], s54 offen offset:0 sc1 lds
buffer_load_dwordx4 v241, s[12:15], s54 offen offset:1024 sc1 lds
buffer_load_dwordx4 v241, s[12:15], s54 offen offset:2048 sc1 lds
buffer_load_dwordx4 v241, s[12:15], s54 offen offset:3072 sc1 lds
s_add_u32 m0, s53, 94208
s_add_u32 s54, s39, 128
buffer_load_dwordx4 v241, s[12:15], s54 offen offset:0 sc1 lds
buffer_load_dwordx4 v241, s[12:15], s54 offen offset:1024 sc1 lds
buffer_load_dwordx4 v241, s[12:15], s54 offen offset:2048 sc1 lds
buffer_load_dwordx4 v241, s[12:15], s54 offen offset:3072 sc1 lds
s_add_u32 m0, s53, 98304
s_add_u32 s54, s39, 256
buffer_load_dwordx4 v241, s[12:15], s54 offen offset:0 sc1 lds
buffer_load_dwordx4 v241, s[12:15], s54 offen offset:1024 sc1 lds
buffer_load_dwordx4 v241, s[12:15], s54 offen offset:2048 sc1 lds
buffer_load_dwordx4 v241, s[12:15], s54 offen offset:3072 sc1 lds
s_add_u32 m0, s53, 102400
s_add_u32 s54, s39, 384
buffer_load_dwordx4 v241, s[12:15], s54 offen offset:0 sc1 lds
buffer_load_dwordx4 v241, s[12:15], s54 offen offset:1024 sc1 lds
buffer_load_dwordx4 v241, s[12:15], s54 offen offset:2048 sc1 lds
buffer_load_dwordx4 v241, s[12:15], s54 offen offset:3072 sc1 lds
s_add_u32 s53, s53, 0x4000
s_and_b32 s53, s53, 0xffff
s_add_u32 m0, s53, 90112
s_add_u32 s54, s28, 0
buffer_load_dwordx4 v241, s[12:15], s54 offen offset:0 sc1 lds
buffer_load_dwordx4 v241, s[12:15], s54 offen offset:1024 sc1 lds
buffer_load_dwordx4 v241, s[12:15], s54 offen offset:2048 sc1 lds
buffer_load_dwordx4 v241, s[12:15], s54 offen offset:3072 sc1 lds
s_add_u32 m0, s53, 94208
s_add_u32 s54, s28, 128
buffer_load_dwordx4 v241, s[12:15], s54 offen offset:0 sc1 lds
buffer_load_dwordx4 v241, s[12:15], s54 offen offset:1024 sc1 lds
buffer_load_dwordx4 v241, s[12:15], s54 offen offset:2048 sc1 lds
buffer_load_dwordx4 v241, s[12:15], s54 offen offset:3072 sc1 lds
s_add_u32 m0, s53, 98304
s_add_u32 s54, s28, 256
buffer_load_dwordx4 v241, s[12:15], s54 offen offset:0 sc1 lds
buffer_load_dwordx4 v241, s[12:15], s54 offen offset:1024 sc1 lds
buffer_load_dwordx4 v241, s[12:15], s54 offen offset:2048 sc1 lds
buffer_load_dwordx4 v241, s[12:15], s54 offen offset:3072 sc1 lds
s_add_u32 m0, s53, 102400
s_add_u32 s54, s28, 384
buffer_load_dwordx4 v241, s[12:15], s54 offen offset:0 sc1 lds
buffer_load_dwordx4 v241, s[12:15], s54 offen offset:1024 sc1 lds
buffer_load_dwordx4 v241, s[12:15], s54 offen offset:2048 sc1 lds
buffer_load_dwordx4 v241, s[12:15], s54 offen offset:3072 sc1 lds
s_add_u32 s53, s53, 0x4000
s_and_b32 s53, s53, 0xffff
s_add_u32 s28, s28, 0x4000
s_add_u32 m0, s53, 90112
s_add_u32 s54, s28, 0
buffer_load_dwordx4 v241, s[12:15], s54 offen offset:0 sc1 lds
buffer_load_dwordx4 v241, s[12:15], s54 offen offset:1024 sc1 lds
buffer_load_dwordx4 v241, s[12:15], s54 offen offset:2048 sc1 lds
buffer_load_dwordx4 v241, s[12:15], s54 offen offset:3072 sc1 lds
s_add_u32 m0, s53, 94208
s_add_u32 s54, s28, 128
buffer_load_dwordx4 v241, s[12:15], s54 offen offset:0 sc1 lds
buffer_load_dwordx4 v241, s[12:15], s54 offen offset:1024 sc1 lds
buffer_load_dwordx4 v241, s[12:15], s54 offen offset:2048 sc1 lds
buffer_load_dwordx4 v241, s[12:15], s54 offen offset:3072 sc1 lds
s_add_u32 m0, s53, 98304
s_add_u32 s54, s28, 256
buffer_load_dwordx4 v241, s[12:15], s54 offen offset:0 sc1 lds
buffer_load_dwordx4 v241, s[12:15], s54 offen offset:1024 sc1 lds
buffer_load_dwordx4 v241, s[12:15], s54 offen offset:2048 sc1 lds
buffer_load_dwordx4 v241, s[12:15], s54 offen offset:3072 sc1 lds
s_add_u32 m0, s53, 102400
s_add_u32 s54, s28, 384
buffer_load_dwordx4 v241, s[12:15], s54 offen offset:0 sc1 lds
buffer_load_dwordx4 v241, s[12:15], s54 offen offset:1024 sc1 lds
buffer_load_dwordx4 v241, s[12:15], s54 offen offset:2048 sc1 lds
buffer_load_dwordx4 v241, s[12:15], s54 offen offset:3072 sc1 lds
s_add_u32 s53, s53, 0x4000
s_and_b32 s53, s53, 0xffff
s_add_u32 s28, s28, 0x4000
s_mul_i32 s35, s37, 0x600000
s_add_u32 s20, s4, 0x2000000
s_addc_u32 s21, s5, 0
s_add_u32 s20, s20, s35
s_addc_u32 s21, s21, 0
s_mov_b32 s22, 0x4e4000
s_mov_b32 s23, 0x00020000
s_add_u32 s24, s4, 0x6000000
s_addc_u32 s25, s5, 0
s_mov_b32 s26, 0x139000
s_mov_b32 s27, 0x00020000
s_lshl_b32 s48, s37, 3
s_add_u32 s48, s48, 638976
s_mov_b32 s48, 1277952
v_bfe_u32 v240, v243, 4, 3
v_lshlrev_b32 v240, 6, v240
v_bfe_u32 v242, v243, 7, 1
v_lshl_or_b32 v240, v242, 10, v240
v_bfe_u32 v242, v243, 8, 2
v_lshl_or_b32 v240, v242, 4, v240
v_bfe_u32 v242, v243, 6, 1
v_lshlrev_b32 v242, 5, v242
v_xor_b32 v240, v240, v242
v_and_b32 v246, 0x1c0, v243
v_bfe_u32 v242, v243, 9, 1
v_lshl_or_b32 v246, v242, 10, v246
v_bfe_u32 v242, v243, 8, 1
v_lshl_or_b32 v246, v242, 5, v246
v_bfe_u32 v242, v243, 4, 2
v_lshl_or_b32 v246, v242, 3, v246
v_xor_b32 v247, 32, v246
v_bfe_i32 v242, v243, 8, 1
v_and_b32 v192, s33, v242
v_and_b32 v193, s33, v242
v_and_b32 v194, s33, v242
v_and_b32 v195, s33, v242
s_add_u32 s51, s31, 0
s_mov_b32 s52, 90112
v_mov_b32 v172, 0xff800000
v_mov_b32 v173, 0
v_accvgpr_write_b32 a0, 0
v_accvgpr_write_b32 a1, 0
v_accvgpr_write_b32 a2, 0
v_accvgpr_write_b32 a3, 0
v_accvgpr_write_b32 a4, 0
v_accvgpr_write_b32 a5, 0
v_accvgpr_write_b32 a6, 0
v_accvgpr_write_b32 a7, 0
v_accvgpr_write_b32 a8, 0
v_accvgpr_write_b32 a9, 0
v_accvgpr_write_b32 a10, 0
v_accvgpr_write_b32 a11, 0
v_accvgpr_write_b32 a12, 0
v_accvgpr_write_b32 a13, 0
v_accvgpr_write_b32 a14, 0
v_accvgpr_write_b32 a15, 0
v_accvgpr_write_b32 a16, 0
v_accvgpr_write_b32 a17, 0
v_accvgpr_write_b32 a18, 0
v_accvgpr_write_b32 a19, 0
v_accvgpr_write_b32 a20, 0
v_accvgpr_write_b32 a21, 0
v_accvgpr_write_b32 a22, 0
v_accvgpr_write_b32 a23, 0
v_accvgpr_write_b32 a24, 0
v_accvgpr_write_b32 a25, 0
v_accvgpr_write_b32 a26, 0
v_accvgpr_write_b32 a27, 0
v_accvgpr_write_b32 a28, 0
v_accvgpr_write_b32 a29, 0
v_accvgpr_write_b32 a30, 0
v_accvgpr_write_b32 a31, 0
v_accvgpr_write_b32 a32, 0
v_accvgpr_write_b32 a33, 0
v_accvgpr_write_b32 a34, 0
v_accvgpr_write_b32 a35, 0
v_accvgpr_write_b32 a36, 0
v_accvgpr_write_b32 a37, 0
v_accvgpr_write_b32 a38, 0
v_accvgpr_write_b32 a39, 0
v_accvgpr_write_b32 a40, 0
v_accvgpr_write_b32 a41, 0
v_accvgpr_write_b32 a42, 0
v_accvgpr_write_b32 a43, 0
v_accvgpr_write_b32 a44, 0
v_accvgpr_write_b32 a45, 0
v_accvgpr_write_b32 a46, 0
v_accvgpr_write_b32 a47, 0
v_accvgpr_write_b32 a48, 0
v_accvgpr_write_b32 a49, 0
v_accvgpr_write_b32 a50, 0
v_accvgpr_write_b32 a51, 0
v_accvgpr_write_b32 a52, 0
v_accvgpr_write_b32 a53, 0
v_accvgpr_write_b32 a54, 0
v_accvgpr_write_b32 a55, 0
v_accvgpr_write_b32 a56, 0
v_accvgpr_write_b32 a57, 0
v_accvgpr_write_b32 a58, 0
v_accvgpr_write_b32 a59, 0
v_accvgpr_write_b32 a60, 0
v_accvgpr_write_b32 a61, 0
v_accvgpr_write_b32 a62, 0
v_accvgpr_write_b32 a63, 0
LT_loop:
s_add_u32 m0, s53, 90112
s_add_u32 s54, s28, 0
buffer_load_dwordx4 v241, s[12:15], s54 offen offset:0 sc1 lds
buffer_load_dwordx4 v241, s[12:15], s54 offen offset:1024 sc1 lds
buffer_load_dwordx4 v241, s[12:15], s54 offen offset:2048 sc1 lds
buffer_load_dwordx4 v241, s[12:15], s54 offen offset:3072 sc1 lds
s_add_u32 m0, s53, 94208
s_add_u32 s54, s28, 128
buffer_load_dwordx4 v241, s[12:15], s54 offen offset:0 sc1 lds
buffer_load_dwordx4 v241, s[12:15], s54 offen offset:1024 sc1 lds
buffer_load_dwordx4 v241, s[12:15], s54 offen offset:2048 sc1 lds
buffer_load_dwordx4 v241, s[12:15], s54 offen offset:3072 sc1 lds
s_add_u32 m0, s53, 98304
s_add_u32 s54, s28, 256
buffer_load_dwordx4 v241, s[12:15], s54 offen offset:0 sc1 lds
buffer_load_dwordx4 v241, s[12:15], s54 offen offset:1024 sc1 lds
buffer_load_dwordx4 v241, s[12:15], s54 offen offset:2048 sc1 lds
buffer_load_dwordx4 v241, s[12:15], s54 offen offset:3072 sc1 lds
s_add_u32 m0, s53, 102400
s_add_u32 s54, s28, 384
buffer_load_dwordx4 v241, s[12:15], s54 offen offset:0 sc1 lds
buffer_load_dwordx4 v241, s[12:15], s54 offen offset:1024 sc1 lds
buffer_load_dwordx4 v241, s[12:15], s54 offen offset:2048 sc1 lds
buffer_load_dwordx4 v241, s[12:15], s54 offen offset:3072 sc1 lds
s_add_u32 s53, s53, 0x4000
s_and_b32 s53, s53, 0xffff
s_add_u32 s28, s28, 0x4000
v_add_u32 v177, s52, v240
v_add_u32 v178, s52, v246
v_add_u32 v179, s52, v247
s_add_u32 s52, s52, 0x4000
s_cmp_eq_u32 s52, 155648
s_cselect_b32 s52, 90112, s52
s_waitcnt vmcnt(48)
ds_read_b128 v[32:35], v177 offset:0
ds_read_b128 v[64:67], v177 offset:2048
ds_read_b128 v[36:39], v177 offset:512
ds_read_b128 v[68:71], v177 offset:2560
ds_read_b128 v[40:43], v177 offset:4096
ds_read_b128 v[72:75], v177 offset:6144
ds_read_b128 v[44:47], v177 offset:4608
ds_read_b128 v[76:79], v177 offset:6656
ds_read_b128 v[48:51], v177 offset:8192
ds_read_b128 v[80:83], v177 offset:10240
ds_read_b128 v[52:55], v177 offset:8704
ds_read_b128 v[84:87], v177 offset:10752
ds_read_b128 v[56:59], v177 offset:12288
ds_read_b128 v[88:91], v177 offset:14336
ds_read_b128 v[60:63], v177 offset:12800
ds_read_b128 v[92:95], v177 offset:14848
s_waitcnt lgkmcnt(14)
v_mfma_f32_16x16x32_bf16 v[160:163], v[32:35], v[0:3], v[192:195]
v_mfma_f32_16x16x32_bf16 v[164:167], v[64:67], v[0:3], v[192:195]
s_waitcnt lgkmcnt(12)
v_mfma_f32_16x16x32_bf16 v[160:163], v[36:39], v[4:7], v[160:163]
v_mfma_f32_16x16x32_bf16 v[164:167], v[68:71], v[4:7], v[164:167]
s_waitcnt lgkmcnt(10)
v_mfma_f32_16x16x32_bf16 v[160:163], v[40:43], v[8:11], v[160:163]
v_mfma_f32_16x16x32_bf16 v[164:167], v[72:75], v[8:11], v[164:167]
s_waitcnt lgkmcnt(8)
v_mfma_f32_16x16x32_bf16 v[160:163], v[44:47], v[12:15], v[160:163]
v_mfma_f32_16x16x32_bf16 v[164:167], v[76:79], v[12:15], v[164:167]
s_waitcnt lgkmcnt(6)
v_mfma_f32_16x16x32_bf16 v[160:163], v[48:51], v[16:19], v[160:163]
v_mfma_f32_16x16x32_bf16 v[164:167], v[80:83], v[16:19], v[164:167]
s_waitcnt lgkmcnt(4)
v_mfma_f32_16x16x32_bf16 v[160:163], v[52:55], v[20:23], v[160:163]
v_mfma_f32_16x16x32_bf16 v[164:167], v[84:87], v[20:23], v[164:167]
s_waitcnt lgkmcnt(2)
v_mfma_f32_16x16x32_bf16 v[160:163], v[56:59], v[24:27], v[160:163]
v_mfma_f32_16x16x32_bf16 v[164:167], v[88:91], v[24:27], v[164:167]
s_waitcnt lgkmcnt(0)
v_mfma_f32_16x16x32_bf16 v[160:163], v[60:63], v[28:31], v[160:163]
v_mfma_f32_16x16x32_bf16 v[164:167], v[92:95], v[28:31], v[164:167]
ds_read_b64_tr_b16 v[96:97], v178 offset:0
ds_read_b64_tr_b16 v[98:99], v178 offset:2048
ds_read_b64_tr_b16 v[100:101], v179 offset:0
ds_read_b64_tr_b16 v[102:103], v179 offset:2048
ds_read_b64_tr_b16 v[104:105], v178 offset:512
ds_read_b64_tr_b16 v[106:107], v178 offset:2560
ds_read_b64_tr_b16 v[108:109], v179 offset:512
ds_read_b64_tr_b16 v[110:111], v179 offset:2560
ds_read_b64_tr_b16 v[112:113], v178 offset:4096
ds_read_b64_tr_b16 v[114:115], v178 offset:6144
ds_read_b64_tr_b16 v[116:117], v179 offset:4096
ds_read_b64_tr_b16 v[118:119], v179 offset:6144
ds_read_b64_tr_b16 v[120:121], v178 offset:4608
ds_read_b64_tr_b16 v[122:123], v178 offset:6656
ds_read_b64_tr_b16 v[124:125], v179 offset:4608
ds_read_b64_tr_b16 v[126:127], v179 offset:6656
ds_read_b64_tr_b16 v[128:129], v178 offset:8192
ds_read_b64_tr_b16 v[130:131], v178 offset:10240
ds_read_b64_tr_b16 v[132:133], v179 offset:8192
ds_read_b64_tr_b16 v[134:135], v179 offset:10240
ds_read_b64_tr_b16 v[136:137], v178 offset:8704
ds_read_b64_tr_b16 v[138:139], v178 offset:10752
ds_read_b64_tr_b16 v[140:141], v179 offset:8704
ds_read_b64_tr_b16 v[142:143], v179 offset:10752
ds_read_b64_tr_b16 v[144:145], v178 offset:12288
ds_read_b64_tr_b16 v[146:147], v178 offset:14336
ds_read_b64_tr_b16 v[148:149], v179 offset:12288
ds_read_b64_tr_b16 v[150:151], v179 offset:14336
ds_read_b64_tr_b16 v[152:153], v178 offset:12800
ds_read_b64_tr_b16 v[154:155], v178 offset:14848
ds_read_b64_tr_b16 v[156:157], v179 offset:12800
ds_read_b64_tr_b16 v[158:159], v179 offset:14848
v_mov_b32 v192, 0
v_mov_b32 v193, 0
v_mov_b32 v194, 0
v_mov_b32 v195, 0
s_nop 7
v_max3_f32 v175, v160, v161, v162
v_max3_f32 v175, v175, v163, v164
v_max3_f32 v175, v175, v165, v166
v_max3_f32 v175, v175, v167, v172
v_mov_b32 v176, v175
s_nop 1
v_permlane32_swap_b32 v175, v176
s_nop 1
v_max_f32 v175, v175, v176
v_mov_b32 v176, v175
s_nop 1
v_permlane16_swap_b32 v175, v176
s_nop 1
v_max_f32 v175, v175, v176
v_ceil_f32 v175, v175
v_sub_f32 v174, v172, v175
v_exp_f32 v174, v174
v_mov_b32 v172, v175
v_sub_f32 v160, v160, v172
v_sub_f32 v161, v161, v172
v_sub_f32 v162, v162, v172
v_sub_f32 v163, v163, v172
v_sub_f32 v164, v164, v172
v_sub_f32 v165, v165, v172
v_sub_f32 v166, v166, v172
v_sub_f32 v167, v167, v172
v_exp_f32 v160, v160
v_exp_f32 v161, v161
v_exp_f32 v162, v162
v_exp_f32 v163, v163
v_exp_f32 v164, v164
v_exp_f32 v165, v165
v_exp_f32 v166, v166
v_exp_f32 v167, v167
v_mul_f32 v173, v173, v174
v_cvt_pk_bf16_f32 v168, v160, v161
v_cvt_pk_bf16_f32 v169, v162, v163
v_cvt_pk_bf16_f32 v170, v164, v165
v_cvt_pk_bf16_f32 v171, v166, v167
v_cmp_neq_f32 vcc, 1.0, v174
v_add_f32 v173, v173, v160
v_add_f32 v173, v173, v161
v_add_f32 v173, v173, v162
v_add_f32 v173, v173, v163
v_add_f32 v173, v173, v164
v_add_f32 v173, v173, v165
v_add_f32 v173, v173, v166
v_add_f32 v173, v173, v167
s_cbranch_vccz LT_nors
v_lshrrev_b32 v176, 4, v243
v_and_b32 v176, 0x30, v176
ds_bpermute_b32 v188, v176, v174 offset:0
ds_bpermute_b32 v189, v176, v174 offset:4
ds_bpermute_b32 v190, v176, v174 offset:8
ds_bpermute_b32 v191, v176, v174 offset:12
s_waitcnt lgkmcnt(0)
v_accvgpr_read_b32 v180, a0
v_accvgpr_read_b32 v181, a1
v_accvgpr_read_b32 v182, a2
v_accvgpr_read_b32 v183, a3
v_accvgpr_read_b32 v184, a4
v_accvgpr_read_b32 v185, a5
v_accvgpr_read_b32 v186, a6
v_accvgpr_read_b32 v187, a7
v_mul_f32 v180, v180, v188
v_mul_f32 v181, v181, v189
v_mul_f32 v182, v182, v190
v_mul_f32 v183, v183, v191
v_mul_f32 v184, v184, v188
v_mul_f32 v185, v185, v189
v_mul_f32 v186, v186, v190
v_mul_f32 v187, v187, v191
v_accvgpr_write_b32 a0, v180
v_accvgpr_write_b32 a1, v181
v_accvgpr_write_b32 a2, v182
v_accvgpr_write_b32 a3, v183
v_accvgpr_write_b32 a4, v184
v_accvgpr_write_b32 a5, v185
v_accvgpr_write_b32 a6, v186
v_accvgpr_write_b32 a7, v187
v_accvgpr_read_b32 v180, a8
v_accvgpr_read_b32 v181, a9
v_accvgpr_read_b32 v182, a10
v_accvgpr_read_b32 v183, a11
v_accvgpr_read_b32 v184, a12
v_accvgpr_read_b32 v185, a13
v_accvgpr_read_b32 v186, a14
v_accvgpr_read_b32 v187, a15
v_mul_f32 v180, v180, v188
v_mul_f32 v181, v181, v189
v_mul_f32 v182, v182, v190
v_mul_f32 v183, v183, v191
v_mul_f32 v184, v184, v188
v_mul_f32 v185, v185, v189
v_mul_f32 v186, v186, v190
v_mul_f32 v187, v187, v191
v_accvgpr_write_b32 a8, v180
v_accvgpr_write_b32 a9, v181
v_accvgpr_write_b32 a10, v182
v_accvgpr_write_b32 a11, v183
v_accvgpr_write_b32 a12, v184
v_accvgpr_write_b32 a13, v185
v_accvgpr_write_b32 a14, v186
v_accvgpr_write_b32 a15, v187
v_accvgpr_read_b32 v180, a16
v_accvgpr_read_b32 v181, a17
v_accvgpr_read_b32 v182, a18
v_accvgpr_read_b32 v183, a19
v_accvgpr_read_b32 v184, a20
v_accvgpr_read_b32 v185, a21
v_accvgpr_read_b32 v186, a22
v_accvgpr_read_b32 v187, a23
v_mul_f32 v180, v180, v188
v_mul_f32 v181, v181, v189
v_mul_f32 v182, v182, v190
v_mul_f32 v183, v183, v191
v_mul_f32 v184, v184, v188
v_mul_f32 v185, v185, v189
v_mul_f32 v186, v186, v190
v_mul_f32 v187, v187, v191
v_accvgpr_write_b32 a16, v180
v_accvgpr_write_b32 a17, v181
v_accvgpr_write_b32 a18, v182
v_accvgpr_write_b32 a19, v183
v_accvgpr_write_b32 a20, v184
v_accvgpr_write_b32 a21, v185
v_accvgpr_write_b32 a22, v186
v_accvgpr_write_b32 a23, v187
v_accvgpr_read_b32 v180, a24
v_accvgpr_read_b32 v181, a25
v_accvgpr_read_b32 v182, a26
v_accvgpr_read_b32 v183, a27
v_accvgpr_read_b32 v184, a28
v_accvgpr_read_b32 v185, a29
v_accvgpr_read_b32 v186, a30
v_accvgpr_read_b32 v187, a31
v_mul_f32 v180, v180, v188
v_mul_f32 v181, v181, v189
v_mul_f32 v182, v182, v190
v_mul_f32 v183, v183, v191
v_mul_f32 v184, v184, v188
v_mul_f32 v185, v185, v189
v_mul_f32 v186, v186, v190
v_mul_f32 v187, v187, v191
v_accvgpr_write_b32 a24, v180
v_accvgpr_write_b32 a25, v181
v_accvgpr_write_b32 a26, v182
v_accvgpr_write_b32 a27, v183
v_accvgpr_write_b32 a28, v184
v_accvgpr_write_b32 a29, v185
v_accvgpr_write_b32 a30, v186
v_accvgpr_write_b32 a31, v187
v_accvgpr_read_b32 v180, a32
v_accvgpr_read_b32 v181, a33
v_accvgpr_read_b32 v182, a34
v_accvgpr_read_b32 v183, a35
v_accvgpr_read_b32 v184, a36
v_accvgpr_read_b32 v185, a37
v_accvgpr_read_b32 v186, a38
v_accvgpr_read_b32 v187, a39
v_mul_f32 v180, v180, v188
v_mul_f32 v181, v181, v189
v_mul_f32 v182, v182, v190
v_mul_f32 v183, v183, v191
v_mul_f32 v184, v184, v188
v_mul_f32 v185, v185, v189
v_mul_f32 v186, v186, v190
v_mul_f32 v187, v187, v191
v_accvgpr_write_b32 a32, v180
v_accvgpr_write_b32 a33, v181
v_accvgpr_write_b32 a34, v182
v_accvgpr_write_b32 a35, v183
v_accvgpr_write_b32 a36, v184
v_accvgpr_write_b32 a37, v185
v_accvgpr_write_b32 a38, v186
v_accvgpr_write_b32 a39, v187
v_accvgpr_read_b32 v180, a40
v_accvgpr_read_b32 v181, a41
v_accvgpr_read_b32 v182, a42
v_accvgpr_read_b32 v183, a43
v_accvgpr_read_b32 v184, a44
v_accvgpr_read_b32 v185, a45
v_accvgpr_read_b32 v186, a46
v_accvgpr_read_b32 v187, a47
v_mul_f32 v180, v180, v188
v_mul_f32 v181, v181, v189
v_mul_f32 v182, v182, v190
v_mul_f32 v183, v183, v191
v_mul_f32 v184, v184, v188
v_mul_f32 v185, v185, v189
v_mul_f32 v186, v186, v190
v_mul_f32 v187, v187, v191
v_accvgpr_write_b32 a40, v180
v_accvgpr_write_b32 a41, v181
v_accvgpr_write_b32 a42, v182
v_accvgpr_write_b32 a43, v183
v_accvgpr_write_b32 a44, v184
v_accvgpr_write_b32 a45, v185
v_accvgpr_write_b32 a46, v186
v_accvgpr_write_b32 a47, v187
v_accvgpr_read_b32 v180, a48
v_accvgpr_read_b32 v181, a49
v_accvgpr_read_b32 v182, a50
v_accvgpr_read_b32 v183, a51
v_accvgpr_read_b32 v184, a52
v_accvgpr_read_b32 v185, a53
v_accvgpr_read_b32 v186, a54
v_accvgpr_read_b32 v187, a55
v_mul_f32 v180, v180, v188
v_mul_f32 v181, v181, v189
v_mul_f32 v182, v182, v190
v_mul_f32 v183, v183, v191
v_mul_f32 v184, v184, v188
v_mul_f32 v185, v185, v189
v_mul_f32 v186, v186, v190
v_mul_f32 v187, v187, v191
v_accvgpr_write_b32 a48, v180
v_accvgpr_write_b32 a49, v181
v_accvgpr_write_b32 a50, v182
v_accvgpr_write_b32 a51, v183
v_accvgpr_write_b32 a52, v184
v_accvgpr_write_b32 a53, v185
v_accvgpr_write_b32 a54, v186
v_accvgpr_write_b32 a55, v187
v_accvgpr_read_b32 v180, a56
v_accvgpr_read_b32 v181, a57
v_accvgpr_read_b32 v182, a58
v_accvgpr_read_b32 v183, a59
v_accvgpr_read_b32 v184, a60
v_accvgpr_read_b32 v185, a61
v_accvgpr_read_b32 v186, a62
v_accvgpr_read_b32 v187, a63
v_mul_f32 v180, v180, v188
v_mul_f32 v181, v181, v189
v_mul_f32 v182, v182, v190
v_mul_f32 v183, v183, v191
v_mul_f32 v184, v184, v188
v_mul_f32 v185, v185, v189
v_mul_f32 v186, v186, v190
v_mul_f32 v187, v187, v191
v_accvgpr_write_b32 a56, v180
v_accvgpr_write_b32 a57, v181
v_accvgpr_write_b32 a58, v182
v_accvgpr_write_b32 a59, v183
v_accvgpr_write_b32 a60, v184
v_accvgpr_write_b32 a61, v185
v_accvgpr_write_b32 a62, v186
v_accvgpr_write_b32 a63, v187
LT_nors:
s_waitcnt lgkmcnt(0)
s_nop 1
v_mfma_f32_16x16x32_bf16 a[0:3], v[168:171], v[96:99], a[0:3]
v_mfma_f32_16x16x32_bf16 a[4:7], v[168:171], v[100:103], a[4:7]
v_mfma_f32_16x16x32_bf16 a[8:11], v[168:171], v[104:107], a[8:11]
v_mfma_f32_16x16x32_bf16 a[12:15], v[168:171], v[108:111], a[12:15]
v_mfma_f32_16x16x32_bf16 a[16:19], v[168:171], v[112:115], a[16:19]
v_mfma_f32_16x16x32_bf16 a[20:23], v[168:171], v[116:119], a[20:23]
v_mfma_f32_16x16x32_bf16 a[24:27], v[168:171], v[120:123], a[24:27]
v_mfma_f32_16x16x32_bf16 a[28:31], v[168:171], v[124:127], a[28:31]
v_mfma_f32_16x16x32_bf16 a[32:35], v[168:171], v[128:131], a[32:35]
v_mfma_f32_16x16x32_bf16 a[36:39], v[168:171], v[132:135], a[36:39]
v_mfma_f32_16x16x32_bf16 a[40:43], v[168:171], v[136:139], a[40:43]
v_mfma_f32_16x16x32_bf16 a[44:47], v[168:171], v[140:143], a[44:47]
v_mfma_f32_16x16x32_bf16 a[48:51], v[168:171], v[144:147], a[48:51]
v_mfma_f32_16x16x32_bf16 a[52:55], v[168:171], v[148:151], a[52:55]
v_mfma_f32_16x16x32_bf16 a[56:59], v[168:171], v[152:155], a[56:59]
v_mfma_f32_16x16x32_bf16 a[60:63], v[168:171], v[156:159], a[60:63]
s_sub_u32 s51, s51, 1
s_cmp_lg_u32 s51, 0
s_cbranch_scc1 LT_loop
s_nop 15
s_add_u32 s16, s4, 0x0
s_addc_u32 s17, s5, 0
s_mov_b32 s18, 0x10000000
s_mov_b32 s19, 0x00020000
s_mul_i32 s52, s37, 0x5000
s_add_u32 s52, s52, 0x1200000
s_add_u32 s53, s37, 1610
s_lshl_b32 s53, s53, 7
s_add_u32 s53, s53, 0x7c00000
s_waitcnt vmcnt(0)
s_cmp_eq_u32 s36, 0
s_cbranch_scc1 LT_merge
buffer_store_dwordx4 a[0:3], v243, s[16:19], s52 offen offset:0 sc1
buffer_store_dwordx4 a[4:7], v243, s[16:19], s52 offen offset:1024 sc1
buffer_store_dwordx4 a[8:11], v243, s[16:19], s52 offen offset:2048 sc1
buffer_store_dwordx4 a[12:15], v243, s[16:19], s52 offen offset:3072 sc1
s_add_u32 s52, s52, 4096
buffer_store_dwordx4 a[16:19], v243, s[16:19], s52 offen offset:0 sc1
buffer_store_dwordx4 a[20:23], v243, s[16:19], s52 offen offset:1024 sc1
buffer_store_dwordx4 a[24:27], v243, s[16:19], s52 offen offset:2048 sc1
buffer_store_dwordx4 a[28:31], v243, s[16:19], s52 offen offset:3072 sc1
s_add_u32 s52, s52, 4096
buffer_store_dwordx4 a[32:35], v243, s[16:19], s52 offen offset:0 sc1
buffer_store_dwordx4 a[36:39], v243, s[16:19], s52 offen offset:1024 sc1
buffer_store_dwordx4 a[40:43], v243, s[16:19], s52 offen offset:2048 sc1
buffer_store_dwordx4 a[44:47], v243, s[16:19], s52 offen offset:3072 sc1
s_add_u32 s52, s52, 4096
buffer_store_dwordx4 a[48:51], v243, s[16:19], s52 offen offset:0 sc1
buffer_store_dwordx4 a[52:55], v243, s[16:19], s52 offen offset:1024 sc1
buffer_store_dwordx4 a[56:59], v243, s[16:19], s52 offen offset:2048 sc1
buffer_store_dwordx4 a[60:63], v243, s[16:19], s52 offen offset:3072 sc1
s_add_u32 s52, s52, 4096
buffer_store_dwordx2 v[172:173], v243, s[16:19], s52 offen sc1
s_waitcnt vmcnt(0)
v_mov_b32 v176, s98
v_mov_b32 v177, s99
v_mov_b32 v178, s98
v_mov_b32 v179, s99
s_mov_b64 exec, 0xff
buffer_store_dwordx4 v[176:179], v243, s[16:19], s53 offen sc1
s_mov_b64 exec, -1
s_branch L2_fin
LT_merge:
s_mov_b32 s94, 0x10000
LT_mw:
buffer_load_dwordx2 v[0:1], off, s[16:19], s53 sc1
s_sub_u32 s94, s94, 1
s_waitcnt vmcnt(0)
s_cbranch_scc1 LT_mw_go
v_cmp_ne_u64 vcc, s[98:99], v[0:1]
s_nop 1
s_cbranch_vccnz LT_mw
LT_mw_go:
buffer_load_dwordx4 v[96:99], v243, s[16:19], s52 offen offset:0 sc1
buffer_load_dwordx4 v[100:103], v243, s[16:19], s52 offen offset:1024 sc1
buffer_load_dwordx4 v[104:107], v243, s[16:19], s52 offen offset:2048 sc1
buffer_load_dwordx4 v[108:111], v243, s[16:19], s52 offen offset:3072 sc1
s_add_u32 s52, s52, 4096
buffer_load_dwordx4 v[112:115], v243, s[16:19], s52 offen offset:0 sc1
buffer_load_dwordx4 v[116:119], v243, s[16:19], s52 offen offset:1024 sc1
buffer_load_dwordx4 v[120:123], v243, s[16:19], s52 offen offset:2048 sc1
buffer_load_dwordx4 v[124:127], v243, s[16:19], s52 offen offset:3072 sc1
s_add_u32 s52, s52, 4096
buffer_load_dwordx4 v[128:131], v243, s[16:19], s52 offen offset:0 sc1
buffer_load_dwordx4 v[132:135], v243, s[16:19], s52 offen offset:1024 sc1
buffer_load_dwordx4 v[136:139], v243, s[16:19], s52 offen offset:2048 sc1
buffer_load_dwordx4 v[140:143], v243, s[16:19], s52 offen offset:3072 sc1
s_add_u32 s52, s52, 4096
buffer_load_dwordx4 v[144:147], v243, s[16:19], s52 offen offset:0 sc1
buffer_load_dwordx4 v[148:151], v243, s[16:19], s52 offen offset:1024 sc1
buffer_load_dwordx4 v[152:155], v243, s[16:19], s52 offen offset:2048 sc1
buffer_load_dwordx4 v[156:159], v243, s[16:19], s52 offen offset:3072 sc1
s_add_u32 s52, s52, 4096
buffer_load_dwordx2 v[0:1], v243, s[16:19], s52 offen sc1
v_lshrrev_b32 v176, 4, v243
v_and_b32 v176, 0x30, v176
s_waitcnt vmcnt(0)
v_max_f32 v175, v172, v0
v_sub_f32 v2, v172, v175
v_sub_f32 v3, v0, v175
v_mov_b32 v172, v175
v_exp_f32 v2, v2
v_exp_f32 v3, v3
s_nop 0
v_mul_f32 v173, v173, v2
v_fmac_f32 v173, v1, v3
ds_bpermute_b32 v4, v176, v2 offset:0
ds_bpermute_b32 v8, v176, v3 offset:0
ds_bpermute_b32 v5, v176, v2 offset:4
ds_bpermute_b32 v9, v176, v3 offset:4
ds_bpermute_b32 v6, v176, v2 offset:8
ds_bpermute_b32 v10, v176, v3 offset:8
ds_bpermute_b32 v7, v176, v2 offset:12
ds_bpermute_b32 v11, v176, v3 offset:12
s_waitcnt lgkmcnt(0)
v_accvgpr_read_b32 v180, a0
v_accvgpr_read_b32 v181, a1
v_accvgpr_read_b32 v182, a2
v_accvgpr_read_b32 v183, a3
v_accvgpr_read_b32 v184, a4
v_accvgpr_read_b32 v185, a5
v_accvgpr_read_b32 v186, a6
v_accvgpr_read_b32 v187, a7
v_mul_f32 v180, v180, v4
v_mul_f32 v181, v181, v5
v_mul_f32 v182, v182, v6
v_mul_f32 v183, v183, v7
v_mul_f32 v184, v184, v4
v_mul_f32 v185, v185, v5
v_mul_f32 v186, v186, v6
v_mul_f32 v187, v187, v7
v_fmac_f32 v180, v96, v8
v_fmac_f32 v181, v97, v9
v_fmac_f32 v182, v98, v10
v_fmac_f32 v183, v99, v11
v_fmac_f32 v184, v100, v8
v_fmac_f32 v185, v101, v9
v_fmac_f32 v186, v102, v10
v_fmac_f32 v187, v103, v11
v_cvt_pk_bf16_f32 v32, v180, v181
v_cvt_pk_bf16_f32 v33, v182, v183
v_cvt_pk_bf16_f32 v34, v184, v185
v_cvt_pk_bf16_f32 v35, v186, v187
buffer_store_dwordx4 v[32:35], v243, s[20:23], s40 offen offset:0 sc1
v_accvgpr_read_b32 v180, a8
v_accvgpr_read_b32 v181, a9
v_accvgpr_read_b32 v182, a10
v_accvgpr_read_b32 v183, a11
v_accvgpr_read_b32 v184, a12
v_accvgpr_read_b32 v185, a13
v_accvgpr_read_b32 v186, a14
v_accvgpr_read_b32 v187, a15
v_mul_f32 v180, v180, v4
v_mul_f32 v181, v181, v5
v_mul_f32 v182, v182, v6
v_mul_f32 v183, v183, v7
v_mul_f32 v184, v184, v4
v_mul_f32 v185, v185, v5
v_mul_f32 v186, v186, v6
v_mul_f32 v187, v187, v7
v_fmac_f32 v180, v104, v8
v_fmac_f32 v181, v105, v9
v_fmac_f32 v182, v106, v10
v_fmac_f32 v183, v107, v11
v_fmac_f32 v184, v108, v8
v_fmac_f32 v185, v109, v9
v_fmac_f32 v186, v110, v10
v_fmac_f32 v187, v111, v11
v_cvt_pk_bf16_f32 v36, v180, v181
v_cvt_pk_bf16_f32 v37, v182, v183
v_cvt_pk_bf16_f32 v38, v184, v185
v_cvt_pk_bf16_f32 v39, v186, v187
buffer_store_dwordx4 v[36:39], v243, s[20:23], s40 offen offset:1024 sc1
v_accvgpr_read_b32 v180, a16
v_accvgpr_read_b32 v181, a17
v_accvgpr_read_b32 v182, a18
v_accvgpr_read_b32 v183, a19
v_accvgpr_read_b32 v184, a20
v_accvgpr_read_b32 v185, a21
v_accvgpr_read_b32 v186, a22
v_accvgpr_read_b32 v187, a23
v_mul_f32 v180, v180, v4
v_mul_f32 v181, v181, v5
v_mul_f32 v182, v182, v6
v_mul_f32 v183, v183, v7
v_mul_f32 v184, v184, v4
v_mul_f32 v185, v185, v5
v_mul_f32 v186, v186, v6
v_mul_f32 v187, v187, v7
v_fmac_f32 v180, v112, v8
v_fmac_f32 v181, v113, v9
v_fmac_f32 v182, v114, v10
v_fmac_f32 v183, v115, v11
v_fmac_f32 v184, v116, v8
v_fmac_f32 v185, v117, v9
v_fmac_f32 v186, v118, v10
v_fmac_f32 v187, v119, v11
v_cvt_pk_bf16_f32 v40, v180, v181
v_cvt_pk_bf16_f32 v41, v182, v183
v_cvt_pk_bf16_f32 v42, v184, v185
v_cvt_pk_bf16_f32 v43, v186, v187
buffer_store_dwordx4 v[40:43], v243, s[20:23], s40 offen offset:2048 sc1
v_accvgpr_read_b32 v180, a24
v_accvgpr_read_b32 v181, a25
v_accvgpr_read_b32 v182, a26
v_accvgpr_read_b32 v183, a27
v_accvgpr_read_b32 v184, a28
v_accvgpr_read_b32 v185, a29
v_accvgpr_read_b32 v186, a30
v_accvgpr_read_b32 v187, a31
v_mul_f32 v180, v180, v4
v_mul_f32 v181, v181, v5
v_mul_f32 v182, v182, v6
v_mul_f32 v183, v183, v7
v_mul_f32 v184, v184, v4
v_mul_f32 v185, v185, v5
v_mul_f32 v186, v186, v6
v_mul_f32 v187, v187, v7
v_fmac_f32 v180, v120, v8
v_fmac_f32 v181, v121, v9
v_fmac_f32 v182, v122, v10
v_fmac_f32 v183, v123, v11
v_fmac_f32 v184, v124, v8
v_fmac_f32 v185, v125, v9
v_fmac_f32 v186, v126, v10
v_fmac_f32 v187, v127, v11
v_cvt_pk_bf16_f32 v44, v180, v181
v_cvt_pk_bf16_f32 v45, v182, v183
v_cvt_pk_bf16_f32 v46, v184, v185
v_cvt_pk_bf16_f32 v47, v186, v187
buffer_store_dwordx4 v[44:47], v243, s[20:23], s40 offen offset:3072 sc1
v_accvgpr_read_b32 v180, a32
v_accvgpr_read_b32 v181, a33
v_accvgpr_read_b32 v182, a34
v_accvgpr_read_b32 v183, a35
v_accvgpr_read_b32 v184, a36
v_accvgpr_read_b32 v185, a37
v_accvgpr_read_b32 v186, a38
v_accvgpr_read_b32 v187, a39
v_mul_f32 v180, v180, v4
v_mul_f32 v181, v181, v5
v_mul_f32 v182, v182, v6
v_mul_f32 v183, v183, v7
v_mul_f32 v184, v184, v4
v_mul_f32 v185, v185, v5
v_mul_f32 v186, v186, v6
v_mul_f32 v187, v187, v7
v_fmac_f32 v180, v128, v8
v_fmac_f32 v181, v129, v9
v_fmac_f32 v182, v130, v10
v_fmac_f32 v183, v131, v11
v_fmac_f32 v184, v132, v8
v_fmac_f32 v185, v133, v9
v_fmac_f32 v186, v134, v10
v_fmac_f32 v187, v135, v11
v_cvt_pk_bf16_f32 v48, v180, v181
v_cvt_pk_bf16_f32 v49, v182, v183
v_cvt_pk_bf16_f32 v50, v184, v185
v_cvt_pk_bf16_f32 v51, v186, v187
buffer_store_dwordx4 v[48:51], v243, s[20:23], s44 offen offset:0 sc1
v_accvgpr_read_b32 v180, a40
v_accvgpr_read_b32 v181, a41
v_accvgpr_read_b32 v182, a42
v_accvgpr_read_b32 v183, a43
v_accvgpr_read_b32 v184, a44
v_accvgpr_read_b32 v185, a45
v_accvgpr_read_b32 v186, a46
v_accvgpr_read_b32 v187, a47
v_mul_f32 v180, v180, v4
v_mul_f32 v181, v181, v5
v_mul_f32 v182, v182, v6
v_mul_f32 v183, v183, v7
v_mul_f32 v184, v184, v4
v_mul_f32 v185, v185, v5
v_mul_f32 v186, v186, v6
v_mul_f32 v187, v187, v7
v_fmac_f32 v180, v136, v8
v_fmac_f32 v181, v137, v9
v_fmac_f32 v182, v138, v10
v_fmac_f32 v183, v139, v11
v_fmac_f32 v184, v140, v8
v_fmac_f32 v185, v141, v9
v_fmac_f32 v186, v142, v10
v_fmac_f32 v187, v143, v11
v_cvt_pk_bf16_f32 v52, v180, v181
v_cvt_pk_bf16_f32 v53, v182, v183
v_cvt_pk_bf16_f32 v54, v184, v185
v_cvt_pk_bf16_f32 v55, v186, v187
buffer_store_dwordx4 v[52:55], v243, s[20:23], s44 offen offset:1024 sc1
v_accvgpr_read_b32 v180, a48
v_accvgpr_read_b32 v181, a49
v_accvgpr_read_b32 v182, a50
v_accvgpr_read_b32 v183, a51
v_accvgpr_read_b32 v184, a52
v_accvgpr_read_b32 v185, a53
v_accvgpr_read_b32 v186, a54
v_accvgpr_read_b32 v187, a55
v_mul_f32 v180, v180, v4
v_mul_f32 v181, v181, v5
v_mul_f32 v182, v182, v6
v_mul_f32 v183, v183, v7
v_mul_f32 v184, v184, v4
v_mul_f32 v185, v185, v5
v_mul_f32 v186, v186, v6
v_mul_f32 v187, v187, v7
v_fmac_f32 v180, v144, v8
v_fmac_f32 v181, v145, v9
v_fmac_f32 v182, v146, v10
v_fmac_f32 v183, v147, v11
v_fmac_f32 v184, v148, v8
v_fmac_f32 v185, v149, v9
v_fmac_f32 v186, v150, v10
v_fmac_f32 v187, v151, v11
v_cvt_pk_bf16_f32 v56, v180, v181
v_cvt_pk_bf16_f32 v57, v182, v183
v_cvt_pk_bf16_f32 v58, v184, v185
v_cvt_pk_bf16_f32 v59, v186, v187
buffer_store_dwordx4 v[56:59], v243, s[20:23], s44 offen offset:2048 sc1
v_accvgpr_read_b32 v180, a56
v_accvgpr_read_b32 v181, a57
v_accvgpr_read_b32 v182, a58
v_accvgpr_read_b32 v183, a59
v_accvgpr_read_b32 v184, a60
v_accvgpr_read_b32 v185, a61
v_accvgpr_read_b32 v186, a62
v_accvgpr_read_b32 v187, a63
v_mul_f32 v180, v180, v4
v_mul_f32 v181, v181, v5
v_mul_f32 v182, v182, v6
v_mul_f32 v183, v183, v7
v_mul_f32 v184, v184, v4
v_mul_f32 v185, v185, v5
v_mul_f32 v186, v186, v6
v_mul_f32 v187, v187, v7
v_fmac_f32 v180, v152, v8
v_fmac_f32 v181, v153, v9
v_fmac_f32 v182, v154, v10
v_fmac_f32 v183, v155, v11
v_fmac_f32 v184, v156, v8
v_fmac_f32 v185, v157, v9
v_fmac_f32 v186, v158, v10
v_fmac_f32 v187, v159, v11
v_cvt_pk_bf16_f32 v60, v180, v181
v_cvt_pk_bf16_f32 v61, v182, v183
v_cvt_pk_bf16_f32 v62, v184, v185
v_cvt_pk_bf16_f32 v63, v186, v187
buffer_store_dwordx4 v[60:63], v243, s[20:23], s44 offen offset:3072 sc1
v_mov_b32 v176, v173
s_nop 1
v_permlane32_swap_b32 v173, v176
s_nop 1
v_add_f32 v173, v173, v176
v_mov_b32 v176, v173
s_nop 1
v_permlane16_swap_b32 v173, v176
s_nop 1
v_add_f32 v173, v173, v176
v_lshlrev_b32 v175, 2, v243
s_mov_b64 exec, 0xffff
s_mov_b64 exec, -1
v_bfe_u32 v175, v243, 8, 1
v_mul_u32_u24 v175, 768, v175
v_lshl_add_u32 v175, s37, 7, v175
v_bfe_u32 v176, v243, 4, 4
v_lshl_add_u32 v175, v176, 3, v175
s_mov_b32 exec_hi, 0
buffer_store_dwordx2 v[172:173], v175, s[24:27], s48 offen sc1
s_add_u32 s16, s4, 0x7c00000
s_addc_u32 s17, s5, 0
s_mov_b32 s18, 0x80000
s_mov_b32 s19, 0x00020000
s_add_u32 s48, s37, 1248
s_mul_i32 s48, s48, 128
s_waitcnt vmcnt(0)
v_mov_b32 v176, s98
v_mov_b32 v177, s99
v_mov_b32 v178, s98
v_mov_b32 v179, s99
s_mov_b64 exec, 0xff
buffer_store_dwordx4 v[176:179], v243, s[16:19], s48 offen sc1
s_mov_b64 exec, -1
s_branch L2_fin
LE_start:
s_cmp_ge_u32 s37, 32
s_cbranch_scc1 L2_end
v_lshrrev_b32 v1, 6, v0
s_sub_u32 s37, s37, 30
s_lshl_b32 s35, s35, 1
v_readfirstlane_b32 s41, v1
s_add_u32 s35, s35, s37
s_mul_i32 s35, s35, 3
s_add_u32 s40, s35, s41
s_cmp_ge_u32 s41, 3
s_cbranch_scc1 L2_end
LE_common:
v_and_b32 v1, 63, v0
s_sub_u32 s36, s40, 0
s_mov_b32 s54, 151
s_mul_i32 s36, s36, 151
s_mov_b32 s55, s36
s_sub_u32 s36, s40, 36
s_cselect_b32 s54, s54, 166
s_mul_i32 s36, s36, 166
s_add_u32 s36, s36, 5436
s_cmp_lt_u32 s40, 36
s_cselect_b32 s55, s55, s36
s_sub_u32 s36, s40, 42
s_cselect_b32 s54, s54, 152
s_mul_i32 s36, s36, 152
s_add_u32 s36, s36, 6432
s_cmp_lt_u32 s40, 42
s_cselect_b32 s55, s55, s36
s_sub_u32 s36, s40, 48
s_cselect_b32 s54, s54, 168
s_mul_i32 s36, s36, 168
s_add_u32 s36, s36, 7344
s_cmp_lt_u32 s40, 48
s_cselect_b32 s55, s55, s36
s_mov_b32 s42, 0
s_mov_b32 s49, 512
v_lshrrev_b32 v33, 2, v1
v_and_b32 v34, 3, v1
v_mul_u32_u24 v6, 0x400, v33
v_lshl_add_u32 v6, v34, 4, v6
v_lshlrev_b32 v33, 8, v33
s_mul_i32 s50, s40, 16384
s_lshl_b32 s48, s40, 2
s_waitcnt lgkmcnt(0)
s_add_u32 s8, s4, 0x7c31800
s_addc_u32 s9, s5, 0
s_mov_b32 s10, 0x800
s_mov_b32 s11, 0x00020000
v_and_b32 v194, 15, v0
v_lshlrev_b32 v194, 7, v194
s_mov_b32 s94, 0x10000
LE_poll0:
buffer_load_dwordx2 v[192:193], v194, s[8:11], 0 offen sc1
s_sub_u32 s94, s94, 1
s_waitcnt vmcnt(0)
s_cbranch_scc1 LE_poll0_go
v_cmp_ne_u64 vcc, s[98:99], v[192:193]
s_nop 1
s_cbranch_vccnz LE_poll0
LE_poll0_go:
s_add_u32 s8, s4, 0x7800000
s_addc_u32 s9, s5, 0
s_mov_b32 s10, 0x1000
s_mov_b32 s11, 0x00020000
s_add_u32 s12, s4, 0x8000000
s_addc_u32 s13, s5, 0
s_mov_b32 s14, 0x2800000
s_mov_b32 s15, 0x00020000
buffer_load_dword v4, v33, s[8:11], s48 offen sc1
buffer_load_dwordx4 v[192:195], v6, s[12:15], s50 offen offset:0 sc1
buffer_load_dwordx4 v[196:199], v6, s[12:15], s50 offen offset:64 sc1
buffer_load_dwordx4 v[200:203], v6, s[12:15], s50 offen offset:128 sc1
buffer_load_dwordx4 v[204:207], v6, s[12:15], s50 offen offset:192 sc1
buffer_load_dwordx4 v[208:211], v6, s[12:15], s50 offen offset:256 sc1
buffer_load_dwordx4 v[212:215], v6, s[12:15], s50 offen offset:320 sc1
buffer_load_dwordx4 v[216:219], v6, s[12:15], s50 offen offset:384 sc1
buffer_load_dwordx4 v[220:223], v6, s[12:15], s50 offen offset:448 sc1
buffer_load_dwordx4 v[224:227], v6, s[12:15], s50 offen offset:512 sc1
buffer_load_dwordx4 v[228:231], v6, s[12:15], s50 offen offset:576 sc1
buffer_load_dwordx4 v[232:235], v6, s[12:15], s50 offen offset:640 sc1
buffer_load_dwordx4 v[236:239], v6, s[12:15], s50 offen offset:704 sc1
buffer_load_dwordx4 v[240:243], v6, s[12:15], s50 offen offset:768 sc1
buffer_load_dwordx4 v[244:247], v6, s[12:15], s50 offen offset:832 sc1
buffer_load_dwordx4 v[248:251], v6, s[12:15], s50 offen offset:896 sc1
buffer_load_dwordx4 v[252:255], v6, s[12:15], s50 offen offset:960 sc1
s_add_u32 s16, s4, 0x6800000
s_addc_u32 s17, s5, 0
s_mov_b32 s18, 0x4e2000
s_mov_b32 s19, 0x00020000
s_add_u32 s20, s4, 0x7000000
s_addc_u32 s21, s5, 0
s_mov_b32 s22, 0x4e2000
s_mov_b32 s23, 0x00020000
v_lshlrev_b32 v5, 2, v34
v_and_b32 v2, 15, v1
v_lshrrev_b32 v3, 4, v1
v_mov_b32 v16, 1
v_mov_b32 v17, 4
v_and_b32 v33, 1, v2
v_lshlrev_b32 v33, 4, v33
v_lshlrev_b32 v33, v33, v16
v_mul_u32_u24 v33, 0x3f80, v33
v_lshrrev_b32 v34, 1, v2
v_cmp_eq_u32 vcc, 0, v34
s_nop 1
v_cndmask_b32 v40, 0, v33, vcc
v_cmp_eq_u32 vcc, 1, v34
s_nop 1
v_cndmask_b32 v41, 0, v33, vcc
v_cmp_eq_u32 vcc, 2, v34
s_nop 1
v_cndmask_b32 v42, 0, v33, vcc
v_cmp_eq_u32 vcc, 3, v34
s_nop 1
v_cndmask_b32 v43, 0, v33, vcc
v_cmp_eq_u32 vcc, 4, v34
s_nop 1
v_cndmask_b32 v44, 0, v33, vcc
v_cmp_eq_u32 vcc, 5, v34
s_nop 1
v_cndmask_b32 v45, 0, v33, vcc
v_cmp_eq_u32 vcc, 6, v34
s_nop 1
v_cndmask_b32 v46, 0, v33, vcc
v_cmp_eq_u32 vcc, 7, v34
s_nop 1
v_cndmask_b32 v47, 0, v33, vcc
v_lshlrev_b32 v39, 5, v2
v_lshl_add_u32 v39, v3, 3, v39
v_lshlrev_b32 v2, 4, v2
s_mul_i32 s48, s41, 21504
s_add_u32 s48, s48, 4096
v_mov_b32 v36, s48
v_lshl_add_u32 v38, v3, 2, v36
s_lshl_b32 s36, s41, 10
s_lshl_b32 s35, s55, 2
s_sub_u32 s35, s36, s35
v_mov_b32 v7, s35
v_lshlrev_b32 v35, 4, v1
v_add_u32 v68, s48, v35
v_add_u32 v35, s36, v35
v_lshlrev_b32 v33, 2, v1
v_mov_b32 v72, 0xffff
v_mov_b32 v73, 0xffff
v_mov_b32 v74, 0xffff
v_mov_b32 v75, 0xffff
v_cmp_gt_u32 vcc, s54, v33
v_mov_b32 v48, 0
s_nop 0
v_cndmask_b32 v18, 0, v16, vcc
v_add_u32 v33, 1, v33
v_cmp_gt_u32 vcc, s54, v33
v_mov_b32 v49, 0
s_nop 0
v_cndmask_b32 v19, 0, v16, vcc
v_add_u32 v33, 1, v33
v_cmp_gt_u32 vcc, s54, v33
v_mov_b32 v50, 0
s_nop 0
v_cndmask_b32 v20, 0, v16, vcc
v_add_u32 v33, 1, v33
v_cmp_gt_u32 vcc, s54, v33
v_mov_b32 v51, 0
s_nop 0
v_cndmask_b32 v21, 0, v16, vcc
LE_pass:
ds_write_b128 v35, v[48:51]
ds_write_b128 v68, v[72:75] offset:0
ds_write_b128 v68, v[72:75] offset:1024
ds_write_b128 v68, v[72:75] offset:2048
ds_write_b128 v68, v[72:75] offset:3072
ds_write_b128 v68, v[72:75] offset:4096
ds_write_b128 v68, v[72:75] offset:5120
ds_write_b128 v68, v[72:75] offset:6144
ds_write_b128 v68, v[72:75] offset:7168
ds_write_b128 v68, v[72:75] offset:8192
ds_write_b128 v68, v[72:75] offset:9216
ds_write_b128 v68, v[72:75] offset:10240
ds_write_b128 v68, v[72:75] offset:11264
ds_write_b128 v68, v[72:75] offset:12288
ds_write_b128 v68, v[72:75] offset:13312
ds_write_b128 v68, v[72:75] offset:14336
ds_write_b128 v68, v[72:75] offset:15360
ds_write_b128 v68, v[72:75] offset:16384
ds_write_b128 v68, v[72:75] offset:17408
ds_write_b128 v68, v[72:75] offset:18432
ds_write_b128 v68, v[72:75] offset:19456
v_lshl_add_u32 v32, v1, 2, v36
ds_write_b32 v32, v48 offset:20480
s_waitcnt vmcnt(16)
v_sub_u32 v32, v4, v5
s_waitcnt vmcnt(15)
v_cmpx_lt_i32 vcc, 0, v32
s_cbranch_execz LE_c
v_mad_u32_u16 v128, v192, 1, v7 op_sel:[1,0,0,0]
ds_add_u32 v128, v16
v_cmpx_lt_i32 vcc, 1, v32
v_mad_u32_u16 v129, v193, 1, v7 op_sel:[1,0,0,0]
ds_add_u32 v129, v16
v_cmpx_lt_i32 vcc, 2, v32
v_mad_u32_u16 v130, v194, 1, v7 op_sel:[1,0,0,0]
ds_add_u32 v130, v16
v_cmpx_lt_i32 vcc, 3, v32
v_mad_u32_u16 v131, v195, 1, v7 op_sel:[1,0,0,0]
ds_add_u32 v131, v16
s_waitcnt vmcnt(14)
v_cmpx_lt_i32 vcc, 16, v32
s_cbranch_execz LE_c
v_mad_u32_u16 v132, v196, 1, v7 op_sel:[1,0,0,0]
ds_add_u32 v132, v16
v_cmpx_lt_i32 vcc, 17, v32
v_mad_u32_u16 v133, v197, 1, v7 op_sel:[1,0,0,0]
ds_add_u32 v133, v16
v_cmpx_lt_i32 vcc, 18, v32
v_mad_u32_u16 v134, v198, 1, v7 op_sel:[1,0,0,0]
ds_add_u32 v134, v16
v_cmpx_lt_i32 vcc, 19, v32
v_mad_u32_u16 v135, v199, 1, v7 op_sel:[1,0,0,0]
ds_add_u32 v135, v16
s_waitcnt vmcnt(13)
v_cmpx_lt_i32 vcc, 32, v32
s_cbranch_execz LE_c
v_mad_u32_u16 v136, v200, 1, v7 op_sel:[1,0,0,0]
ds_add_u32 v136, v16
v_cmpx_lt_i32 vcc, 33, v32
v_mad_u32_u16 v137, v201, 1, v7 op_sel:[1,0,0,0]
ds_add_u32 v137, v16
v_cmpx_lt_i32 vcc, 34, v32
v_mad_u32_u16 v138, v202, 1, v7 op_sel:[1,0,0,0]
ds_add_u32 v138, v16
v_cmpx_lt_i32 vcc, 35, v32
v_mad_u32_u16 v139, v203, 1, v7 op_sel:[1,0,0,0]
ds_add_u32 v139, v16
s_waitcnt vmcnt(12)
v_cmpx_lt_i32 vcc, 48, v32
s_cbranch_execz LE_c
v_mad_u32_u16 v140, v204, 1, v7 op_sel:[1,0,0,0]
ds_add_u32 v140, v16
v_cmpx_lt_i32 vcc, 49, v32
v_mad_u32_u16 v141, v205, 1, v7 op_sel:[1,0,0,0]
ds_add_u32 v141, v16
v_cmpx_lt_i32 vcc, 50, v32
v_mad_u32_u16 v142, v206, 1, v7 op_sel:[1,0,0,0]
ds_add_u32 v142, v16
v_cmpx_lt_i32 vcc, 51, v32
v_mad_u32_u16 v143, v207, 1, v7 op_sel:[1,0,0,0]
ds_add_u32 v143, v16
s_waitcnt vmcnt(11)
v_cmpx_lt_i32 vcc, 64, v32
s_cbranch_execz LE_c
v_mad_u32_u16 v144, v208, 1, v7 op_sel:[1,0,0,0]
ds_add_u32 v144, v16
v_cmpx_lt_i32 vcc, 65, v32
v_mad_u32_u16 v145, v209, 1, v7 op_sel:[1,0,0,0]
ds_add_u32 v145, v16
v_cmpx_lt_i32 vcc, 66, v32
v_mad_u32_u16 v146, v210, 1, v7 op_sel:[1,0,0,0]
ds_add_u32 v146, v16
v_cmpx_lt_i32 vcc, 67, v32
v_mad_u32_u16 v147, v211, 1, v7 op_sel:[1,0,0,0]
ds_add_u32 v147, v16
s_waitcnt vmcnt(10)
v_cmpx_lt_i32 vcc, 80, v32
s_cbranch_execz LE_c
v_mad_u32_u16 v148, v212, 1, v7 op_sel:[1,0,0,0]
ds_add_u32 v148, v16
v_cmpx_lt_i32 vcc, 81, v32
v_mad_u32_u16 v149, v213, 1, v7 op_sel:[1,0,0,0]
ds_add_u32 v149, v16
v_cmpx_lt_i32 vcc, 82, v32
v_mad_u32_u16 v150, v214, 1, v7 op_sel:[1,0,0,0]
ds_add_u32 v150, v16
v_cmpx_lt_i32 vcc, 83, v32
v_mad_u32_u16 v151, v215, 1, v7 op_sel:[1,0,0,0]
ds_add_u32 v151, v16
s_waitcnt vmcnt(9)
v_cmpx_lt_i32 vcc, 96, v32
s_cbranch_execz LE_c
v_mad_u32_u16 v152, v216, 1, v7 op_sel:[1,0,0,0]
ds_add_u32 v152, v16
v_cmpx_lt_i32 vcc, 97, v32
v_mad_u32_u16 v153, v217, 1, v7 op_sel:[1,0,0,0]
ds_add_u32 v153, v16
v_cmpx_lt_i32 vcc, 98, v32
v_mad_u32_u16 v154, v218, 1, v7 op_sel:[1,0,0,0]
ds_add_u32 v154, v16
v_cmpx_lt_i32 vcc, 99, v32
v_mad_u32_u16 v155, v219, 1, v7 op_sel:[1,0,0,0]
ds_add_u32 v155, v16
s_waitcnt vmcnt(8)
v_cmpx_lt_i32 vcc, 112, v32
s_cbranch_execz LE_c
v_mad_u32_u16 v156, v220, 1, v7 op_sel:[1,0,0,0]
ds_add_u32 v156, v16
v_cmpx_lt_i32 vcc, 113, v32
v_mad_u32_u16 v157, v221, 1, v7 op_sel:[1,0,0,0]
ds_add_u32 v157, v16
v_cmpx_lt_i32 vcc, 114, v32
v_mad_u32_u16 v158, v222, 1, v7 op_sel:[1,0,0,0]
ds_add_u32 v158, v16
v_cmpx_lt_i32 vcc, 115, v32
v_mad_u32_u16 v159, v223, 1, v7 op_sel:[1,0,0,0]
ds_add_u32 v159, v16
s_waitcnt vmcnt(7)
v_cmpx_lt_i32 vcc, 128, v32
s_cbranch_execz LE_c
v_mad_u32_u16 v160, v224, 1, v7 op_sel:[1,0,0,0]
ds_add_u32 v160, v16
v_cmpx_lt_i32 vcc, 129, v32
v_mad_u32_u16 v161, v225, 1, v7 op_sel:[1,0,0,0]
ds_add_u32 v161, v16
v_cmpx_lt_i32 vcc, 130, v32
v_mad_u32_u16 v162, v226, 1, v7 op_sel:[1,0,0,0]
ds_add_u32 v162, v16
v_cmpx_lt_i32 vcc, 131, v32
v_mad_u32_u16 v163, v227, 1, v7 op_sel:[1,0,0,0]
ds_add_u32 v163, v16
s_waitcnt vmcnt(6)
v_cmpx_lt_i32 vcc, 144, v32
s_cbranch_execz LE_c
v_mad_u32_u16 v164, v228, 1, v7 op_sel:[1,0,0,0]
ds_add_u32 v164, v16
v_cmpx_lt_i32 vcc, 145, v32
v_mad_u32_u16 v165, v229, 1, v7 op_sel:[1,0,0,0]
ds_add_u32 v165, v16
v_cmpx_lt_i32 vcc, 146, v32
v_mad_u32_u16 v166, v230, 1, v7 op_sel:[1,0,0,0]
ds_add_u32 v166, v16
v_cmpx_lt_i32 vcc, 147, v32
v_mad_u32_u16 v167, v231, 1, v7 op_sel:[1,0,0,0]
ds_add_u32 v167, v16
s_waitcnt vmcnt(5)
v_cmpx_lt_i32 vcc, 160, v32
s_cbranch_execz LE_c
v_mad_u32_u16 v168, v232, 1, v7 op_sel:[1,0,0,0]
ds_add_u32 v168, v16
v_cmpx_lt_i32 vcc, 161, v32
v_mad_u32_u16 v169, v233, 1, v7 op_sel:[1,0,0,0]
ds_add_u32 v169, v16
v_cmpx_lt_i32 vcc, 162, v32
v_mad_u32_u16 v170, v234, 1, v7 op_sel:[1,0,0,0]
ds_add_u32 v170, v16
v_cmpx_lt_i32 vcc, 163, v32
v_mad_u32_u16 v171, v235, 1, v7 op_sel:[1,0,0,0]
ds_add_u32 v171, v16
s_waitcnt vmcnt(4)
v_cmpx_lt_i32 vcc, 176, v32
s_cbranch_execz LE_c
v_mad_u32_u16 v172, v236, 1, v7 op_sel:[1,0,0,0]
ds_add_u32 v172, v16
v_cmpx_lt_i32 vcc, 177, v32
v_mad_u32_u16 v173, v237, 1, v7 op_sel:[1,0,0,0]
ds_add_u32 v173, v16
v_cmpx_lt_i32 vcc, 178, v32
v_mad_u32_u16 v174, v238, 1, v7 op_sel:[1,0,0,0]
ds_add_u32 v174, v16
v_cmpx_lt_i32 vcc, 179, v32
v_mad_u32_u16 v175, v239, 1, v7 op_sel:[1,0,0,0]
ds_add_u32 v175, v16
s_waitcnt vmcnt(3)
v_cmpx_lt_i32 vcc, 192, v32
s_cbranch_execz LE_c
v_mad_u32_u16 v176, v240, 1, v7 op_sel:[1,0,0,0]
ds_add_u32 v176, v16
v_cmpx_lt_i32 vcc, 193, v32
v_mad_u32_u16 v177, v241, 1, v7 op_sel:[1,0,0,0]
ds_add_u32 v177, v16
v_cmpx_lt_i32 vcc, 194, v32
v_mad_u32_u16 v178, v242, 1, v7 op_sel:[1,0,0,0]
ds_add_u32 v178, v16
v_cmpx_lt_i32 vcc, 195, v32
v_mad_u32_u16 v179, v243, 1, v7 op_sel:[1,0,0,0]
ds_add_u32 v179, v16
s_waitcnt vmcnt(2)
v_cmpx_lt_i32 vcc, 208, v32
s_cbranch_execz LE_c
v_mad_u32_u16 v180, v244, 1, v7 op_sel:[1,0,0,0]
ds_add_u32 v180, v16
v_cmpx_lt_i32 vcc, 209, v32
v_mad_u32_u16 v181, v245, 1, v7 op_sel:[1,0,0,0]
ds_add_u32 v181, v16
v_cmpx_lt_i32 vcc, 210, v32
v_mad_u32_u16 v182, v246, 1, v7 op_sel:[1,0,0,0]
ds_add_u32 v182, v16
v_cmpx_lt_i32 vcc, 211, v32
v_mad_u32_u16 v183, v247, 1, v7 op_sel:[1,0,0,0]
ds_add_u32 v183, v16
s_waitcnt vmcnt(1)
v_cmpx_lt_i32 vcc, 224, v32
s_cbranch_execz LE_c
v_mad_u32_u16 v184, v248, 1, v7 op_sel:[1,0,0,0]
ds_add_u32 v184, v16
v_cmpx_lt_i32 vcc, 225, v32
v_mad_u32_u16 v185, v249, 1, v7 op_sel:[1,0,0,0]
ds_add_u32 v185, v16
v_cmpx_lt_i32 vcc, 226, v32
v_mad_u32_u16 v186, v250, 1, v7 op_sel:[1,0,0,0]
ds_add_u32 v186, v16
v_cmpx_lt_i32 vcc, 227, v32
v_mad_u32_u16 v187, v251, 1, v7 op_sel:[1,0,0,0]
ds_add_u32 v187, v16
s_waitcnt vmcnt(0)
v_cmpx_lt_i32 vcc, 240, v32
s_cbranch_execz LE_c
v_mad_u32_u16 v188, v252, 1, v7 op_sel:[1,0,0,0]
ds_add_u32 v188, v16
v_cmpx_lt_i32 vcc, 241, v32
v_mad_u32_u16 v189, v253, 1, v7 op_sel:[1,0,0,0]
ds_add_u32 v189, v16
v_cmpx_lt_i32 vcc, 242, v32
v_mad_u32_u16 v190, v254, 1, v7 op_sel:[1,0,0,0]
ds_add_u32 v190, v16
v_cmpx_lt_i32 vcc, 243, v32
v_mad_u32_u16 v191, v255, 1, v7 op_sel:[1,0,0,0]
ds_add_u32 v191, v16
LE_c:
s_mov_b64 exec, -1
ds_read_b128 v[24:27], v35
s_waitcnt lgkmcnt(0)
v_add_u32 v24, 3, v24
v_lshrrev_b32 v24, 2, v24
v_max_u32 v24, v24, v18
v_add_u32 v25, 3, v25
v_lshrrev_b32 v25, 2, v25
v_max_u32 v25, v25, v19
v_add_u32 v26, 3, v26
v_lshrrev_b32 v26, 2, v26
v_max_u32 v26, v26, v20
v_add_u32 v27, 3, v27
v_lshrrev_b32 v27, 2, v27
v_max_u32 v27, v27, v21
v_add_u32 v33, v24, v25
v_add3_u32 v33, v33, v26, v27
v_mov_b32 v64, v33
s_nop 1
v_add_u32_dpp v64, v64, v64 row_shr:1 row_mask:0xf bank_mask:0xf
s_nop 1
v_add_u32_dpp v64, v64, v64 row_shr:2 row_mask:0xf bank_mask:0xf
s_nop 1
v_add_u32_dpp v64, v64, v64 row_shr:4 row_mask:0xf bank_mask:0xf
s_nop 1
v_add_u32_dpp v64, v64, v64 row_shr:8 row_mask:0xf bank_mask:0xf
s_nop 1
v_add_u32_dpp v64, v64, v64 row_bcast:15 row_mask:0xa bank_mask:0xf
s_nop 1
v_add_u32_dpp v64, v64, v64 row_bcast:31 row_mask:0xc bank_mask:0xf
s_nop 1
v_readlane_b32 s44, v64, 63
v_sub_u32 v28, v64, v33
v_add_u32 v29, v28, v24
v_add_u32 v30, v29, v25
v_add_u32 v31, v30, v26
v_add3_u32 v33, v28, v24, -1
v_lshlrev_b32 v34, v33, v18
v_lshrrev_b32 v33, 5, v33
v_lshl_add_u32 v33, v33, 2, v36
ds_or_b32 v33, v34 offset:20480
v_lshl_add_u32 v28, v28, 4, v36
v_add3_u32 v33, v29, v25, -1
v_lshlrev_b32 v34, v33, v19
v_lshrrev_b32 v33, 5, v33
v_lshl_add_u32 v33, v33, 2, v36
ds_or_b32 v33, v34 offset:20480
v_lshl_add_u32 v29, v29, 4, v36
v_add3_u32 v33, v30, v26, -1
v_lshlrev_b32 v34, v33, v20
v_lshrrev_b32 v33, 5, v33
v_lshl_add_u32 v33, v33, 2, v36
ds_or_b32 v33, v34 offset:20480
v_lshl_add_u32 v30, v30, 4, v36
v_add3_u32 v33, v31, v27, -1
v_lshlrev_b32 v34, v33, v21
v_lshrrev_b32 v33, 5, v33
v_lshl_add_u32 v33, v33, 2, v36
ds_or_b32 v33, v34 offset:20480
v_lshl_add_u32 v31, v31, 4, v36
ds_write_b128 v35, v[28:31]
s_add_u32 s44, s44, 31
s_lshr_b32 s44, s44, 5
v_cmpx_lt_i32 vcc, 0, v32
s_cbranch_execz LE_p
ds_add_rtn_u32 v128, v128, v17
v_cmpx_lt_i32 vcc, 1, v32
ds_add_rtn_u32 v129, v129, v17
v_cmpx_lt_i32 vcc, 2, v32
ds_add_rtn_u32 v130, v130, v17
v_cmpx_lt_i32 vcc, 3, v32
ds_add_rtn_u32 v131, v131, v17
v_cmpx_lt_i32 vcc, 16, v32
s_cbranch_execz LE_p
ds_add_rtn_u32 v132, v132, v17
v_cmpx_lt_i32 vcc, 17, v32
ds_add_rtn_u32 v133, v133, v17
v_cmpx_lt_i32 vcc, 18, v32
ds_add_rtn_u32 v134, v134, v17
v_cmpx_lt_i32 vcc, 19, v32
ds_add_rtn_u32 v135, v135, v17
v_cmpx_lt_i32 vcc, 32, v32
s_cbranch_execz LE_p
ds_add_rtn_u32 v136, v136, v17
v_cmpx_lt_i32 vcc, 33, v32
ds_add_rtn_u32 v137, v137, v17
v_cmpx_lt_i32 vcc, 34, v32
ds_add_rtn_u32 v138, v138, v17
v_cmpx_lt_i32 vcc, 35, v32
ds_add_rtn_u32 v139, v139, v17
v_cmpx_lt_i32 vcc, 48, v32
s_cbranch_execz LE_p
ds_add_rtn_u32 v140, v140, v17
v_cmpx_lt_i32 vcc, 49, v32
ds_add_rtn_u32 v141, v141, v17
v_cmpx_lt_i32 vcc, 50, v32
ds_add_rtn_u32 v142, v142, v17
v_cmpx_lt_i32 vcc, 51, v32
ds_add_rtn_u32 v143, v143, v17
v_cmpx_lt_i32 vcc, 64, v32
s_cbranch_execz LE_p
ds_add_rtn_u32 v144, v144, v17
v_cmpx_lt_i32 vcc, 65, v32
ds_add_rtn_u32 v145, v145, v17
v_cmpx_lt_i32 vcc, 66, v32
ds_add_rtn_u32 v146, v146, v17
v_cmpx_lt_i32 vcc, 67, v32
ds_add_rtn_u32 v147, v147, v17
v_cmpx_lt_i32 vcc, 80, v32
s_cbranch_execz LE_p
ds_add_rtn_u32 v148, v148, v17
v_cmpx_lt_i32 vcc, 81, v32
ds_add_rtn_u32 v149, v149, v17
v_cmpx_lt_i32 vcc, 82, v32
ds_add_rtn_u32 v150, v150, v17
v_cmpx_lt_i32 vcc, 83, v32
ds_add_rtn_u32 v151, v151, v17
v_cmpx_lt_i32 vcc, 96, v32
s_cbranch_execz LE_p
ds_add_rtn_u32 v152, v152, v17
v_cmpx_lt_i32 vcc, 97, v32
ds_add_rtn_u32 v153, v153, v17
v_cmpx_lt_i32 vcc, 98, v32
ds_add_rtn_u32 v154, v154, v17
v_cmpx_lt_i32 vcc, 99, v32
ds_add_rtn_u32 v155, v155, v17
v_cmpx_lt_i32 vcc, 112, v32
s_cbranch_execz LE_p
ds_add_rtn_u32 v156, v156, v17
v_cmpx_lt_i32 vcc, 113, v32
ds_add_rtn_u32 v157, v157, v17
v_cmpx_lt_i32 vcc, 114, v32
ds_add_rtn_u32 v158, v158, v17
v_cmpx_lt_i32 vcc, 115, v32
ds_add_rtn_u32 v159, v159, v17
v_cmpx_lt_i32 vcc, 128, v32
s_cbranch_execz LE_p
ds_add_rtn_u32 v160, v160, v17
v_cmpx_lt_i32 vcc, 129, v32
ds_add_rtn_u32 v161, v161, v17
v_cmpx_lt_i32 vcc, 130, v32
ds_add_rtn_u32 v162, v162, v17
v_cmpx_lt_i32 vcc, 131, v32
ds_add_rtn_u32 v163, v163, v17
v_cmpx_lt_i32 vcc, 144, v32
s_cbranch_execz LE_p
ds_add_rtn_u32 v164, v164, v17
v_cmpx_lt_i32 vcc, 145, v32
ds_add_rtn_u32 v165, v165, v17
v_cmpx_lt_i32 vcc, 146, v32
ds_add_rtn_u32 v166, v166, v17
v_cmpx_lt_i32 vcc, 147, v32
ds_add_rtn_u32 v167, v167, v17
v_cmpx_lt_i32 vcc, 160, v32
s_cbranch_execz LE_p
ds_add_rtn_u32 v168, v168, v17
v_cmpx_lt_i32 vcc, 161, v32
ds_add_rtn_u32 v169, v169, v17
v_cmpx_lt_i32 vcc, 162, v32
ds_add_rtn_u32 v170, v170, v17
v_cmpx_lt_i32 vcc, 163, v32
ds_add_rtn_u32 v171, v171, v17
v_cmpx_lt_i32 vcc, 176, v32
s_cbranch_execz LE_p
ds_add_rtn_u32 v172, v172, v17
v_cmpx_lt_i32 vcc, 177, v32
ds_add_rtn_u32 v173, v173, v17
v_cmpx_lt_i32 vcc, 178, v32
ds_add_rtn_u32 v174, v174, v17
v_cmpx_lt_i32 vcc, 179, v32
ds_add_rtn_u32 v175, v175, v17
v_cmpx_lt_i32 vcc, 192, v32
s_cbranch_execz LE_p
ds_add_rtn_u32 v176, v176, v17
v_cmpx_lt_i32 vcc, 193, v32
ds_add_rtn_u32 v177, v177, v17
v_cmpx_lt_i32 vcc, 194, v32
ds_add_rtn_u32 v178, v178, v17
v_cmpx_lt_i32 vcc, 195, v32
ds_add_rtn_u32 v179, v179, v17
v_cmpx_lt_i32 vcc, 208, v32
s_cbranch_execz LE_p
ds_add_rtn_u32 v180, v180, v17
v_cmpx_lt_i32 vcc, 209, v32
ds_add_rtn_u32 v181, v181, v17
v_cmpx_lt_i32 vcc, 210, v32
ds_add_rtn_u32 v182, v182, v17
v_cmpx_lt_i32 vcc, 211, v32
ds_add_rtn_u32 v183, v183, v17
v_cmpx_lt_i32 vcc, 224, v32
s_cbranch_execz LE_p
ds_add_rtn_u32 v184, v184, v17
v_cmpx_lt_i32 vcc, 225, v32
ds_add_rtn_u32 v185, v185, v17
v_cmpx_lt_i32 vcc, 226, v32
ds_add_rtn_u32 v186, v186, v17
v_cmpx_lt_i32 vcc, 227, v32
ds_add_rtn_u32 v187, v187, v17
v_cmpx_lt_i32 vcc, 240, v32
s_cbranch_execz LE_p
ds_add_rtn_u32 v188, v188, v17
v_cmpx_lt_i32 vcc, 241, v32
ds_add_rtn_u32 v189, v189, v17
v_cmpx_lt_i32 vcc, 242, v32
ds_add_rtn_u32 v190, v190, v17
v_cmpx_lt_i32 vcc, 243, v32
ds_add_rtn_u32 v191, v191, v17
LE_p:
s_mov_b64 exec, -1
v_lshl_add_u32 v33, v1, 2, v36
ds_read_b32 v37, v33 offset:20480
s_waitcnt lgkmcnt(0)
v_cmpx_lt_i32 vcc, 0, v32
s_cbranch_execz LE_w
ds_write_b32 v128, v192
v_cmpx_lt_i32 vcc, 1, v32
ds_write_b32 v129, v193
v_cmpx_lt_i32 vcc, 2, v32
ds_write_b32 v130, v194
v_cmpx_lt_i32 vcc, 3, v32
ds_write_b32 v131, v195
v_cmpx_lt_i32 vcc, 16, v32
s_cbranch_execz LE_w
ds_write_b32 v132, v196
v_cmpx_lt_i32 vcc, 17, v32
ds_write_b32 v133, v197
v_cmpx_lt_i32 vcc, 18, v32
ds_write_b32 v134, v198
v_cmpx_lt_i32 vcc, 19, v32
ds_write_b32 v135, v199
v_cmpx_lt_i32 vcc, 32, v32
s_cbranch_execz LE_w
ds_write_b32 v136, v200
v_cmpx_lt_i32 vcc, 33, v32
ds_write_b32 v137, v201
v_cmpx_lt_i32 vcc, 34, v32
ds_write_b32 v138, v202
v_cmpx_lt_i32 vcc, 35, v32
ds_write_b32 v139, v203
v_cmpx_lt_i32 vcc, 48, v32
s_cbranch_execz LE_w
ds_write_b32 v140, v204
v_cmpx_lt_i32 vcc, 49, v32
ds_write_b32 v141, v205
v_cmpx_lt_i32 vcc, 50, v32
ds_write_b32 v142, v206
v_cmpx_lt_i32 vcc, 51, v32
ds_write_b32 v143, v207
v_cmpx_lt_i32 vcc, 64, v32
s_cbranch_execz LE_w
ds_write_b32 v144, v208
v_cmpx_lt_i32 vcc, 65, v32
ds_write_b32 v145, v209
v_cmpx_lt_i32 vcc, 66, v32
ds_write_b32 v146, v210
v_cmpx_lt_i32 vcc, 67, v32
ds_write_b32 v147, v211
v_cmpx_lt_i32 vcc, 80, v32
s_cbranch_execz LE_w
ds_write_b32 v148, v212
v_cmpx_lt_i32 vcc, 81, v32
ds_write_b32 v149, v213
v_cmpx_lt_i32 vcc, 82, v32
ds_write_b32 v150, v214
v_cmpx_lt_i32 vcc, 83, v32
ds_write_b32 v151, v215
v_cmpx_lt_i32 vcc, 96, v32
s_cbranch_execz LE_w
ds_write_b32 v152, v216
v_cmpx_lt_i32 vcc, 97, v32
ds_write_b32 v153, v217
v_cmpx_lt_i32 vcc, 98, v32
ds_write_b32 v154, v218
v_cmpx_lt_i32 vcc, 99, v32
ds_write_b32 v155, v219
v_cmpx_lt_i32 vcc, 112, v32
s_cbranch_execz LE_w
ds_write_b32 v156, v220
v_cmpx_lt_i32 vcc, 113, v32
ds_write_b32 v157, v221
v_cmpx_lt_i32 vcc, 114, v32
ds_write_b32 v158, v222
v_cmpx_lt_i32 vcc, 115, v32
ds_write_b32 v159, v223
v_cmpx_lt_i32 vcc, 128, v32
s_cbranch_execz LE_w
ds_write_b32 v160, v224
v_cmpx_lt_i32 vcc, 129, v32
ds_write_b32 v161, v225
v_cmpx_lt_i32 vcc, 130, v32
ds_write_b32 v162, v226
v_cmpx_lt_i32 vcc, 131, v32
ds_write_b32 v163, v227
v_cmpx_lt_i32 vcc, 144, v32
s_cbranch_execz LE_w
ds_write_b32 v164, v228
v_cmpx_lt_i32 vcc, 145, v32
ds_write_b32 v165, v229
v_cmpx_lt_i32 vcc, 146, v32
ds_write_b32 v166, v230
v_cmpx_lt_i32 vcc, 147, v32
ds_write_b32 v167, v231
v_cmpx_lt_i32 vcc, 160, v32
s_cbranch_execz LE_w
ds_write_b32 v168, v232
v_cmpx_lt_i32 vcc, 161, v32
ds_write_b32 v169, v233
v_cmpx_lt_i32 vcc, 162, v32
ds_write_b32 v170, v234
v_cmpx_lt_i32 vcc, 163, v32
ds_write_b32 v171, v235
v_cmpx_lt_i32 vcc, 176, v32
s_cbranch_execz LE_w
ds_write_b32 v172, v236
v_cmpx_lt_i32 vcc, 177, v32
ds_write_b32 v173, v237
v_cmpx_lt_i32 vcc, 178, v32
ds_write_b32 v174, v238
v_cmpx_lt_i32 vcc, 179, v32
ds_write_b32 v175, v239
v_cmpx_lt_i32 vcc, 192, v32
s_cbranch_execz LE_w
ds_write_b32 v176, v240
v_cmpx_lt_i32 vcc, 193, v32
ds_write_b32 v177, v241
v_cmpx_lt_i32 vcc, 194, v32
ds_write_b32 v178, v242
v_cmpx_lt_i32 vcc, 195, v32
ds_write_b32 v179, v243
v_cmpx_lt_i32 vcc, 208, v32
s_cbranch_execz LE_w
ds_write_b32 v180, v244
v_cmpx_lt_i32 vcc, 209, v32
ds_write_b32 v181, v245
v_cmpx_lt_i32 vcc, 210, v32
ds_write_b32 v182, v246
v_cmpx_lt_i32 vcc, 211, v32
ds_write_b32 v183, v247
v_cmpx_lt_i32 vcc, 224, v32
s_cbranch_execz LE_w
ds_write_b32 v184, v248
v_cmpx_lt_i32 vcc, 225, v32
ds_write_b32 v185, v249
v_cmpx_lt_i32 vcc, 226, v32
ds_write_b32 v186, v250
v_cmpx_lt_i32 vcc, 227, v32
ds_write_b32 v187, v251
v_cmpx_lt_i32 vcc, 240, v32
s_cbranch_execz LE_w
ds_write_b32 v188, v252
v_cmpx_lt_i32 vcc, 241, v32
ds_write_b32 v189, v253
v_cmpx_lt_i32 vcc, 242, v32
ds_write_b32 v190, v254
v_cmpx_lt_i32 vcc, 243, v32
ds_write_b32 v191, v255
LE_w:
s_mov_b64 exec, -1
s_add_u32 s8, s4, 0x7c2a000
s_addc_u32 s9, s5, 0
s_mov_b32 s10, 0x8000
s_mov_b32 s11, 0x00020000
v_and_b32 v200, 63, v0
v_lshlrev_b32 v200, 7, v200
s_mov_b32 s91, 8192
s_mov_b32 s90, 16384
s_mov_b32 s95, 24576
s_mov_b32 s94, 0x10000
LE_poll:
buffer_load_dwordx2 v[192:193], v200, s[8:11], 0 offen sc1
buffer_load_dwordx2 v[194:195], v200, s[8:11], s91 offen sc1
buffer_load_dwordx2 v[196:197], v200, s[8:11], s90 offen sc1
buffer_load_dwordx2 v[198:199], v200, s[8:11], s95 offen sc1
s_sub_u32 s94, s94, 1
s_waitcnt vmcnt(0)
s_cbranch_scc1 LE_poll_go
v_cmp_ne_u64 vcc, s[98:99], v[192:193]
s_nop 1
s_cbranch_vccnz LE_poll
v_cmp_ne_u64 vcc, s[98:99], v[194:195]
s_nop 1
s_cbranch_vccnz LE_poll
v_cmp_ne_u64 vcc, s[98:99], v[196:197]
s_nop 1
s_cbranch_vccnz LE_poll
v_cmp_ne_u64 vcc, s[98:99], v[198:199]
s_nop 1
s_cbranch_vccnz LE_poll
LE_poll_go:
s_cmp_lg_u32 s40, 0
s_cbranch_scc1 LE_nobump
s_mov_b32 s90, 89984
s_mov_b32 s10, 90112
v_lshlrev_b32 v196, 4, v1
v_mov_b32 v192, s98
v_mov_b32 v193, s99
v_mov_b32 v194, s98
v_mov_b32 v195, s99
s_mov_b64 exec, 0xff
buffer_store_dwordx4 v[192:195], v196, s[8:11], s90 offen sc1
s_mov_b64 exec, -1
LE_nobump:
v_mov_b32 v34, v38
ds_read2_b32 v[52:53], v34 offset0:0 offset1:4
ds_read2_b32 v[54:55], v34 offset0:8 offset1:12
s_waitcnt lgkmcnt(0)
ds_read2_b32 v[56:57], v34 offset0:16 offset1:20
ds_read2_b32 v[58:59], v34 offset0:24 offset1:28
v_mad_u32_u16 v60, v52, s49, v2
v_mad_u32_u16 v61, v53, s49, v2
v_mad_u32_u16 v62, v54, s49, v2
v_mad_u32_u16 v63, v55, s49, v2
buffer_load_dwordx4 a[0:3], v60, s[16:19], 0 offen sc1
buffer_load_dwordx4 a[4:7], v60, s[16:19], 0 offen offset:256 sc1
buffer_load_dwordx4 a[8:11], v61, s[16:19], 0 offen sc1
buffer_load_dwordx4 a[12:15], v61, s[16:19], 0 offen offset:256 sc1
buffer_load_dwordx4 a[16:19], v62, s[16:19], 0 offen sc1
buffer_load_dwordx4 a[20:23], v62, s[16:19], 0 offen offset:256 sc1
buffer_load_dwordx4 a[24:27], v63, s[16:19], 0 offen sc1
buffer_load_dwordx4 a[28:31], v63, s[16:19], 0 offen offset:256 sc1
s_waitcnt lgkmcnt(0)
ds_read2_b32 v[52:53], v34 offset0:32 offset1:36
ds_read2_b32 v[54:55], v34 offset0:40 offset1:44
v_mad_u32_u16 v60, v56, s49, v2
v_mad_u32_u16 v61, v57, s49, v2
v_mad_u32_u16 v62, v58, s49, v2
v_mad_u32_u16 v63, v59, s49, v2
buffer_load_dwordx4 a[32:35], v60, s[16:19], 0 offen sc1
buffer_load_dwordx4 a[36:39], v60, s[16:19], 0 offen offset:256 sc1
buffer_load_dwordx4 a[40:43], v61, s[16:19], 0 offen sc1
buffer_load_dwordx4 a[44:47], v61, s[16:19], 0 offen offset:256 sc1
buffer_load_dwordx4 a[48:51], v62, s[16:19], 0 offen sc1
buffer_load_dwordx4 a[52:55], v62, s[16:19], 0 offen offset:256 sc1
buffer_load_dwordx4 a[56:59], v63, s[16:19], 0 offen sc1
buffer_load_dwordx4 a[60:63], v63, s[16:19], 0 offen offset:256 sc1
s_waitcnt lgkmcnt(0)
ds_read2_b32 v[56:57], v34 offset0:48 offset1:52
ds_read2_b32 v[58:59], v34 offset0:56 offset1:60
v_mad_u32_u16 v60, v52, s49, v2
v_mad_u32_u16 v61, v53, s49, v2
v_mad_u32_u16 v62, v54, s49, v2
v_mad_u32_u16 v63, v55, s49, v2
buffer_load_dwordx4 a[64:67], v60, s[16:19], 0 offen sc1
buffer_load_dwordx4 a[68:71], v60, s[16:19], 0 offen offset:256 sc1
buffer_load_dwordx4 a[72:75], v61, s[16:19], 0 offen sc1
buffer_load_dwordx4 a[76:79], v61, s[16:19], 0 offen offset:256 sc1
buffer_load_dwordx4 a[80:83], v62, s[16:19], 0 offen sc1
buffer_load_dwordx4 a[84:87], v62, s[16:19], 0 offen offset:256 sc1
buffer_load_dwordx4 a[88:91], v63, s[16:19], 0 offen sc1
buffer_load_dwordx4 a[92:95], v63, s[16:19], 0 offen offset:256 sc1
s_waitcnt lgkmcnt(0)
ds_read2_b32 v[52:53], v34 offset0:64 offset1:68
ds_read2_b32 v[54:55], v34 offset0:72 offset1:76
v_mad_u32_u16 v60, v56, s49, v2
v_mad_u32_u16 v61, v57, s49, v2
v_mad_u32_u16 v62, v58, s49, v2
v_mad_u32_u16 v63, v59, s49, v2
buffer_load_dwordx4 a[96:99], v60, s[16:19], 0 offen sc1
buffer_load_dwordx4 a[100:103], v60, s[16:19], 0 offen offset:256 sc1
buffer_load_dwordx4 a[104:107], v61, s[16:19], 0 offen sc1
buffer_load_dwordx4 a[108:111], v61, s[16:19], 0 offen offset:256 sc1
buffer_load_dwordx4 a[112:115], v62, s[16:19], 0 offen sc1
buffer_load_dwordx4 a[116:119], v62, s[16:19], 0 offen offset:256 sc1
buffer_load_dwordx4 a[120:123], v63, s[16:19], 0 offen sc1
buffer_load_dwordx4 a[124:127], v63, s[16:19], 0 offen offset:256 sc1
s_waitcnt lgkmcnt(0)
ds_read2_b32 v[56:57], v34 offset0:80 offset1:84
ds_read2_b32 v[58:59], v34 offset0:88 offset1:92
v_mad_u32_u16 v60, v52, s49, v2
v_mad_u32_u16 v61, v53, s49, v2
v_mad_u32_u16 v62, v54, s49, v2
v_mad_u32_u16 v63, v55, s49, v2
buffer_load_dwordx4 a[128:131], v60, s[16:19], 0 offen sc1
buffer_load_dwordx4 a[132:135], v60, s[16:19], 0 offen offset:256 sc1
buffer_load_dwordx4 a[136:139], v61, s[16:19], 0 offen sc1
buffer_load_dwordx4 a[140:143], v61, s[16:19], 0 offen offset:256 sc1
buffer_load_dwordx4 a[144:147], v62, s[16:19], 0 offen sc1
buffer_load_dwordx4 a[148:151], v62, s[16:19], 0 offen offset:256 sc1
buffer_load_dwordx4 a[152:155], v63, s[16:19], 0 offen sc1
buffer_load_dwordx4 a[156:159], v63, s[16:19], 0 offen offset:256 sc1
s_waitcnt lgkmcnt(0)
ds_read2_b32 v[52:53], v34 offset0:96 offset1:100
ds_read2_b32 v[54:55], v34 offset0:104 offset1:108
v_mad_u32_u16 v60, v56, s49, v2
v_mad_u32_u16 v61, v57, s49, v2
v_mad_u32_u16 v62, v58, s49, v2
v_mad_u32_u16 v63, v59, s49, v2
buffer_load_dwordx4 a[160:163], v60, s[16:19], 0 offen sc1
buffer_load_dwordx4 a[164:167], v60, s[16:19], 0 offen offset:256 sc1
buffer_load_dwordx4 a[168:171], v61, s[16:19], 0 offen sc1
buffer_load_dwordx4 a[172:175], v61, s[16:19], 0 offen offset:256 sc1
buffer_load_dwordx4 a[176:179], v62, s[16:19], 0 offen sc1
buffer_load_dwordx4 a[180:183], v62, s[16:19], 0 offen offset:256 sc1
buffer_load_dwordx4 a[184:187], v63, s[16:19], 0 offen sc1
buffer_load_dwordx4 a[188:191], v63, s[16:19], 0 offen offset:256 sc1
s_waitcnt lgkmcnt(0)
ds_read2_b32 v[56:57], v34 offset0:112 offset1:116
ds_read2_b32 v[58:59], v34 offset0:120 offset1:124
v_mad_u32_u16 v60, v52, s49, v2
v_mad_u32_u16 v61, v53, s49, v2
v_mad_u32_u16 v62, v54, s49, v2
v_mad_u32_u16 v63, v55, s49, v2
buffer_load_dwordx4 a[192:195], v60, s[16:19], 0 offen sc1
buffer_load_dwordx4 a[196:199], v60, s[16:19], 0 offen offset:256 sc1
buffer_load_dwordx4 a[200:203], v61, s[16:19], 0 offen sc1
buffer_load_dwordx4 a[204:207], v61, s[16:19], 0 offen offset:256 sc1
buffer_load_dwordx4 a[208:211], v62, s[16:19], 0 offen sc1
buffer_load_dwordx4 a[212:215], v62, s[16:19], 0 offen offset:256 sc1
buffer_load_dwordx4 a[216:219], v63, s[16:19], 0 offen sc1
buffer_load_dwordx4 a[220:223], v63, s[16:19], 0 offen offset:256 sc1
s_waitcnt lgkmcnt(0)
ds_read2_b32 v[52:53], v34 offset0:128 offset1:132
ds_read2_b32 v[54:55], v34 offset0:136 offset1:140
v_mad_u32_u16 v60, v56, s49, v2
v_mad_u32_u16 v61, v57, s49, v2
v_mad_u32_u16 v62, v58, s49, v2
v_mad_u32_u16 v63, v59, s49, v2
buffer_load_dwordx4 a[224:227], v60, s[16:19], 0 offen sc1
buffer_load_dwordx4 a[228:231], v60, s[16:19], 0 offen offset:256 sc1
buffer_load_dwordx4 a[232:235], v61, s[16:19], 0 offen sc1
buffer_load_dwordx4 a[236:239], v61, s[16:19], 0 offen offset:256 sc1
buffer_load_dwordx4 a[240:243], v62, s[16:19], 0 offen sc1
buffer_load_dwordx4 a[244:247], v62, s[16:19], 0 offen offset:256 sc1
buffer_load_dwordx4 a[248:251], v63, s[16:19], 0 offen sc1
buffer_load_dwordx4 a[252:255], v63, s[16:19], 0 offen offset:256 sc1
v_add_u32 v34, 512, v34
s_mov_b32 s45, 0
s_lshl_b32 s47, s55, 9
LE_loop:
v_readlane_b32 s46, v37, s45
s_add_u32 s45, s45, 1
s_waitcnt vmcnt(56)
v_mfma_f32_16x16x32_bf16 v[48:51], a[0:3], v[40:43], v[48:51]
v_mfma_f32_16x16x32_bf16 v[48:51], a[4:7], v[44:47], v[48:51]
s_bitcmp1_b32 s46, 0
s_cbranch_scc0 LE_nf0
s_cmp_eq_u32 s42, 0
s_cbranch_scc1 LE_fl0
buffer_load_dwordx2 v[66:67], v39, s[20:23], s47 offen sc1
s_waitcnt vmcnt(0)
v_lshlrev_b32 v64, 16, v66
v_and_b32 v65, 0xffff0000, v66
v_add_f32 v48, v48, v64
v_add_f32 v49, v49, v65
v_lshlrev_b32 v64, 16, v67
v_and_b32 v65, 0xffff0000, v67
v_add_f32 v50, v50, v64
v_add_f32 v51, v51, v65
LE_fl0:
s_nop 3
v_cvt_pk_bf16_f32 v64, v48, v49
v_cvt_pk_bf16_f32 v65, v50, v51
v_mov_b32 v48, 0
v_mov_b32 v49, 0
v_mov_b32 v50, 0
v_mov_b32 v51, 0
buffer_store_dwordx2 v[64:65], v39, s[20:23], s47 offen sc1
s_add_u32 s47, s47, 512
LE_nf0:
v_mfma_f32_16x16x32_bf16 v[48:51], a[8:11], v[40:43], v[48:51]
v_mfma_f32_16x16x32_bf16 v[48:51], a[12:15], v[44:47], v[48:51]
s_bitcmp1_b32 s46, 1
s_cbranch_scc0 LE_nf1
s_cmp_eq_u32 s42, 0
s_cbranch_scc1 LE_fl1
buffer_load_dwordx2 v[66:67], v39, s[20:23], s47 offen sc1
s_waitcnt vmcnt(0)
v_lshlrev_b32 v64, 16, v66
v_and_b32 v65, 0xffff0000, v66
v_add_f32 v48, v48, v64
v_add_f32 v49, v49, v65
v_lshlrev_b32 v64, 16, v67
v_and_b32 v65, 0xffff0000, v67
v_add_f32 v50, v50, v64
v_add_f32 v51, v51, v65
LE_fl1:
s_nop 3
v_cvt_pk_bf16_f32 v64, v48, v49
v_cvt_pk_bf16_f32 v65, v50, v51
v_mov_b32 v48, 0
v_mov_b32 v49, 0
v_mov_b32 v50, 0
v_mov_b32 v51, 0
buffer_store_dwordx2 v[64:65], v39, s[20:23], s47 offen sc1
s_add_u32 s47, s47, 512
LE_nf1:
v_mfma_f32_16x16x32_bf16 v[48:51], a[16:19], v[40:43], v[48:51]
v_mfma_f32_16x16x32_bf16 v[48:51], a[20:23], v[44:47], v[48:51]
s_bitcmp1_b32 s46, 2
s_cbranch_scc0 LE_nf2
s_cmp_eq_u32 s42, 0
s_cbranch_scc1 LE_fl2
buffer_load_dwordx2 v[66:67], v39, s[20:23], s47 offen sc1
s_waitcnt vmcnt(0)
v_lshlrev_b32 v64, 16, v66
v_and_b32 v65, 0xffff0000, v66
v_add_f32 v48, v48, v64
v_add_f32 v49, v49, v65
v_lshlrev_b32 v64, 16, v67
v_and_b32 v65, 0xffff0000, v67
v_add_f32 v50, v50, v64
v_add_f32 v51, v51, v65
LE_fl2:
s_nop 3
v_cvt_pk_bf16_f32 v64, v48, v49
v_cvt_pk_bf16_f32 v65, v50, v51
v_mov_b32 v48, 0
v_mov_b32 v49, 0
v_mov_b32 v50, 0
v_mov_b32 v51, 0
buffer_store_dwordx2 v[64:65], v39, s[20:23], s47 offen sc1
s_add_u32 s47, s47, 512
LE_nf2:
v_mfma_f32_16x16x32_bf16 v[48:51], a[24:27], v[40:43], v[48:51]
v_mfma_f32_16x16x32_bf16 v[48:51], a[28:31], v[44:47], v[48:51]
s_bitcmp1_b32 s46, 3
s_cbranch_scc0 LE_nf3
s_cmp_eq_u32 s42, 0
s_cbranch_scc1 LE_fl3
buffer_load_dwordx2 v[66:67], v39, s[20:23], s47 offen sc1
s_waitcnt vmcnt(0)
v_lshlrev_b32 v64, 16, v66
v_and_b32 v65, 0xffff0000, v66
v_add_f32 v48, v48, v64
v_add_f32 v49, v49, v65
v_lshlrev_b32 v64, 16, v67
v_and_b32 v65, 0xffff0000, v67
v_add_f32 v50, v50, v64
v_add_f32 v51, v51, v65
LE_fl3:
s_nop 3
v_cvt_pk_bf16_f32 v64, v48, v49
v_cvt_pk_bf16_f32 v65, v50, v51
v_mov_b32 v48, 0
v_mov_b32 v49, 0
v_mov_b32 v50, 0
v_mov_b32 v51, 0
buffer_store_dwordx2 v[64:65], v39, s[20:23], s47 offen sc1
s_add_u32 s47, s47, 512
LE_nf3:
s_waitcnt lgkmcnt(0)
ds_read2_b32 v[56:57], v34 offset0:16 offset1:20
ds_read2_b32 v[58:59], v34 offset0:24 offset1:28
v_mad_u32_u16 v60, v52, s49, v2
v_mad_u32_u16 v61, v53, s49, v2
v_mad_u32_u16 v62, v54, s49, v2
v_mad_u32_u16 v63, v55, s49, v2
buffer_load_dwordx4 a[0:3], v60, s[16:19], 0 offen sc1
buffer_load_dwordx4 a[4:7], v60, s[16:19], 0 offen offset:256 sc1
buffer_load_dwordx4 a[8:11], v61, s[16:19], 0 offen sc1
buffer_load_dwordx4 a[12:15], v61, s[16:19], 0 offen offset:256 sc1
buffer_load_dwordx4 a[16:19], v62, s[16:19], 0 offen sc1
buffer_load_dwordx4 a[20:23], v62, s[16:19], 0 offen offset:256 sc1
buffer_load_dwordx4 a[24:27], v63, s[16:19], 0 offen sc1
buffer_load_dwordx4 a[28:31], v63, s[16:19], 0 offen offset:256 sc1
s_waitcnt vmcnt(56)
v_mfma_f32_16x16x32_bf16 v[48:51], a[32:35], v[40:43], v[48:51]
v_mfma_f32_16x16x32_bf16 v[48:51], a[36:39], v[44:47], v[48:51]
s_bitcmp1_b32 s46, 4
s_cbranch_scc0 LE_nf4
s_cmp_eq_u32 s42, 0
s_cbranch_scc1 LE_fl4
buffer_load_dwordx2 v[66:67], v39, s[20:23], s47 offen sc1
s_waitcnt vmcnt(0)
v_lshlrev_b32 v64, 16, v66
v_and_b32 v65, 0xffff0000, v66
v_add_f32 v48, v48, v64
v_add_f32 v49, v49, v65
v_lshlrev_b32 v64, 16, v67
v_and_b32 v65, 0xffff0000, v67
v_add_f32 v50, v50, v64
v_add_f32 v51, v51, v65
LE_fl4:
s_nop 3
v_cvt_pk_bf16_f32 v64, v48, v49
v_cvt_pk_bf16_f32 v65, v50, v51
v_mov_b32 v48, 0
v_mov_b32 v49, 0
v_mov_b32 v50, 0
v_mov_b32 v51, 0
buffer_store_dwordx2 v[64:65], v39, s[20:23], s47 offen sc1
s_add_u32 s47, s47, 512
LE_nf4:
v_mfma_f32_16x16x32_bf16 v[48:51], a[40:43], v[40:43], v[48:51]
v_mfma_f32_16x16x32_bf16 v[48:51], a[44:47], v[44:47], v[48:51]
s_bitcmp1_b32 s46, 5
s_cbranch_scc0 LE_nf5
s_cmp_eq_u32 s42, 0
s_cbranch_scc1 LE_fl5
buffer_load_dwordx2 v[66:67], v39, s[20:23], s47 offen sc1
s_waitcnt vmcnt(0)
v_lshlrev_b32 v64, 16, v66
v_and_b32 v65, 0xffff0000, v66
v_add_f32 v48, v48, v64
v_add_f32 v49, v49, v65
v_lshlrev_b32 v64, 16, v67
v_and_b32 v65, 0xffff0000, v67
v_add_f32 v50, v50, v64
v_add_f32 v51, v51, v65
LE_fl5:
s_nop 3
v_cvt_pk_bf16_f32 v64, v48, v49
v_cvt_pk_bf16_f32 v65, v50, v51
v_mov_b32 v48, 0
v_mov_b32 v49, 0
v_mov_b32 v50, 0
v_mov_b32 v51, 0
buffer_store_dwordx2 v[64:65], v39, s[20:23], s47 offen sc1
s_add_u32 s47, s47, 512
LE_nf5:
v_mfma_f32_16x16x32_bf16 v[48:51], a[48:51], v[40:43], v[48:51]
v_mfma_f32_16x16x32_bf16 v[48:51], a[52:55], v[44:47], v[48:51]
s_bitcmp1_b32 s46, 6
s_cbranch_scc0 LE_nf6
s_cmp_eq_u32 s42, 0
s_cbranch_scc1 LE_fl6
buffer_load_dwordx2 v[66:67], v39, s[20:23], s47 offen sc1
s_waitcnt vmcnt(0)
v_lshlrev_b32 v64, 16, v66
v_and_b32 v65, 0xffff0000, v66
v_add_f32 v48, v48, v64
v_add_f32 v49, v49, v65
v_lshlrev_b32 v64, 16, v67
v_and_b32 v65, 0xffff0000, v67
v_add_f32 v50, v50, v64
v_add_f32 v51, v51, v65
LE_fl6:
s_nop 3
v_cvt_pk_bf16_f32 v64, v48, v49
v_cvt_pk_bf16_f32 v65, v50, v51
v_mov_b32 v48, 0
v_mov_b32 v49, 0
v_mov_b32 v50, 0
v_mov_b32 v51, 0
buffer_store_dwordx2 v[64:65], v39, s[20:23], s47 offen sc1
s_add_u32 s47, s47, 512
LE_nf6:
v_mfma_f32_16x16x32_bf16 v[48:51], a[56:59], v[40:43], v[48:51]
v_mfma_f32_16x16x32_bf16 v[48:51], a[60:63], v[44:47], v[48:51]
s_bitcmp1_b32 s46, 7
s_cbranch_scc0 LE_nf7
s_cmp_eq_u32 s42, 0
s_cbranch_scc1 LE_fl7
buffer_load_dwordx2 v[66:67], v39, s[20:23], s47 offen sc1
s_waitcnt vmcnt(0)
v_lshlrev_b32 v64, 16, v66
v_and_b32 v65, 0xffff0000, v66
v_add_f32 v48, v48, v64
v_add_f32 v49, v49, v65
v_lshlrev_b32 v64, 16, v67
v_and_b32 v65, 0xffff0000, v67
v_add_f32 v50, v50, v64
v_add_f32 v51, v51, v65
LE_fl7:
s_nop 3
v_cvt_pk_bf16_f32 v64, v48, v49
v_cvt_pk_bf16_f32 v65, v50, v51
v_mov_b32 v48, 0
v_mov_b32 v49, 0
v_mov_b32 v50, 0
v_mov_b32 v51, 0
buffer_store_dwordx2 v[64:65], v39, s[20:23], s47 offen sc1
s_add_u32 s47, s47, 512
LE_nf7:
s_waitcnt lgkmcnt(0)
ds_read2_b32 v[52:53], v34 offset0:32 offset1:36
ds_read2_b32 v[54:55], v34 offset0:40 offset1:44
v_mad_u32_u16 v60, v56, s49, v2
v_mad_u32_u16 v61, v57, s49, v2
v_mad_u32_u16 v62, v58, s49, v2
v_mad_u32_u16 v63, v59, s49, v2
buffer_load_dwordx4 a[32:35], v60, s[16:19], 0 offen sc1
buffer_load_dwordx4 a[36:39], v60, s[16:19], 0 offen offset:256 sc1
buffer_load_dwordx4 a[40:43], v61, s[16:19], 0 offen sc1
buffer_load_dwordx4 a[44:47], v61, s[16:19], 0 offen offset:256 sc1
buffer_load_dwordx4 a[48:51], v62, s[16:19], 0 offen sc1
buffer_load_dwordx4 a[52:55], v62, s[16:19], 0 offen offset:256 sc1
buffer_load_dwordx4 a[56:59], v63, s[16:19], 0 offen sc1
buffer_load_dwordx4 a[60:63], v63, s[16:19], 0 offen offset:256 sc1
s_waitcnt vmcnt(56)
v_mfma_f32_16x16x32_bf16 v[48:51], a[64:67], v[40:43], v[48:51]
v_mfma_f32_16x16x32_bf16 v[48:51], a[68:71], v[44:47], v[48:51]
s_bitcmp1_b32 s46, 8
s_cbranch_scc0 LE_nf8
s_cmp_eq_u32 s42, 0
s_cbranch_scc1 LE_fl8
buffer_load_dwordx2 v[66:67], v39, s[20:23], s47 offen sc1
s_waitcnt vmcnt(0)
v_lshlrev_b32 v64, 16, v66
v_and_b32 v65, 0xffff0000, v66
v_add_f32 v48, v48, v64
v_add_f32 v49, v49, v65
v_lshlrev_b32 v64, 16, v67
v_and_b32 v65, 0xffff0000, v67
v_add_f32 v50, v50, v64
v_add_f32 v51, v51, v65
LE_fl8:
s_nop 3
v_cvt_pk_bf16_f32 v64, v48, v49
v_cvt_pk_bf16_f32 v65, v50, v51
v_mov_b32 v48, 0
v_mov_b32 v49, 0
v_mov_b32 v50, 0
v_mov_b32 v51, 0
buffer_store_dwordx2 v[64:65], v39, s[20:23], s47 offen sc1
s_add_u32 s47, s47, 512
LE_nf8:
v_mfma_f32_16x16x32_bf16 v[48:51], a[72:75], v[40:43], v[48:51]
v_mfma_f32_16x16x32_bf16 v[48:51], a[76:79], v[44:47], v[48:51]
s_bitcmp1_b32 s46, 9
s_cbranch_scc0 LE_nf9
s_cmp_eq_u32 s42, 0
s_cbranch_scc1 LE_fl9
buffer_load_dwordx2 v[66:67], v39, s[20:23], s47 offen sc1
s_waitcnt vmcnt(0)
v_lshlrev_b32 v64, 16, v66
v_and_b32 v65, 0xffff0000, v66
v_add_f32 v48, v48, v64
v_add_f32 v49, v49, v65
v_lshlrev_b32 v64, 16, v67
v_and_b32 v65, 0xffff0000, v67
v_add_f32 v50, v50, v64
v_add_f32 v51, v51, v65
LE_fl9:
s_nop 3
v_cvt_pk_bf16_f32 v64, v48, v49
v_cvt_pk_bf16_f32 v65, v50, v51
v_mov_b32 v48, 0
v_mov_b32 v49, 0
v_mov_b32 v50, 0
v_mov_b32 v51, 0
buffer_store_dwordx2 v[64:65], v39, s[20:23], s47 offen sc1
s_add_u32 s47, s47, 512
LE_nf9:
v_mfma_f32_16x16x32_bf16 v[48:51], a[80:83], v[40:43], v[48:51]
v_mfma_f32_16x16x32_bf16 v[48:51], a[84:87], v[44:47], v[48:51]
s_bitcmp1_b32 s46, 10
s_cbranch_scc0 LE_nf10
s_cmp_eq_u32 s42, 0
s_cbranch_scc1 LE_fl10
buffer_load_dwordx2 v[66:67], v39, s[20:23], s47 offen sc1
s_waitcnt vmcnt(0)
v_lshlrev_b32 v64, 16, v66
v_and_b32 v65, 0xffff0000, v66
v_add_f32 v48, v48, v64
v_add_f32 v49, v49, v65
v_lshlrev_b32 v64, 16, v67
v_and_b32 v65, 0xffff0000, v67
v_add_f32 v50, v50, v64
v_add_f32 v51, v51, v65
LE_fl10:
s_nop 3
v_cvt_pk_bf16_f32 v64, v48, v49
v_cvt_pk_bf16_f32 v65, v50, v51
v_mov_b32 v48, 0
v_mov_b32 v49, 0
v_mov_b32 v50, 0
v_mov_b32 v51, 0
buffer_store_dwordx2 v[64:65], v39, s[20:23], s47 offen sc1
s_add_u32 s47, s47, 512
LE_nf10:
v_mfma_f32_16x16x32_bf16 v[48:51], a[88:91], v[40:43], v[48:51]
v_mfma_f32_16x16x32_bf16 v[48:51], a[92:95], v[44:47], v[48:51]
s_bitcmp1_b32 s46, 11
s_cbranch_scc0 LE_nf11
s_cmp_eq_u32 s42, 0
s_cbranch_scc1 LE_fl11
buffer_load_dwordx2 v[66:67], v39, s[20:23], s47 offen sc1
s_waitcnt vmcnt(0)
v_lshlrev_b32 v64, 16, v66
v_and_b32 v65, 0xffff0000, v66
v_add_f32 v48, v48, v64
v_add_f32 v49, v49, v65
v_lshlrev_b32 v64, 16, v67
v_and_b32 v65, 0xffff0000, v67
v_add_f32 v50, v50, v64
v_add_f32 v51, v51, v65
LE_fl11:
s_nop 3
v_cvt_pk_bf16_f32 v64, v48, v49
v_cvt_pk_bf16_f32 v65, v50, v51
v_mov_b32 v48, 0
v_mov_b32 v49, 0
v_mov_b32 v50, 0
v_mov_b32 v51, 0
buffer_store_dwordx2 v[64:65], v39, s[20:23], s47 offen sc1
s_add_u32 s47, s47, 512
LE_nf11:
s_waitcnt lgkmcnt(0)
ds_read2_b32 v[56:57], v34 offset0:48 offset1:52
ds_read2_b32 v[58:59], v34 offset0:56 offset1:60
v_mad_u32_u16 v60, v52, s49, v2
v_mad_u32_u16 v61, v53, s49, v2
v_mad_u32_u16 v62, v54, s49, v2
v_mad_u32_u16 v63, v55, s49, v2
buffer_load_dwordx4 a[64:67], v60, s[16:19], 0 offen sc1
buffer_load_dwordx4 a[68:71], v60, s[16:19], 0 offen offset:256 sc1
buffer_load_dwordx4 a[72:75], v61, s[16:19], 0 offen sc1
buffer_load_dwordx4 a[76:79], v61, s[16:19], 0 offen offset:256 sc1
buffer_load_dwordx4 a[80:83], v62, s[16:19], 0 offen sc1
buffer_load_dwordx4 a[84:87], v62, s[16:19], 0 offen offset:256 sc1
buffer_load_dwordx4 a[88:91], v63, s[16:19], 0 offen sc1
buffer_load_dwordx4 a[92:95], v63, s[16:19], 0 offen offset:256 sc1
s_waitcnt vmcnt(56)
v_mfma_f32_16x16x32_bf16 v[48:51], a[96:99], v[40:43], v[48:51]
v_mfma_f32_16x16x32_bf16 v[48:51], a[100:103], v[44:47], v[48:51]
s_bitcmp1_b32 s46, 12
s_cbranch_scc0 LE_nf12
s_cmp_eq_u32 s42, 0
s_cbranch_scc1 LE_fl12
buffer_load_dwordx2 v[66:67], v39, s[20:23], s47 offen sc1
s_waitcnt vmcnt(0)
v_lshlrev_b32 v64, 16, v66
v_and_b32 v65, 0xffff0000, v66
v_add_f32 v48, v48, v64
v_add_f32 v49, v49, v65
v_lshlrev_b32 v64, 16, v67
v_and_b32 v65, 0xffff0000, v67
v_add_f32 v50, v50, v64
v_add_f32 v51, v51, v65
LE_fl12:
s_nop 3
v_cvt_pk_bf16_f32 v64, v48, v49
v_cvt_pk_bf16_f32 v65, v50, v51
v_mov_b32 v48, 0
v_mov_b32 v49, 0
v_mov_b32 v50, 0
v_mov_b32 v51, 0
buffer_store_dwordx2 v[64:65], v39, s[20:23], s47 offen sc1
s_add_u32 s47, s47, 512
LE_nf12:
v_mfma_f32_16x16x32_bf16 v[48:51], a[104:107], v[40:43], v[48:51]
v_mfma_f32_16x16x32_bf16 v[48:51], a[108:111], v[44:47], v[48:51]
s_bitcmp1_b32 s46, 13
s_cbranch_scc0 LE_nf13
s_cmp_eq_u32 s42, 0
s_cbranch_scc1 LE_fl13
buffer_load_dwordx2 v[66:67], v39, s[20:23], s47 offen sc1
s_waitcnt vmcnt(0)
v_lshlrev_b32 v64, 16, v66
v_and_b32 v65, 0xffff0000, v66
v_add_f32 v48, v48, v64
v_add_f32 v49, v49, v65
v_lshlrev_b32 v64, 16, v67
v_and_b32 v65, 0xffff0000, v67
v_add_f32 v50, v50, v64
v_add_f32 v51, v51, v65
LE_fl13:
s_nop 3
v_cvt_pk_bf16_f32 v64, v48, v49
v_cvt_pk_bf16_f32 v65, v50, v51
v_mov_b32 v48, 0
v_mov_b32 v49, 0
v_mov_b32 v50, 0
v_mov_b32 v51, 0
buffer_store_dwordx2 v[64:65], v39, s[20:23], s47 offen sc1
s_add_u32 s47, s47, 512
LE_nf13:
v_mfma_f32_16x16x32_bf16 v[48:51], a[112:115], v[40:43], v[48:51]
v_mfma_f32_16x16x32_bf16 v[48:51], a[116:119], v[44:47], v[48:51]
s_bitcmp1_b32 s46, 14
s_cbranch_scc0 LE_nf14
s_cmp_eq_u32 s42, 0
s_cbranch_scc1 LE_fl14
buffer_load_dwordx2 v[66:67], v39, s[20:23], s47 offen sc1
s_waitcnt vmcnt(0)
v_lshlrev_b32 v64, 16, v66
v_and_b32 v65, 0xffff0000, v66
v_add_f32 v48, v48, v64
v_add_f32 v49, v49, v65
v_lshlrev_b32 v64, 16, v67
v_and_b32 v65, 0xffff0000, v67
v_add_f32 v50, v50, v64
v_add_f32 v51, v51, v65
LE_fl14:
s_nop 3
v_cvt_pk_bf16_f32 v64, v48, v49
v_cvt_pk_bf16_f32 v65, v50, v51
v_mov_b32 v48, 0
v_mov_b32 v49, 0
v_mov_b32 v50, 0
v_mov_b32 v51, 0
buffer_store_dwordx2 v[64:65], v39, s[20:23], s47 offen sc1
s_add_u32 s47, s47, 512
LE_nf14:
v_mfma_f32_16x16x32_bf16 v[48:51], a[120:123], v[40:43], v[48:51]
v_mfma_f32_16x16x32_bf16 v[48:51], a[124:127], v[44:47], v[48:51]
s_bitcmp1_b32 s46, 15
s_cbranch_scc0 LE_nf15
s_cmp_eq_u32 s42, 0
s_cbranch_scc1 LE_fl15
buffer_load_dwordx2 v[66:67], v39, s[20:23], s47 offen sc1
s_waitcnt vmcnt(0)
v_lshlrev_b32 v64, 16, v66
v_and_b32 v65, 0xffff0000, v66
v_add_f32 v48, v48, v64
v_add_f32 v49, v49, v65
v_lshlrev_b32 v64, 16, v67
v_and_b32 v65, 0xffff0000, v67
v_add_f32 v50, v50, v64
v_add_f32 v51, v51, v65
LE_fl15:
s_nop 3
v_cvt_pk_bf16_f32 v64, v48, v49
v_cvt_pk_bf16_f32 v65, v50, v51
v_mov_b32 v48, 0
v_mov_b32 v49, 0
v_mov_b32 v50, 0
v_mov_b32 v51, 0
buffer_store_dwordx2 v[64:65], v39, s[20:23], s47 offen sc1
s_add_u32 s47, s47, 512
LE_nf15:
s_waitcnt lgkmcnt(0)
ds_read2_b32 v[52:53], v34 offset0:64 offset1:68
ds_read2_b32 v[54:55], v34 offset0:72 offset1:76
v_mad_u32_u16 v60, v56, s49, v2
v_mad_u32_u16 v61, v57, s49, v2
v_mad_u32_u16 v62, v58, s49, v2
v_mad_u32_u16 v63, v59, s49, v2
buffer_load_dwordx4 a[96:99], v60, s[16:19], 0 offen sc1
buffer_load_dwordx4 a[100:103], v60, s[16:19], 0 offen offset:256 sc1
buffer_load_dwordx4 a[104:107], v61, s[16:19], 0 offen sc1
buffer_load_dwordx4 a[108:111], v61, s[16:19], 0 offen offset:256 sc1
buffer_load_dwordx4 a[112:115], v62, s[16:19], 0 offen sc1
buffer_load_dwordx4 a[116:119], v62, s[16:19], 0 offen offset:256 sc1
buffer_load_dwordx4 a[120:123], v63, s[16:19], 0 offen sc1
buffer_load_dwordx4 a[124:127], v63, s[16:19], 0 offen offset:256 sc1
s_waitcnt vmcnt(56)
v_mfma_f32_16x16x32_bf16 v[48:51], a[128:131], v[40:43], v[48:51]
v_mfma_f32_16x16x32_bf16 v[48:51], a[132:135], v[44:47], v[48:51]
s_bitcmp1_b32 s46, 16
s_cbranch_scc0 LE_nf16
s_cmp_eq_u32 s42, 0
s_cbranch_scc1 LE_fl16
buffer_load_dwordx2 v[66:67], v39, s[20:23], s47 offen sc1
s_waitcnt vmcnt(0)
v_lshlrev_b32 v64, 16, v66
v_and_b32 v65, 0xffff0000, v66
v_add_f32 v48, v48, v64
v_add_f32 v49, v49, v65
v_lshlrev_b32 v64, 16, v67
v_and_b32 v65, 0xffff0000, v67
v_add_f32 v50, v50, v64
v_add_f32 v51, v51, v65
LE_fl16:
s_nop 3
v_cvt_pk_bf16_f32 v64, v48, v49
v_cvt_pk_bf16_f32 v65, v50, v51
v_mov_b32 v48, 0
v_mov_b32 v49, 0
v_mov_b32 v50, 0
v_mov_b32 v51, 0
buffer_store_dwordx2 v[64:65], v39, s[20:23], s47 offen sc1
s_add_u32 s47, s47, 512
LE_nf16:
v_mfma_f32_16x16x32_bf16 v[48:51], a[136:139], v[40:43], v[48:51]
v_mfma_f32_16x16x32_bf16 v[48:51], a[140:143], v[44:47], v[48:51]
s_bitcmp1_b32 s46, 17
s_cbranch_scc0 LE_nf17
s_cmp_eq_u32 s42, 0
s_cbranch_scc1 LE_fl17
buffer_load_dwordx2 v[66:67], v39, s[20:23], s47 offen sc1
s_waitcnt vmcnt(0)
v_lshlrev_b32 v64, 16, v66
v_and_b32 v65, 0xffff0000, v66
v_add_f32 v48, v48, v64
v_add_f32 v49, v49, v65
v_lshlrev_b32 v64, 16, v67
v_and_b32 v65, 0xffff0000, v67
v_add_f32 v50, v50, v64
v_add_f32 v51, v51, v65
LE_fl17:
s_nop 3
v_cvt_pk_bf16_f32 v64, v48, v49
v_cvt_pk_bf16_f32 v65, v50, v51
v_mov_b32 v48, 0
v_mov_b32 v49, 0
v_mov_b32 v50, 0
v_mov_b32 v51, 0
buffer_store_dwordx2 v[64:65], v39, s[20:23], s47 offen sc1
s_add_u32 s47, s47, 512
LE_nf17:
v_mfma_f32_16x16x32_bf16 v[48:51], a[144:147], v[40:43], v[48:51]
v_mfma_f32_16x16x32_bf16 v[48:51], a[148:151], v[44:47], v[48:51]
s_bitcmp1_b32 s46, 18
s_cbranch_scc0 LE_nf18
s_cmp_eq_u32 s42, 0
s_cbranch_scc1 LE_fl18
buffer_load_dwordx2 v[66:67], v39, s[20:23], s47 offen sc1
s_waitcnt vmcnt(0)
v_lshlrev_b32 v64, 16, v66
v_and_b32 v65, 0xffff0000, v66
v_add_f32 v48, v48, v64
v_add_f32 v49, v49, v65
v_lshlrev_b32 v64, 16, v67
v_and_b32 v65, 0xffff0000, v67
v_add_f32 v50, v50, v64
v_add_f32 v51, v51, v65
LE_fl18:
s_nop 3
v_cvt_pk_bf16_f32 v64, v48, v49
v_cvt_pk_bf16_f32 v65, v50, v51
v_mov_b32 v48, 0
v_mov_b32 v49, 0
v_mov_b32 v50, 0
v_mov_b32 v51, 0
buffer_store_dwordx2 v[64:65], v39, s[20:23], s47 offen sc1
s_add_u32 s47, s47, 512
LE_nf18:
v_mfma_f32_16x16x32_bf16 v[48:51], a[152:155], v[40:43], v[48:51]
v_mfma_f32_16x16x32_bf16 v[48:51], a[156:159], v[44:47], v[48:51]
s_bitcmp1_b32 s46, 19
s_cbranch_scc0 LE_nf19
s_cmp_eq_u32 s42, 0
s_cbranch_scc1 LE_fl19
buffer_load_dwordx2 v[66:67], v39, s[20:23], s47 offen sc1
s_waitcnt vmcnt(0)
v_lshlrev_b32 v64, 16, v66
v_and_b32 v65, 0xffff0000, v66
v_add_f32 v48, v48, v64
v_add_f32 v49, v49, v65
v_lshlrev_b32 v64, 16, v67
v_and_b32 v65, 0xffff0000, v67
v_add_f32 v50, v50, v64
v_add_f32 v51, v51, v65
LE_fl19:
s_nop 3
v_cvt_pk_bf16_f32 v64, v48, v49
v_cvt_pk_bf16_f32 v65, v50, v51
v_mov_b32 v48, 0
v_mov_b32 v49, 0
v_mov_b32 v50, 0
v_mov_b32 v51, 0
buffer_store_dwordx2 v[64:65], v39, s[20:23], s47 offen sc1
s_add_u32 s47, s47, 512
LE_nf19:
s_waitcnt lgkmcnt(0)
ds_read2_b32 v[56:57], v34 offset0:80 offset1:84
ds_read2_b32 v[58:59], v34 offset0:88 offset1:92
v_mad_u32_u16 v60, v52, s49, v2
v_mad_u32_u16 v61, v53, s49, v2
v_mad_u32_u16 v62, v54, s49, v2
v_mad_u32_u16 v63, v55, s49, v2
buffer_load_dwordx4 a[128:131], v60, s[16:19], 0 offen sc1
buffer_load_dwordx4 a[132:135], v60, s[16:19], 0 offen offset:256 sc1
buffer_load_dwordx4 a[136:139], v61, s[16:19], 0 offen sc1
buffer_load_dwordx4 a[140:143], v61, s[16:19], 0 offen offset:256 sc1
buffer_load_dwordx4 a[144:147], v62, s[16:19], 0 offen sc1
buffer_load_dwordx4 a[148:151], v62, s[16:19], 0 offen offset:256 sc1
buffer_load_dwordx4 a[152:155], v63, s[16:19], 0 offen sc1
buffer_load_dwordx4 a[156:159], v63, s[16:19], 0 offen offset:256 sc1
s_waitcnt vmcnt(56)
v_mfma_f32_16x16x32_bf16 v[48:51], a[160:163], v[40:43], v[48:51]
v_mfma_f32_16x16x32_bf16 v[48:51], a[164:167], v[44:47], v[48:51]
s_bitcmp1_b32 s46, 20
s_cbranch_scc0 LE_nf20
s_cmp_eq_u32 s42, 0
s_cbranch_scc1 LE_fl20
buffer_load_dwordx2 v[66:67], v39, s[20:23], s47 offen sc1
s_waitcnt vmcnt(0)
v_lshlrev_b32 v64, 16, v66
v_and_b32 v65, 0xffff0000, v66
v_add_f32 v48, v48, v64
v_add_f32 v49, v49, v65
v_lshlrev_b32 v64, 16, v67
v_and_b32 v65, 0xffff0000, v67
v_add_f32 v50, v50, v64
v_add_f32 v51, v51, v65
LE_fl20:
s_nop 3
v_cvt_pk_bf16_f32 v64, v48, v49
v_cvt_pk_bf16_f32 v65, v50, v51
v_mov_b32 v48, 0
v_mov_b32 v49, 0
v_mov_b32 v50, 0
v_mov_b32 v51, 0
buffer_store_dwordx2 v[64:65], v39, s[20:23], s47 offen sc1
s_add_u32 s47, s47, 512
LE_nf20:
v_mfma_f32_16x16x32_bf16 v[48:51], a[168:171], v[40:43], v[48:51]
v_mfma_f32_16x16x32_bf16 v[48:51], a[172:175], v[44:47], v[48:51]
s_bitcmp1_b32 s46, 21
s_cbranch_scc0 LE_nf21
s_cmp_eq_u32 s42, 0
s_cbranch_scc1 LE_fl21
buffer_load_dwordx2 v[66:67], v39, s[20:23], s47 offen sc1
s_waitcnt vmcnt(0)
v_lshlrev_b32 v64, 16, v66
v_and_b32 v65, 0xffff0000, v66
v_add_f32 v48, v48, v64
v_add_f32 v49, v49, v65
v_lshlrev_b32 v64, 16, v67
v_and_b32 v65, 0xffff0000, v67
v_add_f32 v50, v50, v64
v_add_f32 v51, v51, v65
LE_fl21:
s_nop 3
v_cvt_pk_bf16_f32 v64, v48, v49
v_cvt_pk_bf16_f32 v65, v50, v51
v_mov_b32 v48, 0
v_mov_b32 v49, 0
v_mov_b32 v50, 0
v_mov_b32 v51, 0
buffer_store_dwordx2 v[64:65], v39, s[20:23], s47 offen sc1
s_add_u32 s47, s47, 512
LE_nf21:
v_mfma_f32_16x16x32_bf16 v[48:51], a[176:179], v[40:43], v[48:51]
v_mfma_f32_16x16x32_bf16 v[48:51], a[180:183], v[44:47], v[48:51]
s_bitcmp1_b32 s46, 22
s_cbranch_scc0 LE_nf22
s_cmp_eq_u32 s42, 0
s_cbranch_scc1 LE_fl22
buffer_load_dwordx2 v[66:67], v39, s[20:23], s47 offen sc1
s_waitcnt vmcnt(0)
v_lshlrev_b32 v64, 16, v66
v_and_b32 v65, 0xffff0000, v66
v_add_f32 v48, v48, v64
v_add_f32 v49, v49, v65
v_lshlrev_b32 v64, 16, v67
v_and_b32 v65, 0xffff0000, v67
v_add_f32 v50, v50, v64
v_add_f32 v51, v51, v65
LE_fl22:
s_nop 3
v_cvt_pk_bf16_f32 v64, v48, v49
v_cvt_pk_bf16_f32 v65, v50, v51
v_mov_b32 v48, 0
v_mov_b32 v49, 0
v_mov_b32 v50, 0
v_mov_b32 v51, 0
buffer_store_dwordx2 v[64:65], v39, s[20:23], s47 offen sc1
s_add_u32 s47, s47, 512
LE_nf22:
v_mfma_f32_16x16x32_bf16 v[48:51], a[184:187], v[40:43], v[48:51]
v_mfma_f32_16x16x32_bf16 v[48:51], a[188:191], v[44:47], v[48:51]
s_bitcmp1_b32 s46, 23
s_cbranch_scc0 LE_nf23
s_cmp_eq_u32 s42, 0
s_cbranch_scc1 LE_fl23
buffer_load_dwordx2 v[66:67], v39, s[20:23], s47 offen sc1
s_waitcnt vmcnt(0)
v_lshlrev_b32 v64, 16, v66
v_and_b32 v65, 0xffff0000, v66
v_add_f32 v48, v48, v64
v_add_f32 v49, v49, v65
v_lshlrev_b32 v64, 16, v67
v_and_b32 v65, 0xffff0000, v67
v_add_f32 v50, v50, v64
v_add_f32 v51, v51, v65
LE_fl23:
s_nop 3
v_cvt_pk_bf16_f32 v64, v48, v49
v_cvt_pk_bf16_f32 v65, v50, v51
v_mov_b32 v48, 0
v_mov_b32 v49, 0
v_mov_b32 v50, 0
v_mov_b32 v51, 0
buffer_store_dwordx2 v[64:65], v39, s[20:23], s47 offen sc1
s_add_u32 s47, s47, 512
LE_nf23:
s_waitcnt lgkmcnt(0)
ds_read2_b32 v[52:53], v34 offset0:96 offset1:100
ds_read2_b32 v[54:55], v34 offset0:104 offset1:108
v_mad_u32_u16 v60, v56, s49, v2
v_mad_u32_u16 v61, v57, s49, v2
v_mad_u32_u16 v62, v58, s49, v2
v_mad_u32_u16 v63, v59, s49, v2
buffer_load_dwordx4 a[160:163], v60, s[16:19], 0 offen sc1
buffer_load_dwordx4 a[164:167], v60, s[16:19], 0 offen offset:256 sc1
buffer_load_dwordx4 a[168:171], v61, s[16:19], 0 offen sc1
buffer_load_dwordx4 a[172:175], v61, s[16:19], 0 offen offset:256 sc1
buffer_load_dwordx4 a[176:179], v62, s[16:19], 0 offen sc1
buffer_load_dwordx4 a[180:183], v62, s[16:19], 0 offen offset:256 sc1
buffer_load_dwordx4 a[184:187], v63, s[16:19], 0 offen sc1
buffer_load_dwordx4 a[188:191], v63, s[16:19], 0 offen offset:256 sc1
s_waitcnt vmcnt(56)
v_mfma_f32_16x16x32_bf16 v[48:51], a[192:195], v[40:43], v[48:51]
v_mfma_f32_16x16x32_bf16 v[48:51], a[196:199], v[44:47], v[48:51]
s_bitcmp1_b32 s46, 24
s_cbranch_scc0 LE_nf24
s_cmp_eq_u32 s42, 0
s_cbranch_scc1 LE_fl24
buffer_load_dwordx2 v[66:67], v39, s[20:23], s47 offen sc1
s_waitcnt vmcnt(0)
v_lshlrev_b32 v64, 16, v66
v_and_b32 v65, 0xffff0000, v66
v_add_f32 v48, v48, v64
v_add_f32 v49, v49, v65
v_lshlrev_b32 v64, 16, v67
v_and_b32 v65, 0xffff0000, v67
v_add_f32 v50, v50, v64
v_add_f32 v51, v51, v65
LE_fl24:
s_nop 3
v_cvt_pk_bf16_f32 v64, v48, v49
v_cvt_pk_bf16_f32 v65, v50, v51
v_mov_b32 v48, 0
v_mov_b32 v49, 0
v_mov_b32 v50, 0
v_mov_b32 v51, 0
buffer_store_dwordx2 v[64:65], v39, s[20:23], s47 offen sc1
s_add_u32 s47, s47, 512
LE_nf24:
v_mfma_f32_16x16x32_bf16 v[48:51], a[200:203], v[40:43], v[48:51]
v_mfma_f32_16x16x32_bf16 v[48:51], a[204:207], v[44:47], v[48:51]
s_bitcmp1_b32 s46, 25
s_cbranch_scc0 LE_nf25
s_cmp_eq_u32 s42, 0
s_cbranch_scc1 LE_fl25
buffer_load_dwordx2 v[66:67], v39, s[20:23], s47 offen sc1
s_waitcnt vmcnt(0)
v_lshlrev_b32 v64, 16, v66
v_and_b32 v65, 0xffff0000, v66
v_add_f32 v48, v48, v64
v_add_f32 v49, v49, v65
v_lshlrev_b32 v64, 16, v67
v_and_b32 v65, 0xffff0000, v67
v_add_f32 v50, v50, v64
v_add_f32 v51, v51, v65
LE_fl25:
s_nop 3
v_cvt_pk_bf16_f32 v64, v48, v49
v_cvt_pk_bf16_f32 v65, v50, v51
v_mov_b32 v48, 0
v_mov_b32 v49, 0
v_mov_b32 v50, 0
v_mov_b32 v51, 0
buffer_store_dwordx2 v[64:65], v39, s[20:23], s47 offen sc1
s_add_u32 s47, s47, 512
LE_nf25:
v_mfma_f32_16x16x32_bf16 v[48:51], a[208:211], v[40:43], v[48:51]
v_mfma_f32_16x16x32_bf16 v[48:51], a[212:215], v[44:47], v[48:51]
s_bitcmp1_b32 s46, 26
s_cbranch_scc0 LE_nf26
s_cmp_eq_u32 s42, 0
s_cbranch_scc1 LE_fl26
buffer_load_dwordx2 v[66:67], v39, s[20:23], s47 offen sc1
s_waitcnt vmcnt(0)
v_lshlrev_b32 v64, 16, v66
v_and_b32 v65, 0xffff0000, v66
v_add_f32 v48, v48, v64
v_add_f32 v49, v49, v65
v_lshlrev_b32 v64, 16, v67
v_and_b32 v65, 0xffff0000, v67
v_add_f32 v50, v50, v64
v_add_f32 v51, v51, v65
LE_fl26:
s_nop 3
v_cvt_pk_bf16_f32 v64, v48, v49
v_cvt_pk_bf16_f32 v65, v50, v51
v_mov_b32 v48, 0
v_mov_b32 v49, 0
v_mov_b32 v50, 0
v_mov_b32 v51, 0
buffer_store_dwordx2 v[64:65], v39, s[20:23], s47 offen sc1
s_add_u32 s47, s47, 512
LE_nf26:
v_mfma_f32_16x16x32_bf16 v[48:51], a[216:219], v[40:43], v[48:51]
v_mfma_f32_16x16x32_bf16 v[48:51], a[220:223], v[44:47], v[48:51]
s_bitcmp1_b32 s46, 27
s_cbranch_scc0 LE_nf27
s_cmp_eq_u32 s42, 0
s_cbranch_scc1 LE_fl27
buffer_load_dwordx2 v[66:67], v39, s[20:23], s47 offen sc1
s_waitcnt vmcnt(0)
v_lshlrev_b32 v64, 16, v66
v_and_b32 v65, 0xffff0000, v66
v_add_f32 v48, v48, v64
v_add_f32 v49, v49, v65
v_lshlrev_b32 v64, 16, v67
v_and_b32 v65, 0xffff0000, v67
v_add_f32 v50, v50, v64
v_add_f32 v51, v51, v65
LE_fl27:
s_nop 3
v_cvt_pk_bf16_f32 v64, v48, v49
v_cvt_pk_bf16_f32 v65, v50, v51
v_mov_b32 v48, 0
v_mov_b32 v49, 0
v_mov_b32 v50, 0
v_mov_b32 v51, 0
buffer_store_dwordx2 v[64:65], v39, s[20:23], s47 offen sc1
s_add_u32 s47, s47, 512
LE_nf27:
s_waitcnt lgkmcnt(0)
ds_read2_b32 v[56:57], v34 offset0:112 offset1:116
ds_read2_b32 v[58:59], v34 offset0:120 offset1:124
v_mad_u32_u16 v60, v52, s49, v2
v_mad_u32_u16 v61, v53, s49, v2
v_mad_u32_u16 v62, v54, s49, v2
v_mad_u32_u16 v63, v55, s49, v2
buffer_load_dwordx4 a[192:195], v60, s[16:19], 0 offen sc1
buffer_load_dwordx4 a[196:199], v60, s[16:19], 0 offen offset:256 sc1
buffer_load_dwordx4 a[200:203], v61, s[16:19], 0 offen sc1
buffer_load_dwordx4 a[204:207], v61, s[16:19], 0 offen offset:256 sc1
buffer_load_dwordx4 a[208:211], v62, s[16:19], 0 offen sc1
buffer_load_dwordx4 a[212:215], v62, s[16:19], 0 offen offset:256 sc1
buffer_load_dwordx4 a[216:219], v63, s[16:19], 0 offen sc1
buffer_load_dwordx4 a[220:223], v63, s[16:19], 0 offen offset:256 sc1
s_waitcnt vmcnt(56)
v_mfma_f32_16x16x32_bf16 v[48:51], a[224:227], v[40:43], v[48:51]
v_mfma_f32_16x16x32_bf16 v[48:51], a[228:231], v[44:47], v[48:51]
s_bitcmp1_b32 s46, 28
s_cbranch_scc0 LE_nf28
s_cmp_eq_u32 s42, 0
s_cbranch_scc1 LE_fl28
buffer_load_dwordx2 v[66:67], v39, s[20:23], s47 offen sc1
s_waitcnt vmcnt(0)
v_lshlrev_b32 v64, 16, v66
v_and_b32 v65, 0xffff0000, v66
v_add_f32 v48, v48, v64
v_add_f32 v49, v49, v65
v_lshlrev_b32 v64, 16, v67
v_and_b32 v65, 0xffff0000, v67
v_add_f32 v50, v50, v64
v_add_f32 v51, v51, v65
LE_fl28:
s_nop 3
v_cvt_pk_bf16_f32 v64, v48, v49
v_cvt_pk_bf16_f32 v65, v50, v51
v_mov_b32 v48, 0
v_mov_b32 v49, 0
v_mov_b32 v50, 0
v_mov_b32 v51, 0
buffer_store_dwordx2 v[64:65], v39, s[20:23], s47 offen sc1
s_add_u32 s47, s47, 512
LE_nf28:
v_mfma_f32_16x16x32_bf16 v[48:51], a[232:235], v[40:43], v[48:51]
v_mfma_f32_16x16x32_bf16 v[48:51], a[236:239], v[44:47], v[48:51]
s_bitcmp1_b32 s46, 29
s_cbranch_scc0 LE_nf29
s_cmp_eq_u32 s42, 0
s_cbranch_scc1 LE_fl29
buffer_load_dwordx2 v[66:67], v39, s[20:23], s47 offen sc1
s_waitcnt vmcnt(0)
v_lshlrev_b32 v64, 16, v66
v_and_b32 v65, 0xffff0000, v66
v_add_f32 v48, v48, v64
v_add_f32 v49, v49, v65
v_lshlrev_b32 v64, 16, v67
v_and_b32 v65, 0xffff0000, v67
v_add_f32 v50, v50, v64
v_add_f32 v51, v51, v65
LE_fl29:
s_nop 3
v_cvt_pk_bf16_f32 v64, v48, v49
v_cvt_pk_bf16_f32 v65, v50, v51
v_mov_b32 v48, 0
v_mov_b32 v49, 0
v_mov_b32 v50, 0
v_mov_b32 v51, 0
buffer_store_dwordx2 v[64:65], v39, s[20:23], s47 offen sc1
s_add_u32 s47, s47, 512
LE_nf29:
v_mfma_f32_16x16x32_bf16 v[48:51], a[240:243], v[40:43], v[48:51]
v_mfma_f32_16x16x32_bf16 v[48:51], a[244:247], v[44:47], v[48:51]
s_bitcmp1_b32 s46, 30
s_cbranch_scc0 LE_nf30
s_cmp_eq_u32 s42, 0
s_cbranch_scc1 LE_fl30
buffer_load_dwordx2 v[66:67], v39, s[20:23], s47 offen sc1
s_waitcnt vmcnt(0)
v_lshlrev_b32 v64, 16, v66
v_and_b32 v65, 0xffff0000, v66
v_add_f32 v48, v48, v64
v_add_f32 v49, v49, v65
v_lshlrev_b32 v64, 16, v67
v_and_b32 v65, 0xffff0000, v67
v_add_f32 v50, v50, v64
v_add_f32 v51, v51, v65
LE_fl30:
s_nop 3
v_cvt_pk_bf16_f32 v64, v48, v49
v_cvt_pk_bf16_f32 v65, v50, v51
v_mov_b32 v48, 0
v_mov_b32 v49, 0
v_mov_b32 v50, 0
v_mov_b32 v51, 0
buffer_store_dwordx2 v[64:65], v39, s[20:23], s47 offen sc1
s_add_u32 s47, s47, 512
LE_nf30:
v_mfma_f32_16x16x32_bf16 v[48:51], a[248:251], v[40:43], v[48:51]
v_mfma_f32_16x16x32_bf16 v[48:51], a[252:255], v[44:47], v[48:51]
s_bitcmp1_b32 s46, 31
s_cbranch_scc0 LE_nf31
s_cmp_eq_u32 s42, 0
s_cbranch_scc1 LE_fl31
buffer_load_dwordx2 v[66:67], v39, s[20:23], s47 offen sc1
s_waitcnt vmcnt(0)
v_lshlrev_b32 v64, 16, v66
v_and_b32 v65, 0xffff0000, v66
v_add_f32 v48, v48, v64
v_add_f32 v49, v49, v65
v_lshlrev_b32 v64, 16, v67
v_and_b32 v65, 0xffff0000, v67
v_add_f32 v50, v50, v64
v_add_f32 v51, v51, v65
LE_fl31:
s_nop 3
v_cvt_pk_bf16_f32 v64, v48, v49
v_cvt_pk_bf16_f32 v65, v50, v51
v_mov_b32 v48, 0
v_mov_b32 v49, 0
v_mov_b32 v50, 0
v_mov_b32 v51, 0
buffer_store_dwordx2 v[64:65], v39, s[20:23], s47 offen sc1
s_add_u32 s47, s47, 512
LE_nf31:
s_waitcnt lgkmcnt(0)
ds_read2_b32 v[52:53], v34 offset0:128 offset1:132
ds_read2_b32 v[54:55], v34 offset0:136 offset1:140
v_mad_u32_u16 v60, v56, s49, v2
v_mad_u32_u16 v61, v57, s49, v2
v_mad_u32_u16 v62, v58, s49, v2
v_mad_u32_u16 v63, v59, s49, v2
buffer_load_dwordx4 a[224:227], v60, s[16:19], 0 offen sc1
buffer_load_dwordx4 a[228:231], v60, s[16:19], 0 offen offset:256 sc1
buffer_load_dwordx4 a[232:235], v61, s[16:19], 0 offen sc1
buffer_load_dwordx4 a[236:239], v61, s[16:19], 0 offen offset:256 sc1
buffer_load_dwordx4 a[240:243], v62, s[16:19], 0 offen sc1
buffer_load_dwordx4 a[244:247], v62, s[16:19], 0 offen offset:256 sc1
buffer_load_dwordx4 a[248:251], v63, s[16:19], 0 offen sc1
buffer_load_dwordx4 a[252:255], v63, s[16:19], 0 offen offset:256 sc1
v_add_u32 v34, 512, v34
s_cmp_lt_u32 s45, s44
s_cbranch_scc1 LE_loop
s_add_u32 s42, s42, 1
s_mul_i32 s43, s42, 256
v_cmp_lt_u32 vcc, s43, v4
s_cbranch_vccz LE_done
s_cmp_ge_u32 s42, 40
s_cbranch_scc1 LE_done
s_waitcnt vmcnt(0) lgkmcnt(0)
s_add_u32 s50, s50, 1048576
v_add_u32 v5, 0x100, v5
buffer_load_dwordx4 v[192:195], v6, s[12:15], s50 offen offset:0 sc1
buffer_load_dwordx4 v[196:199], v6, s[12:15], s50 offen offset:64 sc1
buffer_load_dwordx4 v[200:203], v6, s[12:15], s50 offen offset:128 sc1
buffer_load_dwordx4 v[204:207], v6, s[12:15], s50 offen offset:192 sc1
buffer_load_dwordx4 v[208:211], v6, s[12:15], s50 offen offset:256 sc1
buffer_load_dwordx4 v[212:215], v6, s[12:15], s50 offen offset:320 sc1
buffer_load_dwordx4 v[216:219], v6, s[12:15], s50 offen offset:384 sc1
buffer_load_dwordx4 v[220:223], v6, s[12:15], s50 offen offset:448 sc1
buffer_load_dwordx4 v[224:227], v6, s[12:15], s50 offen offset:512 sc1
buffer_load_dwordx4 v[228:231], v6, s[12:15], s50 offen offset:576 sc1
buffer_load_dwordx4 v[232:235], v6, s[12:15], s50 offen offset:640 sc1
buffer_load_dwordx4 v[236:239], v6, s[12:15], s50 offen offset:704 sc1
buffer_load_dwordx4 v[240:243], v6, s[12:15], s50 offen offset:768 sc1
buffer_load_dwordx4 v[244:247], v6, s[12:15], s50 offen offset:832 sc1
buffer_load_dwordx4 v[248:251], v6, s[12:15], s50 offen offset:896 sc1
buffer_load_dwordx4 v[252:255], v6, s[12:15], s50 offen offset:960 sc1
s_branch LE_pass
LE_done:
s_add_u32 s24, s4, 0x7c00000
s_addc_u32 s25, s5, 0
s_mov_b32 s26, 0x80000
s_mov_b32 s27, 0x00020000
s_add_u32 s48, s40, 1280
s_mul_i32 s48, s48, 128
s_waitcnt vmcnt(0)
v_lshlrev_b32 v196, 4, v1
v_mov_b32 v192, s98
v_mov_b32 v193, s99
v_mov_b32 v194, s98
v_mov_b32 v195, s99
s_mov_b64 exec, 0xff
buffer_store_dwordx4 v[192:195], v196, s[24:27], s48 offen sc1
s_mov_b64 exec, -1
s_add_u32 s24, s4, 0x7c32000
s_addc_u32 s25, s5, 0
s_mov_b32 s26, 0x400
s_mov_b32 s27, 0x00020000
v_and_b32 v196, 7, v1
v_lshlrev_b32 v196, 7, v196
s_mov_b32 s94, 0x10000
LE_wf:
buffer_load_dwordx2 v[192:193], v196, s[24:27], 0 offen sc1
s_sub_u32 s94, s94, 1
s_waitcnt vmcnt(0)
s_cbranch_scc1 LE_wf_go
v_cmp_ne_u64 vcc, s[98:99], v[192:193]
s_nop 1
s_cbranch_vccnz LE_wf
LE_wf_go:
s_add_u32 s24, s4, 0x1000000
s_addc_u32 s25, s5, 0
s_mov_b32 s26, 0x40000
s_mov_b32 s27, 0x00020000
s_mul_i32 s36, s40, 43
s_lshr_b32 s36, s36, 8
s_mul_i32 s36, s36, 6
s_sub_u32 s36, s40, s36
s_mul_i32 s36, s36, 49152
v_lshlrev_b32 v196, 7, v1
buffer_load_dword v200, v196, s[24:27], s36 offen
s_add_u32 s36, s36, 8192
buffer_load_dword v201, v196, s[24:27], s36 offen
s_add_u32 s36, s36, 8192
buffer_load_dword v202, v196, s[24:27], s36 offen
s_add_u32 s36, s36, 8192
buffer_load_dword v203, v196, s[24:27], s36 offen
s_add_u32 s36, s36, 8192
buffer_load_dword v204, v196, s[24:27], s36 offen
s_add_u32 s36, s36, 8192
buffer_load_dword v205, v196, s[24:27], s36 offen
s_add_u32 s36, s36, 8192
s_branch L2_end
L2_fin:
L2_end:
s_endpgm
L2_hot:
L2_rare_site0:
s_mov_b32 s36, 0
s_branch L2_rare_0
L2_rare_site4:
s_mov_b32 s36, 4
s_branch L2_rare_0
L2_rare_0:
s_nop 15
s_nop 15
s_waitcnt lgkmcnt(0)
v_lshrrev_b32 v206, 8, v243
v_add_u32 v206, 1, v206
v_lshrrev_b32 v206, 2, v206
v_sub_u32 v206, 0, v206
v_and_b32 v206, 0xffff0000, v206
v_add_u32 v207, 0x18000, v240
v_and_b32 v207, 0x1ffff, v207
ds_read_b128 v[200:203], v207 offset:29184
s_waitcnt lgkmcnt(0)
v_mfma_f32_16x16x32_bf16 v[192:195], v[200:203], v[0:3], 0
s_nop 7
ds_read_b128 v[200:203], v207 offset:28672
s_waitcnt lgkmcnt(0)
v_mfma_f32_16x16x32_bf16 v[192:195], v[200:203], v[4:7], v[192:195]
s_nop 7
ds_read_b128 v[200:203], v207 offset:16384
s_waitcnt lgkmcnt(0)
v_mfma_f32_16x16x32_bf16 v[192:195], v[200:203], v[8:11], v[192:195]
s_nop 7
ds_read_b128 v[200:203], v207 offset:16896
s_waitcnt lgkmcnt(0)
v_mfma_f32_16x16x32_bf16 v[192:195], v[200:203], v[12:15], v[192:195]
s_nop 7
ds_read_b128 v[200:203], v207 offset:20480
s_waitcnt lgkmcnt(0)
v_mfma_f32_16x16x32_bf16 v[192:195], v[200:203], v[16:19], v[192:195]
s_nop 7
ds_read_b128 v[200:203], v207 offset:20992
s_waitcnt lgkmcnt(0)
v_mfma_f32_16x16x32_bf16 v[192:195], v[200:203], v[20:23], v[192:195]
s_nop 7
ds_read_b128 v[200:203], v207 offset:24576
s_waitcnt lgkmcnt(0)
v_mfma_f32_16x16x32_bf16 v[192:195], v[200:203], v[24:27], v[192:195]
s_nop 7
ds_read_b128 v[200:203], v207 offset:25088
s_waitcnt lgkmcnt(0)
v_mfma_f32_16x16x32_bf16 v[192:195], v[200:203], v[28:31], v[192:195]
s_nop 7
ds_read_b128 v[200:203], v207 offset:31232
s_waitcnt lgkmcnt(0)
v_mfma_f32_16x16x32_bf16 v[196:199], v[200:203], v[0:3], 0
s_nop 7
ds_read_b128 v[200:203], v207 offset:30720
s_waitcnt lgkmcnt(0)
v_mfma_f32_16x16x32_bf16 v[196:199], v[200:203], v[4:7], v[196:199]
s_nop 7
ds_read_b128 v[200:203], v207 offset:18432
s_waitcnt lgkmcnt(0)
v_mfma_f32_16x16x32_bf16 v[196:199], v[200:203], v[8:11], v[196:199]
s_nop 7
ds_read_b128 v[200:203], v207 offset:18944
s_waitcnt lgkmcnt(0)
v_mfma_f32_16x16x32_bf16 v[196:199], v[200:203], v[12:15], v[196:199]
s_nop 7
ds_read_b128 v[200:203], v207 offset:22528
s_waitcnt lgkmcnt(0)
v_mfma_f32_16x16x32_bf16 v[196:199], v[200:203], v[16:19], v[196:199]
s_nop 7
ds_read_b128 v[200:203], v207 offset:23040
s_waitcnt lgkmcnt(0)
v_mfma_f32_16x16x32_bf16 v[196:199], v[200:203], v[20:23], v[196:199]
s_nop 7
ds_read_b128 v[200:203], v207 offset:26624
s_waitcnt lgkmcnt(0)
v_mfma_f32_16x16x32_bf16 v[196:199], v[200:203], v[24:27], v[196:199]
s_nop 7
ds_read_b128 v[200:203], v207 offset:27136
s_waitcnt lgkmcnt(0)
v_mfma_f32_16x16x32_bf16 v[196:199], v[200:203], v[28:31], v[196:199]
s_nop 7
s_nop 7
v_max_f32 v204, v192, v193
v_max3_f32 v204, v204, v194, v195
v_max3_f32 v204, v204, v196, v197
v_max3_f32 v204, v204, v198, v199
v_mov_b32 v205, v204
s_nop 1
v_permlane32_swap_b32 v204, v205
s_nop 1
v_max_f32 v204, v204, v205
v_mov_b32 v205, v204
s_nop 1
v_permlane16_swap_b32 v204, v205
s_nop 1
v_max_f32 v204, v204, v205
v_add_f32 v204, 40.0, v204
v_ceil_f32 v204, v204
v_max_f32 v204, 0, v204
v_sub_f32 v205, v224, v204
v_cvt_pk_bf16_f32 v205, v205, v205
v_and_b32 v205, 0xffff0000, v205
v_sub_f32 v204, v205, v224
v_mov_b32 v224, v205
v_exp_f32 v236, v204
v_bfi_b32 v3, v206, v205, v3
v_add_f32 v192, v192, v204
v_add_f32 v193, v193, v204
v_add_f32 v194, v194, v204
v_add_f32 v195, v195, v204
v_add_f32 v196, v196, v204
v_add_f32 v197, v197, v204
v_add_f32 v198, v198, v204
v_add_f32 v199, v199, v204
v_add_f32 v128, v128, v204
v_add_f32 v129, v129, v204
v_add_f32 v130, v130, v204
v_add_f32 v131, v131, v204
v_lshlrev_b32 v242, 16, v160
v_and_b32 v248, 0xffff0000, v160
v_mul_f32 v242, v242, v236
v_mul_f32 v248, v248, v236
v_cvt_pk_bf16_f32 v160, v242, v248
v_lshlrev_b32 v242, 16, v161
v_and_b32 v248, 0xffff0000, v161
v_mul_f32 v242, v242, v236
v_mul_f32 v248, v248, v236
v_cvt_pk_bf16_f32 v161, v242, v248
v_lshlrev_b32 v242, 16, v162
v_and_b32 v248, 0xffff0000, v162
v_mul_f32 v242, v242, v236
v_mul_f32 v248, v248, v236
v_cvt_pk_bf16_f32 v162, v242, v248
v_lshlrev_b32 v242, 16, v163
v_and_b32 v248, 0xffff0000, v163
v_mul_f32 v242, v242, v236
v_mul_f32 v248, v248, v236
v_cvt_pk_bf16_f32 v163, v242, v248
v_exp_f32 v232, v192
v_exp_f32 v233, v193
v_exp_f32 v234, v194
v_exp_f32 v235, v195
s_nop 1
v_cvt_pk_bf16_f32 v176, v232, v233
v_cvt_pk_bf16_f32 v177, v234, v235
v_exp_f32 v232, v196
v_exp_f32 v233, v197
v_exp_f32 v234, v198
v_exp_f32 v235, v199
s_nop 1
v_cvt_pk_bf16_f32 v178, v232, v233
v_cvt_pk_bf16_f32 v179, v234, v235
ds_read_b128 v[200:203], v207 offset:29184
s_waitcnt lgkmcnt(0)
v_mfma_f32_16x16x32_bf16 v[192:195], v[200:203], v[32:35], 0
s_nop 7
ds_read_b128 v[200:203], v207 offset:28672
s_waitcnt lgkmcnt(0)
v_mfma_f32_16x16x32_bf16 v[192:195], v[200:203], v[36:39], v[192:195]
s_nop 7
ds_read_b128 v[200:203], v207 offset:16384
s_waitcnt lgkmcnt(0)
v_mfma_f32_16x16x32_bf16 v[192:195], v[200:203], v[40:43], v[192:195]
s_nop 7
ds_read_b128 v[200:203], v207 offset:16896
s_waitcnt lgkmcnt(0)
v_mfma_f32_16x16x32_bf16 v[192:195], v[200:203], v[44:47], v[192:195]
s_nop 7
ds_read_b128 v[200:203], v207 offset:20480
s_waitcnt lgkmcnt(0)
v_mfma_f32_16x16x32_bf16 v[192:195], v[200:203], v[48:51], v[192:195]
s_nop 7
ds_read_b128 v[200:203], v207 offset:20992
s_waitcnt lgkmcnt(0)
v_mfma_f32_16x16x32_bf16 v[192:195], v[200:203], v[52:55], v[192:195]
s_nop 7
ds_read_b128 v[200:203], v207 offset:24576
s_waitcnt lgkmcnt(0)
v_mfma_f32_16x16x32_bf16 v[192:195], v[200:203], v[56:59], v[192:195]
s_nop 7
ds_read_b128 v[200:203], v207 offset:25088
s_waitcnt lgkmcnt(0)
v_mfma_f32_16x16x32_bf16 v[192:195], v[200:203], v[60:63], v[192:195]
s_nop 7
ds_read_b128 v[200:203], v207 offset:31232
s_waitcnt lgkmcnt(0)
v_mfma_f32_16x16x32_bf16 v[196:199], v[200:203], v[32:35], 0
s_nop 7
ds_read_b128 v[200:203], v207 offset:30720
s_waitcnt lgkmcnt(0)
v_mfma_f32_16x16x32_bf16 v[196:199], v[200:203], v[36:39], v[196:199]
s_nop 7
ds_read_b128 v[200:203], v207 offset:18432
s_waitcnt lgkmcnt(0)
v_mfma_f32_16x16x32_bf16 v[196:199], v[200:203], v[40:43], v[196:199]
s_nop 7
ds_read_b128 v[200:203], v207 offset:18944
s_waitcnt lgkmcnt(0)
v_mfma_f32_16x16x32_bf16 v[196:199], v[200:203], v[44:47], v[196:199]
s_nop 7
ds_read_b128 v[200:203], v207 offset:22528
s_waitcnt lgkmcnt(0)
v_mfma_f32_16x16x32_bf16 v[196:199], v[200:203], v[48:51], v[196:199]
s_nop 7
ds_read_b128 v[200:203], v207 offset:23040
s_waitcnt lgkmcnt(0)
v_mfma_f32_16x16x32_bf16 v[196:199], v[200:203], v[52:55], v[196:199]
s_nop 7
ds_read_b128 v[200:203], v207 offset:26624
s_waitcnt lgkmcnt(0)
v_mfma_f32_16x16x32_bf16 v[196:199], v[200:203], v[56:59], v[196:199]
s_nop 7
ds_read_b128 v[200:203], v207 offset:27136
s_waitcnt lgkmcnt(0)
v_mfma_f32_16x16x32_bf16 v[196:199], v[200:203], v[60:63], v[196:199]
s_nop 7
s_nop 7
v_max_f32 v204, v192, v193
v_max3_f32 v204, v204, v194, v195
v_max3_f32 v204, v204, v196, v197
v_max3_f32 v204, v204, v198, v199
v_mov_b32 v205, v204
s_nop 1
v_permlane32_swap_b32 v204, v205
s_nop 1
v_max_f32 v204, v204, v205
v_mov_b32 v205, v204
s_nop 1
v_permlane16_swap_b32 v204, v205
s_nop 1
v_max_f32 v204, v204, v205
v_add_f32 v204, 40.0, v204
v_ceil_f32 v204, v204
v_max_f32 v204, 0, v204
v_sub_f32 v205, v225, v204
v_cvt_pk_bf16_f32 v205, v205, v205
v_and_b32 v205, 0xffff0000, v205
v_sub_f32 v204, v205, v225
v_mov_b32 v225, v205
v_exp_f32 v237, v204
v_bfi_b32 v35, v206, v205, v35
v_add_f32 v192, v192, v204
v_add_f32 v193, v193, v204
v_add_f32 v194, v194, v204
v_add_f32 v195, v195, v204
v_add_f32 v196, v196, v204
v_add_f32 v197, v197, v204
v_add_f32 v198, v198, v204
v_add_f32 v199, v199, v204
v_add_f32 v132, v132, v204
v_add_f32 v133, v133, v204
v_add_f32 v134, v134, v204
v_add_f32 v135, v135, v204
v_lshlrev_b32 v242, 16, v164
v_and_b32 v248, 0xffff0000, v164
v_mul_f32 v242, v242, v237
v_mul_f32 v248, v248, v237
v_cvt_pk_bf16_f32 v164, v242, v248
v_lshlrev_b32 v242, 16, v165
v_and_b32 v248, 0xffff0000, v165
v_mul_f32 v242, v242, v237
v_mul_f32 v248, v248, v237
v_cvt_pk_bf16_f32 v165, v242, v248
v_lshlrev_b32 v242, 16, v166
v_and_b32 v248, 0xffff0000, v166
v_mul_f32 v242, v242, v237
v_mul_f32 v248, v248, v237
v_cvt_pk_bf16_f32 v166, v242, v248
v_lshlrev_b32 v242, 16, v167
v_and_b32 v248, 0xffff0000, v167
v_mul_f32 v242, v242, v237
v_mul_f32 v248, v248, v237
v_cvt_pk_bf16_f32 v167, v242, v248
v_exp_f32 v232, v192
v_exp_f32 v233, v193
v_exp_f32 v234, v194
v_exp_f32 v235, v195
s_nop 1
v_cvt_pk_bf16_f32 v180, v232, v233
v_cvt_pk_bf16_f32 v181, v234, v235
v_exp_f32 v232, v196
v_exp_f32 v233, v197
v_exp_f32 v234, v198
v_exp_f32 v235, v199
s_nop 1
v_cvt_pk_bf16_f32 v182, v232, v233
v_cvt_pk_bf16_f32 v183, v234, v235
ds_read_b128 v[200:203], v207 offset:29184
s_waitcnt lgkmcnt(0)
v_mfma_f32_16x16x32_bf16 v[192:195], v[200:203], v[64:67], 0
s_nop 7
ds_read_b128 v[200:203], v207 offset:28672
s_waitcnt lgkmcnt(0)
v_mfma_f32_16x16x32_bf16 v[192:195], v[200:203], v[68:71], v[192:195]
s_nop 7
ds_read_b128 v[200:203], v207 offset:16384
s_waitcnt lgkmcnt(0)
v_mfma_f32_16x16x32_bf16 v[192:195], v[200:203], v[72:75], v[192:195]
s_nop 7
ds_read_b128 v[200:203], v207 offset:16896
s_waitcnt lgkmcnt(0)
v_mfma_f32_16x16x32_bf16 v[192:195], v[200:203], v[76:79], v[192:195]
s_nop 7
ds_read_b128 v[200:203], v207 offset:20480
s_waitcnt lgkmcnt(0)
v_mfma_f32_16x16x32_bf16 v[192:195], v[200:203], v[80:83], v[192:195]
s_nop 7
ds_read_b128 v[200:203], v207 offset:20992
s_waitcnt lgkmcnt(0)
v_mfma_f32_16x16x32_bf16 v[192:195], v[200:203], v[84:87], v[192:195]
s_nop 7
ds_read_b128 v[200:203], v207 offset:24576
s_waitcnt lgkmcnt(0)
v_mfma_f32_16x16x32_bf16 v[192:195], v[200:203], v[88:91], v[192:195]
s_nop 7
ds_read_b128 v[200:203], v207 offset:25088
s_waitcnt lgkmcnt(0)
v_mfma_f32_16x16x32_bf16 v[192:195], v[200:203], v[92:95], v[192:195]
s_nop 7
ds_read_b128 v[200:203], v207 offset:31232
s_waitcnt lgkmcnt(0)
v_mfma_f32_16x16x32_bf16 v[196:199], v[200:203], v[64:67], 0
s_nop 7
ds_read_b128 v[200:203], v207 offset:30720
s_waitcnt lgkmcnt(0)
v_mfma_f32_16x16x32_bf16 v[196:199], v[200:203], v[68:71], v[196:199]
s_nop 7
ds_read_b128 v[200:203], v207 offset:18432
s_waitcnt lgkmcnt(0)
v_mfma_f32_16x16x32_bf16 v[196:199], v[200:203], v[72:75], v[196:199]
s_nop 7
ds_read_b128 v[200:203], v207 offset:18944
s_waitcnt lgkmcnt(0)
v_mfma_f32_16x16x32_bf16 v[196:199], v[200:203], v[76:79], v[196:199]
s_nop 7
ds_read_b128 v[200:203], v207 offset:22528
s_waitcnt lgkmcnt(0)
v_mfma_f32_16x16x32_bf16 v[196:199], v[200:203], v[80:83], v[196:199]
s_nop 7
ds_read_b128 v[200:203], v207 offset:23040
s_waitcnt lgkmcnt(0)
v_mfma_f32_16x16x32_bf16 v[196:199], v[200:203], v[84:87], v[196:199]
s_nop 7
ds_read_b128 v[200:203], v207 offset:26624
s_waitcnt lgkmcnt(0)
v_mfma_f32_16x16x32_bf16 v[196:199], v[200:203], v[88:91], v[196:199]
s_nop 7
ds_read_b128 v[200:203], v207 offset:27136
s_waitcnt lgkmcnt(0)
v_mfma_f32_16x16x32_bf16 v[196:199], v[200:203], v[92:95], v[196:199]
s_nop 7
s_nop 7
v_max_f32 v204, v192, v193
v_max3_f32 v204, v204, v194, v195
v_max3_f32 v204, v204, v196, v197
v_max3_f32 v204, v204, v198, v199
v_mov_b32 v205, v204
s_nop 1
v_permlane32_swap_b32 v204, v205
s_nop 1
v_max_f32 v204, v204, v205
v_mov_b32 v205, v204
s_nop 1
v_permlane16_swap_b32 v204, v205
s_nop 1
v_max_f32 v204, v204, v205
v_add_f32 v204, 40.0, v204
v_ceil_f32 v204, v204
v_max_f32 v204, 0, v204
v_sub_f32 v205, v226, v204
v_cvt_pk_bf16_f32 v205, v205, v205
v_and_b32 v205, 0xffff0000, v205
v_sub_f32 v204, v205, v226
v_mov_b32 v226, v205
v_exp_f32 v238, v204
v_bfi_b32 v67, v206, v205, v67
v_add_f32 v192, v192, v204
v_add_f32 v193, v193, v204
v_add_f32 v194, v194, v204
v_add_f32 v195, v195, v204
v_add_f32 v196, v196, v204
v_add_f32 v197, v197, v204
v_add_f32 v198, v198, v204
v_add_f32 v199, v199, v204
v_add_f32 v136, v136, v204
v_add_f32 v137, v137, v204
v_add_f32 v138, v138, v204
v_add_f32 v139, v139, v204
v_lshlrev_b32 v242, 16, v168
v_and_b32 v248, 0xffff0000, v168
v_mul_f32 v242, v242, v238
v_mul_f32 v248, v248, v238
v_cvt_pk_bf16_f32 v168, v242, v248
v_lshlrev_b32 v242, 16, v169
v_and_b32 v248, 0xffff0000, v169
v_mul_f32 v242, v242, v238
v_mul_f32 v248, v248, v238
v_cvt_pk_bf16_f32 v169, v242, v248
v_lshlrev_b32 v242, 16, v170
v_and_b32 v248, 0xffff0000, v170
v_mul_f32 v242, v242, v238
v_mul_f32 v248, v248, v238
v_cvt_pk_bf16_f32 v170, v242, v248
v_lshlrev_b32 v242, 16, v171
v_and_b32 v248, 0xffff0000, v171
v_mul_f32 v242, v242, v238
v_mul_f32 v248, v248, v238
v_cvt_pk_bf16_f32 v171, v242, v248
v_exp_f32 v232, v192
v_exp_f32 v233, v193
v_exp_f32 v234, v194
v_exp_f32 v235, v195
s_nop 1
v_cvt_pk_bf16_f32 v184, v232, v233
v_cvt_pk_bf16_f32 v185, v234, v235
v_exp_f32 v232, v196
v_exp_f32 v233, v197
v_exp_f32 v234, v198
v_exp_f32 v235, v199
s_nop 1
v_cvt_pk_bf16_f32 v186, v232, v233
v_cvt_pk_bf16_f32 v187, v234, v235
ds_read_b128 v[200:203], v207 offset:29184
s_waitcnt lgkmcnt(0)
v_mfma_f32_16x16x32_bf16 v[192:195], v[200:203], v[96:99], 0
s_nop 7
ds_read_b128 v[200:203], v207 offset:28672
s_waitcnt lgkmcnt(0)
v_mfma_f32_16x16x32_bf16 v[192:195], v[200:203], v[100:103], v[192:195]
s_nop 7
ds_read_b128 v[200:203], v207 offset:16384
s_waitcnt lgkmcnt(0)
v_mfma_f32_16x16x32_bf16 v[192:195], v[200:203], v[104:107], v[192:195]
s_nop 7
ds_read_b128 v[200:203], v207 offset:16896
s_waitcnt lgkmcnt(0)
v_mfma_f32_16x16x32_bf16 v[192:195], v[200:203], v[108:111], v[192:195]
s_nop 7
ds_read_b128 v[200:203], v207 offset:20480
s_waitcnt lgkmcnt(0)
v_mfma_f32_16x16x32_bf16 v[192:195], v[200:203], v[112:115], v[192:195]
s_nop 7
ds_read_b128 v[200:203], v207 offset:20992
s_waitcnt lgkmcnt(0)
v_mfma_f32_16x16x32_bf16 v[192:195], v[200:203], v[116:119], v[192:195]
s_nop 7
ds_read_b128 v[200:203], v207 offset:24576
s_waitcnt lgkmcnt(0)
v_mfma_f32_16x16x32_bf16 v[192:195], v[200:203], v[120:123], v[192:195]
s_nop 7
ds_read_b128 v[200:203], v207 offset:25088
s_waitcnt lgkmcnt(0)
v_mfma_f32_16x16x32_bf16 v[192:195], v[200:203], v[124:127], v[192:195]
s_nop 7
ds_read_b128 v[200:203], v207 offset:31232
s_waitcnt lgkmcnt(0)
v_mfma_f32_16x16x32_bf16 v[196:199], v[200:203], v[96:99], 0
s_nop 7
ds_read_b128 v[200:203], v207 offset:30720
s_waitcnt lgkmcnt(0)
v_mfma_f32_16x16x32_bf16 v[196:199], v[200:203], v[100:103], v[196:199]
s_nop 7
ds_read_b128 v[200:203], v207 offset:18432
s_waitcnt lgkmcnt(0)
v_mfma_f32_16x16x32_bf16 v[196:199], v[200:203], v[104:107], v[196:199]
s_nop 7
ds_read_b128 v[200:203], v207 offset:18944
s_waitcnt lgkmcnt(0)
v_mfma_f32_16x16x32_bf16 v[196:199], v[200:203], v[108:111], v[196:199]
s_nop 7
ds_read_b128 v[200:203], v207 offset:22528
s_waitcnt lgkmcnt(0)
v_mfma_f32_16x16x32_bf16 v[196:199], v[200:203], v[112:115], v[196:199]
s_nop 7
ds_read_b128 v[200:203], v207 offset:23040
s_waitcnt lgkmcnt(0)
v_mfma_f32_16x16x32_bf16 v[196:199], v[200:203], v[116:119], v[196:199]
s_nop 7
ds_read_b128 v[200:203], v207 offset:26624
s_waitcnt lgkmcnt(0)
v_mfma_f32_16x16x32_bf16 v[196:199], v[200:203], v[120:123], v[196:199]
s_nop 7
ds_read_b128 v[200:203], v207 offset:27136
s_waitcnt lgkmcnt(0)
v_mfma_f32_16x16x32_bf16 v[196:199], v[200:203], v[124:127], v[196:199]
s_nop 7
s_nop 7
v_max_f32 v204, v192, v193
v_max3_f32 v204, v204, v194, v195
v_max3_f32 v204, v204, v196, v197
v_max3_f32 v204, v204, v198, v199
v_mov_b32 v205, v204
s_nop 1
v_permlane32_swap_b32 v204, v205
s_nop 1
v_max_f32 v204, v204, v205
v_mov_b32 v205, v204
s_nop 1
v_permlane16_swap_b32 v204, v205
s_nop 1
v_max_f32 v204, v204, v205
v_add_f32 v204, 40.0, v204
v_ceil_f32 v204, v204
v_max_f32 v204, 0, v204
v_sub_f32 v205, v227, v204
v_cvt_pk_bf16_f32 v205, v205, v205
v_and_b32 v205, 0xffff0000, v205
v_sub_f32 v204, v205, v227
v_mov_b32 v227, v205
v_exp_f32 v239, v204
v_bfi_b32 v99, v206, v205, v99
v_add_f32 v192, v192, v204
v_add_f32 v193, v193, v204
v_add_f32 v194, v194, v204
v_add_f32 v195, v195, v204
v_add_f32 v196, v196, v204
v_add_f32 v197, v197, v204
v_add_f32 v198, v198, v204
v_add_f32 v199, v199, v204
v_add_f32 v140, v140, v204
v_add_f32 v141, v141, v204
v_add_f32 v142, v142, v204
v_add_f32 v143, v143, v204
v_lshlrev_b32 v242, 16, v172
v_and_b32 v248, 0xffff0000, v172
v_mul_f32 v242, v242, v239
v_mul_f32 v248, v248, v239
v_cvt_pk_bf16_f32 v172, v242, v248
v_lshlrev_b32 v242, 16, v173
v_and_b32 v248, 0xffff0000, v173
v_mul_f32 v242, v242, v239
v_mul_f32 v248, v248, v239
v_cvt_pk_bf16_f32 v173, v242, v248
v_lshlrev_b32 v242, 16, v174
v_and_b32 v248, 0xffff0000, v174
v_mul_f32 v242, v242, v239
v_mul_f32 v248, v248, v239
v_cvt_pk_bf16_f32 v174, v242, v248
v_lshlrev_b32 v242, 16, v175
v_and_b32 v248, 0xffff0000, v175
v_mul_f32 v242, v242, v239
v_mul_f32 v248, v248, v239
v_cvt_pk_bf16_f32 v175, v242, v248
v_exp_f32 v232, v192
v_exp_f32 v233, v193
v_exp_f32 v234, v194
v_exp_f32 v235, v195
s_nop 1
v_cvt_pk_bf16_f32 v188, v232, v233
v_cvt_pk_bf16_f32 v189, v234, v235
v_exp_f32 v232, v196
v_exp_f32 v233, v197
v_exp_f32 v234, v198
v_exp_f32 v235, v199
s_nop 1
v_cvt_pk_bf16_f32 v190, v232, v233
v_cvt_pk_bf16_f32 v191, v234, v235
s_branch L2_rare_common
L2_rare_site2:
s_mov_b32 s36, 2
s_branch L2_rare_1
L2_rare_1:
s_nop 15
s_nop 15
s_waitcnt lgkmcnt(0)
v_lshrrev_b32 v206, 8, v243
v_add_u32 v206, 1, v206
v_lshrrev_b32 v206, 2, v206
v_sub_u32 v206, 0, v206
v_and_b32 v206, 0xffff0000, v206
v_add_u32 v207, 0x0, v240
v_and_b32 v207, 0x1ffff, v207
ds_read_b128 v[200:203], v207 offset:12800
s_waitcnt lgkmcnt(0)
v_mfma_f32_16x16x32_bf16 v[192:195], v[200:203], v[0:3], 0
s_nop 7
ds_read_b128 v[200:203], v207 offset:12288
s_waitcnt lgkmcnt(0)
v_mfma_f32_16x16x32_bf16 v[192:195], v[200:203], v[4:7], v[192:195]
s_nop 7
ds_read_b128 v[200:203], v207 offset:0
s_waitcnt lgkmcnt(0)
v_mfma_f32_16x16x32_bf16 v[192:195], v[200:203], v[8:11], v[192:195]
s_nop 7
ds_read_b128 v[200:203], v207 offset:512
s_waitcnt lgkmcnt(0)
v_mfma_f32_16x16x32_bf16 v[192:195], v[200:203], v[12:15], v[192:195]
s_nop 7
ds_read_b128 v[200:203], v207 offset:4096
s_waitcnt lgkmcnt(0)
v_mfma_f32_16x16x32_bf16 v[192:195], v[200:203], v[16:19], v[192:195]
s_nop 7
ds_read_b128 v[200:203], v207 offset:4608
s_waitcnt lgkmcnt(0)
v_mfma_f32_16x16x32_bf16 v[192:195], v[200:203], v[20:23], v[192:195]
s_nop 7
ds_read_b128 v[200:203], v207 offset:8192
s_waitcnt lgkmcnt(0)
v_mfma_f32_16x16x32_bf16 v[192:195], v[200:203], v[24:27], v[192:195]
s_nop 7
ds_read_b128 v[200:203], v207 offset:8704
s_waitcnt lgkmcnt(0)
v_mfma_f32_16x16x32_bf16 v[192:195], v[200:203], v[28:31], v[192:195]
s_nop 7
ds_read_b128 v[200:203], v207 offset:14848
s_waitcnt lgkmcnt(0)
v_mfma_f32_16x16x32_bf16 v[196:199], v[200:203], v[0:3], 0
s_nop 7
ds_read_b128 v[200:203], v207 offset:14336
s_waitcnt lgkmcnt(0)
v_mfma_f32_16x16x32_bf16 v[196:199], v[200:203], v[4:7], v[196:199]
s_nop 7
ds_read_b128 v[200:203], v207 offset:2048
s_waitcnt lgkmcnt(0)
v_mfma_f32_16x16x32_bf16 v[196:199], v[200:203], v[8:11], v[196:199]
s_nop 7
ds_read_b128 v[200:203], v207 offset:2560
s_waitcnt lgkmcnt(0)
v_mfma_f32_16x16x32_bf16 v[196:199], v[200:203], v[12:15], v[196:199]
s_nop 7
ds_read_b128 v[200:203], v207 offset:6144
s_waitcnt lgkmcnt(0)
v_mfma_f32_16x16x32_bf16 v[196:199], v[200:203], v[16:19], v[196:199]
s_nop 7
ds_read_b128 v[200:203], v207 offset:6656
s_waitcnt lgkmcnt(0)
v_mfma_f32_16x16x32_bf16 v[196:199], v[200:203], v[20:23], v[196:199]
s_nop 7
ds_read_b128 v[200:203], v207 offset:10240
s_waitcnt lgkmcnt(0)
v_mfma_f32_16x16x32_bf16 v[196:199], v[200:203], v[24:27], v[196:199]
s_nop 7
ds_read_b128 v[200:203], v207 offset:10752
s_waitcnt lgkmcnt(0)
v_mfma_f32_16x16x32_bf16 v[196:199], v[200:203], v[28:31], v[196:199]
s_nop 7
s_nop 7
v_max_f32 v204, v192, v193
v_max3_f32 v204, v204, v194, v195
v_max3_f32 v204, v204, v196, v197
v_max3_f32 v204, v204, v198, v199
v_mov_b32 v205, v204
s_nop 1
v_permlane32_swap_b32 v204, v205
s_nop 1
v_max_f32 v204, v204, v205
v_mov_b32 v205, v204
s_nop 1
v_permlane16_swap_b32 v204, v205
s_nop 1
v_max_f32 v204, v204, v205
v_add_f32 v204, 40.0, v204
v_ceil_f32 v204, v204
v_max_f32 v204, 0, v204
v_sub_f32 v205, v224, v204
v_cvt_pk_bf16_f32 v205, v205, v205
v_and_b32 v205, 0xffff0000, v205
v_sub_f32 v204, v205, v224
v_mov_b32 v224, v205
v_exp_f32 v236, v204
v_bfi_b32 v3, v206, v205, v3
v_add_f32 v192, v192, v204
v_add_f32 v193, v193, v204
v_add_f32 v194, v194, v204
v_add_f32 v195, v195, v204
v_add_f32 v196, v196, v204
v_add_f32 v197, v197, v204
v_add_f32 v198, v198, v204
v_add_f32 v199, v199, v204
v_add_f32 v128, v128, v204
v_add_f32 v129, v129, v204
v_add_f32 v130, v130, v204
v_add_f32 v131, v131, v204
v_lshlrev_b32 v242, 16, v176
v_and_b32 v248, 0xffff0000, v176
v_mul_f32 v242, v242, v236
v_mul_f32 v248, v248, v236
v_cvt_pk_bf16_f32 v176, v242, v248
v_lshlrev_b32 v242, 16, v177
v_and_b32 v248, 0xffff0000, v177
v_mul_f32 v242, v242, v236
v_mul_f32 v248, v248, v236
v_cvt_pk_bf16_f32 v177, v242, v248
v_lshlrev_b32 v242, 16, v178
v_and_b32 v248, 0xffff0000, v178
v_mul_f32 v242, v242, v236
v_mul_f32 v248, v248, v236
v_cvt_pk_bf16_f32 v178, v242, v248
v_lshlrev_b32 v242, 16, v179
v_and_b32 v248, 0xffff0000, v179
v_mul_f32 v242, v242, v236
v_mul_f32 v248, v248, v236
v_cvt_pk_bf16_f32 v179, v242, v248
v_exp_f32 v232, v192
v_exp_f32 v233, v193
v_exp_f32 v234, v194
v_exp_f32 v235, v195
s_nop 1
v_cvt_pk_bf16_f32 v160, v232, v233
v_cvt_pk_bf16_f32 v161, v234, v235
v_exp_f32 v232, v196
v_exp_f32 v233, v197
v_exp_f32 v234, v198
v_exp_f32 v235, v199
s_nop 1
v_cvt_pk_bf16_f32 v162, v232, v233
v_cvt_pk_bf16_f32 v163, v234, v235
ds_read_b128 v[200:203], v207 offset:12800
s_waitcnt lgkmcnt(0)
v_mfma_f32_16x16x32_bf16 v[192:195], v[200:203], v[32:35], 0
s_nop 7
ds_read_b128 v[200:203], v207 offset:12288
s_waitcnt lgkmcnt(0)
v_mfma_f32_16x16x32_bf16 v[192:195], v[200:203], v[36:39], v[192:195]
s_nop 7
ds_read_b128 v[200:203], v207 offset:0
s_waitcnt lgkmcnt(0)
v_mfma_f32_16x16x32_bf16 v[192:195], v[200:203], v[40:43], v[192:195]
s_nop 7
ds_read_b128 v[200:203], v207 offset:512
s_waitcnt lgkmcnt(0)
v_mfma_f32_16x16x32_bf16 v[192:195], v[200:203], v[44:47], v[192:195]
s_nop 7
ds_read_b128 v[200:203], v207 offset:4096
s_waitcnt lgkmcnt(0)
v_mfma_f32_16x16x32_bf16 v[192:195], v[200:203], v[48:51], v[192:195]
s_nop 7
ds_read_b128 v[200:203], v207 offset:4608
s_waitcnt lgkmcnt(0)
v_mfma_f32_16x16x32_bf16 v[192:195], v[200:203], v[52:55], v[192:195]
s_nop 7
ds_read_b128 v[200:203], v207 offset:8192
s_waitcnt lgkmcnt(0)
v_mfma_f32_16x16x32_bf16 v[192:195], v[200:203], v[56:59], v[192:195]
s_nop 7
ds_read_b128 v[200:203], v207 offset:8704
s_waitcnt lgkmcnt(0)
v_mfma_f32_16x16x32_bf16 v[192:195], v[200:203], v[60:63], v[192:195]
s_nop 7
ds_read_b128 v[200:203], v207 offset:14848
s_waitcnt lgkmcnt(0)
v_mfma_f32_16x16x32_bf16 v[196:199], v[200:203], v[32:35], 0
s_nop 7
ds_read_b128 v[200:203], v207 offset:14336
s_waitcnt lgkmcnt(0)
v_mfma_f32_16x16x32_bf16 v[196:199], v[200:203], v[36:39], v[196:199]
s_nop 7
ds_read_b128 v[200:203], v207 offset:2048
s_waitcnt lgkmcnt(0)
v_mfma_f32_16x16x32_bf16 v[196:199], v[200:203], v[40:43], v[196:199]
s_nop 7
ds_read_b128 v[200:203], v207 offset:2560
s_waitcnt lgkmcnt(0)
v_mfma_f32_16x16x32_bf16 v[196:199], v[200:203], v[44:47], v[196:199]
s_nop 7
ds_read_b128 v[200:203], v207 offset:6144
s_waitcnt lgkmcnt(0)
v_mfma_f32_16x16x32_bf16 v[196:199], v[200:203], v[48:51], v[196:199]
s_nop 7
ds_read_b128 v[200:203], v207 offset:6656
s_waitcnt lgkmcnt(0)
v_mfma_f32_16x16x32_bf16 v[196:199], v[200:203], v[52:55], v[196:199]
s_nop 7
ds_read_b128 v[200:203], v207 offset:10240
s_waitcnt lgkmcnt(0)
v_mfma_f32_16x16x32_bf16 v[196:199], v[200:203], v[56:59], v[196:199]
s_nop 7
ds_read_b128 v[200:203], v207 offset:10752
s_waitcnt lgkmcnt(0)
v_mfma_f32_16x16x32_bf16 v[196:199], v[200:203], v[60:63], v[196:199]
s_nop 7
s_nop 7
v_max_f32 v204, v192, v193
v_max3_f32 v204, v204, v194, v195
v_max3_f32 v204, v204, v196, v197
v_max3_f32 v204, v204, v198, v199
v_mov_b32 v205, v204
s_nop 1
v_permlane32_swap_b32 v204, v205
s_nop 1
v_max_f32 v204, v204, v205
v_mov_b32 v205, v204
s_nop 1
v_permlane16_swap_b32 v204, v205
s_nop 1
v_max_f32 v204, v204, v205
v_add_f32 v204, 40.0, v204
v_ceil_f32 v204, v204
v_max_f32 v204, 0, v204
v_sub_f32 v205, v225, v204
v_cvt_pk_bf16_f32 v205, v205, v205
v_and_b32 v205, 0xffff0000, v205
v_sub_f32 v204, v205, v225
v_mov_b32 v225, v205
v_exp_f32 v237, v204
v_bfi_b32 v35, v206, v205, v35
v_add_f32 v192, v192, v204
v_add_f32 v193, v193, v204
v_add_f32 v194, v194, v204
v_add_f32 v195, v195, v204
v_add_f32 v196, v196, v204
v_add_f32 v197, v197, v204
v_add_f32 v198, v198, v204
v_add_f32 v199, v199, v204
v_add_f32 v132, v132, v204
v_add_f32 v133, v133, v204
v_add_f32 v134, v134, v204
v_add_f32 v135, v135, v204
v_lshlrev_b32 v242, 16, v180
v_and_b32 v248, 0xffff0000, v180
v_mul_f32 v242, v242, v237
v_mul_f32 v248, v248, v237
v_cvt_pk_bf16_f32 v180, v242, v248
v_lshlrev_b32 v242, 16, v181
v_and_b32 v248, 0xffff0000, v181
v_mul_f32 v242, v242, v237
v_mul_f32 v248, v248, v237
v_cvt_pk_bf16_f32 v181, v242, v248
v_lshlrev_b32 v242, 16, v182
v_and_b32 v248, 0xffff0000, v182
v_mul_f32 v242, v242, v237
v_mul_f32 v248, v248, v237
v_cvt_pk_bf16_f32 v182, v242, v248
v_lshlrev_b32 v242, 16, v183
v_and_b32 v248, 0xffff0000, v183
v_mul_f32 v242, v242, v237
v_mul_f32 v248, v248, v237
v_cvt_pk_bf16_f32 v183, v242, v248
v_exp_f32 v232, v192
v_exp_f32 v233, v193
v_exp_f32 v234, v194
v_exp_f32 v235, v195
s_nop 1
v_cvt_pk_bf16_f32 v164, v232, v233
v_cvt_pk_bf16_f32 v165, v234, v235
v_exp_f32 v232, v196
v_exp_f32 v233, v197
v_exp_f32 v234, v198
v_exp_f32 v235, v199
s_nop 1
v_cvt_pk_bf16_f32 v166, v232, v233
v_cvt_pk_bf16_f32 v167, v234, v235
ds_read_b128 v[200:203], v207 offset:12800
s_waitcnt lgkmcnt(0)
v_mfma_f32_16x16x32_bf16 v[192:195], v[200:203], v[64:67], 0
s_nop 7
ds_read_b128 v[200:203], v207 offset:12288
s_waitcnt lgkmcnt(0)
v_mfma_f32_16x16x32_bf16 v[192:195], v[200:203], v[68:71], v[192:195]
s_nop 7
ds_read_b128 v[200:203], v207 offset:0
s_waitcnt lgkmcnt(0)
v_mfma_f32_16x16x32_bf16 v[192:195], v[200:203], v[72:75], v[192:195]
s_nop 7
ds_read_b128 v[200:203], v207 offset:512
s_waitcnt lgkmcnt(0)
v_mfma_f32_16x16x32_bf16 v[192:195], v[200:203], v[76:79], v[192:195]
s_nop 7
ds_read_b128 v[200:203], v207 offset:4096
s_waitcnt lgkmcnt(0)
v_mfma_f32_16x16x32_bf16 v[192:195], v[200:203], v[80:83], v[192:195]
s_nop 7
ds_read_b128 v[200:203], v207 offset:4608
s_waitcnt lgkmcnt(0)
v_mfma_f32_16x16x32_bf16 v[192:195], v[200:203], v[84:87], v[192:195]
s_nop 7
ds_read_b128 v[200:203], v207 offset:8192
s_waitcnt lgkmcnt(0)
v_mfma_f32_16x16x32_bf16 v[192:195], v[200:203], v[88:91], v[192:195]
s_nop 7
ds_read_b128 v[200:203], v207 offset:8704
s_waitcnt lgkmcnt(0)
v_mfma_f32_16x16x32_bf16 v[192:195], v[200:203], v[92:95], v[192:195]
s_nop 7
ds_read_b128 v[200:203], v207 offset:14848
s_waitcnt lgkmcnt(0)
v_mfma_f32_16x16x32_bf16 v[196:199], v[200:203], v[64:67], 0
s_nop 7
ds_read_b128 v[200:203], v207 offset:14336
s_waitcnt lgkmcnt(0)
v_mfma_f32_16x16x32_bf16 v[196:199], v[200:203], v[68:71], v[196:199]
s_nop 7
ds_read_b128 v[200:203], v207 offset:2048
s_waitcnt lgkmcnt(0)
v_mfma_f32_16x16x32_bf16 v[196:199], v[200:203], v[72:75], v[196:199]
s_nop 7
ds_read_b128 v[200:203], v207 offset:2560
s_waitcnt lgkmcnt(0)
v_mfma_f32_16x16x32_bf16 v[196:199], v[200:203], v[76:79], v[196:199]
s_nop 7
ds_read_b128 v[200:203], v207 offset:6144
s_waitcnt lgkmcnt(0)
v_mfma_f32_16x16x32_bf16 v[196:199], v[200:203], v[80:83], v[196:199]
s_nop 7
ds_read_b128 v[200:203], v207 offset:6656
s_waitcnt lgkmcnt(0)
v_mfma_f32_16x16x32_bf16 v[196:199], v[200:203], v[84:87], v[196:199]
s_nop 7
ds_read_b128 v[200:203], v207 offset:10240
s_waitcnt lgkmcnt(0)
v_mfma_f32_16x16x32_bf16 v[196:199], v[200:203], v[88:91], v[196:199]
s_nop 7
ds_read_b128 v[200:203], v207 offset:10752
s_waitcnt lgkmcnt(0)
v_mfma_f32_16x16x32_bf16 v[196:199], v[200:203], v[92:95], v[196:199]
s_nop 7
s_nop 7
v_max_f32 v204, v192, v193
v_max3_f32 v204, v204, v194, v195
v_max3_f32 v204, v204, v196, v197
v_max3_f32 v204, v204, v198, v199
v_mov_b32 v205, v204
s_nop 1
v_permlane32_swap_b32 v204, v205
s_nop 1
v_max_f32 v204, v204, v205
v_mov_b32 v205, v204
s_nop 1
v_permlane16_swap_b32 v204, v205
s_nop 1
v_max_f32 v204, v204, v205
v_add_f32 v204, 40.0, v204
v_ceil_f32 v204, v204
v_max_f32 v204, 0, v204
v_sub_f32 v205, v226, v204
v_cvt_pk_bf16_f32 v205, v205, v205
v_and_b32 v205, 0xffff0000, v205
v_sub_f32 v204, v205, v226
v_mov_b32 v226, v205
v_exp_f32 v238, v204
v_bfi_b32 v67, v206, v205, v67
v_add_f32 v192, v192, v204
v_add_f32 v193, v193, v204
v_add_f32 v194, v194, v204
v_add_f32 v195, v195, v204
v_add_f32 v196, v196, v204
v_add_f32 v197, v197, v204
v_add_f32 v198, v198, v204
v_add_f32 v199, v199, v204
v_add_f32 v136, v136, v204
v_add_f32 v137, v137, v204
v_add_f32 v138, v138, v204
v_add_f32 v139, v139, v204
v_lshlrev_b32 v242, 16, v184
v_and_b32 v248, 0xffff0000, v184
v_mul_f32 v242, v242, v238
v_mul_f32 v248, v248, v238
v_cvt_pk_bf16_f32 v184, v242, v248
v_lshlrev_b32 v242, 16, v185
v_and_b32 v248, 0xffff0000, v185
v_mul_f32 v242, v242, v238
v_mul_f32 v248, v248, v238
v_cvt_pk_bf16_f32 v185, v242, v248
v_lshlrev_b32 v242, 16, v186
v_and_b32 v248, 0xffff0000, v186
v_mul_f32 v242, v242, v238
v_mul_f32 v248, v248, v238
v_cvt_pk_bf16_f32 v186, v242, v248
v_lshlrev_b32 v242, 16, v187
v_and_b32 v248, 0xffff0000, v187
v_mul_f32 v242, v242, v238
v_mul_f32 v248, v248, v238
v_cvt_pk_bf16_f32 v187, v242, v248
v_exp_f32 v232, v192
v_exp_f32 v233, v193
v_exp_f32 v234, v194
v_exp_f32 v235, v195
s_nop 1
v_cvt_pk_bf16_f32 v168, v232, v233
v_cvt_pk_bf16_f32 v169, v234, v235
v_exp_f32 v232, v196
v_exp_f32 v233, v197
v_exp_f32 v234, v198
v_exp_f32 v235, v199
s_nop 1
v_cvt_pk_bf16_f32 v170, v232, v233
v_cvt_pk_bf16_f32 v171, v234, v235
ds_read_b128 v[200:203], v207 offset:12800
s_waitcnt lgkmcnt(0)
v_mfma_f32_16x16x32_bf16 v[192:195], v[200:203], v[96:99], 0
s_nop 7
ds_read_b128 v[200:203], v207 offset:12288
s_waitcnt lgkmcnt(0)
v_mfma_f32_16x16x32_bf16 v[192:195], v[200:203], v[100:103], v[192:195]
s_nop 7
ds_read_b128 v[200:203], v207 offset:0
s_waitcnt lgkmcnt(0)
v_mfma_f32_16x16x32_bf16 v[192:195], v[200:203], v[104:107], v[192:195]
s_nop 7
ds_read_b128 v[200:203], v207 offset:512
s_waitcnt lgkmcnt(0)
v_mfma_f32_16x16x32_bf16 v[192:195], v[200:203], v[108:111], v[192:195]
s_nop 7
ds_read_b128 v[200:203], v207 offset:4096
s_waitcnt lgkmcnt(0)
v_mfma_f32_16x16x32_bf16 v[192:195], v[200:203], v[112:115], v[192:195]
s_nop 7
ds_read_b128 v[200:203], v207 offset:4608
s_waitcnt lgkmcnt(0)
v_mfma_f32_16x16x32_bf16 v[192:195], v[200:203], v[116:119], v[192:195]
s_nop 7
ds_read_b128 v[200:203], v207 offset:8192
s_waitcnt lgkmcnt(0)
v_mfma_f32_16x16x32_bf16 v[192:195], v[200:203], v[120:123], v[192:195]
s_nop 7
ds_read_b128 v[200:203], v207 offset:8704
s_waitcnt lgkmcnt(0)
v_mfma_f32_16x16x32_bf16 v[192:195], v[200:203], v[124:127], v[192:195]
s_nop 7
ds_read_b128 v[200:203], v207 offset:14848
s_waitcnt lgkmcnt(0)
v_mfma_f32_16x16x32_bf16 v[196:199], v[200:203], v[96:99], 0
s_nop 7
ds_read_b128 v[200:203], v207 offset:14336
s_waitcnt lgkmcnt(0)
v_mfma_f32_16x16x32_bf16 v[196:199], v[200:203], v[100:103], v[196:199]
s_nop 7
ds_read_b128 v[200:203], v207 offset:2048
s_waitcnt lgkmcnt(0)
v_mfma_f32_16x16x32_bf16 v[196:199], v[200:203], v[104:107], v[196:199]
s_nop 7
ds_read_b128 v[200:203], v207 offset:2560
s_waitcnt lgkmcnt(0)
v_mfma_f32_16x16x32_bf16 v[196:199], v[200:203], v[108:111], v[196:199]
s_nop 7
ds_read_b128 v[200:203], v207 offset:6144
s_waitcnt lgkmcnt(0)
v_mfma_f32_16x16x32_bf16 v[196:199], v[200:203], v[112:115], v[196:199]
s_nop 7
ds_read_b128 v[200:203], v207 offset:6656
s_waitcnt lgkmcnt(0)
v_mfma_f32_16x16x32_bf16 v[196:199], v[200:203], v[116:119], v[196:199]
s_nop 7
ds_read_b128 v[200:203], v207 offset:10240
s_waitcnt lgkmcnt(0)
v_mfma_f32_16x16x32_bf16 v[196:199], v[200:203], v[120:123], v[196:199]
s_nop 7
ds_read_b128 v[200:203], v207 offset:10752
s_waitcnt lgkmcnt(0)
v_mfma_f32_16x16x32_bf16 v[196:199], v[200:203], v[124:127], v[196:199]
s_nop 7
s_nop 7
v_max_f32 v204, v192, v193
v_max3_f32 v204, v204, v194, v195
v_max3_f32 v204, v204, v196, v197
v_max3_f32 v204, v204, v198, v199
v_mov_b32 v205, v204
s_nop 1
v_permlane32_swap_b32 v204, v205
s_nop 1
v_max_f32 v204, v204, v205
v_mov_b32 v205, v204
s_nop 1
v_permlane16_swap_b32 v204, v205
s_nop 1
v_max_f32 v204, v204, v205
v_add_f32 v204, 40.0, v204
v_ceil_f32 v204, v204
v_max_f32 v204, 0, v204
v_sub_f32 v205, v227, v204
v_cvt_pk_bf16_f32 v205, v205, v205
v_and_b32 v205, 0xffff0000, v205
v_sub_f32 v204, v205, v227
v_mov_b32 v227, v205
v_exp_f32 v239, v204
v_bfi_b32 v99, v206, v205, v99
v_add_f32 v192, v192, v204
v_add_f32 v193, v193, v204
v_add_f32 v194, v194, v204
v_add_f32 v195, v195, v204
v_add_f32 v196, v196, v204
v_add_f32 v197, v197, v204
v_add_f32 v198, v198, v204
v_add_f32 v199, v199, v204
v_add_f32 v140, v140, v204
v_add_f32 v141, v141, v204
v_add_f32 v142, v142, v204
v_add_f32 v143, v143, v204
v_lshlrev_b32 v242, 16, v188
v_and_b32 v248, 0xffff0000, v188
v_mul_f32 v242, v242, v239
v_mul_f32 v248, v248, v239
v_cvt_pk_bf16_f32 v188, v242, v248
v_lshlrev_b32 v242, 16, v189
v_and_b32 v248, 0xffff0000, v189
v_mul_f32 v242, v242, v239
v_mul_f32 v248, v248, v239
v_cvt_pk_bf16_f32 v189, v242, v248
v_lshlrev_b32 v242, 16, v190
v_and_b32 v248, 0xffff0000, v190
v_mul_f32 v242, v242, v239
v_mul_f32 v248, v248, v239
v_cvt_pk_bf16_f32 v190, v242, v248
v_lshlrev_b32 v242, 16, v191
v_and_b32 v248, 0xffff0000, v191
v_mul_f32 v242, v242, v239
v_mul_f32 v248, v248, v239
v_cvt_pk_bf16_f32 v191, v242, v248
v_exp_f32 v232, v192
v_exp_f32 v233, v193
v_exp_f32 v234, v194
v_exp_f32 v235, v195
s_nop 1
v_cvt_pk_bf16_f32 v172, v232, v233
v_cvt_pk_bf16_f32 v173, v234, v235
v_exp_f32 v232, v196
v_exp_f32 v233, v197
v_exp_f32 v234, v198
v_exp_f32 v235, v199
s_nop 1
v_cvt_pk_bf16_f32 v174, v232, v233
v_cvt_pk_bf16_f32 v175, v234, v235
s_branch L2_rare_common
L2_rare_site6:
s_mov_b32 s36, 6
s_branch L2_rare_t1_0
L2_rare_t1_0:
s_nop 15
s_nop 15
s_waitcnt lgkmcnt(0)
v_lshrrev_b32 v206, 8, v243
v_add_u32 v206, 1, v206
v_lshrrev_b32 v206, 2, v206
v_sub_u32 v206, 0, v206
v_and_b32 v206, 0xffff0000, v206
v_max_f32 v204, v128, v129
v_max3_f32 v204, v204, v130, v131
v_mov_b32 v205, v204
s_nop 1
v_permlane32_swap_b32 v204, v205
s_nop 1
v_max_f32 v204, v204, v205
v_mov_b32 v205, v204
s_nop 1
v_permlane16_swap_b32 v204, v205
s_nop 1
v_max_f32 v204, v204, v205
v_add_f32 v204, 40.0, v204
v_ceil_f32 v204, v204
v_max_f32 v204, 0, v204
v_sub_f32 v205, v224, v204
v_cvt_pk_bf16_f32 v205, v205, v205
v_and_b32 v205, 0xffff0000, v205
v_sub_f32 v204, v205, v224
v_mov_b32 v224, v205
v_exp_f32 v236, v204
v_bfi_b32 v3, v206, v205, v3
v_add_f32 v128, v128, v204
v_add_f32 v129, v129, v204
v_add_f32 v130, v130, v204
v_add_f32 v131, v131, v204
v_add_f32 v144, v144, v204
v_add_f32 v145, v145, v204
v_add_f32 v146, v146, v204
v_add_f32 v147, v147, v204
v_lshlrev_b32 v242, 16, v160
v_and_b32 v248, 0xffff0000, v160
v_mul_f32 v242, v242, v236
v_mul_f32 v248, v248, v236
v_cvt_pk_bf16_f32 v160, v242, v248
v_lshlrev_b32 v242, 16, v161
v_and_b32 v248, 0xffff0000, v161
v_mul_f32 v242, v242, v236
v_mul_f32 v248, v248, v236
v_cvt_pk_bf16_f32 v161, v242, v248
v_lshlrev_b32 v242, 16, v162
v_and_b32 v248, 0xffff0000, v162
v_mul_f32 v242, v242, v236
v_mul_f32 v248, v248, v236
v_cvt_pk_bf16_f32 v162, v242, v248
v_lshlrev_b32 v242, 16, v163
v_and_b32 v248, 0xffff0000, v163
v_mul_f32 v242, v242, v236
v_mul_f32 v248, v248, v236
v_cvt_pk_bf16_f32 v163, v242, v248
ds_read_b64 v[250:251], v231 offset:0
s_waitcnt lgkmcnt(0)
v_lshlrev_b32 v242, 16, v250
v_and_b32 v248, 0xffff0000, v250
v_mul_f32 v242, v242, v236
v_mul_f32 v248, v248, v236
v_cvt_pk_bf16_f32 v250, v242, v248
v_lshlrev_b32 v242, 16, v251
v_and_b32 v248, 0xffff0000, v251
v_mul_f32 v242, v242, v236
v_mul_f32 v248, v248, v236
v_cvt_pk_bf16_f32 v251, v242, v248
ds_write_b64 v231, v[250:251] offset:0
s_waitcnt lgkmcnt(0)
ds_read_b64 v[250:251], v231 offset:8
s_waitcnt lgkmcnt(0)
v_lshlrev_b32 v242, 16, v250
v_and_b32 v248, 0xffff0000, v250
v_mul_f32 v242, v242, v236
v_mul_f32 v248, v248, v236
v_cvt_pk_bf16_f32 v250, v242, v248
v_lshlrev_b32 v242, 16, v251
v_and_b32 v248, 0xffff0000, v251
v_mul_f32 v242, v242, v236
v_mul_f32 v248, v248, v236
v_cvt_pk_bf16_f32 v251, v242, v248
ds_write_b64 v231, v[250:251] offset:8
s_waitcnt lgkmcnt(0)
v_exp_f32 v232, v128
v_exp_f32 v233, v129
v_exp_f32 v234, v130
v_exp_f32 v235, v131
s_nop 1
v_cvt_pk_bf16_f32 v176, v232, v233
v_cvt_pk_bf16_f32 v177, v234, v235
v_max_f32 v204, v132, v133
v_max3_f32 v204, v204, v134, v135
v_mov_b32 v205, v204
s_nop 1
v_permlane32_swap_b32 v204, v205
s_nop 1
v_max_f32 v204, v204, v205
v_mov_b32 v205, v204
s_nop 1
v_permlane16_swap_b32 v204, v205
s_nop 1
v_max_f32 v204, v204, v205
v_add_f32 v204, 40.0, v204
v_ceil_f32 v204, v204
v_max_f32 v204, 0, v204
v_sub_f32 v205, v225, v204
v_cvt_pk_bf16_f32 v205, v205, v205
v_and_b32 v205, 0xffff0000, v205
v_sub_f32 v204, v205, v225
v_mov_b32 v225, v205
v_exp_f32 v237, v204
v_bfi_b32 v35, v206, v205, v35
v_add_f32 v132, v132, v204
v_add_f32 v133, v133, v204
v_add_f32 v134, v134, v204
v_add_f32 v135, v135, v204
v_add_f32 v148, v148, v204
v_add_f32 v149, v149, v204
v_add_f32 v150, v150, v204
v_add_f32 v151, v151, v204
v_lshlrev_b32 v242, 16, v164
v_and_b32 v248, 0xffff0000, v164
v_mul_f32 v242, v242, v237
v_mul_f32 v248, v248, v237
v_cvt_pk_bf16_f32 v164, v242, v248
v_lshlrev_b32 v242, 16, v165
v_and_b32 v248, 0xffff0000, v165
v_mul_f32 v242, v242, v237
v_mul_f32 v248, v248, v237
v_cvt_pk_bf16_f32 v165, v242, v248
v_lshlrev_b32 v242, 16, v166
v_and_b32 v248, 0xffff0000, v166
v_mul_f32 v242, v242, v237
v_mul_f32 v248, v248, v237
v_cvt_pk_bf16_f32 v166, v242, v248
v_lshlrev_b32 v242, 16, v167
v_and_b32 v248, 0xffff0000, v167
v_mul_f32 v242, v242, v237
v_mul_f32 v248, v248, v237
v_cvt_pk_bf16_f32 v167, v242, v248
ds_read_b64 v[250:251], v231 offset:1024
s_waitcnt lgkmcnt(0)
v_lshlrev_b32 v242, 16, v250
v_and_b32 v248, 0xffff0000, v250
v_mul_f32 v242, v242, v237
v_mul_f32 v248, v248, v237
v_cvt_pk_bf16_f32 v250, v242, v248
v_lshlrev_b32 v242, 16, v251
v_and_b32 v248, 0xffff0000, v251
v_mul_f32 v242, v242, v237
v_mul_f32 v248, v248, v237
v_cvt_pk_bf16_f32 v251, v242, v248
ds_write_b64 v231, v[250:251] offset:1024
s_waitcnt lgkmcnt(0)
ds_read_b64 v[250:251], v231 offset:1032
s_waitcnt lgkmcnt(0)
v_lshlrev_b32 v242, 16, v250
v_and_b32 v248, 0xffff0000, v250
v_mul_f32 v242, v242, v237
v_mul_f32 v248, v248, v237
v_cvt_pk_bf16_f32 v250, v242, v248
v_lshlrev_b32 v242, 16, v251
v_and_b32 v248, 0xffff0000, v251
v_mul_f32 v242, v242, v237
v_mul_f32 v248, v248, v237
v_cvt_pk_bf16_f32 v251, v242, v248
ds_write_b64 v231, v[250:251] offset:1032
s_waitcnt lgkmcnt(0)
v_exp_f32 v232, v132
v_exp_f32 v233, v133
v_exp_f32 v234, v134
v_exp_f32 v235, v135
s_nop 1
v_cvt_pk_bf16_f32 v180, v232, v233
v_cvt_pk_bf16_f32 v181, v234, v235
v_max_f32 v204, v136, v137
v_max3_f32 v204, v204, v138, v139
v_mov_b32 v205, v204
s_nop 1
v_permlane32_swap_b32 v204, v205
s_nop 1
v_max_f32 v204, v204, v205
v_mov_b32 v205, v204
s_nop 1
v_permlane16_swap_b32 v204, v205
s_nop 1
v_max_f32 v204, v204, v205
v_add_f32 v204, 40.0, v204
v_ceil_f32 v204, v204
v_max_f32 v204, 0, v204
v_sub_f32 v205, v226, v204
v_cvt_pk_bf16_f32 v205, v205, v205
v_and_b32 v205, 0xffff0000, v205
v_sub_f32 v204, v205, v226
v_mov_b32 v226, v205
v_exp_f32 v238, v204
v_bfi_b32 v67, v206, v205, v67
v_add_f32 v136, v136, v204
v_add_f32 v137, v137, v204
v_add_f32 v138, v138, v204
v_add_f32 v139, v139, v204
v_add_f32 v152, v152, v204
v_add_f32 v153, v153, v204
v_add_f32 v154, v154, v204
v_add_f32 v155, v155, v204
v_lshlrev_b32 v242, 16, v168
v_and_b32 v248, 0xffff0000, v168
v_mul_f32 v242, v242, v238
v_mul_f32 v248, v248, v238
v_cvt_pk_bf16_f32 v168, v242, v248
v_lshlrev_b32 v242, 16, v169
v_and_b32 v248, 0xffff0000, v169
v_mul_f32 v242, v242, v238
v_mul_f32 v248, v248, v238
v_cvt_pk_bf16_f32 v169, v242, v248
v_lshlrev_b32 v242, 16, v170
v_and_b32 v248, 0xffff0000, v170
v_mul_f32 v242, v242, v238
v_mul_f32 v248, v248, v238
v_cvt_pk_bf16_f32 v170, v242, v248
v_lshlrev_b32 v242, 16, v171
v_and_b32 v248, 0xffff0000, v171
v_mul_f32 v242, v242, v238
v_mul_f32 v248, v248, v238
v_cvt_pk_bf16_f32 v171, v242, v248
ds_read_b64 v[250:251], v231 offset:2048
s_waitcnt lgkmcnt(0)
v_lshlrev_b32 v242, 16, v250
v_and_b32 v248, 0xffff0000, v250
v_mul_f32 v242, v242, v238
v_mul_f32 v248, v248, v238
v_cvt_pk_bf16_f32 v250, v242, v248
v_lshlrev_b32 v242, 16, v251
v_and_b32 v248, 0xffff0000, v251
v_mul_f32 v242, v242, v238
v_mul_f32 v248, v248, v238
v_cvt_pk_bf16_f32 v251, v242, v248
ds_write_b64 v231, v[250:251] offset:2048
s_waitcnt lgkmcnt(0)
ds_read_b64 v[250:251], v231 offset:2056
s_waitcnt lgkmcnt(0)
v_lshlrev_b32 v242, 16, v250
v_and_b32 v248, 0xffff0000, v250
v_mul_f32 v242, v242, v238
v_mul_f32 v248, v248, v238
v_cvt_pk_bf16_f32 v250, v242, v248
v_lshlrev_b32 v242, 16, v251
v_and_b32 v248, 0xffff0000, v251
v_mul_f32 v242, v242, v238
v_mul_f32 v248, v248, v238
v_cvt_pk_bf16_f32 v251, v242, v248
ds_write_b64 v231, v[250:251] offset:2056
s_waitcnt lgkmcnt(0)
v_exp_f32 v232, v136
v_exp_f32 v233, v137
v_exp_f32 v234, v138
v_exp_f32 v235, v139
s_nop 1
v_cvt_pk_bf16_f32 v184, v232, v233
v_cvt_pk_bf16_f32 v185, v234, v235
v_max_f32 v204, v140, v141
v_max3_f32 v204, v204, v142, v143
v_mov_b32 v205, v204
s_nop 1
v_permlane32_swap_b32 v204, v205
s_nop 1
v_max_f32 v204, v204, v205
v_mov_b32 v205, v204
s_nop 1
v_permlane16_swap_b32 v204, v205
s_nop 1
v_max_f32 v204, v204, v205
v_add_f32 v204, 40.0, v204
v_ceil_f32 v204, v204
v_max_f32 v204, 0, v204
v_sub_f32 v205, v227, v204
v_cvt_pk_bf16_f32 v205, v205, v205
v_and_b32 v205, 0xffff0000, v205
v_sub_f32 v204, v205, v227
v_mov_b32 v227, v205
v_exp_f32 v239, v204
v_bfi_b32 v99, v206, v205, v99
v_add_f32 v140, v140, v204
v_add_f32 v141, v141, v204
v_add_f32 v142, v142, v204
v_add_f32 v143, v143, v204
v_add_f32 v156, v156, v204
v_add_f32 v157, v157, v204
v_add_f32 v158, v158, v204
v_add_f32 v159, v159, v204
v_lshlrev_b32 v242, 16, v172
v_and_b32 v248, 0xffff0000, v172
v_mul_f32 v242, v242, v239
v_mul_f32 v248, v248, v239
v_cvt_pk_bf16_f32 v172, v242, v248
v_lshlrev_b32 v242, 16, v173
v_and_b32 v248, 0xffff0000, v173
v_mul_f32 v242, v242, v239
v_mul_f32 v248, v248, v239
v_cvt_pk_bf16_f32 v173, v242, v248
v_lshlrev_b32 v242, 16, v174
v_and_b32 v248, 0xffff0000, v174
v_mul_f32 v242, v242, v239
v_mul_f32 v248, v248, v239
v_cvt_pk_bf16_f32 v174, v242, v248
v_lshlrev_b32 v242, 16, v175
v_and_b32 v248, 0xffff0000, v175
v_mul_f32 v242, v242, v239
v_mul_f32 v248, v248, v239
v_cvt_pk_bf16_f32 v175, v242, v248
ds_read_b64 v[250:251], v231 offset:3072
s_waitcnt lgkmcnt(0)
v_lshlrev_b32 v242, 16, v250
v_and_b32 v248, 0xffff0000, v250
v_mul_f32 v242, v242, v239
v_mul_f32 v248, v248, v239
v_cvt_pk_bf16_f32 v250, v242, v248
v_lshlrev_b32 v242, 16, v251
v_and_b32 v248, 0xffff0000, v251
v_mul_f32 v242, v242, v239
v_mul_f32 v248, v248, v239
v_cvt_pk_bf16_f32 v251, v242, v248
ds_write_b64 v231, v[250:251] offset:3072
s_waitcnt lgkmcnt(0)
ds_read_b64 v[250:251], v231 offset:3080
s_waitcnt lgkmcnt(0)
v_lshlrev_b32 v242, 16, v250
v_and_b32 v248, 0xffff0000, v250
v_mul_f32 v242, v242, v239
v_mul_f32 v248, v248, v239
v_cvt_pk_bf16_f32 v250, v242, v248
v_lshlrev_b32 v242, 16, v251
v_and_b32 v248, 0xffff0000, v251
v_mul_f32 v242, v242, v239
v_mul_f32 v248, v248, v239
v_cvt_pk_bf16_f32 v251, v242, v248
ds_write_b64 v231, v[250:251] offset:3080
s_waitcnt lgkmcnt(0)
v_exp_f32 v232, v140
v_exp_f32 v233, v141
v_exp_f32 v234, v142
v_exp_f32 v235, v143
s_nop 1
v_cvt_pk_bf16_f32 v188, v232, v233
v_cvt_pk_bf16_f32 v189, v234, v235
s_branch L2_rare_common
L2_rare_site7:
s_mov_b32 s36, 7
s_branch L2_rare_t1_1
L2_rare_t1_1:
s_nop 15
s_nop 15
s_waitcnt lgkmcnt(0)
v_lshrrev_b32 v206, 8, v243
v_add_u32 v206, 1, v206
v_lshrrev_b32 v206, 2, v206
v_sub_u32 v206, 0, v206
v_and_b32 v206, 0xffff0000, v206
v_max_f32 v204, v144, v145
v_max3_f32 v204, v204, v146, v147
v_mov_b32 v205, v204
s_nop 1
v_permlane32_swap_b32 v204, v205
s_nop 1
v_max_f32 v204, v204, v205
v_mov_b32 v205, v204
s_nop 1
v_permlane16_swap_b32 v204, v205
s_nop 1
v_max_f32 v204, v204, v205
v_add_f32 v204, 40.0, v204
v_ceil_f32 v204, v204
v_max_f32 v204, 0, v204
v_sub_f32 v205, v224, v204
v_cvt_pk_bf16_f32 v205, v205, v205
v_and_b32 v205, 0xffff0000, v205
v_sub_f32 v204, v205, v224
v_mov_b32 v224, v205
v_exp_f32 v236, v204
v_bfi_b32 v3, v206, v205, v3
v_add_f32 v144, v144, v204
v_add_f32 v145, v145, v204
v_add_f32 v146, v146, v204
v_add_f32 v147, v147, v204
v_add_f32 v128, v128, v204
v_add_f32 v129, v129, v204
v_add_f32 v130, v130, v204
v_add_f32 v131, v131, v204
v_lshlrev_b32 v242, 16, v176
v_and_b32 v248, 0xffff0000, v176
v_mul_f32 v242, v242, v236
v_mul_f32 v248, v248, v236
v_cvt_pk_bf16_f32 v176, v242, v248
v_lshlrev_b32 v242, 16, v177
v_and_b32 v248, 0xffff0000, v177
v_mul_f32 v242, v242, v236
v_mul_f32 v248, v248, v236
v_cvt_pk_bf16_f32 v177, v242, v248
ds_read_b64 v[250:251], v231 offset:0
s_waitcnt lgkmcnt(0)
v_lshlrev_b32 v242, 16, v250
v_and_b32 v248, 0xffff0000, v250
v_mul_f32 v242, v242, v236
v_mul_f32 v248, v248, v236
v_cvt_pk_bf16_f32 v250, v242, v248
v_lshlrev_b32 v242, 16, v251
v_and_b32 v248, 0xffff0000, v251
v_mul_f32 v242, v242, v236
v_mul_f32 v248, v248, v236
v_cvt_pk_bf16_f32 v251, v242, v248
ds_write_b64 v231, v[250:251] offset:0
s_waitcnt lgkmcnt(0)
ds_read_b64 v[250:251], v231 offset:8
s_waitcnt lgkmcnt(0)
v_lshlrev_b32 v242, 16, v250
v_and_b32 v248, 0xffff0000, v250
v_mul_f32 v242, v242, v236
v_mul_f32 v248, v248, v236
v_cvt_pk_bf16_f32 v250, v242, v248
v_lshlrev_b32 v242, 16, v251
v_and_b32 v248, 0xffff0000, v251
v_mul_f32 v242, v242, v236
v_mul_f32 v248, v248, v236
v_cvt_pk_bf16_f32 v251, v242, v248
ds_write_b64 v231, v[250:251] offset:8
s_waitcnt lgkmcnt(0)
ds_read_b64 v[250:251], v231 offset:4096
s_waitcnt lgkmcnt(0)
v_lshlrev_b32 v242, 16, v250
v_and_b32 v248, 0xffff0000, v250
v_mul_f32 v242, v242, v236
v_mul_f32 v248, v248, v236
v_cvt_pk_bf16_f32 v250, v242, v248
v_lshlrev_b32 v242, 16, v251
v_and_b32 v248, 0xffff0000, v251
v_mul_f32 v242, v242, v236
v_mul_f32 v248, v248, v236
v_cvt_pk_bf16_f32 v251, v242, v248
ds_write_b64 v231, v[250:251] offset:4096
s_waitcnt lgkmcnt(0)
ds_read_b64 v[250:251], v231 offset:4104
s_waitcnt lgkmcnt(0)
v_lshlrev_b32 v242, 16, v250
v_and_b32 v248, 0xffff0000, v250
v_mul_f32 v242, v242, v236
v_mul_f32 v248, v248, v236
v_cvt_pk_bf16_f32 v250, v242, v248
v_lshlrev_b32 v242, 16, v251
v_and_b32 v248, 0xffff0000, v251
v_mul_f32 v242, v242, v236
v_mul_f32 v248, v248, v236
v_cvt_pk_bf16_f32 v251, v242, v248
ds_write_b64 v231, v[250:251] offset:4104
s_waitcnt lgkmcnt(0)
v_exp_f32 v232, v144
v_exp_f32 v233, v145
v_exp_f32 v234, v146
v_exp_f32 v235, v147
s_nop 1
v_cvt_pk_bf16_f32 v178, v232, v233
v_cvt_pk_bf16_f32 v179, v234, v235
v_max_f32 v204, v148, v149
v_max3_f32 v204, v204, v150, v151
v_mov_b32 v205, v204
s_nop 1
v_permlane32_swap_b32 v204, v205
s_nop 1
v_max_f32 v204, v204, v205
v_mov_b32 v205, v204
s_nop 1
v_permlane16_swap_b32 v204, v205
s_nop 1
v_max_f32 v204, v204, v205
v_add_f32 v204, 40.0, v204
v_ceil_f32 v204, v204
v_max_f32 v204, 0, v204
v_sub_f32 v205, v225, v204
v_cvt_pk_bf16_f32 v205, v205, v205
v_and_b32 v205, 0xffff0000, v205
v_sub_f32 v204, v205, v225
v_mov_b32 v225, v205
v_exp_f32 v237, v204
v_bfi_b32 v35, v206, v205, v35
v_add_f32 v148, v148, v204
v_add_f32 v149, v149, v204
v_add_f32 v150, v150, v204
v_add_f32 v151, v151, v204
v_add_f32 v132, v132, v204
v_add_f32 v133, v133, v204
v_add_f32 v134, v134, v204
v_add_f32 v135, v135, v204
v_lshlrev_b32 v242, 16, v180
v_and_b32 v248, 0xffff0000, v180
v_mul_f32 v242, v242, v237
v_mul_f32 v248, v248, v237
v_cvt_pk_bf16_f32 v180, v242, v248
v_lshlrev_b32 v242, 16, v181
v_and_b32 v248, 0xffff0000, v181
v_mul_f32 v242, v242, v237
v_mul_f32 v248, v248, v237
v_cvt_pk_bf16_f32 v181, v242, v248
ds_read_b64 v[250:251], v231 offset:1024
s_waitcnt lgkmcnt(0)
v_lshlrev_b32 v242, 16, v250
v_and_b32 v248, 0xffff0000, v250
v_mul_f32 v242, v242, v237
v_mul_f32 v248, v248, v237
v_cvt_pk_bf16_f32 v250, v242, v248
v_lshlrev_b32 v242, 16, v251
v_and_b32 v248, 0xffff0000, v251
v_mul_f32 v242, v242, v237
v_mul_f32 v248, v248, v237
v_cvt_pk_bf16_f32 v251, v242, v248
ds_write_b64 v231, v[250:251] offset:1024
s_waitcnt lgkmcnt(0)
ds_read_b64 v[250:251], v231 offset:1032
s_waitcnt lgkmcnt(0)
v_lshlrev_b32 v242, 16, v250
v_and_b32 v248, 0xffff0000, v250
v_mul_f32 v242, v242, v237
v_mul_f32 v248, v248, v237
v_cvt_pk_bf16_f32 v250, v242, v248
v_lshlrev_b32 v242, 16, v251
v_and_b32 v248, 0xffff0000, v251
v_mul_f32 v242, v242, v237
v_mul_f32 v248, v248, v237
v_cvt_pk_bf16_f32 v251, v242, v248
ds_write_b64 v231, v[250:251] offset:1032
s_waitcnt lgkmcnt(0)
ds_read_b64 v[250:251], v231 offset:5120
s_waitcnt lgkmcnt(0)
v_lshlrev_b32 v242, 16, v250
v_and_b32 v248, 0xffff0000, v250
v_mul_f32 v242, v242, v237
v_mul_f32 v248, v248, v237
v_cvt_pk_bf16_f32 v250, v242, v248
v_lshlrev_b32 v242, 16, v251
v_and_b32 v248, 0xffff0000, v251
v_mul_f32 v242, v242, v237
v_mul_f32 v248, v248, v237
v_cvt_pk_bf16_f32 v251, v242, v248
ds_write_b64 v231, v[250:251] offset:5120
s_waitcnt lgkmcnt(0)
ds_read_b64 v[250:251], v231 offset:5128
s_waitcnt lgkmcnt(0)
v_lshlrev_b32 v242, 16, v250
v_and_b32 v248, 0xffff0000, v250
v_mul_f32 v242, v242, v237
v_mul_f32 v248, v248, v237
v_cvt_pk_bf16_f32 v250, v242, v248
v_lshlrev_b32 v242, 16, v251
v_and_b32 v248, 0xffff0000, v251
v_mul_f32 v242, v242, v237
v_mul_f32 v248, v248, v237
v_cvt_pk_bf16_f32 v251, v242, v248
ds_write_b64 v231, v[250:251] offset:5128
s_waitcnt lgkmcnt(0)
v_exp_f32 v232, v148
v_exp_f32 v233, v149
v_exp_f32 v234, v150
v_exp_f32 v235, v151
s_nop 1
v_cvt_pk_bf16_f32 v182, v232, v233
v_cvt_pk_bf16_f32 v183, v234, v235
v_max_f32 v204, v152, v153
v_max3_f32 v204, v204, v154, v155
v_mov_b32 v205, v204
s_nop 1
v_permlane32_swap_b32 v204, v205
s_nop 1
v_max_f32 v204, v204, v205
v_mov_b32 v205, v204
s_nop 1
v_permlane16_swap_b32 v204, v205
s_nop 1
v_max_f32 v204, v204, v205
v_add_f32 v204, 40.0, v204
v_ceil_f32 v204, v204
v_max_f32 v204, 0, v204
v_sub_f32 v205, v226, v204
v_cvt_pk_bf16_f32 v205, v205, v205
v_and_b32 v205, 0xffff0000, v205
v_sub_f32 v204, v205, v226
v_mov_b32 v226, v205
v_exp_f32 v238, v204
v_bfi_b32 v67, v206, v205, v67
v_add_f32 v152, v152, v204
v_add_f32 v153, v153, v204
v_add_f32 v154, v154, v204
v_add_f32 v155, v155, v204
v_add_f32 v136, v136, v204
v_add_f32 v137, v137, v204
v_add_f32 v138, v138, v204
v_add_f32 v139, v139, v204
v_lshlrev_b32 v242, 16, v184
v_and_b32 v248, 0xffff0000, v184
v_mul_f32 v242, v242, v238
v_mul_f32 v248, v248, v238
v_cvt_pk_bf16_f32 v184, v242, v248
v_lshlrev_b32 v242, 16, v185
v_and_b32 v248, 0xffff0000, v185
v_mul_f32 v242, v242, v238
v_mul_f32 v248, v248, v238
v_cvt_pk_bf16_f32 v185, v242, v248
ds_read_b64 v[250:251], v231 offset:2048
s_waitcnt lgkmcnt(0)
v_lshlrev_b32 v242, 16, v250
v_and_b32 v248, 0xffff0000, v250
v_mul_f32 v242, v242, v238
v_mul_f32 v248, v248, v238
v_cvt_pk_bf16_f32 v250, v242, v248
v_lshlrev_b32 v242, 16, v251
v_and_b32 v248, 0xffff0000, v251
v_mul_f32 v242, v242, v238
v_mul_f32 v248, v248, v238
v_cvt_pk_bf16_f32 v251, v242, v248
ds_write_b64 v231, v[250:251] offset:2048
s_waitcnt lgkmcnt(0)
ds_read_b64 v[250:251], v231 offset:2056
s_waitcnt lgkmcnt(0)
v_lshlrev_b32 v242, 16, v250
v_and_b32 v248, 0xffff0000, v250
v_mul_f32 v242, v242, v238
v_mul_f32 v248, v248, v238
v_cvt_pk_bf16_f32 v250, v242, v248
v_lshlrev_b32 v242, 16, v251
v_and_b32 v248, 0xffff0000, v251
v_mul_f32 v242, v242, v238
v_mul_f32 v248, v248, v238
v_cvt_pk_bf16_f32 v251, v242, v248
ds_write_b64 v231, v[250:251] offset:2056
s_waitcnt lgkmcnt(0)
ds_read_b64 v[250:251], v231 offset:6144
s_waitcnt lgkmcnt(0)
v_lshlrev_b32 v242, 16, v250
v_and_b32 v248, 0xffff0000, v250
v_mul_f32 v242, v242, v238
v_mul_f32 v248, v248, v238
v_cvt_pk_bf16_f32 v250, v242, v248
v_lshlrev_b32 v242, 16, v251
v_and_b32 v248, 0xffff0000, v251
v_mul_f32 v242, v242, v238
v_mul_f32 v248, v248, v238
v_cvt_pk_bf16_f32 v251, v242, v248
ds_write_b64 v231, v[250:251] offset:6144
s_waitcnt lgkmcnt(0)
ds_read_b64 v[250:251], v231 offset:6152
s_waitcnt lgkmcnt(0)
v_lshlrev_b32 v242, 16, v250
v_and_b32 v248, 0xffff0000, v250
v_mul_f32 v242, v242, v238
v_mul_f32 v248, v248, v238
v_cvt_pk_bf16_f32 v250, v242, v248
v_lshlrev_b32 v242, 16, v251
v_and_b32 v248, 0xffff0000, v251
v_mul_f32 v242, v242, v238
v_mul_f32 v248, v248, v238
v_cvt_pk_bf16_f32 v251, v242, v248
ds_write_b64 v231, v[250:251] offset:6152
s_waitcnt lgkmcnt(0)
v_exp_f32 v232, v152
v_exp_f32 v233, v153
v_exp_f32 v234, v154
v_exp_f32 v235, v155
s_nop 1
v_cvt_pk_bf16_f32 v186, v232, v233
v_cvt_pk_bf16_f32 v187, v234, v235
v_max_f32 v204, v156, v157
v_max3_f32 v204, v204, v158, v159
v_mov_b32 v205, v204
s_nop 1
v_permlane32_swap_b32 v204, v205
s_nop 1
v_max_f32 v204, v204, v205
v_mov_b32 v205, v204
s_nop 1
v_permlane16_swap_b32 v204, v205
s_nop 1
v_max_f32 v204, v204, v205
v_add_f32 v204, 40.0, v204
v_ceil_f32 v204, v204
v_max_f32 v204, 0, v204
v_sub_f32 v205, v227, v204
v_cvt_pk_bf16_f32 v205, v205, v205
v_and_b32 v205, 0xffff0000, v205
v_sub_f32 v204, v205, v227
v_mov_b32 v227, v205
v_exp_f32 v239, v204
v_bfi_b32 v99, v206, v205, v99
v_add_f32 v156, v156, v204
v_add_f32 v157, v157, v204
v_add_f32 v158, v158, v204
v_add_f32 v159, v159, v204
v_add_f32 v140, v140, v204
v_add_f32 v141, v141, v204
v_add_f32 v142, v142, v204
v_add_f32 v143, v143, v204
v_lshlrev_b32 v242, 16, v188
v_and_b32 v248, 0xffff0000, v188
v_mul_f32 v242, v242, v239
v_mul_f32 v248, v248, v239
v_cvt_pk_bf16_f32 v188, v242, v248
v_lshlrev_b32 v242, 16, v189
v_and_b32 v248, 0xffff0000, v189
v_mul_f32 v242, v242, v239
v_mul_f32 v248, v248, v239
v_cvt_pk_bf16_f32 v189, v242, v248
ds_read_b64 v[250:251], v231 offset:3072
s_waitcnt lgkmcnt(0)
v_lshlrev_b32 v242, 16, v250
v_and_b32 v248, 0xffff0000, v250
v_mul_f32 v242, v242, v239
v_mul_f32 v248, v248, v239
v_cvt_pk_bf16_f32 v250, v242, v248
v_lshlrev_b32 v242, 16, v251
v_and_b32 v248, 0xffff0000, v251
v_mul_f32 v242, v242, v239
v_mul_f32 v248, v248, v239
v_cvt_pk_bf16_f32 v251, v242, v248
ds_write_b64 v231, v[250:251] offset:3072
s_waitcnt lgkmcnt(0)
ds_read_b64 v[250:251], v231 offset:3080
s_waitcnt lgkmcnt(0)
v_lshlrev_b32 v242, 16, v250
v_and_b32 v248, 0xffff0000, v250
v_mul_f32 v242, v242, v239
v_mul_f32 v248, v248, v239
v_cvt_pk_bf16_f32 v250, v242, v248
v_lshlrev_b32 v242, 16, v251
v_and_b32 v248, 0xffff0000, v251
v_mul_f32 v242, v242, v239
v_mul_f32 v248, v248, v239
v_cvt_pk_bf16_f32 v251, v242, v248
ds_write_b64 v231, v[250:251] offset:3080
s_waitcnt lgkmcnt(0)
ds_read_b64 v[250:251], v231 offset:7168
s_waitcnt lgkmcnt(0)
v_lshlrev_b32 v242, 16, v250
v_and_b32 v248, 0xffff0000, v250
v_mul_f32 v242, v242, v239
v_mul_f32 v248, v248, v239
v_cvt_pk_bf16_f32 v250, v242, v248
v_lshlrev_b32 v242, 16, v251
v_and_b32 v248, 0xffff0000, v251
v_mul_f32 v242, v242, v239
v_mul_f32 v248, v248, v239
v_cvt_pk_bf16_f32 v251, v242, v248
ds_write_b64 v231, v[250:251] offset:7168
s_waitcnt lgkmcnt(0)
ds_read_b64 v[250:251], v231 offset:7176
s_waitcnt lgkmcnt(0)
v_lshlrev_b32 v242, 16, v250
v_and_b32 v248, 0xffff0000, v250
v_mul_f32 v242, v242, v239
v_mul_f32 v248, v248, v239
v_cvt_pk_bf16_f32 v250, v242, v248
v_lshlrev_b32 v242, 16, v251
v_and_b32 v248, 0xffff0000, v251
v_mul_f32 v242, v242, v239
v_mul_f32 v248, v248, v239
v_cvt_pk_bf16_f32 v251, v242, v248
ds_write_b64 v231, v[250:251] offset:7176
s_waitcnt lgkmcnt(0)
v_exp_f32 v232, v156
v_exp_f32 v233, v157
v_exp_f32 v234, v158
v_exp_f32 v235, v159
s_nop 1
v_cvt_pk_bf16_f32 v190, v232, v233
v_cvt_pk_bf16_f32 v191, v234, v235
s_branch L2_rare_common
L2_rare_site8:
s_mov_b32 s36, 8
s_branch L2_rare_t1_2
L2_rare_t1_2:
s_nop 15
s_nop 15
s_waitcnt lgkmcnt(0)
v_lshrrev_b32 v206, 8, v243
v_add_u32 v206, 1, v206
v_lshrrev_b32 v206, 2, v206
v_sub_u32 v206, 0, v206
v_and_b32 v206, 0xffff0000, v206
v_max_f32 v204, v128, v129
v_max3_f32 v204, v204, v130, v131
v_mov_b32 v205, v204
s_nop 1
v_permlane32_swap_b32 v204, v205
s_nop 1
v_max_f32 v204, v204, v205
v_mov_b32 v205, v204
s_nop 1
v_permlane16_swap_b32 v204, v205
s_nop 1
v_max_f32 v204, v204, v205
v_add_f32 v204, 40.0, v204
v_ceil_f32 v204, v204
v_max_f32 v204, 0, v204
v_sub_f32 v205, v224, v204
v_cvt_pk_bf16_f32 v205, v205, v205
v_and_b32 v205, 0xffff0000, v205
v_sub_f32 v204, v205, v224
v_mov_b32 v224, v205
v_exp_f32 v236, v204
v_bfi_b32 v3, v206, v205, v3
v_add_f32 v128, v128, v204
v_add_f32 v129, v129, v204
v_add_f32 v130, v130, v204
v_add_f32 v131, v131, v204
v_add_f32 v144, v144, v204
v_add_f32 v145, v145, v204
v_add_f32 v146, v146, v204
v_add_f32 v147, v147, v204
v_lshlrev_b32 v242, 16, v176
v_and_b32 v248, 0xffff0000, v176
v_mul_f32 v242, v242, v236
v_mul_f32 v248, v248, v236
v_cvt_pk_bf16_f32 v176, v242, v248
v_lshlrev_b32 v242, 16, v177
v_and_b32 v248, 0xffff0000, v177
v_mul_f32 v242, v242, v236
v_mul_f32 v248, v248, v236
v_cvt_pk_bf16_f32 v177, v242, v248
v_lshlrev_b32 v242, 16, v178
v_and_b32 v248, 0xffff0000, v178
v_mul_f32 v242, v242, v236
v_mul_f32 v248, v248, v236
v_cvt_pk_bf16_f32 v178, v242, v248
v_lshlrev_b32 v242, 16, v179
v_and_b32 v248, 0xffff0000, v179
v_mul_f32 v242, v242, v236
v_mul_f32 v248, v248, v236
v_cvt_pk_bf16_f32 v179, v242, v248
ds_read_b64 v[250:251], v231 offset:0
s_waitcnt lgkmcnt(0)
v_lshlrev_b32 v242, 16, v250
v_and_b32 v248, 0xffff0000, v250
v_mul_f32 v242, v242, v236
v_mul_f32 v248, v248, v236
v_cvt_pk_bf16_f32 v250, v242, v248
v_lshlrev_b32 v242, 16, v251
v_and_b32 v248, 0xffff0000, v251
v_mul_f32 v242, v242, v236
v_mul_f32 v248, v248, v236
v_cvt_pk_bf16_f32 v251, v242, v248
ds_write_b64 v231, v[250:251] offset:0
s_waitcnt lgkmcnt(0)
ds_read_b64 v[250:251], v231 offset:8
s_waitcnt lgkmcnt(0)
v_lshlrev_b32 v242, 16, v250
v_and_b32 v248, 0xffff0000, v250
v_mul_f32 v242, v242, v236
v_mul_f32 v248, v248, v236
v_cvt_pk_bf16_f32 v250, v242, v248
v_lshlrev_b32 v242, 16, v251
v_and_b32 v248, 0xffff0000, v251
v_mul_f32 v242, v242, v236
v_mul_f32 v248, v248, v236
v_cvt_pk_bf16_f32 v251, v242, v248
ds_write_b64 v231, v[250:251] offset:8
s_waitcnt lgkmcnt(0)
ds_read_b64 v[250:251], v231 offset:4096
s_waitcnt lgkmcnt(0)
v_lshlrev_b32 v242, 16, v250
v_and_b32 v248, 0xffff0000, v250
v_mul_f32 v242, v242, v236
v_mul_f32 v248, v248, v236
v_cvt_pk_bf16_f32 v250, v242, v248
v_lshlrev_b32 v242, 16, v251
v_and_b32 v248, 0xffff0000, v251
v_mul_f32 v242, v242, v236
v_mul_f32 v248, v248, v236
v_cvt_pk_bf16_f32 v251, v242, v248
ds_write_b64 v231, v[250:251] offset:4096
s_waitcnt lgkmcnt(0)
ds_read_b64 v[250:251], v231 offset:4104
s_waitcnt lgkmcnt(0)
v_lshlrev_b32 v242, 16, v250
v_and_b32 v248, 0xffff0000, v250
v_mul_f32 v242, v242, v236
v_mul_f32 v248, v248, v236
v_cvt_pk_bf16_f32 v250, v242, v248
v_lshlrev_b32 v242, 16, v251
v_and_b32 v248, 0xffff0000, v251
v_mul_f32 v242, v242, v236
v_mul_f32 v248, v248, v236
v_cvt_pk_bf16_f32 v251, v242, v248
ds_write_b64 v231, v[250:251] offset:4104
s_waitcnt lgkmcnt(0)
v_exp_f32 v232, v128
v_exp_f32 v233, v129
v_exp_f32 v234, v130
v_exp_f32 v235, v131
s_nop 1
v_cvt_pk_bf16_f32 v160, v232, v233
v_cvt_pk_bf16_f32 v161, v234, v235
v_max_f32 v204, v132, v133
v_max3_f32 v204, v204, v134, v135
v_mov_b32 v205, v204
s_nop 1
v_permlane32_swap_b32 v204, v205
s_nop 1
v_max_f32 v204, v204, v205
v_mov_b32 v205, v204
s_nop 1
v_permlane16_swap_b32 v204, v205
s_nop 1
v_max_f32 v204, v204, v205
v_add_f32 v204, 40.0, v204
v_ceil_f32 v204, v204
v_max_f32 v204, 0, v204
v_sub_f32 v205, v225, v204
v_cvt_pk_bf16_f32 v205, v205, v205
v_and_b32 v205, 0xffff0000, v205
v_sub_f32 v204, v205, v225
v_mov_b32 v225, v205
v_exp_f32 v237, v204
v_bfi_b32 v35, v206, v205, v35
v_add_f32 v132, v132, v204
v_add_f32 v133, v133, v204
v_add_f32 v134, v134, v204
v_add_f32 v135, v135, v204
v_add_f32 v148, v148, v204
v_add_f32 v149, v149, v204
v_add_f32 v150, v150, v204
v_add_f32 v151, v151, v204
v_lshlrev_b32 v242, 16, v180
v_and_b32 v248, 0xffff0000, v180
v_mul_f32 v242, v242, v237
v_mul_f32 v248, v248, v237
v_cvt_pk_bf16_f32 v180, v242, v248
v_lshlrev_b32 v242, 16, v181
v_and_b32 v248, 0xffff0000, v181
v_mul_f32 v242, v242, v237
v_mul_f32 v248, v248, v237
v_cvt_pk_bf16_f32 v181, v242, v248
v_lshlrev_b32 v242, 16, v182
v_and_b32 v248, 0xffff0000, v182
v_mul_f32 v242, v242, v237
v_mul_f32 v248, v248, v237
v_cvt_pk_bf16_f32 v182, v242, v248
v_lshlrev_b32 v242, 16, v183
v_and_b32 v248, 0xffff0000, v183
v_mul_f32 v242, v242, v237
v_mul_f32 v248, v248, v237
v_cvt_pk_bf16_f32 v183, v242, v248
ds_read_b64 v[250:251], v231 offset:1024
s_waitcnt lgkmcnt(0)
v_lshlrev_b32 v242, 16, v250
v_and_b32 v248, 0xffff0000, v250
v_mul_f32 v242, v242, v237
v_mul_f32 v248, v248, v237
v_cvt_pk_bf16_f32 v250, v242, v248
v_lshlrev_b32 v242, 16, v251
v_and_b32 v248, 0xffff0000, v251
v_mul_f32 v242, v242, v237
v_mul_f32 v248, v248, v237
v_cvt_pk_bf16_f32 v251, v242, v248
ds_write_b64 v231, v[250:251] offset:1024
s_waitcnt lgkmcnt(0)
ds_read_b64 v[250:251], v231 offset:1032
s_waitcnt lgkmcnt(0)
v_lshlrev_b32 v242, 16, v250
v_and_b32 v248, 0xffff0000, v250
v_mul_f32 v242, v242, v237
v_mul_f32 v248, v248, v237
v_cvt_pk_bf16_f32 v250, v242, v248
v_lshlrev_b32 v242, 16, v251
v_and_b32 v248, 0xffff0000, v251
v_mul_f32 v242, v242, v237
v_mul_f32 v248, v248, v237
v_cvt_pk_bf16_f32 v251, v242, v248
ds_write_b64 v231, v[250:251] offset:1032
s_waitcnt lgkmcnt(0)
ds_read_b64 v[250:251], v231 offset:5120
s_waitcnt lgkmcnt(0)
v_lshlrev_b32 v242, 16, v250
v_and_b32 v248, 0xffff0000, v250
v_mul_f32 v242, v242, v237
v_mul_f32 v248, v248, v237
v_cvt_pk_bf16_f32 v250, v242, v248
v_lshlrev_b32 v242, 16, v251
v_and_b32 v248, 0xffff0000, v251
v_mul_f32 v242, v242, v237
v_mul_f32 v248, v248, v237
v_cvt_pk_bf16_f32 v251, v242, v248
ds_write_b64 v231, v[250:251] offset:5120
s_waitcnt lgkmcnt(0)
ds_read_b64 v[250:251], v231 offset:5128
s_waitcnt lgkmcnt(0)
v_lshlrev_b32 v242, 16, v250
v_and_b32 v248, 0xffff0000, v250
v_mul_f32 v242, v242, v237
v_mul_f32 v248, v248, v237
v_cvt_pk_bf16_f32 v250, v242, v248
v_lshlrev_b32 v242, 16, v251
v_and_b32 v248, 0xffff0000, v251
v_mul_f32 v242, v242, v237
v_mul_f32 v248, v248, v237
v_cvt_pk_bf16_f32 v251, v242, v248
ds_write_b64 v231, v[250:251] offset:5128
s_waitcnt lgkmcnt(0)
v_exp_f32 v232, v132
v_exp_f32 v233, v133
v_exp_f32 v234, v134
v_exp_f32 v235, v135
s_nop 1
v_cvt_pk_bf16_f32 v164, v232, v233
v_cvt_pk_bf16_f32 v165, v234, v235
v_max_f32 v204, v136, v137
v_max3_f32 v204, v204, v138, v139
v_mov_b32 v205, v204
s_nop 1
v_permlane32_swap_b32 v204, v205
s_nop 1
v_max_f32 v204, v204, v205
v_mov_b32 v205, v204
s_nop 1
v_permlane16_swap_b32 v204, v205
s_nop 1
v_max_f32 v204, v204, v205
v_add_f32 v204, 40.0, v204
v_ceil_f32 v204, v204
v_max_f32 v204, 0, v204
v_sub_f32 v205, v226, v204
v_cvt_pk_bf16_f32 v205, v205, v205
v_and_b32 v205, 0xffff0000, v205
v_sub_f32 v204, v205, v226
v_mov_b32 v226, v205
v_exp_f32 v238, v204
v_bfi_b32 v67, v206, v205, v67
v_add_f32 v136, v136, v204
v_add_f32 v137, v137, v204
v_add_f32 v138, v138, v204
v_add_f32 v139, v139, v204
v_add_f32 v152, v152, v204
v_add_f32 v153, v153, v204
v_add_f32 v154, v154, v204
v_add_f32 v155, v155, v204
v_lshlrev_b32 v242, 16, v184
v_and_b32 v248, 0xffff0000, v184
v_mul_f32 v242, v242, v238
v_mul_f32 v248, v248, v238
v_cvt_pk_bf16_f32 v184, v242, v248
v_lshlrev_b32 v242, 16, v185
v_and_b32 v248, 0xffff0000, v185
v_mul_f32 v242, v242, v238
v_mul_f32 v248, v248, v238
v_cvt_pk_bf16_f32 v185, v242, v248
v_lshlrev_b32 v242, 16, v186
v_and_b32 v248, 0xffff0000, v186
v_mul_f32 v242, v242, v238
v_mul_f32 v248, v248, v238
v_cvt_pk_bf16_f32 v186, v242, v248
v_lshlrev_b32 v242, 16, v187
v_and_b32 v248, 0xffff0000, v187
v_mul_f32 v242, v242, v238
v_mul_f32 v248, v248, v238
v_cvt_pk_bf16_f32 v187, v242, v248
ds_read_b64 v[250:251], v231 offset:2048
s_waitcnt lgkmcnt(0)
v_lshlrev_b32 v242, 16, v250
v_and_b32 v248, 0xffff0000, v250
v_mul_f32 v242, v242, v238
v_mul_f32 v248, v248, v238
v_cvt_pk_bf16_f32 v250, v242, v248
v_lshlrev_b32 v242, 16, v251
v_and_b32 v248, 0xffff0000, v251
v_mul_f32 v242, v242, v238
v_mul_f32 v248, v248, v238
v_cvt_pk_bf16_f32 v251, v242, v248
ds_write_b64 v231, v[250:251] offset:2048
s_waitcnt lgkmcnt(0)
ds_read_b64 v[250:251], v231 offset:2056
s_waitcnt lgkmcnt(0)
v_lshlrev_b32 v242, 16, v250
v_and_b32 v248, 0xffff0000, v250
v_mul_f32 v242, v242, v238
v_mul_f32 v248, v248, v238
v_cvt_pk_bf16_f32 v250, v242, v248
v_lshlrev_b32 v242, 16, v251
v_and_b32 v248, 0xffff0000, v251
v_mul_f32 v242, v242, v238
v_mul_f32 v248, v248, v238
v_cvt_pk_bf16_f32 v251, v242, v248
ds_write_b64 v231, v[250:251] offset:2056
s_waitcnt lgkmcnt(0)
ds_read_b64 v[250:251], v231 offset:6144
s_waitcnt lgkmcnt(0)
v_lshlrev_b32 v242, 16, v250
v_and_b32 v248, 0xffff0000, v250
v_mul_f32 v242, v242, v238
v_mul_f32 v248, v248, v238
v_cvt_pk_bf16_f32 v250, v242, v248
v_lshlrev_b32 v242, 16, v251
v_and_b32 v248, 0xffff0000, v251
v_mul_f32 v242, v242, v238
v_mul_f32 v248, v248, v238
v_cvt_pk_bf16_f32 v251, v242, v248
ds_write_b64 v231, v[250:251] offset:6144
s_waitcnt lgkmcnt(0)
ds_read_b64 v[250:251], v231 offset:6152
s_waitcnt lgkmcnt(0)
v_lshlrev_b32 v242, 16, v250
v_and_b32 v248, 0xffff0000, v250
v_mul_f32 v242, v242, v238
v_mul_f32 v248, v248, v238
v_cvt_pk_bf16_f32 v250, v242, v248
v_lshlrev_b32 v242, 16, v251
v_and_b32 v248, 0xffff0000, v251
v_mul_f32 v242, v242, v238
v_mul_f32 v248, v248, v238
v_cvt_pk_bf16_f32 v251, v242, v248
ds_write_b64 v231, v[250:251] offset:6152
s_waitcnt lgkmcnt(0)
v_exp_f32 v232, v136
v_exp_f32 v233, v137
v_exp_f32 v234, v138
v_exp_f32 v235, v139
s_nop 1
v_cvt_pk_bf16_f32 v168, v232, v233
v_cvt_pk_bf16_f32 v169, v234, v235
v_max_f32 v204, v140, v141
v_max3_f32 v204, v204, v142, v143
v_mov_b32 v205, v204
s_nop 1
v_permlane32_swap_b32 v204, v205
s_nop 1
v_max_f32 v204, v204, v205
v_mov_b32 v205, v204
s_nop 1
v_permlane16_swap_b32 v204, v205
s_nop 1
v_max_f32 v204, v204, v205
v_add_f32 v204, 40.0, v204
v_ceil_f32 v204, v204
v_max_f32 v204, 0, v204
v_sub_f32 v205, v227, v204
v_cvt_pk_bf16_f32 v205, v205, v205
v_and_b32 v205, 0xffff0000, v205
v_sub_f32 v204, v205, v227
v_mov_b32 v227, v205
v_exp_f32 v239, v204
v_bfi_b32 v99, v206, v205, v99
v_add_f32 v140, v140, v204
v_add_f32 v141, v141, v204
v_add_f32 v142, v142, v204
v_add_f32 v143, v143, v204
v_add_f32 v156, v156, v204
v_add_f32 v157, v157, v204
v_add_f32 v158, v158, v204
v_add_f32 v159, v159, v204
v_lshlrev_b32 v242, 16, v188
v_and_b32 v248, 0xffff0000, v188
v_mul_f32 v242, v242, v239
v_mul_f32 v248, v248, v239
v_cvt_pk_bf16_f32 v188, v242, v248
v_lshlrev_b32 v242, 16, v189
v_and_b32 v248, 0xffff0000, v189
v_mul_f32 v242, v242, v239
v_mul_f32 v248, v248, v239
v_cvt_pk_bf16_f32 v189, v242, v248
v_lshlrev_b32 v242, 16, v190
v_and_b32 v248, 0xffff0000, v190
v_mul_f32 v242, v242, v239
v_mul_f32 v248, v248, v239
v_cvt_pk_bf16_f32 v190, v242, v248
v_lshlrev_b32 v242, 16, v191
v_and_b32 v248, 0xffff0000, v191
v_mul_f32 v242, v242, v239
v_mul_f32 v248, v248, v239
v_cvt_pk_bf16_f32 v191, v242, v248
ds_read_b64 v[250:251], v231 offset:3072
s_waitcnt lgkmcnt(0)
v_lshlrev_b32 v242, 16, v250
v_and_b32 v248, 0xffff0000, v250
v_mul_f32 v242, v242, v239
v_mul_f32 v248, v248, v239
v_cvt_pk_bf16_f32 v250, v242, v248
v_lshlrev_b32 v242, 16, v251
v_and_b32 v248, 0xffff0000, v251
v_mul_f32 v242, v242, v239
v_mul_f32 v248, v248, v239
v_cvt_pk_bf16_f32 v251, v242, v248
ds_write_b64 v231, v[250:251] offset:3072
s_waitcnt lgkmcnt(0)
ds_read_b64 v[250:251], v231 offset:3080
s_waitcnt lgkmcnt(0)
v_lshlrev_b32 v242, 16, v250
v_and_b32 v248, 0xffff0000, v250
v_mul_f32 v242, v242, v239
v_mul_f32 v248, v248, v239
v_cvt_pk_bf16_f32 v250, v242, v248
v_lshlrev_b32 v242, 16, v251
v_and_b32 v248, 0xffff0000, v251
v_mul_f32 v242, v242, v239
v_mul_f32 v248, v248, v239
v_cvt_pk_bf16_f32 v251, v242, v248
ds_write_b64 v231, v[250:251] offset:3080
s_waitcnt lgkmcnt(0)
ds_read_b64 v[250:251], v231 offset:7168
s_waitcnt lgkmcnt(0)
v_lshlrev_b32 v242, 16, v250
v_and_b32 v248, 0xffff0000, v250
v_mul_f32 v242, v242, v239
v_mul_f32 v248, v248, v239
v_cvt_pk_bf16_f32 v250, v242, v248
v_lshlrev_b32 v242, 16, v251
v_and_b32 v248, 0xffff0000, v251
v_mul_f32 v242, v242, v239
v_mul_f32 v248, v248, v239
v_cvt_pk_bf16_f32 v251, v242, v248
ds_write_b64 v231, v[250:251] offset:7168
s_waitcnt lgkmcnt(0)
ds_read_b64 v[250:251], v231 offset:7176
s_waitcnt lgkmcnt(0)
v_lshlrev_b32 v242, 16, v250
v_and_b32 v248, 0xffff0000, v250
v_mul_f32 v242, v242, v239
v_mul_f32 v248, v248, v239
v_cvt_pk_bf16_f32 v250, v242, v248
v_lshlrev_b32 v242, 16, v251
v_and_b32 v248, 0xffff0000, v251
v_mul_f32 v242, v242, v239
v_mul_f32 v248, v248, v239
v_cvt_pk_bf16_f32 v251, v242, v248
ds_write_b64 v231, v[250:251] offset:7176
s_waitcnt lgkmcnt(0)
v_exp_f32 v232, v140
v_exp_f32 v233, v141
v_exp_f32 v234, v142
v_exp_f32 v235, v143
s_nop 1
v_cvt_pk_bf16_f32 v172, v232, v233
v_cvt_pk_bf16_f32 v173, v234, v235
s_branch L2_rare_common
L2_rare_site9:
s_mov_b32 s36, 9
s_branch L2_rare_t1_3
L2_rare_t1_3:
s_nop 15
s_nop 15
s_waitcnt lgkmcnt(0)
v_lshrrev_b32 v206, 8, v243
v_add_u32 v206, 1, v206
v_lshrrev_b32 v206, 2, v206
v_sub_u32 v206, 0, v206
v_and_b32 v206, 0xffff0000, v206
v_max_f32 v204, v144, v145
v_max3_f32 v204, v204, v146, v147
v_mov_b32 v205, v204
s_nop 1
v_permlane32_swap_b32 v204, v205
s_nop 1
v_max_f32 v204, v204, v205
v_mov_b32 v205, v204
s_nop 1
v_permlane16_swap_b32 v204, v205
s_nop 1
v_max_f32 v204, v204, v205
v_add_f32 v204, 40.0, v204
v_ceil_f32 v204, v204
v_max_f32 v204, 0, v204
v_sub_f32 v205, v224, v204
v_cvt_pk_bf16_f32 v205, v205, v205
v_and_b32 v205, 0xffff0000, v205
v_sub_f32 v204, v205, v224
v_mov_b32 v224, v205
v_exp_f32 v236, v204
v_bfi_b32 v3, v206, v205, v3
v_add_f32 v144, v144, v204
v_add_f32 v145, v145, v204
v_add_f32 v146, v146, v204
v_add_f32 v147, v147, v204
v_add_f32 v128, v128, v204
v_add_f32 v129, v129, v204
v_add_f32 v130, v130, v204
v_add_f32 v131, v131, v204
v_lshlrev_b32 v242, 16, v176
v_and_b32 v248, 0xffff0000, v176
v_mul_f32 v242, v242, v236
v_mul_f32 v248, v248, v236
v_cvt_pk_bf16_f32 v176, v242, v248
v_lshlrev_b32 v242, 16, v177
v_and_b32 v248, 0xffff0000, v177
v_mul_f32 v242, v242, v236
v_mul_f32 v248, v248, v236
v_cvt_pk_bf16_f32 v177, v242, v248
v_lshlrev_b32 v242, 16, v178
v_and_b32 v248, 0xffff0000, v178
v_mul_f32 v242, v242, v236
v_mul_f32 v248, v248, v236
v_cvt_pk_bf16_f32 v178, v242, v248
v_lshlrev_b32 v242, 16, v179
v_and_b32 v248, 0xffff0000, v179
v_mul_f32 v242, v242, v236
v_mul_f32 v248, v248, v236
v_cvt_pk_bf16_f32 v179, v242, v248
v_lshlrev_b32 v242, 16, v160
v_and_b32 v248, 0xffff0000, v160
v_mul_f32 v242, v242, v236
v_mul_f32 v248, v248, v236
v_cvt_pk_bf16_f32 v160, v242, v248
v_lshlrev_b32 v242, 16, v161
v_and_b32 v248, 0xffff0000, v161
v_mul_f32 v242, v242, v236
v_mul_f32 v248, v248, v236
v_cvt_pk_bf16_f32 v161, v242, v248
ds_read_b64 v[250:251], v231 offset:0
s_waitcnt lgkmcnt(0)
v_lshlrev_b32 v242, 16, v250
v_and_b32 v248, 0xffff0000, v250
v_mul_f32 v242, v242, v236
v_mul_f32 v248, v248, v236
v_cvt_pk_bf16_f32 v250, v242, v248
v_lshlrev_b32 v242, 16, v251
v_and_b32 v248, 0xffff0000, v251
v_mul_f32 v242, v242, v236
v_mul_f32 v248, v248, v236
v_cvt_pk_bf16_f32 v251, v242, v248
ds_write_b64 v231, v[250:251] offset:0
s_waitcnt lgkmcnt(0)
ds_read_b64 v[250:251], v231 offset:8
s_waitcnt lgkmcnt(0)
v_lshlrev_b32 v242, 16, v250
v_and_b32 v248, 0xffff0000, v250
v_mul_f32 v242, v242, v236
v_mul_f32 v248, v248, v236
v_cvt_pk_bf16_f32 v250, v242, v248
v_lshlrev_b32 v242, 16, v251
v_and_b32 v248, 0xffff0000, v251
v_mul_f32 v242, v242, v236
v_mul_f32 v248, v248, v236
v_cvt_pk_bf16_f32 v251, v242, v248
ds_write_b64 v231, v[250:251] offset:8
s_waitcnt lgkmcnt(0)
ds_read_b64 v[250:251], v231 offset:4096
s_waitcnt lgkmcnt(0)
v_lshlrev_b32 v242, 16, v250
v_and_b32 v248, 0xffff0000, v250
v_mul_f32 v242, v242, v236
v_mul_f32 v248, v248, v236
v_cvt_pk_bf16_f32 v250, v242, v248
v_lshlrev_b32 v242, 16, v251
v_and_b32 v248, 0xffff0000, v251
v_mul_f32 v242, v242, v236
v_mul_f32 v248, v248, v236
v_cvt_pk_bf16_f32 v251, v242, v248
ds_write_b64 v231, v[250:251] offset:4096
s_waitcnt lgkmcnt(0)
ds_read_b64 v[250:251], v231 offset:4104
s_waitcnt lgkmcnt(0)
v_lshlrev_b32 v242, 16, v250
v_and_b32 v248, 0xffff0000, v250
v_mul_f32 v242, v242, v236
v_mul_f32 v248, v248, v236
v_cvt_pk_bf16_f32 v250, v242, v248
v_lshlrev_b32 v242, 16, v251
v_and_b32 v248, 0xffff0000, v251
v_mul_f32 v242, v242, v236
v_mul_f32 v248, v248, v236
v_cvt_pk_bf16_f32 v251, v242, v248
ds_write_b64 v231, v[250:251] offset:4104
s_waitcnt lgkmcnt(0)
v_exp_f32 v232, v144
v_exp_f32 v233, v145
v_exp_f32 v234, v146
v_exp_f32 v235, v147
s_nop 1
v_cvt_pk_bf16_f32 v162, v232, v233
v_cvt_pk_bf16_f32 v163, v234, v235
v_max_f32 v204, v148, v149
v_max3_f32 v204, v204, v150, v151
v_mov_b32 v205, v204
s_nop 1
v_permlane32_swap_b32 v204, v205
s_nop 1
v_max_f32 v204, v204, v205
v_mov_b32 v205, v204
s_nop 1
v_permlane16_swap_b32 v204, v205
s_nop 1
v_max_f32 v204, v204, v205
v_add_f32 v204, 40.0, v204
v_ceil_f32 v204, v204
v_max_f32 v204, 0, v204
v_sub_f32 v205, v225, v204
v_cvt_pk_bf16_f32 v205, v205, v205
v_and_b32 v205, 0xffff0000, v205
v_sub_f32 v204, v205, v225
v_mov_b32 v225, v205
v_exp_f32 v237, v204
v_bfi_b32 v35, v206, v205, v35
v_add_f32 v148, v148, v204
v_add_f32 v149, v149, v204
v_add_f32 v150, v150, v204
v_add_f32 v151, v151, v204
v_add_f32 v132, v132, v204
v_add_f32 v133, v133, v204
v_add_f32 v134, v134, v204
v_add_f32 v135, v135, v204
v_lshlrev_b32 v242, 16, v180
v_and_b32 v248, 0xffff0000, v180
v_mul_f32 v242, v242, v237
v_mul_f32 v248, v248, v237
v_cvt_pk_bf16_f32 v180, v242, v248
v_lshlrev_b32 v242, 16, v181
v_and_b32 v248, 0xffff0000, v181
v_mul_f32 v242, v242, v237
v_mul_f32 v248, v248, v237
v_cvt_pk_bf16_f32 v181, v242, v248
v_lshlrev_b32 v242, 16, v182
v_and_b32 v248, 0xffff0000, v182
v_mul_f32 v242, v242, v237
v_mul_f32 v248, v248, v237
v_cvt_pk_bf16_f32 v182, v242, v248
v_lshlrev_b32 v242, 16, v183
v_and_b32 v248, 0xffff0000, v183
v_mul_f32 v242, v242, v237
v_mul_f32 v248, v248, v237
v_cvt_pk_bf16_f32 v183, v242, v248
v_lshlrev_b32 v242, 16, v164
v_and_b32 v248, 0xffff0000, v164
v_mul_f32 v242, v242, v237
v_mul_f32 v248, v248, v237
v_cvt_pk_bf16_f32 v164, v242, v248
v_lshlrev_b32 v242, 16, v165
v_and_b32 v248, 0xffff0000, v165
v_mul_f32 v242, v242, v237
v_mul_f32 v248, v248, v237
v_cvt_pk_bf16_f32 v165, v242, v248
ds_read_b64 v[250:251], v231 offset:1024
s_waitcnt lgkmcnt(0)
v_lshlrev_b32 v242, 16, v250
v_and_b32 v248, 0xffff0000, v250
v_mul_f32 v242, v242, v237
v_mul_f32 v248, v248, v237
v_cvt_pk_bf16_f32 v250, v242, v248
v_lshlrev_b32 v242, 16, v251
v_and_b32 v248, 0xffff0000, v251
v_mul_f32 v242, v242, v237
v_mul_f32 v248, v248, v237
v_cvt_pk_bf16_f32 v251, v242, v248
ds_write_b64 v231, v[250:251] offset:1024
s_waitcnt lgkmcnt(0)
ds_read_b64 v[250:251], v231 offset:1032
s_waitcnt lgkmcnt(0)
v_lshlrev_b32 v242, 16, v250
v_and_b32 v248, 0xffff0000, v250
v_mul_f32 v242, v242, v237
v_mul_f32 v248, v248, v237
v_cvt_pk_bf16_f32 v250, v242, v248
v_lshlrev_b32 v242, 16, v251
v_and_b32 v248, 0xffff0000, v251
v_mul_f32 v242, v242, v237
v_mul_f32 v248, v248, v237
v_cvt_pk_bf16_f32 v251, v242, v248
ds_write_b64 v231, v[250:251] offset:1032
s_waitcnt lgkmcnt(0)
ds_read_b64 v[250:251], v231 offset:5120
s_waitcnt lgkmcnt(0)
v_lshlrev_b32 v242, 16, v250
v_and_b32 v248, 0xffff0000, v250
v_mul_f32 v242, v242, v237
v_mul_f32 v248, v248, v237
v_cvt_pk_bf16_f32 v250, v242, v248
v_lshlrev_b32 v242, 16, v251
v_and_b32 v248, 0xffff0000, v251
v_mul_f32 v242, v242, v237
v_mul_f32 v248, v248, v237
v_cvt_pk_bf16_f32 v251, v242, v248
ds_write_b64 v231, v[250:251] offset:5120
s_waitcnt lgkmcnt(0)
ds_read_b64 v[250:251], v231 offset:5128
s_waitcnt lgkmcnt(0)
v_lshlrev_b32 v242, 16, v250
v_and_b32 v248, 0xffff0000, v250
v_mul_f32 v242, v242, v237
v_mul_f32 v248, v248, v237
v_cvt_pk_bf16_f32 v250, v242, v248
v_lshlrev_b32 v242, 16, v251
v_and_b32 v248, 0xffff0000, v251
v_mul_f32 v242, v242, v237
v_mul_f32 v248, v248, v237
v_cvt_pk_bf16_f32 v251, v242, v248
ds_write_b64 v231, v[250:251] offset:5128
s_waitcnt lgkmcnt(0)
v_exp_f32 v232, v148
v_exp_f32 v233, v149
v_exp_f32 v234, v150
v_exp_f32 v235, v151
s_nop 1
v_cvt_pk_bf16_f32 v166, v232, v233
v_cvt_pk_bf16_f32 v167, v234, v235
v_max_f32 v204, v152, v153
v_max3_f32 v204, v204, v154, v155
v_mov_b32 v205, v204
s_nop 1
v_permlane32_swap_b32 v204, v205
s_nop 1
v_max_f32 v204, v204, v205
v_mov_b32 v205, v204
s_nop 1
v_permlane16_swap_b32 v204, v205
s_nop 1
v_max_f32 v204, v204, v205
v_add_f32 v204, 40.0, v204
v_ceil_f32 v204, v204
v_max_f32 v204, 0, v204
v_sub_f32 v205, v226, v204
v_cvt_pk_bf16_f32 v205, v205, v205
v_and_b32 v205, 0xffff0000, v205
v_sub_f32 v204, v205, v226
v_mov_b32 v226, v205
v_exp_f32 v238, v204
v_bfi_b32 v67, v206, v205, v67
v_add_f32 v152, v152, v204
v_add_f32 v153, v153, v204
v_add_f32 v154, v154, v204
v_add_f32 v155, v155, v204
v_add_f32 v136, v136, v204
v_add_f32 v137, v137, v204
v_add_f32 v138, v138, v204
v_add_f32 v139, v139, v204
v_lshlrev_b32 v242, 16, v184
v_and_b32 v248, 0xffff0000, v184
v_mul_f32 v242, v242, v238
v_mul_f32 v248, v248, v238
v_cvt_pk_bf16_f32 v184, v242, v248
v_lshlrev_b32 v242, 16, v185
v_and_b32 v248, 0xffff0000, v185
v_mul_f32 v242, v242, v238
v_mul_f32 v248, v248, v238
v_cvt_pk_bf16_f32 v185, v242, v248
v_lshlrev_b32 v242, 16, v186
v_and_b32 v248, 0xffff0000, v186
v_mul_f32 v242, v242, v238
v_mul_f32 v248, v248, v238
v_cvt_pk_bf16_f32 v186, v242, v248
v_lshlrev_b32 v242, 16, v187
v_and_b32 v248, 0xffff0000, v187
v_mul_f32 v242, v242, v238
v_mul_f32 v248, v248, v238
v_cvt_pk_bf16_f32 v187, v242, v248
v_lshlrev_b32 v242, 16, v168
v_and_b32 v248, 0xffff0000, v168
v_mul_f32 v242, v242, v238
v_mul_f32 v248, v248, v238
v_cvt_pk_bf16_f32 v168, v242, v248
v_lshlrev_b32 v242, 16, v169
v_and_b32 v248, 0xffff0000, v169
v_mul_f32 v242, v242, v238
v_mul_f32 v248, v248, v238
v_cvt_pk_bf16_f32 v169, v242, v248
ds_read_b64 v[250:251], v231 offset:2048
s_waitcnt lgkmcnt(0)
v_lshlrev_b32 v242, 16, v250
v_and_b32 v248, 0xffff0000, v250
v_mul_f32 v242, v242, v238
v_mul_f32 v248, v248, v238
v_cvt_pk_bf16_f32 v250, v242, v248
v_lshlrev_b32 v242, 16, v251
v_and_b32 v248, 0xffff0000, v251
v_mul_f32 v242, v242, v238
v_mul_f32 v248, v248, v238
v_cvt_pk_bf16_f32 v251, v242, v248
ds_write_b64 v231, v[250:251] offset:2048
s_waitcnt lgkmcnt(0)
ds_read_b64 v[250:251], v231 offset:2056
s_waitcnt lgkmcnt(0)
v_lshlrev_b32 v242, 16, v250
v_and_b32 v248, 0xffff0000, v250
v_mul_f32 v242, v242, v238
v_mul_f32 v248, v248, v238
v_cvt_pk_bf16_f32 v250, v242, v248
v_lshlrev_b32 v242, 16, v251
v_and_b32 v248, 0xffff0000, v251
v_mul_f32 v242, v242, v238
v_mul_f32 v248, v248, v238
v_cvt_pk_bf16_f32 v251, v242, v248
ds_write_b64 v231, v[250:251] offset:2056
s_waitcnt lgkmcnt(0)
ds_read_b64 v[250:251], v231 offset:6144
s_waitcnt lgkmcnt(0)
v_lshlrev_b32 v242, 16, v250
v_and_b32 v248, 0xffff0000, v250
v_mul_f32 v242, v242, v238
v_mul_f32 v248, v248, v238
v_cvt_pk_bf16_f32 v250, v242, v248
v_lshlrev_b32 v242, 16, v251
v_and_b32 v248, 0xffff0000, v251
v_mul_f32 v242, v242, v238
v_mul_f32 v248, v248, v238
v_cvt_pk_bf16_f32 v251, v242, v248
ds_write_b64 v231, v[250:251] offset:6144
s_waitcnt lgkmcnt(0)
ds_read_b64 v[250:251], v231 offset:6152
s_waitcnt lgkmcnt(0)
v_lshlrev_b32 v242, 16, v250
v_and_b32 v248, 0xffff0000, v250
v_mul_f32 v242, v242, v238
v_mul_f32 v248, v248, v238
v_cvt_pk_bf16_f32 v250, v242, v248
v_lshlrev_b32 v242, 16, v251
v_and_b32 v248, 0xffff0000, v251
v_mul_f32 v242, v242, v238
v_mul_f32 v248, v248, v238
v_cvt_pk_bf16_f32 v251, v242, v248
ds_write_b64 v231, v[250:251] offset:6152
s_waitcnt lgkmcnt(0)
v_exp_f32 v232, v152
v_exp_f32 v233, v153
v_exp_f32 v234, v154
v_exp_f32 v235, v155
s_nop 1
v_cvt_pk_bf16_f32 v170, v232, v233
v_cvt_pk_bf16_f32 v171, v234, v235
v_max_f32 v204, v156, v157
v_max3_f32 v204, v204, v158, v159
v_mov_b32 v205, v204
s_nop 1
v_permlane32_swap_b32 v204, v205
s_nop 1
v_max_f32 v204, v204, v205
v_mov_b32 v205, v204
s_nop 1
v_permlane16_swap_b32 v204, v205
s_nop 1
v_max_f32 v204, v204, v205
v_add_f32 v204, 40.0, v204
v_ceil_f32 v204, v204
v_max_f32 v204, 0, v204
v_sub_f32 v205, v227, v204
v_cvt_pk_bf16_f32 v205, v205, v205
v_and_b32 v205, 0xffff0000, v205
v_sub_f32 v204, v205, v227
v_mov_b32 v227, v205
v_exp_f32 v239, v204
v_bfi_b32 v99, v206, v205, v99
v_add_f32 v156, v156, v204
v_add_f32 v157, v157, v204
v_add_f32 v158, v158, v204
v_add_f32 v159, v159, v204
v_add_f32 v140, v140, v204
v_add_f32 v141, v141, v204
v_add_f32 v142, v142, v204
v_add_f32 v143, v143, v204
v_lshlrev_b32 v242, 16, v188
v_and_b32 v248, 0xffff0000, v188
v_mul_f32 v242, v242, v239
v_mul_f32 v248, v248, v239
v_cvt_pk_bf16_f32 v188, v242, v248
v_lshlrev_b32 v242, 16, v189
v_and_b32 v248, 0xffff0000, v189
v_mul_f32 v242, v242, v239
v_mul_f32 v248, v248, v239
v_cvt_pk_bf16_f32 v189, v242, v248
v_lshlrev_b32 v242, 16, v190
v_and_b32 v248, 0xffff0000, v190
v_mul_f32 v242, v242, v239
v_mul_f32 v248, v248, v239
v_cvt_pk_bf16_f32 v190, v242, v248
v_lshlrev_b32 v242, 16, v191
v_and_b32 v248, 0xffff0000, v191
v_mul_f32 v242, v242, v239
v_mul_f32 v248, v248, v239
v_cvt_pk_bf16_f32 v191, v242, v248
v_lshlrev_b32 v242, 16, v172
v_and_b32 v248, 0xffff0000, v172
v_mul_f32 v242, v242, v239
v_mul_f32 v248, v248, v239
v_cvt_pk_bf16_f32 v172, v242, v248
v_lshlrev_b32 v242, 16, v173
v_and_b32 v248, 0xffff0000, v173
v_mul_f32 v242, v242, v239
v_mul_f32 v248, v248, v239
v_cvt_pk_bf16_f32 v173, v242, v248
ds_read_b64 v[250:251], v231 offset:3072
s_waitcnt lgkmcnt(0)
v_lshlrev_b32 v242, 16, v250
v_and_b32 v248, 0xffff0000, v250
v_mul_f32 v242, v242, v239
v_mul_f32 v248, v248, v239
v_cvt_pk_bf16_f32 v250, v242, v248
v_lshlrev_b32 v242, 16, v251
v_and_b32 v248, 0xffff0000, v251
v_mul_f32 v242, v242, v239
v_mul_f32 v248, v248, v239
v_cvt_pk_bf16_f32 v251, v242, v248
ds_write_b64 v231, v[250:251] offset:3072
s_waitcnt lgkmcnt(0)
ds_read_b64 v[250:251], v231 offset:3080
s_waitcnt lgkmcnt(0)
v_lshlrev_b32 v242, 16, v250
v_and_b32 v248, 0xffff0000, v250
v_mul_f32 v242, v242, v239
v_mul_f32 v248, v248, v239
v_cvt_pk_bf16_f32 v250, v242, v248
v_lshlrev_b32 v242, 16, v251
v_and_b32 v248, 0xffff0000, v251
v_mul_f32 v242, v242, v239
v_mul_f32 v248, v248, v239
v_cvt_pk_bf16_f32 v251, v242, v248
ds_write_b64 v231, v[250:251] offset:3080
s_waitcnt lgkmcnt(0)
ds_read_b64 v[250:251], v231 offset:7168
s_waitcnt lgkmcnt(0)
v_lshlrev_b32 v242, 16, v250
v_and_b32 v248, 0xffff0000, v250
v_mul_f32 v242, v242, v239
v_mul_f32 v248, v248, v239
v_cvt_pk_bf16_f32 v250, v242, v248
v_lshlrev_b32 v242, 16, v251
v_and_b32 v248, 0xffff0000, v251
v_mul_f32 v242, v242, v239
v_mul_f32 v248, v248, v239
v_cvt_pk_bf16_f32 v251, v242, v248
ds_write_b64 v231, v[250:251] offset:7168
s_waitcnt lgkmcnt(0)
ds_read_b64 v[250:251], v231 offset:7176
s_waitcnt lgkmcnt(0)
v_lshlrev_b32 v242, 16, v250
v_and_b32 v248, 0xffff0000, v250
v_mul_f32 v242, v242, v239
v_mul_f32 v248, v248, v239
v_cvt_pk_bf16_f32 v250, v242, v248
v_lshlrev_b32 v242, 16, v251
v_and_b32 v248, 0xffff0000, v251
v_mul_f32 v242, v242, v239
v_mul_f32 v248, v248, v239
v_cvt_pk_bf16_f32 v251, v242, v248
ds_write_b64 v231, v[250:251] offset:7176
s_waitcnt lgkmcnt(0)
v_exp_f32 v232, v156
v_exp_f32 v233, v157
v_exp_f32 v234, v158
v_exp_f32 v235, v159
s_nop 1
v_cvt_pk_bf16_f32 v174, v232, v233
v_cvt_pk_bf16_f32 v175, v234, v235
s_branch L2_rare_common
L2_rare_site10:
s_mov_b32 s36, 10
s_branch L2_rare_t1_4
L2_rare_t1_4:
s_nop 15
s_nop 15
s_waitcnt lgkmcnt(0)
v_lshrrev_b32 v206, 8, v243
v_add_u32 v206, 1, v206
v_lshrrev_b32 v206, 2, v206
v_sub_u32 v206, 0, v206
v_and_b32 v206, 0xffff0000, v206
v_max_f32 v204, v128, v129
v_max3_f32 v204, v204, v130, v131
v_mov_b32 v205, v204
s_nop 1
v_permlane32_swap_b32 v204, v205
s_nop 1
v_max_f32 v204, v204, v205
v_mov_b32 v205, v204
s_nop 1
v_permlane16_swap_b32 v204, v205
s_nop 1
v_max_f32 v204, v204, v205
v_add_f32 v204, 40.0, v204
v_ceil_f32 v204, v204
v_max_f32 v204, 0, v204
v_sub_f32 v205, v224, v204
v_cvt_pk_bf16_f32 v205, v205, v205
v_and_b32 v205, 0xffff0000, v205
v_sub_f32 v204, v205, v224
v_mov_b32 v224, v205
v_exp_f32 v236, v204
v_add_f32 v128, v128, v204
v_add_f32 v129, v129, v204
v_add_f32 v130, v130, v204
v_add_f32 v131, v131, v204
v_add_f32 v144, v144, v204
v_add_f32 v145, v145, v204
v_add_f32 v146, v146, v204
v_add_f32 v147, v147, v204
v_lshlrev_b32 v242, 16, v4
v_and_b32 v248, 0xffff0000, v4
v_mul_f32 v242, v242, v236
v_mul_f32 v248, v248, v236
v_cvt_pk_bf16_f32 v4, v242, v248
v_lshlrev_b32 v242, 16, v5
v_and_b32 v248, 0xffff0000, v5
v_mul_f32 v242, v242, v236
v_mul_f32 v248, v248, v236
v_cvt_pk_bf16_f32 v5, v242, v248
v_lshlrev_b32 v242, 16, v6
v_and_b32 v248, 0xffff0000, v6
v_mul_f32 v242, v242, v236
v_mul_f32 v248, v248, v236
v_cvt_pk_bf16_f32 v6, v242, v248
v_lshlrev_b32 v242, 16, v7
v_and_b32 v248, 0xffff0000, v7
v_mul_f32 v242, v242, v236
v_mul_f32 v248, v248, v236
v_cvt_pk_bf16_f32 v7, v242, v248
v_lshlrev_b32 v242, 16, v8
v_and_b32 v248, 0xffff0000, v8
v_mul_f32 v242, v242, v236
v_mul_f32 v248, v248, v236
v_cvt_pk_bf16_f32 v8, v242, v248
v_lshlrev_b32 v242, 16, v9
v_and_b32 v248, 0xffff0000, v9
v_mul_f32 v242, v242, v236
v_mul_f32 v248, v248, v236
v_cvt_pk_bf16_f32 v9, v242, v248
v_lshlrev_b32 v242, 16, v10
v_and_b32 v248, 0xffff0000, v10
v_mul_f32 v242, v242, v236
v_mul_f32 v248, v248, v236
v_cvt_pk_bf16_f32 v10, v242, v248
v_lshlrev_b32 v242, 16, v11
v_and_b32 v248, 0xffff0000, v11
v_mul_f32 v242, v242, v236
v_mul_f32 v248, v248, v236
v_cvt_pk_bf16_f32 v11, v242, v248
v_lshlrev_b32 v242, 16, v176
v_and_b32 v248, 0xffff0000, v176
v_mul_f32 v242, v242, v236
v_mul_f32 v248, v248, v236
v_cvt_pk_bf16_f32 v176, v242, v248
v_lshlrev_b32 v242, 16, v177
v_and_b32 v248, 0xffff0000, v177
v_mul_f32 v242, v242, v236
v_mul_f32 v248, v248, v236
v_cvt_pk_bf16_f32 v177, v242, v248
v_lshlrev_b32 v242, 16, v178
v_and_b32 v248, 0xffff0000, v178
v_mul_f32 v242, v242, v236
v_mul_f32 v248, v248, v236
v_cvt_pk_bf16_f32 v178, v242, v248
v_lshlrev_b32 v242, 16, v179
v_and_b32 v248, 0xffff0000, v179
v_mul_f32 v242, v242, v236
v_mul_f32 v248, v248, v236
v_cvt_pk_bf16_f32 v179, v242, v248
v_lshlrev_b32 v242, 16, v160
v_and_b32 v248, 0xffff0000, v160
v_mul_f32 v242, v242, v236
v_mul_f32 v248, v248, v236
v_cvt_pk_bf16_f32 v160, v242, v248
v_lshlrev_b32 v242, 16, v161
v_and_b32 v248, 0xffff0000, v161
v_mul_f32 v242, v242, v236
v_mul_f32 v248, v248, v236
v_cvt_pk_bf16_f32 v161, v242, v248
v_lshlrev_b32 v242, 16, v162
v_and_b32 v248, 0xffff0000, v162
v_mul_f32 v242, v242, v236
v_mul_f32 v248, v248, v236
v_cvt_pk_bf16_f32 v162, v242, v248
v_lshlrev_b32 v242, 16, v163
v_and_b32 v248, 0xffff0000, v163
v_mul_f32 v242, v242, v236
v_mul_f32 v248, v248, v236
v_cvt_pk_bf16_f32 v163, v242, v248
v_exp_f32 v232, v128
v_exp_f32 v233, v129
v_exp_f32 v234, v130
v_exp_f32 v235, v131
s_nop 1
v_cvt_pk_bf16_f32 v0, v232, v233
v_cvt_pk_bf16_f32 v1, v234, v235
v_max_f32 v204, v132, v133
v_max3_f32 v204, v204, v134, v135
v_mov_b32 v205, v204
s_nop 1
v_permlane32_swap_b32 v204, v205
s_nop 1
v_max_f32 v204, v204, v205
v_mov_b32 v205, v204
s_nop 1
v_permlane16_swap_b32 v204, v205
s_nop 1
v_max_f32 v204, v204, v205
v_add_f32 v204, 40.0, v204
v_ceil_f32 v204, v204
v_max_f32 v204, 0, v204
v_sub_f32 v205, v225, v204
v_cvt_pk_bf16_f32 v205, v205, v205
v_and_b32 v205, 0xffff0000, v205
v_sub_f32 v204, v205, v225
v_mov_b32 v225, v205
v_exp_f32 v237, v204
v_add_f32 v132, v132, v204
v_add_f32 v133, v133, v204
v_add_f32 v134, v134, v204
v_add_f32 v135, v135, v204
v_add_f32 v148, v148, v204
v_add_f32 v149, v149, v204
v_add_f32 v150, v150, v204
v_add_f32 v151, v151, v204
v_lshlrev_b32 v242, 16, v36
v_and_b32 v248, 0xffff0000, v36
v_mul_f32 v242, v242, v237
v_mul_f32 v248, v248, v237
v_cvt_pk_bf16_f32 v36, v242, v248
v_lshlrev_b32 v242, 16, v37
v_and_b32 v248, 0xffff0000, v37
v_mul_f32 v242, v242, v237
v_mul_f32 v248, v248, v237
v_cvt_pk_bf16_f32 v37, v242, v248
v_lshlrev_b32 v242, 16, v38
v_and_b32 v248, 0xffff0000, v38
v_mul_f32 v242, v242, v237
v_mul_f32 v248, v248, v237
v_cvt_pk_bf16_f32 v38, v242, v248
v_lshlrev_b32 v242, 16, v39
v_and_b32 v248, 0xffff0000, v39
v_mul_f32 v242, v242, v237
v_mul_f32 v248, v248, v237
v_cvt_pk_bf16_f32 v39, v242, v248
v_lshlrev_b32 v242, 16, v40
v_and_b32 v248, 0xffff0000, v40
v_mul_f32 v242, v242, v237
v_mul_f32 v248, v248, v237
v_cvt_pk_bf16_f32 v40, v242, v248
v_lshlrev_b32 v242, 16, v41
v_and_b32 v248, 0xffff0000, v41
v_mul_f32 v242, v242, v237
v_mul_f32 v248, v248, v237
v_cvt_pk_bf16_f32 v41, v242, v248
v_lshlrev_b32 v242, 16, v42
v_and_b32 v248, 0xffff0000, v42
v_mul_f32 v242, v242, v237
v_mul_f32 v248, v248, v237
v_cvt_pk_bf16_f32 v42, v242, v248
v_lshlrev_b32 v242, 16, v43
v_and_b32 v248, 0xffff0000, v43
v_mul_f32 v242, v242, v237
v_mul_f32 v248, v248, v237
v_cvt_pk_bf16_f32 v43, v242, v248
v_lshlrev_b32 v242, 16, v180
v_and_b32 v248, 0xffff0000, v180
v_mul_f32 v242, v242, v237
v_mul_f32 v248, v248, v237
v_cvt_pk_bf16_f32 v180, v242, v248
v_lshlrev_b32 v242, 16, v181
v_and_b32 v248, 0xffff0000, v181
v_mul_f32 v242, v242, v237
v_mul_f32 v248, v248, v237
v_cvt_pk_bf16_f32 v181, v242, v248
v_lshlrev_b32 v242, 16, v182
v_and_b32 v248, 0xffff0000, v182
v_mul_f32 v242, v242, v237
v_mul_f32 v248, v248, v237
v_cvt_pk_bf16_f32 v182, v242, v248
v_lshlrev_b32 v242, 16, v183
v_and_b32 v248, 0xffff0000, v183
v_mul_f32 v242, v242, v237
v_mul_f32 v248, v248, v237
v_cvt_pk_bf16_f32 v183, v242, v248
v_lshlrev_b32 v242, 16, v164
v_and_b32 v248, 0xffff0000, v164
v_mul_f32 v242, v242, v237
v_mul_f32 v248, v248, v237
v_cvt_pk_bf16_f32 v164, v242, v248
v_lshlrev_b32 v242, 16, v165
v_and_b32 v248, 0xffff0000, v165
v_mul_f32 v242, v242, v237
v_mul_f32 v248, v248, v237
v_cvt_pk_bf16_f32 v165, v242, v248
v_lshlrev_b32 v242, 16, v166
v_and_b32 v248, 0xffff0000, v166
v_mul_f32 v242, v242, v237
v_mul_f32 v248, v248, v237
v_cvt_pk_bf16_f32 v166, v242, v248
v_lshlrev_b32 v242, 16, v167
v_and_b32 v248, 0xffff0000, v167
v_mul_f32 v242, v242, v237
v_mul_f32 v248, v248, v237
v_cvt_pk_bf16_f32 v167, v242, v248
v_exp_f32 v232, v132
v_exp_f32 v233, v133
v_exp_f32 v234, v134
v_exp_f32 v235, v135
s_nop 1
v_cvt_pk_bf16_f32 v32, v232, v233
v_cvt_pk_bf16_f32 v33, v234, v235
v_max_f32 v204, v136, v137
v_max3_f32 v204, v204, v138, v139
v_mov_b32 v205, v204
s_nop 1
v_permlane32_swap_b32 v204, v205
s_nop 1
v_max_f32 v204, v204, v205
v_mov_b32 v205, v204
s_nop 1
v_permlane16_swap_b32 v204, v205
s_nop 1
v_max_f32 v204, v204, v205
v_add_f32 v204, 40.0, v204
v_ceil_f32 v204, v204
v_max_f32 v204, 0, v204
v_sub_f32 v205, v226, v204
v_cvt_pk_bf16_f32 v205, v205, v205
v_and_b32 v205, 0xffff0000, v205
v_sub_f32 v204, v205, v226
v_mov_b32 v226, v205
v_exp_f32 v238, v204
v_add_f32 v136, v136, v204
v_add_f32 v137, v137, v204
v_add_f32 v138, v138, v204
v_add_f32 v139, v139, v204
v_add_f32 v152, v152, v204
v_add_f32 v153, v153, v204
v_add_f32 v154, v154, v204
v_add_f32 v155, v155, v204
v_lshlrev_b32 v242, 16, v68
v_and_b32 v248, 0xffff0000, v68
v_mul_f32 v242, v242, v238
v_mul_f32 v248, v248, v238
v_cvt_pk_bf16_f32 v68, v242, v248
v_lshlrev_b32 v242, 16, v69
v_and_b32 v248, 0xffff0000, v69
v_mul_f32 v242, v242, v238
v_mul_f32 v248, v248, v238
v_cvt_pk_bf16_f32 v69, v242, v248
v_lshlrev_b32 v242, 16, v70
v_and_b32 v248, 0xffff0000, v70
v_mul_f32 v242, v242, v238
v_mul_f32 v248, v248, v238
v_cvt_pk_bf16_f32 v70, v242, v248
v_lshlrev_b32 v242, 16, v71
v_and_b32 v248, 0xffff0000, v71
v_mul_f32 v242, v242, v238
v_mul_f32 v248, v248, v238
v_cvt_pk_bf16_f32 v71, v242, v248
v_lshlrev_b32 v242, 16, v72
v_and_b32 v248, 0xffff0000, v72
v_mul_f32 v242, v242, v238
v_mul_f32 v248, v248, v238
v_cvt_pk_bf16_f32 v72, v242, v248
v_lshlrev_b32 v242, 16, v73
v_and_b32 v248, 0xffff0000, v73
v_mul_f32 v242, v242, v238
v_mul_f32 v248, v248, v238
v_cvt_pk_bf16_f32 v73, v242, v248
v_lshlrev_b32 v242, 16, v74
v_and_b32 v248, 0xffff0000, v74
v_mul_f32 v242, v242, v238
v_mul_f32 v248, v248, v238
v_cvt_pk_bf16_f32 v74, v242, v248
v_lshlrev_b32 v242, 16, v75
v_and_b32 v248, 0xffff0000, v75
v_mul_f32 v242, v242, v238
v_mul_f32 v248, v248, v238
v_cvt_pk_bf16_f32 v75, v242, v248
v_lshlrev_b32 v242, 16, v184
v_and_b32 v248, 0xffff0000, v184
v_mul_f32 v242, v242, v238
v_mul_f32 v248, v248, v238
v_cvt_pk_bf16_f32 v184, v242, v248
v_lshlrev_b32 v242, 16, v185
v_and_b32 v248, 0xffff0000, v185
v_mul_f32 v242, v242, v238
v_mul_f32 v248, v248, v238
v_cvt_pk_bf16_f32 v185, v242, v248
v_lshlrev_b32 v242, 16, v186
v_and_b32 v248, 0xffff0000, v186
v_mul_f32 v242, v242, v238
v_mul_f32 v248, v248, v238
v_cvt_pk_bf16_f32 v186, v242, v248
v_lshlrev_b32 v242, 16, v187
v_and_b32 v248, 0xffff0000, v187
v_mul_f32 v242, v242, v238
v_mul_f32 v248, v248, v238
v_cvt_pk_bf16_f32 v187, v242, v248
v_lshlrev_b32 v242, 16, v168
v_and_b32 v248, 0xffff0000, v168
v_mul_f32 v242, v242, v238
v_mul_f32 v248, v248, v238
v_cvt_pk_bf16_f32 v168, v242, v248
v_lshlrev_b32 v242, 16, v169
v_and_b32 v248, 0xffff0000, v169
v_mul_f32 v242, v242, v238
v_mul_f32 v248, v248, v238
v_cvt_pk_bf16_f32 v169, v242, v248
v_lshlrev_b32 v242, 16, v170
v_and_b32 v248, 0xffff0000, v170
v_mul_f32 v242, v242, v238
v_mul_f32 v248, v248, v238
v_cvt_pk_bf16_f32 v170, v242, v248
v_lshlrev_b32 v242, 16, v171
v_and_b32 v248, 0xffff0000, v171
v_mul_f32 v242, v242, v238
v_mul_f32 v248, v248, v238
v_cvt_pk_bf16_f32 v171, v242, v248
v_exp_f32 v232, v136
v_exp_f32 v233, v137
v_exp_f32 v234, v138
v_exp_f32 v235, v139
s_nop 1
v_cvt_pk_bf16_f32 v64, v232, v233
v_cvt_pk_bf16_f32 v65, v234, v235
v_max_f32 v204, v140, v141
v_max3_f32 v204, v204, v142, v143
v_mov_b32 v205, v204
s_nop 1
v_permlane32_swap_b32 v204, v205
s_nop 1
v_max_f32 v204, v204, v205
v_mov_b32 v205, v204
s_nop 1
v_permlane16_swap_b32 v204, v205
s_nop 1
v_max_f32 v204, v204, v205
v_add_f32 v204, 40.0, v204
v_ceil_f32 v204, v204
v_max_f32 v204, 0, v204
v_sub_f32 v205, v227, v204
v_cvt_pk_bf16_f32 v205, v205, v205
v_and_b32 v205, 0xffff0000, v205
v_sub_f32 v204, v205, v227
v_mov_b32 v227, v205
v_exp_f32 v239, v204
v_add_f32 v140, v140, v204
v_add_f32 v141, v141, v204
v_add_f32 v142, v142, v204
v_add_f32 v143, v143, v204
v_add_f32 v156, v156, v204
v_add_f32 v157, v157, v204
v_add_f32 v158, v158, v204
v_add_f32 v159, v159, v204
v_lshlrev_b32 v242, 16, v100
v_and_b32 v248, 0xffff0000, v100
v_mul_f32 v242, v242, v239
v_mul_f32 v248, v248, v239
v_cvt_pk_bf16_f32 v100, v242, v248
v_lshlrev_b32 v242, 16, v101
v_and_b32 v248, 0xffff0000, v101
v_mul_f32 v242, v242, v239
v_mul_f32 v248, v248, v239
v_cvt_pk_bf16_f32 v101, v242, v248
v_lshlrev_b32 v242, 16, v102
v_and_b32 v248, 0xffff0000, v102
v_mul_f32 v242, v242, v239
v_mul_f32 v248, v248, v239
v_cvt_pk_bf16_f32 v102, v242, v248
v_lshlrev_b32 v242, 16, v103
v_and_b32 v248, 0xffff0000, v103
v_mul_f32 v242, v242, v239
v_mul_f32 v248, v248, v239
v_cvt_pk_bf16_f32 v103, v242, v248
v_lshlrev_b32 v242, 16, v104
v_and_b32 v248, 0xffff0000, v104
v_mul_f32 v242, v242, v239
v_mul_f32 v248, v248, v239
v_cvt_pk_bf16_f32 v104, v242, v248
v_lshlrev_b32 v242, 16, v105
v_and_b32 v248, 0xffff0000, v105
v_mul_f32 v242, v242, v239
v_mul_f32 v248, v248, v239
v_cvt_pk_bf16_f32 v105, v242, v248
v_lshlrev_b32 v242, 16, v106
v_and_b32 v248, 0xffff0000, v106
v_mul_f32 v242, v242, v239
v_mul_f32 v248, v248, v239
v_cvt_pk_bf16_f32 v106, v242, v248
v_lshlrev_b32 v242, 16, v107
v_and_b32 v248, 0xffff0000, v107
v_mul_f32 v242, v242, v239
v_mul_f32 v248, v248, v239
v_cvt_pk_bf16_f32 v107, v242, v248
v_lshlrev_b32 v242, 16, v188
v_and_b32 v248, 0xffff0000, v188
v_mul_f32 v242, v242, v239
v_mul_f32 v248, v248, v239
v_cvt_pk_bf16_f32 v188, v242, v248
v_lshlrev_b32 v242, 16, v189
v_and_b32 v248, 0xffff0000, v189
v_mul_f32 v242, v242, v239
v_mul_f32 v248, v248, v239
v_cvt_pk_bf16_f32 v189, v242, v248
v_lshlrev_b32 v242, 16, v190
v_and_b32 v248, 0xffff0000, v190
v_mul_f32 v242, v242, v239
v_mul_f32 v248, v248, v239
v_cvt_pk_bf16_f32 v190, v242, v248
v_lshlrev_b32 v242, 16, v191
v_and_b32 v248, 0xffff0000, v191
v_mul_f32 v242, v242, v239
v_mul_f32 v248, v248, v239
v_cvt_pk_bf16_f32 v191, v242, v248
v_lshlrev_b32 v242, 16, v172
v_and_b32 v248, 0xffff0000, v172
v_mul_f32 v242, v242, v239
v_mul_f32 v248, v248, v239
v_cvt_pk_bf16_f32 v172, v242, v248
v_lshlrev_b32 v242, 16, v173
v_and_b32 v248, 0xffff0000, v173
v_mul_f32 v242, v242, v239
v_mul_f32 v248, v248, v239
v_cvt_pk_bf16_f32 v173, v242, v248
v_lshlrev_b32 v242, 16, v174
v_and_b32 v248, 0xffff0000, v174
v_mul_f32 v242, v242, v239
v_mul_f32 v248, v248, v239
v_cvt_pk_bf16_f32 v174, v242, v248
v_lshlrev_b32 v242, 16, v175
v_and_b32 v248, 0xffff0000, v175
v_mul_f32 v242, v242, v239
v_mul_f32 v248, v248, v239
v_cvt_pk_bf16_f32 v175, v242, v248
v_exp_f32 v232, v140
v_exp_f32 v233, v141
v_exp_f32 v234, v142
v_exp_f32 v235, v143
s_nop 1
v_cvt_pk_bf16_f32 v96, v232, v233
v_cvt_pk_bf16_f32 v97, v234, v235
s_branch L2_rare_common
L2_rare_site11:
s_mov_b32 s36, 11
s_branch L2_rare_t1_5
L2_rare_t1_5:
s_nop 15
s_nop 15
s_waitcnt lgkmcnt(0)
v_lshrrev_b32 v206, 8, v243
v_add_u32 v206, 1, v206
v_lshrrev_b32 v206, 2, v206
v_sub_u32 v206, 0, v206
v_and_b32 v206, 0xffff0000, v206
v_max_f32 v204, v144, v145
v_max3_f32 v204, v204, v146, v147
v_mov_b32 v205, v204
s_nop 1
v_permlane32_swap_b32 v204, v205
s_nop 1
v_max_f32 v204, v204, v205
v_mov_b32 v205, v204
s_nop 1
v_permlane16_swap_b32 v204, v205
s_nop 1
v_max_f32 v204, v204, v205
v_add_f32 v204, 40.0, v204
v_ceil_f32 v204, v204
v_max_f32 v204, 0, v204
v_sub_f32 v205, v224, v204
v_cvt_pk_bf16_f32 v205, v205, v205
v_and_b32 v205, 0xffff0000, v205
v_sub_f32 v204, v205, v224
v_mov_b32 v224, v205
v_exp_f32 v236, v204
v_add_f32 v144, v144, v204
v_add_f32 v145, v145, v204
v_add_f32 v146, v146, v204
v_add_f32 v147, v147, v204
v_add_f32 v128, v128, v204
v_add_f32 v129, v129, v204
v_add_f32 v130, v130, v204
v_add_f32 v131, v131, v204
v_lshlrev_b32 v242, 16, v4
v_and_b32 v248, 0xffff0000, v4
v_mul_f32 v242, v242, v236
v_mul_f32 v248, v248, v236
v_cvt_pk_bf16_f32 v4, v242, v248
v_lshlrev_b32 v242, 16, v5
v_and_b32 v248, 0xffff0000, v5
v_mul_f32 v242, v242, v236
v_mul_f32 v248, v248, v236
v_cvt_pk_bf16_f32 v5, v242, v248
v_lshlrev_b32 v242, 16, v6
v_and_b32 v248, 0xffff0000, v6
v_mul_f32 v242, v242, v236
v_mul_f32 v248, v248, v236
v_cvt_pk_bf16_f32 v6, v242, v248
v_lshlrev_b32 v242, 16, v7
v_and_b32 v248, 0xffff0000, v7
v_mul_f32 v242, v242, v236
v_mul_f32 v248, v248, v236
v_cvt_pk_bf16_f32 v7, v242, v248
v_lshlrev_b32 v242, 16, v8
v_and_b32 v248, 0xffff0000, v8
v_mul_f32 v242, v242, v236
v_mul_f32 v248, v248, v236
v_cvt_pk_bf16_f32 v8, v242, v248
v_lshlrev_b32 v242, 16, v9
v_and_b32 v248, 0xffff0000, v9
v_mul_f32 v242, v242, v236
v_mul_f32 v248, v248, v236
v_cvt_pk_bf16_f32 v9, v242, v248
v_lshlrev_b32 v242, 16, v10
v_and_b32 v248, 0xffff0000, v10
v_mul_f32 v242, v242, v236
v_mul_f32 v248, v248, v236
v_cvt_pk_bf16_f32 v10, v242, v248
v_lshlrev_b32 v242, 16, v11
v_and_b32 v248, 0xffff0000, v11
v_mul_f32 v242, v242, v236
v_mul_f32 v248, v248, v236
v_cvt_pk_bf16_f32 v11, v242, v248
v_lshlrev_b32 v242, 16, v176
v_and_b32 v248, 0xffff0000, v176
v_mul_f32 v242, v242, v236
v_mul_f32 v248, v248, v236
v_cvt_pk_bf16_f32 v176, v242, v248
v_lshlrev_b32 v242, 16, v177
v_and_b32 v248, 0xffff0000, v177
v_mul_f32 v242, v242, v236
v_mul_f32 v248, v248, v236
v_cvt_pk_bf16_f32 v177, v242, v248
v_lshlrev_b32 v242, 16, v178
v_and_b32 v248, 0xffff0000, v178
v_mul_f32 v242, v242, v236
v_mul_f32 v248, v248, v236
v_cvt_pk_bf16_f32 v178, v242, v248
v_lshlrev_b32 v242, 16, v179
v_and_b32 v248, 0xffff0000, v179
v_mul_f32 v242, v242, v236
v_mul_f32 v248, v248, v236
v_cvt_pk_bf16_f32 v179, v242, v248
v_lshlrev_b32 v242, 16, v160
v_and_b32 v248, 0xffff0000, v160
v_mul_f32 v242, v242, v236
v_mul_f32 v248, v248, v236
v_cvt_pk_bf16_f32 v160, v242, v248
v_lshlrev_b32 v242, 16, v161
v_and_b32 v248, 0xffff0000, v161
v_mul_f32 v242, v242, v236
v_mul_f32 v248, v248, v236
v_cvt_pk_bf16_f32 v161, v242, v248
v_lshlrev_b32 v242, 16, v162
v_and_b32 v248, 0xffff0000, v162
v_mul_f32 v242, v242, v236
v_mul_f32 v248, v248, v236
v_cvt_pk_bf16_f32 v162, v242, v248
v_lshlrev_b32 v242, 16, v163
v_and_b32 v248, 0xffff0000, v163
v_mul_f32 v242, v242, v236
v_mul_f32 v248, v248, v236
v_cvt_pk_bf16_f32 v163, v242, v248
v_lshlrev_b32 v242, 16, v0
v_and_b32 v248, 0xffff0000, v0
v_mul_f32 v242, v242, v236
v_mul_f32 v248, v248, v236
v_cvt_pk_bf16_f32 v0, v242, v248
v_lshlrev_b32 v242, 16, v1
v_and_b32 v248, 0xffff0000, v1
v_mul_f32 v242, v242, v236
v_mul_f32 v248, v248, v236
v_cvt_pk_bf16_f32 v1, v242, v248
v_exp_f32 v232, v144
v_exp_f32 v233, v145
v_exp_f32 v234, v146
v_exp_f32 v235, v147
s_nop 1
v_cvt_pk_bf16_f32 v2, v232, v233
v_cvt_pk_bf16_f32 v3, v234, v235
v_max_f32 v204, v148, v149
v_max3_f32 v204, v204, v150, v151
v_mov_b32 v205, v204
s_nop 1
v_permlane32_swap_b32 v204, v205
s_nop 1
v_max_f32 v204, v204, v205
v_mov_b32 v205, v204
s_nop 1
v_permlane16_swap_b32 v204, v205
s_nop 1
v_max_f32 v204, v204, v205
v_add_f32 v204, 40.0, v204
v_ceil_f32 v204, v204
v_max_f32 v204, 0, v204
v_sub_f32 v205, v225, v204
v_cvt_pk_bf16_f32 v205, v205, v205
v_and_b32 v205, 0xffff0000, v205
v_sub_f32 v204, v205, v225
v_mov_b32 v225, v205
v_exp_f32 v237, v204
v_add_f32 v148, v148, v204
v_add_f32 v149, v149, v204
v_add_f32 v150, v150, v204
v_add_f32 v151, v151, v204
v_add_f32 v132, v132, v204
v_add_f32 v133, v133, v204
v_add_f32 v134, v134, v204
v_add_f32 v135, v135, v204
v_lshlrev_b32 v242, 16, v36
v_and_b32 v248, 0xffff0000, v36
v_mul_f32 v242, v242, v237
v_mul_f32 v248, v248, v237
v_cvt_pk_bf16_f32 v36, v242, v248
v_lshlrev_b32 v242, 16, v37
v_and_b32 v248, 0xffff0000, v37
v_mul_f32 v242, v242, v237
v_mul_f32 v248, v248, v237
v_cvt_pk_bf16_f32 v37, v242, v248
v_lshlrev_b32 v242, 16, v38
v_and_b32 v248, 0xffff0000, v38
v_mul_f32 v242, v242, v237
v_mul_f32 v248, v248, v237
v_cvt_pk_bf16_f32 v38, v242, v248
v_lshlrev_b32 v242, 16, v39
v_and_b32 v248, 0xffff0000, v39
v_mul_f32 v242, v242, v237
v_mul_f32 v248, v248, v237
v_cvt_pk_bf16_f32 v39, v242, v248
v_lshlrev_b32 v242, 16, v40
v_and_b32 v248, 0xffff0000, v40
v_mul_f32 v242, v242, v237
v_mul_f32 v248, v248, v237
v_cvt_pk_bf16_f32 v40, v242, v248
v_lshlrev_b32 v242, 16, v41
v_and_b32 v248, 0xffff0000, v41
v_mul_f32 v242, v242, v237
v_mul_f32 v248, v248, v237
v_cvt_pk_bf16_f32 v41, v242, v248
v_lshlrev_b32 v242, 16, v42
v_and_b32 v248, 0xffff0000, v42
v_mul_f32 v242, v242, v237
v_mul_f32 v248, v248, v237
v_cvt_pk_bf16_f32 v42, v242, v248
v_lshlrev_b32 v242, 16, v43
v_and_b32 v248, 0xffff0000, v43
v_mul_f32 v242, v242, v237
v_mul_f32 v248, v248, v237
v_cvt_pk_bf16_f32 v43, v242, v248
v_lshlrev_b32 v242, 16, v180
v_and_b32 v248, 0xffff0000, v180
v_mul_f32 v242, v242, v237
v_mul_f32 v248, v248, v237
v_cvt_pk_bf16_f32 v180, v242, v248
v_lshlrev_b32 v242, 16, v181
v_and_b32 v248, 0xffff0000, v181
v_mul_f32 v242, v242, v237
v_mul_f32 v248, v248, v237
v_cvt_pk_bf16_f32 v181, v242, v248
v_lshlrev_b32 v242, 16, v182
v_and_b32 v248, 0xffff0000, v182
v_mul_f32 v242, v242, v237
v_mul_f32 v248, v248, v237
v_cvt_pk_bf16_f32 v182, v242, v248
v_lshlrev_b32 v242, 16, v183
v_and_b32 v248, 0xffff0000, v183
v_mul_f32 v242, v242, v237
v_mul_f32 v248, v248, v237
v_cvt_pk_bf16_f32 v183, v242, v248
v_lshlrev_b32 v242, 16, v164
v_and_b32 v248, 0xffff0000, v164
v_mul_f32 v242, v242, v237
v_mul_f32 v248, v248, v237
v_cvt_pk_bf16_f32 v164, v242, v248
v_lshlrev_b32 v242, 16, v165
v_and_b32 v248, 0xffff0000, v165
v_mul_f32 v242, v242, v237
v_mul_f32 v248, v248, v237
v_cvt_pk_bf16_f32 v165, v242, v248
v_lshlrev_b32 v242, 16, v166
v_and_b32 v248, 0xffff0000, v166
v_mul_f32 v242, v242, v237
v_mul_f32 v248, v248, v237
v_cvt_pk_bf16_f32 v166, v242, v248
v_lshlrev_b32 v242, 16, v167
v_and_b32 v248, 0xffff0000, v167
v_mul_f32 v242, v242, v237
v_mul_f32 v248, v248, v237
v_cvt_pk_bf16_f32 v167, v242, v248
v_lshlrev_b32 v242, 16, v32
v_and_b32 v248, 0xffff0000, v32
v_mul_f32 v242, v242, v237
v_mul_f32 v248, v248, v237
v_cvt_pk_bf16_f32 v32, v242, v248
v_lshlrev_b32 v242, 16, v33
v_and_b32 v248, 0xffff0000, v33
v_mul_f32 v242, v242, v237
v_mul_f32 v248, v248, v237
v_cvt_pk_bf16_f32 v33, v242, v248
v_exp_f32 v232, v148
v_exp_f32 v233, v149
v_exp_f32 v234, v150
v_exp_f32 v235, v151
s_nop 1
v_cvt_pk_bf16_f32 v34, v232, v233
v_cvt_pk_bf16_f32 v35, v234, v235
v_max_f32 v204, v152, v153
v_max3_f32 v204, v204, v154, v155
v_mov_b32 v205, v204
s_nop 1
v_permlane32_swap_b32 v204, v205
s_nop 1
v_max_f32 v204, v204, v205
v_mov_b32 v205, v204
s_nop 1
v_permlane16_swap_b32 v204, v205
s_nop 1
v_max_f32 v204, v204, v205
v_add_f32 v204, 40.0, v204
v_ceil_f32 v204, v204
v_max_f32 v204, 0, v204
v_sub_f32 v205, v226, v204
v_cvt_pk_bf16_f32 v205, v205, v205
v_and_b32 v205, 0xffff0000, v205
v_sub_f32 v204, v205, v226
v_mov_b32 v226, v205
v_exp_f32 v238, v204
v_add_f32 v152, v152, v204
v_add_f32 v153, v153, v204
v_add_f32 v154, v154, v204
v_add_f32 v155, v155, v204
v_add_f32 v136, v136, v204
v_add_f32 v137, v137, v204
v_add_f32 v138, v138, v204
v_add_f32 v139, v139, v204
v_lshlrev_b32 v242, 16, v68
v_and_b32 v248, 0xffff0000, v68
v_mul_f32 v242, v242, v238
v_mul_f32 v248, v248, v238
v_cvt_pk_bf16_f32 v68, v242, v248
v_lshlrev_b32 v242, 16, v69
v_and_b32 v248, 0xffff0000, v69
v_mul_f32 v242, v242, v238
v_mul_f32 v248, v248, v238
v_cvt_pk_bf16_f32 v69, v242, v248
v_lshlrev_b32 v242, 16, v70
v_and_b32 v248, 0xffff0000, v70
v_mul_f32 v242, v242, v238
v_mul_f32 v248, v248, v238
v_cvt_pk_bf16_f32 v70, v242, v248
v_lshlrev_b32 v242, 16, v71
v_and_b32 v248, 0xffff0000, v71
v_mul_f32 v242, v242, v238
v_mul_f32 v248, v248, v238
v_cvt_pk_bf16_f32 v71, v242, v248
v_lshlrev_b32 v242, 16, v72
v_and_b32 v248, 0xffff0000, v72
v_mul_f32 v242, v242, v238
v_mul_f32 v248, v248, v238
v_cvt_pk_bf16_f32 v72, v242, v248
v_lshlrev_b32 v242, 16, v73
v_and_b32 v248, 0xffff0000, v73
v_mul_f32 v242, v242, v238
v_mul_f32 v248, v248, v238
v_cvt_pk_bf16_f32 v73, v242, v248
v_lshlrev_b32 v242, 16, v74
v_and_b32 v248, 0xffff0000, v74
v_mul_f32 v242, v242, v238
v_mul_f32 v248, v248, v238
v_cvt_pk_bf16_f32 v74, v242, v248
v_lshlrev_b32 v242, 16, v75
v_and_b32 v248, 0xffff0000, v75
v_mul_f32 v242, v242, v238
v_mul_f32 v248, v248, v238
v_cvt_pk_bf16_f32 v75, v242, v248
v_lshlrev_b32 v242, 16, v184
v_and_b32 v248, 0xffff0000, v184
v_mul_f32 v242, v242, v238
v_mul_f32 v248, v248, v238
v_cvt_pk_bf16_f32 v184, v242, v248
v_lshlrev_b32 v242, 16, v185
v_and_b32 v248, 0xffff0000, v185
v_mul_f32 v242, v242, v238
v_mul_f32 v248, v248, v238
v_cvt_pk_bf16_f32 v185, v242, v248
v_lshlrev_b32 v242, 16, v186
v_and_b32 v248, 0xffff0000, v186
v_mul_f32 v242, v242, v238
v_mul_f32 v248, v248, v238
v_cvt_pk_bf16_f32 v186, v242, v248
v_lshlrev_b32 v242, 16, v187
v_and_b32 v248, 0xffff0000, v187
v_mul_f32 v242, v242, v238
v_mul_f32 v248, v248, v238
v_cvt_pk_bf16_f32 v187, v242, v248
v_lshlrev_b32 v242, 16, v168
v_and_b32 v248, 0xffff0000, v168
v_mul_f32 v242, v242, v238
v_mul_f32 v248, v248, v238
v_cvt_pk_bf16_f32 v168, v242, v248
v_lshlrev_b32 v242, 16, v169
v_and_b32 v248, 0xffff0000, v169
v_mul_f32 v242, v242, v238
v_mul_f32 v248, v248, v238
v_cvt_pk_bf16_f32 v169, v242, v248
v_lshlrev_b32 v242, 16, v170
v_and_b32 v248, 0xffff0000, v170
v_mul_f32 v242, v242, v238
v_mul_f32 v248, v248, v238
v_cvt_pk_bf16_f32 v170, v242, v248
v_lshlrev_b32 v242, 16, v171
v_and_b32 v248, 0xffff0000, v171
v_mul_f32 v242, v242, v238
v_mul_f32 v248, v248, v238
v_cvt_pk_bf16_f32 v171, v242, v248
v_lshlrev_b32 v242, 16, v64
v_and_b32 v248, 0xffff0000, v64
v_mul_f32 v242, v242, v238
v_mul_f32 v248, v248, v238
v_cvt_pk_bf16_f32 v64, v242, v248
v_lshlrev_b32 v242, 16, v65
v_and_b32 v248, 0xffff0000, v65
v_mul_f32 v242, v242, v238
v_mul_f32 v248, v248, v238
v_cvt_pk_bf16_f32 v65, v242, v248
v_exp_f32 v232, v152
v_exp_f32 v233, v153
v_exp_f32 v234, v154
v_exp_f32 v235, v155
s_nop 1
v_cvt_pk_bf16_f32 v66, v232, v233
v_cvt_pk_bf16_f32 v67, v234, v235
v_max_f32 v204, v156, v157
v_max3_f32 v204, v204, v158, v159
v_mov_b32 v205, v204
s_nop 1
v_permlane32_swap_b32 v204, v205
s_nop 1
v_max_f32 v204, v204, v205
v_mov_b32 v205, v204
s_nop 1
v_permlane16_swap_b32 v204, v205
s_nop 1
v_max_f32 v204, v204, v205
v_add_f32 v204, 40.0, v204
v_ceil_f32 v204, v204
v_max_f32 v204, 0, v204
v_sub_f32 v205, v227, v204
v_cvt_pk_bf16_f32 v205, v205, v205
v_and_b32 v205, 0xffff0000, v205
v_sub_f32 v204, v205, v227
v_mov_b32 v227, v205
v_exp_f32 v239, v204
v_add_f32 v156, v156, v204
v_add_f32 v157, v157, v204
v_add_f32 v158, v158, v204
v_add_f32 v159, v159, v204
v_add_f32 v140, v140, v204
v_add_f32 v141, v141, v204
v_add_f32 v142, v142, v204
v_add_f32 v143, v143, v204
v_lshlrev_b32 v242, 16, v100
v_and_b32 v248, 0xffff0000, v100
v_mul_f32 v242, v242, v239
v_mul_f32 v248, v248, v239
v_cvt_pk_bf16_f32 v100, v242, v248
v_lshlrev_b32 v242, 16, v101
v_and_b32 v248, 0xffff0000, v101
v_mul_f32 v242, v242, v239
v_mul_f32 v248, v248, v239
v_cvt_pk_bf16_f32 v101, v242, v248
v_lshlrev_b32 v242, 16, v102
v_and_b32 v248, 0xffff0000, v102
v_mul_f32 v242, v242, v239
v_mul_f32 v248, v248, v239
v_cvt_pk_bf16_f32 v102, v242, v248
v_lshlrev_b32 v242, 16, v103
v_and_b32 v248, 0xffff0000, v103
v_mul_f32 v242, v242, v239
v_mul_f32 v248, v248, v239
v_cvt_pk_bf16_f32 v103, v242, v248
v_lshlrev_b32 v242, 16, v104
v_and_b32 v248, 0xffff0000, v104
v_mul_f32 v242, v242, v239
v_mul_f32 v248, v248, v239
v_cvt_pk_bf16_f32 v104, v242, v248
v_lshlrev_b32 v242, 16, v105
v_and_b32 v248, 0xffff0000, v105
v_mul_f32 v242, v242, v239
v_mul_f32 v248, v248, v239
v_cvt_pk_bf16_f32 v105, v242, v248
v_lshlrev_b32 v242, 16, v106
v_and_b32 v248, 0xffff0000, v106
v_mul_f32 v242, v242, v239
v_mul_f32 v248, v248, v239
v_cvt_pk_bf16_f32 v106, v242, v248
v_lshlrev_b32 v242, 16, v107
v_and_b32 v248, 0xffff0000, v107
v_mul_f32 v242, v242, v239
v_mul_f32 v248, v248, v239
v_cvt_pk_bf16_f32 v107, v242, v248
v_lshlrev_b32 v242, 16, v188
v_and_b32 v248, 0xffff0000, v188
v_mul_f32 v242, v242, v239
v_mul_f32 v248, v248, v239
v_cvt_pk_bf16_f32 v188, v242, v248
v_lshlrev_b32 v242, 16, v189
v_and_b32 v248, 0xffff0000, v189
v_mul_f32 v242, v242, v239
v_mul_f32 v248, v248, v239
v_cvt_pk_bf16_f32 v189, v242, v248
v_lshlrev_b32 v242, 16, v190
v_and_b32 v248, 0xffff0000, v190
v_mul_f32 v242, v242, v239
v_mul_f32 v248, v248, v239
v_cvt_pk_bf16_f32 v190, v242, v248
v_lshlrev_b32 v242, 16, v191
v_and_b32 v248, 0xffff0000, v191
v_mul_f32 v242, v242, v239
v_mul_f32 v248, v248, v239
v_cvt_pk_bf16_f32 v191, v242, v248
v_lshlrev_b32 v242, 16, v172
v_and_b32 v248, 0xffff0000, v172
v_mul_f32 v242, v242, v239
v_mul_f32 v248, v248, v239
v_cvt_pk_bf16_f32 v172, v242, v248
v_lshlrev_b32 v242, 16, v173
v_and_b32 v248, 0xffff0000, v173
v_mul_f32 v242, v242, v239
v_mul_f32 v248, v248, v239
v_cvt_pk_bf16_f32 v173, v242, v248
v_lshlrev_b32 v242, 16, v174
v_and_b32 v248, 0xffff0000, v174
v_mul_f32 v242, v242, v239
v_mul_f32 v248, v248, v239
v_cvt_pk_bf16_f32 v174, v242, v248
v_lshlrev_b32 v242, 16, v175
v_and_b32 v248, 0xffff0000, v175
v_mul_f32 v242, v242, v239
v_mul_f32 v248, v248, v239
v_cvt_pk_bf16_f32 v175, v242, v248
v_lshlrev_b32 v242, 16, v96
v_and_b32 v248, 0xffff0000, v96
v_mul_f32 v242, v242, v239
v_mul_f32 v248, v248, v239
v_cvt_pk_bf16_f32 v96, v242, v248
v_lshlrev_b32 v242, 16, v97
v_and_b32 v248, 0xffff0000, v97
v_mul_f32 v242, v242, v239
v_mul_f32 v248, v248, v239
v_cvt_pk_bf16_f32 v97, v242, v248
v_exp_f32 v232, v156
v_exp_f32 v233, v157
v_exp_f32 v234, v158
v_exp_f32 v235, v159
s_nop 1
v_cvt_pk_bf16_f32 v98, v232, v233
v_cvt_pk_bf16_f32 v99, v234, v235
s_branch L2_rare_common
LF_hl_1:
s_mov_b32 s94, 0x10000
s_mov_b32 s3, 0x7c28000
LF_hl2_1:
v_lshlrev_b32 v241, 3, v243
buffer_load_dwordx2 v[240:241], v241, s[16:19], s3 offen sc1
s_sub_u32 s94, s94, 1
s_waitcnt vmcnt(0)
s_cbranch_scc1 LF_hlret_1
v_cmp_ne_u64_e64 s[38:39], s[98:99], v[240:241]
s_and_b64 s[38:39], s[38:39], s[96:97]
s_cbranch_scc1 LF_hl2_1
s_branch LF_hlret_1
L2_rare_site12:
s_mov_b32 s36, 12
s_branch L2_rare_t0_0
L2_rare_t0_0:
s_nop 15
s_nop 15
s_waitcnt lgkmcnt(0)
v_lshrrev_b32 v206, 8, v243
v_add_u32 v206, 1, v206
v_lshrrev_b32 v206, 2, v206
v_sub_u32 v206, 0, v206
v_and_b32 v206, 0xffff0000, v206
v_max_f32 v204, v128, v129
v_max3_f32 v204, v204, v130, v131
v_mov_b32 v205, v204
s_nop 1
v_permlane32_swap_b32 v204, v205
s_nop 1
v_max_f32 v204, v204, v205
v_mov_b32 v205, v204
s_nop 1
v_permlane16_swap_b32 v204, v205
s_nop 1
v_max_f32 v204, v204, v205
v_add_f32 v204, 40.0, v204
v_ceil_f32 v204, v204
v_max_f32 v204, 0, v204
v_sub_f32 v205, v224, v204
v_cvt_pk_bf16_f32 v205, v205, v205
v_and_b32 v205, 0xffff0000, v205
v_sub_f32 v204, v205, v224
v_mov_b32 v224, v205
v_exp_f32 v236, v204
v_bfi_b32 v3, v206, v205, v3
v_add_f32 v128, v128, v204
v_add_f32 v129, v129, v204
v_add_f32 v130, v130, v204
v_add_f32 v131, v131, v204
v_add_f32 v144, v144, v204
v_add_f32 v145, v145, v204
v_add_f32 v146, v146, v204
v_add_f32 v147, v147, v204
v_lshlrev_b32 v242, 16, v176
v_and_b32 v248, 0xffff0000, v176
v_mul_f32 v242, v242, v236
v_mul_f32 v248, v248, v236
v_cvt_pk_bf16_f32 v176, v242, v248
v_lshlrev_b32 v242, 16, v177
v_and_b32 v248, 0xffff0000, v177
v_mul_f32 v242, v242, v236
v_mul_f32 v248, v248, v236
v_cvt_pk_bf16_f32 v177, v242, v248
v_lshlrev_b32 v242, 16, v178
v_and_b32 v248, 0xffff0000, v178
v_mul_f32 v242, v242, v236
v_mul_f32 v248, v248, v236
v_cvt_pk_bf16_f32 v178, v242, v248
v_lshlrev_b32 v242, 16, v179
v_and_b32 v248, 0xffff0000, v179
v_mul_f32 v242, v242, v236
v_mul_f32 v248, v248, v236
v_cvt_pk_bf16_f32 v179, v242, v248
ds_read_b64 v[250:251], v231 offset:0
s_waitcnt lgkmcnt(0)
v_lshlrev_b32 v242, 16, v250
v_and_b32 v248, 0xffff0000, v250
v_mul_f32 v242, v242, v236
v_mul_f32 v248, v248, v236
v_cvt_pk_bf16_f32 v250, v242, v248
v_lshlrev_b32 v242, 16, v251
v_and_b32 v248, 0xffff0000, v251
v_mul_f32 v242, v242, v236
v_mul_f32 v248, v248, v236
v_cvt_pk_bf16_f32 v251, v242, v248
ds_write_b64 v231, v[250:251] offset:0
s_waitcnt lgkmcnt(0)
ds_read_b64 v[250:251], v231 offset:8
s_waitcnt lgkmcnt(0)
v_lshlrev_b32 v242, 16, v250
v_and_b32 v248, 0xffff0000, v250
v_mul_f32 v242, v242, v236
v_mul_f32 v248, v248, v236
v_cvt_pk_bf16_f32 v250, v242, v248
v_lshlrev_b32 v242, 16, v251
v_and_b32 v248, 0xffff0000, v251
v_mul_f32 v242, v242, v236
v_mul_f32 v248, v248, v236
v_cvt_pk_bf16_f32 v251, v242, v248
ds_write_b64 v231, v[250:251] offset:8
s_waitcnt lgkmcnt(0)
v_exp_f32 v232, v128
v_exp_f32 v233, v129
v_exp_f32 v234, v130
v_exp_f32 v235, v131
s_nop 1
v_cvt_pk_bf16_f32 v160, v232, v233
v_cvt_pk_bf16_f32 v161, v234, v235
v_max_f32 v204, v132, v133
v_max3_f32 v204, v204, v134, v135
v_mov_b32 v205, v204
s_nop 1
v_permlane32_swap_b32 v204, v205
s_nop 1
v_max_f32 v204, v204, v205
v_mov_b32 v205, v204
s_nop 1
v_permlane16_swap_b32 v204, v205
s_nop 1
v_max_f32 v204, v204, v205
v_add_f32 v204, 40.0, v204
v_ceil_f32 v204, v204
v_max_f32 v204, 0, v204
v_sub_f32 v205, v225, v204
v_cvt_pk_bf16_f32 v205, v205, v205
v_and_b32 v205, 0xffff0000, v205
v_sub_f32 v204, v205, v225
v_mov_b32 v225, v205
v_exp_f32 v237, v204
v_bfi_b32 v35, v206, v205, v35
v_add_f32 v132, v132, v204
v_add_f32 v133, v133, v204
v_add_f32 v134, v134, v204
v_add_f32 v135, v135, v204
v_add_f32 v148, v148, v204
v_add_f32 v149, v149, v204
v_add_f32 v150, v150, v204
v_add_f32 v151, v151, v204
v_lshlrev_b32 v242, 16, v180
v_and_b32 v248, 0xffff0000, v180
v_mul_f32 v242, v242, v237
v_mul_f32 v248, v248, v237
v_cvt_pk_bf16_f32 v180, v242, v248
v_lshlrev_b32 v242, 16, v181
v_and_b32 v248, 0xffff0000, v181
v_mul_f32 v242, v242, v237
v_mul_f32 v248, v248, v237
v_cvt_pk_bf16_f32 v181, v242, v248
v_lshlrev_b32 v242, 16, v182
v_and_b32 v248, 0xffff0000, v182
v_mul_f32 v242, v242, v237
v_mul_f32 v248, v248, v237
v_cvt_pk_bf16_f32 v182, v242, v248
v_lshlrev_b32 v242, 16, v183
v_and_b32 v248, 0xffff0000, v183
v_mul_f32 v242, v242, v237
v_mul_f32 v248, v248, v237
v_cvt_pk_bf16_f32 v183, v242, v248
ds_read_b64 v[250:251], v231 offset:1024
s_waitcnt lgkmcnt(0)
v_lshlrev_b32 v242, 16, v250
v_and_b32 v248, 0xffff0000, v250
v_mul_f32 v242, v242, v237
v_mul_f32 v248, v248, v237
v_cvt_pk_bf16_f32 v250, v242, v248
v_lshlrev_b32 v242, 16, v251
v_and_b32 v248, 0xffff0000, v251
v_mul_f32 v242, v242, v237
v_mul_f32 v248, v248, v237
v_cvt_pk_bf16_f32 v251, v242, v248
ds_write_b64 v231, v[250:251] offset:1024
s_waitcnt lgkmcnt(0)
ds_read_b64 v[250:251], v231 offset:1032
s_waitcnt lgkmcnt(0)
v_lshlrev_b32 v242, 16, v250
v_and_b32 v248, 0xffff0000, v250
v_mul_f32 v242, v242, v237
v_mul_f32 v248, v248, v237
v_cvt_pk_bf16_f32 v250, v242, v248
v_lshlrev_b32 v242, 16, v251
v_and_b32 v248, 0xffff0000, v251
v_mul_f32 v242, v242, v237
v_mul_f32 v248, v248, v237
v_cvt_pk_bf16_f32 v251, v242, v248
ds_write_b64 v231, v[250:251] offset:1032
s_waitcnt lgkmcnt(0)
v_exp_f32 v232, v132
v_exp_f32 v233, v133
v_exp_f32 v234, v134
v_exp_f32 v235, v135
s_nop 1
v_cvt_pk_bf16_f32 v164, v232, v233
v_cvt_pk_bf16_f32 v165, v234, v235
v_max_f32 v204, v136, v137
v_max3_f32 v204, v204, v138, v139
v_mov_b32 v205, v204
s_nop 1
v_permlane32_swap_b32 v204, v205
s_nop 1
v_max_f32 v204, v204, v205
v_mov_b32 v205, v204
s_nop 1
v_permlane16_swap_b32 v204, v205
s_nop 1
v_max_f32 v204, v204, v205
v_add_f32 v204, 40.0, v204
v_ceil_f32 v204, v204
v_max_f32 v204, 0, v204
v_sub_f32 v205, v226, v204
v_cvt_pk_bf16_f32 v205, v205, v205
v_and_b32 v205, 0xffff0000, v205
v_sub_f32 v204, v205, v226
v_mov_b32 v226, v205
v_exp_f32 v238, v204
v_bfi_b32 v67, v206, v205, v67
v_add_f32 v136, v136, v204
v_add_f32 v137, v137, v204
v_add_f32 v138, v138, v204
v_add_f32 v139, v139, v204
v_add_f32 v152, v152, v204
v_add_f32 v153, v153, v204
v_add_f32 v154, v154, v204
v_add_f32 v155, v155, v204
v_lshlrev_b32 v242, 16, v184
v_and_b32 v248, 0xffff0000, v184
v_mul_f32 v242, v242, v238
v_mul_f32 v248, v248, v238
v_cvt_pk_bf16_f32 v184, v242, v248
v_lshlrev_b32 v242, 16, v185
v_and_b32 v248, 0xffff0000, v185
v_mul_f32 v242, v242, v238
v_mul_f32 v248, v248, v238
v_cvt_pk_bf16_f32 v185, v242, v248
v_lshlrev_b32 v242, 16, v186
v_and_b32 v248, 0xffff0000, v186
v_mul_f32 v242, v242, v238
v_mul_f32 v248, v248, v238
v_cvt_pk_bf16_f32 v186, v242, v248
v_lshlrev_b32 v242, 16, v187
v_and_b32 v248, 0xffff0000, v187
v_mul_f32 v242, v242, v238
v_mul_f32 v248, v248, v238
v_cvt_pk_bf16_f32 v187, v242, v248
ds_read_b64 v[250:251], v231 offset:2048
s_waitcnt lgkmcnt(0)
v_lshlrev_b32 v242, 16, v250
v_and_b32 v248, 0xffff0000, v250
v_mul_f32 v242, v242, v238
v_mul_f32 v248, v248, v238
v_cvt_pk_bf16_f32 v250, v242, v248
v_lshlrev_b32 v242, 16, v251
v_and_b32 v248, 0xffff0000, v251
v_mul_f32 v242, v242, v238
v_mul_f32 v248, v248, v238
v_cvt_pk_bf16_f32 v251, v242, v248
ds_write_b64 v231, v[250:251] offset:2048
s_waitcnt lgkmcnt(0)
ds_read_b64 v[250:251], v231 offset:2056
s_waitcnt lgkmcnt(0)
v_lshlrev_b32 v242, 16, v250
v_and_b32 v248, 0xffff0000, v250
v_mul_f32 v242, v242, v238
v_mul_f32 v248, v248, v238
v_cvt_pk_bf16_f32 v250, v242, v248
v_lshlrev_b32 v242, 16, v251
v_and_b32 v248, 0xffff0000, v251
v_mul_f32 v242, v242, v238
v_mul_f32 v248, v248, v238
v_cvt_pk_bf16_f32 v251, v242, v248
ds_write_b64 v231, v[250:251] offset:2056
s_waitcnt lgkmcnt(0)
v_exp_f32 v232, v136
v_exp_f32 v233, v137
v_exp_f32 v234, v138
v_exp_f32 v235, v139
s_nop 1
v_cvt_pk_bf16_f32 v168, v232, v233
v_cvt_pk_bf16_f32 v169, v234, v235
v_max_f32 v204, v140, v141
v_max3_f32 v204, v204, v142, v143
v_mov_b32 v205, v204
s_nop 1
v_permlane32_swap_b32 v204, v205
s_nop 1
v_max_f32 v204, v204, v205
v_mov_b32 v205, v204
s_nop 1
v_permlane16_swap_b32 v204, v205
s_nop 1
v_max_f32 v204, v204, v205
v_add_f32 v204, 40.0, v204
v_ceil_f32 v204, v204
v_max_f32 v204, 0, v204
v_sub_f32 v205, v227, v204
v_cvt_pk_bf16_f32 v205, v205, v205
v_and_b32 v205, 0xffff0000, v205
v_sub_f32 v204, v205, v227
v_mov_b32 v227, v205
v_exp_f32 v239, v204
v_bfi_b32 v99, v206, v205, v99
v_add_f32 v140, v140, v204
v_add_f32 v141, v141, v204
v_add_f32 v142, v142, v204
v_add_f32 v143, v143, v204
v_add_f32 v156, v156, v204
v_add_f32 v157, v157, v204
v_add_f32 v158, v158, v204
v_add_f32 v159, v159, v204
v_lshlrev_b32 v242, 16, v188
v_and_b32 v248, 0xffff0000, v188
v_mul_f32 v242, v242, v239
v_mul_f32 v248, v248, v239
v_cvt_pk_bf16_f32 v188, v242, v248
v_lshlrev_b32 v242, 16, v189
v_and_b32 v248, 0xffff0000, v189
v_mul_f32 v242, v242, v239
v_mul_f32 v248, v248, v239
v_cvt_pk_bf16_f32 v189, v242, v248
v_lshlrev_b32 v242, 16, v190
v_and_b32 v248, 0xffff0000, v190
v_mul_f32 v242, v242, v239
v_mul_f32 v248, v248, v239
v_cvt_pk_bf16_f32 v190, v242, v248
v_lshlrev_b32 v242, 16, v191
v_and_b32 v248, 0xffff0000, v191
v_mul_f32 v242, v242, v239
v_mul_f32 v248, v248, v239
v_cvt_pk_bf16_f32 v191, v242, v248
ds_read_b64 v[250:251], v231 offset:3072
s_waitcnt lgkmcnt(0)
v_lshlrev_b32 v242, 16, v250
v_and_b32 v248, 0xffff0000, v250
v_mul_f32 v242, v242, v239
v_mul_f32 v248, v248, v239
v_cvt_pk_bf16_f32 v250, v242, v248
v_lshlrev_b32 v242, 16, v251
v_and_b32 v248, 0xffff0000, v251
v_mul_f32 v242, v242, v239
v_mul_f32 v248, v248, v239
v_cvt_pk_bf16_f32 v251, v242, v248
ds_write_b64 v231, v[250:251] offset:3072
s_waitcnt lgkmcnt(0)
ds_read_b64 v[250:251], v231 offset:3080
s_waitcnt lgkmcnt(0)
v_lshlrev_b32 v242, 16, v250
v_and_b32 v248, 0xffff0000, v250
v_mul_f32 v242, v242, v239
v_mul_f32 v248, v248, v239
v_cvt_pk_bf16_f32 v250, v242, v248
v_lshlrev_b32 v242, 16, v251
v_and_b32 v248, 0xffff0000, v251
v_mul_f32 v242, v242, v239
v_mul_f32 v248, v248, v239
v_cvt_pk_bf16_f32 v251, v242, v248
ds_write_b64 v231, v[250:251] offset:3080
s_waitcnt lgkmcnt(0)
v_exp_f32 v232, v140
v_exp_f32 v233, v141
v_exp_f32 v234, v142
v_exp_f32 v235, v143
s_nop 1
v_cvt_pk_bf16_f32 v172, v232, v233
v_cvt_pk_bf16_f32 v173, v234, v235
s_branch L2_rare_common
L2_rare_site13:
s_mov_b32 s36, 13
s_branch L2_rare_t0_1
L2_rare_t0_1:
s_nop 15
s_nop 15
s_waitcnt lgkmcnt(0)
v_lshrrev_b32 v206, 8, v243
v_add_u32 v206, 1, v206
v_lshrrev_b32 v206, 2, v206
v_sub_u32 v206, 0, v206
v_and_b32 v206, 0xffff0000, v206
v_max_f32 v204, v144, v145
v_max3_f32 v204, v204, v146, v147
v_mov_b32 v205, v204
s_nop 1
v_permlane32_swap_b32 v204, v205
s_nop 1
v_max_f32 v204, v204, v205
v_mov_b32 v205, v204
s_nop 1
v_permlane16_swap_b32 v204, v205
s_nop 1
v_max_f32 v204, v204, v205
v_add_f32 v204, 40.0, v204
v_ceil_f32 v204, v204
v_max_f32 v204, 0, v204
v_sub_f32 v205, v224, v204
v_cvt_pk_bf16_f32 v205, v205, v205
v_and_b32 v205, 0xffff0000, v205
v_sub_f32 v204, v205, v224
v_mov_b32 v224, v205
v_exp_f32 v236, v204
v_bfi_b32 v3, v206, v205, v3
v_add_f32 v144, v144, v204
v_add_f32 v145, v145, v204
v_add_f32 v146, v146, v204
v_add_f32 v147, v147, v204
v_add_f32 v128, v128, v204
v_add_f32 v129, v129, v204
v_add_f32 v130, v130, v204
v_add_f32 v131, v131, v204
v_lshlrev_b32 v242, 16, v160
v_and_b32 v248, 0xffff0000, v160
v_mul_f32 v242, v242, v236
v_mul_f32 v248, v248, v236
v_cvt_pk_bf16_f32 v160, v242, v248
v_lshlrev_b32 v242, 16, v161
v_and_b32 v248, 0xffff0000, v161
v_mul_f32 v242, v242, v236
v_mul_f32 v248, v248, v236
v_cvt_pk_bf16_f32 v161, v242, v248
ds_read_b64 v[250:251], v231 offset:0
s_waitcnt lgkmcnt(0)
v_lshlrev_b32 v242, 16, v250
v_and_b32 v248, 0xffff0000, v250
v_mul_f32 v242, v242, v236
v_mul_f32 v248, v248, v236
v_cvt_pk_bf16_f32 v250, v242, v248
v_lshlrev_b32 v242, 16, v251
v_and_b32 v248, 0xffff0000, v251
v_mul_f32 v242, v242, v236
v_mul_f32 v248, v248, v236
v_cvt_pk_bf16_f32 v251, v242, v248
ds_write_b64 v231, v[250:251] offset:0
s_waitcnt lgkmcnt(0)
ds_read_b64 v[250:251], v231 offset:8
s_waitcnt lgkmcnt(0)
v_lshlrev_b32 v242, 16, v250
v_and_b32 v248, 0xffff0000, v250
v_mul_f32 v242, v242, v236
v_mul_f32 v248, v248, v236
v_cvt_pk_bf16_f32 v250, v242, v248
v_lshlrev_b32 v242, 16, v251
v_and_b32 v248, 0xffff0000, v251
v_mul_f32 v242, v242, v236
v_mul_f32 v248, v248, v236
v_cvt_pk_bf16_f32 v251, v242, v248
ds_write_b64 v231, v[250:251] offset:8
s_waitcnt lgkmcnt(0)
ds_read_b64 v[250:251], v231 offset:4096
s_waitcnt lgkmcnt(0)
v_lshlrev_b32 v242, 16, v250
v_and_b32 v248, 0xffff0000, v250
v_mul_f32 v242, v242, v236
v_mul_f32 v248, v248, v236
v_cvt_pk_bf16_f32 v250, v242, v248
v_lshlrev_b32 v242, 16, v251
v_and_b32 v248, 0xffff0000, v251
v_mul_f32 v242, v242, v236
v_mul_f32 v248, v248, v236
v_cvt_pk_bf16_f32 v251, v242, v248
ds_write_b64 v231, v[250:251] offset:4096
s_waitcnt lgkmcnt(0)
ds_read_b64 v[250:251], v231 offset:4104
s_waitcnt lgkmcnt(0)
v_lshlrev_b32 v242, 16, v250
v_and_b32 v248, 0xffff0000, v250
v_mul_f32 v242, v242, v236
v_mul_f32 v248, v248, v236
v_cvt_pk_bf16_f32 v250, v242, v248
v_lshlrev_b32 v242, 16, v251
v_and_b32 v248, 0xffff0000, v251
v_mul_f32 v242, v242, v236
v_mul_f32 v248, v248, v236
v_cvt_pk_bf16_f32 v251, v242, v248
ds_write_b64 v231, v[250:251] offset:4104
s_waitcnt lgkmcnt(0)
v_exp_f32 v232, v144
v_exp_f32 v233, v145
v_exp_f32 v234, v146
v_exp_f32 v235, v147
s_nop 1
v_cvt_pk_bf16_f32 v162, v232, v233
v_cvt_pk_bf16_f32 v163, v234, v235
v_max_f32 v204, v148, v149
v_max3_f32 v204, v204, v150, v151
v_mov_b32 v205, v204
s_nop 1
v_permlane32_swap_b32 v204, v205
s_nop 1
v_max_f32 v204, v204, v205
v_mov_b32 v205, v204
s_nop 1
v_permlane16_swap_b32 v204, v205
s_nop 1
v_max_f32 v204, v204, v205
v_add_f32 v204, 40.0, v204
v_ceil_f32 v204, v204
v_max_f32 v204, 0, v204
v_sub_f32 v205, v225, v204
v_cvt_pk_bf16_f32 v205, v205, v205
v_and_b32 v205, 0xffff0000, v205
v_sub_f32 v204, v205, v225
v_mov_b32 v225, v205
v_exp_f32 v237, v204
v_bfi_b32 v35, v206, v205, v35
v_add_f32 v148, v148, v204
v_add_f32 v149, v149, v204
v_add_f32 v150, v150, v204
v_add_f32 v151, v151, v204
v_add_f32 v132, v132, v204
v_add_f32 v133, v133, v204
v_add_f32 v134, v134, v204
v_add_f32 v135, v135, v204
v_lshlrev_b32 v242, 16, v164
v_and_b32 v248, 0xffff0000, v164
v_mul_f32 v242, v242, v237
v_mul_f32 v248, v248, v237
v_cvt_pk_bf16_f32 v164, v242, v248
v_lshlrev_b32 v242, 16, v165
v_and_b32 v248, 0xffff0000, v165
v_mul_f32 v242, v242, v237
v_mul_f32 v248, v248, v237
v_cvt_pk_bf16_f32 v165, v242, v248
ds_read_b64 v[250:251], v231 offset:1024
s_waitcnt lgkmcnt(0)
v_lshlrev_b32 v242, 16, v250
v_and_b32 v248, 0xffff0000, v250
v_mul_f32 v242, v242, v237
v_mul_f32 v248, v248, v237
v_cvt_pk_bf16_f32 v250, v242, v248
v_lshlrev_b32 v242, 16, v251
v_and_b32 v248, 0xffff0000, v251
v_mul_f32 v242, v242, v237
v_mul_f32 v248, v248, v237
v_cvt_pk_bf16_f32 v251, v242, v248
ds_write_b64 v231, v[250:251] offset:1024
s_waitcnt lgkmcnt(0)
ds_read_b64 v[250:251], v231 offset:1032
s_waitcnt lgkmcnt(0)
v_lshlrev_b32 v242, 16, v250
v_and_b32 v248, 0xffff0000, v250
v_mul_f32 v242, v242, v237
v_mul_f32 v248, v248, v237
v_cvt_pk_bf16_f32 v250, v242, v248
v_lshlrev_b32 v242, 16, v251
v_and_b32 v248, 0xffff0000, v251
v_mul_f32 v242, v242, v237
v_mul_f32 v248, v248, v237
v_cvt_pk_bf16_f32 v251, v242, v248
ds_write_b64 v231, v[250:251] offset:1032
s_waitcnt lgkmcnt(0)
ds_read_b64 v[250:251], v231 offset:5120
s_waitcnt lgkmcnt(0)
v_lshlrev_b32 v242, 16, v250
v_and_b32 v248, 0xffff0000, v250
v_mul_f32 v242, v242, v237
v_mul_f32 v248, v248, v237
v_cvt_pk_bf16_f32 v250, v242, v248
v_lshlrev_b32 v242, 16, v251
v_and_b32 v248, 0xffff0000, v251
v_mul_f32 v242, v242, v237
v_mul_f32 v248, v248, v237
v_cvt_pk_bf16_f32 v251, v242, v248
ds_write_b64 v231, v[250:251] offset:5120
s_waitcnt lgkmcnt(0)
ds_read_b64 v[250:251], v231 offset:5128
s_waitcnt lgkmcnt(0)
v_lshlrev_b32 v242, 16, v250
v_and_b32 v248, 0xffff0000, v250
v_mul_f32 v242, v242, v237
v_mul_f32 v248, v248, v237
v_cvt_pk_bf16_f32 v250, v242, v248
v_lshlrev_b32 v242, 16, v251
v_and_b32 v248, 0xffff0000, v251
v_mul_f32 v242, v242, v237
v_mul_f32 v248, v248, v237
v_cvt_pk_bf16_f32 v251, v242, v248
ds_write_b64 v231, v[250:251] offset:5128
s_waitcnt lgkmcnt(0)
v_exp_f32 v232, v148
v_exp_f32 v233, v149
v_exp_f32 v234, v150
v_exp_f32 v235, v151
s_nop 1
v_cvt_pk_bf16_f32 v166, v232, v233
v_cvt_pk_bf16_f32 v167, v234, v235
v_max_f32 v204, v152, v153
v_max3_f32 v204, v204, v154, v155
v_mov_b32 v205, v204
s_nop 1
v_permlane32_swap_b32 v204, v205
s_nop 1
v_max_f32 v204, v204, v205
v_mov_b32 v205, v204
s_nop 1
v_permlane16_swap_b32 v204, v205
s_nop 1
v_max_f32 v204, v204, v205
v_add_f32 v204, 40.0, v204
v_ceil_f32 v204, v204
v_max_f32 v204, 0, v204
v_sub_f32 v205, v226, v204
v_cvt_pk_bf16_f32 v205, v205, v205
v_and_b32 v205, 0xffff0000, v205
v_sub_f32 v204, v205, v226
v_mov_b32 v226, v205
v_exp_f32 v238, v204
v_bfi_b32 v67, v206, v205, v67
v_add_f32 v152, v152, v204
v_add_f32 v153, v153, v204
v_add_f32 v154, v154, v204
v_add_f32 v155, v155, v204
v_add_f32 v136, v136, v204
v_add_f32 v137, v137, v204
v_add_f32 v138, v138, v204
v_add_f32 v139, v139, v204
v_lshlrev_b32 v242, 16, v168
v_and_b32 v248, 0xffff0000, v168
v_mul_f32 v242, v242, v238
v_mul_f32 v248, v248, v238
v_cvt_pk_bf16_f32 v168, v242, v248
v_lshlrev_b32 v242, 16, v169
v_and_b32 v248, 0xffff0000, v169
v_mul_f32 v242, v242, v238
v_mul_f32 v248, v248, v238
v_cvt_pk_bf16_f32 v169, v242, v248
ds_read_b64 v[250:251], v231 offset:2048
s_waitcnt lgkmcnt(0)
v_lshlrev_b32 v242, 16, v250
v_and_b32 v248, 0xffff0000, v250
v_mul_f32 v242, v242, v238
v_mul_f32 v248, v248, v238
v_cvt_pk_bf16_f32 v250, v242, v248
v_lshlrev_b32 v242, 16, v251
v_and_b32 v248, 0xffff0000, v251
v_mul_f32 v242, v242, v238
v_mul_f32 v248, v248, v238
v_cvt_pk_bf16_f32 v251, v242, v248
ds_write_b64 v231, v[250:251] offset:2048
s_waitcnt lgkmcnt(0)
ds_read_b64 v[250:251], v231 offset:2056
s_waitcnt lgkmcnt(0)
v_lshlrev_b32 v242, 16, v250
v_and_b32 v248, 0xffff0000, v250
v_mul_f32 v242, v242, v238
v_mul_f32 v248, v248, v238
v_cvt_pk_bf16_f32 v250, v242, v248
v_lshlrev_b32 v242, 16, v251
v_and_b32 v248, 0xffff0000, v251
v_mul_f32 v242, v242, v238
v_mul_f32 v248, v248, v238
v_cvt_pk_bf16_f32 v251, v242, v248
ds_write_b64 v231, v[250:251] offset:2056
s_waitcnt lgkmcnt(0)
ds_read_b64 v[250:251], v231 offset:6144
s_waitcnt lgkmcnt(0)
v_lshlrev_b32 v242, 16, v250
v_and_b32 v248, 0xffff0000, v250
v_mul_f32 v242, v242, v238
v_mul_f32 v248, v248, v238
v_cvt_pk_bf16_f32 v250, v242, v248
v_lshlrev_b32 v242, 16, v251
v_and_b32 v248, 0xffff0000, v251
v_mul_f32 v242, v242, v238
v_mul_f32 v248, v248, v238
v_cvt_pk_bf16_f32 v251, v242, v248
ds_write_b64 v231, v[250:251] offset:6144
s_waitcnt lgkmcnt(0)
ds_read_b64 v[250:251], v231 offset:6152
s_waitcnt lgkmcnt(0)
v_lshlrev_b32 v242, 16, v250
v_and_b32 v248, 0xffff0000, v250
v_mul_f32 v242, v242, v238
v_mul_f32 v248, v248, v238
v_cvt_pk_bf16_f32 v250, v242, v248
v_lshlrev_b32 v242, 16, v251
v_and_b32 v248, 0xffff0000, v251
v_mul_f32 v242, v242, v238
v_mul_f32 v248, v248, v238
v_cvt_pk_bf16_f32 v251, v242, v248
ds_write_b64 v231, v[250:251] offset:6152
s_waitcnt lgkmcnt(0)
v_exp_f32 v232, v152
v_exp_f32 v233, v153
v_exp_f32 v234, v154
v_exp_f32 v235, v155
s_nop 1
v_cvt_pk_bf16_f32 v170, v232, v233
v_cvt_pk_bf16_f32 v171, v234, v235
v_max_f32 v204, v156, v157
v_max3_f32 v204, v204, v158, v159
v_mov_b32 v205, v204
s_nop 1
v_permlane32_swap_b32 v204, v205
s_nop 1
v_max_f32 v204, v204, v205
v_mov_b32 v205, v204
s_nop 1
v_permlane16_swap_b32 v204, v205
s_nop 1
v_max_f32 v204, v204, v205
v_add_f32 v204, 40.0, v204
v_ceil_f32 v204, v204
v_max_f32 v204, 0, v204
v_sub_f32 v205, v227, v204
v_cvt_pk_bf16_f32 v205, v205, v205
v_and_b32 v205, 0xffff0000, v205
v_sub_f32 v204, v205, v227
v_mov_b32 v227, v205
v_exp_f32 v239, v204
v_bfi_b32 v99, v206, v205, v99
v_add_f32 v156, v156, v204
v_add_f32 v157, v157, v204
v_add_f32 v158, v158, v204
v_add_f32 v159, v159, v204
v_add_f32 v140, v140, v204
v_add_f32 v141, v141, v204
v_add_f32 v142, v142, v204
v_add_f32 v143, v143, v204
v_lshlrev_b32 v242, 16, v172
v_and_b32 v248, 0xffff0000, v172
v_mul_f32 v242, v242, v239
v_mul_f32 v248, v248, v239
v_cvt_pk_bf16_f32 v172, v242, v248
v_lshlrev_b32 v242, 16, v173
v_and_b32 v248, 0xffff0000, v173
v_mul_f32 v242, v242, v239
v_mul_f32 v248, v248, v239
v_cvt_pk_bf16_f32 v173, v242, v248
ds_read_b64 v[250:251], v231 offset:3072
s_waitcnt lgkmcnt(0)
v_lshlrev_b32 v242, 16, v250
v_and_b32 v248, 0xffff0000, v250
v_mul_f32 v242, v242, v239
v_mul_f32 v248, v248, v239
v_cvt_pk_bf16_f32 v250, v242, v248
v_lshlrev_b32 v242, 16, v251
v_and_b32 v248, 0xffff0000, v251
v_mul_f32 v242, v242, v239
v_mul_f32 v248, v248, v239
v_cvt_pk_bf16_f32 v251, v242, v248
ds_write_b64 v231, v[250:251] offset:3072
s_waitcnt lgkmcnt(0)
ds_read_b64 v[250:251], v231 offset:3080
s_waitcnt lgkmcnt(0)
v_lshlrev_b32 v242, 16, v250
v_and_b32 v248, 0xffff0000, v250
v_mul_f32 v242, v242, v239
v_mul_f32 v248, v248, v239
v_cvt_pk_bf16_f32 v250, v242, v248
v_lshlrev_b32 v242, 16, v251
v_and_b32 v248, 0xffff0000, v251
v_mul_f32 v242, v242, v239
v_mul_f32 v248, v248, v239
v_cvt_pk_bf16_f32 v251, v242, v248
ds_write_b64 v231, v[250:251] offset:3080
s_waitcnt lgkmcnt(0)
ds_read_b64 v[250:251], v231 offset:7168
s_waitcnt lgkmcnt(0)
v_lshlrev_b32 v242, 16, v250
v_and_b32 v248, 0xffff0000, v250
v_mul_f32 v242, v242, v239
v_mul_f32 v248, v248, v239
v_cvt_pk_bf16_f32 v250, v242, v248
v_lshlrev_b32 v242, 16, v251
v_and_b32 v248, 0xffff0000, v251
v_mul_f32 v242, v242, v239
v_mul_f32 v248, v248, v239
v_cvt_pk_bf16_f32 v251, v242, v248
ds_write_b64 v231, v[250:251] offset:7168
s_waitcnt lgkmcnt(0)
ds_read_b64 v[250:251], v231 offset:7176
s_waitcnt lgkmcnt(0)
v_lshlrev_b32 v242, 16, v250
v_and_b32 v248, 0xffff0000, v250
v_mul_f32 v242, v242, v239
v_mul_f32 v248, v248, v239
v_cvt_pk_bf16_f32 v250, v242, v248
v_lshlrev_b32 v242, 16, v251
v_and_b32 v248, 0xffff0000, v251
v_mul_f32 v242, v242, v239
v_mul_f32 v248, v248, v239
v_cvt_pk_bf16_f32 v251, v242, v248
ds_write_b64 v231, v[250:251] offset:7176
s_waitcnt lgkmcnt(0)
v_exp_f32 v232, v156
v_exp_f32 v233, v157
v_exp_f32 v234, v158
v_exp_f32 v235, v159
s_nop 1
v_cvt_pk_bf16_f32 v174, v232, v233
v_cvt_pk_bf16_f32 v175, v234, v235
s_branch L2_rare_common
L2_rare_site14:
s_mov_b32 s36, 14
s_branch L2_rare_t0_2
L2_rare_t0_2:
s_nop 15
s_nop 15
s_waitcnt lgkmcnt(0)
v_lshrrev_b32 v206, 8, v243
v_add_u32 v206, 1, v206
v_lshrrev_b32 v206, 2, v206
v_sub_u32 v206, 0, v206
v_and_b32 v206, 0xffff0000, v206
v_max_f32 v204, v128, v129
v_max3_f32 v204, v204, v130, v131
v_mov_b32 v205, v204
s_nop 1
v_permlane32_swap_b32 v204, v205
s_nop 1
v_max_f32 v204, v204, v205
v_mov_b32 v205, v204
s_nop 1
v_permlane16_swap_b32 v204, v205
s_nop 1
v_max_f32 v204, v204, v205
v_add_f32 v204, 40.0, v204
v_ceil_f32 v204, v204
v_max_f32 v204, 0, v204
v_sub_f32 v205, v224, v204
v_cvt_pk_bf16_f32 v205, v205, v205
v_and_b32 v205, 0xffff0000, v205
v_sub_f32 v204, v205, v224
v_mov_b32 v224, v205
v_exp_f32 v236, v204
v_bfi_b32 v3, v206, v205, v3
v_add_f32 v128, v128, v204
v_add_f32 v129, v129, v204
v_add_f32 v130, v130, v204
v_add_f32 v131, v131, v204
v_add_f32 v144, v144, v204
v_add_f32 v145, v145, v204
v_add_f32 v146, v146, v204
v_add_f32 v147, v147, v204
v_lshlrev_b32 v242, 16, v160
v_and_b32 v248, 0xffff0000, v160
v_mul_f32 v242, v242, v236
v_mul_f32 v248, v248, v236
v_cvt_pk_bf16_f32 v160, v242, v248
v_lshlrev_b32 v242, 16, v161
v_and_b32 v248, 0xffff0000, v161
v_mul_f32 v242, v242, v236
v_mul_f32 v248, v248, v236
v_cvt_pk_bf16_f32 v161, v242, v248
v_lshlrev_b32 v242, 16, v162
v_and_b32 v248, 0xffff0000, v162
v_mul_f32 v242, v242, v236
v_mul_f32 v248, v248, v236
v_cvt_pk_bf16_f32 v162, v242, v248
v_lshlrev_b32 v242, 16, v163
v_and_b32 v248, 0xffff0000, v163
v_mul_f32 v242, v242, v236
v_mul_f32 v248, v248, v236
v_cvt_pk_bf16_f32 v163, v242, v248
ds_read_b64 v[250:251], v231 offset:0
s_waitcnt lgkmcnt(0)
v_lshlrev_b32 v242, 16, v250
v_and_b32 v248, 0xffff0000, v250
v_mul_f32 v242, v242, v236
v_mul_f32 v248, v248, v236
v_cvt_pk_bf16_f32 v250, v242, v248
v_lshlrev_b32 v242, 16, v251
v_and_b32 v248, 0xffff0000, v251
v_mul_f32 v242, v242, v236
v_mul_f32 v248, v248, v236
v_cvt_pk_bf16_f32 v251, v242, v248
ds_write_b64 v231, v[250:251] offset:0
s_waitcnt lgkmcnt(0)
ds_read_b64 v[250:251], v231 offset:8
s_waitcnt lgkmcnt(0)
v_lshlrev_b32 v242, 16, v250
v_and_b32 v248, 0xffff0000, v250
v_mul_f32 v242, v242, v236
v_mul_f32 v248, v248, v236
v_cvt_pk_bf16_f32 v250, v242, v248
v_lshlrev_b32 v242, 16, v251
v_and_b32 v248, 0xffff0000, v251
v_mul_f32 v242, v242, v236
v_mul_f32 v248, v248, v236
v_cvt_pk_bf16_f32 v251, v242, v248
ds_write_b64 v231, v[250:251] offset:8
s_waitcnt lgkmcnt(0)
ds_read_b64 v[250:251], v231 offset:4096
s_waitcnt lgkmcnt(0)
v_lshlrev_b32 v242, 16, v250
v_and_b32 v248, 0xffff0000, v250
v_mul_f32 v242, v242, v236
v_mul_f32 v248, v248, v236
v_cvt_pk_bf16_f32 v250, v242, v248
v_lshlrev_b32 v242, 16, v251
v_and_b32 v248, 0xffff0000, v251
v_mul_f32 v242, v242, v236
v_mul_f32 v248, v248, v236
v_cvt_pk_bf16_f32 v251, v242, v248
ds_write_b64 v231, v[250:251] offset:4096
s_waitcnt lgkmcnt(0)
ds_read_b64 v[250:251], v231 offset:4104
s_waitcnt lgkmcnt(0)
v_lshlrev_b32 v242, 16, v250
v_and_b32 v248, 0xffff0000, v250
v_mul_f32 v242, v242, v236
v_mul_f32 v248, v248, v236
v_cvt_pk_bf16_f32 v250, v242, v248
v_lshlrev_b32 v242, 16, v251
v_and_b32 v248, 0xffff0000, v251
v_mul_f32 v242, v242, v236
v_mul_f32 v248, v248, v236
v_cvt_pk_bf16_f32 v251, v242, v248
ds_write_b64 v231, v[250:251] offset:4104
s_waitcnt lgkmcnt(0)
v_exp_f32 v232, v128
v_exp_f32 v233, v129
v_exp_f32 v234, v130
v_exp_f32 v235, v131
s_nop 1
v_cvt_pk_bf16_f32 v176, v232, v233
v_cvt_pk_bf16_f32 v177, v234, v235
v_max_f32 v204, v132, v133
v_max3_f32 v204, v204, v134, v135
v_mov_b32 v205, v204
s_nop 1
v_permlane32_swap_b32 v204, v205
s_nop 1
v_max_f32 v204, v204, v205
v_mov_b32 v205, v204
s_nop 1
v_permlane16_swap_b32 v204, v205
s_nop 1
v_max_f32 v204, v204, v205
v_add_f32 v204, 40.0, v204
v_ceil_f32 v204, v204
v_max_f32 v204, 0, v204
v_sub_f32 v205, v225, v204
v_cvt_pk_bf16_f32 v205, v205, v205
v_and_b32 v205, 0xffff0000, v205
v_sub_f32 v204, v205, v225
v_mov_b32 v225, v205
v_exp_f32 v237, v204
v_bfi_b32 v35, v206, v205, v35
v_add_f32 v132, v132, v204
v_add_f32 v133, v133, v204
v_add_f32 v134, v134, v204
v_add_f32 v135, v135, v204
v_add_f32 v148, v148, v204
v_add_f32 v149, v149, v204
v_add_f32 v150, v150, v204
v_add_f32 v151, v151, v204
v_lshlrev_b32 v242, 16, v164
v_and_b32 v248, 0xffff0000, v164
v_mul_f32 v242, v242, v237
v_mul_f32 v248, v248, v237
v_cvt_pk_bf16_f32 v164, v242, v248
v_lshlrev_b32 v242, 16, v165
v_and_b32 v248, 0xffff0000, v165
v_mul_f32 v242, v242, v237
v_mul_f32 v248, v248, v237
v_cvt_pk_bf16_f32 v165, v242, v248
v_lshlrev_b32 v242, 16, v166
v_and_b32 v248, 0xffff0000, v166
v_mul_f32 v242, v242, v237
v_mul_f32 v248, v248, v237
v_cvt_pk_bf16_f32 v166, v242, v248
v_lshlrev_b32 v242, 16, v167
v_and_b32 v248, 0xffff0000, v167
v_mul_f32 v242, v242, v237
v_mul_f32 v248, v248, v237
v_cvt_pk_bf16_f32 v167, v242, v248
ds_read_b64 v[250:251], v231 offset:1024
s_waitcnt lgkmcnt(0)
v_lshlrev_b32 v242, 16, v250
v_and_b32 v248, 0xffff0000, v250
v_mul_f32 v242, v242, v237
v_mul_f32 v248, v248, v237
v_cvt_pk_bf16_f32 v250, v242, v248
v_lshlrev_b32 v242, 16, v251
v_and_b32 v248, 0xffff0000, v251
v_mul_f32 v242, v242, v237
v_mul_f32 v248, v248, v237
v_cvt_pk_bf16_f32 v251, v242, v248
ds_write_b64 v231, v[250:251] offset:1024
s_waitcnt lgkmcnt(0)
ds_read_b64 v[250:251], v231 offset:1032
s_waitcnt lgkmcnt(0)
v_lshlrev_b32 v242, 16, v250
v_and_b32 v248, 0xffff0000, v250
v_mul_f32 v242, v242, v237
v_mul_f32 v248, v248, v237
v_cvt_pk_bf16_f32 v250, v242, v248
v_lshlrev_b32 v242, 16, v251
v_and_b32 v248, 0xffff0000, v251
v_mul_f32 v242, v242, v237
v_mul_f32 v248, v248, v237
v_cvt_pk_bf16_f32 v251, v242, v248
ds_write_b64 v231, v[250:251] offset:1032
s_waitcnt lgkmcnt(0)
ds_read_b64 v[250:251], v231 offset:5120
s_waitcnt lgkmcnt(0)
v_lshlrev_b32 v242, 16, v250
v_and_b32 v248, 0xffff0000, v250
v_mul_f32 v242, v242, v237
v_mul_f32 v248, v248, v237
v_cvt_pk_bf16_f32 v250, v242, v248
v_lshlrev_b32 v242, 16, v251
v_and_b32 v248, 0xffff0000, v251
v_mul_f32 v242, v242, v237
v_mul_f32 v248, v248, v237
v_cvt_pk_bf16_f32 v251, v242, v248
ds_write_b64 v231, v[250:251] offset:5120
s_waitcnt lgkmcnt(0)
ds_read_b64 v[250:251], v231 offset:5128
s_waitcnt lgkmcnt(0)
v_lshlrev_b32 v242, 16, v250
v_and_b32 v248, 0xffff0000, v250
v_mul_f32 v242, v242, v237
v_mul_f32 v248, v248, v237
v_cvt_pk_bf16_f32 v250, v242, v248
v_lshlrev_b32 v242, 16, v251
v_and_b32 v248, 0xffff0000, v251
v_mul_f32 v242, v242, v237
v_mul_f32 v248, v248, v237
v_cvt_pk_bf16_f32 v251, v242, v248
ds_write_b64 v231, v[250:251] offset:5128
s_waitcnt lgkmcnt(0)
v_exp_f32 v232, v132
v_exp_f32 v233, v133
v_exp_f32 v234, v134
v_exp_f32 v235, v135
s_nop 1
v_cvt_pk_bf16_f32 v180, v232, v233
v_cvt_pk_bf16_f32 v181, v234, v235
v_max_f32 v204, v136, v137
v_max3_f32 v204, v204, v138, v139
v_mov_b32 v205, v204
s_nop 1
v_permlane32_swap_b32 v204, v205
s_nop 1
v_max_f32 v204, v204, v205
v_mov_b32 v205, v204
s_nop 1
v_permlane16_swap_b32 v204, v205
s_nop 1
v_max_f32 v204, v204, v205
v_add_f32 v204, 40.0, v204
v_ceil_f32 v204, v204
v_max_f32 v204, 0, v204
v_sub_f32 v205, v226, v204
v_cvt_pk_bf16_f32 v205, v205, v205
v_and_b32 v205, 0xffff0000, v205
v_sub_f32 v204, v205, v226
v_mov_b32 v226, v205
v_exp_f32 v238, v204
v_bfi_b32 v67, v206, v205, v67
v_add_f32 v136, v136, v204
v_add_f32 v137, v137, v204
v_add_f32 v138, v138, v204
v_add_f32 v139, v139, v204
v_add_f32 v152, v152, v204
v_add_f32 v153, v153, v204
v_add_f32 v154, v154, v204
v_add_f32 v155, v155, v204
v_lshlrev_b32 v242, 16, v168
v_and_b32 v248, 0xffff0000, v168
v_mul_f32 v242, v242, v238
v_mul_f32 v248, v248, v238
v_cvt_pk_bf16_f32 v168, v242, v248
v_lshlrev_b32 v242, 16, v169
v_and_b32 v248, 0xffff0000, v169
v_mul_f32 v242, v242, v238
v_mul_f32 v248, v248, v238
v_cvt_pk_bf16_f32 v169, v242, v248
v_lshlrev_b32 v242, 16, v170
v_and_b32 v248, 0xffff0000, v170
v_mul_f32 v242, v242, v238
v_mul_f32 v248, v248, v238
v_cvt_pk_bf16_f32 v170, v242, v248
v_lshlrev_b32 v242, 16, v171
v_and_b32 v248, 0xffff0000, v171
v_mul_f32 v242, v242, v238
v_mul_f32 v248, v248, v238
v_cvt_pk_bf16_f32 v171, v242, v248
ds_read_b64 v[250:251], v231 offset:2048
s_waitcnt lgkmcnt(0)
v_lshlrev_b32 v242, 16, v250
v_and_b32 v248, 0xffff0000, v250
v_mul_f32 v242, v242, v238
v_mul_f32 v248, v248, v238
v_cvt_pk_bf16_f32 v250, v242, v248
v_lshlrev_b32 v242, 16, v251
v_and_b32 v248, 0xffff0000, v251
v_mul_f32 v242, v242, v238
v_mul_f32 v248, v248, v238
v_cvt_pk_bf16_f32 v251, v242, v248
ds_write_b64 v231, v[250:251] offset:2048
s_waitcnt lgkmcnt(0)
ds_read_b64 v[250:251], v231 offset:2056
s_waitcnt lgkmcnt(0)
v_lshlrev_b32 v242, 16, v250
v_and_b32 v248, 0xffff0000, v250
v_mul_f32 v242, v242, v238
v_mul_f32 v248, v248, v238
v_cvt_pk_bf16_f32 v250, v242, v248
v_lshlrev_b32 v242, 16, v251
v_and_b32 v248, 0xffff0000, v251
v_mul_f32 v242, v242, v238
v_mul_f32 v248, v248, v238
v_cvt_pk_bf16_f32 v251, v242, v248
ds_write_b64 v231, v[250:251] offset:2056
s_waitcnt lgkmcnt(0)
ds_read_b64 v[250:251], v231 offset:6144
s_waitcnt lgkmcnt(0)
v_lshlrev_b32 v242, 16, v250
v_and_b32 v248, 0xffff0000, v250
v_mul_f32 v242, v242, v238
v_mul_f32 v248, v248, v238
v_cvt_pk_bf16_f32 v250, v242, v248
v_lshlrev_b32 v242, 16, v251
v_and_b32 v248, 0xffff0000, v251
v_mul_f32 v242, v242, v238
v_mul_f32 v248, v248, v238
v_cvt_pk_bf16_f32 v251, v242, v248
ds_write_b64 v231, v[250:251] offset:6144
s_waitcnt lgkmcnt(0)
ds_read_b64 v[250:251], v231 offset:6152
s_waitcnt lgkmcnt(0)
v_lshlrev_b32 v242, 16, v250
v_and_b32 v248, 0xffff0000, v250
v_mul_f32 v242, v242, v238
v_mul_f32 v248, v248, v238
v_cvt_pk_bf16_f32 v250, v242, v248
v_lshlrev_b32 v242, 16, v251
v_and_b32 v248, 0xffff0000, v251
v_mul_f32 v242, v242, v238
v_mul_f32 v248, v248, v238
v_cvt_pk_bf16_f32 v251, v242, v248
ds_write_b64 v231, v[250:251] offset:6152
s_waitcnt lgkmcnt(0)
v_exp_f32 v232, v136
v_exp_f32 v233, v137
v_exp_f32 v234, v138
v_exp_f32 v235, v139
s_nop 1
v_cvt_pk_bf16_f32 v184, v232, v233
v_cvt_pk_bf16_f32 v185, v234, v235
v_max_f32 v204, v140, v141
v_max3_f32 v204, v204, v142, v143
v_mov_b32 v205, v204
s_nop 1
v_permlane32_swap_b32 v204, v205
s_nop 1
v_max_f32 v204, v204, v205
v_mov_b32 v205, v204
s_nop 1
v_permlane16_swap_b32 v204, v205
s_nop 1
v_max_f32 v204, v204, v205
v_add_f32 v204, 40.0, v204
v_ceil_f32 v204, v204
v_max_f32 v204, 0, v204
v_sub_f32 v205, v227, v204
v_cvt_pk_bf16_f32 v205, v205, v205
v_and_b32 v205, 0xffff0000, v205
v_sub_f32 v204, v205, v227
v_mov_b32 v227, v205
v_exp_f32 v239, v204
v_bfi_b32 v99, v206, v205, v99
v_add_f32 v140, v140, v204
v_add_f32 v141, v141, v204
v_add_f32 v142, v142, v204
v_add_f32 v143, v143, v204
v_add_f32 v156, v156, v204
v_add_f32 v157, v157, v204
v_add_f32 v158, v158, v204
v_add_f32 v159, v159, v204
v_lshlrev_b32 v242, 16, v172
v_and_b32 v248, 0xffff0000, v172
v_mul_f32 v242, v242, v239
v_mul_f32 v248, v248, v239
v_cvt_pk_bf16_f32 v172, v242, v248
v_lshlrev_b32 v242, 16, v173
v_and_b32 v248, 0xffff0000, v173
v_mul_f32 v242, v242, v239
v_mul_f32 v248, v248, v239
v_cvt_pk_bf16_f32 v173, v242, v248
v_lshlrev_b32 v242, 16, v174
v_and_b32 v248, 0xffff0000, v174
v_mul_f32 v242, v242, v239
v_mul_f32 v248, v248, v239
v_cvt_pk_bf16_f32 v174, v242, v248
v_lshlrev_b32 v242, 16, v175
v_and_b32 v248, 0xffff0000, v175
v_mul_f32 v242, v242, v239
v_mul_f32 v248, v248, v239
v_cvt_pk_bf16_f32 v175, v242, v248
ds_read_b64 v[250:251], v231 offset:3072
s_waitcnt lgkmcnt(0)
v_lshlrev_b32 v242, 16, v250
v_and_b32 v248, 0xffff0000, v250
v_mul_f32 v242, v242, v239
v_mul_f32 v248, v248, v239
v_cvt_pk_bf16_f32 v250, v242, v248
v_lshlrev_b32 v242, 16, v251
v_and_b32 v248, 0xffff0000, v251
v_mul_f32 v242, v242, v239
v_mul_f32 v248, v248, v239
v_cvt_pk_bf16_f32 v251, v242, v248
ds_write_b64 v231, v[250:251] offset:3072
s_waitcnt lgkmcnt(0)
ds_read_b64 v[250:251], v231 offset:3080
s_waitcnt lgkmcnt(0)
v_lshlrev_b32 v242, 16, v250
v_and_b32 v248, 0xffff0000, v250
v_mul_f32 v242, v242, v239
v_mul_f32 v248, v248, v239
v_cvt_pk_bf16_f32 v250, v242, v248
v_lshlrev_b32 v242, 16, v251
v_and_b32 v248, 0xffff0000, v251
v_mul_f32 v242, v242, v239
v_mul_f32 v248, v248, v239
v_cvt_pk_bf16_f32 v251, v242, v248
ds_write_b64 v231, v[250:251] offset:3080
s_waitcnt lgkmcnt(0)
ds_read_b64 v[250:251], v231 offset:7168
s_waitcnt lgkmcnt(0)
v_lshlrev_b32 v242, 16, v250
v_and_b32 v248, 0xffff0000, v250
v_mul_f32 v242, v242, v239
v_mul_f32 v248, v248, v239
v_cvt_pk_bf16_f32 v250, v242, v248
v_lshlrev_b32 v242, 16, v251
v_and_b32 v248, 0xffff0000, v251
v_mul_f32 v242, v242, v239
v_mul_f32 v248, v248, v239
v_cvt_pk_bf16_f32 v251, v242, v248
ds_write_b64 v231, v[250:251] offset:7168
s_waitcnt lgkmcnt(0)
ds_read_b64 v[250:251], v231 offset:7176
s_waitcnt lgkmcnt(0)
v_lshlrev_b32 v242, 16, v250
v_and_b32 v248, 0xffff0000, v250
v_mul_f32 v242, v242, v239
v_mul_f32 v248, v248, v239
v_cvt_pk_bf16_f32 v250, v242, v248
v_lshlrev_b32 v242, 16, v251
v_and_b32 v248, 0xffff0000, v251
v_mul_f32 v242, v242, v239
v_mul_f32 v248, v248, v239
v_cvt_pk_bf16_f32 v251, v242, v248
ds_write_b64 v231, v[250:251] offset:7176
s_waitcnt lgkmcnt(0)
v_exp_f32 v232, v140
v_exp_f32 v233, v141
v_exp_f32 v234, v142
v_exp_f32 v235, v143
s_nop 1
v_cvt_pk_bf16_f32 v188, v232, v233
v_cvt_pk_bf16_f32 v189, v234, v235
s_branch L2_rare_common
L2_rare_site15:
s_mov_b32 s36, 15
s_branch L2_rare_t0_3
L2_rare_t0_3:
s_nop 15
s_nop 15
s_waitcnt lgkmcnt(0)
v_lshrrev_b32 v206, 8, v243
v_add_u32 v206, 1, v206
v_lshrrev_b32 v206, 2, v206
v_sub_u32 v206, 0, v206
v_and_b32 v206, 0xffff0000, v206
v_max_f32 v204, v144, v145
v_max3_f32 v204, v204, v146, v147
v_mov_b32 v205, v204
s_nop 1
v_permlane32_swap_b32 v204, v205
s_nop 1
v_max_f32 v204, v204, v205
v_mov_b32 v205, v204
s_nop 1
v_permlane16_swap_b32 v204, v205
s_nop 1
v_max_f32 v204, v204, v205
v_add_f32 v204, 40.0, v204
v_ceil_f32 v204, v204
v_max_f32 v204, 0, v204
v_sub_f32 v205, v224, v204
v_cvt_pk_bf16_f32 v205, v205, v205
v_and_b32 v205, 0xffff0000, v205
v_sub_f32 v204, v205, v224
v_mov_b32 v224, v205
v_exp_f32 v236, v204
v_bfi_b32 v3, v206, v205, v3
v_add_f32 v144, v144, v204
v_add_f32 v145, v145, v204
v_add_f32 v146, v146, v204
v_add_f32 v147, v147, v204
v_add_f32 v128, v128, v204
v_add_f32 v129, v129, v204
v_add_f32 v130, v130, v204
v_add_f32 v131, v131, v204
v_lshlrev_b32 v242, 16, v160
v_and_b32 v248, 0xffff0000, v160
v_mul_f32 v242, v242, v236
v_mul_f32 v248, v248, v236
v_cvt_pk_bf16_f32 v160, v242, v248
v_lshlrev_b32 v242, 16, v161
v_and_b32 v248, 0xffff0000, v161
v_mul_f32 v242, v242, v236
v_mul_f32 v248, v248, v236
v_cvt_pk_bf16_f32 v161, v242, v248
v_lshlrev_b32 v242, 16, v162
v_and_b32 v248, 0xffff0000, v162
v_mul_f32 v242, v242, v236
v_mul_f32 v248, v248, v236
v_cvt_pk_bf16_f32 v162, v242, v248
v_lshlrev_b32 v242, 16, v163
v_and_b32 v248, 0xffff0000, v163
v_mul_f32 v242, v242, v236
v_mul_f32 v248, v248, v236
v_cvt_pk_bf16_f32 v163, v242, v248
v_lshlrev_b32 v242, 16, v176
v_and_b32 v248, 0xffff0000, v176
v_mul_f32 v242, v242, v236
v_mul_f32 v248, v248, v236
v_cvt_pk_bf16_f32 v176, v242, v248
v_lshlrev_b32 v242, 16, v177
v_and_b32 v248, 0xffff0000, v177
v_mul_f32 v242, v242, v236
v_mul_f32 v248, v248, v236
v_cvt_pk_bf16_f32 v177, v242, v248
ds_read_b64 v[250:251], v231 offset:0
s_waitcnt lgkmcnt(0)
v_lshlrev_b32 v242, 16, v250
v_and_b32 v248, 0xffff0000, v250
v_mul_f32 v242, v242, v236
v_mul_f32 v248, v248, v236
v_cvt_pk_bf16_f32 v250, v242, v248
v_lshlrev_b32 v242, 16, v251
v_and_b32 v248, 0xffff0000, v251
v_mul_f32 v242, v242, v236
v_mul_f32 v248, v248, v236
v_cvt_pk_bf16_f32 v251, v242, v248
ds_write_b64 v231, v[250:251] offset:0
s_waitcnt lgkmcnt(0)
ds_read_b64 v[250:251], v231 offset:8
s_waitcnt lgkmcnt(0)
v_lshlrev_b32 v242, 16, v250
v_and_b32 v248, 0xffff0000, v250
v_mul_f32 v242, v242, v236
v_mul_f32 v248, v248, v236
v_cvt_pk_bf16_f32 v250, v242, v248
v_lshlrev_b32 v242, 16, v251
v_and_b32 v248, 0xffff0000, v251
v_mul_f32 v242, v242, v236
v_mul_f32 v248, v248, v236
v_cvt_pk_bf16_f32 v251, v242, v248
ds_write_b64 v231, v[250:251] offset:8
s_waitcnt lgkmcnt(0)
ds_read_b64 v[250:251], v231 offset:4096
s_waitcnt lgkmcnt(0)
v_lshlrev_b32 v242, 16, v250
v_and_b32 v248, 0xffff0000, v250
v_mul_f32 v242, v242, v236
v_mul_f32 v248, v248, v236
v_cvt_pk_bf16_f32 v250, v242, v248
v_lshlrev_b32 v242, 16, v251
v_and_b32 v248, 0xffff0000, v251
v_mul_f32 v242, v242, v236
v_mul_f32 v248, v248, v236
v_cvt_pk_bf16_f32 v251, v242, v248
ds_write_b64 v231, v[250:251] offset:4096
s_waitcnt lgkmcnt(0)
ds_read_b64 v[250:251], v231 offset:4104
s_waitcnt lgkmcnt(0)
v_lshlrev_b32 v242, 16, v250
v_and_b32 v248, 0xffff0000, v250
v_mul_f32 v242, v242, v236
v_mul_f32 v248, v248, v236
v_cvt_pk_bf16_f32 v250, v242, v248
v_lshlrev_b32 v242, 16, v251
v_and_b32 v248, 0xffff0000, v251
v_mul_f32 v242, v242, v236
v_mul_f32 v248, v248, v236
v_cvt_pk_bf16_f32 v251, v242, v248
ds_write_b64 v231, v[250:251] offset:4104
s_waitcnt lgkmcnt(0)
v_exp_f32 v232, v144
v_exp_f32 v233, v145
v_exp_f32 v234, v146
v_exp_f32 v235, v147
s_nop 1
v_cvt_pk_bf16_f32 v178, v232, v233
v_cvt_pk_bf16_f32 v179, v234, v235
v_max_f32 v204, v148, v149
v_max3_f32 v204, v204, v150, v151
v_mov_b32 v205, v204
s_nop 1
v_permlane32_swap_b32 v204, v205
s_nop 1
v_max_f32 v204, v204, v205
v_mov_b32 v205, v204
s_nop 1
v_permlane16_swap_b32 v204, v205
s_nop 1
v_max_f32 v204, v204, v205
v_add_f32 v204, 40.0, v204
v_ceil_f32 v204, v204
v_max_f32 v204, 0, v204
v_sub_f32 v205, v225, v204
v_cvt_pk_bf16_f32 v205, v205, v205
v_and_b32 v205, 0xffff0000, v205
v_sub_f32 v204, v205, v225
v_mov_b32 v225, v205
v_exp_f32 v237, v204
v_bfi_b32 v35, v206, v205, v35
v_add_f32 v148, v148, v204
v_add_f32 v149, v149, v204
v_add_f32 v150, v150, v204
v_add_f32 v151, v151, v204
v_add_f32 v132, v132, v204
v_add_f32 v133, v133, v204
v_add_f32 v134, v134, v204
v_add_f32 v135, v135, v204
v_lshlrev_b32 v242, 16, v164
v_and_b32 v248, 0xffff0000, v164
v_mul_f32 v242, v242, v237
v_mul_f32 v248, v248, v237
v_cvt_pk_bf16_f32 v164, v242, v248
v_lshlrev_b32 v242, 16, v165
v_and_b32 v248, 0xffff0000, v165
v_mul_f32 v242, v242, v237
v_mul_f32 v248, v248, v237
v_cvt_pk_bf16_f32 v165, v242, v248
v_lshlrev_b32 v242, 16, v166
v_and_b32 v248, 0xffff0000, v166
v_mul_f32 v242, v242, v237
v_mul_f32 v248, v248, v237
v_cvt_pk_bf16_f32 v166, v242, v248
v_lshlrev_b32 v242, 16, v167
v_and_b32 v248, 0xffff0000, v167
v_mul_f32 v242, v242, v237
v_mul_f32 v248, v248, v237
v_cvt_pk_bf16_f32 v167, v242, v248
v_lshlrev_b32 v242, 16, v180
v_and_b32 v248, 0xffff0000, v180
v_mul_f32 v242, v242, v237
v_mul_f32 v248, v248, v237
v_cvt_pk_bf16_f32 v180, v242, v248
v_lshlrev_b32 v242, 16, v181
v_and_b32 v248, 0xffff0000, v181
v_mul_f32 v242, v242, v237
v_mul_f32 v248, v248, v237
v_cvt_pk_bf16_f32 v181, v242, v248
ds_read_b64 v[250:251], v231 offset:1024
s_waitcnt lgkmcnt(0)
v_lshlrev_b32 v242, 16, v250
v_and_b32 v248, 0xffff0000, v250
v_mul_f32 v242, v242, v237
v_mul_f32 v248, v248, v237
v_cvt_pk_bf16_f32 v250, v242, v248
v_lshlrev_b32 v242, 16, v251
v_and_b32 v248, 0xffff0000, v251
v_mul_f32 v242, v242, v237
v_mul_f32 v248, v248, v237
v_cvt_pk_bf16_f32 v251, v242, v248
ds_write_b64 v231, v[250:251] offset:1024
s_waitcnt lgkmcnt(0)
ds_read_b64 v[250:251], v231 offset:1032
s_waitcnt lgkmcnt(0)
v_lshlrev_b32 v242, 16, v250
v_and_b32 v248, 0xffff0000, v250
v_mul_f32 v242, v242, v237
v_mul_f32 v248, v248, v237
v_cvt_pk_bf16_f32 v250, v242, v248
v_lshlrev_b32 v242, 16, v251
v_and_b32 v248, 0xffff0000, v251
v_mul_f32 v242, v242, v237
v_mul_f32 v248, v248, v237
v_cvt_pk_bf16_f32 v251, v242, v248
ds_write_b64 v231, v[250:251] offset:1032
s_waitcnt lgkmcnt(0)
ds_read_b64 v[250:251], v231 offset:5120
s_waitcnt lgkmcnt(0)
v_lshlrev_b32 v242, 16, v250
v_and_b32 v248, 0xffff0000, v250
v_mul_f32 v242, v242, v237
v_mul_f32 v248, v248, v237
v_cvt_pk_bf16_f32 v250, v242, v248
v_lshlrev_b32 v242, 16, v251
v_and_b32 v248, 0xffff0000, v251
v_mul_f32 v242, v242, v237
v_mul_f32 v248, v248, v237
v_cvt_pk_bf16_f32 v251, v242, v248
ds_write_b64 v231, v[250:251] offset:5120
s_waitcnt lgkmcnt(0)
ds_read_b64 v[250:251], v231 offset:5128
s_waitcnt lgkmcnt(0)
v_lshlrev_b32 v242, 16, v250
v_and_b32 v248, 0xffff0000, v250
v_mul_f32 v242, v242, v237
v_mul_f32 v248, v248, v237
v_cvt_pk_bf16_f32 v250, v242, v248
v_lshlrev_b32 v242, 16, v251
v_and_b32 v248, 0xffff0000, v251
v_mul_f32 v242, v242, v237
v_mul_f32 v248, v248, v237
v_cvt_pk_bf16_f32 v251, v242, v248
ds_write_b64 v231, v[250:251] offset:5128
s_waitcnt lgkmcnt(0)
v_exp_f32 v232, v148
v_exp_f32 v233, v149
v_exp_f32 v234, v150
v_exp_f32 v235, v151
s_nop 1
v_cvt_pk_bf16_f32 v182, v232, v233
v_cvt_pk_bf16_f32 v183, v234, v235
v_max_f32 v204, v152, v153
v_max3_f32 v204, v204, v154, v155
v_mov_b32 v205, v204
s_nop 1
v_permlane32_swap_b32 v204, v205
s_nop 1
v_max_f32 v204, v204, v205
v_mov_b32 v205, v204
s_nop 1
v_permlane16_swap_b32 v204, v205
s_nop 1
v_max_f32 v204, v204, v205
v_add_f32 v204, 40.0, v204
v_ceil_f32 v204, v204
v_max_f32 v204, 0, v204
v_sub_f32 v205, v226, v204
v_cvt_pk_bf16_f32 v205, v205, v205
v_and_b32 v205, 0xffff0000, v205
v_sub_f32 v204, v205, v226
v_mov_b32 v226, v205
v_exp_f32 v238, v204
v_bfi_b32 v67, v206, v205, v67
v_add_f32 v152, v152, v204
v_add_f32 v153, v153, v204
v_add_f32 v154, v154, v204
v_add_f32 v155, v155, v204
v_add_f32 v136, v136, v204
v_add_f32 v137, v137, v204
v_add_f32 v138, v138, v204
v_add_f32 v139, v139, v204
v_lshlrev_b32 v242, 16, v168
v_and_b32 v248, 0xffff0000, v168
v_mul_f32 v242, v242, v238
v_mul_f32 v248, v248, v238
v_cvt_pk_bf16_f32 v168, v242, v248
v_lshlrev_b32 v242, 16, v169
v_and_b32 v248, 0xffff0000, v169
v_mul_f32 v242, v242, v238
v_mul_f32 v248, v248, v238
v_cvt_pk_bf16_f32 v169, v242, v248
v_lshlrev_b32 v242, 16, v170
v_and_b32 v248, 0xffff0000, v170
v_mul_f32 v242, v242, v238
v_mul_f32 v248, v248, v238
v_cvt_pk_bf16_f32 v170, v242, v248
v_lshlrev_b32 v242, 16, v171
v_and_b32 v248, 0xffff0000, v171
v_mul_f32 v242, v242, v238
v_mul_f32 v248, v248, v238
v_cvt_pk_bf16_f32 v171, v242, v248
v_lshlrev_b32 v242, 16, v184
v_and_b32 v248, 0xffff0000, v184
v_mul_f32 v242, v242, v238
v_mul_f32 v248, v248, v238
v_cvt_pk_bf16_f32 v184, v242, v248
v_lshlrev_b32 v242, 16, v185
v_and_b32 v248, 0xffff0000, v185
v_mul_f32 v242, v242, v238
v_mul_f32 v248, v248, v238
v_cvt_pk_bf16_f32 v185, v242, v248
ds_read_b64 v[250:251], v231 offset:2048
s_waitcnt lgkmcnt(0)
v_lshlrev_b32 v242, 16, v250
v_and_b32 v248, 0xffff0000, v250
v_mul_f32 v242, v242, v238
v_mul_f32 v248, v248, v238
v_cvt_pk_bf16_f32 v250, v242, v248
v_lshlrev_b32 v242, 16, v251
v_and_b32 v248, 0xffff0000, v251
v_mul_f32 v242, v242, v238
v_mul_f32 v248, v248, v238
v_cvt_pk_bf16_f32 v251, v242, v248
ds_write_b64 v231, v[250:251] offset:2048
s_waitcnt lgkmcnt(0)
ds_read_b64 v[250:251], v231 offset:2056
s_waitcnt lgkmcnt(0)
v_lshlrev_b32 v242, 16, v250
v_and_b32 v248, 0xffff0000, v250
v_mul_f32 v242, v242, v238
v_mul_f32 v248, v248, v238
v_cvt_pk_bf16_f32 v250, v242, v248
v_lshlrev_b32 v242, 16, v251
v_and_b32 v248, 0xffff0000, v251
v_mul_f32 v242, v242, v238
v_mul_f32 v248, v248, v238
v_cvt_pk_bf16_f32 v251, v242, v248
ds_write_b64 v231, v[250:251] offset:2056
s_waitcnt lgkmcnt(0)
ds_read_b64 v[250:251], v231 offset:6144
s_waitcnt lgkmcnt(0)
v_lshlrev_b32 v242, 16, v250
v_and_b32 v248, 0xffff0000, v250
v_mul_f32 v242, v242, v238
v_mul_f32 v248, v248, v238
v_cvt_pk_bf16_f32 v250, v242, v248
v_lshlrev_b32 v242, 16, v251
v_and_b32 v248, 0xffff0000, v251
v_mul_f32 v242, v242, v238
v_mul_f32 v248, v248, v238
v_cvt_pk_bf16_f32 v251, v242, v248
ds_write_b64 v231, v[250:251] offset:6144
s_waitcnt lgkmcnt(0)
ds_read_b64 v[250:251], v231 offset:6152
s_waitcnt lgkmcnt(0)
v_lshlrev_b32 v242, 16, v250
v_and_b32 v248, 0xffff0000, v250
v_mul_f32 v242, v242, v238
v_mul_f32 v248, v248, v238
v_cvt_pk_bf16_f32 v250, v242, v248
v_lshlrev_b32 v242, 16, v251
v_and_b32 v248, 0xffff0000, v251
v_mul_f32 v242, v242, v238
v_mul_f32 v248, v248, v238
v_cvt_pk_bf16_f32 v251, v242, v248
ds_write_b64 v231, v[250:251] offset:6152
s_waitcnt lgkmcnt(0)
v_exp_f32 v232, v152
v_exp_f32 v233, v153
v_exp_f32 v234, v154
v_exp_f32 v235, v155
s_nop 1
v_cvt_pk_bf16_f32 v186, v232, v233
v_cvt_pk_bf16_f32 v187, v234, v235
v_max_f32 v204, v156, v157
v_max3_f32 v204, v204, v158, v159
v_mov_b32 v205, v204
s_nop 1
v_permlane32_swap_b32 v204, v205
s_nop 1
v_max_f32 v204, v204, v205
v_mov_b32 v205, v204
s_nop 1
v_permlane16_swap_b32 v204, v205
s_nop 1
v_max_f32 v204, v204, v205
v_add_f32 v204, 40.0, v204
v_ceil_f32 v204, v204
v_max_f32 v204, 0, v204
v_sub_f32 v205, v227, v204
v_cvt_pk_bf16_f32 v205, v205, v205
v_and_b32 v205, 0xffff0000, v205
v_sub_f32 v204, v205, v227
v_mov_b32 v227, v205
v_exp_f32 v239, v204
v_bfi_b32 v99, v206, v205, v99
v_add_f32 v156, v156, v204
v_add_f32 v157, v157, v204
v_add_f32 v158, v158, v204
v_add_f32 v159, v159, v204
v_add_f32 v140, v140, v204
v_add_f32 v141, v141, v204
v_add_f32 v142, v142, v204
v_add_f32 v143, v143, v204
v_lshlrev_b32 v242, 16, v172
v_and_b32 v248, 0xffff0000, v172
v_mul_f32 v242, v242, v239
v_mul_f32 v248, v248, v239
v_cvt_pk_bf16_f32 v172, v242, v248
v_lshlrev_b32 v242, 16, v173
v_and_b32 v248, 0xffff0000, v173
v_mul_f32 v242, v242, v239
v_mul_f32 v248, v248, v239
v_cvt_pk_bf16_f32 v173, v242, v248
v_lshlrev_b32 v242, 16, v174
v_and_b32 v248, 0xffff0000, v174
v_mul_f32 v242, v242, v239
v_mul_f32 v248, v248, v239
v_cvt_pk_bf16_f32 v174, v242, v248
v_lshlrev_b32 v242, 16, v175
v_and_b32 v248, 0xffff0000, v175
v_mul_f32 v242, v242, v239
v_mul_f32 v248, v248, v239
v_cvt_pk_bf16_f32 v175, v242, v248
v_lshlrev_b32 v242, 16, v188
v_and_b32 v248, 0xffff0000, v188
v_mul_f32 v242, v242, v239
v_mul_f32 v248, v248, v239
v_cvt_pk_bf16_f32 v188, v242, v248
v_lshlrev_b32 v242, 16, v189
v_and_b32 v248, 0xffff0000, v189
v_mul_f32 v242, v242, v239
v_mul_f32 v248, v248, v239
v_cvt_pk_bf16_f32 v189, v242, v248
ds_read_b64 v[250:251], v231 offset:3072
s_waitcnt lgkmcnt(0)
v_lshlrev_b32 v242, 16, v250
v_and_b32 v248, 0xffff0000, v250
v_mul_f32 v242, v242, v239
v_mul_f32 v248, v248, v239
v_cvt_pk_bf16_f32 v250, v242, v248
v_lshlrev_b32 v242, 16, v251
v_and_b32 v248, 0xffff0000, v251
v_mul_f32 v242, v242, v239
v_mul_f32 v248, v248, v239
v_cvt_pk_bf16_f32 v251, v242, v248
ds_write_b64 v231, v[250:251] offset:3072
s_waitcnt lgkmcnt(0)
ds_read_b64 v[250:251], v231 offset:3080
s_waitcnt lgkmcnt(0)
v_lshlrev_b32 v242, 16, v250
v_and_b32 v248, 0xffff0000, v250
v_mul_f32 v242, v242, v239
v_mul_f32 v248, v248, v239
v_cvt_pk_bf16_f32 v250, v242, v248
v_lshlrev_b32 v242, 16, v251
v_and_b32 v248, 0xffff0000, v251
v_mul_f32 v242, v242, v239
v_mul_f32 v248, v248, v239
v_cvt_pk_bf16_f32 v251, v242, v248
ds_write_b64 v231, v[250:251] offset:3080
s_waitcnt lgkmcnt(0)
ds_read_b64 v[250:251], v231 offset:7168
s_waitcnt lgkmcnt(0)
v_lshlrev_b32 v242, 16, v250
v_and_b32 v248, 0xffff0000, v250
v_mul_f32 v242, v242, v239
v_mul_f32 v248, v248, v239
v_cvt_pk_bf16_f32 v250, v242, v248
v_lshlrev_b32 v242, 16, v251
v_and_b32 v248, 0xffff0000, v251
v_mul_f32 v242, v242, v239
v_mul_f32 v248, v248, v239
v_cvt_pk_bf16_f32 v251, v242, v248
ds_write_b64 v231, v[250:251] offset:7168
s_waitcnt lgkmcnt(0)
ds_read_b64 v[250:251], v231 offset:7176
s_waitcnt lgkmcnt(0)
v_lshlrev_b32 v242, 16, v250
v_and_b32 v248, 0xffff0000, v250
v_mul_f32 v242, v242, v239
v_mul_f32 v248, v248, v239
v_cvt_pk_bf16_f32 v250, v242, v248
v_lshlrev_b32 v242, 16, v251
v_and_b32 v248, 0xffff0000, v251
v_mul_f32 v242, v242, v239
v_mul_f32 v248, v248, v239
v_cvt_pk_bf16_f32 v251, v242, v248
ds_write_b64 v231, v[250:251] offset:7176
s_waitcnt lgkmcnt(0)
v_exp_f32 v232, v156
v_exp_f32 v233, v157
v_exp_f32 v234, v158
v_exp_f32 v235, v159
s_nop 1
v_cvt_pk_bf16_f32 v190, v232, v233
v_cvt_pk_bf16_f32 v191, v234, v235
s_branch L2_rare_common
L2_rare_site16:
s_mov_b32 s36, 16
s_branch L2_rare_t0_4
L2_rare_t0_4:
s_nop 15
s_nop 15
s_waitcnt lgkmcnt(0)
v_lshrrev_b32 v206, 8, v243
v_add_u32 v206, 1, v206
v_lshrrev_b32 v206, 2, v206
v_sub_u32 v206, 0, v206
v_and_b32 v206, 0xffff0000, v206
v_max_f32 v204, v128, v129
v_max3_f32 v204, v204, v130, v131
v_mov_b32 v205, v204
s_nop 1
v_permlane32_swap_b32 v204, v205
s_nop 1
v_max_f32 v204, v204, v205
v_mov_b32 v205, v204
s_nop 1
v_permlane16_swap_b32 v204, v205
s_nop 1
v_max_f32 v204, v204, v205
v_add_f32 v204, 40.0, v204
v_ceil_f32 v204, v204
v_max_f32 v204, 0, v204
v_sub_f32 v205, v224, v204
v_cvt_pk_bf16_f32 v205, v205, v205
v_and_b32 v205, 0xffff0000, v205
v_sub_f32 v204, v205, v224
v_mov_b32 v224, v205
v_exp_f32 v236, v204
v_add_f32 v128, v128, v204
v_add_f32 v129, v129, v204
v_add_f32 v130, v130, v204
v_add_f32 v131, v131, v204
v_add_f32 v144, v144, v204
v_add_f32 v145, v145, v204
v_add_f32 v146, v146, v204
v_add_f32 v147, v147, v204
v_lshlrev_b32 v242, 16, v4
v_and_b32 v248, 0xffff0000, v4
v_mul_f32 v242, v242, v236
v_mul_f32 v248, v248, v236
v_cvt_pk_bf16_f32 v4, v242, v248
v_lshlrev_b32 v242, 16, v5
v_and_b32 v248, 0xffff0000, v5
v_mul_f32 v242, v242, v236
v_mul_f32 v248, v248, v236
v_cvt_pk_bf16_f32 v5, v242, v248
v_lshlrev_b32 v242, 16, v6
v_and_b32 v248, 0xffff0000, v6
v_mul_f32 v242, v242, v236
v_mul_f32 v248, v248, v236
v_cvt_pk_bf16_f32 v6, v242, v248
v_lshlrev_b32 v242, 16, v7
v_and_b32 v248, 0xffff0000, v7
v_mul_f32 v242, v242, v236
v_mul_f32 v248, v248, v236
v_cvt_pk_bf16_f32 v7, v242, v248
v_lshlrev_b32 v242, 16, v8
v_and_b32 v248, 0xffff0000, v8
v_mul_f32 v242, v242, v236
v_mul_f32 v248, v248, v236
v_cvt_pk_bf16_f32 v8, v242, v248
v_lshlrev_b32 v242, 16, v9
v_and_b32 v248, 0xffff0000, v9
v_mul_f32 v242, v242, v236
v_mul_f32 v248, v248, v236
v_cvt_pk_bf16_f32 v9, v242, v248
v_lshlrev_b32 v242, 16, v10
v_and_b32 v248, 0xffff0000, v10
v_mul_f32 v242, v242, v236
v_mul_f32 v248, v248, v236
v_cvt_pk_bf16_f32 v10, v242, v248
v_lshlrev_b32 v242, 16, v11
v_and_b32 v248, 0xffff0000, v11
v_mul_f32 v242, v242, v236
v_mul_f32 v248, v248, v236
v_cvt_pk_bf16_f32 v11, v242, v248
v_lshlrev_b32 v242, 16, v160
v_and_b32 v248, 0xffff0000, v160
v_mul_f32 v242, v242, v236
v_mul_f32 v248, v248, v236
v_cvt_pk_bf16_f32 v160, v242, v248
v_lshlrev_b32 v242, 16, v161
v_and_b32 v248, 0xffff0000, v161
v_mul_f32 v242, v242, v236
v_mul_f32 v248, v248, v236
v_cvt_pk_bf16_f32 v161, v242, v248
v_lshlrev_b32 v242, 16, v162
v_and_b32 v248, 0xffff0000, v162
v_mul_f32 v242, v242, v236
v_mul_f32 v248, v248, v236
v_cvt_pk_bf16_f32 v162, v242, v248
v_lshlrev_b32 v242, 16, v163
v_and_b32 v248, 0xffff0000, v163
v_mul_f32 v242, v242, v236
v_mul_f32 v248, v248, v236
v_cvt_pk_bf16_f32 v163, v242, v248
v_lshlrev_b32 v242, 16, v176
v_and_b32 v248, 0xffff0000, v176
v_mul_f32 v242, v242, v236
v_mul_f32 v248, v248, v236
v_cvt_pk_bf16_f32 v176, v242, v248
v_lshlrev_b32 v242, 16, v177
v_and_b32 v248, 0xffff0000, v177
v_mul_f32 v242, v242, v236
v_mul_f32 v248, v248, v236
v_cvt_pk_bf16_f32 v177, v242, v248
v_lshlrev_b32 v242, 16, v178
v_and_b32 v248, 0xffff0000, v178
v_mul_f32 v242, v242, v236
v_mul_f32 v248, v248, v236
v_cvt_pk_bf16_f32 v178, v242, v248
v_lshlrev_b32 v242, 16, v179
v_and_b32 v248, 0xffff0000, v179
v_mul_f32 v242, v242, v236
v_mul_f32 v248, v248, v236
v_cvt_pk_bf16_f32 v179, v242, v248
v_exp_f32 v232, v128
v_exp_f32 v233, v129
v_exp_f32 v234, v130
v_exp_f32 v235, v131
s_nop 1
v_cvt_pk_bf16_f32 v0, v232, v233
v_cvt_pk_bf16_f32 v1, v234, v235
v_max_f32 v204, v132, v133
v_max3_f32 v204, v204, v134, v135
v_mov_b32 v205, v204
s_nop 1
v_permlane32_swap_b32 v204, v205
s_nop 1
v_max_f32 v204, v204, v205
v_mov_b32 v205, v204
s_nop 1
v_permlane16_swap_b32 v204, v205
s_nop 1
v_max_f32 v204, v204, v205
v_add_f32 v204, 40.0, v204
v_ceil_f32 v204, v204
v_max_f32 v204, 0, v204
v_sub_f32 v205, v225, v204
v_cvt_pk_bf16_f32 v205, v205, v205
v_and_b32 v205, 0xffff0000, v205
v_sub_f32 v204, v205, v225
v_mov_b32 v225, v205
v_exp_f32 v237, v204
v_add_f32 v132, v132, v204
v_add_f32 v133, v133, v204
v_add_f32 v134, v134, v204
v_add_f32 v135, v135, v204
v_add_f32 v148, v148, v204
v_add_f32 v149, v149, v204
v_add_f32 v150, v150, v204
v_add_f32 v151, v151, v204
v_lshlrev_b32 v242, 16, v36
v_and_b32 v248, 0xffff0000, v36
v_mul_f32 v242, v242, v237
v_mul_f32 v248, v248, v237
v_cvt_pk_bf16_f32 v36, v242, v248
v_lshlrev_b32 v242, 16, v37
v_and_b32 v248, 0xffff0000, v37
v_mul_f32 v242, v242, v237
v_mul_f32 v248, v248, v237
v_cvt_pk_bf16_f32 v37, v242, v248
v_lshlrev_b32 v242, 16, v38
v_and_b32 v248, 0xffff0000, v38
v_mul_f32 v242, v242, v237
v_mul_f32 v248, v248, v237
v_cvt_pk_bf16_f32 v38, v242, v248
v_lshlrev_b32 v242, 16, v39
v_and_b32 v248, 0xffff0000, v39
v_mul_f32 v242, v242, v237
v_mul_f32 v248, v248, v237
v_cvt_pk_bf16_f32 v39, v242, v248
v_lshlrev_b32 v242, 16, v40
v_and_b32 v248, 0xffff0000, v40
v_mul_f32 v242, v242, v237
v_mul_f32 v248, v248, v237
v_cvt_pk_bf16_f32 v40, v242, v248
v_lshlrev_b32 v242, 16, v41
v_and_b32 v248, 0xffff0000, v41
v_mul_f32 v242, v242, v237
v_mul_f32 v248, v248, v237
v_cvt_pk_bf16_f32 v41, v242, v248
v_lshlrev_b32 v242, 16, v42
v_and_b32 v248, 0xffff0000, v42
v_mul_f32 v242, v242, v237
v_mul_f32 v248, v248, v237
v_cvt_pk_bf16_f32 v42, v242, v248
v_lshlrev_b32 v242, 16, v43
v_and_b32 v248, 0xffff0000, v43
v_mul_f32 v242, v242, v237
v_mul_f32 v248, v248, v237
v_cvt_pk_bf16_f32 v43, v242, v248
v_lshlrev_b32 v242, 16, v164
v_and_b32 v248, 0xffff0000, v164
v_mul_f32 v242, v242, v237
v_mul_f32 v248, v248, v237
v_cvt_pk_bf16_f32 v164, v242, v248
v_lshlrev_b32 v242, 16, v165
v_and_b32 v248, 0xffff0000, v165
v_mul_f32 v242, v242, v237
v_mul_f32 v248, v248, v237
v_cvt_pk_bf16_f32 v165, v242, v248
v_lshlrev_b32 v242, 16, v166
v_and_b32 v248, 0xffff0000, v166
v_mul_f32 v242, v242, v237
v_mul_f32 v248, v248, v237
v_cvt_pk_bf16_f32 v166, v242, v248
v_lshlrev_b32 v242, 16, v167
v_and_b32 v248, 0xffff0000, v167
v_mul_f32 v242, v242, v237
v_mul_f32 v248, v248, v237
v_cvt_pk_bf16_f32 v167, v242, v248
v_lshlrev_b32 v242, 16, v180
v_and_b32 v248, 0xffff0000, v180
v_mul_f32 v242, v242, v237
v_mul_f32 v248, v248, v237
v_cvt_pk_bf16_f32 v180, v242, v248
v_lshlrev_b32 v242, 16, v181
v_and_b32 v248, 0xffff0000, v181
v_mul_f32 v242, v242, v237
v_mul_f32 v248, v248, v237
v_cvt_pk_bf16_f32 v181, v242, v248
v_lshlrev_b32 v242, 16, v182
v_and_b32 v248, 0xffff0000, v182
v_mul_f32 v242, v242, v237
v_mul_f32 v248, v248, v237
v_cvt_pk_bf16_f32 v182, v242, v248
v_lshlrev_b32 v242, 16, v183
v_and_b32 v248, 0xffff0000, v183
v_mul_f32 v242, v242, v237
v_mul_f32 v248, v248, v237
v_cvt_pk_bf16_f32 v183, v242, v248
v_exp_f32 v232, v132
v_exp_f32 v233, v133
v_exp_f32 v234, v134
v_exp_f32 v235, v135
s_nop 1
v_cvt_pk_bf16_f32 v32, v232, v233
v_cvt_pk_bf16_f32 v33, v234, v235
v_max_f32 v204, v136, v137
v_max3_f32 v204, v204, v138, v139
v_mov_b32 v205, v204
s_nop 1
v_permlane32_swap_b32 v204, v205
s_nop 1
v_max_f32 v204, v204, v205
v_mov_b32 v205, v204
s_nop 1
v_permlane16_swap_b32 v204, v205
s_nop 1
v_max_f32 v204, v204, v205
v_add_f32 v204, 40.0, v204
v_ceil_f32 v204, v204
v_max_f32 v204, 0, v204
v_sub_f32 v205, v226, v204
v_cvt_pk_bf16_f32 v205, v205, v205
v_and_b32 v205, 0xffff0000, v205
v_sub_f32 v204, v205, v226
v_mov_b32 v226, v205
v_exp_f32 v238, v204
v_add_f32 v136, v136, v204
v_add_f32 v137, v137, v204
v_add_f32 v138, v138, v204
v_add_f32 v139, v139, v204
v_add_f32 v152, v152, v204
v_add_f32 v153, v153, v204
v_add_f32 v154, v154, v204
v_add_f32 v155, v155, v204
v_lshlrev_b32 v242, 16, v68
v_and_b32 v248, 0xffff0000, v68
v_mul_f32 v242, v242, v238
v_mul_f32 v248, v248, v238
v_cvt_pk_bf16_f32 v68, v242, v248
v_lshlrev_b32 v242, 16, v69
v_and_b32 v248, 0xffff0000, v69
v_mul_f32 v242, v242, v238
v_mul_f32 v248, v248, v238
v_cvt_pk_bf16_f32 v69, v242, v248
v_lshlrev_b32 v242, 16, v70
v_and_b32 v248, 0xffff0000, v70
v_mul_f32 v242, v242, v238
v_mul_f32 v248, v248, v238
v_cvt_pk_bf16_f32 v70, v242, v248
v_lshlrev_b32 v242, 16, v71
v_and_b32 v248, 0xffff0000, v71
v_mul_f32 v242, v242, v238
v_mul_f32 v248, v248, v238
v_cvt_pk_bf16_f32 v71, v242, v248
v_lshlrev_b32 v242, 16, v72
v_and_b32 v248, 0xffff0000, v72
v_mul_f32 v242, v242, v238
v_mul_f32 v248, v248, v238
v_cvt_pk_bf16_f32 v72, v242, v248
v_lshlrev_b32 v242, 16, v73
v_and_b32 v248, 0xffff0000, v73
v_mul_f32 v242, v242, v238
v_mul_f32 v248, v248, v238
v_cvt_pk_bf16_f32 v73, v242, v248
v_lshlrev_b32 v242, 16, v74
v_and_b32 v248, 0xffff0000, v74
v_mul_f32 v242, v242, v238
v_mul_f32 v248, v248, v238
v_cvt_pk_bf16_f32 v74, v242, v248
v_lshlrev_b32 v242, 16, v75
v_and_b32 v248, 0xffff0000, v75
v_mul_f32 v242, v242, v238
v_mul_f32 v248, v248, v238
v_cvt_pk_bf16_f32 v75, v242, v248
v_lshlrev_b32 v242, 16, v168
v_and_b32 v248, 0xffff0000, v168
v_mul_f32 v242, v242, v238
v_mul_f32 v248, v248, v238
v_cvt_pk_bf16_f32 v168, v242, v248
v_lshlrev_b32 v242, 16, v169
v_and_b32 v248, 0xffff0000, v169
v_mul_f32 v242, v242, v238
v_mul_f32 v248, v248, v238
v_cvt_pk_bf16_f32 v169, v242, v248
v_lshlrev_b32 v242, 16, v170
v_and_b32 v248, 0xffff0000, v170
v_mul_f32 v242, v242, v238
v_mul_f32 v248, v248, v238
v_cvt_pk_bf16_f32 v170, v242, v248
v_lshlrev_b32 v242, 16, v171
v_and_b32 v248, 0xffff0000, v171
v_mul_f32 v242, v242, v238
v_mul_f32 v248, v248, v238
v_cvt_pk_bf16_f32 v171, v242, v248
v_lshlrev_b32 v242, 16, v184
v_and_b32 v248, 0xffff0000, v184
v_mul_f32 v242, v242, v238
v_mul_f32 v248, v248, v238
v_cvt_pk_bf16_f32 v184, v242, v248
v_lshlrev_b32 v242, 16, v185
v_and_b32 v248, 0xffff0000, v185
v_mul_f32 v242, v242, v238
v_mul_f32 v248, v248, v238
v_cvt_pk_bf16_f32 v185, v242, v248
v_lshlrev_b32 v242, 16, v186
v_and_b32 v248, 0xffff0000, v186
v_mul_f32 v242, v242, v238
v_mul_f32 v248, v248, v238
v_cvt_pk_bf16_f32 v186, v242, v248
v_lshlrev_b32 v242, 16, v187
v_and_b32 v248, 0xffff0000, v187
v_mul_f32 v242, v242, v238
v_mul_f32 v248, v248, v238
v_cvt_pk_bf16_f32 v187, v242, v248
v_exp_f32 v232, v136
v_exp_f32 v233, v137
v_exp_f32 v234, v138
v_exp_f32 v235, v139
s_nop 1
v_cvt_pk_bf16_f32 v64, v232, v233
v_cvt_pk_bf16_f32 v65, v234, v235
v_max_f32 v204, v140, v141
v_max3_f32 v204, v204, v142, v143
v_mov_b32 v205, v204
s_nop 1
v_permlane32_swap_b32 v204, v205
s_nop 1
v_max_f32 v204, v204, v205
v_mov_b32 v205, v204
s_nop 1
v_permlane16_swap_b32 v204, v205
s_nop 1
v_max_f32 v204, v204, v205
v_add_f32 v204, 40.0, v204
v_ceil_f32 v204, v204
v_max_f32 v204, 0, v204
v_sub_f32 v205, v227, v204
v_cvt_pk_bf16_f32 v205, v205, v205
v_and_b32 v205, 0xffff0000, v205
v_sub_f32 v204, v205, v227
v_mov_b32 v227, v205
v_exp_f32 v239, v204
v_add_f32 v140, v140, v204
v_add_f32 v141, v141, v204
v_add_f32 v142, v142, v204
v_add_f32 v143, v143, v204
v_add_f32 v156, v156, v204
v_add_f32 v157, v157, v204
v_add_f32 v158, v158, v204
v_add_f32 v159, v159, v204
v_lshlrev_b32 v242, 16, v100
v_and_b32 v248, 0xffff0000, v100
v_mul_f32 v242, v242, v239
v_mul_f32 v248, v248, v239
v_cvt_pk_bf16_f32 v100, v242, v248
v_lshlrev_b32 v242, 16, v101
v_and_b32 v248, 0xffff0000, v101
v_mul_f32 v242, v242, v239
v_mul_f32 v248, v248, v239
v_cvt_pk_bf16_f32 v101, v242, v248
v_lshlrev_b32 v242, 16, v102
v_and_b32 v248, 0xffff0000, v102
v_mul_f32 v242, v242, v239
v_mul_f32 v248, v248, v239
v_cvt_pk_bf16_f32 v102, v242, v248
v_lshlrev_b32 v242, 16, v103
v_and_b32 v248, 0xffff0000, v103
v_mul_f32 v242, v242, v239
v_mul_f32 v248, v248, v239
v_cvt_pk_bf16_f32 v103, v242, v248
v_lshlrev_b32 v242, 16, v104
v_and_b32 v248, 0xffff0000, v104
v_mul_f32 v242, v242, v239
v_mul_f32 v248, v248, v239
v_cvt_pk_bf16_f32 v104, v242, v248
v_lshlrev_b32 v242, 16, v105
v_and_b32 v248, 0xffff0000, v105
v_mul_f32 v242, v242, v239
v_mul_f32 v248, v248, v239
v_cvt_pk_bf16_f32 v105, v242, v248
v_lshlrev_b32 v242, 16, v106
v_and_b32 v248, 0xffff0000, v106
v_mul_f32 v242, v242, v239
v_mul_f32 v248, v248, v239
v_cvt_pk_bf16_f32 v106, v242, v248
v_lshlrev_b32 v242, 16, v107
v_and_b32 v248, 0xffff0000, v107
v_mul_f32 v242, v242, v239
v_mul_f32 v248, v248, v239
v_cvt_pk_bf16_f32 v107, v242, v248
v_lshlrev_b32 v242, 16, v172
v_and_b32 v248, 0xffff0000, v172
v_mul_f32 v242, v242, v239
v_mul_f32 v248, v248, v239
v_cvt_pk_bf16_f32 v172, v242, v248
v_lshlrev_b32 v242, 16, v173
v_and_b32 v248, 0xffff0000, v173
v_mul_f32 v242, v242, v239
v_mul_f32 v248, v248, v239
v_cvt_pk_bf16_f32 v173, v242, v248
v_lshlrev_b32 v242, 16, v174
v_and_b32 v248, 0xffff0000, v174
v_mul_f32 v242, v242, v239
v_mul_f32 v248, v248, v239
v_cvt_pk_bf16_f32 v174, v242, v248
v_lshlrev_b32 v242, 16, v175
v_and_b32 v248, 0xffff0000, v175
v_mul_f32 v242, v242, v239
v_mul_f32 v248, v248, v239
v_cvt_pk_bf16_f32 v175, v242, v248
v_lshlrev_b32 v242, 16, v188
v_and_b32 v248, 0xffff0000, v188
v_mul_f32 v242, v242, v239
v_mul_f32 v248, v248, v239
v_cvt_pk_bf16_f32 v188, v242, v248
v_lshlrev_b32 v242, 16, v189
v_and_b32 v248, 0xffff0000, v189
v_mul_f32 v242, v242, v239
v_mul_f32 v248, v248, v239
v_cvt_pk_bf16_f32 v189, v242, v248
v_lshlrev_b32 v242, 16, v190
v_and_b32 v248, 0xffff0000, v190
v_mul_f32 v242, v242, v239
v_mul_f32 v248, v248, v239
v_cvt_pk_bf16_f32 v190, v242, v248
v_lshlrev_b32 v242, 16, v191
v_and_b32 v248, 0xffff0000, v191
v_mul_f32 v242, v242, v239
v_mul_f32 v248, v248, v239
v_cvt_pk_bf16_f32 v191, v242, v248
v_exp_f32 v232, v140
v_exp_f32 v233, v141
v_exp_f32 v234, v142
v_exp_f32 v235, v143
s_nop 1
v_cvt_pk_bf16_f32 v96, v232, v233
v_cvt_pk_bf16_f32 v97, v234, v235
s_branch L2_rare_common
L2_rare_site17:
s_mov_b32 s36, 17
s_branch L2_rare_t0_5
L2_rare_t0_5:
s_nop 15
s_nop 15
s_waitcnt lgkmcnt(0)
v_lshrrev_b32 v206, 8, v243
v_add_u32 v206, 1, v206
v_lshrrev_b32 v206, 2, v206
v_sub_u32 v206, 0, v206
v_and_b32 v206, 0xffff0000, v206
v_max_f32 v204, v144, v145
v_max3_f32 v204, v204, v146, v147
v_mov_b32 v205, v204
s_nop 1
v_permlane32_swap_b32 v204, v205
s_nop 1
v_max_f32 v204, v204, v205
v_mov_b32 v205, v204
s_nop 1
v_permlane16_swap_b32 v204, v205
s_nop 1
v_max_f32 v204, v204, v205
v_add_f32 v204, 40.0, v204
v_ceil_f32 v204, v204
v_max_f32 v204, 0, v204
v_sub_f32 v205, v224, v204
v_cvt_pk_bf16_f32 v205, v205, v205
v_and_b32 v205, 0xffff0000, v205
v_sub_f32 v204, v205, v224
v_mov_b32 v224, v205
v_exp_f32 v236, v204
v_add_f32 v144, v144, v204
v_add_f32 v145, v145, v204
v_add_f32 v146, v146, v204
v_add_f32 v147, v147, v204
v_add_f32 v128, v128, v204
v_add_f32 v129, v129, v204
v_add_f32 v130, v130, v204
v_add_f32 v131, v131, v204
v_lshlrev_b32 v242, 16, v4
v_and_b32 v248, 0xffff0000, v4
v_mul_f32 v242, v242, v236
v_mul_f32 v248, v248, v236
v_cvt_pk_bf16_f32 v4, v242, v248
v_lshlrev_b32 v242, 16, v5
v_and_b32 v248, 0xffff0000, v5
v_mul_f32 v242, v242, v236
v_mul_f32 v248, v248, v236
v_cvt_pk_bf16_f32 v5, v242, v248
v_lshlrev_b32 v242, 16, v6
v_and_b32 v248, 0xffff0000, v6
v_mul_f32 v242, v242, v236
v_mul_f32 v248, v248, v236
v_cvt_pk_bf16_f32 v6, v242, v248
v_lshlrev_b32 v242, 16, v7
v_and_b32 v248, 0xffff0000, v7
v_mul_f32 v242, v242, v236
v_mul_f32 v248, v248, v236
v_cvt_pk_bf16_f32 v7, v242, v248
v_lshlrev_b32 v242, 16, v8
v_and_b32 v248, 0xffff0000, v8
v_mul_f32 v242, v242, v236
v_mul_f32 v248, v248, v236
v_cvt_pk_bf16_f32 v8, v242, v248
v_lshlrev_b32 v242, 16, v9
v_and_b32 v248, 0xffff0000, v9
v_mul_f32 v242, v242, v236
v_mul_f32 v248, v248, v236
v_cvt_pk_bf16_f32 v9, v242, v248
v_lshlrev_b32 v242, 16, v10
v_and_b32 v248, 0xffff0000, v10
v_mul_f32 v242, v242, v236
v_mul_f32 v248, v248, v236
v_cvt_pk_bf16_f32 v10, v242, v248
v_lshlrev_b32 v242, 16, v11
v_and_b32 v248, 0xffff0000, v11
v_mul_f32 v242, v242, v236
v_mul_f32 v248, v248, v236
v_cvt_pk_bf16_f32 v11, v242, v248
v_lshlrev_b32 v242, 16, v160
v_and_b32 v248, 0xffff0000, v160
v_mul_f32 v242, v242, v236
v_mul_f32 v248, v248, v236
v_cvt_pk_bf16_f32 v160, v242, v248
v_lshlrev_b32 v242, 16, v161
v_and_b32 v248, 0xffff0000, v161
v_mul_f32 v242, v242, v236
v_mul_f32 v248, v248, v236
v_cvt_pk_bf16_f32 v161, v242, v248
v_lshlrev_b32 v242, 16, v162
v_and_b32 v248, 0xffff0000, v162
v_mul_f32 v242, v242, v236
v_mul_f32 v248, v248, v236
v_cvt_pk_bf16_f32 v162, v242, v248
v_lshlrev_b32 v242, 16, v163
v_and_b32 v248, 0xffff0000, v163
v_mul_f32 v242, v242, v236
v_mul_f32 v248, v248, v236
v_cvt_pk_bf16_f32 v163, v242, v248
v_lshlrev_b32 v242, 16, v176
v_and_b32 v248, 0xffff0000, v176
v_mul_f32 v242, v242, v236
v_mul_f32 v248, v248, v236
v_cvt_pk_bf16_f32 v176, v242, v248
v_lshlrev_b32 v242, 16, v177
v_and_b32 v248, 0xffff0000, v177
v_mul_f32 v242, v242, v236
v_mul_f32 v248, v248, v236
v_cvt_pk_bf16_f32 v177, v242, v248
v_lshlrev_b32 v242, 16, v178
v_and_b32 v248, 0xffff0000, v178
v_mul_f32 v242, v242, v236
v_mul_f32 v248, v248, v236
v_cvt_pk_bf16_f32 v178, v242, v248
v_lshlrev_b32 v242, 16, v179
v_and_b32 v248, 0xffff0000, v179
v_mul_f32 v242, v242, v236
v_mul_f32 v248, v248, v236
v_cvt_pk_bf16_f32 v179, v242, v248
v_lshlrev_b32 v242, 16, v0
v_and_b32 v248, 0xffff0000, v0
v_mul_f32 v242, v242, v236
v_mul_f32 v248, v248, v236
v_cvt_pk_bf16_f32 v0, v242, v248
v_lshlrev_b32 v242, 16, v1
v_and_b32 v248, 0xffff0000, v1
v_mul_f32 v242, v242, v236
v_mul_f32 v248, v248, v236
v_cvt_pk_bf16_f32 v1, v242, v248
v_exp_f32 v232, v144
v_exp_f32 v233, v145
v_exp_f32 v234, v146
v_exp_f32 v235, v147
s_nop 1
v_cvt_pk_bf16_f32 v2, v232, v233
v_cvt_pk_bf16_f32 v3, v234, v235
v_max_f32 v204, v148, v149
v_max3_f32 v204, v204, v150, v151
v_mov_b32 v205, v204
s_nop 1
v_permlane32_swap_b32 v204, v205
s_nop 1
v_max_f32 v204, v204, v205
v_mov_b32 v205, v204
s_nop 1
v_permlane16_swap_b32 v204, v205
s_nop 1
v_max_f32 v204, v204, v205
v_add_f32 v204, 40.0, v204
v_ceil_f32 v204, v204
v_max_f32 v204, 0, v204
v_sub_f32 v205, v225, v204
v_cvt_pk_bf16_f32 v205, v205, v205
v_and_b32 v205, 0xffff0000, v205
v_sub_f32 v204, v205, v225
v_mov_b32 v225, v205
v_exp_f32 v237, v204
v_add_f32 v148, v148, v204
v_add_f32 v149, v149, v204
v_add_f32 v150, v150, v204
v_add_f32 v151, v151, v204
v_add_f32 v132, v132, v204
v_add_f32 v133, v133, v204
v_add_f32 v134, v134, v204
v_add_f32 v135, v135, v204
v_lshlrev_b32 v242, 16, v36
v_and_b32 v248, 0xffff0000, v36
v_mul_f32 v242, v242, v237
v_mul_f32 v248, v248, v237
v_cvt_pk_bf16_f32 v36, v242, v248
v_lshlrev_b32 v242, 16, v37
v_and_b32 v248, 0xffff0000, v37
v_mul_f32 v242, v242, v237
v_mul_f32 v248, v248, v237
v_cvt_pk_bf16_f32 v37, v242, v248
v_lshlrev_b32 v242, 16, v38
v_and_b32 v248, 0xffff0000, v38
v_mul_f32 v242, v242, v237
v_mul_f32 v248, v248, v237
v_cvt_pk_bf16_f32 v38, v242, v248
v_lshlrev_b32 v242, 16, v39
v_and_b32 v248, 0xffff0000, v39
v_mul_f32 v242, v242, v237
v_mul_f32 v248, v248, v237
v_cvt_pk_bf16_f32 v39, v242, v248
v_lshlrev_b32 v242, 16, v40
v_and_b32 v248, 0xffff0000, v40
v_mul_f32 v242, v242, v237
v_mul_f32 v248, v248, v237
v_cvt_pk_bf16_f32 v40, v242, v248
v_lshlrev_b32 v242, 16, v41
v_and_b32 v248, 0xffff0000, v41
v_mul_f32 v242, v242, v237
v_mul_f32 v248, v248, v237
v_cvt_pk_bf16_f32 v41, v242, v248
v_lshlrev_b32 v242, 16, v42
v_and_b32 v248, 0xffff0000, v42
v_mul_f32 v242, v242, v237
v_mul_f32 v248, v248, v237
v_cvt_pk_bf16_f32 v42, v242, v248
v_lshlrev_b32 v242, 16, v43
v_and_b32 v248, 0xffff0000, v43
v_mul_f32 v242, v242, v237
v_mul_f32 v248, v248, v237
v_cvt_pk_bf16_f32 v43, v242, v248
v_lshlrev_b32 v242, 16, v164
v_and_b32 v248, 0xffff0000, v164
v_mul_f32 v242, v242, v237
v_mul_f32 v248, v248, v237
v_cvt_pk_bf16_f32 v164, v242, v248
v_lshlrev_b32 v242, 16, v165
v_and_b32 v248, 0xffff0000, v165
v_mul_f32 v242, v242, v237
v_mul_f32 v248, v248, v237
v_cvt_pk_bf16_f32 v165, v242, v248
v_lshlrev_b32 v242, 16, v166
v_and_b32 v248, 0xffff0000, v166
v_mul_f32 v242, v242, v237
v_mul_f32 v248, v248, v237
v_cvt_pk_bf16_f32 v166, v242, v248
v_lshlrev_b32 v242, 16, v167
v_and_b32 v248, 0xffff0000, v167
v_mul_f32 v242, v242, v237
v_mul_f32 v248, v248, v237
v_cvt_pk_bf16_f32 v167, v242, v248
v_lshlrev_b32 v242, 16, v180
v_and_b32 v248, 0xffff0000, v180
v_mul_f32 v242, v242, v237
v_mul_f32 v248, v248, v237
v_cvt_pk_bf16_f32 v180, v242, v248
v_lshlrev_b32 v242, 16, v181
v_and_b32 v248, 0xffff0000, v181
v_mul_f32 v242, v242, v237
v_mul_f32 v248, v248, v237
v_cvt_pk_bf16_f32 v181, v242, v248
v_lshlrev_b32 v242, 16, v182
v_and_b32 v248, 0xffff0000, v182
v_mul_f32 v242, v242, v237
v_mul_f32 v248, v248, v237
v_cvt_pk_bf16_f32 v182, v242, v248
v_lshlrev_b32 v242, 16, v183
v_and_b32 v248, 0xffff0000, v183
v_mul_f32 v242, v242, v237
v_mul_f32 v248, v248, v237
v_cvt_pk_bf16_f32 v183, v242, v248
v_lshlrev_b32 v242, 16, v32
v_and_b32 v248, 0xffff0000, v32
v_mul_f32 v242, v242, v237
v_mul_f32 v248, v248, v237
v_cvt_pk_bf16_f32 v32, v242, v248
v_lshlrev_b32 v242, 16, v33
v_and_b32 v248, 0xffff0000, v33
v_mul_f32 v242, v242, v237
v_mul_f32 v248, v248, v237
v_cvt_pk_bf16_f32 v33, v242, v248
v_exp_f32 v232, v148
v_exp_f32 v233, v149
v_exp_f32 v234, v150
v_exp_f32 v235, v151
s_nop 1
v_cvt_pk_bf16_f32 v34, v232, v233
v_cvt_pk_bf16_f32 v35, v234, v235
v_max_f32 v204, v152, v153
v_max3_f32 v204, v204, v154, v155
v_mov_b32 v205, v204
s_nop 1
v_permlane32_swap_b32 v204, v205
s_nop 1
v_max_f32 v204, v204, v205
v_mov_b32 v205, v204
s_nop 1
v_permlane16_swap_b32 v204, v205
s_nop 1
v_max_f32 v204, v204, v205
v_add_f32 v204, 40.0, v204
v_ceil_f32 v204, v204
v_max_f32 v204, 0, v204
v_sub_f32 v205, v226, v204
v_cvt_pk_bf16_f32 v205, v205, v205
v_and_b32 v205, 0xffff0000, v205
v_sub_f32 v204, v205, v226
v_mov_b32 v226, v205
v_exp_f32 v238, v204
v_add_f32 v152, v152, v204
v_add_f32 v153, v153, v204
v_add_f32 v154, v154, v204
v_add_f32 v155, v155, v204
v_add_f32 v136, v136, v204
v_add_f32 v137, v137, v204
v_add_f32 v138, v138, v204
v_add_f32 v139, v139, v204
v_lshlrev_b32 v242, 16, v68
v_and_b32 v248, 0xffff0000, v68
v_mul_f32 v242, v242, v238
v_mul_f32 v248, v248, v238
v_cvt_pk_bf16_f32 v68, v242, v248
v_lshlrev_b32 v242, 16, v69
v_and_b32 v248, 0xffff0000, v69
v_mul_f32 v242, v242, v238
v_mul_f32 v248, v248, v238
v_cvt_pk_bf16_f32 v69, v242, v248
v_lshlrev_b32 v242, 16, v70
v_and_b32 v248, 0xffff0000, v70
v_mul_f32 v242, v242, v238
v_mul_f32 v248, v248, v238
v_cvt_pk_bf16_f32 v70, v242, v248
v_lshlrev_b32 v242, 16, v71
v_and_b32 v248, 0xffff0000, v71
v_mul_f32 v242, v242, v238
v_mul_f32 v248, v248, v238
v_cvt_pk_bf16_f32 v71, v242, v248
v_lshlrev_b32 v242, 16, v72
v_and_b32 v248, 0xffff0000, v72
v_mul_f32 v242, v242, v238
v_mul_f32 v248, v248, v238
v_cvt_pk_bf16_f32 v72, v242, v248
v_lshlrev_b32 v242, 16, v73
v_and_b32 v248, 0xffff0000, v73
v_mul_f32 v242, v242, v238
v_mul_f32 v248, v248, v238
v_cvt_pk_bf16_f32 v73, v242, v248
v_lshlrev_b32 v242, 16, v74
v_and_b32 v248, 0xffff0000, v74
v_mul_f32 v242, v242, v238
v_mul_f32 v248, v248, v238
v_cvt_pk_bf16_f32 v74, v242, v248
v_lshlrev_b32 v242, 16, v75
v_and_b32 v248, 0xffff0000, v75
v_mul_f32 v242, v242, v238
v_mul_f32 v248, v248, v238
v_cvt_pk_bf16_f32 v75, v242, v248
v_lshlrev_b32 v242, 16, v168
v_and_b32 v248, 0xffff0000, v168
v_mul_f32 v242, v242, v238
v_mul_f32 v248, v248, v238
v_cvt_pk_bf16_f32 v168, v242, v248
v_lshlrev_b32 v242, 16, v169
v_and_b32 v248, 0xffff0000, v169
v_mul_f32 v242, v242, v238
v_mul_f32 v248, v248, v238
v_cvt_pk_bf16_f32 v169, v242, v248
v_lshlrev_b32 v242, 16, v170
v_and_b32 v248, 0xffff0000, v170
v_mul_f32 v242, v242, v238
v_mul_f32 v248, v248, v238
v_cvt_pk_bf16_f32 v170, v242, v248
v_lshlrev_b32 v242, 16, v171
v_and_b32 v248, 0xffff0000, v171
v_mul_f32 v242, v242, v238
v_mul_f32 v248, v248, v238
v_cvt_pk_bf16_f32 v171, v242, v248
v_lshlrev_b32 v242, 16, v184
v_and_b32 v248, 0xffff0000, v184
v_mul_f32 v242, v242, v238
v_mul_f32 v248, v248, v238
v_cvt_pk_bf16_f32 v184, v242, v248
v_lshlrev_b32 v242, 16, v185
v_and_b32 v248, 0xffff0000, v185
v_mul_f32 v242, v242, v238
v_mul_f32 v248, v248, v238
v_cvt_pk_bf16_f32 v185, v242, v248
v_lshlrev_b32 v242, 16, v186
v_and_b32 v248, 0xffff0000, v186
v_mul_f32 v242, v242, v238
v_mul_f32 v248, v248, v238
v_cvt_pk_bf16_f32 v186, v242, v248
v_lshlrev_b32 v242, 16, v187
v_and_b32 v248, 0xffff0000, v187
v_mul_f32 v242, v242, v238
v_mul_f32 v248, v248, v238
v_cvt_pk_bf16_f32 v187, v242, v248
v_lshlrev_b32 v242, 16, v64
v_and_b32 v248, 0xffff0000, v64
v_mul_f32 v242, v242, v238
v_mul_f32 v248, v248, v238
v_cvt_pk_bf16_f32 v64, v242, v248
v_lshlrev_b32 v242, 16, v65
v_and_b32 v248, 0xffff0000, v65
v_mul_f32 v242, v242, v238
v_mul_f32 v248, v248, v238
v_cvt_pk_bf16_f32 v65, v242, v248
v_exp_f32 v232, v152
v_exp_f32 v233, v153
v_exp_f32 v234, v154
v_exp_f32 v235, v155
s_nop 1
v_cvt_pk_bf16_f32 v66, v232, v233
v_cvt_pk_bf16_f32 v67, v234, v235
v_max_f32 v204, v156, v157
v_max3_f32 v204, v204, v158, v159
v_mov_b32 v205, v204
s_nop 1
v_permlane32_swap_b32 v204, v205
s_nop 1
v_max_f32 v204, v204, v205
v_mov_b32 v205, v204
s_nop 1
v_permlane16_swap_b32 v204, v205
s_nop 1
v_max_f32 v204, v204, v205
v_add_f32 v204, 40.0, v204
v_ceil_f32 v204, v204
v_max_f32 v204, 0, v204
v_sub_f32 v205, v227, v204
v_cvt_pk_bf16_f32 v205, v205, v205
v_and_b32 v205, 0xffff0000, v205
v_sub_f32 v204, v205, v227
v_mov_b32 v227, v205
v_exp_f32 v239, v204
v_add_f32 v156, v156, v204
v_add_f32 v157, v157, v204
v_add_f32 v158, v158, v204
v_add_f32 v159, v159, v204
v_add_f32 v140, v140, v204
v_add_f32 v141, v141, v204
v_add_f32 v142, v142, v204
v_add_f32 v143, v143, v204
v_lshlrev_b32 v242, 16, v100
v_and_b32 v248, 0xffff0000, v100
v_mul_f32 v242, v242, v239
v_mul_f32 v248, v248, v239
v_cvt_pk_bf16_f32 v100, v242, v248
v_lshlrev_b32 v242, 16, v101
v_and_b32 v248, 0xffff0000, v101
v_mul_f32 v242, v242, v239
v_mul_f32 v248, v248, v239
v_cvt_pk_bf16_f32 v101, v242, v248
v_lshlrev_b32 v242, 16, v102
v_and_b32 v248, 0xffff0000, v102
v_mul_f32 v242, v242, v239
v_mul_f32 v248, v248, v239
v_cvt_pk_bf16_f32 v102, v242, v248
v_lshlrev_b32 v242, 16, v103
v_and_b32 v248, 0xffff0000, v103
v_mul_f32 v242, v242, v239
v_mul_f32 v248, v248, v239
v_cvt_pk_bf16_f32 v103, v242, v248
v_lshlrev_b32 v242, 16, v104
v_and_b32 v248, 0xffff0000, v104
v_mul_f32 v242, v242, v239
v_mul_f32 v248, v248, v239
v_cvt_pk_bf16_f32 v104, v242, v248
v_lshlrev_b32 v242, 16, v105
v_and_b32 v248, 0xffff0000, v105
v_mul_f32 v242, v242, v239
v_mul_f32 v248, v248, v239
v_cvt_pk_bf16_f32 v105, v242, v248
v_lshlrev_b32 v242, 16, v106
v_and_b32 v248, 0xffff0000, v106
v_mul_f32 v242, v242, v239
v_mul_f32 v248, v248, v239
v_cvt_pk_bf16_f32 v106, v242, v248
v_lshlrev_b32 v242, 16, v107
v_and_b32 v248, 0xffff0000, v107
v_mul_f32 v242, v242, v239
v_mul_f32 v248, v248, v239
v_cvt_pk_bf16_f32 v107, v242, v248
v_lshlrev_b32 v242, 16, v172
v_and_b32 v248, 0xffff0000, v172
v_mul_f32 v242, v242, v239
v_mul_f32 v248, v248, v239
v_cvt_pk_bf16_f32 v172, v242, v248
v_lshlrev_b32 v242, 16, v173
v_and_b32 v248, 0xffff0000, v173
v_mul_f32 v242, v242, v239
v_mul_f32 v248, v248, v239
v_cvt_pk_bf16_f32 v173, v242, v248
v_lshlrev_b32 v242, 16, v174
v_and_b32 v248, 0xffff0000, v174
v_mul_f32 v242, v242, v239
v_mul_f32 v248, v248, v239
v_cvt_pk_bf16_f32 v174, v242, v248
v_lshlrev_b32 v242, 16, v175
v_and_b32 v248, 0xffff0000, v175
v_mul_f32 v242, v242, v239
v_mul_f32 v248, v248, v239
v_cvt_pk_bf16_f32 v175, v242, v248
v_lshlrev_b32 v242, 16, v188
v_and_b32 v248, 0xffff0000, v188
v_mul_f32 v242, v242, v239
v_mul_f32 v248, v248, v239
v_cvt_pk_bf16_f32 v188, v242, v248
v_lshlrev_b32 v242, 16, v189
v_and_b32 v248, 0xffff0000, v189
v_mul_f32 v242, v242, v239
v_mul_f32 v248, v248, v239
v_cvt_pk_bf16_f32 v189, v242, v248
v_lshlrev_b32 v242, 16, v190
v_and_b32 v248, 0xffff0000, v190
v_mul_f32 v242, v242, v239
v_mul_f32 v248, v248, v239
v_cvt_pk_bf16_f32 v190, v242, v248
v_lshlrev_b32 v242, 16, v191
v_and_b32 v248, 0xffff0000, v191
v_mul_f32 v242, v242, v239
v_mul_f32 v248, v248, v239
v_cvt_pk_bf16_f32 v191, v242, v248
v_lshlrev_b32 v242, 16, v96
v_and_b32 v248, 0xffff0000, v96
v_mul_f32 v242, v242, v239
v_mul_f32 v248, v248, v239
v_cvt_pk_bf16_f32 v96, v242, v248
v_lshlrev_b32 v242, 16, v97
v_and_b32 v248, 0xffff0000, v97
v_mul_f32 v242, v242, v239
v_mul_f32 v248, v248, v239
v_cvt_pk_bf16_f32 v97, v242, v248
v_exp_f32 v232, v156
v_exp_f32 v233, v157
v_exp_f32 v234, v158
v_exp_f32 v235, v159
s_nop 1
v_cvt_pk_bf16_f32 v98, v232, v233
v_cvt_pk_bf16_f32 v99, v234, v235
s_branch L2_rare_common
LF_hl_0:
s_mov_b32 s94, 0x10000
s_mov_b32 s3, 0x7c28000
LF_hl2_0:
v_lshlrev_b32 v241, 3, v243
buffer_load_dwordx2 v[240:241], v241, s[16:19], s3 offen sc1
s_sub_u32 s94, s94, 1
s_waitcnt vmcnt(0)
s_cbranch_scc1 LF_hlret_0
v_cmp_ne_u64_e64 s[38:39], s[98:99], v[240:241]
s_and_b64 s[38:39], s[38:39], s[96:97]
s_cbranch_scc1 LF_hl2_0
s_branch LF_hlret_0
L2_rare_common:
v_lshrrev_b32 v232, 4, v243
v_and_b32 v232, 0x30, v232
ds_bpermute_b32 v242, v232, v236 offset:0
ds_bpermute_b32 v248, v232, v236 offset:4
ds_bpermute_b32 v250, v232, v236 offset:8
ds_bpermute_b32 v251, v232, v236 offset:12
s_waitcnt lgkmcnt(0)
v_accvgpr_read_b32 v232, a0
v_accvgpr_read_b32 v233, a1
v_accvgpr_read_b32 v234, a2
v_accvgpr_read_b32 v235, a3
v_mul_f32 v232, v232, v242
v_mul_f32 v233, v233, v248
v_mul_f32 v234, v234, v250
v_mul_f32 v235, v235, v251
v_accvgpr_write_b32 a0, v232
v_accvgpr_write_b32 a1, v233
v_accvgpr_write_b32 a2, v234
v_accvgpr_write_b32 a3, v235
v_accvgpr_read_b32 v232, a16
v_accvgpr_read_b32 v233, a17
v_accvgpr_read_b32 v234, a18
v_accvgpr_read_b32 v235, a19
v_mul_f32 v232, v232, v242
v_mul_f32 v233, v233, v248
v_mul_f32 v234, v234, v250
v_mul_f32 v235, v235, v251
v_accvgpr_write_b32 a16, v232
v_accvgpr_write_b32 a17, v233
v_accvgpr_write_b32 a18, v234
v_accvgpr_write_b32 a19, v235
v_accvgpr_read_b32 v232, a32
v_accvgpr_read_b32 v233, a33
v_accvgpr_read_b32 v234, a34
v_accvgpr_read_b32 v235, a35
v_mul_f32 v232, v232, v242
v_mul_f32 v233, v233, v248
v_mul_f32 v234, v234, v250
v_mul_f32 v235, v235, v251
v_accvgpr_write_b32 a32, v232
v_accvgpr_write_b32 a33, v233
v_accvgpr_write_b32 a34, v234
v_accvgpr_write_b32 a35, v235
v_accvgpr_read_b32 v232, a48
v_accvgpr_read_b32 v233, a49
v_accvgpr_read_b32 v234, a50
v_accvgpr_read_b32 v235, a51
v_mul_f32 v232, v232, v242
v_mul_f32 v233, v233, v248
v_mul_f32 v234, v234, v250
v_mul_f32 v235, v235, v251
v_accvgpr_write_b32 a48, v232
v_accvgpr_write_b32 a49, v233
v_accvgpr_write_b32 a50, v234
v_accvgpr_write_b32 a51, v235
v_accvgpr_read_b32 v232, a64
v_accvgpr_read_b32 v233, a65
v_accvgpr_read_b32 v234, a66
v_accvgpr_read_b32 v235, a67
v_mul_f32 v232, v232, v242
v_mul_f32 v233, v233, v248
v_mul_f32 v234, v234, v250
v_mul_f32 v235, v235, v251
v_accvgpr_write_b32 a64, v232
v_accvgpr_write_b32 a65, v233
v_accvgpr_write_b32 a66, v234
v_accvgpr_write_b32 a67, v235
v_accvgpr_read_b32 v232, a80
v_accvgpr_read_b32 v233, a81
v_accvgpr_read_b32 v234, a82
v_accvgpr_read_b32 v235, a83
v_mul_f32 v232, v232, v242
v_mul_f32 v233, v233, v248
v_mul_f32 v234, v234, v250
v_mul_f32 v235, v235, v251
v_accvgpr_write_b32 a80, v232
v_accvgpr_write_b32 a81, v233
v_accvgpr_write_b32 a82, v234
v_accvgpr_write_b32 a83, v235
v_accvgpr_read_b32 v232, a96
v_accvgpr_read_b32 v233, a97
v_accvgpr_read_b32 v234, a98
v_accvgpr_read_b32 v235, a99
v_mul_f32 v232, v232, v242
v_mul_f32 v233, v233, v248
v_mul_f32 v234, v234, v250
v_mul_f32 v235, v235, v251
v_accvgpr_write_b32 a96, v232
v_accvgpr_write_b32 a97, v233
v_accvgpr_write_b32 a98, v234
v_accvgpr_write_b32 a99, v235
v_accvgpr_read_b32 v232, a112
v_accvgpr_read_b32 v233, a113
v_accvgpr_read_b32 v234, a114
v_accvgpr_read_b32 v235, a115
v_mul_f32 v232, v232, v242
v_mul_f32 v233, v233, v248
v_mul_f32 v234, v234, v250
v_mul_f32 v235, v235, v251
v_accvgpr_write_b32 a112, v232
v_accvgpr_write_b32 a113, v233
v_accvgpr_write_b32 a114, v234
v_accvgpr_write_b32 a115, v235
v_accvgpr_read_b32 v232, a128
v_accvgpr_read_b32 v233, a129
v_accvgpr_read_b32 v234, a130
v_accvgpr_read_b32 v235, a131
v_mul_f32 v232, v232, v242
v_mul_f32 v233, v233, v248
v_mul_f32 v234, v234, v250
v_mul_f32 v235, v235, v251
v_accvgpr_write_b32 a128, v232
v_accvgpr_write_b32 a129, v233
v_accvgpr_write_b32 a130, v234
v_accvgpr_write_b32 a131, v235
v_accvgpr_read_b32 v232, a144
v_accvgpr_read_b32 v233, a145
v_accvgpr_read_b32 v234, a146
v_accvgpr_read_b32 v235, a147
v_mul_f32 v232, v232, v242
v_mul_f32 v233, v233, v248
v_mul_f32 v234, v234, v250
v_mul_f32 v235, v235, v251
v_accvgpr_write_b32 a144, v232
v_accvgpr_write_b32 a145, v233
v_accvgpr_write_b32 a146, v234
v_accvgpr_write_b32 a147, v235
v_accvgpr_read_b32 v232, a160
v_accvgpr_read_b32 v233, a161
v_accvgpr_read_b32 v234, a162
v_accvgpr_read_b32 v235, a163
v_mul_f32 v232, v232, v242
v_mul_f32 v233, v233, v248
v_mul_f32 v234, v234, v250
v_mul_f32 v235, v235, v251
v_accvgpr_write_b32 a160, v232
v_accvgpr_write_b32 a161, v233
v_accvgpr_write_b32 a162, v234
v_accvgpr_write_b32 a163, v235
v_accvgpr_read_b32 v232, a176
v_accvgpr_read_b32 v233, a177
v_accvgpr_read_b32 v234, a178
v_accvgpr_read_b32 v235, a179
v_mul_f32 v232, v232, v242
v_mul_f32 v233, v233, v248
v_mul_f32 v234, v234, v250
v_mul_f32 v235, v235, v251
v_accvgpr_write_b32 a176, v232
v_accvgpr_write_b32 a177, v233
v_accvgpr_write_b32 a178, v234
v_accvgpr_write_b32 a179, v235
v_accvgpr_read_b32 v232, a192
v_accvgpr_read_b32 v233, a193
v_accvgpr_read_b32 v234, a194
v_accvgpr_read_b32 v235, a195
v_mul_f32 v232, v232, v242
v_mul_f32 v233, v233, v248
v_mul_f32 v234, v234, v250
v_mul_f32 v235, v235, v251
v_accvgpr_write_b32 a192, v232
v_accvgpr_write_b32 a193, v233
v_accvgpr_write_b32 a194, v234
v_accvgpr_write_b32 a195, v235
v_accvgpr_read_b32 v232, a208
v_accvgpr_read_b32 v233, a209
v_accvgpr_read_b32 v234, a210
v_accvgpr_read_b32 v235, a211
v_mul_f32 v232, v232, v242
v_mul_f32 v233, v233, v248
v_mul_f32 v234, v234, v250
v_mul_f32 v235, v235, v251
v_accvgpr_write_b32 a208, v232
v_accvgpr_write_b32 a209, v233
v_accvgpr_write_b32 a210, v234
v_accvgpr_write_b32 a211, v235
v_accvgpr_read_b32 v232, a224
v_accvgpr_read_b32 v233, a225
v_accvgpr_read_b32 v234, a226
v_accvgpr_read_b32 v235, a227
v_mul_f32 v232, v232, v242
v_mul_f32 v233, v233, v248
v_mul_f32 v234, v234, v250
v_mul_f32 v235, v235, v251
v_accvgpr_write_b32 a224, v232
v_accvgpr_write_b32 a225, v233
v_accvgpr_write_b32 a226, v234
v_accvgpr_write_b32 a227, v235
v_accvgpr_read_b32 v232, a240
v_accvgpr_read_b32 v233, a241
v_accvgpr_read_b32 v234, a242
v_accvgpr_read_b32 v235, a243
v_mul_f32 v232, v232, v242
v_mul_f32 v233, v233, v248
v_mul_f32 v234, v234, v250
v_mul_f32 v235, v235, v251
v_accvgpr_write_b32 a240, v232
v_accvgpr_write_b32 a241, v233
v_accvgpr_write_b32 a242, v234
v_accvgpr_write_b32 a243, v235
v_lshrrev_b32 v232, 4, v243
v_and_b32 v232, 0x30, v232
ds_bpermute_b32 v242, v232, v237 offset:0
ds_bpermute_b32 v248, v232, v237 offset:4
ds_bpermute_b32 v250, v232, v237 offset:8
ds_bpermute_b32 v251, v232, v237 offset:12
s_waitcnt lgkmcnt(0)
v_accvgpr_read_b32 v232, a4
v_accvgpr_read_b32 v233, a5
v_accvgpr_read_b32 v234, a6
v_accvgpr_read_b32 v235, a7
v_mul_f32 v232, v232, v242
v_mul_f32 v233, v233, v248
v_mul_f32 v234, v234, v250
v_mul_f32 v235, v235, v251
v_accvgpr_write_b32 a4, v232
v_accvgpr_write_b32 a5, v233
v_accvgpr_write_b32 a6, v234
v_accvgpr_write_b32 a7, v235
v_accvgpr_read_b32 v232, a20
v_accvgpr_read_b32 v233, a21
v_accvgpr_read_b32 v234, a22
v_accvgpr_read_b32 v235, a23
v_mul_f32 v232, v232, v242
v_mul_f32 v233, v233, v248
v_mul_f32 v234, v234, v250
v_mul_f32 v235, v235, v251
v_accvgpr_write_b32 a20, v232
v_accvgpr_write_b32 a21, v233
v_accvgpr_write_b32 a22, v234
v_accvgpr_write_b32 a23, v235
v_accvgpr_read_b32 v232, a36
v_accvgpr_read_b32 v233, a37
v_accvgpr_read_b32 v234, a38
v_accvgpr_read_b32 v235, a39
v_mul_f32 v232, v232, v242
v_mul_f32 v233, v233, v248
v_mul_f32 v234, v234, v250
v_mul_f32 v235, v235, v251
v_accvgpr_write_b32 a36, v232
v_accvgpr_write_b32 a37, v233
v_accvgpr_write_b32 a38, v234
v_accvgpr_write_b32 a39, v235
v_accvgpr_read_b32 v232, a52
v_accvgpr_read_b32 v233, a53
v_accvgpr_read_b32 v234, a54
v_accvgpr_read_b32 v235, a55
v_mul_f32 v232, v232, v242
v_mul_f32 v233, v233, v248
v_mul_f32 v234, v234, v250
v_mul_f32 v235, v235, v251
v_accvgpr_write_b32 a52, v232
v_accvgpr_write_b32 a53, v233
v_accvgpr_write_b32 a54, v234
v_accvgpr_write_b32 a55, v235
v_accvgpr_read_b32 v232, a68
v_accvgpr_read_b32 v233, a69
v_accvgpr_read_b32 v234, a70
v_accvgpr_read_b32 v235, a71
v_mul_f32 v232, v232, v242
v_mul_f32 v233, v233, v248
v_mul_f32 v234, v234, v250
v_mul_f32 v235, v235, v251
v_accvgpr_write_b32 a68, v232
v_accvgpr_write_b32 a69, v233
v_accvgpr_write_b32 a70, v234
v_accvgpr_write_b32 a71, v235
v_accvgpr_read_b32 v232, a84
v_accvgpr_read_b32 v233, a85
v_accvgpr_read_b32 v234, a86
v_accvgpr_read_b32 v235, a87
v_mul_f32 v232, v232, v242
v_mul_f32 v233, v233, v248
v_mul_f32 v234, v234, v250
v_mul_f32 v235, v235, v251
v_accvgpr_write_b32 a84, v232
v_accvgpr_write_b32 a85, v233
v_accvgpr_write_b32 a86, v234
v_accvgpr_write_b32 a87, v235
v_accvgpr_read_b32 v232, a100
v_accvgpr_read_b32 v233, a101
v_accvgpr_read_b32 v234, a102
v_accvgpr_read_b32 v235, a103
v_mul_f32 v232, v232, v242
v_mul_f32 v233, v233, v248
v_mul_f32 v234, v234, v250
v_mul_f32 v235, v235, v251
v_accvgpr_write_b32 a100, v232
v_accvgpr_write_b32 a101, v233
v_accvgpr_write_b32 a102, v234
v_accvgpr_write_b32 a103, v235
v_accvgpr_read_b32 v232, a116
v_accvgpr_read_b32 v233, a117
v_accvgpr_read_b32 v234, a118
v_accvgpr_read_b32 v235, a119
v_mul_f32 v232, v232, v242
v_mul_f32 v233, v233, v248
v_mul_f32 v234, v234, v250
v_mul_f32 v235, v235, v251
v_accvgpr_write_b32 a116, v232
v_accvgpr_write_b32 a117, v233
v_accvgpr_write_b32 a118, v234
v_accvgpr_write_b32 a119, v235
v_accvgpr_read_b32 v232, a132
v_accvgpr_read_b32 v233, a133
v_accvgpr_read_b32 v234, a134
v_accvgpr_read_b32 v235, a135
v_mul_f32 v232, v232, v242
v_mul_f32 v233, v233, v248
v_mul_f32 v234, v234, v250
v_mul_f32 v235, v235, v251
v_accvgpr_write_b32 a132, v232
v_accvgpr_write_b32 a133, v233
v_accvgpr_write_b32 a134, v234
v_accvgpr_write_b32 a135, v235
v_accvgpr_read_b32 v232, a148
v_accvgpr_read_b32 v233, a149
v_accvgpr_read_b32 v234, a150
v_accvgpr_read_b32 v235, a151
v_mul_f32 v232, v232, v242
v_mul_f32 v233, v233, v248
v_mul_f32 v234, v234, v250
v_mul_f32 v235, v235, v251
v_accvgpr_write_b32 a148, v232
v_accvgpr_write_b32 a149, v233
v_accvgpr_write_b32 a150, v234
v_accvgpr_write_b32 a151, v235
v_accvgpr_read_b32 v232, a164
v_accvgpr_read_b32 v233, a165
v_accvgpr_read_b32 v234, a166
v_accvgpr_read_b32 v235, a167
v_mul_f32 v232, v232, v242
v_mul_f32 v233, v233, v248
v_mul_f32 v234, v234, v250
v_mul_f32 v235, v235, v251
v_accvgpr_write_b32 a164, v232
v_accvgpr_write_b32 a165, v233
v_accvgpr_write_b32 a166, v234
v_accvgpr_write_b32 a167, v235
v_accvgpr_read_b32 v232, a180
v_accvgpr_read_b32 v233, a181
v_accvgpr_read_b32 v234, a182
v_accvgpr_read_b32 v235, a183
v_mul_f32 v232, v232, v242
v_mul_f32 v233, v233, v248
v_mul_f32 v234, v234, v250
v_mul_f32 v235, v235, v251
v_accvgpr_write_b32 a180, v232
v_accvgpr_write_b32 a181, v233
v_accvgpr_write_b32 a182, v234
v_accvgpr_write_b32 a183, v235
v_accvgpr_read_b32 v232, a196
v_accvgpr_read_b32 v233, a197
v_accvgpr_read_b32 v234, a198
v_accvgpr_read_b32 v235, a199
v_mul_f32 v232, v232, v242
v_mul_f32 v233, v233, v248
v_mul_f32 v234, v234, v250
v_mul_f32 v235, v235, v251
v_accvgpr_write_b32 a196, v232
v_accvgpr_write_b32 a197, v233
v_accvgpr_write_b32 a198, v234
v_accvgpr_write_b32 a199, v235
v_accvgpr_read_b32 v232, a212
v_accvgpr_read_b32 v233, a213
v_accvgpr_read_b32 v234, a214
v_accvgpr_read_b32 v235, a215
v_mul_f32 v232, v232, v242
v_mul_f32 v233, v233, v248
v_mul_f32 v234, v234, v250
v_mul_f32 v235, v235, v251
v_accvgpr_write_b32 a212, v232
v_accvgpr_write_b32 a213, v233
v_accvgpr_write_b32 a214, v234
v_accvgpr_write_b32 a215, v235
v_accvgpr_read_b32 v232, a228
v_accvgpr_read_b32 v233, a229
v_accvgpr_read_b32 v234, a230
v_accvgpr_read_b32 v235, a231
v_mul_f32 v232, v232, v242
v_mul_f32 v233, v233, v248
v_mul_f32 v234, v234, v250
v_mul_f32 v235, v235, v251
v_accvgpr_write_b32 a228, v232
v_accvgpr_write_b32 a229, v233
v_accvgpr_write_b32 a230, v234
v_accvgpr_write_b32 a231, v235
v_accvgpr_read_b32 v232, a244
v_accvgpr_read_b32 v233, a245
v_accvgpr_read_b32 v234, a246
v_accvgpr_read_b32 v235, a247
v_mul_f32 v232, v232, v242
v_mul_f32 v233, v233, v248
v_mul_f32 v234, v234, v250
v_mul_f32 v235, v235, v251
v_accvgpr_write_b32 a244, v232
v_accvgpr_write_b32 a245, v233
v_accvgpr_write_b32 a246, v234
v_accvgpr_write_b32 a247, v235
L2_rare_commonB:
v_lshrrev_b32 v232, 4, v243
v_and_b32 v232, 0x30, v232
ds_bpermute_b32 v242, v232, v238 offset:0
ds_bpermute_b32 v248, v232, v238 offset:4
ds_bpermute_b32 v250, v232, v238 offset:8
ds_bpermute_b32 v251, v232, v238 offset:12
s_waitcnt lgkmcnt(0)
v_accvgpr_read_b32 v232, a8
v_accvgpr_read_b32 v233, a9
v_accvgpr_read_b32 v234, a10
v_accvgpr_read_b32 v235, a11
v_mul_f32 v232, v232, v242
v_mul_f32 v233, v233, v248
v_mul_f32 v234, v234, v250
v_mul_f32 v235, v235, v251
v_accvgpr_write_b32 a8, v232
v_accvgpr_write_b32 a9, v233
v_accvgpr_write_b32 a10, v234
v_accvgpr_write_b32 a11, v235
v_accvgpr_read_b32 v232, a24
v_accvgpr_read_b32 v233, a25
v_accvgpr_read_b32 v234, a26
v_accvgpr_read_b32 v235, a27
v_mul_f32 v232, v232, v242
v_mul_f32 v233, v233, v248
v_mul_f32 v234, v234, v250
v_mul_f32 v235, v235, v251
v_accvgpr_write_b32 a24, v232
v_accvgpr_write_b32 a25, v233
v_accvgpr_write_b32 a26, v234
v_accvgpr_write_b32 a27, v235
v_accvgpr_read_b32 v232, a40
v_accvgpr_read_b32 v233, a41
v_accvgpr_read_b32 v234, a42
v_accvgpr_read_b32 v235, a43
v_mul_f32 v232, v232, v242
v_mul_f32 v233, v233, v248
v_mul_f32 v234, v234, v250
v_mul_f32 v235, v235, v251
v_accvgpr_write_b32 a40, v232
v_accvgpr_write_b32 a41, v233
v_accvgpr_write_b32 a42, v234
v_accvgpr_write_b32 a43, v235
v_accvgpr_read_b32 v232, a56
v_accvgpr_read_b32 v233, a57
v_accvgpr_read_b32 v234, a58
v_accvgpr_read_b32 v235, a59
v_mul_f32 v232, v232, v242
v_mul_f32 v233, v233, v248
v_mul_f32 v234, v234, v250
v_mul_f32 v235, v235, v251
v_accvgpr_write_b32 a56, v232
v_accvgpr_write_b32 a57, v233
v_accvgpr_write_b32 a58, v234
v_accvgpr_write_b32 a59, v235
v_accvgpr_read_b32 v232, a72
v_accvgpr_read_b32 v233, a73
v_accvgpr_read_b32 v234, a74
v_accvgpr_read_b32 v235, a75
v_mul_f32 v232, v232, v242
v_mul_f32 v233, v233, v248
v_mul_f32 v234, v234, v250
v_mul_f32 v235, v235, v251
v_accvgpr_write_b32 a72, v232
v_accvgpr_write_b32 a73, v233
v_accvgpr_write_b32 a74, v234
v_accvgpr_write_b32 a75, v235
v_accvgpr_read_b32 v232, a88
v_accvgpr_read_b32 v233, a89
v_accvgpr_read_b32 v234, a90
v_accvgpr_read_b32 v235, a91
v_mul_f32 v232, v232, v242
v_mul_f32 v233, v233, v248
v_mul_f32 v234, v234, v250
v_mul_f32 v235, v235, v251
v_accvgpr_write_b32 a88, v232
v_accvgpr_write_b32 a89, v233
v_accvgpr_write_b32 a90, v234
v_accvgpr_write_b32 a91, v235
v_accvgpr_read_b32 v232, a104
v_accvgpr_read_b32 v233, a105
v_accvgpr_read_b32 v234, a106
v_accvgpr_read_b32 v235, a107
v_mul_f32 v232, v232, v242
v_mul_f32 v233, v233, v248
v_mul_f32 v234, v234, v250
v_mul_f32 v235, v235, v251
v_accvgpr_write_b32 a104, v232
v_accvgpr_write_b32 a105, v233
v_accvgpr_write_b32 a106, v234
v_accvgpr_write_b32 a107, v235
v_accvgpr_read_b32 v232, a120
v_accvgpr_read_b32 v233, a121
v_accvgpr_read_b32 v234, a122
v_accvgpr_read_b32 v235, a123
v_mul_f32 v232, v232, v242
v_mul_f32 v233, v233, v248
v_mul_f32 v234, v234, v250
v_mul_f32 v235, v235, v251
v_accvgpr_write_b32 a120, v232
v_accvgpr_write_b32 a121, v233
v_accvgpr_write_b32 a122, v234
v_accvgpr_write_b32 a123, v235
v_accvgpr_read_b32 v232, a136
v_accvgpr_read_b32 v233, a137
v_accvgpr_read_b32 v234, a138
v_accvgpr_read_b32 v235, a139
v_mul_f32 v232, v232, v242
v_mul_f32 v233, v233, v248
v_mul_f32 v234, v234, v250
v_mul_f32 v235, v235, v251
v_accvgpr_write_b32 a136, v232
v_accvgpr_write_b32 a137, v233
v_accvgpr_write_b32 a138, v234
v_accvgpr_write_b32 a139, v235
v_accvgpr_read_b32 v232, a152
v_accvgpr_read_b32 v233, a153
v_accvgpr_read_b32 v234, a154
v_accvgpr_read_b32 v235, a155
v_mul_f32 v232, v232, v242
v_mul_f32 v233, v233, v248
v_mul_f32 v234, v234, v250
v_mul_f32 v235, v235, v251
v_accvgpr_write_b32 a152, v232
v_accvgpr_write_b32 a153, v233
v_accvgpr_write_b32 a154, v234
v_accvgpr_write_b32 a155, v235
v_accvgpr_read_b32 v232, a168
v_accvgpr_read_b32 v233, a169
v_accvgpr_read_b32 v234, a170
v_accvgpr_read_b32 v235, a171
v_mul_f32 v232, v232, v242
v_mul_f32 v233, v233, v248
v_mul_f32 v234, v234, v250
v_mul_f32 v235, v235, v251
v_accvgpr_write_b32 a168, v232
v_accvgpr_write_b32 a169, v233
v_accvgpr_write_b32 a170, v234
v_accvgpr_write_b32 a171, v235
v_accvgpr_read_b32 v232, a184
v_accvgpr_read_b32 v233, a185
v_accvgpr_read_b32 v234, a186
v_accvgpr_read_b32 v235, a187
v_mul_f32 v232, v232, v242
v_mul_f32 v233, v233, v248
v_mul_f32 v234, v234, v250
v_mul_f32 v235, v235, v251
v_accvgpr_write_b32 a184, v232
v_accvgpr_write_b32 a185, v233
v_accvgpr_write_b32 a186, v234
v_accvgpr_write_b32 a187, v235
v_accvgpr_read_b32 v232, a200
v_accvgpr_read_b32 v233, a201
v_accvgpr_read_b32 v234, a202
v_accvgpr_read_b32 v235, a203
v_mul_f32 v232, v232, v242
v_mul_f32 v233, v233, v248
v_mul_f32 v234, v234, v250
v_mul_f32 v235, v235, v251
v_accvgpr_write_b32 a200, v232
v_accvgpr_write_b32 a201, v233
v_accvgpr_write_b32 a202, v234
v_accvgpr_write_b32 a203, v235
v_accvgpr_read_b32 v232, a216
v_accvgpr_read_b32 v233, a217
v_accvgpr_read_b32 v234, a218
v_accvgpr_read_b32 v235, a219
v_mul_f32 v232, v232, v242
v_mul_f32 v233, v233, v248
v_mul_f32 v234, v234, v250
v_mul_f32 v235, v235, v251
v_accvgpr_write_b32 a216, v232
v_accvgpr_write_b32 a217, v233
v_accvgpr_write_b32 a218, v234
v_accvgpr_write_b32 a219, v235
v_accvgpr_read_b32 v232, a232
v_accvgpr_read_b32 v233, a233
v_accvgpr_read_b32 v234, a234
v_accvgpr_read_b32 v235, a235
v_mul_f32 v232, v232, v242
v_mul_f32 v233, v233, v248
v_mul_f32 v234, v234, v250
v_mul_f32 v235, v235, v251
v_accvgpr_write_b32 a232, v232
v_accvgpr_write_b32 a233, v233
v_accvgpr_write_b32 a234, v234
v_accvgpr_write_b32 a235, v235
v_accvgpr_read_b32 v232, a248
v_accvgpr_read_b32 v233, a249
v_accvgpr_read_b32 v234, a250
v_accvgpr_read_b32 v235, a251
v_mul_f32 v232, v232, v242
v_mul_f32 v233, v233, v248
v_mul_f32 v234, v234, v250
v_mul_f32 v235, v235, v251
v_accvgpr_write_b32 a248, v232
v_accvgpr_write_b32 a249, v233
v_accvgpr_write_b32 a250, v234
v_accvgpr_write_b32 a251, v235
v_lshrrev_b32 v232, 4, v243
v_and_b32 v232, 0x30, v232
ds_bpermute_b32 v242, v232, v239 offset:0
ds_bpermute_b32 v248, v232, v239 offset:4
ds_bpermute_b32 v250, v232, v239 offset:8
ds_bpermute_b32 v251, v232, v239 offset:12
s_waitcnt lgkmcnt(0)
v_accvgpr_read_b32 v232, a12
v_accvgpr_read_b32 v233, a13
v_accvgpr_read_b32 v234, a14
v_accvgpr_read_b32 v235, a15
v_mul_f32 v232, v232, v242
v_mul_f32 v233, v233, v248
v_mul_f32 v234, v234, v250
v_mul_f32 v235, v235, v251
v_accvgpr_write_b32 a12, v232
v_accvgpr_write_b32 a13, v233
v_accvgpr_write_b32 a14, v234
v_accvgpr_write_b32 a15, v235
v_accvgpr_read_b32 v232, a28
v_accvgpr_read_b32 v233, a29
v_accvgpr_read_b32 v234, a30
v_accvgpr_read_b32 v235, a31
v_mul_f32 v232, v232, v242
v_mul_f32 v233, v233, v248
v_mul_f32 v234, v234, v250
v_mul_f32 v235, v235, v251
v_accvgpr_write_b32 a28, v232
v_accvgpr_write_b32 a29, v233
v_accvgpr_write_b32 a30, v234
v_accvgpr_write_b32 a31, v235
v_accvgpr_read_b32 v232, a44
v_accvgpr_read_b32 v233, a45
v_accvgpr_read_b32 v234, a46
v_accvgpr_read_b32 v235, a47
v_mul_f32 v232, v232, v242
v_mul_f32 v233, v233, v248
v_mul_f32 v234, v234, v250
v_mul_f32 v235, v235, v251
v_accvgpr_write_b32 a44, v232
v_accvgpr_write_b32 a45, v233
v_accvgpr_write_b32 a46, v234
v_accvgpr_write_b32 a47, v235
v_accvgpr_read_b32 v232, a60
v_accvgpr_read_b32 v233, a61
v_accvgpr_read_b32 v234, a62
v_accvgpr_read_b32 v235, a63
v_mul_f32 v232, v232, v242
v_mul_f32 v233, v233, v248
v_mul_f32 v234, v234, v250
v_mul_f32 v235, v235, v251
v_accvgpr_write_b32 a60, v232
v_accvgpr_write_b32 a61, v233
v_accvgpr_write_b32 a62, v234
v_accvgpr_write_b32 a63, v235
v_accvgpr_read_b32 v232, a76
v_accvgpr_read_b32 v233, a77
v_accvgpr_read_b32 v234, a78
v_accvgpr_read_b32 v235, a79
v_mul_f32 v232, v232, v242
v_mul_f32 v233, v233, v248
v_mul_f32 v234, v234, v250
v_mul_f32 v235, v235, v251
v_accvgpr_write_b32 a76, v232
v_accvgpr_write_b32 a77, v233
v_accvgpr_write_b32 a78, v234
v_accvgpr_write_b32 a79, v235
v_accvgpr_read_b32 v232, a92
v_accvgpr_read_b32 v233, a93
v_accvgpr_read_b32 v234, a94
v_accvgpr_read_b32 v235, a95
v_mul_f32 v232, v232, v242
v_mul_f32 v233, v233, v248
v_mul_f32 v234, v234, v250
v_mul_f32 v235, v235, v251
v_accvgpr_write_b32 a92, v232
v_accvgpr_write_b32 a93, v233
v_accvgpr_write_b32 a94, v234
v_accvgpr_write_b32 a95, v235
v_accvgpr_read_b32 v232, a108
v_accvgpr_read_b32 v233, a109
v_accvgpr_read_b32 v234, a110
v_accvgpr_read_b32 v235, a111
v_mul_f32 v232, v232, v242
v_mul_f32 v233, v233, v248
v_mul_f32 v234, v234, v250
v_mul_f32 v235, v235, v251
v_accvgpr_write_b32 a108, v232
v_accvgpr_write_b32 a109, v233
v_accvgpr_write_b32 a110, v234
v_accvgpr_write_b32 a111, v235
v_accvgpr_read_b32 v232, a124
v_accvgpr_read_b32 v233, a125
v_accvgpr_read_b32 v234, a126
v_accvgpr_read_b32 v235, a127
v_mul_f32 v232, v232, v242
v_mul_f32 v233, v233, v248
v_mul_f32 v234, v234, v250
v_mul_f32 v235, v235, v251
v_accvgpr_write_b32 a124, v232
v_accvgpr_write_b32 a125, v233
v_accvgpr_write_b32 a126, v234
v_accvgpr_write_b32 a127, v235
v_accvgpr_read_b32 v232, a140
v_accvgpr_read_b32 v233, a141
v_accvgpr_read_b32 v234, a142
v_accvgpr_read_b32 v235, a143
v_mul_f32 v232, v232, v242
v_mul_f32 v233, v233, v248
v_mul_f32 v234, v234, v250
v_mul_f32 v235, v235, v251
v_accvgpr_write_b32 a140, v232
v_accvgpr_write_b32 a141, v233
v_accvgpr_write_b32 a142, v234
v_accvgpr_write_b32 a143, v235
v_accvgpr_read_b32 v232, a156
v_accvgpr_read_b32 v233, a157
v_accvgpr_read_b32 v234, a158
v_accvgpr_read_b32 v235, a159
v_mul_f32 v232, v232, v242
v_mul_f32 v233, v233, v248
v_mul_f32 v234, v234, v250
v_mul_f32 v235, v235, v251
v_accvgpr_write_b32 a156, v232
v_accvgpr_write_b32 a157, v233
v_accvgpr_write_b32 a158, v234
v_accvgpr_write_b32 a159, v235
v_accvgpr_read_b32 v232, a172
v_accvgpr_read_b32 v233, a173
v_accvgpr_read_b32 v234, a174
v_accvgpr_read_b32 v235, a175
v_mul_f32 v232, v232, v242
v_mul_f32 v233, v233, v248
v_mul_f32 v234, v234, v250
v_mul_f32 v235, v235, v251
v_accvgpr_write_b32 a172, v232
v_accvgpr_write_b32 a173, v233
v_accvgpr_write_b32 a174, v234
v_accvgpr_write_b32 a175, v235
v_accvgpr_read_b32 v232, a188
v_accvgpr_read_b32 v233, a189
v_accvgpr_read_b32 v234, a190
v_accvgpr_read_b32 v235, a191
v_mul_f32 v232, v232, v242
v_mul_f32 v233, v233, v248
v_mul_f32 v234, v234, v250
v_mul_f32 v235, v235, v251
v_accvgpr_write_b32 a188, v232
v_accvgpr_write_b32 a189, v233
v_accvgpr_write_b32 a190, v234
v_accvgpr_write_b32 a191, v235
v_accvgpr_read_b32 v232, a204
v_accvgpr_read_b32 v233, a205
v_accvgpr_read_b32 v234, a206
v_accvgpr_read_b32 v235, a207
v_mul_f32 v232, v232, v242
v_mul_f32 v233, v233, v248
v_mul_f32 v234, v234, v250
v_mul_f32 v235, v235, v251
v_accvgpr_write_b32 a204, v232
v_accvgpr_write_b32 a205, v233
v_accvgpr_write_b32 a206, v234
v_accvgpr_write_b32 a207, v235
v_accvgpr_read_b32 v232, a220
v_accvgpr_read_b32 v233, a221
v_accvgpr_read_b32 v234, a222
v_accvgpr_read_b32 v235, a223
v_mul_f32 v232, v232, v242
v_mul_f32 v233, v233, v248
v_mul_f32 v234, v234, v250
v_mul_f32 v235, v235, v251
v_accvgpr_write_b32 a220, v232
v_accvgpr_write_b32 a221, v233
v_accvgpr_write_b32 a222, v234
v_accvgpr_write_b32 a223, v235
v_accvgpr_read_b32 v232, a236
v_accvgpr_read_b32 v233, a237
v_accvgpr_read_b32 v234, a238
v_accvgpr_read_b32 v235, a239
v_mul_f32 v232, v232, v242
v_mul_f32 v233, v233, v248
v_mul_f32 v234, v234, v250
v_mul_f32 v235, v235, v251
v_accvgpr_write_b32 a236, v232
v_accvgpr_write_b32 a237, v233
v_accvgpr_write_b32 a238, v234
v_accvgpr_write_b32 a239, v235
v_accvgpr_read_b32 v232, a252
v_accvgpr_read_b32 v233, a253
v_accvgpr_read_b32 v234, a254
v_accvgpr_read_b32 v235, a255
v_mul_f32 v232, v232, v242
v_mul_f32 v233, v233, v248
v_mul_f32 v234, v234, v250
v_mul_f32 v235, v235, v251
v_accvgpr_write_b32 a252, v232
v_accvgpr_write_b32 a253, v233
v_accvgpr_write_b32 a254, v234
v_accvgpr_write_b32 a255, v235
s_nop 3
s_cmp_eq_u32 s36, 0
s_cbranch_scc1 L2_rr0
s_cmp_eq_u32 s36, 1
s_cbranch_scc1 L2_rr1
s_cmp_eq_u32 s36, 2
s_cbranch_scc1 L2_rr2
s_cmp_eq_u32 s36, 3
s_cbranch_scc1 L2_rr3
s_cmp_eq_u32 s36, 4
s_cbranch_scc1 L2_rr4
s_cmp_eq_u32 s36, 5
s_cbranch_scc1 L2_rr5
s_cmp_eq_u32 s36, 6
s_cbranch_scc1 L2_rr6
s_cmp_eq_u32 s36, 7
s_cbranch_scc1 L2_rr7
s_cmp_eq_u32 s36, 8
s_cbranch_scc1 L2_rr8
s_cmp_eq_u32 s36, 9
s_cbranch_scc1 L2_rr9
s_cmp_eq_u32 s36, 10
s_cbranch_scc1 L2_rr10
s_cmp_eq_u32 s36, 11
s_cbranch_scc1 L2_rr11
s_cmp_eq_u32 s36, 12
s_cbranch_scc1 L2_rr12
s_cmp_eq_u32 s36, 13
s_cbranch_scc1 L2_rr13
s_cmp_eq_u32 s36, 14
s_cbranch_scc1 L2_rr14
s_cmp_eq_u32 s36, 15
s_cbranch_scc1 L2_rr15
s_cmp_eq_u32 s36, 16
s_cbranch_scc1 L2_rr16
L2_rr17:
s_waitcnt lgkmcnt(0)
s_branch L2_ret17
L2_rr16:
s_waitcnt lgkmcnt(0)
s_branch L2_ret16
L2_rr15:
s_waitcnt lgkmcnt(0)
s_branch L2_ret15
L2_rr14:
s_waitcnt lgkmcnt(0)
s_branch L2_ret14
L2_rr13:
s_waitcnt lgkmcnt(0)
s_branch L2_ret13
L2_rr12:
s_waitcnt lgkmcnt(0)
s_branch L2_ret12
L2_rr11:
s_waitcnt lgkmcnt(0)
s_branch L2_ret11
L2_rr10:
s_waitcnt lgkmcnt(0)
s_branch L2_ret10
L2_rr9:
s_waitcnt lgkmcnt(0)
s_branch L2_ret9
L2_rr8:
s_waitcnt lgkmcnt(0)
s_branch L2_ret8
L2_rr7:
s_waitcnt lgkmcnt(0)
s_branch L2_ret7
L2_rr6:
s_waitcnt lgkmcnt(0)
s_branch L2_ret6
L2_rr5:
s_waitcnt lgkmcnt(0)
s_branch L2_ret5
L2_rr4:
s_waitcnt lgkmcnt(0)
s_branch L2_ret4
L2_rr3:
s_waitcnt lgkmcnt(0)
s_branch L2_ret3
L2_rr2:
s_waitcnt lgkmcnt(0)
s_branch L2_ret2
L2_rr1:
s_waitcnt lgkmcnt(0)
s_branch L2_ret1
L2_rr0:
s_waitcnt lgkmcnt(0)
s_branch L2_ret0
s_endpgm
.section .rodata,"a"
.p2align 6
.amdhsa_kernel standalone__hybrid_graph_tf_graphgps__graph_kernel
  .amdhsa_next_free_vgpr 512
  .amdhsa_next_free_sgpr 102
  .amdhsa_accum_offset 256
  .amdhsa_group_segment_fixed_size 0
  .amdhsa_kernarg_size 96
  .amdhsa_user_sgpr_count 2
  .amdhsa_user_sgpr_kernarg_segment_ptr 1
  .amdhsa_system_sgpr_workgroup_id_x 1
.end_amdhsa_kernel
```
